```python
import torch

def _softmax(x, axis=-1):
    return torch.softmax(x, dim=axis)

def _gelu(x):
    return torch.nn.functional.gelu(x, approximate='tanh')

def _silu(x):
    return torch.nn.functional.silu(x)

def _sigmoid(x):
    return torch.sigmoid(x)

def _layernorm(x, axis=-1, eps=1e-05):
    m = x.mean(dim=axis, keepdim=True)
    v = x.var(dim=axis, keepdim=True, unbiased=False)
    return (x - m) / torch.sqrt(v + eps)

def _scatter_add(tgt, idx, src, axis=0):
    return tgt.clone().index_add_(axis, idx, src)

def _segment_sum(src, seg, n):
    out = torch.zeros((n,) + src.shape[1:], dtype=src.dtype)
    return out.index_add_(0, seg, src)

def _pad(x, pw):
    flat = tuple((v for pair in reversed(pw) for v in pair))
    return torch.nn.functional.pad(x, flat)
kernel_name = 'gated_mix__compressed_kv_cla__memory_aug_recurrent_mem_tr__prompt'

def setup_inputs():

    _w = lambda a: (lambda t: t.to(torch.bfloat16) if t.is_floating_point() else t)(torch.as_tensor(a))

    def _A_setup():
        B, H, Sq, Sk, D, M = (1, 32, 2048, 2048, 128, 512)
        Dc = 4 * D
        return {'x': _w((lambda *s: torch.randn(*s, dtype=torch.bfloat16) * 0.05)(B, Sq, M)), 'c_kv': _w((lambda *s: torch.randn(*s, dtype=torch.bfloat16) * 0.8)(B, Sk, Dc)), 'w_q': _w((lambda *s: torch.randn(*s, dtype=torch.bfloat16) * 6.4)(M, H, D) * M ** (-0.5)), 'w_uk': _w((lambda *s: torch.randn(*s, dtype=torch.bfloat16) * 6.4)(Dc, H, D) * Dc ** (-0.5)), 'w_uv': _w((lambda *s: torch.randn(*s, dtype=torch.bfloat16) * 0.8)(Dc, H, D) * Dc ** (-0.5)), 'w_o': _w((lambda *s: torch.randn(*s, dtype=torch.bfloat16) * 0.8)(H, D, M) * (H * D) ** (-0.5))}
    _A_in = _A_setup()

    def _B_setup():
        B, S, Dm = (1, 2048, 512)
        H, Dh = (32, 128)
        M, seg = (8, 32)
        seg = min(seg, S)
        S = S // seg * seg
        return {'x': _w((lambda *s: torch.randn(*s, dtype=torch.bfloat16) * 0.05)(B, S, Dm)), 'mem0': _w((lambda *s: torch.randn(*s, dtype=torch.bfloat16) * 0.8)(B, M, Dm)), 'Wq': _w((lambda *s: torch.randn(*s, dtype=torch.bfloat16) * 3.2)(Dm, H, Dh) * Dm ** (-0.5)), 'Wk': _w((lambda *s: torch.randn(*s, dtype=torch.bfloat16) * 3.2)(Dm, H, Dh) * Dm ** (-0.5)), 'Wv': _w((lambda *s: torch.randn(*s, dtype=torch.bfloat16) * 0.8)(Dm, H, Dh) * Dm ** (-0.5)), 'Wo': _w((lambda *s: torch.randn(*s, dtype=torch.bfloat16) * 0.8)(H, Dh, Dm) * (H * Dh) ** (-0.5)), 'seg_len': seg}
    _B_in = _B_setup()
    return {'A_x': _A_in['x'], 'A_c_kv': _A_in['c_kv'], 'A_w_q': _A_in['w_q'], 'A_w_uk': _A_in['w_uk'], 'A_w_uv': _A_in['w_uv'], 'A_w_o': _A_in['w_o'], 'B_x': _B_in['x'], 'B_mem0': _B_in['mem0'], 'B_Wq': _B_in['Wq'], 'B_Wk': _B_in['Wk'], 'B_Wv': _B_in['Wv'], 'B_Wo': _B_in['Wo'], 'B_seg_len': _B_in['seg_len'], 'gate_w': _w((lambda *s: torch.randn(*s, dtype=torch.bfloat16) * 0.05)(512) * 16.0)}

def reference(A_x, A_c_kv, A_w_q, A_w_uk, A_w_uv, A_w_o, B_x, B_mem0, B_Wq, B_Wk, B_Wv, B_Wo, B_seg_len, gate_w):

    def _A_ref(x, c_kv, w_q, w_uk, w_uv, w_o):
        B, Sq, M = (x.shape[0], x.shape[1], x.shape[2])
        Sk = c_kv.shape[1]
        H, D = (w_q.shape[1], w_q.shape[2])
        q = torch.einsum('bqm,mhd->bhqd', x, w_q)
        k = torch.einsum('bkc,chd->bhkd', c_kv, w_uk)
        v = torch.einsum('bkc,chd->bhkd', c_kv, w_uv)
        scores = torch.einsum('bhqd,bhkd->bhqk', q, k) * D ** (-0.5)
        off = Sk - Sq
        qi = torch.arange(Sq)[:, None]
        kj = torch.arange(Sk)[None, :]
        cmask = kj <= qi + off
        scores = torch.where(cmask[None, None], scores, -1000000000.0)
        p = _softmax(scores, axis=-1)
        ctx = torch.einsum('bhqk,bhkd->bhqd', p, v)
        return torch.einsum('bhqd,hdm->bqm', ctx, w_o)

    def _B_ref(x, mem0, Wq, Wk, Wv, Wo, seg_len):
        B, S, Dm = x.shape
        H, Dh = (Wq.shape[1], Wq.shape[2])
        M = mem0.shape[1]
        scale = Dh ** (-0.5)
        n_seg = S // seg_len
        L = M + seg_len
        idx = torch.arange(L)
        mask = (idx[:, None] < M) | (idx[:, None] >= idx[None, :])
        mem = mem0
        outs = []
        for s in range(n_seg):
            xs = x[:, s * seg_len:(s + 1) * seg_len, :].clone()
            h = torch.concatenate([mem, xs], axis=1)
            q = torch.einsum('btd,dhe->bhte', h, Wq)
            k = torch.einsum('btd,dhe->bhte', h, Wk)
            v = torch.einsum('btd,dhe->bhte', h, Wv)
            scores = torch.einsum('bhqe,bhke->bhqk', q, k) * scale
            scores = torch.where(mask[None, None], scores, -1000000000.0)
            p = _softmax(scores, axis=-1)
            o = torch.einsum('bhqk,bhke->bhqe', p, v)
            o = torch.einsum('bhte,hed->btd', o, Wo)
            mem = o[:, :M, :].clone()
            outs.append(o[:, M:, :])
        return torch.concatenate(outs, axis=1)
    x = A_x
    g = _sigmoid((x * gate_w).sum(-1, keepdims=True))
    a = _A_ref(x, A_c_kv, A_w_q, A_w_uk, A_w_uv, A_w_o)
    b = _B_ref(x, B_mem0, B_Wq, B_Wk, B_Wv, B_Wo, B_seg_len)
    return g * a + (1 - g) * b
```

```asm
; @launch kernel=proj_kernel grid=(192,1,1) block=(256,1,1) lds=163840
; @launch kernel=team_kernel grid=(256,1,1) block=(256,1,1) lds=163840
; @launch kernel=attn_kernel grid=(256,1,1) block=(256,1,1) lds=163840
; @launch kernel=oproj_kernel grid=(256,1,1) block=(256,1,1) lds=163840
; @launch kernel=follow_kernel grid=(256,1,1) block=(256,1,1) lds=163840
; @launch kernel=final_kernel grid=(256,1,1) block=(256,1,1) lds=163840
.amdgcn_target "amdgcn-amd-amdhsa--gfx950"
.text
.globl proj_kernel
.p2align 8
.type proj_kernel,@function
proj_kernel:
  s_cmp_ge_u32 s2, 192
  s_cbranch_scc1 P_exit_1
  v_lshrrev_b32 v3, 6, v0
  v_and_b32 v1, 63, v0
  v_readfirstlane_b32 s16, v3
  v_lshlrev_b32 v2, 4, v1
  s_load_dwordx2 s[4:5], s[0:1], 128
  s_waitcnt lgkmcnt(0)
  s_and_b32 s5, s5, 0xffff
  s_mov_b32 s6, 268435456
  s_mov_b32 s7, 0x20000
  s_and_b32 s40, s2, 31
  s_lshr_b32 s41, s2, 5
  s_mul_i32 s42, s41, 43
  s_lshr_b32 s42, s42, 7
  s_mul_i32 s43, s42, 3
  s_sub_u32 s41, s41, s43
  s_mov_b32 s43, 2
  s_mov_b32 s23, 32
  s_lshr_b32 s29, s16, 1
  s_cmp_eq_u32 s29, 0
  s_cselect_b32 s26, 2, 8
  s_cselect_b32 s27, 3, 4
  s_cselect_b32 s28, 9, 10
  s_cmp_eq_u32 s41, 1
  s_cselect_b32 s26, s27, s26
  s_cmp_eq_u32 s41, 2
  s_cselect_b32 s26, s28, s26
  s_lshl_b32 s26, s26, 3
  s_load_dwordx2 s[8:9], s[0:1], s26
  s_cmp_eq_u32 s41, 1
  s_cselect_b32 s26, 8, 0
  s_load_dwordx2 s[12:13], s[0:1], s26
  s_cmp_eq_u32 s29, 0
  s_cselect_b32 s21, 0, 3
  s_cselect_b32 s27, 1, 2
  s_cselect_b32 s28, 4, 5
  s_cmp_eq_u32 s41, 1
  s_cselect_b32 s21, s27, s21
  s_cmp_eq_u32 s41, 2
  s_cselect_b32 s21, s28, s21
  s_lshl_b32 s21, s21, 5
  s_add_u32 s21, s21, s40
  s_lshl_b32 s21, s21, 6
  s_add_u32 s21, s21, s42
  s_and_b32 s27, s16, 1
  s_lshl_b32 s21, s21, 1
  s_add_u32 s21, s21, s27
  s_lshl_b32 s21, s21, 12
  s_lshl_b32 s22, s43, 13
  s_lshl_b32 s19, s42, 15
  s_lshl_b32 s20, s43, 15
  s_lshl_b32 s17, s40, 1
  s_add_u32 s17, s17, s27
  s_lshl_b32 s17, s17, 7
  s_mov_b32 s18, 8192
  s_cmp_eq_u32 s41, 0
  s_cselect_b32 s24, 0x3e0293ee, 1.0
  s_waitcnt lgkmcnt(0)
  s_and_b32 s9, s9, 0xffff
  s_mov_b32 s10, 4194304
  s_mov_b32 s11, 0x20000
  s_and_b32 s13, s13, 0xffff
  s_mov_b32 s14, 2097152
  s_mov_b32 s15, 0x20000
  v_and_b32 v144, 31, v1
  v_lshrrev_b32 v145, 5, v1
  v_and_b32 v146, 15, v1
  v_or_b32 v147, 0, v145
  v_xor_b32 v147, v147, v146
  v_lshlrev_b32 v147, 4, v147
  v_lshl_add_u32 v8, v144, 8, v147
  v_or_b32 v147, 2, v145
  v_xor_b32 v147, v147, v146
  v_lshlrev_b32 v147, 4, v147
  v_lshl_add_u32 v9, v144, 8, v147
  v_or_b32 v147, 4, v145
  v_xor_b32 v147, v147, v146
  v_lshlrev_b32 v147, 4, v147
  v_lshl_add_u32 v10, v144, 8, v147
  v_or_b32 v147, 6, v145
  v_xor_b32 v147, v147, v146
  v_lshlrev_b32 v147, 4, v147
  v_lshl_add_u32 v11, v144, 8, v147
  v_or_b32 v147, 8, v145
  v_xor_b32 v147, v147, v146
  v_lshlrev_b32 v147, 4, v147
  v_lshl_add_u32 v12, v144, 8, v147
  v_or_b32 v147, 10, v145
  v_xor_b32 v147, v147, v146
  v_lshlrev_b32 v147, 4, v147
  v_lshl_add_u32 v13, v144, 8, v147
  v_or_b32 v147, 12, v145
  v_xor_b32 v147, v147, v146
  v_lshlrev_b32 v147, 4, v147
  v_lshl_add_u32 v14, v144, 8, v147
  v_or_b32 v147, 14, v145
  v_xor_b32 v147, v147, v146
  v_lshlrev_b32 v147, 4, v147
  v_lshl_add_u32 v15, v144, 8, v147
  v_lshrrev_b32 v144, 4, v1
  s_lshl_b32 s26, s16, 8
  v_add_u32 v145, 0, v144
  v_and_b32 v147, 15, v145
  v_xor_b32 v147, v147, v146
  v_lshlrev_b32 v147, 4, v147
  v_lshl_add_u32 v147, v145, 10, v147
  v_add_u32 v16, s26, v147
  v_add_u32 v145, 4, v144
  v_and_b32 v147, 15, v145
  v_xor_b32 v147, v147, v146
  v_lshlrev_b32 v147, 4, v147
  v_lshl_add_u32 v147, v145, 10, v147
  v_add_u32 v17, s26, v147
  v_add_u32 v145, 8, v144
  v_and_b32 v147, 15, v145
  v_xor_b32 v147, v147, v146
  v_lshlrev_b32 v147, 4, v147
  v_lshl_add_u32 v147, v145, 10, v147
  v_add_u32 v18, s26, v147
  v_add_u32 v145, 12, v144
  v_and_b32 v147, 15, v145
  v_xor_b32 v147, v147, v146
  v_lshlrev_b32 v147, 4, v147
  v_lshl_add_u32 v147, v145, 10, v147
  v_add_u32 v19, s26, v147
  v_add_u32 v145, 16, v144
  v_and_b32 v147, 15, v145
  v_xor_b32 v147, v147, v146
  v_lshlrev_b32 v147, 4, v147
  v_lshl_add_u32 v147, v145, 10, v147
  v_add_u32 v20, s26, v147
  v_add_u32 v145, 20, v144
  v_and_b32 v147, 15, v145
  v_xor_b32 v147, v147, v146
  v_lshlrev_b32 v147, 4, v147
  v_lshl_add_u32 v147, v145, 10, v147
  v_add_u32 v21, s26, v147
  v_add_u32 v145, 24, v144
  v_and_b32 v147, 15, v145
  v_xor_b32 v147, v147, v146
  v_lshlrev_b32 v147, 4, v147
  v_lshl_add_u32 v147, v145, 10, v147
  v_add_u32 v22, s26, v147
  v_add_u32 v145, 28, v144
  v_and_b32 v147, 15, v145
  v_xor_b32 v147, v147, v146
  v_lshlrev_b32 v147, 4, v147
  v_lshl_add_u32 v147, v145, 10, v147
  v_add_u32 v23, s26, v147
  v_lshrrev_b32 v144, 3, v1
  v_mul_lo_u32 v144, v144, s18
  v_and_b32 v145, 7, v1
  v_lshl_add_u32 v144, v145, 4, v144
  s_lshl_b32 s28, s16, 15
  s_add_u32 s28, s28, 32768
  s_lshl_b32 s29, s18, 3
  s_add_u32 m0, s28, 0
  s_nop 0
  buffer_load_dwordx4 v144, s[8:11], s17 offen lds
  s_add_u32 s17, s17, s29
  s_add_u32 m0, s28, 1024
  s_nop 0
  buffer_load_dwordx4 v144, s[8:11], s17 offen lds
  s_add_u32 s17, s17, s29
  s_add_u32 m0, s28, 2048
  s_nop 0
  buffer_load_dwordx4 v144, s[8:11], s17 offen lds
  s_add_u32 s17, s17, s29
  s_add_u32 m0, s28, 3072
  s_nop 0
  buffer_load_dwordx4 v144, s[8:11], s17 offen lds
  s_add_u32 s17, s17, s29
  s_add_u32 m0, s28, 4096
  s_nop 0
  buffer_load_dwordx4 v144, s[8:11], s17 offen lds
  s_add_u32 s17, s17, s29
  s_add_u32 m0, s28, 5120
  s_nop 0
  buffer_load_dwordx4 v144, s[8:11], s17 offen lds
  s_add_u32 s17, s17, s29
  s_add_u32 m0, s28, 6144
  s_nop 0
  buffer_load_dwordx4 v144, s[8:11], s17 offen lds
  s_add_u32 s17, s17, s29
  s_add_u32 m0, s28, 7168
  s_nop 0
  buffer_load_dwordx4 v144, s[8:11], s17 offen lds
  s_add_u32 s17, s17, s29
  s_add_u32 m0, s28, 8192
  s_nop 0
  buffer_load_dwordx4 v144, s[8:11], s17 offen lds
  s_add_u32 s17, s17, s29
  s_add_u32 m0, s28, 9216
  s_nop 0
  buffer_load_dwordx4 v144, s[8:11], s17 offen lds
  s_add_u32 s17, s17, s29
  s_add_u32 m0, s28, 10240
  s_nop 0
  buffer_load_dwordx4 v144, s[8:11], s17 offen lds
  s_add_u32 s17, s17, s29
  s_add_u32 m0, s28, 11264
  s_nop 0
  buffer_load_dwordx4 v144, s[8:11], s17 offen lds
  s_add_u32 s17, s17, s29
  s_add_u32 m0, s28, 12288
  s_nop 0
  buffer_load_dwordx4 v144, s[8:11], s17 offen lds
  s_add_u32 s17, s17, s29
  s_add_u32 m0, s28, 13312
  s_nop 0
  buffer_load_dwordx4 v144, s[8:11], s17 offen lds
  s_add_u32 s17, s17, s29
  s_add_u32 m0, s28, 14336
  s_nop 0
  buffer_load_dwordx4 v144, s[8:11], s17 offen lds
  s_add_u32 s17, s17, s29
  s_add_u32 m0, s28, 15360
  s_nop 0
  buffer_load_dwordx4 v144, s[8:11], s17 offen lds
  s_add_u32 s17, s17, s29
  s_add_u32 m0, s28, 16384
  s_nop 0
  buffer_load_dwordx4 v144, s[8:11], s17 offen lds
  s_add_u32 s17, s17, s29
  s_add_u32 m0, s28, 17408
  s_nop 0
  buffer_load_dwordx4 v144, s[8:11], s17 offen lds
  s_add_u32 s17, s17, s29
  s_add_u32 m0, s28, 18432
  s_nop 0
  buffer_load_dwordx4 v144, s[8:11], s17 offen lds
  s_add_u32 s17, s17, s29
  s_add_u32 m0, s28, 19456
  s_nop 0
  buffer_load_dwordx4 v144, s[8:11], s17 offen lds
  s_add_u32 s17, s17, s29
  s_add_u32 m0, s28, 20480
  s_nop 0
  buffer_load_dwordx4 v144, s[8:11], s17 offen lds
  s_add_u32 s17, s17, s29
  s_add_u32 m0, s28, 21504
  s_nop 0
  buffer_load_dwordx4 v144, s[8:11], s17 offen lds
  s_add_u32 s17, s17, s29
  s_add_u32 m0, s28, 22528
  s_nop 0
  buffer_load_dwordx4 v144, s[8:11], s17 offen lds
  s_add_u32 s17, s17, s29
  s_add_u32 m0, s28, 23552
  s_nop 0
  buffer_load_dwordx4 v144, s[8:11], s17 offen lds
  s_add_u32 s17, s17, s29
  s_add_u32 m0, s28, 24576
  s_nop 0
  buffer_load_dwordx4 v144, s[8:11], s17 offen lds
  s_add_u32 s17, s17, s29
  s_add_u32 m0, s28, 25600
  s_nop 0
  buffer_load_dwordx4 v144, s[8:11], s17 offen lds
  s_add_u32 s17, s17, s29
  s_add_u32 m0, s28, 26624
  s_nop 0
  buffer_load_dwordx4 v144, s[8:11], s17 offen lds
  s_add_u32 s17, s17, s29
  s_add_u32 m0, s28, 27648
  s_nop 0
  buffer_load_dwordx4 v144, s[8:11], s17 offen lds
  s_add_u32 s17, s17, s29
  s_add_u32 m0, s28, 28672
  s_nop 0
  buffer_load_dwordx4 v144, s[8:11], s17 offen lds
  s_add_u32 s17, s17, s29
  s_add_u32 m0, s28, 29696
  s_nop 0
  buffer_load_dwordx4 v144, s[8:11], s17 offen lds
  s_add_u32 s17, s17, s29
  s_add_u32 m0, s28, 30720
  s_nop 0
  buffer_load_dwordx4 v144, s[8:11], s17 offen lds
  s_add_u32 s17, s17, s29
  s_add_u32 m0, s28, 31744
  s_nop 0
  buffer_load_dwordx4 v144, s[8:11], s17 offen lds
  s_add_u32 s17, s17, s29
  s_lshl_b32 s25, s16, 13
  s_add_u32 m0, s25, 0
  s_nop 0
  buffer_load_dwordx4 v16, s[12:15], s19 offen lds
  s_add_u32 m0, s25, 1024
  s_nop 0
  buffer_load_dwordx4 v17, s[12:15], s19 offen lds
  s_add_u32 m0, s25, 2048
  s_nop 0
  buffer_load_dwordx4 v18, s[12:15], s19 offen lds
  s_add_u32 m0, s25, 3072
  s_nop 0
  buffer_load_dwordx4 v19, s[12:15], s19 offen lds
  s_add_u32 m0, s25, 4096
  s_nop 0
  buffer_load_dwordx4 v20, s[12:15], s19 offen lds
  s_add_u32 m0, s25, 5120
  s_nop 0
  buffer_load_dwordx4 v21, s[12:15], s19 offen lds
  s_add_u32 m0, s25, 6144
  s_nop 0
  buffer_load_dwordx4 v22, s[12:15], s19 offen lds
  s_add_u32 m0, s25, 7168
  s_nop 0
  buffer_load_dwordx4 v23, s[12:15], s19 offen lds
  s_cmp_gt_u32 s23, 1
  s_cselect_b32 s26, s20, 0
  s_add_u32 s19, s19, s26
  s_add_u32 s25, s25, 32768
  s_and_b32 s25, s25, 0x1ffff
  v_bfe_u32 v148, v1, 2, 2
  v_lshrrev_b32 v149, 5, v1
  v_lshl_add_u32 v148, v149, 3, v148
  v_lshlrev_b32 v148, 7, v148
  v_bfe_u32 v149, v1, 4, 1
  v_lshl_add_u32 v148, v149, 5, v148
  v_and_b32 v149, 3, v1
  v_lshl_add_u32 v148, v149, 3, v148
  v_add_u32 v146, s28, v148
  v_add_u32 v147, 512, v146
  s_waitcnt vmcnt(36)
  ds_read_b64_tr_b16 a[0:1], v146 offset:0
  ds_read_b64_tr_b16 a[2:3], v147 offset:0
  ds_read_b64_tr_b16 a[4:5], v146 offset:64
  ds_read_b64_tr_b16 a[6:7], v147 offset:64
  ds_read_b64_tr_b16 a[8:9], v146 offset:2048
  ds_read_b64_tr_b16 a[10:11], v147 offset:2048
  ds_read_b64_tr_b16 a[12:13], v146 offset:2112
  ds_read_b64_tr_b16 a[14:15], v147 offset:2112
  s_waitcnt lgkmcnt(0)
  s_add_u32 m0, s28, 0
  s_nop 0
  buffer_load_dwordx4 v144, s[8:11], s17 offen lds
  s_add_u32 s17, s17, s29
  s_add_u32 m0, s28, 1024
  s_nop 0
  buffer_load_dwordx4 v144, s[8:11], s17 offen lds
  s_add_u32 s17, s17, s29
  s_add_u32 m0, s28, 2048
  s_nop 0
  buffer_load_dwordx4 v144, s[8:11], s17 offen lds
  s_add_u32 s17, s17, s29
  s_add_u32 m0, s28, 3072
  s_nop 0
  buffer_load_dwordx4 v144, s[8:11], s17 offen lds
  s_add_u32 s17, s17, s29
  s_waitcnt vmcnt(36)
  ds_read_b64_tr_b16 a[16:17], v146 offset:4096
  ds_read_b64_tr_b16 a[18:19], v147 offset:4096
  ds_read_b64_tr_b16 a[20:21], v146 offset:4160
  ds_read_b64_tr_b16 a[22:23], v147 offset:4160
  ds_read_b64_tr_b16 a[24:25], v146 offset:6144
  ds_read_b64_tr_b16 a[26:27], v147 offset:6144
  ds_read_b64_tr_b16 a[28:29], v146 offset:6208
  ds_read_b64_tr_b16 a[30:31], v147 offset:6208
  s_waitcnt lgkmcnt(0)
  s_add_u32 m0, s28, 4096
  s_nop 0
  buffer_load_dwordx4 v144, s[8:11], s17 offen lds
  s_add_u32 s17, s17, s29
  s_add_u32 m0, s28, 5120
  s_nop 0
  buffer_load_dwordx4 v144, s[8:11], s17 offen lds
  s_add_u32 s17, s17, s29
  s_add_u32 m0, s28, 6144
  s_nop 0
  buffer_load_dwordx4 v144, s[8:11], s17 offen lds
  s_add_u32 s17, s17, s29
  s_add_u32 m0, s28, 7168
  s_nop 0
  buffer_load_dwordx4 v144, s[8:11], s17 offen lds
  s_add_u32 s17, s17, s29
  s_waitcnt vmcnt(36)
  ds_read_b64_tr_b16 a[32:33], v146 offset:8192
  ds_read_b64_tr_b16 a[34:35], v147 offset:8192
  ds_read_b64_tr_b16 a[36:37], v146 offset:8256
  ds_read_b64_tr_b16 a[38:39], v147 offset:8256
  ds_read_b64_tr_b16 a[40:41], v146 offset:10240
  ds_read_b64_tr_b16 a[42:43], v147 offset:10240
  ds_read_b64_tr_b16 a[44:45], v146 offset:10304
  ds_read_b64_tr_b16 a[46:47], v147 offset:10304
  s_waitcnt lgkmcnt(0)
  s_add_u32 m0, s28, 8192
  s_nop 0
  buffer_load_dwordx4 v144, s[8:11], s17 offen lds
  s_add_u32 s17, s17, s29
  s_add_u32 m0, s28, 9216
  s_nop 0
  buffer_load_dwordx4 v144, s[8:11], s17 offen lds
  s_add_u32 s17, s17, s29
  s_add_u32 m0, s28, 10240
  s_nop 0
  buffer_load_dwordx4 v144, s[8:11], s17 offen lds
  s_add_u32 s17, s17, s29
  s_add_u32 m0, s28, 11264
  s_nop 0
  buffer_load_dwordx4 v144, s[8:11], s17 offen lds
  s_add_u32 s17, s17, s29
  s_waitcnt vmcnt(36)
  ds_read_b64_tr_b16 a[48:49], v146 offset:12288
  ds_read_b64_tr_b16 a[50:51], v147 offset:12288
  ds_read_b64_tr_b16 a[52:53], v146 offset:12352
  ds_read_b64_tr_b16 a[54:55], v147 offset:12352
  ds_read_b64_tr_b16 a[56:57], v146 offset:14336
  ds_read_b64_tr_b16 a[58:59], v147 offset:14336
  ds_read_b64_tr_b16 a[60:61], v146 offset:14400
  ds_read_b64_tr_b16 a[62:63], v147 offset:14400
  s_waitcnt lgkmcnt(0)
  s_add_u32 m0, s28, 12288
  s_nop 0
  buffer_load_dwordx4 v144, s[8:11], s17 offen lds
  s_add_u32 s17, s17, s29
  s_add_u32 m0, s28, 13312
  s_nop 0
  buffer_load_dwordx4 v144, s[8:11], s17 offen lds
  s_add_u32 s17, s17, s29
  s_add_u32 m0, s28, 14336
  s_nop 0
  buffer_load_dwordx4 v144, s[8:11], s17 offen lds
  s_add_u32 s17, s17, s29
  s_add_u32 m0, s28, 15360
  s_nop 0
  buffer_load_dwordx4 v144, s[8:11], s17 offen lds
  s_add_u32 s17, s17, s29
  s_waitcnt vmcnt(36)
  ds_read_b64_tr_b16 a[64:65], v146 offset:16384
  ds_read_b64_tr_b16 a[66:67], v147 offset:16384
  ds_read_b64_tr_b16 a[68:69], v146 offset:16448
  ds_read_b64_tr_b16 a[70:71], v147 offset:16448
  ds_read_b64_tr_b16 a[72:73], v146 offset:18432
  ds_read_b64_tr_b16 a[74:75], v147 offset:18432
  ds_read_b64_tr_b16 a[76:77], v146 offset:18496
  ds_read_b64_tr_b16 a[78:79], v147 offset:18496
  s_waitcnt lgkmcnt(0)
  s_add_u32 m0, s28, 16384
  s_nop 0
  buffer_load_dwordx4 v144, s[8:11], s17 offen lds
  s_add_u32 s17, s17, s29
  s_add_u32 m0, s28, 17408
  s_nop 0
  buffer_load_dwordx4 v144, s[8:11], s17 offen lds
  s_add_u32 s17, s17, s29
  s_add_u32 m0, s28, 18432
  s_nop 0
  buffer_load_dwordx4 v144, s[8:11], s17 offen lds
  s_add_u32 s17, s17, s29
  s_add_u32 m0, s28, 19456
  s_nop 0
  buffer_load_dwordx4 v144, s[8:11], s17 offen lds
  s_add_u32 s17, s17, s29
  s_waitcnt vmcnt(36)
  ds_read_b64_tr_b16 a[80:81], v146 offset:20480
  ds_read_b64_tr_b16 a[82:83], v147 offset:20480
  ds_read_b64_tr_b16 a[84:85], v146 offset:20544
  ds_read_b64_tr_b16 a[86:87], v147 offset:20544
  ds_read_b64_tr_b16 a[88:89], v146 offset:22528
  ds_read_b64_tr_b16 a[90:91], v147 offset:22528
  ds_read_b64_tr_b16 a[92:93], v146 offset:22592
  ds_read_b64_tr_b16 a[94:95], v147 offset:22592
  s_waitcnt lgkmcnt(0)
  s_add_u32 m0, s28, 20480
  s_nop 0
  buffer_load_dwordx4 v144, s[8:11], s17 offen lds
  s_add_u32 s17, s17, s29
  s_add_u32 m0, s28, 21504
  s_nop 0
  buffer_load_dwordx4 v144, s[8:11], s17 offen lds
  s_add_u32 s17, s17, s29
  s_add_u32 m0, s28, 22528
  s_nop 0
  buffer_load_dwordx4 v144, s[8:11], s17 offen lds
  s_add_u32 s17, s17, s29
  s_add_u32 m0, s28, 23552
  s_nop 0
  buffer_load_dwordx4 v144, s[8:11], s17 offen lds
  s_add_u32 s17, s17, s29
  s_waitcnt vmcnt(36)
  ds_read_b64_tr_b16 a[96:97], v146 offset:24576
  ds_read_b64_tr_b16 a[98:99], v147 offset:24576
  ds_read_b64_tr_b16 a[100:101], v146 offset:24640
  ds_read_b64_tr_b16 a[102:103], v147 offset:24640
  ds_read_b64_tr_b16 a[104:105], v146 offset:26624
  ds_read_b64_tr_b16 a[106:107], v147 offset:26624
  ds_read_b64_tr_b16 a[108:109], v146 offset:26688
  ds_read_b64_tr_b16 a[110:111], v147 offset:26688
  s_waitcnt lgkmcnt(0)
  s_add_u32 m0, s28, 24576
  s_nop 0
  buffer_load_dwordx4 v144, s[8:11], s17 offen lds
  s_add_u32 s17, s17, s29
  s_add_u32 m0, s28, 25600
  s_nop 0
  buffer_load_dwordx4 v144, s[8:11], s17 offen lds
  s_add_u32 s17, s17, s29
  s_add_u32 m0, s28, 26624
  s_nop 0
  buffer_load_dwordx4 v144, s[8:11], s17 offen lds
  s_add_u32 s17, s17, s29
  s_add_u32 m0, s28, 27648
  s_nop 0
  buffer_load_dwordx4 v144, s[8:11], s17 offen lds
  s_add_u32 s17, s17, s29
  s_waitcnt vmcnt(36)
  ds_read_b64_tr_b16 a[112:113], v146 offset:28672
  ds_read_b64_tr_b16 a[114:115], v147 offset:28672
  ds_read_b64_tr_b16 a[116:117], v146 offset:28736
  ds_read_b64_tr_b16 a[118:119], v147 offset:28736
  ds_read_b64_tr_b16 a[120:121], v146 offset:30720
  ds_read_b64_tr_b16 a[122:123], v147 offset:30720
  ds_read_b64_tr_b16 a[124:125], v146 offset:30784
  ds_read_b64_tr_b16 a[126:127], v147 offset:30784
  s_waitcnt lgkmcnt(0)
  s_add_u32 m0, s28, 28672
  s_nop 0
  buffer_load_dwordx4 v144, s[8:11], s17 offen lds
  s_add_u32 s17, s17, s29
  s_add_u32 m0, s28, 29696
  s_nop 0
  buffer_load_dwordx4 v144, s[8:11], s17 offen lds
  s_add_u32 s17, s17, s29
  s_add_u32 m0, s28, 30720
  s_nop 0
  buffer_load_dwordx4 v144, s[8:11], s17 offen lds
  s_add_u32 s17, s17, s29
  s_add_u32 m0, s28, 31744
  s_nop 0
  buffer_load_dwordx4 v144, s[8:11], s17 offen lds
  s_add_u32 s17, s17, s29
  s_waitcnt vmcnt(28)
  ds_read_b64_tr_b16 a[128:129], v146 offset:0
  ds_read_b64_tr_b16 a[130:131], v147 offset:0
  ds_read_b64_tr_b16 a[132:133], v146 offset:64
  ds_read_b64_tr_b16 a[134:135], v147 offset:64
  ds_read_b64_tr_b16 a[136:137], v146 offset:2048
  ds_read_b64_tr_b16 a[138:139], v147 offset:2048
  ds_read_b64_tr_b16 a[140:141], v146 offset:2112
  ds_read_b64_tr_b16 a[142:143], v147 offset:2112
  s_waitcnt lgkmcnt(0)
  s_waitcnt vmcnt(24)
  ds_read_b64_tr_b16 a[144:145], v146 offset:4096
  ds_read_b64_tr_b16 a[146:147], v147 offset:4096
  ds_read_b64_tr_b16 a[148:149], v146 offset:4160
  ds_read_b64_tr_b16 a[150:151], v147 offset:4160
  ds_read_b64_tr_b16 a[152:153], v146 offset:6144
  ds_read_b64_tr_b16 a[154:155], v147 offset:6144
  ds_read_b64_tr_b16 a[156:157], v146 offset:6208
  ds_read_b64_tr_b16 a[158:159], v147 offset:6208
  s_waitcnt lgkmcnt(0)
  s_waitcnt vmcnt(20)
  ds_read_b64_tr_b16 a[160:161], v146 offset:8192
  ds_read_b64_tr_b16 a[162:163], v147 offset:8192
  ds_read_b64_tr_b16 a[164:165], v146 offset:8256
  ds_read_b64_tr_b16 a[166:167], v147 offset:8256
  ds_read_b64_tr_b16 a[168:169], v146 offset:10240
  ds_read_b64_tr_b16 a[170:171], v147 offset:10240
  ds_read_b64_tr_b16 a[172:173], v146 offset:10304
  ds_read_b64_tr_b16 a[174:175], v147 offset:10304
  s_waitcnt lgkmcnt(0)
  s_waitcnt vmcnt(16)
  ds_read_b64_tr_b16 a[176:177], v146 offset:12288
  ds_read_b64_tr_b16 a[178:179], v147 offset:12288
  ds_read_b64_tr_b16 a[180:181], v146 offset:12352
  ds_read_b64_tr_b16 a[182:183], v147 offset:12352
  ds_read_b64_tr_b16 a[184:185], v146 offset:14336
  ds_read_b64_tr_b16 a[186:187], v147 offset:14336
  ds_read_b64_tr_b16 a[188:189], v146 offset:14400
  ds_read_b64_tr_b16 a[190:191], v147 offset:14400
  s_waitcnt lgkmcnt(0)
  s_waitcnt vmcnt(12)
  ds_read_b64_tr_b16 a[192:193], v146 offset:16384
  ds_read_b64_tr_b16 a[194:195], v147 offset:16384
  ds_read_b64_tr_b16 a[196:197], v146 offset:16448
  ds_read_b64_tr_b16 a[198:199], v147 offset:16448
  ds_read_b64_tr_b16 a[200:201], v146 offset:18432
  ds_read_b64_tr_b16 a[202:203], v147 offset:18432
  ds_read_b64_tr_b16 a[204:205], v146 offset:18496
  ds_read_b64_tr_b16 a[206:207], v147 offset:18496
  s_waitcnt lgkmcnt(0)
  s_waitcnt vmcnt(8)
  ds_read_b64_tr_b16 a[208:209], v146 offset:20480
  ds_read_b64_tr_b16 a[210:211], v147 offset:20480
  ds_read_b64_tr_b16 a[212:213], v146 offset:20544
  ds_read_b64_tr_b16 a[214:215], v147 offset:20544
  ds_read_b64_tr_b16 a[216:217], v146 offset:22528
  ds_read_b64_tr_b16 a[218:219], v147 offset:22528
  ds_read_b64_tr_b16 a[220:221], v146 offset:22592
  ds_read_b64_tr_b16 a[222:223], v147 offset:22592
  s_waitcnt lgkmcnt(0)
  s_waitcnt vmcnt(4)
  ds_read_b64_tr_b16 a[224:225], v146 offset:24576
  ds_read_b64_tr_b16 a[226:227], v147 offset:24576
  ds_read_b64_tr_b16 a[228:229], v146 offset:24640
  ds_read_b64_tr_b16 a[230:231], v147 offset:24640
  ds_read_b64_tr_b16 a[232:233], v146 offset:26624
  ds_read_b64_tr_b16 a[234:235], v147 offset:26624
  ds_read_b64_tr_b16 a[236:237], v146 offset:26688
  ds_read_b64_tr_b16 a[238:239], v147 offset:26688
  s_waitcnt lgkmcnt(0)
  s_waitcnt vmcnt(0)
  ds_read_b64_tr_b16 a[240:241], v146 offset:28672
  ds_read_b64_tr_b16 a[242:243], v147 offset:28672
  ds_read_b64_tr_b16 a[244:245], v146 offset:28736
  ds_read_b64_tr_b16 a[246:247], v147 offset:28736
  ds_read_b64_tr_b16 a[248:249], v146 offset:30720
  ds_read_b64_tr_b16 a[250:251], v147 offset:30720
  ds_read_b64_tr_b16 a[252:253], v146 offset:30784
  ds_read_b64_tr_b16 a[254:255], v147 offset:30784
  s_waitcnt lgkmcnt(0)
  s_barrier
  s_add_u32 m0, s25, 0
  s_nop 0
  buffer_load_dwordx4 v16, s[12:15], s19 offen lds
  s_add_u32 m0, s25, 1024
  s_nop 0
  buffer_load_dwordx4 v17, s[12:15], s19 offen lds
  s_add_u32 m0, s25, 2048
  s_nop 0
  buffer_load_dwordx4 v18, s[12:15], s19 offen lds
  s_add_u32 m0, s25, 3072
  s_nop 0
  buffer_load_dwordx4 v19, s[12:15], s19 offen lds
  s_add_u32 m0, s25, 4096
  s_nop 0
  buffer_load_dwordx4 v20, s[12:15], s19 offen lds
  s_add_u32 m0, s25, 5120
  s_nop 0
  buffer_load_dwordx4 v21, s[12:15], s19 offen lds
  s_add_u32 m0, s25, 6144
  s_nop 0
  buffer_load_dwordx4 v22, s[12:15], s19 offen lds
  s_add_u32 m0, s25, 7168
  s_nop 0
  buffer_load_dwordx4 v23, s[12:15], s19 offen lds
  s_cmp_gt_u32 s23, 2
  s_cselect_b32 s26, s20, 0
  s_add_u32 s19, s19, s26
  s_add_u32 s25, s25, 32768
  s_and_b32 s25, s25, 0x1ffff
  s_waitcnt vmcnt(0)
  s_barrier
  s_cmp_eq_u32 s41, 0
  s_cselect_b32 s26, 0, s16
  s_cmp_ge_u32 s26, 2
  s_cbranch_scc1 P_v_2
  s_mov_b32 s27, s21
  s_mov_b32 s21, 149946368
  ds_read_b128 v[24:27], v8 offset:0
  ds_read_b128 v[28:31], v9 offset:0
  ds_read_b128 v[32:35], v10 offset:0
  ds_read_b128 v[36:39], v11 offset:0
  ds_read_b128 v[40:43], v12 offset:0
  ds_read_b128 v[44:47], v13 offset:0
.p2align 6
G_top_4:
  s_waitcnt lgkmcnt(5)
  v_mfma_f32_32x32x16_bf16 v[64:79], a[0:3], v[24:27], 0
  s_add_u32 m0, s25, 0
  ds_read_b128 v[48:51], v14 offset:0
  v_mfma_f32_32x32x16_bf16 v[80:95], a[4:7], v[24:27], 0
  s_waitcnt lgkmcnt(5)
  buffer_load_dwordx4 v16, s[12:15], s19 offen lds
  v_mfma_f32_32x32x16_bf16 v[64:79], a[8:11], v[28:31], v[64:79]
  ds_read_b128 v[52:55], v15 offset:0
  v_mul_f32 v96, s24, v96
  v_mul_f32 v97, s24, v97
  v_mfma_f32_32x32x16_bf16 v[80:95], a[12:15], v[28:31], v[80:95]
  s_waitcnt lgkmcnt(5)
  v_cvt_pk_bf16_f32 v128, v96, v97
  v_mul_f32 v98, s24, v98
  v_mfma_f32_32x32x16_bf16 v[64:79], a[16:19], v[32:35], v[64:79]
  s_add_u32 m0, s25, 1024
  ds_read_b128 v[24:27], v8 offset:8192
  v_mul_f32 v99, s24, v99
  v_cvt_pk_bf16_f32 v129, v98, v99
  v_mfma_f32_32x32x16_bf16 v[80:95], a[20:23], v[32:35], v[80:95]
  s_waitcnt lgkmcnt(5)
  buffer_load_dwordx4 v17, s[12:15], s19 offen lds
  v_mul_f32 v100, s24, v100
  v_mul_f32 v101, s24, v101
  v_mfma_f32_32x32x16_bf16 v[64:79], a[24:27], v[36:39], v[64:79]
  ds_read_b128 v[28:31], v9 offset:8192
  v_cvt_pk_bf16_f32 v130, v100, v101
  v_mul_f32 v102, s24, v102
  v_mfma_f32_32x32x16_bf16 v[80:95], a[28:31], v[36:39], v[80:95]
  s_waitcnt lgkmcnt(5)
  v_mul_f32 v103, s24, v103
  v_cvt_pk_bf16_f32 v131, v102, v103
  v_mfma_f32_32x32x16_bf16 v[64:79], a[32:35], v[40:43], v[64:79]
  s_add_u32 m0, s25, 2048
  ds_read_b128 v[32:35], v10 offset:8192
  v_mul_f32 v104, s24, v104
  v_mul_f32 v105, s24, v105
  v_mfma_f32_32x32x16_bf16 v[80:95], a[36:39], v[40:43], v[80:95]
  s_waitcnt lgkmcnt(5)
  buffer_load_dwordx4 v18, s[12:15], s19 offen lds
  v_cvt_pk_bf16_f32 v132, v104, v105
  v_mul_f32 v106, s24, v106
  v_mfma_f32_32x32x16_bf16 v[64:79], a[40:43], v[44:47], v[64:79]
  ds_read_b128 v[36:39], v11 offset:8192
  v_mul_f32 v107, s24, v107
  v_cvt_pk_bf16_f32 v133, v106, v107
  v_mfma_f32_32x32x16_bf16 v[80:95], a[44:47], v[44:47], v[80:95]
  s_waitcnt lgkmcnt(5)
  v_mul_f32 v108, s24, v108
  v_mul_f32 v109, s24, v109
  v_mfma_f32_32x32x16_bf16 v[64:79], a[48:51], v[48:51], v[64:79]
  s_add_u32 m0, s25, 3072
  ds_read_b128 v[40:43], v12 offset:8192
  v_cvt_pk_bf16_f32 v134, v108, v109
  v_mul_f32 v110, s24, v110
  v_mfma_f32_32x32x16_bf16 v[80:95], a[52:55], v[48:51], v[80:95]
  s_waitcnt lgkmcnt(5)
  buffer_load_dwordx4 v19, s[12:15], s19 offen lds
  v_mul_f32 v111, s24, v111
  v_cvt_pk_bf16_f32 v135, v110, v111
  v_mfma_f32_32x32x16_bf16 v[64:79], a[56:59], v[52:55], v[64:79]
  ds_read_b128 v[44:47], v13 offset:8192
  v_mul_f32 v112, s24, v112
  v_mul_f32 v113, s24, v113
  v_mfma_f32_32x32x16_bf16 v[80:95], a[60:63], v[52:55], v[80:95]
  s_waitcnt lgkmcnt(5)
  v_cvt_pk_bf16_f32 v136, v112, v113
  v_mul_f32 v114, s24, v114
  v_mfma_f32_32x32x16_bf16 v[64:79], a[64:67], v[24:27], v[64:79]
  s_add_u32 m0, s25, 4096
  ds_read_b128 v[48:51], v14 offset:8192
  v_mul_f32 v115, s24, v115
  v_cvt_pk_bf16_f32 v137, v114, v115
  v_mfma_f32_32x32x16_bf16 v[80:95], a[68:71], v[24:27], v[80:95]
  s_waitcnt lgkmcnt(5)
  buffer_load_dwordx4 v20, s[12:15], s19 offen lds
  v_mul_f32 v116, s24, v116
  v_mul_f32 v117, s24, v117
  v_mfma_f32_32x32x16_bf16 v[64:79], a[72:75], v[28:31], v[64:79]
  ds_read_b128 v[52:55], v15 offset:8192
  v_cvt_pk_bf16_f32 v138, v116, v117
  v_mul_f32 v118, s24, v118
  v_mfma_f32_32x32x16_bf16 v[80:95], a[76:79], v[28:31], v[80:95]
  s_waitcnt lgkmcnt(5)
  v_mul_f32 v119, s24, v119
  v_cvt_pk_bf16_f32 v139, v118, v119
  v_mfma_f32_32x32x16_bf16 v[64:79], a[80:83], v[32:35], v[64:79]
  s_add_u32 m0, s25, 5120
  ds_read_b128 v[24:27], v8 offset:16384
  v_mul_f32 v120, s24, v120
  v_mul_f32 v121, s24, v121
  v_mfma_f32_32x32x16_bf16 v[80:95], a[84:87], v[32:35], v[80:95]
  s_waitcnt lgkmcnt(5)
  buffer_load_dwordx4 v21, s[12:15], s19 offen lds
  v_cvt_pk_bf16_f32 v140, v120, v121
  v_mul_f32 v122, s24, v122
  v_mfma_f32_32x32x16_bf16 v[64:79], a[88:91], v[36:39], v[64:79]
  ds_read_b128 v[28:31], v9 offset:16384
  v_mul_f32 v123, s24, v123
  v_cvt_pk_bf16_f32 v141, v122, v123
  v_mfma_f32_32x32x16_bf16 v[80:95], a[92:95], v[36:39], v[80:95]
  s_waitcnt lgkmcnt(5)
  v_mul_f32 v124, s24, v124
  v_mul_f32 v125, s24, v125
  v_mfma_f32_32x32x16_bf16 v[64:79], a[96:99], v[40:43], v[64:79]
  s_add_u32 m0, s25, 6144
  ds_read_b128 v[32:35], v10 offset:16384
  v_cvt_pk_bf16_f32 v142, v124, v125
  v_mul_f32 v126, s24, v126
  v_mfma_f32_32x32x16_bf16 v[80:95], a[100:103], v[40:43], v[80:95]
  s_waitcnt lgkmcnt(5)
  buffer_load_dwordx4 v22, s[12:15], s19 offen lds
  v_mul_f32 v127, s24, v127
  v_cvt_pk_bf16_f32 v143, v126, v127
  v_mfma_f32_32x32x16_bf16 v[64:79], a[104:107], v[44:47], v[64:79]
  ds_read_b128 v[36:39], v11 offset:16384
  v_mfma_f32_32x32x16_bf16 v[80:95], a[108:111], v[44:47], v[80:95]
  s_waitcnt lgkmcnt(5)
  v_mfma_f32_32x32x16_bf16 v[64:79], a[112:115], v[48:51], v[64:79]
  s_add_u32 m0, s25, 7168
  ds_read_b128 v[40:43], v12 offset:16384
  v_mfma_f32_32x32x16_bf16 v[80:95], a[116:119], v[48:51], v[80:95]
  s_waitcnt lgkmcnt(5)
  buffer_load_dwordx4 v23, s[12:15], s19 offen lds
  v_mfma_f32_32x32x16_bf16 v[64:79], a[120:123], v[52:55], v[64:79]
  s_cmp_gt_u32 s23, 3
  ds_read_b128 v[44:47], v13 offset:16384
  v_mfma_f32_32x32x16_bf16 v[80:95], a[124:127], v[52:55], v[80:95]
  s_waitcnt lgkmcnt(5)
  s_cselect_b32 s26, s20, 0
  v_mfma_f32_32x32x16_bf16 v[64:79], a[128:131], v[24:27], v[64:79]
  s_add_u32 s19, s19, s26
  ds_read_b128 v[48:51], v14 offset:16384
  v_mfma_f32_32x32x16_bf16 v[80:95], a[132:135], v[24:27], v[80:95]
  s_waitcnt lgkmcnt(5)
  s_add_u32 s25, s25, 32768
  v_mfma_f32_32x32x16_bf16 v[64:79], a[136:139], v[28:31], v[64:79]
  s_and_b32 s25, s25, 0x1ffff
  ds_read_b128 v[52:55], v15 offset:16384
  v_mfma_f32_32x32x16_bf16 v[80:95], a[140:143], v[28:31], v[80:95]
  s_waitcnt lgkmcnt(5)
  buffer_store_dwordx4 v[128:131], v2, s[4:7], s21 offen offset:0
  v_mfma_f32_32x32x16_bf16 v[64:79], a[144:147], v[32:35], v[64:79]
  ds_read_b128 v[24:27], v8 offset:24576
  v_mfma_f32_32x32x16_bf16 v[80:95], a[148:151], v[32:35], v[80:95]
  s_waitcnt lgkmcnt(5)
  v_mfma_f32_32x32x16_bf16 v[64:79], a[152:155], v[36:39], v[64:79]
  ds_read_b128 v[28:31], v9 offset:24576
  v_mfma_f32_32x32x16_bf16 v[80:95], a[156:159], v[36:39], v[80:95]
  s_waitcnt lgkmcnt(5)
  buffer_store_dwordx4 v[132:135], v2, s[4:7], s21 offen offset:1024
  v_mfma_f32_32x32x16_bf16 v[64:79], a[160:163], v[40:43], v[64:79]
  ds_read_b128 v[32:35], v10 offset:24576
  v_mfma_f32_32x32x16_bf16 v[80:95], a[164:167], v[40:43], v[80:95]
  s_waitcnt lgkmcnt(5)
  v_mfma_f32_32x32x16_bf16 v[64:79], a[168:171], v[44:47], v[64:79]
  ds_read_b128 v[36:39], v11 offset:24576
  v_mfma_f32_32x32x16_bf16 v[80:95], a[172:175], v[44:47], v[80:95]
  s_waitcnt lgkmcnt(5)
  buffer_store_dwordx4 v[136:139], v2, s[4:7], s21 offen offset:2048
  v_mfma_f32_32x32x16_bf16 v[64:79], a[176:179], v[48:51], v[64:79]
  ds_read_b128 v[40:43], v12 offset:24576
  v_mfma_f32_32x32x16_bf16 v[80:95], a[180:183], v[48:51], v[80:95]
  s_waitcnt lgkmcnt(5)
  v_mfma_f32_32x32x16_bf16 v[64:79], a[184:187], v[52:55], v[64:79]
  ds_read_b128 v[44:47], v13 offset:24576
  v_mfma_f32_32x32x16_bf16 v[80:95], a[188:191], v[52:55], v[80:95]
  s_waitcnt lgkmcnt(5)
  buffer_store_dwordx4 v[140:143], v2, s[4:7], s21 offen offset:3072
  v_mfma_f32_32x32x16_bf16 v[64:79], a[192:195], v[24:27], v[64:79]
  s_mov_b32 s21, s27
  ds_read_b128 v[48:51], v14 offset:24576
  v_mfma_f32_32x32x16_bf16 v[80:95], a[196:199], v[24:27], v[80:95]
  s_waitcnt lgkmcnt(5)
  v_mfma_f32_32x32x16_bf16 v[64:79], a[200:203], v[28:31], v[64:79]
  s_add_u32 s27, s27, s22
  ds_read_b128 v[52:55], v15 offset:24576
  v_mfma_f32_32x32x16_bf16 v[80:95], a[204:207], v[28:31], v[80:95]
  s_waitcnt lgkmcnt(5)
  s_waitcnt vmcnt(16)
  s_barrier
  v_mfma_f32_32x32x16_bf16 v[64:79], a[208:211], v[32:35], v[64:79]
  ds_read_b128 v[24:27], v8 offset:32768
  v_mfma_f32_32x32x16_bf16 v[80:95], a[212:215], v[32:35], v[80:95]
  s_waitcnt lgkmcnt(5)
  v_mfma_f32_32x32x16_bf16 v[64:79], a[216:219], v[36:39], v[64:79]
  ds_read_b128 v[28:31], v9 offset:32768
  v_mfma_f32_32x32x16_bf16 v[80:95], a[220:223], v[36:39], v[80:95]
  s_waitcnt lgkmcnt(5)
  v_mfma_f32_32x32x16_bf16 v[64:79], a[224:227], v[40:43], v[64:79]
  ds_read_b128 v[32:35], v10 offset:32768
  v_mfma_f32_32x32x16_bf16 v[80:95], a[228:231], v[40:43], v[80:95]
  s_waitcnt lgkmcnt(5)
  v_mfma_f32_32x32x16_bf16 v[64:79], a[232:235], v[44:47], v[64:79]
  ds_read_b128 v[36:39], v11 offset:32768
  v_mfma_f32_32x32x16_bf16 v[80:95], a[236:239], v[44:47], v[80:95]
  s_waitcnt lgkmcnt(5)
  v_mfma_f32_32x32x16_bf16 v[64:79], a[240:243], v[48:51], v[64:79]
  s_sub_u32 s23, s23, 1
  ds_read_b128 v[40:43], v12 offset:32768
  v_mfma_f32_32x32x16_bf16 v[80:95], a[244:247], v[48:51], v[80:95]
  s_waitcnt lgkmcnt(5)
  v_mfma_f32_32x32x16_bf16 v[64:79], a[248:251], v[52:55], v[64:79]
  s_cmp_eq_u32 s23, 0
  ds_read_b128 v[44:47], v13 offset:32768
  v_mfma_f32_32x32x16_bf16 v[80:95], a[252:255], v[52:55], v[80:95]
  s_cbranch_scc1 G_done0_5
  s_waitcnt lgkmcnt(5)
  v_mfma_f32_32x32x16_bf16 v[96:111], a[0:3], v[24:27], 0
  s_add_u32 m0, s25, 0
  ds_read_b128 v[48:51], v14 offset:32768
  v_mfma_f32_32x32x16_bf16 v[112:127], a[4:7], v[24:27], 0
  s_waitcnt lgkmcnt(5)
  buffer_load_dwordx4 v16, s[12:15], s19 offen lds
  v_mfma_f32_32x32x16_bf16 v[96:111], a[8:11], v[28:31], v[96:111]
  ds_read_b128 v[52:55], v15 offset:32768
  v_mul_f32 v64, s24, v64
  v_mul_f32 v65, s24, v65
  v_mfma_f32_32x32x16_bf16 v[112:127], a[12:15], v[28:31], v[112:127]
  s_waitcnt lgkmcnt(5)
  v_cvt_pk_bf16_f32 v128, v64, v65
  v_mul_f32 v66, s24, v66
  v_mfma_f32_32x32x16_bf16 v[96:111], a[16:19], v[32:35], v[96:111]
  s_add_u32 m0, s25, 1024
  ds_read_b128 v[24:27], v8 offset:40960
  v_mul_f32 v67, s24, v67
  v_cvt_pk_bf16_f32 v129, v66, v67
  v_mfma_f32_32x32x16_bf16 v[112:127], a[20:23], v[32:35], v[112:127]
  s_waitcnt lgkmcnt(5)
  buffer_load_dwordx4 v17, s[12:15], s19 offen lds
  v_mul_f32 v68, s24, v68
  v_mul_f32 v69, s24, v69
  v_mfma_f32_32x32x16_bf16 v[96:111], a[24:27], v[36:39], v[96:111]
  ds_read_b128 v[28:31], v9 offset:40960
  v_cvt_pk_bf16_f32 v130, v68, v69
  v_mul_f32 v70, s24, v70
  v_mfma_f32_32x32x16_bf16 v[112:127], a[28:31], v[36:39], v[112:127]
  s_waitcnt lgkmcnt(5)
  v_mul_f32 v71, s24, v71
  v_cvt_pk_bf16_f32 v131, v70, v71
  v_mfma_f32_32x32x16_bf16 v[96:111], a[32:35], v[40:43], v[96:111]
  s_add_u32 m0, s25, 2048
  ds_read_b128 v[32:35], v10 offset:40960
  v_mul_f32 v72, s24, v72
  v_mul_f32 v73, s24, v73
  v_mfma_f32_32x32x16_bf16 v[112:127], a[36:39], v[40:43], v[112:127]
  s_waitcnt lgkmcnt(5)
  buffer_load_dwordx4 v18, s[12:15], s19 offen lds
  v_cvt_pk_bf16_f32 v132, v72, v73
  v_mul_f32 v74, s24, v74
  v_mfma_f32_32x32x16_bf16 v[96:111], a[40:43], v[44:47], v[96:111]
  ds_read_b128 v[36:39], v11 offset:40960
  v_mul_f32 v75, s24, v75
  v_cvt_pk_bf16_f32 v133, v74, v75
  v_mfma_f32_32x32x16_bf16 v[112:127], a[44:47], v[44:47], v[112:127]
  s_waitcnt lgkmcnt(5)
  v_mul_f32 v76, s24, v76
  v_mul_f32 v77, s24, v77
  v_mfma_f32_32x32x16_bf16 v[96:111], a[48:51], v[48:51], v[96:111]
  s_add_u32 m0, s25, 3072
  ds_read_b128 v[40:43], v12 offset:40960
  v_cvt_pk_bf16_f32 v134, v76, v77
  v_mul_f32 v78, s24, v78
  v_mfma_f32_32x32x16_bf16 v[112:127], a[52:55], v[48:51], v[112:127]
  s_waitcnt lgkmcnt(5)
  buffer_load_dwordx4 v19, s[12:15], s19 offen lds
  v_mul_f32 v79, s24, v79
  v_cvt_pk_bf16_f32 v135, v78, v79
  v_mfma_f32_32x32x16_bf16 v[96:111], a[56:59], v[52:55], v[96:111]
  ds_read_b128 v[44:47], v13 offset:40960
  v_mul_f32 v80, s24, v80
  v_mul_f32 v81, s24, v81
  v_mfma_f32_32x32x16_bf16 v[112:127], a[60:63], v[52:55], v[112:127]
  s_waitcnt lgkmcnt(5)
  v_cvt_pk_bf16_f32 v136, v80, v81
  v_mul_f32 v82, s24, v82
  v_mfma_f32_32x32x16_bf16 v[96:111], a[64:67], v[24:27], v[96:111]
  s_add_u32 m0, s25, 4096
  ds_read_b128 v[48:51], v14 offset:40960
  v_mul_f32 v83, s24, v83
  v_cvt_pk_bf16_f32 v137, v82, v83
  v_mfma_f32_32x32x16_bf16 v[112:127], a[68:71], v[24:27], v[112:127]
  s_waitcnt lgkmcnt(5)
  buffer_load_dwordx4 v20, s[12:15], s19 offen lds
  v_mul_f32 v84, s24, v84
  v_mul_f32 v85, s24, v85
  v_mfma_f32_32x32x16_bf16 v[96:111], a[72:75], v[28:31], v[96:111]
  ds_read_b128 v[52:55], v15 offset:40960
  v_cvt_pk_bf16_f32 v138, v84, v85
  v_mul_f32 v86, s24, v86
  v_mfma_f32_32x32x16_bf16 v[112:127], a[76:79], v[28:31], v[112:127]
  s_waitcnt lgkmcnt(5)
  v_mul_f32 v87, s24, v87
  v_cvt_pk_bf16_f32 v139, v86, v87
  v_mfma_f32_32x32x16_bf16 v[96:111], a[80:83], v[32:35], v[96:111]
  s_add_u32 m0, s25, 5120
  ds_read_b128 v[24:27], v8 offset:49152
  v_mul_f32 v88, s24, v88
  v_mul_f32 v89, s24, v89
  v_mfma_f32_32x32x16_bf16 v[112:127], a[84:87], v[32:35], v[112:127]
  s_waitcnt lgkmcnt(5)
  buffer_load_dwordx4 v21, s[12:15], s19 offen lds
  v_cvt_pk_bf16_f32 v140, v88, v89
  v_mul_f32 v90, s24, v90
  v_mfma_f32_32x32x16_bf16 v[96:111], a[88:91], v[36:39], v[96:111]
  ds_read_b128 v[28:31], v9 offset:49152
  v_mul_f32 v91, s24, v91
  v_cvt_pk_bf16_f32 v141, v90, v91
  v_mfma_f32_32x32x16_bf16 v[112:127], a[92:95], v[36:39], v[112:127]
  s_waitcnt lgkmcnt(5)
  v_mul_f32 v92, s24, v92
  v_mul_f32 v93, s24, v93
  v_mfma_f32_32x32x16_bf16 v[96:111], a[96:99], v[40:43], v[96:111]
  s_add_u32 m0, s25, 6144
  ds_read_b128 v[32:35], v10 offset:49152
  v_cvt_pk_bf16_f32 v142, v92, v93
  v_mul_f32 v94, s24, v94
  v_mfma_f32_32x32x16_bf16 v[112:127], a[100:103], v[40:43], v[112:127]
  s_waitcnt lgkmcnt(5)
  buffer_load_dwordx4 v22, s[12:15], s19 offen lds
  v_mul_f32 v95, s24, v95
  v_cvt_pk_bf16_f32 v143, v94, v95
  v_mfma_f32_32x32x16_bf16 v[96:111], a[104:107], v[44:47], v[96:111]
  ds_read_b128 v[36:39], v11 offset:49152
  v_mfma_f32_32x32x16_bf16 v[112:127], a[108:111], v[44:47], v[112:127]
  s_waitcnt lgkmcnt(5)
  v_mfma_f32_32x32x16_bf16 v[96:111], a[112:115], v[48:51], v[96:111]
  s_add_u32 m0, s25, 7168
  ds_read_b128 v[40:43], v12 offset:49152
  v_mfma_f32_32x32x16_bf16 v[112:127], a[116:119], v[48:51], v[112:127]
  s_waitcnt lgkmcnt(5)
  buffer_load_dwordx4 v23, s[12:15], s19 offen lds
  v_mfma_f32_32x32x16_bf16 v[96:111], a[120:123], v[52:55], v[96:111]
  s_cmp_gt_u32 s23, 3
  ds_read_b128 v[44:47], v13 offset:49152
  v_mfma_f32_32x32x16_bf16 v[112:127], a[124:127], v[52:55], v[112:127]
  s_waitcnt lgkmcnt(5)
  s_cselect_b32 s26, s20, 0
  v_mfma_f32_32x32x16_bf16 v[96:111], a[128:131], v[24:27], v[96:111]
  s_add_u32 s19, s19, s26
  ds_read_b128 v[48:51], v14 offset:49152
  v_mfma_f32_32x32x16_bf16 v[112:127], a[132:135], v[24:27], v[112:127]
  s_waitcnt lgkmcnt(5)
  s_add_u32 s25, s25, 32768
  v_mfma_f32_32x32x16_bf16 v[96:111], a[136:139], v[28:31], v[96:111]
  s_and_b32 s25, s25, 0x1ffff
  ds_read_b128 v[52:55], v15 offset:49152
  v_mfma_f32_32x32x16_bf16 v[112:127], a[140:143], v[28:31], v[112:127]
  s_waitcnt lgkmcnt(5)
  buffer_store_dwordx4 v[128:131], v2, s[4:7], s21 offen offset:0
  v_mfma_f32_32x32x16_bf16 v[96:111], a[144:147], v[32:35], v[96:111]
  ds_read_b128 v[24:27], v8 offset:57344
  v_mfma_f32_32x32x16_bf16 v[112:127], a[148:151], v[32:35], v[112:127]
  s_waitcnt lgkmcnt(5)
  v_xor_b32 v8, 0x10000, v8
  v_mfma_f32_32x32x16_bf16 v[96:111], a[152:155], v[36:39], v[96:111]
  ds_read_b128 v[28:31], v9 offset:57344
  v_mfma_f32_32x32x16_bf16 v[112:127], a[156:159], v[36:39], v[112:127]
  s_waitcnt lgkmcnt(5)
  buffer_store_dwordx4 v[132:135], v2, s[4:7], s21 offen offset:1024
  v_xor_b32 v9, 0x10000, v9
  v_mfma_f32_32x32x16_bf16 v[96:111], a[160:163], v[40:43], v[96:111]
  ds_read_b128 v[32:35], v10 offset:57344
  v_mfma_f32_32x32x16_bf16 v[112:127], a[164:167], v[40:43], v[112:127]
  s_waitcnt lgkmcnt(5)
  v_xor_b32 v10, 0x10000, v10
  v_mfma_f32_32x32x16_bf16 v[96:111], a[168:171], v[44:47], v[96:111]
  ds_read_b128 v[36:39], v11 offset:57344
  v_mfma_f32_32x32x16_bf16 v[112:127], a[172:175], v[44:47], v[112:127]
  s_waitcnt lgkmcnt(5)
  buffer_store_dwordx4 v[136:139], v2, s[4:7], s21 offen offset:2048
  v_xor_b32 v11, 0x10000, v11
  v_mfma_f32_32x32x16_bf16 v[96:111], a[176:179], v[48:51], v[96:111]
  ds_read_b128 v[40:43], v12 offset:57344
  v_mfma_f32_32x32x16_bf16 v[112:127], a[180:183], v[48:51], v[112:127]
  s_waitcnt lgkmcnt(5)
  v_xor_b32 v12, 0x10000, v12
  v_mfma_f32_32x32x16_bf16 v[96:111], a[184:187], v[52:55], v[96:111]
  ds_read_b128 v[44:47], v13 offset:57344
  v_mfma_f32_32x32x16_bf16 v[112:127], a[188:191], v[52:55], v[112:127]
  s_waitcnt lgkmcnt(5)
  buffer_store_dwordx4 v[140:143], v2, s[4:7], s21 offen offset:3072
  v_xor_b32 v13, 0x10000, v13
  v_mfma_f32_32x32x16_bf16 v[96:111], a[192:195], v[24:27], v[96:111]
  s_mov_b32 s21, s27
  ds_read_b128 v[48:51], v14 offset:57344
  v_mfma_f32_32x32x16_bf16 v[112:127], a[196:199], v[24:27], v[112:127]
  s_waitcnt lgkmcnt(5)
  v_xor_b32 v14, 0x10000, v14
  v_mfma_f32_32x32x16_bf16 v[96:111], a[200:203], v[28:31], v[96:111]
  s_add_u32 s27, s27, s22
  ds_read_b128 v[52:55], v15 offset:57344
  v_mfma_f32_32x32x16_bf16 v[112:127], a[204:207], v[28:31], v[112:127]
  s_waitcnt lgkmcnt(5)
  s_waitcnt vmcnt(16)
  s_barrier
  v_xor_b32 v15, 0x10000, v15
  v_mfma_f32_32x32x16_bf16 v[96:111], a[208:211], v[32:35], v[96:111]
  ds_read_b128 v[24:27], v8 offset:0
  v_mfma_f32_32x32x16_bf16 v[112:127], a[212:215], v[32:35], v[112:127]
  s_waitcnt lgkmcnt(5)
  v_mfma_f32_32x32x16_bf16 v[96:111], a[216:219], v[36:39], v[96:111]
  ds_read_b128 v[28:31], v9 offset:0
  v_mfma_f32_32x32x16_bf16 v[112:127], a[220:223], v[36:39], v[112:127]
  s_waitcnt lgkmcnt(5)
  v_mfma_f32_32x32x16_bf16 v[96:111], a[224:227], v[40:43], v[96:111]
  ds_read_b128 v[32:35], v10 offset:0
  v_mfma_f32_32x32x16_bf16 v[112:127], a[228:231], v[40:43], v[112:127]
  s_waitcnt lgkmcnt(5)
  v_mfma_f32_32x32x16_bf16 v[96:111], a[232:235], v[44:47], v[96:111]
  ds_read_b128 v[36:39], v11 offset:0
  v_mfma_f32_32x32x16_bf16 v[112:127], a[236:239], v[44:47], v[112:127]
  s_waitcnt lgkmcnt(5)
  v_mfma_f32_32x32x16_bf16 v[96:111], a[240:243], v[48:51], v[96:111]
  s_sub_u32 s23, s23, 1
  ds_read_b128 v[40:43], v12 offset:0
  v_mfma_f32_32x32x16_bf16 v[112:127], a[244:247], v[48:51], v[112:127]
  s_waitcnt lgkmcnt(5)
  v_mfma_f32_32x32x16_bf16 v[96:111], a[248:251], v[52:55], v[96:111]
  s_cmp_eq_u32 s23, 0
  ds_read_b128 v[44:47], v13 offset:0
  v_mfma_f32_32x32x16_bf16 v[112:127], a[252:255], v[52:55], v[112:127]
  s_cbranch_scc1 G_done1_6
  s_branch G_top_4
G_done0_5:
  s_nop 7
  s_nop 3
  v_mul_f32 v64, s24, v64
  v_mul_f32 v65, s24, v65
  v_cvt_pk_bf16_f32 v128, v64, v65
  v_mul_f32 v66, s24, v66
  v_mul_f32 v67, s24, v67
  v_cvt_pk_bf16_f32 v129, v66, v67
  v_mul_f32 v68, s24, v68
  v_mul_f32 v69, s24, v69
  v_cvt_pk_bf16_f32 v130, v68, v69
  v_mul_f32 v70, s24, v70
  v_mul_f32 v71, s24, v71
  v_cvt_pk_bf16_f32 v131, v70, v71
  buffer_store_dwordx4 v[128:131], v2, s[4:7], s21 offen offset:0
  v_mul_f32 v72, s24, v72
  v_mul_f32 v73, s24, v73
  v_cvt_pk_bf16_f32 v132, v72, v73
  v_mul_f32 v74, s24, v74
  v_mul_f32 v75, s24, v75
  v_cvt_pk_bf16_f32 v133, v74, v75
  v_mul_f32 v76, s24, v76
  v_mul_f32 v77, s24, v77
  v_cvt_pk_bf16_f32 v134, v76, v77
  v_mul_f32 v78, s24, v78
  v_mul_f32 v79, s24, v79
  v_cvt_pk_bf16_f32 v135, v78, v79
  buffer_store_dwordx4 v[132:135], v2, s[4:7], s21 offen offset:1024
  v_mul_f32 v80, s24, v80
  v_mul_f32 v81, s24, v81
  v_cvt_pk_bf16_f32 v136, v80, v81
  v_mul_f32 v82, s24, v82
  v_mul_f32 v83, s24, v83
  v_cvt_pk_bf16_f32 v137, v82, v83
  v_mul_f32 v84, s24, v84
  v_mul_f32 v85, s24, v85
  v_cvt_pk_bf16_f32 v138, v84, v85
  v_mul_f32 v86, s24, v86
  v_mul_f32 v87, s24, v87
  v_cvt_pk_bf16_f32 v139, v86, v87
  buffer_store_dwordx4 v[136:139], v2, s[4:7], s21 offen offset:2048
  v_mul_f32 v88, s24, v88
  v_mul_f32 v89, s24, v89
  v_cvt_pk_bf16_f32 v140, v88, v89
  v_mul_f32 v90, s24, v90
  v_mul_f32 v91, s24, v91
  v_cvt_pk_bf16_f32 v141, v90, v91
  v_mul_f32 v92, s24, v92
  v_mul_f32 v93, s24, v93
  v_cvt_pk_bf16_f32 v142, v92, v93
  v_mul_f32 v94, s24, v94
  v_mul_f32 v95, s24, v95
  v_cvt_pk_bf16_f32 v143, v94, v95
  buffer_store_dwordx4 v[140:143], v2, s[4:7], s21 offen offset:3072
  s_branch G_fin_7
G_done1_6:
  s_nop 7
  s_nop 3
  v_mul_f32 v96, s24, v96
  v_mul_f32 v97, s24, v97
  v_cvt_pk_bf16_f32 v128, v96, v97
  v_mul_f32 v98, s24, v98
  v_mul_f32 v99, s24, v99
  v_cvt_pk_bf16_f32 v129, v98, v99
  v_mul_f32 v100, s24, v100
  v_mul_f32 v101, s24, v101
  v_cvt_pk_bf16_f32 v130, v100, v101
  v_mul_f32 v102, s24, v102
  v_mul_f32 v103, s24, v103
  v_cvt_pk_bf16_f32 v131, v102, v103
  buffer_store_dwordx4 v[128:131], v2, s[4:7], s21 offen offset:0
  v_mul_f32 v104, s24, v104
  v_mul_f32 v105, s24, v105
  v_cvt_pk_bf16_f32 v132, v104, v105
  v_mul_f32 v106, s24, v106
  v_mul_f32 v107, s24, v107
  v_cvt_pk_bf16_f32 v133, v106, v107
  v_mul_f32 v108, s24, v108
  v_mul_f32 v109, s24, v109
  v_cvt_pk_bf16_f32 v134, v108, v109
  v_mul_f32 v110, s24, v110
  v_mul_f32 v111, s24, v111
  v_cvt_pk_bf16_f32 v135, v110, v111
  buffer_store_dwordx4 v[132:135], v2, s[4:7], s21 offen offset:1024
  v_mul_f32 v112, s24, v112
  v_mul_f32 v113, s24, v113
  v_cvt_pk_bf16_f32 v136, v112, v113
  v_mul_f32 v114, s24, v114
  v_mul_f32 v115, s24, v115
  v_cvt_pk_bf16_f32 v137, v114, v115
  v_mul_f32 v116, s24, v116
  v_mul_f32 v117, s24, v117
  v_cvt_pk_bf16_f32 v138, v116, v117
  v_mul_f32 v118, s24, v118
  v_mul_f32 v119, s24, v119
  v_cvt_pk_bf16_f32 v139, v118, v119
  buffer_store_dwordx4 v[136:139], v2, s[4:7], s21 offen offset:2048
  v_mul_f32 v120, s24, v120
  v_mul_f32 v121, s24, v121
  v_cvt_pk_bf16_f32 v140, v120, v121
  v_mul_f32 v122, s24, v122
  v_mul_f32 v123, s24, v123
  v_cvt_pk_bf16_f32 v141, v122, v123
  v_mul_f32 v124, s24, v124
  v_mul_f32 v125, s24, v125
  v_cvt_pk_bf16_f32 v142, v124, v125
  v_mul_f32 v126, s24, v126
  v_mul_f32 v127, s24, v127
  v_cvt_pk_bf16_f32 v143, v126, v127
  buffer_store_dwordx4 v[140:143], v2, s[4:7], s21 offen offset:3072
G_fin_7:
  s_waitcnt vmcnt(0) lgkmcnt(0)
  s_barrier
  s_branch P_end_3
P_v_2:
  s_mov_b32 s27, s21
  s_mov_b32 s21, 149946368
  ds_read_b128 v[24:27], v8 offset:0
  ds_read_b128 v[28:31], v9 offset:0
  ds_read_b128 v[32:35], v10 offset:0
  ds_read_b128 v[36:39], v11 offset:0
  ds_read_b128 v[40:43], v12 offset:0
  ds_read_b128 v[44:47], v13 offset:0
.p2align 6
G_top_8:
  s_waitcnt lgkmcnt(5)
  v_mfma_f32_32x32x16_bf16 v[64:79], v[24:27], a[0:3], 0
  s_add_u32 m0, s25, 0
  ds_read_b128 v[48:51], v14 offset:0
  v_mfma_f32_32x32x16_bf16 v[80:95], v[24:27], a[4:7], 0
  s_waitcnt lgkmcnt(5)
  buffer_load_dwordx4 v16, s[12:15], s19 offen lds
  v_mfma_f32_32x32x16_bf16 v[64:79], v[28:31], a[8:11], v[64:79]
  ds_read_b128 v[52:55], v15 offset:0
  v_mul_f32 v96, s24, v96
  v_mul_f32 v97, s24, v97
  v_mfma_f32_32x32x16_bf16 v[80:95], v[28:31], a[12:15], v[80:95]
  s_waitcnt lgkmcnt(5)
  v_cvt_pk_bf16_f32 v128, v96, v97
  v_mul_f32 v98, s24, v98
  v_mfma_f32_32x32x16_bf16 v[64:79], v[32:35], a[16:19], v[64:79]
  s_add_u32 m0, s25, 1024
  ds_read_b128 v[24:27], v8 offset:8192
  v_mul_f32 v99, s24, v99
  v_cvt_pk_bf16_f32 v129, v98, v99
  v_mfma_f32_32x32x16_bf16 v[80:95], v[32:35], a[20:23], v[80:95]
  s_waitcnt lgkmcnt(5)
  buffer_load_dwordx4 v17, s[12:15], s19 offen lds
  v_mul_f32 v100, s24, v100
  v_mul_f32 v101, s24, v101
  v_mfma_f32_32x32x16_bf16 v[64:79], v[36:39], a[24:27], v[64:79]
  ds_read_b128 v[28:31], v9 offset:8192
  v_cvt_pk_bf16_f32 v130, v100, v101
  v_mul_f32 v102, s24, v102
  v_mfma_f32_32x32x16_bf16 v[80:95], v[36:39], a[28:31], v[80:95]
  s_waitcnt lgkmcnt(5)
  v_mul_f32 v103, s24, v103
  v_cvt_pk_bf16_f32 v131, v102, v103
  v_mfma_f32_32x32x16_bf16 v[64:79], v[40:43], a[32:35], v[64:79]
  s_add_u32 m0, s25, 2048
  ds_read_b128 v[32:35], v10 offset:8192
  v_mul_f32 v104, s24, v104
  v_mul_f32 v105, s24, v105
  v_mfma_f32_32x32x16_bf16 v[80:95], v[40:43], a[36:39], v[80:95]
  s_waitcnt lgkmcnt(5)
  buffer_load_dwordx4 v18, s[12:15], s19 offen lds
  v_cvt_pk_bf16_f32 v132, v104, v105
  v_mul_f32 v106, s24, v106
  v_mfma_f32_32x32x16_bf16 v[64:79], v[44:47], a[40:43], v[64:79]
  ds_read_b128 v[36:39], v11 offset:8192
  v_mul_f32 v107, s24, v107
  v_cvt_pk_bf16_f32 v133, v106, v107
  v_mfma_f32_32x32x16_bf16 v[80:95], v[44:47], a[44:47], v[80:95]
  s_waitcnt lgkmcnt(5)
  v_mul_f32 v108, s24, v108
  v_mul_f32 v109, s24, v109
  v_mfma_f32_32x32x16_bf16 v[64:79], v[48:51], a[48:51], v[64:79]
  s_add_u32 m0, s25, 3072
  ds_read_b128 v[40:43], v12 offset:8192
  v_cvt_pk_bf16_f32 v134, v108, v109
  v_mul_f32 v110, s24, v110
  v_mfma_f32_32x32x16_bf16 v[80:95], v[48:51], a[52:55], v[80:95]
  s_waitcnt lgkmcnt(5)
  buffer_load_dwordx4 v19, s[12:15], s19 offen lds
  v_mul_f32 v111, s24, v111
  v_cvt_pk_bf16_f32 v135, v110, v111
  v_mfma_f32_32x32x16_bf16 v[64:79], v[52:55], a[56:59], v[64:79]
  ds_read_b128 v[44:47], v13 offset:8192
  v_mul_f32 v112, s24, v112
  v_mul_f32 v113, s24, v113
  v_mfma_f32_32x32x16_bf16 v[80:95], v[52:55], a[60:63], v[80:95]
  s_waitcnt lgkmcnt(5)
  v_cvt_pk_bf16_f32 v136, v112, v113
  v_mul_f32 v114, s24, v114
  v_mfma_f32_32x32x16_bf16 v[64:79], v[24:27], a[64:67], v[64:79]
  s_add_u32 m0, s25, 4096
  ds_read_b128 v[48:51], v14 offset:8192
  v_mul_f32 v115, s24, v115
  v_cvt_pk_bf16_f32 v137, v114, v115
  v_mfma_f32_32x32x16_bf16 v[80:95], v[24:27], a[68:71], v[80:95]
  s_waitcnt lgkmcnt(5)
  buffer_load_dwordx4 v20, s[12:15], s19 offen lds
  v_mul_f32 v116, s24, v116
  v_mul_f32 v117, s24, v117
  v_mfma_f32_32x32x16_bf16 v[64:79], v[28:31], a[72:75], v[64:79]
  ds_read_b128 v[52:55], v15 offset:8192
  v_cvt_pk_bf16_f32 v138, v116, v117
  v_mul_f32 v118, s24, v118
  v_mfma_f32_32x32x16_bf16 v[80:95], v[28:31], a[76:79], v[80:95]
  s_waitcnt lgkmcnt(5)
  v_mul_f32 v119, s24, v119
  v_cvt_pk_bf16_f32 v139, v118, v119
  v_mfma_f32_32x32x16_bf16 v[64:79], v[32:35], a[80:83], v[64:79]
  s_add_u32 m0, s25, 5120
  ds_read_b128 v[24:27], v8 offset:16384
  v_mul_f32 v120, s24, v120
  v_mul_f32 v121, s24, v121
  v_mfma_f32_32x32x16_bf16 v[80:95], v[32:35], a[84:87], v[80:95]
  s_waitcnt lgkmcnt(5)
  buffer_load_dwordx4 v21, s[12:15], s19 offen lds
  v_cvt_pk_bf16_f32 v140, v120, v121
  v_mul_f32 v122, s24, v122
  v_mfma_f32_32x32x16_bf16 v[64:79], v[36:39], a[88:91], v[64:79]
  ds_read_b128 v[28:31], v9 offset:16384
  v_mul_f32 v123, s24, v123
  v_cvt_pk_bf16_f32 v141, v122, v123
  v_mfma_f32_32x32x16_bf16 v[80:95], v[36:39], a[92:95], v[80:95]
  s_waitcnt lgkmcnt(5)
  v_mul_f32 v124, s24, v124
  v_mul_f32 v125, s24, v125
  v_mfma_f32_32x32x16_bf16 v[64:79], v[40:43], a[96:99], v[64:79]
  s_add_u32 m0, s25, 6144
  ds_read_b128 v[32:35], v10 offset:16384
  v_cvt_pk_bf16_f32 v142, v124, v125
  v_mul_f32 v126, s24, v126
  v_mfma_f32_32x32x16_bf16 v[80:95], v[40:43], a[100:103], v[80:95]
  s_waitcnt lgkmcnt(5)
  buffer_load_dwordx4 v22, s[12:15], s19 offen lds
  v_mul_f32 v127, s24, v127
  v_cvt_pk_bf16_f32 v143, v126, v127
  v_mfma_f32_32x32x16_bf16 v[64:79], v[44:47], a[104:107], v[64:79]
  ds_read_b128 v[36:39], v11 offset:16384
  v_mfma_f32_32x32x16_bf16 v[80:95], v[44:47], a[108:111], v[80:95]
  s_waitcnt lgkmcnt(5)
  v_mfma_f32_32x32x16_bf16 v[64:79], v[48:51], a[112:115], v[64:79]
  s_add_u32 m0, s25, 7168
  ds_read_b128 v[40:43], v12 offset:16384
  v_mfma_f32_32x32x16_bf16 v[80:95], v[48:51], a[116:119], v[80:95]
  s_waitcnt lgkmcnt(5)
  buffer_load_dwordx4 v23, s[12:15], s19 offen lds
  v_mfma_f32_32x32x16_bf16 v[64:79], v[52:55], a[120:123], v[64:79]
  s_cmp_gt_u32 s23, 3
  ds_read_b128 v[44:47], v13 offset:16384
  v_mfma_f32_32x32x16_bf16 v[80:95], v[52:55], a[124:127], v[80:95]
  s_waitcnt lgkmcnt(5)
  s_cselect_b32 s26, s20, 0
  v_mfma_f32_32x32x16_bf16 v[64:79], v[24:27], a[128:131], v[64:79]
  s_add_u32 s19, s19, s26
  ds_read_b128 v[48:51], v14 offset:16384
  v_mfma_f32_32x32x16_bf16 v[80:95], v[24:27], a[132:135], v[80:95]
  s_waitcnt lgkmcnt(5)
  s_add_u32 s25, s25, 32768
  v_mfma_f32_32x32x16_bf16 v[64:79], v[28:31], a[136:139], v[64:79]
  s_and_b32 s25, s25, 0x1ffff
  ds_read_b128 v[52:55], v15 offset:16384
  v_mfma_f32_32x32x16_bf16 v[80:95], v[28:31], a[140:143], v[80:95]
  s_waitcnt lgkmcnt(5)
  buffer_store_dwordx4 v[128:131], v2, s[4:7], s21 offen offset:0
  v_mfma_f32_32x32x16_bf16 v[64:79], v[32:35], a[144:147], v[64:79]
  ds_read_b128 v[24:27], v8 offset:24576
  v_mfma_f32_32x32x16_bf16 v[80:95], v[32:35], a[148:151], v[80:95]
  s_waitcnt lgkmcnt(5)
  v_mfma_f32_32x32x16_bf16 v[64:79], v[36:39], a[152:155], v[64:79]
  ds_read_b128 v[28:31], v9 offset:24576
  v_mfma_f32_32x32x16_bf16 v[80:95], v[36:39], a[156:159], v[80:95]
  s_waitcnt lgkmcnt(5)
  buffer_store_dwordx4 v[132:135], v2, s[4:7], s21 offen offset:1024
  v_mfma_f32_32x32x16_bf16 v[64:79], v[40:43], a[160:163], v[64:79]
  ds_read_b128 v[32:35], v10 offset:24576
  v_mfma_f32_32x32x16_bf16 v[80:95], v[40:43], a[164:167], v[80:95]
  s_waitcnt lgkmcnt(5)
  v_mfma_f32_32x32x16_bf16 v[64:79], v[44:47], a[168:171], v[64:79]
  ds_read_b128 v[36:39], v11 offset:24576
  v_mfma_f32_32x32x16_bf16 v[80:95], v[44:47], a[172:175], v[80:95]
  s_waitcnt lgkmcnt(5)
  buffer_store_dwordx4 v[136:139], v2, s[4:7], s21 offen offset:2048
  v_mfma_f32_32x32x16_bf16 v[64:79], v[48:51], a[176:179], v[64:79]
  ds_read_b128 v[40:43], v12 offset:24576
  v_mfma_f32_32x32x16_bf16 v[80:95], v[48:51], a[180:183], v[80:95]
  s_waitcnt lgkmcnt(5)
  v_mfma_f32_32x32x16_bf16 v[64:79], v[52:55], a[184:187], v[64:79]
  ds_read_b128 v[44:47], v13 offset:24576
  v_mfma_f32_32x32x16_bf16 v[80:95], v[52:55], a[188:191], v[80:95]
  s_waitcnt lgkmcnt(5)
  buffer_store_dwordx4 v[140:143], v2, s[4:7], s21 offen offset:3072
  v_mfma_f32_32x32x16_bf16 v[64:79], v[24:27], a[192:195], v[64:79]
  s_mov_b32 s21, s27
  ds_read_b128 v[48:51], v14 offset:24576
  v_mfma_f32_32x32x16_bf16 v[80:95], v[24:27], a[196:199], v[80:95]
  s_waitcnt lgkmcnt(5)
  v_mfma_f32_32x32x16_bf16 v[64:79], v[28:31], a[200:203], v[64:79]
  s_add_u32 s27, s27, s22
  ds_read_b128 v[52:55], v15 offset:24576
  v_mfma_f32_32x32x16_bf16 v[80:95], v[28:31], a[204:207], v[80:95]
  s_waitcnt lgkmcnt(5)
  s_waitcnt vmcnt(16)
  s_barrier
  v_mfma_f32_32x32x16_bf16 v[64:79], v[32:35], a[208:211], v[64:79]
  ds_read_b128 v[24:27], v8 offset:32768
  v_mfma_f32_32x32x16_bf16 v[80:95], v[32:35], a[212:215], v[80:95]
  s_waitcnt lgkmcnt(5)
  v_mfma_f32_32x32x16_bf16 v[64:79], v[36:39], a[216:219], v[64:79]
  ds_read_b128 v[28:31], v9 offset:32768
  v_mfma_f32_32x32x16_bf16 v[80:95], v[36:39], a[220:223], v[80:95]
  s_waitcnt lgkmcnt(5)
  v_mfma_f32_32x32x16_bf16 v[64:79], v[40:43], a[224:227], v[64:79]
  ds_read_b128 v[32:35], v10 offset:32768
  v_mfma_f32_32x32x16_bf16 v[80:95], v[40:43], a[228:231], v[80:95]
  s_waitcnt lgkmcnt(5)
  v_mfma_f32_32x32x16_bf16 v[64:79], v[44:47], a[232:235], v[64:79]
  ds_read_b128 v[36:39], v11 offset:32768
  v_mfma_f32_32x32x16_bf16 v[80:95], v[44:47], a[236:239], v[80:95]
  s_waitcnt lgkmcnt(5)
  v_mfma_f32_32x32x16_bf16 v[64:79], v[48:51], a[240:243], v[64:79]
  s_sub_u32 s23, s23, 1
  ds_read_b128 v[40:43], v12 offset:32768
  v_mfma_f32_32x32x16_bf16 v[80:95], v[48:51], a[244:247], v[80:95]
  s_waitcnt lgkmcnt(5)
  v_mfma_f32_32x32x16_bf16 v[64:79], v[52:55], a[248:251], v[64:79]
  s_cmp_eq_u32 s23, 0
  ds_read_b128 v[44:47], v13 offset:32768
  v_mfma_f32_32x32x16_bf16 v[80:95], v[52:55], a[252:255], v[80:95]
  s_cbranch_scc1 G_done0_9
  s_waitcnt lgkmcnt(5)
  v_mfma_f32_32x32x16_bf16 v[96:111], v[24:27], a[0:3], 0
  s_add_u32 m0, s25, 0
  ds_read_b128 v[48:51], v14 offset:32768
  v_mfma_f32_32x32x16_bf16 v[112:127], v[24:27], a[4:7], 0
  s_waitcnt lgkmcnt(5)
  buffer_load_dwordx4 v16, s[12:15], s19 offen lds
  v_mfma_f32_32x32x16_bf16 v[96:111], v[28:31], a[8:11], v[96:111]
  ds_read_b128 v[52:55], v15 offset:32768
  v_mul_f32 v64, s24, v64
  v_mul_f32 v65, s24, v65
  v_mfma_f32_32x32x16_bf16 v[112:127], v[28:31], a[12:15], v[112:127]
  s_waitcnt lgkmcnt(5)
  v_cvt_pk_bf16_f32 v128, v64, v65
  v_mul_f32 v66, s24, v66
  v_mfma_f32_32x32x16_bf16 v[96:111], v[32:35], a[16:19], v[96:111]
  s_add_u32 m0, s25, 1024
  ds_read_b128 v[24:27], v8 offset:40960
  v_mul_f32 v67, s24, v67
  v_cvt_pk_bf16_f32 v129, v66, v67
  v_mfma_f32_32x32x16_bf16 v[112:127], v[32:35], a[20:23], v[112:127]
  s_waitcnt lgkmcnt(5)
  buffer_load_dwordx4 v17, s[12:15], s19 offen lds
  v_mul_f32 v68, s24, v68
  v_mul_f32 v69, s24, v69
  v_mfma_f32_32x32x16_bf16 v[96:111], v[36:39], a[24:27], v[96:111]
  ds_read_b128 v[28:31], v9 offset:40960
  v_cvt_pk_bf16_f32 v130, v68, v69
  v_mul_f32 v70, s24, v70
  v_mfma_f32_32x32x16_bf16 v[112:127], v[36:39], a[28:31], v[112:127]
  s_waitcnt lgkmcnt(5)
  v_mul_f32 v71, s24, v71
  v_cvt_pk_bf16_f32 v131, v70, v71
  v_mfma_f32_32x32x16_bf16 v[96:111], v[40:43], a[32:35], v[96:111]
  s_add_u32 m0, s25, 2048
  ds_read_b128 v[32:35], v10 offset:40960
  v_mul_f32 v72, s24, v72
  v_mul_f32 v73, s24, v73
  v_mfma_f32_32x32x16_bf16 v[112:127], v[40:43], a[36:39], v[112:127]
  s_waitcnt lgkmcnt(5)
  buffer_load_dwordx4 v18, s[12:15], s19 offen lds
  v_cvt_pk_bf16_f32 v132, v72, v73
  v_mul_f32 v74, s24, v74
  v_mfma_f32_32x32x16_bf16 v[96:111], v[44:47], a[40:43], v[96:111]
  ds_read_b128 v[36:39], v11 offset:40960
  v_mul_f32 v75, s24, v75
  v_cvt_pk_bf16_f32 v133, v74, v75
  v_mfma_f32_32x32x16_bf16 v[112:127], v[44:47], a[44:47], v[112:127]
  s_waitcnt lgkmcnt(5)
  v_mul_f32 v76, s24, v76
  v_mul_f32 v77, s24, v77
  v_mfma_f32_32x32x16_bf16 v[96:111], v[48:51], a[48:51], v[96:111]
  s_add_u32 m0, s25, 3072
  ds_read_b128 v[40:43], v12 offset:40960
  v_cvt_pk_bf16_f32 v134, v76, v77
  v_mul_f32 v78, s24, v78
  v_mfma_f32_32x32x16_bf16 v[112:127], v[48:51], a[52:55], v[112:127]
  s_waitcnt lgkmcnt(5)
  buffer_load_dwordx4 v19, s[12:15], s19 offen lds
  v_mul_f32 v79, s24, v79
  v_cvt_pk_bf16_f32 v135, v78, v79
  v_mfma_f32_32x32x16_bf16 v[96:111], v[52:55], a[56:59], v[96:111]
  ds_read_b128 v[44:47], v13 offset:40960
  v_mul_f32 v80, s24, v80
  v_mul_f32 v81, s24, v81
  v_mfma_f32_32x32x16_bf16 v[112:127], v[52:55], a[60:63], v[112:127]
  s_waitcnt lgkmcnt(5)
  v_cvt_pk_bf16_f32 v136, v80, v81
  v_mul_f32 v82, s24, v82
  v_mfma_f32_32x32x16_bf16 v[96:111], v[24:27], a[64:67], v[96:111]
  s_add_u32 m0, s25, 4096
  ds_read_b128 v[48:51], v14 offset:40960
  v_mul_f32 v83, s24, v83
  v_cvt_pk_bf16_f32 v137, v82, v83
  v_mfma_f32_32x32x16_bf16 v[112:127], v[24:27], a[68:71], v[112:127]
  s_waitcnt lgkmcnt(5)
  buffer_load_dwordx4 v20, s[12:15], s19 offen lds
  v_mul_f32 v84, s24, v84
  v_mul_f32 v85, s24, v85
  v_mfma_f32_32x32x16_bf16 v[96:111], v[28:31], a[72:75], v[96:111]
  ds_read_b128 v[52:55], v15 offset:40960
  v_cvt_pk_bf16_f32 v138, v84, v85
  v_mul_f32 v86, s24, v86
  v_mfma_f32_32x32x16_bf16 v[112:127], v[28:31], a[76:79], v[112:127]
  s_waitcnt lgkmcnt(5)
  v_mul_f32 v87, s24, v87
  v_cvt_pk_bf16_f32 v139, v86, v87
  v_mfma_f32_32x32x16_bf16 v[96:111], v[32:35], a[80:83], v[96:111]
  s_add_u32 m0, s25, 5120
  ds_read_b128 v[24:27], v8 offset:49152
  v_mul_f32 v88, s24, v88
  v_mul_f32 v89, s24, v89
  v_mfma_f32_32x32x16_bf16 v[112:127], v[32:35], a[84:87], v[112:127]
  s_waitcnt lgkmcnt(5)
  buffer_load_dwordx4 v21, s[12:15], s19 offen lds
  v_cvt_pk_bf16_f32 v140, v88, v89
  v_mul_f32 v90, s24, v90
  v_mfma_f32_32x32x16_bf16 v[96:111], v[36:39], a[88:91], v[96:111]
  ds_read_b128 v[28:31], v9 offset:49152
  v_mul_f32 v91, s24, v91
  v_cvt_pk_bf16_f32 v141, v90, v91
  v_mfma_f32_32x32x16_bf16 v[112:127], v[36:39], a[92:95], v[112:127]
  s_waitcnt lgkmcnt(5)
  v_mul_f32 v92, s24, v92
  v_mul_f32 v93, s24, v93
  v_mfma_f32_32x32x16_bf16 v[96:111], v[40:43], a[96:99], v[96:111]
  s_add_u32 m0, s25, 6144
  ds_read_b128 v[32:35], v10 offset:49152
  v_cvt_pk_bf16_f32 v142, v92, v93
  v_mul_f32 v94, s24, v94
  v_mfma_f32_32x32x16_bf16 v[112:127], v[40:43], a[100:103], v[112:127]
  s_waitcnt lgkmcnt(5)
  buffer_load_dwordx4 v22, s[12:15], s19 offen lds
  v_mul_f32 v95, s24, v95
  v_cvt_pk_bf16_f32 v143, v94, v95
  v_mfma_f32_32x32x16_bf16 v[96:111], v[44:47], a[104:107], v[96:111]
  ds_read_b128 v[36:39], v11 offset:49152
  v_mfma_f32_32x32x16_bf16 v[112:127], v[44:47], a[108:111], v[112:127]
  s_waitcnt lgkmcnt(5)
  v_mfma_f32_32x32x16_bf16 v[96:111], v[48:51], a[112:115], v[96:111]
  s_add_u32 m0, s25, 7168
  ds_read_b128 v[40:43], v12 offset:49152
  v_mfma_f32_32x32x16_bf16 v[112:127], v[48:51], a[116:119], v[112:127]
  s_waitcnt lgkmcnt(5)
  buffer_load_dwordx4 v23, s[12:15], s19 offen lds
  v_mfma_f32_32x32x16_bf16 v[96:111], v[52:55], a[120:123], v[96:111]
  s_cmp_gt_u32 s23, 3
  ds_read_b128 v[44:47], v13 offset:49152
  v_mfma_f32_32x32x16_bf16 v[112:127], v[52:55], a[124:127], v[112:127]
  s_waitcnt lgkmcnt(5)
  s_cselect_b32 s26, s20, 0
  v_mfma_f32_32x32x16_bf16 v[96:111], v[24:27], a[128:131], v[96:111]
  s_add_u32 s19, s19, s26
  ds_read_b128 v[48:51], v14 offset:49152
  v_mfma_f32_32x32x16_bf16 v[112:127], v[24:27], a[132:135], v[112:127]
  s_waitcnt lgkmcnt(5)
  s_add_u32 s25, s25, 32768
  v_mfma_f32_32x32x16_bf16 v[96:111], v[28:31], a[136:139], v[96:111]
  s_and_b32 s25, s25, 0x1ffff
  ds_read_b128 v[52:55], v15 offset:49152
  v_mfma_f32_32x32x16_bf16 v[112:127], v[28:31], a[140:143], v[112:127]
  s_waitcnt lgkmcnt(5)
  buffer_store_dwordx4 v[128:131], v2, s[4:7], s21 offen offset:0
  v_mfma_f32_32x32x16_bf16 v[96:111], v[32:35], a[144:147], v[96:111]
  ds_read_b128 v[24:27], v8 offset:57344
  v_mfma_f32_32x32x16_bf16 v[112:127], v[32:35], a[148:151], v[112:127]
  s_waitcnt lgkmcnt(5)
  v_xor_b32 v8, 0x10000, v8
  v_mfma_f32_32x32x16_bf16 v[96:111], v[36:39], a[152:155], v[96:111]
  ds_read_b128 v[28:31], v9 offset:57344
  v_mfma_f32_32x32x16_bf16 v[112:127], v[36:39], a[156:159], v[112:127]
  s_waitcnt lgkmcnt(5)
  buffer_store_dwordx4 v[132:135], v2, s[4:7], s21 offen offset:1024
  v_xor_b32 v9, 0x10000, v9
  v_mfma_f32_32x32x16_bf16 v[96:111], v[40:43], a[160:163], v[96:111]
  ds_read_b128 v[32:35], v10 offset:57344
  v_mfma_f32_32x32x16_bf16 v[112:127], v[40:43], a[164:167], v[112:127]
  s_waitcnt lgkmcnt(5)
  v_xor_b32 v10, 0x10000, v10
  v_mfma_f32_32x32x16_bf16 v[96:111], v[44:47], a[168:171], v[96:111]
  ds_read_b128 v[36:39], v11 offset:57344
  v_mfma_f32_32x32x16_bf16 v[112:127], v[44:47], a[172:175], v[112:127]
  s_waitcnt lgkmcnt(5)
  buffer_store_dwordx4 v[136:139], v2, s[4:7], s21 offen offset:2048
  v_xor_b32 v11, 0x10000, v11
  v_mfma_f32_32x32x16_bf16 v[96:111], v[48:51], a[176:179], v[96:111]
  ds_read_b128 v[40:43], v12 offset:57344
  v_mfma_f32_32x32x16_bf16 v[112:127], v[48:51], a[180:183], v[112:127]
  s_waitcnt lgkmcnt(5)
  v_xor_b32 v12, 0x10000, v12
  v_mfma_f32_32x32x16_bf16 v[96:111], v[52:55], a[184:187], v[96:111]
  ds_read_b128 v[44:47], v13 offset:57344
  v_mfma_f32_32x32x16_bf16 v[112:127], v[52:55], a[188:191], v[112:127]
  s_waitcnt lgkmcnt(5)
  buffer_store_dwordx4 v[140:143], v2, s[4:7], s21 offen offset:3072
  v_xor_b32 v13, 0x10000, v13
  v_mfma_f32_32x32x16_bf16 v[96:111], v[24:27], a[192:195], v[96:111]
  s_mov_b32 s21, s27
  ds_read_b128 v[48:51], v14 offset:57344
  v_mfma_f32_32x32x16_bf16 v[112:127], v[24:27], a[196:199], v[112:127]
  s_waitcnt lgkmcnt(5)
  v_xor_b32 v14, 0x10000, v14
  v_mfma_f32_32x32x16_bf16 v[96:111], v[28:31], a[200:203], v[96:111]
  s_add_u32 s27, s27, s22
  ds_read_b128 v[52:55], v15 offset:57344
  v_mfma_f32_32x32x16_bf16 v[112:127], v[28:31], a[204:207], v[112:127]
  s_waitcnt lgkmcnt(5)
  s_waitcnt vmcnt(16)
  s_barrier
  v_xor_b32 v15, 0x10000, v15
  v_mfma_f32_32x32x16_bf16 v[96:111], v[32:35], a[208:211], v[96:111]
  ds_read_b128 v[24:27], v8 offset:0
  v_mfma_f32_32x32x16_bf16 v[112:127], v[32:35], a[212:215], v[112:127]
  s_waitcnt lgkmcnt(5)
  v_mfma_f32_32x32x16_bf16 v[96:111], v[36:39], a[216:219], v[96:111]
  ds_read_b128 v[28:31], v9 offset:0
  v_mfma_f32_32x32x16_bf16 v[112:127], v[36:39], a[220:223], v[112:127]
  s_waitcnt lgkmcnt(5)
  v_mfma_f32_32x32x16_bf16 v[96:111], v[40:43], a[224:227], v[96:111]
  ds_read_b128 v[32:35], v10 offset:0
  v_mfma_f32_32x32x16_bf16 v[112:127], v[40:43], a[228:231], v[112:127]
  s_waitcnt lgkmcnt(5)
  v_mfma_f32_32x32x16_bf16 v[96:111], v[44:47], a[232:235], v[96:111]
  ds_read_b128 v[36:39], v11 offset:0
  v_mfma_f32_32x32x16_bf16 v[112:127], v[44:47], a[236:239], v[112:127]
  s_waitcnt lgkmcnt(5)
  v_mfma_f32_32x32x16_bf16 v[96:111], v[48:51], a[240:243], v[96:111]
  s_sub_u32 s23, s23, 1
  ds_read_b128 v[40:43], v12 offset:0
  v_mfma_f32_32x32x16_bf16 v[112:127], v[48:51], a[244:247], v[112:127]
  s_waitcnt lgkmcnt(5)
  v_mfma_f32_32x32x16_bf16 v[96:111], v[52:55], a[248:251], v[96:111]
  s_cmp_eq_u32 s23, 0
  ds_read_b128 v[44:47], v13 offset:0
  v_mfma_f32_32x32x16_bf16 v[112:127], v[52:55], a[252:255], v[112:127]
  s_cbranch_scc1 G_done1_10
  s_branch G_top_8
G_done0_9:
  s_nop 7
  s_nop 3
  v_mul_f32 v64, s24, v64
  v_mul_f32 v65, s24, v65
  v_cvt_pk_bf16_f32 v128, v64, v65
  v_mul_f32 v66, s24, v66
  v_mul_f32 v67, s24, v67
  v_cvt_pk_bf16_f32 v129, v66, v67
  v_mul_f32 v68, s24, v68
  v_mul_f32 v69, s24, v69
  v_cvt_pk_bf16_f32 v130, v68, v69
  v_mul_f32 v70, s24, v70
  v_mul_f32 v71, s24, v71
  v_cvt_pk_bf16_f32 v131, v70, v71
  buffer_store_dwordx4 v[128:131], v2, s[4:7], s21 offen offset:0
  v_mul_f32 v72, s24, v72
  v_mul_f32 v73, s24, v73
  v_cvt_pk_bf16_f32 v132, v72, v73
  v_mul_f32 v74, s24, v74
  v_mul_f32 v75, s24, v75
  v_cvt_pk_bf16_f32 v133, v74, v75
  v_mul_f32 v76, s24, v76
  v_mul_f32 v77, s24, v77
  v_cvt_pk_bf16_f32 v134, v76, v77
  v_mul_f32 v78, s24, v78
  v_mul_f32 v79, s24, v79
  v_cvt_pk_bf16_f32 v135, v78, v79
  buffer_store_dwordx4 v[132:135], v2, s[4:7], s21 offen offset:1024
  v_mul_f32 v80, s24, v80
  v_mul_f32 v81, s24, v81
  v_cvt_pk_bf16_f32 v136, v80, v81
  v_mul_f32 v82, s24, v82
  v_mul_f32 v83, s24, v83
  v_cvt_pk_bf16_f32 v137, v82, v83
  v_mul_f32 v84, s24, v84
  v_mul_f32 v85, s24, v85
  v_cvt_pk_bf16_f32 v138, v84, v85
  v_mul_f32 v86, s24, v86
  v_mul_f32 v87, s24, v87
  v_cvt_pk_bf16_f32 v139, v86, v87
  buffer_store_dwordx4 v[136:139], v2, s[4:7], s21 offen offset:2048
  v_mul_f32 v88, s24, v88
  v_mul_f32 v89, s24, v89
  v_cvt_pk_bf16_f32 v140, v88, v89
  v_mul_f32 v90, s24, v90
  v_mul_f32 v91, s24, v91
  v_cvt_pk_bf16_f32 v141, v90, v91
  v_mul_f32 v92, s24, v92
  v_mul_f32 v93, s24, v93
  v_cvt_pk_bf16_f32 v142, v92, v93
  v_mul_f32 v94, s24, v94
  v_mul_f32 v95, s24, v95
  v_cvt_pk_bf16_f32 v143, v94, v95
  buffer_store_dwordx4 v[140:143], v2, s[4:7], s21 offen offset:3072
  s_branch G_fin_11
G_done1_10:
  s_nop 7
  s_nop 3
  v_mul_f32 v96, s24, v96
  v_mul_f32 v97, s24, v97
  v_cvt_pk_bf16_f32 v128, v96, v97
  v_mul_f32 v98, s24, v98
  v_mul_f32 v99, s24, v99
  v_cvt_pk_bf16_f32 v129, v98, v99
  v_mul_f32 v100, s24, v100
  v_mul_f32 v101, s24, v101
  v_cvt_pk_bf16_f32 v130, v100, v101
  v_mul_f32 v102, s24, v102
  v_mul_f32 v103, s24, v103
  v_cvt_pk_bf16_f32 v131, v102, v103
  buffer_store_dwordx4 v[128:131], v2, s[4:7], s21 offen offset:0
  v_mul_f32 v104, s24, v104
  v_mul_f32 v105, s24, v105
  v_cvt_pk_bf16_f32 v132, v104, v105
  v_mul_f32 v106, s24, v106
  v_mul_f32 v107, s24, v107
  v_cvt_pk_bf16_f32 v133, v106, v107
  v_mul_f32 v108, s24, v108
  v_mul_f32 v109, s24, v109
  v_cvt_pk_bf16_f32 v134, v108, v109
  v_mul_f32 v110, s24, v110
  v_mul_f32 v111, s24, v111
  v_cvt_pk_bf16_f32 v135, v110, v111
  buffer_store_dwordx4 v[132:135], v2, s[4:7], s21 offen offset:1024
  v_mul_f32 v112, s24, v112
  v_mul_f32 v113, s24, v113
  v_cvt_pk_bf16_f32 v136, v112, v113
  v_mul_f32 v114, s24, v114
  v_mul_f32 v115, s24, v115
  v_cvt_pk_bf16_f32 v137, v114, v115
  v_mul_f32 v116, s24, v116
  v_mul_f32 v117, s24, v117
  v_cvt_pk_bf16_f32 v138, v116, v117
  v_mul_f32 v118, s24, v118
  v_mul_f32 v119, s24, v119
  v_cvt_pk_bf16_f32 v139, v118, v119
  buffer_store_dwordx4 v[136:139], v2, s[4:7], s21 offen offset:2048
  v_mul_f32 v120, s24, v120
  v_mul_f32 v121, s24, v121
  v_cvt_pk_bf16_f32 v140, v120, v121
  v_mul_f32 v122, s24, v122
  v_mul_f32 v123, s24, v123
  v_cvt_pk_bf16_f32 v141, v122, v123
  v_mul_f32 v124, s24, v124
  v_mul_f32 v125, s24, v125
  v_cvt_pk_bf16_f32 v142, v124, v125
  v_mul_f32 v126, s24, v126
  v_mul_f32 v127, s24, v127
  v_cvt_pk_bf16_f32 v143, v126, v127
  buffer_store_dwordx4 v[140:143], v2, s[4:7], s21 offen offset:3072
G_fin_11:
  s_waitcnt vmcnt(0) lgkmcnt(0)
  s_barrier
P_end_3:
P_exit_1:
  s_endpgm
.text
.globl team_kernel
.p2align 8
.type team_kernel,@function
team_kernel:
  s_cmp_ge_u32 s2, 256
  s_cbranch_scc1 T_exit
  s_and_b32 s3, s2, 7
  s_cbranch_scc1 T_exit
  s_lshr_b32 s12, s2, 3
  s_load_dwordx4 s[60:63], s[0:1], 64
  s_load_dwordx4 s[64:67], s[0:1], 80
  s_load_dwordx4 s[68:71], s[0:1], 120
  s_load_dwordx2 s[72:73], s[0:1], 56
  v_lshrrev_b32 v1, 6, v0
  v_and_b32 v20, 63, v0
  v_readfirstlane_b32 s13, v1
  s_getreg_b32 s36, hwreg(HW_REG_XCC_ID, 0, 4)
  s_lshl_b32 s36, 1, s36
  s_waitcnt lgkmcnt(0)
  s_mov_b32 s8, s60
  s_and_b32 s9, s61, 0xffff
  s_mov_b32 s10, 0x400000
  s_mov_b32 s11, 0x20000
  s_mov_b32 s40, s62
  s_and_b32 s41, s63, 0xffff
  s_mov_b32 s42, 0x400000
  s_mov_b32 s43, 0x20000
  s_mov_b32 s44, s64
  s_and_b32 s45, s65, 0xffff
  s_mov_b32 s46, 0x400000
  s_mov_b32 s47, 0x20000
  s_mov_b32 s48, s66
  s_and_b32 s49, s67, 0xffff
  s_mov_b32 s50, 0x400000
  s_mov_b32 s51, 0x20000
  s_mov_b32 s4, s70
  s_and_b32 s5, s71, 0xffff
  s_mov_b32 s6, 0x10000000
  s_mov_b32 s7, 0x20000
  s_mov_b32 s76, s72
  s_and_b32 s77, s73, 0xffff
  s_mov_b32 s78, 0x2000
  s_mov_b32 s79, 0x20000
  s_mov_b64 s[52:53], s[68:69]
  s_cmp_lg_u32 s13, 0
  s_cbranch_scc1 T_reg_12
  s_atomic_or s36, s[52:53], 4 glc
  s_waitcnt lgkmcnt(0)
  s_mov_b32 s36, 1
  s_atomic_add s36, s[52:53], 0 glc
  s_waitcnt lgkmcnt(0)
T_reg_12:
  v_lshrrev_b32 v21, 4, v20
  v_and_b32 v22, 15, v20
  v_and_b32 v23, 1, v21
  v_lshrrev_b32 v24, 1, v21
  v_lshlrev_b32 v2, 4, v20
  s_lshl_b32 s36, s13, 10
  v_add_u32 v3, s36, v2
  s_lshl_b32 s37, s13, 15
  s_add_u32 s37, s37, 32768
  v_add_u32 v4, s37, v2
  v_lshrrev_b32 v25, 2, v20
  v_lshlrev_b32 v25, 13, v25
  v_and_b32 v1, 3, v20
  v_lshl_add_u32 v25, v1, 4, v25
  s_lshl_b32 s36, s13, 6
  s_lshl_b32 s38, s12, 8
  s_add_u32 s36, s36, s38
  v_add_u32 v25, s36, v25
  v_lshrrev_b32 v26, 3, v20
  v_lshlrev_b32 v26, 10, v26
  v_and_b32 v1, 7, v20
  v_lshl_add_u32 v26, v1, 4, v26
  s_lshl_b32 s36, s13, 7
  s_lshl_b32 s38, s12, 17
  s_add_u32 s36, s36, s38
  v_add_u32 v26, s36, v26
  v_bfe_u32 v29, v20, 2, 1
  v_bfe_u32 v30, v20, 3, 1
  v_and_b32 v31, 3, v20
  v_lshl_add_u32 v27, v24, 1, v29
  v_lshl_add_u32 v27, v27, 1, v23
  v_lshlrev_b32 v27, 7, v27
  v_lshl_add_u32 v27, v30, 5, v27
  v_lshl_add_u32 v27, v31, 3, v27
  v_add_u32 v27, s37, v27
  v_lshl_add_u32 v28, v23, 2, v24
  v_lshl_add_u32 v28, v28, 2, v29
  v_lshlrev_b32 v28, 7, v28
  v_lshl_add_u32 v28, v30, 6, v28
  v_lshl_add_u32 v28, v31, 4, v28
  v_add_u32 v28, s37, v28
  s_mov_b32 s39, s37
  s_add_u32 m0, s39, 0
  s_mov_b32 s37, 524288
  buffer_load_dwordx4 v25, s[8:11], s37 offen lds
  s_add_u32 m0, s39, 1024
  s_mov_b32 s37, 655360
  buffer_load_dwordx4 v25, s[8:11], s37 offen lds
  s_add_u32 m0, s39, 2048
  s_mov_b32 s37, 524288
  buffer_load_dwordx4 v25, s[40:43], s37 offen lds
  s_add_u32 m0, s39, 3072
  s_mov_b32 s37, 655360
  buffer_load_dwordx4 v25, s[40:43], s37 offen lds
  s_add_u32 m0, s39, 4096
  s_mov_b32 s37, 524288
  buffer_load_dwordx4 v25, s[44:47], s37 offen lds
  s_add_u32 m0, s39, 5120
  s_mov_b32 s37, 655360
  buffer_load_dwordx4 v25, s[44:47], s37 offen lds
  s_add_u32 m0, s39, 6144
  s_mov_b32 s37, 786432
  buffer_load_dwordx4 v25, s[8:11], s37 offen lds
  s_add_u32 m0, s39, 7168
  s_mov_b32 s37, 917504
  buffer_load_dwordx4 v25, s[8:11], s37 offen lds
  s_add_u32 m0, s39, 8192
  s_mov_b32 s37, 786432
  buffer_load_dwordx4 v25, s[40:43], s37 offen lds
  s_add_u32 m0, s39, 9216
  s_mov_b32 s37, 917504
  buffer_load_dwordx4 v25, s[40:43], s37 offen lds
  s_add_u32 m0, s39, 10240
  s_mov_b32 s37, 1048576
  buffer_load_dwordx4 v25, s[8:11], s37 offen lds
  s_add_u32 m0, s39, 11264
  s_mov_b32 s37, 1179648
  buffer_load_dwordx4 v25, s[8:11], s37 offen lds
  s_add_u32 m0, s39, 12288
  s_mov_b32 s37, 1048576
  buffer_load_dwordx4 v25, s[40:43], s37 offen lds
  s_add_u32 m0, s39, 13312
  s_mov_b32 s37, 1179648
  buffer_load_dwordx4 v25, s[40:43], s37 offen lds
  s_add_u32 m0, s39, 14336
  s_mov_b32 s37, 1048576
  buffer_load_dwordx4 v25, s[44:47], s37 offen lds
  s_add_u32 m0, s39, 15360
  s_mov_b32 s37, 1179648
  buffer_load_dwordx4 v25, s[44:47], s37 offen lds
  s_add_u32 m0, s39, 16384
  s_mov_b32 s37, 1310720
  buffer_load_dwordx4 v25, s[8:11], s37 offen lds
  s_add_u32 m0, s39, 17408
  s_mov_b32 s37, 1441792
  buffer_load_dwordx4 v25, s[8:11], s37 offen lds
  s_add_u32 m0, s39, 18432
  s_mov_b32 s37, 1310720
  buffer_load_dwordx4 v25, s[40:43], s37 offen lds
  s_add_u32 m0, s39, 19456
  s_mov_b32 s37, 1441792
  buffer_load_dwordx4 v25, s[40:43], s37 offen lds
  s_add_u32 m0, s39, 20480
  s_mov_b32 s37, 1572864
  buffer_load_dwordx4 v25, s[8:11], s37 offen lds
  s_add_u32 m0, s39, 21504
  s_mov_b32 s37, 1703936
  buffer_load_dwordx4 v25, s[8:11], s37 offen lds
  s_add_u32 m0, s39, 22528
  s_mov_b32 s37, 1835008
  buffer_load_dwordx4 v25, s[8:11], s37 offen lds
  s_add_u32 m0, s39, 23552
  s_mov_b32 s37, 1966080
  buffer_load_dwordx4 v25, s[8:11], s37 offen lds
  s_add_u32 m0, s39, 24576
  s_mov_b32 s37, 1835008
  buffer_load_dwordx4 v25, s[40:43], s37 offen lds
  s_add_u32 m0, s39, 25600
  s_mov_b32 s37, 1966080
  buffer_load_dwordx4 v25, s[40:43], s37 offen lds
  s_add_u32 m0, s39, 26624
  s_mov_b32 s37, 1835008
  buffer_load_dwordx4 v25, s[44:47], s37 offen lds
  s_add_u32 m0, s39, 27648
  s_mov_b32 s37, 1966080
  buffer_load_dwordx4 v25, s[44:47], s37 offen lds
  s_add_u32 m0, s39, 28672
  s_mov_b32 s37, 2097152
  buffer_load_dwordx4 v25, s[8:11], s37 offen lds
  s_add_u32 m0, s39, 29696
  s_mov_b32 s37, 2228224
  buffer_load_dwordx4 v25, s[8:11], s37 offen lds
  s_add_u32 m0, s39, 30720
  s_mov_b32 s37, 2097152
  buffer_load_dwordx4 v25, s[40:43], s37 offen lds
  s_add_u32 m0, s39, 31744
  s_mov_b32 s37, 2228224
  buffer_load_dwordx4 v25, s[40:43], s37 offen lds
  v_mov_b32 v0, 0x4444
  v_mov_b32 v1, 0xeeee
  v_cmp_lt_u32 vcc, 7, v22
  s_nop 1
  v_cndmask_b32 v32, v0, v1, vcc
  v_mov_b32 v0, v32
  v_and_b32 v32, 7, v20
  v_lshlrev_b32 v32, 4, v32
  v_lshl_add_u32 v1, v21, 7, v32
  s_lshl_b32 s36, s13, 9
  v_add_u32 v11, s36, v1
  v_lshl_add_u32 v33, v24, 4, v22
  s_lshl_b32 s36, s13, 5
  v_add_u32 v33, s36, v33
  v_lshlrev_b32 v33, 3, v33
  v_mul_u32_u24 v34, 1152, v23
  v_add_u32 v5, v33, v34
  v_bfe_u32 v33, v20, 2, 2
  v_lshl_add_u32 v33, v23, 2, v33
  v_lshl_add_u32 v33, v24, 4, v33
  v_lshlrev_b32 v33, 3, v33
  v_and_b32 v34, 1, v20
  v_mul_u32_u24 v34, 1152, v34
  v_add_u32 v6, v33, v34
  s_lshl_b32 s36, s13, 3
  v_lshrrev_b32 v33, 3, v20
  v_add_u32 v33, s36, v33
  v_mul_u32_u24 v34, 0, v33
  v_add_u32 v34, s12, v34
  v_and_b32 v34, 31, v34
  v_lshl_add_u32 v33, v33, 13, v32
  v_lshl_add_u32 v7, v34, 7, v33
  s_lshr_b32 s36, s12, 2
  s_lshl_b32 s36, s36, 9
  s_and_b32 s37, s12, 1
  s_lshl_b32 s37, s37, 8
  s_add_u32 s36, s36, s37
  s_and_b32 s37, s12, 2
  s_lshl_b32 s37, s37, 5
  s_add_u32 s36, s36, s37
  v_lshlrev_b32 v33, 4, v21
  v_lshl_add_u32 v33, v31, 2, v33
  v_lshl_add_u32 v33, v29, 7, v33
  v_lshl_add_u32 v33, v30, 30, v33
  v_add_u32 v8, s36, v33
  s_lshr_b32 s36, s12, 2
  s_lshl_b32 s36, s36, 6
  s_and_b32 s37, s12, 1
  s_lshl_b32 s37, s37, 5
  s_add_u32 s36, s36, s37
  s_and_b32 s37, s12, 2
  s_lshl_b32 s37, s37, 11
  s_add_u32 s36, s36, s37
  v_lshlrev_b32 v35, 10, v21
  v_lshl_add_u32 v35, v31, 1, v35
  v_lshl_add_u32 v35, v29, 4, v35
  v_add_u32 v35, s36, v35
  buffer_load_ushort v44, v35, s[76:79], 0 offen offset:0
  buffer_load_ushort v45, v35, s[76:79], 0 offen offset:8
  buffer_load_ushort v46, v35, s[76:79], 0 offen offset:512
  buffer_load_ushort v47, v35, s[76:79], 0 offen offset:520
  v_lshlrev_b32 v33, 4, v29
  v_mov_b32 v34, 0x3f80
  v_lshlrev_b32 v33, v33, v34
  v_and_b32 v34, 1, v20
  v_lshl_add_u32 v34, v34, 1, v30
  v_cmp_eq_u32 vcc, 0, v34
  s_nop 1
  v_cndmask_b32 v48, 0, v33, vcc
  v_cmp_eq_u32 vcc, 1, v34
  s_nop 1
  v_cndmask_b32 v49, 0, v33, vcc
  v_cmp_eq_u32 vcc, 2, v34
  s_nop 1
  v_cndmask_b32 v50, 0, v33, vcc
  v_cmp_eq_u32 vcc, 3, v34
  s_nop 1
  v_cndmask_b32 v51, 0, v33, vcc
  ds_write_b128 v2, v[48:51] offset:31232
  v_lshlrev_b32 v33, 9, v21
  s_lshl_b32 s36, s13, 11
  v_add_u32 v33, s36, v33
  v_lshl_add_u32 v10, v22, 4, v33
  v_lshl_add_u32 v33, v30, 8, v33
  v_add_u32 v9, v33, v32
  s_mov_b32 s2, 0x3f803f80
  s_mov_b32 s3, 0x3f803f80
  s_mov_b32 s16, 0
  s_mov_b32 s17, -1
  s_mov_b32 s18, 0x3e0293ee
  s_mov_b32 s54, 0x2f800000
  s_mov_b32 s55, 0x28000000
  s_lshl_b32 s36, s13, 10
  s_add_u32 s31, s36, 8192
  s_add_u32 s32, s36, 12160
  s_add_u32 s33, s36, 16384
  s_add_u32 s34, s36, 20224
  s_lshl_b32 s36, s12, 19
  s_add_u32 s27, s36, 67108864
  s_add_u32 s28, s36, 83886080
  s_mul_i32 s36, s12, 4608
  s_add_u32 s29, s36, 134217728
  s_lshl_b32 s36, s12, 13
  s_add_u32 s22, s36, 144703488
  s_add_u32 s23, s36, 144707584
  s_mov_b32 s20, 144703488
  s_mov_b32 s21, 144707584
  s_waitcnt vmcnt(32)
  ds_read_b64_tr_b16 v[128:129], v27 offset:0
  ds_read_b64_tr_b16 v[130:131], v27 offset:64
  ds_read_b64_tr_b16 v[132:133], v27 offset:1024
  ds_read_b64_tr_b16 v[134:135], v27 offset:1088
  ds_read_b64_tr_b16 v[136:137], v27 offset:2048
  ds_read_b64_tr_b16 v[138:139], v27 offset:2112
  ds_read_b64_tr_b16 v[140:141], v27 offset:3072
  ds_read_b64_tr_b16 v[142:143], v27 offset:3136
  s_waitcnt lgkmcnt(0)
  s_add_u32 m0, s39, 0
  s_mov_b32 s37, 2097152
  buffer_load_dwordx4 v25, s[44:47], s37 offen lds
  s_add_u32 m0, s39, 1024
  s_mov_b32 s37, 2228224
  buffer_load_dwordx4 v25, s[44:47], s37 offen lds
  s_add_u32 m0, s39, 2048
  s_mov_b32 s37, 2359296
  buffer_load_dwordx4 v25, s[8:11], s37 offen lds
  s_add_u32 m0, s39, 3072
  s_mov_b32 s37, 2490368
  buffer_load_dwordx4 v25, s[8:11], s37 offen lds
  s_waitcnt vmcnt(32)
  ds_read_b64_tr_b16 v[144:145], v27 offset:4096
  ds_read_b64_tr_b16 v[146:147], v27 offset:4160
  ds_read_b64_tr_b16 v[148:149], v27 offset:5120
  ds_read_b64_tr_b16 v[150:151], v27 offset:5184
  ds_read_b64_tr_b16 v[152:153], v27 offset:6144
  ds_read_b64_tr_b16 v[154:155], v27 offset:6208
  ds_read_b64_tr_b16 v[156:157], v27 offset:7168
  ds_read_b64_tr_b16 v[158:159], v27 offset:7232
  s_waitcnt lgkmcnt(0)
  s_add_u32 m0, s39, 4096
  s_mov_b32 s37, 2359296
  buffer_load_dwordx4 v25, s[44:47], s37 offen lds
  s_add_u32 m0, s39, 5120
  s_mov_b32 s37, 2490368
  buffer_load_dwordx4 v25, s[44:47], s37 offen lds
  s_add_u32 m0, s39, 6144
  s_mov_b32 s37, 2621440
  buffer_load_dwordx4 v25, s[8:11], s37 offen lds
  s_add_u32 m0, s39, 7168
  s_mov_b32 s37, 2752512
  buffer_load_dwordx4 v25, s[8:11], s37 offen lds
  s_waitcnt vmcnt(32)
  ds_read_b64_tr_b16 v[160:161], v27 offset:8192
  ds_read_b64_tr_b16 v[162:163], v27 offset:8256
  ds_read_b64_tr_b16 v[164:165], v27 offset:9216
  ds_read_b64_tr_b16 v[166:167], v27 offset:9280
  ds_read_b64_tr_b16 v[168:169], v27 offset:10240
  ds_read_b64_tr_b16 v[170:171], v27 offset:10304
  ds_read_b64_tr_b16 v[172:173], v27 offset:11264
  ds_read_b64_tr_b16 v[174:175], v27 offset:11328
  s_waitcnt lgkmcnt(0)
  s_add_u32 m0, s39, 8192
  s_mov_b32 s37, 2621440
  buffer_load_dwordx4 v25, s[40:43], s37 offen lds
  s_add_u32 m0, s39, 9216
  s_mov_b32 s37, 2752512
  buffer_load_dwordx4 v25, s[40:43], s37 offen lds
  s_add_u32 m0, s39, 10240
  s_mov_b32 s37, 2621440
  buffer_load_dwordx4 v25, s[44:47], s37 offen lds
  s_add_u32 m0, s39, 11264
  s_mov_b32 s37, 2752512
  buffer_load_dwordx4 v25, s[44:47], s37 offen lds
  s_waitcnt vmcnt(32)
  ds_read_b64_tr_b16 v[176:177], v27 offset:12288
  ds_read_b64_tr_b16 v[178:179], v27 offset:12352
  ds_read_b64_tr_b16 v[180:181], v27 offset:13312
  ds_read_b64_tr_b16 v[182:183], v27 offset:13376
  ds_read_b64_tr_b16 v[184:185], v27 offset:14336
  ds_read_b64_tr_b16 v[186:187], v27 offset:14400
  ds_read_b64_tr_b16 v[188:189], v27 offset:15360
  ds_read_b64_tr_b16 v[190:191], v27 offset:15424
  s_waitcnt lgkmcnt(0)
  s_add_u32 m0, s39, 12288
  s_mov_b32 s37, 2883584
  buffer_load_dwordx4 v25, s[8:11], s37 offen lds
  s_add_u32 m0, s39, 13312
  s_mov_b32 s37, 3014656
  buffer_load_dwordx4 v25, s[8:11], s37 offen lds
  s_add_u32 m0, s39, 14336
  s_mov_b32 s37, 2883584
  buffer_load_dwordx4 v25, s[40:43], s37 offen lds
  s_add_u32 m0, s39, 15360
  s_mov_b32 s37, 3014656
  buffer_load_dwordx4 v25, s[40:43], s37 offen lds
  s_waitcnt vmcnt(32)
  ds_read_b64_tr_b16 v[192:193], v27 offset:16384
  ds_read_b64_tr_b16 v[194:195], v27 offset:16448
  ds_read_b64_tr_b16 v[196:197], v27 offset:17408
  ds_read_b64_tr_b16 v[198:199], v27 offset:17472
  ds_read_b64_tr_b16 v[200:201], v27 offset:18432
  ds_read_b64_tr_b16 v[202:203], v27 offset:18496
  ds_read_b64_tr_b16 v[204:205], v27 offset:19456
  ds_read_b64_tr_b16 v[206:207], v27 offset:19520
  s_waitcnt lgkmcnt(0)
  s_add_u32 m0, s39, 16384
  s_mov_b32 s37, 2883584
  buffer_load_dwordx4 v25, s[44:47], s37 offen lds
  s_add_u32 m0, s39, 17408
  s_mov_b32 s37, 3014656
  buffer_load_dwordx4 v25, s[44:47], s37 offen lds
  s_add_u32 m0, s39, 18432
  s_mov_b32 s37, 3145728
  buffer_load_dwordx4 v25, s[8:11], s37 offen lds
  s_add_u32 m0, s39, 19456
  s_mov_b32 s37, 3276800
  buffer_load_dwordx4 v25, s[8:11], s37 offen lds
  s_waitcnt vmcnt(32)
  ds_read_b64_tr_b16 v[208:209], v27 offset:20480
  ds_read_b64_tr_b16 v[210:211], v27 offset:20544
  ds_read_b64_tr_b16 v[212:213], v27 offset:21504
  ds_read_b64_tr_b16 v[214:215], v27 offset:21568
  ds_read_b64_tr_b16 v[216:217], v27 offset:22528
  ds_read_b64_tr_b16 v[218:219], v27 offset:22592
  ds_read_b64_tr_b16 v[220:221], v27 offset:23552
  ds_read_b64_tr_b16 v[222:223], v27 offset:23616
  s_waitcnt lgkmcnt(0)
  s_add_u32 m0, s39, 20480
  s_mov_b32 s37, 3145728
  buffer_load_dwordx4 v25, s[40:43], s37 offen lds
  s_add_u32 m0, s39, 21504
  s_mov_b32 s37, 3276800
  buffer_load_dwordx4 v25, s[40:43], s37 offen lds
  s_add_u32 m0, s39, 22528
  s_mov_b32 s37, 3145728
  buffer_load_dwordx4 v25, s[44:47], s37 offen lds
  s_add_u32 m0, s39, 23552
  s_mov_b32 s37, 3276800
  buffer_load_dwordx4 v25, s[44:47], s37 offen lds
  s_waitcnt vmcnt(32)
  ds_read_b64_tr_b16 v[224:225], v27 offset:24576
  ds_read_b64_tr_b16 v[226:227], v27 offset:24640
  ds_read_b64_tr_b16 v[228:229], v27 offset:25600
  ds_read_b64_tr_b16 v[230:231], v27 offset:25664
  ds_read_b64_tr_b16 v[232:233], v27 offset:26624
  ds_read_b64_tr_b16 v[234:235], v27 offset:26688
  ds_read_b64_tr_b16 v[236:237], v27 offset:27648
  ds_read_b64_tr_b16 v[238:239], v27 offset:27712
  s_waitcnt lgkmcnt(0)
  s_add_u32 m0, s39, 24576
  s_mov_b32 s37, 3407872
  buffer_load_dwordx4 v25, s[8:11], s37 offen lds
  s_add_u32 m0, s39, 25600
  s_mov_b32 s37, 3538944
  buffer_load_dwordx4 v25, s[8:11], s37 offen lds
  s_add_u32 m0, s39, 26624
  s_mov_b32 s37, 3407872
  buffer_load_dwordx4 v25, s[44:47], s37 offen lds
  s_add_u32 m0, s39, 27648
  s_mov_b32 s37, 3538944
  buffer_load_dwordx4 v25, s[44:47], s37 offen lds
  s_waitcnt vmcnt(32)
  ds_read_b64_tr_b16 v[240:241], v27 offset:28672
  ds_read_b64_tr_b16 v[242:243], v27 offset:28736
  ds_read_b64_tr_b16 v[244:245], v27 offset:29696
  ds_read_b64_tr_b16 v[246:247], v27 offset:29760
  ds_read_b64_tr_b16 v[248:249], v27 offset:30720
  ds_read_b64_tr_b16 v[250:251], v27 offset:30784
  ds_read_b64_tr_b16 v[252:253], v27 offset:31744
  ds_read_b64_tr_b16 v[254:255], v27 offset:31808
  s_waitcnt lgkmcnt(0)
  s_add_u32 m0, s39, 28672
  s_mov_b32 s37, 3670016
  buffer_load_dwordx4 v25, s[8:11], s37 offen lds
  s_add_u32 m0, s39, 29696
  s_mov_b32 s37, 3801088
  buffer_load_dwordx4 v25, s[8:11], s37 offen lds
  s_add_u32 m0, s39, 30720
  s_mov_b32 s37, 3670016
  buffer_load_dwordx4 v25, s[40:43], s37 offen lds
  s_add_u32 m0, s39, 31744
  s_mov_b32 s37, 3801088
  buffer_load_dwordx4 v25, s[40:43], s37 offen lds
  s_waitcnt vmcnt(28)
  ds_read_b64_tr_b16 a[0:1], v27 offset:0
  ds_read_b64_tr_b16 a[2:3], v27 offset:64
  ds_read_b64_tr_b16 a[4:5], v27 offset:1024
  ds_read_b64_tr_b16 a[6:7], v27 offset:1088
  ds_read_b64_tr_b16 a[8:9], v27 offset:2048
  ds_read_b64_tr_b16 a[10:11], v27 offset:2112
  ds_read_b64_tr_b16 a[12:13], v27 offset:3072
  ds_read_b64_tr_b16 a[14:15], v27 offset:3136
  s_waitcnt lgkmcnt(0)
  s_add_u32 m0, s39, 0
  s_mov_b32 s37, 3670016
  buffer_load_dwordx4 v25, s[44:47], s37 offen lds
  s_add_u32 m0, s39, 1024
  s_mov_b32 s37, 3801088
  buffer_load_dwordx4 v25, s[44:47], s37 offen lds
  s_add_u32 m0, s39, 2048
  s_mov_b32 s37, 3932160
  buffer_load_dwordx4 v25, s[8:11], s37 offen lds
  s_add_u32 m0, s39, 3072
  s_mov_b32 s37, 4063232
  buffer_load_dwordx4 v25, s[8:11], s37 offen lds
  s_waitcnt vmcnt(28)
  ds_read_b64_tr_b16 a[16:17], v27 offset:4096
  ds_read_b64_tr_b16 a[18:19], v27 offset:4160
  ds_read_b64_tr_b16 a[20:21], v27 offset:5120
  ds_read_b64_tr_b16 a[22:23], v27 offset:5184
  ds_read_b64_tr_b16 a[24:25], v27 offset:6144
  ds_read_b64_tr_b16 a[26:27], v27 offset:6208
  ds_read_b64_tr_b16 a[28:29], v27 offset:7168
  ds_read_b64_tr_b16 a[30:31], v27 offset:7232
  s_waitcnt lgkmcnt(0)
  s_add_u32 m0, s39, 4096
  s_mov_b32 s37, 3932160
  buffer_load_dwordx4 v25, s[40:43], s37 offen lds
  s_add_u32 m0, s39, 5120
  s_mov_b32 s37, 4063232
  buffer_load_dwordx4 v25, s[40:43], s37 offen lds
  s_add_u32 m0, s39, 6144
  s_mov_b32 s37, 3932160
  buffer_load_dwordx4 v25, s[44:47], s37 offen lds
  s_add_u32 m0, s39, 7168
  s_mov_b32 s37, 4063232
  buffer_load_dwordx4 v25, s[44:47], s37 offen lds
  s_waitcnt vmcnt(28)
  ds_read_b64_tr_b16 a[32:33], v27 offset:8192
  ds_read_b64_tr_b16 a[34:35], v27 offset:8256
  ds_read_b64_tr_b16 a[36:37], v27 offset:9216
  ds_read_b64_tr_b16 a[38:39], v27 offset:9280
  ds_read_b64_tr_b16 a[40:41], v27 offset:10240
  ds_read_b64_tr_b16 a[42:43], v27 offset:10304
  ds_read_b64_tr_b16 a[44:45], v27 offset:11264
  ds_read_b64_tr_b16 a[46:47], v27 offset:11328
  s_waitcnt lgkmcnt(0)
  s_xor_b32 s36, s13, 0
  s_lshl_b32 s36, s36, 15
  s_add_u32 m0, s39, 8192
  s_add_u32 s37, s36, 0
  buffer_load_dwordx4 v26, s[48:51], s37 offen lds
  s_add_u32 m0, s39, 9216
  s_add_u32 s37, s36, 8192
  buffer_load_dwordx4 v26, s[48:51], s37 offen lds
  s_add_u32 m0, s39, 10240
  s_add_u32 s37, s36, 16384
  buffer_load_dwordx4 v26, s[48:51], s37 offen lds
  s_add_u32 m0, s39, 11264
  s_add_u32 s37, s36, 24576
  buffer_load_dwordx4 v26, s[48:51], s37 offen lds
  s_waitcnt vmcnt(28)
  ds_read_b64_tr_b16 a[48:49], v27 offset:12288
  ds_read_b64_tr_b16 a[50:51], v27 offset:12352
  ds_read_b64_tr_b16 a[52:53], v27 offset:13312
  ds_read_b64_tr_b16 a[54:55], v27 offset:13376
  ds_read_b64_tr_b16 a[56:57], v27 offset:14336
  ds_read_b64_tr_b16 a[58:59], v27 offset:14400
  ds_read_b64_tr_b16 a[60:61], v27 offset:15360
  ds_read_b64_tr_b16 a[62:63], v27 offset:15424
  s_waitcnt lgkmcnt(0)
  s_xor_b32 s36, s13, 0
  s_lshl_b32 s36, s36, 15
  s_add_u32 m0, s39, 12288
  s_add_u32 s37, s36, 512
  buffer_load_dwordx4 v26, s[48:51], s37 offen lds
  s_add_u32 m0, s39, 13312
  s_add_u32 s37, s36, 8704
  buffer_load_dwordx4 v26, s[48:51], s37 offen lds
  s_add_u32 m0, s39, 14336
  s_add_u32 s37, s36, 16896
  buffer_load_dwordx4 v26, s[48:51], s37 offen lds
  s_add_u32 m0, s39, 15360
  s_add_u32 s37, s36, 25088
  buffer_load_dwordx4 v26, s[48:51], s37 offen lds
  s_waitcnt vmcnt(28)
  ds_read_b64_tr_b16 a[64:65], v27 offset:16384
  ds_read_b64_tr_b16 a[66:67], v27 offset:16448
  ds_read_b64_tr_b16 a[68:69], v27 offset:17408
  ds_read_b64_tr_b16 a[70:71], v27 offset:17472
  ds_read_b64_tr_b16 a[72:73], v27 offset:18432
  ds_read_b64_tr_b16 a[74:75], v27 offset:18496
  ds_read_b64_tr_b16 a[76:77], v27 offset:19456
  ds_read_b64_tr_b16 a[78:79], v27 offset:19520
  s_waitcnt lgkmcnt(0)
  s_xor_b32 s36, s13, 1
  s_lshl_b32 s36, s36, 15
  s_add_u32 m0, s39, 16384
  s_add_u32 s37, s36, 0
  buffer_load_dwordx4 v26, s[48:51], s37 offen lds
  s_add_u32 m0, s39, 17408
  s_add_u32 s37, s36, 8192
  buffer_load_dwordx4 v26, s[48:51], s37 offen lds
  s_add_u32 m0, s39, 18432
  s_add_u32 s37, s36, 16384
  buffer_load_dwordx4 v26, s[48:51], s37 offen lds
  s_add_u32 m0, s39, 19456
  s_add_u32 s37, s36, 24576
  buffer_load_dwordx4 v26, s[48:51], s37 offen lds
  s_mov_b32 s19, 0
T_spin_13:
  s_add_u32 s19, s19, 1
  s_cmp_gt_u32 s19, 32768
  s_cbranch_scc1 T_exit
  s_mov_b32 s36, 0
  s_atomic_or s36, s[52:53], 0 glc
  s_waitcnt lgkmcnt(0)
  s_cmp_lt_u32 s36, 32
  s_cbranch_scc1 T_spin_13
  s_mov_b32 s36, 0
  s_atomic_or s36, s[52:53], 4 glc
  s_waitcnt lgkmcnt(0)
  s_bcnt1_i32_b32 s36, s36
  s_cmp_eq_u32 s36, 1
  s_cselect_b32 s56, 0, 1
  v_mov_b32 v40, -1
  v_mov_b32 v41, -1
  v_mov_b32 v42, -1
  v_mov_b32 v43, -1
  v_lshl_or_b32 v44, v45, 16, v44
  v_lshl_or_b32 v46, v47, 16, v46
  v_min_u32 v44, -2, v44
  v_min_u32 v46, -2, v46
  s_cmp_eq_u32 s13, 0
  s_cselect_b32 s36, 0, -1
  v_or_b32 v44, s36, v44
  v_or_b32 v46, s36, v46
  s_lshl_b32 s36, s13, 13
  s_add_u32 s36, s36, 145752064
  s_add_u32 s37, s36, 4096
  s_cmp_lg_u32 s56, 0
  s_cbranch_scc1 T_initg_14
  buffer_store_dwordx4 v[40:43], v3, s[4:7], s22 offen
  buffer_store_dwordx4 v[40:43], v3, s[4:7], s23 offen
  buffer_store_dword v44, v8, s[4:7], s36 offen
  buffer_store_dword v46, v8, s[4:7], s37 offen
  s_branch T_initd_15
T_initg_14:
  buffer_store_dwordx4 v[40:43], v3, s[4:7], s22 offen sc1
  buffer_store_dwordx4 v[40:43], v3, s[4:7], s23 offen sc1
  buffer_store_dword v44, v8, s[4:7], s36 offen sc1
  buffer_store_dword v46, v8, s[4:7], s37 offen sc1
T_initd_15:
  s_waitcnt vmcnt(32)
  ds_read_b64_tr_b16 a[80:81], v27 offset:20480
  ds_read_b64_tr_b16 a[82:83], v27 offset:20544
  ds_read_b64_tr_b16 a[84:85], v27 offset:21504
  ds_read_b64_tr_b16 a[86:87], v27 offset:21568
  ds_read_b64_tr_b16 a[88:89], v27 offset:22528
  ds_read_b64_tr_b16 a[90:91], v27 offset:22592
  ds_read_b64_tr_b16 a[92:93], v27 offset:23552
  ds_read_b64_tr_b16 a[94:95], v27 offset:23616
  s_waitcnt lgkmcnt(0)
  s_xor_b32 s36, s13, 1
  s_lshl_b32 s36, s36, 15
  s_add_u32 m0, s39, 20480
  s_add_u32 s37, s36, 512
  buffer_load_dwordx4 v26, s[48:51], s37 offen lds
  s_add_u32 m0, s39, 21504
  s_add_u32 s37, s36, 8704
  buffer_load_dwordx4 v26, s[48:51], s37 offen lds
  s_add_u32 m0, s39, 22528
  s_add_u32 s37, s36, 16896
  buffer_load_dwordx4 v26, s[48:51], s37 offen lds
  s_add_u32 m0, s39, 23552
  s_add_u32 s37, s36, 25088
  buffer_load_dwordx4 v26, s[48:51], s37 offen lds
  s_waitcnt vmcnt(32)
  ds_read_b64_tr_b16 a[96:97], v27 offset:24576
  ds_read_b64_tr_b16 a[98:99], v27 offset:24640
  ds_read_b64_tr_b16 a[100:101], v27 offset:25600
  ds_read_b64_tr_b16 a[102:103], v27 offset:25664
  ds_read_b64_tr_b16 a[104:105], v27 offset:26624
  ds_read_b64_tr_b16 a[106:107], v27 offset:26688
  ds_read_b64_tr_b16 a[108:109], v27 offset:27648
  ds_read_b64_tr_b16 a[110:111], v27 offset:27712
  s_waitcnt lgkmcnt(0)
  s_xor_b32 s36, s13, 2
  s_lshl_b32 s36, s36, 15
  s_add_u32 m0, s39, 24576
  s_add_u32 s37, s36, 0
  buffer_load_dwordx4 v26, s[48:51], s37 offen lds
  s_add_u32 m0, s39, 25600
  s_add_u32 s37, s36, 8192
  buffer_load_dwordx4 v26, s[48:51], s37 offen lds
  s_add_u32 m0, s39, 26624
  s_add_u32 s37, s36, 16384
  buffer_load_dwordx4 v26, s[48:51], s37 offen lds
  s_add_u32 m0, s39, 27648
  s_add_u32 s37, s36, 24576
  buffer_load_dwordx4 v26, s[48:51], s37 offen lds
  s_waitcnt vmcnt(32)
  ds_read_b64_tr_b16 a[112:113], v27 offset:28672
  ds_read_b64_tr_b16 a[114:115], v27 offset:28736
  ds_read_b64_tr_b16 a[116:117], v27 offset:29696
  ds_read_b64_tr_b16 a[118:119], v27 offset:29760
  ds_read_b64_tr_b16 a[120:121], v27 offset:30720
  ds_read_b64_tr_b16 a[122:123], v27 offset:30784
  ds_read_b64_tr_b16 a[124:125], v27 offset:31744
  ds_read_b64_tr_b16 a[126:127], v27 offset:31808
  s_waitcnt lgkmcnt(0)
  s_xor_b32 s36, s13, 3
  s_lshl_b32 s36, s36, 15
  s_add_u32 m0, s39, 28672
  s_add_u32 s37, s36, 0
  buffer_load_dwordx4 v26, s[48:51], s37 offen lds
  s_add_u32 m0, s39, 29696
  s_add_u32 s37, s36, 8192
  buffer_load_dwordx4 v26, s[48:51], s37 offen lds
  s_add_u32 m0, s39, 30720
  s_add_u32 s37, s36, 16384
  buffer_load_dwordx4 v26, s[48:51], s37 offen lds
  s_add_u32 m0, s39, 31744
  s_add_u32 s37, s36, 24576
  buffer_load_dwordx4 v26, s[48:51], s37 offen lds
  s_waitcnt vmcnt(32)
  ds_read_b64_tr_b16 a[128:129], v27 offset:0
  ds_read_b64_tr_b16 a[130:131], v27 offset:64
  ds_read_b64_tr_b16 a[132:133], v27 offset:1024
  ds_read_b64_tr_b16 a[134:135], v27 offset:1088
  ds_read_b64_tr_b16 a[136:137], v27 offset:2048
  ds_read_b64_tr_b16 a[138:139], v27 offset:2112
  ds_read_b64_tr_b16 a[140:141], v27 offset:3072
  ds_read_b64_tr_b16 a[142:143], v27 offset:3136
  s_waitcnt lgkmcnt(0)
  s_add_u32 m0, s39, 0
  s_mov_b32 s37, 0
  buffer_load_dwordx4 v25, s[8:11], s37 offen lds
  s_add_u32 m0, s39, 1024
  s_mov_b32 s37, 131072
  buffer_load_dwordx4 v25, s[8:11], s37 offen lds
  s_add_u32 m0, s39, 2048
  s_mov_b32 s37, 0
  buffer_load_dwordx4 v25, s[40:43], s37 offen lds
  s_add_u32 m0, s39, 3072
  s_mov_b32 s37, 131072
  buffer_load_dwordx4 v25, s[40:43], s37 offen lds
  s_waitcnt vmcnt(32)
  ds_read_b64_tr_b16 a[144:145], v27 offset:4096
  ds_read_b64_tr_b16 a[146:147], v27 offset:4160
  ds_read_b64_tr_b16 a[148:149], v27 offset:5120
  ds_read_b64_tr_b16 a[150:151], v27 offset:5184
  ds_read_b64_tr_b16 a[152:153], v27 offset:6144
  ds_read_b64_tr_b16 a[154:155], v27 offset:6208
  ds_read_b64_tr_b16 a[156:157], v27 offset:7168
  ds_read_b64_tr_b16 a[158:159], v27 offset:7232
  s_waitcnt lgkmcnt(0)
  s_add_u32 m0, s39, 4096
  s_mov_b32 s37, 0
  buffer_load_dwordx4 v25, s[44:47], s37 offen lds
  s_add_u32 m0, s39, 5120
  s_mov_b32 s37, 131072
  buffer_load_dwordx4 v25, s[44:47], s37 offen lds
  s_add_u32 m0, s39, 6144
  s_mov_b32 s37, 262144
  buffer_load_dwordx4 v25, s[8:11], s37 offen lds
  s_add_u32 m0, s39, 7168
  s_mov_b32 s37, 393216
  buffer_load_dwordx4 v25, s[8:11], s37 offen lds
  s_waitcnt vmcnt(32)
  ds_read_b64_tr_b16 a[160:161], v28 offset:8192
  ds_read_b64_tr_b16 a[162:163], v28 offset:8448
  ds_read_b64_tr_b16 a[164:165], v28 offset:9216
  ds_read_b64_tr_b16 a[166:167], v28 offset:9472
  ds_read_b64_tr_b16 a[168:169], v28 offset:8200
  ds_read_b64_tr_b16 a[170:171], v28 offset:8456
  ds_read_b64_tr_b16 a[172:173], v28 offset:9224
  ds_read_b64_tr_b16 a[174:175], v28 offset:9480
  s_waitcnt lgkmcnt(0)
  s_add_u32 m0, s39, 8192
  s_mov_b32 s37, 262144
  buffer_load_dwordx4 v25, s[40:43], s37 offen lds
  s_add_u32 m0, s39, 9216
  s_mov_b32 s37, 393216
  buffer_load_dwordx4 v25, s[40:43], s37 offen lds
  s_add_u32 m0, s39, 10240
  s_mov_b32 s37, 262144
  buffer_load_dwordx4 v25, s[44:47], s37 offen lds
  s_add_u32 m0, s39, 11264
  s_mov_b32 s37, 393216
  buffer_load_dwordx4 v25, s[44:47], s37 offen lds
  s_waitcnt vmcnt(32)
  ds_read_b64_tr_b16 a[176:177], v28 offset:12288
  ds_read_b64_tr_b16 a[178:179], v28 offset:12544
  ds_read_b64_tr_b16 a[180:181], v28 offset:13312
  ds_read_b64_tr_b16 a[182:183], v28 offset:13568
  ds_read_b64_tr_b16 a[184:185], v28 offset:12296
  ds_read_b64_tr_b16 a[186:187], v28 offset:12552
  ds_read_b64_tr_b16 a[188:189], v28 offset:13320
  ds_read_b64_tr_b16 a[190:191], v28 offset:13576
  s_waitcnt lgkmcnt(0)
  s_add_u32 m0, s39, 12288
  s_mov_b32 s37, 786432
  buffer_load_dwordx4 v25, s[44:47], s37 offen lds
  s_add_u32 m0, s39, 13312
  s_mov_b32 s37, 917504
  buffer_load_dwordx4 v25, s[44:47], s37 offen lds
  s_add_u32 m0, s39, 14336
  s_mov_b32 s37, 1310720
  buffer_load_dwordx4 v25, s[44:47], s37 offen lds
  s_add_u32 m0, s39, 15360
  s_mov_b32 s37, 1441792
  buffer_load_dwordx4 v25, s[44:47], s37 offen lds
  s_waitcnt vmcnt(32)
  ds_read_b64_tr_b16 a[192:193], v28 offset:16384
  ds_read_b64_tr_b16 a[194:195], v28 offset:16640
  ds_read_b64_tr_b16 a[196:197], v28 offset:17408
  ds_read_b64_tr_b16 a[198:199], v28 offset:17664
  ds_read_b64_tr_b16 a[200:201], v28 offset:16392
  ds_read_b64_tr_b16 a[202:203], v28 offset:16648
  ds_read_b64_tr_b16 a[204:205], v28 offset:17416
  ds_read_b64_tr_b16 a[206:207], v28 offset:17672
  s_waitcnt lgkmcnt(0)
  s_add_u32 m0, s39, 16384
  s_mov_b32 s37, 1572864
  buffer_load_dwordx4 v25, s[40:43], s37 offen lds
  s_add_u32 m0, s39, 17408
  s_mov_b32 s37, 1703936
  buffer_load_dwordx4 v25, s[40:43], s37 offen lds
  s_add_u32 m0, s39, 18432
  s_mov_b32 s37, 2359296
  buffer_load_dwordx4 v25, s[40:43], s37 offen lds
  s_add_u32 m0, s39, 19456
  s_mov_b32 s37, 2490368
  buffer_load_dwordx4 v25, s[40:43], s37 offen lds
  s_waitcnt vmcnt(28)
  ds_read_b64_tr_b16 a[208:209], v28 offset:20480
  ds_read_b64_tr_b16 a[210:211], v28 offset:20736
  ds_read_b64_tr_b16 a[212:213], v28 offset:21504
  ds_read_b64_tr_b16 a[214:215], v28 offset:21760
  ds_read_b64_tr_b16 a[216:217], v28 offset:20488
  ds_read_b64_tr_b16 a[218:219], v28 offset:20744
  ds_read_b64_tr_b16 a[220:221], v28 offset:21512
  ds_read_b64_tr_b16 a[222:223], v28 offset:21768
  s_waitcnt lgkmcnt(0)
  s_add_u32 m0, s39, 20480
  s_mov_b32 s37, 3407872
  buffer_load_dwordx4 v25, s[40:43], s37 offen lds
  s_add_u32 m0, s39, 21504
  s_mov_b32 s37, 3538944
  buffer_load_dwordx4 v25, s[40:43], s37 offen lds
  s_add_u32 m0, s39, 22528
  s_mov_b32 s37, 1572864
  buffer_load_dwordx4 v25, s[44:47], s37 offen lds
  s_add_u32 m0, s39, 23552
  s_mov_b32 s37, 1703936
  buffer_load_dwordx4 v25, s[44:47], s37 offen lds
  s_barrier
  s_cmp_lg_u32 s13, 0
  s_cbranch_scc1 T_arm_16
  s_mov_b32 s36, 1
  s_atomic_add s36, s[52:53], 8 glc
  s_waitcnt lgkmcnt(0)
T_arm_16:
  s_waitcnt vmcnt(28)
  ds_read_b64_tr_b16 a[224:225], v28 offset:24576
  ds_read_b64_tr_b16 a[226:227], v28 offset:24832
  ds_read_b64_tr_b16 a[228:229], v28 offset:25600
  ds_read_b64_tr_b16 a[230:231], v28 offset:25856
  ds_read_b64_tr_b16 a[232:233], v28 offset:24584
  ds_read_b64_tr_b16 a[234:235], v28 offset:24840
  ds_read_b64_tr_b16 a[236:237], v28 offset:25608
  ds_read_b64_tr_b16 a[238:239], v28 offset:25864
  s_waitcnt lgkmcnt(0)
  s_xor_b32 s36, s13, 2
  s_lshl_b32 s36, s36, 15
  s_add_u32 m0, s39, 24576
  s_add_u32 s37, s36, 512
  buffer_load_dwordx4 v26, s[48:51], s37 offen lds
  s_add_u32 m0, s39, 25600
  s_add_u32 s37, s36, 8704
  buffer_load_dwordx4 v26, s[48:51], s37 offen lds
  s_add_u32 m0, s39, 26624
  s_add_u32 s37, s36, 16896
  buffer_load_dwordx4 v26, s[48:51], s37 offen lds
  s_add_u32 m0, s39, 27648
  s_add_u32 s37, s36, 25088
  buffer_load_dwordx4 v26, s[48:51], s37 offen lds
  s_waitcnt vmcnt(28)
  ds_read_b64_tr_b16 a[240:241], v28 offset:28672
  ds_read_b64_tr_b16 a[242:243], v28 offset:28928
  ds_read_b64_tr_b16 a[244:245], v28 offset:29696
  ds_read_b64_tr_b16 a[246:247], v28 offset:29952
  ds_read_b64_tr_b16 a[248:249], v28 offset:28680
  ds_read_b64_tr_b16 a[250:251], v28 offset:28936
  ds_read_b64_tr_b16 a[252:253], v28 offset:29704
  ds_read_b64_tr_b16 a[254:255], v28 offset:29960
  s_waitcnt lgkmcnt(0)
  s_xor_b32 s36, s13, 3
  s_lshl_b32 s36, s36, 15
  s_add_u32 m0, s39, 28672
  s_add_u32 s37, s36, 512
  buffer_load_dwordx4 v26, s[48:51], s37 offen lds
  s_add_u32 m0, s39, 29696
  s_add_u32 s37, s36, 8704
  buffer_load_dwordx4 v26, s[48:51], s37 offen lds
  s_add_u32 m0, s39, 30720
  s_add_u32 s37, s36, 16896
  buffer_load_dwordx4 v26, s[48:51], s37 offen lds
  s_add_u32 m0, s39, 31744
  s_add_u32 s37, s36, 25088
  buffer_load_dwordx4 v26, s[48:51], s37 offen lds
  s_mov_b32 m0, s31
  s_nop 0
  buffer_load_dwordx4 v9, s[4:7], s27 offen sc1 lds
  s_mov_b32 m0, s32
  s_nop 0
  buffer_load_dwordx4 v9, s[4:7], s27 offen offset:128 sc1 lds
  s_mov_b32 m0, s33
  s_nop 0
  buffer_load_dwordx4 v10, s[4:7], s28 offen sc1 lds
  s_mov_b32 m0, s34
  s_nop 0
  buffer_load_dwordx4 v10, s[4:7], s28 offen offset:256 sc1 lds
  s_add_u32 s27, s27, 8192
  s_add_u32 s28, s28, 8192
  s_waitcnt vmcnt(32)
  ds_read_b64_tr_b16 v[64:65], v27 offset:0
  ds_read_b64_tr_b16 v[66:67], v27 offset:64
  ds_read_b64_tr_b16 v[68:69], v27 offset:1024
  ds_read_b64_tr_b16 v[70:71], v27 offset:1088
  ds_read_b64_tr_b16 v[72:73], v27 offset:2048
  ds_read_b64_tr_b16 v[74:75], v27 offset:2112
  ds_read_b64_tr_b16 v[76:77], v27 offset:3072
  ds_read_b64_tr_b16 v[78:79], v27 offset:3136
  s_waitcnt lgkmcnt(0)
  ds_write_b128 v4, v[64:67] offset:0
  ds_write_b128 v4, v[68:71] offset:1024
  ds_write_b128 v4, v[72:75] offset:2048
  ds_write_b128 v4, v[76:79] offset:3072
  s_waitcnt lgkmcnt(0)
  s_waitcnt vmcnt(28)
  ds_read_b64_tr_b16 v[64:65], v27 offset:4096
  ds_read_b64_tr_b16 v[66:67], v27 offset:4160
  ds_read_b64_tr_b16 v[68:69], v27 offset:5120
  ds_read_b64_tr_b16 v[70:71], v27 offset:5184
  ds_read_b64_tr_b16 v[72:73], v27 offset:6144
  ds_read_b64_tr_b16 v[74:75], v27 offset:6208
  ds_read_b64_tr_b16 v[76:77], v27 offset:7168
  ds_read_b64_tr_b16 v[78:79], v27 offset:7232
  s_waitcnt lgkmcnt(0)
  ds_write_b128 v4, v[64:67] offset:4096
  ds_write_b128 v4, v[68:71] offset:5120
  ds_write_b128 v4, v[72:75] offset:6144
  ds_write_b128 v4, v[76:79] offset:7168
  s_waitcnt lgkmcnt(0)
  s_waitcnt vmcnt(24)
  ds_read_b64_tr_b16 v[64:65], v27 offset:8192
  ds_read_b64_tr_b16 v[66:67], v27 offset:8256
  ds_read_b64_tr_b16 v[68:69], v27 offset:9216
  ds_read_b64_tr_b16 v[70:71], v27 offset:9280
  ds_read_b64_tr_b16 v[72:73], v27 offset:10240
  ds_read_b64_tr_b16 v[74:75], v27 offset:10304
  ds_read_b64_tr_b16 v[76:77], v27 offset:11264
  ds_read_b64_tr_b16 v[78:79], v27 offset:11328
  s_waitcnt lgkmcnt(0)
  ds_write_b128 v4, v[64:67] offset:8192
  ds_write_b128 v4, v[68:71] offset:9216
  ds_write_b128 v4, v[72:75] offset:10240
  ds_write_b128 v4, v[76:79] offset:11264
  s_waitcnt lgkmcnt(0)
  s_waitcnt vmcnt(20)
  ds_read_b64_tr_b16 v[64:65], v27 offset:12288
  ds_read_b64_tr_b16 v[66:67], v27 offset:12352
  ds_read_b64_tr_b16 v[68:69], v27 offset:13312
  ds_read_b64_tr_b16 v[70:71], v27 offset:13376
  ds_read_b64_tr_b16 v[72:73], v27 offset:14336
  ds_read_b64_tr_b16 v[74:75], v27 offset:14400
  ds_read_b64_tr_b16 v[76:77], v27 offset:15360
  ds_read_b64_tr_b16 v[78:79], v27 offset:15424
  s_waitcnt lgkmcnt(0)
  ds_write_b128 v4, v[64:67] offset:12288
  ds_write_b128 v4, v[68:71] offset:13312
  ds_write_b128 v4, v[72:75] offset:14336
  ds_write_b128 v4, v[76:79] offset:15360
  s_waitcnt lgkmcnt(0)
  s_waitcnt vmcnt(16)
  ds_read_b64_tr_b16 v[64:65], v27 offset:16384
  ds_read_b64_tr_b16 v[66:67], v27 offset:16448
  ds_read_b64_tr_b16 v[68:69], v27 offset:17408
  ds_read_b64_tr_b16 v[70:71], v27 offset:17472
  ds_read_b64_tr_b16 v[72:73], v27 offset:18432
  ds_read_b64_tr_b16 v[74:75], v27 offset:18496
  ds_read_b64_tr_b16 v[76:77], v27 offset:19456
  ds_read_b64_tr_b16 v[78:79], v27 offset:19520
  s_waitcnt lgkmcnt(0)
  ds_write_b128 v4, v[64:67] offset:16384
  ds_write_b128 v4, v[68:71] offset:17408
  ds_write_b128 v4, v[72:75] offset:18432
  ds_write_b128 v4, v[76:79] offset:19456
  s_waitcnt lgkmcnt(0)
  s_waitcnt vmcnt(12)
  ds_read_b64_tr_b16 v[64:65], v27 offset:20480
  ds_read_b64_tr_b16 v[66:67], v27 offset:20544
  ds_read_b64_tr_b16 v[68:69], v27 offset:21504
  ds_read_b64_tr_b16 v[70:71], v27 offset:21568
  ds_read_b64_tr_b16 v[72:73], v27 offset:22528
  ds_read_b64_tr_b16 v[74:75], v27 offset:22592
  ds_read_b64_tr_b16 v[76:77], v27 offset:23552
  ds_read_b64_tr_b16 v[78:79], v27 offset:23616
  s_waitcnt lgkmcnt(0)
  ds_write_b128 v4, v[64:67] offset:20480
  ds_write_b128 v4, v[68:71] offset:21504
  ds_write_b128 v4, v[72:75] offset:22528
  ds_write_b128 v4, v[76:79] offset:23552
  s_waitcnt lgkmcnt(0)
  s_mov_b32 s19, 0
T_spin_17:
  s_add_u32 s19, s19, 1
  s_cmp_gt_u32 s19, 32768
  s_cbranch_scc1 T_exit
  s_mov_b32 s36, 0
  s_atomic_or s36, s[52:53], 8 glc
  s_waitcnt lgkmcnt(0)
  s_cmp_lt_u32 s36, 32
  s_cbranch_scc1 T_spin_17
  s_waitcnt vmcnt(8)
  ds_read_b64_tr_b16 v[64:65], v28 offset:24576
  ds_read_b64_tr_b16 v[66:67], v28 offset:24832
  ds_read_b64_tr_b16 v[68:69], v28 offset:25600
  ds_read_b64_tr_b16 v[70:71], v28 offset:25856
  ds_read_b64_tr_b16 v[72:73], v28 offset:24584
  ds_read_b64_tr_b16 v[74:75], v28 offset:24840
  ds_read_b64_tr_b16 v[76:77], v28 offset:25608
  ds_read_b64_tr_b16 v[78:79], v28 offset:25864
  s_waitcnt lgkmcnt(0)
  ds_write_b128 v4, v[64:67] offset:24576
  ds_write_b128 v4, v[68:71] offset:25600
  ds_write_b128 v4, v[72:75] offset:26624
  ds_write_b128 v4, v[76:79] offset:27648
  s_waitcnt lgkmcnt(0)
  s_waitcnt vmcnt(4)
  ds_read_b64_tr_b16 v[64:65], v28 offset:28672
  ds_read_b64_tr_b16 v[66:67], v28 offset:28928
  ds_read_b64_tr_b16 v[68:69], v28 offset:29696
  ds_read_b64_tr_b16 v[70:71], v28 offset:29952
  ds_read_b64_tr_b16 v[72:73], v28 offset:28680
  ds_read_b64_tr_b16 v[74:75], v28 offset:28936
  ds_read_b64_tr_b16 v[76:77], v28 offset:29704
  ds_read_b64_tr_b16 v[78:79], v28 offset:29960
  s_waitcnt lgkmcnt(0)
  ds_write_b128 v4, v[64:67] offset:28672
  ds_write_b128 v4, v[68:71] offset:29696
  ds_write_b128 v4, v[72:75] offset:30720
  ds_write_b128 v4, v[76:79] offset:31744
  s_waitcnt lgkmcnt(0)
  s_waitcnt vmcnt(0) lgkmcnt(0)
  s_barrier
  ds_read_b128 v[68:71], v4 offset:0
  ds_read_b128 v[72:75], v4 offset:1024
  ds_read_b128 v[76:79], v4 offset:2048
  ds_read_b128 v[80:83], v4 offset:3072
  ds_read_b128 v[84:87], v4 offset:4096
  ds_read_b128 v[88:91], v4 offset:5120
  ds_read_b128 v[92:95], v4 offset:6144
  ds_read_b128 v[96:99], v4 offset:7168
  ds_read_b128 v[100:103], v4 offset:8192
  ds_read_b128 v[104:107], v4 offset:9216
  ds_read_b128 v[108:111], v4 offset:10240
  ds_read_b128 v[112:115], v4 offset:11264
  ds_read_b128 v[28:31], v3 offset:16384
  ds_read_b128 v[32:35], v3 offset:20480
  ds_read_b128 v[36:39], v2 offset:8192
  ds_read_b128 v[40:43], v2 offset:9216
  ds_read_b128 v[44:47], v2 offset:10240
  ds_read_b128 v[48:51], v2 offset:11264
  ds_read_b128 v[52:55], v2 offset:12288
  ds_read_b128 v[56:59], v2 offset:13312
  ds_read_b128 v[60:63], v2 offset:14336
  ds_read_b128 v[64:67], v2 offset:15360
  s_and_b32 s36, s13, 1
  s_lshl_b32 s36, s36, 12
  s_add_u32 s22, s22, s36
  s_add_u32 s23, s36, 145752064
  s_mov_b32 s14, -1
  s_and_b32 s57, s14, 1
  s_and_b32 s36, s14, 3
  s_lshl_b32 s36, s36, 13
  s_add_u32 s26, s36, s23
  s_add_u32 s36, s36, 8192
  s_and_b32 s36, s36, 0x7fff
  s_add_u32 s24, s36, 145752064
  s_add_u32 s25, s36, 145756160
  s_add_u32 s35, s36, s23
  s_waitcnt lgkmcnt(0)
  s_cmp_lg_u32 s56, 0
  s_cbranch_scc1 T_global
  s_mov_b32 s19, 0
  v_mov_b64 v[16:17], 0
  v_mov_b64 v[18:19], 0
  v_mov_b64 v[20:21], 0
  v_mov_b64 v[22:23], 0
  v_mov_b64 v[24:25], 0
  v_mov_b64 v[26:27], 0
  buffer_load_dwordx4 v[124:127], v3, s[4:7], s24 offen sc1
  buffer_load_dwordx4 v[124:127], v3, s[4:7], s24 offen sc1
  buffer_load_dwordx4 v[124:127], v3, s[4:7], s24 offen sc1
  s_branch T_loop_18
.p2align 6
T_retry_19:
  s_mov_b64 exec, vcc
  buffer_load_dwordx4 v[124:127], v3, s[4:7], s24 offen sc1
  s_mov_b64 exec, -1
  s_add_u32 s19, s19, 1
  s_cmp_gt_u32 s19, 32768
  s_cbranch_scc1 T_exit
T_loop_18:
  s_waitcnt vmcnt(2)
  v_max3_u32 v122, v124, v125, v126
  v_max_u32 v122, v122, v127
  v_cmp_eq_u32 vcc, -1, v122
  s_cbranch_vccnz T_retry_19
  ds_write_b128 v3, v[124:127] offset:0
  buffer_load_dwordx4 v[12:15], v3, s[4:7], s25 offen sc1
  s_add_u32 s14, s14, 1
  s_waitcnt lgkmcnt(0)
  s_barrier
  ds_read_b128 v[116:119], v1 offset:0
  ds_read_b128 v[120:123], v1 offset:512
  s_waitcnt lgkmcnt(1)
  v_smfmac_f32_16x16x64_bf16 v[16:19], v[116:119], v[68:75], v0
  ds_read_b128 v[68:71], v4 offset:12288
  v_smfmac_f32_16x16x64_bf16 v[20:23], v[116:119], v[76:83], v0
  s_waitcnt vmcnt(1)
  ds_read_b128 v[124:127], v1 offset:1024
  v_smfmac_f32_16x16x64_bf16 v[24:27], v[116:119], v[84:91], v0
  s_waitcnt lgkmcnt(2)
  ds_read_b128 v[84:87], v1 offset:1536
  v_smfmac_f32_16x16x64_bf16 v[16:19], v[120:123], v[92:99], v0
  s_waitcnt vmcnt(0)
  ds_read_b128 v[72:75], v4 offset:13312
  v_max3_u32 v92, v12, v13, v14
  v_smfmac_f32_16x16x64_bf16 v[20:23], v[120:123], v[100:107], v0
  ds_read_b128 v[88:91], v1 offset:2048
  v_max_u32 v92, v92, v15
  v_smfmac_f32_16x16x64_bf16 v[24:27], v[120:123], v[108:115], v0
  s_waitcnt lgkmcnt(3)
  ds_read_b128 v[116:119], v1 offset:2560
  v_cmp_eq_u32 vcc, -1, v92
  v_smfmac_f32_16x16x64_bf16 v[16:19], v[124:127], v[128:135], v0
  s_cbranch_vccnz T_late_20
T_lateok_21:
  ds_write_b64 v3, v[12:13] offset:4096
  v_smfmac_f32_16x16x64_bf16 v[20:23], v[124:127], v[136:143], v0
  s_and_b32 s57, s14, 1
  s_and_b32 s36, s14, 3
  s_lshl_b32 s36, s36, 13
  v_smfmac_f32_16x16x64_bf16 v[24:27], v[124:127], v[144:151], v0
  s_waitcnt lgkmcnt(4)
  ds_write_b64 v3, v[14:15] offset:4104
  s_add_u32 s26, s36, s23
  v_smfmac_f32_16x16x64_bf16 v[16:19], v[84:87], v[152:159], v0
  s_add_u32 s36, s36, 8192
  ds_read_b128 v[76:79], v4 offset:14336
  s_and_b32 s36, s36, 0x7fff
  v_smfmac_f32_16x16x64_bf16 v[20:23], v[84:87], v[160:167], v0
  s_waitcnt lgkmcnt(5)
  ds_read_b128 v[80:83], v4 offset:15360
  s_mov_b32 m0, s31
  v_smfmac_f32_16x16x64_bf16 v[24:27], v[84:87], v[68:75], v0
  s_waitcnt lgkmcnt(5)
  ds_read_b128 v[92:95], v1 offset:3072
  v_smfmac_f32_16x16x64_bf16 v[16:19], v[88:91], v[168:175], v0
  ds_read_b128 v[96:99], v1 offset:3584
  v_smfmac_f32_16x16x64_bf16 v[20:23], v[88:91], v[176:183], v0
  s_waitcnt lgkmcnt(4)
  s_barrier
  v_smfmac_f32_16x16x64_bf16 v[24:27], v[88:91], v[184:191], v0
  ds_read_b128 v[100:103], v1 offset:4096
  v_mov_b64 v[12:13], s[2:3]
  v_smfmac_f32_16x16x64_bf16 v[16:19], v[116:119], v[192:199], v0
  ds_read_b128 v[104:107], v1 offset:4608
  v_mov_b64 v[14:15], s[2:3]
  v_smfmac_f32_16x16x64_bf16 v[20:23], v[116:119], v[200:207], v0
  s_waitcnt lgkmcnt(4)
  ds_read_b128 v[108:111], v1 offset:5120
  s_add_u32 s24, s36, 145752064
  v_smfmac_f32_16x16x64_bf16 v[24:27], v[116:119], v[76:83], v0
  s_waitcnt lgkmcnt(4)
  ds_read_b128 v[112:115], v1 offset:5632
  s_add_u32 s25, s36, 145756160
  v_smfmac_f32_16x16x64_bf16 v[16:19], v[92:95], v[208:215], v0
  s_waitcnt lgkmcnt(4)
  ds_read_b128 v[120:123], v1 offset:6144
  s_add_u32 s35, s36, s23
  v_smfmac_f32_16x16x64_bf16 v[16:19], v[96:99], v[216:223], v0
  s_waitcnt lgkmcnt(4)
  ds_read_b128 v[124:127], v1 offset:6656
  buffer_load_dwordx4 v9, s[4:7], s27 offen sc1 lds
  v_smfmac_f32_16x16x64_bf16 v[16:19], v[100:103], v[240:247], v0
  s_waitcnt lgkmcnt(4)
  ds_read_b128 v[84:87], v1 offset:7168
  v_smfmac_f32_16x16x64_bf16 v[16:19], v[104:107], a[8:15], v0
  s_waitcnt lgkmcnt(4)
  ds_read_b128 v[88:91], v1 offset:7680
  s_mov_b32 m0, s32
  v_smfmac_f32_16x16x64_bf16 v[16:19], v[108:111], a[24:31], v0
  s_waitcnt lgkmcnt(4)
  ds_read_b128 v[68:71], v4 offset:16384
  v_smfmac_f32_16x16x64_bf16 v[16:19], v[112:115], a[48:55], v0
  s_waitcnt lgkmcnt(4)
  ds_read_b128 v[72:75], v4 offset:17408
  v_smfmac_f32_16x16x64_bf16 v[16:19], v[120:123], a[72:79], v0
  s_waitcnt lgkmcnt(4)
  ds_read_b128 v[76:79], v4 offset:18432
  v_smfmac_f32_16x16x64_bf16 v[16:19], v[124:127], a[96:103], v0
  s_waitcnt lgkmcnt(4)
  buffer_load_dwordx4 v9, s[4:7], s27 offen offset:128 sc1 lds
  v_smfmac_f32_16x16x64_bf16 v[16:19], v[84:87], a[112:119], v0
  s_waitcnt lgkmcnt(3)
  ds_read_b128 v[80:83], v4 offset:19456
  v_smfmac_f32_16x16x64_bf16 v[16:19], v[88:91], a[136:143], v0
  s_waitcnt lgkmcnt(2)
  s_mov_b32 m0, s33
  v_smfmac_f32_16x16x64_bf16 v[20:23], v[92:95], v[68:75], v0
  ds_read_b128 v[68:71], v4 offset:20480
  v_smfmac_f32_16x16x64_bf16 v[20:23], v[96:99], v[224:231], v0
  buffer_load_dwordx4 v10, s[4:7], s28 offen sc1 lds
  s_mov_b32 m0, s34
  v_smfmac_f32_16x16x64_bf16 v[20:23], v[100:103], v[248:255], v0
  s_waitcnt lgkmcnt(1)
  ds_read_b128 v[72:75], v4 offset:21504
  v_mul_f32 v16, s18, v16
  v_smfmac_f32_16x16x64_bf16 v[20:23], v[104:107], v[76:83], v0
  ds_read_b128 v[76:79], v4 offset:22528
  v_mul_f32 v17, s18, v17
  v_smfmac_f32_16x16x64_bf16 v[20:23], v[108:111], a[32:39], v0
  ds_read_b128 v[80:83], v4 offset:23552
  v_mul_f32 v18, s18, v18
  v_smfmac_f32_16x16x64_bf16 v[20:23], v[112:115], a[56:63], v0
  buffer_load_dwordx4 v10, s[4:7], s28 offen offset:256 sc1 lds
  v_mul_f32 v19, s18, v19
  v_smfmac_f32_16x16x64_bf16 v[20:23], v[120:123], a[80:87], v0
  s_waitcnt lgkmcnt(2)
  v_cvt_pk_bf16_f32 v116, v16, v17
  v_smfmac_f32_16x16x64_bf16 v[20:23], v[124:127], v[68:75], v0
  v_cvt_pk_bf16_f32 v117, v18, v19
  v_smfmac_f32_16x16x64_bf16 v[20:23], v[84:87], a[120:127], v0
  ds_write_b64 v5, v[116:117] offset:24576
  v_smfmac_f32_16x16x64_bf16 v[20:23], v[88:91], a[144:151], v0
  s_waitcnt lgkmcnt(1)
  s_add_u32 s27, s27, 8192
  s_add_u32 s28, s28, 8192
  v_smfmac_f32_16x16x64_bf16 v[24:27], v[92:95], v[76:83], v0
  v_smfmac_f32_16x16x64_bf16 v[24:27], v[96:99], v[232:239], v0
  s_nop 1
  v_cvt_pk_bf16_f32 v118, v20, v21
  v_cvt_pk_bf16_f32 v119, v22, v23
  v_smfmac_f32_16x16x64_bf16 v[24:27], v[100:103], a[0:7], v0
  ds_write_b64 v5, v[118:119] offset:26880
  buffer_store_dwordx2 v[118:119], v5, s[4:7], s29 offen
  v_smfmac_f32_16x16x64_bf16 v[24:27], v[104:107], a[16:23], v0
  s_waitcnt lgkmcnt(1)
  s_barrier
  ds_read_b64_tr_b16 v[68:69], v6 offset:24576
  v_smfmac_f32_16x16x64_bf16 v[24:27], v[108:111], a[40:47], v0
  s_nop 0
  ds_read_b64_tr_b16 v[70:71], v6 offset:24640
  ds_read_b64_tr_b16 v[72:73], v6 offset:24832
  v_smfmac_f32_16x16x64_bf16 v[24:27], v[112:115], a[64:71], v0
  s_nop 0
  ds_read_b64_tr_b16 v[74:75], v6 offset:24896
  ds_read_b64_tr_b16 v[76:77], v6 offset:25088
  v_smfmac_f32_16x16x64_bf16 v[24:27], v[120:123], a[88:95], v0
  s_nop 0
  ds_read_b64_tr_b16 v[78:79], v6 offset:25152
  ds_read_b64_tr_b16 v[80:81], v6 offset:25344
  v_smfmac_f32_16x16x64_bf16 v[24:27], v[124:127], a[104:111], v0
  s_waitcnt lgkmcnt(7)
  ds_read_b64_tr_b16 v[82:83], v6 offset:25408
  s_barrier
  v_smfmac_f32_16x16x64_bf16 v[24:27], v[84:87], a[128:135], v0
  s_nop 0
  ds_read_b64_tr_b16 v[92:93], v6 offset:26880
  ds_read_b64_tr_b16 v[94:95], v6 offset:26944
  v_smfmac_f32_16x16x64_bf16 v[24:27], v[88:91], a[152:159], v0
  s_waitcnt lgkmcnt(8)
  ds_read_b64_tr_b16 v[96:97], v6 offset:27136
  ds_read_b64_tr_b16 v[98:99], v6 offset:27200
  v_mfma_f32_16x16x32_bf16 v[16:19], v[36:39], v[68:71], 0
  s_waitcnt lgkmcnt(8)
  ds_read_b64_tr_b16 v[100:101], v6 offset:27392
  ds_read_b64_tr_b16 v[102:103], v6 offset:27456
  v_mfma_f32_16x16x32_bf16 v[16:19], v[40:43], v[72:75], v[16:19]
  s_waitcnt lgkmcnt(8)
  ds_read_b64_tr_b16 v[104:105], v6 offset:27648
  ds_read_b64_tr_b16 v[106:107], v6 offset:27712
  v_mfma_f32_16x16x32_bf16 v[16:19], v[44:47], v[76:79], v[16:19]
  s_waitcnt lgkmcnt(8)
  v_cvt_pk_bf16_f32 v116, v24, v25
  v_cvt_pk_bf16_f32 v117, v26, v27
  v_mfma_f32_16x16x32_bf16 v[16:19], v[48:51], v[80:83], v[16:19]
  s_waitcnt lgkmcnt(6)
  buffer_store_dwordx2 v[116:117], v5, s[4:7], s29 offen offset:2304
  v_mov_b64 v[108:109], 0
  v_mfma_f32_16x16x32_bf16 v[120:123], v[92:95], v[68:71], 0
  s_waitcnt lgkmcnt(4)
  v_mov_b64 v[110:111], 0
  v_mov_b64 v[112:113], 0
  v_mfma_f32_16x16x32_bf16 v[120:123], v[96:99], v[72:75], v[120:123]
  s_waitcnt lgkmcnt(2)
  v_mov_b64 v[114:115], 0
  v_mov_b64 v[36:37], 0
  v_mfma_f32_16x16x32_bf16 v[120:123], v[100:103], v[76:79], v[120:123]
  s_waitcnt lgkmcnt(0)
  v_exp_f32 v124, v16
  v_mfma_f32_16x16x32_bf16 v[120:123], v[104:107], v[80:83], v[120:123]
  s_add_u32 s29, s29, 147456
  v_exp_f32 v125, v17
  v_mfma_f32_16x16x32_bf16 v[20:23], v[52:55], v[68:71], 0
  s_cmp_eq_u32 s14, 63
  v_exp_f32 v126, v18
  v_mfma_f32_16x16x32_bf16 v[20:23], v[56:59], v[72:75], v[20:23]
  s_cbranch_scc1 T_exit
  v_exp_f32 v127, v19
  v_mfma_f32_16x16x32_bf16 v[20:23], v[60:63], v[76:79], v[20:23]
  v_cvt_pk_bf16_f32 v44, v124, v125
  v_cvt_pk_bf16_f32 v45, v126, v127
  v_mfma_f32_16x16x32_bf16 v[20:23], v[64:67], v[80:83], v[20:23]
  v_exp_f32 v124, v120
  v_exp_f32 v125, v121
  v_exp_f32 v126, v122
  v_exp_f32 v127, v123
  v_cvt_pk_bf16_f32 v84, v124, v125
  v_cvt_pk_bf16_f32 v85, v126, v127
  v_cndmask_b32 v48, v84, 0, s[16:17]
  v_cndmask_b32 v49, v85, 0, s[16:17]
  v_cndmask_b32 v50, 0, v84, s[16:17]
  v_cndmask_b32 v51, 0, v85, s[16:17]
  v_exp_f32 v124, v20
  v_mfma_f32_16x16x16_bf16 v[88:91], v[12:13], v[48:49], 0
  v_exp_f32 v125, v21
  v_mfma_f32_16x16x16_bf16 v[24:27], v[116:117], v[48:49], 0
  v_exp_f32 v126, v22
  v_mfma_f32_16x16x16_bf16 v[92:95], v[116:117], v[50:51], 0
  v_exp_f32 v127, v23
  v_cvt_pk_bf16_f32 v46, v124, v125
  v_cvt_pk_bf16_f32 v47, v126, v127
  v_mov_b64 v[38:39], 0
  v_mov_b64 v[40:41], 0
  v_mfma_f32_16x16x32_bf16 v[88:91], v[12:15], v[44:47], v[88:91]
  v_xor_b32 v86, 512, v11
  v_xor_b32 v87, 1024, v11
  v_mfma_f32_16x16x32_bf16 v[24:27], v[28:31], v[44:47], v[24:27]
  v_xor_b32 v72, 1536, v11
  v_mov_b64 v[42:43], 0
  v_mfma_f32_16x16x32_bf16 v[92:95], v[32:35], v[44:47], v[92:95]
  s_nop 1
  v_rcp_f32 v89, v88
  v_subrev_u32 v124, s54, v88
  v_cmp_le_u32 vcc, s55, v124
  s_cbranch_vccnz T_slow_22
T_back_23:
  v_mul_f32 v24, v89, v24
  v_mul_f32 v25, v89, v25
  v_mul_f32 v26, v89, v26
  v_mul_f32 v27, v89, v27
  v_cvt_pk_bf16_f32 v96, v24, v25
  v_cvt_pk_bf16_f32 v97, v26, v27
  v_pk_mul_f32 v[92:93], v[92:93], v[88:89] op_sel:[0,1] op_sel_hi:[1,1]
  v_pk_mul_f32 v[94:95], v[94:95], v[88:89] op_sel:[0,1] op_sel_hi:[1,1]
  v_cvt_pk_bf16_f32 v98, v92, v93
  v_cvt_pk_bf16_f32 v99, v94, v95
  ds_write_b128 v11, v[96:99] offset:29184
  s_nop 0
  v_smfmac_f32_16x16x64_bf16 v[108:111], v[96:99], a[160:167], v0
  ds_read_b128 v[52:55], v4 offset:24576
  v_smfmac_f32_16x16x64_bf16 v[112:115], v[96:99], a[168:175], v0
  ds_read_b128 v[56:59], v4 offset:25600
  v_smfmac_f32_16x16x64_bf16 v[36:39], v[96:99], a[176:183], v0
  v_smfmac_f32_16x16x64_bf16 v[40:43], v[96:99], a[184:191], v0
  s_waitcnt lgkmcnt(2)
  s_barrier
  ds_read_b128 v[100:103], v86 offset:29184
  ds_read_b128 v[104:107], v87 offset:29184
  ds_read_b128 v[68:71], v72 offset:29184
  s_waitcnt lgkmcnt(2)
  v_smfmac_f32_16x16x64_bf16 v[108:111], v[100:103], a[192:199], v0
  ds_read_b128 v[60:63], v4 offset:26624
  v_smfmac_f32_16x16x64_bf16 v[112:115], v[100:103], a[200:207], v0
  s_waitcnt lgkmcnt(2)
  ds_read_b128 v[64:67], v4 offset:27648
  v_smfmac_f32_16x16x64_bf16 v[108:111], v[104:107], a[224:231], v0
  ds_read_b128 v[76:79], v4 offset:28672
  v_smfmac_f32_16x16x64_bf16 v[112:115], v[104:107], a[232:239], v0
  s_waitcnt lgkmcnt(3)
  ds_read_b128 v[80:83], v4 offset:29696
  v_smfmac_f32_16x16x64_bf16 v[108:111], v[68:71], a[240:247], v0
  ds_read_b128 v[28:31], v4 offset:30720
  v_smfmac_f32_16x16x64_bf16 v[112:115], v[68:71], a[248:255], v0
  ds_read_b128 v[32:35], v4 offset:31744
  v_smfmac_f32_16x16x64_bf16 v[36:39], v[100:103], a[208:215], v0
  ds_read_b128 v[116:119], v2 offset:31232
  v_smfmac_f32_16x16x64_bf16 v[40:43], v[100:103], a[216:223], v0
  v_cvt_pk_bf16_f32 v16, v108, v109
  v_cvt_pk_bf16_f32 v17, v110, v111
  v_bfi_b32 v16, 1, s57, v16
  v_cvt_pk_bf16_f32 v18, v112, v113
  v_cvt_pk_bf16_f32 v19, v114, v115
  v_smfmac_f32_16x16x64_bf16 v[36:39], v[104:107], v[52:59], v0
  s_waitcnt lgkmcnt(5)
  buffer_store_dwordx4 v[16:19], v7, s[4:7], s20 offen
  v_smfmac_f32_16x16x64_bf16 v[40:43], v[104:107], v[60:67], v0
  s_waitcnt lgkmcnt(3)
  v_smfmac_f32_16x16x64_bf16 v[36:39], v[68:71], v[76:83], v0
  s_waitcnt lgkmcnt(1)
  v_smfmac_f32_16x16x64_bf16 v[40:43], v[68:71], v[28:35], v0
  s_nop 4
  v_cvt_pk_bf16_f32 v20, v36, v37
  v_cvt_pk_bf16_f32 v21, v38, v39
  v_bfi_b32 v20, 1, s57, v20
  v_cvt_pk_bf16_f32 v22, v40, v41
  v_cvt_pk_bf16_f32 v23, v42, v43
  buffer_store_dwordx4 v[20:23], v7, s[4:7], s21 offen
  ds_read_b128 v[68:71], v4 offset:0
  ds_read_b128 v[72:75], v4 offset:1024
  ds_read_b128 v[76:79], v4 offset:2048
  ds_read_b128 v[80:83], v4 offset:3072
  ds_read_b128 v[84:87], v4 offset:4096
  ds_read_b128 v[88:91], v4 offset:5120
  ds_read_b128 v[92:95], v4 offset:6144
  ds_read_b128 v[96:99], v4 offset:7168
  ds_read_b128 v[100:103], v4 offset:8192
  ds_read_b128 v[104:107], v4 offset:9216
  ds_read_b128 v[108:111], v4 offset:10240
  ds_read_b128 v[112:115], v4 offset:11264
  v_mov_b64 v[16:17], 0
  v_mov_b64 v[18:19], 0
  v_mov_b64 v[20:21], 0
  v_mov_b64 v[22:23], 0
  v_mov_b64 v[24:25], 0
  v_mov_b64 v[26:27], 0
  s_mov_b32 s19, 0
  v_mov_b32 v49, -1
  s_cmp_gt_u32 s13, 1
  s_cbranch_scc1 T_w23_24
  s_waitcnt vmcnt(1)
  s_nop 15
  buffer_load_dwordx4 v[52:55], v2, s[4:7], s22 offen offset:0 sc1
  buffer_load_dwordx4 v[56:59], v2, s[4:7], s22 offen offset:1024 sc1
  buffer_load_dwordx4 v[60:63], v2, s[4:7], s22 offen offset:2048 sc1
  buffer_load_dwordx4 v[64:67], v2, s[4:7], s22 offen offset:3072 sc1
  s_waitcnt lgkmcnt(12)
T_p1_26:
  s_waitcnt vmcnt(3)
  v_mfma_f32_16x16x32_bf16 v[120:123], v[116:119], v[52:55], 0
  v_xor_b32 v48, s57, v52
  s_waitcnt vmcnt(2)
  v_mfma_f32_16x16x32_bf16 v[120:123], v[116:119], v[56:59], v[120:123]
  v_bitop3_b32 v48, v48, v56, s57 bitop3:0xf6
  s_waitcnt vmcnt(1)
  v_mfma_f32_16x16x32_bf16 v[120:123], v[116:119], v[60:63], v[120:123]
  v_bitop3_b32 v48, v48, v60, s57 bitop3:0xf6
  s_waitcnt vmcnt(0)
  v_mfma_f32_16x16x32_bf16 v[120:123], v[116:119], v[64:67], v[120:123]
  v_bitop3_b32 v48, v48, v64, s57 bitop3:0xf6
  v_and_b32 v48, 1, v48
  v_cmp_ne_u32 vcc, 0, v48
  s_cbranch_vccnz T_p1re_27
  s_nop 3
  v_add_f32_dpp v120, v120, v120 row_ror:8 row_mask:0xf bank_mask:0xf
  v_add_f32_dpp v121, v121, v121 row_ror:8 row_mask:0xf bank_mask:0xf
  v_cvt_pk_bf16_f32 v48, v120, v121
  v_min_u32 v48, -2, v48
  buffer_store_dword v48, v8, s[4:7], s35 offen
  buffer_store_dword v49, v8, s[4:7], s26 offen
T_join_25:
  s_barrier
  buffer_load_dwordx4 v[124:127], v3, s[4:7], s24 offen sc1
  ds_read_b128 v[28:31], v3 offset:16384
  ds_read_b128 v[32:35], v3 offset:20480
  ds_read_b128 v[36:39], v2 offset:8192
  ds_read_b128 v[40:43], v2 offset:9216
  buffer_load_dwordx4 v[124:127], v3, s[4:7], s24 offen sc1
  ds_read_b128 v[44:47], v2 offset:10240
  ds_read_b128 v[48:51], v2 offset:11264
  ds_read_b128 v[52:55], v2 offset:12288
  ds_read_b128 v[56:59], v2 offset:13312
  buffer_load_dwordx4 v[124:127], v3, s[4:7], s24 offen sc1
  ds_read_b128 v[60:63], v2 offset:14336
  ds_read_b128 v[64:67], v2 offset:15360
  s_mov_b32 s19, 0
  s_branch T_loop_18
T_p1re_27:
  s_mov_b64 exec, vcc
  buffer_load_dwordx4 v[52:55], v2, s[4:7], s22 offen offset:0 sc1
  buffer_load_dwordx4 v[56:59], v2, s[4:7], s22 offen offset:1024 sc1
  buffer_load_dwordx4 v[60:63], v2, s[4:7], s22 offen offset:2048 sc1
  buffer_load_dwordx4 v[64:67], v2, s[4:7], s22 offen offset:3072 sc1
  s_mov_b64 exec, -1
  s_add_u32 s19, s19, 1
  s_cmp_gt_u32 s19, 32768
  s_cbranch_scc1 T_exit
  s_branch T_p1_26
T_w23_24:
  s_waitcnt vmcnt(4)
  s_branch T_join_25
T_late_20:
  buffer_load_dwordx4 v[12:15], v3, s[4:7], s25 offen sc1
  s_add_u32 s19, s19, 1
  s_cmp_gt_u32 s19, 32768
  s_cbranch_scc1 T_exit
  s_waitcnt vmcnt(0)
  v_max3_u32 v92, v12, v13, v14
  v_max_u32 v92, v92, v15
  v_cmp_eq_u32 vcc, -1, v92
  s_cbranch_vccnz T_late_20
  s_branch T_lateok_21
T_slow_22:
  s_nop 7
  v_max3_f32 v124, v16, v17, v18
  v_max3_f32 v124, v124, v19, v20
  v_max3_f32 v124, v124, v21, v22
  v_max3_f32 v124, v124, v23, v120
  v_max3_f32 v124, v124, v121, v122
  v_max_f32 v124, v124, v123
  v_mov_b32 v125, v124
  s_nop 1
  v_permlane32_swap_b32 v124, v125
  s_nop 1
  v_max_f32 v124, v124, v125
  v_mov_b32 v125, v124
  s_nop 1
  v_permlane16_swap_b32 v124, v125
  s_nop 1
  v_max_f32 v124, v124, v125
  v_sub_f32 v16, v16, v124
  v_sub_f32 v17, v17, v124
  v_sub_f32 v18, v18, v124
  v_sub_f32 v19, v19, v124
  v_exp_f32 v16, v16
  v_exp_f32 v17, v17
  v_exp_f32 v18, v18
  v_exp_f32 v19, v19
  v_sub_f32 v20, v20, v124
  v_sub_f32 v21, v21, v124
  v_sub_f32 v22, v22, v124
  v_sub_f32 v23, v23, v124
  v_exp_f32 v20, v20
  v_exp_f32 v21, v21
  v_exp_f32 v22, v22
  v_exp_f32 v23, v23
  v_sub_f32 v120, v120, v124
  v_sub_f32 v121, v121, v124
  v_sub_f32 v122, v122, v124
  v_sub_f32 v123, v123, v124
  v_exp_f32 v120, v120
  v_exp_f32 v121, v121
  v_exp_f32 v122, v122
  v_exp_f32 v123, v123
  s_nop 0
  v_cvt_pk_bf16_f32 v44, v16, v17
  v_cvt_pk_bf16_f32 v45, v18, v19
  v_cvt_pk_bf16_f32 v46, v20, v21
  v_cvt_pk_bf16_f32 v47, v22, v23
  v_cvt_pk_bf16_f32 v84, v120, v121
  v_cvt_pk_bf16_f32 v85, v122, v123
  v_cndmask_b32 v48, v84, 0, s[16:17]
  v_cndmask_b32 v49, v85, 0, s[16:17]
  v_cndmask_b32 v50, 0, v84, s[16:17]
  v_cndmask_b32 v51, 0, v85, s[16:17]
  s_nop 1
  v_mfma_f32_16x16x16_bf16 v[88:91], v[12:13], v[48:49], 0
  v_mfma_f32_16x16x16_bf16 v[24:27], v[116:117], v[48:49], 0
  v_mfma_f32_16x16x16_bf16 v[92:95], v[116:117], v[50:51], 0
  v_mfma_f32_16x16x32_bf16 v[88:91], v[12:15], v[44:47], v[88:91]
  v_mfma_f32_16x16x32_bf16 v[24:27], v[28:31], v[44:47], v[24:27]
  v_mfma_f32_16x16x32_bf16 v[92:95], v[32:35], v[44:47], v[92:95]
  s_nop 7
  s_nop 1
  v_rcp_f32 v89, v88
  s_nop 0
  s_branch T_back_23
T_global:
  s_mov_b32 s19, 0
  v_mov_b64 v[16:17], 0
  v_mov_b64 v[18:19], 0
  v_mov_b64 v[20:21], 0
  v_mov_b64 v[22:23], 0
  v_mov_b64 v[24:25], 0
  v_mov_b64 v[26:27], 0
  buffer_load_dwordx4 v[124:127], v3, s[4:7], s24 offen sc1
  buffer_load_dwordx4 v[124:127], v3, s[4:7], s24 offen sc1
  buffer_load_dwordx4 v[124:127], v3, s[4:7], s24 offen sc1
  s_branch T_loop_28
.p2align 6
T_retry_29:
  s_mov_b64 exec, vcc
  buffer_load_dwordx4 v[124:127], v3, s[4:7], s24 offen sc1
  s_mov_b64 exec, -1
  s_add_u32 s19, s19, 1
  s_cmp_gt_u32 s19, 32768
  s_cbranch_scc1 T_exit
T_loop_28:
  s_waitcnt vmcnt(2)
  v_max3_u32 v122, v124, v125, v126
  v_max_u32 v122, v122, v127
  v_cmp_eq_u32 vcc, -1, v122
  s_cbranch_vccnz T_retry_29
  ds_write_b128 v3, v[124:127] offset:0
  buffer_load_dwordx4 v[12:15], v3, s[4:7], s25 offen sc1
  s_add_u32 s14, s14, 1
  s_waitcnt lgkmcnt(0)
  s_barrier
  ds_read_b128 v[116:119], v1 offset:0
  ds_read_b128 v[120:123], v1 offset:512
  s_waitcnt lgkmcnt(1)
  v_smfmac_f32_16x16x64_bf16 v[16:19], v[116:119], v[68:75], v0
  ds_read_b128 v[68:71], v4 offset:12288
  v_smfmac_f32_16x16x64_bf16 v[20:23], v[116:119], v[76:83], v0
  s_waitcnt vmcnt(1)
  ds_read_b128 v[124:127], v1 offset:1024
  v_smfmac_f32_16x16x64_bf16 v[24:27], v[116:119], v[84:91], v0
  s_waitcnt lgkmcnt(2)
  ds_read_b128 v[84:87], v1 offset:1536
  v_smfmac_f32_16x16x64_bf16 v[16:19], v[120:123], v[92:99], v0
  s_waitcnt vmcnt(0)
  ds_read_b128 v[72:75], v4 offset:13312
  v_max3_u32 v92, v12, v13, v14
  v_smfmac_f32_16x16x64_bf16 v[20:23], v[120:123], v[100:107], v0
  ds_read_b128 v[88:91], v1 offset:2048
  v_max_u32 v92, v92, v15
  v_smfmac_f32_16x16x64_bf16 v[24:27], v[120:123], v[108:115], v0
  s_waitcnt lgkmcnt(3)
  ds_read_b128 v[116:119], v1 offset:2560
  v_cmp_eq_u32 vcc, -1, v92
  v_smfmac_f32_16x16x64_bf16 v[16:19], v[124:127], v[128:135], v0
  s_cbranch_vccnz T_late_30
T_lateok_31:
  ds_write_b64 v3, v[12:13] offset:4096
  v_smfmac_f32_16x16x64_bf16 v[20:23], v[124:127], v[136:143], v0
  s_and_b32 s57, s14, 1
  s_and_b32 s36, s14, 3
  s_lshl_b32 s36, s36, 13
  v_smfmac_f32_16x16x64_bf16 v[24:27], v[124:127], v[144:151], v0
  s_waitcnt lgkmcnt(4)
  ds_write_b64 v3, v[14:15] offset:4104
  s_add_u32 s26, s36, s23
  v_smfmac_f32_16x16x64_bf16 v[16:19], v[84:87], v[152:159], v0
  s_add_u32 s36, s36, 8192
  ds_read_b128 v[76:79], v4 offset:14336
  s_and_b32 s36, s36, 0x7fff
  v_smfmac_f32_16x16x64_bf16 v[20:23], v[84:87], v[160:167], v0
  s_waitcnt lgkmcnt(5)
  ds_read_b128 v[80:83], v4 offset:15360
  s_mov_b32 m0, s31
  v_smfmac_f32_16x16x64_bf16 v[24:27], v[84:87], v[68:75], v0
  s_waitcnt lgkmcnt(5)
  ds_read_b128 v[92:95], v1 offset:3072
  v_smfmac_f32_16x16x64_bf16 v[16:19], v[88:91], v[168:175], v0
  ds_read_b128 v[96:99], v1 offset:3584
  v_smfmac_f32_16x16x64_bf16 v[20:23], v[88:91], v[176:183], v0
  s_waitcnt lgkmcnt(4)
  s_barrier
  v_smfmac_f32_16x16x64_bf16 v[24:27], v[88:91], v[184:191], v0
  ds_read_b128 v[100:103], v1 offset:4096
  v_mov_b64 v[12:13], s[2:3]
  v_smfmac_f32_16x16x64_bf16 v[16:19], v[116:119], v[192:199], v0
  ds_read_b128 v[104:107], v1 offset:4608
  v_mov_b64 v[14:15], s[2:3]
  v_smfmac_f32_16x16x64_bf16 v[20:23], v[116:119], v[200:207], v0
  s_waitcnt lgkmcnt(4)
  ds_read_b128 v[108:111], v1 offset:5120
  s_add_u32 s24, s36, 145752064
  v_smfmac_f32_16x16x64_bf16 v[24:27], v[116:119], v[76:83], v0
  s_waitcnt lgkmcnt(4)
  ds_read_b128 v[112:115], v1 offset:5632
  s_add_u32 s25, s36, 145756160
  v_smfmac_f32_16x16x64_bf16 v[16:19], v[92:95], v[208:215], v0
  s_waitcnt lgkmcnt(4)
  ds_read_b128 v[120:123], v1 offset:6144
  s_add_u32 s35, s36, s23
  v_smfmac_f32_16x16x64_bf16 v[16:19], v[96:99], v[216:223], v0
  s_waitcnt lgkmcnt(4)
  ds_read_b128 v[124:127], v1 offset:6656
  buffer_load_dwordx4 v9, s[4:7], s27 offen sc1 lds
  v_smfmac_f32_16x16x64_bf16 v[16:19], v[100:103], v[240:247], v0
  s_waitcnt lgkmcnt(4)
  ds_read_b128 v[84:87], v1 offset:7168
  v_smfmac_f32_16x16x64_bf16 v[16:19], v[104:107], a[8:15], v0
  s_waitcnt lgkmcnt(4)
  ds_read_b128 v[88:91], v1 offset:7680
  s_mov_b32 m0, s32
  v_smfmac_f32_16x16x64_bf16 v[16:19], v[108:111], a[24:31], v0
  s_waitcnt lgkmcnt(4)
  ds_read_b128 v[68:71], v4 offset:16384
  v_smfmac_f32_16x16x64_bf16 v[16:19], v[112:115], a[48:55], v0
  s_waitcnt lgkmcnt(4)
  ds_read_b128 v[72:75], v4 offset:17408
  v_smfmac_f32_16x16x64_bf16 v[16:19], v[120:123], a[72:79], v0
  s_waitcnt lgkmcnt(4)
  ds_read_b128 v[76:79], v4 offset:18432
  v_smfmac_f32_16x16x64_bf16 v[16:19], v[124:127], a[96:103], v0
  s_waitcnt lgkmcnt(4)
  buffer_load_dwordx4 v9, s[4:7], s27 offen offset:128 sc1 lds
  v_smfmac_f32_16x16x64_bf16 v[16:19], v[84:87], a[112:119], v0
  s_waitcnt lgkmcnt(3)
  ds_read_b128 v[80:83], v4 offset:19456
  v_smfmac_f32_16x16x64_bf16 v[16:19], v[88:91], a[136:143], v0
  s_waitcnt lgkmcnt(2)
  s_mov_b32 m0, s33
  v_smfmac_f32_16x16x64_bf16 v[20:23], v[92:95], v[68:75], v0
  ds_read_b128 v[68:71], v4 offset:20480
  v_smfmac_f32_16x16x64_bf16 v[20:23], v[96:99], v[224:231], v0
  buffer_load_dwordx4 v10, s[4:7], s28 offen sc1 lds
  s_mov_b32 m0, s34
  v_smfmac_f32_16x16x64_bf16 v[20:23], v[100:103], v[248:255], v0
  s_waitcnt lgkmcnt(1)
  ds_read_b128 v[72:75], v4 offset:21504
  v_mul_f32 v16, s18, v16
  v_smfmac_f32_16x16x64_bf16 v[20:23], v[104:107], v[76:83], v0
  ds_read_b128 v[76:79], v4 offset:22528
  v_mul_f32 v17, s18, v17
  v_smfmac_f32_16x16x64_bf16 v[20:23], v[108:111], a[32:39], v0
  ds_read_b128 v[80:83], v4 offset:23552
  v_mul_f32 v18, s18, v18
  v_smfmac_f32_16x16x64_bf16 v[20:23], v[112:115], a[56:63], v0
  buffer_load_dwordx4 v10, s[4:7], s28 offen offset:256 sc1 lds
  v_mul_f32 v19, s18, v19
  v_smfmac_f32_16x16x64_bf16 v[20:23], v[120:123], a[80:87], v0
  s_waitcnt lgkmcnt(2)
  v_cvt_pk_bf16_f32 v116, v16, v17
  v_smfmac_f32_16x16x64_bf16 v[20:23], v[124:127], v[68:75], v0
  v_cvt_pk_bf16_f32 v117, v18, v19
  v_smfmac_f32_16x16x64_bf16 v[20:23], v[84:87], a[120:127], v0
  ds_write_b64 v5, v[116:117] offset:24576
  v_smfmac_f32_16x16x64_bf16 v[20:23], v[88:91], a[144:151], v0
  s_waitcnt lgkmcnt(1)
  s_add_u32 s27, s27, 8192
  s_add_u32 s28, s28, 8192
  v_smfmac_f32_16x16x64_bf16 v[24:27], v[92:95], v[76:83], v0
  v_smfmac_f32_16x16x64_bf16 v[24:27], v[96:99], v[232:239], v0
  s_nop 1
  v_cvt_pk_bf16_f32 v118, v20, v21
  v_cvt_pk_bf16_f32 v119, v22, v23
  v_smfmac_f32_16x16x64_bf16 v[24:27], v[100:103], a[0:7], v0
  ds_write_b64 v5, v[118:119] offset:26880
  buffer_store_dwordx2 v[118:119], v5, s[4:7], s29 offen
  v_smfmac_f32_16x16x64_bf16 v[24:27], v[104:107], a[16:23], v0
  s_waitcnt lgkmcnt(1)
  s_barrier
  ds_read_b64_tr_b16 v[68:69], v6 offset:24576
  v_smfmac_f32_16x16x64_bf16 v[24:27], v[108:111], a[40:47], v0
  s_nop 0
  ds_read_b64_tr_b16 v[70:71], v6 offset:24640
  ds_read_b64_tr_b16 v[72:73], v6 offset:24832
  v_smfmac_f32_16x16x64_bf16 v[24:27], v[112:115], a[64:71], v0
  s_nop 0
  ds_read_b64_tr_b16 v[74:75], v6 offset:24896
  ds_read_b64_tr_b16 v[76:77], v6 offset:25088
  v_smfmac_f32_16x16x64_bf16 v[24:27], v[120:123], a[88:95], v0
  s_nop 0
  ds_read_b64_tr_b16 v[78:79], v6 offset:25152
  ds_read_b64_tr_b16 v[80:81], v6 offset:25344
  v_smfmac_f32_16x16x64_bf16 v[24:27], v[124:127], a[104:111], v0
  s_waitcnt lgkmcnt(7)
  ds_read_b64_tr_b16 v[82:83], v6 offset:25408
  s_barrier
  v_smfmac_f32_16x16x64_bf16 v[24:27], v[84:87], a[128:135], v0
  s_nop 0
  ds_read_b64_tr_b16 v[92:93], v6 offset:26880
  ds_read_b64_tr_b16 v[94:95], v6 offset:26944
  v_smfmac_f32_16x16x64_bf16 v[24:27], v[88:91], a[152:159], v0
  s_waitcnt lgkmcnt(8)
  ds_read_b64_tr_b16 v[96:97], v6 offset:27136
  ds_read_b64_tr_b16 v[98:99], v6 offset:27200
  v_mfma_f32_16x16x32_bf16 v[16:19], v[36:39], v[68:71], 0
  s_waitcnt lgkmcnt(8)
  ds_read_b64_tr_b16 v[100:101], v6 offset:27392
  ds_read_b64_tr_b16 v[102:103], v6 offset:27456
  v_mfma_f32_16x16x32_bf16 v[16:19], v[40:43], v[72:75], v[16:19]
  s_waitcnt lgkmcnt(8)
  ds_read_b64_tr_b16 v[104:105], v6 offset:27648
  ds_read_b64_tr_b16 v[106:107], v6 offset:27712
  v_mfma_f32_16x16x32_bf16 v[16:19], v[44:47], v[76:79], v[16:19]
  s_waitcnt lgkmcnt(8)
  v_cvt_pk_bf16_f32 v116, v24, v25
  v_cvt_pk_bf16_f32 v117, v26, v27
  v_mfma_f32_16x16x32_bf16 v[16:19], v[48:51], v[80:83], v[16:19]
  s_waitcnt lgkmcnt(6)
  buffer_store_dwordx2 v[116:117], v5, s[4:7], s29 offen offset:2304
  v_mov_b64 v[108:109], 0
  v_mfma_f32_16x16x32_bf16 v[120:123], v[92:95], v[68:71], 0
  s_waitcnt lgkmcnt(4)
  v_mov_b64 v[110:111], 0
  v_mov_b64 v[112:113], 0
  v_mfma_f32_16x16x32_bf16 v[120:123], v[96:99], v[72:75], v[120:123]
  s_waitcnt lgkmcnt(2)
  v_mov_b64 v[114:115], 0
  v_mov_b64 v[36:37], 0
  v_mfma_f32_16x16x32_bf16 v[120:123], v[100:103], v[76:79], v[120:123]
  s_waitcnt lgkmcnt(0)
  v_exp_f32 v124, v16
  v_mfma_f32_16x16x32_bf16 v[120:123], v[104:107], v[80:83], v[120:123]
  s_add_u32 s29, s29, 147456
  v_exp_f32 v125, v17
  v_mfma_f32_16x16x32_bf16 v[20:23], v[52:55], v[68:71], 0
  s_cmp_eq_u32 s14, 63
  v_exp_f32 v126, v18
  v_mfma_f32_16x16x32_bf16 v[20:23], v[56:59], v[72:75], v[20:23]
  s_cbranch_scc1 T_exit
  v_exp_f32 v127, v19
  v_mfma_f32_16x16x32_bf16 v[20:23], v[60:63], v[76:79], v[20:23]
  v_cvt_pk_bf16_f32 v44, v124, v125
  v_cvt_pk_bf16_f32 v45, v126, v127
  v_mfma_f32_16x16x32_bf16 v[20:23], v[64:67], v[80:83], v[20:23]
  v_exp_f32 v124, v120
  v_exp_f32 v125, v121
  v_exp_f32 v126, v122
  v_exp_f32 v127, v123
  v_cvt_pk_bf16_f32 v84, v124, v125
  v_cvt_pk_bf16_f32 v85, v126, v127
  v_cndmask_b32 v48, v84, 0, s[16:17]
  v_cndmask_b32 v49, v85, 0, s[16:17]
  v_cndmask_b32 v50, 0, v84, s[16:17]
  v_cndmask_b32 v51, 0, v85, s[16:17]
  v_exp_f32 v124, v20
  v_mfma_f32_16x16x16_bf16 v[88:91], v[12:13], v[48:49], 0
  v_exp_f32 v125, v21
  v_mfma_f32_16x16x16_bf16 v[24:27], v[116:117], v[48:49], 0
  v_exp_f32 v126, v22
  v_mfma_f32_16x16x16_bf16 v[92:95], v[116:117], v[50:51], 0
  v_exp_f32 v127, v23
  v_cvt_pk_bf16_f32 v46, v124, v125
  v_cvt_pk_bf16_f32 v47, v126, v127
  v_mov_b64 v[38:39], 0
  v_mov_b64 v[40:41], 0
  v_mfma_f32_16x16x32_bf16 v[88:91], v[12:15], v[44:47], v[88:91]
  v_xor_b32 v86, 512, v11
  v_xor_b32 v87, 1024, v11
  v_mfma_f32_16x16x32_bf16 v[24:27], v[28:31], v[44:47], v[24:27]
  v_xor_b32 v72, 1536, v11
  v_mov_b64 v[42:43], 0
  v_mfma_f32_16x16x32_bf16 v[92:95], v[32:35], v[44:47], v[92:95]
  s_nop 1
  v_rcp_f32 v89, v88
  v_subrev_u32 v124, s54, v88
  v_cmp_le_u32 vcc, s55, v124
  s_cbranch_vccnz T_slow_32
T_back_33:
  v_mul_f32 v24, v89, v24
  v_mul_f32 v25, v89, v25
  v_mul_f32 v26, v89, v26
  v_mul_f32 v27, v89, v27
  v_cvt_pk_bf16_f32 v96, v24, v25
  v_cvt_pk_bf16_f32 v97, v26, v27
  v_pk_mul_f32 v[92:93], v[92:93], v[88:89] op_sel:[0,1] op_sel_hi:[1,1]
  v_pk_mul_f32 v[94:95], v[94:95], v[88:89] op_sel:[0,1] op_sel_hi:[1,1]
  v_cvt_pk_bf16_f32 v98, v92, v93
  v_cvt_pk_bf16_f32 v99, v94, v95
  ds_write_b128 v11, v[96:99] offset:29184
  s_nop 0
  v_smfmac_f32_16x16x64_bf16 v[108:111], v[96:99], a[160:167], v0
  ds_read_b128 v[52:55], v4 offset:24576
  v_smfmac_f32_16x16x64_bf16 v[112:115], v[96:99], a[168:175], v0
  ds_read_b128 v[56:59], v4 offset:25600
  v_smfmac_f32_16x16x64_bf16 v[36:39], v[96:99], a[176:183], v0
  v_smfmac_f32_16x16x64_bf16 v[40:43], v[96:99], a[184:191], v0
  s_waitcnt lgkmcnt(2)
  s_barrier
  ds_read_b128 v[100:103], v86 offset:29184
  ds_read_b128 v[104:107], v87 offset:29184
  ds_read_b128 v[68:71], v72 offset:29184
  s_waitcnt lgkmcnt(2)
  v_smfmac_f32_16x16x64_bf16 v[108:111], v[100:103], a[192:199], v0
  ds_read_b128 v[60:63], v4 offset:26624
  v_smfmac_f32_16x16x64_bf16 v[112:115], v[100:103], a[200:207], v0
  s_waitcnt lgkmcnt(2)
  ds_read_b128 v[64:67], v4 offset:27648
  v_smfmac_f32_16x16x64_bf16 v[108:111], v[104:107], a[224:231], v0
  ds_read_b128 v[76:79], v4 offset:28672
  v_smfmac_f32_16x16x64_bf16 v[112:115], v[104:107], a[232:239], v0
  s_waitcnt lgkmcnt(3)
  ds_read_b128 v[80:83], v4 offset:29696
  v_smfmac_f32_16x16x64_bf16 v[108:111], v[68:71], a[240:247], v0
  ds_read_b128 v[28:31], v4 offset:30720
  v_smfmac_f32_16x16x64_bf16 v[112:115], v[68:71], a[248:255], v0
  ds_read_b128 v[32:35], v4 offset:31744
  v_smfmac_f32_16x16x64_bf16 v[36:39], v[100:103], a[208:215], v0
  ds_read_b128 v[116:119], v2 offset:31232
  v_smfmac_f32_16x16x64_bf16 v[40:43], v[100:103], a[216:223], v0
  v_cvt_pk_bf16_f32 v16, v108, v109
  v_cvt_pk_bf16_f32 v17, v110, v111
  v_bfi_b32 v16, 1, s57, v16
  v_cvt_pk_bf16_f32 v18, v112, v113
  v_cvt_pk_bf16_f32 v19, v114, v115
  v_smfmac_f32_16x16x64_bf16 v[36:39], v[104:107], v[52:59], v0
  s_waitcnt lgkmcnt(5)
  buffer_store_dwordx4 v[16:19], v7, s[4:7], s20 offen sc1
  v_smfmac_f32_16x16x64_bf16 v[40:43], v[104:107], v[60:67], v0
  s_waitcnt lgkmcnt(3)
  v_smfmac_f32_16x16x64_bf16 v[36:39], v[68:71], v[76:83], v0
  s_waitcnt lgkmcnt(1)
  v_smfmac_f32_16x16x64_bf16 v[40:43], v[68:71], v[28:35], v0
  s_nop 4
  v_cvt_pk_bf16_f32 v20, v36, v37
  v_cvt_pk_bf16_f32 v21, v38, v39
  v_bfi_b32 v20, 1, s57, v20
  v_cvt_pk_bf16_f32 v22, v40, v41
  v_cvt_pk_bf16_f32 v23, v42, v43
  buffer_store_dwordx4 v[20:23], v7, s[4:7], s21 offen sc1
  ds_read_b128 v[68:71], v4 offset:0
  ds_read_b128 v[72:75], v4 offset:1024
  ds_read_b128 v[76:79], v4 offset:2048
  ds_read_b128 v[80:83], v4 offset:3072
  ds_read_b128 v[84:87], v4 offset:4096
  ds_read_b128 v[88:91], v4 offset:5120
  ds_read_b128 v[92:95], v4 offset:6144
  ds_read_b128 v[96:99], v4 offset:7168
  ds_read_b128 v[100:103], v4 offset:8192
  ds_read_b128 v[104:107], v4 offset:9216
  ds_read_b128 v[108:111], v4 offset:10240
  ds_read_b128 v[112:115], v4 offset:11264
  v_mov_b64 v[16:17], 0
  v_mov_b64 v[18:19], 0
  v_mov_b64 v[20:21], 0
  v_mov_b64 v[22:23], 0
  v_mov_b64 v[24:25], 0
  v_mov_b64 v[26:27], 0
  s_mov_b32 s19, 0
  v_mov_b32 v49, -1
  s_cmp_gt_u32 s13, 1
  s_cbranch_scc1 T_w23_34
  s_waitcnt vmcnt(1)
  s_nop 15
  buffer_load_dwordx4 v[52:55], v2, s[4:7], s22 offen offset:0 sc1
  buffer_load_dwordx4 v[56:59], v2, s[4:7], s22 offen offset:1024 sc1
  buffer_load_dwordx4 v[60:63], v2, s[4:7], s22 offen offset:2048 sc1
  buffer_load_dwordx4 v[64:67], v2, s[4:7], s22 offen offset:3072 sc1
  s_waitcnt lgkmcnt(12)
T_p1_36:
  s_waitcnt vmcnt(3)
  v_mfma_f32_16x16x32_bf16 v[120:123], v[116:119], v[52:55], 0
  v_xor_b32 v48, s57, v52
  s_waitcnt vmcnt(2)
  v_mfma_f32_16x16x32_bf16 v[120:123], v[116:119], v[56:59], v[120:123]
  v_bitop3_b32 v48, v48, v56, s57 bitop3:0xf6
  s_waitcnt vmcnt(1)
  v_mfma_f32_16x16x32_bf16 v[120:123], v[116:119], v[60:63], v[120:123]
  v_bitop3_b32 v48, v48, v60, s57 bitop3:0xf6
  s_waitcnt vmcnt(0)
  v_mfma_f32_16x16x32_bf16 v[120:123], v[116:119], v[64:67], v[120:123]
  v_bitop3_b32 v48, v48, v64, s57 bitop3:0xf6
  v_and_b32 v48, 1, v48
  v_cmp_ne_u32 vcc, 0, v48
  s_cbranch_vccnz T_p1re_37
  s_nop 3
  v_add_f32_dpp v120, v120, v120 row_ror:8 row_mask:0xf bank_mask:0xf
  v_add_f32_dpp v121, v121, v121 row_ror:8 row_mask:0xf bank_mask:0xf
  v_cvt_pk_bf16_f32 v48, v120, v121
  v_min_u32 v48, -2, v48
  buffer_store_dword v48, v8, s[4:7], s35 offen sc1
  buffer_store_dword v49, v8, s[4:7], s26 offen sc1
T_join_35:
  s_barrier
  buffer_load_dwordx4 v[124:127], v3, s[4:7], s24 offen sc1
  ds_read_b128 v[28:31], v3 offset:16384
  ds_read_b128 v[32:35], v3 offset:20480
  ds_read_b128 v[36:39], v2 offset:8192
  ds_read_b128 v[40:43], v2 offset:9216
  buffer_load_dwordx4 v[124:127], v3, s[4:7], s24 offen sc1
  ds_read_b128 v[44:47], v2 offset:10240
  ds_read_b128 v[48:51], v2 offset:11264
  ds_read_b128 v[52:55], v2 offset:12288
  ds_read_b128 v[56:59], v2 offset:13312
  buffer_load_dwordx4 v[124:127], v3, s[4:7], s24 offen sc1
  ds_read_b128 v[60:63], v2 offset:14336
  ds_read_b128 v[64:67], v2 offset:15360
  s_mov_b32 s19, 0
  s_branch T_loop_28
T_p1re_37:
  s_mov_b64 exec, vcc
  buffer_load_dwordx4 v[52:55], v2, s[4:7], s22 offen offset:0 sc1
  buffer_load_dwordx4 v[56:59], v2, s[4:7], s22 offen offset:1024 sc1
  buffer_load_dwordx4 v[60:63], v2, s[4:7], s22 offen offset:2048 sc1
  buffer_load_dwordx4 v[64:67], v2, s[4:7], s22 offen offset:3072 sc1
  s_mov_b64 exec, -1
  s_add_u32 s19, s19, 1
  s_cmp_gt_u32 s19, 32768
  s_cbranch_scc1 T_exit
  s_branch T_p1_36
T_w23_34:
  s_waitcnt vmcnt(4)
  s_branch T_join_35
T_late_30:
  buffer_load_dwordx4 v[12:15], v3, s[4:7], s25 offen sc1
  s_add_u32 s19, s19, 1
  s_cmp_gt_u32 s19, 32768
  s_cbranch_scc1 T_exit
  s_waitcnt vmcnt(0)
  v_max3_u32 v92, v12, v13, v14
  v_max_u32 v92, v92, v15
  v_cmp_eq_u32 vcc, -1, v92
  s_cbranch_vccnz T_late_30
  s_branch T_lateok_31
T_slow_32:
  s_nop 7
  v_max3_f32 v124, v16, v17, v18
  v_max3_f32 v124, v124, v19, v20
  v_max3_f32 v124, v124, v21, v22
  v_max3_f32 v124, v124, v23, v120
  v_max3_f32 v124, v124, v121, v122
  v_max_f32 v124, v124, v123
  v_mov_b32 v125, v124
  s_nop 1
  v_permlane32_swap_b32 v124, v125
  s_nop 1
  v_max_f32 v124, v124, v125
  v_mov_b32 v125, v124
  s_nop 1
  v_permlane16_swap_b32 v124, v125
  s_nop 1
  v_max_f32 v124, v124, v125
  v_sub_f32 v16, v16, v124
  v_sub_f32 v17, v17, v124
  v_sub_f32 v18, v18, v124
  v_sub_f32 v19, v19, v124
  v_exp_f32 v16, v16
  v_exp_f32 v17, v17
  v_exp_f32 v18, v18
  v_exp_f32 v19, v19
  v_sub_f32 v20, v20, v124
  v_sub_f32 v21, v21, v124
  v_sub_f32 v22, v22, v124
  v_sub_f32 v23, v23, v124
  v_exp_f32 v20, v20
  v_exp_f32 v21, v21
  v_exp_f32 v22, v22
  v_exp_f32 v23, v23
  v_sub_f32 v120, v120, v124
  v_sub_f32 v121, v121, v124
  v_sub_f32 v122, v122, v124
  v_sub_f32 v123, v123, v124
  v_exp_f32 v120, v120
  v_exp_f32 v121, v121
  v_exp_f32 v122, v122
  v_exp_f32 v123, v123
  s_nop 0
  v_cvt_pk_bf16_f32 v44, v16, v17
  v_cvt_pk_bf16_f32 v45, v18, v19
  v_cvt_pk_bf16_f32 v46, v20, v21
  v_cvt_pk_bf16_f32 v47, v22, v23
  v_cvt_pk_bf16_f32 v84, v120, v121
  v_cvt_pk_bf16_f32 v85, v122, v123
  v_cndmask_b32 v48, v84, 0, s[16:17]
  v_cndmask_b32 v49, v85, 0, s[16:17]
  v_cndmask_b32 v50, 0, v84, s[16:17]
  v_cndmask_b32 v51, 0, v85, s[16:17]
  s_nop 1
  v_mfma_f32_16x16x16_bf16 v[88:91], v[12:13], v[48:49], 0
  v_mfma_f32_16x16x16_bf16 v[24:27], v[116:117], v[48:49], 0
  v_mfma_f32_16x16x16_bf16 v[92:95], v[116:117], v[50:51], 0
  v_mfma_f32_16x16x32_bf16 v[88:91], v[12:15], v[44:47], v[88:91]
  v_mfma_f32_16x16x32_bf16 v[24:27], v[28:31], v[44:47], v[24:27]
  v_mfma_f32_16x16x32_bf16 v[92:95], v[32:35], v[44:47], v[92:95]
  s_nop 7
  s_nop 1
  v_rcp_f32 v89, v88
  s_nop 0
  s_branch T_back_33
T_exit:
  s_endpgm
.text
.globl attn_kernel
.p2align 8
.type attn_kernel,@function
attn_kernel:
  s_cmp_ge_u32 s2, 256
  s_cbranch_scc1 A_exit_38
  v_lshrrev_b32 v3, 6, v0
  v_and_b32 v1, 63, v0
  v_readfirstlane_b32 s16, v3
  v_lshlrev_b32 v2, 4, v1
  s_load_dwordx2 s[4:5], s[0:1], 128
  s_waitcnt lgkmcnt(0)
  s_and_b32 s5, s5, 0xffff
  s_mov_b32 s6, 268435456
  s_mov_b32 s7, 0x20000
  s_and_b32 s50, s2, 31
  s_lshr_b32 s51, s2, 5
  s_sub_u32 s51, 7, s51
  s_mov_b32 s24, 0xf149f2ca
  s_mov_b32 s29, 0
  v_mov_b32 v6, 0
  v_mov_b32 v7, 0
  s_lshl_b32 s26, s16, 11
  v_add_u32 v3, s26, v2
  v_and_b32 v5, 31, v1
  v_lshrrev_b32 v12, 5, v1
  v_lshlrev_b32 v12, 2, v12
  v_sub_u32 v5, v5, v12
  s_lshl_b32 s26, s50, 19
  s_add_u32 s19, s26, 16777216
  s_add_u32 s20, s26, 33554432
  s_lshl_b32 s27, s51, 2
  s_add_u32 s27, s27, s16
  s_lshl_b32 s27, s27, 14
  s_add_u32 s25, s26, s27
  s_add_u32 s28, s25, 0
  buffer_load_dwordx4 a[128:131], v2, s[4:7], s28 offen offset:0
  buffer_load_dwordx4 a[132:135], v2, s[4:7], s28 offen offset:1024
  buffer_load_dwordx4 a[136:139], v2, s[4:7], s28 offen offset:2048
  buffer_load_dwordx4 a[140:143], v2, s[4:7], s28 offen offset:3072
  s_add_u32 s28, s25, 4096
  buffer_load_dwordx4 a[144:147], v2, s[4:7], s28 offen offset:0
  buffer_load_dwordx4 a[148:151], v2, s[4:7], s28 offen offset:1024
  buffer_load_dwordx4 a[152:155], v2, s[4:7], s28 offen offset:2048
  buffer_load_dwordx4 a[156:159], v2, s[4:7], s28 offen offset:3072
  s_add_u32 s28, s25, 8192
  buffer_load_dwordx4 a[160:163], v2, s[4:7], s28 offen offset:0
  buffer_load_dwordx4 a[164:167], v2, s[4:7], s28 offen offset:1024
  buffer_load_dwordx4 a[168:171], v2, s[4:7], s28 offen offset:2048
  buffer_load_dwordx4 a[172:175], v2, s[4:7], s28 offen offset:3072
  s_add_u32 s28, s25, 12288
  buffer_load_dwordx4 a[176:179], v2, s[4:7], s28 offen offset:0
  buffer_load_dwordx4 a[180:183], v2, s[4:7], s28 offen offset:1024
  buffer_load_dwordx4 a[184:187], v2, s[4:7], s28 offen offset:2048
  buffer_load_dwordx4 a[188:191], v2, s[4:7], s28 offen offset:3072
A_again_39:
  s_lshl_b32 s27, s51, 16
  s_add_u32 s27, s27, 57344
  s_add_u32 s17, s19, s27
  s_add_u32 s18, s20, s27
  s_lshl_b32 s21, s16, 11
  s_mov_b32 m0, s21
  s_nop 0
  buffer_load_dwordx4 v3, s[4:7], s18 offen offset:0 lds
  buffer_load_dwordx4 v3, s[4:7], s18 offen offset:1024 lds
  s_add_u32 m0, s21, 8192
  s_nop 0
  buffer_load_dwordx4 v3, s[4:7], s17 offen offset:0 lds
  buffer_load_dwordx4 v3, s[4:7], s17 offen offset:1024 lds
  s_add_u32 s18, s18, 8192
  s_sub_u32 s18, s18, 8192
  s_max_i32 s18, s18, s20
  s_sub_u32 s17, s17, 8192
  s_max_i32 s17, s17, s19
  s_add_u32 s21, s21, 16384
  s_and_b32 s21, s21, 131071
  s_mov_b32 m0, s21
  s_nop 0
  buffer_load_dwordx4 v3, s[4:7], s18 offen offset:0 lds
  buffer_load_dwordx4 v3, s[4:7], s18 offen offset:1024 lds
  s_add_u32 m0, s21, 8192
  s_nop 0
  buffer_load_dwordx4 v3, s[4:7], s17 offen offset:0 lds
  buffer_load_dwordx4 v3, s[4:7], s17 offen offset:1024 lds
  s_sub_u32 s18, s18, 8192
  s_max_i32 s18, s18, s20
  s_sub_u32 s17, s17, 8192
  s_max_i32 s17, s17, s19
  s_add_u32 s21, s21, 16384
  s_and_b32 s21, s21, 131071
  s_mov_b32 m0, s21
  s_nop 0
  buffer_load_dwordx4 v3, s[4:7], s18 offen offset:0 lds
  buffer_load_dwordx4 v3, s[4:7], s18 offen offset:1024 lds
  s_add_u32 m0, s21, 8192
  s_nop 0
  buffer_load_dwordx4 v3, s[4:7], s17 offen offset:0 lds
  buffer_load_dwordx4 v3, s[4:7], s17 offen offset:1024 lds
  s_sub_u32 s18, s18, 8192
  s_max_i32 s18, s18, s20
  s_sub_u32 s17, s17, 8192
  s_max_i32 s17, s17, s19
  s_add_u32 s21, s21, 16384
  s_and_b32 s21, s21, 131071
  s_mov_b32 m0, s21
  s_nop 0
  buffer_load_dwordx4 v3, s[4:7], s18 offen offset:0 lds
  buffer_load_dwordx4 v3, s[4:7], s18 offen offset:1024 lds
  s_add_u32 m0, s21, 8192
  s_nop 0
  buffer_load_dwordx4 v3, s[4:7], s17 offen offset:0 lds
  buffer_load_dwordx4 v3, s[4:7], s17 offen offset:1024 lds
  s_sub_u32 s18, s18, 8192
  s_max_i32 s18, s18, s20
  s_sub_u32 s17, s17, 8192
  s_max_i32 s17, s17, s19
  s_add_u32 s21, s21, 16384
  s_and_b32 s21, s21, 131071
  s_mov_b32 m0, s21
  s_nop 0
  buffer_load_dwordx4 v3, s[4:7], s18 offen offset:0 lds
  buffer_load_dwordx4 v3, s[4:7], s18 offen offset:1024 lds
  s_add_u32 m0, s21, 8192
  s_nop 0
  buffer_load_dwordx4 v3, s[4:7], s17 offen offset:0 lds
  buffer_load_dwordx4 v3, s[4:7], s17 offen offset:1024 lds
  s_sub_u32 s18, s18, 8192
  s_max_i32 s18, s18, s20
  s_sub_u32 s17, s17, 8192
  s_max_i32 s17, s17, s19
  s_add_u32 s21, s21, 16384
  s_and_b32 s21, s21, 131071
  s_mov_b32 m0, s21
  s_nop 0
  buffer_load_dwordx4 v3, s[4:7], s18 offen offset:0 lds
  buffer_load_dwordx4 v3, s[4:7], s18 offen offset:1024 lds
  s_add_u32 m0, s21, 8192
  s_nop 0
  buffer_load_dwordx4 v3, s[4:7], s17 offen offset:0 lds
  buffer_load_dwordx4 v3, s[4:7], s17 offen offset:1024 lds
  v_accvgpr_write_b32 a0, 0
  v_accvgpr_write_b32 a1, 0
  v_accvgpr_write_b32 a2, 0
  v_accvgpr_write_b32 a3, 0
  v_accvgpr_write_b32 a4, 0
  v_accvgpr_write_b32 a5, 0
  v_accvgpr_write_b32 a6, 0
  v_accvgpr_write_b32 a7, 0
  v_accvgpr_write_b32 a8, 0
  v_accvgpr_write_b32 a9, 0
  v_accvgpr_write_b32 a10, 0
  v_accvgpr_write_b32 a11, 0
  v_accvgpr_write_b32 a12, 0
  v_accvgpr_write_b32 a13, 0
  v_accvgpr_write_b32 a14, 0
  v_accvgpr_write_b32 a15, 0
  v_accvgpr_write_b32 a16, 0
  v_accvgpr_write_b32 a17, 0
  v_accvgpr_write_b32 a18, 0
  v_accvgpr_write_b32 a19, 0
  v_accvgpr_write_b32 a20, 0
  v_accvgpr_write_b32 a21, 0
  v_accvgpr_write_b32 a22, 0
  v_accvgpr_write_b32 a23, 0
  v_accvgpr_write_b32 a24, 0
  v_accvgpr_write_b32 a25, 0
  v_accvgpr_write_b32 a26, 0
  v_accvgpr_write_b32 a27, 0
  v_accvgpr_write_b32 a28, 0
  v_accvgpr_write_b32 a29, 0
  v_accvgpr_write_b32 a30, 0
  v_accvgpr_write_b32 a31, 0
  v_accvgpr_write_b32 a32, 0
  v_accvgpr_write_b32 a33, 0
  v_accvgpr_write_b32 a34, 0
  v_accvgpr_write_b32 a35, 0
  v_accvgpr_write_b32 a36, 0
  v_accvgpr_write_b32 a37, 0
  v_accvgpr_write_b32 a38, 0
  v_accvgpr_write_b32 a39, 0
  v_accvgpr_write_b32 a40, 0
  v_accvgpr_write_b32 a41, 0
  v_accvgpr_write_b32 a42, 0
  v_accvgpr_write_b32 a43, 0
  v_accvgpr_write_b32 a44, 0
  v_accvgpr_write_b32 a45, 0
  v_accvgpr_write_b32 a46, 0
  v_accvgpr_write_b32 a47, 0
  v_accvgpr_write_b32 a48, 0
  v_accvgpr_write_b32 a49, 0
  v_accvgpr_write_b32 a50, 0
  v_accvgpr_write_b32 a51, 0
  v_accvgpr_write_b32 a52, 0
  v_accvgpr_write_b32 a53, 0
  v_accvgpr_write_b32 a54, 0
  v_accvgpr_write_b32 a55, 0
  v_accvgpr_write_b32 a56, 0
  v_accvgpr_write_b32 a57, 0
  v_accvgpr_write_b32 a58, 0
  v_accvgpr_write_b32 a59, 0
  v_accvgpr_write_b32 a60, 0
  v_accvgpr_write_b32 a61, 0
  v_accvgpr_write_b32 a62, 0
  v_accvgpr_write_b32 a63, 0
  v_accvgpr_write_b32 a64, 0
  v_accvgpr_write_b32 a65, 0
  v_accvgpr_write_b32 a66, 0
  v_accvgpr_write_b32 a67, 0
  v_accvgpr_write_b32 a68, 0
  v_accvgpr_write_b32 a69, 0
  v_accvgpr_write_b32 a70, 0
  v_accvgpr_write_b32 a71, 0
  v_accvgpr_write_b32 a72, 0
  v_accvgpr_write_b32 a73, 0
  v_accvgpr_write_b32 a74, 0
  v_accvgpr_write_b32 a75, 0
  v_accvgpr_write_b32 a76, 0
  v_accvgpr_write_b32 a77, 0
  v_accvgpr_write_b32 a78, 0
  v_accvgpr_write_b32 a79, 0
  v_accvgpr_write_b32 a80, 0
  v_accvgpr_write_b32 a81, 0
  v_accvgpr_write_b32 a82, 0
  v_accvgpr_write_b32 a83, 0
  v_accvgpr_write_b32 a84, 0
  v_accvgpr_write_b32 a85, 0
  v_accvgpr_write_b32 a86, 0
  v_accvgpr_write_b32 a87, 0
  v_accvgpr_write_b32 a88, 0
  v_accvgpr_write_b32 a89, 0
  v_accvgpr_write_b32 a90, 0
  v_accvgpr_write_b32 a91, 0
  v_accvgpr_write_b32 a92, 0
  v_accvgpr_write_b32 a93, 0
  v_accvgpr_write_b32 a94, 0
  v_accvgpr_write_b32 a95, 0
  v_accvgpr_write_b32 a96, 0
  v_accvgpr_write_b32 a97, 0
  v_accvgpr_write_b32 a98, 0
  v_accvgpr_write_b32 a99, 0
  v_accvgpr_write_b32 a100, 0
  v_accvgpr_write_b32 a101, 0
  v_accvgpr_write_b32 a102, 0
  v_accvgpr_write_b32 a103, 0
  v_accvgpr_write_b32 a104, 0
  v_accvgpr_write_b32 a105, 0
  v_accvgpr_write_b32 a106, 0
  v_accvgpr_write_b32 a107, 0
  v_accvgpr_write_b32 a108, 0
  v_accvgpr_write_b32 a109, 0
  v_accvgpr_write_b32 a110, 0
  v_accvgpr_write_b32 a111, 0
  v_accvgpr_write_b32 a112, 0
  v_accvgpr_write_b32 a113, 0
  v_accvgpr_write_b32 a114, 0
  v_accvgpr_write_b32 a115, 0
  v_accvgpr_write_b32 a116, 0
  v_accvgpr_write_b32 a117, 0
  v_accvgpr_write_b32 a118, 0
  v_accvgpr_write_b32 a119, 0
  v_accvgpr_write_b32 a120, 0
  v_accvgpr_write_b32 a121, 0
  v_accvgpr_write_b32 a122, 0
  v_accvgpr_write_b32 a123, 0
  v_accvgpr_write_b32 a124, 0
  v_accvgpr_write_b32 a125, 0
  v_accvgpr_write_b32 a126, 0
  v_accvgpr_write_b32 a127, 0
  v_mov_b32 v8, 0
  v_mov_b32 v9, 0
  v_mov_b32 v10, 0
  v_mov_b32 v11, 0
  v_mov_b32 v52, 0
  v_mov_b32 v53, 0
  v_mov_b32 v54, s24
  v_mov_b32 v55, s24
  v_mov_b32 v56, s24
  v_mov_b32 v57, s24
  v_mov_b32 v58, s24
  v_mov_b32 v59, s24
  v_mov_b32 v60, s24
  v_mov_b32 v61, s24
  v_mov_b32 v62, s24
  v_mov_b32 v63, s24
  v_mov_b32 v104, 0
  v_mov_b32 v105, 0
  v_mov_b32 v4, v2
  v_mov_b32 v64, s24
  v_mov_b32 v65, s24
  v_mov_b32 v66, s24
  v_mov_b32 v67, s24
  v_mov_b32 v68, s24
  v_mov_b32 v69, s24
  v_mov_b32 v70, s24
  v_mov_b32 v71, s24
  v_mov_b32 v72, s24
  v_mov_b32 v73, s24
  v_mov_b32 v74, s24
  v_mov_b32 v75, s24
  v_mov_b32 v76, s24
  v_mov_b32 v77, s24
  v_mov_b32 v78, s24
  v_mov_b32 v79, s24
  v_mov_b32 v12, s24
  v_cmp_le_i32 s[40:41], 0, v5
  v_cmp_le_i32 s[42:43], 1, v5
  v_cmp_le_i32 s[44:45], 2, v5
  v_cmp_le_i32 s[46:47], 3, v5
  v_cndmask_b32 v80, v12, v7, s[40:41]
  v_cndmask_b32 v81, v12, v7, s[42:43]
  v_cndmask_b32 v82, v12, v7, s[44:45]
  v_cndmask_b32 v83, v12, v7, s[46:47]
  v_cmp_le_i32 s[40:41], 8, v5
  v_cmp_le_i32 s[42:43], 9, v5
  v_cmp_le_i32 s[44:45], 10, v5
  v_cmp_le_i32 s[46:47], 11, v5
  v_cndmask_b32 v84, v12, v7, s[40:41]
  v_cndmask_b32 v85, v12, v7, s[42:43]
  v_cndmask_b32 v86, v12, v7, s[44:45]
  v_cndmask_b32 v87, v12, v7, s[46:47]
  v_cmp_le_i32 s[40:41], 16, v5
  v_cmp_le_i32 s[42:43], 17, v5
  v_cmp_le_i32 s[44:45], 18, v5
  v_cmp_le_i32 s[46:47], 19, v5
  v_cndmask_b32 v88, v12, v7, s[40:41]
  v_cndmask_b32 v89, v12, v7, s[42:43]
  v_cndmask_b32 v90, v12, v7, s[44:45]
  v_cndmask_b32 v91, v12, v7, s[46:47]
  v_cmp_le_i32 s[40:41], 24, v5
  v_cmp_le_i32 s[42:43], 25, v5
  v_cmp_le_i32 s[44:45], 26, v5
  v_cmp_le_i32 s[46:47], 27, v5
  v_cndmask_b32 v92, v12, v7, s[40:41]
  v_cndmask_b32 v93, v12, v7, s[42:43]
  v_cndmask_b32 v94, v12, v7, s[44:45]
  v_cndmask_b32 v95, v12, v7, s[46:47]
  s_lshl_b32 s22, s51, 3
  s_add_u32 s22, s22, 8
  s_lshl_b32 s26, s16, 1
  s_sub_u32 s23, 6, s26
  s_waitcnt vmcnt(20)
  s_barrier
  s_cmp_eq_u32 s23, 0
  s_cbranch_scc1 A_go_41
A_idle_40:
  s_waitcnt vmcnt(16)
  s_barrier
  s_sub_u32 s18, s18, 8192
  s_max_i32 s18, s18, s20
  s_sub_u32 s17, s17, 8192
  s_max_i32 s17, s17, s19
  s_add_u32 s21, s21, 16384
  s_and_b32 s21, s21, 131071
  s_mov_b32 m0, s21
  s_nop 0
  buffer_load_dwordx4 v3, s[4:7], s18 offen offset:0 lds
  buffer_load_dwordx4 v3, s[4:7], s18 offen offset:1024 lds
  s_add_u32 m0, s21, 8192
  s_nop 0
  buffer_load_dwordx4 v3, s[4:7], s17 offen offset:0 lds
  buffer_load_dwordx4 v3, s[4:7], s17 offen offset:1024 lds
  v_add_u32 v4, 16384, v4
  v_and_b32 v4, 131071, v4
  s_sub_u32 s22, s22, 1
  s_sub_u32 s23, s23, 1
  s_cmp_lg_u32 s23, 0
  s_cbranch_scc1 A_idle_40
A_go_41:
  ds_read_b128 a[224:227], v4 offset:0
  ds_read_b128 a[228:231], v4 offset:2048
  ds_read_b128 a[232:235], v4 offset:4096
  ds_read_b128 a[236:239], v4 offset:6144
  ds_read_b128 a[240:243], v4 offset:1024
  ds_read_b128 a[244:247], v4 offset:3072
  ds_read_b128 a[248:251], v4 offset:5120
  ds_read_b128 a[252:255], v4 offset:7168
  ds_read_b128 a[192:195], v4 offset:8192
  ds_read_b128 a[196:199], v4 offset:9216
  ds_read_b128 a[200:203], v4 offset:10240
  ds_read_b128 a[204:207], v4 offset:11264
  ds_read_b128 a[208:211], v4 offset:12288
  ds_read_b128 a[212:215], v4 offset:13312
  ds_read_b128 a[216:219], v4 offset:14336
  ds_read_b128 a[220:223], v4 offset:15360
  v_add_u32 v4, 16384, v4
  v_and_b32 v4, 131071, v4
  s_waitcnt lgkmcnt(8)
.p2align 6
A_top_42:
  s_waitcnt lgkmcnt(7)
  v_mfma_f32_32x32x16_bf16 v[32:47], a[192:195], a[128:131], v[64:79]
  s_waitcnt lgkmcnt(6)
  v_exp_f32 v54, v54
  v_add_f32 v11, v11, v53
  v_cvt_pk_bf16_f32 v106, v52, v53
  v_mfma_f32_32x32x16_bf16 v[32:47], a[196:199], a[132:135], v[32:47]
  s_waitcnt lgkmcnt(4)
  v_exp_f32 v55, v55
  v_add_f32 v10, v10, v54
  v_mfma_f32_32x32x16_bf16 v[32:47], a[200:203], a[136:139], v[32:47]
  v_exp_f32 v56, v56
  v_add_f32 v11, v11, v55
  v_cvt_pk_bf16_f32 v107, v54, v55
  v_mfma_f32_32x32x16_bf16 v[32:47], a[204:207], a[140:143], v[32:47]
  s_waitcnt lgkmcnt(2)
  v_exp_f32 v57, v57
  v_add_f32 v10, v10, v56
  v_mfma_f32_32x32x16_bf16 v[32:47], a[208:211], a[144:147], v[32:47]
  v_exp_f32 v58, v58
  v_add_f32 v11, v11, v57
  v_cvt_pk_bf16_f32 v108, v56, v57
  v_mfma_f32_32x32x16_bf16 v[32:47], a[212:215], a[148:151], v[32:47]
  s_waitcnt lgkmcnt(0)
  v_exp_f32 v59, v59
  v_add_f32 v10, v10, v58
  v_mfma_f32_32x32x16_bf16 v[32:47], a[216:219], a[152:155], v[32:47]
  v_exp_f32 v60, v60
  v_add_f32 v11, v11, v59
  v_cvt_pk_bf16_f32 v109, v58, v59
  v_mfma_f32_32x32x16_bf16 v[32:47], a[220:223], a[156:159], v[32:47]
  s_waitcnt vmcnt(16)
  s_barrier
  v_exp_f32 v61, v61
  v_add_f32 v10, v10, v60
  v_mfma_f32_32x32x16_bf16 a[64:79], a[224:227], v[104:107], a[64:79]
  ds_read_b128 a[224:227], v4 offset:0
  v_exp_f32 v62, v62
  v_add_f32 v11, v11, v61
  v_cvt_pk_bf16_f32 v110, v60, v61
  v_mfma_f32_32x32x16_bf16 a[80:95], a[228:231], v[104:107], a[80:95]
  s_sub_u32 s18, s18, 8192
  ds_read_b128 a[228:231], v4 offset:2048
  v_exp_f32 v63, v63
  v_add_f32 v10, v10, v62
  v_mfma_f32_32x32x16_bf16 a[96:111], a[232:235], v[104:107], a[96:111]
  s_max_i32 s18, s18, s20
  ds_read_b128 a[232:235], v4 offset:4096
  v_exp_f32 v32, v32
  v_add_f32 v11, v11, v63
  v_cvt_pk_bf16_f32 v111, v62, v63
  v_mfma_f32_32x32x16_bf16 a[112:127], a[236:239], v[104:107], a[112:127]
  s_sub_u32 s17, s17, 8192
  ds_read_b128 a[236:239], v4 offset:6144
  v_exp_f32 v33, v33
  v_add_f32 v8, v8, v32
  v_mfma_f32_32x32x16_bf16 a[64:79], a[240:243], v[108:111], a[64:79]
  s_max_i32 s17, s17, s19
  ds_read_b128 a[240:243], v4 offset:1024
  v_exp_f32 v34, v34
  v_add_f32 v9, v9, v33
  v_cvt_pk_bf16_f32 v96, v32, v33
  v_mfma_f32_32x32x16_bf16 a[80:95], a[244:247], v[108:111], a[80:95]
  s_add_u32 s21, s21, 16384
  ds_read_b128 a[244:247], v4 offset:3072
  v_exp_f32 v35, v35
  v_add_f32 v8, v8, v34
  v_mfma_f32_32x32x16_bf16 a[96:111], a[248:251], v[108:111], a[96:111]
  s_and_b32 s21, s21, 131071
  ds_read_b128 a[248:251], v4 offset:5120
  v_exp_f32 v36, v36
  v_add_f32 v9, v9, v35
  v_cvt_pk_bf16_f32 v97, v34, v35
  v_mfma_f32_32x32x16_bf16 a[112:127], a[252:255], v[108:111], a[112:127]
  ds_read_b128 a[252:255], v4 offset:7168
  v_exp_f32 v37, v37
  v_add_f32 v8, v8, v36
  v_mfma_f32_32x32x16_bf16 v[48:63], a[192:195], a[160:163], v[80:95]
  s_add_u32 s23, s23, 1
  ds_read_b128 a[192:195], v4 offset:8192
  v_exp_f32 v38, v38
  v_add_f32 v9, v9, v37
  v_cvt_pk_bf16_f32 v98, v36, v37
  v_mfma_f32_32x32x16_bf16 v[48:63], a[196:199], a[164:167], v[48:63]
  s_sub_u32 s22, s22, 1
  ds_read_b128 a[196:199], v4 offset:9216
  v_exp_f32 v39, v39
  v_add_f32 v8, v8, v38
  v_mfma_f32_32x32x16_bf16 v[48:63], a[200:203], a[168:171], v[48:63]
  s_cmp_lt_u32 s23, 3
  ds_read_b128 a[200:203], v4 offset:10240
  v_exp_f32 v40, v40
  v_add_f32 v9, v9, v39
  v_cvt_pk_bf16_f32 v99, v38, v39
  v_mfma_f32_32x32x16_bf16 v[48:63], a[204:207], a[172:175], v[48:63]
  s_cbranch_scc1 A_upd_43
A_back_44:
  ds_read_b128 a[204:207], v4 offset:11264
  v_exp_f32 v41, v41
  v_add_f32 v8, v8, v40
  v_mfma_f32_32x32x16_bf16 v[48:63], a[208:211], a[176:179], v[48:63]
  ds_read_b128 a[208:211], v4 offset:12288
  v_exp_f32 v42, v42
  v_add_f32 v9, v9, v41
  v_cvt_pk_bf16_f32 v100, v40, v41
  v_mfma_f32_32x32x16_bf16 v[48:63], a[212:215], a[180:183], v[48:63]
  ds_read_b128 a[212:215], v4 offset:13312
  v_exp_f32 v43, v43
  v_add_f32 v8, v8, v42
  v_mfma_f32_32x32x16_bf16 v[48:63], a[216:219], a[184:187], v[48:63]
  s_mov_b32 m0, s21
  ds_read_b128 a[216:219], v4 offset:14336
  v_exp_f32 v44, v44
  v_add_f32 v9, v9, v43
  v_cvt_pk_bf16_f32 v101, v42, v43
  v_mfma_f32_32x32x16_bf16 v[48:63], a[220:223], a[188:191], v[48:63]
  s_waitcnt lgkmcnt(13)
  ds_read_b128 a[220:223], v4 offset:15360
  v_exp_f32 v45, v45
  v_add_f32 v8, v8, v44
  v_mfma_f32_32x32x16_bf16 a[0:15], a[224:227], v[96:99], a[0:15]
  buffer_load_dwordx4 v3, s[4:7], s18 offen offset:0 lds
  v_exp_f32 v46, v46
  v_add_f32 v9, v9, v45
  v_cvt_pk_bf16_f32 v102, v44, v45
  v_mfma_f32_32x32x16_bf16 a[16:31], a[228:231], v[96:99], a[16:31]
  s_waitcnt lgkmcnt(12)
  v_exp_f32 v47, v47
  v_add_f32 v8, v8, v46
  v_add_u32 v4, 16384, v4
  v_mfma_f32_32x32x16_bf16 a[32:47], a[232:235], v[96:99], a[32:47]
  buffer_load_dwordx4 v3, s[4:7], s18 offen offset:1024 lds
  v_exp_f32 v48, v48
  v_add_f32 v9, v9, v47
  v_cvt_pk_bf16_f32 v103, v46, v47
  v_mfma_f32_32x32x16_bf16 a[48:63], a[236:239], v[96:99], a[48:63]
  s_waitcnt lgkmcnt(10)
  s_add_u32 m0, s21, 8192
  v_exp_f32 v49, v49
  v_add_f32 v10, v10, v48
  v_and_b32 v4, 131071, v4
  v_mfma_f32_32x32x16_bf16 a[0:15], a[240:243], v[100:103], a[0:15]
  buffer_load_dwordx4 v3, s[4:7], s17 offen offset:0 lds
  v_exp_f32 v50, v50
  v_add_f32 v11, v11, v49
  v_cvt_pk_bf16_f32 v104, v48, v49
  v_mfma_f32_32x32x16_bf16 a[16:31], a[244:247], v[100:103], a[16:31]
  s_waitcnt lgkmcnt(8)
  s_cmp_lg_u32 s22, 0
  v_exp_f32 v51, v51
  v_add_f32 v10, v10, v50
  v_mfma_f32_32x32x16_bf16 a[32:47], a[248:251], v[100:103], a[32:47]
  buffer_load_dwordx4 v3, s[4:7], s17 offen offset:1024 lds
  v_exp_f32 v52, v52
  v_add_f32 v11, v11, v51
  v_cvt_pk_bf16_f32 v105, v50, v51
  v_mfma_f32_32x32x16_bf16 a[48:63], a[252:255], v[100:103], a[48:63]
  v_exp_f32 v53, v53
  v_add_f32 v10, v10, v52
  s_cbranch_scc1 A_top_42
  v_exp_f32 v54, v54
  v_add_f32 v11, v11, v53
  v_cvt_pk_bf16_f32 v106, v52, v53
  v_exp_f32 v55, v55
  v_add_f32 v10, v10, v54
  v_exp_f32 v56, v56
  v_add_f32 v11, v11, v55
  v_cvt_pk_bf16_f32 v107, v54, v55
  v_exp_f32 v57, v57
  v_add_f32 v10, v10, v56
  v_exp_f32 v58, v58
  v_add_f32 v11, v11, v57
  v_cvt_pk_bf16_f32 v108, v56, v57
  v_exp_f32 v59, v59
  v_add_f32 v10, v10, v58
  v_exp_f32 v60, v60
  v_add_f32 v11, v11, v59
  v_cvt_pk_bf16_f32 v109, v58, v59
  v_exp_f32 v61, v61
  v_add_f32 v10, v10, v60
  v_exp_f32 v62, v62
  v_add_f32 v11, v11, v61
  v_cvt_pk_bf16_f32 v110, v60, v61
  v_exp_f32 v63, v63
  v_add_f32 v10, v10, v62
  v_add_f32 v11, v11, v63
  v_cvt_pk_bf16_f32 v111, v62, v63
  s_nop 1
  v_mfma_f32_32x32x16_bf16 a[64:79], a[224:227], v[104:107], a[64:79]
  v_mfma_f32_32x32x16_bf16 a[80:95], a[228:231], v[104:107], a[80:95]
  v_mfma_f32_32x32x16_bf16 a[96:111], a[232:235], v[104:107], a[96:111]
  v_mfma_f32_32x32x16_bf16 a[112:127], a[236:239], v[104:107], a[112:127]
  v_mfma_f32_32x32x16_bf16 a[64:79], a[240:243], v[108:111], a[64:79]
  v_mfma_f32_32x32x16_bf16 a[80:95], a[244:247], v[108:111], a[80:95]
  v_mfma_f32_32x32x16_bf16 a[96:111], a[248:251], v[108:111], a[96:111]
  v_mfma_f32_32x32x16_bf16 a[112:127], a[252:255], v[108:111], a[112:127]
  v_add_f32 v8, v8, v9
  v_mov_b32 v9, v8
  s_nop 1
  v_permlane32_swap_b32 v8, v9
  s_nop 1
  v_add_f32 v8, v8, v9
  v_add_f32 v10, v10, v11
  v_mov_b32 v11, v10
  s_nop 1
  v_permlane32_swap_b32 v10, v11
  s_nop 1
  v_add_f32 v10, v10, v11
  v_subrev_u32 v12, 0x2f800000, v8
  v_subrev_u32 v13, 0x2f800000, v10
  v_max_u32 v12, v12, v13
  v_cmp_le_u32 vcc, 0x28000000, v12
  s_nop 1
  s_cmp_lg_u64 vcc, 0
  s_cselect_b32 s26, 1, 0
  v_mov_b32 v12, s26
  s_lshl_b32 s26, s16, 2
  s_add_u32 s26, s26, 131072
  v_mov_b32 v13, s26
  ds_write_b32 v13, v12
  v_mov_b32 v14, 131072
  s_waitcnt vmcnt(0) lgkmcnt(0)
  s_barrier
  ds_read_b128 v[16:19], v14
  v_rcp_f32 v8, v8
  v_rcp_f32 v10, v10
  s_waitcnt lgkmcnt(0)
  v_or3_b32 v12, v16, v17, v18
  v_or_b32 v12, v12, v19
  s_nop 0
  v_readfirstlane_b32 s26, v12
  s_nop 1
  s_cmp_gt_u32 s26, s29
  s_cbranch_scc1 A_slow_46
  s_add_u32 s28, s25, 100663296
  v_accvgpr_read_b32 v112, a0
  v_accvgpr_read_b32 v113, a1
  v_accvgpr_read_b32 v114, a2
  v_accvgpr_read_b32 v115, a3
  v_accvgpr_read_b32 v116, a4
  v_accvgpr_read_b32 v117, a5
  v_accvgpr_read_b32 v118, a6
  v_accvgpr_read_b32 v119, a7
  v_pk_mul_f32 v[112:113], v[112:113], v[8:9] op_sel_hi:[1,0]
  v_pk_mul_f32 v[114:115], v[114:115], v[8:9] op_sel_hi:[1,0]
  v_pk_mul_f32 v[116:117], v[116:117], v[8:9] op_sel_hi:[1,0]
  v_pk_mul_f32 v[118:119], v[118:119], v[8:9] op_sel_hi:[1,0]
  v_cvt_pk_bf16_f32 v120, v112, v113
  v_cvt_pk_bf16_f32 v121, v114, v115
  v_cvt_pk_bf16_f32 v122, v116, v117
  v_cvt_pk_bf16_f32 v123, v118, v119
  buffer_store_dwordx4 v[120:123], v2, s[4:7], s28 offen offset:0
  v_accvgpr_read_b32 v124, a8
  v_accvgpr_read_b32 v125, a9
  v_accvgpr_read_b32 v126, a10
  v_accvgpr_read_b32 v127, a11
  v_accvgpr_read_b32 v128, a12
  v_accvgpr_read_b32 v129, a13
  v_accvgpr_read_b32 v130, a14
  v_accvgpr_read_b32 v131, a15
  v_pk_mul_f32 v[124:125], v[124:125], v[8:9] op_sel_hi:[1,0]
  v_pk_mul_f32 v[126:127], v[126:127], v[8:9] op_sel_hi:[1,0]
  v_pk_mul_f32 v[128:129], v[128:129], v[8:9] op_sel_hi:[1,0]
  v_pk_mul_f32 v[130:131], v[130:131], v[8:9] op_sel_hi:[1,0]
  v_cvt_pk_bf16_f32 v132, v124, v125
  v_cvt_pk_bf16_f32 v133, v126, v127
  v_cvt_pk_bf16_f32 v134, v128, v129
  v_cvt_pk_bf16_f32 v135, v130, v131
  buffer_store_dwordx4 v[132:135], v2, s[4:7], s28 offen offset:1024
  v_accvgpr_read_b32 v136, a16
  v_accvgpr_read_b32 v137, a17
  v_accvgpr_read_b32 v138, a18
  v_accvgpr_read_b32 v139, a19
  v_accvgpr_read_b32 v140, a20
  v_accvgpr_read_b32 v141, a21
  v_accvgpr_read_b32 v142, a22
  v_accvgpr_read_b32 v143, a23
  v_pk_mul_f32 v[136:137], v[136:137], v[8:9] op_sel_hi:[1,0]
  v_pk_mul_f32 v[138:139], v[138:139], v[8:9] op_sel_hi:[1,0]
  v_pk_mul_f32 v[140:141], v[140:141], v[8:9] op_sel_hi:[1,0]
  v_pk_mul_f32 v[142:143], v[142:143], v[8:9] op_sel_hi:[1,0]
  v_cvt_pk_bf16_f32 v144, v136, v137
  v_cvt_pk_bf16_f32 v145, v138, v139
  v_cvt_pk_bf16_f32 v146, v140, v141
  v_cvt_pk_bf16_f32 v147, v142, v143
  buffer_store_dwordx4 v[144:147], v2, s[4:7], s28 offen offset:2048
  v_accvgpr_read_b32 v148, a24
  v_accvgpr_read_b32 v149, a25
  v_accvgpr_read_b32 v150, a26
  v_accvgpr_read_b32 v151, a27
  v_accvgpr_read_b32 v152, a28
  v_accvgpr_read_b32 v153, a29
  v_accvgpr_read_b32 v154, a30
  v_accvgpr_read_b32 v155, a31
  v_pk_mul_f32 v[148:149], v[148:149], v[8:9] op_sel_hi:[1,0]
  v_pk_mul_f32 v[150:151], v[150:151], v[8:9] op_sel_hi:[1,0]
  v_pk_mul_f32 v[152:153], v[152:153], v[8:9] op_sel_hi:[1,0]
  v_pk_mul_f32 v[154:155], v[154:155], v[8:9] op_sel_hi:[1,0]
  v_cvt_pk_bf16_f32 v156, v148, v149
  v_cvt_pk_bf16_f32 v157, v150, v151
  v_cvt_pk_bf16_f32 v158, v152, v153
  v_cvt_pk_bf16_f32 v159, v154, v155
  buffer_store_dwordx4 v[156:159], v2, s[4:7], s28 offen offset:3072
  s_add_u32 s28, s25, 100667392
  v_accvgpr_read_b32 v112, a32
  v_accvgpr_read_b32 v113, a33
  v_accvgpr_read_b32 v114, a34
  v_accvgpr_read_b32 v115, a35
  v_accvgpr_read_b32 v116, a36
  v_accvgpr_read_b32 v117, a37
  v_accvgpr_read_b32 v118, a38
  v_accvgpr_read_b32 v119, a39
  v_pk_mul_f32 v[112:113], v[112:113], v[8:9] op_sel_hi:[1,0]
  v_pk_mul_f32 v[114:115], v[114:115], v[8:9] op_sel_hi:[1,0]
  v_pk_mul_f32 v[116:117], v[116:117], v[8:9] op_sel_hi:[1,0]
  v_pk_mul_f32 v[118:119], v[118:119], v[8:9] op_sel_hi:[1,0]
  v_cvt_pk_bf16_f32 v120, v112, v113
  v_cvt_pk_bf16_f32 v121, v114, v115
  v_cvt_pk_bf16_f32 v122, v116, v117
  v_cvt_pk_bf16_f32 v123, v118, v119
  buffer_store_dwordx4 v[120:123], v2, s[4:7], s28 offen offset:0
  v_accvgpr_read_b32 v124, a40
  v_accvgpr_read_b32 v125, a41
  v_accvgpr_read_b32 v126, a42
  v_accvgpr_read_b32 v127, a43
  v_accvgpr_read_b32 v128, a44
  v_accvgpr_read_b32 v129, a45
  v_accvgpr_read_b32 v130, a46
  v_accvgpr_read_b32 v131, a47
  v_pk_mul_f32 v[124:125], v[124:125], v[8:9] op_sel_hi:[1,0]
  v_pk_mul_f32 v[126:127], v[126:127], v[8:9] op_sel_hi:[1,0]
  v_pk_mul_f32 v[128:129], v[128:129], v[8:9] op_sel_hi:[1,0]
  v_pk_mul_f32 v[130:131], v[130:131], v[8:9] op_sel_hi:[1,0]
  v_cvt_pk_bf16_f32 v132, v124, v125
  v_cvt_pk_bf16_f32 v133, v126, v127
  v_cvt_pk_bf16_f32 v134, v128, v129
  v_cvt_pk_bf16_f32 v135, v130, v131
  buffer_store_dwordx4 v[132:135], v2, s[4:7], s28 offen offset:1024
  v_accvgpr_read_b32 v136, a48
  v_accvgpr_read_b32 v137, a49
  v_accvgpr_read_b32 v138, a50
  v_accvgpr_read_b32 v139, a51
  v_accvgpr_read_b32 v140, a52
  v_accvgpr_read_b32 v141, a53
  v_accvgpr_read_b32 v142, a54
  v_accvgpr_read_b32 v143, a55
  v_pk_mul_f32 v[136:137], v[136:137], v[8:9] op_sel_hi:[1,0]
  v_pk_mul_f32 v[138:139], v[138:139], v[8:9] op_sel_hi:[1,0]
  v_pk_mul_f32 v[140:141], v[140:141], v[8:9] op_sel_hi:[1,0]
  v_pk_mul_f32 v[142:143], v[142:143], v[8:9] op_sel_hi:[1,0]
  v_cvt_pk_bf16_f32 v144, v136, v137
  v_cvt_pk_bf16_f32 v145, v138, v139
  v_cvt_pk_bf16_f32 v146, v140, v141
  v_cvt_pk_bf16_f32 v147, v142, v143
  buffer_store_dwordx4 v[144:147], v2, s[4:7], s28 offen offset:2048
  v_accvgpr_read_b32 v148, a56
  v_accvgpr_read_b32 v149, a57
  v_accvgpr_read_b32 v150, a58
  v_accvgpr_read_b32 v151, a59
  v_accvgpr_read_b32 v152, a60
  v_accvgpr_read_b32 v153, a61
  v_accvgpr_read_b32 v154, a62
  v_accvgpr_read_b32 v155, a63
  v_pk_mul_f32 v[148:149], v[148:149], v[8:9] op_sel_hi:[1,0]
  v_pk_mul_f32 v[150:151], v[150:151], v[8:9] op_sel_hi:[1,0]
  v_pk_mul_f32 v[152:153], v[152:153], v[8:9] op_sel_hi:[1,0]
  v_pk_mul_f32 v[154:155], v[154:155], v[8:9] op_sel_hi:[1,0]
  v_cvt_pk_bf16_f32 v156, v148, v149
  v_cvt_pk_bf16_f32 v157, v150, v151
  v_cvt_pk_bf16_f32 v158, v152, v153
  v_cvt_pk_bf16_f32 v159, v154, v155
  buffer_store_dwordx4 v[156:159], v2, s[4:7], s28 offen offset:3072
  s_add_u32 s28, s25, 100671488
  v_accvgpr_read_b32 v112, a64
  v_accvgpr_read_b32 v113, a65
  v_accvgpr_read_b32 v114, a66
  v_accvgpr_read_b32 v115, a67
  v_accvgpr_read_b32 v116, a68
  v_accvgpr_read_b32 v117, a69
  v_accvgpr_read_b32 v118, a70
  v_accvgpr_read_b32 v119, a71
  v_pk_mul_f32 v[112:113], v[112:113], v[10:11] op_sel_hi:[1,0]
  v_pk_mul_f32 v[114:115], v[114:115], v[10:11] op_sel_hi:[1,0]
  v_pk_mul_f32 v[116:117], v[116:117], v[10:11] op_sel_hi:[1,0]
  v_pk_mul_f32 v[118:119], v[118:119], v[10:11] op_sel_hi:[1,0]
  v_cvt_pk_bf16_f32 v120, v112, v113
  v_cvt_pk_bf16_f32 v121, v114, v115
  v_cvt_pk_bf16_f32 v122, v116, v117
  v_cvt_pk_bf16_f32 v123, v118, v119
  buffer_store_dwordx4 v[120:123], v2, s[4:7], s28 offen offset:0
  v_accvgpr_read_b32 v124, a72
  v_accvgpr_read_b32 v125, a73
  v_accvgpr_read_b32 v126, a74
  v_accvgpr_read_b32 v127, a75
  v_accvgpr_read_b32 v128, a76
  v_accvgpr_read_b32 v129, a77
  v_accvgpr_read_b32 v130, a78
  v_accvgpr_read_b32 v131, a79
  v_pk_mul_f32 v[124:125], v[124:125], v[10:11] op_sel_hi:[1,0]
  v_pk_mul_f32 v[126:127], v[126:127], v[10:11] op_sel_hi:[1,0]
  v_pk_mul_f32 v[128:129], v[128:129], v[10:11] op_sel_hi:[1,0]
  v_pk_mul_f32 v[130:131], v[130:131], v[10:11] op_sel_hi:[1,0]
  v_cvt_pk_bf16_f32 v132, v124, v125
  v_cvt_pk_bf16_f32 v133, v126, v127
  v_cvt_pk_bf16_f32 v134, v128, v129
  v_cvt_pk_bf16_f32 v135, v130, v131
  buffer_store_dwordx4 v[132:135], v2, s[4:7], s28 offen offset:1024
  v_accvgpr_read_b32 v136, a80
  v_accvgpr_read_b32 v137, a81
  v_accvgpr_read_b32 v138, a82
  v_accvgpr_read_b32 v139, a83
  v_accvgpr_read_b32 v140, a84
  v_accvgpr_read_b32 v141, a85
  v_accvgpr_read_b32 v142, a86
  v_accvgpr_read_b32 v143, a87
  v_pk_mul_f32 v[136:137], v[136:137], v[10:11] op_sel_hi:[1,0]
  v_pk_mul_f32 v[138:139], v[138:139], v[10:11] op_sel_hi:[1,0]
  v_pk_mul_f32 v[140:141], v[140:141], v[10:11] op_sel_hi:[1,0]
  v_pk_mul_f32 v[142:143], v[142:143], v[10:11] op_sel_hi:[1,0]
  v_cvt_pk_bf16_f32 v144, v136, v137
  v_cvt_pk_bf16_f32 v145, v138, v139
  v_cvt_pk_bf16_f32 v146, v140, v141
  v_cvt_pk_bf16_f32 v147, v142, v143
  buffer_store_dwordx4 v[144:147], v2, s[4:7], s28 offen offset:2048
  v_accvgpr_read_b32 v148, a88
  v_accvgpr_read_b32 v149, a89
  v_accvgpr_read_b32 v150, a90
  v_accvgpr_read_b32 v151, a91
  v_accvgpr_read_b32 v152, a92
  v_accvgpr_read_b32 v153, a93
  v_accvgpr_read_b32 v154, a94
  v_accvgpr_read_b32 v155, a95
  v_pk_mul_f32 v[148:149], v[148:149], v[10:11] op_sel_hi:[1,0]
  v_pk_mul_f32 v[150:151], v[150:151], v[10:11] op_sel_hi:[1,0]
  v_pk_mul_f32 v[152:153], v[152:153], v[10:11] op_sel_hi:[1,0]
  v_pk_mul_f32 v[154:155], v[154:155], v[10:11] op_sel_hi:[1,0]
  v_cvt_pk_bf16_f32 v156, v148, v149
  v_cvt_pk_bf16_f32 v157, v150, v151
  v_cvt_pk_bf16_f32 v158, v152, v153
  v_cvt_pk_bf16_f32 v159, v154, v155
  buffer_store_dwordx4 v[156:159], v2, s[4:7], s28 offen offset:3072
  s_add_u32 s28, s25, 100675584
  v_accvgpr_read_b32 v112, a96
  v_accvgpr_read_b32 v113, a97
  v_accvgpr_read_b32 v114, a98
  v_accvgpr_read_b32 v115, a99
  v_accvgpr_read_b32 v116, a100
  v_accvgpr_read_b32 v117, a101
  v_accvgpr_read_b32 v118, a102
  v_accvgpr_read_b32 v119, a103
  v_pk_mul_f32 v[112:113], v[112:113], v[10:11] op_sel_hi:[1,0]
  v_pk_mul_f32 v[114:115], v[114:115], v[10:11] op_sel_hi:[1,0]
  v_pk_mul_f32 v[116:117], v[116:117], v[10:11] op_sel_hi:[1,0]
  v_pk_mul_f32 v[118:119], v[118:119], v[10:11] op_sel_hi:[1,0]
  v_cvt_pk_bf16_f32 v120, v112, v113
  v_cvt_pk_bf16_f32 v121, v114, v115
  v_cvt_pk_bf16_f32 v122, v116, v117
  v_cvt_pk_bf16_f32 v123, v118, v119
  buffer_store_dwordx4 v[120:123], v2, s[4:7], s28 offen offset:0
  v_accvgpr_read_b32 v124, a104
  v_accvgpr_read_b32 v125, a105
  v_accvgpr_read_b32 v126, a106
  v_accvgpr_read_b32 v127, a107
  v_accvgpr_read_b32 v128, a108
  v_accvgpr_read_b32 v129, a109
  v_accvgpr_read_b32 v130, a110
  v_accvgpr_read_b32 v131, a111
  v_pk_mul_f32 v[124:125], v[124:125], v[10:11] op_sel_hi:[1,0]
  v_pk_mul_f32 v[126:127], v[126:127], v[10:11] op_sel_hi:[1,0]
  v_pk_mul_f32 v[128:129], v[128:129], v[10:11] op_sel_hi:[1,0]
  v_pk_mul_f32 v[130:131], v[130:131], v[10:11] op_sel_hi:[1,0]
  v_cvt_pk_bf16_f32 v132, v124, v125
  v_cvt_pk_bf16_f32 v133, v126, v127
  v_cvt_pk_bf16_f32 v134, v128, v129
  v_cvt_pk_bf16_f32 v135, v130, v131
  buffer_store_dwordx4 v[132:135], v2, s[4:7], s28 offen offset:1024
  v_accvgpr_read_b32 v136, a112
  v_accvgpr_read_b32 v137, a113
  v_accvgpr_read_b32 v138, a114
  v_accvgpr_read_b32 v139, a115
  v_accvgpr_read_b32 v140, a116
  v_accvgpr_read_b32 v141, a117
  v_accvgpr_read_b32 v142, a118
  v_accvgpr_read_b32 v143, a119
  v_pk_mul_f32 v[136:137], v[136:137], v[10:11] op_sel_hi:[1,0]
  v_pk_mul_f32 v[138:139], v[138:139], v[10:11] op_sel_hi:[1,0]
  v_pk_mul_f32 v[140:141], v[140:141], v[10:11] op_sel_hi:[1,0]
  v_pk_mul_f32 v[142:143], v[142:143], v[10:11] op_sel_hi:[1,0]
  v_cvt_pk_bf16_f32 v144, v136, v137
  v_cvt_pk_bf16_f32 v145, v138, v139
  v_cvt_pk_bf16_f32 v146, v140, v141
  v_cvt_pk_bf16_f32 v147, v142, v143
  buffer_store_dwordx4 v[144:147], v2, s[4:7], s28 offen offset:2048
  v_accvgpr_read_b32 v148, a120
  v_accvgpr_read_b32 v149, a121
  v_accvgpr_read_b32 v150, a122
  v_accvgpr_read_b32 v151, a123
  v_accvgpr_read_b32 v152, a124
  v_accvgpr_read_b32 v153, a125
  v_accvgpr_read_b32 v154, a126
  v_accvgpr_read_b32 v155, a127
  v_pk_mul_f32 v[148:149], v[148:149], v[10:11] op_sel_hi:[1,0]
  v_pk_mul_f32 v[150:151], v[150:151], v[10:11] op_sel_hi:[1,0]
  v_pk_mul_f32 v[152:153], v[152:153], v[10:11] op_sel_hi:[1,0]
  v_pk_mul_f32 v[154:155], v[154:155], v[10:11] op_sel_hi:[1,0]
  v_cvt_pk_bf16_f32 v156, v148, v149
  v_cvt_pk_bf16_f32 v157, v150, v151
  v_cvt_pk_bf16_f32 v158, v152, v153
  v_cvt_pk_bf16_f32 v159, v154, v155
  buffer_store_dwordx4 v[156:159], v2, s[4:7], s28 offen offset:3072
  s_branch A_out_45
A_upd_43:
  s_cmp_eq_u32 s23, 2
  s_cbranch_scc1 A_upd2_47
  v_mov_b32 v12, s24
  v_cmp_le_i32 s[40:41], 0, v5
  v_cmp_le_i32 s[42:43], 1, v5
  v_cmp_le_i32 s[44:45], 2, v5
  v_cmp_le_i32 s[46:47], 3, v5
  v_cndmask_b32 v64, v12, v6, s[40:41]
  v_cndmask_b32 v65, v12, v6, s[42:43]
  v_cndmask_b32 v66, v12, v6, s[44:45]
  v_cndmask_b32 v67, v12, v6, s[46:47]
  v_cmp_le_i32 s[40:41], 8, v5
  v_cmp_le_i32 s[42:43], 9, v5
  v_cmp_le_i32 s[44:45], 10, v5
  v_cmp_le_i32 s[46:47], 11, v5
  v_cndmask_b32 v68, v12, v6, s[40:41]
  v_cndmask_b32 v69, v12, v6, s[42:43]
  v_cndmask_b32 v70, v12, v6, s[44:45]
  v_cndmask_b32 v71, v12, v6, s[46:47]
  v_cmp_le_i32 s[40:41], 16, v5
  v_cmp_le_i32 s[42:43], 17, v5
  v_cmp_le_i32 s[44:45], 18, v5
  v_cmp_le_i32 s[46:47], 19, v5
  v_cndmask_b32 v72, v12, v6, s[40:41]
  v_cndmask_b32 v73, v12, v6, s[42:43]
  v_cndmask_b32 v74, v12, v6, s[44:45]
  v_cndmask_b32 v75, v12, v6, s[46:47]
  v_cmp_le_i32 s[40:41], 24, v5
  v_cmp_le_i32 s[42:43], 25, v5
  v_cmp_le_i32 s[44:45], 26, v5
  v_cmp_le_i32 s[46:47], 27, v5
  v_cndmask_b32 v76, v12, v6, s[40:41]
  v_cndmask_b32 v77, v12, v6, s[42:43]
  v_cndmask_b32 v78, v12, v6, s[44:45]
  v_cndmask_b32 v79, v12, v6, s[46:47]
  v_mov_b32 v80, v7
  v_mov_b32 v81, v7
  v_mov_b32 v82, v7
  v_mov_b32 v83, v7
  v_mov_b32 v84, v7
  v_mov_b32 v85, v7
  v_mov_b32 v86, v7
  v_mov_b32 v87, v7
  v_mov_b32 v88, v7
  v_mov_b32 v89, v7
  v_mov_b32 v90, v7
  v_mov_b32 v91, v7
  v_mov_b32 v92, v7
  v_mov_b32 v93, v7
  v_mov_b32 v94, v7
  v_mov_b32 v95, v7
  s_branch A_back_44
A_upd2_47:
  v_mov_b32 v64, v6
  v_mov_b32 v65, v6
  v_mov_b32 v66, v6
  v_mov_b32 v67, v6
  v_mov_b32 v68, v6
  v_mov_b32 v69, v6
  v_mov_b32 v70, v6
  v_mov_b32 v71, v6
  v_mov_b32 v72, v6
  v_mov_b32 v73, v6
  v_mov_b32 v74, v6
  v_mov_b32 v75, v6
  v_mov_b32 v76, v6
  v_mov_b32 v77, v6
  v_mov_b32 v78, v6
  v_mov_b32 v79, v6
  s_branch A_back_44
A_slow_46:
  s_mov_b32 s29, 1
  v_mov_b32 v64, s24
  v_mov_b32 v65, s24
  v_mov_b32 v66, s24
  v_mov_b32 v67, s24
  v_mov_b32 v68, s24
  v_mov_b32 v69, s24
  v_mov_b32 v70, s24
  v_mov_b32 v71, s24
  v_mov_b32 v72, s24
  v_mov_b32 v73, s24
  v_mov_b32 v74, s24
  v_mov_b32 v75, s24
  v_mov_b32 v76, s24
  v_mov_b32 v77, s24
  v_mov_b32 v78, s24
  v_mov_b32 v79, s24
  v_mov_b32 v12, s24
  v_cmp_le_i32 s[40:41], 0, v5
  v_cmp_le_i32 s[42:43], 1, v5
  v_cmp_le_i32 s[44:45], 2, v5
  v_cmp_le_i32 s[46:47], 3, v5
  v_cndmask_b32 v80, v12, v7, s[40:41]
  v_cndmask_b32 v81, v12, v7, s[42:43]
  v_cndmask_b32 v82, v12, v7, s[44:45]
  v_cndmask_b32 v83, v12, v7, s[46:47]
  v_cmp_le_i32 s[40:41], 8, v5
  v_cmp_le_i32 s[42:43], 9, v5
  v_cmp_le_i32 s[44:45], 10, v5
  v_cmp_le_i32 s[46:47], 11, v5
  v_cndmask_b32 v84, v12, v7, s[40:41]
  v_cndmask_b32 v85, v12, v7, s[42:43]
  v_cndmask_b32 v86, v12, v7, s[44:45]
  v_cndmask_b32 v87, v12, v7, s[46:47]
  v_cmp_le_i32 s[40:41], 16, v5
  v_cmp_le_i32 s[42:43], 17, v5
  v_cmp_le_i32 s[44:45], 18, v5
  v_cmp_le_i32 s[46:47], 19, v5
  v_cndmask_b32 v88, v12, v7, s[40:41]
  v_cndmask_b32 v89, v12, v7, s[42:43]
  v_cndmask_b32 v90, v12, v7, s[44:45]
  v_cndmask_b32 v91, v12, v7, s[46:47]
  v_cmp_le_i32 s[40:41], 24, v5
  v_cmp_le_i32 s[42:43], 25, v5
  v_cmp_le_i32 s[44:45], 26, v5
  v_cmp_le_i32 s[46:47], 27, v5
  v_cndmask_b32 v92, v12, v7, s[40:41]
  v_cndmask_b32 v93, v12, v7, s[42:43]
  v_cndmask_b32 v94, v12, v7, s[44:45]
  v_cndmask_b32 v95, v12, v7, s[46:47]
  v_mov_b32 v8, s24
  v_mov_b32 v10, s24
  s_add_u32 s17, s25, 16785408
  s_mov_b32 s23, 0
A_ml_48:
  s_add_u32 s28, s17, 4096
  buffer_load_dwordx4 a[192:195], v2, s[4:7], s17 offen offset:0
  buffer_load_dwordx4 a[196:199], v2, s[4:7], s17 offen offset:1024
  buffer_load_dwordx4 a[200:203], v2, s[4:7], s17 offen offset:2048
  buffer_load_dwordx4 a[204:207], v2, s[4:7], s17 offen offset:3072
  buffer_load_dwordx4 a[208:211], v2, s[4:7], s28 offen offset:0
  buffer_load_dwordx4 a[212:215], v2, s[4:7], s28 offen offset:1024
  buffer_load_dwordx4 a[216:219], v2, s[4:7], s28 offen offset:2048
  buffer_load_dwordx4 a[220:223], v2, s[4:7], s28 offen offset:3072
  s_waitcnt vmcnt(0)
  v_mfma_f32_32x32x16_bf16 v[32:47], a[192:195], a[128:131], v[64:79]
  v_mfma_f32_32x32x16_bf16 v[32:47], a[196:199], a[132:135], v[32:47]
  v_mfma_f32_32x32x16_bf16 v[32:47], a[200:203], a[136:139], v[32:47]
  v_mfma_f32_32x32x16_bf16 v[32:47], a[204:207], a[140:143], v[32:47]
  v_mfma_f32_32x32x16_bf16 v[32:47], a[208:211], a[144:147], v[32:47]
  v_mfma_f32_32x32x16_bf16 v[32:47], a[212:215], a[148:151], v[32:47]
  v_mfma_f32_32x32x16_bf16 v[32:47], a[216:219], a[152:155], v[32:47]
  v_mfma_f32_32x32x16_bf16 v[32:47], a[220:223], a[156:159], v[32:47]
  v_mfma_f32_32x32x16_bf16 v[48:63], a[192:195], a[160:163], v[80:95]
  v_mfma_f32_32x32x16_bf16 v[48:63], a[196:199], a[164:167], v[48:63]
  v_mfma_f32_32x32x16_bf16 v[48:63], a[200:203], a[168:171], v[48:63]
  v_mfma_f32_32x32x16_bf16 v[48:63], a[204:207], a[172:175], v[48:63]
  v_mfma_f32_32x32x16_bf16 v[48:63], a[208:211], a[176:179], v[48:63]
  v_mfma_f32_32x32x16_bf16 v[48:63], a[212:215], a[180:183], v[48:63]
  v_mfma_f32_32x32x16_bf16 v[48:63], a[216:219], a[184:187], v[48:63]
  v_mfma_f32_32x32x16_bf16 v[48:63], a[220:223], a[188:191], v[48:63]
  s_nop 7
  s_nop 3
  v_max3_f32 v8, v8, v32, v33
  v_max3_f32 v8, v8, v34, v35
  v_max3_f32 v8, v8, v36, v37
  v_max3_f32 v8, v8, v38, v39
  v_max3_f32 v8, v8, v40, v41
  v_max3_f32 v8, v8, v42, v43
  v_max3_f32 v8, v8, v44, v45
  v_max3_f32 v8, v8, v46, v47
  v_max3_f32 v10, v10, v48, v49
  v_max3_f32 v10, v10, v50, v51
  v_max3_f32 v10, v10, v52, v53
  v_max3_f32 v10, v10, v54, v55
  v_max3_f32 v10, v10, v56, v57
  v_max3_f32 v10, v10, v58, v59
  v_max3_f32 v10, v10, v60, v61
  v_max3_f32 v10, v10, v62, v63
  s_add_u32 s23, s23, 1
  s_cmp_lg_u32 s23, 1
  s_cbranch_scc1 A_m2_49
  v_mov_b32 v12, s24
  v_cmp_le_i32 s[40:41], 0, v5
  v_cmp_le_i32 s[42:43], 1, v5
  v_cmp_le_i32 s[44:45], 2, v5
  v_cmp_le_i32 s[46:47], 3, v5
  v_cndmask_b32 v64, v12, v6, s[40:41]
  v_cndmask_b32 v65, v12, v6, s[42:43]
  v_cndmask_b32 v66, v12, v6, s[44:45]
  v_cndmask_b32 v67, v12, v6, s[46:47]
  v_cmp_le_i32 s[40:41], 8, v5
  v_cmp_le_i32 s[42:43], 9, v5
  v_cmp_le_i32 s[44:45], 10, v5
  v_cmp_le_i32 s[46:47], 11, v5
  v_cndmask_b32 v68, v12, v6, s[40:41]
  v_cndmask_b32 v69, v12, v6, s[42:43]
  v_cndmask_b32 v70, v12, v6, s[44:45]
  v_cndmask_b32 v71, v12, v6, s[46:47]
  v_cmp_le_i32 s[40:41], 16, v5
  v_cmp_le_i32 s[42:43], 17, v5
  v_cmp_le_i32 s[44:45], 18, v5
  v_cmp_le_i32 s[46:47], 19, v5
  v_cndmask_b32 v72, v12, v6, s[40:41]
  v_cndmask_b32 v73, v12, v6, s[42:43]
  v_cndmask_b32 v74, v12, v6, s[44:45]
  v_cndmask_b32 v75, v12, v6, s[46:47]
  v_cmp_le_i32 s[40:41], 24, v5
  v_cmp_le_i32 s[42:43], 25, v5
  v_cmp_le_i32 s[44:45], 26, v5
  v_cmp_le_i32 s[46:47], 27, v5
  v_cndmask_b32 v76, v12, v6, s[40:41]
  v_cndmask_b32 v77, v12, v6, s[42:43]
  v_cndmask_b32 v78, v12, v6, s[44:45]
  v_cndmask_b32 v79, v12, v6, s[46:47]
  v_mov_b32 v80, v7
  v_mov_b32 v81, v7
  v_mov_b32 v82, v7
  v_mov_b32 v83, v7
  v_mov_b32 v84, v7
  v_mov_b32 v85, v7
  v_mov_b32 v86, v7
  v_mov_b32 v87, v7
  v_mov_b32 v88, v7
  v_mov_b32 v89, v7
  v_mov_b32 v90, v7
  v_mov_b32 v91, v7
  v_mov_b32 v92, v7
  v_mov_b32 v93, v7
  v_mov_b32 v94, v7
  v_mov_b32 v95, v7
A_m2_49:
  s_cmp_lg_u32 s23, 2
  s_cbranch_scc1 A_m3_50
  v_mov_b32 v64, v6
  v_mov_b32 v65, v6
  v_mov_b32 v66, v6
  v_mov_b32 v67, v6
  v_mov_b32 v68, v6
  v_mov_b32 v69, v6
  v_mov_b32 v70, v6
  v_mov_b32 v71, v6
  v_mov_b32 v72, v6
  v_mov_b32 v73, v6
  v_mov_b32 v74, v6
  v_mov_b32 v75, v6
  v_mov_b32 v76, v6
  v_mov_b32 v77, v6
  v_mov_b32 v78, v6
  v_mov_b32 v79, v6
A_m3_50:
  s_sub_u32 s17, s17, 8192
  s_cmp_ge_i32 s17, s19
  s_cbranch_scc1 A_ml_48
  v_mov_b32 v9, v8
  s_nop 1
  v_permlane32_swap_b32 v8, v9
  s_nop 1
  v_max_f32 v8, v8, v9
  v_sub_f32 v6, 0, v8
  v_mov_b32 v11, v10
  s_nop 1
  v_permlane32_swap_b32 v10, v11
  s_nop 1
  v_max_f32 v10, v10, v11
  v_sub_f32 v7, 0, v10
  s_branch A_again_39
A_out_45:
A_exit_38:
  s_endpgm
.text
.globl oproj_kernel
.p2align 8
.type oproj_kernel,@function
oproj_kernel:
  s_cmp_ge_u32 s2, 256
  s_cbranch_scc1 K_exit_51
  v_lshrrev_b32 v3, 6, v0
  v_and_b32 v1, 63, v0
  v_readfirstlane_b32 s16, v3
  v_lshlrev_b32 v2, 4, v1
  s_load_dwordx2 s[4:5], s[0:1], 128
  s_waitcnt lgkmcnt(0)
  s_and_b32 s5, s5, 0xffff
  s_mov_b32 s6, 268435456
  s_mov_b32 s7, 0x20000
  s_and_b32 s40, s2, 7
  s_bfe_u32 s41, s2, 0x10003
  s_lshr_b32 s42, s2, 4
  s_mov_b32 s43, 16
  s_mov_b32 s23, 4
  s_load_dwordx2 s[8:9], s[0:1], 40
  s_lshl_b32 s17, s40, 19
  s_lshl_b32 s26, s41, 2
  s_add_u32 s26, s26, s16
  s_lshl_b32 s27, s26, 7
  s_add_u32 s17, s17, s27
  s_mov_b32 s18, 1024
  s_lshl_b32 s21, s40, 6
  s_add_u32 s21, s21, s42
  s_lshl_b32 s21, s21, 3
  s_add_u32 s21, s21, s26
  s_lshl_b32 s21, s21, 12
  s_add_u32 s21, s21, 150994944
  s_lshl_b32 s22, s43, 15
  s_mov_b32 s24, 1.0
  s_waitcnt lgkmcnt(0)
  s_and_b32 s9, s9, 0xffff
  s_mov_b32 s10, 4194304
  s_mov_b32 s11, 0x20000
  s_mov_b32 s12, s4
  s_mov_b32 s13, s5
  s_mov_b32 s14, 268435456
  s_mov_b32 s15, 0x20000
  s_lshl_b32 s19, s40, 8
  s_add_u32 s19, s19, s42
  s_lshl_b32 s19, s19, 13
  s_add_u32 s19, s19, 100663296
  s_lshl_b32 s20, s43, 13
  s_mul_i32 s26, s16, 524288
  v_add_u32 v8, 0, v2
  v_add_u32 v16, s26, v8
  v_add_u32 v9, 1024, v2
  v_add_u32 v17, s26, v9
  v_add_u32 v10, 2048, v2
  v_add_u32 v18, s26, v10
  v_add_u32 v11, 3072, v2
  v_add_u32 v19, s26, v11
  v_add_u32 v12, 4096, v2
  v_add_u32 v20, s26, v12
  v_add_u32 v13, 5120, v2
  v_add_u32 v21, s26, v13
  v_add_u32 v14, 6144, v2
  v_add_u32 v22, s26, v14
  v_add_u32 v15, 7168, v2
  v_add_u32 v23, s26, v15
  v_lshrrev_b32 v144, 3, v1
  v_mul_lo_u32 v144, v144, s18
  v_and_b32 v145, 7, v1
  v_lshl_add_u32 v144, v145, 4, v144
  s_lshl_b32 s28, s16, 15
  s_add_u32 s28, s28, 32768
  s_lshl_b32 s29, s18, 3
  s_add_u32 m0, s28, 0
  s_nop 0
  buffer_load_dwordx4 v144, s[8:11], s17 offen lds
  s_add_u32 s17, s17, s29
  s_add_u32 m0, s28, 1024
  s_nop 0
  buffer_load_dwordx4 v144, s[8:11], s17 offen lds
  s_add_u32 s17, s17, s29
  s_add_u32 m0, s28, 2048
  s_nop 0
  buffer_load_dwordx4 v144, s[8:11], s17 offen lds
  s_add_u32 s17, s17, s29
  s_add_u32 m0, s28, 3072
  s_nop 0
  buffer_load_dwordx4 v144, s[8:11], s17 offen lds
  s_add_u32 s17, s17, s29
  s_add_u32 m0, s28, 4096
  s_nop 0
  buffer_load_dwordx4 v144, s[8:11], s17 offen lds
  s_add_u32 s17, s17, s29
  s_add_u32 m0, s28, 5120
  s_nop 0
  buffer_load_dwordx4 v144, s[8:11], s17 offen lds
  s_add_u32 s17, s17, s29
  s_add_u32 m0, s28, 6144
  s_nop 0
  buffer_load_dwordx4 v144, s[8:11], s17 offen lds
  s_add_u32 s17, s17, s29
  s_add_u32 m0, s28, 7168
  s_nop 0
  buffer_load_dwordx4 v144, s[8:11], s17 offen lds
  s_add_u32 s17, s17, s29
  s_add_u32 m0, s28, 8192
  s_nop 0
  buffer_load_dwordx4 v144, s[8:11], s17 offen lds
  s_add_u32 s17, s17, s29
  s_add_u32 m0, s28, 9216
  s_nop 0
  buffer_load_dwordx4 v144, s[8:11], s17 offen lds
  s_add_u32 s17, s17, s29
  s_add_u32 m0, s28, 10240
  s_nop 0
  buffer_load_dwordx4 v144, s[8:11], s17 offen lds
  s_add_u32 s17, s17, s29
  s_add_u32 m0, s28, 11264
  s_nop 0
  buffer_load_dwordx4 v144, s[8:11], s17 offen lds
  s_add_u32 s17, s17, s29
  s_add_u32 m0, s28, 12288
  s_nop 0
  buffer_load_dwordx4 v144, s[8:11], s17 offen lds
  s_add_u32 s17, s17, s29
  s_add_u32 m0, s28, 13312
  s_nop 0
  buffer_load_dwordx4 v144, s[8:11], s17 offen lds
  s_add_u32 s17, s17, s29
  s_add_u32 m0, s28, 14336
  s_nop 0
  buffer_load_dwordx4 v144, s[8:11], s17 offen lds
  s_add_u32 s17, s17, s29
  s_add_u32 m0, s28, 15360
  s_nop 0
  buffer_load_dwordx4 v144, s[8:11], s17 offen lds
  s_add_u32 s17, s17, s29
  s_add_u32 m0, s28, 16384
  s_nop 0
  buffer_load_dwordx4 v144, s[8:11], s17 offen lds
  s_add_u32 s17, s17, s29
  s_add_u32 m0, s28, 17408
  s_nop 0
  buffer_load_dwordx4 v144, s[8:11], s17 offen lds
  s_add_u32 s17, s17, s29
  s_add_u32 m0, s28, 18432
  s_nop 0
  buffer_load_dwordx4 v144, s[8:11], s17 offen lds
  s_add_u32 s17, s17, s29
  s_add_u32 m0, s28, 19456
  s_nop 0
  buffer_load_dwordx4 v144, s[8:11], s17 offen lds
  s_add_u32 s17, s17, s29
  s_add_u32 m0, s28, 20480
  s_nop 0
  buffer_load_dwordx4 v144, s[8:11], s17 offen lds
  s_add_u32 s17, s17, s29
  s_add_u32 m0, s28, 21504
  s_nop 0
  buffer_load_dwordx4 v144, s[8:11], s17 offen lds
  s_add_u32 s17, s17, s29
  s_add_u32 m0, s28, 22528
  s_nop 0
  buffer_load_dwordx4 v144, s[8:11], s17 offen lds
  s_add_u32 s17, s17, s29
  s_add_u32 m0, s28, 23552
  s_nop 0
  buffer_load_dwordx4 v144, s[8:11], s17 offen lds
  s_add_u32 s17, s17, s29
  s_add_u32 m0, s28, 24576
  s_nop 0
  buffer_load_dwordx4 v144, s[8:11], s17 offen lds
  s_add_u32 s17, s17, s29
  s_add_u32 m0, s28, 25600
  s_nop 0
  buffer_load_dwordx4 v144, s[8:11], s17 offen lds
  s_add_u32 s17, s17, s29
  s_add_u32 m0, s28, 26624
  s_nop 0
  buffer_load_dwordx4 v144, s[8:11], s17 offen lds
  s_add_u32 s17, s17, s29
  s_add_u32 m0, s28, 27648
  s_nop 0
  buffer_load_dwordx4 v144, s[8:11], s17 offen lds
  s_add_u32 s17, s17, s29
  s_add_u32 m0, s28, 28672
  s_nop 0
  buffer_load_dwordx4 v144, s[8:11], s17 offen lds
  s_add_u32 s17, s17, s29
  s_add_u32 m0, s28, 29696
  s_nop 0
  buffer_load_dwordx4 v144, s[8:11], s17 offen lds
  s_add_u32 s17, s17, s29
  s_add_u32 m0, s28, 30720
  s_nop 0
  buffer_load_dwordx4 v144, s[8:11], s17 offen lds
  s_add_u32 s17, s17, s29
  s_add_u32 m0, s28, 31744
  s_nop 0
  buffer_load_dwordx4 v144, s[8:11], s17 offen lds
  s_add_u32 s17, s17, s29
  v_bfe_u32 v148, v1, 2, 2
  v_lshrrev_b32 v149, 5, v1
  v_lshl_add_u32 v148, v149, 2, v148
  v_lshlrev_b32 v148, 7, v148
  v_bfe_u32 v149, v1, 4, 1
  v_lshl_add_u32 v148, v149, 5, v148
  v_and_b32 v149, 1, v1
  v_lshl_add_u32 v148, v149, 4, v148
  v_bfe_u32 v149, v1, 1, 1
  v_lshl_add_u32 v148, v149, 3, v148
  v_add_u32 v146, s28, v148
  v_add_u32 v147, 1024, v146
  s_waitcnt vmcnt(28)
  ds_read_b64_tr_b16 a[0:1], v146 offset:0
  ds_read_b64_tr_b16 a[2:3], v147 offset:0
  ds_read_b64_tr_b16 a[4:5], v146 offset:64
  ds_read_b64_tr_b16 a[6:7], v147 offset:64
  ds_read_b64_tr_b16 a[8:9], v146 offset:2048
  ds_read_b64_tr_b16 a[10:11], v147 offset:2048
  ds_read_b64_tr_b16 a[12:13], v146 offset:2112
  ds_read_b64_tr_b16 a[14:15], v147 offset:2112
  s_waitcnt lgkmcnt(0)
  s_add_u32 m0, s28, 0
  s_nop 0
  buffer_load_dwordx4 v144, s[8:11], s17 offen lds
  s_add_u32 s17, s17, s29
  s_add_u32 m0, s28, 1024
  s_nop 0
  buffer_load_dwordx4 v144, s[8:11], s17 offen lds
  s_add_u32 s17, s17, s29
  s_add_u32 m0, s28, 2048
  s_nop 0
  buffer_load_dwordx4 v144, s[8:11], s17 offen lds
  s_add_u32 s17, s17, s29
  s_add_u32 m0, s28, 3072
  s_nop 0
  buffer_load_dwordx4 v144, s[8:11], s17 offen lds
  s_add_u32 s17, s17, s29
  s_waitcnt vmcnt(28)
  ds_read_b64_tr_b16 a[16:17], v146 offset:4096
  ds_read_b64_tr_b16 a[18:19], v147 offset:4096
  ds_read_b64_tr_b16 a[20:21], v146 offset:4160
  ds_read_b64_tr_b16 a[22:23], v147 offset:4160
  ds_read_b64_tr_b16 a[24:25], v146 offset:6144
  ds_read_b64_tr_b16 a[26:27], v147 offset:6144
  ds_read_b64_tr_b16 a[28:29], v146 offset:6208
  ds_read_b64_tr_b16 a[30:31], v147 offset:6208
  s_waitcnt lgkmcnt(0)
  s_add_u32 m0, s28, 4096
  s_nop 0
  buffer_load_dwordx4 v144, s[8:11], s17 offen lds
  s_add_u32 s17, s17, s29
  s_add_u32 m0, s28, 5120
  s_nop 0
  buffer_load_dwordx4 v144, s[8:11], s17 offen lds
  s_add_u32 s17, s17, s29
  s_add_u32 m0, s28, 6144
  s_nop 0
  buffer_load_dwordx4 v144, s[8:11], s17 offen lds
  s_add_u32 s17, s17, s29
  s_add_u32 m0, s28, 7168
  s_nop 0
  buffer_load_dwordx4 v144, s[8:11], s17 offen lds
  s_add_u32 s17, s17, s29
  s_waitcnt vmcnt(28)
  ds_read_b64_tr_b16 a[32:33], v146 offset:8192
  ds_read_b64_tr_b16 a[34:35], v147 offset:8192
  ds_read_b64_tr_b16 a[36:37], v146 offset:8256
  ds_read_b64_tr_b16 a[38:39], v147 offset:8256
  ds_read_b64_tr_b16 a[40:41], v146 offset:10240
  ds_read_b64_tr_b16 a[42:43], v147 offset:10240
  ds_read_b64_tr_b16 a[44:45], v146 offset:10304
  ds_read_b64_tr_b16 a[46:47], v147 offset:10304
  s_waitcnt lgkmcnt(0)
  s_add_u32 m0, s28, 8192
  s_nop 0
  buffer_load_dwordx4 v144, s[8:11], s17 offen lds
  s_add_u32 s17, s17, s29
  s_add_u32 m0, s28, 9216
  s_nop 0
  buffer_load_dwordx4 v144, s[8:11], s17 offen lds
  s_add_u32 s17, s17, s29
  s_add_u32 m0, s28, 10240
  s_nop 0
  buffer_load_dwordx4 v144, s[8:11], s17 offen lds
  s_add_u32 s17, s17, s29
  s_add_u32 m0, s28, 11264
  s_nop 0
  buffer_load_dwordx4 v144, s[8:11], s17 offen lds
  s_add_u32 s17, s17, s29
  s_waitcnt vmcnt(28)
  ds_read_b64_tr_b16 a[48:49], v146 offset:12288
  ds_read_b64_tr_b16 a[50:51], v147 offset:12288
  ds_read_b64_tr_b16 a[52:53], v146 offset:12352
  ds_read_b64_tr_b16 a[54:55], v147 offset:12352
  ds_read_b64_tr_b16 a[56:57], v146 offset:14336
  ds_read_b64_tr_b16 a[58:59], v147 offset:14336
  ds_read_b64_tr_b16 a[60:61], v146 offset:14400
  ds_read_b64_tr_b16 a[62:63], v147 offset:14400
  s_waitcnt lgkmcnt(0)
  s_add_u32 m0, s28, 12288
  s_nop 0
  buffer_load_dwordx4 v144, s[8:11], s17 offen lds
  s_add_u32 s17, s17, s29
  s_add_u32 m0, s28, 13312
  s_nop 0
  buffer_load_dwordx4 v144, s[8:11], s17 offen lds
  s_add_u32 s17, s17, s29
  s_add_u32 m0, s28, 14336
  s_nop 0
  buffer_load_dwordx4 v144, s[8:11], s17 offen lds
  s_add_u32 s17, s17, s29
  s_add_u32 m0, s28, 15360
  s_nop 0
  buffer_load_dwordx4 v144, s[8:11], s17 offen lds
  s_add_u32 s17, s17, s29
  s_waitcnt vmcnt(28)
  ds_read_b64_tr_b16 a[64:65], v146 offset:16384
  ds_read_b64_tr_b16 a[66:67], v147 offset:16384
  ds_read_b64_tr_b16 a[68:69], v146 offset:16448
  ds_read_b64_tr_b16 a[70:71], v147 offset:16448
  ds_read_b64_tr_b16 a[72:73], v146 offset:18432
  ds_read_b64_tr_b16 a[74:75], v147 offset:18432
  ds_read_b64_tr_b16 a[76:77], v146 offset:18496
  ds_read_b64_tr_b16 a[78:79], v147 offset:18496
  s_waitcnt lgkmcnt(0)
  s_add_u32 m0, s28, 16384
  s_nop 0
  buffer_load_dwordx4 v144, s[8:11], s17 offen lds
  s_add_u32 s17, s17, s29
  s_add_u32 m0, s28, 17408
  s_nop 0
  buffer_load_dwordx4 v144, s[8:11], s17 offen lds
  s_add_u32 s17, s17, s29
  s_add_u32 m0, s28, 18432
  s_nop 0
  buffer_load_dwordx4 v144, s[8:11], s17 offen lds
  s_add_u32 s17, s17, s29
  s_add_u32 m0, s28, 19456
  s_nop 0
  buffer_load_dwordx4 v144, s[8:11], s17 offen lds
  s_add_u32 s17, s17, s29
  s_waitcnt vmcnt(28)
  ds_read_b64_tr_b16 a[80:81], v146 offset:20480
  ds_read_b64_tr_b16 a[82:83], v147 offset:20480
  ds_read_b64_tr_b16 a[84:85], v146 offset:20544
  ds_read_b64_tr_b16 a[86:87], v147 offset:20544
  ds_read_b64_tr_b16 a[88:89], v146 offset:22528
  ds_read_b64_tr_b16 a[90:91], v147 offset:22528
  ds_read_b64_tr_b16 a[92:93], v146 offset:22592
  ds_read_b64_tr_b16 a[94:95], v147 offset:22592
  s_waitcnt lgkmcnt(0)
  s_add_u32 m0, s28, 20480
  s_nop 0
  buffer_load_dwordx4 v144, s[8:11], s17 offen lds
  s_add_u32 s17, s17, s29
  s_add_u32 m0, s28, 21504
  s_nop 0
  buffer_load_dwordx4 v144, s[8:11], s17 offen lds
  s_add_u32 s17, s17, s29
  s_add_u32 m0, s28, 22528
  s_nop 0
  buffer_load_dwordx4 v144, s[8:11], s17 offen lds
  s_add_u32 s17, s17, s29
  s_add_u32 m0, s28, 23552
  s_nop 0
  buffer_load_dwordx4 v144, s[8:11], s17 offen lds
  s_add_u32 s17, s17, s29
  s_waitcnt vmcnt(28)
  ds_read_b64_tr_b16 a[96:97], v146 offset:24576
  ds_read_b64_tr_b16 a[98:99], v147 offset:24576
  ds_read_b64_tr_b16 a[100:101], v146 offset:24640
  ds_read_b64_tr_b16 a[102:103], v147 offset:24640
  ds_read_b64_tr_b16 a[104:105], v146 offset:26624
  ds_read_b64_tr_b16 a[106:107], v147 offset:26624
  ds_read_b64_tr_b16 a[108:109], v146 offset:26688
  ds_read_b64_tr_b16 a[110:111], v147 offset:26688
  s_waitcnt lgkmcnt(0)
  s_add_u32 m0, s28, 24576
  s_nop 0
  buffer_load_dwordx4 v144, s[8:11], s17 offen lds
  s_add_u32 s17, s17, s29
  s_add_u32 m0, s28, 25600
  s_nop 0
  buffer_load_dwordx4 v144, s[8:11], s17 offen lds
  s_add_u32 s17, s17, s29
  s_add_u32 m0, s28, 26624
  s_nop 0
  buffer_load_dwordx4 v144, s[8:11], s17 offen lds
  s_add_u32 s17, s17, s29
  s_add_u32 m0, s28, 27648
  s_nop 0
  buffer_load_dwordx4 v144, s[8:11], s17 offen lds
  s_add_u32 s17, s17, s29
  s_waitcnt vmcnt(28)
  ds_read_b64_tr_b16 a[112:113], v146 offset:28672
  ds_read_b64_tr_b16 a[114:115], v147 offset:28672
  ds_read_b64_tr_b16 a[116:117], v146 offset:28736
  ds_read_b64_tr_b16 a[118:119], v147 offset:28736
  ds_read_b64_tr_b16 a[120:121], v146 offset:30720
  ds_read_b64_tr_b16 a[122:123], v147 offset:30720
  ds_read_b64_tr_b16 a[124:125], v146 offset:30784
  ds_read_b64_tr_b16 a[126:127], v147 offset:30784
  s_waitcnt lgkmcnt(0)
  s_add_u32 m0, s28, 28672
  s_nop 0
  buffer_load_dwordx4 v144, s[8:11], s17 offen lds
  s_add_u32 s17, s17, s29
  s_add_u32 m0, s28, 29696
  s_nop 0
  buffer_load_dwordx4 v144, s[8:11], s17 offen lds
  s_add_u32 s17, s17, s29
  s_add_u32 m0, s28, 30720
  s_nop 0
  buffer_load_dwordx4 v144, s[8:11], s17 offen lds
  s_add_u32 s17, s17, s29
  s_add_u32 m0, s28, 31744
  s_nop 0
  buffer_load_dwordx4 v144, s[8:11], s17 offen lds
  s_add_u32 s17, s17, s29
  s_waitcnt vmcnt(28)
  ds_read_b64_tr_b16 a[128:129], v146 offset:0
  ds_read_b64_tr_b16 a[130:131], v147 offset:0
  ds_read_b64_tr_b16 a[132:133], v146 offset:64
  ds_read_b64_tr_b16 a[134:135], v147 offset:64
  ds_read_b64_tr_b16 a[136:137], v146 offset:2048
  ds_read_b64_tr_b16 a[138:139], v147 offset:2048
  ds_read_b64_tr_b16 a[140:141], v146 offset:2112
  ds_read_b64_tr_b16 a[142:143], v147 offset:2112
  s_waitcnt lgkmcnt(0)
  s_waitcnt vmcnt(24)
  ds_read_b64_tr_b16 a[144:145], v146 offset:4096
  ds_read_b64_tr_b16 a[146:147], v147 offset:4096
  ds_read_b64_tr_b16 a[148:149], v146 offset:4160
  ds_read_b64_tr_b16 a[150:151], v147 offset:4160
  ds_read_b64_tr_b16 a[152:153], v146 offset:6144
  ds_read_b64_tr_b16 a[154:155], v147 offset:6144
  ds_read_b64_tr_b16 a[156:157], v146 offset:6208
  ds_read_b64_tr_b16 a[158:159], v147 offset:6208
  s_waitcnt lgkmcnt(0)
  s_waitcnt vmcnt(20)
  ds_read_b64_tr_b16 a[160:161], v146 offset:8192
  ds_read_b64_tr_b16 a[162:163], v147 offset:8192
  ds_read_b64_tr_b16 a[164:165], v146 offset:8256
  ds_read_b64_tr_b16 a[166:167], v147 offset:8256
  ds_read_b64_tr_b16 a[168:169], v146 offset:10240
  ds_read_b64_tr_b16 a[170:171], v147 offset:10240
  ds_read_b64_tr_b16 a[172:173], v146 offset:10304
  ds_read_b64_tr_b16 a[174:175], v147 offset:10304
  s_waitcnt lgkmcnt(0)
  s_waitcnt vmcnt(16)
  ds_read_b64_tr_b16 a[176:177], v146 offset:12288
  ds_read_b64_tr_b16 a[178:179], v147 offset:12288
  ds_read_b64_tr_b16 a[180:181], v146 offset:12352
  ds_read_b64_tr_b16 a[182:183], v147 offset:12352
  ds_read_b64_tr_b16 a[184:185], v146 offset:14336
  ds_read_b64_tr_b16 a[186:187], v147 offset:14336
  ds_read_b64_tr_b16 a[188:189], v146 offset:14400
  ds_read_b64_tr_b16 a[190:191], v147 offset:14400
  s_waitcnt lgkmcnt(0)
  s_waitcnt vmcnt(12)
  ds_read_b64_tr_b16 a[192:193], v146 offset:16384
  ds_read_b64_tr_b16 a[194:195], v147 offset:16384
  ds_read_b64_tr_b16 a[196:197], v146 offset:16448
  ds_read_b64_tr_b16 a[198:199], v147 offset:16448
  ds_read_b64_tr_b16 a[200:201], v146 offset:18432
  ds_read_b64_tr_b16 a[202:203], v147 offset:18432
  ds_read_b64_tr_b16 a[204:205], v146 offset:18496
  ds_read_b64_tr_b16 a[206:207], v147 offset:18496
  s_waitcnt lgkmcnt(0)
  s_waitcnt vmcnt(8)
  ds_read_b64_tr_b16 a[208:209], v146 offset:20480
  ds_read_b64_tr_b16 a[210:211], v147 offset:20480
  ds_read_b64_tr_b16 a[212:213], v146 offset:20544
  ds_read_b64_tr_b16 a[214:215], v147 offset:20544
  ds_read_b64_tr_b16 a[216:217], v146 offset:22528
  ds_read_b64_tr_b16 a[218:219], v147 offset:22528
  ds_read_b64_tr_b16 a[220:221], v146 offset:22592
  ds_read_b64_tr_b16 a[222:223], v147 offset:22592
  s_waitcnt lgkmcnt(0)
  s_waitcnt vmcnt(4)
  ds_read_b64_tr_b16 a[224:225], v146 offset:24576
  ds_read_b64_tr_b16 a[226:227], v147 offset:24576
  ds_read_b64_tr_b16 a[228:229], v146 offset:24640
  ds_read_b64_tr_b16 a[230:231], v147 offset:24640
  ds_read_b64_tr_b16 a[232:233], v146 offset:26624
  ds_read_b64_tr_b16 a[234:235], v147 offset:26624
  ds_read_b64_tr_b16 a[236:237], v146 offset:26688
  ds_read_b64_tr_b16 a[238:239], v147 offset:26688
  s_waitcnt lgkmcnt(0)
  s_waitcnt vmcnt(0)
  ds_read_b64_tr_b16 a[240:241], v146 offset:28672
  ds_read_b64_tr_b16 a[242:243], v147 offset:28672
  ds_read_b64_tr_b16 a[244:245], v146 offset:28736
  ds_read_b64_tr_b16 a[246:247], v147 offset:28736
  ds_read_b64_tr_b16 a[248:249], v146 offset:30720
  ds_read_b64_tr_b16 a[250:251], v147 offset:30720
  ds_read_b64_tr_b16 a[252:253], v146 offset:30784
  ds_read_b64_tr_b16 a[254:255], v147 offset:30784
  s_waitcnt lgkmcnt(0)
  s_barrier
  s_lshl_b32 s25, s16, 13
  s_add_u32 m0, s25, 0
  s_nop 0
  buffer_load_dwordx4 v16, s[12:15], s19 offen lds
  s_add_u32 m0, s25, 1024
  s_nop 0
  buffer_load_dwordx4 v17, s[12:15], s19 offen lds
  s_add_u32 m0, s25, 2048
  s_nop 0
  buffer_load_dwordx4 v18, s[12:15], s19 offen lds
  s_add_u32 m0, s25, 3072
  s_nop 0
  buffer_load_dwordx4 v19, s[12:15], s19 offen lds
  s_add_u32 m0, s25, 4096
  s_nop 0
  buffer_load_dwordx4 v20, s[12:15], s19 offen lds
  s_add_u32 m0, s25, 5120
  s_nop 0
  buffer_load_dwordx4 v21, s[12:15], s19 offen lds
  s_add_u32 m0, s25, 6144
  s_nop 0
  buffer_load_dwordx4 v22, s[12:15], s19 offen lds
  s_add_u32 m0, s25, 7168
  s_nop 0
  buffer_load_dwordx4 v23, s[12:15], s19 offen lds
  s_cmp_gt_u32 s23, 1
  s_cselect_b32 s26, s20, 0
  s_add_u32 s19, s19, s26
  s_add_u32 s25, s25, 32768
  s_and_b32 s25, s25, 0x1ffff
  s_add_u32 m0, s25, 0
  s_nop 0
  buffer_load_dwordx4 v16, s[12:15], s19 offen lds
  s_add_u32 m0, s25, 1024
  s_nop 0
  buffer_load_dwordx4 v17, s[12:15], s19 offen lds
  s_add_u32 m0, s25, 2048
  s_nop 0
  buffer_load_dwordx4 v18, s[12:15], s19 offen lds
  s_add_u32 m0, s25, 3072
  s_nop 0
  buffer_load_dwordx4 v19, s[12:15], s19 offen lds
  s_add_u32 m0, s25, 4096
  s_nop 0
  buffer_load_dwordx4 v20, s[12:15], s19 offen lds
  s_add_u32 m0, s25, 5120
  s_nop 0
  buffer_load_dwordx4 v21, s[12:15], s19 offen lds
  s_add_u32 m0, s25, 6144
  s_nop 0
  buffer_load_dwordx4 v22, s[12:15], s19 offen lds
  s_add_u32 m0, s25, 7168
  s_nop 0
  buffer_load_dwordx4 v23, s[12:15], s19 offen lds
  s_cmp_gt_u32 s23, 2
  s_cselect_b32 s26, s20, 0
  s_add_u32 s19, s19, s26
  s_add_u32 s25, s25, 32768
  s_and_b32 s25, s25, 0x1ffff
  s_waitcnt vmcnt(0)
  s_barrier
  s_mov_b32 s27, s21
  s_mov_b32 s21, 149946368
  ds_read_b128 v[24:27], v8 offset:0
  ds_read_b128 v[28:31], v9 offset:0
  ds_read_b128 v[32:35], v10 offset:0
  ds_read_b128 v[36:39], v11 offset:0
  ds_read_b128 v[40:43], v12 offset:0
  ds_read_b128 v[44:47], v13 offset:0
.p2align 6
G_top_52:
  s_waitcnt lgkmcnt(5)
  v_mfma_f32_32x32x16_bf16 v[64:79], a[0:3], v[24:27], 0
  s_add_u32 m0, s25, 0
  ds_read_b128 v[48:51], v14 offset:0
  v_mfma_f32_32x32x16_bf16 v[80:95], a[4:7], v[24:27], 0
  s_waitcnt lgkmcnt(5)
  buffer_load_dwordx4 v16, s[12:15], s19 offen lds
  v_mfma_f32_32x32x16_bf16 v[64:79], a[8:11], v[28:31], v[64:79]
  ds_read_b128 v[52:55], v15 offset:0
  v_mul_f32 v96, s24, v96
  v_mul_f32 v97, s24, v97
  v_mfma_f32_32x32x16_bf16 v[80:95], a[12:15], v[28:31], v[80:95]
  s_waitcnt lgkmcnt(5)
  v_cvt_pk_bf16_f32 v128, v96, v97
  v_mul_f32 v98, s24, v98
  v_mfma_f32_32x32x16_bf16 v[64:79], a[16:19], v[32:35], v[64:79]
  s_add_u32 m0, s25, 1024
  ds_read_b128 v[24:27], v8 offset:8192
  v_mul_f32 v99, s24, v99
  v_cvt_pk_bf16_f32 v129, v98, v99
  v_mfma_f32_32x32x16_bf16 v[80:95], a[20:23], v[32:35], v[80:95]
  s_waitcnt lgkmcnt(5)
  buffer_load_dwordx4 v17, s[12:15], s19 offen lds
  v_mul_f32 v100, s24, v100
  v_mul_f32 v101, s24, v101
  v_mfma_f32_32x32x16_bf16 v[64:79], a[24:27], v[36:39], v[64:79]
  ds_read_b128 v[28:31], v9 offset:8192
  v_cvt_pk_bf16_f32 v130, v100, v101
  v_mul_f32 v102, s24, v102
  v_mfma_f32_32x32x16_bf16 v[80:95], a[28:31], v[36:39], v[80:95]
  s_waitcnt lgkmcnt(5)
  v_mul_f32 v103, s24, v103
  v_cvt_pk_bf16_f32 v131, v102, v103
  v_mfma_f32_32x32x16_bf16 v[64:79], a[32:35], v[40:43], v[64:79]
  s_add_u32 m0, s25, 2048
  ds_read_b128 v[32:35], v10 offset:8192
  v_mul_f32 v104, s24, v104
  v_mul_f32 v105, s24, v105
  v_mfma_f32_32x32x16_bf16 v[80:95], a[36:39], v[40:43], v[80:95]
  s_waitcnt lgkmcnt(5)
  buffer_load_dwordx4 v18, s[12:15], s19 offen lds
  v_cvt_pk_bf16_f32 v132, v104, v105
  v_mul_f32 v106, s24, v106
  v_mfma_f32_32x32x16_bf16 v[64:79], a[40:43], v[44:47], v[64:79]
  ds_read_b128 v[36:39], v11 offset:8192
  v_mul_f32 v107, s24, v107
  v_cvt_pk_bf16_f32 v133, v106, v107
  v_mfma_f32_32x32x16_bf16 v[80:95], a[44:47], v[44:47], v[80:95]
  s_waitcnt lgkmcnt(5)
  v_mul_f32 v108, s24, v108
  v_mul_f32 v109, s24, v109
  v_mfma_f32_32x32x16_bf16 v[64:79], a[48:51], v[48:51], v[64:79]
  s_add_u32 m0, s25, 3072
  ds_read_b128 v[40:43], v12 offset:8192
  v_cvt_pk_bf16_f32 v134, v108, v109
  v_mul_f32 v110, s24, v110
  v_mfma_f32_32x32x16_bf16 v[80:95], a[52:55], v[48:51], v[80:95]
  s_waitcnt lgkmcnt(5)
  buffer_load_dwordx4 v19, s[12:15], s19 offen lds
  v_mul_f32 v111, s24, v111
  v_cvt_pk_bf16_f32 v135, v110, v111
  v_mfma_f32_32x32x16_bf16 v[64:79], a[56:59], v[52:55], v[64:79]
  ds_read_b128 v[44:47], v13 offset:8192
  v_mul_f32 v112, s24, v112
  v_mul_f32 v113, s24, v113
  v_mfma_f32_32x32x16_bf16 v[80:95], a[60:63], v[52:55], v[80:95]
  s_waitcnt lgkmcnt(5)
  v_cvt_pk_bf16_f32 v136, v112, v113
  v_mul_f32 v114, s24, v114
  v_mfma_f32_32x32x16_bf16 v[64:79], a[64:67], v[24:27], v[64:79]
  s_add_u32 m0, s25, 4096
  ds_read_b128 v[48:51], v14 offset:8192
  v_mul_f32 v115, s24, v115
  v_cvt_pk_bf16_f32 v137, v114, v115
  v_mfma_f32_32x32x16_bf16 v[80:95], a[68:71], v[24:27], v[80:95]
  s_waitcnt lgkmcnt(5)
  buffer_load_dwordx4 v20, s[12:15], s19 offen lds
  v_mul_f32 v116, s24, v116
  v_mul_f32 v117, s24, v117
  v_mfma_f32_32x32x16_bf16 v[64:79], a[72:75], v[28:31], v[64:79]
  ds_read_b128 v[52:55], v15 offset:8192
  v_cvt_pk_bf16_f32 v138, v116, v117
  v_mul_f32 v118, s24, v118
  v_mfma_f32_32x32x16_bf16 v[80:95], a[76:79], v[28:31], v[80:95]
  s_waitcnt lgkmcnt(5)
  v_mul_f32 v119, s24, v119
  v_cvt_pk_bf16_f32 v139, v118, v119
  v_mfma_f32_32x32x16_bf16 v[64:79], a[80:83], v[32:35], v[64:79]
  s_add_u32 m0, s25, 5120
  ds_read_b128 v[24:27], v8 offset:16384
  v_mul_f32 v120, s24, v120
  v_mul_f32 v121, s24, v121
  v_mfma_f32_32x32x16_bf16 v[80:95], a[84:87], v[32:35], v[80:95]
  s_waitcnt lgkmcnt(5)
  buffer_load_dwordx4 v21, s[12:15], s19 offen lds
  v_cvt_pk_bf16_f32 v140, v120, v121
  v_mul_f32 v122, s24, v122
  v_mfma_f32_32x32x16_bf16 v[64:79], a[88:91], v[36:39], v[64:79]
  ds_read_b128 v[28:31], v9 offset:16384
  v_mul_f32 v123, s24, v123
  v_cvt_pk_bf16_f32 v141, v122, v123
  v_mfma_f32_32x32x16_bf16 v[80:95], a[92:95], v[36:39], v[80:95]
  s_waitcnt lgkmcnt(5)
  v_mul_f32 v124, s24, v124
  v_mul_f32 v125, s24, v125
  v_mfma_f32_32x32x16_bf16 v[64:79], a[96:99], v[40:43], v[64:79]
  s_add_u32 m0, s25, 6144
  ds_read_b128 v[32:35], v10 offset:16384
  v_cvt_pk_bf16_f32 v142, v124, v125
  v_mul_f32 v126, s24, v126
  v_mfma_f32_32x32x16_bf16 v[80:95], a[100:103], v[40:43], v[80:95]
  s_waitcnt lgkmcnt(5)
  buffer_load_dwordx4 v22, s[12:15], s19 offen lds
  v_mul_f32 v127, s24, v127
  v_cvt_pk_bf16_f32 v143, v126, v127
  v_mfma_f32_32x32x16_bf16 v[64:79], a[104:107], v[44:47], v[64:79]
  ds_read_b128 v[36:39], v11 offset:16384
  v_mfma_f32_32x32x16_bf16 v[80:95], a[108:111], v[44:47], v[80:95]
  s_waitcnt lgkmcnt(5)
  v_mfma_f32_32x32x16_bf16 v[64:79], a[112:115], v[48:51], v[64:79]
  s_add_u32 m0, s25, 7168
  ds_read_b128 v[40:43], v12 offset:16384
  v_mfma_f32_32x32x16_bf16 v[80:95], a[116:119], v[48:51], v[80:95]
  s_waitcnt lgkmcnt(5)
  buffer_load_dwordx4 v23, s[12:15], s19 offen lds
  v_mfma_f32_32x32x16_bf16 v[64:79], a[120:123], v[52:55], v[64:79]
  s_cmp_gt_u32 s23, 3
  ds_read_b128 v[44:47], v13 offset:16384
  v_mfma_f32_32x32x16_bf16 v[80:95], a[124:127], v[52:55], v[80:95]
  s_waitcnt lgkmcnt(5)
  s_cselect_b32 s26, s20, 0
  v_mfma_f32_32x32x16_bf16 v[64:79], a[128:131], v[24:27], v[64:79]
  s_add_u32 s19, s19, s26
  ds_read_b128 v[48:51], v14 offset:16384
  v_mfma_f32_32x32x16_bf16 v[80:95], a[132:135], v[24:27], v[80:95]
  s_waitcnt lgkmcnt(5)
  s_add_u32 s25, s25, 32768
  v_mfma_f32_32x32x16_bf16 v[64:79], a[136:139], v[28:31], v[64:79]
  s_and_b32 s25, s25, 0x1ffff
  ds_read_b128 v[52:55], v15 offset:16384
  v_mfma_f32_32x32x16_bf16 v[80:95], a[140:143], v[28:31], v[80:95]
  s_waitcnt lgkmcnt(5)
  buffer_store_dwordx4 v[128:131], v2, s[4:7], s21 offen offset:0
  v_mfma_f32_32x32x16_bf16 v[64:79], a[144:147], v[32:35], v[64:79]
  ds_read_b128 v[24:27], v8 offset:24576
  v_mfma_f32_32x32x16_bf16 v[80:95], a[148:151], v[32:35], v[80:95]
  s_waitcnt lgkmcnt(5)
  v_mfma_f32_32x32x16_bf16 v[64:79], a[152:155], v[36:39], v[64:79]
  ds_read_b128 v[28:31], v9 offset:24576
  v_mfma_f32_32x32x16_bf16 v[80:95], a[156:159], v[36:39], v[80:95]
  s_waitcnt lgkmcnt(5)
  buffer_store_dwordx4 v[132:135], v2, s[4:7], s21 offen offset:1024
  v_mfma_f32_32x32x16_bf16 v[64:79], a[160:163], v[40:43], v[64:79]
  ds_read_b128 v[32:35], v10 offset:24576
  v_mfma_f32_32x32x16_bf16 v[80:95], a[164:167], v[40:43], v[80:95]
  s_waitcnt lgkmcnt(5)
  v_mfma_f32_32x32x16_bf16 v[64:79], a[168:171], v[44:47], v[64:79]
  ds_read_b128 v[36:39], v11 offset:24576
  v_mfma_f32_32x32x16_bf16 v[80:95], a[172:175], v[44:47], v[80:95]
  s_waitcnt lgkmcnt(5)
  buffer_store_dwordx4 v[136:139], v2, s[4:7], s21 offen offset:2048
  v_mfma_f32_32x32x16_bf16 v[64:79], a[176:179], v[48:51], v[64:79]
  ds_read_b128 v[40:43], v12 offset:24576
  v_mfma_f32_32x32x16_bf16 v[80:95], a[180:183], v[48:51], v[80:95]
  s_waitcnt lgkmcnt(5)
  v_mfma_f32_32x32x16_bf16 v[64:79], a[184:187], v[52:55], v[64:79]
  ds_read_b128 v[44:47], v13 offset:24576
  v_mfma_f32_32x32x16_bf16 v[80:95], a[188:191], v[52:55], v[80:95]
  s_waitcnt lgkmcnt(5)
  buffer_store_dwordx4 v[140:143], v2, s[4:7], s21 offen offset:3072
  v_mfma_f32_32x32x16_bf16 v[64:79], a[192:195], v[24:27], v[64:79]
  s_mov_b32 s21, s27
  ds_read_b128 v[48:51], v14 offset:24576
  v_mfma_f32_32x32x16_bf16 v[80:95], a[196:199], v[24:27], v[80:95]
  s_waitcnt lgkmcnt(5)
  v_mfma_f32_32x32x16_bf16 v[64:79], a[200:203], v[28:31], v[64:79]
  s_add_u32 s27, s27, s22
  ds_read_b128 v[52:55], v15 offset:24576
  v_mfma_f32_32x32x16_bf16 v[80:95], a[204:207], v[28:31], v[80:95]
  s_waitcnt lgkmcnt(5)
  s_waitcnt vmcnt(16)
  s_barrier
  v_mfma_f32_32x32x16_bf16 v[64:79], a[208:211], v[32:35], v[64:79]
  ds_read_b128 v[24:27], v8 offset:32768
  v_mfma_f32_32x32x16_bf16 v[80:95], a[212:215], v[32:35], v[80:95]
  s_waitcnt lgkmcnt(5)
  v_mfma_f32_32x32x16_bf16 v[64:79], a[216:219], v[36:39], v[64:79]
  ds_read_b128 v[28:31], v9 offset:32768
  v_mfma_f32_32x32x16_bf16 v[80:95], a[220:223], v[36:39], v[80:95]
  s_waitcnt lgkmcnt(5)
  v_mfma_f32_32x32x16_bf16 v[64:79], a[224:227], v[40:43], v[64:79]
  ds_read_b128 v[32:35], v10 offset:32768
  v_mfma_f32_32x32x16_bf16 v[80:95], a[228:231], v[40:43], v[80:95]
  s_waitcnt lgkmcnt(5)
  v_mfma_f32_32x32x16_bf16 v[64:79], a[232:235], v[44:47], v[64:79]
  ds_read_b128 v[36:39], v11 offset:32768
  v_mfma_f32_32x32x16_bf16 v[80:95], a[236:239], v[44:47], v[80:95]
  s_waitcnt lgkmcnt(5)
  v_mfma_f32_32x32x16_bf16 v[64:79], a[240:243], v[48:51], v[64:79]
  s_sub_u32 s23, s23, 1
  ds_read_b128 v[40:43], v12 offset:32768
  v_mfma_f32_32x32x16_bf16 v[80:95], a[244:247], v[48:51], v[80:95]
  s_waitcnt lgkmcnt(5)
  v_mfma_f32_32x32x16_bf16 v[64:79], a[248:251], v[52:55], v[64:79]
  s_cmp_eq_u32 s23, 0
  ds_read_b128 v[44:47], v13 offset:32768
  v_mfma_f32_32x32x16_bf16 v[80:95], a[252:255], v[52:55], v[80:95]
  s_cbranch_scc1 G_done0_53
  s_waitcnt lgkmcnt(5)
  v_mfma_f32_32x32x16_bf16 v[96:111], a[0:3], v[24:27], 0
  s_add_u32 m0, s25, 0
  ds_read_b128 v[48:51], v14 offset:32768
  v_mfma_f32_32x32x16_bf16 v[112:127], a[4:7], v[24:27], 0
  s_waitcnt lgkmcnt(5)
  buffer_load_dwordx4 v16, s[12:15], s19 offen lds
  v_mfma_f32_32x32x16_bf16 v[96:111], a[8:11], v[28:31], v[96:111]
  ds_read_b128 v[52:55], v15 offset:32768
  v_mul_f32 v64, s24, v64
  v_mul_f32 v65, s24, v65
  v_mfma_f32_32x32x16_bf16 v[112:127], a[12:15], v[28:31], v[112:127]
  s_waitcnt lgkmcnt(5)
  v_cvt_pk_bf16_f32 v128, v64, v65
  v_mul_f32 v66, s24, v66
  v_mfma_f32_32x32x16_bf16 v[96:111], a[16:19], v[32:35], v[96:111]
  s_add_u32 m0, s25, 1024
  ds_read_b128 v[24:27], v8 offset:40960
  v_mul_f32 v67, s24, v67
  v_cvt_pk_bf16_f32 v129, v66, v67
  v_mfma_f32_32x32x16_bf16 v[112:127], a[20:23], v[32:35], v[112:127]
  s_waitcnt lgkmcnt(5)
  buffer_load_dwordx4 v17, s[12:15], s19 offen lds
  v_mul_f32 v68, s24, v68
  v_mul_f32 v69, s24, v69
  v_mfma_f32_32x32x16_bf16 v[96:111], a[24:27], v[36:39], v[96:111]
  ds_read_b128 v[28:31], v9 offset:40960
  v_cvt_pk_bf16_f32 v130, v68, v69
  v_mul_f32 v70, s24, v70
  v_mfma_f32_32x32x16_bf16 v[112:127], a[28:31], v[36:39], v[112:127]
  s_waitcnt lgkmcnt(5)
  v_mul_f32 v71, s24, v71
  v_cvt_pk_bf16_f32 v131, v70, v71
  v_mfma_f32_32x32x16_bf16 v[96:111], a[32:35], v[40:43], v[96:111]
  s_add_u32 m0, s25, 2048
  ds_read_b128 v[32:35], v10 offset:40960
  v_mul_f32 v72, s24, v72
  v_mul_f32 v73, s24, v73
  v_mfma_f32_32x32x16_bf16 v[112:127], a[36:39], v[40:43], v[112:127]
  s_waitcnt lgkmcnt(5)
  buffer_load_dwordx4 v18, s[12:15], s19 offen lds
  v_cvt_pk_bf16_f32 v132, v72, v73
  v_mul_f32 v74, s24, v74
  v_mfma_f32_32x32x16_bf16 v[96:111], a[40:43], v[44:47], v[96:111]
  ds_read_b128 v[36:39], v11 offset:40960
  v_mul_f32 v75, s24, v75
  v_cvt_pk_bf16_f32 v133, v74, v75
  v_mfma_f32_32x32x16_bf16 v[112:127], a[44:47], v[44:47], v[112:127]
  s_waitcnt lgkmcnt(5)
  v_mul_f32 v76, s24, v76
  v_mul_f32 v77, s24, v77
  v_mfma_f32_32x32x16_bf16 v[96:111], a[48:51], v[48:51], v[96:111]
  s_add_u32 m0, s25, 3072
  ds_read_b128 v[40:43], v12 offset:40960
  v_cvt_pk_bf16_f32 v134, v76, v77
  v_mul_f32 v78, s24, v78
  v_mfma_f32_32x32x16_bf16 v[112:127], a[52:55], v[48:51], v[112:127]
  s_waitcnt lgkmcnt(5)
  buffer_load_dwordx4 v19, s[12:15], s19 offen lds
  v_mul_f32 v79, s24, v79
  v_cvt_pk_bf16_f32 v135, v78, v79
  v_mfma_f32_32x32x16_bf16 v[96:111], a[56:59], v[52:55], v[96:111]
  ds_read_b128 v[44:47], v13 offset:40960
  v_mul_f32 v80, s24, v80
  v_mul_f32 v81, s24, v81
  v_mfma_f32_32x32x16_bf16 v[112:127], a[60:63], v[52:55], v[112:127]
  s_waitcnt lgkmcnt(5)
  v_cvt_pk_bf16_f32 v136, v80, v81
  v_mul_f32 v82, s24, v82
  v_mfma_f32_32x32x16_bf16 v[96:111], a[64:67], v[24:27], v[96:111]
  s_add_u32 m0, s25, 4096
  ds_read_b128 v[48:51], v14 offset:40960
  v_mul_f32 v83, s24, v83
  v_cvt_pk_bf16_f32 v137, v82, v83
  v_mfma_f32_32x32x16_bf16 v[112:127], a[68:71], v[24:27], v[112:127]
  s_waitcnt lgkmcnt(5)
  buffer_load_dwordx4 v20, s[12:15], s19 offen lds
  v_mul_f32 v84, s24, v84
  v_mul_f32 v85, s24, v85
  v_mfma_f32_32x32x16_bf16 v[96:111], a[72:75], v[28:31], v[96:111]
  ds_read_b128 v[52:55], v15 offset:40960
  v_cvt_pk_bf16_f32 v138, v84, v85
  v_mul_f32 v86, s24, v86
  v_mfma_f32_32x32x16_bf16 v[112:127], a[76:79], v[28:31], v[112:127]
  s_waitcnt lgkmcnt(5)
  v_mul_f32 v87, s24, v87
  v_cvt_pk_bf16_f32 v139, v86, v87
  v_mfma_f32_32x32x16_bf16 v[96:111], a[80:83], v[32:35], v[96:111]
  s_add_u32 m0, s25, 5120
  ds_read_b128 v[24:27], v8 offset:49152
  v_mul_f32 v88, s24, v88
  v_mul_f32 v89, s24, v89
  v_mfma_f32_32x32x16_bf16 v[112:127], a[84:87], v[32:35], v[112:127]
  s_waitcnt lgkmcnt(5)
  buffer_load_dwordx4 v21, s[12:15], s19 offen lds
  v_cvt_pk_bf16_f32 v140, v88, v89
  v_mul_f32 v90, s24, v90
  v_mfma_f32_32x32x16_bf16 v[96:111], a[88:91], v[36:39], v[96:111]
  ds_read_b128 v[28:31], v9 offset:49152
  v_mul_f32 v91, s24, v91
  v_cvt_pk_bf16_f32 v141, v90, v91
  v_mfma_f32_32x32x16_bf16 v[112:127], a[92:95], v[36:39], v[112:127]
  s_waitcnt lgkmcnt(5)
  v_mul_f32 v92, s24, v92
  v_mul_f32 v93, s24, v93
  v_mfma_f32_32x32x16_bf16 v[96:111], a[96:99], v[40:43], v[96:111]
  s_add_u32 m0, s25, 6144
  ds_read_b128 v[32:35], v10 offset:49152
  v_cvt_pk_bf16_f32 v142, v92, v93
  v_mul_f32 v94, s24, v94
  v_mfma_f32_32x32x16_bf16 v[112:127], a[100:103], v[40:43], v[112:127]
  s_waitcnt lgkmcnt(5)
  buffer_load_dwordx4 v22, s[12:15], s19 offen lds
  v_mul_f32 v95, s24, v95
  v_cvt_pk_bf16_f32 v143, v94, v95
  v_mfma_f32_32x32x16_bf16 v[96:111], a[104:107], v[44:47], v[96:111]
  ds_read_b128 v[36:39], v11 offset:49152
  v_mfma_f32_32x32x16_bf16 v[112:127], a[108:111], v[44:47], v[112:127]
  s_waitcnt lgkmcnt(5)
  v_mfma_f32_32x32x16_bf16 v[96:111], a[112:115], v[48:51], v[96:111]
  s_add_u32 m0, s25, 7168
  ds_read_b128 v[40:43], v12 offset:49152
  v_mfma_f32_32x32x16_bf16 v[112:127], a[116:119], v[48:51], v[112:127]
  s_waitcnt lgkmcnt(5)
  buffer_load_dwordx4 v23, s[12:15], s19 offen lds
  v_mfma_f32_32x32x16_bf16 v[96:111], a[120:123], v[52:55], v[96:111]
  s_cmp_gt_u32 s23, 3
  ds_read_b128 v[44:47], v13 offset:49152
  v_mfma_f32_32x32x16_bf16 v[112:127], a[124:127], v[52:55], v[112:127]
  s_waitcnt lgkmcnt(5)
  s_cselect_b32 s26, s20, 0
  v_mfma_f32_32x32x16_bf16 v[96:111], a[128:131], v[24:27], v[96:111]
  s_add_u32 s19, s19, s26
  ds_read_b128 v[48:51], v14 offset:49152
  v_mfma_f32_32x32x16_bf16 v[112:127], a[132:135], v[24:27], v[112:127]
  s_waitcnt lgkmcnt(5)
  s_add_u32 s25, s25, 32768
  v_mfma_f32_32x32x16_bf16 v[96:111], a[136:139], v[28:31], v[96:111]
  s_and_b32 s25, s25, 0x1ffff
  ds_read_b128 v[52:55], v15 offset:49152
  v_mfma_f32_32x32x16_bf16 v[112:127], a[140:143], v[28:31], v[112:127]
  s_waitcnt lgkmcnt(5)
  buffer_store_dwordx4 v[128:131], v2, s[4:7], s21 offen offset:0
  v_mfma_f32_32x32x16_bf16 v[96:111], a[144:147], v[32:35], v[96:111]
  ds_read_b128 v[24:27], v8 offset:57344
  v_mfma_f32_32x32x16_bf16 v[112:127], a[148:151], v[32:35], v[112:127]
  s_waitcnt lgkmcnt(5)
  v_xor_b32 v8, 0x10000, v8
  v_mfma_f32_32x32x16_bf16 v[96:111], a[152:155], v[36:39], v[96:111]
  ds_read_b128 v[28:31], v9 offset:57344
  v_mfma_f32_32x32x16_bf16 v[112:127], a[156:159], v[36:39], v[112:127]
  s_waitcnt lgkmcnt(5)
  buffer_store_dwordx4 v[132:135], v2, s[4:7], s21 offen offset:1024
  v_xor_b32 v9, 0x10000, v9
  v_mfma_f32_32x32x16_bf16 v[96:111], a[160:163], v[40:43], v[96:111]
  ds_read_b128 v[32:35], v10 offset:57344
  v_mfma_f32_32x32x16_bf16 v[112:127], a[164:167], v[40:43], v[112:127]
  s_waitcnt lgkmcnt(5)
  v_xor_b32 v10, 0x10000, v10
  v_mfma_f32_32x32x16_bf16 v[96:111], a[168:171], v[44:47], v[96:111]
  ds_read_b128 v[36:39], v11 offset:57344
  v_mfma_f32_32x32x16_bf16 v[112:127], a[172:175], v[44:47], v[112:127]
  s_waitcnt lgkmcnt(5)
  buffer_store_dwordx4 v[136:139], v2, s[4:7], s21 offen offset:2048
  v_xor_b32 v11, 0x10000, v11
  v_mfma_f32_32x32x16_bf16 v[96:111], a[176:179], v[48:51], v[96:111]
  ds_read_b128 v[40:43], v12 offset:57344
  v_mfma_f32_32x32x16_bf16 v[112:127], a[180:183], v[48:51], v[112:127]
  s_waitcnt lgkmcnt(5)
  v_xor_b32 v12, 0x10000, v12
  v_mfma_f32_32x32x16_bf16 v[96:111], a[184:187], v[52:55], v[96:111]
  ds_read_b128 v[44:47], v13 offset:57344
  v_mfma_f32_32x32x16_bf16 v[112:127], a[188:191], v[52:55], v[112:127]
  s_waitcnt lgkmcnt(5)
  buffer_store_dwordx4 v[140:143], v2, s[4:7], s21 offen offset:3072
  v_xor_b32 v13, 0x10000, v13
  v_mfma_f32_32x32x16_bf16 v[96:111], a[192:195], v[24:27], v[96:111]
  s_mov_b32 s21, s27
  ds_read_b128 v[48:51], v14 offset:57344
  v_mfma_f32_32x32x16_bf16 v[112:127], a[196:199], v[24:27], v[112:127]
  s_waitcnt lgkmcnt(5)
  v_xor_b32 v14, 0x10000, v14
  v_mfma_f32_32x32x16_bf16 v[96:111], a[200:203], v[28:31], v[96:111]
  s_add_u32 s27, s27, s22
  ds_read_b128 v[52:55], v15 offset:57344
  v_mfma_f32_32x32x16_bf16 v[112:127], a[204:207], v[28:31], v[112:127]
  s_waitcnt lgkmcnt(5)
  s_waitcnt vmcnt(16)
  s_barrier
  v_xor_b32 v15, 0x10000, v15
  v_mfma_f32_32x32x16_bf16 v[96:111], a[208:211], v[32:35], v[96:111]
  ds_read_b128 v[24:27], v8 offset:0
  v_mfma_f32_32x32x16_bf16 v[112:127], a[212:215], v[32:35], v[112:127]
  s_waitcnt lgkmcnt(5)
  v_mfma_f32_32x32x16_bf16 v[96:111], a[216:219], v[36:39], v[96:111]
  ds_read_b128 v[28:31], v9 offset:0
  v_mfma_f32_32x32x16_bf16 v[112:127], a[220:223], v[36:39], v[112:127]
  s_waitcnt lgkmcnt(5)
  v_mfma_f32_32x32x16_bf16 v[96:111], a[224:227], v[40:43], v[96:111]
  ds_read_b128 v[32:35], v10 offset:0
  v_mfma_f32_32x32x16_bf16 v[112:127], a[228:231], v[40:43], v[112:127]
  s_waitcnt lgkmcnt(5)
  v_mfma_f32_32x32x16_bf16 v[96:111], a[232:235], v[44:47], v[96:111]
  ds_read_b128 v[36:39], v11 offset:0
  v_mfma_f32_32x32x16_bf16 v[112:127], a[236:239], v[44:47], v[112:127]
  s_waitcnt lgkmcnt(5)
  v_mfma_f32_32x32x16_bf16 v[96:111], a[240:243], v[48:51], v[96:111]
  s_sub_u32 s23, s23, 1
  ds_read_b128 v[40:43], v12 offset:0
  v_mfma_f32_32x32x16_bf16 v[112:127], a[244:247], v[48:51], v[112:127]
  s_waitcnt lgkmcnt(5)
  v_mfma_f32_32x32x16_bf16 v[96:111], a[248:251], v[52:55], v[96:111]
  s_cmp_eq_u32 s23, 0
  ds_read_b128 v[44:47], v13 offset:0
  v_mfma_f32_32x32x16_bf16 v[112:127], a[252:255], v[52:55], v[112:127]
  s_cbranch_scc1 G_done1_54
  s_branch G_top_52
G_done0_53:
  s_nop 7
  s_nop 3
  v_mul_f32 v64, s24, v64
  v_mul_f32 v65, s24, v65
  v_cvt_pk_bf16_f32 v128, v64, v65
  v_mul_f32 v66, s24, v66
  v_mul_f32 v67, s24, v67
  v_cvt_pk_bf16_f32 v129, v66, v67
  v_mul_f32 v68, s24, v68
  v_mul_f32 v69, s24, v69
  v_cvt_pk_bf16_f32 v130, v68, v69
  v_mul_f32 v70, s24, v70
  v_mul_f32 v71, s24, v71
  v_cvt_pk_bf16_f32 v131, v70, v71
  buffer_store_dwordx4 v[128:131], v2, s[4:7], s21 offen offset:0
  v_mul_f32 v72, s24, v72
  v_mul_f32 v73, s24, v73
  v_cvt_pk_bf16_f32 v132, v72, v73
  v_mul_f32 v74, s24, v74
  v_mul_f32 v75, s24, v75
  v_cvt_pk_bf16_f32 v133, v74, v75
  v_mul_f32 v76, s24, v76
  v_mul_f32 v77, s24, v77
  v_cvt_pk_bf16_f32 v134, v76, v77
  v_mul_f32 v78, s24, v78
  v_mul_f32 v79, s24, v79
  v_cvt_pk_bf16_f32 v135, v78, v79
  buffer_store_dwordx4 v[132:135], v2, s[4:7], s21 offen offset:1024
  v_mul_f32 v80, s24, v80
  v_mul_f32 v81, s24, v81
  v_cvt_pk_bf16_f32 v136, v80, v81
  v_mul_f32 v82, s24, v82
  v_mul_f32 v83, s24, v83
  v_cvt_pk_bf16_f32 v137, v82, v83
  v_mul_f32 v84, s24, v84
  v_mul_f32 v85, s24, v85
  v_cvt_pk_bf16_f32 v138, v84, v85
  v_mul_f32 v86, s24, v86
  v_mul_f32 v87, s24, v87
  v_cvt_pk_bf16_f32 v139, v86, v87
  buffer_store_dwordx4 v[136:139], v2, s[4:7], s21 offen offset:2048
  v_mul_f32 v88, s24, v88
  v_mul_f32 v89, s24, v89
  v_cvt_pk_bf16_f32 v140, v88, v89
  v_mul_f32 v90, s24, v90
  v_mul_f32 v91, s24, v91
  v_cvt_pk_bf16_f32 v141, v90, v91
  v_mul_f32 v92, s24, v92
  v_mul_f32 v93, s24, v93
  v_cvt_pk_bf16_f32 v142, v92, v93
  v_mul_f32 v94, s24, v94
  v_mul_f32 v95, s24, v95
  v_cvt_pk_bf16_f32 v143, v94, v95
  buffer_store_dwordx4 v[140:143], v2, s[4:7], s21 offen offset:3072
  s_branch G_fin_55
G_done1_54:
  s_nop 7
  s_nop 3
  v_mul_f32 v96, s24, v96
  v_mul_f32 v97, s24, v97
  v_cvt_pk_bf16_f32 v128, v96, v97
  v_mul_f32 v98, s24, v98
  v_mul_f32 v99, s24, v99
  v_cvt_pk_bf16_f32 v129, v98, v99
  v_mul_f32 v100, s24, v100
  v_mul_f32 v101, s24, v101
  v_cvt_pk_bf16_f32 v130, v100, v101
  v_mul_f32 v102, s24, v102
  v_mul_f32 v103, s24, v103
  v_cvt_pk_bf16_f32 v131, v102, v103
  buffer_store_dwordx4 v[128:131], v2, s[4:7], s21 offen offset:0
  v_mul_f32 v104, s24, v104
  v_mul_f32 v105, s24, v105
  v_cvt_pk_bf16_f32 v132, v104, v105
  v_mul_f32 v106, s24, v106
  v_mul_f32 v107, s24, v107
  v_cvt_pk_bf16_f32 v133, v106, v107
  v_mul_f32 v108, s24, v108
  v_mul_f32 v109, s24, v109
  v_cvt_pk_bf16_f32 v134, v108, v109
  v_mul_f32 v110, s24, v110
  v_mul_f32 v111, s24, v111
  v_cvt_pk_bf16_f32 v135, v110, v111
  buffer_store_dwordx4 v[132:135], v2, s[4:7], s21 offen offset:1024
  v_mul_f32 v112, s24, v112
  v_mul_f32 v113, s24, v113
  v_cvt_pk_bf16_f32 v136, v112, v113
  v_mul_f32 v114, s24, v114
  v_mul_f32 v115, s24, v115
  v_cvt_pk_bf16_f32 v137, v114, v115
  v_mul_f32 v116, s24, v116
  v_mul_f32 v117, s24, v117
  v_cvt_pk_bf16_f32 v138, v116, v117
  v_mul_f32 v118, s24, v118
  v_mul_f32 v119, s24, v119
  v_cvt_pk_bf16_f32 v139, v118, v119
  buffer_store_dwordx4 v[136:139], v2, s[4:7], s21 offen offset:2048
  v_mul_f32 v120, s24, v120
  v_mul_f32 v121, s24, v121
  v_cvt_pk_bf16_f32 v140, v120, v121
  v_mul_f32 v122, s24, v122
  v_mul_f32 v123, s24, v123
  v_cvt_pk_bf16_f32 v141, v122, v123
  v_mul_f32 v124, s24, v124
  v_mul_f32 v125, s24, v125
  v_cvt_pk_bf16_f32 v142, v124, v125
  v_mul_f32 v126, s24, v126
  v_mul_f32 v127, s24, v127
  v_cvt_pk_bf16_f32 v143, v126, v127
  buffer_store_dwordx4 v[140:143], v2, s[4:7], s21 offen offset:3072
G_fin_55:
  s_waitcnt vmcnt(0) lgkmcnt(0)
  s_barrier
K_exit_51:
  s_endpgm
.text
.globl follow_kernel
.p2align 8
.type follow_kernel,@function
follow_kernel:
  s_cmp_ge_u32 s2, 256
  s_cbranch_scc1 K_exit_56
  v_lshrrev_b32 v3, 6, v0
  v_and_b32 v1, 63, v0
  v_readfirstlane_b32 s16, v3
  v_lshlrev_b32 v2, 4, v1
  s_load_dwordx2 s[4:5], s[0:1], 128
  s_waitcnt lgkmcnt(0)
  s_and_b32 s5, s5, 0xffff
  s_mov_b32 s6, 268435456
  s_mov_b32 s7, 0x20000
  s_and_b32 s40, s2, 7
  s_bfe_u32 s41, s2, 0x10003
  s_lshr_b32 s42, s2, 4
  s_mov_b32 s43, 16
  s_mov_b32 s23, 4
  s_load_dwordx2 s[8:9], s[0:1], 88
  s_lshl_b32 s17, s40, 19
  s_lshl_b32 s26, s41, 2
  s_add_u32 s26, s26, s16
  s_lshl_b32 s27, s26, 7
  s_add_u32 s17, s17, s27
  s_mov_b32 s18, 1024
  s_lshl_b32 s21, s40, 6
  s_add_u32 s21, s21, s42
  s_lshl_b32 s21, s21, 3
  s_add_u32 s21, s21, s26
  s_lshl_b32 s21, s21, 12
  s_add_u32 s21, s21, 167772160
  s_lshl_b32 s22, s43, 15
  s_mov_b32 s24, 1.0
  s_waitcnt lgkmcnt(0)
  s_and_b32 s9, s9, 0xffff
  s_mov_b32 s10, 4194304
  s_mov_b32 s11, 0x20000
  s_mul_i32 s26, s16, 0
  v_add_u32 v8, 0, v2
  v_add_u32 v16, s26, v8
  v_add_u32 v9, 1024, v2
  v_add_u32 v17, s26, v9
  v_add_u32 v10, 2048, v2
  v_add_u32 v18, s26, v10
  v_add_u32 v11, 3072, v2
  v_add_u32 v19, s26, v11
  v_add_u32 v12, 4096, v2
  v_add_u32 v20, s26, v12
  v_add_u32 v13, 5120, v2
  v_add_u32 v21, s26, v13
  v_add_u32 v14, 6144, v2
  v_add_u32 v22, s26, v14
  v_add_u32 v15, 7168, v2
  v_add_u32 v23, s26, v15
  v_lshrrev_b32 v144, 3, v1
  v_mul_lo_u32 v144, v144, s18
  v_and_b32 v145, 7, v1
  v_lshl_add_u32 v144, v145, 4, v144
  s_lshl_b32 s28, s16, 15
  s_add_u32 s28, s28, 32768
  s_lshl_b32 s29, s18, 3
  s_add_u32 m0, s28, 0
  s_nop 0
  buffer_load_dwordx4 v144, s[8:11], s17 offen lds
  s_add_u32 s17, s17, s29
  s_add_u32 m0, s28, 1024
  s_nop 0
  buffer_load_dwordx4 v144, s[8:11], s17 offen lds
  s_add_u32 s17, s17, s29
  s_add_u32 m0, s28, 2048
  s_nop 0
  buffer_load_dwordx4 v144, s[8:11], s17 offen lds
  s_add_u32 s17, s17, s29
  s_add_u32 m0, s28, 3072
  s_nop 0
  buffer_load_dwordx4 v144, s[8:11], s17 offen lds
  s_add_u32 s17, s17, s29
  s_add_u32 m0, s28, 4096
  s_nop 0
  buffer_load_dwordx4 v144, s[8:11], s17 offen lds
  s_add_u32 s17, s17, s29
  s_add_u32 m0, s28, 5120
  s_nop 0
  buffer_load_dwordx4 v144, s[8:11], s17 offen lds
  s_add_u32 s17, s17, s29
  s_add_u32 m0, s28, 6144
  s_nop 0
  buffer_load_dwordx4 v144, s[8:11], s17 offen lds
  s_add_u32 s17, s17, s29
  s_add_u32 m0, s28, 7168
  s_nop 0
  buffer_load_dwordx4 v144, s[8:11], s17 offen lds
  s_add_u32 s17, s17, s29
  s_add_u32 m0, s28, 8192
  s_nop 0
  buffer_load_dwordx4 v144, s[8:11], s17 offen lds
  s_add_u32 s17, s17, s29
  s_add_u32 m0, s28, 9216
  s_nop 0
  buffer_load_dwordx4 v144, s[8:11], s17 offen lds
  s_add_u32 s17, s17, s29
  s_add_u32 m0, s28, 10240
  s_nop 0
  buffer_load_dwordx4 v144, s[8:11], s17 offen lds
  s_add_u32 s17, s17, s29
  s_add_u32 m0, s28, 11264
  s_nop 0
  buffer_load_dwordx4 v144, s[8:11], s17 offen lds
  s_add_u32 s17, s17, s29
  s_add_u32 m0, s28, 12288
  s_nop 0
  buffer_load_dwordx4 v144, s[8:11], s17 offen lds
  s_add_u32 s17, s17, s29
  s_add_u32 m0, s28, 13312
  s_nop 0
  buffer_load_dwordx4 v144, s[8:11], s17 offen lds
  s_add_u32 s17, s17, s29
  s_add_u32 m0, s28, 14336
  s_nop 0
  buffer_load_dwordx4 v144, s[8:11], s17 offen lds
  s_add_u32 s17, s17, s29
  s_add_u32 m0, s28, 15360
  s_nop 0
  buffer_load_dwordx4 v144, s[8:11], s17 offen lds
  s_add_u32 s17, s17, s29
  s_add_u32 m0, s28, 16384
  s_nop 0
  buffer_load_dwordx4 v144, s[8:11], s17 offen lds
  s_add_u32 s17, s17, s29
  s_add_u32 m0, s28, 17408
  s_nop 0
  buffer_load_dwordx4 v144, s[8:11], s17 offen lds
  s_add_u32 s17, s17, s29
  s_add_u32 m0, s28, 18432
  s_nop 0
  buffer_load_dwordx4 v144, s[8:11], s17 offen lds
  s_add_u32 s17, s17, s29
  s_add_u32 m0, s28, 19456
  s_nop 0
  buffer_load_dwordx4 v144, s[8:11], s17 offen lds
  s_add_u32 s17, s17, s29
  s_add_u32 m0, s28, 20480
  s_nop 0
  buffer_load_dwordx4 v144, s[8:11], s17 offen lds
  s_add_u32 s17, s17, s29
  s_add_u32 m0, s28, 21504
  s_nop 0
  buffer_load_dwordx4 v144, s[8:11], s17 offen lds
  s_add_u32 s17, s17, s29
  s_add_u32 m0, s28, 22528
  s_nop 0
  buffer_load_dwordx4 v144, s[8:11], s17 offen lds
  s_add_u32 s17, s17, s29
  s_add_u32 m0, s28, 23552
  s_nop 0
  buffer_load_dwordx4 v144, s[8:11], s17 offen lds
  s_add_u32 s17, s17, s29
  s_add_u32 m0, s28, 24576
  s_nop 0
  buffer_load_dwordx4 v144, s[8:11], s17 offen lds
  s_add_u32 s17, s17, s29
  s_add_u32 m0, s28, 25600
  s_nop 0
  buffer_load_dwordx4 v144, s[8:11], s17 offen lds
  s_add_u32 s17, s17, s29
  s_add_u32 m0, s28, 26624
  s_nop 0
  buffer_load_dwordx4 v144, s[8:11], s17 offen lds
  s_add_u32 s17, s17, s29
  s_add_u32 m0, s28, 27648
  s_nop 0
  buffer_load_dwordx4 v144, s[8:11], s17 offen lds
  s_add_u32 s17, s17, s29
  s_add_u32 m0, s28, 28672
  s_nop 0
  buffer_load_dwordx4 v144, s[8:11], s17 offen lds
  s_add_u32 s17, s17, s29
  s_add_u32 m0, s28, 29696
  s_nop 0
  buffer_load_dwordx4 v144, s[8:11], s17 offen lds
  s_add_u32 s17, s17, s29
  s_add_u32 m0, s28, 30720
  s_nop 0
  buffer_load_dwordx4 v144, s[8:11], s17 offen lds
  s_add_u32 s17, s17, s29
  s_add_u32 m0, s28, 31744
  s_nop 0
  buffer_load_dwordx4 v144, s[8:11], s17 offen lds
  s_add_u32 s17, s17, s29
  v_bfe_u32 v148, v1, 2, 2
  v_lshrrev_b32 v149, 5, v1
  v_lshl_add_u32 v148, v149, 2, v148
  v_lshlrev_b32 v148, 7, v148
  v_bfe_u32 v149, v1, 4, 1
  v_lshl_add_u32 v148, v149, 5, v148
  v_and_b32 v149, 1, v1
  v_lshl_add_u32 v148, v149, 4, v148
  v_bfe_u32 v149, v1, 1, 1
  v_lshl_add_u32 v148, v149, 3, v148
  v_add_u32 v146, s28, v148
  v_add_u32 v147, 1024, v146
  s_waitcnt vmcnt(28)
  ds_read_b64_tr_b16 a[0:1], v146 offset:0
  ds_read_b64_tr_b16 a[2:3], v147 offset:0
  ds_read_b64_tr_b16 a[4:5], v146 offset:64
  ds_read_b64_tr_b16 a[6:7], v147 offset:64
  ds_read_b64_tr_b16 a[8:9], v146 offset:2048
  ds_read_b64_tr_b16 a[10:11], v147 offset:2048
  ds_read_b64_tr_b16 a[12:13], v146 offset:2112
  ds_read_b64_tr_b16 a[14:15], v147 offset:2112
  s_waitcnt lgkmcnt(0)
  s_add_u32 m0, s28, 0
  s_nop 0
  buffer_load_dwordx4 v144, s[8:11], s17 offen lds
  s_add_u32 s17, s17, s29
  s_add_u32 m0, s28, 1024
  s_nop 0
  buffer_load_dwordx4 v144, s[8:11], s17 offen lds
  s_add_u32 s17, s17, s29
  s_add_u32 m0, s28, 2048
  s_nop 0
  buffer_load_dwordx4 v144, s[8:11], s17 offen lds
  s_add_u32 s17, s17, s29
  s_add_u32 m0, s28, 3072
  s_nop 0
  buffer_load_dwordx4 v144, s[8:11], s17 offen lds
  s_add_u32 s17, s17, s29
  s_waitcnt vmcnt(28)
  ds_read_b64_tr_b16 a[16:17], v146 offset:4096
  ds_read_b64_tr_b16 a[18:19], v147 offset:4096
  ds_read_b64_tr_b16 a[20:21], v146 offset:4160
  ds_read_b64_tr_b16 a[22:23], v147 offset:4160
  ds_read_b64_tr_b16 a[24:25], v146 offset:6144
  ds_read_b64_tr_b16 a[26:27], v147 offset:6144
  ds_read_b64_tr_b16 a[28:29], v146 offset:6208
  ds_read_b64_tr_b16 a[30:31], v147 offset:6208
  s_waitcnt lgkmcnt(0)
  s_add_u32 m0, s28, 4096
  s_nop 0
  buffer_load_dwordx4 v144, s[8:11], s17 offen lds
  s_add_u32 s17, s17, s29
  s_add_u32 m0, s28, 5120
  s_nop 0
  buffer_load_dwordx4 v144, s[8:11], s17 offen lds
  s_add_u32 s17, s17, s29
  s_add_u32 m0, s28, 6144
  s_nop 0
  buffer_load_dwordx4 v144, s[8:11], s17 offen lds
  s_add_u32 s17, s17, s29
  s_add_u32 m0, s28, 7168
  s_nop 0
  buffer_load_dwordx4 v144, s[8:11], s17 offen lds
  s_add_u32 s17, s17, s29
  s_waitcnt vmcnt(28)
  ds_read_b64_tr_b16 a[32:33], v146 offset:8192
  ds_read_b64_tr_b16 a[34:35], v147 offset:8192
  ds_read_b64_tr_b16 a[36:37], v146 offset:8256
  ds_read_b64_tr_b16 a[38:39], v147 offset:8256
  ds_read_b64_tr_b16 a[40:41], v146 offset:10240
  ds_read_b64_tr_b16 a[42:43], v147 offset:10240
  ds_read_b64_tr_b16 a[44:45], v146 offset:10304
  ds_read_b64_tr_b16 a[46:47], v147 offset:10304
  s_waitcnt lgkmcnt(0)
  s_add_u32 m0, s28, 8192
  s_nop 0
  buffer_load_dwordx4 v144, s[8:11], s17 offen lds
  s_add_u32 s17, s17, s29
  s_add_u32 m0, s28, 9216
  s_nop 0
  buffer_load_dwordx4 v144, s[8:11], s17 offen lds
  s_add_u32 s17, s17, s29
  s_add_u32 m0, s28, 10240
  s_nop 0
  buffer_load_dwordx4 v144, s[8:11], s17 offen lds
  s_add_u32 s17, s17, s29
  s_add_u32 m0, s28, 11264
  s_nop 0
  buffer_load_dwordx4 v144, s[8:11], s17 offen lds
  s_add_u32 s17, s17, s29
  s_waitcnt vmcnt(28)
  ds_read_b64_tr_b16 a[48:49], v146 offset:12288
  ds_read_b64_tr_b16 a[50:51], v147 offset:12288
  ds_read_b64_tr_b16 a[52:53], v146 offset:12352
  ds_read_b64_tr_b16 a[54:55], v147 offset:12352
  ds_read_b64_tr_b16 a[56:57], v146 offset:14336
  ds_read_b64_tr_b16 a[58:59], v147 offset:14336
  ds_read_b64_tr_b16 a[60:61], v146 offset:14400
  ds_read_b64_tr_b16 a[62:63], v147 offset:14400
  s_waitcnt lgkmcnt(0)
  s_add_u32 m0, s28, 12288
  s_nop 0
  buffer_load_dwordx4 v144, s[8:11], s17 offen lds
  s_add_u32 s17, s17, s29
  s_add_u32 m0, s28, 13312
  s_nop 0
  buffer_load_dwordx4 v144, s[8:11], s17 offen lds
  s_add_u32 s17, s17, s29
  s_add_u32 m0, s28, 14336
  s_nop 0
  buffer_load_dwordx4 v144, s[8:11], s17 offen lds
  s_add_u32 s17, s17, s29
  s_add_u32 m0, s28, 15360
  s_nop 0
  buffer_load_dwordx4 v144, s[8:11], s17 offen lds
  s_add_u32 s17, s17, s29
  s_waitcnt vmcnt(28)
  ds_read_b64_tr_b16 a[64:65], v146 offset:16384
  ds_read_b64_tr_b16 a[66:67], v147 offset:16384
  ds_read_b64_tr_b16 a[68:69], v146 offset:16448
  ds_read_b64_tr_b16 a[70:71], v147 offset:16448
  ds_read_b64_tr_b16 a[72:73], v146 offset:18432
  ds_read_b64_tr_b16 a[74:75], v147 offset:18432
  ds_read_b64_tr_b16 a[76:77], v146 offset:18496
  ds_read_b64_tr_b16 a[78:79], v147 offset:18496
  s_waitcnt lgkmcnt(0)
  s_add_u32 m0, s28, 16384
  s_nop 0
  buffer_load_dwordx4 v144, s[8:11], s17 offen lds
  s_add_u32 s17, s17, s29
  s_add_u32 m0, s28, 17408
  s_nop 0
  buffer_load_dwordx4 v144, s[8:11], s17 offen lds
  s_add_u32 s17, s17, s29
  s_add_u32 m0, s28, 18432
  s_nop 0
  buffer_load_dwordx4 v144, s[8:11], s17 offen lds
  s_add_u32 s17, s17, s29
  s_add_u32 m0, s28, 19456
  s_nop 0
  buffer_load_dwordx4 v144, s[8:11], s17 offen lds
  s_add_u32 s17, s17, s29
  s_waitcnt vmcnt(28)
  ds_read_b64_tr_b16 a[80:81], v146 offset:20480
  ds_read_b64_tr_b16 a[82:83], v147 offset:20480
  ds_read_b64_tr_b16 a[84:85], v146 offset:20544
  ds_read_b64_tr_b16 a[86:87], v147 offset:20544
  ds_read_b64_tr_b16 a[88:89], v146 offset:22528
  ds_read_b64_tr_b16 a[90:91], v147 offset:22528
  ds_read_b64_tr_b16 a[92:93], v146 offset:22592
  ds_read_b64_tr_b16 a[94:95], v147 offset:22592
  s_waitcnt lgkmcnt(0)
  s_add_u32 m0, s28, 20480
  s_nop 0
  buffer_load_dwordx4 v144, s[8:11], s17 offen lds
  s_add_u32 s17, s17, s29
  s_add_u32 m0, s28, 21504
  s_nop 0
  buffer_load_dwordx4 v144, s[8:11], s17 offen lds
  s_add_u32 s17, s17, s29
  s_add_u32 m0, s28, 22528
  s_nop 0
  buffer_load_dwordx4 v144, s[8:11], s17 offen lds
  s_add_u32 s17, s17, s29
  s_add_u32 m0, s28, 23552
  s_nop 0
  buffer_load_dwordx4 v144, s[8:11], s17 offen lds
  s_add_u32 s17, s17, s29
  s_waitcnt vmcnt(28)
  ds_read_b64_tr_b16 a[96:97], v146 offset:24576
  ds_read_b64_tr_b16 a[98:99], v147 offset:24576
  ds_read_b64_tr_b16 a[100:101], v146 offset:24640
  ds_read_b64_tr_b16 a[102:103], v147 offset:24640
  ds_read_b64_tr_b16 a[104:105], v146 offset:26624
  ds_read_b64_tr_b16 a[106:107], v147 offset:26624
  ds_read_b64_tr_b16 a[108:109], v146 offset:26688
  ds_read_b64_tr_b16 a[110:111], v147 offset:26688
  s_waitcnt lgkmcnt(0)
  s_add_u32 m0, s28, 24576
  s_nop 0
  buffer_load_dwordx4 v144, s[8:11], s17 offen lds
  s_add_u32 s17, s17, s29
  s_add_u32 m0, s28, 25600
  s_nop 0
  buffer_load_dwordx4 v144, s[8:11], s17 offen lds
  s_add_u32 s17, s17, s29
  s_add_u32 m0, s28, 26624
  s_nop 0
  buffer_load_dwordx4 v144, s[8:11], s17 offen lds
  s_add_u32 s17, s17, s29
  s_add_u32 m0, s28, 27648
  s_nop 0
  buffer_load_dwordx4 v144, s[8:11], s17 offen lds
  s_add_u32 s17, s17, s29
  s_waitcnt vmcnt(28)
  ds_read_b64_tr_b16 a[112:113], v146 offset:28672
  ds_read_b64_tr_b16 a[114:115], v147 offset:28672
  ds_read_b64_tr_b16 a[116:117], v146 offset:28736
  ds_read_b64_tr_b16 a[118:119], v147 offset:28736
  ds_read_b64_tr_b16 a[120:121], v146 offset:30720
  ds_read_b64_tr_b16 a[122:123], v147 offset:30720
  ds_read_b64_tr_b16 a[124:125], v146 offset:30784
  ds_read_b64_tr_b16 a[126:127], v147 offset:30784
  s_waitcnt lgkmcnt(0)
  s_add_u32 m0, s28, 28672
  s_nop 0
  buffer_load_dwordx4 v144, s[8:11], s17 offen lds
  s_add_u32 s17, s17, s29
  s_add_u32 m0, s28, 29696
  s_nop 0
  buffer_load_dwordx4 v144, s[8:11], s17 offen lds
  s_add_u32 s17, s17, s29
  s_add_u32 m0, s28, 30720
  s_nop 0
  buffer_load_dwordx4 v144, s[8:11], s17 offen lds
  s_add_u32 s17, s17, s29
  s_add_u32 m0, s28, 31744
  s_nop 0
  buffer_load_dwordx4 v144, s[8:11], s17 offen lds
  s_add_u32 s17, s17, s29
  s_waitcnt vmcnt(28)
  ds_read_b64_tr_b16 a[128:129], v146 offset:0
  ds_read_b64_tr_b16 a[130:131], v147 offset:0
  ds_read_b64_tr_b16 a[132:133], v146 offset:64
  ds_read_b64_tr_b16 a[134:135], v147 offset:64
  ds_read_b64_tr_b16 a[136:137], v146 offset:2048
  ds_read_b64_tr_b16 a[138:139], v147 offset:2048
  ds_read_b64_tr_b16 a[140:141], v146 offset:2112
  ds_read_b64_tr_b16 a[142:143], v147 offset:2112
  s_waitcnt lgkmcnt(0)
  s_waitcnt vmcnt(24)
  ds_read_b64_tr_b16 a[144:145], v146 offset:4096
  ds_read_b64_tr_b16 a[146:147], v147 offset:4096
  ds_read_b64_tr_b16 a[148:149], v146 offset:4160
  ds_read_b64_tr_b16 a[150:151], v147 offset:4160
  ds_read_b64_tr_b16 a[152:153], v146 offset:6144
  ds_read_b64_tr_b16 a[154:155], v147 offset:6144
  ds_read_b64_tr_b16 a[156:157], v146 offset:6208
  ds_read_b64_tr_b16 a[158:159], v147 offset:6208
  s_waitcnt lgkmcnt(0)
  s_waitcnt vmcnt(20)
  ds_read_b64_tr_b16 a[160:161], v146 offset:8192
  ds_read_b64_tr_b16 a[162:163], v147 offset:8192
  ds_read_b64_tr_b16 a[164:165], v146 offset:8256
  ds_read_b64_tr_b16 a[166:167], v147 offset:8256
  ds_read_b64_tr_b16 a[168:169], v146 offset:10240
  ds_read_b64_tr_b16 a[170:171], v147 offset:10240
  ds_read_b64_tr_b16 a[172:173], v146 offset:10304
  ds_read_b64_tr_b16 a[174:175], v147 offset:10304
  s_waitcnt lgkmcnt(0)
  s_waitcnt vmcnt(16)
  ds_read_b64_tr_b16 a[176:177], v146 offset:12288
  ds_read_b64_tr_b16 a[178:179], v147 offset:12288
  ds_read_b64_tr_b16 a[180:181], v146 offset:12352
  ds_read_b64_tr_b16 a[182:183], v147 offset:12352
  ds_read_b64_tr_b16 a[184:185], v146 offset:14336
  ds_read_b64_tr_b16 a[186:187], v147 offset:14336
  ds_read_b64_tr_b16 a[188:189], v146 offset:14400
  ds_read_b64_tr_b16 a[190:191], v147 offset:14400
  s_waitcnt lgkmcnt(0)
  s_waitcnt vmcnt(12)
  ds_read_b64_tr_b16 a[192:193], v146 offset:16384
  ds_read_b64_tr_b16 a[194:195], v147 offset:16384
  ds_read_b64_tr_b16 a[196:197], v146 offset:16448
  ds_read_b64_tr_b16 a[198:199], v147 offset:16448
  ds_read_b64_tr_b16 a[200:201], v146 offset:18432
  ds_read_b64_tr_b16 a[202:203], v147 offset:18432
  ds_read_b64_tr_b16 a[204:205], v146 offset:18496
  ds_read_b64_tr_b16 a[206:207], v147 offset:18496
  s_waitcnt lgkmcnt(0)
  s_waitcnt vmcnt(8)
  ds_read_b64_tr_b16 a[208:209], v146 offset:20480
  ds_read_b64_tr_b16 a[210:211], v147 offset:20480
  ds_read_b64_tr_b16 a[212:213], v146 offset:20544
  ds_read_b64_tr_b16 a[214:215], v147 offset:20544
  ds_read_b64_tr_b16 a[216:217], v146 offset:22528
  ds_read_b64_tr_b16 a[218:219], v147 offset:22528
  ds_read_b64_tr_b16 a[220:221], v146 offset:22592
  ds_read_b64_tr_b16 a[222:223], v147 offset:22592
  s_waitcnt lgkmcnt(0)
  s_waitcnt vmcnt(4)
  ds_read_b64_tr_b16 a[224:225], v146 offset:24576
  ds_read_b64_tr_b16 a[226:227], v147 offset:24576
  ds_read_b64_tr_b16 a[228:229], v146 offset:24640
  ds_read_b64_tr_b16 a[230:231], v147 offset:24640
  ds_read_b64_tr_b16 a[232:233], v146 offset:26624
  ds_read_b64_tr_b16 a[234:235], v147 offset:26624
  ds_read_b64_tr_b16 a[236:237], v146 offset:26688
  ds_read_b64_tr_b16 a[238:239], v147 offset:26688
  s_waitcnt lgkmcnt(0)
  s_waitcnt vmcnt(0)
  ds_read_b64_tr_b16 a[240:241], v146 offset:28672
  ds_read_b64_tr_b16 a[242:243], v147 offset:28672
  ds_read_b64_tr_b16 a[244:245], v146 offset:28736
  ds_read_b64_tr_b16 a[246:247], v147 offset:28736
  ds_read_b64_tr_b16 a[248:249], v146 offset:30720
  ds_read_b64_tr_b16 a[250:251], v147 offset:30720
  ds_read_b64_tr_b16 a[252:253], v146 offset:30784
  ds_read_b64_tr_b16 a[254:255], v147 offset:30784
  s_waitcnt lgkmcnt(0)
  s_lshl_b32 s26, s40, 2
  s_add_u32 s26, s26, s16
  s_lshl_b32 s27, s26, 6
  s_add_u32 s27, s27, s42
  s_lshl_b32 s19, s27, 13
  s_lshl_b32 s27, s42, 5
  s_add_u32 s27, s27, s26
  s_mul_i32 s27, s27, 4608
  s_add_u32 s20, s27, 134217728
  s_lshl_b32 s25, s16, 12
  s_add_u32 s25, s25, 65536
  s_lshl_b32 s26, s16, 13
  v_add_u32 v3, s26, v2
  v_lshrrev_b32 v16, 5, v1
  v_and_b32 v17, 31, v1
  v_mul_u32_u24 v18, 1152, v16
  v_lshl_add_u32 v5, v17, 3, v18
  v_bfe_u32 v18, v1, 2, 2
  v_lshl_add_u32 v18, v16, 2, v18
  v_and_b32 v19, 1, v1
  v_mul_u32_u24 v19, 1152, v19
  v_lshl_add_u32 v18, v18, 3, v19
  v_add_u32 v4, s25, v18
  v_lshlrev_b32 v16, 2, v16
  v_sub_u32 v17, v17, v16
  v_mov_b32 v18, 0xf149f2ca
  v_cmp_le_i32 vcc, 0, v17
  s_nop 1
  v_cndmask_b32 v240, v18, 0, vcc
  v_cmp_le_i32 vcc, 1, v17
  s_nop 1
  v_cndmask_b32 v241, v18, 0, vcc
  v_cmp_le_i32 vcc, 2, v17
  s_nop 1
  v_cndmask_b32 v242, v18, 0, vcc
  v_cmp_le_i32 vcc, 3, v17
  s_nop 1
  v_cndmask_b32 v243, v18, 0, vcc
  v_cmp_le_i32 vcc, 8, v17
  s_nop 1
  v_cndmask_b32 v244, v18, 0, vcc
  v_cmp_le_i32 vcc, 9, v17
  s_nop 1
  v_cndmask_b32 v245, v18, 0, vcc
  v_cmp_le_i32 vcc, 10, v17
  s_nop 1
  v_cndmask_b32 v246, v18, 0, vcc
  v_cmp_le_i32 vcc, 11, v17
  s_nop 1
  v_cndmask_b32 v247, v18, 0, vcc
  v_cmp_le_i32 vcc, 16, v17
  s_nop 1
  v_cndmask_b32 v248, v18, 0, vcc
  v_cmp_le_i32 vcc, 17, v17
  s_nop 1
  v_cndmask_b32 v249, v18, 0, vcc
  v_cmp_le_i32 vcc, 18, v17
  s_nop 1
  v_cndmask_b32 v250, v18, 0, vcc
  v_cmp_le_i32 vcc, 19, v17
  s_nop 1
  v_cndmask_b32 v251, v18, 0, vcc
  v_cmp_le_i32 vcc, 24, v17
  s_nop 1
  v_cndmask_b32 v252, v18, 0, vcc
  v_cmp_le_i32 vcc, 25, v17
  s_nop 1
  v_cndmask_b32 v253, v18, 0, vcc
  v_cmp_le_i32 vcc, 26, v17
  s_nop 1
  v_cndmask_b32 v254, v18, 0, vcc
  v_cmp_le_i32 vcc, 27, v17
  s_nop 1
  v_cndmask_b32 v255, v18, 0, vcc
  s_barrier
  s_add_u32 s28, s19, 50331648
  buffer_load_dwordx4 v[144:147], v2, s[4:7], s28 offen offset:0
  buffer_load_dwordx4 v[148:151], v2, s[4:7], s28 offen offset:1024
  buffer_load_dwordx4 v[152:155], v2, s[4:7], s28 offen offset:2048
  buffer_load_dwordx4 v[156:159], v2, s[4:7], s28 offen offset:3072
  s_add_u32 s29, s19, 50335744
  buffer_load_dwordx4 v[160:163], v2, s[4:7], s29 offen offset:0
  buffer_load_dwordx4 v[164:167], v2, s[4:7], s29 offen offset:1024
  buffer_load_dwordx4 v[168:171], v2, s[4:7], s29 offen offset:2048
  buffer_load_dwordx4 v[172:175], v2, s[4:7], s29 offen offset:3072
  s_add_u32 s28, s19, 67108864
  buffer_load_dwordx4 v[176:179], v2, s[4:7], s28 offen offset:0
  buffer_load_dwordx4 v[180:183], v2, s[4:7], s28 offen offset:1024
  buffer_load_dwordx4 v[184:187], v2, s[4:7], s28 offen offset:2048
  buffer_load_dwordx4 v[188:191], v2, s[4:7], s28 offen offset:3072
  s_add_u32 s29, s19, 67112960
  buffer_load_dwordx4 v[192:195], v2, s[4:7], s29 offen offset:0
  buffer_load_dwordx4 v[196:199], v2, s[4:7], s29 offen offset:1024
  buffer_load_dwordx4 v[200:203], v2, s[4:7], s29 offen offset:2048
  buffer_load_dwordx4 v[204:207], v2, s[4:7], s29 offen offset:3072
  s_add_u32 s28, s19, 83886080
  buffer_load_dwordx4 v[208:211], v2, s[4:7], s28 offen offset:0
  buffer_load_dwordx4 v[212:215], v2, s[4:7], s28 offen offset:1024
  buffer_load_dwordx4 v[216:219], v2, s[4:7], s28 offen offset:2048
  buffer_load_dwordx4 v[220:223], v2, s[4:7], s28 offen offset:3072
  s_add_u32 s29, s19, 83890176
  buffer_load_dwordx4 v[224:227], v2, s[4:7], s29 offen offset:0
  buffer_load_dwordx4 v[228:231], v2, s[4:7], s29 offen offset:1024
  buffer_load_dwordx4 v[232:235], v2, s[4:7], s29 offen offset:2048
  buffer_load_dwordx4 v[236:239], v2, s[4:7], s29 offen offset:3072
  s_waitcnt vmcnt(0)
F_top_57:
  s_waitcnt vmcnt(12)
  v_mfma_f32_32x32x16_bf16 v[24:39], v[176:179], v[144:147], v[240:255]
  v_mfma_f32_32x32x16_bf16 v[24:39], v[180:183], v[148:151], v[24:39]
  v_mfma_f32_32x32x16_bf16 v[24:39], v[184:187], v[152:155], v[24:39]
  v_mfma_f32_32x32x16_bf16 v[24:39], v[188:191], v[156:159], v[24:39]
  v_mfma_f32_32x32x16_bf16 v[24:39], v[192:195], v[160:163], v[24:39]
  v_mfma_f32_32x32x16_bf16 v[24:39], v[196:199], v[164:167], v[24:39]
  v_mfma_f32_32x32x16_bf16 v[24:39], v[200:203], v[168:171], v[24:39]
  v_mfma_f32_32x32x16_bf16 v[24:39], v[204:207], v[172:175], v[24:39]
  s_mov_b32 m0, s25
  s_nop 0
  buffer_load_dwordx4 v2, s[4:7], s20 offen offset:0 lds
  buffer_load_dwordx4 v2, s[4:7], s20 offen offset:1152 lds
  buffer_load_dwordx2 v[56:57], v5, s[4:7], s20 offen offset:2304
  buffer_load_dwordx2 v[58:59], v5, s[4:7], s20 offen offset:2560
  buffer_load_dwordx2 v[60:61], v5, s[4:7], s20 offen offset:2816
  buffer_load_dwordx2 v[62:63], v5, s[4:7], s20 offen offset:3072
  s_nop 3
  v_max_f32 v6, v24, v25
  v_max3_f32 v6, v6, v26, v27
  v_max3_f32 v6, v6, v28, v29
  v_max3_f32 v6, v6, v30, v31
  v_max3_f32 v6, v6, v32, v33
  v_max3_f32 v6, v6, v34, v35
  v_max3_f32 v6, v6, v36, v37
  v_max3_f32 v6, v6, v38, v39
  s_waitcnt vmcnt(4)
  ds_read_b64_tr_b16 v[176:177], v4 offset:0
  ds_read_b64_tr_b16 v[178:179], v4 offset:64
  ds_read_b64_tr_b16 v[180:181], v4 offset:128
  ds_read_b64_tr_b16 v[182:183], v4 offset:192
  ds_read_b64_tr_b16 v[184:185], v4 offset:256
  ds_read_b64_tr_b16 v[186:187], v4 offset:320
  ds_read_b64_tr_b16 v[188:189], v4 offset:384
  ds_read_b64_tr_b16 v[190:191], v4 offset:448
  ds_read_b64_tr_b16 v[192:193], v4 offset:512
  ds_read_b64_tr_b16 v[194:195], v4 offset:576
  ds_read_b64_tr_b16 v[196:197], v4 offset:640
  ds_read_b64_tr_b16 v[198:199], v4 offset:704
  ds_read_b64_tr_b16 v[200:201], v4 offset:768
  ds_read_b64_tr_b16 v[202:203], v4 offset:832
  ds_read_b64_tr_b16 v[204:205], v4 offset:896
  ds_read_b64_tr_b16 v[206:207], v4 offset:960
  s_waitcnt lgkmcnt(14)
  v_mfma_f32_32x32x16_bf16 v[40:55], v[176:179], v[144:147], 0
  s_waitcnt lgkmcnt(12)
  v_mfma_f32_32x32x16_bf16 v[40:55], v[180:183], v[148:151], v[40:55]
  s_waitcnt lgkmcnt(10)
  v_mfma_f32_32x32x16_bf16 v[40:55], v[184:187], v[152:155], v[40:55]
  s_waitcnt lgkmcnt(8)
  v_mfma_f32_32x32x16_bf16 v[40:55], v[188:191], v[156:159], v[40:55]
  s_waitcnt lgkmcnt(6)
  v_mfma_f32_32x32x16_bf16 v[40:55], v[192:195], v[160:163], v[40:55]
  s_waitcnt lgkmcnt(4)
  v_mfma_f32_32x32x16_bf16 v[40:55], v[196:199], v[164:167], v[40:55]
  s_waitcnt lgkmcnt(2)
  v_mfma_f32_32x32x16_bf16 v[40:55], v[200:203], v[168:171], v[40:55]
  s_waitcnt lgkmcnt(0)
  v_mfma_f32_32x32x16_bf16 v[40:55], v[204:207], v[172:175], v[40:55]
  s_nop 7
  s_nop 3
  v_max3_f32 v6, v6, v40, v41
  v_max3_f32 v6, v6, v42, v43
  v_mov_b32 v16, v6
  s_nop 1
  v_permlane32_swap_b32 v6, v16
  s_nop 1
  v_max_f32 v6, v6, v16
  v_sub_f32 v40, v40, v6
  v_sub_f32 v41, v41, v6
  v_sub_f32 v42, v42, v6
  v_sub_f32 v43, v43, v6
  v_exp_f32 v40, v40
  v_exp_f32 v41, v41
  v_exp_f32 v42, v42
  v_exp_f32 v43, v43
  v_cvt_pk_bf16_f32 v136, v40, v41
  v_cvt_pk_bf16_f32 v137, v42, v43
  s_waitcnt vmcnt(0)
  v_sub_f32 v24, v24, v6
  v_mfma_f32_32x32x8_bf16 v[64:79], v[56:57], v[136:137], 0
  v_sub_f32 v25, v25, v6
  v_sub_f32 v26, v26, v6
  v_sub_f32 v27, v27, v6
  v_sub_f32 v28, v28, v6
  v_sub_f32 v29, v29, v6
  v_mfma_f32_32x32x8_bf16 v[80:95], v[58:59], v[136:137], 0
  v_sub_f32 v30, v30, v6
  v_sub_f32 v31, v31, v6
  v_exp_f32 v24, v24
  v_exp_f32 v25, v25
  v_exp_f32 v26, v26
  v_mfma_f32_32x32x8_bf16 v[96:111], v[60:61], v[136:137], 0
  v_exp_f32 v27, v27
  v_exp_f32 v28, v28
  v_exp_f32 v29, v29
  v_exp_f32 v30, v30
  v_exp_f32 v31, v31
  v_mfma_f32_32x32x8_bf16 v[112:127], v[62:63], v[136:137], 0
  v_cvt_pk_bf16_f32 v128, v24, v25
  v_cvt_pk_bf16_f32 v129, v26, v27
  v_cvt_pk_bf16_f32 v130, v28, v29
  v_cvt_pk_bf16_f32 v131, v30, v31
  v_sub_f32 v32, v32, v6
  v_sub_f32 v33, v33, v6
  v_mfma_f32_32x32x16_bf16 v[64:79], v[208:211], v[128:131], v[64:79]
  v_sub_f32 v34, v34, v6
  v_sub_f32 v35, v35, v6
  v_sub_f32 v36, v36, v6
  v_sub_f32 v37, v37, v6
  v_sub_f32 v38, v38, v6
  v_mfma_f32_32x32x16_bf16 v[80:95], v[216:219], v[128:131], v[80:95]
  v_sub_f32 v39, v39, v6
  v_exp_f32 v32, v32
  v_exp_f32 v33, v33
  v_exp_f32 v34, v34
  v_exp_f32 v35, v35
  v_mfma_f32_32x32x16_bf16 v[96:111], v[224:227], v[128:131], v[96:111]
  v_exp_f32 v36, v36
  v_exp_f32 v37, v37
  v_exp_f32 v38, v38
  v_exp_f32 v39, v39
  v_cvt_pk_bf16_f32 v132, v32, v33
  v_mfma_f32_32x32x16_bf16 v[112:127], v[232:235], v[128:131], v[112:127]
  v_cvt_pk_bf16_f32 v133, v34, v35
  v_cvt_pk_bf16_f32 v134, v36, v37
  v_cvt_pk_bf16_f32 v135, v38, v39
  v_add_f32 v7, v40, v41
  v_add_f32 v7, v7, v42
  v_mfma_f32_32x32x16_bf16 v[64:79], v[212:215], v[132:135], v[64:79]
  v_add_f32 v7, v7, v43
  v_add_f32 v7, v7, v24
  v_add_f32 v7, v7, v25
  v_add_f32 v7, v7, v26
  v_add_f32 v7, v7, v27
  v_mfma_f32_32x32x16_bf16 v[80:95], v[220:223], v[132:135], v[80:95]
  v_add_f32 v7, v7, v28
  v_add_f32 v7, v7, v29
  v_add_f32 v7, v7, v30
  v_add_f32 v7, v7, v31
  v_add_f32 v7, v7, v32
  v_mfma_f32_32x32x16_bf16 v[96:111], v[228:231], v[132:135], v[96:111]
  v_add_f32 v7, v7, v33
  v_add_f32 v7, v7, v34
  v_add_f32 v7, v7, v35
  v_add_f32 v7, v7, v36
  v_add_f32 v7, v7, v37
  v_mfma_f32_32x32x16_bf16 v[112:127], v[236:239], v[132:135], v[112:127]
  v_add_f32 v7, v7, v38
  v_add_f32 v7, v7, v39
  v_mov_b32 v16, v7
  s_nop 1
  v_permlane32_swap_b32 v7, v16
  s_nop 1
  v_add_f32 v7, v7, v16
  v_rcp_f32 v6, v7
  s_nop 0
  v_pk_mul_f32 v[64:65], v[64:65], v[6:7] op_sel_hi:[1,0]
  v_pk_mul_f32 v[66:67], v[66:67], v[6:7] op_sel_hi:[1,0]
  v_pk_mul_f32 v[68:69], v[68:69], v[6:7] op_sel_hi:[1,0]
  v_pk_mul_f32 v[70:71], v[70:71], v[6:7] op_sel_hi:[1,0]
  v_cvt_pk_bf16_f32 v128, v64, v65
  v_cvt_pk_bf16_f32 v129, v66, v67
  v_cvt_pk_bf16_f32 v130, v68, v69
  v_cvt_pk_bf16_f32 v131, v70, v71
  ds_write_b128 v3, v[128:131] offset:0
  v_pk_mul_f32 v[72:73], v[72:73], v[6:7] op_sel_hi:[1,0]
  v_pk_mul_f32 v[74:75], v[74:75], v[6:7] op_sel_hi:[1,0]
  v_pk_mul_f32 v[76:77], v[76:77], v[6:7] op_sel_hi:[1,0]
  v_pk_mul_f32 v[78:79], v[78:79], v[6:7] op_sel_hi:[1,0]
  v_cvt_pk_bf16_f32 v132, v72, v73
  v_cvt_pk_bf16_f32 v133, v74, v75
  v_cvt_pk_bf16_f32 v134, v76, v77
  v_cvt_pk_bf16_f32 v135, v78, v79
  ds_write_b128 v3, v[132:135] offset:1024
  v_pk_mul_f32 v[80:81], v[80:81], v[6:7] op_sel_hi:[1,0]
  v_pk_mul_f32 v[82:83], v[82:83], v[6:7] op_sel_hi:[1,0]
  v_pk_mul_f32 v[84:85], v[84:85], v[6:7] op_sel_hi:[1,0]
  v_pk_mul_f32 v[86:87], v[86:87], v[6:7] op_sel_hi:[1,0]
  v_cvt_pk_bf16_f32 v136, v80, v81
  v_cvt_pk_bf16_f32 v137, v82, v83
  v_cvt_pk_bf16_f32 v138, v84, v85
  v_cvt_pk_bf16_f32 v139, v86, v87
  ds_write_b128 v3, v[136:139] offset:2048
  v_pk_mul_f32 v[88:89], v[88:89], v[6:7] op_sel_hi:[1,0]
  v_pk_mul_f32 v[90:91], v[90:91], v[6:7] op_sel_hi:[1,0]
  v_pk_mul_f32 v[92:93], v[92:93], v[6:7] op_sel_hi:[1,0]
  v_pk_mul_f32 v[94:95], v[94:95], v[6:7] op_sel_hi:[1,0]
  v_cvt_pk_bf16_f32 v140, v88, v89
  v_cvt_pk_bf16_f32 v141, v90, v91
  v_cvt_pk_bf16_f32 v142, v92, v93
  v_cvt_pk_bf16_f32 v143, v94, v95
  ds_write_b128 v3, v[140:143] offset:3072
  v_pk_mul_f32 v[96:97], v[96:97], v[6:7] op_sel_hi:[1,0]
  v_pk_mul_f32 v[98:99], v[98:99], v[6:7] op_sel_hi:[1,0]
  v_pk_mul_f32 v[100:101], v[100:101], v[6:7] op_sel_hi:[1,0]
  v_pk_mul_f32 v[102:103], v[102:103], v[6:7] op_sel_hi:[1,0]
  v_cvt_pk_bf16_f32 v128, v96, v97
  v_cvt_pk_bf16_f32 v129, v98, v99
  v_cvt_pk_bf16_f32 v130, v100, v101
  v_cvt_pk_bf16_f32 v131, v102, v103
  ds_write_b128 v3, v[128:131] offset:4096
  v_pk_mul_f32 v[104:105], v[104:105], v[6:7] op_sel_hi:[1,0]
  v_pk_mul_f32 v[106:107], v[106:107], v[6:7] op_sel_hi:[1,0]
  v_pk_mul_f32 v[108:109], v[108:109], v[6:7] op_sel_hi:[1,0]
  v_pk_mul_f32 v[110:111], v[110:111], v[6:7] op_sel_hi:[1,0]
  v_cvt_pk_bf16_f32 v132, v104, v105
  v_cvt_pk_bf16_f32 v133, v106, v107
  v_cvt_pk_bf16_f32 v134, v108, v109
  v_cvt_pk_bf16_f32 v135, v110, v111
  ds_write_b128 v3, v[132:135] offset:5120
  v_pk_mul_f32 v[112:113], v[112:113], v[6:7] op_sel_hi:[1,0]
  v_pk_mul_f32 v[114:115], v[114:115], v[6:7] op_sel_hi:[1,0]
  v_pk_mul_f32 v[116:117], v[116:117], v[6:7] op_sel_hi:[1,0]
  v_pk_mul_f32 v[118:119], v[118:119], v[6:7] op_sel_hi:[1,0]
  v_cvt_pk_bf16_f32 v136, v112, v113
  v_cvt_pk_bf16_f32 v137, v114, v115
  v_cvt_pk_bf16_f32 v138, v116, v117
  v_cvt_pk_bf16_f32 v139, v118, v119
  ds_write_b128 v3, v[136:139] offset:6144
  v_pk_mul_f32 v[120:121], v[120:121], v[6:7] op_sel_hi:[1,0]
  v_pk_mul_f32 v[122:123], v[122:123], v[6:7] op_sel_hi:[1,0]
  v_pk_mul_f32 v[124:125], v[124:125], v[6:7] op_sel_hi:[1,0]
  v_pk_mul_f32 v[126:127], v[126:127], v[6:7] op_sel_hi:[1,0]
  v_cvt_pk_bf16_f32 v140, v120, v121
  v_cvt_pk_bf16_f32 v141, v122, v123
  v_cvt_pk_bf16_f32 v142, v124, v125
  v_cvt_pk_bf16_f32 v143, v126, v127
  ds_write_b128 v3, v[140:143] offset:7168
  s_sub_u32 s23, s23, 1
  s_cmp_gt_u32 s23, 0
  s_cselect_b32 s26, s43, 0
  s_lshl_b32 s27, s26, 13
  s_add_u32 s19, s19, s27
  s_mul_i32 s27, s26, 147456
  s_add_u32 s20, s20, s27
  s_waitcnt lgkmcnt(0)
  s_barrier
  ds_read_b128 v[24:27], v8 offset:0
  ds_read_b128 v[28:31], v9 offset:0
  ds_read_b128 v[32:35], v10 offset:0
  ds_read_b128 v[36:39], v11 offset:0
  ds_read_b128 v[40:43], v12 offset:0
  ds_read_b128 v[44:47], v13 offset:0
  s_waitcnt lgkmcnt(5)
  v_mfma_f32_32x32x16_bf16 v[64:79], a[0:3], v[24:27], 0
  s_add_u32 s28, s19, 50331648
  ds_read_b128 v[48:51], v14 offset:0
  v_mfma_f32_32x32x16_bf16 v[80:95], a[4:7], v[24:27], 0
  s_waitcnt lgkmcnt(5)
  buffer_load_dwordx4 v[144:147], v2, s[4:7], s28 offen offset:0
  v_mfma_f32_32x32x16_bf16 v[64:79], a[8:11], v[28:31], v[64:79]
  ds_read_b128 v[52:55], v15 offset:0
  v_mfma_f32_32x32x16_bf16 v[80:95], a[12:15], v[28:31], v[80:95]
  s_waitcnt lgkmcnt(5)
  buffer_load_dwordx4 v[148:151], v2, s[4:7], s28 offen offset:1024
  v_mfma_f32_32x32x16_bf16 v[64:79], a[16:19], v[32:35], v[64:79]
  ds_read_b128 v[24:27], v8 offset:8192
  v_mfma_f32_32x32x16_bf16 v[80:95], a[20:23], v[32:35], v[80:95]
  s_waitcnt lgkmcnt(5)
  buffer_load_dwordx4 v[152:155], v2, s[4:7], s28 offen offset:2048
  v_mfma_f32_32x32x16_bf16 v[64:79], a[24:27], v[36:39], v[64:79]
  ds_read_b128 v[28:31], v9 offset:8192
  v_mfma_f32_32x32x16_bf16 v[80:95], a[28:31], v[36:39], v[80:95]
  s_waitcnt lgkmcnt(5)
  buffer_load_dwordx4 v[156:159], v2, s[4:7], s28 offen offset:3072
  v_mfma_f32_32x32x16_bf16 v[64:79], a[32:35], v[40:43], v[64:79]
  s_add_u32 s29, s19, 50335744
  ds_read_b128 v[32:35], v10 offset:8192
  v_mfma_f32_32x32x16_bf16 v[80:95], a[36:39], v[40:43], v[80:95]
  s_waitcnt lgkmcnt(5)
  buffer_load_dwordx4 v[160:163], v2, s[4:7], s29 offen offset:0
  v_mfma_f32_32x32x16_bf16 v[64:79], a[40:43], v[44:47], v[64:79]
  ds_read_b128 v[36:39], v11 offset:8192
  v_mfma_f32_32x32x16_bf16 v[80:95], a[44:47], v[44:47], v[80:95]
  s_waitcnt lgkmcnt(5)
  buffer_load_dwordx4 v[164:167], v2, s[4:7], s29 offen offset:1024
  v_mfma_f32_32x32x16_bf16 v[64:79], a[48:51], v[48:51], v[64:79]
  ds_read_b128 v[40:43], v12 offset:8192
  v_mfma_f32_32x32x16_bf16 v[80:95], a[52:55], v[48:51], v[80:95]
  s_waitcnt lgkmcnt(5)
  buffer_load_dwordx4 v[168:171], v2, s[4:7], s29 offen offset:2048
  v_mfma_f32_32x32x16_bf16 v[64:79], a[56:59], v[52:55], v[64:79]
  ds_read_b128 v[44:47], v13 offset:8192
  v_mfma_f32_32x32x16_bf16 v[80:95], a[60:63], v[52:55], v[80:95]
  s_waitcnt lgkmcnt(5)
  buffer_load_dwordx4 v[172:175], v2, s[4:7], s29 offen offset:3072
  v_mfma_f32_32x32x16_bf16 v[64:79], a[64:67], v[24:27], v[64:79]
  s_add_u32 s28, s19, 67108864
  ds_read_b128 v[48:51], v14 offset:8192
  v_mfma_f32_32x32x16_bf16 v[80:95], a[68:71], v[24:27], v[80:95]
  s_waitcnt lgkmcnt(5)
  buffer_load_dwordx4 v[176:179], v2, s[4:7], s28 offen offset:0
  v_mfma_f32_32x32x16_bf16 v[64:79], a[72:75], v[28:31], v[64:79]
  ds_read_b128 v[52:55], v15 offset:8192
  v_mfma_f32_32x32x16_bf16 v[80:95], a[76:79], v[28:31], v[80:95]
  s_waitcnt lgkmcnt(5)
  buffer_load_dwordx4 v[180:183], v2, s[4:7], s28 offen offset:1024
  v_mfma_f32_32x32x16_bf16 v[64:79], a[80:83], v[32:35], v[64:79]
  ds_read_b128 v[24:27], v8 offset:16384
  v_mfma_f32_32x32x16_bf16 v[80:95], a[84:87], v[32:35], v[80:95]
  s_waitcnt lgkmcnt(5)
  buffer_load_dwordx4 v[184:187], v2, s[4:7], s28 offen offset:2048
  v_mfma_f32_32x32x16_bf16 v[64:79], a[88:91], v[36:39], v[64:79]
  ds_read_b128 v[28:31], v9 offset:16384
  v_mfma_f32_32x32x16_bf16 v[80:95], a[92:95], v[36:39], v[80:95]
  s_waitcnt lgkmcnt(5)
  buffer_load_dwordx4 v[188:191], v2, s[4:7], s28 offen offset:3072
  v_mfma_f32_32x32x16_bf16 v[64:79], a[96:99], v[40:43], v[64:79]
  s_add_u32 s29, s19, 67112960
  ds_read_b128 v[32:35], v10 offset:16384
  v_mfma_f32_32x32x16_bf16 v[80:95], a[100:103], v[40:43], v[80:95]
  s_waitcnt lgkmcnt(5)
  buffer_load_dwordx4 v[192:195], v2, s[4:7], s29 offen offset:0
  v_mfma_f32_32x32x16_bf16 v[64:79], a[104:107], v[44:47], v[64:79]
  ds_read_b128 v[36:39], v11 offset:16384
  v_mfma_f32_32x32x16_bf16 v[80:95], a[108:111], v[44:47], v[80:95]
  s_waitcnt lgkmcnt(5)
  buffer_load_dwordx4 v[196:199], v2, s[4:7], s29 offen offset:1024
  v_mfma_f32_32x32x16_bf16 v[64:79], a[112:115], v[48:51], v[64:79]
  ds_read_b128 v[40:43], v12 offset:16384
  v_mfma_f32_32x32x16_bf16 v[80:95], a[116:119], v[48:51], v[80:95]
  s_waitcnt lgkmcnt(5)
  buffer_load_dwordx4 v[200:203], v2, s[4:7], s29 offen offset:2048
  v_mfma_f32_32x32x16_bf16 v[64:79], a[120:123], v[52:55], v[64:79]
  ds_read_b128 v[44:47], v13 offset:16384
  v_mfma_f32_32x32x16_bf16 v[80:95], a[124:127], v[52:55], v[80:95]
  s_waitcnt lgkmcnt(5)
  buffer_load_dwordx4 v[204:207], v2, s[4:7], s29 offen offset:3072
  v_mfma_f32_32x32x16_bf16 v[64:79], a[128:131], v[24:27], v[64:79]
  s_add_u32 s28, s19, 83886080
  ds_read_b128 v[48:51], v14 offset:16384
  v_mfma_f32_32x32x16_bf16 v[80:95], a[132:135], v[24:27], v[80:95]
  s_waitcnt lgkmcnt(5)
  buffer_load_dwordx4 v[208:211], v2, s[4:7], s28 offen offset:0
  v_mfma_f32_32x32x16_bf16 v[64:79], a[136:139], v[28:31], v[64:79]
  ds_read_b128 v[52:55], v15 offset:16384
  v_mfma_f32_32x32x16_bf16 v[80:95], a[140:143], v[28:31], v[80:95]
  s_waitcnt lgkmcnt(5)
  buffer_load_dwordx4 v[212:215], v2, s[4:7], s28 offen offset:1024
  v_mfma_f32_32x32x16_bf16 v[64:79], a[144:147], v[32:35], v[64:79]
  ds_read_b128 v[24:27], v8 offset:24576
  v_mfma_f32_32x32x16_bf16 v[80:95], a[148:151], v[32:35], v[80:95]
  s_waitcnt lgkmcnt(5)
  buffer_load_dwordx4 v[216:219], v2, s[4:7], s28 offen offset:2048
  v_mfma_f32_32x32x16_bf16 v[64:79], a[152:155], v[36:39], v[64:79]
  ds_read_b128 v[28:31], v9 offset:24576
  v_mfma_f32_32x32x16_bf16 v[80:95], a[156:159], v[36:39], v[80:95]
  s_waitcnt lgkmcnt(5)
  buffer_load_dwordx4 v[220:223], v2, s[4:7], s28 offen offset:3072
  v_mfma_f32_32x32x16_bf16 v[64:79], a[160:163], v[40:43], v[64:79]
  s_add_u32 s29, s19, 83890176
  ds_read_b128 v[32:35], v10 offset:24576
  v_mfma_f32_32x32x16_bf16 v[80:95], a[164:167], v[40:43], v[80:95]
  s_waitcnt lgkmcnt(5)
  buffer_load_dwordx4 v[224:227], v2, s[4:7], s29 offen offset:0
  v_mfma_f32_32x32x16_bf16 v[64:79], a[168:171], v[44:47], v[64:79]
  ds_read_b128 v[36:39], v11 offset:24576
  v_mfma_f32_32x32x16_bf16 v[80:95], a[172:175], v[44:47], v[80:95]
  s_waitcnt lgkmcnt(5)
  buffer_load_dwordx4 v[228:231], v2, s[4:7], s29 offen offset:1024
  v_mfma_f32_32x32x16_bf16 v[64:79], a[176:179], v[48:51], v[64:79]
  ds_read_b128 v[40:43], v12 offset:24576
  v_mfma_f32_32x32x16_bf16 v[80:95], a[180:183], v[48:51], v[80:95]
  s_waitcnt lgkmcnt(5)
  buffer_load_dwordx4 v[232:235], v2, s[4:7], s29 offen offset:2048
  v_mfma_f32_32x32x16_bf16 v[64:79], a[184:187], v[52:55], v[64:79]
  ds_read_b128 v[44:47], v13 offset:24576
  v_mfma_f32_32x32x16_bf16 v[80:95], a[188:191], v[52:55], v[80:95]
  s_waitcnt lgkmcnt(5)
  buffer_load_dwordx4 v[236:239], v2, s[4:7], s29 offen offset:3072
  v_mfma_f32_32x32x16_bf16 v[64:79], a[192:195], v[24:27], v[64:79]
  ds_read_b128 v[48:51], v14 offset:24576
  v_mfma_f32_32x32x16_bf16 v[80:95], a[196:199], v[24:27], v[80:95]
  s_waitcnt lgkmcnt(5)
  v_mfma_f32_32x32x16_bf16 v[64:79], a[200:203], v[28:31], v[64:79]
  ds_read_b128 v[52:55], v15 offset:24576
  v_mfma_f32_32x32x16_bf16 v[80:95], a[204:207], v[28:31], v[80:95]
  s_waitcnt lgkmcnt(5)
  v_mfma_f32_32x32x16_bf16 v[64:79], a[208:211], v[32:35], v[64:79]
  v_mfma_f32_32x32x16_bf16 v[80:95], a[212:215], v[32:35], v[80:95]
  s_waitcnt lgkmcnt(4)
  v_mfma_f32_32x32x16_bf16 v[64:79], a[216:219], v[36:39], v[64:79]
  v_xor_b32 v8, 0x8000, v8
  v_mfma_f32_32x32x16_bf16 v[80:95], a[220:223], v[36:39], v[80:95]
  s_waitcnt lgkmcnt(3)
  v_xor_b32 v9, 0x8000, v9
  v_mfma_f32_32x32x16_bf16 v[64:79], a[224:227], v[40:43], v[64:79]
  v_xor_b32 v10, 0x8000, v10
  v_mfma_f32_32x32x16_bf16 v[80:95], a[228:231], v[40:43], v[80:95]
  s_waitcnt lgkmcnt(2)
  v_xor_b32 v11, 0x8000, v11
  v_mfma_f32_32x32x16_bf16 v[64:79], a[232:235], v[44:47], v[64:79]
  v_xor_b32 v12, 0x8000, v12
  v_mfma_f32_32x32x16_bf16 v[80:95], a[236:239], v[44:47], v[80:95]
  s_waitcnt lgkmcnt(1)
  v_xor_b32 v13, 0x8000, v13
  v_mfma_f32_32x32x16_bf16 v[64:79], a[240:243], v[48:51], v[64:79]
  v_xor_b32 v14, 0x8000, v14
  v_mfma_f32_32x32x16_bf16 v[80:95], a[244:247], v[48:51], v[80:95]
  s_waitcnt lgkmcnt(0)
  v_xor_b32 v15, 0x8000, v15
  v_mfma_f32_32x32x16_bf16 v[64:79], a[248:251], v[52:55], v[64:79]
  v_xor_b32 v3, 0x8000, v3
  v_mfma_f32_32x32x16_bf16 v[80:95], a[252:255], v[52:55], v[80:95]
  s_nop 4
  v_cvt_pk_bf16_f32 v128, v64, v65
  v_cvt_pk_bf16_f32 v129, v66, v67
  v_cvt_pk_bf16_f32 v130, v68, v69
  v_cvt_pk_bf16_f32 v131, v70, v71
  buffer_store_dwordx4 v[128:131], v2, s[4:7], s21 offen offset:0
  v_cvt_pk_bf16_f32 v132, v72, v73
  v_cvt_pk_bf16_f32 v133, v74, v75
  v_cvt_pk_bf16_f32 v134, v76, v77
  v_cvt_pk_bf16_f32 v135, v78, v79
  buffer_store_dwordx4 v[132:135], v2, s[4:7], s21 offen offset:1024
  s_nop 1
  v_cvt_pk_bf16_f32 v136, v80, v81
  v_cvt_pk_bf16_f32 v137, v82, v83
  v_cvt_pk_bf16_f32 v138, v84, v85
  v_cvt_pk_bf16_f32 v139, v86, v87
  buffer_store_dwordx4 v[136:139], v2, s[4:7], s21 offen offset:2048
  v_cvt_pk_bf16_f32 v140, v88, v89
  v_cvt_pk_bf16_f32 v141, v90, v91
  v_cvt_pk_bf16_f32 v142, v92, v93
  v_cvt_pk_bf16_f32 v143, v94, v95
  buffer_store_dwordx4 v[140:143], v2, s[4:7], s21 offen offset:3072
  s_add_u32 s21, s21, s22
  s_cmp_gt_u32 s23, 0
  s_cbranch_scc1 F_top_57
  s_waitcnt vmcnt(0) lgkmcnt(0)
  s_barrier
K_exit_56:
  s_endpgm
.text
.globl final_kernel
.p2align 8
.type final_kernel,@function
final_kernel:
  s_cmp_ge_u32 s2, 256
  s_cbranch_scc1 K_exit_58
  v_lshrrev_b32 v3, 6, v0
  v_and_b32 v1, 63, v0
  v_readfirstlane_b32 s16, v3
  v_lshlrev_b32 v2, 4, v1
  s_load_dwordx2 s[4:5], s[0:1], 128
  s_waitcnt lgkmcnt(0)
  s_and_b32 s5, s5, 0xffff
  s_mov_b32 s6, 268435456
  s_mov_b32 s7, 0x20000
  s_lshr_b32 s40, s2, 2
  s_and_b32 s41, s2, 3
  s_load_dwordx2 s[8:9], s[0:1], 0
  s_load_dwordx2 s[12:13], s[0:1], 104
  s_load_dwordx2 s[32:33], s[0:1], 112
  v_and_b32 v4, 31, v1
  v_lshrrev_b32 v5, 5, v1
  v_lshlrev_b32 v5, 4, v5
  v_lshl_add_u32 v6, v4, 10, v5
  s_lshl_b32 s26, s16, 8
  s_lshl_b32 s27, s40, 15
  s_add_u32 s27, s27, s26
  s_waitcnt lgkmcnt(0)
  s_and_b32 s9, s9, 0xffff
  s_mov_b32 s10, 2097152
  s_mov_b32 s11, 0x20000
  s_and_b32 s13, s13, 0xffff
  s_mov_b32 s14, 1024
  s_mov_b32 s15, 0x20000
  s_and_b32 s33, s33, 0xffff
  s_mov_b32 s34, 2097152
  s_mov_b32 s35, 0x20000
  buffer_load_dwordx4 v[16:19], v6, s[8:11], s27 offen offset:0
  buffer_load_dwordx4 v[48:51], v5, s[12:15], s26 offen offset:0
  buffer_load_dwordx4 v[20:23], v6, s[8:11], s27 offen offset:32
  buffer_load_dwordx4 v[52:55], v5, s[12:15], s26 offen offset:32
  buffer_load_dwordx4 v[24:27], v6, s[8:11], s27 offen offset:64
  buffer_load_dwordx4 v[56:59], v5, s[12:15], s26 offen offset:64
  buffer_load_dwordx4 v[28:31], v6, s[8:11], s27 offen offset:96
  buffer_load_dwordx4 v[60:63], v5, s[12:15], s26 offen offset:96
  buffer_load_dwordx4 v[32:35], v6, s[8:11], s27 offen offset:128
  buffer_load_dwordx4 v[64:67], v5, s[12:15], s26 offen offset:128
  buffer_load_dwordx4 v[36:39], v6, s[8:11], s27 offen offset:160
  buffer_load_dwordx4 v[68:71], v5, s[12:15], s26 offen offset:160
  buffer_load_dwordx4 v[40:43], v6, s[8:11], s27 offen offset:192
  buffer_load_dwordx4 v[72:75], v5, s[12:15], s26 offen offset:192
  buffer_load_dwordx4 v[44:47], v6, s[8:11], s27 offen offset:224
  buffer_load_dwordx4 v[76:79], v5, s[12:15], s26 offen offset:224
  s_lshl_b32 s28, s40, 2
  s_add_u32 s28, s28, s41
  s_lshl_b32 s28, s28, 2
  s_add_u32 s28, s28, s16
  s_lshl_b32 s28, s28, 11
  s_waitcnt vmcnt(14)
  v_mfma_f32_32x32x16_bf16 v[80:95], v[48:51], v[16:19], 0
  s_waitcnt vmcnt(12)
  v_mfma_f32_32x32x16_bf16 v[80:95], v[52:55], v[20:23], v[80:95]
  s_waitcnt vmcnt(10)
  v_mfma_f32_32x32x16_bf16 v[80:95], v[56:59], v[24:27], v[80:95]
  s_waitcnt vmcnt(8)
  v_mfma_f32_32x32x16_bf16 v[80:95], v[60:63], v[28:31], v[80:95]
  s_waitcnt vmcnt(6)
  v_mfma_f32_32x32x16_bf16 v[80:95], v[64:67], v[32:35], v[80:95]
  s_waitcnt vmcnt(4)
  v_mfma_f32_32x32x16_bf16 v[80:95], v[68:71], v[36:39], v[80:95]
  s_waitcnt vmcnt(2)
  v_mfma_f32_32x32x16_bf16 v[80:95], v[72:75], v[40:43], v[80:95]
  s_waitcnt vmcnt(0)
  v_mfma_f32_32x32x16_bf16 v[80:95], v[76:79], v[44:47], v[80:95]
  s_add_u32 s29, s28, 150994944
  buffer_load_dwordx4 v[96:99], v2, s[4:7], s29 offen offset:0
  buffer_load_dwordx4 v[100:103], v2, s[4:7], s29 offen offset:1024
  s_add_u32 s29, s28, 153092096
  buffer_load_dwordx4 v[104:107], v2, s[4:7], s29 offen offset:0
  buffer_load_dwordx4 v[108:111], v2, s[4:7], s29 offen offset:1024
  s_add_u32 s29, s28, 155189248
  buffer_load_dwordx4 v[112:115], v2, s[4:7], s29 offen offset:0
  buffer_load_dwordx4 v[116:119], v2, s[4:7], s29 offen offset:1024
  s_add_u32 s29, s28, 157286400
  buffer_load_dwordx4 v[120:123], v2, s[4:7], s29 offen offset:0
  buffer_load_dwordx4 v[124:127], v2, s[4:7], s29 offen offset:1024
  s_add_u32 s29, s28, 159383552
  buffer_load_dwordx4 v[128:131], v2, s[4:7], s29 offen offset:0
  buffer_load_dwordx4 v[132:135], v2, s[4:7], s29 offen offset:1024
  s_add_u32 s29, s28, 161480704
  buffer_load_dwordx4 v[136:139], v2, s[4:7], s29 offen offset:0
  buffer_load_dwordx4 v[140:143], v2, s[4:7], s29 offen offset:1024
  s_add_u32 s29, s28, 163577856
  buffer_load_dwordx4 v[144:147], v2, s[4:7], s29 offen offset:0
  buffer_load_dwordx4 v[148:151], v2, s[4:7], s29 offen offset:1024
  s_add_u32 s29, s28, 165675008
  buffer_load_dwordx4 v[152:155], v2, s[4:7], s29 offen offset:0
  buffer_load_dwordx4 v[156:159], v2, s[4:7], s29 offen offset:1024
  v_lshlrev_b32 v7, 4, v4
  s_lshl_b32 s26, s16, 2
  v_add_u32 v4, s26, v7
  s_barrier
  ds_write_b32 v4, v80
  s_waitcnt lgkmcnt(0)
  s_barrier
  ds_read_b128 v[84:87], v7
  s_waitcnt lgkmcnt(0)
  v_add_f32 v80, v84, v85
  v_add_f32 v81, v86, v87
  v_add_f32 v80, v80, v81
  v_mul_f32 v80, 0xbfb8aa3b, v80
  v_exp_f32 v80, v80
  s_nop 0
  v_add_f32 v80, 1.0, v80
  v_rcp_f32 v80, v80
  s_nop 0
  v_sub_f32 v82, 1.0, v80
  s_waitcnt vmcnt(14)
  v_lshlrev_b32 v160, 16, v96
  v_and_b32 v161, 0xffff0000, v96
  v_lshlrev_b32 v162, 16, v97
  v_and_b32 v163, 0xffff0000, v97
  v_lshlrev_b32 v164, 16, v98
  v_and_b32 v165, 0xffff0000, v98
  v_lshlrev_b32 v166, 16, v99
  v_and_b32 v167, 0xffff0000, v99
  v_lshlrev_b32 v168, 16, v100
  v_and_b32 v169, 0xffff0000, v100
  v_lshlrev_b32 v170, 16, v101
  v_and_b32 v171, 0xffff0000, v101
  v_lshlrev_b32 v172, 16, v102
  v_and_b32 v173, 0xffff0000, v102
  v_lshlrev_b32 v174, 16, v103
  v_and_b32 v175, 0xffff0000, v103
  s_waitcnt vmcnt(12)
  v_lshlrev_b32 v8, 16, v104
  v_and_b32 v9, 0xffff0000, v104
  v_pk_add_f32 v[160:161], v[160:161], v[8:9]
  v_lshlrev_b32 v10, 16, v105
  v_and_b32 v11, 0xffff0000, v105
  v_pk_add_f32 v[162:163], v[162:163], v[10:11]
  v_lshlrev_b32 v12, 16, v106
  v_and_b32 v13, 0xffff0000, v106
  v_pk_add_f32 v[164:165], v[164:165], v[12:13]
  v_lshlrev_b32 v14, 16, v107
  v_and_b32 v15, 0xffff0000, v107
  v_pk_add_f32 v[166:167], v[166:167], v[14:15]
  v_lshlrev_b32 v8, 16, v108
  v_and_b32 v9, 0xffff0000, v108
  v_pk_add_f32 v[168:169], v[168:169], v[8:9]
  v_lshlrev_b32 v10, 16, v109
  v_and_b32 v11, 0xffff0000, v109
  v_pk_add_f32 v[170:171], v[170:171], v[10:11]
  v_lshlrev_b32 v12, 16, v110
  v_and_b32 v13, 0xffff0000, v110
  v_pk_add_f32 v[172:173], v[172:173], v[12:13]
  v_lshlrev_b32 v14, 16, v111
  v_and_b32 v15, 0xffff0000, v111
  v_pk_add_f32 v[174:175], v[174:175], v[14:15]
  s_waitcnt vmcnt(10)
  v_lshlrev_b32 v8, 16, v112
  v_and_b32 v9, 0xffff0000, v112
  v_pk_add_f32 v[160:161], v[160:161], v[8:9]
  v_lshlrev_b32 v10, 16, v113
  v_and_b32 v11, 0xffff0000, v113
  v_pk_add_f32 v[162:163], v[162:163], v[10:11]
  v_lshlrev_b32 v12, 16, v114
  v_and_b32 v13, 0xffff0000, v114
  v_pk_add_f32 v[164:165], v[164:165], v[12:13]
  v_lshlrev_b32 v14, 16, v115
  v_and_b32 v15, 0xffff0000, v115
  v_pk_add_f32 v[166:167], v[166:167], v[14:15]
  v_lshlrev_b32 v8, 16, v116
  v_and_b32 v9, 0xffff0000, v116
  v_pk_add_f32 v[168:169], v[168:169], v[8:9]
  v_lshlrev_b32 v10, 16, v117
  v_and_b32 v11, 0xffff0000, v117
  v_pk_add_f32 v[170:171], v[170:171], v[10:11]
  v_lshlrev_b32 v12, 16, v118
  v_and_b32 v13, 0xffff0000, v118
  v_pk_add_f32 v[172:173], v[172:173], v[12:13]
  v_lshlrev_b32 v14, 16, v119
  v_and_b32 v15, 0xffff0000, v119
  v_pk_add_f32 v[174:175], v[174:175], v[14:15]
  s_waitcnt vmcnt(8)
  v_lshlrev_b32 v8, 16, v120
  v_and_b32 v9, 0xffff0000, v120
  v_pk_add_f32 v[160:161], v[160:161], v[8:9]
  v_lshlrev_b32 v10, 16, v121
  v_and_b32 v11, 0xffff0000, v121
  v_pk_add_f32 v[162:163], v[162:163], v[10:11]
  v_lshlrev_b32 v12, 16, v122
  v_and_b32 v13, 0xffff0000, v122
  v_pk_add_f32 v[164:165], v[164:165], v[12:13]
  v_lshlrev_b32 v14, 16, v123
  v_and_b32 v15, 0xffff0000, v123
  v_pk_add_f32 v[166:167], v[166:167], v[14:15]
  v_lshlrev_b32 v8, 16, v124
  v_and_b32 v9, 0xffff0000, v124
  v_pk_add_f32 v[168:169], v[168:169], v[8:9]
  v_lshlrev_b32 v10, 16, v125
  v_and_b32 v11, 0xffff0000, v125
  v_pk_add_f32 v[170:171], v[170:171], v[10:11]
  v_lshlrev_b32 v12, 16, v126
  v_and_b32 v13, 0xffff0000, v126
  v_pk_add_f32 v[172:173], v[172:173], v[12:13]
  v_lshlrev_b32 v14, 16, v127
  v_and_b32 v15, 0xffff0000, v127
  v_pk_add_f32 v[174:175], v[174:175], v[14:15]
  s_waitcnt vmcnt(6)
  v_lshlrev_b32 v8, 16, v128
  v_and_b32 v9, 0xffff0000, v128
  v_pk_add_f32 v[160:161], v[160:161], v[8:9]
  v_lshlrev_b32 v10, 16, v129
  v_and_b32 v11, 0xffff0000, v129
  v_pk_add_f32 v[162:163], v[162:163], v[10:11]
  v_lshlrev_b32 v12, 16, v130
  v_and_b32 v13, 0xffff0000, v130
  v_pk_add_f32 v[164:165], v[164:165], v[12:13]
  v_lshlrev_b32 v14, 16, v131
  v_and_b32 v15, 0xffff0000, v131
  v_pk_add_f32 v[166:167], v[166:167], v[14:15]
  v_lshlrev_b32 v8, 16, v132
  v_and_b32 v9, 0xffff0000, v132
  v_pk_add_f32 v[168:169], v[168:169], v[8:9]
  v_lshlrev_b32 v10, 16, v133
  v_and_b32 v11, 0xffff0000, v133
  v_pk_add_f32 v[170:171], v[170:171], v[10:11]
  v_lshlrev_b32 v12, 16, v134
  v_and_b32 v13, 0xffff0000, v134
  v_pk_add_f32 v[172:173], v[172:173], v[12:13]
  v_lshlrev_b32 v14, 16, v135
  v_and_b32 v15, 0xffff0000, v135
  v_pk_add_f32 v[174:175], v[174:175], v[14:15]
  s_waitcnt vmcnt(4)
  v_lshlrev_b32 v8, 16, v136
  v_and_b32 v9, 0xffff0000, v136
  v_pk_add_f32 v[160:161], v[160:161], v[8:9]
  v_lshlrev_b32 v10, 16, v137
  v_and_b32 v11, 0xffff0000, v137
  v_pk_add_f32 v[162:163], v[162:163], v[10:11]
  v_lshlrev_b32 v12, 16, v138
  v_and_b32 v13, 0xffff0000, v138
  v_pk_add_f32 v[164:165], v[164:165], v[12:13]
  v_lshlrev_b32 v14, 16, v139
  v_and_b32 v15, 0xffff0000, v139
  v_pk_add_f32 v[166:167], v[166:167], v[14:15]
  v_lshlrev_b32 v8, 16, v140
  v_and_b32 v9, 0xffff0000, v140
  v_pk_add_f32 v[168:169], v[168:169], v[8:9]
  v_lshlrev_b32 v10, 16, v141
  v_and_b32 v11, 0xffff0000, v141
  v_pk_add_f32 v[170:171], v[170:171], v[10:11]
  v_lshlrev_b32 v12, 16, v142
  v_and_b32 v13, 0xffff0000, v142
  v_pk_add_f32 v[172:173], v[172:173], v[12:13]
  v_lshlrev_b32 v14, 16, v143
  v_and_b32 v15, 0xffff0000, v143
  v_pk_add_f32 v[174:175], v[174:175], v[14:15]
  s_waitcnt vmcnt(2)
  v_lshlrev_b32 v8, 16, v144
  v_and_b32 v9, 0xffff0000, v144
  v_pk_add_f32 v[160:161], v[160:161], v[8:9]
  v_lshlrev_b32 v10, 16, v145
  v_and_b32 v11, 0xffff0000, v145
  v_pk_add_f32 v[162:163], v[162:163], v[10:11]
  v_lshlrev_b32 v12, 16, v146
  v_and_b32 v13, 0xffff0000, v146
  v_pk_add_f32 v[164:165], v[164:165], v[12:13]
  v_lshlrev_b32 v14, 16, v147
  v_and_b32 v15, 0xffff0000, v147
  v_pk_add_f32 v[166:167], v[166:167], v[14:15]
  v_lshlrev_b32 v8, 16, v148
  v_and_b32 v9, 0xffff0000, v148
  v_pk_add_f32 v[168:169], v[168:169], v[8:9]
  v_lshlrev_b32 v10, 16, v149
  v_and_b32 v11, 0xffff0000, v149
  v_pk_add_f32 v[170:171], v[170:171], v[10:11]
  v_lshlrev_b32 v12, 16, v150
  v_and_b32 v13, 0xffff0000, v150
  v_pk_add_f32 v[172:173], v[172:173], v[12:13]
  v_lshlrev_b32 v14, 16, v151
  v_and_b32 v15, 0xffff0000, v151
  v_pk_add_f32 v[174:175], v[174:175], v[14:15]
  s_waitcnt vmcnt(0)
  v_lshlrev_b32 v8, 16, v152
  v_and_b32 v9, 0xffff0000, v152
  v_pk_add_f32 v[160:161], v[160:161], v[8:9]
  v_lshlrev_b32 v10, 16, v153
  v_and_b32 v11, 0xffff0000, v153
  v_pk_add_f32 v[162:163], v[162:163], v[10:11]
  v_lshlrev_b32 v12, 16, v154
  v_and_b32 v13, 0xffff0000, v154
  v_pk_add_f32 v[164:165], v[164:165], v[12:13]
  v_lshlrev_b32 v14, 16, v155
  v_and_b32 v15, 0xffff0000, v155
  v_pk_add_f32 v[166:167], v[166:167], v[14:15]
  v_lshlrev_b32 v8, 16, v156
  v_and_b32 v9, 0xffff0000, v156
  v_pk_add_f32 v[168:169], v[168:169], v[8:9]
  v_lshlrev_b32 v10, 16, v157
  v_and_b32 v11, 0xffff0000, v157
  v_pk_add_f32 v[170:171], v[170:171], v[10:11]
  v_lshlrev_b32 v12, 16, v158
  v_and_b32 v13, 0xffff0000, v158
  v_pk_add_f32 v[172:173], v[172:173], v[12:13]
  v_lshlrev_b32 v14, 16, v159
  v_and_b32 v15, 0xffff0000, v159
  v_pk_add_f32 v[174:175], v[174:175], v[14:15]
  s_add_u32 s29, s28, 167772160
  buffer_load_dwordx4 v[96:99], v2, s[4:7], s29 offen offset:0
  buffer_load_dwordx4 v[100:103], v2, s[4:7], s29 offen offset:1024
  s_add_u32 s29, s28, 169869312
  buffer_load_dwordx4 v[104:107], v2, s[4:7], s29 offen offset:0
  buffer_load_dwordx4 v[108:111], v2, s[4:7], s29 offen offset:1024
  s_add_u32 s29, s28, 171966464
  buffer_load_dwordx4 v[112:115], v2, s[4:7], s29 offen offset:0
  buffer_load_dwordx4 v[116:119], v2, s[4:7], s29 offen offset:1024
  s_add_u32 s29, s28, 174063616
  buffer_load_dwordx4 v[120:123], v2, s[4:7], s29 offen offset:0
  buffer_load_dwordx4 v[124:127], v2, s[4:7], s29 offen offset:1024
  s_add_u32 s29, s28, 176160768
  buffer_load_dwordx4 v[128:131], v2, s[4:7], s29 offen offset:0
  buffer_load_dwordx4 v[132:135], v2, s[4:7], s29 offen offset:1024
  s_add_u32 s29, s28, 178257920
  buffer_load_dwordx4 v[136:139], v2, s[4:7], s29 offen offset:0
  buffer_load_dwordx4 v[140:143], v2, s[4:7], s29 offen offset:1024
  s_add_u32 s29, s28, 180355072
  buffer_load_dwordx4 v[144:147], v2, s[4:7], s29 offen offset:0
  buffer_load_dwordx4 v[148:151], v2, s[4:7], s29 offen offset:1024
  s_add_u32 s29, s28, 182452224
  buffer_load_dwordx4 v[152:155], v2, s[4:7], s29 offen offset:0
  buffer_load_dwordx4 v[156:159], v2, s[4:7], s29 offen offset:1024
  v_pk_mul_f32 v[160:161], v[160:161], v[80:81] op_sel_hi:[1,0]
  v_pk_mul_f32 v[162:163], v[162:163], v[80:81] op_sel_hi:[1,0]
  v_pk_mul_f32 v[164:165], v[164:165], v[80:81] op_sel_hi:[1,0]
  v_pk_mul_f32 v[166:167], v[166:167], v[80:81] op_sel_hi:[1,0]
  v_pk_mul_f32 v[168:169], v[168:169], v[80:81] op_sel_hi:[1,0]
  v_pk_mul_f32 v[170:171], v[170:171], v[80:81] op_sel_hi:[1,0]
  v_pk_mul_f32 v[172:173], v[172:173], v[80:81] op_sel_hi:[1,0]
  v_pk_mul_f32 v[174:175], v[174:175], v[80:81] op_sel_hi:[1,0]
  s_waitcnt vmcnt(14)
  v_lshlrev_b32 v176, 16, v96
  v_and_b32 v177, 0xffff0000, v96
  v_lshlrev_b32 v178, 16, v97
  v_and_b32 v179, 0xffff0000, v97
  v_lshlrev_b32 v180, 16, v98
  v_and_b32 v181, 0xffff0000, v98
  v_lshlrev_b32 v182, 16, v99
  v_and_b32 v183, 0xffff0000, v99
  v_lshlrev_b32 v184, 16, v100
  v_and_b32 v185, 0xffff0000, v100
  v_lshlrev_b32 v186, 16, v101
  v_and_b32 v187, 0xffff0000, v101
  v_lshlrev_b32 v188, 16, v102
  v_and_b32 v189, 0xffff0000, v102
  v_lshlrev_b32 v190, 16, v103
  v_and_b32 v191, 0xffff0000, v103
  s_waitcnt vmcnt(12)
  v_lshlrev_b32 v8, 16, v104
  v_and_b32 v9, 0xffff0000, v104
  v_pk_add_f32 v[176:177], v[176:177], v[8:9]
  v_lshlrev_b32 v10, 16, v105
  v_and_b32 v11, 0xffff0000, v105
  v_pk_add_f32 v[178:179], v[178:179], v[10:11]
  v_lshlrev_b32 v12, 16, v106
  v_and_b32 v13, 0xffff0000, v106
  v_pk_add_f32 v[180:181], v[180:181], v[12:13]
  v_lshlrev_b32 v14, 16, v107
  v_and_b32 v15, 0xffff0000, v107
  v_pk_add_f32 v[182:183], v[182:183], v[14:15]
  v_lshlrev_b32 v8, 16, v108
  v_and_b32 v9, 0xffff0000, v108
  v_pk_add_f32 v[184:185], v[184:185], v[8:9]
  v_lshlrev_b32 v10, 16, v109
  v_and_b32 v11, 0xffff0000, v109
  v_pk_add_f32 v[186:187], v[186:187], v[10:11]
  v_lshlrev_b32 v12, 16, v110
  v_and_b32 v13, 0xffff0000, v110
  v_pk_add_f32 v[188:189], v[188:189], v[12:13]
  v_lshlrev_b32 v14, 16, v111
  v_and_b32 v15, 0xffff0000, v111
  v_pk_add_f32 v[190:191], v[190:191], v[14:15]
  s_waitcnt vmcnt(10)
  v_lshlrev_b32 v8, 16, v112
  v_and_b32 v9, 0xffff0000, v112
  v_pk_add_f32 v[176:177], v[176:177], v[8:9]
  v_lshlrev_b32 v10, 16, v113
  v_and_b32 v11, 0xffff0000, v113
  v_pk_add_f32 v[178:179], v[178:179], v[10:11]
  v_lshlrev_b32 v12, 16, v114
  v_and_b32 v13, 0xffff0000, v114
  v_pk_add_f32 v[180:181], v[180:181], v[12:13]
  v_lshlrev_b32 v14, 16, v115
  v_and_b32 v15, 0xffff0000, v115
  v_pk_add_f32 v[182:183], v[182:183], v[14:15]
  v_lshlrev_b32 v8, 16, v116
  v_and_b32 v9, 0xffff0000, v116
  v_pk_add_f32 v[184:185], v[184:185], v[8:9]
  v_lshlrev_b32 v10, 16, v117
  v_and_b32 v11, 0xffff0000, v117
  v_pk_add_f32 v[186:187], v[186:187], v[10:11]
  v_lshlrev_b32 v12, 16, v118
  v_and_b32 v13, 0xffff0000, v118
  v_pk_add_f32 v[188:189], v[188:189], v[12:13]
  v_lshlrev_b32 v14, 16, v119
  v_and_b32 v15, 0xffff0000, v119
  v_pk_add_f32 v[190:191], v[190:191], v[14:15]
  s_waitcnt vmcnt(8)
  v_lshlrev_b32 v8, 16, v120
  v_and_b32 v9, 0xffff0000, v120
  v_pk_add_f32 v[176:177], v[176:177], v[8:9]
  v_lshlrev_b32 v10, 16, v121
  v_and_b32 v11, 0xffff0000, v121
  v_pk_add_f32 v[178:179], v[178:179], v[10:11]
  v_lshlrev_b32 v12, 16, v122
  v_and_b32 v13, 0xffff0000, v122
  v_pk_add_f32 v[180:181], v[180:181], v[12:13]
  v_lshlrev_b32 v14, 16, v123
  v_and_b32 v15, 0xffff0000, v123
  v_pk_add_f32 v[182:183], v[182:183], v[14:15]
  v_lshlrev_b32 v8, 16, v124
  v_and_b32 v9, 0xffff0000, v124
  v_pk_add_f32 v[184:185], v[184:185], v[8:9]
  v_lshlrev_b32 v10, 16, v125
  v_and_b32 v11, 0xffff0000, v125
  v_pk_add_f32 v[186:187], v[186:187], v[10:11]
  v_lshlrev_b32 v12, 16, v126
  v_and_b32 v13, 0xffff0000, v126
  v_pk_add_f32 v[188:189], v[188:189], v[12:13]
  v_lshlrev_b32 v14, 16, v127
  v_and_b32 v15, 0xffff0000, v127
  v_pk_add_f32 v[190:191], v[190:191], v[14:15]
  s_waitcnt vmcnt(6)
  v_lshlrev_b32 v8, 16, v128
  v_and_b32 v9, 0xffff0000, v128
  v_pk_add_f32 v[176:177], v[176:177], v[8:9]
  v_lshlrev_b32 v10, 16, v129
  v_and_b32 v11, 0xffff0000, v129
  v_pk_add_f32 v[178:179], v[178:179], v[10:11]
  v_lshlrev_b32 v12, 16, v130
  v_and_b32 v13, 0xffff0000, v130
  v_pk_add_f32 v[180:181], v[180:181], v[12:13]
  v_lshlrev_b32 v14, 16, v131
  v_and_b32 v15, 0xffff0000, v131
  v_pk_add_f32 v[182:183], v[182:183], v[14:15]
  v_lshlrev_b32 v8, 16, v132
  v_and_b32 v9, 0xffff0000, v132
  v_pk_add_f32 v[184:185], v[184:185], v[8:9]
  v_lshlrev_b32 v10, 16, v133
  v_and_b32 v11, 0xffff0000, v133
  v_pk_add_f32 v[186:187], v[186:187], v[10:11]
  v_lshlrev_b32 v12, 16, v134
  v_and_b32 v13, 0xffff0000, v134
  v_pk_add_f32 v[188:189], v[188:189], v[12:13]
  v_lshlrev_b32 v14, 16, v135
  v_and_b32 v15, 0xffff0000, v135
  v_pk_add_f32 v[190:191], v[190:191], v[14:15]
  s_waitcnt vmcnt(4)
  v_lshlrev_b32 v8, 16, v136
  v_and_b32 v9, 0xffff0000, v136
  v_pk_add_f32 v[176:177], v[176:177], v[8:9]
  v_lshlrev_b32 v10, 16, v137
  v_and_b32 v11, 0xffff0000, v137
  v_pk_add_f32 v[178:179], v[178:179], v[10:11]
  v_lshlrev_b32 v12, 16, v138
  v_and_b32 v13, 0xffff0000, v138
  v_pk_add_f32 v[180:181], v[180:181], v[12:13]
  v_lshlrev_b32 v14, 16, v139
  v_and_b32 v15, 0xffff0000, v139
  v_pk_add_f32 v[182:183], v[182:183], v[14:15]
  v_lshlrev_b32 v8, 16, v140
  v_and_b32 v9, 0xffff0000, v140
  v_pk_add_f32 v[184:185], v[184:185], v[8:9]
  v_lshlrev_b32 v10, 16, v141
  v_and_b32 v11, 0xffff0000, v141
  v_pk_add_f32 v[186:187], v[186:187], v[10:11]
  v_lshlrev_b32 v12, 16, v142
  v_and_b32 v13, 0xffff0000, v142
  v_pk_add_f32 v[188:189], v[188:189], v[12:13]
  v_lshlrev_b32 v14, 16, v143
  v_and_b32 v15, 0xffff0000, v143
  v_pk_add_f32 v[190:191], v[190:191], v[14:15]
  s_waitcnt vmcnt(2)
  v_lshlrev_b32 v8, 16, v144
  v_and_b32 v9, 0xffff0000, v144
  v_pk_add_f32 v[176:177], v[176:177], v[8:9]
  v_lshlrev_b32 v10, 16, v145
  v_and_b32 v11, 0xffff0000, v145
  v_pk_add_f32 v[178:179], v[178:179], v[10:11]
  v_lshlrev_b32 v12, 16, v146
  v_and_b32 v13, 0xffff0000, v146
  v_pk_add_f32 v[180:181], v[180:181], v[12:13]
  v_lshlrev_b32 v14, 16, v147
  v_and_b32 v15, 0xffff0000, v147
  v_pk_add_f32 v[182:183], v[182:183], v[14:15]
  v_lshlrev_b32 v8, 16, v148
  v_and_b32 v9, 0xffff0000, v148
  v_pk_add_f32 v[184:185], v[184:185], v[8:9]
  v_lshlrev_b32 v10, 16, v149
  v_and_b32 v11, 0xffff0000, v149
  v_pk_add_f32 v[186:187], v[186:187], v[10:11]
  v_lshlrev_b32 v12, 16, v150
  v_and_b32 v13, 0xffff0000, v150
  v_pk_add_f32 v[188:189], v[188:189], v[12:13]
  v_lshlrev_b32 v14, 16, v151
  v_and_b32 v15, 0xffff0000, v151
  v_pk_add_f32 v[190:191], v[190:191], v[14:15]
  s_waitcnt vmcnt(0)
  v_lshlrev_b32 v8, 16, v152
  v_and_b32 v9, 0xffff0000, v152
  v_pk_add_f32 v[176:177], v[176:177], v[8:9]
  v_lshlrev_b32 v10, 16, v153
  v_and_b32 v11, 0xffff0000, v153
  v_pk_add_f32 v[178:179], v[178:179], v[10:11]
  v_lshlrev_b32 v12, 16, v154
  v_and_b32 v13, 0xffff0000, v154
  v_pk_add_f32 v[180:181], v[180:181], v[12:13]
  v_lshlrev_b32 v14, 16, v155
  v_and_b32 v15, 0xffff0000, v155
  v_pk_add_f32 v[182:183], v[182:183], v[14:15]
  v_lshlrev_b32 v8, 16, v156
  v_and_b32 v9, 0xffff0000, v156
  v_pk_add_f32 v[184:185], v[184:185], v[8:9]
  v_lshlrev_b32 v10, 16, v157
  v_and_b32 v11, 0xffff0000, v157
  v_pk_add_f32 v[186:187], v[186:187], v[10:11]
  v_lshlrev_b32 v12, 16, v158
  v_and_b32 v13, 0xffff0000, v158
  v_pk_add_f32 v[188:189], v[188:189], v[12:13]
  v_lshlrev_b32 v14, 16, v159
  v_and_b32 v15, 0xffff0000, v159
  v_pk_add_f32 v[190:191], v[190:191], v[14:15]
  v_pk_fma_f32 v[160:161], v[176:177], v[82:83], v[160:161] op_sel_hi:[1,0,1]
  v_cvt_pk_bf16_f32 v16, v160, v161
  v_pk_fma_f32 v[162:163], v[178:179], v[82:83], v[162:163] op_sel_hi:[1,0,1]
  v_cvt_pk_bf16_f32 v17, v162, v163
  v_pk_fma_f32 v[164:165], v[180:181], v[82:83], v[164:165] op_sel_hi:[1,0,1]
  v_cvt_pk_bf16_f32 v18, v164, v165
  v_pk_fma_f32 v[166:167], v[182:183], v[82:83], v[166:167] op_sel_hi:[1,0,1]
  v_cvt_pk_bf16_f32 v19, v166, v167
  v_pk_fma_f32 v[168:169], v[184:185], v[82:83], v[168:169] op_sel_hi:[1,0,1]
  v_cvt_pk_bf16_f32 v20, v168, v169
  v_pk_fma_f32 v[170:171], v[186:187], v[82:83], v[170:171] op_sel_hi:[1,0,1]
  v_cvt_pk_bf16_f32 v21, v170, v171
  v_pk_fma_f32 v[172:173], v[188:189], v[82:83], v[172:173] op_sel_hi:[1,0,1]
  v_cvt_pk_bf16_f32 v22, v172, v173
  v_pk_fma_f32 v[174:175], v[190:191], v[82:83], v[174:175] op_sel_hi:[1,0,1]
  v_cvt_pk_bf16_f32 v23, v174, v175
  s_lshl_b32 s26, s41, 2
  s_add_u32 s26, s26, s16
  s_lshl_b32 s26, s26, 6
  s_lshl_b32 s27, s40, 15
  s_add_u32 s26, s26, s27
  buffer_store_dwordx4 v[16:19], v6, s[32:35], s26 offen offset:0
  buffer_store_dwordx4 v[20:23], v6, s[32:35], s26 offen offset:32
K_exit_58:
  s_endpgm
.section .rodata,"a"
.p2align 6
.amdhsa_kernel proj_kernel
.amdhsa_next_free_vgpr 512
.amdhsa_next_free_sgpr 102
.amdhsa_accum_offset 256
.amdhsa_group_segment_fixed_size 0
.amdhsa_kernarg_size 136
.amdhsa_user_sgpr_count 2
.amdhsa_user_sgpr_kernarg_segment_ptr 1
.amdhsa_system_sgpr_workgroup_id_x 1
.end_amdhsa_kernel
.section .rodata,"a"
.p2align 6
.amdhsa_kernel team_kernel
.amdhsa_next_free_vgpr 512
.amdhsa_next_free_sgpr 102
.amdhsa_accum_offset 256
.amdhsa_group_segment_fixed_size 0
.amdhsa_kernarg_size 136
.amdhsa_user_sgpr_count 2
.amdhsa_user_sgpr_kernarg_segment_ptr 1
.amdhsa_system_sgpr_workgroup_id_x 1
.end_amdhsa_kernel
.section .rodata,"a"
.p2align 6
.amdhsa_kernel attn_kernel
.amdhsa_next_free_vgpr 512
.amdhsa_next_free_sgpr 102
.amdhsa_accum_offset 256
.amdhsa_group_segment_fixed_size 0
.amdhsa_kernarg_size 136
.amdhsa_user_sgpr_count 2
.amdhsa_user_sgpr_kernarg_segment_ptr 1
.amdhsa_system_sgpr_workgroup_id_x 1
.end_amdhsa_kernel
.section .rodata,"a"
.p2align 6
.amdhsa_kernel oproj_kernel
.amdhsa_next_free_vgpr 512
.amdhsa_next_free_sgpr 102
.amdhsa_accum_offset 256
.amdhsa_group_segment_fixed_size 0
.amdhsa_kernarg_size 136
.amdhsa_user_sgpr_count 2
.amdhsa_user_sgpr_kernarg_segment_ptr 1
.amdhsa_system_sgpr_workgroup_id_x 1
.end_amdhsa_kernel
.section .rodata,"a"
.p2align 6
.amdhsa_kernel follow_kernel
.amdhsa_next_free_vgpr 512
.amdhsa_next_free_sgpr 102
.amdhsa_accum_offset 256
.amdhsa_group_segment_fixed_size 0
.amdhsa_kernarg_size 136
.amdhsa_user_sgpr_count 2
.amdhsa_user_sgpr_kernarg_segment_ptr 1
.amdhsa_system_sgpr_workgroup_id_x 1
.end_amdhsa_kernel
.section .rodata,"a"
.p2align 6
.amdhsa_kernel final_kernel
.amdhsa_next_free_vgpr 512
.amdhsa_next_free_sgpr 102
.amdhsa_accum_offset 256
.amdhsa_group_segment_fixed_size 0
.amdhsa_kernarg_size 136
.amdhsa_user_sgpr_count 2
.amdhsa_user_sgpr_kernarg_segment_ptr 1
.amdhsa_system_sgpr_workgroup_id_x 1
.end_amdhsa_kernel
```

```asm
; @launch grid=(256,1,1) block=(256,1,1) lds=163840
.amdgcn_target "amdgcn-amd-amdhsa--gfx950"
.text
.globl gated_mix__compressed_kv_cla__memory_aug_recurrent_mem_tr__prompt_kernel
.p2align 8
.type gated_mix__compressed_kv_cla__memory_aug_recurrent_mem_tr__prompt_kernel,@function
gated_mix__compressed_kv_cla__memory_aug_recurrent_mem_tr__prompt_kernel:
  s_cmp_ge_u32 s2, 256
  s_cbranch_scc1 M_exit
  s_load_dwordx4 s[72:75], s[0:1], 120
  v_lshrrev_b32 v3, 6, v0
  v_and_b32 v1, 63, v0
  v_readfirstlane_b32 s16, v3
  v_lshlrev_b32 v2, 4, v1
  s_and_b32 s76, s2, 7
  s_lshr_b32 s77, s2, 3
  s_sub_u32 s66, s76, 1
  s_and_b32 s66, s66, 7
  s_lshl_b32 s66, s66, 5
  s_add_u32 s66, s66, s77
  s_lshl_b32 s31, s66, 7
  s_add_u32 s31, s31, 148897792
  s_waitcnt lgkmcnt(0)
  s_mov_b64 s[4:5], s[74:75]
  s_mov_b64 s[74:75], s[72:73]
  s_mov_b64 s[72:73], s[4:5]
  s_and_b32 s5, s5, 0xffff
  s_mov_b32 s6, 268435456
  s_mov_b32 s7, 0x20000
  s_cmp_lg_u32 s16, 3
  s_cbranch_scc1 M_noinit
  s_mov_b32 s26, 0
  s_atomic_swap s26, s[72:73], s31 glc
  s_waitcnt lgkmcnt(0)
  s_mov_b32 s79, 1
  s_atomic_add s79, s[74:75], 128
M_noinit:
  s_cmp_eq_u32 s76, 0
  s_cbranch_scc1 M_team
  s_mul_i32 s64, s66, 9363
  s_lshr_b32 s64, s64, 16
  s_mul_i32 s67, s64, 7
  s_sub_u32 s65, s66, s67
  s_lshl_b32 s67, s67, 7
  s_add_u32 s67, s67, 148897792
  s_getpc_b64 s[76:77]
M_pc:
  s_add_u32 s76, s76, M_table-M_pc
  s_addc_u32 s77, s77, 0
  s_lshl_b32 s26, s65, 6
  s_load_dwordx16 s[48:63], s[76:77], s26
  s_waitcnt lgkmcnt(0)
  s_mov_b32 s23, s51
  s_lshr_b32 s29, s16, 1
  s_cmp_eq_u32 s29, 0
  s_cselect_b32 s26, 2, 8
  s_cselect_b32 s27, 3, 4
  s_cselect_b32 s28, 9, 10
  s_cmp_eq_u32 s48, 1
  s_cselect_b32 s26, s27, s26
  s_cmp_eq_u32 s48, 2
  s_cselect_b32 s26, s28, s26
  s_lshl_b32 s26, s26, 3
  s_load_dwordx2 s[8:9], s[0:1], s26
  s_cmp_eq_u32 s48, 1
  s_cselect_b32 s26, 8, 0
  s_load_dwordx2 s[12:13], s[0:1], s26
  s_cmp_eq_u32 s29, 0
  s_cselect_b32 s21, 0, 3
  s_cselect_b32 s27, 1, 2
  s_cselect_b32 s28, 4, 5
  s_cmp_eq_u32 s48, 1
  s_cselect_b32 s21, s27, s21
  s_cmp_eq_u32 s48, 2
  s_cselect_b32 s21, s28, s21
  s_lshl_b32 s21, s21, 5
  s_add_u32 s21, s21, s64
  s_lshl_b32 s21, s21, 6
  s_add_u32 s21, s21, s49
  s_and_b32 s27, s16, 1
  s_lshl_b32 s21, s21, 1
  s_add_u32 s21, s21, s27
  s_lshl_b32 s21, s21, 12
  s_lshl_b32 s22, s50, 13
  s_lshl_b32 s19, s49, 15
  s_lshl_b32 s20, s50, 15
  s_lshl_b32 s17, s64, 1
  s_add_u32 s17, s17, s27
  s_lshl_b32 s17, s17, 7
  s_mov_b32 s18, 8192
  s_cmp_eq_u32 s48, 0
  s_cselect_b32 s24, 0x3e0293ee, 1.0
  s_waitcnt lgkmcnt(0)
  s_and_b32 s9, s9, 0xffff
  s_mov_b32 s10, 4194304
  s_mov_b32 s11, 0x20000
  s_and_b32 s13, s13, 0xffff
  s_mov_b32 s14, 2097152
  s_mov_b32 s15, 0x20000
  v_and_b32 v144, 31, v1
  v_lshrrev_b32 v145, 5, v1
  v_and_b32 v146, 15, v1
  v_or_b32 v147, 0, v145
  v_xor_b32 v147, v147, v146
  v_lshlrev_b32 v147, 4, v147
  v_lshl_add_u32 v8, v144, 8, v147
  v_or_b32 v147, 2, v145
  v_xor_b32 v147, v147, v146
  v_lshlrev_b32 v147, 4, v147
  v_lshl_add_u32 v9, v144, 8, v147
  v_or_b32 v147, 4, v145
  v_xor_b32 v147, v147, v146
  v_lshlrev_b32 v147, 4, v147
  v_lshl_add_u32 v10, v144, 8, v147
  v_or_b32 v147, 6, v145
  v_xor_b32 v147, v147, v146
  v_lshlrev_b32 v147, 4, v147
  v_lshl_add_u32 v11, v144, 8, v147
  v_or_b32 v147, 8, v145
  v_xor_b32 v147, v147, v146
  v_lshlrev_b32 v147, 4, v147
  v_lshl_add_u32 v12, v144, 8, v147
  v_or_b32 v147, 10, v145
  v_xor_b32 v147, v147, v146
  v_lshlrev_b32 v147, 4, v147
  v_lshl_add_u32 v13, v144, 8, v147
  v_or_b32 v147, 12, v145
  v_xor_b32 v147, v147, v146
  v_lshlrev_b32 v147, 4, v147
  v_lshl_add_u32 v14, v144, 8, v147
  v_or_b32 v147, 14, v145
  v_xor_b32 v147, v147, v146
  v_lshlrev_b32 v147, 4, v147
  v_lshl_add_u32 v15, v144, 8, v147
  v_lshrrev_b32 v144, 4, v1
  s_lshl_b32 s26, s16, 8
  v_add_u32 v145, 0, v144
  v_and_b32 v147, 15, v145
  v_xor_b32 v147, v147, v146
  v_lshlrev_b32 v147, 4, v147
  v_lshl_add_u32 v147, v145, 10, v147
  v_add_u32 v16, s26, v147
  v_add_u32 v145, 4, v144
  v_and_b32 v147, 15, v145
  v_xor_b32 v147, v147, v146
  v_lshlrev_b32 v147, 4, v147
  v_lshl_add_u32 v147, v145, 10, v147
  v_add_u32 v17, s26, v147
  v_add_u32 v145, 8, v144
  v_and_b32 v147, 15, v145
  v_xor_b32 v147, v147, v146
  v_lshlrev_b32 v147, 4, v147
  v_lshl_add_u32 v147, v145, 10, v147
  v_add_u32 v18, s26, v147
  v_add_u32 v145, 12, v144
  v_and_b32 v147, 15, v145
  v_xor_b32 v147, v147, v146
  v_lshlrev_b32 v147, 4, v147
  v_lshl_add_u32 v147, v145, 10, v147
  v_add_u32 v19, s26, v147
  v_add_u32 v145, 16, v144
  v_and_b32 v147, 15, v145
  v_xor_b32 v147, v147, v146
  v_lshlrev_b32 v147, 4, v147
  v_lshl_add_u32 v147, v145, 10, v147
  v_add_u32 v20, s26, v147
  v_add_u32 v145, 20, v144
  v_and_b32 v147, 15, v145
  v_xor_b32 v147, v147, v146
  v_lshlrev_b32 v147, 4, v147
  v_lshl_add_u32 v147, v145, 10, v147
  v_add_u32 v21, s26, v147
  v_add_u32 v145, 24, v144
  v_and_b32 v147, 15, v145
  v_xor_b32 v147, v147, v146
  v_lshlrev_b32 v147, 4, v147
  v_lshl_add_u32 v147, v145, 10, v147
  v_add_u32 v22, s26, v147
  v_add_u32 v145, 28, v144
  v_and_b32 v147, 15, v145
  v_xor_b32 v147, v147, v146
  v_lshlrev_b32 v147, 4, v147
  v_lshl_add_u32 v147, v145, 10, v147
  v_add_u32 v23, s26, v147
  v_lshrrev_b32 v144, 3, v1
  v_mul_lo_u32 v144, v144, s18
  v_and_b32 v145, 7, v1
  v_lshl_add_u32 v144, v145, 4, v144
  s_lshl_b32 s28, s16, 15
  s_add_u32 s28, s28, 32768
  s_lshl_b32 s29, s18, 3
  s_add_u32 m0, s28, 0
  s_nop 0
  buffer_load_dwordx4 v144, s[8:11], s17 offen lds
  s_add_u32 s17, s17, s29
  s_add_u32 m0, s28, 1024
  s_nop 0
  buffer_load_dwordx4 v144, s[8:11], s17 offen lds
  s_add_u32 s17, s17, s29
  s_add_u32 m0, s28, 2048
  s_nop 0
  buffer_load_dwordx4 v144, s[8:11], s17 offen lds
  s_add_u32 s17, s17, s29
  s_add_u32 m0, s28, 3072
  s_nop 0
  buffer_load_dwordx4 v144, s[8:11], s17 offen lds
  s_add_u32 s17, s17, s29
  s_add_u32 m0, s28, 4096
  s_nop 0
  buffer_load_dwordx4 v144, s[8:11], s17 offen lds
  s_add_u32 s17, s17, s29
  s_add_u32 m0, s28, 5120
  s_nop 0
  buffer_load_dwordx4 v144, s[8:11], s17 offen lds
  s_add_u32 s17, s17, s29
  s_add_u32 m0, s28, 6144
  s_nop 0
  buffer_load_dwordx4 v144, s[8:11], s17 offen lds
  s_add_u32 s17, s17, s29
  s_add_u32 m0, s28, 7168
  s_nop 0
  buffer_load_dwordx4 v144, s[8:11], s17 offen lds
  s_add_u32 s17, s17, s29
  s_add_u32 m0, s28, 8192
  s_nop 0
  buffer_load_dwordx4 v144, s[8:11], s17 offen lds
  s_add_u32 s17, s17, s29
  s_add_u32 m0, s28, 9216
  s_nop 0
  buffer_load_dwordx4 v144, s[8:11], s17 offen lds
  s_add_u32 s17, s17, s29
  s_add_u32 m0, s28, 10240
  s_nop 0
  buffer_load_dwordx4 v144, s[8:11], s17 offen lds
  s_add_u32 s17, s17, s29
  s_add_u32 m0, s28, 11264
  s_nop 0
  buffer_load_dwordx4 v144, s[8:11], s17 offen lds
  s_add_u32 s17, s17, s29
  s_add_u32 m0, s28, 12288
  s_nop 0
  buffer_load_dwordx4 v144, s[8:11], s17 offen lds
  s_add_u32 s17, s17, s29
  s_add_u32 m0, s28, 13312
  s_nop 0
  buffer_load_dwordx4 v144, s[8:11], s17 offen lds
  s_add_u32 s17, s17, s29
  s_add_u32 m0, s28, 14336
  s_nop 0
  buffer_load_dwordx4 v144, s[8:11], s17 offen lds
  s_add_u32 s17, s17, s29
  s_add_u32 m0, s28, 15360
  s_nop 0
  buffer_load_dwordx4 v144, s[8:11], s17 offen lds
  s_add_u32 s17, s17, s29
  s_add_u32 m0, s28, 16384
  s_nop 0
  buffer_load_dwordx4 v144, s[8:11], s17 offen lds
  s_add_u32 s17, s17, s29
  s_add_u32 m0, s28, 17408
  s_nop 0
  buffer_load_dwordx4 v144, s[8:11], s17 offen lds
  s_add_u32 s17, s17, s29
  s_add_u32 m0, s28, 18432
  s_nop 0
  buffer_load_dwordx4 v144, s[8:11], s17 offen lds
  s_add_u32 s17, s17, s29
  s_add_u32 m0, s28, 19456
  s_nop 0
  buffer_load_dwordx4 v144, s[8:11], s17 offen lds
  s_add_u32 s17, s17, s29
  s_add_u32 m0, s28, 20480
  s_nop 0
  buffer_load_dwordx4 v144, s[8:11], s17 offen lds
  s_add_u32 s17, s17, s29
  s_add_u32 m0, s28, 21504
  s_nop 0
  buffer_load_dwordx4 v144, s[8:11], s17 offen lds
  s_add_u32 s17, s17, s29
  s_add_u32 m0, s28, 22528
  s_nop 0
  buffer_load_dwordx4 v144, s[8:11], s17 offen lds
  s_add_u32 s17, s17, s29
  s_add_u32 m0, s28, 23552
  s_nop 0
  buffer_load_dwordx4 v144, s[8:11], s17 offen lds
  s_add_u32 s17, s17, s29
  s_add_u32 m0, s28, 24576
  s_nop 0
  buffer_load_dwordx4 v144, s[8:11], s17 offen lds
  s_add_u32 s17, s17, s29
  s_add_u32 m0, s28, 25600
  s_nop 0
  buffer_load_dwordx4 v144, s[8:11], s17 offen lds
  s_add_u32 s17, s17, s29
  s_add_u32 m0, s28, 26624
  s_nop 0
  buffer_load_dwordx4 v144, s[8:11], s17 offen lds
  s_add_u32 s17, s17, s29
  s_add_u32 m0, s28, 27648
  s_nop 0
  buffer_load_dwordx4 v144, s[8:11], s17 offen lds
  s_add_u32 s17, s17, s29
  s_add_u32 m0, s28, 28672
  s_nop 0
  buffer_load_dwordx4 v144, s[8:11], s17 offen lds
  s_add_u32 s17, s17, s29
  s_add_u32 m0, s28, 29696
  s_nop 0
  buffer_load_dwordx4 v144, s[8:11], s17 offen lds
  s_add_u32 s17, s17, s29
  s_add_u32 m0, s28, 30720
  s_nop 0
  buffer_load_dwordx4 v144, s[8:11], s17 offen lds
  s_add_u32 s17, s17, s29
  s_add_u32 m0, s28, 31744
  s_nop 0
  buffer_load_dwordx4 v144, s[8:11], s17 offen lds
  s_add_u32 s17, s17, s29
  s_lshl_b32 s25, s16, 13
  s_add_u32 m0, s25, 0
  s_nop 0
  buffer_load_dwordx4 v16, s[12:15], s19 offen lds
  s_add_u32 m0, s25, 1024
  s_nop 0
  buffer_load_dwordx4 v17, s[12:15], s19 offen lds
  s_add_u32 m0, s25, 2048
  s_nop 0
  buffer_load_dwordx4 v18, s[12:15], s19 offen lds
  s_add_u32 m0, s25, 3072
  s_nop 0
  buffer_load_dwordx4 v19, s[12:15], s19 offen lds
  s_add_u32 m0, s25, 4096
  s_nop 0
  buffer_load_dwordx4 v20, s[12:15], s19 offen lds
  s_add_u32 m0, s25, 5120
  s_nop 0
  buffer_load_dwordx4 v21, s[12:15], s19 offen lds
  s_add_u32 m0, s25, 6144
  s_nop 0
  buffer_load_dwordx4 v22, s[12:15], s19 offen lds
  s_add_u32 m0, s25, 7168
  s_nop 0
  buffer_load_dwordx4 v23, s[12:15], s19 offen lds
  s_cmp_gt_u32 s23, 1
  s_cselect_b32 s26, s20, 0
  s_add_u32 s19, s19, s26
  s_add_u32 s25, s25, 32768
  s_and_b32 s25, s25, 0x1ffff
  v_bfe_u32 v148, v1, 2, 2
  v_lshrrev_b32 v149, 5, v1
  v_lshl_add_u32 v148, v149, 3, v148
  v_lshlrev_b32 v148, 7, v148
  v_bfe_u32 v149, v1, 4, 1
  v_lshl_add_u32 v148, v149, 5, v148
  v_and_b32 v149, 3, v1
  v_lshl_add_u32 v148, v149, 3, v148
  v_add_u32 v146, s28, v148
  v_add_u32 v147, 512, v146
  s_waitcnt vmcnt(36)
  ds_read_b64_tr_b16 a[0:1], v146 offset:0
  ds_read_b64_tr_b16 a[2:3], v147 offset:0
  ds_read_b64_tr_b16 a[4:5], v146 offset:64
  ds_read_b64_tr_b16 a[6:7], v147 offset:64
  ds_read_b64_tr_b16 a[8:9], v146 offset:2048
  ds_read_b64_tr_b16 a[10:11], v147 offset:2048
  ds_read_b64_tr_b16 a[12:13], v146 offset:2112
  ds_read_b64_tr_b16 a[14:15], v147 offset:2112
  s_waitcnt lgkmcnt(0)
  s_add_u32 m0, s28, 0
  s_nop 0
  buffer_load_dwordx4 v144, s[8:11], s17 offen lds
  s_add_u32 s17, s17, s29
  s_add_u32 m0, s28, 1024
  s_nop 0
  buffer_load_dwordx4 v144, s[8:11], s17 offen lds
  s_add_u32 s17, s17, s29
  s_add_u32 m0, s28, 2048
  s_nop 0
  buffer_load_dwordx4 v144, s[8:11], s17 offen lds
  s_add_u32 s17, s17, s29
  s_add_u32 m0, s28, 3072
  s_nop 0
  buffer_load_dwordx4 v144, s[8:11], s17 offen lds
  s_add_u32 s17, s17, s29
  s_waitcnt vmcnt(36)
  ds_read_b64_tr_b16 a[16:17], v146 offset:4096
  ds_read_b64_tr_b16 a[18:19], v147 offset:4096
  ds_read_b64_tr_b16 a[20:21], v146 offset:4160
  ds_read_b64_tr_b16 a[22:23], v147 offset:4160
  ds_read_b64_tr_b16 a[24:25], v146 offset:6144
  ds_read_b64_tr_b16 a[26:27], v147 offset:6144
  ds_read_b64_tr_b16 a[28:29], v146 offset:6208
  ds_read_b64_tr_b16 a[30:31], v147 offset:6208
  s_waitcnt lgkmcnt(0)
  s_add_u32 m0, s28, 4096
  s_nop 0
  buffer_load_dwordx4 v144, s[8:11], s17 offen lds
  s_add_u32 s17, s17, s29
  s_add_u32 m0, s28, 5120
  s_nop 0
  buffer_load_dwordx4 v144, s[8:11], s17 offen lds
  s_add_u32 s17, s17, s29
  s_add_u32 m0, s28, 6144
  s_nop 0
  buffer_load_dwordx4 v144, s[8:11], s17 offen lds
  s_add_u32 s17, s17, s29
  s_add_u32 m0, s28, 7168
  s_nop 0
  buffer_load_dwordx4 v144, s[8:11], s17 offen lds
  s_add_u32 s17, s17, s29
  s_waitcnt vmcnt(36)
  ds_read_b64_tr_b16 a[32:33], v146 offset:8192
  ds_read_b64_tr_b16 a[34:35], v147 offset:8192
  ds_read_b64_tr_b16 a[36:37], v146 offset:8256
  ds_read_b64_tr_b16 a[38:39], v147 offset:8256
  ds_read_b64_tr_b16 a[40:41], v146 offset:10240
  ds_read_b64_tr_b16 a[42:43], v147 offset:10240
  ds_read_b64_tr_b16 a[44:45], v146 offset:10304
  ds_read_b64_tr_b16 a[46:47], v147 offset:10304
  s_waitcnt lgkmcnt(0)
  s_add_u32 m0, s28, 8192
  s_nop 0
  buffer_load_dwordx4 v144, s[8:11], s17 offen lds
  s_add_u32 s17, s17, s29
  s_add_u32 m0, s28, 9216
  s_nop 0
  buffer_load_dwordx4 v144, s[8:11], s17 offen lds
  s_add_u32 s17, s17, s29
  s_add_u32 m0, s28, 10240
  s_nop 0
  buffer_load_dwordx4 v144, s[8:11], s17 offen lds
  s_add_u32 s17, s17, s29
  s_add_u32 m0, s28, 11264
  s_nop 0
  buffer_load_dwordx4 v144, s[8:11], s17 offen lds
  s_add_u32 s17, s17, s29
  s_waitcnt vmcnt(36)
  ds_read_b64_tr_b16 a[48:49], v146 offset:12288
  ds_read_b64_tr_b16 a[50:51], v147 offset:12288
  ds_read_b64_tr_b16 a[52:53], v146 offset:12352
  ds_read_b64_tr_b16 a[54:55], v147 offset:12352
  ds_read_b64_tr_b16 a[56:57], v146 offset:14336
  ds_read_b64_tr_b16 a[58:59], v147 offset:14336
  ds_read_b64_tr_b16 a[60:61], v146 offset:14400
  ds_read_b64_tr_b16 a[62:63], v147 offset:14400
  s_waitcnt lgkmcnt(0)
  s_add_u32 m0, s28, 12288
  s_nop 0
  buffer_load_dwordx4 v144, s[8:11], s17 offen lds
  s_add_u32 s17, s17, s29
  s_add_u32 m0, s28, 13312
  s_nop 0
  buffer_load_dwordx4 v144, s[8:11], s17 offen lds
  s_add_u32 s17, s17, s29
  s_add_u32 m0, s28, 14336
  s_nop 0
  buffer_load_dwordx4 v144, s[8:11], s17 offen lds
  s_add_u32 s17, s17, s29
  s_add_u32 m0, s28, 15360
  s_nop 0
  buffer_load_dwordx4 v144, s[8:11], s17 offen lds
  s_add_u32 s17, s17, s29
  s_waitcnt vmcnt(36)
  ds_read_b64_tr_b16 a[64:65], v146 offset:16384
  ds_read_b64_tr_b16 a[66:67], v147 offset:16384
  ds_read_b64_tr_b16 a[68:69], v146 offset:16448
  ds_read_b64_tr_b16 a[70:71], v147 offset:16448
  ds_read_b64_tr_b16 a[72:73], v146 offset:18432
  ds_read_b64_tr_b16 a[74:75], v147 offset:18432
  ds_read_b64_tr_b16 a[76:77], v146 offset:18496
  ds_read_b64_tr_b16 a[78:79], v147 offset:18496
  s_waitcnt lgkmcnt(0)
  s_add_u32 m0, s28, 16384
  s_nop 0
  buffer_load_dwordx4 v144, s[8:11], s17 offen lds
  s_add_u32 s17, s17, s29
  s_add_u32 m0, s28, 17408
  s_nop 0
  buffer_load_dwordx4 v144, s[8:11], s17 offen lds
  s_add_u32 s17, s17, s29
  s_add_u32 m0, s28, 18432
  s_nop 0
  buffer_load_dwordx4 v144, s[8:11], s17 offen lds
  s_add_u32 s17, s17, s29
  s_add_u32 m0, s28, 19456
  s_nop 0
  buffer_load_dwordx4 v144, s[8:11], s17 offen lds
  s_add_u32 s17, s17, s29
  s_waitcnt vmcnt(36)
  ds_read_b64_tr_b16 a[80:81], v146 offset:20480
  ds_read_b64_tr_b16 a[82:83], v147 offset:20480
  ds_read_b64_tr_b16 a[84:85], v146 offset:20544
  ds_read_b64_tr_b16 a[86:87], v147 offset:20544
  ds_read_b64_tr_b16 a[88:89], v146 offset:22528
  ds_read_b64_tr_b16 a[90:91], v147 offset:22528
  ds_read_b64_tr_b16 a[92:93], v146 offset:22592
  ds_read_b64_tr_b16 a[94:95], v147 offset:22592
  s_waitcnt lgkmcnt(0)
  s_add_u32 m0, s28, 20480
  s_nop 0
  buffer_load_dwordx4 v144, s[8:11], s17 offen lds
  s_add_u32 s17, s17, s29
  s_add_u32 m0, s28, 21504
  s_nop 0
  buffer_load_dwordx4 v144, s[8:11], s17 offen lds
  s_add_u32 s17, s17, s29
  s_add_u32 m0, s28, 22528
  s_nop 0
  buffer_load_dwordx4 v144, s[8:11], s17 offen lds
  s_add_u32 s17, s17, s29
  s_add_u32 m0, s28, 23552
  s_nop 0
  buffer_load_dwordx4 v144, s[8:11], s17 offen lds
  s_add_u32 s17, s17, s29
  s_waitcnt vmcnt(36)
  ds_read_b64_tr_b16 a[96:97], v146 offset:24576
  ds_read_b64_tr_b16 a[98:99], v147 offset:24576
  ds_read_b64_tr_b16 a[100:101], v146 offset:24640
  ds_read_b64_tr_b16 a[102:103], v147 offset:24640
  ds_read_b64_tr_b16 a[104:105], v146 offset:26624
  ds_read_b64_tr_b16 a[106:107], v147 offset:26624
  ds_read_b64_tr_b16 a[108:109], v146 offset:26688
  ds_read_b64_tr_b16 a[110:111], v147 offset:26688
  s_waitcnt lgkmcnt(0)
  s_add_u32 m0, s28, 24576
  s_nop 0
  buffer_load_dwordx4 v144, s[8:11], s17 offen lds
  s_add_u32 s17, s17, s29
  s_add_u32 m0, s28, 25600
  s_nop 0
  buffer_load_dwordx4 v144, s[8:11], s17 offen lds
  s_add_u32 s17, s17, s29
  s_add_u32 m0, s28, 26624
  s_nop 0
  buffer_load_dwordx4 v144, s[8:11], s17 offen lds
  s_add_u32 s17, s17, s29
  s_add_u32 m0, s28, 27648
  s_nop 0
  buffer_load_dwordx4 v144, s[8:11], s17 offen lds
  s_add_u32 s17, s17, s29
  s_waitcnt vmcnt(36)
  ds_read_b64_tr_b16 a[112:113], v146 offset:28672
  ds_read_b64_tr_b16 a[114:115], v147 offset:28672
  ds_read_b64_tr_b16 a[116:117], v146 offset:28736
  ds_read_b64_tr_b16 a[118:119], v147 offset:28736
  ds_read_b64_tr_b16 a[120:121], v146 offset:30720
  ds_read_b64_tr_b16 a[122:123], v147 offset:30720
  ds_read_b64_tr_b16 a[124:125], v146 offset:30784
  ds_read_b64_tr_b16 a[126:127], v147 offset:30784
  s_waitcnt lgkmcnt(0)
  s_add_u32 m0, s28, 28672
  s_nop 0
  buffer_load_dwordx4 v144, s[8:11], s17 offen lds
  s_add_u32 s17, s17, s29
  s_add_u32 m0, s28, 29696
  s_nop 0
  buffer_load_dwordx4 v144, s[8:11], s17 offen lds
  s_add_u32 s17, s17, s29
  s_add_u32 m0, s28, 30720
  s_nop 0
  buffer_load_dwordx4 v144, s[8:11], s17 offen lds
  s_add_u32 s17, s17, s29
  s_add_u32 m0, s28, 31744
  s_nop 0
  buffer_load_dwordx4 v144, s[8:11], s17 offen lds
  s_add_u32 s17, s17, s29
  s_waitcnt vmcnt(28)
  ds_read_b64_tr_b16 a[128:129], v146 offset:0
  ds_read_b64_tr_b16 a[130:131], v147 offset:0
  ds_read_b64_tr_b16 a[132:133], v146 offset:64
  ds_read_b64_tr_b16 a[134:135], v147 offset:64
  ds_read_b64_tr_b16 a[136:137], v146 offset:2048
  ds_read_b64_tr_b16 a[138:139], v147 offset:2048
  ds_read_b64_tr_b16 a[140:141], v146 offset:2112
  ds_read_b64_tr_b16 a[142:143], v147 offset:2112
  s_waitcnt lgkmcnt(0)
  s_waitcnt vmcnt(24)
  ds_read_b64_tr_b16 a[144:145], v146 offset:4096
  ds_read_b64_tr_b16 a[146:147], v147 offset:4096
  ds_read_b64_tr_b16 a[148:149], v146 offset:4160
  ds_read_b64_tr_b16 a[150:151], v147 offset:4160
  ds_read_b64_tr_b16 a[152:153], v146 offset:6144
  ds_read_b64_tr_b16 a[154:155], v147 offset:6144
  ds_read_b64_tr_b16 a[156:157], v146 offset:6208
  ds_read_b64_tr_b16 a[158:159], v147 offset:6208
  s_waitcnt lgkmcnt(0)
  s_waitcnt vmcnt(20)
  ds_read_b64_tr_b16 a[160:161], v146 offset:8192
  ds_read_b64_tr_b16 a[162:163], v147 offset:8192
  ds_read_b64_tr_b16 a[164:165], v146 offset:8256
  ds_read_b64_tr_b16 a[166:167], v147 offset:8256
  ds_read_b64_tr_b16 a[168:169], v146 offset:10240
  ds_read_b64_tr_b16 a[170:171], v147 offset:10240
  ds_read_b64_tr_b16 a[172:173], v146 offset:10304
  ds_read_b64_tr_b16 a[174:175], v147 offset:10304
  s_waitcnt lgkmcnt(0)
  s_waitcnt vmcnt(16)
  ds_read_b64_tr_b16 a[176:177], v146 offset:12288
  ds_read_b64_tr_b16 a[178:179], v147 offset:12288
  ds_read_b64_tr_b16 a[180:181], v146 offset:12352
  ds_read_b64_tr_b16 a[182:183], v147 offset:12352
  ds_read_b64_tr_b16 a[184:185], v146 offset:14336
  ds_read_b64_tr_b16 a[186:187], v147 offset:14336
  ds_read_b64_tr_b16 a[188:189], v146 offset:14400
  ds_read_b64_tr_b16 a[190:191], v147 offset:14400
  s_waitcnt lgkmcnt(0)
  s_waitcnt vmcnt(12)
  ds_read_b64_tr_b16 a[192:193], v146 offset:16384
  ds_read_b64_tr_b16 a[194:195], v147 offset:16384
  ds_read_b64_tr_b16 a[196:197], v146 offset:16448
  ds_read_b64_tr_b16 a[198:199], v147 offset:16448
  ds_read_b64_tr_b16 a[200:201], v146 offset:18432
  ds_read_b64_tr_b16 a[202:203], v147 offset:18432
  ds_read_b64_tr_b16 a[204:205], v146 offset:18496
  ds_read_b64_tr_b16 a[206:207], v147 offset:18496
  s_waitcnt lgkmcnt(0)
  s_waitcnt vmcnt(8)
  ds_read_b64_tr_b16 a[208:209], v146 offset:20480
  ds_read_b64_tr_b16 a[210:211], v147 offset:20480
  ds_read_b64_tr_b16 a[212:213], v146 offset:20544
  ds_read_b64_tr_b16 a[214:215], v147 offset:20544
  ds_read_b64_tr_b16 a[216:217], v146 offset:22528
  ds_read_b64_tr_b16 a[218:219], v147 offset:22528
  ds_read_b64_tr_b16 a[220:221], v146 offset:22592
  ds_read_b64_tr_b16 a[222:223], v147 offset:22592
  s_waitcnt lgkmcnt(0)
  s_waitcnt vmcnt(4)
  ds_read_b64_tr_b16 a[224:225], v146 offset:24576
  ds_read_b64_tr_b16 a[226:227], v147 offset:24576
  ds_read_b64_tr_b16 a[228:229], v146 offset:24640
  ds_read_b64_tr_b16 a[230:231], v147 offset:24640
  ds_read_b64_tr_b16 a[232:233], v146 offset:26624
  ds_read_b64_tr_b16 a[234:235], v147 offset:26624
  ds_read_b64_tr_b16 a[236:237], v146 offset:26688
  ds_read_b64_tr_b16 a[238:239], v147 offset:26688
  s_waitcnt lgkmcnt(0)
  s_waitcnt vmcnt(0)
  ds_read_b64_tr_b16 a[240:241], v146 offset:28672
  ds_read_b64_tr_b16 a[242:243], v147 offset:28672
  ds_read_b64_tr_b16 a[244:245], v146 offset:28736
  ds_read_b64_tr_b16 a[246:247], v147 offset:28736
  ds_read_b64_tr_b16 a[248:249], v146 offset:30720
  ds_read_b64_tr_b16 a[250:251], v147 offset:30720
  ds_read_b64_tr_b16 a[252:253], v146 offset:30784
  ds_read_b64_tr_b16 a[254:255], v147 offset:30784
  s_waitcnt lgkmcnt(0)
  s_barrier
  s_add_u32 m0, s25, 0
  s_nop 0
  buffer_load_dwordx4 v16, s[12:15], s19 offen lds
  s_add_u32 m0, s25, 1024
  s_nop 0
  buffer_load_dwordx4 v17, s[12:15], s19 offen lds
  s_add_u32 m0, s25, 2048
  s_nop 0
  buffer_load_dwordx4 v18, s[12:15], s19 offen lds
  s_add_u32 m0, s25, 3072
  s_nop 0
  buffer_load_dwordx4 v19, s[12:15], s19 offen lds
  s_add_u32 m0, s25, 4096
  s_nop 0
  buffer_load_dwordx4 v20, s[12:15], s19 offen lds
  s_add_u32 m0, s25, 5120
  s_nop 0
  buffer_load_dwordx4 v21, s[12:15], s19 offen lds
  s_add_u32 m0, s25, 6144
  s_nop 0
  buffer_load_dwordx4 v22, s[12:15], s19 offen lds
  s_add_u32 m0, s25, 7168
  s_nop 0
  buffer_load_dwordx4 v23, s[12:15], s19 offen lds
  s_cmp_gt_u32 s23, 2
  s_cselect_b32 s26, s20, 0
  s_add_u32 s19, s19, s26
  s_add_u32 s25, s25, 32768
  s_and_b32 s25, s25, 0x1ffff
  s_waitcnt vmcnt(0)
  s_barrier
  s_cmp_eq_u32 s48, 0
  s_cselect_b32 s26, 0, s16
  s_cmp_ge_u32 s26, 2
  s_cbranch_scc1 P_v_1
  s_mov_b32 s27, s21
  v_mov_b32 v7, 0x40000000
  s_mov_b32 s29, -3
  v_min_u32 v145, 1, v0
  v_lshlrev_b32 v145, 30, v145
  ds_read_b128 v[24:27], v8 offset:0
  ds_read_b128 v[28:31], v9 offset:0
  ds_read_b128 v[32:35], v10 offset:0
  ds_read_b128 v[36:39], v11 offset:0
  ds_read_b128 v[40:43], v12 offset:0
  ds_read_b128 v[44:47], v13 offset:0
.p2align 6
G_top_3:
  s_waitcnt lgkmcnt(5)
  v_mfma_f32_32x32x16_bf16 v[64:79], a[0:3], v[24:27], 0
  s_add_u32 m0, s25, 0
  ds_read_b128 v[48:51], v14 offset:0
  v_mfma_f32_32x32x16_bf16 v[80:95], a[4:7], v[24:27], 0
  s_waitcnt lgkmcnt(5)
  buffer_load_dwordx4 v16, s[12:15], s19 offen lds
  v_mfma_f32_32x32x16_bf16 v[64:79], a[8:11], v[28:31], v[64:79]
  ds_read_b128 v[52:55], v15 offset:0
  v_mul_f32 v96, s24, v96
  v_mul_f32 v97, s24, v97
  v_mfma_f32_32x32x16_bf16 v[80:95], a[12:15], v[28:31], v[80:95]
  s_waitcnt lgkmcnt(5)
  v_cvt_pk_bf16_f32 v128, v96, v97
  v_mul_f32 v98, s24, v98
  v_mfma_f32_32x32x16_bf16 v[64:79], a[16:19], v[32:35], v[64:79]
  s_add_u32 m0, s25, 1024
  ds_read_b128 v[24:27], v8 offset:8192
  v_mul_f32 v99, s24, v99
  v_cvt_pk_bf16_f32 v129, v98, v99
  v_mfma_f32_32x32x16_bf16 v[80:95], a[20:23], v[32:35], v[80:95]
  s_waitcnt lgkmcnt(5)
  buffer_load_dwordx4 v17, s[12:15], s19 offen lds
  v_mul_f32 v100, s24, v100
  v_mul_f32 v101, s24, v101
  v_mfma_f32_32x32x16_bf16 v[64:79], a[24:27], v[36:39], v[64:79]
  ds_read_b128 v[28:31], v9 offset:8192
  v_cvt_pk_bf16_f32 v130, v100, v101
  v_mul_f32 v102, s24, v102
  v_mfma_f32_32x32x16_bf16 v[80:95], a[28:31], v[36:39], v[80:95]
  s_waitcnt lgkmcnt(5)
  v_mul_f32 v103, s24, v103
  v_cvt_pk_bf16_f32 v131, v102, v103
  v_mfma_f32_32x32x16_bf16 v[64:79], a[32:35], v[40:43], v[64:79]
  s_add_u32 m0, s25, 2048
  ds_read_b128 v[32:35], v10 offset:8192
  v_mul_f32 v104, s24, v104
  v_mul_f32 v105, s24, v105
  v_mfma_f32_32x32x16_bf16 v[80:95], a[36:39], v[40:43], v[80:95]
  s_waitcnt lgkmcnt(5)
  buffer_load_dwordx4 v18, s[12:15], s19 offen lds
  v_cvt_pk_bf16_f32 v132, v104, v105
  v_mul_f32 v106, s24, v106
  v_mfma_f32_32x32x16_bf16 v[64:79], a[40:43], v[44:47], v[64:79]
  ds_read_b128 v[36:39], v11 offset:8192
  v_mul_f32 v107, s24, v107
  v_cvt_pk_bf16_f32 v133, v106, v107
  v_mfma_f32_32x32x16_bf16 v[80:95], a[44:47], v[44:47], v[80:95]
  s_waitcnt lgkmcnt(5)
  v_mul_f32 v108, s24, v108
  v_mul_f32 v109, s24, v109
  v_mfma_f32_32x32x16_bf16 v[64:79], a[48:51], v[48:51], v[64:79]
  s_add_u32 m0, s25, 3072
  ds_read_b128 v[40:43], v12 offset:8192
  v_cvt_pk_bf16_f32 v134, v108, v109
  v_mul_f32 v110, s24, v110
  v_mfma_f32_32x32x16_bf16 v[80:95], a[52:55], v[48:51], v[80:95]
  s_waitcnt lgkmcnt(5)
  buffer_load_dwordx4 v19, s[12:15], s19 offen lds
  v_mul_f32 v111, s24, v111
  v_cvt_pk_bf16_f32 v135, v110, v111
  v_mfma_f32_32x32x16_bf16 v[64:79], a[56:59], v[52:55], v[64:79]
  ds_read_b128 v[44:47], v13 offset:8192
  v_mul_f32 v112, s24, v112
  v_mul_f32 v113, s24, v113
  v_mfma_f32_32x32x16_bf16 v[80:95], a[60:63], v[52:55], v[80:95]
  s_waitcnt lgkmcnt(5)
  v_cvt_pk_bf16_f32 v136, v112, v113
  v_mul_f32 v114, s24, v114
  v_mfma_f32_32x32x16_bf16 v[64:79], a[64:67], v[24:27], v[64:79]
  s_add_u32 m0, s25, 4096
  ds_read_b128 v[48:51], v14 offset:8192
  v_mul_f32 v115, s24, v115
  v_cvt_pk_bf16_f32 v137, v114, v115
  v_mfma_f32_32x32x16_bf16 v[80:95], a[68:71], v[24:27], v[80:95]
  s_waitcnt lgkmcnt(5)
  buffer_load_dwordx4 v20, s[12:15], s19 offen lds
  v_mul_f32 v116, s24, v116
  v_mul_f32 v117, s24, v117
  v_mfma_f32_32x32x16_bf16 v[64:79], a[72:75], v[28:31], v[64:79]
  ds_read_b128 v[52:55], v15 offset:8192
  v_cvt_pk_bf16_f32 v138, v116, v117
  v_mul_f32 v118, s24, v118
  v_mfma_f32_32x32x16_bf16 v[80:95], a[76:79], v[28:31], v[80:95]
  s_waitcnt lgkmcnt(5)
  v_mul_f32 v119, s24, v119
  v_cvt_pk_bf16_f32 v139, v118, v119
  v_mfma_f32_32x32x16_bf16 v[64:79], a[80:83], v[32:35], v[64:79]
  s_add_u32 m0, s25, 5120
  ds_read_b128 v[24:27], v8 offset:16384
  v_mul_f32 v120, s24, v120
  v_mul_f32 v121, s24, v121
  v_mfma_f32_32x32x16_bf16 v[80:95], a[84:87], v[32:35], v[80:95]
  s_waitcnt lgkmcnt(5)
  buffer_load_dwordx4 v21, s[12:15], s19 offen lds
  v_cvt_pk_bf16_f32 v140, v120, v121
  v_mul_f32 v122, s24, v122
  v_mfma_f32_32x32x16_bf16 v[64:79], a[88:91], v[36:39], v[64:79]
  ds_read_b128 v[28:31], v9 offset:16384
  v_mul_f32 v123, s24, v123
  v_cvt_pk_bf16_f32 v141, v122, v123
  v_mfma_f32_32x32x16_bf16 v[80:95], a[92:95], v[36:39], v[80:95]
  s_waitcnt lgkmcnt(5)
  v_mul_f32 v124, s24, v124
  v_mul_f32 v125, s24, v125
  v_mfma_f32_32x32x16_bf16 v[64:79], a[96:99], v[40:43], v[64:79]
  s_add_u32 m0, s25, 6144
  ds_read_b128 v[32:35], v10 offset:16384
  v_cvt_pk_bf16_f32 v142, v124, v125
  v_mul_f32 v126, s24, v126
  v_mfma_f32_32x32x16_bf16 v[80:95], a[100:103], v[40:43], v[80:95]
  s_waitcnt lgkmcnt(5)
  buffer_load_dwordx4 v22, s[12:15], s19 offen lds
  v_mul_f32 v127, s24, v127
  v_cvt_pk_bf16_f32 v143, v126, v127
  v_mfma_f32_32x32x16_bf16 v[64:79], a[104:107], v[44:47], v[64:79]
  ds_read_b128 v[36:39], v11 offset:16384
  v_mfma_f32_32x32x16_bf16 v[80:95], a[108:111], v[44:47], v[80:95]
  s_waitcnt lgkmcnt(5)
  v_mfma_f32_32x32x16_bf16 v[64:79], a[112:115], v[48:51], v[64:79]
  s_add_u32 m0, s25, 7168
  ds_read_b128 v[40:43], v12 offset:16384
  v_mfma_f32_32x32x16_bf16 v[80:95], a[116:119], v[48:51], v[80:95]
  s_waitcnt lgkmcnt(5)
  buffer_load_dwordx4 v23, s[12:15], s19 offen lds
  v_mfma_f32_32x32x16_bf16 v[64:79], a[120:123], v[52:55], v[64:79]
  s_cmp_gt_u32 s23, 3
  ds_read_b128 v[44:47], v13 offset:16384
  v_mfma_f32_32x32x16_bf16 v[80:95], a[124:127], v[52:55], v[80:95]
  s_waitcnt lgkmcnt(5)
  s_cselect_b32 s26, s20, 0
  v_mfma_f32_32x32x16_bf16 v[64:79], a[128:131], v[24:27], v[64:79]
  s_add_u32 s19, s19, s26
  ds_read_b128 v[48:51], v14 offset:16384
  v_mfma_f32_32x32x16_bf16 v[80:95], a[132:135], v[24:27], v[80:95]
  s_waitcnt lgkmcnt(5)
  s_add_u32 s25, s25, 32768
  v_mfma_f32_32x32x16_bf16 v[64:79], a[136:139], v[28:31], v[64:79]
  s_and_b32 s25, s25, 0x1ffff
  ds_read_b128 v[52:55], v15 offset:16384
  v_mfma_f32_32x32x16_bf16 v[80:95], a[140:143], v[28:31], v[80:95]
  s_waitcnt lgkmcnt(5)
  buffer_store_dwordx4 v[128:131], v7, s[4:7], s21 offen offset:0 sc1
  v_mfma_f32_32x32x16_bf16 v[64:79], a[144:147], v[32:35], v[64:79]
  ds_read_b128 v[24:27], v8 offset:24576
  v_mfma_f32_32x32x16_bf16 v[80:95], a[148:151], v[32:35], v[80:95]
  s_waitcnt lgkmcnt(5)
  v_mfma_f32_32x32x16_bf16 v[64:79], a[152:155], v[36:39], v[64:79]
  ds_read_b128 v[28:31], v9 offset:24576
  v_mfma_f32_32x32x16_bf16 v[80:95], a[156:159], v[36:39], v[80:95]
  s_waitcnt lgkmcnt(5)
  buffer_store_dwordx4 v[132:135], v7, s[4:7], s21 offen offset:1024 sc1
  v_mfma_f32_32x32x16_bf16 v[64:79], a[160:163], v[40:43], v[64:79]
  ds_read_b128 v[32:35], v10 offset:24576
  v_mfma_f32_32x32x16_bf16 v[80:95], a[164:167], v[40:43], v[80:95]
  s_waitcnt lgkmcnt(5)
  v_mfma_f32_32x32x16_bf16 v[64:79], a[168:171], v[44:47], v[64:79]
  ds_read_b128 v[36:39], v11 offset:24576
  v_mfma_f32_32x32x16_bf16 v[80:95], a[172:175], v[44:47], v[80:95]
  s_waitcnt lgkmcnt(5)
  buffer_store_dwordx4 v[136:139], v7, s[4:7], s21 offen offset:2048 sc1
  v_mfma_f32_32x32x16_bf16 v[64:79], a[176:179], v[48:51], v[64:79]
  ds_read_b128 v[40:43], v12 offset:24576
  v_mfma_f32_32x32x16_bf16 v[80:95], a[180:183], v[48:51], v[80:95]
  s_waitcnt lgkmcnt(5)
  v_mfma_f32_32x32x16_bf16 v[64:79], a[184:187], v[52:55], v[64:79]
  ds_read_b128 v[44:47], v13 offset:24576
  v_mfma_f32_32x32x16_bf16 v[80:95], a[188:191], v[52:55], v[80:95]
  s_waitcnt lgkmcnt(5)
  buffer_store_dwordx4 v[140:143], v7, s[4:7], s21 offen offset:3072 sc1
  v_mfma_f32_32x32x16_bf16 v[64:79], a[192:195], v[24:27], v[64:79]
  s_mov_b32 s21, s27
  ds_read_b128 v[48:51], v14 offset:24576
  v_mov_b32 v7, v2
  v_mfma_f32_32x32x16_bf16 v[80:95], a[196:199], v[24:27], v[80:95]
  s_waitcnt lgkmcnt(5)
  v_mfma_f32_32x32x16_bf16 v[64:79], a[200:203], v[28:31], v[64:79]
  s_add_u32 s27, s27, s22
  ds_read_b128 v[52:55], v15 offset:24576
  v_mfma_f32_32x32x16_bf16 v[80:95], a[204:207], v[28:31], v[80:95]
  s_waitcnt lgkmcnt(5)
  s_waitcnt vmcnt(17)
  s_barrier
  v_mfma_f32_32x32x16_bf16 v[64:79], a[208:211], v[32:35], v[64:79]
  ds_read_b128 v[24:27], v8 offset:32768
  v_mfma_f32_32x32x16_bf16 v[80:95], a[212:215], v[32:35], v[80:95]
  s_waitcnt lgkmcnt(5)
  v_mfma_f32_32x32x16_bf16 v[64:79], a[216:219], v[36:39], v[64:79]
  s_add_u32 s29, s29, 1
  ds_read_b128 v[28:31], v9 offset:32768
  v_mfma_f32_32x32x16_bf16 v[80:95], a[220:223], v[36:39], v[80:95]
  s_waitcnt lgkmcnt(5)
  s_max_i32 s30, s29, 0
  v_mov_b32 v144, s30
  v_mfma_f32_32x32x16_bf16 v[64:79], a[224:227], v[40:43], v[64:79]
  ds_read_b128 v[32:35], v10 offset:32768
  v_mfma_f32_32x32x16_bf16 v[80:95], a[228:231], v[40:43], v[80:95]
  s_waitcnt lgkmcnt(5)
  buffer_store_dword v144, v145, s[4:7], s31 offen sc1
  v_mfma_f32_32x32x16_bf16 v[64:79], a[232:235], v[44:47], v[64:79]
  ds_read_b128 v[36:39], v11 offset:32768
  v_mfma_f32_32x32x16_bf16 v[80:95], a[236:239], v[44:47], v[80:95]
  s_waitcnt lgkmcnt(5)
  v_mfma_f32_32x32x16_bf16 v[64:79], a[240:243], v[48:51], v[64:79]
  s_sub_u32 s23, s23, 1
  ds_read_b128 v[40:43], v12 offset:32768
  v_mfma_f32_32x32x16_bf16 v[80:95], a[244:247], v[48:51], v[80:95]
  s_waitcnt lgkmcnt(5)
  v_mfma_f32_32x32x16_bf16 v[64:79], a[248:251], v[52:55], v[64:79]
  s_cmp_eq_u32 s23, 0
  ds_read_b128 v[44:47], v13 offset:32768
  v_mfma_f32_32x32x16_bf16 v[80:95], a[252:255], v[52:55], v[80:95]
  s_cbranch_scc1 G_done0_4
  s_waitcnt lgkmcnt(5)
  v_mfma_f32_32x32x16_bf16 v[96:111], a[0:3], v[24:27], 0
  s_add_u32 m0, s25, 0
  ds_read_b128 v[48:51], v14 offset:32768
  v_mfma_f32_32x32x16_bf16 v[112:127], a[4:7], v[24:27], 0
  s_waitcnt lgkmcnt(5)
  buffer_load_dwordx4 v16, s[12:15], s19 offen lds
  v_mfma_f32_32x32x16_bf16 v[96:111], a[8:11], v[28:31], v[96:111]
  ds_read_b128 v[52:55], v15 offset:32768
  v_mul_f32 v64, s24, v64
  v_mul_f32 v65, s24, v65
  v_mfma_f32_32x32x16_bf16 v[112:127], a[12:15], v[28:31], v[112:127]
  s_waitcnt lgkmcnt(5)
  v_cvt_pk_bf16_f32 v128, v64, v65
  v_mul_f32 v66, s24, v66
  v_mfma_f32_32x32x16_bf16 v[96:111], a[16:19], v[32:35], v[96:111]
  s_add_u32 m0, s25, 1024
  ds_read_b128 v[24:27], v8 offset:40960
  v_mul_f32 v67, s24, v67
  v_cvt_pk_bf16_f32 v129, v66, v67
  v_mfma_f32_32x32x16_bf16 v[112:127], a[20:23], v[32:35], v[112:127]
  s_waitcnt lgkmcnt(5)
  buffer_load_dwordx4 v17, s[12:15], s19 offen lds
  v_mul_f32 v68, s24, v68
  v_mul_f32 v69, s24, v69
  v_mfma_f32_32x32x16_bf16 v[96:111], a[24:27], v[36:39], v[96:111]
  ds_read_b128 v[28:31], v9 offset:40960
  v_cvt_pk_bf16_f32 v130, v68, v69
  v_mul_f32 v70, s24, v70
  v_mfma_f32_32x32x16_bf16 v[112:127], a[28:31], v[36:39], v[112:127]
  s_waitcnt lgkmcnt(5)
  v_mul_f32 v71, s24, v71
  v_cvt_pk_bf16_f32 v131, v70, v71
  v_mfma_f32_32x32x16_bf16 v[96:111], a[32:35], v[40:43], v[96:111]
  s_add_u32 m0, s25, 2048
  ds_read_b128 v[32:35], v10 offset:40960
  v_mul_f32 v72, s24, v72
  v_mul_f32 v73, s24, v73
  v_mfma_f32_32x32x16_bf16 v[112:127], a[36:39], v[40:43], v[112:127]
  s_waitcnt lgkmcnt(5)
  buffer_load_dwordx4 v18, s[12:15], s19 offen lds
  v_cvt_pk_bf16_f32 v132, v72, v73
  v_mul_f32 v74, s24, v74
  v_mfma_f32_32x32x16_bf16 v[96:111], a[40:43], v[44:47], v[96:111]
  ds_read_b128 v[36:39], v11 offset:40960
  v_mul_f32 v75, s24, v75
  v_cvt_pk_bf16_f32 v133, v74, v75
  v_mfma_f32_32x32x16_bf16 v[112:127], a[44:47], v[44:47], v[112:127]
  s_waitcnt lgkmcnt(5)
  v_mul_f32 v76, s24, v76
  v_mul_f32 v77, s24, v77
  v_mfma_f32_32x32x16_bf16 v[96:111], a[48:51], v[48:51], v[96:111]
  s_add_u32 m0, s25, 3072
  ds_read_b128 v[40:43], v12 offset:40960
  v_cvt_pk_bf16_f32 v134, v76, v77
  v_mul_f32 v78, s24, v78
  v_mfma_f32_32x32x16_bf16 v[112:127], a[52:55], v[48:51], v[112:127]
  s_waitcnt lgkmcnt(5)
  buffer_load_dwordx4 v19, s[12:15], s19 offen lds
  v_mul_f32 v79, s24, v79
  v_cvt_pk_bf16_f32 v135, v78, v79
  v_mfma_f32_32x32x16_bf16 v[96:111], a[56:59], v[52:55], v[96:111]
  ds_read_b128 v[44:47], v13 offset:40960
  v_mul_f32 v80, s24, v80
  v_mul_f32 v81, s24, v81
  v_mfma_f32_32x32x16_bf16 v[112:127], a[60:63], v[52:55], v[112:127]
  s_waitcnt lgkmcnt(5)
  v_cvt_pk_bf16_f32 v136, v80, v81
  v_mul_f32 v82, s24, v82
  v_mfma_f32_32x32x16_bf16 v[96:111], a[64:67], v[24:27], v[96:111]
  s_add_u32 m0, s25, 4096
  ds_read_b128 v[48:51], v14 offset:40960
  v_mul_f32 v83, s24, v83
  v_cvt_pk_bf16_f32 v137, v82, v83
  v_mfma_f32_32x32x16_bf16 v[112:127], a[68:71], v[24:27], v[112:127]
  s_waitcnt lgkmcnt(5)
  buffer_load_dwordx4 v20, s[12:15], s19 offen lds
  v_mul_f32 v84, s24, v84
  v_mul_f32 v85, s24, v85
  v_mfma_f32_32x32x16_bf16 v[96:111], a[72:75], v[28:31], v[96:111]
  ds_read_b128 v[52:55], v15 offset:40960
  v_cvt_pk_bf16_f32 v138, v84, v85
  v_mul_f32 v86, s24, v86
  v_mfma_f32_32x32x16_bf16 v[112:127], a[76:79], v[28:31], v[112:127]
  s_waitcnt lgkmcnt(5)
  v_mul_f32 v87, s24, v87
  v_cvt_pk_bf16_f32 v139, v86, v87
  v_mfma_f32_32x32x16_bf16 v[96:111], a[80:83], v[32:35], v[96:111]
  s_add_u32 m0, s25, 5120
  ds_read_b128 v[24:27], v8 offset:49152
  v_mul_f32 v88, s24, v88
  v_mul_f32 v89, s24, v89
  v_mfma_f32_32x32x16_bf16 v[112:127], a[84:87], v[32:35], v[112:127]
  s_waitcnt lgkmcnt(5)
  buffer_load_dwordx4 v21, s[12:15], s19 offen lds
  v_cvt_pk_bf16_f32 v140, v88, v89
  v_mul_f32 v90, s24, v90
  v_mfma_f32_32x32x16_bf16 v[96:111], a[88:91], v[36:39], v[96:111]
  ds_read_b128 v[28:31], v9 offset:49152
  v_mul_f32 v91, s24, v91
  v_cvt_pk_bf16_f32 v141, v90, v91
  v_mfma_f32_32x32x16_bf16 v[112:127], a[92:95], v[36:39], v[112:127]
  s_waitcnt lgkmcnt(5)
  v_mul_f32 v92, s24, v92
  v_mul_f32 v93, s24, v93
  v_mfma_f32_32x32x16_bf16 v[96:111], a[96:99], v[40:43], v[96:111]
  s_add_u32 m0, s25, 6144
  ds_read_b128 v[32:35], v10 offset:49152
  v_cvt_pk_bf16_f32 v142, v92, v93
  v_mul_f32 v94, s24, v94
  v_mfma_f32_32x32x16_bf16 v[112:127], a[100:103], v[40:43], v[112:127]
  s_waitcnt lgkmcnt(5)
  buffer_load_dwordx4 v22, s[12:15], s19 offen lds
  v_mul_f32 v95, s24, v95
  v_cvt_pk_bf16_f32 v143, v94, v95
  v_mfma_f32_32x32x16_bf16 v[96:111], a[104:107], v[44:47], v[96:111]
  ds_read_b128 v[36:39], v11 offset:49152
  v_mfma_f32_32x32x16_bf16 v[112:127], a[108:111], v[44:47], v[112:127]
  s_waitcnt lgkmcnt(5)
  v_mfma_f32_32x32x16_bf16 v[96:111], a[112:115], v[48:51], v[96:111]
  s_add_u32 m0, s25, 7168
  ds_read_b128 v[40:43], v12 offset:49152
  v_mfma_f32_32x32x16_bf16 v[112:127], a[116:119], v[48:51], v[112:127]
  s_waitcnt lgkmcnt(5)
  buffer_load_dwordx4 v23, s[12:15], s19 offen lds
  v_mfma_f32_32x32x16_bf16 v[96:111], a[120:123], v[52:55], v[96:111]
  s_cmp_gt_u32 s23, 3
  ds_read_b128 v[44:47], v13 offset:49152
  v_mfma_f32_32x32x16_bf16 v[112:127], a[124:127], v[52:55], v[112:127]
  s_waitcnt lgkmcnt(5)
  s_cselect_b32 s26, s20, 0
  v_mfma_f32_32x32x16_bf16 v[96:111], a[128:131], v[24:27], v[96:111]
  s_add_u32 s19, s19, s26
  ds_read_b128 v[48:51], v14 offset:49152
  v_mfma_f32_32x32x16_bf16 v[112:127], a[132:135], v[24:27], v[112:127]
  s_waitcnt lgkmcnt(5)
  s_add_u32 s25, s25, 32768
  v_mfma_f32_32x32x16_bf16 v[96:111], a[136:139], v[28:31], v[96:111]
  s_and_b32 s25, s25, 0x1ffff
  ds_read_b128 v[52:55], v15 offset:49152
  v_mfma_f32_32x32x16_bf16 v[112:127], a[140:143], v[28:31], v[112:127]
  s_waitcnt lgkmcnt(5)
  buffer_store_dwordx4 v[128:131], v7, s[4:7], s21 offen offset:0 sc1
  v_mfma_f32_32x32x16_bf16 v[96:111], a[144:147], v[32:35], v[96:111]
  ds_read_b128 v[24:27], v8 offset:57344
  v_mfma_f32_32x32x16_bf16 v[112:127], a[148:151], v[32:35], v[112:127]
  s_waitcnt lgkmcnt(5)
  v_xor_b32 v8, 0x10000, v8
  v_mfma_f32_32x32x16_bf16 v[96:111], a[152:155], v[36:39], v[96:111]
  ds_read_b128 v[28:31], v9 offset:57344
  v_mfma_f32_32x32x16_bf16 v[112:127], a[156:159], v[36:39], v[112:127]
  s_waitcnt lgkmcnt(5)
  buffer_store_dwordx4 v[132:135], v7, s[4:7], s21 offen offset:1024 sc1
  v_xor_b32 v9, 0x10000, v9
  v_mfma_f32_32x32x16_bf16 v[96:111], a[160:163], v[40:43], v[96:111]
  ds_read_b128 v[32:35], v10 offset:57344
  v_mfma_f32_32x32x16_bf16 v[112:127], a[164:167], v[40:43], v[112:127]
  s_waitcnt lgkmcnt(5)
  v_xor_b32 v10, 0x10000, v10
  v_mfma_f32_32x32x16_bf16 v[96:111], a[168:171], v[44:47], v[96:111]
  ds_read_b128 v[36:39], v11 offset:57344
  v_mfma_f32_32x32x16_bf16 v[112:127], a[172:175], v[44:47], v[112:127]
  s_waitcnt lgkmcnt(5)
  buffer_store_dwordx4 v[136:139], v7, s[4:7], s21 offen offset:2048 sc1
  v_xor_b32 v11, 0x10000, v11
  v_mfma_f32_32x32x16_bf16 v[96:111], a[176:179], v[48:51], v[96:111]
  ds_read_b128 v[40:43], v12 offset:57344
  v_mfma_f32_32x32x16_bf16 v[112:127], a[180:183], v[48:51], v[112:127]
  s_waitcnt lgkmcnt(5)
  v_xor_b32 v12, 0x10000, v12
  v_mfma_f32_32x32x16_bf16 v[96:111], a[184:187], v[52:55], v[96:111]
  ds_read_b128 v[44:47], v13 offset:57344
  v_mfma_f32_32x32x16_bf16 v[112:127], a[188:191], v[52:55], v[112:127]
  s_waitcnt lgkmcnt(5)
  buffer_store_dwordx4 v[140:143], v7, s[4:7], s21 offen offset:3072 sc1
  v_xor_b32 v13, 0x10000, v13
  v_mfma_f32_32x32x16_bf16 v[96:111], a[192:195], v[24:27], v[96:111]
  s_mov_b32 s21, s27
  ds_read_b128 v[48:51], v14 offset:57344
  v_mov_b32 v7, v2
  v_mfma_f32_32x32x16_bf16 v[112:127], a[196:199], v[24:27], v[112:127]
  s_waitcnt lgkmcnt(5)
  v_xor_b32 v14, 0x10000, v14
  v_mfma_f32_32x32x16_bf16 v[96:111], a[200:203], v[28:31], v[96:111]
  s_add_u32 s27, s27, s22
  ds_read_b128 v[52:55], v15 offset:57344
  v_mfma_f32_32x32x16_bf16 v[112:127], a[204:207], v[28:31], v[112:127]
  s_waitcnt lgkmcnt(5)
  s_waitcnt vmcnt(17)
  s_barrier
  v_xor_b32 v15, 0x10000, v15
  v_mfma_f32_32x32x16_bf16 v[96:111], a[208:211], v[32:35], v[96:111]
  ds_read_b128 v[24:27], v8 offset:0
  v_mfma_f32_32x32x16_bf16 v[112:127], a[212:215], v[32:35], v[112:127]
  s_waitcnt lgkmcnt(5)
  v_mfma_f32_32x32x16_bf16 v[96:111], a[216:219], v[36:39], v[96:111]
  s_add_u32 s29, s29, 1
  ds_read_b128 v[28:31], v9 offset:0
  v_mfma_f32_32x32x16_bf16 v[112:127], a[220:223], v[36:39], v[112:127]
  s_waitcnt lgkmcnt(5)
  s_max_i32 s30, s29, 0
  v_mov_b32 v144, s30
  v_mfma_f32_32x32x16_bf16 v[96:111], a[224:227], v[40:43], v[96:111]
  ds_read_b128 v[32:35], v10 offset:0
  v_mfma_f32_32x32x16_bf16 v[112:127], a[228:231], v[40:43], v[112:127]
  s_waitcnt lgkmcnt(5)
  buffer_store_dword v144, v145, s[4:7], s31 offen sc1
  v_mfma_f32_32x32x16_bf16 v[96:111], a[232:235], v[44:47], v[96:111]
  ds_read_b128 v[36:39], v11 offset:0
  v_mfma_f32_32x32x16_bf16 v[112:127], a[236:239], v[44:47], v[112:127]
  s_waitcnt lgkmcnt(5)
  v_mfma_f32_32x32x16_bf16 v[96:111], a[240:243], v[48:51], v[96:111]
  s_sub_u32 s23, s23, 1
  ds_read_b128 v[40:43], v12 offset:0
  v_mfma_f32_32x32x16_bf16 v[112:127], a[244:247], v[48:51], v[112:127]
  s_waitcnt lgkmcnt(5)
  v_mfma_f32_32x32x16_bf16 v[96:111], a[248:251], v[52:55], v[96:111]
  s_cmp_eq_u32 s23, 0
  ds_read_b128 v[44:47], v13 offset:0
  v_mfma_f32_32x32x16_bf16 v[112:127], a[252:255], v[52:55], v[112:127]
  s_cbranch_scc1 G_done1_5
  s_branch G_top_3
G_done0_4:
  s_nop 7
  s_nop 3
  v_mul_f32 v64, s24, v64
  v_mul_f32 v65, s24, v65
  v_cvt_pk_bf16_f32 v128, v64, v65
  v_mul_f32 v66, s24, v66
  v_mul_f32 v67, s24, v67
  v_cvt_pk_bf16_f32 v129, v66, v67
  v_mul_f32 v68, s24, v68
  v_mul_f32 v69, s24, v69
  v_cvt_pk_bf16_f32 v130, v68, v69
  v_mul_f32 v70, s24, v70
  v_mul_f32 v71, s24, v71
  v_cvt_pk_bf16_f32 v131, v70, v71
  buffer_store_dwordx4 v[128:131], v7, s[4:7], s21 offen offset:0 sc1
  v_mul_f32 v72, s24, v72
  v_mul_f32 v73, s24, v73
  v_cvt_pk_bf16_f32 v132, v72, v73
  v_mul_f32 v74, s24, v74
  v_mul_f32 v75, s24, v75
  v_cvt_pk_bf16_f32 v133, v74, v75
  v_mul_f32 v76, s24, v76
  v_mul_f32 v77, s24, v77
  v_cvt_pk_bf16_f32 v134, v76, v77
  v_mul_f32 v78, s24, v78
  v_mul_f32 v79, s24, v79
  v_cvt_pk_bf16_f32 v135, v78, v79
  buffer_store_dwordx4 v[132:135], v7, s[4:7], s21 offen offset:1024 sc1
  v_mul_f32 v80, s24, v80
  v_mul_f32 v81, s24, v81
  v_cvt_pk_bf16_f32 v136, v80, v81
  v_mul_f32 v82, s24, v82
  v_mul_f32 v83, s24, v83
  v_cvt_pk_bf16_f32 v137, v82, v83
  v_mul_f32 v84, s24, v84
  v_mul_f32 v85, s24, v85
  v_cvt_pk_bf16_f32 v138, v84, v85
  v_mul_f32 v86, s24, v86
  v_mul_f32 v87, s24, v87
  v_cvt_pk_bf16_f32 v139, v86, v87
  buffer_store_dwordx4 v[136:139], v7, s[4:7], s21 offen offset:2048 sc1
  v_mul_f32 v88, s24, v88
  v_mul_f32 v89, s24, v89
  v_cvt_pk_bf16_f32 v140, v88, v89
  v_mul_f32 v90, s24, v90
  v_mul_f32 v91, s24, v91
  v_cvt_pk_bf16_f32 v141, v90, v91
  v_mul_f32 v92, s24, v92
  v_mul_f32 v93, s24, v93
  v_cvt_pk_bf16_f32 v142, v92, v93
  v_mul_f32 v94, s24, v94
  v_mul_f32 v95, s24, v95
  v_cvt_pk_bf16_f32 v143, v94, v95
  buffer_store_dwordx4 v[140:143], v7, s[4:7], s21 offen offset:3072 sc1
  s_branch G_fin_6
G_done1_5:
  s_nop 7
  s_nop 3
  v_mul_f32 v96, s24, v96
  v_mul_f32 v97, s24, v97
  v_cvt_pk_bf16_f32 v128, v96, v97
  v_mul_f32 v98, s24, v98
  v_mul_f32 v99, s24, v99
  v_cvt_pk_bf16_f32 v129, v98, v99
  v_mul_f32 v100, s24, v100
  v_mul_f32 v101, s24, v101
  v_cvt_pk_bf16_f32 v130, v100, v101
  v_mul_f32 v102, s24, v102
  v_mul_f32 v103, s24, v103
  v_cvt_pk_bf16_f32 v131, v102, v103
  buffer_store_dwordx4 v[128:131], v7, s[4:7], s21 offen offset:0 sc1
  v_mul_f32 v104, s24, v104
  v_mul_f32 v105, s24, v105
  v_cvt_pk_bf16_f32 v132, v104, v105
  v_mul_f32 v106, s24, v106
  v_mul_f32 v107, s24, v107
  v_cvt_pk_bf16_f32 v133, v106, v107
  v_mul_f32 v108, s24, v108
  v_mul_f32 v109, s24, v109
  v_cvt_pk_bf16_f32 v134, v108, v109
  v_mul_f32 v110, s24, v110
  v_mul_f32 v111, s24, v111
  v_cvt_pk_bf16_f32 v135, v110, v111
  buffer_store_dwordx4 v[132:135], v7, s[4:7], s21 offen offset:1024 sc1
  v_mul_f32 v112, s24, v112
  v_mul_f32 v113, s24, v113
  v_cvt_pk_bf16_f32 v136, v112, v113
  v_mul_f32 v114, s24, v114
  v_mul_f32 v115, s24, v115
  v_cvt_pk_bf16_f32 v137, v114, v115
  v_mul_f32 v116, s24, v116
  v_mul_f32 v117, s24, v117
  v_cvt_pk_bf16_f32 v138, v116, v117
  v_mul_f32 v118, s24, v118
  v_mul_f32 v119, s24, v119
  v_cvt_pk_bf16_f32 v139, v118, v119
  buffer_store_dwordx4 v[136:139], v7, s[4:7], s21 offen offset:2048 sc1
  v_mul_f32 v120, s24, v120
  v_mul_f32 v121, s24, v121
  v_cvt_pk_bf16_f32 v140, v120, v121
  v_mul_f32 v122, s24, v122
  v_mul_f32 v123, s24, v123
  v_cvt_pk_bf16_f32 v141, v122, v123
  v_mul_f32 v124, s24, v124
  v_mul_f32 v125, s24, v125
  v_cvt_pk_bf16_f32 v142, v124, v125
  v_mul_f32 v126, s24, v126
  v_mul_f32 v127, s24, v127
  v_cvt_pk_bf16_f32 v143, v126, v127
  buffer_store_dwordx4 v[140:143], v7, s[4:7], s21 offen offset:3072 sc1
G_fin_6:
  s_waitcnt vmcnt(0) lgkmcnt(0)
  s_barrier
  s_add_u32 s30, s29, 3
  v_mov_b32 v144, s30
  v_min_u32 v145, 1, v0
  v_lshlrev_b32 v145, 30, v145
  buffer_store_dword v144, v145, s[4:7], s31 offen sc1
  s_branch P_end_2
P_v_1:
  s_mov_b32 s27, s21
  v_mov_b32 v7, 0x40000000
  s_mov_b32 s29, -3
  v_min_u32 v145, 1, v0
  v_lshlrev_b32 v145, 30, v145
  ds_read_b128 v[24:27], v8 offset:0
  ds_read_b128 v[28:31], v9 offset:0
  ds_read_b128 v[32:35], v10 offset:0
  ds_read_b128 v[36:39], v11 offset:0
  ds_read_b128 v[40:43], v12 offset:0
  ds_read_b128 v[44:47], v13 offset:0
.p2align 6
G_top_7:
  s_waitcnt lgkmcnt(5)
  v_mfma_f32_32x32x16_bf16 v[64:79], v[24:27], a[0:3], 0
  s_add_u32 m0, s25, 0
  ds_read_b128 v[48:51], v14 offset:0
  v_mfma_f32_32x32x16_bf16 v[80:95], v[24:27], a[4:7], 0
  s_waitcnt lgkmcnt(5)
  buffer_load_dwordx4 v16, s[12:15], s19 offen lds
  v_mfma_f32_32x32x16_bf16 v[64:79], v[28:31], a[8:11], v[64:79]
  ds_read_b128 v[52:55], v15 offset:0
  v_mul_f32 v96, s24, v96
  v_mul_f32 v97, s24, v97
  v_mfma_f32_32x32x16_bf16 v[80:95], v[28:31], a[12:15], v[80:95]
  s_waitcnt lgkmcnt(5)
  v_cvt_pk_bf16_f32 v128, v96, v97
  v_mul_f32 v98, s24, v98
  v_mfma_f32_32x32x16_bf16 v[64:79], v[32:35], a[16:19], v[64:79]
  s_add_u32 m0, s25, 1024
  ds_read_b128 v[24:27], v8 offset:8192
  v_mul_f32 v99, s24, v99
  v_cvt_pk_bf16_f32 v129, v98, v99
  v_mfma_f32_32x32x16_bf16 v[80:95], v[32:35], a[20:23], v[80:95]
  s_waitcnt lgkmcnt(5)
  buffer_load_dwordx4 v17, s[12:15], s19 offen lds
  v_mul_f32 v100, s24, v100
  v_mul_f32 v101, s24, v101
  v_mfma_f32_32x32x16_bf16 v[64:79], v[36:39], a[24:27], v[64:79]
  ds_read_b128 v[28:31], v9 offset:8192
  v_cvt_pk_bf16_f32 v130, v100, v101
  v_mul_f32 v102, s24, v102
  v_mfma_f32_32x32x16_bf16 v[80:95], v[36:39], a[28:31], v[80:95]
  s_waitcnt lgkmcnt(5)
  v_mul_f32 v103, s24, v103
  v_cvt_pk_bf16_f32 v131, v102, v103
  v_mfma_f32_32x32x16_bf16 v[64:79], v[40:43], a[32:35], v[64:79]
  s_add_u32 m0, s25, 2048
  ds_read_b128 v[32:35], v10 offset:8192
  v_mul_f32 v104, s24, v104
  v_mul_f32 v105, s24, v105
  v_mfma_f32_32x32x16_bf16 v[80:95], v[40:43], a[36:39], v[80:95]
  s_waitcnt lgkmcnt(5)
  buffer_load_dwordx4 v18, s[12:15], s19 offen lds
  v_cvt_pk_bf16_f32 v132, v104, v105
  v_mul_f32 v106, s24, v106
  v_mfma_f32_32x32x16_bf16 v[64:79], v[44:47], a[40:43], v[64:79]
  ds_read_b128 v[36:39], v11 offset:8192
  v_mul_f32 v107, s24, v107
  v_cvt_pk_bf16_f32 v133, v106, v107
  v_mfma_f32_32x32x16_bf16 v[80:95], v[44:47], a[44:47], v[80:95]
  s_waitcnt lgkmcnt(5)
  v_mul_f32 v108, s24, v108
  v_mul_f32 v109, s24, v109
  v_mfma_f32_32x32x16_bf16 v[64:79], v[48:51], a[48:51], v[64:79]
  s_add_u32 m0, s25, 3072
  ds_read_b128 v[40:43], v12 offset:8192
  v_cvt_pk_bf16_f32 v134, v108, v109
  v_mul_f32 v110, s24, v110
  v_mfma_f32_32x32x16_bf16 v[80:95], v[48:51], a[52:55], v[80:95]
  s_waitcnt lgkmcnt(5)
  buffer_load_dwordx4 v19, s[12:15], s19 offen lds
  v_mul_f32 v111, s24, v111
  v_cvt_pk_bf16_f32 v135, v110, v111
  v_mfma_f32_32x32x16_bf16 v[64:79], v[52:55], a[56:59], v[64:79]
  ds_read_b128 v[44:47], v13 offset:8192
  v_mul_f32 v112, s24, v112
  v_mul_f32 v113, s24, v113
  v_mfma_f32_32x32x16_bf16 v[80:95], v[52:55], a[60:63], v[80:95]
  s_waitcnt lgkmcnt(5)
  v_cvt_pk_bf16_f32 v136, v112, v113
  v_mul_f32 v114, s24, v114
  v_mfma_f32_32x32x16_bf16 v[64:79], v[24:27], a[64:67], v[64:79]
  s_add_u32 m0, s25, 4096
  ds_read_b128 v[48:51], v14 offset:8192
  v_mul_f32 v115, s24, v115
  v_cvt_pk_bf16_f32 v137, v114, v115
  v_mfma_f32_32x32x16_bf16 v[80:95], v[24:27], a[68:71], v[80:95]
  s_waitcnt lgkmcnt(5)
  buffer_load_dwordx4 v20, s[12:15], s19 offen lds
  v_mul_f32 v116, s24, v116
  v_mul_f32 v117, s24, v117
  v_mfma_f32_32x32x16_bf16 v[64:79], v[28:31], a[72:75], v[64:79]
  ds_read_b128 v[52:55], v15 offset:8192
  v_cvt_pk_bf16_f32 v138, v116, v117
  v_mul_f32 v118, s24, v118
  v_mfma_f32_32x32x16_bf16 v[80:95], v[28:31], a[76:79], v[80:95]
  s_waitcnt lgkmcnt(5)
  v_mul_f32 v119, s24, v119
  v_cvt_pk_bf16_f32 v139, v118, v119
  v_mfma_f32_32x32x16_bf16 v[64:79], v[32:35], a[80:83], v[64:79]
  s_add_u32 m0, s25, 5120
  ds_read_b128 v[24:27], v8 offset:16384
  v_mul_f32 v120, s24, v120
  v_mul_f32 v121, s24, v121
  v_mfma_f32_32x32x16_bf16 v[80:95], v[32:35], a[84:87], v[80:95]
  s_waitcnt lgkmcnt(5)
  buffer_load_dwordx4 v21, s[12:15], s19 offen lds
  v_cvt_pk_bf16_f32 v140, v120, v121
  v_mul_f32 v122, s24, v122
  v_mfma_f32_32x32x16_bf16 v[64:79], v[36:39], a[88:91], v[64:79]
  ds_read_b128 v[28:31], v9 offset:16384
  v_mul_f32 v123, s24, v123
  v_cvt_pk_bf16_f32 v141, v122, v123
  v_mfma_f32_32x32x16_bf16 v[80:95], v[36:39], a[92:95], v[80:95]
  s_waitcnt lgkmcnt(5)
  v_mul_f32 v124, s24, v124
  v_mul_f32 v125, s24, v125
  v_mfma_f32_32x32x16_bf16 v[64:79], v[40:43], a[96:99], v[64:79]
  s_add_u32 m0, s25, 6144
  ds_read_b128 v[32:35], v10 offset:16384
  v_cvt_pk_bf16_f32 v142, v124, v125
  v_mul_f32 v126, s24, v126
  v_mfma_f32_32x32x16_bf16 v[80:95], v[40:43], a[100:103], v[80:95]
  s_waitcnt lgkmcnt(5)
  buffer_load_dwordx4 v22, s[12:15], s19 offen lds
  v_mul_f32 v127, s24, v127
  v_cvt_pk_bf16_f32 v143, v126, v127
  v_mfma_f32_32x32x16_bf16 v[64:79], v[44:47], a[104:107], v[64:79]
  ds_read_b128 v[36:39], v11 offset:16384
  v_mfma_f32_32x32x16_bf16 v[80:95], v[44:47], a[108:111], v[80:95]
  s_waitcnt lgkmcnt(5)
  v_mfma_f32_32x32x16_bf16 v[64:79], v[48:51], a[112:115], v[64:79]
  s_add_u32 m0, s25, 7168
  ds_read_b128 v[40:43], v12 offset:16384
  v_mfma_f32_32x32x16_bf16 v[80:95], v[48:51], a[116:119], v[80:95]
  s_waitcnt lgkmcnt(5)
  buffer_load_dwordx4 v23, s[12:15], s19 offen lds
  v_mfma_f32_32x32x16_bf16 v[64:79], v[52:55], a[120:123], v[64:79]
  s_cmp_gt_u32 s23, 3
  ds_read_b128 v[44:47], v13 offset:16384
  v_mfma_f32_32x32x16_bf16 v[80:95], v[52:55], a[124:127], v[80:95]
  s_waitcnt lgkmcnt(5)
  s_cselect_b32 s26, s20, 0
  v_mfma_f32_32x32x16_bf16 v[64:79], v[24:27], a[128:131], v[64:79]
  s_add_u32 s19, s19, s26
  ds_read_b128 v[48:51], v14 offset:16384
  v_mfma_f32_32x32x16_bf16 v[80:95], v[24:27], a[132:135], v[80:95]
  s_waitcnt lgkmcnt(5)
  s_add_u32 s25, s25, 32768
  v_mfma_f32_32x32x16_bf16 v[64:79], v[28:31], a[136:139], v[64:79]
  s_and_b32 s25, s25, 0x1ffff
  ds_read_b128 v[52:55], v15 offset:16384
  v_mfma_f32_32x32x16_bf16 v[80:95], v[28:31], a[140:143], v[80:95]
  s_waitcnt lgkmcnt(5)
  buffer_store_dwordx4 v[128:131], v7, s[4:7], s21 offen offset:0 sc1
  v_mfma_f32_32x32x16_bf16 v[64:79], v[32:35], a[144:147], v[64:79]
  ds_read_b128 v[24:27], v8 offset:24576
  v_mfma_f32_32x32x16_bf16 v[80:95], v[32:35], a[148:151], v[80:95]
  s_waitcnt lgkmcnt(5)
  v_mfma_f32_32x32x16_bf16 v[64:79], v[36:39], a[152:155], v[64:79]
  ds_read_b128 v[28:31], v9 offset:24576
  v_mfma_f32_32x32x16_bf16 v[80:95], v[36:39], a[156:159], v[80:95]
  s_waitcnt lgkmcnt(5)
  buffer_store_dwordx4 v[132:135], v7, s[4:7], s21 offen offset:1024 sc1
  v_mfma_f32_32x32x16_bf16 v[64:79], v[40:43], a[160:163], v[64:79]
  ds_read_b128 v[32:35], v10 offset:24576
  v_mfma_f32_32x32x16_bf16 v[80:95], v[40:43], a[164:167], v[80:95]
  s_waitcnt lgkmcnt(5)
  v_mfma_f32_32x32x16_bf16 v[64:79], v[44:47], a[168:171], v[64:79]
  ds_read_b128 v[36:39], v11 offset:24576
  v_mfma_f32_32x32x16_bf16 v[80:95], v[44:47], a[172:175], v[80:95]
  s_waitcnt lgkmcnt(5)
  buffer_store_dwordx4 v[136:139], v7, s[4:7], s21 offen offset:2048 sc1
  v_mfma_f32_32x32x16_bf16 v[64:79], v[48:51], a[176:179], v[64:79]
  ds_read_b128 v[40:43], v12 offset:24576
  v_mfma_f32_32x32x16_bf16 v[80:95], v[48:51], a[180:183], v[80:95]
  s_waitcnt lgkmcnt(5)
  v_mfma_f32_32x32x16_bf16 v[64:79], v[52:55], a[184:187], v[64:79]
  ds_read_b128 v[44:47], v13 offset:24576
  v_mfma_f32_32x32x16_bf16 v[80:95], v[52:55], a[188:191], v[80:95]
  s_waitcnt lgkmcnt(5)
  buffer_store_dwordx4 v[140:143], v7, s[4:7], s21 offen offset:3072 sc1
  v_mfma_f32_32x32x16_bf16 v[64:79], v[24:27], a[192:195], v[64:79]
  s_mov_b32 s21, s27
  ds_read_b128 v[48:51], v14 offset:24576
  v_mov_b32 v7, v2
  v_mfma_f32_32x32x16_bf16 v[80:95], v[24:27], a[196:199], v[80:95]
  s_waitcnt lgkmcnt(5)
  v_mfma_f32_32x32x16_bf16 v[64:79], v[28:31], a[200:203], v[64:79]
  s_add_u32 s27, s27, s22
  ds_read_b128 v[52:55], v15 offset:24576
  v_mfma_f32_32x32x16_bf16 v[80:95], v[28:31], a[204:207], v[80:95]
  s_waitcnt lgkmcnt(5)
  s_waitcnt vmcnt(17)
  s_barrier
  v_mfma_f32_32x32x16_bf16 v[64:79], v[32:35], a[208:211], v[64:79]
  ds_read_b128 v[24:27], v8 offset:32768
  v_mfma_f32_32x32x16_bf16 v[80:95], v[32:35], a[212:215], v[80:95]
  s_waitcnt lgkmcnt(5)
  v_mfma_f32_32x32x16_bf16 v[64:79], v[36:39], a[216:219], v[64:79]
  s_add_u32 s29, s29, 1
  ds_read_b128 v[28:31], v9 offset:32768
  v_mfma_f32_32x32x16_bf16 v[80:95], v[36:39], a[220:223], v[80:95]
  s_waitcnt lgkmcnt(5)
  s_max_i32 s30, s29, 0
  v_mov_b32 v144, s30
  v_mfma_f32_32x32x16_bf16 v[64:79], v[40:43], a[224:227], v[64:79]
  ds_read_b128 v[32:35], v10 offset:32768
  v_mfma_f32_32x32x16_bf16 v[80:95], v[40:43], a[228:231], v[80:95]
  s_waitcnt lgkmcnt(5)
  buffer_store_dword v144, v145, s[4:7], s31 offen sc1
  v_mfma_f32_32x32x16_bf16 v[64:79], v[44:47], a[232:235], v[64:79]
  ds_read_b128 v[36:39], v11 offset:32768
  v_mfma_f32_32x32x16_bf16 v[80:95], v[44:47], a[236:239], v[80:95]
  s_waitcnt lgkmcnt(5)
  v_mfma_f32_32x32x16_bf16 v[64:79], v[48:51], a[240:243], v[64:79]
  s_sub_u32 s23, s23, 1
  ds_read_b128 v[40:43], v12 offset:32768
  v_mfma_f32_32x32x16_bf16 v[80:95], v[48:51], a[244:247], v[80:95]
  s_waitcnt lgkmcnt(5)
  v_mfma_f32_32x32x16_bf16 v[64:79], v[52:55], a[248:251], v[64:79]
  s_cmp_eq_u32 s23, 0
  ds_read_b128 v[44:47], v13 offset:32768
  v_mfma_f32_32x32x16_bf16 v[80:95], v[52:55], a[252:255], v[80:95]
  s_cbranch_scc1 G_done0_8
  s_waitcnt lgkmcnt(5)
  v_mfma_f32_32x32x16_bf16 v[96:111], v[24:27], a[0:3], 0
  s_add_u32 m0, s25, 0
  ds_read_b128 v[48:51], v14 offset:32768
  v_mfma_f32_32x32x16_bf16 v[112:127], v[24:27], a[4:7], 0
  s_waitcnt lgkmcnt(5)
  buffer_load_dwordx4 v16, s[12:15], s19 offen lds
  v_mfma_f32_32x32x16_bf16 v[96:111], v[28:31], a[8:11], v[96:111]
  ds_read_b128 v[52:55], v15 offset:32768
  v_mul_f32 v64, s24, v64
  v_mul_f32 v65, s24, v65
  v_mfma_f32_32x32x16_bf16 v[112:127], v[28:31], a[12:15], v[112:127]
  s_waitcnt lgkmcnt(5)
  v_cvt_pk_bf16_f32 v128, v64, v65
  v_mul_f32 v66, s24, v66
  v_mfma_f32_32x32x16_bf16 v[96:111], v[32:35], a[16:19], v[96:111]
  s_add_u32 m0, s25, 1024
  ds_read_b128 v[24:27], v8 offset:40960
  v_mul_f32 v67, s24, v67
  v_cvt_pk_bf16_f32 v129, v66, v67
  v_mfma_f32_32x32x16_bf16 v[112:127], v[32:35], a[20:23], v[112:127]
  s_waitcnt lgkmcnt(5)
  buffer_load_dwordx4 v17, s[12:15], s19 offen lds
  v_mul_f32 v68, s24, v68
  v_mul_f32 v69, s24, v69
  v_mfma_f32_32x32x16_bf16 v[96:111], v[36:39], a[24:27], v[96:111]
  ds_read_b128 v[28:31], v9 offset:40960
  v_cvt_pk_bf16_f32 v130, v68, v69
  v_mul_f32 v70, s24, v70
  v_mfma_f32_32x32x16_bf16 v[112:127], v[36:39], a[28:31], v[112:127]
  s_waitcnt lgkmcnt(5)
  v_mul_f32 v71, s24, v71
  v_cvt_pk_bf16_f32 v131, v70, v71
  v_mfma_f32_32x32x16_bf16 v[96:111], v[40:43], a[32:35], v[96:111]
  s_add_u32 m0, s25, 2048
  ds_read_b128 v[32:35], v10 offset:40960
  v_mul_f32 v72, s24, v72
  v_mul_f32 v73, s24, v73
  v_mfma_f32_32x32x16_bf16 v[112:127], v[40:43], a[36:39], v[112:127]
  s_waitcnt lgkmcnt(5)
  buffer_load_dwordx4 v18, s[12:15], s19 offen lds
  v_cvt_pk_bf16_f32 v132, v72, v73
  v_mul_f32 v74, s24, v74
  v_mfma_f32_32x32x16_bf16 v[96:111], v[44:47], a[40:43], v[96:111]
  ds_read_b128 v[36:39], v11 offset:40960
  v_mul_f32 v75, s24, v75
  v_cvt_pk_bf16_f32 v133, v74, v75
  v_mfma_f32_32x32x16_bf16 v[112:127], v[44:47], a[44:47], v[112:127]
  s_waitcnt lgkmcnt(5)
  v_mul_f32 v76, s24, v76
  v_mul_f32 v77, s24, v77
  v_mfma_f32_32x32x16_bf16 v[96:111], v[48:51], a[48:51], v[96:111]
  s_add_u32 m0, s25, 3072
  ds_read_b128 v[40:43], v12 offset:40960
  v_cvt_pk_bf16_f32 v134, v76, v77
  v_mul_f32 v78, s24, v78
  v_mfma_f32_32x32x16_bf16 v[112:127], v[48:51], a[52:55], v[112:127]
  s_waitcnt lgkmcnt(5)
  buffer_load_dwordx4 v19, s[12:15], s19 offen lds
  v_mul_f32 v79, s24, v79
  v_cvt_pk_bf16_f32 v135, v78, v79
  v_mfma_f32_32x32x16_bf16 v[96:111], v[52:55], a[56:59], v[96:111]
  ds_read_b128 v[44:47], v13 offset:40960
  v_mul_f32 v80, s24, v80
  v_mul_f32 v81, s24, v81
  v_mfma_f32_32x32x16_bf16 v[112:127], v[52:55], a[60:63], v[112:127]
  s_waitcnt lgkmcnt(5)
  v_cvt_pk_bf16_f32 v136, v80, v81
  v_mul_f32 v82, s24, v82
  v_mfma_f32_32x32x16_bf16 v[96:111], v[24:27], a[64:67], v[96:111]
  s_add_u32 m0, s25, 4096
  ds_read_b128 v[48:51], v14 offset:40960
  v_mul_f32 v83, s24, v83
  v_cvt_pk_bf16_f32 v137, v82, v83
  v_mfma_f32_32x32x16_bf16 v[112:127], v[24:27], a[68:71], v[112:127]
  s_waitcnt lgkmcnt(5)
  buffer_load_dwordx4 v20, s[12:15], s19 offen lds
  v_mul_f32 v84, s24, v84
  v_mul_f32 v85, s24, v85
  v_mfma_f32_32x32x16_bf16 v[96:111], v[28:31], a[72:75], v[96:111]
  ds_read_b128 v[52:55], v15 offset:40960
  v_cvt_pk_bf16_f32 v138, v84, v85
  v_mul_f32 v86, s24, v86
  v_mfma_f32_32x32x16_bf16 v[112:127], v[28:31], a[76:79], v[112:127]
  s_waitcnt lgkmcnt(5)
  v_mul_f32 v87, s24, v87
  v_cvt_pk_bf16_f32 v139, v86, v87
  v_mfma_f32_32x32x16_bf16 v[96:111], v[32:35], a[80:83], v[96:111]
  s_add_u32 m0, s25, 5120
  ds_read_b128 v[24:27], v8 offset:49152
  v_mul_f32 v88, s24, v88
  v_mul_f32 v89, s24, v89
  v_mfma_f32_32x32x16_bf16 v[112:127], v[32:35], a[84:87], v[112:127]
  s_waitcnt lgkmcnt(5)
  buffer_load_dwordx4 v21, s[12:15], s19 offen lds
  v_cvt_pk_bf16_f32 v140, v88, v89
  v_mul_f32 v90, s24, v90
  v_mfma_f32_32x32x16_bf16 v[96:111], v[36:39], a[88:91], v[96:111]
  ds_read_b128 v[28:31], v9 offset:49152
  v_mul_f32 v91, s24, v91
  v_cvt_pk_bf16_f32 v141, v90, v91
  v_mfma_f32_32x32x16_bf16 v[112:127], v[36:39], a[92:95], v[112:127]
  s_waitcnt lgkmcnt(5)
  v_mul_f32 v92, s24, v92
  v_mul_f32 v93, s24, v93
  v_mfma_f32_32x32x16_bf16 v[96:111], v[40:43], a[96:99], v[96:111]
  s_add_u32 m0, s25, 6144
  ds_read_b128 v[32:35], v10 offset:49152
  v_cvt_pk_bf16_f32 v142, v92, v93
  v_mul_f32 v94, s24, v94
  v_mfma_f32_32x32x16_bf16 v[112:127], v[40:43], a[100:103], v[112:127]
  s_waitcnt lgkmcnt(5)
  buffer_load_dwordx4 v22, s[12:15], s19 offen lds
  v_mul_f32 v95, s24, v95
  v_cvt_pk_bf16_f32 v143, v94, v95
  v_mfma_f32_32x32x16_bf16 v[96:111], v[44:47], a[104:107], v[96:111]
  ds_read_b128 v[36:39], v11 offset:49152
  v_mfma_f32_32x32x16_bf16 v[112:127], v[44:47], a[108:111], v[112:127]
  s_waitcnt lgkmcnt(5)
  v_mfma_f32_32x32x16_bf16 v[96:111], v[48:51], a[112:115], v[96:111]
  s_add_u32 m0, s25, 7168
  ds_read_b128 v[40:43], v12 offset:49152
  v_mfma_f32_32x32x16_bf16 v[112:127], v[48:51], a[116:119], v[112:127]
  s_waitcnt lgkmcnt(5)
  buffer_load_dwordx4 v23, s[12:15], s19 offen lds
  v_mfma_f32_32x32x16_bf16 v[96:111], v[52:55], a[120:123], v[96:111]
  s_cmp_gt_u32 s23, 3
  ds_read_b128 v[44:47], v13 offset:49152
  v_mfma_f32_32x32x16_bf16 v[112:127], v[52:55], a[124:127], v[112:127]
  s_waitcnt lgkmcnt(5)
  s_cselect_b32 s26, s20, 0
  v_mfma_f32_32x32x16_bf16 v[96:111], v[24:27], a[128:131], v[96:111]
  s_add_u32 s19, s19, s26
  ds_read_b128 v[48:51], v14 offset:49152
  v_mfma_f32_32x32x16_bf16 v[112:127], v[24:27], a[132:135], v[112:127]
  s_waitcnt lgkmcnt(5)
  s_add_u32 s25, s25, 32768
  v_mfma_f32_32x32x16_bf16 v[96:111], v[28:31], a[136:139], v[96:111]
  s_and_b32 s25, s25, 0x1ffff
  ds_read_b128 v[52:55], v15 offset:49152
  v_mfma_f32_32x32x16_bf16 v[112:127], v[28:31], a[140:143], v[112:127]
  s_waitcnt lgkmcnt(5)
  buffer_store_dwordx4 v[128:131], v7, s[4:7], s21 offen offset:0 sc1
  v_mfma_f32_32x32x16_bf16 v[96:111], v[32:35], a[144:147], v[96:111]
  ds_read_b128 v[24:27], v8 offset:57344
  v_mfma_f32_32x32x16_bf16 v[112:127], v[32:35], a[148:151], v[112:127]
  s_waitcnt lgkmcnt(5)
  v_xor_b32 v8, 0x10000, v8
  v_mfma_f32_32x32x16_bf16 v[96:111], v[36:39], a[152:155], v[96:111]
  ds_read_b128 v[28:31], v9 offset:57344
  v_mfma_f32_32x32x16_bf16 v[112:127], v[36:39], a[156:159], v[112:127]
  s_waitcnt lgkmcnt(5)
  buffer_store_dwordx4 v[132:135], v7, s[4:7], s21 offen offset:1024 sc1
  v_xor_b32 v9, 0x10000, v9
  v_mfma_f32_32x32x16_bf16 v[96:111], v[40:43], a[160:163], v[96:111]
  ds_read_b128 v[32:35], v10 offset:57344
  v_mfma_f32_32x32x16_bf16 v[112:127], v[40:43], a[164:167], v[112:127]
  s_waitcnt lgkmcnt(5)
  v_xor_b32 v10, 0x10000, v10
  v_mfma_f32_32x32x16_bf16 v[96:111], v[44:47], a[168:171], v[96:111]
  ds_read_b128 v[36:39], v11 offset:57344
  v_mfma_f32_32x32x16_bf16 v[112:127], v[44:47], a[172:175], v[112:127]
  s_waitcnt lgkmcnt(5)
  buffer_store_dwordx4 v[136:139], v7, s[4:7], s21 offen offset:2048 sc1
  v_xor_b32 v11, 0x10000, v11
  v_mfma_f32_32x32x16_bf16 v[96:111], v[48:51], a[176:179], v[96:111]
  ds_read_b128 v[40:43], v12 offset:57344
  v_mfma_f32_32x32x16_bf16 v[112:127], v[48:51], a[180:183], v[112:127]
  s_waitcnt lgkmcnt(5)
  v_xor_b32 v12, 0x10000, v12
  v_mfma_f32_32x32x16_bf16 v[96:111], v[52:55], a[184:187], v[96:111]
  ds_read_b128 v[44:47], v13 offset:57344
  v_mfma_f32_32x32x16_bf16 v[112:127], v[52:55], a[188:191], v[112:127]
  s_waitcnt lgkmcnt(5)
  buffer_store_dwordx4 v[140:143], v7, s[4:7], s21 offen offset:3072 sc1
  v_xor_b32 v13, 0x10000, v13
  v_mfma_f32_32x32x16_bf16 v[96:111], v[24:27], a[192:195], v[96:111]
  s_mov_b32 s21, s27
  ds_read_b128 v[48:51], v14 offset:57344
  v_mov_b32 v7, v2
  v_mfma_f32_32x32x16_bf16 v[112:127], v[24:27], a[196:199], v[112:127]
  s_waitcnt lgkmcnt(5)
  v_xor_b32 v14, 0x10000, v14
  v_mfma_f32_32x32x16_bf16 v[96:111], v[28:31], a[200:203], v[96:111]
  s_add_u32 s27, s27, s22
  ds_read_b128 v[52:55], v15 offset:57344
  v_mfma_f32_32x32x16_bf16 v[112:127], v[28:31], a[204:207], v[112:127]
  s_waitcnt lgkmcnt(5)
  s_waitcnt vmcnt(17)
  s_barrier
  v_xor_b32 v15, 0x10000, v15
  v_mfma_f32_32x32x16_bf16 v[96:111], v[32:35], a[208:211], v[96:111]
  ds_read_b128 v[24:27], v8 offset:0
  v_mfma_f32_32x32x16_bf16 v[112:127], v[32:35], a[212:215], v[112:127]
  s_waitcnt lgkmcnt(5)
  v_mfma_f32_32x32x16_bf16 v[96:111], v[36:39], a[216:219], v[96:111]
  s_add_u32 s29, s29, 1
  ds_read_b128 v[28:31], v9 offset:0
  v_mfma_f32_32x32x16_bf16 v[112:127], v[36:39], a[220:223], v[112:127]
  s_waitcnt lgkmcnt(5)
  s_max_i32 s30, s29, 0
  v_mov_b32 v144, s30
  v_mfma_f32_32x32x16_bf16 v[96:111], v[40:43], a[224:227], v[96:111]
  ds_read_b128 v[32:35], v10 offset:0
  v_mfma_f32_32x32x16_bf16 v[112:127], v[40:43], a[228:231], v[112:127]
  s_waitcnt lgkmcnt(5)
  buffer_store_dword v144, v145, s[4:7], s31 offen sc1
  v_mfma_f32_32x32x16_bf16 v[96:111], v[44:47], a[232:235], v[96:111]
  ds_read_b128 v[36:39], v11 offset:0
  v_mfma_f32_32x32x16_bf16 v[112:127], v[44:47], a[236:239], v[112:127]
  s_waitcnt lgkmcnt(5)
  v_mfma_f32_32x32x16_bf16 v[96:111], v[48:51], a[240:243], v[96:111]
  s_sub_u32 s23, s23, 1
  ds_read_b128 v[40:43], v12 offset:0
  v_mfma_f32_32x32x16_bf16 v[112:127], v[48:51], a[244:247], v[112:127]
  s_waitcnt lgkmcnt(5)
  v_mfma_f32_32x32x16_bf16 v[96:111], v[52:55], a[248:251], v[96:111]
  s_cmp_eq_u32 s23, 0
  ds_read_b128 v[44:47], v13 offset:0
  v_mfma_f32_32x32x16_bf16 v[112:127], v[52:55], a[252:255], v[112:127]
  s_cbranch_scc1 G_done1_9
  s_branch G_top_7
G_done0_8:
  s_nop 7
  s_nop 3
  v_mul_f32 v64, s24, v64
  v_mul_f32 v65, s24, v65
  v_cvt_pk_bf16_f32 v128, v64, v65
  v_mul_f32 v66, s24, v66
  v_mul_f32 v67, s24, v67
  v_cvt_pk_bf16_f32 v129, v66, v67
  v_mul_f32 v68, s24, v68
  v_mul_f32 v69, s24, v69
  v_cvt_pk_bf16_f32 v130, v68, v69
  v_mul_f32 v70, s24, v70
  v_mul_f32 v71, s24, v71
  v_cvt_pk_bf16_f32 v131, v70, v71
  buffer_store_dwordx4 v[128:131], v7, s[4:7], s21 offen offset:0 sc1
  v_mul_f32 v72, s24, v72
  v_mul_f32 v73, s24, v73
  v_cvt_pk_bf16_f32 v132, v72, v73
  v_mul_f32 v74, s24, v74
  v_mul_f32 v75, s24, v75
  v_cvt_pk_bf16_f32 v133, v74, v75
  v_mul_f32 v76, s24, v76
  v_mul_f32 v77, s24, v77
  v_cvt_pk_bf16_f32 v134, v76, v77
  v_mul_f32 v78, s24, v78
  v_mul_f32 v79, s24, v79
  v_cvt_pk_bf16_f32 v135, v78, v79
  buffer_store_dwordx4 v[132:135], v7, s[4:7], s21 offen offset:1024 sc1
  v_mul_f32 v80, s24, v80
  v_mul_f32 v81, s24, v81
  v_cvt_pk_bf16_f32 v136, v80, v81
  v_mul_f32 v82, s24, v82
  v_mul_f32 v83, s24, v83
  v_cvt_pk_bf16_f32 v137, v82, v83
  v_mul_f32 v84, s24, v84
  v_mul_f32 v85, s24, v85
  v_cvt_pk_bf16_f32 v138, v84, v85
  v_mul_f32 v86, s24, v86
  v_mul_f32 v87, s24, v87
  v_cvt_pk_bf16_f32 v139, v86, v87
  buffer_store_dwordx4 v[136:139], v7, s[4:7], s21 offen offset:2048 sc1
  v_mul_f32 v88, s24, v88
  v_mul_f32 v89, s24, v89
  v_cvt_pk_bf16_f32 v140, v88, v89
  v_mul_f32 v90, s24, v90
  v_mul_f32 v91, s24, v91
  v_cvt_pk_bf16_f32 v141, v90, v91
  v_mul_f32 v92, s24, v92
  v_mul_f32 v93, s24, v93
  v_cvt_pk_bf16_f32 v142, v92, v93
  v_mul_f32 v94, s24, v94
  v_mul_f32 v95, s24, v95
  v_cvt_pk_bf16_f32 v143, v94, v95
  buffer_store_dwordx4 v[140:143], v7, s[4:7], s21 offen offset:3072 sc1
  s_branch G_fin_10
G_done1_9:
  s_nop 7
  s_nop 3
  v_mul_f32 v96, s24, v96
  v_mul_f32 v97, s24, v97
  v_cvt_pk_bf16_f32 v128, v96, v97
  v_mul_f32 v98, s24, v98
  v_mul_f32 v99, s24, v99
  v_cvt_pk_bf16_f32 v129, v98, v99
  v_mul_f32 v100, s24, v100
  v_mul_f32 v101, s24, v101
  v_cvt_pk_bf16_f32 v130, v100, v101
  v_mul_f32 v102, s24, v102
  v_mul_f32 v103, s24, v103
  v_cvt_pk_bf16_f32 v131, v102, v103
  buffer_store_dwordx4 v[128:131], v7, s[4:7], s21 offen offset:0 sc1
  v_mul_f32 v104, s24, v104
  v_mul_f32 v105, s24, v105
  v_cvt_pk_bf16_f32 v132, v104, v105
  v_mul_f32 v106, s24, v106
  v_mul_f32 v107, s24, v107
  v_cvt_pk_bf16_f32 v133, v106, v107
  v_mul_f32 v108, s24, v108
  v_mul_f32 v109, s24, v109
  v_cvt_pk_bf16_f32 v134, v108, v109
  v_mul_f32 v110, s24, v110
  v_mul_f32 v111, s24, v111
  v_cvt_pk_bf16_f32 v135, v110, v111
  buffer_store_dwordx4 v[132:135], v7, s[4:7], s21 offen offset:1024 sc1
  v_mul_f32 v112, s24, v112
  v_mul_f32 v113, s24, v113
  v_cvt_pk_bf16_f32 v136, v112, v113
  v_mul_f32 v114, s24, v114
  v_mul_f32 v115, s24, v115
  v_cvt_pk_bf16_f32 v137, v114, v115
  v_mul_f32 v116, s24, v116
  v_mul_f32 v117, s24, v117
  v_cvt_pk_bf16_f32 v138, v116, v117
  v_mul_f32 v118, s24, v118
  v_mul_f32 v119, s24, v119
  v_cvt_pk_bf16_f32 v139, v118, v119
  buffer_store_dwordx4 v[136:139], v7, s[4:7], s21 offen offset:2048 sc1
  v_mul_f32 v120, s24, v120
  v_mul_f32 v121, s24, v121
  v_cvt_pk_bf16_f32 v140, v120, v121
  v_mul_f32 v122, s24, v122
  v_mul_f32 v123, s24, v123
  v_cvt_pk_bf16_f32 v141, v122, v123
  v_mul_f32 v124, s24, v124
  v_mul_f32 v125, s24, v125
  v_cvt_pk_bf16_f32 v142, v124, v125
  v_mul_f32 v126, s24, v126
  v_mul_f32 v127, s24, v127
  v_cvt_pk_bf16_f32 v143, v126, v127
  buffer_store_dwordx4 v[140:143], v7, s[4:7], s21 offen offset:3072 sc1
G_fin_10:
  s_waitcnt vmcnt(0) lgkmcnt(0)
  s_barrier
  s_add_u32 s30, s29, 3
  v_mov_b32 v144, s30
  v_min_u32 v145, 1, v0
  v_lshlrev_b32 v145, 30, v145
  buffer_store_dword v144, v145, s[4:7], s31 offen sc1
P_end_2:
  s_mov_b32 s71, 0
M_sw_11:
  s_add_u32 s71, s71, 1
  s_cmp_gt_u32 s71, 262144
  s_cbranch_scc1 M_exit
  s_mov_b32 s79, 0
  s_atomic_or s79, s[74:75], 128 glc
  s_waitcnt lgkmcnt(0)
  s_cmp_lt_u32 s79, 256
  s_cbranch_scc1 M_sw_11
  s_cmp_eq_u32 s65, 6
  s_cbranch_scc1 M_follow
  s_mov_b32 s68, 0
  s_mov_b32 s36, -1
  s_mov_b32 s69, s53
  s_mov_b32 s70, s54
M_att:
  s_mov_b32 s24, 0xf149f2ca
  s_mov_b32 s29, 0
  v_mov_b32 v6, 0
  v_mov_b32 v7, 0
  s_lshl_b32 s26, s16, 11
  v_add_u32 v3, s26, v2
  v_and_b32 v5, 31, v1
  v_lshrrev_b32 v12, 5, v1
  v_lshlrev_b32 v12, 2, v12
  v_sub_u32 v5, v5, v12
  s_lshl_b32 s26, s64, 19
  s_add_u32 s19, s26, 16777216
  s_add_u32 s20, s26, 33554432
  s_lshl_b32 s27, s69, 2
  s_add_u32 s27, s27, s16
  s_lshl_b32 s27, s27, 14
  s_add_u32 s25, s26, s27
  s_bfe_u32 s78, s70, 0x80000
  s_add_u32 s76, s67, 384
  s_mov_b32 s71, 0
M_sw_12:
  s_add_u32 s71, s71, 1
  s_cmp_gt_u32 s71, 262144
  s_cbranch_scc1 M_exit
  s_mov_b32 s79, 0
  s_atomic_or s79, s[72:73], s76 glc
  s_waitcnt lgkmcnt(0)
  s_cmp_lt_u32 s79, s78
  s_cbranch_scc1 M_sw_12
  s_bfe_u32 s78, s70, 0x80008
  s_add_u32 s76, s67, 640
  s_mov_b32 s71, 0
M_sw_13:
  s_add_u32 s71, s71, 1
  s_cmp_gt_u32 s71, 262144
  s_cbranch_scc1 M_exit
  s_mov_b32 s79, 0
  s_atomic_or s79, s[72:73], s76 glc
  s_waitcnt lgkmcnt(0)
  s_cmp_lt_u32 s79, s78
  s_cbranch_scc1 M_sw_13
  s_lshl_b32 s27, s69, 16
  s_add_u32 s27, s27, 16384
  s_add_u32 s17, s19, s27
M_kv_14:
  s_cmp_ge_u32 s17, s36
  s_cbranch_scc1 M_kvok_15
  s_mov_b32 s76, 0
  s_mov_b32 s78, 18
  s_mov_b32 s77, 376832
  s_cmp_eq_u32 s68, 1
  s_cmov_b32 s76, 128
  s_cmov_b32 s78, 22
  s_cmov_b32 s77, 196608
  s_cmp_eq_u32 s68, 2
  s_cmov_b32 s76, 512
  s_cmov_b32 s78, 24
  s_cmov_b32 s77, 0
  s_add_u32 s76, s76, s67
  s_mov_b32 s71, 0
M_sw_16:
  s_add_u32 s71, s71, 1
  s_cmp_gt_u32 s71, 262144
  s_cbranch_scc1 M_exit
  s_mov_b32 s79, 0
  s_atomic_or s79, s[72:73], s76 glc
  s_waitcnt lgkmcnt(0)
  s_cmp_lt_u32 s79, s78
  s_cbranch_scc1 M_sw_16
  s_add_u32 s36, s77, s19
  s_add_u32 s68, s68, 1
  s_branch M_kv_14
M_kvok_15:
  s_add_u32 s28, s25, 0
  buffer_load_dwordx4 a[128:131], v2, s[4:7], s28 offen offset:0 sc1
  buffer_load_dwordx4 a[132:135], v2, s[4:7], s28 offen offset:1024 sc1
  buffer_load_dwordx4 a[136:139], v2, s[4:7], s28 offen offset:2048 sc1
  buffer_load_dwordx4 a[140:143], v2, s[4:7], s28 offen offset:3072 sc1
  s_add_u32 s28, s25, 4096
  buffer_load_dwordx4 a[144:147], v2, s[4:7], s28 offen offset:0 sc1
  buffer_load_dwordx4 a[148:151], v2, s[4:7], s28 offen offset:1024 sc1
  buffer_load_dwordx4 a[152:155], v2, s[4:7], s28 offen offset:2048 sc1
  buffer_load_dwordx4 a[156:159], v2, s[4:7], s28 offen offset:3072 sc1
  s_add_u32 s28, s25, 8192
  buffer_load_dwordx4 a[160:163], v2, s[4:7], s28 offen offset:0 sc1
  buffer_load_dwordx4 a[164:167], v2, s[4:7], s28 offen offset:1024 sc1
  buffer_load_dwordx4 a[168:171], v2, s[4:7], s28 offen offset:2048 sc1
  buffer_load_dwordx4 a[172:175], v2, s[4:7], s28 offen offset:3072 sc1
  s_add_u32 s28, s25, 12288
  buffer_load_dwordx4 a[176:179], v2, s[4:7], s28 offen offset:0 sc1
  buffer_load_dwordx4 a[180:183], v2, s[4:7], s28 offen offset:1024 sc1
  buffer_load_dwordx4 a[184:187], v2, s[4:7], s28 offen offset:2048 sc1
  buffer_load_dwordx4 a[188:191], v2, s[4:7], s28 offen offset:3072 sc1
A_again_17:
  s_lshl_b32 s27, s69, 16
  s_add_u32 s27, s27, 57344
  s_add_u32 s17, s19, s27
  s_add_u32 s18, s20, s27
  s_lshl_b32 s21, s16, 11
  s_mov_b32 m0, s21
  s_nop 0
  buffer_load_dwordx4 v3, s[4:7], s18 offen offset:0 sc1 lds
  buffer_load_dwordx4 v3, s[4:7], s18 offen offset:1024 sc1 lds
  s_add_u32 m0, s21, 8192
  s_nop 0
  buffer_load_dwordx4 v3, s[4:7], s17 offen offset:0 sc1 lds
  buffer_load_dwordx4 v3, s[4:7], s17 offen offset:1024 sc1 lds
  s_add_u32 s18, s18, 8192
  s_sub_u32 s18, s18, 8192
  s_max_i32 s18, s18, s20
  s_sub_u32 s17, s17, 8192
  s_max_i32 s17, s17, s19
  s_add_u32 s21, s21, 16384
  s_and_b32 s21, s21, 131071
  s_mov_b32 m0, s21
  s_nop 0
  buffer_load_dwordx4 v3, s[4:7], s18 offen offset:0 sc1 lds
  buffer_load_dwordx4 v3, s[4:7], s18 offen offset:1024 sc1 lds
  s_add_u32 m0, s21, 8192
  s_nop 0
  buffer_load_dwordx4 v3, s[4:7], s17 offen offset:0 sc1 lds
  buffer_load_dwordx4 v3, s[4:7], s17 offen offset:1024 sc1 lds
  s_sub_u32 s18, s18, 8192
  s_max_i32 s18, s18, s20
  s_sub_u32 s17, s17, 8192
  s_max_i32 s17, s17, s19
  s_add_u32 s21, s21, 16384
  s_and_b32 s21, s21, 131071
  s_mov_b32 m0, s21
  s_nop 0
  buffer_load_dwordx4 v3, s[4:7], s18 offen offset:0 sc1 lds
  buffer_load_dwordx4 v3, s[4:7], s18 offen offset:1024 sc1 lds
  s_add_u32 m0, s21, 8192
  s_nop 0
  buffer_load_dwordx4 v3, s[4:7], s17 offen offset:0 sc1 lds
  buffer_load_dwordx4 v3, s[4:7], s17 offen offset:1024 sc1 lds
  s_sub_u32 s18, s18, 8192
  s_max_i32 s18, s18, s20
  s_sub_u32 s17, s17, 8192
  s_max_i32 s17, s17, s19
  s_add_u32 s21, s21, 16384
  s_and_b32 s21, s21, 131071
  s_mov_b32 m0, s21
  s_nop 0
  buffer_load_dwordx4 v3, s[4:7], s18 offen offset:0 sc1 lds
  buffer_load_dwordx4 v3, s[4:7], s18 offen offset:1024 sc1 lds
  s_add_u32 m0, s21, 8192
  s_nop 0
  buffer_load_dwordx4 v3, s[4:7], s17 offen offset:0 sc1 lds
  buffer_load_dwordx4 v3, s[4:7], s17 offen offset:1024 sc1 lds
  s_sub_u32 s18, s18, 8192
  s_max_i32 s18, s18, s20
  s_sub_u32 s17, s17, 8192
  s_max_i32 s17, s17, s19
  s_add_u32 s21, s21, 16384
  s_and_b32 s21, s21, 131071
  s_mov_b32 m0, s21
  s_nop 0
  buffer_load_dwordx4 v3, s[4:7], s18 offen offset:0 sc1 lds
  buffer_load_dwordx4 v3, s[4:7], s18 offen offset:1024 sc1 lds
  s_add_u32 m0, s21, 8192
  s_nop 0
  buffer_load_dwordx4 v3, s[4:7], s17 offen offset:0 sc1 lds
  buffer_load_dwordx4 v3, s[4:7], s17 offen offset:1024 sc1 lds
  s_sub_u32 s18, s18, 8192
  s_max_i32 s18, s18, s20
  s_sub_u32 s17, s17, 8192
  s_max_i32 s17, s17, s19
  s_add_u32 s21, s21, 16384
  s_and_b32 s21, s21, 131071
  s_mov_b32 m0, s21
  s_nop 0
  buffer_load_dwordx4 v3, s[4:7], s18 offen offset:0 sc1 lds
  buffer_load_dwordx4 v3, s[4:7], s18 offen offset:1024 sc1 lds
  s_add_u32 m0, s21, 8192
  s_nop 0
  buffer_load_dwordx4 v3, s[4:7], s17 offen offset:0 sc1 lds
  buffer_load_dwordx4 v3, s[4:7], s17 offen offset:1024 sc1 lds
  v_accvgpr_write_b32 a0, 0
  v_accvgpr_write_b32 a1, 0
  v_accvgpr_write_b32 a2, 0
  v_accvgpr_write_b32 a3, 0
  v_accvgpr_write_b32 a4, 0
  v_accvgpr_write_b32 a5, 0
  v_accvgpr_write_b32 a6, 0
  v_accvgpr_write_b32 a7, 0
  v_accvgpr_write_b32 a8, 0
  v_accvgpr_write_b32 a9, 0
  v_accvgpr_write_b32 a10, 0
  v_accvgpr_write_b32 a11, 0
  v_accvgpr_write_b32 a12, 0
  v_accvgpr_write_b32 a13, 0
  v_accvgpr_write_b32 a14, 0
  v_accvgpr_write_b32 a15, 0
  v_accvgpr_write_b32 a16, 0
  v_accvgpr_write_b32 a17, 0
  v_accvgpr_write_b32 a18, 0
  v_accvgpr_write_b32 a19, 0
  v_accvgpr_write_b32 a20, 0
  v_accvgpr_write_b32 a21, 0
  v_accvgpr_write_b32 a22, 0
  v_accvgpr_write_b32 a23, 0
  v_accvgpr_write_b32 a24, 0
  v_accvgpr_write_b32 a25, 0
  v_accvgpr_write_b32 a26, 0
  v_accvgpr_write_b32 a27, 0
  v_accvgpr_write_b32 a28, 0
  v_accvgpr_write_b32 a29, 0
  v_accvgpr_write_b32 a30, 0
  v_accvgpr_write_b32 a31, 0
  v_accvgpr_write_b32 a32, 0
  v_accvgpr_write_b32 a33, 0
  v_accvgpr_write_b32 a34, 0
  v_accvgpr_write_b32 a35, 0
  v_accvgpr_write_b32 a36, 0
  v_accvgpr_write_b32 a37, 0
  v_accvgpr_write_b32 a38, 0
  v_accvgpr_write_b32 a39, 0
  v_accvgpr_write_b32 a40, 0
  v_accvgpr_write_b32 a41, 0
  v_accvgpr_write_b32 a42, 0
  v_accvgpr_write_b32 a43, 0
  v_accvgpr_write_b32 a44, 0
  v_accvgpr_write_b32 a45, 0
  v_accvgpr_write_b32 a46, 0
  v_accvgpr_write_b32 a47, 0
  v_accvgpr_write_b32 a48, 0
  v_accvgpr_write_b32 a49, 0
  v_accvgpr_write_b32 a50, 0
  v_accvgpr_write_b32 a51, 0
  v_accvgpr_write_b32 a52, 0
  v_accvgpr_write_b32 a53, 0
  v_accvgpr_write_b32 a54, 0
  v_accvgpr_write_b32 a55, 0
  v_accvgpr_write_b32 a56, 0
  v_accvgpr_write_b32 a57, 0
  v_accvgpr_write_b32 a58, 0
  v_accvgpr_write_b32 a59, 0
  v_accvgpr_write_b32 a60, 0
  v_accvgpr_write_b32 a61, 0
  v_accvgpr_write_b32 a62, 0
  v_accvgpr_write_b32 a63, 0
  v_accvgpr_write_b32 a64, 0
  v_accvgpr_write_b32 a65, 0
  v_accvgpr_write_b32 a66, 0
  v_accvgpr_write_b32 a67, 0
  v_accvgpr_write_b32 a68, 0
  v_accvgpr_write_b32 a69, 0
  v_accvgpr_write_b32 a70, 0
  v_accvgpr_write_b32 a71, 0
  v_accvgpr_write_b32 a72, 0
  v_accvgpr_write_b32 a73, 0
  v_accvgpr_write_b32 a74, 0
  v_accvgpr_write_b32 a75, 0
  v_accvgpr_write_b32 a76, 0
  v_accvgpr_write_b32 a77, 0
  v_accvgpr_write_b32 a78, 0
  v_accvgpr_write_b32 a79, 0
  v_accvgpr_write_b32 a80, 0
  v_accvgpr_write_b32 a81, 0
  v_accvgpr_write_b32 a82, 0
  v_accvgpr_write_b32 a83, 0
  v_accvgpr_write_b32 a84, 0
  v_accvgpr_write_b32 a85, 0
  v_accvgpr_write_b32 a86, 0
  v_accvgpr_write_b32 a87, 0
  v_accvgpr_write_b32 a88, 0
  v_accvgpr_write_b32 a89, 0
  v_accvgpr_write_b32 a90, 0
  v_accvgpr_write_b32 a91, 0
  v_accvgpr_write_b32 a92, 0
  v_accvgpr_write_b32 a93, 0
  v_accvgpr_write_b32 a94, 0
  v_accvgpr_write_b32 a95, 0
  v_accvgpr_write_b32 a96, 0
  v_accvgpr_write_b32 a97, 0
  v_accvgpr_write_b32 a98, 0
  v_accvgpr_write_b32 a99, 0
  v_accvgpr_write_b32 a100, 0
  v_accvgpr_write_b32 a101, 0
  v_accvgpr_write_b32 a102, 0
  v_accvgpr_write_b32 a103, 0
  v_accvgpr_write_b32 a104, 0
  v_accvgpr_write_b32 a105, 0
  v_accvgpr_write_b32 a106, 0
  v_accvgpr_write_b32 a107, 0
  v_accvgpr_write_b32 a108, 0
  v_accvgpr_write_b32 a109, 0
  v_accvgpr_write_b32 a110, 0
  v_accvgpr_write_b32 a111, 0
  v_accvgpr_write_b32 a112, 0
  v_accvgpr_write_b32 a113, 0
  v_accvgpr_write_b32 a114, 0
  v_accvgpr_write_b32 a115, 0
  v_accvgpr_write_b32 a116, 0
  v_accvgpr_write_b32 a117, 0
  v_accvgpr_write_b32 a118, 0
  v_accvgpr_write_b32 a119, 0
  v_accvgpr_write_b32 a120, 0
  v_accvgpr_write_b32 a121, 0
  v_accvgpr_write_b32 a122, 0
  v_accvgpr_write_b32 a123, 0
  v_accvgpr_write_b32 a124, 0
  v_accvgpr_write_b32 a125, 0
  v_accvgpr_write_b32 a126, 0
  v_accvgpr_write_b32 a127, 0
  v_mov_b32 v8, 0
  v_mov_b32 v9, 0
  v_mov_b32 v10, 0
  v_mov_b32 v11, 0
  v_mov_b32 v52, 0
  v_mov_b32 v53, 0
  v_mov_b32 v54, s24
  v_mov_b32 v55, s24
  v_mov_b32 v56, s24
  v_mov_b32 v57, s24
  v_mov_b32 v58, s24
  v_mov_b32 v59, s24
  v_mov_b32 v60, s24
  v_mov_b32 v61, s24
  v_mov_b32 v62, s24
  v_mov_b32 v63, s24
  v_mov_b32 v104, 0
  v_mov_b32 v105, 0
  v_mov_b32 v4, v2
  v_mov_b32 v64, s24
  v_mov_b32 v65, s24
  v_mov_b32 v66, s24
  v_mov_b32 v67, s24
  v_mov_b32 v68, s24
  v_mov_b32 v69, s24
  v_mov_b32 v70, s24
  v_mov_b32 v71, s24
  v_mov_b32 v72, s24
  v_mov_b32 v73, s24
  v_mov_b32 v74, s24
  v_mov_b32 v75, s24
  v_mov_b32 v76, s24
  v_mov_b32 v77, s24
  v_mov_b32 v78, s24
  v_mov_b32 v79, s24
  v_mov_b32 v12, s24
  v_cmp_le_i32 s[40:41], 0, v5
  v_cmp_le_i32 s[42:43], 1, v5
  v_cmp_le_i32 s[44:45], 2, v5
  v_cmp_le_i32 s[46:47], 3, v5
  v_cndmask_b32 v80, v12, v7, s[40:41]
  v_cndmask_b32 v81, v12, v7, s[42:43]
  v_cndmask_b32 v82, v12, v7, s[44:45]
  v_cndmask_b32 v83, v12, v7, s[46:47]
  v_cmp_le_i32 s[40:41], 8, v5
  v_cmp_le_i32 s[42:43], 9, v5
  v_cmp_le_i32 s[44:45], 10, v5
  v_cmp_le_i32 s[46:47], 11, v5
  v_cndmask_b32 v84, v12, v7, s[40:41]
  v_cndmask_b32 v85, v12, v7, s[42:43]
  v_cndmask_b32 v86, v12, v7, s[44:45]
  v_cndmask_b32 v87, v12, v7, s[46:47]
  v_cmp_le_i32 s[40:41], 16, v5
  v_cmp_le_i32 s[42:43], 17, v5
  v_cmp_le_i32 s[44:45], 18, v5
  v_cmp_le_i32 s[46:47], 19, v5
  v_cndmask_b32 v88, v12, v7, s[40:41]
  v_cndmask_b32 v89, v12, v7, s[42:43]
  v_cndmask_b32 v90, v12, v7, s[44:45]
  v_cndmask_b32 v91, v12, v7, s[46:47]
  v_cmp_le_i32 s[40:41], 24, v5
  v_cmp_le_i32 s[42:43], 25, v5
  v_cmp_le_i32 s[44:45], 26, v5
  v_cmp_le_i32 s[46:47], 27, v5
  v_cndmask_b32 v92, v12, v7, s[40:41]
  v_cndmask_b32 v93, v12, v7, s[42:43]
  v_cndmask_b32 v94, v12, v7, s[44:45]
  v_cndmask_b32 v95, v12, v7, s[46:47]
  s_lshl_b32 s22, s69, 3
  s_add_u32 s22, s22, 8
  s_lshl_b32 s26, s16, 1
  s_sub_u32 s23, 6, s26
  s_waitcnt vmcnt(20)
  s_barrier
  s_cmp_eq_u32 s23, 0
  s_cbranch_scc1 A_go_19
A_idle_18:
  s_waitcnt vmcnt(16)
  s_barrier
  s_sub_u32 s18, s18, 8192
  s_max_i32 s18, s18, s20
  s_sub_u32 s17, s17, 8192
  s_max_i32 s17, s17, s19
  s_add_u32 s21, s21, 16384
  s_and_b32 s21, s21, 131071
M_kv_20:
  s_cmp_ge_u32 s17, s36
  s_cbranch_scc1 M_kvok_21
  s_mov_b32 s76, 0
  s_mov_b32 s78, 18
  s_mov_b32 s77, 376832
  s_cmp_eq_u32 s68, 1
  s_cmov_b32 s76, 128
  s_cmov_b32 s78, 22
  s_cmov_b32 s77, 196608
  s_cmp_eq_u32 s68, 2
  s_cmov_b32 s76, 512
  s_cmov_b32 s78, 24
  s_cmov_b32 s77, 0
  s_add_u32 s76, s76, s67
  s_mov_b32 s71, 0
M_sw_22:
  s_add_u32 s71, s71, 1
  s_cmp_gt_u32 s71, 262144
  s_cbranch_scc1 M_exit
  s_mov_b32 s79, 0
  s_atomic_or s79, s[72:73], s76 glc
  s_waitcnt lgkmcnt(0)
  s_cmp_lt_u32 s79, s78
  s_cbranch_scc1 M_sw_22
  s_add_u32 s36, s77, s19
  s_add_u32 s68, s68, 1
  s_branch M_kv_20
M_kvok_21:
  s_mov_b32 m0, s21
  s_nop 0
  buffer_load_dwordx4 v3, s[4:7], s18 offen offset:0 sc1 lds
  buffer_load_dwordx4 v3, s[4:7], s18 offen offset:1024 sc1 lds
  s_add_u32 m0, s21, 8192
  s_nop 0
  buffer_load_dwordx4 v3, s[4:7], s17 offen offset:0 sc1 lds
  buffer_load_dwordx4 v3, s[4:7], s17 offen offset:1024 sc1 lds
  v_add_u32 v4, 16384, v4
  v_and_b32 v4, 131071, v4
  s_sub_u32 s22, s22, 1
  s_sub_u32 s23, s23, 1
  s_cmp_lg_u32 s23, 0
  s_cbranch_scc1 A_idle_18
A_go_19:
  ds_read_b128 a[224:227], v4 offset:0
  ds_read_b128 a[228:231], v4 offset:2048
  ds_read_b128 a[232:235], v4 offset:4096
  ds_read_b128 a[236:239], v4 offset:6144
  ds_read_b128 a[240:243], v4 offset:1024
  ds_read_b128 a[244:247], v4 offset:3072
  ds_read_b128 a[248:251], v4 offset:5120
  ds_read_b128 a[252:255], v4 offset:7168
  ds_read_b128 a[192:195], v4 offset:8192
  ds_read_b128 a[196:199], v4 offset:9216
  ds_read_b128 a[200:203], v4 offset:10240
  ds_read_b128 a[204:207], v4 offset:11264
  ds_read_b128 a[208:211], v4 offset:12288
  ds_read_b128 a[212:215], v4 offset:13312
  ds_read_b128 a[216:219], v4 offset:14336
  ds_read_b128 a[220:223], v4 offset:15360
  v_add_u32 v4, 16384, v4
  v_and_b32 v4, 131071, v4
  s_waitcnt lgkmcnt(8)
.p2align 6
A_top_23:
  s_waitcnt lgkmcnt(7)
  v_mfma_f32_32x32x16_bf16 v[32:47], a[192:195], a[128:131], v[64:79]
  s_waitcnt lgkmcnt(6)
  v_exp_f32 v54, v54
  v_add_f32 v11, v11, v53
  v_cvt_pk_bf16_f32 v106, v52, v53
  v_mfma_f32_32x32x16_bf16 v[32:47], a[196:199], a[132:135], v[32:47]
  s_waitcnt lgkmcnt(4)
  v_exp_f32 v55, v55
  v_add_f32 v10, v10, v54
  v_mfma_f32_32x32x16_bf16 v[32:47], a[200:203], a[136:139], v[32:47]
  v_exp_f32 v56, v56
  v_add_f32 v11, v11, v55
  v_cvt_pk_bf16_f32 v107, v54, v55
  v_mfma_f32_32x32x16_bf16 v[32:47], a[204:207], a[140:143], v[32:47]
  s_waitcnt lgkmcnt(2)
  v_exp_f32 v57, v57
  v_add_f32 v10, v10, v56
  v_mfma_f32_32x32x16_bf16 v[32:47], a[208:211], a[144:147], v[32:47]
  v_exp_f32 v58, v58
  v_add_f32 v11, v11, v57
  v_cvt_pk_bf16_f32 v108, v56, v57
  v_mfma_f32_32x32x16_bf16 v[32:47], a[212:215], a[148:151], v[32:47]
  s_waitcnt lgkmcnt(0)
  v_exp_f32 v59, v59
  v_add_f32 v10, v10, v58
  v_mfma_f32_32x32x16_bf16 v[32:47], a[216:219], a[152:155], v[32:47]
  v_exp_f32 v60, v60
  v_add_f32 v11, v11, v59
  v_cvt_pk_bf16_f32 v109, v58, v59
  v_mfma_f32_32x32x16_bf16 v[32:47], a[220:223], a[156:159], v[32:47]
  s_waitcnt vmcnt(16)
  s_barrier
  v_exp_f32 v61, v61
  v_add_f32 v10, v10, v60
  v_mfma_f32_32x32x16_bf16 a[64:79], a[224:227], v[104:107], a[64:79]
  ds_read_b128 a[224:227], v4 offset:0
  v_exp_f32 v62, v62
  v_add_f32 v11, v11, v61
  v_cvt_pk_bf16_f32 v110, v60, v61
  v_mfma_f32_32x32x16_bf16 a[80:95], a[228:231], v[104:107], a[80:95]
  s_sub_u32 s18, s18, 8192
  ds_read_b128 a[228:231], v4 offset:2048
  v_exp_f32 v63, v63
  v_add_f32 v10, v10, v62
  v_mfma_f32_32x32x16_bf16 a[96:111], a[232:235], v[104:107], a[96:111]
  s_max_i32 s18, s18, s20
  ds_read_b128 a[232:235], v4 offset:4096
  v_exp_f32 v32, v32
  v_add_f32 v11, v11, v63
  v_cvt_pk_bf16_f32 v111, v62, v63
  v_mfma_f32_32x32x16_bf16 a[112:127], a[236:239], v[104:107], a[112:127]
  s_sub_u32 s17, s17, 8192
  ds_read_b128 a[236:239], v4 offset:6144
  v_exp_f32 v33, v33
  v_add_f32 v8, v8, v32
  v_mfma_f32_32x32x16_bf16 a[64:79], a[240:243], v[108:111], a[64:79]
  s_max_i32 s17, s17, s19
  ds_read_b128 a[240:243], v4 offset:1024
  v_exp_f32 v34, v34
  v_add_f32 v9, v9, v33
  v_cvt_pk_bf16_f32 v96, v32, v33
  v_mfma_f32_32x32x16_bf16 a[80:95], a[244:247], v[108:111], a[80:95]
  s_add_u32 s21, s21, 16384
  ds_read_b128 a[244:247], v4 offset:3072
  v_exp_f32 v35, v35
  v_add_f32 v8, v8, v34
  v_mfma_f32_32x32x16_bf16 a[96:111], a[248:251], v[108:111], a[96:111]
  s_and_b32 s21, s21, 131071
  ds_read_b128 a[248:251], v4 offset:5120
  v_exp_f32 v36, v36
  v_add_f32 v9, v9, v35
  v_cvt_pk_bf16_f32 v97, v34, v35
  v_mfma_f32_32x32x16_bf16 a[112:127], a[252:255], v[108:111], a[112:127]
  ds_read_b128 a[252:255], v4 offset:7168
  v_exp_f32 v37, v37
  v_add_f32 v8, v8, v36
  v_mfma_f32_32x32x16_bf16 v[48:63], a[192:195], a[160:163], v[80:95]
  s_add_u32 s23, s23, 1
  ds_read_b128 a[192:195], v4 offset:8192
  v_exp_f32 v38, v38
  v_add_f32 v9, v9, v37
  v_cvt_pk_bf16_f32 v98, v36, v37
  v_mfma_f32_32x32x16_bf16 v[48:63], a[196:199], a[164:167], v[48:63]
  s_sub_u32 s22, s22, 1
  ds_read_b128 a[196:199], v4 offset:9216
  v_exp_f32 v39, v39
  v_add_f32 v8, v8, v38
  v_mfma_f32_32x32x16_bf16 v[48:63], a[200:203], a[168:171], v[48:63]
  s_cmp_lt_u32 s23, 3
  ds_read_b128 a[200:203], v4 offset:10240
  v_exp_f32 v40, v40
  v_add_f32 v9, v9, v39
  v_cvt_pk_bf16_f32 v99, v38, v39
  v_mfma_f32_32x32x16_bf16 v[48:63], a[204:207], a[172:175], v[48:63]
  s_cbranch_scc1 A_upd_24
A_back_25:
  ds_read_b128 a[204:207], v4 offset:11264
  v_exp_f32 v41, v41
  v_add_f32 v8, v8, v40
  v_mfma_f32_32x32x16_bf16 v[48:63], a[208:211], a[176:179], v[48:63]
  s_cmp_lt_u32 s17, s36
  ds_read_b128 a[208:211], v4 offset:12288
  v_exp_f32 v42, v42
  v_add_f32 v9, v9, v41
  v_cvt_pk_bf16_f32 v100, v40, v41
  v_mfma_f32_32x32x16_bf16 v[48:63], a[212:215], a[180:183], v[48:63]
  s_cbranch_scc1 A_kvw_27
A_kvb_28:
  ds_read_b128 a[212:215], v4 offset:13312
  v_exp_f32 v43, v43
  v_add_f32 v8, v8, v42
  v_mfma_f32_32x32x16_bf16 v[48:63], a[216:219], a[184:187], v[48:63]
  s_mov_b32 m0, s21
  ds_read_b128 a[216:219], v4 offset:14336
  v_exp_f32 v44, v44
  v_add_f32 v9, v9, v43
  v_cvt_pk_bf16_f32 v101, v42, v43
  v_mfma_f32_32x32x16_bf16 v[48:63], a[220:223], a[188:191], v[48:63]
  s_waitcnt lgkmcnt(13)
  ds_read_b128 a[220:223], v4 offset:15360
  v_exp_f32 v45, v45
  v_add_f32 v8, v8, v44
  v_mfma_f32_32x32x16_bf16 a[0:15], a[224:227], v[96:99], a[0:15]
  buffer_load_dwordx4 v3, s[4:7], s18 offen offset:0 sc1 lds
  v_exp_f32 v46, v46
  v_add_f32 v9, v9, v45
  v_cvt_pk_bf16_f32 v102, v44, v45
  v_mfma_f32_32x32x16_bf16 a[16:31], a[228:231], v[96:99], a[16:31]
  s_waitcnt lgkmcnt(12)
  v_exp_f32 v47, v47
  v_add_f32 v8, v8, v46
  v_add_u32 v4, 16384, v4
  v_mfma_f32_32x32x16_bf16 a[32:47], a[232:235], v[96:99], a[32:47]
  buffer_load_dwordx4 v3, s[4:7], s18 offen offset:1024 sc1 lds
  v_exp_f32 v48, v48
  v_add_f32 v9, v9, v47
  v_cvt_pk_bf16_f32 v103, v46, v47
  v_mfma_f32_32x32x16_bf16 a[48:63], a[236:239], v[96:99], a[48:63]
  s_waitcnt lgkmcnt(10)
  s_add_u32 m0, s21, 8192
  v_exp_f32 v49, v49
  v_add_f32 v10, v10, v48
  v_and_b32 v4, 131071, v4
  v_mfma_f32_32x32x16_bf16 a[0:15], a[240:243], v[100:103], a[0:15]
  buffer_load_dwordx4 v3, s[4:7], s17 offen offset:0 sc1 lds
  v_exp_f32 v50, v50
  v_add_f32 v11, v11, v49
  v_cvt_pk_bf16_f32 v104, v48, v49
  v_mfma_f32_32x32x16_bf16 a[16:31], a[244:247], v[100:103], a[16:31]
  s_waitcnt lgkmcnt(8)
  s_cmp_lg_u32 s22, 0
  v_exp_f32 v51, v51
  v_add_f32 v10, v10, v50
  v_mfma_f32_32x32x16_bf16 a[32:47], a[248:251], v[100:103], a[32:47]
  buffer_load_dwordx4 v3, s[4:7], s17 offen offset:1024 sc1 lds
  v_exp_f32 v52, v52
  v_add_f32 v11, v11, v51
  v_cvt_pk_bf16_f32 v105, v50, v51
  v_mfma_f32_32x32x16_bf16 a[48:63], a[252:255], v[100:103], a[48:63]
  v_exp_f32 v53, v53
  v_add_f32 v10, v10, v52
  s_cbranch_scc1 A_top_23
  v_exp_f32 v54, v54
  v_add_f32 v11, v11, v53
  v_cvt_pk_bf16_f32 v106, v52, v53
  v_exp_f32 v55, v55
  v_add_f32 v10, v10, v54
  v_exp_f32 v56, v56
  v_add_f32 v11, v11, v55
  v_cvt_pk_bf16_f32 v107, v54, v55
  v_exp_f32 v57, v57
  v_add_f32 v10, v10, v56
  v_exp_f32 v58, v58
  v_add_f32 v11, v11, v57
  v_cvt_pk_bf16_f32 v108, v56, v57
  v_exp_f32 v59, v59
  v_add_f32 v10, v10, v58
  v_exp_f32 v60, v60
  v_add_f32 v11, v11, v59
  v_cvt_pk_bf16_f32 v109, v58, v59
  v_exp_f32 v61, v61
  v_add_f32 v10, v10, v60
  v_exp_f32 v62, v62
  v_add_f32 v11, v11, v61
  v_cvt_pk_bf16_f32 v110, v60, v61
  v_exp_f32 v63, v63
  v_add_f32 v10, v10, v62
  v_add_f32 v11, v11, v63
  v_cvt_pk_bf16_f32 v111, v62, v63
  s_nop 1
  v_mfma_f32_32x32x16_bf16 a[64:79], a[224:227], v[104:107], a[64:79]
  v_mfma_f32_32x32x16_bf16 a[80:95], a[228:231], v[104:107], a[80:95]
  v_mfma_f32_32x32x16_bf16 a[96:111], a[232:235], v[104:107], a[96:111]
  v_mfma_f32_32x32x16_bf16 a[112:127], a[236:239], v[104:107], a[112:127]
  v_mfma_f32_32x32x16_bf16 a[64:79], a[240:243], v[108:111], a[64:79]
  v_mfma_f32_32x32x16_bf16 a[80:95], a[244:247], v[108:111], a[80:95]
  v_mfma_f32_32x32x16_bf16 a[96:111], a[248:251], v[108:111], a[96:111]
  v_mfma_f32_32x32x16_bf16 a[112:127], a[252:255], v[108:111], a[112:127]
  v_add_f32 v8, v8, v9
  v_mov_b32 v9, v8
  s_nop 1
  v_permlane32_swap_b32 v8, v9
  s_nop 1
  v_add_f32 v8, v8, v9
  v_add_f32 v10, v10, v11
  v_mov_b32 v11, v10
  s_nop 1
  v_permlane32_swap_b32 v10, v11
  s_nop 1
  v_add_f32 v10, v10, v11
  v_subrev_u32 v12, 0x2f800000, v8
  v_subrev_u32 v13, 0x2f800000, v10
  v_max_u32 v12, v12, v13
  v_cmp_le_u32 vcc, 0x28000000, v12
  s_nop 1
  s_cmp_lg_u64 vcc, 0
  s_cselect_b32 s26, 1, 0
  v_mov_b32 v12, s26
  s_lshl_b32 s26, s16, 2
  s_add_u32 s26, s26, 131072
  v_mov_b32 v13, s26
  ds_write_b32 v13, v12
  v_mov_b32 v14, 131072
  s_waitcnt vmcnt(0) lgkmcnt(0)
  s_barrier
  ds_read_b128 v[16:19], v14
  v_rcp_f32 v8, v8
  v_rcp_f32 v10, v10
  s_waitcnt lgkmcnt(0)
  v_or3_b32 v12, v16, v17, v18
  v_or_b32 v12, v12, v19
  s_nop 0
  v_readfirstlane_b32 s26, v12
  s_nop 1
  s_cmp_gt_u32 s26, s29
  s_cbranch_scc1 A_slow_29
  s_add_u32 s28, s25, 100663296
  v_accvgpr_read_b32 v112, a0
  v_accvgpr_read_b32 v113, a1
  v_accvgpr_read_b32 v114, a2
  v_accvgpr_read_b32 v115, a3
  v_accvgpr_read_b32 v116, a4
  v_accvgpr_read_b32 v117, a5
  v_accvgpr_read_b32 v118, a6
  v_accvgpr_read_b32 v119, a7
  v_pk_mul_f32 v[112:113], v[112:113], v[8:9] op_sel_hi:[1,0]
  v_pk_mul_f32 v[114:115], v[114:115], v[8:9] op_sel_hi:[1,0]
  v_pk_mul_f32 v[116:117], v[116:117], v[8:9] op_sel_hi:[1,0]
  v_pk_mul_f32 v[118:119], v[118:119], v[8:9] op_sel_hi:[1,0]
  v_cvt_pk_bf16_f32 v120, v112, v113
  v_cvt_pk_bf16_f32 v121, v114, v115
  v_cvt_pk_bf16_f32 v122, v116, v117
  v_cvt_pk_bf16_f32 v123, v118, v119
  buffer_store_dwordx4 v[120:123], v2, s[4:7], s28 offen offset:0 sc1
  v_accvgpr_read_b32 v124, a8
  v_accvgpr_read_b32 v125, a9
  v_accvgpr_read_b32 v126, a10
  v_accvgpr_read_b32 v127, a11
  v_accvgpr_read_b32 v128, a12
  v_accvgpr_read_b32 v129, a13
  v_accvgpr_read_b32 v130, a14
  v_accvgpr_read_b32 v131, a15
  v_pk_mul_f32 v[124:125], v[124:125], v[8:9] op_sel_hi:[1,0]
  v_pk_mul_f32 v[126:127], v[126:127], v[8:9] op_sel_hi:[1,0]
  v_pk_mul_f32 v[128:129], v[128:129], v[8:9] op_sel_hi:[1,0]
  v_pk_mul_f32 v[130:131], v[130:131], v[8:9] op_sel_hi:[1,0]
  v_cvt_pk_bf16_f32 v132, v124, v125
  v_cvt_pk_bf16_f32 v133, v126, v127
  v_cvt_pk_bf16_f32 v134, v128, v129
  v_cvt_pk_bf16_f32 v135, v130, v131
  buffer_store_dwordx4 v[132:135], v2, s[4:7], s28 offen offset:1024 sc1
  v_accvgpr_read_b32 v136, a16
  v_accvgpr_read_b32 v137, a17
  v_accvgpr_read_b32 v138, a18
  v_accvgpr_read_b32 v139, a19
  v_accvgpr_read_b32 v140, a20
  v_accvgpr_read_b32 v141, a21
  v_accvgpr_read_b32 v142, a22
  v_accvgpr_read_b32 v143, a23
  v_pk_mul_f32 v[136:137], v[136:137], v[8:9] op_sel_hi:[1,0]
  v_pk_mul_f32 v[138:139], v[138:139], v[8:9] op_sel_hi:[1,0]
  v_pk_mul_f32 v[140:141], v[140:141], v[8:9] op_sel_hi:[1,0]
  v_pk_mul_f32 v[142:143], v[142:143], v[8:9] op_sel_hi:[1,0]
  v_cvt_pk_bf16_f32 v144, v136, v137
  v_cvt_pk_bf16_f32 v145, v138, v139
  v_cvt_pk_bf16_f32 v146, v140, v141
  v_cvt_pk_bf16_f32 v147, v142, v143
  buffer_store_dwordx4 v[144:147], v2, s[4:7], s28 offen offset:2048 sc1
  v_accvgpr_read_b32 v148, a24
  v_accvgpr_read_b32 v149, a25
  v_accvgpr_read_b32 v150, a26
  v_accvgpr_read_b32 v151, a27
  v_accvgpr_read_b32 v152, a28
  v_accvgpr_read_b32 v153, a29
  v_accvgpr_read_b32 v154, a30
  v_accvgpr_read_b32 v155, a31
  v_pk_mul_f32 v[148:149], v[148:149], v[8:9] op_sel_hi:[1,0]
  v_pk_mul_f32 v[150:151], v[150:151], v[8:9] op_sel_hi:[1,0]
  v_pk_mul_f32 v[152:153], v[152:153], v[8:9] op_sel_hi:[1,0]
  v_pk_mul_f32 v[154:155], v[154:155], v[8:9] op_sel_hi:[1,0]
  v_cvt_pk_bf16_f32 v156, v148, v149
  v_cvt_pk_bf16_f32 v157, v150, v151
  v_cvt_pk_bf16_f32 v158, v152, v153
  v_cvt_pk_bf16_f32 v159, v154, v155
  buffer_store_dwordx4 v[156:159], v2, s[4:7], s28 offen offset:3072 sc1
  s_add_u32 s28, s25, 100667392
  v_accvgpr_read_b32 v112, a32
  v_accvgpr_read_b32 v113, a33
  v_accvgpr_read_b32 v114, a34
  v_accvgpr_read_b32 v115, a35
  v_accvgpr_read_b32 v116, a36
  v_accvgpr_read_b32 v117, a37
  v_accvgpr_read_b32 v118, a38
  v_accvgpr_read_b32 v119, a39
  v_pk_mul_f32 v[112:113], v[112:113], v[8:9] op_sel_hi:[1,0]
  v_pk_mul_f32 v[114:115], v[114:115], v[8:9] op_sel_hi:[1,0]
  v_pk_mul_f32 v[116:117], v[116:117], v[8:9] op_sel_hi:[1,0]
  v_pk_mul_f32 v[118:119], v[118:119], v[8:9] op_sel_hi:[1,0]
  v_cvt_pk_bf16_f32 v120, v112, v113
  v_cvt_pk_bf16_f32 v121, v114, v115
  v_cvt_pk_bf16_f32 v122, v116, v117
  v_cvt_pk_bf16_f32 v123, v118, v119
  buffer_store_dwordx4 v[120:123], v2, s[4:7], s28 offen offset:0 sc1
  v_accvgpr_read_b32 v124, a40
  v_accvgpr_read_b32 v125, a41
  v_accvgpr_read_b32 v126, a42
  v_accvgpr_read_b32 v127, a43
  v_accvgpr_read_b32 v128, a44
  v_accvgpr_read_b32 v129, a45
  v_accvgpr_read_b32 v130, a46
  v_accvgpr_read_b32 v131, a47
  v_pk_mul_f32 v[124:125], v[124:125], v[8:9] op_sel_hi:[1,0]
  v_pk_mul_f32 v[126:127], v[126:127], v[8:9] op_sel_hi:[1,0]
  v_pk_mul_f32 v[128:129], v[128:129], v[8:9] op_sel_hi:[1,0]
  v_pk_mul_f32 v[130:131], v[130:131], v[8:9] op_sel_hi:[1,0]
  v_cvt_pk_bf16_f32 v132, v124, v125
  v_cvt_pk_bf16_f32 v133, v126, v127
  v_cvt_pk_bf16_f32 v134, v128, v129
  v_cvt_pk_bf16_f32 v135, v130, v131
  buffer_store_dwordx4 v[132:135], v2, s[4:7], s28 offen offset:1024 sc1
  v_accvgpr_read_b32 v136, a48
  v_accvgpr_read_b32 v137, a49
  v_accvgpr_read_b32 v138, a50
  v_accvgpr_read_b32 v139, a51
  v_accvgpr_read_b32 v140, a52
  v_accvgpr_read_b32 v141, a53
  v_accvgpr_read_b32 v142, a54
  v_accvgpr_read_b32 v143, a55
  v_pk_mul_f32 v[136:137], v[136:137], v[8:9] op_sel_hi:[1,0]
  v_pk_mul_f32 v[138:139], v[138:139], v[8:9] op_sel_hi:[1,0]
  v_pk_mul_f32 v[140:141], v[140:141], v[8:9] op_sel_hi:[1,0]
  v_pk_mul_f32 v[142:143], v[142:143], v[8:9] op_sel_hi:[1,0]
  v_cvt_pk_bf16_f32 v144, v136, v137
  v_cvt_pk_bf16_f32 v145, v138, v139
  v_cvt_pk_bf16_f32 v146, v140, v141
  v_cvt_pk_bf16_f32 v147, v142, v143
  buffer_store_dwordx4 v[144:147], v2, s[4:7], s28 offen offset:2048 sc1
  v_accvgpr_read_b32 v148, a56
  v_accvgpr_read_b32 v149, a57
  v_accvgpr_read_b32 v150, a58
  v_accvgpr_read_b32 v151, a59
  v_accvgpr_read_b32 v152, a60
  v_accvgpr_read_b32 v153, a61
  v_accvgpr_read_b32 v154, a62
  v_accvgpr_read_b32 v155, a63
  v_pk_mul_f32 v[148:149], v[148:149], v[8:9] op_sel_hi:[1,0]
  v_pk_mul_f32 v[150:151], v[150:151], v[8:9] op_sel_hi:[1,0]
  v_pk_mul_f32 v[152:153], v[152:153], v[8:9] op_sel_hi:[1,0]
  v_pk_mul_f32 v[154:155], v[154:155], v[8:9] op_sel_hi:[1,0]
  v_cvt_pk_bf16_f32 v156, v148, v149
  v_cvt_pk_bf16_f32 v157, v150, v151
  v_cvt_pk_bf16_f32 v158, v152, v153
  v_cvt_pk_bf16_f32 v159, v154, v155
  buffer_store_dwordx4 v[156:159], v2, s[4:7], s28 offen offset:3072 sc1
  s_add_u32 s28, s25, 100671488
  v_accvgpr_read_b32 v112, a64
  v_accvgpr_read_b32 v113, a65
  v_accvgpr_read_b32 v114, a66
  v_accvgpr_read_b32 v115, a67
  v_accvgpr_read_b32 v116, a68
  v_accvgpr_read_b32 v117, a69
  v_accvgpr_read_b32 v118, a70
  v_accvgpr_read_b32 v119, a71
  v_pk_mul_f32 v[112:113], v[112:113], v[10:11] op_sel_hi:[1,0]
  v_pk_mul_f32 v[114:115], v[114:115], v[10:11] op_sel_hi:[1,0]
  v_pk_mul_f32 v[116:117], v[116:117], v[10:11] op_sel_hi:[1,0]
  v_pk_mul_f32 v[118:119], v[118:119], v[10:11] op_sel_hi:[1,0]
  v_cvt_pk_bf16_f32 v120, v112, v113
  v_cvt_pk_bf16_f32 v121, v114, v115
  v_cvt_pk_bf16_f32 v122, v116, v117
  v_cvt_pk_bf16_f32 v123, v118, v119
  buffer_store_dwordx4 v[120:123], v2, s[4:7], s28 offen offset:0 sc1
  v_accvgpr_read_b32 v124, a72
  v_accvgpr_read_b32 v125, a73
  v_accvgpr_read_b32 v126, a74
  v_accvgpr_read_b32 v127, a75
  v_accvgpr_read_b32 v128, a76
  v_accvgpr_read_b32 v129, a77
  v_accvgpr_read_b32 v130, a78
  v_accvgpr_read_b32 v131, a79
  v_pk_mul_f32 v[124:125], v[124:125], v[10:11] op_sel_hi:[1,0]
  v_pk_mul_f32 v[126:127], v[126:127], v[10:11] op_sel_hi:[1,0]
  v_pk_mul_f32 v[128:129], v[128:129], v[10:11] op_sel_hi:[1,0]
  v_pk_mul_f32 v[130:131], v[130:131], v[10:11] op_sel_hi:[1,0]
  v_cvt_pk_bf16_f32 v132, v124, v125
  v_cvt_pk_bf16_f32 v133, v126, v127
  v_cvt_pk_bf16_f32 v134, v128, v129
  v_cvt_pk_bf16_f32 v135, v130, v131
  buffer_store_dwordx4 v[132:135], v2, s[4:7], s28 offen offset:1024 sc1
  v_accvgpr_read_b32 v136, a80
  v_accvgpr_read_b32 v137, a81
  v_accvgpr_read_b32 v138, a82
  v_accvgpr_read_b32 v139, a83
  v_accvgpr_read_b32 v140, a84
  v_accvgpr_read_b32 v141, a85
  v_accvgpr_read_b32 v142, a86
  v_accvgpr_read_b32 v143, a87
  v_pk_mul_f32 v[136:137], v[136:137], v[10:11] op_sel_hi:[1,0]
  v_pk_mul_f32 v[138:139], v[138:139], v[10:11] op_sel_hi:[1,0]
  v_pk_mul_f32 v[140:141], v[140:141], v[10:11] op_sel_hi:[1,0]
  v_pk_mul_f32 v[142:143], v[142:143], v[10:11] op_sel_hi:[1,0]
  v_cvt_pk_bf16_f32 v144, v136, v137
  v_cvt_pk_bf16_f32 v145, v138, v139
  v_cvt_pk_bf16_f32 v146, v140, v141
  v_cvt_pk_bf16_f32 v147, v142, v143
  buffer_store_dwordx4 v[144:147], v2, s[4:7], s28 offen offset:2048 sc1
  v_accvgpr_read_b32 v148, a88
  v_accvgpr_read_b32 v149, a89
  v_accvgpr_read_b32 v150, a90
  v_accvgpr_read_b32 v151, a91
  v_accvgpr_read_b32 v152, a92
  v_accvgpr_read_b32 v153, a93
  v_accvgpr_read_b32 v154, a94
  v_accvgpr_read_b32 v155, a95
  v_pk_mul_f32 v[148:149], v[148:149], v[10:11] op_sel_hi:[1,0]
  v_pk_mul_f32 v[150:151], v[150:151], v[10:11] op_sel_hi:[1,0]
  v_pk_mul_f32 v[152:153], v[152:153], v[10:11] op_sel_hi:[1,0]
  v_pk_mul_f32 v[154:155], v[154:155], v[10:11] op_sel_hi:[1,0]
  v_cvt_pk_bf16_f32 v156, v148, v149
  v_cvt_pk_bf16_f32 v157, v150, v151
  v_cvt_pk_bf16_f32 v158, v152, v153
  v_cvt_pk_bf16_f32 v159, v154, v155
  buffer_store_dwordx4 v[156:159], v2, s[4:7], s28 offen offset:3072 sc1
  s_add_u32 s28, s25, 100675584
  v_accvgpr_read_b32 v112, a96
  v_accvgpr_read_b32 v113, a97
  v_accvgpr_read_b32 v114, a98
  v_accvgpr_read_b32 v115, a99
  v_accvgpr_read_b32 v116, a100
  v_accvgpr_read_b32 v117, a101
  v_accvgpr_read_b32 v118, a102
  v_accvgpr_read_b32 v119, a103
  v_pk_mul_f32 v[112:113], v[112:113], v[10:11] op_sel_hi:[1,0]
  v_pk_mul_f32 v[114:115], v[114:115], v[10:11] op_sel_hi:[1,0]
  v_pk_mul_f32 v[116:117], v[116:117], v[10:11] op_sel_hi:[1,0]
  v_pk_mul_f32 v[118:119], v[118:119], v[10:11] op_sel_hi:[1,0]
  v_cvt_pk_bf16_f32 v120, v112, v113
  v_cvt_pk_bf16_f32 v121, v114, v115
  v_cvt_pk_bf16_f32 v122, v116, v117
  v_cvt_pk_bf16_f32 v123, v118, v119
  buffer_store_dwordx4 v[120:123], v2, s[4:7], s28 offen offset:0 sc1
  v_accvgpr_read_b32 v124, a104
  v_accvgpr_read_b32 v125, a105
  v_accvgpr_read_b32 v126, a106
  v_accvgpr_read_b32 v127, a107
  v_accvgpr_read_b32 v128, a108
  v_accvgpr_read_b32 v129, a109
  v_accvgpr_read_b32 v130, a110
  v_accvgpr_read_b32 v131, a111
  v_pk_mul_f32 v[124:125], v[124:125], v[10:11] op_sel_hi:[1,0]
  v_pk_mul_f32 v[126:127], v[126:127], v[10:11] op_sel_hi:[1,0]
  v_pk_mul_f32 v[128:129], v[128:129], v[10:11] op_sel_hi:[1,0]
  v_pk_mul_f32 v[130:131], v[130:131], v[10:11] op_sel_hi:[1,0]
  v_cvt_pk_bf16_f32 v132, v124, v125
  v_cvt_pk_bf16_f32 v133, v126, v127
  v_cvt_pk_bf16_f32 v134, v128, v129
  v_cvt_pk_bf16_f32 v135, v130, v131
  buffer_store_dwordx4 v[132:135], v2, s[4:7], s28 offen offset:1024 sc1
  v_accvgpr_read_b32 v136, a112
  v_accvgpr_read_b32 v137, a113
  v_accvgpr_read_b32 v138, a114
  v_accvgpr_read_b32 v139, a115
  v_accvgpr_read_b32 v140, a116
  v_accvgpr_read_b32 v141, a117
  v_accvgpr_read_b32 v142, a118
  v_accvgpr_read_b32 v143, a119
  v_pk_mul_f32 v[136:137], v[136:137], v[10:11] op_sel_hi:[1,0]
  v_pk_mul_f32 v[138:139], v[138:139], v[10:11] op_sel_hi:[1,0]
  v_pk_mul_f32 v[140:141], v[140:141], v[10:11] op_sel_hi:[1,0]
  v_pk_mul_f32 v[142:143], v[142:143], v[10:11] op_sel_hi:[1,0]
  v_cvt_pk_bf16_f32 v144, v136, v137
  v_cvt_pk_bf16_f32 v145, v138, v139
  v_cvt_pk_bf16_f32 v146, v140, v141
  v_cvt_pk_bf16_f32 v147, v142, v143
  buffer_store_dwordx4 v[144:147], v2, s[4:7], s28 offen offset:2048 sc1
  v_accvgpr_read_b32 v148, a120
  v_accvgpr_read_b32 v149, a121
  v_accvgpr_read_b32 v150, a122
  v_accvgpr_read_b32 v151, a123
  v_accvgpr_read_b32 v152, a124
  v_accvgpr_read_b32 v153, a125
  v_accvgpr_read_b32 v154, a126
  v_accvgpr_read_b32 v155, a127
  v_pk_mul_f32 v[148:149], v[148:149], v[10:11] op_sel_hi:[1,0]
  v_pk_mul_f32 v[150:151], v[150:151], v[10:11] op_sel_hi:[1,0]
  v_pk_mul_f32 v[152:153], v[152:153], v[10:11] op_sel_hi:[1,0]
  v_pk_mul_f32 v[154:155], v[154:155], v[10:11] op_sel_hi:[1,0]
  v_cvt_pk_bf16_f32 v156, v148, v149
  v_cvt_pk_bf16_f32 v157, v150, v151
  v_cvt_pk_bf16_f32 v158, v152, v153
  v_cvt_pk_bf16_f32 v159, v154, v155
  buffer_store_dwordx4 v[156:159], v2, s[4:7], s28 offen offset:3072 sc1
  s_branch A_out_26
A_kvw_27:
M_kv_30:
  s_cmp_ge_u32 s17, s36
  s_cbranch_scc1 M_kvok_31
  s_mov_b32 s76, 0
  s_mov_b32 s78, 18
  s_mov_b32 s77, 376832
  s_cmp_eq_u32 s68, 1
  s_cmov_b32 s76, 128
  s_cmov_b32 s78, 22
  s_cmov_b32 s77, 196608
  s_cmp_eq_u32 s68, 2
  s_cmov_b32 s76, 512
  s_cmov_b32 s78, 24
  s_cmov_b32 s77, 0
  s_add_u32 s76, s76, s67
  s_mov_b32 s71, 0
M_sw_32:
  s_add_u32 s71, s71, 1
  s_cmp_gt_u32 s71, 262144
  s_cbranch_scc1 M_exit
  s_mov_b32 s79, 0
  s_atomic_or s79, s[72:73], s76 glc
  s_waitcnt lgkmcnt(0)
  s_cmp_lt_u32 s79, s78
  s_cbranch_scc1 M_sw_32
  s_add_u32 s36, s77, s19
  s_add_u32 s68, s68, 1
  s_branch M_kv_30
M_kvok_31:
  s_branch A_kvb_28
A_upd_24:
  s_cmp_eq_u32 s23, 2
  s_cbranch_scc1 A_upd2_33
  v_mov_b32 v12, s24
  v_cmp_le_i32 s[40:41], 0, v5
  v_cmp_le_i32 s[42:43], 1, v5
  v_cmp_le_i32 s[44:45], 2, v5
  v_cmp_le_i32 s[46:47], 3, v5
  v_cndmask_b32 v64, v12, v6, s[40:41]
  v_cndmask_b32 v65, v12, v6, s[42:43]
  v_cndmask_b32 v66, v12, v6, s[44:45]
  v_cndmask_b32 v67, v12, v6, s[46:47]
  v_cmp_le_i32 s[40:41], 8, v5
  v_cmp_le_i32 s[42:43], 9, v5
  v_cmp_le_i32 s[44:45], 10, v5
  v_cmp_le_i32 s[46:47], 11, v5
  v_cndmask_b32 v68, v12, v6, s[40:41]
  v_cndmask_b32 v69, v12, v6, s[42:43]
  v_cndmask_b32 v70, v12, v6, s[44:45]
  v_cndmask_b32 v71, v12, v6, s[46:47]
  v_cmp_le_i32 s[40:41], 16, v5
  v_cmp_le_i32 s[42:43], 17, v5
  v_cmp_le_i32 s[44:45], 18, v5
  v_cmp_le_i32 s[46:47], 19, v5
  v_cndmask_b32 v72, v12, v6, s[40:41]
  v_cndmask_b32 v73, v12, v6, s[42:43]
  v_cndmask_b32 v74, v12, v6, s[44:45]
  v_cndmask_b32 v75, v12, v6, s[46:47]
  v_cmp_le_i32 s[40:41], 24, v5
  v_cmp_le_i32 s[42:43], 25, v5
  v_cmp_le_i32 s[44:45], 26, v5
  v_cmp_le_i32 s[46:47], 27, v5
  v_cndmask_b32 v76, v12, v6, s[40:41]
  v_cndmask_b32 v77, v12, v6, s[42:43]
  v_cndmask_b32 v78, v12, v6, s[44:45]
  v_cndmask_b32 v79, v12, v6, s[46:47]
  v_mov_b32 v80, v7
  v_mov_b32 v81, v7
  v_mov_b32 v82, v7
  v_mov_b32 v83, v7
  v_mov_b32 v84, v7
  v_mov_b32 v85, v7
  v_mov_b32 v86, v7
  v_mov_b32 v87, v7
  v_mov_b32 v88, v7
  v_mov_b32 v89, v7
  v_mov_b32 v90, v7
  v_mov_b32 v91, v7
  v_mov_b32 v92, v7
  v_mov_b32 v93, v7
  v_mov_b32 v94, v7
  v_mov_b32 v95, v7
  s_branch A_back_25
A_upd2_33:
  v_mov_b32 v64, v6
  v_mov_b32 v65, v6
  v_mov_b32 v66, v6
  v_mov_b32 v67, v6
  v_mov_b32 v68, v6
  v_mov_b32 v69, v6
  v_mov_b32 v70, v6
  v_mov_b32 v71, v6
  v_mov_b32 v72, v6
  v_mov_b32 v73, v6
  v_mov_b32 v74, v6
  v_mov_b32 v75, v6
  v_mov_b32 v76, v6
  v_mov_b32 v77, v6
  v_mov_b32 v78, v6
  v_mov_b32 v79, v6
  s_branch A_back_25
A_slow_29:
  s_mov_b32 s29, 1
  v_mov_b32 v64, s24
  v_mov_b32 v65, s24
  v_mov_b32 v66, s24
  v_mov_b32 v67, s24
  v_mov_b32 v68, s24
  v_mov_b32 v69, s24
  v_mov_b32 v70, s24
  v_mov_b32 v71, s24
  v_mov_b32 v72, s24
  v_mov_b32 v73, s24
  v_mov_b32 v74, s24
  v_mov_b32 v75, s24
  v_mov_b32 v76, s24
  v_mov_b32 v77, s24
  v_mov_b32 v78, s24
  v_mov_b32 v79, s24
  v_mov_b32 v12, s24
  v_cmp_le_i32 s[40:41], 0, v5
  v_cmp_le_i32 s[42:43], 1, v5
  v_cmp_le_i32 s[44:45], 2, v5
  v_cmp_le_i32 s[46:47], 3, v5
  v_cndmask_b32 v80, v12, v7, s[40:41]
  v_cndmask_b32 v81, v12, v7, s[42:43]
  v_cndmask_b32 v82, v12, v7, s[44:45]
  v_cndmask_b32 v83, v12, v7, s[46:47]
  v_cmp_le_i32 s[40:41], 8, v5
  v_cmp_le_i32 s[42:43], 9, v5
  v_cmp_le_i32 s[44:45], 10, v5
  v_cmp_le_i32 s[46:47], 11, v5
  v_cndmask_b32 v84, v12, v7, s[40:41]
  v_cndmask_b32 v85, v12, v7, s[42:43]
  v_cndmask_b32 v86, v12, v7, s[44:45]
  v_cndmask_b32 v87, v12, v7, s[46:47]
  v_cmp_le_i32 s[40:41], 16, v5
  v_cmp_le_i32 s[42:43], 17, v5
  v_cmp_le_i32 s[44:45], 18, v5
  v_cmp_le_i32 s[46:47], 19, v5
  v_cndmask_b32 v88, v12, v7, s[40:41]
  v_cndmask_b32 v89, v12, v7, s[42:43]
  v_cndmask_b32 v90, v12, v7, s[44:45]
  v_cndmask_b32 v91, v12, v7, s[46:47]
  v_cmp_le_i32 s[40:41], 24, v5
  v_cmp_le_i32 s[42:43], 25, v5
  v_cmp_le_i32 s[44:45], 26, v5
  v_cmp_le_i32 s[46:47], 27, v5
  v_cndmask_b32 v92, v12, v7, s[40:41]
  v_cndmask_b32 v93, v12, v7, s[42:43]
  v_cndmask_b32 v94, v12, v7, s[44:45]
  v_cndmask_b32 v95, v12, v7, s[46:47]
  v_mov_b32 v8, s24
  v_mov_b32 v10, s24
  s_add_u32 s17, s25, 16785408
  s_mov_b32 s23, 0
A_ml_34:
  s_add_u32 s28, s17, 4096
  buffer_load_dwordx4 a[192:195], v2, s[4:7], s17 offen offset:0 sc1
  buffer_load_dwordx4 a[196:199], v2, s[4:7], s17 offen offset:1024 sc1
  buffer_load_dwordx4 a[200:203], v2, s[4:7], s17 offen offset:2048 sc1
  buffer_load_dwordx4 a[204:207], v2, s[4:7], s17 offen offset:3072 sc1
  buffer_load_dwordx4 a[208:211], v2, s[4:7], s28 offen offset:0 sc1
  buffer_load_dwordx4 a[212:215], v2, s[4:7], s28 offen offset:1024 sc1
  buffer_load_dwordx4 a[216:219], v2, s[4:7], s28 offen offset:2048 sc1
  buffer_load_dwordx4 a[220:223], v2, s[4:7], s28 offen offset:3072 sc1
  s_waitcnt vmcnt(0)
  v_mfma_f32_32x32x16_bf16 v[32:47], a[192:195], a[128:131], v[64:79]
  v_mfma_f32_32x32x16_bf16 v[32:47], a[196:199], a[132:135], v[32:47]
  v_mfma_f32_32x32x16_bf16 v[32:47], a[200:203], a[136:139], v[32:47]
  v_mfma_f32_32x32x16_bf16 v[32:47], a[204:207], a[140:143], v[32:47]
  v_mfma_f32_32x32x16_bf16 v[32:47], a[208:211], a[144:147], v[32:47]
  v_mfma_f32_32x32x16_bf16 v[32:47], a[212:215], a[148:151], v[32:47]
  v_mfma_f32_32x32x16_bf16 v[32:47], a[216:219], a[152:155], v[32:47]
  v_mfma_f32_32x32x16_bf16 v[32:47], a[220:223], a[156:159], v[32:47]
  v_mfma_f32_32x32x16_bf16 v[48:63], a[192:195], a[160:163], v[80:95]
  v_mfma_f32_32x32x16_bf16 v[48:63], a[196:199], a[164:167], v[48:63]
  v_mfma_f32_32x32x16_bf16 v[48:63], a[200:203], a[168:171], v[48:63]
  v_mfma_f32_32x32x16_bf16 v[48:63], a[204:207], a[172:175], v[48:63]
  v_mfma_f32_32x32x16_bf16 v[48:63], a[208:211], a[176:179], v[48:63]
  v_mfma_f32_32x32x16_bf16 v[48:63], a[212:215], a[180:183], v[48:63]
  v_mfma_f32_32x32x16_bf16 v[48:63], a[216:219], a[184:187], v[48:63]
  v_mfma_f32_32x32x16_bf16 v[48:63], a[220:223], a[188:191], v[48:63]
  s_nop 7
  s_nop 3
  v_max3_f32 v8, v8, v32, v33
  v_max3_f32 v8, v8, v34, v35
  v_max3_f32 v8, v8, v36, v37
  v_max3_f32 v8, v8, v38, v39
  v_max3_f32 v8, v8, v40, v41
  v_max3_f32 v8, v8, v42, v43
  v_max3_f32 v8, v8, v44, v45
  v_max3_f32 v8, v8, v46, v47
  v_max3_f32 v10, v10, v48, v49
  v_max3_f32 v10, v10, v50, v51
  v_max3_f32 v10, v10, v52, v53
  v_max3_f32 v10, v10, v54, v55
  v_max3_f32 v10, v10, v56, v57
  v_max3_f32 v10, v10, v58, v59
  v_max3_f32 v10, v10, v60, v61
  v_max3_f32 v10, v10, v62, v63
  s_add_u32 s23, s23, 1
  s_cmp_lg_u32 s23, 1
  s_cbranch_scc1 A_m2_35
  v_mov_b32 v12, s24
  v_cmp_le_i32 s[40:41], 0, v5
  v_cmp_le_i32 s[42:43], 1, v5
  v_cmp_le_i32 s[44:45], 2, v5
  v_cmp_le_i32 s[46:47], 3, v5
  v_cndmask_b32 v64, v12, v6, s[40:41]
  v_cndmask_b32 v65, v12, v6, s[42:43]
  v_cndmask_b32 v66, v12, v6, s[44:45]
  v_cndmask_b32 v67, v12, v6, s[46:47]
  v_cmp_le_i32 s[40:41], 8, v5
  v_cmp_le_i32 s[42:43], 9, v5
  v_cmp_le_i32 s[44:45], 10, v5
  v_cmp_le_i32 s[46:47], 11, v5
  v_cndmask_b32 v68, v12, v6, s[40:41]
  v_cndmask_b32 v69, v12, v6, s[42:43]
  v_cndmask_b32 v70, v12, v6, s[44:45]
  v_cndmask_b32 v71, v12, v6, s[46:47]
  v_cmp_le_i32 s[40:41], 16, v5
  v_cmp_le_i32 s[42:43], 17, v5
  v_cmp_le_i32 s[44:45], 18, v5
  v_cmp_le_i32 s[46:47], 19, v5
  v_cndmask_b32 v72, v12, v6, s[40:41]
  v_cndmask_b32 v73, v12, v6, s[42:43]
  v_cndmask_b32 v74, v12, v6, s[44:45]
  v_cndmask_b32 v75, v12, v6, s[46:47]
  v_cmp_le_i32 s[40:41], 24, v5
  v_cmp_le_i32 s[42:43], 25, v5
  v_cmp_le_i32 s[44:45], 26, v5
  v_cmp_le_i32 s[46:47], 27, v5
  v_cndmask_b32 v76, v12, v6, s[40:41]
  v_cndmask_b32 v77, v12, v6, s[42:43]
  v_cndmask_b32 v78, v12, v6, s[44:45]
  v_cndmask_b32 v79, v12, v6, s[46:47]
  v_mov_b32 v80, v7
  v_mov_b32 v81, v7
  v_mov_b32 v82, v7
  v_mov_b32 v83, v7
  v_mov_b32 v84, v7
  v_mov_b32 v85, v7
  v_mov_b32 v86, v7
  v_mov_b32 v87, v7
  v_mov_b32 v88, v7
  v_mov_b32 v89, v7
  v_mov_b32 v90, v7
  v_mov_b32 v91, v7
  v_mov_b32 v92, v7
  v_mov_b32 v93, v7
  v_mov_b32 v94, v7
  v_mov_b32 v95, v7
A_m2_35:
  s_cmp_lg_u32 s23, 2
  s_cbranch_scc1 A_m3_36
  v_mov_b32 v64, v6
  v_mov_b32 v65, v6
  v_mov_b32 v66, v6
  v_mov_b32 v67, v6
  v_mov_b32 v68, v6
  v_mov_b32 v69, v6
  v_mov_b32 v70, v6
  v_mov_b32 v71, v6
  v_mov_b32 v72, v6
  v_mov_b32 v73, v6
  v_mov_b32 v74, v6
  v_mov_b32 v75, v6
  v_mov_b32 v76, v6
  v_mov_b32 v77, v6
  v_mov_b32 v78, v6
  v_mov_b32 v79, v6
A_m3_36:
  s_sub_u32 s17, s17, 8192
  s_cmp_ge_i32 s17, s19
  s_cbranch_scc1 A_ml_34
  v_mov_b32 v9, v8
  s_nop 1
  v_permlane32_swap_b32 v8, v9
  s_nop 1
  v_max_f32 v8, v8, v9
  v_sub_f32 v6, 0, v8
  v_mov_b32 v11, v10
  s_nop 1
  v_permlane32_swap_b32 v10, v11
  s_nop 1
  v_max_f32 v10, v10, v11
  v_sub_f32 v7, 0, v10
  s_branch A_again_17
A_out_26:
  s_mov_b32 s69, s55
  s_mov_b32 s70, s56
  s_sub_u32 s52, s52, 1
  s_cmp_lg_u32 s52, 0
  s_cbranch_scc1 M_att
  s_waitcnt vmcnt(0)
  s_barrier
  s_mov_b32 s30, 512
  v_mov_b32 v144, s30
  v_min_u32 v145, 1, v0
  v_lshlrev_b32 v145, 30, v145
  buffer_store_dword v144, v145, s[4:7], s31 offen sc1
  s_lshr_b32 s48, s64, 2
  s_bfe_u32 s49, s64, 0x10001
  s_and_b32 s50, s64, 1
  s_mul_i32 s50, s50, 6
  s_add_u32 s50, s50, s65
  s_mov_b32 s51, 12
  s_cmp_lt_u32 s50, 4
  s_cselect_b32 s23, 6, 5
  s_load_dwordx2 s[8:9], s[0:1], 40
  s_lshl_b32 s17, s48, 19
  s_lshl_b32 s26, s49, 2
  s_add_u32 s26, s26, s16
  s_lshl_b32 s27, s26, 7
  s_add_u32 s17, s17, s27
  s_mov_b32 s18, 1024
  s_lshl_b32 s21, s48, 6
  s_add_u32 s21, s21, s50
  s_lshl_b32 s21, s21, 3
  s_add_u32 s21, s21, s26
  s_lshl_b32 s21, s21, 12
  s_add_u32 s21, s21, 150994944
  s_lshl_b32 s22, s51, 15
  s_mov_b32 s24, 1.0
  s_waitcnt lgkmcnt(0)
  s_and_b32 s9, s9, 0xffff
  s_mov_b32 s10, 4194304
  s_mov_b32 s11, 0x20000
  s_mov_b32 s12, s4
  s_mov_b32 s13, s5
  s_mov_b32 s14, 268435456
  s_mov_b32 s15, 0x20000
  s_lshl_b32 s19, s48, 8
  s_add_u32 s19, s19, s50
  s_lshl_b32 s19, s19, 13
  s_add_u32 s19, s19, 100663296
  s_lshl_b32 s20, s51, 13
  s_mul_i32 s26, s16, 524288
  v_add_u32 v8, 0, v2
  v_add_u32 v16, s26, v8
  v_add_u32 v9, 1024, v2
  v_add_u32 v17, s26, v9
  v_add_u32 v10, 2048, v2
  v_add_u32 v18, s26, v10
  v_add_u32 v11, 3072, v2
  v_add_u32 v19, s26, v11
  v_add_u32 v12, 4096, v2
  v_add_u32 v20, s26, v12
  v_add_u32 v13, 5120, v2
  v_add_u32 v21, s26, v13
  v_add_u32 v14, 6144, v2
  v_add_u32 v22, s26, v14
  v_add_u32 v15, 7168, v2
  v_add_u32 v23, s26, v15
  v_lshrrev_b32 v144, 3, v1
  v_mul_lo_u32 v144, v144, s18
  v_and_b32 v145, 7, v1
  v_lshl_add_u32 v144, v145, 4, v144
  s_lshl_b32 s28, s16, 15
  s_add_u32 s28, s28, 32768
  s_lshl_b32 s29, s18, 3
  s_add_u32 m0, s28, 0
  s_nop 0
  buffer_load_dwordx4 v144, s[8:11], s17 offen lds
  s_add_u32 s17, s17, s29
  s_add_u32 m0, s28, 1024
  s_nop 0
  buffer_load_dwordx4 v144, s[8:11], s17 offen lds
  s_add_u32 s17, s17, s29
  s_add_u32 m0, s28, 2048
  s_nop 0
  buffer_load_dwordx4 v144, s[8:11], s17 offen lds
  s_add_u32 s17, s17, s29
  s_add_u32 m0, s28, 3072
  s_nop 0
  buffer_load_dwordx4 v144, s[8:11], s17 offen lds
  s_add_u32 s17, s17, s29
  s_add_u32 m0, s28, 4096
  s_nop 0
  buffer_load_dwordx4 v144, s[8:11], s17 offen lds
  s_add_u32 s17, s17, s29
  s_add_u32 m0, s28, 5120
  s_nop 0
  buffer_load_dwordx4 v144, s[8:11], s17 offen lds
  s_add_u32 s17, s17, s29
  s_add_u32 m0, s28, 6144
  s_nop 0
  buffer_load_dwordx4 v144, s[8:11], s17 offen lds
  s_add_u32 s17, s17, s29
  s_add_u32 m0, s28, 7168
  s_nop 0
  buffer_load_dwordx4 v144, s[8:11], s17 offen lds
  s_add_u32 s17, s17, s29
  s_add_u32 m0, s28, 8192
  s_nop 0
  buffer_load_dwordx4 v144, s[8:11], s17 offen lds
  s_add_u32 s17, s17, s29
  s_add_u32 m0, s28, 9216
  s_nop 0
  buffer_load_dwordx4 v144, s[8:11], s17 offen lds
  s_add_u32 s17, s17, s29
  s_add_u32 m0, s28, 10240
  s_nop 0
  buffer_load_dwordx4 v144, s[8:11], s17 offen lds
  s_add_u32 s17, s17, s29
  s_add_u32 m0, s28, 11264
  s_nop 0
  buffer_load_dwordx4 v144, s[8:11], s17 offen lds
  s_add_u32 s17, s17, s29
  s_add_u32 m0, s28, 12288
  s_nop 0
  buffer_load_dwordx4 v144, s[8:11], s17 offen lds
  s_add_u32 s17, s17, s29
  s_add_u32 m0, s28, 13312
  s_nop 0
  buffer_load_dwordx4 v144, s[8:11], s17 offen lds
  s_add_u32 s17, s17, s29
  s_add_u32 m0, s28, 14336
  s_nop 0
  buffer_load_dwordx4 v144, s[8:11], s17 offen lds
  s_add_u32 s17, s17, s29
  s_add_u32 m0, s28, 15360
  s_nop 0
  buffer_load_dwordx4 v144, s[8:11], s17 offen lds
  s_add_u32 s17, s17, s29
  s_add_u32 m0, s28, 16384
  s_nop 0
  buffer_load_dwordx4 v144, s[8:11], s17 offen lds
  s_add_u32 s17, s17, s29
  s_add_u32 m0, s28, 17408
  s_nop 0
  buffer_load_dwordx4 v144, s[8:11], s17 offen lds
  s_add_u32 s17, s17, s29
  s_add_u32 m0, s28, 18432
  s_nop 0
  buffer_load_dwordx4 v144, s[8:11], s17 offen lds
  s_add_u32 s17, s17, s29
  s_add_u32 m0, s28, 19456
  s_nop 0
  buffer_load_dwordx4 v144, s[8:11], s17 offen lds
  s_add_u32 s17, s17, s29
  s_add_u32 m0, s28, 20480
  s_nop 0
  buffer_load_dwordx4 v144, s[8:11], s17 offen lds
  s_add_u32 s17, s17, s29
  s_add_u32 m0, s28, 21504
  s_nop 0
  buffer_load_dwordx4 v144, s[8:11], s17 offen lds
  s_add_u32 s17, s17, s29
  s_add_u32 m0, s28, 22528
  s_nop 0
  buffer_load_dwordx4 v144, s[8:11], s17 offen lds
  s_add_u32 s17, s17, s29
  s_add_u32 m0, s28, 23552
  s_nop 0
  buffer_load_dwordx4 v144, s[8:11], s17 offen lds
  s_add_u32 s17, s17, s29
  s_add_u32 m0, s28, 24576
  s_nop 0
  buffer_load_dwordx4 v144, s[8:11], s17 offen lds
  s_add_u32 s17, s17, s29
  s_add_u32 m0, s28, 25600
  s_nop 0
  buffer_load_dwordx4 v144, s[8:11], s17 offen lds
  s_add_u32 s17, s17, s29
  s_add_u32 m0, s28, 26624
  s_nop 0
  buffer_load_dwordx4 v144, s[8:11], s17 offen lds
  s_add_u32 s17, s17, s29
  s_add_u32 m0, s28, 27648
  s_nop 0
  buffer_load_dwordx4 v144, s[8:11], s17 offen lds
  s_add_u32 s17, s17, s29
  s_add_u32 m0, s28, 28672
  s_nop 0
  buffer_load_dwordx4 v144, s[8:11], s17 offen lds
  s_add_u32 s17, s17, s29
  s_add_u32 m0, s28, 29696
  s_nop 0
  buffer_load_dwordx4 v144, s[8:11], s17 offen lds
  s_add_u32 s17, s17, s29
  s_add_u32 m0, s28, 30720
  s_nop 0
  buffer_load_dwordx4 v144, s[8:11], s17 offen lds
  s_add_u32 s17, s17, s29
  s_add_u32 m0, s28, 31744
  s_nop 0
  buffer_load_dwordx4 v144, s[8:11], s17 offen lds
  s_add_u32 s17, s17, s29
  v_bfe_u32 v148, v1, 2, 2
  v_lshrrev_b32 v149, 5, v1
  v_lshl_add_u32 v148, v149, 2, v148
  v_lshlrev_b32 v148, 7, v148
  v_bfe_u32 v149, v1, 4, 1
  v_lshl_add_u32 v148, v149, 5, v148
  v_and_b32 v149, 1, v1
  v_lshl_add_u32 v148, v149, 4, v148
  v_bfe_u32 v149, v1, 1, 1
  v_lshl_add_u32 v148, v149, 3, v148
  v_add_u32 v146, s28, v148
  v_add_u32 v147, 1024, v146
  s_waitcnt vmcnt(28)
  ds_read_b64_tr_b16 a[0:1], v146 offset:0
  ds_read_b64_tr_b16 a[2:3], v147 offset:0
  ds_read_b64_tr_b16 a[4:5], v146 offset:64
  ds_read_b64_tr_b16 a[6:7], v147 offset:64
  ds_read_b64_tr_b16 a[8:9], v146 offset:2048
  ds_read_b64_tr_b16 a[10:11], v147 offset:2048
  ds_read_b64_tr_b16 a[12:13], v146 offset:2112
  ds_read_b64_tr_b16 a[14:15], v147 offset:2112
  s_waitcnt lgkmcnt(0)
  s_add_u32 m0, s28, 0
  s_nop 0
  buffer_load_dwordx4 v144, s[8:11], s17 offen lds
  s_add_u32 s17, s17, s29
  s_add_u32 m0, s28, 1024
  s_nop 0
  buffer_load_dwordx4 v144, s[8:11], s17 offen lds
  s_add_u32 s17, s17, s29
  s_add_u32 m0, s28, 2048
  s_nop 0
  buffer_load_dwordx4 v144, s[8:11], s17 offen lds
  s_add_u32 s17, s17, s29
  s_add_u32 m0, s28, 3072
  s_nop 0
  buffer_load_dwordx4 v144, s[8:11], s17 offen lds
  s_add_u32 s17, s17, s29
  s_waitcnt vmcnt(28)
  ds_read_b64_tr_b16 a[16:17], v146 offset:4096
  ds_read_b64_tr_b16 a[18:19], v147 offset:4096
  ds_read_b64_tr_b16 a[20:21], v146 offset:4160
  ds_read_b64_tr_b16 a[22:23], v147 offset:4160
  ds_read_b64_tr_b16 a[24:25], v146 offset:6144
  ds_read_b64_tr_b16 a[26:27], v147 offset:6144
  ds_read_b64_tr_b16 a[28:29], v146 offset:6208
  ds_read_b64_tr_b16 a[30:31], v147 offset:6208
  s_waitcnt lgkmcnt(0)
  s_add_u32 m0, s28, 4096
  s_nop 0
  buffer_load_dwordx4 v144, s[8:11], s17 offen lds
  s_add_u32 s17, s17, s29
  s_add_u32 m0, s28, 5120
  s_nop 0
  buffer_load_dwordx4 v144, s[8:11], s17 offen lds
  s_add_u32 s17, s17, s29
  s_add_u32 m0, s28, 6144
  s_nop 0
  buffer_load_dwordx4 v144, s[8:11], s17 offen lds
  s_add_u32 s17, s17, s29
  s_add_u32 m0, s28, 7168
  s_nop 0
  buffer_load_dwordx4 v144, s[8:11], s17 offen lds
  s_add_u32 s17, s17, s29
  s_waitcnt vmcnt(28)
  ds_read_b64_tr_b16 a[32:33], v146 offset:8192
  ds_read_b64_tr_b16 a[34:35], v147 offset:8192
  ds_read_b64_tr_b16 a[36:37], v146 offset:8256
  ds_read_b64_tr_b16 a[38:39], v147 offset:8256
  ds_read_b64_tr_b16 a[40:41], v146 offset:10240
  ds_read_b64_tr_b16 a[42:43], v147 offset:10240
  ds_read_b64_tr_b16 a[44:45], v146 offset:10304
  ds_read_b64_tr_b16 a[46:47], v147 offset:10304
  s_waitcnt lgkmcnt(0)
  s_add_u32 m0, s28, 8192
  s_nop 0
  buffer_load_dwordx4 v144, s[8:11], s17 offen lds
  s_add_u32 s17, s17, s29
  s_add_u32 m0, s28, 9216
  s_nop 0
  buffer_load_dwordx4 v144, s[8:11], s17 offen lds
  s_add_u32 s17, s17, s29
  s_add_u32 m0, s28, 10240
  s_nop 0
  buffer_load_dwordx4 v144, s[8:11], s17 offen lds
  s_add_u32 s17, s17, s29
  s_add_u32 m0, s28, 11264
  s_nop 0
  buffer_load_dwordx4 v144, s[8:11], s17 offen lds
  s_add_u32 s17, s17, s29
  s_waitcnt vmcnt(28)
  ds_read_b64_tr_b16 a[48:49], v146 offset:12288
  ds_read_b64_tr_b16 a[50:51], v147 offset:12288
  ds_read_b64_tr_b16 a[52:53], v146 offset:12352
  ds_read_b64_tr_b16 a[54:55], v147 offset:12352
  ds_read_b64_tr_b16 a[56:57], v146 offset:14336
  ds_read_b64_tr_b16 a[58:59], v147 offset:14336
  ds_read_b64_tr_b16 a[60:61], v146 offset:14400
  ds_read_b64_tr_b16 a[62:63], v147 offset:14400
  s_waitcnt lgkmcnt(0)
  s_add_u32 m0, s28, 12288
  s_nop 0
  buffer_load_dwordx4 v144, s[8:11], s17 offen lds
  s_add_u32 s17, s17, s29
  s_add_u32 m0, s28, 13312
  s_nop 0
  buffer_load_dwordx4 v144, s[8:11], s17 offen lds
  s_add_u32 s17, s17, s29
  s_add_u32 m0, s28, 14336
  s_nop 0
  buffer_load_dwordx4 v144, s[8:11], s17 offen lds
  s_add_u32 s17, s17, s29
  s_add_u32 m0, s28, 15360
  s_nop 0
  buffer_load_dwordx4 v144, s[8:11], s17 offen lds
  s_add_u32 s17, s17, s29
  s_waitcnt vmcnt(28)
  ds_read_b64_tr_b16 a[64:65], v146 offset:16384
  ds_read_b64_tr_b16 a[66:67], v147 offset:16384
  ds_read_b64_tr_b16 a[68:69], v146 offset:16448
  ds_read_b64_tr_b16 a[70:71], v147 offset:16448
  ds_read_b64_tr_b16 a[72:73], v146 offset:18432
  ds_read_b64_tr_b16 a[74:75], v147 offset:18432
  ds_read_b64_tr_b16 a[76:77], v146 offset:18496
  ds_read_b64_tr_b16 a[78:79], v147 offset:18496
  s_waitcnt lgkmcnt(0)
  s_add_u32 m0, s28, 16384
  s_nop 0
  buffer_load_dwordx4 v144, s[8:11], s17 offen lds
  s_add_u32 s17, s17, s29
  s_add_u32 m0, s28, 17408
  s_nop 0
  buffer_load_dwordx4 v144, s[8:11], s17 offen lds
  s_add_u32 s17, s17, s29
  s_add_u32 m0, s28, 18432
  s_nop 0
  buffer_load_dwordx4 v144, s[8:11], s17 offen lds
  s_add_u32 s17, s17, s29
  s_add_u32 m0, s28, 19456
  s_nop 0
  buffer_load_dwordx4 v144, s[8:11], s17 offen lds
  s_add_u32 s17, s17, s29
  s_waitcnt vmcnt(28)
  ds_read_b64_tr_b16 a[80:81], v146 offset:20480
  ds_read_b64_tr_b16 a[82:83], v147 offset:20480
  ds_read_b64_tr_b16 a[84:85], v146 offset:20544
  ds_read_b64_tr_b16 a[86:87], v147 offset:20544
  ds_read_b64_tr_b16 a[88:89], v146 offset:22528
  ds_read_b64_tr_b16 a[90:91], v147 offset:22528
  ds_read_b64_tr_b16 a[92:93], v146 offset:22592
  ds_read_b64_tr_b16 a[94:95], v147 offset:22592
  s_waitcnt lgkmcnt(0)
  s_add_u32 m0, s28, 20480
  s_nop 0
  buffer_load_dwordx4 v144, s[8:11], s17 offen lds
  s_add_u32 s17, s17, s29
  s_add_u32 m0, s28, 21504
  s_nop 0
  buffer_load_dwordx4 v144, s[8:11], s17 offen lds
  s_add_u32 s17, s17, s29
  s_add_u32 m0, s28, 22528
  s_nop 0
  buffer_load_dwordx4 v144, s[8:11], s17 offen lds
  s_add_u32 s17, s17, s29
  s_add_u32 m0, s28, 23552
  s_nop 0
  buffer_load_dwordx4 v144, s[8:11], s17 offen lds
  s_add_u32 s17, s17, s29
  s_waitcnt vmcnt(28)
  ds_read_b64_tr_b16 a[96:97], v146 offset:24576
  ds_read_b64_tr_b16 a[98:99], v147 offset:24576
  ds_read_b64_tr_b16 a[100:101], v146 offset:24640
  ds_read_b64_tr_b16 a[102:103], v147 offset:24640
  ds_read_b64_tr_b16 a[104:105], v146 offset:26624
  ds_read_b64_tr_b16 a[106:107], v147 offset:26624
  ds_read_b64_tr_b16 a[108:109], v146 offset:26688
  ds_read_b64_tr_b16 a[110:111], v147 offset:26688
  s_waitcnt lgkmcnt(0)
  s_add_u32 m0, s28, 24576
  s_nop 0
  buffer_load_dwordx4 v144, s[8:11], s17 offen lds
  s_add_u32 s17, s17, s29
  s_add_u32 m0, s28, 25600
  s_nop 0
  buffer_load_dwordx4 v144, s[8:11], s17 offen lds
  s_add_u32 s17, s17, s29
  s_add_u32 m0, s28, 26624
  s_nop 0
  buffer_load_dwordx4 v144, s[8:11], s17 offen lds
  s_add_u32 s17, s17, s29
  s_add_u32 m0, s28, 27648
  s_nop 0
  buffer_load_dwordx4 v144, s[8:11], s17 offen lds
  s_add_u32 s17, s17, s29
  s_waitcnt vmcnt(28)
  ds_read_b64_tr_b16 a[112:113], v146 offset:28672
  ds_read_b64_tr_b16 a[114:115], v147 offset:28672
  ds_read_b64_tr_b16 a[116:117], v146 offset:28736
  ds_read_b64_tr_b16 a[118:119], v147 offset:28736
  ds_read_b64_tr_b16 a[120:121], v146 offset:30720
  ds_read_b64_tr_b16 a[122:123], v147 offset:30720
  ds_read_b64_tr_b16 a[124:125], v146 offset:30784
  ds_read_b64_tr_b16 a[126:127], v147 offset:30784
  s_waitcnt lgkmcnt(0)
  s_add_u32 m0, s28, 28672
  s_nop 0
  buffer_load_dwordx4 v144, s[8:11], s17 offen lds
  s_add_u32 s17, s17, s29
  s_add_u32 m0, s28, 29696
  s_nop 0
  buffer_load_dwordx4 v144, s[8:11], s17 offen lds
  s_add_u32 s17, s17, s29
  s_add_u32 m0, s28, 30720
  s_nop 0
  buffer_load_dwordx4 v144, s[8:11], s17 offen lds
  s_add_u32 s17, s17, s29
  s_add_u32 m0, s28, 31744
  s_nop 0
  buffer_load_dwordx4 v144, s[8:11], s17 offen lds
  s_add_u32 s17, s17, s29
  s_waitcnt vmcnt(28)
  ds_read_b64_tr_b16 a[128:129], v146 offset:0
  ds_read_b64_tr_b16 a[130:131], v147 offset:0
  ds_read_b64_tr_b16 a[132:133], v146 offset:64
  ds_read_b64_tr_b16 a[134:135], v147 offset:64
  ds_read_b64_tr_b16 a[136:137], v146 offset:2048
  ds_read_b64_tr_b16 a[138:139], v147 offset:2048
  ds_read_b64_tr_b16 a[140:141], v146 offset:2112
  ds_read_b64_tr_b16 a[142:143], v147 offset:2112
  s_waitcnt lgkmcnt(0)
  s_waitcnt vmcnt(24)
  ds_read_b64_tr_b16 a[144:145], v146 offset:4096
  ds_read_b64_tr_b16 a[146:147], v147 offset:4096
  ds_read_b64_tr_b16 a[148:149], v146 offset:4160
  ds_read_b64_tr_b16 a[150:151], v147 offset:4160
  ds_read_b64_tr_b16 a[152:153], v146 offset:6144
  ds_read_b64_tr_b16 a[154:155], v147 offset:6144
  ds_read_b64_tr_b16 a[156:157], v146 offset:6208
  ds_read_b64_tr_b16 a[158:159], v147 offset:6208
  s_waitcnt lgkmcnt(0)
  s_waitcnt vmcnt(20)
  ds_read_b64_tr_b16 a[160:161], v146 offset:8192
  ds_read_b64_tr_b16 a[162:163], v147 offset:8192
  ds_read_b64_tr_b16 a[164:165], v146 offset:8256
  ds_read_b64_tr_b16 a[166:167], v147 offset:8256
  ds_read_b64_tr_b16 a[168:169], v146 offset:10240
  ds_read_b64_tr_b16 a[170:171], v147 offset:10240
  ds_read_b64_tr_b16 a[172:173], v146 offset:10304
  ds_read_b64_tr_b16 a[174:175], v147 offset:10304
  s_waitcnt lgkmcnt(0)
  s_waitcnt vmcnt(16)
  ds_read_b64_tr_b16 a[176:177], v146 offset:12288
  ds_read_b64_tr_b16 a[178:179], v147 offset:12288
  ds_read_b64_tr_b16 a[180:181], v146 offset:12352
  ds_read_b64_tr_b16 a[182:183], v147 offset:12352
  ds_read_b64_tr_b16 a[184:185], v146 offset:14336
  ds_read_b64_tr_b16 a[186:187], v147 offset:14336
  ds_read_b64_tr_b16 a[188:189], v146 offset:14400
  ds_read_b64_tr_b16 a[190:191], v147 offset:14400
  s_waitcnt lgkmcnt(0)
  s_waitcnt vmcnt(12)
  ds_read_b64_tr_b16 a[192:193], v146 offset:16384
  ds_read_b64_tr_b16 a[194:195], v147 offset:16384
  ds_read_b64_tr_b16 a[196:197], v146 offset:16448
  ds_read_b64_tr_b16 a[198:199], v147 offset:16448
  ds_read_b64_tr_b16 a[200:201], v146 offset:18432
  ds_read_b64_tr_b16 a[202:203], v147 offset:18432
  ds_read_b64_tr_b16 a[204:205], v146 offset:18496
  ds_read_b64_tr_b16 a[206:207], v147 offset:18496
  s_waitcnt lgkmcnt(0)
  s_waitcnt vmcnt(8)
  ds_read_b64_tr_b16 a[208:209], v146 offset:20480
  ds_read_b64_tr_b16 a[210:211], v147 offset:20480
  ds_read_b64_tr_b16 a[212:213], v146 offset:20544
  ds_read_b64_tr_b16 a[214:215], v147 offset:20544
  ds_read_b64_tr_b16 a[216:217], v146 offset:22528
  ds_read_b64_tr_b16 a[218:219], v147 offset:22528
  ds_read_b64_tr_b16 a[220:221], v146 offset:22592
  ds_read_b64_tr_b16 a[222:223], v147 offset:22592
  s_waitcnt lgkmcnt(0)
  s_waitcnt vmcnt(4)
  ds_read_b64_tr_b16 a[224:225], v146 offset:24576
  ds_read_b64_tr_b16 a[226:227], v147 offset:24576
  ds_read_b64_tr_b16 a[228:229], v146 offset:24640
  ds_read_b64_tr_b16 a[230:231], v147 offset:24640
  ds_read_b64_tr_b16 a[232:233], v146 offset:26624
  ds_read_b64_tr_b16 a[234:235], v147 offset:26624
  ds_read_b64_tr_b16 a[236:237], v146 offset:26688
  ds_read_b64_tr_b16 a[238:239], v147 offset:26688
  s_waitcnt lgkmcnt(0)
  s_waitcnt vmcnt(0)
  ds_read_b64_tr_b16 a[240:241], v146 offset:28672
  ds_read_b64_tr_b16 a[242:243], v147 offset:28672
  ds_read_b64_tr_b16 a[244:245], v146 offset:28736
  ds_read_b64_tr_b16 a[246:247], v147 offset:28736
  ds_read_b64_tr_b16 a[248:249], v146 offset:30720
  ds_read_b64_tr_b16 a[250:251], v147 offset:30720
  ds_read_b64_tr_b16 a[252:253], v146 offset:30784
  ds_read_b64_tr_b16 a[254:255], v147 offset:30784
  s_waitcnt lgkmcnt(0)
  v_min_u32 v4, 27, v1
  v_mul_u32_u24 v5, 37, v4
  v_lshrrev_b32 v5, 8, v5
  v_mul_u32_u24 v5, 7, v5
  v_sub_u32 v5, v4, v5
  v_mov_b32 v6, 0x200
  v_cmp_ne_u32 vcc, 6, v5
  s_mul_i32 s76, s48, 3584
  s_add_u32 s76, s76, 148897792
  v_cndmask_b32 v5, 0, v6, vcc
  v_lshl_add_u32 v4, v4, 7, s76
  s_mov_b32 s71, 0
  s_branch M_vg_38
M_vw_37:
  s_sleep 2
  s_add_u32 s71, s71, 1
  s_cmp_gt_u32 s71, 262144
  s_cbranch_scc1 M_exit
M_vg_38:
  buffer_load_dword v6, v4, s[4:7], 0 offen sc1
  s_waitcnt vmcnt(0)
  v_cmp_lt_u32 vcc, v6, v5
  s_cbranch_vccnz M_vw_37
  s_barrier
  s_lshl_b32 s25, s16, 13
  s_add_u32 m0, s25, 0
  s_nop 0
  buffer_load_dwordx4 v16, s[12:15], s19 offen sc1 lds
  s_add_u32 m0, s25, 1024
  s_nop 0
  buffer_load_dwordx4 v17, s[12:15], s19 offen sc1 lds
  s_add_u32 m0, s25, 2048
  s_nop 0
  buffer_load_dwordx4 v18, s[12:15], s19 offen sc1 lds
  s_add_u32 m0, s25, 3072
  s_nop 0
  buffer_load_dwordx4 v19, s[12:15], s19 offen sc1 lds
  s_add_u32 m0, s25, 4096
  s_nop 0
  buffer_load_dwordx4 v20, s[12:15], s19 offen sc1 lds
  s_add_u32 m0, s25, 5120
  s_nop 0
  buffer_load_dwordx4 v21, s[12:15], s19 offen sc1 lds
  s_add_u32 m0, s25, 6144
  s_nop 0
  buffer_load_dwordx4 v22, s[12:15], s19 offen sc1 lds
  s_add_u32 m0, s25, 7168
  s_nop 0
  buffer_load_dwordx4 v23, s[12:15], s19 offen sc1 lds
  s_cmp_gt_u32 s23, 1
  s_cselect_b32 s26, s20, 0
  s_add_u32 s19, s19, s26
  s_add_u32 s25, s25, 32768
  s_and_b32 s25, s25, 0x1ffff
  s_add_u32 m0, s25, 0
  s_nop 0
  buffer_load_dwordx4 v16, s[12:15], s19 offen sc1 lds
  s_add_u32 m0, s25, 1024
  s_nop 0
  buffer_load_dwordx4 v17, s[12:15], s19 offen sc1 lds
  s_add_u32 m0, s25, 2048
  s_nop 0
  buffer_load_dwordx4 v18, s[12:15], s19 offen sc1 lds
  s_add_u32 m0, s25, 3072
  s_nop 0
  buffer_load_dwordx4 v19, s[12:15], s19 offen sc1 lds
  s_add_u32 m0, s25, 4096
  s_nop 0
  buffer_load_dwordx4 v20, s[12:15], s19 offen sc1 lds
  s_add_u32 m0, s25, 5120
  s_nop 0
  buffer_load_dwordx4 v21, s[12:15], s19 offen sc1 lds
  s_add_u32 m0, s25, 6144
  s_nop 0
  buffer_load_dwordx4 v22, s[12:15], s19 offen sc1 lds
  s_add_u32 m0, s25, 7168
  s_nop 0
  buffer_load_dwordx4 v23, s[12:15], s19 offen sc1 lds
  s_cmp_gt_u32 s23, 2
  s_cselect_b32 s26, s20, 0
  s_add_u32 s19, s19, s26
  s_add_u32 s25, s25, 32768
  s_and_b32 s25, s25, 0x1ffff
  s_waitcnt vmcnt(0)
  s_barrier
  s_mov_b32 s27, s21
  v_mov_b32 v7, 0x40000000
  ds_read_b128 v[24:27], v8 offset:0
  ds_read_b128 v[28:31], v9 offset:0
  ds_read_b128 v[32:35], v10 offset:0
  ds_read_b128 v[36:39], v11 offset:0
  ds_read_b128 v[40:43], v12 offset:0
  ds_read_b128 v[44:47], v13 offset:0
.p2align 6
G_top_39:
  s_waitcnt lgkmcnt(5)
  v_mfma_f32_32x32x16_bf16 v[64:79], a[0:3], v[24:27], 0
  s_add_u32 m0, s25, 0
  ds_read_b128 v[48:51], v14 offset:0
  v_mfma_f32_32x32x16_bf16 v[80:95], a[4:7], v[24:27], 0
  s_waitcnt lgkmcnt(5)
  buffer_load_dwordx4 v16, s[12:15], s19 offen sc1 lds
  v_mfma_f32_32x32x16_bf16 v[64:79], a[8:11], v[28:31], v[64:79]
  ds_read_b128 v[52:55], v15 offset:0
  v_mul_f32 v96, s24, v96
  v_mul_f32 v97, s24, v97
  v_mfma_f32_32x32x16_bf16 v[80:95], a[12:15], v[28:31], v[80:95]
  s_waitcnt lgkmcnt(5)
  v_cvt_pk_bf16_f32 v128, v96, v97
  v_mul_f32 v98, s24, v98
  v_mfma_f32_32x32x16_bf16 v[64:79], a[16:19], v[32:35], v[64:79]
  s_add_u32 m0, s25, 1024
  ds_read_b128 v[24:27], v8 offset:8192
  v_mul_f32 v99, s24, v99
  v_cvt_pk_bf16_f32 v129, v98, v99
  v_mfma_f32_32x32x16_bf16 v[80:95], a[20:23], v[32:35], v[80:95]
  s_waitcnt lgkmcnt(5)
  buffer_load_dwordx4 v17, s[12:15], s19 offen sc1 lds
  v_mul_f32 v100, s24, v100
  v_mul_f32 v101, s24, v101
  v_mfma_f32_32x32x16_bf16 v[64:79], a[24:27], v[36:39], v[64:79]
  ds_read_b128 v[28:31], v9 offset:8192
  v_cvt_pk_bf16_f32 v130, v100, v101
  v_mul_f32 v102, s24, v102
  v_mfma_f32_32x32x16_bf16 v[80:95], a[28:31], v[36:39], v[80:95]
  s_waitcnt lgkmcnt(5)
  v_mul_f32 v103, s24, v103
  v_cvt_pk_bf16_f32 v131, v102, v103
  v_mfma_f32_32x32x16_bf16 v[64:79], a[32:35], v[40:43], v[64:79]
  s_add_u32 m0, s25, 2048
  ds_read_b128 v[32:35], v10 offset:8192
  v_mul_f32 v104, s24, v104
  v_mul_f32 v105, s24, v105
  v_mfma_f32_32x32x16_bf16 v[80:95], a[36:39], v[40:43], v[80:95]
  s_waitcnt lgkmcnt(5)
  buffer_load_dwordx4 v18, s[12:15], s19 offen sc1 lds
  v_cvt_pk_bf16_f32 v132, v104, v105
  v_mul_f32 v106, s24, v106
  v_mfma_f32_32x32x16_bf16 v[64:79], a[40:43], v[44:47], v[64:79]
  ds_read_b128 v[36:39], v11 offset:8192
  v_mul_f32 v107, s24, v107
  v_cvt_pk_bf16_f32 v133, v106, v107
  v_mfma_f32_32x32x16_bf16 v[80:95], a[44:47], v[44:47], v[80:95]
  s_waitcnt lgkmcnt(5)
  v_mul_f32 v108, s24, v108
  v_mul_f32 v109, s24, v109
  v_mfma_f32_32x32x16_bf16 v[64:79], a[48:51], v[48:51], v[64:79]
  s_add_u32 m0, s25, 3072
  ds_read_b128 v[40:43], v12 offset:8192
  v_cvt_pk_bf16_f32 v134, v108, v109
  v_mul_f32 v110, s24, v110
  v_mfma_f32_32x32x16_bf16 v[80:95], a[52:55], v[48:51], v[80:95]
  s_waitcnt lgkmcnt(5)
  buffer_load_dwordx4 v19, s[12:15], s19 offen sc1 lds
  v_mul_f32 v111, s24, v111
  v_cvt_pk_bf16_f32 v135, v110, v111
  v_mfma_f32_32x32x16_bf16 v[64:79], a[56:59], v[52:55], v[64:79]
  ds_read_b128 v[44:47], v13 offset:8192
  v_mul_f32 v112, s24, v112
  v_mul_f32 v113, s24, v113
  v_mfma_f32_32x32x16_bf16 v[80:95], a[60:63], v[52:55], v[80:95]
  s_waitcnt lgkmcnt(5)
  v_cvt_pk_bf16_f32 v136, v112, v113
  v_mul_f32 v114, s24, v114
  v_mfma_f32_32x32x16_bf16 v[64:79], a[64:67], v[24:27], v[64:79]
  s_add_u32 m0, s25, 4096
  ds_read_b128 v[48:51], v14 offset:8192
  v_mul_f32 v115, s24, v115
  v_cvt_pk_bf16_f32 v137, v114, v115
  v_mfma_f32_32x32x16_bf16 v[80:95], a[68:71], v[24:27], v[80:95]
  s_waitcnt lgkmcnt(5)
  buffer_load_dwordx4 v20, s[12:15], s19 offen sc1 lds
  v_mul_f32 v116, s24, v116
  v_mul_f32 v117, s24, v117
  v_mfma_f32_32x32x16_bf16 v[64:79], a[72:75], v[28:31], v[64:79]
  ds_read_b128 v[52:55], v15 offset:8192
  v_cvt_pk_bf16_f32 v138, v116, v117
  v_mul_f32 v118, s24, v118
  v_mfma_f32_32x32x16_bf16 v[80:95], a[76:79], v[28:31], v[80:95]
  s_waitcnt lgkmcnt(5)
  v_mul_f32 v119, s24, v119
  v_cvt_pk_bf16_f32 v139, v118, v119
  v_mfma_f32_32x32x16_bf16 v[64:79], a[80:83], v[32:35], v[64:79]
  s_add_u32 m0, s25, 5120
  ds_read_b128 v[24:27], v8 offset:16384
  v_mul_f32 v120, s24, v120
  v_mul_f32 v121, s24, v121
  v_mfma_f32_32x32x16_bf16 v[80:95], a[84:87], v[32:35], v[80:95]
  s_waitcnt lgkmcnt(5)
  buffer_load_dwordx4 v21, s[12:15], s19 offen sc1 lds
  v_cvt_pk_bf16_f32 v140, v120, v121
  v_mul_f32 v122, s24, v122
  v_mfma_f32_32x32x16_bf16 v[64:79], a[88:91], v[36:39], v[64:79]
  ds_read_b128 v[28:31], v9 offset:16384
  v_mul_f32 v123, s24, v123
  v_cvt_pk_bf16_f32 v141, v122, v123
  v_mfma_f32_32x32x16_bf16 v[80:95], a[92:95], v[36:39], v[80:95]
  s_waitcnt lgkmcnt(5)
  v_mul_f32 v124, s24, v124
  v_mul_f32 v125, s24, v125
  v_mfma_f32_32x32x16_bf16 v[64:79], a[96:99], v[40:43], v[64:79]
  s_add_u32 m0, s25, 6144
  ds_read_b128 v[32:35], v10 offset:16384
  v_cvt_pk_bf16_f32 v142, v124, v125
  v_mul_f32 v126, s24, v126
  v_mfma_f32_32x32x16_bf16 v[80:95], a[100:103], v[40:43], v[80:95]
  s_waitcnt lgkmcnt(5)
  buffer_load_dwordx4 v22, s[12:15], s19 offen sc1 lds
  v_mul_f32 v127, s24, v127
  v_cvt_pk_bf16_f32 v143, v126, v127
  v_mfma_f32_32x32x16_bf16 v[64:79], a[104:107], v[44:47], v[64:79]
  ds_read_b128 v[36:39], v11 offset:16384
  v_mfma_f32_32x32x16_bf16 v[80:95], a[108:111], v[44:47], v[80:95]
  s_waitcnt lgkmcnt(5)
  v_mfma_f32_32x32x16_bf16 v[64:79], a[112:115], v[48:51], v[64:79]
  s_add_u32 m0, s25, 7168
  ds_read_b128 v[40:43], v12 offset:16384
  v_mfma_f32_32x32x16_bf16 v[80:95], a[116:119], v[48:51], v[80:95]
  s_waitcnt lgkmcnt(5)
  buffer_load_dwordx4 v23, s[12:15], s19 offen sc1 lds
  v_mfma_f32_32x32x16_bf16 v[64:79], a[120:123], v[52:55], v[64:79]
  s_cmp_gt_u32 s23, 3
  ds_read_b128 v[44:47], v13 offset:16384
  v_mfma_f32_32x32x16_bf16 v[80:95], a[124:127], v[52:55], v[80:95]
  s_waitcnt lgkmcnt(5)
  s_cselect_b32 s26, s20, 0
  v_mfma_f32_32x32x16_bf16 v[64:79], a[128:131], v[24:27], v[64:79]
  s_add_u32 s19, s19, s26
  ds_read_b128 v[48:51], v14 offset:16384
  v_mfma_f32_32x32x16_bf16 v[80:95], a[132:135], v[24:27], v[80:95]
  s_waitcnt lgkmcnt(5)
  s_add_u32 s25, s25, 32768
  v_mfma_f32_32x32x16_bf16 v[64:79], a[136:139], v[28:31], v[64:79]
  s_and_b32 s25, s25, 0x1ffff
  ds_read_b128 v[52:55], v15 offset:16384
  v_mfma_f32_32x32x16_bf16 v[80:95], a[140:143], v[28:31], v[80:95]
  s_waitcnt lgkmcnt(5)
  buffer_store_dwordx4 v[128:131], v7, s[4:7], s21 offen offset:0 sc1
  v_mfma_f32_32x32x16_bf16 v[64:79], a[144:147], v[32:35], v[64:79]
  ds_read_b128 v[24:27], v8 offset:24576
  v_mfma_f32_32x32x16_bf16 v[80:95], a[148:151], v[32:35], v[80:95]
  s_waitcnt lgkmcnt(5)
  v_mfma_f32_32x32x16_bf16 v[64:79], a[152:155], v[36:39], v[64:79]
  ds_read_b128 v[28:31], v9 offset:24576
  v_mfma_f32_32x32x16_bf16 v[80:95], a[156:159], v[36:39], v[80:95]
  s_waitcnt lgkmcnt(5)
  buffer_store_dwordx4 v[132:135], v7, s[4:7], s21 offen offset:1024 sc1
  v_mfma_f32_32x32x16_bf16 v[64:79], a[160:163], v[40:43], v[64:79]
  ds_read_b128 v[32:35], v10 offset:24576
  v_mfma_f32_32x32x16_bf16 v[80:95], a[164:167], v[40:43], v[80:95]
  s_waitcnt lgkmcnt(5)
  v_mfma_f32_32x32x16_bf16 v[64:79], a[168:171], v[44:47], v[64:79]
  ds_read_b128 v[36:39], v11 offset:24576
  v_mfma_f32_32x32x16_bf16 v[80:95], a[172:175], v[44:47], v[80:95]
  s_waitcnt lgkmcnt(5)
  buffer_store_dwordx4 v[136:139], v7, s[4:7], s21 offen offset:2048 sc1
  v_mfma_f32_32x32x16_bf16 v[64:79], a[176:179], v[48:51], v[64:79]
  ds_read_b128 v[40:43], v12 offset:24576
  v_mfma_f32_32x32x16_bf16 v[80:95], a[180:183], v[48:51], v[80:95]
  s_waitcnt lgkmcnt(5)
  v_mfma_f32_32x32x16_bf16 v[64:79], a[184:187], v[52:55], v[64:79]
  ds_read_b128 v[44:47], v13 offset:24576
  v_mfma_f32_32x32x16_bf16 v[80:95], a[188:191], v[52:55], v[80:95]
  s_waitcnt lgkmcnt(5)
  buffer_store_dwordx4 v[140:143], v7, s[4:7], s21 offen offset:3072 sc1
  v_mfma_f32_32x32x16_bf16 v[64:79], a[192:195], v[24:27], v[64:79]
  s_mov_b32 s21, s27
  ds_read_b128 v[48:51], v14 offset:24576
  v_mov_b32 v7, v2
  v_mfma_f32_32x32x16_bf16 v[80:95], a[196:199], v[24:27], v[80:95]
  s_waitcnt lgkmcnt(5)
  v_mfma_f32_32x32x16_bf16 v[64:79], a[200:203], v[28:31], v[64:79]
  s_add_u32 s27, s27, s22
  ds_read_b128 v[52:55], v15 offset:24576
  v_mfma_f32_32x32x16_bf16 v[80:95], a[204:207], v[28:31], v[80:95]
  s_waitcnt lgkmcnt(5)
  s_waitcnt vmcnt(16)
  s_barrier
  v_mfma_f32_32x32x16_bf16 v[64:79], a[208:211], v[32:35], v[64:79]
  ds_read_b128 v[24:27], v8 offset:32768
  v_mfma_f32_32x32x16_bf16 v[80:95], a[212:215], v[32:35], v[80:95]
  s_waitcnt lgkmcnt(5)
  v_mfma_f32_32x32x16_bf16 v[64:79], a[216:219], v[36:39], v[64:79]
  ds_read_b128 v[28:31], v9 offset:32768
  v_mfma_f32_32x32x16_bf16 v[80:95], a[220:223], v[36:39], v[80:95]
  s_waitcnt lgkmcnt(5)
  v_mfma_f32_32x32x16_bf16 v[64:79], a[224:227], v[40:43], v[64:79]
  ds_read_b128 v[32:35], v10 offset:32768
  v_mfma_f32_32x32x16_bf16 v[80:95], a[228:231], v[40:43], v[80:95]
  s_waitcnt lgkmcnt(5)
  v_mfma_f32_32x32x16_bf16 v[64:79], a[232:235], v[44:47], v[64:79]
  ds_read_b128 v[36:39], v11 offset:32768
  v_mfma_f32_32x32x16_bf16 v[80:95], a[236:239], v[44:47], v[80:95]
  s_waitcnt lgkmcnt(5)
  v_mfma_f32_32x32x16_bf16 v[64:79], a[240:243], v[48:51], v[64:79]
  s_sub_u32 s23, s23, 1
  ds_read_b128 v[40:43], v12 offset:32768
  v_mfma_f32_32x32x16_bf16 v[80:95], a[244:247], v[48:51], v[80:95]
  s_waitcnt lgkmcnt(5)
  v_mfma_f32_32x32x16_bf16 v[64:79], a[248:251], v[52:55], v[64:79]
  s_cmp_eq_u32 s23, 0
  ds_read_b128 v[44:47], v13 offset:32768
  v_mfma_f32_32x32x16_bf16 v[80:95], a[252:255], v[52:55], v[80:95]
  s_cbranch_scc1 G_done0_40
  s_waitcnt lgkmcnt(5)
  v_mfma_f32_32x32x16_bf16 v[96:111], a[0:3], v[24:27], 0
  s_add_u32 m0, s25, 0
  ds_read_b128 v[48:51], v14 offset:32768
  v_mfma_f32_32x32x16_bf16 v[112:127], a[4:7], v[24:27], 0
  s_waitcnt lgkmcnt(5)
  buffer_load_dwordx4 v16, s[12:15], s19 offen sc1 lds
  v_mfma_f32_32x32x16_bf16 v[96:111], a[8:11], v[28:31], v[96:111]
  ds_read_b128 v[52:55], v15 offset:32768
  v_mul_f32 v64, s24, v64
  v_mul_f32 v65, s24, v65
  v_mfma_f32_32x32x16_bf16 v[112:127], a[12:15], v[28:31], v[112:127]
  s_waitcnt lgkmcnt(5)
  v_cvt_pk_bf16_f32 v128, v64, v65
  v_mul_f32 v66, s24, v66
  v_mfma_f32_32x32x16_bf16 v[96:111], a[16:19], v[32:35], v[96:111]
  s_add_u32 m0, s25, 1024
  ds_read_b128 v[24:27], v8 offset:40960
  v_mul_f32 v67, s24, v67
  v_cvt_pk_bf16_f32 v129, v66, v67
  v_mfma_f32_32x32x16_bf16 v[112:127], a[20:23], v[32:35], v[112:127]
  s_waitcnt lgkmcnt(5)
  buffer_load_dwordx4 v17, s[12:15], s19 offen sc1 lds
  v_mul_f32 v68, s24, v68
  v_mul_f32 v69, s24, v69
  v_mfma_f32_32x32x16_bf16 v[96:111], a[24:27], v[36:39], v[96:111]
  ds_read_b128 v[28:31], v9 offset:40960
  v_cvt_pk_bf16_f32 v130, v68, v69
  v_mul_f32 v70, s24, v70
  v_mfma_f32_32x32x16_bf16 v[112:127], a[28:31], v[36:39], v[112:127]
  s_waitcnt lgkmcnt(5)
  v_mul_f32 v71, s24, v71
  v_cvt_pk_bf16_f32 v131, v70, v71
  v_mfma_f32_32x32x16_bf16 v[96:111], a[32:35], v[40:43], v[96:111]
  s_add_u32 m0, s25, 2048
  ds_read_b128 v[32:35], v10 offset:40960
  v_mul_f32 v72, s24, v72
  v_mul_f32 v73, s24, v73
  v_mfma_f32_32x32x16_bf16 v[112:127], a[36:39], v[40:43], v[112:127]
  s_waitcnt lgkmcnt(5)
  buffer_load_dwordx4 v18, s[12:15], s19 offen sc1 lds
  v_cvt_pk_bf16_f32 v132, v72, v73
  v_mul_f32 v74, s24, v74
  v_mfma_f32_32x32x16_bf16 v[96:111], a[40:43], v[44:47], v[96:111]
  ds_read_b128 v[36:39], v11 offset:40960
  v_mul_f32 v75, s24, v75
  v_cvt_pk_bf16_f32 v133, v74, v75
  v_mfma_f32_32x32x16_bf16 v[112:127], a[44:47], v[44:47], v[112:127]
  s_waitcnt lgkmcnt(5)
  v_mul_f32 v76, s24, v76
  v_mul_f32 v77, s24, v77
  v_mfma_f32_32x32x16_bf16 v[96:111], a[48:51], v[48:51], v[96:111]
  s_add_u32 m0, s25, 3072
  ds_read_b128 v[40:43], v12 offset:40960
  v_cvt_pk_bf16_f32 v134, v76, v77
  v_mul_f32 v78, s24, v78
  v_mfma_f32_32x32x16_bf16 v[112:127], a[52:55], v[48:51], v[112:127]
  s_waitcnt lgkmcnt(5)
  buffer_load_dwordx4 v19, s[12:15], s19 offen sc1 lds
  v_mul_f32 v79, s24, v79
  v_cvt_pk_bf16_f32 v135, v78, v79
  v_mfma_f32_32x32x16_bf16 v[96:111], a[56:59], v[52:55], v[96:111]
  ds_read_b128 v[44:47], v13 offset:40960
  v_mul_f32 v80, s24, v80
  v_mul_f32 v81, s24, v81
  v_mfma_f32_32x32x16_bf16 v[112:127], a[60:63], v[52:55], v[112:127]
  s_waitcnt lgkmcnt(5)
  v_cvt_pk_bf16_f32 v136, v80, v81
  v_mul_f32 v82, s24, v82
  v_mfma_f32_32x32x16_bf16 v[96:111], a[64:67], v[24:27], v[96:111]
  s_add_u32 m0, s25, 4096
  ds_read_b128 v[48:51], v14 offset:40960
  v_mul_f32 v83, s24, v83
  v_cvt_pk_bf16_f32 v137, v82, v83
  v_mfma_f32_32x32x16_bf16 v[112:127], a[68:71], v[24:27], v[112:127]
  s_waitcnt lgkmcnt(5)
  buffer_load_dwordx4 v20, s[12:15], s19 offen sc1 lds
  v_mul_f32 v84, s24, v84
  v_mul_f32 v85, s24, v85
  v_mfma_f32_32x32x16_bf16 v[96:111], a[72:75], v[28:31], v[96:111]
  ds_read_b128 v[52:55], v15 offset:40960
  v_cvt_pk_bf16_f32 v138, v84, v85
  v_mul_f32 v86, s24, v86
  v_mfma_f32_32x32x16_bf16 v[112:127], a[76:79], v[28:31], v[112:127]
  s_waitcnt lgkmcnt(5)
  v_mul_f32 v87, s24, v87
  v_cvt_pk_bf16_f32 v139, v86, v87
  v_mfma_f32_32x32x16_bf16 v[96:111], a[80:83], v[32:35], v[96:111]
  s_add_u32 m0, s25, 5120
  ds_read_b128 v[24:27], v8 offset:49152
  v_mul_f32 v88, s24, v88
  v_mul_f32 v89, s24, v89
  v_mfma_f32_32x32x16_bf16 v[112:127], a[84:87], v[32:35], v[112:127]
  s_waitcnt lgkmcnt(5)
  buffer_load_dwordx4 v21, s[12:15], s19 offen sc1 lds
  v_cvt_pk_bf16_f32 v140, v88, v89
  v_mul_f32 v90, s24, v90
  v_mfma_f32_32x32x16_bf16 v[96:111], a[88:91], v[36:39], v[96:111]
  ds_read_b128 v[28:31], v9 offset:49152
  v_mul_f32 v91, s24, v91
  v_cvt_pk_bf16_f32 v141, v90, v91
  v_mfma_f32_32x32x16_bf16 v[112:127], a[92:95], v[36:39], v[112:127]
  s_waitcnt lgkmcnt(5)
  v_mul_f32 v92, s24, v92
  v_mul_f32 v93, s24, v93
  v_mfma_f32_32x32x16_bf16 v[96:111], a[96:99], v[40:43], v[96:111]
  s_add_u32 m0, s25, 6144
  ds_read_b128 v[32:35], v10 offset:49152
  v_cvt_pk_bf16_f32 v142, v92, v93
  v_mul_f32 v94, s24, v94
  v_mfma_f32_32x32x16_bf16 v[112:127], a[100:103], v[40:43], v[112:127]
  s_waitcnt lgkmcnt(5)
  buffer_load_dwordx4 v22, s[12:15], s19 offen sc1 lds
  v_mul_f32 v95, s24, v95
  v_cvt_pk_bf16_f32 v143, v94, v95
  v_mfma_f32_32x32x16_bf16 v[96:111], a[104:107], v[44:47], v[96:111]
  ds_read_b128 v[36:39], v11 offset:49152
  v_mfma_f32_32x32x16_bf16 v[112:127], a[108:111], v[44:47], v[112:127]
  s_waitcnt lgkmcnt(5)
  v_mfma_f32_32x32x16_bf16 v[96:111], a[112:115], v[48:51], v[96:111]
  s_add_u32 m0, s25, 7168
  ds_read_b128 v[40:43], v12 offset:49152
  v_mfma_f32_32x32x16_bf16 v[112:127], a[116:119], v[48:51], v[112:127]
  s_waitcnt lgkmcnt(5)
  buffer_load_dwordx4 v23, s[12:15], s19 offen sc1 lds
  v_mfma_f32_32x32x16_bf16 v[96:111], a[120:123], v[52:55], v[96:111]
  s_cmp_gt_u32 s23, 3
  ds_read_b128 v[44:47], v13 offset:49152
  v_mfma_f32_32x32x16_bf16 v[112:127], a[124:127], v[52:55], v[112:127]
  s_waitcnt lgkmcnt(5)
  s_cselect_b32 s26, s20, 0
  v_mfma_f32_32x32x16_bf16 v[96:111], a[128:131], v[24:27], v[96:111]
  s_add_u32 s19, s19, s26
  ds_read_b128 v[48:51], v14 offset:49152
  v_mfma_f32_32x32x16_bf16 v[112:127], a[132:135], v[24:27], v[112:127]
  s_waitcnt lgkmcnt(5)
  s_add_u32 s25, s25, 32768
  v_mfma_f32_32x32x16_bf16 v[96:111], a[136:139], v[28:31], v[96:111]
  s_and_b32 s25, s25, 0x1ffff
  ds_read_b128 v[52:55], v15 offset:49152
  v_mfma_f32_32x32x16_bf16 v[112:127], a[140:143], v[28:31], v[112:127]
  s_waitcnt lgkmcnt(5)
  buffer_store_dwordx4 v[128:131], v7, s[4:7], s21 offen offset:0 sc1
  v_mfma_f32_32x32x16_bf16 v[96:111], a[144:147], v[32:35], v[96:111]
  ds_read_b128 v[24:27], v8 offset:57344
  v_mfma_f32_32x32x16_bf16 v[112:127], a[148:151], v[32:35], v[112:127]
  s_waitcnt lgkmcnt(5)
  v_xor_b32 v8, 0x10000, v8
  v_mfma_f32_32x32x16_bf16 v[96:111], a[152:155], v[36:39], v[96:111]
  ds_read_b128 v[28:31], v9 offset:57344
  v_mfma_f32_32x32x16_bf16 v[112:127], a[156:159], v[36:39], v[112:127]
  s_waitcnt lgkmcnt(5)
  buffer_store_dwordx4 v[132:135], v7, s[4:7], s21 offen offset:1024 sc1
  v_xor_b32 v9, 0x10000, v9
  v_mfma_f32_32x32x16_bf16 v[96:111], a[160:163], v[40:43], v[96:111]
  ds_read_b128 v[32:35], v10 offset:57344
  v_mfma_f32_32x32x16_bf16 v[112:127], a[164:167], v[40:43], v[112:127]
  s_waitcnt lgkmcnt(5)
  v_xor_b32 v10, 0x10000, v10
  v_mfma_f32_32x32x16_bf16 v[96:111], a[168:171], v[44:47], v[96:111]
  ds_read_b128 v[36:39], v11 offset:57344
  v_mfma_f32_32x32x16_bf16 v[112:127], a[172:175], v[44:47], v[112:127]
  s_waitcnt lgkmcnt(5)
  buffer_store_dwordx4 v[136:139], v7, s[4:7], s21 offen offset:2048 sc1
  v_xor_b32 v11, 0x10000, v11
  v_mfma_f32_32x32x16_bf16 v[96:111], a[176:179], v[48:51], v[96:111]
  ds_read_b128 v[40:43], v12 offset:57344
  v_mfma_f32_32x32x16_bf16 v[112:127], a[180:183], v[48:51], v[112:127]
  s_waitcnt lgkmcnt(5)
  v_xor_b32 v12, 0x10000, v12
  v_mfma_f32_32x32x16_bf16 v[96:111], a[184:187], v[52:55], v[96:111]
  ds_read_b128 v[44:47], v13 offset:57344
  v_mfma_f32_32x32x16_bf16 v[112:127], a[188:191], v[52:55], v[112:127]
  s_waitcnt lgkmcnt(5)
  buffer_store_dwordx4 v[140:143], v7, s[4:7], s21 offen offset:3072 sc1
  v_xor_b32 v13, 0x10000, v13
  v_mfma_f32_32x32x16_bf16 v[96:111], a[192:195], v[24:27], v[96:111]
  s_mov_b32 s21, s27
  ds_read_b128 v[48:51], v14 offset:57344
  v_mov_b32 v7, v2
  v_mfma_f32_32x32x16_bf16 v[112:127], a[196:199], v[24:27], v[112:127]
  s_waitcnt lgkmcnt(5)
  v_xor_b32 v14, 0x10000, v14
  v_mfma_f32_32x32x16_bf16 v[96:111], a[200:203], v[28:31], v[96:111]
  s_add_u32 s27, s27, s22
  ds_read_b128 v[52:55], v15 offset:57344
  v_mfma_f32_32x32x16_bf16 v[112:127], a[204:207], v[28:31], v[112:127]
  s_waitcnt lgkmcnt(5)
  s_waitcnt vmcnt(16)
  s_barrier
  v_xor_b32 v15, 0x10000, v15
  v_mfma_f32_32x32x16_bf16 v[96:111], a[208:211], v[32:35], v[96:111]
  ds_read_b128 v[24:27], v8 offset:0
  v_mfma_f32_32x32x16_bf16 v[112:127], a[212:215], v[32:35], v[112:127]
  s_waitcnt lgkmcnt(5)
  v_mfma_f32_32x32x16_bf16 v[96:111], a[216:219], v[36:39], v[96:111]
  ds_read_b128 v[28:31], v9 offset:0
  v_mfma_f32_32x32x16_bf16 v[112:127], a[220:223], v[36:39], v[112:127]
  s_waitcnt lgkmcnt(5)
  v_mfma_f32_32x32x16_bf16 v[96:111], a[224:227], v[40:43], v[96:111]
  ds_read_b128 v[32:35], v10 offset:0
  v_mfma_f32_32x32x16_bf16 v[112:127], a[228:231], v[40:43], v[112:127]
  s_waitcnt lgkmcnt(5)
  v_mfma_f32_32x32x16_bf16 v[96:111], a[232:235], v[44:47], v[96:111]
  ds_read_b128 v[36:39], v11 offset:0
  v_mfma_f32_32x32x16_bf16 v[112:127], a[236:239], v[44:47], v[112:127]
  s_waitcnt lgkmcnt(5)
  v_mfma_f32_32x32x16_bf16 v[96:111], a[240:243], v[48:51], v[96:111]
  s_sub_u32 s23, s23, 1
  ds_read_b128 v[40:43], v12 offset:0
  v_mfma_f32_32x32x16_bf16 v[112:127], a[244:247], v[48:51], v[112:127]
  s_waitcnt lgkmcnt(5)
  v_mfma_f32_32x32x16_bf16 v[96:111], a[248:251], v[52:55], v[96:111]
  s_cmp_eq_u32 s23, 0
  ds_read_b128 v[44:47], v13 offset:0
  v_mfma_f32_32x32x16_bf16 v[112:127], a[252:255], v[52:55], v[112:127]
  s_cbranch_scc1 G_done1_41
  s_branch G_top_39
G_done0_40:
  s_nop 7
  s_nop 3
  v_mul_f32 v64, s24, v64
  v_mul_f32 v65, s24, v65
  v_cvt_pk_bf16_f32 v128, v64, v65
  v_mul_f32 v66, s24, v66
  v_mul_f32 v67, s24, v67
  v_cvt_pk_bf16_f32 v129, v66, v67
  v_mul_f32 v68, s24, v68
  v_mul_f32 v69, s24, v69
  v_cvt_pk_bf16_f32 v130, v68, v69
  v_mul_f32 v70, s24, v70
  v_mul_f32 v71, s24, v71
  v_cvt_pk_bf16_f32 v131, v70, v71
  buffer_store_dwordx4 v[128:131], v7, s[4:7], s21 offen offset:0 sc1
  v_mul_f32 v72, s24, v72
  v_mul_f32 v73, s24, v73
  v_cvt_pk_bf16_f32 v132, v72, v73
  v_mul_f32 v74, s24, v74
  v_mul_f32 v75, s24, v75
  v_cvt_pk_bf16_f32 v133, v74, v75
  v_mul_f32 v76, s24, v76
  v_mul_f32 v77, s24, v77
  v_cvt_pk_bf16_f32 v134, v76, v77
  v_mul_f32 v78, s24, v78
  v_mul_f32 v79, s24, v79
  v_cvt_pk_bf16_f32 v135, v78, v79
  buffer_store_dwordx4 v[132:135], v7, s[4:7], s21 offen offset:1024 sc1
  v_mul_f32 v80, s24, v80
  v_mul_f32 v81, s24, v81
  v_cvt_pk_bf16_f32 v136, v80, v81
  v_mul_f32 v82, s24, v82
  v_mul_f32 v83, s24, v83
  v_cvt_pk_bf16_f32 v137, v82, v83
  v_mul_f32 v84, s24, v84
  v_mul_f32 v85, s24, v85
  v_cvt_pk_bf16_f32 v138, v84, v85
  v_mul_f32 v86, s24, v86
  v_mul_f32 v87, s24, v87
  v_cvt_pk_bf16_f32 v139, v86, v87
  buffer_store_dwordx4 v[136:139], v7, s[4:7], s21 offen offset:2048 sc1
  v_mul_f32 v88, s24, v88
  v_mul_f32 v89, s24, v89
  v_cvt_pk_bf16_f32 v140, v88, v89
  v_mul_f32 v90, s24, v90
  v_mul_f32 v91, s24, v91
  v_cvt_pk_bf16_f32 v141, v90, v91
  v_mul_f32 v92, s24, v92
  v_mul_f32 v93, s24, v93
  v_cvt_pk_bf16_f32 v142, v92, v93
  v_mul_f32 v94, s24, v94
  v_mul_f32 v95, s24, v95
  v_cvt_pk_bf16_f32 v143, v94, v95
  buffer_store_dwordx4 v[140:143], v7, s[4:7], s21 offen offset:3072 sc1
  s_branch G_fin_42
G_done1_41:
  s_nop 7
  s_nop 3
  v_mul_f32 v96, s24, v96
  v_mul_f32 v97, s24, v97
  v_cvt_pk_bf16_f32 v128, v96, v97
  v_mul_f32 v98, s24, v98
  v_mul_f32 v99, s24, v99
  v_cvt_pk_bf16_f32 v129, v98, v99
  v_mul_f32 v100, s24, v100
  v_mul_f32 v101, s24, v101
  v_cvt_pk_bf16_f32 v130, v100, v101
  v_mul_f32 v102, s24, v102
  v_mul_f32 v103, s24, v103
  v_cvt_pk_bf16_f32 v131, v102, v103
  buffer_store_dwordx4 v[128:131], v7, s[4:7], s21 offen offset:0 sc1
  v_mul_f32 v104, s24, v104
  v_mul_f32 v105, s24, v105
  v_cvt_pk_bf16_f32 v132, v104, v105
  v_mul_f32 v106, s24, v106
  v_mul_f32 v107, s24, v107
  v_cvt_pk_bf16_f32 v133, v106, v107
  v_mul_f32 v108, s24, v108
  v_mul_f32 v109, s24, v109
  v_cvt_pk_bf16_f32 v134, v108, v109
  v_mul_f32 v110, s24, v110
  v_mul_f32 v111, s24, v111
  v_cvt_pk_bf16_f32 v135, v110, v111
  buffer_store_dwordx4 v[132:135], v7, s[4:7], s21 offen offset:1024 sc1
  v_mul_f32 v112, s24, v112
  v_mul_f32 v113, s24, v113
  v_cvt_pk_bf16_f32 v136, v112, v113
  v_mul_f32 v114, s24, v114
  v_mul_f32 v115, s24, v115
  v_cvt_pk_bf16_f32 v137, v114, v115
  v_mul_f32 v116, s24, v116
  v_mul_f32 v117, s24, v117
  v_cvt_pk_bf16_f32 v138, v116, v117
  v_mul_f32 v118, s24, v118
  v_mul_f32 v119, s24, v119
  v_cvt_pk_bf16_f32 v139, v118, v119
  buffer_store_dwordx4 v[136:139], v7, s[4:7], s21 offen offset:2048 sc1
  v_mul_f32 v120, s24, v120
  v_mul_f32 v121, s24, v121
  v_cvt_pk_bf16_f32 v140, v120, v121
  v_mul_f32 v122, s24, v122
  v_mul_f32 v123, s24, v123
  v_cvt_pk_bf16_f32 v141, v122, v123
  v_mul_f32 v124, s24, v124
  v_mul_f32 v125, s24, v125
  v_cvt_pk_bf16_f32 v142, v124, v125
  v_mul_f32 v126, s24, v126
  v_mul_f32 v127, s24, v127
  v_cvt_pk_bf16_f32 v143, v126, v127
  buffer_store_dwordx4 v[140:143], v7, s[4:7], s21 offen offset:3072 sc1
G_fin_42:
  s_waitcnt vmcnt(0) lgkmcnt(0)
  s_barrier
  s_waitcnt vmcnt(0)
  s_barrier
  s_mov_b32 s30, 768
  v_mov_b32 v144, s30
  v_min_u32 v145, 1, v0
  v_lshlrev_b32 v145, 30, v145
  buffer_store_dword v144, v145, s[4:7], s31 offen sc1
  s_mul_i32 s50, s64, 6
  s_add_u32 s50, s50, s65
  s_mul_i32 s76, s50, 21846
  s_lshr_b32 s76, s76, 16
  s_mul_i32 s77, s76, 3
  s_add_u32 s51, s50, 64
  s_cmp_eq_u32 s77, s50
  s_cselect_b32 s50, s76, s51
M_fin:
  s_lshr_b32 s48, s50, 2
  s_and_b32 s49, s50, 3
  s_load_dwordx2 s[8:9], s[0:1], 0
  s_load_dwordx2 s[12:13], s[0:1], 104
  s_load_dwordx2 s[32:33], s[0:1], 112
  v_and_b32 v4, 31, v1
  v_lshrrev_b32 v5, 5, v1
  v_lshlrev_b32 v5, 4, v5
  v_lshl_add_u32 v6, v4, 10, v5
  s_lshl_b32 s26, s16, 8
  s_lshl_b32 s27, s48, 15
  s_add_u32 s27, s27, s26
  s_waitcnt lgkmcnt(0)
  s_and_b32 s9, s9, 0xffff
  s_mov_b32 s10, 2097152
  s_mov_b32 s11, 0x20000
  s_and_b32 s13, s13, 0xffff
  s_mov_b32 s14, 1024
  s_mov_b32 s15, 0x20000
  s_and_b32 s33, s33, 0xffff
  s_mov_b32 s34, 2097152
  s_mov_b32 s35, 0x20000
  buffer_load_dwordx4 v[16:19], v6, s[8:11], s27 offen offset:0
  buffer_load_dwordx4 v[48:51], v5, s[12:15], s26 offen offset:0
  buffer_load_dwordx4 v[20:23], v6, s[8:11], s27 offen offset:32
  buffer_load_dwordx4 v[52:55], v5, s[12:15], s26 offen offset:32
  buffer_load_dwordx4 v[24:27], v6, s[8:11], s27 offen offset:64
  buffer_load_dwordx4 v[56:59], v5, s[12:15], s26 offen offset:64
  buffer_load_dwordx4 v[28:31], v6, s[8:11], s27 offen offset:96
  buffer_load_dwordx4 v[60:63], v5, s[12:15], s26 offen offset:96
  buffer_load_dwordx4 v[32:35], v6, s[8:11], s27 offen offset:128
  buffer_load_dwordx4 v[64:67], v5, s[12:15], s26 offen offset:128
  buffer_load_dwordx4 v[36:39], v6, s[8:11], s27 offen offset:160
  buffer_load_dwordx4 v[68:71], v5, s[12:15], s26 offen offset:160
  buffer_load_dwordx4 v[40:43], v6, s[8:11], s27 offen offset:192
  buffer_load_dwordx4 v[72:75], v5, s[12:15], s26 offen offset:192
  buffer_load_dwordx4 v[44:47], v6, s[8:11], s27 offen offset:224
  buffer_load_dwordx4 v[76:79], v5, s[12:15], s26 offen offset:224
  s_lshl_b32 s28, s48, 2
  s_add_u32 s28, s28, s49
  s_lshl_b32 s28, s28, 2
  s_add_u32 s28, s28, s16
  s_lshl_b32 s28, s28, 11
  s_waitcnt vmcnt(14)
  v_mfma_f32_32x32x16_bf16 v[80:95], v[48:51], v[16:19], 0
  s_waitcnt vmcnt(12)
  v_mfma_f32_32x32x16_bf16 v[80:95], v[52:55], v[20:23], v[80:95]
  s_waitcnt vmcnt(10)
  v_mfma_f32_32x32x16_bf16 v[80:95], v[56:59], v[24:27], v[80:95]
  s_waitcnt vmcnt(8)
  v_mfma_f32_32x32x16_bf16 v[80:95], v[60:63], v[28:31], v[80:95]
  s_waitcnt vmcnt(6)
  v_mfma_f32_32x32x16_bf16 v[80:95], v[64:67], v[32:35], v[80:95]
  s_waitcnt vmcnt(4)
  v_mfma_f32_32x32x16_bf16 v[80:95], v[68:71], v[36:39], v[80:95]
  s_waitcnt vmcnt(2)
  v_mfma_f32_32x32x16_bf16 v[80:95], v[72:75], v[40:43], v[80:95]
  s_waitcnt vmcnt(0)
  v_mfma_f32_32x32x16_bf16 v[80:95], v[76:79], v[44:47], v[80:95]
  s_mul_i32 s76, s48, 43
  s_lshr_b32 s76, s76, 9
  s_mul_i32 s76, s76, 12
  s_sub_u32 s76, s48, s76
  s_cmp_ge_u32 s76, 6
  s_addc_u32 s76, s76, 0
  s_and_b32 s77, s49, 2
  s_mul_i32 s77, s77, 7
  s_add_u32 s76, s76, s77
  v_mov_b32 v193, 0x300
  s_lshl_b32 s76, s76, 7
  s_add_u32 s76, s76, 148897792
  v_and_b32 v192, 7, v1
  v_mul_u32_u24 v192, 3584, v192
  v_add_u32 v192, s76, v192
  s_mov_b32 s71, 0
  s_branch M_vg_44
M_vw_43:
  s_sleep 2
  s_add_u32 s71, s71, 1
  s_cmp_gt_u32 s71, 262144
  s_cbranch_scc1 M_exit
M_vg_44:
  buffer_load_dword v194, v192, s[4:7], 0 offen sc1
  s_waitcnt vmcnt(0)
  v_cmp_lt_u32 vcc, v194, v193
  s_cbranch_vccnz M_vw_43
  s_add_u32 s29, s28, 150994944
  buffer_load_dwordx4 v[96:99], v2, s[4:7], s29 offen offset:0 sc1
  buffer_load_dwordx4 v[100:103], v2, s[4:7], s29 offen offset:1024 sc1
  s_add_u32 s29, s28, 153092096
  buffer_load_dwordx4 v[104:107], v2, s[4:7], s29 offen offset:0 sc1
  buffer_load_dwordx4 v[108:111], v2, s[4:7], s29 offen offset:1024 sc1
  s_add_u32 s29, s28, 155189248
  buffer_load_dwordx4 v[112:115], v2, s[4:7], s29 offen offset:0 sc1
  buffer_load_dwordx4 v[116:119], v2, s[4:7], s29 offen offset:1024 sc1
  s_add_u32 s29, s28, 157286400
  buffer_load_dwordx4 v[120:123], v2, s[4:7], s29 offen offset:0 sc1
  buffer_load_dwordx4 v[124:127], v2, s[4:7], s29 offen offset:1024 sc1
  s_add_u32 s29, s28, 159383552
  buffer_load_dwordx4 v[128:131], v2, s[4:7], s29 offen offset:0 sc1
  buffer_load_dwordx4 v[132:135], v2, s[4:7], s29 offen offset:1024 sc1
  s_add_u32 s29, s28, 161480704
  buffer_load_dwordx4 v[136:139], v2, s[4:7], s29 offen offset:0 sc1
  buffer_load_dwordx4 v[140:143], v2, s[4:7], s29 offen offset:1024 sc1
  s_add_u32 s29, s28, 163577856
  buffer_load_dwordx4 v[144:147], v2, s[4:7], s29 offen offset:0 sc1
  buffer_load_dwordx4 v[148:151], v2, s[4:7], s29 offen offset:1024 sc1
  s_add_u32 s29, s28, 165675008
  buffer_load_dwordx4 v[152:155], v2, s[4:7], s29 offen offset:0 sc1
  buffer_load_dwordx4 v[156:159], v2, s[4:7], s29 offen offset:1024 sc1
  v_lshlrev_b32 v7, 4, v4
  s_lshl_b32 s26, s16, 2
  v_add_u32 v4, s26, v7
  s_barrier
  ds_write_b32 v4, v80
  s_waitcnt lgkmcnt(0)
  s_barrier
  ds_read_b128 v[84:87], v7
  s_waitcnt lgkmcnt(0)
  v_add_f32 v80, v84, v85
  v_add_f32 v81, v86, v87
  v_add_f32 v80, v80, v81
  v_mul_f32 v80, 0xbfb8aa3b, v80
  v_exp_f32 v80, v80
  s_nop 0
  v_add_f32 v80, 1.0, v80
  v_rcp_f32 v80, v80
  s_nop 0
  v_sub_f32 v82, 1.0, v80
  s_waitcnt vmcnt(14)
  v_lshlrev_b32 v160, 16, v96
  v_and_b32 v161, 0xffff0000, v96
  v_lshlrev_b32 v162, 16, v97
  v_and_b32 v163, 0xffff0000, v97
  v_lshlrev_b32 v164, 16, v98
  v_and_b32 v165, 0xffff0000, v98
  v_lshlrev_b32 v166, 16, v99
  v_and_b32 v167, 0xffff0000, v99
  v_lshlrev_b32 v168, 16, v100
  v_and_b32 v169, 0xffff0000, v100
  v_lshlrev_b32 v170, 16, v101
  v_and_b32 v171, 0xffff0000, v101
  v_lshlrev_b32 v172, 16, v102
  v_and_b32 v173, 0xffff0000, v102
  v_lshlrev_b32 v174, 16, v103
  v_and_b32 v175, 0xffff0000, v103
  s_waitcnt vmcnt(12)
  v_lshlrev_b32 v8, 16, v104
  v_and_b32 v9, 0xffff0000, v104
  v_pk_add_f32 v[160:161], v[160:161], v[8:9]
  v_lshlrev_b32 v10, 16, v105
  v_and_b32 v11, 0xffff0000, v105
  v_pk_add_f32 v[162:163], v[162:163], v[10:11]
  v_lshlrev_b32 v12, 16, v106
  v_and_b32 v13, 0xffff0000, v106
  v_pk_add_f32 v[164:165], v[164:165], v[12:13]
  v_lshlrev_b32 v14, 16, v107
  v_and_b32 v15, 0xffff0000, v107
  v_pk_add_f32 v[166:167], v[166:167], v[14:15]
  v_lshlrev_b32 v8, 16, v108
  v_and_b32 v9, 0xffff0000, v108
  v_pk_add_f32 v[168:169], v[168:169], v[8:9]
  v_lshlrev_b32 v10, 16, v109
  v_and_b32 v11, 0xffff0000, v109
  v_pk_add_f32 v[170:171], v[170:171], v[10:11]
  v_lshlrev_b32 v12, 16, v110
  v_and_b32 v13, 0xffff0000, v110
  v_pk_add_f32 v[172:173], v[172:173], v[12:13]
  v_lshlrev_b32 v14, 16, v111
  v_and_b32 v15, 0xffff0000, v111
  v_pk_add_f32 v[174:175], v[174:175], v[14:15]
  s_waitcnt vmcnt(10)
  v_lshlrev_b32 v8, 16, v112
  v_and_b32 v9, 0xffff0000, v112
  v_pk_add_f32 v[160:161], v[160:161], v[8:9]
  v_lshlrev_b32 v10, 16, v113
  v_and_b32 v11, 0xffff0000, v113
  v_pk_add_f32 v[162:163], v[162:163], v[10:11]
  v_lshlrev_b32 v12, 16, v114
  v_and_b32 v13, 0xffff0000, v114
  v_pk_add_f32 v[164:165], v[164:165], v[12:13]
  v_lshlrev_b32 v14, 16, v115
  v_and_b32 v15, 0xffff0000, v115
  v_pk_add_f32 v[166:167], v[166:167], v[14:15]
  v_lshlrev_b32 v8, 16, v116
  v_and_b32 v9, 0xffff0000, v116
  v_pk_add_f32 v[168:169], v[168:169], v[8:9]
  v_lshlrev_b32 v10, 16, v117
  v_and_b32 v11, 0xffff0000, v117
  v_pk_add_f32 v[170:171], v[170:171], v[10:11]
  v_lshlrev_b32 v12, 16, v118
  v_and_b32 v13, 0xffff0000, v118
  v_pk_add_f32 v[172:173], v[172:173], v[12:13]
  v_lshlrev_b32 v14, 16, v119
  v_and_b32 v15, 0xffff0000, v119
  v_pk_add_f32 v[174:175], v[174:175], v[14:15]
  s_waitcnt vmcnt(8)
  v_lshlrev_b32 v8, 16, v120
  v_and_b32 v9, 0xffff0000, v120
  v_pk_add_f32 v[160:161], v[160:161], v[8:9]
  v_lshlrev_b32 v10, 16, v121
  v_and_b32 v11, 0xffff0000, v121
  v_pk_add_f32 v[162:163], v[162:163], v[10:11]
  v_lshlrev_b32 v12, 16, v122
  v_and_b32 v13, 0xffff0000, v122
  v_pk_add_f32 v[164:165], v[164:165], v[12:13]
  v_lshlrev_b32 v14, 16, v123
  v_and_b32 v15, 0xffff0000, v123
  v_pk_add_f32 v[166:167], v[166:167], v[14:15]
  v_lshlrev_b32 v8, 16, v124
  v_and_b32 v9, 0xffff0000, v124
  v_pk_add_f32 v[168:169], v[168:169], v[8:9]
  v_lshlrev_b32 v10, 16, v125
  v_and_b32 v11, 0xffff0000, v125
  v_pk_add_f32 v[170:171], v[170:171], v[10:11]
  v_lshlrev_b32 v12, 16, v126
  v_and_b32 v13, 0xffff0000, v126
  v_pk_add_f32 v[172:173], v[172:173], v[12:13]
  v_lshlrev_b32 v14, 16, v127
  v_and_b32 v15, 0xffff0000, v127
  v_pk_add_f32 v[174:175], v[174:175], v[14:15]
  s_waitcnt vmcnt(6)
  v_lshlrev_b32 v8, 16, v128
  v_and_b32 v9, 0xffff0000, v128
  v_pk_add_f32 v[160:161], v[160:161], v[8:9]
  v_lshlrev_b32 v10, 16, v129
  v_and_b32 v11, 0xffff0000, v129
  v_pk_add_f32 v[162:163], v[162:163], v[10:11]
  v_lshlrev_b32 v12, 16, v130
  v_and_b32 v13, 0xffff0000, v130
  v_pk_add_f32 v[164:165], v[164:165], v[12:13]
  v_lshlrev_b32 v14, 16, v131
  v_and_b32 v15, 0xffff0000, v131
  v_pk_add_f32 v[166:167], v[166:167], v[14:15]
  v_lshlrev_b32 v8, 16, v132
  v_and_b32 v9, 0xffff0000, v132
  v_pk_add_f32 v[168:169], v[168:169], v[8:9]
  v_lshlrev_b32 v10, 16, v133
  v_and_b32 v11, 0xffff0000, v133
  v_pk_add_f32 v[170:171], v[170:171], v[10:11]
  v_lshlrev_b32 v12, 16, v134
  v_and_b32 v13, 0xffff0000, v134
  v_pk_add_f32 v[172:173], v[172:173], v[12:13]
  v_lshlrev_b32 v14, 16, v135
  v_and_b32 v15, 0xffff0000, v135
  v_pk_add_f32 v[174:175], v[174:175], v[14:15]
  s_waitcnt vmcnt(4)
  v_lshlrev_b32 v8, 16, v136
  v_and_b32 v9, 0xffff0000, v136
  v_pk_add_f32 v[160:161], v[160:161], v[8:9]
  v_lshlrev_b32 v10, 16, v137
  v_and_b32 v11, 0xffff0000, v137
  v_pk_add_f32 v[162:163], v[162:163], v[10:11]
  v_lshlrev_b32 v12, 16, v138
  v_and_b32 v13, 0xffff0000, v138
  v_pk_add_f32 v[164:165], v[164:165], v[12:13]
  v_lshlrev_b32 v14, 16, v139
  v_and_b32 v15, 0xffff0000, v139
  v_pk_add_f32 v[166:167], v[166:167], v[14:15]
  v_lshlrev_b32 v8, 16, v140
  v_and_b32 v9, 0xffff0000, v140
  v_pk_add_f32 v[168:169], v[168:169], v[8:9]
  v_lshlrev_b32 v10, 16, v141
  v_and_b32 v11, 0xffff0000, v141
  v_pk_add_f32 v[170:171], v[170:171], v[10:11]
  v_lshlrev_b32 v12, 16, v142
  v_and_b32 v13, 0xffff0000, v142
  v_pk_add_f32 v[172:173], v[172:173], v[12:13]
  v_lshlrev_b32 v14, 16, v143
  v_and_b32 v15, 0xffff0000, v143
  v_pk_add_f32 v[174:175], v[174:175], v[14:15]
  s_waitcnt vmcnt(2)
  v_lshlrev_b32 v8, 16, v144
  v_and_b32 v9, 0xffff0000, v144
  v_pk_add_f32 v[160:161], v[160:161], v[8:9]
  v_lshlrev_b32 v10, 16, v145
  v_and_b32 v11, 0xffff0000, v145
  v_pk_add_f32 v[162:163], v[162:163], v[10:11]
  v_lshlrev_b32 v12, 16, v146
  v_and_b32 v13, 0xffff0000, v146
  v_pk_add_f32 v[164:165], v[164:165], v[12:13]
  v_lshlrev_b32 v14, 16, v147
  v_and_b32 v15, 0xffff0000, v147
  v_pk_add_f32 v[166:167], v[166:167], v[14:15]
  v_lshlrev_b32 v8, 16, v148
  v_and_b32 v9, 0xffff0000, v148
  v_pk_add_f32 v[168:169], v[168:169], v[8:9]
  v_lshlrev_b32 v10, 16, v149
  v_and_b32 v11, 0xffff0000, v149
  v_pk_add_f32 v[170:171], v[170:171], v[10:11]
  v_lshlrev_b32 v12, 16, v150
  v_and_b32 v13, 0xffff0000, v150
  v_pk_add_f32 v[172:173], v[172:173], v[12:13]
  v_lshlrev_b32 v14, 16, v151
  v_and_b32 v15, 0xffff0000, v151
  v_pk_add_f32 v[174:175], v[174:175], v[14:15]
  s_waitcnt vmcnt(0)
  v_lshlrev_b32 v8, 16, v152
  v_and_b32 v9, 0xffff0000, v152
  v_pk_add_f32 v[160:161], v[160:161], v[8:9]
  v_lshlrev_b32 v10, 16, v153
  v_and_b32 v11, 0xffff0000, v153
  v_pk_add_f32 v[162:163], v[162:163], v[10:11]
  v_lshlrev_b32 v12, 16, v154
  v_and_b32 v13, 0xffff0000, v154
  v_pk_add_f32 v[164:165], v[164:165], v[12:13]
  v_lshlrev_b32 v14, 16, v155
  v_and_b32 v15, 0xffff0000, v155
  v_pk_add_f32 v[166:167], v[166:167], v[14:15]
  v_lshlrev_b32 v8, 16, v156
  v_and_b32 v9, 0xffff0000, v156
  v_pk_add_f32 v[168:169], v[168:169], v[8:9]
  v_lshlrev_b32 v10, 16, v157
  v_and_b32 v11, 0xffff0000, v157
  v_pk_add_f32 v[170:171], v[170:171], v[10:11]
  v_lshlrev_b32 v12, 16, v158
  v_and_b32 v13, 0xffff0000, v158
  v_pk_add_f32 v[172:173], v[172:173], v[12:13]
  v_lshlrev_b32 v14, 16, v159
  v_and_b32 v15, 0xffff0000, v159
  v_pk_add_f32 v[174:175], v[174:175], v[14:15]
  s_and_b32 s76, s48, 1
  s_lshl_b32 s76, s76, 1
  s_lshr_b32 s77, s49, 1
  s_add_u32 s76, s76, s77
  s_mul_i32 s76, s76, 7
  s_add_u32 s76, s76, 6
  s_lshr_b32 s77, s48, 1
  s_add_u32 s77, s77, 0x201
  v_mov_b32 v193, s77
  s_lshl_b32 s76, s76, 7
  s_add_u32 s76, s76, 148897792
  v_and_b32 v192, 7, v1
  v_mul_u32_u24 v192, 3584, v192
  v_add_u32 v192, s76, v192
  s_mov_b32 s71, 0
  s_branch M_vg_46
M_vw_45:
  s_sleep 2
  s_add_u32 s71, s71, 1
  s_cmp_gt_u32 s71, 262144
  s_cbranch_scc1 M_exit
M_vg_46:
  buffer_load_dword v194, v192, s[4:7], 0 offen sc1
  s_waitcnt vmcnt(0)
  v_cmp_lt_u32 vcc, v194, v193
  s_cbranch_vccnz M_vw_45
  s_add_u32 s29, s28, 167772160
  buffer_load_dwordx4 v[96:99], v2, s[4:7], s29 offen offset:0 sc1
  buffer_load_dwordx4 v[100:103], v2, s[4:7], s29 offen offset:1024 sc1
  s_add_u32 s29, s28, 169869312
  buffer_load_dwordx4 v[104:107], v2, s[4:7], s29 offen offset:0 sc1
  buffer_load_dwordx4 v[108:111], v2, s[4:7], s29 offen offset:1024 sc1
  s_add_u32 s29, s28, 171966464
  buffer_load_dwordx4 v[112:115], v2, s[4:7], s29 offen offset:0 sc1
  buffer_load_dwordx4 v[116:119], v2, s[4:7], s29 offen offset:1024 sc1
  s_add_u32 s29, s28, 174063616
  buffer_load_dwordx4 v[120:123], v2, s[4:7], s29 offen offset:0 sc1
  buffer_load_dwordx4 v[124:127], v2, s[4:7], s29 offen offset:1024 sc1
  s_add_u32 s29, s28, 176160768
  buffer_load_dwordx4 v[128:131], v2, s[4:7], s29 offen offset:0 sc1
  buffer_load_dwordx4 v[132:135], v2, s[4:7], s29 offen offset:1024 sc1
  s_add_u32 s29, s28, 178257920
  buffer_load_dwordx4 v[136:139], v2, s[4:7], s29 offen offset:0 sc1
  buffer_load_dwordx4 v[140:143], v2, s[4:7], s29 offen offset:1024 sc1
  s_add_u32 s29, s28, 180355072
  buffer_load_dwordx4 v[144:147], v2, s[4:7], s29 offen offset:0 sc1
  buffer_load_dwordx4 v[148:151], v2, s[4:7], s29 offen offset:1024 sc1
  s_add_u32 s29, s28, 182452224
  buffer_load_dwordx4 v[152:155], v2, s[4:7], s29 offen offset:0 sc1
  buffer_load_dwordx4 v[156:159], v2, s[4:7], s29 offen offset:1024 sc1
  v_pk_mul_f32 v[160:161], v[160:161], v[80:81] op_sel_hi:[1,0]
  v_pk_mul_f32 v[162:163], v[162:163], v[80:81] op_sel_hi:[1,0]
  v_pk_mul_f32 v[164:165], v[164:165], v[80:81] op_sel_hi:[1,0]
  v_pk_mul_f32 v[166:167], v[166:167], v[80:81] op_sel_hi:[1,0]
  v_pk_mul_f32 v[168:169], v[168:169], v[80:81] op_sel_hi:[1,0]
  v_pk_mul_f32 v[170:171], v[170:171], v[80:81] op_sel_hi:[1,0]
  v_pk_mul_f32 v[172:173], v[172:173], v[80:81] op_sel_hi:[1,0]
  v_pk_mul_f32 v[174:175], v[174:175], v[80:81] op_sel_hi:[1,0]
  s_waitcnt vmcnt(14)
  v_lshlrev_b32 v176, 16, v96
  v_and_b32 v177, 0xffff0000, v96
  v_lshlrev_b32 v178, 16, v97
  v_and_b32 v179, 0xffff0000, v97
  v_lshlrev_b32 v180, 16, v98
  v_and_b32 v181, 0xffff0000, v98
  v_lshlrev_b32 v182, 16, v99
  v_and_b32 v183, 0xffff0000, v99
  v_lshlrev_b32 v184, 16, v100
  v_and_b32 v185, 0xffff0000, v100
  v_lshlrev_b32 v186, 16, v101
  v_and_b32 v187, 0xffff0000, v101
  v_lshlrev_b32 v188, 16, v102
  v_and_b32 v189, 0xffff0000, v102
  v_lshlrev_b32 v190, 16, v103
  v_and_b32 v191, 0xffff0000, v103
  s_waitcnt vmcnt(12)
  v_lshlrev_b32 v8, 16, v104
  v_and_b32 v9, 0xffff0000, v104
  v_pk_add_f32 v[176:177], v[176:177], v[8:9]
  v_lshlrev_b32 v10, 16, v105
  v_and_b32 v11, 0xffff0000, v105
  v_pk_add_f32 v[178:179], v[178:179], v[10:11]
  v_lshlrev_b32 v12, 16, v106
  v_and_b32 v13, 0xffff0000, v106
  v_pk_add_f32 v[180:181], v[180:181], v[12:13]
  v_lshlrev_b32 v14, 16, v107
  v_and_b32 v15, 0xffff0000, v107
  v_pk_add_f32 v[182:183], v[182:183], v[14:15]
  v_lshlrev_b32 v8, 16, v108
  v_and_b32 v9, 0xffff0000, v108
  v_pk_add_f32 v[184:185], v[184:185], v[8:9]
  v_lshlrev_b32 v10, 16, v109
  v_and_b32 v11, 0xffff0000, v109
  v_pk_add_f32 v[186:187], v[186:187], v[10:11]
  v_lshlrev_b32 v12, 16, v110
  v_and_b32 v13, 0xffff0000, v110
  v_pk_add_f32 v[188:189], v[188:189], v[12:13]
  v_lshlrev_b32 v14, 16, v111
  v_and_b32 v15, 0xffff0000, v111
  v_pk_add_f32 v[190:191], v[190:191], v[14:15]
  s_waitcnt vmcnt(10)
  v_lshlrev_b32 v8, 16, v112
  v_and_b32 v9, 0xffff0000, v112
  v_pk_add_f32 v[176:177], v[176:177], v[8:9]
  v_lshlrev_b32 v10, 16, v113
  v_and_b32 v11, 0xffff0000, v113
  v_pk_add_f32 v[178:179], v[178:179], v[10:11]
  v_lshlrev_b32 v12, 16, v114
  v_and_b32 v13, 0xffff0000, v114
  v_pk_add_f32 v[180:181], v[180:181], v[12:13]
  v_lshlrev_b32 v14, 16, v115
  v_and_b32 v15, 0xffff0000, v115
  v_pk_add_f32 v[182:183], v[182:183], v[14:15]
  v_lshlrev_b32 v8, 16, v116
  v_and_b32 v9, 0xffff0000, v116
  v_pk_add_f32 v[184:185], v[184:185], v[8:9]
  v_lshlrev_b32 v10, 16, v117
  v_and_b32 v11, 0xffff0000, v117
  v_pk_add_f32 v[186:187], v[186:187], v[10:11]
  v_lshlrev_b32 v12, 16, v118
  v_and_b32 v13, 0xffff0000, v118
  v_pk_add_f32 v[188:189], v[188:189], v[12:13]
  v_lshlrev_b32 v14, 16, v119
  v_and_b32 v15, 0xffff0000, v119
  v_pk_add_f32 v[190:191], v[190:191], v[14:15]
  s_waitcnt vmcnt(8)
  v_lshlrev_b32 v8, 16, v120
  v_and_b32 v9, 0xffff0000, v120
  v_pk_add_f32 v[176:177], v[176:177], v[8:9]
  v_lshlrev_b32 v10, 16, v121
  v_and_b32 v11, 0xffff0000, v121
  v_pk_add_f32 v[178:179], v[178:179], v[10:11]
  v_lshlrev_b32 v12, 16, v122
  v_and_b32 v13, 0xffff0000, v122
  v_pk_add_f32 v[180:181], v[180:181], v[12:13]
  v_lshlrev_b32 v14, 16, v123
  v_and_b32 v15, 0xffff0000, v123
  v_pk_add_f32 v[182:183], v[182:183], v[14:15]
  v_lshlrev_b32 v8, 16, v124
  v_and_b32 v9, 0xffff0000, v124
  v_pk_add_f32 v[184:185], v[184:185], v[8:9]
  v_lshlrev_b32 v10, 16, v125
  v_and_b32 v11, 0xffff0000, v125
  v_pk_add_f32 v[186:187], v[186:187], v[10:11]
  v_lshlrev_b32 v12, 16, v126
  v_and_b32 v13, 0xffff0000, v126
  v_pk_add_f32 v[188:189], v[188:189], v[12:13]
  v_lshlrev_b32 v14, 16, v127
  v_and_b32 v15, 0xffff0000, v127
  v_pk_add_f32 v[190:191], v[190:191], v[14:15]
  s_waitcnt vmcnt(6)
  v_lshlrev_b32 v8, 16, v128
  v_and_b32 v9, 0xffff0000, v128
  v_pk_add_f32 v[176:177], v[176:177], v[8:9]
  v_lshlrev_b32 v10, 16, v129
  v_and_b32 v11, 0xffff0000, v129
  v_pk_add_f32 v[178:179], v[178:179], v[10:11]
  v_lshlrev_b32 v12, 16, v130
  v_and_b32 v13, 0xffff0000, v130
  v_pk_add_f32 v[180:181], v[180:181], v[12:13]
  v_lshlrev_b32 v14, 16, v131
  v_and_b32 v15, 0xffff0000, v131
  v_pk_add_f32 v[182:183], v[182:183], v[14:15]
  v_lshlrev_b32 v8, 16, v132
  v_and_b32 v9, 0xffff0000, v132
  v_pk_add_f32 v[184:185], v[184:185], v[8:9]
  v_lshlrev_b32 v10, 16, v133
  v_and_b32 v11, 0xffff0000, v133
  v_pk_add_f32 v[186:187], v[186:187], v[10:11]
  v_lshlrev_b32 v12, 16, v134
  v_and_b32 v13, 0xffff0000, v134
  v_pk_add_f32 v[188:189], v[188:189], v[12:13]
  v_lshlrev_b32 v14, 16, v135
  v_and_b32 v15, 0xffff0000, v135
  v_pk_add_f32 v[190:191], v[190:191], v[14:15]
  s_waitcnt vmcnt(4)
  v_lshlrev_b32 v8, 16, v136
  v_and_b32 v9, 0xffff0000, v136
  v_pk_add_f32 v[176:177], v[176:177], v[8:9]
  v_lshlrev_b32 v10, 16, v137
  v_and_b32 v11, 0xffff0000, v137
  v_pk_add_f32 v[178:179], v[178:179], v[10:11]
  v_lshlrev_b32 v12, 16, v138
  v_and_b32 v13, 0xffff0000, v138
  v_pk_add_f32 v[180:181], v[180:181], v[12:13]
  v_lshlrev_b32 v14, 16, v139
  v_and_b32 v15, 0xffff0000, v139
  v_pk_add_f32 v[182:183], v[182:183], v[14:15]
  v_lshlrev_b32 v8, 16, v140
  v_and_b32 v9, 0xffff0000, v140
  v_pk_add_f32 v[184:185], v[184:185], v[8:9]
  v_lshlrev_b32 v10, 16, v141
  v_and_b32 v11, 0xffff0000, v141
  v_pk_add_f32 v[186:187], v[186:187], v[10:11]
  v_lshlrev_b32 v12, 16, v142
  v_and_b32 v13, 0xffff0000, v142
  v_pk_add_f32 v[188:189], v[188:189], v[12:13]
  v_lshlrev_b32 v14, 16, v143
  v_and_b32 v15, 0xffff0000, v143
  v_pk_add_f32 v[190:191], v[190:191], v[14:15]
  s_waitcnt vmcnt(2)
  v_lshlrev_b32 v8, 16, v144
  v_and_b32 v9, 0xffff0000, v144
  v_pk_add_f32 v[176:177], v[176:177], v[8:9]
  v_lshlrev_b32 v10, 16, v145
  v_and_b32 v11, 0xffff0000, v145
  v_pk_add_f32 v[178:179], v[178:179], v[10:11]
  v_lshlrev_b32 v12, 16, v146
  v_and_b32 v13, 0xffff0000, v146
  v_pk_add_f32 v[180:181], v[180:181], v[12:13]
  v_lshlrev_b32 v14, 16, v147
  v_and_b32 v15, 0xffff0000, v147
  v_pk_add_f32 v[182:183], v[182:183], v[14:15]
  v_lshlrev_b32 v8, 16, v148
  v_and_b32 v9, 0xffff0000, v148
  v_pk_add_f32 v[184:185], v[184:185], v[8:9]
  v_lshlrev_b32 v10, 16, v149
  v_and_b32 v11, 0xffff0000, v149
  v_pk_add_f32 v[186:187], v[186:187], v[10:11]
  v_lshlrev_b32 v12, 16, v150
  v_and_b32 v13, 0xffff0000, v150
  v_pk_add_f32 v[188:189], v[188:189], v[12:13]
  v_lshlrev_b32 v14, 16, v151
  v_and_b32 v15, 0xffff0000, v151
  v_pk_add_f32 v[190:191], v[190:191], v[14:15]
  s_waitcnt vmcnt(0)
  v_lshlrev_b32 v8, 16, v152
  v_and_b32 v9, 0xffff0000, v152
  v_pk_add_f32 v[176:177], v[176:177], v[8:9]
  v_lshlrev_b32 v10, 16, v153
  v_and_b32 v11, 0xffff0000, v153
  v_pk_add_f32 v[178:179], v[178:179], v[10:11]
  v_lshlrev_b32 v12, 16, v154
  v_and_b32 v13, 0xffff0000, v154
  v_pk_add_f32 v[180:181], v[180:181], v[12:13]
  v_lshlrev_b32 v14, 16, v155
  v_and_b32 v15, 0xffff0000, v155
  v_pk_add_f32 v[182:183], v[182:183], v[14:15]
  v_lshlrev_b32 v8, 16, v156
  v_and_b32 v9, 0xffff0000, v156
  v_pk_add_f32 v[184:185], v[184:185], v[8:9]
  v_lshlrev_b32 v10, 16, v157
  v_and_b32 v11, 0xffff0000, v157
  v_pk_add_f32 v[186:187], v[186:187], v[10:11]
  v_lshlrev_b32 v12, 16, v158
  v_and_b32 v13, 0xffff0000, v158
  v_pk_add_f32 v[188:189], v[188:189], v[12:13]
  v_lshlrev_b32 v14, 16, v159
  v_and_b32 v15, 0xffff0000, v159
  v_pk_add_f32 v[190:191], v[190:191], v[14:15]
  v_pk_fma_f32 v[160:161], v[176:177], v[82:83], v[160:161] op_sel_hi:[1,0,1]
  v_cvt_pk_bf16_f32 v16, v160, v161
  v_pk_fma_f32 v[162:163], v[178:179], v[82:83], v[162:163] op_sel_hi:[1,0,1]
  v_cvt_pk_bf16_f32 v17, v162, v163
  v_pk_fma_f32 v[164:165], v[180:181], v[82:83], v[164:165] op_sel_hi:[1,0,1]
  v_cvt_pk_bf16_f32 v18, v164, v165
  v_pk_fma_f32 v[166:167], v[182:183], v[82:83], v[166:167] op_sel_hi:[1,0,1]
  v_cvt_pk_bf16_f32 v19, v166, v167
  v_pk_fma_f32 v[168:169], v[184:185], v[82:83], v[168:169] op_sel_hi:[1,0,1]
  v_cvt_pk_bf16_f32 v20, v168, v169
  v_pk_fma_f32 v[170:171], v[186:187], v[82:83], v[170:171] op_sel_hi:[1,0,1]
  v_cvt_pk_bf16_f32 v21, v170, v171
  v_pk_fma_f32 v[172:173], v[188:189], v[82:83], v[172:173] op_sel_hi:[1,0,1]
  v_cvt_pk_bf16_f32 v22, v172, v173
  v_pk_fma_f32 v[174:175], v[190:191], v[82:83], v[174:175] op_sel_hi:[1,0,1]
  v_cvt_pk_bf16_f32 v23, v174, v175
  s_lshl_b32 s26, s49, 2
  s_add_u32 s26, s26, s16
  s_lshl_b32 s26, s26, 6
  s_lshl_b32 s27, s48, 15
  s_add_u32 s26, s26, s27
  buffer_store_dwordx4 v[16:19], v6, s[32:35], s26 offen offset:0
  buffer_store_dwordx4 v[20:23], v6, s[32:35], s26 offen offset:32
  s_cmp_lt_u32 s50, 64
  s_mov_b32 s50, s51
  s_cbranch_scc1 M_fin
  s_branch M_done
M_follow:
  s_lshr_b32 s48, s64, 2
  s_and_b32 s49, s64, 1
  s_bfe_u32 s50, s64, 0x10001
  s_mov_b32 s51, 2
  s_mov_b32 s23, 32
  s_load_dwordx2 s[8:9], s[0:1], 88
  s_lshl_b32 s17, s48, 19
  s_lshl_b32 s26, s49, 2
  s_add_u32 s26, s26, s16
  s_lshl_b32 s27, s26, 7
  s_add_u32 s17, s17, s27
  s_mov_b32 s18, 1024
  s_lshl_b32 s21, s48, 6
  s_add_u32 s21, s21, s50
  s_lshl_b32 s21, s21, 3
  s_add_u32 s21, s21, s26
  s_lshl_b32 s21, s21, 12
  s_add_u32 s21, s21, 167772160
  s_lshl_b32 s22, s51, 15
  s_mov_b32 s24, 1.0
  s_waitcnt lgkmcnt(0)
  s_and_b32 s9, s9, 0xffff
  s_mov_b32 s10, 4194304
  s_mov_b32 s11, 0x20000
  s_mul_i32 s26, s16, 0
  v_add_u32 v8, 0, v2
  v_add_u32 v16, s26, v8
  v_add_u32 v9, 1024, v2
  v_add_u32 v17, s26, v9
  v_add_u32 v10, 2048, v2
  v_add_u32 v18, s26, v10
  v_add_u32 v11, 3072, v2
  v_add_u32 v19, s26, v11
  v_add_u32 v12, 4096, v2
  v_add_u32 v20, s26, v12
  v_add_u32 v13, 5120, v2
  v_add_u32 v21, s26, v13
  v_add_u32 v14, 6144, v2
  v_add_u32 v22, s26, v14
  v_add_u32 v15, 7168, v2
  v_add_u32 v23, s26, v15
  v_lshrrev_b32 v144, 3, v1
  v_mul_lo_u32 v144, v144, s18
  v_and_b32 v145, 7, v1
  v_lshl_add_u32 v144, v145, 4, v144
  s_lshl_b32 s28, s16, 15
  s_add_u32 s28, s28, 32768
  s_lshl_b32 s29, s18, 3
  s_add_u32 m0, s28, 0
  s_nop 0
  buffer_load_dwordx4 v144, s[8:11], s17 offen lds
  s_add_u32 s17, s17, s29
  s_add_u32 m0, s28, 1024
  s_nop 0
  buffer_load_dwordx4 v144, s[8:11], s17 offen lds
  s_add_u32 s17, s17, s29
  s_add_u32 m0, s28, 2048
  s_nop 0
  buffer_load_dwordx4 v144, s[8:11], s17 offen lds
  s_add_u32 s17, s17, s29
  s_add_u32 m0, s28, 3072
  s_nop 0
  buffer_load_dwordx4 v144, s[8:11], s17 offen lds
  s_add_u32 s17, s17, s29
  s_add_u32 m0, s28, 4096
  s_nop 0
  buffer_load_dwordx4 v144, s[8:11], s17 offen lds
  s_add_u32 s17, s17, s29
  s_add_u32 m0, s28, 5120
  s_nop 0
  buffer_load_dwordx4 v144, s[8:11], s17 offen lds
  s_add_u32 s17, s17, s29
  s_add_u32 m0, s28, 6144
  s_nop 0
  buffer_load_dwordx4 v144, s[8:11], s17 offen lds
  s_add_u32 s17, s17, s29
  s_add_u32 m0, s28, 7168
  s_nop 0
  buffer_load_dwordx4 v144, s[8:11], s17 offen lds
  s_add_u32 s17, s17, s29
  s_add_u32 m0, s28, 8192
  s_nop 0
  buffer_load_dwordx4 v144, s[8:11], s17 offen lds
  s_add_u32 s17, s17, s29
  s_add_u32 m0, s28, 9216
  s_nop 0
  buffer_load_dwordx4 v144, s[8:11], s17 offen lds
  s_add_u32 s17, s17, s29
  s_add_u32 m0, s28, 10240
  s_nop 0
  buffer_load_dwordx4 v144, s[8:11], s17 offen lds
  s_add_u32 s17, s17, s29
  s_add_u32 m0, s28, 11264
  s_nop 0
  buffer_load_dwordx4 v144, s[8:11], s17 offen lds
  s_add_u32 s17, s17, s29
  s_add_u32 m0, s28, 12288
  s_nop 0
  buffer_load_dwordx4 v144, s[8:11], s17 offen lds
  s_add_u32 s17, s17, s29
  s_add_u32 m0, s28, 13312
  s_nop 0
  buffer_load_dwordx4 v144, s[8:11], s17 offen lds
  s_add_u32 s17, s17, s29
  s_add_u32 m0, s28, 14336
  s_nop 0
  buffer_load_dwordx4 v144, s[8:11], s17 offen lds
  s_add_u32 s17, s17, s29
  s_add_u32 m0, s28, 15360
  s_nop 0
  buffer_load_dwordx4 v144, s[8:11], s17 offen lds
  s_add_u32 s17, s17, s29
  s_add_u32 m0, s28, 16384
  s_nop 0
  buffer_load_dwordx4 v144, s[8:11], s17 offen lds
  s_add_u32 s17, s17, s29
  s_add_u32 m0, s28, 17408
  s_nop 0
  buffer_load_dwordx4 v144, s[8:11], s17 offen lds
  s_add_u32 s17, s17, s29
  s_add_u32 m0, s28, 18432
  s_nop 0
  buffer_load_dwordx4 v144, s[8:11], s17 offen lds
  s_add_u32 s17, s17, s29
  s_add_u32 m0, s28, 19456
  s_nop 0
  buffer_load_dwordx4 v144, s[8:11], s17 offen lds
  s_add_u32 s17, s17, s29
  s_add_u32 m0, s28, 20480
  s_nop 0
  buffer_load_dwordx4 v144, s[8:11], s17 offen lds
  s_add_u32 s17, s17, s29
  s_add_u32 m0, s28, 21504
  s_nop 0
  buffer_load_dwordx4 v144, s[8:11], s17 offen lds
  s_add_u32 s17, s17, s29
  s_add_u32 m0, s28, 22528
  s_nop 0
  buffer_load_dwordx4 v144, s[8:11], s17 offen lds
  s_add_u32 s17, s17, s29
  s_add_u32 m0, s28, 23552
  s_nop 0
  buffer_load_dwordx4 v144, s[8:11], s17 offen lds
  s_add_u32 s17, s17, s29
  s_add_u32 m0, s28, 24576
  s_nop 0
  buffer_load_dwordx4 v144, s[8:11], s17 offen lds
  s_add_u32 s17, s17, s29
  s_add_u32 m0, s28, 25600
  s_nop 0
  buffer_load_dwordx4 v144, s[8:11], s17 offen lds
  s_add_u32 s17, s17, s29
  s_add_u32 m0, s28, 26624
  s_nop 0
  buffer_load_dwordx4 v144, s[8:11], s17 offen lds
  s_add_u32 s17, s17, s29
  s_add_u32 m0, s28, 27648
  s_nop 0
  buffer_load_dwordx4 v144, s[8:11], s17 offen lds
  s_add_u32 s17, s17, s29
  s_add_u32 m0, s28, 28672
  s_nop 0
  buffer_load_dwordx4 v144, s[8:11], s17 offen lds
  s_add_u32 s17, s17, s29
  s_add_u32 m0, s28, 29696
  s_nop 0
  buffer_load_dwordx4 v144, s[8:11], s17 offen lds
  s_add_u32 s17, s17, s29
  s_add_u32 m0, s28, 30720
  s_nop 0
  buffer_load_dwordx4 v144, s[8:11], s17 offen lds
  s_add_u32 s17, s17, s29
  s_add_u32 m0, s28, 31744
  s_nop 0
  buffer_load_dwordx4 v144, s[8:11], s17 offen lds
  s_add_u32 s17, s17, s29
  v_bfe_u32 v148, v1, 2, 2
  v_lshrrev_b32 v149, 5, v1
  v_lshl_add_u32 v148, v149, 2, v148
  v_lshlrev_b32 v148, 7, v148
  v_bfe_u32 v149, v1, 4, 1
  v_lshl_add_u32 v148, v149, 5, v148
  v_and_b32 v149, 1, v1
  v_lshl_add_u32 v148, v149, 4, v148
  v_bfe_u32 v149, v1, 1, 1
  v_lshl_add_u32 v148, v149, 3, v148
  v_add_u32 v146, s28, v148
  v_add_u32 v147, 1024, v146
  s_waitcnt vmcnt(28)
  ds_read_b64_tr_b16 a[0:1], v146 offset:0
  ds_read_b64_tr_b16 a[2:3], v147 offset:0
  ds_read_b64_tr_b16 a[4:5], v146 offset:64
  ds_read_b64_tr_b16 a[6:7], v147 offset:64
  ds_read_b64_tr_b16 a[8:9], v146 offset:2048
  ds_read_b64_tr_b16 a[10:11], v147 offset:2048
  ds_read_b64_tr_b16 a[12:13], v146 offset:2112
  ds_read_b64_tr_b16 a[14:15], v147 offset:2112
  s_waitcnt lgkmcnt(0)
  s_add_u32 m0, s28, 0
  s_nop 0
  buffer_load_dwordx4 v144, s[8:11], s17 offen lds
  s_add_u32 s17, s17, s29
  s_add_u32 m0, s28, 1024
  s_nop 0
  buffer_load_dwordx4 v144, s[8:11], s17 offen lds
  s_add_u32 s17, s17, s29
  s_add_u32 m0, s28, 2048
  s_nop 0
  buffer_load_dwordx4 v144, s[8:11], s17 offen lds
  s_add_u32 s17, s17, s29
  s_add_u32 m0, s28, 3072
  s_nop 0
  buffer_load_dwordx4 v144, s[8:11], s17 offen lds
  s_add_u32 s17, s17, s29
  s_waitcnt vmcnt(28)
  ds_read_b64_tr_b16 a[16:17], v146 offset:4096
  ds_read_b64_tr_b16 a[18:19], v147 offset:4096
  ds_read_b64_tr_b16 a[20:21], v146 offset:4160
  ds_read_b64_tr_b16 a[22:23], v147 offset:4160
  ds_read_b64_tr_b16 a[24:25], v146 offset:6144
  ds_read_b64_tr_b16 a[26:27], v147 offset:6144
  ds_read_b64_tr_b16 a[28:29], v146 offset:6208
  ds_read_b64_tr_b16 a[30:31], v147 offset:6208
  s_waitcnt lgkmcnt(0)
  s_add_u32 m0, s28, 4096
  s_nop 0
  buffer_load_dwordx4 v144, s[8:11], s17 offen lds
  s_add_u32 s17, s17, s29
  s_add_u32 m0, s28, 5120
  s_nop 0
  buffer_load_dwordx4 v144, s[8:11], s17 offen lds
  s_add_u32 s17, s17, s29
  s_add_u32 m0, s28, 6144
  s_nop 0
  buffer_load_dwordx4 v144, s[8:11], s17 offen lds
  s_add_u32 s17, s17, s29
  s_add_u32 m0, s28, 7168
  s_nop 0
  buffer_load_dwordx4 v144, s[8:11], s17 offen lds
  s_add_u32 s17, s17, s29
  s_waitcnt vmcnt(28)
  ds_read_b64_tr_b16 a[32:33], v146 offset:8192
  ds_read_b64_tr_b16 a[34:35], v147 offset:8192
  ds_read_b64_tr_b16 a[36:37], v146 offset:8256
  ds_read_b64_tr_b16 a[38:39], v147 offset:8256
  ds_read_b64_tr_b16 a[40:41], v146 offset:10240
  ds_read_b64_tr_b16 a[42:43], v147 offset:10240
  ds_read_b64_tr_b16 a[44:45], v146 offset:10304
  ds_read_b64_tr_b16 a[46:47], v147 offset:10304
  s_waitcnt lgkmcnt(0)
  s_add_u32 m0, s28, 8192
  s_nop 0
  buffer_load_dwordx4 v144, s[8:11], s17 offen lds
  s_add_u32 s17, s17, s29
  s_add_u32 m0, s28, 9216
  s_nop 0
  buffer_load_dwordx4 v144, s[8:11], s17 offen lds
  s_add_u32 s17, s17, s29
  s_add_u32 m0, s28, 10240
  s_nop 0
  buffer_load_dwordx4 v144, s[8:11], s17 offen lds
  s_add_u32 s17, s17, s29
  s_add_u32 m0, s28, 11264
  s_nop 0
  buffer_load_dwordx4 v144, s[8:11], s17 offen lds
  s_add_u32 s17, s17, s29
  s_waitcnt vmcnt(28)
  ds_read_b64_tr_b16 a[48:49], v146 offset:12288
  ds_read_b64_tr_b16 a[50:51], v147 offset:12288
  ds_read_b64_tr_b16 a[52:53], v146 offset:12352
  ds_read_b64_tr_b16 a[54:55], v147 offset:12352
  ds_read_b64_tr_b16 a[56:57], v146 offset:14336
  ds_read_b64_tr_b16 a[58:59], v147 offset:14336
  ds_read_b64_tr_b16 a[60:61], v146 offset:14400
  ds_read_b64_tr_b16 a[62:63], v147 offset:14400
  s_waitcnt lgkmcnt(0)
  s_add_u32 m0, s28, 12288
  s_nop 0
  buffer_load_dwordx4 v144, s[8:11], s17 offen lds
  s_add_u32 s17, s17, s29
  s_add_u32 m0, s28, 13312
  s_nop 0
  buffer_load_dwordx4 v144, s[8:11], s17 offen lds
  s_add_u32 s17, s17, s29
  s_add_u32 m0, s28, 14336
  s_nop 0
  buffer_load_dwordx4 v144, s[8:11], s17 offen lds
  s_add_u32 s17, s17, s29
  s_add_u32 m0, s28, 15360
  s_nop 0
  buffer_load_dwordx4 v144, s[8:11], s17 offen lds
  s_add_u32 s17, s17, s29
  s_waitcnt vmcnt(28)
  ds_read_b64_tr_b16 a[64:65], v146 offset:16384
  ds_read_b64_tr_b16 a[66:67], v147 offset:16384
  ds_read_b64_tr_b16 a[68:69], v146 offset:16448
  ds_read_b64_tr_b16 a[70:71], v147 offset:16448
  ds_read_b64_tr_b16 a[72:73], v146 offset:18432
  ds_read_b64_tr_b16 a[74:75], v147 offset:18432
  ds_read_b64_tr_b16 a[76:77], v146 offset:18496
  ds_read_b64_tr_b16 a[78:79], v147 offset:18496
  s_waitcnt lgkmcnt(0)
  s_add_u32 m0, s28, 16384
  s_nop 0
  buffer_load_dwordx4 v144, s[8:11], s17 offen lds
  s_add_u32 s17, s17, s29
  s_add_u32 m0, s28, 17408
  s_nop 0
  buffer_load_dwordx4 v144, s[8:11], s17 offen lds
  s_add_u32 s17, s17, s29
  s_add_u32 m0, s28, 18432
  s_nop 0
  buffer_load_dwordx4 v144, s[8:11], s17 offen lds
  s_add_u32 s17, s17, s29
  s_add_u32 m0, s28, 19456
  s_nop 0
  buffer_load_dwordx4 v144, s[8:11], s17 offen lds
  s_add_u32 s17, s17, s29
  s_waitcnt vmcnt(28)
  ds_read_b64_tr_b16 a[80:81], v146 offset:20480
  ds_read_b64_tr_b16 a[82:83], v147 offset:20480
  ds_read_b64_tr_b16 a[84:85], v146 offset:20544
  ds_read_b64_tr_b16 a[86:87], v147 offset:20544
  ds_read_b64_tr_b16 a[88:89], v146 offset:22528
  ds_read_b64_tr_b16 a[90:91], v147 offset:22528
  ds_read_b64_tr_b16 a[92:93], v146 offset:22592
  ds_read_b64_tr_b16 a[94:95], v147 offset:22592
  s_waitcnt lgkmcnt(0)
  s_add_u32 m0, s28, 20480
  s_nop 0
  buffer_load_dwordx4 v144, s[8:11], s17 offen lds
  s_add_u32 s17, s17, s29
  s_add_u32 m0, s28, 21504
  s_nop 0
  buffer_load_dwordx4 v144, s[8:11], s17 offen lds
  s_add_u32 s17, s17, s29
  s_add_u32 m0, s28, 22528
  s_nop 0
  buffer_load_dwordx4 v144, s[8:11], s17 offen lds
  s_add_u32 s17, s17, s29
  s_add_u32 m0, s28, 23552
  s_nop 0
  buffer_load_dwordx4 v144, s[8:11], s17 offen lds
  s_add_u32 s17, s17, s29
  s_waitcnt vmcnt(28)
  ds_read_b64_tr_b16 a[96:97], v146 offset:24576
  ds_read_b64_tr_b16 a[98:99], v147 offset:24576
  ds_read_b64_tr_b16 a[100:101], v146 offset:24640
  ds_read_b64_tr_b16 a[102:103], v147 offset:24640
  ds_read_b64_tr_b16 a[104:105], v146 offset:26624
  ds_read_b64_tr_b16 a[106:107], v147 offset:26624
  ds_read_b64_tr_b16 a[108:109], v146 offset:26688
  ds_read_b64_tr_b16 a[110:111], v147 offset:26688
  s_waitcnt lgkmcnt(0)
  s_add_u32 m0, s28, 24576
  s_nop 0
  buffer_load_dwordx4 v144, s[8:11], s17 offen lds
  s_add_u32 s17, s17, s29
  s_add_u32 m0, s28, 25600
  s_nop 0
  buffer_load_dwordx4 v144, s[8:11], s17 offen lds
  s_add_u32 s17, s17, s29
  s_add_u32 m0, s28, 26624
  s_nop 0
  buffer_load_dwordx4 v144, s[8:11], s17 offen lds
  s_add_u32 s17, s17, s29
  s_add_u32 m0, s28, 27648
  s_nop 0
  buffer_load_dwordx4 v144, s[8:11], s17 offen lds
  s_add_u32 s17, s17, s29
  s_waitcnt vmcnt(28)
  ds_read_b64_tr_b16 a[112:113], v146 offset:28672
  ds_read_b64_tr_b16 a[114:115], v147 offset:28672
  ds_read_b64_tr_b16 a[116:117], v146 offset:28736
  ds_read_b64_tr_b16 a[118:119], v147 offset:28736
  ds_read_b64_tr_b16 a[120:121], v146 offset:30720
  ds_read_b64_tr_b16 a[122:123], v147 offset:30720
  ds_read_b64_tr_b16 a[124:125], v146 offset:30784
  ds_read_b64_tr_b16 a[126:127], v147 offset:30784
  s_waitcnt lgkmcnt(0)
  s_add_u32 m0, s28, 28672
  s_nop 0
  buffer_load_dwordx4 v144, s[8:11], s17 offen lds
  s_add_u32 s17, s17, s29
  s_add_u32 m0, s28, 29696
  s_nop 0
  buffer_load_dwordx4 v144, s[8:11], s17 offen lds
  s_add_u32 s17, s17, s29
  s_add_u32 m0, s28, 30720
  s_nop 0
  buffer_load_dwordx4 v144, s[8:11], s17 offen lds
  s_add_u32 s17, s17, s29
  s_add_u32 m0, s28, 31744
  s_nop 0
  buffer_load_dwordx4 v144, s[8:11], s17 offen lds
  s_add_u32 s17, s17, s29
  s_waitcnt vmcnt(28)
  ds_read_b64_tr_b16 a[128:129], v146 offset:0
  ds_read_b64_tr_b16 a[130:131], v147 offset:0
  ds_read_b64_tr_b16 a[132:133], v146 offset:64
  ds_read_b64_tr_b16 a[134:135], v147 offset:64
  ds_read_b64_tr_b16 a[136:137], v146 offset:2048
  ds_read_b64_tr_b16 a[138:139], v147 offset:2048
  ds_read_b64_tr_b16 a[140:141], v146 offset:2112
  ds_read_b64_tr_b16 a[142:143], v147 offset:2112
  s_waitcnt lgkmcnt(0)
  s_waitcnt vmcnt(24)
  ds_read_b64_tr_b16 a[144:145], v146 offset:4096
  ds_read_b64_tr_b16 a[146:147], v147 offset:4096
  ds_read_b64_tr_b16 a[148:149], v146 offset:4160
  ds_read_b64_tr_b16 a[150:151], v147 offset:4160
  ds_read_b64_tr_b16 a[152:153], v146 offset:6144
  ds_read_b64_tr_b16 a[154:155], v147 offset:6144
  ds_read_b64_tr_b16 a[156:157], v146 offset:6208
  ds_read_b64_tr_b16 a[158:159], v147 offset:6208
  s_waitcnt lgkmcnt(0)
  s_waitcnt vmcnt(20)
  ds_read_b64_tr_b16 a[160:161], v146 offset:8192
  ds_read_b64_tr_b16 a[162:163], v147 offset:8192
  ds_read_b64_tr_b16 a[164:165], v146 offset:8256
  ds_read_b64_tr_b16 a[166:167], v147 offset:8256
  ds_read_b64_tr_b16 a[168:169], v146 offset:10240
  ds_read_b64_tr_b16 a[170:171], v147 offset:10240
  ds_read_b64_tr_b16 a[172:173], v146 offset:10304
  ds_read_b64_tr_b16 a[174:175], v147 offset:10304
  s_waitcnt lgkmcnt(0)
  s_waitcnt vmcnt(16)
  ds_read_b64_tr_b16 a[176:177], v146 offset:12288
  ds_read_b64_tr_b16 a[178:179], v147 offset:12288
  ds_read_b64_tr_b16 a[180:181], v146 offset:12352
  ds_read_b64_tr_b16 a[182:183], v147 offset:12352
  ds_read_b64_tr_b16 a[184:185], v146 offset:14336
  ds_read_b64_tr_b16 a[186:187], v147 offset:14336
  ds_read_b64_tr_b16 a[188:189], v146 offset:14400
  ds_read_b64_tr_b16 a[190:191], v147 offset:14400
  s_waitcnt lgkmcnt(0)
  s_waitcnt vmcnt(12)
  ds_read_b64_tr_b16 a[192:193], v146 offset:16384
  ds_read_b64_tr_b16 a[194:195], v147 offset:16384
  ds_read_b64_tr_b16 a[196:197], v146 offset:16448
  ds_read_b64_tr_b16 a[198:199], v147 offset:16448
  ds_read_b64_tr_b16 a[200:201], v146 offset:18432
  ds_read_b64_tr_b16 a[202:203], v147 offset:18432
  ds_read_b64_tr_b16 a[204:205], v146 offset:18496
  ds_read_b64_tr_b16 a[206:207], v147 offset:18496
  s_waitcnt lgkmcnt(0)
  s_waitcnt vmcnt(8)
  ds_read_b64_tr_b16 a[208:209], v146 offset:20480
  ds_read_b64_tr_b16 a[210:211], v147 offset:20480
  ds_read_b64_tr_b16 a[212:213], v146 offset:20544
  ds_read_b64_tr_b16 a[214:215], v147 offset:20544
  ds_read_b64_tr_b16 a[216:217], v146 offset:22528
  ds_read_b64_tr_b16 a[218:219], v147 offset:22528
  ds_read_b64_tr_b16 a[220:221], v146 offset:22592
  ds_read_b64_tr_b16 a[222:223], v147 offset:22592
  s_waitcnt lgkmcnt(0)
  s_waitcnt vmcnt(4)
  ds_read_b64_tr_b16 a[224:225], v146 offset:24576
  ds_read_b64_tr_b16 a[226:227], v147 offset:24576
  ds_read_b64_tr_b16 a[228:229], v146 offset:24640
  ds_read_b64_tr_b16 a[230:231], v147 offset:24640
  ds_read_b64_tr_b16 a[232:233], v146 offset:26624
  ds_read_b64_tr_b16 a[234:235], v147 offset:26624
  ds_read_b64_tr_b16 a[236:237], v146 offset:26688
  ds_read_b64_tr_b16 a[238:239], v147 offset:26688
  s_waitcnt lgkmcnt(0)
  s_waitcnt vmcnt(0)
  ds_read_b64_tr_b16 a[240:241], v146 offset:28672
  ds_read_b64_tr_b16 a[242:243], v147 offset:28672
  ds_read_b64_tr_b16 a[244:245], v146 offset:28736
  ds_read_b64_tr_b16 a[246:247], v147 offset:28736
  ds_read_b64_tr_b16 a[248:249], v146 offset:30720
  ds_read_b64_tr_b16 a[250:251], v147 offset:30720
  ds_read_b64_tr_b16 a[252:253], v146 offset:30784
  ds_read_b64_tr_b16 a[254:255], v147 offset:30784
  s_waitcnt lgkmcnt(0)
  s_lshl_b32 s26, s48, 2
  s_add_u32 s26, s26, s16
  s_lshl_b32 s27, s26, 6
  s_add_u32 s27, s27, s50
  s_lshl_b32 s19, s27, 13
  s_lshl_b32 s27, s50, 5
  s_add_u32 s27, s27, s26
  s_mul_i32 s27, s27, 4608
  s_add_u32 s20, s27, 134217728
  s_lshl_b32 s25, s16, 12
  s_add_u32 s25, s25, 65536
  s_lshl_b32 s26, s16, 13
  v_add_u32 v3, s26, v2
  v_lshrrev_b32 v16, 5, v1
  v_and_b32 v17, 31, v1
  v_mul_u32_u24 v18, 1152, v16
  v_lshl_add_u32 v5, v17, 3, v18
  v_bfe_u32 v18, v1, 2, 2
  v_lshl_add_u32 v18, v16, 2, v18
  v_and_b32 v19, 1, v1
  v_mul_u32_u24 v19, 1152, v19
  v_lshl_add_u32 v18, v18, 3, v19
  v_add_u32 v4, s25, v18
  v_lshlrev_b32 v16, 2, v16
  v_sub_u32 v17, v17, v16
  v_mov_b32 v18, 0xf149f2ca
  v_cmp_le_i32 vcc, 0, v17
  s_nop 1
  v_cndmask_b32 v240, v18, 0, vcc
  v_cmp_le_i32 vcc, 1, v17
  s_nop 1
  v_cndmask_b32 v241, v18, 0, vcc
  v_cmp_le_i32 vcc, 2, v17
  s_nop 1
  v_cndmask_b32 v242, v18, 0, vcc
  v_cmp_le_i32 vcc, 3, v17
  s_nop 1
  v_cndmask_b32 v243, v18, 0, vcc
  v_cmp_le_i32 vcc, 8, v17
  s_nop 1
  v_cndmask_b32 v244, v18, 0, vcc
  v_cmp_le_i32 vcc, 9, v17
  s_nop 1
  v_cndmask_b32 v245, v18, 0, vcc
  v_cmp_le_i32 vcc, 10, v17
  s_nop 1
  v_cndmask_b32 v246, v18, 0, vcc
  v_cmp_le_i32 vcc, 11, v17
  s_nop 1
  v_cndmask_b32 v247, v18, 0, vcc
  v_cmp_le_i32 vcc, 16, v17
  s_nop 1
  v_cndmask_b32 v248, v18, 0, vcc
  v_cmp_le_i32 vcc, 17, v17
  s_nop 1
  v_cndmask_b32 v249, v18, 0, vcc
  v_cmp_le_i32 vcc, 18, v17
  s_nop 1
  v_cndmask_b32 v250, v18, 0, vcc
  v_cmp_le_i32 vcc, 19, v17
  s_nop 1
  v_cndmask_b32 v251, v18, 0, vcc
  v_cmp_le_i32 vcc, 24, v17
  s_nop 1
  v_cndmask_b32 v252, v18, 0, vcc
  v_cmp_le_i32 vcc, 25, v17
  s_nop 1
  v_cndmask_b32 v253, v18, 0, vcc
  v_cmp_le_i32 vcc, 26, v17
  s_nop 1
  v_cndmask_b32 v254, v18, 0, vcc
  v_cmp_le_i32 vcc, 27, v17
  s_nop 1
  v_cndmask_b32 v255, v18, 0, vcc
  s_barrier
  s_lshl_b32 s77, s48, 2
  s_add_u32 s77, s77, s16
  s_mul_i32 s78, s77, 896
  s_add_u32 s76, s78, 148898176
  s_mov_b32 s71, 0
M_sw_47:
  s_add_u32 s71, s71, 1
  s_cmp_gt_u32 s71, 262144
  s_cbranch_scc1 M_exit
  s_mov_b32 s79, 0
  s_atomic_or s79, s[72:73], s76 glc
  s_waitcnt lgkmcnt(0)
  s_cmp_lt_u32 s79, 25
  s_cbranch_scc1 M_sw_47
  s_add_u32 s76, s78, 148898432
  s_mov_b32 s71, 0
M_sw_48:
  s_add_u32 s71, s71, 1
  s_cmp_gt_u32 s71, 262144
  s_cbranch_scc1 M_exit
  s_mov_b32 s79, 0
  s_atomic_or s79, s[72:73], s76 glc
  s_waitcnt lgkmcnt(0)
  s_cmp_lt_u32 s79, 39
  s_cbranch_scc1 M_sw_48
  s_add_u32 s76, s78, 148898048
  s_mov_b32 s71, 0
M_sw_49:
  s_add_u32 s71, s71, 1
  s_cmp_gt_u32 s71, 262144
  s_cbranch_scc1 M_exit
  s_mov_b32 s79, 0
  s_atomic_or s79, s[72:73], s76 glc
  s_waitcnt lgkmcnt(0)
  s_cmp_lt_u32 s79, 28
  s_cbranch_scc1 M_sw_49
  s_add_u32 s76, s78, 148898560
  s_mov_b32 s71, 0
M_sw_50:
  s_add_u32 s71, s71, 1
  s_cmp_gt_u32 s71, 262144
  s_cbranch_scc1 M_exit
  s_mov_b32 s79, 0
  s_atomic_or s79, s[72:73], s76 glc
  s_waitcnt lgkmcnt(0)
  s_cmp_lt_u32 s79, 36
  s_cbranch_scc1 M_sw_50
  s_lshl_b32 s77, s77, 7
  s_add_u32 s54, s77, 148926464
  s_add_u32 s52, s50, 1
  s_mov_b32 s53, 0
  s_mov_b32 s30, 0x200
  s_add_u32 s28, s19, 50331648
  buffer_load_dwordx4 v[144:147], v2, s[4:7], s28 offen offset:0 sc1
  buffer_load_dwordx4 v[148:151], v2, s[4:7], s28 offen offset:1024 sc1
  buffer_load_dwordx4 v[152:155], v2, s[4:7], s28 offen offset:2048 sc1
  buffer_load_dwordx4 v[156:159], v2, s[4:7], s28 offen offset:3072 sc1
  s_add_u32 s29, s19, 50335744
  buffer_load_dwordx4 v[160:163], v2, s[4:7], s29 offen offset:0 sc1
  buffer_load_dwordx4 v[164:167], v2, s[4:7], s29 offen offset:1024 sc1
  buffer_load_dwordx4 v[168:171], v2, s[4:7], s29 offen offset:2048 sc1
  buffer_load_dwordx4 v[172:175], v2, s[4:7], s29 offen offset:3072 sc1
  s_add_u32 s28, s19, 67108864
  buffer_load_dwordx4 v[176:179], v2, s[4:7], s28 offen offset:0 sc1
  buffer_load_dwordx4 v[180:183], v2, s[4:7], s28 offen offset:1024 sc1
  buffer_load_dwordx4 v[184:187], v2, s[4:7], s28 offen offset:2048 sc1
  buffer_load_dwordx4 v[188:191], v2, s[4:7], s28 offen offset:3072 sc1
  s_add_u32 s29, s19, 67112960
  buffer_load_dwordx4 v[192:195], v2, s[4:7], s29 offen offset:0 sc1
  buffer_load_dwordx4 v[196:199], v2, s[4:7], s29 offen offset:1024 sc1
  buffer_load_dwordx4 v[200:203], v2, s[4:7], s29 offen offset:2048 sc1
  buffer_load_dwordx4 v[204:207], v2, s[4:7], s29 offen offset:3072 sc1
  s_add_u32 s28, s19, 83886080
  buffer_load_dwordx4 v[208:211], v2, s[4:7], s28 offen offset:0 sc1
  buffer_load_dwordx4 v[212:215], v2, s[4:7], s28 offen offset:1024 sc1
  buffer_load_dwordx4 v[216:219], v2, s[4:7], s28 offen offset:2048 sc1
  buffer_load_dwordx4 v[220:223], v2, s[4:7], s28 offen offset:3072 sc1
  s_add_u32 s29, s19, 83890176
  buffer_load_dwordx4 v[224:227], v2, s[4:7], s29 offen offset:0 sc1
  buffer_load_dwordx4 v[228:231], v2, s[4:7], s29 offen offset:1024 sc1
  buffer_load_dwordx4 v[232:235], v2, s[4:7], s29 offen offset:2048 sc1
  buffer_load_dwordx4 v[236:239], v2, s[4:7], s29 offen offset:3072 sc1
  s_waitcnt vmcnt(0)
F_top_51:
  s_waitcnt vmcnt(12)
  v_mfma_f32_32x32x16_bf16 v[24:39], v[176:179], v[144:147], v[240:255]
  v_mfma_f32_32x32x16_bf16 v[24:39], v[180:183], v[148:151], v[24:39]
  v_mfma_f32_32x32x16_bf16 v[24:39], v[184:187], v[152:155], v[24:39]
  v_mfma_f32_32x32x16_bf16 v[24:39], v[188:191], v[156:159], v[24:39]
  v_mfma_f32_32x32x16_bf16 v[24:39], v[192:195], v[160:163], v[24:39]
  v_mfma_f32_32x32x16_bf16 v[24:39], v[196:199], v[164:167], v[24:39]
  v_mfma_f32_32x32x16_bf16 v[24:39], v[200:203], v[168:171], v[24:39]
  v_mfma_f32_32x32x16_bf16 v[24:39], v[204:207], v[172:175], v[24:39]
  s_cmp_ge_u32 s53, s52
  s_cbranch_scc1 M_mok_52
  v_mov_b32 v16, s54
  v_mov_b32 v17, s52
  s_mov_b32 s71, 0
  s_branch M_vg_54
M_vw_53:
  s_sleep 2
  s_add_u32 s71, s71, 1
  s_cmp_gt_u32 s71, 262144
  s_cbranch_scc1 M_exit
M_vg_54:
  buffer_load_dword v18, v16, s[4:7], 0 offen sc1
  s_waitcnt vmcnt(0)
  v_cmp_lt_u32 vcc, v18, v17
  s_cbranch_vccnz M_vw_53
  v_readfirstlane_b32 s53, v18
M_mok_52:
  s_add_u32 s52, s52, 2
  s_mov_b32 m0, s25
  s_nop 0
  buffer_load_dwordx4 v2, s[4:7], s20 offen offset:0 sc1 lds
  buffer_load_dwordx4 v2, s[4:7], s20 offen offset:1152 sc1 lds
  buffer_load_dwordx2 v[56:57], v5, s[4:7], s20 offen offset:2304 sc1
  buffer_load_dwordx2 v[58:59], v5, s[4:7], s20 offen offset:2560 sc1
  buffer_load_dwordx2 v[60:61], v5, s[4:7], s20 offen offset:2816 sc1
  buffer_load_dwordx2 v[62:63], v5, s[4:7], s20 offen offset:3072 sc1
  s_nop 3
  v_max_f32 v6, v24, v25
  v_max3_f32 v6, v6, v26, v27
  v_max3_f32 v6, v6, v28, v29
  v_max3_f32 v6, v6, v30, v31
  v_max3_f32 v6, v6, v32, v33
  v_max3_f32 v6, v6, v34, v35
  v_max3_f32 v6, v6, v36, v37
  v_max3_f32 v6, v6, v38, v39
  s_waitcnt vmcnt(4)
  ds_read_b64_tr_b16 v[176:177], v4 offset:0
  ds_read_b64_tr_b16 v[178:179], v4 offset:64
  ds_read_b64_tr_b16 v[180:181], v4 offset:128
  ds_read_b64_tr_b16 v[182:183], v4 offset:192
  ds_read_b64_tr_b16 v[184:185], v4 offset:256
  ds_read_b64_tr_b16 v[186:187], v4 offset:320
  ds_read_b64_tr_b16 v[188:189], v4 offset:384
  ds_read_b64_tr_b16 v[190:191], v4 offset:448
  ds_read_b64_tr_b16 v[192:193], v4 offset:512
  ds_read_b64_tr_b16 v[194:195], v4 offset:576
  ds_read_b64_tr_b16 v[196:197], v4 offset:640
  ds_read_b64_tr_b16 v[198:199], v4 offset:704
  ds_read_b64_tr_b16 v[200:201], v4 offset:768
  ds_read_b64_tr_b16 v[202:203], v4 offset:832
  ds_read_b64_tr_b16 v[204:205], v4 offset:896
  ds_read_b64_tr_b16 v[206:207], v4 offset:960
  s_waitcnt lgkmcnt(14)
  v_mfma_f32_32x32x16_bf16 v[40:55], v[176:179], v[144:147], 0
  s_waitcnt lgkmcnt(12)
  v_mfma_f32_32x32x16_bf16 v[40:55], v[180:183], v[148:151], v[40:55]
  s_waitcnt lgkmcnt(10)
  v_mfma_f32_32x32x16_bf16 v[40:55], v[184:187], v[152:155], v[40:55]
  s_waitcnt lgkmcnt(8)
  v_mfma_f32_32x32x16_bf16 v[40:55], v[188:191], v[156:159], v[40:55]
  s_waitcnt lgkmcnt(6)
  v_mfma_f32_32x32x16_bf16 v[40:55], v[192:195], v[160:163], v[40:55]
  s_waitcnt lgkmcnt(4)
  v_mfma_f32_32x32x16_bf16 v[40:55], v[196:199], v[164:167], v[40:55]
  s_waitcnt lgkmcnt(2)
  v_mfma_f32_32x32x16_bf16 v[40:55], v[200:203], v[168:171], v[40:55]
  s_waitcnt lgkmcnt(0)
  v_mfma_f32_32x32x16_bf16 v[40:55], v[204:207], v[172:175], v[40:55]
  s_nop 7
  s_nop 3
  v_max3_f32 v6, v6, v40, v41
  v_max3_f32 v6, v6, v42, v43
  v_mov_b32 v16, v6
  s_nop 1
  v_permlane32_swap_b32 v6, v16
  s_nop 1
  v_max_f32 v6, v6, v16
  v_sub_f32 v40, v40, v6
  v_sub_f32 v41, v41, v6
  v_sub_f32 v42, v42, v6
  v_sub_f32 v43, v43, v6
  v_exp_f32 v40, v40
  v_exp_f32 v41, v41
  v_exp_f32 v42, v42
  v_exp_f32 v43, v43
  v_cvt_pk_bf16_f32 v136, v40, v41
  v_cvt_pk_bf16_f32 v137, v42, v43
  s_waitcnt vmcnt(0)
  v_sub_f32 v24, v24, v6
  v_mfma_f32_32x32x8_bf16 v[64:79], v[56:57], v[136:137], 0
  v_sub_f32 v25, v25, v6
  v_sub_f32 v26, v26, v6
  v_sub_f32 v27, v27, v6
  v_sub_f32 v28, v28, v6
  v_sub_f32 v29, v29, v6
  v_mfma_f32_32x32x8_bf16 v[80:95], v[58:59], v[136:137], 0
  v_sub_f32 v30, v30, v6
  v_sub_f32 v31, v31, v6
  v_exp_f32 v24, v24
  v_exp_f32 v25, v25
  v_exp_f32 v26, v26
  v_mfma_f32_32x32x8_bf16 v[96:111], v[60:61], v[136:137], 0
  v_exp_f32 v27, v27
  v_exp_f32 v28, v28
  v_exp_f32 v29, v29
  v_exp_f32 v30, v30
  v_exp_f32 v31, v31
  v_mfma_f32_32x32x8_bf16 v[112:127], v[62:63], v[136:137], 0
  v_cvt_pk_bf16_f32 v128, v24, v25
  v_cvt_pk_bf16_f32 v129, v26, v27
  v_cvt_pk_bf16_f32 v130, v28, v29
  v_cvt_pk_bf16_f32 v131, v30, v31
  v_sub_f32 v32, v32, v6
  v_sub_f32 v33, v33, v6
  v_mfma_f32_32x32x16_bf16 v[64:79], v[208:211], v[128:131], v[64:79]
  v_sub_f32 v34, v34, v6
  v_sub_f32 v35, v35, v6
  v_sub_f32 v36, v36, v6
  v_sub_f32 v37, v37, v6
  v_sub_f32 v38, v38, v6
  v_mfma_f32_32x32x16_bf16 v[80:95], v[216:219], v[128:131], v[80:95]
  v_sub_f32 v39, v39, v6
  v_exp_f32 v32, v32
  v_exp_f32 v33, v33
  v_exp_f32 v34, v34
  v_exp_f32 v35, v35
  v_mfma_f32_32x32x16_bf16 v[96:111], v[224:227], v[128:131], v[96:111]
  v_exp_f32 v36, v36
  v_exp_f32 v37, v37
  v_exp_f32 v38, v38
  v_exp_f32 v39, v39
  v_cvt_pk_bf16_f32 v132, v32, v33
  v_mfma_f32_32x32x16_bf16 v[112:127], v[232:235], v[128:131], v[112:127]
  v_cvt_pk_bf16_f32 v133, v34, v35
  v_cvt_pk_bf16_f32 v134, v36, v37
  v_cvt_pk_bf16_f32 v135, v38, v39
  v_add_f32 v7, v40, v41
  v_add_f32 v7, v7, v42
  v_mfma_f32_32x32x16_bf16 v[64:79], v[212:215], v[132:135], v[64:79]
  v_add_f32 v7, v7, v43
  v_add_f32 v7, v7, v24
  v_add_f32 v7, v7, v25
  v_add_f32 v7, v7, v26
  v_add_f32 v7, v7, v27
  v_mfma_f32_32x32x16_bf16 v[80:95], v[220:223], v[132:135], v[80:95]
  v_add_f32 v7, v7, v28
  v_add_f32 v7, v7, v29
  v_add_f32 v7, v7, v30
  v_add_f32 v7, v7, v31
  v_add_f32 v7, v7, v32
  v_mfma_f32_32x32x16_bf16 v[96:111], v[228:231], v[132:135], v[96:111]
  v_add_f32 v7, v7, v33
  v_add_f32 v7, v7, v34
  v_add_f32 v7, v7, v35
  v_add_f32 v7, v7, v36
  v_add_f32 v7, v7, v37
  v_mfma_f32_32x32x16_bf16 v[112:127], v[236:239], v[132:135], v[112:127]
  v_add_f32 v7, v7, v38
  v_add_f32 v7, v7, v39
  v_mov_b32 v16, v7
  s_nop 1
  v_permlane32_swap_b32 v7, v16
  s_nop 1
  v_add_f32 v7, v7, v16
  v_rcp_f32 v6, v7
  s_nop 0
  v_pk_mul_f32 v[64:65], v[64:65], v[6:7] op_sel_hi:[1,0]
  v_pk_mul_f32 v[66:67], v[66:67], v[6:7] op_sel_hi:[1,0]
  v_pk_mul_f32 v[68:69], v[68:69], v[6:7] op_sel_hi:[1,0]
  v_pk_mul_f32 v[70:71], v[70:71], v[6:7] op_sel_hi:[1,0]
  v_cvt_pk_bf16_f32 v128, v64, v65
  v_cvt_pk_bf16_f32 v129, v66, v67
  v_cvt_pk_bf16_f32 v130, v68, v69
  v_cvt_pk_bf16_f32 v131, v70, v71
  ds_write_b128 v3, v[128:131] offset:0
  v_pk_mul_f32 v[72:73], v[72:73], v[6:7] op_sel_hi:[1,0]
  v_pk_mul_f32 v[74:75], v[74:75], v[6:7] op_sel_hi:[1,0]
  v_pk_mul_f32 v[76:77], v[76:77], v[6:7] op_sel_hi:[1,0]
  v_pk_mul_f32 v[78:79], v[78:79], v[6:7] op_sel_hi:[1,0]
  v_cvt_pk_bf16_f32 v132, v72, v73
  v_cvt_pk_bf16_f32 v133, v74, v75
  v_cvt_pk_bf16_f32 v134, v76, v77
  v_cvt_pk_bf16_f32 v135, v78, v79
  ds_write_b128 v3, v[132:135] offset:1024
  v_pk_mul_f32 v[80:81], v[80:81], v[6:7] op_sel_hi:[1,0]
  v_pk_mul_f32 v[82:83], v[82:83], v[6:7] op_sel_hi:[1,0]
  v_pk_mul_f32 v[84:85], v[84:85], v[6:7] op_sel_hi:[1,0]
  v_pk_mul_f32 v[86:87], v[86:87], v[6:7] op_sel_hi:[1,0]
  v_cvt_pk_bf16_f32 v136, v80, v81
  v_cvt_pk_bf16_f32 v137, v82, v83
  v_cvt_pk_bf16_f32 v138, v84, v85
  v_cvt_pk_bf16_f32 v139, v86, v87
  ds_write_b128 v3, v[136:139] offset:2048
  v_pk_mul_f32 v[88:89], v[88:89], v[6:7] op_sel_hi:[1,0]
  v_pk_mul_f32 v[90:91], v[90:91], v[6:7] op_sel_hi:[1,0]
  v_pk_mul_f32 v[92:93], v[92:93], v[6:7] op_sel_hi:[1,0]
  v_pk_mul_f32 v[94:95], v[94:95], v[6:7] op_sel_hi:[1,0]
  v_cvt_pk_bf16_f32 v140, v88, v89
  v_cvt_pk_bf16_f32 v141, v90, v91
  v_cvt_pk_bf16_f32 v142, v92, v93
  v_cvt_pk_bf16_f32 v143, v94, v95
  ds_write_b128 v3, v[140:143] offset:3072
  v_pk_mul_f32 v[96:97], v[96:97], v[6:7] op_sel_hi:[1,0]
  v_pk_mul_f32 v[98:99], v[98:99], v[6:7] op_sel_hi:[1,0]
  v_pk_mul_f32 v[100:101], v[100:101], v[6:7] op_sel_hi:[1,0]
  v_pk_mul_f32 v[102:103], v[102:103], v[6:7] op_sel_hi:[1,0]
  v_cvt_pk_bf16_f32 v128, v96, v97
  v_cvt_pk_bf16_f32 v129, v98, v99
  v_cvt_pk_bf16_f32 v130, v100, v101
  v_cvt_pk_bf16_f32 v131, v102, v103
  ds_write_b128 v3, v[128:131] offset:4096
  v_pk_mul_f32 v[104:105], v[104:105], v[6:7] op_sel_hi:[1,0]
  v_pk_mul_f32 v[106:107], v[106:107], v[6:7] op_sel_hi:[1,0]
  v_pk_mul_f32 v[108:109], v[108:109], v[6:7] op_sel_hi:[1,0]
  v_pk_mul_f32 v[110:111], v[110:111], v[6:7] op_sel_hi:[1,0]
  v_cvt_pk_bf16_f32 v132, v104, v105
  v_cvt_pk_bf16_f32 v133, v106, v107
  v_cvt_pk_bf16_f32 v134, v108, v109
  v_cvt_pk_bf16_f32 v135, v110, v111
  ds_write_b128 v3, v[132:135] offset:5120
  v_pk_mul_f32 v[112:113], v[112:113], v[6:7] op_sel_hi:[1,0]
  v_pk_mul_f32 v[114:115], v[114:115], v[6:7] op_sel_hi:[1,0]
  v_pk_mul_f32 v[116:117], v[116:117], v[6:7] op_sel_hi:[1,0]
  v_pk_mul_f32 v[118:119], v[118:119], v[6:7] op_sel_hi:[1,0]
  v_cvt_pk_bf16_f32 v136, v112, v113
  v_cvt_pk_bf16_f32 v137, v114, v115
  v_cvt_pk_bf16_f32 v138, v116, v117
  v_cvt_pk_bf16_f32 v139, v118, v119
  ds_write_b128 v3, v[136:139] offset:6144
  v_pk_mul_f32 v[120:121], v[120:121], v[6:7] op_sel_hi:[1,0]
  v_pk_mul_f32 v[122:123], v[122:123], v[6:7] op_sel_hi:[1,0]
  v_pk_mul_f32 v[124:125], v[124:125], v[6:7] op_sel_hi:[1,0]
  v_pk_mul_f32 v[126:127], v[126:127], v[6:7] op_sel_hi:[1,0]
  v_cvt_pk_bf16_f32 v140, v120, v121
  v_cvt_pk_bf16_f32 v141, v122, v123
  v_cvt_pk_bf16_f32 v142, v124, v125
  v_cvt_pk_bf16_f32 v143, v126, v127
  ds_write_b128 v3, v[140:143] offset:7168
  s_sub_u32 s23, s23, 1
  s_cmp_gt_u32 s23, 0
  s_cselect_b32 s26, s51, 0
  s_lshl_b32 s27, s26, 13
  s_add_u32 s19, s19, s27
  s_mul_i32 s27, s26, 147456
  s_add_u32 s20, s20, s27
  s_waitcnt lgkmcnt(0)
  s_barrier
  ds_read_b128 v[24:27], v8 offset:0
  ds_read_b128 v[28:31], v9 offset:0
  ds_read_b128 v[32:35], v10 offset:0
  ds_read_b128 v[36:39], v11 offset:0
  ds_read_b128 v[40:43], v12 offset:0
  ds_read_b128 v[44:47], v13 offset:0
  v_mov_b32 v16, s30
  v_min_u32 v17, 1, v0
  v_lshlrev_b32 v17, 30, v17
  buffer_store_dword v16, v17, s[4:7], s31 offen sc1
  s_add_u32 s30, s30, 1
  s_waitcnt lgkmcnt(5)
  v_mfma_f32_32x32x16_bf16 v[64:79], a[0:3], v[24:27], 0
  s_add_u32 s28, s19, 50331648
  ds_read_b128 v[48:51], v14 offset:0
  v_mfma_f32_32x32x16_bf16 v[80:95], a[4:7], v[24:27], 0
  s_waitcnt lgkmcnt(5)
  buffer_load_dwordx4 v[144:147], v2, s[4:7], s28 offen offset:0 sc1
  v_mfma_f32_32x32x16_bf16 v[64:79], a[8:11], v[28:31], v[64:79]
  ds_read_b128 v[52:55], v15 offset:0
  v_mfma_f32_32x32x16_bf16 v[80:95], a[12:15], v[28:31], v[80:95]
  s_waitcnt lgkmcnt(5)
  buffer_load_dwordx4 v[148:151], v2, s[4:7], s28 offen offset:1024 sc1
  v_mfma_f32_32x32x16_bf16 v[64:79], a[16:19], v[32:35], v[64:79]
  ds_read_b128 v[24:27], v8 offset:8192
  v_mfma_f32_32x32x16_bf16 v[80:95], a[20:23], v[32:35], v[80:95]
  s_waitcnt lgkmcnt(5)
  buffer_load_dwordx4 v[152:155], v2, s[4:7], s28 offen offset:2048 sc1
  v_mfma_f32_32x32x16_bf16 v[64:79], a[24:27], v[36:39], v[64:79]
  ds_read_b128 v[28:31], v9 offset:8192
  v_mfma_f32_32x32x16_bf16 v[80:95], a[28:31], v[36:39], v[80:95]
  s_waitcnt lgkmcnt(5)
  buffer_load_dwordx4 v[156:159], v2, s[4:7], s28 offen offset:3072 sc1
  v_mfma_f32_32x32x16_bf16 v[64:79], a[32:35], v[40:43], v[64:79]
  s_add_u32 s29, s19, 50335744
  ds_read_b128 v[32:35], v10 offset:8192
  v_mfma_f32_32x32x16_bf16 v[80:95], a[36:39], v[40:43], v[80:95]
  s_waitcnt lgkmcnt(5)
  buffer_load_dwordx4 v[160:163], v2, s[4:7], s29 offen offset:0 sc1
  v_mfma_f32_32x32x16_bf16 v[64:79], a[40:43], v[44:47], v[64:79]
  ds_read_b128 v[36:39], v11 offset:8192
  v_mfma_f32_32x32x16_bf16 v[80:95], a[44:47], v[44:47], v[80:95]
  s_waitcnt lgkmcnt(5)
  buffer_load_dwordx4 v[164:167], v2, s[4:7], s29 offen offset:1024 sc1
  v_mfma_f32_32x32x16_bf16 v[64:79], a[48:51], v[48:51], v[64:79]
  ds_read_b128 v[40:43], v12 offset:8192
  v_mfma_f32_32x32x16_bf16 v[80:95], a[52:55], v[48:51], v[80:95]
  s_waitcnt lgkmcnt(5)
  buffer_load_dwordx4 v[168:171], v2, s[4:7], s29 offen offset:2048 sc1
  v_mfma_f32_32x32x16_bf16 v[64:79], a[56:59], v[52:55], v[64:79]
  ds_read_b128 v[44:47], v13 offset:8192
  v_mfma_f32_32x32x16_bf16 v[80:95], a[60:63], v[52:55], v[80:95]
  s_waitcnt lgkmcnt(5)
  buffer_load_dwordx4 v[172:175], v2, s[4:7], s29 offen offset:3072 sc1
  v_mfma_f32_32x32x16_bf16 v[64:79], a[64:67], v[24:27], v[64:79]
  s_add_u32 s28, s19, 67108864
  ds_read_b128 v[48:51], v14 offset:8192
  v_mfma_f32_32x32x16_bf16 v[80:95], a[68:71], v[24:27], v[80:95]
  s_waitcnt lgkmcnt(5)
  buffer_load_dwordx4 v[176:179], v2, s[4:7], s28 offen offset:0 sc1
  v_mfma_f32_32x32x16_bf16 v[64:79], a[72:75], v[28:31], v[64:79]
  ds_read_b128 v[52:55], v15 offset:8192
  v_mfma_f32_32x32x16_bf16 v[80:95], a[76:79], v[28:31], v[80:95]
  s_waitcnt lgkmcnt(5)
  buffer_load_dwordx4 v[180:183], v2, s[4:7], s28 offen offset:1024 sc1
  v_mfma_f32_32x32x16_bf16 v[64:79], a[80:83], v[32:35], v[64:79]
  ds_read_b128 v[24:27], v8 offset:16384
  v_mfma_f32_32x32x16_bf16 v[80:95], a[84:87], v[32:35], v[80:95]
  s_waitcnt lgkmcnt(5)
  buffer_load_dwordx4 v[184:187], v2, s[4:7], s28 offen offset:2048 sc1
  v_mfma_f32_32x32x16_bf16 v[64:79], a[88:91], v[36:39], v[64:79]
  ds_read_b128 v[28:31], v9 offset:16384
  v_mfma_f32_32x32x16_bf16 v[80:95], a[92:95], v[36:39], v[80:95]
  s_waitcnt lgkmcnt(5)
  buffer_load_dwordx4 v[188:191], v2, s[4:7], s28 offen offset:3072 sc1
  v_mfma_f32_32x32x16_bf16 v[64:79], a[96:99], v[40:43], v[64:79]
  s_add_u32 s29, s19, 67112960
  ds_read_b128 v[32:35], v10 offset:16384
  v_mfma_f32_32x32x16_bf16 v[80:95], a[100:103], v[40:43], v[80:95]
  s_waitcnt lgkmcnt(5)
  buffer_load_dwordx4 v[192:195], v2, s[4:7], s29 offen offset:0 sc1
  v_mfma_f32_32x32x16_bf16 v[64:79], a[104:107], v[44:47], v[64:79]
  ds_read_b128 v[36:39], v11 offset:16384
  v_mfma_f32_32x32x16_bf16 v[80:95], a[108:111], v[44:47], v[80:95]
  s_waitcnt lgkmcnt(5)
  buffer_load_dwordx4 v[196:199], v2, s[4:7], s29 offen offset:1024 sc1
  v_mfma_f32_32x32x16_bf16 v[64:79], a[112:115], v[48:51], v[64:79]
  ds_read_b128 v[40:43], v12 offset:16384
  v_mfma_f32_32x32x16_bf16 v[80:95], a[116:119], v[48:51], v[80:95]
  s_waitcnt lgkmcnt(5)
  buffer_load_dwordx4 v[200:203], v2, s[4:7], s29 offen offset:2048 sc1
  v_mfma_f32_32x32x16_bf16 v[64:79], a[120:123], v[52:55], v[64:79]
  ds_read_b128 v[44:47], v13 offset:16384
  v_mfma_f32_32x32x16_bf16 v[80:95], a[124:127], v[52:55], v[80:95]
  s_waitcnt lgkmcnt(5)
  buffer_load_dwordx4 v[204:207], v2, s[4:7], s29 offen offset:3072 sc1
  v_mfma_f32_32x32x16_bf16 v[64:79], a[128:131], v[24:27], v[64:79]
  s_add_u32 s28, s19, 83886080
  ds_read_b128 v[48:51], v14 offset:16384
  v_mfma_f32_32x32x16_bf16 v[80:95], a[132:135], v[24:27], v[80:95]
  s_waitcnt lgkmcnt(5)
  buffer_load_dwordx4 v[208:211], v2, s[4:7], s28 offen offset:0 sc1
  v_mfma_f32_32x32x16_bf16 v[64:79], a[136:139], v[28:31], v[64:79]
  ds_read_b128 v[52:55], v15 offset:16384
  v_mfma_f32_32x32x16_bf16 v[80:95], a[140:143], v[28:31], v[80:95]
  s_waitcnt lgkmcnt(5)
  buffer_load_dwordx4 v[212:215], v2, s[4:7], s28 offen offset:1024 sc1
  v_mfma_f32_32x32x16_bf16 v[64:79], a[144:147], v[32:35], v[64:79]
  ds_read_b128 v[24:27], v8 offset:24576
  v_mfma_f32_32x32x16_bf16 v[80:95], a[148:151], v[32:35], v[80:95]
  s_waitcnt lgkmcnt(5)
  buffer_load_dwordx4 v[216:219], v2, s[4:7], s28 offen offset:2048 sc1
  v_mfma_f32_32x32x16_bf16 v[64:79], a[152:155], v[36:39], v[64:79]
  ds_read_b128 v[28:31], v9 offset:24576
  v_mfma_f32_32x32x16_bf16 v[80:95], a[156:159], v[36:39], v[80:95]
  s_waitcnt lgkmcnt(5)
  buffer_load_dwordx4 v[220:223], v2, s[4:7], s28 offen offset:3072 sc1
  v_mfma_f32_32x32x16_bf16 v[64:79], a[160:163], v[40:43], v[64:79]
  s_add_u32 s29, s19, 83890176
  ds_read_b128 v[32:35], v10 offset:24576
  v_mfma_f32_32x32x16_bf16 v[80:95], a[164:167], v[40:43], v[80:95]
  s_waitcnt lgkmcnt(5)
  buffer_load_dwordx4 v[224:227], v2, s[4:7], s29 offen offset:0 sc1
  v_mfma_f32_32x32x16_bf16 v[64:79], a[168:171], v[44:47], v[64:79]
  ds_read_b128 v[36:39], v11 offset:24576
  v_mfma_f32_32x32x16_bf16 v[80:95], a[172:175], v[44:47], v[80:95]
  s_waitcnt lgkmcnt(5)
  buffer_load_dwordx4 v[228:231], v2, s[4:7], s29 offen offset:1024 sc1
  v_mfma_f32_32x32x16_bf16 v[64:79], a[176:179], v[48:51], v[64:79]
  ds_read_b128 v[40:43], v12 offset:24576
  v_mfma_f32_32x32x16_bf16 v[80:95], a[180:183], v[48:51], v[80:95]
  s_waitcnt lgkmcnt(5)
  buffer_load_dwordx4 v[232:235], v2, s[4:7], s29 offen offset:2048 sc1
  v_mfma_f32_32x32x16_bf16 v[64:79], a[184:187], v[52:55], v[64:79]
  ds_read_b128 v[44:47], v13 offset:24576
  v_mfma_f32_32x32x16_bf16 v[80:95], a[188:191], v[52:55], v[80:95]
  s_waitcnt lgkmcnt(5)
  buffer_load_dwordx4 v[236:239], v2, s[4:7], s29 offen offset:3072 sc1
  v_mfma_f32_32x32x16_bf16 v[64:79], a[192:195], v[24:27], v[64:79]
  ds_read_b128 v[48:51], v14 offset:24576
  v_mfma_f32_32x32x16_bf16 v[80:95], a[196:199], v[24:27], v[80:95]
  s_waitcnt lgkmcnt(5)
  v_mfma_f32_32x32x16_bf16 v[64:79], a[200:203], v[28:31], v[64:79]
  ds_read_b128 v[52:55], v15 offset:24576
  v_mfma_f32_32x32x16_bf16 v[80:95], a[204:207], v[28:31], v[80:95]
  s_waitcnt lgkmcnt(5)
  v_mfma_f32_32x32x16_bf16 v[64:79], a[208:211], v[32:35], v[64:79]
  v_mfma_f32_32x32x16_bf16 v[80:95], a[212:215], v[32:35], v[80:95]
  s_waitcnt lgkmcnt(4)
  v_mfma_f32_32x32x16_bf16 v[64:79], a[216:219], v[36:39], v[64:79]
  v_xor_b32 v8, 0x8000, v8
  v_mfma_f32_32x32x16_bf16 v[80:95], a[220:223], v[36:39], v[80:95]
  s_waitcnt lgkmcnt(3)
  v_xor_b32 v9, 0x8000, v9
  v_mfma_f32_32x32x16_bf16 v[64:79], a[224:227], v[40:43], v[64:79]
  v_xor_b32 v10, 0x8000, v10
  v_mfma_f32_32x32x16_bf16 v[80:95], a[228:231], v[40:43], v[80:95]
  s_waitcnt lgkmcnt(2)
  v_xor_b32 v11, 0x8000, v11
  v_mfma_f32_32x32x16_bf16 v[64:79], a[232:235], v[44:47], v[64:79]
  v_xor_b32 v12, 0x8000, v12
  v_mfma_f32_32x32x16_bf16 v[80:95], a[236:239], v[44:47], v[80:95]
  s_waitcnt lgkmcnt(1)
  v_xor_b32 v13, 0x8000, v13
  v_mfma_f32_32x32x16_bf16 v[64:79], a[240:243], v[48:51], v[64:79]
  v_xor_b32 v14, 0x8000, v14
  v_mfma_f32_32x32x16_bf16 v[80:95], a[244:247], v[48:51], v[80:95]
  s_waitcnt lgkmcnt(0)
  v_xor_b32 v15, 0x8000, v15
  v_mfma_f32_32x32x16_bf16 v[64:79], a[248:251], v[52:55], v[64:79]
  v_xor_b32 v3, 0x8000, v3
  v_mfma_f32_32x32x16_bf16 v[80:95], a[252:255], v[52:55], v[80:95]
  s_nop 4
  v_cvt_pk_bf16_f32 v128, v64, v65
  v_cvt_pk_bf16_f32 v129, v66, v67
  v_cvt_pk_bf16_f32 v130, v68, v69
  v_cvt_pk_bf16_f32 v131, v70, v71
  buffer_store_dwordx4 v[128:131], v2, s[4:7], s21 offen offset:0 sc1
  v_cvt_pk_bf16_f32 v132, v72, v73
  v_cvt_pk_bf16_f32 v133, v74, v75
  v_cvt_pk_bf16_f32 v134, v76, v77
  v_cvt_pk_bf16_f32 v135, v78, v79
  buffer_store_dwordx4 v[132:135], v2, s[4:7], s21 offen offset:1024 sc1
  s_nop 1
  v_cvt_pk_bf16_f32 v136, v80, v81
  v_cvt_pk_bf16_f32 v137, v82, v83
  v_cvt_pk_bf16_f32 v138, v84, v85
  v_cvt_pk_bf16_f32 v139, v86, v87
  buffer_store_dwordx4 v[136:139], v2, s[4:7], s21 offen offset:2048 sc1
  v_cvt_pk_bf16_f32 v140, v88, v89
  v_cvt_pk_bf16_f32 v141, v90, v91
  v_cvt_pk_bf16_f32 v142, v92, v93
  v_cvt_pk_bf16_f32 v143, v94, v95
  buffer_store_dwordx4 v[140:143], v2, s[4:7], s21 offen offset:3072 sc1
  s_add_u32 s21, s21, s22
  s_cmp_gt_u32 s23, 0
  s_cbranch_scc1 F_top_51
  s_waitcnt vmcnt(0) lgkmcnt(0)
  s_barrier
  v_mov_b32 v144, s30
  v_min_u32 v145, 1, v0
  v_lshlrev_b32 v145, 30, v145
  buffer_store_dword v144, v145, s[4:7], s31 offen sc1
  s_branch M_done
M_team:
  s_mov_b32 s12, s77
  s_load_dwordx4 s[60:63], s[0:1], 64
  s_load_dwordx4 s[64:67], s[0:1], 80
  s_load_dwordx4 s[68:71], s[0:1], 120
  s_load_dwordx2 s[72:73], s[0:1], 56
  v_lshrrev_b32 v1, 6, v0
  v_and_b32 v20, 63, v0
  v_readfirstlane_b32 s13, v1
  s_getreg_b32 s36, hwreg(HW_REG_XCC_ID, 0, 4)
  s_lshl_b32 s36, 1, s36
  s_waitcnt lgkmcnt(0)
  s_mov_b32 s8, s60
  s_and_b32 s9, s61, 0xffff
  s_mov_b32 s10, 0x400000
  s_mov_b32 s11, 0x20000
  s_mov_b32 s40, s62
  s_and_b32 s41, s63, 0xffff
  s_mov_b32 s42, 0x400000
  s_mov_b32 s43, 0x20000
  s_mov_b32 s44, s64
  s_and_b32 s45, s65, 0xffff
  s_mov_b32 s46, 0x400000
  s_mov_b32 s47, 0x20000
  s_mov_b32 s48, s66
  s_and_b32 s49, s67, 0xffff
  s_mov_b32 s50, 0x400000
  s_mov_b32 s51, 0x20000
  s_mov_b32 s4, s70
  s_and_b32 s5, s71, 0xffff
  s_mov_b32 s6, 0x10000000
  s_mov_b32 s7, 0x20000
  s_mov_b32 s76, s72
  s_and_b32 s77, s73, 0xffff
  s_mov_b32 s78, 0x2000
  s_mov_b32 s79, 0x20000
  s_mov_b64 s[52:53], s[68:69]
  s_mov_b64 s[58:59], s[70:71]
  s_lshl_b32 s15, s12, 7
  s_add_u32 s15, s15, 148926464
  s_cmp_lg_u32 s13, 0
  s_cbranch_scc1 T_reg_55
  s_atomic_or s36, s[52:53], 4 glc
  s_waitcnt lgkmcnt(0)
  s_mov_b32 s36, 1
  s_atomic_add s36, s[52:53], 0 glc
  s_waitcnt lgkmcnt(0)
T_reg_55:
  v_lshrrev_b32 v21, 4, v20
  v_and_b32 v22, 15, v20
  v_and_b32 v23, 1, v21
  v_lshrrev_b32 v24, 1, v21
  v_lshlrev_b32 v2, 4, v20
  s_lshl_b32 s36, s13, 10
  v_add_u32 v3, s36, v2
  s_lshl_b32 s37, s13, 15
  s_add_u32 s37, s37, 32768
  v_add_u32 v4, s37, v2
  v_lshrrev_b32 v25, 2, v20
  v_lshlrev_b32 v25, 13, v25
  v_and_b32 v1, 3, v20
  v_lshl_add_u32 v25, v1, 4, v25
  s_lshl_b32 s36, s13, 6
  s_lshl_b32 s38, s12, 8
  s_add_u32 s36, s36, s38
  v_add_u32 v25, s36, v25
  v_lshrrev_b32 v26, 3, v20
  v_lshlrev_b32 v26, 10, v26
  v_and_b32 v1, 7, v20
  v_lshl_add_u32 v26, v1, 4, v26
  s_lshl_b32 s36, s13, 7
  s_lshl_b32 s38, s12, 17
  s_add_u32 s36, s36, s38
  v_add_u32 v26, s36, v26
  v_bfe_u32 v29, v20, 2, 1
  v_bfe_u32 v30, v20, 3, 1
  v_and_b32 v31, 3, v20
  v_lshl_add_u32 v27, v24, 1, v29
  v_lshl_add_u32 v27, v27, 1, v23
  v_lshlrev_b32 v27, 7, v27
  v_lshl_add_u32 v27, v30, 5, v27
  v_lshl_add_u32 v27, v31, 3, v27
  v_add_u32 v27, s37, v27
  v_lshl_add_u32 v28, v23, 2, v24
  v_lshl_add_u32 v28, v28, 2, v29
  v_lshlrev_b32 v28, 7, v28
  v_lshl_add_u32 v28, v30, 6, v28
  v_lshl_add_u32 v28, v31, 4, v28
  v_add_u32 v28, s37, v28
  s_mov_b32 s39, s37
  s_add_u32 m0, s39, 0
  s_mov_b32 s37, 524288
  buffer_load_dwordx4 v25, s[8:11], s37 offen lds
  s_add_u32 m0, s39, 1024
  s_mov_b32 s37, 655360
  buffer_load_dwordx4 v25, s[8:11], s37 offen lds
  s_add_u32 m0, s39, 2048
  s_mov_b32 s37, 524288
  buffer_load_dwordx4 v25, s[40:43], s37 offen lds
  s_add_u32 m0, s39, 3072
  s_mov_b32 s37, 655360
  buffer_load_dwordx4 v25, s[40:43], s37 offen lds
  s_add_u32 m0, s39, 4096
  s_mov_b32 s37, 524288
  buffer_load_dwordx4 v25, s[44:47], s37 offen lds
  s_add_u32 m0, s39, 5120
  s_mov_b32 s37, 655360
  buffer_load_dwordx4 v25, s[44:47], s37 offen lds
  s_add_u32 m0, s39, 6144
  s_mov_b32 s37, 786432
  buffer_load_dwordx4 v25, s[8:11], s37 offen lds
  s_add_u32 m0, s39, 7168
  s_mov_b32 s37, 917504
  buffer_load_dwordx4 v25, s[8:11], s37 offen lds
  s_add_u32 m0, s39, 8192
  s_mov_b32 s37, 786432
  buffer_load_dwordx4 v25, s[40:43], s37 offen lds
  s_add_u32 m0, s39, 9216
  s_mov_b32 s37, 917504
  buffer_load_dwordx4 v25, s[40:43], s37 offen lds
  s_add_u32 m0, s39, 10240
  s_mov_b32 s37, 1048576
  buffer_load_dwordx4 v25, s[8:11], s37 offen lds
  s_add_u32 m0, s39, 11264
  s_mov_b32 s37, 1179648
  buffer_load_dwordx4 v25, s[8:11], s37 offen lds
  s_add_u32 m0, s39, 12288
  s_mov_b32 s37, 1048576
  buffer_load_dwordx4 v25, s[40:43], s37 offen lds
  s_add_u32 m0, s39, 13312
  s_mov_b32 s37, 1179648
  buffer_load_dwordx4 v25, s[40:43], s37 offen lds
  s_add_u32 m0, s39, 14336
  s_mov_b32 s37, 1048576
  buffer_load_dwordx4 v25, s[44:47], s37 offen lds
  s_add_u32 m0, s39, 15360
  s_mov_b32 s37, 1179648
  buffer_load_dwordx4 v25, s[44:47], s37 offen lds
  s_add_u32 m0, s39, 16384
  s_mov_b32 s37, 1310720
  buffer_load_dwordx4 v25, s[8:11], s37 offen lds
  s_add_u32 m0, s39, 17408
  s_mov_b32 s37, 1441792
  buffer_load_dwordx4 v25, s[8:11], s37 offen lds
  s_add_u32 m0, s39, 18432
  s_mov_b32 s37, 1310720
  buffer_load_dwordx4 v25, s[40:43], s37 offen lds
  s_add_u32 m0, s39, 19456
  s_mov_b32 s37, 1441792
  buffer_load_dwordx4 v25, s[40:43], s37 offen lds
  s_add_u32 m0, s39, 20480
  s_mov_b32 s37, 1572864
  buffer_load_dwordx4 v25, s[8:11], s37 offen lds
  s_add_u32 m0, s39, 21504
  s_mov_b32 s37, 1703936
  buffer_load_dwordx4 v25, s[8:11], s37 offen lds
  s_add_u32 m0, s39, 22528
  s_mov_b32 s37, 1835008
  buffer_load_dwordx4 v25, s[8:11], s37 offen lds
  s_add_u32 m0, s39, 23552
  s_mov_b32 s37, 1966080
  buffer_load_dwordx4 v25, s[8:11], s37 offen lds
  s_add_u32 m0, s39, 24576
  s_mov_b32 s37, 1835008
  buffer_load_dwordx4 v25, s[40:43], s37 offen lds
  s_add_u32 m0, s39, 25600
  s_mov_b32 s37, 1966080
  buffer_load_dwordx4 v25, s[40:43], s37 offen lds
  s_add_u32 m0, s39, 26624
  s_mov_b32 s37, 1835008
  buffer_load_dwordx4 v25, s[44:47], s37 offen lds
  s_add_u32 m0, s39, 27648
  s_mov_b32 s37, 1966080
  buffer_load_dwordx4 v25, s[44:47], s37 offen lds
  s_add_u32 m0, s39, 28672
  s_mov_b32 s37, 2097152
  buffer_load_dwordx4 v25, s[8:11], s37 offen lds
  s_add_u32 m0, s39, 29696
  s_mov_b32 s37, 2228224
  buffer_load_dwordx4 v25, s[8:11], s37 offen lds
  s_add_u32 m0, s39, 30720
  s_mov_b32 s37, 2097152
  buffer_load_dwordx4 v25, s[40:43], s37 offen lds
  s_add_u32 m0, s39, 31744
  s_mov_b32 s37, 2228224
  buffer_load_dwordx4 v25, s[40:43], s37 offen lds
  v_mov_b32 v0, 0x4444
  v_mov_b32 v1, 0xeeee
  v_cmp_lt_u32 vcc, 7, v22
  s_nop 1
  v_cndmask_b32 v32, v0, v1, vcc
  v_mov_b32 v0, v32
  v_and_b32 v32, 7, v20
  v_lshlrev_b32 v32, 4, v32
  v_lshl_add_u32 v1, v21, 7, v32
  s_lshl_b32 s36, s13, 9
  v_add_u32 v11, s36, v1
  v_lshl_add_u32 v33, v24, 4, v22
  s_lshl_b32 s36, s13, 5
  v_add_u32 v33, s36, v33
  v_lshlrev_b32 v33, 3, v33
  v_mul_u32_u24 v34, 1152, v23
  v_add_u32 v5, v33, v34
  v_bfe_u32 v33, v20, 2, 2
  v_lshl_add_u32 v33, v23, 2, v33
  v_lshl_add_u32 v33, v24, 4, v33
  v_lshlrev_b32 v33, 3, v33
  v_and_b32 v34, 1, v20
  v_mul_u32_u24 v34, 1152, v34
  v_add_u32 v6, v33, v34
  s_lshl_b32 s36, s13, 3
  v_lshrrev_b32 v33, 3, v20
  v_add_u32 v33, s36, v33
  v_mul_u32_u24 v34, 0, v33
  v_add_u32 v34, s12, v34
  v_and_b32 v34, 31, v34
  v_lshl_add_u32 v33, v33, 13, v32
  v_lshl_add_u32 v7, v34, 7, v33
  s_lshr_b32 s36, s12, 2
  s_lshl_b32 s36, s36, 9
  s_and_b32 s37, s12, 1
  s_lshl_b32 s37, s37, 8
  s_add_u32 s36, s36, s37
  s_and_b32 s37, s12, 2
  s_lshl_b32 s37, s37, 5
  s_add_u32 s36, s36, s37
  v_lshlrev_b32 v33, 4, v21
  v_lshl_add_u32 v33, v31, 2, v33
  v_lshl_add_u32 v33, v29, 7, v33
  v_lshl_add_u32 v33, v30, 30, v33
  v_add_u32 v8, s36, v33
  s_lshr_b32 s36, s12, 2
  s_lshl_b32 s36, s36, 6
  s_and_b32 s37, s12, 1
  s_lshl_b32 s37, s37, 5
  s_add_u32 s36, s36, s37
  s_and_b32 s37, s12, 2
  s_lshl_b32 s37, s37, 11
  s_add_u32 s36, s36, s37
  v_lshlrev_b32 v35, 10, v21
  v_lshl_add_u32 v35, v31, 1, v35
  v_lshl_add_u32 v35, v29, 4, v35
  v_add_u32 v35, s36, v35
  buffer_load_ushort v44, v35, s[76:79], 0 offen offset:0
  buffer_load_ushort v45, v35, s[76:79], 0 offen offset:8
  buffer_load_ushort v46, v35, s[76:79], 0 offen offset:512
  buffer_load_ushort v47, v35, s[76:79], 0 offen offset:520
  v_lshlrev_b32 v33, 4, v29
  v_mov_b32 v34, 0x3f80
  v_lshlrev_b32 v33, v33, v34
  v_and_b32 v34, 1, v20
  v_lshl_add_u32 v34, v34, 1, v30
  v_cmp_eq_u32 vcc, 0, v34
  s_nop 1
  v_cndmask_b32 v48, 0, v33, vcc
  v_cmp_eq_u32 vcc, 1, v34
  s_nop 1
  v_cndmask_b32 v49, 0, v33, vcc
  v_cmp_eq_u32 vcc, 2, v34
  s_nop 1
  v_cndmask_b32 v50, 0, v33, vcc
  v_cmp_eq_u32 vcc, 3, v34
  s_nop 1
  v_cndmask_b32 v51, 0, v33, vcc
  ds_write_b128 v2, v[48:51] offset:31232
  v_lshlrev_b32 v33, 9, v21
  s_lshl_b32 s36, s13, 11
  v_add_u32 v33, s36, v33
  v_lshl_add_u32 v10, v22, 4, v33
  v_lshl_add_u32 v33, v30, 8, v33
  v_add_u32 v9, v33, v32
  s_mov_b32 s2, 0x3f803f80
  s_mov_b32 s3, 0x3f803f80
  s_mov_b32 s16, 0
  s_mov_b32 s17, -1
  s_mov_b32 s18, 0x3e0293ee
  s_mov_b32 s54, 0x2f800000
  s_mov_b32 s55, 0x28000000
  s_lshl_b32 s36, s13, 10
  s_add_u32 s31, s36, 8192
  s_add_u32 s32, s36, 12160
  s_add_u32 s33, s36, 16384
  s_add_u32 s34, s36, 20224
  s_lshl_b32 s36, s12, 19
  s_add_u32 s27, s36, 67108864
  s_add_u32 s28, s36, 83886080
  s_mul_i32 s36, s12, 4608
  s_add_u32 s29, s36, 134217728
  s_lshl_b32 s36, s12, 13
  s_add_u32 s22, s36, 144703488
  s_add_u32 s23, s36, 144707584
  s_mov_b32 s20, 144703488
  s_mov_b32 s21, 144707584
  s_waitcnt vmcnt(32)
  ds_read_b64_tr_b16 v[128:129], v27 offset:0
  ds_read_b64_tr_b16 v[130:131], v27 offset:64
  ds_read_b64_tr_b16 v[132:133], v27 offset:1024
  ds_read_b64_tr_b16 v[134:135], v27 offset:1088
  ds_read_b64_tr_b16 v[136:137], v27 offset:2048
  ds_read_b64_tr_b16 v[138:139], v27 offset:2112
  ds_read_b64_tr_b16 v[140:141], v27 offset:3072
  ds_read_b64_tr_b16 v[142:143], v27 offset:3136
  s_waitcnt lgkmcnt(0)
  s_add_u32 m0, s39, 0
  s_mov_b32 s37, 2097152
  buffer_load_dwordx4 v25, s[44:47], s37 offen lds
  s_add_u32 m0, s39, 1024
  s_mov_b32 s37, 2228224
  buffer_load_dwordx4 v25, s[44:47], s37 offen lds
  s_add_u32 m0, s39, 2048
  s_mov_b32 s37, 2359296
  buffer_load_dwordx4 v25, s[8:11], s37 offen lds
  s_add_u32 m0, s39, 3072
  s_mov_b32 s37, 2490368
  buffer_load_dwordx4 v25, s[8:11], s37 offen lds
  s_waitcnt vmcnt(32)
  ds_read_b64_tr_b16 v[144:145], v27 offset:4096
  ds_read_b64_tr_b16 v[146:147], v27 offset:4160
  ds_read_b64_tr_b16 v[148:149], v27 offset:5120
  ds_read_b64_tr_b16 v[150:151], v27 offset:5184
  ds_read_b64_tr_b16 v[152:153], v27 offset:6144
  ds_read_b64_tr_b16 v[154:155], v27 offset:6208
  ds_read_b64_tr_b16 v[156:157], v27 offset:7168
  ds_read_b64_tr_b16 v[158:159], v27 offset:7232
  s_waitcnt lgkmcnt(0)
  s_add_u32 m0, s39, 4096
  s_mov_b32 s37, 2359296
  buffer_load_dwordx4 v25, s[44:47], s37 offen lds
  s_add_u32 m0, s39, 5120
  s_mov_b32 s37, 2490368
  buffer_load_dwordx4 v25, s[44:47], s37 offen lds
  s_add_u32 m0, s39, 6144
  s_mov_b32 s37, 2621440
  buffer_load_dwordx4 v25, s[8:11], s37 offen lds
  s_add_u32 m0, s39, 7168
  s_mov_b32 s37, 2752512
  buffer_load_dwordx4 v25, s[8:11], s37 offen lds
  s_waitcnt vmcnt(32)
  ds_read_b64_tr_b16 v[160:161], v27 offset:8192
  ds_read_b64_tr_b16 v[162:163], v27 offset:8256
  ds_read_b64_tr_b16 v[164:165], v27 offset:9216
  ds_read_b64_tr_b16 v[166:167], v27 offset:9280
  ds_read_b64_tr_b16 v[168:169], v27 offset:10240
  ds_read_b64_tr_b16 v[170:171], v27 offset:10304
  ds_read_b64_tr_b16 v[172:173], v27 offset:11264
  ds_read_b64_tr_b16 v[174:175], v27 offset:11328
  s_waitcnt lgkmcnt(0)
  s_add_u32 m0, s39, 8192
  s_mov_b32 s37, 2621440
  buffer_load_dwordx4 v25, s[40:43], s37 offen lds
  s_add_u32 m0, s39, 9216
  s_mov_b32 s37, 2752512
  buffer_load_dwordx4 v25, s[40:43], s37 offen lds
  s_add_u32 m0, s39, 10240
  s_mov_b32 s37, 2621440
  buffer_load_dwordx4 v25, s[44:47], s37 offen lds
  s_add_u32 m0, s39, 11264
  s_mov_b32 s37, 2752512
  buffer_load_dwordx4 v25, s[44:47], s37 offen lds
  s_waitcnt vmcnt(32)
  ds_read_b64_tr_b16 v[176:177], v27 offset:12288
  ds_read_b64_tr_b16 v[178:179], v27 offset:12352
  ds_read_b64_tr_b16 v[180:181], v27 offset:13312
  ds_read_b64_tr_b16 v[182:183], v27 offset:13376
  ds_read_b64_tr_b16 v[184:185], v27 offset:14336
  ds_read_b64_tr_b16 v[186:187], v27 offset:14400
  ds_read_b64_tr_b16 v[188:189], v27 offset:15360
  ds_read_b64_tr_b16 v[190:191], v27 offset:15424
  s_waitcnt lgkmcnt(0)
  s_add_u32 m0, s39, 12288
  s_mov_b32 s37, 2883584
  buffer_load_dwordx4 v25, s[8:11], s37 offen lds
  s_add_u32 m0, s39, 13312
  s_mov_b32 s37, 3014656
  buffer_load_dwordx4 v25, s[8:11], s37 offen lds
  s_add_u32 m0, s39, 14336
  s_mov_b32 s37, 2883584
  buffer_load_dwordx4 v25, s[40:43], s37 offen lds
  s_add_u32 m0, s39, 15360
  s_mov_b32 s37, 3014656
  buffer_load_dwordx4 v25, s[40:43], s37 offen lds
  s_waitcnt vmcnt(32)
  ds_read_b64_tr_b16 v[192:193], v27 offset:16384
  ds_read_b64_tr_b16 v[194:195], v27 offset:16448
  ds_read_b64_tr_b16 v[196:197], v27 offset:17408
  ds_read_b64_tr_b16 v[198:199], v27 offset:17472
  ds_read_b64_tr_b16 v[200:201], v27 offset:18432
  ds_read_b64_tr_b16 v[202:203], v27 offset:18496
  ds_read_b64_tr_b16 v[204:205], v27 offset:19456
  ds_read_b64_tr_b16 v[206:207], v27 offset:19520
  s_waitcnt lgkmcnt(0)
  s_add_u32 m0, s39, 16384
  s_mov_b32 s37, 2883584
  buffer_load_dwordx4 v25, s[44:47], s37 offen lds
  s_add_u32 m0, s39, 17408
  s_mov_b32 s37, 3014656
  buffer_load_dwordx4 v25, s[44:47], s37 offen lds
  s_add_u32 m0, s39, 18432
  s_mov_b32 s37, 3145728
  buffer_load_dwordx4 v25, s[8:11], s37 offen lds
  s_add_u32 m0, s39, 19456
  s_mov_b32 s37, 3276800
  buffer_load_dwordx4 v25, s[8:11], s37 offen lds
  s_waitcnt vmcnt(32)
  ds_read_b64_tr_b16 v[208:209], v27 offset:20480
  ds_read_b64_tr_b16 v[210:211], v27 offset:20544
  ds_read_b64_tr_b16 v[212:213], v27 offset:21504
  ds_read_b64_tr_b16 v[214:215], v27 offset:21568
  ds_read_b64_tr_b16 v[216:217], v27 offset:22528
  ds_read_b64_tr_b16 v[218:219], v27 offset:22592
  ds_read_b64_tr_b16 v[220:221], v27 offset:23552
  ds_read_b64_tr_b16 v[222:223], v27 offset:23616
  s_waitcnt lgkmcnt(0)
  s_add_u32 m0, s39, 20480
  s_mov_b32 s37, 3145728
  buffer_load_dwordx4 v25, s[40:43], s37 offen lds
  s_add_u32 m0, s39, 21504
  s_mov_b32 s37, 3276800
  buffer_load_dwordx4 v25, s[40:43], s37 offen lds
  s_add_u32 m0, s39, 22528
  s_mov_b32 s37, 3145728
  buffer_load_dwordx4 v25, s[44:47], s37 offen lds
  s_add_u32 m0, s39, 23552
  s_mov_b32 s37, 3276800
  buffer_load_dwordx4 v25, s[44:47], s37 offen lds
  s_waitcnt vmcnt(32)
  ds_read_b64_tr_b16 v[224:225], v27 offset:24576
  ds_read_b64_tr_b16 v[226:227], v27 offset:24640
  ds_read_b64_tr_b16 v[228:229], v27 offset:25600
  ds_read_b64_tr_b16 v[230:231], v27 offset:25664
  ds_read_b64_tr_b16 v[232:233], v27 offset:26624
  ds_read_b64_tr_b16 v[234:235], v27 offset:26688
  ds_read_b64_tr_b16 v[236:237], v27 offset:27648
  ds_read_b64_tr_b16 v[238:239], v27 offset:27712
  s_waitcnt lgkmcnt(0)
  s_add_u32 m0, s39, 24576
  s_mov_b32 s37, 3407872
  buffer_load_dwordx4 v25, s[8:11], s37 offen lds
  s_add_u32 m0, s39, 25600
  s_mov_b32 s37, 3538944
  buffer_load_dwordx4 v25, s[8:11], s37 offen lds
  s_add_u32 m0, s39, 26624
  s_mov_b32 s37, 3407872
  buffer_load_dwordx4 v25, s[44:47], s37 offen lds
  s_add_u32 m0, s39, 27648
  s_mov_b32 s37, 3538944
  buffer_load_dwordx4 v25, s[44:47], s37 offen lds
  s_waitcnt vmcnt(32)
  ds_read_b64_tr_b16 v[240:241], v27 offset:28672
  ds_read_b64_tr_b16 v[242:243], v27 offset:28736
  ds_read_b64_tr_b16 v[244:245], v27 offset:29696
  ds_read_b64_tr_b16 v[246:247], v27 offset:29760
  ds_read_b64_tr_b16 v[248:249], v27 offset:30720
  ds_read_b64_tr_b16 v[250:251], v27 offset:30784
  ds_read_b64_tr_b16 v[252:253], v27 offset:31744
  ds_read_b64_tr_b16 v[254:255], v27 offset:31808
  s_waitcnt lgkmcnt(0)
  s_add_u32 m0, s39, 28672
  s_mov_b32 s37, 3670016
  buffer_load_dwordx4 v25, s[8:11], s37 offen lds
  s_add_u32 m0, s39, 29696
  s_mov_b32 s37, 3801088
  buffer_load_dwordx4 v25, s[8:11], s37 offen lds
  s_add_u32 m0, s39, 30720
  s_mov_b32 s37, 3670016
  buffer_load_dwordx4 v25, s[40:43], s37 offen lds
  s_add_u32 m0, s39, 31744
  s_mov_b32 s37, 3801088
  buffer_load_dwordx4 v25, s[40:43], s37 offen lds
  s_waitcnt vmcnt(28)
  ds_read_b64_tr_b16 a[0:1], v27 offset:0
  ds_read_b64_tr_b16 a[2:3], v27 offset:64
  ds_read_b64_tr_b16 a[4:5], v27 offset:1024
  ds_read_b64_tr_b16 a[6:7], v27 offset:1088
  ds_read_b64_tr_b16 a[8:9], v27 offset:2048
  ds_read_b64_tr_b16 a[10:11], v27 offset:2112
  ds_read_b64_tr_b16 a[12:13], v27 offset:3072
  ds_read_b64_tr_b16 a[14:15], v27 offset:3136
  s_waitcnt lgkmcnt(0)
  s_add_u32 m0, s39, 0
  s_mov_b32 s37, 3670016
  buffer_load_dwordx4 v25, s[44:47], s37 offen lds
  s_add_u32 m0, s39, 1024
  s_mov_b32 s37, 3801088
  buffer_load_dwordx4 v25, s[44:47], s37 offen lds
  s_add_u32 m0, s39, 2048
  s_mov_b32 s37, 3932160
  buffer_load_dwordx4 v25, s[8:11], s37 offen lds
  s_add_u32 m0, s39, 3072
  s_mov_b32 s37, 4063232
  buffer_load_dwordx4 v25, s[8:11], s37 offen lds
  s_waitcnt vmcnt(28)
  ds_read_b64_tr_b16 a[16:17], v27 offset:4096
  ds_read_b64_tr_b16 a[18:19], v27 offset:4160
  ds_read_b64_tr_b16 a[20:21], v27 offset:5120
  ds_read_b64_tr_b16 a[22:23], v27 offset:5184
  ds_read_b64_tr_b16 a[24:25], v27 offset:6144
  ds_read_b64_tr_b16 a[26:27], v27 offset:6208
  ds_read_b64_tr_b16 a[28:29], v27 offset:7168
  ds_read_b64_tr_b16 a[30:31], v27 offset:7232
  s_waitcnt lgkmcnt(0)
  s_add_u32 m0, s39, 4096
  s_mov_b32 s37, 3932160
  buffer_load_dwordx4 v25, s[40:43], s37 offen lds
  s_add_u32 m0, s39, 5120
  s_mov_b32 s37, 4063232
  buffer_load_dwordx4 v25, s[40:43], s37 offen lds
  s_add_u32 m0, s39, 6144
  s_mov_b32 s37, 3932160
  buffer_load_dwordx4 v25, s[44:47], s37 offen lds
  s_add_u32 m0, s39, 7168
  s_mov_b32 s37, 4063232
  buffer_load_dwordx4 v25, s[44:47], s37 offen lds
  s_waitcnt vmcnt(28)
  ds_read_b64_tr_b16 a[32:33], v27 offset:8192
  ds_read_b64_tr_b16 a[34:35], v27 offset:8256
  ds_read_b64_tr_b16 a[36:37], v27 offset:9216
  ds_read_b64_tr_b16 a[38:39], v27 offset:9280
  ds_read_b64_tr_b16 a[40:41], v27 offset:10240
  ds_read_b64_tr_b16 a[42:43], v27 offset:10304
  ds_read_b64_tr_b16 a[44:45], v27 offset:11264
  ds_read_b64_tr_b16 a[46:47], v27 offset:11328
  s_waitcnt lgkmcnt(0)
  s_xor_b32 s36, s13, 0
  s_lshl_b32 s36, s36, 15
  s_add_u32 m0, s39, 8192
  s_add_u32 s37, s36, 0
  buffer_load_dwordx4 v26, s[48:51], s37 offen lds
  s_add_u32 m0, s39, 9216
  s_add_u32 s37, s36, 8192
  buffer_load_dwordx4 v26, s[48:51], s37 offen lds
  s_add_u32 m0, s39, 10240
  s_add_u32 s37, s36, 16384
  buffer_load_dwordx4 v26, s[48:51], s37 offen lds
  s_add_u32 m0, s39, 11264
  s_add_u32 s37, s36, 24576
  buffer_load_dwordx4 v26, s[48:51], s37 offen lds
  s_waitcnt vmcnt(28)
  ds_read_b64_tr_b16 a[48:49], v27 offset:12288
  ds_read_b64_tr_b16 a[50:51], v27 offset:12352
  ds_read_b64_tr_b16 a[52:53], v27 offset:13312
  ds_read_b64_tr_b16 a[54:55], v27 offset:13376
  ds_read_b64_tr_b16 a[56:57], v27 offset:14336
  ds_read_b64_tr_b16 a[58:59], v27 offset:14400
  ds_read_b64_tr_b16 a[60:61], v27 offset:15360
  ds_read_b64_tr_b16 a[62:63], v27 offset:15424
  s_waitcnt lgkmcnt(0)
  s_xor_b32 s36, s13, 0
  s_lshl_b32 s36, s36, 15
  s_add_u32 m0, s39, 12288
  s_add_u32 s37, s36, 512
  buffer_load_dwordx4 v26, s[48:51], s37 offen lds
  s_add_u32 m0, s39, 13312
  s_add_u32 s37, s36, 8704
  buffer_load_dwordx4 v26, s[48:51], s37 offen lds
  s_add_u32 m0, s39, 14336
  s_add_u32 s37, s36, 16896
  buffer_load_dwordx4 v26, s[48:51], s37 offen lds
  s_add_u32 m0, s39, 15360
  s_add_u32 s37, s36, 25088
  buffer_load_dwordx4 v26, s[48:51], s37 offen lds
  s_waitcnt vmcnt(28)
  ds_read_b64_tr_b16 a[64:65], v27 offset:16384
  ds_read_b64_tr_b16 a[66:67], v27 offset:16448
  ds_read_b64_tr_b16 a[68:69], v27 offset:17408
  ds_read_b64_tr_b16 a[70:71], v27 offset:17472
  ds_read_b64_tr_b16 a[72:73], v27 offset:18432
  ds_read_b64_tr_b16 a[74:75], v27 offset:18496
  ds_read_b64_tr_b16 a[76:77], v27 offset:19456
  ds_read_b64_tr_b16 a[78:79], v27 offset:19520
  s_waitcnt lgkmcnt(0)
  s_xor_b32 s36, s13, 1
  s_lshl_b32 s36, s36, 15
  s_add_u32 m0, s39, 16384
  s_add_u32 s37, s36, 0
  buffer_load_dwordx4 v26, s[48:51], s37 offen lds
  s_add_u32 m0, s39, 17408
  s_add_u32 s37, s36, 8192
  buffer_load_dwordx4 v26, s[48:51], s37 offen lds
  s_add_u32 m0, s39, 18432
  s_add_u32 s37, s36, 16384
  buffer_load_dwordx4 v26, s[48:51], s37 offen lds
  s_add_u32 m0, s39, 19456
  s_add_u32 s37, s36, 24576
  buffer_load_dwordx4 v26, s[48:51], s37 offen lds
  s_mov_b32 s19, 0
T_spin_56:
  s_add_u32 s19, s19, 1
  s_cmp_gt_u32 s19, 32768
  s_cbranch_scc1 M_exit
  s_mov_b32 s36, 0
  s_atomic_or s36, s[52:53], 0 glc
  s_waitcnt lgkmcnt(0)
  s_cmp_lt_u32 s36, 32
  s_cbranch_scc1 T_spin_56
  s_mov_b32 s36, 0
  s_atomic_or s36, s[52:53], 4 glc
  s_waitcnt lgkmcnt(0)
  s_bcnt1_i32_b32 s36, s36
  s_cmp_eq_u32 s36, 1
  s_cselect_b32 s56, 0, 1
  v_mov_b32 v40, -1
  v_mov_b32 v41, -1
  v_mov_b32 v42, -1
  v_mov_b32 v43, -1
  v_lshl_or_b32 v44, v45, 16, v44
  v_lshl_or_b32 v46, v47, 16, v46
  v_min_u32 v44, -2, v44
  v_min_u32 v46, -2, v46
  s_cmp_eq_u32 s13, 0
  s_cselect_b32 s36, 0, -1
  v_or_b32 v44, s36, v44
  v_or_b32 v46, s36, v46
  s_lshl_b32 s36, s13, 13
  s_add_u32 s36, s36, 145752064
  s_add_u32 s37, s36, 4096
  s_cmp_lg_u32 s56, 0
  s_cbranch_scc1 T_initg_57
  buffer_store_dwordx4 v[40:43], v3, s[4:7], s22 offen
  buffer_store_dwordx4 v[40:43], v3, s[4:7], s23 offen
  buffer_store_dword v44, v8, s[4:7], s36 offen
  buffer_store_dword v46, v8, s[4:7], s37 offen
  s_branch T_initd_58
T_initg_57:
  buffer_store_dwordx4 v[40:43], v3, s[4:7], s22 offen sc1
  buffer_store_dwordx4 v[40:43], v3, s[4:7], s23 offen sc1
  buffer_store_dword v44, v8, s[4:7], s36 offen sc1
  buffer_store_dword v46, v8, s[4:7], s37 offen sc1
T_initd_58:
  s_waitcnt vmcnt(32)
  ds_read_b64_tr_b16 a[80:81], v27 offset:20480
  ds_read_b64_tr_b16 a[82:83], v27 offset:20544
  ds_read_b64_tr_b16 a[84:85], v27 offset:21504
  ds_read_b64_tr_b16 a[86:87], v27 offset:21568
  ds_read_b64_tr_b16 a[88:89], v27 offset:22528
  ds_read_b64_tr_b16 a[90:91], v27 offset:22592
  ds_read_b64_tr_b16 a[92:93], v27 offset:23552
  ds_read_b64_tr_b16 a[94:95], v27 offset:23616
  s_waitcnt lgkmcnt(0)
  s_xor_b32 s36, s13, 1
  s_lshl_b32 s36, s36, 15
  s_add_u32 m0, s39, 20480
  s_add_u32 s37, s36, 512
  buffer_load_dwordx4 v26, s[48:51], s37 offen lds
  s_add_u32 m0, s39, 21504
  s_add_u32 s37, s36, 8704
  buffer_load_dwordx4 v26, s[48:51], s37 offen lds
  s_add_u32 m0, s39, 22528
  s_add_u32 s37, s36, 16896
  buffer_load_dwordx4 v26, s[48:51], s37 offen lds
  s_add_u32 m0, s39, 23552
  s_add_u32 s37, s36, 25088
  buffer_load_dwordx4 v26, s[48:51], s37 offen lds
  s_waitcnt vmcnt(32)
  ds_read_b64_tr_b16 a[96:97], v27 offset:24576
  ds_read_b64_tr_b16 a[98:99], v27 offset:24640
  ds_read_b64_tr_b16 a[100:101], v27 offset:25600
  ds_read_b64_tr_b16 a[102:103], v27 offset:25664
  ds_read_b64_tr_b16 a[104:105], v27 offset:26624
  ds_read_b64_tr_b16 a[106:107], v27 offset:26688
  ds_read_b64_tr_b16 a[108:109], v27 offset:27648
  ds_read_b64_tr_b16 a[110:111], v27 offset:27712
  s_waitcnt lgkmcnt(0)
  s_xor_b32 s36, s13, 2
  s_lshl_b32 s36, s36, 15
  s_add_u32 m0, s39, 24576
  s_add_u32 s37, s36, 0
  buffer_load_dwordx4 v26, s[48:51], s37 offen lds
  s_add_u32 m0, s39, 25600
  s_add_u32 s37, s36, 8192
  buffer_load_dwordx4 v26, s[48:51], s37 offen lds
  s_add_u32 m0, s39, 26624
  s_add_u32 s37, s36, 16384
  buffer_load_dwordx4 v26, s[48:51], s37 offen lds
  s_add_u32 m0, s39, 27648
  s_add_u32 s37, s36, 24576
  buffer_load_dwordx4 v26, s[48:51], s37 offen lds
  s_waitcnt vmcnt(32)
  ds_read_b64_tr_b16 a[112:113], v27 offset:28672
  ds_read_b64_tr_b16 a[114:115], v27 offset:28736
  ds_read_b64_tr_b16 a[116:117], v27 offset:29696
  ds_read_b64_tr_b16 a[118:119], v27 offset:29760
  ds_read_b64_tr_b16 a[120:121], v27 offset:30720
  ds_read_b64_tr_b16 a[122:123], v27 offset:30784
  ds_read_b64_tr_b16 a[124:125], v27 offset:31744
  ds_read_b64_tr_b16 a[126:127], v27 offset:31808
  s_waitcnt lgkmcnt(0)
  s_xor_b32 s36, s13, 3
  s_lshl_b32 s36, s36, 15
  s_add_u32 m0, s39, 28672
  s_add_u32 s37, s36, 0
  buffer_load_dwordx4 v26, s[48:51], s37 offen lds
  s_add_u32 m0, s39, 29696
  s_add_u32 s37, s36, 8192
  buffer_load_dwordx4 v26, s[48:51], s37 offen lds
  s_add_u32 m0, s39, 30720
  s_add_u32 s37, s36, 16384
  buffer_load_dwordx4 v26, s[48:51], s37 offen lds
  s_add_u32 m0, s39, 31744
  s_add_u32 s37, s36, 24576
  buffer_load_dwordx4 v26, s[48:51], s37 offen lds
  s_waitcnt vmcnt(32)
  ds_read_b64_tr_b16 a[128:129], v27 offset:0
  ds_read_b64_tr_b16 a[130:131], v27 offset:64
  ds_read_b64_tr_b16 a[132:133], v27 offset:1024
  ds_read_b64_tr_b16 a[134:135], v27 offset:1088
  ds_read_b64_tr_b16 a[136:137], v27 offset:2048
  ds_read_b64_tr_b16 a[138:139], v27 offset:2112
  ds_read_b64_tr_b16 a[140:141], v27 offset:3072
  ds_read_b64_tr_b16 a[142:143], v27 offset:3136
  s_waitcnt lgkmcnt(0)
  s_add_u32 m0, s39, 0
  s_mov_b32 s37, 0
  buffer_load_dwordx4 v25, s[8:11], s37 offen lds
  s_add_u32 m0, s39, 1024
  s_mov_b32 s37, 131072
  buffer_load_dwordx4 v25, s[8:11], s37 offen lds
  s_add_u32 m0, s39, 2048
  s_mov_b32 s37, 0
  buffer_load_dwordx4 v25, s[40:43], s37 offen lds
  s_add_u32 m0, s39, 3072
  s_mov_b32 s37, 131072
  buffer_load_dwordx4 v25, s[40:43], s37 offen lds
  s_waitcnt vmcnt(32)
  ds_read_b64_tr_b16 a[144:145], v27 offset:4096
  ds_read_b64_tr_b16 a[146:147], v27 offset:4160
  ds_read_b64_tr_b16 a[148:149], v27 offset:5120
  ds_read_b64_tr_b16 a[150:151], v27 offset:5184
  ds_read_b64_tr_b16 a[152:153], v27 offset:6144
  ds_read_b64_tr_b16 a[154:155], v27 offset:6208
  ds_read_b64_tr_b16 a[156:157], v27 offset:7168
  ds_read_b64_tr_b16 a[158:159], v27 offset:7232
  s_waitcnt lgkmcnt(0)
  s_add_u32 m0, s39, 4096
  s_mov_b32 s37, 0
  buffer_load_dwordx4 v25, s[44:47], s37 offen lds
  s_add_u32 m0, s39, 5120
  s_mov_b32 s37, 131072
  buffer_load_dwordx4 v25, s[44:47], s37 offen lds
  s_add_u32 m0, s39, 6144
  s_mov_b32 s37, 262144
  buffer_load_dwordx4 v25, s[8:11], s37 offen lds
  s_add_u32 m0, s39, 7168
  s_mov_b32 s37, 393216
  buffer_load_dwordx4 v25, s[8:11], s37 offen lds
  s_waitcnt vmcnt(32)
  ds_read_b64_tr_b16 a[160:161], v28 offset:8192
  ds_read_b64_tr_b16 a[162:163], v28 offset:8448
  ds_read_b64_tr_b16 a[164:165], v28 offset:9216
  ds_read_b64_tr_b16 a[166:167], v28 offset:9472
  ds_read_b64_tr_b16 a[168:169], v28 offset:8200
  ds_read_b64_tr_b16 a[170:171], v28 offset:8456
  ds_read_b64_tr_b16 a[172:173], v28 offset:9224
  ds_read_b64_tr_b16 a[174:175], v28 offset:9480
  s_waitcnt lgkmcnt(0)
  s_add_u32 m0, s39, 8192
  s_mov_b32 s37, 262144
  buffer_load_dwordx4 v25, s[40:43], s37 offen lds
  s_add_u32 m0, s39, 9216
  s_mov_b32 s37, 393216
  buffer_load_dwordx4 v25, s[40:43], s37 offen lds
  s_add_u32 m0, s39, 10240
  s_mov_b32 s37, 262144
  buffer_load_dwordx4 v25, s[44:47], s37 offen lds
  s_add_u32 m0, s39, 11264
  s_mov_b32 s37, 393216
  buffer_load_dwordx4 v25, s[44:47], s37 offen lds
  s_waitcnt vmcnt(32)
  ds_read_b64_tr_b16 a[176:177], v28 offset:12288
  ds_read_b64_tr_b16 a[178:179], v28 offset:12544
  ds_read_b64_tr_b16 a[180:181], v28 offset:13312
  ds_read_b64_tr_b16 a[182:183], v28 offset:13568
  ds_read_b64_tr_b16 a[184:185], v28 offset:12296
  ds_read_b64_tr_b16 a[186:187], v28 offset:12552
  ds_read_b64_tr_b16 a[188:189], v28 offset:13320
  ds_read_b64_tr_b16 a[190:191], v28 offset:13576
  s_waitcnt lgkmcnt(0)
  s_add_u32 m0, s39, 12288
  s_mov_b32 s37, 786432
  buffer_load_dwordx4 v25, s[44:47], s37 offen lds
  s_add_u32 m0, s39, 13312
  s_mov_b32 s37, 917504
  buffer_load_dwordx4 v25, s[44:47], s37 offen lds
  s_add_u32 m0, s39, 14336
  s_mov_b32 s37, 1310720
  buffer_load_dwordx4 v25, s[44:47], s37 offen lds
  s_add_u32 m0, s39, 15360
  s_mov_b32 s37, 1441792
  buffer_load_dwordx4 v25, s[44:47], s37 offen lds
  s_waitcnt vmcnt(32)
  ds_read_b64_tr_b16 a[192:193], v28 offset:16384
  ds_read_b64_tr_b16 a[194:195], v28 offset:16640
  ds_read_b64_tr_b16 a[196:197], v28 offset:17408
  ds_read_b64_tr_b16 a[198:199], v28 offset:17664
  ds_read_b64_tr_b16 a[200:201], v28 offset:16392
  ds_read_b64_tr_b16 a[202:203], v28 offset:16648
  ds_read_b64_tr_b16 a[204:205], v28 offset:17416
  ds_read_b64_tr_b16 a[206:207], v28 offset:17672
  s_waitcnt lgkmcnt(0)
  s_add_u32 m0, s39, 16384
  s_mov_b32 s37, 1572864
  buffer_load_dwordx4 v25, s[40:43], s37 offen lds
  s_add_u32 m0, s39, 17408
  s_mov_b32 s37, 1703936
  buffer_load_dwordx4 v25, s[40:43], s37 offen lds
  s_add_u32 m0, s39, 18432
  s_mov_b32 s37, 2359296
  buffer_load_dwordx4 v25, s[40:43], s37 offen lds
  s_add_u32 m0, s39, 19456
  s_mov_b32 s37, 2490368
  buffer_load_dwordx4 v25, s[40:43], s37 offen lds
  s_waitcnt vmcnt(28)
  ds_read_b64_tr_b16 a[208:209], v28 offset:20480
  ds_read_b64_tr_b16 a[210:211], v28 offset:20736
  ds_read_b64_tr_b16 a[212:213], v28 offset:21504
  ds_read_b64_tr_b16 a[214:215], v28 offset:21760
  ds_read_b64_tr_b16 a[216:217], v28 offset:20488
  ds_read_b64_tr_b16 a[218:219], v28 offset:20744
  ds_read_b64_tr_b16 a[220:221], v28 offset:21512
  ds_read_b64_tr_b16 a[222:223], v28 offset:21768
  s_waitcnt lgkmcnt(0)
  s_add_u32 m0, s39, 20480
  s_mov_b32 s37, 3407872
  buffer_load_dwordx4 v25, s[40:43], s37 offen lds
  s_add_u32 m0, s39, 21504
  s_mov_b32 s37, 3538944
  buffer_load_dwordx4 v25, s[40:43], s37 offen lds
  s_add_u32 m0, s39, 22528
  s_mov_b32 s37, 1572864
  buffer_load_dwordx4 v25, s[44:47], s37 offen lds
  s_add_u32 m0, s39, 23552
  s_mov_b32 s37, 1703936
  buffer_load_dwordx4 v25, s[44:47], s37 offen lds
  s_barrier
  s_cmp_lg_u32 s13, 0
  s_cbranch_scc1 T_arm_59
  s_mov_b32 s36, 1
  s_atomic_add s36, s[52:53], 8 glc
  s_waitcnt lgkmcnt(0)
T_arm_59:
  s_waitcnt vmcnt(28)
  ds_read_b64_tr_b16 a[224:225], v28 offset:24576
  ds_read_b64_tr_b16 a[226:227], v28 offset:24832
  ds_read_b64_tr_b16 a[228:229], v28 offset:25600
  ds_read_b64_tr_b16 a[230:231], v28 offset:25856
  ds_read_b64_tr_b16 a[232:233], v28 offset:24584
  ds_read_b64_tr_b16 a[234:235], v28 offset:24840
  ds_read_b64_tr_b16 a[236:237], v28 offset:25608
  ds_read_b64_tr_b16 a[238:239], v28 offset:25864
  s_waitcnt lgkmcnt(0)
  s_xor_b32 s36, s13, 2
  s_lshl_b32 s36, s36, 15
  s_add_u32 m0, s39, 24576
  s_add_u32 s37, s36, 512
  buffer_load_dwordx4 v26, s[48:51], s37 offen lds
  s_add_u32 m0, s39, 25600
  s_add_u32 s37, s36, 8704
  buffer_load_dwordx4 v26, s[48:51], s37 offen lds
  s_add_u32 m0, s39, 26624
  s_add_u32 s37, s36, 16896
  buffer_load_dwordx4 v26, s[48:51], s37 offen lds
  s_add_u32 m0, s39, 27648
  s_add_u32 s37, s36, 25088
  buffer_load_dwordx4 v26, s[48:51], s37 offen lds
  s_waitcnt vmcnt(28)
  ds_read_b64_tr_b16 a[240:241], v28 offset:28672
  ds_read_b64_tr_b16 a[242:243], v28 offset:28928
  ds_read_b64_tr_b16 a[244:245], v28 offset:29696
  ds_read_b64_tr_b16 a[246:247], v28 offset:29952
  ds_read_b64_tr_b16 a[248:249], v28 offset:28680
  ds_read_b64_tr_b16 a[250:251], v28 offset:28936
  ds_read_b64_tr_b16 a[252:253], v28 offset:29704
  ds_read_b64_tr_b16 a[254:255], v28 offset:29960
  s_waitcnt lgkmcnt(0)
  s_xor_b32 s36, s13, 3
  s_lshl_b32 s36, s36, 15
  s_add_u32 m0, s39, 28672
  s_add_u32 s37, s36, 512
  buffer_load_dwordx4 v26, s[48:51], s37 offen lds
  s_add_u32 m0, s39, 29696
  s_add_u32 s37, s36, 8704
  buffer_load_dwordx4 v26, s[48:51], s37 offen lds
  s_add_u32 m0, s39, 30720
  s_add_u32 s37, s36, 16896
  buffer_load_dwordx4 v26, s[48:51], s37 offen lds
  s_add_u32 m0, s39, 31744
  s_add_u32 s37, s36, 25088
  buffer_load_dwordx4 v26, s[48:51], s37 offen lds
  s_mov_b32 s19, 0
T_spin_60:
  s_add_u32 s19, s19, 1
  s_cmp_gt_u32 s19, 32768
  s_cbranch_scc1 M_exit
  s_mov_b32 s36, 0
  s_atomic_or s36, s[52:53], 128 glc
  s_waitcnt lgkmcnt(0)
  s_cmp_lt_u32 s36, 256
  s_cbranch_scc1 T_spin_60
  s_mov_b32 s14, -1
  s_mov_b32 s19, 0
T_kv_61:
  s_add_u32 s19, s19, 1
  s_cmp_gt_u32 s19, 32768
  s_cbranch_scc1 M_exit
  s_mul_i32 s38, s12, 896
  s_add_u32 s39, s38, 148898560
  s_add_u32 s38, s38, 148898048
  s_mov_b32 s30, 0
  s_mov_b32 s37, 0
  s_atomic_or s30, s[58:59], s38 glc
  s_atomic_or s37, s[58:59], s39 glc
  s_waitcnt lgkmcnt(0)
  s_add_u32 s37, s37, 28
  s_cmp_ge_u32 s30, 28
  s_cselect_b32 s30, s37, s30
  s_cmp_ge_u32 s30, 64
  s_cselect_b32 s30, 100, s30
  s_sub_u32 s30, s30, 1
  s_cmp_ge_i32 s14, s30
  s_cbranch_scc1 T_kv_61
  s_mov_b32 m0, s31
  s_nop 0
  buffer_load_dwordx4 v9, s[4:7], s27 offen sc1 lds
  s_mov_b32 m0, s32
  s_nop 0
  buffer_load_dwordx4 v9, s[4:7], s27 offen offset:128 sc1 lds
  s_mov_b32 m0, s33
  s_nop 0
  buffer_load_dwordx4 v10, s[4:7], s28 offen sc1 lds
  s_mov_b32 m0, s34
  s_nop 0
  buffer_load_dwordx4 v10, s[4:7], s28 offen offset:256 sc1 lds
  s_add_u32 s27, s27, 8192
  s_add_u32 s28, s28, 8192
  s_waitcnt vmcnt(32)
  ds_read_b64_tr_b16 v[64:65], v27 offset:0
  ds_read_b64_tr_b16 v[66:67], v27 offset:64
  ds_read_b64_tr_b16 v[68:69], v27 offset:1024
  ds_read_b64_tr_b16 v[70:71], v27 offset:1088
  ds_read_b64_tr_b16 v[72:73], v27 offset:2048
  ds_read_b64_tr_b16 v[74:75], v27 offset:2112
  ds_read_b64_tr_b16 v[76:77], v27 offset:3072
  ds_read_b64_tr_b16 v[78:79], v27 offset:3136
  s_waitcnt lgkmcnt(0)
  ds_write_b128 v4, v[64:67] offset:0
  ds_write_b128 v4, v[68:71] offset:1024
  ds_write_b128 v4, v[72:75] offset:2048
  ds_write_b128 v4, v[76:79] offset:3072
  s_waitcnt lgkmcnt(0)
  s_waitcnt vmcnt(28)
  ds_read_b64_tr_b16 v[64:65], v27 offset:4096
  ds_read_b64_tr_b16 v[66:67], v27 offset:4160
  ds_read_b64_tr_b16 v[68:69], v27 offset:5120
  ds_read_b64_tr_b16 v[70:71], v27 offset:5184
  ds_read_b64_tr_b16 v[72:73], v27 offset:6144
  ds_read_b64_tr_b16 v[74:75], v27 offset:6208
  ds_read_b64_tr_b16 v[76:77], v27 offset:7168
  ds_read_b64_tr_b16 v[78:79], v27 offset:7232
  s_waitcnt lgkmcnt(0)
  ds_write_b128 v4, v[64:67] offset:4096
  ds_write_b128 v4, v[68:71] offset:5120
  ds_write_b128 v4, v[72:75] offset:6144
  ds_write_b128 v4, v[76:79] offset:7168
  s_waitcnt lgkmcnt(0)
  s_waitcnt vmcnt(24)
  ds_read_b64_tr_b16 v[64:65], v27 offset:8192
  ds_read_b64_tr_b16 v[66:67], v27 offset:8256
  ds_read_b64_tr_b16 v[68:69], v27 offset:9216
  ds_read_b64_tr_b16 v[70:71], v27 offset:9280
  ds_read_b64_tr_b16 v[72:73], v27 offset:10240
  ds_read_b64_tr_b16 v[74:75], v27 offset:10304
  ds_read_b64_tr_b16 v[76:77], v27 offset:11264
  ds_read_b64_tr_b16 v[78:79], v27 offset:11328
  s_waitcnt lgkmcnt(0)
  ds_write_b128 v4, v[64:67] offset:8192
  ds_write_b128 v4, v[68:71] offset:9216
  ds_write_b128 v4, v[72:75] offset:10240
  ds_write_b128 v4, v[76:79] offset:11264
  s_waitcnt lgkmcnt(0)
  s_waitcnt vmcnt(20)
  ds_read_b64_tr_b16 v[64:65], v27 offset:12288
  ds_read_b64_tr_b16 v[66:67], v27 offset:12352
  ds_read_b64_tr_b16 v[68:69], v27 offset:13312
  ds_read_b64_tr_b16 v[70:71], v27 offset:13376
  ds_read_b64_tr_b16 v[72:73], v27 offset:14336
  ds_read_b64_tr_b16 v[74:75], v27 offset:14400
  ds_read_b64_tr_b16 v[76:77], v27 offset:15360
  ds_read_b64_tr_b16 v[78:79], v27 offset:15424
  s_waitcnt lgkmcnt(0)
  ds_write_b128 v4, v[64:67] offset:12288
  ds_write_b128 v4, v[68:71] offset:13312
  ds_write_b128 v4, v[72:75] offset:14336
  ds_write_b128 v4, v[76:79] offset:15360
  s_waitcnt lgkmcnt(0)
  s_waitcnt vmcnt(16)
  ds_read_b64_tr_b16 v[64:65], v27 offset:16384
  ds_read_b64_tr_b16 v[66:67], v27 offset:16448
  ds_read_b64_tr_b16 v[68:69], v27 offset:17408
  ds_read_b64_tr_b16 v[70:71], v27 offset:17472
  ds_read_b64_tr_b16 v[72:73], v27 offset:18432
  ds_read_b64_tr_b16 v[74:75], v27 offset:18496
  ds_read_b64_tr_b16 v[76:77], v27 offset:19456
  ds_read_b64_tr_b16 v[78:79], v27 offset:19520
  s_waitcnt lgkmcnt(0)
  ds_write_b128 v4, v[64:67] offset:16384
  ds_write_b128 v4, v[68:71] offset:17408
  ds_write_b128 v4, v[72:75] offset:18432
  ds_write_b128 v4, v[76:79] offset:19456
  s_waitcnt lgkmcnt(0)
  s_waitcnt vmcnt(12)
  ds_read_b64_tr_b16 v[64:65], v27 offset:20480
  ds_read_b64_tr_b16 v[66:67], v27 offset:20544
  ds_read_b64_tr_b16 v[68:69], v27 offset:21504
  ds_read_b64_tr_b16 v[70:71], v27 offset:21568
  ds_read_b64_tr_b16 v[72:73], v27 offset:22528
  ds_read_b64_tr_b16 v[74:75], v27 offset:22592
  ds_read_b64_tr_b16 v[76:77], v27 offset:23552
  ds_read_b64_tr_b16 v[78:79], v27 offset:23616
  s_waitcnt lgkmcnt(0)
  ds_write_b128 v4, v[64:67] offset:20480
  ds_write_b128 v4, v[68:71] offset:21504
  ds_write_b128 v4, v[72:75] offset:22528
  ds_write_b128 v4, v[76:79] offset:23552
  s_waitcnt lgkmcnt(0)
  s_mov_b32 s19, 0
T_spin_63:
  s_add_u32 s19, s19, 1
  s_cmp_gt_u32 s19, 32768
  s_cbranch_scc1 M_exit
  s_mov_b32 s36, 0
  s_atomic_or s36, s[52:53], 8 glc
  s_waitcnt lgkmcnt(0)
  s_cmp_lt_u32 s36, 32
  s_cbranch_scc1 T_spin_63
  s_waitcnt vmcnt(8)
  ds_read_b64_tr_b16 v[64:65], v28 offset:24576
  ds_read_b64_tr_b16 v[66:67], v28 offset:24832
  ds_read_b64_tr_b16 v[68:69], v28 offset:25600
  ds_read_b64_tr_b16 v[70:71], v28 offset:25856
  ds_read_b64_tr_b16 v[72:73], v28 offset:24584
  ds_read_b64_tr_b16 v[74:75], v28 offset:24840
  ds_read_b64_tr_b16 v[76:77], v28 offset:25608
  ds_read_b64_tr_b16 v[78:79], v28 offset:25864
  s_waitcnt lgkmcnt(0)
  ds_write_b128 v4, v[64:67] offset:24576
  ds_write_b128 v4, v[68:71] offset:25600
  ds_write_b128 v4, v[72:75] offset:26624
  ds_write_b128 v4, v[76:79] offset:27648
  s_waitcnt lgkmcnt(0)
  s_waitcnt vmcnt(4)
  ds_read_b64_tr_b16 v[64:65], v28 offset:28672
  ds_read_b64_tr_b16 v[66:67], v28 offset:28928
  ds_read_b64_tr_b16 v[68:69], v28 offset:29696
  ds_read_b64_tr_b16 v[70:71], v28 offset:29952
  ds_read_b64_tr_b16 v[72:73], v28 offset:28680
  ds_read_b64_tr_b16 v[74:75], v28 offset:28936
  ds_read_b64_tr_b16 v[76:77], v28 offset:29704
  ds_read_b64_tr_b16 v[78:79], v28 offset:29960
  s_waitcnt lgkmcnt(0)
  ds_write_b128 v4, v[64:67] offset:28672
  ds_write_b128 v4, v[68:71] offset:29696
  ds_write_b128 v4, v[72:75] offset:30720
  ds_write_b128 v4, v[76:79] offset:31744
  s_waitcnt lgkmcnt(0)
  s_waitcnt vmcnt(0) lgkmcnt(0)
  s_barrier
  ds_read_b128 v[68:71], v4 offset:0
  ds_read_b128 v[72:75], v4 offset:1024
  ds_read_b128 v[76:79], v4 offset:2048
  ds_read_b128 v[80:83], v4 offset:3072
  ds_read_b128 v[84:87], v4 offset:4096
  ds_read_b128 v[88:91], v4 offset:5120
  ds_read_b128 v[92:95], v4 offset:6144
  ds_read_b128 v[96:99], v4 offset:7168
  ds_read_b128 v[100:103], v4 offset:8192
  ds_read_b128 v[104:107], v4 offset:9216
  ds_read_b128 v[108:111], v4 offset:10240
  ds_read_b128 v[112:115], v4 offset:11264
  ds_read_b128 v[28:31], v3 offset:16384
  ds_read_b128 v[32:35], v3 offset:20480
  ds_read_b128 v[36:39], v2 offset:8192
  ds_read_b128 v[40:43], v2 offset:9216
  ds_read_b128 v[44:47], v2 offset:10240
  ds_read_b128 v[48:51], v2 offset:11264
  ds_read_b128 v[52:55], v2 offset:12288
  ds_read_b128 v[56:59], v2 offset:13312
  ds_read_b128 v[60:63], v2 offset:14336
  ds_read_b128 v[64:67], v2 offset:15360
  s_and_b32 s36, s13, 1
  s_lshl_b32 s36, s36, 12
  s_add_u32 s22, s22, s36
  s_add_u32 s23, s36, 145752064
  s_mov_b32 s14, -1
  s_and_b32 s57, s14, 1
  s_and_b32 s36, s14, 3
  s_lshl_b32 s36, s36, 13
  s_add_u32 s26, s36, s23
  s_add_u32 s36, s36, 8192
  s_and_b32 s36, s36, 0x7fff
  s_add_u32 s24, s36, 145752064
  s_add_u32 s25, s36, 145756160
  s_add_u32 s35, s36, s23
  s_waitcnt lgkmcnt(0)
  s_cmp_lg_u32 s56, 0
  s_cbranch_scc1 M_global
  s_mov_b32 s19, 0
  v_mov_b64 v[16:17], 0
  v_mov_b64 v[18:19], 0
  v_mov_b64 v[20:21], 0
  v_mov_b64 v[22:23], 0
  v_mov_b64 v[24:25], 0
  v_mov_b64 v[26:27], 0
  buffer_load_dwordx4 v[124:127], v3, s[4:7], s24 offen sc1
  buffer_load_dwordx4 v[124:127], v3, s[4:7], s24 offen sc1
  buffer_load_dwordx4 v[124:127], v3, s[4:7], s24 offen sc1
  s_branch T_loop_64
.p2align 6
T_retry_65:
  s_mov_b64 exec, vcc
  buffer_load_dwordx4 v[124:127], v3, s[4:7], s24 offen sc1
  s_mov_b64 exec, -1
  s_add_u32 s19, s19, 1
  s_cmp_gt_u32 s19, 32768
  s_cbranch_scc1 M_exit
T_loop_64:
  s_waitcnt vmcnt(2)
  v_max3_u32 v122, v124, v125, v126
  v_max_u32 v122, v122, v127
  v_cmp_eq_u32 vcc, -1, v122
  s_cbranch_vccnz T_retry_65
  ds_write_b128 v3, v[124:127] offset:0
  buffer_load_dwordx4 v[12:15], v3, s[4:7], s25 offen sc1
  s_add_u32 s14, s14, 1
  s_waitcnt lgkmcnt(0)
  s_barrier
  ds_read_b128 v[116:119], v1 offset:0
  ds_read_b128 v[120:123], v1 offset:512
  s_waitcnt lgkmcnt(1)
  v_smfmac_f32_16x16x64_bf16 v[16:19], v[116:119], v[68:75], v0
  ds_read_b128 v[68:71], v4 offset:12288
  v_smfmac_f32_16x16x64_bf16 v[20:23], v[116:119], v[76:83], v0
  s_waitcnt vmcnt(1)
  ds_read_b128 v[124:127], v1 offset:1024
  v_smfmac_f32_16x16x64_bf16 v[24:27], v[116:119], v[84:91], v0
  s_waitcnt lgkmcnt(2)
  ds_read_b128 v[84:87], v1 offset:1536
  v_smfmac_f32_16x16x64_bf16 v[16:19], v[120:123], v[92:99], v0
  s_waitcnt vmcnt(0)
  ds_read_b128 v[72:75], v4 offset:13312
  v_max3_u32 v92, v12, v13, v14
  v_smfmac_f32_16x16x64_bf16 v[20:23], v[120:123], v[100:107], v0
  ds_read_b128 v[88:91], v1 offset:2048
  v_max_u32 v92, v92, v15
  v_smfmac_f32_16x16x64_bf16 v[24:27], v[120:123], v[108:115], v0
  s_waitcnt lgkmcnt(3)
  ds_read_b128 v[116:119], v1 offset:2560
  v_cmp_eq_u32 vcc, -1, v92
  v_smfmac_f32_16x16x64_bf16 v[16:19], v[124:127], v[128:135], v0
  s_cbranch_vccnz T_late_66
T_lateok_67:
  ds_write_b64 v3, v[12:13] offset:4096
  v_smfmac_f32_16x16x64_bf16 v[20:23], v[124:127], v[136:143], v0
  s_and_b32 s57, s14, 1
  s_and_b32 s36, s14, 3
  s_lshl_b32 s36, s36, 13
  v_smfmac_f32_16x16x64_bf16 v[24:27], v[124:127], v[144:151], v0
  s_waitcnt lgkmcnt(4)
  ds_write_b64 v3, v[14:15] offset:4104
  s_add_u32 s26, s36, s23
  v_smfmac_f32_16x16x64_bf16 v[16:19], v[84:87], v[152:159], v0
  s_add_u32 s36, s36, 8192
  ds_read_b128 v[76:79], v4 offset:14336
  s_and_b32 s36, s36, 0x7fff
  v_smfmac_f32_16x16x64_bf16 v[20:23], v[84:87], v[160:167], v0
  s_waitcnt lgkmcnt(5)
  ds_read_b128 v[80:83], v4 offset:15360
  s_mov_b32 m0, s31
  v_smfmac_f32_16x16x64_bf16 v[24:27], v[84:87], v[68:75], v0
  s_waitcnt lgkmcnt(5)
  ds_read_b128 v[92:95], v1 offset:3072
  s_cmp_ge_i32 s14, s30
  v_smfmac_f32_16x16x64_bf16 v[16:19], v[88:91], v[168:175], v0
  s_cbranch_scc1 T_kvw_68
T_kvb_69:
  ds_read_b128 v[96:99], v1 offset:3584
  v_smfmac_f32_16x16x64_bf16 v[20:23], v[88:91], v[176:183], v0
  s_waitcnt lgkmcnt(4)
  s_barrier
  v_smfmac_f32_16x16x64_bf16 v[24:27], v[88:91], v[184:191], v0
  ds_read_b128 v[100:103], v1 offset:4096
  v_mov_b64 v[12:13], s[2:3]
  v_smfmac_f32_16x16x64_bf16 v[16:19], v[116:119], v[192:199], v0
  ds_read_b128 v[104:107], v1 offset:4608
  v_mov_b64 v[14:15], s[2:3]
  v_smfmac_f32_16x16x64_bf16 v[20:23], v[116:119], v[200:207], v0
  s_waitcnt lgkmcnt(4)
  ds_read_b128 v[108:111], v1 offset:5120
  s_add_u32 s24, s36, 145752064
  v_smfmac_f32_16x16x64_bf16 v[24:27], v[116:119], v[76:83], v0
  s_waitcnt lgkmcnt(4)
  ds_read_b128 v[112:115], v1 offset:5632
  s_add_u32 s25, s36, 145756160
  v_smfmac_f32_16x16x64_bf16 v[16:19], v[92:95], v[208:215], v0
  s_waitcnt lgkmcnt(4)
  ds_read_b128 v[120:123], v1 offset:6144
  s_add_u32 s35, s36, s23
  v_smfmac_f32_16x16x64_bf16 v[16:19], v[96:99], v[216:223], v0
  s_waitcnt lgkmcnt(4)
  ds_read_b128 v[124:127], v1 offset:6656
  buffer_load_dwordx4 v9, s[4:7], s27 offen sc1 lds
  v_smfmac_f32_16x16x64_bf16 v[16:19], v[100:103], v[240:247], v0
  s_waitcnt lgkmcnt(4)
  ds_read_b128 v[84:87], v1 offset:7168
  v_mov_b32 v118, s14
  v_smfmac_f32_16x16x64_bf16 v[16:19], v[104:107], a[8:15], v0
  s_waitcnt lgkmcnt(4)
  ds_read_b128 v[88:91], v1 offset:7680
  s_mov_b32 m0, s32
  v_smfmac_f32_16x16x64_bf16 v[16:19], v[108:111], a[24:31], v0
  s_waitcnt lgkmcnt(4)
  ds_read_b128 v[68:71], v4 offset:16384
  v_min_u32 v119, 1, v3
  v_smfmac_f32_16x16x64_bf16 v[16:19], v[112:115], a[48:55], v0
  s_waitcnt lgkmcnt(4)
  ds_read_b128 v[72:75], v4 offset:17408
  v_lshlrev_b32 v119, 30, v119
  v_smfmac_f32_16x16x64_bf16 v[16:19], v[120:123], a[72:79], v0
  s_waitcnt lgkmcnt(4)
  ds_read_b128 v[76:79], v4 offset:18432
  v_smfmac_f32_16x16x64_bf16 v[16:19], v[124:127], a[96:103], v0
  s_waitcnt lgkmcnt(4)
  buffer_load_dwordx4 v9, s[4:7], s27 offen offset:128 sc1 lds
  v_smfmac_f32_16x16x64_bf16 v[16:19], v[84:87], a[112:119], v0
  s_waitcnt lgkmcnt(3)
  ds_read_b128 v[80:83], v4 offset:19456
  v_smfmac_f32_16x16x64_bf16 v[16:19], v[88:91], a[136:143], v0
  s_waitcnt lgkmcnt(2)
  buffer_store_dword v118, v119, s[4:7], s15 offen sc1
  s_mov_b32 m0, s33
  v_smfmac_f32_16x16x64_bf16 v[20:23], v[92:95], v[68:75], v0
  ds_read_b128 v[68:71], v4 offset:20480
  v_smfmac_f32_16x16x64_bf16 v[20:23], v[96:99], v[224:231], v0
  buffer_load_dwordx4 v10, s[4:7], s28 offen sc1 lds
  s_mov_b32 m0, s34
  v_smfmac_f32_16x16x64_bf16 v[20:23], v[100:103], v[248:255], v0
  s_waitcnt lgkmcnt(1)
  ds_read_b128 v[72:75], v4 offset:21504
  v_mul_f32 v16, s18, v16
  v_smfmac_f32_16x16x64_bf16 v[20:23], v[104:107], v[76:83], v0
  ds_read_b128 v[76:79], v4 offset:22528
  v_mul_f32 v17, s18, v17
  v_smfmac_f32_16x16x64_bf16 v[20:23], v[108:111], a[32:39], v0
  ds_read_b128 v[80:83], v4 offset:23552
  v_mul_f32 v18, s18, v18
  v_smfmac_f32_16x16x64_bf16 v[20:23], v[112:115], a[56:63], v0
  buffer_load_dwordx4 v10, s[4:7], s28 offen offset:256 sc1 lds
  v_mul_f32 v19, s18, v19
  v_smfmac_f32_16x16x64_bf16 v[20:23], v[120:123], a[80:87], v0
  s_waitcnt lgkmcnt(2)
  v_cvt_pk_bf16_f32 v116, v16, v17
  v_smfmac_f32_16x16x64_bf16 v[20:23], v[124:127], v[68:75], v0
  v_cvt_pk_bf16_f32 v117, v18, v19
  v_smfmac_f32_16x16x64_bf16 v[20:23], v[84:87], a[120:127], v0
  ds_write_b64 v5, v[116:117] offset:24576
  v_smfmac_f32_16x16x64_bf16 v[20:23], v[88:91], a[144:151], v0
  s_waitcnt lgkmcnt(1)
  s_add_u32 s27, s27, 8192
  s_add_u32 s28, s28, 8192
  v_smfmac_f32_16x16x64_bf16 v[24:27], v[92:95], v[76:83], v0
  v_smfmac_f32_16x16x64_bf16 v[24:27], v[96:99], v[232:239], v0
  s_nop 1
  v_cvt_pk_bf16_f32 v118, v20, v21
  v_cvt_pk_bf16_f32 v119, v22, v23
  v_smfmac_f32_16x16x64_bf16 v[24:27], v[100:103], a[0:7], v0
  ds_write_b64 v5, v[118:119] offset:26880
  buffer_store_dwordx2 v[118:119], v5, s[4:7], s29 offen sc1
  v_smfmac_f32_16x16x64_bf16 v[24:27], v[104:107], a[16:23], v0
  s_waitcnt lgkmcnt(1)
  s_barrier
  ds_read_b64_tr_b16 v[68:69], v6 offset:24576
  v_smfmac_f32_16x16x64_bf16 v[24:27], v[108:111], a[40:47], v0
  s_nop 0
  ds_read_b64_tr_b16 v[70:71], v6 offset:24640
  ds_read_b64_tr_b16 v[72:73], v6 offset:24832
  v_smfmac_f32_16x16x64_bf16 v[24:27], v[112:115], a[64:71], v0
  s_nop 0
  ds_read_b64_tr_b16 v[74:75], v6 offset:24896
  ds_read_b64_tr_b16 v[76:77], v6 offset:25088
  v_smfmac_f32_16x16x64_bf16 v[24:27], v[120:123], a[88:95], v0
  s_nop 0
  ds_read_b64_tr_b16 v[78:79], v6 offset:25152
  ds_read_b64_tr_b16 v[80:81], v6 offset:25344
  v_smfmac_f32_16x16x64_bf16 v[24:27], v[124:127], a[104:111], v0
  s_waitcnt lgkmcnt(7)
  ds_read_b64_tr_b16 v[82:83], v6 offset:25408
  s_barrier
  v_smfmac_f32_16x16x64_bf16 v[24:27], v[84:87], a[128:135], v0
  s_nop 0
  ds_read_b64_tr_b16 v[92:93], v6 offset:26880
  ds_read_b64_tr_b16 v[94:95], v6 offset:26944
  v_smfmac_f32_16x16x64_bf16 v[24:27], v[88:91], a[152:159], v0
  s_waitcnt lgkmcnt(8)
  ds_read_b64_tr_b16 v[96:97], v6 offset:27136
  ds_read_b64_tr_b16 v[98:99], v6 offset:27200
  v_mfma_f32_16x16x32_bf16 v[16:19], v[36:39], v[68:71], 0
  s_waitcnt lgkmcnt(8)
  ds_read_b64_tr_b16 v[100:101], v6 offset:27392
  ds_read_b64_tr_b16 v[102:103], v6 offset:27456
  v_mfma_f32_16x16x32_bf16 v[16:19], v[40:43], v[72:75], v[16:19]
  s_waitcnt lgkmcnt(8)
  ds_read_b64_tr_b16 v[104:105], v6 offset:27648
  ds_read_b64_tr_b16 v[106:107], v6 offset:27712
  v_mfma_f32_16x16x32_bf16 v[16:19], v[44:47], v[76:79], v[16:19]
  s_waitcnt lgkmcnt(8)
  v_cvt_pk_bf16_f32 v116, v24, v25
  v_cvt_pk_bf16_f32 v117, v26, v27
  v_mfma_f32_16x16x32_bf16 v[16:19], v[48:51], v[80:83], v[16:19]
  s_waitcnt lgkmcnt(6)
  buffer_store_dwordx2 v[116:117], v5, s[4:7], s29 offen offset:2304 sc1
  v_mov_b64 v[108:109], 0
  v_mfma_f32_16x16x32_bf16 v[120:123], v[92:95], v[68:71], 0
  s_waitcnt lgkmcnt(4)
  v_mov_b64 v[110:111], 0
  v_mov_b64 v[112:113], 0
  v_mfma_f32_16x16x32_bf16 v[120:123], v[96:99], v[72:75], v[120:123]
  s_waitcnt lgkmcnt(2)
  v_mov_b64 v[114:115], 0
  v_mov_b64 v[36:37], 0
  v_mfma_f32_16x16x32_bf16 v[120:123], v[100:103], v[76:79], v[120:123]
  s_waitcnt lgkmcnt(0)
  v_exp_f32 v124, v16
  v_mfma_f32_16x16x32_bf16 v[120:123], v[104:107], v[80:83], v[120:123]
  s_add_u32 s29, s29, 147456
  v_exp_f32 v125, v17
  v_mfma_f32_16x16x32_bf16 v[20:23], v[52:55], v[68:71], 0
  s_cmp_eq_u32 s14, 63
  v_exp_f32 v126, v18
  v_mfma_f32_16x16x32_bf16 v[20:23], v[56:59], v[72:75], v[20:23]
  s_cbranch_scc1 M_tdone
  v_exp_f32 v127, v19
  v_mfma_f32_16x16x32_bf16 v[20:23], v[60:63], v[76:79], v[20:23]
  v_cvt_pk_bf16_f32 v44, v124, v125
  v_cvt_pk_bf16_f32 v45, v126, v127
  v_mfma_f32_16x16x32_bf16 v[20:23], v[64:67], v[80:83], v[20:23]
  v_exp_f32 v124, v120
  v_exp_f32 v125, v121
  v_exp_f32 v126, v122
  v_exp_f32 v127, v123
  v_cvt_pk_bf16_f32 v84, v124, v125
  v_cvt_pk_bf16_f32 v85, v126, v127
  v_cndmask_b32 v48, v84, 0, s[16:17]
  v_cndmask_b32 v49, v85, 0, s[16:17]
  v_cndmask_b32 v50, 0, v84, s[16:17]
  v_cndmask_b32 v51, 0, v85, s[16:17]
  v_exp_f32 v124, v20
  v_mfma_f32_16x16x16_bf16 v[88:91], v[12:13], v[48:49], 0
  v_exp_f32 v125, v21
  v_mfma_f32_16x16x16_bf16 v[24:27], v[116:117], v[48:49], 0
  v_exp_f32 v126, v22
  v_mfma_f32_16x16x16_bf16 v[92:95], v[116:117], v[50:51], 0
  v_exp_f32 v127, v23
  v_cvt_pk_bf16_f32 v46, v124, v125
  v_cvt_pk_bf16_f32 v47, v126, v127
  v_mov_b64 v[38:39], 0
  v_mov_b64 v[40:41], 0
  v_mfma_f32_16x16x32_bf16 v[88:91], v[12:15], v[44:47], v[88:91]
  v_xor_b32 v86, 512, v11
  v_xor_b32 v87, 1024, v11
  v_mfma_f32_16x16x32_bf16 v[24:27], v[28:31], v[44:47], v[24:27]
  v_xor_b32 v72, 1536, v11
  v_mov_b64 v[42:43], 0
  v_mfma_f32_16x16x32_bf16 v[92:95], v[32:35], v[44:47], v[92:95]
  s_nop 1
  v_rcp_f32 v89, v88
  v_subrev_u32 v124, s54, v88
  v_cmp_le_u32 vcc, s55, v124
  s_cbranch_vccnz T_slow_70
T_back_71:
  v_mul_f32 v24, v89, v24
  v_mul_f32 v25, v89, v25
  v_mul_f32 v26, v89, v26
  v_mul_f32 v27, v89, v27
  v_cvt_pk_bf16_f32 v96, v24, v25
  v_cvt_pk_bf16_f32 v97, v26, v27
  v_pk_mul_f32 v[92:93], v[92:93], v[88:89] op_sel:[0,1] op_sel_hi:[1,1]
  v_pk_mul_f32 v[94:95], v[94:95], v[88:89] op_sel:[0,1] op_sel_hi:[1,1]
  v_cvt_pk_bf16_f32 v98, v92, v93
  v_cvt_pk_bf16_f32 v99, v94, v95
  ds_write_b128 v11, v[96:99] offset:29184
  s_nop 0
  v_smfmac_f32_16x16x64_bf16 v[108:111], v[96:99], a[160:167], v0
  ds_read_b128 v[52:55], v4 offset:24576
  v_smfmac_f32_16x16x64_bf16 v[112:115], v[96:99], a[168:175], v0
  ds_read_b128 v[56:59], v4 offset:25600
  v_smfmac_f32_16x16x64_bf16 v[36:39], v[96:99], a[176:183], v0
  v_smfmac_f32_16x16x64_bf16 v[40:43], v[96:99], a[184:191], v0
  s_waitcnt lgkmcnt(2)
  s_barrier
  ds_read_b128 v[100:103], v86 offset:29184
  ds_read_b128 v[104:107], v87 offset:29184
  ds_read_b128 v[68:71], v72 offset:29184
  s_waitcnt lgkmcnt(2)
  v_smfmac_f32_16x16x64_bf16 v[108:111], v[100:103], a[192:199], v0
  ds_read_b128 v[60:63], v4 offset:26624
  v_smfmac_f32_16x16x64_bf16 v[112:115], v[100:103], a[200:207], v0
  s_waitcnt lgkmcnt(2)
  ds_read_b128 v[64:67], v4 offset:27648
  v_smfmac_f32_16x16x64_bf16 v[108:111], v[104:107], a[224:231], v0
  ds_read_b128 v[76:79], v4 offset:28672
  v_smfmac_f32_16x16x64_bf16 v[112:115], v[104:107], a[232:239], v0
  s_waitcnt lgkmcnt(3)
  ds_read_b128 v[80:83], v4 offset:29696
  v_smfmac_f32_16x16x64_bf16 v[108:111], v[68:71], a[240:247], v0
  ds_read_b128 v[28:31], v4 offset:30720
  v_smfmac_f32_16x16x64_bf16 v[112:115], v[68:71], a[248:255], v0
  ds_read_b128 v[32:35], v4 offset:31744
  v_smfmac_f32_16x16x64_bf16 v[36:39], v[100:103], a[208:215], v0
  ds_read_b128 v[116:119], v2 offset:31232
  v_smfmac_f32_16x16x64_bf16 v[40:43], v[100:103], a[216:223], v0
  v_cvt_pk_bf16_f32 v16, v108, v109
  v_cvt_pk_bf16_f32 v17, v110, v111
  v_bfi_b32 v16, 1, s57, v16
  v_cvt_pk_bf16_f32 v18, v112, v113
  v_cvt_pk_bf16_f32 v19, v114, v115
  v_smfmac_f32_16x16x64_bf16 v[36:39], v[104:107], v[52:59], v0
  s_waitcnt lgkmcnt(5)
  buffer_store_dwordx4 v[16:19], v7, s[4:7], s20 offen
  v_smfmac_f32_16x16x64_bf16 v[40:43], v[104:107], v[60:67], v0
  s_waitcnt lgkmcnt(3)
  v_smfmac_f32_16x16x64_bf16 v[36:39], v[68:71], v[76:83], v0
  s_waitcnt lgkmcnt(1)
  v_smfmac_f32_16x16x64_bf16 v[40:43], v[68:71], v[28:35], v0
  s_nop 4
  v_cvt_pk_bf16_f32 v20, v36, v37
  v_cvt_pk_bf16_f32 v21, v38, v39
  v_bfi_b32 v20, 1, s57, v20
  v_cvt_pk_bf16_f32 v22, v40, v41
  v_cvt_pk_bf16_f32 v23, v42, v43
  buffer_store_dwordx4 v[20:23], v7, s[4:7], s21 offen
  ds_read_b128 v[68:71], v4 offset:0
  ds_read_b128 v[72:75], v4 offset:1024
  ds_read_b128 v[76:79], v4 offset:2048
  ds_read_b128 v[80:83], v4 offset:3072
  ds_read_b128 v[84:87], v4 offset:4096
  ds_read_b128 v[88:91], v4 offset:5120
  ds_read_b128 v[92:95], v4 offset:6144
  ds_read_b128 v[96:99], v4 offset:7168
  ds_read_b128 v[100:103], v4 offset:8192
  ds_read_b128 v[104:107], v4 offset:9216
  ds_read_b128 v[108:111], v4 offset:10240
  ds_read_b128 v[112:115], v4 offset:11264
  v_mov_b64 v[16:17], 0
  v_mov_b64 v[18:19], 0
  v_mov_b64 v[20:21], 0
  v_mov_b64 v[22:23], 0
  v_mov_b64 v[24:25], 0
  v_mov_b64 v[26:27], 0
  s_mov_b32 s19, 0
  v_mov_b32 v49, -1
  s_cmp_gt_u32 s13, 1
  s_cbranch_scc1 T_w23_72
  s_waitcnt vmcnt(1)
  s_nop 15
  buffer_load_dwordx4 v[52:55], v2, s[4:7], s22 offen offset:0 sc1
  buffer_load_dwordx4 v[56:59], v2, s[4:7], s22 offen offset:1024 sc1
  buffer_load_dwordx4 v[60:63], v2, s[4:7], s22 offen offset:2048 sc1
  buffer_load_dwordx4 v[64:67], v2, s[4:7], s22 offen offset:3072 sc1
  s_waitcnt lgkmcnt(12)
T_p1_74:
  s_waitcnt vmcnt(3)
  v_mfma_f32_16x16x32_bf16 v[120:123], v[116:119], v[52:55], 0
  v_xor_b32 v48, s57, v52
  s_waitcnt vmcnt(2)
  v_mfma_f32_16x16x32_bf16 v[120:123], v[116:119], v[56:59], v[120:123]
  v_bitop3_b32 v48, v48, v56, s57 bitop3:0xf6
  s_waitcnt vmcnt(1)
  v_mfma_f32_16x16x32_bf16 v[120:123], v[116:119], v[60:63], v[120:123]
  v_bitop3_b32 v48, v48, v60, s57 bitop3:0xf6
  s_waitcnt vmcnt(0)
  v_mfma_f32_16x16x32_bf16 v[120:123], v[116:119], v[64:67], v[120:123]
  v_bitop3_b32 v48, v48, v64, s57 bitop3:0xf6
  v_and_b32 v48, 1, v48
  v_cmp_ne_u32 vcc, 0, v48
  s_cbranch_vccnz T_p1re_75
  s_nop 3
  v_add_f32_dpp v120, v120, v120 row_ror:8 row_mask:0xf bank_mask:0xf
  v_add_f32_dpp v121, v121, v121 row_ror:8 row_mask:0xf bank_mask:0xf
  v_cvt_pk_bf16_f32 v48, v120, v121
  v_min_u32 v48, -2, v48
  buffer_store_dword v48, v8, s[4:7], s35 offen
  buffer_store_dword v49, v8, s[4:7], s26 offen
T_join_73:
  s_barrier
  buffer_load_dwordx4 v[124:127], v3, s[4:7], s24 offen sc1
  ds_read_b128 v[28:31], v3 offset:16384
  ds_read_b128 v[32:35], v3 offset:20480
  ds_read_b128 v[36:39], v2 offset:8192
  ds_read_b128 v[40:43], v2 offset:9216
  buffer_load_dwordx4 v[124:127], v3, s[4:7], s24 offen sc1
  ds_read_b128 v[44:47], v2 offset:10240
  ds_read_b128 v[48:51], v2 offset:11264
  ds_read_b128 v[52:55], v2 offset:12288
  ds_read_b128 v[56:59], v2 offset:13312
  buffer_load_dwordx4 v[124:127], v3, s[4:7], s24 offen sc1
  ds_read_b128 v[60:63], v2 offset:14336
  ds_read_b128 v[64:67], v2 offset:15360
  s_mov_b32 s19, 0
  s_branch T_loop_64
T_p1re_75:
  s_mov_b64 exec, vcc
  buffer_load_dwordx4 v[52:55], v2, s[4:7], s22 offen offset:0 sc1
  buffer_load_dwordx4 v[56:59], v2, s[4:7], s22 offen offset:1024 sc1
  buffer_load_dwordx4 v[60:63], v2, s[4:7], s22 offen offset:2048 sc1
  buffer_load_dwordx4 v[64:67], v2, s[4:7], s22 offen offset:3072 sc1
  s_mov_b64 exec, -1
  s_add_u32 s19, s19, 1
  s_cmp_gt_u32 s19, 32768
  s_cbranch_scc1 M_exit
  s_branch T_p1_74
T_w23_72:
  s_waitcnt vmcnt(2)
  s_branch T_join_73
T_kvw_68:
  s_mov_b32 s19, 0
T_kv_76:
  s_add_u32 s19, s19, 1
  s_cmp_gt_u32 s19, 32768
  s_cbranch_scc1 M_exit
  s_mul_i32 s38, s12, 896
  s_add_u32 s39, s38, 148898560
  s_add_u32 s38, s38, 148898048
  s_mov_b32 s30, 0
  s_mov_b32 s37, 0
  s_atomic_or s30, s[58:59], s38 glc
  s_atomic_or s37, s[58:59], s39 glc
  s_waitcnt lgkmcnt(0)
  s_add_u32 s37, s37, 28
  s_cmp_ge_u32 s30, 28
  s_cselect_b32 s30, s37, s30
  s_cmp_ge_u32 s30, 64
  s_cselect_b32 s30, 100, s30
  s_sub_u32 s30, s30, 1
  s_cmp_ge_i32 s14, s30
  s_cbranch_scc1 T_kv_76
  s_branch T_kvb_69
T_late_66:
  buffer_load_dwordx4 v[12:15], v3, s[4:7], s25 offen sc1
  s_add_u32 s19, s19, 1
  s_cmp_gt_u32 s19, 32768
  s_cbranch_scc1 M_exit
  s_waitcnt vmcnt(0)
  v_max3_u32 v92, v12, v13, v14
  v_max_u32 v92, v92, v15
  v_cmp_eq_u32 vcc, -1, v92
  s_cbranch_vccnz T_late_66
  s_branch T_lateok_67
T_slow_70:
  s_nop 7
  v_max3_f32 v124, v16, v17, v18
  v_max3_f32 v124, v124, v19, v20
  v_max3_f32 v124, v124, v21, v22
  v_max3_f32 v124, v124, v23, v120
  v_max3_f32 v124, v124, v121, v122
  v_max_f32 v124, v124, v123
  v_mov_b32 v125, v124
  s_nop 1
  v_permlane32_swap_b32 v124, v125
  s_nop 1
  v_max_f32 v124, v124, v125
  v_mov_b32 v125, v124
  s_nop 1
  v_permlane16_swap_b32 v124, v125
  s_nop 1
  v_max_f32 v124, v124, v125
  v_sub_f32 v16, v16, v124
  v_sub_f32 v17, v17, v124
  v_sub_f32 v18, v18, v124
  v_sub_f32 v19, v19, v124
  v_exp_f32 v16, v16
  v_exp_f32 v17, v17
  v_exp_f32 v18, v18
  v_exp_f32 v19, v19
  v_sub_f32 v20, v20, v124
  v_sub_f32 v21, v21, v124
  v_sub_f32 v22, v22, v124
  v_sub_f32 v23, v23, v124
  v_exp_f32 v20, v20
  v_exp_f32 v21, v21
  v_exp_f32 v22, v22
  v_exp_f32 v23, v23
  v_sub_f32 v120, v120, v124
  v_sub_f32 v121, v121, v124
  v_sub_f32 v122, v122, v124
  v_sub_f32 v123, v123, v124
  v_exp_f32 v120, v120
  v_exp_f32 v121, v121
  v_exp_f32 v122, v122
  v_exp_f32 v123, v123
  s_nop 0
  v_cvt_pk_bf16_f32 v44, v16, v17
  v_cvt_pk_bf16_f32 v45, v18, v19
  v_cvt_pk_bf16_f32 v46, v20, v21
  v_cvt_pk_bf16_f32 v47, v22, v23
  v_cvt_pk_bf16_f32 v84, v120, v121
  v_cvt_pk_bf16_f32 v85, v122, v123
  v_cndmask_b32 v48, v84, 0, s[16:17]
  v_cndmask_b32 v49, v85, 0, s[16:17]
  v_cndmask_b32 v50, 0, v84, s[16:17]
  v_cndmask_b32 v51, 0, v85, s[16:17]
  s_nop 1
  v_mfma_f32_16x16x16_bf16 v[88:91], v[12:13], v[48:49], 0
  v_mfma_f32_16x16x16_bf16 v[24:27], v[116:117], v[48:49], 0
  v_mfma_f32_16x16x16_bf16 v[92:95], v[116:117], v[50:51], 0
  v_mfma_f32_16x16x32_bf16 v[88:91], v[12:15], v[44:47], v[88:91]
  v_mfma_f32_16x16x32_bf16 v[24:27], v[28:31], v[44:47], v[24:27]
  v_mfma_f32_16x16x32_bf16 v[92:95], v[32:35], v[44:47], v[92:95]
  s_nop 7
  s_nop 1
  v_rcp_f32 v89, v88
  s_nop 0
  s_branch T_back_71
M_global:
  s_mov_b32 s19, 0
  v_mov_b64 v[16:17], 0
  v_mov_b64 v[18:19], 0
  v_mov_b64 v[20:21], 0
  v_mov_b64 v[22:23], 0
  v_mov_b64 v[24:25], 0
  v_mov_b64 v[26:27], 0
  buffer_load_dwordx4 v[124:127], v3, s[4:7], s24 offen sc1
  buffer_load_dwordx4 v[124:127], v3, s[4:7], s24 offen sc1
  buffer_load_dwordx4 v[124:127], v3, s[4:7], s24 offen sc1
  s_branch T_loop_78
.p2align 6
T_retry_79:
  s_mov_b64 exec, vcc
  buffer_load_dwordx4 v[124:127], v3, s[4:7], s24 offen sc1
  s_mov_b64 exec, -1
  s_add_u32 s19, s19, 1
  s_cmp_gt_u32 s19, 32768
  s_cbranch_scc1 M_exit
T_loop_78:
  s_waitcnt vmcnt(2)
  v_max3_u32 v122, v124, v125, v126
  v_max_u32 v122, v122, v127
  v_cmp_eq_u32 vcc, -1, v122
  s_cbranch_vccnz T_retry_79
  ds_write_b128 v3, v[124:127] offset:0
  buffer_load_dwordx4 v[12:15], v3, s[4:7], s25 offen sc1
  s_add_u32 s14, s14, 1
  s_waitcnt lgkmcnt(0)
  s_barrier
  ds_read_b128 v[116:119], v1 offset:0
  ds_read_b128 v[120:123], v1 offset:512
  s_waitcnt lgkmcnt(1)
  v_smfmac_f32_16x16x64_bf16 v[16:19], v[116:119], v[68:75], v0
  ds_read_b128 v[68:71], v4 offset:12288
  v_smfmac_f32_16x16x64_bf16 v[20:23], v[116:119], v[76:83], v0
  s_waitcnt vmcnt(1)
  ds_read_b128 v[124:127], v1 offset:1024
  v_smfmac_f32_16x16x64_bf16 v[24:27], v[116:119], v[84:91], v0
  s_waitcnt lgkmcnt(2)
  ds_read_b128 v[84:87], v1 offset:1536
  v_smfmac_f32_16x16x64_bf16 v[16:19], v[120:123], v[92:99], v0
  s_waitcnt vmcnt(0)
  ds_read_b128 v[72:75], v4 offset:13312
  v_max3_u32 v92, v12, v13, v14
  v_smfmac_f32_16x16x64_bf16 v[20:23], v[120:123], v[100:107], v0
  ds_read_b128 v[88:91], v1 offset:2048
  v_max_u32 v92, v92, v15
  v_smfmac_f32_16x16x64_bf16 v[24:27], v[120:123], v[108:115], v0
  s_waitcnt lgkmcnt(3)
  ds_read_b128 v[116:119], v1 offset:2560
  v_cmp_eq_u32 vcc, -1, v92
  v_smfmac_f32_16x16x64_bf16 v[16:19], v[124:127], v[128:135], v0
  s_cbranch_vccnz T_late_80
T_lateok_81:
  ds_write_b64 v3, v[12:13] offset:4096
  v_smfmac_f32_16x16x64_bf16 v[20:23], v[124:127], v[136:143], v0
  s_and_b32 s57, s14, 1
  s_and_b32 s36, s14, 3
  s_lshl_b32 s36, s36, 13
  v_smfmac_f32_16x16x64_bf16 v[24:27], v[124:127], v[144:151], v0
  s_waitcnt lgkmcnt(4)
  ds_write_b64 v3, v[14:15] offset:4104
  s_add_u32 s26, s36, s23
  v_smfmac_f32_16x16x64_bf16 v[16:19], v[84:87], v[152:159], v0
  s_add_u32 s36, s36, 8192
  ds_read_b128 v[76:79], v4 offset:14336
  s_and_b32 s36, s36, 0x7fff
  v_smfmac_f32_16x16x64_bf16 v[20:23], v[84:87], v[160:167], v0
  s_waitcnt lgkmcnt(5)
  ds_read_b128 v[80:83], v4 offset:15360
  s_mov_b32 m0, s31
  v_smfmac_f32_16x16x64_bf16 v[24:27], v[84:87], v[68:75], v0
  s_waitcnt lgkmcnt(5)
  ds_read_b128 v[92:95], v1 offset:3072
  s_cmp_ge_i32 s14, s30
  v_smfmac_f32_16x16x64_bf16 v[16:19], v[88:91], v[168:175], v0
  s_cbranch_scc1 T_kvw_82
T_kvb_83:
  ds_read_b128 v[96:99], v1 offset:3584
  v_smfmac_f32_16x16x64_bf16 v[20:23], v[88:91], v[176:183], v0
  s_waitcnt lgkmcnt(4)
  s_barrier
  v_smfmac_f32_16x16x64_bf16 v[24:27], v[88:91], v[184:191], v0
  ds_read_b128 v[100:103], v1 offset:4096
  v_mov_b64 v[12:13], s[2:3]
  v_smfmac_f32_16x16x64_bf16 v[16:19], v[116:119], v[192:199], v0
  ds_read_b128 v[104:107], v1 offset:4608
  v_mov_b64 v[14:15], s[2:3]
  v_smfmac_f32_16x16x64_bf16 v[20:23], v[116:119], v[200:207], v0
  s_waitcnt lgkmcnt(4)
  ds_read_b128 v[108:111], v1 offset:5120
  s_add_u32 s24, s36, 145752064
  v_smfmac_f32_16x16x64_bf16 v[24:27], v[116:119], v[76:83], v0
  s_waitcnt lgkmcnt(4)
  ds_read_b128 v[112:115], v1 offset:5632
  s_add_u32 s25, s36, 145756160
  v_smfmac_f32_16x16x64_bf16 v[16:19], v[92:95], v[208:215], v0
  s_waitcnt lgkmcnt(4)
  ds_read_b128 v[120:123], v1 offset:6144
  s_add_u32 s35, s36, s23
  v_smfmac_f32_16x16x64_bf16 v[16:19], v[96:99], v[216:223], v0
  s_waitcnt lgkmcnt(4)
  ds_read_b128 v[124:127], v1 offset:6656
  buffer_load_dwordx4 v9, s[4:7], s27 offen sc1 lds
  v_smfmac_f32_16x16x64_bf16 v[16:19], v[100:103], v[240:247], v0
  s_waitcnt lgkmcnt(4)
  ds_read_b128 v[84:87], v1 offset:7168
  v_mov_b32 v118, s14
  v_smfmac_f32_16x16x64_bf16 v[16:19], v[104:107], a[8:15], v0
  s_waitcnt lgkmcnt(4)
  ds_read_b128 v[88:91], v1 offset:7680
  s_mov_b32 m0, s32
  v_smfmac_f32_16x16x64_bf16 v[16:19], v[108:111], a[24:31], v0
  s_waitcnt lgkmcnt(4)
  ds_read_b128 v[68:71], v4 offset:16384
  v_min_u32 v119, 1, v3
  v_smfmac_f32_16x16x64_bf16 v[16:19], v[112:115], a[48:55], v0
  s_waitcnt lgkmcnt(4)
  ds_read_b128 v[72:75], v4 offset:17408
  v_lshlrev_b32 v119, 30, v119
  v_smfmac_f32_16x16x64_bf16 v[16:19], v[120:123], a[72:79], v0
  s_waitcnt lgkmcnt(4)
  ds_read_b128 v[76:79], v4 offset:18432
  v_smfmac_f32_16x16x64_bf16 v[16:19], v[124:127], a[96:103], v0
  s_waitcnt lgkmcnt(4)
  buffer_load_dwordx4 v9, s[4:7], s27 offen offset:128 sc1 lds
  v_smfmac_f32_16x16x64_bf16 v[16:19], v[84:87], a[112:119], v0
  s_waitcnt lgkmcnt(3)
  ds_read_b128 v[80:83], v4 offset:19456
  v_smfmac_f32_16x16x64_bf16 v[16:19], v[88:91], a[136:143], v0
  s_waitcnt lgkmcnt(2)
  buffer_store_dword v118, v119, s[4:7], s15 offen sc1
  s_mov_b32 m0, s33
  v_smfmac_f32_16x16x64_bf16 v[20:23], v[92:95], v[68:75], v0
  ds_read_b128 v[68:71], v4 offset:20480
  v_smfmac_f32_16x16x64_bf16 v[20:23], v[96:99], v[224:231], v0
  buffer_load_dwordx4 v10, s[4:7], s28 offen sc1 lds
  s_mov_b32 m0, s34
  v_smfmac_f32_16x16x64_bf16 v[20:23], v[100:103], v[248:255], v0
  s_waitcnt lgkmcnt(1)
  ds_read_b128 v[72:75], v4 offset:21504
  v_mul_f32 v16, s18, v16
  v_smfmac_f32_16x16x64_bf16 v[20:23], v[104:107], v[76:83], v0
  ds_read_b128 v[76:79], v4 offset:22528
  v_mul_f32 v17, s18, v17
  v_smfmac_f32_16x16x64_bf16 v[20:23], v[108:111], a[32:39], v0
  ds_read_b128 v[80:83], v4 offset:23552
  v_mul_f32 v18, s18, v18
  v_smfmac_f32_16x16x64_bf16 v[20:23], v[112:115], a[56:63], v0
  buffer_load_dwordx4 v10, s[4:7], s28 offen offset:256 sc1 lds
  v_mul_f32 v19, s18, v19
  v_smfmac_f32_16x16x64_bf16 v[20:23], v[120:123], a[80:87], v0
  s_waitcnt lgkmcnt(2)
  v_cvt_pk_bf16_f32 v116, v16, v17
  v_smfmac_f32_16x16x64_bf16 v[20:23], v[124:127], v[68:75], v0
  v_cvt_pk_bf16_f32 v117, v18, v19
  v_smfmac_f32_16x16x64_bf16 v[20:23], v[84:87], a[120:127], v0
  ds_write_b64 v5, v[116:117] offset:24576
  v_smfmac_f32_16x16x64_bf16 v[20:23], v[88:91], a[144:151], v0
  s_waitcnt lgkmcnt(1)
  s_add_u32 s27, s27, 8192
  s_add_u32 s28, s28, 8192
  v_smfmac_f32_16x16x64_bf16 v[24:27], v[92:95], v[76:83], v0
  v_smfmac_f32_16x16x64_bf16 v[24:27], v[96:99], v[232:239], v0
  s_nop 1
  v_cvt_pk_bf16_f32 v118, v20, v21
  v_cvt_pk_bf16_f32 v119, v22, v23
  v_smfmac_f32_16x16x64_bf16 v[24:27], v[100:103], a[0:7], v0
  ds_write_b64 v5, v[118:119] offset:26880
  buffer_store_dwordx2 v[118:119], v5, s[4:7], s29 offen sc1
  v_smfmac_f32_16x16x64_bf16 v[24:27], v[104:107], a[16:23], v0
  s_waitcnt lgkmcnt(1)
  s_barrier
  ds_read_b64_tr_b16 v[68:69], v6 offset:24576
  v_smfmac_f32_16x16x64_bf16 v[24:27], v[108:111], a[40:47], v0
  s_nop 0
  ds_read_b64_tr_b16 v[70:71], v6 offset:24640
  ds_read_b64_tr_b16 v[72:73], v6 offset:24832
  v_smfmac_f32_16x16x64_bf16 v[24:27], v[112:115], a[64:71], v0
  s_nop 0
  ds_read_b64_tr_b16 v[74:75], v6 offset:24896
  ds_read_b64_tr_b16 v[76:77], v6 offset:25088
  v_smfmac_f32_16x16x64_bf16 v[24:27], v[120:123], a[88:95], v0
  s_nop 0
  ds_read_b64_tr_b16 v[78:79], v6 offset:25152
  ds_read_b64_tr_b16 v[80:81], v6 offset:25344
  v_smfmac_f32_16x16x64_bf16 v[24:27], v[124:127], a[104:111], v0
  s_waitcnt lgkmcnt(7)
  ds_read_b64_tr_b16 v[82:83], v6 offset:25408
  s_barrier
  v_smfmac_f32_16x16x64_bf16 v[24:27], v[84:87], a[128:135], v0
  s_nop 0
  ds_read_b64_tr_b16 v[92:93], v6 offset:26880
  ds_read_b64_tr_b16 v[94:95], v6 offset:26944
  v_smfmac_f32_16x16x64_bf16 v[24:27], v[88:91], a[152:159], v0
  s_waitcnt lgkmcnt(8)
  ds_read_b64_tr_b16 v[96:97], v6 offset:27136
  ds_read_b64_tr_b16 v[98:99], v6 offset:27200
  v_mfma_f32_16x16x32_bf16 v[16:19], v[36:39], v[68:71], 0
  s_waitcnt lgkmcnt(8)
  ds_read_b64_tr_b16 v[100:101], v6 offset:27392
  ds_read_b64_tr_b16 v[102:103], v6 offset:27456
  v_mfma_f32_16x16x32_bf16 v[16:19], v[40:43], v[72:75], v[16:19]
  s_waitcnt lgkmcnt(8)
  ds_read_b64_tr_b16 v[104:105], v6 offset:27648
  ds_read_b64_tr_b16 v[106:107], v6 offset:27712
  v_mfma_f32_16x16x32_bf16 v[16:19], v[44:47], v[76:79], v[16:19]
  s_waitcnt lgkmcnt(8)
  v_cvt_pk_bf16_f32 v116, v24, v25
  v_cvt_pk_bf16_f32 v117, v26, v27
  v_mfma_f32_16x16x32_bf16 v[16:19], v[48:51], v[80:83], v[16:19]
  s_waitcnt lgkmcnt(6)
  buffer_store_dwordx2 v[116:117], v5, s[4:7], s29 offen offset:2304 sc1
  v_mov_b64 v[108:109], 0
  v_mfma_f32_16x16x32_bf16 v[120:123], v[92:95], v[68:71], 0
  s_waitcnt lgkmcnt(4)
  v_mov_b64 v[110:111], 0
  v_mov_b64 v[112:113], 0
  v_mfma_f32_16x16x32_bf16 v[120:123], v[96:99], v[72:75], v[120:123]
  s_waitcnt lgkmcnt(2)
  v_mov_b64 v[114:115], 0
  v_mov_b64 v[36:37], 0
  v_mfma_f32_16x16x32_bf16 v[120:123], v[100:103], v[76:79], v[120:123]
  s_waitcnt lgkmcnt(0)
  v_exp_f32 v124, v16
  v_mfma_f32_16x16x32_bf16 v[120:123], v[104:107], v[80:83], v[120:123]
  s_add_u32 s29, s29, 147456
  v_exp_f32 v125, v17
  v_mfma_f32_16x16x32_bf16 v[20:23], v[52:55], v[68:71], 0
  s_cmp_eq_u32 s14, 63
  v_exp_f32 v126, v18
  v_mfma_f32_16x16x32_bf16 v[20:23], v[56:59], v[72:75], v[20:23]
  s_cbranch_scc1 M_tdone
  v_exp_f32 v127, v19
  v_mfma_f32_16x16x32_bf16 v[20:23], v[60:63], v[76:79], v[20:23]
  v_cvt_pk_bf16_f32 v44, v124, v125
  v_cvt_pk_bf16_f32 v45, v126, v127
  v_mfma_f32_16x16x32_bf16 v[20:23], v[64:67], v[80:83], v[20:23]
  v_exp_f32 v124, v120
  v_exp_f32 v125, v121
  v_exp_f32 v126, v122
  v_exp_f32 v127, v123
  v_cvt_pk_bf16_f32 v84, v124, v125
  v_cvt_pk_bf16_f32 v85, v126, v127
  v_cndmask_b32 v48, v84, 0, s[16:17]
  v_cndmask_b32 v49, v85, 0, s[16:17]
  v_cndmask_b32 v50, 0, v84, s[16:17]
  v_cndmask_b32 v51, 0, v85, s[16:17]
  v_exp_f32 v124, v20
  v_mfma_f32_16x16x16_bf16 v[88:91], v[12:13], v[48:49], 0
  v_exp_f32 v125, v21
  v_mfma_f32_16x16x16_bf16 v[24:27], v[116:117], v[48:49], 0
  v_exp_f32 v126, v22
  v_mfma_f32_16x16x16_bf16 v[92:95], v[116:117], v[50:51], 0
  v_exp_f32 v127, v23
  v_cvt_pk_bf16_f32 v46, v124, v125
  v_cvt_pk_bf16_f32 v47, v126, v127
  v_mov_b64 v[38:39], 0
  v_mov_b64 v[40:41], 0
  v_mfma_f32_16x16x32_bf16 v[88:91], v[12:15], v[44:47], v[88:91]
  v_xor_b32 v86, 512, v11
  v_xor_b32 v87, 1024, v11
  v_mfma_f32_16x16x32_bf16 v[24:27], v[28:31], v[44:47], v[24:27]
  v_xor_b32 v72, 1536, v11
  v_mov_b64 v[42:43], 0
  v_mfma_f32_16x16x32_bf16 v[92:95], v[32:35], v[44:47], v[92:95]
  s_nop 1
  v_rcp_f32 v89, v88
  v_subrev_u32 v124, s54, v88
  v_cmp_le_u32 vcc, s55, v124
  s_cbranch_vccnz T_slow_84
T_back_85:
  v_mul_f32 v24, v89, v24
  v_mul_f32 v25, v89, v25
  v_mul_f32 v26, v89, v26
  v_mul_f32 v27, v89, v27
  v_cvt_pk_bf16_f32 v96, v24, v25
  v_cvt_pk_bf16_f32 v97, v26, v27
  v_pk_mul_f32 v[92:93], v[92:93], v[88:89] op_sel:[0,1] op_sel_hi:[1,1]
  v_pk_mul_f32 v[94:95], v[94:95], v[88:89] op_sel:[0,1] op_sel_hi:[1,1]
  v_cvt_pk_bf16_f32 v98, v92, v93
  v_cvt_pk_bf16_f32 v99, v94, v95
  ds_write_b128 v11, v[96:99] offset:29184
  s_nop 0
  v_smfmac_f32_16x16x64_bf16 v[108:111], v[96:99], a[160:167], v0
  ds_read_b128 v[52:55], v4 offset:24576
  v_smfmac_f32_16x16x64_bf16 v[112:115], v[96:99], a[168:175], v0
  ds_read_b128 v[56:59], v4 offset:25600
  v_smfmac_f32_16x16x64_bf16 v[36:39], v[96:99], a[176:183], v0
  v_smfmac_f32_16x16x64_bf16 v[40:43], v[96:99], a[184:191], v0
  s_waitcnt lgkmcnt(2)
  s_barrier
  ds_read_b128 v[100:103], v86 offset:29184
  ds_read_b128 v[104:107], v87 offset:29184
  ds_read_b128 v[68:71], v72 offset:29184
  s_waitcnt lgkmcnt(2)
  v_smfmac_f32_16x16x64_bf16 v[108:111], v[100:103], a[192:199], v0
  ds_read_b128 v[60:63], v4 offset:26624
  v_smfmac_f32_16x16x64_bf16 v[112:115], v[100:103], a[200:207], v0
  s_waitcnt lgkmcnt(2)
  ds_read_b128 v[64:67], v4 offset:27648
  v_smfmac_f32_16x16x64_bf16 v[108:111], v[104:107], a[224:231], v0
  ds_read_b128 v[76:79], v4 offset:28672
  v_smfmac_f32_16x16x64_bf16 v[112:115], v[104:107], a[232:239], v0
  s_waitcnt lgkmcnt(3)
  ds_read_b128 v[80:83], v4 offset:29696
  v_smfmac_f32_16x16x64_bf16 v[108:111], v[68:71], a[240:247], v0
  ds_read_b128 v[28:31], v4 offset:30720
  v_smfmac_f32_16x16x64_bf16 v[112:115], v[68:71], a[248:255], v0
  ds_read_b128 v[32:35], v4 offset:31744
  v_smfmac_f32_16x16x64_bf16 v[36:39], v[100:103], a[208:215], v0
  ds_read_b128 v[116:119], v2 offset:31232
  v_smfmac_f32_16x16x64_bf16 v[40:43], v[100:103], a[216:223], v0
  v_cvt_pk_bf16_f32 v16, v108, v109
  v_cvt_pk_bf16_f32 v17, v110, v111
  v_bfi_b32 v16, 1, s57, v16
  v_cvt_pk_bf16_f32 v18, v112, v113
  v_cvt_pk_bf16_f32 v19, v114, v115
  v_smfmac_f32_16x16x64_bf16 v[36:39], v[104:107], v[52:59], v0
  s_waitcnt lgkmcnt(5)
  buffer_store_dwordx4 v[16:19], v7, s[4:7], s20 offen sc1
  v_smfmac_f32_16x16x64_bf16 v[40:43], v[104:107], v[60:67], v0
  s_waitcnt lgkmcnt(3)
  v_smfmac_f32_16x16x64_bf16 v[36:39], v[68:71], v[76:83], v0
  s_waitcnt lgkmcnt(1)
  v_smfmac_f32_16x16x64_bf16 v[40:43], v[68:71], v[28:35], v0
  s_nop 4
  v_cvt_pk_bf16_f32 v20, v36, v37
  v_cvt_pk_bf16_f32 v21, v38, v39
  v_bfi_b32 v20, 1, s57, v20
  v_cvt_pk_bf16_f32 v22, v40, v41
  v_cvt_pk_bf16_f32 v23, v42, v43
  buffer_store_dwordx4 v[20:23], v7, s[4:7], s21 offen sc1
  ds_read_b128 v[68:71], v4 offset:0
  ds_read_b128 v[72:75], v4 offset:1024
  ds_read_b128 v[76:79], v4 offset:2048
  ds_read_b128 v[80:83], v4 offset:3072
  ds_read_b128 v[84:87], v4 offset:4096
  ds_read_b128 v[88:91], v4 offset:5120
  ds_read_b128 v[92:95], v4 offset:6144
  ds_read_b128 v[96:99], v4 offset:7168
  ds_read_b128 v[100:103], v4 offset:8192
  ds_read_b128 v[104:107], v4 offset:9216
  ds_read_b128 v[108:111], v4 offset:10240
  ds_read_b128 v[112:115], v4 offset:11264
  v_mov_b64 v[16:17], 0
  v_mov_b64 v[18:19], 0
  v_mov_b64 v[20:21], 0
  v_mov_b64 v[22:23], 0
  v_mov_b64 v[24:25], 0
  v_mov_b64 v[26:27], 0
  s_mov_b32 s19, 0
  v_mov_b32 v49, -1
  s_cmp_gt_u32 s13, 1
  s_cbranch_scc1 T_w23_86
  s_waitcnt vmcnt(1)
  s_nop 15
  buffer_load_dwordx4 v[52:55], v2, s[4:7], s22 offen offset:0 sc1
  buffer_load_dwordx4 v[56:59], v2, s[4:7], s22 offen offset:1024 sc1
  buffer_load_dwordx4 v[60:63], v2, s[4:7], s22 offen offset:2048 sc1
  buffer_load_dwordx4 v[64:67], v2, s[4:7], s22 offen offset:3072 sc1
  s_waitcnt lgkmcnt(12)
T_p1_88:
  s_waitcnt vmcnt(3)
  v_mfma_f32_16x16x32_bf16 v[120:123], v[116:119], v[52:55], 0
  v_xor_b32 v48, s57, v52
  s_waitcnt vmcnt(2)
  v_mfma_f32_16x16x32_bf16 v[120:123], v[116:119], v[56:59], v[120:123]
  v_bitop3_b32 v48, v48, v56, s57 bitop3:0xf6
  s_waitcnt vmcnt(1)
  v_mfma_f32_16x16x32_bf16 v[120:123], v[116:119], v[60:63], v[120:123]
  v_bitop3_b32 v48, v48, v60, s57 bitop3:0xf6
  s_waitcnt vmcnt(0)
  v_mfma_f32_16x16x32_bf16 v[120:123], v[116:119], v[64:67], v[120:123]
  v_bitop3_b32 v48, v48, v64, s57 bitop3:0xf6
  v_and_b32 v48, 1, v48
  v_cmp_ne_u32 vcc, 0, v48
  s_cbranch_vccnz T_p1re_89
  s_nop 3
  v_add_f32_dpp v120, v120, v120 row_ror:8 row_mask:0xf bank_mask:0xf
  v_add_f32_dpp v121, v121, v121 row_ror:8 row_mask:0xf bank_mask:0xf
  v_cvt_pk_bf16_f32 v48, v120, v121
  v_min_u32 v48, -2, v48
  buffer_store_dword v48, v8, s[4:7], s35 offen sc1
  buffer_store_dword v49, v8, s[4:7], s26 offen sc1
T_join_87:
  s_barrier
  buffer_load_dwordx4 v[124:127], v3, s[4:7], s24 offen sc1
  ds_read_b128 v[28:31], v3 offset:16384
  ds_read_b128 v[32:35], v3 offset:20480
  ds_read_b128 v[36:39], v2 offset:8192
  ds_read_b128 v[40:43], v2 offset:9216
  buffer_load_dwordx4 v[124:127], v3, s[4:7], s24 offen sc1
  ds_read_b128 v[44:47], v2 offset:10240
  ds_read_b128 v[48:51], v2 offset:11264
  ds_read_b128 v[52:55], v2 offset:12288
  ds_read_b128 v[56:59], v2 offset:13312
  buffer_load_dwordx4 v[124:127], v3, s[4:7], s24 offen sc1
  ds_read_b128 v[60:63], v2 offset:14336
  ds_read_b128 v[64:67], v2 offset:15360
  s_mov_b32 s19, 0
  s_branch T_loop_78
T_p1re_89:
  s_mov_b64 exec, vcc
  buffer_load_dwordx4 v[52:55], v2, s[4:7], s22 offen offset:0 sc1
  buffer_load_dwordx4 v[56:59], v2, s[4:7], s22 offen offset:1024 sc1
  buffer_load_dwordx4 v[60:63], v2, s[4:7], s22 offen offset:2048 sc1
  buffer_load_dwordx4 v[64:67], v2, s[4:7], s22 offen offset:3072 sc1
  s_mov_b64 exec, -1
  s_add_u32 s19, s19, 1
  s_cmp_gt_u32 s19, 32768
  s_cbranch_scc1 M_exit
  s_branch T_p1_88
T_w23_86:
  s_waitcnt vmcnt(2)
  s_branch T_join_87
T_kvw_82:
  s_mov_b32 s19, 0
T_kv_90:
  s_add_u32 s19, s19, 1
  s_cmp_gt_u32 s19, 32768
  s_cbranch_scc1 M_exit
  s_mul_i32 s38, s12, 896
  s_add_u32 s39, s38, 148898560
  s_add_u32 s38, s38, 148898048
  s_mov_b32 s30, 0
  s_mov_b32 s37, 0
  s_atomic_or s30, s[58:59], s38 glc
  s_atomic_or s37, s[58:59], s39 glc
  s_waitcnt lgkmcnt(0)
  s_add_u32 s37, s37, 28
  s_cmp_ge_u32 s30, 28
  s_cselect_b32 s30, s37, s30
  s_cmp_ge_u32 s30, 64
  s_cselect_b32 s30, 100, s30
  s_sub_u32 s30, s30, 1
  s_cmp_ge_i32 s14, s30
  s_cbranch_scc1 T_kv_90
  s_branch T_kvb_83
T_late_80:
  buffer_load_dwordx4 v[12:15], v3, s[4:7], s25 offen sc1
  s_add_u32 s19, s19, 1
  s_cmp_gt_u32 s19, 32768
  s_cbranch_scc1 M_exit
  s_waitcnt vmcnt(0)
  v_max3_u32 v92, v12, v13, v14
  v_max_u32 v92, v92, v15
  v_cmp_eq_u32 vcc, -1, v92
  s_cbranch_vccnz T_late_80
  s_branch T_lateok_81
T_slow_84:
  s_nop 7
  v_max3_f32 v124, v16, v17, v18
  v_max3_f32 v124, v124, v19, v20
  v_max3_f32 v124, v124, v21, v22
  v_max3_f32 v124, v124, v23, v120
  v_max3_f32 v124, v124, v121, v122
  v_max_f32 v124, v124, v123
  v_mov_b32 v125, v124
  s_nop 1
  v_permlane32_swap_b32 v124, v125
  s_nop 1
  v_max_f32 v124, v124, v125
  v_mov_b32 v125, v124
  s_nop 1
  v_permlane16_swap_b32 v124, v125
  s_nop 1
  v_max_f32 v124, v124, v125
  v_sub_f32 v16, v16, v124
  v_sub_f32 v17, v17, v124
  v_sub_f32 v18, v18, v124
  v_sub_f32 v19, v19, v124
  v_exp_f32 v16, v16
  v_exp_f32 v17, v17
  v_exp_f32 v18, v18
  v_exp_f32 v19, v19
  v_sub_f32 v20, v20, v124
  v_sub_f32 v21, v21, v124
  v_sub_f32 v22, v22, v124
  v_sub_f32 v23, v23, v124
  v_exp_f32 v20, v20
  v_exp_f32 v21, v21
  v_exp_f32 v22, v22
  v_exp_f32 v23, v23
  v_sub_f32 v120, v120, v124
  v_sub_f32 v121, v121, v124
  v_sub_f32 v122, v122, v124
  v_sub_f32 v123, v123, v124
  v_exp_f32 v120, v120
  v_exp_f32 v121, v121
  v_exp_f32 v122, v122
  v_exp_f32 v123, v123
  s_nop 0
  v_cvt_pk_bf16_f32 v44, v16, v17
  v_cvt_pk_bf16_f32 v45, v18, v19
  v_cvt_pk_bf16_f32 v46, v20, v21
  v_cvt_pk_bf16_f32 v47, v22, v23
  v_cvt_pk_bf16_f32 v84, v120, v121
  v_cvt_pk_bf16_f32 v85, v122, v123
  v_cndmask_b32 v48, v84, 0, s[16:17]
  v_cndmask_b32 v49, v85, 0, s[16:17]
  v_cndmask_b32 v50, 0, v84, s[16:17]
  v_cndmask_b32 v51, 0, v85, s[16:17]
  s_nop 1
  v_mfma_f32_16x16x16_bf16 v[88:91], v[12:13], v[48:49], 0
  v_mfma_f32_16x16x16_bf16 v[24:27], v[116:117], v[48:49], 0
  v_mfma_f32_16x16x16_bf16 v[92:95], v[116:117], v[50:51], 0
  v_mfma_f32_16x16x32_bf16 v[88:91], v[12:15], v[44:47], v[88:91]
  v_mfma_f32_16x16x32_bf16 v[24:27], v[28:31], v[44:47], v[24:27]
  v_mfma_f32_16x16x32_bf16 v[92:95], v[32:35], v[44:47], v[92:95]
  s_nop 7
  s_nop 1
  v_rcp_f32 v89, v88
  s_nop 0
  s_branch T_back_85
M_tdone:
  v_mov_b32 v16, 64
  v_min_u32 v17, 1, v3
  v_lshlrev_b32 v17, 30, v17
  s_waitcnt vmcnt(0)
  s_barrier
  buffer_store_dword v16, v17, s[4:7], s15 offen sc1
M_done:
M_exit:
  s_endpgm
.p2align 6
.type M_table,@object
M_table:
.long 0x1, 0x3f, 0xffffffff, 0x12, 0x1, 0x7, 0x8, 0x0, 0x2700, 0x0, 0x0, 0x0, 0x0, 0x0, 0x0, 0x0
.long 0x1, 0x2d, 0xffffffff, 0x16, 0x1, 0x6, 0x10, 0x0, 0x2700, 0x0, 0x0, 0x0, 0x0, 0x0, 0x0, 0x0
.long 0x2, 0x0, 0x1, 0x1c, 0x1, 0x5, 0x18, 0x0, 0x2700, 0x0, 0x0, 0x0, 0x0, 0x0, 0x0, 0x0
.long 0x0, 0x3f, 0xffffffff, 0x19, 0x2, 0x4, 0x719, 0x0, 0x2700, 0x0, 0x0, 0x0, 0x0, 0x0, 0x0, 0x0
.long 0x1, 0x17, 0xffffffff, 0x18, 0x2, 0x3, 0xf00, 0x1, 0x1f00, 0x0, 0x0, 0x0, 0x0, 0x0, 0x0, 0x0
.long 0x0, 0x26, 0xffffffff, 0x27, 0x1, 0x2, 0x1700, 0x0, 0x2700, 0x0, 0x0, 0x0, 0x0, 0x0, 0x0, 0x0
.long 0x2, 0x1c, 0x1, 0x24, 0x0, 0x0, 0x2700, 0x0, 0x2700, 0x0, 0x0, 0x0, 0x0, 0x0, 0x0, 0x0
.size M_table, 448
.section .rodata,"a"
.p2align 6
.amdhsa_kernel gated_mix__compressed_kv_cla__memory_aug_recurrent_mem_tr__prompt_kernel
.amdhsa_next_free_vgpr 512
.amdhsa_next_free_sgpr 102
.amdhsa_accum_offset 256
.amdhsa_group_segment_fixed_size 0
.amdhsa_kernarg_size 136
.amdhsa_user_sgpr_count 2
.amdhsa_user_sgpr_kernarg_segment_ptr 1
.amdhsa_system_sgpr_workgroup_id_x 1
.end_amdhsa_kernel
```

```asm
; @launch grid=(256,1,1) block=(256,1,1) lds=163840
.amdgcn_target "amdgcn-amd-amdhsa--gfx950"
.text
.globl gated_mix__compressed_kv_cla__memory_aug_recurrent_mem_tr__prompt_kernel
.p2align 8
.type gated_mix__compressed_kv_cla__memory_aug_recurrent_mem_tr__prompt_kernel,@function
gated_mix__compressed_kv_cla__memory_aug_recurrent_mem_tr__prompt_kernel:
  s_cmp_ge_u32 s2, 256
  s_cbranch_scc1 M_exit
  s_load_dwordx4 s[72:75], s[0:1], 120
  v_lshrrev_b32 v3, 6, v0
  v_and_b32 v1, 63, v0
  v_readfirstlane_b32 s16, v3
  v_lshlrev_b32 v2, 4, v1
  s_and_b32 s76, s2, 7
  s_lshr_b32 s77, s2, 3
  s_sub_u32 s66, s76, 1
  s_and_b32 s66, s66, 7
  s_lshl_b32 s66, s66, 5
  s_add_u32 s66, s66, s77
  s_lshl_b32 s31, s66, 7
  s_add_u32 s31, s31, 148897792
  s_waitcnt lgkmcnt(0)
  s_mov_b64 s[4:5], s[74:75]
  s_mov_b64 s[74:75], s[72:73]
  s_mov_b64 s[72:73], s[4:5]
  s_and_b32 s5, s5, 0xffff
  s_mov_b32 s6, 268435456
  s_mov_b32 s7, 0x20000
  s_cmp_eq_u32 s76, 0
  s_cbranch_scc1 M_team
  s_mul_i32 s64, s66, 9363
  s_lshr_b32 s64, s64, 16
  s_mul_i32 s67, s64, 7
  s_sub_u32 s65, s66, s67
  s_lshl_b32 s67, s67, 7
  s_add_u32 s67, s67, 148897792
  s_getpc_b64 s[76:77]
M_pc:
  s_add_u32 s76, s76, M_table-M_pc
  s_addc_u32 s77, s77, 0
  s_lshl_b32 s26, s65, 6
  s_load_dwordx16 s[48:63], s[76:77], s26
  s_waitcnt lgkmcnt(0)
  s_mov_b32 s23, s51
  s_lshr_b32 s29, s16, 1
  s_cmp_eq_u32 s29, 0
  s_cselect_b32 s26, 2, 8
  s_cselect_b32 s27, 3, 4
  s_cselect_b32 s28, 9, 10
  s_cmp_eq_u32 s48, 1
  s_cselect_b32 s26, s27, s26
  s_cmp_eq_u32 s48, 2
  s_cselect_b32 s26, s28, s26
  s_lshl_b32 s26, s26, 3
  s_load_dwordx2 s[8:9], s[0:1], s26
  s_cmp_eq_u32 s48, 1
  s_cselect_b32 s26, 8, 0
  s_load_dwordx2 s[12:13], s[0:1], s26
  s_cmp_eq_u32 s29, 0
  s_cselect_b32 s21, 0, 3
  s_cselect_b32 s27, 1, 2
  s_cselect_b32 s28, 4, 5
  s_cmp_eq_u32 s48, 1
  s_cselect_b32 s21, s27, s21
  s_cmp_eq_u32 s48, 2
  s_cselect_b32 s21, s28, s21
  s_lshl_b32 s21, s21, 5
  s_add_u32 s21, s21, s64
  s_lshl_b32 s21, s21, 6
  s_add_u32 s21, s21, s49
  s_and_b32 s27, s16, 1
  s_lshl_b32 s21, s21, 1
  s_add_u32 s21, s21, s27
  s_lshl_b32 s21, s21, 12
  s_lshl_b32 s22, s50, 13
  s_lshl_b32 s19, s49, 15
  s_lshl_b32 s20, s50, 15
  s_lshl_b32 s17, s64, 1
  s_add_u32 s17, s17, s27
  s_lshl_b32 s17, s17, 7
  s_mov_b32 s18, 8192
  s_cmp_eq_u32 s48, 0
  s_cselect_b32 s24, 0x3e0293ee, 1.0
  s_waitcnt lgkmcnt(0)
  s_and_b32 s9, s9, 0xffff
  s_mov_b32 s10, 4194304
  s_mov_b32 s11, 0x20000
  s_and_b32 s13, s13, 0xffff
  s_mov_b32 s14, 2097152
  s_mov_b32 s15, 0x20000
  v_and_b32 v144, 31, v1
  v_lshrrev_b32 v145, 5, v1
  v_and_b32 v146, 15, v1
  v_or_b32 v147, 0, v145
  v_xor_b32 v147, v147, v146
  v_lshlrev_b32 v147, 4, v147
  v_lshl_add_u32 v8, v144, 8, v147
  v_or_b32 v147, 2, v145
  v_xor_b32 v147, v147, v146
  v_lshlrev_b32 v147, 4, v147
  v_lshl_add_u32 v9, v144, 8, v147
  v_or_b32 v147, 4, v145
  v_xor_b32 v147, v147, v146
  v_lshlrev_b32 v147, 4, v147
  v_lshl_add_u32 v10, v144, 8, v147
  v_or_b32 v147, 6, v145
  v_xor_b32 v147, v147, v146
  v_lshlrev_b32 v147, 4, v147
  v_lshl_add_u32 v11, v144, 8, v147
  v_or_b32 v147, 8, v145
  v_xor_b32 v147, v147, v146
  v_lshlrev_b32 v147, 4, v147
  v_lshl_add_u32 v12, v144, 8, v147
  v_or_b32 v147, 10, v145
  v_xor_b32 v147, v147, v146
  v_lshlrev_b32 v147, 4, v147
  v_lshl_add_u32 v13, v144, 8, v147
  v_or_b32 v147, 12, v145
  v_xor_b32 v147, v147, v146
  v_lshlrev_b32 v147, 4, v147
  v_lshl_add_u32 v14, v144, 8, v147
  v_or_b32 v147, 14, v145
  v_xor_b32 v147, v147, v146
  v_lshlrev_b32 v147, 4, v147
  v_lshl_add_u32 v15, v144, 8, v147
  v_lshrrev_b32 v144, 4, v1
  s_lshl_b32 s26, s16, 8
  v_add_u32 v145, 0, v144
  v_and_b32 v147, 15, v145
  v_xor_b32 v147, v147, v146
  v_lshlrev_b32 v147, 4, v147
  v_lshl_add_u32 v147, v145, 10, v147
  v_add_u32 v16, s26, v147
  v_add_u32 v145, 4, v144
  v_and_b32 v147, 15, v145
  v_xor_b32 v147, v147, v146
  v_lshlrev_b32 v147, 4, v147
  v_lshl_add_u32 v147, v145, 10, v147
  v_add_u32 v17, s26, v147
  v_add_u32 v145, 8, v144
  v_and_b32 v147, 15, v145
  v_xor_b32 v147, v147, v146
  v_lshlrev_b32 v147, 4, v147
  v_lshl_add_u32 v147, v145, 10, v147
  v_add_u32 v18, s26, v147
  v_add_u32 v145, 12, v144
  v_and_b32 v147, 15, v145
  v_xor_b32 v147, v147, v146
  v_lshlrev_b32 v147, 4, v147
  v_lshl_add_u32 v147, v145, 10, v147
  v_add_u32 v19, s26, v147
  v_add_u32 v145, 16, v144
  v_and_b32 v147, 15, v145
  v_xor_b32 v147, v147, v146
  v_lshlrev_b32 v147, 4, v147
  v_lshl_add_u32 v147, v145, 10, v147
  v_add_u32 v20, s26, v147
  v_add_u32 v145, 20, v144
  v_and_b32 v147, 15, v145
  v_xor_b32 v147, v147, v146
  v_lshlrev_b32 v147, 4, v147
  v_lshl_add_u32 v147, v145, 10, v147
  v_add_u32 v21, s26, v147
  v_add_u32 v145, 24, v144
  v_and_b32 v147, 15, v145
  v_xor_b32 v147, v147, v146
  v_lshlrev_b32 v147, 4, v147
  v_lshl_add_u32 v147, v145, 10, v147
  v_add_u32 v22, s26, v147
  v_add_u32 v145, 28, v144
  v_and_b32 v147, 15, v145
  v_xor_b32 v147, v147, v146
  v_lshlrev_b32 v147, 4, v147
  v_lshl_add_u32 v147, v145, 10, v147
  v_add_u32 v23, s26, v147
  v_lshrrev_b32 v144, 3, v1
  v_mul_lo_u32 v144, v144, s18
  v_and_b32 v145, 7, v1
  v_lshl_add_u32 v144, v145, 4, v144
  s_lshl_b32 s28, s16, 15
  s_add_u32 s28, s28, 32768
  s_lshl_b32 s29, s18, 3
  s_add_u32 m0, s28, 0
  s_nop 0
  buffer_load_dwordx4 v144, s[8:11], s17 offen lds
  s_add_u32 s17, s17, s29
  s_add_u32 m0, s28, 1024
  s_nop 0
  buffer_load_dwordx4 v144, s[8:11], s17 offen lds
  s_add_u32 s17, s17, s29
  s_add_u32 m0, s28, 2048
  s_nop 0
  buffer_load_dwordx4 v144, s[8:11], s17 offen lds
  s_add_u32 s17, s17, s29
  s_add_u32 m0, s28, 3072
  s_nop 0
  buffer_load_dwordx4 v144, s[8:11], s17 offen lds
  s_add_u32 s17, s17, s29
  s_add_u32 m0, s28, 4096
  s_nop 0
  buffer_load_dwordx4 v144, s[8:11], s17 offen lds
  s_add_u32 s17, s17, s29
  s_add_u32 m0, s28, 5120
  s_nop 0
  buffer_load_dwordx4 v144, s[8:11], s17 offen lds
  s_add_u32 s17, s17, s29
  s_add_u32 m0, s28, 6144
  s_nop 0
  buffer_load_dwordx4 v144, s[8:11], s17 offen lds
  s_add_u32 s17, s17, s29
  s_add_u32 m0, s28, 7168
  s_nop 0
  buffer_load_dwordx4 v144, s[8:11], s17 offen lds
  s_add_u32 s17, s17, s29
  s_add_u32 m0, s28, 8192
  s_nop 0
  buffer_load_dwordx4 v144, s[8:11], s17 offen lds
  s_add_u32 s17, s17, s29
  s_add_u32 m0, s28, 9216
  s_nop 0
  buffer_load_dwordx4 v144, s[8:11], s17 offen lds
  s_add_u32 s17, s17, s29
  s_add_u32 m0, s28, 10240
  s_nop 0
  buffer_load_dwordx4 v144, s[8:11], s17 offen lds
  s_add_u32 s17, s17, s29
  s_add_u32 m0, s28, 11264
  s_nop 0
  buffer_load_dwordx4 v144, s[8:11], s17 offen lds
  s_add_u32 s17, s17, s29
  s_add_u32 m0, s28, 12288
  s_nop 0
  buffer_load_dwordx4 v144, s[8:11], s17 offen lds
  s_add_u32 s17, s17, s29
  s_add_u32 m0, s28, 13312
  s_nop 0
  buffer_load_dwordx4 v144, s[8:11], s17 offen lds
  s_add_u32 s17, s17, s29
  s_add_u32 m0, s28, 14336
  s_nop 0
  buffer_load_dwordx4 v144, s[8:11], s17 offen lds
  s_add_u32 s17, s17, s29
  s_add_u32 m0, s28, 15360
  s_nop 0
  buffer_load_dwordx4 v144, s[8:11], s17 offen lds
  s_add_u32 s17, s17, s29
  s_add_u32 m0, s28, 16384
  s_nop 0
  buffer_load_dwordx4 v144, s[8:11], s17 offen lds
  s_add_u32 s17, s17, s29
  s_add_u32 m0, s28, 17408
  s_nop 0
  buffer_load_dwordx4 v144, s[8:11], s17 offen lds
  s_add_u32 s17, s17, s29
  s_add_u32 m0, s28, 18432
  s_nop 0
  buffer_load_dwordx4 v144, s[8:11], s17 offen lds
  s_add_u32 s17, s17, s29
  s_add_u32 m0, s28, 19456
  s_nop 0
  buffer_load_dwordx4 v144, s[8:11], s17 offen lds
  s_add_u32 s17, s17, s29
  s_add_u32 m0, s28, 20480
  s_nop 0
  buffer_load_dwordx4 v144, s[8:11], s17 offen lds
  s_add_u32 s17, s17, s29
  s_add_u32 m0, s28, 21504
  s_nop 0
  buffer_load_dwordx4 v144, s[8:11], s17 offen lds
  s_add_u32 s17, s17, s29
  s_add_u32 m0, s28, 22528
  s_nop 0
  buffer_load_dwordx4 v144, s[8:11], s17 offen lds
  s_add_u32 s17, s17, s29
  s_add_u32 m0, s28, 23552
  s_nop 0
  buffer_load_dwordx4 v144, s[8:11], s17 offen lds
  s_add_u32 s17, s17, s29
  s_add_u32 m0, s28, 24576
  s_nop 0
  buffer_load_dwordx4 v144, s[8:11], s17 offen lds
  s_add_u32 s17, s17, s29
  s_add_u32 m0, s28, 25600
  s_nop 0
  buffer_load_dwordx4 v144, s[8:11], s17 offen lds
  s_add_u32 s17, s17, s29
  s_add_u32 m0, s28, 26624
  s_nop 0
  buffer_load_dwordx4 v144, s[8:11], s17 offen lds
  s_add_u32 s17, s17, s29
  s_add_u32 m0, s28, 27648
  s_nop 0
  buffer_load_dwordx4 v144, s[8:11], s17 offen lds
  s_add_u32 s17, s17, s29
  s_add_u32 m0, s28, 28672
  s_nop 0
  buffer_load_dwordx4 v144, s[8:11], s17 offen lds
  s_add_u32 s17, s17, s29
  s_add_u32 m0, s28, 29696
  s_nop 0
  buffer_load_dwordx4 v144, s[8:11], s17 offen lds
  s_add_u32 s17, s17, s29
  s_add_u32 m0, s28, 30720
  s_nop 0
  buffer_load_dwordx4 v144, s[8:11], s17 offen lds
  s_add_u32 s17, s17, s29
  s_add_u32 m0, s28, 31744
  s_nop 0
  buffer_load_dwordx4 v144, s[8:11], s17 offen lds
  s_add_u32 s17, s17, s29
  s_lshl_b32 s25, s16, 13
  s_add_u32 m0, s25, 0
  s_nop 0
  buffer_load_dwordx4 v16, s[12:15], s19 offen lds
  s_add_u32 m0, s25, 1024
  s_nop 0
  buffer_load_dwordx4 v17, s[12:15], s19 offen lds
  s_add_u32 m0, s25, 2048
  s_nop 0
  buffer_load_dwordx4 v18, s[12:15], s19 offen lds
  s_add_u32 m0, s25, 3072
  s_nop 0
  buffer_load_dwordx4 v19, s[12:15], s19 offen lds
  s_add_u32 m0, s25, 4096
  s_nop 0
  buffer_load_dwordx4 v20, s[12:15], s19 offen lds
  s_add_u32 m0, s25, 5120
  s_nop 0
  buffer_load_dwordx4 v21, s[12:15], s19 offen lds
  s_add_u32 m0, s25, 6144
  s_nop 0
  buffer_load_dwordx4 v22, s[12:15], s19 offen lds
  s_add_u32 m0, s25, 7168
  s_nop 0
  buffer_load_dwordx4 v23, s[12:15], s19 offen lds
  s_cmp_gt_u32 s23, 1
  s_cselect_b32 s26, s20, 0
  s_add_u32 s19, s19, s26
  s_add_u32 s25, s25, 32768
  s_and_b32 s25, s25, 0x1ffff
  s_cmp_lg_u32 s16, 3
  s_cbranch_scc1 M_noinit
  s_mov_b32 s79, 0
  s_atomic_swap s79, s[72:73], s31 glc
  s_waitcnt lgkmcnt(0)
  s_mov_b32 s79, 1
  s_atomic_add s79, s[74:75], 128
M_noinit:
  v_bfe_u32 v148, v1, 2, 2
  v_lshrrev_b32 v149, 5, v1
  v_lshl_add_u32 v148, v149, 3, v148
  v_lshlrev_b32 v148, 7, v148
  v_bfe_u32 v149, v1, 4, 1
  v_lshl_add_u32 v148, v149, 5, v148
  v_and_b32 v149, 3, v1
  v_lshl_add_u32 v148, v149, 3, v148
  v_add_u32 v146, s28, v148
  v_add_u32 v147, 512, v146
  s_waitcnt vmcnt(36)
  ds_read_b64_tr_b16 a[0:1], v146 offset:0
  ds_read_b64_tr_b16 a[2:3], v147 offset:0
  ds_read_b64_tr_b16 a[4:5], v146 offset:64
  ds_read_b64_tr_b16 a[6:7], v147 offset:64
  ds_read_b64_tr_b16 a[8:9], v146 offset:2048
  ds_read_b64_tr_b16 a[10:11], v147 offset:2048
  ds_read_b64_tr_b16 a[12:13], v146 offset:2112
  ds_read_b64_tr_b16 a[14:15], v147 offset:2112
  s_waitcnt lgkmcnt(0)
  s_add_u32 m0, s28, 0
  s_nop 0
  buffer_load_dwordx4 v144, s[8:11], s17 offen lds
  s_add_u32 s17, s17, s29
  s_add_u32 m0, s28, 1024
  s_nop 0
  buffer_load_dwordx4 v144, s[8:11], s17 offen lds
  s_add_u32 s17, s17, s29
  s_add_u32 m0, s28, 2048
  s_nop 0
  buffer_load_dwordx4 v144, s[8:11], s17 offen lds
  s_add_u32 s17, s17, s29
  s_add_u32 m0, s28, 3072
  s_nop 0
  buffer_load_dwordx4 v144, s[8:11], s17 offen lds
  s_add_u32 s17, s17, s29
  s_waitcnt vmcnt(36)
  ds_read_b64_tr_b16 a[16:17], v146 offset:4096
  ds_read_b64_tr_b16 a[18:19], v147 offset:4096
  ds_read_b64_tr_b16 a[20:21], v146 offset:4160
  ds_read_b64_tr_b16 a[22:23], v147 offset:4160
  ds_read_b64_tr_b16 a[24:25], v146 offset:6144
  ds_read_b64_tr_b16 a[26:27], v147 offset:6144
  ds_read_b64_tr_b16 a[28:29], v146 offset:6208
  ds_read_b64_tr_b16 a[30:31], v147 offset:6208
  s_waitcnt lgkmcnt(0)
  s_add_u32 m0, s28, 4096
  s_nop 0
  buffer_load_dwordx4 v144, s[8:11], s17 offen lds
  s_add_u32 s17, s17, s29
  s_add_u32 m0, s28, 5120
  s_nop 0
  buffer_load_dwordx4 v144, s[8:11], s17 offen lds
  s_add_u32 s17, s17, s29
  s_add_u32 m0, s28, 6144
  s_nop 0
  buffer_load_dwordx4 v144, s[8:11], s17 offen lds
  s_add_u32 s17, s17, s29
  s_add_u32 m0, s28, 7168
  s_nop 0
  buffer_load_dwordx4 v144, s[8:11], s17 offen lds
  s_add_u32 s17, s17, s29
  s_waitcnt vmcnt(36)
  ds_read_b64_tr_b16 a[32:33], v146 offset:8192
  ds_read_b64_tr_b16 a[34:35], v147 offset:8192
  ds_read_b64_tr_b16 a[36:37], v146 offset:8256
  ds_read_b64_tr_b16 a[38:39], v147 offset:8256
  ds_read_b64_tr_b16 a[40:41], v146 offset:10240
  ds_read_b64_tr_b16 a[42:43], v147 offset:10240
  ds_read_b64_tr_b16 a[44:45], v146 offset:10304
  ds_read_b64_tr_b16 a[46:47], v147 offset:10304
  s_waitcnt lgkmcnt(0)
  s_add_u32 m0, s28, 8192
  s_nop 0
  buffer_load_dwordx4 v144, s[8:11], s17 offen lds
  s_add_u32 s17, s17, s29
  s_add_u32 m0, s28, 9216
  s_nop 0
  buffer_load_dwordx4 v144, s[8:11], s17 offen lds
  s_add_u32 s17, s17, s29
  s_add_u32 m0, s28, 10240
  s_nop 0
  buffer_load_dwordx4 v144, s[8:11], s17 offen lds
  s_add_u32 s17, s17, s29
  s_add_u32 m0, s28, 11264
  s_nop 0
  buffer_load_dwordx4 v144, s[8:11], s17 offen lds
  s_add_u32 s17, s17, s29
  s_waitcnt vmcnt(36)
  ds_read_b64_tr_b16 a[48:49], v146 offset:12288
  ds_read_b64_tr_b16 a[50:51], v147 offset:12288
  ds_read_b64_tr_b16 a[52:53], v146 offset:12352
  ds_read_b64_tr_b16 a[54:55], v147 offset:12352
  ds_read_b64_tr_b16 a[56:57], v146 offset:14336
  ds_read_b64_tr_b16 a[58:59], v147 offset:14336
  ds_read_b64_tr_b16 a[60:61], v146 offset:14400
  ds_read_b64_tr_b16 a[62:63], v147 offset:14400
  s_waitcnt lgkmcnt(0)
  s_add_u32 m0, s28, 12288
  s_nop 0
  buffer_load_dwordx4 v144, s[8:11], s17 offen lds
  s_add_u32 s17, s17, s29
  s_add_u32 m0, s28, 13312
  s_nop 0
  buffer_load_dwordx4 v144, s[8:11], s17 offen lds
  s_add_u32 s17, s17, s29
  s_add_u32 m0, s28, 14336
  s_nop 0
  buffer_load_dwordx4 v144, s[8:11], s17 offen lds
  s_add_u32 s17, s17, s29
  s_add_u32 m0, s28, 15360
  s_nop 0
  buffer_load_dwordx4 v144, s[8:11], s17 offen lds
  s_add_u32 s17, s17, s29
  s_waitcnt vmcnt(36)
  ds_read_b64_tr_b16 a[64:65], v146 offset:16384
  ds_read_b64_tr_b16 a[66:67], v147 offset:16384
  ds_read_b64_tr_b16 a[68:69], v146 offset:16448
  ds_read_b64_tr_b16 a[70:71], v147 offset:16448
  ds_read_b64_tr_b16 a[72:73], v146 offset:18432
  ds_read_b64_tr_b16 a[74:75], v147 offset:18432
  ds_read_b64_tr_b16 a[76:77], v146 offset:18496
  ds_read_b64_tr_b16 a[78:79], v147 offset:18496
  s_waitcnt lgkmcnt(0)
  s_add_u32 m0, s28, 16384
  s_nop 0
  buffer_load_dwordx4 v144, s[8:11], s17 offen lds
  s_add_u32 s17, s17, s29
  s_add_u32 m0, s28, 17408
  s_nop 0
  buffer_load_dwordx4 v144, s[8:11], s17 offen lds
  s_add_u32 s17, s17, s29
  s_add_u32 m0, s28, 18432
  s_nop 0
  buffer_load_dwordx4 v144, s[8:11], s17 offen lds
  s_add_u32 s17, s17, s29
  s_add_u32 m0, s28, 19456
  s_nop 0
  buffer_load_dwordx4 v144, s[8:11], s17 offen lds
  s_add_u32 s17, s17, s29
  s_waitcnt vmcnt(36)
  ds_read_b64_tr_b16 a[80:81], v146 offset:20480
  ds_read_b64_tr_b16 a[82:83], v147 offset:20480
  ds_read_b64_tr_b16 a[84:85], v146 offset:20544
  ds_read_b64_tr_b16 a[86:87], v147 offset:20544
  ds_read_b64_tr_b16 a[88:89], v146 offset:22528
  ds_read_b64_tr_b16 a[90:91], v147 offset:22528
  ds_read_b64_tr_b16 a[92:93], v146 offset:22592
  ds_read_b64_tr_b16 a[94:95], v147 offset:22592
  s_waitcnt lgkmcnt(0)
  s_add_u32 m0, s28, 20480
  s_nop 0
  buffer_load_dwordx4 v144, s[8:11], s17 offen lds
  s_add_u32 s17, s17, s29
  s_add_u32 m0, s28, 21504
  s_nop 0
  buffer_load_dwordx4 v144, s[8:11], s17 offen lds
  s_add_u32 s17, s17, s29
  s_add_u32 m0, s28, 22528
  s_nop 0
  buffer_load_dwordx4 v144, s[8:11], s17 offen lds
  s_add_u32 s17, s17, s29
  s_add_u32 m0, s28, 23552
  s_nop 0
  buffer_load_dwordx4 v144, s[8:11], s17 offen lds
  s_add_u32 s17, s17, s29
  s_waitcnt vmcnt(36)
  ds_read_b64_tr_b16 a[96:97], v146 offset:24576
  ds_read_b64_tr_b16 a[98:99], v147 offset:24576
  ds_read_b64_tr_b16 a[100:101], v146 offset:24640
  ds_read_b64_tr_b16 a[102:103], v147 offset:24640
  ds_read_b64_tr_b16 a[104:105], v146 offset:26624
  ds_read_b64_tr_b16 a[106:107], v147 offset:26624
  ds_read_b64_tr_b16 a[108:109], v146 offset:26688
  ds_read_b64_tr_b16 a[110:111], v147 offset:26688
  s_waitcnt lgkmcnt(0)
  s_add_u32 m0, s28, 24576
  s_nop 0
  buffer_load_dwordx4 v144, s[8:11], s17 offen lds
  s_add_u32 s17, s17, s29
  s_add_u32 m0, s28, 25600
  s_nop 0
  buffer_load_dwordx4 v144, s[8:11], s17 offen lds
  s_add_u32 s17, s17, s29
  s_add_u32 m0, s28, 26624
  s_nop 0
  buffer_load_dwordx4 v144, s[8:11], s17 offen lds
  s_add_u32 s17, s17, s29
  s_add_u32 m0, s28, 27648
  s_nop 0
  buffer_load_dwordx4 v144, s[8:11], s17 offen lds
  s_add_u32 s17, s17, s29
  s_waitcnt vmcnt(36)
  ds_read_b64_tr_b16 a[112:113], v146 offset:28672
  ds_read_b64_tr_b16 a[114:115], v147 offset:28672
  ds_read_b64_tr_b16 a[116:117], v146 offset:28736
  ds_read_b64_tr_b16 a[118:119], v147 offset:28736
  ds_read_b64_tr_b16 a[120:121], v146 offset:30720
  ds_read_b64_tr_b16 a[122:123], v147 offset:30720
  ds_read_b64_tr_b16 a[124:125], v146 offset:30784
  ds_read_b64_tr_b16 a[126:127], v147 offset:30784
  s_waitcnt lgkmcnt(0)
  s_add_u32 m0, s28, 28672
  s_nop 0
  buffer_load_dwordx4 v144, s[8:11], s17 offen lds
  s_add_u32 s17, s17, s29
  s_add_u32 m0, s28, 29696
  s_nop 0
  buffer_load_dwordx4 v144, s[8:11], s17 offen lds
  s_add_u32 s17, s17, s29
  s_add_u32 m0, s28, 30720
  s_nop 0
  buffer_load_dwordx4 v144, s[8:11], s17 offen lds
  s_add_u32 s17, s17, s29
  s_add_u32 m0, s28, 31744
  s_nop 0
  buffer_load_dwordx4 v144, s[8:11], s17 offen lds
  s_add_u32 s17, s17, s29
  s_waitcnt vmcnt(28)
  ds_read_b64_tr_b16 a[128:129], v146 offset:0
  ds_read_b64_tr_b16 a[130:131], v147 offset:0
  ds_read_b64_tr_b16 a[132:133], v146 offset:64
  ds_read_b64_tr_b16 a[134:135], v147 offset:64
  ds_read_b64_tr_b16 a[136:137], v146 offset:2048
  ds_read_b64_tr_b16 a[138:139], v147 offset:2048
  ds_read_b64_tr_b16 a[140:141], v146 offset:2112
  ds_read_b64_tr_b16 a[142:143], v147 offset:2112
  s_waitcnt lgkmcnt(0)
  s_waitcnt vmcnt(24)
  ds_read_b64_tr_b16 a[144:145], v146 offset:4096
  ds_read_b64_tr_b16 a[146:147], v147 offset:4096
  ds_read_b64_tr_b16 a[148:149], v146 offset:4160
  ds_read_b64_tr_b16 a[150:151], v147 offset:4160
  ds_read_b64_tr_b16 a[152:153], v146 offset:6144
  ds_read_b64_tr_b16 a[154:155], v147 offset:6144
  ds_read_b64_tr_b16 a[156:157], v146 offset:6208
  ds_read_b64_tr_b16 a[158:159], v147 offset:6208
  s_waitcnt lgkmcnt(0)
  s_waitcnt vmcnt(20)
  ds_read_b64_tr_b16 a[160:161], v146 offset:8192
  ds_read_b64_tr_b16 a[162:163], v147 offset:8192
  ds_read_b64_tr_b16 a[164:165], v146 offset:8256
  ds_read_b64_tr_b16 a[166:167], v147 offset:8256
  ds_read_b64_tr_b16 a[168:169], v146 offset:10240
  ds_read_b64_tr_b16 a[170:171], v147 offset:10240
  ds_read_b64_tr_b16 a[172:173], v146 offset:10304
  ds_read_b64_tr_b16 a[174:175], v147 offset:10304
  s_waitcnt lgkmcnt(0)
  s_waitcnt vmcnt(16)
  ds_read_b64_tr_b16 a[176:177], v146 offset:12288
  ds_read_b64_tr_b16 a[178:179], v147 offset:12288
  ds_read_b64_tr_b16 a[180:181], v146 offset:12352
  ds_read_b64_tr_b16 a[182:183], v147 offset:12352
  ds_read_b64_tr_b16 a[184:185], v146 offset:14336
  ds_read_b64_tr_b16 a[186:187], v147 offset:14336
  ds_read_b64_tr_b16 a[188:189], v146 offset:14400
  ds_read_b64_tr_b16 a[190:191], v147 offset:14400
  s_waitcnt lgkmcnt(0)
  s_waitcnt vmcnt(12)
  ds_read_b64_tr_b16 a[192:193], v146 offset:16384
  ds_read_b64_tr_b16 a[194:195], v147 offset:16384
  ds_read_b64_tr_b16 a[196:197], v146 offset:16448
  ds_read_b64_tr_b16 a[198:199], v147 offset:16448
  ds_read_b64_tr_b16 a[200:201], v146 offset:18432
  ds_read_b64_tr_b16 a[202:203], v147 offset:18432
  ds_read_b64_tr_b16 a[204:205], v146 offset:18496
  ds_read_b64_tr_b16 a[206:207], v147 offset:18496
  s_waitcnt lgkmcnt(0)
  s_waitcnt vmcnt(8)
  ds_read_b64_tr_b16 a[208:209], v146 offset:20480
  ds_read_b64_tr_b16 a[210:211], v147 offset:20480
  ds_read_b64_tr_b16 a[212:213], v146 offset:20544
  ds_read_b64_tr_b16 a[214:215], v147 offset:20544
  ds_read_b64_tr_b16 a[216:217], v146 offset:22528
  ds_read_b64_tr_b16 a[218:219], v147 offset:22528
  ds_read_b64_tr_b16 a[220:221], v146 offset:22592
  ds_read_b64_tr_b16 a[222:223], v147 offset:22592
  s_waitcnt lgkmcnt(0)
  s_waitcnt vmcnt(4)
  ds_read_b64_tr_b16 a[224:225], v146 offset:24576
  ds_read_b64_tr_b16 a[226:227], v147 offset:24576
  ds_read_b64_tr_b16 a[228:229], v146 offset:24640
  ds_read_b64_tr_b16 a[230:231], v147 offset:24640
  ds_read_b64_tr_b16 a[232:233], v146 offset:26624
  ds_read_b64_tr_b16 a[234:235], v147 offset:26624
  ds_read_b64_tr_b16 a[236:237], v146 offset:26688
  ds_read_b64_tr_b16 a[238:239], v147 offset:26688
  s_waitcnt lgkmcnt(0)
  s_waitcnt vmcnt(0)
  ds_read_b64_tr_b16 a[240:241], v146 offset:28672
  ds_read_b64_tr_b16 a[242:243], v147 offset:28672
  ds_read_b64_tr_b16 a[244:245], v146 offset:28736
  ds_read_b64_tr_b16 a[246:247], v147 offset:28736
  ds_read_b64_tr_b16 a[248:249], v146 offset:30720
  ds_read_b64_tr_b16 a[250:251], v147 offset:30720
  ds_read_b64_tr_b16 a[252:253], v146 offset:30784
  ds_read_b64_tr_b16 a[254:255], v147 offset:30784
  s_waitcnt lgkmcnt(0)
  s_barrier
  s_add_u32 m0, s25, 0
  s_nop 0
  buffer_load_dwordx4 v16, s[12:15], s19 offen lds
  s_add_u32 m0, s25, 1024
  s_nop 0
  buffer_load_dwordx4 v17, s[12:15], s19 offen lds
  s_add_u32 m0, s25, 2048
  s_nop 0
  buffer_load_dwordx4 v18, s[12:15], s19 offen lds
  s_add_u32 m0, s25, 3072
  s_nop 0
  buffer_load_dwordx4 v19, s[12:15], s19 offen lds
  s_add_u32 m0, s25, 4096
  s_nop 0
  buffer_load_dwordx4 v20, s[12:15], s19 offen lds
  s_add_u32 m0, s25, 5120
  s_nop 0
  buffer_load_dwordx4 v21, s[12:15], s19 offen lds
  s_add_u32 m0, s25, 6144
  s_nop 0
  buffer_load_dwordx4 v22, s[12:15], s19 offen lds
  s_add_u32 m0, s25, 7168
  s_nop 0
  buffer_load_dwordx4 v23, s[12:15], s19 offen lds
  s_cmp_gt_u32 s23, 2
  s_cselect_b32 s26, s20, 0
  s_add_u32 s19, s19, s26
  s_add_u32 s25, s25, 32768
  s_and_b32 s25, s25, 0x1ffff
  s_waitcnt vmcnt(0)
  s_barrier
  s_cmp_eq_u32 s48, 0
  s_cselect_b32 s26, 0, s16
  s_cmp_ge_u32 s26, 2
  s_cbranch_scc1 P_v_1
  s_mov_b32 s27, s21
  v_mov_b32 v7, 0x40000000
  s_mov_b32 s29, -3
  v_min_u32 v145, 1, v0
  v_lshlrev_b32 v145, 30, v145
  ds_read_b128 v[24:27], v8 offset:0
  ds_read_b128 v[28:31], v9 offset:0
  ds_read_b128 v[32:35], v10 offset:0
  ds_read_b128 v[36:39], v11 offset:0
  ds_read_b128 v[40:43], v12 offset:0
  ds_read_b128 v[44:47], v13 offset:0
.p2align 6
G_top_3:
  s_waitcnt lgkmcnt(5)
  v_mfma_f32_32x32x16_bf16 v[64:79], a[0:3], v[24:27], 0
  s_add_u32 m0, s25, 0
  ds_read_b128 v[48:51], v14 offset:0
  v_mfma_f32_32x32x16_bf16 v[80:95], a[4:7], v[24:27], 0
  s_waitcnt lgkmcnt(5)
  buffer_load_dwordx4 v16, s[12:15], s19 offen lds
  v_mfma_f32_32x32x16_bf16 v[64:79], a[8:11], v[28:31], v[64:79]
  ds_read_b128 v[52:55], v15 offset:0
  v_mul_f32 v96, s24, v96
  v_mul_f32 v97, s24, v97
  v_mfma_f32_32x32x16_bf16 v[80:95], a[12:15], v[28:31], v[80:95]
  s_waitcnt lgkmcnt(5)
  v_cvt_pk_bf16_f32 v128, v96, v97
  v_mul_f32 v98, s24, v98
  v_mfma_f32_32x32x16_bf16 v[64:79], a[16:19], v[32:35], v[64:79]
  s_add_u32 m0, s25, 1024
  ds_read_b128 v[24:27], v8 offset:8192
  v_mul_f32 v99, s24, v99
  v_cvt_pk_bf16_f32 v129, v98, v99
  v_mfma_f32_32x32x16_bf16 v[80:95], a[20:23], v[32:35], v[80:95]
  s_waitcnt lgkmcnt(5)
  buffer_load_dwordx4 v17, s[12:15], s19 offen lds
  v_mul_f32 v100, s24, v100
  v_mul_f32 v101, s24, v101
  v_mfma_f32_32x32x16_bf16 v[64:79], a[24:27], v[36:39], v[64:79]
  ds_read_b128 v[28:31], v9 offset:8192
  v_cvt_pk_bf16_f32 v130, v100, v101
  v_mul_f32 v102, s24, v102
  v_mfma_f32_32x32x16_bf16 v[80:95], a[28:31], v[36:39], v[80:95]
  s_waitcnt lgkmcnt(5)
  v_mul_f32 v103, s24, v103
  v_cvt_pk_bf16_f32 v131, v102, v103
  v_mfma_f32_32x32x16_bf16 v[64:79], a[32:35], v[40:43], v[64:79]
  s_add_u32 m0, s25, 2048
  ds_read_b128 v[32:35], v10 offset:8192
  v_mul_f32 v104, s24, v104
  v_mul_f32 v105, s24, v105
  v_mfma_f32_32x32x16_bf16 v[80:95], a[36:39], v[40:43], v[80:95]
  s_waitcnt lgkmcnt(5)
  buffer_load_dwordx4 v18, s[12:15], s19 offen lds
  v_cvt_pk_bf16_f32 v132, v104, v105
  v_mul_f32 v106, s24, v106
  v_mfma_f32_32x32x16_bf16 v[64:79], a[40:43], v[44:47], v[64:79]
  ds_read_b128 v[36:39], v11 offset:8192
  v_mul_f32 v107, s24, v107
  v_cvt_pk_bf16_f32 v133, v106, v107
  v_mfma_f32_32x32x16_bf16 v[80:95], a[44:47], v[44:47], v[80:95]
  s_waitcnt lgkmcnt(5)
  v_mul_f32 v108, s24, v108
  v_mul_f32 v109, s24, v109
  v_mfma_f32_32x32x16_bf16 v[64:79], a[48:51], v[48:51], v[64:79]
  s_add_u32 m0, s25, 3072
  ds_read_b128 v[40:43], v12 offset:8192
  v_cvt_pk_bf16_f32 v134, v108, v109
  v_mul_f32 v110, s24, v110
  v_mfma_f32_32x32x16_bf16 v[80:95], a[52:55], v[48:51], v[80:95]
  s_waitcnt lgkmcnt(5)
  buffer_load_dwordx4 v19, s[12:15], s19 offen lds
  v_mul_f32 v111, s24, v111
  v_cvt_pk_bf16_f32 v135, v110, v111
  v_mfma_f32_32x32x16_bf16 v[64:79], a[56:59], v[52:55], v[64:79]
  ds_read_b128 v[44:47], v13 offset:8192
  v_mul_f32 v112, s24, v112
  v_mul_f32 v113, s24, v113
  v_mfma_f32_32x32x16_bf16 v[80:95], a[60:63], v[52:55], v[80:95]
  s_waitcnt lgkmcnt(5)
  v_cvt_pk_bf16_f32 v136, v112, v113
  v_mul_f32 v114, s24, v114
  v_mfma_f32_32x32x16_bf16 v[64:79], a[64:67], v[24:27], v[64:79]
  s_add_u32 m0, s25, 4096
  ds_read_b128 v[48:51], v14 offset:8192
  v_mul_f32 v115, s24, v115
  v_cvt_pk_bf16_f32 v137, v114, v115
  v_mfma_f32_32x32x16_bf16 v[80:95], a[68:71], v[24:27], v[80:95]
  s_waitcnt lgkmcnt(5)
  buffer_load_dwordx4 v20, s[12:15], s19 offen lds
  v_mul_f32 v116, s24, v116
  v_mul_f32 v117, s24, v117
  v_mfma_f32_32x32x16_bf16 v[64:79], a[72:75], v[28:31], v[64:79]
  ds_read_b128 v[52:55], v15 offset:8192
  v_cvt_pk_bf16_f32 v138, v116, v117
  v_mul_f32 v118, s24, v118
  v_mfma_f32_32x32x16_bf16 v[80:95], a[76:79], v[28:31], v[80:95]
  s_waitcnt lgkmcnt(5)
  v_mul_f32 v119, s24, v119
  v_cvt_pk_bf16_f32 v139, v118, v119
  v_mfma_f32_32x32x16_bf16 v[64:79], a[80:83], v[32:35], v[64:79]
  s_add_u32 m0, s25, 5120
  ds_read_b128 v[24:27], v8 offset:16384
  v_mul_f32 v120, s24, v120
  v_mul_f32 v121, s24, v121
  v_mfma_f32_32x32x16_bf16 v[80:95], a[84:87], v[32:35], v[80:95]
  s_waitcnt lgkmcnt(5)
  buffer_load_dwordx4 v21, s[12:15], s19 offen lds
  v_cvt_pk_bf16_f32 v140, v120, v121
  v_mul_f32 v122, s24, v122
  v_mfma_f32_32x32x16_bf16 v[64:79], a[88:91], v[36:39], v[64:79]
  ds_read_b128 v[28:31], v9 offset:16384
  v_mul_f32 v123, s24, v123
  v_cvt_pk_bf16_f32 v141, v122, v123
  v_mfma_f32_32x32x16_bf16 v[80:95], a[92:95], v[36:39], v[80:95]
  s_waitcnt lgkmcnt(5)
  v_mul_f32 v124, s24, v124
  v_mul_f32 v125, s24, v125
  v_mfma_f32_32x32x16_bf16 v[64:79], a[96:99], v[40:43], v[64:79]
  s_add_u32 m0, s25, 6144
  ds_read_b128 v[32:35], v10 offset:16384
  v_cvt_pk_bf16_f32 v142, v124, v125
  v_mul_f32 v126, s24, v126
  v_mfma_f32_32x32x16_bf16 v[80:95], a[100:103], v[40:43], v[80:95]
  s_waitcnt lgkmcnt(5)
  buffer_load_dwordx4 v22, s[12:15], s19 offen lds
  v_mul_f32 v127, s24, v127
  v_cvt_pk_bf16_f32 v143, v126, v127
  v_mfma_f32_32x32x16_bf16 v[64:79], a[104:107], v[44:47], v[64:79]
  ds_read_b128 v[36:39], v11 offset:16384
  v_mfma_f32_32x32x16_bf16 v[80:95], a[108:111], v[44:47], v[80:95]
  s_waitcnt lgkmcnt(5)
  v_mfma_f32_32x32x16_bf16 v[64:79], a[112:115], v[48:51], v[64:79]
  s_add_u32 m0, s25, 7168
  ds_read_b128 v[40:43], v12 offset:16384
  v_mfma_f32_32x32x16_bf16 v[80:95], a[116:119], v[48:51], v[80:95]
  s_waitcnt lgkmcnt(5)
  buffer_load_dwordx4 v23, s[12:15], s19 offen lds
  v_mfma_f32_32x32x16_bf16 v[64:79], a[120:123], v[52:55], v[64:79]
  s_cmp_gt_u32 s23, 3
  ds_read_b128 v[44:47], v13 offset:16384
  v_mfma_f32_32x32x16_bf16 v[80:95], a[124:127], v[52:55], v[80:95]
  s_waitcnt lgkmcnt(5)
  s_cselect_b32 s26, s20, 0
  v_mfma_f32_32x32x16_bf16 v[64:79], a[128:131], v[24:27], v[64:79]
  s_add_u32 s19, s19, s26
  ds_read_b128 v[48:51], v14 offset:16384
  v_mfma_f32_32x32x16_bf16 v[80:95], a[132:135], v[24:27], v[80:95]
  s_waitcnt lgkmcnt(5)
  s_add_u32 s25, s25, 32768
  v_mfma_f32_32x32x16_bf16 v[64:79], a[136:139], v[28:31], v[64:79]
  s_and_b32 s25, s25, 0x1ffff
  ds_read_b128 v[52:55], v15 offset:16384
  v_mfma_f32_32x32x16_bf16 v[80:95], a[140:143], v[28:31], v[80:95]
  s_waitcnt lgkmcnt(5)
  buffer_store_dwordx4 v[128:131], v7, s[4:7], s21 offen offset:0 sc1
  v_mfma_f32_32x32x16_bf16 v[64:79], a[144:147], v[32:35], v[64:79]
  ds_read_b128 v[24:27], v8 offset:24576
  v_mfma_f32_32x32x16_bf16 v[80:95], a[148:151], v[32:35], v[80:95]
  s_waitcnt lgkmcnt(5)
  v_mfma_f32_32x32x16_bf16 v[64:79], a[152:155], v[36:39], v[64:79]
  ds_read_b128 v[28:31], v9 offset:24576
  v_mfma_f32_32x32x16_bf16 v[80:95], a[156:159], v[36:39], v[80:95]
  s_waitcnt lgkmcnt(5)
  buffer_store_dwordx4 v[132:135], v7, s[4:7], s21 offen offset:1024 sc1
  v_mfma_f32_32x32x16_bf16 v[64:79], a[160:163], v[40:43], v[64:79]
  ds_read_b128 v[32:35], v10 offset:24576
  v_mfma_f32_32x32x16_bf16 v[80:95], a[164:167], v[40:43], v[80:95]
  s_waitcnt lgkmcnt(5)
  v_mfma_f32_32x32x16_bf16 v[64:79], a[168:171], v[44:47], v[64:79]
  ds_read_b128 v[36:39], v11 offset:24576
  v_mfma_f32_32x32x16_bf16 v[80:95], a[172:175], v[44:47], v[80:95]
  s_waitcnt lgkmcnt(5)
  buffer_store_dwordx4 v[136:139], v7, s[4:7], s21 offen offset:2048 sc1
  v_mfma_f32_32x32x16_bf16 v[64:79], a[176:179], v[48:51], v[64:79]
  ds_read_b128 v[40:43], v12 offset:24576
  v_mfma_f32_32x32x16_bf16 v[80:95], a[180:183], v[48:51], v[80:95]
  s_waitcnt lgkmcnt(5)
  v_mfma_f32_32x32x16_bf16 v[64:79], a[184:187], v[52:55], v[64:79]
  ds_read_b128 v[44:47], v13 offset:24576
  v_mfma_f32_32x32x16_bf16 v[80:95], a[188:191], v[52:55], v[80:95]
  s_waitcnt lgkmcnt(5)
  buffer_store_dwordx4 v[140:143], v7, s[4:7], s21 offen offset:3072 sc1
  v_mfma_f32_32x32x16_bf16 v[64:79], a[192:195], v[24:27], v[64:79]
  s_mov_b32 s21, s27
  ds_read_b128 v[48:51], v14 offset:24576
  v_mov_b32 v7, v2
  v_mfma_f32_32x32x16_bf16 v[80:95], a[196:199], v[24:27], v[80:95]
  s_waitcnt lgkmcnt(5)
  v_mfma_f32_32x32x16_bf16 v[64:79], a[200:203], v[28:31], v[64:79]
  s_add_u32 s27, s27, s22
  ds_read_b128 v[52:55], v15 offset:24576
  v_mfma_f32_32x32x16_bf16 v[80:95], a[204:207], v[28:31], v[80:95]
  s_waitcnt lgkmcnt(5)
  s_waitcnt vmcnt(17)
  s_barrier
  v_mfma_f32_32x32x16_bf16 v[64:79], a[208:211], v[32:35], v[64:79]
  ds_read_b128 v[24:27], v8 offset:32768
  v_mfma_f32_32x32x16_bf16 v[80:95], a[212:215], v[32:35], v[80:95]
  s_waitcnt lgkmcnt(5)
  v_mfma_f32_32x32x16_bf16 v[64:79], a[216:219], v[36:39], v[64:79]
  s_add_u32 s29, s29, 1
  ds_read_b128 v[28:31], v9 offset:32768
  v_mfma_f32_32x32x16_bf16 v[80:95], a[220:223], v[36:39], v[80:95]
  s_waitcnt lgkmcnt(5)
  s_max_i32 s30, s29, 0
  v_mov_b32 v144, s30
  v_mfma_f32_32x32x16_bf16 v[64:79], a[224:227], v[40:43], v[64:79]
  ds_read_b128 v[32:35], v10 offset:32768
  v_mfma_f32_32x32x16_bf16 v[80:95], a[228:231], v[40:43], v[80:95]
  s_waitcnt lgkmcnt(5)
  buffer_store_dword v144, v145, s[4:7], s31 offen sc1
  v_mfma_f32_32x32x16_bf16 v[64:79], a[232:235], v[44:47], v[64:79]
  ds_read_b128 v[36:39], v11 offset:32768
  v_mfma_f32_32x32x16_bf16 v[80:95], a[236:239], v[44:47], v[80:95]
  s_waitcnt lgkmcnt(5)
  v_mfma_f32_32x32x16_bf16 v[64:79], a[240:243], v[48:51], v[64:79]
  s_sub_u32 s23, s23, 1
  ds_read_b128 v[40:43], v12 offset:32768
  v_mfma_f32_32x32x16_bf16 v[80:95], a[244:247], v[48:51], v[80:95]
  s_waitcnt lgkmcnt(5)
  v_mfma_f32_32x32x16_bf16 v[64:79], a[248:251], v[52:55], v[64:79]
  s_cmp_eq_u32 s23, 0
  ds_read_b128 v[44:47], v13 offset:32768
  v_mfma_f32_32x32x16_bf16 v[80:95], a[252:255], v[52:55], v[80:95]
  s_cbranch_scc1 G_done0_4
  s_waitcnt lgkmcnt(5)
  v_mfma_f32_32x32x16_bf16 v[96:111], a[0:3], v[24:27], 0
  s_add_u32 m0, s25, 0
  ds_read_b128 v[48:51], v14 offset:32768
  v_mfma_f32_32x32x16_bf16 v[112:127], a[4:7], v[24:27], 0
  s_waitcnt lgkmcnt(5)
  buffer_load_dwordx4 v16, s[12:15], s19 offen lds
  v_mfma_f32_32x32x16_bf16 v[96:111], a[8:11], v[28:31], v[96:111]
  ds_read_b128 v[52:55], v15 offset:32768
  v_mul_f32 v64, s24, v64
  v_mul_f32 v65, s24, v65
  v_mfma_f32_32x32x16_bf16 v[112:127], a[12:15], v[28:31], v[112:127]
  s_waitcnt lgkmcnt(5)
  v_cvt_pk_bf16_f32 v128, v64, v65
  v_mul_f32 v66, s24, v66
  v_mfma_f32_32x32x16_bf16 v[96:111], a[16:19], v[32:35], v[96:111]
  s_add_u32 m0, s25, 1024
  ds_read_b128 v[24:27], v8 offset:40960
  v_mul_f32 v67, s24, v67
  v_cvt_pk_bf16_f32 v129, v66, v67
  v_mfma_f32_32x32x16_bf16 v[112:127], a[20:23], v[32:35], v[112:127]
  s_waitcnt lgkmcnt(5)
  buffer_load_dwordx4 v17, s[12:15], s19 offen lds
  v_mul_f32 v68, s24, v68
  v_mul_f32 v69, s24, v69
  v_mfma_f32_32x32x16_bf16 v[96:111], a[24:27], v[36:39], v[96:111]
  ds_read_b128 v[28:31], v9 offset:40960
  v_cvt_pk_bf16_f32 v130, v68, v69
  v_mul_f32 v70, s24, v70
  v_mfma_f32_32x32x16_bf16 v[112:127], a[28:31], v[36:39], v[112:127]
  s_waitcnt lgkmcnt(5)
  v_mul_f32 v71, s24, v71
  v_cvt_pk_bf16_f32 v131, v70, v71
  v_mfma_f32_32x32x16_bf16 v[96:111], a[32:35], v[40:43], v[96:111]
  s_add_u32 m0, s25, 2048
  ds_read_b128 v[32:35], v10 offset:40960
  v_mul_f32 v72, s24, v72
  v_mul_f32 v73, s24, v73
  v_mfma_f32_32x32x16_bf16 v[112:127], a[36:39], v[40:43], v[112:127]
  s_waitcnt lgkmcnt(5)
  buffer_load_dwordx4 v18, s[12:15], s19 offen lds
  v_cvt_pk_bf16_f32 v132, v72, v73
  v_mul_f32 v74, s24, v74
  v_mfma_f32_32x32x16_bf16 v[96:111], a[40:43], v[44:47], v[96:111]
  ds_read_b128 v[36:39], v11 offset:40960
  v_mul_f32 v75, s24, v75
  v_cvt_pk_bf16_f32 v133, v74, v75
  v_mfma_f32_32x32x16_bf16 v[112:127], a[44:47], v[44:47], v[112:127]
  s_waitcnt lgkmcnt(5)
  v_mul_f32 v76, s24, v76
  v_mul_f32 v77, s24, v77
  v_mfma_f32_32x32x16_bf16 v[96:111], a[48:51], v[48:51], v[96:111]
  s_add_u32 m0, s25, 3072
  ds_read_b128 v[40:43], v12 offset:40960
  v_cvt_pk_bf16_f32 v134, v76, v77
  v_mul_f32 v78, s24, v78
  v_mfma_f32_32x32x16_bf16 v[112:127], a[52:55], v[48:51], v[112:127]
  s_waitcnt lgkmcnt(5)
  buffer_load_dwordx4 v19, s[12:15], s19 offen lds
  v_mul_f32 v79, s24, v79
  v_cvt_pk_bf16_f32 v135, v78, v79
  v_mfma_f32_32x32x16_bf16 v[96:111], a[56:59], v[52:55], v[96:111]
  ds_read_b128 v[44:47], v13 offset:40960
  v_mul_f32 v80, s24, v80
  v_mul_f32 v81, s24, v81
  v_mfma_f32_32x32x16_bf16 v[112:127], a[60:63], v[52:55], v[112:127]
  s_waitcnt lgkmcnt(5)
  v_cvt_pk_bf16_f32 v136, v80, v81
  v_mul_f32 v82, s24, v82
  v_mfma_f32_32x32x16_bf16 v[96:111], a[64:67], v[24:27], v[96:111]
  s_add_u32 m0, s25, 4096
  ds_read_b128 v[48:51], v14 offset:40960
  v_mul_f32 v83, s24, v83
  v_cvt_pk_bf16_f32 v137, v82, v83
  v_mfma_f32_32x32x16_bf16 v[112:127], a[68:71], v[24:27], v[112:127]
  s_waitcnt lgkmcnt(5)
  buffer_load_dwordx4 v20, s[12:15], s19 offen lds
  v_mul_f32 v84, s24, v84
  v_mul_f32 v85, s24, v85
  v_mfma_f32_32x32x16_bf16 v[96:111], a[72:75], v[28:31], v[96:111]
  ds_read_b128 v[52:55], v15 offset:40960
  v_cvt_pk_bf16_f32 v138, v84, v85
  v_mul_f32 v86, s24, v86
  v_mfma_f32_32x32x16_bf16 v[112:127], a[76:79], v[28:31], v[112:127]
  s_waitcnt lgkmcnt(5)
  v_mul_f32 v87, s24, v87
  v_cvt_pk_bf16_f32 v139, v86, v87
  v_mfma_f32_32x32x16_bf16 v[96:111], a[80:83], v[32:35], v[96:111]
  s_add_u32 m0, s25, 5120
  ds_read_b128 v[24:27], v8 offset:49152
  v_mul_f32 v88, s24, v88
  v_mul_f32 v89, s24, v89
  v_mfma_f32_32x32x16_bf16 v[112:127], a[84:87], v[32:35], v[112:127]
  s_waitcnt lgkmcnt(5)
  buffer_load_dwordx4 v21, s[12:15], s19 offen lds
  v_cvt_pk_bf16_f32 v140, v88, v89
  v_mul_f32 v90, s24, v90
  v_mfma_f32_32x32x16_bf16 v[96:111], a[88:91], v[36:39], v[96:111]
  ds_read_b128 v[28:31], v9 offset:49152
  v_mul_f32 v91, s24, v91
  v_cvt_pk_bf16_f32 v141, v90, v91
  v_mfma_f32_32x32x16_bf16 v[112:127], a[92:95], v[36:39], v[112:127]
  s_waitcnt lgkmcnt(5)
  v_mul_f32 v92, s24, v92
  v_mul_f32 v93, s24, v93
  v_mfma_f32_32x32x16_bf16 v[96:111], a[96:99], v[40:43], v[96:111]
  s_add_u32 m0, s25, 6144
  ds_read_b128 v[32:35], v10 offset:49152
  v_cvt_pk_bf16_f32 v142, v92, v93
  v_mul_f32 v94, s24, v94
  v_mfma_f32_32x32x16_bf16 v[112:127], a[100:103], v[40:43], v[112:127]
  s_waitcnt lgkmcnt(5)
  buffer_load_dwordx4 v22, s[12:15], s19 offen lds
  v_mul_f32 v95, s24, v95
  v_cvt_pk_bf16_f32 v143, v94, v95
  v_mfma_f32_32x32x16_bf16 v[96:111], a[104:107], v[44:47], v[96:111]
  ds_read_b128 v[36:39], v11 offset:49152
  v_mfma_f32_32x32x16_bf16 v[112:127], a[108:111], v[44:47], v[112:127]
  s_waitcnt lgkmcnt(5)
  v_mfma_f32_32x32x16_bf16 v[96:111], a[112:115], v[48:51], v[96:111]
  s_add_u32 m0, s25, 7168
  ds_read_b128 v[40:43], v12 offset:49152
  v_mfma_f32_32x32x16_bf16 v[112:127], a[116:119], v[48:51], v[112:127]
  s_waitcnt lgkmcnt(5)
  buffer_load_dwordx4 v23, s[12:15], s19 offen lds
  v_mfma_f32_32x32x16_bf16 v[96:111], a[120:123], v[52:55], v[96:111]
  s_cmp_gt_u32 s23, 3
  ds_read_b128 v[44:47], v13 offset:49152
  v_mfma_f32_32x32x16_bf16 v[112:127], a[124:127], v[52:55], v[112:127]
  s_waitcnt lgkmcnt(5)
  s_cselect_b32 s26, s20, 0
  v_mfma_f32_32x32x16_bf16 v[96:111], a[128:131], v[24:27], v[96:111]
  s_add_u32 s19, s19, s26
  ds_read_b128 v[48:51], v14 offset:49152
  v_mfma_f32_32x32x16_bf16 v[112:127], a[132:135], v[24:27], v[112:127]
  s_waitcnt lgkmcnt(5)
  s_add_u32 s25, s25, 32768
  v_mfma_f32_32x32x16_bf16 v[96:111], a[136:139], v[28:31], v[96:111]
  s_and_b32 s25, s25, 0x1ffff
  ds_read_b128 v[52:55], v15 offset:49152
  v_mfma_f32_32x32x16_bf16 v[112:127], a[140:143], v[28:31], v[112:127]
  s_waitcnt lgkmcnt(5)
  buffer_store_dwordx4 v[128:131], v7, s[4:7], s21 offen offset:0 sc1
  v_mfma_f32_32x32x16_bf16 v[96:111], a[144:147], v[32:35], v[96:111]
  ds_read_b128 v[24:27], v8 offset:57344
  v_mfma_f32_32x32x16_bf16 v[112:127], a[148:151], v[32:35], v[112:127]
  s_waitcnt lgkmcnt(5)
  v_xor_b32 v8, 0x10000, v8
  v_mfma_f32_32x32x16_bf16 v[96:111], a[152:155], v[36:39], v[96:111]
  ds_read_b128 v[28:31], v9 offset:57344
  v_mfma_f32_32x32x16_bf16 v[112:127], a[156:159], v[36:39], v[112:127]
  s_waitcnt lgkmcnt(5)
  buffer_store_dwordx4 v[132:135], v7, s[4:7], s21 offen offset:1024 sc1
  v_xor_b32 v9, 0x10000, v9
  v_mfma_f32_32x32x16_bf16 v[96:111], a[160:163], v[40:43], v[96:111]
  ds_read_b128 v[32:35], v10 offset:57344
  v_mfma_f32_32x32x16_bf16 v[112:127], a[164:167], v[40:43], v[112:127]
  s_waitcnt lgkmcnt(5)
  v_xor_b32 v10, 0x10000, v10
  v_mfma_f32_32x32x16_bf16 v[96:111], a[168:171], v[44:47], v[96:111]
  ds_read_b128 v[36:39], v11 offset:57344
  v_mfma_f32_32x32x16_bf16 v[112:127], a[172:175], v[44:47], v[112:127]
  s_waitcnt lgkmcnt(5)
  buffer_store_dwordx4 v[136:139], v7, s[4:7], s21 offen offset:2048 sc1
  v_xor_b32 v11, 0x10000, v11
  v_mfma_f32_32x32x16_bf16 v[96:111], a[176:179], v[48:51], v[96:111]
  ds_read_b128 v[40:43], v12 offset:57344
  v_mfma_f32_32x32x16_bf16 v[112:127], a[180:183], v[48:51], v[112:127]
  s_waitcnt lgkmcnt(5)
  v_xor_b32 v12, 0x10000, v12
  v_mfma_f32_32x32x16_bf16 v[96:111], a[184:187], v[52:55], v[96:111]
  ds_read_b128 v[44:47], v13 offset:57344
  v_mfma_f32_32x32x16_bf16 v[112:127], a[188:191], v[52:55], v[112:127]
  s_waitcnt lgkmcnt(5)
  buffer_store_dwordx4 v[140:143], v7, s[4:7], s21 offen offset:3072 sc1
  v_xor_b32 v13, 0x10000, v13
  v_mfma_f32_32x32x16_bf16 v[96:111], a[192:195], v[24:27], v[96:111]
  s_mov_b32 s21, s27
  ds_read_b128 v[48:51], v14 offset:57344
  v_mov_b32 v7, v2
  v_mfma_f32_32x32x16_bf16 v[112:127], a[196:199], v[24:27], v[112:127]
  s_waitcnt lgkmcnt(5)
  v_xor_b32 v14, 0x10000, v14
  v_mfma_f32_32x32x16_bf16 v[96:111], a[200:203], v[28:31], v[96:111]
  s_add_u32 s27, s27, s22
  ds_read_b128 v[52:55], v15 offset:57344
  v_mfma_f32_32x32x16_bf16 v[112:127], a[204:207], v[28:31], v[112:127]
  s_waitcnt lgkmcnt(5)
  s_waitcnt vmcnt(17)
  s_barrier
  v_xor_b32 v15, 0x10000, v15
  v_mfma_f32_32x32x16_bf16 v[96:111], a[208:211], v[32:35], v[96:111]
  ds_read_b128 v[24:27], v8 offset:0
  v_mfma_f32_32x32x16_bf16 v[112:127], a[212:215], v[32:35], v[112:127]
  s_waitcnt lgkmcnt(5)
  v_mfma_f32_32x32x16_bf16 v[96:111], a[216:219], v[36:39], v[96:111]
  s_add_u32 s29, s29, 1
  ds_read_b128 v[28:31], v9 offset:0
  v_mfma_f32_32x32x16_bf16 v[112:127], a[220:223], v[36:39], v[112:127]
  s_waitcnt lgkmcnt(5)
  s_max_i32 s30, s29, 0
  v_mov_b32 v144, s30
  v_mfma_f32_32x32x16_bf16 v[96:111], a[224:227], v[40:43], v[96:111]
  ds_read_b128 v[32:35], v10 offset:0
  v_mfma_f32_32x32x16_bf16 v[112:127], a[228:231], v[40:43], v[112:127]
  s_waitcnt lgkmcnt(5)
  buffer_store_dword v144, v145, s[4:7], s31 offen sc1
  v_mfma_f32_32x32x16_bf16 v[96:111], a[232:235], v[44:47], v[96:111]
  ds_read_b128 v[36:39], v11 offset:0
  v_mfma_f32_32x32x16_bf16 v[112:127], a[236:239], v[44:47], v[112:127]
  s_waitcnt lgkmcnt(5)
  v_mfma_f32_32x32x16_bf16 v[96:111], a[240:243], v[48:51], v[96:111]
  s_sub_u32 s23, s23, 1
  ds_read_b128 v[40:43], v12 offset:0
  v_mfma_f32_32x32x16_bf16 v[112:127], a[244:247], v[48:51], v[112:127]
  s_waitcnt lgkmcnt(5)
  v_mfma_f32_32x32x16_bf16 v[96:111], a[248:251], v[52:55], v[96:111]
  s_cmp_eq_u32 s23, 0
  ds_read_b128 v[44:47], v13 offset:0
  v_mfma_f32_32x32x16_bf16 v[112:127], a[252:255], v[52:55], v[112:127]
  s_cbranch_scc1 G_done1_5
  s_branch G_top_3
G_done0_4:
  s_nop 7
  s_nop 3
  v_mul_f32 v64, s24, v64
  v_mul_f32 v65, s24, v65
  v_cvt_pk_bf16_f32 v128, v64, v65
  v_mul_f32 v66, s24, v66
  v_mul_f32 v67, s24, v67
  v_cvt_pk_bf16_f32 v129, v66, v67
  v_mul_f32 v68, s24, v68
  v_mul_f32 v69, s24, v69
  v_cvt_pk_bf16_f32 v130, v68, v69
  v_mul_f32 v70, s24, v70
  v_mul_f32 v71, s24, v71
  v_cvt_pk_bf16_f32 v131, v70, v71
  buffer_store_dwordx4 v[128:131], v7, s[4:7], s21 offen offset:0 sc1
  v_mul_f32 v72, s24, v72
  v_mul_f32 v73, s24, v73
  v_cvt_pk_bf16_f32 v132, v72, v73
  v_mul_f32 v74, s24, v74
  v_mul_f32 v75, s24, v75
  v_cvt_pk_bf16_f32 v133, v74, v75
  v_mul_f32 v76, s24, v76
  v_mul_f32 v77, s24, v77
  v_cvt_pk_bf16_f32 v134, v76, v77
  v_mul_f32 v78, s24, v78
  v_mul_f32 v79, s24, v79
  v_cvt_pk_bf16_f32 v135, v78, v79
  buffer_store_dwordx4 v[132:135], v7, s[4:7], s21 offen offset:1024 sc1
  v_mul_f32 v80, s24, v80
  v_mul_f32 v81, s24, v81
  v_cvt_pk_bf16_f32 v136, v80, v81
  v_mul_f32 v82, s24, v82
  v_mul_f32 v83, s24, v83
  v_cvt_pk_bf16_f32 v137, v82, v83
  v_mul_f32 v84, s24, v84
  v_mul_f32 v85, s24, v85
  v_cvt_pk_bf16_f32 v138, v84, v85
  v_mul_f32 v86, s24, v86
  v_mul_f32 v87, s24, v87
  v_cvt_pk_bf16_f32 v139, v86, v87
  buffer_store_dwordx4 v[136:139], v7, s[4:7], s21 offen offset:2048 sc1
  v_mul_f32 v88, s24, v88
  v_mul_f32 v89, s24, v89
  v_cvt_pk_bf16_f32 v140, v88, v89
  v_mul_f32 v90, s24, v90
  v_mul_f32 v91, s24, v91
  v_cvt_pk_bf16_f32 v141, v90, v91
  v_mul_f32 v92, s24, v92
  v_mul_f32 v93, s24, v93
  v_cvt_pk_bf16_f32 v142, v92, v93
  v_mul_f32 v94, s24, v94
  v_mul_f32 v95, s24, v95
  v_cvt_pk_bf16_f32 v143, v94, v95
  buffer_store_dwordx4 v[140:143], v7, s[4:7], s21 offen offset:3072 sc1
  s_branch G_fin_6
G_done1_5:
  s_nop 7
  s_nop 3
  v_mul_f32 v96, s24, v96
  v_mul_f32 v97, s24, v97
  v_cvt_pk_bf16_f32 v128, v96, v97
  v_mul_f32 v98, s24, v98
  v_mul_f32 v99, s24, v99
  v_cvt_pk_bf16_f32 v129, v98, v99
  v_mul_f32 v100, s24, v100
  v_mul_f32 v101, s24, v101
  v_cvt_pk_bf16_f32 v130, v100, v101
  v_mul_f32 v102, s24, v102
  v_mul_f32 v103, s24, v103
  v_cvt_pk_bf16_f32 v131, v102, v103
  buffer_store_dwordx4 v[128:131], v7, s[4:7], s21 offen offset:0 sc1
  v_mul_f32 v104, s24, v104
  v_mul_f32 v105, s24, v105
  v_cvt_pk_bf16_f32 v132, v104, v105
  v_mul_f32 v106, s24, v106
  v_mul_f32 v107, s24, v107
  v_cvt_pk_bf16_f32 v133, v106, v107
  v_mul_f32 v108, s24, v108
  v_mul_f32 v109, s24, v109
  v_cvt_pk_bf16_f32 v134, v108, v109
  v_mul_f32 v110, s24, v110
  v_mul_f32 v111, s24, v111
  v_cvt_pk_bf16_f32 v135, v110, v111
  buffer_store_dwordx4 v[132:135], v7, s[4:7], s21 offen offset:1024 sc1
  v_mul_f32 v112, s24, v112
  v_mul_f32 v113, s24, v113
  v_cvt_pk_bf16_f32 v136, v112, v113
  v_mul_f32 v114, s24, v114
  v_mul_f32 v115, s24, v115
  v_cvt_pk_bf16_f32 v137, v114, v115
  v_mul_f32 v116, s24, v116
  v_mul_f32 v117, s24, v117
  v_cvt_pk_bf16_f32 v138, v116, v117
  v_mul_f32 v118, s24, v118
  v_mul_f32 v119, s24, v119
  v_cvt_pk_bf16_f32 v139, v118, v119
  buffer_store_dwordx4 v[136:139], v7, s[4:7], s21 offen offset:2048 sc1
  v_mul_f32 v120, s24, v120
  v_mul_f32 v121, s24, v121
  v_cvt_pk_bf16_f32 v140, v120, v121
  v_mul_f32 v122, s24, v122
  v_mul_f32 v123, s24, v123
  v_cvt_pk_bf16_f32 v141, v122, v123
  v_mul_f32 v124, s24, v124
  v_mul_f32 v125, s24, v125
  v_cvt_pk_bf16_f32 v142, v124, v125
  v_mul_f32 v126, s24, v126
  v_mul_f32 v127, s24, v127
  v_cvt_pk_bf16_f32 v143, v126, v127
  buffer_store_dwordx4 v[140:143], v7, s[4:7], s21 offen offset:3072 sc1
G_fin_6:
  s_waitcnt vmcnt(0) lgkmcnt(0)
  s_barrier
  s_add_u32 s30, s29, 3
  v_mov_b32 v144, s30
  v_min_u32 v145, 1, v0
  v_lshlrev_b32 v145, 30, v145
  buffer_store_dword v144, v145, s[4:7], s31 offen sc1
  s_branch P_end_2
P_v_1:
  s_mov_b32 s27, s21
  v_mov_b32 v7, 0x40000000
  s_mov_b32 s29, -3
  v_min_u32 v145, 1, v0
  v_lshlrev_b32 v145, 30, v145
  ds_read_b128 v[24:27], v8 offset:0
  ds_read_b128 v[28:31], v9 offset:0
  ds_read_b128 v[32:35], v10 offset:0
  ds_read_b128 v[36:39], v11 offset:0
  ds_read_b128 v[40:43], v12 offset:0
  ds_read_b128 v[44:47], v13 offset:0
.p2align 6
G_top_7:
  s_waitcnt lgkmcnt(5)
  v_mfma_f32_32x32x16_bf16 v[64:79], v[24:27], a[0:3], 0
  s_add_u32 m0, s25, 0
  ds_read_b128 v[48:51], v14 offset:0
  v_mfma_f32_32x32x16_bf16 v[80:95], v[24:27], a[4:7], 0
  s_waitcnt lgkmcnt(5)
  buffer_load_dwordx4 v16, s[12:15], s19 offen lds
  v_mfma_f32_32x32x16_bf16 v[64:79], v[28:31], a[8:11], v[64:79]
  ds_read_b128 v[52:55], v15 offset:0
  v_mul_f32 v96, s24, v96
  v_mul_f32 v97, s24, v97
  v_mfma_f32_32x32x16_bf16 v[80:95], v[28:31], a[12:15], v[80:95]
  s_waitcnt lgkmcnt(5)
  v_cvt_pk_bf16_f32 v128, v96, v97
  v_mul_f32 v98, s24, v98
  v_mfma_f32_32x32x16_bf16 v[64:79], v[32:35], a[16:19], v[64:79]
  s_add_u32 m0, s25, 1024
  ds_read_b128 v[24:27], v8 offset:8192
  v_mul_f32 v99, s24, v99
  v_cvt_pk_bf16_f32 v129, v98, v99
  v_mfma_f32_32x32x16_bf16 v[80:95], v[32:35], a[20:23], v[80:95]
  s_waitcnt lgkmcnt(5)
  buffer_load_dwordx4 v17, s[12:15], s19 offen lds
  v_mul_f32 v100, s24, v100
  v_mul_f32 v101, s24, v101
  v_mfma_f32_32x32x16_bf16 v[64:79], v[36:39], a[24:27], v[64:79]
  ds_read_b128 v[28:31], v9 offset:8192
  v_cvt_pk_bf16_f32 v130, v100, v101
  v_mul_f32 v102, s24, v102
  v_mfma_f32_32x32x16_bf16 v[80:95], v[36:39], a[28:31], v[80:95]
  s_waitcnt lgkmcnt(5)
  v_mul_f32 v103, s24, v103
  v_cvt_pk_bf16_f32 v131, v102, v103
  v_mfma_f32_32x32x16_bf16 v[64:79], v[40:43], a[32:35], v[64:79]
  s_add_u32 m0, s25, 2048
  ds_read_b128 v[32:35], v10 offset:8192
  v_mul_f32 v104, s24, v104
  v_mul_f32 v105, s24, v105
  v_mfma_f32_32x32x16_bf16 v[80:95], v[40:43], a[36:39], v[80:95]
  s_waitcnt lgkmcnt(5)
  buffer_load_dwordx4 v18, s[12:15], s19 offen lds
  v_cvt_pk_bf16_f32 v132, v104, v105
  v_mul_f32 v106, s24, v106
  v_mfma_f32_32x32x16_bf16 v[64:79], v[44:47], a[40:43], v[64:79]
  ds_read_b128 v[36:39], v11 offset:8192
  v_mul_f32 v107, s24, v107
  v_cvt_pk_bf16_f32 v133, v106, v107
  v_mfma_f32_32x32x16_bf16 v[80:95], v[44:47], a[44:47], v[80:95]
  s_waitcnt lgkmcnt(5)
  v_mul_f32 v108, s24, v108
  v_mul_f32 v109, s24, v109
  v_mfma_f32_32x32x16_bf16 v[64:79], v[48:51], a[48:51], v[64:79]
  s_add_u32 m0, s25, 3072
  ds_read_b128 v[40:43], v12 offset:8192
  v_cvt_pk_bf16_f32 v134, v108, v109
  v_mul_f32 v110, s24, v110
  v_mfma_f32_32x32x16_bf16 v[80:95], v[48:51], a[52:55], v[80:95]
  s_waitcnt lgkmcnt(5)
  buffer_load_dwordx4 v19, s[12:15], s19 offen lds
  v_mul_f32 v111, s24, v111
  v_cvt_pk_bf16_f32 v135, v110, v111
  v_mfma_f32_32x32x16_bf16 v[64:79], v[52:55], a[56:59], v[64:79]
  ds_read_b128 v[44:47], v13 offset:8192
  v_mul_f32 v112, s24, v112
  v_mul_f32 v113, s24, v113
  v_mfma_f32_32x32x16_bf16 v[80:95], v[52:55], a[60:63], v[80:95]
  s_waitcnt lgkmcnt(5)
  v_cvt_pk_bf16_f32 v136, v112, v113
  v_mul_f32 v114, s24, v114
  v_mfma_f32_32x32x16_bf16 v[64:79], v[24:27], a[64:67], v[64:79]
  s_add_u32 m0, s25, 4096
  ds_read_b128 v[48:51], v14 offset:8192
  v_mul_f32 v115, s24, v115
  v_cvt_pk_bf16_f32 v137, v114, v115
  v_mfma_f32_32x32x16_bf16 v[80:95], v[24:27], a[68:71], v[80:95]
  s_waitcnt lgkmcnt(5)
  buffer_load_dwordx4 v20, s[12:15], s19 offen lds
  v_mul_f32 v116, s24, v116
  v_mul_f32 v117, s24, v117
  v_mfma_f32_32x32x16_bf16 v[64:79], v[28:31], a[72:75], v[64:79]
  ds_read_b128 v[52:55], v15 offset:8192
  v_cvt_pk_bf16_f32 v138, v116, v117
  v_mul_f32 v118, s24, v118
  v_mfma_f32_32x32x16_bf16 v[80:95], v[28:31], a[76:79], v[80:95]
  s_waitcnt lgkmcnt(5)
  v_mul_f32 v119, s24, v119
  v_cvt_pk_bf16_f32 v139, v118, v119
  v_mfma_f32_32x32x16_bf16 v[64:79], v[32:35], a[80:83], v[64:79]
  s_add_u32 m0, s25, 5120
  ds_read_b128 v[24:27], v8 offset:16384
  v_mul_f32 v120, s24, v120
  v_mul_f32 v121, s24, v121
  v_mfma_f32_32x32x16_bf16 v[80:95], v[32:35], a[84:87], v[80:95]
  s_waitcnt lgkmcnt(5)
  buffer_load_dwordx4 v21, s[12:15], s19 offen lds
  v_cvt_pk_bf16_f32 v140, v120, v121
  v_mul_f32 v122, s24, v122
  v_mfma_f32_32x32x16_bf16 v[64:79], v[36:39], a[88:91], v[64:79]
  ds_read_b128 v[28:31], v9 offset:16384
  v_mul_f32 v123, s24, v123
  v_cvt_pk_bf16_f32 v141, v122, v123
  v_mfma_f32_32x32x16_bf16 v[80:95], v[36:39], a[92:95], v[80:95]
  s_waitcnt lgkmcnt(5)
  v_mul_f32 v124, s24, v124
  v_mul_f32 v125, s24, v125
  v_mfma_f32_32x32x16_bf16 v[64:79], v[40:43], a[96:99], v[64:79]
  s_add_u32 m0, s25, 6144
  ds_read_b128 v[32:35], v10 offset:16384
  v_cvt_pk_bf16_f32 v142, v124, v125
  v_mul_f32 v126, s24, v126
  v_mfma_f32_32x32x16_bf16 v[80:95], v[40:43], a[100:103], v[80:95]
  s_waitcnt lgkmcnt(5)
  buffer_load_dwordx4 v22, s[12:15], s19 offen lds
  v_mul_f32 v127, s24, v127
  v_cvt_pk_bf16_f32 v143, v126, v127
  v_mfma_f32_32x32x16_bf16 v[64:79], v[44:47], a[104:107], v[64:79]
  ds_read_b128 v[36:39], v11 offset:16384
  v_mfma_f32_32x32x16_bf16 v[80:95], v[44:47], a[108:111], v[80:95]
  s_waitcnt lgkmcnt(5)
  v_mfma_f32_32x32x16_bf16 v[64:79], v[48:51], a[112:115], v[64:79]
  s_add_u32 m0, s25, 7168
  ds_read_b128 v[40:43], v12 offset:16384
  v_mfma_f32_32x32x16_bf16 v[80:95], v[48:51], a[116:119], v[80:95]
  s_waitcnt lgkmcnt(5)
  buffer_load_dwordx4 v23, s[12:15], s19 offen lds
  v_mfma_f32_32x32x16_bf16 v[64:79], v[52:55], a[120:123], v[64:79]
  s_cmp_gt_u32 s23, 3
  ds_read_b128 v[44:47], v13 offset:16384
  v_mfma_f32_32x32x16_bf16 v[80:95], v[52:55], a[124:127], v[80:95]
  s_waitcnt lgkmcnt(5)
  s_cselect_b32 s26, s20, 0
  v_mfma_f32_32x32x16_bf16 v[64:79], v[24:27], a[128:131], v[64:79]
  s_add_u32 s19, s19, s26
  ds_read_b128 v[48:51], v14 offset:16384
  v_mfma_f32_32x32x16_bf16 v[80:95], v[24:27], a[132:135], v[80:95]
  s_waitcnt lgkmcnt(5)
  s_add_u32 s25, s25, 32768
  v_mfma_f32_32x32x16_bf16 v[64:79], v[28:31], a[136:139], v[64:79]
  s_and_b32 s25, s25, 0x1ffff
  ds_read_b128 v[52:55], v15 offset:16384
  v_mfma_f32_32x32x16_bf16 v[80:95], v[28:31], a[140:143], v[80:95]
  s_waitcnt lgkmcnt(5)
  buffer_store_dwordx4 v[128:131], v7, s[4:7], s21 offen offset:0 sc1
  v_mfma_f32_32x32x16_bf16 v[64:79], v[32:35], a[144:147], v[64:79]
  ds_read_b128 v[24:27], v8 offset:24576
  v_mfma_f32_32x32x16_bf16 v[80:95], v[32:35], a[148:151], v[80:95]
  s_waitcnt lgkmcnt(5)
  v_mfma_f32_32x32x16_bf16 v[64:79], v[36:39], a[152:155], v[64:79]
  ds_read_b128 v[28:31], v9 offset:24576
  v_mfma_f32_32x32x16_bf16 v[80:95], v[36:39], a[156:159], v[80:95]
  s_waitcnt lgkmcnt(5)
  buffer_store_dwordx4 v[132:135], v7, s[4:7], s21 offen offset:1024 sc1
  v_mfma_f32_32x32x16_bf16 v[64:79], v[40:43], a[160:163], v[64:79]
  ds_read_b128 v[32:35], v10 offset:24576
  v_mfma_f32_32x32x16_bf16 v[80:95], v[40:43], a[164:167], v[80:95]
  s_waitcnt lgkmcnt(5)
  v_mfma_f32_32x32x16_bf16 v[64:79], v[44:47], a[168:171], v[64:79]
  ds_read_b128 v[36:39], v11 offset:24576
  v_mfma_f32_32x32x16_bf16 v[80:95], v[44:47], a[172:175], v[80:95]
  s_waitcnt lgkmcnt(5)
  buffer_store_dwordx4 v[136:139], v7, s[4:7], s21 offen offset:2048 sc1
  v_mfma_f32_32x32x16_bf16 v[64:79], v[48:51], a[176:179], v[64:79]
  ds_read_b128 v[40:43], v12 offset:24576
  v_mfma_f32_32x32x16_bf16 v[80:95], v[48:51], a[180:183], v[80:95]
  s_waitcnt lgkmcnt(5)
  v_mfma_f32_32x32x16_bf16 v[64:79], v[52:55], a[184:187], v[64:79]
  ds_read_b128 v[44:47], v13 offset:24576
  v_mfma_f32_32x32x16_bf16 v[80:95], v[52:55], a[188:191], v[80:95]
  s_waitcnt lgkmcnt(5)
  buffer_store_dwordx4 v[140:143], v7, s[4:7], s21 offen offset:3072 sc1
  v_mfma_f32_32x32x16_bf16 v[64:79], v[24:27], a[192:195], v[64:79]
  s_mov_b32 s21, s27
  ds_read_b128 v[48:51], v14 offset:24576
  v_mov_b32 v7, v2
  v_mfma_f32_32x32x16_bf16 v[80:95], v[24:27], a[196:199], v[80:95]
  s_waitcnt lgkmcnt(5)
  v_mfma_f32_32x32x16_bf16 v[64:79], v[28:31], a[200:203], v[64:79]
  s_add_u32 s27, s27, s22
  ds_read_b128 v[52:55], v15 offset:24576
  v_mfma_f32_32x32x16_bf16 v[80:95], v[28:31], a[204:207], v[80:95]
  s_waitcnt lgkmcnt(5)
  s_waitcnt vmcnt(17)
  s_barrier
  v_mfma_f32_32x32x16_bf16 v[64:79], v[32:35], a[208:211], v[64:79]
  ds_read_b128 v[24:27], v8 offset:32768
  v_mfma_f32_32x32x16_bf16 v[80:95], v[32:35], a[212:215], v[80:95]
  s_waitcnt lgkmcnt(5)
  v_mfma_f32_32x32x16_bf16 v[64:79], v[36:39], a[216:219], v[64:79]
  s_add_u32 s29, s29, 1
  ds_read_b128 v[28:31], v9 offset:32768
  v_mfma_f32_32x32x16_bf16 v[80:95], v[36:39], a[220:223], v[80:95]
  s_waitcnt lgkmcnt(5)
  s_max_i32 s30, s29, 0
  v_mov_b32 v144, s30
  v_mfma_f32_32x32x16_bf16 v[64:79], v[40:43], a[224:227], v[64:79]
  ds_read_b128 v[32:35], v10 offset:32768
  v_mfma_f32_32x32x16_bf16 v[80:95], v[40:43], a[228:231], v[80:95]
  s_waitcnt lgkmcnt(5)
  buffer_store_dword v144, v145, s[4:7], s31 offen sc1
  v_mfma_f32_32x32x16_bf16 v[64:79], v[44:47], a[232:235], v[64:79]
  ds_read_b128 v[36:39], v11 offset:32768
  v_mfma_f32_32x32x16_bf16 v[80:95], v[44:47], a[236:239], v[80:95]
  s_waitcnt lgkmcnt(5)
  v_mfma_f32_32x32x16_bf16 v[64:79], v[48:51], a[240:243], v[64:79]
  s_sub_u32 s23, s23, 1
  ds_read_b128 v[40:43], v12 offset:32768
  v_mfma_f32_32x32x16_bf16 v[80:95], v[48:51], a[244:247], v[80:95]
  s_waitcnt lgkmcnt(5)
  v_mfma_f32_32x32x16_bf16 v[64:79], v[52:55], a[248:251], v[64:79]
  s_cmp_eq_u32 s23, 0
  ds_read_b128 v[44:47], v13 offset:32768
  v_mfma_f32_32x32x16_bf16 v[80:95], v[52:55], a[252:255], v[80:95]
  s_cbranch_scc1 G_done0_8
  s_waitcnt lgkmcnt(5)
  v_mfma_f32_32x32x16_bf16 v[96:111], v[24:27], a[0:3], 0
  s_add_u32 m0, s25, 0
  ds_read_b128 v[48:51], v14 offset:32768
  v_mfma_f32_32x32x16_bf16 v[112:127], v[24:27], a[4:7], 0
  s_waitcnt lgkmcnt(5)
  buffer_load_dwordx4 v16, s[12:15], s19 offen lds
  v_mfma_f32_32x32x16_bf16 v[96:111], v[28:31], a[8:11], v[96:111]
  ds_read_b128 v[52:55], v15 offset:32768
  v_mul_f32 v64, s24, v64
  v_mul_f32 v65, s24, v65
  v_mfma_f32_32x32x16_bf16 v[112:127], v[28:31], a[12:15], v[112:127]
  s_waitcnt lgkmcnt(5)
  v_cvt_pk_bf16_f32 v128, v64, v65
  v_mul_f32 v66, s24, v66
  v_mfma_f32_32x32x16_bf16 v[96:111], v[32:35], a[16:19], v[96:111]
  s_add_u32 m0, s25, 1024
  ds_read_b128 v[24:27], v8 offset:40960
  v_mul_f32 v67, s24, v67
  v_cvt_pk_bf16_f32 v129, v66, v67
  v_mfma_f32_32x32x16_bf16 v[112:127], v[32:35], a[20:23], v[112:127]
  s_waitcnt lgkmcnt(5)
  buffer_load_dwordx4 v17, s[12:15], s19 offen lds
  v_mul_f32 v68, s24, v68
  v_mul_f32 v69, s24, v69
  v_mfma_f32_32x32x16_bf16 v[96:111], v[36:39], a[24:27], v[96:111]
  ds_read_b128 v[28:31], v9 offset:40960
  v_cvt_pk_bf16_f32 v130, v68, v69
  v_mul_f32 v70, s24, v70
  v_mfma_f32_32x32x16_bf16 v[112:127], v[36:39], a[28:31], v[112:127]
  s_waitcnt lgkmcnt(5)
  v_mul_f32 v71, s24, v71
  v_cvt_pk_bf16_f32 v131, v70, v71
  v_mfma_f32_32x32x16_bf16 v[96:111], v[40:43], a[32:35], v[96:111]
  s_add_u32 m0, s25, 2048
  ds_read_b128 v[32:35], v10 offset:40960
  v_mul_f32 v72, s24, v72
  v_mul_f32 v73, s24, v73
  v_mfma_f32_32x32x16_bf16 v[112:127], v[40:43], a[36:39], v[112:127]
  s_waitcnt lgkmcnt(5)
  buffer_load_dwordx4 v18, s[12:15], s19 offen lds
  v_cvt_pk_bf16_f32 v132, v72, v73
  v_mul_f32 v74, s24, v74
  v_mfma_f32_32x32x16_bf16 v[96:111], v[44:47], a[40:43], v[96:111]
  ds_read_b128 v[36:39], v11 offset:40960
  v_mul_f32 v75, s24, v75
  v_cvt_pk_bf16_f32 v133, v74, v75
  v_mfma_f32_32x32x16_bf16 v[112:127], v[44:47], a[44:47], v[112:127]
  s_waitcnt lgkmcnt(5)
  v_mul_f32 v76, s24, v76
  v_mul_f32 v77, s24, v77
  v_mfma_f32_32x32x16_bf16 v[96:111], v[48:51], a[48:51], v[96:111]
  s_add_u32 m0, s25, 3072
  ds_read_b128 v[40:43], v12 offset:40960
  v_cvt_pk_bf16_f32 v134, v76, v77
  v_mul_f32 v78, s24, v78
  v_mfma_f32_32x32x16_bf16 v[112:127], v[48:51], a[52:55], v[112:127]
  s_waitcnt lgkmcnt(5)
  buffer_load_dwordx4 v19, s[12:15], s19 offen lds
  v_mul_f32 v79, s24, v79
  v_cvt_pk_bf16_f32 v135, v78, v79
  v_mfma_f32_32x32x16_bf16 v[96:111], v[52:55], a[56:59], v[96:111]
  ds_read_b128 v[44:47], v13 offset:40960
  v_mul_f32 v80, s24, v80
  v_mul_f32 v81, s24, v81
  v_mfma_f32_32x32x16_bf16 v[112:127], v[52:55], a[60:63], v[112:127]
  s_waitcnt lgkmcnt(5)
  v_cvt_pk_bf16_f32 v136, v80, v81
  v_mul_f32 v82, s24, v82
  v_mfma_f32_32x32x16_bf16 v[96:111], v[24:27], a[64:67], v[96:111]
  s_add_u32 m0, s25, 4096
  ds_read_b128 v[48:51], v14 offset:40960
  v_mul_f32 v83, s24, v83
  v_cvt_pk_bf16_f32 v137, v82, v83
  v_mfma_f32_32x32x16_bf16 v[112:127], v[24:27], a[68:71], v[112:127]
  s_waitcnt lgkmcnt(5)
  buffer_load_dwordx4 v20, s[12:15], s19 offen lds
  v_mul_f32 v84, s24, v84
  v_mul_f32 v85, s24, v85
  v_mfma_f32_32x32x16_bf16 v[96:111], v[28:31], a[72:75], v[96:111]
  ds_read_b128 v[52:55], v15 offset:40960
  v_cvt_pk_bf16_f32 v138, v84, v85
  v_mul_f32 v86, s24, v86
  v_mfma_f32_32x32x16_bf16 v[112:127], v[28:31], a[76:79], v[112:127]
  s_waitcnt lgkmcnt(5)
  v_mul_f32 v87, s24, v87
  v_cvt_pk_bf16_f32 v139, v86, v87
  v_mfma_f32_32x32x16_bf16 v[96:111], v[32:35], a[80:83], v[96:111]
  s_add_u32 m0, s25, 5120
  ds_read_b128 v[24:27], v8 offset:49152
  v_mul_f32 v88, s24, v88
  v_mul_f32 v89, s24, v89
  v_mfma_f32_32x32x16_bf16 v[112:127], v[32:35], a[84:87], v[112:127]
  s_waitcnt lgkmcnt(5)
  buffer_load_dwordx4 v21, s[12:15], s19 offen lds
  v_cvt_pk_bf16_f32 v140, v88, v89
  v_mul_f32 v90, s24, v90
  v_mfma_f32_32x32x16_bf16 v[96:111], v[36:39], a[88:91], v[96:111]
  ds_read_b128 v[28:31], v9 offset:49152
  v_mul_f32 v91, s24, v91
  v_cvt_pk_bf16_f32 v141, v90, v91
  v_mfma_f32_32x32x16_bf16 v[112:127], v[36:39], a[92:95], v[112:127]
  s_waitcnt lgkmcnt(5)
  v_mul_f32 v92, s24, v92
  v_mul_f32 v93, s24, v93
  v_mfma_f32_32x32x16_bf16 v[96:111], v[40:43], a[96:99], v[96:111]
  s_add_u32 m0, s25, 6144
  ds_read_b128 v[32:35], v10 offset:49152
  v_cvt_pk_bf16_f32 v142, v92, v93
  v_mul_f32 v94, s24, v94
  v_mfma_f32_32x32x16_bf16 v[112:127], v[40:43], a[100:103], v[112:127]
  s_waitcnt lgkmcnt(5)
  buffer_load_dwordx4 v22, s[12:15], s19 offen lds
  v_mul_f32 v95, s24, v95
  v_cvt_pk_bf16_f32 v143, v94, v95
  v_mfma_f32_32x32x16_bf16 v[96:111], v[44:47], a[104:107], v[96:111]
  ds_read_b128 v[36:39], v11 offset:49152
  v_mfma_f32_32x32x16_bf16 v[112:127], v[44:47], a[108:111], v[112:127]
  s_waitcnt lgkmcnt(5)
  v_mfma_f32_32x32x16_bf16 v[96:111], v[48:51], a[112:115], v[96:111]
  s_add_u32 m0, s25, 7168
  ds_read_b128 v[40:43], v12 offset:49152
  v_mfma_f32_32x32x16_bf16 v[112:127], v[48:51], a[116:119], v[112:127]
  s_waitcnt lgkmcnt(5)
  buffer_load_dwordx4 v23, s[12:15], s19 offen lds
  v_mfma_f32_32x32x16_bf16 v[96:111], v[52:55], a[120:123], v[96:111]
  s_cmp_gt_u32 s23, 3
  ds_read_b128 v[44:47], v13 offset:49152
  v_mfma_f32_32x32x16_bf16 v[112:127], v[52:55], a[124:127], v[112:127]
  s_waitcnt lgkmcnt(5)
  s_cselect_b32 s26, s20, 0
  v_mfma_f32_32x32x16_bf16 v[96:111], v[24:27], a[128:131], v[96:111]
  s_add_u32 s19, s19, s26
  ds_read_b128 v[48:51], v14 offset:49152
  v_mfma_f32_32x32x16_bf16 v[112:127], v[24:27], a[132:135], v[112:127]
  s_waitcnt lgkmcnt(5)
  s_add_u32 s25, s25, 32768
  v_mfma_f32_32x32x16_bf16 v[96:111], v[28:31], a[136:139], v[96:111]
  s_and_b32 s25, s25, 0x1ffff
  ds_read_b128 v[52:55], v15 offset:49152
  v_mfma_f32_32x32x16_bf16 v[112:127], v[28:31], a[140:143], v[112:127]
  s_waitcnt lgkmcnt(5)
  buffer_store_dwordx4 v[128:131], v7, s[4:7], s21 offen offset:0 sc1
  v_mfma_f32_32x32x16_bf16 v[96:111], v[32:35], a[144:147], v[96:111]
  ds_read_b128 v[24:27], v8 offset:57344
  v_mfma_f32_32x32x16_bf16 v[112:127], v[32:35], a[148:151], v[112:127]
  s_waitcnt lgkmcnt(5)
  v_xor_b32 v8, 0x10000, v8
  v_mfma_f32_32x32x16_bf16 v[96:111], v[36:39], a[152:155], v[96:111]
  ds_read_b128 v[28:31], v9 offset:57344
  v_mfma_f32_32x32x16_bf16 v[112:127], v[36:39], a[156:159], v[112:127]
  s_waitcnt lgkmcnt(5)
  buffer_store_dwordx4 v[132:135], v7, s[4:7], s21 offen offset:1024 sc1
  v_xor_b32 v9, 0x10000, v9
  v_mfma_f32_32x32x16_bf16 v[96:111], v[40:43], a[160:163], v[96:111]
  ds_read_b128 v[32:35], v10 offset:57344
  v_mfma_f32_32x32x16_bf16 v[112:127], v[40:43], a[164:167], v[112:127]
  s_waitcnt lgkmcnt(5)
  v_xor_b32 v10, 0x10000, v10
  v_mfma_f32_32x32x16_bf16 v[96:111], v[44:47], a[168:171], v[96:111]
  ds_read_b128 v[36:39], v11 offset:57344
  v_mfma_f32_32x32x16_bf16 v[112:127], v[44:47], a[172:175], v[112:127]
  s_waitcnt lgkmcnt(5)
  buffer_store_dwordx4 v[136:139], v7, s[4:7], s21 offen offset:2048 sc1
  v_xor_b32 v11, 0x10000, v11
  v_mfma_f32_32x32x16_bf16 v[96:111], v[48:51], a[176:179], v[96:111]
  ds_read_b128 v[40:43], v12 offset:57344
  v_mfma_f32_32x32x16_bf16 v[112:127], v[48:51], a[180:183], v[112:127]
  s_waitcnt lgkmcnt(5)
  v_xor_b32 v12, 0x10000, v12
  v_mfma_f32_32x32x16_bf16 v[96:111], v[52:55], a[184:187], v[96:111]
  ds_read_b128 v[44:47], v13 offset:57344
  v_mfma_f32_32x32x16_bf16 v[112:127], v[52:55], a[188:191], v[112:127]
  s_waitcnt lgkmcnt(5)
  buffer_store_dwordx4 v[140:143], v7, s[4:7], s21 offen offset:3072 sc1
  v_xor_b32 v13, 0x10000, v13
  v_mfma_f32_32x32x16_bf16 v[96:111], v[24:27], a[192:195], v[96:111]
  s_mov_b32 s21, s27
  ds_read_b128 v[48:51], v14 offset:57344
  v_mov_b32 v7, v2
  v_mfma_f32_32x32x16_bf16 v[112:127], v[24:27], a[196:199], v[112:127]
  s_waitcnt lgkmcnt(5)
  v_xor_b32 v14, 0x10000, v14
  v_mfma_f32_32x32x16_bf16 v[96:111], v[28:31], a[200:203], v[96:111]
  s_add_u32 s27, s27, s22
  ds_read_b128 v[52:55], v15 offset:57344
  v_mfma_f32_32x32x16_bf16 v[112:127], v[28:31], a[204:207], v[112:127]
  s_waitcnt lgkmcnt(5)
  s_waitcnt vmcnt(17)
  s_barrier
  v_xor_b32 v15, 0x10000, v15
  v_mfma_f32_32x32x16_bf16 v[96:111], v[32:35], a[208:211], v[96:111]
  ds_read_b128 v[24:27], v8 offset:0
  v_mfma_f32_32x32x16_bf16 v[112:127], v[32:35], a[212:215], v[112:127]
  s_waitcnt lgkmcnt(5)
  v_mfma_f32_32x32x16_bf16 v[96:111], v[36:39], a[216:219], v[96:111]
  s_add_u32 s29, s29, 1
  ds_read_b128 v[28:31], v9 offset:0
  v_mfma_f32_32x32x16_bf16 v[112:127], v[36:39], a[220:223], v[112:127]
  s_waitcnt lgkmcnt(5)
  s_max_i32 s30, s29, 0
  v_mov_b32 v144, s30
  v_mfma_f32_32x32x16_bf16 v[96:111], v[40:43], a[224:227], v[96:111]
  ds_read_b128 v[32:35], v10 offset:0
  v_mfma_f32_32x32x16_bf16 v[112:127], v[40:43], a[228:231], v[112:127]
  s_waitcnt lgkmcnt(5)
  buffer_store_dword v144, v145, s[4:7], s31 offen sc1
  v_mfma_f32_32x32x16_bf16 v[96:111], v[44:47], a[232:235], v[96:111]
  ds_read_b128 v[36:39], v11 offset:0
  v_mfma_f32_32x32x16_bf16 v[112:127], v[44:47], a[236:239], v[112:127]
  s_waitcnt lgkmcnt(5)
  v_mfma_f32_32x32x16_bf16 v[96:111], v[48:51], a[240:243], v[96:111]
  s_sub_u32 s23, s23, 1
  ds_read_b128 v[40:43], v12 offset:0
  v_mfma_f32_32x32x16_bf16 v[112:127], v[48:51], a[244:247], v[112:127]
  s_waitcnt lgkmcnt(5)
  v_mfma_f32_32x32x16_bf16 v[96:111], v[52:55], a[248:251], v[96:111]
  s_cmp_eq_u32 s23, 0
  ds_read_b128 v[44:47], v13 offset:0
  v_mfma_f32_32x32x16_bf16 v[112:127], v[52:55], a[252:255], v[112:127]
  s_cbranch_scc1 G_done1_9
  s_branch G_top_7
G_done0_8:
  s_nop 7
  s_nop 3
  v_mul_f32 v64, s24, v64
  v_mul_f32 v65, s24, v65
  v_cvt_pk_bf16_f32 v128, v64, v65
  v_mul_f32 v66, s24, v66
  v_mul_f32 v67, s24, v67
  v_cvt_pk_bf16_f32 v129, v66, v67
  v_mul_f32 v68, s24, v68
  v_mul_f32 v69, s24, v69
  v_cvt_pk_bf16_f32 v130, v68, v69
  v_mul_f32 v70, s24, v70
  v_mul_f32 v71, s24, v71
  v_cvt_pk_bf16_f32 v131, v70, v71
  buffer_store_dwordx4 v[128:131], v7, s[4:7], s21 offen offset:0 sc1
  v_mul_f32 v72, s24, v72
  v_mul_f32 v73, s24, v73
  v_cvt_pk_bf16_f32 v132, v72, v73
  v_mul_f32 v74, s24, v74
  v_mul_f32 v75, s24, v75
  v_cvt_pk_bf16_f32 v133, v74, v75
  v_mul_f32 v76, s24, v76
  v_mul_f32 v77, s24, v77
  v_cvt_pk_bf16_f32 v134, v76, v77
  v_mul_f32 v78, s24, v78
  v_mul_f32 v79, s24, v79
  v_cvt_pk_bf16_f32 v135, v78, v79
  buffer_store_dwordx4 v[132:135], v7, s[4:7], s21 offen offset:1024 sc1
  v_mul_f32 v80, s24, v80
  v_mul_f32 v81, s24, v81
  v_cvt_pk_bf16_f32 v136, v80, v81
  v_mul_f32 v82, s24, v82
  v_mul_f32 v83, s24, v83
  v_cvt_pk_bf16_f32 v137, v82, v83
  v_mul_f32 v84, s24, v84
  v_mul_f32 v85, s24, v85
  v_cvt_pk_bf16_f32 v138, v84, v85
  v_mul_f32 v86, s24, v86
  v_mul_f32 v87, s24, v87
  v_cvt_pk_bf16_f32 v139, v86, v87
  buffer_store_dwordx4 v[136:139], v7, s[4:7], s21 offen offset:2048 sc1
  v_mul_f32 v88, s24, v88
  v_mul_f32 v89, s24, v89
  v_cvt_pk_bf16_f32 v140, v88, v89
  v_mul_f32 v90, s24, v90
  v_mul_f32 v91, s24, v91
  v_cvt_pk_bf16_f32 v141, v90, v91
  v_mul_f32 v92, s24, v92
  v_mul_f32 v93, s24, v93
  v_cvt_pk_bf16_f32 v142, v92, v93
  v_mul_f32 v94, s24, v94
  v_mul_f32 v95, s24, v95
  v_cvt_pk_bf16_f32 v143, v94, v95
  buffer_store_dwordx4 v[140:143], v7, s[4:7], s21 offen offset:3072 sc1
  s_branch G_fin_10
G_done1_9:
  s_nop 7
  s_nop 3
  v_mul_f32 v96, s24, v96
  v_mul_f32 v97, s24, v97
  v_cvt_pk_bf16_f32 v128, v96, v97
  v_mul_f32 v98, s24, v98
  v_mul_f32 v99, s24, v99
  v_cvt_pk_bf16_f32 v129, v98, v99
  v_mul_f32 v100, s24, v100
  v_mul_f32 v101, s24, v101
  v_cvt_pk_bf16_f32 v130, v100, v101
  v_mul_f32 v102, s24, v102
  v_mul_f32 v103, s24, v103
  v_cvt_pk_bf16_f32 v131, v102, v103
  buffer_store_dwordx4 v[128:131], v7, s[4:7], s21 offen offset:0 sc1
  v_mul_f32 v104, s24, v104
  v_mul_f32 v105, s24, v105
  v_cvt_pk_bf16_f32 v132, v104, v105
  v_mul_f32 v106, s24, v106
  v_mul_f32 v107, s24, v107
  v_cvt_pk_bf16_f32 v133, v106, v107
  v_mul_f32 v108, s24, v108
  v_mul_f32 v109, s24, v109
  v_cvt_pk_bf16_f32 v134, v108, v109
  v_mul_f32 v110, s24, v110
  v_mul_f32 v111, s24, v111
  v_cvt_pk_bf16_f32 v135, v110, v111
  buffer_store_dwordx4 v[132:135], v7, s[4:7], s21 offen offset:1024 sc1
  v_mul_f32 v112, s24, v112
  v_mul_f32 v113, s24, v113
  v_cvt_pk_bf16_f32 v136, v112, v113
  v_mul_f32 v114, s24, v114
  v_mul_f32 v115, s24, v115
  v_cvt_pk_bf16_f32 v137, v114, v115
  v_mul_f32 v116, s24, v116
  v_mul_f32 v117, s24, v117
  v_cvt_pk_bf16_f32 v138, v116, v117
  v_mul_f32 v118, s24, v118
  v_mul_f32 v119, s24, v119
  v_cvt_pk_bf16_f32 v139, v118, v119
  buffer_store_dwordx4 v[136:139], v7, s[4:7], s21 offen offset:2048 sc1
  v_mul_f32 v120, s24, v120
  v_mul_f32 v121, s24, v121
  v_cvt_pk_bf16_f32 v140, v120, v121
  v_mul_f32 v122, s24, v122
  v_mul_f32 v123, s24, v123
  v_cvt_pk_bf16_f32 v141, v122, v123
  v_mul_f32 v124, s24, v124
  v_mul_f32 v125, s24, v125
  v_cvt_pk_bf16_f32 v142, v124, v125
  v_mul_f32 v126, s24, v126
  v_mul_f32 v127, s24, v127
  v_cvt_pk_bf16_f32 v143, v126, v127
  buffer_store_dwordx4 v[140:143], v7, s[4:7], s21 offen offset:3072 sc1
G_fin_10:
  s_waitcnt vmcnt(0) lgkmcnt(0)
  s_barrier
  s_add_u32 s30, s29, 3
  v_mov_b32 v144, s30
  v_min_u32 v145, 1, v0
  v_lshlrev_b32 v145, 30, v145
  buffer_store_dword v144, v145, s[4:7], s31 offen sc1
P_end_2:
  s_mov_b32 s71, 0
  s_branch M_sg_12
M_sw_11:
  s_sleep 8
  s_add_u32 s71, s71, 1
  s_cmp_gt_u32 s71, 262144
  s_cbranch_scc1 M_exit
M_sg_12:
  s_mov_b32 s79, 0
  s_atomic_or s79, s[74:75], 128 glc
  s_waitcnt lgkmcnt(0)
  s_cmp_lt_u32 s79, 256
  s_cbranch_scc1 M_sw_11
  s_cmp_eq_u32 s65, 6
  s_cbranch_scc1 M_follow
  s_mov_b32 s68, 0
  s_mov_b32 s36, -1
  s_mov_b32 s69, s53
  s_mov_b32 s70, s54
M_att:
  s_mov_b32 s24, 0xf149f2ca
  s_mov_b32 s29, 0
  v_mov_b32 v6, 0
  v_mov_b32 v7, 0
  s_lshl_b32 s26, s16, 11
  v_add_u32 v3, s26, v2
  v_and_b32 v5, 31, v1
  v_lshrrev_b32 v12, 5, v1
  v_lshlrev_b32 v12, 2, v12
  v_sub_u32 v5, v5, v12
  s_lshl_b32 s26, s64, 19
  s_add_u32 s19, s26, 16777216
  s_add_u32 s20, s26, 33554432
  s_lshl_b32 s27, s69, 2
  s_add_u32 s27, s27, s16
  s_lshl_b32 s27, s27, 14
  s_add_u32 s25, s26, s27
  s_bfe_u32 s78, s70, 0x80000
  s_add_u32 s76, s67, 384
  s_mov_b32 s71, 0
  s_branch M_sg_14
M_sw_13:
  s_sleep 8
  s_add_u32 s71, s71, 1
  s_cmp_gt_u32 s71, 262144
  s_cbranch_scc1 M_exit
M_sg_14:
  s_mov_b32 s79, 0
  s_atomic_or s79, s[72:73], s76 glc
  s_waitcnt lgkmcnt(0)
  s_cmp_lt_u32 s79, s78
  s_cbranch_scc1 M_sw_13
  s_bfe_u32 s78, s70, 0x80008
  s_add_u32 s76, s67, 640
  s_mov_b32 s71, 0
  s_branch M_sg_16
M_sw_15:
  s_sleep 8
  s_add_u32 s71, s71, 1
  s_cmp_gt_u32 s71, 262144
  s_cbranch_scc1 M_exit
M_sg_16:
  s_mov_b32 s79, 0
  s_atomic_or s79, s[72:73], s76 glc
  s_waitcnt lgkmcnt(0)
  s_cmp_lt_u32 s79, s78
  s_cbranch_scc1 M_sw_15
  s_lshl_b32 s27, s69, 16
  s_add_u32 s27, s27, 16384
  s_add_u32 s17, s19, s27
M_kv_17:
  s_cmp_ge_u32 s17, s36
  s_cbranch_scc1 M_kvok_18
  s_mov_b32 s76, 0
  s_mov_b32 s78, 18
  s_mov_b32 s77, 376832
  s_cmp_eq_u32 s68, 1
  s_cmov_b32 s76, 128
  s_cmov_b32 s78, 22
  s_cmov_b32 s77, 196608
  s_cmp_eq_u32 s68, 2
  s_cmov_b32 s76, 512
  s_cmov_b32 s78, 24
  s_cmov_b32 s77, 0
  s_add_u32 s76, s76, s67
  s_mov_b32 s71, 0
  s_branch M_sg_20
M_sw_19:
  s_sleep 8
  s_add_u32 s71, s71, 1
  s_cmp_gt_u32 s71, 262144
  s_cbranch_scc1 M_exit
M_sg_20:
  s_mov_b32 s79, 0
  s_atomic_or s79, s[72:73], s76 glc
  s_waitcnt lgkmcnt(0)
  s_cmp_lt_u32 s79, s78
  s_cbranch_scc1 M_sw_19
  s_add_u32 s36, s77, s19
  s_add_u32 s68, s68, 1
  s_branch M_kv_17
M_kvok_18:
  s_add_u32 s28, s25, 0
  buffer_load_dwordx4 a[128:131], v2, s[4:7], s28 offen offset:0 sc1
  buffer_load_dwordx4 a[132:135], v2, s[4:7], s28 offen offset:1024 sc1
  buffer_load_dwordx4 a[136:139], v2, s[4:7], s28 offen offset:2048 sc1
  buffer_load_dwordx4 a[140:143], v2, s[4:7], s28 offen offset:3072 sc1
  s_add_u32 s28, s25, 4096
  buffer_load_dwordx4 a[144:147], v2, s[4:7], s28 offen offset:0 sc1
  buffer_load_dwordx4 a[148:151], v2, s[4:7], s28 offen offset:1024 sc1
  buffer_load_dwordx4 a[152:155], v2, s[4:7], s28 offen offset:2048 sc1
  buffer_load_dwordx4 a[156:159], v2, s[4:7], s28 offen offset:3072 sc1
  s_add_u32 s28, s25, 8192
  buffer_load_dwordx4 a[160:163], v2, s[4:7], s28 offen offset:0 sc1
  buffer_load_dwordx4 a[164:167], v2, s[4:7], s28 offen offset:1024 sc1
  buffer_load_dwordx4 a[168:171], v2, s[4:7], s28 offen offset:2048 sc1
  buffer_load_dwordx4 a[172:175], v2, s[4:7], s28 offen offset:3072 sc1
  s_add_u32 s28, s25, 12288
  buffer_load_dwordx4 a[176:179], v2, s[4:7], s28 offen offset:0 sc1
  buffer_load_dwordx4 a[180:183], v2, s[4:7], s28 offen offset:1024 sc1
  buffer_load_dwordx4 a[184:187], v2, s[4:7], s28 offen offset:2048 sc1
  buffer_load_dwordx4 a[188:191], v2, s[4:7], s28 offen offset:3072 sc1
A_again_21:
  s_lshl_b32 s27, s69, 16
  s_add_u32 s27, s27, 57344
  s_add_u32 s17, s19, s27
  s_add_u32 s18, s20, s27
  s_lshl_b32 s21, s16, 11
  s_mov_b32 m0, s21
  s_nop 0
  buffer_load_dwordx4 v3, s[4:7], s18 offen offset:0 sc1 lds
  buffer_load_dwordx4 v3, s[4:7], s18 offen offset:1024 sc1 lds
  s_add_u32 m0, s21, 8192
  s_nop 0
  buffer_load_dwordx4 v3, s[4:7], s17 offen offset:0 sc1 lds
  buffer_load_dwordx4 v3, s[4:7], s17 offen offset:1024 sc1 lds
  s_add_u32 s18, s18, 8192
  s_sub_u32 s18, s18, 8192
  s_max_i32 s18, s18, s20
  s_sub_u32 s17, s17, 8192
  s_max_i32 s17, s17, s19
  s_add_u32 s21, s21, 16384
  s_and_b32 s21, s21, 131071
  s_mov_b32 m0, s21
  s_nop 0
  buffer_load_dwordx4 v3, s[4:7], s18 offen offset:0 sc1 lds
  buffer_load_dwordx4 v3, s[4:7], s18 offen offset:1024 sc1 lds
  s_add_u32 m0, s21, 8192
  s_nop 0
  buffer_load_dwordx4 v3, s[4:7], s17 offen offset:0 sc1 lds
  buffer_load_dwordx4 v3, s[4:7], s17 offen offset:1024 sc1 lds
  s_sub_u32 s18, s18, 8192
  s_max_i32 s18, s18, s20
  s_sub_u32 s17, s17, 8192
  s_max_i32 s17, s17, s19
  s_add_u32 s21, s21, 16384
  s_and_b32 s21, s21, 131071
  s_mov_b32 m0, s21
  s_nop 0
  buffer_load_dwordx4 v3, s[4:7], s18 offen offset:0 sc1 lds
  buffer_load_dwordx4 v3, s[4:7], s18 offen offset:1024 sc1 lds
  s_add_u32 m0, s21, 8192
  s_nop 0
  buffer_load_dwordx4 v3, s[4:7], s17 offen offset:0 sc1 lds
  buffer_load_dwordx4 v3, s[4:7], s17 offen offset:1024 sc1 lds
  s_sub_u32 s18, s18, 8192
  s_max_i32 s18, s18, s20
  s_sub_u32 s17, s17, 8192
  s_max_i32 s17, s17, s19
  s_add_u32 s21, s21, 16384
  s_and_b32 s21, s21, 131071
  s_mov_b32 m0, s21
  s_nop 0
  buffer_load_dwordx4 v3, s[4:7], s18 offen offset:0 sc1 lds
  buffer_load_dwordx4 v3, s[4:7], s18 offen offset:1024 sc1 lds
  s_add_u32 m0, s21, 8192
  s_nop 0
  buffer_load_dwordx4 v3, s[4:7], s17 offen offset:0 sc1 lds
  buffer_load_dwordx4 v3, s[4:7], s17 offen offset:1024 sc1 lds
  s_sub_u32 s18, s18, 8192
  s_max_i32 s18, s18, s20
  s_sub_u32 s17, s17, 8192
  s_max_i32 s17, s17, s19
  s_add_u32 s21, s21, 16384
  s_and_b32 s21, s21, 131071
  s_mov_b32 m0, s21
  s_nop 0
  buffer_load_dwordx4 v3, s[4:7], s18 offen offset:0 sc1 lds
  buffer_load_dwordx4 v3, s[4:7], s18 offen offset:1024 sc1 lds
  s_add_u32 m0, s21, 8192
  s_nop 0
  buffer_load_dwordx4 v3, s[4:7], s17 offen offset:0 sc1 lds
  buffer_load_dwordx4 v3, s[4:7], s17 offen offset:1024 sc1 lds
  s_sub_u32 s18, s18, 8192
  s_max_i32 s18, s18, s20
  s_sub_u32 s17, s17, 8192
  s_max_i32 s17, s17, s19
  s_add_u32 s21, s21, 16384
  s_and_b32 s21, s21, 131071
  s_mov_b32 m0, s21
  s_nop 0
  buffer_load_dwordx4 v3, s[4:7], s18 offen offset:0 sc1 lds
  buffer_load_dwordx4 v3, s[4:7], s18 offen offset:1024 sc1 lds
  s_add_u32 m0, s21, 8192
  s_nop 0
  buffer_load_dwordx4 v3, s[4:7], s17 offen offset:0 sc1 lds
  buffer_load_dwordx4 v3, s[4:7], s17 offen offset:1024 sc1 lds
  v_accvgpr_write_b32 a0, 0
  v_accvgpr_write_b32 a1, 0
  v_accvgpr_write_b32 a2, 0
  v_accvgpr_write_b32 a3, 0
  v_accvgpr_write_b32 a4, 0
  v_accvgpr_write_b32 a5, 0
  v_accvgpr_write_b32 a6, 0
  v_accvgpr_write_b32 a7, 0
  v_accvgpr_write_b32 a8, 0
  v_accvgpr_write_b32 a9, 0
  v_accvgpr_write_b32 a10, 0
  v_accvgpr_write_b32 a11, 0
  v_accvgpr_write_b32 a12, 0
  v_accvgpr_write_b32 a13, 0
  v_accvgpr_write_b32 a14, 0
  v_accvgpr_write_b32 a15, 0
  v_accvgpr_write_b32 a16, 0
  v_accvgpr_write_b32 a17, 0
  v_accvgpr_write_b32 a18, 0
  v_accvgpr_write_b32 a19, 0
  v_accvgpr_write_b32 a20, 0
  v_accvgpr_write_b32 a21, 0
  v_accvgpr_write_b32 a22, 0
  v_accvgpr_write_b32 a23, 0
  v_accvgpr_write_b32 a24, 0
  v_accvgpr_write_b32 a25, 0
  v_accvgpr_write_b32 a26, 0
  v_accvgpr_write_b32 a27, 0
  v_accvgpr_write_b32 a28, 0
  v_accvgpr_write_b32 a29, 0
  v_accvgpr_write_b32 a30, 0
  v_accvgpr_write_b32 a31, 0
  v_accvgpr_write_b32 a32, 0
  v_accvgpr_write_b32 a33, 0
  v_accvgpr_write_b32 a34, 0
  v_accvgpr_write_b32 a35, 0
  v_accvgpr_write_b32 a36, 0
  v_accvgpr_write_b32 a37, 0
  v_accvgpr_write_b32 a38, 0
  v_accvgpr_write_b32 a39, 0
  v_accvgpr_write_b32 a40, 0
  v_accvgpr_write_b32 a41, 0
  v_accvgpr_write_b32 a42, 0
  v_accvgpr_write_b32 a43, 0
  v_accvgpr_write_b32 a44, 0
  v_accvgpr_write_b32 a45, 0
  v_accvgpr_write_b32 a46, 0
  v_accvgpr_write_b32 a47, 0
  v_accvgpr_write_b32 a48, 0
  v_accvgpr_write_b32 a49, 0
  v_accvgpr_write_b32 a50, 0
  v_accvgpr_write_b32 a51, 0
  v_accvgpr_write_b32 a52, 0
  v_accvgpr_write_b32 a53, 0
  v_accvgpr_write_b32 a54, 0
  v_accvgpr_write_b32 a55, 0
  v_accvgpr_write_b32 a56, 0
  v_accvgpr_write_b32 a57, 0
  v_accvgpr_write_b32 a58, 0
  v_accvgpr_write_b32 a59, 0
  v_accvgpr_write_b32 a60, 0
  v_accvgpr_write_b32 a61, 0
  v_accvgpr_write_b32 a62, 0
  v_accvgpr_write_b32 a63, 0
  v_accvgpr_write_b32 a64, 0
  v_accvgpr_write_b32 a65, 0
  v_accvgpr_write_b32 a66, 0
  v_accvgpr_write_b32 a67, 0
  v_accvgpr_write_b32 a68, 0
  v_accvgpr_write_b32 a69, 0
  v_accvgpr_write_b32 a70, 0
  v_accvgpr_write_b32 a71, 0
  v_accvgpr_write_b32 a72, 0
  v_accvgpr_write_b32 a73, 0
  v_accvgpr_write_b32 a74, 0
  v_accvgpr_write_b32 a75, 0
  v_accvgpr_write_b32 a76, 0
  v_accvgpr_write_b32 a77, 0
  v_accvgpr_write_b32 a78, 0
  v_accvgpr_write_b32 a79, 0
  v_accvgpr_write_b32 a80, 0
  v_accvgpr_write_b32 a81, 0
  v_accvgpr_write_b32 a82, 0
  v_accvgpr_write_b32 a83, 0
  v_accvgpr_write_b32 a84, 0
  v_accvgpr_write_b32 a85, 0
  v_accvgpr_write_b32 a86, 0
  v_accvgpr_write_b32 a87, 0
  v_accvgpr_write_b32 a88, 0
  v_accvgpr_write_b32 a89, 0
  v_accvgpr_write_b32 a90, 0
  v_accvgpr_write_b32 a91, 0
  v_accvgpr_write_b32 a92, 0
  v_accvgpr_write_b32 a93, 0
  v_accvgpr_write_b32 a94, 0
  v_accvgpr_write_b32 a95, 0
  v_accvgpr_write_b32 a96, 0
  v_accvgpr_write_b32 a97, 0
  v_accvgpr_write_b32 a98, 0
  v_accvgpr_write_b32 a99, 0
  v_accvgpr_write_b32 a100, 0
  v_accvgpr_write_b32 a101, 0
  v_accvgpr_write_b32 a102, 0
  v_accvgpr_write_b32 a103, 0
  v_accvgpr_write_b32 a104, 0
  v_accvgpr_write_b32 a105, 0
  v_accvgpr_write_b32 a106, 0
  v_accvgpr_write_b32 a107, 0
  v_accvgpr_write_b32 a108, 0
  v_accvgpr_write_b32 a109, 0
  v_accvgpr_write_b32 a110, 0
  v_accvgpr_write_b32 a111, 0
  v_accvgpr_write_b32 a112, 0
  v_accvgpr_write_b32 a113, 0
  v_accvgpr_write_b32 a114, 0
  v_accvgpr_write_b32 a115, 0
  v_accvgpr_write_b32 a116, 0
  v_accvgpr_write_b32 a117, 0
  v_accvgpr_write_b32 a118, 0
  v_accvgpr_write_b32 a119, 0
  v_accvgpr_write_b32 a120, 0
  v_accvgpr_write_b32 a121, 0
  v_accvgpr_write_b32 a122, 0
  v_accvgpr_write_b32 a123, 0
  v_accvgpr_write_b32 a124, 0
  v_accvgpr_write_b32 a125, 0
  v_accvgpr_write_b32 a126, 0
  v_accvgpr_write_b32 a127, 0
  v_mov_b32 v8, 0
  v_mov_b32 v9, 0
  v_mov_b32 v10, 0
  v_mov_b32 v11, 0
  v_mov_b32 v52, 0
  v_mov_b32 v53, 0
  v_mov_b32 v54, s24
  v_mov_b32 v55, s24
  v_mov_b32 v56, s24
  v_mov_b32 v57, s24
  v_mov_b32 v58, s24
  v_mov_b32 v59, s24
  v_mov_b32 v60, s24
  v_mov_b32 v61, s24
  v_mov_b32 v62, s24
  v_mov_b32 v63, s24
  v_mov_b32 v104, 0
  v_mov_b32 v105, 0
  v_mov_b32 v4, v2
  v_mov_b32 v64, s24
  v_mov_b32 v65, s24
  v_mov_b32 v66, s24
  v_mov_b32 v67, s24
  v_mov_b32 v68, s24
  v_mov_b32 v69, s24
  v_mov_b32 v70, s24
  v_mov_b32 v71, s24
  v_mov_b32 v72, s24
  v_mov_b32 v73, s24
  v_mov_b32 v74, s24
  v_mov_b32 v75, s24
  v_mov_b32 v76, s24
  v_mov_b32 v77, s24
  v_mov_b32 v78, s24
  v_mov_b32 v79, s24
  v_mov_b32 v12, s24
  v_cmp_le_i32 s[40:41], 0, v5
  v_cmp_le_i32 s[42:43], 1, v5
  v_cmp_le_i32 s[44:45], 2, v5
  v_cmp_le_i32 s[46:47], 3, v5
  v_cndmask_b32 v80, v12, v7, s[40:41]
  v_cndmask_b32 v81, v12, v7, s[42:43]
  v_cndmask_b32 v82, v12, v7, s[44:45]
  v_cndmask_b32 v83, v12, v7, s[46:47]
  v_cmp_le_i32 s[40:41], 8, v5
  v_cmp_le_i32 s[42:43], 9, v5
  v_cmp_le_i32 s[44:45], 10, v5
  v_cmp_le_i32 s[46:47], 11, v5
  v_cndmask_b32 v84, v12, v7, s[40:41]
  v_cndmask_b32 v85, v12, v7, s[42:43]
  v_cndmask_b32 v86, v12, v7, s[44:45]
  v_cndmask_b32 v87, v12, v7, s[46:47]
  v_cmp_le_i32 s[40:41], 16, v5
  v_cmp_le_i32 s[42:43], 17, v5
  v_cmp_le_i32 s[44:45], 18, v5
  v_cmp_le_i32 s[46:47], 19, v5
  v_cndmask_b32 v88, v12, v7, s[40:41]
  v_cndmask_b32 v89, v12, v7, s[42:43]
  v_cndmask_b32 v90, v12, v7, s[44:45]
  v_cndmask_b32 v91, v12, v7, s[46:47]
  v_cmp_le_i32 s[40:41], 24, v5
  v_cmp_le_i32 s[42:43], 25, v5
  v_cmp_le_i32 s[44:45], 26, v5
  v_cmp_le_i32 s[46:47], 27, v5
  v_cndmask_b32 v92, v12, v7, s[40:41]
  v_cndmask_b32 v93, v12, v7, s[42:43]
  v_cndmask_b32 v94, v12, v7, s[44:45]
  v_cndmask_b32 v95, v12, v7, s[46:47]
  s_lshl_b32 s22, s69, 3
  s_add_u32 s22, s22, 8
  s_lshl_b32 s26, s16, 1
  s_sub_u32 s23, 6, s26
  s_waitcnt vmcnt(20)
  s_barrier
  s_cmp_eq_u32 s23, 0
  s_cbranch_scc1 A_go_23
A_idle_22:
  s_waitcnt vmcnt(16)
  s_barrier
  s_sub_u32 s18, s18, 8192
  s_max_i32 s18, s18, s20
  s_sub_u32 s17, s17, 8192
  s_max_i32 s17, s17, s19
  s_add_u32 s21, s21, 16384
  s_and_b32 s21, s21, 131071
M_kv_24:
  s_cmp_ge_u32 s17, s36
  s_cbranch_scc1 M_kvok_25
  s_mov_b32 s76, 0
  s_mov_b32 s78, 18
  s_mov_b32 s77, 376832
  s_cmp_eq_u32 s68, 1
  s_cmov_b32 s76, 128
  s_cmov_b32 s78, 22
  s_cmov_b32 s77, 196608
  s_cmp_eq_u32 s68, 2
  s_cmov_b32 s76, 512
  s_cmov_b32 s78, 24
  s_cmov_b32 s77, 0
  s_add_u32 s76, s76, s67
  s_mov_b32 s71, 0
  s_branch M_sg_27
M_sw_26:
  s_sleep 8
  s_add_u32 s71, s71, 1
  s_cmp_gt_u32 s71, 262144
  s_cbranch_scc1 M_exit
M_sg_27:
  s_mov_b32 s79, 0
  s_atomic_or s79, s[72:73], s76 glc
  s_waitcnt lgkmcnt(0)
  s_cmp_lt_u32 s79, s78
  s_cbranch_scc1 M_sw_26
  s_add_u32 s36, s77, s19
  s_add_u32 s68, s68, 1
  s_branch M_kv_24
M_kvok_25:
  s_mov_b32 m0, s21
  s_nop 0
  buffer_load_dwordx4 v3, s[4:7], s18 offen offset:0 sc1 lds
  buffer_load_dwordx4 v3, s[4:7], s18 offen offset:1024 sc1 lds
  s_add_u32 m0, s21, 8192
  s_nop 0
  buffer_load_dwordx4 v3, s[4:7], s17 offen offset:0 sc1 lds
  buffer_load_dwordx4 v3, s[4:7], s17 offen offset:1024 sc1 lds
  v_add_u32 v4, 16384, v4
  v_and_b32 v4, 131071, v4
  s_sub_u32 s22, s22, 1
  s_sub_u32 s23, s23, 1
  s_cmp_lg_u32 s23, 0
  s_cbranch_scc1 A_idle_22
A_go_23:
  ds_read_b128 a[224:227], v4 offset:0
  ds_read_b128 a[228:231], v4 offset:2048
  ds_read_b128 a[232:235], v4 offset:4096
  ds_read_b128 a[236:239], v4 offset:6144
  ds_read_b128 a[240:243], v4 offset:1024
  ds_read_b128 a[244:247], v4 offset:3072
  ds_read_b128 a[248:251], v4 offset:5120
  ds_read_b128 a[252:255], v4 offset:7168
  ds_read_b128 a[192:195], v4 offset:8192
  ds_read_b128 a[196:199], v4 offset:9216
  ds_read_b128 a[200:203], v4 offset:10240
  ds_read_b128 a[204:207], v4 offset:11264
  ds_read_b128 a[208:211], v4 offset:12288
  ds_read_b128 a[212:215], v4 offset:13312
  ds_read_b128 a[216:219], v4 offset:14336
  ds_read_b128 a[220:223], v4 offset:15360
  v_add_u32 v4, 16384, v4
  v_and_b32 v4, 131071, v4
  s_waitcnt lgkmcnt(8)
.p2align 6
A_top_28:
  s_waitcnt lgkmcnt(7)
  v_mfma_f32_32x32x16_bf16 v[32:47], a[192:195], a[128:131], v[64:79]
  s_waitcnt lgkmcnt(6)
  v_exp_f32 v54, v54
  v_add_f32 v11, v11, v53
  v_cvt_pk_bf16_f32 v106, v52, v53
  v_mfma_f32_32x32x16_bf16 v[32:47], a[196:199], a[132:135], v[32:47]
  s_waitcnt lgkmcnt(4)
  v_exp_f32 v55, v55
  v_add_f32 v10, v10, v54
  v_mfma_f32_32x32x16_bf16 v[32:47], a[200:203], a[136:139], v[32:47]
  v_exp_f32 v56, v56
  v_add_f32 v11, v11, v55
  v_cvt_pk_bf16_f32 v107, v54, v55
  v_mfma_f32_32x32x16_bf16 v[32:47], a[204:207], a[140:143], v[32:47]
  s_waitcnt lgkmcnt(2)
  v_exp_f32 v57, v57
  v_add_f32 v10, v10, v56
  v_mfma_f32_32x32x16_bf16 v[32:47], a[208:211], a[144:147], v[32:47]
  v_exp_f32 v58, v58
  v_add_f32 v11, v11, v57
  v_cvt_pk_bf16_f32 v108, v56, v57
  v_mfma_f32_32x32x16_bf16 v[32:47], a[212:215], a[148:151], v[32:47]
  s_waitcnt lgkmcnt(0)
  v_exp_f32 v59, v59
  v_add_f32 v10, v10, v58
  v_mfma_f32_32x32x16_bf16 v[32:47], a[216:219], a[152:155], v[32:47]
  v_exp_f32 v60, v60
  v_add_f32 v11, v11, v59
  v_cvt_pk_bf16_f32 v109, v58, v59
  v_mfma_f32_32x32x16_bf16 v[32:47], a[220:223], a[156:159], v[32:47]
  s_waitcnt vmcnt(16)
  s_barrier
  v_exp_f32 v61, v61
  v_add_f32 v10, v10, v60
  v_mfma_f32_32x32x16_bf16 a[64:79], a[224:227], v[104:107], a[64:79]
  ds_read_b128 a[224:227], v4 offset:0
  v_exp_f32 v62, v62
  v_add_f32 v11, v11, v61
  v_cvt_pk_bf16_f32 v110, v60, v61
  v_mfma_f32_32x32x16_bf16 a[80:95], a[228:231], v[104:107], a[80:95]
  s_sub_u32 s18, s18, 8192
  ds_read_b128 a[228:231], v4 offset:2048
  v_exp_f32 v63, v63
  v_add_f32 v10, v10, v62
  v_mfma_f32_32x32x16_bf16 a[96:111], a[232:235], v[104:107], a[96:111]
  s_max_i32 s18, s18, s20
  ds_read_b128 a[232:235], v4 offset:4096
  v_exp_f32 v32, v32
  v_add_f32 v11, v11, v63
  v_cvt_pk_bf16_f32 v111, v62, v63
  v_mfma_f32_32x32x16_bf16 a[112:127], a[236:239], v[104:107], a[112:127]
  s_sub_u32 s17, s17, 8192
  ds_read_b128 a[236:239], v4 offset:6144
  v_exp_f32 v33, v33
  v_add_f32 v8, v8, v32
  v_mfma_f32_32x32x16_bf16 a[64:79], a[240:243], v[108:111], a[64:79]
  s_max_i32 s17, s17, s19
  ds_read_b128 a[240:243], v4 offset:1024
  v_exp_f32 v34, v34
  v_add_f32 v9, v9, v33
  v_cvt_pk_bf16_f32 v96, v32, v33
  v_mfma_f32_32x32x16_bf16 a[80:95], a[244:247], v[108:111], a[80:95]
  s_add_u32 s21, s21, 16384
  ds_read_b128 a[244:247], v4 offset:3072
  v_exp_f32 v35, v35
  v_add_f32 v8, v8, v34
  v_mfma_f32_32x32x16_bf16 a[96:111], a[248:251], v[108:111], a[96:111]
  s_and_b32 s21, s21, 131071
  ds_read_b128 a[248:251], v4 offset:5120
  v_exp_f32 v36, v36
  v_add_f32 v9, v9, v35
  v_cvt_pk_bf16_f32 v97, v34, v35
  v_mfma_f32_32x32x16_bf16 a[112:127], a[252:255], v[108:111], a[112:127]
  ds_read_b128 a[252:255], v4 offset:7168
  v_exp_f32 v37, v37
  v_add_f32 v8, v8, v36
  v_mfma_f32_32x32x16_bf16 v[48:63], a[192:195], a[160:163], v[80:95]
  s_add_u32 s23, s23, 1
  ds_read_b128 a[192:195], v4 offset:8192
  v_exp_f32 v38, v38
  v_add_f32 v9, v9, v37
  v_cvt_pk_bf16_f32 v98, v36, v37
  v_mfma_f32_32x32x16_bf16 v[48:63], a[196:199], a[164:167], v[48:63]
  s_sub_u32 s22, s22, 1
  ds_read_b128 a[196:199], v4 offset:9216
  v_exp_f32 v39, v39
  v_add_f32 v8, v8, v38
  v_mfma_f32_32x32x16_bf16 v[48:63], a[200:203], a[168:171], v[48:63]
  s_cmp_lt_u32 s23, 3
  ds_read_b128 a[200:203], v4 offset:10240
  v_exp_f32 v40, v40
  v_add_f32 v9, v9, v39
  v_cvt_pk_bf16_f32 v99, v38, v39
  v_mfma_f32_32x32x16_bf16 v[48:63], a[204:207], a[172:175], v[48:63]
  s_cbranch_scc1 A_upd_29
A_back_30:
  ds_read_b128 a[204:207], v4 offset:11264
  v_exp_f32 v41, v41
  v_add_f32 v8, v8, v40
  v_mfma_f32_32x32x16_bf16 v[48:63], a[208:211], a[176:179], v[48:63]
  s_cmp_lt_u32 s17, s36
  ds_read_b128 a[208:211], v4 offset:12288
  v_exp_f32 v42, v42
  v_add_f32 v9, v9, v41
  v_cvt_pk_bf16_f32 v100, v40, v41
  v_mfma_f32_32x32x16_bf16 v[48:63], a[212:215], a[180:183], v[48:63]
  s_cbranch_scc1 A_kvw_32
A_kvb_33:
  ds_read_b128 a[212:215], v4 offset:13312
  v_exp_f32 v43, v43
  v_add_f32 v8, v8, v42
  v_mfma_f32_32x32x16_bf16 v[48:63], a[216:219], a[184:187], v[48:63]
  s_mov_b32 m0, s21
  ds_read_b128 a[216:219], v4 offset:14336
  v_exp_f32 v44, v44
  v_add_f32 v9, v9, v43
  v_cvt_pk_bf16_f32 v101, v42, v43
  v_mfma_f32_32x32x16_bf16 v[48:63], a[220:223], a[188:191], v[48:63]
  s_waitcnt lgkmcnt(13)
  ds_read_b128 a[220:223], v4 offset:15360
  v_exp_f32 v45, v45
  v_add_f32 v8, v8, v44
  v_mfma_f32_32x32x16_bf16 a[0:15], a[224:227], v[96:99], a[0:15]
  buffer_load_dwordx4 v3, s[4:7], s18 offen offset:0 sc1 lds
  v_exp_f32 v46, v46
  v_add_f32 v9, v9, v45
  v_cvt_pk_bf16_f32 v102, v44, v45
  v_mfma_f32_32x32x16_bf16 a[16:31], a[228:231], v[96:99], a[16:31]
  s_waitcnt lgkmcnt(12)
  v_exp_f32 v47, v47
  v_add_f32 v8, v8, v46
  v_add_u32 v4, 16384, v4
  v_mfma_f32_32x32x16_bf16 a[32:47], a[232:235], v[96:99], a[32:47]
  buffer_load_dwordx4 v3, s[4:7], s18 offen offset:1024 sc1 lds
  v_exp_f32 v48, v48
  v_add_f32 v9, v9, v47
  v_cvt_pk_bf16_f32 v103, v46, v47
  v_mfma_f32_32x32x16_bf16 a[48:63], a[236:239], v[96:99], a[48:63]
  s_waitcnt lgkmcnt(10)
  s_add_u32 m0, s21, 8192
  v_exp_f32 v49, v49
  v_add_f32 v10, v10, v48
  v_and_b32 v4, 131071, v4
  v_mfma_f32_32x32x16_bf16 a[0:15], a[240:243], v[100:103], a[0:15]
  buffer_load_dwordx4 v3, s[4:7], s17 offen offset:0 sc1 lds
  v_exp_f32 v50, v50
  v_add_f32 v11, v11, v49
  v_cvt_pk_bf16_f32 v104, v48, v49
  v_mfma_f32_32x32x16_bf16 a[16:31], a[244:247], v[100:103], a[16:31]
  s_waitcnt lgkmcnt(8)
  s_cmp_lg_u32 s22, 0
  v_exp_f32 v51, v51
  v_add_f32 v10, v10, v50
  v_mfma_f32_32x32x16_bf16 a[32:47], a[248:251], v[100:103], a[32:47]
  buffer_load_dwordx4 v3, s[4:7], s17 offen offset:1024 sc1 lds
  v_exp_f32 v52, v52
  v_add_f32 v11, v11, v51
  v_cvt_pk_bf16_f32 v105, v50, v51
  v_mfma_f32_32x32x16_bf16 a[48:63], a[252:255], v[100:103], a[48:63]
  v_exp_f32 v53, v53
  v_add_f32 v10, v10, v52
  s_cbranch_scc1 A_top_28
  v_exp_f32 v54, v54
  v_add_f32 v11, v11, v53
  v_cvt_pk_bf16_f32 v106, v52, v53
  v_exp_f32 v55, v55
  v_add_f32 v10, v10, v54
  v_exp_f32 v56, v56
  v_add_f32 v11, v11, v55
  v_cvt_pk_bf16_f32 v107, v54, v55
  v_exp_f32 v57, v57
  v_add_f32 v10, v10, v56
  v_exp_f32 v58, v58
  v_add_f32 v11, v11, v57
  v_cvt_pk_bf16_f32 v108, v56, v57
  v_exp_f32 v59, v59
  v_add_f32 v10, v10, v58
  v_exp_f32 v60, v60
  v_add_f32 v11, v11, v59
  v_cvt_pk_bf16_f32 v109, v58, v59
  v_exp_f32 v61, v61
  v_add_f32 v10, v10, v60
  v_exp_f32 v62, v62
  v_add_f32 v11, v11, v61
  v_cvt_pk_bf16_f32 v110, v60, v61
  v_exp_f32 v63, v63
  v_add_f32 v10, v10, v62
  v_add_f32 v11, v11, v63
  v_cvt_pk_bf16_f32 v111, v62, v63
  s_nop 1
  v_mfma_f32_32x32x16_bf16 a[64:79], a[224:227], v[104:107], a[64:79]
  v_mfma_f32_32x32x16_bf16 a[80:95], a[228:231], v[104:107], a[80:95]
  v_mfma_f32_32x32x16_bf16 a[96:111], a[232:235], v[104:107], a[96:111]
  v_mfma_f32_32x32x16_bf16 a[112:127], a[236:239], v[104:107], a[112:127]
  v_mfma_f32_32x32x16_bf16 a[64:79], a[240:243], v[108:111], a[64:79]
  v_mfma_f32_32x32x16_bf16 a[80:95], a[244:247], v[108:111], a[80:95]
  v_mfma_f32_32x32x16_bf16 a[96:111], a[248:251], v[108:111], a[96:111]
  v_mfma_f32_32x32x16_bf16 a[112:127], a[252:255], v[108:111], a[112:127]
  v_add_f32 v8, v8, v9
  v_mov_b32 v9, v8
  s_nop 1
  v_permlane32_swap_b32 v8, v9
  s_nop 1
  v_add_f32 v8, v8, v9
  v_add_f32 v10, v10, v11
  v_mov_b32 v11, v10
  s_nop 1
  v_permlane32_swap_b32 v10, v11
  s_nop 1
  v_add_f32 v10, v10, v11
  v_subrev_u32 v12, 0x2f800000, v8
  v_subrev_u32 v13, 0x2f800000, v10
  v_max_u32 v12, v12, v13
  v_cmp_le_u32 vcc, 0x28000000, v12
  s_nop 1
  s_cmp_lg_u64 vcc, 0
  s_cselect_b32 s26, 1, 0
  v_mov_b32 v12, s26
  s_lshl_b32 s26, s16, 2
  s_add_u32 s26, s26, 131072
  v_mov_b32 v13, s26
  ds_write_b32 v13, v12
  v_mov_b32 v14, 131072
  s_waitcnt vmcnt(0) lgkmcnt(0)
  s_barrier
  ds_read_b128 v[16:19], v14
  v_rcp_f32 v8, v8
  v_rcp_f32 v10, v10
  s_waitcnt lgkmcnt(0)
  v_or3_b32 v12, v16, v17, v18
  v_or_b32 v12, v12, v19
  s_nop 0
  v_readfirstlane_b32 s26, v12
  s_nop 1
  s_cmp_gt_u32 s26, s29
  s_cbranch_scc1 A_slow_34
  s_add_u32 s28, s25, 100663296
  v_accvgpr_read_b32 v112, a0
  v_accvgpr_read_b32 v113, a1
  v_accvgpr_read_b32 v114, a2
  v_accvgpr_read_b32 v115, a3
  v_accvgpr_read_b32 v116, a4
  v_accvgpr_read_b32 v117, a5
  v_accvgpr_read_b32 v118, a6
  v_accvgpr_read_b32 v119, a7
  v_pk_mul_f32 v[112:113], v[112:113], v[8:9] op_sel_hi:[1,0]
  v_pk_mul_f32 v[114:115], v[114:115], v[8:9] op_sel_hi:[1,0]
  v_pk_mul_f32 v[116:117], v[116:117], v[8:9] op_sel_hi:[1,0]
  v_pk_mul_f32 v[118:119], v[118:119], v[8:9] op_sel_hi:[1,0]
  v_cvt_pk_bf16_f32 v120, v112, v113
  v_cvt_pk_bf16_f32 v121, v114, v115
  v_cvt_pk_bf16_f32 v122, v116, v117
  v_cvt_pk_bf16_f32 v123, v118, v119
  buffer_store_dwordx4 v[120:123], v2, s[4:7], s28 offen offset:0 sc1
  v_accvgpr_read_b32 v124, a8
  v_accvgpr_read_b32 v125, a9
  v_accvgpr_read_b32 v126, a10
  v_accvgpr_read_b32 v127, a11
  v_accvgpr_read_b32 v128, a12
  v_accvgpr_read_b32 v129, a13
  v_accvgpr_read_b32 v130, a14
  v_accvgpr_read_b32 v131, a15
  v_pk_mul_f32 v[124:125], v[124:125], v[8:9] op_sel_hi:[1,0]
  v_pk_mul_f32 v[126:127], v[126:127], v[8:9] op_sel_hi:[1,0]
  v_pk_mul_f32 v[128:129], v[128:129], v[8:9] op_sel_hi:[1,0]
  v_pk_mul_f32 v[130:131], v[130:131], v[8:9] op_sel_hi:[1,0]
  v_cvt_pk_bf16_f32 v132, v124, v125
  v_cvt_pk_bf16_f32 v133, v126, v127
  v_cvt_pk_bf16_f32 v134, v128, v129
  v_cvt_pk_bf16_f32 v135, v130, v131
  buffer_store_dwordx4 v[132:135], v2, s[4:7], s28 offen offset:1024 sc1
  v_accvgpr_read_b32 v136, a16
  v_accvgpr_read_b32 v137, a17
  v_accvgpr_read_b32 v138, a18
  v_accvgpr_read_b32 v139, a19
  v_accvgpr_read_b32 v140, a20
  v_accvgpr_read_b32 v141, a21
  v_accvgpr_read_b32 v142, a22
  v_accvgpr_read_b32 v143, a23
  v_pk_mul_f32 v[136:137], v[136:137], v[8:9] op_sel_hi:[1,0]
  v_pk_mul_f32 v[138:139], v[138:139], v[8:9] op_sel_hi:[1,0]
  v_pk_mul_f32 v[140:141], v[140:141], v[8:9] op_sel_hi:[1,0]
  v_pk_mul_f32 v[142:143], v[142:143], v[8:9] op_sel_hi:[1,0]
  v_cvt_pk_bf16_f32 v144, v136, v137
  v_cvt_pk_bf16_f32 v145, v138, v139
  v_cvt_pk_bf16_f32 v146, v140, v141
  v_cvt_pk_bf16_f32 v147, v142, v143
  buffer_store_dwordx4 v[144:147], v2, s[4:7], s28 offen offset:2048 sc1
  v_accvgpr_read_b32 v148, a24
  v_accvgpr_read_b32 v149, a25
  v_accvgpr_read_b32 v150, a26
  v_accvgpr_read_b32 v151, a27
  v_accvgpr_read_b32 v152, a28
  v_accvgpr_read_b32 v153, a29
  v_accvgpr_read_b32 v154, a30
  v_accvgpr_read_b32 v155, a31
  v_pk_mul_f32 v[148:149], v[148:149], v[8:9] op_sel_hi:[1,0]
  v_pk_mul_f32 v[150:151], v[150:151], v[8:9] op_sel_hi:[1,0]
  v_pk_mul_f32 v[152:153], v[152:153], v[8:9] op_sel_hi:[1,0]
  v_pk_mul_f32 v[154:155], v[154:155], v[8:9] op_sel_hi:[1,0]
  v_cvt_pk_bf16_f32 v156, v148, v149
  v_cvt_pk_bf16_f32 v157, v150, v151
  v_cvt_pk_bf16_f32 v158, v152, v153
  v_cvt_pk_bf16_f32 v159, v154, v155
  buffer_store_dwordx4 v[156:159], v2, s[4:7], s28 offen offset:3072 sc1
  s_add_u32 s28, s25, 100667392
  v_accvgpr_read_b32 v112, a32
  v_accvgpr_read_b32 v113, a33
  v_accvgpr_read_b32 v114, a34
  v_accvgpr_read_b32 v115, a35
  v_accvgpr_read_b32 v116, a36
  v_accvgpr_read_b32 v117, a37
  v_accvgpr_read_b32 v118, a38
  v_accvgpr_read_b32 v119, a39
  v_pk_mul_f32 v[112:113], v[112:113], v[8:9] op_sel_hi:[1,0]
  v_pk_mul_f32 v[114:115], v[114:115], v[8:9] op_sel_hi:[1,0]
  v_pk_mul_f32 v[116:117], v[116:117], v[8:9] op_sel_hi:[1,0]
  v_pk_mul_f32 v[118:119], v[118:119], v[8:9] op_sel_hi:[1,0]
  v_cvt_pk_bf16_f32 v120, v112, v113
  v_cvt_pk_bf16_f32 v121, v114, v115
  v_cvt_pk_bf16_f32 v122, v116, v117
  v_cvt_pk_bf16_f32 v123, v118, v119
  buffer_store_dwordx4 v[120:123], v2, s[4:7], s28 offen offset:0 sc1
  v_accvgpr_read_b32 v124, a40
  v_accvgpr_read_b32 v125, a41
  v_accvgpr_read_b32 v126, a42
  v_accvgpr_read_b32 v127, a43
  v_accvgpr_read_b32 v128, a44
  v_accvgpr_read_b32 v129, a45
  v_accvgpr_read_b32 v130, a46
  v_accvgpr_read_b32 v131, a47
  v_pk_mul_f32 v[124:125], v[124:125], v[8:9] op_sel_hi:[1,0]
  v_pk_mul_f32 v[126:127], v[126:127], v[8:9] op_sel_hi:[1,0]
  v_pk_mul_f32 v[128:129], v[128:129], v[8:9] op_sel_hi:[1,0]
  v_pk_mul_f32 v[130:131], v[130:131], v[8:9] op_sel_hi:[1,0]
  v_cvt_pk_bf16_f32 v132, v124, v125
  v_cvt_pk_bf16_f32 v133, v126, v127
  v_cvt_pk_bf16_f32 v134, v128, v129
  v_cvt_pk_bf16_f32 v135, v130, v131
  buffer_store_dwordx4 v[132:135], v2, s[4:7], s28 offen offset:1024 sc1
  v_accvgpr_read_b32 v136, a48
  v_accvgpr_read_b32 v137, a49
  v_accvgpr_read_b32 v138, a50
  v_accvgpr_read_b32 v139, a51
  v_accvgpr_read_b32 v140, a52
  v_accvgpr_read_b32 v141, a53
  v_accvgpr_read_b32 v142, a54
  v_accvgpr_read_b32 v143, a55
  v_pk_mul_f32 v[136:137], v[136:137], v[8:9] op_sel_hi:[1,0]
  v_pk_mul_f32 v[138:139], v[138:139], v[8:9] op_sel_hi:[1,0]
  v_pk_mul_f32 v[140:141], v[140:141], v[8:9] op_sel_hi:[1,0]
  v_pk_mul_f32 v[142:143], v[142:143], v[8:9] op_sel_hi:[1,0]
  v_cvt_pk_bf16_f32 v144, v136, v137
  v_cvt_pk_bf16_f32 v145, v138, v139
  v_cvt_pk_bf16_f32 v146, v140, v141
  v_cvt_pk_bf16_f32 v147, v142, v143
  buffer_store_dwordx4 v[144:147], v2, s[4:7], s28 offen offset:2048 sc1
  v_accvgpr_read_b32 v148, a56
  v_accvgpr_read_b32 v149, a57
  v_accvgpr_read_b32 v150, a58
  v_accvgpr_read_b32 v151, a59
  v_accvgpr_read_b32 v152, a60
  v_accvgpr_read_b32 v153, a61
  v_accvgpr_read_b32 v154, a62
  v_accvgpr_read_b32 v155, a63
  v_pk_mul_f32 v[148:149], v[148:149], v[8:9] op_sel_hi:[1,0]
  v_pk_mul_f32 v[150:151], v[150:151], v[8:9] op_sel_hi:[1,0]
  v_pk_mul_f32 v[152:153], v[152:153], v[8:9] op_sel_hi:[1,0]
  v_pk_mul_f32 v[154:155], v[154:155], v[8:9] op_sel_hi:[1,0]
  v_cvt_pk_bf16_f32 v156, v148, v149
  v_cvt_pk_bf16_f32 v157, v150, v151
  v_cvt_pk_bf16_f32 v158, v152, v153
  v_cvt_pk_bf16_f32 v159, v154, v155
  buffer_store_dwordx4 v[156:159], v2, s[4:7], s28 offen offset:3072 sc1
  s_add_u32 s28, s25, 100671488
  v_accvgpr_read_b32 v112, a64
  v_accvgpr_read_b32 v113, a65
  v_accvgpr_read_b32 v114, a66
  v_accvgpr_read_b32 v115, a67
  v_accvgpr_read_b32 v116, a68
  v_accvgpr_read_b32 v117, a69
  v_accvgpr_read_b32 v118, a70
  v_accvgpr_read_b32 v119, a71
  v_pk_mul_f32 v[112:113], v[112:113], v[10:11] op_sel_hi:[1,0]
  v_pk_mul_f32 v[114:115], v[114:115], v[10:11] op_sel_hi:[1,0]
  v_pk_mul_f32 v[116:117], v[116:117], v[10:11] op_sel_hi:[1,0]
  v_pk_mul_f32 v[118:119], v[118:119], v[10:11] op_sel_hi:[1,0]
  v_cvt_pk_bf16_f32 v120, v112, v113
  v_cvt_pk_bf16_f32 v121, v114, v115
  v_cvt_pk_bf16_f32 v122, v116, v117
  v_cvt_pk_bf16_f32 v123, v118, v119
  buffer_store_dwordx4 v[120:123], v2, s[4:7], s28 offen offset:0 sc1
  v_accvgpr_read_b32 v124, a72
  v_accvgpr_read_b32 v125, a73
  v_accvgpr_read_b32 v126, a74
  v_accvgpr_read_b32 v127, a75
  v_accvgpr_read_b32 v128, a76
  v_accvgpr_read_b32 v129, a77
  v_accvgpr_read_b32 v130, a78
  v_accvgpr_read_b32 v131, a79
  v_pk_mul_f32 v[124:125], v[124:125], v[10:11] op_sel_hi:[1,0]
  v_pk_mul_f32 v[126:127], v[126:127], v[10:11] op_sel_hi:[1,0]
  v_pk_mul_f32 v[128:129], v[128:129], v[10:11] op_sel_hi:[1,0]
  v_pk_mul_f32 v[130:131], v[130:131], v[10:11] op_sel_hi:[1,0]
  v_cvt_pk_bf16_f32 v132, v124, v125
  v_cvt_pk_bf16_f32 v133, v126, v127
  v_cvt_pk_bf16_f32 v134, v128, v129
  v_cvt_pk_bf16_f32 v135, v130, v131
  buffer_store_dwordx4 v[132:135], v2, s[4:7], s28 offen offset:1024 sc1
  v_accvgpr_read_b32 v136, a80
  v_accvgpr_read_b32 v137, a81
  v_accvgpr_read_b32 v138, a82
  v_accvgpr_read_b32 v139, a83
  v_accvgpr_read_b32 v140, a84
  v_accvgpr_read_b32 v141, a85
  v_accvgpr_read_b32 v142, a86
  v_accvgpr_read_b32 v143, a87
  v_pk_mul_f32 v[136:137], v[136:137], v[10:11] op_sel_hi:[1,0]
  v_pk_mul_f32 v[138:139], v[138:139], v[10:11] op_sel_hi:[1,0]
  v_pk_mul_f32 v[140:141], v[140:141], v[10:11] op_sel_hi:[1,0]
  v_pk_mul_f32 v[142:143], v[142:143], v[10:11] op_sel_hi:[1,0]
  v_cvt_pk_bf16_f32 v144, v136, v137
  v_cvt_pk_bf16_f32 v145, v138, v139
  v_cvt_pk_bf16_f32 v146, v140, v141
  v_cvt_pk_bf16_f32 v147, v142, v143
  buffer_store_dwordx4 v[144:147], v2, s[4:7], s28 offen offset:2048 sc1
  v_accvgpr_read_b32 v148, a88
  v_accvgpr_read_b32 v149, a89
  v_accvgpr_read_b32 v150, a90
  v_accvgpr_read_b32 v151, a91
  v_accvgpr_read_b32 v152, a92
  v_accvgpr_read_b32 v153, a93
  v_accvgpr_read_b32 v154, a94
  v_accvgpr_read_b32 v155, a95
  v_pk_mul_f32 v[148:149], v[148:149], v[10:11] op_sel_hi:[1,0]
  v_pk_mul_f32 v[150:151], v[150:151], v[10:11] op_sel_hi:[1,0]
  v_pk_mul_f32 v[152:153], v[152:153], v[10:11] op_sel_hi:[1,0]
  v_pk_mul_f32 v[154:155], v[154:155], v[10:11] op_sel_hi:[1,0]
  v_cvt_pk_bf16_f32 v156, v148, v149
  v_cvt_pk_bf16_f32 v157, v150, v151
  v_cvt_pk_bf16_f32 v158, v152, v153
  v_cvt_pk_bf16_f32 v159, v154, v155
  buffer_store_dwordx4 v[156:159], v2, s[4:7], s28 offen offset:3072 sc1
  s_add_u32 s28, s25, 100675584
  v_accvgpr_read_b32 v112, a96
  v_accvgpr_read_b32 v113, a97
  v_accvgpr_read_b32 v114, a98
  v_accvgpr_read_b32 v115, a99
  v_accvgpr_read_b32 v116, a100
  v_accvgpr_read_b32 v117, a101
  v_accvgpr_read_b32 v118, a102
  v_accvgpr_read_b32 v119, a103
  v_pk_mul_f32 v[112:113], v[112:113], v[10:11] op_sel_hi:[1,0]
  v_pk_mul_f32 v[114:115], v[114:115], v[10:11] op_sel_hi:[1,0]
  v_pk_mul_f32 v[116:117], v[116:117], v[10:11] op_sel_hi:[1,0]
  v_pk_mul_f32 v[118:119], v[118:119], v[10:11] op_sel_hi:[1,0]
  v_cvt_pk_bf16_f32 v120, v112, v113
  v_cvt_pk_bf16_f32 v121, v114, v115
  v_cvt_pk_bf16_f32 v122, v116, v117
  v_cvt_pk_bf16_f32 v123, v118, v119
  buffer_store_dwordx4 v[120:123], v2, s[4:7], s28 offen offset:0 sc1
  v_accvgpr_read_b32 v124, a104
  v_accvgpr_read_b32 v125, a105
  v_accvgpr_read_b32 v126, a106
  v_accvgpr_read_b32 v127, a107
  v_accvgpr_read_b32 v128, a108
  v_accvgpr_read_b32 v129, a109
  v_accvgpr_read_b32 v130, a110
  v_accvgpr_read_b32 v131, a111
  v_pk_mul_f32 v[124:125], v[124:125], v[10:11] op_sel_hi:[1,0]
  v_pk_mul_f32 v[126:127], v[126:127], v[10:11] op_sel_hi:[1,0]
  v_pk_mul_f32 v[128:129], v[128:129], v[10:11] op_sel_hi:[1,0]
  v_pk_mul_f32 v[130:131], v[130:131], v[10:11] op_sel_hi:[1,0]
  v_cvt_pk_bf16_f32 v132, v124, v125
  v_cvt_pk_bf16_f32 v133, v126, v127
  v_cvt_pk_bf16_f32 v134, v128, v129
  v_cvt_pk_bf16_f32 v135, v130, v131
  buffer_store_dwordx4 v[132:135], v2, s[4:7], s28 offen offset:1024 sc1
  v_accvgpr_read_b32 v136, a112
  v_accvgpr_read_b32 v137, a113
  v_accvgpr_read_b32 v138, a114
  v_accvgpr_read_b32 v139, a115
  v_accvgpr_read_b32 v140, a116
  v_accvgpr_read_b32 v141, a117
  v_accvgpr_read_b32 v142, a118
  v_accvgpr_read_b32 v143, a119
  v_pk_mul_f32 v[136:137], v[136:137], v[10:11] op_sel_hi:[1,0]
  v_pk_mul_f32 v[138:139], v[138:139], v[10:11] op_sel_hi:[1,0]
  v_pk_mul_f32 v[140:141], v[140:141], v[10:11] op_sel_hi:[1,0]
  v_pk_mul_f32 v[142:143], v[142:143], v[10:11] op_sel_hi:[1,0]
  v_cvt_pk_bf16_f32 v144, v136, v137
  v_cvt_pk_bf16_f32 v145, v138, v139
  v_cvt_pk_bf16_f32 v146, v140, v141
  v_cvt_pk_bf16_f32 v147, v142, v143
  buffer_store_dwordx4 v[144:147], v2, s[4:7], s28 offen offset:2048 sc1
  v_accvgpr_read_b32 v148, a120
  v_accvgpr_read_b32 v149, a121
  v_accvgpr_read_b32 v150, a122
  v_accvgpr_read_b32 v151, a123
  v_accvgpr_read_b32 v152, a124
  v_accvgpr_read_b32 v153, a125
  v_accvgpr_read_b32 v154, a126
  v_accvgpr_read_b32 v155, a127
  v_pk_mul_f32 v[148:149], v[148:149], v[10:11] op_sel_hi:[1,0]
  v_pk_mul_f32 v[150:151], v[150:151], v[10:11] op_sel_hi:[1,0]
  v_pk_mul_f32 v[152:153], v[152:153], v[10:11] op_sel_hi:[1,0]
  v_pk_mul_f32 v[154:155], v[154:155], v[10:11] op_sel_hi:[1,0]
  v_cvt_pk_bf16_f32 v156, v148, v149
  v_cvt_pk_bf16_f32 v157, v150, v151
  v_cvt_pk_bf16_f32 v158, v152, v153
  v_cvt_pk_bf16_f32 v159, v154, v155
  buffer_store_dwordx4 v[156:159], v2, s[4:7], s28 offen offset:3072 sc1
  s_branch A_out_31
A_kvw_32:
M_kv_35:
  s_cmp_ge_u32 s17, s36
  s_cbranch_scc1 M_kvok_36
  s_mov_b32 s76, 0
  s_mov_b32 s78, 18
  s_mov_b32 s77, 376832
  s_cmp_eq_u32 s68, 1
  s_cmov_b32 s76, 128
  s_cmov_b32 s78, 22
  s_cmov_b32 s77, 196608
  s_cmp_eq_u32 s68, 2
  s_cmov_b32 s76, 512
  s_cmov_b32 s78, 24
  s_cmov_b32 s77, 0
  s_add_u32 s76, s76, s67
  s_mov_b32 s71, 0
  s_branch M_sg_38
M_sw_37:
  s_sleep 8
  s_add_u32 s71, s71, 1
  s_cmp_gt_u32 s71, 262144
  s_cbranch_scc1 M_exit
M_sg_38:
  s_mov_b32 s79, 0
  s_atomic_or s79, s[72:73], s76 glc
  s_waitcnt lgkmcnt(0)
  s_cmp_lt_u32 s79, s78
  s_cbranch_scc1 M_sw_37
  s_add_u32 s36, s77, s19
  s_add_u32 s68, s68, 1
  s_branch M_kv_35
M_kvok_36:
  s_branch A_kvb_33
A_upd_29:
  s_cmp_eq_u32 s23, 2
  s_cbranch_scc1 A_upd2_39
  v_mov_b32 v12, s24
  v_cmp_le_i32 s[40:41], 0, v5
  v_cmp_le_i32 s[42:43], 1, v5
  v_cmp_le_i32 s[44:45], 2, v5
  v_cmp_le_i32 s[46:47], 3, v5
  v_cndmask_b32 v64, v12, v6, s[40:41]
  v_cndmask_b32 v65, v12, v6, s[42:43]
  v_cndmask_b32 v66, v12, v6, s[44:45]
  v_cndmask_b32 v67, v12, v6, s[46:47]
  v_cmp_le_i32 s[40:41], 8, v5
  v_cmp_le_i32 s[42:43], 9, v5
  v_cmp_le_i32 s[44:45], 10, v5
  v_cmp_le_i32 s[46:47], 11, v5
  v_cndmask_b32 v68, v12, v6, s[40:41]
  v_cndmask_b32 v69, v12, v6, s[42:43]
  v_cndmask_b32 v70, v12, v6, s[44:45]
  v_cndmask_b32 v71, v12, v6, s[46:47]
  v_cmp_le_i32 s[40:41], 16, v5
  v_cmp_le_i32 s[42:43], 17, v5
  v_cmp_le_i32 s[44:45], 18, v5
  v_cmp_le_i32 s[46:47], 19, v5
  v_cndmask_b32 v72, v12, v6, s[40:41]
  v_cndmask_b32 v73, v12, v6, s[42:43]
  v_cndmask_b32 v74, v12, v6, s[44:45]
  v_cndmask_b32 v75, v12, v6, s[46:47]
  v_cmp_le_i32 s[40:41], 24, v5
  v_cmp_le_i32 s[42:43], 25, v5
  v_cmp_le_i32 s[44:45], 26, v5
  v_cmp_le_i32 s[46:47], 27, v5
  v_cndmask_b32 v76, v12, v6, s[40:41]
  v_cndmask_b32 v77, v12, v6, s[42:43]
  v_cndmask_b32 v78, v12, v6, s[44:45]
  v_cndmask_b32 v79, v12, v6, s[46:47]
  v_mov_b32 v80, v7
  v_mov_b32 v81, v7
  v_mov_b32 v82, v7
  v_mov_b32 v83, v7
  v_mov_b32 v84, v7
  v_mov_b32 v85, v7
  v_mov_b32 v86, v7
  v_mov_b32 v87, v7
  v_mov_b32 v88, v7
  v_mov_b32 v89, v7
  v_mov_b32 v90, v7
  v_mov_b32 v91, v7
  v_mov_b32 v92, v7
  v_mov_b32 v93, v7
  v_mov_b32 v94, v7
  v_mov_b32 v95, v7
  s_branch A_back_30
A_upd2_39:
  v_mov_b32 v64, v6
  v_mov_b32 v65, v6
  v_mov_b32 v66, v6
  v_mov_b32 v67, v6
  v_mov_b32 v68, v6
  v_mov_b32 v69, v6
  v_mov_b32 v70, v6
  v_mov_b32 v71, v6
  v_mov_b32 v72, v6
  v_mov_b32 v73, v6
  v_mov_b32 v74, v6
  v_mov_b32 v75, v6
  v_mov_b32 v76, v6
  v_mov_b32 v77, v6
  v_mov_b32 v78, v6
  v_mov_b32 v79, v6
  s_branch A_back_30
A_slow_34:
  s_mov_b32 s29, 1
  v_mov_b32 v64, s24
  v_mov_b32 v65, s24
  v_mov_b32 v66, s24
  v_mov_b32 v67, s24
  v_mov_b32 v68, s24
  v_mov_b32 v69, s24
  v_mov_b32 v70, s24
  v_mov_b32 v71, s24
  v_mov_b32 v72, s24
  v_mov_b32 v73, s24
  v_mov_b32 v74, s24
  v_mov_b32 v75, s24
  v_mov_b32 v76, s24
  v_mov_b32 v77, s24
  v_mov_b32 v78, s24
  v_mov_b32 v79, s24
  v_mov_b32 v12, s24
  v_cmp_le_i32 s[40:41], 0, v5
  v_cmp_le_i32 s[42:43], 1, v5
  v_cmp_le_i32 s[44:45], 2, v5
  v_cmp_le_i32 s[46:47], 3, v5
  v_cndmask_b32 v80, v12, v7, s[40:41]
  v_cndmask_b32 v81, v12, v7, s[42:43]
  v_cndmask_b32 v82, v12, v7, s[44:45]
  v_cndmask_b32 v83, v12, v7, s[46:47]
  v_cmp_le_i32 s[40:41], 8, v5
  v_cmp_le_i32 s[42:43], 9, v5
  v_cmp_le_i32 s[44:45], 10, v5
  v_cmp_le_i32 s[46:47], 11, v5
  v_cndmask_b32 v84, v12, v7, s[40:41]
  v_cndmask_b32 v85, v12, v7, s[42:43]
  v_cndmask_b32 v86, v12, v7, s[44:45]
  v_cndmask_b32 v87, v12, v7, s[46:47]
  v_cmp_le_i32 s[40:41], 16, v5
  v_cmp_le_i32 s[42:43], 17, v5
  v_cmp_le_i32 s[44:45], 18, v5
  v_cmp_le_i32 s[46:47], 19, v5
  v_cndmask_b32 v88, v12, v7, s[40:41]
  v_cndmask_b32 v89, v12, v7, s[42:43]
  v_cndmask_b32 v90, v12, v7, s[44:45]
  v_cndmask_b32 v91, v12, v7, s[46:47]
  v_cmp_le_i32 s[40:41], 24, v5
  v_cmp_le_i32 s[42:43], 25, v5
  v_cmp_le_i32 s[44:45], 26, v5
  v_cmp_le_i32 s[46:47], 27, v5
  v_cndmask_b32 v92, v12, v7, s[40:41]
  v_cndmask_b32 v93, v12, v7, s[42:43]
  v_cndmask_b32 v94, v12, v7, s[44:45]
  v_cndmask_b32 v95, v12, v7, s[46:47]
  v_mov_b32 v8, s24
  v_mov_b32 v10, s24
  s_add_u32 s17, s25, 16785408
  s_mov_b32 s23, 0
A_ml_40:
  s_add_u32 s28, s17, 4096
  buffer_load_dwordx4 a[192:195], v2, s[4:7], s17 offen offset:0 sc1
  buffer_load_dwordx4 a[196:199], v2, s[4:7], s17 offen offset:1024 sc1
  buffer_load_dwordx4 a[200:203], v2, s[4:7], s17 offen offset:2048 sc1
  buffer_load_dwordx4 a[204:207], v2, s[4:7], s17 offen offset:3072 sc1
  buffer_load_dwordx4 a[208:211], v2, s[4:7], s28 offen offset:0 sc1
  buffer_load_dwordx4 a[212:215], v2, s[4:7], s28 offen offset:1024 sc1
  buffer_load_dwordx4 a[216:219], v2, s[4:7], s28 offen offset:2048 sc1
  buffer_load_dwordx4 a[220:223], v2, s[4:7], s28 offen offset:3072 sc1
  s_waitcnt vmcnt(0)
  v_mfma_f32_32x32x16_bf16 v[32:47], a[192:195], a[128:131], v[64:79]
  v_mfma_f32_32x32x16_bf16 v[32:47], a[196:199], a[132:135], v[32:47]
  v_mfma_f32_32x32x16_bf16 v[32:47], a[200:203], a[136:139], v[32:47]
  v_mfma_f32_32x32x16_bf16 v[32:47], a[204:207], a[140:143], v[32:47]
  v_mfma_f32_32x32x16_bf16 v[32:47], a[208:211], a[144:147], v[32:47]
  v_mfma_f32_32x32x16_bf16 v[32:47], a[212:215], a[148:151], v[32:47]
  v_mfma_f32_32x32x16_bf16 v[32:47], a[216:219], a[152:155], v[32:47]
  v_mfma_f32_32x32x16_bf16 v[32:47], a[220:223], a[156:159], v[32:47]
  v_mfma_f32_32x32x16_bf16 v[48:63], a[192:195], a[160:163], v[80:95]
  v_mfma_f32_32x32x16_bf16 v[48:63], a[196:199], a[164:167], v[48:63]
  v_mfma_f32_32x32x16_bf16 v[48:63], a[200:203], a[168:171], v[48:63]
  v_mfma_f32_32x32x16_bf16 v[48:63], a[204:207], a[172:175], v[48:63]
  v_mfma_f32_32x32x16_bf16 v[48:63], a[208:211], a[176:179], v[48:63]
  v_mfma_f32_32x32x16_bf16 v[48:63], a[212:215], a[180:183], v[48:63]
  v_mfma_f32_32x32x16_bf16 v[48:63], a[216:219], a[184:187], v[48:63]
  v_mfma_f32_32x32x16_bf16 v[48:63], a[220:223], a[188:191], v[48:63]
  s_nop 7
  s_nop 3
  v_max3_f32 v8, v8, v32, v33
  v_max3_f32 v8, v8, v34, v35
  v_max3_f32 v8, v8, v36, v37
  v_max3_f32 v8, v8, v38, v39
  v_max3_f32 v8, v8, v40, v41
  v_max3_f32 v8, v8, v42, v43
  v_max3_f32 v8, v8, v44, v45
  v_max3_f32 v8, v8, v46, v47
  v_max3_f32 v10, v10, v48, v49
  v_max3_f32 v10, v10, v50, v51
  v_max3_f32 v10, v10, v52, v53
  v_max3_f32 v10, v10, v54, v55
  v_max3_f32 v10, v10, v56, v57
  v_max3_f32 v10, v10, v58, v59
  v_max3_f32 v10, v10, v60, v61
  v_max3_f32 v10, v10, v62, v63
  s_add_u32 s23, s23, 1
  s_cmp_lg_u32 s23, 1
  s_cbranch_scc1 A_m2_41
  v_mov_b32 v12, s24
  v_cmp_le_i32 s[40:41], 0, v5
  v_cmp_le_i32 s[42:43], 1, v5
  v_cmp_le_i32 s[44:45], 2, v5
  v_cmp_le_i32 s[46:47], 3, v5
  v_cndmask_b32 v64, v12, v6, s[40:41]
  v_cndmask_b32 v65, v12, v6, s[42:43]
  v_cndmask_b32 v66, v12, v6, s[44:45]
  v_cndmask_b32 v67, v12, v6, s[46:47]
  v_cmp_le_i32 s[40:41], 8, v5
  v_cmp_le_i32 s[42:43], 9, v5
  v_cmp_le_i32 s[44:45], 10, v5
  v_cmp_le_i32 s[46:47], 11, v5
  v_cndmask_b32 v68, v12, v6, s[40:41]
  v_cndmask_b32 v69, v12, v6, s[42:43]
  v_cndmask_b32 v70, v12, v6, s[44:45]
  v_cndmask_b32 v71, v12, v6, s[46:47]
  v_cmp_le_i32 s[40:41], 16, v5
  v_cmp_le_i32 s[42:43], 17, v5
  v_cmp_le_i32 s[44:45], 18, v5
  v_cmp_le_i32 s[46:47], 19, v5
  v_cndmask_b32 v72, v12, v6, s[40:41]
  v_cndmask_b32 v73, v12, v6, s[42:43]
  v_cndmask_b32 v74, v12, v6, s[44:45]
  v_cndmask_b32 v75, v12, v6, s[46:47]
  v_cmp_le_i32 s[40:41], 24, v5
  v_cmp_le_i32 s[42:43], 25, v5
  v_cmp_le_i32 s[44:45], 26, v5
  v_cmp_le_i32 s[46:47], 27, v5
  v_cndmask_b32 v76, v12, v6, s[40:41]
  v_cndmask_b32 v77, v12, v6, s[42:43]
  v_cndmask_b32 v78, v12, v6, s[44:45]
  v_cndmask_b32 v79, v12, v6, s[46:47]
  v_mov_b32 v80, v7
  v_mov_b32 v81, v7
  v_mov_b32 v82, v7
  v_mov_b32 v83, v7
  v_mov_b32 v84, v7
  v_mov_b32 v85, v7
  v_mov_b32 v86, v7
  v_mov_b32 v87, v7
  v_mov_b32 v88, v7
  v_mov_b32 v89, v7
  v_mov_b32 v90, v7
  v_mov_b32 v91, v7
  v_mov_b32 v92, v7
  v_mov_b32 v93, v7
  v_mov_b32 v94, v7
  v_mov_b32 v95, v7
A_m2_41:
  s_cmp_lg_u32 s23, 2
  s_cbranch_scc1 A_m3_42
  v_mov_b32 v64, v6
  v_mov_b32 v65, v6
  v_mov_b32 v66, v6
  v_mov_b32 v67, v6
  v_mov_b32 v68, v6
  v_mov_b32 v69, v6
  v_mov_b32 v70, v6
  v_mov_b32 v71, v6
  v_mov_b32 v72, v6
  v_mov_b32 v73, v6
  v_mov_b32 v74, v6
  v_mov_b32 v75, v6
  v_mov_b32 v76, v6
  v_mov_b32 v77, v6
  v_mov_b32 v78, v6
  v_mov_b32 v79, v6
A_m3_42:
  s_sub_u32 s17, s17, 8192
  s_cmp_ge_i32 s17, s19
  s_cbranch_scc1 A_ml_40
  v_mov_b32 v9, v8
  s_nop 1
  v_permlane32_swap_b32 v8, v9
  s_nop 1
  v_max_f32 v8, v8, v9
  v_sub_f32 v6, 0, v8
  v_mov_b32 v11, v10
  s_nop 1
  v_permlane32_swap_b32 v10, v11
  s_nop 1
  v_max_f32 v10, v10, v11
  v_sub_f32 v7, 0, v10
  s_branch A_again_21
A_out_31:
  s_mov_b32 s69, s55
  s_mov_b32 s70, s56
  s_sub_u32 s52, s52, 1
  s_cmp_lg_u32 s52, 0
  s_cbranch_scc1 M_att
  s_waitcnt vmcnt(0)
  s_barrier
  s_mov_b32 s30, 512
  v_mov_b32 v144, s30
  v_min_u32 v145, 1, v0
  v_lshlrev_b32 v145, 30, v145
  buffer_store_dword v144, v145, s[4:7], s31 offen sc1
  s_lshr_b32 s48, s64, 2
  s_bfe_u32 s49, s64, 0x10001
  s_and_b32 s50, s64, 1
  s_mul_i32 s50, s50, 6
  s_add_u32 s50, s50, s65
  s_mov_b32 s51, 12
  s_cmp_lt_u32 s50, 4
  s_cselect_b32 s23, 6, 5
  s_load_dwordx2 s[8:9], s[0:1], 40
  s_lshl_b32 s17, s48, 19
  s_lshl_b32 s26, s49, 2
  s_add_u32 s26, s26, s16
  s_lshl_b32 s27, s26, 7
  s_add_u32 s17, s17, s27
  s_mov_b32 s18, 1024
  s_lshl_b32 s21, s48, 6
  s_add_u32 s21, s21, s50
  s_lshl_b32 s21, s21, 3
  s_add_u32 s21, s21, s26
  s_lshl_b32 s21, s21, 12
  s_add_u32 s21, s21, 150994944
  s_lshl_b32 s22, s51, 15
  s_mov_b32 s24, 1.0
  s_waitcnt lgkmcnt(0)
  s_and_b32 s9, s9, 0xffff
  s_mov_b32 s10, 4194304
  s_mov_b32 s11, 0x20000
  s_mov_b32 s12, s4
  s_mov_b32 s13, s5
  s_mov_b32 s14, 268435456
  s_mov_b32 s15, 0x20000
  s_lshl_b32 s19, s48, 8
  s_add_u32 s19, s19, s50
  s_lshl_b32 s19, s19, 13
  s_add_u32 s19, s19, 100663296
  s_lshl_b32 s20, s51, 13
  s_mul_i32 s26, s16, 524288
  v_add_u32 v8, 0, v2
  v_add_u32 v16, s26, v8
  v_add_u32 v9, 1024, v2
  v_add_u32 v17, s26, v9
  v_add_u32 v10, 2048, v2
  v_add_u32 v18, s26, v10
  v_add_u32 v11, 3072, v2
  v_add_u32 v19, s26, v11
  v_add_u32 v12, 4096, v2
  v_add_u32 v20, s26, v12
  v_add_u32 v13, 5120, v2
  v_add_u32 v21, s26, v13
  v_add_u32 v14, 6144, v2
  v_add_u32 v22, s26, v14
  v_add_u32 v15, 7168, v2
  v_add_u32 v23, s26, v15
  v_lshrrev_b32 v144, 3, v1
  v_mul_lo_u32 v144, v144, s18
  v_and_b32 v145, 7, v1
  v_lshl_add_u32 v144, v145, 4, v144
  s_lshl_b32 s28, s16, 15
  s_add_u32 s28, s28, 32768
  s_lshl_b32 s29, s18, 3
  s_add_u32 m0, s28, 0
  s_nop 0
  buffer_load_dwordx4 v144, s[8:11], s17 offen lds
  s_add_u32 s17, s17, s29
  s_add_u32 m0, s28, 1024
  s_nop 0
  buffer_load_dwordx4 v144, s[8:11], s17 offen lds
  s_add_u32 s17, s17, s29
  s_add_u32 m0, s28, 2048
  s_nop 0
  buffer_load_dwordx4 v144, s[8:11], s17 offen lds
  s_add_u32 s17, s17, s29
  s_add_u32 m0, s28, 3072
  s_nop 0
  buffer_load_dwordx4 v144, s[8:11], s17 offen lds
  s_add_u32 s17, s17, s29
  s_add_u32 m0, s28, 4096
  s_nop 0
  buffer_load_dwordx4 v144, s[8:11], s17 offen lds
  s_add_u32 s17, s17, s29
  s_add_u32 m0, s28, 5120
  s_nop 0
  buffer_load_dwordx4 v144, s[8:11], s17 offen lds
  s_add_u32 s17, s17, s29
  s_add_u32 m0, s28, 6144
  s_nop 0
  buffer_load_dwordx4 v144, s[8:11], s17 offen lds
  s_add_u32 s17, s17, s29
  s_add_u32 m0, s28, 7168
  s_nop 0
  buffer_load_dwordx4 v144, s[8:11], s17 offen lds
  s_add_u32 s17, s17, s29
  s_add_u32 m0, s28, 8192
  s_nop 0
  buffer_load_dwordx4 v144, s[8:11], s17 offen lds
  s_add_u32 s17, s17, s29
  s_add_u32 m0, s28, 9216
  s_nop 0
  buffer_load_dwordx4 v144, s[8:11], s17 offen lds
  s_add_u32 s17, s17, s29
  s_add_u32 m0, s28, 10240
  s_nop 0
  buffer_load_dwordx4 v144, s[8:11], s17 offen lds
  s_add_u32 s17, s17, s29
  s_add_u32 m0, s28, 11264
  s_nop 0
  buffer_load_dwordx4 v144, s[8:11], s17 offen lds
  s_add_u32 s17, s17, s29
  s_add_u32 m0, s28, 12288
  s_nop 0
  buffer_load_dwordx4 v144, s[8:11], s17 offen lds
  s_add_u32 s17, s17, s29
  s_add_u32 m0, s28, 13312
  s_nop 0
  buffer_load_dwordx4 v144, s[8:11], s17 offen lds
  s_add_u32 s17, s17, s29
  s_add_u32 m0, s28, 14336
  s_nop 0
  buffer_load_dwordx4 v144, s[8:11], s17 offen lds
  s_add_u32 s17, s17, s29
  s_add_u32 m0, s28, 15360
  s_nop 0
  buffer_load_dwordx4 v144, s[8:11], s17 offen lds
  s_add_u32 s17, s17, s29
  s_add_u32 m0, s28, 16384
  s_nop 0
  buffer_load_dwordx4 v144, s[8:11], s17 offen lds
  s_add_u32 s17, s17, s29
  s_add_u32 m0, s28, 17408
  s_nop 0
  buffer_load_dwordx4 v144, s[8:11], s17 offen lds
  s_add_u32 s17, s17, s29
  s_add_u32 m0, s28, 18432
  s_nop 0
  buffer_load_dwordx4 v144, s[8:11], s17 offen lds
  s_add_u32 s17, s17, s29
  s_add_u32 m0, s28, 19456
  s_nop 0
  buffer_load_dwordx4 v144, s[8:11], s17 offen lds
  s_add_u32 s17, s17, s29
  s_add_u32 m0, s28, 20480
  s_nop 0
  buffer_load_dwordx4 v144, s[8:11], s17 offen lds
  s_add_u32 s17, s17, s29
  s_add_u32 m0, s28, 21504
  s_nop 0
  buffer_load_dwordx4 v144, s[8:11], s17 offen lds
  s_add_u32 s17, s17, s29
  s_add_u32 m0, s28, 22528
  s_nop 0
  buffer_load_dwordx4 v144, s[8:11], s17 offen lds
  s_add_u32 s17, s17, s29
  s_add_u32 m0, s28, 23552
  s_nop 0
  buffer_load_dwordx4 v144, s[8:11], s17 offen lds
  s_add_u32 s17, s17, s29
  s_add_u32 m0, s28, 24576
  s_nop 0
  buffer_load_dwordx4 v144, s[8:11], s17 offen lds
  s_add_u32 s17, s17, s29
  s_add_u32 m0, s28, 25600
  s_nop 0
  buffer_load_dwordx4 v144, s[8:11], s17 offen lds
  s_add_u32 s17, s17, s29
  s_add_u32 m0, s28, 26624
  s_nop 0
  buffer_load_dwordx4 v144, s[8:11], s17 offen lds
  s_add_u32 s17, s17, s29
  s_add_u32 m0, s28, 27648
  s_nop 0
  buffer_load_dwordx4 v144, s[8:11], s17 offen lds
  s_add_u32 s17, s17, s29
  s_add_u32 m0, s28, 28672
  s_nop 0
  buffer_load_dwordx4 v144, s[8:11], s17 offen lds
  s_add_u32 s17, s17, s29
  s_add_u32 m0, s28, 29696
  s_nop 0
  buffer_load_dwordx4 v144, s[8:11], s17 offen lds
  s_add_u32 s17, s17, s29
  s_add_u32 m0, s28, 30720
  s_nop 0
  buffer_load_dwordx4 v144, s[8:11], s17 offen lds
  s_add_u32 s17, s17, s29
  s_add_u32 m0, s28, 31744
  s_nop 0
  buffer_load_dwordx4 v144, s[8:11], s17 offen lds
  s_add_u32 s17, s17, s29
  v_bfe_u32 v148, v1, 2, 2
  v_lshrrev_b32 v149, 5, v1
  v_lshl_add_u32 v148, v149, 2, v148
  v_lshlrev_b32 v148, 7, v148
  v_bfe_u32 v149, v1, 4, 1
  v_lshl_add_u32 v148, v149, 5, v148
  v_and_b32 v149, 1, v1
  v_lshl_add_u32 v148, v149, 4, v148
  v_bfe_u32 v149, v1, 1, 1
  v_lshl_add_u32 v148, v149, 3, v148
  v_add_u32 v146, s28, v148
  v_add_u32 v147, 1024, v146
  s_waitcnt vmcnt(28)
  ds_read_b64_tr_b16 a[0:1], v146 offset:0
  ds_read_b64_tr_b16 a[2:3], v147 offset:0
  ds_read_b64_tr_b16 a[4:5], v146 offset:64
  ds_read_b64_tr_b16 a[6:7], v147 offset:64
  ds_read_b64_tr_b16 a[8:9], v146 offset:2048
  ds_read_b64_tr_b16 a[10:11], v147 offset:2048
  ds_read_b64_tr_b16 a[12:13], v146 offset:2112
  ds_read_b64_tr_b16 a[14:15], v147 offset:2112
  s_waitcnt lgkmcnt(0)
  s_add_u32 m0, s28, 0
  s_nop 0
  buffer_load_dwordx4 v144, s[8:11], s17 offen lds
  s_add_u32 s17, s17, s29
  s_add_u32 m0, s28, 1024
  s_nop 0
  buffer_load_dwordx4 v144, s[8:11], s17 offen lds
  s_add_u32 s17, s17, s29
  s_add_u32 m0, s28, 2048
  s_nop 0
  buffer_load_dwordx4 v144, s[8:11], s17 offen lds
  s_add_u32 s17, s17, s29
  s_add_u32 m0, s28, 3072
  s_nop 0
  buffer_load_dwordx4 v144, s[8:11], s17 offen lds
  s_add_u32 s17, s17, s29
  s_waitcnt vmcnt(28)
  ds_read_b64_tr_b16 a[16:17], v146 offset:4096
  ds_read_b64_tr_b16 a[18:19], v147 offset:4096
  ds_read_b64_tr_b16 a[20:21], v146 offset:4160
  ds_read_b64_tr_b16 a[22:23], v147 offset:4160
  ds_read_b64_tr_b16 a[24:25], v146 offset:6144
  ds_read_b64_tr_b16 a[26:27], v147 offset:6144
  ds_read_b64_tr_b16 a[28:29], v146 offset:6208
  ds_read_b64_tr_b16 a[30:31], v147 offset:6208
  s_waitcnt lgkmcnt(0)
  s_add_u32 m0, s28, 4096
  s_nop 0
  buffer_load_dwordx4 v144, s[8:11], s17 offen lds
  s_add_u32 s17, s17, s29
  s_add_u32 m0, s28, 5120
  s_nop 0
  buffer_load_dwordx4 v144, s[8:11], s17 offen lds
  s_add_u32 s17, s17, s29
  s_add_u32 m0, s28, 6144
  s_nop 0
  buffer_load_dwordx4 v144, s[8:11], s17 offen lds
  s_add_u32 s17, s17, s29
  s_add_u32 m0, s28, 7168
  s_nop 0
  buffer_load_dwordx4 v144, s[8:11], s17 offen lds
  s_add_u32 s17, s17, s29
  s_waitcnt vmcnt(28)
  ds_read_b64_tr_b16 a[32:33], v146 offset:8192
  ds_read_b64_tr_b16 a[34:35], v147 offset:8192
  ds_read_b64_tr_b16 a[36:37], v146 offset:8256
  ds_read_b64_tr_b16 a[38:39], v147 offset:8256
  ds_read_b64_tr_b16 a[40:41], v146 offset:10240
  ds_read_b64_tr_b16 a[42:43], v147 offset:10240
  ds_read_b64_tr_b16 a[44:45], v146 offset:10304
  ds_read_b64_tr_b16 a[46:47], v147 offset:10304
  s_waitcnt lgkmcnt(0)
  s_add_u32 m0, s28, 8192
  s_nop 0
  buffer_load_dwordx4 v144, s[8:11], s17 offen lds
  s_add_u32 s17, s17, s29
  s_add_u32 m0, s28, 9216
  s_nop 0
  buffer_load_dwordx4 v144, s[8:11], s17 offen lds
  s_add_u32 s17, s17, s29
  s_add_u32 m0, s28, 10240
  s_nop 0
  buffer_load_dwordx4 v144, s[8:11], s17 offen lds
  s_add_u32 s17, s17, s29
  s_add_u32 m0, s28, 11264
  s_nop 0
  buffer_load_dwordx4 v144, s[8:11], s17 offen lds
  s_add_u32 s17, s17, s29
  s_waitcnt vmcnt(28)
  ds_read_b64_tr_b16 a[48:49], v146 offset:12288
  ds_read_b64_tr_b16 a[50:51], v147 offset:12288
  ds_read_b64_tr_b16 a[52:53], v146 offset:12352
  ds_read_b64_tr_b16 a[54:55], v147 offset:12352
  ds_read_b64_tr_b16 a[56:57], v146 offset:14336
  ds_read_b64_tr_b16 a[58:59], v147 offset:14336
  ds_read_b64_tr_b16 a[60:61], v146 offset:14400
  ds_read_b64_tr_b16 a[62:63], v147 offset:14400
  s_waitcnt lgkmcnt(0)
  s_add_u32 m0, s28, 12288
  s_nop 0
  buffer_load_dwordx4 v144, s[8:11], s17 offen lds
  s_add_u32 s17, s17, s29
  s_add_u32 m0, s28, 13312
  s_nop 0
  buffer_load_dwordx4 v144, s[8:11], s17 offen lds
  s_add_u32 s17, s17, s29
  s_add_u32 m0, s28, 14336
  s_nop 0
  buffer_load_dwordx4 v144, s[8:11], s17 offen lds
  s_add_u32 s17, s17, s29
  s_add_u32 m0, s28, 15360
  s_nop 0
  buffer_load_dwordx4 v144, s[8:11], s17 offen lds
  s_add_u32 s17, s17, s29
  s_waitcnt vmcnt(28)
  ds_read_b64_tr_b16 a[64:65], v146 offset:16384
  ds_read_b64_tr_b16 a[66:67], v147 offset:16384
  ds_read_b64_tr_b16 a[68:69], v146 offset:16448
  ds_read_b64_tr_b16 a[70:71], v147 offset:16448
  ds_read_b64_tr_b16 a[72:73], v146 offset:18432
  ds_read_b64_tr_b16 a[74:75], v147 offset:18432
  ds_read_b64_tr_b16 a[76:77], v146 offset:18496
  ds_read_b64_tr_b16 a[78:79], v147 offset:18496
  s_waitcnt lgkmcnt(0)
  s_add_u32 m0, s28, 16384
  s_nop 0
  buffer_load_dwordx4 v144, s[8:11], s17 offen lds
  s_add_u32 s17, s17, s29
  s_add_u32 m0, s28, 17408
  s_nop 0
  buffer_load_dwordx4 v144, s[8:11], s17 offen lds
  s_add_u32 s17, s17, s29
  s_add_u32 m0, s28, 18432
  s_nop 0
  buffer_load_dwordx4 v144, s[8:11], s17 offen lds
  s_add_u32 s17, s17, s29
  s_add_u32 m0, s28, 19456
  s_nop 0
  buffer_load_dwordx4 v144, s[8:11], s17 offen lds
  s_add_u32 s17, s17, s29
  s_waitcnt vmcnt(28)
  ds_read_b64_tr_b16 a[80:81], v146 offset:20480
  ds_read_b64_tr_b16 a[82:83], v147 offset:20480
  ds_read_b64_tr_b16 a[84:85], v146 offset:20544
  ds_read_b64_tr_b16 a[86:87], v147 offset:20544
  ds_read_b64_tr_b16 a[88:89], v146 offset:22528
  ds_read_b64_tr_b16 a[90:91], v147 offset:22528
  ds_read_b64_tr_b16 a[92:93], v146 offset:22592
  ds_read_b64_tr_b16 a[94:95], v147 offset:22592
  s_waitcnt lgkmcnt(0)
  s_add_u32 m0, s28, 20480
  s_nop 0
  buffer_load_dwordx4 v144, s[8:11], s17 offen lds
  s_add_u32 s17, s17, s29
  s_add_u32 m0, s28, 21504
  s_nop 0
  buffer_load_dwordx4 v144, s[8:11], s17 offen lds
  s_add_u32 s17, s17, s29
  s_add_u32 m0, s28, 22528
  s_nop 0
  buffer_load_dwordx4 v144, s[8:11], s17 offen lds
  s_add_u32 s17, s17, s29
  s_add_u32 m0, s28, 23552
  s_nop 0
  buffer_load_dwordx4 v144, s[8:11], s17 offen lds
  s_add_u32 s17, s17, s29
  s_waitcnt vmcnt(28)
  ds_read_b64_tr_b16 a[96:97], v146 offset:24576
  ds_read_b64_tr_b16 a[98:99], v147 offset:24576
  ds_read_b64_tr_b16 a[100:101], v146 offset:24640
  ds_read_b64_tr_b16 a[102:103], v147 offset:24640
  ds_read_b64_tr_b16 a[104:105], v146 offset:26624
  ds_read_b64_tr_b16 a[106:107], v147 offset:26624
  ds_read_b64_tr_b16 a[108:109], v146 offset:26688
  ds_read_b64_tr_b16 a[110:111], v147 offset:26688
  s_waitcnt lgkmcnt(0)
  s_add_u32 m0, s28, 24576
  s_nop 0
  buffer_load_dwordx4 v144, s[8:11], s17 offen lds
  s_add_u32 s17, s17, s29
  s_add_u32 m0, s28, 25600
  s_nop 0
  buffer_load_dwordx4 v144, s[8:11], s17 offen lds
  s_add_u32 s17, s17, s29
  s_add_u32 m0, s28, 26624
  s_nop 0
  buffer_load_dwordx4 v144, s[8:11], s17 offen lds
  s_add_u32 s17, s17, s29
  s_add_u32 m0, s28, 27648
  s_nop 0
  buffer_load_dwordx4 v144, s[8:11], s17 offen lds
  s_add_u32 s17, s17, s29
  s_waitcnt vmcnt(28)
  ds_read_b64_tr_b16 a[112:113], v146 offset:28672
  ds_read_b64_tr_b16 a[114:115], v147 offset:28672
  ds_read_b64_tr_b16 a[116:117], v146 offset:28736
  ds_read_b64_tr_b16 a[118:119], v147 offset:28736
  ds_read_b64_tr_b16 a[120:121], v146 offset:30720
  ds_read_b64_tr_b16 a[122:123], v147 offset:30720
  ds_read_b64_tr_b16 a[124:125], v146 offset:30784
  ds_read_b64_tr_b16 a[126:127], v147 offset:30784
  s_waitcnt lgkmcnt(0)
  s_add_u32 m0, s28, 28672
  s_nop 0
  buffer_load_dwordx4 v144, s[8:11], s17 offen lds
  s_add_u32 s17, s17, s29
  s_add_u32 m0, s28, 29696
  s_nop 0
  buffer_load_dwordx4 v144, s[8:11], s17 offen lds
  s_add_u32 s17, s17, s29
  s_add_u32 m0, s28, 30720
  s_nop 0
  buffer_load_dwordx4 v144, s[8:11], s17 offen lds
  s_add_u32 s17, s17, s29
  s_add_u32 m0, s28, 31744
  s_nop 0
  buffer_load_dwordx4 v144, s[8:11], s17 offen lds
  s_add_u32 s17, s17, s29
  s_waitcnt vmcnt(28)
  ds_read_b64_tr_b16 a[128:129], v146 offset:0
  ds_read_b64_tr_b16 a[130:131], v147 offset:0
  ds_read_b64_tr_b16 a[132:133], v146 offset:64
  ds_read_b64_tr_b16 a[134:135], v147 offset:64
  ds_read_b64_tr_b16 a[136:137], v146 offset:2048
  ds_read_b64_tr_b16 a[138:139], v147 offset:2048
  ds_read_b64_tr_b16 a[140:141], v146 offset:2112
  ds_read_b64_tr_b16 a[142:143], v147 offset:2112
  s_waitcnt lgkmcnt(0)
  s_waitcnt vmcnt(24)
  ds_read_b64_tr_b16 a[144:145], v146 offset:4096
  ds_read_b64_tr_b16 a[146:147], v147 offset:4096
  ds_read_b64_tr_b16 a[148:149], v146 offset:4160
  ds_read_b64_tr_b16 a[150:151], v147 offset:4160
  ds_read_b64_tr_b16 a[152:153], v146 offset:6144
  ds_read_b64_tr_b16 a[154:155], v147 offset:6144
  ds_read_b64_tr_b16 a[156:157], v146 offset:6208
  ds_read_b64_tr_b16 a[158:159], v147 offset:6208
  s_waitcnt lgkmcnt(0)
  s_waitcnt vmcnt(20)
  ds_read_b64_tr_b16 a[160:161], v146 offset:8192
  ds_read_b64_tr_b16 a[162:163], v147 offset:8192
  ds_read_b64_tr_b16 a[164:165], v146 offset:8256
  ds_read_b64_tr_b16 a[166:167], v147 offset:8256
  ds_read_b64_tr_b16 a[168:169], v146 offset:10240
  ds_read_b64_tr_b16 a[170:171], v147 offset:10240
  ds_read_b64_tr_b16 a[172:173], v146 offset:10304
  ds_read_b64_tr_b16 a[174:175], v147 offset:10304
  s_waitcnt lgkmcnt(0)
  s_waitcnt vmcnt(16)
  ds_read_b64_tr_b16 a[176:177], v146 offset:12288
  ds_read_b64_tr_b16 a[178:179], v147 offset:12288
  ds_read_b64_tr_b16 a[180:181], v146 offset:12352
  ds_read_b64_tr_b16 a[182:183], v147 offset:12352
  ds_read_b64_tr_b16 a[184:185], v146 offset:14336
  ds_read_b64_tr_b16 a[186:187], v147 offset:14336
  ds_read_b64_tr_b16 a[188:189], v146 offset:14400
  ds_read_b64_tr_b16 a[190:191], v147 offset:14400
  s_waitcnt lgkmcnt(0)
  s_waitcnt vmcnt(12)
  ds_read_b64_tr_b16 a[192:193], v146 offset:16384
  ds_read_b64_tr_b16 a[194:195], v147 offset:16384
  ds_read_b64_tr_b16 a[196:197], v146 offset:16448
  ds_read_b64_tr_b16 a[198:199], v147 offset:16448
  ds_read_b64_tr_b16 a[200:201], v146 offset:18432
  ds_read_b64_tr_b16 a[202:203], v147 offset:18432
  ds_read_b64_tr_b16 a[204:205], v146 offset:18496
  ds_read_b64_tr_b16 a[206:207], v147 offset:18496
  s_waitcnt lgkmcnt(0)
  s_waitcnt vmcnt(8)
  ds_read_b64_tr_b16 a[208:209], v146 offset:20480
  ds_read_b64_tr_b16 a[210:211], v147 offset:20480
  ds_read_b64_tr_b16 a[212:213], v146 offset:20544
  ds_read_b64_tr_b16 a[214:215], v147 offset:20544
  ds_read_b64_tr_b16 a[216:217], v146 offset:22528
  ds_read_b64_tr_b16 a[218:219], v147 offset:22528
  ds_read_b64_tr_b16 a[220:221], v146 offset:22592
  ds_read_b64_tr_b16 a[222:223], v147 offset:22592
  s_waitcnt lgkmcnt(0)
  s_waitcnt vmcnt(4)
  ds_read_b64_tr_b16 a[224:225], v146 offset:24576
  ds_read_b64_tr_b16 a[226:227], v147 offset:24576
  ds_read_b64_tr_b16 a[228:229], v146 offset:24640
  ds_read_b64_tr_b16 a[230:231], v147 offset:24640
  ds_read_b64_tr_b16 a[232:233], v146 offset:26624
  ds_read_b64_tr_b16 a[234:235], v147 offset:26624
  ds_read_b64_tr_b16 a[236:237], v146 offset:26688
  ds_read_b64_tr_b16 a[238:239], v147 offset:26688
  s_waitcnt lgkmcnt(0)
  s_waitcnt vmcnt(0)
  ds_read_b64_tr_b16 a[240:241], v146 offset:28672
  ds_read_b64_tr_b16 a[242:243], v147 offset:28672
  ds_read_b64_tr_b16 a[244:245], v146 offset:28736
  ds_read_b64_tr_b16 a[246:247], v147 offset:28736
  ds_read_b64_tr_b16 a[248:249], v146 offset:30720
  ds_read_b64_tr_b16 a[250:251], v147 offset:30720
  ds_read_b64_tr_b16 a[252:253], v146 offset:30784
  ds_read_b64_tr_b16 a[254:255], v147 offset:30784
  s_waitcnt lgkmcnt(0)
  v_min_u32 v4, 27, v1
  v_mul_u32_u24 v5, 37, v4
  v_lshrrev_b32 v5, 8, v5
  v_mul_u32_u24 v5, 7, v5
  v_sub_u32 v5, v4, v5
  v_mov_b32 v6, 0x200
  v_cmp_ne_u32 vcc, 6, v5
  s_mul_i32 s76, s48, 3584
  s_add_u32 s76, s76, 148897792
  v_cndmask_b32 v5, 0, v6, vcc
  v_lshl_add_u32 v4, v4, 7, s76
  s_mov_b32 s71, 0
  s_branch M_vg_44
M_vw_43:
  s_sleep 2
  s_add_u32 s71, s71, 1
  s_cmp_gt_u32 s71, 262144
  s_cbranch_scc1 M_exit
M_vg_44:
  buffer_load_dword v6, v4, s[4:7], 0 offen sc1
  s_waitcnt vmcnt(0)
  v_cmp_lt_u32 vcc, v6, v5
  s_cbranch_vccnz M_vw_43
  s_barrier
  s_lshl_b32 s25, s16, 13
  s_add_u32 m0, s25, 0
  s_nop 0
  buffer_load_dwordx4 v16, s[12:15], s19 offen sc1 lds
  s_add_u32 m0, s25, 1024
  s_nop 0
  buffer_load_dwordx4 v17, s[12:15], s19 offen sc1 lds
  s_add_u32 m0, s25, 2048
  s_nop 0
  buffer_load_dwordx4 v18, s[12:15], s19 offen sc1 lds
  s_add_u32 m0, s25, 3072
  s_nop 0
  buffer_load_dwordx4 v19, s[12:15], s19 offen sc1 lds
  s_add_u32 m0, s25, 4096
  s_nop 0
  buffer_load_dwordx4 v20, s[12:15], s19 offen sc1 lds
  s_add_u32 m0, s25, 5120
  s_nop 0
  buffer_load_dwordx4 v21, s[12:15], s19 offen sc1 lds
  s_add_u32 m0, s25, 6144
  s_nop 0
  buffer_load_dwordx4 v22, s[12:15], s19 offen sc1 lds
  s_add_u32 m0, s25, 7168
  s_nop 0
  buffer_load_dwordx4 v23, s[12:15], s19 offen sc1 lds
  s_cmp_gt_u32 s23, 1
  s_cselect_b32 s26, s20, 0
  s_add_u32 s19, s19, s26
  s_add_u32 s25, s25, 32768
  s_and_b32 s25, s25, 0x1ffff
  s_add_u32 m0, s25, 0
  s_nop 0
  buffer_load_dwordx4 v16, s[12:15], s19 offen sc1 lds
  s_add_u32 m0, s25, 1024
  s_nop 0
  buffer_load_dwordx4 v17, s[12:15], s19 offen sc1 lds
  s_add_u32 m0, s25, 2048
  s_nop 0
  buffer_load_dwordx4 v18, s[12:15], s19 offen sc1 lds
  s_add_u32 m0, s25, 3072
  s_nop 0
  buffer_load_dwordx4 v19, s[12:15], s19 offen sc1 lds
  s_add_u32 m0, s25, 4096
  s_nop 0
  buffer_load_dwordx4 v20, s[12:15], s19 offen sc1 lds
  s_add_u32 m0, s25, 5120
  s_nop 0
  buffer_load_dwordx4 v21, s[12:15], s19 offen sc1 lds
  s_add_u32 m0, s25, 6144
  s_nop 0
  buffer_load_dwordx4 v22, s[12:15], s19 offen sc1 lds
  s_add_u32 m0, s25, 7168
  s_nop 0
  buffer_load_dwordx4 v23, s[12:15], s19 offen sc1 lds
  s_cmp_gt_u32 s23, 2
  s_cselect_b32 s26, s20, 0
  s_add_u32 s19, s19, s26
  s_add_u32 s25, s25, 32768
  s_and_b32 s25, s25, 0x1ffff
  s_waitcnt vmcnt(0)
  s_barrier
  s_mov_b32 s27, s21
  v_mov_b32 v7, 0x40000000
  ds_read_b128 v[24:27], v8 offset:0
  ds_read_b128 v[28:31], v9 offset:0
  ds_read_b128 v[32:35], v10 offset:0
  ds_read_b128 v[36:39], v11 offset:0
  ds_read_b128 v[40:43], v12 offset:0
  ds_read_b128 v[44:47], v13 offset:0
.p2align 6
G_top_45:
  s_waitcnt lgkmcnt(5)
  v_mfma_f32_32x32x16_bf16 v[64:79], a[0:3], v[24:27], 0
  s_add_u32 m0, s25, 0
  ds_read_b128 v[48:51], v14 offset:0
  v_mfma_f32_32x32x16_bf16 v[80:95], a[4:7], v[24:27], 0
  s_waitcnt lgkmcnt(5)
  buffer_load_dwordx4 v16, s[12:15], s19 offen sc1 lds
  v_mfma_f32_32x32x16_bf16 v[64:79], a[8:11], v[28:31], v[64:79]
  ds_read_b128 v[52:55], v15 offset:0
  v_mul_f32 v96, s24, v96
  v_mul_f32 v97, s24, v97
  v_mfma_f32_32x32x16_bf16 v[80:95], a[12:15], v[28:31], v[80:95]
  s_waitcnt lgkmcnt(5)
  v_cvt_pk_bf16_f32 v128, v96, v97
  v_mul_f32 v98, s24, v98
  v_mfma_f32_32x32x16_bf16 v[64:79], a[16:19], v[32:35], v[64:79]
  s_add_u32 m0, s25, 1024
  ds_read_b128 v[24:27], v8 offset:8192
  v_mul_f32 v99, s24, v99
  v_cvt_pk_bf16_f32 v129, v98, v99
  v_mfma_f32_32x32x16_bf16 v[80:95], a[20:23], v[32:35], v[80:95]
  s_waitcnt lgkmcnt(5)
  buffer_load_dwordx4 v17, s[12:15], s19 offen sc1 lds
  v_mul_f32 v100, s24, v100
  v_mul_f32 v101, s24, v101
  v_mfma_f32_32x32x16_bf16 v[64:79], a[24:27], v[36:39], v[64:79]
  ds_read_b128 v[28:31], v9 offset:8192
  v_cvt_pk_bf16_f32 v130, v100, v101
  v_mul_f32 v102, s24, v102
  v_mfma_f32_32x32x16_bf16 v[80:95], a[28:31], v[36:39], v[80:95]
  s_waitcnt lgkmcnt(5)
  v_mul_f32 v103, s24, v103
  v_cvt_pk_bf16_f32 v131, v102, v103
  v_mfma_f32_32x32x16_bf16 v[64:79], a[32:35], v[40:43], v[64:79]
  s_add_u32 m0, s25, 2048
  ds_read_b128 v[32:35], v10 offset:8192
  v_mul_f32 v104, s24, v104
  v_mul_f32 v105, s24, v105
  v_mfma_f32_32x32x16_bf16 v[80:95], a[36:39], v[40:43], v[80:95]
  s_waitcnt lgkmcnt(5)
  buffer_load_dwordx4 v18, s[12:15], s19 offen sc1 lds
  v_cvt_pk_bf16_f32 v132, v104, v105
  v_mul_f32 v106, s24, v106
  v_mfma_f32_32x32x16_bf16 v[64:79], a[40:43], v[44:47], v[64:79]
  ds_read_b128 v[36:39], v11 offset:8192
  v_mul_f32 v107, s24, v107
  v_cvt_pk_bf16_f32 v133, v106, v107
  v_mfma_f32_32x32x16_bf16 v[80:95], a[44:47], v[44:47], v[80:95]
  s_waitcnt lgkmcnt(5)
  v_mul_f32 v108, s24, v108
  v_mul_f32 v109, s24, v109
  v_mfma_f32_32x32x16_bf16 v[64:79], a[48:51], v[48:51], v[64:79]
  s_add_u32 m0, s25, 3072
  ds_read_b128 v[40:43], v12 offset:8192
  v_cvt_pk_bf16_f32 v134, v108, v109
  v_mul_f32 v110, s24, v110
  v_mfma_f32_32x32x16_bf16 v[80:95], a[52:55], v[48:51], v[80:95]
  s_waitcnt lgkmcnt(5)
  buffer_load_dwordx4 v19, s[12:15], s19 offen sc1 lds
  v_mul_f32 v111, s24, v111
  v_cvt_pk_bf16_f32 v135, v110, v111
  v_mfma_f32_32x32x16_bf16 v[64:79], a[56:59], v[52:55], v[64:79]
  ds_read_b128 v[44:47], v13 offset:8192
  v_mul_f32 v112, s24, v112
  v_mul_f32 v113, s24, v113
  v_mfma_f32_32x32x16_bf16 v[80:95], a[60:63], v[52:55], v[80:95]
  s_waitcnt lgkmcnt(5)
  v_cvt_pk_bf16_f32 v136, v112, v113
  v_mul_f32 v114, s24, v114
  v_mfma_f32_32x32x16_bf16 v[64:79], a[64:67], v[24:27], v[64:79]
  s_add_u32 m0, s25, 4096
  ds_read_b128 v[48:51], v14 offset:8192
  v_mul_f32 v115, s24, v115
  v_cvt_pk_bf16_f32 v137, v114, v115
  v_mfma_f32_32x32x16_bf16 v[80:95], a[68:71], v[24:27], v[80:95]
  s_waitcnt lgkmcnt(5)
  buffer_load_dwordx4 v20, s[12:15], s19 offen sc1 lds
  v_mul_f32 v116, s24, v116
  v_mul_f32 v117, s24, v117
  v_mfma_f32_32x32x16_bf16 v[64:79], a[72:75], v[28:31], v[64:79]
  ds_read_b128 v[52:55], v15 offset:8192
  v_cvt_pk_bf16_f32 v138, v116, v117
  v_mul_f32 v118, s24, v118
  v_mfma_f32_32x32x16_bf16 v[80:95], a[76:79], v[28:31], v[80:95]
  s_waitcnt lgkmcnt(5)
  v_mul_f32 v119, s24, v119
  v_cvt_pk_bf16_f32 v139, v118, v119
  v_mfma_f32_32x32x16_bf16 v[64:79], a[80:83], v[32:35], v[64:79]
  s_add_u32 m0, s25, 5120
  ds_read_b128 v[24:27], v8 offset:16384
  v_mul_f32 v120, s24, v120
  v_mul_f32 v121, s24, v121
  v_mfma_f32_32x32x16_bf16 v[80:95], a[84:87], v[32:35], v[80:95]
  s_waitcnt lgkmcnt(5)
  buffer_load_dwordx4 v21, s[12:15], s19 offen sc1 lds
  v_cvt_pk_bf16_f32 v140, v120, v121
  v_mul_f32 v122, s24, v122
  v_mfma_f32_32x32x16_bf16 v[64:79], a[88:91], v[36:39], v[64:79]
  ds_read_b128 v[28:31], v9 offset:16384
  v_mul_f32 v123, s24, v123
  v_cvt_pk_bf16_f32 v141, v122, v123
  v_mfma_f32_32x32x16_bf16 v[80:95], a[92:95], v[36:39], v[80:95]
  s_waitcnt lgkmcnt(5)
  v_mul_f32 v124, s24, v124
  v_mul_f32 v125, s24, v125
  v_mfma_f32_32x32x16_bf16 v[64:79], a[96:99], v[40:43], v[64:79]
  s_add_u32 m0, s25, 6144
  ds_read_b128 v[32:35], v10 offset:16384
  v_cvt_pk_bf16_f32 v142, v124, v125
  v_mul_f32 v126, s24, v126
  v_mfma_f32_32x32x16_bf16 v[80:95], a[100:103], v[40:43], v[80:95]
  s_waitcnt lgkmcnt(5)
  buffer_load_dwordx4 v22, s[12:15], s19 offen sc1 lds
  v_mul_f32 v127, s24, v127
  v_cvt_pk_bf16_f32 v143, v126, v127
  v_mfma_f32_32x32x16_bf16 v[64:79], a[104:107], v[44:47], v[64:79]
  ds_read_b128 v[36:39], v11 offset:16384
  v_mfma_f32_32x32x16_bf16 v[80:95], a[108:111], v[44:47], v[80:95]
  s_waitcnt lgkmcnt(5)
  v_mfma_f32_32x32x16_bf16 v[64:79], a[112:115], v[48:51], v[64:79]
  s_add_u32 m0, s25, 7168
  ds_read_b128 v[40:43], v12 offset:16384
  v_mfma_f32_32x32x16_bf16 v[80:95], a[116:119], v[48:51], v[80:95]
  s_waitcnt lgkmcnt(5)
  buffer_load_dwordx4 v23, s[12:15], s19 offen sc1 lds
  v_mfma_f32_32x32x16_bf16 v[64:79], a[120:123], v[52:55], v[64:79]
  s_cmp_gt_u32 s23, 3
  ds_read_b128 v[44:47], v13 offset:16384
  v_mfma_f32_32x32x16_bf16 v[80:95], a[124:127], v[52:55], v[80:95]
  s_waitcnt lgkmcnt(5)
  s_cselect_b32 s26, s20, 0
  v_mfma_f32_32x32x16_bf16 v[64:79], a[128:131], v[24:27], v[64:79]
  s_add_u32 s19, s19, s26
  ds_read_b128 v[48:51], v14 offset:16384
  v_mfma_f32_32x32x16_bf16 v[80:95], a[132:135], v[24:27], v[80:95]
  s_waitcnt lgkmcnt(5)
  s_add_u32 s25, s25, 32768
  v_mfma_f32_32x32x16_bf16 v[64:79], a[136:139], v[28:31], v[64:79]
  s_and_b32 s25, s25, 0x1ffff
  ds_read_b128 v[52:55], v15 offset:16384
  v_mfma_f32_32x32x16_bf16 v[80:95], a[140:143], v[28:31], v[80:95]
  s_waitcnt lgkmcnt(5)
  buffer_store_dwordx4 v[128:131], v7, s[4:7], s21 offen offset:0 sc1
  v_mfma_f32_32x32x16_bf16 v[64:79], a[144:147], v[32:35], v[64:79]
  ds_read_b128 v[24:27], v8 offset:24576
  v_mfma_f32_32x32x16_bf16 v[80:95], a[148:151], v[32:35], v[80:95]
  s_waitcnt lgkmcnt(5)
  v_mfma_f32_32x32x16_bf16 v[64:79], a[152:155], v[36:39], v[64:79]
  ds_read_b128 v[28:31], v9 offset:24576
  v_mfma_f32_32x32x16_bf16 v[80:95], a[156:159], v[36:39], v[80:95]
  s_waitcnt lgkmcnt(5)
  buffer_store_dwordx4 v[132:135], v7, s[4:7], s21 offen offset:1024 sc1
  v_mfma_f32_32x32x16_bf16 v[64:79], a[160:163], v[40:43], v[64:79]
  ds_read_b128 v[32:35], v10 offset:24576
  v_mfma_f32_32x32x16_bf16 v[80:95], a[164:167], v[40:43], v[80:95]
  s_waitcnt lgkmcnt(5)
  v_mfma_f32_32x32x16_bf16 v[64:79], a[168:171], v[44:47], v[64:79]
  ds_read_b128 v[36:39], v11 offset:24576
  v_mfma_f32_32x32x16_bf16 v[80:95], a[172:175], v[44:47], v[80:95]
  s_waitcnt lgkmcnt(5)
  buffer_store_dwordx4 v[136:139], v7, s[4:7], s21 offen offset:2048 sc1
  v_mfma_f32_32x32x16_bf16 v[64:79], a[176:179], v[48:51], v[64:79]
  ds_read_b128 v[40:43], v12 offset:24576
  v_mfma_f32_32x32x16_bf16 v[80:95], a[180:183], v[48:51], v[80:95]
  s_waitcnt lgkmcnt(5)
  v_mfma_f32_32x32x16_bf16 v[64:79], a[184:187], v[52:55], v[64:79]
  ds_read_b128 v[44:47], v13 offset:24576
  v_mfma_f32_32x32x16_bf16 v[80:95], a[188:191], v[52:55], v[80:95]
  s_waitcnt lgkmcnt(5)
  buffer_store_dwordx4 v[140:143], v7, s[4:7], s21 offen offset:3072 sc1
  v_mfma_f32_32x32x16_bf16 v[64:79], a[192:195], v[24:27], v[64:79]
  s_mov_b32 s21, s27
  ds_read_b128 v[48:51], v14 offset:24576
  v_mov_b32 v7, v2
  v_mfma_f32_32x32x16_bf16 v[80:95], a[196:199], v[24:27], v[80:95]
  s_waitcnt lgkmcnt(5)
  v_mfma_f32_32x32x16_bf16 v[64:79], a[200:203], v[28:31], v[64:79]
  s_add_u32 s27, s27, s22
  ds_read_b128 v[52:55], v15 offset:24576
  v_mfma_f32_32x32x16_bf16 v[80:95], a[204:207], v[28:31], v[80:95]
  s_waitcnt lgkmcnt(5)
  s_waitcnt vmcnt(16)
  s_barrier
  v_mfma_f32_32x32x16_bf16 v[64:79], a[208:211], v[32:35], v[64:79]
  ds_read_b128 v[24:27], v8 offset:32768
  v_mfma_f32_32x32x16_bf16 v[80:95], a[212:215], v[32:35], v[80:95]
  s_waitcnt lgkmcnt(5)
  v_mfma_f32_32x32x16_bf16 v[64:79], a[216:219], v[36:39], v[64:79]
  ds_read_b128 v[28:31], v9 offset:32768
  v_mfma_f32_32x32x16_bf16 v[80:95], a[220:223], v[36:39], v[80:95]
  s_waitcnt lgkmcnt(5)
  v_mfma_f32_32x32x16_bf16 v[64:79], a[224:227], v[40:43], v[64:79]
  ds_read_b128 v[32:35], v10 offset:32768
  v_mfma_f32_32x32x16_bf16 v[80:95], a[228:231], v[40:43], v[80:95]
  s_waitcnt lgkmcnt(5)
  v_mfma_f32_32x32x16_bf16 v[64:79], a[232:235], v[44:47], v[64:79]
  ds_read_b128 v[36:39], v11 offset:32768
  v_mfma_f32_32x32x16_bf16 v[80:95], a[236:239], v[44:47], v[80:95]
  s_waitcnt lgkmcnt(5)
  v_mfma_f32_32x32x16_bf16 v[64:79], a[240:243], v[48:51], v[64:79]
  s_sub_u32 s23, s23, 1
  ds_read_b128 v[40:43], v12 offset:32768
  v_mfma_f32_32x32x16_bf16 v[80:95], a[244:247], v[48:51], v[80:95]
  s_waitcnt lgkmcnt(5)
  v_mfma_f32_32x32x16_bf16 v[64:79], a[248:251], v[52:55], v[64:79]
  s_cmp_eq_u32 s23, 0
  ds_read_b128 v[44:47], v13 offset:32768
  v_mfma_f32_32x32x16_bf16 v[80:95], a[252:255], v[52:55], v[80:95]
  s_cbranch_scc1 G_done0_46
  s_waitcnt lgkmcnt(5)
  v_mfma_f32_32x32x16_bf16 v[96:111], a[0:3], v[24:27], 0
  s_add_u32 m0, s25, 0
  ds_read_b128 v[48:51], v14 offset:32768
  v_mfma_f32_32x32x16_bf16 v[112:127], a[4:7], v[24:27], 0
  s_waitcnt lgkmcnt(5)
  buffer_load_dwordx4 v16, s[12:15], s19 offen sc1 lds
  v_mfma_f32_32x32x16_bf16 v[96:111], a[8:11], v[28:31], v[96:111]
  ds_read_b128 v[52:55], v15 offset:32768
  v_mul_f32 v64, s24, v64
  v_mul_f32 v65, s24, v65
  v_mfma_f32_32x32x16_bf16 v[112:127], a[12:15], v[28:31], v[112:127]
  s_waitcnt lgkmcnt(5)
  v_cvt_pk_bf16_f32 v128, v64, v65
  v_mul_f32 v66, s24, v66
  v_mfma_f32_32x32x16_bf16 v[96:111], a[16:19], v[32:35], v[96:111]
  s_add_u32 m0, s25, 1024
  ds_read_b128 v[24:27], v8 offset:40960
  v_mul_f32 v67, s24, v67
  v_cvt_pk_bf16_f32 v129, v66, v67
  v_mfma_f32_32x32x16_bf16 v[112:127], a[20:23], v[32:35], v[112:127]
  s_waitcnt lgkmcnt(5)
  buffer_load_dwordx4 v17, s[12:15], s19 offen sc1 lds
  v_mul_f32 v68, s24, v68
  v_mul_f32 v69, s24, v69
  v_mfma_f32_32x32x16_bf16 v[96:111], a[24:27], v[36:39], v[96:111]
  ds_read_b128 v[28:31], v9 offset:40960
  v_cvt_pk_bf16_f32 v130, v68, v69
  v_mul_f32 v70, s24, v70
  v_mfma_f32_32x32x16_bf16 v[112:127], a[28:31], v[36:39], v[112:127]
  s_waitcnt lgkmcnt(5)
  v_mul_f32 v71, s24, v71
  v_cvt_pk_bf16_f32 v131, v70, v71
  v_mfma_f32_32x32x16_bf16 v[96:111], a[32:35], v[40:43], v[96:111]
  s_add_u32 m0, s25, 2048
  ds_read_b128 v[32:35], v10 offset:40960
  v_mul_f32 v72, s24, v72
  v_mul_f32 v73, s24, v73
  v_mfma_f32_32x32x16_bf16 v[112:127], a[36:39], v[40:43], v[112:127]
  s_waitcnt lgkmcnt(5)
  buffer_load_dwordx4 v18, s[12:15], s19 offen sc1 lds
  v_cvt_pk_bf16_f32 v132, v72, v73
  v_mul_f32 v74, s24, v74
  v_mfma_f32_32x32x16_bf16 v[96:111], a[40:43], v[44:47], v[96:111]
  ds_read_b128 v[36:39], v11 offset:40960
  v_mul_f32 v75, s24, v75
  v_cvt_pk_bf16_f32 v133, v74, v75
  v_mfma_f32_32x32x16_bf16 v[112:127], a[44:47], v[44:47], v[112:127]
  s_waitcnt lgkmcnt(5)
  v_mul_f32 v76, s24, v76
  v_mul_f32 v77, s24, v77
  v_mfma_f32_32x32x16_bf16 v[96:111], a[48:51], v[48:51], v[96:111]
  s_add_u32 m0, s25, 3072
  ds_read_b128 v[40:43], v12 offset:40960
  v_cvt_pk_bf16_f32 v134, v76, v77
  v_mul_f32 v78, s24, v78
  v_mfma_f32_32x32x16_bf16 v[112:127], a[52:55], v[48:51], v[112:127]
  s_waitcnt lgkmcnt(5)
  buffer_load_dwordx4 v19, s[12:15], s19 offen sc1 lds
  v_mul_f32 v79, s24, v79
  v_cvt_pk_bf16_f32 v135, v78, v79
  v_mfma_f32_32x32x16_bf16 v[96:111], a[56:59], v[52:55], v[96:111]
  ds_read_b128 v[44:47], v13 offset:40960
  v_mul_f32 v80, s24, v80
  v_mul_f32 v81, s24, v81
  v_mfma_f32_32x32x16_bf16 v[112:127], a[60:63], v[52:55], v[112:127]
  s_waitcnt lgkmcnt(5)
  v_cvt_pk_bf16_f32 v136, v80, v81
  v_mul_f32 v82, s24, v82
  v_mfma_f32_32x32x16_bf16 v[96:111], a[64:67], v[24:27], v[96:111]
  s_add_u32 m0, s25, 4096
  ds_read_b128 v[48:51], v14 offset:40960
  v_mul_f32 v83, s24, v83
  v_cvt_pk_bf16_f32 v137, v82, v83
  v_mfma_f32_32x32x16_bf16 v[112:127], a[68:71], v[24:27], v[112:127]
  s_waitcnt lgkmcnt(5)
  buffer_load_dwordx4 v20, s[12:15], s19 offen sc1 lds
  v_mul_f32 v84, s24, v84
  v_mul_f32 v85, s24, v85
  v_mfma_f32_32x32x16_bf16 v[96:111], a[72:75], v[28:31], v[96:111]
  ds_read_b128 v[52:55], v15 offset:40960
  v_cvt_pk_bf16_f32 v138, v84, v85
  v_mul_f32 v86, s24, v86
  v_mfma_f32_32x32x16_bf16 v[112:127], a[76:79], v[28:31], v[112:127]
  s_waitcnt lgkmcnt(5)
  v_mul_f32 v87, s24, v87
  v_cvt_pk_bf16_f32 v139, v86, v87
  v_mfma_f32_32x32x16_bf16 v[96:111], a[80:83], v[32:35], v[96:111]
  s_add_u32 m0, s25, 5120
  ds_read_b128 v[24:27], v8 offset:49152
  v_mul_f32 v88, s24, v88
  v_mul_f32 v89, s24, v89
  v_mfma_f32_32x32x16_bf16 v[112:127], a[84:87], v[32:35], v[112:127]
  s_waitcnt lgkmcnt(5)
  buffer_load_dwordx4 v21, s[12:15], s19 offen sc1 lds
  v_cvt_pk_bf16_f32 v140, v88, v89
  v_mul_f32 v90, s24, v90
  v_mfma_f32_32x32x16_bf16 v[96:111], a[88:91], v[36:39], v[96:111]
  ds_read_b128 v[28:31], v9 offset:49152
  v_mul_f32 v91, s24, v91
  v_cvt_pk_bf16_f32 v141, v90, v91
  v_mfma_f32_32x32x16_bf16 v[112:127], a[92:95], v[36:39], v[112:127]
  s_waitcnt lgkmcnt(5)
  v_mul_f32 v92, s24, v92
  v_mul_f32 v93, s24, v93
  v_mfma_f32_32x32x16_bf16 v[96:111], a[96:99], v[40:43], v[96:111]
  s_add_u32 m0, s25, 6144
  ds_read_b128 v[32:35], v10 offset:49152
  v_cvt_pk_bf16_f32 v142, v92, v93
  v_mul_f32 v94, s24, v94
  v_mfma_f32_32x32x16_bf16 v[112:127], a[100:103], v[40:43], v[112:127]
  s_waitcnt lgkmcnt(5)
  buffer_load_dwordx4 v22, s[12:15], s19 offen sc1 lds
  v_mul_f32 v95, s24, v95
  v_cvt_pk_bf16_f32 v143, v94, v95
  v_mfma_f32_32x32x16_bf16 v[96:111], a[104:107], v[44:47], v[96:111]
  ds_read_b128 v[36:39], v11 offset:49152
  v_mfma_f32_32x32x16_bf16 v[112:127], a[108:111], v[44:47], v[112:127]
  s_waitcnt lgkmcnt(5)
  v_mfma_f32_32x32x16_bf16 v[96:111], a[112:115], v[48:51], v[96:111]
  s_add_u32 m0, s25, 7168
  ds_read_b128 v[40:43], v12 offset:49152
  v_mfma_f32_32x32x16_bf16 v[112:127], a[116:119], v[48:51], v[112:127]
  s_waitcnt lgkmcnt(5)
  buffer_load_dwordx4 v23, s[12:15], s19 offen sc1 lds
  v_mfma_f32_32x32x16_bf16 v[96:111], a[120:123], v[52:55], v[96:111]
  s_cmp_gt_u32 s23, 3
  ds_read_b128 v[44:47], v13 offset:49152
  v_mfma_f32_32x32x16_bf16 v[112:127], a[124:127], v[52:55], v[112:127]
  s_waitcnt lgkmcnt(5)
  s_cselect_b32 s26, s20, 0
  v_mfma_f32_32x32x16_bf16 v[96:111], a[128:131], v[24:27], v[96:111]
  s_add_u32 s19, s19, s26
  ds_read_b128 v[48:51], v14 offset:49152
  v_mfma_f32_32x32x16_bf16 v[112:127], a[132:135], v[24:27], v[112:127]
  s_waitcnt lgkmcnt(5)
  s_add_u32 s25, s25, 32768
  v_mfma_f32_32x32x16_bf16 v[96:111], a[136:139], v[28:31], v[96:111]
  s_and_b32 s25, s25, 0x1ffff
  ds_read_b128 v[52:55], v15 offset:49152
  v_mfma_f32_32x32x16_bf16 v[112:127], a[140:143], v[28:31], v[112:127]
  s_waitcnt lgkmcnt(5)
  buffer_store_dwordx4 v[128:131], v7, s[4:7], s21 offen offset:0 sc1
  v_mfma_f32_32x32x16_bf16 v[96:111], a[144:147], v[32:35], v[96:111]
  ds_read_b128 v[24:27], v8 offset:57344
  v_mfma_f32_32x32x16_bf16 v[112:127], a[148:151], v[32:35], v[112:127]
  s_waitcnt lgkmcnt(5)
  v_xor_b32 v8, 0x10000, v8
  v_mfma_f32_32x32x16_bf16 v[96:111], a[152:155], v[36:39], v[96:111]
  ds_read_b128 v[28:31], v9 offset:57344
  v_mfma_f32_32x32x16_bf16 v[112:127], a[156:159], v[36:39], v[112:127]
  s_waitcnt lgkmcnt(5)
  buffer_store_dwordx4 v[132:135], v7, s[4:7], s21 offen offset:1024 sc1
  v_xor_b32 v9, 0x10000, v9
  v_mfma_f32_32x32x16_bf16 v[96:111], a[160:163], v[40:43], v[96:111]
  ds_read_b128 v[32:35], v10 offset:57344
  v_mfma_f32_32x32x16_bf16 v[112:127], a[164:167], v[40:43], v[112:127]
  s_waitcnt lgkmcnt(5)
  v_xor_b32 v10, 0x10000, v10
  v_mfma_f32_32x32x16_bf16 v[96:111], a[168:171], v[44:47], v[96:111]
  ds_read_b128 v[36:39], v11 offset:57344
  v_mfma_f32_32x32x16_bf16 v[112:127], a[172:175], v[44:47], v[112:127]
  s_waitcnt lgkmcnt(5)
  buffer_store_dwordx4 v[136:139], v7, s[4:7], s21 offen offset:2048 sc1
  v_xor_b32 v11, 0x10000, v11
  v_mfma_f32_32x32x16_bf16 v[96:111], a[176:179], v[48:51], v[96:111]
  ds_read_b128 v[40:43], v12 offset:57344
  v_mfma_f32_32x32x16_bf16 v[112:127], a[180:183], v[48:51], v[112:127]
  s_waitcnt lgkmcnt(5)
  v_xor_b32 v12, 0x10000, v12
  v_mfma_f32_32x32x16_bf16 v[96:111], a[184:187], v[52:55], v[96:111]
  ds_read_b128 v[44:47], v13 offset:57344
  v_mfma_f32_32x32x16_bf16 v[112:127], a[188:191], v[52:55], v[112:127]
  s_waitcnt lgkmcnt(5)
  buffer_store_dwordx4 v[140:143], v7, s[4:7], s21 offen offset:3072 sc1
  v_xor_b32 v13, 0x10000, v13
  v_mfma_f32_32x32x16_bf16 v[96:111], a[192:195], v[24:27], v[96:111]
  s_mov_b32 s21, s27
  ds_read_b128 v[48:51], v14 offset:57344
  v_mov_b32 v7, v2
  v_mfma_f32_32x32x16_bf16 v[112:127], a[196:199], v[24:27], v[112:127]
  s_waitcnt lgkmcnt(5)
  v_xor_b32 v14, 0x10000, v14
  v_mfma_f32_32x32x16_bf16 v[96:111], a[200:203], v[28:31], v[96:111]
  s_add_u32 s27, s27, s22
  ds_read_b128 v[52:55], v15 offset:57344
  v_mfma_f32_32x32x16_bf16 v[112:127], a[204:207], v[28:31], v[112:127]
  s_waitcnt lgkmcnt(5)
  s_waitcnt vmcnt(16)
  s_barrier
  v_xor_b32 v15, 0x10000, v15
  v_mfma_f32_32x32x16_bf16 v[96:111], a[208:211], v[32:35], v[96:111]
  ds_read_b128 v[24:27], v8 offset:0
  v_mfma_f32_32x32x16_bf16 v[112:127], a[212:215], v[32:35], v[112:127]
  s_waitcnt lgkmcnt(5)
  v_mfma_f32_32x32x16_bf16 v[96:111], a[216:219], v[36:39], v[96:111]
  ds_read_b128 v[28:31], v9 offset:0
  v_mfma_f32_32x32x16_bf16 v[112:127], a[220:223], v[36:39], v[112:127]
  s_waitcnt lgkmcnt(5)
  v_mfma_f32_32x32x16_bf16 v[96:111], a[224:227], v[40:43], v[96:111]
  ds_read_b128 v[32:35], v10 offset:0
  v_mfma_f32_32x32x16_bf16 v[112:127], a[228:231], v[40:43], v[112:127]
  s_waitcnt lgkmcnt(5)
  v_mfma_f32_32x32x16_bf16 v[96:111], a[232:235], v[44:47], v[96:111]
  ds_read_b128 v[36:39], v11 offset:0
  v_mfma_f32_32x32x16_bf16 v[112:127], a[236:239], v[44:47], v[112:127]
  s_waitcnt lgkmcnt(5)
  v_mfma_f32_32x32x16_bf16 v[96:111], a[240:243], v[48:51], v[96:111]
  s_sub_u32 s23, s23, 1
  ds_read_b128 v[40:43], v12 offset:0
  v_mfma_f32_32x32x16_bf16 v[112:127], a[244:247], v[48:51], v[112:127]
  s_waitcnt lgkmcnt(5)
  v_mfma_f32_32x32x16_bf16 v[96:111], a[248:251], v[52:55], v[96:111]
  s_cmp_eq_u32 s23, 0
  ds_read_b128 v[44:47], v13 offset:0
  v_mfma_f32_32x32x16_bf16 v[112:127], a[252:255], v[52:55], v[112:127]
  s_cbranch_scc1 G_done1_47
  s_branch G_top_45
G_done0_46:
  s_nop 7
  s_nop 3
  v_mul_f32 v64, s24, v64
  v_mul_f32 v65, s24, v65
  v_cvt_pk_bf16_f32 v128, v64, v65
  v_mul_f32 v66, s24, v66
  v_mul_f32 v67, s24, v67
  v_cvt_pk_bf16_f32 v129, v66, v67
  v_mul_f32 v68, s24, v68
  v_mul_f32 v69, s24, v69
  v_cvt_pk_bf16_f32 v130, v68, v69
  v_mul_f32 v70, s24, v70
  v_mul_f32 v71, s24, v71
  v_cvt_pk_bf16_f32 v131, v70, v71
  buffer_store_dwordx4 v[128:131], v7, s[4:7], s21 offen offset:0 sc1
  v_mul_f32 v72, s24, v72
  v_mul_f32 v73, s24, v73
  v_cvt_pk_bf16_f32 v132, v72, v73
  v_mul_f32 v74, s24, v74
  v_mul_f32 v75, s24, v75
  v_cvt_pk_bf16_f32 v133, v74, v75
  v_mul_f32 v76, s24, v76
  v_mul_f32 v77, s24, v77
  v_cvt_pk_bf16_f32 v134, v76, v77
  v_mul_f32 v78, s24, v78
  v_mul_f32 v79, s24, v79
  v_cvt_pk_bf16_f32 v135, v78, v79
  buffer_store_dwordx4 v[132:135], v7, s[4:7], s21 offen offset:1024 sc1
  v_mul_f32 v80, s24, v80
  v_mul_f32 v81, s24, v81
  v_cvt_pk_bf16_f32 v136, v80, v81
  v_mul_f32 v82, s24, v82
  v_mul_f32 v83, s24, v83
  v_cvt_pk_bf16_f32 v137, v82, v83
  v_mul_f32 v84, s24, v84
  v_mul_f32 v85, s24, v85
  v_cvt_pk_bf16_f32 v138, v84, v85
  v_mul_f32 v86, s24, v86
  v_mul_f32 v87, s24, v87
  v_cvt_pk_bf16_f32 v139, v86, v87
  buffer_store_dwordx4 v[136:139], v7, s[4:7], s21 offen offset:2048 sc1
  v_mul_f32 v88, s24, v88
  v_mul_f32 v89, s24, v89
  v_cvt_pk_bf16_f32 v140, v88, v89
  v_mul_f32 v90, s24, v90
  v_mul_f32 v91, s24, v91
  v_cvt_pk_bf16_f32 v141, v90, v91
  v_mul_f32 v92, s24, v92
  v_mul_f32 v93, s24, v93
  v_cvt_pk_bf16_f32 v142, v92, v93
  v_mul_f32 v94, s24, v94
  v_mul_f32 v95, s24, v95
  v_cvt_pk_bf16_f32 v143, v94, v95
  buffer_store_dwordx4 v[140:143], v7, s[4:7], s21 offen offset:3072 sc1
  s_branch G_fin_48
G_done1_47:
  s_nop 7
  s_nop 3
  v_mul_f32 v96, s24, v96
  v_mul_f32 v97, s24, v97
  v_cvt_pk_bf16_f32 v128, v96, v97
  v_mul_f32 v98, s24, v98
  v_mul_f32 v99, s24, v99
  v_cvt_pk_bf16_f32 v129, v98, v99
  v_mul_f32 v100, s24, v100
  v_mul_f32 v101, s24, v101
  v_cvt_pk_bf16_f32 v130, v100, v101
  v_mul_f32 v102, s24, v102
  v_mul_f32 v103, s24, v103
  v_cvt_pk_bf16_f32 v131, v102, v103
  buffer_store_dwordx4 v[128:131], v7, s[4:7], s21 offen offset:0 sc1
  v_mul_f32 v104, s24, v104
  v_mul_f32 v105, s24, v105
  v_cvt_pk_bf16_f32 v132, v104, v105
  v_mul_f32 v106, s24, v106
  v_mul_f32 v107, s24, v107
  v_cvt_pk_bf16_f32 v133, v106, v107
  v_mul_f32 v108, s24, v108
  v_mul_f32 v109, s24, v109
  v_cvt_pk_bf16_f32 v134, v108, v109
  v_mul_f32 v110, s24, v110
  v_mul_f32 v111, s24, v111
  v_cvt_pk_bf16_f32 v135, v110, v111
  buffer_store_dwordx4 v[132:135], v7, s[4:7], s21 offen offset:1024 sc1
  v_mul_f32 v112, s24, v112
  v_mul_f32 v113, s24, v113
  v_cvt_pk_bf16_f32 v136, v112, v113
  v_mul_f32 v114, s24, v114
  v_mul_f32 v115, s24, v115
  v_cvt_pk_bf16_f32 v137, v114, v115
  v_mul_f32 v116, s24, v116
  v_mul_f32 v117, s24, v117
  v_cvt_pk_bf16_f32 v138, v116, v117
  v_mul_f32 v118, s24, v118
  v_mul_f32 v119, s24, v119
  v_cvt_pk_bf16_f32 v139, v118, v119
  buffer_store_dwordx4 v[136:139], v7, s[4:7], s21 offen offset:2048 sc1
  v_mul_f32 v120, s24, v120
  v_mul_f32 v121, s24, v121
  v_cvt_pk_bf16_f32 v140, v120, v121
  v_mul_f32 v122, s24, v122
  v_mul_f32 v123, s24, v123
  v_cvt_pk_bf16_f32 v141, v122, v123
  v_mul_f32 v124, s24, v124
  v_mul_f32 v125, s24, v125
  v_cvt_pk_bf16_f32 v142, v124, v125
  v_mul_f32 v126, s24, v126
  v_mul_f32 v127, s24, v127
  v_cvt_pk_bf16_f32 v143, v126, v127
  buffer_store_dwordx4 v[140:143], v7, s[4:7], s21 offen offset:3072 sc1
G_fin_48:
  s_waitcnt vmcnt(0) lgkmcnt(0)
  s_barrier
  s_waitcnt vmcnt(0)
  s_barrier
  s_mov_b32 s30, 768
  v_mov_b32 v144, s30
  v_min_u32 v145, 1, v0
  v_lshlrev_b32 v145, 30, v145
  buffer_store_dword v144, v145, s[4:7], s31 offen sc1
  s_mul_i32 s50, s64, 6
  s_add_u32 s50, s50, s65
  s_mul_i32 s76, s50, 21846
  s_lshr_b32 s76, s76, 16
  s_mul_i32 s77, s76, 3
  s_add_u32 s51, s50, 64
  s_cmp_eq_u32 s77, s50
  s_cselect_b32 s50, s76, s51
M_fin:
  s_lshr_b32 s48, s50, 2
  s_and_b32 s49, s50, 3
  s_load_dwordx2 s[8:9], s[0:1], 0
  s_load_dwordx2 s[12:13], s[0:1], 104
  s_load_dwordx2 s[32:33], s[0:1], 112
  v_and_b32 v4, 31, v1
  v_lshrrev_b32 v5, 5, v1
  v_lshlrev_b32 v5, 4, v5
  v_lshl_add_u32 v6, v4, 10, v5
  s_lshl_b32 s26, s16, 8
  s_lshl_b32 s27, s48, 15
  s_add_u32 s27, s27, s26
  s_waitcnt lgkmcnt(0)
  s_and_b32 s9, s9, 0xffff
  s_mov_b32 s10, 2097152
  s_mov_b32 s11, 0x20000
  s_and_b32 s13, s13, 0xffff
  s_mov_b32 s14, 1024
  s_mov_b32 s15, 0x20000
  s_and_b32 s33, s33, 0xffff
  s_mov_b32 s34, 2097152
  s_mov_b32 s35, 0x20000
  buffer_load_dwordx4 v[16:19], v6, s[8:11], s27 offen offset:0
  buffer_load_dwordx4 v[48:51], v5, s[12:15], s26 offen offset:0
  buffer_load_dwordx4 v[20:23], v6, s[8:11], s27 offen offset:32
  buffer_load_dwordx4 v[52:55], v5, s[12:15], s26 offen offset:32
  buffer_load_dwordx4 v[24:27], v6, s[8:11], s27 offen offset:64
  buffer_load_dwordx4 v[56:59], v5, s[12:15], s26 offen offset:64
  buffer_load_dwordx4 v[28:31], v6, s[8:11], s27 offen offset:96
  buffer_load_dwordx4 v[60:63], v5, s[12:15], s26 offen offset:96
  buffer_load_dwordx4 v[32:35], v6, s[8:11], s27 offen offset:128
  buffer_load_dwordx4 v[64:67], v5, s[12:15], s26 offen offset:128
  buffer_load_dwordx4 v[36:39], v6, s[8:11], s27 offen offset:160
  buffer_load_dwordx4 v[68:71], v5, s[12:15], s26 offen offset:160
  buffer_load_dwordx4 v[40:43], v6, s[8:11], s27 offen offset:192
  buffer_load_dwordx4 v[72:75], v5, s[12:15], s26 offen offset:192
  buffer_load_dwordx4 v[44:47], v6, s[8:11], s27 offen offset:224
  buffer_load_dwordx4 v[76:79], v5, s[12:15], s26 offen offset:224
  s_lshl_b32 s28, s48, 2
  s_add_u32 s28, s28, s49
  s_lshl_b32 s28, s28, 2
  s_add_u32 s28, s28, s16
  s_lshl_b32 s28, s28, 11
  s_waitcnt vmcnt(14)
  v_mfma_f32_32x32x16_bf16 v[80:95], v[48:51], v[16:19], 0
  s_waitcnt vmcnt(12)
  v_mfma_f32_32x32x16_bf16 v[80:95], v[52:55], v[20:23], v[80:95]
  s_waitcnt vmcnt(10)
  v_mfma_f32_32x32x16_bf16 v[80:95], v[56:59], v[24:27], v[80:95]
  s_waitcnt vmcnt(8)
  v_mfma_f32_32x32x16_bf16 v[80:95], v[60:63], v[28:31], v[80:95]
  s_waitcnt vmcnt(6)
  v_mfma_f32_32x32x16_bf16 v[80:95], v[64:67], v[32:35], v[80:95]
  s_waitcnt vmcnt(4)
  v_mfma_f32_32x32x16_bf16 v[80:95], v[68:71], v[36:39], v[80:95]
  s_waitcnt vmcnt(2)
  v_mfma_f32_32x32x16_bf16 v[80:95], v[72:75], v[40:43], v[80:95]
  s_waitcnt vmcnt(0)
  v_mfma_f32_32x32x16_bf16 v[80:95], v[76:79], v[44:47], v[80:95]
  s_mul_i32 s76, s48, 43
  s_lshr_b32 s76, s76, 9
  s_mul_i32 s76, s76, 12
  s_sub_u32 s76, s48, s76
  s_cmp_ge_u32 s76, 6
  s_addc_u32 s76, s76, 0
  s_and_b32 s77, s49, 2
  s_mul_i32 s77, s77, 7
  s_add_u32 s76, s76, s77
  v_mov_b32 v193, 0x300
  s_lshl_b32 s76, s76, 7
  s_add_u32 s76, s76, 148897792
  v_and_b32 v192, 7, v1
  v_mul_u32_u24 v192, 3584, v192
  v_add_u32 v192, s76, v192
  s_mov_b32 s71, 0
  s_branch M_vg_50
M_vw_49:
  s_sleep 2
  s_add_u32 s71, s71, 1
  s_cmp_gt_u32 s71, 262144
  s_cbranch_scc1 M_exit
M_vg_50:
  buffer_load_dword v194, v192, s[4:7], 0 offen sc1
  s_waitcnt vmcnt(0)
  v_cmp_lt_u32 vcc, v194, v193
  s_cbranch_vccnz M_vw_49
  s_add_u32 s29, s28, 150994944
  buffer_load_dwordx4 v[96:99], v2, s[4:7], s29 offen offset:0 sc1
  buffer_load_dwordx4 v[100:103], v2, s[4:7], s29 offen offset:1024 sc1
  s_add_u32 s29, s28, 153092096
  buffer_load_dwordx4 v[104:107], v2, s[4:7], s29 offen offset:0 sc1
  buffer_load_dwordx4 v[108:111], v2, s[4:7], s29 offen offset:1024 sc1
  s_add_u32 s29, s28, 155189248
  buffer_load_dwordx4 v[112:115], v2, s[4:7], s29 offen offset:0 sc1
  buffer_load_dwordx4 v[116:119], v2, s[4:7], s29 offen offset:1024 sc1
  s_add_u32 s29, s28, 157286400
  buffer_load_dwordx4 v[120:123], v2, s[4:7], s29 offen offset:0 sc1
  buffer_load_dwordx4 v[124:127], v2, s[4:7], s29 offen offset:1024 sc1
  s_add_u32 s29, s28, 159383552
  buffer_load_dwordx4 v[128:131], v2, s[4:7], s29 offen offset:0 sc1
  buffer_load_dwordx4 v[132:135], v2, s[4:7], s29 offen offset:1024 sc1
  s_add_u32 s29, s28, 161480704
  buffer_load_dwordx4 v[136:139], v2, s[4:7], s29 offen offset:0 sc1
  buffer_load_dwordx4 v[140:143], v2, s[4:7], s29 offen offset:1024 sc1
  s_add_u32 s29, s28, 163577856
  buffer_load_dwordx4 v[144:147], v2, s[4:7], s29 offen offset:0 sc1
  buffer_load_dwordx4 v[148:151], v2, s[4:7], s29 offen offset:1024 sc1
  s_add_u32 s29, s28, 165675008
  buffer_load_dwordx4 v[152:155], v2, s[4:7], s29 offen offset:0 sc1
  buffer_load_dwordx4 v[156:159], v2, s[4:7], s29 offen offset:1024 sc1
  v_lshlrev_b32 v7, 4, v4
  s_lshl_b32 s26, s16, 2
  v_add_u32 v4, s26, v7
  s_barrier
  ds_write_b32 v4, v80
  s_waitcnt lgkmcnt(0)
  s_barrier
  ds_read_b128 v[84:87], v7
  s_waitcnt lgkmcnt(0)
  v_add_f32 v80, v84, v85
  v_add_f32 v81, v86, v87
  v_add_f32 v80, v80, v81
  v_mul_f32 v80, 0xbfb8aa3b, v80
  v_exp_f32 v80, v80
  s_nop 0
  v_add_f32 v80, 1.0, v80
  v_rcp_f32 v80, v80
  s_nop 0
  v_sub_f32 v82, 1.0, v80
  s_waitcnt vmcnt(14)
  v_lshlrev_b32 v160, 16, v96
  v_and_b32 v161, 0xffff0000, v96
  v_lshlrev_b32 v162, 16, v97
  v_and_b32 v163, 0xffff0000, v97
  v_lshlrev_b32 v164, 16, v98
  v_and_b32 v165, 0xffff0000, v98
  v_lshlrev_b32 v166, 16, v99
  v_and_b32 v167, 0xffff0000, v99
  v_lshlrev_b32 v168, 16, v100
  v_and_b32 v169, 0xffff0000, v100
  v_lshlrev_b32 v170, 16, v101
  v_and_b32 v171, 0xffff0000, v101
  v_lshlrev_b32 v172, 16, v102
  v_and_b32 v173, 0xffff0000, v102
  v_lshlrev_b32 v174, 16, v103
  v_and_b32 v175, 0xffff0000, v103
  s_waitcnt vmcnt(12)
  v_lshlrev_b32 v8, 16, v104
  v_and_b32 v9, 0xffff0000, v104
  v_pk_add_f32 v[160:161], v[160:161], v[8:9]
  v_lshlrev_b32 v10, 16, v105
  v_and_b32 v11, 0xffff0000, v105
  v_pk_add_f32 v[162:163], v[162:163], v[10:11]
  v_lshlrev_b32 v12, 16, v106
  v_and_b32 v13, 0xffff0000, v106
  v_pk_add_f32 v[164:165], v[164:165], v[12:13]
  v_lshlrev_b32 v14, 16, v107
  v_and_b32 v15, 0xffff0000, v107
  v_pk_add_f32 v[166:167], v[166:167], v[14:15]
  v_lshlrev_b32 v8, 16, v108
  v_and_b32 v9, 0xffff0000, v108
  v_pk_add_f32 v[168:169], v[168:169], v[8:9]
  v_lshlrev_b32 v10, 16, v109
  v_and_b32 v11, 0xffff0000, v109
  v_pk_add_f32 v[170:171], v[170:171], v[10:11]
  v_lshlrev_b32 v12, 16, v110
  v_and_b32 v13, 0xffff0000, v110
  v_pk_add_f32 v[172:173], v[172:173], v[12:13]
  v_lshlrev_b32 v14, 16, v111
  v_and_b32 v15, 0xffff0000, v111
  v_pk_add_f32 v[174:175], v[174:175], v[14:15]
  s_waitcnt vmcnt(10)
  v_lshlrev_b32 v8, 16, v112
  v_and_b32 v9, 0xffff0000, v112
  v_pk_add_f32 v[160:161], v[160:161], v[8:9]
  v_lshlrev_b32 v10, 16, v113
  v_and_b32 v11, 0xffff0000, v113
  v_pk_add_f32 v[162:163], v[162:163], v[10:11]
  v_lshlrev_b32 v12, 16, v114
  v_and_b32 v13, 0xffff0000, v114
  v_pk_add_f32 v[164:165], v[164:165], v[12:13]
  v_lshlrev_b32 v14, 16, v115
  v_and_b32 v15, 0xffff0000, v115
  v_pk_add_f32 v[166:167], v[166:167], v[14:15]
  v_lshlrev_b32 v8, 16, v116
  v_and_b32 v9, 0xffff0000, v116
  v_pk_add_f32 v[168:169], v[168:169], v[8:9]
  v_lshlrev_b32 v10, 16, v117
  v_and_b32 v11, 0xffff0000, v117
  v_pk_add_f32 v[170:171], v[170:171], v[10:11]
  v_lshlrev_b32 v12, 16, v118
  v_and_b32 v13, 0xffff0000, v118
  v_pk_add_f32 v[172:173], v[172:173], v[12:13]
  v_lshlrev_b32 v14, 16, v119
  v_and_b32 v15, 0xffff0000, v119
  v_pk_add_f32 v[174:175], v[174:175], v[14:15]
  s_waitcnt vmcnt(8)
  v_lshlrev_b32 v8, 16, v120
  v_and_b32 v9, 0xffff0000, v120
  v_pk_add_f32 v[160:161], v[160:161], v[8:9]
  v_lshlrev_b32 v10, 16, v121
  v_and_b32 v11, 0xffff0000, v121
  v_pk_add_f32 v[162:163], v[162:163], v[10:11]
  v_lshlrev_b32 v12, 16, v122
  v_and_b32 v13, 0xffff0000, v122
  v_pk_add_f32 v[164:165], v[164:165], v[12:13]
  v_lshlrev_b32 v14, 16, v123
  v_and_b32 v15, 0xffff0000, v123
  v_pk_add_f32 v[166:167], v[166:167], v[14:15]
  v_lshlrev_b32 v8, 16, v124
  v_and_b32 v9, 0xffff0000, v124
  v_pk_add_f32 v[168:169], v[168:169], v[8:9]
  v_lshlrev_b32 v10, 16, v125
  v_and_b32 v11, 0xffff0000, v125
  v_pk_add_f32 v[170:171], v[170:171], v[10:11]
  v_lshlrev_b32 v12, 16, v126
  v_and_b32 v13, 0xffff0000, v126
  v_pk_add_f32 v[172:173], v[172:173], v[12:13]
  v_lshlrev_b32 v14, 16, v127
  v_and_b32 v15, 0xffff0000, v127
  v_pk_add_f32 v[174:175], v[174:175], v[14:15]
  s_waitcnt vmcnt(6)
  v_lshlrev_b32 v8, 16, v128
  v_and_b32 v9, 0xffff0000, v128
  v_pk_add_f32 v[160:161], v[160:161], v[8:9]
  v_lshlrev_b32 v10, 16, v129
  v_and_b32 v11, 0xffff0000, v129
  v_pk_add_f32 v[162:163], v[162:163], v[10:11]
  v_lshlrev_b32 v12, 16, v130
  v_and_b32 v13, 0xffff0000, v130
  v_pk_add_f32 v[164:165], v[164:165], v[12:13]
  v_lshlrev_b32 v14, 16, v131
  v_and_b32 v15, 0xffff0000, v131
  v_pk_add_f32 v[166:167], v[166:167], v[14:15]
  v_lshlrev_b32 v8, 16, v132
  v_and_b32 v9, 0xffff0000, v132
  v_pk_add_f32 v[168:169], v[168:169], v[8:9]
  v_lshlrev_b32 v10, 16, v133
  v_and_b32 v11, 0xffff0000, v133
  v_pk_add_f32 v[170:171], v[170:171], v[10:11]
  v_lshlrev_b32 v12, 16, v134
  v_and_b32 v13, 0xffff0000, v134
  v_pk_add_f32 v[172:173], v[172:173], v[12:13]
  v_lshlrev_b32 v14, 16, v135
  v_and_b32 v15, 0xffff0000, v135
  v_pk_add_f32 v[174:175], v[174:175], v[14:15]
  s_waitcnt vmcnt(4)
  v_lshlrev_b32 v8, 16, v136
  v_and_b32 v9, 0xffff0000, v136
  v_pk_add_f32 v[160:161], v[160:161], v[8:9]
  v_lshlrev_b32 v10, 16, v137
  v_and_b32 v11, 0xffff0000, v137
  v_pk_add_f32 v[162:163], v[162:163], v[10:11]
  v_lshlrev_b32 v12, 16, v138
  v_and_b32 v13, 0xffff0000, v138
  v_pk_add_f32 v[164:165], v[164:165], v[12:13]
  v_lshlrev_b32 v14, 16, v139
  v_and_b32 v15, 0xffff0000, v139
  v_pk_add_f32 v[166:167], v[166:167], v[14:15]
  v_lshlrev_b32 v8, 16, v140
  v_and_b32 v9, 0xffff0000, v140
  v_pk_add_f32 v[168:169], v[168:169], v[8:9]
  v_lshlrev_b32 v10, 16, v141
  v_and_b32 v11, 0xffff0000, v141
  v_pk_add_f32 v[170:171], v[170:171], v[10:11]
  v_lshlrev_b32 v12, 16, v142
  v_and_b32 v13, 0xffff0000, v142
  v_pk_add_f32 v[172:173], v[172:173], v[12:13]
  v_lshlrev_b32 v14, 16, v143
  v_and_b32 v15, 0xffff0000, v143
  v_pk_add_f32 v[174:175], v[174:175], v[14:15]
  s_waitcnt vmcnt(2)
  v_lshlrev_b32 v8, 16, v144
  v_and_b32 v9, 0xffff0000, v144
  v_pk_add_f32 v[160:161], v[160:161], v[8:9]
  v_lshlrev_b32 v10, 16, v145
  v_and_b32 v11, 0xffff0000, v145
  v_pk_add_f32 v[162:163], v[162:163], v[10:11]
  v_lshlrev_b32 v12, 16, v146
  v_and_b32 v13, 0xffff0000, v146
  v_pk_add_f32 v[164:165], v[164:165], v[12:13]
  v_lshlrev_b32 v14, 16, v147
  v_and_b32 v15, 0xffff0000, v147
  v_pk_add_f32 v[166:167], v[166:167], v[14:15]
  v_lshlrev_b32 v8, 16, v148
  v_and_b32 v9, 0xffff0000, v148
  v_pk_add_f32 v[168:169], v[168:169], v[8:9]
  v_lshlrev_b32 v10, 16, v149
  v_and_b32 v11, 0xffff0000, v149
  v_pk_add_f32 v[170:171], v[170:171], v[10:11]
  v_lshlrev_b32 v12, 16, v150
  v_and_b32 v13, 0xffff0000, v150
  v_pk_add_f32 v[172:173], v[172:173], v[12:13]
  v_lshlrev_b32 v14, 16, v151
  v_and_b32 v15, 0xffff0000, v151
  v_pk_add_f32 v[174:175], v[174:175], v[14:15]
  s_waitcnt vmcnt(0)
  v_lshlrev_b32 v8, 16, v152
  v_and_b32 v9, 0xffff0000, v152
  v_pk_add_f32 v[160:161], v[160:161], v[8:9]
  v_lshlrev_b32 v10, 16, v153
  v_and_b32 v11, 0xffff0000, v153
  v_pk_add_f32 v[162:163], v[162:163], v[10:11]
  v_lshlrev_b32 v12, 16, v154
  v_and_b32 v13, 0xffff0000, v154
  v_pk_add_f32 v[164:165], v[164:165], v[12:13]
  v_lshlrev_b32 v14, 16, v155
  v_and_b32 v15, 0xffff0000, v155
  v_pk_add_f32 v[166:167], v[166:167], v[14:15]
  v_lshlrev_b32 v8, 16, v156
  v_and_b32 v9, 0xffff0000, v156
  v_pk_add_f32 v[168:169], v[168:169], v[8:9]
  v_lshlrev_b32 v10, 16, v157
  v_and_b32 v11, 0xffff0000, v157
  v_pk_add_f32 v[170:171], v[170:171], v[10:11]
  v_lshlrev_b32 v12, 16, v158
  v_and_b32 v13, 0xffff0000, v158
  v_pk_add_f32 v[172:173], v[172:173], v[12:13]
  v_lshlrev_b32 v14, 16, v159
  v_and_b32 v15, 0xffff0000, v159
  v_pk_add_f32 v[174:175], v[174:175], v[14:15]
  s_and_b32 s76, s48, 1
  s_lshl_b32 s76, s76, 1
  s_lshr_b32 s77, s49, 1
  s_add_u32 s76, s76, s77
  s_mul_i32 s76, s76, 7
  s_add_u32 s76, s76, 6
  s_lshr_b32 s77, s48, 1
  s_add_u32 s77, s77, 0x201
  v_mov_b32 v193, s77
  s_lshl_b32 s76, s76, 7
  s_add_u32 s76, s76, 148897792
  v_and_b32 v192, 7, v1
  v_mul_u32_u24 v192, 3584, v192
  v_add_u32 v192, s76, v192
  s_mov_b32 s71, 0
  s_branch M_vg_52
M_vw_51:
  s_sleep 2
  s_add_u32 s71, s71, 1
  s_cmp_gt_u32 s71, 262144
  s_cbranch_scc1 M_exit
M_vg_52:
  buffer_load_dword v194, v192, s[4:7], 0 offen sc1
  s_waitcnt vmcnt(0)
  v_cmp_lt_u32 vcc, v194, v193
  s_cbranch_vccnz M_vw_51
  s_add_u32 s29, s28, 167772160
  buffer_load_dwordx4 v[96:99], v2, s[4:7], s29 offen offset:0 sc1
  buffer_load_dwordx4 v[100:103], v2, s[4:7], s29 offen offset:1024 sc1
  s_add_u32 s29, s28, 169869312
  buffer_load_dwordx4 v[104:107], v2, s[4:7], s29 offen offset:0 sc1
  buffer_load_dwordx4 v[108:111], v2, s[4:7], s29 offen offset:1024 sc1
  s_add_u32 s29, s28, 171966464
  buffer_load_dwordx4 v[112:115], v2, s[4:7], s29 offen offset:0 sc1
  buffer_load_dwordx4 v[116:119], v2, s[4:7], s29 offen offset:1024 sc1
  s_add_u32 s29, s28, 174063616
  buffer_load_dwordx4 v[120:123], v2, s[4:7], s29 offen offset:0 sc1
  buffer_load_dwordx4 v[124:127], v2, s[4:7], s29 offen offset:1024 sc1
  s_add_u32 s29, s28, 176160768
  buffer_load_dwordx4 v[128:131], v2, s[4:7], s29 offen offset:0 sc1
  buffer_load_dwordx4 v[132:135], v2, s[4:7], s29 offen offset:1024 sc1
  s_add_u32 s29, s28, 178257920
  buffer_load_dwordx4 v[136:139], v2, s[4:7], s29 offen offset:0 sc1
  buffer_load_dwordx4 v[140:143], v2, s[4:7], s29 offen offset:1024 sc1
  s_add_u32 s29, s28, 180355072
  buffer_load_dwordx4 v[144:147], v2, s[4:7], s29 offen offset:0 sc1
  buffer_load_dwordx4 v[148:151], v2, s[4:7], s29 offen offset:1024 sc1
  s_add_u32 s29, s28, 182452224
  buffer_load_dwordx4 v[152:155], v2, s[4:7], s29 offen offset:0 sc1
  buffer_load_dwordx4 v[156:159], v2, s[4:7], s29 offen offset:1024 sc1
  v_pk_mul_f32 v[160:161], v[160:161], v[80:81] op_sel_hi:[1,0]
  v_pk_mul_f32 v[162:163], v[162:163], v[80:81] op_sel_hi:[1,0]
  v_pk_mul_f32 v[164:165], v[164:165], v[80:81] op_sel_hi:[1,0]
  v_pk_mul_f32 v[166:167], v[166:167], v[80:81] op_sel_hi:[1,0]
  v_pk_mul_f32 v[168:169], v[168:169], v[80:81] op_sel_hi:[1,0]
  v_pk_mul_f32 v[170:171], v[170:171], v[80:81] op_sel_hi:[1,0]
  v_pk_mul_f32 v[172:173], v[172:173], v[80:81] op_sel_hi:[1,0]
  v_pk_mul_f32 v[174:175], v[174:175], v[80:81] op_sel_hi:[1,0]
  s_waitcnt vmcnt(14)
  v_lshlrev_b32 v176, 16, v96
  v_and_b32 v177, 0xffff0000, v96
  v_lshlrev_b32 v178, 16, v97
  v_and_b32 v179, 0xffff0000, v97
  v_lshlrev_b32 v180, 16, v98
  v_and_b32 v181, 0xffff0000, v98
  v_lshlrev_b32 v182, 16, v99
  v_and_b32 v183, 0xffff0000, v99
  v_lshlrev_b32 v184, 16, v100
  v_and_b32 v185, 0xffff0000, v100
  v_lshlrev_b32 v186, 16, v101
  v_and_b32 v187, 0xffff0000, v101
  v_lshlrev_b32 v188, 16, v102
  v_and_b32 v189, 0xffff0000, v102
  v_lshlrev_b32 v190, 16, v103
  v_and_b32 v191, 0xffff0000, v103
  s_waitcnt vmcnt(12)
  v_lshlrev_b32 v8, 16, v104
  v_and_b32 v9, 0xffff0000, v104
  v_pk_add_f32 v[176:177], v[176:177], v[8:9]
  v_lshlrev_b32 v10, 16, v105
  v_and_b32 v11, 0xffff0000, v105
  v_pk_add_f32 v[178:179], v[178:179], v[10:11]
  v_lshlrev_b32 v12, 16, v106
  v_and_b32 v13, 0xffff0000, v106
  v_pk_add_f32 v[180:181], v[180:181], v[12:13]
  v_lshlrev_b32 v14, 16, v107
  v_and_b32 v15, 0xffff0000, v107
  v_pk_add_f32 v[182:183], v[182:183], v[14:15]
  v_lshlrev_b32 v8, 16, v108
  v_and_b32 v9, 0xffff0000, v108
  v_pk_add_f32 v[184:185], v[184:185], v[8:9]
  v_lshlrev_b32 v10, 16, v109
  v_and_b32 v11, 0xffff0000, v109
  v_pk_add_f32 v[186:187], v[186:187], v[10:11]
  v_lshlrev_b32 v12, 16, v110
  v_and_b32 v13, 0xffff0000, v110
  v_pk_add_f32 v[188:189], v[188:189], v[12:13]
  v_lshlrev_b32 v14, 16, v111
  v_and_b32 v15, 0xffff0000, v111
  v_pk_add_f32 v[190:191], v[190:191], v[14:15]
  s_waitcnt vmcnt(10)
  v_lshlrev_b32 v8, 16, v112
  v_and_b32 v9, 0xffff0000, v112
  v_pk_add_f32 v[176:177], v[176:177], v[8:9]
  v_lshlrev_b32 v10, 16, v113
  v_and_b32 v11, 0xffff0000, v113
  v_pk_add_f32 v[178:179], v[178:179], v[10:11]
  v_lshlrev_b32 v12, 16, v114
  v_and_b32 v13, 0xffff0000, v114
  v_pk_add_f32 v[180:181], v[180:181], v[12:13]
  v_lshlrev_b32 v14, 16, v115
  v_and_b32 v15, 0xffff0000, v115
  v_pk_add_f32 v[182:183], v[182:183], v[14:15]
  v_lshlrev_b32 v8, 16, v116
  v_and_b32 v9, 0xffff0000, v116
  v_pk_add_f32 v[184:185], v[184:185], v[8:9]
  v_lshlrev_b32 v10, 16, v117
  v_and_b32 v11, 0xffff0000, v117
  v_pk_add_f32 v[186:187], v[186:187], v[10:11]
  v_lshlrev_b32 v12, 16, v118
  v_and_b32 v13, 0xffff0000, v118
  v_pk_add_f32 v[188:189], v[188:189], v[12:13]
  v_lshlrev_b32 v14, 16, v119
  v_and_b32 v15, 0xffff0000, v119
  v_pk_add_f32 v[190:191], v[190:191], v[14:15]
  s_waitcnt vmcnt(8)
  v_lshlrev_b32 v8, 16, v120
  v_and_b32 v9, 0xffff0000, v120
  v_pk_add_f32 v[176:177], v[176:177], v[8:9]
  v_lshlrev_b32 v10, 16, v121
  v_and_b32 v11, 0xffff0000, v121
  v_pk_add_f32 v[178:179], v[178:179], v[10:11]
  v_lshlrev_b32 v12, 16, v122
  v_and_b32 v13, 0xffff0000, v122
  v_pk_add_f32 v[180:181], v[180:181], v[12:13]
  v_lshlrev_b32 v14, 16, v123
  v_and_b32 v15, 0xffff0000, v123
  v_pk_add_f32 v[182:183], v[182:183], v[14:15]
  v_lshlrev_b32 v8, 16, v124
  v_and_b32 v9, 0xffff0000, v124
  v_pk_add_f32 v[184:185], v[184:185], v[8:9]
  v_lshlrev_b32 v10, 16, v125
  v_and_b32 v11, 0xffff0000, v125
  v_pk_add_f32 v[186:187], v[186:187], v[10:11]
  v_lshlrev_b32 v12, 16, v126
  v_and_b32 v13, 0xffff0000, v126
  v_pk_add_f32 v[188:189], v[188:189], v[12:13]
  v_lshlrev_b32 v14, 16, v127
  v_and_b32 v15, 0xffff0000, v127
  v_pk_add_f32 v[190:191], v[190:191], v[14:15]
  s_waitcnt vmcnt(6)
  v_lshlrev_b32 v8, 16, v128
  v_and_b32 v9, 0xffff0000, v128
  v_pk_add_f32 v[176:177], v[176:177], v[8:9]
  v_lshlrev_b32 v10, 16, v129
  v_and_b32 v11, 0xffff0000, v129
  v_pk_add_f32 v[178:179], v[178:179], v[10:11]
  v_lshlrev_b32 v12, 16, v130
  v_and_b32 v13, 0xffff0000, v130
  v_pk_add_f32 v[180:181], v[180:181], v[12:13]
  v_lshlrev_b32 v14, 16, v131
  v_and_b32 v15, 0xffff0000, v131
  v_pk_add_f32 v[182:183], v[182:183], v[14:15]
  v_lshlrev_b32 v8, 16, v132
  v_and_b32 v9, 0xffff0000, v132
  v_pk_add_f32 v[184:185], v[184:185], v[8:9]
  v_lshlrev_b32 v10, 16, v133
  v_and_b32 v11, 0xffff0000, v133
  v_pk_add_f32 v[186:187], v[186:187], v[10:11]
  v_lshlrev_b32 v12, 16, v134
  v_and_b32 v13, 0xffff0000, v134
  v_pk_add_f32 v[188:189], v[188:189], v[12:13]
  v_lshlrev_b32 v14, 16, v135
  v_and_b32 v15, 0xffff0000, v135
  v_pk_add_f32 v[190:191], v[190:191], v[14:15]
  s_waitcnt vmcnt(4)
  v_lshlrev_b32 v8, 16, v136
  v_and_b32 v9, 0xffff0000, v136
  v_pk_add_f32 v[176:177], v[176:177], v[8:9]
  v_lshlrev_b32 v10, 16, v137
  v_and_b32 v11, 0xffff0000, v137
  v_pk_add_f32 v[178:179], v[178:179], v[10:11]
  v_lshlrev_b32 v12, 16, v138
  v_and_b32 v13, 0xffff0000, v138
  v_pk_add_f32 v[180:181], v[180:181], v[12:13]
  v_lshlrev_b32 v14, 16, v139
  v_and_b32 v15, 0xffff0000, v139
  v_pk_add_f32 v[182:183], v[182:183], v[14:15]
  v_lshlrev_b32 v8, 16, v140
  v_and_b32 v9, 0xffff0000, v140
  v_pk_add_f32 v[184:185], v[184:185], v[8:9]
  v_lshlrev_b32 v10, 16, v141
  v_and_b32 v11, 0xffff0000, v141
  v_pk_add_f32 v[186:187], v[186:187], v[10:11]
  v_lshlrev_b32 v12, 16, v142
  v_and_b32 v13, 0xffff0000, v142
  v_pk_add_f32 v[188:189], v[188:189], v[12:13]
  v_lshlrev_b32 v14, 16, v143
  v_and_b32 v15, 0xffff0000, v143
  v_pk_add_f32 v[190:191], v[190:191], v[14:15]
  s_waitcnt vmcnt(2)
  v_lshlrev_b32 v8, 16, v144
  v_and_b32 v9, 0xffff0000, v144
  v_pk_add_f32 v[176:177], v[176:177], v[8:9]
  v_lshlrev_b32 v10, 16, v145
  v_and_b32 v11, 0xffff0000, v145
  v_pk_add_f32 v[178:179], v[178:179], v[10:11]
  v_lshlrev_b32 v12, 16, v146
  v_and_b32 v13, 0xffff0000, v146
  v_pk_add_f32 v[180:181], v[180:181], v[12:13]
  v_lshlrev_b32 v14, 16, v147
  v_and_b32 v15, 0xffff0000, v147
  v_pk_add_f32 v[182:183], v[182:183], v[14:15]
  v_lshlrev_b32 v8, 16, v148
  v_and_b32 v9, 0xffff0000, v148
  v_pk_add_f32 v[184:185], v[184:185], v[8:9]
  v_lshlrev_b32 v10, 16, v149
  v_and_b32 v11, 0xffff0000, v149
  v_pk_add_f32 v[186:187], v[186:187], v[10:11]
  v_lshlrev_b32 v12, 16, v150
  v_and_b32 v13, 0xffff0000, v150
  v_pk_add_f32 v[188:189], v[188:189], v[12:13]
  v_lshlrev_b32 v14, 16, v151
  v_and_b32 v15, 0xffff0000, v151
  v_pk_add_f32 v[190:191], v[190:191], v[14:15]
  s_waitcnt vmcnt(0)
  v_lshlrev_b32 v8, 16, v152
  v_and_b32 v9, 0xffff0000, v152
  v_pk_add_f32 v[176:177], v[176:177], v[8:9]
  v_lshlrev_b32 v10, 16, v153
  v_and_b32 v11, 0xffff0000, v153
  v_pk_add_f32 v[178:179], v[178:179], v[10:11]
  v_lshlrev_b32 v12, 16, v154
  v_and_b32 v13, 0xffff0000, v154
  v_pk_add_f32 v[180:181], v[180:181], v[12:13]
  v_lshlrev_b32 v14, 16, v155
  v_and_b32 v15, 0xffff0000, v155
  v_pk_add_f32 v[182:183], v[182:183], v[14:15]
  v_lshlrev_b32 v8, 16, v156
  v_and_b32 v9, 0xffff0000, v156
  v_pk_add_f32 v[184:185], v[184:185], v[8:9]
  v_lshlrev_b32 v10, 16, v157
  v_and_b32 v11, 0xffff0000, v157
  v_pk_add_f32 v[186:187], v[186:187], v[10:11]
  v_lshlrev_b32 v12, 16, v158
  v_and_b32 v13, 0xffff0000, v158
  v_pk_add_f32 v[188:189], v[188:189], v[12:13]
  v_lshlrev_b32 v14, 16, v159
  v_and_b32 v15, 0xffff0000, v159
  v_pk_add_f32 v[190:191], v[190:191], v[14:15]
  v_pk_fma_f32 v[160:161], v[176:177], v[82:83], v[160:161] op_sel_hi:[1,0,1]
  v_cvt_pk_bf16_f32 v16, v160, v161
  v_pk_fma_f32 v[162:163], v[178:179], v[82:83], v[162:163] op_sel_hi:[1,0,1]
  v_cvt_pk_bf16_f32 v17, v162, v163
  v_pk_fma_f32 v[164:165], v[180:181], v[82:83], v[164:165] op_sel_hi:[1,0,1]
  v_cvt_pk_bf16_f32 v18, v164, v165
  v_pk_fma_f32 v[166:167], v[182:183], v[82:83], v[166:167] op_sel_hi:[1,0,1]
  v_cvt_pk_bf16_f32 v19, v166, v167
  v_pk_fma_f32 v[168:169], v[184:185], v[82:83], v[168:169] op_sel_hi:[1,0,1]
  v_cvt_pk_bf16_f32 v20, v168, v169
  v_pk_fma_f32 v[170:171], v[186:187], v[82:83], v[170:171] op_sel_hi:[1,0,1]
  v_cvt_pk_bf16_f32 v21, v170, v171
  v_pk_fma_f32 v[172:173], v[188:189], v[82:83], v[172:173] op_sel_hi:[1,0,1]
  v_cvt_pk_bf16_f32 v22, v172, v173
  v_pk_fma_f32 v[174:175], v[190:191], v[82:83], v[174:175] op_sel_hi:[1,0,1]
  v_cvt_pk_bf16_f32 v23, v174, v175
  s_lshl_b32 s26, s49, 2
  s_add_u32 s26, s26, s16
  s_lshl_b32 s26, s26, 6
  s_lshl_b32 s27, s48, 15
  s_add_u32 s26, s26, s27
  buffer_store_dwordx4 v[16:19], v6, s[32:35], s26 offen offset:0
  buffer_store_dwordx4 v[20:23], v6, s[32:35], s26 offen offset:32
  s_cmp_lt_u32 s50, 64
  s_mov_b32 s50, s51
  s_cbranch_scc1 M_fin
  s_branch M_done
M_follow:
  s_lshr_b32 s48, s64, 2
  s_and_b32 s49, s64, 1
  s_bfe_u32 s50, s64, 0x10001
  s_mov_b32 s51, 2
  s_mov_b32 s23, 32
  s_load_dwordx2 s[8:9], s[0:1], 88
  s_lshl_b32 s17, s48, 19
  s_lshl_b32 s26, s49, 2
  s_add_u32 s26, s26, s16
  s_lshl_b32 s27, s26, 7
  s_add_u32 s17, s17, s27
  s_mov_b32 s18, 1024
  s_lshl_b32 s21, s48, 6
  s_add_u32 s21, s21, s50
  s_lshl_b32 s21, s21, 3
  s_add_u32 s21, s21, s26
  s_lshl_b32 s21, s21, 12
  s_add_u32 s21, s21, 167772160
  s_lshl_b32 s22, s51, 15
  s_mov_b32 s24, 1.0
  s_waitcnt lgkmcnt(0)
  s_and_b32 s9, s9, 0xffff
  s_mov_b32 s10, 4194304
  s_mov_b32 s11, 0x20000
  s_mul_i32 s26, s16, 0
  v_add_u32 v8, 0, v2
  v_add_u32 v16, s26, v8
  v_add_u32 v9, 1024, v2
  v_add_u32 v17, s26, v9
  v_add_u32 v10, 2048, v2
  v_add_u32 v18, s26, v10
  v_add_u32 v11, 3072, v2
  v_add_u32 v19, s26, v11
  v_add_u32 v12, 4096, v2
  v_add_u32 v20, s26, v12
  v_add_u32 v13, 5120, v2
  v_add_u32 v21, s26, v13
  v_add_u32 v14, 6144, v2
  v_add_u32 v22, s26, v14
  v_add_u32 v15, 7168, v2
  v_add_u32 v23, s26, v15
  v_lshrrev_b32 v144, 3, v1
  v_mul_lo_u32 v144, v144, s18
  v_and_b32 v145, 7, v1
  v_lshl_add_u32 v144, v145, 4, v144
  s_lshl_b32 s28, s16, 15
  s_add_u32 s28, s28, 32768
  s_lshl_b32 s29, s18, 3
  s_add_u32 m0, s28, 0
  s_nop 0
  buffer_load_dwordx4 v144, s[8:11], s17 offen lds
  s_add_u32 s17, s17, s29
  s_add_u32 m0, s28, 1024
  s_nop 0
  buffer_load_dwordx4 v144, s[8:11], s17 offen lds
  s_add_u32 s17, s17, s29
  s_add_u32 m0, s28, 2048
  s_nop 0
  buffer_load_dwordx4 v144, s[8:11], s17 offen lds
  s_add_u32 s17, s17, s29
  s_add_u32 m0, s28, 3072
  s_nop 0
  buffer_load_dwordx4 v144, s[8:11], s17 offen lds
  s_add_u32 s17, s17, s29
  s_add_u32 m0, s28, 4096
  s_nop 0
  buffer_load_dwordx4 v144, s[8:11], s17 offen lds
  s_add_u32 s17, s17, s29
  s_add_u32 m0, s28, 5120
  s_nop 0
  buffer_load_dwordx4 v144, s[8:11], s17 offen lds
  s_add_u32 s17, s17, s29
  s_add_u32 m0, s28, 6144
  s_nop 0
  buffer_load_dwordx4 v144, s[8:11], s17 offen lds
  s_add_u32 s17, s17, s29
  s_add_u32 m0, s28, 7168
  s_nop 0
  buffer_load_dwordx4 v144, s[8:11], s17 offen lds
  s_add_u32 s17, s17, s29
  s_add_u32 m0, s28, 8192
  s_nop 0
  buffer_load_dwordx4 v144, s[8:11], s17 offen lds
  s_add_u32 s17, s17, s29
  s_add_u32 m0, s28, 9216
  s_nop 0
  buffer_load_dwordx4 v144, s[8:11], s17 offen lds
  s_add_u32 s17, s17, s29
  s_add_u32 m0, s28, 10240
  s_nop 0
  buffer_load_dwordx4 v144, s[8:11], s17 offen lds
  s_add_u32 s17, s17, s29
  s_add_u32 m0, s28, 11264
  s_nop 0
  buffer_load_dwordx4 v144, s[8:11], s17 offen lds
  s_add_u32 s17, s17, s29
  s_add_u32 m0, s28, 12288
  s_nop 0
  buffer_load_dwordx4 v144, s[8:11], s17 offen lds
  s_add_u32 s17, s17, s29
  s_add_u32 m0, s28, 13312
  s_nop 0
  buffer_load_dwordx4 v144, s[8:11], s17 offen lds
  s_add_u32 s17, s17, s29
  s_add_u32 m0, s28, 14336
  s_nop 0
  buffer_load_dwordx4 v144, s[8:11], s17 offen lds
  s_add_u32 s17, s17, s29
  s_add_u32 m0, s28, 15360
  s_nop 0
  buffer_load_dwordx4 v144, s[8:11], s17 offen lds
  s_add_u32 s17, s17, s29
  s_add_u32 m0, s28, 16384
  s_nop 0
  buffer_load_dwordx4 v144, s[8:11], s17 offen lds
  s_add_u32 s17, s17, s29
  s_add_u32 m0, s28, 17408
  s_nop 0
  buffer_load_dwordx4 v144, s[8:11], s17 offen lds
  s_add_u32 s17, s17, s29
  s_add_u32 m0, s28, 18432
  s_nop 0
  buffer_load_dwordx4 v144, s[8:11], s17 offen lds
  s_add_u32 s17, s17, s29
  s_add_u32 m0, s28, 19456
  s_nop 0
  buffer_load_dwordx4 v144, s[8:11], s17 offen lds
  s_add_u32 s17, s17, s29
  s_add_u32 m0, s28, 20480
  s_nop 0
  buffer_load_dwordx4 v144, s[8:11], s17 offen lds
  s_add_u32 s17, s17, s29
  s_add_u32 m0, s28, 21504
  s_nop 0
  buffer_load_dwordx4 v144, s[8:11], s17 offen lds
  s_add_u32 s17, s17, s29
  s_add_u32 m0, s28, 22528
  s_nop 0
  buffer_load_dwordx4 v144, s[8:11], s17 offen lds
  s_add_u32 s17, s17, s29
  s_add_u32 m0, s28, 23552
  s_nop 0
  buffer_load_dwordx4 v144, s[8:11], s17 offen lds
  s_add_u32 s17, s17, s29
  s_add_u32 m0, s28, 24576
  s_nop 0
  buffer_load_dwordx4 v144, s[8:11], s17 offen lds
  s_add_u32 s17, s17, s29
  s_add_u32 m0, s28, 25600
  s_nop 0
  buffer_load_dwordx4 v144, s[8:11], s17 offen lds
  s_add_u32 s17, s17, s29
  s_add_u32 m0, s28, 26624
  s_nop 0
  buffer_load_dwordx4 v144, s[8:11], s17 offen lds
  s_add_u32 s17, s17, s29
  s_add_u32 m0, s28, 27648
  s_nop 0
  buffer_load_dwordx4 v144, s[8:11], s17 offen lds
  s_add_u32 s17, s17, s29
  s_add_u32 m0, s28, 28672
  s_nop 0
  buffer_load_dwordx4 v144, s[8:11], s17 offen lds
  s_add_u32 s17, s17, s29
  s_add_u32 m0, s28, 29696
  s_nop 0
  buffer_load_dwordx4 v144, s[8:11], s17 offen lds
  s_add_u32 s17, s17, s29
  s_add_u32 m0, s28, 30720
  s_nop 0
  buffer_load_dwordx4 v144, s[8:11], s17 offen lds
  s_add_u32 s17, s17, s29
  s_add_u32 m0, s28, 31744
  s_nop 0
  buffer_load_dwordx4 v144, s[8:11], s17 offen lds
  s_add_u32 s17, s17, s29
  v_bfe_u32 v148, v1, 2, 2
  v_lshrrev_b32 v149, 5, v1
  v_lshl_add_u32 v148, v149, 2, v148
  v_lshlrev_b32 v148, 7, v148
  v_bfe_u32 v149, v1, 4, 1
  v_lshl_add_u32 v148, v149, 5, v148
  v_and_b32 v149, 1, v1
  v_lshl_add_u32 v148, v149, 4, v148
  v_bfe_u32 v149, v1, 1, 1
  v_lshl_add_u32 v148, v149, 3, v148
  v_add_u32 v146, s28, v148
  v_add_u32 v147, 1024, v146
  s_waitcnt vmcnt(28)
  ds_read_b64_tr_b16 a[0:1], v146 offset:0
  ds_read_b64_tr_b16 a[2:3], v147 offset:0
  ds_read_b64_tr_b16 a[4:5], v146 offset:64
  ds_read_b64_tr_b16 a[6:7], v147 offset:64
  ds_read_b64_tr_b16 a[8:9], v146 offset:2048
  ds_read_b64_tr_b16 a[10:11], v147 offset:2048
  ds_read_b64_tr_b16 a[12:13], v146 offset:2112
  ds_read_b64_tr_b16 a[14:15], v147 offset:2112
  s_waitcnt lgkmcnt(0)
  s_add_u32 m0, s28, 0
  s_nop 0
  buffer_load_dwordx4 v144, s[8:11], s17 offen lds
  s_add_u32 s17, s17, s29
  s_add_u32 m0, s28, 1024
  s_nop 0
  buffer_load_dwordx4 v144, s[8:11], s17 offen lds
  s_add_u32 s17, s17, s29
  s_add_u32 m0, s28, 2048
  s_nop 0
  buffer_load_dwordx4 v144, s[8:11], s17 offen lds
  s_add_u32 s17, s17, s29
  s_add_u32 m0, s28, 3072
  s_nop 0
  buffer_load_dwordx4 v144, s[8:11], s17 offen lds
  s_add_u32 s17, s17, s29
  s_waitcnt vmcnt(28)
  ds_read_b64_tr_b16 a[16:17], v146 offset:4096
  ds_read_b64_tr_b16 a[18:19], v147 offset:4096
  ds_read_b64_tr_b16 a[20:21], v146 offset:4160
  ds_read_b64_tr_b16 a[22:23], v147 offset:4160
  ds_read_b64_tr_b16 a[24:25], v146 offset:6144
  ds_read_b64_tr_b16 a[26:27], v147 offset:6144
  ds_read_b64_tr_b16 a[28:29], v146 offset:6208
  ds_read_b64_tr_b16 a[30:31], v147 offset:6208
  s_waitcnt lgkmcnt(0)
  s_add_u32 m0, s28, 4096
  s_nop 0
  buffer_load_dwordx4 v144, s[8:11], s17 offen lds
  s_add_u32 s17, s17, s29
  s_add_u32 m0, s28, 5120
  s_nop 0
  buffer_load_dwordx4 v144, s[8:11], s17 offen lds
  s_add_u32 s17, s17, s29
  s_add_u32 m0, s28, 6144
  s_nop 0
  buffer_load_dwordx4 v144, s[8:11], s17 offen lds
  s_add_u32 s17, s17, s29
  s_add_u32 m0, s28, 7168
  s_nop 0
  buffer_load_dwordx4 v144, s[8:11], s17 offen lds
  s_add_u32 s17, s17, s29
  s_waitcnt vmcnt(28)
  ds_read_b64_tr_b16 a[32:33], v146 offset:8192
  ds_read_b64_tr_b16 a[34:35], v147 offset:8192
  ds_read_b64_tr_b16 a[36:37], v146 offset:8256
  ds_read_b64_tr_b16 a[38:39], v147 offset:8256
  ds_read_b64_tr_b16 a[40:41], v146 offset:10240
  ds_read_b64_tr_b16 a[42:43], v147 offset:10240
  ds_read_b64_tr_b16 a[44:45], v146 offset:10304
  ds_read_b64_tr_b16 a[46:47], v147 offset:10304
  s_waitcnt lgkmcnt(0)
  s_add_u32 m0, s28, 8192
  s_nop 0
  buffer_load_dwordx4 v144, s[8:11], s17 offen lds
  s_add_u32 s17, s17, s29
  s_add_u32 m0, s28, 9216
  s_nop 0
  buffer_load_dwordx4 v144, s[8:11], s17 offen lds
  s_add_u32 s17, s17, s29
  s_add_u32 m0, s28, 10240
  s_nop 0
  buffer_load_dwordx4 v144, s[8:11], s17 offen lds
  s_add_u32 s17, s17, s29
  s_add_u32 m0, s28, 11264
  s_nop 0
  buffer_load_dwordx4 v144, s[8:11], s17 offen lds
  s_add_u32 s17, s17, s29
  s_waitcnt vmcnt(28)
  ds_read_b64_tr_b16 a[48:49], v146 offset:12288
  ds_read_b64_tr_b16 a[50:51], v147 offset:12288
  ds_read_b64_tr_b16 a[52:53], v146 offset:12352
  ds_read_b64_tr_b16 a[54:55], v147 offset:12352
  ds_read_b64_tr_b16 a[56:57], v146 offset:14336
  ds_read_b64_tr_b16 a[58:59], v147 offset:14336
  ds_read_b64_tr_b16 a[60:61], v146 offset:14400
  ds_read_b64_tr_b16 a[62:63], v147 offset:14400
  s_waitcnt lgkmcnt(0)
  s_add_u32 m0, s28, 12288
  s_nop 0
  buffer_load_dwordx4 v144, s[8:11], s17 offen lds
  s_add_u32 s17, s17, s29
  s_add_u32 m0, s28, 13312
  s_nop 0
  buffer_load_dwordx4 v144, s[8:11], s17 offen lds
  s_add_u32 s17, s17, s29
  s_add_u32 m0, s28, 14336
  s_nop 0
  buffer_load_dwordx4 v144, s[8:11], s17 offen lds
  s_add_u32 s17, s17, s29
  s_add_u32 m0, s28, 15360
  s_nop 0
  buffer_load_dwordx4 v144, s[8:11], s17 offen lds
  s_add_u32 s17, s17, s29
  s_waitcnt vmcnt(28)
  ds_read_b64_tr_b16 a[64:65], v146 offset:16384
  ds_read_b64_tr_b16 a[66:67], v147 offset:16384
  ds_read_b64_tr_b16 a[68:69], v146 offset:16448
  ds_read_b64_tr_b16 a[70:71], v147 offset:16448
  ds_read_b64_tr_b16 a[72:73], v146 offset:18432
  ds_read_b64_tr_b16 a[74:75], v147 offset:18432
  ds_read_b64_tr_b16 a[76:77], v146 offset:18496
  ds_read_b64_tr_b16 a[78:79], v147 offset:18496
  s_waitcnt lgkmcnt(0)
  s_add_u32 m0, s28, 16384
  s_nop 0
  buffer_load_dwordx4 v144, s[8:11], s17 offen lds
  s_add_u32 s17, s17, s29
  s_add_u32 m0, s28, 17408
  s_nop 0
  buffer_load_dwordx4 v144, s[8:11], s17 offen lds
  s_add_u32 s17, s17, s29
  s_add_u32 m0, s28, 18432
  s_nop 0
  buffer_load_dwordx4 v144, s[8:11], s17 offen lds
  s_add_u32 s17, s17, s29
  s_add_u32 m0, s28, 19456
  s_nop 0
  buffer_load_dwordx4 v144, s[8:11], s17 offen lds
  s_add_u32 s17, s17, s29
  s_waitcnt vmcnt(28)
  ds_read_b64_tr_b16 a[80:81], v146 offset:20480
  ds_read_b64_tr_b16 a[82:83], v147 offset:20480
  ds_read_b64_tr_b16 a[84:85], v146 offset:20544
  ds_read_b64_tr_b16 a[86:87], v147 offset:20544
  ds_read_b64_tr_b16 a[88:89], v146 offset:22528
  ds_read_b64_tr_b16 a[90:91], v147 offset:22528
  ds_read_b64_tr_b16 a[92:93], v146 offset:22592
  ds_read_b64_tr_b16 a[94:95], v147 offset:22592
  s_waitcnt lgkmcnt(0)
  s_add_u32 m0, s28, 20480
  s_nop 0
  buffer_load_dwordx4 v144, s[8:11], s17 offen lds
  s_add_u32 s17, s17, s29
  s_add_u32 m0, s28, 21504
  s_nop 0
  buffer_load_dwordx4 v144, s[8:11], s17 offen lds
  s_add_u32 s17, s17, s29
  s_add_u32 m0, s28, 22528
  s_nop 0
  buffer_load_dwordx4 v144, s[8:11], s17 offen lds
  s_add_u32 s17, s17, s29
  s_add_u32 m0, s28, 23552
  s_nop 0
  buffer_load_dwordx4 v144, s[8:11], s17 offen lds
  s_add_u32 s17, s17, s29
  s_waitcnt vmcnt(28)
  ds_read_b64_tr_b16 a[96:97], v146 offset:24576
  ds_read_b64_tr_b16 a[98:99], v147 offset:24576
  ds_read_b64_tr_b16 a[100:101], v146 offset:24640
  ds_read_b64_tr_b16 a[102:103], v147 offset:24640
  ds_read_b64_tr_b16 a[104:105], v146 offset:26624
  ds_read_b64_tr_b16 a[106:107], v147 offset:26624
  ds_read_b64_tr_b16 a[108:109], v146 offset:26688
  ds_read_b64_tr_b16 a[110:111], v147 offset:26688
  s_waitcnt lgkmcnt(0)
  s_add_u32 m0, s28, 24576
  s_nop 0
  buffer_load_dwordx4 v144, s[8:11], s17 offen lds
  s_add_u32 s17, s17, s29
  s_add_u32 m0, s28, 25600
  s_nop 0
  buffer_load_dwordx4 v144, s[8:11], s17 offen lds
  s_add_u32 s17, s17, s29
  s_add_u32 m0, s28, 26624
  s_nop 0
  buffer_load_dwordx4 v144, s[8:11], s17 offen lds
  s_add_u32 s17, s17, s29
  s_add_u32 m0, s28, 27648
  s_nop 0
  buffer_load_dwordx4 v144, s[8:11], s17 offen lds
  s_add_u32 s17, s17, s29
  s_waitcnt vmcnt(28)
  ds_read_b64_tr_b16 a[112:113], v146 offset:28672
  ds_read_b64_tr_b16 a[114:115], v147 offset:28672
  ds_read_b64_tr_b16 a[116:117], v146 offset:28736
  ds_read_b64_tr_b16 a[118:119], v147 offset:28736
  ds_read_b64_tr_b16 a[120:121], v146 offset:30720
  ds_read_b64_tr_b16 a[122:123], v147 offset:30720
  ds_read_b64_tr_b16 a[124:125], v146 offset:30784
  ds_read_b64_tr_b16 a[126:127], v147 offset:30784
  s_waitcnt lgkmcnt(0)
  s_add_u32 m0, s28, 28672
  s_nop 0
  buffer_load_dwordx4 v144, s[8:11], s17 offen lds
  s_add_u32 s17, s17, s29
  s_add_u32 m0, s28, 29696
  s_nop 0
  buffer_load_dwordx4 v144, s[8:11], s17 offen lds
  s_add_u32 s17, s17, s29
  s_add_u32 m0, s28, 30720
  s_nop 0
  buffer_load_dwordx4 v144, s[8:11], s17 offen lds
  s_add_u32 s17, s17, s29
  s_add_u32 m0, s28, 31744
  s_nop 0
  buffer_load_dwordx4 v144, s[8:11], s17 offen lds
  s_add_u32 s17, s17, s29
  s_waitcnt vmcnt(28)
  ds_read_b64_tr_b16 a[128:129], v146 offset:0
  ds_read_b64_tr_b16 a[130:131], v147 offset:0
  ds_read_b64_tr_b16 a[132:133], v146 offset:64
  ds_read_b64_tr_b16 a[134:135], v147 offset:64
  ds_read_b64_tr_b16 a[136:137], v146 offset:2048
  ds_read_b64_tr_b16 a[138:139], v147 offset:2048
  ds_read_b64_tr_b16 a[140:141], v146 offset:2112
  ds_read_b64_tr_b16 a[142:143], v147 offset:2112
  s_waitcnt lgkmcnt(0)
  s_waitcnt vmcnt(24)
  ds_read_b64_tr_b16 a[144:145], v146 offset:4096
  ds_read_b64_tr_b16 a[146:147], v147 offset:4096
  ds_read_b64_tr_b16 a[148:149], v146 offset:4160
  ds_read_b64_tr_b16 a[150:151], v147 offset:4160
  ds_read_b64_tr_b16 a[152:153], v146 offset:6144
  ds_read_b64_tr_b16 a[154:155], v147 offset:6144
  ds_read_b64_tr_b16 a[156:157], v146 offset:6208
  ds_read_b64_tr_b16 a[158:159], v147 offset:6208
  s_waitcnt lgkmcnt(0)
  s_waitcnt vmcnt(20)
  ds_read_b64_tr_b16 a[160:161], v146 offset:8192
  ds_read_b64_tr_b16 a[162:163], v147 offset:8192
  ds_read_b64_tr_b16 a[164:165], v146 offset:8256
  ds_read_b64_tr_b16 a[166:167], v147 offset:8256
  ds_read_b64_tr_b16 a[168:169], v146 offset:10240
  ds_read_b64_tr_b16 a[170:171], v147 offset:10240
  ds_read_b64_tr_b16 a[172:173], v146 offset:10304
  ds_read_b64_tr_b16 a[174:175], v147 offset:10304
  s_waitcnt lgkmcnt(0)
  s_waitcnt vmcnt(16)
  ds_read_b64_tr_b16 a[176:177], v146 offset:12288
  ds_read_b64_tr_b16 a[178:179], v147 offset:12288
  ds_read_b64_tr_b16 a[180:181], v146 offset:12352
  ds_read_b64_tr_b16 a[182:183], v147 offset:12352
  ds_read_b64_tr_b16 a[184:185], v146 offset:14336
  ds_read_b64_tr_b16 a[186:187], v147 offset:14336
  ds_read_b64_tr_b16 a[188:189], v146 offset:14400
  ds_read_b64_tr_b16 a[190:191], v147 offset:14400
  s_waitcnt lgkmcnt(0)
  s_waitcnt vmcnt(12)
  ds_read_b64_tr_b16 a[192:193], v146 offset:16384
  ds_read_b64_tr_b16 a[194:195], v147 offset:16384
  ds_read_b64_tr_b16 a[196:197], v146 offset:16448
  ds_read_b64_tr_b16 a[198:199], v147 offset:16448
  ds_read_b64_tr_b16 a[200:201], v146 offset:18432
  ds_read_b64_tr_b16 a[202:203], v147 offset:18432
  ds_read_b64_tr_b16 a[204:205], v146 offset:18496
  ds_read_b64_tr_b16 a[206:207], v147 offset:18496
  s_waitcnt lgkmcnt(0)
  s_waitcnt vmcnt(8)
  ds_read_b64_tr_b16 a[208:209], v146 offset:20480
  ds_read_b64_tr_b16 a[210:211], v147 offset:20480
  ds_read_b64_tr_b16 a[212:213], v146 offset:20544
  ds_read_b64_tr_b16 a[214:215], v147 offset:20544
  ds_read_b64_tr_b16 a[216:217], v146 offset:22528
  ds_read_b64_tr_b16 a[218:219], v147 offset:22528
  ds_read_b64_tr_b16 a[220:221], v146 offset:22592
  ds_read_b64_tr_b16 a[222:223], v147 offset:22592
  s_waitcnt lgkmcnt(0)
  s_waitcnt vmcnt(4)
  ds_read_b64_tr_b16 a[224:225], v146 offset:24576
  ds_read_b64_tr_b16 a[226:227], v147 offset:24576
  ds_read_b64_tr_b16 a[228:229], v146 offset:24640
  ds_read_b64_tr_b16 a[230:231], v147 offset:24640
  ds_read_b64_tr_b16 a[232:233], v146 offset:26624
  ds_read_b64_tr_b16 a[234:235], v147 offset:26624
  ds_read_b64_tr_b16 a[236:237], v146 offset:26688
  ds_read_b64_tr_b16 a[238:239], v147 offset:26688
  s_waitcnt lgkmcnt(0)
  s_waitcnt vmcnt(0)
  ds_read_b64_tr_b16 a[240:241], v146 offset:28672
  ds_read_b64_tr_b16 a[242:243], v147 offset:28672
  ds_read_b64_tr_b16 a[244:245], v146 offset:28736
  ds_read_b64_tr_b16 a[246:247], v147 offset:28736
  ds_read_b64_tr_b16 a[248:249], v146 offset:30720
  ds_read_b64_tr_b16 a[250:251], v147 offset:30720
  ds_read_b64_tr_b16 a[252:253], v146 offset:30784
  ds_read_b64_tr_b16 a[254:255], v147 offset:30784
  s_waitcnt lgkmcnt(0)
  s_lshl_b32 s26, s48, 2
  s_add_u32 s26, s26, s16
  s_lshl_b32 s27, s26, 6
  s_add_u32 s27, s27, s50
  s_lshl_b32 s19, s27, 13
  s_lshl_b32 s27, s50, 5
  s_add_u32 s27, s27, s26
  s_mul_i32 s27, s27, 4608
  s_add_u32 s20, s27, 134217728
  s_lshl_b32 s25, s16, 12
  s_add_u32 s25, s25, 65536
  s_lshl_b32 s26, s16, 13
  v_add_u32 v3, s26, v2
  v_lshrrev_b32 v16, 5, v1
  v_and_b32 v17, 31, v1
  v_mul_u32_u24 v18, 1152, v16
  v_lshl_add_u32 v5, v17, 3, v18
  v_bfe_u32 v18, v1, 2, 2
  v_lshl_add_u32 v18, v16, 2, v18
  v_and_b32 v19, 1, v1
  v_mul_u32_u24 v19, 1152, v19
  v_lshl_add_u32 v18, v18, 3, v19
  v_add_u32 v4, s25, v18
  v_lshlrev_b32 v16, 2, v16
  v_sub_u32 v17, v17, v16
  v_mov_b32 v18, 0xf149f2ca
  v_cmp_le_i32 vcc, 0, v17
  s_nop 1
  v_cndmask_b32 v240, v18, 0, vcc
  v_cmp_le_i32 vcc, 1, v17
  s_nop 1
  v_cndmask_b32 v241, v18, 0, vcc
  v_cmp_le_i32 vcc, 2, v17
  s_nop 1
  v_cndmask_b32 v242, v18, 0, vcc
  v_cmp_le_i32 vcc, 3, v17
  s_nop 1
  v_cndmask_b32 v243, v18, 0, vcc
  v_cmp_le_i32 vcc, 8, v17
  s_nop 1
  v_cndmask_b32 v244, v18, 0, vcc
  v_cmp_le_i32 vcc, 9, v17
  s_nop 1
  v_cndmask_b32 v245, v18, 0, vcc
  v_cmp_le_i32 vcc, 10, v17
  s_nop 1
  v_cndmask_b32 v246, v18, 0, vcc
  v_cmp_le_i32 vcc, 11, v17
  s_nop 1
  v_cndmask_b32 v247, v18, 0, vcc
  v_cmp_le_i32 vcc, 16, v17
  s_nop 1
  v_cndmask_b32 v248, v18, 0, vcc
  v_cmp_le_i32 vcc, 17, v17
  s_nop 1
  v_cndmask_b32 v249, v18, 0, vcc
  v_cmp_le_i32 vcc, 18, v17
  s_nop 1
  v_cndmask_b32 v250, v18, 0, vcc
  v_cmp_le_i32 vcc, 19, v17
  s_nop 1
  v_cndmask_b32 v251, v18, 0, vcc
  v_cmp_le_i32 vcc, 24, v17
  s_nop 1
  v_cndmask_b32 v252, v18, 0, vcc
  v_cmp_le_i32 vcc, 25, v17
  s_nop 1
  v_cndmask_b32 v253, v18, 0, vcc
  v_cmp_le_i32 vcc, 26, v17
  s_nop 1
  v_cndmask_b32 v254, v18, 0, vcc
  v_cmp_le_i32 vcc, 27, v17
  s_nop 1
  v_cndmask_b32 v255, v18, 0, vcc
  v_mov_b32 v21, v2
  s_barrier
  s_lshl_b32 s77, s48, 2
  s_add_u32 s77, s77, s16
  s_mul_i32 s78, s77, 896
  s_add_u32 s76, s78, 148898176
  s_mov_b32 s71, 0
  s_branch M_sg_54
M_sw_53:
  s_sleep 8
  s_add_u32 s71, s71, 1
  s_cmp_gt_u32 s71, 262144
  s_cbranch_scc1 M_exit
M_sg_54:
  s_mov_b32 s79, 0
  s_atomic_or s79, s[72:73], s76 glc
  s_waitcnt lgkmcnt(0)
  s_cmp_lt_u32 s79, 25
  s_cbranch_scc1 M_sw_53
  s_add_u32 s76, s78, 148898432
  s_mov_b32 s71, 0
  s_branch M_sg_56
M_sw_55:
  s_sleep 8
  s_add_u32 s71, s71, 1
  s_cmp_gt_u32 s71, 262144
  s_cbranch_scc1 M_exit
M_sg_56:
  s_mov_b32 s79, 0
  s_atomic_or s79, s[72:73], s76 glc
  s_waitcnt lgkmcnt(0)
  s_cmp_lt_u32 s79, 39
  s_cbranch_scc1 M_sw_55
  s_add_u32 s76, s78, 148898048
  s_mov_b32 s71, 0
  s_branch M_sg_58
M_sw_57:
  s_sleep 8
  s_add_u32 s71, s71, 1
  s_cmp_gt_u32 s71, 262144
  s_cbranch_scc1 M_exit
M_sg_58:
  s_mov_b32 s79, 0
  s_atomic_or s79, s[72:73], s76 glc
  s_waitcnt lgkmcnt(0)
  s_cmp_lt_u32 s79, 28
  s_cbranch_scc1 M_sw_57
  s_add_u32 s76, s78, 148898560
  s_mov_b32 s71, 0
  s_branch M_sg_60
M_sw_59:
  s_sleep 8
  s_add_u32 s71, s71, 1
  s_cmp_gt_u32 s71, 262144
  s_cbranch_scc1 M_exit
M_sg_60:
  s_mov_b32 s79, 0
  s_atomic_or s79, s[72:73], s76 glc
  s_waitcnt lgkmcnt(0)
  s_cmp_lt_u32 s79, 36
  s_cbranch_scc1 M_sw_59
  s_lshl_b32 s77, s77, 7
  s_add_u32 s54, s77, 148926464
  s_add_u32 s52, s50, 1
  s_mov_b32 s53, 0
  s_mov_b32 s30, 0x200
  s_add_u32 s28, s19, 50331648
  buffer_load_dwordx4 v[144:147], v21, s[4:7], s28 offen offset:0 sc1
  buffer_load_dwordx4 v[148:151], v21, s[4:7], s28 offen offset:1024 sc1
  buffer_load_dwordx4 v[152:155], v21, s[4:7], s28 offen offset:2048 sc1
  buffer_load_dwordx4 v[156:159], v21, s[4:7], s28 offen offset:3072 sc1
  s_add_u32 s29, s19, 50335744
  buffer_load_dwordx4 v[160:163], v21, s[4:7], s29 offen offset:0 sc1
  buffer_load_dwordx4 v[164:167], v21, s[4:7], s29 offen offset:1024 sc1
  buffer_load_dwordx4 v[168:171], v21, s[4:7], s29 offen offset:2048 sc1
  buffer_load_dwordx4 v[172:175], v21, s[4:7], s29 offen offset:3072 sc1
  s_add_u32 s28, s19, 67108864
  buffer_load_dwordx4 v[176:179], v21, s[4:7], s28 offen offset:0 sc1
  buffer_load_dwordx4 v[180:183], v21, s[4:7], s28 offen offset:1024 sc1
  buffer_load_dwordx4 v[184:187], v21, s[4:7], s28 offen offset:2048 sc1
  buffer_load_dwordx4 v[188:191], v21, s[4:7], s28 offen offset:3072 sc1
  s_add_u32 s29, s19, 67112960
  buffer_load_dwordx4 v[192:195], v21, s[4:7], s29 offen offset:0 sc1
  buffer_load_dwordx4 v[196:199], v21, s[4:7], s29 offen offset:1024 sc1
  buffer_load_dwordx4 v[200:203], v21, s[4:7], s29 offen offset:2048 sc1
  buffer_load_dwordx4 v[204:207], v21, s[4:7], s29 offen offset:3072 sc1
  s_add_u32 s28, s19, 83886080
  buffer_load_dwordx4 v[208:211], v21, s[4:7], s28 offen offset:0 sc1
  buffer_load_dwordx4 v[212:215], v21, s[4:7], s28 offen offset:1024 sc1
  buffer_load_dwordx4 v[216:219], v21, s[4:7], s28 offen offset:2048 sc1
  buffer_load_dwordx4 v[220:223], v21, s[4:7], s28 offen offset:3072 sc1
  s_add_u32 s29, s19, 83890176
  buffer_load_dwordx4 v[224:227], v21, s[4:7], s29 offen offset:0 sc1
  buffer_load_dwordx4 v[228:231], v21, s[4:7], s29 offen offset:1024 sc1
  buffer_load_dwordx4 v[232:235], v21, s[4:7], s29 offen offset:2048 sc1
  buffer_load_dwordx4 v[236:239], v21, s[4:7], s29 offen offset:3072 sc1
  s_mov_b32 s24, 0
  v_mov_b32 v22, 0x40000000
  s_sub_u32 s21, s21, s22
F_top_61:
  s_waitcnt vmcnt(8)
  v_mfma_f32_32x32x16_bf16 v[24:39], v[176:179], v[144:147], v[240:255]
  s_nop 1
  v_cvt_pk_bf16_f32 v128, v64, v65
  v_cvt_pk_bf16_f32 v129, v66, v67
  v_cvt_pk_bf16_f32 v130, v68, v69
  v_cvt_pk_bf16_f32 v131, v70, v71
  v_mfma_f32_32x32x16_bf16 v[24:39], v[180:183], v[148:151], v[24:39]
  buffer_store_dwordx4 v[128:131], v22, s[4:7], s21 offen offset:0 sc1
  v_mfma_f32_32x32x16_bf16 v[24:39], v[184:187], v[152:155], v[24:39]
  v_cvt_pk_bf16_f32 v132, v72, v73
  v_cvt_pk_bf16_f32 v133, v74, v75
  v_cvt_pk_bf16_f32 v134, v76, v77
  v_cvt_pk_bf16_f32 v135, v78, v79
  v_mfma_f32_32x32x16_bf16 v[24:39], v[188:191], v[156:159], v[24:39]
  buffer_store_dwordx4 v[132:135], v22, s[4:7], s21 offen offset:1024 sc1
  v_mfma_f32_32x32x16_bf16 v[24:39], v[192:195], v[160:163], v[24:39]
  v_cvt_pk_bf16_f32 v136, v80, v81
  v_cvt_pk_bf16_f32 v137, v82, v83
  v_cvt_pk_bf16_f32 v138, v84, v85
  v_cvt_pk_bf16_f32 v139, v86, v87
  v_mfma_f32_32x32x16_bf16 v[24:39], v[196:199], v[164:167], v[24:39]
  buffer_store_dwordx4 v[136:139], v22, s[4:7], s21 offen offset:2048 sc1
  v_mfma_f32_32x32x16_bf16 v[24:39], v[200:203], v[168:171], v[24:39]
  v_cvt_pk_bf16_f32 v140, v88, v89
  v_cvt_pk_bf16_f32 v141, v90, v91
  v_cvt_pk_bf16_f32 v142, v92, v93
  v_cvt_pk_bf16_f32 v143, v94, v95
  v_mfma_f32_32x32x16_bf16 v[24:39], v[204:207], v[172:175], v[24:39]
  buffer_store_dwordx4 v[140:143], v22, s[4:7], s21 offen offset:3072 sc1
  s_add_u32 s21, s21, s22
  v_mov_b32 v22, v2
  s_cmp_lg_u32 s24, 0
  s_cbranch_scc1 F_have_62
  v_mov_b32 v16, s54
  v_mov_b32 v17, s52
  s_mov_b32 s71, 0
  s_branch M_vg_64
M_vw_63:
  s_sleep 2
  s_add_u32 s71, s71, 1
  s_cmp_gt_u32 s71, 262144
  s_cbranch_scc1 M_exit
M_vg_64:
  buffer_load_dword v23, v16, s[4:7], 0 offen sc1
  s_waitcnt vmcnt(0)
  v_cmp_lt_u32 vcc, v23, v17
  s_cbranch_vccnz M_vw_63
  s_mov_b32 m0, s25
  s_nop 0
  buffer_load_dwordx4 v2, s[4:7], s20 offen offset:0 sc1 lds
  buffer_load_dwordx4 v2, s[4:7], s20 offen offset:1152 sc1 lds
  buffer_load_dwordx2 v[56:57], v5, s[4:7], s20 offen offset:2304 sc1
  buffer_load_dwordx2 v[58:59], v5, s[4:7], s20 offen offset:2560 sc1
  buffer_load_dwordx2 v[60:61], v5, s[4:7], s20 offen offset:2816 sc1
  buffer_load_dwordx2 v[62:63], v5, s[4:7], s20 offen offset:3072 sc1
  s_waitcnt vmcnt(0)
F_have_62:
  ds_read_b64_tr_b16 v[176:177], v4 offset:0
  ds_read_b64_tr_b16 v[178:179], v4 offset:64
  ds_read_b64_tr_b16 v[180:181], v4 offset:128
  ds_read_b64_tr_b16 v[182:183], v4 offset:192
  ds_read_b64_tr_b16 v[184:185], v4 offset:256
  ds_read_b64_tr_b16 v[186:187], v4 offset:320
  ds_read_b64_tr_b16 v[188:189], v4 offset:384
  ds_read_b64_tr_b16 v[190:191], v4 offset:448
  ds_read_b64_tr_b16 v[192:193], v4 offset:512
  ds_read_b64_tr_b16 v[194:195], v4 offset:576
  ds_read_b64_tr_b16 v[196:197], v4 offset:640
  ds_read_b64_tr_b16 v[198:199], v4 offset:704
  s_sub_u32 s23, s23, 1
  s_cmp_gt_u32 s23, 0
  s_cselect_b32 s26, s51, 0
  s_cselect_b32 s27, 0, 0x40000000
  v_or_b32 v21, s27, v21
  s_lshl_b32 s27, s26, 13
  s_add_u32 s19, s19, s27
  s_mul_i32 s27, s26, 147456
  s_add_u32 s20, s20, s27
  s_waitcnt lgkmcnt(10)
  v_mfma_f32_32x32x16_bf16 v[40:55], v[176:179], v[144:147], 0
  ds_read_b64_tr_b16 v[200:201], v4 offset:768
  ds_read_b64_tr_b16 v[202:203], v4 offset:832
  v_max_f32 v6, v24, v25
  s_waitcnt lgkmcnt(10)
  v_mfma_f32_32x32x16_bf16 v[40:55], v[180:183], v[148:151], v[40:55]
  ds_read_b64_tr_b16 v[204:205], v4 offset:896
  ds_read_b64_tr_b16 v[206:207], v4 offset:960
  v_max3_f32 v6, v6, v26, v27
  s_waitcnt lgkmcnt(10)
  v_mfma_f32_32x32x16_bf16 v[40:55], v[184:187], v[152:155], v[40:55]
  v_max3_f32 v6, v6, v28, v29
  s_waitcnt lgkmcnt(8)
  v_mfma_f32_32x32x16_bf16 v[40:55], v[188:191], v[156:159], v[40:55]
  v_max3_f32 v6, v6, v30, v31
  s_waitcnt lgkmcnt(6)
  v_mfma_f32_32x32x16_bf16 v[40:55], v[192:195], v[160:163], v[40:55]
  v_max3_f32 v6, v6, v32, v33
  s_waitcnt lgkmcnt(4)
  v_mfma_f32_32x32x16_bf16 v[40:55], v[196:199], v[164:167], v[40:55]
  v_max3_f32 v6, v6, v34, v35
  s_waitcnt lgkmcnt(2)
  v_mfma_f32_32x32x16_bf16 v[40:55], v[200:203], v[168:171], v[40:55]
  v_max3_f32 v6, v6, v36, v37
  s_waitcnt lgkmcnt(0)
  v_mfma_f32_32x32x16_bf16 v[40:55], v[204:207], v[172:175], v[40:55]
  v_max3_f32 v6, v6, v38, v39
  s_add_u32 s28, s19, 50331648
  buffer_load_dwordx4 v[144:147], v21, s[4:7], s28 offen offset:0 sc1
  buffer_load_dwordx4 v[148:151], v21, s[4:7], s28 offen offset:1024 sc1
  s_nop 7
  v_max3_f32 v6, v6, v40, v41
  v_max3_f32 v6, v6, v42, v43
  v_mov_b32 v16, v6
  s_nop 1
  v_permlane32_swap_b32 v6, v16
  s_nop 1
  v_max_f32 v6, v6, v16
  v_pk_add_f32 v[24:25], v[24:25], v[6:7] op_sel_hi:[1,0] neg_lo:[0,1] neg_hi:[0,1]
  v_pk_add_f32 v[26:27], v[26:27], v[6:7] op_sel_hi:[1,0] neg_lo:[0,1] neg_hi:[0,1]
  v_pk_add_f32 v[28:29], v[28:29], v[6:7] op_sel_hi:[1,0] neg_lo:[0,1] neg_hi:[0,1]
  v_pk_add_f32 v[30:31], v[30:31], v[6:7] op_sel_hi:[1,0] neg_lo:[0,1] neg_hi:[0,1]
  v_pk_add_f32 v[32:33], v[32:33], v[6:7] op_sel_hi:[1,0] neg_lo:[0,1] neg_hi:[0,1]
  v_pk_add_f32 v[34:35], v[34:35], v[6:7] op_sel_hi:[1,0] neg_lo:[0,1] neg_hi:[0,1]
  v_pk_add_f32 v[36:37], v[36:37], v[6:7] op_sel_hi:[1,0] neg_lo:[0,1] neg_hi:[0,1]
  v_pk_add_f32 v[38:39], v[38:39], v[6:7] op_sel_hi:[1,0] neg_lo:[0,1] neg_hi:[0,1]
  v_pk_add_f32 v[40:41], v[40:41], v[6:7] op_sel_hi:[1,0] neg_lo:[0,1] neg_hi:[0,1]
  v_pk_add_f32 v[42:43], v[42:43], v[6:7] op_sel_hi:[1,0] neg_lo:[0,1] neg_hi:[0,1]
  v_exp_f32 v24, v24
  v_exp_f32 v25, v25
  v_exp_f32 v26, v26
  v_exp_f32 v27, v27
  v_exp_f32 v28, v28
  v_exp_f32 v29, v29
  v_exp_f32 v30, v30
  v_exp_f32 v31, v31
  v_exp_f32 v32, v32
  v_exp_f32 v33, v33
  buffer_load_dwordx4 v[152:155], v21, s[4:7], s28 offen offset:2048 sc1
  v_exp_f32 v34, v34
  v_exp_f32 v35, v35
  v_exp_f32 v36, v36
  v_exp_f32 v37, v37
  v_exp_f32 v38, v38
  v_exp_f32 v39, v39
  v_exp_f32 v40, v40
  v_exp_f32 v41, v41
  v_exp_f32 v42, v42
  v_exp_f32 v43, v43
  v_pk_add_f32 v[16:17], v[24:25], v[26:27]
  v_pk_add_f32 v[16:17], v[16:17], v[28:29]
  v_pk_add_f32 v[16:17], v[16:17], v[30:31]
  v_pk_add_f32 v[16:17], v[16:17], v[32:33]
  v_pk_add_f32 v[16:17], v[16:17], v[34:35]
  v_pk_add_f32 v[16:17], v[16:17], v[36:37]
  v_pk_add_f32 v[16:17], v[16:17], v[38:39]
  v_pk_add_f32 v[16:17], v[16:17], v[40:41]
  v_pk_add_f32 v[16:17], v[16:17], v[42:43]
  v_add_f32 v16, v16, v17
  v_mov_b32 v17, v16
  buffer_load_dwordx4 v[156:159], v21, s[4:7], s28 offen offset:3072 sc1
  s_nop 0
  v_permlane32_swap_b32 v16, v17
  s_nop 1
  v_add_f32 v16, v16, v17
  v_rcp_f32 v6, v16
  s_nop 0
  v_pk_mul_f32 v[24:25], v[24:25], v[6:7] op_sel_hi:[1,0]
  v_pk_mul_f32 v[26:27], v[26:27], v[6:7] op_sel_hi:[1,0]
  v_pk_mul_f32 v[28:29], v[28:29], v[6:7] op_sel_hi:[1,0]
  v_pk_mul_f32 v[30:31], v[30:31], v[6:7] op_sel_hi:[1,0]
  v_pk_mul_f32 v[32:33], v[32:33], v[6:7] op_sel_hi:[1,0]
  v_pk_mul_f32 v[34:35], v[34:35], v[6:7] op_sel_hi:[1,0]
  v_pk_mul_f32 v[36:37], v[36:37], v[6:7] op_sel_hi:[1,0]
  v_pk_mul_f32 v[38:39], v[38:39], v[6:7] op_sel_hi:[1,0]
  v_pk_mul_f32 v[40:41], v[40:41], v[6:7] op_sel_hi:[1,0]
  v_pk_mul_f32 v[42:43], v[42:43], v[6:7] op_sel_hi:[1,0]
  v_cvt_pk_bf16_f32 v128, v24, v25
  v_cvt_pk_bf16_f32 v129, v26, v27
  v_cvt_pk_bf16_f32 v130, v28, v29
  v_cvt_pk_bf16_f32 v131, v30, v31
  v_cvt_pk_bf16_f32 v132, v32, v33
  v_cvt_pk_bf16_f32 v133, v34, v35
  v_cvt_pk_bf16_f32 v134, v36, v37
  v_cvt_pk_bf16_f32 v135, v38, v39
  v_cvt_pk_bf16_f32 v136, v40, v41
  v_cvt_pk_bf16_f32 v137, v42, v43
  s_waitcnt vmcnt(8)
  v_mfma_f32_32x32x16_bf16 v[64:79], v[208:211], v[128:131], 0
  s_add_u32 s29, s19, 50335744
  buffer_load_dwordx4 v[160:163], v21, s[4:7], s29 offen offset:0 sc1
  v_mfma_f32_32x32x16_bf16 v[64:79], v[212:215], v[132:135], v[64:79]
  v_mfma_f32_32x32x8_bf16 v[64:79], v[56:57], v[136:137], v[64:79]
  v_mfma_f32_32x32x16_bf16 v[80:95], v[216:219], v[128:131], 0
  buffer_load_dwordx4 v[164:167], v21, s[4:7], s29 offen offset:1024 sc1
  v_mfma_f32_32x32x16_bf16 v[80:95], v[220:223], v[132:135], v[80:95]
  v_cvt_pk_bf16_f32 v24, v64, v65
  v_cvt_pk_bf16_f32 v25, v66, v67
  v_cvt_pk_bf16_f32 v26, v68, v69
  v_cvt_pk_bf16_f32 v27, v70, v71
  v_mfma_f32_32x32x8_bf16 v[80:95], v[58:59], v[136:137], v[80:95]
  ds_write_b128 v3, v[24:27] offset:0
  v_cvt_pk_bf16_f32 v28, v72, v73
  v_cvt_pk_bf16_f32 v29, v74, v75
  v_cvt_pk_bf16_f32 v30, v76, v77
  v_cvt_pk_bf16_f32 v31, v78, v79
  v_mfma_f32_32x32x16_bf16 v[96:111], v[224:227], v[128:131], 0
  ds_write_b128 v3, v[28:31] offset:1024
  buffer_load_dwordx4 v[168:171], v21, s[4:7], s29 offen offset:2048 sc1
  v_mfma_f32_32x32x16_bf16 v[96:111], v[228:231], v[132:135], v[96:111]
  v_cvt_pk_bf16_f32 v32, v80, v81
  v_cvt_pk_bf16_f32 v33, v82, v83
  v_cvt_pk_bf16_f32 v34, v84, v85
  v_cvt_pk_bf16_f32 v35, v86, v87
  v_mfma_f32_32x32x8_bf16 v[96:111], v[60:61], v[136:137], v[96:111]
  ds_write_b128 v3, v[32:35] offset:2048
  v_cvt_pk_bf16_f32 v36, v88, v89
  v_cvt_pk_bf16_f32 v37, v90, v91
  v_cvt_pk_bf16_f32 v38, v92, v93
  v_cvt_pk_bf16_f32 v39, v94, v95
  v_mfma_f32_32x32x16_bf16 v[112:127], v[232:235], v[128:131], 0
  ds_write_b128 v3, v[36:39] offset:3072
  buffer_load_dwordx4 v[172:175], v21, s[4:7], s29 offen offset:3072 sc1
  v_mfma_f32_32x32x16_bf16 v[112:127], v[236:239], v[132:135], v[112:127]
  v_cvt_pk_bf16_f32 v40, v96, v97
  v_cvt_pk_bf16_f32 v41, v98, v99
  v_cvt_pk_bf16_f32 v42, v100, v101
  v_cvt_pk_bf16_f32 v43, v102, v103
  v_mfma_f32_32x32x8_bf16 v[112:127], v[62:63], v[136:137], v[112:127]
  ds_write_b128 v3, v[40:43] offset:4096
  v_cvt_pk_bf16_f32 v44, v104, v105
  v_cvt_pk_bf16_f32 v45, v106, v107
  v_cvt_pk_bf16_f32 v46, v108, v109
  v_cvt_pk_bf16_f32 v47, v110, v111
  ds_write_b128 v3, v[44:47] offset:5120
  s_nop 5
  v_cvt_pk_bf16_f32 v48, v112, v113
  v_cvt_pk_bf16_f32 v49, v114, v115
  v_cvt_pk_bf16_f32 v50, v116, v117
  v_cvt_pk_bf16_f32 v51, v118, v119
  ds_write_b128 v3, v[48:51] offset:6144
  v_cvt_pk_bf16_f32 v52, v120, v121
  v_cvt_pk_bf16_f32 v53, v122, v123
  v_cvt_pk_bf16_f32 v54, v124, v125
  v_cvt_pk_bf16_f32 v55, v126, v127
  ds_write_b128 v3, v[52:55] offset:7168
  s_waitcnt vmcnt(8)
  s_waitcnt lgkmcnt(0)
  s_barrier
  ds_read_b128 v[24:27], v8 offset:0
  ds_read_b128 v[28:31], v9 offset:0
  ds_read_b128 v[32:35], v10 offset:0
  ds_read_b128 v[36:39], v11 offset:0
  ds_read_b128 v[40:43], v12 offset:0
  ds_read_b128 v[44:47], v13 offset:0
  v_readfirstlane_b32 s53, v23
  v_mov_b32 v16, s30
  v_min_u32 v17, 1, v0
  v_lshlrev_b32 v17, 30, v17
  buffer_store_dword v16, v17, s[4:7], s31 offen sc1
  s_add_u32 s30, s30, 1
  s_add_u32 s52, s52, 2
  s_cmp_ge_u32 s53, s52
  s_cselect_b32 s24, 1, 0
  buffer_load_dword v23, off, s[4:7], s54 sc1
  s_cmp_eq_u32 s24, 0
  s_cbranch_scc1 F_nopre_65
  s_mov_b32 m0, s25
  s_nop 0
  buffer_load_dwordx4 v2, s[4:7], s20 offen offset:0 sc1 lds
  buffer_load_dwordx4 v2, s[4:7], s20 offen offset:1152 sc1 lds
  buffer_load_dwordx2 v[56:57], v5, s[4:7], s20 offen offset:2304 sc1
  buffer_load_dwordx2 v[58:59], v5, s[4:7], s20 offen offset:2560 sc1
  buffer_load_dwordx2 v[60:61], v5, s[4:7], s20 offen offset:2816 sc1
  buffer_load_dwordx2 v[62:63], v5, s[4:7], s20 offen offset:3072 sc1
F_nopre_65:
  s_waitcnt lgkmcnt(5)
  v_mfma_f32_32x32x16_bf16 v[64:79], a[0:3], v[24:27], 0
  s_add_u32 s28, s19, 67108864
  ds_read_b128 v[48:51], v14 offset:0
  v_mfma_f32_32x32x16_bf16 v[80:95], a[4:7], v[24:27], 0
  s_waitcnt lgkmcnt(5)
  v_mfma_f32_32x32x16_bf16 v[64:79], a[8:11], v[28:31], v[64:79]
  ds_read_b128 v[52:55], v15 offset:0
  v_mfma_f32_32x32x16_bf16 v[80:95], a[12:15], v[28:31], v[80:95]
  s_waitcnt lgkmcnt(5)
  buffer_load_dwordx4 v[176:179], v21, s[4:7], s28 offen offset:0 sc1
  v_mfma_f32_32x32x16_bf16 v[64:79], a[16:19], v[32:35], v[64:79]
  ds_read_b128 v[24:27], v8 offset:8192
  v_mfma_f32_32x32x16_bf16 v[80:95], a[20:23], v[32:35], v[80:95]
  s_waitcnt lgkmcnt(5)
  v_mfma_f32_32x32x16_bf16 v[64:79], a[24:27], v[36:39], v[64:79]
  ds_read_b128 v[28:31], v9 offset:8192
  v_mfma_f32_32x32x16_bf16 v[80:95], a[28:31], v[36:39], v[80:95]
  s_waitcnt lgkmcnt(5)
  buffer_load_dwordx4 v[180:183], v21, s[4:7], s28 offen offset:1024 sc1
  v_mfma_f32_32x32x16_bf16 v[64:79], a[32:35], v[40:43], v[64:79]
  ds_read_b128 v[32:35], v10 offset:8192
  v_mfma_f32_32x32x16_bf16 v[80:95], a[36:39], v[40:43], v[80:95]
  s_waitcnt lgkmcnt(5)
  v_mfma_f32_32x32x16_bf16 v[64:79], a[40:43], v[44:47], v[64:79]
  ds_read_b128 v[36:39], v11 offset:8192
  v_mfma_f32_32x32x16_bf16 v[80:95], a[44:47], v[44:47], v[80:95]
  s_waitcnt lgkmcnt(5)
  buffer_load_dwordx4 v[184:187], v21, s[4:7], s28 offen offset:2048 sc1
  v_mfma_f32_32x32x16_bf16 v[64:79], a[48:51], v[48:51], v[64:79]
  ds_read_b128 v[40:43], v12 offset:8192
  v_mfma_f32_32x32x16_bf16 v[80:95], a[52:55], v[48:51], v[80:95]
  s_waitcnt lgkmcnt(5)
  v_mfma_f32_32x32x16_bf16 v[64:79], a[56:59], v[52:55], v[64:79]
  ds_read_b128 v[44:47], v13 offset:8192
  v_mfma_f32_32x32x16_bf16 v[80:95], a[60:63], v[52:55], v[80:95]
  s_waitcnt lgkmcnt(5)
  buffer_load_dwordx4 v[188:191], v21, s[4:7], s28 offen offset:3072 sc1
  v_mfma_f32_32x32x16_bf16 v[64:79], a[64:67], v[24:27], v[64:79]
  s_add_u32 s29, s19, 67112960
  ds_read_b128 v[48:51], v14 offset:8192
  v_mfma_f32_32x32x16_bf16 v[80:95], a[68:71], v[24:27], v[80:95]
  s_waitcnt lgkmcnt(5)
  v_mfma_f32_32x32x16_bf16 v[64:79], a[72:75], v[28:31], v[64:79]
  ds_read_b128 v[52:55], v15 offset:8192
  v_mfma_f32_32x32x16_bf16 v[80:95], a[76:79], v[28:31], v[80:95]
  s_waitcnt lgkmcnt(5)
  buffer_load_dwordx4 v[192:195], v21, s[4:7], s29 offen offset:0 sc1
  v_mfma_f32_32x32x16_bf16 v[64:79], a[80:83], v[32:35], v[64:79]
  ds_read_b128 v[24:27], v8 offset:16384
  v_mfma_f32_32x32x16_bf16 v[80:95], a[84:87], v[32:35], v[80:95]
  s_waitcnt lgkmcnt(5)
  v_mfma_f32_32x32x16_bf16 v[64:79], a[88:91], v[36:39], v[64:79]
  ds_read_b128 v[28:31], v9 offset:16384
  v_mfma_f32_32x32x16_bf16 v[80:95], a[92:95], v[36:39], v[80:95]
  s_waitcnt lgkmcnt(5)
  buffer_load_dwordx4 v[196:199], v21, s[4:7], s29 offen offset:1024 sc1
  v_mfma_f32_32x32x16_bf16 v[64:79], a[96:99], v[40:43], v[64:79]
  ds_read_b128 v[32:35], v10 offset:16384
  v_mfma_f32_32x32x16_bf16 v[80:95], a[100:103], v[40:43], v[80:95]
  s_waitcnt lgkmcnt(5)
  v_mfma_f32_32x32x16_bf16 v[64:79], a[104:107], v[44:47], v[64:79]
  ds_read_b128 v[36:39], v11 offset:16384
  v_mfma_f32_32x32x16_bf16 v[80:95], a[108:111], v[44:47], v[80:95]
  s_waitcnt lgkmcnt(5)
  buffer_load_dwordx4 v[200:203], v21, s[4:7], s29 offen offset:2048 sc1
  v_mfma_f32_32x32x16_bf16 v[64:79], a[112:115], v[48:51], v[64:79]
  ds_read_b128 v[40:43], v12 offset:16384
  v_mfma_f32_32x32x16_bf16 v[80:95], a[116:119], v[48:51], v[80:95]
  s_waitcnt lgkmcnt(5)
  v_mfma_f32_32x32x16_bf16 v[64:79], a[120:123], v[52:55], v[64:79]
  ds_read_b128 v[44:47], v13 offset:16384
  v_mfma_f32_32x32x16_bf16 v[80:95], a[124:127], v[52:55], v[80:95]
  s_waitcnt lgkmcnt(5)
  buffer_load_dwordx4 v[204:207], v21, s[4:7], s29 offen offset:3072 sc1
  v_mfma_f32_32x32x16_bf16 v[64:79], a[128:131], v[24:27], v[64:79]
  s_add_u32 s28, s19, 83886080
  ds_read_b128 v[48:51], v14 offset:16384
  v_mfma_f32_32x32x16_bf16 v[80:95], a[132:135], v[24:27], v[80:95]
  s_waitcnt lgkmcnt(5)
  v_mfma_f32_32x32x16_bf16 v[64:79], a[136:139], v[28:31], v[64:79]
  ds_read_b128 v[52:55], v15 offset:16384
  v_mfma_f32_32x32x16_bf16 v[80:95], a[140:143], v[28:31], v[80:95]
  s_waitcnt lgkmcnt(5)
  buffer_load_dwordx4 v[208:211], v21, s[4:7], s28 offen offset:0 sc1
  v_mfma_f32_32x32x16_bf16 v[64:79], a[144:147], v[32:35], v[64:79]
  ds_read_b128 v[24:27], v8 offset:24576
  v_mfma_f32_32x32x16_bf16 v[80:95], a[148:151], v[32:35], v[80:95]
  s_waitcnt lgkmcnt(5)
  v_mfma_f32_32x32x16_bf16 v[64:79], a[152:155], v[36:39], v[64:79]
  ds_read_b128 v[28:31], v9 offset:24576
  v_mfma_f32_32x32x16_bf16 v[80:95], a[156:159], v[36:39], v[80:95]
  s_waitcnt lgkmcnt(5)
  buffer_load_dwordx4 v[212:215], v21, s[4:7], s28 offen offset:1024 sc1
  v_mfma_f32_32x32x16_bf16 v[64:79], a[160:163], v[40:43], v[64:79]
  ds_read_b128 v[32:35], v10 offset:24576
  v_mfma_f32_32x32x16_bf16 v[80:95], a[164:167], v[40:43], v[80:95]
  s_waitcnt lgkmcnt(5)
  v_mfma_f32_32x32x16_bf16 v[64:79], a[168:171], v[44:47], v[64:79]
  ds_read_b128 v[36:39], v11 offset:24576
  v_mfma_f32_32x32x16_bf16 v[80:95], a[172:175], v[44:47], v[80:95]
  s_waitcnt lgkmcnt(5)
  buffer_load_dwordx4 v[216:219], v21, s[4:7], s28 offen offset:2048 sc1
  v_mfma_f32_32x32x16_bf16 v[64:79], a[176:179], v[48:51], v[64:79]
  ds_read_b128 v[40:43], v12 offset:24576
  v_mfma_f32_32x32x16_bf16 v[80:95], a[180:183], v[48:51], v[80:95]
  s_waitcnt lgkmcnt(5)
  v_mfma_f32_32x32x16_bf16 v[64:79], a[184:187], v[52:55], v[64:79]
  ds_read_b128 v[44:47], v13 offset:24576
  v_mfma_f32_32x32x16_bf16 v[80:95], a[188:191], v[52:55], v[80:95]
  s_waitcnt lgkmcnt(5)
  buffer_load_dwordx4 v[220:223], v21, s[4:7], s28 offen offset:3072 sc1
  v_mfma_f32_32x32x16_bf16 v[64:79], a[192:195], v[24:27], v[64:79]
  s_add_u32 s29, s19, 83890176
  ds_read_b128 v[48:51], v14 offset:24576
  v_mfma_f32_32x32x16_bf16 v[80:95], a[196:199], v[24:27], v[80:95]
  s_waitcnt lgkmcnt(5)
  v_mfma_f32_32x32x16_bf16 v[64:79], a[200:203], v[28:31], v[64:79]
  ds_read_b128 v[52:55], v15 offset:24576
  v_mfma_f32_32x32x16_bf16 v[80:95], a[204:207], v[28:31], v[80:95]
  s_waitcnt lgkmcnt(5)
  buffer_load_dwordx4 v[224:227], v21, s[4:7], s29 offen offset:0 sc1
  v_mfma_f32_32x32x16_bf16 v[64:79], a[208:211], v[32:35], v[64:79]
  v_mfma_f32_32x32x16_bf16 v[80:95], a[212:215], v[32:35], v[80:95]
  s_waitcnt lgkmcnt(4)
  v_mfma_f32_32x32x16_bf16 v[64:79], a[216:219], v[36:39], v[64:79]
  v_xor_b32 v8, 0x8000, v8
  v_mfma_f32_32x32x16_bf16 v[80:95], a[220:223], v[36:39], v[80:95]
  s_waitcnt lgkmcnt(3)
  buffer_load_dwordx4 v[228:231], v21, s[4:7], s29 offen offset:1024 sc1
  v_xor_b32 v9, 0x8000, v9
  v_mfma_f32_32x32x16_bf16 v[64:79], a[224:227], v[40:43], v[64:79]
  v_xor_b32 v10, 0x8000, v10
  v_mfma_f32_32x32x16_bf16 v[80:95], a[228:231], v[40:43], v[80:95]
  s_waitcnt lgkmcnt(2)
  v_xor_b32 v11, 0x8000, v11
  v_mfma_f32_32x32x16_bf16 v[64:79], a[232:235], v[44:47], v[64:79]
  v_xor_b32 v12, 0x8000, v12
  v_mfma_f32_32x32x16_bf16 v[80:95], a[236:239], v[44:47], v[80:95]
  s_waitcnt lgkmcnt(1)
  buffer_load_dwordx4 v[232:235], v21, s[4:7], s29 offen offset:2048 sc1
  v_xor_b32 v13, 0x8000, v13
  v_mfma_f32_32x32x16_bf16 v[64:79], a[240:243], v[48:51], v[64:79]
  v_xor_b32 v14, 0x8000, v14
  v_mfma_f32_32x32x16_bf16 v[80:95], a[244:247], v[48:51], v[80:95]
  s_waitcnt lgkmcnt(0)
  v_xor_b32 v15, 0x8000, v15
  v_mfma_f32_32x32x16_bf16 v[64:79], a[248:251], v[52:55], v[64:79]
  v_xor_b32 v3, 0x8000, v3
  v_mfma_f32_32x32x16_bf16 v[80:95], a[252:255], v[52:55], v[80:95]
  buffer_load_dwordx4 v[236:239], v21, s[4:7], s29 offen offset:3072 sc1
  s_cmp_gt_u32 s23, 0
  s_cbranch_scc1 F_top_61
  s_nop 2
  v_cvt_pk_bf16_f32 v128, v64, v65
  v_cvt_pk_bf16_f32 v129, v66, v67
  v_cvt_pk_bf16_f32 v130, v68, v69
  v_cvt_pk_bf16_f32 v131, v70, v71
  buffer_store_dwordx4 v[128:131], v22, s[4:7], s21 offen offset:0 sc1
  v_cvt_pk_bf16_f32 v132, v72, v73
  v_cvt_pk_bf16_f32 v133, v74, v75
  v_cvt_pk_bf16_f32 v134, v76, v77
  v_cvt_pk_bf16_f32 v135, v78, v79
  buffer_store_dwordx4 v[132:135], v22, s[4:7], s21 offen offset:1024 sc1
  v_cvt_pk_bf16_f32 v136, v80, v81
  v_cvt_pk_bf16_f32 v137, v82, v83
  v_cvt_pk_bf16_f32 v138, v84, v85
  v_cvt_pk_bf16_f32 v139, v86, v87
  buffer_store_dwordx4 v[136:139], v22, s[4:7], s21 offen offset:2048 sc1
  v_cvt_pk_bf16_f32 v140, v88, v89
  v_cvt_pk_bf16_f32 v141, v90, v91
  v_cvt_pk_bf16_f32 v142, v92, v93
  v_cvt_pk_bf16_f32 v143, v94, v95
  buffer_store_dwordx4 v[140:143], v22, s[4:7], s21 offen offset:3072 sc1
  s_waitcnt vmcnt(0) lgkmcnt(0)
  s_barrier
  v_mov_b32 v144, s30
  v_min_u32 v145, 1, v0
  v_lshlrev_b32 v145, 30, v145
  buffer_store_dword v144, v145, s[4:7], s31 offen sc1
  s_branch M_done
M_team:
  s_mov_b32 s12, s77
  s_load_dwordx4 s[60:63], s[0:1], 64
  s_load_dwordx4 s[64:67], s[0:1], 80
  s_load_dwordx4 s[68:71], s[0:1], 120
  s_load_dwordx2 s[72:73], s[0:1], 56
  v_lshrrev_b32 v1, 6, v0
  v_and_b32 v20, 63, v0
  v_readfirstlane_b32 s13, v1
  s_waitcnt lgkmcnt(0)
  s_mov_b32 s8, s60
  s_and_b32 s9, s61, 0xffff
  s_mov_b32 s10, 0x400000
  s_mov_b32 s11, 0x20000
  s_mov_b32 s40, s62
  s_and_b32 s41, s63, 0xffff
  s_mov_b32 s42, 0x400000
  s_mov_b32 s43, 0x20000
  s_mov_b32 s44, s64
  s_and_b32 s45, s65, 0xffff
  s_mov_b32 s46, 0x400000
  s_mov_b32 s47, 0x20000
  s_mov_b32 s48, s66
  s_and_b32 s49, s67, 0xffff
  s_mov_b32 s50, 0x400000
  s_mov_b32 s51, 0x20000
  s_mov_b32 s4, s70
  s_and_b32 s5, s71, 0xffff
  s_mov_b32 s6, 0x10000000
  s_mov_b32 s7, 0x20000
  s_mov_b32 s76, s72
  s_and_b32 s77, s73, 0xffff
  s_mov_b32 s78, 0x2000
  s_mov_b32 s79, 0x20000
  s_mov_b32 s72, s68
  s_and_b32 s73, s69, 0xffff
  s_mov_b32 s74, 0x100
  s_mov_b32 s75, 0x20000
  s_mov_b64 s[52:53], s[68:69]
  s_mov_b64 s[58:59], s[70:71]
  s_lshl_b32 s15, s12, 7
  s_add_u32 s15, s15, 148926464
  v_lshrrev_b32 v21, 4, v20
  v_and_b32 v22, 15, v20
  v_and_b32 v23, 1, v21
  v_lshrrev_b32 v24, 1, v21
  v_lshlrev_b32 v2, 4, v20
  s_lshl_b32 s36, s13, 10
  v_add_u32 v3, s36, v2
  s_lshl_b32 s37, s13, 15
  s_add_u32 s37, s37, 32768
  v_add_u32 v4, s37, v2
  v_lshrrev_b32 v25, 2, v20
  v_lshlrev_b32 v25, 13, v25
  v_and_b32 v1, 3, v20
  v_lshl_add_u32 v25, v1, 4, v25
  s_lshl_b32 s36, s13, 6
  s_lshl_b32 s38, s12, 8
  s_add_u32 s36, s36, s38
  v_add_u32 v25, s36, v25
  v_lshrrev_b32 v26, 3, v20
  v_lshlrev_b32 v26, 10, v26
  v_and_b32 v1, 7, v20
  v_lshl_add_u32 v26, v1, 4, v26
  s_lshl_b32 s36, s13, 7
  s_lshl_b32 s38, s12, 17
  s_add_u32 s36, s36, s38
  v_add_u32 v26, s36, v26
  v_bfe_u32 v29, v20, 2, 1
  v_bfe_u32 v30, v20, 3, 1
  v_and_b32 v31, 3, v20
  v_lshl_add_u32 v27, v24, 1, v29
  v_lshl_add_u32 v27, v27, 1, v23
  v_lshlrev_b32 v27, 7, v27
  v_lshl_add_u32 v27, v30, 5, v27
  v_lshl_add_u32 v27, v31, 3, v27
  v_add_u32 v27, s37, v27
  v_lshl_add_u32 v28, v23, 2, v24
  v_lshl_add_u32 v28, v28, 2, v29
  v_lshlrev_b32 v28, 7, v28
  v_lshl_add_u32 v28, v30, 6, v28
  v_lshl_add_u32 v28, v31, 4, v28
  v_add_u32 v28, s37, v28
  s_mov_b32 s39, s37
  s_add_u32 m0, s39, 0
  s_mov_b32 s37, 524288
  buffer_load_dwordx4 v25, s[8:11], s37 offen lds
  s_add_u32 m0, s39, 1024
  s_mov_b32 s37, 655360
  buffer_load_dwordx4 v25, s[8:11], s37 offen lds
  s_add_u32 m0, s39, 2048
  s_mov_b32 s37, 524288
  buffer_load_dwordx4 v25, s[40:43], s37 offen lds
  s_add_u32 m0, s39, 3072
  s_mov_b32 s37, 655360
  buffer_load_dwordx4 v25, s[40:43], s37 offen lds
  s_add_u32 m0, s39, 4096
  s_mov_b32 s37, 524288
  buffer_load_dwordx4 v25, s[44:47], s37 offen lds
  s_add_u32 m0, s39, 5120
  s_mov_b32 s37, 655360
  buffer_load_dwordx4 v25, s[44:47], s37 offen lds
  s_add_u32 m0, s39, 6144
  s_mov_b32 s37, 786432
  buffer_load_dwordx4 v25, s[8:11], s37 offen lds
  s_add_u32 m0, s39, 7168
  s_mov_b32 s37, 917504
  buffer_load_dwordx4 v25, s[8:11], s37 offen lds
  v_mov_b32 v0, 0x4444
  v_mov_b32 v1, 0xeeee
  v_cmp_lt_u32 vcc, 7, v22
  s_nop 1
  v_cndmask_b32 v32, v0, v1, vcc
  v_mov_b32 v0, v32
  v_and_b32 v32, 7, v20
  v_lshlrev_b32 v32, 4, v32
  v_lshl_add_u32 v1, v21, 7, v32
  s_lshl_b32 s36, s13, 9
  v_add_u32 v11, s36, v1
  v_lshl_add_u32 v33, v24, 4, v22
  s_lshl_b32 s36, s13, 5
  v_add_u32 v33, s36, v33
  v_lshlrev_b32 v33, 3, v33
  v_mul_u32_u24 v34, 1152, v23
  v_add_u32 v5, v33, v34
  v_bfe_u32 v33, v20, 2, 2
  v_lshl_add_u32 v33, v23, 2, v33
  v_lshl_add_u32 v33, v24, 4, v33
  v_lshlrev_b32 v33, 3, v33
  v_and_b32 v34, 1, v20
  v_mul_u32_u24 v34, 1152, v34
  v_add_u32 v6, v33, v34
  s_lshl_b32 s36, s13, 3
  v_lshrrev_b32 v33, 3, v20
  v_add_u32 v33, s36, v33
  v_mul_u32_u24 v34, 0, v33
  v_add_u32 v34, s12, v34
  v_and_b32 v34, 31, v34
  v_lshl_add_u32 v33, v33, 13, v32
  v_lshl_add_u32 v7, v34, 7, v33
  s_lshr_b32 s36, s12, 2
  s_lshl_b32 s36, s36, 9
  s_and_b32 s37, s12, 1
  s_lshl_b32 s37, s37, 8
  s_add_u32 s36, s36, s37
  s_and_b32 s37, s12, 2
  s_lshl_b32 s37, s37, 5
  s_add_u32 s36, s36, s37
  v_lshlrev_b32 v33, 4, v21
  v_lshl_add_u32 v33, v31, 2, v33
  v_lshl_add_u32 v33, v29, 7, v33
  v_lshl_add_u32 v33, v30, 30, v33
  v_add_u32 v8, s36, v33
  s_lshr_b32 s36, s12, 2
  s_lshl_b32 s36, s36, 6
  s_and_b32 s37, s12, 1
  s_lshl_b32 s37, s37, 5
  s_add_u32 s36, s36, s37
  s_and_b32 s37, s12, 2
  s_lshl_b32 s37, s37, 11
  s_add_u32 s36, s36, s37
  v_lshlrev_b32 v35, 10, v21
  v_lshl_add_u32 v35, v31, 1, v35
  v_lshl_add_u32 v35, v29, 4, v35
  v_add_u32 v35, s36, v35
  buffer_load_ushort v44, v35, s[76:79], 0 offen offset:0
  buffer_load_ushort v45, v35, s[76:79], 0 offen offset:8
  buffer_load_ushort v46, v35, s[76:79], 0 offen offset:512
  buffer_load_ushort v47, v35, s[76:79], 0 offen offset:520
  v_lshlrev_b32 v33, 4, v29
  v_mov_b32 v34, 0x3f80
  v_lshlrev_b32 v33, v33, v34
  v_and_b32 v34, 1, v20
  v_lshl_add_u32 v34, v34, 1, v30
  v_cmp_eq_u32 vcc, 0, v34
  s_nop 1
  v_cndmask_b32 v48, 0, v33, vcc
  v_cmp_eq_u32 vcc, 1, v34
  s_nop 1
  v_cndmask_b32 v49, 0, v33, vcc
  v_cmp_eq_u32 vcc, 2, v34
  s_nop 1
  v_cndmask_b32 v50, 0, v33, vcc
  v_cmp_eq_u32 vcc, 3, v34
  s_nop 1
  v_cndmask_b32 v51, 0, v33, vcc
  ds_write_b128 v2, v[48:51] offset:31232
  v_lshlrev_b32 v33, 9, v21
  s_lshl_b32 s36, s13, 11
  v_add_u32 v33, s36, v33
  v_lshl_add_u32 v10, v22, 4, v33
  v_lshl_add_u32 v33, v30, 8, v33
  v_add_u32 v9, v33, v32
  s_mov_b32 s2, 0x3f803f80
  s_mov_b32 s3, 0x3f803f80
  s_mov_b32 s16, 0
  s_mov_b32 s17, -1
  s_mov_b32 s18, 0x3e0293ee
  s_mov_b32 s54, 0x2f800000
  s_mov_b32 s55, 0x28000000
  s_lshl_b32 s36, s13, 10
  s_add_u32 s31, s36, 8192
  s_add_u32 s32, s36, 12160
  s_add_u32 s33, s36, 16384
  s_add_u32 s34, s36, 20224
  s_lshl_b32 s36, s12, 19
  s_add_u32 s27, s36, 67108864
  s_add_u32 s28, s36, 83886080
  s_mul_i32 s36, s12, 4608
  s_add_u32 s29, s36, 134217728
  s_lshl_b32 s36, s12, 13
  s_add_u32 s22, s36, 144703488
  s_add_u32 s23, s36, 144707584
  s_mov_b32 s20, 144703488
  s_mov_b32 s21, 144707584
  v_mov_b32 v40, -1
  v_mov_b32 v41, -1
  v_mov_b32 v42, -1
  v_mov_b32 v43, -1
  s_lshl_b32 s36, s13, 13
  s_add_u32 s36, s36, 145752064
  s_add_u32 s37, s36, 4096
  buffer_store_dwordx4 v[40:43], v3, s[4:7], s22 offen sc1
  buffer_store_dwordx4 v[40:43], v3, s[4:7], s23 offen sc1
  buffer_store_dword v40, v8, s[4:7], s36 offen sc1
  buffer_store_dword v40, v8, s[4:7], s37 offen sc1
  v_mov_b32 v52, 0
  v_min_u32 v53, 1, v3
  v_lshlrev_b32 v53, 30, v53
  buffer_store_dword v52, v53, s[4:7], s15 offen sc1
  s_add_u32 m0, s39, 8192
  s_mov_b32 s37, 786432
  buffer_load_dwordx4 v25, s[40:43], s37 offen lds
  s_add_u32 m0, s39, 9216
  s_mov_b32 s37, 917504
  buffer_load_dwordx4 v25, s[40:43], s37 offen lds
  s_add_u32 m0, s39, 10240
  s_mov_b32 s37, 1048576
  buffer_load_dwordx4 v25, s[8:11], s37 offen lds
  s_add_u32 m0, s39, 11264
  s_mov_b32 s37, 1179648
  buffer_load_dwordx4 v25, s[8:11], s37 offen lds
  s_add_u32 m0, s39, 12288
  s_mov_b32 s37, 1048576
  buffer_load_dwordx4 v25, s[40:43], s37 offen lds
  s_add_u32 m0, s39, 13312
  s_mov_b32 s37, 1179648
  buffer_load_dwordx4 v25, s[40:43], s37 offen lds
  s_add_u32 m0, s39, 14336
  s_mov_b32 s37, 1048576
  buffer_load_dwordx4 v25, s[44:47], s37 offen lds
  s_add_u32 m0, s39, 15360
  s_mov_b32 s37, 1179648
  buffer_load_dwordx4 v25, s[44:47], s37 offen lds
  s_add_u32 m0, s39, 16384
  s_mov_b32 s37, 1310720
  buffer_load_dwordx4 v25, s[8:11], s37 offen lds
  s_add_u32 m0, s39, 17408
  s_mov_b32 s37, 1441792
  buffer_load_dwordx4 v25, s[8:11], s37 offen lds
  s_add_u32 m0, s39, 18432
  s_mov_b32 s37, 1310720
  buffer_load_dwordx4 v25, s[40:43], s37 offen lds
  s_add_u32 m0, s39, 19456
  s_mov_b32 s37, 1441792
  buffer_load_dwordx4 v25, s[40:43], s37 offen lds
  s_add_u32 m0, s39, 20480
  s_mov_b32 s37, 1572864
  buffer_load_dwordx4 v25, s[8:11], s37 offen lds
  s_add_u32 m0, s39, 21504
  s_mov_b32 s37, 1703936
  buffer_load_dwordx4 v25, s[8:11], s37 offen lds
  s_add_u32 m0, s39, 22528
  s_mov_b32 s37, 1835008
  buffer_load_dwordx4 v25, s[8:11], s37 offen lds
  s_add_u32 m0, s39, 23552
  s_mov_b32 s37, 1966080
  buffer_load_dwordx4 v25, s[8:11], s37 offen lds
  s_add_u32 m0, s39, 24576
  s_mov_b32 s37, 1835008
  buffer_load_dwordx4 v25, s[40:43], s37 offen lds
  s_add_u32 m0, s39, 25600
  s_mov_b32 s37, 1966080
  buffer_load_dwordx4 v25, s[40:43], s37 offen lds
  s_add_u32 m0, s39, 26624
  s_mov_b32 s37, 1835008
  buffer_load_dwordx4 v25, s[44:47], s37 offen lds
  s_add_u32 m0, s39, 27648
  s_mov_b32 s37, 1966080
  buffer_load_dwordx4 v25, s[44:47], s37 offen lds
  s_add_u32 m0, s39, 28672
  s_mov_b32 s37, 2097152
  buffer_load_dwordx4 v25, s[8:11], s37 offen lds
  s_add_u32 m0, s39, 29696
  s_mov_b32 s37, 2228224
  buffer_load_dwordx4 v25, s[8:11], s37 offen lds
  s_add_u32 m0, s39, 30720
  s_mov_b32 s37, 2097152
  buffer_load_dwordx4 v25, s[40:43], s37 offen lds
  s_add_u32 m0, s39, 31744
  s_mov_b32 s37, 2228224
  buffer_load_dwordx4 v25, s[40:43], s37 offen lds
  s_waitcnt vmcnt(37)
  ds_read_b64_tr_b16 v[128:129], v27 offset:0
  ds_read_b64_tr_b16 v[130:131], v27 offset:64
  ds_read_b64_tr_b16 v[132:133], v27 offset:1024
  ds_read_b64_tr_b16 v[134:135], v27 offset:1088
  ds_read_b64_tr_b16 v[136:137], v27 offset:2048
  ds_read_b64_tr_b16 v[138:139], v27 offset:2112
  ds_read_b64_tr_b16 v[140:141], v27 offset:3072
  ds_read_b64_tr_b16 v[142:143], v27 offset:3136
  s_waitcnt lgkmcnt(0)
  s_add_u32 m0, s39, 0
  s_mov_b32 s37, 2097152
  buffer_load_dwordx4 v25, s[44:47], s37 offen lds
  s_add_u32 m0, s39, 1024
  s_mov_b32 s37, 2228224
  buffer_load_dwordx4 v25, s[44:47], s37 offen lds
  s_add_u32 m0, s39, 2048
  s_mov_b32 s37, 2359296
  buffer_load_dwordx4 v25, s[8:11], s37 offen lds
  s_add_u32 m0, s39, 3072
  s_mov_b32 s37, 2490368
  buffer_load_dwordx4 v25, s[8:11], s37 offen lds
  s_waitcnt vmcnt(37)
  ds_read_b64_tr_b16 v[144:145], v27 offset:4096
  ds_read_b64_tr_b16 v[146:147], v27 offset:4160
  ds_read_b64_tr_b16 v[148:149], v27 offset:5120
  ds_read_b64_tr_b16 v[150:151], v27 offset:5184
  ds_read_b64_tr_b16 v[152:153], v27 offset:6144
  ds_read_b64_tr_b16 v[154:155], v27 offset:6208
  ds_read_b64_tr_b16 v[156:157], v27 offset:7168
  ds_read_b64_tr_b16 v[158:159], v27 offset:7232
  s_waitcnt lgkmcnt(0)
  s_add_u32 m0, s39, 4096
  s_mov_b32 s37, 2359296
  buffer_load_dwordx4 v25, s[44:47], s37 offen lds
  s_add_u32 m0, s39, 5120
  s_mov_b32 s37, 2490368
  buffer_load_dwordx4 v25, s[44:47], s37 offen lds
  s_add_u32 m0, s39, 6144
  s_mov_b32 s37, 2621440
  buffer_load_dwordx4 v25, s[8:11], s37 offen lds
  s_add_u32 m0, s39, 7168
  s_mov_b32 s37, 2752512
  buffer_load_dwordx4 v25, s[8:11], s37 offen lds
  s_waitcnt vmcnt(28)
  ds_read_b64_tr_b16 v[160:161], v27 offset:8192
  ds_read_b64_tr_b16 v[162:163], v27 offset:8256
  ds_read_b64_tr_b16 v[164:165], v27 offset:9216
  ds_read_b64_tr_b16 v[166:167], v27 offset:9280
  ds_read_b64_tr_b16 v[168:169], v27 offset:10240
  ds_read_b64_tr_b16 v[170:171], v27 offset:10304
  ds_read_b64_tr_b16 v[172:173], v27 offset:11264
  ds_read_b64_tr_b16 v[174:175], v27 offset:11328
  s_waitcnt lgkmcnt(0)
  s_add_u32 m0, s39, 8192
  s_mov_b32 s37, 2621440
  buffer_load_dwordx4 v25, s[40:43], s37 offen lds
  s_add_u32 m0, s39, 9216
  s_mov_b32 s37, 2752512
  buffer_load_dwordx4 v25, s[40:43], s37 offen lds
  s_add_u32 m0, s39, 10240
  s_mov_b32 s37, 2621440
  buffer_load_dwordx4 v25, s[44:47], s37 offen lds
  s_add_u32 m0, s39, 11264
  s_mov_b32 s37, 2752512
  buffer_load_dwordx4 v25, s[44:47], s37 offen lds
  s_barrier
  s_cmp_lg_u32 s13, 0
  s_cbranch_scc1 T_arm_66
  s_getreg_b32 s36, hwreg(HW_REG_XCC_ID, 0, 3)
  s_lshl_b32 s36, s36, 3
  s_lshl_b64 s[60:61], 1, s36
  s_mov_b32 s62, 1
  s_atomic_add_x2 s[60:61], s[52:53], 0
  s_atomic_add s62, s[52:53], 128
  v_lshl_or_b32 v44, v45, 16, v44
  v_lshl_or_b32 v46, v47, 16, v46
  v_min_u32 v44, -2, v44
  v_min_u32 v46, -2, v46
  s_mov_b32 s36, 145752064
  s_mov_b32 s37, 145756160
  buffer_store_dword v44, v8, s[4:7], s36 offen sc1
  buffer_store_dword v46, v8, s[4:7], s37 offen sc1
T_arm_66:
  s_waitcnt vmcnt(28)
  ds_read_b64_tr_b16 v[176:177], v27 offset:12288
  ds_read_b64_tr_b16 v[178:179], v27 offset:12352
  ds_read_b64_tr_b16 v[180:181], v27 offset:13312
  ds_read_b64_tr_b16 v[182:183], v27 offset:13376
  ds_read_b64_tr_b16 v[184:185], v27 offset:14336
  ds_read_b64_tr_b16 v[186:187], v27 offset:14400
  ds_read_b64_tr_b16 v[188:189], v27 offset:15360
  ds_read_b64_tr_b16 v[190:191], v27 offset:15424
  s_waitcnt lgkmcnt(0)
  s_add_u32 m0, s39, 12288
  s_mov_b32 s37, 2883584
  buffer_load_dwordx4 v25, s[8:11], s37 offen lds
  s_add_u32 m0, s39, 13312
  s_mov_b32 s37, 3014656
  buffer_load_dwordx4 v25, s[8:11], s37 offen lds
  s_add_u32 m0, s39, 14336
  s_mov_b32 s37, 2883584
  buffer_load_dwordx4 v25, s[40:43], s37 offen lds
  s_add_u32 m0, s39, 15360
  s_mov_b32 s37, 3014656
  buffer_load_dwordx4 v25, s[40:43], s37 offen lds
  s_waitcnt vmcnt(28)
  ds_read_b64_tr_b16 v[192:193], v27 offset:16384
  ds_read_b64_tr_b16 v[194:195], v27 offset:16448
  ds_read_b64_tr_b16 v[196:197], v27 offset:17408
  ds_read_b64_tr_b16 v[198:199], v27 offset:17472
  ds_read_b64_tr_b16 v[200:201], v27 offset:18432
  ds_read_b64_tr_b16 v[202:203], v27 offset:18496
  ds_read_b64_tr_b16 v[204:205], v27 offset:19456
  ds_read_b64_tr_b16 v[206:207], v27 offset:19520
  s_waitcnt lgkmcnt(0)
  s_add_u32 m0, s39, 16384
  s_mov_b32 s37, 2883584
  buffer_load_dwordx4 v25, s[44:47], s37 offen lds
  s_add_u32 m0, s39, 17408
  s_mov_b32 s37, 3014656
  buffer_load_dwordx4 v25, s[44:47], s37 offen lds
  s_add_u32 m0, s39, 18432
  s_mov_b32 s37, 3145728
  buffer_load_dwordx4 v25, s[8:11], s37 offen lds
  s_add_u32 m0, s39, 19456
  s_mov_b32 s37, 3276800
  buffer_load_dwordx4 v25, s[8:11], s37 offen lds
  s_waitcnt vmcnt(28)
  ds_read_b64_tr_b16 v[208:209], v27 offset:20480
  ds_read_b64_tr_b16 v[210:211], v27 offset:20544
  ds_read_b64_tr_b16 v[212:213], v27 offset:21504
  ds_read_b64_tr_b16 v[214:215], v27 offset:21568
  ds_read_b64_tr_b16 v[216:217], v27 offset:22528
  ds_read_b64_tr_b16 v[218:219], v27 offset:22592
  ds_read_b64_tr_b16 v[220:221], v27 offset:23552
  ds_read_b64_tr_b16 v[222:223], v27 offset:23616
  s_waitcnt lgkmcnt(0)
  s_add_u32 m0, s39, 20480
  s_mov_b32 s37, 3145728
  buffer_load_dwordx4 v25, s[40:43], s37 offen lds
  s_add_u32 m0, s39, 21504
  s_mov_b32 s37, 3276800
  buffer_load_dwordx4 v25, s[40:43], s37 offen lds
  s_add_u32 m0, s39, 22528
  s_mov_b32 s37, 3145728
  buffer_load_dwordx4 v25, s[44:47], s37 offen lds
  s_add_u32 m0, s39, 23552
  s_mov_b32 s37, 3276800
  buffer_load_dwordx4 v25, s[44:47], s37 offen lds
  s_waitcnt vmcnt(28)
  ds_read_b64_tr_b16 v[224:225], v27 offset:24576
  ds_read_b64_tr_b16 v[226:227], v27 offset:24640
  ds_read_b64_tr_b16 v[228:229], v27 offset:25600
  ds_read_b64_tr_b16 v[230:231], v27 offset:25664
  ds_read_b64_tr_b16 v[232:233], v27 offset:26624
  ds_read_b64_tr_b16 v[234:235], v27 offset:26688
  ds_read_b64_tr_b16 v[236:237], v27 offset:27648
  ds_read_b64_tr_b16 v[238:239], v27 offset:27712
  s_waitcnt lgkmcnt(0)
  s_add_u32 m0, s39, 24576
  s_mov_b32 s37, 3407872
  buffer_load_dwordx4 v25, s[8:11], s37 offen lds
  s_add_u32 m0, s39, 25600
  s_mov_b32 s37, 3538944
  buffer_load_dwordx4 v25, s[8:11], s37 offen lds
  s_add_u32 m0, s39, 26624
  s_mov_b32 s37, 3407872
  buffer_load_dwordx4 v25, s[44:47], s37 offen lds
  s_add_u32 m0, s39, 27648
  s_mov_b32 s37, 3538944
  buffer_load_dwordx4 v25, s[44:47], s37 offen lds
  s_waitcnt vmcnt(28)
  ds_read_b64_tr_b16 v[240:241], v27 offset:28672
  ds_read_b64_tr_b16 v[242:243], v27 offset:28736
  ds_read_b64_tr_b16 v[244:245], v27 offset:29696
  ds_read_b64_tr_b16 v[246:247], v27 offset:29760
  ds_read_b64_tr_b16 v[248:249], v27 offset:30720
  ds_read_b64_tr_b16 v[250:251], v27 offset:30784
  ds_read_b64_tr_b16 v[252:253], v27 offset:31744
  ds_read_b64_tr_b16 v[254:255], v27 offset:31808
  s_waitcnt lgkmcnt(0)
  s_add_u32 m0, s39, 28672
  s_mov_b32 s37, 3670016
  buffer_load_dwordx4 v25, s[8:11], s37 offen lds
  s_add_u32 m0, s39, 29696
  s_mov_b32 s37, 3801088
  buffer_load_dwordx4 v25, s[8:11], s37 offen lds
  s_add_u32 m0, s39, 30720
  s_mov_b32 s37, 3670016
  buffer_load_dwordx4 v25, s[40:43], s37 offen lds
  s_add_u32 m0, s39, 31744
  s_mov_b32 s37, 3801088
  buffer_load_dwordx4 v25, s[40:43], s37 offen lds
  s_waitcnt vmcnt(28)
  ds_read_b64_tr_b16 a[0:1], v27 offset:0
  ds_read_b64_tr_b16 a[2:3], v27 offset:64
  ds_read_b64_tr_b16 a[4:5], v27 offset:1024
  ds_read_b64_tr_b16 a[6:7], v27 offset:1088
  ds_read_b64_tr_b16 a[8:9], v27 offset:2048
  ds_read_b64_tr_b16 a[10:11], v27 offset:2112
  ds_read_b64_tr_b16 a[12:13], v27 offset:3072
  ds_read_b64_tr_b16 a[14:15], v27 offset:3136
  s_waitcnt lgkmcnt(0)
  s_add_u32 m0, s39, 0
  s_mov_b32 s37, 3670016
  buffer_load_dwordx4 v25, s[44:47], s37 offen lds
  s_add_u32 m0, s39, 1024
  s_mov_b32 s37, 3801088
  buffer_load_dwordx4 v25, s[44:47], s37 offen lds
  s_add_u32 m0, s39, 2048
  s_mov_b32 s37, 3932160
  buffer_load_dwordx4 v25, s[8:11], s37 offen lds
  s_add_u32 m0, s39, 3072
  s_mov_b32 s37, 4063232
  buffer_load_dwordx4 v25, s[8:11], s37 offen lds
  s_waitcnt vmcnt(28)
  ds_read_b64_tr_b16 a[16:17], v27 offset:4096
  ds_read_b64_tr_b16 a[18:19], v27 offset:4160
  ds_read_b64_tr_b16 a[20:21], v27 offset:5120
  ds_read_b64_tr_b16 a[22:23], v27 offset:5184
  ds_read_b64_tr_b16 a[24:25], v27 offset:6144
  ds_read_b64_tr_b16 a[26:27], v27 offset:6208
  ds_read_b64_tr_b16 a[28:29], v27 offset:7168
  ds_read_b64_tr_b16 a[30:31], v27 offset:7232
  s_waitcnt lgkmcnt(0)
  s_add_u32 m0, s39, 4096
  s_mov_b32 s37, 3932160
  buffer_load_dwordx4 v25, s[40:43], s37 offen lds
  s_add_u32 m0, s39, 5120
  s_mov_b32 s37, 4063232
  buffer_load_dwordx4 v25, s[40:43], s37 offen lds
  s_add_u32 m0, s39, 6144
  s_mov_b32 s37, 3932160
  buffer_load_dwordx4 v25, s[44:47], s37 offen lds
  s_add_u32 m0, s39, 7168
  s_mov_b32 s37, 4063232
  buffer_load_dwordx4 v25, s[44:47], s37 offen lds
  s_waitcnt vmcnt(28)
  ds_read_b64_tr_b16 a[32:33], v27 offset:8192
  ds_read_b64_tr_b16 a[34:35], v27 offset:8256
  ds_read_b64_tr_b16 a[36:37], v27 offset:9216
  ds_read_b64_tr_b16 a[38:39], v27 offset:9280
  ds_read_b64_tr_b16 a[40:41], v27 offset:10240
  ds_read_b64_tr_b16 a[42:43], v27 offset:10304
  ds_read_b64_tr_b16 a[44:45], v27 offset:11264
  ds_read_b64_tr_b16 a[46:47], v27 offset:11328
  s_waitcnt lgkmcnt(0)
  s_xor_b32 s36, s13, 0
  s_lshl_b32 s36, s36, 15
  s_add_u32 m0, s39, 8192
  s_add_u32 s37, s36, 0
  buffer_load_dwordx4 v26, s[48:51], s37 offen lds
  s_add_u32 m0, s39, 9216
  s_add_u32 s37, s36, 8192
  buffer_load_dwordx4 v26, s[48:51], s37 offen lds
  s_add_u32 m0, s39, 10240
  s_add_u32 s37, s36, 16384
  buffer_load_dwordx4 v26, s[48:51], s37 offen lds
  s_add_u32 m0, s39, 11264
  s_add_u32 s37, s36, 24576
  buffer_load_dwordx4 v26, s[48:51], s37 offen lds
  s_waitcnt vmcnt(28)
  ds_read_b64_tr_b16 a[48:49], v27 offset:12288
  ds_read_b64_tr_b16 a[50:51], v27 offset:12352
  ds_read_b64_tr_b16 a[52:53], v27 offset:13312
  ds_read_b64_tr_b16 a[54:55], v27 offset:13376
  ds_read_b64_tr_b16 a[56:57], v27 offset:14336
  ds_read_b64_tr_b16 a[58:59], v27 offset:14400
  ds_read_b64_tr_b16 a[60:61], v27 offset:15360
  ds_read_b64_tr_b16 a[62:63], v27 offset:15424
  s_waitcnt lgkmcnt(0)
  s_xor_b32 s36, s13, 0
  s_lshl_b32 s36, s36, 15
  s_add_u32 m0, s39, 12288
  s_add_u32 s37, s36, 512
  buffer_load_dwordx4 v26, s[48:51], s37 offen lds
  s_add_u32 m0, s39, 13312
  s_add_u32 s37, s36, 8704
  buffer_load_dwordx4 v26, s[48:51], s37 offen lds
  s_add_u32 m0, s39, 14336
  s_add_u32 s37, s36, 16896
  buffer_load_dwordx4 v26, s[48:51], s37 offen lds
  s_add_u32 m0, s39, 15360
  s_add_u32 s37, s36, 25088
  buffer_load_dwordx4 v26, s[48:51], s37 offen lds
  s_waitcnt vmcnt(28)
  ds_read_b64_tr_b16 a[64:65], v27 offset:16384
  ds_read_b64_tr_b16 a[66:67], v27 offset:16448
  ds_read_b64_tr_b16 a[68:69], v27 offset:17408
  ds_read_b64_tr_b16 a[70:71], v27 offset:17472
  ds_read_b64_tr_b16 a[72:73], v27 offset:18432
  ds_read_b64_tr_b16 a[74:75], v27 offset:18496
  ds_read_b64_tr_b16 a[76:77], v27 offset:19456
  ds_read_b64_tr_b16 a[78:79], v27 offset:19520
  s_waitcnt lgkmcnt(0)
  s_xor_b32 s36, s13, 1
  s_lshl_b32 s36, s36, 15
  s_add_u32 m0, s39, 16384
  s_add_u32 s37, s36, 0
  buffer_load_dwordx4 v26, s[48:51], s37 offen lds
  s_add_u32 m0, s39, 17408
  s_add_u32 s37, s36, 8192
  buffer_load_dwordx4 v26, s[48:51], s37 offen lds
  s_add_u32 m0, s39, 18432
  s_add_u32 s37, s36, 16384
  buffer_load_dwordx4 v26, s[48:51], s37 offen lds
  s_add_u32 m0, s39, 19456
  s_add_u32 s37, s36, 24576
  buffer_load_dwordx4 v26, s[48:51], s37 offen lds
  s_waitcnt vmcnt(28)
  ds_read_b64_tr_b16 a[80:81], v27 offset:20480
  ds_read_b64_tr_b16 a[82:83], v27 offset:20544
  ds_read_b64_tr_b16 a[84:85], v27 offset:21504
  ds_read_b64_tr_b16 a[86:87], v27 offset:21568
  ds_read_b64_tr_b16 a[88:89], v27 offset:22528
  ds_read_b64_tr_b16 a[90:91], v27 offset:22592
  ds_read_b64_tr_b16 a[92:93], v27 offset:23552
  ds_read_b64_tr_b16 a[94:95], v27 offset:23616
  s_waitcnt lgkmcnt(0)
  s_xor_b32 s36, s13, 1
  s_lshl_b32 s36, s36, 15
  s_add_u32 m0, s39, 20480
  s_add_u32 s37, s36, 512
  buffer_load_dwordx4 v26, s[48:51], s37 offen lds
  s_add_u32 m0, s39, 21504
  s_add_u32 s37, s36, 8704
  buffer_load_dwordx4 v26, s[48:51], s37 offen lds
  s_add_u32 m0, s39, 22528
  s_add_u32 s37, s36, 16896
  buffer_load_dwordx4 v26, s[48:51], s37 offen lds
  s_add_u32 m0, s39, 23552
  s_add_u32 s37, s36, 25088
  buffer_load_dwordx4 v26, s[48:51], s37 offen lds
  s_waitcnt vmcnt(28)
  ds_read_b64_tr_b16 a[96:97], v27 offset:24576
  ds_read_b64_tr_b16 a[98:99], v27 offset:24640
  ds_read_b64_tr_b16 a[100:101], v27 offset:25600
  ds_read_b64_tr_b16 a[102:103], v27 offset:25664
  ds_read_b64_tr_b16 a[104:105], v27 offset:26624
  ds_read_b64_tr_b16 a[106:107], v27 offset:26688
  ds_read_b64_tr_b16 a[108:109], v27 offset:27648
  ds_read_b64_tr_b16 a[110:111], v27 offset:27712
  s_waitcnt lgkmcnt(0)
  s_xor_b32 s36, s13, 2
  s_lshl_b32 s36, s36, 15
  s_add_u32 m0, s39, 24576
  s_add_u32 s37, s36, 0
  buffer_load_dwordx4 v26, s[48:51], s37 offen lds
  s_add_u32 m0, s39, 25600
  s_add_u32 s37, s36, 8192
  buffer_load_dwordx4 v26, s[48:51], s37 offen lds
  s_add_u32 m0, s39, 26624
  s_add_u32 s37, s36, 16384
  buffer_load_dwordx4 v26, s[48:51], s37 offen lds
  s_add_u32 m0, s39, 27648
  s_add_u32 s37, s36, 24576
  buffer_load_dwordx4 v26, s[48:51], s37 offen lds
  buffer_load_dwordx2 v[54:55], off, s[72:75], 0 sc1
  buffer_load_dword v56, off, s[72:75], 0 offset:128 sc1
  s_waitcnt vmcnt(30)
  ds_read_b64_tr_b16 a[112:113], v27 offset:28672
  ds_read_b64_tr_b16 a[114:115], v27 offset:28736
  ds_read_b64_tr_b16 a[116:117], v27 offset:29696
  ds_read_b64_tr_b16 a[118:119], v27 offset:29760
  ds_read_b64_tr_b16 a[120:121], v27 offset:30720
  ds_read_b64_tr_b16 a[122:123], v27 offset:30784
  ds_read_b64_tr_b16 a[124:125], v27 offset:31744
  ds_read_b64_tr_b16 a[126:127], v27 offset:31808
  s_waitcnt lgkmcnt(0)
  s_xor_b32 s36, s13, 3
  s_lshl_b32 s36, s36, 15
  s_add_u32 m0, s39, 28672
  s_add_u32 s37, s36, 0
  buffer_load_dwordx4 v26, s[48:51], s37 offen lds
  s_add_u32 m0, s39, 29696
  s_add_u32 s37, s36, 8192
  buffer_load_dwordx4 v26, s[48:51], s37 offen lds
  s_add_u32 m0, s39, 30720
  s_add_u32 s37, s36, 16384
  buffer_load_dwordx4 v26, s[48:51], s37 offen lds
  s_add_u32 m0, s39, 31744
  s_add_u32 s37, s36, 24576
  buffer_load_dwordx4 v26, s[48:51], s37 offen lds
  s_waitcnt vmcnt(30)
  ds_read_b64_tr_b16 a[128:129], v27 offset:0
  ds_read_b64_tr_b16 a[130:131], v27 offset:64
  ds_read_b64_tr_b16 a[132:133], v27 offset:1024
  ds_read_b64_tr_b16 a[134:135], v27 offset:1088
  ds_read_b64_tr_b16 a[136:137], v27 offset:2048
  ds_read_b64_tr_b16 a[138:139], v27 offset:2112
  ds_read_b64_tr_b16 a[140:141], v27 offset:3072
  ds_read_b64_tr_b16 a[142:143], v27 offset:3136
  s_waitcnt lgkmcnt(0)
  s_add_u32 m0, s39, 0
  s_mov_b32 s37, 0
  buffer_load_dwordx4 v25, s[8:11], s37 offen lds
  s_add_u32 m0, s39, 1024
  s_mov_b32 s37, 131072
  buffer_load_dwordx4 v25, s[8:11], s37 offen lds
  s_add_u32 m0, s39, 2048
  s_mov_b32 s37, 0
  buffer_load_dwordx4 v25, s[40:43], s37 offen lds
  s_add_u32 m0, s39, 3072
  s_mov_b32 s37, 131072
  buffer_load_dwordx4 v25, s[40:43], s37 offen lds
  s_waitcnt vmcnt(30)
  ds_read_b64_tr_b16 a[144:145], v27 offset:4096
  ds_read_b64_tr_b16 a[146:147], v27 offset:4160
  ds_read_b64_tr_b16 a[148:149], v27 offset:5120
  ds_read_b64_tr_b16 a[150:151], v27 offset:5184
  ds_read_b64_tr_b16 a[152:153], v27 offset:6144
  ds_read_b64_tr_b16 a[154:155], v27 offset:6208
  ds_read_b64_tr_b16 a[156:157], v27 offset:7168
  ds_read_b64_tr_b16 a[158:159], v27 offset:7232
  s_waitcnt lgkmcnt(0)
  s_add_u32 m0, s39, 4096
  s_mov_b32 s37, 0
  buffer_load_dwordx4 v25, s[44:47], s37 offen lds
  s_add_u32 m0, s39, 5120
  s_mov_b32 s37, 131072
  buffer_load_dwordx4 v25, s[44:47], s37 offen lds
  s_add_u32 m0, s39, 6144
  s_mov_b32 s37, 262144
  buffer_load_dwordx4 v25, s[8:11], s37 offen lds
  s_add_u32 m0, s39, 7168
  s_mov_b32 s37, 393216
  buffer_load_dwordx4 v25, s[8:11], s37 offen lds
  s_waitcnt vmcnt(30)
  ds_read_b64_tr_b16 a[160:161], v28 offset:8192
  ds_read_b64_tr_b16 a[162:163], v28 offset:8448
  ds_read_b64_tr_b16 a[164:165], v28 offset:9216
  ds_read_b64_tr_b16 a[166:167], v28 offset:9472
  ds_read_b64_tr_b16 a[168:169], v28 offset:8200
  ds_read_b64_tr_b16 a[170:171], v28 offset:8456
  ds_read_b64_tr_b16 a[172:173], v28 offset:9224
  ds_read_b64_tr_b16 a[174:175], v28 offset:9480
  s_waitcnt lgkmcnt(0)
  s_add_u32 m0, s39, 8192
  s_mov_b32 s37, 262144
  buffer_load_dwordx4 v25, s[40:43], s37 offen lds
  s_add_u32 m0, s39, 9216
  s_mov_b32 s37, 393216
  buffer_load_dwordx4 v25, s[40:43], s37 offen lds
  s_add_u32 m0, s39, 10240
  s_mov_b32 s37, 262144
  buffer_load_dwordx4 v25, s[44:47], s37 offen lds
  s_add_u32 m0, s39, 11264
  s_mov_b32 s37, 393216
  buffer_load_dwordx4 v25, s[44:47], s37 offen lds
  s_waitcnt vmcnt(30)
  ds_read_b64_tr_b16 a[176:177], v28 offset:12288
  ds_read_b64_tr_b16 a[178:179], v28 offset:12544
  ds_read_b64_tr_b16 a[180:181], v28 offset:13312
  ds_read_b64_tr_b16 a[182:183], v28 offset:13568
  ds_read_b64_tr_b16 a[184:185], v28 offset:12296
  ds_read_b64_tr_b16 a[186:187], v28 offset:12552
  ds_read_b64_tr_b16 a[188:189], v28 offset:13320
  ds_read_b64_tr_b16 a[190:191], v28 offset:13576
  s_waitcnt lgkmcnt(0)
  s_add_u32 m0, s39, 12288
  s_mov_b32 s37, 786432
  buffer_load_dwordx4 v25, s[44:47], s37 offen lds
  s_add_u32 m0, s39, 13312
  s_mov_b32 s37, 917504
  buffer_load_dwordx4 v25, s[44:47], s37 offen lds
  s_add_u32 m0, s39, 14336
  s_mov_b32 s37, 1310720
  buffer_load_dwordx4 v25, s[44:47], s37 offen lds
  s_add_u32 m0, s39, 15360
  s_mov_b32 s37, 1441792
  buffer_load_dwordx4 v25, s[44:47], s37 offen lds
  s_waitcnt vmcnt(30)
  ds_read_b64_tr_b16 a[192:193], v28 offset:16384
  ds_read_b64_tr_b16 a[194:195], v28 offset:16640
  ds_read_b64_tr_b16 a[196:197], v28 offset:17408
  ds_read_b64_tr_b16 a[198:199], v28 offset:17664
  ds_read_b64_tr_b16 a[200:201], v28 offset:16392
  ds_read_b64_tr_b16 a[202:203], v28 offset:16648
  ds_read_b64_tr_b16 a[204:205], v28 offset:17416
  ds_read_b64_tr_b16 a[206:207], v28 offset:17672
  s_waitcnt lgkmcnt(0)
  s_add_u32 m0, s39, 16384
  s_mov_b32 s37, 1572864
  buffer_load_dwordx4 v25, s[40:43], s37 offen lds
  s_add_u32 m0, s39, 17408
  s_mov_b32 s37, 1703936
  buffer_load_dwordx4 v25, s[40:43], s37 offen lds
  s_add_u32 m0, s39, 18432
  s_mov_b32 s37, 2359296
  buffer_load_dwordx4 v25, s[40:43], s37 offen lds
  s_add_u32 m0, s39, 19456
  s_mov_b32 s37, 2490368
  buffer_load_dwordx4 v25, s[40:43], s37 offen lds
  s_waitcnt vmcnt(30)
  ds_read_b64_tr_b16 a[208:209], v28 offset:20480
  ds_read_b64_tr_b16 a[210:211], v28 offset:20736
  ds_read_b64_tr_b16 a[212:213], v28 offset:21504
  ds_read_b64_tr_b16 a[214:215], v28 offset:21760
  ds_read_b64_tr_b16 a[216:217], v28 offset:20488
  ds_read_b64_tr_b16 a[218:219], v28 offset:20744
  ds_read_b64_tr_b16 a[220:221], v28 offset:21512
  ds_read_b64_tr_b16 a[222:223], v28 offset:21768
  s_waitcnt lgkmcnt(0)
  s_add_u32 m0, s39, 20480
  s_mov_b32 s37, 3407872
  buffer_load_dwordx4 v25, s[40:43], s37 offen lds
  s_add_u32 m0, s39, 21504
  s_mov_b32 s37, 3538944
  buffer_load_dwordx4 v25, s[40:43], s37 offen lds
  s_add_u32 m0, s39, 22528
  s_mov_b32 s37, 1572864
  buffer_load_dwordx4 v25, s[44:47], s37 offen lds
  s_add_u32 m0, s39, 23552
  s_mov_b32 s37, 1703936
  buffer_load_dwordx4 v25, s[44:47], s37 offen lds
  s_waitcnt vmcnt(30)
  ds_read_b64_tr_b16 a[224:225], v28 offset:24576
  ds_read_b64_tr_b16 a[226:227], v28 offset:24832
  ds_read_b64_tr_b16 a[228:229], v28 offset:25600
  ds_read_b64_tr_b16 a[230:231], v28 offset:25856
  ds_read_b64_tr_b16 a[232:233], v28 offset:24584
  ds_read_b64_tr_b16 a[234:235], v28 offset:24840
  ds_read_b64_tr_b16 a[236:237], v28 offset:25608
  ds_read_b64_tr_b16 a[238:239], v28 offset:25864
  s_waitcnt lgkmcnt(0)
  s_xor_b32 s36, s13, 2
  s_lshl_b32 s36, s36, 15
  s_add_u32 m0, s39, 24576
  s_add_u32 s37, s36, 512
  buffer_load_dwordx4 v26, s[48:51], s37 offen lds
  s_add_u32 m0, s39, 25600
  s_add_u32 s37, s36, 8704
  buffer_load_dwordx4 v26, s[48:51], s37 offen lds
  s_add_u32 m0, s39, 26624
  s_add_u32 s37, s36, 16896
  buffer_load_dwordx4 v26, s[48:51], s37 offen lds
  s_add_u32 m0, s39, 27648
  s_add_u32 s37, s36, 25088
  buffer_load_dwordx4 v26, s[48:51], s37 offen lds
  s_waitcnt vmcnt(28)
  ds_read_b64_tr_b16 a[240:241], v28 offset:28672
  ds_read_b64_tr_b16 a[242:243], v28 offset:28928
  ds_read_b64_tr_b16 a[244:245], v28 offset:29696
  ds_read_b64_tr_b16 a[246:247], v28 offset:29952
  ds_read_b64_tr_b16 a[248:249], v28 offset:28680
  ds_read_b64_tr_b16 a[250:251], v28 offset:28936
  ds_read_b64_tr_b16 a[252:253], v28 offset:29704
  ds_read_b64_tr_b16 a[254:255], v28 offset:29960
  s_waitcnt lgkmcnt(0)
  s_xor_b32 s36, s13, 3
  s_lshl_b32 s36, s36, 15
  s_add_u32 m0, s39, 28672
  s_add_u32 s37, s36, 512
  buffer_load_dwordx4 v26, s[48:51], s37 offen lds
  s_add_u32 m0, s39, 29696
  s_add_u32 s37, s36, 8704
  buffer_load_dwordx4 v26, s[48:51], s37 offen lds
  s_add_u32 m0, s39, 30720
  s_add_u32 s37, s36, 16896
  buffer_load_dwordx4 v26, s[48:51], s37 offen lds
  s_add_u32 m0, s39, 31744
  s_add_u32 s37, s36, 25088
  buffer_load_dwordx4 v26, s[48:51], s37 offen lds
  s_mov_b32 s19, 0
  s_branch T_arrgo_68
T_arr_67:
  s_add_u32 s19, s19, 1
  s_cmp_gt_u32 s19, 32768
  s_cbranch_scc1 M_exit
  buffer_load_dwordx2 v[54:55], off, s[72:75], 0 sc1
  buffer_load_dword v56, off, s[72:75], 0 offset:128 sc1
  s_waitcnt vmcnt(0)
T_arrgo_68:
  v_sad_u8 v57, v54, 0, 0
  v_sad_u8 v57, v55, 0, v57
  v_or_b32 v58, v54, v55
  v_cmp_gt_u32 vcc, 32, v57
  s_cbranch_vccnz T_arr_67
  v_cmp_gt_u32 vcc, 0x100, v56
  s_cbranch_vccnz T_arr_67
  v_readfirstlane_b32 s36, v58
  s_nop 0
  s_and_b32 s36, s36, 0x20202020
  s_cselect_b32 s56, 0, 1
  s_mov_b32 s14, -1
  s_mov_b32 s19, 0
  s_branch T_kvok_70
T_kv_69:
  s_sleep 4
  s_add_u32 s19, s19, 1
  s_cmp_gt_u32 s19, 32768
  s_cbranch_scc1 M_exit
T_kvok_70:
  s_mul_i32 s38, s12, 896
  s_add_u32 s39, s38, 148898560
  s_add_u32 s38, s38, 148898048
  s_mov_b32 s30, 0
  s_mov_b32 s37, 0
  s_atomic_or s30, s[58:59], s38 glc
  s_atomic_or s37, s[58:59], s39 glc
  s_waitcnt lgkmcnt(0)
  s_add_u32 s37, s37, 28
  s_cmp_ge_u32 s30, 28
  s_cselect_b32 s30, s37, s30
  s_cmp_ge_u32 s30, 64
  s_cselect_b32 s30, 100, s30
  s_sub_u32 s30, s30, 1
  s_cmp_ge_i32 s14, s30
  s_cbranch_scc1 T_kv_69
  s_mov_b32 m0, s31
  s_nop 0
  buffer_load_dwordx4 v9, s[4:7], s27 offen sc1 lds
  s_mov_b32 m0, s32
  s_nop 0
  buffer_load_dwordx4 v9, s[4:7], s27 offen offset:128 sc1 lds
  s_mov_b32 m0, s33
  s_nop 0
  buffer_load_dwordx4 v10, s[4:7], s28 offen sc1 lds
  s_mov_b32 m0, s34
  s_nop 0
  buffer_load_dwordx4 v10, s[4:7], s28 offen offset:256 sc1 lds
  s_add_u32 s27, s27, 8192
  s_add_u32 s28, s28, 8192
  s_lshl_b32 s36, s12, 10
  s_add_u32 s36, s36, 145752064
  buffer_load_dwordx4 v[40:43], v2, s[4:7], s36 offen sc1
  s_waitcnt vmcnt(33)
  ds_read_b64_tr_b16 v[64:65], v27 offset:0
  ds_read_b64_tr_b16 v[66:67], v27 offset:64
  ds_read_b64_tr_b16 v[68:69], v27 offset:1024
  ds_read_b64_tr_b16 v[70:71], v27 offset:1088
  ds_read_b64_tr_b16 v[72:73], v27 offset:2048
  ds_read_b64_tr_b16 v[74:75], v27 offset:2112
  ds_read_b64_tr_b16 v[76:77], v27 offset:3072
  ds_read_b64_tr_b16 v[78:79], v27 offset:3136
  s_waitcnt lgkmcnt(0)
  ds_write_b128 v4, v[64:67] offset:0
  ds_write_b128 v4, v[68:71] offset:1024
  ds_write_b128 v4, v[72:75] offset:2048
  ds_write_b128 v4, v[76:79] offset:3072
  s_waitcnt lgkmcnt(0)
  s_waitcnt vmcnt(29)
  ds_read_b64_tr_b16 v[64:65], v27 offset:4096
  ds_read_b64_tr_b16 v[66:67], v27 offset:4160
  ds_read_b64_tr_b16 v[68:69], v27 offset:5120
  ds_read_b64_tr_b16 v[70:71], v27 offset:5184
  ds_read_b64_tr_b16 v[72:73], v27 offset:6144
  ds_read_b64_tr_b16 v[74:75], v27 offset:6208
  ds_read_b64_tr_b16 v[76:77], v27 offset:7168
  ds_read_b64_tr_b16 v[78:79], v27 offset:7232
  s_waitcnt lgkmcnt(0)
  ds_write_b128 v4, v[64:67] offset:4096
  ds_write_b128 v4, v[68:71] offset:5120
  ds_write_b128 v4, v[72:75] offset:6144
  ds_write_b128 v4, v[76:79] offset:7168
  s_waitcnt lgkmcnt(0)
  s_waitcnt vmcnt(25)
  ds_read_b64_tr_b16 v[64:65], v27 offset:8192
  ds_read_b64_tr_b16 v[66:67], v27 offset:8256
  ds_read_b64_tr_b16 v[68:69], v27 offset:9216
  ds_read_b64_tr_b16 v[70:71], v27 offset:9280
  ds_read_b64_tr_b16 v[72:73], v27 offset:10240
  ds_read_b64_tr_b16 v[74:75], v27 offset:10304
  ds_read_b64_tr_b16 v[76:77], v27 offset:11264
  ds_read_b64_tr_b16 v[78:79], v27 offset:11328
  s_waitcnt lgkmcnt(0)
  ds_write_b128 v4, v[64:67] offset:8192
  ds_write_b128 v4, v[68:71] offset:9216
  ds_write_b128 v4, v[72:75] offset:10240
  ds_write_b128 v4, v[76:79] offset:11264
  s_waitcnt lgkmcnt(0)
  s_waitcnt vmcnt(21)
  ds_read_b64_tr_b16 v[64:65], v27 offset:12288
  ds_read_b64_tr_b16 v[66:67], v27 offset:12352
  ds_read_b64_tr_b16 v[68:69], v27 offset:13312
  ds_read_b64_tr_b16 v[70:71], v27 offset:13376
  ds_read_b64_tr_b16 v[72:73], v27 offset:14336
  ds_read_b64_tr_b16 v[74:75], v27 offset:14400
  ds_read_b64_tr_b16 v[76:77], v27 offset:15360
  ds_read_b64_tr_b16 v[78:79], v27 offset:15424
  s_waitcnt lgkmcnt(0)
  ds_write_b128 v4, v[64:67] offset:12288
  ds_write_b128 v4, v[68:71] offset:13312
  ds_write_b128 v4, v[72:75] offset:14336
  ds_write_b128 v4, v[76:79] offset:15360
  s_waitcnt lgkmcnt(0)
  s_waitcnt vmcnt(17)
  ds_read_b64_tr_b16 v[64:65], v27 offset:16384
  ds_read_b64_tr_b16 v[66:67], v27 offset:16448
  ds_read_b64_tr_b16 v[68:69], v27 offset:17408
  ds_read_b64_tr_b16 v[70:71], v27 offset:17472
  ds_read_b64_tr_b16 v[72:73], v27 offset:18432
  ds_read_b64_tr_b16 v[74:75], v27 offset:18496
  ds_read_b64_tr_b16 v[76:77], v27 offset:19456
  ds_read_b64_tr_b16 v[78:79], v27 offset:19520
  s_waitcnt lgkmcnt(0)
  ds_write_b128 v4, v[64:67] offset:16384
  ds_write_b128 v4, v[68:71] offset:17408
  ds_write_b128 v4, v[72:75] offset:18432
  ds_write_b128 v4, v[76:79] offset:19456
  s_waitcnt lgkmcnt(0)
  s_waitcnt vmcnt(13)
  ds_read_b64_tr_b16 v[64:65], v27 offset:20480
  ds_read_b64_tr_b16 v[66:67], v27 offset:20544
  ds_read_b64_tr_b16 v[68:69], v27 offset:21504
  ds_read_b64_tr_b16 v[70:71], v27 offset:21568
  ds_read_b64_tr_b16 v[72:73], v27 offset:22528
  ds_read_b64_tr_b16 v[74:75], v27 offset:22592
  ds_read_b64_tr_b16 v[76:77], v27 offset:23552
  ds_read_b64_tr_b16 v[78:79], v27 offset:23616
  s_waitcnt lgkmcnt(0)
  ds_write_b128 v4, v[64:67] offset:20480
  ds_write_b128 v4, v[68:71] offset:21504
  ds_write_b128 v4, v[72:75] offset:22528
  ds_write_b128 v4, v[76:79] offset:23552
  s_waitcnt lgkmcnt(0)
  s_waitcnt vmcnt(9)
  ds_read_b64_tr_b16 v[64:65], v28 offset:24576
  ds_read_b64_tr_b16 v[66:67], v28 offset:24832
  ds_read_b64_tr_b16 v[68:69], v28 offset:25600
  ds_read_b64_tr_b16 v[70:71], v28 offset:25856
  ds_read_b64_tr_b16 v[72:73], v28 offset:24584
  ds_read_b64_tr_b16 v[74:75], v28 offset:24840
  ds_read_b64_tr_b16 v[76:77], v28 offset:25608
  ds_read_b64_tr_b16 v[78:79], v28 offset:25864
  s_waitcnt lgkmcnt(0)
  ds_write_b128 v4, v[64:67] offset:24576
  ds_write_b128 v4, v[68:71] offset:25600
  ds_write_b128 v4, v[72:75] offset:26624
  ds_write_b128 v4, v[76:79] offset:27648
  s_waitcnt lgkmcnt(0)
  s_waitcnt vmcnt(5)
  ds_read_b64_tr_b16 v[64:65], v28 offset:28672
  ds_read_b64_tr_b16 v[66:67], v28 offset:28928
  ds_read_b64_tr_b16 v[68:69], v28 offset:29696
  ds_read_b64_tr_b16 v[70:71], v28 offset:29952
  ds_read_b64_tr_b16 v[72:73], v28 offset:28680
  ds_read_b64_tr_b16 v[74:75], v28 offset:28936
  ds_read_b64_tr_b16 v[76:77], v28 offset:29704
  ds_read_b64_tr_b16 v[78:79], v28 offset:29960
  s_waitcnt lgkmcnt(0)
  ds_write_b128 v4, v[64:67] offset:28672
  ds_write_b128 v4, v[68:71] offset:29696
  ds_write_b128 v4, v[72:75] offset:30720
  ds_write_b128 v4, v[76:79] offset:31744
  s_waitcnt lgkmcnt(0)
  s_waitcnt vmcnt(0) lgkmcnt(0)
  s_barrier
  ds_read_b128 v[68:71], v4 offset:0
  ds_read_b128 v[72:75], v4 offset:1024
  ds_read_b128 v[76:79], v4 offset:2048
  ds_read_b128 v[80:83], v4 offset:3072
  ds_read_b128 v[84:87], v4 offset:4096
  ds_read_b128 v[88:91], v4 offset:5120
  ds_read_b128 v[92:95], v4 offset:6144
  ds_read_b128 v[96:99], v4 offset:7168
  ds_read_b128 v[100:103], v4 offset:8192
  ds_read_b128 v[104:107], v4 offset:9216
  ds_read_b128 v[108:111], v4 offset:10240
  ds_read_b128 v[112:115], v4 offset:11264
  ds_read_b128 v[28:31], v3 offset:16384
  ds_read_b128 v[32:35], v3 offset:20480
  ds_read_b128 v[36:39], v2 offset:8192
  ds_read_b128 v[40:43], v2 offset:9216
  ds_read_b128 v[44:47], v2 offset:10240
  ds_read_b128 v[48:51], v2 offset:11264
  ds_read_b128 v[52:55], v2 offset:12288
  ds_read_b128 v[56:59], v2 offset:13312
  ds_read_b128 v[60:63], v2 offset:14336
  ds_read_b128 v[64:67], v2 offset:15360
  s_and_b32 s36, s13, 1
  s_lshl_b32 s36, s36, 12
  s_add_u32 s22, s22, s36
  s_add_u32 s23, s36, 145752064
  s_mov_b32 s14, -1
  s_and_b32 s57, s14, 1
  s_and_b32 s36, s14, 3
  s_lshl_b32 s36, s36, 13
  s_add_u32 s26, s36, s23
  s_add_u32 s36, s36, 8192
  s_and_b32 s36, s36, 0x7fff
  s_add_u32 s24, s36, 145752064
  s_add_u32 s25, s36, 145756160
  s_add_u32 s35, s36, s23
  s_waitcnt lgkmcnt(0)
  s_cmp_lg_u32 s56, 0
  s_cbranch_scc1 M_global
  s_mov_b32 s19, 0
  v_mov_b64 v[16:17], 0
  v_mov_b64 v[18:19], 0
  v_mov_b64 v[20:21], 0
  v_mov_b64 v[22:23], 0
  v_mov_b64 v[24:25], 0
  v_mov_b64 v[26:27], 0
  buffer_load_dwordx4 v[124:127], v3, s[4:7], s24 offen sc1
  buffer_load_dwordx4 v[124:127], v3, s[4:7], s24 offen sc1
  buffer_load_dwordx4 v[124:127], v3, s[4:7], s24 offen sc1
  s_branch T_loop_71
.p2align 6
T_retry_72:
  s_mov_b64 exec, vcc
  buffer_load_dwordx4 v[124:127], v3, s[4:7], s24 offen sc1
  s_mov_b64 exec, -1
  s_add_u32 s19, s19, 1
  s_cmp_gt_u32 s19, 32768
  s_cbranch_scc1 M_exit
T_loop_71:
  s_waitcnt vmcnt(2)
  v_max3_u32 v122, v124, v125, v126
  v_max_u32 v122, v122, v127
  v_cmp_eq_u32 vcc, -1, v122
  s_cbranch_vccnz T_retry_72
  ds_write_b128 v3, v[124:127] offset:0
  buffer_load_dwordx4 v[12:15], v3, s[4:7], s25 offen sc1
  s_add_u32 s14, s14, 1
  s_waitcnt lgkmcnt(0)
  s_barrier
  ds_read_b128 v[116:119], v1 offset:0
  ds_read_b128 v[120:123], v1 offset:512
  s_waitcnt lgkmcnt(1)
  v_smfmac_f32_16x16x64_bf16 v[16:19], v[116:119], v[68:75], v0
  ds_read_b128 v[68:71], v4 offset:12288
  v_smfmac_f32_16x16x64_bf16 v[20:23], v[116:119], v[76:83], v0
  s_waitcnt vmcnt(1)
  ds_read_b128 v[124:127], v1 offset:1024
  v_smfmac_f32_16x16x64_bf16 v[24:27], v[116:119], v[84:91], v0
  s_waitcnt lgkmcnt(2)
  ds_read_b128 v[84:87], v1 offset:1536
  v_smfmac_f32_16x16x64_bf16 v[16:19], v[120:123], v[92:99], v0
  s_waitcnt vmcnt(0)
  ds_read_b128 v[72:75], v4 offset:13312
  v_max3_u32 v92, v12, v13, v14
  v_smfmac_f32_16x16x64_bf16 v[20:23], v[120:123], v[100:107], v0
  ds_read_b128 v[88:91], v1 offset:2048
  v_max_u32 v92, v92, v15
  v_smfmac_f32_16x16x64_bf16 v[24:27], v[120:123], v[108:115], v0
  s_waitcnt lgkmcnt(3)
  ds_read_b128 v[116:119], v1 offset:2560
  v_cmp_eq_u32 vcc, -1, v92
  v_smfmac_f32_16x16x64_bf16 v[16:19], v[124:127], v[128:135], v0
  s_cbranch_vccnz T_late_73
T_lateok_74:
  ds_write_b64 v3, v[12:13] offset:4096
  v_smfmac_f32_16x16x64_bf16 v[20:23], v[124:127], v[136:143], v0
  s_and_b32 s57, s14, 1
  s_and_b32 s36, s14, 3
  s_lshl_b32 s36, s36, 13
  v_smfmac_f32_16x16x64_bf16 v[24:27], v[124:127], v[144:151], v0
  s_waitcnt lgkmcnt(4)
  ds_write_b64 v3, v[14:15] offset:4104
  s_add_u32 s26, s36, s23
  v_smfmac_f32_16x16x64_bf16 v[16:19], v[84:87], v[152:159], v0
  s_add_u32 s36, s36, 8192
  ds_read_b128 v[76:79], v4 offset:14336
  s_and_b32 s36, s36, 0x7fff
  v_smfmac_f32_16x16x64_bf16 v[20:23], v[84:87], v[160:167], v0
  s_waitcnt lgkmcnt(5)
  ds_read_b128 v[80:83], v4 offset:15360
  s_mov_b32 m0, s31
  v_smfmac_f32_16x16x64_bf16 v[24:27], v[84:87], v[68:75], v0
  s_waitcnt lgkmcnt(5)
  ds_read_b128 v[92:95], v1 offset:3072
  s_cmp_ge_i32 s14, s30
  v_smfmac_f32_16x16x64_bf16 v[16:19], v[88:91], v[168:175], v0
  s_cbranch_scc1 T_kvw_75
T_kvb_76:
  ds_read_b128 v[96:99], v1 offset:3584
  v_smfmac_f32_16x16x64_bf16 v[20:23], v[88:91], v[176:183], v0
  s_waitcnt lgkmcnt(4)
  s_barrier
  v_smfmac_f32_16x16x64_bf16 v[24:27], v[88:91], v[184:191], v0
  ds_read_b128 v[100:103], v1 offset:4096
  v_mov_b64 v[12:13], s[2:3]
  v_smfmac_f32_16x16x64_bf16 v[16:19], v[116:119], v[192:199], v0
  ds_read_b128 v[104:107], v1 offset:4608
  v_mov_b64 v[14:15], s[2:3]
  v_smfmac_f32_16x16x64_bf16 v[20:23], v[116:119], v[200:207], v0
  s_waitcnt lgkmcnt(4)
  ds_read_b128 v[108:111], v1 offset:5120
  s_add_u32 s24, s36, 145752064
  v_smfmac_f32_16x16x64_bf16 v[24:27], v[116:119], v[76:83], v0
  s_waitcnt lgkmcnt(4)
  ds_read_b128 v[112:115], v1 offset:5632
  s_add_u32 s25, s36, 145756160
  v_smfmac_f32_16x16x64_bf16 v[16:19], v[92:95], v[208:215], v0
  s_waitcnt lgkmcnt(4)
  ds_read_b128 v[120:123], v1 offset:6144
  s_add_u32 s35, s36, s23
  v_smfmac_f32_16x16x64_bf16 v[16:19], v[96:99], v[216:223], v0
  s_waitcnt lgkmcnt(4)
  ds_read_b128 v[124:127], v1 offset:6656
  buffer_load_dwordx4 v9, s[4:7], s27 offen sc1 lds
  v_smfmac_f32_16x16x64_bf16 v[16:19], v[100:103], v[240:247], v0
  s_waitcnt lgkmcnt(4)
  ds_read_b128 v[84:87], v1 offset:7168
  v_mov_b32 v118, s14
  v_smfmac_f32_16x16x64_bf16 v[16:19], v[104:107], a[8:15], v0
  s_waitcnt lgkmcnt(4)
  ds_read_b128 v[88:91], v1 offset:7680
  s_mov_b32 m0, s32
  v_smfmac_f32_16x16x64_bf16 v[16:19], v[108:111], a[24:31], v0
  s_waitcnt lgkmcnt(4)
  ds_read_b128 v[68:71], v4 offset:16384
  v_min_u32 v119, 1, v3
  v_smfmac_f32_16x16x64_bf16 v[16:19], v[112:115], a[48:55], v0
  s_waitcnt lgkmcnt(4)
  ds_read_b128 v[72:75], v4 offset:17408
  v_lshlrev_b32 v119, 30, v119
  v_smfmac_f32_16x16x64_bf16 v[16:19], v[120:123], a[72:79], v0
  s_waitcnt lgkmcnt(4)
  ds_read_b128 v[76:79], v4 offset:18432
  v_smfmac_f32_16x16x64_bf16 v[16:19], v[124:127], a[96:103], v0
  s_waitcnt lgkmcnt(4)
  buffer_load_dwordx4 v9, s[4:7], s27 offen offset:128 sc1 lds
  v_smfmac_f32_16x16x64_bf16 v[16:19], v[84:87], a[112:119], v0
  s_waitcnt lgkmcnt(3)
  ds_read_b128 v[80:83], v4 offset:19456
  v_smfmac_f32_16x16x64_bf16 v[16:19], v[88:91], a[136:143], v0
  s_waitcnt lgkmcnt(2)
  buffer_store_dword v118, v119, s[4:7], s15 offen sc1
  s_mov_b32 m0, s33
  v_smfmac_f32_16x16x64_bf16 v[20:23], v[92:95], v[68:75], v0
  ds_read_b128 v[68:71], v4 offset:20480
  v_smfmac_f32_16x16x64_bf16 v[20:23], v[96:99], v[224:231], v0
  buffer_load_dwordx4 v10, s[4:7], s28 offen sc1 lds
  s_mov_b32 m0, s34
  v_smfmac_f32_16x16x64_bf16 v[20:23], v[100:103], v[248:255], v0
  s_waitcnt lgkmcnt(1)
  ds_read_b128 v[72:75], v4 offset:21504
  v_mul_f32 v16, s18, v16
  v_smfmac_f32_16x16x64_bf16 v[20:23], v[104:107], v[76:83], v0
  ds_read_b128 v[76:79], v4 offset:22528
  v_mul_f32 v17, s18, v17
  v_smfmac_f32_16x16x64_bf16 v[20:23], v[108:111], a[32:39], v0
  ds_read_b128 v[80:83], v4 offset:23552
  v_mul_f32 v18, s18, v18
  v_smfmac_f32_16x16x64_bf16 v[20:23], v[112:115], a[56:63], v0
  buffer_load_dwordx4 v10, s[4:7], s28 offen offset:256 sc1 lds
  v_mul_f32 v19, s18, v19
  v_smfmac_f32_16x16x64_bf16 v[20:23], v[120:123], a[80:87], v0
  s_waitcnt lgkmcnt(2)
  v_cvt_pk_bf16_f32 v116, v16, v17
  v_smfmac_f32_16x16x64_bf16 v[20:23], v[124:127], v[68:75], v0
  v_cvt_pk_bf16_f32 v117, v18, v19
  v_smfmac_f32_16x16x64_bf16 v[20:23], v[84:87], a[120:127], v0
  ds_write_b64 v5, v[116:117] offset:24576
  v_smfmac_f32_16x16x64_bf16 v[20:23], v[88:91], a[144:151], v0
  s_waitcnt lgkmcnt(1)
  s_add_u32 s27, s27, 8192
  s_add_u32 s28, s28, 8192
  v_smfmac_f32_16x16x64_bf16 v[24:27], v[92:95], v[76:83], v0
  v_smfmac_f32_16x16x64_bf16 v[24:27], v[96:99], v[232:239], v0
  s_nop 1
  v_cvt_pk_bf16_f32 v118, v20, v21
  v_cvt_pk_bf16_f32 v119, v22, v23
  v_smfmac_f32_16x16x64_bf16 v[24:27], v[100:103], a[0:7], v0
  ds_write_b64 v5, v[118:119] offset:26880
  buffer_store_dwordx2 v[118:119], v5, s[4:7], s29 offen sc1
  v_smfmac_f32_16x16x64_bf16 v[24:27], v[104:107], a[16:23], v0
  s_waitcnt lgkmcnt(1)
  s_barrier
  ds_read_b64_tr_b16 v[68:69], v6 offset:24576
  v_smfmac_f32_16x16x64_bf16 v[24:27], v[108:111], a[40:47], v0
  s_nop 0
  ds_read_b64_tr_b16 v[70:71], v6 offset:24640
  ds_read_b64_tr_b16 v[72:73], v6 offset:24832
  v_smfmac_f32_16x16x64_bf16 v[24:27], v[112:115], a[64:71], v0
  s_nop 0
  ds_read_b64_tr_b16 v[74:75], v6 offset:24896
  ds_read_b64_tr_b16 v[76:77], v6 offset:25088
  v_smfmac_f32_16x16x64_bf16 v[24:27], v[120:123], a[88:95], v0
  s_nop 0
  ds_read_b64_tr_b16 v[78:79], v6 offset:25152
  ds_read_b64_tr_b16 v[80:81], v6 offset:25344
  v_smfmac_f32_16x16x64_bf16 v[24:27], v[124:127], a[104:111], v0
  s_waitcnt lgkmcnt(7)
  ds_read_b64_tr_b16 v[82:83], v6 offset:25408
  s_barrier
  v_smfmac_f32_16x16x64_bf16 v[24:27], v[84:87], a[128:135], v0
  s_nop 0
  ds_read_b64_tr_b16 v[92:93], v6 offset:26880
  ds_read_b64_tr_b16 v[94:95], v6 offset:26944
  v_smfmac_f32_16x16x64_bf16 v[24:27], v[88:91], a[152:159], v0
  s_waitcnt lgkmcnt(8)
  ds_read_b64_tr_b16 v[96:97], v6 offset:27136
  ds_read_b64_tr_b16 v[98:99], v6 offset:27200
  v_mfma_f32_16x16x32_bf16 v[16:19], v[36:39], v[68:71], 0
  s_waitcnt lgkmcnt(8)
  ds_read_b64_tr_b16 v[100:101], v6 offset:27392
  ds_read_b64_tr_b16 v[102:103], v6 offset:27456
  v_mfma_f32_16x16x32_bf16 v[16:19], v[40:43], v[72:75], v[16:19]
  s_waitcnt lgkmcnt(8)
  ds_read_b64_tr_b16 v[104:105], v6 offset:27648
  ds_read_b64_tr_b16 v[106:107], v6 offset:27712
  v_mfma_f32_16x16x32_bf16 v[16:19], v[44:47], v[76:79], v[16:19]
  s_waitcnt lgkmcnt(8)
  v_cvt_pk_bf16_f32 v116, v24, v25
  v_cvt_pk_bf16_f32 v117, v26, v27
  v_mfma_f32_16x16x32_bf16 v[16:19], v[48:51], v[80:83], v[16:19]
  s_waitcnt lgkmcnt(6)
  buffer_store_dwordx2 v[116:117], v5, s[4:7], s29 offen offset:2304 sc1
  v_mov_b64 v[108:109], 0
  v_mfma_f32_16x16x32_bf16 v[120:123], v[92:95], v[68:71], 0
  s_waitcnt lgkmcnt(4)
  v_mov_b64 v[110:111], 0
  v_mov_b64 v[112:113], 0
  v_mfma_f32_16x16x32_bf16 v[120:123], v[96:99], v[72:75], v[120:123]
  s_waitcnt lgkmcnt(2)
  v_mov_b64 v[114:115], 0
  v_mov_b64 v[36:37], 0
  v_mfma_f32_16x16x32_bf16 v[120:123], v[100:103], v[76:79], v[120:123]
  s_waitcnt lgkmcnt(0)
  v_exp_f32 v124, v16
  v_mfma_f32_16x16x32_bf16 v[120:123], v[104:107], v[80:83], v[120:123]
  s_add_u32 s29, s29, 147456
  v_exp_f32 v125, v17
  v_mfma_f32_16x16x32_bf16 v[20:23], v[52:55], v[68:71], 0
  s_cmp_eq_u32 s14, 63
  v_exp_f32 v126, v18
  v_mfma_f32_16x16x32_bf16 v[20:23], v[56:59], v[72:75], v[20:23]
  s_cbranch_scc1 M_tdone
  v_exp_f32 v127, v19
  v_mfma_f32_16x16x32_bf16 v[20:23], v[60:63], v[76:79], v[20:23]
  v_cvt_pk_bf16_f32 v44, v124, v125
  v_cvt_pk_bf16_f32 v45, v126, v127
  v_mfma_f32_16x16x32_bf16 v[20:23], v[64:67], v[80:83], v[20:23]
  v_exp_f32 v124, v120
  v_exp_f32 v125, v121
  v_exp_f32 v126, v122
  v_exp_f32 v127, v123
  v_cvt_pk_bf16_f32 v84, v124, v125
  v_cvt_pk_bf16_f32 v85, v126, v127
  v_cndmask_b32 v48, v84, 0, s[16:17]
  v_cndmask_b32 v49, v85, 0, s[16:17]
  v_cndmask_b32 v50, 0, v84, s[16:17]
  v_cndmask_b32 v51, 0, v85, s[16:17]
  v_exp_f32 v124, v20
  v_mfma_f32_16x16x16_bf16 v[88:91], v[12:13], v[48:49], 0
  v_exp_f32 v125, v21
  v_mfma_f32_16x16x16_bf16 v[24:27], v[116:117], v[48:49], 0
  v_exp_f32 v126, v22
  v_mfma_f32_16x16x16_bf16 v[92:95], v[116:117], v[50:51], 0
  v_exp_f32 v127, v23
  v_cvt_pk_bf16_f32 v46, v124, v125
  v_cvt_pk_bf16_f32 v47, v126, v127
  v_mov_b64 v[38:39], 0
  v_mov_b64 v[40:41], 0
  v_mfma_f32_16x16x32_bf16 v[88:91], v[12:15], v[44:47], v[88:91]
  v_xor_b32 v86, 512, v11
  v_xor_b32 v87, 1024, v11
  v_mfma_f32_16x16x32_bf16 v[24:27], v[28:31], v[44:47], v[24:27]
  v_xor_b32 v72, 1536, v11
  v_mov_b64 v[42:43], 0
  v_mfma_f32_16x16x32_bf16 v[92:95], v[32:35], v[44:47], v[92:95]
  s_nop 1
  v_rcp_f32 v89, v88
  v_subrev_u32 v124, s54, v88
  v_cmp_le_u32 vcc, s55, v124
  s_cbranch_vccnz T_slow_77
T_back_78:
  v_mul_f32 v24, v89, v24
  v_mul_f32 v25, v89, v25
  v_mul_f32 v26, v89, v26
  v_mul_f32 v27, v89, v27
  v_cvt_pk_bf16_f32 v96, v24, v25
  v_cvt_pk_bf16_f32 v97, v26, v27
  v_pk_mul_f32 v[92:93], v[92:93], v[88:89] op_sel:[0,1] op_sel_hi:[1,1]
  v_pk_mul_f32 v[94:95], v[94:95], v[88:89] op_sel:[0,1] op_sel_hi:[1,1]
  v_cvt_pk_bf16_f32 v98, v92, v93
  v_cvt_pk_bf16_f32 v99, v94, v95
  ds_write_b128 v11, v[96:99] offset:29184
  s_nop 0
  v_smfmac_f32_16x16x64_bf16 v[108:111], v[96:99], a[160:167], v0
  ds_read_b128 v[52:55], v4 offset:24576
  v_smfmac_f32_16x16x64_bf16 v[112:115], v[96:99], a[168:175], v0
  ds_read_b128 v[56:59], v4 offset:25600
  v_smfmac_f32_16x16x64_bf16 v[36:39], v[96:99], a[176:183], v0
  v_smfmac_f32_16x16x64_bf16 v[40:43], v[96:99], a[184:191], v0
  s_waitcnt lgkmcnt(2)
  s_barrier
  ds_read_b128 v[100:103], v86 offset:29184
  ds_read_b128 v[104:107], v87 offset:29184
  ds_read_b128 v[68:71], v72 offset:29184
  s_waitcnt lgkmcnt(2)
  v_smfmac_f32_16x16x64_bf16 v[108:111], v[100:103], a[192:199], v0
  ds_read_b128 v[60:63], v4 offset:26624
  v_smfmac_f32_16x16x64_bf16 v[112:115], v[100:103], a[200:207], v0
  s_waitcnt lgkmcnt(2)
  ds_read_b128 v[64:67], v4 offset:27648
  v_smfmac_f32_16x16x64_bf16 v[108:111], v[104:107], a[224:231], v0
  ds_read_b128 v[76:79], v4 offset:28672
  v_smfmac_f32_16x16x64_bf16 v[112:115], v[104:107], a[232:239], v0
  s_waitcnt lgkmcnt(3)
  ds_read_b128 v[80:83], v4 offset:29696
  v_smfmac_f32_16x16x64_bf16 v[108:111], v[68:71], a[240:247], v0
  ds_read_b128 v[28:31], v4 offset:30720
  v_smfmac_f32_16x16x64_bf16 v[112:115], v[68:71], a[248:255], v0
  ds_read_b128 v[32:35], v4 offset:31744
  v_smfmac_f32_16x16x64_bf16 v[36:39], v[100:103], a[208:215], v0
  ds_read_b128 v[116:119], v2 offset:31232
  v_smfmac_f32_16x16x64_bf16 v[40:43], v[100:103], a[216:223], v0
  v_cvt_pk_bf16_f32 v16, v108, v109
  v_cvt_pk_bf16_f32 v17, v110, v111
  v_bfi_b32 v16, 1, s57, v16
  v_cvt_pk_bf16_f32 v18, v112, v113
  v_cvt_pk_bf16_f32 v19, v114, v115
  v_smfmac_f32_16x16x64_bf16 v[36:39], v[104:107], v[52:59], v0
  s_waitcnt lgkmcnt(5)
  buffer_store_dwordx4 v[16:19], v7, s[4:7], s20 offen
  v_smfmac_f32_16x16x64_bf16 v[40:43], v[104:107], v[60:67], v0
  s_waitcnt lgkmcnt(3)
  v_smfmac_f32_16x16x64_bf16 v[36:39], v[68:71], v[76:83], v0
  s_waitcnt lgkmcnt(1)
  v_smfmac_f32_16x16x64_bf16 v[40:43], v[68:71], v[28:35], v0
  s_nop 4
  v_cvt_pk_bf16_f32 v20, v36, v37
  v_cvt_pk_bf16_f32 v21, v38, v39
  v_bfi_b32 v20, 1, s57, v20
  v_cvt_pk_bf16_f32 v22, v40, v41
  v_cvt_pk_bf16_f32 v23, v42, v43
  buffer_store_dwordx4 v[20:23], v7, s[4:7], s21 offen
  ds_read_b128 v[68:71], v4 offset:0
  ds_read_b128 v[72:75], v4 offset:1024
  ds_read_b128 v[76:79], v4 offset:2048
  ds_read_b128 v[80:83], v4 offset:3072
  ds_read_b128 v[84:87], v4 offset:4096
  ds_read_b128 v[88:91], v4 offset:5120
  ds_read_b128 v[92:95], v4 offset:6144
  ds_read_b128 v[96:99], v4 offset:7168
  ds_read_b128 v[100:103], v4 offset:8192
  ds_read_b128 v[104:107], v4 offset:9216
  ds_read_b128 v[108:111], v4 offset:10240
  ds_read_b128 v[112:115], v4 offset:11264
  v_mov_b64 v[16:17], 0
  v_mov_b64 v[18:19], 0
  v_mov_b64 v[20:21], 0
  v_mov_b64 v[22:23], 0
  v_mov_b64 v[24:25], 0
  v_mov_b64 v[26:27], 0
  s_mov_b32 s19, 0
  v_mov_b32 v49, -1
  s_cmp_gt_u32 s13, 1
  s_cbranch_scc1 T_w23_79
  s_waitcnt vmcnt(1)
  s_nop 15
  buffer_load_dwordx4 v[52:55], v2, s[4:7], s22 offen offset:0 sc1
  buffer_load_dwordx4 v[56:59], v2, s[4:7], s22 offen offset:1024 sc1
  buffer_load_dwordx4 v[60:63], v2, s[4:7], s22 offen offset:2048 sc1
  buffer_load_dwordx4 v[64:67], v2, s[4:7], s22 offen offset:3072 sc1
  s_waitcnt lgkmcnt(12)
T_p1_81:
  s_waitcnt vmcnt(3)
  v_mfma_f32_16x16x32_bf16 v[120:123], v[116:119], v[52:55], 0
  v_xor_b32 v48, s57, v52
  s_waitcnt vmcnt(2)
  v_mfma_f32_16x16x32_bf16 v[120:123], v[116:119], v[56:59], v[120:123]
  v_bitop3_b32 v48, v48, v56, s57 bitop3:0xf6
  s_waitcnt vmcnt(1)
  v_mfma_f32_16x16x32_bf16 v[120:123], v[116:119], v[60:63], v[120:123]
  v_bitop3_b32 v48, v48, v60, s57 bitop3:0xf6
  s_waitcnt vmcnt(0)
  v_mfma_f32_16x16x32_bf16 v[120:123], v[116:119], v[64:67], v[120:123]
  v_bitop3_b32 v48, v48, v64, s57 bitop3:0xf6
  v_and_b32 v48, 1, v48
  v_cmp_ne_u32 vcc, 0, v48
  s_cbranch_vccnz T_p1re_82
  s_nop 3
  v_add_f32_dpp v120, v120, v120 row_ror:8 row_mask:0xf bank_mask:0xf
  v_add_f32_dpp v121, v121, v121 row_ror:8 row_mask:0xf bank_mask:0xf
  v_cvt_pk_bf16_f32 v48, v120, v121
  v_min_u32 v48, -2, v48
  buffer_store_dword v48, v8, s[4:7], s35 offen
  buffer_store_dword v49, v8, s[4:7], s26 offen
T_join_80:
  s_barrier
  buffer_load_dwordx4 v[124:127], v3, s[4:7], s24 offen sc1
  ds_read_b128 v[28:31], v3 offset:16384
  ds_read_b128 v[32:35], v3 offset:20480
  ds_read_b128 v[36:39], v2 offset:8192
  ds_read_b128 v[40:43], v2 offset:9216
  buffer_load_dwordx4 v[124:127], v3, s[4:7], s24 offen sc1
  ds_read_b128 v[44:47], v2 offset:10240
  ds_read_b128 v[48:51], v2 offset:11264
  ds_read_b128 v[52:55], v2 offset:12288
  ds_read_b128 v[56:59], v2 offset:13312
  buffer_load_dwordx4 v[124:127], v3, s[4:7], s24 offen sc1
  ds_read_b128 v[60:63], v2 offset:14336
  ds_read_b128 v[64:67], v2 offset:15360
  s_mov_b32 s19, 0
  s_branch T_loop_71
T_p1re_82:
  s_mov_b64 exec, vcc
  buffer_load_dwordx4 v[52:55], v2, s[4:7], s22 offen offset:0 sc1
  buffer_load_dwordx4 v[56:59], v2, s[4:7], s22 offen offset:1024 sc1
  buffer_load_dwordx4 v[60:63], v2, s[4:7], s22 offen offset:2048 sc1
  buffer_load_dwordx4 v[64:67], v2, s[4:7], s22 offen offset:3072 sc1
  s_mov_b64 exec, -1
  s_add_u32 s19, s19, 1
  s_cmp_gt_u32 s19, 32768
  s_cbranch_scc1 M_exit
  s_branch T_p1_81
T_w23_79:
  s_waitcnt vmcnt(2)
  s_branch T_join_80
T_kvw_75:
  s_mov_b32 s19, 0
  s_branch T_kvok_84
T_kv_83:
  s_sleep 4
  s_add_u32 s19, s19, 1
  s_cmp_gt_u32 s19, 32768
  s_cbranch_scc1 M_exit
T_kvok_84:
  s_mul_i32 s38, s12, 896
  s_add_u32 s39, s38, 148898560
  s_add_u32 s38, s38, 148898048
  s_mov_b32 s30, 0
  s_mov_b32 s37, 0
  s_atomic_or s30, s[58:59], s38 glc
  s_atomic_or s37, s[58:59], s39 glc
  s_waitcnt lgkmcnt(0)
  s_add_u32 s37, s37, 28
  s_cmp_ge_u32 s30, 28
  s_cselect_b32 s30, s37, s30
  s_cmp_ge_u32 s30, 64
  s_cselect_b32 s30, 100, s30
  s_sub_u32 s30, s30, 1
  s_cmp_ge_i32 s14, s30
  s_cbranch_scc1 T_kv_83
  s_branch T_kvb_76
T_late_73:
  buffer_load_dwordx4 v[12:15], v3, s[4:7], s25 offen sc1
  s_add_u32 s19, s19, 1
  s_cmp_gt_u32 s19, 32768
  s_cbranch_scc1 M_exit
  s_waitcnt vmcnt(0)
  v_max3_u32 v92, v12, v13, v14
  v_max_u32 v92, v92, v15
  v_cmp_eq_u32 vcc, -1, v92
  s_cbranch_vccnz T_late_73
  s_branch T_lateok_74
T_slow_77:
  s_nop 7
  v_max3_f32 v124, v16, v17, v18
  v_max3_f32 v124, v124, v19, v20
  v_max3_f32 v124, v124, v21, v22
  v_max3_f32 v124, v124, v23, v120
  v_max3_f32 v124, v124, v121, v122
  v_max_f32 v124, v124, v123
  v_mov_b32 v125, v124
  s_nop 1
  v_permlane32_swap_b32 v124, v125
  s_nop 1
  v_max_f32 v124, v124, v125
  v_mov_b32 v125, v124
  s_nop 1
  v_permlane16_swap_b32 v124, v125
  s_nop 1
  v_max_f32 v124, v124, v125
  v_sub_f32 v16, v16, v124
  v_sub_f32 v17, v17, v124
  v_sub_f32 v18, v18, v124
  v_sub_f32 v19, v19, v124
  v_exp_f32 v16, v16
  v_exp_f32 v17, v17
  v_exp_f32 v18, v18
  v_exp_f32 v19, v19
  v_sub_f32 v20, v20, v124
  v_sub_f32 v21, v21, v124
  v_sub_f32 v22, v22, v124
  v_sub_f32 v23, v23, v124
  v_exp_f32 v20, v20
  v_exp_f32 v21, v21
  v_exp_f32 v22, v22
  v_exp_f32 v23, v23
  v_sub_f32 v120, v120, v124
  v_sub_f32 v121, v121, v124
  v_sub_f32 v122, v122, v124
  v_sub_f32 v123, v123, v124
  v_exp_f32 v120, v120
  v_exp_f32 v121, v121
  v_exp_f32 v122, v122
  v_exp_f32 v123, v123
  s_nop 0
  v_cvt_pk_bf16_f32 v44, v16, v17
  v_cvt_pk_bf16_f32 v45, v18, v19
  v_cvt_pk_bf16_f32 v46, v20, v21
  v_cvt_pk_bf16_f32 v47, v22, v23
  v_cvt_pk_bf16_f32 v84, v120, v121
  v_cvt_pk_bf16_f32 v85, v122, v123
  v_cndmask_b32 v48, v84, 0, s[16:17]
  v_cndmask_b32 v49, v85, 0, s[16:17]
  v_cndmask_b32 v50, 0, v84, s[16:17]
  v_cndmask_b32 v51, 0, v85, s[16:17]
  s_nop 1
  v_mfma_f32_16x16x16_bf16 v[88:91], v[12:13], v[48:49], 0
  v_mfma_f32_16x16x16_bf16 v[24:27], v[116:117], v[48:49], 0
  v_mfma_f32_16x16x16_bf16 v[92:95], v[116:117], v[50:51], 0
  v_mfma_f32_16x16x32_bf16 v[88:91], v[12:15], v[44:47], v[88:91]
  v_mfma_f32_16x16x32_bf16 v[24:27], v[28:31], v[44:47], v[24:27]
  v_mfma_f32_16x16x32_bf16 v[92:95], v[32:35], v[44:47], v[92:95]
  s_nop 7
  s_nop 1
  v_rcp_f32 v89, v88
  s_nop 0
  s_branch T_back_78
M_global:
  s_mov_b32 s19, 0
  v_mov_b64 v[16:17], 0
  v_mov_b64 v[18:19], 0
  v_mov_b64 v[20:21], 0
  v_mov_b64 v[22:23], 0
  v_mov_b64 v[24:25], 0
  v_mov_b64 v[26:27], 0
  buffer_load_dwordx4 v[124:127], v3, s[4:7], s24 offen sc1
  buffer_load_dwordx4 v[124:127], v3, s[4:7], s24 offen sc1
  buffer_load_dwordx4 v[124:127], v3, s[4:7], s24 offen sc1
  s_branch T_loop_85
.p2align 6
T_retry_86:
  s_mov_b64 exec, vcc
  buffer_load_dwordx4 v[124:127], v3, s[4:7], s24 offen sc1
  s_mov_b64 exec, -1
  s_add_u32 s19, s19, 1
  s_cmp_gt_u32 s19, 32768
  s_cbranch_scc1 M_exit
T_loop_85:
  s_waitcnt vmcnt(2)
  v_max3_u32 v122, v124, v125, v126
  v_max_u32 v122, v122, v127
  v_cmp_eq_u32 vcc, -1, v122
  s_cbranch_vccnz T_retry_86
  ds_write_b128 v3, v[124:127] offset:0
  buffer_load_dwordx4 v[12:15], v3, s[4:7], s25 offen sc1
  s_add_u32 s14, s14, 1
  s_waitcnt lgkmcnt(0)
  s_barrier
  ds_read_b128 v[116:119], v1 offset:0
  ds_read_b128 v[120:123], v1 offset:512
  s_waitcnt lgkmcnt(1)
  v_smfmac_f32_16x16x64_bf16 v[16:19], v[116:119], v[68:75], v0
  ds_read_b128 v[68:71], v4 offset:12288
  v_smfmac_f32_16x16x64_bf16 v[20:23], v[116:119], v[76:83], v0
  s_waitcnt vmcnt(1)
  ds_read_b128 v[124:127], v1 offset:1024
  v_smfmac_f32_16x16x64_bf16 v[24:27], v[116:119], v[84:91], v0
  s_waitcnt lgkmcnt(2)
  ds_read_b128 v[84:87], v1 offset:1536
  v_smfmac_f32_16x16x64_bf16 v[16:19], v[120:123], v[92:99], v0
  s_waitcnt vmcnt(0)
  ds_read_b128 v[72:75], v4 offset:13312
  v_max3_u32 v92, v12, v13, v14
  v_smfmac_f32_16x16x64_bf16 v[20:23], v[120:123], v[100:107], v0
  ds_read_b128 v[88:91], v1 offset:2048
  v_max_u32 v92, v92, v15
  v_smfmac_f32_16x16x64_bf16 v[24:27], v[120:123], v[108:115], v0
  s_waitcnt lgkmcnt(3)
  ds_read_b128 v[116:119], v1 offset:2560
  v_cmp_eq_u32 vcc, -1, v92
  v_smfmac_f32_16x16x64_bf16 v[16:19], v[124:127], v[128:135], v0
  s_cbranch_vccnz T_late_87
T_lateok_88:
  ds_write_b64 v3, v[12:13] offset:4096
  v_smfmac_f32_16x16x64_bf16 v[20:23], v[124:127], v[136:143], v0
  s_and_b32 s57, s14, 1
  s_and_b32 s36, s14, 3
  s_lshl_b32 s36, s36, 13
  v_smfmac_f32_16x16x64_bf16 v[24:27], v[124:127], v[144:151], v0
  s_waitcnt lgkmcnt(4)
  ds_write_b64 v3, v[14:15] offset:4104
  s_add_u32 s26, s36, s23
  v_smfmac_f32_16x16x64_bf16 v[16:19], v[84:87], v[152:159], v0
  s_add_u32 s36, s36, 8192
  ds_read_b128 v[76:79], v4 offset:14336
  s_and_b32 s36, s36, 0x7fff
  v_smfmac_f32_16x16x64_bf16 v[20:23], v[84:87], v[160:167], v0
  s_waitcnt lgkmcnt(5)
  ds_read_b128 v[80:83], v4 offset:15360
  s_mov_b32 m0, s31
  v_smfmac_f32_16x16x64_bf16 v[24:27], v[84:87], v[68:75], v0
  s_waitcnt lgkmcnt(5)
  ds_read_b128 v[92:95], v1 offset:3072
  s_cmp_ge_i32 s14, s30
  v_smfmac_f32_16x16x64_bf16 v[16:19], v[88:91], v[168:175], v0
  s_cbranch_scc1 T_kvw_89
T_kvb_90:
  ds_read_b128 v[96:99], v1 offset:3584
  v_smfmac_f32_16x16x64_bf16 v[20:23], v[88:91], v[176:183], v0
  s_waitcnt lgkmcnt(4)
  s_barrier
  v_smfmac_f32_16x16x64_bf16 v[24:27], v[88:91], v[184:191], v0
  ds_read_b128 v[100:103], v1 offset:4096
  v_mov_b64 v[12:13], s[2:3]
  v_smfmac_f32_16x16x64_bf16 v[16:19], v[116:119], v[192:199], v0
  ds_read_b128 v[104:107], v1 offset:4608
  v_mov_b64 v[14:15], s[2:3]
  v_smfmac_f32_16x16x64_bf16 v[20:23], v[116:119], v[200:207], v0
  s_waitcnt lgkmcnt(4)
  ds_read_b128 v[108:111], v1 offset:5120
  s_add_u32 s24, s36, 145752064
  v_smfmac_f32_16x16x64_bf16 v[24:27], v[116:119], v[76:83], v0
  s_waitcnt lgkmcnt(4)
  ds_read_b128 v[112:115], v1 offset:5632
  s_add_u32 s25, s36, 145756160
  v_smfmac_f32_16x16x64_bf16 v[16:19], v[92:95], v[208:215], v0
  s_waitcnt lgkmcnt(4)
  ds_read_b128 v[120:123], v1 offset:6144
  s_add_u32 s35, s36, s23
  v_smfmac_f32_16x16x64_bf16 v[16:19], v[96:99], v[216:223], v0
  s_waitcnt lgkmcnt(4)
  ds_read_b128 v[124:127], v1 offset:6656
  buffer_load_dwordx4 v9, s[4:7], s27 offen sc1 lds
  v_smfmac_f32_16x16x64_bf16 v[16:19], v[100:103], v[240:247], v0
  s_waitcnt lgkmcnt(4)
  ds_read_b128 v[84:87], v1 offset:7168
  v_mov_b32 v118, s14
  v_smfmac_f32_16x16x64_bf16 v[16:19], v[104:107], a[8:15], v0
  s_waitcnt lgkmcnt(4)
  ds_read_b128 v[88:91], v1 offset:7680
  s_mov_b32 m0, s32
  v_smfmac_f32_16x16x64_bf16 v[16:19], v[108:111], a[24:31], v0
  s_waitcnt lgkmcnt(4)
  ds_read_b128 v[68:71], v4 offset:16384
  v_min_u32 v119, 1, v3
  v_smfmac_f32_16x16x64_bf16 v[16:19], v[112:115], a[48:55], v0
  s_waitcnt lgkmcnt(4)
  ds_read_b128 v[72:75], v4 offset:17408
  v_lshlrev_b32 v119, 30, v119
  v_smfmac_f32_16x16x64_bf16 v[16:19], v[120:123], a[72:79], v0
  s_waitcnt lgkmcnt(4)
  ds_read_b128 v[76:79], v4 offset:18432
  v_smfmac_f32_16x16x64_bf16 v[16:19], v[124:127], a[96:103], v0
  s_waitcnt lgkmcnt(4)
  buffer_load_dwordx4 v9, s[4:7], s27 offen offset:128 sc1 lds
  v_smfmac_f32_16x16x64_bf16 v[16:19], v[84:87], a[112:119], v0
  s_waitcnt lgkmcnt(3)
  ds_read_b128 v[80:83], v4 offset:19456
  v_smfmac_f32_16x16x64_bf16 v[16:19], v[88:91], a[136:143], v0
  s_waitcnt lgkmcnt(2)
  buffer_store_dword v118, v119, s[4:7], s15 offen sc1
  s_mov_b32 m0, s33
  v_smfmac_f32_16x16x64_bf16 v[20:23], v[92:95], v[68:75], v0
  ds_read_b128 v[68:71], v4 offset:20480
  v_smfmac_f32_16x16x64_bf16 v[20:23], v[96:99], v[224:231], v0
  buffer_load_dwordx4 v10, s[4:7], s28 offen sc1 lds
  s_mov_b32 m0, s34
  v_smfmac_f32_16x16x64_bf16 v[20:23], v[100:103], v[248:255], v0
  s_waitcnt lgkmcnt(1)
  ds_read_b128 v[72:75], v4 offset:21504
  v_mul_f32 v16, s18, v16
  v_smfmac_f32_16x16x64_bf16 v[20:23], v[104:107], v[76:83], v0
  ds_read_b128 v[76:79], v4 offset:22528
  v_mul_f32 v17, s18, v17
  v_smfmac_f32_16x16x64_bf16 v[20:23], v[108:111], a[32:39], v0
  ds_read_b128 v[80:83], v4 offset:23552
  v_mul_f32 v18, s18, v18
  v_smfmac_f32_16x16x64_bf16 v[20:23], v[112:115], a[56:63], v0
  buffer_load_dwordx4 v10, s[4:7], s28 offen offset:256 sc1 lds
  v_mul_f32 v19, s18, v19
  v_smfmac_f32_16x16x64_bf16 v[20:23], v[120:123], a[80:87], v0
  s_waitcnt lgkmcnt(2)
  v_cvt_pk_bf16_f32 v116, v16, v17
  v_smfmac_f32_16x16x64_bf16 v[20:23], v[124:127], v[68:75], v0
  v_cvt_pk_bf16_f32 v117, v18, v19
  v_smfmac_f32_16x16x64_bf16 v[20:23], v[84:87], a[120:127], v0
  ds_write_b64 v5, v[116:117] offset:24576
  v_smfmac_f32_16x16x64_bf16 v[20:23], v[88:91], a[144:151], v0
  s_waitcnt lgkmcnt(1)
  s_add_u32 s27, s27, 8192
  s_add_u32 s28, s28, 8192
  v_smfmac_f32_16x16x64_bf16 v[24:27], v[92:95], v[76:83], v0
  v_smfmac_f32_16x16x64_bf16 v[24:27], v[96:99], v[232:239], v0
  s_nop 1
  v_cvt_pk_bf16_f32 v118, v20, v21
  v_cvt_pk_bf16_f32 v119, v22, v23
  v_smfmac_f32_16x16x64_bf16 v[24:27], v[100:103], a[0:7], v0
  ds_write_b64 v5, v[118:119] offset:26880
  buffer_store_dwordx2 v[118:119], v5, s[4:7], s29 offen sc1
  v_smfmac_f32_16x16x64_bf16 v[24:27], v[104:107], a[16:23], v0
  s_waitcnt lgkmcnt(1)
  s_barrier
  ds_read_b64_tr_b16 v[68:69], v6 offset:24576
  v_smfmac_f32_16x16x64_bf16 v[24:27], v[108:111], a[40:47], v0
  s_nop 0
  ds_read_b64_tr_b16 v[70:71], v6 offset:24640
  ds_read_b64_tr_b16 v[72:73], v6 offset:24832
  v_smfmac_f32_16x16x64_bf16 v[24:27], v[112:115], a[64:71], v0
  s_nop 0
  ds_read_b64_tr_b16 v[74:75], v6 offset:24896
  ds_read_b64_tr_b16 v[76:77], v6 offset:25088
  v_smfmac_f32_16x16x64_bf16 v[24:27], v[120:123], a[88:95], v0
  s_nop 0
  ds_read_b64_tr_b16 v[78:79], v6 offset:25152
  ds_read_b64_tr_b16 v[80:81], v6 offset:25344
  v_smfmac_f32_16x16x64_bf16 v[24:27], v[124:127], a[104:111], v0
  s_waitcnt lgkmcnt(7)
  ds_read_b64_tr_b16 v[82:83], v6 offset:25408
  s_barrier
  v_smfmac_f32_16x16x64_bf16 v[24:27], v[84:87], a[128:135], v0
  s_nop 0
  ds_read_b64_tr_b16 v[92:93], v6 offset:26880
  ds_read_b64_tr_b16 v[94:95], v6 offset:26944
  v_smfmac_f32_16x16x64_bf16 v[24:27], v[88:91], a[152:159], v0
  s_waitcnt lgkmcnt(8)
  ds_read_b64_tr_b16 v[96:97], v6 offset:27136
  ds_read_b64_tr_b16 v[98:99], v6 offset:27200
  v_mfma_f32_16x16x32_bf16 v[16:19], v[36:39], v[68:71], 0
  s_waitcnt lgkmcnt(8)
  ds_read_b64_tr_b16 v[100:101], v6 offset:27392
  ds_read_b64_tr_b16 v[102:103], v6 offset:27456
  v_mfma_f32_16x16x32_bf16 v[16:19], v[40:43], v[72:75], v[16:19]
  s_waitcnt lgkmcnt(8)
  ds_read_b64_tr_b16 v[104:105], v6 offset:27648
  ds_read_b64_tr_b16 v[106:107], v6 offset:27712
  v_mfma_f32_16x16x32_bf16 v[16:19], v[44:47], v[76:79], v[16:19]
  s_waitcnt lgkmcnt(8)
  v_cvt_pk_bf16_f32 v116, v24, v25
  v_cvt_pk_bf16_f32 v117, v26, v27
  v_mfma_f32_16x16x32_bf16 v[16:19], v[48:51], v[80:83], v[16:19]
  s_waitcnt lgkmcnt(6)
  buffer_store_dwordx2 v[116:117], v5, s[4:7], s29 offen offset:2304 sc1
  v_mov_b64 v[108:109], 0
  v_mfma_f32_16x16x32_bf16 v[120:123], v[92:95], v[68:71], 0
  s_waitcnt lgkmcnt(4)
  v_mov_b64 v[110:111], 0
  v_mov_b64 v[112:113], 0
  v_mfma_f32_16x16x32_bf16 v[120:123], v[96:99], v[72:75], v[120:123]
  s_waitcnt lgkmcnt(2)
  v_mov_b64 v[114:115], 0
  v_mov_b64 v[36:37], 0
  v_mfma_f32_16x16x32_bf16 v[120:123], v[100:103], v[76:79], v[120:123]
  s_waitcnt lgkmcnt(0)
  v_exp_f32 v124, v16
  v_mfma_f32_16x16x32_bf16 v[120:123], v[104:107], v[80:83], v[120:123]
  s_add_u32 s29, s29, 147456
  v_exp_f32 v125, v17
  v_mfma_f32_16x16x32_bf16 v[20:23], v[52:55], v[68:71], 0
  s_cmp_eq_u32 s14, 63
  v_exp_f32 v126, v18
  v_mfma_f32_16x16x32_bf16 v[20:23], v[56:59], v[72:75], v[20:23]
  s_cbranch_scc1 M_tdone
  v_exp_f32 v127, v19
  v_mfma_f32_16x16x32_bf16 v[20:23], v[60:63], v[76:79], v[20:23]
  v_cvt_pk_bf16_f32 v44, v124, v125
  v_cvt_pk_bf16_f32 v45, v126, v127
  v_mfma_f32_16x16x32_bf16 v[20:23], v[64:67], v[80:83], v[20:23]
  v_exp_f32 v124, v120
  v_exp_f32 v125, v121
  v_exp_f32 v126, v122
  v_exp_f32 v127, v123
  v_cvt_pk_bf16_f32 v84, v124, v125
  v_cvt_pk_bf16_f32 v85, v126, v127
  v_cndmask_b32 v48, v84, 0, s[16:17]
  v_cndmask_b32 v49, v85, 0, s[16:17]
  v_cndmask_b32 v50, 0, v84, s[16:17]
  v_cndmask_b32 v51, 0, v85, s[16:17]
  v_exp_f32 v124, v20
  v_mfma_f32_16x16x16_bf16 v[88:91], v[12:13], v[48:49], 0
  v_exp_f32 v125, v21
  v_mfma_f32_16x16x16_bf16 v[24:27], v[116:117], v[48:49], 0
  v_exp_f32 v126, v22
  v_mfma_f32_16x16x16_bf16 v[92:95], v[116:117], v[50:51], 0
  v_exp_f32 v127, v23
  v_cvt_pk_bf16_f32 v46, v124, v125
  v_cvt_pk_bf16_f32 v47, v126, v127
  v_mov_b64 v[38:39], 0
  v_mov_b64 v[40:41], 0
  v_mfma_f32_16x16x32_bf16 v[88:91], v[12:15], v[44:47], v[88:91]
  v_xor_b32 v86, 512, v11
  v_xor_b32 v87, 1024, v11
  v_mfma_f32_16x16x32_bf16 v[24:27], v[28:31], v[44:47], v[24:27]
  v_xor_b32 v72, 1536, v11
  v_mov_b64 v[42:43], 0
  v_mfma_f32_16x16x32_bf16 v[92:95], v[32:35], v[44:47], v[92:95]
  s_nop 1
  v_rcp_f32 v89, v88
  v_subrev_u32 v124, s54, v88
  v_cmp_le_u32 vcc, s55, v124
  s_cbranch_vccnz T_slow_91
T_back_92:
  v_mul_f32 v24, v89, v24
  v_mul_f32 v25, v89, v25
  v_mul_f32 v26, v89, v26
  v_mul_f32 v27, v89, v27
  v_cvt_pk_bf16_f32 v96, v24, v25
  v_cvt_pk_bf16_f32 v97, v26, v27
  v_pk_mul_f32 v[92:93], v[92:93], v[88:89] op_sel:[0,1] op_sel_hi:[1,1]
  v_pk_mul_f32 v[94:95], v[94:95], v[88:89] op_sel:[0,1] op_sel_hi:[1,1]
  v_cvt_pk_bf16_f32 v98, v92, v93
  v_cvt_pk_bf16_f32 v99, v94, v95
  ds_write_b128 v11, v[96:99] offset:29184
  s_nop 0
  v_smfmac_f32_16x16x64_bf16 v[108:111], v[96:99], a[160:167], v0
  ds_read_b128 v[52:55], v4 offset:24576
  v_smfmac_f32_16x16x64_bf16 v[112:115], v[96:99], a[168:175], v0
  ds_read_b128 v[56:59], v4 offset:25600
  v_smfmac_f32_16x16x64_bf16 v[36:39], v[96:99], a[176:183], v0
  v_smfmac_f32_16x16x64_bf16 v[40:43], v[96:99], a[184:191], v0
  s_waitcnt lgkmcnt(2)
  s_barrier
  ds_read_b128 v[100:103], v86 offset:29184
  ds_read_b128 v[104:107], v87 offset:29184
  ds_read_b128 v[68:71], v72 offset:29184
  s_waitcnt lgkmcnt(2)
  v_smfmac_f32_16x16x64_bf16 v[108:111], v[100:103], a[192:199], v0
  ds_read_b128 v[60:63], v4 offset:26624
  v_smfmac_f32_16x16x64_bf16 v[112:115], v[100:103], a[200:207], v0
  s_waitcnt lgkmcnt(2)
  ds_read_b128 v[64:67], v4 offset:27648
  v_smfmac_f32_16x16x64_bf16 v[108:111], v[104:107], a[224:231], v0
  ds_read_b128 v[76:79], v4 offset:28672
  v_smfmac_f32_16x16x64_bf16 v[112:115], v[104:107], a[232:239], v0
  s_waitcnt lgkmcnt(3)
  ds_read_b128 v[80:83], v4 offset:29696
  v_smfmac_f32_16x16x64_bf16 v[108:111], v[68:71], a[240:247], v0
  ds_read_b128 v[28:31], v4 offset:30720
  v_smfmac_f32_16x16x64_bf16 v[112:115], v[68:71], a[248:255], v0
  ds_read_b128 v[32:35], v4 offset:31744
  v_smfmac_f32_16x16x64_bf16 v[36:39], v[100:103], a[208:215], v0
  ds_read_b128 v[116:119], v2 offset:31232
  v_smfmac_f32_16x16x64_bf16 v[40:43], v[100:103], a[216:223], v0
  v_cvt_pk_bf16_f32 v16, v108, v109
  v_cvt_pk_bf16_f32 v17, v110, v111
  v_bfi_b32 v16, 1, s57, v16
  v_cvt_pk_bf16_f32 v18, v112, v113
  v_cvt_pk_bf16_f32 v19, v114, v115
  v_smfmac_f32_16x16x64_bf16 v[36:39], v[104:107], v[52:59], v0
  s_waitcnt lgkmcnt(5)
  buffer_store_dwordx4 v[16:19], v7, s[4:7], s20 offen sc1
  v_smfmac_f32_16x16x64_bf16 v[40:43], v[104:107], v[60:67], v0
  s_waitcnt lgkmcnt(3)
  v_smfmac_f32_16x16x64_bf16 v[36:39], v[68:71], v[76:83], v0
  s_waitcnt lgkmcnt(1)
  v_smfmac_f32_16x16x64_bf16 v[40:43], v[68:71], v[28:35], v0
  s_nop 4
  v_cvt_pk_bf16_f32 v20, v36, v37
  v_cvt_pk_bf16_f32 v21, v38, v39
  v_bfi_b32 v20, 1, s57, v20
  v_cvt_pk_bf16_f32 v22, v40, v41
  v_cvt_pk_bf16_f32 v23, v42, v43
  buffer_store_dwordx4 v[20:23], v7, s[4:7], s21 offen sc1
  ds_read_b128 v[68:71], v4 offset:0
  ds_read_b128 v[72:75], v4 offset:1024
  ds_read_b128 v[76:79], v4 offset:2048
  ds_read_b128 v[80:83], v4 offset:3072
  ds_read_b128 v[84:87], v4 offset:4096
  ds_read_b128 v[88:91], v4 offset:5120
  ds_read_b128 v[92:95], v4 offset:6144
  ds_read_b128 v[96:99], v4 offset:7168
  ds_read_b128 v[100:103], v4 offset:8192
  ds_read_b128 v[104:107], v4 offset:9216
  ds_read_b128 v[108:111], v4 offset:10240
  ds_read_b128 v[112:115], v4 offset:11264
  v_mov_b64 v[16:17], 0
  v_mov_b64 v[18:19], 0
  v_mov_b64 v[20:21], 0
  v_mov_b64 v[22:23], 0
  v_mov_b64 v[24:25], 0
  v_mov_b64 v[26:27], 0
  s_mov_b32 s19, 0
  v_mov_b32 v49, -1
  s_cmp_gt_u32 s13, 1
  s_cbranch_scc1 T_w23_93
  s_waitcnt vmcnt(1)
  s_nop 15
  buffer_load_dwordx4 v[52:55], v2, s[4:7], s22 offen offset:0 sc1
  buffer_load_dwordx4 v[56:59], v2, s[4:7], s22 offen offset:1024 sc1
  buffer_load_dwordx4 v[60:63], v2, s[4:7], s22 offen offset:2048 sc1
  buffer_load_dwordx4 v[64:67], v2, s[4:7], s22 offen offset:3072 sc1
  s_waitcnt lgkmcnt(12)
T_p1_95:
  s_waitcnt vmcnt(3)
  v_mfma_f32_16x16x32_bf16 v[120:123], v[116:119], v[52:55], 0
  v_xor_b32 v48, s57, v52
  s_waitcnt vmcnt(2)
  v_mfma_f32_16x16x32_bf16 v[120:123], v[116:119], v[56:59], v[120:123]
  v_bitop3_b32 v48, v48, v56, s57 bitop3:0xf6
  s_waitcnt vmcnt(1)
  v_mfma_f32_16x16x32_bf16 v[120:123], v[116:119], v[60:63], v[120:123]
  v_bitop3_b32 v48, v48, v60, s57 bitop3:0xf6
  s_waitcnt vmcnt(0)
  v_mfma_f32_16x16x32_bf16 v[120:123], v[116:119], v[64:67], v[120:123]
  v_bitop3_b32 v48, v48, v64, s57 bitop3:0xf6
  v_and_b32 v48, 1, v48
  v_cmp_ne_u32 vcc, 0, v48
  s_cbranch_vccnz T_p1re_96
  s_nop 3
  v_add_f32_dpp v120, v120, v120 row_ror:8 row_mask:0xf bank_mask:0xf
  v_add_f32_dpp v121, v121, v121 row_ror:8 row_mask:0xf bank_mask:0xf
  v_cvt_pk_bf16_f32 v48, v120, v121
  v_min_u32 v48, -2, v48
  buffer_store_dword v48, v8, s[4:7], s35 offen sc1
  buffer_store_dword v49, v8, s[4:7], s26 offen sc1
T_join_94:
  s_barrier
  buffer_load_dwordx4 v[124:127], v3, s[4:7], s24 offen sc1
  ds_read_b128 v[28:31], v3 offset:16384
  ds_read_b128 v[32:35], v3 offset:20480
  ds_read_b128 v[36:39], v2 offset:8192
  ds_read_b128 v[40:43], v2 offset:9216
  buffer_load_dwordx4 v[124:127], v3, s[4:7], s24 offen sc1
  ds_read_b128 v[44:47], v2 offset:10240
  ds_read_b128 v[48:51], v2 offset:11264
  ds_read_b128 v[52:55], v2 offset:12288
  ds_read_b128 v[56:59], v2 offset:13312
  buffer_load_dwordx4 v[124:127], v3, s[4:7], s24 offen sc1
  ds_read_b128 v[60:63], v2 offset:14336
  ds_read_b128 v[64:67], v2 offset:15360
  s_mov_b32 s19, 0
  s_branch T_loop_85
T_p1re_96:
  s_mov_b64 exec, vcc
  buffer_load_dwordx4 v[52:55], v2, s[4:7], s22 offen offset:0 sc1
  buffer_load_dwordx4 v[56:59], v2, s[4:7], s22 offen offset:1024 sc1
  buffer_load_dwordx4 v[60:63], v2, s[4:7], s22 offen offset:2048 sc1
  buffer_load_dwordx4 v[64:67], v2, s[4:7], s22 offen offset:3072 sc1
  s_mov_b64 exec, -1
  s_add_u32 s19, s19, 1
  s_cmp_gt_u32 s19, 32768
  s_cbranch_scc1 M_exit
  s_branch T_p1_95
T_w23_93:
  s_waitcnt vmcnt(2)
  s_branch T_join_94
T_kvw_89:
  s_mov_b32 s19, 0
  s_branch T_kvok_98
T_kv_97:
  s_sleep 4
  s_add_u32 s19, s19, 1
  s_cmp_gt_u32 s19, 32768
  s_cbranch_scc1 M_exit
T_kvok_98:
  s_mul_i32 s38, s12, 896
  s_add_u32 s39, s38, 148898560
  s_add_u32 s38, s38, 148898048
  s_mov_b32 s30, 0
  s_mov_b32 s37, 0
  s_atomic_or s30, s[58:59], s38 glc
  s_atomic_or s37, s[58:59], s39 glc
  s_waitcnt lgkmcnt(0)
  s_add_u32 s37, s37, 28
  s_cmp_ge_u32 s30, 28
  s_cselect_b32 s30, s37, s30
  s_cmp_ge_u32 s30, 64
  s_cselect_b32 s30, 100, s30
  s_sub_u32 s30, s30, 1
  s_cmp_ge_i32 s14, s30
  s_cbranch_scc1 T_kv_97
  s_branch T_kvb_90
T_late_87:
  buffer_load_dwordx4 v[12:15], v3, s[4:7], s25 offen sc1
  s_add_u32 s19, s19, 1
  s_cmp_gt_u32 s19, 32768
  s_cbranch_scc1 M_exit
  s_waitcnt vmcnt(0)
  v_max3_u32 v92, v12, v13, v14
  v_max_u32 v92, v92, v15
  v_cmp_eq_u32 vcc, -1, v92
  s_cbranch_vccnz T_late_87
  s_branch T_lateok_88
T_slow_91:
  s_nop 7
  v_max3_f32 v124, v16, v17, v18
  v_max3_f32 v124, v124, v19, v20
  v_max3_f32 v124, v124, v21, v22
  v_max3_f32 v124, v124, v23, v120
  v_max3_f32 v124, v124, v121, v122
  v_max_f32 v124, v124, v123
  v_mov_b32 v125, v124
  s_nop 1
  v_permlane32_swap_b32 v124, v125
  s_nop 1
  v_max_f32 v124, v124, v125
  v_mov_b32 v125, v124
  s_nop 1
  v_permlane16_swap_b32 v124, v125
  s_nop 1
  v_max_f32 v124, v124, v125
  v_sub_f32 v16, v16, v124
  v_sub_f32 v17, v17, v124
  v_sub_f32 v18, v18, v124
  v_sub_f32 v19, v19, v124
  v_exp_f32 v16, v16
  v_exp_f32 v17, v17
  v_exp_f32 v18, v18
  v_exp_f32 v19, v19
  v_sub_f32 v20, v20, v124
  v_sub_f32 v21, v21, v124
  v_sub_f32 v22, v22, v124
  v_sub_f32 v23, v23, v124
  v_exp_f32 v20, v20
  v_exp_f32 v21, v21
  v_exp_f32 v22, v22
  v_exp_f32 v23, v23
  v_sub_f32 v120, v120, v124
  v_sub_f32 v121, v121, v124
  v_sub_f32 v122, v122, v124
  v_sub_f32 v123, v123, v124
  v_exp_f32 v120, v120
  v_exp_f32 v121, v121
  v_exp_f32 v122, v122
  v_exp_f32 v123, v123
  s_nop 0
  v_cvt_pk_bf16_f32 v44, v16, v17
  v_cvt_pk_bf16_f32 v45, v18, v19
  v_cvt_pk_bf16_f32 v46, v20, v21
  v_cvt_pk_bf16_f32 v47, v22, v23
  v_cvt_pk_bf16_f32 v84, v120, v121
  v_cvt_pk_bf16_f32 v85, v122, v123
  v_cndmask_b32 v48, v84, 0, s[16:17]
  v_cndmask_b32 v49, v85, 0, s[16:17]
  v_cndmask_b32 v50, 0, v84, s[16:17]
  v_cndmask_b32 v51, 0, v85, s[16:17]
  s_nop 1
  v_mfma_f32_16x16x16_bf16 v[88:91], v[12:13], v[48:49], 0
  v_mfma_f32_16x16x16_bf16 v[24:27], v[116:117], v[48:49], 0
  v_mfma_f32_16x16x16_bf16 v[92:95], v[116:117], v[50:51], 0
  v_mfma_f32_16x16x32_bf16 v[88:91], v[12:15], v[44:47], v[88:91]
  v_mfma_f32_16x16x32_bf16 v[24:27], v[28:31], v[44:47], v[24:27]
  v_mfma_f32_16x16x32_bf16 v[92:95], v[32:35], v[44:47], v[92:95]
  s_nop 7
  s_nop 1
  v_rcp_f32 v89, v88
  s_nop 0
  s_branch T_back_92
M_tdone:
  v_mov_b32 v16, 64
  v_min_u32 v17, 1, v3
  v_lshlrev_b32 v17, 30, v17
  s_waitcnt vmcnt(0)
  s_barrier
  buffer_store_dword v16, v17, s[4:7], s15 offen sc1
M_done:
M_exit:
  s_endpgm
.p2align 6
.type M_table,@object
M_table:
.long 0x1, 0x3f, 0xffffffff, 0x12, 0x1, 0x7, 0x8, 0x0, 0x2700, 0x0, 0x0, 0x0, 0x0, 0x0, 0x0, 0x0
.long 0x1, 0x2d, 0xffffffff, 0x16, 0x1, 0x6, 0x10, 0x0, 0x2700, 0x0, 0x0, 0x0, 0x0, 0x0, 0x0, 0x0
.long 0x2, 0x0, 0x1, 0x1c, 0x1, 0x5, 0x18, 0x0, 0x2700, 0x0, 0x0, 0x0, 0x0, 0x0, 0x0, 0x0
.long 0x0, 0x3f, 0xffffffff, 0x19, 0x2, 0x4, 0x719, 0x0, 0x2700, 0x0, 0x0, 0x0, 0x0, 0x0, 0x0, 0x0
.long 0x1, 0x17, 0xffffffff, 0x18, 0x2, 0x3, 0xf00, 0x1, 0x1f00, 0x0, 0x0, 0x0, 0x0, 0x0, 0x0, 0x0
.long 0x0, 0x26, 0xffffffff, 0x27, 0x1, 0x2, 0x1700, 0x0, 0x2700, 0x0, 0x0, 0x0, 0x0, 0x0, 0x0, 0x0
.long 0x2, 0x1c, 0x1, 0x24, 0x0, 0x0, 0x2700, 0x0, 0x2700, 0x0, 0x0, 0x0, 0x0, 0x0, 0x0, 0x0
.size M_table, 448
.section .rodata,"a"
.p2align 6
.amdhsa_kernel gated_mix__compressed_kv_cla__memory_aug_recurrent_mem_tr__prompt_kernel
.amdhsa_next_free_vgpr 512
.amdhsa_next_free_sgpr 102
.amdhsa_accum_offset 256
.amdhsa_group_segment_fixed_size 0
.amdhsa_kernarg_size 136
.amdhsa_user_sgpr_count 2
.amdhsa_user_sgpr_kernarg_segment_ptr 1
.amdhsa_system_sgpr_workgroup_id_x 1
.end_amdhsa_kernel
```

```asm
; @launch grid=(256,1,1) block=(256,1,1) lds=163840
.amdgcn_target "amdgcn-amd-amdhsa--gfx950"
.text
.globl gated_mix__compressed_kv_cla__memory_aug_recurrent_mem_tr__prompt_kernel
.p2align 8
.type gated_mix__compressed_kv_cla__memory_aug_recurrent_mem_tr__prompt_kernel,@function
gated_mix__compressed_kv_cla__memory_aug_recurrent_mem_tr__prompt_kernel:
  s_cmp_ge_u32 s2, 256
  s_cbranch_scc1 M_exit
  s_load_dwordx4 s[72:75], s[0:1], 120
  v_lshrrev_b32 v3, 6, v0
  v_and_b32 v1, 63, v0
  v_readfirstlane_b32 s16, v3
  v_lshlrev_b32 v2, 4, v1
  s_and_b32 s76, s2, 7
  s_lshr_b32 s77, s2, 3
  s_sub_u32 s66, s76, 1
  s_and_b32 s66, s66, 7
  s_lshl_b32 s66, s66, 5
  s_add_u32 s66, s66, s77
  s_lshl_b32 s31, s66, 7
  s_add_u32 s31, s31, 148897792
  s_waitcnt lgkmcnt(0)
  s_mov_b64 s[4:5], s[74:75]
  s_mov_b64 s[74:75], s[72:73]
  s_mov_b64 s[72:73], s[4:5]
  s_and_b32 s5, s5, 0xffff
  s_mov_b32 s6, 268435456
  s_mov_b32 s7, 0x20000
  s_cmp_eq_u32 s76, 0
  s_cbranch_scc1 M_team
  s_mul_i32 s64, s66, 9363
  s_lshr_b32 s64, s64, 16
  s_mul_i32 s67, s64, 7
  s_sub_u32 s65, s66, s67
  s_lshl_b32 s67, s67, 7
  s_add_u32 s67, s67, 148897792
  s_getpc_b64 s[76:77]
M_pc:
  s_add_u32 s76, s76, M_table-M_pc
  s_addc_u32 s77, s77, 0
  s_lshl_b32 s26, s65, 6
  s_load_dwordx16 s[48:63], s[76:77], s26
  s_waitcnt lgkmcnt(0)
  s_mov_b32 s23, s51
  s_lshr_b32 s29, s16, 1
  s_cmp_eq_u32 s29, 0
  s_cselect_b32 s26, 2, 8
  s_cselect_b32 s27, 3, 4
  s_cselect_b32 s28, 9, 10
  s_cmp_eq_u32 s48, 1
  s_cselect_b32 s26, s27, s26
  s_cmp_eq_u32 s48, 2
  s_cselect_b32 s26, s28, s26
  s_lshl_b32 s26, s26, 3
  s_load_dwordx2 s[8:9], s[0:1], s26
  s_cmp_eq_u32 s48, 1
  s_cselect_b32 s26, 8, 0
  s_load_dwordx2 s[12:13], s[0:1], s26
  s_cmp_eq_u32 s29, 0
  s_cselect_b32 s21, 0, 3
  s_cselect_b32 s27, 1, 2
  s_cselect_b32 s28, 4, 5
  s_cmp_eq_u32 s48, 1
  s_cselect_b32 s21, s27, s21
  s_cmp_eq_u32 s48, 2
  s_cselect_b32 s21, s28, s21
  s_lshl_b32 s21, s21, 5
  s_add_u32 s21, s21, s64
  s_lshl_b32 s21, s21, 6
  s_add_u32 s21, s21, s49
  s_and_b32 s27, s16, 1
  s_lshl_b32 s21, s21, 1
  s_add_u32 s21, s21, s27
  s_lshl_b32 s21, s21, 12
  s_lshl_b32 s22, s50, 13
  s_lshl_b32 s19, s49, 15
  s_lshl_b32 s20, s50, 15
  s_lshl_b32 s17, s64, 1
  s_add_u32 s17, s17, s27
  s_lshl_b32 s17, s17, 7
  s_mov_b32 s18, 8192
  s_cmp_eq_u32 s48, 0
  s_cselect_b32 s24, 0x3e0293ee, 1.0
  s_waitcnt lgkmcnt(0)
  s_and_b32 s9, s9, 0xffff
  s_mov_b32 s10, 4194304
  s_mov_b32 s11, 0x20000
  s_and_b32 s13, s13, 0xffff
  s_mov_b32 s14, 2097152
  s_mov_b32 s15, 0x20000
  v_and_b32 v144, 31, v1
  v_lshrrev_b32 v145, 5, v1
  v_and_b32 v146, 15, v1
  v_or_b32 v147, 0, v145
  v_xor_b32 v147, v147, v146
  v_lshlrev_b32 v147, 4, v147
  v_lshl_add_u32 v8, v144, 8, v147
  v_or_b32 v147, 2, v145
  v_xor_b32 v147, v147, v146
  v_lshlrev_b32 v147, 4, v147
  v_lshl_add_u32 v9, v144, 8, v147
  v_or_b32 v147, 4, v145
  v_xor_b32 v147, v147, v146
  v_lshlrev_b32 v147, 4, v147
  v_lshl_add_u32 v10, v144, 8, v147
  v_or_b32 v147, 6, v145
  v_xor_b32 v147, v147, v146
  v_lshlrev_b32 v147, 4, v147
  v_lshl_add_u32 v11, v144, 8, v147
  v_or_b32 v147, 8, v145
  v_xor_b32 v147, v147, v146
  v_lshlrev_b32 v147, 4, v147
  v_lshl_add_u32 v12, v144, 8, v147
  v_or_b32 v147, 10, v145
  v_xor_b32 v147, v147, v146
  v_lshlrev_b32 v147, 4, v147
  v_lshl_add_u32 v13, v144, 8, v147
  v_or_b32 v147, 12, v145
  v_xor_b32 v147, v147, v146
  v_lshlrev_b32 v147, 4, v147
  v_lshl_add_u32 v14, v144, 8, v147
  v_or_b32 v147, 14, v145
  v_xor_b32 v147, v147, v146
  v_lshlrev_b32 v147, 4, v147
  v_lshl_add_u32 v15, v144, 8, v147
  v_lshrrev_b32 v144, 4, v1
  s_lshl_b32 s26, s16, 8
  v_add_u32 v145, 0, v144
  v_and_b32 v147, 15, v145
  v_xor_b32 v147, v147, v146
  v_lshlrev_b32 v147, 4, v147
  v_lshl_add_u32 v147, v145, 10, v147
  v_add_u32 v16, s26, v147
  v_add_u32 v145, 4, v144
  v_and_b32 v147, 15, v145
  v_xor_b32 v147, v147, v146
  v_lshlrev_b32 v147, 4, v147
  v_lshl_add_u32 v147, v145, 10, v147
  v_add_u32 v17, s26, v147
  v_add_u32 v145, 8, v144
  v_and_b32 v147, 15, v145
  v_xor_b32 v147, v147, v146
  v_lshlrev_b32 v147, 4, v147
  v_lshl_add_u32 v147, v145, 10, v147
  v_add_u32 v18, s26, v147
  v_add_u32 v145, 12, v144
  v_and_b32 v147, 15, v145
  v_xor_b32 v147, v147, v146
  v_lshlrev_b32 v147, 4, v147
  v_lshl_add_u32 v147, v145, 10, v147
  v_add_u32 v19, s26, v147
  v_add_u32 v145, 16, v144
  v_and_b32 v147, 15, v145
  v_xor_b32 v147, v147, v146
  v_lshlrev_b32 v147, 4, v147
  v_lshl_add_u32 v147, v145, 10, v147
  v_add_u32 v20, s26, v147
  v_add_u32 v145, 20, v144
  v_and_b32 v147, 15, v145
  v_xor_b32 v147, v147, v146
  v_lshlrev_b32 v147, 4, v147
  v_lshl_add_u32 v147, v145, 10, v147
  v_add_u32 v21, s26, v147
  v_add_u32 v145, 24, v144
  v_and_b32 v147, 15, v145
  v_xor_b32 v147, v147, v146
  v_lshlrev_b32 v147, 4, v147
  v_lshl_add_u32 v147, v145, 10, v147
  v_add_u32 v22, s26, v147
  v_add_u32 v145, 28, v144
  v_and_b32 v147, 15, v145
  v_xor_b32 v147, v147, v146
  v_lshlrev_b32 v147, 4, v147
  v_lshl_add_u32 v147, v145, 10, v147
  v_add_u32 v23, s26, v147
  v_lshrrev_b32 v144, 3, v1
  v_mul_lo_u32 v144, v144, s18
  v_and_b32 v145, 7, v1
  v_lshl_add_u32 v144, v145, 4, v144
  s_lshl_b32 s28, s16, 15
  s_add_u32 s28, s28, 32768
  s_lshl_b32 s29, s18, 3
  s_add_u32 m0, s28, 0
  s_nop 0
  buffer_load_dwordx4 v144, s[8:11], s17 offen lds
  s_add_u32 s17, s17, s29
  s_add_u32 m0, s28, 1024
  s_nop 0
  buffer_load_dwordx4 v144, s[8:11], s17 offen lds
  s_add_u32 s17, s17, s29
  s_add_u32 m0, s28, 2048
  s_nop 0
  buffer_load_dwordx4 v144, s[8:11], s17 offen lds
  s_add_u32 s17, s17, s29
  s_add_u32 m0, s28, 3072
  s_nop 0
  buffer_load_dwordx4 v144, s[8:11], s17 offen lds
  s_add_u32 s17, s17, s29
  s_add_u32 m0, s28, 4096
  s_nop 0
  buffer_load_dwordx4 v144, s[8:11], s17 offen lds
  s_add_u32 s17, s17, s29
  s_add_u32 m0, s28, 5120
  s_nop 0
  buffer_load_dwordx4 v144, s[8:11], s17 offen lds
  s_add_u32 s17, s17, s29
  s_add_u32 m0, s28, 6144
  s_nop 0
  buffer_load_dwordx4 v144, s[8:11], s17 offen lds
  s_add_u32 s17, s17, s29
  s_add_u32 m0, s28, 7168
  s_nop 0
  buffer_load_dwordx4 v144, s[8:11], s17 offen lds
  s_add_u32 s17, s17, s29
  s_add_u32 m0, s28, 8192
  s_nop 0
  buffer_load_dwordx4 v144, s[8:11], s17 offen lds
  s_add_u32 s17, s17, s29
  s_add_u32 m0, s28, 9216
  s_nop 0
  buffer_load_dwordx4 v144, s[8:11], s17 offen lds
  s_add_u32 s17, s17, s29
  s_add_u32 m0, s28, 10240
  s_nop 0
  buffer_load_dwordx4 v144, s[8:11], s17 offen lds
  s_add_u32 s17, s17, s29
  s_add_u32 m0, s28, 11264
  s_nop 0
  buffer_load_dwordx4 v144, s[8:11], s17 offen lds
  s_add_u32 s17, s17, s29
  s_add_u32 m0, s28, 12288
  s_nop 0
  buffer_load_dwordx4 v144, s[8:11], s17 offen lds
  s_add_u32 s17, s17, s29
  s_add_u32 m0, s28, 13312
  s_nop 0
  buffer_load_dwordx4 v144, s[8:11], s17 offen lds
  s_add_u32 s17, s17, s29
  s_add_u32 m0, s28, 14336
  s_nop 0
  buffer_load_dwordx4 v144, s[8:11], s17 offen lds
  s_add_u32 s17, s17, s29
  s_add_u32 m0, s28, 15360
  s_nop 0
  buffer_load_dwordx4 v144, s[8:11], s17 offen lds
  s_add_u32 s17, s17, s29
  s_add_u32 m0, s28, 16384
  s_nop 0
  buffer_load_dwordx4 v144, s[8:11], s17 offen lds
  s_add_u32 s17, s17, s29
  s_add_u32 m0, s28, 17408
  s_nop 0
  buffer_load_dwordx4 v144, s[8:11], s17 offen lds
  s_add_u32 s17, s17, s29
  s_add_u32 m0, s28, 18432
  s_nop 0
  buffer_load_dwordx4 v144, s[8:11], s17 offen lds
  s_add_u32 s17, s17, s29
  s_add_u32 m0, s28, 19456
  s_nop 0
  buffer_load_dwordx4 v144, s[8:11], s17 offen lds
  s_add_u32 s17, s17, s29
  s_add_u32 m0, s28, 20480
  s_nop 0
  buffer_load_dwordx4 v144, s[8:11], s17 offen lds
  s_add_u32 s17, s17, s29
  s_add_u32 m0, s28, 21504
  s_nop 0
  buffer_load_dwordx4 v144, s[8:11], s17 offen lds
  s_add_u32 s17, s17, s29
  s_add_u32 m0, s28, 22528
  s_nop 0
  buffer_load_dwordx4 v144, s[8:11], s17 offen lds
  s_add_u32 s17, s17, s29
  s_add_u32 m0, s28, 23552
  s_nop 0
  buffer_load_dwordx4 v144, s[8:11], s17 offen lds
  s_add_u32 s17, s17, s29
  s_add_u32 m0, s28, 24576
  s_nop 0
  buffer_load_dwordx4 v144, s[8:11], s17 offen lds
  s_add_u32 s17, s17, s29
  s_add_u32 m0, s28, 25600
  s_nop 0
  buffer_load_dwordx4 v144, s[8:11], s17 offen lds
  s_add_u32 s17, s17, s29
  s_add_u32 m0, s28, 26624
  s_nop 0
  buffer_load_dwordx4 v144, s[8:11], s17 offen lds
  s_add_u32 s17, s17, s29
  s_add_u32 m0, s28, 27648
  s_nop 0
  buffer_load_dwordx4 v144, s[8:11], s17 offen lds
  s_add_u32 s17, s17, s29
  s_add_u32 m0, s28, 28672
  s_nop 0
  buffer_load_dwordx4 v144, s[8:11], s17 offen lds
  s_add_u32 s17, s17, s29
  s_add_u32 m0, s28, 29696
  s_nop 0
  buffer_load_dwordx4 v144, s[8:11], s17 offen lds
  s_add_u32 s17, s17, s29
  s_add_u32 m0, s28, 30720
  s_nop 0
  buffer_load_dwordx4 v144, s[8:11], s17 offen lds
  s_add_u32 s17, s17, s29
  s_add_u32 m0, s28, 31744
  s_nop 0
  buffer_load_dwordx4 v144, s[8:11], s17 offen lds
  s_add_u32 s17, s17, s29
  s_lshl_b32 s25, s16, 13
  s_add_u32 m0, s25, 0
  s_nop 0
  buffer_load_dwordx4 v16, s[12:15], s19 offen lds
  s_add_u32 m0, s25, 1024
  s_nop 0
  buffer_load_dwordx4 v17, s[12:15], s19 offen lds
  s_add_u32 m0, s25, 2048
  s_nop 0
  buffer_load_dwordx4 v18, s[12:15], s19 offen lds
  s_add_u32 m0, s25, 3072
  s_nop 0
  buffer_load_dwordx4 v19, s[12:15], s19 offen lds
  s_add_u32 m0, s25, 4096
  s_nop 0
  buffer_load_dwordx4 v20, s[12:15], s19 offen lds
  s_add_u32 m0, s25, 5120
  s_nop 0
  buffer_load_dwordx4 v21, s[12:15], s19 offen lds
  s_add_u32 m0, s25, 6144
  s_nop 0
  buffer_load_dwordx4 v22, s[12:15], s19 offen lds
  s_add_u32 m0, s25, 7168
  s_nop 0
  buffer_load_dwordx4 v23, s[12:15], s19 offen lds
  s_cmp_gt_u32 s23, 1
  s_cselect_b32 s26, s20, 0
  s_add_u32 s19, s19, s26
  s_add_u32 s25, s25, 32768
  s_and_b32 s25, s25, 0x1ffff
  s_cmp_lg_u32 s16, 3
  s_cbranch_scc1 M_noinit
  s_mov_b32 s79, 0
  s_atomic_swap s79, s[72:73], s31 glc
  s_waitcnt lgkmcnt(0)
  s_mov_b32 s79, 1
  s_atomic_add s79, s[74:75], 128
M_noinit:
  s_mul_i32 s76, s64, 3
  s_add_u32 s76, s76, s57
  s_mul_i32 s76, s76, 24576
  v_lshlrev_b32 v4, 7, v0
  v_add_u32 v4, s76, v4
  buffer_load_dword v5, v4, s[12:15], 0 offen
  buffer_load_dword v5, v4, s[12:15], 0 offen offset:64
  v_bfe_u32 v148, v1, 2, 2
  v_lshrrev_b32 v149, 5, v1
  v_lshl_add_u32 v148, v149, 3, v148
  v_lshlrev_b32 v148, 7, v148
  v_bfe_u32 v149, v1, 4, 1
  v_lshl_add_u32 v148, v149, 5, v148
  v_and_b32 v149, 3, v1
  v_lshl_add_u32 v148, v149, 3, v148
  v_add_u32 v146, s28, v148
  v_add_u32 v147, 512, v146
  s_waitcnt vmcnt(38)
  ds_read_b64_tr_b16 a[0:1], v146 offset:0
  ds_read_b64_tr_b16 a[2:3], v147 offset:0
  ds_read_b64_tr_b16 a[4:5], v146 offset:64
  ds_read_b64_tr_b16 a[6:7], v147 offset:64
  ds_read_b64_tr_b16 a[8:9], v146 offset:2048
  ds_read_b64_tr_b16 a[10:11], v147 offset:2048
  ds_read_b64_tr_b16 a[12:13], v146 offset:2112
  ds_read_b64_tr_b16 a[14:15], v147 offset:2112
  s_waitcnt lgkmcnt(0)
  s_add_u32 m0, s28, 0
  s_nop 0
  buffer_load_dwordx4 v144, s[8:11], s17 offen lds
  s_add_u32 s17, s17, s29
  s_add_u32 m0, s28, 1024
  s_nop 0
  buffer_load_dwordx4 v144, s[8:11], s17 offen lds
  s_add_u32 s17, s17, s29
  s_add_u32 m0, s28, 2048
  s_nop 0
  buffer_load_dwordx4 v144, s[8:11], s17 offen lds
  s_add_u32 s17, s17, s29
  s_add_u32 m0, s28, 3072
  s_nop 0
  buffer_load_dwordx4 v144, s[8:11], s17 offen lds
  s_add_u32 s17, s17, s29
  s_waitcnt vmcnt(38)
  ds_read_b64_tr_b16 a[16:17], v146 offset:4096
  ds_read_b64_tr_b16 a[18:19], v147 offset:4096
  ds_read_b64_tr_b16 a[20:21], v146 offset:4160
  ds_read_b64_tr_b16 a[22:23], v147 offset:4160
  ds_read_b64_tr_b16 a[24:25], v146 offset:6144
  ds_read_b64_tr_b16 a[26:27], v147 offset:6144
  ds_read_b64_tr_b16 a[28:29], v146 offset:6208
  ds_read_b64_tr_b16 a[30:31], v147 offset:6208
  s_waitcnt lgkmcnt(0)
  s_add_u32 m0, s28, 4096
  s_nop 0
  buffer_load_dwordx4 v144, s[8:11], s17 offen lds
  s_add_u32 s17, s17, s29
  s_add_u32 m0, s28, 5120
  s_nop 0
  buffer_load_dwordx4 v144, s[8:11], s17 offen lds
  s_add_u32 s17, s17, s29
  s_add_u32 m0, s28, 6144
  s_nop 0
  buffer_load_dwordx4 v144, s[8:11], s17 offen lds
  s_add_u32 s17, s17, s29
  s_add_u32 m0, s28, 7168
  s_nop 0
  buffer_load_dwordx4 v144, s[8:11], s17 offen lds
  s_add_u32 s17, s17, s29
  s_waitcnt vmcnt(38)
  ds_read_b64_tr_b16 a[32:33], v146 offset:8192
  ds_read_b64_tr_b16 a[34:35], v147 offset:8192
  ds_read_b64_tr_b16 a[36:37], v146 offset:8256
  ds_read_b64_tr_b16 a[38:39], v147 offset:8256
  ds_read_b64_tr_b16 a[40:41], v146 offset:10240
  ds_read_b64_tr_b16 a[42:43], v147 offset:10240
  ds_read_b64_tr_b16 a[44:45], v146 offset:10304
  ds_read_b64_tr_b16 a[46:47], v147 offset:10304
  s_waitcnt lgkmcnt(0)
  s_add_u32 m0, s28, 8192
  s_nop 0
  buffer_load_dwordx4 v144, s[8:11], s17 offen lds
  s_add_u32 s17, s17, s29
  s_add_u32 m0, s28, 9216
  s_nop 0
  buffer_load_dwordx4 v144, s[8:11], s17 offen lds
  s_add_u32 s17, s17, s29
  s_add_u32 m0, s28, 10240
  s_nop 0
  buffer_load_dwordx4 v144, s[8:11], s17 offen lds
  s_add_u32 s17, s17, s29
  s_add_u32 m0, s28, 11264
  s_nop 0
  buffer_load_dwordx4 v144, s[8:11], s17 offen lds
  s_add_u32 s17, s17, s29
  s_waitcnt vmcnt(38)
  ds_read_b64_tr_b16 a[48:49], v146 offset:12288
  ds_read_b64_tr_b16 a[50:51], v147 offset:12288
  ds_read_b64_tr_b16 a[52:53], v146 offset:12352
  ds_read_b64_tr_b16 a[54:55], v147 offset:12352
  ds_read_b64_tr_b16 a[56:57], v146 offset:14336
  ds_read_b64_tr_b16 a[58:59], v147 offset:14336
  ds_read_b64_tr_b16 a[60:61], v146 offset:14400
  ds_read_b64_tr_b16 a[62:63], v147 offset:14400
  s_waitcnt lgkmcnt(0)
  s_add_u32 m0, s28, 12288
  s_nop 0
  buffer_load_dwordx4 v144, s[8:11], s17 offen lds
  s_add_u32 s17, s17, s29
  s_add_u32 m0, s28, 13312
  s_nop 0
  buffer_load_dwordx4 v144, s[8:11], s17 offen lds
  s_add_u32 s17, s17, s29
  s_add_u32 m0, s28, 14336
  s_nop 0
  buffer_load_dwordx4 v144, s[8:11], s17 offen lds
  s_add_u32 s17, s17, s29
  s_add_u32 m0, s28, 15360
  s_nop 0
  buffer_load_dwordx4 v144, s[8:11], s17 offen lds
  s_add_u32 s17, s17, s29
  s_waitcnt vmcnt(38)
  ds_read_b64_tr_b16 a[64:65], v146 offset:16384
  ds_read_b64_tr_b16 a[66:67], v147 offset:16384
  ds_read_b64_tr_b16 a[68:69], v146 offset:16448
  ds_read_b64_tr_b16 a[70:71], v147 offset:16448
  ds_read_b64_tr_b16 a[72:73], v146 offset:18432
  ds_read_b64_tr_b16 a[74:75], v147 offset:18432
  ds_read_b64_tr_b16 a[76:77], v146 offset:18496
  ds_read_b64_tr_b16 a[78:79], v147 offset:18496
  s_waitcnt lgkmcnt(0)
  s_add_u32 m0, s28, 16384
  s_nop 0
  buffer_load_dwordx4 v144, s[8:11], s17 offen lds
  s_add_u32 s17, s17, s29
  s_add_u32 m0, s28, 17408
  s_nop 0
  buffer_load_dwordx4 v144, s[8:11], s17 offen lds
  s_add_u32 s17, s17, s29
  s_add_u32 m0, s28, 18432
  s_nop 0
  buffer_load_dwordx4 v144, s[8:11], s17 offen lds
  s_add_u32 s17, s17, s29
  s_add_u32 m0, s28, 19456
  s_nop 0
  buffer_load_dwordx4 v144, s[8:11], s17 offen lds
  s_add_u32 s17, s17, s29
  s_waitcnt vmcnt(38)
  ds_read_b64_tr_b16 a[80:81], v146 offset:20480
  ds_read_b64_tr_b16 a[82:83], v147 offset:20480
  ds_read_b64_tr_b16 a[84:85], v146 offset:20544
  ds_read_b64_tr_b16 a[86:87], v147 offset:20544
  ds_read_b64_tr_b16 a[88:89], v146 offset:22528
  ds_read_b64_tr_b16 a[90:91], v147 offset:22528
  ds_read_b64_tr_b16 a[92:93], v146 offset:22592
  ds_read_b64_tr_b16 a[94:95], v147 offset:22592
  s_waitcnt lgkmcnt(0)
  s_add_u32 m0, s28, 20480
  s_nop 0
  buffer_load_dwordx4 v144, s[8:11], s17 offen lds
  s_add_u32 s17, s17, s29
  s_add_u32 m0, s28, 21504
  s_nop 0
  buffer_load_dwordx4 v144, s[8:11], s17 offen lds
  s_add_u32 s17, s17, s29
  s_add_u32 m0, s28, 22528
  s_nop 0
  buffer_load_dwordx4 v144, s[8:11], s17 offen lds
  s_add_u32 s17, s17, s29
  s_add_u32 m0, s28, 23552
  s_nop 0
  buffer_load_dwordx4 v144, s[8:11], s17 offen lds
  s_add_u32 s17, s17, s29
  s_waitcnt vmcnt(38)
  ds_read_b64_tr_b16 a[96:97], v146 offset:24576
  ds_read_b64_tr_b16 a[98:99], v147 offset:24576
  ds_read_b64_tr_b16 a[100:101], v146 offset:24640
  ds_read_b64_tr_b16 a[102:103], v147 offset:24640
  ds_read_b64_tr_b16 a[104:105], v146 offset:26624
  ds_read_b64_tr_b16 a[106:107], v147 offset:26624
  ds_read_b64_tr_b16 a[108:109], v146 offset:26688
  ds_read_b64_tr_b16 a[110:111], v147 offset:26688
  s_waitcnt lgkmcnt(0)
  s_add_u32 m0, s28, 24576
  s_nop 0
  buffer_load_dwordx4 v144, s[8:11], s17 offen lds
  s_add_u32 s17, s17, s29
  s_add_u32 m0, s28, 25600
  s_nop 0
  buffer_load_dwordx4 v144, s[8:11], s17 offen lds
  s_add_u32 s17, s17, s29
  s_add_u32 m0, s28, 26624
  s_nop 0
  buffer_load_dwordx4 v144, s[8:11], s17 offen lds
  s_add_u32 s17, s17, s29
  s_add_u32 m0, s28, 27648
  s_nop 0
  buffer_load_dwordx4 v144, s[8:11], s17 offen lds
  s_add_u32 s17, s17, s29
  s_waitcnt vmcnt(38)
  ds_read_b64_tr_b16 a[112:113], v146 offset:28672
  ds_read_b64_tr_b16 a[114:115], v147 offset:28672
  ds_read_b64_tr_b16 a[116:117], v146 offset:28736
  ds_read_b64_tr_b16 a[118:119], v147 offset:28736
  ds_read_b64_tr_b16 a[120:121], v146 offset:30720
  ds_read_b64_tr_b16 a[122:123], v147 offset:30720
  ds_read_b64_tr_b16 a[124:125], v146 offset:30784
  ds_read_b64_tr_b16 a[126:127], v147 offset:30784
  s_waitcnt lgkmcnt(0)
  s_add_u32 m0, s28, 28672
  s_nop 0
  buffer_load_dwordx4 v144, s[8:11], s17 offen lds
  s_add_u32 s17, s17, s29
  s_add_u32 m0, s28, 29696
  s_nop 0
  buffer_load_dwordx4 v144, s[8:11], s17 offen lds
  s_add_u32 s17, s17, s29
  s_add_u32 m0, s28, 30720
  s_nop 0
  buffer_load_dwordx4 v144, s[8:11], s17 offen lds
  s_add_u32 s17, s17, s29
  s_add_u32 m0, s28, 31744
  s_nop 0
  buffer_load_dwordx4 v144, s[8:11], s17 offen lds
  s_add_u32 s17, s17, s29
  s_waitcnt vmcnt(28)
  ds_read_b64_tr_b16 a[128:129], v146 offset:0
  ds_read_b64_tr_b16 a[130:131], v147 offset:0
  ds_read_b64_tr_b16 a[132:133], v146 offset:64
  ds_read_b64_tr_b16 a[134:135], v147 offset:64
  ds_read_b64_tr_b16 a[136:137], v146 offset:2048
  ds_read_b64_tr_b16 a[138:139], v147 offset:2048
  ds_read_b64_tr_b16 a[140:141], v146 offset:2112
  ds_read_b64_tr_b16 a[142:143], v147 offset:2112
  s_waitcnt lgkmcnt(0)
  s_waitcnt vmcnt(24)
  ds_read_b64_tr_b16 a[144:145], v146 offset:4096
  ds_read_b64_tr_b16 a[146:147], v147 offset:4096
  ds_read_b64_tr_b16 a[148:149], v146 offset:4160
  ds_read_b64_tr_b16 a[150:151], v147 offset:4160
  ds_read_b64_tr_b16 a[152:153], v146 offset:6144
  ds_read_b64_tr_b16 a[154:155], v147 offset:6144
  ds_read_b64_tr_b16 a[156:157], v146 offset:6208
  ds_read_b64_tr_b16 a[158:159], v147 offset:6208
  s_waitcnt lgkmcnt(0)
  s_waitcnt vmcnt(20)
  ds_read_b64_tr_b16 a[160:161], v146 offset:8192
  ds_read_b64_tr_b16 a[162:163], v147 offset:8192
  ds_read_b64_tr_b16 a[164:165], v146 offset:8256
  ds_read_b64_tr_b16 a[166:167], v147 offset:8256
  ds_read_b64_tr_b16 a[168:169], v146 offset:10240
  ds_read_b64_tr_b16 a[170:171], v147 offset:10240
  ds_read_b64_tr_b16 a[172:173], v146 offset:10304
  ds_read_b64_tr_b16 a[174:175], v147 offset:10304
  s_waitcnt lgkmcnt(0)
  s_waitcnt vmcnt(16)
  ds_read_b64_tr_b16 a[176:177], v146 offset:12288
  ds_read_b64_tr_b16 a[178:179], v147 offset:12288
  ds_read_b64_tr_b16 a[180:181], v146 offset:12352
  ds_read_b64_tr_b16 a[182:183], v147 offset:12352
  ds_read_b64_tr_b16 a[184:185], v146 offset:14336
  ds_read_b64_tr_b16 a[186:187], v147 offset:14336
  ds_read_b64_tr_b16 a[188:189], v146 offset:14400
  ds_read_b64_tr_b16 a[190:191], v147 offset:14400
  s_waitcnt lgkmcnt(0)
  s_waitcnt vmcnt(12)
  ds_read_b64_tr_b16 a[192:193], v146 offset:16384
  ds_read_b64_tr_b16 a[194:195], v147 offset:16384
  ds_read_b64_tr_b16 a[196:197], v146 offset:16448
  ds_read_b64_tr_b16 a[198:199], v147 offset:16448
  ds_read_b64_tr_b16 a[200:201], v146 offset:18432
  ds_read_b64_tr_b16 a[202:203], v147 offset:18432
  ds_read_b64_tr_b16 a[204:205], v146 offset:18496
  ds_read_b64_tr_b16 a[206:207], v147 offset:18496
  s_waitcnt lgkmcnt(0)
  s_waitcnt vmcnt(8)
  ds_read_b64_tr_b16 a[208:209], v146 offset:20480
  ds_read_b64_tr_b16 a[210:211], v147 offset:20480
  ds_read_b64_tr_b16 a[212:213], v146 offset:20544
  ds_read_b64_tr_b16 a[214:215], v147 offset:20544
  ds_read_b64_tr_b16 a[216:217], v146 offset:22528
  ds_read_b64_tr_b16 a[218:219], v147 offset:22528
  ds_read_b64_tr_b16 a[220:221], v146 offset:22592
  ds_read_b64_tr_b16 a[222:223], v147 offset:22592
  s_waitcnt lgkmcnt(0)
  s_waitcnt vmcnt(4)
  ds_read_b64_tr_b16 a[224:225], v146 offset:24576
  ds_read_b64_tr_b16 a[226:227], v147 offset:24576
  ds_read_b64_tr_b16 a[228:229], v146 offset:24640
  ds_read_b64_tr_b16 a[230:231], v147 offset:24640
  ds_read_b64_tr_b16 a[232:233], v146 offset:26624
  ds_read_b64_tr_b16 a[234:235], v147 offset:26624
  ds_read_b64_tr_b16 a[236:237], v146 offset:26688
  ds_read_b64_tr_b16 a[238:239], v147 offset:26688
  s_waitcnt lgkmcnt(0)
  s_waitcnt vmcnt(0)
  ds_read_b64_tr_b16 a[240:241], v146 offset:28672
  ds_read_b64_tr_b16 a[242:243], v147 offset:28672
  ds_read_b64_tr_b16 a[244:245], v146 offset:28736
  ds_read_b64_tr_b16 a[246:247], v147 offset:28736
  ds_read_b64_tr_b16 a[248:249], v146 offset:30720
  ds_read_b64_tr_b16 a[250:251], v147 offset:30720
  ds_read_b64_tr_b16 a[252:253], v146 offset:30784
  ds_read_b64_tr_b16 a[254:255], v147 offset:30784
  s_waitcnt lgkmcnt(0)
  s_barrier
  s_add_u32 m0, s25, 0
  s_nop 0
  buffer_load_dwordx4 v16, s[12:15], s19 offen lds
  s_add_u32 m0, s25, 1024
  s_nop 0
  buffer_load_dwordx4 v17, s[12:15], s19 offen lds
  s_add_u32 m0, s25, 2048
  s_nop 0
  buffer_load_dwordx4 v18, s[12:15], s19 offen lds
  s_add_u32 m0, s25, 3072
  s_nop 0
  buffer_load_dwordx4 v19, s[12:15], s19 offen lds
  s_add_u32 m0, s25, 4096
  s_nop 0
  buffer_load_dwordx4 v20, s[12:15], s19 offen lds
  s_add_u32 m0, s25, 5120
  s_nop 0
  buffer_load_dwordx4 v21, s[12:15], s19 offen lds
  s_add_u32 m0, s25, 6144
  s_nop 0
  buffer_load_dwordx4 v22, s[12:15], s19 offen lds
  s_add_u32 m0, s25, 7168
  s_nop 0
  buffer_load_dwordx4 v23, s[12:15], s19 offen lds
  s_cmp_gt_u32 s23, 2
  s_cselect_b32 s26, s20, 0
  s_add_u32 s19, s19, s26
  s_add_u32 s25, s25, 32768
  s_and_b32 s25, s25, 0x1ffff
  s_waitcnt vmcnt(0)
  s_barrier
  s_cmp_eq_u32 s48, 0
  s_cselect_b32 s26, 0, s16
  s_cmp_ge_u32 s26, 2
  s_cbranch_scc1 P_v_1
  s_mov_b32 s27, s21
  v_mov_b32 v7, 0x40000000
  s_mov_b32 s29, -3
  v_min_u32 v145, 1, v0
  v_lshlrev_b32 v145, 30, v145
  ds_read_b128 v[24:27], v8 offset:0
  ds_read_b128 v[28:31], v9 offset:0
  ds_read_b128 v[32:35], v10 offset:0
  ds_read_b128 v[36:39], v11 offset:0
  ds_read_b128 v[40:43], v12 offset:0
  ds_read_b128 v[44:47], v13 offset:0
.p2align 6
G_top_3:
  s_waitcnt lgkmcnt(5)
  v_mfma_f32_32x32x16_bf16 v[64:79], a[0:3], v[24:27], 0
  s_add_u32 m0, s25, 0
  ds_read_b128 v[48:51], v14 offset:0
  v_mfma_f32_32x32x16_bf16 v[80:95], a[4:7], v[24:27], 0
  s_waitcnt lgkmcnt(5)
  buffer_load_dwordx4 v16, s[12:15], s19 offen lds
  v_mfma_f32_32x32x16_bf16 v[64:79], a[8:11], v[28:31], v[64:79]
  ds_read_b128 v[52:55], v15 offset:0
  v_mul_f32 v96, s24, v96
  v_mul_f32 v97, s24, v97
  v_mfma_f32_32x32x16_bf16 v[80:95], a[12:15], v[28:31], v[80:95]
  s_waitcnt lgkmcnt(5)
  v_cvt_pk_bf16_f32 v128, v96, v97
  v_mul_f32 v98, s24, v98
  v_mfma_f32_32x32x16_bf16 v[64:79], a[16:19], v[32:35], v[64:79]
  s_add_u32 m0, s25, 1024
  ds_read_b128 v[24:27], v8 offset:8192
  v_mul_f32 v99, s24, v99
  v_cvt_pk_bf16_f32 v129, v98, v99
  v_mfma_f32_32x32x16_bf16 v[80:95], a[20:23], v[32:35], v[80:95]
  s_waitcnt lgkmcnt(5)
  buffer_load_dwordx4 v17, s[12:15], s19 offen lds
  v_mul_f32 v100, s24, v100
  v_mul_f32 v101, s24, v101
  v_mfma_f32_32x32x16_bf16 v[64:79], a[24:27], v[36:39], v[64:79]
  ds_read_b128 v[28:31], v9 offset:8192
  v_cvt_pk_bf16_f32 v130, v100, v101
  v_mul_f32 v102, s24, v102
  v_mfma_f32_32x32x16_bf16 v[80:95], a[28:31], v[36:39], v[80:95]
  s_waitcnt lgkmcnt(5)
  v_mul_f32 v103, s24, v103
  v_cvt_pk_bf16_f32 v131, v102, v103
  v_mfma_f32_32x32x16_bf16 v[64:79], a[32:35], v[40:43], v[64:79]
  s_add_u32 m0, s25, 2048
  ds_read_b128 v[32:35], v10 offset:8192
  v_mul_f32 v104, s24, v104
  v_mul_f32 v105, s24, v105
  v_mfma_f32_32x32x16_bf16 v[80:95], a[36:39], v[40:43], v[80:95]
  s_waitcnt lgkmcnt(5)
  buffer_load_dwordx4 v18, s[12:15], s19 offen lds
  v_cvt_pk_bf16_f32 v132, v104, v105
  v_mul_f32 v106, s24, v106
  v_mfma_f32_32x32x16_bf16 v[64:79], a[40:43], v[44:47], v[64:79]
  ds_read_b128 v[36:39], v11 offset:8192
  v_mul_f32 v107, s24, v107
  v_cvt_pk_bf16_f32 v133, v106, v107
  v_mfma_f32_32x32x16_bf16 v[80:95], a[44:47], v[44:47], v[80:95]
  s_waitcnt lgkmcnt(5)
  v_mul_f32 v108, s24, v108
  v_mul_f32 v109, s24, v109
  v_mfma_f32_32x32x16_bf16 v[64:79], a[48:51], v[48:51], v[64:79]
  s_add_u32 m0, s25, 3072
  ds_read_b128 v[40:43], v12 offset:8192
  v_cvt_pk_bf16_f32 v134, v108, v109
  v_mul_f32 v110, s24, v110
  v_mfma_f32_32x32x16_bf16 v[80:95], a[52:55], v[48:51], v[80:95]
  s_waitcnt lgkmcnt(5)
  buffer_load_dwordx4 v19, s[12:15], s19 offen lds
  v_mul_f32 v111, s24, v111
  v_cvt_pk_bf16_f32 v135, v110, v111
  v_mfma_f32_32x32x16_bf16 v[64:79], a[56:59], v[52:55], v[64:79]
  ds_read_b128 v[44:47], v13 offset:8192
  v_mul_f32 v112, s24, v112
  v_mul_f32 v113, s24, v113
  v_mfma_f32_32x32x16_bf16 v[80:95], a[60:63], v[52:55], v[80:95]
  s_waitcnt lgkmcnt(5)
  v_cvt_pk_bf16_f32 v136, v112, v113
  v_mul_f32 v114, s24, v114
  v_mfma_f32_32x32x16_bf16 v[64:79], a[64:67], v[24:27], v[64:79]
  s_add_u32 m0, s25, 4096
  ds_read_b128 v[48:51], v14 offset:8192
  v_mul_f32 v115, s24, v115
  v_cvt_pk_bf16_f32 v137, v114, v115
  v_mfma_f32_32x32x16_bf16 v[80:95], a[68:71], v[24:27], v[80:95]
  s_waitcnt lgkmcnt(5)
  buffer_load_dwordx4 v20, s[12:15], s19 offen lds
  v_mul_f32 v116, s24, v116
  v_mul_f32 v117, s24, v117
  v_mfma_f32_32x32x16_bf16 v[64:79], a[72:75], v[28:31], v[64:79]
  ds_read_b128 v[52:55], v15 offset:8192
  v_cvt_pk_bf16_f32 v138, v116, v117
  v_mul_f32 v118, s24, v118
  v_mfma_f32_32x32x16_bf16 v[80:95], a[76:79], v[28:31], v[80:95]
  s_waitcnt lgkmcnt(5)
  v_mul_f32 v119, s24, v119
  v_cvt_pk_bf16_f32 v139, v118, v119
  v_mfma_f32_32x32x16_bf16 v[64:79], a[80:83], v[32:35], v[64:79]
  s_add_u32 m0, s25, 5120
  ds_read_b128 v[24:27], v8 offset:16384
  v_mul_f32 v120, s24, v120
  v_mul_f32 v121, s24, v121
  v_mfma_f32_32x32x16_bf16 v[80:95], a[84:87], v[32:35], v[80:95]
  s_waitcnt lgkmcnt(5)
  buffer_load_dwordx4 v21, s[12:15], s19 offen lds
  v_cvt_pk_bf16_f32 v140, v120, v121
  v_mul_f32 v122, s24, v122
  v_mfma_f32_32x32x16_bf16 v[64:79], a[88:91], v[36:39], v[64:79]
  ds_read_b128 v[28:31], v9 offset:16384
  v_mul_f32 v123, s24, v123
  v_cvt_pk_bf16_f32 v141, v122, v123
  v_mfma_f32_32x32x16_bf16 v[80:95], a[92:95], v[36:39], v[80:95]
  s_waitcnt lgkmcnt(5)
  v_mul_f32 v124, s24, v124
  v_mul_f32 v125, s24, v125
  v_mfma_f32_32x32x16_bf16 v[64:79], a[96:99], v[40:43], v[64:79]
  s_add_u32 m0, s25, 6144
  ds_read_b128 v[32:35], v10 offset:16384
  v_cvt_pk_bf16_f32 v142, v124, v125
  v_mul_f32 v126, s24, v126
  v_mfma_f32_32x32x16_bf16 v[80:95], a[100:103], v[40:43], v[80:95]
  s_waitcnt lgkmcnt(5)
  buffer_load_dwordx4 v22, s[12:15], s19 offen lds
  v_mul_f32 v127, s24, v127
  v_cvt_pk_bf16_f32 v143, v126, v127
  v_mfma_f32_32x32x16_bf16 v[64:79], a[104:107], v[44:47], v[64:79]
  ds_read_b128 v[36:39], v11 offset:16384
  v_mfma_f32_32x32x16_bf16 v[80:95], a[108:111], v[44:47], v[80:95]
  s_waitcnt lgkmcnt(5)
  v_mfma_f32_32x32x16_bf16 v[64:79], a[112:115], v[48:51], v[64:79]
  s_add_u32 m0, s25, 7168
  ds_read_b128 v[40:43], v12 offset:16384
  v_mfma_f32_32x32x16_bf16 v[80:95], a[116:119], v[48:51], v[80:95]
  s_waitcnt lgkmcnt(5)
  buffer_load_dwordx4 v23, s[12:15], s19 offen lds
  v_mfma_f32_32x32x16_bf16 v[64:79], a[120:123], v[52:55], v[64:79]
  s_cmp_gt_u32 s23, 3
  ds_read_b128 v[44:47], v13 offset:16384
  v_mfma_f32_32x32x16_bf16 v[80:95], a[124:127], v[52:55], v[80:95]
  s_waitcnt lgkmcnt(5)
  s_cselect_b32 s26, s20, 0
  v_mfma_f32_32x32x16_bf16 v[64:79], a[128:131], v[24:27], v[64:79]
  s_add_u32 s19, s19, s26
  ds_read_b128 v[48:51], v14 offset:16384
  v_mfma_f32_32x32x16_bf16 v[80:95], a[132:135], v[24:27], v[80:95]
  s_waitcnt lgkmcnt(5)
  s_add_u32 s25, s25, 32768
  v_mfma_f32_32x32x16_bf16 v[64:79], a[136:139], v[28:31], v[64:79]
  s_and_b32 s25, s25, 0x1ffff
  ds_read_b128 v[52:55], v15 offset:16384
  v_mfma_f32_32x32x16_bf16 v[80:95], a[140:143], v[28:31], v[80:95]
  s_waitcnt lgkmcnt(5)
  buffer_store_dwordx4 v[128:131], v7, s[4:7], s21 offen offset:0 sc1
  v_mfma_f32_32x32x16_bf16 v[64:79], a[144:147], v[32:35], v[64:79]
  ds_read_b128 v[24:27], v8 offset:24576
  v_mfma_f32_32x32x16_bf16 v[80:95], a[148:151], v[32:35], v[80:95]
  s_waitcnt lgkmcnt(5)
  v_mfma_f32_32x32x16_bf16 v[64:79], a[152:155], v[36:39], v[64:79]
  ds_read_b128 v[28:31], v9 offset:24576
  v_mfma_f32_32x32x16_bf16 v[80:95], a[156:159], v[36:39], v[80:95]
  s_waitcnt lgkmcnt(5)
  buffer_store_dwordx4 v[132:135], v7, s[4:7], s21 offen offset:1024 sc1
  v_mfma_f32_32x32x16_bf16 v[64:79], a[160:163], v[40:43], v[64:79]
  ds_read_b128 v[32:35], v10 offset:24576
  v_mfma_f32_32x32x16_bf16 v[80:95], a[164:167], v[40:43], v[80:95]
  s_waitcnt lgkmcnt(5)
  v_mfma_f32_32x32x16_bf16 v[64:79], a[168:171], v[44:47], v[64:79]
  ds_read_b128 v[36:39], v11 offset:24576
  v_mfma_f32_32x32x16_bf16 v[80:95], a[172:175], v[44:47], v[80:95]
  s_waitcnt lgkmcnt(5)
  buffer_store_dwordx4 v[136:139], v7, s[4:7], s21 offen offset:2048 sc1
  v_mfma_f32_32x32x16_bf16 v[64:79], a[176:179], v[48:51], v[64:79]
  ds_read_b128 v[40:43], v12 offset:24576
  v_mfma_f32_32x32x16_bf16 v[80:95], a[180:183], v[48:51], v[80:95]
  s_waitcnt lgkmcnt(5)
  v_mfma_f32_32x32x16_bf16 v[64:79], a[184:187], v[52:55], v[64:79]
  ds_read_b128 v[44:47], v13 offset:24576
  v_mfma_f32_32x32x16_bf16 v[80:95], a[188:191], v[52:55], v[80:95]
  s_waitcnt lgkmcnt(5)
  buffer_store_dwordx4 v[140:143], v7, s[4:7], s21 offen offset:3072 sc1
  v_mfma_f32_32x32x16_bf16 v[64:79], a[192:195], v[24:27], v[64:79]
  s_mov_b32 s21, s27
  ds_read_b128 v[48:51], v14 offset:24576
  v_mov_b32 v7, v2
  v_mfma_f32_32x32x16_bf16 v[80:95], a[196:199], v[24:27], v[80:95]
  s_waitcnt lgkmcnt(5)
  v_mfma_f32_32x32x16_bf16 v[64:79], a[200:203], v[28:31], v[64:79]
  s_add_u32 s27, s27, s22
  ds_read_b128 v[52:55], v15 offset:24576
  v_mfma_f32_32x32x16_bf16 v[80:95], a[204:207], v[28:31], v[80:95]
  s_waitcnt lgkmcnt(5)
  s_waitcnt vmcnt(17)
  s_barrier
  v_mfma_f32_32x32x16_bf16 v[64:79], a[208:211], v[32:35], v[64:79]
  ds_read_b128 v[24:27], v8 offset:32768
  v_mfma_f32_32x32x16_bf16 v[80:95], a[212:215], v[32:35], v[80:95]
  s_waitcnt lgkmcnt(5)
  v_mfma_f32_32x32x16_bf16 v[64:79], a[216:219], v[36:39], v[64:79]
  s_add_u32 s29, s29, 1
  ds_read_b128 v[28:31], v9 offset:32768
  v_mfma_f32_32x32x16_bf16 v[80:95], a[220:223], v[36:39], v[80:95]
  s_waitcnt lgkmcnt(5)
  s_max_i32 s30, s29, 0
  v_mov_b32 v144, s30
  v_mfma_f32_32x32x16_bf16 v[64:79], a[224:227], v[40:43], v[64:79]
  ds_read_b128 v[32:35], v10 offset:32768
  v_mfma_f32_32x32x16_bf16 v[80:95], a[228:231], v[40:43], v[80:95]
  s_waitcnt lgkmcnt(5)
  buffer_store_dword v144, v145, s[4:7], s31 offen sc1
  v_mfma_f32_32x32x16_bf16 v[64:79], a[232:235], v[44:47], v[64:79]
  ds_read_b128 v[36:39], v11 offset:32768
  v_mfma_f32_32x32x16_bf16 v[80:95], a[236:239], v[44:47], v[80:95]
  s_waitcnt lgkmcnt(5)
  v_mfma_f32_32x32x16_bf16 v[64:79], a[240:243], v[48:51], v[64:79]
  s_sub_u32 s23, s23, 1
  ds_read_b128 v[40:43], v12 offset:32768
  v_mfma_f32_32x32x16_bf16 v[80:95], a[244:247], v[48:51], v[80:95]
  s_waitcnt lgkmcnt(5)
  v_mfma_f32_32x32x16_bf16 v[64:79], a[248:251], v[52:55], v[64:79]
  s_cmp_eq_u32 s23, 0
  ds_read_b128 v[44:47], v13 offset:32768
  v_mfma_f32_32x32x16_bf16 v[80:95], a[252:255], v[52:55], v[80:95]
  s_cbranch_scc1 G_done0_4
  s_waitcnt lgkmcnt(5)
  v_mfma_f32_32x32x16_bf16 v[96:111], a[0:3], v[24:27], 0
  s_add_u32 m0, s25, 0
  ds_read_b128 v[48:51], v14 offset:32768
  v_mfma_f32_32x32x16_bf16 v[112:127], a[4:7], v[24:27], 0
  s_waitcnt lgkmcnt(5)
  buffer_load_dwordx4 v16, s[12:15], s19 offen lds
  v_mfma_f32_32x32x16_bf16 v[96:111], a[8:11], v[28:31], v[96:111]
  ds_read_b128 v[52:55], v15 offset:32768
  v_mul_f32 v64, s24, v64
  v_mul_f32 v65, s24, v65
  v_mfma_f32_32x32x16_bf16 v[112:127], a[12:15], v[28:31], v[112:127]
  s_waitcnt lgkmcnt(5)
  v_cvt_pk_bf16_f32 v128, v64, v65
  v_mul_f32 v66, s24, v66
  v_mfma_f32_32x32x16_bf16 v[96:111], a[16:19], v[32:35], v[96:111]
  s_add_u32 m0, s25, 1024
  ds_read_b128 v[24:27], v8 offset:40960
  v_mul_f32 v67, s24, v67
  v_cvt_pk_bf16_f32 v129, v66, v67
  v_mfma_f32_32x32x16_bf16 v[112:127], a[20:23], v[32:35], v[112:127]
  s_waitcnt lgkmcnt(5)
  buffer_load_dwordx4 v17, s[12:15], s19 offen lds
  v_mul_f32 v68, s24, v68
  v_mul_f32 v69, s24, v69
  v_mfma_f32_32x32x16_bf16 v[96:111], a[24:27], v[36:39], v[96:111]
  ds_read_b128 v[28:31], v9 offset:40960
  v_cvt_pk_bf16_f32 v130, v68, v69
  v_mul_f32 v70, s24, v70
  v_mfma_f32_32x32x16_bf16 v[112:127], a[28:31], v[36:39], v[112:127]
  s_waitcnt lgkmcnt(5)
  v_mul_f32 v71, s24, v71
  v_cvt_pk_bf16_f32 v131, v70, v71
  v_mfma_f32_32x32x16_bf16 v[96:111], a[32:35], v[40:43], v[96:111]
  s_add_u32 m0, s25, 2048
  ds_read_b128 v[32:35], v10 offset:40960
  v_mul_f32 v72, s24, v72
  v_mul_f32 v73, s24, v73
  v_mfma_f32_32x32x16_bf16 v[112:127], a[36:39], v[40:43], v[112:127]
  s_waitcnt lgkmcnt(5)
  buffer_load_dwordx4 v18, s[12:15], s19 offen lds
  v_cvt_pk_bf16_f32 v132, v72, v73
  v_mul_f32 v74, s24, v74
  v_mfma_f32_32x32x16_bf16 v[96:111], a[40:43], v[44:47], v[96:111]
  ds_read_b128 v[36:39], v11 offset:40960
  v_mul_f32 v75, s24, v75
  v_cvt_pk_bf16_f32 v133, v74, v75
  v_mfma_f32_32x32x16_bf16 v[112:127], a[44:47], v[44:47], v[112:127]
  s_waitcnt lgkmcnt(5)
  v_mul_f32 v76, s24, v76
  v_mul_f32 v77, s24, v77
  v_mfma_f32_32x32x16_bf16 v[96:111], a[48:51], v[48:51], v[96:111]
  s_add_u32 m0, s25, 3072
  ds_read_b128 v[40:43], v12 offset:40960
  v_cvt_pk_bf16_f32 v134, v76, v77
  v_mul_f32 v78, s24, v78
  v_mfma_f32_32x32x16_bf16 v[112:127], a[52:55], v[48:51], v[112:127]
  s_waitcnt lgkmcnt(5)
  buffer_load_dwordx4 v19, s[12:15], s19 offen lds
  v_mul_f32 v79, s24, v79
  v_cvt_pk_bf16_f32 v135, v78, v79
  v_mfma_f32_32x32x16_bf16 v[96:111], a[56:59], v[52:55], v[96:111]
  ds_read_b128 v[44:47], v13 offset:40960
  v_mul_f32 v80, s24, v80
  v_mul_f32 v81, s24, v81
  v_mfma_f32_32x32x16_bf16 v[112:127], a[60:63], v[52:55], v[112:127]
  s_waitcnt lgkmcnt(5)
  v_cvt_pk_bf16_f32 v136, v80, v81
  v_mul_f32 v82, s24, v82
  v_mfma_f32_32x32x16_bf16 v[96:111], a[64:67], v[24:27], v[96:111]
  s_add_u32 m0, s25, 4096
  ds_read_b128 v[48:51], v14 offset:40960
  v_mul_f32 v83, s24, v83
  v_cvt_pk_bf16_f32 v137, v82, v83
  v_mfma_f32_32x32x16_bf16 v[112:127], a[68:71], v[24:27], v[112:127]
  s_waitcnt lgkmcnt(5)
  buffer_load_dwordx4 v20, s[12:15], s19 offen lds
  v_mul_f32 v84, s24, v84
  v_mul_f32 v85, s24, v85
  v_mfma_f32_32x32x16_bf16 v[96:111], a[72:75], v[28:31], v[96:111]
  ds_read_b128 v[52:55], v15 offset:40960
  v_cvt_pk_bf16_f32 v138, v84, v85
  v_mul_f32 v86, s24, v86
  v_mfma_f32_32x32x16_bf16 v[112:127], a[76:79], v[28:31], v[112:127]
  s_waitcnt lgkmcnt(5)
  v_mul_f32 v87, s24, v87
  v_cvt_pk_bf16_f32 v139, v86, v87
  v_mfma_f32_32x32x16_bf16 v[96:111], a[80:83], v[32:35], v[96:111]
  s_add_u32 m0, s25, 5120
  ds_read_b128 v[24:27], v8 offset:49152
  v_mul_f32 v88, s24, v88
  v_mul_f32 v89, s24, v89
  v_mfma_f32_32x32x16_bf16 v[112:127], a[84:87], v[32:35], v[112:127]
  s_waitcnt lgkmcnt(5)
  buffer_load_dwordx4 v21, s[12:15], s19 offen lds
  v_cvt_pk_bf16_f32 v140, v88, v89
  v_mul_f32 v90, s24, v90
  v_mfma_f32_32x32x16_bf16 v[96:111], a[88:91], v[36:39], v[96:111]
  ds_read_b128 v[28:31], v9 offset:49152
  v_mul_f32 v91, s24, v91
  v_cvt_pk_bf16_f32 v141, v90, v91
  v_mfma_f32_32x32x16_bf16 v[112:127], a[92:95], v[36:39], v[112:127]
  s_waitcnt lgkmcnt(5)
  v_mul_f32 v92, s24, v92
  v_mul_f32 v93, s24, v93
  v_mfma_f32_32x32x16_bf16 v[96:111], a[96:99], v[40:43], v[96:111]
  s_add_u32 m0, s25, 6144
  ds_read_b128 v[32:35], v10 offset:49152
  v_cvt_pk_bf16_f32 v142, v92, v93
  v_mul_f32 v94, s24, v94
  v_mfma_f32_32x32x16_bf16 v[112:127], a[100:103], v[40:43], v[112:127]
  s_waitcnt lgkmcnt(5)
  buffer_load_dwordx4 v22, s[12:15], s19 offen lds
  v_mul_f32 v95, s24, v95
  v_cvt_pk_bf16_f32 v143, v94, v95
  v_mfma_f32_32x32x16_bf16 v[96:111], a[104:107], v[44:47], v[96:111]
  ds_read_b128 v[36:39], v11 offset:49152
  v_mfma_f32_32x32x16_bf16 v[112:127], a[108:111], v[44:47], v[112:127]
  s_waitcnt lgkmcnt(5)
  v_mfma_f32_32x32x16_bf16 v[96:111], a[112:115], v[48:51], v[96:111]
  s_add_u32 m0, s25, 7168
  ds_read_b128 v[40:43], v12 offset:49152
  v_mfma_f32_32x32x16_bf16 v[112:127], a[116:119], v[48:51], v[112:127]
  s_waitcnt lgkmcnt(5)
  buffer_load_dwordx4 v23, s[12:15], s19 offen lds
  v_mfma_f32_32x32x16_bf16 v[96:111], a[120:123], v[52:55], v[96:111]
  s_cmp_gt_u32 s23, 3
  ds_read_b128 v[44:47], v13 offset:49152
  v_mfma_f32_32x32x16_bf16 v[112:127], a[124:127], v[52:55], v[112:127]
  s_waitcnt lgkmcnt(5)
  s_cselect_b32 s26, s20, 0
  v_mfma_f32_32x32x16_bf16 v[96:111], a[128:131], v[24:27], v[96:111]
  s_add_u32 s19, s19, s26
  ds_read_b128 v[48:51], v14 offset:49152
  v_mfma_f32_32x32x16_bf16 v[112:127], a[132:135], v[24:27], v[112:127]
  s_waitcnt lgkmcnt(5)
  s_add_u32 s25, s25, 32768
  v_mfma_f32_32x32x16_bf16 v[96:111], a[136:139], v[28:31], v[96:111]
  s_and_b32 s25, s25, 0x1ffff
  ds_read_b128 v[52:55], v15 offset:49152
  v_mfma_f32_32x32x16_bf16 v[112:127], a[140:143], v[28:31], v[112:127]
  s_waitcnt lgkmcnt(5)
  buffer_store_dwordx4 v[128:131], v7, s[4:7], s21 offen offset:0 sc1
  v_mfma_f32_32x32x16_bf16 v[96:111], a[144:147], v[32:35], v[96:111]
  ds_read_b128 v[24:27], v8 offset:57344
  v_mfma_f32_32x32x16_bf16 v[112:127], a[148:151], v[32:35], v[112:127]
  s_waitcnt lgkmcnt(5)
  v_xor_b32 v8, 0x10000, v8
  v_mfma_f32_32x32x16_bf16 v[96:111], a[152:155], v[36:39], v[96:111]
  ds_read_b128 v[28:31], v9 offset:57344
  v_mfma_f32_32x32x16_bf16 v[112:127], a[156:159], v[36:39], v[112:127]
  s_waitcnt lgkmcnt(5)
  buffer_store_dwordx4 v[132:135], v7, s[4:7], s21 offen offset:1024 sc1
  v_xor_b32 v9, 0x10000, v9
  v_mfma_f32_32x32x16_bf16 v[96:111], a[160:163], v[40:43], v[96:111]
  ds_read_b128 v[32:35], v10 offset:57344
  v_mfma_f32_32x32x16_bf16 v[112:127], a[164:167], v[40:43], v[112:127]
  s_waitcnt lgkmcnt(5)
  v_xor_b32 v10, 0x10000, v10
  v_mfma_f32_32x32x16_bf16 v[96:111], a[168:171], v[44:47], v[96:111]
  ds_read_b128 v[36:39], v11 offset:57344
  v_mfma_f32_32x32x16_bf16 v[112:127], a[172:175], v[44:47], v[112:127]
  s_waitcnt lgkmcnt(5)
  buffer_store_dwordx4 v[136:139], v7, s[4:7], s21 offen offset:2048 sc1
  v_xor_b32 v11, 0x10000, v11
  v_mfma_f32_32x32x16_bf16 v[96:111], a[176:179], v[48:51], v[96:111]
  ds_read_b128 v[40:43], v12 offset:57344
  v_mfma_f32_32x32x16_bf16 v[112:127], a[180:183], v[48:51], v[112:127]
  s_waitcnt lgkmcnt(5)
  v_xor_b32 v12, 0x10000, v12
  v_mfma_f32_32x32x16_bf16 v[96:111], a[184:187], v[52:55], v[96:111]
  ds_read_b128 v[44:47], v13 offset:57344
  v_mfma_f32_32x32x16_bf16 v[112:127], a[188:191], v[52:55], v[112:127]
  s_waitcnt lgkmcnt(5)
  buffer_store_dwordx4 v[140:143], v7, s[4:7], s21 offen offset:3072 sc1
  v_xor_b32 v13, 0x10000, v13
  v_mfma_f32_32x32x16_bf16 v[96:111], a[192:195], v[24:27], v[96:111]
  s_mov_b32 s21, s27
  ds_read_b128 v[48:51], v14 offset:57344
  v_mov_b32 v7, v2
  v_mfma_f32_32x32x16_bf16 v[112:127], a[196:199], v[24:27], v[112:127]
  s_waitcnt lgkmcnt(5)
  v_xor_b32 v14, 0x10000, v14
  v_mfma_f32_32x32x16_bf16 v[96:111], a[200:203], v[28:31], v[96:111]
  s_add_u32 s27, s27, s22
  ds_read_b128 v[52:55], v15 offset:57344
  v_mfma_f32_32x32x16_bf16 v[112:127], a[204:207], v[28:31], v[112:127]
  s_waitcnt lgkmcnt(5)
  s_waitcnt vmcnt(17)
  s_barrier
  v_xor_b32 v15, 0x10000, v15
  v_mfma_f32_32x32x16_bf16 v[96:111], a[208:211], v[32:35], v[96:111]
  ds_read_b128 v[24:27], v8 offset:0
  v_mfma_f32_32x32x16_bf16 v[112:127], a[212:215], v[32:35], v[112:127]
  s_waitcnt lgkmcnt(5)
  v_mfma_f32_32x32x16_bf16 v[96:111], a[216:219], v[36:39], v[96:111]
  s_add_u32 s29, s29, 1
  ds_read_b128 v[28:31], v9 offset:0
  v_mfma_f32_32x32x16_bf16 v[112:127], a[220:223], v[36:39], v[112:127]
  s_waitcnt lgkmcnt(5)
  s_max_i32 s30, s29, 0
  v_mov_b32 v144, s30
  v_mfma_f32_32x32x16_bf16 v[96:111], a[224:227], v[40:43], v[96:111]
  ds_read_b128 v[32:35], v10 offset:0
  v_mfma_f32_32x32x16_bf16 v[112:127], a[228:231], v[40:43], v[112:127]
  s_waitcnt lgkmcnt(5)
  buffer_store_dword v144, v145, s[4:7], s31 offen sc1
  v_mfma_f32_32x32x16_bf16 v[96:111], a[232:235], v[44:47], v[96:111]
  ds_read_b128 v[36:39], v11 offset:0
  v_mfma_f32_32x32x16_bf16 v[112:127], a[236:239], v[44:47], v[112:127]
  s_waitcnt lgkmcnt(5)
  v_mfma_f32_32x32x16_bf16 v[96:111], a[240:243], v[48:51], v[96:111]
  s_sub_u32 s23, s23, 1
  ds_read_b128 v[40:43], v12 offset:0
  v_mfma_f32_32x32x16_bf16 v[112:127], a[244:247], v[48:51], v[112:127]
  s_waitcnt lgkmcnt(5)
  v_mfma_f32_32x32x16_bf16 v[96:111], a[248:251], v[52:55], v[96:111]
  s_cmp_eq_u32 s23, 0
  ds_read_b128 v[44:47], v13 offset:0
  v_mfma_f32_32x32x16_bf16 v[112:127], a[252:255], v[52:55], v[112:127]
  s_cbranch_scc1 G_done1_5
  s_branch G_top_3
G_done0_4:
  s_nop 7
  s_nop 3
  v_mul_f32 v64, s24, v64
  v_mul_f32 v65, s24, v65
  v_cvt_pk_bf16_f32 v128, v64, v65
  v_mul_f32 v66, s24, v66
  v_mul_f32 v67, s24, v67
  v_cvt_pk_bf16_f32 v129, v66, v67
  v_mul_f32 v68, s24, v68
  v_mul_f32 v69, s24, v69
  v_cvt_pk_bf16_f32 v130, v68, v69
  v_mul_f32 v70, s24, v70
  v_mul_f32 v71, s24, v71
  v_cvt_pk_bf16_f32 v131, v70, v71
  buffer_store_dwordx4 v[128:131], v7, s[4:7], s21 offen offset:0 sc1
  v_mul_f32 v72, s24, v72
  v_mul_f32 v73, s24, v73
  v_cvt_pk_bf16_f32 v132, v72, v73
  v_mul_f32 v74, s24, v74
  v_mul_f32 v75, s24, v75
  v_cvt_pk_bf16_f32 v133, v74, v75
  v_mul_f32 v76, s24, v76
  v_mul_f32 v77, s24, v77
  v_cvt_pk_bf16_f32 v134, v76, v77
  v_mul_f32 v78, s24, v78
  v_mul_f32 v79, s24, v79
  v_cvt_pk_bf16_f32 v135, v78, v79
  buffer_store_dwordx4 v[132:135], v7, s[4:7], s21 offen offset:1024 sc1
  v_mul_f32 v80, s24, v80
  v_mul_f32 v81, s24, v81
  v_cvt_pk_bf16_f32 v136, v80, v81
  v_mul_f32 v82, s24, v82
  v_mul_f32 v83, s24, v83
  v_cvt_pk_bf16_f32 v137, v82, v83
  v_mul_f32 v84, s24, v84
  v_mul_f32 v85, s24, v85
  v_cvt_pk_bf16_f32 v138, v84, v85
  v_mul_f32 v86, s24, v86
  v_mul_f32 v87, s24, v87
  v_cvt_pk_bf16_f32 v139, v86, v87
  buffer_store_dwordx4 v[136:139], v7, s[4:7], s21 offen offset:2048 sc1
  v_mul_f32 v88, s24, v88
  v_mul_f32 v89, s24, v89
  v_cvt_pk_bf16_f32 v140, v88, v89
  v_mul_f32 v90, s24, v90
  v_mul_f32 v91, s24, v91
  v_cvt_pk_bf16_f32 v141, v90, v91
  v_mul_f32 v92, s24, v92
  v_mul_f32 v93, s24, v93
  v_cvt_pk_bf16_f32 v142, v92, v93
  v_mul_f32 v94, s24, v94
  v_mul_f32 v95, s24, v95
  v_cvt_pk_bf16_f32 v143, v94, v95
  buffer_store_dwordx4 v[140:143], v7, s[4:7], s21 offen offset:3072 sc1
  s_branch G_fin_6
G_done1_5:
  s_nop 7
  s_nop 3
  v_mul_f32 v96, s24, v96
  v_mul_f32 v97, s24, v97
  v_cvt_pk_bf16_f32 v128, v96, v97
  v_mul_f32 v98, s24, v98
  v_mul_f32 v99, s24, v99
  v_cvt_pk_bf16_f32 v129, v98, v99
  v_mul_f32 v100, s24, v100
  v_mul_f32 v101, s24, v101
  v_cvt_pk_bf16_f32 v130, v100, v101
  v_mul_f32 v102, s24, v102
  v_mul_f32 v103, s24, v103
  v_cvt_pk_bf16_f32 v131, v102, v103
  buffer_store_dwordx4 v[128:131], v7, s[4:7], s21 offen offset:0 sc1
  v_mul_f32 v104, s24, v104
  v_mul_f32 v105, s24, v105
  v_cvt_pk_bf16_f32 v132, v104, v105
  v_mul_f32 v106, s24, v106
  v_mul_f32 v107, s24, v107
  v_cvt_pk_bf16_f32 v133, v106, v107
  v_mul_f32 v108, s24, v108
  v_mul_f32 v109, s24, v109
  v_cvt_pk_bf16_f32 v134, v108, v109
  v_mul_f32 v110, s24, v110
  v_mul_f32 v111, s24, v111
  v_cvt_pk_bf16_f32 v135, v110, v111
  buffer_store_dwordx4 v[132:135], v7, s[4:7], s21 offen offset:1024 sc1
  v_mul_f32 v112, s24, v112
  v_mul_f32 v113, s24, v113
  v_cvt_pk_bf16_f32 v136, v112, v113
  v_mul_f32 v114, s24, v114
  v_mul_f32 v115, s24, v115
  v_cvt_pk_bf16_f32 v137, v114, v115
  v_mul_f32 v116, s24, v116
  v_mul_f32 v117, s24, v117
  v_cvt_pk_bf16_f32 v138, v116, v117
  v_mul_f32 v118, s24, v118
  v_mul_f32 v119, s24, v119
  v_cvt_pk_bf16_f32 v139, v118, v119
  buffer_store_dwordx4 v[136:139], v7, s[4:7], s21 offen offset:2048 sc1
  v_mul_f32 v120, s24, v120
  v_mul_f32 v121, s24, v121
  v_cvt_pk_bf16_f32 v140, v120, v121
  v_mul_f32 v122, s24, v122
  v_mul_f32 v123, s24, v123
  v_cvt_pk_bf16_f32 v141, v122, v123
  v_mul_f32 v124, s24, v124
  v_mul_f32 v125, s24, v125
  v_cvt_pk_bf16_f32 v142, v124, v125
  v_mul_f32 v126, s24, v126
  v_mul_f32 v127, s24, v127
  v_cvt_pk_bf16_f32 v143, v126, v127
  buffer_store_dwordx4 v[140:143], v7, s[4:7], s21 offen offset:3072 sc1
G_fin_6:
  s_waitcnt vmcnt(0) lgkmcnt(0)
  s_barrier
  s_add_u32 s30, s29, 3
  v_mov_b32 v144, s30
  v_min_u32 v145, 1, v0
  v_lshlrev_b32 v145, 30, v145
  buffer_store_dword v144, v145, s[4:7], s31 offen sc1
  s_branch P_end_2
P_v_1:
  s_mov_b32 s27, s21
  v_mov_b32 v7, 0x40000000
  s_mov_b32 s29, -3
  v_min_u32 v145, 1, v0
  v_lshlrev_b32 v145, 30, v145
  ds_read_b128 v[24:27], v8 offset:0
  ds_read_b128 v[28:31], v9 offset:0
  ds_read_b128 v[32:35], v10 offset:0
  ds_read_b128 v[36:39], v11 offset:0
  ds_read_b128 v[40:43], v12 offset:0
  ds_read_b128 v[44:47], v13 offset:0
.p2align 6
G_top_7:
  s_waitcnt lgkmcnt(5)
  v_mfma_f32_32x32x16_bf16 v[64:79], v[24:27], a[0:3], 0
  s_add_u32 m0, s25, 0
  ds_read_b128 v[48:51], v14 offset:0
  v_mfma_f32_32x32x16_bf16 v[80:95], v[24:27], a[4:7], 0
  s_waitcnt lgkmcnt(5)
  buffer_load_dwordx4 v16, s[12:15], s19 offen lds
  v_mfma_f32_32x32x16_bf16 v[64:79], v[28:31], a[8:11], v[64:79]
  ds_read_b128 v[52:55], v15 offset:0
  v_mul_f32 v96, s24, v96
  v_mul_f32 v97, s24, v97
  v_mfma_f32_32x32x16_bf16 v[80:95], v[28:31], a[12:15], v[80:95]
  s_waitcnt lgkmcnt(5)
  v_cvt_pk_bf16_f32 v128, v96, v97
  v_mul_f32 v98, s24, v98
  v_mfma_f32_32x32x16_bf16 v[64:79], v[32:35], a[16:19], v[64:79]
  s_add_u32 m0, s25, 1024
  ds_read_b128 v[24:27], v8 offset:8192
  v_mul_f32 v99, s24, v99
  v_cvt_pk_bf16_f32 v129, v98, v99
  v_mfma_f32_32x32x16_bf16 v[80:95], v[32:35], a[20:23], v[80:95]
  s_waitcnt lgkmcnt(5)
  buffer_load_dwordx4 v17, s[12:15], s19 offen lds
  v_mul_f32 v100, s24, v100
  v_mul_f32 v101, s24, v101
  v_mfma_f32_32x32x16_bf16 v[64:79], v[36:39], a[24:27], v[64:79]
  ds_read_b128 v[28:31], v9 offset:8192
  v_cvt_pk_bf16_f32 v130, v100, v101
  v_mul_f32 v102, s24, v102
  v_mfma_f32_32x32x16_bf16 v[80:95], v[36:39], a[28:31], v[80:95]
  s_waitcnt lgkmcnt(5)
  v_mul_f32 v103, s24, v103
  v_cvt_pk_bf16_f32 v131, v102, v103
  v_mfma_f32_32x32x16_bf16 v[64:79], v[40:43], a[32:35], v[64:79]
  s_add_u32 m0, s25, 2048
  ds_read_b128 v[32:35], v10 offset:8192
  v_mul_f32 v104, s24, v104
  v_mul_f32 v105, s24, v105
  v_mfma_f32_32x32x16_bf16 v[80:95], v[40:43], a[36:39], v[80:95]
  s_waitcnt lgkmcnt(5)
  buffer_load_dwordx4 v18, s[12:15], s19 offen lds
  v_cvt_pk_bf16_f32 v132, v104, v105
  v_mul_f32 v106, s24, v106
  v_mfma_f32_32x32x16_bf16 v[64:79], v[44:47], a[40:43], v[64:79]
  ds_read_b128 v[36:39], v11 offset:8192
  v_mul_f32 v107, s24, v107
  v_cvt_pk_bf16_f32 v133, v106, v107
  v_mfma_f32_32x32x16_bf16 v[80:95], v[44:47], a[44:47], v[80:95]
  s_waitcnt lgkmcnt(5)
  v_mul_f32 v108, s24, v108
  v_mul_f32 v109, s24, v109
  v_mfma_f32_32x32x16_bf16 v[64:79], v[48:51], a[48:51], v[64:79]
  s_add_u32 m0, s25, 3072
  ds_read_b128 v[40:43], v12 offset:8192
  v_cvt_pk_bf16_f32 v134, v108, v109
  v_mul_f32 v110, s24, v110
  v_mfma_f32_32x32x16_bf16 v[80:95], v[48:51], a[52:55], v[80:95]
  s_waitcnt lgkmcnt(5)
  buffer_load_dwordx4 v19, s[12:15], s19 offen lds
  v_mul_f32 v111, s24, v111
  v_cvt_pk_bf16_f32 v135, v110, v111
  v_mfma_f32_32x32x16_bf16 v[64:79], v[52:55], a[56:59], v[64:79]
  ds_read_b128 v[44:47], v13 offset:8192
  v_mul_f32 v112, s24, v112
  v_mul_f32 v113, s24, v113
  v_mfma_f32_32x32x16_bf16 v[80:95], v[52:55], a[60:63], v[80:95]
  s_waitcnt lgkmcnt(5)
  v_cvt_pk_bf16_f32 v136, v112, v113
  v_mul_f32 v114, s24, v114
  v_mfma_f32_32x32x16_bf16 v[64:79], v[24:27], a[64:67], v[64:79]
  s_add_u32 m0, s25, 4096
  ds_read_b128 v[48:51], v14 offset:8192
  v_mul_f32 v115, s24, v115
  v_cvt_pk_bf16_f32 v137, v114, v115
  v_mfma_f32_32x32x16_bf16 v[80:95], v[24:27], a[68:71], v[80:95]
  s_waitcnt lgkmcnt(5)
  buffer_load_dwordx4 v20, s[12:15], s19 offen lds
  v_mul_f32 v116, s24, v116
  v_mul_f32 v117, s24, v117
  v_mfma_f32_32x32x16_bf16 v[64:79], v[28:31], a[72:75], v[64:79]
  ds_read_b128 v[52:55], v15 offset:8192
  v_cvt_pk_bf16_f32 v138, v116, v117
  v_mul_f32 v118, s24, v118
  v_mfma_f32_32x32x16_bf16 v[80:95], v[28:31], a[76:79], v[80:95]
  s_waitcnt lgkmcnt(5)
  v_mul_f32 v119, s24, v119
  v_cvt_pk_bf16_f32 v139, v118, v119
  v_mfma_f32_32x32x16_bf16 v[64:79], v[32:35], a[80:83], v[64:79]
  s_add_u32 m0, s25, 5120
  ds_read_b128 v[24:27], v8 offset:16384
  v_mul_f32 v120, s24, v120
  v_mul_f32 v121, s24, v121
  v_mfma_f32_32x32x16_bf16 v[80:95], v[32:35], a[84:87], v[80:95]
  s_waitcnt lgkmcnt(5)
  buffer_load_dwordx4 v21, s[12:15], s19 offen lds
  v_cvt_pk_bf16_f32 v140, v120, v121
  v_mul_f32 v122, s24, v122
  v_mfma_f32_32x32x16_bf16 v[64:79], v[36:39], a[88:91], v[64:79]
  ds_read_b128 v[28:31], v9 offset:16384
  v_mul_f32 v123, s24, v123
  v_cvt_pk_bf16_f32 v141, v122, v123
  v_mfma_f32_32x32x16_bf16 v[80:95], v[36:39], a[92:95], v[80:95]
  s_waitcnt lgkmcnt(5)
  v_mul_f32 v124, s24, v124
  v_mul_f32 v125, s24, v125
  v_mfma_f32_32x32x16_bf16 v[64:79], v[40:43], a[96:99], v[64:79]
  s_add_u32 m0, s25, 6144
  ds_read_b128 v[32:35], v10 offset:16384
  v_cvt_pk_bf16_f32 v142, v124, v125
  v_mul_f32 v126, s24, v126
  v_mfma_f32_32x32x16_bf16 v[80:95], v[40:43], a[100:103], v[80:95]
  s_waitcnt lgkmcnt(5)
  buffer_load_dwordx4 v22, s[12:15], s19 offen lds
  v_mul_f32 v127, s24, v127
  v_cvt_pk_bf16_f32 v143, v126, v127
  v_mfma_f32_32x32x16_bf16 v[64:79], v[44:47], a[104:107], v[64:79]
  ds_read_b128 v[36:39], v11 offset:16384
  v_mfma_f32_32x32x16_bf16 v[80:95], v[44:47], a[108:111], v[80:95]
  s_waitcnt lgkmcnt(5)
  v_mfma_f32_32x32x16_bf16 v[64:79], v[48:51], a[112:115], v[64:79]
  s_add_u32 m0, s25, 7168
  ds_read_b128 v[40:43], v12 offset:16384
  v_mfma_f32_32x32x16_bf16 v[80:95], v[48:51], a[116:119], v[80:95]
  s_waitcnt lgkmcnt(5)
  buffer_load_dwordx4 v23, s[12:15], s19 offen lds
  v_mfma_f32_32x32x16_bf16 v[64:79], v[52:55], a[120:123], v[64:79]
  s_cmp_gt_u32 s23, 3
  ds_read_b128 v[44:47], v13 offset:16384
  v_mfma_f32_32x32x16_bf16 v[80:95], v[52:55], a[124:127], v[80:95]
  s_waitcnt lgkmcnt(5)
  s_cselect_b32 s26, s20, 0
  v_mfma_f32_32x32x16_bf16 v[64:79], v[24:27], a[128:131], v[64:79]
  s_add_u32 s19, s19, s26
  ds_read_b128 v[48:51], v14 offset:16384
  v_mfma_f32_32x32x16_bf16 v[80:95], v[24:27], a[132:135], v[80:95]
  s_waitcnt lgkmcnt(5)
  s_add_u32 s25, s25, 32768
  v_mfma_f32_32x32x16_bf16 v[64:79], v[28:31], a[136:139], v[64:79]
  s_and_b32 s25, s25, 0x1ffff
  ds_read_b128 v[52:55], v15 offset:16384
  v_mfma_f32_32x32x16_bf16 v[80:95], v[28:31], a[140:143], v[80:95]
  s_waitcnt lgkmcnt(5)
  buffer_store_dwordx4 v[128:131], v7, s[4:7], s21 offen offset:0 sc1
  v_mfma_f32_32x32x16_bf16 v[64:79], v[32:35], a[144:147], v[64:79]
  ds_read_b128 v[24:27], v8 offset:24576
  v_mfma_f32_32x32x16_bf16 v[80:95], v[32:35], a[148:151], v[80:95]
  s_waitcnt lgkmcnt(5)
  v_mfma_f32_32x32x16_bf16 v[64:79], v[36:39], a[152:155], v[64:79]
  ds_read_b128 v[28:31], v9 offset:24576
  v_mfma_f32_32x32x16_bf16 v[80:95], v[36:39], a[156:159], v[80:95]
  s_waitcnt lgkmcnt(5)
  buffer_store_dwordx4 v[132:135], v7, s[4:7], s21 offen offset:1024 sc1
  v_mfma_f32_32x32x16_bf16 v[64:79], v[40:43], a[160:163], v[64:79]
  ds_read_b128 v[32:35], v10 offset:24576
  v_mfma_f32_32x32x16_bf16 v[80:95], v[40:43], a[164:167], v[80:95]
  s_waitcnt lgkmcnt(5)
  v_mfma_f32_32x32x16_bf16 v[64:79], v[44:47], a[168:171], v[64:79]
  ds_read_b128 v[36:39], v11 offset:24576
  v_mfma_f32_32x32x16_bf16 v[80:95], v[44:47], a[172:175], v[80:95]
  s_waitcnt lgkmcnt(5)
  buffer_store_dwordx4 v[136:139], v7, s[4:7], s21 offen offset:2048 sc1
  v_mfma_f32_32x32x16_bf16 v[64:79], v[48:51], a[176:179], v[64:79]
  ds_read_b128 v[40:43], v12 offset:24576
  v_mfma_f32_32x32x16_bf16 v[80:95], v[48:51], a[180:183], v[80:95]
  s_waitcnt lgkmcnt(5)
  v_mfma_f32_32x32x16_bf16 v[64:79], v[52:55], a[184:187], v[64:79]
  ds_read_b128 v[44:47], v13 offset:24576
  v_mfma_f32_32x32x16_bf16 v[80:95], v[52:55], a[188:191], v[80:95]
  s_waitcnt lgkmcnt(5)
  buffer_store_dwordx4 v[140:143], v7, s[4:7], s21 offen offset:3072 sc1
  v_mfma_f32_32x32x16_bf16 v[64:79], v[24:27], a[192:195], v[64:79]
  s_mov_b32 s21, s27
  ds_read_b128 v[48:51], v14 offset:24576
  v_mov_b32 v7, v2
  v_mfma_f32_32x32x16_bf16 v[80:95], v[24:27], a[196:199], v[80:95]
  s_waitcnt lgkmcnt(5)
  v_mfma_f32_32x32x16_bf16 v[64:79], v[28:31], a[200:203], v[64:79]
  s_add_u32 s27, s27, s22
  ds_read_b128 v[52:55], v15 offset:24576
  v_mfma_f32_32x32x16_bf16 v[80:95], v[28:31], a[204:207], v[80:95]
  s_waitcnt lgkmcnt(5)
  s_waitcnt vmcnt(17)
  s_barrier
  v_mfma_f32_32x32x16_bf16 v[64:79], v[32:35], a[208:211], v[64:79]
  ds_read_b128 v[24:27], v8 offset:32768
  v_mfma_f32_32x32x16_bf16 v[80:95], v[32:35], a[212:215], v[80:95]
  s_waitcnt lgkmcnt(5)
  v_mfma_f32_32x32x16_bf16 v[64:79], v[36:39], a[216:219], v[64:79]
  s_add_u32 s29, s29, 1
  ds_read_b128 v[28:31], v9 offset:32768
  v_mfma_f32_32x32x16_bf16 v[80:95], v[36:39], a[220:223], v[80:95]
  s_waitcnt lgkmcnt(5)
  s_max_i32 s30, s29, 0
  v_mov_b32 v144, s30
  v_mfma_f32_32x32x16_bf16 v[64:79], v[40:43], a[224:227], v[64:79]
  ds_read_b128 v[32:35], v10 offset:32768
  v_mfma_f32_32x32x16_bf16 v[80:95], v[40:43], a[228:231], v[80:95]
  s_waitcnt lgkmcnt(5)
  buffer_store_dword v144, v145, s[4:7], s31 offen sc1
  v_mfma_f32_32x32x16_bf16 v[64:79], v[44:47], a[232:235], v[64:79]
  ds_read_b128 v[36:39], v11 offset:32768
  v_mfma_f32_32x32x16_bf16 v[80:95], v[44:47], a[236:239], v[80:95]
  s_waitcnt lgkmcnt(5)
  v_mfma_f32_32x32x16_bf16 v[64:79], v[48:51], a[240:243], v[64:79]
  s_sub_u32 s23, s23, 1
  ds_read_b128 v[40:43], v12 offset:32768
  v_mfma_f32_32x32x16_bf16 v[80:95], v[48:51], a[244:247], v[80:95]
  s_waitcnt lgkmcnt(5)
  v_mfma_f32_32x32x16_bf16 v[64:79], v[52:55], a[248:251], v[64:79]
  s_cmp_eq_u32 s23, 0
  ds_read_b128 v[44:47], v13 offset:32768
  v_mfma_f32_32x32x16_bf16 v[80:95], v[52:55], a[252:255], v[80:95]
  s_cbranch_scc1 G_done0_8
  s_waitcnt lgkmcnt(5)
  v_mfma_f32_32x32x16_bf16 v[96:111], v[24:27], a[0:3], 0
  s_add_u32 m0, s25, 0
  ds_read_b128 v[48:51], v14 offset:32768
  v_mfma_f32_32x32x16_bf16 v[112:127], v[24:27], a[4:7], 0
  s_waitcnt lgkmcnt(5)
  buffer_load_dwordx4 v16, s[12:15], s19 offen lds
  v_mfma_f32_32x32x16_bf16 v[96:111], v[28:31], a[8:11], v[96:111]
  ds_read_b128 v[52:55], v15 offset:32768
  v_mul_f32 v64, s24, v64
  v_mul_f32 v65, s24, v65
  v_mfma_f32_32x32x16_bf16 v[112:127], v[28:31], a[12:15], v[112:127]
  s_waitcnt lgkmcnt(5)
  v_cvt_pk_bf16_f32 v128, v64, v65
  v_mul_f32 v66, s24, v66
  v_mfma_f32_32x32x16_bf16 v[96:111], v[32:35], a[16:19], v[96:111]
  s_add_u32 m0, s25, 1024
  ds_read_b128 v[24:27], v8 offset:40960
  v_mul_f32 v67, s24, v67
  v_cvt_pk_bf16_f32 v129, v66, v67
  v_mfma_f32_32x32x16_bf16 v[112:127], v[32:35], a[20:23], v[112:127]
  s_waitcnt lgkmcnt(5)
  buffer_load_dwordx4 v17, s[12:15], s19 offen lds
  v_mul_f32 v68, s24, v68
  v_mul_f32 v69, s24, v69
  v_mfma_f32_32x32x16_bf16 v[96:111], v[36:39], a[24:27], v[96:111]
  ds_read_b128 v[28:31], v9 offset:40960
  v_cvt_pk_bf16_f32 v130, v68, v69
  v_mul_f32 v70, s24, v70
  v_mfma_f32_32x32x16_bf16 v[112:127], v[36:39], a[28:31], v[112:127]
  s_waitcnt lgkmcnt(5)
  v_mul_f32 v71, s24, v71
  v_cvt_pk_bf16_f32 v131, v70, v71
  v_mfma_f32_32x32x16_bf16 v[96:111], v[40:43], a[32:35], v[96:111]
  s_add_u32 m0, s25, 2048
  ds_read_b128 v[32:35], v10 offset:40960
  v_mul_f32 v72, s24, v72
  v_mul_f32 v73, s24, v73
  v_mfma_f32_32x32x16_bf16 v[112:127], v[40:43], a[36:39], v[112:127]
  s_waitcnt lgkmcnt(5)
  buffer_load_dwordx4 v18, s[12:15], s19 offen lds
  v_cvt_pk_bf16_f32 v132, v72, v73
  v_mul_f32 v74, s24, v74
  v_mfma_f32_32x32x16_bf16 v[96:111], v[44:47], a[40:43], v[96:111]
  ds_read_b128 v[36:39], v11 offset:40960
  v_mul_f32 v75, s24, v75
  v_cvt_pk_bf16_f32 v133, v74, v75
  v_mfma_f32_32x32x16_bf16 v[112:127], v[44:47], a[44:47], v[112:127]
  s_waitcnt lgkmcnt(5)
  v_mul_f32 v76, s24, v76
  v_mul_f32 v77, s24, v77
  v_mfma_f32_32x32x16_bf16 v[96:111], v[48:51], a[48:51], v[96:111]
  s_add_u32 m0, s25, 3072
  ds_read_b128 v[40:43], v12 offset:40960
  v_cvt_pk_bf16_f32 v134, v76, v77
  v_mul_f32 v78, s24, v78
  v_mfma_f32_32x32x16_bf16 v[112:127], v[48:51], a[52:55], v[112:127]
  s_waitcnt lgkmcnt(5)
  buffer_load_dwordx4 v19, s[12:15], s19 offen lds
  v_mul_f32 v79, s24, v79
  v_cvt_pk_bf16_f32 v135, v78, v79
  v_mfma_f32_32x32x16_bf16 v[96:111], v[52:55], a[56:59], v[96:111]
  ds_read_b128 v[44:47], v13 offset:40960
  v_mul_f32 v80, s24, v80
  v_mul_f32 v81, s24, v81
  v_mfma_f32_32x32x16_bf16 v[112:127], v[52:55], a[60:63], v[112:127]
  s_waitcnt lgkmcnt(5)
  v_cvt_pk_bf16_f32 v136, v80, v81
  v_mul_f32 v82, s24, v82
  v_mfma_f32_32x32x16_bf16 v[96:111], v[24:27], a[64:67], v[96:111]
  s_add_u32 m0, s25, 4096
  ds_read_b128 v[48:51], v14 offset:40960
  v_mul_f32 v83, s24, v83
  v_cvt_pk_bf16_f32 v137, v82, v83
  v_mfma_f32_32x32x16_bf16 v[112:127], v[24:27], a[68:71], v[112:127]
  s_waitcnt lgkmcnt(5)
  buffer_load_dwordx4 v20, s[12:15], s19 offen lds
  v_mul_f32 v84, s24, v84
  v_mul_f32 v85, s24, v85
  v_mfma_f32_32x32x16_bf16 v[96:111], v[28:31], a[72:75], v[96:111]
  ds_read_b128 v[52:55], v15 offset:40960
  v_cvt_pk_bf16_f32 v138, v84, v85
  v_mul_f32 v86, s24, v86
  v_mfma_f32_32x32x16_bf16 v[112:127], v[28:31], a[76:79], v[112:127]
  s_waitcnt lgkmcnt(5)
  v_mul_f32 v87, s24, v87
  v_cvt_pk_bf16_f32 v139, v86, v87
  v_mfma_f32_32x32x16_bf16 v[96:111], v[32:35], a[80:83], v[96:111]
  s_add_u32 m0, s25, 5120
  ds_read_b128 v[24:27], v8 offset:49152
  v_mul_f32 v88, s24, v88
  v_mul_f32 v89, s24, v89
  v_mfma_f32_32x32x16_bf16 v[112:127], v[32:35], a[84:87], v[112:127]
  s_waitcnt lgkmcnt(5)
  buffer_load_dwordx4 v21, s[12:15], s19 offen lds
  v_cvt_pk_bf16_f32 v140, v88, v89
  v_mul_f32 v90, s24, v90
  v_mfma_f32_32x32x16_bf16 v[96:111], v[36:39], a[88:91], v[96:111]
  ds_read_b128 v[28:31], v9 offset:49152
  v_mul_f32 v91, s24, v91
  v_cvt_pk_bf16_f32 v141, v90, v91
  v_mfma_f32_32x32x16_bf16 v[112:127], v[36:39], a[92:95], v[112:127]
  s_waitcnt lgkmcnt(5)
  v_mul_f32 v92, s24, v92
  v_mul_f32 v93, s24, v93
  v_mfma_f32_32x32x16_bf16 v[96:111], v[40:43], a[96:99], v[96:111]
  s_add_u32 m0, s25, 6144
  ds_read_b128 v[32:35], v10 offset:49152
  v_cvt_pk_bf16_f32 v142, v92, v93
  v_mul_f32 v94, s24, v94
  v_mfma_f32_32x32x16_bf16 v[112:127], v[40:43], a[100:103], v[112:127]
  s_waitcnt lgkmcnt(5)
  buffer_load_dwordx4 v22, s[12:15], s19 offen lds
  v_mul_f32 v95, s24, v95
  v_cvt_pk_bf16_f32 v143, v94, v95
  v_mfma_f32_32x32x16_bf16 v[96:111], v[44:47], a[104:107], v[96:111]
  ds_read_b128 v[36:39], v11 offset:49152
  v_mfma_f32_32x32x16_bf16 v[112:127], v[44:47], a[108:111], v[112:127]
  s_waitcnt lgkmcnt(5)
  v_mfma_f32_32x32x16_bf16 v[96:111], v[48:51], a[112:115], v[96:111]
  s_add_u32 m0, s25, 7168
  ds_read_b128 v[40:43], v12 offset:49152
  v_mfma_f32_32x32x16_bf16 v[112:127], v[48:51], a[116:119], v[112:127]
  s_waitcnt lgkmcnt(5)
  buffer_load_dwordx4 v23, s[12:15], s19 offen lds
  v_mfma_f32_32x32x16_bf16 v[96:111], v[52:55], a[120:123], v[96:111]
  s_cmp_gt_u32 s23, 3
  ds_read_b128 v[44:47], v13 offset:49152
  v_mfma_f32_32x32x16_bf16 v[112:127], v[52:55], a[124:127], v[112:127]
  s_waitcnt lgkmcnt(5)
  s_cselect_b32 s26, s20, 0
  v_mfma_f32_32x32x16_bf16 v[96:111], v[24:27], a[128:131], v[96:111]
  s_add_u32 s19, s19, s26
  ds_read_b128 v[48:51], v14 offset:49152
  v_mfma_f32_32x32x16_bf16 v[112:127], v[24:27], a[132:135], v[112:127]
  s_waitcnt lgkmcnt(5)
  s_add_u32 s25, s25, 32768
  v_mfma_f32_32x32x16_bf16 v[96:111], v[28:31], a[136:139], v[96:111]
  s_and_b32 s25, s25, 0x1ffff
  ds_read_b128 v[52:55], v15 offset:49152
  v_mfma_f32_32x32x16_bf16 v[112:127], v[28:31], a[140:143], v[112:127]
  s_waitcnt lgkmcnt(5)
  buffer_store_dwordx4 v[128:131], v7, s[4:7], s21 offen offset:0 sc1
  v_mfma_f32_32x32x16_bf16 v[96:111], v[32:35], a[144:147], v[96:111]
  ds_read_b128 v[24:27], v8 offset:57344
  v_mfma_f32_32x32x16_bf16 v[112:127], v[32:35], a[148:151], v[112:127]
  s_waitcnt lgkmcnt(5)
  v_xor_b32 v8, 0x10000, v8
  v_mfma_f32_32x32x16_bf16 v[96:111], v[36:39], a[152:155], v[96:111]
  ds_read_b128 v[28:31], v9 offset:57344
  v_mfma_f32_32x32x16_bf16 v[112:127], v[36:39], a[156:159], v[112:127]
  s_waitcnt lgkmcnt(5)
  buffer_store_dwordx4 v[132:135], v7, s[4:7], s21 offen offset:1024 sc1
  v_xor_b32 v9, 0x10000, v9
  v_mfma_f32_32x32x16_bf16 v[96:111], v[40:43], a[160:163], v[96:111]
  ds_read_b128 v[32:35], v10 offset:57344
  v_mfma_f32_32x32x16_bf16 v[112:127], v[40:43], a[164:167], v[112:127]
  s_waitcnt lgkmcnt(5)
  v_xor_b32 v10, 0x10000, v10
  v_mfma_f32_32x32x16_bf16 v[96:111], v[44:47], a[168:171], v[96:111]
  ds_read_b128 v[36:39], v11 offset:57344
  v_mfma_f32_32x32x16_bf16 v[112:127], v[44:47], a[172:175], v[112:127]
  s_waitcnt lgkmcnt(5)
  buffer_store_dwordx4 v[136:139], v7, s[4:7], s21 offen offset:2048 sc1
  v_xor_b32 v11, 0x10000, v11
  v_mfma_f32_32x32x16_bf16 v[96:111], v[48:51], a[176:179], v[96:111]
  ds_read_b128 v[40:43], v12 offset:57344
  v_mfma_f32_32x32x16_bf16 v[112:127], v[48:51], a[180:183], v[112:127]
  s_waitcnt lgkmcnt(5)
  v_xor_b32 v12, 0x10000, v12
  v_mfma_f32_32x32x16_bf16 v[96:111], v[52:55], a[184:187], v[96:111]
  ds_read_b128 v[44:47], v13 offset:57344
  v_mfma_f32_32x32x16_bf16 v[112:127], v[52:55], a[188:191], v[112:127]
  s_waitcnt lgkmcnt(5)
  buffer_store_dwordx4 v[140:143], v7, s[4:7], s21 offen offset:3072 sc1
  v_xor_b32 v13, 0x10000, v13
  v_mfma_f32_32x32x16_bf16 v[96:111], v[24:27], a[192:195], v[96:111]
  s_mov_b32 s21, s27
  ds_read_b128 v[48:51], v14 offset:57344
  v_mov_b32 v7, v2
  v_mfma_f32_32x32x16_bf16 v[112:127], v[24:27], a[196:199], v[112:127]
  s_waitcnt lgkmcnt(5)
  v_xor_b32 v14, 0x10000, v14
  v_mfma_f32_32x32x16_bf16 v[96:111], v[28:31], a[200:203], v[96:111]
  s_add_u32 s27, s27, s22
  ds_read_b128 v[52:55], v15 offset:57344
  v_mfma_f32_32x32x16_bf16 v[112:127], v[28:31], a[204:207], v[112:127]
  s_waitcnt lgkmcnt(5)
  s_waitcnt vmcnt(17)
  s_barrier
  v_xor_b32 v15, 0x10000, v15
  v_mfma_f32_32x32x16_bf16 v[96:111], v[32:35], a[208:211], v[96:111]
  ds_read_b128 v[24:27], v8 offset:0
  v_mfma_f32_32x32x16_bf16 v[112:127], v[32:35], a[212:215], v[112:127]
  s_waitcnt lgkmcnt(5)
  v_mfma_f32_32x32x16_bf16 v[96:111], v[36:39], a[216:219], v[96:111]
  s_add_u32 s29, s29, 1
  ds_read_b128 v[28:31], v9 offset:0
  v_mfma_f32_32x32x16_bf16 v[112:127], v[36:39], a[220:223], v[112:127]
  s_waitcnt lgkmcnt(5)
  s_max_i32 s30, s29, 0
  v_mov_b32 v144, s30
  v_mfma_f32_32x32x16_bf16 v[96:111], v[40:43], a[224:227], v[96:111]
  ds_read_b128 v[32:35], v10 offset:0
  v_mfma_f32_32x32x16_bf16 v[112:127], v[40:43], a[228:231], v[112:127]
  s_waitcnt lgkmcnt(5)
  buffer_store_dword v144, v145, s[4:7], s31 offen sc1
  v_mfma_f32_32x32x16_bf16 v[96:111], v[44:47], a[232:235], v[96:111]
  ds_read_b128 v[36:39], v11 offset:0
  v_mfma_f32_32x32x16_bf16 v[112:127], v[44:47], a[236:239], v[112:127]
  s_waitcnt lgkmcnt(5)
  v_mfma_f32_32x32x16_bf16 v[96:111], v[48:51], a[240:243], v[96:111]
  s_sub_u32 s23, s23, 1
  ds_read_b128 v[40:43], v12 offset:0
  v_mfma_f32_32x32x16_bf16 v[112:127], v[48:51], a[244:247], v[112:127]
  s_waitcnt lgkmcnt(5)
  v_mfma_f32_32x32x16_bf16 v[96:111], v[52:55], a[248:251], v[96:111]
  s_cmp_eq_u32 s23, 0
  ds_read_b128 v[44:47], v13 offset:0
  v_mfma_f32_32x32x16_bf16 v[112:127], v[52:55], a[252:255], v[112:127]
  s_cbranch_scc1 G_done1_9
  s_branch G_top_7
G_done0_8:
  s_nop 7
  s_nop 3
  v_mul_f32 v64, s24, v64
  v_mul_f32 v65, s24, v65
  v_cvt_pk_bf16_f32 v128, v64, v65
  v_mul_f32 v66, s24, v66
  v_mul_f32 v67, s24, v67
  v_cvt_pk_bf16_f32 v129, v66, v67
  v_mul_f32 v68, s24, v68
  v_mul_f32 v69, s24, v69
  v_cvt_pk_bf16_f32 v130, v68, v69
  v_mul_f32 v70, s24, v70
  v_mul_f32 v71, s24, v71
  v_cvt_pk_bf16_f32 v131, v70, v71
  buffer_store_dwordx4 v[128:131], v7, s[4:7], s21 offen offset:0 sc1
  v_mul_f32 v72, s24, v72
  v_mul_f32 v73, s24, v73
  v_cvt_pk_bf16_f32 v132, v72, v73
  v_mul_f32 v74, s24, v74
  v_mul_f32 v75, s24, v75
  v_cvt_pk_bf16_f32 v133, v74, v75
  v_mul_f32 v76, s24, v76
  v_mul_f32 v77, s24, v77
  v_cvt_pk_bf16_f32 v134, v76, v77
  v_mul_f32 v78, s24, v78
  v_mul_f32 v79, s24, v79
  v_cvt_pk_bf16_f32 v135, v78, v79
  buffer_store_dwordx4 v[132:135], v7, s[4:7], s21 offen offset:1024 sc1
  v_mul_f32 v80, s24, v80
  v_mul_f32 v81, s24, v81
  v_cvt_pk_bf16_f32 v136, v80, v81
  v_mul_f32 v82, s24, v82
  v_mul_f32 v83, s24, v83
  v_cvt_pk_bf16_f32 v137, v82, v83
  v_mul_f32 v84, s24, v84
  v_mul_f32 v85, s24, v85
  v_cvt_pk_bf16_f32 v138, v84, v85
  v_mul_f32 v86, s24, v86
  v_mul_f32 v87, s24, v87
  v_cvt_pk_bf16_f32 v139, v86, v87
  buffer_store_dwordx4 v[136:139], v7, s[4:7], s21 offen offset:2048 sc1
  v_mul_f32 v88, s24, v88
  v_mul_f32 v89, s24, v89
  v_cvt_pk_bf16_f32 v140, v88, v89
  v_mul_f32 v90, s24, v90
  v_mul_f32 v91, s24, v91
  v_cvt_pk_bf16_f32 v141, v90, v91
  v_mul_f32 v92, s24, v92
  v_mul_f32 v93, s24, v93
  v_cvt_pk_bf16_f32 v142, v92, v93
  v_mul_f32 v94, s24, v94
  v_mul_f32 v95, s24, v95
  v_cvt_pk_bf16_f32 v143, v94, v95
  buffer_store_dwordx4 v[140:143], v7, s[4:7], s21 offen offset:3072 sc1
  s_branch G_fin_10
G_done1_9:
  s_nop 7
  s_nop 3
  v_mul_f32 v96, s24, v96
  v_mul_f32 v97, s24, v97
  v_cvt_pk_bf16_f32 v128, v96, v97
  v_mul_f32 v98, s24, v98
  v_mul_f32 v99, s24, v99
  v_cvt_pk_bf16_f32 v129, v98, v99
  v_mul_f32 v100, s24, v100
  v_mul_f32 v101, s24, v101
  v_cvt_pk_bf16_f32 v130, v100, v101
  v_mul_f32 v102, s24, v102
  v_mul_f32 v103, s24, v103
  v_cvt_pk_bf16_f32 v131, v102, v103
  buffer_store_dwordx4 v[128:131], v7, s[4:7], s21 offen offset:0 sc1
  v_mul_f32 v104, s24, v104
  v_mul_f32 v105, s24, v105
  v_cvt_pk_bf16_f32 v132, v104, v105
  v_mul_f32 v106, s24, v106
  v_mul_f32 v107, s24, v107
  v_cvt_pk_bf16_f32 v133, v106, v107
  v_mul_f32 v108, s24, v108
  v_mul_f32 v109, s24, v109
  v_cvt_pk_bf16_f32 v134, v108, v109
  v_mul_f32 v110, s24, v110
  v_mul_f32 v111, s24, v111
  v_cvt_pk_bf16_f32 v135, v110, v111
  buffer_store_dwordx4 v[132:135], v7, s[4:7], s21 offen offset:1024 sc1
  v_mul_f32 v112, s24, v112
  v_mul_f32 v113, s24, v113
  v_cvt_pk_bf16_f32 v136, v112, v113
  v_mul_f32 v114, s24, v114
  v_mul_f32 v115, s24, v115
  v_cvt_pk_bf16_f32 v137, v114, v115
  v_mul_f32 v116, s24, v116
  v_mul_f32 v117, s24, v117
  v_cvt_pk_bf16_f32 v138, v116, v117
  v_mul_f32 v118, s24, v118
  v_mul_f32 v119, s24, v119
  v_cvt_pk_bf16_f32 v139, v118, v119
  buffer_store_dwordx4 v[136:139], v7, s[4:7], s21 offen offset:2048 sc1
  v_mul_f32 v120, s24, v120
  v_mul_f32 v121, s24, v121
  v_cvt_pk_bf16_f32 v140, v120, v121
  v_mul_f32 v122, s24, v122
  v_mul_f32 v123, s24, v123
  v_cvt_pk_bf16_f32 v141, v122, v123
  v_mul_f32 v124, s24, v124
  v_mul_f32 v125, s24, v125
  v_cvt_pk_bf16_f32 v142, v124, v125
  v_mul_f32 v126, s24, v126
  v_mul_f32 v127, s24, v127
  v_cvt_pk_bf16_f32 v143, v126, v127
  buffer_store_dwordx4 v[140:143], v7, s[4:7], s21 offen offset:3072 sc1
G_fin_10:
  s_waitcnt vmcnt(0) lgkmcnt(0)
  s_barrier
  s_add_u32 s30, s29, 3
  v_mov_b32 v144, s30
  v_min_u32 v145, 1, v0
  v_lshlrev_b32 v145, 30, v145
  buffer_store_dword v144, v145, s[4:7], s31 offen sc1
P_end_2:
  s_mov_b32 s71, 0
  s_branch M_sg_12
M_sw_11:
  s_sleep 8
  s_add_u32 s71, s71, 1
  s_cmp_gt_u32 s71, 262144
  s_cbranch_scc1 M_exit
M_sg_12:
  s_mov_b32 s79, 0
  s_atomic_or s79, s[74:75], 128 glc
  s_waitcnt lgkmcnt(0)
  s_cmp_lt_u32 s79, 256
  s_cbranch_scc1 M_sw_11
  s_cmp_eq_u32 s65, 6
  s_cbranch_scc1 M_follow
  s_mov_b32 s68, 0
  s_mov_b32 s36, -1
  s_mov_b32 s69, s53
  s_mov_b32 s70, s54
M_att:
  s_mov_b32 s24, 0xf149f2ca
  s_mov_b32 s29, 0
  v_mov_b32 v6, 0
  v_mov_b32 v7, 0
  s_lshl_b32 s26, s16, 11
  v_add_u32 v3, s26, v2
  v_and_b32 v5, 31, v1
  v_lshrrev_b32 v12, 5, v1
  v_lshlrev_b32 v12, 2, v12
  v_sub_u32 v5, v5, v12
  s_lshl_b32 s26, s64, 19
  s_add_u32 s19, s26, 16777216
  s_add_u32 s20, s26, 33554432
  s_lshl_b32 s27, s69, 2
  s_add_u32 s27, s27, s16
  s_lshl_b32 s27, s27, 14
  s_add_u32 s25, s26, s27
  s_bfe_u32 s78, s70, 0x80000
  s_add_u32 s76, s67, 512
  s_mov_b32 s71, 0
  s_branch M_sg_14
M_sw_13:
  s_sleep 8
  s_add_u32 s71, s71, 1
  s_cmp_gt_u32 s71, 262144
  s_cbranch_scc1 M_exit
M_sg_14:
  s_mov_b32 s79, 0
  s_atomic_or s79, s[72:73], s76 glc
  s_waitcnt lgkmcnt(0)
  s_cmp_lt_u32 s79, s78
  s_cbranch_scc1 M_sw_13
  s_bfe_u32 s78, s70, 0x80008
  s_add_u32 s76, s67, 640
  s_mov_b32 s71, 0
  s_branch M_sg_16
M_sw_15:
  s_sleep 8
  s_add_u32 s71, s71, 1
  s_cmp_gt_u32 s71, 262144
  s_cbranch_scc1 M_exit
M_sg_16:
  s_mov_b32 s79, 0
  s_atomic_or s79, s[72:73], s76 glc
  s_waitcnt lgkmcnt(0)
  s_cmp_lt_u32 s79, s78
  s_cbranch_scc1 M_sw_15
  s_lshl_b32 s27, s69, 16
  s_add_u32 s27, s27, 16384
  s_add_u32 s17, s19, s27
M_kv_17:
  s_cmp_ge_u32 s17, s36
  s_cbranch_scc1 M_kvok_18
  s_mov_b32 s76, 0
  s_mov_b32 s78, 20
  s_mov_b32 s77, 360448
  s_cmp_eq_u32 s68, 1
  s_cmov_b32 s76, 128
  s_cmov_b32 s78, 24
  s_cmov_b32 s77, 163840
  s_cmp_eq_u32 s68, 2
  s_cmov_b32 s76, 768
  s_cmov_b32 s78, 20
  s_cmov_b32 s77, 0
  s_add_u32 s76, s76, s67
  s_mov_b32 s71, 0
  s_branch M_sg_20
M_sw_19:
  s_sleep 8
  s_add_u32 s71, s71, 1
  s_cmp_gt_u32 s71, 262144
  s_cbranch_scc1 M_exit
M_sg_20:
  s_mov_b32 s79, 0
  s_atomic_or s79, s[72:73], s76 glc
  s_waitcnt lgkmcnt(0)
  s_cmp_lt_u32 s79, s78
  s_cbranch_scc1 M_sw_19
  s_add_u32 s36, s77, s19
  s_add_u32 s68, s68, 1
  s_branch M_kv_17
M_kvok_18:
  s_add_u32 s28, s25, 0
  buffer_load_dwordx4 a[128:131], v2, s[4:7], s28 offen offset:0 sc1
  buffer_load_dwordx4 a[132:135], v2, s[4:7], s28 offen offset:1024 sc1
  buffer_load_dwordx4 a[136:139], v2, s[4:7], s28 offen offset:2048 sc1
  buffer_load_dwordx4 a[140:143], v2, s[4:7], s28 offen offset:3072 sc1
  s_add_u32 s28, s25, 4096
  buffer_load_dwordx4 a[144:147], v2, s[4:7], s28 offen offset:0 sc1
  buffer_load_dwordx4 a[148:151], v2, s[4:7], s28 offen offset:1024 sc1
  buffer_load_dwordx4 a[152:155], v2, s[4:7], s28 offen offset:2048 sc1
  buffer_load_dwordx4 a[156:159], v2, s[4:7], s28 offen offset:3072 sc1
  s_add_u32 s28, s25, 8192
  buffer_load_dwordx4 a[160:163], v2, s[4:7], s28 offen offset:0 sc1
  buffer_load_dwordx4 a[164:167], v2, s[4:7], s28 offen offset:1024 sc1
  buffer_load_dwordx4 a[168:171], v2, s[4:7], s28 offen offset:2048 sc1
  buffer_load_dwordx4 a[172:175], v2, s[4:7], s28 offen offset:3072 sc1
  s_add_u32 s28, s25, 12288
  buffer_load_dwordx4 a[176:179], v2, s[4:7], s28 offen offset:0 sc1
  buffer_load_dwordx4 a[180:183], v2, s[4:7], s28 offen offset:1024 sc1
  buffer_load_dwordx4 a[184:187], v2, s[4:7], s28 offen offset:2048 sc1
  buffer_load_dwordx4 a[188:191], v2, s[4:7], s28 offen offset:3072 sc1
A_again_21:
  s_lshl_b32 s27, s69, 16
  s_add_u32 s27, s27, 57344
  s_add_u32 s17, s19, s27
  s_add_u32 s18, s20, s27
  s_lshl_b32 s21, s16, 11
  s_mov_b32 m0, s21
  s_nop 0
  buffer_load_dwordx4 v3, s[4:7], s18 offen offset:0 sc1 lds
  buffer_load_dwordx4 v3, s[4:7], s18 offen offset:1024 sc1 lds
  s_add_u32 m0, s21, 8192
  s_nop 0
  buffer_load_dwordx4 v3, s[4:7], s17 offen offset:0 sc1 lds
  buffer_load_dwordx4 v3, s[4:7], s17 offen offset:1024 sc1 lds
  s_add_u32 s18, s18, 8192
  s_sub_u32 s18, s18, 8192
  s_max_i32 s18, s18, s20
  s_sub_u32 s17, s17, 8192
  s_max_i32 s17, s17, s19
  s_add_u32 s21, s21, 16384
  s_and_b32 s21, s21, 131071
  s_mov_b32 m0, s21
  s_nop 0
  buffer_load_dwordx4 v3, s[4:7], s18 offen offset:0 sc1 lds
  buffer_load_dwordx4 v3, s[4:7], s18 offen offset:1024 sc1 lds
  s_add_u32 m0, s21, 8192
  s_nop 0
  buffer_load_dwordx4 v3, s[4:7], s17 offen offset:0 sc1 lds
  buffer_load_dwordx4 v3, s[4:7], s17 offen offset:1024 sc1 lds
  s_sub_u32 s18, s18, 8192
  s_max_i32 s18, s18, s20
  s_sub_u32 s17, s17, 8192
  s_max_i32 s17, s17, s19
  s_add_u32 s21, s21, 16384
  s_and_b32 s21, s21, 131071
  s_mov_b32 m0, s21
  s_nop 0
  buffer_load_dwordx4 v3, s[4:7], s18 offen offset:0 sc1 lds
  buffer_load_dwordx4 v3, s[4:7], s18 offen offset:1024 sc1 lds
  s_add_u32 m0, s21, 8192
  s_nop 0
  buffer_load_dwordx4 v3, s[4:7], s17 offen offset:0 sc1 lds
  buffer_load_dwordx4 v3, s[4:7], s17 offen offset:1024 sc1 lds
  s_sub_u32 s18, s18, 8192
  s_max_i32 s18, s18, s20
  s_sub_u32 s17, s17, 8192
  s_max_i32 s17, s17, s19
  s_add_u32 s21, s21, 16384
  s_and_b32 s21, s21, 131071
  s_mov_b32 m0, s21
  s_nop 0
  buffer_load_dwordx4 v3, s[4:7], s18 offen offset:0 sc1 lds
  buffer_load_dwordx4 v3, s[4:7], s18 offen offset:1024 sc1 lds
  s_add_u32 m0, s21, 8192
  s_nop 0
  buffer_load_dwordx4 v3, s[4:7], s17 offen offset:0 sc1 lds
  buffer_load_dwordx4 v3, s[4:7], s17 offen offset:1024 sc1 lds
  s_sub_u32 s18, s18, 8192
  s_max_i32 s18, s18, s20
  s_sub_u32 s17, s17, 8192
  s_max_i32 s17, s17, s19
  s_add_u32 s21, s21, 16384
  s_and_b32 s21, s21, 131071
  s_mov_b32 m0, s21
  s_nop 0
  buffer_load_dwordx4 v3, s[4:7], s18 offen offset:0 sc1 lds
  buffer_load_dwordx4 v3, s[4:7], s18 offen offset:1024 sc1 lds
  s_add_u32 m0, s21, 8192
  s_nop 0
  buffer_load_dwordx4 v3, s[4:7], s17 offen offset:0 sc1 lds
  buffer_load_dwordx4 v3, s[4:7], s17 offen offset:1024 sc1 lds
  s_sub_u32 s18, s18, 8192
  s_max_i32 s18, s18, s20
  s_sub_u32 s17, s17, 8192
  s_max_i32 s17, s17, s19
  s_add_u32 s21, s21, 16384
  s_and_b32 s21, s21, 131071
  s_mov_b32 m0, s21
  s_nop 0
  buffer_load_dwordx4 v3, s[4:7], s18 offen offset:0 sc1 lds
  buffer_load_dwordx4 v3, s[4:7], s18 offen offset:1024 sc1 lds
  s_add_u32 m0, s21, 8192
  s_nop 0
  buffer_load_dwordx4 v3, s[4:7], s17 offen offset:0 sc1 lds
  buffer_load_dwordx4 v3, s[4:7], s17 offen offset:1024 sc1 lds
  v_accvgpr_write_b32 a0, 0
  v_accvgpr_write_b32 a1, 0
  v_accvgpr_write_b32 a2, 0
  v_accvgpr_write_b32 a3, 0
  v_accvgpr_write_b32 a4, 0
  v_accvgpr_write_b32 a5, 0
  v_accvgpr_write_b32 a6, 0
  v_accvgpr_write_b32 a7, 0
  v_accvgpr_write_b32 a8, 0
  v_accvgpr_write_b32 a9, 0
  v_accvgpr_write_b32 a10, 0
  v_accvgpr_write_b32 a11, 0
  v_accvgpr_write_b32 a12, 0
  v_accvgpr_write_b32 a13, 0
  v_accvgpr_write_b32 a14, 0
  v_accvgpr_write_b32 a15, 0
  v_accvgpr_write_b32 a16, 0
  v_accvgpr_write_b32 a17, 0
  v_accvgpr_write_b32 a18, 0
  v_accvgpr_write_b32 a19, 0
  v_accvgpr_write_b32 a20, 0
  v_accvgpr_write_b32 a21, 0
  v_accvgpr_write_b32 a22, 0
  v_accvgpr_write_b32 a23, 0
  v_accvgpr_write_b32 a24, 0
  v_accvgpr_write_b32 a25, 0
  v_accvgpr_write_b32 a26, 0
  v_accvgpr_write_b32 a27, 0
  v_accvgpr_write_b32 a28, 0
  v_accvgpr_write_b32 a29, 0
  v_accvgpr_write_b32 a30, 0
  v_accvgpr_write_b32 a31, 0
  v_accvgpr_write_b32 a32, 0
  v_accvgpr_write_b32 a33, 0
  v_accvgpr_write_b32 a34, 0
  v_accvgpr_write_b32 a35, 0
  v_accvgpr_write_b32 a36, 0
  v_accvgpr_write_b32 a37, 0
  v_accvgpr_write_b32 a38, 0
  v_accvgpr_write_b32 a39, 0
  v_accvgpr_write_b32 a40, 0
  v_accvgpr_write_b32 a41, 0
  v_accvgpr_write_b32 a42, 0
  v_accvgpr_write_b32 a43, 0
  v_accvgpr_write_b32 a44, 0
  v_accvgpr_write_b32 a45, 0
  v_accvgpr_write_b32 a46, 0
  v_accvgpr_write_b32 a47, 0
  v_accvgpr_write_b32 a48, 0
  v_accvgpr_write_b32 a49, 0
  v_accvgpr_write_b32 a50, 0
  v_accvgpr_write_b32 a51, 0
  v_accvgpr_write_b32 a52, 0
  v_accvgpr_write_b32 a53, 0
  v_accvgpr_write_b32 a54, 0
  v_accvgpr_write_b32 a55, 0
  v_accvgpr_write_b32 a56, 0
  v_accvgpr_write_b32 a57, 0
  v_accvgpr_write_b32 a58, 0
  v_accvgpr_write_b32 a59, 0
  v_accvgpr_write_b32 a60, 0
  v_accvgpr_write_b32 a61, 0
  v_accvgpr_write_b32 a62, 0
  v_accvgpr_write_b32 a63, 0
  v_accvgpr_write_b32 a64, 0
  v_accvgpr_write_b32 a65, 0
  v_accvgpr_write_b32 a66, 0
  v_accvgpr_write_b32 a67, 0
  v_accvgpr_write_b32 a68, 0
  v_accvgpr_write_b32 a69, 0
  v_accvgpr_write_b32 a70, 0
  v_accvgpr_write_b32 a71, 0
  v_accvgpr_write_b32 a72, 0
  v_accvgpr_write_b32 a73, 0
  v_accvgpr_write_b32 a74, 0
  v_accvgpr_write_b32 a75, 0
  v_accvgpr_write_b32 a76, 0
  v_accvgpr_write_b32 a77, 0
  v_accvgpr_write_b32 a78, 0
  v_accvgpr_write_b32 a79, 0
  v_accvgpr_write_b32 a80, 0
  v_accvgpr_write_b32 a81, 0
  v_accvgpr_write_b32 a82, 0
  v_accvgpr_write_b32 a83, 0
  v_accvgpr_write_b32 a84, 0
  v_accvgpr_write_b32 a85, 0
  v_accvgpr_write_b32 a86, 0
  v_accvgpr_write_b32 a87, 0
  v_accvgpr_write_b32 a88, 0
  v_accvgpr_write_b32 a89, 0
  v_accvgpr_write_b32 a90, 0
  v_accvgpr_write_b32 a91, 0
  v_accvgpr_write_b32 a92, 0
  v_accvgpr_write_b32 a93, 0
  v_accvgpr_write_b32 a94, 0
  v_accvgpr_write_b32 a95, 0
  v_accvgpr_write_b32 a96, 0
  v_accvgpr_write_b32 a97, 0
  v_accvgpr_write_b32 a98, 0
  v_accvgpr_write_b32 a99, 0
  v_accvgpr_write_b32 a100, 0
  v_accvgpr_write_b32 a101, 0
  v_accvgpr_write_b32 a102, 0
  v_accvgpr_write_b32 a103, 0
  v_accvgpr_write_b32 a104, 0
  v_accvgpr_write_b32 a105, 0
  v_accvgpr_write_b32 a106, 0
  v_accvgpr_write_b32 a107, 0
  v_accvgpr_write_b32 a108, 0
  v_accvgpr_write_b32 a109, 0
  v_accvgpr_write_b32 a110, 0
  v_accvgpr_write_b32 a111, 0
  v_accvgpr_write_b32 a112, 0
  v_accvgpr_write_b32 a113, 0
  v_accvgpr_write_b32 a114, 0
  v_accvgpr_write_b32 a115, 0
  v_accvgpr_write_b32 a116, 0
  v_accvgpr_write_b32 a117, 0
  v_accvgpr_write_b32 a118, 0
  v_accvgpr_write_b32 a119, 0
  v_accvgpr_write_b32 a120, 0
  v_accvgpr_write_b32 a121, 0
  v_accvgpr_write_b32 a122, 0
  v_accvgpr_write_b32 a123, 0
  v_accvgpr_write_b32 a124, 0
  v_accvgpr_write_b32 a125, 0
  v_accvgpr_write_b32 a126, 0
  v_accvgpr_write_b32 a127, 0
  v_mov_b32 v8, 0
  v_mov_b32 v9, 0
  v_mov_b32 v10, 0
  v_mov_b32 v11, 0
  v_mov_b32 v52, 0
  v_mov_b32 v53, 0
  v_mov_b32 v54, s24
  v_mov_b32 v55, s24
  v_mov_b32 v56, s24
  v_mov_b32 v57, s24
  v_mov_b32 v58, s24
  v_mov_b32 v59, s24
  v_mov_b32 v60, s24
  v_mov_b32 v61, s24
  v_mov_b32 v62, s24
  v_mov_b32 v63, s24
  v_mov_b32 v104, 0
  v_mov_b32 v105, 0
  v_mov_b32 v4, v2
  v_mov_b32 v64, s24
  v_mov_b32 v65, s24
  v_mov_b32 v66, s24
  v_mov_b32 v67, s24
  v_mov_b32 v68, s24
  v_mov_b32 v69, s24
  v_mov_b32 v70, s24
  v_mov_b32 v71, s24
  v_mov_b32 v72, s24
  v_mov_b32 v73, s24
  v_mov_b32 v74, s24
  v_mov_b32 v75, s24
  v_mov_b32 v76, s24
  v_mov_b32 v77, s24
  v_mov_b32 v78, s24
  v_mov_b32 v79, s24
  v_mov_b32 v12, s24
  v_cmp_le_i32 s[40:41], 0, v5
  v_cmp_le_i32 s[42:43], 1, v5
  v_cmp_le_i32 s[44:45], 2, v5
  v_cmp_le_i32 s[46:47], 3, v5
  v_cndmask_b32 v80, v12, v7, s[40:41]
  v_cndmask_b32 v81, v12, v7, s[42:43]
  v_cndmask_b32 v82, v12, v7, s[44:45]
  v_cndmask_b32 v83, v12, v7, s[46:47]
  v_cmp_le_i32 s[40:41], 8, v5
  v_cmp_le_i32 s[42:43], 9, v5
  v_cmp_le_i32 s[44:45], 10, v5
  v_cmp_le_i32 s[46:47], 11, v5
  v_cndmask_b32 v84, v12, v7, s[40:41]
  v_cndmask_b32 v85, v12, v7, s[42:43]
  v_cndmask_b32 v86, v12, v7, s[44:45]
  v_cndmask_b32 v87, v12, v7, s[46:47]
  v_cmp_le_i32 s[40:41], 16, v5
  v_cmp_le_i32 s[42:43], 17, v5
  v_cmp_le_i32 s[44:45], 18, v5
  v_cmp_le_i32 s[46:47], 19, v5
  v_cndmask_b32 v88, v12, v7, s[40:41]
  v_cndmask_b32 v89, v12, v7, s[42:43]
  v_cndmask_b32 v90, v12, v7, s[44:45]
  v_cndmask_b32 v91, v12, v7, s[46:47]
  v_cmp_le_i32 s[40:41], 24, v5
  v_cmp_le_i32 s[42:43], 25, v5
  v_cmp_le_i32 s[44:45], 26, v5
  v_cmp_le_i32 s[46:47], 27, v5
  v_cndmask_b32 v92, v12, v7, s[40:41]
  v_cndmask_b32 v93, v12, v7, s[42:43]
  v_cndmask_b32 v94, v12, v7, s[44:45]
  v_cndmask_b32 v95, v12, v7, s[46:47]
  s_lshl_b32 s22, s69, 3
  s_add_u32 s22, s22, 8
  s_lshl_b32 s26, s16, 1
  s_sub_u32 s23, 6, s26
  s_waitcnt vmcnt(20)
  s_barrier
  s_cmp_eq_u32 s23, 0
  s_cbranch_scc1 A_go_23
A_idle_22:
  s_waitcnt vmcnt(16)
  s_barrier
  s_sub_u32 s18, s18, 8192
  s_max_i32 s18, s18, s20
  s_sub_u32 s17, s17, 8192
  s_max_i32 s17, s17, s19
  s_add_u32 s21, s21, 16384
  s_and_b32 s21, s21, 131071
M_kv_24:
  s_cmp_ge_u32 s17, s36
  s_cbranch_scc1 M_kvok_25
  s_mov_b32 s76, 0
  s_mov_b32 s78, 20
  s_mov_b32 s77, 360448
  s_cmp_eq_u32 s68, 1
  s_cmov_b32 s76, 128
  s_cmov_b32 s78, 24
  s_cmov_b32 s77, 163840
  s_cmp_eq_u32 s68, 2
  s_cmov_b32 s76, 768
  s_cmov_b32 s78, 20
  s_cmov_b32 s77, 0
  s_add_u32 s76, s76, s67
  s_mov_b32 s71, 0
  s_branch M_sg_27
M_sw_26:
  s_sleep 8
  s_add_u32 s71, s71, 1
  s_cmp_gt_u32 s71, 262144
  s_cbranch_scc1 M_exit
M_sg_27:
  s_mov_b32 s79, 0
  s_atomic_or s79, s[72:73], s76 glc
  s_waitcnt lgkmcnt(0)
  s_cmp_lt_u32 s79, s78
  s_cbranch_scc1 M_sw_26
  s_add_u32 s36, s77, s19
  s_add_u32 s68, s68, 1
  s_branch M_kv_24
M_kvok_25:
  s_mov_b32 m0, s21
  s_nop 0
  buffer_load_dwordx4 v3, s[4:7], s18 offen offset:0 sc1 lds
  buffer_load_dwordx4 v3, s[4:7], s18 offen offset:1024 sc1 lds
  s_add_u32 m0, s21, 8192
  s_nop 0
  buffer_load_dwordx4 v3, s[4:7], s17 offen offset:0 sc1 lds
  buffer_load_dwordx4 v3, s[4:7], s17 offen offset:1024 sc1 lds
  v_add_u32 v4, 16384, v4
  v_and_b32 v4, 131071, v4
  s_sub_u32 s22, s22, 1
  s_sub_u32 s23, s23, 1
  s_cmp_lg_u32 s23, 0
  s_cbranch_scc1 A_idle_22
A_go_23:
  ds_read_b128 a[224:227], v4 offset:0
  ds_read_b128 a[228:231], v4 offset:2048
  ds_read_b128 a[232:235], v4 offset:4096
  ds_read_b128 a[236:239], v4 offset:6144
  ds_read_b128 a[240:243], v4 offset:1024
  ds_read_b128 a[244:247], v4 offset:3072
  ds_read_b128 a[248:251], v4 offset:5120
  ds_read_b128 a[252:255], v4 offset:7168
  ds_read_b128 a[192:195], v4 offset:8192
  ds_read_b128 a[196:199], v4 offset:9216
  ds_read_b128 a[200:203], v4 offset:10240
  ds_read_b128 a[204:207], v4 offset:11264
  ds_read_b128 a[208:211], v4 offset:12288
  ds_read_b128 a[212:215], v4 offset:13312
  ds_read_b128 a[216:219], v4 offset:14336
  ds_read_b128 a[220:223], v4 offset:15360
  v_add_u32 v4, 16384, v4
  v_and_b32 v4, 131071, v4
  s_waitcnt lgkmcnt(8)
.p2align 6
A_top_28:
  s_waitcnt lgkmcnt(7)
  v_mfma_f32_32x32x16_bf16 v[32:47], a[192:195], a[128:131], v[64:79]
  s_waitcnt lgkmcnt(6)
  v_exp_f32 v54, v54
  v_add_f32 v11, v11, v53
  v_cvt_pk_bf16_f32 v106, v52, v53
  v_mfma_f32_32x32x16_bf16 v[32:47], a[196:199], a[132:135], v[32:47]
  s_waitcnt lgkmcnt(4)
  v_exp_f32 v55, v55
  v_add_f32 v10, v10, v54
  v_mfma_f32_32x32x16_bf16 v[32:47], a[200:203], a[136:139], v[32:47]
  v_exp_f32 v56, v56
  v_add_f32 v11, v11, v55
  v_cvt_pk_bf16_f32 v107, v54, v55
  v_mfma_f32_32x32x16_bf16 v[32:47], a[204:207], a[140:143], v[32:47]
  s_waitcnt lgkmcnt(2)
  v_exp_f32 v57, v57
  v_add_f32 v10, v10, v56
  v_mfma_f32_32x32x16_bf16 v[32:47], a[208:211], a[144:147], v[32:47]
  v_exp_f32 v58, v58
  v_add_f32 v11, v11, v57
  v_cvt_pk_bf16_f32 v108, v56, v57
  v_mfma_f32_32x32x16_bf16 v[32:47], a[212:215], a[148:151], v[32:47]
  s_waitcnt lgkmcnt(0)
  v_exp_f32 v59, v59
  v_add_f32 v10, v10, v58
  v_mfma_f32_32x32x16_bf16 v[32:47], a[216:219], a[152:155], v[32:47]
  v_exp_f32 v60, v60
  v_add_f32 v11, v11, v59
  v_cvt_pk_bf16_f32 v109, v58, v59
  v_mfma_f32_32x32x16_bf16 v[32:47], a[220:223], a[156:159], v[32:47]
  s_waitcnt vmcnt(16)
  s_barrier
  v_exp_f32 v61, v61
  v_add_f32 v10, v10, v60
  v_mfma_f32_32x32x16_bf16 a[64:79], a[224:227], v[104:107], a[64:79]
  ds_read_b128 a[224:227], v4 offset:0
  v_exp_f32 v62, v62
  v_add_f32 v11, v11, v61
  v_cvt_pk_bf16_f32 v110, v60, v61
  v_mfma_f32_32x32x16_bf16 a[80:95], a[228:231], v[104:107], a[80:95]
  s_sub_u32 s18, s18, 8192
  ds_read_b128 a[228:231], v4 offset:2048
  v_exp_f32 v63, v63
  v_add_f32 v10, v10, v62
  v_mfma_f32_32x32x16_bf16 a[96:111], a[232:235], v[104:107], a[96:111]
  s_max_i32 s18, s18, s20
  ds_read_b128 a[232:235], v4 offset:4096
  v_exp_f32 v32, v32
  v_add_f32 v11, v11, v63
  v_cvt_pk_bf16_f32 v111, v62, v63
  v_mfma_f32_32x32x16_bf16 a[112:127], a[236:239], v[104:107], a[112:127]
  s_sub_u32 s17, s17, 8192
  ds_read_b128 a[236:239], v4 offset:6144
  v_exp_f32 v33, v33
  v_add_f32 v8, v8, v32
  v_mfma_f32_32x32x16_bf16 a[64:79], a[240:243], v[108:111], a[64:79]
  s_max_i32 s17, s17, s19
  ds_read_b128 a[240:243], v4 offset:1024
  v_exp_f32 v34, v34
  v_add_f32 v9, v9, v33
  v_cvt_pk_bf16_f32 v96, v32, v33
  v_mfma_f32_32x32x16_bf16 a[80:95], a[244:247], v[108:111], a[80:95]
  s_add_u32 s21, s21, 16384
  ds_read_b128 a[244:247], v4 offset:3072
  v_exp_f32 v35, v35
  v_add_f32 v8, v8, v34
  v_mfma_f32_32x32x16_bf16 a[96:111], a[248:251], v[108:111], a[96:111]
  s_and_b32 s21, s21, 131071
  ds_read_b128 a[248:251], v4 offset:5120
  v_exp_f32 v36, v36
  v_add_f32 v9, v9, v35
  v_cvt_pk_bf16_f32 v97, v34, v35
  v_mfma_f32_32x32x16_bf16 a[112:127], a[252:255], v[108:111], a[112:127]
  ds_read_b128 a[252:255], v4 offset:7168
  v_exp_f32 v37, v37
  v_add_f32 v8, v8, v36
  v_mfma_f32_32x32x16_bf16 v[48:63], a[192:195], a[160:163], v[80:95]
  s_add_u32 s23, s23, 1
  ds_read_b128 a[192:195], v4 offset:8192
  v_exp_f32 v38, v38
  v_add_f32 v9, v9, v37
  v_cvt_pk_bf16_f32 v98, v36, v37
  v_mfma_f32_32x32x16_bf16 v[48:63], a[196:199], a[164:167], v[48:63]
  s_sub_u32 s22, s22, 1
  ds_read_b128 a[196:199], v4 offset:9216
  v_exp_f32 v39, v39
  v_add_f32 v8, v8, v38
  v_mfma_f32_32x32x16_bf16 v[48:63], a[200:203], a[168:171], v[48:63]
  s_cmp_lt_u32 s23, 3
  ds_read_b128 a[200:203], v4 offset:10240
  v_exp_f32 v40, v40
  v_add_f32 v9, v9, v39
  v_cvt_pk_bf16_f32 v99, v38, v39
  v_mfma_f32_32x32x16_bf16 v[48:63], a[204:207], a[172:175], v[48:63]
  s_cbranch_scc1 A_upd_29
A_back_30:
  ds_read_b128 a[204:207], v4 offset:11264
  v_exp_f32 v41, v41
  v_add_f32 v8, v8, v40
  v_mfma_f32_32x32x16_bf16 v[48:63], a[208:211], a[176:179], v[48:63]
  s_cmp_lt_u32 s17, s36
  ds_read_b128 a[208:211], v4 offset:12288
  v_exp_f32 v42, v42
  v_add_f32 v9, v9, v41
  v_cvt_pk_bf16_f32 v100, v40, v41
  v_mfma_f32_32x32x16_bf16 v[48:63], a[212:215], a[180:183], v[48:63]
  s_cbranch_scc1 A_kvw_32
A_kvb_33:
  ds_read_b128 a[212:215], v4 offset:13312
  v_exp_f32 v43, v43
  v_add_f32 v8, v8, v42
  v_mfma_f32_32x32x16_bf16 v[48:63], a[216:219], a[184:187], v[48:63]
  s_mov_b32 m0, s21
  ds_read_b128 a[216:219], v4 offset:14336
  v_exp_f32 v44, v44
  v_add_f32 v9, v9, v43
  v_cvt_pk_bf16_f32 v101, v42, v43
  v_mfma_f32_32x32x16_bf16 v[48:63], a[220:223], a[188:191], v[48:63]
  s_waitcnt lgkmcnt(13)
  ds_read_b128 a[220:223], v4 offset:15360
  v_exp_f32 v45, v45
  v_add_f32 v8, v8, v44
  v_mfma_f32_32x32x16_bf16 a[0:15], a[224:227], v[96:99], a[0:15]
  buffer_load_dwordx4 v3, s[4:7], s18 offen offset:0 sc1 lds
  v_exp_f32 v46, v46
  v_add_f32 v9, v9, v45
  v_cvt_pk_bf16_f32 v102, v44, v45
  v_mfma_f32_32x32x16_bf16 a[16:31], a[228:231], v[96:99], a[16:31]
  s_waitcnt lgkmcnt(12)
  v_exp_f32 v47, v47
  v_add_f32 v8, v8, v46
  v_add_u32 v4, 16384, v4
  v_mfma_f32_32x32x16_bf16 a[32:47], a[232:235], v[96:99], a[32:47]
  buffer_load_dwordx4 v3, s[4:7], s18 offen offset:1024 sc1 lds
  v_exp_f32 v48, v48
  v_add_f32 v9, v9, v47
  v_cvt_pk_bf16_f32 v103, v46, v47
  v_mfma_f32_32x32x16_bf16 a[48:63], a[236:239], v[96:99], a[48:63]
  s_waitcnt lgkmcnt(10)
  s_add_u32 m0, s21, 8192
  v_exp_f32 v49, v49
  v_add_f32 v10, v10, v48
  v_and_b32 v4, 131071, v4
  v_mfma_f32_32x32x16_bf16 a[0:15], a[240:243], v[100:103], a[0:15]
  buffer_load_dwordx4 v3, s[4:7], s17 offen offset:0 sc1 lds
  v_exp_f32 v50, v50
  v_add_f32 v11, v11, v49
  v_cvt_pk_bf16_f32 v104, v48, v49
  v_mfma_f32_32x32x16_bf16 a[16:31], a[244:247], v[100:103], a[16:31]
  s_waitcnt lgkmcnt(8)
  s_cmp_lg_u32 s22, 0
  v_exp_f32 v51, v51
  v_add_f32 v10, v10, v50
  v_mfma_f32_32x32x16_bf16 a[32:47], a[248:251], v[100:103], a[32:47]
  buffer_load_dwordx4 v3, s[4:7], s17 offen offset:1024 sc1 lds
  v_exp_f32 v52, v52
  v_add_f32 v11, v11, v51
  v_cvt_pk_bf16_f32 v105, v50, v51
  v_mfma_f32_32x32x16_bf16 a[48:63], a[252:255], v[100:103], a[48:63]
  v_exp_f32 v53, v53
  v_add_f32 v10, v10, v52
  s_cbranch_scc1 A_top_28
  v_exp_f32 v54, v54
  v_add_f32 v11, v11, v53
  v_cvt_pk_bf16_f32 v106, v52, v53
  v_exp_f32 v55, v55
  v_add_f32 v10, v10, v54
  v_exp_f32 v56, v56
  v_add_f32 v11, v11, v55
  v_cvt_pk_bf16_f32 v107, v54, v55
  v_exp_f32 v57, v57
  v_add_f32 v10, v10, v56
  v_exp_f32 v58, v58
  v_add_f32 v11, v11, v57
  v_cvt_pk_bf16_f32 v108, v56, v57
  v_exp_f32 v59, v59
  v_add_f32 v10, v10, v58
  v_exp_f32 v60, v60
  v_add_f32 v11, v11, v59
  v_cvt_pk_bf16_f32 v109, v58, v59
  v_exp_f32 v61, v61
  v_add_f32 v10, v10, v60
  v_exp_f32 v62, v62
  v_add_f32 v11, v11, v61
  v_cvt_pk_bf16_f32 v110, v60, v61
  v_exp_f32 v63, v63
  v_add_f32 v10, v10, v62
  v_add_f32 v11, v11, v63
  v_cvt_pk_bf16_f32 v111, v62, v63
  s_nop 1
  v_mfma_f32_32x32x16_bf16 a[64:79], a[224:227], v[104:107], a[64:79]
  v_mfma_f32_32x32x16_bf16 a[80:95], a[228:231], v[104:107], a[80:95]
  v_mfma_f32_32x32x16_bf16 a[96:111], a[232:235], v[104:107], a[96:111]
  v_mfma_f32_32x32x16_bf16 a[112:127], a[236:239], v[104:107], a[112:127]
  v_mfma_f32_32x32x16_bf16 a[64:79], a[240:243], v[108:111], a[64:79]
  v_mfma_f32_32x32x16_bf16 a[80:95], a[244:247], v[108:111], a[80:95]
  v_mfma_f32_32x32x16_bf16 a[96:111], a[248:251], v[108:111], a[96:111]
  v_mfma_f32_32x32x16_bf16 a[112:127], a[252:255], v[108:111], a[112:127]
  v_add_f32 v8, v8, v9
  v_mov_b32 v9, v8
  s_nop 1
  v_permlane32_swap_b32 v8, v9
  s_nop 1
  v_add_f32 v8, v8, v9
  v_add_f32 v10, v10, v11
  v_mov_b32 v11, v10
  s_nop 1
  v_permlane32_swap_b32 v10, v11
  s_nop 1
  v_add_f32 v10, v10, v11
  v_subrev_u32 v12, 0x2f800000, v8
  v_subrev_u32 v13, 0x2f800000, v10
  v_max_u32 v12, v12, v13
  v_cmp_le_u32 vcc, 0x28000000, v12
  s_nop 1
  s_cmp_lg_u64 vcc, 0
  s_cselect_b32 s26, 1, 0
  v_mov_b32 v12, s26
  s_lshl_b32 s26, s16, 2
  s_add_u32 s26, s26, 131072
  v_mov_b32 v13, s26
  ds_write_b32 v13, v12
  v_mov_b32 v14, 131072
  s_waitcnt vmcnt(0) lgkmcnt(0)
  s_barrier
  ds_read_b128 v[16:19], v14
  v_rcp_f32 v8, v8
  v_rcp_f32 v10, v10
  s_waitcnt lgkmcnt(0)
  v_or3_b32 v12, v16, v17, v18
  v_or_b32 v12, v12, v19
  s_nop 0
  v_readfirstlane_b32 s26, v12
  s_nop 1
  s_cmp_gt_u32 s26, s29
  s_cbranch_scc1 A_slow_34
  s_add_u32 s28, s25, 100663296
  v_accvgpr_read_b32 v112, a0
  v_accvgpr_read_b32 v113, a1
  v_accvgpr_read_b32 v114, a2
  v_accvgpr_read_b32 v115, a3
  v_accvgpr_read_b32 v116, a4
  v_accvgpr_read_b32 v117, a5
  v_accvgpr_read_b32 v118, a6
  v_accvgpr_read_b32 v119, a7
  v_pk_mul_f32 v[112:113], v[112:113], v[8:9] op_sel_hi:[1,0]
  v_pk_mul_f32 v[114:115], v[114:115], v[8:9] op_sel_hi:[1,0]
  v_pk_mul_f32 v[116:117], v[116:117], v[8:9] op_sel_hi:[1,0]
  v_pk_mul_f32 v[118:119], v[118:119], v[8:9] op_sel_hi:[1,0]
  v_cvt_pk_bf16_f32 v120, v112, v113
  v_cvt_pk_bf16_f32 v121, v114, v115
  v_cvt_pk_bf16_f32 v122, v116, v117
  v_cvt_pk_bf16_f32 v123, v118, v119
  buffer_store_dwordx4 v[120:123], v2, s[4:7], s28 offen offset:0 sc1
  v_accvgpr_read_b32 v124, a8
  v_accvgpr_read_b32 v125, a9
  v_accvgpr_read_b32 v126, a10
  v_accvgpr_read_b32 v127, a11
  v_accvgpr_read_b32 v128, a12
  v_accvgpr_read_b32 v129, a13
  v_accvgpr_read_b32 v130, a14
  v_accvgpr_read_b32 v131, a15
  v_pk_mul_f32 v[124:125], v[124:125], v[8:9] op_sel_hi:[1,0]
  v_pk_mul_f32 v[126:127], v[126:127], v[8:9] op_sel_hi:[1,0]
  v_pk_mul_f32 v[128:129], v[128:129], v[8:9] op_sel_hi:[1,0]
  v_pk_mul_f32 v[130:131], v[130:131], v[8:9] op_sel_hi:[1,0]
  v_cvt_pk_bf16_f32 v132, v124, v125
  v_cvt_pk_bf16_f32 v133, v126, v127
  v_cvt_pk_bf16_f32 v134, v128, v129
  v_cvt_pk_bf16_f32 v135, v130, v131
  buffer_store_dwordx4 v[132:135], v2, s[4:7], s28 offen offset:1024 sc1
  v_accvgpr_read_b32 v136, a16
  v_accvgpr_read_b32 v137, a17
  v_accvgpr_read_b32 v138, a18
  v_accvgpr_read_b32 v139, a19
  v_accvgpr_read_b32 v140, a20
  v_accvgpr_read_b32 v141, a21
  v_accvgpr_read_b32 v142, a22
  v_accvgpr_read_b32 v143, a23
  v_pk_mul_f32 v[136:137], v[136:137], v[8:9] op_sel_hi:[1,0]
  v_pk_mul_f32 v[138:139], v[138:139], v[8:9] op_sel_hi:[1,0]
  v_pk_mul_f32 v[140:141], v[140:141], v[8:9] op_sel_hi:[1,0]
  v_pk_mul_f32 v[142:143], v[142:143], v[8:9] op_sel_hi:[1,0]
  v_cvt_pk_bf16_f32 v144, v136, v137
  v_cvt_pk_bf16_f32 v145, v138, v139
  v_cvt_pk_bf16_f32 v146, v140, v141
  v_cvt_pk_bf16_f32 v147, v142, v143
  buffer_store_dwordx4 v[144:147], v2, s[4:7], s28 offen offset:2048 sc1
  v_accvgpr_read_b32 v148, a24
  v_accvgpr_read_b32 v149, a25
  v_accvgpr_read_b32 v150, a26
  v_accvgpr_read_b32 v151, a27
  v_accvgpr_read_b32 v152, a28
  v_accvgpr_read_b32 v153, a29
  v_accvgpr_read_b32 v154, a30
  v_accvgpr_read_b32 v155, a31
  v_pk_mul_f32 v[148:149], v[148:149], v[8:9] op_sel_hi:[1,0]
  v_pk_mul_f32 v[150:151], v[150:151], v[8:9] op_sel_hi:[1,0]
  v_pk_mul_f32 v[152:153], v[152:153], v[8:9] op_sel_hi:[1,0]
  v_pk_mul_f32 v[154:155], v[154:155], v[8:9] op_sel_hi:[1,0]
  v_cvt_pk_bf16_f32 v156, v148, v149
  v_cvt_pk_bf16_f32 v157, v150, v151
  v_cvt_pk_bf16_f32 v158, v152, v153
  v_cvt_pk_bf16_f32 v159, v154, v155
  buffer_store_dwordx4 v[156:159], v2, s[4:7], s28 offen offset:3072 sc1
  s_add_u32 s28, s25, 100667392
  v_accvgpr_read_b32 v112, a32
  v_accvgpr_read_b32 v113, a33
  v_accvgpr_read_b32 v114, a34
  v_accvgpr_read_b32 v115, a35
  v_accvgpr_read_b32 v116, a36
  v_accvgpr_read_b32 v117, a37
  v_accvgpr_read_b32 v118, a38
  v_accvgpr_read_b32 v119, a39
  v_pk_mul_f32 v[112:113], v[112:113], v[8:9] op_sel_hi:[1,0]
  v_pk_mul_f32 v[114:115], v[114:115], v[8:9] op_sel_hi:[1,0]
  v_pk_mul_f32 v[116:117], v[116:117], v[8:9] op_sel_hi:[1,0]
  v_pk_mul_f32 v[118:119], v[118:119], v[8:9] op_sel_hi:[1,0]
  v_cvt_pk_bf16_f32 v120, v112, v113
  v_cvt_pk_bf16_f32 v121, v114, v115
  v_cvt_pk_bf16_f32 v122, v116, v117
  v_cvt_pk_bf16_f32 v123, v118, v119
  buffer_store_dwordx4 v[120:123], v2, s[4:7], s28 offen offset:0 sc1
  v_accvgpr_read_b32 v124, a40
  v_accvgpr_read_b32 v125, a41
  v_accvgpr_read_b32 v126, a42
  v_accvgpr_read_b32 v127, a43
  v_accvgpr_read_b32 v128, a44
  v_accvgpr_read_b32 v129, a45
  v_accvgpr_read_b32 v130, a46
  v_accvgpr_read_b32 v131, a47
  v_pk_mul_f32 v[124:125], v[124:125], v[8:9] op_sel_hi:[1,0]
  v_pk_mul_f32 v[126:127], v[126:127], v[8:9] op_sel_hi:[1,0]
  v_pk_mul_f32 v[128:129], v[128:129], v[8:9] op_sel_hi:[1,0]
  v_pk_mul_f32 v[130:131], v[130:131], v[8:9] op_sel_hi:[1,0]
  v_cvt_pk_bf16_f32 v132, v124, v125
  v_cvt_pk_bf16_f32 v133, v126, v127
  v_cvt_pk_bf16_f32 v134, v128, v129
  v_cvt_pk_bf16_f32 v135, v130, v131
  buffer_store_dwordx4 v[132:135], v2, s[4:7], s28 offen offset:1024 sc1
  v_accvgpr_read_b32 v136, a48
  v_accvgpr_read_b32 v137, a49
  v_accvgpr_read_b32 v138, a50
  v_accvgpr_read_b32 v139, a51
  v_accvgpr_read_b32 v140, a52
  v_accvgpr_read_b32 v141, a53
  v_accvgpr_read_b32 v142, a54
  v_accvgpr_read_b32 v143, a55
  v_pk_mul_f32 v[136:137], v[136:137], v[8:9] op_sel_hi:[1,0]
  v_pk_mul_f32 v[138:139], v[138:139], v[8:9] op_sel_hi:[1,0]
  v_pk_mul_f32 v[140:141], v[140:141], v[8:9] op_sel_hi:[1,0]
  v_pk_mul_f32 v[142:143], v[142:143], v[8:9] op_sel_hi:[1,0]
  v_cvt_pk_bf16_f32 v144, v136, v137
  v_cvt_pk_bf16_f32 v145, v138, v139
  v_cvt_pk_bf16_f32 v146, v140, v141
  v_cvt_pk_bf16_f32 v147, v142, v143
  buffer_store_dwordx4 v[144:147], v2, s[4:7], s28 offen offset:2048 sc1
  v_accvgpr_read_b32 v148, a56
  v_accvgpr_read_b32 v149, a57
  v_accvgpr_read_b32 v150, a58
  v_accvgpr_read_b32 v151, a59
  v_accvgpr_read_b32 v152, a60
  v_accvgpr_read_b32 v153, a61
  v_accvgpr_read_b32 v154, a62
  v_accvgpr_read_b32 v155, a63
  v_pk_mul_f32 v[148:149], v[148:149], v[8:9] op_sel_hi:[1,0]
  v_pk_mul_f32 v[150:151], v[150:151], v[8:9] op_sel_hi:[1,0]
  v_pk_mul_f32 v[152:153], v[152:153], v[8:9] op_sel_hi:[1,0]
  v_pk_mul_f32 v[154:155], v[154:155], v[8:9] op_sel_hi:[1,0]
  v_cvt_pk_bf16_f32 v156, v148, v149
  v_cvt_pk_bf16_f32 v157, v150, v151
  v_cvt_pk_bf16_f32 v158, v152, v153
  v_cvt_pk_bf16_f32 v159, v154, v155
  buffer_store_dwordx4 v[156:159], v2, s[4:7], s28 offen offset:3072 sc1
  s_add_u32 s28, s25, 100671488
  v_accvgpr_read_b32 v112, a64
  v_accvgpr_read_b32 v113, a65
  v_accvgpr_read_b32 v114, a66
  v_accvgpr_read_b32 v115, a67
  v_accvgpr_read_b32 v116, a68
  v_accvgpr_read_b32 v117, a69
  v_accvgpr_read_b32 v118, a70
  v_accvgpr_read_b32 v119, a71
  v_pk_mul_f32 v[112:113], v[112:113], v[10:11] op_sel_hi:[1,0]
  v_pk_mul_f32 v[114:115], v[114:115], v[10:11] op_sel_hi:[1,0]
  v_pk_mul_f32 v[116:117], v[116:117], v[10:11] op_sel_hi:[1,0]
  v_pk_mul_f32 v[118:119], v[118:119], v[10:11] op_sel_hi:[1,0]
  v_cvt_pk_bf16_f32 v120, v112, v113
  v_cvt_pk_bf16_f32 v121, v114, v115
  v_cvt_pk_bf16_f32 v122, v116, v117
  v_cvt_pk_bf16_f32 v123, v118, v119
  buffer_store_dwordx4 v[120:123], v2, s[4:7], s28 offen offset:0 sc1
  v_accvgpr_read_b32 v124, a72
  v_accvgpr_read_b32 v125, a73
  v_accvgpr_read_b32 v126, a74
  v_accvgpr_read_b32 v127, a75
  v_accvgpr_read_b32 v128, a76
  v_accvgpr_read_b32 v129, a77
  v_accvgpr_read_b32 v130, a78
  v_accvgpr_read_b32 v131, a79
  v_pk_mul_f32 v[124:125], v[124:125], v[10:11] op_sel_hi:[1,0]
  v_pk_mul_f32 v[126:127], v[126:127], v[10:11] op_sel_hi:[1,0]
  v_pk_mul_f32 v[128:129], v[128:129], v[10:11] op_sel_hi:[1,0]
  v_pk_mul_f32 v[130:131], v[130:131], v[10:11] op_sel_hi:[1,0]
  v_cvt_pk_bf16_f32 v132, v124, v125
  v_cvt_pk_bf16_f32 v133, v126, v127
  v_cvt_pk_bf16_f32 v134, v128, v129
  v_cvt_pk_bf16_f32 v135, v130, v131
  buffer_store_dwordx4 v[132:135], v2, s[4:7], s28 offen offset:1024 sc1
  v_accvgpr_read_b32 v136, a80
  v_accvgpr_read_b32 v137, a81
  v_accvgpr_read_b32 v138, a82
  v_accvgpr_read_b32 v139, a83
  v_accvgpr_read_b32 v140, a84
  v_accvgpr_read_b32 v141, a85
  v_accvgpr_read_b32 v142, a86
  v_accvgpr_read_b32 v143, a87
  v_pk_mul_f32 v[136:137], v[136:137], v[10:11] op_sel_hi:[1,0]
  v_pk_mul_f32 v[138:139], v[138:139], v[10:11] op_sel_hi:[1,0]
  v_pk_mul_f32 v[140:141], v[140:141], v[10:11] op_sel_hi:[1,0]
  v_pk_mul_f32 v[142:143], v[142:143], v[10:11] op_sel_hi:[1,0]
  v_cvt_pk_bf16_f32 v144, v136, v137
  v_cvt_pk_bf16_f32 v145, v138, v139
  v_cvt_pk_bf16_f32 v146, v140, v141
  v_cvt_pk_bf16_f32 v147, v142, v143
  buffer_store_dwordx4 v[144:147], v2, s[4:7], s28 offen offset:2048 sc1
  v_accvgpr_read_b32 v148, a88
  v_accvgpr_read_b32 v149, a89
  v_accvgpr_read_b32 v150, a90
  v_accvgpr_read_b32 v151, a91
  v_accvgpr_read_b32 v152, a92
  v_accvgpr_read_b32 v153, a93
  v_accvgpr_read_b32 v154, a94
  v_accvgpr_read_b32 v155, a95
  v_pk_mul_f32 v[148:149], v[148:149], v[10:11] op_sel_hi:[1,0]
  v_pk_mul_f32 v[150:151], v[150:151], v[10:11] op_sel_hi:[1,0]
  v_pk_mul_f32 v[152:153], v[152:153], v[10:11] op_sel_hi:[1,0]
  v_pk_mul_f32 v[154:155], v[154:155], v[10:11] op_sel_hi:[1,0]
  v_cvt_pk_bf16_f32 v156, v148, v149
  v_cvt_pk_bf16_f32 v157, v150, v151
  v_cvt_pk_bf16_f32 v158, v152, v153
  v_cvt_pk_bf16_f32 v159, v154, v155
  buffer_store_dwordx4 v[156:159], v2, s[4:7], s28 offen offset:3072 sc1
  s_add_u32 s28, s25, 100675584
  v_accvgpr_read_b32 v112, a96
  v_accvgpr_read_b32 v113, a97
  v_accvgpr_read_b32 v114, a98
  v_accvgpr_read_b32 v115, a99
  v_accvgpr_read_b32 v116, a100
  v_accvgpr_read_b32 v117, a101
  v_accvgpr_read_b32 v118, a102
  v_accvgpr_read_b32 v119, a103
  v_pk_mul_f32 v[112:113], v[112:113], v[10:11] op_sel_hi:[1,0]
  v_pk_mul_f32 v[114:115], v[114:115], v[10:11] op_sel_hi:[1,0]
  v_pk_mul_f32 v[116:117], v[116:117], v[10:11] op_sel_hi:[1,0]
  v_pk_mul_f32 v[118:119], v[118:119], v[10:11] op_sel_hi:[1,0]
  v_cvt_pk_bf16_f32 v120, v112, v113
  v_cvt_pk_bf16_f32 v121, v114, v115
  v_cvt_pk_bf16_f32 v122, v116, v117
  v_cvt_pk_bf16_f32 v123, v118, v119
  buffer_store_dwordx4 v[120:123], v2, s[4:7], s28 offen offset:0 sc1
  v_accvgpr_read_b32 v124, a104
  v_accvgpr_read_b32 v125, a105
  v_accvgpr_read_b32 v126, a106
  v_accvgpr_read_b32 v127, a107
  v_accvgpr_read_b32 v128, a108
  v_accvgpr_read_b32 v129, a109
  v_accvgpr_read_b32 v130, a110
  v_accvgpr_read_b32 v131, a111
  v_pk_mul_f32 v[124:125], v[124:125], v[10:11] op_sel_hi:[1,0]
  v_pk_mul_f32 v[126:127], v[126:127], v[10:11] op_sel_hi:[1,0]
  v_pk_mul_f32 v[128:129], v[128:129], v[10:11] op_sel_hi:[1,0]
  v_pk_mul_f32 v[130:131], v[130:131], v[10:11] op_sel_hi:[1,0]
  v_cvt_pk_bf16_f32 v132, v124, v125
  v_cvt_pk_bf16_f32 v133, v126, v127
  v_cvt_pk_bf16_f32 v134, v128, v129
  v_cvt_pk_bf16_f32 v135, v130, v131
  buffer_store_dwordx4 v[132:135], v2, s[4:7], s28 offen offset:1024 sc1
  v_accvgpr_read_b32 v136, a112
  v_accvgpr_read_b32 v137, a113
  v_accvgpr_read_b32 v138, a114
  v_accvgpr_read_b32 v139, a115
  v_accvgpr_read_b32 v140, a116
  v_accvgpr_read_b32 v141, a117
  v_accvgpr_read_b32 v142, a118
  v_accvgpr_read_b32 v143, a119
  v_pk_mul_f32 v[136:137], v[136:137], v[10:11] op_sel_hi:[1,0]
  v_pk_mul_f32 v[138:139], v[138:139], v[10:11] op_sel_hi:[1,0]
  v_pk_mul_f32 v[140:141], v[140:141], v[10:11] op_sel_hi:[1,0]
  v_pk_mul_f32 v[142:143], v[142:143], v[10:11] op_sel_hi:[1,0]
  v_cvt_pk_bf16_f32 v144, v136, v137
  v_cvt_pk_bf16_f32 v145, v138, v139
  v_cvt_pk_bf16_f32 v146, v140, v141
  v_cvt_pk_bf16_f32 v147, v142, v143
  buffer_store_dwordx4 v[144:147], v2, s[4:7], s28 offen offset:2048 sc1
  v_accvgpr_read_b32 v148, a120
  v_accvgpr_read_b32 v149, a121
  v_accvgpr_read_b32 v150, a122
  v_accvgpr_read_b32 v151, a123
  v_accvgpr_read_b32 v152, a124
  v_accvgpr_read_b32 v153, a125
  v_accvgpr_read_b32 v154, a126
  v_accvgpr_read_b32 v155, a127
  v_pk_mul_f32 v[148:149], v[148:149], v[10:11] op_sel_hi:[1,0]
  v_pk_mul_f32 v[150:151], v[150:151], v[10:11] op_sel_hi:[1,0]
  v_pk_mul_f32 v[152:153], v[152:153], v[10:11] op_sel_hi:[1,0]
  v_pk_mul_f32 v[154:155], v[154:155], v[10:11] op_sel_hi:[1,0]
  v_cvt_pk_bf16_f32 v156, v148, v149
  v_cvt_pk_bf16_f32 v157, v150, v151
  v_cvt_pk_bf16_f32 v158, v152, v153
  v_cvt_pk_bf16_f32 v159, v154, v155
  buffer_store_dwordx4 v[156:159], v2, s[4:7], s28 offen offset:3072 sc1
  s_branch A_out_31
A_kvw_32:
M_kv_35:
  s_cmp_ge_u32 s17, s36
  s_cbranch_scc1 M_kvok_36
  s_mov_b32 s76, 0
  s_mov_b32 s78, 20
  s_mov_b32 s77, 360448
  s_cmp_eq_u32 s68, 1
  s_cmov_b32 s76, 128
  s_cmov_b32 s78, 24
  s_cmov_b32 s77, 163840
  s_cmp_eq_u32 s68, 2
  s_cmov_b32 s76, 768
  s_cmov_b32 s78, 20
  s_cmov_b32 s77, 0
  s_add_u32 s76, s76, s67
  s_mov_b32 s71, 0
  s_branch M_sg_38
M_sw_37:
  s_sleep 8
  s_add_u32 s71, s71, 1
  s_cmp_gt_u32 s71, 262144
  s_cbranch_scc1 M_exit
M_sg_38:
  s_mov_b32 s79, 0
  s_atomic_or s79, s[72:73], s76 glc
  s_waitcnt lgkmcnt(0)
  s_cmp_lt_u32 s79, s78
  s_cbranch_scc1 M_sw_37
  s_add_u32 s36, s77, s19
  s_add_u32 s68, s68, 1
  s_branch M_kv_35
M_kvok_36:
  s_branch A_kvb_33
A_upd_29:
  s_cmp_eq_u32 s23, 2
  s_cbranch_scc1 A_upd2_39
  v_mov_b32 v12, s24
  v_cmp_le_i32 s[40:41], 0, v5
  v_cmp_le_i32 s[42:43], 1, v5
  v_cmp_le_i32 s[44:45], 2, v5
  v_cmp_le_i32 s[46:47], 3, v5
  v_cndmask_b32 v64, v12, v6, s[40:41]
  v_cndmask_b32 v65, v12, v6, s[42:43]
  v_cndmask_b32 v66, v12, v6, s[44:45]
  v_cndmask_b32 v67, v12, v6, s[46:47]
  v_cmp_le_i32 s[40:41], 8, v5
  v_cmp_le_i32 s[42:43], 9, v5
  v_cmp_le_i32 s[44:45], 10, v5
  v_cmp_le_i32 s[46:47], 11, v5
  v_cndmask_b32 v68, v12, v6, s[40:41]
  v_cndmask_b32 v69, v12, v6, s[42:43]
  v_cndmask_b32 v70, v12, v6, s[44:45]
  v_cndmask_b32 v71, v12, v6, s[46:47]
  v_cmp_le_i32 s[40:41], 16, v5
  v_cmp_le_i32 s[42:43], 17, v5
  v_cmp_le_i32 s[44:45], 18, v5
  v_cmp_le_i32 s[46:47], 19, v5
  v_cndmask_b32 v72, v12, v6, s[40:41]
  v_cndmask_b32 v73, v12, v6, s[42:43]
  v_cndmask_b32 v74, v12, v6, s[44:45]
  v_cndmask_b32 v75, v12, v6, s[46:47]
  v_cmp_le_i32 s[40:41], 24, v5
  v_cmp_le_i32 s[42:43], 25, v5
  v_cmp_le_i32 s[44:45], 26, v5
  v_cmp_le_i32 s[46:47], 27, v5
  v_cndmask_b32 v76, v12, v6, s[40:41]
  v_cndmask_b32 v77, v12, v6, s[42:43]
  v_cndmask_b32 v78, v12, v6, s[44:45]
  v_cndmask_b32 v79, v12, v6, s[46:47]
  v_mov_b32 v80, v7
  v_mov_b32 v81, v7
  v_mov_b32 v82, v7
  v_mov_b32 v83, v7
  v_mov_b32 v84, v7
  v_mov_b32 v85, v7
  v_mov_b32 v86, v7
  v_mov_b32 v87, v7
  v_mov_b32 v88, v7
  v_mov_b32 v89, v7
  v_mov_b32 v90, v7
  v_mov_b32 v91, v7
  v_mov_b32 v92, v7
  v_mov_b32 v93, v7
  v_mov_b32 v94, v7
  v_mov_b32 v95, v7
  s_branch A_back_30
A_upd2_39:
  v_mov_b32 v64, v6
  v_mov_b32 v65, v6
  v_mov_b32 v66, v6
  v_mov_b32 v67, v6
  v_mov_b32 v68, v6
  v_mov_b32 v69, v6
  v_mov_b32 v70, v6
  v_mov_b32 v71, v6
  v_mov_b32 v72, v6
  v_mov_b32 v73, v6
  v_mov_b32 v74, v6
  v_mov_b32 v75, v6
  v_mov_b32 v76, v6
  v_mov_b32 v77, v6
  v_mov_b32 v78, v6
  v_mov_b32 v79, v6
  s_branch A_back_30
A_slow_34:
  s_mov_b32 s29, 1
  v_mov_b32 v64, s24
  v_mov_b32 v65, s24
  v_mov_b32 v66, s24
  v_mov_b32 v67, s24
  v_mov_b32 v68, s24
  v_mov_b32 v69, s24
  v_mov_b32 v70, s24
  v_mov_b32 v71, s24
  v_mov_b32 v72, s24
  v_mov_b32 v73, s24
  v_mov_b32 v74, s24
  v_mov_b32 v75, s24
  v_mov_b32 v76, s24
  v_mov_b32 v77, s24
  v_mov_b32 v78, s24
  v_mov_b32 v79, s24
  v_mov_b32 v12, s24
  v_cmp_le_i32 s[40:41], 0, v5
  v_cmp_le_i32 s[42:43], 1, v5
  v_cmp_le_i32 s[44:45], 2, v5
  v_cmp_le_i32 s[46:47], 3, v5
  v_cndmask_b32 v80, v12, v7, s[40:41]
  v_cndmask_b32 v81, v12, v7, s[42:43]
  v_cndmask_b32 v82, v12, v7, s[44:45]
  v_cndmask_b32 v83, v12, v7, s[46:47]
  v_cmp_le_i32 s[40:41], 8, v5
  v_cmp_le_i32 s[42:43], 9, v5
  v_cmp_le_i32 s[44:45], 10, v5
  v_cmp_le_i32 s[46:47], 11, v5
  v_cndmask_b32 v84, v12, v7, s[40:41]
  v_cndmask_b32 v85, v12, v7, s[42:43]
  v_cndmask_b32 v86, v12, v7, s[44:45]
  v_cndmask_b32 v87, v12, v7, s[46:47]
  v_cmp_le_i32 s[40:41], 16, v5
  v_cmp_le_i32 s[42:43], 17, v5
  v_cmp_le_i32 s[44:45], 18, v5
  v_cmp_le_i32 s[46:47], 19, v5
  v_cndmask_b32 v88, v12, v7, s[40:41]
  v_cndmask_b32 v89, v12, v7, s[42:43]
  v_cndmask_b32 v90, v12, v7, s[44:45]
  v_cndmask_b32 v91, v12, v7, s[46:47]
  v_cmp_le_i32 s[40:41], 24, v5
  v_cmp_le_i32 s[42:43], 25, v5
  v_cmp_le_i32 s[44:45], 26, v5
  v_cmp_le_i32 s[46:47], 27, v5
  v_cndmask_b32 v92, v12, v7, s[40:41]
  v_cndmask_b32 v93, v12, v7, s[42:43]
  v_cndmask_b32 v94, v12, v7, s[44:45]
  v_cndmask_b32 v95, v12, v7, s[46:47]
  v_mov_b32 v8, s24
  v_mov_b32 v10, s24
  s_add_u32 s17, s25, 16785408
  s_mov_b32 s23, 0
A_ml_40:
  s_add_u32 s28, s17, 4096
  buffer_load_dwordx4 a[192:195], v2, s[4:7], s17 offen offset:0 sc1
  buffer_load_dwordx4 a[196:199], v2, s[4:7], s17 offen offset:1024 sc1
  buffer_load_dwordx4 a[200:203], v2, s[4:7], s17 offen offset:2048 sc1
  buffer_load_dwordx4 a[204:207], v2, s[4:7], s17 offen offset:3072 sc1
  buffer_load_dwordx4 a[208:211], v2, s[4:7], s28 offen offset:0 sc1
  buffer_load_dwordx4 a[212:215], v2, s[4:7], s28 offen offset:1024 sc1
  buffer_load_dwordx4 a[216:219], v2, s[4:7], s28 offen offset:2048 sc1
  buffer_load_dwordx4 a[220:223], v2, s[4:7], s28 offen offset:3072 sc1
  s_waitcnt vmcnt(0)
  v_mfma_f32_32x32x16_bf16 v[32:47], a[192:195], a[128:131], v[64:79]
  v_mfma_f32_32x32x16_bf16 v[32:47], a[196:199], a[132:135], v[32:47]
  v_mfma_f32_32x32x16_bf16 v[32:47], a[200:203], a[136:139], v[32:47]
  v_mfma_f32_32x32x16_bf16 v[32:47], a[204:207], a[140:143], v[32:47]
  v_mfma_f32_32x32x16_bf16 v[32:47], a[208:211], a[144:147], v[32:47]
  v_mfma_f32_32x32x16_bf16 v[32:47], a[212:215], a[148:151], v[32:47]
  v_mfma_f32_32x32x16_bf16 v[32:47], a[216:219], a[152:155], v[32:47]
  v_mfma_f32_32x32x16_bf16 v[32:47], a[220:223], a[156:159], v[32:47]
  v_mfma_f32_32x32x16_bf16 v[48:63], a[192:195], a[160:163], v[80:95]
  v_mfma_f32_32x32x16_bf16 v[48:63], a[196:199], a[164:167], v[48:63]
  v_mfma_f32_32x32x16_bf16 v[48:63], a[200:203], a[168:171], v[48:63]
  v_mfma_f32_32x32x16_bf16 v[48:63], a[204:207], a[172:175], v[48:63]
  v_mfma_f32_32x32x16_bf16 v[48:63], a[208:211], a[176:179], v[48:63]
  v_mfma_f32_32x32x16_bf16 v[48:63], a[212:215], a[180:183], v[48:63]
  v_mfma_f32_32x32x16_bf16 v[48:63], a[216:219], a[184:187], v[48:63]
  v_mfma_f32_32x32x16_bf16 v[48:63], a[220:223], a[188:191], v[48:63]
  s_nop 7
  s_nop 3
  v_max3_f32 v8, v8, v32, v33
  v_max3_f32 v8, v8, v34, v35
  v_max3_f32 v8, v8, v36, v37
  v_max3_f32 v8, v8, v38, v39
  v_max3_f32 v8, v8, v40, v41
  v_max3_f32 v8, v8, v42, v43
  v_max3_f32 v8, v8, v44, v45
  v_max3_f32 v8, v8, v46, v47
  v_max3_f32 v10, v10, v48, v49
  v_max3_f32 v10, v10, v50, v51
  v_max3_f32 v10, v10, v52, v53
  v_max3_f32 v10, v10, v54, v55
  v_max3_f32 v10, v10, v56, v57
  v_max3_f32 v10, v10, v58, v59
  v_max3_f32 v10, v10, v60, v61
  v_max3_f32 v10, v10, v62, v63
  s_add_u32 s23, s23, 1
  s_cmp_lg_u32 s23, 1
  s_cbranch_scc1 A_m2_41
  v_mov_b32 v12, s24
  v_cmp_le_i32 s[40:41], 0, v5
  v_cmp_le_i32 s[42:43], 1, v5
  v_cmp_le_i32 s[44:45], 2, v5
  v_cmp_le_i32 s[46:47], 3, v5
  v_cndmask_b32 v64, v12, v6, s[40:41]
  v_cndmask_b32 v65, v12, v6, s[42:43]
  v_cndmask_b32 v66, v12, v6, s[44:45]
  v_cndmask_b32 v67, v12, v6, s[46:47]
  v_cmp_le_i32 s[40:41], 8, v5
  v_cmp_le_i32 s[42:43], 9, v5
  v_cmp_le_i32 s[44:45], 10, v5
  v_cmp_le_i32 s[46:47], 11, v5
  v_cndmask_b32 v68, v12, v6, s[40:41]
  v_cndmask_b32 v69, v12, v6, s[42:43]
  v_cndmask_b32 v70, v12, v6, s[44:45]
  v_cndmask_b32 v71, v12, v6, s[46:47]
  v_cmp_le_i32 s[40:41], 16, v5
  v_cmp_le_i32 s[42:43], 17, v5
  v_cmp_le_i32 s[44:45], 18, v5
  v_cmp_le_i32 s[46:47], 19, v5
  v_cndmask_b32 v72, v12, v6, s[40:41]
  v_cndmask_b32 v73, v12, v6, s[42:43]
  v_cndmask_b32 v74, v12, v6, s[44:45]
  v_cndmask_b32 v75, v12, v6, s[46:47]
  v_cmp_le_i32 s[40:41], 24, v5
  v_cmp_le_i32 s[42:43], 25, v5
  v_cmp_le_i32 s[44:45], 26, v5
  v_cmp_le_i32 s[46:47], 27, v5
  v_cndmask_b32 v76, v12, v6, s[40:41]
  v_cndmask_b32 v77, v12, v6, s[42:43]
  v_cndmask_b32 v78, v12, v6, s[44:45]
  v_cndmask_b32 v79, v12, v6, s[46:47]
  v_mov_b32 v80, v7
  v_mov_b32 v81, v7
  v_mov_b32 v82, v7
  v_mov_b32 v83, v7
  v_mov_b32 v84, v7
  v_mov_b32 v85, v7
  v_mov_b32 v86, v7
  v_mov_b32 v87, v7
  v_mov_b32 v88, v7
  v_mov_b32 v89, v7
  v_mov_b32 v90, v7
  v_mov_b32 v91, v7
  v_mov_b32 v92, v7
  v_mov_b32 v93, v7
  v_mov_b32 v94, v7
  v_mov_b32 v95, v7
A_m2_41:
  s_cmp_lg_u32 s23, 2
  s_cbranch_scc1 A_m3_42
  v_mov_b32 v64, v6
  v_mov_b32 v65, v6
  v_mov_b32 v66, v6
  v_mov_b32 v67, v6
  v_mov_b32 v68, v6
  v_mov_b32 v69, v6
  v_mov_b32 v70, v6
  v_mov_b32 v71, v6
  v_mov_b32 v72, v6
  v_mov_b32 v73, v6
  v_mov_b32 v74, v6
  v_mov_b32 v75, v6
  v_mov_b32 v76, v6
  v_mov_b32 v77, v6
  v_mov_b32 v78, v6
  v_mov_b32 v79, v6
A_m3_42:
  s_sub_u32 s17, s17, 8192
  s_cmp_ge_i32 s17, s19
  s_cbranch_scc1 A_ml_40
  v_mov_b32 v9, v8
  s_nop 1
  v_permlane32_swap_b32 v8, v9
  s_nop 1
  v_max_f32 v8, v8, v9
  v_sub_f32 v6, 0, v8
  v_mov_b32 v11, v10
  s_nop 1
  v_permlane32_swap_b32 v10, v11
  s_nop 1
  v_max_f32 v10, v10, v11
  v_sub_f32 v7, 0, v10
  s_branch A_again_21
A_out_31:
  s_mov_b32 s69, s55
  s_mov_b32 s70, s56
  s_sub_u32 s52, s52, 1
  s_cmp_lg_u32 s52, 0
  s_cbranch_scc1 M_att
  s_waitcnt vmcnt(0)
  s_barrier
  s_mov_b32 s30, 512
  v_mov_b32 v144, s30
  v_min_u32 v145, 1, v0
  v_lshlrev_b32 v145, 30, v145
  buffer_store_dword v144, v145, s[4:7], s31 offen sc1
  s_lshr_b32 s48, s64, 2
  s_bfe_u32 s49, s64, 0x10001
  s_and_b32 s50, s64, 1
  s_mul_i32 s50, s50, 6
  s_add_u32 s50, s50, s65
  s_mov_b32 s51, 12
  s_cmp_lt_u32 s50, 4
  s_cselect_b32 s23, 6, 5
  s_load_dwordx2 s[8:9], s[0:1], 40
  s_lshl_b32 s17, s48, 19
  s_lshl_b32 s26, s49, 2
  s_add_u32 s26, s26, s16
  s_lshl_b32 s27, s26, 7
  s_add_u32 s17, s17, s27
  s_mov_b32 s18, 1024
  s_lshl_b32 s21, s48, 6
  s_add_u32 s21, s21, s50
  s_lshl_b32 s21, s21, 3
  s_add_u32 s21, s21, s26
  s_lshl_b32 s21, s21, 12
  s_add_u32 s21, s21, 150994944
  s_lshl_b32 s22, s51, 15
  s_mov_b32 s24, 1.0
  s_waitcnt lgkmcnt(0)
  s_and_b32 s9, s9, 0xffff
  s_mov_b32 s10, 4194304
  s_mov_b32 s11, 0x20000
  s_mov_b32 s12, s4
  s_mov_b32 s13, s5
  s_mov_b32 s14, 268435456
  s_mov_b32 s15, 0x20000
  s_lshl_b32 s19, s48, 8
  s_add_u32 s19, s19, s50
  s_lshl_b32 s19, s19, 13
  s_add_u32 s19, s19, 100663296
  s_lshl_b32 s20, s51, 13
  s_mul_i32 s26, s16, 524288
  v_add_u32 v8, 0, v2
  v_add_u32 v16, s26, v8
  v_add_u32 v9, 1024, v2
  v_add_u32 v17, s26, v9
  v_add_u32 v10, 2048, v2
  v_add_u32 v18, s26, v10
  v_add_u32 v11, 3072, v2
  v_add_u32 v19, s26, v11
  v_add_u32 v12, 4096, v2
  v_add_u32 v20, s26, v12
  v_add_u32 v13, 5120, v2
  v_add_u32 v21, s26, v13
  v_add_u32 v14, 6144, v2
  v_add_u32 v22, s26, v14
  v_add_u32 v15, 7168, v2
  v_add_u32 v23, s26, v15
  v_lshrrev_b32 v144, 3, v1
  v_mul_lo_u32 v144, v144, s18
  v_and_b32 v145, 7, v1
  v_lshl_add_u32 v144, v145, 4, v144
  s_lshl_b32 s28, s16, 15
  s_add_u32 s28, s28, 32768
  s_lshl_b32 s29, s18, 3
  s_add_u32 m0, s28, 0
  s_nop 0
  buffer_load_dwordx4 v144, s[8:11], s17 offen lds
  s_add_u32 s17, s17, s29
  s_add_u32 m0, s28, 1024
  s_nop 0
  buffer_load_dwordx4 v144, s[8:11], s17 offen lds
  s_add_u32 s17, s17, s29
  s_add_u32 m0, s28, 2048
  s_nop 0
  buffer_load_dwordx4 v144, s[8:11], s17 offen lds
  s_add_u32 s17, s17, s29
  s_add_u32 m0, s28, 3072
  s_nop 0
  buffer_load_dwordx4 v144, s[8:11], s17 offen lds
  s_add_u32 s17, s17, s29
  s_add_u32 m0, s28, 4096
  s_nop 0
  buffer_load_dwordx4 v144, s[8:11], s17 offen lds
  s_add_u32 s17, s17, s29
  s_add_u32 m0, s28, 5120
  s_nop 0
  buffer_load_dwordx4 v144, s[8:11], s17 offen lds
  s_add_u32 s17, s17, s29
  s_add_u32 m0, s28, 6144
  s_nop 0
  buffer_load_dwordx4 v144, s[8:11], s17 offen lds
  s_add_u32 s17, s17, s29
  s_add_u32 m0, s28, 7168
  s_nop 0
  buffer_load_dwordx4 v144, s[8:11], s17 offen lds
  s_add_u32 s17, s17, s29
  s_add_u32 m0, s28, 8192
  s_nop 0
  buffer_load_dwordx4 v144, s[8:11], s17 offen lds
  s_add_u32 s17, s17, s29
  s_add_u32 m0, s28, 9216
  s_nop 0
  buffer_load_dwordx4 v144, s[8:11], s17 offen lds
  s_add_u32 s17, s17, s29
  s_add_u32 m0, s28, 10240
  s_nop 0
  buffer_load_dwordx4 v144, s[8:11], s17 offen lds
  s_add_u32 s17, s17, s29
  s_add_u32 m0, s28, 11264
  s_nop 0
  buffer_load_dwordx4 v144, s[8:11], s17 offen lds
  s_add_u32 s17, s17, s29
  s_add_u32 m0, s28, 12288
  s_nop 0
  buffer_load_dwordx4 v144, s[8:11], s17 offen lds
  s_add_u32 s17, s17, s29
  s_add_u32 m0, s28, 13312
  s_nop 0
  buffer_load_dwordx4 v144, s[8:11], s17 offen lds
  s_add_u32 s17, s17, s29
  s_add_u32 m0, s28, 14336
  s_nop 0
  buffer_load_dwordx4 v144, s[8:11], s17 offen lds
  s_add_u32 s17, s17, s29
  s_add_u32 m0, s28, 15360
  s_nop 0
  buffer_load_dwordx4 v144, s[8:11], s17 offen lds
  s_add_u32 s17, s17, s29
  s_add_u32 m0, s28, 16384
  s_nop 0
  buffer_load_dwordx4 v144, s[8:11], s17 offen lds
  s_add_u32 s17, s17, s29
  s_add_u32 m0, s28, 17408
  s_nop 0
  buffer_load_dwordx4 v144, s[8:11], s17 offen lds
  s_add_u32 s17, s17, s29
  s_add_u32 m0, s28, 18432
  s_nop 0
  buffer_load_dwordx4 v144, s[8:11], s17 offen lds
  s_add_u32 s17, s17, s29
  s_add_u32 m0, s28, 19456
  s_nop 0
  buffer_load_dwordx4 v144, s[8:11], s17 offen lds
  s_add_u32 s17, s17, s29
  s_add_u32 m0, s28, 20480
  s_nop 0
  buffer_load_dwordx4 v144, s[8:11], s17 offen lds
  s_add_u32 s17, s17, s29
  s_add_u32 m0, s28, 21504
  s_nop 0
  buffer_load_dwordx4 v144, s[8:11], s17 offen lds
  s_add_u32 s17, s17, s29
  s_add_u32 m0, s28, 22528
  s_nop 0
  buffer_load_dwordx4 v144, s[8:11], s17 offen lds
  s_add_u32 s17, s17, s29
  s_add_u32 m0, s28, 23552
  s_nop 0
  buffer_load_dwordx4 v144, s[8:11], s17 offen lds
  s_add_u32 s17, s17, s29
  s_add_u32 m0, s28, 24576
  s_nop 0
  buffer_load_dwordx4 v144, s[8:11], s17 offen lds
  s_add_u32 s17, s17, s29
  s_add_u32 m0, s28, 25600
  s_nop 0
  buffer_load_dwordx4 v144, s[8:11], s17 offen lds
  s_add_u32 s17, s17, s29
  s_add_u32 m0, s28, 26624
  s_nop 0
  buffer_load_dwordx4 v144, s[8:11], s17 offen lds
  s_add_u32 s17, s17, s29
  s_add_u32 m0, s28, 27648
  s_nop 0
  buffer_load_dwordx4 v144, s[8:11], s17 offen lds
  s_add_u32 s17, s17, s29
  s_add_u32 m0, s28, 28672
  s_nop 0
  buffer_load_dwordx4 v144, s[8:11], s17 offen lds
  s_add_u32 s17, s17, s29
  s_add_u32 m0, s28, 29696
  s_nop 0
  buffer_load_dwordx4 v144, s[8:11], s17 offen lds
  s_add_u32 s17, s17, s29
  s_add_u32 m0, s28, 30720
  s_nop 0
  buffer_load_dwordx4 v144, s[8:11], s17 offen lds
  s_add_u32 s17, s17, s29
  s_add_u32 m0, s28, 31744
  s_nop 0
  buffer_load_dwordx4 v144, s[8:11], s17 offen lds
  s_add_u32 s17, s17, s29
  v_bfe_u32 v148, v1, 2, 2
  v_lshrrev_b32 v149, 5, v1
  v_lshl_add_u32 v148, v149, 2, v148
  v_lshlrev_b32 v148, 7, v148
  v_bfe_u32 v149, v1, 4, 1
  v_lshl_add_u32 v148, v149, 5, v148
  v_and_b32 v149, 1, v1
  v_lshl_add_u32 v148, v149, 4, v148
  v_bfe_u32 v149, v1, 1, 1
  v_lshl_add_u32 v148, v149, 3, v148
  v_add_u32 v146, s28, v148
  v_add_u32 v147, 1024, v146
  s_waitcnt vmcnt(28)
  ds_read_b64_tr_b16 a[0:1], v146 offset:0
  ds_read_b64_tr_b16 a[2:3], v147 offset:0
  ds_read_b64_tr_b16 a[4:5], v146 offset:64
  ds_read_b64_tr_b16 a[6:7], v147 offset:64
  ds_read_b64_tr_b16 a[8:9], v146 offset:2048
  ds_read_b64_tr_b16 a[10:11], v147 offset:2048
  ds_read_b64_tr_b16 a[12:13], v146 offset:2112
  ds_read_b64_tr_b16 a[14:15], v147 offset:2112
  s_waitcnt lgkmcnt(0)
  s_add_u32 m0, s28, 0
  s_nop 0
  buffer_load_dwordx4 v144, s[8:11], s17 offen lds
  s_add_u32 s17, s17, s29
  s_add_u32 m0, s28, 1024
  s_nop 0
  buffer_load_dwordx4 v144, s[8:11], s17 offen lds
  s_add_u32 s17, s17, s29
  s_add_u32 m0, s28, 2048
  s_nop 0
  buffer_load_dwordx4 v144, s[8:11], s17 offen lds
  s_add_u32 s17, s17, s29
  s_add_u32 m0, s28, 3072
  s_nop 0
  buffer_load_dwordx4 v144, s[8:11], s17 offen lds
  s_add_u32 s17, s17, s29
  s_waitcnt vmcnt(28)
  ds_read_b64_tr_b16 a[16:17], v146 offset:4096
  ds_read_b64_tr_b16 a[18:19], v147 offset:4096
  ds_read_b64_tr_b16 a[20:21], v146 offset:4160
  ds_read_b64_tr_b16 a[22:23], v147 offset:4160
  ds_read_b64_tr_b16 a[24:25], v146 offset:6144
  ds_read_b64_tr_b16 a[26:27], v147 offset:6144
  ds_read_b64_tr_b16 a[28:29], v146 offset:6208
  ds_read_b64_tr_b16 a[30:31], v147 offset:6208
  s_waitcnt lgkmcnt(0)
  s_add_u32 m0, s28, 4096
  s_nop 0
  buffer_load_dwordx4 v144, s[8:11], s17 offen lds
  s_add_u32 s17, s17, s29
  s_add_u32 m0, s28, 5120
  s_nop 0
  buffer_load_dwordx4 v144, s[8:11], s17 offen lds
  s_add_u32 s17, s17, s29
  s_add_u32 m0, s28, 6144
  s_nop 0
  buffer_load_dwordx4 v144, s[8:11], s17 offen lds
  s_add_u32 s17, s17, s29
  s_add_u32 m0, s28, 7168
  s_nop 0
  buffer_load_dwordx4 v144, s[8:11], s17 offen lds
  s_add_u32 s17, s17, s29
  s_waitcnt vmcnt(28)
  ds_read_b64_tr_b16 a[32:33], v146 offset:8192
  ds_read_b64_tr_b16 a[34:35], v147 offset:8192
  ds_read_b64_tr_b16 a[36:37], v146 offset:8256
  ds_read_b64_tr_b16 a[38:39], v147 offset:8256
  ds_read_b64_tr_b16 a[40:41], v146 offset:10240
  ds_read_b64_tr_b16 a[42:43], v147 offset:10240
  ds_read_b64_tr_b16 a[44:45], v146 offset:10304
  ds_read_b64_tr_b16 a[46:47], v147 offset:10304
  s_waitcnt lgkmcnt(0)
  s_add_u32 m0, s28, 8192
  s_nop 0
  buffer_load_dwordx4 v144, s[8:11], s17 offen lds
  s_add_u32 s17, s17, s29
  s_add_u32 m0, s28, 9216
  s_nop 0
  buffer_load_dwordx4 v144, s[8:11], s17 offen lds
  s_add_u32 s17, s17, s29
  s_add_u32 m0, s28, 10240
  s_nop 0
  buffer_load_dwordx4 v144, s[8:11], s17 offen lds
  s_add_u32 s17, s17, s29
  s_add_u32 m0, s28, 11264
  s_nop 0
  buffer_load_dwordx4 v144, s[8:11], s17 offen lds
  s_add_u32 s17, s17, s29
  s_waitcnt vmcnt(28)
  ds_read_b64_tr_b16 a[48:49], v146 offset:12288
  ds_read_b64_tr_b16 a[50:51], v147 offset:12288
  ds_read_b64_tr_b16 a[52:53], v146 offset:12352
  ds_read_b64_tr_b16 a[54:55], v147 offset:12352
  ds_read_b64_tr_b16 a[56:57], v146 offset:14336
  ds_read_b64_tr_b16 a[58:59], v147 offset:14336
  ds_read_b64_tr_b16 a[60:61], v146 offset:14400
  ds_read_b64_tr_b16 a[62:63], v147 offset:14400
  s_waitcnt lgkmcnt(0)
  s_add_u32 m0, s28, 12288
  s_nop 0
  buffer_load_dwordx4 v144, s[8:11], s17 offen lds
  s_add_u32 s17, s17, s29
  s_add_u32 m0, s28, 13312
  s_nop 0
  buffer_load_dwordx4 v144, s[8:11], s17 offen lds
  s_add_u32 s17, s17, s29
  s_add_u32 m0, s28, 14336
  s_nop 0
  buffer_load_dwordx4 v144, s[8:11], s17 offen lds
  s_add_u32 s17, s17, s29
  s_add_u32 m0, s28, 15360
  s_nop 0
  buffer_load_dwordx4 v144, s[8:11], s17 offen lds
  s_add_u32 s17, s17, s29
  s_waitcnt vmcnt(28)
  ds_read_b64_tr_b16 a[64:65], v146 offset:16384
  ds_read_b64_tr_b16 a[66:67], v147 offset:16384
  ds_read_b64_tr_b16 a[68:69], v146 offset:16448
  ds_read_b64_tr_b16 a[70:71], v147 offset:16448
  ds_read_b64_tr_b16 a[72:73], v146 offset:18432
  ds_read_b64_tr_b16 a[74:75], v147 offset:18432
  ds_read_b64_tr_b16 a[76:77], v146 offset:18496
  ds_read_b64_tr_b16 a[78:79], v147 offset:18496
  s_waitcnt lgkmcnt(0)
  s_add_u32 m0, s28, 16384
  s_nop 0
  buffer_load_dwordx4 v144, s[8:11], s17 offen lds
  s_add_u32 s17, s17, s29
  s_add_u32 m0, s28, 17408
  s_nop 0
  buffer_load_dwordx4 v144, s[8:11], s17 offen lds
  s_add_u32 s17, s17, s29
  s_add_u32 m0, s28, 18432
  s_nop 0
  buffer_load_dwordx4 v144, s[8:11], s17 offen lds
  s_add_u32 s17, s17, s29
  s_add_u32 m0, s28, 19456
  s_nop 0
  buffer_load_dwordx4 v144, s[8:11], s17 offen lds
  s_add_u32 s17, s17, s29
  s_waitcnt vmcnt(28)
  ds_read_b64_tr_b16 a[80:81], v146 offset:20480
  ds_read_b64_tr_b16 a[82:83], v147 offset:20480
  ds_read_b64_tr_b16 a[84:85], v146 offset:20544
  ds_read_b64_tr_b16 a[86:87], v147 offset:20544
  ds_read_b64_tr_b16 a[88:89], v146 offset:22528
  ds_read_b64_tr_b16 a[90:91], v147 offset:22528
  ds_read_b64_tr_b16 a[92:93], v146 offset:22592
  ds_read_b64_tr_b16 a[94:95], v147 offset:22592
  s_waitcnt lgkmcnt(0)
  s_add_u32 m0, s28, 20480
  s_nop 0
  buffer_load_dwordx4 v144, s[8:11], s17 offen lds
  s_add_u32 s17, s17, s29
  s_add_u32 m0, s28, 21504
  s_nop 0
  buffer_load_dwordx4 v144, s[8:11], s17 offen lds
  s_add_u32 s17, s17, s29
  s_add_u32 m0, s28, 22528
  s_nop 0
  buffer_load_dwordx4 v144, s[8:11], s17 offen lds
  s_add_u32 s17, s17, s29
  s_add_u32 m0, s28, 23552
  s_nop 0
  buffer_load_dwordx4 v144, s[8:11], s17 offen lds
  s_add_u32 s17, s17, s29
  s_waitcnt vmcnt(28)
  ds_read_b64_tr_b16 a[96:97], v146 offset:24576
  ds_read_b64_tr_b16 a[98:99], v147 offset:24576
  ds_read_b64_tr_b16 a[100:101], v146 offset:24640
  ds_read_b64_tr_b16 a[102:103], v147 offset:24640
  ds_read_b64_tr_b16 a[104:105], v146 offset:26624
  ds_read_b64_tr_b16 a[106:107], v147 offset:26624
  ds_read_b64_tr_b16 a[108:109], v146 offset:26688
  ds_read_b64_tr_b16 a[110:111], v147 offset:26688
  s_waitcnt lgkmcnt(0)
  s_add_u32 m0, s28, 24576
  s_nop 0
  buffer_load_dwordx4 v144, s[8:11], s17 offen lds
  s_add_u32 s17, s17, s29
  s_add_u32 m0, s28, 25600
  s_nop 0
  buffer_load_dwordx4 v144, s[8:11], s17 offen lds
  s_add_u32 s17, s17, s29
  s_add_u32 m0, s28, 26624
  s_nop 0
  buffer_load_dwordx4 v144, s[8:11], s17 offen lds
  s_add_u32 s17, s17, s29
  s_add_u32 m0, s28, 27648
  s_nop 0
  buffer_load_dwordx4 v144, s[8:11], s17 offen lds
  s_add_u32 s17, s17, s29
  s_waitcnt vmcnt(28)
  ds_read_b64_tr_b16 a[112:113], v146 offset:28672
  ds_read_b64_tr_b16 a[114:115], v147 offset:28672
  ds_read_b64_tr_b16 a[116:117], v146 offset:28736
  ds_read_b64_tr_b16 a[118:119], v147 offset:28736
  ds_read_b64_tr_b16 a[120:121], v146 offset:30720
  ds_read_b64_tr_b16 a[122:123], v147 offset:30720
  ds_read_b64_tr_b16 a[124:125], v146 offset:30784
  ds_read_b64_tr_b16 a[126:127], v147 offset:30784
  s_waitcnt lgkmcnt(0)
  s_add_u32 m0, s28, 28672
  s_nop 0
  buffer_load_dwordx4 v144, s[8:11], s17 offen lds
  s_add_u32 s17, s17, s29
  s_add_u32 m0, s28, 29696
  s_nop 0
  buffer_load_dwordx4 v144, s[8:11], s17 offen lds
  s_add_u32 s17, s17, s29
  s_add_u32 m0, s28, 30720
  s_nop 0
  buffer_load_dwordx4 v144, s[8:11], s17 offen lds
  s_add_u32 s17, s17, s29
  s_add_u32 m0, s28, 31744
  s_nop 0
  buffer_load_dwordx4 v144, s[8:11], s17 offen lds
  s_add_u32 s17, s17, s29
  s_waitcnt vmcnt(28)
  ds_read_b64_tr_b16 a[128:129], v146 offset:0
  ds_read_b64_tr_b16 a[130:131], v147 offset:0
  ds_read_b64_tr_b16 a[132:133], v146 offset:64
  ds_read_b64_tr_b16 a[134:135], v147 offset:64
  ds_read_b64_tr_b16 a[136:137], v146 offset:2048
  ds_read_b64_tr_b16 a[138:139], v147 offset:2048
  ds_read_b64_tr_b16 a[140:141], v146 offset:2112
  ds_read_b64_tr_b16 a[142:143], v147 offset:2112
  s_waitcnt lgkmcnt(0)
  s_waitcnt vmcnt(24)
  ds_read_b64_tr_b16 a[144:145], v146 offset:4096
  ds_read_b64_tr_b16 a[146:147], v147 offset:4096
  ds_read_b64_tr_b16 a[148:149], v146 offset:4160
  ds_read_b64_tr_b16 a[150:151], v147 offset:4160
  ds_read_b64_tr_b16 a[152:153], v146 offset:6144
  ds_read_b64_tr_b16 a[154:155], v147 offset:6144
  ds_read_b64_tr_b16 a[156:157], v146 offset:6208
  ds_read_b64_tr_b16 a[158:159], v147 offset:6208
  s_waitcnt lgkmcnt(0)
  s_waitcnt vmcnt(20)
  ds_read_b64_tr_b16 a[160:161], v146 offset:8192
  ds_read_b64_tr_b16 a[162:163], v147 offset:8192
  ds_read_b64_tr_b16 a[164:165], v146 offset:8256
  ds_read_b64_tr_b16 a[166:167], v147 offset:8256
  ds_read_b64_tr_b16 a[168:169], v146 offset:10240
  ds_read_b64_tr_b16 a[170:171], v147 offset:10240
  ds_read_b64_tr_b16 a[172:173], v146 offset:10304
  ds_read_b64_tr_b16 a[174:175], v147 offset:10304
  s_waitcnt lgkmcnt(0)
  s_waitcnt vmcnt(16)
  ds_read_b64_tr_b16 a[176:177], v146 offset:12288
  ds_read_b64_tr_b16 a[178:179], v147 offset:12288
  ds_read_b64_tr_b16 a[180:181], v146 offset:12352
  ds_read_b64_tr_b16 a[182:183], v147 offset:12352
  ds_read_b64_tr_b16 a[184:185], v146 offset:14336
  ds_read_b64_tr_b16 a[186:187], v147 offset:14336
  ds_read_b64_tr_b16 a[188:189], v146 offset:14400
  ds_read_b64_tr_b16 a[190:191], v147 offset:14400
  s_waitcnt lgkmcnt(0)
  s_waitcnt vmcnt(12)
  ds_read_b64_tr_b16 a[192:193], v146 offset:16384
  ds_read_b64_tr_b16 a[194:195], v147 offset:16384
  ds_read_b64_tr_b16 a[196:197], v146 offset:16448
  ds_read_b64_tr_b16 a[198:199], v147 offset:16448
  ds_read_b64_tr_b16 a[200:201], v146 offset:18432
  ds_read_b64_tr_b16 a[202:203], v147 offset:18432
  ds_read_b64_tr_b16 a[204:205], v146 offset:18496
  ds_read_b64_tr_b16 a[206:207], v147 offset:18496
  s_waitcnt lgkmcnt(0)
  s_waitcnt vmcnt(8)
  ds_read_b64_tr_b16 a[208:209], v146 offset:20480
  ds_read_b64_tr_b16 a[210:211], v147 offset:20480
  ds_read_b64_tr_b16 a[212:213], v146 offset:20544
  ds_read_b64_tr_b16 a[214:215], v147 offset:20544
  ds_read_b64_tr_b16 a[216:217], v146 offset:22528
  ds_read_b64_tr_b16 a[218:219], v147 offset:22528
  ds_read_b64_tr_b16 a[220:221], v146 offset:22592
  ds_read_b64_tr_b16 a[222:223], v147 offset:22592
  s_waitcnt lgkmcnt(0)
  s_waitcnt vmcnt(4)
  ds_read_b64_tr_b16 a[224:225], v146 offset:24576
  ds_read_b64_tr_b16 a[226:227], v147 offset:24576
  ds_read_b64_tr_b16 a[228:229], v146 offset:24640
  ds_read_b64_tr_b16 a[230:231], v147 offset:24640
  ds_read_b64_tr_b16 a[232:233], v146 offset:26624
  ds_read_b64_tr_b16 a[234:235], v147 offset:26624
  ds_read_b64_tr_b16 a[236:237], v146 offset:26688
  ds_read_b64_tr_b16 a[238:239], v147 offset:26688
  s_waitcnt lgkmcnt(0)
  s_waitcnt vmcnt(0)
  ds_read_b64_tr_b16 a[240:241], v146 offset:28672
  ds_read_b64_tr_b16 a[242:243], v147 offset:28672
  ds_read_b64_tr_b16 a[244:245], v146 offset:28736
  ds_read_b64_tr_b16 a[246:247], v147 offset:28736
  ds_read_b64_tr_b16 a[248:249], v146 offset:30720
  ds_read_b64_tr_b16 a[250:251], v147 offset:30720
  ds_read_b64_tr_b16 a[252:253], v146 offset:30784
  ds_read_b64_tr_b16 a[254:255], v147 offset:30784
  s_waitcnt lgkmcnt(0)
  v_min_u32 v4, 27, v1
  v_mul_u32_u24 v5, 37, v4
  v_lshrrev_b32 v5, 8, v5
  v_mul_u32_u24 v5, 7, v5
  v_sub_u32 v5, v4, v5
  v_mov_b32 v6, 0x200
  v_cmp_ne_u32 vcc, 6, v5
  s_mul_i32 s76, s48, 3584
  s_add_u32 s76, s76, 148897792
  v_cndmask_b32 v5, 0, v6, vcc
  v_lshl_add_u32 v4, v4, 7, s76
  s_mov_b32 s71, 0
  s_branch M_vg_44
M_vw_43:
  s_sleep 2
  s_add_u32 s71, s71, 1
  s_cmp_gt_u32 s71, 262144
  s_cbranch_scc1 M_exit
M_vg_44:
  buffer_load_dword v6, v4, s[4:7], 0 offen sc1
  s_waitcnt vmcnt(0)
  v_cmp_lt_u32 vcc, v6, v5
  s_cbranch_vccnz M_vw_43
  s_barrier
  s_lshl_b32 s25, s16, 13
  s_add_u32 m0, s25, 0
  s_nop 0
  buffer_load_dwordx4 v16, s[12:15], s19 offen sc1 lds
  s_add_u32 m0, s25, 1024
  s_nop 0
  buffer_load_dwordx4 v17, s[12:15], s19 offen sc1 lds
  s_add_u32 m0, s25, 2048
  s_nop 0
  buffer_load_dwordx4 v18, s[12:15], s19 offen sc1 lds
  s_add_u32 m0, s25, 3072
  s_nop 0
  buffer_load_dwordx4 v19, s[12:15], s19 offen sc1 lds
  s_add_u32 m0, s25, 4096
  s_nop 0
  buffer_load_dwordx4 v20, s[12:15], s19 offen sc1 lds
  s_add_u32 m0, s25, 5120
  s_nop 0
  buffer_load_dwordx4 v21, s[12:15], s19 offen sc1 lds
  s_add_u32 m0, s25, 6144
  s_nop 0
  buffer_load_dwordx4 v22, s[12:15], s19 offen sc1 lds
  s_add_u32 m0, s25, 7168
  s_nop 0
  buffer_load_dwordx4 v23, s[12:15], s19 offen sc1 lds
  s_cmp_gt_u32 s23, 1
  s_cselect_b32 s26, s20, 0
  s_add_u32 s19, s19, s26
  s_add_u32 s25, s25, 32768
  s_and_b32 s25, s25, 0x1ffff
  s_add_u32 m0, s25, 0
  s_nop 0
  buffer_load_dwordx4 v16, s[12:15], s19 offen sc1 lds
  s_add_u32 m0, s25, 1024
  s_nop 0
  buffer_load_dwordx4 v17, s[12:15], s19 offen sc1 lds
  s_add_u32 m0, s25, 2048
  s_nop 0
  buffer_load_dwordx4 v18, s[12:15], s19 offen sc1 lds
  s_add_u32 m0, s25, 3072
  s_nop 0
  buffer_load_dwordx4 v19, s[12:15], s19 offen sc1 lds
  s_add_u32 m0, s25, 4096
  s_nop 0
  buffer_load_dwordx4 v20, s[12:15], s19 offen sc1 lds
  s_add_u32 m0, s25, 5120
  s_nop 0
  buffer_load_dwordx4 v21, s[12:15], s19 offen sc1 lds
  s_add_u32 m0, s25, 6144
  s_nop 0
  buffer_load_dwordx4 v22, s[12:15], s19 offen sc1 lds
  s_add_u32 m0, s25, 7168
  s_nop 0
  buffer_load_dwordx4 v23, s[12:15], s19 offen sc1 lds
  s_cmp_gt_u32 s23, 2
  s_cselect_b32 s26, s20, 0
  s_add_u32 s19, s19, s26
  s_add_u32 s25, s25, 32768
  s_and_b32 s25, s25, 0x1ffff
  s_waitcnt vmcnt(0)
  s_barrier
  s_mov_b32 s27, s21
  v_mov_b32 v7, 0x40000000
  ds_read_b128 v[24:27], v8 offset:0
  ds_read_b128 v[28:31], v9 offset:0
  ds_read_b128 v[32:35], v10 offset:0
  ds_read_b128 v[36:39], v11 offset:0
  ds_read_b128 v[40:43], v12 offset:0
  ds_read_b128 v[44:47], v13 offset:0
.p2align 6
G_top_45:
  s_waitcnt lgkmcnt(5)
  v_mfma_f32_32x32x16_bf16 v[64:79], a[0:3], v[24:27], 0
  s_add_u32 m0, s25, 0
  ds_read_b128 v[48:51], v14 offset:0
  v_mfma_f32_32x32x16_bf16 v[80:95], a[4:7], v[24:27], 0
  s_waitcnt lgkmcnt(5)
  buffer_load_dwordx4 v16, s[12:15], s19 offen sc1 lds
  v_mfma_f32_32x32x16_bf16 v[64:79], a[8:11], v[28:31], v[64:79]
  ds_read_b128 v[52:55], v15 offset:0
  v_mul_f32 v96, s24, v96
  v_mul_f32 v97, s24, v97
  v_mfma_f32_32x32x16_bf16 v[80:95], a[12:15], v[28:31], v[80:95]
  s_waitcnt lgkmcnt(5)
  v_cvt_pk_bf16_f32 v128, v96, v97
  v_mul_f32 v98, s24, v98
  v_mfma_f32_32x32x16_bf16 v[64:79], a[16:19], v[32:35], v[64:79]
  s_add_u32 m0, s25, 1024
  ds_read_b128 v[24:27], v8 offset:8192
  v_mul_f32 v99, s24, v99
  v_cvt_pk_bf16_f32 v129, v98, v99
  v_mfma_f32_32x32x16_bf16 v[80:95], a[20:23], v[32:35], v[80:95]
  s_waitcnt lgkmcnt(5)
  buffer_load_dwordx4 v17, s[12:15], s19 offen sc1 lds
  v_mul_f32 v100, s24, v100
  v_mul_f32 v101, s24, v101
  v_mfma_f32_32x32x16_bf16 v[64:79], a[24:27], v[36:39], v[64:79]
  ds_read_b128 v[28:31], v9 offset:8192
  v_cvt_pk_bf16_f32 v130, v100, v101
  v_mul_f32 v102, s24, v102
  v_mfma_f32_32x32x16_bf16 v[80:95], a[28:31], v[36:39], v[80:95]
  s_waitcnt lgkmcnt(5)
  v_mul_f32 v103, s24, v103
  v_cvt_pk_bf16_f32 v131, v102, v103
  v_mfma_f32_32x32x16_bf16 v[64:79], a[32:35], v[40:43], v[64:79]
  s_add_u32 m0, s25, 2048
  ds_read_b128 v[32:35], v10 offset:8192
  v_mul_f32 v104, s24, v104
  v_mul_f32 v105, s24, v105
  v_mfma_f32_32x32x16_bf16 v[80:95], a[36:39], v[40:43], v[80:95]
  s_waitcnt lgkmcnt(5)
  buffer_load_dwordx4 v18, s[12:15], s19 offen sc1 lds
  v_cvt_pk_bf16_f32 v132, v104, v105
  v_mul_f32 v106, s24, v106
  v_mfma_f32_32x32x16_bf16 v[64:79], a[40:43], v[44:47], v[64:79]
  ds_read_b128 v[36:39], v11 offset:8192
  v_mul_f32 v107, s24, v107
  v_cvt_pk_bf16_f32 v133, v106, v107
  v_mfma_f32_32x32x16_bf16 v[80:95], a[44:47], v[44:47], v[80:95]
  s_waitcnt lgkmcnt(5)
  v_mul_f32 v108, s24, v108
  v_mul_f32 v109, s24, v109
  v_mfma_f32_32x32x16_bf16 v[64:79], a[48:51], v[48:51], v[64:79]
  s_add_u32 m0, s25, 3072
  ds_read_b128 v[40:43], v12 offset:8192
  v_cvt_pk_bf16_f32 v134, v108, v109
  v_mul_f32 v110, s24, v110
  v_mfma_f32_32x32x16_bf16 v[80:95], a[52:55], v[48:51], v[80:95]
  s_waitcnt lgkmcnt(5)
  buffer_load_dwordx4 v19, s[12:15], s19 offen sc1 lds
  v_mul_f32 v111, s24, v111
  v_cvt_pk_bf16_f32 v135, v110, v111
  v_mfma_f32_32x32x16_bf16 v[64:79], a[56:59], v[52:55], v[64:79]
  ds_read_b128 v[44:47], v13 offset:8192
  v_mul_f32 v112, s24, v112
  v_mul_f32 v113, s24, v113
  v_mfma_f32_32x32x16_bf16 v[80:95], a[60:63], v[52:55], v[80:95]
  s_waitcnt lgkmcnt(5)
  v_cvt_pk_bf16_f32 v136, v112, v113
  v_mul_f32 v114, s24, v114
  v_mfma_f32_32x32x16_bf16 v[64:79], a[64:67], v[24:27], v[64:79]
  s_add_u32 m0, s25, 4096
  ds_read_b128 v[48:51], v14 offset:8192
  v_mul_f32 v115, s24, v115
  v_cvt_pk_bf16_f32 v137, v114, v115
  v_mfma_f32_32x32x16_bf16 v[80:95], a[68:71], v[24:27], v[80:95]
  s_waitcnt lgkmcnt(5)
  buffer_load_dwordx4 v20, s[12:15], s19 offen sc1 lds
  v_mul_f32 v116, s24, v116
  v_mul_f32 v117, s24, v117
  v_mfma_f32_32x32x16_bf16 v[64:79], a[72:75], v[28:31], v[64:79]
  ds_read_b128 v[52:55], v15 offset:8192
  v_cvt_pk_bf16_f32 v138, v116, v117
  v_mul_f32 v118, s24, v118
  v_mfma_f32_32x32x16_bf16 v[80:95], a[76:79], v[28:31], v[80:95]
  s_waitcnt lgkmcnt(5)
  v_mul_f32 v119, s24, v119
  v_cvt_pk_bf16_f32 v139, v118, v119
  v_mfma_f32_32x32x16_bf16 v[64:79], a[80:83], v[32:35], v[64:79]
  s_add_u32 m0, s25, 5120
  ds_read_b128 v[24:27], v8 offset:16384
  v_mul_f32 v120, s24, v120
  v_mul_f32 v121, s24, v121
  v_mfma_f32_32x32x16_bf16 v[80:95], a[84:87], v[32:35], v[80:95]
  s_waitcnt lgkmcnt(5)
  buffer_load_dwordx4 v21, s[12:15], s19 offen sc1 lds
  v_cvt_pk_bf16_f32 v140, v120, v121
  v_mul_f32 v122, s24, v122
  v_mfma_f32_32x32x16_bf16 v[64:79], a[88:91], v[36:39], v[64:79]
  ds_read_b128 v[28:31], v9 offset:16384
  v_mul_f32 v123, s24, v123
  v_cvt_pk_bf16_f32 v141, v122, v123
  v_mfma_f32_32x32x16_bf16 v[80:95], a[92:95], v[36:39], v[80:95]
  s_waitcnt lgkmcnt(5)
  v_mul_f32 v124, s24, v124
  v_mul_f32 v125, s24, v125
  v_mfma_f32_32x32x16_bf16 v[64:79], a[96:99], v[40:43], v[64:79]
  s_add_u32 m0, s25, 6144
  ds_read_b128 v[32:35], v10 offset:16384
  v_cvt_pk_bf16_f32 v142, v124, v125
  v_mul_f32 v126, s24, v126
  v_mfma_f32_32x32x16_bf16 v[80:95], a[100:103], v[40:43], v[80:95]
  s_waitcnt lgkmcnt(5)
  buffer_load_dwordx4 v22, s[12:15], s19 offen sc1 lds
  v_mul_f32 v127, s24, v127
  v_cvt_pk_bf16_f32 v143, v126, v127
  v_mfma_f32_32x32x16_bf16 v[64:79], a[104:107], v[44:47], v[64:79]
  ds_read_b128 v[36:39], v11 offset:16384
  v_mfma_f32_32x32x16_bf16 v[80:95], a[108:111], v[44:47], v[80:95]
  s_waitcnt lgkmcnt(5)
  v_mfma_f32_32x32x16_bf16 v[64:79], a[112:115], v[48:51], v[64:79]
  s_add_u32 m0, s25, 7168
  ds_read_b128 v[40:43], v12 offset:16384
  v_mfma_f32_32x32x16_bf16 v[80:95], a[116:119], v[48:51], v[80:95]
  s_waitcnt lgkmcnt(5)
  buffer_load_dwordx4 v23, s[12:15], s19 offen sc1 lds
  v_mfma_f32_32x32x16_bf16 v[64:79], a[120:123], v[52:55], v[64:79]
  s_cmp_gt_u32 s23, 3
  ds_read_b128 v[44:47], v13 offset:16384
  v_mfma_f32_32x32x16_bf16 v[80:95], a[124:127], v[52:55], v[80:95]
  s_waitcnt lgkmcnt(5)
  s_cselect_b32 s26, s20, 0
  v_mfma_f32_32x32x16_bf16 v[64:79], a[128:131], v[24:27], v[64:79]
  s_add_u32 s19, s19, s26
  ds_read_b128 v[48:51], v14 offset:16384
  v_mfma_f32_32x32x16_bf16 v[80:95], a[132:135], v[24:27], v[80:95]
  s_waitcnt lgkmcnt(5)
  s_add_u32 s25, s25, 32768
  v_mfma_f32_32x32x16_bf16 v[64:79], a[136:139], v[28:31], v[64:79]
  s_and_b32 s25, s25, 0x1ffff
  ds_read_b128 v[52:55], v15 offset:16384
  v_mfma_f32_32x32x16_bf16 v[80:95], a[140:143], v[28:31], v[80:95]
  s_waitcnt lgkmcnt(5)
  buffer_store_dwordx4 v[128:131], v7, s[4:7], s21 offen offset:0 sc1
  v_mfma_f32_32x32x16_bf16 v[64:79], a[144:147], v[32:35], v[64:79]
  ds_read_b128 v[24:27], v8 offset:24576
  v_mfma_f32_32x32x16_bf16 v[80:95], a[148:151], v[32:35], v[80:95]
  s_waitcnt lgkmcnt(5)
  v_mfma_f32_32x32x16_bf16 v[64:79], a[152:155], v[36:39], v[64:79]
  ds_read_b128 v[28:31], v9 offset:24576
  v_mfma_f32_32x32x16_bf16 v[80:95], a[156:159], v[36:39], v[80:95]
  s_waitcnt lgkmcnt(5)
  buffer_store_dwordx4 v[132:135], v7, s[4:7], s21 offen offset:1024 sc1
  v_mfma_f32_32x32x16_bf16 v[64:79], a[160:163], v[40:43], v[64:79]
  ds_read_b128 v[32:35], v10 offset:24576
  v_mfma_f32_32x32x16_bf16 v[80:95], a[164:167], v[40:43], v[80:95]
  s_waitcnt lgkmcnt(5)
  v_mfma_f32_32x32x16_bf16 v[64:79], a[168:171], v[44:47], v[64:79]
  ds_read_b128 v[36:39], v11 offset:24576
  v_mfma_f32_32x32x16_bf16 v[80:95], a[172:175], v[44:47], v[80:95]
  s_waitcnt lgkmcnt(5)
  buffer_store_dwordx4 v[136:139], v7, s[4:7], s21 offen offset:2048 sc1
  v_mfma_f32_32x32x16_bf16 v[64:79], a[176:179], v[48:51], v[64:79]
  ds_read_b128 v[40:43], v12 offset:24576
  v_mfma_f32_32x32x16_bf16 v[80:95], a[180:183], v[48:51], v[80:95]
  s_waitcnt lgkmcnt(5)
  v_mfma_f32_32x32x16_bf16 v[64:79], a[184:187], v[52:55], v[64:79]
  ds_read_b128 v[44:47], v13 offset:24576
  v_mfma_f32_32x32x16_bf16 v[80:95], a[188:191], v[52:55], v[80:95]
  s_waitcnt lgkmcnt(5)
  buffer_store_dwordx4 v[140:143], v7, s[4:7], s21 offen offset:3072 sc1
  v_mfma_f32_32x32x16_bf16 v[64:79], a[192:195], v[24:27], v[64:79]
  s_mov_b32 s21, s27
  ds_read_b128 v[48:51], v14 offset:24576
  v_mov_b32 v7, v2
  v_mfma_f32_32x32x16_bf16 v[80:95], a[196:199], v[24:27], v[80:95]
  s_waitcnt lgkmcnt(5)
  v_mfma_f32_32x32x16_bf16 v[64:79], a[200:203], v[28:31], v[64:79]
  s_add_u32 s27, s27, s22
  ds_read_b128 v[52:55], v15 offset:24576
  v_mfma_f32_32x32x16_bf16 v[80:95], a[204:207], v[28:31], v[80:95]
  s_waitcnt lgkmcnt(5)
  s_waitcnt vmcnt(16)
  s_barrier
  v_mfma_f32_32x32x16_bf16 v[64:79], a[208:211], v[32:35], v[64:79]
  ds_read_b128 v[24:27], v8 offset:32768
  v_mfma_f32_32x32x16_bf16 v[80:95], a[212:215], v[32:35], v[80:95]
  s_waitcnt lgkmcnt(5)
  v_mfma_f32_32x32x16_bf16 v[64:79], a[216:219], v[36:39], v[64:79]
  ds_read_b128 v[28:31], v9 offset:32768
  v_mfma_f32_32x32x16_bf16 v[80:95], a[220:223], v[36:39], v[80:95]
  s_waitcnt lgkmcnt(5)
  v_mfma_f32_32x32x16_bf16 v[64:79], a[224:227], v[40:43], v[64:79]
  ds_read_b128 v[32:35], v10 offset:32768
  v_mfma_f32_32x32x16_bf16 v[80:95], a[228:231], v[40:43], v[80:95]
  s_waitcnt lgkmcnt(5)
  v_mfma_f32_32x32x16_bf16 v[64:79], a[232:235], v[44:47], v[64:79]
  ds_read_b128 v[36:39], v11 offset:32768
  v_mfma_f32_32x32x16_bf16 v[80:95], a[236:239], v[44:47], v[80:95]
  s_waitcnt lgkmcnt(5)
  v_mfma_f32_32x32x16_bf16 v[64:79], a[240:243], v[48:51], v[64:79]
  s_sub_u32 s23, s23, 1
  ds_read_b128 v[40:43], v12 offset:32768
  v_mfma_f32_32x32x16_bf16 v[80:95], a[244:247], v[48:51], v[80:95]
  s_waitcnt lgkmcnt(5)
  v_mfma_f32_32x32x16_bf16 v[64:79], a[248:251], v[52:55], v[64:79]
  s_cmp_eq_u32 s23, 0
  ds_read_b128 v[44:47], v13 offset:32768
  v_mfma_f32_32x32x16_bf16 v[80:95], a[252:255], v[52:55], v[80:95]
  s_cbranch_scc1 G_done0_46
  s_waitcnt lgkmcnt(5)
  v_mfma_f32_32x32x16_bf16 v[96:111], a[0:3], v[24:27], 0
  s_add_u32 m0, s25, 0
  ds_read_b128 v[48:51], v14 offset:32768
  v_mfma_f32_32x32x16_bf16 v[112:127], a[4:7], v[24:27], 0
  s_waitcnt lgkmcnt(5)
  buffer_load_dwordx4 v16, s[12:15], s19 offen sc1 lds
  v_mfma_f32_32x32x16_bf16 v[96:111], a[8:11], v[28:31], v[96:111]
  ds_read_b128 v[52:55], v15 offset:32768
  v_mul_f32 v64, s24, v64
  v_mul_f32 v65, s24, v65
  v_mfma_f32_32x32x16_bf16 v[112:127], a[12:15], v[28:31], v[112:127]
  s_waitcnt lgkmcnt(5)
  v_cvt_pk_bf16_f32 v128, v64, v65
  v_mul_f32 v66, s24, v66
  v_mfma_f32_32x32x16_bf16 v[96:111], a[16:19], v[32:35], v[96:111]
  s_add_u32 m0, s25, 1024
  ds_read_b128 v[24:27], v8 offset:40960
  v_mul_f32 v67, s24, v67
  v_cvt_pk_bf16_f32 v129, v66, v67
  v_mfma_f32_32x32x16_bf16 v[112:127], a[20:23], v[32:35], v[112:127]
  s_waitcnt lgkmcnt(5)
  buffer_load_dwordx4 v17, s[12:15], s19 offen sc1 lds
  v_mul_f32 v68, s24, v68
  v_mul_f32 v69, s24, v69
  v_mfma_f32_32x32x16_bf16 v[96:111], a[24:27], v[36:39], v[96:111]
  ds_read_b128 v[28:31], v9 offset:40960
  v_cvt_pk_bf16_f32 v130, v68, v69
  v_mul_f32 v70, s24, v70
  v_mfma_f32_32x32x16_bf16 v[112:127], a[28:31], v[36:39], v[112:127]
  s_waitcnt lgkmcnt(5)
  v_mul_f32 v71, s24, v71
  v_cvt_pk_bf16_f32 v131, v70, v71
  v_mfma_f32_32x32x16_bf16 v[96:111], a[32:35], v[40:43], v[96:111]
  s_add_u32 m0, s25, 2048
  ds_read_b128 v[32:35], v10 offset:40960
  v_mul_f32 v72, s24, v72
  v_mul_f32 v73, s24, v73
  v_mfma_f32_32x32x16_bf16 v[112:127], a[36:39], v[40:43], v[112:127]
  s_waitcnt lgkmcnt(5)
  buffer_load_dwordx4 v18, s[12:15], s19 offen sc1 lds
  v_cvt_pk_bf16_f32 v132, v72, v73
  v_mul_f32 v74, s24, v74
  v_mfma_f32_32x32x16_bf16 v[96:111], a[40:43], v[44:47], v[96:111]
  ds_read_b128 v[36:39], v11 offset:40960
  v_mul_f32 v75, s24, v75
  v_cvt_pk_bf16_f32 v133, v74, v75
  v_mfma_f32_32x32x16_bf16 v[112:127], a[44:47], v[44:47], v[112:127]
  s_waitcnt lgkmcnt(5)
  v_mul_f32 v76, s24, v76
  v_mul_f32 v77, s24, v77
  v_mfma_f32_32x32x16_bf16 v[96:111], a[48:51], v[48:51], v[96:111]
  s_add_u32 m0, s25, 3072
  ds_read_b128 v[40:43], v12 offset:40960
  v_cvt_pk_bf16_f32 v134, v76, v77
  v_mul_f32 v78, s24, v78
  v_mfma_f32_32x32x16_bf16 v[112:127], a[52:55], v[48:51], v[112:127]
  s_waitcnt lgkmcnt(5)
  buffer_load_dwordx4 v19, s[12:15], s19 offen sc1 lds
  v_mul_f32 v79, s24, v79
  v_cvt_pk_bf16_f32 v135, v78, v79
  v_mfma_f32_32x32x16_bf16 v[96:111], a[56:59], v[52:55], v[96:111]
  ds_read_b128 v[44:47], v13 offset:40960
  v_mul_f32 v80, s24, v80
  v_mul_f32 v81, s24, v81
  v_mfma_f32_32x32x16_bf16 v[112:127], a[60:63], v[52:55], v[112:127]
  s_waitcnt lgkmcnt(5)
  v_cvt_pk_bf16_f32 v136, v80, v81
  v_mul_f32 v82, s24, v82
  v_mfma_f32_32x32x16_bf16 v[96:111], a[64:67], v[24:27], v[96:111]
  s_add_u32 m0, s25, 4096
  ds_read_b128 v[48:51], v14 offset:40960
  v_mul_f32 v83, s24, v83
  v_cvt_pk_bf16_f32 v137, v82, v83
  v_mfma_f32_32x32x16_bf16 v[112:127], a[68:71], v[24:27], v[112:127]
  s_waitcnt lgkmcnt(5)
  buffer_load_dwordx4 v20, s[12:15], s19 offen sc1 lds
  v_mul_f32 v84, s24, v84
  v_mul_f32 v85, s24, v85
  v_mfma_f32_32x32x16_bf16 v[96:111], a[72:75], v[28:31], v[96:111]
  ds_read_b128 v[52:55], v15 offset:40960
  v_cvt_pk_bf16_f32 v138, v84, v85
  v_mul_f32 v86, s24, v86
  v_mfma_f32_32x32x16_bf16 v[112:127], a[76:79], v[28:31], v[112:127]
  s_waitcnt lgkmcnt(5)
  v_mul_f32 v87, s24, v87
  v_cvt_pk_bf16_f32 v139, v86, v87
  v_mfma_f32_32x32x16_bf16 v[96:111], a[80:83], v[32:35], v[96:111]
  s_add_u32 m0, s25, 5120
  ds_read_b128 v[24:27], v8 offset:49152
  v_mul_f32 v88, s24, v88
  v_mul_f32 v89, s24, v89
  v_mfma_f32_32x32x16_bf16 v[112:127], a[84:87], v[32:35], v[112:127]
  s_waitcnt lgkmcnt(5)
  buffer_load_dwordx4 v21, s[12:15], s19 offen sc1 lds
  v_cvt_pk_bf16_f32 v140, v88, v89
  v_mul_f32 v90, s24, v90
  v_mfma_f32_32x32x16_bf16 v[96:111], a[88:91], v[36:39], v[96:111]
  ds_read_b128 v[28:31], v9 offset:49152
  v_mul_f32 v91, s24, v91
  v_cvt_pk_bf16_f32 v141, v90, v91
  v_mfma_f32_32x32x16_bf16 v[112:127], a[92:95], v[36:39], v[112:127]
  s_waitcnt lgkmcnt(5)
  v_mul_f32 v92, s24, v92
  v_mul_f32 v93, s24, v93
  v_mfma_f32_32x32x16_bf16 v[96:111], a[96:99], v[40:43], v[96:111]
  s_add_u32 m0, s25, 6144
  ds_read_b128 v[32:35], v10 offset:49152
  v_cvt_pk_bf16_f32 v142, v92, v93
  v_mul_f32 v94, s24, v94
  v_mfma_f32_32x32x16_bf16 v[112:127], a[100:103], v[40:43], v[112:127]
  s_waitcnt lgkmcnt(5)
  buffer_load_dwordx4 v22, s[12:15], s19 offen sc1 lds
  v_mul_f32 v95, s24, v95
  v_cvt_pk_bf16_f32 v143, v94, v95
  v_mfma_f32_32x32x16_bf16 v[96:111], a[104:107], v[44:47], v[96:111]
  ds_read_b128 v[36:39], v11 offset:49152
  v_mfma_f32_32x32x16_bf16 v[112:127], a[108:111], v[44:47], v[112:127]
  s_waitcnt lgkmcnt(5)
  v_mfma_f32_32x32x16_bf16 v[96:111], a[112:115], v[48:51], v[96:111]
  s_add_u32 m0, s25, 7168
  ds_read_b128 v[40:43], v12 offset:49152
  v_mfma_f32_32x32x16_bf16 v[112:127], a[116:119], v[48:51], v[112:127]
  s_waitcnt lgkmcnt(5)
  buffer_load_dwordx4 v23, s[12:15], s19 offen sc1 lds
  v_mfma_f32_32x32x16_bf16 v[96:111], a[120:123], v[52:55], v[96:111]
  s_cmp_gt_u32 s23, 3
  ds_read_b128 v[44:47], v13 offset:49152
  v_mfma_f32_32x32x16_bf16 v[112:127], a[124:127], v[52:55], v[112:127]
  s_waitcnt lgkmcnt(5)
  s_cselect_b32 s26, s20, 0
  v_mfma_f32_32x32x16_bf16 v[96:111], a[128:131], v[24:27], v[96:111]
  s_add_u32 s19, s19, s26
  ds_read_b128 v[48:51], v14 offset:49152
  v_mfma_f32_32x32x16_bf16 v[112:127], a[132:135], v[24:27], v[112:127]
  s_waitcnt lgkmcnt(5)
  s_add_u32 s25, s25, 32768
  v_mfma_f32_32x32x16_bf16 v[96:111], a[136:139], v[28:31], v[96:111]
  s_and_b32 s25, s25, 0x1ffff
  ds_read_b128 v[52:55], v15 offset:49152
  v_mfma_f32_32x32x16_bf16 v[112:127], a[140:143], v[28:31], v[112:127]
  s_waitcnt lgkmcnt(5)
  buffer_store_dwordx4 v[128:131], v7, s[4:7], s21 offen offset:0 sc1
  v_mfma_f32_32x32x16_bf16 v[96:111], a[144:147], v[32:35], v[96:111]
  ds_read_b128 v[24:27], v8 offset:57344
  v_mfma_f32_32x32x16_bf16 v[112:127], a[148:151], v[32:35], v[112:127]
  s_waitcnt lgkmcnt(5)
  v_xor_b32 v8, 0x10000, v8
  v_mfma_f32_32x32x16_bf16 v[96:111], a[152:155], v[36:39], v[96:111]
  ds_read_b128 v[28:31], v9 offset:57344
  v_mfma_f32_32x32x16_bf16 v[112:127], a[156:159], v[36:39], v[112:127]
  s_waitcnt lgkmcnt(5)
  buffer_store_dwordx4 v[132:135], v7, s[4:7], s21 offen offset:1024 sc1
  v_xor_b32 v9, 0x10000, v9
  v_mfma_f32_32x32x16_bf16 v[96:111], a[160:163], v[40:43], v[96:111]
  ds_read_b128 v[32:35], v10 offset:57344
  v_mfma_f32_32x32x16_bf16 v[112:127], a[164:167], v[40:43], v[112:127]
  s_waitcnt lgkmcnt(5)
  v_xor_b32 v10, 0x10000, v10
  v_mfma_f32_32x32x16_bf16 v[96:111], a[168:171], v[44:47], v[96:111]
  ds_read_b128 v[36:39], v11 offset:57344
  v_mfma_f32_32x32x16_bf16 v[112:127], a[172:175], v[44:47], v[112:127]
  s_waitcnt lgkmcnt(5)
  buffer_store_dwordx4 v[136:139], v7, s[4:7], s21 offen offset:2048 sc1
  v_xor_b32 v11, 0x10000, v11
  v_mfma_f32_32x32x16_bf16 v[96:111], a[176:179], v[48:51], v[96:111]
  ds_read_b128 v[40:43], v12 offset:57344
  v_mfma_f32_32x32x16_bf16 v[112:127], a[180:183], v[48:51], v[112:127]
  s_waitcnt lgkmcnt(5)
  v_xor_b32 v12, 0x10000, v12
  v_mfma_f32_32x32x16_bf16 v[96:111], a[184:187], v[52:55], v[96:111]
  ds_read_b128 v[44:47], v13 offset:57344
  v_mfma_f32_32x32x16_bf16 v[112:127], a[188:191], v[52:55], v[112:127]
  s_waitcnt lgkmcnt(5)
  buffer_store_dwordx4 v[140:143], v7, s[4:7], s21 offen offset:3072 sc1
  v_xor_b32 v13, 0x10000, v13
  v_mfma_f32_32x32x16_bf16 v[96:111], a[192:195], v[24:27], v[96:111]
  s_mov_b32 s21, s27
  ds_read_b128 v[48:51], v14 offset:57344
  v_mov_b32 v7, v2
  v_mfma_f32_32x32x16_bf16 v[112:127], a[196:199], v[24:27], v[112:127]
  s_waitcnt lgkmcnt(5)
  v_xor_b32 v14, 0x10000, v14
  v_mfma_f32_32x32x16_bf16 v[96:111], a[200:203], v[28:31], v[96:111]
  s_add_u32 s27, s27, s22
  ds_read_b128 v[52:55], v15 offset:57344
  v_mfma_f32_32x32x16_bf16 v[112:127], a[204:207], v[28:31], v[112:127]
  s_waitcnt lgkmcnt(5)
  s_waitcnt vmcnt(16)
  s_barrier
  v_xor_b32 v15, 0x10000, v15
  v_mfma_f32_32x32x16_bf16 v[96:111], a[208:211], v[32:35], v[96:111]
  ds_read_b128 v[24:27], v8 offset:0
  v_mfma_f32_32x32x16_bf16 v[112:127], a[212:215], v[32:35], v[112:127]
  s_waitcnt lgkmcnt(5)
  v_mfma_f32_32x32x16_bf16 v[96:111], a[216:219], v[36:39], v[96:111]
  ds_read_b128 v[28:31], v9 offset:0
  v_mfma_f32_32x32x16_bf16 v[112:127], a[220:223], v[36:39], v[112:127]
  s_waitcnt lgkmcnt(5)
  v_mfma_f32_32x32x16_bf16 v[96:111], a[224:227], v[40:43], v[96:111]
  ds_read_b128 v[32:35], v10 offset:0
  v_mfma_f32_32x32x16_bf16 v[112:127], a[228:231], v[40:43], v[112:127]
  s_waitcnt lgkmcnt(5)
  v_mfma_f32_32x32x16_bf16 v[96:111], a[232:235], v[44:47], v[96:111]
  ds_read_b128 v[36:39], v11 offset:0
  v_mfma_f32_32x32x16_bf16 v[112:127], a[236:239], v[44:47], v[112:127]
  s_waitcnt lgkmcnt(5)
  v_mfma_f32_32x32x16_bf16 v[96:111], a[240:243], v[48:51], v[96:111]
  s_sub_u32 s23, s23, 1
  ds_read_b128 v[40:43], v12 offset:0
  v_mfma_f32_32x32x16_bf16 v[112:127], a[244:247], v[48:51], v[112:127]
  s_waitcnt lgkmcnt(5)
  v_mfma_f32_32x32x16_bf16 v[96:111], a[248:251], v[52:55], v[96:111]
  s_cmp_eq_u32 s23, 0
  ds_read_b128 v[44:47], v13 offset:0
  v_mfma_f32_32x32x16_bf16 v[112:127], a[252:255], v[52:55], v[112:127]
  s_cbranch_scc1 G_done1_47
  s_branch G_top_45
G_done0_46:
  s_nop 7
  s_nop 3
  v_mul_f32 v64, s24, v64
  v_mul_f32 v65, s24, v65
  v_cvt_pk_bf16_f32 v128, v64, v65
  v_mul_f32 v66, s24, v66
  v_mul_f32 v67, s24, v67
  v_cvt_pk_bf16_f32 v129, v66, v67
  v_mul_f32 v68, s24, v68
  v_mul_f32 v69, s24, v69
  v_cvt_pk_bf16_f32 v130, v68, v69
  v_mul_f32 v70, s24, v70
  v_mul_f32 v71, s24, v71
  v_cvt_pk_bf16_f32 v131, v70, v71
  buffer_store_dwordx4 v[128:131], v7, s[4:7], s21 offen offset:0 sc1
  v_mul_f32 v72, s24, v72
  v_mul_f32 v73, s24, v73
  v_cvt_pk_bf16_f32 v132, v72, v73
  v_mul_f32 v74, s24, v74
  v_mul_f32 v75, s24, v75
  v_cvt_pk_bf16_f32 v133, v74, v75
  v_mul_f32 v76, s24, v76
  v_mul_f32 v77, s24, v77
  v_cvt_pk_bf16_f32 v134, v76, v77
  v_mul_f32 v78, s24, v78
  v_mul_f32 v79, s24, v79
  v_cvt_pk_bf16_f32 v135, v78, v79
  buffer_store_dwordx4 v[132:135], v7, s[4:7], s21 offen offset:1024 sc1
  v_mul_f32 v80, s24, v80
  v_mul_f32 v81, s24, v81
  v_cvt_pk_bf16_f32 v136, v80, v81
  v_mul_f32 v82, s24, v82
  v_mul_f32 v83, s24, v83
  v_cvt_pk_bf16_f32 v137, v82, v83
  v_mul_f32 v84, s24, v84
  v_mul_f32 v85, s24, v85
  v_cvt_pk_bf16_f32 v138, v84, v85
  v_mul_f32 v86, s24, v86
  v_mul_f32 v87, s24, v87
  v_cvt_pk_bf16_f32 v139, v86, v87
  buffer_store_dwordx4 v[136:139], v7, s[4:7], s21 offen offset:2048 sc1
  v_mul_f32 v88, s24, v88
  v_mul_f32 v89, s24, v89
  v_cvt_pk_bf16_f32 v140, v88, v89
  v_mul_f32 v90, s24, v90
  v_mul_f32 v91, s24, v91
  v_cvt_pk_bf16_f32 v141, v90, v91
  v_mul_f32 v92, s24, v92
  v_mul_f32 v93, s24, v93
  v_cvt_pk_bf16_f32 v142, v92, v93
  v_mul_f32 v94, s24, v94
  v_mul_f32 v95, s24, v95
  v_cvt_pk_bf16_f32 v143, v94, v95
  buffer_store_dwordx4 v[140:143], v7, s[4:7], s21 offen offset:3072 sc1
  s_branch G_fin_48
G_done1_47:
  s_nop 7
  s_nop 3
  v_mul_f32 v96, s24, v96
  v_mul_f32 v97, s24, v97
  v_cvt_pk_bf16_f32 v128, v96, v97
  v_mul_f32 v98, s24, v98
  v_mul_f32 v99, s24, v99
  v_cvt_pk_bf16_f32 v129, v98, v99
  v_mul_f32 v100, s24, v100
  v_mul_f32 v101, s24, v101
  v_cvt_pk_bf16_f32 v130, v100, v101
  v_mul_f32 v102, s24, v102
  v_mul_f32 v103, s24, v103
  v_cvt_pk_bf16_f32 v131, v102, v103
  buffer_store_dwordx4 v[128:131], v7, s[4:7], s21 offen offset:0 sc1
  v_mul_f32 v104, s24, v104
  v_mul_f32 v105, s24, v105
  v_cvt_pk_bf16_f32 v132, v104, v105
  v_mul_f32 v106, s24, v106
  v_mul_f32 v107, s24, v107
  v_cvt_pk_bf16_f32 v133, v106, v107
  v_mul_f32 v108, s24, v108
  v_mul_f32 v109, s24, v109
  v_cvt_pk_bf16_f32 v134, v108, v109
  v_mul_f32 v110, s24, v110
  v_mul_f32 v111, s24, v111
  v_cvt_pk_bf16_f32 v135, v110, v111
  buffer_store_dwordx4 v[132:135], v7, s[4:7], s21 offen offset:1024 sc1
  v_mul_f32 v112, s24, v112
  v_mul_f32 v113, s24, v113
  v_cvt_pk_bf16_f32 v136, v112, v113
  v_mul_f32 v114, s24, v114
  v_mul_f32 v115, s24, v115
  v_cvt_pk_bf16_f32 v137, v114, v115
  v_mul_f32 v116, s24, v116
  v_mul_f32 v117, s24, v117
  v_cvt_pk_bf16_f32 v138, v116, v117
  v_mul_f32 v118, s24, v118
  v_mul_f32 v119, s24, v119
  v_cvt_pk_bf16_f32 v139, v118, v119
  buffer_store_dwordx4 v[136:139], v7, s[4:7], s21 offen offset:2048 sc1
  v_mul_f32 v120, s24, v120
  v_mul_f32 v121, s24, v121
  v_cvt_pk_bf16_f32 v140, v120, v121
  v_mul_f32 v122, s24, v122
  v_mul_f32 v123, s24, v123
  v_cvt_pk_bf16_f32 v141, v122, v123
  v_mul_f32 v124, s24, v124
  v_mul_f32 v125, s24, v125
  v_cvt_pk_bf16_f32 v142, v124, v125
  v_mul_f32 v126, s24, v126
  v_mul_f32 v127, s24, v127
  v_cvt_pk_bf16_f32 v143, v126, v127
  buffer_store_dwordx4 v[140:143], v7, s[4:7], s21 offen offset:3072 sc1
G_fin_48:
  s_waitcnt vmcnt(0) lgkmcnt(0)
  s_barrier
  s_waitcnt vmcnt(0)
  s_barrier
  s_mov_b32 s30, 768
  v_mov_b32 v144, s30
  v_min_u32 v145, 1, v0
  v_lshlrev_b32 v145, 30, v145
  buffer_store_dword v144, v145, s[4:7], s31 offen sc1
  s_mul_i32 s50, s64, 6
  s_add_u32 s50, s50, s65
  s_mul_i32 s76, s50, 21846
  s_lshr_b32 s76, s76, 16
  s_mul_i32 s77, s76, 3
  s_add_u32 s51, s50, 64
  s_cmp_eq_u32 s77, s50
  s_cselect_b32 s50, s76, s51
M_fin:
  s_lshr_b32 s48, s50, 2
  s_and_b32 s49, s50, 3
  s_load_dwordx2 s[8:9], s[0:1], 0
  s_load_dwordx2 s[12:13], s[0:1], 104
  s_load_dwordx2 s[32:33], s[0:1], 112
  v_and_b32 v4, 31, v1
  v_lshrrev_b32 v5, 5, v1
  v_lshlrev_b32 v5, 4, v5
  v_lshl_add_u32 v6, v4, 10, v5
  s_lshl_b32 s26, s16, 8
  s_lshl_b32 s27, s48, 15
  s_add_u32 s27, s27, s26
  s_waitcnt lgkmcnt(0)
  s_and_b32 s9, s9, 0xffff
  s_mov_b32 s10, 2097152
  s_mov_b32 s11, 0x20000
  s_and_b32 s13, s13, 0xffff
  s_mov_b32 s14, 1024
  s_mov_b32 s15, 0x20000
  s_and_b32 s33, s33, 0xffff
  s_mov_b32 s34, 2097152
  s_mov_b32 s35, 0x20000
  buffer_load_dwordx4 v[16:19], v6, s[8:11], s27 offen offset:0
  buffer_load_dwordx4 v[48:51], v5, s[12:15], s26 offen offset:0
  buffer_load_dwordx4 v[20:23], v6, s[8:11], s27 offen offset:32
  buffer_load_dwordx4 v[52:55], v5, s[12:15], s26 offen offset:32
  buffer_load_dwordx4 v[24:27], v6, s[8:11], s27 offen offset:64
  buffer_load_dwordx4 v[56:59], v5, s[12:15], s26 offen offset:64
  buffer_load_dwordx4 v[28:31], v6, s[8:11], s27 offen offset:96
  buffer_load_dwordx4 v[60:63], v5, s[12:15], s26 offen offset:96
  buffer_load_dwordx4 v[32:35], v6, s[8:11], s27 offen offset:128
  buffer_load_dwordx4 v[64:67], v5, s[12:15], s26 offen offset:128
  buffer_load_dwordx4 v[36:39], v6, s[8:11], s27 offen offset:160
  buffer_load_dwordx4 v[68:71], v5, s[12:15], s26 offen offset:160
  buffer_load_dwordx4 v[40:43], v6, s[8:11], s27 offen offset:192
  buffer_load_dwordx4 v[72:75], v5, s[12:15], s26 offen offset:192
  buffer_load_dwordx4 v[44:47], v6, s[8:11], s27 offen offset:224
  buffer_load_dwordx4 v[76:79], v5, s[12:15], s26 offen offset:224
  s_lshl_b32 s28, s48, 2
  s_add_u32 s28, s28, s49
  s_lshl_b32 s28, s28, 2
  s_add_u32 s28, s28, s16
  s_lshl_b32 s28, s28, 11
  s_waitcnt vmcnt(14)
  v_mfma_f32_32x32x16_bf16 v[80:95], v[48:51], v[16:19], 0
  s_waitcnt vmcnt(12)
  v_mfma_f32_32x32x16_bf16 v[80:95], v[52:55], v[20:23], v[80:95]
  s_waitcnt vmcnt(10)
  v_mfma_f32_32x32x16_bf16 v[80:95], v[56:59], v[24:27], v[80:95]
  s_waitcnt vmcnt(8)
  v_mfma_f32_32x32x16_bf16 v[80:95], v[60:63], v[28:31], v[80:95]
  s_waitcnt vmcnt(6)
  v_mfma_f32_32x32x16_bf16 v[80:95], v[64:67], v[32:35], v[80:95]
  s_waitcnt vmcnt(4)
  v_mfma_f32_32x32x16_bf16 v[80:95], v[68:71], v[36:39], v[80:95]
  s_waitcnt vmcnt(2)
  v_mfma_f32_32x32x16_bf16 v[80:95], v[72:75], v[40:43], v[80:95]
  s_waitcnt vmcnt(0)
  v_mfma_f32_32x32x16_bf16 v[80:95], v[76:79], v[44:47], v[80:95]
  s_mul_i32 s76, s48, 43
  s_lshr_b32 s76, s76, 9
  s_mul_i32 s76, s76, 12
  s_sub_u32 s76, s48, s76
  s_cmp_ge_u32 s76, 6
  s_addc_u32 s76, s76, 0
  s_and_b32 s77, s49, 2
  s_mul_i32 s77, s77, 7
  s_add_u32 s76, s76, s77
  v_mov_b32 v193, 0x300
  s_lshl_b32 s76, s76, 7
  s_add_u32 s76, s76, 148897792
  v_and_b32 v192, 7, v1
  v_mul_u32_u24 v192, 3584, v192
  v_add_u32 v192, s76, v192
  s_mov_b32 s71, 0
  s_branch M_vg_50
M_vw_49:
  s_sleep 2
  s_add_u32 s71, s71, 1
  s_cmp_gt_u32 s71, 262144
  s_cbranch_scc1 M_exit
M_vg_50:
  buffer_load_dword v194, v192, s[4:7], 0 offen sc1
  s_waitcnt vmcnt(0)
  v_cmp_lt_u32 vcc, v194, v193
  s_cbranch_vccnz M_vw_49
  s_add_u32 s29, s28, 150994944
  buffer_load_dwordx4 v[96:99], v2, s[4:7], s29 offen offset:0 sc1
  buffer_load_dwordx4 v[100:103], v2, s[4:7], s29 offen offset:1024 sc1
  s_add_u32 s29, s28, 153092096
  buffer_load_dwordx4 v[104:107], v2, s[4:7], s29 offen offset:0 sc1
  buffer_load_dwordx4 v[108:111], v2, s[4:7], s29 offen offset:1024 sc1
  s_add_u32 s29, s28, 155189248
  buffer_load_dwordx4 v[112:115], v2, s[4:7], s29 offen offset:0 sc1
  buffer_load_dwordx4 v[116:119], v2, s[4:7], s29 offen offset:1024 sc1
  s_add_u32 s29, s28, 157286400
  buffer_load_dwordx4 v[120:123], v2, s[4:7], s29 offen offset:0 sc1
  buffer_load_dwordx4 v[124:127], v2, s[4:7], s29 offen offset:1024 sc1
  s_add_u32 s29, s28, 159383552
  buffer_load_dwordx4 v[128:131], v2, s[4:7], s29 offen offset:0 sc1
  buffer_load_dwordx4 v[132:135], v2, s[4:7], s29 offen offset:1024 sc1
  s_add_u32 s29, s28, 161480704
  buffer_load_dwordx4 v[136:139], v2, s[4:7], s29 offen offset:0 sc1
  buffer_load_dwordx4 v[140:143], v2, s[4:7], s29 offen offset:1024 sc1
  s_add_u32 s29, s28, 163577856
  buffer_load_dwordx4 v[144:147], v2, s[4:7], s29 offen offset:0 sc1
  buffer_load_dwordx4 v[148:151], v2, s[4:7], s29 offen offset:1024 sc1
  s_add_u32 s29, s28, 165675008
  buffer_load_dwordx4 v[152:155], v2, s[4:7], s29 offen offset:0 sc1
  buffer_load_dwordx4 v[156:159], v2, s[4:7], s29 offen offset:1024 sc1
  v_lshlrev_b32 v7, 4, v4
  s_lshl_b32 s26, s16, 2
  v_add_u32 v4, s26, v7
  s_barrier
  ds_write_b32 v4, v80
  s_waitcnt lgkmcnt(0)
  s_barrier
  ds_read_b128 v[84:87], v7
  s_waitcnt lgkmcnt(0)
  v_add_f32 v80, v84, v85
  v_add_f32 v81, v86, v87
  v_add_f32 v80, v80, v81
  v_mul_f32 v80, 0xbfb8aa3b, v80
  v_exp_f32 v80, v80
  s_nop 0
  v_add_f32 v80, 1.0, v80
  v_rcp_f32 v80, v80
  s_nop 0
  v_sub_f32 v82, 1.0, v80
  s_waitcnt vmcnt(14)
  v_lshlrev_b32 v160, 16, v96
  v_and_b32 v161, 0xffff0000, v96
  v_lshlrev_b32 v162, 16, v97
  v_and_b32 v163, 0xffff0000, v97
  v_lshlrev_b32 v164, 16, v98
  v_and_b32 v165, 0xffff0000, v98
  v_lshlrev_b32 v166, 16, v99
  v_and_b32 v167, 0xffff0000, v99
  v_lshlrev_b32 v168, 16, v100
  v_and_b32 v169, 0xffff0000, v100
  v_lshlrev_b32 v170, 16, v101
  v_and_b32 v171, 0xffff0000, v101
  v_lshlrev_b32 v172, 16, v102
  v_and_b32 v173, 0xffff0000, v102
  v_lshlrev_b32 v174, 16, v103
  v_and_b32 v175, 0xffff0000, v103
  s_waitcnt vmcnt(12)
  v_lshlrev_b32 v8, 16, v104
  v_and_b32 v9, 0xffff0000, v104
  v_pk_add_f32 v[160:161], v[160:161], v[8:9]
  v_lshlrev_b32 v10, 16, v105
  v_and_b32 v11, 0xffff0000, v105
  v_pk_add_f32 v[162:163], v[162:163], v[10:11]
  v_lshlrev_b32 v12, 16, v106
  v_and_b32 v13, 0xffff0000, v106
  v_pk_add_f32 v[164:165], v[164:165], v[12:13]
  v_lshlrev_b32 v14, 16, v107
  v_and_b32 v15, 0xffff0000, v107
  v_pk_add_f32 v[166:167], v[166:167], v[14:15]
  v_lshlrev_b32 v8, 16, v108
  v_and_b32 v9, 0xffff0000, v108
  v_pk_add_f32 v[168:169], v[168:169], v[8:9]
  v_lshlrev_b32 v10, 16, v109
  v_and_b32 v11, 0xffff0000, v109
  v_pk_add_f32 v[170:171], v[170:171], v[10:11]
  v_lshlrev_b32 v12, 16, v110
  v_and_b32 v13, 0xffff0000, v110
  v_pk_add_f32 v[172:173], v[172:173], v[12:13]
  v_lshlrev_b32 v14, 16, v111
  v_and_b32 v15, 0xffff0000, v111
  v_pk_add_f32 v[174:175], v[174:175], v[14:15]
  s_waitcnt vmcnt(10)
  v_lshlrev_b32 v8, 16, v112
  v_and_b32 v9, 0xffff0000, v112
  v_pk_add_f32 v[160:161], v[160:161], v[8:9]
  v_lshlrev_b32 v10, 16, v113
  v_and_b32 v11, 0xffff0000, v113
  v_pk_add_f32 v[162:163], v[162:163], v[10:11]
  v_lshlrev_b32 v12, 16, v114
  v_and_b32 v13, 0xffff0000, v114
  v_pk_add_f32 v[164:165], v[164:165], v[12:13]
  v_lshlrev_b32 v14, 16, v115
  v_and_b32 v15, 0xffff0000, v115
  v_pk_add_f32 v[166:167], v[166:167], v[14:15]
  v_lshlrev_b32 v8, 16, v116
  v_and_b32 v9, 0xffff0000, v116
  v_pk_add_f32 v[168:169], v[168:169], v[8:9]
  v_lshlrev_b32 v10, 16, v117
  v_and_b32 v11, 0xffff0000, v117
  v_pk_add_f32 v[170:171], v[170:171], v[10:11]
  v_lshlrev_b32 v12, 16, v118
  v_and_b32 v13, 0xffff0000, v118
  v_pk_add_f32 v[172:173], v[172:173], v[12:13]
  v_lshlrev_b32 v14, 16, v119
  v_and_b32 v15, 0xffff0000, v119
  v_pk_add_f32 v[174:175], v[174:175], v[14:15]
  s_waitcnt vmcnt(8)
  v_lshlrev_b32 v8, 16, v120
  v_and_b32 v9, 0xffff0000, v120
  v_pk_add_f32 v[160:161], v[160:161], v[8:9]
  v_lshlrev_b32 v10, 16, v121
  v_and_b32 v11, 0xffff0000, v121
  v_pk_add_f32 v[162:163], v[162:163], v[10:11]
  v_lshlrev_b32 v12, 16, v122
  v_and_b32 v13, 0xffff0000, v122
  v_pk_add_f32 v[164:165], v[164:165], v[12:13]
  v_lshlrev_b32 v14, 16, v123
  v_and_b32 v15, 0xffff0000, v123
  v_pk_add_f32 v[166:167], v[166:167], v[14:15]
  v_lshlrev_b32 v8, 16, v124
  v_and_b32 v9, 0xffff0000, v124
  v_pk_add_f32 v[168:169], v[168:169], v[8:9]
  v_lshlrev_b32 v10, 16, v125
  v_and_b32 v11, 0xffff0000, v125
  v_pk_add_f32 v[170:171], v[170:171], v[10:11]
  v_lshlrev_b32 v12, 16, v126
  v_and_b32 v13, 0xffff0000, v126
  v_pk_add_f32 v[172:173], v[172:173], v[12:13]
  v_lshlrev_b32 v14, 16, v127
  v_and_b32 v15, 0xffff0000, v127
  v_pk_add_f32 v[174:175], v[174:175], v[14:15]
  s_waitcnt vmcnt(6)
  v_lshlrev_b32 v8, 16, v128
  v_and_b32 v9, 0xffff0000, v128
  v_pk_add_f32 v[160:161], v[160:161], v[8:9]
  v_lshlrev_b32 v10, 16, v129
  v_and_b32 v11, 0xffff0000, v129
  v_pk_add_f32 v[162:163], v[162:163], v[10:11]
  v_lshlrev_b32 v12, 16, v130
  v_and_b32 v13, 0xffff0000, v130
  v_pk_add_f32 v[164:165], v[164:165], v[12:13]
  v_lshlrev_b32 v14, 16, v131
  v_and_b32 v15, 0xffff0000, v131
  v_pk_add_f32 v[166:167], v[166:167], v[14:15]
  v_lshlrev_b32 v8, 16, v132
  v_and_b32 v9, 0xffff0000, v132
  v_pk_add_f32 v[168:169], v[168:169], v[8:9]
  v_lshlrev_b32 v10, 16, v133
  v_and_b32 v11, 0xffff0000, v133
  v_pk_add_f32 v[170:171], v[170:171], v[10:11]
  v_lshlrev_b32 v12, 16, v134
  v_and_b32 v13, 0xffff0000, v134
  v_pk_add_f32 v[172:173], v[172:173], v[12:13]
  v_lshlrev_b32 v14, 16, v135
  v_and_b32 v15, 0xffff0000, v135
  v_pk_add_f32 v[174:175], v[174:175], v[14:15]
  s_waitcnt vmcnt(4)
  v_lshlrev_b32 v8, 16, v136
  v_and_b32 v9, 0xffff0000, v136
  v_pk_add_f32 v[160:161], v[160:161], v[8:9]
  v_lshlrev_b32 v10, 16, v137
  v_and_b32 v11, 0xffff0000, v137
  v_pk_add_f32 v[162:163], v[162:163], v[10:11]
  v_lshlrev_b32 v12, 16, v138
  v_and_b32 v13, 0xffff0000, v138
  v_pk_add_f32 v[164:165], v[164:165], v[12:13]
  v_lshlrev_b32 v14, 16, v139
  v_and_b32 v15, 0xffff0000, v139
  v_pk_add_f32 v[166:167], v[166:167], v[14:15]
  v_lshlrev_b32 v8, 16, v140
  v_and_b32 v9, 0xffff0000, v140
  v_pk_add_f32 v[168:169], v[168:169], v[8:9]
  v_lshlrev_b32 v10, 16, v141
  v_and_b32 v11, 0xffff0000, v141
  v_pk_add_f32 v[170:171], v[170:171], v[10:11]
  v_lshlrev_b32 v12, 16, v142
  v_and_b32 v13, 0xffff0000, v142
  v_pk_add_f32 v[172:173], v[172:173], v[12:13]
  v_lshlrev_b32 v14, 16, v143
  v_and_b32 v15, 0xffff0000, v143
  v_pk_add_f32 v[174:175], v[174:175], v[14:15]
  s_waitcnt vmcnt(2)
  v_lshlrev_b32 v8, 16, v144
  v_and_b32 v9, 0xffff0000, v144
  v_pk_add_f32 v[160:161], v[160:161], v[8:9]
  v_lshlrev_b32 v10, 16, v145
  v_and_b32 v11, 0xffff0000, v145
  v_pk_add_f32 v[162:163], v[162:163], v[10:11]
  v_lshlrev_b32 v12, 16, v146
  v_and_b32 v13, 0xffff0000, v146
  v_pk_add_f32 v[164:165], v[164:165], v[12:13]
  v_lshlrev_b32 v14, 16, v147
  v_and_b32 v15, 0xffff0000, v147
  v_pk_add_f32 v[166:167], v[166:167], v[14:15]
  v_lshlrev_b32 v8, 16, v148
  v_and_b32 v9, 0xffff0000, v148
  v_pk_add_f32 v[168:169], v[168:169], v[8:9]
  v_lshlrev_b32 v10, 16, v149
  v_and_b32 v11, 0xffff0000, v149
  v_pk_add_f32 v[170:171], v[170:171], v[10:11]
  v_lshlrev_b32 v12, 16, v150
  v_and_b32 v13, 0xffff0000, v150
  v_pk_add_f32 v[172:173], v[172:173], v[12:13]
  v_lshlrev_b32 v14, 16, v151
  v_and_b32 v15, 0xffff0000, v151
  v_pk_add_f32 v[174:175], v[174:175], v[14:15]
  s_waitcnt vmcnt(0)
  v_lshlrev_b32 v8, 16, v152
  v_and_b32 v9, 0xffff0000, v152
  v_pk_add_f32 v[160:161], v[160:161], v[8:9]
  v_lshlrev_b32 v10, 16, v153
  v_and_b32 v11, 0xffff0000, v153
  v_pk_add_f32 v[162:163], v[162:163], v[10:11]
  v_lshlrev_b32 v12, 16, v154
  v_and_b32 v13, 0xffff0000, v154
  v_pk_add_f32 v[164:165], v[164:165], v[12:13]
  v_lshlrev_b32 v14, 16, v155
  v_and_b32 v15, 0xffff0000, v155
  v_pk_add_f32 v[166:167], v[166:167], v[14:15]
  v_lshlrev_b32 v8, 16, v156
  v_and_b32 v9, 0xffff0000, v156
  v_pk_add_f32 v[168:169], v[168:169], v[8:9]
  v_lshlrev_b32 v10, 16, v157
  v_and_b32 v11, 0xffff0000, v157
  v_pk_add_f32 v[170:171], v[170:171], v[10:11]
  v_lshlrev_b32 v12, 16, v158
  v_and_b32 v13, 0xffff0000, v158
  v_pk_add_f32 v[172:173], v[172:173], v[12:13]
  v_lshlrev_b32 v14, 16, v159
  v_and_b32 v15, 0xffff0000, v159
  v_pk_add_f32 v[174:175], v[174:175], v[14:15]
  s_and_b32 s76, s48, 1
  s_lshl_b32 s76, s76, 1
  s_lshr_b32 s77, s49, 1
  s_add_u32 s76, s76, s77
  s_mul_i32 s76, s76, 7
  s_add_u32 s76, s76, 6
  s_lshr_b32 s77, s48, 1
  s_add_u32 s77, s77, 0x201
  v_mov_b32 v193, s77
  s_lshl_b32 s76, s76, 7
  s_add_u32 s76, s76, 148897792
  v_and_b32 v192, 7, v1
  v_mul_u32_u24 v192, 3584, v192
  v_add_u32 v192, s76, v192
  s_mov_b32 s71, 0
  s_branch M_vg_52
M_vw_51:
  s_sleep 2
  s_add_u32 s71, s71, 1
  s_cmp_gt_u32 s71, 262144
  s_cbranch_scc1 M_exit
M_vg_52:
  buffer_load_dword v194, v192, s[4:7], 0 offen sc1
  s_waitcnt vmcnt(0)
  v_cmp_lt_u32 vcc, v194, v193
  s_cbranch_vccnz M_vw_51
  s_add_u32 s29, s28, 167772160
  buffer_load_dwordx4 v[96:99], v2, s[4:7], s29 offen offset:0 sc1
  buffer_load_dwordx4 v[100:103], v2, s[4:7], s29 offen offset:1024 sc1
  s_add_u32 s29, s28, 169869312
  buffer_load_dwordx4 v[104:107], v2, s[4:7], s29 offen offset:0 sc1
  buffer_load_dwordx4 v[108:111], v2, s[4:7], s29 offen offset:1024 sc1
  s_add_u32 s29, s28, 171966464
  buffer_load_dwordx4 v[112:115], v2, s[4:7], s29 offen offset:0 sc1
  buffer_load_dwordx4 v[116:119], v2, s[4:7], s29 offen offset:1024 sc1
  s_add_u32 s29, s28, 174063616
  buffer_load_dwordx4 v[120:123], v2, s[4:7], s29 offen offset:0 sc1
  buffer_load_dwordx4 v[124:127], v2, s[4:7], s29 offen offset:1024 sc1
  s_add_u32 s29, s28, 176160768
  buffer_load_dwordx4 v[128:131], v2, s[4:7], s29 offen offset:0 sc1
  buffer_load_dwordx4 v[132:135], v2, s[4:7], s29 offen offset:1024 sc1
  s_add_u32 s29, s28, 178257920
  buffer_load_dwordx4 v[136:139], v2, s[4:7], s29 offen offset:0 sc1
  buffer_load_dwordx4 v[140:143], v2, s[4:7], s29 offen offset:1024 sc1
  s_add_u32 s29, s28, 180355072
  buffer_load_dwordx4 v[144:147], v2, s[4:7], s29 offen offset:0 sc1
  buffer_load_dwordx4 v[148:151], v2, s[4:7], s29 offen offset:1024 sc1
  s_add_u32 s29, s28, 182452224
  buffer_load_dwordx4 v[152:155], v2, s[4:7], s29 offen offset:0 sc1
  buffer_load_dwordx4 v[156:159], v2, s[4:7], s29 offen offset:1024 sc1
  v_pk_mul_f32 v[160:161], v[160:161], v[80:81] op_sel_hi:[1,0]
  v_pk_mul_f32 v[162:163], v[162:163], v[80:81] op_sel_hi:[1,0]
  v_pk_mul_f32 v[164:165], v[164:165], v[80:81] op_sel_hi:[1,0]
  v_pk_mul_f32 v[166:167], v[166:167], v[80:81] op_sel_hi:[1,0]
  v_pk_mul_f32 v[168:169], v[168:169], v[80:81] op_sel_hi:[1,0]
  v_pk_mul_f32 v[170:171], v[170:171], v[80:81] op_sel_hi:[1,0]
  v_pk_mul_f32 v[172:173], v[172:173], v[80:81] op_sel_hi:[1,0]
  v_pk_mul_f32 v[174:175], v[174:175], v[80:81] op_sel_hi:[1,0]
  s_waitcnt vmcnt(14)
  v_lshlrev_b32 v176, 16, v96
  v_and_b32 v177, 0xffff0000, v96
  v_lshlrev_b32 v178, 16, v97
  v_and_b32 v179, 0xffff0000, v97
  v_lshlrev_b32 v180, 16, v98
  v_and_b32 v181, 0xffff0000, v98
  v_lshlrev_b32 v182, 16, v99
  v_and_b32 v183, 0xffff0000, v99
  v_lshlrev_b32 v184, 16, v100
  v_and_b32 v185, 0xffff0000, v100
  v_lshlrev_b32 v186, 16, v101
  v_and_b32 v187, 0xffff0000, v101
  v_lshlrev_b32 v188, 16, v102
  v_and_b32 v189, 0xffff0000, v102
  v_lshlrev_b32 v190, 16, v103
  v_and_b32 v191, 0xffff0000, v103
  s_waitcnt vmcnt(12)
  v_lshlrev_b32 v8, 16, v104
  v_and_b32 v9, 0xffff0000, v104
  v_pk_add_f32 v[176:177], v[176:177], v[8:9]
  v_lshlrev_b32 v10, 16, v105
  v_and_b32 v11, 0xffff0000, v105
  v_pk_add_f32 v[178:179], v[178:179], v[10:11]
  v_lshlrev_b32 v12, 16, v106
  v_and_b32 v13, 0xffff0000, v106
  v_pk_add_f32 v[180:181], v[180:181], v[12:13]
  v_lshlrev_b32 v14, 16, v107
  v_and_b32 v15, 0xffff0000, v107
  v_pk_add_f32 v[182:183], v[182:183], v[14:15]
  v_lshlrev_b32 v8, 16, v108
  v_and_b32 v9, 0xffff0000, v108
  v_pk_add_f32 v[184:185], v[184:185], v[8:9]
  v_lshlrev_b32 v10, 16, v109
  v_and_b32 v11, 0xffff0000, v109
  v_pk_add_f32 v[186:187], v[186:187], v[10:11]
  v_lshlrev_b32 v12, 16, v110
  v_and_b32 v13, 0xffff0000, v110
  v_pk_add_f32 v[188:189], v[188:189], v[12:13]
  v_lshlrev_b32 v14, 16, v111
  v_and_b32 v15, 0xffff0000, v111
  v_pk_add_f32 v[190:191], v[190:191], v[14:15]
  s_waitcnt vmcnt(10)
  v_lshlrev_b32 v8, 16, v112
  v_and_b32 v9, 0xffff0000, v112
  v_pk_add_f32 v[176:177], v[176:177], v[8:9]
  v_lshlrev_b32 v10, 16, v113
  v_and_b32 v11, 0xffff0000, v113
  v_pk_add_f32 v[178:179], v[178:179], v[10:11]
  v_lshlrev_b32 v12, 16, v114
  v_and_b32 v13, 0xffff0000, v114
  v_pk_add_f32 v[180:181], v[180:181], v[12:13]
  v_lshlrev_b32 v14, 16, v115
  v_and_b32 v15, 0xffff0000, v115
  v_pk_add_f32 v[182:183], v[182:183], v[14:15]
  v_lshlrev_b32 v8, 16, v116
  v_and_b32 v9, 0xffff0000, v116
  v_pk_add_f32 v[184:185], v[184:185], v[8:9]
  v_lshlrev_b32 v10, 16, v117
  v_and_b32 v11, 0xffff0000, v117
  v_pk_add_f32 v[186:187], v[186:187], v[10:11]
  v_lshlrev_b32 v12, 16, v118
  v_and_b32 v13, 0xffff0000, v118
  v_pk_add_f32 v[188:189], v[188:189], v[12:13]
  v_lshlrev_b32 v14, 16, v119
  v_and_b32 v15, 0xffff0000, v119
  v_pk_add_f32 v[190:191], v[190:191], v[14:15]
  s_waitcnt vmcnt(8)
  v_lshlrev_b32 v8, 16, v120
  v_and_b32 v9, 0xffff0000, v120
  v_pk_add_f32 v[176:177], v[176:177], v[8:9]
  v_lshlrev_b32 v10, 16, v121
  v_and_b32 v11, 0xffff0000, v121
  v_pk_add_f32 v[178:179], v[178:179], v[10:11]
  v_lshlrev_b32 v12, 16, v122
  v_and_b32 v13, 0xffff0000, v122
  v_pk_add_f32 v[180:181], v[180:181], v[12:13]
  v_lshlrev_b32 v14, 16, v123
  v_and_b32 v15, 0xffff0000, v123
  v_pk_add_f32 v[182:183], v[182:183], v[14:15]
  v_lshlrev_b32 v8, 16, v124
  v_and_b32 v9, 0xffff0000, v124
  v_pk_add_f32 v[184:185], v[184:185], v[8:9]
  v_lshlrev_b32 v10, 16, v125
  v_and_b32 v11, 0xffff0000, v125
  v_pk_add_f32 v[186:187], v[186:187], v[10:11]
  v_lshlrev_b32 v12, 16, v126
  v_and_b32 v13, 0xffff0000, v126
  v_pk_add_f32 v[188:189], v[188:189], v[12:13]
  v_lshlrev_b32 v14, 16, v127
  v_and_b32 v15, 0xffff0000, v127
  v_pk_add_f32 v[190:191], v[190:191], v[14:15]
  s_waitcnt vmcnt(6)
  v_lshlrev_b32 v8, 16, v128
  v_and_b32 v9, 0xffff0000, v128
  v_pk_add_f32 v[176:177], v[176:177], v[8:9]
  v_lshlrev_b32 v10, 16, v129
  v_and_b32 v11, 0xffff0000, v129
  v_pk_add_f32 v[178:179], v[178:179], v[10:11]
  v_lshlrev_b32 v12, 16, v130
  v_and_b32 v13, 0xffff0000, v130
  v_pk_add_f32 v[180:181], v[180:181], v[12:13]
  v_lshlrev_b32 v14, 16, v131
  v_and_b32 v15, 0xffff0000, v131
  v_pk_add_f32 v[182:183], v[182:183], v[14:15]
  v_lshlrev_b32 v8, 16, v132
  v_and_b32 v9, 0xffff0000, v132
  v_pk_add_f32 v[184:185], v[184:185], v[8:9]
  v_lshlrev_b32 v10, 16, v133
  v_and_b32 v11, 0xffff0000, v133
  v_pk_add_f32 v[186:187], v[186:187], v[10:11]
  v_lshlrev_b32 v12, 16, v134
  v_and_b32 v13, 0xffff0000, v134
  v_pk_add_f32 v[188:189], v[188:189], v[12:13]
  v_lshlrev_b32 v14, 16, v135
  v_and_b32 v15, 0xffff0000, v135
  v_pk_add_f32 v[190:191], v[190:191], v[14:15]
  s_waitcnt vmcnt(4)
  v_lshlrev_b32 v8, 16, v136
  v_and_b32 v9, 0xffff0000, v136
  v_pk_add_f32 v[176:177], v[176:177], v[8:9]
  v_lshlrev_b32 v10, 16, v137
  v_and_b32 v11, 0xffff0000, v137
  v_pk_add_f32 v[178:179], v[178:179], v[10:11]
  v_lshlrev_b32 v12, 16, v138
  v_and_b32 v13, 0xffff0000, v138
  v_pk_add_f32 v[180:181], v[180:181], v[12:13]
  v_lshlrev_b32 v14, 16, v139
  v_and_b32 v15, 0xffff0000, v139
  v_pk_add_f32 v[182:183], v[182:183], v[14:15]
  v_lshlrev_b32 v8, 16, v140
  v_and_b32 v9, 0xffff0000, v140
  v_pk_add_f32 v[184:185], v[184:185], v[8:9]
  v_lshlrev_b32 v10, 16, v141
  v_and_b32 v11, 0xffff0000, v141
  v_pk_add_f32 v[186:187], v[186:187], v[10:11]
  v_lshlrev_b32 v12, 16, v142
  v_and_b32 v13, 0xffff0000, v142
  v_pk_add_f32 v[188:189], v[188:189], v[12:13]
  v_lshlrev_b32 v14, 16, v143
  v_and_b32 v15, 0xffff0000, v143
  v_pk_add_f32 v[190:191], v[190:191], v[14:15]
  s_waitcnt vmcnt(2)
  v_lshlrev_b32 v8, 16, v144
  v_and_b32 v9, 0xffff0000, v144
  v_pk_add_f32 v[176:177], v[176:177], v[8:9]
  v_lshlrev_b32 v10, 16, v145
  v_and_b32 v11, 0xffff0000, v145
  v_pk_add_f32 v[178:179], v[178:179], v[10:11]
  v_lshlrev_b32 v12, 16, v146
  v_and_b32 v13, 0xffff0000, v146
  v_pk_add_f32 v[180:181], v[180:181], v[12:13]
  v_lshlrev_b32 v14, 16, v147
  v_and_b32 v15, 0xffff0000, v147
  v_pk_add_f32 v[182:183], v[182:183], v[14:15]
  v_lshlrev_b32 v8, 16, v148
  v_and_b32 v9, 0xffff0000, v148
  v_pk_add_f32 v[184:185], v[184:185], v[8:9]
  v_lshlrev_b32 v10, 16, v149
  v_and_b32 v11, 0xffff0000, v149
  v_pk_add_f32 v[186:187], v[186:187], v[10:11]
  v_lshlrev_b32 v12, 16, v150
  v_and_b32 v13, 0xffff0000, v150
  v_pk_add_f32 v[188:189], v[188:189], v[12:13]
  v_lshlrev_b32 v14, 16, v151
  v_and_b32 v15, 0xffff0000, v151
  v_pk_add_f32 v[190:191], v[190:191], v[14:15]
  s_waitcnt vmcnt(0)
  v_lshlrev_b32 v8, 16, v152
  v_and_b32 v9, 0xffff0000, v152
  v_pk_add_f32 v[176:177], v[176:177], v[8:9]
  v_lshlrev_b32 v10, 16, v153
  v_and_b32 v11, 0xffff0000, v153
  v_pk_add_f32 v[178:179], v[178:179], v[10:11]
  v_lshlrev_b32 v12, 16, v154
  v_and_b32 v13, 0xffff0000, v154
  v_pk_add_f32 v[180:181], v[180:181], v[12:13]
  v_lshlrev_b32 v14, 16, v155
  v_and_b32 v15, 0xffff0000, v155
  v_pk_add_f32 v[182:183], v[182:183], v[14:15]
  v_lshlrev_b32 v8, 16, v156
  v_and_b32 v9, 0xffff0000, v156
  v_pk_add_f32 v[184:185], v[184:185], v[8:9]
  v_lshlrev_b32 v10, 16, v157
  v_and_b32 v11, 0xffff0000, v157
  v_pk_add_f32 v[186:187], v[186:187], v[10:11]
  v_lshlrev_b32 v12, 16, v158
  v_and_b32 v13, 0xffff0000, v158
  v_pk_add_f32 v[188:189], v[188:189], v[12:13]
  v_lshlrev_b32 v14, 16, v159
  v_and_b32 v15, 0xffff0000, v159
  v_pk_add_f32 v[190:191], v[190:191], v[14:15]
  v_pk_fma_f32 v[160:161], v[176:177], v[82:83], v[160:161] op_sel_hi:[1,0,1]
  v_cvt_pk_bf16_f32 v16, v160, v161
  v_pk_fma_f32 v[162:163], v[178:179], v[82:83], v[162:163] op_sel_hi:[1,0,1]
  v_cvt_pk_bf16_f32 v17, v162, v163
  v_pk_fma_f32 v[164:165], v[180:181], v[82:83], v[164:165] op_sel_hi:[1,0,1]
  v_cvt_pk_bf16_f32 v18, v164, v165
  v_pk_fma_f32 v[166:167], v[182:183], v[82:83], v[166:167] op_sel_hi:[1,0,1]
  v_cvt_pk_bf16_f32 v19, v166, v167
  v_pk_fma_f32 v[168:169], v[184:185], v[82:83], v[168:169] op_sel_hi:[1,0,1]
  v_cvt_pk_bf16_f32 v20, v168, v169
  v_pk_fma_f32 v[170:171], v[186:187], v[82:83], v[170:171] op_sel_hi:[1,0,1]
  v_cvt_pk_bf16_f32 v21, v170, v171
  v_pk_fma_f32 v[172:173], v[188:189], v[82:83], v[172:173] op_sel_hi:[1,0,1]
  v_cvt_pk_bf16_f32 v22, v172, v173
  v_pk_fma_f32 v[174:175], v[190:191], v[82:83], v[174:175] op_sel_hi:[1,0,1]
  v_cvt_pk_bf16_f32 v23, v174, v175
  s_lshl_b32 s26, s49, 2
  s_add_u32 s26, s26, s16
  s_lshl_b32 s26, s26, 6
  s_lshl_b32 s27, s48, 15
  s_add_u32 s26, s26, s27
  buffer_store_dwordx4 v[16:19], v6, s[32:35], s26 offen offset:0
  buffer_store_dwordx4 v[20:23], v6, s[32:35], s26 offen offset:32
  s_cmp_lt_u32 s50, 64
  s_mov_b32 s50, s51
  s_cbranch_scc1 M_fin
  s_branch M_done
M_follow:
  s_lshr_b32 s48, s64, 2
  s_and_b32 s49, s64, 1
  s_bfe_u32 s50, s64, 0x10001
  s_mov_b32 s51, 2
  s_mov_b32 s23, 32
  s_load_dwordx2 s[8:9], s[0:1], 88
  s_lshl_b32 s17, s48, 19
  s_lshl_b32 s26, s49, 2
  s_add_u32 s26, s26, s16
  s_lshl_b32 s27, s26, 7
  s_add_u32 s17, s17, s27
  s_mov_b32 s18, 1024
  s_lshl_b32 s21, s48, 6
  s_add_u32 s21, s21, s50
  s_lshl_b32 s21, s21, 3
  s_add_u32 s21, s21, s26
  s_lshl_b32 s21, s21, 12
  s_add_u32 s21, s21, 167772160
  s_lshl_b32 s22, s51, 15
  s_mov_b32 s24, 1.0
  s_waitcnt lgkmcnt(0)
  s_and_b32 s9, s9, 0xffff
  s_mov_b32 s10, 4194304
  s_mov_b32 s11, 0x20000
  s_mul_i32 s26, s16, 0
  v_add_u32 v8, 0, v2
  v_add_u32 v16, s26, v8
  v_add_u32 v9, 1024, v2
  v_add_u32 v17, s26, v9
  v_add_u32 v10, 2048, v2
  v_add_u32 v18, s26, v10
  v_add_u32 v11, 3072, v2
  v_add_u32 v19, s26, v11
  v_add_u32 v12, 4096, v2
  v_add_u32 v20, s26, v12
  v_add_u32 v13, 5120, v2
  v_add_u32 v21, s26, v13
  v_add_u32 v14, 6144, v2
  v_add_u32 v22, s26, v14
  v_add_u32 v15, 7168, v2
  v_add_u32 v23, s26, v15
  v_lshrrev_b32 v144, 3, v1
  v_mul_lo_u32 v144, v144, s18
  v_and_b32 v145, 7, v1
  v_lshl_add_u32 v144, v145, 4, v144
  s_lshl_b32 s28, s16, 15
  s_add_u32 s28, s28, 32768
  s_lshl_b32 s29, s18, 3
  s_add_u32 m0, s28, 0
  s_nop 0
  buffer_load_dwordx4 v144, s[8:11], s17 offen lds
  s_add_u32 s17, s17, s29
  s_add_u32 m0, s28, 1024
  s_nop 0
  buffer_load_dwordx4 v144, s[8:11], s17 offen lds
  s_add_u32 s17, s17, s29
  s_add_u32 m0, s28, 2048
  s_nop 0
  buffer_load_dwordx4 v144, s[8:11], s17 offen lds
  s_add_u32 s17, s17, s29
  s_add_u32 m0, s28, 3072
  s_nop 0
  buffer_load_dwordx4 v144, s[8:11], s17 offen lds
  s_add_u32 s17, s17, s29
  s_add_u32 m0, s28, 4096
  s_nop 0
  buffer_load_dwordx4 v144, s[8:11], s17 offen lds
  s_add_u32 s17, s17, s29
  s_add_u32 m0, s28, 5120
  s_nop 0
  buffer_load_dwordx4 v144, s[8:11], s17 offen lds
  s_add_u32 s17, s17, s29
  s_add_u32 m0, s28, 6144
  s_nop 0
  buffer_load_dwordx4 v144, s[8:11], s17 offen lds
  s_add_u32 s17, s17, s29
  s_add_u32 m0, s28, 7168
  s_nop 0
  buffer_load_dwordx4 v144, s[8:11], s17 offen lds
  s_add_u32 s17, s17, s29
  s_add_u32 m0, s28, 8192
  s_nop 0
  buffer_load_dwordx4 v144, s[8:11], s17 offen lds
  s_add_u32 s17, s17, s29
  s_add_u32 m0, s28, 9216
  s_nop 0
  buffer_load_dwordx4 v144, s[8:11], s17 offen lds
  s_add_u32 s17, s17, s29
  s_add_u32 m0, s28, 10240
  s_nop 0
  buffer_load_dwordx4 v144, s[8:11], s17 offen lds
  s_add_u32 s17, s17, s29
  s_add_u32 m0, s28, 11264
  s_nop 0
  buffer_load_dwordx4 v144, s[8:11], s17 offen lds
  s_add_u32 s17, s17, s29
  s_add_u32 m0, s28, 12288
  s_nop 0
  buffer_load_dwordx4 v144, s[8:11], s17 offen lds
  s_add_u32 s17, s17, s29
  s_add_u32 m0, s28, 13312
  s_nop 0
  buffer_load_dwordx4 v144, s[8:11], s17 offen lds
  s_add_u32 s17, s17, s29
  s_add_u32 m0, s28, 14336
  s_nop 0
  buffer_load_dwordx4 v144, s[8:11], s17 offen lds
  s_add_u32 s17, s17, s29
  s_add_u32 m0, s28, 15360
  s_nop 0
  buffer_load_dwordx4 v144, s[8:11], s17 offen lds
  s_add_u32 s17, s17, s29
  s_add_u32 m0, s28, 16384
  s_nop 0
  buffer_load_dwordx4 v144, s[8:11], s17 offen lds
  s_add_u32 s17, s17, s29
  s_add_u32 m0, s28, 17408
  s_nop 0
  buffer_load_dwordx4 v144, s[8:11], s17 offen lds
  s_add_u32 s17, s17, s29
  s_add_u32 m0, s28, 18432
  s_nop 0
  buffer_load_dwordx4 v144, s[8:11], s17 offen lds
  s_add_u32 s17, s17, s29
  s_add_u32 m0, s28, 19456
  s_nop 0
  buffer_load_dwordx4 v144, s[8:11], s17 offen lds
  s_add_u32 s17, s17, s29
  s_add_u32 m0, s28, 20480
  s_nop 0
  buffer_load_dwordx4 v144, s[8:11], s17 offen lds
  s_add_u32 s17, s17, s29
  s_add_u32 m0, s28, 21504
  s_nop 0
  buffer_load_dwordx4 v144, s[8:11], s17 offen lds
  s_add_u32 s17, s17, s29
  s_add_u32 m0, s28, 22528
  s_nop 0
  buffer_load_dwordx4 v144, s[8:11], s17 offen lds
  s_add_u32 s17, s17, s29
  s_add_u32 m0, s28, 23552
  s_nop 0
  buffer_load_dwordx4 v144, s[8:11], s17 offen lds
  s_add_u32 s17, s17, s29
  s_add_u32 m0, s28, 24576
  s_nop 0
  buffer_load_dwordx4 v144, s[8:11], s17 offen lds
  s_add_u32 s17, s17, s29
  s_add_u32 m0, s28, 25600
  s_nop 0
  buffer_load_dwordx4 v144, s[8:11], s17 offen lds
  s_add_u32 s17, s17, s29
  s_add_u32 m0, s28, 26624
  s_nop 0
  buffer_load_dwordx4 v144, s[8:11], s17 offen lds
  s_add_u32 s17, s17, s29
  s_add_u32 m0, s28, 27648
  s_nop 0
  buffer_load_dwordx4 v144, s[8:11], s17 offen lds
  s_add_u32 s17, s17, s29
  s_add_u32 m0, s28, 28672
  s_nop 0
  buffer_load_dwordx4 v144, s[8:11], s17 offen lds
  s_add_u32 s17, s17, s29
  s_add_u32 m0, s28, 29696
  s_nop 0
  buffer_load_dwordx4 v144, s[8:11], s17 offen lds
  s_add_u32 s17, s17, s29
  s_add_u32 m0, s28, 30720
  s_nop 0
  buffer_load_dwordx4 v144, s[8:11], s17 offen lds
  s_add_u32 s17, s17, s29
  s_add_u32 m0, s28, 31744
  s_nop 0
  buffer_load_dwordx4 v144, s[8:11], s17 offen lds
  s_add_u32 s17, s17, s29
  v_bfe_u32 v148, v1, 2, 2
  v_lshrrev_b32 v149, 5, v1
  v_lshl_add_u32 v148, v149, 2, v148
  v_lshlrev_b32 v148, 7, v148
  v_bfe_u32 v149, v1, 4, 1
  v_lshl_add_u32 v148, v149, 5, v148
  v_and_b32 v149, 1, v1
  v_lshl_add_u32 v148, v149, 4, v148
  v_bfe_u32 v149, v1, 1, 1
  v_lshl_add_u32 v148, v149, 3, v148
  v_add_u32 v146, s28, v148
  v_add_u32 v147, 1024, v146
  s_waitcnt vmcnt(28)
  ds_read_b64_tr_b16 a[0:1], v146 offset:0
  ds_read_b64_tr_b16 a[2:3], v147 offset:0
  ds_read_b64_tr_b16 a[4:5], v146 offset:64
  ds_read_b64_tr_b16 a[6:7], v147 offset:64
  ds_read_b64_tr_b16 a[8:9], v146 offset:2048
  ds_read_b64_tr_b16 a[10:11], v147 offset:2048
  ds_read_b64_tr_b16 a[12:13], v146 offset:2112
  ds_read_b64_tr_b16 a[14:15], v147 offset:2112
  s_waitcnt lgkmcnt(0)
  s_add_u32 m0, s28, 0
  s_nop 0
  buffer_load_dwordx4 v144, s[8:11], s17 offen lds
  s_add_u32 s17, s17, s29
  s_add_u32 m0, s28, 1024
  s_nop 0
  buffer_load_dwordx4 v144, s[8:11], s17 offen lds
  s_add_u32 s17, s17, s29
  s_add_u32 m0, s28, 2048
  s_nop 0
  buffer_load_dwordx4 v144, s[8:11], s17 offen lds
  s_add_u32 s17, s17, s29
  s_add_u32 m0, s28, 3072
  s_nop 0
  buffer_load_dwordx4 v144, s[8:11], s17 offen lds
  s_add_u32 s17, s17, s29
  s_waitcnt vmcnt(28)
  ds_read_b64_tr_b16 a[16:17], v146 offset:4096
  ds_read_b64_tr_b16 a[18:19], v147 offset:4096
  ds_read_b64_tr_b16 a[20:21], v146 offset:4160
  ds_read_b64_tr_b16 a[22:23], v147 offset:4160
  ds_read_b64_tr_b16 a[24:25], v146 offset:6144
  ds_read_b64_tr_b16 a[26:27], v147 offset:6144
  ds_read_b64_tr_b16 a[28:29], v146 offset:6208
  ds_read_b64_tr_b16 a[30:31], v147 offset:6208
  s_waitcnt lgkmcnt(0)
  s_add_u32 m0, s28, 4096
  s_nop 0
  buffer_load_dwordx4 v144, s[8:11], s17 offen lds
  s_add_u32 s17, s17, s29
  s_add_u32 m0, s28, 5120
  s_nop 0
  buffer_load_dwordx4 v144, s[8:11], s17 offen lds
  s_add_u32 s17, s17, s29
  s_add_u32 m0, s28, 6144
  s_nop 0
  buffer_load_dwordx4 v144, s[8:11], s17 offen lds
  s_add_u32 s17, s17, s29
  s_add_u32 m0, s28, 7168
  s_nop 0
  buffer_load_dwordx4 v144, s[8:11], s17 offen lds
  s_add_u32 s17, s17, s29
  s_waitcnt vmcnt(28)
  ds_read_b64_tr_b16 a[32:33], v146 offset:8192
  ds_read_b64_tr_b16 a[34:35], v147 offset:8192
  ds_read_b64_tr_b16 a[36:37], v146 offset:8256
  ds_read_b64_tr_b16 a[38:39], v147 offset:8256
  ds_read_b64_tr_b16 a[40:41], v146 offset:10240
  ds_read_b64_tr_b16 a[42:43], v147 offset:10240
  ds_read_b64_tr_b16 a[44:45], v146 offset:10304
  ds_read_b64_tr_b16 a[46:47], v147 offset:10304
  s_waitcnt lgkmcnt(0)
  s_add_u32 m0, s28, 8192
  s_nop 0
  buffer_load_dwordx4 v144, s[8:11], s17 offen lds
  s_add_u32 s17, s17, s29
  s_add_u32 m0, s28, 9216
  s_nop 0
  buffer_load_dwordx4 v144, s[8:11], s17 offen lds
  s_add_u32 s17, s17, s29
  s_add_u32 m0, s28, 10240
  s_nop 0
  buffer_load_dwordx4 v144, s[8:11], s17 offen lds
  s_add_u32 s17, s17, s29
  s_add_u32 m0, s28, 11264
  s_nop 0
  buffer_load_dwordx4 v144, s[8:11], s17 offen lds
  s_add_u32 s17, s17, s29
  s_waitcnt vmcnt(28)
  ds_read_b64_tr_b16 a[48:49], v146 offset:12288
  ds_read_b64_tr_b16 a[50:51], v147 offset:12288
  ds_read_b64_tr_b16 a[52:53], v146 offset:12352
  ds_read_b64_tr_b16 a[54:55], v147 offset:12352
  ds_read_b64_tr_b16 a[56:57], v146 offset:14336
  ds_read_b64_tr_b16 a[58:59], v147 offset:14336
  ds_read_b64_tr_b16 a[60:61], v146 offset:14400
  ds_read_b64_tr_b16 a[62:63], v147 offset:14400
  s_waitcnt lgkmcnt(0)
  s_add_u32 m0, s28, 12288
  s_nop 0
  buffer_load_dwordx4 v144, s[8:11], s17 offen lds
  s_add_u32 s17, s17, s29
  s_add_u32 m0, s28, 13312
  s_nop 0
  buffer_load_dwordx4 v144, s[8:11], s17 offen lds
  s_add_u32 s17, s17, s29
  s_add_u32 m0, s28, 14336
  s_nop 0
  buffer_load_dwordx4 v144, s[8:11], s17 offen lds
  s_add_u32 s17, s17, s29
  s_add_u32 m0, s28, 15360
  s_nop 0
  buffer_load_dwordx4 v144, s[8:11], s17 offen lds
  s_add_u32 s17, s17, s29
  s_waitcnt vmcnt(28)
  ds_read_b64_tr_b16 a[64:65], v146 offset:16384
  ds_read_b64_tr_b16 a[66:67], v147 offset:16384
  ds_read_b64_tr_b16 a[68:69], v146 offset:16448
  ds_read_b64_tr_b16 a[70:71], v147 offset:16448
  ds_read_b64_tr_b16 a[72:73], v146 offset:18432
  ds_read_b64_tr_b16 a[74:75], v147 offset:18432
  ds_read_b64_tr_b16 a[76:77], v146 offset:18496
  ds_read_b64_tr_b16 a[78:79], v147 offset:18496
  s_waitcnt lgkmcnt(0)
  s_add_u32 m0, s28, 16384
  s_nop 0
  buffer_load_dwordx4 v144, s[8:11], s17 offen lds
  s_add_u32 s17, s17, s29
  s_add_u32 m0, s28, 17408
  s_nop 0
  buffer_load_dwordx4 v144, s[8:11], s17 offen lds
  s_add_u32 s17, s17, s29
  s_add_u32 m0, s28, 18432
  s_nop 0
  buffer_load_dwordx4 v144, s[8:11], s17 offen lds
  s_add_u32 s17, s17, s29
  s_add_u32 m0, s28, 19456
  s_nop 0
  buffer_load_dwordx4 v144, s[8:11], s17 offen lds
  s_add_u32 s17, s17, s29
  s_waitcnt vmcnt(28)
  ds_read_b64_tr_b16 a[80:81], v146 offset:20480
  ds_read_b64_tr_b16 a[82:83], v147 offset:20480
  ds_read_b64_tr_b16 a[84:85], v146 offset:20544
  ds_read_b64_tr_b16 a[86:87], v147 offset:20544
  ds_read_b64_tr_b16 a[88:89], v146 offset:22528
  ds_read_b64_tr_b16 a[90:91], v147 offset:22528
  ds_read_b64_tr_b16 a[92:93], v146 offset:22592
  ds_read_b64_tr_b16 a[94:95], v147 offset:22592
  s_waitcnt lgkmcnt(0)
  s_add_u32 m0, s28, 20480
  s_nop 0
  buffer_load_dwordx4 v144, s[8:11], s17 offen lds
  s_add_u32 s17, s17, s29
  s_add_u32 m0, s28, 21504
  s_nop 0
  buffer_load_dwordx4 v144, s[8:11], s17 offen lds
  s_add_u32 s17, s17, s29
  s_add_u32 m0, s28, 22528
  s_nop 0
  buffer_load_dwordx4 v144, s[8:11], s17 offen lds
  s_add_u32 s17, s17, s29
  s_add_u32 m0, s28, 23552
  s_nop 0
  buffer_load_dwordx4 v144, s[8:11], s17 offen lds
  s_add_u32 s17, s17, s29
  s_waitcnt vmcnt(28)
  ds_read_b64_tr_b16 a[96:97], v146 offset:24576
  ds_read_b64_tr_b16 a[98:99], v147 offset:24576
  ds_read_b64_tr_b16 a[100:101], v146 offset:24640
  ds_read_b64_tr_b16 a[102:103], v147 offset:24640
  ds_read_b64_tr_b16 a[104:105], v146 offset:26624
  ds_read_b64_tr_b16 a[106:107], v147 offset:26624
  ds_read_b64_tr_b16 a[108:109], v146 offset:26688
  ds_read_b64_tr_b16 a[110:111], v147 offset:26688
  s_waitcnt lgkmcnt(0)
  s_add_u32 m0, s28, 24576
  s_nop 0
  buffer_load_dwordx4 v144, s[8:11], s17 offen lds
  s_add_u32 s17, s17, s29
  s_add_u32 m0, s28, 25600
  s_nop 0
  buffer_load_dwordx4 v144, s[8:11], s17 offen lds
  s_add_u32 s17, s17, s29
  s_add_u32 m0, s28, 26624
  s_nop 0
  buffer_load_dwordx4 v144, s[8:11], s17 offen lds
  s_add_u32 s17, s17, s29
  s_add_u32 m0, s28, 27648
  s_nop 0
  buffer_load_dwordx4 v144, s[8:11], s17 offen lds
  s_add_u32 s17, s17, s29
  s_waitcnt vmcnt(28)
  ds_read_b64_tr_b16 a[112:113], v146 offset:28672
  ds_read_b64_tr_b16 a[114:115], v147 offset:28672
  ds_read_b64_tr_b16 a[116:117], v146 offset:28736
  ds_read_b64_tr_b16 a[118:119], v147 offset:28736
  ds_read_b64_tr_b16 a[120:121], v146 offset:30720
  ds_read_b64_tr_b16 a[122:123], v147 offset:30720
  ds_read_b64_tr_b16 a[124:125], v146 offset:30784
  ds_read_b64_tr_b16 a[126:127], v147 offset:30784
  s_waitcnt lgkmcnt(0)
  s_add_u32 m0, s28, 28672
  s_nop 0
  buffer_load_dwordx4 v144, s[8:11], s17 offen lds
  s_add_u32 s17, s17, s29
  s_add_u32 m0, s28, 29696
  s_nop 0
  buffer_load_dwordx4 v144, s[8:11], s17 offen lds
  s_add_u32 s17, s17, s29
  s_add_u32 m0, s28, 30720
  s_nop 0
  buffer_load_dwordx4 v144, s[8:11], s17 offen lds
  s_add_u32 s17, s17, s29
  s_add_u32 m0, s28, 31744
  s_nop 0
  buffer_load_dwordx4 v144, s[8:11], s17 offen lds
  s_add_u32 s17, s17, s29
  s_waitcnt vmcnt(28)
  ds_read_b64_tr_b16 a[128:129], v146 offset:0
  ds_read_b64_tr_b16 a[130:131], v147 offset:0
  ds_read_b64_tr_b16 a[132:133], v146 offset:64
  ds_read_b64_tr_b16 a[134:135], v147 offset:64
  ds_read_b64_tr_b16 a[136:137], v146 offset:2048
  ds_read_b64_tr_b16 a[138:139], v147 offset:2048
  ds_read_b64_tr_b16 a[140:141], v146 offset:2112
  ds_read_b64_tr_b16 a[142:143], v147 offset:2112
  s_waitcnt lgkmcnt(0)
  s_waitcnt vmcnt(24)
  ds_read_b64_tr_b16 a[144:145], v146 offset:4096
  ds_read_b64_tr_b16 a[146:147], v147 offset:4096
  ds_read_b64_tr_b16 a[148:149], v146 offset:4160
  ds_read_b64_tr_b16 a[150:151], v147 offset:4160
  ds_read_b64_tr_b16 a[152:153], v146 offset:6144
  ds_read_b64_tr_b16 a[154:155], v147 offset:6144
  ds_read_b64_tr_b16 a[156:157], v146 offset:6208
  ds_read_b64_tr_b16 a[158:159], v147 offset:6208
  s_waitcnt lgkmcnt(0)
  s_waitcnt vmcnt(20)
  ds_read_b64_tr_b16 a[160:161], v146 offset:8192
  ds_read_b64_tr_b16 a[162:163], v147 offset:8192
  ds_read_b64_tr_b16 a[164:165], v146 offset:8256
  ds_read_b64_tr_b16 a[166:167], v147 offset:8256
  ds_read_b64_tr_b16 a[168:169], v146 offset:10240
  ds_read_b64_tr_b16 a[170:171], v147 offset:10240
  ds_read_b64_tr_b16 a[172:173], v146 offset:10304
  ds_read_b64_tr_b16 a[174:175], v147 offset:10304
  s_waitcnt lgkmcnt(0)
  s_waitcnt vmcnt(16)
  ds_read_b64_tr_b16 a[176:177], v146 offset:12288
  ds_read_b64_tr_b16 a[178:179], v147 offset:12288
  ds_read_b64_tr_b16 a[180:181], v146 offset:12352
  ds_read_b64_tr_b16 a[182:183], v147 offset:12352
  ds_read_b64_tr_b16 a[184:185], v146 offset:14336
  ds_read_b64_tr_b16 a[186:187], v147 offset:14336
  ds_read_b64_tr_b16 a[188:189], v146 offset:14400
  ds_read_b64_tr_b16 a[190:191], v147 offset:14400
  s_waitcnt lgkmcnt(0)
  s_waitcnt vmcnt(12)
  ds_read_b64_tr_b16 a[192:193], v146 offset:16384
  ds_read_b64_tr_b16 a[194:195], v147 offset:16384
  ds_read_b64_tr_b16 a[196:197], v146 offset:16448
  ds_read_b64_tr_b16 a[198:199], v147 offset:16448
  ds_read_b64_tr_b16 a[200:201], v146 offset:18432
  ds_read_b64_tr_b16 a[202:203], v147 offset:18432
  ds_read_b64_tr_b16 a[204:205], v146 offset:18496
  ds_read_b64_tr_b16 a[206:207], v147 offset:18496
  s_waitcnt lgkmcnt(0)
  s_waitcnt vmcnt(8)
  ds_read_b64_tr_b16 a[208:209], v146 offset:20480
  ds_read_b64_tr_b16 a[210:211], v147 offset:20480
  ds_read_b64_tr_b16 a[212:213], v146 offset:20544
  ds_read_b64_tr_b16 a[214:215], v147 offset:20544
  ds_read_b64_tr_b16 a[216:217], v146 offset:22528
  ds_read_b64_tr_b16 a[218:219], v147 offset:22528
  ds_read_b64_tr_b16 a[220:221], v146 offset:22592
  ds_read_b64_tr_b16 a[222:223], v147 offset:22592
  s_waitcnt lgkmcnt(0)
  s_waitcnt vmcnt(4)
  ds_read_b64_tr_b16 a[224:225], v146 offset:24576
  ds_read_b64_tr_b16 a[226:227], v147 offset:24576
  ds_read_b64_tr_b16 a[228:229], v146 offset:24640
  ds_read_b64_tr_b16 a[230:231], v147 offset:24640
  ds_read_b64_tr_b16 a[232:233], v146 offset:26624
  ds_read_b64_tr_b16 a[234:235], v147 offset:26624
  ds_read_b64_tr_b16 a[236:237], v146 offset:26688
  ds_read_b64_tr_b16 a[238:239], v147 offset:26688
  s_waitcnt lgkmcnt(0)
  s_waitcnt vmcnt(0)
  ds_read_b64_tr_b16 a[240:241], v146 offset:28672
  ds_read_b64_tr_b16 a[242:243], v147 offset:28672
  ds_read_b64_tr_b16 a[244:245], v146 offset:28736
  ds_read_b64_tr_b16 a[246:247], v147 offset:28736
  ds_read_b64_tr_b16 a[248:249], v146 offset:30720
  ds_read_b64_tr_b16 a[250:251], v147 offset:30720
  ds_read_b64_tr_b16 a[252:253], v146 offset:30784
  ds_read_b64_tr_b16 a[254:255], v147 offset:30784
  s_waitcnt lgkmcnt(0)
  s_lshl_b32 s26, s48, 2
  s_add_u32 s26, s26, s16
  s_lshl_b32 s27, s26, 6
  s_add_u32 s27, s27, s50
  s_lshl_b32 s19, s27, 13
  s_lshl_b32 s27, s50, 5
  s_add_u32 s27, s27, s26
  s_mul_i32 s27, s27, 4608
  s_add_u32 s20, s27, 134217728
  s_lshl_b32 s25, s16, 12
  s_add_u32 s25, s25, 65536
  s_lshl_b32 s26, s16, 13
  v_add_u32 v3, s26, v2
  v_lshrrev_b32 v16, 5, v1
  v_and_b32 v17, 31, v1
  v_mul_u32_u24 v18, 1152, v16
  v_lshl_add_u32 v5, v17, 3, v18
  v_bfe_u32 v18, v1, 2, 2
  v_lshl_add_u32 v18, v16, 2, v18
  v_and_b32 v19, 1, v1
  v_mul_u32_u24 v19, 1152, v19
  v_lshl_add_u32 v18, v18, 3, v19
  v_add_u32 v4, s25, v18
  v_lshlrev_b32 v16, 2, v16
  v_sub_u32 v17, v17, v16
  v_mov_b32 v18, 0xf149f2ca
  v_cmp_le_i32 vcc, 0, v17
  s_nop 1
  v_cndmask_b32 v240, v18, 0, vcc
  v_cmp_le_i32 vcc, 1, v17
  s_nop 1
  v_cndmask_b32 v241, v18, 0, vcc
  v_cmp_le_i32 vcc, 2, v17
  s_nop 1
  v_cndmask_b32 v242, v18, 0, vcc
  v_cmp_le_i32 vcc, 3, v17
  s_nop 1
  v_cndmask_b32 v243, v18, 0, vcc
  v_cmp_le_i32 vcc, 8, v17
  s_nop 1
  v_cndmask_b32 v244, v18, 0, vcc
  v_cmp_le_i32 vcc, 9, v17
  s_nop 1
  v_cndmask_b32 v245, v18, 0, vcc
  v_cmp_le_i32 vcc, 10, v17
  s_nop 1
  v_cndmask_b32 v246, v18, 0, vcc
  v_cmp_le_i32 vcc, 11, v17
  s_nop 1
  v_cndmask_b32 v247, v18, 0, vcc
  v_cmp_le_i32 vcc, 16, v17
  s_nop 1
  v_cndmask_b32 v248, v18, 0, vcc
  v_cmp_le_i32 vcc, 17, v17
  s_nop 1
  v_cndmask_b32 v249, v18, 0, vcc
  v_cmp_le_i32 vcc, 18, v17
  s_nop 1
  v_cndmask_b32 v250, v18, 0, vcc
  v_cmp_le_i32 vcc, 19, v17
  s_nop 1
  v_cndmask_b32 v251, v18, 0, vcc
  v_cmp_le_i32 vcc, 24, v17
  s_nop 1
  v_cndmask_b32 v252, v18, 0, vcc
  v_cmp_le_i32 vcc, 25, v17
  s_nop 1
  v_cndmask_b32 v253, v18, 0, vcc
  v_cmp_le_i32 vcc, 26, v17
  s_nop 1
  v_cndmask_b32 v254, v18, 0, vcc
  v_cmp_le_i32 vcc, 27, v17
  s_nop 1
  v_cndmask_b32 v255, v18, 0, vcc
  v_mov_b32 v21, v2
  s_barrier
  s_lshl_b32 s77, s48, 2
  s_add_u32 s77, s77, s16
  s_mul_i32 s78, s77, 896
  s_add_u32 s76, s78, 148898304
  s_mov_b32 s71, 0
  s_branch M_sg_55
M_sw_54:
  s_sleep 8
  s_add_u32 s71, s71, 1
  s_cmp_gt_u32 s71, 262144
  s_cbranch_scc1 M_exit
M_sg_55:
  s_mov_b32 s79, 0
  s_atomic_or s79, s[72:73], s76 glc
  s_waitcnt lgkmcnt(0)
  s_cmp_lt_u32 s79, 16
  s_cbranch_scc1 M_sw_54
  s_add_u32 s76, s78, 148898048
  s_mov_b32 s71, 0
  s_branch M_sg_57
M_sw_56:
  s_sleep 8
  s_add_u32 s71, s71, 1
  s_cmp_gt_u32 s71, 262144
  s_cbranch_scc1 M_exit
M_sg_57:
  s_mov_b32 s79, 0
  s_atomic_or s79, s[72:73], s76 glc
  s_waitcnt lgkmcnt(0)
  s_cmp_lt_u32 s79, 16
  s_cbranch_scc1 M_sw_56
M_xok_53:
  s_lshl_b32 s77, s77, 7
  s_add_u32 s54, s77, 148926464
  s_add_u32 s52, s50, 1
  s_mov_b32 s53, 0
  s_mov_b32 s30, 0x200
  s_add_u32 s28, s19, 50331648
  buffer_load_dwordx4 v[144:147], v21, s[4:7], s28 offen offset:0 sc1
  buffer_load_dwordx4 v[148:151], v21, s[4:7], s28 offen offset:1024 sc1
  buffer_load_dwordx4 v[152:155], v21, s[4:7], s28 offen offset:2048 sc1
  buffer_load_dwordx4 v[156:159], v21, s[4:7], s28 offen offset:3072 sc1
  s_add_u32 s29, s19, 50335744
  buffer_load_dwordx4 v[160:163], v21, s[4:7], s29 offen offset:0 sc1
  buffer_load_dwordx4 v[164:167], v21, s[4:7], s29 offen offset:1024 sc1
  buffer_load_dwordx4 v[168:171], v21, s[4:7], s29 offen offset:2048 sc1
  buffer_load_dwordx4 v[172:175], v21, s[4:7], s29 offen offset:3072 sc1
  s_add_u32 s28, s19, 67108864
  buffer_load_dwordx4 v[176:179], v21, s[4:7], s28 offen offset:0 sc1
  buffer_load_dwordx4 v[180:183], v21, s[4:7], s28 offen offset:1024 sc1
  buffer_load_dwordx4 v[184:187], v21, s[4:7], s28 offen offset:2048 sc1
  buffer_load_dwordx4 v[188:191], v21, s[4:7], s28 offen offset:3072 sc1
  s_add_u32 s29, s19, 67112960
  buffer_load_dwordx4 v[192:195], v21, s[4:7], s29 offen offset:0 sc1
  buffer_load_dwordx4 v[196:199], v21, s[4:7], s29 offen offset:1024 sc1
  buffer_load_dwordx4 v[200:203], v21, s[4:7], s29 offen offset:2048 sc1
  buffer_load_dwordx4 v[204:207], v21, s[4:7], s29 offen offset:3072 sc1
  s_add_u32 s28, s19, 83886080
  buffer_load_dwordx4 v[208:211], v21, s[4:7], s28 offen offset:0 sc1
  buffer_load_dwordx4 v[212:215], v21, s[4:7], s28 offen offset:1024 sc1
  buffer_load_dwordx4 v[216:219], v21, s[4:7], s28 offen offset:2048 sc1
  buffer_load_dwordx4 v[220:223], v21, s[4:7], s28 offen offset:3072 sc1
  s_add_u32 s29, s19, 83890176
  buffer_load_dwordx4 v[224:227], v21, s[4:7], s29 offen offset:0 sc1
  buffer_load_dwordx4 v[228:231], v21, s[4:7], s29 offen offset:1024 sc1
  buffer_load_dwordx4 v[232:235], v21, s[4:7], s29 offen offset:2048 sc1
  buffer_load_dwordx4 v[236:239], v21, s[4:7], s29 offen offset:3072 sc1
  s_mov_b32 s24, 0
  v_mov_b32 v22, 0x40000000
  s_sub_u32 s21, s21, s22
F_top_58:
  s_waitcnt vmcnt(8)
  v_mfma_f32_32x32x16_bf16 v[24:39], v[176:179], v[144:147], v[240:255]
  s_nop 1
  v_cvt_pk_bf16_f32 v128, v64, v65
  v_cvt_pk_bf16_f32 v129, v66, v67
  v_cvt_pk_bf16_f32 v130, v68, v69
  v_cvt_pk_bf16_f32 v131, v70, v71
  v_mfma_f32_32x32x16_bf16 v[24:39], v[180:183], v[148:151], v[24:39]
  buffer_store_dwordx4 v[128:131], v22, s[4:7], s21 offen offset:0 sc1
  v_mfma_f32_32x32x16_bf16 v[24:39], v[184:187], v[152:155], v[24:39]
  v_cvt_pk_bf16_f32 v132, v72, v73
  v_cvt_pk_bf16_f32 v133, v74, v75
  v_cvt_pk_bf16_f32 v134, v76, v77
  v_cvt_pk_bf16_f32 v135, v78, v79
  v_mfma_f32_32x32x16_bf16 v[24:39], v[188:191], v[156:159], v[24:39]
  buffer_store_dwordx4 v[132:135], v22, s[4:7], s21 offen offset:1024 sc1
  v_mfma_f32_32x32x16_bf16 v[24:39], v[192:195], v[160:163], v[24:39]
  v_cvt_pk_bf16_f32 v136, v80, v81
  v_cvt_pk_bf16_f32 v137, v82, v83
  v_cvt_pk_bf16_f32 v138, v84, v85
  v_cvt_pk_bf16_f32 v139, v86, v87
  v_mfma_f32_32x32x16_bf16 v[24:39], v[196:199], v[164:167], v[24:39]
  buffer_store_dwordx4 v[136:139], v22, s[4:7], s21 offen offset:2048 sc1
  v_mfma_f32_32x32x16_bf16 v[24:39], v[200:203], v[168:171], v[24:39]
  v_cvt_pk_bf16_f32 v140, v88, v89
  v_cvt_pk_bf16_f32 v141, v90, v91
  v_cvt_pk_bf16_f32 v142, v92, v93
  v_cvt_pk_bf16_f32 v143, v94, v95
  v_mfma_f32_32x32x16_bf16 v[24:39], v[204:207], v[172:175], v[24:39]
  buffer_store_dwordx4 v[140:143], v22, s[4:7], s21 offen offset:3072 sc1
  s_add_u32 s21, s21, s22
  v_mov_b32 v22, v2
  s_cmp_lg_u32 s24, 0
  s_cbranch_scc1 F_have_59
  v_mov_b32 v16, s54
  v_mov_b32 v17, s52
  s_mov_b32 s71, 0
  s_branch M_vg_61
M_vw_60:
  s_sleep 2
  s_add_u32 s71, s71, 1
  s_cmp_gt_u32 s71, 262144
  s_cbranch_scc1 M_exit
M_vg_61:
  buffer_load_dword v23, v16, s[4:7], 0 offen sc1
  s_waitcnt vmcnt(0)
  v_cmp_lt_u32 vcc, v23, v17
  s_cbranch_vccnz M_vw_60
  s_mov_b32 m0, s25
  s_nop 0
  buffer_load_dwordx4 v2, s[4:7], s20 offen offset:0 sc1 lds
  buffer_load_dwordx4 v2, s[4:7], s20 offen offset:1152 sc1 lds
  buffer_load_dwordx2 v[56:57], v5, s[4:7], s20 offen offset:2304 sc1
  buffer_load_dwordx2 v[58:59], v5, s[4:7], s20 offen offset:2560 sc1
  buffer_load_dwordx2 v[60:61], v5, s[4:7], s20 offen offset:2816 sc1
  buffer_load_dwordx2 v[62:63], v5, s[4:7], s20 offen offset:3072 sc1
  s_waitcnt vmcnt(0)
F_have_59:
  ds_read_b64_tr_b16 v[176:177], v4 offset:0
  ds_read_b64_tr_b16 v[178:179], v4 offset:64
  ds_read_b64_tr_b16 v[180:181], v4 offset:128
  ds_read_b64_tr_b16 v[182:183], v4 offset:192
  ds_read_b64_tr_b16 v[184:185], v4 offset:256
  ds_read_b64_tr_b16 v[186:187], v4 offset:320
  ds_read_b64_tr_b16 v[188:189], v4 offset:384
  ds_read_b64_tr_b16 v[190:191], v4 offset:448
  ds_read_b64_tr_b16 v[192:193], v4 offset:512
  ds_read_b64_tr_b16 v[194:195], v4 offset:576
  ds_read_b64_tr_b16 v[196:197], v4 offset:640
  ds_read_b64_tr_b16 v[198:199], v4 offset:704
  s_sub_u32 s23, s23, 1
  s_cmp_gt_u32 s23, 0
  s_cselect_b32 s26, s51, 0
  s_cselect_b32 s27, 0, 0x40000000
  v_or_b32 v21, s27, v21
  s_lshl_b32 s27, s26, 13
  s_add_u32 s19, s19, s27
  s_mul_i32 s27, s26, 147456
  s_add_u32 s20, s20, s27
  s_cmp_lg_u32 s23, 24
  s_cbranch_scc1 M_xok_62
  s_lshl_b32 s77, s48, 2
  s_add_u32 s77, s77, s16
  s_mul_i32 s78, s77, 896
  s_add_u32 s76, s78, 148898304
  s_mov_b32 s71, 0
  s_branch M_sg_64
M_sw_63:
  s_sleep 8
  s_add_u32 s71, s71, 1
  s_cmp_gt_u32 s71, 262144
  s_cbranch_scc1 M_exit
M_sg_64:
  s_mov_b32 s79, 0
  s_atomic_or s79, s[72:73], s76 glc
  s_waitcnt lgkmcnt(0)
  s_cmp_lt_u32 s79, 32
  s_cbranch_scc1 M_sw_63
  s_add_u32 s76, s78, 148898432
  s_mov_b32 s71, 0
  s_branch M_sg_66
M_sw_65:
  s_sleep 8
  s_add_u32 s71, s71, 1
  s_cmp_gt_u32 s71, 262144
  s_cbranch_scc1 M_exit
M_sg_66:
  s_mov_b32 s79, 0
  s_atomic_or s79, s[72:73], s76 glc
  s_waitcnt lgkmcnt(0)
  s_cmp_lt_u32 s79, 32
  s_cbranch_scc1 M_sw_65
  s_add_u32 s76, s78, 148898048
  s_mov_b32 s71, 0
  s_branch M_sg_68
M_sw_67:
  s_sleep 8
  s_add_u32 s71, s71, 1
  s_cmp_gt_u32 s71, 262144
  s_cbranch_scc1 M_exit
M_sg_68:
  s_mov_b32 s79, 0
  s_atomic_or s79, s[72:73], s76 glc
  s_waitcnt lgkmcnt(0)
  s_cmp_lt_u32 s79, 30
  s_cbranch_scc1 M_sw_67
  s_add_u32 s76, s78, 148898176
  s_mov_b32 s71, 0
  s_branch M_sg_70
M_sw_69:
  s_sleep 8
  s_add_u32 s71, s71, 1
  s_cmp_gt_u32 s71, 262144
  s_cbranch_scc1 M_exit
M_sg_70:
  s_mov_b32 s79, 0
  s_atomic_or s79, s[72:73], s76 glc
  s_waitcnt lgkmcnt(0)
  s_cmp_lt_u32 s79, 34
  s_cbranch_scc1 M_sw_69
M_xok_62:
  s_waitcnt lgkmcnt(10)
  v_mfma_f32_32x32x16_bf16 v[40:55], v[176:179], v[144:147], 0
  ds_read_b64_tr_b16 v[200:201], v4 offset:768
  ds_read_b64_tr_b16 v[202:203], v4 offset:832
  v_max_f32 v6, v24, v25
  s_waitcnt lgkmcnt(10)
  v_mfma_f32_32x32x16_bf16 v[40:55], v[180:183], v[148:151], v[40:55]
  ds_read_b64_tr_b16 v[204:205], v4 offset:896
  ds_read_b64_tr_b16 v[206:207], v4 offset:960
  v_max3_f32 v6, v6, v26, v27
  s_waitcnt lgkmcnt(10)
  v_mfma_f32_32x32x16_bf16 v[40:55], v[184:187], v[152:155], v[40:55]
  v_max3_f32 v6, v6, v28, v29
  s_waitcnt lgkmcnt(8)
  v_mfma_f32_32x32x16_bf16 v[40:55], v[188:191], v[156:159], v[40:55]
  v_max3_f32 v6, v6, v30, v31
  s_waitcnt lgkmcnt(6)
  v_mfma_f32_32x32x16_bf16 v[40:55], v[192:195], v[160:163], v[40:55]
  v_max3_f32 v6, v6, v32, v33
  s_waitcnt lgkmcnt(4)
  v_mfma_f32_32x32x16_bf16 v[40:55], v[196:199], v[164:167], v[40:55]
  v_max3_f32 v6, v6, v34, v35
  s_waitcnt lgkmcnt(2)
  v_mfma_f32_32x32x16_bf16 v[40:55], v[200:203], v[168:171], v[40:55]
  v_max3_f32 v6, v6, v36, v37
  s_waitcnt lgkmcnt(0)
  v_mfma_f32_32x32x16_bf16 v[40:55], v[204:207], v[172:175], v[40:55]
  v_max3_f32 v6, v6, v38, v39
  s_add_u32 s28, s19, 50331648
  buffer_load_dwordx4 v[144:147], v21, s[4:7], s28 offen offset:0 sc1
  buffer_load_dwordx4 v[148:151], v21, s[4:7], s28 offen offset:1024 sc1
  s_nop 7
  v_max3_f32 v6, v6, v40, v41
  v_max3_f32 v6, v6, v42, v43
  v_mov_b32 v16, v6
  s_nop 1
  v_permlane32_swap_b32 v6, v16
  s_nop 1
  v_max_f32 v6, v6, v16
  v_pk_add_f32 v[24:25], v[24:25], v[6:7] op_sel_hi:[1,0] neg_lo:[0,1] neg_hi:[0,1]
  v_pk_add_f32 v[26:27], v[26:27], v[6:7] op_sel_hi:[1,0] neg_lo:[0,1] neg_hi:[0,1]
  v_pk_add_f32 v[28:29], v[28:29], v[6:7] op_sel_hi:[1,0] neg_lo:[0,1] neg_hi:[0,1]
  v_pk_add_f32 v[30:31], v[30:31], v[6:7] op_sel_hi:[1,0] neg_lo:[0,1] neg_hi:[0,1]
  v_pk_add_f32 v[32:33], v[32:33], v[6:7] op_sel_hi:[1,0] neg_lo:[0,1] neg_hi:[0,1]
  v_pk_add_f32 v[34:35], v[34:35], v[6:7] op_sel_hi:[1,0] neg_lo:[0,1] neg_hi:[0,1]
  v_pk_add_f32 v[36:37], v[36:37], v[6:7] op_sel_hi:[1,0] neg_lo:[0,1] neg_hi:[0,1]
  v_pk_add_f32 v[38:39], v[38:39], v[6:7] op_sel_hi:[1,0] neg_lo:[0,1] neg_hi:[0,1]
  v_pk_add_f32 v[40:41], v[40:41], v[6:7] op_sel_hi:[1,0] neg_lo:[0,1] neg_hi:[0,1]
  v_pk_add_f32 v[42:43], v[42:43], v[6:7] op_sel_hi:[1,0] neg_lo:[0,1] neg_hi:[0,1]
  v_exp_f32 v24, v24
  v_exp_f32 v25, v25
  v_exp_f32 v26, v26
  v_exp_f32 v27, v27
  v_exp_f32 v28, v28
  v_exp_f32 v29, v29
  v_exp_f32 v30, v30
  v_exp_f32 v31, v31
  v_exp_f32 v32, v32
  v_exp_f32 v33, v33
  buffer_load_dwordx4 v[152:155], v21, s[4:7], s28 offen offset:2048 sc1
  v_exp_f32 v34, v34
  v_exp_f32 v35, v35
  v_exp_f32 v36, v36
  v_exp_f32 v37, v37
  v_exp_f32 v38, v38
  v_exp_f32 v39, v39
  v_exp_f32 v40, v40
  v_exp_f32 v41, v41
  v_exp_f32 v42, v42
  v_exp_f32 v43, v43
  v_pk_add_f32 v[16:17], v[24:25], v[26:27]
  v_pk_add_f32 v[16:17], v[16:17], v[28:29]
  v_pk_add_f32 v[16:17], v[16:17], v[30:31]
  v_pk_add_f32 v[16:17], v[16:17], v[32:33]
  v_pk_add_f32 v[16:17], v[16:17], v[34:35]
  v_pk_add_f32 v[16:17], v[16:17], v[36:37]
  v_pk_add_f32 v[16:17], v[16:17], v[38:39]
  v_pk_add_f32 v[16:17], v[16:17], v[40:41]
  v_pk_add_f32 v[16:17], v[16:17], v[42:43]
  v_add_f32 v16, v16, v17
  v_mov_b32 v17, v16
  buffer_load_dwordx4 v[156:159], v21, s[4:7], s28 offen offset:3072 sc1
  s_nop 0
  v_permlane32_swap_b32 v16, v17
  s_nop 1
  v_add_f32 v16, v16, v17
  v_rcp_f32 v6, v16
  s_nop 0
  v_pk_mul_f32 v[24:25], v[24:25], v[6:7] op_sel_hi:[1,0]
  v_pk_mul_f32 v[26:27], v[26:27], v[6:7] op_sel_hi:[1,0]
  v_pk_mul_f32 v[28:29], v[28:29], v[6:7] op_sel_hi:[1,0]
  v_pk_mul_f32 v[30:31], v[30:31], v[6:7] op_sel_hi:[1,0]
  v_pk_mul_f32 v[32:33], v[32:33], v[6:7] op_sel_hi:[1,0]
  v_pk_mul_f32 v[34:35], v[34:35], v[6:7] op_sel_hi:[1,0]
  v_pk_mul_f32 v[36:37], v[36:37], v[6:7] op_sel_hi:[1,0]
  v_pk_mul_f32 v[38:39], v[38:39], v[6:7] op_sel_hi:[1,0]
  v_pk_mul_f32 v[40:41], v[40:41], v[6:7] op_sel_hi:[1,0]
  v_pk_mul_f32 v[42:43], v[42:43], v[6:7] op_sel_hi:[1,0]
  v_cvt_pk_bf16_f32 v128, v24, v25
  v_cvt_pk_bf16_f32 v129, v26, v27
  v_cvt_pk_bf16_f32 v130, v28, v29
  v_cvt_pk_bf16_f32 v131, v30, v31
  v_cvt_pk_bf16_f32 v132, v32, v33
  v_cvt_pk_bf16_f32 v133, v34, v35
  v_cvt_pk_bf16_f32 v134, v36, v37
  v_cvt_pk_bf16_f32 v135, v38, v39
  v_cvt_pk_bf16_f32 v136, v40, v41
  v_cvt_pk_bf16_f32 v137, v42, v43
  s_waitcnt vmcnt(8)
  v_mfma_f32_32x32x16_bf16 v[64:79], v[208:211], v[128:131], 0
  s_add_u32 s29, s19, 50335744
  buffer_load_dwordx4 v[160:163], v21, s[4:7], s29 offen offset:0 sc1
  v_mfma_f32_32x32x16_bf16 v[64:79], v[212:215], v[132:135], v[64:79]
  v_mfma_f32_32x32x8_bf16 v[64:79], v[56:57], v[136:137], v[64:79]
  v_mfma_f32_32x32x16_bf16 v[80:95], v[216:219], v[128:131], 0
  buffer_load_dwordx4 v[164:167], v21, s[4:7], s29 offen offset:1024 sc1
  v_mfma_f32_32x32x16_bf16 v[80:95], v[220:223], v[132:135], v[80:95]
  v_cvt_pk_bf16_f32 v24, v64, v65
  v_cvt_pk_bf16_f32 v25, v66, v67
  v_cvt_pk_bf16_f32 v26, v68, v69
  v_cvt_pk_bf16_f32 v27, v70, v71
  v_mfma_f32_32x32x8_bf16 v[80:95], v[58:59], v[136:137], v[80:95]
  ds_write_b128 v3, v[24:27] offset:0
  v_cvt_pk_bf16_f32 v28, v72, v73
  v_cvt_pk_bf16_f32 v29, v74, v75
  v_cvt_pk_bf16_f32 v30, v76, v77
  v_cvt_pk_bf16_f32 v31, v78, v79
  v_mfma_f32_32x32x16_bf16 v[96:111], v[224:227], v[128:131], 0
  ds_write_b128 v3, v[28:31] offset:1024
  buffer_load_dwordx4 v[168:171], v21, s[4:7], s29 offen offset:2048 sc1
  v_mfma_f32_32x32x16_bf16 v[96:111], v[228:231], v[132:135], v[96:111]
  v_cvt_pk_bf16_f32 v32, v80, v81
  v_cvt_pk_bf16_f32 v33, v82, v83
  v_cvt_pk_bf16_f32 v34, v84, v85
  v_cvt_pk_bf16_f32 v35, v86, v87
  v_mfma_f32_32x32x8_bf16 v[96:111], v[60:61], v[136:137], v[96:111]
  ds_write_b128 v3, v[32:35] offset:2048
  v_cvt_pk_bf16_f32 v36, v88, v89
  v_cvt_pk_bf16_f32 v37, v90, v91
  v_cvt_pk_bf16_f32 v38, v92, v93
  v_cvt_pk_bf16_f32 v39, v94, v95
  v_mfma_f32_32x32x16_bf16 v[112:127], v[232:235], v[128:131], 0
  ds_write_b128 v3, v[36:39] offset:3072
  buffer_load_dwordx4 v[172:175], v21, s[4:7], s29 offen offset:3072 sc1
  v_mfma_f32_32x32x16_bf16 v[112:127], v[236:239], v[132:135], v[112:127]
  v_cvt_pk_bf16_f32 v40, v96, v97
  v_cvt_pk_bf16_f32 v41, v98, v99
  v_cvt_pk_bf16_f32 v42, v100, v101
  v_cvt_pk_bf16_f32 v43, v102, v103
  v_mfma_f32_32x32x8_bf16 v[112:127], v[62:63], v[136:137], v[112:127]
  ds_write_b128 v3, v[40:43] offset:4096
  v_cvt_pk_bf16_f32 v44, v104, v105
  v_cvt_pk_bf16_f32 v45, v106, v107
  v_cvt_pk_bf16_f32 v46, v108, v109
  v_cvt_pk_bf16_f32 v47, v110, v111
  ds_write_b128 v3, v[44:47] offset:5120
  s_nop 5
  v_cvt_pk_bf16_f32 v48, v112, v113
  v_cvt_pk_bf16_f32 v49, v114, v115
  v_cvt_pk_bf16_f32 v50, v116, v117
  v_cvt_pk_bf16_f32 v51, v118, v119
  ds_write_b128 v3, v[48:51] offset:6144
  v_cvt_pk_bf16_f32 v52, v120, v121
  v_cvt_pk_bf16_f32 v53, v122, v123
  v_cvt_pk_bf16_f32 v54, v124, v125
  v_cvt_pk_bf16_f32 v55, v126, v127
  ds_write_b128 v3, v[52:55] offset:7168
  s_waitcnt vmcnt(8)
  s_waitcnt lgkmcnt(0)
  s_barrier
  ds_read_b128 v[24:27], v8 offset:0
  ds_read_b128 v[28:31], v9 offset:0
  ds_read_b128 v[32:35], v10 offset:0
  ds_read_b128 v[36:39], v11 offset:0
  ds_read_b128 v[40:43], v12 offset:0
  ds_read_b128 v[44:47], v13 offset:0
  v_readfirstlane_b32 s53, v23
  v_mov_b32 v16, s30
  v_min_u32 v17, 1, v0
  v_lshlrev_b32 v17, 30, v17
  buffer_store_dword v16, v17, s[4:7], s31 offen sc1
  s_add_u32 s30, s30, 1
  s_add_u32 s52, s52, 2
  s_cmp_ge_u32 s53, s52
  s_cselect_b32 s24, 1, 0
  buffer_load_dword v23, off, s[4:7], s54 sc1
  s_cmp_eq_u32 s24, 0
  s_cbranch_scc1 F_nopre_71
  s_mov_b32 m0, s25
  s_nop 0
  buffer_load_dwordx4 v2, s[4:7], s20 offen offset:0 sc1 lds
  buffer_load_dwordx4 v2, s[4:7], s20 offen offset:1152 sc1 lds
  buffer_load_dwordx2 v[56:57], v5, s[4:7], s20 offen offset:2304 sc1
  buffer_load_dwordx2 v[58:59], v5, s[4:7], s20 offen offset:2560 sc1
  buffer_load_dwordx2 v[60:61], v5, s[4:7], s20 offen offset:2816 sc1
  buffer_load_dwordx2 v[62:63], v5, s[4:7], s20 offen offset:3072 sc1
F_nopre_71:
  s_waitcnt lgkmcnt(5)
  v_mfma_f32_32x32x16_bf16 v[64:79], a[0:3], v[24:27], 0
  s_add_u32 s28, s19, 67108864
  ds_read_b128 v[48:51], v14 offset:0
  v_mfma_f32_32x32x16_bf16 v[80:95], a[4:7], v[24:27], 0
  s_waitcnt lgkmcnt(5)
  v_mfma_f32_32x32x16_bf16 v[64:79], a[8:11], v[28:31], v[64:79]
  ds_read_b128 v[52:55], v15 offset:0
  v_mfma_f32_32x32x16_bf16 v[80:95], a[12:15], v[28:31], v[80:95]
  s_waitcnt lgkmcnt(5)
  buffer_load_dwordx4 v[176:179], v21, s[4:7], s28 offen offset:0 sc1
  v_mfma_f32_32x32x16_bf16 v[64:79], a[16:19], v[32:35], v[64:79]
  ds_read_b128 v[24:27], v8 offset:8192
  v_mfma_f32_32x32x16_bf16 v[80:95], a[20:23], v[32:35], v[80:95]
  s_waitcnt lgkmcnt(5)
  v_mfma_f32_32x32x16_bf16 v[64:79], a[24:27], v[36:39], v[64:79]
  ds_read_b128 v[28:31], v9 offset:8192
  v_mfma_f32_32x32x16_bf16 v[80:95], a[28:31], v[36:39], v[80:95]
  s_waitcnt lgkmcnt(5)
  buffer_load_dwordx4 v[180:183], v21, s[4:7], s28 offen offset:1024 sc1
  v_mfma_f32_32x32x16_bf16 v[64:79], a[32:35], v[40:43], v[64:79]
  ds_read_b128 v[32:35], v10 offset:8192
  v_mfma_f32_32x32x16_bf16 v[80:95], a[36:39], v[40:43], v[80:95]
  s_waitcnt lgkmcnt(5)
  v_mfma_f32_32x32x16_bf16 v[64:79], a[40:43], v[44:47], v[64:79]
  ds_read_b128 v[36:39], v11 offset:8192
  v_mfma_f32_32x32x16_bf16 v[80:95], a[44:47], v[44:47], v[80:95]
  s_waitcnt lgkmcnt(5)
  buffer_load_dwordx4 v[184:187], v21, s[4:7], s28 offen offset:2048 sc1
  v_mfma_f32_32x32x16_bf16 v[64:79], a[48:51], v[48:51], v[64:79]
  ds_read_b128 v[40:43], v12 offset:8192
  v_mfma_f32_32x32x16_bf16 v[80:95], a[52:55], v[48:51], v[80:95]
  s_waitcnt lgkmcnt(5)
  v_mfma_f32_32x32x16_bf16 v[64:79], a[56:59], v[52:55], v[64:79]
  ds_read_b128 v[44:47], v13 offset:8192
  v_mfma_f32_32x32x16_bf16 v[80:95], a[60:63], v[52:55], v[80:95]
  s_waitcnt lgkmcnt(5)
  buffer_load_dwordx4 v[188:191], v21, s[4:7], s28 offen offset:3072 sc1
  v_mfma_f32_32x32x16_bf16 v[64:79], a[64:67], v[24:27], v[64:79]
  s_add_u32 s29, s19, 67112960
  ds_read_b128 v[48:51], v14 offset:8192
  v_mfma_f32_32x32x16_bf16 v[80:95], a[68:71], v[24:27], v[80:95]
  s_waitcnt lgkmcnt(5)
  v_mfma_f32_32x32x16_bf16 v[64:79], a[72:75], v[28:31], v[64:79]
  ds_read_b128 v[52:55], v15 offset:8192
  v_mfma_f32_32x32x16_bf16 v[80:95], a[76:79], v[28:31], v[80:95]
  s_waitcnt lgkmcnt(5)
  buffer_load_dwordx4 v[192:195], v21, s[4:7], s29 offen offset:0 sc1
  v_mfma_f32_32x32x16_bf16 v[64:79], a[80:83], v[32:35], v[64:79]
  ds_read_b128 v[24:27], v8 offset:16384
  v_mfma_f32_32x32x16_bf16 v[80:95], a[84:87], v[32:35], v[80:95]
  s_waitcnt lgkmcnt(5)
  v_mfma_f32_32x32x16_bf16 v[64:79], a[88:91], v[36:39], v[64:79]
  ds_read_b128 v[28:31], v9 offset:16384
  v_mfma_f32_32x32x16_bf16 v[80:95], a[92:95], v[36:39], v[80:95]
  s_waitcnt lgkmcnt(5)
  buffer_load_dwordx4 v[196:199], v21, s[4:7], s29 offen offset:1024 sc1
  v_mfma_f32_32x32x16_bf16 v[64:79], a[96:99], v[40:43], v[64:79]
  ds_read_b128 v[32:35], v10 offset:16384
  v_mfma_f32_32x32x16_bf16 v[80:95], a[100:103], v[40:43], v[80:95]
  s_waitcnt lgkmcnt(5)
  v_mfma_f32_32x32x16_bf16 v[64:79], a[104:107], v[44:47], v[64:79]
  ds_read_b128 v[36:39], v11 offset:16384
  v_mfma_f32_32x32x16_bf16 v[80:95], a[108:111], v[44:47], v[80:95]
  s_waitcnt lgkmcnt(5)
  buffer_load_dwordx4 v[200:203], v21, s[4:7], s29 offen offset:2048 sc1
  v_mfma_f32_32x32x16_bf16 v[64:79], a[112:115], v[48:51], v[64:79]
  ds_read_b128 v[40:43], v12 offset:16384
  v_mfma_f32_32x32x16_bf16 v[80:95], a[116:119], v[48:51], v[80:95]
  s_waitcnt lgkmcnt(5)
  v_mfma_f32_32x32x16_bf16 v[64:79], a[120:123], v[52:55], v[64:79]
  ds_read_b128 v[44:47], v13 offset:16384
  v_mfma_f32_32x32x16_bf16 v[80:95], a[124:127], v[52:55], v[80:95]
  s_waitcnt lgkmcnt(5)
  buffer_load_dwordx4 v[204:207], v21, s[4:7], s29 offen offset:3072 sc1
  v_mfma_f32_32x32x16_bf16 v[64:79], a[128:131], v[24:27], v[64:79]
  s_add_u32 s28, s19, 83886080
  ds_read_b128 v[48:51], v14 offset:16384
  v_mfma_f32_32x32x16_bf16 v[80:95], a[132:135], v[24:27], v[80:95]
  s_waitcnt lgkmcnt(5)
  v_mfma_f32_32x32x16_bf16 v[64:79], a[136:139], v[28:31], v[64:79]
  ds_read_b128 v[52:55], v15 offset:16384
  v_mfma_f32_32x32x16_bf16 v[80:95], a[140:143], v[28:31], v[80:95]
  s_waitcnt lgkmcnt(5)
  buffer_load_dwordx4 v[208:211], v21, s[4:7], s28 offen offset:0 sc1
  v_mfma_f32_32x32x16_bf16 v[64:79], a[144:147], v[32:35], v[64:79]
  ds_read_b128 v[24:27], v8 offset:24576
  v_mfma_f32_32x32x16_bf16 v[80:95], a[148:151], v[32:35], v[80:95]
  s_waitcnt lgkmcnt(5)
  v_mfma_f32_32x32x16_bf16 v[64:79], a[152:155], v[36:39], v[64:79]
  ds_read_b128 v[28:31], v9 offset:24576
  v_mfma_f32_32x32x16_bf16 v[80:95], a[156:159], v[36:39], v[80:95]
  s_waitcnt lgkmcnt(5)
  buffer_load_dwordx4 v[212:215], v21, s[4:7], s28 offen offset:1024 sc1
  v_mfma_f32_32x32x16_bf16 v[64:79], a[160:163], v[40:43], v[64:79]
  ds_read_b128 v[32:35], v10 offset:24576
  v_mfma_f32_32x32x16_bf16 v[80:95], a[164:167], v[40:43], v[80:95]
  s_waitcnt lgkmcnt(5)
  v_mfma_f32_32x32x16_bf16 v[64:79], a[168:171], v[44:47], v[64:79]
  ds_read_b128 v[36:39], v11 offset:24576
  v_mfma_f32_32x32x16_bf16 v[80:95], a[172:175], v[44:47], v[80:95]
  s_waitcnt lgkmcnt(5)
  buffer_load_dwordx4 v[216:219], v21, s[4:7], s28 offen offset:2048 sc1
  v_mfma_f32_32x32x16_bf16 v[64:79], a[176:179], v[48:51], v[64:79]
  ds_read_b128 v[40:43], v12 offset:24576
  v_mfma_f32_32x32x16_bf16 v[80:95], a[180:183], v[48:51], v[80:95]
  s_waitcnt lgkmcnt(5)
  v_mfma_f32_32x32x16_bf16 v[64:79], a[184:187], v[52:55], v[64:79]
  ds_read_b128 v[44:47], v13 offset:24576
  v_mfma_f32_32x32x16_bf16 v[80:95], a[188:191], v[52:55], v[80:95]
  s_waitcnt lgkmcnt(5)
  buffer_load_dwordx4 v[220:223], v21, s[4:7], s28 offen offset:3072 sc1
  v_mfma_f32_32x32x16_bf16 v[64:79], a[192:195], v[24:27], v[64:79]
  s_add_u32 s29, s19, 83890176
  ds_read_b128 v[48:51], v14 offset:24576
  v_mfma_f32_32x32x16_bf16 v[80:95], a[196:199], v[24:27], v[80:95]
  s_waitcnt lgkmcnt(5)
  v_mfma_f32_32x32x16_bf16 v[64:79], a[200:203], v[28:31], v[64:79]
  ds_read_b128 v[52:55], v15 offset:24576
  v_mfma_f32_32x32x16_bf16 v[80:95], a[204:207], v[28:31], v[80:95]
  s_waitcnt lgkmcnt(5)
  buffer_load_dwordx4 v[224:227], v21, s[4:7], s29 offen offset:0 sc1
  v_mfma_f32_32x32x16_bf16 v[64:79], a[208:211], v[32:35], v[64:79]
  v_mfma_f32_32x32x16_bf16 v[80:95], a[212:215], v[32:35], v[80:95]
  s_waitcnt lgkmcnt(4)
  v_mfma_f32_32x32x16_bf16 v[64:79], a[216:219], v[36:39], v[64:79]
  v_xor_b32 v8, 0x8000, v8
  v_mfma_f32_32x32x16_bf16 v[80:95], a[220:223], v[36:39], v[80:95]
  s_waitcnt lgkmcnt(3)
  buffer_load_dwordx4 v[228:231], v21, s[4:7], s29 offen offset:1024 sc1
  v_xor_b32 v9, 0x8000, v9
  v_mfma_f32_32x32x16_bf16 v[64:79], a[224:227], v[40:43], v[64:79]
  v_xor_b32 v10, 0x8000, v10
  v_mfma_f32_32x32x16_bf16 v[80:95], a[228:231], v[40:43], v[80:95]
  s_waitcnt lgkmcnt(2)
  v_xor_b32 v11, 0x8000, v11
  v_mfma_f32_32x32x16_bf16 v[64:79], a[232:235], v[44:47], v[64:79]
  v_xor_b32 v12, 0x8000, v12
  v_mfma_f32_32x32x16_bf16 v[80:95], a[236:239], v[44:47], v[80:95]
  s_waitcnt lgkmcnt(1)
  buffer_load_dwordx4 v[232:235], v21, s[4:7], s29 offen offset:2048 sc1
  v_xor_b32 v13, 0x8000, v13
  v_mfma_f32_32x32x16_bf16 v[64:79], a[240:243], v[48:51], v[64:79]
  v_xor_b32 v14, 0x8000, v14
  v_mfma_f32_32x32x16_bf16 v[80:95], a[244:247], v[48:51], v[80:95]
  s_waitcnt lgkmcnt(0)
  v_xor_b32 v15, 0x8000, v15
  v_mfma_f32_32x32x16_bf16 v[64:79], a[248:251], v[52:55], v[64:79]
  v_xor_b32 v3, 0x8000, v3
  v_mfma_f32_32x32x16_bf16 v[80:95], a[252:255], v[52:55], v[80:95]
  buffer_load_dwordx4 v[236:239], v21, s[4:7], s29 offen offset:3072 sc1
  s_cmp_gt_u32 s23, 0
  s_cbranch_scc1 F_top_58
  s_nop 2
  v_cvt_pk_bf16_f32 v128, v64, v65
  v_cvt_pk_bf16_f32 v129, v66, v67
  v_cvt_pk_bf16_f32 v130, v68, v69
  v_cvt_pk_bf16_f32 v131, v70, v71
  buffer_store_dwordx4 v[128:131], v22, s[4:7], s21 offen offset:0 sc1
  v_cvt_pk_bf16_f32 v132, v72, v73
  v_cvt_pk_bf16_f32 v133, v74, v75
  v_cvt_pk_bf16_f32 v134, v76, v77
  v_cvt_pk_bf16_f32 v135, v78, v79
  buffer_store_dwordx4 v[132:135], v22, s[4:7], s21 offen offset:1024 sc1
  v_cvt_pk_bf16_f32 v136, v80, v81
  v_cvt_pk_bf16_f32 v137, v82, v83
  v_cvt_pk_bf16_f32 v138, v84, v85
  v_cvt_pk_bf16_f32 v139, v86, v87
  buffer_store_dwordx4 v[136:139], v22, s[4:7], s21 offen offset:2048 sc1
  v_cvt_pk_bf16_f32 v140, v88, v89
  v_cvt_pk_bf16_f32 v141, v90, v91
  v_cvt_pk_bf16_f32 v142, v92, v93
  v_cvt_pk_bf16_f32 v143, v94, v95
  buffer_store_dwordx4 v[140:143], v22, s[4:7], s21 offen offset:3072 sc1
  s_waitcnt vmcnt(0) lgkmcnt(0)
  s_barrier
  v_mov_b32 v144, s30
  v_min_u32 v145, 1, v0
  v_lshlrev_b32 v145, 30, v145
  buffer_store_dword v144, v145, s[4:7], s31 offen sc1
  s_branch M_done
M_team:
  s_mov_b32 s12, s77
  s_load_dwordx4 s[60:63], s[0:1], 64
  s_load_dwordx4 s[64:67], s[0:1], 80
  s_load_dwordx4 s[68:71], s[0:1], 120
  s_load_dwordx2 s[72:73], s[0:1], 56
  v_lshrrev_b32 v1, 6, v0
  v_and_b32 v20, 63, v0
  v_readfirstlane_b32 s13, v1
  s_waitcnt lgkmcnt(0)
  s_mov_b32 s8, s60
  s_and_b32 s9, s61, 0xffff
  s_mov_b32 s10, 0x400000
  s_mov_b32 s11, 0x20000
  s_mov_b32 s40, s62
  s_and_b32 s41, s63, 0xffff
  s_mov_b32 s42, 0x400000
  s_mov_b32 s43, 0x20000
  s_mov_b32 s44, s64
  s_and_b32 s45, s65, 0xffff
  s_mov_b32 s46, 0x400000
  s_mov_b32 s47, 0x20000
  s_mov_b32 s48, s66
  s_and_b32 s49, s67, 0xffff
  s_mov_b32 s50, 0x400000
  s_mov_b32 s51, 0x20000
  s_mov_b32 s4, s70
  s_and_b32 s5, s71, 0xffff
  s_mov_b32 s6, 0x10000000
  s_mov_b32 s7, 0x20000
  s_mov_b32 s76, s72
  s_and_b32 s77, s73, 0xffff
  s_mov_b32 s78, 0x2000
  s_mov_b32 s79, 0x20000
  s_mov_b32 s72, s68
  s_and_b32 s73, s69, 0xffff
  s_mov_b32 s74, 0x100
  s_mov_b32 s75, 0x20000
  s_mov_b64 s[52:53], s[68:69]
  s_mov_b64 s[58:59], s[70:71]
  s_mul_i32 s99, s12, 896
  s_add_u32 s99, s99, 148898048
  s_lshl_b32 s15, s12, 7
  s_add_u32 s15, s15, 148926464
  v_lshrrev_b32 v21, 4, v20
  v_and_b32 v22, 15, v20
  v_and_b32 v23, 1, v21
  v_lshrrev_b32 v24, 1, v21
  v_lshlrev_b32 v2, 4, v20
  s_lshl_b32 s36, s13, 10
  v_add_u32 v59, s36, v2
  s_lshl_b32 s37, s13, 15
  s_add_u32 s37, s37, 32768
  v_add_u32 v4, s37, v2
  v_lshrrev_b32 v25, 2, v20
  v_lshlrev_b32 v25, 13, v25
  v_and_b32 v1, 3, v20
  v_lshl_add_u32 v25, v1, 4, v25
  s_lshl_b32 s36, s13, 6
  s_lshl_b32 s38, s12, 8
  s_add_u32 s36, s36, s38
  v_add_u32 v25, s36, v25
  v_lshrrev_b32 v26, 3, v20
  v_lshlrev_b32 v26, 10, v26
  v_and_b32 v1, 7, v20
  v_lshl_add_u32 v26, v1, 4, v26
  s_lshl_b32 s36, s13, 7
  s_lshl_b32 s38, s12, 17
  s_add_u32 s36, s36, s38
  v_add_u32 v26, s36, v26
  v_bfe_u32 v29, v20, 2, 1
  v_bfe_u32 v30, v20, 3, 1
  v_and_b32 v31, 3, v20
  v_lshl_add_u32 v27, v21, 2, v29
  v_lshlrev_b32 v27, 6, v27
  v_lshl_add_u32 v27, v30, 5, v27
  v_lshl_add_u32 v27, v31, 3, v27
  v_add_u32 v27, s37, v27
  v_xor_b32 v36, 1, v30
  v_lshl_add_u32 v36, v36, 11, v27
  v_lshl_add_u32 v27, v30, 11, v27
  v_lshl_add_u32 v28, v23, 2, v24
  v_lshl_add_u32 v28, v28, 2, v29
  v_lshlrev_b32 v28, 7, v28
  v_lshl_add_u32 v28, v30, 6, v28
  v_lshl_add_u32 v28, v31, 4, v28
  v_add_u32 v28, s37, v28
  s_mov_b32 s39, s37
  s_xor_b32 s36, s13, 0
  s_lshl_b32 s36, s36, 15
  s_add_u32 m0, s39, 0
  s_add_u32 s37, s36, 0
  buffer_load_dwordx4 v26, s[48:51], s37 offen lds
  s_add_u32 m0, s39, 1024
  s_add_u32 s37, s36, 8192
  buffer_load_dwordx4 v26, s[48:51], s37 offen lds
  s_add_u32 m0, s39, 2048
  s_add_u32 s37, s36, 16384
  buffer_load_dwordx4 v26, s[48:51], s37 offen lds
  s_add_u32 m0, s39, 3072
  s_add_u32 s37, s36, 24576
  buffer_load_dwordx4 v26, s[48:51], s37 offen lds
  s_xor_b32 s36, s13, 0
  s_lshl_b32 s36, s36, 15
  s_add_u32 m0, s39, 4096
  s_add_u32 s37, s36, 512
  buffer_load_dwordx4 v26, s[48:51], s37 offen lds
  s_add_u32 m0, s39, 5120
  s_add_u32 s37, s36, 8704
  buffer_load_dwordx4 v26, s[48:51], s37 offen lds
  s_add_u32 m0, s39, 6144
  s_add_u32 s37, s36, 16896
  buffer_load_dwordx4 v26, s[48:51], s37 offen lds
  s_add_u32 m0, s39, 7168
  s_add_u32 s37, s36, 25088
  buffer_load_dwordx4 v26, s[48:51], s37 offen lds
  v_mov_b32 v0, 0x4444
  v_mov_b32 v1, 0xeeee
  v_cmp_lt_u32 vcc, 7, v22
  s_nop 1
  v_cndmask_b32 v32, v0, v1, vcc
  v_mov_b32 v0, v32
  v_and_b32 v32, 7, v20
  v_lshlrev_b32 v32, 4, v32
  v_lshl_add_u32 v11, v21, 7, v32
  v_xor_b32 v1, 128, v2
  v_lshl_add_u32 v33, v24, 4, v22
  s_lshl_b32 s36, s13, 5
  v_add_u32 v33, s36, v33
  v_lshlrev_b32 v33, 3, v33
  v_mul_u32_u24 v34, 1152, v23
  v_add_u32 v5, v33, v34
  v_bfe_u32 v33, v20, 2, 2
  v_lshl_add_u32 v33, v23, 2, v33
  v_lshl_add_u32 v33, v24, 4, v33
  v_lshlrev_b32 v33, 3, v33
  v_and_b32 v34, 1, v20
  v_mul_u32_u24 v34, 1152, v34
  v_add_u32 v6, v33, v34
  s_lshl_b32 s36, s13, 3
  v_lshrrev_b32 v33, 3, v20
  v_add_u32 v33, s36, v33
  v_mul_u32_u24 v34, 0, v33
  v_add_u32 v34, s12, v34
  v_and_b32 v34, 31, v34
  v_lshrrev_b32 v37, 1, v32
  v_lshl_add_u32 v33, v33, 13, v37
  v_lshl_add_u32 v7, v34, 7, v33
  v_and_b32 v37, 1, v20
  v_bfe_u32 v38, v20, 1, 1
  v_lshl_add_u32 v37, v29, 1, v37
  s_lshr_b32 s36, s12, 3
  s_lshl_b32 s36, s36, 10
  s_and_b32 s37, s12, 1
  s_lshl_b32 s37, s37, 9
  s_add_u32 s36, s36, s37
  s_and_b32 s37, s12, 6
  s_lshl_b32 s37, s37, 5
  s_add_u32 s36, s36, s37
  v_lshlrev_b32 v33, 4, v21
  v_lshl_add_u32 v33, v37, 2, v33
  v_lshl_add_u32 v33, v38, 8, v33
  v_lshl_add_u32 v33, v30, 30, v33
  v_add_u32 v8, s36, v33
  s_lshr_b32 s36, s12, 2
  s_lshl_b32 s36, s36, 6
  s_and_b32 s37, s12, 1
  s_lshl_b32 s37, s37, 5
  s_add_u32 s36, s36, s37
  s_and_b32 s37, s12, 2
  s_lshl_b32 s37, s37, 11
  s_add_u32 s36, s36, s37
  v_lshlrev_b32 v35, 10, v21
  v_lshl_add_u32 v35, v37, 2, v35
  v_lshl_add_u32 v35, v38, 4, v35
  v_add_u32 v35, s36, v35
  buffer_load_ushort v44, v35, s[76:79], 0 offen offset:0
  buffer_load_ushort v45, v35, s[76:79], 0 offen offset:2
  buffer_load_ushort v46, v35, s[76:79], 0 offen offset:512
  buffer_load_ushort v47, v35, s[76:79], 0 offen offset:514
  v_lshlrev_b32 v33, 4, v29
  v_mov_b32 v34, 0x3f80
  v_lshlrev_b32 v33, v33, v34
  v_and_b32 v34, 1, v20
  v_lshl_add_u32 v34, v34, 1, v30
  v_cmp_eq_u32 vcc, 0, v34
  s_nop 1
  v_cndmask_b32 v48, 0, v33, vcc
  v_cmp_eq_u32 vcc, 1, v34
  s_nop 1
  v_cndmask_b32 v49, 0, v33, vcc
  v_cmp_eq_u32 vcc, 2, v34
  s_nop 1
  v_cndmask_b32 v50, 0, v33, vcc
  v_cmp_eq_u32 vcc, 3, v34
  s_nop 1
  v_cndmask_b32 v51, 0, v33, vcc
  ds_write_b128 v2, v[48:51] offset:31232
  v_lshlrev_b32 v33, 9, v21
  s_lshl_b32 s36, s13, 11
  v_add_u32 v33, s36, v33
  v_lshl_add_u32 v10, v22, 4, v33
  v_lshl_add_u32 v33, v30, 8, v33
  v_add_u32 v9, v33, v32
  v_mov_b32 v12, 0x3f803f80
  v_mov_b32 v13, 0x3f803f80
  v_mov_b32 v14, 0x3f803f80
  v_mov_b32 v15, 0x3f803f80
  v_and_b32 v33, 1, v20
  v_mul_u32_u24 v33, 128, v33
  v_min_u32 v34, 1, v20
  v_lshlrev_b32 v34, 30, v34
  s_cmp_eq_u32 s13, 3
  s_cselect_b64 vcc, -1, 0
  v_cndmask_b32 v3, v34, v33, vcc
  v_mov_b64 v[60:61], 0
  v_mov_b32 v62, 32256
  ds_write_b64 v62, v[60:61]
  s_mov_b32 s16, 0
  s_mov_b32 s17, -1
  s_mov_b32 s18, 0x3e0293ee
  s_mov_b32 s54, 0x2f800000
  s_mov_b32 s55, 0x28000000
  s_lshl_b32 s36, s13, 10
  s_add_u32 s31, s36, 8192
  s_add_u32 s32, s36, 12160
  s_add_u32 s33, s36, 16384
  s_add_u32 s34, s36, 20224
  s_lshl_b32 s36, s12, 19
  s_add_u32 s27, s36, 67108864
  s_add_u32 s28, s36, 83886080
  s_mul_i32 s36, s12, 4608
  s_add_u32 s29, s36, 134217728
  s_lshl_b32 s36, s12, 13
  s_add_u32 s22, s36, 144703488
  s_add_u32 s23, s36, 144707584
  s_mov_b32 s20, 144703488
  s_mov_b32 s21, 144707584
  v_mov_b32 v40, -1
  v_mov_b32 v41, -1
  v_mov_b32 v42, -1
  v_mov_b32 v43, -1
  s_lshl_b32 s36, s13, 13
  s_add_u32 s36, s36, 145752064
  s_add_u32 s37, s36, 4096
  buffer_store_dwordx4 v[40:43], v59, s[4:7], s22 offen sc1
  buffer_store_dwordx4 v[40:43], v59, s[4:7], s23 offen sc1
  buffer_store_dword v40, v8, s[4:7], s36 offen sc1
  buffer_store_dword v40, v8, s[4:7], s37 offen sc1
  v_mov_b32 v52, 0
  v_min_u32 v53, 1, v59
  v_lshlrev_b32 v53, 30, v53
  buffer_store_dword v52, v53, s[4:7], s15 offen sc1
  s_xor_b32 s36, s13, 1
  s_lshl_b32 s36, s36, 15
  s_add_u32 m0, s39, 8192
  s_add_u32 s37, s36, 0
  buffer_load_dwordx4 v26, s[48:51], s37 offen lds
  s_add_u32 m0, s39, 9216
  s_add_u32 s37, s36, 8192
  buffer_load_dwordx4 v26, s[48:51], s37 offen lds
  s_add_u32 m0, s39, 10240
  s_add_u32 s37, s36, 16384
  buffer_load_dwordx4 v26, s[48:51], s37 offen lds
  s_add_u32 m0, s39, 11264
  s_add_u32 s37, s36, 24576
  buffer_load_dwordx4 v26, s[48:51], s37 offen lds
  s_xor_b32 s36, s13, 1
  s_lshl_b32 s36, s36, 15
  s_add_u32 m0, s39, 12288
  s_add_u32 s37, s36, 512
  buffer_load_dwordx4 v26, s[48:51], s37 offen lds
  s_add_u32 m0, s39, 13312
  s_add_u32 s37, s36, 8704
  buffer_load_dwordx4 v26, s[48:51], s37 offen lds
  s_add_u32 m0, s39, 14336
  s_add_u32 s37, s36, 16896
  buffer_load_dwordx4 v26, s[48:51], s37 offen lds
  s_add_u32 m0, s39, 15360
  s_add_u32 s37, s36, 25088
  buffer_load_dwordx4 v26, s[48:51], s37 offen lds
  s_waitcnt vmcnt(21)
  ds_read_b64_tr_b16 a[160:161], v28 offset:0
  ds_read_b64_tr_b16 a[162:163], v28 offset:256
  ds_read_b64_tr_b16 a[164:165], v28 offset:1024
  ds_read_b64_tr_b16 a[166:167], v28 offset:1280
  ds_read_b64_tr_b16 a[168:169], v28 offset:8
  ds_read_b64_tr_b16 a[170:171], v28 offset:264
  ds_read_b64_tr_b16 a[172:173], v28 offset:1032
  ds_read_b64_tr_b16 a[174:175], v28 offset:1288
  s_waitcnt lgkmcnt(0)
  s_xor_b32 s36, s13, 2
  s_lshl_b32 s36, s36, 15
  s_add_u32 m0, s39, 0
  s_add_u32 s37, s36, 0
  buffer_load_dwordx4 v26, s[48:51], s37 offen lds
  s_add_u32 m0, s39, 1024
  s_add_u32 s37, s36, 8192
  buffer_load_dwordx4 v26, s[48:51], s37 offen lds
  s_add_u32 m0, s39, 2048
  s_add_u32 s37, s36, 16384
  buffer_load_dwordx4 v26, s[48:51], s37 offen lds
  s_add_u32 m0, s39, 3072
  s_add_u32 s37, s36, 24576
  buffer_load_dwordx4 v26, s[48:51], s37 offen lds
  s_waitcnt vmcnt(21)
  ds_read_b64_tr_b16 a[176:177], v28 offset:4096
  ds_read_b64_tr_b16 a[178:179], v28 offset:4352
  ds_read_b64_tr_b16 a[180:181], v28 offset:5120
  ds_read_b64_tr_b16 a[182:183], v28 offset:5376
  ds_read_b64_tr_b16 a[184:185], v28 offset:4104
  ds_read_b64_tr_b16 a[186:187], v28 offset:4360
  ds_read_b64_tr_b16 a[188:189], v28 offset:5128
  ds_read_b64_tr_b16 a[190:191], v28 offset:5384
  s_waitcnt lgkmcnt(0)
  s_xor_b32 s36, s13, 3
  s_lshl_b32 s36, s36, 15
  s_add_u32 m0, s39, 4096
  s_add_u32 s37, s36, 0
  buffer_load_dwordx4 v26, s[48:51], s37 offen lds
  s_add_u32 m0, s39, 5120
  s_add_u32 s37, s36, 8192
  buffer_load_dwordx4 v26, s[48:51], s37 offen lds
  s_add_u32 m0, s39, 6144
  s_add_u32 s37, s36, 16384
  buffer_load_dwordx4 v26, s[48:51], s37 offen lds
  s_add_u32 m0, s39, 7168
  s_add_u32 s37, s36, 24576
  buffer_load_dwordx4 v26, s[48:51], s37 offen lds
  s_waitcnt vmcnt(12)
  ds_read_b64_tr_b16 a[192:193], v28 offset:8192
  ds_read_b64_tr_b16 a[194:195], v28 offset:8448
  ds_read_b64_tr_b16 a[196:197], v28 offset:9216
  ds_read_b64_tr_b16 a[198:199], v28 offset:9472
  ds_read_b64_tr_b16 a[200:201], v28 offset:8200
  ds_read_b64_tr_b16 a[202:203], v28 offset:8456
  ds_read_b64_tr_b16 a[204:205], v28 offset:9224
  ds_read_b64_tr_b16 a[206:207], v28 offset:9480
  s_waitcnt lgkmcnt(0)
  s_xor_b32 s36, s13, 2
  s_lshl_b32 s36, s36, 19
  s_add_u32 m0, s39, 8192
  s_add_u32 s37, s36, 0
  buffer_load_dwordx4 v25, s[8:11], s37 offen lds
  s_add_u32 m0, s39, 9216
  s_add_u32 s37, s36, 131072
  buffer_load_dwordx4 v25, s[8:11], s37 offen lds
  s_add_u32 m0, s39, 10240
  s_add_u32 s37, s36, 262144
  buffer_load_dwordx4 v25, s[8:11], s37 offen lds
  s_add_u32 m0, s39, 11264
  s_add_u32 s37, s36, 393216
  buffer_load_dwordx4 v25, s[8:11], s37 offen lds
  s_barrier
  s_cmp_lg_u32 s13, 0
  s_cbranch_scc1 T_arm_72
  s_getreg_b32 s36, hwreg(HW_REG_XCC_ID, 0, 3)
  s_lshl_b32 s36, s36, 3
  s_lshl_b64 s[60:61], 1, s36
  s_mov_b32 s62, 1
  s_atomic_add_x2 s[60:61], s[52:53], 0
  s_atomic_add s62, s[52:53], 128
  v_lshl_or_b32 v44, v45, 16, v44
  v_lshl_or_b32 v46, v47, 16, v46
  v_min_u32 v44, -2, v44
  v_min_u32 v46, -2, v46
  s_mov_b32 s36, 145752064
  s_mov_b32 s37, 145756160
  buffer_store_dword v44, v8, s[4:7], s36 offen sc1
  buffer_store_dword v46, v8, s[4:7], s37 offen sc1
T_arm_72:
  s_waitcnt vmcnt(12)
  ds_read_b64_tr_b16 a[208:209], v28 offset:12288
  ds_read_b64_tr_b16 a[210:211], v28 offset:12544
  ds_read_b64_tr_b16 a[212:213], v28 offset:13312
  ds_read_b64_tr_b16 a[214:215], v28 offset:13568
  ds_read_b64_tr_b16 a[216:217], v28 offset:12296
  ds_read_b64_tr_b16 a[218:219], v28 offset:12552
  ds_read_b64_tr_b16 a[220:221], v28 offset:13320
  ds_read_b64_tr_b16 a[222:223], v28 offset:13576
  s_waitcnt lgkmcnt(0)
  s_xor_b32 s36, s13, 3
  s_lshl_b32 s36, s36, 19
  s_add_u32 m0, s39, 12288
  s_add_u32 s37, s36, 0
  buffer_load_dwordx4 v25, s[8:11], s37 offen lds
  s_add_u32 m0, s39, 13312
  s_add_u32 s37, s36, 131072
  buffer_load_dwordx4 v25, s[8:11], s37 offen lds
  s_add_u32 m0, s39, 14336
  s_add_u32 s37, s36, 262144
  buffer_load_dwordx4 v25, s[8:11], s37 offen lds
  s_add_u32 m0, s39, 15360
  s_add_u32 s37, s36, 393216
  buffer_load_dwordx4 v25, s[8:11], s37 offen lds
  s_waitcnt vmcnt(12)
  ds_read_b64_tr_b16 a[224:225], v28 offset:0
  ds_read_b64_tr_b16 a[226:227], v28 offset:256
  ds_read_b64_tr_b16 a[228:229], v28 offset:1024
  ds_read_b64_tr_b16 a[230:231], v28 offset:1280
  ds_read_b64_tr_b16 a[232:233], v28 offset:8
  ds_read_b64_tr_b16 a[234:235], v28 offset:264
  ds_read_b64_tr_b16 a[236:237], v28 offset:1032
  ds_read_b64_tr_b16 a[238:239], v28 offset:1288
  s_waitcnt lgkmcnt(0)
  s_xor_b32 s36, s13, 4
  s_lshl_b32 s36, s36, 19
  s_add_u32 m0, s39, 0
  s_add_u32 s37, s36, 0
  buffer_load_dwordx4 v25, s[8:11], s37 offen lds
  s_add_u32 m0, s39, 1024
  s_add_u32 s37, s36, 131072
  buffer_load_dwordx4 v25, s[8:11], s37 offen lds
  s_add_u32 m0, s39, 2048
  s_add_u32 s37, s36, 262144
  buffer_load_dwordx4 v25, s[8:11], s37 offen lds
  s_add_u32 m0, s39, 3072
  s_add_u32 s37, s36, 393216
  buffer_load_dwordx4 v25, s[8:11], s37 offen lds
  s_waitcnt vmcnt(12)
  ds_read_b64_tr_b16 a[240:241], v28 offset:4096
  ds_read_b64_tr_b16 a[242:243], v28 offset:4352
  ds_read_b64_tr_b16 a[244:245], v28 offset:5120
  ds_read_b64_tr_b16 a[246:247], v28 offset:5376
  ds_read_b64_tr_b16 a[248:249], v28 offset:4104
  ds_read_b64_tr_b16 a[250:251], v28 offset:4360
  ds_read_b64_tr_b16 a[252:253], v28 offset:5128
  ds_read_b64_tr_b16 a[254:255], v28 offset:5384
  s_waitcnt lgkmcnt(0)
  s_xor_b32 s36, s13, 5
  s_lshl_b32 s36, s36, 19
  s_add_u32 m0, s39, 4096
  s_add_u32 s37, s36, 0
  buffer_load_dwordx4 v25, s[8:11], s37 offen lds
  s_add_u32 m0, s39, 5120
  s_add_u32 s37, s36, 131072
  buffer_load_dwordx4 v25, s[8:11], s37 offen lds
  s_add_u32 m0, s39, 6144
  s_add_u32 s37, s36, 262144
  buffer_load_dwordx4 v25, s[8:11], s37 offen lds
  s_add_u32 m0, s39, 7168
  s_add_u32 s37, s36, 393216
  buffer_load_dwordx4 v25, s[8:11], s37 offen lds
  s_waitcnt vmcnt(12)
  ds_read_b64_tr_b16 v[160:161], v27 offset:8192
  ds_read_b64_tr_b16 v[162:163], v27 offset:8320
  ds_read_b64_tr_b16 v[164:165], v27 offset:9216
  ds_read_b64_tr_b16 v[166:167], v27 offset:9344
  ds_read_b64_tr_b16 v[168:169], v36 offset:8192
  ds_read_b64_tr_b16 v[170:171], v36 offset:8320
  ds_read_b64_tr_b16 v[172:173], v36 offset:9216
  ds_read_b64_tr_b16 v[174:175], v36 offset:9344
  s_waitcnt lgkmcnt(0)
  s_xor_b32 s36, s13, 4
  s_lshl_b32 s36, s36, 19
  s_add_u32 m0, s39, 8192
  s_add_u32 s37, s36, 0
  buffer_load_dwordx4 v25, s[40:43], s37 offen lds
  s_add_u32 m0, s39, 9216
  s_add_u32 s37, s36, 131072
  buffer_load_dwordx4 v25, s[40:43], s37 offen lds
  s_add_u32 m0, s39, 10240
  s_add_u32 s37, s36, 262144
  buffer_load_dwordx4 v25, s[40:43], s37 offen lds
  s_add_u32 m0, s39, 11264
  s_add_u32 s37, s36, 393216
  buffer_load_dwordx4 v25, s[40:43], s37 offen lds
  s_waitcnt vmcnt(12)
  ds_read_b64_tr_b16 v[192:193], v27 offset:12288
  ds_read_b64_tr_b16 v[194:195], v27 offset:12416
  ds_read_b64_tr_b16 v[196:197], v27 offset:13312
  ds_read_b64_tr_b16 v[198:199], v27 offset:13440
  ds_read_b64_tr_b16 v[200:201], v36 offset:12288
  ds_read_b64_tr_b16 v[202:203], v36 offset:12416
  ds_read_b64_tr_b16 v[204:205], v36 offset:13312
  ds_read_b64_tr_b16 v[206:207], v36 offset:13440
  s_waitcnt lgkmcnt(0)
  s_xor_b32 s36, s13, 5
  s_lshl_b32 s36, s36, 19
  s_add_u32 m0, s39, 12288
  s_add_u32 s37, s36, 0
  buffer_load_dwordx4 v25, s[40:43], s37 offen lds
  s_add_u32 m0, s39, 13312
  s_add_u32 s37, s36, 131072
  buffer_load_dwordx4 v25, s[40:43], s37 offen lds
  s_add_u32 m0, s39, 14336
  s_add_u32 s37, s36, 262144
  buffer_load_dwordx4 v25, s[40:43], s37 offen lds
  s_add_u32 m0, s39, 15360
  s_add_u32 s37, s36, 393216
  buffer_load_dwordx4 v25, s[40:43], s37 offen lds
  s_waitcnt vmcnt(12)
  ds_read_b64_tr_b16 v[224:225], v27 offset:0
  ds_read_b64_tr_b16 v[226:227], v27 offset:128
  ds_read_b64_tr_b16 v[228:229], v27 offset:1024
  ds_read_b64_tr_b16 v[230:231], v27 offset:1152
  ds_read_b64_tr_b16 v[232:233], v36 offset:0
  ds_read_b64_tr_b16 v[234:235], v36 offset:128
  ds_read_b64_tr_b16 v[236:237], v36 offset:1024
  ds_read_b64_tr_b16 v[238:239], v36 offset:1152
  s_waitcnt lgkmcnt(0)
  s_xor_b32 s36, s13, 4
  s_lshl_b32 s36, s36, 19
  s_add_u32 m0, s39, 0
  s_add_u32 s37, s36, 0
  buffer_load_dwordx4 v25, s[44:47], s37 offen lds
  s_add_u32 m0, s39, 1024
  s_add_u32 s37, s36, 131072
  buffer_load_dwordx4 v25, s[44:47], s37 offen lds
  s_add_u32 m0, s39, 2048
  s_add_u32 s37, s36, 262144
  buffer_load_dwordx4 v25, s[44:47], s37 offen lds
  s_add_u32 m0, s39, 3072
  s_add_u32 s37, s36, 393216
  buffer_load_dwordx4 v25, s[44:47], s37 offen lds
  s_waitcnt vmcnt(12)
  ds_read_b64_tr_b16 a[16:17], v27 offset:4096
  ds_read_b64_tr_b16 a[18:19], v27 offset:4224
  ds_read_b64_tr_b16 a[20:21], v27 offset:5120
  ds_read_b64_tr_b16 a[22:23], v27 offset:5248
  ds_read_b64_tr_b16 a[24:25], v36 offset:4096
  ds_read_b64_tr_b16 a[26:27], v36 offset:4224
  ds_read_b64_tr_b16 a[28:29], v36 offset:5120
  ds_read_b64_tr_b16 a[30:31], v36 offset:5248
  s_waitcnt lgkmcnt(0)
  s_xor_b32 s36, s13, 5
  s_lshl_b32 s36, s36, 19
  s_add_u32 m0, s39, 4096
  s_add_u32 s37, s36, 0
  buffer_load_dwordx4 v25, s[44:47], s37 offen lds
  s_add_u32 m0, s39, 5120
  s_add_u32 s37, s36, 131072
  buffer_load_dwordx4 v25, s[44:47], s37 offen lds
  s_add_u32 m0, s39, 6144
  s_add_u32 s37, s36, 262144
  buffer_load_dwordx4 v25, s[44:47], s37 offen lds
  s_add_u32 m0, s39, 7168
  s_add_u32 s37, s36, 393216
  buffer_load_dwordx4 v25, s[44:47], s37 offen lds
  s_waitcnt vmcnt(12)
  ds_read_b64_tr_b16 v[240:241], v27 offset:8192
  ds_read_b64_tr_b16 v[242:243], v27 offset:8320
  ds_read_b64_tr_b16 v[244:245], v27 offset:9216
  ds_read_b64_tr_b16 v[246:247], v27 offset:9344
  ds_read_b64_tr_b16 v[248:249], v36 offset:8192
  ds_read_b64_tr_b16 v[250:251], v36 offset:8320
  ds_read_b64_tr_b16 v[252:253], v36 offset:9216
  ds_read_b64_tr_b16 v[254:255], v36 offset:9344
  s_waitcnt lgkmcnt(0)
  s_xor_b32 s36, s13, 6
  s_lshl_b32 s36, s36, 19
  s_add_u32 m0, s39, 8192
  s_add_u32 s37, s36, 0
  buffer_load_dwordx4 v25, s[8:11], s37 offen lds
  s_add_u32 m0, s39, 9216
  s_add_u32 s37, s36, 131072
  buffer_load_dwordx4 v25, s[8:11], s37 offen lds
  s_add_u32 m0, s39, 10240
  s_add_u32 s37, s36, 262144
  buffer_load_dwordx4 v25, s[8:11], s37 offen lds
  s_add_u32 m0, s39, 11264
  s_add_u32 s37, s36, 393216
  buffer_load_dwordx4 v25, s[8:11], s37 offen lds
  s_waitcnt vmcnt(12)
  ds_read_b64_tr_b16 a[32:33], v27 offset:12288
  ds_read_b64_tr_b16 a[34:35], v27 offset:12416
  ds_read_b64_tr_b16 a[36:37], v27 offset:13312
  ds_read_b64_tr_b16 a[38:39], v27 offset:13440
  ds_read_b64_tr_b16 a[40:41], v36 offset:12288
  ds_read_b64_tr_b16 a[42:43], v36 offset:12416
  ds_read_b64_tr_b16 a[44:45], v36 offset:13312
  ds_read_b64_tr_b16 a[46:47], v36 offset:13440
  s_waitcnt lgkmcnt(0)
  s_xor_b32 s36, s13, 7
  s_lshl_b32 s36, s36, 19
  s_add_u32 m0, s39, 12288
  s_add_u32 s37, s36, 0
  buffer_load_dwordx4 v25, s[8:11], s37 offen lds
  s_add_u32 m0, s39, 13312
  s_add_u32 s37, s36, 131072
  buffer_load_dwordx4 v25, s[8:11], s37 offen lds
  s_add_u32 m0, s39, 14336
  s_add_u32 s37, s36, 262144
  buffer_load_dwordx4 v25, s[8:11], s37 offen lds
  s_add_u32 m0, s39, 15360
  s_add_u32 s37, s36, 393216
  buffer_load_dwordx4 v25, s[8:11], s37 offen lds
  s_waitcnt vmcnt(12)
  ds_read_b64_tr_b16 a[0:1], v27 offset:0
  ds_read_b64_tr_b16 a[2:3], v27 offset:128
  ds_read_b64_tr_b16 a[4:5], v27 offset:1024
  ds_read_b64_tr_b16 a[6:7], v27 offset:1152
  ds_read_b64_tr_b16 a[8:9], v36 offset:0
  ds_read_b64_tr_b16 a[10:11], v36 offset:128
  ds_read_b64_tr_b16 a[12:13], v36 offset:1024
  ds_read_b64_tr_b16 a[14:15], v36 offset:1152
  s_waitcnt lgkmcnt(0)
  s_xor_b32 s36, s13, 6
  s_lshl_b32 s36, s36, 19
  s_add_u32 m0, s39, 0
  s_add_u32 s37, s36, 0
  buffer_load_dwordx4 v25, s[40:43], s37 offen lds
  s_add_u32 m0, s39, 1024
  s_add_u32 s37, s36, 131072
  buffer_load_dwordx4 v25, s[40:43], s37 offen lds
  s_add_u32 m0, s39, 2048
  s_add_u32 s37, s36, 262144
  buffer_load_dwordx4 v25, s[40:43], s37 offen lds
  s_add_u32 m0, s39, 3072
  s_add_u32 s37, s36, 393216
  buffer_load_dwordx4 v25, s[40:43], s37 offen lds
  s_waitcnt vmcnt(12)
  ds_read_b64_tr_b16 a[48:49], v27 offset:4096
  ds_read_b64_tr_b16 a[50:51], v27 offset:4224
  ds_read_b64_tr_b16 a[52:53], v27 offset:5120
  ds_read_b64_tr_b16 a[54:55], v27 offset:5248
  ds_read_b64_tr_b16 a[56:57], v36 offset:4096
  ds_read_b64_tr_b16 a[58:59], v36 offset:4224
  ds_read_b64_tr_b16 a[60:61], v36 offset:5120
  ds_read_b64_tr_b16 a[62:63], v36 offset:5248
  s_waitcnt lgkmcnt(0)
  s_xor_b32 s36, s13, 7
  s_lshl_b32 s36, s36, 19
  s_add_u32 m0, s39, 4096
  s_add_u32 s37, s36, 0
  buffer_load_dwordx4 v25, s[40:43], s37 offen lds
  s_add_u32 m0, s39, 5120
  s_add_u32 s37, s36, 131072
  buffer_load_dwordx4 v25, s[40:43], s37 offen lds
  s_add_u32 m0, s39, 6144
  s_add_u32 s37, s36, 262144
  buffer_load_dwordx4 v25, s[40:43], s37 offen lds
  s_add_u32 m0, s39, 7168
  s_add_u32 s37, s36, 393216
  buffer_load_dwordx4 v25, s[40:43], s37 offen lds
  s_waitcnt vmcnt(12)
  ds_read_b64_tr_b16 a[64:65], v27 offset:8192
  ds_read_b64_tr_b16 a[66:67], v27 offset:8320
  ds_read_b64_tr_b16 a[68:69], v27 offset:9216
  ds_read_b64_tr_b16 a[70:71], v27 offset:9344
  ds_read_b64_tr_b16 a[72:73], v36 offset:8192
  ds_read_b64_tr_b16 a[74:75], v36 offset:8320
  ds_read_b64_tr_b16 a[76:77], v36 offset:9216
  ds_read_b64_tr_b16 a[78:79], v36 offset:9344
  s_waitcnt lgkmcnt(0)
  s_xor_b32 s36, s13, 6
  s_lshl_b32 s36, s36, 19
  s_add_u32 m0, s39, 8192
  s_add_u32 s37, s36, 0
  buffer_load_dwordx4 v25, s[44:47], s37 offen lds
  s_add_u32 m0, s39, 9216
  s_add_u32 s37, s36, 131072
  buffer_load_dwordx4 v25, s[44:47], s37 offen lds
  s_add_u32 m0, s39, 10240
  s_add_u32 s37, s36, 262144
  buffer_load_dwordx4 v25, s[44:47], s37 offen lds
  s_add_u32 m0, s39, 11264
  s_add_u32 s37, s36, 393216
  buffer_load_dwordx4 v25, s[44:47], s37 offen lds
  s_waitcnt vmcnt(12)
  ds_read_b64_tr_b16 a[112:113], v27 offset:12288
  ds_read_b64_tr_b16 a[114:115], v27 offset:12416
  ds_read_b64_tr_b16 a[116:117], v27 offset:13312
  ds_read_b64_tr_b16 a[118:119], v27 offset:13440
  ds_read_b64_tr_b16 a[120:121], v36 offset:12288
  ds_read_b64_tr_b16 a[122:123], v36 offset:12416
  ds_read_b64_tr_b16 a[124:125], v36 offset:13312
  ds_read_b64_tr_b16 a[126:127], v36 offset:13440
  s_waitcnt lgkmcnt(0)
  s_xor_b32 s36, s13, 7
  s_lshl_b32 s36, s36, 19
  s_add_u32 m0, s39, 12288
  s_add_u32 s37, s36, 0
  buffer_load_dwordx4 v25, s[44:47], s37 offen lds
  s_add_u32 m0, s39, 13312
  s_add_u32 s37, s36, 131072
  buffer_load_dwordx4 v25, s[44:47], s37 offen lds
  s_add_u32 m0, s39, 14336
  s_add_u32 s37, s36, 262144
  buffer_load_dwordx4 v25, s[44:47], s37 offen lds
  s_add_u32 m0, s39, 15360
  s_add_u32 s37, s36, 393216
  buffer_load_dwordx4 v25, s[44:47], s37 offen lds
  s_waitcnt vmcnt(12)
  ds_read_b64_tr_b16 a[80:81], v27 offset:0
  ds_read_b64_tr_b16 a[82:83], v27 offset:128
  ds_read_b64_tr_b16 a[84:85], v27 offset:1024
  ds_read_b64_tr_b16 a[86:87], v27 offset:1152
  ds_read_b64_tr_b16 a[88:89], v36 offset:0
  ds_read_b64_tr_b16 a[90:91], v36 offset:128
  ds_read_b64_tr_b16 a[92:93], v36 offset:1024
  ds_read_b64_tr_b16 a[94:95], v36 offset:1152
  s_waitcnt lgkmcnt(0)
  s_xor_b32 s36, s13, 1
  s_lshl_b32 s36, s36, 19
  s_add_u32 m0, s39, 16384
  s_add_u32 s37, s36, 0
  buffer_load_dwordx4 v25, s[8:11], s37 offen lds
  s_add_u32 m0, s39, 17408
  s_add_u32 s37, s36, 131072
  buffer_load_dwordx4 v25, s[8:11], s37 offen lds
  s_add_u32 m0, s39, 18432
  s_add_u32 s37, s36, 262144
  buffer_load_dwordx4 v25, s[8:11], s37 offen lds
  s_add_u32 m0, s39, 19456
  s_add_u32 s37, s36, 393216
  buffer_load_dwordx4 v25, s[8:11], s37 offen lds
  s_waitcnt vmcnt(12)
  ds_read_b64_tr_b16 a[128:129], v27 offset:4096
  ds_read_b64_tr_b16 a[130:131], v27 offset:4224
  ds_read_b64_tr_b16 a[132:133], v27 offset:5120
  ds_read_b64_tr_b16 a[134:135], v27 offset:5248
  ds_read_b64_tr_b16 a[136:137], v36 offset:4096
  ds_read_b64_tr_b16 a[138:139], v36 offset:4224
  ds_read_b64_tr_b16 a[140:141], v36 offset:5120
  ds_read_b64_tr_b16 a[142:143], v36 offset:5248
  s_waitcnt lgkmcnt(0)
  s_xor_b32 s36, s13, 0
  s_lshl_b32 s36, s36, 19
  s_add_u32 m0, s39, 0
  s_add_u32 s37, s36, 0
  buffer_load_dwordx4 v25, s[8:11], s37 offen lds
  s_add_u32 m0, s39, 1024
  s_add_u32 s37, s36, 131072
  buffer_load_dwordx4 v25, s[8:11], s37 offen lds
  s_add_u32 m0, s39, 2048
  s_add_u32 s37, s36, 262144
  buffer_load_dwordx4 v25, s[8:11], s37 offen lds
  s_add_u32 m0, s39, 3072
  s_add_u32 s37, s36, 393216
  buffer_load_dwordx4 v25, s[8:11], s37 offen lds
  s_waitcnt vmcnt(12)
  ds_read_b64_tr_b16 a[96:97], v27 offset:8192
  ds_read_b64_tr_b16 a[98:99], v27 offset:8320
  ds_read_b64_tr_b16 a[100:101], v27 offset:9216
  ds_read_b64_tr_b16 a[102:103], v27 offset:9344
  ds_read_b64_tr_b16 a[104:105], v36 offset:8192
  ds_read_b64_tr_b16 a[106:107], v36 offset:8320
  ds_read_b64_tr_b16 a[108:109], v36 offset:9216
  ds_read_b64_tr_b16 a[110:111], v36 offset:9344
  s_waitcnt lgkmcnt(0)
  s_xor_b32 s36, s13, 1
  s_lshl_b32 s36, s36, 19
  s_add_u32 m0, s39, 8192
  s_add_u32 s37, s36, 0
  buffer_load_dwordx4 v25, s[40:43], s37 offen lds
  s_add_u32 m0, s39, 9216
  s_add_u32 s37, s36, 131072
  buffer_load_dwordx4 v25, s[40:43], s37 offen lds
  s_add_u32 m0, s39, 10240
  s_add_u32 s37, s36, 262144
  buffer_load_dwordx4 v25, s[40:43], s37 offen lds
  s_add_u32 m0, s39, 11264
  s_add_u32 s37, s36, 393216
  buffer_load_dwordx4 v25, s[40:43], s37 offen lds
  s_waitcnt vmcnt(12)
  ds_read_b64_tr_b16 a[144:145], v27 offset:12288
  ds_read_b64_tr_b16 a[146:147], v27 offset:12416
  ds_read_b64_tr_b16 a[148:149], v27 offset:13312
  ds_read_b64_tr_b16 a[150:151], v27 offset:13440
  ds_read_b64_tr_b16 a[152:153], v36 offset:12288
  ds_read_b64_tr_b16 a[154:155], v36 offset:12416
  ds_read_b64_tr_b16 a[156:157], v36 offset:13312
  ds_read_b64_tr_b16 a[158:159], v36 offset:13440
  s_waitcnt lgkmcnt(0)
  s_xor_b32 s36, s13, 0
  s_lshl_b32 s36, s36, 19
  s_add_u32 m0, s39, 4096
  s_add_u32 s37, s36, 0
  buffer_load_dwordx4 v25, s[40:43], s37 offen lds
  s_add_u32 m0, s39, 5120
  s_add_u32 s37, s36, 131072
  buffer_load_dwordx4 v25, s[40:43], s37 offen lds
  s_add_u32 m0, s39, 6144
  s_add_u32 s37, s36, 262144
  buffer_load_dwordx4 v25, s[40:43], s37 offen lds
  s_add_u32 m0, s39, 7168
  s_add_u32 s37, s36, 393216
  buffer_load_dwordx4 v25, s[40:43], s37 offen lds
  s_waitcnt vmcnt(12)
  ds_read_b64_tr_b16 v[128:129], v27 offset:16384
  ds_read_b64_tr_b16 v[130:131], v27 offset:16512
  ds_read_b64_tr_b16 v[132:133], v27 offset:17408
  ds_read_b64_tr_b16 v[134:135], v27 offset:17536
  ds_read_b64_tr_b16 v[136:137], v36 offset:16384
  ds_read_b64_tr_b16 v[138:139], v36 offset:16512
  ds_read_b64_tr_b16 v[140:141], v36 offset:17408
  ds_read_b64_tr_b16 v[142:143], v36 offset:17536
  s_waitcnt lgkmcnt(0)
  s_xor_b32 s36, s13, 2
  s_lshl_b32 s36, s36, 19
  s_add_u32 m0, s39, 12288
  s_add_u32 s37, s36, 0
  buffer_load_dwordx4 v25, s[40:43], s37 offen lds
  s_add_u32 m0, s39, 13312
  s_add_u32 s37, s36, 131072
  buffer_load_dwordx4 v25, s[40:43], s37 offen lds
  s_add_u32 m0, s39, 14336
  s_add_u32 s37, s36, 262144
  buffer_load_dwordx4 v25, s[40:43], s37 offen lds
  s_add_u32 m0, s39, 15360
  s_add_u32 s37, s36, 393216
  buffer_load_dwordx4 v25, s[40:43], s37 offen lds
  s_waitcnt vmcnt(12)
  ds_read_b64_tr_b16 v[64:65], v27 offset:0
  ds_read_b64_tr_b16 v[66:67], v27 offset:128
  ds_read_b64_tr_b16 v[68:69], v27 offset:1024
  ds_read_b64_tr_b16 v[70:71], v27 offset:1152
  ds_read_b64_tr_b16 v[72:73], v36 offset:0
  ds_read_b64_tr_b16 v[74:75], v36 offset:128
  ds_read_b64_tr_b16 v[76:77], v36 offset:1024
  ds_read_b64_tr_b16 v[78:79], v36 offset:1152
  s_waitcnt lgkmcnt(0)
  ds_write_b128 v4, v[64:67] offset:0
  ds_write_b128 v4, v[68:71] offset:1024
  ds_write_b128 v4, v[72:75] offset:2048
  ds_write_b128 v4, v[76:79] offset:3072
  s_waitcnt lgkmcnt(0)
  s_xor_b32 s36, s13, 3
  s_lshl_b32 s36, s36, 19
  s_add_u32 m0, s39, 16384
  s_add_u32 s37, s36, 0
  buffer_load_dwordx4 v25, s[40:43], s37 offen lds
  s_add_u32 m0, s39, 17408
  s_add_u32 s37, s36, 131072
  buffer_load_dwordx4 v25, s[40:43], s37 offen lds
  s_add_u32 m0, s39, 18432
  s_add_u32 s37, s36, 262144
  buffer_load_dwordx4 v25, s[40:43], s37 offen lds
  s_add_u32 m0, s39, 19456
  s_add_u32 s37, s36, 393216
  buffer_load_dwordx4 v25, s[40:43], s37 offen lds
  s_waitcnt vmcnt(12)
  ds_read_b64_tr_b16 v[144:145], v27 offset:8192
  ds_read_b64_tr_b16 v[146:147], v27 offset:8320
  ds_read_b64_tr_b16 v[148:149], v27 offset:9216
  ds_read_b64_tr_b16 v[150:151], v27 offset:9344
  ds_read_b64_tr_b16 v[152:153], v36 offset:8192
  ds_read_b64_tr_b16 v[154:155], v36 offset:8320
  ds_read_b64_tr_b16 v[156:157], v36 offset:9216
  ds_read_b64_tr_b16 v[158:159], v36 offset:9344
  s_waitcnt lgkmcnt(0)
  s_xor_b32 s36, s13, 3
  s_lshl_b32 s36, s36, 19
  s_add_u32 m0, s39, 24576
  s_add_u32 s37, s36, 0
  buffer_load_dwordx4 v25, s[44:47], s37 offen lds
  s_add_u32 m0, s39, 25600
  s_add_u32 s37, s36, 131072
  buffer_load_dwordx4 v25, s[44:47], s37 offen lds
  s_add_u32 m0, s39, 26624
  s_add_u32 s37, s36, 262144
  buffer_load_dwordx4 v25, s[44:47], s37 offen lds
  s_add_u32 m0, s39, 27648
  s_add_u32 s37, s36, 393216
  buffer_load_dwordx4 v25, s[44:47], s37 offen lds
  buffer_load_dwordx2 v[54:55], off, s[72:75], 0 sc1
  buffer_load_dword v56, off, s[72:75], 0 offset:128 sc1
  s_waitcnt vmcnt(14)
  ds_read_b64_tr_b16 v[64:65], v27 offset:4096
  ds_read_b64_tr_b16 v[66:67], v27 offset:4224
  ds_read_b64_tr_b16 v[68:69], v27 offset:5120
  ds_read_b64_tr_b16 v[70:71], v27 offset:5248
  ds_read_b64_tr_b16 v[72:73], v36 offset:4096
  ds_read_b64_tr_b16 v[74:75], v36 offset:4224
  ds_read_b64_tr_b16 v[76:77], v36 offset:5120
  ds_read_b64_tr_b16 v[78:79], v36 offset:5248
  s_waitcnt lgkmcnt(0)
  ds_write_b128 v4, v[64:67] offset:4096
  ds_write_b128 v4, v[68:71] offset:5120
  ds_write_b128 v4, v[72:75] offset:6144
  ds_write_b128 v4, v[76:79] offset:7168
  s_waitcnt lgkmcnt(0)
  s_xor_b32 s36, s13, 2
  s_lshl_b32 s36, s36, 19
  s_add_u32 m0, s39, 20480
  s_add_u32 s37, s36, 0
  buffer_load_dwordx4 v25, s[44:47], s37 offen lds
  s_add_u32 m0, s39, 21504
  s_add_u32 s37, s36, 131072
  buffer_load_dwordx4 v25, s[44:47], s37 offen lds
  s_add_u32 m0, s39, 22528
  s_add_u32 s37, s36, 262144
  buffer_load_dwordx4 v25, s[44:47], s37 offen lds
  s_add_u32 m0, s39, 23552
  s_add_u32 s37, s36, 393216
  buffer_load_dwordx4 v25, s[44:47], s37 offen lds
  s_waitcnt vmcnt(14)
  ds_read_b64_tr_b16 v[176:177], v27 offset:12288
  ds_read_b64_tr_b16 v[178:179], v27 offset:12416
  ds_read_b64_tr_b16 v[180:181], v27 offset:13312
  ds_read_b64_tr_b16 v[182:183], v27 offset:13440
  ds_read_b64_tr_b16 v[184:185], v36 offset:12288
  ds_read_b64_tr_b16 v[186:187], v36 offset:12416
  ds_read_b64_tr_b16 v[188:189], v36 offset:13312
  ds_read_b64_tr_b16 v[190:191], v36 offset:13440
  s_waitcnt lgkmcnt(0)
  s_xor_b32 s36, s13, 0
  s_lshl_b32 s36, s36, 19
  s_add_u32 m0, s39, 8192
  s_add_u32 s37, s36, 0
  buffer_load_dwordx4 v25, s[44:47], s37 offen lds
  s_add_u32 m0, s39, 9216
  s_add_u32 s37, s36, 131072
  buffer_load_dwordx4 v25, s[44:47], s37 offen lds
  s_add_u32 m0, s39, 10240
  s_add_u32 s37, s36, 262144
  buffer_load_dwordx4 v25, s[44:47], s37 offen lds
  s_add_u32 m0, s39, 11264
  s_add_u32 s37, s36, 393216
  buffer_load_dwordx4 v25, s[44:47], s37 offen lds
  s_waitcnt vmcnt(14)
  ds_read_b64_tr_b16 v[64:65], v27 offset:16384
  ds_read_b64_tr_b16 v[66:67], v27 offset:16512
  ds_read_b64_tr_b16 v[68:69], v27 offset:17408
  ds_read_b64_tr_b16 v[70:71], v27 offset:17536
  ds_read_b64_tr_b16 v[72:73], v36 offset:16384
  ds_read_b64_tr_b16 v[74:75], v36 offset:16512
  ds_read_b64_tr_b16 v[76:77], v36 offset:17408
  ds_read_b64_tr_b16 v[78:79], v36 offset:17536
  s_waitcnt lgkmcnt(0)
  ds_write_b128 v4, v[64:67] offset:16384
  ds_write_b128 v4, v[68:71] offset:17408
  ds_write_b128 v4, v[72:75] offset:18432
  ds_write_b128 v4, v[76:79] offset:19456
  s_waitcnt lgkmcnt(0)
  s_xor_b32 s36, s13, 1
  s_lshl_b32 s36, s36, 19
  s_add_u32 m0, s39, 12288
  s_add_u32 s37, s36, 0
  buffer_load_dwordx4 v25, s[44:47], s37 offen lds
  s_add_u32 m0, s39, 13312
  s_add_u32 s37, s36, 131072
  buffer_load_dwordx4 v25, s[44:47], s37 offen lds
  s_add_u32 m0, s39, 14336
  s_add_u32 s37, s36, 262144
  buffer_load_dwordx4 v25, s[44:47], s37 offen lds
  s_add_u32 m0, s39, 15360
  s_add_u32 s37, s36, 393216
  buffer_load_dwordx4 v25, s[44:47], s37 offen lds
  s_waitcnt vmcnt(14)
  ds_read_b64_tr_b16 v[208:209], v27 offset:24576
  ds_read_b64_tr_b16 v[210:211], v27 offset:24704
  ds_read_b64_tr_b16 v[212:213], v27 offset:25600
  ds_read_b64_tr_b16 v[214:215], v27 offset:25728
  ds_read_b64_tr_b16 v[216:217], v36 offset:24576
  ds_read_b64_tr_b16 v[218:219], v36 offset:24704
  ds_read_b64_tr_b16 v[220:221], v36 offset:25600
  ds_read_b64_tr_b16 v[222:223], v36 offset:25728
  s_waitcnt lgkmcnt(0)
  s_xor_b32 s36, s13, 2
  s_lshl_b32 s36, s36, 15
  s_add_u32 m0, s39, 24576
  s_add_u32 s37, s36, 512
  buffer_load_dwordx4 v26, s[48:51], s37 offen lds
  s_add_u32 m0, s39, 25600
  s_add_u32 s37, s36, 8704
  buffer_load_dwordx4 v26, s[48:51], s37 offen lds
  s_add_u32 m0, s39, 26624
  s_add_u32 s37, s36, 16896
  buffer_load_dwordx4 v26, s[48:51], s37 offen lds
  s_add_u32 m0, s39, 27648
  s_add_u32 s37, s36, 25088
  buffer_load_dwordx4 v26, s[48:51], s37 offen lds
  s_waitcnt vmcnt(12)
  ds_read_b64_tr_b16 v[64:65], v27 offset:20480
  ds_read_b64_tr_b16 v[66:67], v27 offset:20608
  ds_read_b64_tr_b16 v[68:69], v27 offset:21504
  ds_read_b64_tr_b16 v[70:71], v27 offset:21632
  ds_read_b64_tr_b16 v[72:73], v36 offset:20480
  ds_read_b64_tr_b16 v[74:75], v36 offset:20608
  ds_read_b64_tr_b16 v[76:77], v36 offset:21504
  ds_read_b64_tr_b16 v[78:79], v36 offset:21632
  s_waitcnt lgkmcnt(0)
  ds_write_b128 v4, v[64:67] offset:20480
  ds_write_b128 v4, v[68:71] offset:21504
  ds_write_b128 v4, v[72:75] offset:22528
  ds_write_b128 v4, v[76:79] offset:23552
  s_waitcnt lgkmcnt(0)
  s_xor_b32 s36, s13, 3
  s_lshl_b32 s36, s36, 15
  s_add_u32 m0, s39, 28672
  s_add_u32 s37, s36, 512
  buffer_load_dwordx4 v26, s[48:51], s37 offen lds
  s_add_u32 m0, s39, 29696
  s_add_u32 s37, s36, 8704
  buffer_load_dwordx4 v26, s[48:51], s37 offen lds
  s_add_u32 m0, s39, 30720
  s_add_u32 s37, s36, 16896
  buffer_load_dwordx4 v26, s[48:51], s37 offen lds
  s_add_u32 m0, s39, 31744
  s_add_u32 s37, s36, 25088
  buffer_load_dwordx4 v26, s[48:51], s37 offen lds
  s_mov_b32 s19, 0
  s_branch T_arrgo_74
T_arr_73:
  s_add_u32 s19, s19, 1
  s_cmp_gt_u32 s19, 32768
  s_cbranch_scc1 M_exit
  buffer_load_dwordx2 v[54:55], off, s[72:75], 0 sc1
  buffer_load_dword v56, off, s[72:75], 0 offset:128 sc1
  s_waitcnt vmcnt(0)
T_arrgo_74:
  v_sad_u8 v57, v54, 0, 0
  v_sad_u8 v57, v55, 0, v57
  v_or_b32 v58, v54, v55
  v_cmp_gt_u32 vcc, 32, v57
  s_cbranch_vccnz T_arr_73
  v_cmp_gt_u32 vcc, 0x100, v56
  s_cbranch_vccnz T_arr_73
  v_readfirstlane_b32 s36, v58
  s_nop 0
  s_and_b32 s36, s36, 0x20202020
  s_cselect_b32 s56, 0, 1
  s_mov_b32 s14, -1
  s_mov_b32 s30, -1
  s_mov_b32 s19, 0
  s_branch T_kvok_76
T_kv_75:
  s_sleep 4
  s_add_u32 s19, s19, 1
  s_cmp_gt_u32 s19, 32768
  s_cbranch_scc1 M_exit
T_kvok_76:
  s_add_u32 s39, s99, 128
  s_mov_b32 s38, 0
  s_mov_b32 s37, 0
  s_atomic_or s38, s[58:59], s99 glc
  s_atomic_or s37, s[58:59], s39 glc
  s_waitcnt lgkmcnt(0)
  s_add_u32 s37, s37, 30
  s_cmp_ge_u32 s38, 30
  s_cselect_b32 s38, s37, s38
  s_cmp_ge_u32 s38, 64
  s_cselect_b32 s38, 100, s38
  s_sub_u32 s38, s38, 1
  s_max_i32 s30, s30, s38
  s_cmp_ge_i32 s14, s30
  s_cbranch_scc1 T_kv_75
  s_mov_b32 m0, s31
  s_nop 0
  buffer_load_dwordx4 v9, s[4:7], s27 offen sc1 lds
  s_mov_b32 m0, s32
  s_nop 0
  buffer_load_dwordx4 v9, s[4:7], s27 offen offset:128 sc1 lds
  s_mov_b32 m0, s33
  s_nop 0
  buffer_load_dwordx4 v10, s[4:7], s28 offen sc1 lds
  s_mov_b32 m0, s34
  s_nop 0
  buffer_load_dwordx4 v10, s[4:7], s28 offen offset:256 sc1 lds
  s_add_u32 s27, s27, 8192
  s_add_u32 s28, s28, 8192
  s_lshl_b32 s36, s12, 10
  s_add_u32 s36, s36, 145752064
  buffer_load_dwordx4 v[40:43], v2, s[4:7], s36 offen sc1
  s_waitcnt vmcnt(17)
  ds_read_b64_tr_b16 v[64:65], v27 offset:8192
  ds_read_b64_tr_b16 v[66:67], v27 offset:8320
  ds_read_b64_tr_b16 v[68:69], v27 offset:9216
  ds_read_b64_tr_b16 v[70:71], v27 offset:9344
  ds_read_b64_tr_b16 v[72:73], v36 offset:8192
  ds_read_b64_tr_b16 v[74:75], v36 offset:8320
  ds_read_b64_tr_b16 v[76:77], v36 offset:9216
  ds_read_b64_tr_b16 v[78:79], v36 offset:9344
  s_waitcnt lgkmcnt(0)
  ds_write_b128 v4, v[64:67] offset:8192
  ds_write_b128 v4, v[68:71] offset:9216
  ds_write_b128 v4, v[72:75] offset:10240
  ds_write_b128 v4, v[76:79] offset:11264
  s_waitcnt lgkmcnt(0)
  s_waitcnt vmcnt(13)
  ds_read_b64_tr_b16 v[64:65], v27 offset:12288
  ds_read_b64_tr_b16 v[66:67], v27 offset:12416
  ds_read_b64_tr_b16 v[68:69], v27 offset:13312
  ds_read_b64_tr_b16 v[70:71], v27 offset:13440
  ds_read_b64_tr_b16 v[72:73], v36 offset:12288
  ds_read_b64_tr_b16 v[74:75], v36 offset:12416
  ds_read_b64_tr_b16 v[76:77], v36 offset:13312
  ds_read_b64_tr_b16 v[78:79], v36 offset:13440
  s_waitcnt lgkmcnt(0)
  ds_write_b128 v4, v[64:67] offset:12288
  ds_write_b128 v4, v[68:71] offset:13312
  ds_write_b128 v4, v[72:75] offset:14336
  ds_write_b128 v4, v[76:79] offset:15360
  s_waitcnt lgkmcnt(0)
  s_waitcnt vmcnt(9)
  ds_read_b64_tr_b16 v[64:65], v28 offset:24576
  ds_read_b64_tr_b16 v[66:67], v28 offset:24832
  ds_read_b64_tr_b16 v[68:69], v28 offset:25600
  ds_read_b64_tr_b16 v[70:71], v28 offset:25856
  ds_read_b64_tr_b16 v[72:73], v28 offset:24584
  ds_read_b64_tr_b16 v[74:75], v28 offset:24840
  ds_read_b64_tr_b16 v[76:77], v28 offset:25608
  ds_read_b64_tr_b16 v[78:79], v28 offset:25864
  s_waitcnt lgkmcnt(0)
  ds_write_b128 v4, v[64:67] offset:24576
  ds_write_b128 v4, v[68:71] offset:25600
  ds_write_b128 v4, v[72:75] offset:26624
  ds_write_b128 v4, v[76:79] offset:27648
  s_waitcnt lgkmcnt(0)
  s_waitcnt vmcnt(5)
  ds_read_b64_tr_b16 v[64:65], v28 offset:28672
  ds_read_b64_tr_b16 v[66:67], v28 offset:28928
  ds_read_b64_tr_b16 v[68:69], v28 offset:29696
  ds_read_b64_tr_b16 v[70:71], v28 offset:29952
  ds_read_b64_tr_b16 v[72:73], v28 offset:28680
  ds_read_b64_tr_b16 v[74:75], v28 offset:28936
  ds_read_b64_tr_b16 v[76:77], v28 offset:29704
  ds_read_b64_tr_b16 v[78:79], v28 offset:29960
  s_waitcnt lgkmcnt(0)
  ds_write_b128 v4, v[64:67] offset:28672
  ds_write_b128 v4, v[68:71] offset:29696
  ds_write_b128 v4, v[72:75] offset:30720
  ds_write_b128 v4, v[76:79] offset:31744
  s_waitcnt lgkmcnt(0)
  s_waitcnt vmcnt(0) lgkmcnt(0)
  s_barrier
  ds_read_b128 v[68:71], v4 offset:0
  ds_read_b128 v[72:75], v4 offset:1024
  ds_read_b128 v[76:79], v4 offset:4096
  ds_read_b128 v[80:83], v4 offset:5120
  ds_read_b128 v[84:87], v4 offset:8192
  ds_read_b128 v[88:91], v4 offset:9216
  ds_read_b128 v[92:95], v4 offset:2048
  ds_read_b128 v[96:99], v4 offset:3072
  ds_read_b128 v[100:103], v4 offset:6144
  ds_read_b128 v[104:107], v4 offset:7168
  ds_read_b128 v[108:111], v4 offset:10240
  ds_read_b128 v[112:115], v4 offset:11264
  ds_read_b128 v[28:31], v59 offset:16384
  ds_read_b128 v[32:35], v59 offset:20480
  ds_read_b128 v[36:39], v2 offset:8192
  ds_read_b128 v[40:43], v2 offset:9216
  ds_read_b128 v[44:47], v2 offset:10240
  ds_read_b128 v[48:51], v2 offset:11264
  ds_read_b128 v[52:55], v2 offset:12288
  ds_read_b128 v[56:59], v2 offset:13312
  ds_read_b128 v[60:63], v2 offset:14336
  ds_read_b128 v[64:67], v2 offset:15360
  s_and_b32 s36, s13, 1
  s_lshl_b32 s36, s36, 12
  s_add_u32 s22, s22, s36
  s_add_u32 s23, s36, 145752064
  s_mov_b32 s14, -1
  s_and_b32 s57, s14, 1
  s_and_b32 s36, s14, 3
  s_lshl_b32 s36, s36, 13
  s_add_u32 s26, s36, s23
  s_add_u32 s36, s36, 8192
  s_and_b32 s36, s36, 0x7fff
  s_add_u32 s24, s36, 145752064
  s_add_u32 s25, s36, 145756160
  s_add_u32 s35, s36, s23
  s_waitcnt lgkmcnt(0)
  s_cmp_lg_u32 s56, 0
  s_cbranch_scc1 M_global
  s_cmp_eq_u32 s13, 1
  s_cbranch_scc1 T_w_78
  s_cmp_eq_u32 s13, 2
  s_cbranch_scc1 T_w_79
  s_cmp_eq_u32 s13, 3
  s_cbranch_scc1 T_w_80
T_w_77:
  s_mov_b32 s19, 0
  v_mov_b64 v[16:17], 0
  v_mov_b64 v[18:19], 0
  v_mov_b64 v[20:21], 0
  v_mov_b64 v[22:23], 0
  v_mov_b64 v[24:25], 0
  v_mov_b64 v[26:27], 0
  buffer_load_dwordx4 v[124:127], v2, s[4:7], s24 offen offset:0 sc1
  buffer_load_dwordx4 v[116:119], v2, s[4:7], s25 offen offset:0 sc1
  buffer_load_dwordx4 v[124:127], v2, s[4:7], s24 offen offset:0 sc1
  buffer_load_dwordx4 v[116:119], v2, s[4:7], s25 offen offset:0 sc1
  s_branch T_loop_81
.p2align 6
T_retry_82:
  s_mov_b64 exec, vcc
  buffer_load_dwordx4 v[124:127], v2, s[4:7], s24 offen offset:0 sc1
  buffer_load_dwordx4 v[116:119], v2, s[4:7], s25 offen offset:0 sc1
  s_mov_b64 exec, -1
  s_add_u32 s19, s19, 1
  s_cmp_gt_u32 s19, 32768
  s_cbranch_scc1 M_exit
T_loop_81:
  s_waitcnt vmcnt(3) lgkmcnt(0)
  v_max3_u32 v123, v124, v125, v126
  v_max_u32 v123, v123, v127
  v_mov_b32_dpp v120, v124 row_ror:8 row_mask:0xf bank_mask:0xf
  v_mov_b32_dpp v121, v125 row_ror:8 row_mask:0xf bank_mask:0xf
  s_waitcnt vmcnt(2)
  v_max3_u32 v123, v123, v116, v117
  v_max3_u32 v123, v123, v118, v119
  v_cmp_eq_u32 vcc, -1, v123
  s_cbranch_vccnz T_retry_82
  v_smfmac_f32_16x16x64_bf16 v[16:19], v[124:127], v[68:75], v0
  s_add_u32 s14, s14, 1
  ds_write_b128 v2, v[124:127] offset:0
  v_mov_b32_dpp v122, v126 row_ror:8 row_mask:0xf bank_mask:0xf
  v_smfmac_f32_16x16x64_bf16 v[20:23], v[124:127], v[76:83], v0
  s_and_b32 s57, s14, 1
  v_mov_b32_dpp v123, v127 row_ror:8 row_mask:0xf bank_mask:0xf
  v_smfmac_f32_16x16x64_bf16 v[24:27], v[124:127], v[84:91], v0
  s_and_b32 s36, s14, 3
  ds_write_b128 v2, v[116:119] offset:4096
  v_smfmac_f32_16x16x64_bf16 v[16:19], v[120:123], v[92:99], v0
  s_lshl_b32 s36, s36, 13
  v_mov_b32_dpp v84, v116 row_ror:8 row_mask:0xf bank_mask:0xf
  v_smfmac_f32_16x16x64_bf16 v[20:23], v[120:123], v[100:107], v0
  s_add_u32 s26, s36, s23
  ds_read_b128 v[68:71], v4 offset:12288
  v_mov_b32_dpp v85, v117 row_ror:8 row_mask:0xf bank_mask:0xf
  v_smfmac_f32_16x16x64_bf16 v[24:27], v[120:123], v[108:115], v0
  s_add_u32 s36, s36, 8192
  ds_read_b128 v[72:75], v4 offset:13312
  v_mov_b32_dpp v86, v118 row_ror:8 row_mask:0xf bank_mask:0xf
  v_smfmac_f32_16x16x64_bf16 v[16:19], v[116:119], v[224:231], v0
  s_and_b32 s36, s36, 0x7fff
  ds_read_b128 v[76:79], v4 offset:14336
  v_mov_b32_dpp v87, v119 row_ror:8 row_mask:0xf bank_mask:0xf
  v_smfmac_f32_16x16x64_bf16 v[20:23], v[116:119], v[240:247], v0
  s_waitcnt lgkmcnt(3)
  s_barrier
  ds_read_b128 v[100:103], v2 offset:1024
  v_smfmac_f32_16x16x64_bf16 v[24:27], v[116:119], a[0:7], v0
  s_mov_b32 m0, s31
  ds_read_b128 v[120:123], v1 offset:1024
  v_smfmac_f32_16x16x64_bf16 v[16:19], v[84:87], v[232:239], v0
  s_cmp_ge_i32 s14, s30
  s_cbranch_scc1 T_kvw_85
T_kvb_86:
  v_smfmac_f32_16x16x64_bf16 v[20:23], v[84:87], v[248:255], v0
  ds_read_b128 v[80:83], v4 offset:15360
  buffer_load_dwordx4 v9, s[4:7], s27 offen sc1 lds
  v_smfmac_f32_16x16x64_bf16 v[24:27], v[84:87], a[8:15], v0
  s_waitcnt lgkmcnt(2)
  s_mov_b32 m0, s32
  v_smfmac_f32_16x16x64_bf16 v[16:19], v[100:103], v[128:135], v0
  ds_read_b128 v[92:95], v2 offset:2048
  v_smfmac_f32_16x16x64_bf16 v[20:23], v[100:103], v[144:151], v0
  ds_read_b128 v[96:99], v1 offset:2048
  v_smfmac_f32_16x16x64_bf16 v[24:27], v[100:103], v[68:75], v0
  s_waitcnt vmcnt(1) lgkmcnt(3)
  ds_read_b128 v[116:119], v2 offset:3072
  buffer_load_dwordx4 v9, s[4:7], s27 offen offset:128 sc1 lds
  v_smfmac_f32_16x16x64_bf16 v[16:19], v[120:123], v[136:143], v0
  ds_read_b128 v[124:127], v1 offset:3072
  s_mov_b32 m0, s33
  v_smfmac_f32_16x16x64_bf16 v[20:23], v[120:123], v[152:159], v0
  s_waitcnt lgkmcnt(4)
  ds_read_b128 v[104:107], v2 offset:5120
  v_smfmac_f32_16x16x64_bf16 v[24:27], v[120:123], v[76:83], v0
  s_waitcnt lgkmcnt(4)
  ds_read_b128 v[108:111], v1 offset:5120
  v_smfmac_f32_16x16x64_bf16 v[16:19], v[92:95], v[160:167], v0
  s_waitcnt lgkmcnt(4)
  ds_read_b128 v[112:115], v2 offset:6144
  buffer_load_dwordx4 v10, s[4:7], s28 offen sc1 lds
  v_smfmac_f32_16x16x64_bf16 v[16:19], v[96:99], v[168:175], v0
  s_waitcnt lgkmcnt(4)
  ds_read_b128 v[84:87], v1 offset:6144
  s_mov_b32 m0, s34
  v_smfmac_f32_16x16x64_bf16 v[16:19], v[116:119], v[192:199], v0
  s_waitcnt lgkmcnt(4)
  ds_read_b128 v[88:91], v2 offset:7168
  v_smfmac_f32_16x16x64_bf16 v[16:19], v[124:127], v[200:207], v0
  s_waitcnt lgkmcnt(4)
  ds_read_b128 v[100:103], v1 offset:7168
  v_smfmac_f32_16x16x64_bf16 v[16:19], v[104:107], a[16:23], v0
  s_waitcnt lgkmcnt(4)
  ds_read_b128 v[68:71], v4 offset:16384
  buffer_load_dwordx4 v10, s[4:7], s28 offen offset:256 sc1 lds
  v_smfmac_f32_16x16x64_bf16 v[16:19], v[108:111], a[24:31], v0
  s_waitcnt lgkmcnt(4)
  ds_read_b128 v[72:75], v4 offset:17408
  v_smfmac_f32_16x16x64_bf16 v[16:19], v[112:115], a[64:71], v0
  s_waitcnt lgkmcnt(4)
  ds_read_b128 v[76:79], v4 offset:18432
  v_smfmac_f32_16x16x64_bf16 v[16:19], v[84:87], a[72:79], v0
  s_waitcnt lgkmcnt(4)
  ds_read_b128 v[80:83], v4 offset:19456
  v_smfmac_f32_16x16x64_bf16 v[16:19], v[88:91], a[112:119], v0
  s_waitcnt lgkmcnt(4)
  v_smfmac_f32_16x16x64_bf16 v[16:19], v[100:103], a[120:127], v0
  s_add_u32 s24, s36, 145752064
  s_add_u32 s25, s36, 145756160
  v_smfmac_f32_16x16x64_bf16 v[20:23], v[92:95], v[176:183], v0
  s_add_u32 s35, s36, s23
  v_smfmac_f32_16x16x64_bf16 v[20:23], v[96:99], v[184:191], v0
  s_waitcnt lgkmcnt(2)
  v_smfmac_f32_16x16x64_bf16 v[20:23], v[116:119], v[68:75], v0
  s_waitcnt lgkmcnt(0)
  ds_read_b128 v[68:71], v4 offset:20480
  v_mul_f32 v16, s18, v16
  v_smfmac_f32_16x16x64_bf16 v[20:23], v[124:127], v[76:83], v0
  ds_read_b128 v[72:75], v4 offset:21504
  v_mul_f32 v17, s18, v17
  v_smfmac_f32_16x16x64_bf16 v[20:23], v[104:107], a[32:39], v0
  ds_read_b128 v[76:79], v4 offset:22528
  v_mul_f32 v18, s18, v18
  v_smfmac_f32_16x16x64_bf16 v[20:23], v[108:111], a[40:47], v0
  ds_read_b128 v[80:83], v4 offset:23552
  v_mul_f32 v19, s18, v19
  v_smfmac_f32_16x16x64_bf16 v[20:23], v[112:115], a[80:87], v0
  v_cvt_pk_bf16_f32 v120, v16, v17
  v_smfmac_f32_16x16x64_bf16 v[20:23], v[84:87], a[88:95], v0
  v_cvt_pk_bf16_f32 v121, v18, v19
  v_smfmac_f32_16x16x64_bf16 v[20:23], v[88:91], a[128:135], v0
  ds_write_b64 v5, v[120:121] offset:24576
  v_smfmac_f32_16x16x64_bf16 v[20:23], v[100:103], a[136:143], v0
  s_waitcnt lgkmcnt(3)
  v_smfmac_f32_16x16x64_bf16 v[24:27], v[92:95], v[68:75], v0
  s_waitcnt lgkmcnt(1)
  v_mov_b64 v[92:93], 0
  v_smfmac_f32_16x16x64_bf16 v[24:27], v[96:99], v[76:83], v0
  s_nop 1
  v_cvt_pk_bf16_f32 v122, v20, v21
  v_cvt_pk_bf16_f32 v123, v22, v23
  v_smfmac_f32_16x16x64_bf16 v[24:27], v[116:119], v[208:215], v0
  ds_write_b64 v5, v[122:123] offset:26880
  v_mov_b64 v[94:95], 0
  v_smfmac_f32_16x16x64_bf16 v[24:27], v[124:127], v[216:223], v0
  s_waitcnt lgkmcnt(1)
  s_barrier
  ds_read_b64_tr_b16 v[68:69], v6 offset:24576
  v_smfmac_f32_16x16x64_bf16 v[24:27], v[104:107], a[48:55], v0
  s_add_u32 s27, s27, 8192
  ds_read_b64_tr_b16 v[70:71], v6 offset:24640
  ds_read_b64_tr_b16 v[72:73], v6 offset:24832
  v_smfmac_f32_16x16x64_bf16 v[24:27], v[108:111], a[56:63], v0
  s_add_u32 s28, s28, 8192
  ds_read_b64_tr_b16 v[74:75], v6 offset:24896
  ds_read_b64_tr_b16 v[76:77], v6 offset:25088
  v_smfmac_f32_16x16x64_bf16 v[24:27], v[112:115], a[96:103], v0
  s_nop 0
  ds_read_b64_tr_b16 v[78:79], v6 offset:25152
  ds_read_b64_tr_b16 v[80:81], v6 offset:25344
  v_smfmac_f32_16x16x64_bf16 v[24:27], v[84:87], a[104:111], v0
  ds_read_b64_tr_b16 v[82:83], v6 offset:25408
  v_mov_b64 v[96:97], 0
  v_smfmac_f32_16x16x64_bf16 v[24:27], v[88:91], a[144:151], v0
  s_waitcnt lgkmcnt(8)
  s_barrier
  ds_read_b64_tr_b16 v[116:117], v6 offset:26880
  v_smfmac_f32_16x16x64_bf16 v[24:27], v[100:103], a[152:159], v0
  s_waitcnt lgkmcnt(7)
  ds_read_b64_tr_b16 v[118:119], v6 offset:26944
  buffer_store_dwordx2 v[122:123], v5, s[4:7], s29 offen sc1
  v_mfma_f32_16x16x32_bf16 v[16:19], v[36:39], v[68:71], 0
  s_waitcnt lgkmcnt(6)
  ds_read_b64_tr_b16 v[124:125], v6 offset:27136
  ds_read_b64_tr_b16 v[126:127], v6 offset:27200
  v_mfma_f32_16x16x32_bf16 v[16:19], v[40:43], v[72:75], v[16:19]
  s_waitcnt lgkmcnt(6)
  ds_read_b64_tr_b16 v[104:105], v6 offset:27392
  ds_read_b64_tr_b16 v[106:107], v6 offset:27456
  v_mfma_f32_16x16x32_bf16 v[16:19], v[44:47], v[76:79], v[16:19]
  s_waitcnt lgkmcnt(6)
  ds_read_b64_tr_b16 v[108:109], v6 offset:27648
  ds_read_b64_tr_b16 v[110:111], v6 offset:27712
  v_mfma_f32_16x16x32_bf16 v[16:19], v[48:51], v[80:83], v[16:19]
  s_waitcnt lgkmcnt(6)
  v_cvt_pk_bf16_f32 v120, v24, v25
  v_cvt_pk_bf16_f32 v121, v26, v27
  v_mfma_f32_16x16x32_bf16 v[112:115], v[116:119], v[68:71], 0
  s_waitcnt lgkmcnt(4)
  buffer_store_dwordx2 v[120:121], v5, s[4:7], s29 offen offset:2304 sc1
  v_mov_b64 v[98:99], 0
  v_mfma_f32_16x16x32_bf16 v[112:115], v[124:127], v[72:75], v[112:115]
  s_waitcnt lgkmcnt(2)
  v_mov_b64 v[36:37], 0
  v_exp_f32 v100, v16
  v_mfma_f32_16x16x32_bf16 v[112:115], v[104:107], v[76:79], v[112:115]
  s_waitcnt lgkmcnt(0)
  v_exp_f32 v101, v17
  v_mfma_f32_16x16x32_bf16 v[112:115], v[108:111], v[80:83], v[112:115]
  s_add_u32 s29, s29, 147456
  v_exp_f32 v102, v18
  v_mfma_f32_16x16x32_bf16 v[20:23], v[52:55], v[68:71], 0
  s_cmp_eq_u32 s14, 63
  v_exp_f32 v103, v19
  v_mfma_f32_16x16x32_bf16 v[20:23], v[56:59], v[72:75], v[20:23]
  s_cbranch_scc1 M_tdone
  v_cvt_pk_bf16_f32 v44, v100, v101
  v_cvt_pk_bf16_f32 v45, v102, v103
  v_mfma_f32_16x16x32_bf16 v[20:23], v[60:63], v[76:79], v[20:23]
  v_exp_f32 v100, v112
  v_mfma_f32_16x16x32_bf16 v[20:23], v[64:67], v[80:83], v[20:23]
  v_exp_f32 v101, v113
  v_exp_f32 v102, v114
  v_exp_f32 v103, v115
  v_cvt_pk_bf16_f32 v84, v100, v101
  v_cvt_pk_bf16_f32 v85, v102, v103
  v_cndmask_b32 v48, v84, 0, s[16:17]
  v_cndmask_b32 v49, v85, 0, s[16:17]
  v_cndmask_b32 v50, 0, v84, s[16:17]
  v_cndmask_b32 v51, 0, v85, s[16:17]
  v_exp_f32 v100, v20
  v_mfma_f32_16x16x16_bf16 v[88:91], v[12:13], v[48:49], 0
  v_exp_f32 v101, v21
  v_mfma_f32_16x16x16_bf16 v[24:27], v[120:121], v[48:49], 0
  v_exp_f32 v102, v22
  v_mfma_f32_16x16x16_bf16 v[116:119], v[120:121], v[50:51], 0
  v_exp_f32 v103, v23
  v_cvt_pk_bf16_f32 v46, v100, v101
  v_cvt_pk_bf16_f32 v47, v102, v103
  v_mov_b64 v[38:39], 0
  s_nop 0
  v_mfma_f32_16x16x32_bf16 v[88:91], v[12:15], v[44:47], v[88:91]
  v_mov_b64 v[40:41], 0
  v_mov_b64 v[42:43], 0
  v_mfma_f32_16x16x32_bf16 v[24:27], v[28:31], v[44:47], v[24:27]
  ds_read_b128 v[52:55], v4 offset:24576
  ds_read_b128 v[56:59], v4 offset:25600
  v_mfma_f32_16x16x32_bf16 v[116:119], v[32:35], v[44:47], v[116:119]
  s_nop 1
  v_rcp_f32 v89, v88
  v_subrev_u32 v100, s54, v88
  v_cmp_le_u32 vcc, s55, v100
  v_mul_f32 v24, v89, v24
  v_mul_f32 v25, v89, v25
  s_cbranch_vccnz T_slow_87
T_back_88:
  v_cvt_pk_bf16_f32 v124, v24, v25
  v_pk_mul_f32 v[26:27], v[26:27], v[88:89] op_sel:[0,1] op_sel_hi:[1,1]
  v_pk_mul_f32 v[116:117], v[116:117], v[88:89] op_sel:[0,1] op_sel_hi:[1,1]
  v_pk_mul_f32 v[118:119], v[118:119], v[88:89] op_sel:[0,1] op_sel_hi:[1,1]
  v_cvt_pk_bf16_f32 v125, v26, v27
  v_cvt_pk_bf16_f32 v126, v116, v117
  v_cvt_pk_bf16_f32 v127, v118, v119
  ds_write_b128 v11, v[124:127] offset:29184
  s_nop 0
  v_smfmac_f32_16x16x64_bf16 v[92:95], v[124:127], a[160:167], v0
  v_smfmac_f32_16x16x64_bf16 v[96:99], v[124:127], a[168:175], v0
  v_smfmac_f32_16x16x64_bf16 v[36:39], v[124:127], a[176:183], v0
  v_smfmac_f32_16x16x64_bf16 v[40:43], v[124:127], a[184:191], v0
  s_waitcnt lgkmcnt(0)
  s_barrier
  ds_read_b128 v[104:107], v11 offset:29696
  ds_read_b128 v[108:111], v11 offset:30208
  ds_read_b128 v[68:71], v11 offset:30720
  s_waitcnt lgkmcnt(2)
  v_smfmac_f32_16x16x64_bf16 v[92:95], v[104:107], a[192:199], v0
  s_waitcnt lgkmcnt(1)
  ds_read_b128 v[76:79], v4 offset:28672
  v_smfmac_f32_16x16x64_bf16 v[92:95], v[108:111], a[224:231], v0
  s_waitcnt lgkmcnt(1)
  ds_read_b128 v[80:83], v4 offset:29696
  v_smfmac_f32_16x16x64_bf16 v[92:95], v[68:71], a[240:247], v0
  ds_read_b128 v[60:63], v4 offset:26624
  v_smfmac_f32_16x16x64_bf16 v[96:99], v[104:107], a[200:207], v0
  ds_read_b128 v[64:67], v4 offset:27648
  v_smfmac_f32_16x16x64_bf16 v[96:99], v[108:111], a[232:239], v0
  ds_read_b128 v[28:31], v4 offset:30720
  s_nop 0
  v_cvt_pk_bf16_f32 v16, v92, v93
  v_cvt_pk_bf16_f32 v17, v94, v95
  v_bfi_b32 v16, 1, s57, v16
  v_smfmac_f32_16x16x64_bf16 v[96:99], v[68:71], a[248:255], v0
  buffer_store_dwordx2 v[16:17], v7, s[4:7], s20 offen offset:0
  v_smfmac_f32_16x16x64_bf16 v[36:39], v[104:107], a[208:215], v0
  ds_read_b128 v[32:35], v4 offset:31744
  v_smfmac_f32_16x16x64_bf16 v[36:39], v[108:111], v[52:59], v0
  s_waitcnt lgkmcnt(4)
  s_nop 0
  v_cvt_pk_bf16_f32 v18, v96, v97
  v_cvt_pk_bf16_f32 v19, v98, v99
  v_bfi_b32 v18, 1, s57, v18
  v_smfmac_f32_16x16x64_bf16 v[36:39], v[68:71], v[76:83], v0
  buffer_store_dwordx2 v[18:19], v7, s[4:7], s20 offen offset:64
  v_smfmac_f32_16x16x64_bf16 v[40:43], v[104:107], a[216:223], v0
  s_waitcnt lgkmcnt(2)
  ds_read_b128 v[116:119], v2 offset:31232
  v_smfmac_f32_16x16x64_bf16 v[40:43], v[108:111], v[60:67], v0
  s_waitcnt lgkmcnt(1)
  s_nop 0
  v_cvt_pk_bf16_f32 v20, v36, v37
  v_cvt_pk_bf16_f32 v21, v38, v39
  v_bfi_b32 v20, 1, s57, v20
  v_smfmac_f32_16x16x64_bf16 v[40:43], v[68:71], v[28:35], v0
  buffer_store_dwordx2 v[20:21], v7, s[4:7], s21 offen offset:0
  s_nop 6
  v_cvt_pk_bf16_f32 v22, v40, v41
  v_cvt_pk_bf16_f32 v23, v42, v43
  v_bfi_b32 v22, 1, s57, v22
  buffer_store_dwordx2 v[22:23], v7, s[4:7], s21 offen offset:64
  ds_read_b128 v[68:71], v4 offset:0
  ds_read_b128 v[72:75], v4 offset:1024
  ds_read_b128 v[76:79], v4 offset:4096
  ds_read_b128 v[80:83], v4 offset:5120
  ds_read_b128 v[84:87], v4 offset:8192
  ds_read_b128 v[88:91], v4 offset:9216
  ds_read_b128 v[92:95], v4 offset:2048
  ds_read_b128 v[96:99], v4 offset:3072
  ds_read_b128 v[100:103], v4 offset:6144
  ds_read_b128 v[104:107], v4 offset:7168
  ds_read_b128 v[108:111], v4 offset:10240
  ds_read_b128 v[112:115], v4 offset:11264
  v_mov_b64 v[16:17], 0
  v_mov_b64 v[18:19], 0
  v_mov_b64 v[20:21], 0
  v_mov_b64 v[22:23], 0
  v_mov_b64 v[24:25], 0
  v_mov_b64 v[26:27], 0
  s_mov_b32 s19, 0
  v_mov_b32 v49, -1
  ds_read_b64 v[44:45], v2 offset:32256
  s_waitcnt lgkmcnt(0)
  v_readfirstlane_b32 s38, v44
  v_readfirstlane_b32 s37, v45
  s_nop 0
  s_add_u32 s37, s37, 30
  s_cmp_ge_u32 s38, 30
  s_cselect_b32 s38, s37, s38
  s_cmp_ge_u32 s38, 64
  s_cselect_b32 s38, 100, s38
  s_sub_u32 s38, s38, 1
  s_max_i32 s30, s30, s38
  s_waitcnt vmcnt(1)
  buffer_load_dwordx4 v[52:55], v2, s[4:7], s22 offen offset:0 sc1
  buffer_load_dwordx4 v[56:59], v2, s[4:7], s22 offen offset:1024 sc1
  buffer_load_dwordx4 v[60:63], v2, s[4:7], s22 offen offset:2048 sc1
  buffer_load_dwordx4 v[64:67], v2, s[4:7], s22 offen offset:3072 sc1
  s_waitcnt lgkmcnt(12)
  s_waitcnt vmcnt(3)
  v_mfma_f32_16x16x32_bf16 v[120:123], v[116:119], v[52:55], 0
  v_xor_b32 v48, s57, v52
  v_bitop3_b32 v48, v48, v54, s57 bitop3:0xf6
  s_waitcnt vmcnt(2)
  v_mfma_f32_16x16x32_bf16 v[120:123], v[116:119], v[56:59], v[120:123]
  v_bitop3_b32 v48, v48, v56, s57 bitop3:0xf6
  v_bitop3_b32 v48, v48, v58, s57 bitop3:0xf6
  s_waitcnt vmcnt(1)
  v_mfma_f32_16x16x32_bf16 v[120:123], v[116:119], v[60:63], v[120:123]
  v_bitop3_b32 v48, v48, v60, s57 bitop3:0xf6
  v_bitop3_b32 v48, v48, v62, s57 bitop3:0xf6
  s_waitcnt vmcnt(0)
  v_mfma_f32_16x16x32_bf16 v[120:123], v[116:119], v[64:67], v[120:123]
  v_bitop3_b32 v48, v48, v64, s57 bitop3:0xf6
  v_bitop3_b32 v48, v48, v66, s57 bitop3:0xf6
  v_and_b32 v48, 1, v48
  v_cmp_ne_u32 vcc, 0, v48
  s_cbranch_vccnz T_p1re_90
T_p1ok_91:
  s_nop 2
  v_add_f32_dpp v120, v120, v120 row_ror:8 row_mask:0xf bank_mask:0xf
  v_add_f32_dpp v121, v121, v121 row_ror:8 row_mask:0xf bank_mask:0xf
  v_cvt_pk_bf16_f32 v48, v120, v121
  v_min_u32 v48, -2, v48
  buffer_store_dword v48, v8, s[4:7], s35 offen
  buffer_store_dword v49, v8, s[4:7], s26 offen
  s_barrier
  ds_read_b128 v[28:31], v2 offset:16384
  ds_read_b128 v[32:35], v2 offset:20480
  ds_read_b128 v[36:39], v2 offset:8192
  ds_read_b128 v[40:43], v2 offset:9216
  ds_read_b128 v[44:47], v2 offset:10240
  ds_read_b128 v[48:51], v2 offset:11264
  buffer_load_dwordx4 v[124:127], v2, s[4:7], s24 offen offset:0 sc1
  buffer_load_dwordx4 v[116:119], v2, s[4:7], s25 offen offset:0 sc1
  ds_read_b128 v[52:55], v2 offset:12288
  ds_read_b128 v[56:59], v2 offset:13312
  ds_read_b128 v[60:63], v2 offset:14336
  ds_read_b128 v[64:67], v2 offset:15360
  buffer_load_dwordx4 v[124:127], v2, s[4:7], s24 offen offset:0 sc1
  buffer_load_dwordx4 v[116:119], v2, s[4:7], s25 offen offset:0 sc1
  s_mov_b32 s19, 0
  s_branch T_loop_81
T_p1re_90:
  s_mov_b64 exec, vcc
  buffer_load_dwordx4 v[52:55], v2, s[4:7], s22 offen offset:0 sc1
  buffer_load_dwordx4 v[56:59], v2, s[4:7], s22 offen offset:1024 sc1
  buffer_load_dwordx4 v[60:63], v2, s[4:7], s22 offen offset:2048 sc1
  buffer_load_dwordx4 v[64:67], v2, s[4:7], s22 offen offset:3072 sc1
  s_mov_b64 exec, -1
  s_add_u32 s19, s19, 1
  s_cmp_gt_u32 s19, 32768
  s_cbranch_scc1 M_exit
  s_waitcnt vmcnt(3)
  v_mfma_f32_16x16x32_bf16 v[120:123], v[116:119], v[52:55], 0
  v_xor_b32 v48, s57, v52
  v_bitop3_b32 v48, v48, v54, s57 bitop3:0xf6
  s_waitcnt vmcnt(2)
  v_mfma_f32_16x16x32_bf16 v[120:123], v[116:119], v[56:59], v[120:123]
  v_bitop3_b32 v48, v48, v56, s57 bitop3:0xf6
  v_bitop3_b32 v48, v48, v58, s57 bitop3:0xf6
  s_waitcnt vmcnt(1)
  v_mfma_f32_16x16x32_bf16 v[120:123], v[116:119], v[60:63], v[120:123]
  v_bitop3_b32 v48, v48, v60, s57 bitop3:0xf6
  v_bitop3_b32 v48, v48, v62, s57 bitop3:0xf6
  s_waitcnt vmcnt(0)
  v_mfma_f32_16x16x32_bf16 v[120:123], v[116:119], v[64:67], v[120:123]
  v_bitop3_b32 v48, v48, v64, s57 bitop3:0xf6
  v_bitop3_b32 v48, v48, v66, s57 bitop3:0xf6
  v_and_b32 v48, 1, v48
  v_cmp_ne_u32 vcc, 0, v48
  s_cbranch_vccnz T_p1re_90
  s_branch T_p1ok_91
T_kvw_85:
  s_mov_b32 s19, 0
  s_branch T_kvok_93
T_kv_92:
  s_sleep 4
  s_add_u32 s19, s19, 1
  s_cmp_gt_u32 s19, 32768
  s_cbranch_scc1 M_exit
T_kvok_93:
  s_add_u32 s39, s99, 128
  s_mov_b32 s38, 0
  s_mov_b32 s37, 0
  s_atomic_or s38, s[58:59], s99 glc
  s_atomic_or s37, s[58:59], s39 glc
  s_waitcnt lgkmcnt(0)
  s_add_u32 s37, s37, 30
  s_cmp_ge_u32 s38, 30
  s_cselect_b32 s38, s37, s38
  s_cmp_ge_u32 s38, 64
  s_cselect_b32 s38, 100, s38
  s_sub_u32 s38, s38, 1
  s_max_i32 s30, s30, s38
  s_cmp_ge_i32 s14, s30
  s_cbranch_scc1 T_kv_92
  s_branch T_kvb_86
T_slow_87:
  s_nop 7
  v_max3_f32 v100, v16, v17, v18
  v_max3_f32 v100, v100, v19, v20
  v_max3_f32 v100, v100, v21, v22
  v_max3_f32 v100, v100, v23, v112
  v_max3_f32 v100, v100, v113, v114
  v_max_f32 v100, v100, v115
  v_mov_b32 v101, v100
  s_nop 1
  v_permlane32_swap_b32 v100, v101
  s_nop 1
  v_max_f32 v100, v100, v101
  v_mov_b32 v101, v100
  s_nop 1
  v_permlane16_swap_b32 v100, v101
  s_nop 1
  v_max_f32 v100, v100, v101
  v_sub_f32 v16, v16, v100
  v_sub_f32 v17, v17, v100
  v_sub_f32 v18, v18, v100
  v_sub_f32 v19, v19, v100
  v_exp_f32 v16, v16
  v_exp_f32 v17, v17
  v_exp_f32 v18, v18
  v_exp_f32 v19, v19
  v_sub_f32 v20, v20, v100
  v_sub_f32 v21, v21, v100
  v_sub_f32 v22, v22, v100
  v_sub_f32 v23, v23, v100
  v_exp_f32 v20, v20
  v_exp_f32 v21, v21
  v_exp_f32 v22, v22
  v_exp_f32 v23, v23
  v_sub_f32 v112, v112, v100
  v_sub_f32 v113, v113, v100
  v_sub_f32 v114, v114, v100
  v_sub_f32 v115, v115, v100
  v_exp_f32 v112, v112
  v_exp_f32 v113, v113
  v_exp_f32 v114, v114
  v_exp_f32 v115, v115
  s_nop 0
  v_cvt_pk_bf16_f32 v44, v16, v17
  v_cvt_pk_bf16_f32 v45, v18, v19
  v_cvt_pk_bf16_f32 v46, v20, v21
  v_cvt_pk_bf16_f32 v47, v22, v23
  v_cvt_pk_bf16_f32 v84, v112, v113
  v_cvt_pk_bf16_f32 v85, v114, v115
  v_cndmask_b32 v48, v84, 0, s[16:17]
  v_cndmask_b32 v49, v85, 0, s[16:17]
  v_cndmask_b32 v50, 0, v84, s[16:17]
  v_cndmask_b32 v51, 0, v85, s[16:17]
  s_nop 1
  v_mfma_f32_16x16x16_bf16 v[88:91], v[12:13], v[48:49], 0
  v_mfma_f32_16x16x16_bf16 v[24:27], v[120:121], v[48:49], 0
  v_mfma_f32_16x16x16_bf16 v[116:119], v[120:121], v[50:51], 0
  v_mfma_f32_16x16x32_bf16 v[88:91], v[12:15], v[44:47], v[88:91]
  v_mfma_f32_16x16x32_bf16 v[24:27], v[28:31], v[44:47], v[24:27]
  v_mfma_f32_16x16x32_bf16 v[116:119], v[32:35], v[44:47], v[116:119]
  s_nop 7
  s_nop 1
  v_rcp_f32 v89, v88
  s_nop 0
  v_mul_f32 v24, v89, v24
  v_mul_f32 v25, v89, v25
  s_branch T_back_88
T_w_78:
  s_mov_b32 s19, 0
  v_mov_b64 v[16:17], 0
  v_mov_b64 v[18:19], 0
  v_mov_b64 v[20:21], 0
  v_mov_b64 v[22:23], 0
  v_mov_b64 v[24:25], 0
  v_mov_b64 v[26:27], 0
  buffer_load_dwordx4 v[124:127], v2, s[4:7], s24 offen offset:1024 sc1
  buffer_load_dwordx4 v[116:119], v2, s[4:7], s25 offen offset:1024 sc1
  buffer_load_dwordx4 v[124:127], v2, s[4:7], s24 offen offset:1024 sc1
  buffer_load_dwordx4 v[116:119], v2, s[4:7], s25 offen offset:1024 sc1
  s_branch T_loop_94
.p2align 6
T_retry_95:
  s_mov_b64 exec, vcc
  buffer_load_dwordx4 v[124:127], v2, s[4:7], s24 offen offset:1024 sc1
  buffer_load_dwordx4 v[116:119], v2, s[4:7], s25 offen offset:1024 sc1
  s_mov_b64 exec, -1
  s_add_u32 s19, s19, 1
  s_cmp_gt_u32 s19, 32768
  s_cbranch_scc1 M_exit
T_loop_94:
  s_waitcnt vmcnt(3) lgkmcnt(0)
  v_max3_u32 v123, v124, v125, v126
  v_max_u32 v123, v123, v127
  v_mov_b32_dpp v120, v124 row_ror:8 row_mask:0xf bank_mask:0xf
  v_mov_b32_dpp v121, v125 row_ror:8 row_mask:0xf bank_mask:0xf
  s_waitcnt vmcnt(2)
  v_max3_u32 v123, v123, v116, v117
  v_max3_u32 v123, v123, v118, v119
  v_cmp_eq_u32 vcc, -1, v123
  s_cbranch_vccnz T_retry_95
  v_smfmac_f32_16x16x64_bf16 v[16:19], v[124:127], v[68:75], v0
  s_add_u32 s14, s14, 1
  ds_write_b128 v2, v[124:127] offset:1024
  v_mov_b32_dpp v122, v126 row_ror:8 row_mask:0xf bank_mask:0xf
  v_smfmac_f32_16x16x64_bf16 v[20:23], v[124:127], v[76:83], v0
  s_and_b32 s57, s14, 1
  v_mov_b32_dpp v123, v127 row_ror:8 row_mask:0xf bank_mask:0xf
  v_smfmac_f32_16x16x64_bf16 v[24:27], v[124:127], v[84:91], v0
  s_and_b32 s36, s14, 3
  ds_write_b128 v2, v[116:119] offset:5120
  v_smfmac_f32_16x16x64_bf16 v[16:19], v[120:123], v[92:99], v0
  s_lshl_b32 s36, s36, 13
  v_mov_b32_dpp v84, v116 row_ror:8 row_mask:0xf bank_mask:0xf
  v_smfmac_f32_16x16x64_bf16 v[20:23], v[120:123], v[100:107], v0
  s_add_u32 s26, s36, s23
  ds_read_b128 v[68:71], v4 offset:12288
  v_mov_b32_dpp v85, v117 row_ror:8 row_mask:0xf bank_mask:0xf
  v_smfmac_f32_16x16x64_bf16 v[24:27], v[120:123], v[108:115], v0
  s_add_u32 s36, s36, 8192
  ds_read_b128 v[72:75], v4 offset:13312
  v_mov_b32_dpp v86, v118 row_ror:8 row_mask:0xf bank_mask:0xf
  v_smfmac_f32_16x16x64_bf16 v[16:19], v[116:119], v[224:231], v0
  s_and_b32 s36, s36, 0x7fff
  ds_read_b128 v[76:79], v4 offset:14336
  v_mov_b32_dpp v87, v119 row_ror:8 row_mask:0xf bank_mask:0xf
  v_smfmac_f32_16x16x64_bf16 v[20:23], v[116:119], v[240:247], v0
  s_waitcnt lgkmcnt(3)
  s_barrier
  ds_read_b128 v[100:103], v2 offset:0
  v_smfmac_f32_16x16x64_bf16 v[24:27], v[116:119], a[0:7], v0
  s_mov_b32 m0, s31
  ds_read_b128 v[120:123], v1 offset:0
  v_smfmac_f32_16x16x64_bf16 v[16:19], v[84:87], v[232:239], v0
  s_cmp_ge_i32 s14, s30
  s_cbranch_scc1 T_kvw_98
T_kvb_99:
  v_smfmac_f32_16x16x64_bf16 v[20:23], v[84:87], v[248:255], v0
  ds_read_b128 v[80:83], v4 offset:15360
  v_smfmac_f32_16x16x64_bf16 v[24:27], v[84:87], a[8:15], v0
  s_waitcnt lgkmcnt(2)
  buffer_load_dwordx4 v9, s[4:7], s27 offen sc1 lds
  v_smfmac_f32_16x16x64_bf16 v[16:19], v[100:103], v[128:135], v0
  ds_read_b128 v[92:95], v2 offset:3072
  s_mov_b32 m0, s32
  v_smfmac_f32_16x16x64_bf16 v[20:23], v[100:103], v[144:151], v0
  ds_read_b128 v[96:99], v1 offset:3072
  v_smfmac_f32_16x16x64_bf16 v[24:27], v[100:103], v[68:75], v0
  s_waitcnt vmcnt(1) lgkmcnt(3)
  ds_read_b128 v[116:119], v2 offset:2048
  v_smfmac_f32_16x16x64_bf16 v[16:19], v[120:123], v[136:143], v0
  ds_read_b128 v[124:127], v1 offset:2048
  buffer_load_dwordx4 v9, s[4:7], s27 offen offset:128 sc1 lds
  v_smfmac_f32_16x16x64_bf16 v[20:23], v[120:123], v[152:159], v0
  s_waitcnt lgkmcnt(4)
  ds_read_b128 v[104:107], v2 offset:4096
  s_mov_b32 m0, s33
  v_smfmac_f32_16x16x64_bf16 v[24:27], v[120:123], v[76:83], v0
  s_waitcnt lgkmcnt(4)
  ds_read_b128 v[108:111], v1 offset:4096
  v_smfmac_f32_16x16x64_bf16 v[16:19], v[92:95], v[160:167], v0
  s_waitcnt lgkmcnt(4)
  ds_read_b128 v[112:115], v2 offset:7168
  v_smfmac_f32_16x16x64_bf16 v[16:19], v[96:99], v[168:175], v0
  s_waitcnt lgkmcnt(4)
  ds_read_b128 v[84:87], v1 offset:7168
  buffer_load_dwordx4 v10, s[4:7], s28 offen sc1 lds
  v_smfmac_f32_16x16x64_bf16 v[16:19], v[116:119], v[192:199], v0
  s_waitcnt lgkmcnt(4)
  ds_read_b128 v[88:91], v2 offset:6144
  s_mov_b32 m0, s34
  v_smfmac_f32_16x16x64_bf16 v[16:19], v[124:127], v[200:207], v0
  s_waitcnt lgkmcnt(4)
  ds_read_b128 v[100:103], v1 offset:6144
  v_smfmac_f32_16x16x64_bf16 v[16:19], v[104:107], a[16:23], v0
  s_waitcnt lgkmcnt(4)
  ds_read_b128 v[68:71], v4 offset:16384
  v_smfmac_f32_16x16x64_bf16 v[16:19], v[108:111], a[24:31], v0
  s_waitcnt lgkmcnt(4)
  ds_read_b128 v[72:75], v4 offset:17408
  buffer_load_dwordx4 v10, s[4:7], s28 offen offset:256 sc1 lds
  v_smfmac_f32_16x16x64_bf16 v[16:19], v[112:115], a[64:71], v0
  s_waitcnt lgkmcnt(4)
  ds_read_b128 v[76:79], v4 offset:18432
  v_smfmac_f32_16x16x64_bf16 v[16:19], v[84:87], a[72:79], v0
  s_waitcnt lgkmcnt(4)
  ds_read_b128 v[80:83], v4 offset:19456
  v_smfmac_f32_16x16x64_bf16 v[16:19], v[88:91], a[112:119], v0
  s_waitcnt lgkmcnt(4)
  v_smfmac_f32_16x16x64_bf16 v[16:19], v[100:103], a[120:127], v0
  s_add_u32 s24, s36, 145752064
  s_add_u32 s25, s36, 145756160
  v_smfmac_f32_16x16x64_bf16 v[20:23], v[92:95], v[176:183], v0
  s_add_u32 s35, s36, s23
  v_smfmac_f32_16x16x64_bf16 v[20:23], v[96:99], v[184:191], v0
  s_waitcnt lgkmcnt(2)
  v_smfmac_f32_16x16x64_bf16 v[20:23], v[116:119], v[68:75], v0
  s_waitcnt lgkmcnt(0)
  ds_read_b128 v[68:71], v4 offset:20480
  v_mul_f32 v16, s18, v16
  v_smfmac_f32_16x16x64_bf16 v[20:23], v[124:127], v[76:83], v0
  ds_read_b128 v[72:75], v4 offset:21504
  v_mul_f32 v17, s18, v17
  v_smfmac_f32_16x16x64_bf16 v[20:23], v[104:107], a[32:39], v0
  ds_read_b128 v[76:79], v4 offset:22528
  v_mul_f32 v18, s18, v18
  v_smfmac_f32_16x16x64_bf16 v[20:23], v[108:111], a[40:47], v0
  ds_read_b128 v[80:83], v4 offset:23552
  v_mul_f32 v19, s18, v19
  v_smfmac_f32_16x16x64_bf16 v[20:23], v[112:115], a[80:87], v0
  v_cvt_pk_bf16_f32 v120, v16, v17
  v_smfmac_f32_16x16x64_bf16 v[20:23], v[84:87], a[88:95], v0
  v_cvt_pk_bf16_f32 v121, v18, v19
  v_smfmac_f32_16x16x64_bf16 v[20:23], v[88:91], a[128:135], v0
  ds_write_b64 v5, v[120:121] offset:24576
  v_smfmac_f32_16x16x64_bf16 v[20:23], v[100:103], a[136:143], v0
  s_waitcnt lgkmcnt(3)
  v_smfmac_f32_16x16x64_bf16 v[24:27], v[92:95], v[68:75], v0
  s_waitcnt lgkmcnt(1)
  v_mov_b64 v[92:93], 0
  v_smfmac_f32_16x16x64_bf16 v[24:27], v[96:99], v[76:83], v0
  s_nop 1
  v_cvt_pk_bf16_f32 v122, v20, v21
  v_cvt_pk_bf16_f32 v123, v22, v23
  v_smfmac_f32_16x16x64_bf16 v[24:27], v[116:119], v[208:215], v0
  ds_write_b64 v5, v[122:123] offset:26880
  v_mov_b64 v[94:95], 0
  v_smfmac_f32_16x16x64_bf16 v[24:27], v[124:127], v[216:223], v0
  s_waitcnt lgkmcnt(1)
  s_barrier
  ds_read_b64_tr_b16 v[68:69], v6 offset:24576
  v_smfmac_f32_16x16x64_bf16 v[24:27], v[104:107], a[48:55], v0
  s_add_u32 s27, s27, 8192
  ds_read_b64_tr_b16 v[70:71], v6 offset:24640
  ds_read_b64_tr_b16 v[72:73], v6 offset:24832
  v_smfmac_f32_16x16x64_bf16 v[24:27], v[108:111], a[56:63], v0
  s_add_u32 s28, s28, 8192
  ds_read_b64_tr_b16 v[74:75], v6 offset:24896
  ds_read_b64_tr_b16 v[76:77], v6 offset:25088
  v_smfmac_f32_16x16x64_bf16 v[24:27], v[112:115], a[96:103], v0
  s_nop 0
  ds_read_b64_tr_b16 v[78:79], v6 offset:25152
  ds_read_b64_tr_b16 v[80:81], v6 offset:25344
  v_smfmac_f32_16x16x64_bf16 v[24:27], v[84:87], a[104:111], v0
  ds_read_b64_tr_b16 v[82:83], v6 offset:25408
  v_mov_b64 v[96:97], 0
  v_smfmac_f32_16x16x64_bf16 v[24:27], v[88:91], a[144:151], v0
  s_waitcnt lgkmcnt(8)
  s_barrier
  ds_read_b64_tr_b16 v[116:117], v6 offset:26880
  v_smfmac_f32_16x16x64_bf16 v[24:27], v[100:103], a[152:159], v0
  s_waitcnt lgkmcnt(7)
  ds_read_b64_tr_b16 v[118:119], v6 offset:26944
  buffer_store_dwordx2 v[122:123], v5, s[4:7], s29 offen sc1
  v_mfma_f32_16x16x32_bf16 v[16:19], v[36:39], v[68:71], 0
  s_waitcnt lgkmcnt(6)
  ds_read_b64_tr_b16 v[124:125], v6 offset:27136
  ds_read_b64_tr_b16 v[126:127], v6 offset:27200
  v_mfma_f32_16x16x32_bf16 v[16:19], v[40:43], v[72:75], v[16:19]
  s_waitcnt lgkmcnt(6)
  ds_read_b64_tr_b16 v[104:105], v6 offset:27392
  ds_read_b64_tr_b16 v[106:107], v6 offset:27456
  v_mfma_f32_16x16x32_bf16 v[16:19], v[44:47], v[76:79], v[16:19]
  s_waitcnt lgkmcnt(6)
  ds_read_b64_tr_b16 v[108:109], v6 offset:27648
  ds_read_b64_tr_b16 v[110:111], v6 offset:27712
  v_mfma_f32_16x16x32_bf16 v[16:19], v[48:51], v[80:83], v[16:19]
  s_waitcnt lgkmcnt(6)
  v_cvt_pk_bf16_f32 v120, v24, v25
  v_cvt_pk_bf16_f32 v121, v26, v27
  v_mfma_f32_16x16x32_bf16 v[112:115], v[116:119], v[68:71], 0
  s_waitcnt lgkmcnt(4)
  buffer_store_dwordx2 v[120:121], v5, s[4:7], s29 offen offset:2304 sc1
  v_mov_b64 v[98:99], 0
  v_mfma_f32_16x16x32_bf16 v[112:115], v[124:127], v[72:75], v[112:115]
  s_waitcnt lgkmcnt(2)
  v_mov_b64 v[36:37], 0
  v_exp_f32 v100, v16
  v_mfma_f32_16x16x32_bf16 v[112:115], v[104:107], v[76:79], v[112:115]
  s_waitcnt lgkmcnt(0)
  v_exp_f32 v101, v17
  v_mfma_f32_16x16x32_bf16 v[112:115], v[108:111], v[80:83], v[112:115]
  s_add_u32 s29, s29, 147456
  v_exp_f32 v102, v18
  v_mfma_f32_16x16x32_bf16 v[20:23], v[52:55], v[68:71], 0
  s_cmp_eq_u32 s14, 63
  v_exp_f32 v103, v19
  v_mfma_f32_16x16x32_bf16 v[20:23], v[56:59], v[72:75], v[20:23]
  s_cbranch_scc1 M_tdone
  v_cvt_pk_bf16_f32 v44, v100, v101
  v_cvt_pk_bf16_f32 v45, v102, v103
  v_mfma_f32_16x16x32_bf16 v[20:23], v[60:63], v[76:79], v[20:23]
  v_exp_f32 v100, v112
  v_mfma_f32_16x16x32_bf16 v[20:23], v[64:67], v[80:83], v[20:23]
  v_exp_f32 v101, v113
  v_exp_f32 v102, v114
  v_exp_f32 v103, v115
  v_cvt_pk_bf16_f32 v84, v100, v101
  v_cvt_pk_bf16_f32 v85, v102, v103
  v_cndmask_b32 v48, v84, 0, s[16:17]
  v_cndmask_b32 v49, v85, 0, s[16:17]
  v_cndmask_b32 v50, 0, v84, s[16:17]
  v_cndmask_b32 v51, 0, v85, s[16:17]
  v_exp_f32 v100, v20
  v_mfma_f32_16x16x16_bf16 v[88:91], v[12:13], v[48:49], 0
  v_exp_f32 v101, v21
  v_mfma_f32_16x16x16_bf16 v[24:27], v[120:121], v[48:49], 0
  v_exp_f32 v102, v22
  v_mfma_f32_16x16x16_bf16 v[116:119], v[120:121], v[50:51], 0
  v_exp_f32 v103, v23
  v_cvt_pk_bf16_f32 v46, v100, v101
  v_cvt_pk_bf16_f32 v47, v102, v103
  v_mov_b64 v[38:39], 0
  s_nop 0
  v_mfma_f32_16x16x32_bf16 v[88:91], v[12:15], v[44:47], v[88:91]
  v_mov_b64 v[40:41], 0
  v_mov_b64 v[42:43], 0
  v_mfma_f32_16x16x32_bf16 v[24:27], v[28:31], v[44:47], v[24:27]
  ds_read_b128 v[52:55], v4 offset:24576
  ds_read_b128 v[56:59], v4 offset:25600
  v_mfma_f32_16x16x32_bf16 v[116:119], v[32:35], v[44:47], v[116:119]
  s_nop 1
  v_rcp_f32 v89, v88
  v_subrev_u32 v100, s54, v88
  v_cmp_le_u32 vcc, s55, v100
  v_mul_f32 v24, v89, v24
  v_mul_f32 v25, v89, v25
  s_cbranch_vccnz T_slow_100
T_back_101:
  v_cvt_pk_bf16_f32 v124, v24, v25
  v_pk_mul_f32 v[26:27], v[26:27], v[88:89] op_sel:[0,1] op_sel_hi:[1,1]
  v_pk_mul_f32 v[116:117], v[116:117], v[88:89] op_sel:[0,1] op_sel_hi:[1,1]
  v_pk_mul_f32 v[118:119], v[118:119], v[88:89] op_sel:[0,1] op_sel_hi:[1,1]
  v_cvt_pk_bf16_f32 v125, v26, v27
  v_cvt_pk_bf16_f32 v126, v116, v117
  v_cvt_pk_bf16_f32 v127, v118, v119
  ds_write_b128 v11, v[124:127] offset:29696
  s_nop 0
  v_smfmac_f32_16x16x64_bf16 v[92:95], v[124:127], a[160:167], v0
  v_smfmac_f32_16x16x64_bf16 v[96:99], v[124:127], a[168:175], v0
  v_smfmac_f32_16x16x64_bf16 v[36:39], v[124:127], a[176:183], v0
  v_smfmac_f32_16x16x64_bf16 v[40:43], v[124:127], a[184:191], v0
  s_waitcnt lgkmcnt(0)
  s_barrier
  ds_read_b128 v[104:107], v11 offset:29184
  ds_read_b128 v[108:111], v11 offset:30720
  ds_read_b128 v[68:71], v11 offset:30208
  s_waitcnt lgkmcnt(2)
  v_smfmac_f32_16x16x64_bf16 v[92:95], v[104:107], a[192:199], v0
  s_waitcnt lgkmcnt(1)
  ds_read_b128 v[76:79], v4 offset:28672
  v_smfmac_f32_16x16x64_bf16 v[92:95], v[108:111], a[224:231], v0
  s_waitcnt lgkmcnt(1)
  ds_read_b128 v[80:83], v4 offset:29696
  v_smfmac_f32_16x16x64_bf16 v[92:95], v[68:71], a[240:247], v0
  ds_read_b128 v[60:63], v4 offset:26624
  v_smfmac_f32_16x16x64_bf16 v[96:99], v[104:107], a[200:207], v0
  ds_read_b128 v[64:67], v4 offset:27648
  v_smfmac_f32_16x16x64_bf16 v[96:99], v[108:111], a[232:239], v0
  ds_read_b128 v[28:31], v4 offset:30720
  s_nop 0
  v_cvt_pk_bf16_f32 v16, v92, v93
  v_cvt_pk_bf16_f32 v17, v94, v95
  v_bfi_b32 v16, 1, s57, v16
  v_smfmac_f32_16x16x64_bf16 v[96:99], v[68:71], a[248:255], v0
  buffer_store_dwordx2 v[16:17], v7, s[4:7], s20 offen offset:0
  v_smfmac_f32_16x16x64_bf16 v[36:39], v[104:107], a[208:215], v0
  ds_read_b128 v[32:35], v4 offset:31744
  v_smfmac_f32_16x16x64_bf16 v[36:39], v[108:111], v[52:59], v0
  s_waitcnt lgkmcnt(4)
  s_nop 0
  v_cvt_pk_bf16_f32 v18, v96, v97
  v_cvt_pk_bf16_f32 v19, v98, v99
  v_bfi_b32 v18, 1, s57, v18
  v_smfmac_f32_16x16x64_bf16 v[36:39], v[68:71], v[76:83], v0
  buffer_store_dwordx2 v[18:19], v7, s[4:7], s20 offen offset:64
  v_smfmac_f32_16x16x64_bf16 v[40:43], v[104:107], a[216:223], v0
  s_waitcnt lgkmcnt(2)
  ds_read_b128 v[116:119], v2 offset:31232
  v_smfmac_f32_16x16x64_bf16 v[40:43], v[108:111], v[60:67], v0
  s_waitcnt lgkmcnt(1)
  s_nop 0
  v_cvt_pk_bf16_f32 v20, v36, v37
  v_cvt_pk_bf16_f32 v21, v38, v39
  v_bfi_b32 v20, 1, s57, v20
  v_smfmac_f32_16x16x64_bf16 v[40:43], v[68:71], v[28:35], v0
  buffer_store_dwordx2 v[20:21], v7, s[4:7], s21 offen offset:0
  s_nop 6
  v_cvt_pk_bf16_f32 v22, v40, v41
  v_cvt_pk_bf16_f32 v23, v42, v43
  v_bfi_b32 v22, 1, s57, v22
  buffer_store_dwordx2 v[22:23], v7, s[4:7], s21 offen offset:64
  ds_read_b128 v[68:71], v4 offset:0
  ds_read_b128 v[72:75], v4 offset:1024
  ds_read_b128 v[76:79], v4 offset:4096
  ds_read_b128 v[80:83], v4 offset:5120
  ds_read_b128 v[84:87], v4 offset:8192
  ds_read_b128 v[88:91], v4 offset:9216
  ds_read_b128 v[92:95], v4 offset:2048
  ds_read_b128 v[96:99], v4 offset:3072
  ds_read_b128 v[100:103], v4 offset:6144
  ds_read_b128 v[104:107], v4 offset:7168
  ds_read_b128 v[108:111], v4 offset:10240
  ds_read_b128 v[112:115], v4 offset:11264
  v_mov_b64 v[16:17], 0
  v_mov_b64 v[18:19], 0
  v_mov_b64 v[20:21], 0
  v_mov_b64 v[22:23], 0
  v_mov_b64 v[24:25], 0
  v_mov_b64 v[26:27], 0
  s_mov_b32 s19, 0
  v_mov_b32 v49, -1
  ds_read_b64 v[44:45], v2 offset:32256
  s_waitcnt lgkmcnt(0)
  v_readfirstlane_b32 s38, v44
  v_readfirstlane_b32 s37, v45
  s_nop 0
  s_add_u32 s37, s37, 30
  s_cmp_ge_u32 s38, 30
  s_cselect_b32 s38, s37, s38
  s_cmp_ge_u32 s38, 64
  s_cselect_b32 s38, 100, s38
  s_sub_u32 s38, s38, 1
  s_max_i32 s30, s30, s38
  s_waitcnt vmcnt(1)
  buffer_load_dwordx4 v[52:55], v2, s[4:7], s22 offen offset:0 sc1
  buffer_load_dwordx4 v[56:59], v2, s[4:7], s22 offen offset:1024 sc1
  buffer_load_dwordx4 v[60:63], v2, s[4:7], s22 offen offset:2048 sc1
  buffer_load_dwordx4 v[64:67], v2, s[4:7], s22 offen offset:3072 sc1
  s_waitcnt lgkmcnt(12)
  s_waitcnt vmcnt(3)
  v_mfma_f32_16x16x32_bf16 v[120:123], v[116:119], v[52:55], 0
  v_xor_b32 v48, s57, v52
  v_bitop3_b32 v48, v48, v54, s57 bitop3:0xf6
  s_waitcnt vmcnt(2)
  v_mfma_f32_16x16x32_bf16 v[120:123], v[116:119], v[56:59], v[120:123]
  v_bitop3_b32 v48, v48, v56, s57 bitop3:0xf6
  v_bitop3_b32 v48, v48, v58, s57 bitop3:0xf6
  s_waitcnt vmcnt(1)
  v_mfma_f32_16x16x32_bf16 v[120:123], v[116:119], v[60:63], v[120:123]
  v_bitop3_b32 v48, v48, v60, s57 bitop3:0xf6
  v_bitop3_b32 v48, v48, v62, s57 bitop3:0xf6
  s_waitcnt vmcnt(0)
  v_mfma_f32_16x16x32_bf16 v[120:123], v[116:119], v[64:67], v[120:123]
  v_bitop3_b32 v48, v48, v64, s57 bitop3:0xf6
  v_bitop3_b32 v48, v48, v66, s57 bitop3:0xf6
  v_and_b32 v48, 1, v48
  v_cmp_ne_u32 vcc, 0, v48
  s_cbranch_vccnz T_p1re_103
T_p1ok_104:
  s_nop 2
  v_add_f32_dpp v120, v120, v120 row_ror:8 row_mask:0xf bank_mask:0xf
  v_add_f32_dpp v121, v121, v121 row_ror:8 row_mask:0xf bank_mask:0xf
  v_cvt_pk_bf16_f32 v48, v120, v121
  v_min_u32 v48, -2, v48
  buffer_store_dword v48, v8, s[4:7], s35 offen
  buffer_store_dword v49, v8, s[4:7], s26 offen
  s_barrier
  ds_read_b128 v[28:31], v2 offset:17408
  ds_read_b128 v[32:35], v2 offset:21504
  ds_read_b128 v[36:39], v2 offset:8192
  ds_read_b128 v[40:43], v2 offset:9216
  ds_read_b128 v[44:47], v2 offset:10240
  ds_read_b128 v[48:51], v2 offset:11264
  buffer_load_dwordx4 v[124:127], v2, s[4:7], s24 offen offset:1024 sc1
  buffer_load_dwordx4 v[116:119], v2, s[4:7], s25 offen offset:1024 sc1
  ds_read_b128 v[52:55], v2 offset:12288
  ds_read_b128 v[56:59], v2 offset:13312
  ds_read_b128 v[60:63], v2 offset:14336
  ds_read_b128 v[64:67], v2 offset:15360
  buffer_load_dwordx4 v[124:127], v2, s[4:7], s24 offen offset:1024 sc1
  buffer_load_dwordx4 v[116:119], v2, s[4:7], s25 offen offset:1024 sc1
  s_mov_b32 s19, 0
  s_branch T_loop_94
T_p1re_103:
  s_mov_b64 exec, vcc
  buffer_load_dwordx4 v[52:55], v2, s[4:7], s22 offen offset:0 sc1
  buffer_load_dwordx4 v[56:59], v2, s[4:7], s22 offen offset:1024 sc1
  buffer_load_dwordx4 v[60:63], v2, s[4:7], s22 offen offset:2048 sc1
  buffer_load_dwordx4 v[64:67], v2, s[4:7], s22 offen offset:3072 sc1
  s_mov_b64 exec, -1
  s_add_u32 s19, s19, 1
  s_cmp_gt_u32 s19, 32768
  s_cbranch_scc1 M_exit
  s_waitcnt vmcnt(3)
  v_mfma_f32_16x16x32_bf16 v[120:123], v[116:119], v[52:55], 0
  v_xor_b32 v48, s57, v52
  v_bitop3_b32 v48, v48, v54, s57 bitop3:0xf6
  s_waitcnt vmcnt(2)
  v_mfma_f32_16x16x32_bf16 v[120:123], v[116:119], v[56:59], v[120:123]
  v_bitop3_b32 v48, v48, v56, s57 bitop3:0xf6
  v_bitop3_b32 v48, v48, v58, s57 bitop3:0xf6
  s_waitcnt vmcnt(1)
  v_mfma_f32_16x16x32_bf16 v[120:123], v[116:119], v[60:63], v[120:123]
  v_bitop3_b32 v48, v48, v60, s57 bitop3:0xf6
  v_bitop3_b32 v48, v48, v62, s57 bitop3:0xf6
  s_waitcnt vmcnt(0)
  v_mfma_f32_16x16x32_bf16 v[120:123], v[116:119], v[64:67], v[120:123]
  v_bitop3_b32 v48, v48, v64, s57 bitop3:0xf6
  v_bitop3_b32 v48, v48, v66, s57 bitop3:0xf6
  v_and_b32 v48, 1, v48
  v_cmp_ne_u32 vcc, 0, v48
  s_cbranch_vccnz T_p1re_103
  s_branch T_p1ok_104
T_kvw_98:
  s_mov_b32 s19, 0
  s_branch T_kvok_106
T_kv_105:
  s_sleep 4
  s_add_u32 s19, s19, 1
  s_cmp_gt_u32 s19, 32768
  s_cbranch_scc1 M_exit
T_kvok_106:
  s_add_u32 s39, s99, 128
  s_mov_b32 s38, 0
  s_mov_b32 s37, 0
  s_atomic_or s38, s[58:59], s99 glc
  s_atomic_or s37, s[58:59], s39 glc
  s_waitcnt lgkmcnt(0)
  s_add_u32 s37, s37, 30
  s_cmp_ge_u32 s38, 30
  s_cselect_b32 s38, s37, s38
  s_cmp_ge_u32 s38, 64
  s_cselect_b32 s38, 100, s38
  s_sub_u32 s38, s38, 1
  s_max_i32 s30, s30, s38
  s_cmp_ge_i32 s14, s30
  s_cbranch_scc1 T_kv_105
  s_branch T_kvb_99
T_slow_100:
  s_nop 7
  v_max3_f32 v100, v16, v17, v18
  v_max3_f32 v100, v100, v19, v20
  v_max3_f32 v100, v100, v21, v22
  v_max3_f32 v100, v100, v23, v112
  v_max3_f32 v100, v100, v113, v114
  v_max_f32 v100, v100, v115
  v_mov_b32 v101, v100
  s_nop 1
  v_permlane32_swap_b32 v100, v101
  s_nop 1
  v_max_f32 v100, v100, v101
  v_mov_b32 v101, v100
  s_nop 1
  v_permlane16_swap_b32 v100, v101
  s_nop 1
  v_max_f32 v100, v100, v101
  v_sub_f32 v16, v16, v100
  v_sub_f32 v17, v17, v100
  v_sub_f32 v18, v18, v100
  v_sub_f32 v19, v19, v100
  v_exp_f32 v16, v16
  v_exp_f32 v17, v17
  v_exp_f32 v18, v18
  v_exp_f32 v19, v19
  v_sub_f32 v20, v20, v100
  v_sub_f32 v21, v21, v100
  v_sub_f32 v22, v22, v100
  v_sub_f32 v23, v23, v100
  v_exp_f32 v20, v20
  v_exp_f32 v21, v21
  v_exp_f32 v22, v22
  v_exp_f32 v23, v23
  v_sub_f32 v112, v112, v100
  v_sub_f32 v113, v113, v100
  v_sub_f32 v114, v114, v100
  v_sub_f32 v115, v115, v100
  v_exp_f32 v112, v112
  v_exp_f32 v113, v113
  v_exp_f32 v114, v114
  v_exp_f32 v115, v115
  s_nop 0
  v_cvt_pk_bf16_f32 v44, v16, v17
  v_cvt_pk_bf16_f32 v45, v18, v19
  v_cvt_pk_bf16_f32 v46, v20, v21
  v_cvt_pk_bf16_f32 v47, v22, v23
  v_cvt_pk_bf16_f32 v84, v112, v113
  v_cvt_pk_bf16_f32 v85, v114, v115
  v_cndmask_b32 v48, v84, 0, s[16:17]
  v_cndmask_b32 v49, v85, 0, s[16:17]
  v_cndmask_b32 v50, 0, v84, s[16:17]
  v_cndmask_b32 v51, 0, v85, s[16:17]
  s_nop 1
  v_mfma_f32_16x16x16_bf16 v[88:91], v[12:13], v[48:49], 0
  v_mfma_f32_16x16x16_bf16 v[24:27], v[120:121], v[48:49], 0
  v_mfma_f32_16x16x16_bf16 v[116:119], v[120:121], v[50:51], 0
  v_mfma_f32_16x16x32_bf16 v[88:91], v[12:15], v[44:47], v[88:91]
  v_mfma_f32_16x16x32_bf16 v[24:27], v[28:31], v[44:47], v[24:27]
  v_mfma_f32_16x16x32_bf16 v[116:119], v[32:35], v[44:47], v[116:119]
  s_nop 7
  s_nop 1
  v_rcp_f32 v89, v88
  s_nop 0
  v_mul_f32 v24, v89, v24
  v_mul_f32 v25, v89, v25
  s_branch T_back_101
T_w_79:
  s_mov_b32 s19, 0
  v_mov_b64 v[16:17], 0
  v_mov_b64 v[18:19], 0
  v_mov_b64 v[20:21], 0
  v_mov_b64 v[22:23], 0
  v_mov_b64 v[24:25], 0
  v_mov_b64 v[26:27], 0
  buffer_load_dwordx4 v[124:127], v2, s[4:7], s24 offen offset:2048 sc1
  buffer_load_dwordx4 v[116:119], v2, s[4:7], s25 offen offset:2048 sc1
  buffer_load_dwordx4 v[124:127], v2, s[4:7], s24 offen offset:2048 sc1
  buffer_load_dwordx4 v[116:119], v2, s[4:7], s25 offen offset:2048 sc1
  s_branch T_loop_107
.p2align 6
T_retry_108:
  s_mov_b64 exec, vcc
  buffer_load_dwordx4 v[124:127], v2, s[4:7], s24 offen offset:2048 sc1
  buffer_load_dwordx4 v[116:119], v2, s[4:7], s25 offen offset:2048 sc1
  s_mov_b64 exec, -1
  s_add_u32 s19, s19, 1
  s_cmp_gt_u32 s19, 32768
  s_cbranch_scc1 M_exit
T_loop_107:
  s_waitcnt vmcnt(3) lgkmcnt(0)
  v_max3_u32 v123, v124, v125, v126
  v_max_u32 v123, v123, v127
  v_mov_b32_dpp v120, v124 row_ror:8 row_mask:0xf bank_mask:0xf
  v_mov_b32_dpp v121, v125 row_ror:8 row_mask:0xf bank_mask:0xf
  s_waitcnt vmcnt(2)
  v_max3_u32 v123, v123, v116, v117
  v_max3_u32 v123, v123, v118, v119
  v_cmp_eq_u32 vcc, -1, v123
  s_cbranch_vccnz T_retry_108
  v_smfmac_f32_16x16x64_bf16 v[16:19], v[124:127], v[68:75], v0
  s_add_u32 s14, s14, 1
  ds_write_b128 v2, v[124:127] offset:2048
  v_mov_b32_dpp v122, v126 row_ror:8 row_mask:0xf bank_mask:0xf
  v_smfmac_f32_16x16x64_bf16 v[20:23], v[124:127], v[76:83], v0
  s_and_b32 s57, s14, 1
  v_mov_b32_dpp v123, v127 row_ror:8 row_mask:0xf bank_mask:0xf
  v_smfmac_f32_16x16x64_bf16 v[24:27], v[124:127], v[84:91], v0
  s_and_b32 s36, s14, 3
  ds_write_b128 v2, v[116:119] offset:6144
  v_smfmac_f32_16x16x64_bf16 v[16:19], v[120:123], v[92:99], v0
  s_lshl_b32 s36, s36, 13
  v_mov_b32_dpp v84, v116 row_ror:8 row_mask:0xf bank_mask:0xf
  v_smfmac_f32_16x16x64_bf16 v[20:23], v[120:123], v[100:107], v0
  s_add_u32 s26, s36, s23
  ds_read_b128 v[68:71], v4 offset:12288
  v_mov_b32_dpp v85, v117 row_ror:8 row_mask:0xf bank_mask:0xf
  v_smfmac_f32_16x16x64_bf16 v[24:27], v[120:123], v[108:115], v0
  s_add_u32 s36, s36, 8192
  ds_read_b128 v[72:75], v4 offset:13312
  v_mov_b32_dpp v86, v118 row_ror:8 row_mask:0xf bank_mask:0xf
  v_smfmac_f32_16x16x64_bf16 v[16:19], v[116:119], v[224:231], v0
  s_and_b32 s36, s36, 0x7fff
  ds_read_b128 v[76:79], v4 offset:14336
  v_mov_b32_dpp v87, v119 row_ror:8 row_mask:0xf bank_mask:0xf
  v_smfmac_f32_16x16x64_bf16 v[20:23], v[116:119], v[240:247], v0
  s_waitcnt lgkmcnt(3)
  s_barrier
  ds_read_b128 v[100:103], v2 offset:3072
  v_smfmac_f32_16x16x64_bf16 v[24:27], v[116:119], a[0:7], v0
  s_mov_b32 m0, s31
  ds_read_b128 v[120:123], v1 offset:3072
  v_smfmac_f32_16x16x64_bf16 v[16:19], v[84:87], v[232:239], v0
  s_cmp_ge_i32 s14, s30
  s_cbranch_scc1 T_kvw_111
T_kvb_112:
  v_smfmac_f32_16x16x64_bf16 v[20:23], v[84:87], v[248:255], v0
  ds_read_b128 v[80:83], v4 offset:15360
  v_smfmac_f32_16x16x64_bf16 v[24:27], v[84:87], a[8:15], v0
  s_waitcnt lgkmcnt(2)
  v_smfmac_f32_16x16x64_bf16 v[16:19], v[100:103], v[128:135], v0
  ds_read_b128 v[92:95], v2 offset:0
  buffer_load_dwordx4 v9, s[4:7], s27 offen sc1 lds
  v_smfmac_f32_16x16x64_bf16 v[20:23], v[100:103], v[144:151], v0
  ds_read_b128 v[96:99], v1 offset:0
  s_mov_b32 m0, s32
  v_smfmac_f32_16x16x64_bf16 v[24:27], v[100:103], v[68:75], v0
  s_waitcnt vmcnt(1) lgkmcnt(3)
  ds_read_b128 v[116:119], v2 offset:1024
  v_smfmac_f32_16x16x64_bf16 v[16:19], v[120:123], v[136:143], v0
  ds_read_b128 v[124:127], v1 offset:1024
  v_smfmac_f32_16x16x64_bf16 v[20:23], v[120:123], v[152:159], v0
  s_waitcnt lgkmcnt(4)
  ds_read_b128 v[104:107], v2 offset:7168
  buffer_load_dwordx4 v9, s[4:7], s27 offen offset:128 sc1 lds
  v_smfmac_f32_16x16x64_bf16 v[24:27], v[120:123], v[76:83], v0
  s_waitcnt lgkmcnt(4)
  ds_read_b128 v[108:111], v1 offset:7168
  s_mov_b32 m0, s33
  v_smfmac_f32_16x16x64_bf16 v[16:19], v[92:95], v[160:167], v0
  s_waitcnt lgkmcnt(4)
  ds_read_b128 v[112:115], v2 offset:4096
  v_smfmac_f32_16x16x64_bf16 v[16:19], v[96:99], v[168:175], v0
  s_waitcnt lgkmcnt(4)
  ds_read_b128 v[84:87], v1 offset:4096
  v_smfmac_f32_16x16x64_bf16 v[16:19], v[116:119], v[192:199], v0
  s_waitcnt lgkmcnt(4)
  ds_read_b128 v[88:91], v2 offset:5120
  buffer_load_dwordx4 v10, s[4:7], s28 offen sc1 lds
  v_smfmac_f32_16x16x64_bf16 v[16:19], v[124:127], v[200:207], v0
  s_waitcnt lgkmcnt(4)
  ds_read_b128 v[100:103], v1 offset:5120
  s_mov_b32 m0, s34
  v_smfmac_f32_16x16x64_bf16 v[16:19], v[104:107], a[16:23], v0
  s_waitcnt lgkmcnt(4)
  ds_read_b128 v[68:71], v4 offset:16384
  v_smfmac_f32_16x16x64_bf16 v[16:19], v[108:111], a[24:31], v0
  s_waitcnt lgkmcnt(4)
  ds_read_b128 v[72:75], v4 offset:17408
  v_smfmac_f32_16x16x64_bf16 v[16:19], v[112:115], a[64:71], v0
  s_waitcnt lgkmcnt(4)
  ds_read_b128 v[76:79], v4 offset:18432
  buffer_load_dwordx4 v10, s[4:7], s28 offen offset:256 sc1 lds
  v_smfmac_f32_16x16x64_bf16 v[16:19], v[84:87], a[72:79], v0
  s_waitcnt lgkmcnt(4)
  ds_read_b128 v[80:83], v4 offset:19456
  v_smfmac_f32_16x16x64_bf16 v[16:19], v[88:91], a[112:119], v0
  s_waitcnt lgkmcnt(4)
  v_smfmac_f32_16x16x64_bf16 v[16:19], v[100:103], a[120:127], v0
  s_add_u32 s24, s36, 145752064
  s_add_u32 s25, s36, 145756160
  v_smfmac_f32_16x16x64_bf16 v[20:23], v[92:95], v[176:183], v0
  s_add_u32 s35, s36, s23
  v_smfmac_f32_16x16x64_bf16 v[20:23], v[96:99], v[184:191], v0
  s_waitcnt lgkmcnt(2)
  v_smfmac_f32_16x16x64_bf16 v[20:23], v[116:119], v[68:75], v0
  s_waitcnt lgkmcnt(0)
  ds_read_b128 v[68:71], v4 offset:20480
  v_mul_f32 v16, s18, v16
  v_smfmac_f32_16x16x64_bf16 v[20:23], v[124:127], v[76:83], v0
  ds_read_b128 v[72:75], v4 offset:21504
  v_mul_f32 v17, s18, v17
  v_smfmac_f32_16x16x64_bf16 v[20:23], v[104:107], a[32:39], v0
  ds_read_b128 v[76:79], v4 offset:22528
  v_mul_f32 v18, s18, v18
  v_smfmac_f32_16x16x64_bf16 v[20:23], v[108:111], a[40:47], v0
  ds_read_b128 v[80:83], v4 offset:23552
  v_mul_f32 v19, s18, v19
  v_smfmac_f32_16x16x64_bf16 v[20:23], v[112:115], a[80:87], v0
  v_cvt_pk_bf16_f32 v120, v16, v17
  v_smfmac_f32_16x16x64_bf16 v[20:23], v[84:87], a[88:95], v0
  v_cvt_pk_bf16_f32 v121, v18, v19
  v_smfmac_f32_16x16x64_bf16 v[20:23], v[88:91], a[128:135], v0
  ds_write_b64 v5, v[120:121] offset:24576
  v_smfmac_f32_16x16x64_bf16 v[20:23], v[100:103], a[136:143], v0
  s_waitcnt lgkmcnt(3)
  v_smfmac_f32_16x16x64_bf16 v[24:27], v[92:95], v[68:75], v0
  s_waitcnt lgkmcnt(1)
  v_mov_b64 v[92:93], 0
  v_smfmac_f32_16x16x64_bf16 v[24:27], v[96:99], v[76:83], v0
  s_nop 1
  v_cvt_pk_bf16_f32 v122, v20, v21
  v_cvt_pk_bf16_f32 v123, v22, v23
  v_smfmac_f32_16x16x64_bf16 v[24:27], v[116:119], v[208:215], v0
  ds_write_b64 v5, v[122:123] offset:26880
  v_mov_b64 v[94:95], 0
  v_smfmac_f32_16x16x64_bf16 v[24:27], v[124:127], v[216:223], v0
  s_waitcnt lgkmcnt(1)
  s_barrier
  ds_read_b64_tr_b16 v[68:69], v6 offset:24576
  v_smfmac_f32_16x16x64_bf16 v[24:27], v[104:107], a[48:55], v0
  s_add_u32 s27, s27, 8192
  ds_read_b64_tr_b16 v[70:71], v6 offset:24640
  ds_read_b64_tr_b16 v[72:73], v6 offset:24832
  v_smfmac_f32_16x16x64_bf16 v[24:27], v[108:111], a[56:63], v0
  s_add_u32 s28, s28, 8192
  ds_read_b64_tr_b16 v[74:75], v6 offset:24896
  ds_read_b64_tr_b16 v[76:77], v6 offset:25088
  v_smfmac_f32_16x16x64_bf16 v[24:27], v[112:115], a[96:103], v0
  s_nop 0
  ds_read_b64_tr_b16 v[78:79], v6 offset:25152
  ds_read_b64_tr_b16 v[80:81], v6 offset:25344
  v_smfmac_f32_16x16x64_bf16 v[24:27], v[84:87], a[104:111], v0
  ds_read_b64_tr_b16 v[82:83], v6 offset:25408
  v_mov_b64 v[96:97], 0
  v_smfmac_f32_16x16x64_bf16 v[24:27], v[88:91], a[144:151], v0
  s_waitcnt lgkmcnt(8)
  s_barrier
  ds_read_b64_tr_b16 v[116:117], v6 offset:26880
  v_smfmac_f32_16x16x64_bf16 v[24:27], v[100:103], a[152:159], v0
  s_waitcnt lgkmcnt(7)
  ds_read_b64_tr_b16 v[118:119], v6 offset:26944
  buffer_store_dwordx2 v[122:123], v5, s[4:7], s29 offen sc1
  v_mfma_f32_16x16x32_bf16 v[16:19], v[36:39], v[68:71], 0
  s_waitcnt lgkmcnt(6)
  ds_read_b64_tr_b16 v[124:125], v6 offset:27136
  ds_read_b64_tr_b16 v[126:127], v6 offset:27200
  v_mfma_f32_16x16x32_bf16 v[16:19], v[40:43], v[72:75], v[16:19]
  s_waitcnt lgkmcnt(6)
  ds_read_b64_tr_b16 v[104:105], v6 offset:27392
  ds_read_b64_tr_b16 v[106:107], v6 offset:27456
  v_mfma_f32_16x16x32_bf16 v[16:19], v[44:47], v[76:79], v[16:19]
  s_waitcnt lgkmcnt(6)
  ds_read_b64_tr_b16 v[108:109], v6 offset:27648
  ds_read_b64_tr_b16 v[110:111], v6 offset:27712
  v_mfma_f32_16x16x32_bf16 v[16:19], v[48:51], v[80:83], v[16:19]
  s_waitcnt lgkmcnt(6)
  v_cvt_pk_bf16_f32 v120, v24, v25
  v_cvt_pk_bf16_f32 v121, v26, v27
  v_mov_b32 v86, s14
  v_mfma_f32_16x16x32_bf16 v[112:115], v[116:119], v[68:71], 0
  s_waitcnt lgkmcnt(4)
  buffer_store_dword v86, v3, s[4:7], s15 offen sc1
  buffer_store_dwordx2 v[120:121], v5, s[4:7], s29 offen offset:2304 sc1
  v_mov_b64 v[98:99], 0
  v_mfma_f32_16x16x32_bf16 v[112:115], v[124:127], v[72:75], v[112:115]
  s_waitcnt lgkmcnt(2)
  v_mov_b64 v[36:37], 0
  v_exp_f32 v100, v16
  v_mfma_f32_16x16x32_bf16 v[112:115], v[104:107], v[76:79], v[112:115]
  s_waitcnt lgkmcnt(0)
  v_exp_f32 v101, v17
  v_mfma_f32_16x16x32_bf16 v[112:115], v[108:111], v[80:83], v[112:115]
  s_add_u32 s29, s29, 147456
  v_exp_f32 v102, v18
  v_mfma_f32_16x16x32_bf16 v[20:23], v[52:55], v[68:71], 0
  s_cmp_eq_u32 s14, 63
  v_exp_f32 v103, v19
  v_mfma_f32_16x16x32_bf16 v[20:23], v[56:59], v[72:75], v[20:23]
  s_cbranch_scc1 M_tdone
  v_cvt_pk_bf16_f32 v44, v100, v101
  v_cvt_pk_bf16_f32 v45, v102, v103
  v_mfma_f32_16x16x32_bf16 v[20:23], v[60:63], v[76:79], v[20:23]
  v_exp_f32 v100, v112
  v_mfma_f32_16x16x32_bf16 v[20:23], v[64:67], v[80:83], v[20:23]
  v_exp_f32 v101, v113
  v_exp_f32 v102, v114
  v_exp_f32 v103, v115
  v_cvt_pk_bf16_f32 v84, v100, v101
  v_cvt_pk_bf16_f32 v85, v102, v103
  v_cndmask_b32 v48, v84, 0, s[16:17]
  v_cndmask_b32 v49, v85, 0, s[16:17]
  v_cndmask_b32 v50, 0, v84, s[16:17]
  v_cndmask_b32 v51, 0, v85, s[16:17]
  v_exp_f32 v100, v20
  v_mfma_f32_16x16x16_bf16 v[88:91], v[12:13], v[48:49], 0
  v_exp_f32 v101, v21
  v_mfma_f32_16x16x16_bf16 v[24:27], v[120:121], v[48:49], 0
  v_exp_f32 v102, v22
  v_mfma_f32_16x16x16_bf16 v[116:119], v[120:121], v[50:51], 0
  v_exp_f32 v103, v23
  v_cvt_pk_bf16_f32 v46, v100, v101
  v_cvt_pk_bf16_f32 v47, v102, v103
  v_mov_b64 v[38:39], 0
  s_nop 0
  v_mfma_f32_16x16x32_bf16 v[88:91], v[12:15], v[44:47], v[88:91]
  v_mov_b64 v[40:41], 0
  v_mov_b64 v[42:43], 0
  v_mfma_f32_16x16x32_bf16 v[24:27], v[28:31], v[44:47], v[24:27]
  ds_read_b128 v[52:55], v4 offset:24576
  ds_read_b128 v[56:59], v4 offset:25600
  v_mfma_f32_16x16x32_bf16 v[116:119], v[32:35], v[44:47], v[116:119]
  s_nop 1
  v_rcp_f32 v89, v88
  v_subrev_u32 v100, s54, v88
  v_cmp_le_u32 vcc, s55, v100
  v_mul_f32 v24, v89, v24
  v_mul_f32 v25, v89, v25
  s_cbranch_vccnz T_slow_113
T_back_114:
  v_cvt_pk_bf16_f32 v124, v24, v25
  v_pk_mul_f32 v[26:27], v[26:27], v[88:89] op_sel:[0,1] op_sel_hi:[1,1]
  v_pk_mul_f32 v[116:117], v[116:117], v[88:89] op_sel:[0,1] op_sel_hi:[1,1]
  v_pk_mul_f32 v[118:119], v[118:119], v[88:89] op_sel:[0,1] op_sel_hi:[1,1]
  v_cvt_pk_bf16_f32 v125, v26, v27
  v_cvt_pk_bf16_f32 v126, v116, v117
  v_cvt_pk_bf16_f32 v127, v118, v119
  ds_write_b128 v11, v[124:127] offset:30208
  s_nop 0
  v_smfmac_f32_16x16x64_bf16 v[92:95], v[124:127], a[160:167], v0
  v_smfmac_f32_16x16x64_bf16 v[96:99], v[124:127], a[168:175], v0
  v_smfmac_f32_16x16x64_bf16 v[36:39], v[124:127], a[176:183], v0
  v_smfmac_f32_16x16x64_bf16 v[40:43], v[124:127], a[184:191], v0
  s_waitcnt lgkmcnt(0)
  s_barrier
  ds_read_b128 v[104:107], v11 offset:30720
  ds_read_b128 v[108:111], v11 offset:29184
  ds_read_b128 v[68:71], v11 offset:29696
  s_waitcnt lgkmcnt(2)
  v_smfmac_f32_16x16x64_bf16 v[92:95], v[104:107], a[192:199], v0
  s_waitcnt lgkmcnt(1)
  ds_read_b128 v[76:79], v4 offset:28672
  v_smfmac_f32_16x16x64_bf16 v[92:95], v[108:111], a[224:231], v0
  s_waitcnt lgkmcnt(1)
  ds_read_b128 v[80:83], v4 offset:29696
  v_smfmac_f32_16x16x64_bf16 v[92:95], v[68:71], a[240:247], v0
  ds_read_b128 v[60:63], v4 offset:26624
  v_smfmac_f32_16x16x64_bf16 v[96:99], v[104:107], a[200:207], v0
  ds_read_b128 v[64:67], v4 offset:27648
  v_smfmac_f32_16x16x64_bf16 v[96:99], v[108:111], a[232:239], v0
  ds_read_b128 v[28:31], v4 offset:30720
  s_nop 0
  v_cvt_pk_bf16_f32 v16, v92, v93
  v_cvt_pk_bf16_f32 v17, v94, v95
  v_bfi_b32 v16, 1, s57, v16
  v_smfmac_f32_16x16x64_bf16 v[96:99], v[68:71], a[248:255], v0
  buffer_store_dwordx2 v[16:17], v7, s[4:7], s20 offen offset:0
  v_smfmac_f32_16x16x64_bf16 v[36:39], v[104:107], a[208:215], v0
  ds_read_b128 v[32:35], v4 offset:31744
  v_smfmac_f32_16x16x64_bf16 v[36:39], v[108:111], v[52:59], v0
  s_waitcnt lgkmcnt(4)
  s_nop 0
  v_cvt_pk_bf16_f32 v18, v96, v97
  v_cvt_pk_bf16_f32 v19, v98, v99
  v_bfi_b32 v18, 1, s57, v18
  v_smfmac_f32_16x16x64_bf16 v[36:39], v[68:71], v[76:83], v0
  buffer_store_dwordx2 v[18:19], v7, s[4:7], s20 offen offset:64
  v_smfmac_f32_16x16x64_bf16 v[40:43], v[104:107], a[216:223], v0
  s_waitcnt lgkmcnt(2)
  v_smfmac_f32_16x16x64_bf16 v[40:43], v[108:111], v[60:67], v0
  s_waitcnt lgkmcnt(0)
  s_nop 0
  v_cvt_pk_bf16_f32 v20, v36, v37
  v_cvt_pk_bf16_f32 v21, v38, v39
  v_bfi_b32 v20, 1, s57, v20
  v_smfmac_f32_16x16x64_bf16 v[40:43], v[68:71], v[28:35], v0
  buffer_store_dwordx2 v[20:21], v7, s[4:7], s21 offen offset:0
  s_nop 6
  v_cvt_pk_bf16_f32 v22, v40, v41
  v_cvt_pk_bf16_f32 v23, v42, v43
  v_bfi_b32 v22, 1, s57, v22
  buffer_store_dwordx2 v[22:23], v7, s[4:7], s21 offen offset:64
  ds_read_b128 v[68:71], v4 offset:0
  ds_read_b128 v[72:75], v4 offset:1024
  ds_read_b128 v[76:79], v4 offset:4096
  ds_read_b128 v[80:83], v4 offset:5120
  ds_read_b128 v[84:87], v4 offset:8192
  ds_read_b128 v[88:91], v4 offset:9216
  ds_read_b128 v[92:95], v4 offset:2048
  ds_read_b128 v[96:99], v4 offset:3072
  ds_read_b128 v[100:103], v4 offset:6144
  ds_read_b128 v[104:107], v4 offset:7168
  ds_read_b128 v[108:111], v4 offset:10240
  ds_read_b128 v[112:115], v4 offset:11264
  v_mov_b64 v[16:17], 0
  v_mov_b64 v[18:19], 0
  v_mov_b64 v[20:21], 0
  v_mov_b64 v[22:23], 0
  v_mov_b64 v[24:25], 0
  v_mov_b64 v[26:27], 0
  ds_read_b64 v[44:45], v2 offset:32256
  s_waitcnt lgkmcnt(0)
  v_readfirstlane_b32 s38, v44
  v_readfirstlane_b32 s37, v45
  s_nop 0
  s_add_u32 s37, s37, 30
  s_cmp_ge_u32 s38, 30
  s_cselect_b32 s38, s37, s38
  s_cmp_ge_u32 s38, 64
  s_cselect_b32 s38, 100, s38
  s_sub_u32 s38, s38, 1
  s_max_i32 s30, s30, s38
  s_waitcnt vmcnt(4)
  s_barrier
  ds_read_b128 v[28:31], v2 offset:18432
  ds_read_b128 v[32:35], v2 offset:22528
  ds_read_b128 v[36:39], v2 offset:8192
  ds_read_b128 v[40:43], v2 offset:9216
  ds_read_b128 v[44:47], v2 offset:10240
  ds_read_b128 v[48:51], v2 offset:11264
  buffer_load_dwordx4 v[124:127], v2, s[4:7], s24 offen offset:2048 sc1
  buffer_load_dwordx4 v[116:119], v2, s[4:7], s25 offen offset:2048 sc1
  ds_read_b128 v[52:55], v2 offset:12288
  ds_read_b128 v[56:59], v2 offset:13312
  ds_read_b128 v[60:63], v2 offset:14336
  ds_read_b128 v[64:67], v2 offset:15360
  buffer_load_dwordx4 v[124:127], v2, s[4:7], s24 offen offset:2048 sc1
  buffer_load_dwordx4 v[116:119], v2, s[4:7], s25 offen offset:2048 sc1
  s_mov_b32 s19, 0
  s_branch T_loop_107
T_kvw_111:
  s_mov_b32 s19, 0
  s_branch T_kvok_119
T_kv_118:
  s_sleep 4
  s_add_u32 s19, s19, 1
  s_cmp_gt_u32 s19, 32768
  s_cbranch_scc1 M_exit
T_kvok_119:
  s_add_u32 s39, s99, 128
  s_mov_b32 s38, 0
  s_mov_b32 s37, 0
  s_atomic_or s38, s[58:59], s99 glc
  s_atomic_or s37, s[58:59], s39 glc
  s_waitcnt lgkmcnt(0)
  s_add_u32 s37, s37, 30
  s_cmp_ge_u32 s38, 30
  s_cselect_b32 s38, s37, s38
  s_cmp_ge_u32 s38, 64
  s_cselect_b32 s38, 100, s38
  s_sub_u32 s38, s38, 1
  s_max_i32 s30, s30, s38
  s_cmp_ge_i32 s14, s30
  s_cbranch_scc1 T_kv_118
  s_branch T_kvb_112
T_slow_113:
  s_nop 7
  v_max3_f32 v100, v16, v17, v18
  v_max3_f32 v100, v100, v19, v20
  v_max3_f32 v100, v100, v21, v22
  v_max3_f32 v100, v100, v23, v112
  v_max3_f32 v100, v100, v113, v114
  v_max_f32 v100, v100, v115
  v_mov_b32 v101, v100
  s_nop 1
  v_permlane32_swap_b32 v100, v101
  s_nop 1
  v_max_f32 v100, v100, v101
  v_mov_b32 v101, v100
  s_nop 1
  v_permlane16_swap_b32 v100, v101
  s_nop 1
  v_max_f32 v100, v100, v101
  v_sub_f32 v16, v16, v100
  v_sub_f32 v17, v17, v100
  v_sub_f32 v18, v18, v100
  v_sub_f32 v19, v19, v100
  v_exp_f32 v16, v16
  v_exp_f32 v17, v17
  v_exp_f32 v18, v18
  v_exp_f32 v19, v19
  v_sub_f32 v20, v20, v100
  v_sub_f32 v21, v21, v100
  v_sub_f32 v22, v22, v100
  v_sub_f32 v23, v23, v100
  v_exp_f32 v20, v20
  v_exp_f32 v21, v21
  v_exp_f32 v22, v22
  v_exp_f32 v23, v23
  v_sub_f32 v112, v112, v100
  v_sub_f32 v113, v113, v100
  v_sub_f32 v114, v114, v100
  v_sub_f32 v115, v115, v100
  v_exp_f32 v112, v112
  v_exp_f32 v113, v113
  v_exp_f32 v114, v114
  v_exp_f32 v115, v115
  s_nop 0
  v_cvt_pk_bf16_f32 v44, v16, v17
  v_cvt_pk_bf16_f32 v45, v18, v19
  v_cvt_pk_bf16_f32 v46, v20, v21
  v_cvt_pk_bf16_f32 v47, v22, v23
  v_cvt_pk_bf16_f32 v84, v112, v113
  v_cvt_pk_bf16_f32 v85, v114, v115
  v_cndmask_b32 v48, v84, 0, s[16:17]
  v_cndmask_b32 v49, v85, 0, s[16:17]
  v_cndmask_b32 v50, 0, v84, s[16:17]
  v_cndmask_b32 v51, 0, v85, s[16:17]
  s_nop 1
  v_mfma_f32_16x16x16_bf16 v[88:91], v[12:13], v[48:49], 0
  v_mfma_f32_16x16x16_bf16 v[24:27], v[120:121], v[48:49], 0
  v_mfma_f32_16x16x16_bf16 v[116:119], v[120:121], v[50:51], 0
  v_mfma_f32_16x16x32_bf16 v[88:91], v[12:15], v[44:47], v[88:91]
  v_mfma_f32_16x16x32_bf16 v[24:27], v[28:31], v[44:47], v[24:27]
  v_mfma_f32_16x16x32_bf16 v[116:119], v[32:35], v[44:47], v[116:119]
  s_nop 7
  s_nop 1
  v_rcp_f32 v89, v88
  s_nop 0
  v_mul_f32 v24, v89, v24
  v_mul_f32 v25, v89, v25
  s_branch T_back_114
T_w_80:
  s_mov_b32 s19, 0
  v_mov_b64 v[16:17], 0
  v_mov_b64 v[18:19], 0
  v_mov_b64 v[20:21], 0
  v_mov_b64 v[22:23], 0
  v_mov_b64 v[24:25], 0
  v_mov_b64 v[26:27], 0
  buffer_load_dwordx4 v[124:127], v2, s[4:7], s24 offen offset:3072 sc1
  buffer_load_dwordx4 v[116:119], v2, s[4:7], s25 offen offset:3072 sc1
  buffer_load_dwordx4 v[124:127], v2, s[4:7], s24 offen offset:3072 sc1
  buffer_load_dwordx4 v[116:119], v2, s[4:7], s25 offen offset:3072 sc1
  s_branch T_loop_120
.p2align 6
T_retry_121:
  s_mov_b64 exec, vcc
  buffer_load_dwordx4 v[124:127], v2, s[4:7], s24 offen offset:3072 sc1
  buffer_load_dwordx4 v[116:119], v2, s[4:7], s25 offen offset:3072 sc1
  s_mov_b64 exec, -1
  s_add_u32 s19, s19, 1
  s_cmp_gt_u32 s19, 32768
  s_cbranch_scc1 M_exit
T_loop_120:
  s_waitcnt vmcnt(3) lgkmcnt(0)
  v_max3_u32 v123, v124, v125, v126
  v_max_u32 v123, v123, v127
  v_mov_b32_dpp v120, v124 row_ror:8 row_mask:0xf bank_mask:0xf
  v_mov_b32_dpp v121, v125 row_ror:8 row_mask:0xf bank_mask:0xf
  s_waitcnt vmcnt(2)
  v_max3_u32 v123, v123, v116, v117
  v_max3_u32 v123, v123, v118, v119
  v_cmp_eq_u32 vcc, -1, v123
  s_cbranch_vccnz T_retry_121
  v_smfmac_f32_16x16x64_bf16 v[16:19], v[124:127], v[68:75], v0
  s_add_u32 s14, s14, 1
  ds_write_b128 v2, v[124:127] offset:3072
  v_mov_b32_dpp v122, v126 row_ror:8 row_mask:0xf bank_mask:0xf
  v_smfmac_f32_16x16x64_bf16 v[20:23], v[124:127], v[76:83], v0
  s_and_b32 s57, s14, 1
  v_mov_b32_dpp v123, v127 row_ror:8 row_mask:0xf bank_mask:0xf
  v_smfmac_f32_16x16x64_bf16 v[24:27], v[124:127], v[84:91], v0
  s_and_b32 s36, s14, 3
  ds_write_b128 v2, v[116:119] offset:7168
  v_smfmac_f32_16x16x64_bf16 v[16:19], v[120:123], v[92:99], v0
  s_lshl_b32 s36, s36, 13
  v_mov_b32_dpp v84, v116 row_ror:8 row_mask:0xf bank_mask:0xf
  v_smfmac_f32_16x16x64_bf16 v[20:23], v[120:123], v[100:107], v0
  s_add_u32 s26, s36, s23
  ds_read_b128 v[68:71], v4 offset:12288
  v_mov_b32_dpp v85, v117 row_ror:8 row_mask:0xf bank_mask:0xf
  v_smfmac_f32_16x16x64_bf16 v[24:27], v[120:123], v[108:115], v0
  s_add_u32 s36, s36, 8192
  ds_read_b128 v[72:75], v4 offset:13312
  v_mov_b32_dpp v86, v118 row_ror:8 row_mask:0xf bank_mask:0xf
  v_smfmac_f32_16x16x64_bf16 v[16:19], v[116:119], v[224:231], v0
  s_and_b32 s36, s36, 0x7fff
  ds_read_b128 v[76:79], v4 offset:14336
  v_mov_b32_dpp v87, v119 row_ror:8 row_mask:0xf bank_mask:0xf
  v_smfmac_f32_16x16x64_bf16 v[20:23], v[116:119], v[240:247], v0
  s_waitcnt lgkmcnt(3)
  s_barrier
  ds_read_b128 v[100:103], v2 offset:2048
  v_smfmac_f32_16x16x64_bf16 v[24:27], v[116:119], a[0:7], v0
  s_mov_b32 m0, s31
  ds_read_b128 v[120:123], v1 offset:2048
  v_smfmac_f32_16x16x64_bf16 v[16:19], v[84:87], v[232:239], v0
  s_cmp_ge_i32 s14, s30
  s_cbranch_scc1 T_kvw_124
T_kvb_125:
  v_smfmac_f32_16x16x64_bf16 v[20:23], v[84:87], v[248:255], v0
  ds_read_b128 v[80:83], v4 offset:15360
  v_smfmac_f32_16x16x64_bf16 v[24:27], v[84:87], a[8:15], v0
  s_waitcnt lgkmcnt(2)
  v_smfmac_f32_16x16x64_bf16 v[16:19], v[100:103], v[128:135], v0
  ds_read_b128 v[92:95], v2 offset:1024
  v_smfmac_f32_16x16x64_bf16 v[20:23], v[100:103], v[144:151], v0
  ds_read_b128 v[96:99], v1 offset:1024
  buffer_load_dwordx4 v9, s[4:7], s27 offen sc1 lds
  v_smfmac_f32_16x16x64_bf16 v[24:27], v[100:103], v[68:75], v0
  s_waitcnt vmcnt(1) lgkmcnt(3)
  ds_read_b128 v[116:119], v2 offset:0
  s_mov_b32 m0, s32
  v_smfmac_f32_16x16x64_bf16 v[16:19], v[120:123], v[136:143], v0
  ds_read_b128 v[124:127], v1 offset:0
  v_smfmac_f32_16x16x64_bf16 v[20:23], v[120:123], v[152:159], v0
  s_waitcnt lgkmcnt(4)
  ds_read_b128 v[104:107], v2 offset:6144
  v_smfmac_f32_16x16x64_bf16 v[24:27], v[120:123], v[76:83], v0
  s_waitcnt lgkmcnt(4)
  ds_read_b128 v[108:111], v1 offset:6144
  buffer_load_dwordx4 v9, s[4:7], s27 offen offset:128 sc1 lds
  v_smfmac_f32_16x16x64_bf16 v[16:19], v[92:95], v[160:167], v0
  s_waitcnt lgkmcnt(4)
  ds_read_b128 v[112:115], v2 offset:5120
  s_mov_b32 m0, s33
  v_smfmac_f32_16x16x64_bf16 v[16:19], v[96:99], v[168:175], v0
  s_waitcnt lgkmcnt(4)
  ds_read_b128 v[84:87], v1 offset:5120
  v_smfmac_f32_16x16x64_bf16 v[16:19], v[116:119], v[192:199], v0
  s_waitcnt lgkmcnt(4)
  ds_read_b128 v[88:91], v2 offset:4096
  v_smfmac_f32_16x16x64_bf16 v[16:19], v[124:127], v[200:207], v0
  s_waitcnt lgkmcnt(4)
  ds_read_b128 v[100:103], v1 offset:4096
  buffer_load_dwordx4 v10, s[4:7], s28 offen sc1 lds
  v_smfmac_f32_16x16x64_bf16 v[16:19], v[104:107], a[16:23], v0
  s_waitcnt lgkmcnt(4)
  ds_read_b128 v[68:71], v4 offset:16384
  s_mov_b32 m0, s34
  v_smfmac_f32_16x16x64_bf16 v[16:19], v[108:111], a[24:31], v0
  s_waitcnt lgkmcnt(4)
  ds_read_b128 v[72:75], v4 offset:17408
  v_smfmac_f32_16x16x64_bf16 v[16:19], v[112:115], a[64:71], v0
  s_waitcnt lgkmcnt(4)
  ds_read_b128 v[76:79], v4 offset:18432
  v_smfmac_f32_16x16x64_bf16 v[16:19], v[84:87], a[72:79], v0
  s_waitcnt lgkmcnt(4)
  ds_read_b128 v[80:83], v4 offset:19456
  buffer_load_dwordx4 v10, s[4:7], s28 offen offset:256 sc1 lds
  v_smfmac_f32_16x16x64_bf16 v[16:19], v[88:91], a[112:119], v0
  s_waitcnt lgkmcnt(4)
  v_smfmac_f32_16x16x64_bf16 v[16:19], v[100:103], a[120:127], v0
  s_add_u32 s24, s36, 145752064
  s_add_u32 s25, s36, 145756160
  v_smfmac_f32_16x16x64_bf16 v[20:23], v[92:95], v[176:183], v0
  s_add_u32 s35, s36, s23
  v_smfmac_f32_16x16x64_bf16 v[20:23], v[96:99], v[184:191], v0
  s_waitcnt lgkmcnt(2)
  v_smfmac_f32_16x16x64_bf16 v[20:23], v[116:119], v[68:75], v0
  s_waitcnt lgkmcnt(0)
  ds_read_b128 v[68:71], v4 offset:20480
  v_mul_f32 v16, s18, v16
  v_smfmac_f32_16x16x64_bf16 v[20:23], v[124:127], v[76:83], v0
  ds_read_b128 v[72:75], v4 offset:21504
  v_mul_f32 v17, s18, v17
  v_smfmac_f32_16x16x64_bf16 v[20:23], v[104:107], a[32:39], v0
  ds_read_b128 v[76:79], v4 offset:22528
  v_mul_f32 v18, s18, v18
  v_smfmac_f32_16x16x64_bf16 v[20:23], v[108:111], a[40:47], v0
  ds_read_b128 v[80:83], v4 offset:23552
  v_mul_f32 v19, s18, v19
  v_smfmac_f32_16x16x64_bf16 v[20:23], v[112:115], a[80:87], v0
  v_cvt_pk_bf16_f32 v120, v16, v17
  v_smfmac_f32_16x16x64_bf16 v[20:23], v[84:87], a[88:95], v0
  v_cvt_pk_bf16_f32 v121, v18, v19
  v_smfmac_f32_16x16x64_bf16 v[20:23], v[88:91], a[128:135], v0
  ds_write_b64 v5, v[120:121] offset:24576
  v_smfmac_f32_16x16x64_bf16 v[20:23], v[100:103], a[136:143], v0
  s_waitcnt lgkmcnt(3)
  v_smfmac_f32_16x16x64_bf16 v[24:27], v[92:95], v[68:75], v0
  s_waitcnt lgkmcnt(1)
  v_mov_b64 v[92:93], 0
  v_smfmac_f32_16x16x64_bf16 v[24:27], v[96:99], v[76:83], v0
  s_nop 1
  v_cvt_pk_bf16_f32 v122, v20, v21
  v_cvt_pk_bf16_f32 v123, v22, v23
  v_smfmac_f32_16x16x64_bf16 v[24:27], v[116:119], v[208:215], v0
  ds_write_b64 v5, v[122:123] offset:26880
  v_mov_b64 v[94:95], 0
  v_smfmac_f32_16x16x64_bf16 v[24:27], v[124:127], v[216:223], v0
  s_waitcnt lgkmcnt(1)
  s_barrier
  ds_read_b64_tr_b16 v[68:69], v6 offset:24576
  v_smfmac_f32_16x16x64_bf16 v[24:27], v[104:107], a[48:55], v0
  s_add_u32 s27, s27, 8192
  ds_read_b64_tr_b16 v[70:71], v6 offset:24640
  ds_read_b64_tr_b16 v[72:73], v6 offset:24832
  v_smfmac_f32_16x16x64_bf16 v[24:27], v[108:111], a[56:63], v0
  s_add_u32 s28, s28, 8192
  ds_read_b64_tr_b16 v[74:75], v6 offset:24896
  ds_read_b64_tr_b16 v[76:77], v6 offset:25088
  v_smfmac_f32_16x16x64_bf16 v[24:27], v[112:115], a[96:103], v0
  s_nop 0
  ds_read_b64_tr_b16 v[78:79], v6 offset:25152
  ds_read_b64_tr_b16 v[80:81], v6 offset:25344
  v_smfmac_f32_16x16x64_bf16 v[24:27], v[84:87], a[104:111], v0
  ds_read_b64_tr_b16 v[82:83], v6 offset:25408
  v_mov_b64 v[96:97], 0
  v_smfmac_f32_16x16x64_bf16 v[24:27], v[88:91], a[144:151], v0
  s_waitcnt lgkmcnt(8)
  s_barrier
  ds_read_b64_tr_b16 v[116:117], v6 offset:26880
  v_smfmac_f32_16x16x64_bf16 v[24:27], v[100:103], a[152:159], v0
  s_waitcnt lgkmcnt(7)
  ds_read_b64_tr_b16 v[118:119], v6 offset:26944
  buffer_store_dwordx2 v[122:123], v5, s[4:7], s29 offen sc1
  v_mfma_f32_16x16x32_bf16 v[16:19], v[36:39], v[68:71], 0
  s_waitcnt lgkmcnt(6)
  ds_read_b64_tr_b16 v[124:125], v6 offset:27136
  ds_read_b64_tr_b16 v[126:127], v6 offset:27200
  v_mfma_f32_16x16x32_bf16 v[16:19], v[40:43], v[72:75], v[16:19]
  s_waitcnt lgkmcnt(6)
  ds_read_b64_tr_b16 v[104:105], v6 offset:27392
  ds_read_b64_tr_b16 v[106:107], v6 offset:27456
  v_mfma_f32_16x16x32_bf16 v[16:19], v[44:47], v[76:79], v[16:19]
  s_waitcnt lgkmcnt(6)
  ds_read_b64_tr_b16 v[108:109], v6 offset:27648
  ds_read_b64_tr_b16 v[110:111], v6 offset:27712
  v_mfma_f32_16x16x32_bf16 v[16:19], v[48:51], v[80:83], v[16:19]
  s_waitcnt lgkmcnt(6)
  s_mov_b32 m0, 32256
  v_cvt_pk_bf16_f32 v120, v24, v25
  v_cvt_pk_bf16_f32 v121, v26, v27
  v_mfma_f32_16x16x32_bf16 v[112:115], v[116:119], v[68:71], 0
  s_waitcnt lgkmcnt(4)
  buffer_load_dword v3, s[4:7], s99 offen sc1 lds
  buffer_store_dwordx2 v[120:121], v5, s[4:7], s29 offen offset:2304 sc1
  v_mov_b64 v[98:99], 0
  v_mfma_f32_16x16x32_bf16 v[112:115], v[124:127], v[72:75], v[112:115]
  s_waitcnt lgkmcnt(2)
  v_mov_b64 v[36:37], 0
  v_exp_f32 v100, v16
  v_mfma_f32_16x16x32_bf16 v[112:115], v[104:107], v[76:79], v[112:115]
  s_waitcnt lgkmcnt(0)
  v_exp_f32 v101, v17
  v_mfma_f32_16x16x32_bf16 v[112:115], v[108:111], v[80:83], v[112:115]
  s_add_u32 s29, s29, 147456
  v_exp_f32 v102, v18
  v_mfma_f32_16x16x32_bf16 v[20:23], v[52:55], v[68:71], 0
  s_cmp_eq_u32 s14, 63
  v_exp_f32 v103, v19
  v_mfma_f32_16x16x32_bf16 v[20:23], v[56:59], v[72:75], v[20:23]
  s_cbranch_scc1 M_tdone
  v_cvt_pk_bf16_f32 v44, v100, v101
  v_cvt_pk_bf16_f32 v45, v102, v103
  v_mfma_f32_16x16x32_bf16 v[20:23], v[60:63], v[76:79], v[20:23]
  v_exp_f32 v100, v112
  v_mfma_f32_16x16x32_bf16 v[20:23], v[64:67], v[80:83], v[20:23]
  v_exp_f32 v101, v113
  v_exp_f32 v102, v114
  v_exp_f32 v103, v115
  v_cvt_pk_bf16_f32 v84, v100, v101
  v_cvt_pk_bf16_f32 v85, v102, v103
  v_cndmask_b32 v48, v84, 0, s[16:17]
  v_cndmask_b32 v49, v85, 0, s[16:17]
  v_cndmask_b32 v50, 0, v84, s[16:17]
  v_cndmask_b32 v51, 0, v85, s[16:17]
  v_exp_f32 v100, v20
  v_mfma_f32_16x16x16_bf16 v[88:91], v[12:13], v[48:49], 0
  v_exp_f32 v101, v21
  v_mfma_f32_16x16x16_bf16 v[24:27], v[120:121], v[48:49], 0
  v_exp_f32 v102, v22
  v_mfma_f32_16x16x16_bf16 v[116:119], v[120:121], v[50:51], 0
  v_exp_f32 v103, v23
  v_cvt_pk_bf16_f32 v46, v100, v101
  v_cvt_pk_bf16_f32 v47, v102, v103
  v_mov_b64 v[38:39], 0
  s_nop 0
  v_mfma_f32_16x16x32_bf16 v[88:91], v[12:15], v[44:47], v[88:91]
  v_mov_b64 v[40:41], 0
  v_mov_b64 v[42:43], 0
  v_mfma_f32_16x16x32_bf16 v[24:27], v[28:31], v[44:47], v[24:27]
  ds_read_b128 v[52:55], v4 offset:24576
  ds_read_b128 v[56:59], v4 offset:25600
  v_mfma_f32_16x16x32_bf16 v[116:119], v[32:35], v[44:47], v[116:119]
  s_nop 1
  v_rcp_f32 v89, v88
  v_subrev_u32 v100, s54, v88
  v_cmp_le_u32 vcc, s55, v100
  v_mul_f32 v24, v89, v24
  v_mul_f32 v25, v89, v25
  s_cbranch_vccnz T_slow_126
T_back_127:
  v_cvt_pk_bf16_f32 v124, v24, v25
  v_pk_mul_f32 v[26:27], v[26:27], v[88:89] op_sel:[0,1] op_sel_hi:[1,1]
  v_pk_mul_f32 v[116:117], v[116:117], v[88:89] op_sel:[0,1] op_sel_hi:[1,1]
  v_pk_mul_f32 v[118:119], v[118:119], v[88:89] op_sel:[0,1] op_sel_hi:[1,1]
  v_cvt_pk_bf16_f32 v125, v26, v27
  v_cvt_pk_bf16_f32 v126, v116, v117
  v_cvt_pk_bf16_f32 v127, v118, v119
  ds_write_b128 v11, v[124:127] offset:30720
  s_nop 0
  v_smfmac_f32_16x16x64_bf16 v[92:95], v[124:127], a[160:167], v0
  v_smfmac_f32_16x16x64_bf16 v[96:99], v[124:127], a[168:175], v0
  v_smfmac_f32_16x16x64_bf16 v[36:39], v[124:127], a[176:183], v0
  v_smfmac_f32_16x16x64_bf16 v[40:43], v[124:127], a[184:191], v0
  s_waitcnt lgkmcnt(0)
  s_barrier
  ds_read_b128 v[104:107], v11 offset:30208
  ds_read_b128 v[108:111], v11 offset:29696
  ds_read_b128 v[68:71], v11 offset:29184
  s_waitcnt lgkmcnt(2)
  v_smfmac_f32_16x16x64_bf16 v[92:95], v[104:107], a[192:199], v0
  s_waitcnt lgkmcnt(1)
  ds_read_b128 v[76:79], v4 offset:28672
  v_smfmac_f32_16x16x64_bf16 v[92:95], v[108:111], a[224:231], v0
  s_waitcnt lgkmcnt(1)
  ds_read_b128 v[80:83], v4 offset:29696
  v_smfmac_f32_16x16x64_bf16 v[92:95], v[68:71], a[240:247], v0
  ds_read_b128 v[60:63], v4 offset:26624
  v_smfmac_f32_16x16x64_bf16 v[96:99], v[104:107], a[200:207], v0
  ds_read_b128 v[64:67], v4 offset:27648
  v_smfmac_f32_16x16x64_bf16 v[96:99], v[108:111], a[232:239], v0
  ds_read_b128 v[28:31], v4 offset:30720
  s_nop 0
  v_cvt_pk_bf16_f32 v16, v92, v93
  v_cvt_pk_bf16_f32 v17, v94, v95
  v_bfi_b32 v16, 1, s57, v16
  v_smfmac_f32_16x16x64_bf16 v[96:99], v[68:71], a[248:255], v0
  buffer_store_dwordx2 v[16:17], v7, s[4:7], s20 offen offset:0
  v_smfmac_f32_16x16x64_bf16 v[36:39], v[104:107], a[208:215], v0
  ds_read_b128 v[32:35], v4 offset:31744
  v_smfmac_f32_16x16x64_bf16 v[36:39], v[108:111], v[52:59], v0
  s_waitcnt lgkmcnt(4)
  s_nop 0
  v_cvt_pk_bf16_f32 v18, v96, v97
  v_cvt_pk_bf16_f32 v19, v98, v99
  v_bfi_b32 v18, 1, s57, v18
  v_smfmac_f32_16x16x64_bf16 v[36:39], v[68:71], v[76:83], v0
  buffer_store_dwordx2 v[18:19], v7, s[4:7], s20 offen offset:64
  v_smfmac_f32_16x16x64_bf16 v[40:43], v[104:107], a[216:223], v0
  s_waitcnt lgkmcnt(2)
  v_smfmac_f32_16x16x64_bf16 v[40:43], v[108:111], v[60:67], v0
  s_waitcnt lgkmcnt(0)
  s_nop 0
  v_cvt_pk_bf16_f32 v20, v36, v37
  v_cvt_pk_bf16_f32 v21, v38, v39
  v_bfi_b32 v20, 1, s57, v20
  v_smfmac_f32_16x16x64_bf16 v[40:43], v[68:71], v[28:35], v0
  buffer_store_dwordx2 v[20:21], v7, s[4:7], s21 offen offset:0
  s_nop 6
  v_cvt_pk_bf16_f32 v22, v40, v41
  v_cvt_pk_bf16_f32 v23, v42, v43
  v_bfi_b32 v22, 1, s57, v22
  buffer_store_dwordx2 v[22:23], v7, s[4:7], s21 offen offset:64
  ds_read_b128 v[68:71], v4 offset:0
  ds_read_b128 v[72:75], v4 offset:1024
  ds_read_b128 v[76:79], v4 offset:4096
  ds_read_b128 v[80:83], v4 offset:5120
  ds_read_b128 v[84:87], v4 offset:8192
  ds_read_b128 v[88:91], v4 offset:9216
  ds_read_b128 v[92:95], v4 offset:2048
  ds_read_b128 v[96:99], v4 offset:3072
  ds_read_b128 v[100:103], v4 offset:6144
  ds_read_b128 v[104:107], v4 offset:7168
  ds_read_b128 v[108:111], v4 offset:10240
  ds_read_b128 v[112:115], v4 offset:11264
  v_mov_b64 v[16:17], 0
  v_mov_b64 v[18:19], 0
  v_mov_b64 v[20:21], 0
  v_mov_b64 v[22:23], 0
  v_mov_b64 v[24:25], 0
  v_mov_b64 v[26:27], 0
  ds_read_b64 v[44:45], v2 offset:32256
  s_waitcnt lgkmcnt(0)
  v_readfirstlane_b32 s38, v44
  v_readfirstlane_b32 s37, v45
  s_nop 0
  s_add_u32 s37, s37, 30
  s_cmp_ge_u32 s38, 30
  s_cselect_b32 s38, s37, s38
  s_cmp_ge_u32 s38, 64
  s_cselect_b32 s38, 100, s38
  s_sub_u32 s38, s38, 1
  s_max_i32 s30, s30, s38
  s_waitcnt vmcnt(4)
  s_barrier
  ds_read_b128 v[28:31], v2 offset:19456
  ds_read_b128 v[32:35], v2 offset:23552
  ds_read_b128 v[36:39], v2 offset:8192
  ds_read_b128 v[40:43], v2 offset:9216
  ds_read_b128 v[44:47], v2 offset:10240
  ds_read_b128 v[48:51], v2 offset:11264
  buffer_load_dwordx4 v[124:127], v2, s[4:7], s24 offen offset:3072 sc1
  buffer_load_dwordx4 v[116:119], v2, s[4:7], s25 offen offset:3072 sc1
  ds_read_b128 v[52:55], v2 offset:12288
  ds_read_b128 v[56:59], v2 offset:13312
  ds_read_b128 v[60:63], v2 offset:14336
  ds_read_b128 v[64:67], v2 offset:15360
  buffer_load_dwordx4 v[124:127], v2, s[4:7], s24 offen offset:3072 sc1
  buffer_load_dwordx4 v[116:119], v2, s[4:7], s25 offen offset:3072 sc1
  s_mov_b32 s19, 0
  s_branch T_loop_120
T_kvw_124:
  s_mov_b32 s19, 0
  s_branch T_kvok_132
T_kv_131:
  s_sleep 4
  s_add_u32 s19, s19, 1
  s_cmp_gt_u32 s19, 32768
  s_cbranch_scc1 M_exit
T_kvok_132:
  s_add_u32 s39, s99, 128
  s_mov_b32 s38, 0
  s_mov_b32 s37, 0
  s_atomic_or s38, s[58:59], s99 glc
  s_atomic_or s37, s[58:59], s39 glc
  s_waitcnt lgkmcnt(0)
  s_add_u32 s37, s37, 30
  s_cmp_ge_u32 s38, 30
  s_cselect_b32 s38, s37, s38
  s_cmp_ge_u32 s38, 64
  s_cselect_b32 s38, 100, s38
  s_sub_u32 s38, s38, 1
  s_max_i32 s30, s30, s38
  s_cmp_ge_i32 s14, s30
  s_cbranch_scc1 T_kv_131
  s_branch T_kvb_125
T_slow_126:
  s_nop 7
  v_max3_f32 v100, v16, v17, v18
  v_max3_f32 v100, v100, v19, v20
  v_max3_f32 v100, v100, v21, v22
  v_max3_f32 v100, v100, v23, v112
  v_max3_f32 v100, v100, v113, v114
  v_max_f32 v100, v100, v115
  v_mov_b32 v101, v100
  s_nop 1
  v_permlane32_swap_b32 v100, v101
  s_nop 1
  v_max_f32 v100, v100, v101
  v_mov_b32 v101, v100
  s_nop 1
  v_permlane16_swap_b32 v100, v101
  s_nop 1
  v_max_f32 v100, v100, v101
  v_sub_f32 v16, v16, v100
  v_sub_f32 v17, v17, v100
  v_sub_f32 v18, v18, v100
  v_sub_f32 v19, v19, v100
  v_exp_f32 v16, v16
  v_exp_f32 v17, v17
  v_exp_f32 v18, v18
  v_exp_f32 v19, v19
  v_sub_f32 v20, v20, v100
  v_sub_f32 v21, v21, v100
  v_sub_f32 v22, v22, v100
  v_sub_f32 v23, v23, v100
  v_exp_f32 v20, v20
  v_exp_f32 v21, v21
  v_exp_f32 v22, v22
  v_exp_f32 v23, v23
  v_sub_f32 v112, v112, v100
  v_sub_f32 v113, v113, v100
  v_sub_f32 v114, v114, v100
  v_sub_f32 v115, v115, v100
  v_exp_f32 v112, v112
  v_exp_f32 v113, v113
  v_exp_f32 v114, v114
  v_exp_f32 v115, v115
  s_nop 0
  v_cvt_pk_bf16_f32 v44, v16, v17
  v_cvt_pk_bf16_f32 v45, v18, v19
  v_cvt_pk_bf16_f32 v46, v20, v21
  v_cvt_pk_bf16_f32 v47, v22, v23
  v_cvt_pk_bf16_f32 v84, v112, v113
  v_cvt_pk_bf16_f32 v85, v114, v115
  v_cndmask_b32 v48, v84, 0, s[16:17]
  v_cndmask_b32 v49, v85, 0, s[16:17]
  v_cndmask_b32 v50, 0, v84, s[16:17]
  v_cndmask_b32 v51, 0, v85, s[16:17]
  s_nop 1
  v_mfma_f32_16x16x16_bf16 v[88:91], v[12:13], v[48:49], 0
  v_mfma_f32_16x16x16_bf16 v[24:27], v[120:121], v[48:49], 0
  v_mfma_f32_16x16x16_bf16 v[116:119], v[120:121], v[50:51], 0
  v_mfma_f32_16x16x32_bf16 v[88:91], v[12:15], v[44:47], v[88:91]
  v_mfma_f32_16x16x32_bf16 v[24:27], v[28:31], v[44:47], v[24:27]
  v_mfma_f32_16x16x32_bf16 v[116:119], v[32:35], v[44:47], v[116:119]
  s_nop 7
  s_nop 1
  v_rcp_f32 v89, v88
  s_nop 0
  v_mul_f32 v24, v89, v24
  v_mul_f32 v25, v89, v25
  s_branch T_back_127
M_global:
  s_cmp_eq_u32 s13, 1
  s_cbranch_scc1 T_w_134
  s_cmp_eq_u32 s13, 2
  s_cbranch_scc1 T_w_135
  s_cmp_eq_u32 s13, 3
  s_cbranch_scc1 T_w_136
T_w_133:
  s_mov_b32 s19, 0
  v_mov_b64 v[16:17], 0
  v_mov_b64 v[18:19], 0
  v_mov_b64 v[20:21], 0
  v_mov_b64 v[22:23], 0
  v_mov_b64 v[24:25], 0
  v_mov_b64 v[26:27], 0
  buffer_load_dwordx4 v[124:127], v2, s[4:7], s24 offen offset:0 sc1
  buffer_load_dwordx4 v[116:119], v2, s[4:7], s25 offen offset:0 sc1
  buffer_load_dwordx4 v[124:127], v2, s[4:7], s24 offen offset:0 sc1
  buffer_load_dwordx4 v[116:119], v2, s[4:7], s25 offen offset:0 sc1
  s_branch T_loop_137
.p2align 6
T_retry_138:
  s_mov_b64 exec, vcc
  buffer_load_dwordx4 v[124:127], v2, s[4:7], s24 offen offset:0 sc1
  buffer_load_dwordx4 v[116:119], v2, s[4:7], s25 offen offset:0 sc1
  s_mov_b64 exec, -1
  s_add_u32 s19, s19, 1
  s_cmp_gt_u32 s19, 32768
  s_cbranch_scc1 M_exit
T_loop_137:
  s_waitcnt vmcnt(3) lgkmcnt(0)
  v_max3_u32 v123, v124, v125, v126
  v_max_u32 v123, v123, v127
  v_mov_b32_dpp v120, v124 row_ror:8 row_mask:0xf bank_mask:0xf
  v_mov_b32_dpp v121, v125 row_ror:8 row_mask:0xf bank_mask:0xf
  s_waitcnt vmcnt(2)
  v_max3_u32 v123, v123, v116, v117
  v_max3_u32 v123, v123, v118, v119
  v_cmp_eq_u32 vcc, -1, v123
  s_cbranch_vccnz T_retry_138
  v_smfmac_f32_16x16x64_bf16 v[16:19], v[124:127], v[68:75], v0
  s_add_u32 s14, s14, 1
  ds_write_b128 v2, v[124:127] offset:0
  v_mov_b32_dpp v122, v126 row_ror:8 row_mask:0xf bank_mask:0xf
  v_smfmac_f32_16x16x64_bf16 v[20:23], v[124:127], v[76:83], v0
  s_and_b32 s57, s14, 1
  v_mov_b32_dpp v123, v127 row_ror:8 row_mask:0xf bank_mask:0xf
  v_smfmac_f32_16x16x64_bf16 v[24:27], v[124:127], v[84:91], v0
  s_and_b32 s36, s14, 3
  ds_write_b128 v2, v[116:119] offset:4096
  v_smfmac_f32_16x16x64_bf16 v[16:19], v[120:123], v[92:99], v0
  s_lshl_b32 s36, s36, 13
  v_mov_b32_dpp v84, v116 row_ror:8 row_mask:0xf bank_mask:0xf
  v_smfmac_f32_16x16x64_bf16 v[20:23], v[120:123], v[100:107], v0
  s_add_u32 s26, s36, s23
  ds_read_b128 v[68:71], v4 offset:12288
  v_mov_b32_dpp v85, v117 row_ror:8 row_mask:0xf bank_mask:0xf
  v_smfmac_f32_16x16x64_bf16 v[24:27], v[120:123], v[108:115], v0
  s_add_u32 s36, s36, 8192
  ds_read_b128 v[72:75], v4 offset:13312
  v_mov_b32_dpp v86, v118 row_ror:8 row_mask:0xf bank_mask:0xf
  v_smfmac_f32_16x16x64_bf16 v[16:19], v[116:119], v[224:231], v0
  s_and_b32 s36, s36, 0x7fff
  ds_read_b128 v[76:79], v4 offset:14336
  v_mov_b32_dpp v87, v119 row_ror:8 row_mask:0xf bank_mask:0xf
  v_smfmac_f32_16x16x64_bf16 v[20:23], v[116:119], v[240:247], v0
  s_waitcnt lgkmcnt(3)
  s_barrier
  ds_read_b128 v[100:103], v2 offset:1024
  v_smfmac_f32_16x16x64_bf16 v[24:27], v[116:119], a[0:7], v0
  s_mov_b32 m0, s31
  ds_read_b128 v[120:123], v1 offset:1024
  v_smfmac_f32_16x16x64_bf16 v[16:19], v[84:87], v[232:239], v0
  s_cmp_ge_i32 s14, s30
  s_cbranch_scc1 T_kvw_141
T_kvb_142:
  v_smfmac_f32_16x16x64_bf16 v[20:23], v[84:87], v[248:255], v0
  ds_read_b128 v[80:83], v4 offset:15360
  buffer_load_dwordx4 v9, s[4:7], s27 offen sc1 lds
  v_smfmac_f32_16x16x64_bf16 v[24:27], v[84:87], a[8:15], v0
  s_waitcnt lgkmcnt(2)
  s_mov_b32 m0, s32
  v_smfmac_f32_16x16x64_bf16 v[16:19], v[100:103], v[128:135], v0
  ds_read_b128 v[92:95], v2 offset:2048
  v_smfmac_f32_16x16x64_bf16 v[20:23], v[100:103], v[144:151], v0
  ds_read_b128 v[96:99], v1 offset:2048
  v_smfmac_f32_16x16x64_bf16 v[24:27], v[100:103], v[68:75], v0
  s_waitcnt vmcnt(1) lgkmcnt(3)
  ds_read_b128 v[116:119], v2 offset:3072
  buffer_load_dwordx4 v9, s[4:7], s27 offen offset:128 sc1 lds
  v_smfmac_f32_16x16x64_bf16 v[16:19], v[120:123], v[136:143], v0
  ds_read_b128 v[124:127], v1 offset:3072
  s_mov_b32 m0, s33
  v_smfmac_f32_16x16x64_bf16 v[20:23], v[120:123], v[152:159], v0
  s_waitcnt lgkmcnt(4)
  ds_read_b128 v[104:107], v2 offset:5120
  v_smfmac_f32_16x16x64_bf16 v[24:27], v[120:123], v[76:83], v0
  s_waitcnt lgkmcnt(4)
  ds_read_b128 v[108:111], v1 offset:5120
  v_smfmac_f32_16x16x64_bf16 v[16:19], v[92:95], v[160:167], v0
  s_waitcnt lgkmcnt(4)
  ds_read_b128 v[112:115], v2 offset:6144
  buffer_load_dwordx4 v10, s[4:7], s28 offen sc1 lds
  v_smfmac_f32_16x16x64_bf16 v[16:19], v[96:99], v[168:175], v0
  s_waitcnt lgkmcnt(4)
  ds_read_b128 v[84:87], v1 offset:6144
  s_mov_b32 m0, s34
  v_smfmac_f32_16x16x64_bf16 v[16:19], v[116:119], v[192:199], v0
  s_waitcnt lgkmcnt(4)
  ds_read_b128 v[88:91], v2 offset:7168
  v_smfmac_f32_16x16x64_bf16 v[16:19], v[124:127], v[200:207], v0
  s_waitcnt lgkmcnt(4)
  ds_read_b128 v[100:103], v1 offset:7168
  v_smfmac_f32_16x16x64_bf16 v[16:19], v[104:107], a[16:23], v0
  s_waitcnt lgkmcnt(4)
  ds_read_b128 v[68:71], v4 offset:16384
  buffer_load_dwordx4 v10, s[4:7], s28 offen offset:256 sc1 lds
  v_smfmac_f32_16x16x64_bf16 v[16:19], v[108:111], a[24:31], v0
  s_waitcnt lgkmcnt(4)
  ds_read_b128 v[72:75], v4 offset:17408
  v_smfmac_f32_16x16x64_bf16 v[16:19], v[112:115], a[64:71], v0
  s_waitcnt lgkmcnt(4)
  ds_read_b128 v[76:79], v4 offset:18432
  v_smfmac_f32_16x16x64_bf16 v[16:19], v[84:87], a[72:79], v0
  s_waitcnt lgkmcnt(4)
  ds_read_b128 v[80:83], v4 offset:19456
  v_smfmac_f32_16x16x64_bf16 v[16:19], v[88:91], a[112:119], v0
  s_waitcnt lgkmcnt(4)
  v_smfmac_f32_16x16x64_bf16 v[16:19], v[100:103], a[120:127], v0
  s_add_u32 s24, s36, 145752064
  s_add_u32 s25, s36, 145756160
  v_smfmac_f32_16x16x64_bf16 v[20:23], v[92:95], v[176:183], v0
  s_add_u32 s35, s36, s23
  v_smfmac_f32_16x16x64_bf16 v[20:23], v[96:99], v[184:191], v0
  s_waitcnt lgkmcnt(2)
  v_smfmac_f32_16x16x64_bf16 v[20:23], v[116:119], v[68:75], v0
  s_waitcnt lgkmcnt(0)
  ds_read_b128 v[68:71], v4 offset:20480
  v_mul_f32 v16, s18, v16
  v_smfmac_f32_16x16x64_bf16 v[20:23], v[124:127], v[76:83], v0
  ds_read_b128 v[72:75], v4 offset:21504
  v_mul_f32 v17, s18, v17
  v_smfmac_f32_16x16x64_bf16 v[20:23], v[104:107], a[32:39], v0
  ds_read_b128 v[76:79], v4 offset:22528
  v_mul_f32 v18, s18, v18
  v_smfmac_f32_16x16x64_bf16 v[20:23], v[108:111], a[40:47], v0
  ds_read_b128 v[80:83], v4 offset:23552
  v_mul_f32 v19, s18, v19
  v_smfmac_f32_16x16x64_bf16 v[20:23], v[112:115], a[80:87], v0
  v_cvt_pk_bf16_f32 v120, v16, v17
  v_smfmac_f32_16x16x64_bf16 v[20:23], v[84:87], a[88:95], v0
  v_cvt_pk_bf16_f32 v121, v18, v19
  v_smfmac_f32_16x16x64_bf16 v[20:23], v[88:91], a[128:135], v0
  ds_write_b64 v5, v[120:121] offset:24576
  v_smfmac_f32_16x16x64_bf16 v[20:23], v[100:103], a[136:143], v0
  s_waitcnt lgkmcnt(3)
  v_smfmac_f32_16x16x64_bf16 v[24:27], v[92:95], v[68:75], v0
  s_waitcnt lgkmcnt(1)
  v_mov_b64 v[92:93], 0
  v_smfmac_f32_16x16x64_bf16 v[24:27], v[96:99], v[76:83], v0
  s_nop 1
  v_cvt_pk_bf16_f32 v122, v20, v21
  v_cvt_pk_bf16_f32 v123, v22, v23
  v_smfmac_f32_16x16x64_bf16 v[24:27], v[116:119], v[208:215], v0
  ds_write_b64 v5, v[122:123] offset:26880
  v_mov_b64 v[94:95], 0
  v_smfmac_f32_16x16x64_bf16 v[24:27], v[124:127], v[216:223], v0
  s_waitcnt lgkmcnt(1)
  s_barrier
  ds_read_b64_tr_b16 v[68:69], v6 offset:24576
  v_smfmac_f32_16x16x64_bf16 v[24:27], v[104:107], a[48:55], v0
  s_add_u32 s27, s27, 8192
  ds_read_b64_tr_b16 v[70:71], v6 offset:24640
  ds_read_b64_tr_b16 v[72:73], v6 offset:24832
  v_smfmac_f32_16x16x64_bf16 v[24:27], v[108:111], a[56:63], v0
  s_add_u32 s28, s28, 8192
  ds_read_b64_tr_b16 v[74:75], v6 offset:24896
  ds_read_b64_tr_b16 v[76:77], v6 offset:25088
  v_smfmac_f32_16x16x64_bf16 v[24:27], v[112:115], a[96:103], v0
  s_nop 0
  ds_read_b64_tr_b16 v[78:79], v6 offset:25152
  ds_read_b64_tr_b16 v[80:81], v6 offset:25344
  v_smfmac_f32_16x16x64_bf16 v[24:27], v[84:87], a[104:111], v0
  ds_read_b64_tr_b16 v[82:83], v6 offset:25408
  v_mov_b64 v[96:97], 0
  v_smfmac_f32_16x16x64_bf16 v[24:27], v[88:91], a[144:151], v0
  s_waitcnt lgkmcnt(8)
  s_barrier
  ds_read_b64_tr_b16 v[116:117], v6 offset:26880
  v_smfmac_f32_16x16x64_bf16 v[24:27], v[100:103], a[152:159], v0
  s_waitcnt lgkmcnt(7)
  ds_read_b64_tr_b16 v[118:119], v6 offset:26944
  buffer_store_dwordx2 v[122:123], v5, s[4:7], s29 offen sc1
  v_mfma_f32_16x16x32_bf16 v[16:19], v[36:39], v[68:71], 0
  s_waitcnt lgkmcnt(6)
  ds_read_b64_tr_b16 v[124:125], v6 offset:27136
  ds_read_b64_tr_b16 v[126:127], v6 offset:27200
  v_mfma_f32_16x16x32_bf16 v[16:19], v[40:43], v[72:75], v[16:19]
  s_waitcnt lgkmcnt(6)
  ds_read_b64_tr_b16 v[104:105], v6 offset:27392
  ds_read_b64_tr_b16 v[106:107], v6 offset:27456
  v_mfma_f32_16x16x32_bf16 v[16:19], v[44:47], v[76:79], v[16:19]
  s_waitcnt lgkmcnt(6)
  ds_read_b64_tr_b16 v[108:109], v6 offset:27648
  ds_read_b64_tr_b16 v[110:111], v6 offset:27712
  v_mfma_f32_16x16x32_bf16 v[16:19], v[48:51], v[80:83], v[16:19]
  s_waitcnt lgkmcnt(6)
  v_cvt_pk_bf16_f32 v120, v24, v25
  v_cvt_pk_bf16_f32 v121, v26, v27
  v_mfma_f32_16x16x32_bf16 v[112:115], v[116:119], v[68:71], 0
  s_waitcnt lgkmcnt(4)
  buffer_store_dwordx2 v[120:121], v5, s[4:7], s29 offen offset:2304 sc1
  v_mov_b64 v[98:99], 0
  v_mfma_f32_16x16x32_bf16 v[112:115], v[124:127], v[72:75], v[112:115]
  s_waitcnt lgkmcnt(2)
  v_mov_b64 v[36:37], 0
  v_exp_f32 v100, v16
  v_mfma_f32_16x16x32_bf16 v[112:115], v[104:107], v[76:79], v[112:115]
  s_waitcnt lgkmcnt(0)
  v_exp_f32 v101, v17
  v_mfma_f32_16x16x32_bf16 v[112:115], v[108:111], v[80:83], v[112:115]
  s_add_u32 s29, s29, 147456
  v_exp_f32 v102, v18
  v_mfma_f32_16x16x32_bf16 v[20:23], v[52:55], v[68:71], 0
  s_cmp_eq_u32 s14, 63
  v_exp_f32 v103, v19
  v_mfma_f32_16x16x32_bf16 v[20:23], v[56:59], v[72:75], v[20:23]
  s_cbranch_scc1 M_tdone
  v_cvt_pk_bf16_f32 v44, v100, v101
  v_cvt_pk_bf16_f32 v45, v102, v103
  v_mfma_f32_16x16x32_bf16 v[20:23], v[60:63], v[76:79], v[20:23]
  v_exp_f32 v100, v112
  v_mfma_f32_16x16x32_bf16 v[20:23], v[64:67], v[80:83], v[20:23]
  v_exp_f32 v101, v113
  v_exp_f32 v102, v114
  v_exp_f32 v103, v115
  v_cvt_pk_bf16_f32 v84, v100, v101
  v_cvt_pk_bf16_f32 v85, v102, v103
  v_cndmask_b32 v48, v84, 0, s[16:17]
  v_cndmask_b32 v49, v85, 0, s[16:17]
  v_cndmask_b32 v50, 0, v84, s[16:17]
  v_cndmask_b32 v51, 0, v85, s[16:17]
  v_exp_f32 v100, v20
  v_mfma_f32_16x16x16_bf16 v[88:91], v[12:13], v[48:49], 0
  v_exp_f32 v101, v21
  v_mfma_f32_16x16x16_bf16 v[24:27], v[120:121], v[48:49], 0
  v_exp_f32 v102, v22
  v_mfma_f32_16x16x16_bf16 v[116:119], v[120:121], v[50:51], 0
  v_exp_f32 v103, v23
  v_cvt_pk_bf16_f32 v46, v100, v101
  v_cvt_pk_bf16_f32 v47, v102, v103
  v_mov_b64 v[38:39], 0
  s_nop 0
  v_mfma_f32_16x16x32_bf16 v[88:91], v[12:15], v[44:47], v[88:91]
  v_mov_b64 v[40:41], 0
  v_mov_b64 v[42:43], 0
  v_mfma_f32_16x16x32_bf16 v[24:27], v[28:31], v[44:47], v[24:27]
  ds_read_b128 v[52:55], v4 offset:24576
  ds_read_b128 v[56:59], v4 offset:25600
  v_mfma_f32_16x16x32_bf16 v[116:119], v[32:35], v[44:47], v[116:119]
  s_nop 1
  v_rcp_f32 v89, v88
  v_subrev_u32 v100, s54, v88
  v_cmp_le_u32 vcc, s55, v100
  v_mul_f32 v24, v89, v24
  v_mul_f32 v25, v89, v25
  s_cbranch_vccnz T_slow_143
T_back_144:
  v_cvt_pk_bf16_f32 v124, v24, v25
  v_pk_mul_f32 v[26:27], v[26:27], v[88:89] op_sel:[0,1] op_sel_hi:[1,1]
  v_pk_mul_f32 v[116:117], v[116:117], v[88:89] op_sel:[0,1] op_sel_hi:[1,1]
  v_pk_mul_f32 v[118:119], v[118:119], v[88:89] op_sel:[0,1] op_sel_hi:[1,1]
  v_cvt_pk_bf16_f32 v125, v26, v27
  v_cvt_pk_bf16_f32 v126, v116, v117
  v_cvt_pk_bf16_f32 v127, v118, v119
  ds_write_b128 v11, v[124:127] offset:29184
  s_nop 0
  v_smfmac_f32_16x16x64_bf16 v[92:95], v[124:127], a[160:167], v0
  v_smfmac_f32_16x16x64_bf16 v[96:99], v[124:127], a[168:175], v0
  v_smfmac_f32_16x16x64_bf16 v[36:39], v[124:127], a[176:183], v0
  v_smfmac_f32_16x16x64_bf16 v[40:43], v[124:127], a[184:191], v0
  s_waitcnt lgkmcnt(0)
  s_barrier
  ds_read_b128 v[104:107], v11 offset:29696
  ds_read_b128 v[108:111], v11 offset:30208
  ds_read_b128 v[68:71], v11 offset:30720
  s_waitcnt lgkmcnt(2)
  v_smfmac_f32_16x16x64_bf16 v[92:95], v[104:107], a[192:199], v0
  s_waitcnt lgkmcnt(1)
  ds_read_b128 v[76:79], v4 offset:28672
  v_smfmac_f32_16x16x64_bf16 v[92:95], v[108:111], a[224:231], v0
  s_waitcnt lgkmcnt(1)
  ds_read_b128 v[80:83], v4 offset:29696
  v_smfmac_f32_16x16x64_bf16 v[92:95], v[68:71], a[240:247], v0
  ds_read_b128 v[60:63], v4 offset:26624
  v_smfmac_f32_16x16x64_bf16 v[96:99], v[104:107], a[200:207], v0
  ds_read_b128 v[64:67], v4 offset:27648
  v_smfmac_f32_16x16x64_bf16 v[96:99], v[108:111], a[232:239], v0
  ds_read_b128 v[28:31], v4 offset:30720
  s_nop 0
  v_cvt_pk_bf16_f32 v16, v92, v93
  v_cvt_pk_bf16_f32 v17, v94, v95
  v_bfi_b32 v16, 1, s57, v16
  v_smfmac_f32_16x16x64_bf16 v[96:99], v[68:71], a[248:255], v0
  buffer_store_dwordx2 v[16:17], v7, s[4:7], s20 offen offset:0 sc1
  v_smfmac_f32_16x16x64_bf16 v[36:39], v[104:107], a[208:215], v0
  ds_read_b128 v[32:35], v4 offset:31744
  v_smfmac_f32_16x16x64_bf16 v[36:39], v[108:111], v[52:59], v0
  s_waitcnt lgkmcnt(4)
  s_nop 0
  v_cvt_pk_bf16_f32 v18, v96, v97
  v_cvt_pk_bf16_f32 v19, v98, v99
  v_bfi_b32 v18, 1, s57, v18
  v_smfmac_f32_16x16x64_bf16 v[36:39], v[68:71], v[76:83], v0
  buffer_store_dwordx2 v[18:19], v7, s[4:7], s20 offen offset:64 sc1
  v_smfmac_f32_16x16x64_bf16 v[40:43], v[104:107], a[216:223], v0
  s_waitcnt lgkmcnt(2)
  ds_read_b128 v[116:119], v2 offset:31232
  v_smfmac_f32_16x16x64_bf16 v[40:43], v[108:111], v[60:67], v0
  s_waitcnt lgkmcnt(1)
  s_nop 0
  v_cvt_pk_bf16_f32 v20, v36, v37
  v_cvt_pk_bf16_f32 v21, v38, v39
  v_bfi_b32 v20, 1, s57, v20
  v_smfmac_f32_16x16x64_bf16 v[40:43], v[68:71], v[28:35], v0
  buffer_store_dwordx2 v[20:21], v7, s[4:7], s21 offen offset:0 sc1
  s_nop 6
  v_cvt_pk_bf16_f32 v22, v40, v41
  v_cvt_pk_bf16_f32 v23, v42, v43
  v_bfi_b32 v22, 1, s57, v22
  buffer_store_dwordx2 v[22:23], v7, s[4:7], s21 offen offset:64 sc1
  ds_read_b128 v[68:71], v4 offset:0
  ds_read_b128 v[72:75], v4 offset:1024
  ds_read_b128 v[76:79], v4 offset:4096
  ds_read_b128 v[80:83], v4 offset:5120
  ds_read_b128 v[84:87], v4 offset:8192
  ds_read_b128 v[88:91], v4 offset:9216
  ds_read_b128 v[92:95], v4 offset:2048
  ds_read_b128 v[96:99], v4 offset:3072
  ds_read_b128 v[100:103], v4 offset:6144
  ds_read_b128 v[104:107], v4 offset:7168
  ds_read_b128 v[108:111], v4 offset:10240
  ds_read_b128 v[112:115], v4 offset:11264
  v_mov_b64 v[16:17], 0
  v_mov_b64 v[18:19], 0
  v_mov_b64 v[20:21], 0
  v_mov_b64 v[22:23], 0
  v_mov_b64 v[24:25], 0
  v_mov_b64 v[26:27], 0
  s_mov_b32 s19, 0
  v_mov_b32 v49, -1
  ds_read_b64 v[44:45], v2 offset:32256
  s_waitcnt lgkmcnt(0)
  v_readfirstlane_b32 s38, v44
  v_readfirstlane_b32 s37, v45
  s_nop 0
  s_add_u32 s37, s37, 30
  s_cmp_ge_u32 s38, 30
  s_cselect_b32 s38, s37, s38
  s_cmp_ge_u32 s38, 64
  s_cselect_b32 s38, 100, s38
  s_sub_u32 s38, s38, 1
  s_max_i32 s30, s30, s38
  s_waitcnt vmcnt(1)
  buffer_load_dwordx4 v[52:55], v2, s[4:7], s22 offen offset:0 sc1
  buffer_load_dwordx4 v[56:59], v2, s[4:7], s22 offen offset:1024 sc1
  buffer_load_dwordx4 v[60:63], v2, s[4:7], s22 offen offset:2048 sc1
  buffer_load_dwordx4 v[64:67], v2, s[4:7], s22 offen offset:3072 sc1
  s_waitcnt lgkmcnt(12)
  s_waitcnt vmcnt(3)
  v_mfma_f32_16x16x32_bf16 v[120:123], v[116:119], v[52:55], 0
  v_xor_b32 v48, s57, v52
  v_bitop3_b32 v48, v48, v54, s57 bitop3:0xf6
  s_waitcnt vmcnt(2)
  v_mfma_f32_16x16x32_bf16 v[120:123], v[116:119], v[56:59], v[120:123]
  v_bitop3_b32 v48, v48, v56, s57 bitop3:0xf6
  v_bitop3_b32 v48, v48, v58, s57 bitop3:0xf6
  s_waitcnt vmcnt(1)
  v_mfma_f32_16x16x32_bf16 v[120:123], v[116:119], v[60:63], v[120:123]
  v_bitop3_b32 v48, v48, v60, s57 bitop3:0xf6
  v_bitop3_b32 v48, v48, v62, s57 bitop3:0xf6
  s_waitcnt vmcnt(0)
  v_mfma_f32_16x16x32_bf16 v[120:123], v[116:119], v[64:67], v[120:123]
  v_bitop3_b32 v48, v48, v64, s57 bitop3:0xf6
  v_bitop3_b32 v48, v48, v66, s57 bitop3:0xf6
  v_and_b32 v48, 1, v48
  v_cmp_ne_u32 vcc, 0, v48
  s_cbranch_vccnz T_p1re_146
T_p1ok_147:
  s_nop 2
  v_add_f32_dpp v120, v120, v120 row_ror:8 row_mask:0xf bank_mask:0xf
  v_add_f32_dpp v121, v121, v121 row_ror:8 row_mask:0xf bank_mask:0xf
  v_cvt_pk_bf16_f32 v48, v120, v121
  v_min_u32 v48, -2, v48
  buffer_store_dword v48, v8, s[4:7], s35 offen sc1
  buffer_store_dword v49, v8, s[4:7], s26 offen sc1
  s_barrier
  ds_read_b128 v[28:31], v2 offset:16384
  ds_read_b128 v[32:35], v2 offset:20480
  ds_read_b128 v[36:39], v2 offset:8192
  ds_read_b128 v[40:43], v2 offset:9216
  ds_read_b128 v[44:47], v2 offset:10240
  ds_read_b128 v[48:51], v2 offset:11264
  buffer_load_dwordx4 v[124:127], v2, s[4:7], s24 offen offset:0 sc1
  buffer_load_dwordx4 v[116:119], v2, s[4:7], s25 offen offset:0 sc1
  ds_read_b128 v[52:55], v2 offset:12288
  ds_read_b128 v[56:59], v2 offset:13312
  ds_read_b128 v[60:63], v2 offset:14336
  ds_read_b128 v[64:67], v2 offset:15360
  buffer_load_dwordx4 v[124:127], v2, s[4:7], s24 offen offset:0 sc1
  buffer_load_dwordx4 v[116:119], v2, s[4:7], s25 offen offset:0 sc1
  s_mov_b32 s19, 0
  s_branch T_loop_137
T_p1re_146:
  s_mov_b64 exec, vcc
  buffer_load_dwordx4 v[52:55], v2, s[4:7], s22 offen offset:0 sc1
  buffer_load_dwordx4 v[56:59], v2, s[4:7], s22 offen offset:1024 sc1
  buffer_load_dwordx4 v[60:63], v2, s[4:7], s22 offen offset:2048 sc1
  buffer_load_dwordx4 v[64:67], v2, s[4:7], s22 offen offset:3072 sc1
  s_mov_b64 exec, -1
  s_add_u32 s19, s19, 1
  s_cmp_gt_u32 s19, 32768
  s_cbranch_scc1 M_exit
  s_waitcnt vmcnt(3)
  v_mfma_f32_16x16x32_bf16 v[120:123], v[116:119], v[52:55], 0
  v_xor_b32 v48, s57, v52
  v_bitop3_b32 v48, v48, v54, s57 bitop3:0xf6
  s_waitcnt vmcnt(2)
  v_mfma_f32_16x16x32_bf16 v[120:123], v[116:119], v[56:59], v[120:123]
  v_bitop3_b32 v48, v48, v56, s57 bitop3:0xf6
  v_bitop3_b32 v48, v48, v58, s57 bitop3:0xf6
  s_waitcnt vmcnt(1)
  v_mfma_f32_16x16x32_bf16 v[120:123], v[116:119], v[60:63], v[120:123]
  v_bitop3_b32 v48, v48, v60, s57 bitop3:0xf6
  v_bitop3_b32 v48, v48, v62, s57 bitop3:0xf6
  s_waitcnt vmcnt(0)
  v_mfma_f32_16x16x32_bf16 v[120:123], v[116:119], v[64:67], v[120:123]
  v_bitop3_b32 v48, v48, v64, s57 bitop3:0xf6
  v_bitop3_b32 v48, v48, v66, s57 bitop3:0xf6
  v_and_b32 v48, 1, v48
  v_cmp_ne_u32 vcc, 0, v48
  s_cbranch_vccnz T_p1re_146
  s_branch T_p1ok_147
T_kvw_141:
  s_mov_b32 s19, 0
  s_branch T_kvok_149
T_kv_148:
  s_sleep 4
  s_add_u32 s19, s19, 1
  s_cmp_gt_u32 s19, 32768
  s_cbranch_scc1 M_exit
T_kvok_149:
  s_add_u32 s39, s99, 128
  s_mov_b32 s38, 0
  s_mov_b32 s37, 0
  s_atomic_or s38, s[58:59], s99 glc
  s_atomic_or s37, s[58:59], s39 glc
  s_waitcnt lgkmcnt(0)
  s_add_u32 s37, s37, 30
  s_cmp_ge_u32 s38, 30
  s_cselect_b32 s38, s37, s38
  s_cmp_ge_u32 s38, 64
  s_cselect_b32 s38, 100, s38
  s_sub_u32 s38, s38, 1
  s_max_i32 s30, s30, s38
  s_cmp_ge_i32 s14, s30
  s_cbranch_scc1 T_kv_148
  s_branch T_kvb_142
T_slow_143:
  s_nop 7
  v_max3_f32 v100, v16, v17, v18
  v_max3_f32 v100, v100, v19, v20
  v_max3_f32 v100, v100, v21, v22
  v_max3_f32 v100, v100, v23, v112
  v_max3_f32 v100, v100, v113, v114
  v_max_f32 v100, v100, v115
  v_mov_b32 v101, v100
  s_nop 1
  v_permlane32_swap_b32 v100, v101
  s_nop 1
  v_max_f32 v100, v100, v101
  v_mov_b32 v101, v100
  s_nop 1
  v_permlane16_swap_b32 v100, v101
  s_nop 1
  v_max_f32 v100, v100, v101
  v_sub_f32 v16, v16, v100
  v_sub_f32 v17, v17, v100
  v_sub_f32 v18, v18, v100
  v_sub_f32 v19, v19, v100
  v_exp_f32 v16, v16
  v_exp_f32 v17, v17
  v_exp_f32 v18, v18
  v_exp_f32 v19, v19
  v_sub_f32 v20, v20, v100
  v_sub_f32 v21, v21, v100
  v_sub_f32 v22, v22, v100
  v_sub_f32 v23, v23, v100
  v_exp_f32 v20, v20
  v_exp_f32 v21, v21
  v_exp_f32 v22, v22
  v_exp_f32 v23, v23
  v_sub_f32 v112, v112, v100
  v_sub_f32 v113, v113, v100
  v_sub_f32 v114, v114, v100
  v_sub_f32 v115, v115, v100
  v_exp_f32 v112, v112
  v_exp_f32 v113, v113
  v_exp_f32 v114, v114
  v_exp_f32 v115, v115
  s_nop 0
  v_cvt_pk_bf16_f32 v44, v16, v17
  v_cvt_pk_bf16_f32 v45, v18, v19
  v_cvt_pk_bf16_f32 v46, v20, v21
  v_cvt_pk_bf16_f32 v47, v22, v23
  v_cvt_pk_bf16_f32 v84, v112, v113
  v_cvt_pk_bf16_f32 v85, v114, v115
  v_cndmask_b32 v48, v84, 0, s[16:17]
  v_cndmask_b32 v49, v85, 0, s[16:17]
  v_cndmask_b32 v50, 0, v84, s[16:17]
  v_cndmask_b32 v51, 0, v85, s[16:17]
  s_nop 1
  v_mfma_f32_16x16x16_bf16 v[88:91], v[12:13], v[48:49], 0
  v_mfma_f32_16x16x16_bf16 v[24:27], v[120:121], v[48:49], 0
  v_mfma_f32_16x16x16_bf16 v[116:119], v[120:121], v[50:51], 0
  v_mfma_f32_16x16x32_bf16 v[88:91], v[12:15], v[44:47], v[88:91]
  v_mfma_f32_16x16x32_bf16 v[24:27], v[28:31], v[44:47], v[24:27]
  v_mfma_f32_16x16x32_bf16 v[116:119], v[32:35], v[44:47], v[116:119]
  s_nop 7
  s_nop 1
  v_rcp_f32 v89, v88
  s_nop 0
  v_mul_f32 v24, v89, v24
  v_mul_f32 v25, v89, v25
  s_branch T_back_144
T_w_134:
  s_mov_b32 s19, 0
  v_mov_b64 v[16:17], 0
  v_mov_b64 v[18:19], 0
  v_mov_b64 v[20:21], 0
  v_mov_b64 v[22:23], 0
  v_mov_b64 v[24:25], 0
  v_mov_b64 v[26:27], 0
  buffer_load_dwordx4 v[124:127], v2, s[4:7], s24 offen offset:1024 sc1
  buffer_load_dwordx4 v[116:119], v2, s[4:7], s25 offen offset:1024 sc1
  buffer_load_dwordx4 v[124:127], v2, s[4:7], s24 offen offset:1024 sc1
  buffer_load_dwordx4 v[116:119], v2, s[4:7], s25 offen offset:1024 sc1
  s_branch T_loop_150
.p2align 6
T_retry_151:
  s_mov_b64 exec, vcc
  buffer_load_dwordx4 v[124:127], v2, s[4:7], s24 offen offset:1024 sc1
  buffer_load_dwordx4 v[116:119], v2, s[4:7], s25 offen offset:1024 sc1
  s_mov_b64 exec, -1
  s_add_u32 s19, s19, 1
  s_cmp_gt_u32 s19, 32768
  s_cbranch_scc1 M_exit
T_loop_150:
  s_waitcnt vmcnt(3) lgkmcnt(0)
  v_max3_u32 v123, v124, v125, v126
  v_max_u32 v123, v123, v127
  v_mov_b32_dpp v120, v124 row_ror:8 row_mask:0xf bank_mask:0xf
  v_mov_b32_dpp v121, v125 row_ror:8 row_mask:0xf bank_mask:0xf
  s_waitcnt vmcnt(2)
  v_max3_u32 v123, v123, v116, v117
  v_max3_u32 v123, v123, v118, v119
  v_cmp_eq_u32 vcc, -1, v123
  s_cbranch_vccnz T_retry_151
  v_smfmac_f32_16x16x64_bf16 v[16:19], v[124:127], v[68:75], v0
  s_add_u32 s14, s14, 1
  ds_write_b128 v2, v[124:127] offset:1024
  v_mov_b32_dpp v122, v126 row_ror:8 row_mask:0xf bank_mask:0xf
  v_smfmac_f32_16x16x64_bf16 v[20:23], v[124:127], v[76:83], v0
  s_and_b32 s57, s14, 1
  v_mov_b32_dpp v123, v127 row_ror:8 row_mask:0xf bank_mask:0xf
  v_smfmac_f32_16x16x64_bf16 v[24:27], v[124:127], v[84:91], v0
  s_and_b32 s36, s14, 3
  ds_write_b128 v2, v[116:119] offset:5120
  v_smfmac_f32_16x16x64_bf16 v[16:19], v[120:123], v[92:99], v0
  s_lshl_b32 s36, s36, 13
  v_mov_b32_dpp v84, v116 row_ror:8 row_mask:0xf bank_mask:0xf
  v_smfmac_f32_16x16x64_bf16 v[20:23], v[120:123], v[100:107], v0
  s_add_u32 s26, s36, s23
  ds_read_b128 v[68:71], v4 offset:12288
  v_mov_b32_dpp v85, v117 row_ror:8 row_mask:0xf bank_mask:0xf
  v_smfmac_f32_16x16x64_bf16 v[24:27], v[120:123], v[108:115], v0
  s_add_u32 s36, s36, 8192
  ds_read_b128 v[72:75], v4 offset:13312
  v_mov_b32_dpp v86, v118 row_ror:8 row_mask:0xf bank_mask:0xf
  v_smfmac_f32_16x16x64_bf16 v[16:19], v[116:119], v[224:231], v0
  s_and_b32 s36, s36, 0x7fff
  ds_read_b128 v[76:79], v4 offset:14336
  v_mov_b32_dpp v87, v119 row_ror:8 row_mask:0xf bank_mask:0xf
  v_smfmac_f32_16x16x64_bf16 v[20:23], v[116:119], v[240:247], v0
  s_waitcnt lgkmcnt(3)
  s_barrier
  ds_read_b128 v[100:103], v2 offset:0
  v_smfmac_f32_16x16x64_bf16 v[24:27], v[116:119], a[0:7], v0
  s_mov_b32 m0, s31
  ds_read_b128 v[120:123], v1 offset:0
  v_smfmac_f32_16x16x64_bf16 v[16:19], v[84:87], v[232:239], v0
  s_cmp_ge_i32 s14, s30
  s_cbranch_scc1 T_kvw_154
T_kvb_155:
  v_smfmac_f32_16x16x64_bf16 v[20:23], v[84:87], v[248:255], v0
  ds_read_b128 v[80:83], v4 offset:15360
  v_smfmac_f32_16x16x64_bf16 v[24:27], v[84:87], a[8:15], v0
  s_waitcnt lgkmcnt(2)
  buffer_load_dwordx4 v9, s[4:7], s27 offen sc1 lds
  v_smfmac_f32_16x16x64_bf16 v[16:19], v[100:103], v[128:135], v0
  ds_read_b128 v[92:95], v2 offset:3072
  s_mov_b32 m0, s32
  v_smfmac_f32_16x16x64_bf16 v[20:23], v[100:103], v[144:151], v0
  ds_read_b128 v[96:99], v1 offset:3072
  v_smfmac_f32_16x16x64_bf16 v[24:27], v[100:103], v[68:75], v0
  s_waitcnt vmcnt(1) lgkmcnt(3)
  ds_read_b128 v[116:119], v2 offset:2048
  v_smfmac_f32_16x16x64_bf16 v[16:19], v[120:123], v[136:143], v0
  ds_read_b128 v[124:127], v1 offset:2048
  buffer_load_dwordx4 v9, s[4:7], s27 offen offset:128 sc1 lds
  v_smfmac_f32_16x16x64_bf16 v[20:23], v[120:123], v[152:159], v0
  s_waitcnt lgkmcnt(4)
  ds_read_b128 v[104:107], v2 offset:4096
  s_mov_b32 m0, s33
  v_smfmac_f32_16x16x64_bf16 v[24:27], v[120:123], v[76:83], v0
  s_waitcnt lgkmcnt(4)
  ds_read_b128 v[108:111], v1 offset:4096
  v_smfmac_f32_16x16x64_bf16 v[16:19], v[92:95], v[160:167], v0
  s_waitcnt lgkmcnt(4)
  ds_read_b128 v[112:115], v2 offset:7168
  v_smfmac_f32_16x16x64_bf16 v[16:19], v[96:99], v[168:175], v0
  s_waitcnt lgkmcnt(4)
  ds_read_b128 v[84:87], v1 offset:7168
  buffer_load_dwordx4 v10, s[4:7], s28 offen sc1 lds
  v_smfmac_f32_16x16x64_bf16 v[16:19], v[116:119], v[192:199], v0
  s_waitcnt lgkmcnt(4)
  ds_read_b128 v[88:91], v2 offset:6144
  s_mov_b32 m0, s34
  v_smfmac_f32_16x16x64_bf16 v[16:19], v[124:127], v[200:207], v0
  s_waitcnt lgkmcnt(4)
  ds_read_b128 v[100:103], v1 offset:6144
  v_smfmac_f32_16x16x64_bf16 v[16:19], v[104:107], a[16:23], v0
  s_waitcnt lgkmcnt(4)
  ds_read_b128 v[68:71], v4 offset:16384
  v_smfmac_f32_16x16x64_bf16 v[16:19], v[108:111], a[24:31], v0
  s_waitcnt lgkmcnt(4)
  ds_read_b128 v[72:75], v4 offset:17408
  buffer_load_dwordx4 v10, s[4:7], s28 offen offset:256 sc1 lds
  v_smfmac_f32_16x16x64_bf16 v[16:19], v[112:115], a[64:71], v0
  s_waitcnt lgkmcnt(4)
  ds_read_b128 v[76:79], v4 offset:18432
  v_smfmac_f32_16x16x64_bf16 v[16:19], v[84:87], a[72:79], v0
  s_waitcnt lgkmcnt(4)
  ds_read_b128 v[80:83], v4 offset:19456
  v_smfmac_f32_16x16x64_bf16 v[16:19], v[88:91], a[112:119], v0
  s_waitcnt lgkmcnt(4)
  v_smfmac_f32_16x16x64_bf16 v[16:19], v[100:103], a[120:127], v0
  s_add_u32 s24, s36, 145752064
  s_add_u32 s25, s36, 145756160
  v_smfmac_f32_16x16x64_bf16 v[20:23], v[92:95], v[176:183], v0
  s_add_u32 s35, s36, s23
  v_smfmac_f32_16x16x64_bf16 v[20:23], v[96:99], v[184:191], v0
  s_waitcnt lgkmcnt(2)
  v_smfmac_f32_16x16x64_bf16 v[20:23], v[116:119], v[68:75], v0
  s_waitcnt lgkmcnt(0)
  ds_read_b128 v[68:71], v4 offset:20480
  v_mul_f32 v16, s18, v16
  v_smfmac_f32_16x16x64_bf16 v[20:23], v[124:127], v[76:83], v0
  ds_read_b128 v[72:75], v4 offset:21504
  v_mul_f32 v17, s18, v17
  v_smfmac_f32_16x16x64_bf16 v[20:23], v[104:107], a[32:39], v0
  ds_read_b128 v[76:79], v4 offset:22528
  v_mul_f32 v18, s18, v18
  v_smfmac_f32_16x16x64_bf16 v[20:23], v[108:111], a[40:47], v0
  ds_read_b128 v[80:83], v4 offset:23552
  v_mul_f32 v19, s18, v19
  v_smfmac_f32_16x16x64_bf16 v[20:23], v[112:115], a[80:87], v0
  v_cvt_pk_bf16_f32 v120, v16, v17
  v_smfmac_f32_16x16x64_bf16 v[20:23], v[84:87], a[88:95], v0
  v_cvt_pk_bf16_f32 v121, v18, v19
  v_smfmac_f32_16x16x64_bf16 v[20:23], v[88:91], a[128:135], v0
  ds_write_b64 v5, v[120:121] offset:24576
  v_smfmac_f32_16x16x64_bf16 v[20:23], v[100:103], a[136:143], v0
  s_waitcnt lgkmcnt(3)
  v_smfmac_f32_16x16x64_bf16 v[24:27], v[92:95], v[68:75], v0
  s_waitcnt lgkmcnt(1)
  v_mov_b64 v[92:93], 0
  v_smfmac_f32_16x16x64_bf16 v[24:27], v[96:99], v[76:83], v0
  s_nop 1
  v_cvt_pk_bf16_f32 v122, v20, v21
  v_cvt_pk_bf16_f32 v123, v22, v23
  v_smfmac_f32_16x16x64_bf16 v[24:27], v[116:119], v[208:215], v0
  ds_write_b64 v5, v[122:123] offset:26880
  v_mov_b64 v[94:95], 0
  v_smfmac_f32_16x16x64_bf16 v[24:27], v[124:127], v[216:223], v0
  s_waitcnt lgkmcnt(1)
  s_barrier
  ds_read_b64_tr_b16 v[68:69], v6 offset:24576
  v_smfmac_f32_16x16x64_bf16 v[24:27], v[104:107], a[48:55], v0
  s_add_u32 s27, s27, 8192
  ds_read_b64_tr_b16 v[70:71], v6 offset:24640
  ds_read_b64_tr_b16 v[72:73], v6 offset:24832
  v_smfmac_f32_16x16x64_bf16 v[24:27], v[108:111], a[56:63], v0
  s_add_u32 s28, s28, 8192
  ds_read_b64_tr_b16 v[74:75], v6 offset:24896
  ds_read_b64_tr_b16 v[76:77], v6 offset:25088
  v_smfmac_f32_16x16x64_bf16 v[24:27], v[112:115], a[96:103], v0
  s_nop 0
  ds_read_b64_tr_b16 v[78:79], v6 offset:25152
  ds_read_b64_tr_b16 v[80:81], v6 offset:25344
  v_smfmac_f32_16x16x64_bf16 v[24:27], v[84:87], a[104:111], v0
  ds_read_b64_tr_b16 v[82:83], v6 offset:25408
  v_mov_b64 v[96:97], 0
  v_smfmac_f32_16x16x64_bf16 v[24:27], v[88:91], a[144:151], v0
  s_waitcnt lgkmcnt(8)
  s_barrier
  ds_read_b64_tr_b16 v[116:117], v6 offset:26880
  v_smfmac_f32_16x16x64_bf16 v[24:27], v[100:103], a[152:159], v0
  s_waitcnt lgkmcnt(7)
  ds_read_b64_tr_b16 v[118:119], v6 offset:26944
  buffer_store_dwordx2 v[122:123], v5, s[4:7], s29 offen sc1
  v_mfma_f32_16x16x32_bf16 v[16:19], v[36:39], v[68:71], 0
  s_waitcnt lgkmcnt(6)
  ds_read_b64_tr_b16 v[124:125], v6 offset:27136
  ds_read_b64_tr_b16 v[126:127], v6 offset:27200
  v_mfma_f32_16x16x32_bf16 v[16:19], v[40:43], v[72:75], v[16:19]
  s_waitcnt lgkmcnt(6)
  ds_read_b64_tr_b16 v[104:105], v6 offset:27392
  ds_read_b64_tr_b16 v[106:107], v6 offset:27456
  v_mfma_f32_16x16x32_bf16 v[16:19], v[44:47], v[76:79], v[16:19]
  s_waitcnt lgkmcnt(6)
  ds_read_b64_tr_b16 v[108:109], v6 offset:27648
  ds_read_b64_tr_b16 v[110:111], v6 offset:27712
  v_mfma_f32_16x16x32_bf16 v[16:19], v[48:51], v[80:83], v[16:19]
  s_waitcnt lgkmcnt(6)
  v_cvt_pk_bf16_f32 v120, v24, v25
  v_cvt_pk_bf16_f32 v121, v26, v27
  v_mfma_f32_16x16x32_bf16 v[112:115], v[116:119], v[68:71], 0
  s_waitcnt lgkmcnt(4)
  buffer_store_dwordx2 v[120:121], v5, s[4:7], s29 offen offset:2304 sc1
  v_mov_b64 v[98:99], 0
  v_mfma_f32_16x16x32_bf16 v[112:115], v[124:127], v[72:75], v[112:115]
  s_waitcnt lgkmcnt(2)
  v_mov_b64 v[36:37], 0
  v_exp_f32 v100, v16
  v_mfma_f32_16x16x32_bf16 v[112:115], v[104:107], v[76:79], v[112:115]
  s_waitcnt lgkmcnt(0)
  v_exp_f32 v101, v17
  v_mfma_f32_16x16x32_bf16 v[112:115], v[108:111], v[80:83], v[112:115]
  s_add_u32 s29, s29, 147456
  v_exp_f32 v102, v18
  v_mfma_f32_16x16x32_bf16 v[20:23], v[52:55], v[68:71], 0
  s_cmp_eq_u32 s14, 63
  v_exp_f32 v103, v19
  v_mfma_f32_16x16x32_bf16 v[20:23], v[56:59], v[72:75], v[20:23]
  s_cbranch_scc1 M_tdone
  v_cvt_pk_bf16_f32 v44, v100, v101
  v_cvt_pk_bf16_f32 v45, v102, v103
  v_mfma_f32_16x16x32_bf16 v[20:23], v[60:63], v[76:79], v[20:23]
  v_exp_f32 v100, v112
  v_mfma_f32_16x16x32_bf16 v[20:23], v[64:67], v[80:83], v[20:23]
  v_exp_f32 v101, v113
  v_exp_f32 v102, v114
  v_exp_f32 v103, v115
  v_cvt_pk_bf16_f32 v84, v100, v101
  v_cvt_pk_bf16_f32 v85, v102, v103
  v_cndmask_b32 v48, v84, 0, s[16:17]
  v_cndmask_b32 v49, v85, 0, s[16:17]
  v_cndmask_b32 v50, 0, v84, s[16:17]
  v_cndmask_b32 v51, 0, v85, s[16:17]
  v_exp_f32 v100, v20
  v_mfma_f32_16x16x16_bf16 v[88:91], v[12:13], v[48:49], 0
  v_exp_f32 v101, v21
  v_mfma_f32_16x16x16_bf16 v[24:27], v[120:121], v[48:49], 0
  v_exp_f32 v102, v22
  v_mfma_f32_16x16x16_bf16 v[116:119], v[120:121], v[50:51], 0
  v_exp_f32 v103, v23
  v_cvt_pk_bf16_f32 v46, v100, v101
  v_cvt_pk_bf16_f32 v47, v102, v103
  v_mov_b64 v[38:39], 0
  s_nop 0
  v_mfma_f32_16x16x32_bf16 v[88:91], v[12:15], v[44:47], v[88:91]
  v_mov_b64 v[40:41], 0
  v_mov_b64 v[42:43], 0
  v_mfma_f32_16x16x32_bf16 v[24:27], v[28:31], v[44:47], v[24:27]
  ds_read_b128 v[52:55], v4 offset:24576
  ds_read_b128 v[56:59], v4 offset:25600
  v_mfma_f32_16x16x32_bf16 v[116:119], v[32:35], v[44:47], v[116:119]
  s_nop 1
  v_rcp_f32 v89, v88
  v_subrev_u32 v100, s54, v88
  v_cmp_le_u32 vcc, s55, v100
  v_mul_f32 v24, v89, v24
  v_mul_f32 v25, v89, v25
  s_cbranch_vccnz T_slow_156
T_back_157:
  v_cvt_pk_bf16_f32 v124, v24, v25
  v_pk_mul_f32 v[26:27], v[26:27], v[88:89] op_sel:[0,1] op_sel_hi:[1,1]
  v_pk_mul_f32 v[116:117], v[116:117], v[88:89] op_sel:[0,1] op_sel_hi:[1,1]
  v_pk_mul_f32 v[118:119], v[118:119], v[88:89] op_sel:[0,1] op_sel_hi:[1,1]
  v_cvt_pk_bf16_f32 v125, v26, v27
  v_cvt_pk_bf16_f32 v126, v116, v117
  v_cvt_pk_bf16_f32 v127, v118, v119
  ds_write_b128 v11, v[124:127] offset:29696
  s_nop 0
  v_smfmac_f32_16x16x64_bf16 v[92:95], v[124:127], a[160:167], v0
  v_smfmac_f32_16x16x64_bf16 v[96:99], v[124:127], a[168:175], v0
  v_smfmac_f32_16x16x64_bf16 v[36:39], v[124:127], a[176:183], v0
  v_smfmac_f32_16x16x64_bf16 v[40:43], v[124:127], a[184:191], v0
  s_waitcnt lgkmcnt(0)
  s_barrier
  ds_read_b128 v[104:107], v11 offset:29184
  ds_read_b128 v[108:111], v11 offset:30720
  ds_read_b128 v[68:71], v11 offset:30208
  s_waitcnt lgkmcnt(2)
  v_smfmac_f32_16x16x64_bf16 v[92:95], v[104:107], a[192:199], v0
  s_waitcnt lgkmcnt(1)
  ds_read_b128 v[76:79], v4 offset:28672
  v_smfmac_f32_16x16x64_bf16 v[92:95], v[108:111], a[224:231], v0
  s_waitcnt lgkmcnt(1)
  ds_read_b128 v[80:83], v4 offset:29696
  v_smfmac_f32_16x16x64_bf16 v[92:95], v[68:71], a[240:247], v0
  ds_read_b128 v[60:63], v4 offset:26624
  v_smfmac_f32_16x16x64_bf16 v[96:99], v[104:107], a[200:207], v0
  ds_read_b128 v[64:67], v4 offset:27648
  v_smfmac_f32_16x16x64_bf16 v[96:99], v[108:111], a[232:239], v0
  ds_read_b128 v[28:31], v4 offset:30720
  s_nop 0
  v_cvt_pk_bf16_f32 v16, v92, v93
  v_cvt_pk_bf16_f32 v17, v94, v95
  v_bfi_b32 v16, 1, s57, v16
  v_smfmac_f32_16x16x64_bf16 v[96:99], v[68:71], a[248:255], v0
  buffer_store_dwordx2 v[16:17], v7, s[4:7], s20 offen offset:0 sc1
  v_smfmac_f32_16x16x64_bf16 v[36:39], v[104:107], a[208:215], v0
  ds_read_b128 v[32:35], v4 offset:31744
  v_smfmac_f32_16x16x64_bf16 v[36:39], v[108:111], v[52:59], v0
  s_waitcnt lgkmcnt(4)
  s_nop 0
  v_cvt_pk_bf16_f32 v18, v96, v97
  v_cvt_pk_bf16_f32 v19, v98, v99
  v_bfi_b32 v18, 1, s57, v18
  v_smfmac_f32_16x16x64_bf16 v[36:39], v[68:71], v[76:83], v0
  buffer_store_dwordx2 v[18:19], v7, s[4:7], s20 offen offset:64 sc1
  v_smfmac_f32_16x16x64_bf16 v[40:43], v[104:107], a[216:223], v0
  s_waitcnt lgkmcnt(2)
  ds_read_b128 v[116:119], v2 offset:31232
  v_smfmac_f32_16x16x64_bf16 v[40:43], v[108:111], v[60:67], v0
  s_waitcnt lgkmcnt(1)
  s_nop 0
  v_cvt_pk_bf16_f32 v20, v36, v37
  v_cvt_pk_bf16_f32 v21, v38, v39
  v_bfi_b32 v20, 1, s57, v20
  v_smfmac_f32_16x16x64_bf16 v[40:43], v[68:71], v[28:35], v0
  buffer_store_dwordx2 v[20:21], v7, s[4:7], s21 offen offset:0 sc1
  s_nop 6
  v_cvt_pk_bf16_f32 v22, v40, v41
  v_cvt_pk_bf16_f32 v23, v42, v43
  v_bfi_b32 v22, 1, s57, v22
  buffer_store_dwordx2 v[22:23], v7, s[4:7], s21 offen offset:64 sc1
  ds_read_b128 v[68:71], v4 offset:0
  ds_read_b128 v[72:75], v4 offset:1024
  ds_read_b128 v[76:79], v4 offset:4096
  ds_read_b128 v[80:83], v4 offset:5120
  ds_read_b128 v[84:87], v4 offset:8192
  ds_read_b128 v[88:91], v4 offset:9216
  ds_read_b128 v[92:95], v4 offset:2048
  ds_read_b128 v[96:99], v4 offset:3072
  ds_read_b128 v[100:103], v4 offset:6144
  ds_read_b128 v[104:107], v4 offset:7168
  ds_read_b128 v[108:111], v4 offset:10240
  ds_read_b128 v[112:115], v4 offset:11264
  v_mov_b64 v[16:17], 0
  v_mov_b64 v[18:19], 0
  v_mov_b64 v[20:21], 0
  v_mov_b64 v[22:23], 0
  v_mov_b64 v[24:25], 0
  v_mov_b64 v[26:27], 0
  s_mov_b32 s19, 0
  v_mov_b32 v49, -1
  ds_read_b64 v[44:45], v2 offset:32256
  s_waitcnt lgkmcnt(0)
  v_readfirstlane_b32 s38, v44
  v_readfirstlane_b32 s37, v45
  s_nop 0
  s_add_u32 s37, s37, 30
  s_cmp_ge_u32 s38, 30
  s_cselect_b32 s38, s37, s38
  s_cmp_ge_u32 s38, 64
  s_cselect_b32 s38, 100, s38
  s_sub_u32 s38, s38, 1
  s_max_i32 s30, s30, s38
  s_waitcnt vmcnt(1)
  buffer_load_dwordx4 v[52:55], v2, s[4:7], s22 offen offset:0 sc1
  buffer_load_dwordx4 v[56:59], v2, s[4:7], s22 offen offset:1024 sc1
  buffer_load_dwordx4 v[60:63], v2, s[4:7], s22 offen offset:2048 sc1
  buffer_load_dwordx4 v[64:67], v2, s[4:7], s22 offen offset:3072 sc1
  s_waitcnt lgkmcnt(12)
  s_waitcnt vmcnt(3)
  v_mfma_f32_16x16x32_bf16 v[120:123], v[116:119], v[52:55], 0
  v_xor_b32 v48, s57, v52
  v_bitop3_b32 v48, v48, v54, s57 bitop3:0xf6
  s_waitcnt vmcnt(2)
  v_mfma_f32_16x16x32_bf16 v[120:123], v[116:119], v[56:59], v[120:123]
  v_bitop3_b32 v48, v48, v56, s57 bitop3:0xf6
  v_bitop3_b32 v48, v48, v58, s57 bitop3:0xf6
  s_waitcnt vmcnt(1)
  v_mfma_f32_16x16x32_bf16 v[120:123], v[116:119], v[60:63], v[120:123]
  v_bitop3_b32 v48, v48, v60, s57 bitop3:0xf6
  v_bitop3_b32 v48, v48, v62, s57 bitop3:0xf6
  s_waitcnt vmcnt(0)
  v_mfma_f32_16x16x32_bf16 v[120:123], v[116:119], v[64:67], v[120:123]
  v_bitop3_b32 v48, v48, v64, s57 bitop3:0xf6
  v_bitop3_b32 v48, v48, v66, s57 bitop3:0xf6
  v_and_b32 v48, 1, v48
  v_cmp_ne_u32 vcc, 0, v48
  s_cbranch_vccnz T_p1re_159
T_p1ok_160:
  s_nop 2
  v_add_f32_dpp v120, v120, v120 row_ror:8 row_mask:0xf bank_mask:0xf
  v_add_f32_dpp v121, v121, v121 row_ror:8 row_mask:0xf bank_mask:0xf
  v_cvt_pk_bf16_f32 v48, v120, v121
  v_min_u32 v48, -2, v48
  buffer_store_dword v48, v8, s[4:7], s35 offen sc1
  buffer_store_dword v49, v8, s[4:7], s26 offen sc1
  s_barrier
  ds_read_b128 v[28:31], v2 offset:17408
  ds_read_b128 v[32:35], v2 offset:21504
  ds_read_b128 v[36:39], v2 offset:8192
  ds_read_b128 v[40:43], v2 offset:9216
  ds_read_b128 v[44:47], v2 offset:10240
  ds_read_b128 v[48:51], v2 offset:11264
  buffer_load_dwordx4 v[124:127], v2, s[4:7], s24 offen offset:1024 sc1
  buffer_load_dwordx4 v[116:119], v2, s[4:7], s25 offen offset:1024 sc1
  ds_read_b128 v[52:55], v2 offset:12288
  ds_read_b128 v[56:59], v2 offset:13312
  ds_read_b128 v[60:63], v2 offset:14336
  ds_read_b128 v[64:67], v2 offset:15360
  buffer_load_dwordx4 v[124:127], v2, s[4:7], s24 offen offset:1024 sc1
  buffer_load_dwordx4 v[116:119], v2, s[4:7], s25 offen offset:1024 sc1
  s_mov_b32 s19, 0
  s_branch T_loop_150
T_p1re_159:
  s_mov_b64 exec, vcc
  buffer_load_dwordx4 v[52:55], v2, s[4:7], s22 offen offset:0 sc1
  buffer_load_dwordx4 v[56:59], v2, s[4:7], s22 offen offset:1024 sc1
  buffer_load_dwordx4 v[60:63], v2, s[4:7], s22 offen offset:2048 sc1
  buffer_load_dwordx4 v[64:67], v2, s[4:7], s22 offen offset:3072 sc1
  s_mov_b64 exec, -1
  s_add_u32 s19, s19, 1
  s_cmp_gt_u32 s19, 32768
  s_cbranch_scc1 M_exit
  s_waitcnt vmcnt(3)
  v_mfma_f32_16x16x32_bf16 v[120:123], v[116:119], v[52:55], 0
  v_xor_b32 v48, s57, v52
  v_bitop3_b32 v48, v48, v54, s57 bitop3:0xf6
  s_waitcnt vmcnt(2)
  v_mfma_f32_16x16x32_bf16 v[120:123], v[116:119], v[56:59], v[120:123]
  v_bitop3_b32 v48, v48, v56, s57 bitop3:0xf6
  v_bitop3_b32 v48, v48, v58, s57 bitop3:0xf6
  s_waitcnt vmcnt(1)
  v_mfma_f32_16x16x32_bf16 v[120:123], v[116:119], v[60:63], v[120:123]
  v_bitop3_b32 v48, v48, v60, s57 bitop3:0xf6
  v_bitop3_b32 v48, v48, v62, s57 bitop3:0xf6
  s_waitcnt vmcnt(0)
  v_mfma_f32_16x16x32_bf16 v[120:123], v[116:119], v[64:67], v[120:123]
  v_bitop3_b32 v48, v48, v64, s57 bitop3:0xf6
  v_bitop3_b32 v48, v48, v66, s57 bitop3:0xf6
  v_and_b32 v48, 1, v48
  v_cmp_ne_u32 vcc, 0, v48
  s_cbranch_vccnz T_p1re_159
  s_branch T_p1ok_160
T_kvw_154:
  s_mov_b32 s19, 0
  s_branch T_kvok_162
T_kv_161:
  s_sleep 4
  s_add_u32 s19, s19, 1
  s_cmp_gt_u32 s19, 32768
  s_cbranch_scc1 M_exit
T_kvok_162:
  s_add_u32 s39, s99, 128
  s_mov_b32 s38, 0
  s_mov_b32 s37, 0
  s_atomic_or s38, s[58:59], s99 glc
  s_atomic_or s37, s[58:59], s39 glc
  s_waitcnt lgkmcnt(0)
  s_add_u32 s37, s37, 30
  s_cmp_ge_u32 s38, 30
  s_cselect_b32 s38, s37, s38
  s_cmp_ge_u32 s38, 64
  s_cselect_b32 s38, 100, s38
  s_sub_u32 s38, s38, 1
  s_max_i32 s30, s30, s38
  s_cmp_ge_i32 s14, s30
  s_cbranch_scc1 T_kv_161
  s_branch T_kvb_155
T_slow_156:
  s_nop 7
  v_max3_f32 v100, v16, v17, v18
  v_max3_f32 v100, v100, v19, v20
  v_max3_f32 v100, v100, v21, v22
  v_max3_f32 v100, v100, v23, v112
  v_max3_f32 v100, v100, v113, v114
  v_max_f32 v100, v100, v115
  v_mov_b32 v101, v100
  s_nop 1
  v_permlane32_swap_b32 v100, v101
  s_nop 1
  v_max_f32 v100, v100, v101
  v_mov_b32 v101, v100
  s_nop 1
  v_permlane16_swap_b32 v100, v101
  s_nop 1
  v_max_f32 v100, v100, v101
  v_sub_f32 v16, v16, v100
  v_sub_f32 v17, v17, v100
  v_sub_f32 v18, v18, v100
  v_sub_f32 v19, v19, v100
  v_exp_f32 v16, v16
  v_exp_f32 v17, v17
  v_exp_f32 v18, v18
  v_exp_f32 v19, v19
  v_sub_f32 v20, v20, v100
  v_sub_f32 v21, v21, v100
  v_sub_f32 v22, v22, v100
  v_sub_f32 v23, v23, v100
  v_exp_f32 v20, v20
  v_exp_f32 v21, v21
  v_exp_f32 v22, v22
  v_exp_f32 v23, v23
  v_sub_f32 v112, v112, v100
  v_sub_f32 v113, v113, v100
  v_sub_f32 v114, v114, v100
  v_sub_f32 v115, v115, v100
  v_exp_f32 v112, v112
  v_exp_f32 v113, v113
  v_exp_f32 v114, v114
  v_exp_f32 v115, v115
  s_nop 0
  v_cvt_pk_bf16_f32 v44, v16, v17
  v_cvt_pk_bf16_f32 v45, v18, v19
  v_cvt_pk_bf16_f32 v46, v20, v21
  v_cvt_pk_bf16_f32 v47, v22, v23
  v_cvt_pk_bf16_f32 v84, v112, v113
  v_cvt_pk_bf16_f32 v85, v114, v115
  v_cndmask_b32 v48, v84, 0, s[16:17]
  v_cndmask_b32 v49, v85, 0, s[16:17]
  v_cndmask_b32 v50, 0, v84, s[16:17]
  v_cndmask_b32 v51, 0, v85, s[16:17]
  s_nop 1
  v_mfma_f32_16x16x16_bf16 v[88:91], v[12:13], v[48:49], 0
  v_mfma_f32_16x16x16_bf16 v[24:27], v[120:121], v[48:49], 0
  v_mfma_f32_16x16x16_bf16 v[116:119], v[120:121], v[50:51], 0
  v_mfma_f32_16x16x32_bf16 v[88:91], v[12:15], v[44:47], v[88:91]
  v_mfma_f32_16x16x32_bf16 v[24:27], v[28:31], v[44:47], v[24:27]
  v_mfma_f32_16x16x32_bf16 v[116:119], v[32:35], v[44:47], v[116:119]
  s_nop 7
  s_nop 1
  v_rcp_f32 v89, v88
  s_nop 0
  v_mul_f32 v24, v89, v24
  v_mul_f32 v25, v89, v25
  s_branch T_back_157
T_w_135:
  s_mov_b32 s19, 0
  v_mov_b64 v[16:17], 0
  v_mov_b64 v[18:19], 0
  v_mov_b64 v[20:21], 0
  v_mov_b64 v[22:23], 0
  v_mov_b64 v[24:25], 0
  v_mov_b64 v[26:27], 0
  buffer_load_dwordx4 v[124:127], v2, s[4:7], s24 offen offset:2048 sc1
  buffer_load_dwordx4 v[116:119], v2, s[4:7], s25 offen offset:2048 sc1
  buffer_load_dwordx4 v[124:127], v2, s[4:7], s24 offen offset:2048 sc1
  buffer_load_dwordx4 v[116:119], v2, s[4:7], s25 offen offset:2048 sc1
  s_branch T_loop_163
.p2align 6
T_retry_164:
  s_mov_b64 exec, vcc
  buffer_load_dwordx4 v[124:127], v2, s[4:7], s24 offen offset:2048 sc1
  buffer_load_dwordx4 v[116:119], v2, s[4:7], s25 offen offset:2048 sc1
  s_mov_b64 exec, -1
  s_add_u32 s19, s19, 1
  s_cmp_gt_u32 s19, 32768
  s_cbranch_scc1 M_exit
T_loop_163:
  s_waitcnt vmcnt(3) lgkmcnt(0)
  v_max3_u32 v123, v124, v125, v126
  v_max_u32 v123, v123, v127
  v_mov_b32_dpp v120, v124 row_ror:8 row_mask:0xf bank_mask:0xf
  v_mov_b32_dpp v121, v125 row_ror:8 row_mask:0xf bank_mask:0xf
  s_waitcnt vmcnt(2)
  v_max3_u32 v123, v123, v116, v117
  v_max3_u32 v123, v123, v118, v119
  v_cmp_eq_u32 vcc, -1, v123
  s_cbranch_vccnz T_retry_164
  v_smfmac_f32_16x16x64_bf16 v[16:19], v[124:127], v[68:75], v0
  s_add_u32 s14, s14, 1
  ds_write_b128 v2, v[124:127] offset:2048
  v_mov_b32_dpp v122, v126 row_ror:8 row_mask:0xf bank_mask:0xf
  v_smfmac_f32_16x16x64_bf16 v[20:23], v[124:127], v[76:83], v0
  s_and_b32 s57, s14, 1
  v_mov_b32_dpp v123, v127 row_ror:8 row_mask:0xf bank_mask:0xf
  v_smfmac_f32_16x16x64_bf16 v[24:27], v[124:127], v[84:91], v0
  s_and_b32 s36, s14, 3
  ds_write_b128 v2, v[116:119] offset:6144
  v_smfmac_f32_16x16x64_bf16 v[16:19], v[120:123], v[92:99], v0
  s_lshl_b32 s36, s36, 13
  v_mov_b32_dpp v84, v116 row_ror:8 row_mask:0xf bank_mask:0xf
  v_smfmac_f32_16x16x64_bf16 v[20:23], v[120:123], v[100:107], v0
  s_add_u32 s26, s36, s23
  ds_read_b128 v[68:71], v4 offset:12288
  v_mov_b32_dpp v85, v117 row_ror:8 row_mask:0xf bank_mask:0xf
  v_smfmac_f32_16x16x64_bf16 v[24:27], v[120:123], v[108:115], v0
  s_add_u32 s36, s36, 8192
  ds_read_b128 v[72:75], v4 offset:13312
  v_mov_b32_dpp v86, v118 row_ror:8 row_mask:0xf bank_mask:0xf
  v_smfmac_f32_16x16x64_bf16 v[16:19], v[116:119], v[224:231], v0
  s_and_b32 s36, s36, 0x7fff
  ds_read_b128 v[76:79], v4 offset:14336
  v_mov_b32_dpp v87, v119 row_ror:8 row_mask:0xf bank_mask:0xf
  v_smfmac_f32_16x16x64_bf16 v[20:23], v[116:119], v[240:247], v0
  s_waitcnt lgkmcnt(3)
  s_barrier
  ds_read_b128 v[100:103], v2 offset:3072
  v_smfmac_f32_16x16x64_bf16 v[24:27], v[116:119], a[0:7], v0
  s_mov_b32 m0, s31
  ds_read_b128 v[120:123], v1 offset:3072
  v_smfmac_f32_16x16x64_bf16 v[16:19], v[84:87], v[232:239], v0
  s_cmp_ge_i32 s14, s30
  s_cbranch_scc1 T_kvw_167
T_kvb_168:
  v_smfmac_f32_16x16x64_bf16 v[20:23], v[84:87], v[248:255], v0
  ds_read_b128 v[80:83], v4 offset:15360
  v_smfmac_f32_16x16x64_bf16 v[24:27], v[84:87], a[8:15], v0
  s_waitcnt lgkmcnt(2)
  v_smfmac_f32_16x16x64_bf16 v[16:19], v[100:103], v[128:135], v0
  ds_read_b128 v[92:95], v2 offset:0
  buffer_load_dwordx4 v9, s[4:7], s27 offen sc1 lds
  v_smfmac_f32_16x16x64_bf16 v[20:23], v[100:103], v[144:151], v0
  ds_read_b128 v[96:99], v1 offset:0
  s_mov_b32 m0, s32
  v_smfmac_f32_16x16x64_bf16 v[24:27], v[100:103], v[68:75], v0
  s_waitcnt vmcnt(1) lgkmcnt(3)
  ds_read_b128 v[116:119], v2 offset:1024
  v_smfmac_f32_16x16x64_bf16 v[16:19], v[120:123], v[136:143], v0
  ds_read_b128 v[124:127], v1 offset:1024
  v_smfmac_f32_16x16x64_bf16 v[20:23], v[120:123], v[152:159], v0
  s_waitcnt lgkmcnt(4)
  ds_read_b128 v[104:107], v2 offset:7168
  buffer_load_dwordx4 v9, s[4:7], s27 offen offset:128 sc1 lds
  v_smfmac_f32_16x16x64_bf16 v[24:27], v[120:123], v[76:83], v0
  s_waitcnt lgkmcnt(4)
  ds_read_b128 v[108:111], v1 offset:7168
  s_mov_b32 m0, s33
  v_smfmac_f32_16x16x64_bf16 v[16:19], v[92:95], v[160:167], v0
  s_waitcnt lgkmcnt(4)
  ds_read_b128 v[112:115], v2 offset:4096
  v_smfmac_f32_16x16x64_bf16 v[16:19], v[96:99], v[168:175], v0
  s_waitcnt lgkmcnt(4)
  ds_read_b128 v[84:87], v1 offset:4096
  v_smfmac_f32_16x16x64_bf16 v[16:19], v[116:119], v[192:199], v0
  s_waitcnt lgkmcnt(4)
  ds_read_b128 v[88:91], v2 offset:5120
  buffer_load_dwordx4 v10, s[4:7], s28 offen sc1 lds
  v_smfmac_f32_16x16x64_bf16 v[16:19], v[124:127], v[200:207], v0
  s_waitcnt lgkmcnt(4)
  ds_read_b128 v[100:103], v1 offset:5120
  s_mov_b32 m0, s34
  v_smfmac_f32_16x16x64_bf16 v[16:19], v[104:107], a[16:23], v0
  s_waitcnt lgkmcnt(4)
  ds_read_b128 v[68:71], v4 offset:16384
  v_smfmac_f32_16x16x64_bf16 v[16:19], v[108:111], a[24:31], v0
  s_waitcnt lgkmcnt(4)
  ds_read_b128 v[72:75], v4 offset:17408
  v_smfmac_f32_16x16x64_bf16 v[16:19], v[112:115], a[64:71], v0
  s_waitcnt lgkmcnt(4)
  ds_read_b128 v[76:79], v4 offset:18432
  buffer_load_dwordx4 v10, s[4:7], s28 offen offset:256 sc1 lds
  v_smfmac_f32_16x16x64_bf16 v[16:19], v[84:87], a[72:79], v0
  s_waitcnt lgkmcnt(4)
  ds_read_b128 v[80:83], v4 offset:19456
  v_smfmac_f32_16x16x64_bf16 v[16:19], v[88:91], a[112:119], v0
  s_waitcnt lgkmcnt(4)
  v_smfmac_f32_16x16x64_bf16 v[16:19], v[100:103], a[120:127], v0
  s_add_u32 s24, s36, 145752064
  s_add_u32 s25, s36, 145756160
  v_smfmac_f32_16x16x64_bf16 v[20:23], v[92:95], v[176:183], v0
  s_add_u32 s35, s36, s23
  v_smfmac_f32_16x16x64_bf16 v[20:23], v[96:99], v[184:191], v0
  s_waitcnt lgkmcnt(2)
  v_smfmac_f32_16x16x64_bf16 v[20:23], v[116:119], v[68:75], v0
  s_waitcnt lgkmcnt(0)
  ds_read_b128 v[68:71], v4 offset:20480
  v_mul_f32 v16, s18, v16
  v_smfmac_f32_16x16x64_bf16 v[20:23], v[124:127], v[76:83], v0
  ds_read_b128 v[72:75], v4 offset:21504
  v_mul_f32 v17, s18, v17
  v_smfmac_f32_16x16x64_bf16 v[20:23], v[104:107], a[32:39], v0
  ds_read_b128 v[76:79], v4 offset:22528
  v_mul_f32 v18, s18, v18
  v_smfmac_f32_16x16x64_bf16 v[20:23], v[108:111], a[40:47], v0
  ds_read_b128 v[80:83], v4 offset:23552
  v_mul_f32 v19, s18, v19
  v_smfmac_f32_16x16x64_bf16 v[20:23], v[112:115], a[80:87], v0
  v_cvt_pk_bf16_f32 v120, v16, v17
  v_smfmac_f32_16x16x64_bf16 v[20:23], v[84:87], a[88:95], v0
  v_cvt_pk_bf16_f32 v121, v18, v19
  v_smfmac_f32_16x16x64_bf16 v[20:23], v[88:91], a[128:135], v0
  ds_write_b64 v5, v[120:121] offset:24576
  v_smfmac_f32_16x16x64_bf16 v[20:23], v[100:103], a[136:143], v0
  s_waitcnt lgkmcnt(3)
  v_smfmac_f32_16x16x64_bf16 v[24:27], v[92:95], v[68:75], v0
  s_waitcnt lgkmcnt(1)
  v_mov_b64 v[92:93], 0
  v_smfmac_f32_16x16x64_bf16 v[24:27], v[96:99], v[76:83], v0
  s_nop 1
  v_cvt_pk_bf16_f32 v122, v20, v21
  v_cvt_pk_bf16_f32 v123, v22, v23
  v_smfmac_f32_16x16x64_bf16 v[24:27], v[116:119], v[208:215], v0
  ds_write_b64 v5, v[122:123] offset:26880
  v_mov_b64 v[94:95], 0
  v_smfmac_f32_16x16x64_bf16 v[24:27], v[124:127], v[216:223], v0
  s_waitcnt lgkmcnt(1)
  s_barrier
  ds_read_b64_tr_b16 v[68:69], v6 offset:24576
  v_smfmac_f32_16x16x64_bf16 v[24:27], v[104:107], a[48:55], v0
  s_add_u32 s27, s27, 8192
  ds_read_b64_tr_b16 v[70:71], v6 offset:24640
  ds_read_b64_tr_b16 v[72:73], v6 offset:24832
  v_smfmac_f32_16x16x64_bf16 v[24:27], v[108:111], a[56:63], v0
  s_add_u32 s28, s28, 8192
  ds_read_b64_tr_b16 v[74:75], v6 offset:24896
  ds_read_b64_tr_b16 v[76:77], v6 offset:25088
  v_smfmac_f32_16x16x64_bf16 v[24:27], v[112:115], a[96:103], v0
  s_nop 0
  ds_read_b64_tr_b16 v[78:79], v6 offset:25152
  ds_read_b64_tr_b16 v[80:81], v6 offset:25344
  v_smfmac_f32_16x16x64_bf16 v[24:27], v[84:87], a[104:111], v0
  ds_read_b64_tr_b16 v[82:83], v6 offset:25408
  v_mov_b64 v[96:97], 0
  v_smfmac_f32_16x16x64_bf16 v[24:27], v[88:91], a[144:151], v0
  s_waitcnt lgkmcnt(8)
  s_barrier
  ds_read_b64_tr_b16 v[116:117], v6 offset:26880
  v_smfmac_f32_16x16x64_bf16 v[24:27], v[100:103], a[152:159], v0
  s_waitcnt lgkmcnt(7)
  ds_read_b64_tr_b16 v[118:119], v6 offset:26944
  buffer_store_dwordx2 v[122:123], v5, s[4:7], s29 offen sc1
  v_mfma_f32_16x16x32_bf16 v[16:19], v[36:39], v[68:71], 0
  s_waitcnt lgkmcnt(6)
  ds_read_b64_tr_b16 v[124:125], v6 offset:27136
  ds_read_b64_tr_b16 v[126:127], v6 offset:27200
  v_mfma_f32_16x16x32_bf16 v[16:19], v[40:43], v[72:75], v[16:19]
  s_waitcnt lgkmcnt(6)
  ds_read_b64_tr_b16 v[104:105], v6 offset:27392
  ds_read_b64_tr_b16 v[106:107], v6 offset:27456
  v_mfma_f32_16x16x32_bf16 v[16:19], v[44:47], v[76:79], v[16:19]
  s_waitcnt lgkmcnt(6)
  ds_read_b64_tr_b16 v[108:109], v6 offset:27648
  ds_read_b64_tr_b16 v[110:111], v6 offset:27712
  v_mfma_f32_16x16x32_bf16 v[16:19], v[48:51], v[80:83], v[16:19]
  s_waitcnt lgkmcnt(6)
  v_cvt_pk_bf16_f32 v120, v24, v25
  v_cvt_pk_bf16_f32 v121, v26, v27
  v_mov_b32 v86, s14
  v_mfma_f32_16x16x32_bf16 v[112:115], v[116:119], v[68:71], 0
  s_waitcnt lgkmcnt(4)
  buffer_store_dword v86, v3, s[4:7], s15 offen sc1
  buffer_store_dwordx2 v[120:121], v5, s[4:7], s29 offen offset:2304 sc1
  v_mov_b64 v[98:99], 0
  v_mfma_f32_16x16x32_bf16 v[112:115], v[124:127], v[72:75], v[112:115]
  s_waitcnt lgkmcnt(2)
  v_mov_b64 v[36:37], 0
  v_exp_f32 v100, v16
  v_mfma_f32_16x16x32_bf16 v[112:115], v[104:107], v[76:79], v[112:115]
  s_waitcnt lgkmcnt(0)
  v_exp_f32 v101, v17
  v_mfma_f32_16x16x32_bf16 v[112:115], v[108:111], v[80:83], v[112:115]
  s_add_u32 s29, s29, 147456
  v_exp_f32 v102, v18
  v_mfma_f32_16x16x32_bf16 v[20:23], v[52:55], v[68:71], 0
  s_cmp_eq_u32 s14, 63
  v_exp_f32 v103, v19
  v_mfma_f32_16x16x32_bf16 v[20:23], v[56:59], v[72:75], v[20:23]
  s_cbranch_scc1 M_tdone
  v_cvt_pk_bf16_f32 v44, v100, v101
  v_cvt_pk_bf16_f32 v45, v102, v103
  v_mfma_f32_16x16x32_bf16 v[20:23], v[60:63], v[76:79], v[20:23]
  v_exp_f32 v100, v112
  v_mfma_f32_16x16x32_bf16 v[20:23], v[64:67], v[80:83], v[20:23]
  v_exp_f32 v101, v113
  v_exp_f32 v102, v114
  v_exp_f32 v103, v115
  v_cvt_pk_bf16_f32 v84, v100, v101
  v_cvt_pk_bf16_f32 v85, v102, v103
  v_cndmask_b32 v48, v84, 0, s[16:17]
  v_cndmask_b32 v49, v85, 0, s[16:17]
  v_cndmask_b32 v50, 0, v84, s[16:17]
  v_cndmask_b32 v51, 0, v85, s[16:17]
  v_exp_f32 v100, v20
  v_mfma_f32_16x16x16_bf16 v[88:91], v[12:13], v[48:49], 0
  v_exp_f32 v101, v21
  v_mfma_f32_16x16x16_bf16 v[24:27], v[120:121], v[48:49], 0
  v_exp_f32 v102, v22
  v_mfma_f32_16x16x16_bf16 v[116:119], v[120:121], v[50:51], 0
  v_exp_f32 v103, v23
  v_cvt_pk_bf16_f32 v46, v100, v101
  v_cvt_pk_bf16_f32 v47, v102, v103
  v_mov_b64 v[38:39], 0
  s_nop 0
  v_mfma_f32_16x16x32_bf16 v[88:91], v[12:15], v[44:47], v[88:91]
  v_mov_b64 v[40:41], 0
  v_mov_b64 v[42:43], 0
  v_mfma_f32_16x16x32_bf16 v[24:27], v[28:31], v[44:47], v[24:27]
  ds_read_b128 v[52:55], v4 offset:24576
  ds_read_b128 v[56:59], v4 offset:25600
  v_mfma_f32_16x16x32_bf16 v[116:119], v[32:35], v[44:47], v[116:119]
  s_nop 1
  v_rcp_f32 v89, v88
  v_subrev_u32 v100, s54, v88
  v_cmp_le_u32 vcc, s55, v100
  v_mul_f32 v24, v89, v24
  v_mul_f32 v25, v89, v25
  s_cbranch_vccnz T_slow_169
T_back_170:
  v_cvt_pk_bf16_f32 v124, v24, v25
  v_pk_mul_f32 v[26:27], v[26:27], v[88:89] op_sel:[0,1] op_sel_hi:[1,1]
  v_pk_mul_f32 v[116:117], v[116:117], v[88:89] op_sel:[0,1] op_sel_hi:[1,1]
  v_pk_mul_f32 v[118:119], v[118:119], v[88:89] op_sel:[0,1] op_sel_hi:[1,1]
  v_cvt_pk_bf16_f32 v125, v26, v27
  v_cvt_pk_bf16_f32 v126, v116, v117
  v_cvt_pk_bf16_f32 v127, v118, v119
  ds_write_b128 v11, v[124:127] offset:30208
  s_nop 0
  v_smfmac_f32_16x16x64_bf16 v[92:95], v[124:127], a[160:167], v0
  v_smfmac_f32_16x16x64_bf16 v[96:99], v[124:127], a[168:175], v0
  v_smfmac_f32_16x16x64_bf16 v[36:39], v[124:127], a[176:183], v0
  v_smfmac_f32_16x16x64_bf16 v[40:43], v[124:127], a[184:191], v0
  s_waitcnt lgkmcnt(0)
  s_barrier
  ds_read_b128 v[104:107], v11 offset:30720
  ds_read_b128 v[108:111], v11 offset:29184
  ds_read_b128 v[68:71], v11 offset:29696
  s_waitcnt lgkmcnt(2)
  v_smfmac_f32_16x16x64_bf16 v[92:95], v[104:107], a[192:199], v0
  s_waitcnt lgkmcnt(1)
  ds_read_b128 v[76:79], v4 offset:28672
  v_smfmac_f32_16x16x64_bf16 v[92:95], v[108:111], a[224:231], v0
  s_waitcnt lgkmcnt(1)
  ds_read_b128 v[80:83], v4 offset:29696
  v_smfmac_f32_16x16x64_bf16 v[92:95], v[68:71], a[240:247], v0
  ds_read_b128 v[60:63], v4 offset:26624
  v_smfmac_f32_16x16x64_bf16 v[96:99], v[104:107], a[200:207], v0
  ds_read_b128 v[64:67], v4 offset:27648
  v_smfmac_f32_16x16x64_bf16 v[96:99], v[108:111], a[232:239], v0
  ds_read_b128 v[28:31], v4 offset:30720
  s_nop 0
  v_cvt_pk_bf16_f32 v16, v92, v93
  v_cvt_pk_bf16_f32 v17, v94, v95
  v_bfi_b32 v16, 1, s57, v16
  v_smfmac_f32_16x16x64_bf16 v[96:99], v[68:71], a[248:255], v0
  buffer_store_dwordx2 v[16:17], v7, s[4:7], s20 offen offset:0 sc1
  v_smfmac_f32_16x16x64_bf16 v[36:39], v[104:107], a[208:215], v0
  ds_read_b128 v[32:35], v4 offset:31744
  v_smfmac_f32_16x16x64_bf16 v[36:39], v[108:111], v[52:59], v0
  s_waitcnt lgkmcnt(4)
  s_nop 0
  v_cvt_pk_bf16_f32 v18, v96, v97
  v_cvt_pk_bf16_f32 v19, v98, v99
  v_bfi_b32 v18, 1, s57, v18
  v_smfmac_f32_16x16x64_bf16 v[36:39], v[68:71], v[76:83], v0
  buffer_store_dwordx2 v[18:19], v7, s[4:7], s20 offen offset:64 sc1
  v_smfmac_f32_16x16x64_bf16 v[40:43], v[104:107], a[216:223], v0
  s_waitcnt lgkmcnt(2)
  v_smfmac_f32_16x16x64_bf16 v[40:43], v[108:111], v[60:67], v0
  s_waitcnt lgkmcnt(0)
  s_nop 0
  v_cvt_pk_bf16_f32 v20, v36, v37
  v_cvt_pk_bf16_f32 v21, v38, v39
  v_bfi_b32 v20, 1, s57, v20
  v_smfmac_f32_16x16x64_bf16 v[40:43], v[68:71], v[28:35], v0
  buffer_store_dwordx2 v[20:21], v7, s[4:7], s21 offen offset:0 sc1
  s_nop 6
  v_cvt_pk_bf16_f32 v22, v40, v41
  v_cvt_pk_bf16_f32 v23, v42, v43
  v_bfi_b32 v22, 1, s57, v22
  buffer_store_dwordx2 v[22:23], v7, s[4:7], s21 offen offset:64 sc1
  ds_read_b128 v[68:71], v4 offset:0
  ds_read_b128 v[72:75], v4 offset:1024
  ds_read_b128 v[76:79], v4 offset:4096
  ds_read_b128 v[80:83], v4 offset:5120
  ds_read_b128 v[84:87], v4 offset:8192
  ds_read_b128 v[88:91], v4 offset:9216
  ds_read_b128 v[92:95], v4 offset:2048
  ds_read_b128 v[96:99], v4 offset:3072
  ds_read_b128 v[100:103], v4 offset:6144
  ds_read_b128 v[104:107], v4 offset:7168
  ds_read_b128 v[108:111], v4 offset:10240
  ds_read_b128 v[112:115], v4 offset:11264
  v_mov_b64 v[16:17], 0
  v_mov_b64 v[18:19], 0
  v_mov_b64 v[20:21], 0
  v_mov_b64 v[22:23], 0
  v_mov_b64 v[24:25], 0
  v_mov_b64 v[26:27], 0
  ds_read_b64 v[44:45], v2 offset:32256
  s_waitcnt lgkmcnt(0)
  v_readfirstlane_b32 s38, v44
  v_readfirstlane_b32 s37, v45
  s_nop 0
  s_add_u32 s37, s37, 30
  s_cmp_ge_u32 s38, 30
  s_cselect_b32 s38, s37, s38
  s_cmp_ge_u32 s38, 64
  s_cselect_b32 s38, 100, s38
  s_sub_u32 s38, s38, 1
  s_max_i32 s30, s30, s38
  s_waitcnt vmcnt(4)
  s_barrier
  ds_read_b128 v[28:31], v2 offset:18432
  ds_read_b128 v[32:35], v2 offset:22528
  ds_read_b128 v[36:39], v2 offset:8192
  ds_read_b128 v[40:43], v2 offset:9216
  ds_read_b128 v[44:47], v2 offset:10240
  ds_read_b128 v[48:51], v2 offset:11264
  buffer_load_dwordx4 v[124:127], v2, s[4:7], s24 offen offset:2048 sc1
  buffer_load_dwordx4 v[116:119], v2, s[4:7], s25 offen offset:2048 sc1
  ds_read_b128 v[52:55], v2 offset:12288
  ds_read_b128 v[56:59], v2 offset:13312
  ds_read_b128 v[60:63], v2 offset:14336
  ds_read_b128 v[64:67], v2 offset:15360
  buffer_load_dwordx4 v[124:127], v2, s[4:7], s24 offen offset:2048 sc1
  buffer_load_dwordx4 v[116:119], v2, s[4:7], s25 offen offset:2048 sc1
  s_mov_b32 s19, 0
  s_branch T_loop_163
T_kvw_167:
  s_mov_b32 s19, 0
  s_branch T_kvok_175
T_kv_174:
  s_sleep 4
  s_add_u32 s19, s19, 1
  s_cmp_gt_u32 s19, 32768
  s_cbranch_scc1 M_exit
T_kvok_175:
  s_add_u32 s39, s99, 128
  s_mov_b32 s38, 0
  s_mov_b32 s37, 0
  s_atomic_or s38, s[58:59], s99 glc
  s_atomic_or s37, s[58:59], s39 glc
  s_waitcnt lgkmcnt(0)
  s_add_u32 s37, s37, 30
  s_cmp_ge_u32 s38, 30
  s_cselect_b32 s38, s37, s38
  s_cmp_ge_u32 s38, 64
  s_cselect_b32 s38, 100, s38
  s_sub_u32 s38, s38, 1
  s_max_i32 s30, s30, s38
  s_cmp_ge_i32 s14, s30
  s_cbranch_scc1 T_kv_174
  s_branch T_kvb_168
T_slow_169:
  s_nop 7
  v_max3_f32 v100, v16, v17, v18
  v_max3_f32 v100, v100, v19, v20
  v_max3_f32 v100, v100, v21, v22
  v_max3_f32 v100, v100, v23, v112
  v_max3_f32 v100, v100, v113, v114
  v_max_f32 v100, v100, v115
  v_mov_b32 v101, v100
  s_nop 1
  v_permlane32_swap_b32 v100, v101
  s_nop 1
  v_max_f32 v100, v100, v101
  v_mov_b32 v101, v100
  s_nop 1
  v_permlane16_swap_b32 v100, v101
  s_nop 1
  v_max_f32 v100, v100, v101
  v_sub_f32 v16, v16, v100
  v_sub_f32 v17, v17, v100
  v_sub_f32 v18, v18, v100
  v_sub_f32 v19, v19, v100
  v_exp_f32 v16, v16
  v_exp_f32 v17, v17
  v_exp_f32 v18, v18
  v_exp_f32 v19, v19
  v_sub_f32 v20, v20, v100
  v_sub_f32 v21, v21, v100
  v_sub_f32 v22, v22, v100
  v_sub_f32 v23, v23, v100
  v_exp_f32 v20, v20
  v_exp_f32 v21, v21
  v_exp_f32 v22, v22
  v_exp_f32 v23, v23
  v_sub_f32 v112, v112, v100
  v_sub_f32 v113, v113, v100
  v_sub_f32 v114, v114, v100
  v_sub_f32 v115, v115, v100
  v_exp_f32 v112, v112
  v_exp_f32 v113, v113
  v_exp_f32 v114, v114
  v_exp_f32 v115, v115
  s_nop 0
  v_cvt_pk_bf16_f32 v44, v16, v17
  v_cvt_pk_bf16_f32 v45, v18, v19
  v_cvt_pk_bf16_f32 v46, v20, v21
  v_cvt_pk_bf16_f32 v47, v22, v23
  v_cvt_pk_bf16_f32 v84, v112, v113
  v_cvt_pk_bf16_f32 v85, v114, v115
  v_cndmask_b32 v48, v84, 0, s[16:17]
  v_cndmask_b32 v49, v85, 0, s[16:17]
  v_cndmask_b32 v50, 0, v84, s[16:17]
  v_cndmask_b32 v51, 0, v85, s[16:17]
  s_nop 1
  v_mfma_f32_16x16x16_bf16 v[88:91], v[12:13], v[48:49], 0
  v_mfma_f32_16x16x16_bf16 v[24:27], v[120:121], v[48:49], 0
  v_mfma_f32_16x16x16_bf16 v[116:119], v[120:121], v[50:51], 0
  v_mfma_f32_16x16x32_bf16 v[88:91], v[12:15], v[44:47], v[88:91]
  v_mfma_f32_16x16x32_bf16 v[24:27], v[28:31], v[44:47], v[24:27]
  v_mfma_f32_16x16x32_bf16 v[116:119], v[32:35], v[44:47], v[116:119]
  s_nop 7
  s_nop 1
  v_rcp_f32 v89, v88
  s_nop 0
  v_mul_f32 v24, v89, v24
  v_mul_f32 v25, v89, v25
  s_branch T_back_170
T_w_136:
  s_mov_b32 s19, 0
  v_mov_b64 v[16:17], 0
  v_mov_b64 v[18:19], 0
  v_mov_b64 v[20:21], 0
  v_mov_b64 v[22:23], 0
  v_mov_b64 v[24:25], 0
  v_mov_b64 v[26:27], 0
  buffer_load_dwordx4 v[124:127], v2, s[4:7], s24 offen offset:3072 sc1
  buffer_load_dwordx4 v[116:119], v2, s[4:7], s25 offen offset:3072 sc1
  buffer_load_dwordx4 v[124:127], v2, s[4:7], s24 offen offset:3072 sc1
  buffer_load_dwordx4 v[116:119], v2, s[4:7], s25 offen offset:3072 sc1
  s_branch T_loop_176
.p2align 6
T_retry_177:
  s_mov_b64 exec, vcc
  buffer_load_dwordx4 v[124:127], v2, s[4:7], s24 offen offset:3072 sc1
  buffer_load_dwordx4 v[116:119], v2, s[4:7], s25 offen offset:3072 sc1
  s_mov_b64 exec, -1
  s_add_u32 s19, s19, 1
  s_cmp_gt_u32 s19, 32768
  s_cbranch_scc1 M_exit
T_loop_176:
  s_waitcnt vmcnt(3) lgkmcnt(0)
  v_max3_u32 v123, v124, v125, v126
  v_max_u32 v123, v123, v127
  v_mov_b32_dpp v120, v124 row_ror:8 row_mask:0xf bank_mask:0xf
  v_mov_b32_dpp v121, v125 row_ror:8 row_mask:0xf bank_mask:0xf
  s_waitcnt vmcnt(2)
  v_max3_u32 v123, v123, v116, v117
  v_max3_u32 v123, v123, v118, v119
  v_cmp_eq_u32 vcc, -1, v123
  s_cbranch_vccnz T_retry_177
  v_smfmac_f32_16x16x64_bf16 v[16:19], v[124:127], v[68:75], v0
  s_add_u32 s14, s14, 1
  ds_write_b128 v2, v[124:127] offset:3072
  v_mov_b32_dpp v122, v126 row_ror:8 row_mask:0xf bank_mask:0xf
  v_smfmac_f32_16x16x64_bf16 v[20:23], v[124:127], v[76:83], v0
  s_and_b32 s57, s14, 1
  v_mov_b32_dpp v123, v127 row_ror:8 row_mask:0xf bank_mask:0xf
  v_smfmac_f32_16x16x64_bf16 v[24:27], v[124:127], v[84:91], v0
  s_and_b32 s36, s14, 3
  ds_write_b128 v2, v[116:119] offset:7168
  v_smfmac_f32_16x16x64_bf16 v[16:19], v[120:123], v[92:99], v0
  s_lshl_b32 s36, s36, 13
  v_mov_b32_dpp v84, v116 row_ror:8 row_mask:0xf bank_mask:0xf
  v_smfmac_f32_16x16x64_bf16 v[20:23], v[120:123], v[100:107], v0
  s_add_u32 s26, s36, s23
  ds_read_b128 v[68:71], v4 offset:12288
  v_mov_b32_dpp v85, v117 row_ror:8 row_mask:0xf bank_mask:0xf
  v_smfmac_f32_16x16x64_bf16 v[24:27], v[120:123], v[108:115], v0
  s_add_u32 s36, s36, 8192
  ds_read_b128 v[72:75], v4 offset:13312
  v_mov_b32_dpp v86, v118 row_ror:8 row_mask:0xf bank_mask:0xf
  v_smfmac_f32_16x16x64_bf16 v[16:19], v[116:119], v[224:231], v0
  s_and_b32 s36, s36, 0x7fff
  ds_read_b128 v[76:79], v4 offset:14336
  v_mov_b32_dpp v87, v119 row_ror:8 row_mask:0xf bank_mask:0xf
  v_smfmac_f32_16x16x64_bf16 v[20:23], v[116:119], v[240:247], v0
  s_waitcnt lgkmcnt(3)
  s_barrier
  ds_read_b128 v[100:103], v2 offset:2048
  v_smfmac_f32_16x16x64_bf16 v[24:27], v[116:119], a[0:7], v0
  s_mov_b32 m0, s31
  ds_read_b128 v[120:123], v1 offset:2048
  v_smfmac_f32_16x16x64_bf16 v[16:19], v[84:87], v[232:239], v0
  s_cmp_ge_i32 s14, s30
  s_cbranch_scc1 T_kvw_180
T_kvb_181:
  v_smfmac_f32_16x16x64_bf16 v[20:23], v[84:87], v[248:255], v0
  ds_read_b128 v[80:83], v4 offset:15360
  v_smfmac_f32_16x16x64_bf16 v[24:27], v[84:87], a[8:15], v0
  s_waitcnt lgkmcnt(2)
  v_smfmac_f32_16x16x64_bf16 v[16:19], v[100:103], v[128:135], v0
  ds_read_b128 v[92:95], v2 offset:1024
  v_smfmac_f32_16x16x64_bf16 v[20:23], v[100:103], v[144:151], v0
  ds_read_b128 v[96:99], v1 offset:1024
  buffer_load_dwordx4 v9, s[4:7], s27 offen sc1 lds
  v_smfmac_f32_16x16x64_bf16 v[24:27], v[100:103], v[68:75], v0
  s_waitcnt vmcnt(1) lgkmcnt(3)
  ds_read_b128 v[116:119], v2 offset:0
  s_mov_b32 m0, s32
  v_smfmac_f32_16x16x64_bf16 v[16:19], v[120:123], v[136:143], v0
  ds_read_b128 v[124:127], v1 offset:0
  v_smfmac_f32_16x16x64_bf16 v[20:23], v[120:123], v[152:159], v0
  s_waitcnt lgkmcnt(4)
  ds_read_b128 v[104:107], v2 offset:6144
  v_smfmac_f32_16x16x64_bf16 v[24:27], v[120:123], v[76:83], v0
  s_waitcnt lgkmcnt(4)
  ds_read_b128 v[108:111], v1 offset:6144
  buffer_load_dwordx4 v9, s[4:7], s27 offen offset:128 sc1 lds
  v_smfmac_f32_16x16x64_bf16 v[16:19], v[92:95], v[160:167], v0
  s_waitcnt lgkmcnt(4)
  ds_read_b128 v[112:115], v2 offset:5120
  s_mov_b32 m0, s33
  v_smfmac_f32_16x16x64_bf16 v[16:19], v[96:99], v[168:175], v0
  s_waitcnt lgkmcnt(4)
  ds_read_b128 v[84:87], v1 offset:5120
  v_smfmac_f32_16x16x64_bf16 v[16:19], v[116:119], v[192:199], v0
  s_waitcnt lgkmcnt(4)
  ds_read_b128 v[88:91], v2 offset:4096
  v_smfmac_f32_16x16x64_bf16 v[16:19], v[124:127], v[200:207], v0
  s_waitcnt lgkmcnt(4)
  ds_read_b128 v[100:103], v1 offset:4096
  buffer_load_dwordx4 v10, s[4:7], s28 offen sc1 lds
  v_smfmac_f32_16x16x64_bf16 v[16:19], v[104:107], a[16:23], v0
  s_waitcnt lgkmcnt(4)
  ds_read_b128 v[68:71], v4 offset:16384
  s_mov_b32 m0, s34
  v_smfmac_f32_16x16x64_bf16 v[16:19], v[108:111], a[24:31], v0
  s_waitcnt lgkmcnt(4)
  ds_read_b128 v[72:75], v4 offset:17408
  v_smfmac_f32_16x16x64_bf16 v[16:19], v[112:115], a[64:71], v0
  s_waitcnt lgkmcnt(4)
  ds_read_b128 v[76:79], v4 offset:18432
  v_smfmac_f32_16x16x64_bf16 v[16:19], v[84:87], a[72:79], v0
  s_waitcnt lgkmcnt(4)
  ds_read_b128 v[80:83], v4 offset:19456
  buffer_load_dwordx4 v10, s[4:7], s28 offen offset:256 sc1 lds
  v_smfmac_f32_16x16x64_bf16 v[16:19], v[88:91], a[112:119], v0
  s_waitcnt lgkmcnt(4)
  v_smfmac_f32_16x16x64_bf16 v[16:19], v[100:103], a[120:127], v0
  s_add_u32 s24, s36, 145752064
  s_add_u32 s25, s36, 145756160
  v_smfmac_f32_16x16x64_bf16 v[20:23], v[92:95], v[176:183], v0
  s_add_u32 s35, s36, s23
  v_smfmac_f32_16x16x64_bf16 v[20:23], v[96:99], v[184:191], v0
  s_waitcnt lgkmcnt(2)
  v_smfmac_f32_16x16x64_bf16 v[20:23], v[116:119], v[68:75], v0
  s_waitcnt lgkmcnt(0)
  ds_read_b128 v[68:71], v4 offset:20480
  v_mul_f32 v16, s18, v16
  v_smfmac_f32_16x16x64_bf16 v[20:23], v[124:127], v[76:83], v0
  ds_read_b128 v[72:75], v4 offset:21504
  v_mul_f32 v17, s18, v17
  v_smfmac_f32_16x16x64_bf16 v[20:23], v[104:107], a[32:39], v0
  ds_read_b128 v[76:79], v4 offset:22528
  v_mul_f32 v18, s18, v18
  v_smfmac_f32_16x16x64_bf16 v[20:23], v[108:111], a[40:47], v0
  ds_read_b128 v[80:83], v4 offset:23552
  v_mul_f32 v19, s18, v19
  v_smfmac_f32_16x16x64_bf16 v[20:23], v[112:115], a[80:87], v0
  v_cvt_pk_bf16_f32 v120, v16, v17
  v_smfmac_f32_16x16x64_bf16 v[20:23], v[84:87], a[88:95], v0
  v_cvt_pk_bf16_f32 v121, v18, v19
  v_smfmac_f32_16x16x64_bf16 v[20:23], v[88:91], a[128:135], v0
  ds_write_b64 v5, v[120:121] offset:24576
  v_smfmac_f32_16x16x64_bf16 v[20:23], v[100:103], a[136:143], v0
  s_waitcnt lgkmcnt(3)
  v_smfmac_f32_16x16x64_bf16 v[24:27], v[92:95], v[68:75], v0
  s_waitcnt lgkmcnt(1)
  v_mov_b64 v[92:93], 0
  v_smfmac_f32_16x16x64_bf16 v[24:27], v[96:99], v[76:83], v0
  s_nop 1
  v_cvt_pk_bf16_f32 v122, v20, v21
  v_cvt_pk_bf16_f32 v123, v22, v23
  v_smfmac_f32_16x16x64_bf16 v[24:27], v[116:119], v[208:215], v0
  ds_write_b64 v5, v[122:123] offset:26880
  v_mov_b64 v[94:95], 0
  v_smfmac_f32_16x16x64_bf16 v[24:27], v[124:127], v[216:223], v0
  s_waitcnt lgkmcnt(1)
  s_barrier
  ds_read_b64_tr_b16 v[68:69], v6 offset:24576
  v_smfmac_f32_16x16x64_bf16 v[24:27], v[104:107], a[48:55], v0
  s_add_u32 s27, s27, 8192
  ds_read_b64_tr_b16 v[70:71], v6 offset:24640
  ds_read_b64_tr_b16 v[72:73], v6 offset:24832
  v_smfmac_f32_16x16x64_bf16 v[24:27], v[108:111], a[56:63], v0
  s_add_u32 s28, s28, 8192
  ds_read_b64_tr_b16 v[74:75], v6 offset:24896
  ds_read_b64_tr_b16 v[76:77], v6 offset:25088
  v_smfmac_f32_16x16x64_bf16 v[24:27], v[112:115], a[96:103], v0
  s_nop 0
  ds_read_b64_tr_b16 v[78:79], v6 offset:25152
  ds_read_b64_tr_b16 v[80:81], v6 offset:25344
  v_smfmac_f32_16x16x64_bf16 v[24:27], v[84:87], a[104:111], v0
  ds_read_b64_tr_b16 v[82:83], v6 offset:25408
  v_mov_b64 v[96:97], 0
  v_smfmac_f32_16x16x64_bf16 v[24:27], v[88:91], a[144:151], v0
  s_waitcnt lgkmcnt(8)
  s_barrier
  ds_read_b64_tr_b16 v[116:117], v6 offset:26880
  v_smfmac_f32_16x16x64_bf16 v[24:27], v[100:103], a[152:159], v0
  s_waitcnt lgkmcnt(7)
  ds_read_b64_tr_b16 v[118:119], v6 offset:26944
  buffer_store_dwordx2 v[122:123], v5, s[4:7], s29 offen sc1
  v_mfma_f32_16x16x32_bf16 v[16:19], v[36:39], v[68:71], 0
  s_waitcnt lgkmcnt(6)
  ds_read_b64_tr_b16 v[124:125], v6 offset:27136
  ds_read_b64_tr_b16 v[126:127], v6 offset:27200
  v_mfma_f32_16x16x32_bf16 v[16:19], v[40:43], v[72:75], v[16:19]
  s_waitcnt lgkmcnt(6)
  ds_read_b64_tr_b16 v[104:105], v6 offset:27392
  ds_read_b64_tr_b16 v[106:107], v6 offset:27456
  v_mfma_f32_16x16x32_bf16 v[16:19], v[44:47], v[76:79], v[16:19]
  s_waitcnt lgkmcnt(6)
  ds_read_b64_tr_b16 v[108:109], v6 offset:27648
  ds_read_b64_tr_b16 v[110:111], v6 offset:27712
  v_mfma_f32_16x16x32_bf16 v[16:19], v[48:51], v[80:83], v[16:19]
  s_waitcnt lgkmcnt(6)
  s_mov_b32 m0, 32256
  v_cvt_pk_bf16_f32 v120, v24, v25
  v_cvt_pk_bf16_f32 v121, v26, v27
  v_mfma_f32_16x16x32_bf16 v[112:115], v[116:119], v[68:71], 0
  s_waitcnt lgkmcnt(4)
  buffer_load_dword v3, s[4:7], s99 offen sc1 lds
  buffer_store_dwordx2 v[120:121], v5, s[4:7], s29 offen offset:2304 sc1
  v_mov_b64 v[98:99], 0
  v_mfma_f32_16x16x32_bf16 v[112:115], v[124:127], v[72:75], v[112:115]
  s_waitcnt lgkmcnt(2)
  v_mov_b64 v[36:37], 0
  v_exp_f32 v100, v16
  v_mfma_f32_16x16x32_bf16 v[112:115], v[104:107], v[76:79], v[112:115]
  s_waitcnt lgkmcnt(0)
  v_exp_f32 v101, v17
  v_mfma_f32_16x16x32_bf16 v[112:115], v[108:111], v[80:83], v[112:115]
  s_add_u32 s29, s29, 147456
  v_exp_f32 v102, v18
  v_mfma_f32_16x16x32_bf16 v[20:23], v[52:55], v[68:71], 0
  s_cmp_eq_u32 s14, 63
  v_exp_f32 v103, v19
  v_mfma_f32_16x16x32_bf16 v[20:23], v[56:59], v[72:75], v[20:23]
  s_cbranch_scc1 M_tdone
  v_cvt_pk_bf16_f32 v44, v100, v101
  v_cvt_pk_bf16_f32 v45, v102, v103
  v_mfma_f32_16x16x32_bf16 v[20:23], v[60:63], v[76:79], v[20:23]
  v_exp_f32 v100, v112
  v_mfma_f32_16x16x32_bf16 v[20:23], v[64:67], v[80:83], v[20:23]
  v_exp_f32 v101, v113
  v_exp_f32 v102, v114
  v_exp_f32 v103, v115
  v_cvt_pk_bf16_f32 v84, v100, v101
  v_cvt_pk_bf16_f32 v85, v102, v103
  v_cndmask_b32 v48, v84, 0, s[16:17]
  v_cndmask_b32 v49, v85, 0, s[16:17]
  v_cndmask_b32 v50, 0, v84, s[16:17]
  v_cndmask_b32 v51, 0, v85, s[16:17]
  v_exp_f32 v100, v20
  v_mfma_f32_16x16x16_bf16 v[88:91], v[12:13], v[48:49], 0
  v_exp_f32 v101, v21
  v_mfma_f32_16x16x16_bf16 v[24:27], v[120:121], v[48:49], 0
  v_exp_f32 v102, v22
  v_mfma_f32_16x16x16_bf16 v[116:119], v[120:121], v[50:51], 0
  v_exp_f32 v103, v23
  v_cvt_pk_bf16_f32 v46, v100, v101
  v_cvt_pk_bf16_f32 v47, v102, v103
  v_mov_b64 v[38:39], 0
  s_nop 0
  v_mfma_f32_16x16x32_bf16 v[88:91], v[12:15], v[44:47], v[88:91]
  v_mov_b64 v[40:41], 0
  v_mov_b64 v[42:43], 0
  v_mfma_f32_16x16x32_bf16 v[24:27], v[28:31], v[44:47], v[24:27]
  ds_read_b128 v[52:55], v4 offset:24576
  ds_read_b128 v[56:59], v4 offset:25600
  v_mfma_f32_16x16x32_bf16 v[116:119], v[32:35], v[44:47], v[116:119]
  s_nop 1
  v_rcp_f32 v89, v88
  v_subrev_u32 v100, s54, v88
  v_cmp_le_u32 vcc, s55, v100
  v_mul_f32 v24, v89, v24
  v_mul_f32 v25, v89, v25
  s_cbranch_vccnz T_slow_182
T_back_183:
  v_cvt_pk_bf16_f32 v124, v24, v25
  v_pk_mul_f32 v[26:27], v[26:27], v[88:89] op_sel:[0,1] op_sel_hi:[1,1]
  v_pk_mul_f32 v[116:117], v[116:117], v[88:89] op_sel:[0,1] op_sel_hi:[1,1]
  v_pk_mul_f32 v[118:119], v[118:119], v[88:89] op_sel:[0,1] op_sel_hi:[1,1]
  v_cvt_pk_bf16_f32 v125, v26, v27
  v_cvt_pk_bf16_f32 v126, v116, v117
  v_cvt_pk_bf16_f32 v127, v118, v119
  ds_write_b128 v11, v[124:127] offset:30720
  s_nop 0
  v_smfmac_f32_16x16x64_bf16 v[92:95], v[124:127], a[160:167], v0
  v_smfmac_f32_16x16x64_bf16 v[96:99], v[124:127], a[168:175], v0
  v_smfmac_f32_16x16x64_bf16 v[36:39], v[124:127], a[176:183], v0
  v_smfmac_f32_16x16x64_bf16 v[40:43], v[124:127], a[184:191], v0
  s_waitcnt lgkmcnt(0)
  s_barrier
  ds_read_b128 v[104:107], v11 offset:30208
  ds_read_b128 v[108:111], v11 offset:29696
  ds_read_b128 v[68:71], v11 offset:29184
  s_waitcnt lgkmcnt(2)
  v_smfmac_f32_16x16x64_bf16 v[92:95], v[104:107], a[192:199], v0
  s_waitcnt lgkmcnt(1)
  ds_read_b128 v[76:79], v4 offset:28672
  v_smfmac_f32_16x16x64_bf16 v[92:95], v[108:111], a[224:231], v0
  s_waitcnt lgkmcnt(1)
  ds_read_b128 v[80:83], v4 offset:29696
  v_smfmac_f32_16x16x64_bf16 v[92:95], v[68:71], a[240:247], v0
  ds_read_b128 v[60:63], v4 offset:26624
  v_smfmac_f32_16x16x64_bf16 v[96:99], v[104:107], a[200:207], v0
  ds_read_b128 v[64:67], v4 offset:27648
  v_smfmac_f32_16x16x64_bf16 v[96:99], v[108:111], a[232:239], v0
  ds_read_b128 v[28:31], v4 offset:30720
  s_nop 0
  v_cvt_pk_bf16_f32 v16, v92, v93
  v_cvt_pk_bf16_f32 v17, v94, v95
  v_bfi_b32 v16, 1, s57, v16
  v_smfmac_f32_16x16x64_bf16 v[96:99], v[68:71], a[248:255], v0
  buffer_store_dwordx2 v[16:17], v7, s[4:7], s20 offen offset:0 sc1
  v_smfmac_f32_16x16x64_bf16 v[36:39], v[104:107], a[208:215], v0
  ds_read_b128 v[32:35], v4 offset:31744
  v_smfmac_f32_16x16x64_bf16 v[36:39], v[108:111], v[52:59], v0
  s_waitcnt lgkmcnt(4)
  s_nop 0
  v_cvt_pk_bf16_f32 v18, v96, v97
  v_cvt_pk_bf16_f32 v19, v98, v99
  v_bfi_b32 v18, 1, s57, v18
  v_smfmac_f32_16x16x64_bf16 v[36:39], v[68:71], v[76:83], v0
  buffer_store_dwordx2 v[18:19], v7, s[4:7], s20 offen offset:64 sc1
  v_smfmac_f32_16x16x64_bf16 v[40:43], v[104:107], a[216:223], v0
  s_waitcnt lgkmcnt(2)
  v_smfmac_f32_16x16x64_bf16 v[40:43], v[108:111], v[60:67], v0
  s_waitcnt lgkmcnt(0)
  s_nop 0
  v_cvt_pk_bf16_f32 v20, v36, v37
  v_cvt_pk_bf16_f32 v21, v38, v39
  v_bfi_b32 v20, 1, s57, v20
  v_smfmac_f32_16x16x64_bf16 v[40:43], v[68:71], v[28:35], v0
  buffer_store_dwordx2 v[20:21], v7, s[4:7], s21 offen offset:0 sc1
  s_nop 6
  v_cvt_pk_bf16_f32 v22, v40, v41
  v_cvt_pk_bf16_f32 v23, v42, v43
  v_bfi_b32 v22, 1, s57, v22
  buffer_store_dwordx2 v[22:23], v7, s[4:7], s21 offen offset:64 sc1
  ds_read_b128 v[68:71], v4 offset:0
  ds_read_b128 v[72:75], v4 offset:1024
  ds_read_b128 v[76:79], v4 offset:4096
  ds_read_b128 v[80:83], v4 offset:5120
  ds_read_b128 v[84:87], v4 offset:8192
  ds_read_b128 v[88:91], v4 offset:9216
  ds_read_b128 v[92:95], v4 offset:2048
  ds_read_b128 v[96:99], v4 offset:3072
  ds_read_b128 v[100:103], v4 offset:6144
  ds_read_b128 v[104:107], v4 offset:7168
  ds_read_b128 v[108:111], v4 offset:10240
  ds_read_b128 v[112:115], v4 offset:11264
  v_mov_b64 v[16:17], 0
  v_mov_b64 v[18:19], 0
  v_mov_b64 v[20:21], 0
  v_mov_b64 v[22:23], 0
  v_mov_b64 v[24:25], 0
  v_mov_b64 v[26:27], 0
  ds_read_b64 v[44:45], v2 offset:32256
  s_waitcnt lgkmcnt(0)
  v_readfirstlane_b32 s38, v44
  v_readfirstlane_b32 s37, v45
  s_nop 0
  s_add_u32 s37, s37, 30
  s_cmp_ge_u32 s38, 30
  s_cselect_b32 s38, s37, s38
  s_cmp_ge_u32 s38, 64
  s_cselect_b32 s38, 100, s38
  s_sub_u32 s38, s38, 1
  s_max_i32 s30, s30, s38
  s_waitcnt vmcnt(4)
  s_barrier
  ds_read_b128 v[28:31], v2 offset:19456
  ds_read_b128 v[32:35], v2 offset:23552
  ds_read_b128 v[36:39], v2 offset:8192
  ds_read_b128 v[40:43], v2 offset:9216
  ds_read_b128 v[44:47], v2 offset:10240
  ds_read_b128 v[48:51], v2 offset:11264
  buffer_load_dwordx4 v[124:127], v2, s[4:7], s24 offen offset:3072 sc1
  buffer_load_dwordx4 v[116:119], v2, s[4:7], s25 offen offset:3072 sc1
  ds_read_b128 v[52:55], v2 offset:12288
  ds_read_b128 v[56:59], v2 offset:13312
  ds_read_b128 v[60:63], v2 offset:14336
  ds_read_b128 v[64:67], v2 offset:15360
  buffer_load_dwordx4 v[124:127], v2, s[4:7], s24 offen offset:3072 sc1
  buffer_load_dwordx4 v[116:119], v2, s[4:7], s25 offen offset:3072 sc1
  s_mov_b32 s19, 0
  s_branch T_loop_176
T_kvw_180:
  s_mov_b32 s19, 0
  s_branch T_kvok_188
T_kv_187:
  s_sleep 4
  s_add_u32 s19, s19, 1
  s_cmp_gt_u32 s19, 32768
  s_cbranch_scc1 M_exit
T_kvok_188:
  s_add_u32 s39, s99, 128
  s_mov_b32 s38, 0
  s_mov_b32 s37, 0
  s_atomic_or s38, s[58:59], s99 glc
  s_atomic_or s37, s[58:59], s39 glc
  s_waitcnt lgkmcnt(0)
  s_add_u32 s37, s37, 30
  s_cmp_ge_u32 s38, 30
  s_cselect_b32 s38, s37, s38
  s_cmp_ge_u32 s38, 64
  s_cselect_b32 s38, 100, s38
  s_sub_u32 s38, s38, 1
  s_max_i32 s30, s30, s38
  s_cmp_ge_i32 s14, s30
  s_cbranch_scc1 T_kv_187
  s_branch T_kvb_181
T_slow_182:
  s_nop 7
  v_max3_f32 v100, v16, v17, v18
  v_max3_f32 v100, v100, v19, v20
  v_max3_f32 v100, v100, v21, v22
  v_max3_f32 v100, v100, v23, v112
  v_max3_f32 v100, v100, v113, v114
  v_max_f32 v100, v100, v115
  v_mov_b32 v101, v100
  s_nop 1
  v_permlane32_swap_b32 v100, v101
  s_nop 1
  v_max_f32 v100, v100, v101
  v_mov_b32 v101, v100
  s_nop 1
  v_permlane16_swap_b32 v100, v101
  s_nop 1
  v_max_f32 v100, v100, v101
  v_sub_f32 v16, v16, v100
  v_sub_f32 v17, v17, v100
  v_sub_f32 v18, v18, v100
  v_sub_f32 v19, v19, v100
  v_exp_f32 v16, v16
  v_exp_f32 v17, v17
  v_exp_f32 v18, v18
  v_exp_f32 v19, v19
  v_sub_f32 v20, v20, v100
  v_sub_f32 v21, v21, v100
  v_sub_f32 v22, v22, v100
  v_sub_f32 v23, v23, v100
  v_exp_f32 v20, v20
  v_exp_f32 v21, v21
  v_exp_f32 v22, v22
  v_exp_f32 v23, v23
  v_sub_f32 v112, v112, v100
  v_sub_f32 v113, v113, v100
  v_sub_f32 v114, v114, v100
  v_sub_f32 v115, v115, v100
  v_exp_f32 v112, v112
  v_exp_f32 v113, v113
  v_exp_f32 v114, v114
  v_exp_f32 v115, v115
  s_nop 0
  v_cvt_pk_bf16_f32 v44, v16, v17
  v_cvt_pk_bf16_f32 v45, v18, v19
  v_cvt_pk_bf16_f32 v46, v20, v21
  v_cvt_pk_bf16_f32 v47, v22, v23
  v_cvt_pk_bf16_f32 v84, v112, v113
  v_cvt_pk_bf16_f32 v85, v114, v115
  v_cndmask_b32 v48, v84, 0, s[16:17]
  v_cndmask_b32 v49, v85, 0, s[16:17]
  v_cndmask_b32 v50, 0, v84, s[16:17]
  v_cndmask_b32 v51, 0, v85, s[16:17]
  s_nop 1
  v_mfma_f32_16x16x16_bf16 v[88:91], v[12:13], v[48:49], 0
  v_mfma_f32_16x16x16_bf16 v[24:27], v[120:121], v[48:49], 0
  v_mfma_f32_16x16x16_bf16 v[116:119], v[120:121], v[50:51], 0
  v_mfma_f32_16x16x32_bf16 v[88:91], v[12:15], v[44:47], v[88:91]
  v_mfma_f32_16x16x32_bf16 v[24:27], v[28:31], v[44:47], v[24:27]
  v_mfma_f32_16x16x32_bf16 v[116:119], v[32:35], v[44:47], v[116:119]
  s_nop 7
  s_nop 1
  v_rcp_f32 v89, v88
  s_nop 0
  v_mul_f32 v24, v89, v24
  v_mul_f32 v25, v89, v25
  s_branch T_back_183
M_tdone:
  v_mov_b32 v16, 64
  v_or_b32 v17, s13, v2
  v_min_u32 v17, 1, v17
  v_lshlrev_b32 v17, 30, v17
  s_waitcnt vmcnt(0)
  s_barrier
  buffer_store_dword v16, v17, s[4:7], s15 offen sc1
M_done:
M_exit:
  s_endpgm
.p2align 6
.type M_table,@object
M_table:
.long 0x1, 0x3f, 0xffffffff, 0x14, 0x1, 0x7, 0x800, 0x0, 0x8, 0x0, 0x0, 0x0, 0x0, 0x0, 0x0, 0x0
.long 0x1, 0x2b, 0xffffffff, 0x18, 0x1, 0x6, 0x1000, 0x0, 0x8, 0x1, 0x0, 0x0, 0x0, 0x0, 0x0, 0x0
.long 0x2, 0x0, 0x1, 0x1e, 0x1, 0x5, 0x1800, 0x0, 0x8, 0x0, 0x0, 0x0, 0x0, 0x0, 0x0, 0x0
.long 0x2, 0x1e, 0x1, 0x22, 0x1, 0x4, 0x2000, 0x0, 0x8, 0x1, 0x0, 0x0, 0x0, 0x0, 0x0, 0x0
.long 0x0, 0x0, 0x1, 0x20, 0x2, 0x3, 0x20, 0x0, 0x8, 0x2, 0x0, 0x0, 0x0, 0x0, 0x0, 0x0
.long 0x0, 0x3f, 0xffffffff, 0x20, 0x2, 0x2, 0x18, 0x1, 0x10, 0x0, 0x0, 0x0, 0x0, 0x0, 0x0, 0x0
.long 0x1, 0x13, 0xffffffff, 0x14, 0x0, 0x0, 0x8, 0x0, 0x8, 0x2, 0x0, 0x0, 0x0, 0x0, 0x0, 0x0
.size M_table, 448
.section .rodata,"a"
.p2align 6
.amdhsa_kernel gated_mix__compressed_kv_cla__memory_aug_recurrent_mem_tr__prompt_kernel
.amdhsa_next_free_vgpr 512
.amdhsa_next_free_sgpr 102
.amdhsa_accum_offset 256
.amdhsa_group_segment_fixed_size 0
.amdhsa_kernarg_size 136
.amdhsa_user_sgpr_count 2
.amdhsa_user_sgpr_kernarg_segment_ptr 1
.amdhsa_system_sgpr_workgroup_id_x 1
.end_amdhsa_kernel
```

```asm
; @launch grid=(256,1,1) block=(256,1,1) lds=163840
.amdgcn_target "amdgcn-amd-amdhsa--gfx950"
.text
.globl gated_mix__compressed_kv_cla__memory_aug_recurrent_mem_tr__prompt_kernel
.p2align 8
.type gated_mix__compressed_kv_cla__memory_aug_recurrent_mem_tr__prompt_kernel,@function
gated_mix__compressed_kv_cla__memory_aug_recurrent_mem_tr__prompt_kernel:
  s_cmp_ge_u32 s2, 256
  s_cbranch_scc1 M_exit
  s_load_dwordx4 s[72:75], s[0:1], 120
  v_lshrrev_b32 v3, 6, v0
  v_and_b32 v1, 63, v0
  v_readfirstlane_b32 s16, v3
  v_lshlrev_b32 v2, 4, v1
  s_and_b32 s76, s2, 7
  s_lshr_b32 s77, s2, 3
  s_sub_u32 s66, s76, 1
  s_and_b32 s66, s66, 7
  s_lshl_b32 s66, s66, 5
  s_add_u32 s66, s66, s77
  s_lshl_b32 s31, s66, 7
  s_add_u32 s31, s31, 148897792
  s_waitcnt lgkmcnt(0)
  s_mov_b64 s[4:5], s[74:75]
  s_mov_b64 s[74:75], s[72:73]
  s_mov_b64 s[72:73], s[4:5]
  s_and_b32 s5, s5, 0xffff
  s_mov_b32 s6, 268435456
  s_mov_b32 s7, 0x20000
  s_cmp_eq_u32 s76, 0
  s_cbranch_scc1 M_team
  s_mul_i32 s64, s66, 9363
  s_lshr_b32 s64, s64, 16
  s_mul_i32 s67, s64, 7
  s_sub_u32 s65, s66, s67
  s_lshl_b32 s67, s67, 7
  s_add_u32 s67, s67, 148897792
  s_getpc_b64 s[76:77]
M_pc:
  s_add_u32 s76, s76, M_table-M_pc
  s_addc_u32 s77, s77, 0
  s_lshl_b32 s26, s65, 6
  s_load_dwordx16 s[48:63], s[76:77], s26
  s_waitcnt lgkmcnt(0)
  s_mov_b32 s23, s51
  s_cmp_lg_u32 s48, 1
  s_cbranch_scc1 M_nobpf
  s_load_dwordx8 s[36:43], s[0:1], 64
  s_mul_i32 s76, s64, 3
  s_add_u32 s76, s76, s57
  v_lshlrev_b32 v4, 7, v0
  s_mov_b32 s10, 4194304
  s_mov_b32 s11, 0x20000
  s_waitcnt lgkmcnt(0)
  s_mov_b32 s8, s42
  s_and_b32 s9, s43, 0xffff
  s_mul_i32 s77, s76, 43776
  s_add_u32 s77, s77, 0
  v_min_u32 v5, 32640, v4
  v_add_u32 v5, s77, v5
  s_add_u32 s77, s77, 32768
  buffer_load_dword v6, v5, s[8:11], 0 offen
  v_min_u32 v5, 10880, v4
  v_add_u32 v5, s77, v5
  s_add_u32 s77, s77, 32768
  buffer_load_dword v6, v5, s[8:11], 0 offen
  s_mov_b32 s8, s38
  s_and_b32 s9, s39, 0xffff
  s_mul_i32 s77, s76, 21888
  s_add_u32 s77, s77, 2097152
  v_min_u32 v5, 21760, v4
  v_add_u32 v5, s77, v5
  s_add_u32 s77, s77, 32768
  buffer_load_dword v6, v5, s[8:11], 0 offen
  s_mov_b32 s8, s40
  s_and_b32 s9, s41, 0xffff
  s_mul_i32 s77, s76, 21888
  s_add_u32 s77, s77, 2097152
  v_min_u32 v5, 21760, v4
  v_add_u32 v5, s77, v5
  s_add_u32 s77, s77, 32768
  buffer_load_dword v6, v5, s[8:11], 0 offen
  s_mov_b32 s8, s36
  s_and_b32 s9, s37, 0xffff
  s_mul_i32 s77, s76, 21888
  s_add_u32 s77, s77, 2097152
  v_min_u32 v5, 21760, v4
  v_add_u32 v5, s77, v5
  s_add_u32 s77, s77, 32768
  buffer_load_dword v6, v5, s[8:11], 0 offen
  s_waitcnt vmcnt(0)
M_nobpf:
  s_lshr_b32 s29, s16, 1
  s_cmp_eq_u32 s29, 0
  s_cselect_b32 s26, 2, 8
  s_cselect_b32 s27, 3, 4
  s_cselect_b32 s28, 9, 10
  s_cmp_eq_u32 s48, 1
  s_cselect_b32 s26, s27, s26
  s_cmp_eq_u32 s48, 2
  s_cselect_b32 s26, s28, s26
  s_lshl_b32 s26, s26, 3
  s_load_dwordx2 s[8:9], s[0:1], s26
  s_cmp_eq_u32 s48, 1
  s_cselect_b32 s26, 8, 0
  s_load_dwordx2 s[12:13], s[0:1], s26
  s_cmp_eq_u32 s29, 0
  s_cselect_b32 s21, 0, 3
  s_cselect_b32 s27, 1, 2
  s_cselect_b32 s28, 4, 5
  s_cmp_eq_u32 s48, 1
  s_cselect_b32 s21, s27, s21
  s_cmp_eq_u32 s48, 2
  s_cselect_b32 s21, s28, s21
  s_lshl_b32 s21, s21, 5
  s_add_u32 s21, s21, s64
  s_lshl_b32 s21, s21, 6
  s_add_u32 s21, s21, s49
  s_and_b32 s27, s16, 1
  s_lshl_b32 s21, s21, 1
  s_add_u32 s21, s21, s27
  s_lshl_b32 s21, s21, 12
  s_lshl_b32 s22, s50, 13
  s_lshl_b32 s19, s49, 15
  s_lshl_b32 s20, s50, 15
  s_lshl_b32 s17, s64, 1
  s_add_u32 s17, s17, s27
  s_lshl_b32 s17, s17, 7
  s_mov_b32 s18, 8192
  s_cmp_eq_u32 s48, 0
  s_cselect_b32 s24, 0x3e0293ee, 1.0
  s_waitcnt lgkmcnt(0)
  s_and_b32 s9, s9, 0xffff
  s_mov_b32 s10, 4194304
  s_mov_b32 s11, 0x20000
  s_and_b32 s13, s13, 0xffff
  s_mov_b32 s14, 2097152
  s_mov_b32 s15, 0x20000
  v_and_b32 v144, 31, v1
  v_lshrrev_b32 v145, 5, v1
  v_and_b32 v146, 15, v1
  v_or_b32 v147, 0, v145
  v_xor_b32 v147, v147, v146
  v_lshlrev_b32 v147, 4, v147
  v_lshl_add_u32 v8, v144, 8, v147
  v_or_b32 v147, 2, v145
  v_xor_b32 v147, v147, v146
  v_lshlrev_b32 v147, 4, v147
  v_lshl_add_u32 v9, v144, 8, v147
  v_or_b32 v147, 4, v145
  v_xor_b32 v147, v147, v146
  v_lshlrev_b32 v147, 4, v147
  v_lshl_add_u32 v10, v144, 8, v147
  v_or_b32 v147, 6, v145
  v_xor_b32 v147, v147, v146
  v_lshlrev_b32 v147, 4, v147
  v_lshl_add_u32 v11, v144, 8, v147
  v_or_b32 v147, 8, v145
  v_xor_b32 v147, v147, v146
  v_lshlrev_b32 v147, 4, v147
  v_lshl_add_u32 v12, v144, 8, v147
  v_or_b32 v147, 10, v145
  v_xor_b32 v147, v147, v146
  v_lshlrev_b32 v147, 4, v147
  v_lshl_add_u32 v13, v144, 8, v147
  v_or_b32 v147, 12, v145
  v_xor_b32 v147, v147, v146
  v_lshlrev_b32 v147, 4, v147
  v_lshl_add_u32 v14, v144, 8, v147
  v_or_b32 v147, 14, v145
  v_xor_b32 v147, v147, v146
  v_lshlrev_b32 v147, 4, v147
  v_lshl_add_u32 v15, v144, 8, v147
  v_lshrrev_b32 v144, 4, v1
  s_lshl_b32 s26, s16, 8
  v_add_u32 v145, 0, v144
  v_and_b32 v147, 15, v145
  v_xor_b32 v147, v147, v146
  v_lshlrev_b32 v147, 4, v147
  v_lshl_add_u32 v147, v145, 10, v147
  v_add_u32 v16, s26, v147
  v_add_u32 v145, 4, v144
  v_and_b32 v147, 15, v145
  v_xor_b32 v147, v147, v146
  v_lshlrev_b32 v147, 4, v147
  v_lshl_add_u32 v147, v145, 10, v147
  v_add_u32 v17, s26, v147
  v_add_u32 v145, 8, v144
  v_and_b32 v147, 15, v145
  v_xor_b32 v147, v147, v146
  v_lshlrev_b32 v147, 4, v147
  v_lshl_add_u32 v147, v145, 10, v147
  v_add_u32 v18, s26, v147
  v_add_u32 v145, 12, v144
  v_and_b32 v147, 15, v145
  v_xor_b32 v147, v147, v146
  v_lshlrev_b32 v147, 4, v147
  v_lshl_add_u32 v147, v145, 10, v147
  v_add_u32 v19, s26, v147
  v_add_u32 v145, 16, v144
  v_and_b32 v147, 15, v145
  v_xor_b32 v147, v147, v146
  v_lshlrev_b32 v147, 4, v147
  v_lshl_add_u32 v147, v145, 10, v147
  v_add_u32 v20, s26, v147
  v_add_u32 v145, 20, v144
  v_and_b32 v147, 15, v145
  v_xor_b32 v147, v147, v146
  v_lshlrev_b32 v147, 4, v147
  v_lshl_add_u32 v147, v145, 10, v147
  v_add_u32 v21, s26, v147
  v_add_u32 v145, 24, v144
  v_and_b32 v147, 15, v145
  v_xor_b32 v147, v147, v146
  v_lshlrev_b32 v147, 4, v147
  v_lshl_add_u32 v147, v145, 10, v147
  v_add_u32 v22, s26, v147
  v_add_u32 v145, 28, v144
  v_and_b32 v147, 15, v145
  v_xor_b32 v147, v147, v146
  v_lshlrev_b32 v147, 4, v147
  v_lshl_add_u32 v147, v145, 10, v147
  v_add_u32 v23, s26, v147
  v_lshrrev_b32 v144, 3, v1
  v_mul_lo_u32 v144, v144, s18
  v_and_b32 v145, 7, v1
  v_lshl_add_u32 v144, v145, 4, v144
  s_lshl_b32 s28, s16, 15
  s_add_u32 s28, s28, 32768
  s_lshl_b32 s29, s18, 3
  s_add_u32 m0, s28, 0
  s_nop 0
  buffer_load_dwordx4 v144, s[8:11], s17 offen lds
  s_add_u32 s17, s17, s29
  s_add_u32 m0, s28, 1024
  s_nop 0
  buffer_load_dwordx4 v144, s[8:11], s17 offen lds
  s_add_u32 s17, s17, s29
  s_add_u32 m0, s28, 2048
  s_nop 0
  buffer_load_dwordx4 v144, s[8:11], s17 offen lds
  s_add_u32 s17, s17, s29
  s_add_u32 m0, s28, 3072
  s_nop 0
  buffer_load_dwordx4 v144, s[8:11], s17 offen lds
  s_add_u32 s17, s17, s29
  s_add_u32 m0, s28, 4096
  s_nop 0
  buffer_load_dwordx4 v144, s[8:11], s17 offen lds
  s_add_u32 s17, s17, s29
  s_add_u32 m0, s28, 5120
  s_nop 0
  buffer_load_dwordx4 v144, s[8:11], s17 offen lds
  s_add_u32 s17, s17, s29
  s_add_u32 m0, s28, 6144
  s_nop 0
  buffer_load_dwordx4 v144, s[8:11], s17 offen lds
  s_add_u32 s17, s17, s29
  s_add_u32 m0, s28, 7168
  s_nop 0
  buffer_load_dwordx4 v144, s[8:11], s17 offen lds
  s_add_u32 s17, s17, s29
  s_add_u32 m0, s28, 8192
  s_nop 0
  buffer_load_dwordx4 v144, s[8:11], s17 offen lds
  s_add_u32 s17, s17, s29
  s_add_u32 m0, s28, 9216
  s_nop 0
  buffer_load_dwordx4 v144, s[8:11], s17 offen lds
  s_add_u32 s17, s17, s29
  s_add_u32 m0, s28, 10240
  s_nop 0
  buffer_load_dwordx4 v144, s[8:11], s17 offen lds
  s_add_u32 s17, s17, s29
  s_add_u32 m0, s28, 11264
  s_nop 0
  buffer_load_dwordx4 v144, s[8:11], s17 offen lds
  s_add_u32 s17, s17, s29
  s_add_u32 m0, s28, 12288
  s_nop 0
  buffer_load_dwordx4 v144, s[8:11], s17 offen lds
  s_add_u32 s17, s17, s29
  s_add_u32 m0, s28, 13312
  s_nop 0
  buffer_load_dwordx4 v144, s[8:11], s17 offen lds
  s_add_u32 s17, s17, s29
  s_add_u32 m0, s28, 14336
  s_nop 0
  buffer_load_dwordx4 v144, s[8:11], s17 offen lds
  s_add_u32 s17, s17, s29
  s_add_u32 m0, s28, 15360
  s_nop 0
  buffer_load_dwordx4 v144, s[8:11], s17 offen lds
  s_add_u32 s17, s17, s29
  s_add_u32 m0, s28, 16384
  s_nop 0
  buffer_load_dwordx4 v144, s[8:11], s17 offen lds
  s_add_u32 s17, s17, s29
  s_add_u32 m0, s28, 17408
  s_nop 0
  buffer_load_dwordx4 v144, s[8:11], s17 offen lds
  s_add_u32 s17, s17, s29
  s_add_u32 m0, s28, 18432
  s_nop 0
  buffer_load_dwordx4 v144, s[8:11], s17 offen lds
  s_add_u32 s17, s17, s29
  s_add_u32 m0, s28, 19456
  s_nop 0
  buffer_load_dwordx4 v144, s[8:11], s17 offen lds
  s_add_u32 s17, s17, s29
  s_add_u32 m0, s28, 20480
  s_nop 0
  buffer_load_dwordx4 v144, s[8:11], s17 offen lds
  s_add_u32 s17, s17, s29
  s_add_u32 m0, s28, 21504
  s_nop 0
  buffer_load_dwordx4 v144, s[8:11], s17 offen lds
  s_add_u32 s17, s17, s29
  s_add_u32 m0, s28, 22528
  s_nop 0
  buffer_load_dwordx4 v144, s[8:11], s17 offen lds
  s_add_u32 s17, s17, s29
  s_add_u32 m0, s28, 23552
  s_nop 0
  buffer_load_dwordx4 v144, s[8:11], s17 offen lds
  s_add_u32 s17, s17, s29
  s_add_u32 m0, s28, 24576
  s_nop 0
  buffer_load_dwordx4 v144, s[8:11], s17 offen lds
  s_add_u32 s17, s17, s29
  s_add_u32 m0, s28, 25600
  s_nop 0
  buffer_load_dwordx4 v144, s[8:11], s17 offen lds
  s_add_u32 s17, s17, s29
  s_add_u32 m0, s28, 26624
  s_nop 0
  buffer_load_dwordx4 v144, s[8:11], s17 offen lds
  s_add_u32 s17, s17, s29
  s_add_u32 m0, s28, 27648
  s_nop 0
  buffer_load_dwordx4 v144, s[8:11], s17 offen lds
  s_add_u32 s17, s17, s29
  s_add_u32 m0, s28, 28672
  s_nop 0
  buffer_load_dwordx4 v144, s[8:11], s17 offen lds
  s_add_u32 s17, s17, s29
  s_add_u32 m0, s28, 29696
  s_nop 0
  buffer_load_dwordx4 v144, s[8:11], s17 offen lds
  s_add_u32 s17, s17, s29
  s_add_u32 m0, s28, 30720
  s_nop 0
  buffer_load_dwordx4 v144, s[8:11], s17 offen lds
  s_add_u32 s17, s17, s29
  s_add_u32 m0, s28, 31744
  s_nop 0
  buffer_load_dwordx4 v144, s[8:11], s17 offen lds
  s_add_u32 s17, s17, s29
  s_lshl_b32 s25, s16, 13
  s_add_u32 m0, s25, 0
  s_nop 0
  buffer_load_dwordx4 v16, s[12:15], s19 offen lds
  s_add_u32 m0, s25, 1024
  s_nop 0
  buffer_load_dwordx4 v17, s[12:15], s19 offen lds
  s_add_u32 m0, s25, 2048
  s_nop 0
  buffer_load_dwordx4 v18, s[12:15], s19 offen lds
  s_add_u32 m0, s25, 3072
  s_nop 0
  buffer_load_dwordx4 v19, s[12:15], s19 offen lds
  s_add_u32 m0, s25, 4096
  s_nop 0
  buffer_load_dwordx4 v20, s[12:15], s19 offen lds
  s_add_u32 m0, s25, 5120
  s_nop 0
  buffer_load_dwordx4 v21, s[12:15], s19 offen lds
  s_add_u32 m0, s25, 6144
  s_nop 0
  buffer_load_dwordx4 v22, s[12:15], s19 offen lds
  s_add_u32 m0, s25, 7168
  s_nop 0
  buffer_load_dwordx4 v23, s[12:15], s19 offen lds
  s_cmp_gt_u32 s23, 1
  s_cselect_b32 s26, s20, 0
  s_add_u32 s19, s19, s26
  s_add_u32 s25, s25, 32768
  s_and_b32 s25, s25, 0x1ffff
  s_cmp_lg_u32 s16, 3
  s_cbranch_scc1 M_noinit
  s_mov_b32 s79, 0
  s_atomic_swap s79, s[72:73], s31 glc
  s_waitcnt lgkmcnt(0)
  s_mov_b32 s79, 1
  s_atomic_add s79, s[74:75], 128
M_noinit:
  s_mul_i32 s76, s64, 3
  s_add_u32 s76, s76, s57
  s_mul_i32 s76, s76, 24576
  v_lshlrev_b32 v4, 7, v0
  v_add_u32 v4, s76, v4
  buffer_load_dword v5, v4, s[12:15], 0 offen
  v_bfe_u32 v148, v1, 2, 2
  v_lshrrev_b32 v149, 5, v1
  v_lshl_add_u32 v148, v149, 3, v148
  v_lshlrev_b32 v148, 7, v148
  v_bfe_u32 v149, v1, 4, 1
  v_lshl_add_u32 v148, v149, 5, v148
  v_and_b32 v149, 3, v1
  v_lshl_add_u32 v148, v149, 3, v148
  v_add_u32 v146, s28, v148
  v_add_u32 v147, 512, v146
  s_waitcnt vmcnt(37)
  ds_read_b64_tr_b16 a[0:1], v146 offset:0
  ds_read_b64_tr_b16 a[2:3], v147 offset:0
  ds_read_b64_tr_b16 a[4:5], v146 offset:64
  ds_read_b64_tr_b16 a[6:7], v147 offset:64
  ds_read_b64_tr_b16 a[8:9], v146 offset:2048
  ds_read_b64_tr_b16 a[10:11], v147 offset:2048
  ds_read_b64_tr_b16 a[12:13], v146 offset:2112
  ds_read_b64_tr_b16 a[14:15], v147 offset:2112
  s_waitcnt lgkmcnt(0)
  s_add_u32 m0, s28, 0
  s_nop 0
  buffer_load_dwordx4 v144, s[8:11], s17 offen lds
  s_add_u32 s17, s17, s29
  s_add_u32 m0, s28, 1024
  s_nop 0
  buffer_load_dwordx4 v144, s[8:11], s17 offen lds
  s_add_u32 s17, s17, s29
  s_add_u32 m0, s28, 2048
  s_nop 0
  buffer_load_dwordx4 v144, s[8:11], s17 offen lds
  s_add_u32 s17, s17, s29
  s_add_u32 m0, s28, 3072
  s_nop 0
  buffer_load_dwordx4 v144, s[8:11], s17 offen lds
  s_add_u32 s17, s17, s29
  s_waitcnt vmcnt(37)
  ds_read_b64_tr_b16 a[16:17], v146 offset:4096
  ds_read_b64_tr_b16 a[18:19], v147 offset:4096
  ds_read_b64_tr_b16 a[20:21], v146 offset:4160
  ds_read_b64_tr_b16 a[22:23], v147 offset:4160
  ds_read_b64_tr_b16 a[24:25], v146 offset:6144
  ds_read_b64_tr_b16 a[26:27], v147 offset:6144
  ds_read_b64_tr_b16 a[28:29], v146 offset:6208
  ds_read_b64_tr_b16 a[30:31], v147 offset:6208
  s_waitcnt lgkmcnt(0)
  s_add_u32 m0, s28, 4096
  s_nop 0
  buffer_load_dwordx4 v144, s[8:11], s17 offen lds
  s_add_u32 s17, s17, s29
  s_add_u32 m0, s28, 5120
  s_nop 0
  buffer_load_dwordx4 v144, s[8:11], s17 offen lds
  s_add_u32 s17, s17, s29
  s_add_u32 m0, s28, 6144
  s_nop 0
  buffer_load_dwordx4 v144, s[8:11], s17 offen lds
  s_add_u32 s17, s17, s29
  s_add_u32 m0, s28, 7168
  s_nop 0
  buffer_load_dwordx4 v144, s[8:11], s17 offen lds
  s_add_u32 s17, s17, s29
  s_waitcnt vmcnt(37)
  ds_read_b64_tr_b16 a[32:33], v146 offset:8192
  ds_read_b64_tr_b16 a[34:35], v147 offset:8192
  ds_read_b64_tr_b16 a[36:37], v146 offset:8256
  ds_read_b64_tr_b16 a[38:39], v147 offset:8256
  ds_read_b64_tr_b16 a[40:41], v146 offset:10240
  ds_read_b64_tr_b16 a[42:43], v147 offset:10240
  ds_read_b64_tr_b16 a[44:45], v146 offset:10304
  ds_read_b64_tr_b16 a[46:47], v147 offset:10304
  s_waitcnt lgkmcnt(0)
  s_add_u32 m0, s28, 8192
  s_nop 0
  buffer_load_dwordx4 v144, s[8:11], s17 offen lds
  s_add_u32 s17, s17, s29
  s_add_u32 m0, s28, 9216
  s_nop 0
  buffer_load_dwordx4 v144, s[8:11], s17 offen lds
  s_add_u32 s17, s17, s29
  s_add_u32 m0, s28, 10240
  s_nop 0
  buffer_load_dwordx4 v144, s[8:11], s17 offen lds
  s_add_u32 s17, s17, s29
  s_add_u32 m0, s28, 11264
  s_nop 0
  buffer_load_dwordx4 v144, s[8:11], s17 offen lds
  s_add_u32 s17, s17, s29
  s_waitcnt vmcnt(37)
  ds_read_b64_tr_b16 a[48:49], v146 offset:12288
  ds_read_b64_tr_b16 a[50:51], v147 offset:12288
  ds_read_b64_tr_b16 a[52:53], v146 offset:12352
  ds_read_b64_tr_b16 a[54:55], v147 offset:12352
  ds_read_b64_tr_b16 a[56:57], v146 offset:14336
  ds_read_b64_tr_b16 a[58:59], v147 offset:14336
  ds_read_b64_tr_b16 a[60:61], v146 offset:14400
  ds_read_b64_tr_b16 a[62:63], v147 offset:14400
  s_waitcnt lgkmcnt(0)
  s_add_u32 m0, s28, 12288
  s_nop 0
  buffer_load_dwordx4 v144, s[8:11], s17 offen lds
  s_add_u32 s17, s17, s29
  s_add_u32 m0, s28, 13312
  s_nop 0
  buffer_load_dwordx4 v144, s[8:11], s17 offen lds
  s_add_u32 s17, s17, s29
  s_add_u32 m0, s28, 14336
  s_nop 0
  buffer_load_dwordx4 v144, s[8:11], s17 offen lds
  s_add_u32 s17, s17, s29
  s_add_u32 m0, s28, 15360
  s_nop 0
  buffer_load_dwordx4 v144, s[8:11], s17 offen lds
  s_add_u32 s17, s17, s29
  s_waitcnt vmcnt(37)
  ds_read_b64_tr_b16 a[64:65], v146 offset:16384
  ds_read_b64_tr_b16 a[66:67], v147 offset:16384
  ds_read_b64_tr_b16 a[68:69], v146 offset:16448
  ds_read_b64_tr_b16 a[70:71], v147 offset:16448
  ds_read_b64_tr_b16 a[72:73], v146 offset:18432
  ds_read_b64_tr_b16 a[74:75], v147 offset:18432
  ds_read_b64_tr_b16 a[76:77], v146 offset:18496
  ds_read_b64_tr_b16 a[78:79], v147 offset:18496
  s_waitcnt lgkmcnt(0)
  s_add_u32 m0, s28, 16384
  s_nop 0
  buffer_load_dwordx4 v144, s[8:11], s17 offen lds
  s_add_u32 s17, s17, s29
  s_add_u32 m0, s28, 17408
  s_nop 0
  buffer_load_dwordx4 v144, s[8:11], s17 offen lds
  s_add_u32 s17, s17, s29
  s_add_u32 m0, s28, 18432
  s_nop 0
  buffer_load_dwordx4 v144, s[8:11], s17 offen lds
  s_add_u32 s17, s17, s29
  s_add_u32 m0, s28, 19456
  s_nop 0
  buffer_load_dwordx4 v144, s[8:11], s17 offen lds
  s_add_u32 s17, s17, s29
  s_waitcnt vmcnt(37)
  ds_read_b64_tr_b16 a[80:81], v146 offset:20480
  ds_read_b64_tr_b16 a[82:83], v147 offset:20480
  ds_read_b64_tr_b16 a[84:85], v146 offset:20544
  ds_read_b64_tr_b16 a[86:87], v147 offset:20544
  ds_read_b64_tr_b16 a[88:89], v146 offset:22528
  ds_read_b64_tr_b16 a[90:91], v147 offset:22528
  ds_read_b64_tr_b16 a[92:93], v146 offset:22592
  ds_read_b64_tr_b16 a[94:95], v147 offset:22592
  s_waitcnt lgkmcnt(0)
  s_add_u32 m0, s28, 20480
  s_nop 0
  buffer_load_dwordx4 v144, s[8:11], s17 offen lds
  s_add_u32 s17, s17, s29
  s_add_u32 m0, s28, 21504
  s_nop 0
  buffer_load_dwordx4 v144, s[8:11], s17 offen lds
  s_add_u32 s17, s17, s29
  s_add_u32 m0, s28, 22528
  s_nop 0
  buffer_load_dwordx4 v144, s[8:11], s17 offen lds
  s_add_u32 s17, s17, s29
  s_add_u32 m0, s28, 23552
  s_nop 0
  buffer_load_dwordx4 v144, s[8:11], s17 offen lds
  s_add_u32 s17, s17, s29
  s_waitcnt vmcnt(37)
  ds_read_b64_tr_b16 a[96:97], v146 offset:24576
  ds_read_b64_tr_b16 a[98:99], v147 offset:24576
  ds_read_b64_tr_b16 a[100:101], v146 offset:24640
  ds_read_b64_tr_b16 a[102:103], v147 offset:24640
  ds_read_b64_tr_b16 a[104:105], v146 offset:26624
  ds_read_b64_tr_b16 a[106:107], v147 offset:26624
  ds_read_b64_tr_b16 a[108:109], v146 offset:26688
  ds_read_b64_tr_b16 a[110:111], v147 offset:26688
  s_waitcnt lgkmcnt(0)
  s_add_u32 m0, s28, 24576
  s_nop 0
  buffer_load_dwordx4 v144, s[8:11], s17 offen lds
  s_add_u32 s17, s17, s29
  s_add_u32 m0, s28, 25600
  s_nop 0
  buffer_load_dwordx4 v144, s[8:11], s17 offen lds
  s_add_u32 s17, s17, s29
  s_add_u32 m0, s28, 26624
  s_nop 0
  buffer_load_dwordx4 v144, s[8:11], s17 offen lds
  s_add_u32 s17, s17, s29
  s_add_u32 m0, s28, 27648
  s_nop 0
  buffer_load_dwordx4 v144, s[8:11], s17 offen lds
  s_add_u32 s17, s17, s29
  s_waitcnt vmcnt(37)
  ds_read_b64_tr_b16 a[112:113], v146 offset:28672
  ds_read_b64_tr_b16 a[114:115], v147 offset:28672
  ds_read_b64_tr_b16 a[116:117], v146 offset:28736
  ds_read_b64_tr_b16 a[118:119], v147 offset:28736
  ds_read_b64_tr_b16 a[120:121], v146 offset:30720
  ds_read_b64_tr_b16 a[122:123], v147 offset:30720
  ds_read_b64_tr_b16 a[124:125], v146 offset:30784
  ds_read_b64_tr_b16 a[126:127], v147 offset:30784
  s_waitcnt lgkmcnt(0)
  s_add_u32 m0, s28, 28672
  s_nop 0
  buffer_load_dwordx4 v144, s[8:11], s17 offen lds
  s_add_u32 s17, s17, s29
  s_add_u32 m0, s28, 29696
  s_nop 0
  buffer_load_dwordx4 v144, s[8:11], s17 offen lds
  s_add_u32 s17, s17, s29
  s_add_u32 m0, s28, 30720
  s_nop 0
  buffer_load_dwordx4 v144, s[8:11], s17 offen lds
  s_add_u32 s17, s17, s29
  s_add_u32 m0, s28, 31744
  s_nop 0
  buffer_load_dwordx4 v144, s[8:11], s17 offen lds
  s_add_u32 s17, s17, s29
  s_waitcnt vmcnt(28)
  ds_read_b64_tr_b16 a[128:129], v146 offset:0
  ds_read_b64_tr_b16 a[130:131], v147 offset:0
  ds_read_b64_tr_b16 a[132:133], v146 offset:64
  ds_read_b64_tr_b16 a[134:135], v147 offset:64
  ds_read_b64_tr_b16 a[136:137], v146 offset:2048
  ds_read_b64_tr_b16 a[138:139], v147 offset:2048
  ds_read_b64_tr_b16 a[140:141], v146 offset:2112
  ds_read_b64_tr_b16 a[142:143], v147 offset:2112
  s_waitcnt lgkmcnt(0)
  s_waitcnt vmcnt(24)
  ds_read_b64_tr_b16 a[144:145], v146 offset:4096
  ds_read_b64_tr_b16 a[146:147], v147 offset:4096
  ds_read_b64_tr_b16 a[148:149], v146 offset:4160
  ds_read_b64_tr_b16 a[150:151], v147 offset:4160
  ds_read_b64_tr_b16 a[152:153], v146 offset:6144
  ds_read_b64_tr_b16 a[154:155], v147 offset:6144
  ds_read_b64_tr_b16 a[156:157], v146 offset:6208
  ds_read_b64_tr_b16 a[158:159], v147 offset:6208
  s_waitcnt lgkmcnt(0)
  s_waitcnt vmcnt(20)
  ds_read_b64_tr_b16 a[160:161], v146 offset:8192
  ds_read_b64_tr_b16 a[162:163], v147 offset:8192
  ds_read_b64_tr_b16 a[164:165], v146 offset:8256
  ds_read_b64_tr_b16 a[166:167], v147 offset:8256
  ds_read_b64_tr_b16 a[168:169], v146 offset:10240
  ds_read_b64_tr_b16 a[170:171], v147 offset:10240
  ds_read_b64_tr_b16 a[172:173], v146 offset:10304
  ds_read_b64_tr_b16 a[174:175], v147 offset:10304
  s_waitcnt lgkmcnt(0)
  s_waitcnt vmcnt(16)
  ds_read_b64_tr_b16 a[176:177], v146 offset:12288
  ds_read_b64_tr_b16 a[178:179], v147 offset:12288
  ds_read_b64_tr_b16 a[180:181], v146 offset:12352
  ds_read_b64_tr_b16 a[182:183], v147 offset:12352
  ds_read_b64_tr_b16 a[184:185], v146 offset:14336
  ds_read_b64_tr_b16 a[186:187], v147 offset:14336
  ds_read_b64_tr_b16 a[188:189], v146 offset:14400
  ds_read_b64_tr_b16 a[190:191], v147 offset:14400
  s_waitcnt lgkmcnt(0)
  s_waitcnt vmcnt(12)
  ds_read_b64_tr_b16 a[192:193], v146 offset:16384
  ds_read_b64_tr_b16 a[194:195], v147 offset:16384
  ds_read_b64_tr_b16 a[196:197], v146 offset:16448
  ds_read_b64_tr_b16 a[198:199], v147 offset:16448
  ds_read_b64_tr_b16 a[200:201], v146 offset:18432
  ds_read_b64_tr_b16 a[202:203], v147 offset:18432
  ds_read_b64_tr_b16 a[204:205], v146 offset:18496
  ds_read_b64_tr_b16 a[206:207], v147 offset:18496
  s_waitcnt lgkmcnt(0)
  s_waitcnt vmcnt(8)
  ds_read_b64_tr_b16 a[208:209], v146 offset:20480
  ds_read_b64_tr_b16 a[210:211], v147 offset:20480
  ds_read_b64_tr_b16 a[212:213], v146 offset:20544
  ds_read_b64_tr_b16 a[214:215], v147 offset:20544
  ds_read_b64_tr_b16 a[216:217], v146 offset:22528
  ds_read_b64_tr_b16 a[218:219], v147 offset:22528
  ds_read_b64_tr_b16 a[220:221], v146 offset:22592
  ds_read_b64_tr_b16 a[222:223], v147 offset:22592
  s_waitcnt lgkmcnt(0)
  s_waitcnt vmcnt(4)
  ds_read_b64_tr_b16 a[224:225], v146 offset:24576
  ds_read_b64_tr_b16 a[226:227], v147 offset:24576
  ds_read_b64_tr_b16 a[228:229], v146 offset:24640
  ds_read_b64_tr_b16 a[230:231], v147 offset:24640
  ds_read_b64_tr_b16 a[232:233], v146 offset:26624
  ds_read_b64_tr_b16 a[234:235], v147 offset:26624
  ds_read_b64_tr_b16 a[236:237], v146 offset:26688
  ds_read_b64_tr_b16 a[238:239], v147 offset:26688
  s_waitcnt lgkmcnt(0)
  s_waitcnt vmcnt(0)
  ds_read_b64_tr_b16 a[240:241], v146 offset:28672
  ds_read_b64_tr_b16 a[242:243], v147 offset:28672
  ds_read_b64_tr_b16 a[244:245], v146 offset:28736
  ds_read_b64_tr_b16 a[246:247], v147 offset:28736
  ds_read_b64_tr_b16 a[248:249], v146 offset:30720
  ds_read_b64_tr_b16 a[250:251], v147 offset:30720
  ds_read_b64_tr_b16 a[252:253], v146 offset:30784
  ds_read_b64_tr_b16 a[254:255], v147 offset:30784
  s_waitcnt lgkmcnt(0)
  s_barrier
  s_add_u32 m0, s25, 0
  s_nop 0
  buffer_load_dwordx4 v16, s[12:15], s19 offen lds
  s_add_u32 m0, s25, 1024
  s_nop 0
  buffer_load_dwordx4 v17, s[12:15], s19 offen lds
  s_add_u32 m0, s25, 2048
  s_nop 0
  buffer_load_dwordx4 v18, s[12:15], s19 offen lds
  s_add_u32 m0, s25, 3072
  s_nop 0
  buffer_load_dwordx4 v19, s[12:15], s19 offen lds
  s_add_u32 m0, s25, 4096
  s_nop 0
  buffer_load_dwordx4 v20, s[12:15], s19 offen lds
  s_add_u32 m0, s25, 5120
  s_nop 0
  buffer_load_dwordx4 v21, s[12:15], s19 offen lds
  s_add_u32 m0, s25, 6144
  s_nop 0
  buffer_load_dwordx4 v22, s[12:15], s19 offen lds
  s_add_u32 m0, s25, 7168
  s_nop 0
  buffer_load_dwordx4 v23, s[12:15], s19 offen lds
  s_cmp_gt_u32 s23, 2
  s_cselect_b32 s26, s20, 0
  s_add_u32 s19, s19, s26
  s_add_u32 s25, s25, 32768
  s_and_b32 s25, s25, 0x1ffff
  s_waitcnt vmcnt(0)
  s_barrier
  s_cmp_eq_u32 s48, 0
  s_cselect_b32 s26, 0, s16
  s_cmp_ge_u32 s26, 2
  s_cbranch_scc1 P_v_1
  s_mov_b32 s27, s21
  v_mov_b32 v7, 0x40000000
  s_mov_b32 s29, -3
  v_min_u32 v145, 1, v0
  v_lshlrev_b32 v145, 30, v145
  ds_read_b128 v[24:27], v8 offset:0
  ds_read_b128 v[28:31], v9 offset:0
  ds_read_b128 v[32:35], v10 offset:0
  ds_read_b128 v[36:39], v11 offset:0
  ds_read_b128 v[40:43], v12 offset:0
  ds_read_b128 v[44:47], v13 offset:0
.p2align 6
G_top_3:
  s_waitcnt lgkmcnt(5)
  v_mfma_f32_32x32x16_bf16 v[64:79], a[0:3], v[24:27], 0
  s_add_u32 m0, s25, 0
  ds_read_b128 v[48:51], v14 offset:0
  v_mfma_f32_32x32x16_bf16 v[80:95], a[4:7], v[24:27], 0
  s_waitcnt lgkmcnt(5)
  buffer_load_dwordx4 v16, s[12:15], s19 offen lds
  v_mfma_f32_32x32x16_bf16 v[64:79], a[8:11], v[28:31], v[64:79]
  ds_read_b128 v[52:55], v15 offset:0
  v_mul_f32 v96, s24, v96
  v_mul_f32 v97, s24, v97
  v_mfma_f32_32x32x16_bf16 v[80:95], a[12:15], v[28:31], v[80:95]
  s_waitcnt lgkmcnt(5)
  v_cvt_pk_bf16_f32 v128, v96, v97
  v_mul_f32 v98, s24, v98
  v_mfma_f32_32x32x16_bf16 v[64:79], a[16:19], v[32:35], v[64:79]
  s_add_u32 m0, s25, 1024
  ds_read_b128 v[24:27], v8 offset:8192
  v_mul_f32 v99, s24, v99
  v_cvt_pk_bf16_f32 v129, v98, v99
  v_mfma_f32_32x32x16_bf16 v[80:95], a[20:23], v[32:35], v[80:95]
  s_waitcnt lgkmcnt(5)
  buffer_load_dwordx4 v17, s[12:15], s19 offen lds
  v_mul_f32 v100, s24, v100
  v_mul_f32 v101, s24, v101
  v_mfma_f32_32x32x16_bf16 v[64:79], a[24:27], v[36:39], v[64:79]
  ds_read_b128 v[28:31], v9 offset:8192
  v_cvt_pk_bf16_f32 v130, v100, v101
  v_mul_f32 v102, s24, v102
  v_mfma_f32_32x32x16_bf16 v[80:95], a[28:31], v[36:39], v[80:95]
  s_waitcnt lgkmcnt(5)
  v_mul_f32 v103, s24, v103
  v_cvt_pk_bf16_f32 v131, v102, v103
  v_mfma_f32_32x32x16_bf16 v[64:79], a[32:35], v[40:43], v[64:79]
  s_add_u32 m0, s25, 2048
  ds_read_b128 v[32:35], v10 offset:8192
  v_mul_f32 v104, s24, v104
  v_mul_f32 v105, s24, v105
  v_mfma_f32_32x32x16_bf16 v[80:95], a[36:39], v[40:43], v[80:95]
  s_waitcnt lgkmcnt(5)
  buffer_load_dwordx4 v18, s[12:15], s19 offen lds
  v_cvt_pk_bf16_f32 v132, v104, v105
  v_mul_f32 v106, s24, v106
  v_mfma_f32_32x32x16_bf16 v[64:79], a[40:43], v[44:47], v[64:79]
  ds_read_b128 v[36:39], v11 offset:8192
  v_mul_f32 v107, s24, v107
  v_cvt_pk_bf16_f32 v133, v106, v107
  v_mfma_f32_32x32x16_bf16 v[80:95], a[44:47], v[44:47], v[80:95]
  s_waitcnt lgkmcnt(5)
  v_mul_f32 v108, s24, v108
  v_mul_f32 v109, s24, v109
  v_mfma_f32_32x32x16_bf16 v[64:79], a[48:51], v[48:51], v[64:79]
  s_add_u32 m0, s25, 3072
  ds_read_b128 v[40:43], v12 offset:8192
  v_cvt_pk_bf16_f32 v134, v108, v109
  v_mul_f32 v110, s24, v110
  v_mfma_f32_32x32x16_bf16 v[80:95], a[52:55], v[48:51], v[80:95]
  s_waitcnt lgkmcnt(5)
  buffer_load_dwordx4 v19, s[12:15], s19 offen lds
  v_mul_f32 v111, s24, v111
  v_cvt_pk_bf16_f32 v135, v110, v111
  v_mfma_f32_32x32x16_bf16 v[64:79], a[56:59], v[52:55], v[64:79]
  ds_read_b128 v[44:47], v13 offset:8192
  v_mul_f32 v112, s24, v112
  v_mul_f32 v113, s24, v113
  v_mfma_f32_32x32x16_bf16 v[80:95], a[60:63], v[52:55], v[80:95]
  s_waitcnt lgkmcnt(5)
  v_cvt_pk_bf16_f32 v136, v112, v113
  v_mul_f32 v114, s24, v114
  v_mfma_f32_32x32x16_bf16 v[64:79], a[64:67], v[24:27], v[64:79]
  s_add_u32 m0, s25, 4096
  ds_read_b128 v[48:51], v14 offset:8192
  v_mul_f32 v115, s24, v115
  v_cvt_pk_bf16_f32 v137, v114, v115
  v_mfma_f32_32x32x16_bf16 v[80:95], a[68:71], v[24:27], v[80:95]
  s_waitcnt lgkmcnt(5)
  buffer_load_dwordx4 v20, s[12:15], s19 offen lds
  v_mul_f32 v116, s24, v116
  v_mul_f32 v117, s24, v117
  v_mfma_f32_32x32x16_bf16 v[64:79], a[72:75], v[28:31], v[64:79]
  ds_read_b128 v[52:55], v15 offset:8192
  v_cvt_pk_bf16_f32 v138, v116, v117
  v_mul_f32 v118, s24, v118
  v_mfma_f32_32x32x16_bf16 v[80:95], a[76:79], v[28:31], v[80:95]
  s_waitcnt lgkmcnt(5)
  v_mul_f32 v119, s24, v119
  v_cvt_pk_bf16_f32 v139, v118, v119
  v_mfma_f32_32x32x16_bf16 v[64:79], a[80:83], v[32:35], v[64:79]
  s_add_u32 m0, s25, 5120
  ds_read_b128 v[24:27], v8 offset:16384
  v_mul_f32 v120, s24, v120
  v_mul_f32 v121, s24, v121
  v_mfma_f32_32x32x16_bf16 v[80:95], a[84:87], v[32:35], v[80:95]
  s_waitcnt lgkmcnt(5)
  buffer_load_dwordx4 v21, s[12:15], s19 offen lds
  v_cvt_pk_bf16_f32 v140, v120, v121
  v_mul_f32 v122, s24, v122
  v_mfma_f32_32x32x16_bf16 v[64:79], a[88:91], v[36:39], v[64:79]
  ds_read_b128 v[28:31], v9 offset:16384
  v_mul_f32 v123, s24, v123
  v_cvt_pk_bf16_f32 v141, v122, v123
  v_mfma_f32_32x32x16_bf16 v[80:95], a[92:95], v[36:39], v[80:95]
  s_waitcnt lgkmcnt(5)
  v_mul_f32 v124, s24, v124
  v_mul_f32 v125, s24, v125
  v_mfma_f32_32x32x16_bf16 v[64:79], a[96:99], v[40:43], v[64:79]
  s_add_u32 m0, s25, 6144
  ds_read_b128 v[32:35], v10 offset:16384
  v_cvt_pk_bf16_f32 v142, v124, v125
  v_mul_f32 v126, s24, v126
  v_mfma_f32_32x32x16_bf16 v[80:95], a[100:103], v[40:43], v[80:95]
  s_waitcnt lgkmcnt(5)
  buffer_load_dwordx4 v22, s[12:15], s19 offen lds
  v_mul_f32 v127, s24, v127
  v_cvt_pk_bf16_f32 v143, v126, v127
  v_mfma_f32_32x32x16_bf16 v[64:79], a[104:107], v[44:47], v[64:79]
  ds_read_b128 v[36:39], v11 offset:16384
  v_mfma_f32_32x32x16_bf16 v[80:95], a[108:111], v[44:47], v[80:95]
  s_waitcnt lgkmcnt(5)
  v_mfma_f32_32x32x16_bf16 v[64:79], a[112:115], v[48:51], v[64:79]
  s_add_u32 m0, s25, 7168
  ds_read_b128 v[40:43], v12 offset:16384
  v_mfma_f32_32x32x16_bf16 v[80:95], a[116:119], v[48:51], v[80:95]
  s_waitcnt lgkmcnt(5)
  buffer_load_dwordx4 v23, s[12:15], s19 offen lds
  v_mfma_f32_32x32x16_bf16 v[64:79], a[120:123], v[52:55], v[64:79]
  s_cmp_gt_u32 s23, 3
  ds_read_b128 v[44:47], v13 offset:16384
  v_mfma_f32_32x32x16_bf16 v[80:95], a[124:127], v[52:55], v[80:95]
  s_waitcnt lgkmcnt(5)
  s_cselect_b32 s26, s20, 0
  v_mfma_f32_32x32x16_bf16 v[64:79], a[128:131], v[24:27], v[64:79]
  s_add_u32 s19, s19, s26
  ds_read_b128 v[48:51], v14 offset:16384
  v_mfma_f32_32x32x16_bf16 v[80:95], a[132:135], v[24:27], v[80:95]
  s_waitcnt lgkmcnt(5)
  s_add_u32 s25, s25, 32768
  v_mfma_f32_32x32x16_bf16 v[64:79], a[136:139], v[28:31], v[64:79]
  s_and_b32 s25, s25, 0x1ffff
  ds_read_b128 v[52:55], v15 offset:16384
  v_mfma_f32_32x32x16_bf16 v[80:95], a[140:143], v[28:31], v[80:95]
  s_waitcnt lgkmcnt(5)
  buffer_store_dwordx4 v[128:131], v7, s[4:7], s21 offen offset:0 sc1
  v_mfma_f32_32x32x16_bf16 v[64:79], a[144:147], v[32:35], v[64:79]
  ds_read_b128 v[24:27], v8 offset:24576
  v_mfma_f32_32x32x16_bf16 v[80:95], a[148:151], v[32:35], v[80:95]
  s_waitcnt lgkmcnt(5)
  v_mfma_f32_32x32x16_bf16 v[64:79], a[152:155], v[36:39], v[64:79]
  ds_read_b128 v[28:31], v9 offset:24576
  v_mfma_f32_32x32x16_bf16 v[80:95], a[156:159], v[36:39], v[80:95]
  s_waitcnt lgkmcnt(5)
  buffer_store_dwordx4 v[132:135], v7, s[4:7], s21 offen offset:1024 sc1
  v_mfma_f32_32x32x16_bf16 v[64:79], a[160:163], v[40:43], v[64:79]
  ds_read_b128 v[32:35], v10 offset:24576
  v_mfma_f32_32x32x16_bf16 v[80:95], a[164:167], v[40:43], v[80:95]
  s_waitcnt lgkmcnt(5)
  v_mfma_f32_32x32x16_bf16 v[64:79], a[168:171], v[44:47], v[64:79]
  ds_read_b128 v[36:39], v11 offset:24576
  v_mfma_f32_32x32x16_bf16 v[80:95], a[172:175], v[44:47], v[80:95]
  s_waitcnt lgkmcnt(5)
  buffer_store_dwordx4 v[136:139], v7, s[4:7], s21 offen offset:2048 sc1
  v_mfma_f32_32x32x16_bf16 v[64:79], a[176:179], v[48:51], v[64:79]
  ds_read_b128 v[40:43], v12 offset:24576
  v_mfma_f32_32x32x16_bf16 v[80:95], a[180:183], v[48:51], v[80:95]
  s_waitcnt lgkmcnt(5)
  v_mfma_f32_32x32x16_bf16 v[64:79], a[184:187], v[52:55], v[64:79]
  ds_read_b128 v[44:47], v13 offset:24576
  v_mfma_f32_32x32x16_bf16 v[80:95], a[188:191], v[52:55], v[80:95]
  s_waitcnt lgkmcnt(5)
  buffer_store_dwordx4 v[140:143], v7, s[4:7], s21 offen offset:3072 sc1
  v_mfma_f32_32x32x16_bf16 v[64:79], a[192:195], v[24:27], v[64:79]
  s_mov_b32 s21, s27
  ds_read_b128 v[48:51], v14 offset:24576
  v_mov_b32 v7, v2
  v_mfma_f32_32x32x16_bf16 v[80:95], a[196:199], v[24:27], v[80:95]
  s_waitcnt lgkmcnt(5)
  v_mfma_f32_32x32x16_bf16 v[64:79], a[200:203], v[28:31], v[64:79]
  s_add_u32 s27, s27, s22
  ds_read_b128 v[52:55], v15 offset:24576
  v_mfma_f32_32x32x16_bf16 v[80:95], a[204:207], v[28:31], v[80:95]
  s_waitcnt lgkmcnt(5)
  s_waitcnt vmcnt(17)
  s_barrier
  v_mfma_f32_32x32x16_bf16 v[64:79], a[208:211], v[32:35], v[64:79]
  ds_read_b128 v[24:27], v8 offset:32768
  v_mfma_f32_32x32x16_bf16 v[80:95], a[212:215], v[32:35], v[80:95]
  s_waitcnt lgkmcnt(5)
  v_mfma_f32_32x32x16_bf16 v[64:79], a[216:219], v[36:39], v[64:79]
  s_add_u32 s29, s29, 1
  ds_read_b128 v[28:31], v9 offset:32768
  v_mfma_f32_32x32x16_bf16 v[80:95], a[220:223], v[36:39], v[80:95]
  s_waitcnt lgkmcnt(5)
  s_max_i32 s30, s29, 0
  v_mov_b32 v144, s30
  v_mfma_f32_32x32x16_bf16 v[64:79], a[224:227], v[40:43], v[64:79]
  ds_read_b128 v[32:35], v10 offset:32768
  v_mfma_f32_32x32x16_bf16 v[80:95], a[228:231], v[40:43], v[80:95]
  s_waitcnt lgkmcnt(5)
  buffer_store_dword v144, v145, s[4:7], s31 offen sc1
  v_mfma_f32_32x32x16_bf16 v[64:79], a[232:235], v[44:47], v[64:79]
  ds_read_b128 v[36:39], v11 offset:32768
  v_mfma_f32_32x32x16_bf16 v[80:95], a[236:239], v[44:47], v[80:95]
  s_waitcnt lgkmcnt(5)
  v_mfma_f32_32x32x16_bf16 v[64:79], a[240:243], v[48:51], v[64:79]
  s_sub_u32 s23, s23, 1
  ds_read_b128 v[40:43], v12 offset:32768
  v_mfma_f32_32x32x16_bf16 v[80:95], a[244:247], v[48:51], v[80:95]
  s_waitcnt lgkmcnt(5)
  v_mfma_f32_32x32x16_bf16 v[64:79], a[248:251], v[52:55], v[64:79]
  s_cmp_eq_u32 s23, 0
  ds_read_b128 v[44:47], v13 offset:32768
  v_mfma_f32_32x32x16_bf16 v[80:95], a[252:255], v[52:55], v[80:95]
  s_cbranch_scc1 G_done0_4
  s_waitcnt lgkmcnt(5)
  v_mfma_f32_32x32x16_bf16 v[96:111], a[0:3], v[24:27], 0
  s_add_u32 m0, s25, 0
  ds_read_b128 v[48:51], v14 offset:32768
  v_mfma_f32_32x32x16_bf16 v[112:127], a[4:7], v[24:27], 0
  s_waitcnt lgkmcnt(5)
  buffer_load_dwordx4 v16, s[12:15], s19 offen lds
  v_mfma_f32_32x32x16_bf16 v[96:111], a[8:11], v[28:31], v[96:111]
  ds_read_b128 v[52:55], v15 offset:32768
  v_mul_f32 v64, s24, v64
  v_mul_f32 v65, s24, v65
  v_mfma_f32_32x32x16_bf16 v[112:127], a[12:15], v[28:31], v[112:127]
  s_waitcnt lgkmcnt(5)
  v_cvt_pk_bf16_f32 v128, v64, v65
  v_mul_f32 v66, s24, v66
  v_mfma_f32_32x32x16_bf16 v[96:111], a[16:19], v[32:35], v[96:111]
  s_add_u32 m0, s25, 1024
  ds_read_b128 v[24:27], v8 offset:40960
  v_mul_f32 v67, s24, v67
  v_cvt_pk_bf16_f32 v129, v66, v67
  v_mfma_f32_32x32x16_bf16 v[112:127], a[20:23], v[32:35], v[112:127]
  s_waitcnt lgkmcnt(5)
  buffer_load_dwordx4 v17, s[12:15], s19 offen lds
  v_mul_f32 v68, s24, v68
  v_mul_f32 v69, s24, v69
  v_mfma_f32_32x32x16_bf16 v[96:111], a[24:27], v[36:39], v[96:111]
  ds_read_b128 v[28:31], v9 offset:40960
  v_cvt_pk_bf16_f32 v130, v68, v69
  v_mul_f32 v70, s24, v70
  v_mfma_f32_32x32x16_bf16 v[112:127], a[28:31], v[36:39], v[112:127]
  s_waitcnt lgkmcnt(5)
  v_mul_f32 v71, s24, v71
  v_cvt_pk_bf16_f32 v131, v70, v71
  v_mfma_f32_32x32x16_bf16 v[96:111], a[32:35], v[40:43], v[96:111]
  s_add_u32 m0, s25, 2048
  ds_read_b128 v[32:35], v10 offset:40960
  v_mul_f32 v72, s24, v72
  v_mul_f32 v73, s24, v73
  v_mfma_f32_32x32x16_bf16 v[112:127], a[36:39], v[40:43], v[112:127]
  s_waitcnt lgkmcnt(5)
  buffer_load_dwordx4 v18, s[12:15], s19 offen lds
  v_cvt_pk_bf16_f32 v132, v72, v73
  v_mul_f32 v74, s24, v74
  v_mfma_f32_32x32x16_bf16 v[96:111], a[40:43], v[44:47], v[96:111]
  ds_read_b128 v[36:39], v11 offset:40960
  v_mul_f32 v75, s24, v75
  v_cvt_pk_bf16_f32 v133, v74, v75
  v_mfma_f32_32x32x16_bf16 v[112:127], a[44:47], v[44:47], v[112:127]
  s_waitcnt lgkmcnt(5)
  v_mul_f32 v76, s24, v76
  v_mul_f32 v77, s24, v77
  v_mfma_f32_32x32x16_bf16 v[96:111], a[48:51], v[48:51], v[96:111]
  s_add_u32 m0, s25, 3072
  ds_read_b128 v[40:43], v12 offset:40960
  v_cvt_pk_bf16_f32 v134, v76, v77
  v_mul_f32 v78, s24, v78
  v_mfma_f32_32x32x16_bf16 v[112:127], a[52:55], v[48:51], v[112:127]
  s_waitcnt lgkmcnt(5)
  buffer_load_dwordx4 v19, s[12:15], s19 offen lds
  v_mul_f32 v79, s24, v79
  v_cvt_pk_bf16_f32 v135, v78, v79
  v_mfma_f32_32x32x16_bf16 v[96:111], a[56:59], v[52:55], v[96:111]
  ds_read_b128 v[44:47], v13 offset:40960
  v_mul_f32 v80, s24, v80
  v_mul_f32 v81, s24, v81
  v_mfma_f32_32x32x16_bf16 v[112:127], a[60:63], v[52:55], v[112:127]
  s_waitcnt lgkmcnt(5)
  v_cvt_pk_bf16_f32 v136, v80, v81
  v_mul_f32 v82, s24, v82
  v_mfma_f32_32x32x16_bf16 v[96:111], a[64:67], v[24:27], v[96:111]
  s_add_u32 m0, s25, 4096
  ds_read_b128 v[48:51], v14 offset:40960
  v_mul_f32 v83, s24, v83
  v_cvt_pk_bf16_f32 v137, v82, v83
  v_mfma_f32_32x32x16_bf16 v[112:127], a[68:71], v[24:27], v[112:127]
  s_waitcnt lgkmcnt(5)
  buffer_load_dwordx4 v20, s[12:15], s19 offen lds
  v_mul_f32 v84, s24, v84
  v_mul_f32 v85, s24, v85
  v_mfma_f32_32x32x16_bf16 v[96:111], a[72:75], v[28:31], v[96:111]
  ds_read_b128 v[52:55], v15 offset:40960
  v_cvt_pk_bf16_f32 v138, v84, v85
  v_mul_f32 v86, s24, v86
  v_mfma_f32_32x32x16_bf16 v[112:127], a[76:79], v[28:31], v[112:127]
  s_waitcnt lgkmcnt(5)
  v_mul_f32 v87, s24, v87
  v_cvt_pk_bf16_f32 v139, v86, v87
  v_mfma_f32_32x32x16_bf16 v[96:111], a[80:83], v[32:35], v[96:111]
  s_add_u32 m0, s25, 5120
  ds_read_b128 v[24:27], v8 offset:49152
  v_mul_f32 v88, s24, v88
  v_mul_f32 v89, s24, v89
  v_mfma_f32_32x32x16_bf16 v[112:127], a[84:87], v[32:35], v[112:127]
  s_waitcnt lgkmcnt(5)
  buffer_load_dwordx4 v21, s[12:15], s19 offen lds
  v_cvt_pk_bf16_f32 v140, v88, v89
  v_mul_f32 v90, s24, v90
  v_mfma_f32_32x32x16_bf16 v[96:111], a[88:91], v[36:39], v[96:111]
  ds_read_b128 v[28:31], v9 offset:49152
  v_mul_f32 v91, s24, v91
  v_cvt_pk_bf16_f32 v141, v90, v91
  v_mfma_f32_32x32x16_bf16 v[112:127], a[92:95], v[36:39], v[112:127]
  s_waitcnt lgkmcnt(5)
  v_mul_f32 v92, s24, v92
  v_mul_f32 v93, s24, v93
  v_mfma_f32_32x32x16_bf16 v[96:111], a[96:99], v[40:43], v[96:111]
  s_add_u32 m0, s25, 6144
  ds_read_b128 v[32:35], v10 offset:49152
  v_cvt_pk_bf16_f32 v142, v92, v93
  v_mul_f32 v94, s24, v94
  v_mfma_f32_32x32x16_bf16 v[112:127], a[100:103], v[40:43], v[112:127]
  s_waitcnt lgkmcnt(5)
  buffer_load_dwordx4 v22, s[12:15], s19 offen lds
  v_mul_f32 v95, s24, v95
  v_cvt_pk_bf16_f32 v143, v94, v95
  v_mfma_f32_32x32x16_bf16 v[96:111], a[104:107], v[44:47], v[96:111]
  ds_read_b128 v[36:39], v11 offset:49152
  v_mfma_f32_32x32x16_bf16 v[112:127], a[108:111], v[44:47], v[112:127]
  s_waitcnt lgkmcnt(5)
  v_mfma_f32_32x32x16_bf16 v[96:111], a[112:115], v[48:51], v[96:111]
  s_add_u32 m0, s25, 7168
  ds_read_b128 v[40:43], v12 offset:49152
  v_mfma_f32_32x32x16_bf16 v[112:127], a[116:119], v[48:51], v[112:127]
  s_waitcnt lgkmcnt(5)
  buffer_load_dwordx4 v23, s[12:15], s19 offen lds
  v_mfma_f32_32x32x16_bf16 v[96:111], a[120:123], v[52:55], v[96:111]
  s_cmp_gt_u32 s23, 3
  ds_read_b128 v[44:47], v13 offset:49152
  v_mfma_f32_32x32x16_bf16 v[112:127], a[124:127], v[52:55], v[112:127]
  s_waitcnt lgkmcnt(5)
  s_cselect_b32 s26, s20, 0
  v_mfma_f32_32x32x16_bf16 v[96:111], a[128:131], v[24:27], v[96:111]
  s_add_u32 s19, s19, s26
  ds_read_b128 v[48:51], v14 offset:49152
  v_mfma_f32_32x32x16_bf16 v[112:127], a[132:135], v[24:27], v[112:127]
  s_waitcnt lgkmcnt(5)
  s_add_u32 s25, s25, 32768
  v_mfma_f32_32x32x16_bf16 v[96:111], a[136:139], v[28:31], v[96:111]
  s_and_b32 s25, s25, 0x1ffff
  ds_read_b128 v[52:55], v15 offset:49152
  v_mfma_f32_32x32x16_bf16 v[112:127], a[140:143], v[28:31], v[112:127]
  s_waitcnt lgkmcnt(5)
  buffer_store_dwordx4 v[128:131], v7, s[4:7], s21 offen offset:0 sc1
  v_mfma_f32_32x32x16_bf16 v[96:111], a[144:147], v[32:35], v[96:111]
  ds_read_b128 v[24:27], v8 offset:57344
  v_mfma_f32_32x32x16_bf16 v[112:127], a[148:151], v[32:35], v[112:127]
  s_waitcnt lgkmcnt(5)
  v_xor_b32 v8, 0x10000, v8
  v_mfma_f32_32x32x16_bf16 v[96:111], a[152:155], v[36:39], v[96:111]
  ds_read_b128 v[28:31], v9 offset:57344
  v_mfma_f32_32x32x16_bf16 v[112:127], a[156:159], v[36:39], v[112:127]
  s_waitcnt lgkmcnt(5)
  buffer_store_dwordx4 v[132:135], v7, s[4:7], s21 offen offset:1024 sc1
  v_xor_b32 v9, 0x10000, v9
  v_mfma_f32_32x32x16_bf16 v[96:111], a[160:163], v[40:43], v[96:111]
  ds_read_b128 v[32:35], v10 offset:57344
  v_mfma_f32_32x32x16_bf16 v[112:127], a[164:167], v[40:43], v[112:127]
  s_waitcnt lgkmcnt(5)
  v_xor_b32 v10, 0x10000, v10
  v_mfma_f32_32x32x16_bf16 v[96:111], a[168:171], v[44:47], v[96:111]
  ds_read_b128 v[36:39], v11 offset:57344
  v_mfma_f32_32x32x16_bf16 v[112:127], a[172:175], v[44:47], v[112:127]
  s_waitcnt lgkmcnt(5)
  buffer_store_dwordx4 v[136:139], v7, s[4:7], s21 offen offset:2048 sc1
  v_xor_b32 v11, 0x10000, v11
  v_mfma_f32_32x32x16_bf16 v[96:111], a[176:179], v[48:51], v[96:111]
  ds_read_b128 v[40:43], v12 offset:57344
  v_mfma_f32_32x32x16_bf16 v[112:127], a[180:183], v[48:51], v[112:127]
  s_waitcnt lgkmcnt(5)
  v_xor_b32 v12, 0x10000, v12
  v_mfma_f32_32x32x16_bf16 v[96:111], a[184:187], v[52:55], v[96:111]
  ds_read_b128 v[44:47], v13 offset:57344
  v_mfma_f32_32x32x16_bf16 v[112:127], a[188:191], v[52:55], v[112:127]
  s_waitcnt lgkmcnt(5)
  buffer_store_dwordx4 v[140:143], v7, s[4:7], s21 offen offset:3072 sc1
  v_xor_b32 v13, 0x10000, v13
  v_mfma_f32_32x32x16_bf16 v[96:111], a[192:195], v[24:27], v[96:111]
  s_mov_b32 s21, s27
  ds_read_b128 v[48:51], v14 offset:57344
  v_mov_b32 v7, v2
  v_mfma_f32_32x32x16_bf16 v[112:127], a[196:199], v[24:27], v[112:127]
  s_waitcnt lgkmcnt(5)
  v_xor_b32 v14, 0x10000, v14
  v_mfma_f32_32x32x16_bf16 v[96:111], a[200:203], v[28:31], v[96:111]
  s_add_u32 s27, s27, s22
  ds_read_b128 v[52:55], v15 offset:57344
  v_mfma_f32_32x32x16_bf16 v[112:127], a[204:207], v[28:31], v[112:127]
  s_waitcnt lgkmcnt(5)
  s_waitcnt vmcnt(17)
  s_barrier
  v_xor_b32 v15, 0x10000, v15
  v_mfma_f32_32x32x16_bf16 v[96:111], a[208:211], v[32:35], v[96:111]
  ds_read_b128 v[24:27], v8 offset:0
  v_mfma_f32_32x32x16_bf16 v[112:127], a[212:215], v[32:35], v[112:127]
  s_waitcnt lgkmcnt(5)
  v_mfma_f32_32x32x16_bf16 v[96:111], a[216:219], v[36:39], v[96:111]
  s_add_u32 s29, s29, 1
  ds_read_b128 v[28:31], v9 offset:0
  v_mfma_f32_32x32x16_bf16 v[112:127], a[220:223], v[36:39], v[112:127]
  s_waitcnt lgkmcnt(5)
  s_max_i32 s30, s29, 0
  v_mov_b32 v144, s30
  v_mfma_f32_32x32x16_bf16 v[96:111], a[224:227], v[40:43], v[96:111]
  ds_read_b128 v[32:35], v10 offset:0
  v_mfma_f32_32x32x16_bf16 v[112:127], a[228:231], v[40:43], v[112:127]
  s_waitcnt lgkmcnt(5)
  buffer_store_dword v144, v145, s[4:7], s31 offen sc1
  v_mfma_f32_32x32x16_bf16 v[96:111], a[232:235], v[44:47], v[96:111]
  ds_read_b128 v[36:39], v11 offset:0
  v_mfma_f32_32x32x16_bf16 v[112:127], a[236:239], v[44:47], v[112:127]
  s_waitcnt lgkmcnt(5)
  v_mfma_f32_32x32x16_bf16 v[96:111], a[240:243], v[48:51], v[96:111]
  s_sub_u32 s23, s23, 1
  ds_read_b128 v[40:43], v12 offset:0
  v_mfma_f32_32x32x16_bf16 v[112:127], a[244:247], v[48:51], v[112:127]
  s_waitcnt lgkmcnt(5)
  v_mfma_f32_32x32x16_bf16 v[96:111], a[248:251], v[52:55], v[96:111]
  s_cmp_eq_u32 s23, 0
  ds_read_b128 v[44:47], v13 offset:0
  v_mfma_f32_32x32x16_bf16 v[112:127], a[252:255], v[52:55], v[112:127]
  s_cbranch_scc1 G_done1_5
  s_branch G_top_3
G_done0_4:
  s_nop 7
  s_nop 3
  v_mul_f32 v64, s24, v64
  v_mul_f32 v65, s24, v65
  v_cvt_pk_bf16_f32 v128, v64, v65
  v_mul_f32 v66, s24, v66
  v_mul_f32 v67, s24, v67
  v_cvt_pk_bf16_f32 v129, v66, v67
  v_mul_f32 v68, s24, v68
  v_mul_f32 v69, s24, v69
  v_cvt_pk_bf16_f32 v130, v68, v69
  v_mul_f32 v70, s24, v70
  v_mul_f32 v71, s24, v71
  v_cvt_pk_bf16_f32 v131, v70, v71
  buffer_store_dwordx4 v[128:131], v7, s[4:7], s21 offen offset:0 sc1
  v_mul_f32 v72, s24, v72
  v_mul_f32 v73, s24, v73
  v_cvt_pk_bf16_f32 v132, v72, v73
  v_mul_f32 v74, s24, v74
  v_mul_f32 v75, s24, v75
  v_cvt_pk_bf16_f32 v133, v74, v75
  v_mul_f32 v76, s24, v76
  v_mul_f32 v77, s24, v77
  v_cvt_pk_bf16_f32 v134, v76, v77
  v_mul_f32 v78, s24, v78
  v_mul_f32 v79, s24, v79
  v_cvt_pk_bf16_f32 v135, v78, v79
  buffer_store_dwordx4 v[132:135], v7, s[4:7], s21 offen offset:1024 sc1
  v_mul_f32 v80, s24, v80
  v_mul_f32 v81, s24, v81
  v_cvt_pk_bf16_f32 v136, v80, v81
  v_mul_f32 v82, s24, v82
  v_mul_f32 v83, s24, v83
  v_cvt_pk_bf16_f32 v137, v82, v83
  v_mul_f32 v84, s24, v84
  v_mul_f32 v85, s24, v85
  v_cvt_pk_bf16_f32 v138, v84, v85
  v_mul_f32 v86, s24, v86
  v_mul_f32 v87, s24, v87
  v_cvt_pk_bf16_f32 v139, v86, v87
  buffer_store_dwordx4 v[136:139], v7, s[4:7], s21 offen offset:2048 sc1
  v_mul_f32 v88, s24, v88
  v_mul_f32 v89, s24, v89
  v_cvt_pk_bf16_f32 v140, v88, v89
  v_mul_f32 v90, s24, v90
  v_mul_f32 v91, s24, v91
  v_cvt_pk_bf16_f32 v141, v90, v91
  v_mul_f32 v92, s24, v92
  v_mul_f32 v93, s24, v93
  v_cvt_pk_bf16_f32 v142, v92, v93
  v_mul_f32 v94, s24, v94
  v_mul_f32 v95, s24, v95
  v_cvt_pk_bf16_f32 v143, v94, v95
  buffer_store_dwordx4 v[140:143], v7, s[4:7], s21 offen offset:3072 sc1
  s_branch G_fin_6
G_done1_5:
  s_nop 7
  s_nop 3
  v_mul_f32 v96, s24, v96
  v_mul_f32 v97, s24, v97
  v_cvt_pk_bf16_f32 v128, v96, v97
  v_mul_f32 v98, s24, v98
  v_mul_f32 v99, s24, v99
  v_cvt_pk_bf16_f32 v129, v98, v99
  v_mul_f32 v100, s24, v100
  v_mul_f32 v101, s24, v101
  v_cvt_pk_bf16_f32 v130, v100, v101
  v_mul_f32 v102, s24, v102
  v_mul_f32 v103, s24, v103
  v_cvt_pk_bf16_f32 v131, v102, v103
  buffer_store_dwordx4 v[128:131], v7, s[4:7], s21 offen offset:0 sc1
  v_mul_f32 v104, s24, v104
  v_mul_f32 v105, s24, v105
  v_cvt_pk_bf16_f32 v132, v104, v105
  v_mul_f32 v106, s24, v106
  v_mul_f32 v107, s24, v107
  v_cvt_pk_bf16_f32 v133, v106, v107
  v_mul_f32 v108, s24, v108
  v_mul_f32 v109, s24, v109
  v_cvt_pk_bf16_f32 v134, v108, v109
  v_mul_f32 v110, s24, v110
  v_mul_f32 v111, s24, v111
  v_cvt_pk_bf16_f32 v135, v110, v111
  buffer_store_dwordx4 v[132:135], v7, s[4:7], s21 offen offset:1024 sc1
  v_mul_f32 v112, s24, v112
  v_mul_f32 v113, s24, v113
  v_cvt_pk_bf16_f32 v136, v112, v113
  v_mul_f32 v114, s24, v114
  v_mul_f32 v115, s24, v115
  v_cvt_pk_bf16_f32 v137, v114, v115
  v_mul_f32 v116, s24, v116
  v_mul_f32 v117, s24, v117
  v_cvt_pk_bf16_f32 v138, v116, v117
  v_mul_f32 v118, s24, v118
  v_mul_f32 v119, s24, v119
  v_cvt_pk_bf16_f32 v139, v118, v119
  buffer_store_dwordx4 v[136:139], v7, s[4:7], s21 offen offset:2048 sc1
  v_mul_f32 v120, s24, v120
  v_mul_f32 v121, s24, v121
  v_cvt_pk_bf16_f32 v140, v120, v121
  v_mul_f32 v122, s24, v122
  v_mul_f32 v123, s24, v123
  v_cvt_pk_bf16_f32 v141, v122, v123
  v_mul_f32 v124, s24, v124
  v_mul_f32 v125, s24, v125
  v_cvt_pk_bf16_f32 v142, v124, v125
  v_mul_f32 v126, s24, v126
  v_mul_f32 v127, s24, v127
  v_cvt_pk_bf16_f32 v143, v126, v127
  buffer_store_dwordx4 v[140:143], v7, s[4:7], s21 offen offset:3072 sc1
G_fin_6:
  s_waitcnt vmcnt(0) lgkmcnt(0)
  s_barrier
  s_add_u32 s30, s29, 3
  v_mov_b32 v144, s30
  v_min_u32 v145, 1, v0
  v_lshlrev_b32 v145, 30, v145
  buffer_store_dword v144, v145, s[4:7], s31 offen sc1
  s_branch P_end_2
P_v_1:
  s_mov_b32 s27, s21
  v_mov_b32 v7, 0x40000000
  s_mov_b32 s29, -3
  v_min_u32 v145, 1, v0
  v_lshlrev_b32 v145, 30, v145
  ds_read_b128 v[24:27], v8 offset:0
  ds_read_b128 v[28:31], v9 offset:0
  ds_read_b128 v[32:35], v10 offset:0
  ds_read_b128 v[36:39], v11 offset:0
  ds_read_b128 v[40:43], v12 offset:0
  ds_read_b128 v[44:47], v13 offset:0
.p2align 6
G_top_7:
  s_waitcnt lgkmcnt(5)
  v_mfma_f32_32x32x16_bf16 v[64:79], v[24:27], a[0:3], 0
  s_add_u32 m0, s25, 0
  ds_read_b128 v[48:51], v14 offset:0
  v_mfma_f32_32x32x16_bf16 v[80:95], v[24:27], a[4:7], 0
  s_waitcnt lgkmcnt(5)
  buffer_load_dwordx4 v16, s[12:15], s19 offen lds
  v_mfma_f32_32x32x16_bf16 v[64:79], v[28:31], a[8:11], v[64:79]
  ds_read_b128 v[52:55], v15 offset:0
  v_mul_f32 v96, s24, v96
  v_mul_f32 v97, s24, v97
  v_mfma_f32_32x32x16_bf16 v[80:95], v[28:31], a[12:15], v[80:95]
  s_waitcnt lgkmcnt(5)
  v_cvt_pk_bf16_f32 v128, v96, v97
  v_mul_f32 v98, s24, v98
  v_mfma_f32_32x32x16_bf16 v[64:79], v[32:35], a[16:19], v[64:79]
  s_add_u32 m0, s25, 1024
  ds_read_b128 v[24:27], v8 offset:8192
  v_mul_f32 v99, s24, v99
  v_cvt_pk_bf16_f32 v129, v98, v99
  v_mfma_f32_32x32x16_bf16 v[80:95], v[32:35], a[20:23], v[80:95]
  s_waitcnt lgkmcnt(5)
  buffer_load_dwordx4 v17, s[12:15], s19 offen lds
  v_mul_f32 v100, s24, v100
  v_mul_f32 v101, s24, v101
  v_mfma_f32_32x32x16_bf16 v[64:79], v[36:39], a[24:27], v[64:79]
  ds_read_b128 v[28:31], v9 offset:8192
  v_cvt_pk_bf16_f32 v130, v100, v101
  v_mul_f32 v102, s24, v102
  v_mfma_f32_32x32x16_bf16 v[80:95], v[36:39], a[28:31], v[80:95]
  s_waitcnt lgkmcnt(5)
  v_mul_f32 v103, s24, v103
  v_cvt_pk_bf16_f32 v131, v102, v103
  v_mfma_f32_32x32x16_bf16 v[64:79], v[40:43], a[32:35], v[64:79]
  s_add_u32 m0, s25, 2048
  ds_read_b128 v[32:35], v10 offset:8192
  v_mul_f32 v104, s24, v104
  v_mul_f32 v105, s24, v105
  v_mfma_f32_32x32x16_bf16 v[80:95], v[40:43], a[36:39], v[80:95]
  s_waitcnt lgkmcnt(5)
  buffer_load_dwordx4 v18, s[12:15], s19 offen lds
  v_cvt_pk_bf16_f32 v132, v104, v105
  v_mul_f32 v106, s24, v106
  v_mfma_f32_32x32x16_bf16 v[64:79], v[44:47], a[40:43], v[64:79]
  ds_read_b128 v[36:39], v11 offset:8192
  v_mul_f32 v107, s24, v107
  v_cvt_pk_bf16_f32 v133, v106, v107
  v_mfma_f32_32x32x16_bf16 v[80:95], v[44:47], a[44:47], v[80:95]
  s_waitcnt lgkmcnt(5)
  v_mul_f32 v108, s24, v108
  v_mul_f32 v109, s24, v109
  v_mfma_f32_32x32x16_bf16 v[64:79], v[48:51], a[48:51], v[64:79]
  s_add_u32 m0, s25, 3072
  ds_read_b128 v[40:43], v12 offset:8192
  v_cvt_pk_bf16_f32 v134, v108, v109
  v_mul_f32 v110, s24, v110
  v_mfma_f32_32x32x16_bf16 v[80:95], v[48:51], a[52:55], v[80:95]
  s_waitcnt lgkmcnt(5)
  buffer_load_dwordx4 v19, s[12:15], s19 offen lds
  v_mul_f32 v111, s24, v111
  v_cvt_pk_bf16_f32 v135, v110, v111
  v_mfma_f32_32x32x16_bf16 v[64:79], v[52:55], a[56:59], v[64:79]
  ds_read_b128 v[44:47], v13 offset:8192
  v_mul_f32 v112, s24, v112
  v_mul_f32 v113, s24, v113
  v_mfma_f32_32x32x16_bf16 v[80:95], v[52:55], a[60:63], v[80:95]
  s_waitcnt lgkmcnt(5)
  v_cvt_pk_bf16_f32 v136, v112, v113
  v_mul_f32 v114, s24, v114
  v_mfma_f32_32x32x16_bf16 v[64:79], v[24:27], a[64:67], v[64:79]
  s_add_u32 m0, s25, 4096
  ds_read_b128 v[48:51], v14 offset:8192
  v_mul_f32 v115, s24, v115
  v_cvt_pk_bf16_f32 v137, v114, v115
  v_mfma_f32_32x32x16_bf16 v[80:95], v[24:27], a[68:71], v[80:95]
  s_waitcnt lgkmcnt(5)
  buffer_load_dwordx4 v20, s[12:15], s19 offen lds
  v_mul_f32 v116, s24, v116
  v_mul_f32 v117, s24, v117
  v_mfma_f32_32x32x16_bf16 v[64:79], v[28:31], a[72:75], v[64:79]
  ds_read_b128 v[52:55], v15 offset:8192
  v_cvt_pk_bf16_f32 v138, v116, v117
  v_mul_f32 v118, s24, v118
  v_mfma_f32_32x32x16_bf16 v[80:95], v[28:31], a[76:79], v[80:95]
  s_waitcnt lgkmcnt(5)
  v_mul_f32 v119, s24, v119
  v_cvt_pk_bf16_f32 v139, v118, v119
  v_mfma_f32_32x32x16_bf16 v[64:79], v[32:35], a[80:83], v[64:79]
  s_add_u32 m0, s25, 5120
  ds_read_b128 v[24:27], v8 offset:16384
  v_mul_f32 v120, s24, v120
  v_mul_f32 v121, s24, v121
  v_mfma_f32_32x32x16_bf16 v[80:95], v[32:35], a[84:87], v[80:95]
  s_waitcnt lgkmcnt(5)
  buffer_load_dwordx4 v21, s[12:15], s19 offen lds
  v_cvt_pk_bf16_f32 v140, v120, v121
  v_mul_f32 v122, s24, v122
  v_mfma_f32_32x32x16_bf16 v[64:79], v[36:39], a[88:91], v[64:79]
  ds_read_b128 v[28:31], v9 offset:16384
  v_mul_f32 v123, s24, v123
  v_cvt_pk_bf16_f32 v141, v122, v123
  v_mfma_f32_32x32x16_bf16 v[80:95], v[36:39], a[92:95], v[80:95]
  s_waitcnt lgkmcnt(5)
  v_mul_f32 v124, s24, v124
  v_mul_f32 v125, s24, v125
  v_mfma_f32_32x32x16_bf16 v[64:79], v[40:43], a[96:99], v[64:79]
  s_add_u32 m0, s25, 6144
  ds_read_b128 v[32:35], v10 offset:16384
  v_cvt_pk_bf16_f32 v142, v124, v125
  v_mul_f32 v126, s24, v126
  v_mfma_f32_32x32x16_bf16 v[80:95], v[40:43], a[100:103], v[80:95]
  s_waitcnt lgkmcnt(5)
  buffer_load_dwordx4 v22, s[12:15], s19 offen lds
  v_mul_f32 v127, s24, v127
  v_cvt_pk_bf16_f32 v143, v126, v127
  v_mfma_f32_32x32x16_bf16 v[64:79], v[44:47], a[104:107], v[64:79]
  ds_read_b128 v[36:39], v11 offset:16384
  v_mfma_f32_32x32x16_bf16 v[80:95], v[44:47], a[108:111], v[80:95]
  s_waitcnt lgkmcnt(5)
  v_mfma_f32_32x32x16_bf16 v[64:79], v[48:51], a[112:115], v[64:79]
  s_add_u32 m0, s25, 7168
  ds_read_b128 v[40:43], v12 offset:16384
  v_mfma_f32_32x32x16_bf16 v[80:95], v[48:51], a[116:119], v[80:95]
  s_waitcnt lgkmcnt(5)
  buffer_load_dwordx4 v23, s[12:15], s19 offen lds
  v_mfma_f32_32x32x16_bf16 v[64:79], v[52:55], a[120:123], v[64:79]
  s_cmp_gt_u32 s23, 3
  ds_read_b128 v[44:47], v13 offset:16384
  v_mfma_f32_32x32x16_bf16 v[80:95], v[52:55], a[124:127], v[80:95]
  s_waitcnt lgkmcnt(5)
  s_cselect_b32 s26, s20, 0
  v_mfma_f32_32x32x16_bf16 v[64:79], v[24:27], a[128:131], v[64:79]
  s_add_u32 s19, s19, s26
  ds_read_b128 v[48:51], v14 offset:16384
  v_mfma_f32_32x32x16_bf16 v[80:95], v[24:27], a[132:135], v[80:95]
  s_waitcnt lgkmcnt(5)
  s_add_u32 s25, s25, 32768
  v_mfma_f32_32x32x16_bf16 v[64:79], v[28:31], a[136:139], v[64:79]
  s_and_b32 s25, s25, 0x1ffff
  ds_read_b128 v[52:55], v15 offset:16384
  v_mfma_f32_32x32x16_bf16 v[80:95], v[28:31], a[140:143], v[80:95]
  s_waitcnt lgkmcnt(5)
  buffer_store_dwordx4 v[128:131], v7, s[4:7], s21 offen offset:0 sc1
  v_mfma_f32_32x32x16_bf16 v[64:79], v[32:35], a[144:147], v[64:79]
  ds_read_b128 v[24:27], v8 offset:24576
  v_mfma_f32_32x32x16_bf16 v[80:95], v[32:35], a[148:151], v[80:95]
  s_waitcnt lgkmcnt(5)
  v_mfma_f32_32x32x16_bf16 v[64:79], v[36:39], a[152:155], v[64:79]
  ds_read_b128 v[28:31], v9 offset:24576
  v_mfma_f32_32x32x16_bf16 v[80:95], v[36:39], a[156:159], v[80:95]
  s_waitcnt lgkmcnt(5)
  buffer_store_dwordx4 v[132:135], v7, s[4:7], s21 offen offset:1024 sc1
  v_mfma_f32_32x32x16_bf16 v[64:79], v[40:43], a[160:163], v[64:79]
  ds_read_b128 v[32:35], v10 offset:24576
  v_mfma_f32_32x32x16_bf16 v[80:95], v[40:43], a[164:167], v[80:95]
  s_waitcnt lgkmcnt(5)
  v_mfma_f32_32x32x16_bf16 v[64:79], v[44:47], a[168:171], v[64:79]
  ds_read_b128 v[36:39], v11 offset:24576
  v_mfma_f32_32x32x16_bf16 v[80:95], v[44:47], a[172:175], v[80:95]
  s_waitcnt lgkmcnt(5)
  buffer_store_dwordx4 v[136:139], v7, s[4:7], s21 offen offset:2048 sc1
  v_mfma_f32_32x32x16_bf16 v[64:79], v[48:51], a[176:179], v[64:79]
  ds_read_b128 v[40:43], v12 offset:24576
  v_mfma_f32_32x32x16_bf16 v[80:95], v[48:51], a[180:183], v[80:95]
  s_waitcnt lgkmcnt(5)
  v_mfma_f32_32x32x16_bf16 v[64:79], v[52:55], a[184:187], v[64:79]
  ds_read_b128 v[44:47], v13 offset:24576
  v_mfma_f32_32x32x16_bf16 v[80:95], v[52:55], a[188:191], v[80:95]
  s_waitcnt lgkmcnt(5)
  buffer_store_dwordx4 v[140:143], v7, s[4:7], s21 offen offset:3072 sc1
  v_mfma_f32_32x32x16_bf16 v[64:79], v[24:27], a[192:195], v[64:79]
  s_mov_b32 s21, s27
  ds_read_b128 v[48:51], v14 offset:24576
  v_mov_b32 v7, v2
  v_mfma_f32_32x32x16_bf16 v[80:95], v[24:27], a[196:199], v[80:95]
  s_waitcnt lgkmcnt(5)
  v_mfma_f32_32x32x16_bf16 v[64:79], v[28:31], a[200:203], v[64:79]
  s_add_u32 s27, s27, s22
  ds_read_b128 v[52:55], v15 offset:24576
  v_mfma_f32_32x32x16_bf16 v[80:95], v[28:31], a[204:207], v[80:95]
  s_waitcnt lgkmcnt(5)
  s_waitcnt vmcnt(17)
  s_barrier
  v_mfma_f32_32x32x16_bf16 v[64:79], v[32:35], a[208:211], v[64:79]
  ds_read_b128 v[24:27], v8 offset:32768
  v_mfma_f32_32x32x16_bf16 v[80:95], v[32:35], a[212:215], v[80:95]
  s_waitcnt lgkmcnt(5)
  v_mfma_f32_32x32x16_bf16 v[64:79], v[36:39], a[216:219], v[64:79]
  s_add_u32 s29, s29, 1
  ds_read_b128 v[28:31], v9 offset:32768
  v_mfma_f32_32x32x16_bf16 v[80:95], v[36:39], a[220:223], v[80:95]
  s_waitcnt lgkmcnt(5)
  s_max_i32 s30, s29, 0
  v_mov_b32 v144, s30
  v_mfma_f32_32x32x16_bf16 v[64:79], v[40:43], a[224:227], v[64:79]
  ds_read_b128 v[32:35], v10 offset:32768
  v_mfma_f32_32x32x16_bf16 v[80:95], v[40:43], a[228:231], v[80:95]
  s_waitcnt lgkmcnt(5)
  buffer_store_dword v144, v145, s[4:7], s31 offen sc1
  v_mfma_f32_32x32x16_bf16 v[64:79], v[44:47], a[232:235], v[64:79]
  ds_read_b128 v[36:39], v11 offset:32768
  v_mfma_f32_32x32x16_bf16 v[80:95], v[44:47], a[236:239], v[80:95]
  s_waitcnt lgkmcnt(5)
  v_mfma_f32_32x32x16_bf16 v[64:79], v[48:51], a[240:243], v[64:79]
  s_sub_u32 s23, s23, 1
  ds_read_b128 v[40:43], v12 offset:32768
  v_mfma_f32_32x32x16_bf16 v[80:95], v[48:51], a[244:247], v[80:95]
  s_waitcnt lgkmcnt(5)
  v_mfma_f32_32x32x16_bf16 v[64:79], v[52:55], a[248:251], v[64:79]
  s_cmp_eq_u32 s23, 0
  ds_read_b128 v[44:47], v13 offset:32768
  v_mfma_f32_32x32x16_bf16 v[80:95], v[52:55], a[252:255], v[80:95]
  s_cbranch_scc1 G_done0_8
  s_waitcnt lgkmcnt(5)
  v_mfma_f32_32x32x16_bf16 v[96:111], v[24:27], a[0:3], 0
  s_add_u32 m0, s25, 0
  ds_read_b128 v[48:51], v14 offset:32768
  v_mfma_f32_32x32x16_bf16 v[112:127], v[24:27], a[4:7], 0
  s_waitcnt lgkmcnt(5)
  buffer_load_dwordx4 v16, s[12:15], s19 offen lds
  v_mfma_f32_32x32x16_bf16 v[96:111], v[28:31], a[8:11], v[96:111]
  ds_read_b128 v[52:55], v15 offset:32768
  v_mul_f32 v64, s24, v64
  v_mul_f32 v65, s24, v65
  v_mfma_f32_32x32x16_bf16 v[112:127], v[28:31], a[12:15], v[112:127]
  s_waitcnt lgkmcnt(5)
  v_cvt_pk_bf16_f32 v128, v64, v65
  v_mul_f32 v66, s24, v66
  v_mfma_f32_32x32x16_bf16 v[96:111], v[32:35], a[16:19], v[96:111]
  s_add_u32 m0, s25, 1024
  ds_read_b128 v[24:27], v8 offset:40960
  v_mul_f32 v67, s24, v67
  v_cvt_pk_bf16_f32 v129, v66, v67
  v_mfma_f32_32x32x16_bf16 v[112:127], v[32:35], a[20:23], v[112:127]
  s_waitcnt lgkmcnt(5)
  buffer_load_dwordx4 v17, s[12:15], s19 offen lds
  v_mul_f32 v68, s24, v68
  v_mul_f32 v69, s24, v69
  v_mfma_f32_32x32x16_bf16 v[96:111], v[36:39], a[24:27], v[96:111]
  ds_read_b128 v[28:31], v9 offset:40960
  v_cvt_pk_bf16_f32 v130, v68, v69
  v_mul_f32 v70, s24, v70
  v_mfma_f32_32x32x16_bf16 v[112:127], v[36:39], a[28:31], v[112:127]
  s_waitcnt lgkmcnt(5)
  v_mul_f32 v71, s24, v71
  v_cvt_pk_bf16_f32 v131, v70, v71
  v_mfma_f32_32x32x16_bf16 v[96:111], v[40:43], a[32:35], v[96:111]
  s_add_u32 m0, s25, 2048
  ds_read_b128 v[32:35], v10 offset:40960
  v_mul_f32 v72, s24, v72
  v_mul_f32 v73, s24, v73
  v_mfma_f32_32x32x16_bf16 v[112:127], v[40:43], a[36:39], v[112:127]
  s_waitcnt lgkmcnt(5)
  buffer_load_dwordx4 v18, s[12:15], s19 offen lds
  v_cvt_pk_bf16_f32 v132, v72, v73
  v_mul_f32 v74, s24, v74
  v_mfma_f32_32x32x16_bf16 v[96:111], v[44:47], a[40:43], v[96:111]
  ds_read_b128 v[36:39], v11 offset:40960
  v_mul_f32 v75, s24, v75
  v_cvt_pk_bf16_f32 v133, v74, v75
  v_mfma_f32_32x32x16_bf16 v[112:127], v[44:47], a[44:47], v[112:127]
  s_waitcnt lgkmcnt(5)
  v_mul_f32 v76, s24, v76
  v_mul_f32 v77, s24, v77
  v_mfma_f32_32x32x16_bf16 v[96:111], v[48:51], a[48:51], v[96:111]
  s_add_u32 m0, s25, 3072
  ds_read_b128 v[40:43], v12 offset:40960
  v_cvt_pk_bf16_f32 v134, v76, v77
  v_mul_f32 v78, s24, v78
  v_mfma_f32_32x32x16_bf16 v[112:127], v[48:51], a[52:55], v[112:127]
  s_waitcnt lgkmcnt(5)
  buffer_load_dwordx4 v19, s[12:15], s19 offen lds
  v_mul_f32 v79, s24, v79
  v_cvt_pk_bf16_f32 v135, v78, v79
  v_mfma_f32_32x32x16_bf16 v[96:111], v[52:55], a[56:59], v[96:111]
  ds_read_b128 v[44:47], v13 offset:40960
  v_mul_f32 v80, s24, v80
  v_mul_f32 v81, s24, v81
  v_mfma_f32_32x32x16_bf16 v[112:127], v[52:55], a[60:63], v[112:127]
  s_waitcnt lgkmcnt(5)
  v_cvt_pk_bf16_f32 v136, v80, v81
  v_mul_f32 v82, s24, v82
  v_mfma_f32_32x32x16_bf16 v[96:111], v[24:27], a[64:67], v[96:111]
  s_add_u32 m0, s25, 4096
  ds_read_b128 v[48:51], v14 offset:40960
  v_mul_f32 v83, s24, v83
  v_cvt_pk_bf16_f32 v137, v82, v83
  v_mfma_f32_32x32x16_bf16 v[112:127], v[24:27], a[68:71], v[112:127]
  s_waitcnt lgkmcnt(5)
  buffer_load_dwordx4 v20, s[12:15], s19 offen lds
  v_mul_f32 v84, s24, v84
  v_mul_f32 v85, s24, v85
  v_mfma_f32_32x32x16_bf16 v[96:111], v[28:31], a[72:75], v[96:111]
  ds_read_b128 v[52:55], v15 offset:40960
  v_cvt_pk_bf16_f32 v138, v84, v85
  v_mul_f32 v86, s24, v86
  v_mfma_f32_32x32x16_bf16 v[112:127], v[28:31], a[76:79], v[112:127]
  s_waitcnt lgkmcnt(5)
  v_mul_f32 v87, s24, v87
  v_cvt_pk_bf16_f32 v139, v86, v87
  v_mfma_f32_32x32x16_bf16 v[96:111], v[32:35], a[80:83], v[96:111]
  s_add_u32 m0, s25, 5120
  ds_read_b128 v[24:27], v8 offset:49152
  v_mul_f32 v88, s24, v88
  v_mul_f32 v89, s24, v89
  v_mfma_f32_32x32x16_bf16 v[112:127], v[32:35], a[84:87], v[112:127]
  s_waitcnt lgkmcnt(5)
  buffer_load_dwordx4 v21, s[12:15], s19 offen lds
  v_cvt_pk_bf16_f32 v140, v88, v89
  v_mul_f32 v90, s24, v90
  v_mfma_f32_32x32x16_bf16 v[96:111], v[36:39], a[88:91], v[96:111]
  ds_read_b128 v[28:31], v9 offset:49152
  v_mul_f32 v91, s24, v91
  v_cvt_pk_bf16_f32 v141, v90, v91
  v_mfma_f32_32x32x16_bf16 v[112:127], v[36:39], a[92:95], v[112:127]
  s_waitcnt lgkmcnt(5)
  v_mul_f32 v92, s24, v92
  v_mul_f32 v93, s24, v93
  v_mfma_f32_32x32x16_bf16 v[96:111], v[40:43], a[96:99], v[96:111]
  s_add_u32 m0, s25, 6144
  ds_read_b128 v[32:35], v10 offset:49152
  v_cvt_pk_bf16_f32 v142, v92, v93
  v_mul_f32 v94, s24, v94
  v_mfma_f32_32x32x16_bf16 v[112:127], v[40:43], a[100:103], v[112:127]
  s_waitcnt lgkmcnt(5)
  buffer_load_dwordx4 v22, s[12:15], s19 offen lds
  v_mul_f32 v95, s24, v95
  v_cvt_pk_bf16_f32 v143, v94, v95
  v_mfma_f32_32x32x16_bf16 v[96:111], v[44:47], a[104:107], v[96:111]
  ds_read_b128 v[36:39], v11 offset:49152
  v_mfma_f32_32x32x16_bf16 v[112:127], v[44:47], a[108:111], v[112:127]
  s_waitcnt lgkmcnt(5)
  v_mfma_f32_32x32x16_bf16 v[96:111], v[48:51], a[112:115], v[96:111]
  s_add_u32 m0, s25, 7168
  ds_read_b128 v[40:43], v12 offset:49152
  v_mfma_f32_32x32x16_bf16 v[112:127], v[48:51], a[116:119], v[112:127]
  s_waitcnt lgkmcnt(5)
  buffer_load_dwordx4 v23, s[12:15], s19 offen lds
  v_mfma_f32_32x32x16_bf16 v[96:111], v[52:55], a[120:123], v[96:111]
  s_cmp_gt_u32 s23, 3
  ds_read_b128 v[44:47], v13 offset:49152
  v_mfma_f32_32x32x16_bf16 v[112:127], v[52:55], a[124:127], v[112:127]
  s_waitcnt lgkmcnt(5)
  s_cselect_b32 s26, s20, 0
  v_mfma_f32_32x32x16_bf16 v[96:111], v[24:27], a[128:131], v[96:111]
  s_add_u32 s19, s19, s26
  ds_read_b128 v[48:51], v14 offset:49152
  v_mfma_f32_32x32x16_bf16 v[112:127], v[24:27], a[132:135], v[112:127]
  s_waitcnt lgkmcnt(5)
  s_add_u32 s25, s25, 32768
  v_mfma_f32_32x32x16_bf16 v[96:111], v[28:31], a[136:139], v[96:111]
  s_and_b32 s25, s25, 0x1ffff
  ds_read_b128 v[52:55], v15 offset:49152
  v_mfma_f32_32x32x16_bf16 v[112:127], v[28:31], a[140:143], v[112:127]
  s_waitcnt lgkmcnt(5)
  buffer_store_dwordx4 v[128:131], v7, s[4:7], s21 offen offset:0 sc1
  v_mfma_f32_32x32x16_bf16 v[96:111], v[32:35], a[144:147], v[96:111]
  ds_read_b128 v[24:27], v8 offset:57344
  v_mfma_f32_32x32x16_bf16 v[112:127], v[32:35], a[148:151], v[112:127]
  s_waitcnt lgkmcnt(5)
  v_xor_b32 v8, 0x10000, v8
  v_mfma_f32_32x32x16_bf16 v[96:111], v[36:39], a[152:155], v[96:111]
  ds_read_b128 v[28:31], v9 offset:57344
  v_mfma_f32_32x32x16_bf16 v[112:127], v[36:39], a[156:159], v[112:127]
  s_waitcnt lgkmcnt(5)
  buffer_store_dwordx4 v[132:135], v7, s[4:7], s21 offen offset:1024 sc1
  v_xor_b32 v9, 0x10000, v9
  v_mfma_f32_32x32x16_bf16 v[96:111], v[40:43], a[160:163], v[96:111]
  ds_read_b128 v[32:35], v10 offset:57344
  v_mfma_f32_32x32x16_bf16 v[112:127], v[40:43], a[164:167], v[112:127]
  s_waitcnt lgkmcnt(5)
  v_xor_b32 v10, 0x10000, v10
  v_mfma_f32_32x32x16_bf16 v[96:111], v[44:47], a[168:171], v[96:111]
  ds_read_b128 v[36:39], v11 offset:57344
  v_mfma_f32_32x32x16_bf16 v[112:127], v[44:47], a[172:175], v[112:127]
  s_waitcnt lgkmcnt(5)
  buffer_store_dwordx4 v[136:139], v7, s[4:7], s21 offen offset:2048 sc1
  v_xor_b32 v11, 0x10000, v11
  v_mfma_f32_32x32x16_bf16 v[96:111], v[48:51], a[176:179], v[96:111]
  ds_read_b128 v[40:43], v12 offset:57344
  v_mfma_f32_32x32x16_bf16 v[112:127], v[48:51], a[180:183], v[112:127]
  s_waitcnt lgkmcnt(5)
  v_xor_b32 v12, 0x10000, v12
  v_mfma_f32_32x32x16_bf16 v[96:111], v[52:55], a[184:187], v[96:111]
  ds_read_b128 v[44:47], v13 offset:57344
  v_mfma_f32_32x32x16_bf16 v[112:127], v[52:55], a[188:191], v[112:127]
  s_waitcnt lgkmcnt(5)
  buffer_store_dwordx4 v[140:143], v7, s[4:7], s21 offen offset:3072 sc1
  v_xor_b32 v13, 0x10000, v13
  v_mfma_f32_32x32x16_bf16 v[96:111], v[24:27], a[192:195], v[96:111]
  s_mov_b32 s21, s27
  ds_read_b128 v[48:51], v14 offset:57344
  v_mov_b32 v7, v2
  v_mfma_f32_32x32x16_bf16 v[112:127], v[24:27], a[196:199], v[112:127]
  s_waitcnt lgkmcnt(5)
  v_xor_b32 v14, 0x10000, v14
  v_mfma_f32_32x32x16_bf16 v[96:111], v[28:31], a[200:203], v[96:111]
  s_add_u32 s27, s27, s22
  ds_read_b128 v[52:55], v15 offset:57344
  v_mfma_f32_32x32x16_bf16 v[112:127], v[28:31], a[204:207], v[112:127]
  s_waitcnt lgkmcnt(5)
  s_waitcnt vmcnt(17)
  s_barrier
  v_xor_b32 v15, 0x10000, v15
  v_mfma_f32_32x32x16_bf16 v[96:111], v[32:35], a[208:211], v[96:111]
  ds_read_b128 v[24:27], v8 offset:0
  v_mfma_f32_32x32x16_bf16 v[112:127], v[32:35], a[212:215], v[112:127]
  s_waitcnt lgkmcnt(5)
  v_mfma_f32_32x32x16_bf16 v[96:111], v[36:39], a[216:219], v[96:111]
  s_add_u32 s29, s29, 1
  ds_read_b128 v[28:31], v9 offset:0
  v_mfma_f32_32x32x16_bf16 v[112:127], v[36:39], a[220:223], v[112:127]
  s_waitcnt lgkmcnt(5)
  s_max_i32 s30, s29, 0
  v_mov_b32 v144, s30
  v_mfma_f32_32x32x16_bf16 v[96:111], v[40:43], a[224:227], v[96:111]
  ds_read_b128 v[32:35], v10 offset:0
  v_mfma_f32_32x32x16_bf16 v[112:127], v[40:43], a[228:231], v[112:127]
  s_waitcnt lgkmcnt(5)
  buffer_store_dword v144, v145, s[4:7], s31 offen sc1
  v_mfma_f32_32x32x16_bf16 v[96:111], v[44:47], a[232:235], v[96:111]
  ds_read_b128 v[36:39], v11 offset:0
  v_mfma_f32_32x32x16_bf16 v[112:127], v[44:47], a[236:239], v[112:127]
  s_waitcnt lgkmcnt(5)
  v_mfma_f32_32x32x16_bf16 v[96:111], v[48:51], a[240:243], v[96:111]
  s_sub_u32 s23, s23, 1
  ds_read_b128 v[40:43], v12 offset:0
  v_mfma_f32_32x32x16_bf16 v[112:127], v[48:51], a[244:247], v[112:127]
  s_waitcnt lgkmcnt(5)
  v_mfma_f32_32x32x16_bf16 v[96:111], v[52:55], a[248:251], v[96:111]
  s_cmp_eq_u32 s23, 0
  ds_read_b128 v[44:47], v13 offset:0
  v_mfma_f32_32x32x16_bf16 v[112:127], v[52:55], a[252:255], v[112:127]
  s_cbranch_scc1 G_done1_9
  s_branch G_top_7
G_done0_8:
  s_nop 7
  s_nop 3
  v_mul_f32 v64, s24, v64
  v_mul_f32 v65, s24, v65
  v_cvt_pk_bf16_f32 v128, v64, v65
  v_mul_f32 v66, s24, v66
  v_mul_f32 v67, s24, v67
  v_cvt_pk_bf16_f32 v129, v66, v67
  v_mul_f32 v68, s24, v68
  v_mul_f32 v69, s24, v69
  v_cvt_pk_bf16_f32 v130, v68, v69
  v_mul_f32 v70, s24, v70
  v_mul_f32 v71, s24, v71
  v_cvt_pk_bf16_f32 v131, v70, v71
  buffer_store_dwordx4 v[128:131], v7, s[4:7], s21 offen offset:0 sc1
  v_mul_f32 v72, s24, v72
  v_mul_f32 v73, s24, v73
  v_cvt_pk_bf16_f32 v132, v72, v73
  v_mul_f32 v74, s24, v74
  v_mul_f32 v75, s24, v75
  v_cvt_pk_bf16_f32 v133, v74, v75
  v_mul_f32 v76, s24, v76
  v_mul_f32 v77, s24, v77
  v_cvt_pk_bf16_f32 v134, v76, v77
  v_mul_f32 v78, s24, v78
  v_mul_f32 v79, s24, v79
  v_cvt_pk_bf16_f32 v135, v78, v79
  buffer_store_dwordx4 v[132:135], v7, s[4:7], s21 offen offset:1024 sc1
  v_mul_f32 v80, s24, v80
  v_mul_f32 v81, s24, v81
  v_cvt_pk_bf16_f32 v136, v80, v81
  v_mul_f32 v82, s24, v82
  v_mul_f32 v83, s24, v83
  v_cvt_pk_bf16_f32 v137, v82, v83
  v_mul_f32 v84, s24, v84
  v_mul_f32 v85, s24, v85
  v_cvt_pk_bf16_f32 v138, v84, v85
  v_mul_f32 v86, s24, v86
  v_mul_f32 v87, s24, v87
  v_cvt_pk_bf16_f32 v139, v86, v87
  buffer_store_dwordx4 v[136:139], v7, s[4:7], s21 offen offset:2048 sc1
  v_mul_f32 v88, s24, v88
  v_mul_f32 v89, s24, v89
  v_cvt_pk_bf16_f32 v140, v88, v89
  v_mul_f32 v90, s24, v90
  v_mul_f32 v91, s24, v91
  v_cvt_pk_bf16_f32 v141, v90, v91
  v_mul_f32 v92, s24, v92
  v_mul_f32 v93, s24, v93
  v_cvt_pk_bf16_f32 v142, v92, v93
  v_mul_f32 v94, s24, v94
  v_mul_f32 v95, s24, v95
  v_cvt_pk_bf16_f32 v143, v94, v95
  buffer_store_dwordx4 v[140:143], v7, s[4:7], s21 offen offset:3072 sc1
  s_branch G_fin_10
G_done1_9:
  s_nop 7
  s_nop 3
  v_mul_f32 v96, s24, v96
  v_mul_f32 v97, s24, v97
  v_cvt_pk_bf16_f32 v128, v96, v97
  v_mul_f32 v98, s24, v98
  v_mul_f32 v99, s24, v99
  v_cvt_pk_bf16_f32 v129, v98, v99
  v_mul_f32 v100, s24, v100
  v_mul_f32 v101, s24, v101
  v_cvt_pk_bf16_f32 v130, v100, v101
  v_mul_f32 v102, s24, v102
  v_mul_f32 v103, s24, v103
  v_cvt_pk_bf16_f32 v131, v102, v103
  buffer_store_dwordx4 v[128:131], v7, s[4:7], s21 offen offset:0 sc1
  v_mul_f32 v104, s24, v104
  v_mul_f32 v105, s24, v105
  v_cvt_pk_bf16_f32 v132, v104, v105
  v_mul_f32 v106, s24, v106
  v_mul_f32 v107, s24, v107
  v_cvt_pk_bf16_f32 v133, v106, v107
  v_mul_f32 v108, s24, v108
  v_mul_f32 v109, s24, v109
  v_cvt_pk_bf16_f32 v134, v108, v109
  v_mul_f32 v110, s24, v110
  v_mul_f32 v111, s24, v111
  v_cvt_pk_bf16_f32 v135, v110, v111
  buffer_store_dwordx4 v[132:135], v7, s[4:7], s21 offen offset:1024 sc1
  v_mul_f32 v112, s24, v112
  v_mul_f32 v113, s24, v113
  v_cvt_pk_bf16_f32 v136, v112, v113
  v_mul_f32 v114, s24, v114
  v_mul_f32 v115, s24, v115
  v_cvt_pk_bf16_f32 v137, v114, v115
  v_mul_f32 v116, s24, v116
  v_mul_f32 v117, s24, v117
  v_cvt_pk_bf16_f32 v138, v116, v117
  v_mul_f32 v118, s24, v118
  v_mul_f32 v119, s24, v119
  v_cvt_pk_bf16_f32 v139, v118, v119
  buffer_store_dwordx4 v[136:139], v7, s[4:7], s21 offen offset:2048 sc1
  v_mul_f32 v120, s24, v120
  v_mul_f32 v121, s24, v121
  v_cvt_pk_bf16_f32 v140, v120, v121
  v_mul_f32 v122, s24, v122
  v_mul_f32 v123, s24, v123
  v_cvt_pk_bf16_f32 v141, v122, v123
  v_mul_f32 v124, s24, v124
  v_mul_f32 v125, s24, v125
  v_cvt_pk_bf16_f32 v142, v124, v125
  v_mul_f32 v126, s24, v126
  v_mul_f32 v127, s24, v127
  v_cvt_pk_bf16_f32 v143, v126, v127
  buffer_store_dwordx4 v[140:143], v7, s[4:7], s21 offen offset:3072 sc1
G_fin_10:
  s_waitcnt vmcnt(0) lgkmcnt(0)
  s_barrier
  s_add_u32 s30, s29, 3
  v_mov_b32 v144, s30
  v_min_u32 v145, 1, v0
  v_lshlrev_b32 v145, 30, v145
  buffer_store_dword v144, v145, s[4:7], s31 offen sc1
P_end_2:
  s_mov_b32 s71, 0
  s_branch M_sg_12
M_sw_11:
  s_sleep 8
  s_add_u32 s71, s71, 1
  s_cmp_gt_u32 s71, 262144
  s_cbranch_scc1 M_exit
M_sg_12:
  s_mov_b32 s79, 0
  s_atomic_or s79, s[74:75], 128 glc
  s_waitcnt lgkmcnt(0)
  s_cmp_lt_u32 s79, 256
  s_cbranch_scc1 M_sw_11
  s_cmp_eq_u32 s65, 6
  s_cbranch_scc1 M_follow
  s_mov_b32 s68, 0
  s_mov_b32 s36, -1
  s_mov_b32 s69, s53
  s_mov_b32 s70, s54
M_att:
  s_mov_b32 s24, 0xf149f2ca
  s_mov_b32 s29, 0
  v_mov_b32 v6, 0
  v_mov_b32 v7, 0
  s_lshl_b32 s26, s16, 11
  v_add_u32 v3, s26, v2
  v_and_b32 v5, 31, v1
  v_lshrrev_b32 v12, 5, v1
  v_lshlrev_b32 v12, 2, v12
  v_sub_u32 v5, v5, v12
  s_lshl_b32 s26, s64, 19
  s_add_u32 s19, s26, 16777216
  s_add_u32 s20, s26, 33554432
  s_lshl_b32 s27, s69, 2
  s_add_u32 s27, s27, s16
  s_lshl_b32 s27, s27, 14
  s_add_u32 s25, s26, s27
  s_bfe_u32 s78, s70, 0x80000
  s_add_u32 s76, s67, 512
  s_mov_b32 s71, 0
  s_branch M_sg_14
M_sw_13:
  s_sleep 8
  s_add_u32 s71, s71, 1
  s_cmp_gt_u32 s71, 262144
  s_cbranch_scc1 M_exit
M_sg_14:
  s_mov_b32 s79, 0
  s_atomic_or s79, s[72:73], s76 glc
  s_waitcnt lgkmcnt(0)
  s_cmp_lt_u32 s79, s78
  s_cbranch_scc1 M_sw_13
  s_bfe_u32 s78, s70, 0x80008
  s_add_u32 s76, s67, 640
  s_mov_b32 s71, 0
  s_branch M_sg_16
M_sw_15:
  s_sleep 8
  s_add_u32 s71, s71, 1
  s_cmp_gt_u32 s71, 262144
  s_cbranch_scc1 M_exit
M_sg_16:
  s_mov_b32 s79, 0
  s_atomic_or s79, s[72:73], s76 glc
  s_waitcnt lgkmcnt(0)
  s_cmp_lt_u32 s79, s78
  s_cbranch_scc1 M_sw_15
  s_lshl_b32 s27, s69, 16
  s_add_u32 s27, s27, 16384
  s_add_u32 s17, s19, s27
M_kv_17:
  s_cmp_ge_u32 s17, s36
  s_cbranch_scc1 M_kvok_18
  s_mov_b32 s76, 0
  s_mov_b32 s78, 23
  s_mov_b32 s77, 335872
  s_cmp_eq_u32 s68, 1
  s_cmov_b32 s76, 128
  s_cmov_b32 s78, 27
  s_cmov_b32 s77, 114688
  s_cmp_eq_u32 s68, 2
  s_cmov_b32 s76, 768
  s_cmov_b32 s78, 14
  s_cmov_b32 s77, 0
  s_add_u32 s76, s76, s67
  s_mov_b32 s71, 0
  s_branch M_sg_20
M_sw_19:
  s_sleep 8
  s_add_u32 s71, s71, 1
  s_cmp_gt_u32 s71, 262144
  s_cbranch_scc1 M_exit
M_sg_20:
  s_mov_b32 s79, 0
  s_atomic_or s79, s[72:73], s76 glc
  s_waitcnt lgkmcnt(0)
  s_cmp_lt_u32 s79, s78
  s_cbranch_scc1 M_sw_19
  s_add_u32 s36, s77, s19
  s_add_u32 s68, s68, 1
  s_branch M_kv_17
M_kvok_18:
  s_add_u32 s28, s25, 0
  buffer_load_dwordx4 a[128:131], v2, s[4:7], s28 offen offset:0 sc1
  buffer_load_dwordx4 a[132:135], v2, s[4:7], s28 offen offset:1024 sc1
  buffer_load_dwordx4 a[136:139], v2, s[4:7], s28 offen offset:2048 sc1
  buffer_load_dwordx4 a[140:143], v2, s[4:7], s28 offen offset:3072 sc1
  s_add_u32 s28, s25, 4096
  buffer_load_dwordx4 a[144:147], v2, s[4:7], s28 offen offset:0 sc1
  buffer_load_dwordx4 a[148:151], v2, s[4:7], s28 offen offset:1024 sc1
  buffer_load_dwordx4 a[152:155], v2, s[4:7], s28 offen offset:2048 sc1
  buffer_load_dwordx4 a[156:159], v2, s[4:7], s28 offen offset:3072 sc1
  s_add_u32 s28, s25, 8192
  buffer_load_dwordx4 a[160:163], v2, s[4:7], s28 offen offset:0 sc1
  buffer_load_dwordx4 a[164:167], v2, s[4:7], s28 offen offset:1024 sc1
  buffer_load_dwordx4 a[168:171], v2, s[4:7], s28 offen offset:2048 sc1
  buffer_load_dwordx4 a[172:175], v2, s[4:7], s28 offen offset:3072 sc1
  s_add_u32 s28, s25, 12288
  buffer_load_dwordx4 a[176:179], v2, s[4:7], s28 offen offset:0 sc1
  buffer_load_dwordx4 a[180:183], v2, s[4:7], s28 offen offset:1024 sc1
  buffer_load_dwordx4 a[184:187], v2, s[4:7], s28 offen offset:2048 sc1
  buffer_load_dwordx4 a[188:191], v2, s[4:7], s28 offen offset:3072 sc1
A_again_21:
  s_lshl_b32 s27, s69, 16
  s_add_u32 s27, s27, 57344
  s_add_u32 s17, s19, s27
  s_add_u32 s18, s20, s27
  s_lshl_b32 s21, s16, 11
  s_mov_b32 m0, s21
  s_nop 0
  buffer_load_dwordx4 v3, s[4:7], s18 offen offset:0 sc1 lds
  buffer_load_dwordx4 v3, s[4:7], s18 offen offset:1024 sc1 lds
  s_add_u32 m0, s21, 8192
  s_nop 0
  buffer_load_dwordx4 v3, s[4:7], s17 offen offset:0 sc1 lds
  buffer_load_dwordx4 v3, s[4:7], s17 offen offset:1024 sc1 lds
  s_add_u32 s18, s18, 8192
  s_sub_u32 s18, s18, 8192
  s_max_i32 s18, s18, s20
  s_sub_u32 s17, s17, 8192
  s_max_i32 s17, s17, s19
  s_add_u32 s21, s21, 16384
  s_and_b32 s21, s21, 131071
  s_mov_b32 m0, s21
  s_nop 0
  buffer_load_dwordx4 v3, s[4:7], s18 offen offset:0 sc1 lds
  buffer_load_dwordx4 v3, s[4:7], s18 offen offset:1024 sc1 lds
  s_add_u32 m0, s21, 8192
  s_nop 0
  buffer_load_dwordx4 v3, s[4:7], s17 offen offset:0 sc1 lds
  buffer_load_dwordx4 v3, s[4:7], s17 offen offset:1024 sc1 lds
  s_sub_u32 s18, s18, 8192
  s_max_i32 s18, s18, s20
  s_sub_u32 s17, s17, 8192
  s_max_i32 s17, s17, s19
  s_add_u32 s21, s21, 16384
  s_and_b32 s21, s21, 131071
  s_mov_b32 m0, s21
  s_nop 0
  buffer_load_dwordx4 v3, s[4:7], s18 offen offset:0 sc1 lds
  buffer_load_dwordx4 v3, s[4:7], s18 offen offset:1024 sc1 lds
  s_add_u32 m0, s21, 8192
  s_nop 0
  buffer_load_dwordx4 v3, s[4:7], s17 offen offset:0 sc1 lds
  buffer_load_dwordx4 v3, s[4:7], s17 offen offset:1024 sc1 lds
  s_sub_u32 s18, s18, 8192
  s_max_i32 s18, s18, s20
  s_sub_u32 s17, s17, 8192
  s_max_i32 s17, s17, s19
  s_add_u32 s21, s21, 16384
  s_and_b32 s21, s21, 131071
  s_mov_b32 m0, s21
  s_nop 0
  buffer_load_dwordx4 v3, s[4:7], s18 offen offset:0 sc1 lds
  buffer_load_dwordx4 v3, s[4:7], s18 offen offset:1024 sc1 lds
  s_add_u32 m0, s21, 8192
  s_nop 0
  buffer_load_dwordx4 v3, s[4:7], s17 offen offset:0 sc1 lds
  buffer_load_dwordx4 v3, s[4:7], s17 offen offset:1024 sc1 lds
  s_sub_u32 s18, s18, 8192
  s_max_i32 s18, s18, s20
  s_sub_u32 s17, s17, 8192
  s_max_i32 s17, s17, s19
  s_add_u32 s21, s21, 16384
  s_and_b32 s21, s21, 131071
  s_mov_b32 m0, s21
  s_nop 0
  buffer_load_dwordx4 v3, s[4:7], s18 offen offset:0 sc1 lds
  buffer_load_dwordx4 v3, s[4:7], s18 offen offset:1024 sc1 lds
  s_add_u32 m0, s21, 8192
  s_nop 0
  buffer_load_dwordx4 v3, s[4:7], s17 offen offset:0 sc1 lds
  buffer_load_dwordx4 v3, s[4:7], s17 offen offset:1024 sc1 lds
  s_sub_u32 s18, s18, 8192
  s_max_i32 s18, s18, s20
  s_sub_u32 s17, s17, 8192
  s_max_i32 s17, s17, s19
  s_add_u32 s21, s21, 16384
  s_and_b32 s21, s21, 131071
  s_mov_b32 m0, s21
  s_nop 0
  buffer_load_dwordx4 v3, s[4:7], s18 offen offset:0 sc1 lds
  buffer_load_dwordx4 v3, s[4:7], s18 offen offset:1024 sc1 lds
  s_add_u32 m0, s21, 8192
  s_nop 0
  buffer_load_dwordx4 v3, s[4:7], s17 offen offset:0 sc1 lds
  buffer_load_dwordx4 v3, s[4:7], s17 offen offset:1024 sc1 lds
  v_accvgpr_write_b32 a0, 0
  v_accvgpr_write_b32 a1, 0
  v_accvgpr_write_b32 a2, 0
  v_accvgpr_write_b32 a3, 0
  v_accvgpr_write_b32 a4, 0
  v_accvgpr_write_b32 a5, 0
  v_accvgpr_write_b32 a6, 0
  v_accvgpr_write_b32 a7, 0
  v_accvgpr_write_b32 a8, 0
  v_accvgpr_write_b32 a9, 0
  v_accvgpr_write_b32 a10, 0
  v_accvgpr_write_b32 a11, 0
  v_accvgpr_write_b32 a12, 0
  v_accvgpr_write_b32 a13, 0
  v_accvgpr_write_b32 a14, 0
  v_accvgpr_write_b32 a15, 0
  v_accvgpr_write_b32 a16, 0
  v_accvgpr_write_b32 a17, 0
  v_accvgpr_write_b32 a18, 0
  v_accvgpr_write_b32 a19, 0
  v_accvgpr_write_b32 a20, 0
  v_accvgpr_write_b32 a21, 0
  v_accvgpr_write_b32 a22, 0
  v_accvgpr_write_b32 a23, 0
  v_accvgpr_write_b32 a24, 0
  v_accvgpr_write_b32 a25, 0
  v_accvgpr_write_b32 a26, 0
  v_accvgpr_write_b32 a27, 0
  v_accvgpr_write_b32 a28, 0
  v_accvgpr_write_b32 a29, 0
  v_accvgpr_write_b32 a30, 0
  v_accvgpr_write_b32 a31, 0
  v_accvgpr_write_b32 a32, 0
  v_accvgpr_write_b32 a33, 0
  v_accvgpr_write_b32 a34, 0
  v_accvgpr_write_b32 a35, 0
  v_accvgpr_write_b32 a36, 0
  v_accvgpr_write_b32 a37, 0
  v_accvgpr_write_b32 a38, 0
  v_accvgpr_write_b32 a39, 0
  v_accvgpr_write_b32 a40, 0
  v_accvgpr_write_b32 a41, 0
  v_accvgpr_write_b32 a42, 0
  v_accvgpr_write_b32 a43, 0
  v_accvgpr_write_b32 a44, 0
  v_accvgpr_write_b32 a45, 0
  v_accvgpr_write_b32 a46, 0
  v_accvgpr_write_b32 a47, 0
  v_accvgpr_write_b32 a48, 0
  v_accvgpr_write_b32 a49, 0
  v_accvgpr_write_b32 a50, 0
  v_accvgpr_write_b32 a51, 0
  v_accvgpr_write_b32 a52, 0
  v_accvgpr_write_b32 a53, 0
  v_accvgpr_write_b32 a54, 0
  v_accvgpr_write_b32 a55, 0
  v_accvgpr_write_b32 a56, 0
  v_accvgpr_write_b32 a57, 0
  v_accvgpr_write_b32 a58, 0
  v_accvgpr_write_b32 a59, 0
  v_accvgpr_write_b32 a60, 0
  v_accvgpr_write_b32 a61, 0
  v_accvgpr_write_b32 a62, 0
  v_accvgpr_write_b32 a63, 0
  v_accvgpr_write_b32 a64, 0
  v_accvgpr_write_b32 a65, 0
  v_accvgpr_write_b32 a66, 0
  v_accvgpr_write_b32 a67, 0
  v_accvgpr_write_b32 a68, 0
  v_accvgpr_write_b32 a69, 0
  v_accvgpr_write_b32 a70, 0
  v_accvgpr_write_b32 a71, 0
  v_accvgpr_write_b32 a72, 0
  v_accvgpr_write_b32 a73, 0
  v_accvgpr_write_b32 a74, 0
  v_accvgpr_write_b32 a75, 0
  v_accvgpr_write_b32 a76, 0
  v_accvgpr_write_b32 a77, 0
  v_accvgpr_write_b32 a78, 0
  v_accvgpr_write_b32 a79, 0
  v_accvgpr_write_b32 a80, 0
  v_accvgpr_write_b32 a81, 0
  v_accvgpr_write_b32 a82, 0
  v_accvgpr_write_b32 a83, 0
  v_accvgpr_write_b32 a84, 0
  v_accvgpr_write_b32 a85, 0
  v_accvgpr_write_b32 a86, 0
  v_accvgpr_write_b32 a87, 0
  v_accvgpr_write_b32 a88, 0
  v_accvgpr_write_b32 a89, 0
  v_accvgpr_write_b32 a90, 0
  v_accvgpr_write_b32 a91, 0
  v_accvgpr_write_b32 a92, 0
  v_accvgpr_write_b32 a93, 0
  v_accvgpr_write_b32 a94, 0
  v_accvgpr_write_b32 a95, 0
  v_accvgpr_write_b32 a96, 0
  v_accvgpr_write_b32 a97, 0
  v_accvgpr_write_b32 a98, 0
  v_accvgpr_write_b32 a99, 0
  v_accvgpr_write_b32 a100, 0
  v_accvgpr_write_b32 a101, 0
  v_accvgpr_write_b32 a102, 0
  v_accvgpr_write_b32 a103, 0
  v_accvgpr_write_b32 a104, 0
  v_accvgpr_write_b32 a105, 0
  v_accvgpr_write_b32 a106, 0
  v_accvgpr_write_b32 a107, 0
  v_accvgpr_write_b32 a108, 0
  v_accvgpr_write_b32 a109, 0
  v_accvgpr_write_b32 a110, 0
  v_accvgpr_write_b32 a111, 0
  v_accvgpr_write_b32 a112, 0
  v_accvgpr_write_b32 a113, 0
  v_accvgpr_write_b32 a114, 0
  v_accvgpr_write_b32 a115, 0
  v_accvgpr_write_b32 a116, 0
  v_accvgpr_write_b32 a117, 0
  v_accvgpr_write_b32 a118, 0
  v_accvgpr_write_b32 a119, 0
  v_accvgpr_write_b32 a120, 0
  v_accvgpr_write_b32 a121, 0
  v_accvgpr_write_b32 a122, 0
  v_accvgpr_write_b32 a123, 0
  v_accvgpr_write_b32 a124, 0
  v_accvgpr_write_b32 a125, 0
  v_accvgpr_write_b32 a126, 0
  v_accvgpr_write_b32 a127, 0
  v_mov_b32 v8, 0
  v_mov_b32 v9, 0
  v_mov_b32 v10, 0
  v_mov_b32 v11, 0
  v_mov_b32 v52, 0
  v_mov_b32 v53, 0
  v_mov_b32 v54, s24
  v_mov_b32 v55, s24
  v_mov_b32 v56, s24
  v_mov_b32 v57, s24
  v_mov_b32 v58, s24
  v_mov_b32 v59, s24
  v_mov_b32 v60, s24
  v_mov_b32 v61, s24
  v_mov_b32 v62, s24
  v_mov_b32 v63, s24
  v_mov_b32 v104, 0
  v_mov_b32 v105, 0
  v_mov_b32 v4, v2
  v_mov_b32 v64, s24
  v_mov_b32 v65, s24
  v_mov_b32 v66, s24
  v_mov_b32 v67, s24
  v_mov_b32 v68, s24
  v_mov_b32 v69, s24
  v_mov_b32 v70, s24
  v_mov_b32 v71, s24
  v_mov_b32 v72, s24
  v_mov_b32 v73, s24
  v_mov_b32 v74, s24
  v_mov_b32 v75, s24
  v_mov_b32 v76, s24
  v_mov_b32 v77, s24
  v_mov_b32 v78, s24
  v_mov_b32 v79, s24
  v_mov_b32 v12, s24
  v_cmp_le_i32 s[40:41], 0, v5
  v_cmp_le_i32 s[42:43], 1, v5
  v_cmp_le_i32 s[44:45], 2, v5
  v_cmp_le_i32 s[46:47], 3, v5
  v_cndmask_b32 v80, v12, v7, s[40:41]
  v_cndmask_b32 v81, v12, v7, s[42:43]
  v_cndmask_b32 v82, v12, v7, s[44:45]
  v_cndmask_b32 v83, v12, v7, s[46:47]
  v_cmp_le_i32 s[40:41], 8, v5
  v_cmp_le_i32 s[42:43], 9, v5
  v_cmp_le_i32 s[44:45], 10, v5
  v_cmp_le_i32 s[46:47], 11, v5
  v_cndmask_b32 v84, v12, v7, s[40:41]
  v_cndmask_b32 v85, v12, v7, s[42:43]
  v_cndmask_b32 v86, v12, v7, s[44:45]
  v_cndmask_b32 v87, v12, v7, s[46:47]
  v_cmp_le_i32 s[40:41], 16, v5
  v_cmp_le_i32 s[42:43], 17, v5
  v_cmp_le_i32 s[44:45], 18, v5
  v_cmp_le_i32 s[46:47], 19, v5
  v_cndmask_b32 v88, v12, v7, s[40:41]
  v_cndmask_b32 v89, v12, v7, s[42:43]
  v_cndmask_b32 v90, v12, v7, s[44:45]
  v_cndmask_b32 v91, v12, v7, s[46:47]
  v_cmp_le_i32 s[40:41], 24, v5
  v_cmp_le_i32 s[42:43], 25, v5
  v_cmp_le_i32 s[44:45], 26, v5
  v_cmp_le_i32 s[46:47], 27, v5
  v_cndmask_b32 v92, v12, v7, s[40:41]
  v_cndmask_b32 v93, v12, v7, s[42:43]
  v_cndmask_b32 v94, v12, v7, s[44:45]
  v_cndmask_b32 v95, v12, v7, s[46:47]
  s_lshl_b32 s22, s69, 3
  s_add_u32 s22, s22, 8
  s_lshl_b32 s26, s16, 1
  s_sub_u32 s23, 6, s26
  s_waitcnt vmcnt(20)
  s_barrier
  s_cmp_eq_u32 s23, 0
  s_cbranch_scc1 A_go_23
A_idle_22:
  s_waitcnt vmcnt(16)
  s_barrier
  s_sub_u32 s18, s18, 8192
  s_max_i32 s18, s18, s20
  s_sub_u32 s17, s17, 8192
  s_max_i32 s17, s17, s19
  s_add_u32 s21, s21, 16384
  s_and_b32 s21, s21, 131071
M_kv_24:
  s_cmp_ge_u32 s17, s36
  s_cbranch_scc1 M_kvok_25
  s_mov_b32 s76, 0
  s_mov_b32 s78, 23
  s_mov_b32 s77, 335872
  s_cmp_eq_u32 s68, 1
  s_cmov_b32 s76, 128
  s_cmov_b32 s78, 27
  s_cmov_b32 s77, 114688
  s_cmp_eq_u32 s68, 2
  s_cmov_b32 s76, 768
  s_cmov_b32 s78, 14
  s_cmov_b32 s77, 0
  s_add_u32 s76, s76, s67
  s_mov_b32 s71, 0
  s_branch M_sg_27
M_sw_26:
  s_sleep 8
  s_add_u32 s71, s71, 1
  s_cmp_gt_u32 s71, 262144
  s_cbranch_scc1 M_exit
M_sg_27:
  s_mov_b32 s79, 0
  s_atomic_or s79, s[72:73], s76 glc
  s_waitcnt lgkmcnt(0)
  s_cmp_lt_u32 s79, s78
  s_cbranch_scc1 M_sw_26
  s_add_u32 s36, s77, s19
  s_add_u32 s68, s68, 1
  s_branch M_kv_24
M_kvok_25:
  s_mov_b32 m0, s21
  s_nop 0
  buffer_load_dwordx4 v3, s[4:7], s18 offen offset:0 sc1 lds
  buffer_load_dwordx4 v3, s[4:7], s18 offen offset:1024 sc1 lds
  s_add_u32 m0, s21, 8192
  s_nop 0
  buffer_load_dwordx4 v3, s[4:7], s17 offen offset:0 sc1 lds
  buffer_load_dwordx4 v3, s[4:7], s17 offen offset:1024 sc1 lds
  v_add_u32 v4, 16384, v4
  v_and_b32 v4, 131071, v4
  s_sub_u32 s22, s22, 1
  s_sub_u32 s23, s23, 1
  s_cmp_lg_u32 s23, 0
  s_cbranch_scc1 A_idle_22
A_go_23:
  ds_read_b128 a[224:227], v4 offset:0
  ds_read_b128 a[228:231], v4 offset:2048
  ds_read_b128 a[232:235], v4 offset:4096
  ds_read_b128 a[236:239], v4 offset:6144
  ds_read_b128 a[240:243], v4 offset:1024
  ds_read_b128 a[244:247], v4 offset:3072
  ds_read_b128 a[248:251], v4 offset:5120
  ds_read_b128 a[252:255], v4 offset:7168
  ds_read_b128 a[192:195], v4 offset:8192
  ds_read_b128 a[196:199], v4 offset:9216
  ds_read_b128 a[200:203], v4 offset:10240
  ds_read_b128 a[204:207], v4 offset:11264
  ds_read_b128 a[208:211], v4 offset:12288
  ds_read_b128 a[212:215], v4 offset:13312
  ds_read_b128 a[216:219], v4 offset:14336
  ds_read_b128 a[220:223], v4 offset:15360
  v_add_u32 v4, 16384, v4
  v_and_b32 v4, 131071, v4
  s_waitcnt lgkmcnt(8)
.p2align 6
A_top_28:
  s_waitcnt lgkmcnt(7)
  v_mfma_f32_32x32x16_bf16 v[32:47], a[192:195], a[128:131], v[64:79]
  s_waitcnt lgkmcnt(6)
  v_exp_f32 v54, v54
  v_add_f32 v11, v11, v53
  v_cvt_pk_bf16_f32 v106, v52, v53
  v_mfma_f32_32x32x16_bf16 v[32:47], a[196:199], a[132:135], v[32:47]
  s_waitcnt lgkmcnt(4)
  v_exp_f32 v55, v55
  v_add_f32 v10, v10, v54
  v_mfma_f32_32x32x16_bf16 v[32:47], a[200:203], a[136:139], v[32:47]
  v_exp_f32 v56, v56
  v_add_f32 v11, v11, v55
  v_cvt_pk_bf16_f32 v107, v54, v55
  v_mfma_f32_32x32x16_bf16 v[32:47], a[204:207], a[140:143], v[32:47]
  s_waitcnt lgkmcnt(2)
  v_exp_f32 v57, v57
  v_add_f32 v10, v10, v56
  v_mfma_f32_32x32x16_bf16 v[32:47], a[208:211], a[144:147], v[32:47]
  v_exp_f32 v58, v58
  v_add_f32 v11, v11, v57
  v_cvt_pk_bf16_f32 v108, v56, v57
  v_mfma_f32_32x32x16_bf16 v[32:47], a[212:215], a[148:151], v[32:47]
  s_waitcnt lgkmcnt(0)
  v_exp_f32 v59, v59
  v_add_f32 v10, v10, v58
  v_mfma_f32_32x32x16_bf16 v[32:47], a[216:219], a[152:155], v[32:47]
  v_exp_f32 v60, v60
  v_add_f32 v11, v11, v59
  v_cvt_pk_bf16_f32 v109, v58, v59
  v_mfma_f32_32x32x16_bf16 v[32:47], a[220:223], a[156:159], v[32:47]
  s_waitcnt vmcnt(16)
  s_barrier
  v_exp_f32 v61, v61
  v_add_f32 v10, v10, v60
  v_mfma_f32_32x32x16_bf16 a[64:79], a[224:227], v[104:107], a[64:79]
  ds_read_b128 a[224:227], v4 offset:0
  v_exp_f32 v62, v62
  v_add_f32 v11, v11, v61
  v_cvt_pk_bf16_f32 v110, v60, v61
  v_mfma_f32_32x32x16_bf16 a[80:95], a[228:231], v[104:107], a[80:95]
  s_sub_u32 s18, s18, 8192
  ds_read_b128 a[228:231], v4 offset:2048
  v_exp_f32 v63, v63
  v_add_f32 v10, v10, v62
  v_mfma_f32_32x32x16_bf16 a[96:111], a[232:235], v[104:107], a[96:111]
  s_max_i32 s18, s18, s20
  ds_read_b128 a[232:235], v4 offset:4096
  v_exp_f32 v32, v32
  v_add_f32 v11, v11, v63
  v_cvt_pk_bf16_f32 v111, v62, v63
  v_mfma_f32_32x32x16_bf16 a[112:127], a[236:239], v[104:107], a[112:127]
  s_sub_u32 s17, s17, 8192
  ds_read_b128 a[236:239], v4 offset:6144
  v_exp_f32 v33, v33
  v_add_f32 v8, v8, v32
  v_mfma_f32_32x32x16_bf16 a[64:79], a[240:243], v[108:111], a[64:79]
  s_max_i32 s17, s17, s19
  ds_read_b128 a[240:243], v4 offset:1024
  v_exp_f32 v34, v34
  v_add_f32 v9, v9, v33
  v_cvt_pk_bf16_f32 v96, v32, v33
  v_mfma_f32_32x32x16_bf16 a[80:95], a[244:247], v[108:111], a[80:95]
  s_add_u32 s21, s21, 16384
  ds_read_b128 a[244:247], v4 offset:3072
  v_exp_f32 v35, v35
  v_add_f32 v8, v8, v34
  v_mfma_f32_32x32x16_bf16 a[96:111], a[248:251], v[108:111], a[96:111]
  s_and_b32 s21, s21, 131071
  ds_read_b128 a[248:251], v4 offset:5120
  v_exp_f32 v36, v36
  v_add_f32 v9, v9, v35
  v_cvt_pk_bf16_f32 v97, v34, v35
  v_mfma_f32_32x32x16_bf16 a[112:127], a[252:255], v[108:111], a[112:127]
  ds_read_b128 a[252:255], v4 offset:7168
  v_exp_f32 v37, v37
  v_add_f32 v8, v8, v36
  v_mfma_f32_32x32x16_bf16 v[48:63], a[192:195], a[160:163], v[80:95]
  s_add_u32 s23, s23, 1
  ds_read_b128 a[192:195], v4 offset:8192
  v_exp_f32 v38, v38
  v_add_f32 v9, v9, v37
  v_cvt_pk_bf16_f32 v98, v36, v37
  v_mfma_f32_32x32x16_bf16 v[48:63], a[196:199], a[164:167], v[48:63]
  s_sub_u32 s22, s22, 1
  ds_read_b128 a[196:199], v4 offset:9216
  v_exp_f32 v39, v39
  v_add_f32 v8, v8, v38
  v_mfma_f32_32x32x16_bf16 v[48:63], a[200:203], a[168:171], v[48:63]
  s_cmp_lt_u32 s23, 3
  ds_read_b128 a[200:203], v4 offset:10240
  v_exp_f32 v40, v40
  v_add_f32 v9, v9, v39
  v_cvt_pk_bf16_f32 v99, v38, v39
  v_mfma_f32_32x32x16_bf16 v[48:63], a[204:207], a[172:175], v[48:63]
  s_cbranch_scc1 A_upd_29
A_back_30:
  ds_read_b128 a[204:207], v4 offset:11264
  v_exp_f32 v41, v41
  v_add_f32 v8, v8, v40
  v_mfma_f32_32x32x16_bf16 v[48:63], a[208:211], a[176:179], v[48:63]
  s_cmp_lt_u32 s17, s36
  ds_read_b128 a[208:211], v4 offset:12288
  v_exp_f32 v42, v42
  v_add_f32 v9, v9, v41
  v_cvt_pk_bf16_f32 v100, v40, v41
  v_mfma_f32_32x32x16_bf16 v[48:63], a[212:215], a[180:183], v[48:63]
  s_cbranch_scc1 A_kvw_32
A_kvb_33:
  ds_read_b128 a[212:215], v4 offset:13312
  v_exp_f32 v43, v43
  v_add_f32 v8, v8, v42
  v_mfma_f32_32x32x16_bf16 v[48:63], a[216:219], a[184:187], v[48:63]
  s_mov_b32 m0, s21
  ds_read_b128 a[216:219], v4 offset:14336
  v_exp_f32 v44, v44
  v_add_f32 v9, v9, v43
  v_cvt_pk_bf16_f32 v101, v42, v43
  v_mfma_f32_32x32x16_bf16 v[48:63], a[220:223], a[188:191], v[48:63]
  s_waitcnt lgkmcnt(13)
  ds_read_b128 a[220:223], v4 offset:15360
  v_exp_f32 v45, v45
  v_add_f32 v8, v8, v44
  v_mfma_f32_32x32x16_bf16 a[0:15], a[224:227], v[96:99], a[0:15]
  buffer_load_dwordx4 v3, s[4:7], s18 offen offset:0 sc1 lds
  v_exp_f32 v46, v46
  v_add_f32 v9, v9, v45
  v_cvt_pk_bf16_f32 v102, v44, v45
  v_mfma_f32_32x32x16_bf16 a[16:31], a[228:231], v[96:99], a[16:31]
  s_waitcnt lgkmcnt(12)
  v_exp_f32 v47, v47
  v_add_f32 v8, v8, v46
  v_add_u32 v4, 16384, v4
  v_mfma_f32_32x32x16_bf16 a[32:47], a[232:235], v[96:99], a[32:47]
  buffer_load_dwordx4 v3, s[4:7], s18 offen offset:1024 sc1 lds
  v_exp_f32 v48, v48
  v_add_f32 v9, v9, v47
  v_cvt_pk_bf16_f32 v103, v46, v47
  v_mfma_f32_32x32x16_bf16 a[48:63], a[236:239], v[96:99], a[48:63]
  s_waitcnt lgkmcnt(10)
  s_add_u32 m0, s21, 8192
  v_exp_f32 v49, v49
  v_add_f32 v10, v10, v48
  v_and_b32 v4, 131071, v4
  v_mfma_f32_32x32x16_bf16 a[0:15], a[240:243], v[100:103], a[0:15]
  buffer_load_dwordx4 v3, s[4:7], s17 offen offset:0 sc1 lds
  v_exp_f32 v50, v50
  v_add_f32 v11, v11, v49
  v_cvt_pk_bf16_f32 v104, v48, v49
  v_mfma_f32_32x32x16_bf16 a[16:31], a[244:247], v[100:103], a[16:31]
  s_waitcnt lgkmcnt(8)
  s_cmp_lg_u32 s22, 0
  v_exp_f32 v51, v51
  v_add_f32 v10, v10, v50
  v_mfma_f32_32x32x16_bf16 a[32:47], a[248:251], v[100:103], a[32:47]
  buffer_load_dwordx4 v3, s[4:7], s17 offen offset:1024 sc1 lds
  v_exp_f32 v52, v52
  v_add_f32 v11, v11, v51
  v_cvt_pk_bf16_f32 v105, v50, v51
  v_mfma_f32_32x32x16_bf16 a[48:63], a[252:255], v[100:103], a[48:63]
  v_exp_f32 v53, v53
  v_add_f32 v10, v10, v52
  s_cbranch_scc1 A_top_28
  v_exp_f32 v54, v54
  v_add_f32 v11, v11, v53
  v_cvt_pk_bf16_f32 v106, v52, v53
  v_exp_f32 v55, v55
  v_add_f32 v10, v10, v54
  v_exp_f32 v56, v56
  v_add_f32 v11, v11, v55
  v_cvt_pk_bf16_f32 v107, v54, v55
  v_exp_f32 v57, v57
  v_add_f32 v10, v10, v56
  v_exp_f32 v58, v58
  v_add_f32 v11, v11, v57
  v_cvt_pk_bf16_f32 v108, v56, v57
  v_exp_f32 v59, v59
  v_add_f32 v10, v10, v58
  v_exp_f32 v60, v60
  v_add_f32 v11, v11, v59
  v_cvt_pk_bf16_f32 v109, v58, v59
  v_exp_f32 v61, v61
  v_add_f32 v10, v10, v60
  v_exp_f32 v62, v62
  v_add_f32 v11, v11, v61
  v_cvt_pk_bf16_f32 v110, v60, v61
  v_exp_f32 v63, v63
  v_add_f32 v10, v10, v62
  v_add_f32 v11, v11, v63
  v_cvt_pk_bf16_f32 v111, v62, v63
  s_nop 1
  v_mfma_f32_32x32x16_bf16 a[64:79], a[224:227], v[104:107], a[64:79]
  v_mfma_f32_32x32x16_bf16 a[80:95], a[228:231], v[104:107], a[80:95]
  v_mfma_f32_32x32x16_bf16 a[96:111], a[232:235], v[104:107], a[96:111]
  v_mfma_f32_32x32x16_bf16 a[112:127], a[236:239], v[104:107], a[112:127]
  v_mfma_f32_32x32x16_bf16 a[64:79], a[240:243], v[108:111], a[64:79]
  v_mfma_f32_32x32x16_bf16 a[80:95], a[244:247], v[108:111], a[80:95]
  v_mfma_f32_32x32x16_bf16 a[96:111], a[248:251], v[108:111], a[96:111]
  v_mfma_f32_32x32x16_bf16 a[112:127], a[252:255], v[108:111], a[112:127]
  v_add_f32 v8, v8, v9
  v_mov_b32 v9, v8
  s_nop 1
  v_permlane32_swap_b32 v8, v9
  s_nop 1
  v_add_f32 v8, v8, v9
  v_add_f32 v10, v10, v11
  v_mov_b32 v11, v10
  s_nop 1
  v_permlane32_swap_b32 v10, v11
  s_nop 1
  v_add_f32 v10, v10, v11
  v_subrev_u32 v12, 0x2f800000, v8
  v_subrev_u32 v13, 0x2f800000, v10
  v_max_u32 v12, v12, v13
  v_cmp_le_u32 vcc, 0x28000000, v12
  s_nop 1
  s_cmp_lg_u64 vcc, 0
  s_cselect_b32 s26, 1, 0
  v_mov_b32 v12, s26
  s_lshl_b32 s26, s16, 2
  s_add_u32 s26, s26, 131072
  v_mov_b32 v13, s26
  ds_write_b32 v13, v12
  v_mov_b32 v14, 131072
  s_waitcnt vmcnt(0) lgkmcnt(0)
  s_barrier
  ds_read_b128 v[16:19], v14
  v_rcp_f32 v8, v8
  v_rcp_f32 v10, v10
  s_waitcnt lgkmcnt(0)
  v_or3_b32 v12, v16, v17, v18
  v_or_b32 v12, v12, v19
  s_nop 0
  v_readfirstlane_b32 s26, v12
  s_nop 1
  s_cmp_gt_u32 s26, s29
  s_cbranch_scc1 A_slow_34
  s_add_u32 s28, s25, 100663296
  v_accvgpr_read_b32 v112, a0
  v_accvgpr_read_b32 v113, a1
  v_accvgpr_read_b32 v114, a2
  v_accvgpr_read_b32 v115, a3
  v_accvgpr_read_b32 v116, a4
  v_accvgpr_read_b32 v117, a5
  v_accvgpr_read_b32 v118, a6
  v_accvgpr_read_b32 v119, a7
  v_pk_mul_f32 v[112:113], v[112:113], v[8:9] op_sel_hi:[1,0]
  v_pk_mul_f32 v[114:115], v[114:115], v[8:9] op_sel_hi:[1,0]
  v_pk_mul_f32 v[116:117], v[116:117], v[8:9] op_sel_hi:[1,0]
  v_pk_mul_f32 v[118:119], v[118:119], v[8:9] op_sel_hi:[1,0]
  v_cvt_pk_bf16_f32 v120, v112, v113
  v_cvt_pk_bf16_f32 v121, v114, v115
  v_cvt_pk_bf16_f32 v122, v116, v117
  v_cvt_pk_bf16_f32 v123, v118, v119
  buffer_store_dwordx4 v[120:123], v2, s[4:7], s28 offen offset:0 sc1
  v_accvgpr_read_b32 v124, a8
  v_accvgpr_read_b32 v125, a9
  v_accvgpr_read_b32 v126, a10
  v_accvgpr_read_b32 v127, a11
  v_accvgpr_read_b32 v128, a12
  v_accvgpr_read_b32 v129, a13
  v_accvgpr_read_b32 v130, a14
  v_accvgpr_read_b32 v131, a15
  v_pk_mul_f32 v[124:125], v[124:125], v[8:9] op_sel_hi:[1,0]
  v_pk_mul_f32 v[126:127], v[126:127], v[8:9] op_sel_hi:[1,0]
  v_pk_mul_f32 v[128:129], v[128:129], v[8:9] op_sel_hi:[1,0]
  v_pk_mul_f32 v[130:131], v[130:131], v[8:9] op_sel_hi:[1,0]
  v_cvt_pk_bf16_f32 v132, v124, v125
  v_cvt_pk_bf16_f32 v133, v126, v127
  v_cvt_pk_bf16_f32 v134, v128, v129
  v_cvt_pk_bf16_f32 v135, v130, v131
  buffer_store_dwordx4 v[132:135], v2, s[4:7], s28 offen offset:1024 sc1
  v_accvgpr_read_b32 v136, a16
  v_accvgpr_read_b32 v137, a17
  v_accvgpr_read_b32 v138, a18
  v_accvgpr_read_b32 v139, a19
  v_accvgpr_read_b32 v140, a20
  v_accvgpr_read_b32 v141, a21
  v_accvgpr_read_b32 v142, a22
  v_accvgpr_read_b32 v143, a23
  v_pk_mul_f32 v[136:137], v[136:137], v[8:9] op_sel_hi:[1,0]
  v_pk_mul_f32 v[138:139], v[138:139], v[8:9] op_sel_hi:[1,0]
  v_pk_mul_f32 v[140:141], v[140:141], v[8:9] op_sel_hi:[1,0]
  v_pk_mul_f32 v[142:143], v[142:143], v[8:9] op_sel_hi:[1,0]
  v_cvt_pk_bf16_f32 v144, v136, v137
  v_cvt_pk_bf16_f32 v145, v138, v139
  v_cvt_pk_bf16_f32 v146, v140, v141
  v_cvt_pk_bf16_f32 v147, v142, v143
  buffer_store_dwordx4 v[144:147], v2, s[4:7], s28 offen offset:2048 sc1
  v_accvgpr_read_b32 v148, a24
  v_accvgpr_read_b32 v149, a25
  v_accvgpr_read_b32 v150, a26
  v_accvgpr_read_b32 v151, a27
  v_accvgpr_read_b32 v152, a28
  v_accvgpr_read_b32 v153, a29
  v_accvgpr_read_b32 v154, a30
  v_accvgpr_read_b32 v155, a31
  v_pk_mul_f32 v[148:149], v[148:149], v[8:9] op_sel_hi:[1,0]
  v_pk_mul_f32 v[150:151], v[150:151], v[8:9] op_sel_hi:[1,0]
  v_pk_mul_f32 v[152:153], v[152:153], v[8:9] op_sel_hi:[1,0]
  v_pk_mul_f32 v[154:155], v[154:155], v[8:9] op_sel_hi:[1,0]
  v_cvt_pk_bf16_f32 v156, v148, v149
  v_cvt_pk_bf16_f32 v157, v150, v151
  v_cvt_pk_bf16_f32 v158, v152, v153
  v_cvt_pk_bf16_f32 v159, v154, v155
  buffer_store_dwordx4 v[156:159], v2, s[4:7], s28 offen offset:3072 sc1
  s_add_u32 s28, s25, 100667392
  v_accvgpr_read_b32 v112, a32
  v_accvgpr_read_b32 v113, a33
  v_accvgpr_read_b32 v114, a34
  v_accvgpr_read_b32 v115, a35
  v_accvgpr_read_b32 v116, a36
  v_accvgpr_read_b32 v117, a37
  v_accvgpr_read_b32 v118, a38
  v_accvgpr_read_b32 v119, a39
  v_pk_mul_f32 v[112:113], v[112:113], v[8:9] op_sel_hi:[1,0]
  v_pk_mul_f32 v[114:115], v[114:115], v[8:9] op_sel_hi:[1,0]
  v_pk_mul_f32 v[116:117], v[116:117], v[8:9] op_sel_hi:[1,0]
  v_pk_mul_f32 v[118:119], v[118:119], v[8:9] op_sel_hi:[1,0]
  v_cvt_pk_bf16_f32 v120, v112, v113
  v_cvt_pk_bf16_f32 v121, v114, v115
  v_cvt_pk_bf16_f32 v122, v116, v117
  v_cvt_pk_bf16_f32 v123, v118, v119
  buffer_store_dwordx4 v[120:123], v2, s[4:7], s28 offen offset:0 sc1
  v_accvgpr_read_b32 v124, a40
  v_accvgpr_read_b32 v125, a41
  v_accvgpr_read_b32 v126, a42
  v_accvgpr_read_b32 v127, a43
  v_accvgpr_read_b32 v128, a44
  v_accvgpr_read_b32 v129, a45
  v_accvgpr_read_b32 v130, a46
  v_accvgpr_read_b32 v131, a47
  v_pk_mul_f32 v[124:125], v[124:125], v[8:9] op_sel_hi:[1,0]
  v_pk_mul_f32 v[126:127], v[126:127], v[8:9] op_sel_hi:[1,0]
  v_pk_mul_f32 v[128:129], v[128:129], v[8:9] op_sel_hi:[1,0]
  v_pk_mul_f32 v[130:131], v[130:131], v[8:9] op_sel_hi:[1,0]
  v_cvt_pk_bf16_f32 v132, v124, v125
  v_cvt_pk_bf16_f32 v133, v126, v127
  v_cvt_pk_bf16_f32 v134, v128, v129
  v_cvt_pk_bf16_f32 v135, v130, v131
  buffer_store_dwordx4 v[132:135], v2, s[4:7], s28 offen offset:1024 sc1
  v_accvgpr_read_b32 v136, a48
  v_accvgpr_read_b32 v137, a49
  v_accvgpr_read_b32 v138, a50
  v_accvgpr_read_b32 v139, a51
  v_accvgpr_read_b32 v140, a52
  v_accvgpr_read_b32 v141, a53
  v_accvgpr_read_b32 v142, a54
  v_accvgpr_read_b32 v143, a55
  v_pk_mul_f32 v[136:137], v[136:137], v[8:9] op_sel_hi:[1,0]
  v_pk_mul_f32 v[138:139], v[138:139], v[8:9] op_sel_hi:[1,0]
  v_pk_mul_f32 v[140:141], v[140:141], v[8:9] op_sel_hi:[1,0]
  v_pk_mul_f32 v[142:143], v[142:143], v[8:9] op_sel_hi:[1,0]
  v_cvt_pk_bf16_f32 v144, v136, v137
  v_cvt_pk_bf16_f32 v145, v138, v139
  v_cvt_pk_bf16_f32 v146, v140, v141
  v_cvt_pk_bf16_f32 v147, v142, v143
  buffer_store_dwordx4 v[144:147], v2, s[4:7], s28 offen offset:2048 sc1
  v_accvgpr_read_b32 v148, a56
  v_accvgpr_read_b32 v149, a57
  v_accvgpr_read_b32 v150, a58
  v_accvgpr_read_b32 v151, a59
  v_accvgpr_read_b32 v152, a60
  v_accvgpr_read_b32 v153, a61
  v_accvgpr_read_b32 v154, a62
  v_accvgpr_read_b32 v155, a63
  v_pk_mul_f32 v[148:149], v[148:149], v[8:9] op_sel_hi:[1,0]
  v_pk_mul_f32 v[150:151], v[150:151], v[8:9] op_sel_hi:[1,0]
  v_pk_mul_f32 v[152:153], v[152:153], v[8:9] op_sel_hi:[1,0]
  v_pk_mul_f32 v[154:155], v[154:155], v[8:9] op_sel_hi:[1,0]
  v_cvt_pk_bf16_f32 v156, v148, v149
  v_cvt_pk_bf16_f32 v157, v150, v151
  v_cvt_pk_bf16_f32 v158, v152, v153
  v_cvt_pk_bf16_f32 v159, v154, v155
  buffer_store_dwordx4 v[156:159], v2, s[4:7], s28 offen offset:3072 sc1
  s_add_u32 s28, s25, 100671488
  v_accvgpr_read_b32 v112, a64
  v_accvgpr_read_b32 v113, a65
  v_accvgpr_read_b32 v114, a66
  v_accvgpr_read_b32 v115, a67
  v_accvgpr_read_b32 v116, a68
  v_accvgpr_read_b32 v117, a69
  v_accvgpr_read_b32 v118, a70
  v_accvgpr_read_b32 v119, a71
  v_pk_mul_f32 v[112:113], v[112:113], v[10:11] op_sel_hi:[1,0]
  v_pk_mul_f32 v[114:115], v[114:115], v[10:11] op_sel_hi:[1,0]
  v_pk_mul_f32 v[116:117], v[116:117], v[10:11] op_sel_hi:[1,0]
  v_pk_mul_f32 v[118:119], v[118:119], v[10:11] op_sel_hi:[1,0]
  v_cvt_pk_bf16_f32 v120, v112, v113
  v_cvt_pk_bf16_f32 v121, v114, v115
  v_cvt_pk_bf16_f32 v122, v116, v117
  v_cvt_pk_bf16_f32 v123, v118, v119
  buffer_store_dwordx4 v[120:123], v2, s[4:7], s28 offen offset:0 sc1
  v_accvgpr_read_b32 v124, a72
  v_accvgpr_read_b32 v125, a73
  v_accvgpr_read_b32 v126, a74
  v_accvgpr_read_b32 v127, a75
  v_accvgpr_read_b32 v128, a76
  v_accvgpr_read_b32 v129, a77
  v_accvgpr_read_b32 v130, a78
  v_accvgpr_read_b32 v131, a79
  v_pk_mul_f32 v[124:125], v[124:125], v[10:11] op_sel_hi:[1,0]
  v_pk_mul_f32 v[126:127], v[126:127], v[10:11] op_sel_hi:[1,0]
  v_pk_mul_f32 v[128:129], v[128:129], v[10:11] op_sel_hi:[1,0]
  v_pk_mul_f32 v[130:131], v[130:131], v[10:11] op_sel_hi:[1,0]
  v_cvt_pk_bf16_f32 v132, v124, v125
  v_cvt_pk_bf16_f32 v133, v126, v127
  v_cvt_pk_bf16_f32 v134, v128, v129
  v_cvt_pk_bf16_f32 v135, v130, v131
  buffer_store_dwordx4 v[132:135], v2, s[4:7], s28 offen offset:1024 sc1
  v_accvgpr_read_b32 v136, a80
  v_accvgpr_read_b32 v137, a81
  v_accvgpr_read_b32 v138, a82
  v_accvgpr_read_b32 v139, a83
  v_accvgpr_read_b32 v140, a84
  v_accvgpr_read_b32 v141, a85
  v_accvgpr_read_b32 v142, a86
  v_accvgpr_read_b32 v143, a87
  v_pk_mul_f32 v[136:137], v[136:137], v[10:11] op_sel_hi:[1,0]
  v_pk_mul_f32 v[138:139], v[138:139], v[10:11] op_sel_hi:[1,0]
  v_pk_mul_f32 v[140:141], v[140:141], v[10:11] op_sel_hi:[1,0]
  v_pk_mul_f32 v[142:143], v[142:143], v[10:11] op_sel_hi:[1,0]
  v_cvt_pk_bf16_f32 v144, v136, v137
  v_cvt_pk_bf16_f32 v145, v138, v139
  v_cvt_pk_bf16_f32 v146, v140, v141
  v_cvt_pk_bf16_f32 v147, v142, v143
  buffer_store_dwordx4 v[144:147], v2, s[4:7], s28 offen offset:2048 sc1
  v_accvgpr_read_b32 v148, a88
  v_accvgpr_read_b32 v149, a89
  v_accvgpr_read_b32 v150, a90
  v_accvgpr_read_b32 v151, a91
  v_accvgpr_read_b32 v152, a92
  v_accvgpr_read_b32 v153, a93
  v_accvgpr_read_b32 v154, a94
  v_accvgpr_read_b32 v155, a95
  v_pk_mul_f32 v[148:149], v[148:149], v[10:11] op_sel_hi:[1,0]
  v_pk_mul_f32 v[150:151], v[150:151], v[10:11] op_sel_hi:[1,0]
  v_pk_mul_f32 v[152:153], v[152:153], v[10:11] op_sel_hi:[1,0]
  v_pk_mul_f32 v[154:155], v[154:155], v[10:11] op_sel_hi:[1,0]
  v_cvt_pk_bf16_f32 v156, v148, v149
  v_cvt_pk_bf16_f32 v157, v150, v151
  v_cvt_pk_bf16_f32 v158, v152, v153
  v_cvt_pk_bf16_f32 v159, v154, v155
  buffer_store_dwordx4 v[156:159], v2, s[4:7], s28 offen offset:3072 sc1
  s_add_u32 s28, s25, 100675584
  v_accvgpr_read_b32 v112, a96
  v_accvgpr_read_b32 v113, a97
  v_accvgpr_read_b32 v114, a98
  v_accvgpr_read_b32 v115, a99
  v_accvgpr_read_b32 v116, a100
  v_accvgpr_read_b32 v117, a101
  v_accvgpr_read_b32 v118, a102
  v_accvgpr_read_b32 v119, a103
  v_pk_mul_f32 v[112:113], v[112:113], v[10:11] op_sel_hi:[1,0]
  v_pk_mul_f32 v[114:115], v[114:115], v[10:11] op_sel_hi:[1,0]
  v_pk_mul_f32 v[116:117], v[116:117], v[10:11] op_sel_hi:[1,0]
  v_pk_mul_f32 v[118:119], v[118:119], v[10:11] op_sel_hi:[1,0]
  v_cvt_pk_bf16_f32 v120, v112, v113
  v_cvt_pk_bf16_f32 v121, v114, v115
  v_cvt_pk_bf16_f32 v122, v116, v117
  v_cvt_pk_bf16_f32 v123, v118, v119
  buffer_store_dwordx4 v[120:123], v2, s[4:7], s28 offen offset:0 sc1
  v_accvgpr_read_b32 v124, a104
  v_accvgpr_read_b32 v125, a105
  v_accvgpr_read_b32 v126, a106
  v_accvgpr_read_b32 v127, a107
  v_accvgpr_read_b32 v128, a108
  v_accvgpr_read_b32 v129, a109
  v_accvgpr_read_b32 v130, a110
  v_accvgpr_read_b32 v131, a111
  v_pk_mul_f32 v[124:125], v[124:125], v[10:11] op_sel_hi:[1,0]
  v_pk_mul_f32 v[126:127], v[126:127], v[10:11] op_sel_hi:[1,0]
  v_pk_mul_f32 v[128:129], v[128:129], v[10:11] op_sel_hi:[1,0]
  v_pk_mul_f32 v[130:131], v[130:131], v[10:11] op_sel_hi:[1,0]
  v_cvt_pk_bf16_f32 v132, v124, v125
  v_cvt_pk_bf16_f32 v133, v126, v127
  v_cvt_pk_bf16_f32 v134, v128, v129
  v_cvt_pk_bf16_f32 v135, v130, v131
  buffer_store_dwordx4 v[132:135], v2, s[4:7], s28 offen offset:1024 sc1
  v_accvgpr_read_b32 v136, a112
  v_accvgpr_read_b32 v137, a113
  v_accvgpr_read_b32 v138, a114
  v_accvgpr_read_b32 v139, a115
  v_accvgpr_read_b32 v140, a116
  v_accvgpr_read_b32 v141, a117
  v_accvgpr_read_b32 v142, a118
  v_accvgpr_read_b32 v143, a119
  v_pk_mul_f32 v[136:137], v[136:137], v[10:11] op_sel_hi:[1,0]
  v_pk_mul_f32 v[138:139], v[138:139], v[10:11] op_sel_hi:[1,0]
  v_pk_mul_f32 v[140:141], v[140:141], v[10:11] op_sel_hi:[1,0]
  v_pk_mul_f32 v[142:143], v[142:143], v[10:11] op_sel_hi:[1,0]
  v_cvt_pk_bf16_f32 v144, v136, v137
  v_cvt_pk_bf16_f32 v145, v138, v139
  v_cvt_pk_bf16_f32 v146, v140, v141
  v_cvt_pk_bf16_f32 v147, v142, v143
  buffer_store_dwordx4 v[144:147], v2, s[4:7], s28 offen offset:2048 sc1
  v_accvgpr_read_b32 v148, a120
  v_accvgpr_read_b32 v149, a121
  v_accvgpr_read_b32 v150, a122
  v_accvgpr_read_b32 v151, a123
  v_accvgpr_read_b32 v152, a124
  v_accvgpr_read_b32 v153, a125
  v_accvgpr_read_b32 v154, a126
  v_accvgpr_read_b32 v155, a127
  v_pk_mul_f32 v[148:149], v[148:149], v[10:11] op_sel_hi:[1,0]
  v_pk_mul_f32 v[150:151], v[150:151], v[10:11] op_sel_hi:[1,0]
  v_pk_mul_f32 v[152:153], v[152:153], v[10:11] op_sel_hi:[1,0]
  v_pk_mul_f32 v[154:155], v[154:155], v[10:11] op_sel_hi:[1,0]
  v_cvt_pk_bf16_f32 v156, v148, v149
  v_cvt_pk_bf16_f32 v157, v150, v151
  v_cvt_pk_bf16_f32 v158, v152, v153
  v_cvt_pk_bf16_f32 v159, v154, v155
  buffer_store_dwordx4 v[156:159], v2, s[4:7], s28 offen offset:3072 sc1
  s_branch A_out_31
A_kvw_32:
M_kv_35:
  s_cmp_ge_u32 s17, s36
  s_cbranch_scc1 M_kvok_36
  s_mov_b32 s76, 0
  s_mov_b32 s78, 23
  s_mov_b32 s77, 335872
  s_cmp_eq_u32 s68, 1
  s_cmov_b32 s76, 128
  s_cmov_b32 s78, 27
  s_cmov_b32 s77, 114688
  s_cmp_eq_u32 s68, 2
  s_cmov_b32 s76, 768
  s_cmov_b32 s78, 14
  s_cmov_b32 s77, 0
  s_add_u32 s76, s76, s67
  s_mov_b32 s71, 0
  s_branch M_sg_38
M_sw_37:
  s_sleep 8
  s_add_u32 s71, s71, 1
  s_cmp_gt_u32 s71, 262144
  s_cbranch_scc1 M_exit
M_sg_38:
  s_mov_b32 s79, 0
  s_atomic_or s79, s[72:73], s76 glc
  s_waitcnt lgkmcnt(0)
  s_cmp_lt_u32 s79, s78
  s_cbranch_scc1 M_sw_37
  s_add_u32 s36, s77, s19
  s_add_u32 s68, s68, 1
  s_branch M_kv_35
M_kvok_36:
  s_branch A_kvb_33
A_upd_29:
  s_cmp_eq_u32 s23, 2
  s_cbranch_scc1 A_upd2_39
  v_mov_b32 v12, s24
  v_cmp_le_i32 s[40:41], 0, v5
  v_cmp_le_i32 s[42:43], 1, v5
  v_cmp_le_i32 s[44:45], 2, v5
  v_cmp_le_i32 s[46:47], 3, v5
  v_cndmask_b32 v64, v12, v6, s[40:41]
  v_cndmask_b32 v65, v12, v6, s[42:43]
  v_cndmask_b32 v66, v12, v6, s[44:45]
  v_cndmask_b32 v67, v12, v6, s[46:47]
  v_cmp_le_i32 s[40:41], 8, v5
  v_cmp_le_i32 s[42:43], 9, v5
  v_cmp_le_i32 s[44:45], 10, v5
  v_cmp_le_i32 s[46:47], 11, v5
  v_cndmask_b32 v68, v12, v6, s[40:41]
  v_cndmask_b32 v69, v12, v6, s[42:43]
  v_cndmask_b32 v70, v12, v6, s[44:45]
  v_cndmask_b32 v71, v12, v6, s[46:47]
  v_cmp_le_i32 s[40:41], 16, v5
  v_cmp_le_i32 s[42:43], 17, v5
  v_cmp_le_i32 s[44:45], 18, v5
  v_cmp_le_i32 s[46:47], 19, v5
  v_cndmask_b32 v72, v12, v6, s[40:41]
  v_cndmask_b32 v73, v12, v6, s[42:43]
  v_cndmask_b32 v74, v12, v6, s[44:45]
  v_cndmask_b32 v75, v12, v6, s[46:47]
  v_cmp_le_i32 s[40:41], 24, v5
  v_cmp_le_i32 s[42:43], 25, v5
  v_cmp_le_i32 s[44:45], 26, v5
  v_cmp_le_i32 s[46:47], 27, v5
  v_cndmask_b32 v76, v12, v6, s[40:41]
  v_cndmask_b32 v77, v12, v6, s[42:43]
  v_cndmask_b32 v78, v12, v6, s[44:45]
  v_cndmask_b32 v79, v12, v6, s[46:47]
  v_mov_b32 v80, v7
  v_mov_b32 v81, v7
  v_mov_b32 v82, v7
  v_mov_b32 v83, v7
  v_mov_b32 v84, v7
  v_mov_b32 v85, v7
  v_mov_b32 v86, v7
  v_mov_b32 v87, v7
  v_mov_b32 v88, v7
  v_mov_b32 v89, v7
  v_mov_b32 v90, v7
  v_mov_b32 v91, v7
  v_mov_b32 v92, v7
  v_mov_b32 v93, v7
  v_mov_b32 v94, v7
  v_mov_b32 v95, v7
  s_branch A_back_30
A_upd2_39:
  v_mov_b32 v64, v6
  v_mov_b32 v65, v6
  v_mov_b32 v66, v6
  v_mov_b32 v67, v6
  v_mov_b32 v68, v6
  v_mov_b32 v69, v6
  v_mov_b32 v70, v6
  v_mov_b32 v71, v6
  v_mov_b32 v72, v6
  v_mov_b32 v73, v6
  v_mov_b32 v74, v6
  v_mov_b32 v75, v6
  v_mov_b32 v76, v6
  v_mov_b32 v77, v6
  v_mov_b32 v78, v6
  v_mov_b32 v79, v6
  s_branch A_back_30
A_slow_34:
  s_mov_b32 s29, 1
  v_mov_b32 v64, s24
  v_mov_b32 v65, s24
  v_mov_b32 v66, s24
  v_mov_b32 v67, s24
  v_mov_b32 v68, s24
  v_mov_b32 v69, s24
  v_mov_b32 v70, s24
  v_mov_b32 v71, s24
  v_mov_b32 v72, s24
  v_mov_b32 v73, s24
  v_mov_b32 v74, s24
  v_mov_b32 v75, s24
  v_mov_b32 v76, s24
  v_mov_b32 v77, s24
  v_mov_b32 v78, s24
  v_mov_b32 v79, s24
  v_mov_b32 v12, s24
  v_cmp_le_i32 s[40:41], 0, v5
  v_cmp_le_i32 s[42:43], 1, v5
  v_cmp_le_i32 s[44:45], 2, v5
  v_cmp_le_i32 s[46:47], 3, v5
  v_cndmask_b32 v80, v12, v7, s[40:41]
  v_cndmask_b32 v81, v12, v7, s[42:43]
  v_cndmask_b32 v82, v12, v7, s[44:45]
  v_cndmask_b32 v83, v12, v7, s[46:47]
  v_cmp_le_i32 s[40:41], 8, v5
  v_cmp_le_i32 s[42:43], 9, v5
  v_cmp_le_i32 s[44:45], 10, v5
  v_cmp_le_i32 s[46:47], 11, v5
  v_cndmask_b32 v84, v12, v7, s[40:41]
  v_cndmask_b32 v85, v12, v7, s[42:43]
  v_cndmask_b32 v86, v12, v7, s[44:45]
  v_cndmask_b32 v87, v12, v7, s[46:47]
  v_cmp_le_i32 s[40:41], 16, v5
  v_cmp_le_i32 s[42:43], 17, v5
  v_cmp_le_i32 s[44:45], 18, v5
  v_cmp_le_i32 s[46:47], 19, v5
  v_cndmask_b32 v88, v12, v7, s[40:41]
  v_cndmask_b32 v89, v12, v7, s[42:43]
  v_cndmask_b32 v90, v12, v7, s[44:45]
  v_cndmask_b32 v91, v12, v7, s[46:47]
  v_cmp_le_i32 s[40:41], 24, v5
  v_cmp_le_i32 s[42:43], 25, v5
  v_cmp_le_i32 s[44:45], 26, v5
  v_cmp_le_i32 s[46:47], 27, v5
  v_cndmask_b32 v92, v12, v7, s[40:41]
  v_cndmask_b32 v93, v12, v7, s[42:43]
  v_cndmask_b32 v94, v12, v7, s[44:45]
  v_cndmask_b32 v95, v12, v7, s[46:47]
  v_mov_b32 v8, s24
  v_mov_b32 v10, s24
  s_add_u32 s17, s25, 16785408
  s_mov_b32 s23, 0
A_ml_40:
  s_add_u32 s28, s17, 4096
  buffer_load_dwordx4 a[192:195], v2, s[4:7], s17 offen offset:0 sc1
  buffer_load_dwordx4 a[196:199], v2, s[4:7], s17 offen offset:1024 sc1
  buffer_load_dwordx4 a[200:203], v2, s[4:7], s17 offen offset:2048 sc1
  buffer_load_dwordx4 a[204:207], v2, s[4:7], s17 offen offset:3072 sc1
  buffer_load_dwordx4 a[208:211], v2, s[4:7], s28 offen offset:0 sc1
  buffer_load_dwordx4 a[212:215], v2, s[4:7], s28 offen offset:1024 sc1
  buffer_load_dwordx4 a[216:219], v2, s[4:7], s28 offen offset:2048 sc1
  buffer_load_dwordx4 a[220:223], v2, s[4:7], s28 offen offset:3072 sc1
  s_waitcnt vmcnt(0)
  v_mfma_f32_32x32x16_bf16 v[32:47], a[192:195], a[128:131], v[64:79]
  v_mfma_f32_32x32x16_bf16 v[32:47], a[196:199], a[132:135], v[32:47]
  v_mfma_f32_32x32x16_bf16 v[32:47], a[200:203], a[136:139], v[32:47]
  v_mfma_f32_32x32x16_bf16 v[32:47], a[204:207], a[140:143], v[32:47]
  v_mfma_f32_32x32x16_bf16 v[32:47], a[208:211], a[144:147], v[32:47]
  v_mfma_f32_32x32x16_bf16 v[32:47], a[212:215], a[148:151], v[32:47]
  v_mfma_f32_32x32x16_bf16 v[32:47], a[216:219], a[152:155], v[32:47]
  v_mfma_f32_32x32x16_bf16 v[32:47], a[220:223], a[156:159], v[32:47]
  v_mfma_f32_32x32x16_bf16 v[48:63], a[192:195], a[160:163], v[80:95]
  v_mfma_f32_32x32x16_bf16 v[48:63], a[196:199], a[164:167], v[48:63]
  v_mfma_f32_32x32x16_bf16 v[48:63], a[200:203], a[168:171], v[48:63]
  v_mfma_f32_32x32x16_bf16 v[48:63], a[204:207], a[172:175], v[48:63]
  v_mfma_f32_32x32x16_bf16 v[48:63], a[208:211], a[176:179], v[48:63]
  v_mfma_f32_32x32x16_bf16 v[48:63], a[212:215], a[180:183], v[48:63]
  v_mfma_f32_32x32x16_bf16 v[48:63], a[216:219], a[184:187], v[48:63]
  v_mfma_f32_32x32x16_bf16 v[48:63], a[220:223], a[188:191], v[48:63]
  s_nop 7
  s_nop 3
  v_max3_f32 v8, v8, v32, v33
  v_max3_f32 v8, v8, v34, v35
  v_max3_f32 v8, v8, v36, v37
  v_max3_f32 v8, v8, v38, v39
  v_max3_f32 v8, v8, v40, v41
  v_max3_f32 v8, v8, v42, v43
  v_max3_f32 v8, v8, v44, v45
  v_max3_f32 v8, v8, v46, v47
  v_max3_f32 v10, v10, v48, v49
  v_max3_f32 v10, v10, v50, v51
  v_max3_f32 v10, v10, v52, v53
  v_max3_f32 v10, v10, v54, v55
  v_max3_f32 v10, v10, v56, v57
  v_max3_f32 v10, v10, v58, v59
  v_max3_f32 v10, v10, v60, v61
  v_max3_f32 v10, v10, v62, v63
  s_add_u32 s23, s23, 1
  s_cmp_lg_u32 s23, 1
  s_cbranch_scc1 A_m2_41
  v_mov_b32 v12, s24
  v_cmp_le_i32 s[40:41], 0, v5
  v_cmp_le_i32 s[42:43], 1, v5
  v_cmp_le_i32 s[44:45], 2, v5
  v_cmp_le_i32 s[46:47], 3, v5
  v_cndmask_b32 v64, v12, v6, s[40:41]
  v_cndmask_b32 v65, v12, v6, s[42:43]
  v_cndmask_b32 v66, v12, v6, s[44:45]
  v_cndmask_b32 v67, v12, v6, s[46:47]
  v_cmp_le_i32 s[40:41], 8, v5
  v_cmp_le_i32 s[42:43], 9, v5
  v_cmp_le_i32 s[44:45], 10, v5
  v_cmp_le_i32 s[46:47], 11, v5
  v_cndmask_b32 v68, v12, v6, s[40:41]
  v_cndmask_b32 v69, v12, v6, s[42:43]
  v_cndmask_b32 v70, v12, v6, s[44:45]
  v_cndmask_b32 v71, v12, v6, s[46:47]
  v_cmp_le_i32 s[40:41], 16, v5
  v_cmp_le_i32 s[42:43], 17, v5
  v_cmp_le_i32 s[44:45], 18, v5
  v_cmp_le_i32 s[46:47], 19, v5
  v_cndmask_b32 v72, v12, v6, s[40:41]
  v_cndmask_b32 v73, v12, v6, s[42:43]
  v_cndmask_b32 v74, v12, v6, s[44:45]
  v_cndmask_b32 v75, v12, v6, s[46:47]
  v_cmp_le_i32 s[40:41], 24, v5
  v_cmp_le_i32 s[42:43], 25, v5
  v_cmp_le_i32 s[44:45], 26, v5
  v_cmp_le_i32 s[46:47], 27, v5
  v_cndmask_b32 v76, v12, v6, s[40:41]
  v_cndmask_b32 v77, v12, v6, s[42:43]
  v_cndmask_b32 v78, v12, v6, s[44:45]
  v_cndmask_b32 v79, v12, v6, s[46:47]
  v_mov_b32 v80, v7
  v_mov_b32 v81, v7
  v_mov_b32 v82, v7
  v_mov_b32 v83, v7
  v_mov_b32 v84, v7
  v_mov_b32 v85, v7
  v_mov_b32 v86, v7
  v_mov_b32 v87, v7
  v_mov_b32 v88, v7
  v_mov_b32 v89, v7
  v_mov_b32 v90, v7
  v_mov_b32 v91, v7
  v_mov_b32 v92, v7
  v_mov_b32 v93, v7
  v_mov_b32 v94, v7
  v_mov_b32 v95, v7
A_m2_41:
  s_cmp_lg_u32 s23, 2
  s_cbranch_scc1 A_m3_42
  v_mov_b32 v64, v6
  v_mov_b32 v65, v6
  v_mov_b32 v66, v6
  v_mov_b32 v67, v6
  v_mov_b32 v68, v6
  v_mov_b32 v69, v6
  v_mov_b32 v70, v6
  v_mov_b32 v71, v6
  v_mov_b32 v72, v6
  v_mov_b32 v73, v6
  v_mov_b32 v74, v6
  v_mov_b32 v75, v6
  v_mov_b32 v76, v6
  v_mov_b32 v77, v6
  v_mov_b32 v78, v6
  v_mov_b32 v79, v6
A_m3_42:
  s_sub_u32 s17, s17, 8192
  s_cmp_ge_i32 s17, s19
  s_cbranch_scc1 A_ml_40
  v_mov_b32 v9, v8
  s_nop 1
  v_permlane32_swap_b32 v8, v9
  s_nop 1
  v_max_f32 v8, v8, v9
  v_sub_f32 v6, 0, v8
  v_mov_b32 v11, v10
  s_nop 1
  v_permlane32_swap_b32 v10, v11
  s_nop 1
  v_max_f32 v10, v10, v11
  v_sub_f32 v7, 0, v10
  s_branch A_again_21
A_out_31:
  s_mov_b32 s69, s55
  s_mov_b32 s70, s56
  s_sub_u32 s52, s52, 1
  s_cmp_lg_u32 s52, 0
  s_cbranch_scc1 M_att
  s_waitcnt vmcnt(0)
  s_barrier
  s_mov_b32 s30, 512
  v_mov_b32 v144, s30
  v_min_u32 v145, 1, v0
  v_lshlrev_b32 v145, 30, v145
  buffer_store_dword v144, v145, s[4:7], s31 offen sc1
  s_lshr_b32 s48, s64, 2
  s_bfe_u32 s49, s64, 0x10001
  s_and_b32 s50, s64, 1
  s_mul_i32 s50, s50, 6
  s_add_u32 s50, s50, s65
  s_mov_b32 s51, 12
  s_cmp_lt_u32 s50, 4
  s_cselect_b32 s23, 6, 5
  s_load_dwordx2 s[8:9], s[0:1], 40
  s_lshl_b32 s17, s48, 19
  s_lshl_b32 s26, s49, 2
  s_add_u32 s26, s26, s16
  s_lshl_b32 s27, s26, 7
  s_add_u32 s17, s17, s27
  s_mov_b32 s18, 1024
  s_lshl_b32 s21, s48, 6
  s_add_u32 s21, s21, s50
  s_lshl_b32 s21, s21, 3
  s_add_u32 s21, s21, s26
  s_lshl_b32 s21, s21, 12
  s_add_u32 s21, s21, 150994944
  s_lshl_b32 s22, s51, 15
  s_mov_b32 s24, 1.0
  s_waitcnt lgkmcnt(0)
  s_and_b32 s9, s9, 0xffff
  s_mov_b32 s10, 4194304
  s_mov_b32 s11, 0x20000
  s_mov_b32 s12, s4
  s_mov_b32 s13, s5
  s_mov_b32 s14, 268435456
  s_mov_b32 s15, 0x20000
  s_lshl_b32 s19, s48, 8
  s_add_u32 s19, s19, s50
  s_lshl_b32 s19, s19, 13
  s_add_u32 s19, s19, 100663296
  s_lshl_b32 s20, s51, 13
  s_mul_i32 s26, s16, 524288
  v_add_u32 v8, 0, v2
  v_add_u32 v16, s26, v8
  v_add_u32 v9, 1024, v2
  v_add_u32 v17, s26, v9
  v_add_u32 v10, 2048, v2
  v_add_u32 v18, s26, v10
  v_add_u32 v11, 3072, v2
  v_add_u32 v19, s26, v11
  v_add_u32 v12, 4096, v2
  v_add_u32 v20, s26, v12
  v_add_u32 v13, 5120, v2
  v_add_u32 v21, s26, v13
  v_add_u32 v14, 6144, v2
  v_add_u32 v22, s26, v14
  v_add_u32 v15, 7168, v2
  v_add_u32 v23, s26, v15
  v_lshrrev_b32 v144, 3, v1
  v_mul_lo_u32 v144, v144, s18
  v_and_b32 v145, 7, v1
  v_lshl_add_u32 v144, v145, 4, v144
  s_lshl_b32 s28, s16, 15
  s_add_u32 s28, s28, 32768
  s_lshl_b32 s29, s18, 3
  s_add_u32 m0, s28, 0
  s_nop 0
  buffer_load_dwordx4 v144, s[8:11], s17 offen lds
  s_add_u32 s17, s17, s29
  s_add_u32 m0, s28, 1024
  s_nop 0
  buffer_load_dwordx4 v144, s[8:11], s17 offen lds
  s_add_u32 s17, s17, s29
  s_add_u32 m0, s28, 2048
  s_nop 0
  buffer_load_dwordx4 v144, s[8:11], s17 offen lds
  s_add_u32 s17, s17, s29
  s_add_u32 m0, s28, 3072
  s_nop 0
  buffer_load_dwordx4 v144, s[8:11], s17 offen lds
  s_add_u32 s17, s17, s29
  s_add_u32 m0, s28, 4096
  s_nop 0
  buffer_load_dwordx4 v144, s[8:11], s17 offen lds
  s_add_u32 s17, s17, s29
  s_add_u32 m0, s28, 5120
  s_nop 0
  buffer_load_dwordx4 v144, s[8:11], s17 offen lds
  s_add_u32 s17, s17, s29
  s_add_u32 m0, s28, 6144
  s_nop 0
  buffer_load_dwordx4 v144, s[8:11], s17 offen lds
  s_add_u32 s17, s17, s29
  s_add_u32 m0, s28, 7168
  s_nop 0
  buffer_load_dwordx4 v144, s[8:11], s17 offen lds
  s_add_u32 s17, s17, s29
  s_add_u32 m0, s28, 8192
  s_nop 0
  buffer_load_dwordx4 v144, s[8:11], s17 offen lds
  s_add_u32 s17, s17, s29
  s_add_u32 m0, s28, 9216
  s_nop 0
  buffer_load_dwordx4 v144, s[8:11], s17 offen lds
  s_add_u32 s17, s17, s29
  s_add_u32 m0, s28, 10240
  s_nop 0
  buffer_load_dwordx4 v144, s[8:11], s17 offen lds
  s_add_u32 s17, s17, s29
  s_add_u32 m0, s28, 11264
  s_nop 0
  buffer_load_dwordx4 v144, s[8:11], s17 offen lds
  s_add_u32 s17, s17, s29
  s_add_u32 m0, s28, 12288
  s_nop 0
  buffer_load_dwordx4 v144, s[8:11], s17 offen lds
  s_add_u32 s17, s17, s29
  s_add_u32 m0, s28, 13312
  s_nop 0
  buffer_load_dwordx4 v144, s[8:11], s17 offen lds
  s_add_u32 s17, s17, s29
  s_add_u32 m0, s28, 14336
  s_nop 0
  buffer_load_dwordx4 v144, s[8:11], s17 offen lds
  s_add_u32 s17, s17, s29
  s_add_u32 m0, s28, 15360
  s_nop 0
  buffer_load_dwordx4 v144, s[8:11], s17 offen lds
  s_add_u32 s17, s17, s29
  s_add_u32 m0, s28, 16384
  s_nop 0
  buffer_load_dwordx4 v144, s[8:11], s17 offen lds
  s_add_u32 s17, s17, s29
  s_add_u32 m0, s28, 17408
  s_nop 0
  buffer_load_dwordx4 v144, s[8:11], s17 offen lds
  s_add_u32 s17, s17, s29
  s_add_u32 m0, s28, 18432
  s_nop 0
  buffer_load_dwordx4 v144, s[8:11], s17 offen lds
  s_add_u32 s17, s17, s29
  s_add_u32 m0, s28, 19456
  s_nop 0
  buffer_load_dwordx4 v144, s[8:11], s17 offen lds
  s_add_u32 s17, s17, s29
  s_add_u32 m0, s28, 20480
  s_nop 0
  buffer_load_dwordx4 v144, s[8:11], s17 offen lds
  s_add_u32 s17, s17, s29
  s_add_u32 m0, s28, 21504
  s_nop 0
  buffer_load_dwordx4 v144, s[8:11], s17 offen lds
  s_add_u32 s17, s17, s29
  s_add_u32 m0, s28, 22528
  s_nop 0
  buffer_load_dwordx4 v144, s[8:11], s17 offen lds
  s_add_u32 s17, s17, s29
  s_add_u32 m0, s28, 23552
  s_nop 0
  buffer_load_dwordx4 v144, s[8:11], s17 offen lds
  s_add_u32 s17, s17, s29
  s_add_u32 m0, s28, 24576
  s_nop 0
  buffer_load_dwordx4 v144, s[8:11], s17 offen lds
  s_add_u32 s17, s17, s29
  s_add_u32 m0, s28, 25600
  s_nop 0
  buffer_load_dwordx4 v144, s[8:11], s17 offen lds
  s_add_u32 s17, s17, s29
  s_add_u32 m0, s28, 26624
  s_nop 0
  buffer_load_dwordx4 v144, s[8:11], s17 offen lds
  s_add_u32 s17, s17, s29
  s_add_u32 m0, s28, 27648
  s_nop 0
  buffer_load_dwordx4 v144, s[8:11], s17 offen lds
  s_add_u32 s17, s17, s29
  s_add_u32 m0, s28, 28672
  s_nop 0
  buffer_load_dwordx4 v144, s[8:11], s17 offen lds
  s_add_u32 s17, s17, s29
  s_add_u32 m0, s28, 29696
  s_nop 0
  buffer_load_dwordx4 v144, s[8:11], s17 offen lds
  s_add_u32 s17, s17, s29
  s_add_u32 m0, s28, 30720
  s_nop 0
  buffer_load_dwordx4 v144, s[8:11], s17 offen lds
  s_add_u32 s17, s17, s29
  s_add_u32 m0, s28, 31744
  s_nop 0
  buffer_load_dwordx4 v144, s[8:11], s17 offen lds
  s_add_u32 s17, s17, s29
  v_bfe_u32 v148, v1, 2, 2
  v_lshrrev_b32 v149, 5, v1
  v_lshl_add_u32 v148, v149, 2, v148
  v_lshlrev_b32 v148, 7, v148
  v_bfe_u32 v149, v1, 4, 1
  v_lshl_add_u32 v148, v149, 5, v148
  v_and_b32 v149, 1, v1
  v_lshl_add_u32 v148, v149, 4, v148
  v_bfe_u32 v149, v1, 1, 1
  v_lshl_add_u32 v148, v149, 3, v148
  v_add_u32 v146, s28, v148
  v_add_u32 v147, 1024, v146
  s_waitcnt vmcnt(28)
  ds_read_b64_tr_b16 a[0:1], v146 offset:0
  ds_read_b64_tr_b16 a[2:3], v147 offset:0
  ds_read_b64_tr_b16 a[4:5], v146 offset:64
  ds_read_b64_tr_b16 a[6:7], v147 offset:64
  ds_read_b64_tr_b16 a[8:9], v146 offset:2048
  ds_read_b64_tr_b16 a[10:11], v147 offset:2048
  ds_read_b64_tr_b16 a[12:13], v146 offset:2112
  ds_read_b64_tr_b16 a[14:15], v147 offset:2112
  s_waitcnt lgkmcnt(0)
  s_add_u32 m0, s28, 0
  s_nop 0
  buffer_load_dwordx4 v144, s[8:11], s17 offen lds
  s_add_u32 s17, s17, s29
  s_add_u32 m0, s28, 1024
  s_nop 0
  buffer_load_dwordx4 v144, s[8:11], s17 offen lds
  s_add_u32 s17, s17, s29
  s_add_u32 m0, s28, 2048
  s_nop 0
  buffer_load_dwordx4 v144, s[8:11], s17 offen lds
  s_add_u32 s17, s17, s29
  s_add_u32 m0, s28, 3072
  s_nop 0
  buffer_load_dwordx4 v144, s[8:11], s17 offen lds
  s_add_u32 s17, s17, s29
  s_waitcnt vmcnt(28)
  ds_read_b64_tr_b16 a[16:17], v146 offset:4096
  ds_read_b64_tr_b16 a[18:19], v147 offset:4096
  ds_read_b64_tr_b16 a[20:21], v146 offset:4160
  ds_read_b64_tr_b16 a[22:23], v147 offset:4160
  ds_read_b64_tr_b16 a[24:25], v146 offset:6144
  ds_read_b64_tr_b16 a[26:27], v147 offset:6144
  ds_read_b64_tr_b16 a[28:29], v146 offset:6208
  ds_read_b64_tr_b16 a[30:31], v147 offset:6208
  s_waitcnt lgkmcnt(0)
  s_add_u32 m0, s28, 4096
  s_nop 0
  buffer_load_dwordx4 v144, s[8:11], s17 offen lds
  s_add_u32 s17, s17, s29
  s_add_u32 m0, s28, 5120
  s_nop 0
  buffer_load_dwordx4 v144, s[8:11], s17 offen lds
  s_add_u32 s17, s17, s29
  s_add_u32 m0, s28, 6144
  s_nop 0
  buffer_load_dwordx4 v144, s[8:11], s17 offen lds
  s_add_u32 s17, s17, s29
  s_add_u32 m0, s28, 7168
  s_nop 0
  buffer_load_dwordx4 v144, s[8:11], s17 offen lds
  s_add_u32 s17, s17, s29
  s_waitcnt vmcnt(28)
  ds_read_b64_tr_b16 a[32:33], v146 offset:8192
  ds_read_b64_tr_b16 a[34:35], v147 offset:8192
  ds_read_b64_tr_b16 a[36:37], v146 offset:8256
  ds_read_b64_tr_b16 a[38:39], v147 offset:8256
  ds_read_b64_tr_b16 a[40:41], v146 offset:10240
  ds_read_b64_tr_b16 a[42:43], v147 offset:10240
  ds_read_b64_tr_b16 a[44:45], v146 offset:10304
  ds_read_b64_tr_b16 a[46:47], v147 offset:10304
  s_waitcnt lgkmcnt(0)
  s_add_u32 m0, s28, 8192
  s_nop 0
  buffer_load_dwordx4 v144, s[8:11], s17 offen lds
  s_add_u32 s17, s17, s29
  s_add_u32 m0, s28, 9216
  s_nop 0
  buffer_load_dwordx4 v144, s[8:11], s17 offen lds
  s_add_u32 s17, s17, s29
  s_add_u32 m0, s28, 10240
  s_nop 0
  buffer_load_dwordx4 v144, s[8:11], s17 offen lds
  s_add_u32 s17, s17, s29
  s_add_u32 m0, s28, 11264
  s_nop 0
  buffer_load_dwordx4 v144, s[8:11], s17 offen lds
  s_add_u32 s17, s17, s29
  s_waitcnt vmcnt(28)
  ds_read_b64_tr_b16 a[48:49], v146 offset:12288
  ds_read_b64_tr_b16 a[50:51], v147 offset:12288
  ds_read_b64_tr_b16 a[52:53], v146 offset:12352
  ds_read_b64_tr_b16 a[54:55], v147 offset:12352
  ds_read_b64_tr_b16 a[56:57], v146 offset:14336
  ds_read_b64_tr_b16 a[58:59], v147 offset:14336
  ds_read_b64_tr_b16 a[60:61], v146 offset:14400
  ds_read_b64_tr_b16 a[62:63], v147 offset:14400
  s_waitcnt lgkmcnt(0)
  s_add_u32 m0, s28, 12288
  s_nop 0
  buffer_load_dwordx4 v144, s[8:11], s17 offen lds
  s_add_u32 s17, s17, s29
  s_add_u32 m0, s28, 13312
  s_nop 0
  buffer_load_dwordx4 v144, s[8:11], s17 offen lds
  s_add_u32 s17, s17, s29
  s_add_u32 m0, s28, 14336
  s_nop 0
  buffer_load_dwordx4 v144, s[8:11], s17 offen lds
  s_add_u32 s17, s17, s29
  s_add_u32 m0, s28, 15360
  s_nop 0
  buffer_load_dwordx4 v144, s[8:11], s17 offen lds
  s_add_u32 s17, s17, s29
  s_waitcnt vmcnt(28)
  ds_read_b64_tr_b16 a[64:65], v146 offset:16384
  ds_read_b64_tr_b16 a[66:67], v147 offset:16384
  ds_read_b64_tr_b16 a[68:69], v146 offset:16448
  ds_read_b64_tr_b16 a[70:71], v147 offset:16448
  ds_read_b64_tr_b16 a[72:73], v146 offset:18432
  ds_read_b64_tr_b16 a[74:75], v147 offset:18432
  ds_read_b64_tr_b16 a[76:77], v146 offset:18496
  ds_read_b64_tr_b16 a[78:79], v147 offset:18496
  s_waitcnt lgkmcnt(0)
  s_add_u32 m0, s28, 16384
  s_nop 0
  buffer_load_dwordx4 v144, s[8:11], s17 offen lds
  s_add_u32 s17, s17, s29
  s_add_u32 m0, s28, 17408
  s_nop 0
  buffer_load_dwordx4 v144, s[8:11], s17 offen lds
  s_add_u32 s17, s17, s29
  s_add_u32 m0, s28, 18432
  s_nop 0
  buffer_load_dwordx4 v144, s[8:11], s17 offen lds
  s_add_u32 s17, s17, s29
  s_add_u32 m0, s28, 19456
  s_nop 0
  buffer_load_dwordx4 v144, s[8:11], s17 offen lds
  s_add_u32 s17, s17, s29
  s_waitcnt vmcnt(28)
  ds_read_b64_tr_b16 a[80:81], v146 offset:20480
  ds_read_b64_tr_b16 a[82:83], v147 offset:20480
  ds_read_b64_tr_b16 a[84:85], v146 offset:20544
  ds_read_b64_tr_b16 a[86:87], v147 offset:20544
  ds_read_b64_tr_b16 a[88:89], v146 offset:22528
  ds_read_b64_tr_b16 a[90:91], v147 offset:22528
  ds_read_b64_tr_b16 a[92:93], v146 offset:22592
  ds_read_b64_tr_b16 a[94:95], v147 offset:22592
  s_waitcnt lgkmcnt(0)
  s_add_u32 m0, s28, 20480
  s_nop 0
  buffer_load_dwordx4 v144, s[8:11], s17 offen lds
  s_add_u32 s17, s17, s29
  s_add_u32 m0, s28, 21504
  s_nop 0
  buffer_load_dwordx4 v144, s[8:11], s17 offen lds
  s_add_u32 s17, s17, s29
  s_add_u32 m0, s28, 22528
  s_nop 0
  buffer_load_dwordx4 v144, s[8:11], s17 offen lds
  s_add_u32 s17, s17, s29
  s_add_u32 m0, s28, 23552
  s_nop 0
  buffer_load_dwordx4 v144, s[8:11], s17 offen lds
  s_add_u32 s17, s17, s29
  s_waitcnt vmcnt(28)
  ds_read_b64_tr_b16 a[96:97], v146 offset:24576
  ds_read_b64_tr_b16 a[98:99], v147 offset:24576
  ds_read_b64_tr_b16 a[100:101], v146 offset:24640
  ds_read_b64_tr_b16 a[102:103], v147 offset:24640
  ds_read_b64_tr_b16 a[104:105], v146 offset:26624
  ds_read_b64_tr_b16 a[106:107], v147 offset:26624
  ds_read_b64_tr_b16 a[108:109], v146 offset:26688
  ds_read_b64_tr_b16 a[110:111], v147 offset:26688
  s_waitcnt lgkmcnt(0)
  s_add_u32 m0, s28, 24576
  s_nop 0
  buffer_load_dwordx4 v144, s[8:11], s17 offen lds
  s_add_u32 s17, s17, s29
  s_add_u32 m0, s28, 25600
  s_nop 0
  buffer_load_dwordx4 v144, s[8:11], s17 offen lds
  s_add_u32 s17, s17, s29
  s_add_u32 m0, s28, 26624
  s_nop 0
  buffer_load_dwordx4 v144, s[8:11], s17 offen lds
  s_add_u32 s17, s17, s29
  s_add_u32 m0, s28, 27648
  s_nop 0
  buffer_load_dwordx4 v144, s[8:11], s17 offen lds
  s_add_u32 s17, s17, s29
  s_waitcnt vmcnt(28)
  ds_read_b64_tr_b16 a[112:113], v146 offset:28672
  ds_read_b64_tr_b16 a[114:115], v147 offset:28672
  ds_read_b64_tr_b16 a[116:117], v146 offset:28736
  ds_read_b64_tr_b16 a[118:119], v147 offset:28736
  ds_read_b64_tr_b16 a[120:121], v146 offset:30720
  ds_read_b64_tr_b16 a[122:123], v147 offset:30720
  ds_read_b64_tr_b16 a[124:125], v146 offset:30784
  ds_read_b64_tr_b16 a[126:127], v147 offset:30784
  s_waitcnt lgkmcnt(0)
  s_add_u32 m0, s28, 28672
  s_nop 0
  buffer_load_dwordx4 v144, s[8:11], s17 offen lds
  s_add_u32 s17, s17, s29
  s_add_u32 m0, s28, 29696
  s_nop 0
  buffer_load_dwordx4 v144, s[8:11], s17 offen lds
  s_add_u32 s17, s17, s29
  s_add_u32 m0, s28, 30720
  s_nop 0
  buffer_load_dwordx4 v144, s[8:11], s17 offen lds
  s_add_u32 s17, s17, s29
  s_add_u32 m0, s28, 31744
  s_nop 0
  buffer_load_dwordx4 v144, s[8:11], s17 offen lds
  s_add_u32 s17, s17, s29
  s_waitcnt vmcnt(28)
  ds_read_b64_tr_b16 a[128:129], v146 offset:0
  ds_read_b64_tr_b16 a[130:131], v147 offset:0
  ds_read_b64_tr_b16 a[132:133], v146 offset:64
  ds_read_b64_tr_b16 a[134:135], v147 offset:64
  ds_read_b64_tr_b16 a[136:137], v146 offset:2048
  ds_read_b64_tr_b16 a[138:139], v147 offset:2048
  ds_read_b64_tr_b16 a[140:141], v146 offset:2112
  ds_read_b64_tr_b16 a[142:143], v147 offset:2112
  s_waitcnt lgkmcnt(0)
  s_waitcnt vmcnt(24)
  ds_read_b64_tr_b16 a[144:145], v146 offset:4096
  ds_read_b64_tr_b16 a[146:147], v147 offset:4096
  ds_read_b64_tr_b16 a[148:149], v146 offset:4160
  ds_read_b64_tr_b16 a[150:151], v147 offset:4160
  ds_read_b64_tr_b16 a[152:153], v146 offset:6144
  ds_read_b64_tr_b16 a[154:155], v147 offset:6144
  ds_read_b64_tr_b16 a[156:157], v146 offset:6208
  ds_read_b64_tr_b16 a[158:159], v147 offset:6208
  s_waitcnt lgkmcnt(0)
  s_waitcnt vmcnt(20)
  ds_read_b64_tr_b16 a[160:161], v146 offset:8192
  ds_read_b64_tr_b16 a[162:163], v147 offset:8192
  ds_read_b64_tr_b16 a[164:165], v146 offset:8256
  ds_read_b64_tr_b16 a[166:167], v147 offset:8256
  ds_read_b64_tr_b16 a[168:169], v146 offset:10240
  ds_read_b64_tr_b16 a[170:171], v147 offset:10240
  ds_read_b64_tr_b16 a[172:173], v146 offset:10304
  ds_read_b64_tr_b16 a[174:175], v147 offset:10304
  s_waitcnt lgkmcnt(0)
  s_waitcnt vmcnt(16)
  ds_read_b64_tr_b16 a[176:177], v146 offset:12288
  ds_read_b64_tr_b16 a[178:179], v147 offset:12288
  ds_read_b64_tr_b16 a[180:181], v146 offset:12352
  ds_read_b64_tr_b16 a[182:183], v147 offset:12352
  ds_read_b64_tr_b16 a[184:185], v146 offset:14336
  ds_read_b64_tr_b16 a[186:187], v147 offset:14336
  ds_read_b64_tr_b16 a[188:189], v146 offset:14400
  ds_read_b64_tr_b16 a[190:191], v147 offset:14400
  s_waitcnt lgkmcnt(0)
  s_waitcnt vmcnt(12)
  ds_read_b64_tr_b16 a[192:193], v146 offset:16384
  ds_read_b64_tr_b16 a[194:195], v147 offset:16384
  ds_read_b64_tr_b16 a[196:197], v146 offset:16448
  ds_read_b64_tr_b16 a[198:199], v147 offset:16448
  ds_read_b64_tr_b16 a[200:201], v146 offset:18432
  ds_read_b64_tr_b16 a[202:203], v147 offset:18432
  ds_read_b64_tr_b16 a[204:205], v146 offset:18496
  ds_read_b64_tr_b16 a[206:207], v147 offset:18496
  s_waitcnt lgkmcnt(0)
  s_waitcnt vmcnt(8)
  ds_read_b64_tr_b16 a[208:209], v146 offset:20480
  ds_read_b64_tr_b16 a[210:211], v147 offset:20480
  ds_read_b64_tr_b16 a[212:213], v146 offset:20544
  ds_read_b64_tr_b16 a[214:215], v147 offset:20544
  ds_read_b64_tr_b16 a[216:217], v146 offset:22528
  ds_read_b64_tr_b16 a[218:219], v147 offset:22528
  ds_read_b64_tr_b16 a[220:221], v146 offset:22592
  ds_read_b64_tr_b16 a[222:223], v147 offset:22592
  s_waitcnt lgkmcnt(0)
  s_waitcnt vmcnt(4)
  ds_read_b64_tr_b16 a[224:225], v146 offset:24576
  ds_read_b64_tr_b16 a[226:227], v147 offset:24576
  ds_read_b64_tr_b16 a[228:229], v146 offset:24640
  ds_read_b64_tr_b16 a[230:231], v147 offset:24640
  ds_read_b64_tr_b16 a[232:233], v146 offset:26624
  ds_read_b64_tr_b16 a[234:235], v147 offset:26624
  ds_read_b64_tr_b16 a[236:237], v146 offset:26688
  ds_read_b64_tr_b16 a[238:239], v147 offset:26688
  s_waitcnt lgkmcnt(0)
  s_waitcnt vmcnt(0)
  ds_read_b64_tr_b16 a[240:241], v146 offset:28672
  ds_read_b64_tr_b16 a[242:243], v147 offset:28672
  ds_read_b64_tr_b16 a[244:245], v146 offset:28736
  ds_read_b64_tr_b16 a[246:247], v147 offset:28736
  ds_read_b64_tr_b16 a[248:249], v146 offset:30720
  ds_read_b64_tr_b16 a[250:251], v147 offset:30720
  ds_read_b64_tr_b16 a[252:253], v146 offset:30784
  ds_read_b64_tr_b16 a[254:255], v147 offset:30784
  s_waitcnt lgkmcnt(0)
  v_min_u32 v4, 27, v1
  v_mul_u32_u24 v5, 37, v4
  v_lshrrev_b32 v5, 8, v5
  v_mul_u32_u24 v5, 7, v5
  v_sub_u32 v5, v4, v5
  v_mov_b32 v6, 0x200
  v_cmp_ne_u32 vcc, 6, v5
  s_mul_i32 s76, s48, 3584
  s_add_u32 s76, s76, 148897792
  v_cndmask_b32 v5, 0, v6, vcc
  v_lshl_add_u32 v4, v4, 7, s76
  s_mov_b32 s71, 0
  s_branch M_vg_44
M_vw_43:
  s_sleep 2
  s_add_u32 s71, s71, 1
  s_cmp_gt_u32 s71, 262144
  s_cbranch_scc1 M_exit
M_vg_44:
  buffer_load_dword v6, v4, s[4:7], 0 offen sc1
  s_waitcnt vmcnt(0)
  v_cmp_lt_u32 vcc, v6, v5
  s_cbranch_vccnz M_vw_43
  s_barrier
  s_lshl_b32 s25, s16, 13
  s_add_u32 m0, s25, 0
  s_nop 0
  buffer_load_dwordx4 v16, s[12:15], s19 offen sc1 lds
  s_add_u32 m0, s25, 1024
  s_nop 0
  buffer_load_dwordx4 v17, s[12:15], s19 offen sc1 lds
  s_add_u32 m0, s25, 2048
  s_nop 0
  buffer_load_dwordx4 v18, s[12:15], s19 offen sc1 lds
  s_add_u32 m0, s25, 3072
  s_nop 0
  buffer_load_dwordx4 v19, s[12:15], s19 offen sc1 lds
  s_add_u32 m0, s25, 4096
  s_nop 0
  buffer_load_dwordx4 v20, s[12:15], s19 offen sc1 lds
  s_add_u32 m0, s25, 5120
  s_nop 0
  buffer_load_dwordx4 v21, s[12:15], s19 offen sc1 lds
  s_add_u32 m0, s25, 6144
  s_nop 0
  buffer_load_dwordx4 v22, s[12:15], s19 offen sc1 lds
  s_add_u32 m0, s25, 7168
  s_nop 0
  buffer_load_dwordx4 v23, s[12:15], s19 offen sc1 lds
  s_cmp_gt_u32 s23, 1
  s_cselect_b32 s26, s20, 0
  s_add_u32 s19, s19, s26
  s_add_u32 s25, s25, 32768
  s_and_b32 s25, s25, 0x1ffff
  s_add_u32 m0, s25, 0
  s_nop 0
  buffer_load_dwordx4 v16, s[12:15], s19 offen sc1 lds
  s_add_u32 m0, s25, 1024
  s_nop 0
  buffer_load_dwordx4 v17, s[12:15], s19 offen sc1 lds
  s_add_u32 m0, s25, 2048
  s_nop 0
  buffer_load_dwordx4 v18, s[12:15], s19 offen sc1 lds
  s_add_u32 m0, s25, 3072
  s_nop 0
  buffer_load_dwordx4 v19, s[12:15], s19 offen sc1 lds
  s_add_u32 m0, s25, 4096
  s_nop 0
  buffer_load_dwordx4 v20, s[12:15], s19 offen sc1 lds
  s_add_u32 m0, s25, 5120
  s_nop 0
  buffer_load_dwordx4 v21, s[12:15], s19 offen sc1 lds
  s_add_u32 m0, s25, 6144
  s_nop 0
  buffer_load_dwordx4 v22, s[12:15], s19 offen sc1 lds
  s_add_u32 m0, s25, 7168
  s_nop 0
  buffer_load_dwordx4 v23, s[12:15], s19 offen sc1 lds
  s_cmp_gt_u32 s23, 2
  s_cselect_b32 s26, s20, 0
  s_add_u32 s19, s19, s26
  s_add_u32 s25, s25, 32768
  s_and_b32 s25, s25, 0x1ffff
  s_waitcnt vmcnt(0)
  s_barrier
  s_mov_b32 s27, s21
  v_mov_b32 v7, 0x40000000
  ds_read_b128 v[24:27], v8 offset:0
  ds_read_b128 v[28:31], v9 offset:0
  ds_read_b128 v[32:35], v10 offset:0
  ds_read_b128 v[36:39], v11 offset:0
  ds_read_b128 v[40:43], v12 offset:0
  ds_read_b128 v[44:47], v13 offset:0
.p2align 6
G_top_45:
  s_waitcnt lgkmcnt(5)
  v_mfma_f32_32x32x16_bf16 v[64:79], a[0:3], v[24:27], 0
  s_add_u32 m0, s25, 0
  ds_read_b128 v[48:51], v14 offset:0
  v_mfma_f32_32x32x16_bf16 v[80:95], a[4:7], v[24:27], 0
  s_waitcnt lgkmcnt(5)
  buffer_load_dwordx4 v16, s[12:15], s19 offen sc1 lds
  v_mfma_f32_32x32x16_bf16 v[64:79], a[8:11], v[28:31], v[64:79]
  ds_read_b128 v[52:55], v15 offset:0
  v_mul_f32 v96, s24, v96
  v_mul_f32 v97, s24, v97
  v_mfma_f32_32x32x16_bf16 v[80:95], a[12:15], v[28:31], v[80:95]
  s_waitcnt lgkmcnt(5)
  v_cvt_pk_bf16_f32 v128, v96, v97
  v_mul_f32 v98, s24, v98
  v_mfma_f32_32x32x16_bf16 v[64:79], a[16:19], v[32:35], v[64:79]
  s_add_u32 m0, s25, 1024
  ds_read_b128 v[24:27], v8 offset:8192
  v_mul_f32 v99, s24, v99
  v_cvt_pk_bf16_f32 v129, v98, v99
  v_mfma_f32_32x32x16_bf16 v[80:95], a[20:23], v[32:35], v[80:95]
  s_waitcnt lgkmcnt(5)
  buffer_load_dwordx4 v17, s[12:15], s19 offen sc1 lds
  v_mul_f32 v100, s24, v100
  v_mul_f32 v101, s24, v101
  v_mfma_f32_32x32x16_bf16 v[64:79], a[24:27], v[36:39], v[64:79]
  ds_read_b128 v[28:31], v9 offset:8192
  v_cvt_pk_bf16_f32 v130, v100, v101
  v_mul_f32 v102, s24, v102
  v_mfma_f32_32x32x16_bf16 v[80:95], a[28:31], v[36:39], v[80:95]
  s_waitcnt lgkmcnt(5)
  v_mul_f32 v103, s24, v103
  v_cvt_pk_bf16_f32 v131, v102, v103
  v_mfma_f32_32x32x16_bf16 v[64:79], a[32:35], v[40:43], v[64:79]
  s_add_u32 m0, s25, 2048
  ds_read_b128 v[32:35], v10 offset:8192
  v_mul_f32 v104, s24, v104
  v_mul_f32 v105, s24, v105
  v_mfma_f32_32x32x16_bf16 v[80:95], a[36:39], v[40:43], v[80:95]
  s_waitcnt lgkmcnt(5)
  buffer_load_dwordx4 v18, s[12:15], s19 offen sc1 lds
  v_cvt_pk_bf16_f32 v132, v104, v105
  v_mul_f32 v106, s24, v106
  v_mfma_f32_32x32x16_bf16 v[64:79], a[40:43], v[44:47], v[64:79]
  ds_read_b128 v[36:39], v11 offset:8192
  v_mul_f32 v107, s24, v107
  v_cvt_pk_bf16_f32 v133, v106, v107
  v_mfma_f32_32x32x16_bf16 v[80:95], a[44:47], v[44:47], v[80:95]
  s_waitcnt lgkmcnt(5)
  v_mul_f32 v108, s24, v108
  v_mul_f32 v109, s24, v109
  v_mfma_f32_32x32x16_bf16 v[64:79], a[48:51], v[48:51], v[64:79]
  s_add_u32 m0, s25, 3072
  ds_read_b128 v[40:43], v12 offset:8192
  v_cvt_pk_bf16_f32 v134, v108, v109
  v_mul_f32 v110, s24, v110
  v_mfma_f32_32x32x16_bf16 v[80:95], a[52:55], v[48:51], v[80:95]
  s_waitcnt lgkmcnt(5)
  buffer_load_dwordx4 v19, s[12:15], s19 offen sc1 lds
  v_mul_f32 v111, s24, v111
  v_cvt_pk_bf16_f32 v135, v110, v111
  v_mfma_f32_32x32x16_bf16 v[64:79], a[56:59], v[52:55], v[64:79]
  ds_read_b128 v[44:47], v13 offset:8192
  v_mul_f32 v112, s24, v112
  v_mul_f32 v113, s24, v113
  v_mfma_f32_32x32x16_bf16 v[80:95], a[60:63], v[52:55], v[80:95]
  s_waitcnt lgkmcnt(5)
  v_cvt_pk_bf16_f32 v136, v112, v113
  v_mul_f32 v114, s24, v114
  v_mfma_f32_32x32x16_bf16 v[64:79], a[64:67], v[24:27], v[64:79]
  s_add_u32 m0, s25, 4096
  ds_read_b128 v[48:51], v14 offset:8192
  v_mul_f32 v115, s24, v115
  v_cvt_pk_bf16_f32 v137, v114, v115
  v_mfma_f32_32x32x16_bf16 v[80:95], a[68:71], v[24:27], v[80:95]
  s_waitcnt lgkmcnt(5)
  buffer_load_dwordx4 v20, s[12:15], s19 offen sc1 lds
  v_mul_f32 v116, s24, v116
  v_mul_f32 v117, s24, v117
  v_mfma_f32_32x32x16_bf16 v[64:79], a[72:75], v[28:31], v[64:79]
  ds_read_b128 v[52:55], v15 offset:8192
  v_cvt_pk_bf16_f32 v138, v116, v117
  v_mul_f32 v118, s24, v118
  v_mfma_f32_32x32x16_bf16 v[80:95], a[76:79], v[28:31], v[80:95]
  s_waitcnt lgkmcnt(5)
  v_mul_f32 v119, s24, v119
  v_cvt_pk_bf16_f32 v139, v118, v119
  v_mfma_f32_32x32x16_bf16 v[64:79], a[80:83], v[32:35], v[64:79]
  s_add_u32 m0, s25, 5120
  ds_read_b128 v[24:27], v8 offset:16384
  v_mul_f32 v120, s24, v120
  v_mul_f32 v121, s24, v121
  v_mfma_f32_32x32x16_bf16 v[80:95], a[84:87], v[32:35], v[80:95]
  s_waitcnt lgkmcnt(5)
  buffer_load_dwordx4 v21, s[12:15], s19 offen sc1 lds
  v_cvt_pk_bf16_f32 v140, v120, v121
  v_mul_f32 v122, s24, v122
  v_mfma_f32_32x32x16_bf16 v[64:79], a[88:91], v[36:39], v[64:79]
  ds_read_b128 v[28:31], v9 offset:16384
  v_mul_f32 v123, s24, v123
  v_cvt_pk_bf16_f32 v141, v122, v123
  v_mfma_f32_32x32x16_bf16 v[80:95], a[92:95], v[36:39], v[80:95]
  s_waitcnt lgkmcnt(5)
  v_mul_f32 v124, s24, v124
  v_mul_f32 v125, s24, v125
  v_mfma_f32_32x32x16_bf16 v[64:79], a[96:99], v[40:43], v[64:79]
  s_add_u32 m0, s25, 6144
  ds_read_b128 v[32:35], v10 offset:16384
  v_cvt_pk_bf16_f32 v142, v124, v125
  v_mul_f32 v126, s24, v126
  v_mfma_f32_32x32x16_bf16 v[80:95], a[100:103], v[40:43], v[80:95]
  s_waitcnt lgkmcnt(5)
  buffer_load_dwordx4 v22, s[12:15], s19 offen sc1 lds
  v_mul_f32 v127, s24, v127
  v_cvt_pk_bf16_f32 v143, v126, v127
  v_mfma_f32_32x32x16_bf16 v[64:79], a[104:107], v[44:47], v[64:79]
  ds_read_b128 v[36:39], v11 offset:16384
  v_mfma_f32_32x32x16_bf16 v[80:95], a[108:111], v[44:47], v[80:95]
  s_waitcnt lgkmcnt(5)
  v_mfma_f32_32x32x16_bf16 v[64:79], a[112:115], v[48:51], v[64:79]
  s_add_u32 m0, s25, 7168
  ds_read_b128 v[40:43], v12 offset:16384
  v_mfma_f32_32x32x16_bf16 v[80:95], a[116:119], v[48:51], v[80:95]
  s_waitcnt lgkmcnt(5)
  buffer_load_dwordx4 v23, s[12:15], s19 offen sc1 lds
  v_mfma_f32_32x32x16_bf16 v[64:79], a[120:123], v[52:55], v[64:79]
  s_cmp_gt_u32 s23, 3
  ds_read_b128 v[44:47], v13 offset:16384
  v_mfma_f32_32x32x16_bf16 v[80:95], a[124:127], v[52:55], v[80:95]
  s_waitcnt lgkmcnt(5)
  s_cselect_b32 s26, s20, 0
  v_mfma_f32_32x32x16_bf16 v[64:79], a[128:131], v[24:27], v[64:79]
  s_add_u32 s19, s19, s26
  ds_read_b128 v[48:51], v14 offset:16384
  v_mfma_f32_32x32x16_bf16 v[80:95], a[132:135], v[24:27], v[80:95]
  s_waitcnt lgkmcnt(5)
  s_add_u32 s25, s25, 32768
  v_mfma_f32_32x32x16_bf16 v[64:79], a[136:139], v[28:31], v[64:79]
  s_and_b32 s25, s25, 0x1ffff
  ds_read_b128 v[52:55], v15 offset:16384
  v_mfma_f32_32x32x16_bf16 v[80:95], a[140:143], v[28:31], v[80:95]
  s_waitcnt lgkmcnt(5)
  buffer_store_dwordx4 v[128:131], v7, s[4:7], s21 offen offset:0 sc1
  v_mfma_f32_32x32x16_bf16 v[64:79], a[144:147], v[32:35], v[64:79]
  ds_read_b128 v[24:27], v8 offset:24576
  v_mfma_f32_32x32x16_bf16 v[80:95], a[148:151], v[32:35], v[80:95]
  s_waitcnt lgkmcnt(5)
  v_mfma_f32_32x32x16_bf16 v[64:79], a[152:155], v[36:39], v[64:79]
  ds_read_b128 v[28:31], v9 offset:24576
  v_mfma_f32_32x32x16_bf16 v[80:95], a[156:159], v[36:39], v[80:95]
  s_waitcnt lgkmcnt(5)
  buffer_store_dwordx4 v[132:135], v7, s[4:7], s21 offen offset:1024 sc1
  v_mfma_f32_32x32x16_bf16 v[64:79], a[160:163], v[40:43], v[64:79]
  ds_read_b128 v[32:35], v10 offset:24576
  v_mfma_f32_32x32x16_bf16 v[80:95], a[164:167], v[40:43], v[80:95]
  s_waitcnt lgkmcnt(5)
  v_mfma_f32_32x32x16_bf16 v[64:79], a[168:171], v[44:47], v[64:79]
  ds_read_b128 v[36:39], v11 offset:24576
  v_mfma_f32_32x32x16_bf16 v[80:95], a[172:175], v[44:47], v[80:95]
  s_waitcnt lgkmcnt(5)
  buffer_store_dwordx4 v[136:139], v7, s[4:7], s21 offen offset:2048 sc1
  v_mfma_f32_32x32x16_bf16 v[64:79], a[176:179], v[48:51], v[64:79]
  ds_read_b128 v[40:43], v12 offset:24576
  v_mfma_f32_32x32x16_bf16 v[80:95], a[180:183], v[48:51], v[80:95]
  s_waitcnt lgkmcnt(5)
  v_mfma_f32_32x32x16_bf16 v[64:79], a[184:187], v[52:55], v[64:79]
  ds_read_b128 v[44:47], v13 offset:24576
  v_mfma_f32_32x32x16_bf16 v[80:95], a[188:191], v[52:55], v[80:95]
  s_waitcnt lgkmcnt(5)
  buffer_store_dwordx4 v[140:143], v7, s[4:7], s21 offen offset:3072 sc1
  v_mfma_f32_32x32x16_bf16 v[64:79], a[192:195], v[24:27], v[64:79]
  s_mov_b32 s21, s27
  ds_read_b128 v[48:51], v14 offset:24576
  v_mov_b32 v7, v2
  v_mfma_f32_32x32x16_bf16 v[80:95], a[196:199], v[24:27], v[80:95]
  s_waitcnt lgkmcnt(5)
  v_mfma_f32_32x32x16_bf16 v[64:79], a[200:203], v[28:31], v[64:79]
  s_add_u32 s27, s27, s22
  ds_read_b128 v[52:55], v15 offset:24576
  v_mfma_f32_32x32x16_bf16 v[80:95], a[204:207], v[28:31], v[80:95]
  s_waitcnt lgkmcnt(5)
  s_waitcnt vmcnt(16)
  s_barrier
  v_mfma_f32_32x32x16_bf16 v[64:79], a[208:211], v[32:35], v[64:79]
  ds_read_b128 v[24:27], v8 offset:32768
  v_mfma_f32_32x32x16_bf16 v[80:95], a[212:215], v[32:35], v[80:95]
  s_waitcnt lgkmcnt(5)
  v_mfma_f32_32x32x16_bf16 v[64:79], a[216:219], v[36:39], v[64:79]
  ds_read_b128 v[28:31], v9 offset:32768
  v_mfma_f32_32x32x16_bf16 v[80:95], a[220:223], v[36:39], v[80:95]
  s_waitcnt lgkmcnt(5)
  v_mfma_f32_32x32x16_bf16 v[64:79], a[224:227], v[40:43], v[64:79]
  ds_read_b128 v[32:35], v10 offset:32768
  v_mfma_f32_32x32x16_bf16 v[80:95], a[228:231], v[40:43], v[80:95]
  s_waitcnt lgkmcnt(5)
  v_mfma_f32_32x32x16_bf16 v[64:79], a[232:235], v[44:47], v[64:79]
  ds_read_b128 v[36:39], v11 offset:32768
  v_mfma_f32_32x32x16_bf16 v[80:95], a[236:239], v[44:47], v[80:95]
  s_waitcnt lgkmcnt(5)
  v_mfma_f32_32x32x16_bf16 v[64:79], a[240:243], v[48:51], v[64:79]
  s_sub_u32 s23, s23, 1
  ds_read_b128 v[40:43], v12 offset:32768
  v_mfma_f32_32x32x16_bf16 v[80:95], a[244:247], v[48:51], v[80:95]
  s_waitcnt lgkmcnt(5)
  v_mfma_f32_32x32x16_bf16 v[64:79], a[248:251], v[52:55], v[64:79]
  s_cmp_eq_u32 s23, 0
  ds_read_b128 v[44:47], v13 offset:32768
  v_mfma_f32_32x32x16_bf16 v[80:95], a[252:255], v[52:55], v[80:95]
  s_cbranch_scc1 G_done0_46
  s_waitcnt lgkmcnt(5)
  v_mfma_f32_32x32x16_bf16 v[96:111], a[0:3], v[24:27], 0
  s_add_u32 m0, s25, 0
  ds_read_b128 v[48:51], v14 offset:32768
  v_mfma_f32_32x32x16_bf16 v[112:127], a[4:7], v[24:27], 0
  s_waitcnt lgkmcnt(5)
  buffer_load_dwordx4 v16, s[12:15], s19 offen sc1 lds
  v_mfma_f32_32x32x16_bf16 v[96:111], a[8:11], v[28:31], v[96:111]
  ds_read_b128 v[52:55], v15 offset:32768
  v_mul_f32 v64, s24, v64
  v_mul_f32 v65, s24, v65
  v_mfma_f32_32x32x16_bf16 v[112:127], a[12:15], v[28:31], v[112:127]
  s_waitcnt lgkmcnt(5)
  v_cvt_pk_bf16_f32 v128, v64, v65
  v_mul_f32 v66, s24, v66
  v_mfma_f32_32x32x16_bf16 v[96:111], a[16:19], v[32:35], v[96:111]
  s_add_u32 m0, s25, 1024
  ds_read_b128 v[24:27], v8 offset:40960
  v_mul_f32 v67, s24, v67
  v_cvt_pk_bf16_f32 v129, v66, v67
  v_mfma_f32_32x32x16_bf16 v[112:127], a[20:23], v[32:35], v[112:127]
  s_waitcnt lgkmcnt(5)
  buffer_load_dwordx4 v17, s[12:15], s19 offen sc1 lds
  v_mul_f32 v68, s24, v68
  v_mul_f32 v69, s24, v69
  v_mfma_f32_32x32x16_bf16 v[96:111], a[24:27], v[36:39], v[96:111]
  ds_read_b128 v[28:31], v9 offset:40960
  v_cvt_pk_bf16_f32 v130, v68, v69
  v_mul_f32 v70, s24, v70
  v_mfma_f32_32x32x16_bf16 v[112:127], a[28:31], v[36:39], v[112:127]
  s_waitcnt lgkmcnt(5)
  v_mul_f32 v71, s24, v71
  v_cvt_pk_bf16_f32 v131, v70, v71
  v_mfma_f32_32x32x16_bf16 v[96:111], a[32:35], v[40:43], v[96:111]
  s_add_u32 m0, s25, 2048
  ds_read_b128 v[32:35], v10 offset:40960
  v_mul_f32 v72, s24, v72
  v_mul_f32 v73, s24, v73
  v_mfma_f32_32x32x16_bf16 v[112:127], a[36:39], v[40:43], v[112:127]
  s_waitcnt lgkmcnt(5)
  buffer_load_dwordx4 v18, s[12:15], s19 offen sc1 lds
  v_cvt_pk_bf16_f32 v132, v72, v73
  v_mul_f32 v74, s24, v74
  v_mfma_f32_32x32x16_bf16 v[96:111], a[40:43], v[44:47], v[96:111]
  ds_read_b128 v[36:39], v11 offset:40960
  v_mul_f32 v75, s24, v75
  v_cvt_pk_bf16_f32 v133, v74, v75
  v_mfma_f32_32x32x16_bf16 v[112:127], a[44:47], v[44:47], v[112:127]
  s_waitcnt lgkmcnt(5)
  v_mul_f32 v76, s24, v76
  v_mul_f32 v77, s24, v77
  v_mfma_f32_32x32x16_bf16 v[96:111], a[48:51], v[48:51], v[96:111]
  s_add_u32 m0, s25, 3072
  ds_read_b128 v[40:43], v12 offset:40960
  v_cvt_pk_bf16_f32 v134, v76, v77
  v_mul_f32 v78, s24, v78
  v_mfma_f32_32x32x16_bf16 v[112:127], a[52:55], v[48:51], v[112:127]
  s_waitcnt lgkmcnt(5)
  buffer_load_dwordx4 v19, s[12:15], s19 offen sc1 lds
  v_mul_f32 v79, s24, v79
  v_cvt_pk_bf16_f32 v135, v78, v79
  v_mfma_f32_32x32x16_bf16 v[96:111], a[56:59], v[52:55], v[96:111]
  ds_read_b128 v[44:47], v13 offset:40960
  v_mul_f32 v80, s24, v80
  v_mul_f32 v81, s24, v81
  v_mfma_f32_32x32x16_bf16 v[112:127], a[60:63], v[52:55], v[112:127]
  s_waitcnt lgkmcnt(5)
  v_cvt_pk_bf16_f32 v136, v80, v81
  v_mul_f32 v82, s24, v82
  v_mfma_f32_32x32x16_bf16 v[96:111], a[64:67], v[24:27], v[96:111]
  s_add_u32 m0, s25, 4096
  ds_read_b128 v[48:51], v14 offset:40960
  v_mul_f32 v83, s24, v83
  v_cvt_pk_bf16_f32 v137, v82, v83
  v_mfma_f32_32x32x16_bf16 v[112:127], a[68:71], v[24:27], v[112:127]
  s_waitcnt lgkmcnt(5)
  buffer_load_dwordx4 v20, s[12:15], s19 offen sc1 lds
  v_mul_f32 v84, s24, v84
  v_mul_f32 v85, s24, v85
  v_mfma_f32_32x32x16_bf16 v[96:111], a[72:75], v[28:31], v[96:111]
  ds_read_b128 v[52:55], v15 offset:40960
  v_cvt_pk_bf16_f32 v138, v84, v85
  v_mul_f32 v86, s24, v86
  v_mfma_f32_32x32x16_bf16 v[112:127], a[76:79], v[28:31], v[112:127]
  s_waitcnt lgkmcnt(5)
  v_mul_f32 v87, s24, v87
  v_cvt_pk_bf16_f32 v139, v86, v87
  v_mfma_f32_32x32x16_bf16 v[96:111], a[80:83], v[32:35], v[96:111]
  s_add_u32 m0, s25, 5120
  ds_read_b128 v[24:27], v8 offset:49152
  v_mul_f32 v88, s24, v88
  v_mul_f32 v89, s24, v89
  v_mfma_f32_32x32x16_bf16 v[112:127], a[84:87], v[32:35], v[112:127]
  s_waitcnt lgkmcnt(5)
  buffer_load_dwordx4 v21, s[12:15], s19 offen sc1 lds
  v_cvt_pk_bf16_f32 v140, v88, v89
  v_mul_f32 v90, s24, v90
  v_mfma_f32_32x32x16_bf16 v[96:111], a[88:91], v[36:39], v[96:111]
  ds_read_b128 v[28:31], v9 offset:49152
  v_mul_f32 v91, s24, v91
  v_cvt_pk_bf16_f32 v141, v90, v91
  v_mfma_f32_32x32x16_bf16 v[112:127], a[92:95], v[36:39], v[112:127]
  s_waitcnt lgkmcnt(5)
  v_mul_f32 v92, s24, v92
  v_mul_f32 v93, s24, v93
  v_mfma_f32_32x32x16_bf16 v[96:111], a[96:99], v[40:43], v[96:111]
  s_add_u32 m0, s25, 6144
  ds_read_b128 v[32:35], v10 offset:49152
  v_cvt_pk_bf16_f32 v142, v92, v93
  v_mul_f32 v94, s24, v94
  v_mfma_f32_32x32x16_bf16 v[112:127], a[100:103], v[40:43], v[112:127]
  s_waitcnt lgkmcnt(5)
  buffer_load_dwordx4 v22, s[12:15], s19 offen sc1 lds
  v_mul_f32 v95, s24, v95
  v_cvt_pk_bf16_f32 v143, v94, v95
  v_mfma_f32_32x32x16_bf16 v[96:111], a[104:107], v[44:47], v[96:111]
  ds_read_b128 v[36:39], v11 offset:49152
  v_mfma_f32_32x32x16_bf16 v[112:127], a[108:111], v[44:47], v[112:127]
  s_waitcnt lgkmcnt(5)
  v_mfma_f32_32x32x16_bf16 v[96:111], a[112:115], v[48:51], v[96:111]
  s_add_u32 m0, s25, 7168
  ds_read_b128 v[40:43], v12 offset:49152
  v_mfma_f32_32x32x16_bf16 v[112:127], a[116:119], v[48:51], v[112:127]
  s_waitcnt lgkmcnt(5)
  buffer_load_dwordx4 v23, s[12:15], s19 offen sc1 lds
  v_mfma_f32_32x32x16_bf16 v[96:111], a[120:123], v[52:55], v[96:111]
  s_cmp_gt_u32 s23, 3
  ds_read_b128 v[44:47], v13 offset:49152
  v_mfma_f32_32x32x16_bf16 v[112:127], a[124:127], v[52:55], v[112:127]
  s_waitcnt lgkmcnt(5)
  s_cselect_b32 s26, s20, 0
  v_mfma_f32_32x32x16_bf16 v[96:111], a[128:131], v[24:27], v[96:111]
  s_add_u32 s19, s19, s26
  ds_read_b128 v[48:51], v14 offset:49152
  v_mfma_f32_32x32x16_bf16 v[112:127], a[132:135], v[24:27], v[112:127]
  s_waitcnt lgkmcnt(5)
  s_add_u32 s25, s25, 32768
  v_mfma_f32_32x32x16_bf16 v[96:111], a[136:139], v[28:31], v[96:111]
  s_and_b32 s25, s25, 0x1ffff
  ds_read_b128 v[52:55], v15 offset:49152
  v_mfma_f32_32x32x16_bf16 v[112:127], a[140:143], v[28:31], v[112:127]
  s_waitcnt lgkmcnt(5)
  buffer_store_dwordx4 v[128:131], v7, s[4:7], s21 offen offset:0 sc1
  v_mfma_f32_32x32x16_bf16 v[96:111], a[144:147], v[32:35], v[96:111]
  ds_read_b128 v[24:27], v8 offset:57344
  v_mfma_f32_32x32x16_bf16 v[112:127], a[148:151], v[32:35], v[112:127]
  s_waitcnt lgkmcnt(5)
  v_xor_b32 v8, 0x10000, v8
  v_mfma_f32_32x32x16_bf16 v[96:111], a[152:155], v[36:39], v[96:111]
  ds_read_b128 v[28:31], v9 offset:57344
  v_mfma_f32_32x32x16_bf16 v[112:127], a[156:159], v[36:39], v[112:127]
  s_waitcnt lgkmcnt(5)
  buffer_store_dwordx4 v[132:135], v7, s[4:7], s21 offen offset:1024 sc1
  v_xor_b32 v9, 0x10000, v9
  v_mfma_f32_32x32x16_bf16 v[96:111], a[160:163], v[40:43], v[96:111]
  ds_read_b128 v[32:35], v10 offset:57344
  v_mfma_f32_32x32x16_bf16 v[112:127], a[164:167], v[40:43], v[112:127]
  s_waitcnt lgkmcnt(5)
  v_xor_b32 v10, 0x10000, v10
  v_mfma_f32_32x32x16_bf16 v[96:111], a[168:171], v[44:47], v[96:111]
  ds_read_b128 v[36:39], v11 offset:57344
  v_mfma_f32_32x32x16_bf16 v[112:127], a[172:175], v[44:47], v[112:127]
  s_waitcnt lgkmcnt(5)
  buffer_store_dwordx4 v[136:139], v7, s[4:7], s21 offen offset:2048 sc1
  v_xor_b32 v11, 0x10000, v11
  v_mfma_f32_32x32x16_bf16 v[96:111], a[176:179], v[48:51], v[96:111]
  ds_read_b128 v[40:43], v12 offset:57344
  v_mfma_f32_32x32x16_bf16 v[112:127], a[180:183], v[48:51], v[112:127]
  s_waitcnt lgkmcnt(5)
  v_xor_b32 v12, 0x10000, v12
  v_mfma_f32_32x32x16_bf16 v[96:111], a[184:187], v[52:55], v[96:111]
  ds_read_b128 v[44:47], v13 offset:57344
  v_mfma_f32_32x32x16_bf16 v[112:127], a[188:191], v[52:55], v[112:127]
  s_waitcnt lgkmcnt(5)
  buffer_store_dwordx4 v[140:143], v7, s[4:7], s21 offen offset:3072 sc1
  v_xor_b32 v13, 0x10000, v13
  v_mfma_f32_32x32x16_bf16 v[96:111], a[192:195], v[24:27], v[96:111]
  s_mov_b32 s21, s27
  ds_read_b128 v[48:51], v14 offset:57344
  v_mov_b32 v7, v2
  v_mfma_f32_32x32x16_bf16 v[112:127], a[196:199], v[24:27], v[112:127]
  s_waitcnt lgkmcnt(5)
  v_xor_b32 v14, 0x10000, v14
  v_mfma_f32_32x32x16_bf16 v[96:111], a[200:203], v[28:31], v[96:111]
  s_add_u32 s27, s27, s22
  ds_read_b128 v[52:55], v15 offset:57344
  v_mfma_f32_32x32x16_bf16 v[112:127], a[204:207], v[28:31], v[112:127]
  s_waitcnt lgkmcnt(5)
  s_waitcnt vmcnt(16)
  s_barrier
  v_xor_b32 v15, 0x10000, v15
  v_mfma_f32_32x32x16_bf16 v[96:111], a[208:211], v[32:35], v[96:111]
  ds_read_b128 v[24:27], v8 offset:0
  v_mfma_f32_32x32x16_bf16 v[112:127], a[212:215], v[32:35], v[112:127]
  s_waitcnt lgkmcnt(5)
  v_mfma_f32_32x32x16_bf16 v[96:111], a[216:219], v[36:39], v[96:111]
  ds_read_b128 v[28:31], v9 offset:0
  v_mfma_f32_32x32x16_bf16 v[112:127], a[220:223], v[36:39], v[112:127]
  s_waitcnt lgkmcnt(5)
  v_mfma_f32_32x32x16_bf16 v[96:111], a[224:227], v[40:43], v[96:111]
  ds_read_b128 v[32:35], v10 offset:0
  v_mfma_f32_32x32x16_bf16 v[112:127], a[228:231], v[40:43], v[112:127]
  s_waitcnt lgkmcnt(5)
  v_mfma_f32_32x32x16_bf16 v[96:111], a[232:235], v[44:47], v[96:111]
  ds_read_b128 v[36:39], v11 offset:0
  v_mfma_f32_32x32x16_bf16 v[112:127], a[236:239], v[44:47], v[112:127]
  s_waitcnt lgkmcnt(5)
  v_mfma_f32_32x32x16_bf16 v[96:111], a[240:243], v[48:51], v[96:111]
  s_sub_u32 s23, s23, 1
  ds_read_b128 v[40:43], v12 offset:0
  v_mfma_f32_32x32x16_bf16 v[112:127], a[244:247], v[48:51], v[112:127]
  s_waitcnt lgkmcnt(5)
  v_mfma_f32_32x32x16_bf16 v[96:111], a[248:251], v[52:55], v[96:111]
  s_cmp_eq_u32 s23, 0
  ds_read_b128 v[44:47], v13 offset:0
  v_mfma_f32_32x32x16_bf16 v[112:127], a[252:255], v[52:55], v[112:127]
  s_cbranch_scc1 G_done1_47
  s_branch G_top_45
G_done0_46:
  s_nop 7
  s_nop 3
  v_mul_f32 v64, s24, v64
  v_mul_f32 v65, s24, v65
  v_cvt_pk_bf16_f32 v128, v64, v65
  v_mul_f32 v66, s24, v66
  v_mul_f32 v67, s24, v67
  v_cvt_pk_bf16_f32 v129, v66, v67
  v_mul_f32 v68, s24, v68
  v_mul_f32 v69, s24, v69
  v_cvt_pk_bf16_f32 v130, v68, v69
  v_mul_f32 v70, s24, v70
  v_mul_f32 v71, s24, v71
  v_cvt_pk_bf16_f32 v131, v70, v71
  buffer_store_dwordx4 v[128:131], v7, s[4:7], s21 offen offset:0 sc1
  v_mul_f32 v72, s24, v72
  v_mul_f32 v73, s24, v73
  v_cvt_pk_bf16_f32 v132, v72, v73
  v_mul_f32 v74, s24, v74
  v_mul_f32 v75, s24, v75
  v_cvt_pk_bf16_f32 v133, v74, v75
  v_mul_f32 v76, s24, v76
  v_mul_f32 v77, s24, v77
  v_cvt_pk_bf16_f32 v134, v76, v77
  v_mul_f32 v78, s24, v78
  v_mul_f32 v79, s24, v79
  v_cvt_pk_bf16_f32 v135, v78, v79
  buffer_store_dwordx4 v[132:135], v7, s[4:7], s21 offen offset:1024 sc1
  v_mul_f32 v80, s24, v80
  v_mul_f32 v81, s24, v81
  v_cvt_pk_bf16_f32 v136, v80, v81
  v_mul_f32 v82, s24, v82
  v_mul_f32 v83, s24, v83
  v_cvt_pk_bf16_f32 v137, v82, v83
  v_mul_f32 v84, s24, v84
  v_mul_f32 v85, s24, v85
  v_cvt_pk_bf16_f32 v138, v84, v85
  v_mul_f32 v86, s24, v86
  v_mul_f32 v87, s24, v87
  v_cvt_pk_bf16_f32 v139, v86, v87
  buffer_store_dwordx4 v[136:139], v7, s[4:7], s21 offen offset:2048 sc1
  v_mul_f32 v88, s24, v88
  v_mul_f32 v89, s24, v89
  v_cvt_pk_bf16_f32 v140, v88, v89
  v_mul_f32 v90, s24, v90
  v_mul_f32 v91, s24, v91
  v_cvt_pk_bf16_f32 v141, v90, v91
  v_mul_f32 v92, s24, v92
  v_mul_f32 v93, s24, v93
  v_cvt_pk_bf16_f32 v142, v92, v93
  v_mul_f32 v94, s24, v94
  v_mul_f32 v95, s24, v95
  v_cvt_pk_bf16_f32 v143, v94, v95
  buffer_store_dwordx4 v[140:143], v7, s[4:7], s21 offen offset:3072 sc1
  s_branch G_fin_48
G_done1_47:
  s_nop 7
  s_nop 3
  v_mul_f32 v96, s24, v96
  v_mul_f32 v97, s24, v97
  v_cvt_pk_bf16_f32 v128, v96, v97
  v_mul_f32 v98, s24, v98
  v_mul_f32 v99, s24, v99
  v_cvt_pk_bf16_f32 v129, v98, v99
  v_mul_f32 v100, s24, v100
  v_mul_f32 v101, s24, v101
  v_cvt_pk_bf16_f32 v130, v100, v101
  v_mul_f32 v102, s24, v102
  v_mul_f32 v103, s24, v103
  v_cvt_pk_bf16_f32 v131, v102, v103
  buffer_store_dwordx4 v[128:131], v7, s[4:7], s21 offen offset:0 sc1
  v_mul_f32 v104, s24, v104
  v_mul_f32 v105, s24, v105
  v_cvt_pk_bf16_f32 v132, v104, v105
  v_mul_f32 v106, s24, v106
  v_mul_f32 v107, s24, v107
  v_cvt_pk_bf16_f32 v133, v106, v107
  v_mul_f32 v108, s24, v108
  v_mul_f32 v109, s24, v109
  v_cvt_pk_bf16_f32 v134, v108, v109
  v_mul_f32 v110, s24, v110
  v_mul_f32 v111, s24, v111
  v_cvt_pk_bf16_f32 v135, v110, v111
  buffer_store_dwordx4 v[132:135], v7, s[4:7], s21 offen offset:1024 sc1
  v_mul_f32 v112, s24, v112
  v_mul_f32 v113, s24, v113
  v_cvt_pk_bf16_f32 v136, v112, v113
  v_mul_f32 v114, s24, v114
  v_mul_f32 v115, s24, v115
  v_cvt_pk_bf16_f32 v137, v114, v115
  v_mul_f32 v116, s24, v116
  v_mul_f32 v117, s24, v117
  v_cvt_pk_bf16_f32 v138, v116, v117
  v_mul_f32 v118, s24, v118
  v_mul_f32 v119, s24, v119
  v_cvt_pk_bf16_f32 v139, v118, v119
  buffer_store_dwordx4 v[136:139], v7, s[4:7], s21 offen offset:2048 sc1
  v_mul_f32 v120, s24, v120
  v_mul_f32 v121, s24, v121
  v_cvt_pk_bf16_f32 v140, v120, v121
  v_mul_f32 v122, s24, v122
  v_mul_f32 v123, s24, v123
  v_cvt_pk_bf16_f32 v141, v122, v123
  v_mul_f32 v124, s24, v124
  v_mul_f32 v125, s24, v125
  v_cvt_pk_bf16_f32 v142, v124, v125
  v_mul_f32 v126, s24, v126
  v_mul_f32 v127, s24, v127
  v_cvt_pk_bf16_f32 v143, v126, v127
  buffer_store_dwordx4 v[140:143], v7, s[4:7], s21 offen offset:3072 sc1
G_fin_48:
  s_waitcnt vmcnt(0) lgkmcnt(0)
  s_barrier
  s_waitcnt vmcnt(0)
  s_barrier
  s_mov_b32 s30, 768
  v_mov_b32 v144, s30
  v_min_u32 v145, 1, v0
  v_lshlrev_b32 v145, 30, v145
  buffer_store_dword v144, v145, s[4:7], s31 offen sc1
  s_mul_i32 s50, s64, 6
  s_add_u32 s50, s50, s65
  s_mul_i32 s76, s50, 21846
  s_lshr_b32 s76, s76, 16
  s_mul_i32 s77, s76, 3
  s_add_u32 s51, s50, 64
  s_cmp_eq_u32 s77, s50
  s_cselect_b32 s50, s76, s51
M_fin:
  s_lshr_b32 s48, s50, 2
  s_and_b32 s49, s50, 3
  s_load_dwordx2 s[8:9], s[0:1], 0
  s_load_dwordx2 s[12:13], s[0:1], 104
  s_load_dwordx2 s[32:33], s[0:1], 112
  v_and_b32 v4, 31, v1
  v_lshrrev_b32 v5, 5, v1
  v_lshlrev_b32 v5, 4, v5
  v_lshl_add_u32 v6, v4, 10, v5
  s_lshl_b32 s26, s16, 8
  s_lshl_b32 s27, s48, 15
  s_add_u32 s27, s27, s26
  s_waitcnt lgkmcnt(0)
  s_and_b32 s9, s9, 0xffff
  s_mov_b32 s10, 2097152
  s_mov_b32 s11, 0x20000
  s_and_b32 s13, s13, 0xffff
  s_mov_b32 s14, 1024
  s_mov_b32 s15, 0x20000
  s_and_b32 s33, s33, 0xffff
  s_mov_b32 s34, 2097152
  s_mov_b32 s35, 0x20000
  buffer_load_dwordx4 v[16:19], v6, s[8:11], s27 offen offset:0
  buffer_load_dwordx4 v[48:51], v5, s[12:15], s26 offen offset:0
  buffer_load_dwordx4 v[20:23], v6, s[8:11], s27 offen offset:32
  buffer_load_dwordx4 v[52:55], v5, s[12:15], s26 offen offset:32
  buffer_load_dwordx4 v[24:27], v6, s[8:11], s27 offen offset:64
  buffer_load_dwordx4 v[56:59], v5, s[12:15], s26 offen offset:64
  buffer_load_dwordx4 v[28:31], v6, s[8:11], s27 offen offset:96
  buffer_load_dwordx4 v[60:63], v5, s[12:15], s26 offen offset:96
  buffer_load_dwordx4 v[32:35], v6, s[8:11], s27 offen offset:128
  buffer_load_dwordx4 v[64:67], v5, s[12:15], s26 offen offset:128
  buffer_load_dwordx4 v[36:39], v6, s[8:11], s27 offen offset:160
  buffer_load_dwordx4 v[68:71], v5, s[12:15], s26 offen offset:160
  buffer_load_dwordx4 v[40:43], v6, s[8:11], s27 offen offset:192
  buffer_load_dwordx4 v[72:75], v5, s[12:15], s26 offen offset:192
  buffer_load_dwordx4 v[44:47], v6, s[8:11], s27 offen offset:224
  buffer_load_dwordx4 v[76:79], v5, s[12:15], s26 offen offset:224
  s_lshl_b32 s28, s48, 2
  s_add_u32 s28, s28, s49
  s_lshl_b32 s28, s28, 2
  s_add_u32 s28, s28, s16
  s_lshl_b32 s28, s28, 11
  s_waitcnt vmcnt(14)
  v_mfma_f32_32x32x16_bf16 v[80:95], v[48:51], v[16:19], 0
  s_waitcnt vmcnt(12)
  v_mfma_f32_32x32x16_bf16 v[80:95], v[52:55], v[20:23], v[80:95]
  s_waitcnt vmcnt(10)
  v_mfma_f32_32x32x16_bf16 v[80:95], v[56:59], v[24:27], v[80:95]
  s_waitcnt vmcnt(8)
  v_mfma_f32_32x32x16_bf16 v[80:95], v[60:63], v[28:31], v[80:95]
  s_waitcnt vmcnt(6)
  v_mfma_f32_32x32x16_bf16 v[80:95], v[64:67], v[32:35], v[80:95]
  s_waitcnt vmcnt(4)
  v_mfma_f32_32x32x16_bf16 v[80:95], v[68:71], v[36:39], v[80:95]
  s_waitcnt vmcnt(2)
  v_mfma_f32_32x32x16_bf16 v[80:95], v[72:75], v[40:43], v[80:95]
  s_waitcnt vmcnt(0)
  v_mfma_f32_32x32x16_bf16 v[80:95], v[76:79], v[44:47], v[80:95]
  s_mul_i32 s76, s48, 43
  s_lshr_b32 s76, s76, 9
  s_mul_i32 s76, s76, 12
  s_sub_u32 s76, s48, s76
  s_cmp_ge_u32 s76, 6
  s_addc_u32 s76, s76, 0
  s_and_b32 s77, s49, 2
  s_mul_i32 s77, s77, 7
  s_add_u32 s76, s76, s77
  v_mov_b32 v193, 0x300
  s_lshl_b32 s76, s76, 7
  s_add_u32 s76, s76, 148897792
  v_and_b32 v192, 7, v1
  v_mul_u32_u24 v192, 3584, v192
  v_add_u32 v192, s76, v192
  s_mov_b32 s71, 0
  s_branch M_vg_50
M_vw_49:
  s_sleep 2
  s_add_u32 s71, s71, 1
  s_cmp_gt_u32 s71, 262144
  s_cbranch_scc1 M_exit
M_vg_50:
  buffer_load_dword v194, v192, s[4:7], 0 offen sc1
  s_waitcnt vmcnt(0)
  v_cmp_lt_u32 vcc, v194, v193
  s_cbranch_vccnz M_vw_49
  s_add_u32 s29, s28, 150994944
  buffer_load_dwordx4 v[96:99], v2, s[4:7], s29 offen offset:0 sc1
  buffer_load_dwordx4 v[100:103], v2, s[4:7], s29 offen offset:1024 sc1
  s_add_u32 s29, s28, 153092096
  buffer_load_dwordx4 v[104:107], v2, s[4:7], s29 offen offset:0 sc1
  buffer_load_dwordx4 v[108:111], v2, s[4:7], s29 offen offset:1024 sc1
  s_add_u32 s29, s28, 155189248
  buffer_load_dwordx4 v[112:115], v2, s[4:7], s29 offen offset:0 sc1
  buffer_load_dwordx4 v[116:119], v2, s[4:7], s29 offen offset:1024 sc1
  s_add_u32 s29, s28, 157286400
  buffer_load_dwordx4 v[120:123], v2, s[4:7], s29 offen offset:0 sc1
  buffer_load_dwordx4 v[124:127], v2, s[4:7], s29 offen offset:1024 sc1
  s_add_u32 s29, s28, 159383552
  buffer_load_dwordx4 v[128:131], v2, s[4:7], s29 offen offset:0 sc1
  buffer_load_dwordx4 v[132:135], v2, s[4:7], s29 offen offset:1024 sc1
  s_add_u32 s29, s28, 161480704
  buffer_load_dwordx4 v[136:139], v2, s[4:7], s29 offen offset:0 sc1
  buffer_load_dwordx4 v[140:143], v2, s[4:7], s29 offen offset:1024 sc1
  s_add_u32 s29, s28, 163577856
  buffer_load_dwordx4 v[144:147], v2, s[4:7], s29 offen offset:0 sc1
  buffer_load_dwordx4 v[148:151], v2, s[4:7], s29 offen offset:1024 sc1
  s_add_u32 s29, s28, 165675008
  buffer_load_dwordx4 v[152:155], v2, s[4:7], s29 offen offset:0 sc1
  buffer_load_dwordx4 v[156:159], v2, s[4:7], s29 offen offset:1024 sc1
  v_lshlrev_b32 v7, 4, v4
  s_lshl_b32 s26, s16, 2
  v_add_u32 v4, s26, v7
  s_barrier
  ds_write_b32 v4, v80
  s_waitcnt lgkmcnt(0)
  s_barrier
  ds_read_b128 v[84:87], v7
  s_waitcnt lgkmcnt(0)
  v_add_f32 v80, v84, v85
  v_add_f32 v81, v86, v87
  v_add_f32 v80, v80, v81
  v_mul_f32 v80, 0xbfb8aa3b, v80
  v_exp_f32 v80, v80
  s_nop 0
  v_add_f32 v80, 1.0, v80
  v_rcp_f32 v80, v80
  s_nop 0
  v_sub_f32 v82, 1.0, v80
  s_waitcnt vmcnt(14)
  v_lshlrev_b32 v160, 16, v96
  v_and_b32 v161, 0xffff0000, v96
  v_lshlrev_b32 v162, 16, v97
  v_and_b32 v163, 0xffff0000, v97
  v_lshlrev_b32 v164, 16, v98
  v_and_b32 v165, 0xffff0000, v98
  v_lshlrev_b32 v166, 16, v99
  v_and_b32 v167, 0xffff0000, v99
  v_lshlrev_b32 v168, 16, v100
  v_and_b32 v169, 0xffff0000, v100
  v_lshlrev_b32 v170, 16, v101
  v_and_b32 v171, 0xffff0000, v101
  v_lshlrev_b32 v172, 16, v102
  v_and_b32 v173, 0xffff0000, v102
  v_lshlrev_b32 v174, 16, v103
  v_and_b32 v175, 0xffff0000, v103
  s_waitcnt vmcnt(12)
  v_lshlrev_b32 v8, 16, v104
  v_and_b32 v9, 0xffff0000, v104
  v_pk_add_f32 v[160:161], v[160:161], v[8:9]
  v_lshlrev_b32 v10, 16, v105
  v_and_b32 v11, 0xffff0000, v105
  v_pk_add_f32 v[162:163], v[162:163], v[10:11]
  v_lshlrev_b32 v12, 16, v106
  v_and_b32 v13, 0xffff0000, v106
  v_pk_add_f32 v[164:165], v[164:165], v[12:13]
  v_lshlrev_b32 v14, 16, v107
  v_and_b32 v15, 0xffff0000, v107
  v_pk_add_f32 v[166:167], v[166:167], v[14:15]
  v_lshlrev_b32 v8, 16, v108
  v_and_b32 v9, 0xffff0000, v108
  v_pk_add_f32 v[168:169], v[168:169], v[8:9]
  v_lshlrev_b32 v10, 16, v109
  v_and_b32 v11, 0xffff0000, v109
  v_pk_add_f32 v[170:171], v[170:171], v[10:11]
  v_lshlrev_b32 v12, 16, v110
  v_and_b32 v13, 0xffff0000, v110
  v_pk_add_f32 v[172:173], v[172:173], v[12:13]
  v_lshlrev_b32 v14, 16, v111
  v_and_b32 v15, 0xffff0000, v111
  v_pk_add_f32 v[174:175], v[174:175], v[14:15]
  s_waitcnt vmcnt(10)
  v_lshlrev_b32 v8, 16, v112
  v_and_b32 v9, 0xffff0000, v112
  v_pk_add_f32 v[160:161], v[160:161], v[8:9]
  v_lshlrev_b32 v10, 16, v113
  v_and_b32 v11, 0xffff0000, v113
  v_pk_add_f32 v[162:163], v[162:163], v[10:11]
  v_lshlrev_b32 v12, 16, v114
  v_and_b32 v13, 0xffff0000, v114
  v_pk_add_f32 v[164:165], v[164:165], v[12:13]
  v_lshlrev_b32 v14, 16, v115
  v_and_b32 v15, 0xffff0000, v115
  v_pk_add_f32 v[166:167], v[166:167], v[14:15]
  v_lshlrev_b32 v8, 16, v116
  v_and_b32 v9, 0xffff0000, v116
  v_pk_add_f32 v[168:169], v[168:169], v[8:9]
  v_lshlrev_b32 v10, 16, v117
  v_and_b32 v11, 0xffff0000, v117
  v_pk_add_f32 v[170:171], v[170:171], v[10:11]
  v_lshlrev_b32 v12, 16, v118
  v_and_b32 v13, 0xffff0000, v118
  v_pk_add_f32 v[172:173], v[172:173], v[12:13]
  v_lshlrev_b32 v14, 16, v119
  v_and_b32 v15, 0xffff0000, v119
  v_pk_add_f32 v[174:175], v[174:175], v[14:15]
  s_waitcnt vmcnt(8)
  v_lshlrev_b32 v8, 16, v120
  v_and_b32 v9, 0xffff0000, v120
  v_pk_add_f32 v[160:161], v[160:161], v[8:9]
  v_lshlrev_b32 v10, 16, v121
  v_and_b32 v11, 0xffff0000, v121
  v_pk_add_f32 v[162:163], v[162:163], v[10:11]
  v_lshlrev_b32 v12, 16, v122
  v_and_b32 v13, 0xffff0000, v122
  v_pk_add_f32 v[164:165], v[164:165], v[12:13]
  v_lshlrev_b32 v14, 16, v123
  v_and_b32 v15, 0xffff0000, v123
  v_pk_add_f32 v[166:167], v[166:167], v[14:15]
  v_lshlrev_b32 v8, 16, v124
  v_and_b32 v9, 0xffff0000, v124
  v_pk_add_f32 v[168:169], v[168:169], v[8:9]
  v_lshlrev_b32 v10, 16, v125
  v_and_b32 v11, 0xffff0000, v125
  v_pk_add_f32 v[170:171], v[170:171], v[10:11]
  v_lshlrev_b32 v12, 16, v126
  v_and_b32 v13, 0xffff0000, v126
  v_pk_add_f32 v[172:173], v[172:173], v[12:13]
  v_lshlrev_b32 v14, 16, v127
  v_and_b32 v15, 0xffff0000, v127
  v_pk_add_f32 v[174:175], v[174:175], v[14:15]
  s_waitcnt vmcnt(6)
  v_lshlrev_b32 v8, 16, v128
  v_and_b32 v9, 0xffff0000, v128
  v_pk_add_f32 v[160:161], v[160:161], v[8:9]
  v_lshlrev_b32 v10, 16, v129
  v_and_b32 v11, 0xffff0000, v129
  v_pk_add_f32 v[162:163], v[162:163], v[10:11]
  v_lshlrev_b32 v12, 16, v130
  v_and_b32 v13, 0xffff0000, v130
  v_pk_add_f32 v[164:165], v[164:165], v[12:13]
  v_lshlrev_b32 v14, 16, v131
  v_and_b32 v15, 0xffff0000, v131
  v_pk_add_f32 v[166:167], v[166:167], v[14:15]
  v_lshlrev_b32 v8, 16, v132
  v_and_b32 v9, 0xffff0000, v132
  v_pk_add_f32 v[168:169], v[168:169], v[8:9]
  v_lshlrev_b32 v10, 16, v133
  v_and_b32 v11, 0xffff0000, v133
  v_pk_add_f32 v[170:171], v[170:171], v[10:11]
  v_lshlrev_b32 v12, 16, v134
  v_and_b32 v13, 0xffff0000, v134
  v_pk_add_f32 v[172:173], v[172:173], v[12:13]
  v_lshlrev_b32 v14, 16, v135
  v_and_b32 v15, 0xffff0000, v135
  v_pk_add_f32 v[174:175], v[174:175], v[14:15]
  s_waitcnt vmcnt(4)
  v_lshlrev_b32 v8, 16, v136
  v_and_b32 v9, 0xffff0000, v136
  v_pk_add_f32 v[160:161], v[160:161], v[8:9]
  v_lshlrev_b32 v10, 16, v137
  v_and_b32 v11, 0xffff0000, v137
  v_pk_add_f32 v[162:163], v[162:163], v[10:11]
  v_lshlrev_b32 v12, 16, v138
  v_and_b32 v13, 0xffff0000, v138
  v_pk_add_f32 v[164:165], v[164:165], v[12:13]
  v_lshlrev_b32 v14, 16, v139
  v_and_b32 v15, 0xffff0000, v139
  v_pk_add_f32 v[166:167], v[166:167], v[14:15]
  v_lshlrev_b32 v8, 16, v140
  v_and_b32 v9, 0xffff0000, v140
  v_pk_add_f32 v[168:169], v[168:169], v[8:9]
  v_lshlrev_b32 v10, 16, v141
  v_and_b32 v11, 0xffff0000, v141
  v_pk_add_f32 v[170:171], v[170:171], v[10:11]
  v_lshlrev_b32 v12, 16, v142
  v_and_b32 v13, 0xffff0000, v142
  v_pk_add_f32 v[172:173], v[172:173], v[12:13]
  v_lshlrev_b32 v14, 16, v143
  v_and_b32 v15, 0xffff0000, v143
  v_pk_add_f32 v[174:175], v[174:175], v[14:15]
  s_waitcnt vmcnt(2)
  v_lshlrev_b32 v8, 16, v144
  v_and_b32 v9, 0xffff0000, v144
  v_pk_add_f32 v[160:161], v[160:161], v[8:9]
  v_lshlrev_b32 v10, 16, v145
  v_and_b32 v11, 0xffff0000, v145
  v_pk_add_f32 v[162:163], v[162:163], v[10:11]
  v_lshlrev_b32 v12, 16, v146
  v_and_b32 v13, 0xffff0000, v146
  v_pk_add_f32 v[164:165], v[164:165], v[12:13]
  v_lshlrev_b32 v14, 16, v147
  v_and_b32 v15, 0xffff0000, v147
  v_pk_add_f32 v[166:167], v[166:167], v[14:15]
  v_lshlrev_b32 v8, 16, v148
  v_and_b32 v9, 0xffff0000, v148
  v_pk_add_f32 v[168:169], v[168:169], v[8:9]
  v_lshlrev_b32 v10, 16, v149
  v_and_b32 v11, 0xffff0000, v149
  v_pk_add_f32 v[170:171], v[170:171], v[10:11]
  v_lshlrev_b32 v12, 16, v150
  v_and_b32 v13, 0xffff0000, v150
  v_pk_add_f32 v[172:173], v[172:173], v[12:13]
  v_lshlrev_b32 v14, 16, v151
  v_and_b32 v15, 0xffff0000, v151
  v_pk_add_f32 v[174:175], v[174:175], v[14:15]
  s_waitcnt vmcnt(0)
  v_lshlrev_b32 v8, 16, v152
  v_and_b32 v9, 0xffff0000, v152
  v_pk_add_f32 v[160:161], v[160:161], v[8:9]
  v_lshlrev_b32 v10, 16, v153
  v_and_b32 v11, 0xffff0000, v153
  v_pk_add_f32 v[162:163], v[162:163], v[10:11]
  v_lshlrev_b32 v12, 16, v154
  v_and_b32 v13, 0xffff0000, v154
  v_pk_add_f32 v[164:165], v[164:165], v[12:13]
  v_lshlrev_b32 v14, 16, v155
  v_and_b32 v15, 0xffff0000, v155
  v_pk_add_f32 v[166:167], v[166:167], v[14:15]
  v_lshlrev_b32 v8, 16, v156
  v_and_b32 v9, 0xffff0000, v156
  v_pk_add_f32 v[168:169], v[168:169], v[8:9]
  v_lshlrev_b32 v10, 16, v157
  v_and_b32 v11, 0xffff0000, v157
  v_pk_add_f32 v[170:171], v[170:171], v[10:11]
  v_lshlrev_b32 v12, 16, v158
  v_and_b32 v13, 0xffff0000, v158
  v_pk_add_f32 v[172:173], v[172:173], v[12:13]
  v_lshlrev_b32 v14, 16, v159
  v_and_b32 v15, 0xffff0000, v159
  v_pk_add_f32 v[174:175], v[174:175], v[14:15]
  s_and_b32 s76, s48, 1
  s_lshl_b32 s76, s76, 1
  s_lshr_b32 s77, s49, 1
  s_add_u32 s76, s76, s77
  s_mul_i32 s76, s76, 7
  s_add_u32 s76, s76, 6
  s_lshr_b32 s77, s48, 1
  s_add_u32 s77, s77, 0x201
  v_mov_b32 v193, s77
  s_lshl_b32 s76, s76, 7
  s_add_u32 s76, s76, 148897792
  v_and_b32 v192, 7, v1
  v_mul_u32_u24 v192, 3584, v192
  v_add_u32 v192, s76, v192
  s_mov_b32 s71, 0
  s_branch M_vg_52
M_vw_51:
  s_sleep 2
  s_add_u32 s71, s71, 1
  s_cmp_gt_u32 s71, 262144
  s_cbranch_scc1 M_exit
M_vg_52:
  buffer_load_dword v194, v192, s[4:7], 0 offen sc1
  s_waitcnt vmcnt(0)
  v_cmp_lt_u32 vcc, v194, v193
  s_cbranch_vccnz M_vw_51
  s_add_u32 s29, s28, 167772160
  buffer_load_dwordx4 v[96:99], v2, s[4:7], s29 offen offset:0 sc1
  buffer_load_dwordx4 v[100:103], v2, s[4:7], s29 offen offset:1024 sc1
  s_add_u32 s29, s28, 169869312
  buffer_load_dwordx4 v[104:107], v2, s[4:7], s29 offen offset:0 sc1
  buffer_load_dwordx4 v[108:111], v2, s[4:7], s29 offen offset:1024 sc1
  s_add_u32 s29, s28, 171966464
  buffer_load_dwordx4 v[112:115], v2, s[4:7], s29 offen offset:0 sc1
  buffer_load_dwordx4 v[116:119], v2, s[4:7], s29 offen offset:1024 sc1
  s_add_u32 s29, s28, 174063616
  buffer_load_dwordx4 v[120:123], v2, s[4:7], s29 offen offset:0 sc1
  buffer_load_dwordx4 v[124:127], v2, s[4:7], s29 offen offset:1024 sc1
  s_add_u32 s29, s28, 176160768
  buffer_load_dwordx4 v[128:131], v2, s[4:7], s29 offen offset:0 sc1
  buffer_load_dwordx4 v[132:135], v2, s[4:7], s29 offen offset:1024 sc1
  s_add_u32 s29, s28, 178257920
  buffer_load_dwordx4 v[136:139], v2, s[4:7], s29 offen offset:0 sc1
  buffer_load_dwordx4 v[140:143], v2, s[4:7], s29 offen offset:1024 sc1
  s_add_u32 s29, s28, 180355072
  buffer_load_dwordx4 v[144:147], v2, s[4:7], s29 offen offset:0 sc1
  buffer_load_dwordx4 v[148:151], v2, s[4:7], s29 offen offset:1024 sc1
  s_add_u32 s29, s28, 182452224
  buffer_load_dwordx4 v[152:155], v2, s[4:7], s29 offen offset:0 sc1
  buffer_load_dwordx4 v[156:159], v2, s[4:7], s29 offen offset:1024 sc1
  v_pk_mul_f32 v[160:161], v[160:161], v[80:81] op_sel_hi:[1,0]
  v_pk_mul_f32 v[162:163], v[162:163], v[80:81] op_sel_hi:[1,0]
  v_pk_mul_f32 v[164:165], v[164:165], v[80:81] op_sel_hi:[1,0]
  v_pk_mul_f32 v[166:167], v[166:167], v[80:81] op_sel_hi:[1,0]
  v_pk_mul_f32 v[168:169], v[168:169], v[80:81] op_sel_hi:[1,0]
  v_pk_mul_f32 v[170:171], v[170:171], v[80:81] op_sel_hi:[1,0]
  v_pk_mul_f32 v[172:173], v[172:173], v[80:81] op_sel_hi:[1,0]
  v_pk_mul_f32 v[174:175], v[174:175], v[80:81] op_sel_hi:[1,0]
  s_waitcnt vmcnt(14)
  v_lshlrev_b32 v176, 16, v96
  v_and_b32 v177, 0xffff0000, v96
  v_lshlrev_b32 v178, 16, v97
  v_and_b32 v179, 0xffff0000, v97
  v_lshlrev_b32 v180, 16, v98
  v_and_b32 v181, 0xffff0000, v98
  v_lshlrev_b32 v182, 16, v99
  v_and_b32 v183, 0xffff0000, v99
  v_lshlrev_b32 v184, 16, v100
  v_and_b32 v185, 0xffff0000, v100
  v_lshlrev_b32 v186, 16, v101
  v_and_b32 v187, 0xffff0000, v101
  v_lshlrev_b32 v188, 16, v102
  v_and_b32 v189, 0xffff0000, v102
  v_lshlrev_b32 v190, 16, v103
  v_and_b32 v191, 0xffff0000, v103
  s_waitcnt vmcnt(12)
  v_lshlrev_b32 v8, 16, v104
  v_and_b32 v9, 0xffff0000, v104
  v_pk_add_f32 v[176:177], v[176:177], v[8:9]
  v_lshlrev_b32 v10, 16, v105
  v_and_b32 v11, 0xffff0000, v105
  v_pk_add_f32 v[178:179], v[178:179], v[10:11]
  v_lshlrev_b32 v12, 16, v106
  v_and_b32 v13, 0xffff0000, v106
  v_pk_add_f32 v[180:181], v[180:181], v[12:13]
  v_lshlrev_b32 v14, 16, v107
  v_and_b32 v15, 0xffff0000, v107
  v_pk_add_f32 v[182:183], v[182:183], v[14:15]
  v_lshlrev_b32 v8, 16, v108
  v_and_b32 v9, 0xffff0000, v108
  v_pk_add_f32 v[184:185], v[184:185], v[8:9]
  v_lshlrev_b32 v10, 16, v109
  v_and_b32 v11, 0xffff0000, v109
  v_pk_add_f32 v[186:187], v[186:187], v[10:11]
  v_lshlrev_b32 v12, 16, v110
  v_and_b32 v13, 0xffff0000, v110
  v_pk_add_f32 v[188:189], v[188:189], v[12:13]
  v_lshlrev_b32 v14, 16, v111
  v_and_b32 v15, 0xffff0000, v111
  v_pk_add_f32 v[190:191], v[190:191], v[14:15]
  s_waitcnt vmcnt(10)
  v_lshlrev_b32 v8, 16, v112
  v_and_b32 v9, 0xffff0000, v112
  v_pk_add_f32 v[176:177], v[176:177], v[8:9]
  v_lshlrev_b32 v10, 16, v113
  v_and_b32 v11, 0xffff0000, v113
  v_pk_add_f32 v[178:179], v[178:179], v[10:11]
  v_lshlrev_b32 v12, 16, v114
  v_and_b32 v13, 0xffff0000, v114
  v_pk_add_f32 v[180:181], v[180:181], v[12:13]
  v_lshlrev_b32 v14, 16, v115
  v_and_b32 v15, 0xffff0000, v115
  v_pk_add_f32 v[182:183], v[182:183], v[14:15]
  v_lshlrev_b32 v8, 16, v116
  v_and_b32 v9, 0xffff0000, v116
  v_pk_add_f32 v[184:185], v[184:185], v[8:9]
  v_lshlrev_b32 v10, 16, v117
  v_and_b32 v11, 0xffff0000, v117
  v_pk_add_f32 v[186:187], v[186:187], v[10:11]
  v_lshlrev_b32 v12, 16, v118
  v_and_b32 v13, 0xffff0000, v118
  v_pk_add_f32 v[188:189], v[188:189], v[12:13]
  v_lshlrev_b32 v14, 16, v119
  v_and_b32 v15, 0xffff0000, v119
  v_pk_add_f32 v[190:191], v[190:191], v[14:15]
  s_waitcnt vmcnt(8)
  v_lshlrev_b32 v8, 16, v120
  v_and_b32 v9, 0xffff0000, v120
  v_pk_add_f32 v[176:177], v[176:177], v[8:9]
  v_lshlrev_b32 v10, 16, v121
  v_and_b32 v11, 0xffff0000, v121
  v_pk_add_f32 v[178:179], v[178:179], v[10:11]
  v_lshlrev_b32 v12, 16, v122
  v_and_b32 v13, 0xffff0000, v122
  v_pk_add_f32 v[180:181], v[180:181], v[12:13]
  v_lshlrev_b32 v14, 16, v123
  v_and_b32 v15, 0xffff0000, v123
  v_pk_add_f32 v[182:183], v[182:183], v[14:15]
  v_lshlrev_b32 v8, 16, v124
  v_and_b32 v9, 0xffff0000, v124
  v_pk_add_f32 v[184:185], v[184:185], v[8:9]
  v_lshlrev_b32 v10, 16, v125
  v_and_b32 v11, 0xffff0000, v125
  v_pk_add_f32 v[186:187], v[186:187], v[10:11]
  v_lshlrev_b32 v12, 16, v126
  v_and_b32 v13, 0xffff0000, v126
  v_pk_add_f32 v[188:189], v[188:189], v[12:13]
  v_lshlrev_b32 v14, 16, v127
  v_and_b32 v15, 0xffff0000, v127
  v_pk_add_f32 v[190:191], v[190:191], v[14:15]
  s_waitcnt vmcnt(6)
  v_lshlrev_b32 v8, 16, v128
  v_and_b32 v9, 0xffff0000, v128
  v_pk_add_f32 v[176:177], v[176:177], v[8:9]
  v_lshlrev_b32 v10, 16, v129
  v_and_b32 v11, 0xffff0000, v129
  v_pk_add_f32 v[178:179], v[178:179], v[10:11]
  v_lshlrev_b32 v12, 16, v130
  v_and_b32 v13, 0xffff0000, v130
  v_pk_add_f32 v[180:181], v[180:181], v[12:13]
  v_lshlrev_b32 v14, 16, v131
  v_and_b32 v15, 0xffff0000, v131
  v_pk_add_f32 v[182:183], v[182:183], v[14:15]
  v_lshlrev_b32 v8, 16, v132
  v_and_b32 v9, 0xffff0000, v132
  v_pk_add_f32 v[184:185], v[184:185], v[8:9]
  v_lshlrev_b32 v10, 16, v133
  v_and_b32 v11, 0xffff0000, v133
  v_pk_add_f32 v[186:187], v[186:187], v[10:11]
  v_lshlrev_b32 v12, 16, v134
  v_and_b32 v13, 0xffff0000, v134
  v_pk_add_f32 v[188:189], v[188:189], v[12:13]
  v_lshlrev_b32 v14, 16, v135
  v_and_b32 v15, 0xffff0000, v135
  v_pk_add_f32 v[190:191], v[190:191], v[14:15]
  s_waitcnt vmcnt(4)
  v_lshlrev_b32 v8, 16, v136
  v_and_b32 v9, 0xffff0000, v136
  v_pk_add_f32 v[176:177], v[176:177], v[8:9]
  v_lshlrev_b32 v10, 16, v137
  v_and_b32 v11, 0xffff0000, v137
  v_pk_add_f32 v[178:179], v[178:179], v[10:11]
  v_lshlrev_b32 v12, 16, v138
  v_and_b32 v13, 0xffff0000, v138
  v_pk_add_f32 v[180:181], v[180:181], v[12:13]
  v_lshlrev_b32 v14, 16, v139
  v_and_b32 v15, 0xffff0000, v139
  v_pk_add_f32 v[182:183], v[182:183], v[14:15]
  v_lshlrev_b32 v8, 16, v140
  v_and_b32 v9, 0xffff0000, v140
  v_pk_add_f32 v[184:185], v[184:185], v[8:9]
  v_lshlrev_b32 v10, 16, v141
  v_and_b32 v11, 0xffff0000, v141
  v_pk_add_f32 v[186:187], v[186:187], v[10:11]
  v_lshlrev_b32 v12, 16, v142
  v_and_b32 v13, 0xffff0000, v142
  v_pk_add_f32 v[188:189], v[188:189], v[12:13]
  v_lshlrev_b32 v14, 16, v143
  v_and_b32 v15, 0xffff0000, v143
  v_pk_add_f32 v[190:191], v[190:191], v[14:15]
  s_waitcnt vmcnt(2)
  v_lshlrev_b32 v8, 16, v144
  v_and_b32 v9, 0xffff0000, v144
  v_pk_add_f32 v[176:177], v[176:177], v[8:9]
  v_lshlrev_b32 v10, 16, v145
  v_and_b32 v11, 0xffff0000, v145
  v_pk_add_f32 v[178:179], v[178:179], v[10:11]
  v_lshlrev_b32 v12, 16, v146
  v_and_b32 v13, 0xffff0000, v146
  v_pk_add_f32 v[180:181], v[180:181], v[12:13]
  v_lshlrev_b32 v14, 16, v147
  v_and_b32 v15, 0xffff0000, v147
  v_pk_add_f32 v[182:183], v[182:183], v[14:15]
  v_lshlrev_b32 v8, 16, v148
  v_and_b32 v9, 0xffff0000, v148
  v_pk_add_f32 v[184:185], v[184:185], v[8:9]
  v_lshlrev_b32 v10, 16, v149
  v_and_b32 v11, 0xffff0000, v149
  v_pk_add_f32 v[186:187], v[186:187], v[10:11]
  v_lshlrev_b32 v12, 16, v150
  v_and_b32 v13, 0xffff0000, v150
  v_pk_add_f32 v[188:189], v[188:189], v[12:13]
  v_lshlrev_b32 v14, 16, v151
  v_and_b32 v15, 0xffff0000, v151
  v_pk_add_f32 v[190:191], v[190:191], v[14:15]
  s_waitcnt vmcnt(0)
  v_lshlrev_b32 v8, 16, v152
  v_and_b32 v9, 0xffff0000, v152
  v_pk_add_f32 v[176:177], v[176:177], v[8:9]
  v_lshlrev_b32 v10, 16, v153
  v_and_b32 v11, 0xffff0000, v153
  v_pk_add_f32 v[178:179], v[178:179], v[10:11]
  v_lshlrev_b32 v12, 16, v154
  v_and_b32 v13, 0xffff0000, v154
  v_pk_add_f32 v[180:181], v[180:181], v[12:13]
  v_lshlrev_b32 v14, 16, v155
  v_and_b32 v15, 0xffff0000, v155
  v_pk_add_f32 v[182:183], v[182:183], v[14:15]
  v_lshlrev_b32 v8, 16, v156
  v_and_b32 v9, 0xffff0000, v156
  v_pk_add_f32 v[184:185], v[184:185], v[8:9]
  v_lshlrev_b32 v10, 16, v157
  v_and_b32 v11, 0xffff0000, v157
  v_pk_add_f32 v[186:187], v[186:187], v[10:11]
  v_lshlrev_b32 v12, 16, v158
  v_and_b32 v13, 0xffff0000, v158
  v_pk_add_f32 v[188:189], v[188:189], v[12:13]
  v_lshlrev_b32 v14, 16, v159
  v_and_b32 v15, 0xffff0000, v159
  v_pk_add_f32 v[190:191], v[190:191], v[14:15]
  v_pk_fma_f32 v[160:161], v[176:177], v[82:83], v[160:161] op_sel_hi:[1,0,1]
  v_cvt_pk_bf16_f32 v16, v160, v161
  v_pk_fma_f32 v[162:163], v[178:179], v[82:83], v[162:163] op_sel_hi:[1,0,1]
  v_cvt_pk_bf16_f32 v17, v162, v163
  v_pk_fma_f32 v[164:165], v[180:181], v[82:83], v[164:165] op_sel_hi:[1,0,1]
  v_cvt_pk_bf16_f32 v18, v164, v165
  v_pk_fma_f32 v[166:167], v[182:183], v[82:83], v[166:167] op_sel_hi:[1,0,1]
  v_cvt_pk_bf16_f32 v19, v166, v167
  v_pk_fma_f32 v[168:169], v[184:185], v[82:83], v[168:169] op_sel_hi:[1,0,1]
  v_cvt_pk_bf16_f32 v20, v168, v169
  v_pk_fma_f32 v[170:171], v[186:187], v[82:83], v[170:171] op_sel_hi:[1,0,1]
  v_cvt_pk_bf16_f32 v21, v170, v171
  v_pk_fma_f32 v[172:173], v[188:189], v[82:83], v[172:173] op_sel_hi:[1,0,1]
  v_cvt_pk_bf16_f32 v22, v172, v173
  v_pk_fma_f32 v[174:175], v[190:191], v[82:83], v[174:175] op_sel_hi:[1,0,1]
  v_cvt_pk_bf16_f32 v23, v174, v175
  s_lshl_b32 s26, s49, 2
  s_add_u32 s26, s26, s16
  s_lshl_b32 s26, s26, 6
  s_lshl_b32 s27, s48, 15
  s_add_u32 s26, s26, s27
  buffer_store_dwordx4 v[16:19], v6, s[32:35], s26 offen offset:0
  buffer_store_dwordx4 v[20:23], v6, s[32:35], s26 offen offset:32
  s_cmp_lt_u32 s50, 64
  s_mov_b32 s50, s51
  s_cbranch_scc1 M_fin
  s_branch M_done
M_follow:
  s_lshr_b32 s48, s64, 2
  s_and_b32 s49, s64, 1
  s_bfe_u32 s50, s64, 0x10001
  s_mov_b32 s51, 2
  s_mov_b32 s23, 32
  s_load_dwordx2 s[8:9], s[0:1], 40
  s_lshl_b32 s77, s64, 17
  v_lshlrev_b32 v4, 7, v0
  s_waitcnt lgkmcnt(0)
  s_and_b32 s9, s9, 0xffff
  s_mov_b32 s10, 4194304
  s_mov_b32 s11, 0x20000
  buffer_load_dword v250, v4, s[8:11], s77 offen
  s_add_u32 s77, s77, 32768
  buffer_load_dword v250, v4, s[8:11], s77 offen
  s_add_u32 s77, s77, 32768
  buffer_load_dword v250, v4, s[8:11], s77 offen
  s_add_u32 s77, s77, 32768
  buffer_load_dword v250, v4, s[8:11], s77 offen
  s_add_u32 s77, s77, 32768
  s_load_dwordx2 s[8:9], s[0:1], 88
  s_lshl_b32 s17, s48, 19
  s_lshl_b32 s26, s49, 2
  s_add_u32 s26, s26, s16
  s_lshl_b32 s27, s26, 7
  s_add_u32 s17, s17, s27
  s_mov_b32 s18, 1024
  s_lshl_b32 s21, s48, 6
  s_add_u32 s21, s21, s50
  s_lshl_b32 s21, s21, 3
  s_add_u32 s21, s21, s26
  s_lshl_b32 s21, s21, 12
  s_add_u32 s21, s21, 167772160
  s_lshl_b32 s22, s51, 15
  s_mov_b32 s24, 1.0
  s_waitcnt lgkmcnt(0)
  s_and_b32 s9, s9, 0xffff
  s_mov_b32 s10, 4194304
  s_mov_b32 s11, 0x20000
  s_mul_i32 s26, s16, 0
  v_add_u32 v8, 0, v2
  v_add_u32 v16, s26, v8
  v_add_u32 v9, 1024, v2
  v_add_u32 v17, s26, v9
  v_add_u32 v10, 2048, v2
  v_add_u32 v18, s26, v10
  v_add_u32 v11, 3072, v2
  v_add_u32 v19, s26, v11
  v_add_u32 v12, 4096, v2
  v_add_u32 v20, s26, v12
  v_add_u32 v13, 5120, v2
  v_add_u32 v21, s26, v13
  v_add_u32 v14, 6144, v2
  v_add_u32 v22, s26, v14
  v_add_u32 v15, 7168, v2
  v_add_u32 v23, s26, v15
  v_lshrrev_b32 v144, 3, v1
  v_mul_lo_u32 v144, v144, s18
  v_and_b32 v145, 7, v1
  v_lshl_add_u32 v144, v145, 4, v144
  s_lshl_b32 s28, s16, 15
  s_add_u32 s28, s28, 32768
  s_lshl_b32 s29, s18, 3
  s_add_u32 m0, s28, 0
  s_nop 0
  buffer_load_dwordx4 v144, s[8:11], s17 offen lds
  s_add_u32 s17, s17, s29
  s_add_u32 m0, s28, 1024
  s_nop 0
  buffer_load_dwordx4 v144, s[8:11], s17 offen lds
  s_add_u32 s17, s17, s29
  s_add_u32 m0, s28, 2048
  s_nop 0
  buffer_load_dwordx4 v144, s[8:11], s17 offen lds
  s_add_u32 s17, s17, s29
  s_add_u32 m0, s28, 3072
  s_nop 0
  buffer_load_dwordx4 v144, s[8:11], s17 offen lds
  s_add_u32 s17, s17, s29
  s_add_u32 m0, s28, 4096
  s_nop 0
  buffer_load_dwordx4 v144, s[8:11], s17 offen lds
  s_add_u32 s17, s17, s29
  s_add_u32 m0, s28, 5120
  s_nop 0
  buffer_load_dwordx4 v144, s[8:11], s17 offen lds
  s_add_u32 s17, s17, s29
  s_add_u32 m0, s28, 6144
  s_nop 0
  buffer_load_dwordx4 v144, s[8:11], s17 offen lds
  s_add_u32 s17, s17, s29
  s_add_u32 m0, s28, 7168
  s_nop 0
  buffer_load_dwordx4 v144, s[8:11], s17 offen lds
  s_add_u32 s17, s17, s29
  s_add_u32 m0, s28, 8192
  s_nop 0
  buffer_load_dwordx4 v144, s[8:11], s17 offen lds
  s_add_u32 s17, s17, s29
  s_add_u32 m0, s28, 9216
  s_nop 0
  buffer_load_dwordx4 v144, s[8:11], s17 offen lds
  s_add_u32 s17, s17, s29
  s_add_u32 m0, s28, 10240
  s_nop 0
  buffer_load_dwordx4 v144, s[8:11], s17 offen lds
  s_add_u32 s17, s17, s29
  s_add_u32 m0, s28, 11264
  s_nop 0
  buffer_load_dwordx4 v144, s[8:11], s17 offen lds
  s_add_u32 s17, s17, s29
  s_add_u32 m0, s28, 12288
  s_nop 0
  buffer_load_dwordx4 v144, s[8:11], s17 offen lds
  s_add_u32 s17, s17, s29
  s_add_u32 m0, s28, 13312
  s_nop 0
  buffer_load_dwordx4 v144, s[8:11], s17 offen lds
  s_add_u32 s17, s17, s29
  s_add_u32 m0, s28, 14336
  s_nop 0
  buffer_load_dwordx4 v144, s[8:11], s17 offen lds
  s_add_u32 s17, s17, s29
  s_add_u32 m0, s28, 15360
  s_nop 0
  buffer_load_dwordx4 v144, s[8:11], s17 offen lds
  s_add_u32 s17, s17, s29
  s_add_u32 m0, s28, 16384
  s_nop 0
  buffer_load_dwordx4 v144, s[8:11], s17 offen lds
  s_add_u32 s17, s17, s29
  s_add_u32 m0, s28, 17408
  s_nop 0
  buffer_load_dwordx4 v144, s[8:11], s17 offen lds
  s_add_u32 s17, s17, s29
  s_add_u32 m0, s28, 18432
  s_nop 0
  buffer_load_dwordx4 v144, s[8:11], s17 offen lds
  s_add_u32 s17, s17, s29
  s_add_u32 m0, s28, 19456
  s_nop 0
  buffer_load_dwordx4 v144, s[8:11], s17 offen lds
  s_add_u32 s17, s17, s29
  s_add_u32 m0, s28, 20480
  s_nop 0
  buffer_load_dwordx4 v144, s[8:11], s17 offen lds
  s_add_u32 s17, s17, s29
  s_add_u32 m0, s28, 21504
  s_nop 0
  buffer_load_dwordx4 v144, s[8:11], s17 offen lds
  s_add_u32 s17, s17, s29
  s_add_u32 m0, s28, 22528
  s_nop 0
  buffer_load_dwordx4 v144, s[8:11], s17 offen lds
  s_add_u32 s17, s17, s29
  s_add_u32 m0, s28, 23552
  s_nop 0
  buffer_load_dwordx4 v144, s[8:11], s17 offen lds
  s_add_u32 s17, s17, s29
  s_add_u32 m0, s28, 24576
  s_nop 0
  buffer_load_dwordx4 v144, s[8:11], s17 offen lds
  s_add_u32 s17, s17, s29
  s_add_u32 m0, s28, 25600
  s_nop 0
  buffer_load_dwordx4 v144, s[8:11], s17 offen lds
  s_add_u32 s17, s17, s29
  s_add_u32 m0, s28, 26624
  s_nop 0
  buffer_load_dwordx4 v144, s[8:11], s17 offen lds
  s_add_u32 s17, s17, s29
  s_add_u32 m0, s28, 27648
  s_nop 0
  buffer_load_dwordx4 v144, s[8:11], s17 offen lds
  s_add_u32 s17, s17, s29
  s_add_u32 m0, s28, 28672
  s_nop 0
  buffer_load_dwordx4 v144, s[8:11], s17 offen lds
  s_add_u32 s17, s17, s29
  s_add_u32 m0, s28, 29696
  s_nop 0
  buffer_load_dwordx4 v144, s[8:11], s17 offen lds
  s_add_u32 s17, s17, s29
  s_add_u32 m0, s28, 30720
  s_nop 0
  buffer_load_dwordx4 v144, s[8:11], s17 offen lds
  s_add_u32 s17, s17, s29
  s_add_u32 m0, s28, 31744
  s_nop 0
  buffer_load_dwordx4 v144, s[8:11], s17 offen lds
  s_add_u32 s17, s17, s29
  v_bfe_u32 v148, v1, 2, 2
  v_lshrrev_b32 v149, 5, v1
  v_lshl_add_u32 v148, v149, 2, v148
  v_lshlrev_b32 v148, 7, v148
  v_bfe_u32 v149, v1, 4, 1
  v_lshl_add_u32 v148, v149, 5, v148
  v_and_b32 v149, 1, v1
  v_lshl_add_u32 v148, v149, 4, v148
  v_bfe_u32 v149, v1, 1, 1
  v_lshl_add_u32 v148, v149, 3, v148
  v_add_u32 v146, s28, v148
  v_add_u32 v147, 1024, v146
  s_waitcnt vmcnt(28)
  ds_read_b64_tr_b16 a[0:1], v146 offset:0
  ds_read_b64_tr_b16 a[2:3], v147 offset:0
  ds_read_b64_tr_b16 a[4:5], v146 offset:64
  ds_read_b64_tr_b16 a[6:7], v147 offset:64
  ds_read_b64_tr_b16 a[8:9], v146 offset:2048
  ds_read_b64_tr_b16 a[10:11], v147 offset:2048
  ds_read_b64_tr_b16 a[12:13], v146 offset:2112
  ds_read_b64_tr_b16 a[14:15], v147 offset:2112
  s_waitcnt lgkmcnt(0)
  s_add_u32 m0, s28, 0
  s_nop 0
  buffer_load_dwordx4 v144, s[8:11], s17 offen lds
  s_add_u32 s17, s17, s29
  s_add_u32 m0, s28, 1024
  s_nop 0
  buffer_load_dwordx4 v144, s[8:11], s17 offen lds
  s_add_u32 s17, s17, s29
  s_add_u32 m0, s28, 2048
  s_nop 0
  buffer_load_dwordx4 v144, s[8:11], s17 offen lds
  s_add_u32 s17, s17, s29
  s_add_u32 m0, s28, 3072
  s_nop 0
  buffer_load_dwordx4 v144, s[8:11], s17 offen lds
  s_add_u32 s17, s17, s29
  s_waitcnt vmcnt(28)
  ds_read_b64_tr_b16 a[16:17], v146 offset:4096
  ds_read_b64_tr_b16 a[18:19], v147 offset:4096
  ds_read_b64_tr_b16 a[20:21], v146 offset:4160
  ds_read_b64_tr_b16 a[22:23], v147 offset:4160
  ds_read_b64_tr_b16 a[24:25], v146 offset:6144
  ds_read_b64_tr_b16 a[26:27], v147 offset:6144
  ds_read_b64_tr_b16 a[28:29], v146 offset:6208
  ds_read_b64_tr_b16 a[30:31], v147 offset:6208
  s_waitcnt lgkmcnt(0)
  s_add_u32 m0, s28, 4096
  s_nop 0
  buffer_load_dwordx4 v144, s[8:11], s17 offen lds
  s_add_u32 s17, s17, s29
  s_add_u32 m0, s28, 5120
  s_nop 0
  buffer_load_dwordx4 v144, s[8:11], s17 offen lds
  s_add_u32 s17, s17, s29
  s_add_u32 m0, s28, 6144
  s_nop 0
  buffer_load_dwordx4 v144, s[8:11], s17 offen lds
  s_add_u32 s17, s17, s29
  s_add_u32 m0, s28, 7168
  s_nop 0
  buffer_load_dwordx4 v144, s[8:11], s17 offen lds
  s_add_u32 s17, s17, s29
  s_waitcnt vmcnt(28)
  ds_read_b64_tr_b16 a[32:33], v146 offset:8192
  ds_read_b64_tr_b16 a[34:35], v147 offset:8192
  ds_read_b64_tr_b16 a[36:37], v146 offset:8256
  ds_read_b64_tr_b16 a[38:39], v147 offset:8256
  ds_read_b64_tr_b16 a[40:41], v146 offset:10240
  ds_read_b64_tr_b16 a[42:43], v147 offset:10240
  ds_read_b64_tr_b16 a[44:45], v146 offset:10304
  ds_read_b64_tr_b16 a[46:47], v147 offset:10304
  s_waitcnt lgkmcnt(0)
  s_add_u32 m0, s28, 8192
  s_nop 0
  buffer_load_dwordx4 v144, s[8:11], s17 offen lds
  s_add_u32 s17, s17, s29
  s_add_u32 m0, s28, 9216
  s_nop 0
  buffer_load_dwordx4 v144, s[8:11], s17 offen lds
  s_add_u32 s17, s17, s29
  s_add_u32 m0, s28, 10240
  s_nop 0
  buffer_load_dwordx4 v144, s[8:11], s17 offen lds
  s_add_u32 s17, s17, s29
  s_add_u32 m0, s28, 11264
  s_nop 0
  buffer_load_dwordx4 v144, s[8:11], s17 offen lds
  s_add_u32 s17, s17, s29
  s_waitcnt vmcnt(28)
  ds_read_b64_tr_b16 a[48:49], v146 offset:12288
  ds_read_b64_tr_b16 a[50:51], v147 offset:12288
  ds_read_b64_tr_b16 a[52:53], v146 offset:12352
  ds_read_b64_tr_b16 a[54:55], v147 offset:12352
  ds_read_b64_tr_b16 a[56:57], v146 offset:14336
  ds_read_b64_tr_b16 a[58:59], v147 offset:14336
  ds_read_b64_tr_b16 a[60:61], v146 offset:14400
  ds_read_b64_tr_b16 a[62:63], v147 offset:14400
  s_waitcnt lgkmcnt(0)
  s_add_u32 m0, s28, 12288
  s_nop 0
  buffer_load_dwordx4 v144, s[8:11], s17 offen lds
  s_add_u32 s17, s17, s29
  s_add_u32 m0, s28, 13312
  s_nop 0
  buffer_load_dwordx4 v144, s[8:11], s17 offen lds
  s_add_u32 s17, s17, s29
  s_add_u32 m0, s28, 14336
  s_nop 0
  buffer_load_dwordx4 v144, s[8:11], s17 offen lds
  s_add_u32 s17, s17, s29
  s_add_u32 m0, s28, 15360
  s_nop 0
  buffer_load_dwordx4 v144, s[8:11], s17 offen lds
  s_add_u32 s17, s17, s29
  s_waitcnt vmcnt(28)
  ds_read_b64_tr_b16 a[64:65], v146 offset:16384
  ds_read_b64_tr_b16 a[66:67], v147 offset:16384
  ds_read_b64_tr_b16 a[68:69], v146 offset:16448
  ds_read_b64_tr_b16 a[70:71], v147 offset:16448
  ds_read_b64_tr_b16 a[72:73], v146 offset:18432
  ds_read_b64_tr_b16 a[74:75], v147 offset:18432
  ds_read_b64_tr_b16 a[76:77], v146 offset:18496
  ds_read_b64_tr_b16 a[78:79], v147 offset:18496
  s_waitcnt lgkmcnt(0)
  s_add_u32 m0, s28, 16384
  s_nop 0
  buffer_load_dwordx4 v144, s[8:11], s17 offen lds
  s_add_u32 s17, s17, s29
  s_add_u32 m0, s28, 17408
  s_nop 0
  buffer_load_dwordx4 v144, s[8:11], s17 offen lds
  s_add_u32 s17, s17, s29
  s_add_u32 m0, s28, 18432
  s_nop 0
  buffer_load_dwordx4 v144, s[8:11], s17 offen lds
  s_add_u32 s17, s17, s29
  s_add_u32 m0, s28, 19456
  s_nop 0
  buffer_load_dwordx4 v144, s[8:11], s17 offen lds
  s_add_u32 s17, s17, s29
  s_waitcnt vmcnt(28)
  ds_read_b64_tr_b16 a[80:81], v146 offset:20480
  ds_read_b64_tr_b16 a[82:83], v147 offset:20480
  ds_read_b64_tr_b16 a[84:85], v146 offset:20544
  ds_read_b64_tr_b16 a[86:87], v147 offset:20544
  ds_read_b64_tr_b16 a[88:89], v146 offset:22528
  ds_read_b64_tr_b16 a[90:91], v147 offset:22528
  ds_read_b64_tr_b16 a[92:93], v146 offset:22592
  ds_read_b64_tr_b16 a[94:95], v147 offset:22592
  s_waitcnt lgkmcnt(0)
  s_add_u32 m0, s28, 20480
  s_nop 0
  buffer_load_dwordx4 v144, s[8:11], s17 offen lds
  s_add_u32 s17, s17, s29
  s_add_u32 m0, s28, 21504
  s_nop 0
  buffer_load_dwordx4 v144, s[8:11], s17 offen lds
  s_add_u32 s17, s17, s29
  s_add_u32 m0, s28, 22528
  s_nop 0
  buffer_load_dwordx4 v144, s[8:11], s17 offen lds
  s_add_u32 s17, s17, s29
  s_add_u32 m0, s28, 23552
  s_nop 0
  buffer_load_dwordx4 v144, s[8:11], s17 offen lds
  s_add_u32 s17, s17, s29
  s_waitcnt vmcnt(28)
  ds_read_b64_tr_b16 a[96:97], v146 offset:24576
  ds_read_b64_tr_b16 a[98:99], v147 offset:24576
  ds_read_b64_tr_b16 a[100:101], v146 offset:24640
  ds_read_b64_tr_b16 a[102:103], v147 offset:24640
  ds_read_b64_tr_b16 a[104:105], v146 offset:26624
  ds_read_b64_tr_b16 a[106:107], v147 offset:26624
  ds_read_b64_tr_b16 a[108:109], v146 offset:26688
  ds_read_b64_tr_b16 a[110:111], v147 offset:26688
  s_waitcnt lgkmcnt(0)
  s_add_u32 m0, s28, 24576
  s_nop 0
  buffer_load_dwordx4 v144, s[8:11], s17 offen lds
  s_add_u32 s17, s17, s29
  s_add_u32 m0, s28, 25600
  s_nop 0
  buffer_load_dwordx4 v144, s[8:11], s17 offen lds
  s_add_u32 s17, s17, s29
  s_add_u32 m0, s28, 26624
  s_nop 0
  buffer_load_dwordx4 v144, s[8:11], s17 offen lds
  s_add_u32 s17, s17, s29
  s_add_u32 m0, s28, 27648
  s_nop 0
  buffer_load_dwordx4 v144, s[8:11], s17 offen lds
  s_add_u32 s17, s17, s29
  s_waitcnt vmcnt(28)
  ds_read_b64_tr_b16 a[112:113], v146 offset:28672
  ds_read_b64_tr_b16 a[114:115], v147 offset:28672
  ds_read_b64_tr_b16 a[116:117], v146 offset:28736
  ds_read_b64_tr_b16 a[118:119], v147 offset:28736
  ds_read_b64_tr_b16 a[120:121], v146 offset:30720
  ds_read_b64_tr_b16 a[122:123], v147 offset:30720
  ds_read_b64_tr_b16 a[124:125], v146 offset:30784
  ds_read_b64_tr_b16 a[126:127], v147 offset:30784
  s_waitcnt lgkmcnt(0)
  s_add_u32 m0, s28, 28672
  s_nop 0
  buffer_load_dwordx4 v144, s[8:11], s17 offen lds
  s_add_u32 s17, s17, s29
  s_add_u32 m0, s28, 29696
  s_nop 0
  buffer_load_dwordx4 v144, s[8:11], s17 offen lds
  s_add_u32 s17, s17, s29
  s_add_u32 m0, s28, 30720
  s_nop 0
  buffer_load_dwordx4 v144, s[8:11], s17 offen lds
  s_add_u32 s17, s17, s29
  s_add_u32 m0, s28, 31744
  s_nop 0
  buffer_load_dwordx4 v144, s[8:11], s17 offen lds
  s_add_u32 s17, s17, s29
  s_waitcnt vmcnt(28)
  ds_read_b64_tr_b16 a[128:129], v146 offset:0
  ds_read_b64_tr_b16 a[130:131], v147 offset:0
  ds_read_b64_tr_b16 a[132:133], v146 offset:64
  ds_read_b64_tr_b16 a[134:135], v147 offset:64
  ds_read_b64_tr_b16 a[136:137], v146 offset:2048
  ds_read_b64_tr_b16 a[138:139], v147 offset:2048
  ds_read_b64_tr_b16 a[140:141], v146 offset:2112
  ds_read_b64_tr_b16 a[142:143], v147 offset:2112
  s_waitcnt lgkmcnt(0)
  s_waitcnt vmcnt(24)
  ds_read_b64_tr_b16 a[144:145], v146 offset:4096
  ds_read_b64_tr_b16 a[146:147], v147 offset:4096
  ds_read_b64_tr_b16 a[148:149], v146 offset:4160
  ds_read_b64_tr_b16 a[150:151], v147 offset:4160
  ds_read_b64_tr_b16 a[152:153], v146 offset:6144
  ds_read_b64_tr_b16 a[154:155], v147 offset:6144
  ds_read_b64_tr_b16 a[156:157], v146 offset:6208
  ds_read_b64_tr_b16 a[158:159], v147 offset:6208
  s_waitcnt lgkmcnt(0)
  s_waitcnt vmcnt(20)
  ds_read_b64_tr_b16 a[160:161], v146 offset:8192
  ds_read_b64_tr_b16 a[162:163], v147 offset:8192
  ds_read_b64_tr_b16 a[164:165], v146 offset:8256
  ds_read_b64_tr_b16 a[166:167], v147 offset:8256
  ds_read_b64_tr_b16 a[168:169], v146 offset:10240
  ds_read_b64_tr_b16 a[170:171], v147 offset:10240
  ds_read_b64_tr_b16 a[172:173], v146 offset:10304
  ds_read_b64_tr_b16 a[174:175], v147 offset:10304
  s_waitcnt lgkmcnt(0)
  s_waitcnt vmcnt(16)
  ds_read_b64_tr_b16 a[176:177], v146 offset:12288
  ds_read_b64_tr_b16 a[178:179], v147 offset:12288
  ds_read_b64_tr_b16 a[180:181], v146 offset:12352
  ds_read_b64_tr_b16 a[182:183], v147 offset:12352
  ds_read_b64_tr_b16 a[184:185], v146 offset:14336
  ds_read_b64_tr_b16 a[186:187], v147 offset:14336
  ds_read_b64_tr_b16 a[188:189], v146 offset:14400
  ds_read_b64_tr_b16 a[190:191], v147 offset:14400
  s_waitcnt lgkmcnt(0)
  s_waitcnt vmcnt(12)
  ds_read_b64_tr_b16 a[192:193], v146 offset:16384
  ds_read_b64_tr_b16 a[194:195], v147 offset:16384
  ds_read_b64_tr_b16 a[196:197], v146 offset:16448
  ds_read_b64_tr_b16 a[198:199], v147 offset:16448
  ds_read_b64_tr_b16 a[200:201], v146 offset:18432
  ds_read_b64_tr_b16 a[202:203], v147 offset:18432
  ds_read_b64_tr_b16 a[204:205], v146 offset:18496
  ds_read_b64_tr_b16 a[206:207], v147 offset:18496
  s_waitcnt lgkmcnt(0)
  s_waitcnt vmcnt(8)
  ds_read_b64_tr_b16 a[208:209], v146 offset:20480
  ds_read_b64_tr_b16 a[210:211], v147 offset:20480
  ds_read_b64_tr_b16 a[212:213], v146 offset:20544
  ds_read_b64_tr_b16 a[214:215], v147 offset:20544
  ds_read_b64_tr_b16 a[216:217], v146 offset:22528
  ds_read_b64_tr_b16 a[218:219], v147 offset:22528
  ds_read_b64_tr_b16 a[220:221], v146 offset:22592
  ds_read_b64_tr_b16 a[222:223], v147 offset:22592
  s_waitcnt lgkmcnt(0)
  s_waitcnt vmcnt(4)
  ds_read_b64_tr_b16 a[224:225], v146 offset:24576
  ds_read_b64_tr_b16 a[226:227], v147 offset:24576
  ds_read_b64_tr_b16 a[228:229], v146 offset:24640
  ds_read_b64_tr_b16 a[230:231], v147 offset:24640
  ds_read_b64_tr_b16 a[232:233], v146 offset:26624
  ds_read_b64_tr_b16 a[234:235], v147 offset:26624
  ds_read_b64_tr_b16 a[236:237], v146 offset:26688
  ds_read_b64_tr_b16 a[238:239], v147 offset:26688
  s_waitcnt lgkmcnt(0)
  s_waitcnt vmcnt(0)
  ds_read_b64_tr_b16 a[240:241], v146 offset:28672
  ds_read_b64_tr_b16 a[242:243], v147 offset:28672
  ds_read_b64_tr_b16 a[244:245], v146 offset:28736
  ds_read_b64_tr_b16 a[246:247], v147 offset:28736
  ds_read_b64_tr_b16 a[248:249], v146 offset:30720
  ds_read_b64_tr_b16 a[250:251], v147 offset:30720
  ds_read_b64_tr_b16 a[252:253], v146 offset:30784
  ds_read_b64_tr_b16 a[254:255], v147 offset:30784
  s_waitcnt lgkmcnt(0)
  s_lshl_b32 s26, s48, 2
  s_add_u32 s26, s26, s16
  s_lshl_b32 s27, s26, 6
  s_add_u32 s27, s27, s50
  s_lshl_b32 s19, s27, 13
  s_lshl_b32 s27, s50, 5
  s_add_u32 s27, s27, s26
  s_mul_i32 s27, s27, 4608
  s_add_u32 s20, s27, 134217728
  s_lshl_b32 s25, s16, 12
  s_add_u32 s25, s25, 65536
  s_lshl_b32 s26, s16, 13
  v_add_u32 v3, s26, v2
  v_lshrrev_b32 v16, 5, v1
  v_and_b32 v17, 31, v1
  v_mul_u32_u24 v18, 1152, v16
  v_lshl_add_u32 v5, v17, 3, v18
  v_bfe_u32 v18, v1, 2, 2
  v_lshl_add_u32 v18, v16, 2, v18
  v_and_b32 v19, 1, v1
  v_mul_u32_u24 v19, 1152, v19
  v_lshl_add_u32 v18, v18, 3, v19
  v_add_u32 v4, s25, v18
  v_lshlrev_b32 v16, 2, v16
  v_sub_u32 v17, v17, v16
  v_mov_b32 v18, 0xf149f2ca
  v_cmp_le_i32 vcc, 0, v17
  s_nop 1
  v_cndmask_b32 v240, v18, 0, vcc
  v_cmp_le_i32 vcc, 1, v17
  s_nop 1
  v_cndmask_b32 v241, v18, 0, vcc
  v_cmp_le_i32 vcc, 2, v17
  s_nop 1
  v_cndmask_b32 v242, v18, 0, vcc
  v_cmp_le_i32 vcc, 3, v17
  s_nop 1
  v_cndmask_b32 v243, v18, 0, vcc
  v_cmp_le_i32 vcc, 8, v17
  s_nop 1
  v_cndmask_b32 v244, v18, 0, vcc
  v_cmp_le_i32 vcc, 9, v17
  s_nop 1
  v_cndmask_b32 v245, v18, 0, vcc
  v_cmp_le_i32 vcc, 10, v17
  s_nop 1
  v_cndmask_b32 v246, v18, 0, vcc
  v_cmp_le_i32 vcc, 11, v17
  s_nop 1
  v_cndmask_b32 v247, v18, 0, vcc
  v_cmp_le_i32 vcc, 16, v17
  s_nop 1
  v_cndmask_b32 v248, v18, 0, vcc
  v_cmp_le_i32 vcc, 17, v17
  s_nop 1
  v_cndmask_b32 v249, v18, 0, vcc
  v_cmp_le_i32 vcc, 18, v17
  s_nop 1
  v_cndmask_b32 v250, v18, 0, vcc
  v_cmp_le_i32 vcc, 19, v17
  s_nop 1
  v_cndmask_b32 v251, v18, 0, vcc
  v_cmp_le_i32 vcc, 24, v17
  s_nop 1
  v_cndmask_b32 v252, v18, 0, vcc
  v_cmp_le_i32 vcc, 25, v17
  s_nop 1
  v_cndmask_b32 v253, v18, 0, vcc
  v_cmp_le_i32 vcc, 26, v17
  s_nop 1
  v_cndmask_b32 v254, v18, 0, vcc
  v_cmp_le_i32 vcc, 27, v17
  s_nop 1
  v_cndmask_b32 v255, v18, 0, vcc
  v_mov_b32 v21, v2
  s_barrier
  s_lshl_b32 s77, s48, 2
  s_add_u32 s77, s77, s16
  s_mul_i32 s78, s77, 896
  s_add_u32 s76, s78, 148898304
  s_mov_b32 s71, 0
  s_branch M_sg_55
M_sw_54:
  s_sleep 8
  s_add_u32 s71, s71, 1
  s_cmp_gt_u32 s71, 262144
  s_cbranch_scc1 M_exit
M_sg_55:
  s_mov_b32 s79, 0
  s_atomic_or s79, s[72:73], s76 glc
  s_waitcnt lgkmcnt(0)
  s_cmp_lt_u32 s79, 16
  s_cbranch_scc1 M_sw_54
  s_add_u32 s76, s78, 148898048
  s_mov_b32 s71, 0
  s_branch M_sg_57
M_sw_56:
  s_sleep 8
  s_add_u32 s71, s71, 1
  s_cmp_gt_u32 s71, 262144
  s_cbranch_scc1 M_exit
M_sg_57:
  s_mov_b32 s79, 0
  s_atomic_or s79, s[72:73], s76 glc
  s_waitcnt lgkmcnt(0)
  s_cmp_lt_u32 s79, 16
  s_cbranch_scc1 M_sw_56
M_xok_53:
  s_lshl_b32 s77, s77, 7
  s_add_u32 s54, s77, 148926464
  s_add_u32 s52, s50, 1
  s_mov_b32 s53, 0
  s_mov_b32 s30, 0x200
  s_add_u32 s28, s19, 50331648
  buffer_load_dwordx4 v[144:147], v21, s[4:7], s28 offen offset:0 sc1
  buffer_load_dwordx4 v[148:151], v21, s[4:7], s28 offen offset:1024 sc1
  buffer_load_dwordx4 v[152:155], v21, s[4:7], s28 offen offset:2048 sc1
  buffer_load_dwordx4 v[156:159], v21, s[4:7], s28 offen offset:3072 sc1
  s_add_u32 s29, s19, 50335744
  buffer_load_dwordx4 v[160:163], v21, s[4:7], s29 offen offset:0 sc1
  buffer_load_dwordx4 v[164:167], v21, s[4:7], s29 offen offset:1024 sc1
  buffer_load_dwordx4 v[168:171], v21, s[4:7], s29 offen offset:2048 sc1
  buffer_load_dwordx4 v[172:175], v21, s[4:7], s29 offen offset:3072 sc1
  s_add_u32 s28, s19, 67108864
  buffer_load_dwordx4 v[176:179], v21, s[4:7], s28 offen offset:0 sc1
  buffer_load_dwordx4 v[180:183], v21, s[4:7], s28 offen offset:1024 sc1
  buffer_load_dwordx4 v[184:187], v21, s[4:7], s28 offen offset:2048 sc1
  buffer_load_dwordx4 v[188:191], v21, s[4:7], s28 offen offset:3072 sc1
  s_add_u32 s29, s19, 67112960
  buffer_load_dwordx4 v[192:195], v21, s[4:7], s29 offen offset:0 sc1
  buffer_load_dwordx4 v[196:199], v21, s[4:7], s29 offen offset:1024 sc1
  buffer_load_dwordx4 v[200:203], v21, s[4:7], s29 offen offset:2048 sc1
  buffer_load_dwordx4 v[204:207], v21, s[4:7], s29 offen offset:3072 sc1
  s_add_u32 s28, s19, 83886080
  buffer_load_dwordx4 v[208:211], v21, s[4:7], s28 offen offset:0 sc1
  buffer_load_dwordx4 v[212:215], v21, s[4:7], s28 offen offset:1024 sc1
  buffer_load_dwordx4 v[216:219], v21, s[4:7], s28 offen offset:2048 sc1
  buffer_load_dwordx4 v[220:223], v21, s[4:7], s28 offen offset:3072 sc1
  s_add_u32 s29, s19, 83890176
  buffer_load_dwordx4 v[224:227], v21, s[4:7], s29 offen offset:0 sc1
  buffer_load_dwordx4 v[228:231], v21, s[4:7], s29 offen offset:1024 sc1
  buffer_load_dwordx4 v[232:235], v21, s[4:7], s29 offen offset:2048 sc1
  buffer_load_dwordx4 v[236:239], v21, s[4:7], s29 offen offset:3072 sc1
  s_mov_b32 s24, 0
  v_mov_b32 v22, 0x40000000
  s_sub_u32 s21, s21, s22
F_top_58:
  s_waitcnt vmcnt(8)
  v_mfma_f32_32x32x16_bf16 v[24:39], v[176:179], v[144:147], v[240:255]
  s_nop 1
  v_cvt_pk_bf16_f32 v128, v64, v65
  v_cvt_pk_bf16_f32 v129, v66, v67
  v_cvt_pk_bf16_f32 v130, v68, v69
  v_cvt_pk_bf16_f32 v131, v70, v71
  v_mfma_f32_32x32x16_bf16 v[24:39], v[180:183], v[148:151], v[24:39]
  buffer_store_dwordx4 v[128:131], v22, s[4:7], s21 offen offset:0 sc1
  v_mfma_f32_32x32x16_bf16 v[24:39], v[184:187], v[152:155], v[24:39]
  v_cvt_pk_bf16_f32 v132, v72, v73
  v_cvt_pk_bf16_f32 v133, v74, v75
  v_cvt_pk_bf16_f32 v134, v76, v77
  v_cvt_pk_bf16_f32 v135, v78, v79
  v_mfma_f32_32x32x16_bf16 v[24:39], v[188:191], v[156:159], v[24:39]
  buffer_store_dwordx4 v[132:135], v22, s[4:7], s21 offen offset:1024 sc1
  v_mfma_f32_32x32x16_bf16 v[24:39], v[192:195], v[160:163], v[24:39]
  v_cvt_pk_bf16_f32 v136, v80, v81
  v_cvt_pk_bf16_f32 v137, v82, v83
  v_cvt_pk_bf16_f32 v138, v84, v85
  v_cvt_pk_bf16_f32 v139, v86, v87
  v_mfma_f32_32x32x16_bf16 v[24:39], v[196:199], v[164:167], v[24:39]
  buffer_store_dwordx4 v[136:139], v22, s[4:7], s21 offen offset:2048 sc1
  v_mfma_f32_32x32x16_bf16 v[24:39], v[200:203], v[168:171], v[24:39]
  v_cvt_pk_bf16_f32 v140, v88, v89
  v_cvt_pk_bf16_f32 v141, v90, v91
  v_cvt_pk_bf16_f32 v142, v92, v93
  v_cvt_pk_bf16_f32 v143, v94, v95
  v_mfma_f32_32x32x16_bf16 v[24:39], v[204:207], v[172:175], v[24:39]
  buffer_store_dwordx4 v[140:143], v22, s[4:7], s21 offen offset:3072 sc1
  s_add_u32 s21, s21, s22
  v_mov_b32 v22, v2
  s_cmp_lg_u32 s24, 0
  s_cbranch_scc1 F_have_59
  v_mov_b32 v16, s54
  v_mov_b32 v17, s52
  s_mov_b32 s71, 0
  s_branch M_vg_61
M_vw_60:
  s_sleep 2
  s_add_u32 s71, s71, 1
  s_cmp_gt_u32 s71, 262144
  s_cbranch_scc1 M_exit
M_vg_61:
  buffer_load_dword v23, v16, s[4:7], 0 offen sc1
  s_waitcnt vmcnt(0)
  v_cmp_lt_u32 vcc, v23, v17
  s_cbranch_vccnz M_vw_60
  s_mov_b32 m0, s25
  s_nop 0
  buffer_load_dwordx4 v2, s[4:7], s20 offen offset:0 sc1 lds
  buffer_load_dwordx4 v2, s[4:7], s20 offen offset:1152 sc1 lds
  buffer_load_dwordx2 v[56:57], v5, s[4:7], s20 offen offset:2304 sc1
  buffer_load_dwordx2 v[58:59], v5, s[4:7], s20 offen offset:2560 sc1
  buffer_load_dwordx2 v[60:61], v5, s[4:7], s20 offen offset:2816 sc1
  buffer_load_dwordx2 v[62:63], v5, s[4:7], s20 offen offset:3072 sc1
  s_waitcnt vmcnt(0)
F_have_59:
  ds_read_b64_tr_b16 v[176:177], v4 offset:0
  ds_read_b64_tr_b16 v[178:179], v4 offset:64
  ds_read_b64_tr_b16 v[180:181], v4 offset:128
  ds_read_b64_tr_b16 v[182:183], v4 offset:192
  ds_read_b64_tr_b16 v[184:185], v4 offset:256
  ds_read_b64_tr_b16 v[186:187], v4 offset:320
  ds_read_b64_tr_b16 v[188:189], v4 offset:384
  ds_read_b64_tr_b16 v[190:191], v4 offset:448
  ds_read_b64_tr_b16 v[192:193], v4 offset:512
  ds_read_b64_tr_b16 v[194:195], v4 offset:576
  ds_read_b64_tr_b16 v[196:197], v4 offset:640
  ds_read_b64_tr_b16 v[198:199], v4 offset:704
  s_sub_u32 s23, s23, 1
  s_cmp_gt_u32 s23, 0
  s_cselect_b32 s26, s51, 0
  s_cselect_b32 s27, 0, 0x40000000
  v_or_b32 v21, s27, v21
  s_lshl_b32 s27, s26, 13
  s_add_u32 s19, s19, s27
  s_mul_i32 s27, s26, 147456
  s_add_u32 s20, s20, s27
  s_cmp_lg_u32 s23, 24
  s_cbranch_scc1 M_xok_62
  s_lshl_b32 s77, s48, 2
  s_add_u32 s77, s77, s16
  s_mul_i32 s78, s77, 896
  s_add_u32 s76, s78, 148898304
  s_mov_b32 s71, 0
  s_branch M_sg_64
M_sw_63:
  s_sleep 8
  s_add_u32 s71, s71, 1
  s_cmp_gt_u32 s71, 262144
  s_cbranch_scc1 M_exit
M_sg_64:
  s_mov_b32 s79, 0
  s_atomic_or s79, s[72:73], s76 glc
  s_waitcnt lgkmcnt(0)
  s_cmp_lt_u32 s79, 32
  s_cbranch_scc1 M_sw_63
  s_add_u32 s76, s78, 148898432
  s_mov_b32 s71, 0
  s_branch M_sg_66
M_sw_65:
  s_sleep 8
  s_add_u32 s71, s71, 1
  s_cmp_gt_u32 s71, 262144
  s_cbranch_scc1 M_exit
M_sg_66:
  s_mov_b32 s79, 0
  s_atomic_or s79, s[72:73], s76 glc
  s_waitcnt lgkmcnt(0)
  s_cmp_lt_u32 s79, 32
  s_cbranch_scc1 M_sw_65
  s_add_u32 s76, s78, 148898048
  s_mov_b32 s71, 0
  s_branch M_sg_68
M_sw_67:
  s_sleep 8
  s_add_u32 s71, s71, 1
  s_cmp_gt_u32 s71, 262144
  s_cbranch_scc1 M_exit
M_sg_68:
  s_mov_b32 s79, 0
  s_atomic_or s79, s[72:73], s76 glc
  s_waitcnt lgkmcnt(0)
  s_cmp_lt_u32 s79, 30
  s_cbranch_scc1 M_sw_67
  s_add_u32 s76, s78, 148898176
  s_mov_b32 s71, 0
  s_branch M_sg_70
M_sw_69:
  s_sleep 8
  s_add_u32 s71, s71, 1
  s_cmp_gt_u32 s71, 262144
  s_cbranch_scc1 M_exit
M_sg_70:
  s_mov_b32 s79, 0
  s_atomic_or s79, s[72:73], s76 glc
  s_waitcnt lgkmcnt(0)
  s_cmp_lt_u32 s79, 34
  s_cbranch_scc1 M_sw_69
M_xok_62:
  s_waitcnt lgkmcnt(10)
  v_mfma_f32_32x32x16_bf16 v[40:55], v[176:179], v[144:147], 0
  ds_read_b64_tr_b16 v[200:201], v4 offset:768
  ds_read_b64_tr_b16 v[202:203], v4 offset:832
  v_max_f32 v6, v24, v25
  s_waitcnt lgkmcnt(10)
  v_mfma_f32_32x32x16_bf16 v[40:55], v[180:183], v[148:151], v[40:55]
  ds_read_b64_tr_b16 v[204:205], v4 offset:896
  ds_read_b64_tr_b16 v[206:207], v4 offset:960
  v_max3_f32 v6, v6, v26, v27
  s_waitcnt lgkmcnt(10)
  v_mfma_f32_32x32x16_bf16 v[40:55], v[184:187], v[152:155], v[40:55]
  v_max3_f32 v6, v6, v28, v29
  s_waitcnt lgkmcnt(8)
  v_mfma_f32_32x32x16_bf16 v[40:55], v[188:191], v[156:159], v[40:55]
  v_max3_f32 v6, v6, v30, v31
  s_waitcnt lgkmcnt(6)
  v_mfma_f32_32x32x16_bf16 v[40:55], v[192:195], v[160:163], v[40:55]
  v_max3_f32 v6, v6, v32, v33
  s_waitcnt lgkmcnt(4)
  v_mfma_f32_32x32x16_bf16 v[40:55], v[196:199], v[164:167], v[40:55]
  v_max3_f32 v6, v6, v34, v35
  s_waitcnt lgkmcnt(2)
  v_mfma_f32_32x32x16_bf16 v[40:55], v[200:203], v[168:171], v[40:55]
  v_max3_f32 v6, v6, v36, v37
  s_waitcnt lgkmcnt(0)
  v_mfma_f32_32x32x16_bf16 v[40:55], v[204:207], v[172:175], v[40:55]
  v_max3_f32 v6, v6, v38, v39
  s_add_u32 s28, s19, 50331648
  buffer_load_dwordx4 v[144:147], v21, s[4:7], s28 offen offset:0 sc1
  buffer_load_dwordx4 v[148:151], v21, s[4:7], s28 offen offset:1024 sc1
  s_nop 7
  v_max3_f32 v6, v6, v40, v41
  v_max3_f32 v6, v6, v42, v43
  v_mov_b32 v16, v6
  s_nop 1
  v_permlane32_swap_b32 v6, v16
  s_nop 1
  v_max_f32 v6, v6, v16
  v_pk_add_f32 v[24:25], v[24:25], v[6:7] op_sel_hi:[1,0] neg_lo:[0,1] neg_hi:[0,1]
  v_pk_add_f32 v[26:27], v[26:27], v[6:7] op_sel_hi:[1,0] neg_lo:[0,1] neg_hi:[0,1]
  v_pk_add_f32 v[28:29], v[28:29], v[6:7] op_sel_hi:[1,0] neg_lo:[0,1] neg_hi:[0,1]
  v_pk_add_f32 v[30:31], v[30:31], v[6:7] op_sel_hi:[1,0] neg_lo:[0,1] neg_hi:[0,1]
  v_pk_add_f32 v[32:33], v[32:33], v[6:7] op_sel_hi:[1,0] neg_lo:[0,1] neg_hi:[0,1]
  v_pk_add_f32 v[34:35], v[34:35], v[6:7] op_sel_hi:[1,0] neg_lo:[0,1] neg_hi:[0,1]
  v_pk_add_f32 v[36:37], v[36:37], v[6:7] op_sel_hi:[1,0] neg_lo:[0,1] neg_hi:[0,1]
  v_pk_add_f32 v[38:39], v[38:39], v[6:7] op_sel_hi:[1,0] neg_lo:[0,1] neg_hi:[0,1]
  v_pk_add_f32 v[40:41], v[40:41], v[6:7] op_sel_hi:[1,0] neg_lo:[0,1] neg_hi:[0,1]
  v_pk_add_f32 v[42:43], v[42:43], v[6:7] op_sel_hi:[1,0] neg_lo:[0,1] neg_hi:[0,1]
  v_exp_f32 v24, v24
  v_exp_f32 v25, v25
  v_exp_f32 v26, v26
  v_exp_f32 v27, v27
  v_exp_f32 v28, v28
  v_exp_f32 v29, v29
  v_exp_f32 v30, v30
  v_exp_f32 v31, v31
  v_exp_f32 v32, v32
  v_exp_f32 v33, v33
  buffer_load_dwordx4 v[152:155], v21, s[4:7], s28 offen offset:2048 sc1
  v_exp_f32 v34, v34
  v_exp_f32 v35, v35
  v_exp_f32 v36, v36
  v_exp_f32 v37, v37
  v_exp_f32 v38, v38
  v_exp_f32 v39, v39
  v_exp_f32 v40, v40
  v_exp_f32 v41, v41
  v_exp_f32 v42, v42
  v_exp_f32 v43, v43
  v_pk_add_f32 v[16:17], v[24:25], v[26:27]
  v_pk_add_f32 v[16:17], v[16:17], v[28:29]
  v_pk_add_f32 v[16:17], v[16:17], v[30:31]
  v_pk_add_f32 v[16:17], v[16:17], v[32:33]
  v_pk_add_f32 v[16:17], v[16:17], v[34:35]
  v_pk_add_f32 v[16:17], v[16:17], v[36:37]
  v_pk_add_f32 v[16:17], v[16:17], v[38:39]
  v_pk_add_f32 v[16:17], v[16:17], v[40:41]
  v_pk_add_f32 v[16:17], v[16:17], v[42:43]
  v_add_f32 v16, v16, v17
  v_mov_b32 v17, v16
  buffer_load_dwordx4 v[156:159], v21, s[4:7], s28 offen offset:3072 sc1
  s_nop 0
  v_permlane32_swap_b32 v16, v17
  s_nop 1
  v_add_f32 v16, v16, v17
  v_rcp_f32 v6, v16
  s_nop 0
  v_pk_mul_f32 v[24:25], v[24:25], v[6:7] op_sel_hi:[1,0]
  v_pk_mul_f32 v[26:27], v[26:27], v[6:7] op_sel_hi:[1,0]
  v_pk_mul_f32 v[28:29], v[28:29], v[6:7] op_sel_hi:[1,0]
  v_pk_mul_f32 v[30:31], v[30:31], v[6:7] op_sel_hi:[1,0]
  v_pk_mul_f32 v[32:33], v[32:33], v[6:7] op_sel_hi:[1,0]
  v_pk_mul_f32 v[34:35], v[34:35], v[6:7] op_sel_hi:[1,0]
  v_pk_mul_f32 v[36:37], v[36:37], v[6:7] op_sel_hi:[1,0]
  v_pk_mul_f32 v[38:39], v[38:39], v[6:7] op_sel_hi:[1,0]
  v_pk_mul_f32 v[40:41], v[40:41], v[6:7] op_sel_hi:[1,0]
  v_pk_mul_f32 v[42:43], v[42:43], v[6:7] op_sel_hi:[1,0]
  v_cvt_pk_bf16_f32 v128, v24, v25
  v_cvt_pk_bf16_f32 v129, v26, v27
  v_cvt_pk_bf16_f32 v130, v28, v29
  v_cvt_pk_bf16_f32 v131, v30, v31
  v_cvt_pk_bf16_f32 v132, v32, v33
  v_cvt_pk_bf16_f32 v133, v34, v35
  v_cvt_pk_bf16_f32 v134, v36, v37
  v_cvt_pk_bf16_f32 v135, v38, v39
  v_cvt_pk_bf16_f32 v136, v40, v41
  v_cvt_pk_bf16_f32 v137, v42, v43
  s_waitcnt vmcnt(8)
  v_mfma_f32_32x32x16_bf16 v[64:79], v[208:211], v[128:131], 0
  s_add_u32 s29, s19, 50335744
  buffer_load_dwordx4 v[160:163], v21, s[4:7], s29 offen offset:0 sc1
  v_mfma_f32_32x32x16_bf16 v[64:79], v[212:215], v[132:135], v[64:79]
  v_mfma_f32_32x32x8_bf16 v[64:79], v[56:57], v[136:137], v[64:79]
  v_mfma_f32_32x32x16_bf16 v[80:95], v[216:219], v[128:131], 0
  buffer_load_dwordx4 v[164:167], v21, s[4:7], s29 offen offset:1024 sc1
  v_mfma_f32_32x32x16_bf16 v[80:95], v[220:223], v[132:135], v[80:95]
  v_cvt_pk_bf16_f32 v24, v64, v65
  v_cvt_pk_bf16_f32 v25, v66, v67
  v_cvt_pk_bf16_f32 v26, v68, v69
  v_cvt_pk_bf16_f32 v27, v70, v71
  v_mfma_f32_32x32x8_bf16 v[80:95], v[58:59], v[136:137], v[80:95]
  ds_write_b128 v3, v[24:27] offset:0
  v_cvt_pk_bf16_f32 v28, v72, v73
  v_cvt_pk_bf16_f32 v29, v74, v75
  v_cvt_pk_bf16_f32 v30, v76, v77
  v_cvt_pk_bf16_f32 v31, v78, v79
  v_mfma_f32_32x32x16_bf16 v[96:111], v[224:227], v[128:131], 0
  ds_write_b128 v3, v[28:31] offset:1024
  buffer_load_dwordx4 v[168:171], v21, s[4:7], s29 offen offset:2048 sc1
  v_mfma_f32_32x32x16_bf16 v[96:111], v[228:231], v[132:135], v[96:111]
  v_cvt_pk_bf16_f32 v32, v80, v81
  v_cvt_pk_bf16_f32 v33, v82, v83
  v_cvt_pk_bf16_f32 v34, v84, v85
  v_cvt_pk_bf16_f32 v35, v86, v87
  v_mfma_f32_32x32x8_bf16 v[96:111], v[60:61], v[136:137], v[96:111]
  ds_write_b128 v3, v[32:35] offset:2048
  v_cvt_pk_bf16_f32 v36, v88, v89
  v_cvt_pk_bf16_f32 v37, v90, v91
  v_cvt_pk_bf16_f32 v38, v92, v93
  v_cvt_pk_bf16_f32 v39, v94, v95
  v_mfma_f32_32x32x16_bf16 v[112:127], v[232:235], v[128:131], 0
  ds_write_b128 v3, v[36:39] offset:3072
  buffer_load_dwordx4 v[172:175], v21, s[4:7], s29 offen offset:3072 sc1
  v_mfma_f32_32x32x16_bf16 v[112:127], v[236:239], v[132:135], v[112:127]
  v_cvt_pk_bf16_f32 v40, v96, v97
  v_cvt_pk_bf16_f32 v41, v98, v99
  v_cvt_pk_bf16_f32 v42, v100, v101
  v_cvt_pk_bf16_f32 v43, v102, v103
  v_mfma_f32_32x32x8_bf16 v[112:127], v[62:63], v[136:137], v[112:127]
  ds_write_b128 v3, v[40:43] offset:4096
  v_cvt_pk_bf16_f32 v44, v104, v105
  v_cvt_pk_bf16_f32 v45, v106, v107
  v_cvt_pk_bf16_f32 v46, v108, v109
  v_cvt_pk_bf16_f32 v47, v110, v111
  ds_write_b128 v3, v[44:47] offset:5120
  s_nop 5
  v_cvt_pk_bf16_f32 v48, v112, v113
  v_cvt_pk_bf16_f32 v49, v114, v115
  v_cvt_pk_bf16_f32 v50, v116, v117
  v_cvt_pk_bf16_f32 v51, v118, v119
  ds_write_b128 v3, v[48:51] offset:6144
  v_cvt_pk_bf16_f32 v52, v120, v121
  v_cvt_pk_bf16_f32 v53, v122, v123
  v_cvt_pk_bf16_f32 v54, v124, v125
  v_cvt_pk_bf16_f32 v55, v126, v127
  ds_write_b128 v3, v[52:55] offset:7168
  s_waitcnt vmcnt(8)
  s_waitcnt lgkmcnt(0)
  s_barrier
  ds_read_b128 v[24:27], v8 offset:0
  ds_read_b128 v[28:31], v9 offset:0
  ds_read_b128 v[32:35], v10 offset:0
  ds_read_b128 v[36:39], v11 offset:0
  ds_read_b128 v[40:43], v12 offset:0
  ds_read_b128 v[44:47], v13 offset:0
  v_readfirstlane_b32 s53, v23
  v_mov_b32 v16, s30
  v_min_u32 v17, 1, v0
  v_lshlrev_b32 v17, 30, v17
  buffer_store_dword v16, v17, s[4:7], s31 offen sc1
  s_add_u32 s30, s30, 1
  s_add_u32 s52, s52, 2
  s_cmp_ge_u32 s53, s52
  s_cselect_b32 s24, 1, 0
  buffer_load_dword v23, off, s[4:7], s54 sc1
  s_cmp_eq_u32 s24, 0
  s_cbranch_scc1 F_nopre_71
  s_mov_b32 m0, s25
  s_nop 0
  buffer_load_dwordx4 v2, s[4:7], s20 offen offset:0 sc1 lds
  buffer_load_dwordx4 v2, s[4:7], s20 offen offset:1152 sc1 lds
  buffer_load_dwordx2 v[56:57], v5, s[4:7], s20 offen offset:2304 sc1
  buffer_load_dwordx2 v[58:59], v5, s[4:7], s20 offen offset:2560 sc1
  buffer_load_dwordx2 v[60:61], v5, s[4:7], s20 offen offset:2816 sc1
  buffer_load_dwordx2 v[62:63], v5, s[4:7], s20 offen offset:3072 sc1
F_nopre_71:
  s_waitcnt lgkmcnt(5)
  v_mfma_f32_32x32x16_bf16 v[64:79], a[0:3], v[24:27], 0
  s_add_u32 s28, s19, 67108864
  ds_read_b128 v[48:51], v14 offset:0
  v_mfma_f32_32x32x16_bf16 v[80:95], a[4:7], v[24:27], 0
  s_waitcnt lgkmcnt(5)
  v_mfma_f32_32x32x16_bf16 v[64:79], a[8:11], v[28:31], v[64:79]
  ds_read_b128 v[52:55], v15 offset:0
  v_mfma_f32_32x32x16_bf16 v[80:95], a[12:15], v[28:31], v[80:95]
  s_waitcnt lgkmcnt(5)
  buffer_load_dwordx4 v[176:179], v21, s[4:7], s28 offen offset:0 sc1
  v_mfma_f32_32x32x16_bf16 v[64:79], a[16:19], v[32:35], v[64:79]
  ds_read_b128 v[24:27], v8 offset:8192
  v_mfma_f32_32x32x16_bf16 v[80:95], a[20:23], v[32:35], v[80:95]
  s_waitcnt lgkmcnt(5)
  v_mfma_f32_32x32x16_bf16 v[64:79], a[24:27], v[36:39], v[64:79]
  ds_read_b128 v[28:31], v9 offset:8192
  v_mfma_f32_32x32x16_bf16 v[80:95], a[28:31], v[36:39], v[80:95]
  s_waitcnt lgkmcnt(5)
  buffer_load_dwordx4 v[180:183], v21, s[4:7], s28 offen offset:1024 sc1
  v_mfma_f32_32x32x16_bf16 v[64:79], a[32:35], v[40:43], v[64:79]
  ds_read_b128 v[32:35], v10 offset:8192
  v_mfma_f32_32x32x16_bf16 v[80:95], a[36:39], v[40:43], v[80:95]
  s_waitcnt lgkmcnt(5)
  v_mfma_f32_32x32x16_bf16 v[64:79], a[40:43], v[44:47], v[64:79]
  ds_read_b128 v[36:39], v11 offset:8192
  v_mfma_f32_32x32x16_bf16 v[80:95], a[44:47], v[44:47], v[80:95]
  s_waitcnt lgkmcnt(5)
  buffer_load_dwordx4 v[184:187], v21, s[4:7], s28 offen offset:2048 sc1
  v_mfma_f32_32x32x16_bf16 v[64:79], a[48:51], v[48:51], v[64:79]
  ds_read_b128 v[40:43], v12 offset:8192
  v_mfma_f32_32x32x16_bf16 v[80:95], a[52:55], v[48:51], v[80:95]
  s_waitcnt lgkmcnt(5)
  v_mfma_f32_32x32x16_bf16 v[64:79], a[56:59], v[52:55], v[64:79]
  ds_read_b128 v[44:47], v13 offset:8192
  v_mfma_f32_32x32x16_bf16 v[80:95], a[60:63], v[52:55], v[80:95]
  s_waitcnt lgkmcnt(5)
  buffer_load_dwordx4 v[188:191], v21, s[4:7], s28 offen offset:3072 sc1
  v_mfma_f32_32x32x16_bf16 v[64:79], a[64:67], v[24:27], v[64:79]
  s_add_u32 s29, s19, 67112960
  ds_read_b128 v[48:51], v14 offset:8192
  v_mfma_f32_32x32x16_bf16 v[80:95], a[68:71], v[24:27], v[80:95]
  s_waitcnt lgkmcnt(5)
  v_mfma_f32_32x32x16_bf16 v[64:79], a[72:75], v[28:31], v[64:79]
  ds_read_b128 v[52:55], v15 offset:8192
  v_mfma_f32_32x32x16_bf16 v[80:95], a[76:79], v[28:31], v[80:95]
  s_waitcnt lgkmcnt(5)
  buffer_load_dwordx4 v[192:195], v21, s[4:7], s29 offen offset:0 sc1
  v_mfma_f32_32x32x16_bf16 v[64:79], a[80:83], v[32:35], v[64:79]
  ds_read_b128 v[24:27], v8 offset:16384
  v_mfma_f32_32x32x16_bf16 v[80:95], a[84:87], v[32:35], v[80:95]
  s_waitcnt lgkmcnt(5)
  v_mfma_f32_32x32x16_bf16 v[64:79], a[88:91], v[36:39], v[64:79]
  ds_read_b128 v[28:31], v9 offset:16384
  v_mfma_f32_32x32x16_bf16 v[80:95], a[92:95], v[36:39], v[80:95]
  s_waitcnt lgkmcnt(5)
  buffer_load_dwordx4 v[196:199], v21, s[4:7], s29 offen offset:1024 sc1
  v_mfma_f32_32x32x16_bf16 v[64:79], a[96:99], v[40:43], v[64:79]
  ds_read_b128 v[32:35], v10 offset:16384
  v_mfma_f32_32x32x16_bf16 v[80:95], a[100:103], v[40:43], v[80:95]
  s_waitcnt lgkmcnt(5)
  v_mfma_f32_32x32x16_bf16 v[64:79], a[104:107], v[44:47], v[64:79]
  ds_read_b128 v[36:39], v11 offset:16384
  v_mfma_f32_32x32x16_bf16 v[80:95], a[108:111], v[44:47], v[80:95]
  s_waitcnt lgkmcnt(5)
  buffer_load_dwordx4 v[200:203], v21, s[4:7], s29 offen offset:2048 sc1
  v_mfma_f32_32x32x16_bf16 v[64:79], a[112:115], v[48:51], v[64:79]
  ds_read_b128 v[40:43], v12 offset:16384
  v_mfma_f32_32x32x16_bf16 v[80:95], a[116:119], v[48:51], v[80:95]
  s_waitcnt lgkmcnt(5)
  v_mfma_f32_32x32x16_bf16 v[64:79], a[120:123], v[52:55], v[64:79]
  ds_read_b128 v[44:47], v13 offset:16384
  v_mfma_f32_32x32x16_bf16 v[80:95], a[124:127], v[52:55], v[80:95]
  s_waitcnt lgkmcnt(5)
  buffer_load_dwordx4 v[204:207], v21, s[4:7], s29 offen offset:3072 sc1
  v_mfma_f32_32x32x16_bf16 v[64:79], a[128:131], v[24:27], v[64:79]
  s_add_u32 s28, s19, 83886080
  ds_read_b128 v[48:51], v14 offset:16384
  v_mfma_f32_32x32x16_bf16 v[80:95], a[132:135], v[24:27], v[80:95]
  s_waitcnt lgkmcnt(5)
  v_mfma_f32_32x32x16_bf16 v[64:79], a[136:139], v[28:31], v[64:79]
  ds_read_b128 v[52:55], v15 offset:16384
  v_mfma_f32_32x32x16_bf16 v[80:95], a[140:143], v[28:31], v[80:95]
  s_waitcnt lgkmcnt(5)
  buffer_load_dwordx4 v[208:211], v21, s[4:7], s28 offen offset:0 sc1
  v_mfma_f32_32x32x16_bf16 v[64:79], a[144:147], v[32:35], v[64:79]
  ds_read_b128 v[24:27], v8 offset:24576
  v_mfma_f32_32x32x16_bf16 v[80:95], a[148:151], v[32:35], v[80:95]
  s_waitcnt lgkmcnt(5)
  v_mfma_f32_32x32x16_bf16 v[64:79], a[152:155], v[36:39], v[64:79]
  ds_read_b128 v[28:31], v9 offset:24576
  v_mfma_f32_32x32x16_bf16 v[80:95], a[156:159], v[36:39], v[80:95]
  s_waitcnt lgkmcnt(5)
  buffer_load_dwordx4 v[212:215], v21, s[4:7], s28 offen offset:1024 sc1
  v_mfma_f32_32x32x16_bf16 v[64:79], a[160:163], v[40:43], v[64:79]
  ds_read_b128 v[32:35], v10 offset:24576
  v_mfma_f32_32x32x16_bf16 v[80:95], a[164:167], v[40:43], v[80:95]
  s_waitcnt lgkmcnt(5)
  v_mfma_f32_32x32x16_bf16 v[64:79], a[168:171], v[44:47], v[64:79]
  ds_read_b128 v[36:39], v11 offset:24576
  v_mfma_f32_32x32x16_bf16 v[80:95], a[172:175], v[44:47], v[80:95]
  s_waitcnt lgkmcnt(5)
  buffer_load_dwordx4 v[216:219], v21, s[4:7], s28 offen offset:2048 sc1
  v_mfma_f32_32x32x16_bf16 v[64:79], a[176:179], v[48:51], v[64:79]
  ds_read_b128 v[40:43], v12 offset:24576
  v_mfma_f32_32x32x16_bf16 v[80:95], a[180:183], v[48:51], v[80:95]
  s_waitcnt lgkmcnt(5)
  v_mfma_f32_32x32x16_bf16 v[64:79], a[184:187], v[52:55], v[64:79]
  ds_read_b128 v[44:47], v13 offset:24576
  v_mfma_f32_32x32x16_bf16 v[80:95], a[188:191], v[52:55], v[80:95]
  s_waitcnt lgkmcnt(5)
  buffer_load_dwordx4 v[220:223], v21, s[4:7], s28 offen offset:3072 sc1
  v_mfma_f32_32x32x16_bf16 v[64:79], a[192:195], v[24:27], v[64:79]
  s_add_u32 s29, s19, 83890176
  ds_read_b128 v[48:51], v14 offset:24576
  v_mfma_f32_32x32x16_bf16 v[80:95], a[196:199], v[24:27], v[80:95]
  s_waitcnt lgkmcnt(5)
  v_mfma_f32_32x32x16_bf16 v[64:79], a[200:203], v[28:31], v[64:79]
  ds_read_b128 v[52:55], v15 offset:24576
  v_mfma_f32_32x32x16_bf16 v[80:95], a[204:207], v[28:31], v[80:95]
  s_waitcnt lgkmcnt(5)
  buffer_load_dwordx4 v[224:227], v21, s[4:7], s29 offen offset:0 sc1
  v_mfma_f32_32x32x16_bf16 v[64:79], a[208:211], v[32:35], v[64:79]
  v_mfma_f32_32x32x16_bf16 v[80:95], a[212:215], v[32:35], v[80:95]
  s_waitcnt lgkmcnt(4)
  v_mfma_f32_32x32x16_bf16 v[64:79], a[216:219], v[36:39], v[64:79]
  v_xor_b32 v8, 0x8000, v8
  v_mfma_f32_32x32x16_bf16 v[80:95], a[220:223], v[36:39], v[80:95]
  s_waitcnt lgkmcnt(3)
  buffer_load_dwordx4 v[228:231], v21, s[4:7], s29 offen offset:1024 sc1
  v_xor_b32 v9, 0x8000, v9
  v_mfma_f32_32x32x16_bf16 v[64:79], a[224:227], v[40:43], v[64:79]
  v_xor_b32 v10, 0x8000, v10
  v_mfma_f32_32x32x16_bf16 v[80:95], a[228:231], v[40:43], v[80:95]
  s_waitcnt lgkmcnt(2)
  v_xor_b32 v11, 0x8000, v11
  v_mfma_f32_32x32x16_bf16 v[64:79], a[232:235], v[44:47], v[64:79]
  v_xor_b32 v12, 0x8000, v12
  v_mfma_f32_32x32x16_bf16 v[80:95], a[236:239], v[44:47], v[80:95]
  s_waitcnt lgkmcnt(1)
  buffer_load_dwordx4 v[232:235], v21, s[4:7], s29 offen offset:2048 sc1
  v_xor_b32 v13, 0x8000, v13
  v_mfma_f32_32x32x16_bf16 v[64:79], a[240:243], v[48:51], v[64:79]
  v_xor_b32 v14, 0x8000, v14
  v_mfma_f32_32x32x16_bf16 v[80:95], a[244:247], v[48:51], v[80:95]
  s_waitcnt lgkmcnt(0)
  v_xor_b32 v15, 0x8000, v15
  v_mfma_f32_32x32x16_bf16 v[64:79], a[248:251], v[52:55], v[64:79]
  v_xor_b32 v3, 0x8000, v3
  v_mfma_f32_32x32x16_bf16 v[80:95], a[252:255], v[52:55], v[80:95]
  buffer_load_dwordx4 v[236:239], v21, s[4:7], s29 offen offset:3072 sc1
  s_cmp_gt_u32 s23, 0
  s_cbranch_scc1 F_top_58
  s_nop 2
  v_cvt_pk_bf16_f32 v128, v64, v65
  v_cvt_pk_bf16_f32 v129, v66, v67
  v_cvt_pk_bf16_f32 v130, v68, v69
  v_cvt_pk_bf16_f32 v131, v70, v71
  buffer_store_dwordx4 v[128:131], v22, s[4:7], s21 offen offset:0 sc1
  v_cvt_pk_bf16_f32 v132, v72, v73
  v_cvt_pk_bf16_f32 v133, v74, v75
  v_cvt_pk_bf16_f32 v134, v76, v77
  v_cvt_pk_bf16_f32 v135, v78, v79
  buffer_store_dwordx4 v[132:135], v22, s[4:7], s21 offen offset:1024 sc1
  v_cvt_pk_bf16_f32 v136, v80, v81
  v_cvt_pk_bf16_f32 v137, v82, v83
  v_cvt_pk_bf16_f32 v138, v84, v85
  v_cvt_pk_bf16_f32 v139, v86, v87
  buffer_store_dwordx4 v[136:139], v22, s[4:7], s21 offen offset:2048 sc1
  v_cvt_pk_bf16_f32 v140, v88, v89
  v_cvt_pk_bf16_f32 v141, v90, v91
  v_cvt_pk_bf16_f32 v142, v92, v93
  v_cvt_pk_bf16_f32 v143, v94, v95
  buffer_store_dwordx4 v[140:143], v22, s[4:7], s21 offen offset:3072 sc1
  s_waitcnt vmcnt(0) lgkmcnt(0)
  s_barrier
  v_mov_b32 v144, s30
  v_min_u32 v145, 1, v0
  v_lshlrev_b32 v145, 30, v145
  buffer_store_dword v144, v145, s[4:7], s31 offen sc1
  s_branch M_done
M_team:
  s_mov_b32 s12, s77
  s_load_dwordx4 s[60:63], s[0:1], 64
  s_load_dwordx4 s[64:67], s[0:1], 80
  s_load_dwordx4 s[68:71], s[0:1], 120
  s_load_dwordx2 s[72:73], s[0:1], 56
  v_lshrrev_b32 v1, 6, v0
  v_and_b32 v20, 63, v0
  v_readfirstlane_b32 s13, v1
  s_waitcnt lgkmcnt(0)
  s_mov_b32 s8, s60
  s_and_b32 s9, s61, 0xffff
  s_mov_b32 s10, 0x400000
  s_mov_b32 s11, 0x20000
  s_mov_b32 s40, s62
  s_and_b32 s41, s63, 0xffff
  s_mov_b32 s42, 0x400000
  s_mov_b32 s43, 0x20000
  s_mov_b32 s44, s64
  s_and_b32 s45, s65, 0xffff
  s_mov_b32 s46, 0x400000
  s_mov_b32 s47, 0x20000
  s_mov_b32 s48, s66
  s_and_b32 s49, s67, 0xffff
  s_mov_b32 s50, 0x400000
  s_mov_b32 s51, 0x20000
  s_mov_b32 s4, s70
  s_and_b32 s5, s71, 0xffff
  s_mov_b32 s6, 0x10000000
  s_mov_b32 s7, 0x20000
  s_mov_b32 s76, s72
  s_and_b32 s77, s73, 0xffff
  s_mov_b32 s78, 0x2000
  s_mov_b32 s79, 0x20000
  s_mov_b32 s72, s68
  s_and_b32 s73, s69, 0xffff
  s_mov_b32 s74, 0x100
  s_mov_b32 s75, 0x20000
  s_mov_b64 s[52:53], s[68:69]
  s_mov_b64 s[58:59], s[70:71]
  s_mul_i32 s99, s12, 896
  s_add_u32 s99, s99, 148898048
  s_lshl_b32 s15, s12, 7
  s_add_u32 s15, s15, 148926464
  v_lshrrev_b32 v21, 4, v20
  v_and_b32 v22, 15, v20
  v_and_b32 v23, 1, v21
  v_lshrrev_b32 v24, 1, v21
  v_lshlrev_b32 v2, 4, v20
  s_lshl_b32 s36, s13, 10
  v_add_u32 v59, s36, v2
  s_lshl_b32 s37, s13, 15
  s_add_u32 s37, s37, 32768
  v_add_u32 v4, s37, v2
  v_lshrrev_b32 v25, 2, v20
  v_lshlrev_b32 v25, 13, v25
  v_and_b32 v1, 3, v20
  v_lshl_add_u32 v25, v1, 4, v25
  s_lshl_b32 s36, s13, 6
  s_lshl_b32 s38, s12, 8
  s_add_u32 s36, s36, s38
  v_add_u32 v25, s36, v25
  v_lshrrev_b32 v26, 3, v20
  v_lshlrev_b32 v26, 10, v26
  v_and_b32 v1, 7, v20
  v_lshl_add_u32 v26, v1, 4, v26
  s_lshl_b32 s36, s13, 7
  s_lshl_b32 s38, s12, 17
  s_add_u32 s36, s36, s38
  v_add_u32 v26, s36, v26
  v_bfe_u32 v29, v20, 2, 1
  v_bfe_u32 v30, v20, 3, 1
  v_and_b32 v31, 3, v20
  v_lshl_add_u32 v27, v21, 2, v29
  v_lshlrev_b32 v27, 6, v27
  v_lshl_add_u32 v27, v30, 5, v27
  v_lshl_add_u32 v27, v31, 3, v27
  v_add_u32 v27, s37, v27
  v_xor_b32 v36, 1, v30
  v_lshl_add_u32 v36, v36, 11, v27
  v_lshl_add_u32 v27, v30, 11, v27
  v_lshl_add_u32 v28, v23, 2, v24
  v_lshl_add_u32 v28, v28, 2, v29
  v_lshlrev_b32 v28, 7, v28
  v_lshl_add_u32 v28, v30, 6, v28
  v_lshl_add_u32 v28, v31, 4, v28
  v_add_u32 v28, s37, v28
  s_mov_b32 s39, s37
  s_xor_b32 s36, s13, 0
  s_lshl_b32 s36, s36, 15
  s_add_u32 m0, s39, 0
  s_add_u32 s37, s36, 0
  buffer_load_dwordx4 v26, s[48:51], s37 offen lds
  s_add_u32 m0, s39, 1024
  s_add_u32 s37, s36, 8192
  buffer_load_dwordx4 v26, s[48:51], s37 offen lds
  s_add_u32 m0, s39, 2048
  s_add_u32 s37, s36, 16384
  buffer_load_dwordx4 v26, s[48:51], s37 offen lds
  s_add_u32 m0, s39, 3072
  s_add_u32 s37, s36, 24576
  buffer_load_dwordx4 v26, s[48:51], s37 offen lds
  s_xor_b32 s36, s13, 0
  s_lshl_b32 s36, s36, 15
  s_add_u32 m0, s39, 4096
  s_add_u32 s37, s36, 512
  buffer_load_dwordx4 v26, s[48:51], s37 offen lds
  s_add_u32 m0, s39, 5120
  s_add_u32 s37, s36, 8704
  buffer_load_dwordx4 v26, s[48:51], s37 offen lds
  s_add_u32 m0, s39, 6144
  s_add_u32 s37, s36, 16896
  buffer_load_dwordx4 v26, s[48:51], s37 offen lds
  s_add_u32 m0, s39, 7168
  s_add_u32 s37, s36, 25088
  buffer_load_dwordx4 v26, s[48:51], s37 offen lds
  v_mov_b32 v0, 0x4444
  v_mov_b32 v1, 0xeeee
  v_cmp_lt_u32 vcc, 7, v22
  s_nop 1
  v_cndmask_b32 v32, v0, v1, vcc
  v_mov_b32 v0, v32
  v_and_b32 v32, 7, v20
  v_lshlrev_b32 v32, 4, v32
  v_lshl_add_u32 v11, v21, 7, v32
  v_xor_b32 v1, 128, v2
  v_lshl_add_u32 v33, v24, 4, v22
  s_lshl_b32 s36, s13, 5
  v_add_u32 v33, s36, v33
  v_lshlrev_b32 v33, 3, v33
  v_mul_u32_u24 v34, 1152, v23
  v_add_u32 v5, v33, v34
  v_bfe_u32 v33, v20, 2, 2
  v_lshl_add_u32 v33, v23, 2, v33
  v_lshl_add_u32 v33, v24, 4, v33
  v_lshlrev_b32 v33, 3, v33
  v_and_b32 v34, 1, v20
  v_mul_u32_u24 v34, 1152, v34
  v_add_u32 v6, v33, v34
  s_lshl_b32 s36, s13, 3
  v_lshrrev_b32 v33, 3, v20
  v_add_u32 v33, s36, v33
  v_mul_u32_u24 v34, 0, v33
  v_add_u32 v34, s12, v34
  v_and_b32 v34, 31, v34
  v_lshrrev_b32 v37, 1, v32
  v_lshl_add_u32 v33, v33, 13, v37
  v_lshl_add_u32 v7, v34, 7, v33
  v_and_b32 v37, 1, v20
  v_bfe_u32 v38, v20, 1, 1
  v_lshl_add_u32 v37, v29, 1, v37
  s_lshr_b32 s36, s12, 3
  s_lshl_b32 s36, s36, 10
  s_and_b32 s37, s12, 1
  s_lshl_b32 s37, s37, 9
  s_add_u32 s36, s36, s37
  s_and_b32 s37, s12, 6
  s_lshl_b32 s37, s37, 5
  s_add_u32 s36, s36, s37
  v_lshlrev_b32 v33, 4, v21
  v_lshl_add_u32 v33, v37, 2, v33
  v_lshl_add_u32 v33, v38, 8, v33
  v_lshl_add_u32 v33, v30, 30, v33
  v_add_u32 v8, s36, v33
  s_lshr_b32 s36, s12, 2
  s_lshl_b32 s36, s36, 6
  s_and_b32 s37, s12, 1
  s_lshl_b32 s37, s37, 5
  s_add_u32 s36, s36, s37
  s_and_b32 s37, s12, 2
  s_lshl_b32 s37, s37, 11
  s_add_u32 s36, s36, s37
  v_lshlrev_b32 v35, 10, v21
  v_lshl_add_u32 v35, v37, 2, v35
  v_lshl_add_u32 v35, v38, 4, v35
  v_add_u32 v35, s36, v35
  buffer_load_ushort v44, v35, s[76:79], 0 offen offset:0
  buffer_load_ushort v45, v35, s[76:79], 0 offen offset:2
  buffer_load_ushort v46, v35, s[76:79], 0 offen offset:512
  buffer_load_ushort v47, v35, s[76:79], 0 offen offset:514
  v_lshlrev_b32 v33, 4, v29
  v_mov_b32 v34, 0x3f80
  v_lshlrev_b32 v33, v33, v34
  v_and_b32 v34, 1, v20
  v_lshl_add_u32 v34, v34, 1, v30
  v_cmp_eq_u32 vcc, 0, v34
  s_nop 1
  v_cndmask_b32 v48, 0, v33, vcc
  v_cmp_eq_u32 vcc, 1, v34
  s_nop 1
  v_cndmask_b32 v49, 0, v33, vcc
  v_cmp_eq_u32 vcc, 2, v34
  s_nop 1
  v_cndmask_b32 v50, 0, v33, vcc
  v_cmp_eq_u32 vcc, 3, v34
  s_nop 1
  v_cndmask_b32 v51, 0, v33, vcc
  ds_write_b128 v2, v[48:51] offset:31232
  v_lshlrev_b32 v33, 9, v21
  s_lshl_b32 s36, s13, 11
  v_add_u32 v33, s36, v33
  v_lshl_add_u32 v10, v22, 4, v33
  v_lshl_add_u32 v33, v30, 8, v33
  v_add_u32 v9, v33, v32
  v_mov_b32 v12, 0x3f803f80
  v_mov_b32 v13, 0x3f803f80
  v_mov_b32 v14, 0x3f803f80
  v_mov_b32 v15, 0x3f803f80
  v_and_b32 v33, 1, v20
  v_mul_u32_u24 v33, 128, v33
  v_min_u32 v34, 1, v20
  v_lshlrev_b32 v34, 30, v34
  s_cmp_eq_u32 s13, 3
  s_cselect_b64 vcc, -1, 0
  v_cndmask_b32 v3, v34, v33, vcc
  v_mov_b64 v[60:61], 0
  v_mov_b32 v62, 32256
  ds_write_b64 v62, v[60:61]
  s_mov_b32 s16, 0
  s_mov_b32 s17, -1
  s_mov_b32 s18, 0x3e0293ee
  s_mov_b32 s54, 0x2f800000
  s_mov_b32 s55, 0x28000000
  s_lshl_b32 s36, s13, 10
  s_add_u32 s31, s36, 8192
  s_add_u32 s32, s36, 12160
  s_add_u32 s33, s36, 16384
  s_add_u32 s34, s36, 20224
  s_lshl_b32 s36, s12, 19
  s_add_u32 s27, s36, 67108864
  s_add_u32 s28, s36, 83886080
  s_mul_i32 s36, s12, 4608
  s_add_u32 s29, s36, 134217728
  s_lshl_b32 s36, s12, 13
  s_add_u32 s22, s36, 144703488
  s_add_u32 s23, s36, 144707584
  s_mov_b32 s20, 144703488
  s_mov_b32 s21, 144707584
  v_mov_b32 v40, -1
  v_mov_b32 v41, -1
  v_mov_b32 v42, -1
  v_mov_b32 v43, -1
  s_lshl_b32 s36, s13, 13
  s_add_u32 s36, s36, 145752064
  s_add_u32 s37, s36, 4096
  buffer_store_dwordx4 v[40:43], v59, s[4:7], s22 offen sc1
  buffer_store_dwordx4 v[40:43], v59, s[4:7], s23 offen sc1
  buffer_store_dword v40, v8, s[4:7], s36 offen sc1
  buffer_store_dword v40, v8, s[4:7], s37 offen sc1
  v_mov_b32 v52, 0
  v_min_u32 v53, 1, v59
  v_lshlrev_b32 v53, 30, v53
  buffer_store_dword v52, v53, s[4:7], s15 offen sc1
  s_xor_b32 s36, s13, 1
  s_lshl_b32 s36, s36, 15
  s_add_u32 m0, s39, 8192
  s_add_u32 s37, s36, 0
  buffer_load_dwordx4 v26, s[48:51], s37 offen lds
  s_add_u32 m0, s39, 9216
  s_add_u32 s37, s36, 8192
  buffer_load_dwordx4 v26, s[48:51], s37 offen lds
  s_add_u32 m0, s39, 10240
  s_add_u32 s37, s36, 16384
  buffer_load_dwordx4 v26, s[48:51], s37 offen lds
  s_add_u32 m0, s39, 11264
  s_add_u32 s37, s36, 24576
  buffer_load_dwordx4 v26, s[48:51], s37 offen lds
  s_xor_b32 s36, s13, 1
  s_lshl_b32 s36, s36, 15
  s_add_u32 m0, s39, 12288
  s_add_u32 s37, s36, 512
  buffer_load_dwordx4 v26, s[48:51], s37 offen lds
  s_add_u32 m0, s39, 13312
  s_add_u32 s37, s36, 8704
  buffer_load_dwordx4 v26, s[48:51], s37 offen lds
  s_add_u32 m0, s39, 14336
  s_add_u32 s37, s36, 16896
  buffer_load_dwordx4 v26, s[48:51], s37 offen lds
  s_add_u32 m0, s39, 15360
  s_add_u32 s37, s36, 25088
  buffer_load_dwordx4 v26, s[48:51], s37 offen lds
  s_waitcnt vmcnt(21)
  ds_read_b64_tr_b16 a[160:161], v28 offset:0
  ds_read_b64_tr_b16 a[162:163], v28 offset:256
  ds_read_b64_tr_b16 a[164:165], v28 offset:1024
  ds_read_b64_tr_b16 a[166:167], v28 offset:1280
  ds_read_b64_tr_b16 a[168:169], v28 offset:8
  ds_read_b64_tr_b16 a[170:171], v28 offset:264
  ds_read_b64_tr_b16 a[172:173], v28 offset:1032
  ds_read_b64_tr_b16 a[174:175], v28 offset:1288
  s_waitcnt lgkmcnt(0)
  s_xor_b32 s36, s13, 2
  s_lshl_b32 s36, s36, 15
  s_add_u32 m0, s39, 0
  s_add_u32 s37, s36, 0
  buffer_load_dwordx4 v26, s[48:51], s37 offen lds
  s_add_u32 m0, s39, 1024
  s_add_u32 s37, s36, 8192
  buffer_load_dwordx4 v26, s[48:51], s37 offen lds
  s_add_u32 m0, s39, 2048
  s_add_u32 s37, s36, 16384
  buffer_load_dwordx4 v26, s[48:51], s37 offen lds
  s_add_u32 m0, s39, 3072
  s_add_u32 s37, s36, 24576
  buffer_load_dwordx4 v26, s[48:51], s37 offen lds
  s_waitcnt vmcnt(21)
  ds_read_b64_tr_b16 a[176:177], v28 offset:4096
  ds_read_b64_tr_b16 a[178:179], v28 offset:4352
  ds_read_b64_tr_b16 a[180:181], v28 offset:5120
  ds_read_b64_tr_b16 a[182:183], v28 offset:5376
  ds_read_b64_tr_b16 a[184:185], v28 offset:4104
  ds_read_b64_tr_b16 a[186:187], v28 offset:4360
  ds_read_b64_tr_b16 a[188:189], v28 offset:5128
  ds_read_b64_tr_b16 a[190:191], v28 offset:5384
  s_waitcnt lgkmcnt(0)
  s_xor_b32 s36, s13, 3
  s_lshl_b32 s36, s36, 15
  s_add_u32 m0, s39, 4096
  s_add_u32 s37, s36, 0
  buffer_load_dwordx4 v26, s[48:51], s37 offen lds
  s_add_u32 m0, s39, 5120
  s_add_u32 s37, s36, 8192
  buffer_load_dwordx4 v26, s[48:51], s37 offen lds
  s_add_u32 m0, s39, 6144
  s_add_u32 s37, s36, 16384
  buffer_load_dwordx4 v26, s[48:51], s37 offen lds
  s_add_u32 m0, s39, 7168
  s_add_u32 s37, s36, 24576
  buffer_load_dwordx4 v26, s[48:51], s37 offen lds
  s_waitcnt vmcnt(12)
  ds_read_b64_tr_b16 a[192:193], v28 offset:8192
  ds_read_b64_tr_b16 a[194:195], v28 offset:8448
  ds_read_b64_tr_b16 a[196:197], v28 offset:9216
  ds_read_b64_tr_b16 a[198:199], v28 offset:9472
  ds_read_b64_tr_b16 a[200:201], v28 offset:8200
  ds_read_b64_tr_b16 a[202:203], v28 offset:8456
  ds_read_b64_tr_b16 a[204:205], v28 offset:9224
  ds_read_b64_tr_b16 a[206:207], v28 offset:9480
  s_waitcnt lgkmcnt(0)
  s_xor_b32 s36, s13, 2
  s_lshl_b32 s36, s36, 19
  s_add_u32 m0, s39, 8192
  s_add_u32 s37, s36, 0
  buffer_load_dwordx4 v25, s[8:11], s37 offen lds
  s_add_u32 m0, s39, 9216
  s_add_u32 s37, s36, 131072
  buffer_load_dwordx4 v25, s[8:11], s37 offen lds
  s_add_u32 m0, s39, 10240
  s_add_u32 s37, s36, 262144
  buffer_load_dwordx4 v25, s[8:11], s37 offen lds
  s_add_u32 m0, s39, 11264
  s_add_u32 s37, s36, 393216
  buffer_load_dwordx4 v25, s[8:11], s37 offen lds
  s_barrier
  s_cmp_lg_u32 s13, 0
  s_cbranch_scc1 T_arm_72
  s_getreg_b32 s36, hwreg(HW_REG_XCC_ID, 0, 3)
  s_lshl_b32 s36, s36, 3
  s_lshl_b64 s[60:61], 1, s36
  s_mov_b32 s62, 1
  s_atomic_add_x2 s[60:61], s[52:53], 0
  s_atomic_add s62, s[52:53], 128
  v_lshl_or_b32 v44, v45, 16, v44
  v_lshl_or_b32 v46, v47, 16, v46
  v_min_u32 v44, -2, v44
  v_min_u32 v46, -2, v46
  s_mov_b32 s36, 145752064
  s_mov_b32 s37, 145756160
  buffer_store_dword v44, v8, s[4:7], s36 offen sc1
  buffer_store_dword v46, v8, s[4:7], s37 offen sc1
T_arm_72:
  s_waitcnt vmcnt(12)
  ds_read_b64_tr_b16 a[208:209], v28 offset:12288
  ds_read_b64_tr_b16 a[210:211], v28 offset:12544
  ds_read_b64_tr_b16 a[212:213], v28 offset:13312
  ds_read_b64_tr_b16 a[214:215], v28 offset:13568
  ds_read_b64_tr_b16 a[216:217], v28 offset:12296
  ds_read_b64_tr_b16 a[218:219], v28 offset:12552
  ds_read_b64_tr_b16 a[220:221], v28 offset:13320
  ds_read_b64_tr_b16 a[222:223], v28 offset:13576
  s_waitcnt lgkmcnt(0)
  s_xor_b32 s36, s13, 3
  s_lshl_b32 s36, s36, 19
  s_add_u32 m0, s39, 12288
  s_add_u32 s37, s36, 0
  buffer_load_dwordx4 v25, s[8:11], s37 offen lds
  s_add_u32 m0, s39, 13312
  s_add_u32 s37, s36, 131072
  buffer_load_dwordx4 v25, s[8:11], s37 offen lds
  s_add_u32 m0, s39, 14336
  s_add_u32 s37, s36, 262144
  buffer_load_dwordx4 v25, s[8:11], s37 offen lds
  s_add_u32 m0, s39, 15360
  s_add_u32 s37, s36, 393216
  buffer_load_dwordx4 v25, s[8:11], s37 offen lds
  s_waitcnt vmcnt(12)
  ds_read_b64_tr_b16 a[224:225], v28 offset:0
  ds_read_b64_tr_b16 a[226:227], v28 offset:256
  ds_read_b64_tr_b16 a[228:229], v28 offset:1024
  ds_read_b64_tr_b16 a[230:231], v28 offset:1280
  ds_read_b64_tr_b16 a[232:233], v28 offset:8
  ds_read_b64_tr_b16 a[234:235], v28 offset:264
  ds_read_b64_tr_b16 a[236:237], v28 offset:1032
  ds_read_b64_tr_b16 a[238:239], v28 offset:1288
  s_waitcnt lgkmcnt(0)
  s_xor_b32 s36, s13, 4
  s_lshl_b32 s36, s36, 19
  s_add_u32 m0, s39, 0
  s_add_u32 s37, s36, 0
  buffer_load_dwordx4 v25, s[8:11], s37 offen lds
  s_add_u32 m0, s39, 1024
  s_add_u32 s37, s36, 131072
  buffer_load_dwordx4 v25, s[8:11], s37 offen lds
  s_add_u32 m0, s39, 2048
  s_add_u32 s37, s36, 262144
  buffer_load_dwordx4 v25, s[8:11], s37 offen lds
  s_add_u32 m0, s39, 3072
  s_add_u32 s37, s36, 393216
  buffer_load_dwordx4 v25, s[8:11], s37 offen lds
  s_waitcnt vmcnt(12)
  ds_read_b64_tr_b16 a[240:241], v28 offset:4096
  ds_read_b64_tr_b16 a[242:243], v28 offset:4352
  ds_read_b64_tr_b16 a[244:245], v28 offset:5120
  ds_read_b64_tr_b16 a[246:247], v28 offset:5376
  ds_read_b64_tr_b16 a[248:249], v28 offset:4104
  ds_read_b64_tr_b16 a[250:251], v28 offset:4360
  ds_read_b64_tr_b16 a[252:253], v28 offset:5128
  ds_read_b64_tr_b16 a[254:255], v28 offset:5384
  s_waitcnt lgkmcnt(0)
  s_xor_b32 s36, s13, 5
  s_lshl_b32 s36, s36, 19
  s_add_u32 m0, s39, 4096
  s_add_u32 s37, s36, 0
  buffer_load_dwordx4 v25, s[8:11], s37 offen lds
  s_add_u32 m0, s39, 5120
  s_add_u32 s37, s36, 131072
  buffer_load_dwordx4 v25, s[8:11], s37 offen lds
  s_add_u32 m0, s39, 6144
  s_add_u32 s37, s36, 262144
  buffer_load_dwordx4 v25, s[8:11], s37 offen lds
  s_add_u32 m0, s39, 7168
  s_add_u32 s37, s36, 393216
  buffer_load_dwordx4 v25, s[8:11], s37 offen lds
  s_waitcnt vmcnt(12)
  ds_read_b64_tr_b16 v[160:161], v27 offset:8192
  ds_read_b64_tr_b16 v[162:163], v27 offset:8320
  ds_read_b64_tr_b16 v[164:165], v27 offset:9216
  ds_read_b64_tr_b16 v[166:167], v27 offset:9344
  ds_read_b64_tr_b16 v[168:169], v36 offset:8192
  ds_read_b64_tr_b16 v[170:171], v36 offset:8320
  ds_read_b64_tr_b16 v[172:173], v36 offset:9216
  ds_read_b64_tr_b16 v[174:175], v36 offset:9344
  s_waitcnt lgkmcnt(0)
  s_xor_b32 s36, s13, 4
  s_lshl_b32 s36, s36, 19
  s_add_u32 m0, s39, 8192
  s_add_u32 s37, s36, 0
  buffer_load_dwordx4 v25, s[40:43], s37 offen lds
  s_add_u32 m0, s39, 9216
  s_add_u32 s37, s36, 131072
  buffer_load_dwordx4 v25, s[40:43], s37 offen lds
  s_add_u32 m0, s39, 10240
  s_add_u32 s37, s36, 262144
  buffer_load_dwordx4 v25, s[40:43], s37 offen lds
  s_add_u32 m0, s39, 11264
  s_add_u32 s37, s36, 393216
  buffer_load_dwordx4 v25, s[40:43], s37 offen lds
  s_waitcnt vmcnt(12)
  ds_read_b64_tr_b16 v[192:193], v27 offset:12288
  ds_read_b64_tr_b16 v[194:195], v27 offset:12416
  ds_read_b64_tr_b16 v[196:197], v27 offset:13312
  ds_read_b64_tr_b16 v[198:199], v27 offset:13440
  ds_read_b64_tr_b16 v[200:201], v36 offset:12288
  ds_read_b64_tr_b16 v[202:203], v36 offset:12416
  ds_read_b64_tr_b16 v[204:205], v36 offset:13312
  ds_read_b64_tr_b16 v[206:207], v36 offset:13440
  s_waitcnt lgkmcnt(0)
  s_xor_b32 s36, s13, 5
  s_lshl_b32 s36, s36, 19
  s_add_u32 m0, s39, 12288
  s_add_u32 s37, s36, 0
  buffer_load_dwordx4 v25, s[40:43], s37 offen lds
  s_add_u32 m0, s39, 13312
  s_add_u32 s37, s36, 131072
  buffer_load_dwordx4 v25, s[40:43], s37 offen lds
  s_add_u32 m0, s39, 14336
  s_add_u32 s37, s36, 262144
  buffer_load_dwordx4 v25, s[40:43], s37 offen lds
  s_add_u32 m0, s39, 15360
  s_add_u32 s37, s36, 393216
  buffer_load_dwordx4 v25, s[40:43], s37 offen lds
  s_waitcnt vmcnt(12)
  ds_read_b64_tr_b16 v[224:225], v27 offset:0
  ds_read_b64_tr_b16 v[226:227], v27 offset:128
  ds_read_b64_tr_b16 v[228:229], v27 offset:1024
  ds_read_b64_tr_b16 v[230:231], v27 offset:1152
  ds_read_b64_tr_b16 v[232:233], v36 offset:0
  ds_read_b64_tr_b16 v[234:235], v36 offset:128
  ds_read_b64_tr_b16 v[236:237], v36 offset:1024
  ds_read_b64_tr_b16 v[238:239], v36 offset:1152
  s_waitcnt lgkmcnt(0)
  s_xor_b32 s36, s13, 4
  s_lshl_b32 s36, s36, 19
  s_add_u32 m0, s39, 0
  s_add_u32 s37, s36, 0
  buffer_load_dwordx4 v25, s[44:47], s37 offen lds
  s_add_u32 m0, s39, 1024
  s_add_u32 s37, s36, 131072
  buffer_load_dwordx4 v25, s[44:47], s37 offen lds
  s_add_u32 m0, s39, 2048
  s_add_u32 s37, s36, 262144
  buffer_load_dwordx4 v25, s[44:47], s37 offen lds
  s_add_u32 m0, s39, 3072
  s_add_u32 s37, s36, 393216
  buffer_load_dwordx4 v25, s[44:47], s37 offen lds
  s_waitcnt vmcnt(12)
  ds_read_b64_tr_b16 a[16:17], v27 offset:4096
  ds_read_b64_tr_b16 a[18:19], v27 offset:4224
  ds_read_b64_tr_b16 a[20:21], v27 offset:5120
  ds_read_b64_tr_b16 a[22:23], v27 offset:5248
  ds_read_b64_tr_b16 a[24:25], v36 offset:4096
  ds_read_b64_tr_b16 a[26:27], v36 offset:4224
  ds_read_b64_tr_b16 a[28:29], v36 offset:5120
  ds_read_b64_tr_b16 a[30:31], v36 offset:5248
  s_waitcnt lgkmcnt(0)
  s_xor_b32 s36, s13, 5
  s_lshl_b32 s36, s36, 19
  s_add_u32 m0, s39, 4096
  s_add_u32 s37, s36, 0
  buffer_load_dwordx4 v25, s[44:47], s37 offen lds
  s_add_u32 m0, s39, 5120
  s_add_u32 s37, s36, 131072
  buffer_load_dwordx4 v25, s[44:47], s37 offen lds
  s_add_u32 m0, s39, 6144
  s_add_u32 s37, s36, 262144
  buffer_load_dwordx4 v25, s[44:47], s37 offen lds
  s_add_u32 m0, s39, 7168
  s_add_u32 s37, s36, 393216
  buffer_load_dwordx4 v25, s[44:47], s37 offen lds
  s_waitcnt vmcnt(12)
  ds_read_b64_tr_b16 v[240:241], v27 offset:8192
  ds_read_b64_tr_b16 v[242:243], v27 offset:8320
  ds_read_b64_tr_b16 v[244:245], v27 offset:9216
  ds_read_b64_tr_b16 v[246:247], v27 offset:9344
  ds_read_b64_tr_b16 v[248:249], v36 offset:8192
  ds_read_b64_tr_b16 v[250:251], v36 offset:8320
  ds_read_b64_tr_b16 v[252:253], v36 offset:9216
  ds_read_b64_tr_b16 v[254:255], v36 offset:9344
  s_waitcnt lgkmcnt(0)
  s_xor_b32 s36, s13, 6
  s_lshl_b32 s36, s36, 19
  s_add_u32 m0, s39, 8192
  s_add_u32 s37, s36, 0
  buffer_load_dwordx4 v25, s[8:11], s37 offen lds
  s_add_u32 m0, s39, 9216
  s_add_u32 s37, s36, 131072
  buffer_load_dwordx4 v25, s[8:11], s37 offen lds
  s_add_u32 m0, s39, 10240
  s_add_u32 s37, s36, 262144
  buffer_load_dwordx4 v25, s[8:11], s37 offen lds
  s_add_u32 m0, s39, 11264
  s_add_u32 s37, s36, 393216
  buffer_load_dwordx4 v25, s[8:11], s37 offen lds
  s_waitcnt vmcnt(12)
  ds_read_b64_tr_b16 a[32:33], v27 offset:12288
  ds_read_b64_tr_b16 a[34:35], v27 offset:12416
  ds_read_b64_tr_b16 a[36:37], v27 offset:13312
  ds_read_b64_tr_b16 a[38:39], v27 offset:13440
  ds_read_b64_tr_b16 a[40:41], v36 offset:12288
  ds_read_b64_tr_b16 a[42:43], v36 offset:12416
  ds_read_b64_tr_b16 a[44:45], v36 offset:13312
  ds_read_b64_tr_b16 a[46:47], v36 offset:13440
  s_waitcnt lgkmcnt(0)
  s_xor_b32 s36, s13, 7
  s_lshl_b32 s36, s36, 19
  s_add_u32 m0, s39, 12288
  s_add_u32 s37, s36, 0
  buffer_load_dwordx4 v25, s[8:11], s37 offen lds
  s_add_u32 m0, s39, 13312
  s_add_u32 s37, s36, 131072
  buffer_load_dwordx4 v25, s[8:11], s37 offen lds
  s_add_u32 m0, s39, 14336
  s_add_u32 s37, s36, 262144
  buffer_load_dwordx4 v25, s[8:11], s37 offen lds
  s_add_u32 m0, s39, 15360
  s_add_u32 s37, s36, 393216
  buffer_load_dwordx4 v25, s[8:11], s37 offen lds
  s_waitcnt vmcnt(12)
  ds_read_b64_tr_b16 a[0:1], v27 offset:0
  ds_read_b64_tr_b16 a[2:3], v27 offset:128
  ds_read_b64_tr_b16 a[4:5], v27 offset:1024
  ds_read_b64_tr_b16 a[6:7], v27 offset:1152
  ds_read_b64_tr_b16 a[8:9], v36 offset:0
  ds_read_b64_tr_b16 a[10:11], v36 offset:128
  ds_read_b64_tr_b16 a[12:13], v36 offset:1024
  ds_read_b64_tr_b16 a[14:15], v36 offset:1152
  s_waitcnt lgkmcnt(0)
  s_xor_b32 s36, s13, 6
  s_lshl_b32 s36, s36, 19
  s_add_u32 m0, s39, 0
  s_add_u32 s37, s36, 0
  buffer_load_dwordx4 v25, s[40:43], s37 offen lds
  s_add_u32 m0, s39, 1024
  s_add_u32 s37, s36, 131072
  buffer_load_dwordx4 v25, s[40:43], s37 offen lds
  s_add_u32 m0, s39, 2048
  s_add_u32 s37, s36, 262144
  buffer_load_dwordx4 v25, s[40:43], s37 offen lds
  s_add_u32 m0, s39, 3072
  s_add_u32 s37, s36, 393216
  buffer_load_dwordx4 v25, s[40:43], s37 offen lds
  s_waitcnt vmcnt(12)
  ds_read_b64_tr_b16 a[48:49], v27 offset:4096
  ds_read_b64_tr_b16 a[50:51], v27 offset:4224
  ds_read_b64_tr_b16 a[52:53], v27 offset:5120
  ds_read_b64_tr_b16 a[54:55], v27 offset:5248
  ds_read_b64_tr_b16 a[56:57], v36 offset:4096
  ds_read_b64_tr_b16 a[58:59], v36 offset:4224
  ds_read_b64_tr_b16 a[60:61], v36 offset:5120
  ds_read_b64_tr_b16 a[62:63], v36 offset:5248
  s_waitcnt lgkmcnt(0)
  s_xor_b32 s36, s13, 7
  s_lshl_b32 s36, s36, 19
  s_add_u32 m0, s39, 4096
  s_add_u32 s37, s36, 0
  buffer_load_dwordx4 v25, s[40:43], s37 offen lds
  s_add_u32 m0, s39, 5120
  s_add_u32 s37, s36, 131072
  buffer_load_dwordx4 v25, s[40:43], s37 offen lds
  s_add_u32 m0, s39, 6144
  s_add_u32 s37, s36, 262144
  buffer_load_dwordx4 v25, s[40:43], s37 offen lds
  s_add_u32 m0, s39, 7168
  s_add_u32 s37, s36, 393216
  buffer_load_dwordx4 v25, s[40:43], s37 offen lds
  s_waitcnt vmcnt(12)
  ds_read_b64_tr_b16 a[64:65], v27 offset:8192
  ds_read_b64_tr_b16 a[66:67], v27 offset:8320
  ds_read_b64_tr_b16 a[68:69], v27 offset:9216
  ds_read_b64_tr_b16 a[70:71], v27 offset:9344
  ds_read_b64_tr_b16 a[72:73], v36 offset:8192
  ds_read_b64_tr_b16 a[74:75], v36 offset:8320
  ds_read_b64_tr_b16 a[76:77], v36 offset:9216
  ds_read_b64_tr_b16 a[78:79], v36 offset:9344
  s_waitcnt lgkmcnt(0)
  s_xor_b32 s36, s13, 6
  s_lshl_b32 s36, s36, 19
  s_add_u32 m0, s39, 8192
  s_add_u32 s37, s36, 0
  buffer_load_dwordx4 v25, s[44:47], s37 offen lds
  s_add_u32 m0, s39, 9216
  s_add_u32 s37, s36, 131072
  buffer_load_dwordx4 v25, s[44:47], s37 offen lds
  s_add_u32 m0, s39, 10240
  s_add_u32 s37, s36, 262144
  buffer_load_dwordx4 v25, s[44:47], s37 offen lds
  s_add_u32 m0, s39, 11264
  s_add_u32 s37, s36, 393216
  buffer_load_dwordx4 v25, s[44:47], s37 offen lds
  s_waitcnt vmcnt(12)
  ds_read_b64_tr_b16 a[112:113], v27 offset:12288
  ds_read_b64_tr_b16 a[114:115], v27 offset:12416
  ds_read_b64_tr_b16 a[116:117], v27 offset:13312
  ds_read_b64_tr_b16 a[118:119], v27 offset:13440
  ds_read_b64_tr_b16 a[120:121], v36 offset:12288
  ds_read_b64_tr_b16 a[122:123], v36 offset:12416
  ds_read_b64_tr_b16 a[124:125], v36 offset:13312
  ds_read_b64_tr_b16 a[126:127], v36 offset:13440
  s_waitcnt lgkmcnt(0)
  s_xor_b32 s36, s13, 7
  s_lshl_b32 s36, s36, 19
  s_add_u32 m0, s39, 12288
  s_add_u32 s37, s36, 0
  buffer_load_dwordx4 v25, s[44:47], s37 offen lds
  s_add_u32 m0, s39, 13312
  s_add_u32 s37, s36, 131072
  buffer_load_dwordx4 v25, s[44:47], s37 offen lds
  s_add_u32 m0, s39, 14336
  s_add_u32 s37, s36, 262144
  buffer_load_dwordx4 v25, s[44:47], s37 offen lds
  s_add_u32 m0, s39, 15360
  s_add_u32 s37, s36, 393216
  buffer_load_dwordx4 v25, s[44:47], s37 offen lds
  s_waitcnt vmcnt(12)
  ds_read_b64_tr_b16 a[80:81], v27 offset:0
  ds_read_b64_tr_b16 a[82:83], v27 offset:128
  ds_read_b64_tr_b16 a[84:85], v27 offset:1024
  ds_read_b64_tr_b16 a[86:87], v27 offset:1152
  ds_read_b64_tr_b16 a[88:89], v36 offset:0
  ds_read_b64_tr_b16 a[90:91], v36 offset:128
  ds_read_b64_tr_b16 a[92:93], v36 offset:1024
  ds_read_b64_tr_b16 a[94:95], v36 offset:1152
  s_waitcnt lgkmcnt(0)
  s_xor_b32 s36, s13, 1
  s_lshl_b32 s36, s36, 19
  s_add_u32 m0, s39, 16384
  s_add_u32 s37, s36, 0
  buffer_load_dwordx4 v25, s[8:11], s37 offen lds
  s_add_u32 m0, s39, 17408
  s_add_u32 s37, s36, 131072
  buffer_load_dwordx4 v25, s[8:11], s37 offen lds
  s_add_u32 m0, s39, 18432
  s_add_u32 s37, s36, 262144
  buffer_load_dwordx4 v25, s[8:11], s37 offen lds
  s_add_u32 m0, s39, 19456
  s_add_u32 s37, s36, 393216
  buffer_load_dwordx4 v25, s[8:11], s37 offen lds
  s_waitcnt vmcnt(12)
  ds_read_b64_tr_b16 a[128:129], v27 offset:4096
  ds_read_b64_tr_b16 a[130:131], v27 offset:4224
  ds_read_b64_tr_b16 a[132:133], v27 offset:5120
  ds_read_b64_tr_b16 a[134:135], v27 offset:5248
  ds_read_b64_tr_b16 a[136:137], v36 offset:4096
  ds_read_b64_tr_b16 a[138:139], v36 offset:4224
  ds_read_b64_tr_b16 a[140:141], v36 offset:5120
  ds_read_b64_tr_b16 a[142:143], v36 offset:5248
  s_waitcnt lgkmcnt(0)
  s_xor_b32 s36, s13, 0
  s_lshl_b32 s36, s36, 19
  s_add_u32 m0, s39, 0
  s_add_u32 s37, s36, 0
  buffer_load_dwordx4 v25, s[8:11], s37 offen lds
  s_add_u32 m0, s39, 1024
  s_add_u32 s37, s36, 131072
  buffer_load_dwordx4 v25, s[8:11], s37 offen lds
  s_add_u32 m0, s39, 2048
  s_add_u32 s37, s36, 262144
  buffer_load_dwordx4 v25, s[8:11], s37 offen lds
  s_add_u32 m0, s39, 3072
  s_add_u32 s37, s36, 393216
  buffer_load_dwordx4 v25, s[8:11], s37 offen lds
  s_waitcnt vmcnt(12)
  ds_read_b64_tr_b16 a[96:97], v27 offset:8192
  ds_read_b64_tr_b16 a[98:99], v27 offset:8320
  ds_read_b64_tr_b16 a[100:101], v27 offset:9216
  ds_read_b64_tr_b16 a[102:103], v27 offset:9344
  ds_read_b64_tr_b16 a[104:105], v36 offset:8192
  ds_read_b64_tr_b16 a[106:107], v36 offset:8320
  ds_read_b64_tr_b16 a[108:109], v36 offset:9216
  ds_read_b64_tr_b16 a[110:111], v36 offset:9344
  s_waitcnt lgkmcnt(0)
  s_xor_b32 s36, s13, 1
  s_lshl_b32 s36, s36, 19
  s_add_u32 m0, s39, 8192
  s_add_u32 s37, s36, 0
  buffer_load_dwordx4 v25, s[40:43], s37 offen lds
  s_add_u32 m0, s39, 9216
  s_add_u32 s37, s36, 131072
  buffer_load_dwordx4 v25, s[40:43], s37 offen lds
  s_add_u32 m0, s39, 10240
  s_add_u32 s37, s36, 262144
  buffer_load_dwordx4 v25, s[40:43], s37 offen lds
  s_add_u32 m0, s39, 11264
  s_add_u32 s37, s36, 393216
  buffer_load_dwordx4 v25, s[40:43], s37 offen lds
  s_waitcnt vmcnt(12)
  ds_read_b64_tr_b16 a[144:145], v27 offset:12288
  ds_read_b64_tr_b16 a[146:147], v27 offset:12416
  ds_read_b64_tr_b16 a[148:149], v27 offset:13312
  ds_read_b64_tr_b16 a[150:151], v27 offset:13440
  ds_read_b64_tr_b16 a[152:153], v36 offset:12288
  ds_read_b64_tr_b16 a[154:155], v36 offset:12416
  ds_read_b64_tr_b16 a[156:157], v36 offset:13312
  ds_read_b64_tr_b16 a[158:159], v36 offset:13440
  s_waitcnt lgkmcnt(0)
  s_xor_b32 s36, s13, 0
  s_lshl_b32 s36, s36, 19
  s_add_u32 m0, s39, 4096
  s_add_u32 s37, s36, 0
  buffer_load_dwordx4 v25, s[40:43], s37 offen lds
  s_add_u32 m0, s39, 5120
  s_add_u32 s37, s36, 131072
  buffer_load_dwordx4 v25, s[40:43], s37 offen lds
  s_add_u32 m0, s39, 6144
  s_add_u32 s37, s36, 262144
  buffer_load_dwordx4 v25, s[40:43], s37 offen lds
  s_add_u32 m0, s39, 7168
  s_add_u32 s37, s36, 393216
  buffer_load_dwordx4 v25, s[40:43], s37 offen lds
  s_waitcnt vmcnt(12)
  ds_read_b64_tr_b16 v[128:129], v27 offset:16384
  ds_read_b64_tr_b16 v[130:131], v27 offset:16512
  ds_read_b64_tr_b16 v[132:133], v27 offset:17408
  ds_read_b64_tr_b16 v[134:135], v27 offset:17536
  ds_read_b64_tr_b16 v[136:137], v36 offset:16384
  ds_read_b64_tr_b16 v[138:139], v36 offset:16512
  ds_read_b64_tr_b16 v[140:141], v36 offset:17408
  ds_read_b64_tr_b16 v[142:143], v36 offset:17536
  s_waitcnt lgkmcnt(0)
  s_xor_b32 s36, s13, 2
  s_lshl_b32 s36, s36, 19
  s_add_u32 m0, s39, 12288
  s_add_u32 s37, s36, 0
  buffer_load_dwordx4 v25, s[40:43], s37 offen lds
  s_add_u32 m0, s39, 13312
  s_add_u32 s37, s36, 131072
  buffer_load_dwordx4 v25, s[40:43], s37 offen lds
  s_add_u32 m0, s39, 14336
  s_add_u32 s37, s36, 262144
  buffer_load_dwordx4 v25, s[40:43], s37 offen lds
  s_add_u32 m0, s39, 15360
  s_add_u32 s37, s36, 393216
  buffer_load_dwordx4 v25, s[40:43], s37 offen lds
  s_waitcnt vmcnt(12)
  ds_read_b64_tr_b16 v[64:65], v27 offset:0
  ds_read_b64_tr_b16 v[66:67], v27 offset:128
  ds_read_b64_tr_b16 v[68:69], v27 offset:1024
  ds_read_b64_tr_b16 v[70:71], v27 offset:1152
  ds_read_b64_tr_b16 v[72:73], v36 offset:0
  ds_read_b64_tr_b16 v[74:75], v36 offset:128
  ds_read_b64_tr_b16 v[76:77], v36 offset:1024
  ds_read_b64_tr_b16 v[78:79], v36 offset:1152
  s_waitcnt lgkmcnt(0)
  ds_write_b128 v4, v[64:67] offset:0
  ds_write_b128 v4, v[68:71] offset:1024
  ds_write_b128 v4, v[72:75] offset:2048
  ds_write_b128 v4, v[76:79] offset:3072
  s_waitcnt lgkmcnt(0)
  s_xor_b32 s36, s13, 3
  s_lshl_b32 s36, s36, 19
  s_add_u32 m0, s39, 16384
  s_add_u32 s37, s36, 0
  buffer_load_dwordx4 v25, s[40:43], s37 offen lds
  s_add_u32 m0, s39, 17408
  s_add_u32 s37, s36, 131072
  buffer_load_dwordx4 v25, s[40:43], s37 offen lds
  s_add_u32 m0, s39, 18432
  s_add_u32 s37, s36, 262144
  buffer_load_dwordx4 v25, s[40:43], s37 offen lds
  s_add_u32 m0, s39, 19456
  s_add_u32 s37, s36, 393216
  buffer_load_dwordx4 v25, s[40:43], s37 offen lds
  s_waitcnt vmcnt(12)
  ds_read_b64_tr_b16 v[144:145], v27 offset:8192
  ds_read_b64_tr_b16 v[146:147], v27 offset:8320
  ds_read_b64_tr_b16 v[148:149], v27 offset:9216
  ds_read_b64_tr_b16 v[150:151], v27 offset:9344
  ds_read_b64_tr_b16 v[152:153], v36 offset:8192
  ds_read_b64_tr_b16 v[154:155], v36 offset:8320
  ds_read_b64_tr_b16 v[156:157], v36 offset:9216
  ds_read_b64_tr_b16 v[158:159], v36 offset:9344
  s_waitcnt lgkmcnt(0)
  s_xor_b32 s36, s13, 3
  s_lshl_b32 s36, s36, 19
  s_add_u32 m0, s39, 24576
  s_add_u32 s37, s36, 0
  buffer_load_dwordx4 v25, s[44:47], s37 offen lds
  s_add_u32 m0, s39, 25600
  s_add_u32 s37, s36, 131072
  buffer_load_dwordx4 v25, s[44:47], s37 offen lds
  s_add_u32 m0, s39, 26624
  s_add_u32 s37, s36, 262144
  buffer_load_dwordx4 v25, s[44:47], s37 offen lds
  s_add_u32 m0, s39, 27648
  s_add_u32 s37, s36, 393216
  buffer_load_dwordx4 v25, s[44:47], s37 offen lds
  buffer_load_dwordx2 v[54:55], off, s[72:75], 0 sc1
  buffer_load_dword v56, off, s[72:75], 0 offset:128 sc1
  s_waitcnt vmcnt(14)
  ds_read_b64_tr_b16 v[64:65], v27 offset:4096
  ds_read_b64_tr_b16 v[66:67], v27 offset:4224
  ds_read_b64_tr_b16 v[68:69], v27 offset:5120
  ds_read_b64_tr_b16 v[70:71], v27 offset:5248
  ds_read_b64_tr_b16 v[72:73], v36 offset:4096
  ds_read_b64_tr_b16 v[74:75], v36 offset:4224
  ds_read_b64_tr_b16 v[76:77], v36 offset:5120
  ds_read_b64_tr_b16 v[78:79], v36 offset:5248
  s_waitcnt lgkmcnt(0)
  ds_write_b128 v4, v[64:67] offset:4096
  ds_write_b128 v4, v[68:71] offset:5120
  ds_write_b128 v4, v[72:75] offset:6144
  ds_write_b128 v4, v[76:79] offset:7168
  s_waitcnt lgkmcnt(0)
  s_xor_b32 s36, s13, 2
  s_lshl_b32 s36, s36, 19
  s_add_u32 m0, s39, 20480
  s_add_u32 s37, s36, 0
  buffer_load_dwordx4 v25, s[44:47], s37 offen lds
  s_add_u32 m0, s39, 21504
  s_add_u32 s37, s36, 131072
  buffer_load_dwordx4 v25, s[44:47], s37 offen lds
  s_add_u32 m0, s39, 22528
  s_add_u32 s37, s36, 262144
  buffer_load_dwordx4 v25, s[44:47], s37 offen lds
  s_add_u32 m0, s39, 23552
  s_add_u32 s37, s36, 393216
  buffer_load_dwordx4 v25, s[44:47], s37 offen lds
  s_waitcnt vmcnt(14)
  ds_read_b64_tr_b16 v[176:177], v27 offset:12288
  ds_read_b64_tr_b16 v[178:179], v27 offset:12416
  ds_read_b64_tr_b16 v[180:181], v27 offset:13312
  ds_read_b64_tr_b16 v[182:183], v27 offset:13440
  ds_read_b64_tr_b16 v[184:185], v36 offset:12288
  ds_read_b64_tr_b16 v[186:187], v36 offset:12416
  ds_read_b64_tr_b16 v[188:189], v36 offset:13312
  ds_read_b64_tr_b16 v[190:191], v36 offset:13440
  s_waitcnt lgkmcnt(0)
  s_xor_b32 s36, s13, 0
  s_lshl_b32 s36, s36, 19
  s_add_u32 m0, s39, 8192
  s_add_u32 s37, s36, 0
  buffer_load_dwordx4 v25, s[44:47], s37 offen lds
  s_add_u32 m0, s39, 9216
  s_add_u32 s37, s36, 131072
  buffer_load_dwordx4 v25, s[44:47], s37 offen lds
  s_add_u32 m0, s39, 10240
  s_add_u32 s37, s36, 262144
  buffer_load_dwordx4 v25, s[44:47], s37 offen lds
  s_add_u32 m0, s39, 11264
  s_add_u32 s37, s36, 393216
  buffer_load_dwordx4 v25, s[44:47], s37 offen lds
  s_waitcnt vmcnt(14)
  ds_read_b64_tr_b16 v[64:65], v27 offset:16384
  ds_read_b64_tr_b16 v[66:67], v27 offset:16512
  ds_read_b64_tr_b16 v[68:69], v27 offset:17408
  ds_read_b64_tr_b16 v[70:71], v27 offset:17536
  ds_read_b64_tr_b16 v[72:73], v36 offset:16384
  ds_read_b64_tr_b16 v[74:75], v36 offset:16512
  ds_read_b64_tr_b16 v[76:77], v36 offset:17408
  ds_read_b64_tr_b16 v[78:79], v36 offset:17536
  s_waitcnt lgkmcnt(0)
  ds_write_b128 v4, v[64:67] offset:16384
  ds_write_b128 v4, v[68:71] offset:17408
  ds_write_b128 v4, v[72:75] offset:18432
  ds_write_b128 v4, v[76:79] offset:19456
  s_waitcnt lgkmcnt(0)
  s_xor_b32 s36, s13, 1
  s_lshl_b32 s36, s36, 19
  s_add_u32 m0, s39, 12288
  s_add_u32 s37, s36, 0
  buffer_load_dwordx4 v25, s[44:47], s37 offen lds
  s_add_u32 m0, s39, 13312
  s_add_u32 s37, s36, 131072
  buffer_load_dwordx4 v25, s[44:47], s37 offen lds
  s_add_u32 m0, s39, 14336
  s_add_u32 s37, s36, 262144
  buffer_load_dwordx4 v25, s[44:47], s37 offen lds
  s_add_u32 m0, s39, 15360
  s_add_u32 s37, s36, 393216
  buffer_load_dwordx4 v25, s[44:47], s37 offen lds
  s_waitcnt vmcnt(14)
  ds_read_b64_tr_b16 v[208:209], v27 offset:24576
  ds_read_b64_tr_b16 v[210:211], v27 offset:24704
  ds_read_b64_tr_b16 v[212:213], v27 offset:25600
  ds_read_b64_tr_b16 v[214:215], v27 offset:25728
  ds_read_b64_tr_b16 v[216:217], v36 offset:24576
  ds_read_b64_tr_b16 v[218:219], v36 offset:24704
  ds_read_b64_tr_b16 v[220:221], v36 offset:25600
  ds_read_b64_tr_b16 v[222:223], v36 offset:25728
  s_waitcnt lgkmcnt(0)
  s_xor_b32 s36, s13, 2
  s_lshl_b32 s36, s36, 15
  s_add_u32 m0, s39, 24576
  s_add_u32 s37, s36, 512
  buffer_load_dwordx4 v26, s[48:51], s37 offen lds
  s_add_u32 m0, s39, 25600
  s_add_u32 s37, s36, 8704
  buffer_load_dwordx4 v26, s[48:51], s37 offen lds
  s_add_u32 m0, s39, 26624
  s_add_u32 s37, s36, 16896
  buffer_load_dwordx4 v26, s[48:51], s37 offen lds
  s_add_u32 m0, s39, 27648
  s_add_u32 s37, s36, 25088
  buffer_load_dwordx4 v26, s[48:51], s37 offen lds
  s_waitcnt vmcnt(12)
  ds_read_b64_tr_b16 v[64:65], v27 offset:20480
  ds_read_b64_tr_b16 v[66:67], v27 offset:20608
  ds_read_b64_tr_b16 v[68:69], v27 offset:21504
  ds_read_b64_tr_b16 v[70:71], v27 offset:21632
  ds_read_b64_tr_b16 v[72:73], v36 offset:20480
  ds_read_b64_tr_b16 v[74:75], v36 offset:20608
  ds_read_b64_tr_b16 v[76:77], v36 offset:21504
  ds_read_b64_tr_b16 v[78:79], v36 offset:21632
  s_waitcnt lgkmcnt(0)
  ds_write_b128 v4, v[64:67] offset:20480
  ds_write_b128 v4, v[68:71] offset:21504
  ds_write_b128 v4, v[72:75] offset:22528
  ds_write_b128 v4, v[76:79] offset:23552
  s_waitcnt lgkmcnt(0)
  s_xor_b32 s36, s13, 3
  s_lshl_b32 s36, s36, 15
  s_add_u32 m0, s39, 28672
  s_add_u32 s37, s36, 512
  buffer_load_dwordx4 v26, s[48:51], s37 offen lds
  s_add_u32 m0, s39, 29696
  s_add_u32 s37, s36, 8704
  buffer_load_dwordx4 v26, s[48:51], s37 offen lds
  s_add_u32 m0, s39, 30720
  s_add_u32 s37, s36, 16896
  buffer_load_dwordx4 v26, s[48:51], s37 offen lds
  s_add_u32 m0, s39, 31744
  s_add_u32 s37, s36, 25088
  buffer_load_dwordx4 v26, s[48:51], s37 offen lds
  s_mov_b32 s19, 0
  s_branch T_arrgo_74
T_arr_73:
  s_add_u32 s19, s19, 1
  s_cmp_gt_u32 s19, 32768
  s_cbranch_scc1 M_exit
  buffer_load_dwordx2 v[54:55], off, s[72:75], 0 sc1
  buffer_load_dword v56, off, s[72:75], 0 offset:128 sc1
  s_waitcnt vmcnt(0)
T_arrgo_74:
  v_sad_u8 v57, v54, 0, 0
  v_sad_u8 v57, v55, 0, v57
  v_or_b32 v58, v54, v55
  v_cmp_gt_u32 vcc, 32, v57
  s_cbranch_vccnz T_arr_73
  v_cmp_gt_u32 vcc, 0x100, v56
  s_cbranch_vccnz T_arr_73
  v_readfirstlane_b32 s36, v58
  s_nop 0
  s_and_b32 s36, s36, 0x20202020
  s_cselect_b32 s56, 0, 1
  s_mov_b32 s14, -1
  s_mov_b32 s30, -1
  s_mov_b32 s19, 0
  s_branch T_kvok_76
T_kv_75:
  s_sleep 4
  s_add_u32 s19, s19, 1
  s_cmp_gt_u32 s19, 32768
  s_cbranch_scc1 M_exit
T_kvok_76:
  s_add_u32 s39, s99, 128
  s_mov_b32 s38, 0
  s_mov_b32 s37, 0
  s_atomic_or s38, s[58:59], s99 glc
  s_atomic_or s37, s[58:59], s39 glc
  s_waitcnt lgkmcnt(0)
  s_add_u32 s37, s37, 30
  s_cmp_ge_u32 s38, 30
  s_cselect_b32 s38, s37, s38
  s_cmp_ge_u32 s38, 64
  s_cselect_b32 s38, 100, s38
  s_sub_u32 s38, s38, 1
  s_max_i32 s30, s30, s38
  s_cmp_ge_i32 s14, s30
  s_cbranch_scc1 T_kv_75
  s_mov_b32 m0, s31
  s_nop 0
  buffer_load_dwordx4 v9, s[4:7], s27 offen sc1 lds
  s_mov_b32 m0, s32
  s_nop 0
  buffer_load_dwordx4 v9, s[4:7], s27 offen offset:128 sc1 lds
  s_mov_b32 m0, s33
  s_nop 0
  buffer_load_dwordx4 v10, s[4:7], s28 offen sc1 lds
  s_mov_b32 m0, s34
  s_nop 0
  buffer_load_dwordx4 v10, s[4:7], s28 offen offset:256 sc1 lds
  s_add_u32 s27, s27, 8192
  s_add_u32 s28, s28, 8192
  s_lshl_b32 s36, s12, 10
  s_add_u32 s36, s36, 145752064
  buffer_load_dwordx4 v[40:43], v2, s[4:7], s36 offen sc1
  s_waitcnt vmcnt(17)
  ds_read_b64_tr_b16 v[64:65], v27 offset:8192
  ds_read_b64_tr_b16 v[66:67], v27 offset:8320
  ds_read_b64_tr_b16 v[68:69], v27 offset:9216
  ds_read_b64_tr_b16 v[70:71], v27 offset:9344
  ds_read_b64_tr_b16 v[72:73], v36 offset:8192
  ds_read_b64_tr_b16 v[74:75], v36 offset:8320
  ds_read_b64_tr_b16 v[76:77], v36 offset:9216
  ds_read_b64_tr_b16 v[78:79], v36 offset:9344
  s_waitcnt lgkmcnt(0)
  ds_write_b128 v4, v[64:67] offset:8192
  ds_write_b128 v4, v[68:71] offset:9216
  ds_write_b128 v4, v[72:75] offset:10240
  ds_write_b128 v4, v[76:79] offset:11264
  s_waitcnt lgkmcnt(0)
  s_waitcnt vmcnt(13)
  ds_read_b64_tr_b16 v[64:65], v27 offset:12288
  ds_read_b64_tr_b16 v[66:67], v27 offset:12416
  ds_read_b64_tr_b16 v[68:69], v27 offset:13312
  ds_read_b64_tr_b16 v[70:71], v27 offset:13440
  ds_read_b64_tr_b16 v[72:73], v36 offset:12288
  ds_read_b64_tr_b16 v[74:75], v36 offset:12416
  ds_read_b64_tr_b16 v[76:77], v36 offset:13312
  ds_read_b64_tr_b16 v[78:79], v36 offset:13440
  s_waitcnt lgkmcnt(0)
  ds_write_b128 v4, v[64:67] offset:12288
  ds_write_b128 v4, v[68:71] offset:13312
  ds_write_b128 v4, v[72:75] offset:14336
  ds_write_b128 v4, v[76:79] offset:15360
  s_waitcnt lgkmcnt(0)
  s_waitcnt vmcnt(9)
  ds_read_b64_tr_b16 v[64:65], v28 offset:24576
  ds_read_b64_tr_b16 v[66:67], v28 offset:24832
  ds_read_b64_tr_b16 v[68:69], v28 offset:25600
  ds_read_b64_tr_b16 v[70:71], v28 offset:25856
  ds_read_b64_tr_b16 v[72:73], v28 offset:24584
  ds_read_b64_tr_b16 v[74:75], v28 offset:24840
  ds_read_b64_tr_b16 v[76:77], v28 offset:25608
  ds_read_b64_tr_b16 v[78:79], v28 offset:25864
  s_waitcnt lgkmcnt(0)
  ds_write_b128 v4, v[64:67] offset:24576
  ds_write_b128 v4, v[68:71] offset:25600
  ds_write_b128 v4, v[72:75] offset:26624
  ds_write_b128 v4, v[76:79] offset:27648
  s_waitcnt lgkmcnt(0)
  s_waitcnt vmcnt(5)
  ds_read_b64_tr_b16 v[64:65], v28 offset:28672
  ds_read_b64_tr_b16 v[66:67], v28 offset:28928
  ds_read_b64_tr_b16 v[68:69], v28 offset:29696
  ds_read_b64_tr_b16 v[70:71], v28 offset:29952
  ds_read_b64_tr_b16 v[72:73], v28 offset:28680
  ds_read_b64_tr_b16 v[74:75], v28 offset:28936
  ds_read_b64_tr_b16 v[76:77], v28 offset:29704
  ds_read_b64_tr_b16 v[78:79], v28 offset:29960
  s_waitcnt lgkmcnt(0)
  ds_write_b128 v4, v[64:67] offset:28672
  ds_write_b128 v4, v[68:71] offset:29696
  ds_write_b128 v4, v[72:75] offset:30720
  ds_write_b128 v4, v[76:79] offset:31744
  s_waitcnt lgkmcnt(0)
  s_waitcnt vmcnt(0) lgkmcnt(0)
  s_barrier
  ds_read_b128 v[68:71], v4 offset:0
  ds_read_b128 v[72:75], v4 offset:1024
  ds_read_b128 v[76:79], v4 offset:4096
  ds_read_b128 v[80:83], v4 offset:5120
  ds_read_b128 v[84:87], v4 offset:8192
  ds_read_b128 v[88:91], v4 offset:9216
  ds_read_b128 v[92:95], v4 offset:2048
  ds_read_b128 v[96:99], v4 offset:3072
  ds_read_b128 v[100:103], v4 offset:6144
  ds_read_b128 v[104:107], v4 offset:7168
  ds_read_b128 v[108:111], v4 offset:10240
  ds_read_b128 v[112:115], v4 offset:11264
  ds_read_b128 v[28:31], v59 offset:16384
  ds_read_b128 v[32:35], v59 offset:20480
  ds_read_b128 v[36:39], v2 offset:8192
  ds_read_b128 v[40:43], v2 offset:9216
  ds_read_b128 v[44:47], v2 offset:10240
  ds_read_b128 v[48:51], v2 offset:11264
  ds_read_b128 v[52:55], v2 offset:12288
  ds_read_b128 v[56:59], v2 offset:13312
  ds_read_b128 v[60:63], v2 offset:14336
  ds_read_b128 v[64:67], v2 offset:15360
  s_and_b32 s36, s13, 1
  s_lshl_b32 s36, s36, 12
  s_add_u32 s22, s22, s36
  s_add_u32 s23, s36, 145752064
  s_mov_b32 s14, -1
  s_and_b32 s57, s14, 1
  s_and_b32 s36, s14, 3
  s_lshl_b32 s36, s36, 13
  s_add_u32 s26, s36, s23
  s_add_u32 s36, s36, 8192
  s_and_b32 s36, s36, 0x7fff
  s_add_u32 s24, s36, 145752064
  s_add_u32 s25, s36, 145756160
  s_add_u32 s35, s36, s23
  s_waitcnt lgkmcnt(0)
  s_cmp_lg_u32 s56, 0
  s_cbranch_scc1 M_global
  s_cmp_eq_u32 s13, 1
  s_cbranch_scc1 T_w_78
  s_cmp_eq_u32 s13, 2
  s_cbranch_scc1 T_w_79
  s_cmp_eq_u32 s13, 3
  s_cbranch_scc1 T_w_80
T_w_77:
  s_mov_b32 s19, 0
  v_mov_b64 v[16:17], 0
  v_mov_b64 v[18:19], 0
  v_mov_b64 v[20:21], 0
  v_mov_b64 v[22:23], 0
  v_mov_b64 v[24:25], 0
  v_mov_b64 v[26:27], 0
  buffer_load_dwordx4 v[124:127], v2, s[4:7], s24 offen offset:0 sc1
  buffer_load_dwordx4 v[116:119], v2, s[4:7], s25 offen offset:0 sc1
  buffer_load_dwordx4 v[124:127], v2, s[4:7], s24 offen offset:0 sc1
  buffer_load_dwordx4 v[116:119], v2, s[4:7], s25 offen offset:0 sc1
  s_branch T_loop_81
.p2align 6
T_retry_82:
  s_mov_b64 exec, vcc
  buffer_load_dwordx4 v[124:127], v2, s[4:7], s24 offen offset:0 sc1
  buffer_load_dwordx4 v[116:119], v2, s[4:7], s25 offen offset:0 sc1
  s_mov_b64 exec, -1
  s_add_u32 s19, s19, 1
  s_cmp_gt_u32 s19, 32768
  s_cbranch_scc1 M_exit
T_loop_81:
  s_waitcnt vmcnt(3) lgkmcnt(0)
  v_max3_u32 v123, v124, v125, v126
  v_max_u32 v123, v123, v127
  v_mov_b32_dpp v120, v124 row_ror:8 row_mask:0xf bank_mask:0xf
  v_mov_b32_dpp v121, v125 row_ror:8 row_mask:0xf bank_mask:0xf
  s_waitcnt vmcnt(2)
  v_max3_u32 v123, v123, v116, v117
  v_max3_u32 v123, v123, v118, v119
  v_cmp_eq_u32 vcc, -1, v123
  s_cbranch_vccnz T_retry_82
  v_smfmac_f32_16x16x64_bf16 v[16:19], v[124:127], v[68:75], v0
  s_add_u32 s14, s14, 1
  ds_write_b128 v2, v[124:127] offset:0
  v_mov_b32_dpp v122, v126 row_ror:8 row_mask:0xf bank_mask:0xf
  v_smfmac_f32_16x16x64_bf16 v[20:23], v[124:127], v[76:83], v0
  s_and_b32 s57, s14, 1
  v_mov_b32_dpp v123, v127 row_ror:8 row_mask:0xf bank_mask:0xf
  v_smfmac_f32_16x16x64_bf16 v[24:27], v[124:127], v[84:91], v0
  s_and_b32 s36, s14, 3
  ds_write_b128 v2, v[116:119] offset:4096
  v_smfmac_f32_16x16x64_bf16 v[16:19], v[120:123], v[92:99], v0
  s_lshl_b32 s36, s36, 13
  v_mov_b32_dpp v84, v116 row_ror:8 row_mask:0xf bank_mask:0xf
  v_smfmac_f32_16x16x64_bf16 v[20:23], v[120:123], v[100:107], v0
  s_add_u32 s26, s36, s23
  ds_read_b128 v[68:71], v4 offset:12288
  v_mov_b32_dpp v85, v117 row_ror:8 row_mask:0xf bank_mask:0xf
  v_smfmac_f32_16x16x64_bf16 v[24:27], v[120:123], v[108:115], v0
  s_add_u32 s36, s36, 8192
  ds_read_b128 v[72:75], v4 offset:13312
  v_mov_b32_dpp v86, v118 row_ror:8 row_mask:0xf bank_mask:0xf
  v_smfmac_f32_16x16x64_bf16 v[16:19], v[116:119], v[224:231], v0
  s_and_b32 s36, s36, 0x7fff
  ds_read_b128 v[76:79], v4 offset:14336
  v_mov_b32_dpp v87, v119 row_ror:8 row_mask:0xf bank_mask:0xf
  v_smfmac_f32_16x16x64_bf16 v[20:23], v[116:119], v[240:247], v0
  s_waitcnt lgkmcnt(3)
  s_barrier
  ds_read_b128 v[100:103], v2 offset:1024
  v_smfmac_f32_16x16x64_bf16 v[24:27], v[116:119], a[0:7], v0
  s_mov_b32 m0, s31
  ds_read_b128 v[120:123], v1 offset:1024
  v_smfmac_f32_16x16x64_bf16 v[16:19], v[84:87], v[232:239], v0
  s_cmp_ge_i32 s14, s30
  s_cbranch_scc1 T_kvw_85
T_kvb_86:
  v_smfmac_f32_16x16x64_bf16 v[20:23], v[84:87], v[248:255], v0
  ds_read_b128 v[80:83], v4 offset:15360
  buffer_load_dwordx4 v9, s[4:7], s27 offen sc1 lds
  v_smfmac_f32_16x16x64_bf16 v[24:27], v[84:87], a[8:15], v0
  s_waitcnt lgkmcnt(2)
  s_mov_b32 m0, s32
  v_smfmac_f32_16x16x64_bf16 v[16:19], v[100:103], v[128:135], v0
  ds_read_b128 v[92:95], v2 offset:2048
  v_smfmac_f32_16x16x64_bf16 v[20:23], v[100:103], v[144:151], v0
  ds_read_b128 v[96:99], v1 offset:2048
  v_smfmac_f32_16x16x64_bf16 v[24:27], v[100:103], v[68:75], v0
  s_waitcnt vmcnt(1) lgkmcnt(3)
  ds_read_b128 v[116:119], v2 offset:3072
  buffer_load_dwordx4 v9, s[4:7], s27 offen offset:128 sc1 lds
  v_smfmac_f32_16x16x64_bf16 v[16:19], v[120:123], v[136:143], v0
  ds_read_b128 v[124:127], v1 offset:3072
  s_mov_b32 m0, s33
  v_smfmac_f32_16x16x64_bf16 v[20:23], v[120:123], v[152:159], v0
  s_waitcnt lgkmcnt(4)
  ds_read_b128 v[104:107], v2 offset:5120
  v_smfmac_f32_16x16x64_bf16 v[24:27], v[120:123], v[76:83], v0
  s_waitcnt lgkmcnt(4)
  ds_read_b128 v[108:111], v1 offset:5120
  v_smfmac_f32_16x16x64_bf16 v[16:19], v[92:95], v[160:167], v0
  s_waitcnt lgkmcnt(4)
  ds_read_b128 v[112:115], v2 offset:6144
  buffer_load_dwordx4 v10, s[4:7], s28 offen sc1 lds
  v_smfmac_f32_16x16x64_bf16 v[16:19], v[96:99], v[168:175], v0
  s_waitcnt lgkmcnt(4)
  ds_read_b128 v[84:87], v1 offset:6144
  s_mov_b32 m0, s34
  v_smfmac_f32_16x16x64_bf16 v[16:19], v[116:119], v[192:199], v0
  s_waitcnt lgkmcnt(4)
  ds_read_b128 v[88:91], v2 offset:7168
  v_smfmac_f32_16x16x64_bf16 v[16:19], v[124:127], v[200:207], v0
  s_waitcnt lgkmcnt(4)
  ds_read_b128 v[100:103], v1 offset:7168
  v_smfmac_f32_16x16x64_bf16 v[16:19], v[104:107], a[16:23], v0
  s_waitcnt lgkmcnt(4)
  ds_read_b128 v[68:71], v4 offset:16384
  buffer_load_dwordx4 v10, s[4:7], s28 offen offset:256 sc1 lds
  v_smfmac_f32_16x16x64_bf16 v[16:19], v[108:111], a[24:31], v0
  s_waitcnt lgkmcnt(4)
  ds_read_b128 v[72:75], v4 offset:17408
  v_smfmac_f32_16x16x64_bf16 v[16:19], v[112:115], a[64:71], v0
  s_waitcnt lgkmcnt(4)
  ds_read_b128 v[76:79], v4 offset:18432
  v_smfmac_f32_16x16x64_bf16 v[16:19], v[84:87], a[72:79], v0
  s_waitcnt lgkmcnt(4)
  ds_read_b128 v[80:83], v4 offset:19456
  v_smfmac_f32_16x16x64_bf16 v[16:19], v[88:91], a[112:119], v0
  s_waitcnt lgkmcnt(4)
  v_smfmac_f32_16x16x64_bf16 v[16:19], v[100:103], a[120:127], v0
  s_add_u32 s24, s36, 145752064
  s_add_u32 s25, s36, 145756160
  v_smfmac_f32_16x16x64_bf16 v[20:23], v[92:95], v[176:183], v0
  s_add_u32 s35, s36, s23
  v_smfmac_f32_16x16x64_bf16 v[20:23], v[96:99], v[184:191], v0
  s_waitcnt lgkmcnt(2)
  v_smfmac_f32_16x16x64_bf16 v[20:23], v[116:119], v[68:75], v0
  s_waitcnt lgkmcnt(0)
  ds_read_b128 v[68:71], v4 offset:20480
  v_mul_f32 v16, s18, v16
  v_smfmac_f32_16x16x64_bf16 v[20:23], v[124:127], v[76:83], v0
  ds_read_b128 v[72:75], v4 offset:21504
  v_mul_f32 v17, s18, v17
  v_smfmac_f32_16x16x64_bf16 v[20:23], v[104:107], a[32:39], v0
  ds_read_b128 v[76:79], v4 offset:22528
  v_mul_f32 v18, s18, v18
  v_smfmac_f32_16x16x64_bf16 v[20:23], v[108:111], a[40:47], v0
  ds_read_b128 v[80:83], v4 offset:23552
  v_mul_f32 v19, s18, v19
  v_smfmac_f32_16x16x64_bf16 v[20:23], v[112:115], a[80:87], v0
  v_cvt_pk_bf16_f32 v120, v16, v17
  v_smfmac_f32_16x16x64_bf16 v[20:23], v[84:87], a[88:95], v0
  v_cvt_pk_bf16_f32 v121, v18, v19
  v_smfmac_f32_16x16x64_bf16 v[20:23], v[88:91], a[128:135], v0
  ds_write_b64 v5, v[120:121] offset:24576
  v_smfmac_f32_16x16x64_bf16 v[20:23], v[100:103], a[136:143], v0
  s_waitcnt lgkmcnt(3)
  v_smfmac_f32_16x16x64_bf16 v[24:27], v[92:95], v[68:75], v0
  s_waitcnt lgkmcnt(1)
  v_mov_b64 v[92:93], 0
  v_smfmac_f32_16x16x64_bf16 v[24:27], v[96:99], v[76:83], v0
  s_nop 1
  v_cvt_pk_bf16_f32 v122, v20, v21
  v_cvt_pk_bf16_f32 v123, v22, v23
  v_smfmac_f32_16x16x64_bf16 v[24:27], v[116:119], v[208:215], v0
  ds_write_b64 v5, v[122:123] offset:26880
  v_mov_b64 v[94:95], 0
  v_smfmac_f32_16x16x64_bf16 v[24:27], v[124:127], v[216:223], v0
  s_waitcnt lgkmcnt(1)
  s_barrier
  ds_read_b64_tr_b16 v[68:69], v6 offset:24576
  v_smfmac_f32_16x16x64_bf16 v[24:27], v[104:107], a[48:55], v0
  s_add_u32 s27, s27, 8192
  ds_read_b64_tr_b16 v[70:71], v6 offset:24640
  ds_read_b64_tr_b16 v[72:73], v6 offset:24832
  v_smfmac_f32_16x16x64_bf16 v[24:27], v[108:111], a[56:63], v0
  s_add_u32 s28, s28, 8192
  ds_read_b64_tr_b16 v[74:75], v6 offset:24896
  ds_read_b64_tr_b16 v[76:77], v6 offset:25088
  v_smfmac_f32_16x16x64_bf16 v[24:27], v[112:115], a[96:103], v0
  s_nop 0
  ds_read_b64_tr_b16 v[78:79], v6 offset:25152
  ds_read_b64_tr_b16 v[80:81], v6 offset:25344
  v_smfmac_f32_16x16x64_bf16 v[24:27], v[84:87], a[104:111], v0
  ds_read_b64_tr_b16 v[82:83], v6 offset:25408
  v_mov_b64 v[96:97], 0
  v_smfmac_f32_16x16x64_bf16 v[24:27], v[88:91], a[144:151], v0
  s_waitcnt lgkmcnt(8)
  s_barrier
  ds_read_b64_tr_b16 v[116:117], v6 offset:26880
  v_smfmac_f32_16x16x64_bf16 v[24:27], v[100:103], a[152:159], v0
  s_waitcnt lgkmcnt(7)
  ds_read_b64_tr_b16 v[118:119], v6 offset:26944
  buffer_store_dwordx2 v[122:123], v5, s[4:7], s29 offen sc1
  v_mfma_f32_16x16x32_bf16 v[16:19], v[36:39], v[68:71], 0
  s_waitcnt lgkmcnt(6)
  ds_read_b64_tr_b16 v[124:125], v6 offset:27136
  ds_read_b64_tr_b16 v[126:127], v6 offset:27200
  v_mfma_f32_16x16x32_bf16 v[16:19], v[40:43], v[72:75], v[16:19]
  s_waitcnt lgkmcnt(6)
  ds_read_b64_tr_b16 v[104:105], v6 offset:27392
  ds_read_b64_tr_b16 v[106:107], v6 offset:27456
  v_mfma_f32_16x16x32_bf16 v[16:19], v[44:47], v[76:79], v[16:19]
  s_waitcnt lgkmcnt(6)
  ds_read_b64_tr_b16 v[108:109], v6 offset:27648
  ds_read_b64_tr_b16 v[110:111], v6 offset:27712
  v_mfma_f32_16x16x32_bf16 v[16:19], v[48:51], v[80:83], v[16:19]
  s_waitcnt lgkmcnt(6)
  v_cvt_pk_bf16_f32 v120, v24, v25
  v_cvt_pk_bf16_f32 v121, v26, v27
  v_mfma_f32_16x16x32_bf16 v[112:115], v[116:119], v[68:71], 0
  s_waitcnt lgkmcnt(4)
  buffer_store_dwordx2 v[120:121], v5, s[4:7], s29 offen offset:2304 sc1
  v_mov_b64 v[98:99], 0
  v_mfma_f32_16x16x32_bf16 v[112:115], v[124:127], v[72:75], v[112:115]
  s_waitcnt lgkmcnt(2)
  v_mov_b64 v[36:37], 0
  v_exp_f32 v100, v16
  v_mfma_f32_16x16x32_bf16 v[112:115], v[104:107], v[76:79], v[112:115]
  s_waitcnt lgkmcnt(0)
  v_exp_f32 v101, v17
  v_mfma_f32_16x16x32_bf16 v[112:115], v[108:111], v[80:83], v[112:115]
  s_add_u32 s29, s29, 147456
  v_exp_f32 v102, v18
  v_mfma_f32_16x16x32_bf16 v[20:23], v[52:55], v[68:71], 0
  s_cmp_eq_u32 s14, 63
  v_exp_f32 v103, v19
  v_mfma_f32_16x16x32_bf16 v[20:23], v[56:59], v[72:75], v[20:23]
  s_cbranch_scc1 M_tdone
  v_cvt_pk_bf16_f32 v44, v100, v101
  v_cvt_pk_bf16_f32 v45, v102, v103
  v_mfma_f32_16x16x32_bf16 v[20:23], v[60:63], v[76:79], v[20:23]
  v_exp_f32 v100, v112
  v_mfma_f32_16x16x32_bf16 v[20:23], v[64:67], v[80:83], v[20:23]
  v_exp_f32 v101, v113
  v_exp_f32 v102, v114
  v_exp_f32 v103, v115
  v_cvt_pk_bf16_f32 v84, v100, v101
  v_cvt_pk_bf16_f32 v85, v102, v103
  v_cndmask_b32 v48, v84, 0, s[16:17]
  v_cndmask_b32 v49, v85, 0, s[16:17]
  v_cndmask_b32 v50, 0, v84, s[16:17]
  v_cndmask_b32 v51, 0, v85, s[16:17]
  v_exp_f32 v100, v20
  v_mfma_f32_16x16x16_bf16 v[88:91], v[12:13], v[48:49], 0
  v_exp_f32 v101, v21
  v_mfma_f32_16x16x16_bf16 v[24:27], v[120:121], v[48:49], 0
  v_exp_f32 v102, v22
  v_mfma_f32_16x16x16_bf16 v[116:119], v[120:121], v[50:51], 0
  v_exp_f32 v103, v23
  v_cvt_pk_bf16_f32 v46, v100, v101
  v_cvt_pk_bf16_f32 v47, v102, v103
  v_mov_b64 v[38:39], 0
  s_nop 0
  v_mfma_f32_16x16x32_bf16 v[88:91], v[12:15], v[44:47], v[88:91]
  v_mov_b64 v[40:41], 0
  v_mov_b64 v[42:43], 0
  v_mfma_f32_16x16x32_bf16 v[24:27], v[28:31], v[44:47], v[24:27]
  ds_read_b128 v[52:55], v4 offset:24576
  ds_read_b128 v[56:59], v4 offset:25600
  v_mfma_f32_16x16x32_bf16 v[116:119], v[32:35], v[44:47], v[116:119]
  s_nop 1
  v_rcp_f32 v89, v88
  v_subrev_u32 v100, s54, v88
  v_cmp_le_u32 vcc, s55, v100
  v_mul_f32 v24, v89, v24
  v_mul_f32 v25, v89, v25
  s_cbranch_vccnz T_slow_87
T_back_88:
  v_cvt_pk_bf16_f32 v124, v24, v25
  v_pk_mul_f32 v[26:27], v[26:27], v[88:89] op_sel:[0,1] op_sel_hi:[1,1]
  v_pk_mul_f32 v[116:117], v[116:117], v[88:89] op_sel:[0,1] op_sel_hi:[1,1]
  v_pk_mul_f32 v[118:119], v[118:119], v[88:89] op_sel:[0,1] op_sel_hi:[1,1]
  v_cvt_pk_bf16_f32 v125, v26, v27
  v_cvt_pk_bf16_f32 v126, v116, v117
  v_cvt_pk_bf16_f32 v127, v118, v119
  ds_write_b128 v11, v[124:127] offset:29184
  s_nop 0
  v_smfmac_f32_16x16x64_bf16 v[92:95], v[124:127], a[160:167], v0
  v_smfmac_f32_16x16x64_bf16 v[96:99], v[124:127], a[168:175], v0
  v_smfmac_f32_16x16x64_bf16 v[36:39], v[124:127], a[176:183], v0
  v_smfmac_f32_16x16x64_bf16 v[40:43], v[124:127], a[184:191], v0
  s_waitcnt lgkmcnt(0)
  s_barrier
  ds_read_b128 v[104:107], v11 offset:29696
  ds_read_b128 v[108:111], v11 offset:30208
  ds_read_b128 v[68:71], v11 offset:30720
  s_waitcnt lgkmcnt(2)
  v_smfmac_f32_16x16x64_bf16 v[92:95], v[104:107], a[192:199], v0
  s_waitcnt lgkmcnt(1)
  ds_read_b128 v[76:79], v4 offset:28672
  v_smfmac_f32_16x16x64_bf16 v[92:95], v[108:111], a[224:231], v0
  s_waitcnt lgkmcnt(1)
  ds_read_b128 v[80:83], v4 offset:29696
  v_smfmac_f32_16x16x64_bf16 v[92:95], v[68:71], a[240:247], v0
  ds_read_b128 v[60:63], v4 offset:26624
  v_smfmac_f32_16x16x64_bf16 v[96:99], v[104:107], a[200:207], v0
  ds_read_b128 v[64:67], v4 offset:27648
  v_smfmac_f32_16x16x64_bf16 v[96:99], v[108:111], a[232:239], v0
  ds_read_b128 v[28:31], v4 offset:30720
  s_nop 0
  v_cvt_pk_bf16_f32 v16, v92, v93
  v_cvt_pk_bf16_f32 v17, v94, v95
  v_bfi_b32 v16, 1, s57, v16
  v_smfmac_f32_16x16x64_bf16 v[96:99], v[68:71], a[248:255], v0
  buffer_store_dwordx2 v[16:17], v7, s[4:7], s20 offen offset:0
  v_smfmac_f32_16x16x64_bf16 v[36:39], v[104:107], a[208:215], v0
  ds_read_b128 v[32:35], v4 offset:31744
  v_smfmac_f32_16x16x64_bf16 v[36:39], v[108:111], v[52:59], v0
  s_waitcnt lgkmcnt(4)
  s_nop 0
  v_cvt_pk_bf16_f32 v18, v96, v97
  v_cvt_pk_bf16_f32 v19, v98, v99
  v_bfi_b32 v18, 1, s57, v18
  v_smfmac_f32_16x16x64_bf16 v[36:39], v[68:71], v[76:83], v0
  buffer_store_dwordx2 v[18:19], v7, s[4:7], s20 offen offset:64
  v_smfmac_f32_16x16x64_bf16 v[40:43], v[104:107], a[216:223], v0
  s_waitcnt lgkmcnt(2)
  ds_read_b128 v[116:119], v2 offset:31232
  v_smfmac_f32_16x16x64_bf16 v[40:43], v[108:111], v[60:67], v0
  s_waitcnt lgkmcnt(1)
  s_nop 0
  v_cvt_pk_bf16_f32 v20, v36, v37
  v_cvt_pk_bf16_f32 v21, v38, v39
  v_bfi_b32 v20, 1, s57, v20
  v_smfmac_f32_16x16x64_bf16 v[40:43], v[68:71], v[28:35], v0
  buffer_store_dwordx2 v[20:21], v7, s[4:7], s21 offen offset:0
  s_nop 6
  v_cvt_pk_bf16_f32 v22, v40, v41
  v_cvt_pk_bf16_f32 v23, v42, v43
  v_bfi_b32 v22, 1, s57, v22
  buffer_store_dwordx2 v[22:23], v7, s[4:7], s21 offen offset:64
  ds_read_b128 v[68:71], v4 offset:0
  ds_read_b128 v[72:75], v4 offset:1024
  ds_read_b128 v[76:79], v4 offset:4096
  ds_read_b128 v[80:83], v4 offset:5120
  ds_read_b128 v[84:87], v4 offset:8192
  ds_read_b128 v[88:91], v4 offset:9216
  ds_read_b128 v[92:95], v4 offset:2048
  ds_read_b128 v[96:99], v4 offset:3072
  ds_read_b128 v[100:103], v4 offset:6144
  ds_read_b128 v[104:107], v4 offset:7168
  ds_read_b128 v[108:111], v4 offset:10240
  ds_read_b128 v[112:115], v4 offset:11264
  v_mov_b64 v[16:17], 0
  v_mov_b64 v[18:19], 0
  v_mov_b64 v[20:21], 0
  v_mov_b64 v[22:23], 0
  v_mov_b64 v[24:25], 0
  v_mov_b64 v[26:27], 0
  s_mov_b32 s19, 0
  v_mov_b32 v49, -1
  ds_read_b64 v[44:45], v2 offset:32256
  s_waitcnt lgkmcnt(0)
  v_readfirstlane_b32 s38, v44
  v_readfirstlane_b32 s37, v45
  s_nop 0
  s_add_u32 s37, s37, 30
  s_cmp_ge_u32 s38, 30
  s_cselect_b32 s38, s37, s38
  s_cmp_ge_u32 s38, 64
  s_cselect_b32 s38, 100, s38
  s_sub_u32 s38, s38, 1
  s_max_i32 s30, s30, s38
  s_waitcnt vmcnt(1)
  buffer_load_dwordx4 v[52:55], v2, s[4:7], s22 offen offset:0 sc1
  buffer_load_dwordx4 v[56:59], v2, s[4:7], s22 offen offset:1024 sc1
  buffer_load_dwordx4 v[60:63], v2, s[4:7], s22 offen offset:2048 sc1
  buffer_load_dwordx4 v[64:67], v2, s[4:7], s22 offen offset:3072 sc1
  s_waitcnt lgkmcnt(12)
  s_waitcnt vmcnt(3)
  v_mfma_f32_16x16x32_bf16 v[120:123], v[116:119], v[52:55], 0
  v_xor_b32 v48, s57, v52
  v_bitop3_b32 v48, v48, v54, s57 bitop3:0xf6
  s_waitcnt vmcnt(2)
  v_mfma_f32_16x16x32_bf16 v[120:123], v[116:119], v[56:59], v[120:123]
  v_bitop3_b32 v48, v48, v56, s57 bitop3:0xf6
  v_bitop3_b32 v48, v48, v58, s57 bitop3:0xf6
  s_waitcnt vmcnt(1)
  v_mfma_f32_16x16x32_bf16 v[120:123], v[116:119], v[60:63], v[120:123]
  v_bitop3_b32 v48, v48, v60, s57 bitop3:0xf6
  v_bitop3_b32 v48, v48, v62, s57 bitop3:0xf6
  s_waitcnt vmcnt(0)
  v_mfma_f32_16x16x32_bf16 v[120:123], v[116:119], v[64:67], v[120:123]
  v_bitop3_b32 v48, v48, v64, s57 bitop3:0xf6
  v_bitop3_b32 v48, v48, v66, s57 bitop3:0xf6
  v_and_b32 v48, 1, v48
  v_cmp_ne_u32 vcc, 0, v48
  s_cbranch_vccnz T_p1re_90
T_p1ok_91:
  s_nop 2
  v_add_f32_dpp v120, v120, v120 row_ror:8 row_mask:0xf bank_mask:0xf
  v_add_f32_dpp v121, v121, v121 row_ror:8 row_mask:0xf bank_mask:0xf
  v_cvt_pk_bf16_f32 v48, v120, v121
  v_min_u32 v48, -2, v48
  buffer_store_dword v48, v8, s[4:7], s35 offen
  buffer_store_dword v49, v8, s[4:7], s26 offen
  s_barrier
  ds_read_b128 v[28:31], v2 offset:16384
  ds_read_b128 v[32:35], v2 offset:20480
  ds_read_b128 v[36:39], v2 offset:8192
  ds_read_b128 v[40:43], v2 offset:9216
  ds_read_b128 v[44:47], v2 offset:10240
  ds_read_b128 v[48:51], v2 offset:11264
  buffer_load_dwordx4 v[124:127], v2, s[4:7], s24 offen offset:0 sc1
  buffer_load_dwordx4 v[116:119], v2, s[4:7], s25 offen offset:0 sc1
  ds_read_b128 v[52:55], v2 offset:12288
  ds_read_b128 v[56:59], v2 offset:13312
  ds_read_b128 v[60:63], v2 offset:14336
  ds_read_b128 v[64:67], v2 offset:15360
  buffer_load_dwordx4 v[124:127], v2, s[4:7], s24 offen offset:0 sc1
  buffer_load_dwordx4 v[116:119], v2, s[4:7], s25 offen offset:0 sc1
  s_mov_b32 s19, 0
  s_branch T_loop_81
T_p1re_90:
  s_mov_b64 exec, vcc
  buffer_load_dwordx4 v[52:55], v2, s[4:7], s22 offen offset:0 sc1
  buffer_load_dwordx4 v[56:59], v2, s[4:7], s22 offen offset:1024 sc1
  buffer_load_dwordx4 v[60:63], v2, s[4:7], s22 offen offset:2048 sc1
  buffer_load_dwordx4 v[64:67], v2, s[4:7], s22 offen offset:3072 sc1
  s_mov_b64 exec, -1
  s_add_u32 s19, s19, 1
  s_cmp_gt_u32 s19, 32768
  s_cbranch_scc1 M_exit
  s_waitcnt vmcnt(3)
  v_mfma_f32_16x16x32_bf16 v[120:123], v[116:119], v[52:55], 0
  v_xor_b32 v48, s57, v52
  v_bitop3_b32 v48, v48, v54, s57 bitop3:0xf6
  s_waitcnt vmcnt(2)
  v_mfma_f32_16x16x32_bf16 v[120:123], v[116:119], v[56:59], v[120:123]
  v_bitop3_b32 v48, v48, v56, s57 bitop3:0xf6
  v_bitop3_b32 v48, v48, v58, s57 bitop3:0xf6
  s_waitcnt vmcnt(1)
  v_mfma_f32_16x16x32_bf16 v[120:123], v[116:119], v[60:63], v[120:123]
  v_bitop3_b32 v48, v48, v60, s57 bitop3:0xf6
  v_bitop3_b32 v48, v48, v62, s57 bitop3:0xf6
  s_waitcnt vmcnt(0)
  v_mfma_f32_16x16x32_bf16 v[120:123], v[116:119], v[64:67], v[120:123]
  v_bitop3_b32 v48, v48, v64, s57 bitop3:0xf6
  v_bitop3_b32 v48, v48, v66, s57 bitop3:0xf6
  v_and_b32 v48, 1, v48
  v_cmp_ne_u32 vcc, 0, v48
  s_cbranch_vccnz T_p1re_90
  s_branch T_p1ok_91
T_kvw_85:
  s_mov_b32 s19, 0
  s_branch T_kvok_93
T_kv_92:
  s_sleep 4
  s_add_u32 s19, s19, 1
  s_cmp_gt_u32 s19, 32768
  s_cbranch_scc1 M_exit
T_kvok_93:
  s_add_u32 s39, s99, 128
  s_mov_b32 s38, 0
  s_mov_b32 s37, 0
  s_atomic_or s38, s[58:59], s99 glc
  s_atomic_or s37, s[58:59], s39 glc
  s_waitcnt lgkmcnt(0)
  s_add_u32 s37, s37, 30
  s_cmp_ge_u32 s38, 30
  s_cselect_b32 s38, s37, s38
  s_cmp_ge_u32 s38, 64
  s_cselect_b32 s38, 100, s38
  s_sub_u32 s38, s38, 1
  s_max_i32 s30, s30, s38
  s_cmp_ge_i32 s14, s30
  s_cbranch_scc1 T_kv_92
  s_branch T_kvb_86
T_slow_87:
  s_nop 7
  v_max3_f32 v100, v16, v17, v18
  v_max3_f32 v100, v100, v19, v20
  v_max3_f32 v100, v100, v21, v22
  v_max3_f32 v100, v100, v23, v112
  v_max3_f32 v100, v100, v113, v114
  v_max_f32 v100, v100, v115
  v_mov_b32 v101, v100
  s_nop 1
  v_permlane32_swap_b32 v100, v101
  s_nop 1
  v_max_f32 v100, v100, v101
  v_mov_b32 v101, v100
  s_nop 1
  v_permlane16_swap_b32 v100, v101
  s_nop 1
  v_max_f32 v100, v100, v101
  v_sub_f32 v16, v16, v100
  v_sub_f32 v17, v17, v100
  v_sub_f32 v18, v18, v100
  v_sub_f32 v19, v19, v100
  v_exp_f32 v16, v16
  v_exp_f32 v17, v17
  v_exp_f32 v18, v18
  v_exp_f32 v19, v19
  v_sub_f32 v20, v20, v100
  v_sub_f32 v21, v21, v100
  v_sub_f32 v22, v22, v100
  v_sub_f32 v23, v23, v100
  v_exp_f32 v20, v20
  v_exp_f32 v21, v21
  v_exp_f32 v22, v22
  v_exp_f32 v23, v23
  v_sub_f32 v112, v112, v100
  v_sub_f32 v113, v113, v100
  v_sub_f32 v114, v114, v100
  v_sub_f32 v115, v115, v100
  v_exp_f32 v112, v112
  v_exp_f32 v113, v113
  v_exp_f32 v114, v114
  v_exp_f32 v115, v115
  s_nop 0
  v_cvt_pk_bf16_f32 v44, v16, v17
  v_cvt_pk_bf16_f32 v45, v18, v19
  v_cvt_pk_bf16_f32 v46, v20, v21
  v_cvt_pk_bf16_f32 v47, v22, v23
  v_cvt_pk_bf16_f32 v84, v112, v113
  v_cvt_pk_bf16_f32 v85, v114, v115
  v_cndmask_b32 v48, v84, 0, s[16:17]
  v_cndmask_b32 v49, v85, 0, s[16:17]
  v_cndmask_b32 v50, 0, v84, s[16:17]
  v_cndmask_b32 v51, 0, v85, s[16:17]
  s_nop 1
  v_mfma_f32_16x16x16_bf16 v[88:91], v[12:13], v[48:49], 0
  v_mfma_f32_16x16x16_bf16 v[24:27], v[120:121], v[48:49], 0
  v_mfma_f32_16x16x16_bf16 v[116:119], v[120:121], v[50:51], 0
  v_mfma_f32_16x16x32_bf16 v[88:91], v[12:15], v[44:47], v[88:91]
  v_mfma_f32_16x16x32_bf16 v[24:27], v[28:31], v[44:47], v[24:27]
  v_mfma_f32_16x16x32_bf16 v[116:119], v[32:35], v[44:47], v[116:119]
  s_nop 7
  s_nop 1
  v_rcp_f32 v89, v88
  s_nop 0
  v_mul_f32 v24, v89, v24
  v_mul_f32 v25, v89, v25
  s_branch T_back_88
T_w_78:
  s_mov_b32 s19, 0
  v_mov_b64 v[16:17], 0
  v_mov_b64 v[18:19], 0
  v_mov_b64 v[20:21], 0
  v_mov_b64 v[22:23], 0
  v_mov_b64 v[24:25], 0
  v_mov_b64 v[26:27], 0
  buffer_load_dwordx4 v[124:127], v2, s[4:7], s24 offen offset:1024 sc1
  buffer_load_dwordx4 v[116:119], v2, s[4:7], s25 offen offset:1024 sc1
  buffer_load_dwordx4 v[124:127], v2, s[4:7], s24 offen offset:1024 sc1
  buffer_load_dwordx4 v[116:119], v2, s[4:7], s25 offen offset:1024 sc1
  s_branch T_loop_94
.p2align 6
T_retry_95:
  s_mov_b64 exec, vcc
  buffer_load_dwordx4 v[124:127], v2, s[4:7], s24 offen offset:1024 sc1
  buffer_load_dwordx4 v[116:119], v2, s[4:7], s25 offen offset:1024 sc1
  s_mov_b64 exec, -1
  s_add_u32 s19, s19, 1
  s_cmp_gt_u32 s19, 32768
  s_cbranch_scc1 M_exit
T_loop_94:
  s_waitcnt vmcnt(3) lgkmcnt(0)
  v_max3_u32 v123, v124, v125, v126
  v_max_u32 v123, v123, v127
  v_mov_b32_dpp v120, v124 row_ror:8 row_mask:0xf bank_mask:0xf
  v_mov_b32_dpp v121, v125 row_ror:8 row_mask:0xf bank_mask:0xf
  s_waitcnt vmcnt(2)
  v_max3_u32 v123, v123, v116, v117
  v_max3_u32 v123, v123, v118, v119
  v_cmp_eq_u32 vcc, -1, v123
  s_cbranch_vccnz T_retry_95
  v_smfmac_f32_16x16x64_bf16 v[16:19], v[124:127], v[68:75], v0
  s_add_u32 s14, s14, 1
  ds_write_b128 v2, v[124:127] offset:1024
  v_mov_b32_dpp v122, v126 row_ror:8 row_mask:0xf bank_mask:0xf
  v_smfmac_f32_16x16x64_bf16 v[20:23], v[124:127], v[76:83], v0
  s_and_b32 s57, s14, 1
  v_mov_b32_dpp v123, v127 row_ror:8 row_mask:0xf bank_mask:0xf
  v_smfmac_f32_16x16x64_bf16 v[24:27], v[124:127], v[84:91], v0
  s_and_b32 s36, s14, 3
  ds_write_b128 v2, v[116:119] offset:5120
  v_smfmac_f32_16x16x64_bf16 v[16:19], v[120:123], v[92:99], v0
  s_lshl_b32 s36, s36, 13
  v_mov_b32_dpp v84, v116 row_ror:8 row_mask:0xf bank_mask:0xf
  v_smfmac_f32_16x16x64_bf16 v[20:23], v[120:123], v[100:107], v0
  s_add_u32 s26, s36, s23
  ds_read_b128 v[68:71], v4 offset:12288
  v_mov_b32_dpp v85, v117 row_ror:8 row_mask:0xf bank_mask:0xf
  v_smfmac_f32_16x16x64_bf16 v[24:27], v[120:123], v[108:115], v0
  s_add_u32 s36, s36, 8192
  ds_read_b128 v[72:75], v4 offset:13312
  v_mov_b32_dpp v86, v118 row_ror:8 row_mask:0xf bank_mask:0xf
  v_smfmac_f32_16x16x64_bf16 v[16:19], v[116:119], v[224:231], v0
  s_and_b32 s36, s36, 0x7fff
  ds_read_b128 v[76:79], v4 offset:14336
  v_mov_b32_dpp v87, v119 row_ror:8 row_mask:0xf bank_mask:0xf
  v_smfmac_f32_16x16x64_bf16 v[20:23], v[116:119], v[240:247], v0
  s_waitcnt lgkmcnt(3)
  s_barrier
  ds_read_b128 v[100:103], v2 offset:0
  v_smfmac_f32_16x16x64_bf16 v[24:27], v[116:119], a[0:7], v0
  s_mov_b32 m0, s31
  ds_read_b128 v[120:123], v1 offset:0
  v_smfmac_f32_16x16x64_bf16 v[16:19], v[84:87], v[232:239], v0
  s_cmp_ge_i32 s14, s30
  s_cbranch_scc1 T_kvw_98
T_kvb_99:
  v_smfmac_f32_16x16x64_bf16 v[20:23], v[84:87], v[248:255], v0
  ds_read_b128 v[80:83], v4 offset:15360
  v_smfmac_f32_16x16x64_bf16 v[24:27], v[84:87], a[8:15], v0
  s_waitcnt lgkmcnt(2)
  buffer_load_dwordx4 v9, s[4:7], s27 offen sc1 lds
  v_smfmac_f32_16x16x64_bf16 v[16:19], v[100:103], v[128:135], v0
  ds_read_b128 v[92:95], v2 offset:3072
  s_mov_b32 m0, s32
  v_smfmac_f32_16x16x64_bf16 v[20:23], v[100:103], v[144:151], v0
  ds_read_b128 v[96:99], v1 offset:3072
  v_smfmac_f32_16x16x64_bf16 v[24:27], v[100:103], v[68:75], v0
  s_waitcnt vmcnt(1) lgkmcnt(3)
  ds_read_b128 v[116:119], v2 offset:2048
  v_smfmac_f32_16x16x64_bf16 v[16:19], v[120:123], v[136:143], v0
  ds_read_b128 v[124:127], v1 offset:2048
  buffer_load_dwordx4 v9, s[4:7], s27 offen offset:128 sc1 lds
  v_smfmac_f32_16x16x64_bf16 v[20:23], v[120:123], v[152:159], v0
  s_waitcnt lgkmcnt(4)
  ds_read_b128 v[104:107], v2 offset:4096
  s_mov_b32 m0, s33
  v_smfmac_f32_16x16x64_bf16 v[24:27], v[120:123], v[76:83], v0
  s_waitcnt lgkmcnt(4)
  ds_read_b128 v[108:111], v1 offset:4096
  v_smfmac_f32_16x16x64_bf16 v[16:19], v[92:95], v[160:167], v0
  s_waitcnt lgkmcnt(4)
  ds_read_b128 v[112:115], v2 offset:7168
  v_smfmac_f32_16x16x64_bf16 v[16:19], v[96:99], v[168:175], v0
  s_waitcnt lgkmcnt(4)
  ds_read_b128 v[84:87], v1 offset:7168
  buffer_load_dwordx4 v10, s[4:7], s28 offen sc1 lds
  v_smfmac_f32_16x16x64_bf16 v[16:19], v[116:119], v[192:199], v0
  s_waitcnt lgkmcnt(4)
  ds_read_b128 v[88:91], v2 offset:6144
  s_mov_b32 m0, s34
  v_smfmac_f32_16x16x64_bf16 v[16:19], v[124:127], v[200:207], v0
  s_waitcnt lgkmcnt(4)
  ds_read_b128 v[100:103], v1 offset:6144
  v_smfmac_f32_16x16x64_bf16 v[16:19], v[104:107], a[16:23], v0
  s_waitcnt lgkmcnt(4)
  ds_read_b128 v[68:71], v4 offset:16384
  v_smfmac_f32_16x16x64_bf16 v[16:19], v[108:111], a[24:31], v0
  s_waitcnt lgkmcnt(4)
  ds_read_b128 v[72:75], v4 offset:17408
  buffer_load_dwordx4 v10, s[4:7], s28 offen offset:256 sc1 lds
  v_smfmac_f32_16x16x64_bf16 v[16:19], v[112:115], a[64:71], v0
  s_waitcnt lgkmcnt(4)
  ds_read_b128 v[76:79], v4 offset:18432
  v_smfmac_f32_16x16x64_bf16 v[16:19], v[84:87], a[72:79], v0
  s_waitcnt lgkmcnt(4)
  ds_read_b128 v[80:83], v4 offset:19456
  v_smfmac_f32_16x16x64_bf16 v[16:19], v[88:91], a[112:119], v0
  s_waitcnt lgkmcnt(4)
  v_smfmac_f32_16x16x64_bf16 v[16:19], v[100:103], a[120:127], v0
  s_add_u32 s24, s36, 145752064
  s_add_u32 s25, s36, 145756160
  v_smfmac_f32_16x16x64_bf16 v[20:23], v[92:95], v[176:183], v0
  s_add_u32 s35, s36, s23
  v_smfmac_f32_16x16x64_bf16 v[20:23], v[96:99], v[184:191], v0
  s_waitcnt lgkmcnt(2)
  v_smfmac_f32_16x16x64_bf16 v[20:23], v[116:119], v[68:75], v0
  s_waitcnt lgkmcnt(0)
  ds_read_b128 v[68:71], v4 offset:20480
  v_mul_f32 v16, s18, v16
  v_smfmac_f32_16x16x64_bf16 v[20:23], v[124:127], v[76:83], v0
  ds_read_b128 v[72:75], v4 offset:21504
  v_mul_f32 v17, s18, v17
  v_smfmac_f32_16x16x64_bf16 v[20:23], v[104:107], a[32:39], v0
  ds_read_b128 v[76:79], v4 offset:22528
  v_mul_f32 v18, s18, v18
  v_smfmac_f32_16x16x64_bf16 v[20:23], v[108:111], a[40:47], v0
  ds_read_b128 v[80:83], v4 offset:23552
  v_mul_f32 v19, s18, v19
  v_smfmac_f32_16x16x64_bf16 v[20:23], v[112:115], a[80:87], v0
  v_cvt_pk_bf16_f32 v120, v16, v17
  v_smfmac_f32_16x16x64_bf16 v[20:23], v[84:87], a[88:95], v0
  v_cvt_pk_bf16_f32 v121, v18, v19
  v_smfmac_f32_16x16x64_bf16 v[20:23], v[88:91], a[128:135], v0
  ds_write_b64 v5, v[120:121] offset:24576
  v_smfmac_f32_16x16x64_bf16 v[20:23], v[100:103], a[136:143], v0
  s_waitcnt lgkmcnt(3)
  v_smfmac_f32_16x16x64_bf16 v[24:27], v[92:95], v[68:75], v0
  s_waitcnt lgkmcnt(1)
  v_mov_b64 v[92:93], 0
  v_smfmac_f32_16x16x64_bf16 v[24:27], v[96:99], v[76:83], v0
  s_nop 1
  v_cvt_pk_bf16_f32 v122, v20, v21
  v_cvt_pk_bf16_f32 v123, v22, v23
  v_smfmac_f32_16x16x64_bf16 v[24:27], v[116:119], v[208:215], v0
  ds_write_b64 v5, v[122:123] offset:26880
  v_mov_b64 v[94:95], 0
  v_smfmac_f32_16x16x64_bf16 v[24:27], v[124:127], v[216:223], v0
  s_waitcnt lgkmcnt(1)
  s_barrier
  ds_read_b64_tr_b16 v[68:69], v6 offset:24576
  v_smfmac_f32_16x16x64_bf16 v[24:27], v[104:107], a[48:55], v0
  s_add_u32 s27, s27, 8192
  ds_read_b64_tr_b16 v[70:71], v6 offset:24640
  ds_read_b64_tr_b16 v[72:73], v6 offset:24832
  v_smfmac_f32_16x16x64_bf16 v[24:27], v[108:111], a[56:63], v0
  s_add_u32 s28, s28, 8192
  ds_read_b64_tr_b16 v[74:75], v6 offset:24896
  ds_read_b64_tr_b16 v[76:77], v6 offset:25088
  v_smfmac_f32_16x16x64_bf16 v[24:27], v[112:115], a[96:103], v0
  s_nop 0
  ds_read_b64_tr_b16 v[78:79], v6 offset:25152
  ds_read_b64_tr_b16 v[80:81], v6 offset:25344
  v_smfmac_f32_16x16x64_bf16 v[24:27], v[84:87], a[104:111], v0
  ds_read_b64_tr_b16 v[82:83], v6 offset:25408
  v_mov_b64 v[96:97], 0
  v_smfmac_f32_16x16x64_bf16 v[24:27], v[88:91], a[144:151], v0
  s_waitcnt lgkmcnt(8)
  s_barrier
  ds_read_b64_tr_b16 v[116:117], v6 offset:26880
  v_smfmac_f32_16x16x64_bf16 v[24:27], v[100:103], a[152:159], v0
  s_waitcnt lgkmcnt(7)
  ds_read_b64_tr_b16 v[118:119], v6 offset:26944
  buffer_store_dwordx2 v[122:123], v5, s[4:7], s29 offen sc1
  v_mfma_f32_16x16x32_bf16 v[16:19], v[36:39], v[68:71], 0
  s_waitcnt lgkmcnt(6)
  ds_read_b64_tr_b16 v[124:125], v6 offset:27136
  ds_read_b64_tr_b16 v[126:127], v6 offset:27200
  v_mfma_f32_16x16x32_bf16 v[16:19], v[40:43], v[72:75], v[16:19]
  s_waitcnt lgkmcnt(6)
  ds_read_b64_tr_b16 v[104:105], v6 offset:27392
  ds_read_b64_tr_b16 v[106:107], v6 offset:27456
  v_mfma_f32_16x16x32_bf16 v[16:19], v[44:47], v[76:79], v[16:19]
  s_waitcnt lgkmcnt(6)
  ds_read_b64_tr_b16 v[108:109], v6 offset:27648
  ds_read_b64_tr_b16 v[110:111], v6 offset:27712
  v_mfma_f32_16x16x32_bf16 v[16:19], v[48:51], v[80:83], v[16:19]
  s_waitcnt lgkmcnt(6)
  v_cvt_pk_bf16_f32 v120, v24, v25
  v_cvt_pk_bf16_f32 v121, v26, v27
  v_mfma_f32_16x16x32_bf16 v[112:115], v[116:119], v[68:71], 0
  s_waitcnt lgkmcnt(4)
  buffer_store_dwordx2 v[120:121], v5, s[4:7], s29 offen offset:2304 sc1
  v_mov_b64 v[98:99], 0
  v_mfma_f32_16x16x32_bf16 v[112:115], v[124:127], v[72:75], v[112:115]
  s_waitcnt lgkmcnt(2)
  v_mov_b64 v[36:37], 0
  v_exp_f32 v100, v16
  v_mfma_f32_16x16x32_bf16 v[112:115], v[104:107], v[76:79], v[112:115]
  s_waitcnt lgkmcnt(0)
  v_exp_f32 v101, v17
  v_mfma_f32_16x16x32_bf16 v[112:115], v[108:111], v[80:83], v[112:115]
  s_add_u32 s29, s29, 147456
  v_exp_f32 v102, v18
  v_mfma_f32_16x16x32_bf16 v[20:23], v[52:55], v[68:71], 0
  s_cmp_eq_u32 s14, 63
  v_exp_f32 v103, v19
  v_mfma_f32_16x16x32_bf16 v[20:23], v[56:59], v[72:75], v[20:23]
  s_cbranch_scc1 M_tdone
  v_cvt_pk_bf16_f32 v44, v100, v101
  v_cvt_pk_bf16_f32 v45, v102, v103
  v_mfma_f32_16x16x32_bf16 v[20:23], v[60:63], v[76:79], v[20:23]
  v_exp_f32 v100, v112
  v_mfma_f32_16x16x32_bf16 v[20:23], v[64:67], v[80:83], v[20:23]
  v_exp_f32 v101, v113
  v_exp_f32 v102, v114
  v_exp_f32 v103, v115
  v_cvt_pk_bf16_f32 v84, v100, v101
  v_cvt_pk_bf16_f32 v85, v102, v103
  v_cndmask_b32 v48, v84, 0, s[16:17]
  v_cndmask_b32 v49, v85, 0, s[16:17]
  v_cndmask_b32 v50, 0, v84, s[16:17]
  v_cndmask_b32 v51, 0, v85, s[16:17]
  v_exp_f32 v100, v20
  v_mfma_f32_16x16x16_bf16 v[88:91], v[12:13], v[48:49], 0
  v_exp_f32 v101, v21
  v_mfma_f32_16x16x16_bf16 v[24:27], v[120:121], v[48:49], 0
  v_exp_f32 v102, v22
  v_mfma_f32_16x16x16_bf16 v[116:119], v[120:121], v[50:51], 0
  v_exp_f32 v103, v23
  v_cvt_pk_bf16_f32 v46, v100, v101
  v_cvt_pk_bf16_f32 v47, v102, v103
  v_mov_b64 v[38:39], 0
  s_nop 0
  v_mfma_f32_16x16x32_bf16 v[88:91], v[12:15], v[44:47], v[88:91]
  v_mov_b64 v[40:41], 0
  v_mov_b64 v[42:43], 0
  v_mfma_f32_16x16x32_bf16 v[24:27], v[28:31], v[44:47], v[24:27]
  ds_read_b128 v[52:55], v4 offset:24576
  ds_read_b128 v[56:59], v4 offset:25600
  v_mfma_f32_16x16x32_bf16 v[116:119], v[32:35], v[44:47], v[116:119]
  s_nop 1
  v_rcp_f32 v89, v88
  v_subrev_u32 v100, s54, v88
  v_cmp_le_u32 vcc, s55, v100
  v_mul_f32 v24, v89, v24
  v_mul_f32 v25, v89, v25
  s_cbranch_vccnz T_slow_100
T_back_101:
  v_cvt_pk_bf16_f32 v124, v24, v25
  v_pk_mul_f32 v[26:27], v[26:27], v[88:89] op_sel:[0,1] op_sel_hi:[1,1]
  v_pk_mul_f32 v[116:117], v[116:117], v[88:89] op_sel:[0,1] op_sel_hi:[1,1]
  v_pk_mul_f32 v[118:119], v[118:119], v[88:89] op_sel:[0,1] op_sel_hi:[1,1]
  v_cvt_pk_bf16_f32 v125, v26, v27
  v_cvt_pk_bf16_f32 v126, v116, v117
  v_cvt_pk_bf16_f32 v127, v118, v119
  ds_write_b128 v11, v[124:127] offset:29696
  s_nop 0
  v_smfmac_f32_16x16x64_bf16 v[92:95], v[124:127], a[160:167], v0
  v_smfmac_f32_16x16x64_bf16 v[96:99], v[124:127], a[168:175], v0
  v_smfmac_f32_16x16x64_bf16 v[36:39], v[124:127], a[176:183], v0
  v_smfmac_f32_16x16x64_bf16 v[40:43], v[124:127], a[184:191], v0
  s_waitcnt lgkmcnt(0)
  s_barrier
  ds_read_b128 v[104:107], v11 offset:29184
  ds_read_b128 v[108:111], v11 offset:30720
  ds_read_b128 v[68:71], v11 offset:30208
  s_waitcnt lgkmcnt(2)
  v_smfmac_f32_16x16x64_bf16 v[92:95], v[104:107], a[192:199], v0
  s_waitcnt lgkmcnt(1)
  ds_read_b128 v[76:79], v4 offset:28672
  v_smfmac_f32_16x16x64_bf16 v[92:95], v[108:111], a[224:231], v0
  s_waitcnt lgkmcnt(1)
  ds_read_b128 v[80:83], v4 offset:29696
  v_smfmac_f32_16x16x64_bf16 v[92:95], v[68:71], a[240:247], v0
  ds_read_b128 v[60:63], v4 offset:26624
  v_smfmac_f32_16x16x64_bf16 v[96:99], v[104:107], a[200:207], v0
  ds_read_b128 v[64:67], v4 offset:27648
  v_smfmac_f32_16x16x64_bf16 v[96:99], v[108:111], a[232:239], v0
  ds_read_b128 v[28:31], v4 offset:30720
  s_nop 0
  v_cvt_pk_bf16_f32 v16, v92, v93
  v_cvt_pk_bf16_f32 v17, v94, v95
  v_bfi_b32 v16, 1, s57, v16
  v_smfmac_f32_16x16x64_bf16 v[96:99], v[68:71], a[248:255], v0
  buffer_store_dwordx2 v[16:17], v7, s[4:7], s20 offen offset:0
  v_smfmac_f32_16x16x64_bf16 v[36:39], v[104:107], a[208:215], v0
  ds_read_b128 v[32:35], v4 offset:31744
  v_smfmac_f32_16x16x64_bf16 v[36:39], v[108:111], v[52:59], v0
  s_waitcnt lgkmcnt(4)
  s_nop 0
  v_cvt_pk_bf16_f32 v18, v96, v97
  v_cvt_pk_bf16_f32 v19, v98, v99
  v_bfi_b32 v18, 1, s57, v18
  v_smfmac_f32_16x16x64_bf16 v[36:39], v[68:71], v[76:83], v0
  buffer_store_dwordx2 v[18:19], v7, s[4:7], s20 offen offset:64
  v_smfmac_f32_16x16x64_bf16 v[40:43], v[104:107], a[216:223], v0
  s_waitcnt lgkmcnt(2)
  ds_read_b128 v[116:119], v2 offset:31232
  v_smfmac_f32_16x16x64_bf16 v[40:43], v[108:111], v[60:67], v0
  s_waitcnt lgkmcnt(1)
  s_nop 0
  v_cvt_pk_bf16_f32 v20, v36, v37
  v_cvt_pk_bf16_f32 v21, v38, v39
  v_bfi_b32 v20, 1, s57, v20
  v_smfmac_f32_16x16x64_bf16 v[40:43], v[68:71], v[28:35], v0
  buffer_store_dwordx2 v[20:21], v7, s[4:7], s21 offen offset:0
  s_nop 6
  v_cvt_pk_bf16_f32 v22, v40, v41
  v_cvt_pk_bf16_f32 v23, v42, v43
  v_bfi_b32 v22, 1, s57, v22
  buffer_store_dwordx2 v[22:23], v7, s[4:7], s21 offen offset:64
  ds_read_b128 v[68:71], v4 offset:0
  ds_read_b128 v[72:75], v4 offset:1024
  ds_read_b128 v[76:79], v4 offset:4096
  ds_read_b128 v[80:83], v4 offset:5120
  ds_read_b128 v[84:87], v4 offset:8192
  ds_read_b128 v[88:91], v4 offset:9216
  ds_read_b128 v[92:95], v4 offset:2048
  ds_read_b128 v[96:99], v4 offset:3072
  ds_read_b128 v[100:103], v4 offset:6144
  ds_read_b128 v[104:107], v4 offset:7168
  ds_read_b128 v[108:111], v4 offset:10240
  ds_read_b128 v[112:115], v4 offset:11264
  v_mov_b64 v[16:17], 0
  v_mov_b64 v[18:19], 0
  v_mov_b64 v[20:21], 0
  v_mov_b64 v[22:23], 0
  v_mov_b64 v[24:25], 0
  v_mov_b64 v[26:27], 0
  s_mov_b32 s19, 0
  v_mov_b32 v49, -1
  ds_read_b64 v[44:45], v2 offset:32256
  s_waitcnt lgkmcnt(0)
  v_readfirstlane_b32 s38, v44
  v_readfirstlane_b32 s37, v45
  s_nop 0
  s_add_u32 s37, s37, 30
  s_cmp_ge_u32 s38, 30
  s_cselect_b32 s38, s37, s38
  s_cmp_ge_u32 s38, 64
  s_cselect_b32 s38, 100, s38
  s_sub_u32 s38, s38, 1
  s_max_i32 s30, s30, s38
  s_waitcnt vmcnt(1)
  buffer_load_dwordx4 v[52:55], v2, s[4:7], s22 offen offset:0 sc1
  buffer_load_dwordx4 v[56:59], v2, s[4:7], s22 offen offset:1024 sc1
  buffer_load_dwordx4 v[60:63], v2, s[4:7], s22 offen offset:2048 sc1
  buffer_load_dwordx4 v[64:67], v2, s[4:7], s22 offen offset:3072 sc1
  s_waitcnt lgkmcnt(12)
  s_waitcnt vmcnt(3)
  v_mfma_f32_16x16x32_bf16 v[120:123], v[116:119], v[52:55], 0
  v_xor_b32 v48, s57, v52
  v_bitop3_b32 v48, v48, v54, s57 bitop3:0xf6
  s_waitcnt vmcnt(2)
  v_mfma_f32_16x16x32_bf16 v[120:123], v[116:119], v[56:59], v[120:123]
  v_bitop3_b32 v48, v48, v56, s57 bitop3:0xf6
  v_bitop3_b32 v48, v48, v58, s57 bitop3:0xf6
  s_waitcnt vmcnt(1)
  v_mfma_f32_16x16x32_bf16 v[120:123], v[116:119], v[60:63], v[120:123]
  v_bitop3_b32 v48, v48, v60, s57 bitop3:0xf6
  v_bitop3_b32 v48, v48, v62, s57 bitop3:0xf6
  s_waitcnt vmcnt(0)
  v_mfma_f32_16x16x32_bf16 v[120:123], v[116:119], v[64:67], v[120:123]
  v_bitop3_b32 v48, v48, v64, s57 bitop3:0xf6
  v_bitop3_b32 v48, v48, v66, s57 bitop3:0xf6
  v_and_b32 v48, 1, v48
  v_cmp_ne_u32 vcc, 0, v48
  s_cbranch_vccnz T_p1re_103
T_p1ok_104:
  s_nop 2
  v_add_f32_dpp v120, v120, v120 row_ror:8 row_mask:0xf bank_mask:0xf
  v_add_f32_dpp v121, v121, v121 row_ror:8 row_mask:0xf bank_mask:0xf
  v_cvt_pk_bf16_f32 v48, v120, v121
  v_min_u32 v48, -2, v48
  buffer_store_dword v48, v8, s[4:7], s35 offen
  buffer_store_dword v49, v8, s[4:7], s26 offen
  s_barrier
  ds_read_b128 v[28:31], v2 offset:17408
  ds_read_b128 v[32:35], v2 offset:21504
  ds_read_b128 v[36:39], v2 offset:8192
  ds_read_b128 v[40:43], v2 offset:9216
  ds_read_b128 v[44:47], v2 offset:10240
  ds_read_b128 v[48:51], v2 offset:11264
  buffer_load_dwordx4 v[124:127], v2, s[4:7], s24 offen offset:1024 sc1
  buffer_load_dwordx4 v[116:119], v2, s[4:7], s25 offen offset:1024 sc1
  ds_read_b128 v[52:55], v2 offset:12288
  ds_read_b128 v[56:59], v2 offset:13312
  ds_read_b128 v[60:63], v2 offset:14336
  ds_read_b128 v[64:67], v2 offset:15360
  buffer_load_dwordx4 v[124:127], v2, s[4:7], s24 offen offset:1024 sc1
  buffer_load_dwordx4 v[116:119], v2, s[4:7], s25 offen offset:1024 sc1
  s_mov_b32 s19, 0
  s_branch T_loop_94
T_p1re_103:
  s_mov_b64 exec, vcc
  buffer_load_dwordx4 v[52:55], v2, s[4:7], s22 offen offset:0 sc1
  buffer_load_dwordx4 v[56:59], v2, s[4:7], s22 offen offset:1024 sc1
  buffer_load_dwordx4 v[60:63], v2, s[4:7], s22 offen offset:2048 sc1
  buffer_load_dwordx4 v[64:67], v2, s[4:7], s22 offen offset:3072 sc1
  s_mov_b64 exec, -1
  s_add_u32 s19, s19, 1
  s_cmp_gt_u32 s19, 32768
  s_cbranch_scc1 M_exit
  s_waitcnt vmcnt(3)
  v_mfma_f32_16x16x32_bf16 v[120:123], v[116:119], v[52:55], 0
  v_xor_b32 v48, s57, v52
  v_bitop3_b32 v48, v48, v54, s57 bitop3:0xf6
  s_waitcnt vmcnt(2)
  v_mfma_f32_16x16x32_bf16 v[120:123], v[116:119], v[56:59], v[120:123]
  v_bitop3_b32 v48, v48, v56, s57 bitop3:0xf6
  v_bitop3_b32 v48, v48, v58, s57 bitop3:0xf6
  s_waitcnt vmcnt(1)
  v_mfma_f32_16x16x32_bf16 v[120:123], v[116:119], v[60:63], v[120:123]
  v_bitop3_b32 v48, v48, v60, s57 bitop3:0xf6
  v_bitop3_b32 v48, v48, v62, s57 bitop3:0xf6
  s_waitcnt vmcnt(0)
  v_mfma_f32_16x16x32_bf16 v[120:123], v[116:119], v[64:67], v[120:123]
  v_bitop3_b32 v48, v48, v64, s57 bitop3:0xf6
  v_bitop3_b32 v48, v48, v66, s57 bitop3:0xf6
  v_and_b32 v48, 1, v48
  v_cmp_ne_u32 vcc, 0, v48
  s_cbranch_vccnz T_p1re_103
  s_branch T_p1ok_104
T_kvw_98:
  s_mov_b32 s19, 0
  s_branch T_kvok_106
T_kv_105:
  s_sleep 4
  s_add_u32 s19, s19, 1
  s_cmp_gt_u32 s19, 32768
  s_cbranch_scc1 M_exit
T_kvok_106:
  s_add_u32 s39, s99, 128
  s_mov_b32 s38, 0
  s_mov_b32 s37, 0
  s_atomic_or s38, s[58:59], s99 glc
  s_atomic_or s37, s[58:59], s39 glc
  s_waitcnt lgkmcnt(0)
  s_add_u32 s37, s37, 30
  s_cmp_ge_u32 s38, 30
  s_cselect_b32 s38, s37, s38
  s_cmp_ge_u32 s38, 64
  s_cselect_b32 s38, 100, s38
  s_sub_u32 s38, s38, 1
  s_max_i32 s30, s30, s38
  s_cmp_ge_i32 s14, s30
  s_cbranch_scc1 T_kv_105
  s_branch T_kvb_99
T_slow_100:
  s_nop 7
  v_max3_f32 v100, v16, v17, v18
  v_max3_f32 v100, v100, v19, v20
  v_max3_f32 v100, v100, v21, v22
  v_max3_f32 v100, v100, v23, v112
  v_max3_f32 v100, v100, v113, v114
  v_max_f32 v100, v100, v115
  v_mov_b32 v101, v100
  s_nop 1
  v_permlane32_swap_b32 v100, v101
  s_nop 1
  v_max_f32 v100, v100, v101
  v_mov_b32 v101, v100
  s_nop 1
  v_permlane16_swap_b32 v100, v101
  s_nop 1
  v_max_f32 v100, v100, v101
  v_sub_f32 v16, v16, v100
  v_sub_f32 v17, v17, v100
  v_sub_f32 v18, v18, v100
  v_sub_f32 v19, v19, v100
  v_exp_f32 v16, v16
  v_exp_f32 v17, v17
  v_exp_f32 v18, v18
  v_exp_f32 v19, v19
  v_sub_f32 v20, v20, v100
  v_sub_f32 v21, v21, v100
  v_sub_f32 v22, v22, v100
  v_sub_f32 v23, v23, v100
  v_exp_f32 v20, v20
  v_exp_f32 v21, v21
  v_exp_f32 v22, v22
  v_exp_f32 v23, v23
  v_sub_f32 v112, v112, v100
  v_sub_f32 v113, v113, v100
  v_sub_f32 v114, v114, v100
  v_sub_f32 v115, v115, v100
  v_exp_f32 v112, v112
  v_exp_f32 v113, v113
  v_exp_f32 v114, v114
  v_exp_f32 v115, v115
  s_nop 0
  v_cvt_pk_bf16_f32 v44, v16, v17
  v_cvt_pk_bf16_f32 v45, v18, v19
  v_cvt_pk_bf16_f32 v46, v20, v21
  v_cvt_pk_bf16_f32 v47, v22, v23
  v_cvt_pk_bf16_f32 v84, v112, v113
  v_cvt_pk_bf16_f32 v85, v114, v115
  v_cndmask_b32 v48, v84, 0, s[16:17]
  v_cndmask_b32 v49, v85, 0, s[16:17]
  v_cndmask_b32 v50, 0, v84, s[16:17]
  v_cndmask_b32 v51, 0, v85, s[16:17]
  s_nop 1
  v_mfma_f32_16x16x16_bf16 v[88:91], v[12:13], v[48:49], 0
  v_mfma_f32_16x16x16_bf16 v[24:27], v[120:121], v[48:49], 0
  v_mfma_f32_16x16x16_bf16 v[116:119], v[120:121], v[50:51], 0
  v_mfma_f32_16x16x32_bf16 v[88:91], v[12:15], v[44:47], v[88:91]
  v_mfma_f32_16x16x32_bf16 v[24:27], v[28:31], v[44:47], v[24:27]
  v_mfma_f32_16x16x32_bf16 v[116:119], v[32:35], v[44:47], v[116:119]
  s_nop 7
  s_nop 1
  v_rcp_f32 v89, v88
  s_nop 0
  v_mul_f32 v24, v89, v24
  v_mul_f32 v25, v89, v25
  s_branch T_back_101
T_w_79:
  s_mov_b32 s19, 0
  v_mov_b64 v[16:17], 0
  v_mov_b64 v[18:19], 0
  v_mov_b64 v[20:21], 0
  v_mov_b64 v[22:23], 0
  v_mov_b64 v[24:25], 0
  v_mov_b64 v[26:27], 0
  buffer_load_dwordx4 v[124:127], v2, s[4:7], s24 offen offset:2048 sc1
  buffer_load_dwordx4 v[116:119], v2, s[4:7], s25 offen offset:2048 sc1
  buffer_load_dwordx4 v[124:127], v2, s[4:7], s24 offen offset:2048 sc1
  buffer_load_dwordx4 v[116:119], v2, s[4:7], s25 offen offset:2048 sc1
  s_branch T_loop_107
.p2align 6
T_retry_108:
  s_mov_b64 exec, vcc
  buffer_load_dwordx4 v[124:127], v2, s[4:7], s24 offen offset:2048 sc1
  buffer_load_dwordx4 v[116:119], v2, s[4:7], s25 offen offset:2048 sc1
  s_mov_b64 exec, -1
  s_add_u32 s19, s19, 1
  s_cmp_gt_u32 s19, 32768
  s_cbranch_scc1 M_exit
T_loop_107:
  s_waitcnt vmcnt(3) lgkmcnt(0)
  v_max3_u32 v123, v124, v125, v126
  v_max_u32 v123, v123, v127
  v_mov_b32_dpp v120, v124 row_ror:8 row_mask:0xf bank_mask:0xf
  v_mov_b32_dpp v121, v125 row_ror:8 row_mask:0xf bank_mask:0xf
  s_waitcnt vmcnt(2)
  v_max3_u32 v123, v123, v116, v117
  v_max3_u32 v123, v123, v118, v119
  v_cmp_eq_u32 vcc, -1, v123
  s_cbranch_vccnz T_retry_108
  v_smfmac_f32_16x16x64_bf16 v[16:19], v[124:127], v[68:75], v0
  s_add_u32 s14, s14, 1
  ds_write_b128 v2, v[124:127] offset:2048
  v_mov_b32_dpp v122, v126 row_ror:8 row_mask:0xf bank_mask:0xf
  v_smfmac_f32_16x16x64_bf16 v[20:23], v[124:127], v[76:83], v0
  s_and_b32 s57, s14, 1
  v_mov_b32_dpp v123, v127 row_ror:8 row_mask:0xf bank_mask:0xf
  v_smfmac_f32_16x16x64_bf16 v[24:27], v[124:127], v[84:91], v0
  s_and_b32 s36, s14, 3
  ds_write_b128 v2, v[116:119] offset:6144
  v_smfmac_f32_16x16x64_bf16 v[16:19], v[120:123], v[92:99], v0
  s_lshl_b32 s36, s36, 13
  v_mov_b32_dpp v84, v116 row_ror:8 row_mask:0xf bank_mask:0xf
  v_smfmac_f32_16x16x64_bf16 v[20:23], v[120:123], v[100:107], v0
  s_add_u32 s26, s36, s23
  ds_read_b128 v[68:71], v4 offset:12288
  v_mov_b32_dpp v85, v117 row_ror:8 row_mask:0xf bank_mask:0xf
  v_smfmac_f32_16x16x64_bf16 v[24:27], v[120:123], v[108:115], v0
  s_add_u32 s36, s36, 8192
  ds_read_b128 v[72:75], v4 offset:13312
  v_mov_b32_dpp v86, v118 row_ror:8 row_mask:0xf bank_mask:0xf
  v_smfmac_f32_16x16x64_bf16 v[16:19], v[116:119], v[224:231], v0
  s_and_b32 s36, s36, 0x7fff
  ds_read_b128 v[76:79], v4 offset:14336
  v_mov_b32_dpp v87, v119 row_ror:8 row_mask:0xf bank_mask:0xf
  v_smfmac_f32_16x16x64_bf16 v[20:23], v[116:119], v[240:247], v0
  s_waitcnt lgkmcnt(3)
  s_barrier
  ds_read_b128 v[100:103], v2 offset:3072
  v_smfmac_f32_16x16x64_bf16 v[24:27], v[116:119], a[0:7], v0
  s_mov_b32 m0, s31
  ds_read_b128 v[120:123], v1 offset:3072
  v_smfmac_f32_16x16x64_bf16 v[16:19], v[84:87], v[232:239], v0
  s_cmp_ge_i32 s14, s30
  s_cbranch_scc1 T_kvw_111
T_kvb_112:
  v_smfmac_f32_16x16x64_bf16 v[20:23], v[84:87], v[248:255], v0
  ds_read_b128 v[80:83], v4 offset:15360
  v_smfmac_f32_16x16x64_bf16 v[24:27], v[84:87], a[8:15], v0
  s_waitcnt lgkmcnt(2)
  v_smfmac_f32_16x16x64_bf16 v[16:19], v[100:103], v[128:135], v0
  ds_read_b128 v[92:95], v2 offset:0
  buffer_load_dwordx4 v9, s[4:7], s27 offen sc1 lds
  v_smfmac_f32_16x16x64_bf16 v[20:23], v[100:103], v[144:151], v0
  ds_read_b128 v[96:99], v1 offset:0
  s_mov_b32 m0, s32
  v_smfmac_f32_16x16x64_bf16 v[24:27], v[100:103], v[68:75], v0
  s_waitcnt vmcnt(1) lgkmcnt(3)
  ds_read_b128 v[116:119], v2 offset:1024
  v_smfmac_f32_16x16x64_bf16 v[16:19], v[120:123], v[136:143], v0
  ds_read_b128 v[124:127], v1 offset:1024
  v_smfmac_f32_16x16x64_bf16 v[20:23], v[120:123], v[152:159], v0
  s_waitcnt lgkmcnt(4)
  ds_read_b128 v[104:107], v2 offset:7168
  buffer_load_dwordx4 v9, s[4:7], s27 offen offset:128 sc1 lds
  v_smfmac_f32_16x16x64_bf16 v[24:27], v[120:123], v[76:83], v0
  s_waitcnt lgkmcnt(4)
  ds_read_b128 v[108:111], v1 offset:7168
  s_mov_b32 m0, s33
  v_smfmac_f32_16x16x64_bf16 v[16:19], v[92:95], v[160:167], v0
  s_waitcnt lgkmcnt(4)
  ds_read_b128 v[112:115], v2 offset:4096
  v_smfmac_f32_16x16x64_bf16 v[16:19], v[96:99], v[168:175], v0
  s_waitcnt lgkmcnt(4)
  ds_read_b128 v[84:87], v1 offset:4096
  v_smfmac_f32_16x16x64_bf16 v[16:19], v[116:119], v[192:199], v0
  s_waitcnt lgkmcnt(4)
  ds_read_b128 v[88:91], v2 offset:5120
  buffer_load_dwordx4 v10, s[4:7], s28 offen sc1 lds
  v_smfmac_f32_16x16x64_bf16 v[16:19], v[124:127], v[200:207], v0
  s_waitcnt lgkmcnt(4)
  ds_read_b128 v[100:103], v1 offset:5120
  s_mov_b32 m0, s34
  v_smfmac_f32_16x16x64_bf16 v[16:19], v[104:107], a[16:23], v0
  s_waitcnt lgkmcnt(4)
  ds_read_b128 v[68:71], v4 offset:16384
  v_smfmac_f32_16x16x64_bf16 v[16:19], v[108:111], a[24:31], v0
  s_waitcnt lgkmcnt(4)
  ds_read_b128 v[72:75], v4 offset:17408
  v_smfmac_f32_16x16x64_bf16 v[16:19], v[112:115], a[64:71], v0
  s_waitcnt lgkmcnt(4)
  ds_read_b128 v[76:79], v4 offset:18432
  buffer_load_dwordx4 v10, s[4:7], s28 offen offset:256 sc1 lds
  v_smfmac_f32_16x16x64_bf16 v[16:19], v[84:87], a[72:79], v0
  s_waitcnt lgkmcnt(4)
  ds_read_b128 v[80:83], v4 offset:19456
  v_smfmac_f32_16x16x64_bf16 v[16:19], v[88:91], a[112:119], v0
  s_waitcnt lgkmcnt(4)
  v_smfmac_f32_16x16x64_bf16 v[16:19], v[100:103], a[120:127], v0
  s_add_u32 s24, s36, 145752064
  s_add_u32 s25, s36, 145756160
  v_smfmac_f32_16x16x64_bf16 v[20:23], v[92:95], v[176:183], v0
  s_add_u32 s35, s36, s23
  v_smfmac_f32_16x16x64_bf16 v[20:23], v[96:99], v[184:191], v0
  s_waitcnt lgkmcnt(2)
  v_smfmac_f32_16x16x64_bf16 v[20:23], v[116:119], v[68:75], v0
  s_waitcnt lgkmcnt(0)
  ds_read_b128 v[68:71], v4 offset:20480
  v_mul_f32 v16, s18, v16
  v_smfmac_f32_16x16x64_bf16 v[20:23], v[124:127], v[76:83], v0
  ds_read_b128 v[72:75], v4 offset:21504
  v_mul_f32 v17, s18, v17
  v_smfmac_f32_16x16x64_bf16 v[20:23], v[104:107], a[32:39], v0
  ds_read_b128 v[76:79], v4 offset:22528
  v_mul_f32 v18, s18, v18
  v_smfmac_f32_16x16x64_bf16 v[20:23], v[108:111], a[40:47], v0
  ds_read_b128 v[80:83], v4 offset:23552
  v_mul_f32 v19, s18, v19
  v_smfmac_f32_16x16x64_bf16 v[20:23], v[112:115], a[80:87], v0
  v_cvt_pk_bf16_f32 v120, v16, v17
  v_smfmac_f32_16x16x64_bf16 v[20:23], v[84:87], a[88:95], v0
  v_cvt_pk_bf16_f32 v121, v18, v19
  v_smfmac_f32_16x16x64_bf16 v[20:23], v[88:91], a[128:135], v0
  ds_write_b64 v5, v[120:121] offset:24576
  v_smfmac_f32_16x16x64_bf16 v[20:23], v[100:103], a[136:143], v0
  s_waitcnt lgkmcnt(3)
  v_smfmac_f32_16x16x64_bf16 v[24:27], v[92:95], v[68:75], v0
  s_waitcnt lgkmcnt(1)
  v_mov_b64 v[92:93], 0
  v_smfmac_f32_16x16x64_bf16 v[24:27], v[96:99], v[76:83], v0
  s_nop 1
  v_cvt_pk_bf16_f32 v122, v20, v21
  v_cvt_pk_bf16_f32 v123, v22, v23
  v_smfmac_f32_16x16x64_bf16 v[24:27], v[116:119], v[208:215], v0
  ds_write_b64 v5, v[122:123] offset:26880
  v_mov_b64 v[94:95], 0
  v_smfmac_f32_16x16x64_bf16 v[24:27], v[124:127], v[216:223], v0
  s_waitcnt lgkmcnt(1)
  s_barrier
  ds_read_b64_tr_b16 v[68:69], v6 offset:24576
  v_smfmac_f32_16x16x64_bf16 v[24:27], v[104:107], a[48:55], v0
  s_add_u32 s27, s27, 8192
  ds_read_b64_tr_b16 v[70:71], v6 offset:24640
  ds_read_b64_tr_b16 v[72:73], v6 offset:24832
  v_smfmac_f32_16x16x64_bf16 v[24:27], v[108:111], a[56:63], v0
  s_add_u32 s28, s28, 8192
  ds_read_b64_tr_b16 v[74:75], v6 offset:24896
  ds_read_b64_tr_b16 v[76:77], v6 offset:25088
  v_smfmac_f32_16x16x64_bf16 v[24:27], v[112:115], a[96:103], v0
  s_nop 0
  ds_read_b64_tr_b16 v[78:79], v6 offset:25152
  ds_read_b64_tr_b16 v[80:81], v6 offset:25344
  v_smfmac_f32_16x16x64_bf16 v[24:27], v[84:87], a[104:111], v0
  ds_read_b64_tr_b16 v[82:83], v6 offset:25408
  v_mov_b64 v[96:97], 0
  v_smfmac_f32_16x16x64_bf16 v[24:27], v[88:91], a[144:151], v0
  s_waitcnt lgkmcnt(8)
  s_barrier
  ds_read_b64_tr_b16 v[116:117], v6 offset:26880
  v_smfmac_f32_16x16x64_bf16 v[24:27], v[100:103], a[152:159], v0
  s_waitcnt lgkmcnt(7)
  ds_read_b64_tr_b16 v[118:119], v6 offset:26944
  buffer_store_dwordx2 v[122:123], v5, s[4:7], s29 offen sc1
  v_mfma_f32_16x16x32_bf16 v[16:19], v[36:39], v[68:71], 0
  s_waitcnt lgkmcnt(6)
  ds_read_b64_tr_b16 v[124:125], v6 offset:27136
  ds_read_b64_tr_b16 v[126:127], v6 offset:27200
  v_mfma_f32_16x16x32_bf16 v[16:19], v[40:43], v[72:75], v[16:19]
  s_waitcnt lgkmcnt(6)
  ds_read_b64_tr_b16 v[104:105], v6 offset:27392
  ds_read_b64_tr_b16 v[106:107], v6 offset:27456
  v_mfma_f32_16x16x32_bf16 v[16:19], v[44:47], v[76:79], v[16:19]
  s_waitcnt lgkmcnt(6)
  ds_read_b64_tr_b16 v[108:109], v6 offset:27648
  ds_read_b64_tr_b16 v[110:111], v6 offset:27712
  v_mfma_f32_16x16x32_bf16 v[16:19], v[48:51], v[80:83], v[16:19]
  s_waitcnt lgkmcnt(6)
  v_cvt_pk_bf16_f32 v120, v24, v25
  v_cvt_pk_bf16_f32 v121, v26, v27
  v_mov_b32 v86, s14
  v_mfma_f32_16x16x32_bf16 v[112:115], v[116:119], v[68:71], 0
  s_waitcnt lgkmcnt(4)
  buffer_store_dword v86, v3, s[4:7], s15 offen sc1
  buffer_store_dwordx2 v[120:121], v5, s[4:7], s29 offen offset:2304 sc1
  v_mov_b64 v[98:99], 0
  v_mfma_f32_16x16x32_bf16 v[112:115], v[124:127], v[72:75], v[112:115]
  s_waitcnt lgkmcnt(2)
  v_mov_b64 v[36:37], 0
  v_exp_f32 v100, v16
  v_mfma_f32_16x16x32_bf16 v[112:115], v[104:107], v[76:79], v[112:115]
  s_waitcnt lgkmcnt(0)
  v_exp_f32 v101, v17
  v_mfma_f32_16x16x32_bf16 v[112:115], v[108:111], v[80:83], v[112:115]
  s_add_u32 s29, s29, 147456
  v_exp_f32 v102, v18
  v_mfma_f32_16x16x32_bf16 v[20:23], v[52:55], v[68:71], 0
  s_cmp_eq_u32 s14, 63
  v_exp_f32 v103, v19
  v_mfma_f32_16x16x32_bf16 v[20:23], v[56:59], v[72:75], v[20:23]
  s_cbranch_scc1 M_tdone
  v_cvt_pk_bf16_f32 v44, v100, v101
  v_cvt_pk_bf16_f32 v45, v102, v103
  v_mfma_f32_16x16x32_bf16 v[20:23], v[60:63], v[76:79], v[20:23]
  v_exp_f32 v100, v112
  v_mfma_f32_16x16x32_bf16 v[20:23], v[64:67], v[80:83], v[20:23]
  v_exp_f32 v101, v113
  v_exp_f32 v102, v114
  v_exp_f32 v103, v115
  v_cvt_pk_bf16_f32 v84, v100, v101
  v_cvt_pk_bf16_f32 v85, v102, v103
  v_cndmask_b32 v48, v84, 0, s[16:17]
  v_cndmask_b32 v49, v85, 0, s[16:17]
  v_cndmask_b32 v50, 0, v84, s[16:17]
  v_cndmask_b32 v51, 0, v85, s[16:17]
  v_exp_f32 v100, v20
  v_mfma_f32_16x16x16_bf16 v[88:91], v[12:13], v[48:49], 0
  v_exp_f32 v101, v21
  v_mfma_f32_16x16x16_bf16 v[24:27], v[120:121], v[48:49], 0
  v_exp_f32 v102, v22
  v_mfma_f32_16x16x16_bf16 v[116:119], v[120:121], v[50:51], 0
  v_exp_f32 v103, v23
  v_cvt_pk_bf16_f32 v46, v100, v101
  v_cvt_pk_bf16_f32 v47, v102, v103
  v_mov_b64 v[38:39], 0
  s_nop 0
  v_mfma_f32_16x16x32_bf16 v[88:91], v[12:15], v[44:47], v[88:91]
  v_mov_b64 v[40:41], 0
  v_mov_b64 v[42:43], 0
  v_mfma_f32_16x16x32_bf16 v[24:27], v[28:31], v[44:47], v[24:27]
  ds_read_b128 v[52:55], v4 offset:24576
  ds_read_b128 v[56:59], v4 offset:25600
  v_mfma_f32_16x16x32_bf16 v[116:119], v[32:35], v[44:47], v[116:119]
  s_nop 1
  v_rcp_f32 v89, v88
  v_subrev_u32 v100, s54, v88
  v_cmp_le_u32 vcc, s55, v100
  v_mul_f32 v24, v89, v24
  v_mul_f32 v25, v89, v25
  s_cbranch_vccnz T_slow_113
T_back_114:
  v_cvt_pk_bf16_f32 v124, v24, v25
  v_pk_mul_f32 v[26:27], v[26:27], v[88:89] op_sel:[0,1] op_sel_hi:[1,1]
  v_pk_mul_f32 v[116:117], v[116:117], v[88:89] op_sel:[0,1] op_sel_hi:[1,1]
  v_pk_mul_f32 v[118:119], v[118:119], v[88:89] op_sel:[0,1] op_sel_hi:[1,1]
  v_cvt_pk_bf16_f32 v125, v26, v27
  v_cvt_pk_bf16_f32 v126, v116, v117
  v_cvt_pk_bf16_f32 v127, v118, v119
  ds_write_b128 v11, v[124:127] offset:30208
  s_nop 0
  v_smfmac_f32_16x16x64_bf16 v[92:95], v[124:127], a[160:167], v0
  v_smfmac_f32_16x16x64_bf16 v[96:99], v[124:127], a[168:175], v0
  v_smfmac_f32_16x16x64_bf16 v[36:39], v[124:127], a[176:183], v0
  v_smfmac_f32_16x16x64_bf16 v[40:43], v[124:127], a[184:191], v0
  s_waitcnt lgkmcnt(0)
  s_barrier
  ds_read_b128 v[104:107], v11 offset:30720
  ds_read_b128 v[108:111], v11 offset:29184
  ds_read_b128 v[68:71], v11 offset:29696
  s_waitcnt lgkmcnt(2)
  v_smfmac_f32_16x16x64_bf16 v[92:95], v[104:107], a[192:199], v0
  s_waitcnt lgkmcnt(1)
  ds_read_b128 v[76:79], v4 offset:28672
  v_smfmac_f32_16x16x64_bf16 v[92:95], v[108:111], a[224:231], v0
  s_waitcnt lgkmcnt(1)
  ds_read_b128 v[80:83], v4 offset:29696
  v_smfmac_f32_16x16x64_bf16 v[92:95], v[68:71], a[240:247], v0
  ds_read_b128 v[60:63], v4 offset:26624
  v_smfmac_f32_16x16x64_bf16 v[96:99], v[104:107], a[200:207], v0
  ds_read_b128 v[64:67], v4 offset:27648
  v_smfmac_f32_16x16x64_bf16 v[96:99], v[108:111], a[232:239], v0
  ds_read_b128 v[28:31], v4 offset:30720
  s_nop 0
  v_cvt_pk_bf16_f32 v16, v92, v93
  v_cvt_pk_bf16_f32 v17, v94, v95
  v_bfi_b32 v16, 1, s57, v16
  v_smfmac_f32_16x16x64_bf16 v[96:99], v[68:71], a[248:255], v0
  buffer_store_dwordx2 v[16:17], v7, s[4:7], s20 offen offset:0
  v_smfmac_f32_16x16x64_bf16 v[36:39], v[104:107], a[208:215], v0
  ds_read_b128 v[32:35], v4 offset:31744
  v_smfmac_f32_16x16x64_bf16 v[36:39], v[108:111], v[52:59], v0
  s_waitcnt lgkmcnt(4)
  s_nop 0
  v_cvt_pk_bf16_f32 v18, v96, v97
  v_cvt_pk_bf16_f32 v19, v98, v99
  v_bfi_b32 v18, 1, s57, v18
  v_smfmac_f32_16x16x64_bf16 v[36:39], v[68:71], v[76:83], v0
  buffer_store_dwordx2 v[18:19], v7, s[4:7], s20 offen offset:64
  v_smfmac_f32_16x16x64_bf16 v[40:43], v[104:107], a[216:223], v0
  s_waitcnt lgkmcnt(2)
  v_smfmac_f32_16x16x64_bf16 v[40:43], v[108:111], v[60:67], v0
  s_waitcnt lgkmcnt(0)
  s_nop 0
  v_cvt_pk_bf16_f32 v20, v36, v37
  v_cvt_pk_bf16_f32 v21, v38, v39
  v_bfi_b32 v20, 1, s57, v20
  v_smfmac_f32_16x16x64_bf16 v[40:43], v[68:71], v[28:35], v0
  buffer_store_dwordx2 v[20:21], v7, s[4:7], s21 offen offset:0
  s_nop 6
  v_cvt_pk_bf16_f32 v22, v40, v41
  v_cvt_pk_bf16_f32 v23, v42, v43
  v_bfi_b32 v22, 1, s57, v22
  buffer_store_dwordx2 v[22:23], v7, s[4:7], s21 offen offset:64
  ds_read_b128 v[68:71], v4 offset:0
  ds_read_b128 v[72:75], v4 offset:1024
  ds_read_b128 v[76:79], v4 offset:4096
  ds_read_b128 v[80:83], v4 offset:5120
  ds_read_b128 v[84:87], v4 offset:8192
  ds_read_b128 v[88:91], v4 offset:9216
  ds_read_b128 v[92:95], v4 offset:2048
  ds_read_b128 v[96:99], v4 offset:3072
  ds_read_b128 v[100:103], v4 offset:6144
  ds_read_b128 v[104:107], v4 offset:7168
  ds_read_b128 v[108:111], v4 offset:10240
  ds_read_b128 v[112:115], v4 offset:11264
  v_mov_b64 v[16:17], 0
  v_mov_b64 v[18:19], 0
  v_mov_b64 v[20:21], 0
  v_mov_b64 v[22:23], 0
  v_mov_b64 v[24:25], 0
  v_mov_b64 v[26:27], 0
  ds_read_b64 v[44:45], v2 offset:32256
  s_waitcnt lgkmcnt(0)
  v_readfirstlane_b32 s38, v44
  v_readfirstlane_b32 s37, v45
  s_nop 0
  s_add_u32 s37, s37, 30
  s_cmp_ge_u32 s38, 30
  s_cselect_b32 s38, s37, s38
  s_cmp_ge_u32 s38, 64
  s_cselect_b32 s38, 100, s38
  s_sub_u32 s38, s38, 1
  s_max_i32 s30, s30, s38
  s_waitcnt vmcnt(4)
  s_barrier
  ds_read_b128 v[28:31], v2 offset:18432
  ds_read_b128 v[32:35], v2 offset:22528
  ds_read_b128 v[36:39], v2 offset:8192
  ds_read_b128 v[40:43], v2 offset:9216
  ds_read_b128 v[44:47], v2 offset:10240
  ds_read_b128 v[48:51], v2 offset:11264
  buffer_load_dwordx4 v[124:127], v2, s[4:7], s24 offen offset:2048 sc1
  buffer_load_dwordx4 v[116:119], v2, s[4:7], s25 offen offset:2048 sc1
  ds_read_b128 v[52:55], v2 offset:12288
  ds_read_b128 v[56:59], v2 offset:13312
  ds_read_b128 v[60:63], v2 offset:14336
  ds_read_b128 v[64:67], v2 offset:15360
  buffer_load_dwordx4 v[124:127], v2, s[4:7], s24 offen offset:2048 sc1
  buffer_load_dwordx4 v[116:119], v2, s[4:7], s25 offen offset:2048 sc1
  s_mov_b32 s19, 0
  s_branch T_loop_107
T_kvw_111:
  s_mov_b32 s19, 0
  s_branch T_kvok_119
T_kv_118:
  s_sleep 4
  s_add_u32 s19, s19, 1
  s_cmp_gt_u32 s19, 32768
  s_cbranch_scc1 M_exit
T_kvok_119:
  s_add_u32 s39, s99, 128
  s_mov_b32 s38, 0
  s_mov_b32 s37, 0
  s_atomic_or s38, s[58:59], s99 glc
  s_atomic_or s37, s[58:59], s39 glc
  s_waitcnt lgkmcnt(0)
  s_add_u32 s37, s37, 30
  s_cmp_ge_u32 s38, 30
  s_cselect_b32 s38, s37, s38
  s_cmp_ge_u32 s38, 64
  s_cselect_b32 s38, 100, s38
  s_sub_u32 s38, s38, 1
  s_max_i32 s30, s30, s38
  s_cmp_ge_i32 s14, s30
  s_cbranch_scc1 T_kv_118
  s_branch T_kvb_112
T_slow_113:
  s_nop 7
  v_max3_f32 v100, v16, v17, v18
  v_max3_f32 v100, v100, v19, v20
  v_max3_f32 v100, v100, v21, v22
  v_max3_f32 v100, v100, v23, v112
  v_max3_f32 v100, v100, v113, v114
  v_max_f32 v100, v100, v115
  v_mov_b32 v101, v100
  s_nop 1
  v_permlane32_swap_b32 v100, v101
  s_nop 1
  v_max_f32 v100, v100, v101
  v_mov_b32 v101, v100
  s_nop 1
  v_permlane16_swap_b32 v100, v101
  s_nop 1
  v_max_f32 v100, v100, v101
  v_sub_f32 v16, v16, v100
  v_sub_f32 v17, v17, v100
  v_sub_f32 v18, v18, v100
  v_sub_f32 v19, v19, v100
  v_exp_f32 v16, v16
  v_exp_f32 v17, v17
  v_exp_f32 v18, v18
  v_exp_f32 v19, v19
  v_sub_f32 v20, v20, v100
  v_sub_f32 v21, v21, v100
  v_sub_f32 v22, v22, v100
  v_sub_f32 v23, v23, v100
  v_exp_f32 v20, v20
  v_exp_f32 v21, v21
  v_exp_f32 v22, v22
  v_exp_f32 v23, v23
  v_sub_f32 v112, v112, v100
  v_sub_f32 v113, v113, v100
  v_sub_f32 v114, v114, v100
  v_sub_f32 v115, v115, v100
  v_exp_f32 v112, v112
  v_exp_f32 v113, v113
  v_exp_f32 v114, v114
  v_exp_f32 v115, v115
  s_nop 0
  v_cvt_pk_bf16_f32 v44, v16, v17
  v_cvt_pk_bf16_f32 v45, v18, v19
  v_cvt_pk_bf16_f32 v46, v20, v21
  v_cvt_pk_bf16_f32 v47, v22, v23
  v_cvt_pk_bf16_f32 v84, v112, v113
  v_cvt_pk_bf16_f32 v85, v114, v115
  v_cndmask_b32 v48, v84, 0, s[16:17]
  v_cndmask_b32 v49, v85, 0, s[16:17]
  v_cndmask_b32 v50, 0, v84, s[16:17]
  v_cndmask_b32 v51, 0, v85, s[16:17]
  s_nop 1
  v_mfma_f32_16x16x16_bf16 v[88:91], v[12:13], v[48:49], 0
  v_mfma_f32_16x16x16_bf16 v[24:27], v[120:121], v[48:49], 0
  v_mfma_f32_16x16x16_bf16 v[116:119], v[120:121], v[50:51], 0
  v_mfma_f32_16x16x32_bf16 v[88:91], v[12:15], v[44:47], v[88:91]
  v_mfma_f32_16x16x32_bf16 v[24:27], v[28:31], v[44:47], v[24:27]
  v_mfma_f32_16x16x32_bf16 v[116:119], v[32:35], v[44:47], v[116:119]
  s_nop 7
  s_nop 1
  v_rcp_f32 v89, v88
  s_nop 0
  v_mul_f32 v24, v89, v24
  v_mul_f32 v25, v89, v25
  s_branch T_back_114
T_w_80:
  s_mov_b32 s19, 0
  v_mov_b64 v[16:17], 0
  v_mov_b64 v[18:19], 0
  v_mov_b64 v[20:21], 0
  v_mov_b64 v[22:23], 0
  v_mov_b64 v[24:25], 0
  v_mov_b64 v[26:27], 0
  buffer_load_dwordx4 v[124:127], v2, s[4:7], s24 offen offset:3072 sc1
  buffer_load_dwordx4 v[116:119], v2, s[4:7], s25 offen offset:3072 sc1
  buffer_load_dwordx4 v[124:127], v2, s[4:7], s24 offen offset:3072 sc1
  buffer_load_dwordx4 v[116:119], v2, s[4:7], s25 offen offset:3072 sc1
  s_branch T_loop_120
.p2align 6
T_retry_121:
  s_mov_b64 exec, vcc
  buffer_load_dwordx4 v[124:127], v2, s[4:7], s24 offen offset:3072 sc1
  buffer_load_dwordx4 v[116:119], v2, s[4:7], s25 offen offset:3072 sc1
  s_mov_b64 exec, -1
  s_add_u32 s19, s19, 1
  s_cmp_gt_u32 s19, 32768
  s_cbranch_scc1 M_exit
T_loop_120:
  s_waitcnt vmcnt(3) lgkmcnt(0)
  v_max3_u32 v123, v124, v125, v126
  v_max_u32 v123, v123, v127
  v_mov_b32_dpp v120, v124 row_ror:8 row_mask:0xf bank_mask:0xf
  v_mov_b32_dpp v121, v125 row_ror:8 row_mask:0xf bank_mask:0xf
  s_waitcnt vmcnt(2)
  v_max3_u32 v123, v123, v116, v117
  v_max3_u32 v123, v123, v118, v119
  v_cmp_eq_u32 vcc, -1, v123
  s_cbranch_vccnz T_retry_121
  v_smfmac_f32_16x16x64_bf16 v[16:19], v[124:127], v[68:75], v0
  s_add_u32 s14, s14, 1
  ds_write_b128 v2, v[124:127] offset:3072
  v_mov_b32_dpp v122, v126 row_ror:8 row_mask:0xf bank_mask:0xf
  v_smfmac_f32_16x16x64_bf16 v[20:23], v[124:127], v[76:83], v0
  s_and_b32 s57, s14, 1
  v_mov_b32_dpp v123, v127 row_ror:8 row_mask:0xf bank_mask:0xf
  v_smfmac_f32_16x16x64_bf16 v[24:27], v[124:127], v[84:91], v0
  s_and_b32 s36, s14, 3
  ds_write_b128 v2, v[116:119] offset:7168
  v_smfmac_f32_16x16x64_bf16 v[16:19], v[120:123], v[92:99], v0
  s_lshl_b32 s36, s36, 13
  v_mov_b32_dpp v84, v116 row_ror:8 row_mask:0xf bank_mask:0xf
  v_smfmac_f32_16x16x64_bf16 v[20:23], v[120:123], v[100:107], v0
  s_add_u32 s26, s36, s23
  ds_read_b128 v[68:71], v4 offset:12288
  v_mov_b32_dpp v85, v117 row_ror:8 row_mask:0xf bank_mask:0xf
  v_smfmac_f32_16x16x64_bf16 v[24:27], v[120:123], v[108:115], v0
  s_add_u32 s36, s36, 8192
  ds_read_b128 v[72:75], v4 offset:13312
  v_mov_b32_dpp v86, v118 row_ror:8 row_mask:0xf bank_mask:0xf
  v_smfmac_f32_16x16x64_bf16 v[16:19], v[116:119], v[224:231], v0
  s_and_b32 s36, s36, 0x7fff
  ds_read_b128 v[76:79], v4 offset:14336
  v_mov_b32_dpp v87, v119 row_ror:8 row_mask:0xf bank_mask:0xf
  v_smfmac_f32_16x16x64_bf16 v[20:23], v[116:119], v[240:247], v0
  s_waitcnt lgkmcnt(3)
  s_barrier
  ds_read_b128 v[100:103], v2 offset:2048
  v_smfmac_f32_16x16x64_bf16 v[24:27], v[116:119], a[0:7], v0
  s_mov_b32 m0, s31
  ds_read_b128 v[120:123], v1 offset:2048
  v_smfmac_f32_16x16x64_bf16 v[16:19], v[84:87], v[232:239], v0
  s_cmp_ge_i32 s14, s30
  s_cbranch_scc1 T_kvw_124
T_kvb_125:
  v_smfmac_f32_16x16x64_bf16 v[20:23], v[84:87], v[248:255], v0
  ds_read_b128 v[80:83], v4 offset:15360
  v_smfmac_f32_16x16x64_bf16 v[24:27], v[84:87], a[8:15], v0
  s_waitcnt lgkmcnt(2)
  v_smfmac_f32_16x16x64_bf16 v[16:19], v[100:103], v[128:135], v0
  ds_read_b128 v[92:95], v2 offset:1024
  v_smfmac_f32_16x16x64_bf16 v[20:23], v[100:103], v[144:151], v0
  ds_read_b128 v[96:99], v1 offset:1024
  buffer_load_dwordx4 v9, s[4:7], s27 offen sc1 lds
  v_smfmac_f32_16x16x64_bf16 v[24:27], v[100:103], v[68:75], v0
  s_waitcnt vmcnt(1) lgkmcnt(3)
  ds_read_b128 v[116:119], v2 offset:0
  s_mov_b32 m0, s32
  v_smfmac_f32_16x16x64_bf16 v[16:19], v[120:123], v[136:143], v0
  ds_read_b128 v[124:127], v1 offset:0
  v_smfmac_f32_16x16x64_bf16 v[20:23], v[120:123], v[152:159], v0
  s_waitcnt lgkmcnt(4)
  ds_read_b128 v[104:107], v2 offset:6144
  v_smfmac_f32_16x16x64_bf16 v[24:27], v[120:123], v[76:83], v0
  s_waitcnt lgkmcnt(4)
  ds_read_b128 v[108:111], v1 offset:6144
  buffer_load_dwordx4 v9, s[4:7], s27 offen offset:128 sc1 lds
  v_smfmac_f32_16x16x64_bf16 v[16:19], v[92:95], v[160:167], v0
  s_waitcnt lgkmcnt(4)
  ds_read_b128 v[112:115], v2 offset:5120
  s_mov_b32 m0, s33
  v_smfmac_f32_16x16x64_bf16 v[16:19], v[96:99], v[168:175], v0
  s_waitcnt lgkmcnt(4)
  ds_read_b128 v[84:87], v1 offset:5120
  v_smfmac_f32_16x16x64_bf16 v[16:19], v[116:119], v[192:199], v0
  s_waitcnt lgkmcnt(4)
  ds_read_b128 v[88:91], v2 offset:4096
  v_smfmac_f32_16x16x64_bf16 v[16:19], v[124:127], v[200:207], v0
  s_waitcnt lgkmcnt(4)
  ds_read_b128 v[100:103], v1 offset:4096
  buffer_load_dwordx4 v10, s[4:7], s28 offen sc1 lds
  v_smfmac_f32_16x16x64_bf16 v[16:19], v[104:107], a[16:23], v0
  s_waitcnt lgkmcnt(4)
  ds_read_b128 v[68:71], v4 offset:16384
  s_mov_b32 m0, s34
  v_smfmac_f32_16x16x64_bf16 v[16:19], v[108:111], a[24:31], v0
  s_waitcnt lgkmcnt(4)
  ds_read_b128 v[72:75], v4 offset:17408
  v_smfmac_f32_16x16x64_bf16 v[16:19], v[112:115], a[64:71], v0
  s_waitcnt lgkmcnt(4)
  ds_read_b128 v[76:79], v4 offset:18432
  v_smfmac_f32_16x16x64_bf16 v[16:19], v[84:87], a[72:79], v0
  s_waitcnt lgkmcnt(4)
  ds_read_b128 v[80:83], v4 offset:19456
  buffer_load_dwordx4 v10, s[4:7], s28 offen offset:256 sc1 lds
  v_smfmac_f32_16x16x64_bf16 v[16:19], v[88:91], a[112:119], v0
  s_waitcnt lgkmcnt(4)
  v_smfmac_f32_16x16x64_bf16 v[16:19], v[100:103], a[120:127], v0
  s_add_u32 s24, s36, 145752064
  s_add_u32 s25, s36, 145756160
  v_smfmac_f32_16x16x64_bf16 v[20:23], v[92:95], v[176:183], v0
  s_add_u32 s35, s36, s23
  v_smfmac_f32_16x16x64_bf16 v[20:23], v[96:99], v[184:191], v0
  s_waitcnt lgkmcnt(2)
  v_smfmac_f32_16x16x64_bf16 v[20:23], v[116:119], v[68:75], v0
  s_waitcnt lgkmcnt(0)
  ds_read_b128 v[68:71], v4 offset:20480
  v_mul_f32 v16, s18, v16
  v_smfmac_f32_16x16x64_bf16 v[20:23], v[124:127], v[76:83], v0
  ds_read_b128 v[72:75], v4 offset:21504
  v_mul_f32 v17, s18, v17
  v_smfmac_f32_16x16x64_bf16 v[20:23], v[104:107], a[32:39], v0
  ds_read_b128 v[76:79], v4 offset:22528
  v_mul_f32 v18, s18, v18
  v_smfmac_f32_16x16x64_bf16 v[20:23], v[108:111], a[40:47], v0
  ds_read_b128 v[80:83], v4 offset:23552
  v_mul_f32 v19, s18, v19
  v_smfmac_f32_16x16x64_bf16 v[20:23], v[112:115], a[80:87], v0
  v_cvt_pk_bf16_f32 v120, v16, v17
  v_smfmac_f32_16x16x64_bf16 v[20:23], v[84:87], a[88:95], v0
  v_cvt_pk_bf16_f32 v121, v18, v19
  v_smfmac_f32_16x16x64_bf16 v[20:23], v[88:91], a[128:135], v0
  ds_write_b64 v5, v[120:121] offset:24576
  v_smfmac_f32_16x16x64_bf16 v[20:23], v[100:103], a[136:143], v0
  s_waitcnt lgkmcnt(3)
  v_smfmac_f32_16x16x64_bf16 v[24:27], v[92:95], v[68:75], v0
  s_waitcnt lgkmcnt(1)
  v_mov_b64 v[92:93], 0
  v_smfmac_f32_16x16x64_bf16 v[24:27], v[96:99], v[76:83], v0
  s_nop 1
  v_cvt_pk_bf16_f32 v122, v20, v21
  v_cvt_pk_bf16_f32 v123, v22, v23
  v_smfmac_f32_16x16x64_bf16 v[24:27], v[116:119], v[208:215], v0
  ds_write_b64 v5, v[122:123] offset:26880
  v_mov_b64 v[94:95], 0
  v_smfmac_f32_16x16x64_bf16 v[24:27], v[124:127], v[216:223], v0
  s_waitcnt lgkmcnt(1)
  s_barrier
  ds_read_b64_tr_b16 v[68:69], v6 offset:24576
  v_smfmac_f32_16x16x64_bf16 v[24:27], v[104:107], a[48:55], v0
  s_add_u32 s27, s27, 8192
  ds_read_b64_tr_b16 v[70:71], v6 offset:24640
  ds_read_b64_tr_b16 v[72:73], v6 offset:24832
  v_smfmac_f32_16x16x64_bf16 v[24:27], v[108:111], a[56:63], v0
  s_add_u32 s28, s28, 8192
  ds_read_b64_tr_b16 v[74:75], v6 offset:24896
  ds_read_b64_tr_b16 v[76:77], v6 offset:25088
  v_smfmac_f32_16x16x64_bf16 v[24:27], v[112:115], a[96:103], v0
  s_nop 0
  ds_read_b64_tr_b16 v[78:79], v6 offset:25152
  ds_read_b64_tr_b16 v[80:81], v6 offset:25344
  v_smfmac_f32_16x16x64_bf16 v[24:27], v[84:87], a[104:111], v0
  ds_read_b64_tr_b16 v[82:83], v6 offset:25408
  v_mov_b64 v[96:97], 0
  v_smfmac_f32_16x16x64_bf16 v[24:27], v[88:91], a[144:151], v0
  s_waitcnt lgkmcnt(8)
  s_barrier
  ds_read_b64_tr_b16 v[116:117], v6 offset:26880
  v_smfmac_f32_16x16x64_bf16 v[24:27], v[100:103], a[152:159], v0
  s_waitcnt lgkmcnt(7)
  ds_read_b64_tr_b16 v[118:119], v6 offset:26944
  buffer_store_dwordx2 v[122:123], v5, s[4:7], s29 offen sc1
  v_mfma_f32_16x16x32_bf16 v[16:19], v[36:39], v[68:71], 0
  s_waitcnt lgkmcnt(6)
  ds_read_b64_tr_b16 v[124:125], v6 offset:27136
  ds_read_b64_tr_b16 v[126:127], v6 offset:27200
  v_mfma_f32_16x16x32_bf16 v[16:19], v[40:43], v[72:75], v[16:19]
  s_waitcnt lgkmcnt(6)
  ds_read_b64_tr_b16 v[104:105], v6 offset:27392
  ds_read_b64_tr_b16 v[106:107], v6 offset:27456
  v_mfma_f32_16x16x32_bf16 v[16:19], v[44:47], v[76:79], v[16:19]
  s_waitcnt lgkmcnt(6)
  ds_read_b64_tr_b16 v[108:109], v6 offset:27648
  ds_read_b64_tr_b16 v[110:111], v6 offset:27712
  v_mfma_f32_16x16x32_bf16 v[16:19], v[48:51], v[80:83], v[16:19]
  s_waitcnt lgkmcnt(6)
  s_mov_b32 m0, 32256
  v_cvt_pk_bf16_f32 v120, v24, v25
  v_cvt_pk_bf16_f32 v121, v26, v27
  v_mfma_f32_16x16x32_bf16 v[112:115], v[116:119], v[68:71], 0
  s_waitcnt lgkmcnt(4)
  buffer_load_dword v3, s[4:7], s99 offen sc1 lds
  buffer_store_dwordx2 v[120:121], v5, s[4:7], s29 offen offset:2304 sc1
  v_mov_b64 v[98:99], 0
  v_mfma_f32_16x16x32_bf16 v[112:115], v[124:127], v[72:75], v[112:115]
  s_waitcnt lgkmcnt(2)
  v_mov_b64 v[36:37], 0
  v_exp_f32 v100, v16
  v_mfma_f32_16x16x32_bf16 v[112:115], v[104:107], v[76:79], v[112:115]
  s_waitcnt lgkmcnt(0)
  v_exp_f32 v101, v17
  v_mfma_f32_16x16x32_bf16 v[112:115], v[108:111], v[80:83], v[112:115]
  s_add_u32 s29, s29, 147456
  v_exp_f32 v102, v18
  v_mfma_f32_16x16x32_bf16 v[20:23], v[52:55], v[68:71], 0
  s_cmp_eq_u32 s14, 63
  v_exp_f32 v103, v19
  v_mfma_f32_16x16x32_bf16 v[20:23], v[56:59], v[72:75], v[20:23]
  s_cbranch_scc1 M_tdone
  v_cvt_pk_bf16_f32 v44, v100, v101
  v_cvt_pk_bf16_f32 v45, v102, v103
  v_mfma_f32_16x16x32_bf16 v[20:23], v[60:63], v[76:79], v[20:23]
  v_exp_f32 v100, v112
  v_mfma_f32_16x16x32_bf16 v[20:23], v[64:67], v[80:83], v[20:23]
  v_exp_f32 v101, v113
  v_exp_f32 v102, v114
  v_exp_f32 v103, v115
  v_cvt_pk_bf16_f32 v84, v100, v101
  v_cvt_pk_bf16_f32 v85, v102, v103
  v_cndmask_b32 v48, v84, 0, s[16:17]
  v_cndmask_b32 v49, v85, 0, s[16:17]
  v_cndmask_b32 v50, 0, v84, s[16:17]
  v_cndmask_b32 v51, 0, v85, s[16:17]
  v_exp_f32 v100, v20
  v_mfma_f32_16x16x16_bf16 v[88:91], v[12:13], v[48:49], 0
  v_exp_f32 v101, v21
  v_mfma_f32_16x16x16_bf16 v[24:27], v[120:121], v[48:49], 0
  v_exp_f32 v102, v22
  v_mfma_f32_16x16x16_bf16 v[116:119], v[120:121], v[50:51], 0
  v_exp_f32 v103, v23
  v_cvt_pk_bf16_f32 v46, v100, v101
  v_cvt_pk_bf16_f32 v47, v102, v103
  v_mov_b64 v[38:39], 0
  s_nop 0
  v_mfma_f32_16x16x32_bf16 v[88:91], v[12:15], v[44:47], v[88:91]
  v_mov_b64 v[40:41], 0
  v_mov_b64 v[42:43], 0
  v_mfma_f32_16x16x32_bf16 v[24:27], v[28:31], v[44:47], v[24:27]
  ds_read_b128 v[52:55], v4 offset:24576
  ds_read_b128 v[56:59], v4 offset:25600
  v_mfma_f32_16x16x32_bf16 v[116:119], v[32:35], v[44:47], v[116:119]
  s_nop 1
  v_rcp_f32 v89, v88
  v_subrev_u32 v100, s54, v88
  v_cmp_le_u32 vcc, s55, v100
  v_mul_f32 v24, v89, v24
  v_mul_f32 v25, v89, v25
  s_cbranch_vccnz T_slow_126
T_back_127:
  v_cvt_pk_bf16_f32 v124, v24, v25
  v_pk_mul_f32 v[26:27], v[26:27], v[88:89] op_sel:[0,1] op_sel_hi:[1,1]
  v_pk_mul_f32 v[116:117], v[116:117], v[88:89] op_sel:[0,1] op_sel_hi:[1,1]
  v_pk_mul_f32 v[118:119], v[118:119], v[88:89] op_sel:[0,1] op_sel_hi:[1,1]
  v_cvt_pk_bf16_f32 v125, v26, v27
  v_cvt_pk_bf16_f32 v126, v116, v117
  v_cvt_pk_bf16_f32 v127, v118, v119
  ds_write_b128 v11, v[124:127] offset:30720
  s_nop 0
  v_smfmac_f32_16x16x64_bf16 v[92:95], v[124:127], a[160:167], v0
  v_smfmac_f32_16x16x64_bf16 v[96:99], v[124:127], a[168:175], v0
  v_smfmac_f32_16x16x64_bf16 v[36:39], v[124:127], a[176:183], v0
  v_smfmac_f32_16x16x64_bf16 v[40:43], v[124:127], a[184:191], v0
  s_waitcnt lgkmcnt(0)
  s_barrier
  ds_read_b128 v[104:107], v11 offset:30208
  ds_read_b128 v[108:111], v11 offset:29696
  ds_read_b128 v[68:71], v11 offset:29184
  s_waitcnt lgkmcnt(2)
  v_smfmac_f32_16x16x64_bf16 v[92:95], v[104:107], a[192:199], v0
  s_waitcnt lgkmcnt(1)
  ds_read_b128 v[76:79], v4 offset:28672
  v_smfmac_f32_16x16x64_bf16 v[92:95], v[108:111], a[224:231], v0
  s_waitcnt lgkmcnt(1)
  ds_read_b128 v[80:83], v4 offset:29696
  v_smfmac_f32_16x16x64_bf16 v[92:95], v[68:71], a[240:247], v0
  ds_read_b128 v[60:63], v4 offset:26624
  v_smfmac_f32_16x16x64_bf16 v[96:99], v[104:107], a[200:207], v0
  ds_read_b128 v[64:67], v4 offset:27648
  v_smfmac_f32_16x16x64_bf16 v[96:99], v[108:111], a[232:239], v0
  ds_read_b128 v[28:31], v4 offset:30720
  s_nop 0
  v_cvt_pk_bf16_f32 v16, v92, v93
  v_cvt_pk_bf16_f32 v17, v94, v95
  v_bfi_b32 v16, 1, s57, v16
  v_smfmac_f32_16x16x64_bf16 v[96:99], v[68:71], a[248:255], v0
  buffer_store_dwordx2 v[16:17], v7, s[4:7], s20 offen offset:0
  v_smfmac_f32_16x16x64_bf16 v[36:39], v[104:107], a[208:215], v0
  ds_read_b128 v[32:35], v4 offset:31744
  v_smfmac_f32_16x16x64_bf16 v[36:39], v[108:111], v[52:59], v0
  s_waitcnt lgkmcnt(4)
  s_nop 0
  v_cvt_pk_bf16_f32 v18, v96, v97
  v_cvt_pk_bf16_f32 v19, v98, v99
  v_bfi_b32 v18, 1, s57, v18
  v_smfmac_f32_16x16x64_bf16 v[36:39], v[68:71], v[76:83], v0
  buffer_store_dwordx2 v[18:19], v7, s[4:7], s20 offen offset:64
  v_smfmac_f32_16x16x64_bf16 v[40:43], v[104:107], a[216:223], v0
  s_waitcnt lgkmcnt(2)
  v_smfmac_f32_16x16x64_bf16 v[40:43], v[108:111], v[60:67], v0
  s_waitcnt lgkmcnt(0)
  s_nop 0
  v_cvt_pk_bf16_f32 v20, v36, v37
  v_cvt_pk_bf16_f32 v21, v38, v39
  v_bfi_b32 v20, 1, s57, v20
  v_smfmac_f32_16x16x64_bf16 v[40:43], v[68:71], v[28:35], v0
  buffer_store_dwordx2 v[20:21], v7, s[4:7], s21 offen offset:0
  s_nop 6
  v_cvt_pk_bf16_f32 v22, v40, v41
  v_cvt_pk_bf16_f32 v23, v42, v43
  v_bfi_b32 v22, 1, s57, v22
  buffer_store_dwordx2 v[22:23], v7, s[4:7], s21 offen offset:64
  ds_read_b128 v[68:71], v4 offset:0
  ds_read_b128 v[72:75], v4 offset:1024
  ds_read_b128 v[76:79], v4 offset:4096
  ds_read_b128 v[80:83], v4 offset:5120
  ds_read_b128 v[84:87], v4 offset:8192
  ds_read_b128 v[88:91], v4 offset:9216
  ds_read_b128 v[92:95], v4 offset:2048
  ds_read_b128 v[96:99], v4 offset:3072
  ds_read_b128 v[100:103], v4 offset:6144
  ds_read_b128 v[104:107], v4 offset:7168
  ds_read_b128 v[108:111], v4 offset:10240
  ds_read_b128 v[112:115], v4 offset:11264
  v_mov_b64 v[16:17], 0
  v_mov_b64 v[18:19], 0
  v_mov_b64 v[20:21], 0
  v_mov_b64 v[22:23], 0
  v_mov_b64 v[24:25], 0
  v_mov_b64 v[26:27], 0
  ds_read_b64 v[44:45], v2 offset:32256
  s_waitcnt lgkmcnt(0)
  v_readfirstlane_b32 s38, v44
  v_readfirstlane_b32 s37, v45
  s_nop 0
  s_add_u32 s37, s37, 30
  s_cmp_ge_u32 s38, 30
  s_cselect_b32 s38, s37, s38
  s_cmp_ge_u32 s38, 64
  s_cselect_b32 s38, 100, s38
  s_sub_u32 s38, s38, 1
  s_max_i32 s30, s30, s38
  s_waitcnt vmcnt(4)
  s_barrier
  ds_read_b128 v[28:31], v2 offset:19456
  ds_read_b128 v[32:35], v2 offset:23552
  ds_read_b128 v[36:39], v2 offset:8192
  ds_read_b128 v[40:43], v2 offset:9216
  ds_read_b128 v[44:47], v2 offset:10240
  ds_read_b128 v[48:51], v2 offset:11264
  buffer_load_dwordx4 v[124:127], v2, s[4:7], s24 offen offset:3072 sc1
  buffer_load_dwordx4 v[116:119], v2, s[4:7], s25 offen offset:3072 sc1
  ds_read_b128 v[52:55], v2 offset:12288
  ds_read_b128 v[56:59], v2 offset:13312
  ds_read_b128 v[60:63], v2 offset:14336
  ds_read_b128 v[64:67], v2 offset:15360
  buffer_load_dwordx4 v[124:127], v2, s[4:7], s24 offen offset:3072 sc1
  buffer_load_dwordx4 v[116:119], v2, s[4:7], s25 offen offset:3072 sc1
  s_mov_b32 s19, 0
  s_branch T_loop_120
T_kvw_124:
  s_mov_b32 s19, 0
  s_branch T_kvok_132
T_kv_131:
  s_sleep 4
  s_add_u32 s19, s19, 1
  s_cmp_gt_u32 s19, 32768
  s_cbranch_scc1 M_exit
T_kvok_132:
  s_add_u32 s39, s99, 128
  s_mov_b32 s38, 0
  s_mov_b32 s37, 0
  s_atomic_or s38, s[58:59], s99 glc
  s_atomic_or s37, s[58:59], s39 glc
  s_waitcnt lgkmcnt(0)
  s_add_u32 s37, s37, 30
  s_cmp_ge_u32 s38, 30
  s_cselect_b32 s38, s37, s38
  s_cmp_ge_u32 s38, 64
  s_cselect_b32 s38, 100, s38
  s_sub_u32 s38, s38, 1
  s_max_i32 s30, s30, s38
  s_cmp_ge_i32 s14, s30
  s_cbranch_scc1 T_kv_131
  s_branch T_kvb_125
T_slow_126:
  s_nop 7
  v_max3_f32 v100, v16, v17, v18
  v_max3_f32 v100, v100, v19, v20
  v_max3_f32 v100, v100, v21, v22
  v_max3_f32 v100, v100, v23, v112
  v_max3_f32 v100, v100, v113, v114
  v_max_f32 v100, v100, v115
  v_mov_b32 v101, v100
  s_nop 1
  v_permlane32_swap_b32 v100, v101
  s_nop 1
  v_max_f32 v100, v100, v101
  v_mov_b32 v101, v100
  s_nop 1
  v_permlane16_swap_b32 v100, v101
  s_nop 1
  v_max_f32 v100, v100, v101
  v_sub_f32 v16, v16, v100
  v_sub_f32 v17, v17, v100
  v_sub_f32 v18, v18, v100
  v_sub_f32 v19, v19, v100
  v_exp_f32 v16, v16
  v_exp_f32 v17, v17
  v_exp_f32 v18, v18
  v_exp_f32 v19, v19
  v_sub_f32 v20, v20, v100
  v_sub_f32 v21, v21, v100
  v_sub_f32 v22, v22, v100
  v_sub_f32 v23, v23, v100
  v_exp_f32 v20, v20
  v_exp_f32 v21, v21
  v_exp_f32 v22, v22
  v_exp_f32 v23, v23
  v_sub_f32 v112, v112, v100
  v_sub_f32 v113, v113, v100
  v_sub_f32 v114, v114, v100
  v_sub_f32 v115, v115, v100
  v_exp_f32 v112, v112
  v_exp_f32 v113, v113
  v_exp_f32 v114, v114
  v_exp_f32 v115, v115
  s_nop 0
  v_cvt_pk_bf16_f32 v44, v16, v17
  v_cvt_pk_bf16_f32 v45, v18, v19
  v_cvt_pk_bf16_f32 v46, v20, v21
  v_cvt_pk_bf16_f32 v47, v22, v23
  v_cvt_pk_bf16_f32 v84, v112, v113
  v_cvt_pk_bf16_f32 v85, v114, v115
  v_cndmask_b32 v48, v84, 0, s[16:17]
  v_cndmask_b32 v49, v85, 0, s[16:17]
  v_cndmask_b32 v50, 0, v84, s[16:17]
  v_cndmask_b32 v51, 0, v85, s[16:17]
  s_nop 1
  v_mfma_f32_16x16x16_bf16 v[88:91], v[12:13], v[48:49], 0
  v_mfma_f32_16x16x16_bf16 v[24:27], v[120:121], v[48:49], 0
  v_mfma_f32_16x16x16_bf16 v[116:119], v[120:121], v[50:51], 0
  v_mfma_f32_16x16x32_bf16 v[88:91], v[12:15], v[44:47], v[88:91]
  v_mfma_f32_16x16x32_bf16 v[24:27], v[28:31], v[44:47], v[24:27]
  v_mfma_f32_16x16x32_bf16 v[116:119], v[32:35], v[44:47], v[116:119]
  s_nop 7
  s_nop 1
  v_rcp_f32 v89, v88
  s_nop 0
  v_mul_f32 v24, v89, v24
  v_mul_f32 v25, v89, v25
  s_branch T_back_127
M_global:
  s_cmp_eq_u32 s13, 1
  s_cbranch_scc1 T_w_134
  s_cmp_eq_u32 s13, 2
  s_cbranch_scc1 T_w_135
  s_cmp_eq_u32 s13, 3
  s_cbranch_scc1 T_w_136
T_w_133:
  s_mov_b32 s19, 0
  v_mov_b64 v[16:17], 0
  v_mov_b64 v[18:19], 0
  v_mov_b64 v[20:21], 0
  v_mov_b64 v[22:23], 0
  v_mov_b64 v[24:25], 0
  v_mov_b64 v[26:27], 0
  buffer_load_dwordx4 v[124:127], v2, s[4:7], s24 offen offset:0 sc1
  buffer_load_dwordx4 v[116:119], v2, s[4:7], s25 offen offset:0 sc1
  buffer_load_dwordx4 v[124:127], v2, s[4:7], s24 offen offset:0 sc1
  buffer_load_dwordx4 v[116:119], v2, s[4:7], s25 offen offset:0 sc1
  s_branch T_loop_137
.p2align 6
T_retry_138:
  s_mov_b64 exec, vcc
  buffer_load_dwordx4 v[124:127], v2, s[4:7], s24 offen offset:0 sc1
  buffer_load_dwordx4 v[116:119], v2, s[4:7], s25 offen offset:0 sc1
  s_mov_b64 exec, -1
  s_add_u32 s19, s19, 1
  s_cmp_gt_u32 s19, 32768
  s_cbranch_scc1 M_exit
T_loop_137:
  s_waitcnt vmcnt(3) lgkmcnt(0)
  v_max3_u32 v123, v124, v125, v126
  v_max_u32 v123, v123, v127
  v_mov_b32_dpp v120, v124 row_ror:8 row_mask:0xf bank_mask:0xf
  v_mov_b32_dpp v121, v125 row_ror:8 row_mask:0xf bank_mask:0xf
  s_waitcnt vmcnt(2)
  v_max3_u32 v123, v123, v116, v117
  v_max3_u32 v123, v123, v118, v119
  v_cmp_eq_u32 vcc, -1, v123
  s_cbranch_vccnz T_retry_138
  v_smfmac_f32_16x16x64_bf16 v[16:19], v[124:127], v[68:75], v0
  s_add_u32 s14, s14, 1
  ds_write_b128 v2, v[124:127] offset:0
  v_mov_b32_dpp v122, v126 row_ror:8 row_mask:0xf bank_mask:0xf
  v_smfmac_f32_16x16x64_bf16 v[20:23], v[124:127], v[76:83], v0
  s_and_b32 s57, s14, 1
  v_mov_b32_dpp v123, v127 row_ror:8 row_mask:0xf bank_mask:0xf
  v_smfmac_f32_16x16x64_bf16 v[24:27], v[124:127], v[84:91], v0
  s_and_b32 s36, s14, 3
  ds_write_b128 v2, v[116:119] offset:4096
  v_smfmac_f32_16x16x64_bf16 v[16:19], v[120:123], v[92:99], v0
  s_lshl_b32 s36, s36, 13
  v_mov_b32_dpp v84, v116 row_ror:8 row_mask:0xf bank_mask:0xf
  v_smfmac_f32_16x16x64_bf16 v[20:23], v[120:123], v[100:107], v0
  s_add_u32 s26, s36, s23
  ds_read_b128 v[68:71], v4 offset:12288
  v_mov_b32_dpp v85, v117 row_ror:8 row_mask:0xf bank_mask:0xf
  v_smfmac_f32_16x16x64_bf16 v[24:27], v[120:123], v[108:115], v0
  s_add_u32 s36, s36, 8192
  ds_read_b128 v[72:75], v4 offset:13312
  v_mov_b32_dpp v86, v118 row_ror:8 row_mask:0xf bank_mask:0xf
  v_smfmac_f32_16x16x64_bf16 v[16:19], v[116:119], v[224:231], v0
  s_and_b32 s36, s36, 0x7fff
  ds_read_b128 v[76:79], v4 offset:14336
  v_mov_b32_dpp v87, v119 row_ror:8 row_mask:0xf bank_mask:0xf
  v_smfmac_f32_16x16x64_bf16 v[20:23], v[116:119], v[240:247], v0
  s_waitcnt lgkmcnt(3)
  s_barrier
  ds_read_b128 v[100:103], v2 offset:1024
  v_smfmac_f32_16x16x64_bf16 v[24:27], v[116:119], a[0:7], v0
  s_mov_b32 m0, s31
  ds_read_b128 v[120:123], v1 offset:1024
  v_smfmac_f32_16x16x64_bf16 v[16:19], v[84:87], v[232:239], v0
  s_cmp_ge_i32 s14, s30
  s_cbranch_scc1 T_kvw_141
T_kvb_142:
  v_smfmac_f32_16x16x64_bf16 v[20:23], v[84:87], v[248:255], v0
  ds_read_b128 v[80:83], v4 offset:15360
  buffer_load_dwordx4 v9, s[4:7], s27 offen sc1 lds
  v_smfmac_f32_16x16x64_bf16 v[24:27], v[84:87], a[8:15], v0
  s_waitcnt lgkmcnt(2)
  s_mov_b32 m0, s32
  v_smfmac_f32_16x16x64_bf16 v[16:19], v[100:103], v[128:135], v0
  ds_read_b128 v[92:95], v2 offset:2048
  v_smfmac_f32_16x16x64_bf16 v[20:23], v[100:103], v[144:151], v0
  ds_read_b128 v[96:99], v1 offset:2048
  v_smfmac_f32_16x16x64_bf16 v[24:27], v[100:103], v[68:75], v0
  s_waitcnt vmcnt(1) lgkmcnt(3)
  ds_read_b128 v[116:119], v2 offset:3072
  buffer_load_dwordx4 v9, s[4:7], s27 offen offset:128 sc1 lds
  v_smfmac_f32_16x16x64_bf16 v[16:19], v[120:123], v[136:143], v0
  ds_read_b128 v[124:127], v1 offset:3072
  s_mov_b32 m0, s33
  v_smfmac_f32_16x16x64_bf16 v[20:23], v[120:123], v[152:159], v0
  s_waitcnt lgkmcnt(4)
  ds_read_b128 v[104:107], v2 offset:5120
  v_smfmac_f32_16x16x64_bf16 v[24:27], v[120:123], v[76:83], v0
  s_waitcnt lgkmcnt(4)
  ds_read_b128 v[108:111], v1 offset:5120
  v_smfmac_f32_16x16x64_bf16 v[16:19], v[92:95], v[160:167], v0
  s_waitcnt lgkmcnt(4)
  ds_read_b128 v[112:115], v2 offset:6144
  buffer_load_dwordx4 v10, s[4:7], s28 offen sc1 lds
  v_smfmac_f32_16x16x64_bf16 v[16:19], v[96:99], v[168:175], v0
  s_waitcnt lgkmcnt(4)
  ds_read_b128 v[84:87], v1 offset:6144
  s_mov_b32 m0, s34
  v_smfmac_f32_16x16x64_bf16 v[16:19], v[116:119], v[192:199], v0
  s_waitcnt lgkmcnt(4)
  ds_read_b128 v[88:91], v2 offset:7168
  v_smfmac_f32_16x16x64_bf16 v[16:19], v[124:127], v[200:207], v0
  s_waitcnt lgkmcnt(4)
  ds_read_b128 v[100:103], v1 offset:7168
  v_smfmac_f32_16x16x64_bf16 v[16:19], v[104:107], a[16:23], v0
  s_waitcnt lgkmcnt(4)
  ds_read_b128 v[68:71], v4 offset:16384
  buffer_load_dwordx4 v10, s[4:7], s28 offen offset:256 sc1 lds
  v_smfmac_f32_16x16x64_bf16 v[16:19], v[108:111], a[24:31], v0
  s_waitcnt lgkmcnt(4)
  ds_read_b128 v[72:75], v4 offset:17408
  v_smfmac_f32_16x16x64_bf16 v[16:19], v[112:115], a[64:71], v0
  s_waitcnt lgkmcnt(4)
  ds_read_b128 v[76:79], v4 offset:18432
  v_smfmac_f32_16x16x64_bf16 v[16:19], v[84:87], a[72:79], v0
  s_waitcnt lgkmcnt(4)
  ds_read_b128 v[80:83], v4 offset:19456
  v_smfmac_f32_16x16x64_bf16 v[16:19], v[88:91], a[112:119], v0
  s_waitcnt lgkmcnt(4)
  v_smfmac_f32_16x16x64_bf16 v[16:19], v[100:103], a[120:127], v0
  s_add_u32 s24, s36, 145752064
  s_add_u32 s25, s36, 145756160
  v_smfmac_f32_16x16x64_bf16 v[20:23], v[92:95], v[176:183], v0
  s_add_u32 s35, s36, s23
  v_smfmac_f32_16x16x64_bf16 v[20:23], v[96:99], v[184:191], v0
  s_waitcnt lgkmcnt(2)
  v_smfmac_f32_16x16x64_bf16 v[20:23], v[116:119], v[68:75], v0
  s_waitcnt lgkmcnt(0)
  ds_read_b128 v[68:71], v4 offset:20480
  v_mul_f32 v16, s18, v16
  v_smfmac_f32_16x16x64_bf16 v[20:23], v[124:127], v[76:83], v0
  ds_read_b128 v[72:75], v4 offset:21504
  v_mul_f32 v17, s18, v17
  v_smfmac_f32_16x16x64_bf16 v[20:23], v[104:107], a[32:39], v0
  ds_read_b128 v[76:79], v4 offset:22528
  v_mul_f32 v18, s18, v18
  v_smfmac_f32_16x16x64_bf16 v[20:23], v[108:111], a[40:47], v0
  ds_read_b128 v[80:83], v4 offset:23552
  v_mul_f32 v19, s18, v19
  v_smfmac_f32_16x16x64_bf16 v[20:23], v[112:115], a[80:87], v0
  v_cvt_pk_bf16_f32 v120, v16, v17
  v_smfmac_f32_16x16x64_bf16 v[20:23], v[84:87], a[88:95], v0
  v_cvt_pk_bf16_f32 v121, v18, v19
  v_smfmac_f32_16x16x64_bf16 v[20:23], v[88:91], a[128:135], v0
  ds_write_b64 v5, v[120:121] offset:24576
  v_smfmac_f32_16x16x64_bf16 v[20:23], v[100:103], a[136:143], v0
  s_waitcnt lgkmcnt(3)
  v_smfmac_f32_16x16x64_bf16 v[24:27], v[92:95], v[68:75], v0
  s_waitcnt lgkmcnt(1)
  v_mov_b64 v[92:93], 0
  v_smfmac_f32_16x16x64_bf16 v[24:27], v[96:99], v[76:83], v0
  s_nop 1
  v_cvt_pk_bf16_f32 v122, v20, v21
  v_cvt_pk_bf16_f32 v123, v22, v23
  v_smfmac_f32_16x16x64_bf16 v[24:27], v[116:119], v[208:215], v0
  ds_write_b64 v5, v[122:123] offset:26880
  v_mov_b64 v[94:95], 0
  v_smfmac_f32_16x16x64_bf16 v[24:27], v[124:127], v[216:223], v0
  s_waitcnt lgkmcnt(1)
  s_barrier
  ds_read_b64_tr_b16 v[68:69], v6 offset:24576
  v_smfmac_f32_16x16x64_bf16 v[24:27], v[104:107], a[48:55], v0
  s_add_u32 s27, s27, 8192
  ds_read_b64_tr_b16 v[70:71], v6 offset:24640
  ds_read_b64_tr_b16 v[72:73], v6 offset:24832
  v_smfmac_f32_16x16x64_bf16 v[24:27], v[108:111], a[56:63], v0
  s_add_u32 s28, s28, 8192
  ds_read_b64_tr_b16 v[74:75], v6 offset:24896
  ds_read_b64_tr_b16 v[76:77], v6 offset:25088
  v_smfmac_f32_16x16x64_bf16 v[24:27], v[112:115], a[96:103], v0
  s_nop 0
  ds_read_b64_tr_b16 v[78:79], v6 offset:25152
  ds_read_b64_tr_b16 v[80:81], v6 offset:25344
  v_smfmac_f32_16x16x64_bf16 v[24:27], v[84:87], a[104:111], v0
  ds_read_b64_tr_b16 v[82:83], v6 offset:25408
  v_mov_b64 v[96:97], 0
  v_smfmac_f32_16x16x64_bf16 v[24:27], v[88:91], a[144:151], v0
  s_waitcnt lgkmcnt(8)
  s_barrier
  ds_read_b64_tr_b16 v[116:117], v6 offset:26880
  v_smfmac_f32_16x16x64_bf16 v[24:27], v[100:103], a[152:159], v0
  s_waitcnt lgkmcnt(7)
  ds_read_b64_tr_b16 v[118:119], v6 offset:26944
  buffer_store_dwordx2 v[122:123], v5, s[4:7], s29 offen sc1
  v_mfma_f32_16x16x32_bf16 v[16:19], v[36:39], v[68:71], 0
  s_waitcnt lgkmcnt(6)
  ds_read_b64_tr_b16 v[124:125], v6 offset:27136
  ds_read_b64_tr_b16 v[126:127], v6 offset:27200
  v_mfma_f32_16x16x32_bf16 v[16:19], v[40:43], v[72:75], v[16:19]
  s_waitcnt lgkmcnt(6)
  ds_read_b64_tr_b16 v[104:105], v6 offset:27392
  ds_read_b64_tr_b16 v[106:107], v6 offset:27456
  v_mfma_f32_16x16x32_bf16 v[16:19], v[44:47], v[76:79], v[16:19]
  s_waitcnt lgkmcnt(6)
  ds_read_b64_tr_b16 v[108:109], v6 offset:27648
  ds_read_b64_tr_b16 v[110:111], v6 offset:27712
  v_mfma_f32_16x16x32_bf16 v[16:19], v[48:51], v[80:83], v[16:19]
  s_waitcnt lgkmcnt(6)
  v_cvt_pk_bf16_f32 v120, v24, v25
  v_cvt_pk_bf16_f32 v121, v26, v27
  v_mfma_f32_16x16x32_bf16 v[112:115], v[116:119], v[68:71], 0
  s_waitcnt lgkmcnt(4)
  buffer_store_dwordx2 v[120:121], v5, s[4:7], s29 offen offset:2304 sc1
  v_mov_b64 v[98:99], 0
  v_mfma_f32_16x16x32_bf16 v[112:115], v[124:127], v[72:75], v[112:115]
  s_waitcnt lgkmcnt(2)
  v_mov_b64 v[36:37], 0
  v_exp_f32 v100, v16
  v_mfma_f32_16x16x32_bf16 v[112:115], v[104:107], v[76:79], v[112:115]
  s_waitcnt lgkmcnt(0)
  v_exp_f32 v101, v17
  v_mfma_f32_16x16x32_bf16 v[112:115], v[108:111], v[80:83], v[112:115]
  s_add_u32 s29, s29, 147456
  v_exp_f32 v102, v18
  v_mfma_f32_16x16x32_bf16 v[20:23], v[52:55], v[68:71], 0
  s_cmp_eq_u32 s14, 63
  v_exp_f32 v103, v19
  v_mfma_f32_16x16x32_bf16 v[20:23], v[56:59], v[72:75], v[20:23]
  s_cbranch_scc1 M_tdone
  v_cvt_pk_bf16_f32 v44, v100, v101
  v_cvt_pk_bf16_f32 v45, v102, v103
  v_mfma_f32_16x16x32_bf16 v[20:23], v[60:63], v[76:79], v[20:23]
  v_exp_f32 v100, v112
  v_mfma_f32_16x16x32_bf16 v[20:23], v[64:67], v[80:83], v[20:23]
  v_exp_f32 v101, v113
  v_exp_f32 v102, v114
  v_exp_f32 v103, v115
  v_cvt_pk_bf16_f32 v84, v100, v101
  v_cvt_pk_bf16_f32 v85, v102, v103
  v_cndmask_b32 v48, v84, 0, s[16:17]
  v_cndmask_b32 v49, v85, 0, s[16:17]
  v_cndmask_b32 v50, 0, v84, s[16:17]
  v_cndmask_b32 v51, 0, v85, s[16:17]
  v_exp_f32 v100, v20
  v_mfma_f32_16x16x16_bf16 v[88:91], v[12:13], v[48:49], 0
  v_exp_f32 v101, v21
  v_mfma_f32_16x16x16_bf16 v[24:27], v[120:121], v[48:49], 0
  v_exp_f32 v102, v22
  v_mfma_f32_16x16x16_bf16 v[116:119], v[120:121], v[50:51], 0
  v_exp_f32 v103, v23
  v_cvt_pk_bf16_f32 v46, v100, v101
  v_cvt_pk_bf16_f32 v47, v102, v103
  v_mov_b64 v[38:39], 0
  s_nop 0
  v_mfma_f32_16x16x32_bf16 v[88:91], v[12:15], v[44:47], v[88:91]
  v_mov_b64 v[40:41], 0
  v_mov_b64 v[42:43], 0
  v_mfma_f32_16x16x32_bf16 v[24:27], v[28:31], v[44:47], v[24:27]
  ds_read_b128 v[52:55], v4 offset:24576
  ds_read_b128 v[56:59], v4 offset:25600
  v_mfma_f32_16x16x32_bf16 v[116:119], v[32:35], v[44:47], v[116:119]
  s_nop 1
  v_rcp_f32 v89, v88
  v_subrev_u32 v100, s54, v88
  v_cmp_le_u32 vcc, s55, v100
  v_mul_f32 v24, v89, v24
  v_mul_f32 v25, v89, v25
  s_cbranch_vccnz T_slow_143
T_back_144:
  v_cvt_pk_bf16_f32 v124, v24, v25
  v_pk_mul_f32 v[26:27], v[26:27], v[88:89] op_sel:[0,1] op_sel_hi:[1,1]
  v_pk_mul_f32 v[116:117], v[116:117], v[88:89] op_sel:[0,1] op_sel_hi:[1,1]
  v_pk_mul_f32 v[118:119], v[118:119], v[88:89] op_sel:[0,1] op_sel_hi:[1,1]
  v_cvt_pk_bf16_f32 v125, v26, v27
  v_cvt_pk_bf16_f32 v126, v116, v117
  v_cvt_pk_bf16_f32 v127, v118, v119
  ds_write_b128 v11, v[124:127] offset:29184
  s_nop 0
  v_smfmac_f32_16x16x64_bf16 v[92:95], v[124:127], a[160:167], v0
  v_smfmac_f32_16x16x64_bf16 v[96:99], v[124:127], a[168:175], v0
  v_smfmac_f32_16x16x64_bf16 v[36:39], v[124:127], a[176:183], v0
  v_smfmac_f32_16x16x64_bf16 v[40:43], v[124:127], a[184:191], v0
  s_waitcnt lgkmcnt(0)
  s_barrier
  ds_read_b128 v[104:107], v11 offset:29696
  ds_read_b128 v[108:111], v11 offset:30208
  ds_read_b128 v[68:71], v11 offset:30720
  s_waitcnt lgkmcnt(2)
  v_smfmac_f32_16x16x64_bf16 v[92:95], v[104:107], a[192:199], v0
  s_waitcnt lgkmcnt(1)
  ds_read_b128 v[76:79], v4 offset:28672
  v_smfmac_f32_16x16x64_bf16 v[92:95], v[108:111], a[224:231], v0
  s_waitcnt lgkmcnt(1)
  ds_read_b128 v[80:83], v4 offset:29696
  v_smfmac_f32_16x16x64_bf16 v[92:95], v[68:71], a[240:247], v0
  ds_read_b128 v[60:63], v4 offset:26624
  v_smfmac_f32_16x16x64_bf16 v[96:99], v[104:107], a[200:207], v0
  ds_read_b128 v[64:67], v4 offset:27648
  v_smfmac_f32_16x16x64_bf16 v[96:99], v[108:111], a[232:239], v0
  ds_read_b128 v[28:31], v4 offset:30720
  s_nop 0
  v_cvt_pk_bf16_f32 v16, v92, v93
  v_cvt_pk_bf16_f32 v17, v94, v95
  v_bfi_b32 v16, 1, s57, v16
  v_smfmac_f32_16x16x64_bf16 v[96:99], v[68:71], a[248:255], v0
  buffer_store_dwordx2 v[16:17], v7, s[4:7], s20 offen offset:0 sc1
  v_smfmac_f32_16x16x64_bf16 v[36:39], v[104:107], a[208:215], v0
  ds_read_b128 v[32:35], v4 offset:31744
  v_smfmac_f32_16x16x64_bf16 v[36:39], v[108:111], v[52:59], v0
  s_waitcnt lgkmcnt(4)
  s_nop 0
  v_cvt_pk_bf16_f32 v18, v96, v97
  v_cvt_pk_bf16_f32 v19, v98, v99
  v_bfi_b32 v18, 1, s57, v18
  v_smfmac_f32_16x16x64_bf16 v[36:39], v[68:71], v[76:83], v0
  buffer_store_dwordx2 v[18:19], v7, s[4:7], s20 offen offset:64 sc1
  v_smfmac_f32_16x16x64_bf16 v[40:43], v[104:107], a[216:223], v0
  s_waitcnt lgkmcnt(2)
  ds_read_b128 v[116:119], v2 offset:31232
  v_smfmac_f32_16x16x64_bf16 v[40:43], v[108:111], v[60:67], v0
  s_waitcnt lgkmcnt(1)
  s_nop 0
  v_cvt_pk_bf16_f32 v20, v36, v37
  v_cvt_pk_bf16_f32 v21, v38, v39
  v_bfi_b32 v20, 1, s57, v20
  v_smfmac_f32_16x16x64_bf16 v[40:43], v[68:71], v[28:35], v0
  buffer_store_dwordx2 v[20:21], v7, s[4:7], s21 offen offset:0 sc1
  s_nop 6
  v_cvt_pk_bf16_f32 v22, v40, v41
  v_cvt_pk_bf16_f32 v23, v42, v43
  v_bfi_b32 v22, 1, s57, v22
  buffer_store_dwordx2 v[22:23], v7, s[4:7], s21 offen offset:64 sc1
  ds_read_b128 v[68:71], v4 offset:0
  ds_read_b128 v[72:75], v4 offset:1024
  ds_read_b128 v[76:79], v4 offset:4096
  ds_read_b128 v[80:83], v4 offset:5120
  ds_read_b128 v[84:87], v4 offset:8192
  ds_read_b128 v[88:91], v4 offset:9216
  ds_read_b128 v[92:95], v4 offset:2048
  ds_read_b128 v[96:99], v4 offset:3072
  ds_read_b128 v[100:103], v4 offset:6144
  ds_read_b128 v[104:107], v4 offset:7168
  ds_read_b128 v[108:111], v4 offset:10240
  ds_read_b128 v[112:115], v4 offset:11264
  v_mov_b64 v[16:17], 0
  v_mov_b64 v[18:19], 0
  v_mov_b64 v[20:21], 0
  v_mov_b64 v[22:23], 0
  v_mov_b64 v[24:25], 0
  v_mov_b64 v[26:27], 0
  s_mov_b32 s19, 0
  v_mov_b32 v49, -1
  ds_read_b64 v[44:45], v2 offset:32256
  s_waitcnt lgkmcnt(0)
  v_readfirstlane_b32 s38, v44
  v_readfirstlane_b32 s37, v45
  s_nop 0
  s_add_u32 s37, s37, 30
  s_cmp_ge_u32 s38, 30
  s_cselect_b32 s38, s37, s38
  s_cmp_ge_u32 s38, 64
  s_cselect_b32 s38, 100, s38
  s_sub_u32 s38, s38, 1
  s_max_i32 s30, s30, s38
  s_waitcnt vmcnt(1)
  buffer_load_dwordx4 v[52:55], v2, s[4:7], s22 offen offset:0 sc1
  buffer_load_dwordx4 v[56:59], v2, s[4:7], s22 offen offset:1024 sc1
  buffer_load_dwordx4 v[60:63], v2, s[4:7], s22 offen offset:2048 sc1
  buffer_load_dwordx4 v[64:67], v2, s[4:7], s22 offen offset:3072 sc1
  s_waitcnt lgkmcnt(12)
  s_waitcnt vmcnt(3)
  v_mfma_f32_16x16x32_bf16 v[120:123], v[116:119], v[52:55], 0
  v_xor_b32 v48, s57, v52
  v_bitop3_b32 v48, v48, v54, s57 bitop3:0xf6
  s_waitcnt vmcnt(2)
  v_mfma_f32_16x16x32_bf16 v[120:123], v[116:119], v[56:59], v[120:123]
  v_bitop3_b32 v48, v48, v56, s57 bitop3:0xf6
  v_bitop3_b32 v48, v48, v58, s57 bitop3:0xf6
  s_waitcnt vmcnt(1)
  v_mfma_f32_16x16x32_bf16 v[120:123], v[116:119], v[60:63], v[120:123]
  v_bitop3_b32 v48, v48, v60, s57 bitop3:0xf6
  v_bitop3_b32 v48, v48, v62, s57 bitop3:0xf6
  s_waitcnt vmcnt(0)
  v_mfma_f32_16x16x32_bf16 v[120:123], v[116:119], v[64:67], v[120:123]
  v_bitop3_b32 v48, v48, v64, s57 bitop3:0xf6
  v_bitop3_b32 v48, v48, v66, s57 bitop3:0xf6
  v_and_b32 v48, 1, v48
  v_cmp_ne_u32 vcc, 0, v48
  s_cbranch_vccnz T_p1re_146
T_p1ok_147:
  s_nop 2
  v_add_f32_dpp v120, v120, v120 row_ror:8 row_mask:0xf bank_mask:0xf
  v_add_f32_dpp v121, v121, v121 row_ror:8 row_mask:0xf bank_mask:0xf
  v_cvt_pk_bf16_f32 v48, v120, v121
  v_min_u32 v48, -2, v48
  buffer_store_dword v48, v8, s[4:7], s35 offen sc1
  buffer_store_dword v49, v8, s[4:7], s26 offen sc1
  s_barrier
  ds_read_b128 v[28:31], v2 offset:16384
  ds_read_b128 v[32:35], v2 offset:20480
  ds_read_b128 v[36:39], v2 offset:8192
  ds_read_b128 v[40:43], v2 offset:9216
  ds_read_b128 v[44:47], v2 offset:10240
  ds_read_b128 v[48:51], v2 offset:11264
  buffer_load_dwordx4 v[124:127], v2, s[4:7], s24 offen offset:0 sc1
  buffer_load_dwordx4 v[116:119], v2, s[4:7], s25 offen offset:0 sc1
  ds_read_b128 v[52:55], v2 offset:12288
  ds_read_b128 v[56:59], v2 offset:13312
  ds_read_b128 v[60:63], v2 offset:14336
  ds_read_b128 v[64:67], v2 offset:15360
  buffer_load_dwordx4 v[124:127], v2, s[4:7], s24 offen offset:0 sc1
  buffer_load_dwordx4 v[116:119], v2, s[4:7], s25 offen offset:0 sc1
  s_mov_b32 s19, 0
  s_branch T_loop_137
T_p1re_146:
  s_mov_b64 exec, vcc
  buffer_load_dwordx4 v[52:55], v2, s[4:7], s22 offen offset:0 sc1
  buffer_load_dwordx4 v[56:59], v2, s[4:7], s22 offen offset:1024 sc1
  buffer_load_dwordx4 v[60:63], v2, s[4:7], s22 offen offset:2048 sc1
  buffer_load_dwordx4 v[64:67], v2, s[4:7], s22 offen offset:3072 sc1
  s_mov_b64 exec, -1
  s_add_u32 s19, s19, 1
  s_cmp_gt_u32 s19, 32768
  s_cbranch_scc1 M_exit
  s_waitcnt vmcnt(3)
  v_mfma_f32_16x16x32_bf16 v[120:123], v[116:119], v[52:55], 0
  v_xor_b32 v48, s57, v52
  v_bitop3_b32 v48, v48, v54, s57 bitop3:0xf6
  s_waitcnt vmcnt(2)
  v_mfma_f32_16x16x32_bf16 v[120:123], v[116:119], v[56:59], v[120:123]
  v_bitop3_b32 v48, v48, v56, s57 bitop3:0xf6
  v_bitop3_b32 v48, v48, v58, s57 bitop3:0xf6
  s_waitcnt vmcnt(1)
  v_mfma_f32_16x16x32_bf16 v[120:123], v[116:119], v[60:63], v[120:123]
  v_bitop3_b32 v48, v48, v60, s57 bitop3:0xf6
  v_bitop3_b32 v48, v48, v62, s57 bitop3:0xf6
  s_waitcnt vmcnt(0)
  v_mfma_f32_16x16x32_bf16 v[120:123], v[116:119], v[64:67], v[120:123]
  v_bitop3_b32 v48, v48, v64, s57 bitop3:0xf6
  v_bitop3_b32 v48, v48, v66, s57 bitop3:0xf6
  v_and_b32 v48, 1, v48
  v_cmp_ne_u32 vcc, 0, v48
  s_cbranch_vccnz T_p1re_146
  s_branch T_p1ok_147
T_kvw_141:
  s_mov_b32 s19, 0
  s_branch T_kvok_149
T_kv_148:
  s_sleep 4
  s_add_u32 s19, s19, 1
  s_cmp_gt_u32 s19, 32768
  s_cbranch_scc1 M_exit
T_kvok_149:
  s_add_u32 s39, s99, 128
  s_mov_b32 s38, 0
  s_mov_b32 s37, 0
  s_atomic_or s38, s[58:59], s99 glc
  s_atomic_or s37, s[58:59], s39 glc
  s_waitcnt lgkmcnt(0)
  s_add_u32 s37, s37, 30
  s_cmp_ge_u32 s38, 30
  s_cselect_b32 s38, s37, s38
  s_cmp_ge_u32 s38, 64
  s_cselect_b32 s38, 100, s38
  s_sub_u32 s38, s38, 1
  s_max_i32 s30, s30, s38
  s_cmp_ge_i32 s14, s30
  s_cbranch_scc1 T_kv_148
  s_branch T_kvb_142
T_slow_143:
  s_nop 7
  v_max3_f32 v100, v16, v17, v18
  v_max3_f32 v100, v100, v19, v20
  v_max3_f32 v100, v100, v21, v22
  v_max3_f32 v100, v100, v23, v112
  v_max3_f32 v100, v100, v113, v114
  v_max_f32 v100, v100, v115
  v_mov_b32 v101, v100
  s_nop 1
  v_permlane32_swap_b32 v100, v101
  s_nop 1
  v_max_f32 v100, v100, v101
  v_mov_b32 v101, v100
  s_nop 1
  v_permlane16_swap_b32 v100, v101
  s_nop 1
  v_max_f32 v100, v100, v101
  v_sub_f32 v16, v16, v100
  v_sub_f32 v17, v17, v100
  v_sub_f32 v18, v18, v100
  v_sub_f32 v19, v19, v100
  v_exp_f32 v16, v16
  v_exp_f32 v17, v17
  v_exp_f32 v18, v18
  v_exp_f32 v19, v19
  v_sub_f32 v20, v20, v100
  v_sub_f32 v21, v21, v100
  v_sub_f32 v22, v22, v100
  v_sub_f32 v23, v23, v100
  v_exp_f32 v20, v20
  v_exp_f32 v21, v21
  v_exp_f32 v22, v22
  v_exp_f32 v23, v23
  v_sub_f32 v112, v112, v100
  v_sub_f32 v113, v113, v100
  v_sub_f32 v114, v114, v100
  v_sub_f32 v115, v115, v100
  v_exp_f32 v112, v112
  v_exp_f32 v113, v113
  v_exp_f32 v114, v114
  v_exp_f32 v115, v115
  s_nop 0
  v_cvt_pk_bf16_f32 v44, v16, v17
  v_cvt_pk_bf16_f32 v45, v18, v19
  v_cvt_pk_bf16_f32 v46, v20, v21
  v_cvt_pk_bf16_f32 v47, v22, v23
  v_cvt_pk_bf16_f32 v84, v112, v113
  v_cvt_pk_bf16_f32 v85, v114, v115
  v_cndmask_b32 v48, v84, 0, s[16:17]
  v_cndmask_b32 v49, v85, 0, s[16:17]
  v_cndmask_b32 v50, 0, v84, s[16:17]
  v_cndmask_b32 v51, 0, v85, s[16:17]
  s_nop 1
  v_mfma_f32_16x16x16_bf16 v[88:91], v[12:13], v[48:49], 0
  v_mfma_f32_16x16x16_bf16 v[24:27], v[120:121], v[48:49], 0
  v_mfma_f32_16x16x16_bf16 v[116:119], v[120:121], v[50:51], 0
  v_mfma_f32_16x16x32_bf16 v[88:91], v[12:15], v[44:47], v[88:91]
  v_mfma_f32_16x16x32_bf16 v[24:27], v[28:31], v[44:47], v[24:27]
  v_mfma_f32_16x16x32_bf16 v[116:119], v[32:35], v[44:47], v[116:119]
  s_nop 7
  s_nop 1
  v_rcp_f32 v89, v88
  s_nop 0
  v_mul_f32 v24, v89, v24
  v_mul_f32 v25, v89, v25
  s_branch T_back_144
T_w_134:
  s_mov_b32 s19, 0
  v_mov_b64 v[16:17], 0
  v_mov_b64 v[18:19], 0
  v_mov_b64 v[20:21], 0
  v_mov_b64 v[22:23], 0
  v_mov_b64 v[24:25], 0
  v_mov_b64 v[26:27], 0
  buffer_load_dwordx4 v[124:127], v2, s[4:7], s24 offen offset:1024 sc1
  buffer_load_dwordx4 v[116:119], v2, s[4:7], s25 offen offset:1024 sc1
  buffer_load_dwordx4 v[124:127], v2, s[4:7], s24 offen offset:1024 sc1
  buffer_load_dwordx4 v[116:119], v2, s[4:7], s25 offen offset:1024 sc1
  s_branch T_loop_150
.p2align 6
T_retry_151:
  s_mov_b64 exec, vcc
  buffer_load_dwordx4 v[124:127], v2, s[4:7], s24 offen offset:1024 sc1
  buffer_load_dwordx4 v[116:119], v2, s[4:7], s25 offen offset:1024 sc1
  s_mov_b64 exec, -1
  s_add_u32 s19, s19, 1
  s_cmp_gt_u32 s19, 32768
  s_cbranch_scc1 M_exit
T_loop_150:
  s_waitcnt vmcnt(3) lgkmcnt(0)
  v_max3_u32 v123, v124, v125, v126
  v_max_u32 v123, v123, v127
  v_mov_b32_dpp v120, v124 row_ror:8 row_mask:0xf bank_mask:0xf
  v_mov_b32_dpp v121, v125 row_ror:8 row_mask:0xf bank_mask:0xf
  s_waitcnt vmcnt(2)
  v_max3_u32 v123, v123, v116, v117
  v_max3_u32 v123, v123, v118, v119
  v_cmp_eq_u32 vcc, -1, v123
  s_cbranch_vccnz T_retry_151
  v_smfmac_f32_16x16x64_bf16 v[16:19], v[124:127], v[68:75], v0
  s_add_u32 s14, s14, 1
  ds_write_b128 v2, v[124:127] offset:1024
  v_mov_b32_dpp v122, v126 row_ror:8 row_mask:0xf bank_mask:0xf
  v_smfmac_f32_16x16x64_bf16 v[20:23], v[124:127], v[76:83], v0
  s_and_b32 s57, s14, 1
  v_mov_b32_dpp v123, v127 row_ror:8 row_mask:0xf bank_mask:0xf
  v_smfmac_f32_16x16x64_bf16 v[24:27], v[124:127], v[84:91], v0
  s_and_b32 s36, s14, 3
  ds_write_b128 v2, v[116:119] offset:5120
  v_smfmac_f32_16x16x64_bf16 v[16:19], v[120:123], v[92:99], v0
  s_lshl_b32 s36, s36, 13
  v_mov_b32_dpp v84, v116 row_ror:8 row_mask:0xf bank_mask:0xf
  v_smfmac_f32_16x16x64_bf16 v[20:23], v[120:123], v[100:107], v0
  s_add_u32 s26, s36, s23
  ds_read_b128 v[68:71], v4 offset:12288
  v_mov_b32_dpp v85, v117 row_ror:8 row_mask:0xf bank_mask:0xf
  v_smfmac_f32_16x16x64_bf16 v[24:27], v[120:123], v[108:115], v0
  s_add_u32 s36, s36, 8192
  ds_read_b128 v[72:75], v4 offset:13312
  v_mov_b32_dpp v86, v118 row_ror:8 row_mask:0xf bank_mask:0xf
  v_smfmac_f32_16x16x64_bf16 v[16:19], v[116:119], v[224:231], v0
  s_and_b32 s36, s36, 0x7fff
  ds_read_b128 v[76:79], v4 offset:14336
  v_mov_b32_dpp v87, v119 row_ror:8 row_mask:0xf bank_mask:0xf
  v_smfmac_f32_16x16x64_bf16 v[20:23], v[116:119], v[240:247], v0
  s_waitcnt lgkmcnt(3)
  s_barrier
  ds_read_b128 v[100:103], v2 offset:0
  v_smfmac_f32_16x16x64_bf16 v[24:27], v[116:119], a[0:7], v0
  s_mov_b32 m0, s31
  ds_read_b128 v[120:123], v1 offset:0
  v_smfmac_f32_16x16x64_bf16 v[16:19], v[84:87], v[232:239], v0
  s_cmp_ge_i32 s14, s30
  s_cbranch_scc1 T_kvw_154
T_kvb_155:
  v_smfmac_f32_16x16x64_bf16 v[20:23], v[84:87], v[248:255], v0
  ds_read_b128 v[80:83], v4 offset:15360
  v_smfmac_f32_16x16x64_bf16 v[24:27], v[84:87], a[8:15], v0
  s_waitcnt lgkmcnt(2)
  buffer_load_dwordx4 v9, s[4:7], s27 offen sc1 lds
  v_smfmac_f32_16x16x64_bf16 v[16:19], v[100:103], v[128:135], v0
  ds_read_b128 v[92:95], v2 offset:3072
  s_mov_b32 m0, s32
  v_smfmac_f32_16x16x64_bf16 v[20:23], v[100:103], v[144:151], v0
  ds_read_b128 v[96:99], v1 offset:3072
  v_smfmac_f32_16x16x64_bf16 v[24:27], v[100:103], v[68:75], v0
  s_waitcnt vmcnt(1) lgkmcnt(3)
  ds_read_b128 v[116:119], v2 offset:2048
  v_smfmac_f32_16x16x64_bf16 v[16:19], v[120:123], v[136:143], v0
  ds_read_b128 v[124:127], v1 offset:2048
  buffer_load_dwordx4 v9, s[4:7], s27 offen offset:128 sc1 lds
  v_smfmac_f32_16x16x64_bf16 v[20:23], v[120:123], v[152:159], v0
  s_waitcnt lgkmcnt(4)
  ds_read_b128 v[104:107], v2 offset:4096
  s_mov_b32 m0, s33
  v_smfmac_f32_16x16x64_bf16 v[24:27], v[120:123], v[76:83], v0
  s_waitcnt lgkmcnt(4)
  ds_read_b128 v[108:111], v1 offset:4096
  v_smfmac_f32_16x16x64_bf16 v[16:19], v[92:95], v[160:167], v0
  s_waitcnt lgkmcnt(4)
  ds_read_b128 v[112:115], v2 offset:7168
  v_smfmac_f32_16x16x64_bf16 v[16:19], v[96:99], v[168:175], v0
  s_waitcnt lgkmcnt(4)
  ds_read_b128 v[84:87], v1 offset:7168
  buffer_load_dwordx4 v10, s[4:7], s28 offen sc1 lds
  v_smfmac_f32_16x16x64_bf16 v[16:19], v[116:119], v[192:199], v0
  s_waitcnt lgkmcnt(4)
  ds_read_b128 v[88:91], v2 offset:6144
  s_mov_b32 m0, s34
  v_smfmac_f32_16x16x64_bf16 v[16:19], v[124:127], v[200:207], v0
  s_waitcnt lgkmcnt(4)
  ds_read_b128 v[100:103], v1 offset:6144
  v_smfmac_f32_16x16x64_bf16 v[16:19], v[104:107], a[16:23], v0
  s_waitcnt lgkmcnt(4)
  ds_read_b128 v[68:71], v4 offset:16384
  v_smfmac_f32_16x16x64_bf16 v[16:19], v[108:111], a[24:31], v0
  s_waitcnt lgkmcnt(4)
  ds_read_b128 v[72:75], v4 offset:17408
  buffer_load_dwordx4 v10, s[4:7], s28 offen offset:256 sc1 lds
  v_smfmac_f32_16x16x64_bf16 v[16:19], v[112:115], a[64:71], v0
  s_waitcnt lgkmcnt(4)
  ds_read_b128 v[76:79], v4 offset:18432
  v_smfmac_f32_16x16x64_bf16 v[16:19], v[84:87], a[72:79], v0
  s_waitcnt lgkmcnt(4)
  ds_read_b128 v[80:83], v4 offset:19456
  v_smfmac_f32_16x16x64_bf16 v[16:19], v[88:91], a[112:119], v0
  s_waitcnt lgkmcnt(4)
  v_smfmac_f32_16x16x64_bf16 v[16:19], v[100:103], a[120:127], v0
  s_add_u32 s24, s36, 145752064
  s_add_u32 s25, s36, 145756160
  v_smfmac_f32_16x16x64_bf16 v[20:23], v[92:95], v[176:183], v0
  s_add_u32 s35, s36, s23
  v_smfmac_f32_16x16x64_bf16 v[20:23], v[96:99], v[184:191], v0
  s_waitcnt lgkmcnt(2)
  v_smfmac_f32_16x16x64_bf16 v[20:23], v[116:119], v[68:75], v0
  s_waitcnt lgkmcnt(0)
  ds_read_b128 v[68:71], v4 offset:20480
  v_mul_f32 v16, s18, v16
  v_smfmac_f32_16x16x64_bf16 v[20:23], v[124:127], v[76:83], v0
  ds_read_b128 v[72:75], v4 offset:21504
  v_mul_f32 v17, s18, v17
  v_smfmac_f32_16x16x64_bf16 v[20:23], v[104:107], a[32:39], v0
  ds_read_b128 v[76:79], v4 offset:22528
  v_mul_f32 v18, s18, v18
  v_smfmac_f32_16x16x64_bf16 v[20:23], v[108:111], a[40:47], v0
  ds_read_b128 v[80:83], v4 offset:23552
  v_mul_f32 v19, s18, v19
  v_smfmac_f32_16x16x64_bf16 v[20:23], v[112:115], a[80:87], v0
  v_cvt_pk_bf16_f32 v120, v16, v17
  v_smfmac_f32_16x16x64_bf16 v[20:23], v[84:87], a[88:95], v0
  v_cvt_pk_bf16_f32 v121, v18, v19
  v_smfmac_f32_16x16x64_bf16 v[20:23], v[88:91], a[128:135], v0
  ds_write_b64 v5, v[120:121] offset:24576
  v_smfmac_f32_16x16x64_bf16 v[20:23], v[100:103], a[136:143], v0
  s_waitcnt lgkmcnt(3)
  v_smfmac_f32_16x16x64_bf16 v[24:27], v[92:95], v[68:75], v0
  s_waitcnt lgkmcnt(1)
  v_mov_b64 v[92:93], 0
  v_smfmac_f32_16x16x64_bf16 v[24:27], v[96:99], v[76:83], v0
  s_nop 1
  v_cvt_pk_bf16_f32 v122, v20, v21
  v_cvt_pk_bf16_f32 v123, v22, v23
  v_smfmac_f32_16x16x64_bf16 v[24:27], v[116:119], v[208:215], v0
  ds_write_b64 v5, v[122:123] offset:26880
  v_mov_b64 v[94:95], 0
  v_smfmac_f32_16x16x64_bf16 v[24:27], v[124:127], v[216:223], v0
  s_waitcnt lgkmcnt(1)
  s_barrier
  ds_read_b64_tr_b16 v[68:69], v6 offset:24576
  v_smfmac_f32_16x16x64_bf16 v[24:27], v[104:107], a[48:55], v0
  s_add_u32 s27, s27, 8192
  ds_read_b64_tr_b16 v[70:71], v6 offset:24640
  ds_read_b64_tr_b16 v[72:73], v6 offset:24832
  v_smfmac_f32_16x16x64_bf16 v[24:27], v[108:111], a[56:63], v0
  s_add_u32 s28, s28, 8192
  ds_read_b64_tr_b16 v[74:75], v6 offset:24896
  ds_read_b64_tr_b16 v[76:77], v6 offset:25088
  v_smfmac_f32_16x16x64_bf16 v[24:27], v[112:115], a[96:103], v0
  s_nop 0
  ds_read_b64_tr_b16 v[78:79], v6 offset:25152
  ds_read_b64_tr_b16 v[80:81], v6 offset:25344
  v_smfmac_f32_16x16x64_bf16 v[24:27], v[84:87], a[104:111], v0
  ds_read_b64_tr_b16 v[82:83], v6 offset:25408
  v_mov_b64 v[96:97], 0
  v_smfmac_f32_16x16x64_bf16 v[24:27], v[88:91], a[144:151], v0
  s_waitcnt lgkmcnt(8)
  s_barrier
  ds_read_b64_tr_b16 v[116:117], v6 offset:26880
  v_smfmac_f32_16x16x64_bf16 v[24:27], v[100:103], a[152:159], v0
  s_waitcnt lgkmcnt(7)
  ds_read_b64_tr_b16 v[118:119], v6 offset:26944
  buffer_store_dwordx2 v[122:123], v5, s[4:7], s29 offen sc1
  v_mfma_f32_16x16x32_bf16 v[16:19], v[36:39], v[68:71], 0
  s_waitcnt lgkmcnt(6)
  ds_read_b64_tr_b16 v[124:125], v6 offset:27136
  ds_read_b64_tr_b16 v[126:127], v6 offset:27200
  v_mfma_f32_16x16x32_bf16 v[16:19], v[40:43], v[72:75], v[16:19]
  s_waitcnt lgkmcnt(6)
  ds_read_b64_tr_b16 v[104:105], v6 offset:27392
  ds_read_b64_tr_b16 v[106:107], v6 offset:27456
  v_mfma_f32_16x16x32_bf16 v[16:19], v[44:47], v[76:79], v[16:19]
  s_waitcnt lgkmcnt(6)
  ds_read_b64_tr_b16 v[108:109], v6 offset:27648
  ds_read_b64_tr_b16 v[110:111], v6 offset:27712
  v_mfma_f32_16x16x32_bf16 v[16:19], v[48:51], v[80:83], v[16:19]
  s_waitcnt lgkmcnt(6)
  v_cvt_pk_bf16_f32 v120, v24, v25
  v_cvt_pk_bf16_f32 v121, v26, v27
  v_mfma_f32_16x16x32_bf16 v[112:115], v[116:119], v[68:71], 0
  s_waitcnt lgkmcnt(4)
  buffer_store_dwordx2 v[120:121], v5, s[4:7], s29 offen offset:2304 sc1
  v_mov_b64 v[98:99], 0
  v_mfma_f32_16x16x32_bf16 v[112:115], v[124:127], v[72:75], v[112:115]
  s_waitcnt lgkmcnt(2)
  v_mov_b64 v[36:37], 0
  v_exp_f32 v100, v16
  v_mfma_f32_16x16x32_bf16 v[112:115], v[104:107], v[76:79], v[112:115]
  s_waitcnt lgkmcnt(0)
  v_exp_f32 v101, v17
  v_mfma_f32_16x16x32_bf16 v[112:115], v[108:111], v[80:83], v[112:115]
  s_add_u32 s29, s29, 147456
  v_exp_f32 v102, v18
  v_mfma_f32_16x16x32_bf16 v[20:23], v[52:55], v[68:71], 0
  s_cmp_eq_u32 s14, 63
  v_exp_f32 v103, v19
  v_mfma_f32_16x16x32_bf16 v[20:23], v[56:59], v[72:75], v[20:23]
  s_cbranch_scc1 M_tdone
  v_cvt_pk_bf16_f32 v44, v100, v101
  v_cvt_pk_bf16_f32 v45, v102, v103
  v_mfma_f32_16x16x32_bf16 v[20:23], v[60:63], v[76:79], v[20:23]
  v_exp_f32 v100, v112
  v_mfma_f32_16x16x32_bf16 v[20:23], v[64:67], v[80:83], v[20:23]
  v_exp_f32 v101, v113
  v_exp_f32 v102, v114
  v_exp_f32 v103, v115
  v_cvt_pk_bf16_f32 v84, v100, v101
  v_cvt_pk_bf16_f32 v85, v102, v103
  v_cndmask_b32 v48, v84, 0, s[16:17]
  v_cndmask_b32 v49, v85, 0, s[16:17]
  v_cndmask_b32 v50, 0, v84, s[16:17]
  v_cndmask_b32 v51, 0, v85, s[16:17]
  v_exp_f32 v100, v20
  v_mfma_f32_16x16x16_bf16 v[88:91], v[12:13], v[48:49], 0
  v_exp_f32 v101, v21
  v_mfma_f32_16x16x16_bf16 v[24:27], v[120:121], v[48:49], 0
  v_exp_f32 v102, v22
  v_mfma_f32_16x16x16_bf16 v[116:119], v[120:121], v[50:51], 0
  v_exp_f32 v103, v23
  v_cvt_pk_bf16_f32 v46, v100, v101
  v_cvt_pk_bf16_f32 v47, v102, v103
  v_mov_b64 v[38:39], 0
  s_nop 0
  v_mfma_f32_16x16x32_bf16 v[88:91], v[12:15], v[44:47], v[88:91]
  v_mov_b64 v[40:41], 0
  v_mov_b64 v[42:43], 0
  v_mfma_f32_16x16x32_bf16 v[24:27], v[28:31], v[44:47], v[24:27]
  ds_read_b128 v[52:55], v4 offset:24576
  ds_read_b128 v[56:59], v4 offset:25600
  v_mfma_f32_16x16x32_bf16 v[116:119], v[32:35], v[44:47], v[116:119]
  s_nop 1
  v_rcp_f32 v89, v88
  v_subrev_u32 v100, s54, v88
  v_cmp_le_u32 vcc, s55, v100
  v_mul_f32 v24, v89, v24
  v_mul_f32 v25, v89, v25
  s_cbranch_vccnz T_slow_156
T_back_157:
  v_cvt_pk_bf16_f32 v124, v24, v25
  v_pk_mul_f32 v[26:27], v[26:27], v[88:89] op_sel:[0,1] op_sel_hi:[1,1]
  v_pk_mul_f32 v[116:117], v[116:117], v[88:89] op_sel:[0,1] op_sel_hi:[1,1]
  v_pk_mul_f32 v[118:119], v[118:119], v[88:89] op_sel:[0,1] op_sel_hi:[1,1]
  v_cvt_pk_bf16_f32 v125, v26, v27
  v_cvt_pk_bf16_f32 v126, v116, v117
  v_cvt_pk_bf16_f32 v127, v118, v119
  ds_write_b128 v11, v[124:127] offset:29696
  s_nop 0
  v_smfmac_f32_16x16x64_bf16 v[92:95], v[124:127], a[160:167], v0
  v_smfmac_f32_16x16x64_bf16 v[96:99], v[124:127], a[168:175], v0
  v_smfmac_f32_16x16x64_bf16 v[36:39], v[124:127], a[176:183], v0
  v_smfmac_f32_16x16x64_bf16 v[40:43], v[124:127], a[184:191], v0
  s_waitcnt lgkmcnt(0)
  s_barrier
  ds_read_b128 v[104:107], v11 offset:29184
  ds_read_b128 v[108:111], v11 offset:30720
  ds_read_b128 v[68:71], v11 offset:30208
  s_waitcnt lgkmcnt(2)
  v_smfmac_f32_16x16x64_bf16 v[92:95], v[104:107], a[192:199], v0
  s_waitcnt lgkmcnt(1)
  ds_read_b128 v[76:79], v4 offset:28672
  v_smfmac_f32_16x16x64_bf16 v[92:95], v[108:111], a[224:231], v0
  s_waitcnt lgkmcnt(1)
  ds_read_b128 v[80:83], v4 offset:29696
  v_smfmac_f32_16x16x64_bf16 v[92:95], v[68:71], a[240:247], v0
  ds_read_b128 v[60:63], v4 offset:26624
  v_smfmac_f32_16x16x64_bf16 v[96:99], v[104:107], a[200:207], v0
  ds_read_b128 v[64:67], v4 offset:27648
  v_smfmac_f32_16x16x64_bf16 v[96:99], v[108:111], a[232:239], v0
  ds_read_b128 v[28:31], v4 offset:30720
  s_nop 0
  v_cvt_pk_bf16_f32 v16, v92, v93
  v_cvt_pk_bf16_f32 v17, v94, v95
  v_bfi_b32 v16, 1, s57, v16
  v_smfmac_f32_16x16x64_bf16 v[96:99], v[68:71], a[248:255], v0
  buffer_store_dwordx2 v[16:17], v7, s[4:7], s20 offen offset:0 sc1
  v_smfmac_f32_16x16x64_bf16 v[36:39], v[104:107], a[208:215], v0
  ds_read_b128 v[32:35], v4 offset:31744
  v_smfmac_f32_16x16x64_bf16 v[36:39], v[108:111], v[52:59], v0
  s_waitcnt lgkmcnt(4)
  s_nop 0
  v_cvt_pk_bf16_f32 v18, v96, v97
  v_cvt_pk_bf16_f32 v19, v98, v99
  v_bfi_b32 v18, 1, s57, v18
  v_smfmac_f32_16x16x64_bf16 v[36:39], v[68:71], v[76:83], v0
  buffer_store_dwordx2 v[18:19], v7, s[4:7], s20 offen offset:64 sc1
  v_smfmac_f32_16x16x64_bf16 v[40:43], v[104:107], a[216:223], v0
  s_waitcnt lgkmcnt(2)
  ds_read_b128 v[116:119], v2 offset:31232
  v_smfmac_f32_16x16x64_bf16 v[40:43], v[108:111], v[60:67], v0
  s_waitcnt lgkmcnt(1)
  s_nop 0
  v_cvt_pk_bf16_f32 v20, v36, v37
  v_cvt_pk_bf16_f32 v21, v38, v39
  v_bfi_b32 v20, 1, s57, v20
  v_smfmac_f32_16x16x64_bf16 v[40:43], v[68:71], v[28:35], v0
  buffer_store_dwordx2 v[20:21], v7, s[4:7], s21 offen offset:0 sc1
  s_nop 6
  v_cvt_pk_bf16_f32 v22, v40, v41
  v_cvt_pk_bf16_f32 v23, v42, v43
  v_bfi_b32 v22, 1, s57, v22
  buffer_store_dwordx2 v[22:23], v7, s[4:7], s21 offen offset:64 sc1
  ds_read_b128 v[68:71], v4 offset:0
  ds_read_b128 v[72:75], v4 offset:1024
  ds_read_b128 v[76:79], v4 offset:4096
  ds_read_b128 v[80:83], v4 offset:5120
  ds_read_b128 v[84:87], v4 offset:8192
  ds_read_b128 v[88:91], v4 offset:9216
  ds_read_b128 v[92:95], v4 offset:2048
  ds_read_b128 v[96:99], v4 offset:3072
  ds_read_b128 v[100:103], v4 offset:6144
  ds_read_b128 v[104:107], v4 offset:7168
  ds_read_b128 v[108:111], v4 offset:10240
  ds_read_b128 v[112:115], v4 offset:11264
  v_mov_b64 v[16:17], 0
  v_mov_b64 v[18:19], 0
  v_mov_b64 v[20:21], 0
  v_mov_b64 v[22:23], 0
  v_mov_b64 v[24:25], 0
  v_mov_b64 v[26:27], 0
  s_mov_b32 s19, 0
  v_mov_b32 v49, -1
  ds_read_b64 v[44:45], v2 offset:32256
  s_waitcnt lgkmcnt(0)
  v_readfirstlane_b32 s38, v44
  v_readfirstlane_b32 s37, v45
  s_nop 0
  s_add_u32 s37, s37, 30
  s_cmp_ge_u32 s38, 30
  s_cselect_b32 s38, s37, s38
  s_cmp_ge_u32 s38, 64
  s_cselect_b32 s38, 100, s38
  s_sub_u32 s38, s38, 1
  s_max_i32 s30, s30, s38
  s_waitcnt vmcnt(1)
  buffer_load_dwordx4 v[52:55], v2, s[4:7], s22 offen offset:0 sc1
  buffer_load_dwordx4 v[56:59], v2, s[4:7], s22 offen offset:1024 sc1
  buffer_load_dwordx4 v[60:63], v2, s[4:7], s22 offen offset:2048 sc1
  buffer_load_dwordx4 v[64:67], v2, s[4:7], s22 offen offset:3072 sc1
  s_waitcnt lgkmcnt(12)
  s_waitcnt vmcnt(3)
  v_mfma_f32_16x16x32_bf16 v[120:123], v[116:119], v[52:55], 0
  v_xor_b32 v48, s57, v52
  v_bitop3_b32 v48, v48, v54, s57 bitop3:0xf6
  s_waitcnt vmcnt(2)
  v_mfma_f32_16x16x32_bf16 v[120:123], v[116:119], v[56:59], v[120:123]
  v_bitop3_b32 v48, v48, v56, s57 bitop3:0xf6
  v_bitop3_b32 v48, v48, v58, s57 bitop3:0xf6
  s_waitcnt vmcnt(1)
  v_mfma_f32_16x16x32_bf16 v[120:123], v[116:119], v[60:63], v[120:123]
  v_bitop3_b32 v48, v48, v60, s57 bitop3:0xf6
  v_bitop3_b32 v48, v48, v62, s57 bitop3:0xf6
  s_waitcnt vmcnt(0)
  v_mfma_f32_16x16x32_bf16 v[120:123], v[116:119], v[64:67], v[120:123]
  v_bitop3_b32 v48, v48, v64, s57 bitop3:0xf6
  v_bitop3_b32 v48, v48, v66, s57 bitop3:0xf6
  v_and_b32 v48, 1, v48
  v_cmp_ne_u32 vcc, 0, v48
  s_cbranch_vccnz T_p1re_159
T_p1ok_160:
  s_nop 2
  v_add_f32_dpp v120, v120, v120 row_ror:8 row_mask:0xf bank_mask:0xf
  v_add_f32_dpp v121, v121, v121 row_ror:8 row_mask:0xf bank_mask:0xf
  v_cvt_pk_bf16_f32 v48, v120, v121
  v_min_u32 v48, -2, v48
  buffer_store_dword v48, v8, s[4:7], s35 offen sc1
  buffer_store_dword v49, v8, s[4:7], s26 offen sc1
  s_barrier
  ds_read_b128 v[28:31], v2 offset:17408
  ds_read_b128 v[32:35], v2 offset:21504
  ds_read_b128 v[36:39], v2 offset:8192
  ds_read_b128 v[40:43], v2 offset:9216
  ds_read_b128 v[44:47], v2 offset:10240
  ds_read_b128 v[48:51], v2 offset:11264
  buffer_load_dwordx4 v[124:127], v2, s[4:7], s24 offen offset:1024 sc1
  buffer_load_dwordx4 v[116:119], v2, s[4:7], s25 offen offset:1024 sc1
  ds_read_b128 v[52:55], v2 offset:12288
  ds_read_b128 v[56:59], v2 offset:13312
  ds_read_b128 v[60:63], v2 offset:14336
  ds_read_b128 v[64:67], v2 offset:15360
  buffer_load_dwordx4 v[124:127], v2, s[4:7], s24 offen offset:1024 sc1
  buffer_load_dwordx4 v[116:119], v2, s[4:7], s25 offen offset:1024 sc1
  s_mov_b32 s19, 0
  s_branch T_loop_150
T_p1re_159:
  s_mov_b64 exec, vcc
  buffer_load_dwordx4 v[52:55], v2, s[4:7], s22 offen offset:0 sc1
  buffer_load_dwordx4 v[56:59], v2, s[4:7], s22 offen offset:1024 sc1
  buffer_load_dwordx4 v[60:63], v2, s[4:7], s22 offen offset:2048 sc1
  buffer_load_dwordx4 v[64:67], v2, s[4:7], s22 offen offset:3072 sc1
  s_mov_b64 exec, -1
  s_add_u32 s19, s19, 1
  s_cmp_gt_u32 s19, 32768
  s_cbranch_scc1 M_exit
  s_waitcnt vmcnt(3)
  v_mfma_f32_16x16x32_bf16 v[120:123], v[116:119], v[52:55], 0
  v_xor_b32 v48, s57, v52
  v_bitop3_b32 v48, v48, v54, s57 bitop3:0xf6
  s_waitcnt vmcnt(2)
  v_mfma_f32_16x16x32_bf16 v[120:123], v[116:119], v[56:59], v[120:123]
  v_bitop3_b32 v48, v48, v56, s57 bitop3:0xf6
  v_bitop3_b32 v48, v48, v58, s57 bitop3:0xf6
  s_waitcnt vmcnt(1)
  v_mfma_f32_16x16x32_bf16 v[120:123], v[116:119], v[60:63], v[120:123]
  v_bitop3_b32 v48, v48, v60, s57 bitop3:0xf6
  v_bitop3_b32 v48, v48, v62, s57 bitop3:0xf6
  s_waitcnt vmcnt(0)
  v_mfma_f32_16x16x32_bf16 v[120:123], v[116:119], v[64:67], v[120:123]
  v_bitop3_b32 v48, v48, v64, s57 bitop3:0xf6
  v_bitop3_b32 v48, v48, v66, s57 bitop3:0xf6
  v_and_b32 v48, 1, v48
  v_cmp_ne_u32 vcc, 0, v48
  s_cbranch_vccnz T_p1re_159
  s_branch T_p1ok_160
T_kvw_154:
  s_mov_b32 s19, 0
  s_branch T_kvok_162
T_kv_161:
  s_sleep 4
  s_add_u32 s19, s19, 1
  s_cmp_gt_u32 s19, 32768
  s_cbranch_scc1 M_exit
T_kvok_162:
  s_add_u32 s39, s99, 128
  s_mov_b32 s38, 0
  s_mov_b32 s37, 0
  s_atomic_or s38, s[58:59], s99 glc
  s_atomic_or s37, s[58:59], s39 glc
  s_waitcnt lgkmcnt(0)
  s_add_u32 s37, s37, 30
  s_cmp_ge_u32 s38, 30
  s_cselect_b32 s38, s37, s38
  s_cmp_ge_u32 s38, 64
  s_cselect_b32 s38, 100, s38
  s_sub_u32 s38, s38, 1
  s_max_i32 s30, s30, s38
  s_cmp_ge_i32 s14, s30
  s_cbranch_scc1 T_kv_161
  s_branch T_kvb_155
T_slow_156:
  s_nop 7
  v_max3_f32 v100, v16, v17, v18
  v_max3_f32 v100, v100, v19, v20
  v_max3_f32 v100, v100, v21, v22
  v_max3_f32 v100, v100, v23, v112
  v_max3_f32 v100, v100, v113, v114
  v_max_f32 v100, v100, v115
  v_mov_b32 v101, v100
  s_nop 1
  v_permlane32_swap_b32 v100, v101
  s_nop 1
  v_max_f32 v100, v100, v101
  v_mov_b32 v101, v100
  s_nop 1
  v_permlane16_swap_b32 v100, v101
  s_nop 1
  v_max_f32 v100, v100, v101
  v_sub_f32 v16, v16, v100
  v_sub_f32 v17, v17, v100
  v_sub_f32 v18, v18, v100
  v_sub_f32 v19, v19, v100
  v_exp_f32 v16, v16
  v_exp_f32 v17, v17
  v_exp_f32 v18, v18
  v_exp_f32 v19, v19
  v_sub_f32 v20, v20, v100
  v_sub_f32 v21, v21, v100
  v_sub_f32 v22, v22, v100
  v_sub_f32 v23, v23, v100
  v_exp_f32 v20, v20
  v_exp_f32 v21, v21
  v_exp_f32 v22, v22
  v_exp_f32 v23, v23
  v_sub_f32 v112, v112, v100
  v_sub_f32 v113, v113, v100
  v_sub_f32 v114, v114, v100
  v_sub_f32 v115, v115, v100
  v_exp_f32 v112, v112
  v_exp_f32 v113, v113
  v_exp_f32 v114, v114
  v_exp_f32 v115, v115
  s_nop 0
  v_cvt_pk_bf16_f32 v44, v16, v17
  v_cvt_pk_bf16_f32 v45, v18, v19
  v_cvt_pk_bf16_f32 v46, v20, v21
  v_cvt_pk_bf16_f32 v47, v22, v23
  v_cvt_pk_bf16_f32 v84, v112, v113
  v_cvt_pk_bf16_f32 v85, v114, v115
  v_cndmask_b32 v48, v84, 0, s[16:17]
  v_cndmask_b32 v49, v85, 0, s[16:17]
  v_cndmask_b32 v50, 0, v84, s[16:17]
  v_cndmask_b32 v51, 0, v85, s[16:17]
  s_nop 1
  v_mfma_f32_16x16x16_bf16 v[88:91], v[12:13], v[48:49], 0
  v_mfma_f32_16x16x16_bf16 v[24:27], v[120:121], v[48:49], 0
  v_mfma_f32_16x16x16_bf16 v[116:119], v[120:121], v[50:51], 0
  v_mfma_f32_16x16x32_bf16 v[88:91], v[12:15], v[44:47], v[88:91]
  v_mfma_f32_16x16x32_bf16 v[24:27], v[28:31], v[44:47], v[24:27]
  v_mfma_f32_16x16x32_bf16 v[116:119], v[32:35], v[44:47], v[116:119]
  s_nop 7
  s_nop 1
  v_rcp_f32 v89, v88
  s_nop 0
  v_mul_f32 v24, v89, v24
  v_mul_f32 v25, v89, v25
  s_branch T_back_157
T_w_135:
  s_mov_b32 s19, 0
  v_mov_b64 v[16:17], 0
  v_mov_b64 v[18:19], 0
  v_mov_b64 v[20:21], 0
  v_mov_b64 v[22:23], 0
  v_mov_b64 v[24:25], 0
  v_mov_b64 v[26:27], 0
  buffer_load_dwordx4 v[124:127], v2, s[4:7], s24 offen offset:2048 sc1
  buffer_load_dwordx4 v[116:119], v2, s[4:7], s25 offen offset:2048 sc1
  buffer_load_dwordx4 v[124:127], v2, s[4:7], s24 offen offset:2048 sc1
  buffer_load_dwordx4 v[116:119], v2, s[4:7], s25 offen offset:2048 sc1
  s_branch T_loop_163
.p2align 6
T_retry_164:
  s_mov_b64 exec, vcc
  buffer_load_dwordx4 v[124:127], v2, s[4:7], s24 offen offset:2048 sc1
  buffer_load_dwordx4 v[116:119], v2, s[4:7], s25 offen offset:2048 sc1
  s_mov_b64 exec, -1
  s_add_u32 s19, s19, 1
  s_cmp_gt_u32 s19, 32768
  s_cbranch_scc1 M_exit
T_loop_163:
  s_waitcnt vmcnt(3) lgkmcnt(0)
  v_max3_u32 v123, v124, v125, v126
  v_max_u32 v123, v123, v127
  v_mov_b32_dpp v120, v124 row_ror:8 row_mask:0xf bank_mask:0xf
  v_mov_b32_dpp v121, v125 row_ror:8 row_mask:0xf bank_mask:0xf
  s_waitcnt vmcnt(2)
  v_max3_u32 v123, v123, v116, v117
  v_max3_u32 v123, v123, v118, v119
  v_cmp_eq_u32 vcc, -1, v123
  s_cbranch_vccnz T_retry_164
  v_smfmac_f32_16x16x64_bf16 v[16:19], v[124:127], v[68:75], v0
  s_add_u32 s14, s14, 1
  ds_write_b128 v2, v[124:127] offset:2048
  v_mov_b32_dpp v122, v126 row_ror:8 row_mask:0xf bank_mask:0xf
  v_smfmac_f32_16x16x64_bf16 v[20:23], v[124:127], v[76:83], v0
  s_and_b32 s57, s14, 1
  v_mov_b32_dpp v123, v127 row_ror:8 row_mask:0xf bank_mask:0xf
  v_smfmac_f32_16x16x64_bf16 v[24:27], v[124:127], v[84:91], v0
  s_and_b32 s36, s14, 3
  ds_write_b128 v2, v[116:119] offset:6144
  v_smfmac_f32_16x16x64_bf16 v[16:19], v[120:123], v[92:99], v0
  s_lshl_b32 s36, s36, 13
  v_mov_b32_dpp v84, v116 row_ror:8 row_mask:0xf bank_mask:0xf
  v_smfmac_f32_16x16x64_bf16 v[20:23], v[120:123], v[100:107], v0
  s_add_u32 s26, s36, s23
  ds_read_b128 v[68:71], v4 offset:12288
  v_mov_b32_dpp v85, v117 row_ror:8 row_mask:0xf bank_mask:0xf
  v_smfmac_f32_16x16x64_bf16 v[24:27], v[120:123], v[108:115], v0
  s_add_u32 s36, s36, 8192
  ds_read_b128 v[72:75], v4 offset:13312
  v_mov_b32_dpp v86, v118 row_ror:8 row_mask:0xf bank_mask:0xf
  v_smfmac_f32_16x16x64_bf16 v[16:19], v[116:119], v[224:231], v0
  s_and_b32 s36, s36, 0x7fff
  ds_read_b128 v[76:79], v4 offset:14336
  v_mov_b32_dpp v87, v119 row_ror:8 row_mask:0xf bank_mask:0xf
  v_smfmac_f32_16x16x64_bf16 v[20:23], v[116:119], v[240:247], v0
  s_waitcnt lgkmcnt(3)
  s_barrier
  ds_read_b128 v[100:103], v2 offset:3072
  v_smfmac_f32_16x16x64_bf16 v[24:27], v[116:119], a[0:7], v0
  s_mov_b32 m0, s31
  ds_read_b128 v[120:123], v1 offset:3072
  v_smfmac_f32_16x16x64_bf16 v[16:19], v[84:87], v[232:239], v0
  s_cmp_ge_i32 s14, s30
  s_cbranch_scc1 T_kvw_167
T_kvb_168:
  v_smfmac_f32_16x16x64_bf16 v[20:23], v[84:87], v[248:255], v0
  ds_read_b128 v[80:83], v4 offset:15360
  v_smfmac_f32_16x16x64_bf16 v[24:27], v[84:87], a[8:15], v0
  s_waitcnt lgkmcnt(2)
  v_smfmac_f32_16x16x64_bf16 v[16:19], v[100:103], v[128:135], v0
  ds_read_b128 v[92:95], v2 offset:0
  buffer_load_dwordx4 v9, s[4:7], s27 offen sc1 lds
  v_smfmac_f32_16x16x64_bf16 v[20:23], v[100:103], v[144:151], v0
  ds_read_b128 v[96:99], v1 offset:0
  s_mov_b32 m0, s32
  v_smfmac_f32_16x16x64_bf16 v[24:27], v[100:103], v[68:75], v0
  s_waitcnt vmcnt(1) lgkmcnt(3)
  ds_read_b128 v[116:119], v2 offset:1024
  v_smfmac_f32_16x16x64_bf16 v[16:19], v[120:123], v[136:143], v0
  ds_read_b128 v[124:127], v1 offset:1024
  v_smfmac_f32_16x16x64_bf16 v[20:23], v[120:123], v[152:159], v0
  s_waitcnt lgkmcnt(4)
  ds_read_b128 v[104:107], v2 offset:7168
  buffer_load_dwordx4 v9, s[4:7], s27 offen offset:128 sc1 lds
  v_smfmac_f32_16x16x64_bf16 v[24:27], v[120:123], v[76:83], v0
  s_waitcnt lgkmcnt(4)
  ds_read_b128 v[108:111], v1 offset:7168
  s_mov_b32 m0, s33
  v_smfmac_f32_16x16x64_bf16 v[16:19], v[92:95], v[160:167], v0
  s_waitcnt lgkmcnt(4)
  ds_read_b128 v[112:115], v2 offset:4096
  v_smfmac_f32_16x16x64_bf16 v[16:19], v[96:99], v[168:175], v0
  s_waitcnt lgkmcnt(4)
  ds_read_b128 v[84:87], v1 offset:4096
  v_smfmac_f32_16x16x64_bf16 v[16:19], v[116:119], v[192:199], v0
  s_waitcnt lgkmcnt(4)
  ds_read_b128 v[88:91], v2 offset:5120
  buffer_load_dwordx4 v10, s[4:7], s28 offen sc1 lds
  v_smfmac_f32_16x16x64_bf16 v[16:19], v[124:127], v[200:207], v0
  s_waitcnt lgkmcnt(4)
  ds_read_b128 v[100:103], v1 offset:5120
  s_mov_b32 m0, s34
  v_smfmac_f32_16x16x64_bf16 v[16:19], v[104:107], a[16:23], v0
  s_waitcnt lgkmcnt(4)
  ds_read_b128 v[68:71], v4 offset:16384
  v_smfmac_f32_16x16x64_bf16 v[16:19], v[108:111], a[24:31], v0
  s_waitcnt lgkmcnt(4)
  ds_read_b128 v[72:75], v4 offset:17408
  v_smfmac_f32_16x16x64_bf16 v[16:19], v[112:115], a[64:71], v0
  s_waitcnt lgkmcnt(4)
  ds_read_b128 v[76:79], v4 offset:18432
  buffer_load_dwordx4 v10, s[4:7], s28 offen offset:256 sc1 lds
  v_smfmac_f32_16x16x64_bf16 v[16:19], v[84:87], a[72:79], v0
  s_waitcnt lgkmcnt(4)
  ds_read_b128 v[80:83], v4 offset:19456
  v_smfmac_f32_16x16x64_bf16 v[16:19], v[88:91], a[112:119], v0
  s_waitcnt lgkmcnt(4)
  v_smfmac_f32_16x16x64_bf16 v[16:19], v[100:103], a[120:127], v0
  s_add_u32 s24, s36, 145752064
  s_add_u32 s25, s36, 145756160
  v_smfmac_f32_16x16x64_bf16 v[20:23], v[92:95], v[176:183], v0
  s_add_u32 s35, s36, s23
  v_smfmac_f32_16x16x64_bf16 v[20:23], v[96:99], v[184:191], v0
  s_waitcnt lgkmcnt(2)
  v_smfmac_f32_16x16x64_bf16 v[20:23], v[116:119], v[68:75], v0
  s_waitcnt lgkmcnt(0)
  ds_read_b128 v[68:71], v4 offset:20480
  v_mul_f32 v16, s18, v16
  v_smfmac_f32_16x16x64_bf16 v[20:23], v[124:127], v[76:83], v0
  ds_read_b128 v[72:75], v4 offset:21504
  v_mul_f32 v17, s18, v17
  v_smfmac_f32_16x16x64_bf16 v[20:23], v[104:107], a[32:39], v0
  ds_read_b128 v[76:79], v4 offset:22528
  v_mul_f32 v18, s18, v18
  v_smfmac_f32_16x16x64_bf16 v[20:23], v[108:111], a[40:47], v0
  ds_read_b128 v[80:83], v4 offset:23552
  v_mul_f32 v19, s18, v19
  v_smfmac_f32_16x16x64_bf16 v[20:23], v[112:115], a[80:87], v0
  v_cvt_pk_bf16_f32 v120, v16, v17
  v_smfmac_f32_16x16x64_bf16 v[20:23], v[84:87], a[88:95], v0
  v_cvt_pk_bf16_f32 v121, v18, v19
  v_smfmac_f32_16x16x64_bf16 v[20:23], v[88:91], a[128:135], v0
  ds_write_b64 v5, v[120:121] offset:24576
  v_smfmac_f32_16x16x64_bf16 v[20:23], v[100:103], a[136:143], v0
  s_waitcnt lgkmcnt(3)
  v_smfmac_f32_16x16x64_bf16 v[24:27], v[92:95], v[68:75], v0
  s_waitcnt lgkmcnt(1)
  v_mov_b64 v[92:93], 0
  v_smfmac_f32_16x16x64_bf16 v[24:27], v[96:99], v[76:83], v0
  s_nop 1
  v_cvt_pk_bf16_f32 v122, v20, v21
  v_cvt_pk_bf16_f32 v123, v22, v23
  v_smfmac_f32_16x16x64_bf16 v[24:27], v[116:119], v[208:215], v0
  ds_write_b64 v5, v[122:123] offset:26880
  v_mov_b64 v[94:95], 0
  v_smfmac_f32_16x16x64_bf16 v[24:27], v[124:127], v[216:223], v0
  s_waitcnt lgkmcnt(1)
  s_barrier
  ds_read_b64_tr_b16 v[68:69], v6 offset:24576
  v_smfmac_f32_16x16x64_bf16 v[24:27], v[104:107], a[48:55], v0
  s_add_u32 s27, s27, 8192
  ds_read_b64_tr_b16 v[70:71], v6 offset:24640
  ds_read_b64_tr_b16 v[72:73], v6 offset:24832
  v_smfmac_f32_16x16x64_bf16 v[24:27], v[108:111], a[56:63], v0
  s_add_u32 s28, s28, 8192
  ds_read_b64_tr_b16 v[74:75], v6 offset:24896
  ds_read_b64_tr_b16 v[76:77], v6 offset:25088
  v_smfmac_f32_16x16x64_bf16 v[24:27], v[112:115], a[96:103], v0
  s_nop 0
  ds_read_b64_tr_b16 v[78:79], v6 offset:25152
  ds_read_b64_tr_b16 v[80:81], v6 offset:25344
  v_smfmac_f32_16x16x64_bf16 v[24:27], v[84:87], a[104:111], v0
  ds_read_b64_tr_b16 v[82:83], v6 offset:25408
  v_mov_b64 v[96:97], 0
  v_smfmac_f32_16x16x64_bf16 v[24:27], v[88:91], a[144:151], v0
  s_waitcnt lgkmcnt(8)
  s_barrier
  ds_read_b64_tr_b16 v[116:117], v6 offset:26880
  v_smfmac_f32_16x16x64_bf16 v[24:27], v[100:103], a[152:159], v0
  s_waitcnt lgkmcnt(7)
  ds_read_b64_tr_b16 v[118:119], v6 offset:26944
  buffer_store_dwordx2 v[122:123], v5, s[4:7], s29 offen sc1
  v_mfma_f32_16x16x32_bf16 v[16:19], v[36:39], v[68:71], 0
  s_waitcnt lgkmcnt(6)
  ds_read_b64_tr_b16 v[124:125], v6 offset:27136
  ds_read_b64_tr_b16 v[126:127], v6 offset:27200
  v_mfma_f32_16x16x32_bf16 v[16:19], v[40:43], v[72:75], v[16:19]
  s_waitcnt lgkmcnt(6)
  ds_read_b64_tr_b16 v[104:105], v6 offset:27392
  ds_read_b64_tr_b16 v[106:107], v6 offset:27456
  v_mfma_f32_16x16x32_bf16 v[16:19], v[44:47], v[76:79], v[16:19]
  s_waitcnt lgkmcnt(6)
  ds_read_b64_tr_b16 v[108:109], v6 offset:27648
  ds_read_b64_tr_b16 v[110:111], v6 offset:27712
  v_mfma_f32_16x16x32_bf16 v[16:19], v[48:51], v[80:83], v[16:19]
  s_waitcnt lgkmcnt(6)
  v_cvt_pk_bf16_f32 v120, v24, v25
  v_cvt_pk_bf16_f32 v121, v26, v27
  v_mov_b32 v86, s14
  v_mfma_f32_16x16x32_bf16 v[112:115], v[116:119], v[68:71], 0
  s_waitcnt lgkmcnt(4)
  buffer_store_dword v86, v3, s[4:7], s15 offen sc1
  buffer_store_dwordx2 v[120:121], v5, s[4:7], s29 offen offset:2304 sc1
  v_mov_b64 v[98:99], 0
  v_mfma_f32_16x16x32_bf16 v[112:115], v[124:127], v[72:75], v[112:115]
  s_waitcnt lgkmcnt(2)
  v_mov_b64 v[36:37], 0
  v_exp_f32 v100, v16
  v_mfma_f32_16x16x32_bf16 v[112:115], v[104:107], v[76:79], v[112:115]
  s_waitcnt lgkmcnt(0)
  v_exp_f32 v101, v17
  v_mfma_f32_16x16x32_bf16 v[112:115], v[108:111], v[80:83], v[112:115]
  s_add_u32 s29, s29, 147456
  v_exp_f32 v102, v18
  v_mfma_f32_16x16x32_bf16 v[20:23], v[52:55], v[68:71], 0
  s_cmp_eq_u32 s14, 63
  v_exp_f32 v103, v19
  v_mfma_f32_16x16x32_bf16 v[20:23], v[56:59], v[72:75], v[20:23]
  s_cbranch_scc1 M_tdone
  v_cvt_pk_bf16_f32 v44, v100, v101
  v_cvt_pk_bf16_f32 v45, v102, v103
  v_mfma_f32_16x16x32_bf16 v[20:23], v[60:63], v[76:79], v[20:23]
  v_exp_f32 v100, v112
  v_mfma_f32_16x16x32_bf16 v[20:23], v[64:67], v[80:83], v[20:23]
  v_exp_f32 v101, v113
  v_exp_f32 v102, v114
  v_exp_f32 v103, v115
  v_cvt_pk_bf16_f32 v84, v100, v101
  v_cvt_pk_bf16_f32 v85, v102, v103
  v_cndmask_b32 v48, v84, 0, s[16:17]
  v_cndmask_b32 v49, v85, 0, s[16:17]
  v_cndmask_b32 v50, 0, v84, s[16:17]
  v_cndmask_b32 v51, 0, v85, s[16:17]
  v_exp_f32 v100, v20
  v_mfma_f32_16x16x16_bf16 v[88:91], v[12:13], v[48:49], 0
  v_exp_f32 v101, v21
  v_mfma_f32_16x16x16_bf16 v[24:27], v[120:121], v[48:49], 0
  v_exp_f32 v102, v22
  v_mfma_f32_16x16x16_bf16 v[116:119], v[120:121], v[50:51], 0
  v_exp_f32 v103, v23
  v_cvt_pk_bf16_f32 v46, v100, v101
  v_cvt_pk_bf16_f32 v47, v102, v103
  v_mov_b64 v[38:39], 0
  s_nop 0
  v_mfma_f32_16x16x32_bf16 v[88:91], v[12:15], v[44:47], v[88:91]
  v_mov_b64 v[40:41], 0
  v_mov_b64 v[42:43], 0
  v_mfma_f32_16x16x32_bf16 v[24:27], v[28:31], v[44:47], v[24:27]
  ds_read_b128 v[52:55], v4 offset:24576
  ds_read_b128 v[56:59], v4 offset:25600
  v_mfma_f32_16x16x32_bf16 v[116:119], v[32:35], v[44:47], v[116:119]
  s_nop 1
  v_rcp_f32 v89, v88
  v_subrev_u32 v100, s54, v88
  v_cmp_le_u32 vcc, s55, v100
  v_mul_f32 v24, v89, v24
  v_mul_f32 v25, v89, v25
  s_cbranch_vccnz T_slow_169
T_back_170:
  v_cvt_pk_bf16_f32 v124, v24, v25
  v_pk_mul_f32 v[26:27], v[26:27], v[88:89] op_sel:[0,1] op_sel_hi:[1,1]
  v_pk_mul_f32 v[116:117], v[116:117], v[88:89] op_sel:[0,1] op_sel_hi:[1,1]
  v_pk_mul_f32 v[118:119], v[118:119], v[88:89] op_sel:[0,1] op_sel_hi:[1,1]
  v_cvt_pk_bf16_f32 v125, v26, v27
  v_cvt_pk_bf16_f32 v126, v116, v117
  v_cvt_pk_bf16_f32 v127, v118, v119
  ds_write_b128 v11, v[124:127] offset:30208
  s_nop 0
  v_smfmac_f32_16x16x64_bf16 v[92:95], v[124:127], a[160:167], v0
  v_smfmac_f32_16x16x64_bf16 v[96:99], v[124:127], a[168:175], v0
  v_smfmac_f32_16x16x64_bf16 v[36:39], v[124:127], a[176:183], v0
  v_smfmac_f32_16x16x64_bf16 v[40:43], v[124:127], a[184:191], v0
  s_waitcnt lgkmcnt(0)
  s_barrier
  ds_read_b128 v[104:107], v11 offset:30720
  ds_read_b128 v[108:111], v11 offset:29184
  ds_read_b128 v[68:71], v11 offset:29696
  s_waitcnt lgkmcnt(2)
  v_smfmac_f32_16x16x64_bf16 v[92:95], v[104:107], a[192:199], v0
  s_waitcnt lgkmcnt(1)
  ds_read_b128 v[76:79], v4 offset:28672
  v_smfmac_f32_16x16x64_bf16 v[92:95], v[108:111], a[224:231], v0
  s_waitcnt lgkmcnt(1)
  ds_read_b128 v[80:83], v4 offset:29696
  v_smfmac_f32_16x16x64_bf16 v[92:95], v[68:71], a[240:247], v0
  ds_read_b128 v[60:63], v4 offset:26624
  v_smfmac_f32_16x16x64_bf16 v[96:99], v[104:107], a[200:207], v0
  ds_read_b128 v[64:67], v4 offset:27648
  v_smfmac_f32_16x16x64_bf16 v[96:99], v[108:111], a[232:239], v0
  ds_read_b128 v[28:31], v4 offset:30720
  s_nop 0
  v_cvt_pk_bf16_f32 v16, v92, v93
  v_cvt_pk_bf16_f32 v17, v94, v95
  v_bfi_b32 v16, 1, s57, v16
  v_smfmac_f32_16x16x64_bf16 v[96:99], v[68:71], a[248:255], v0
  buffer_store_dwordx2 v[16:17], v7, s[4:7], s20 offen offset:0 sc1
  v_smfmac_f32_16x16x64_bf16 v[36:39], v[104:107], a[208:215], v0
  ds_read_b128 v[32:35], v4 offset:31744
  v_smfmac_f32_16x16x64_bf16 v[36:39], v[108:111], v[52:59], v0
  s_waitcnt lgkmcnt(4)
  s_nop 0
  v_cvt_pk_bf16_f32 v18, v96, v97
  v_cvt_pk_bf16_f32 v19, v98, v99
  v_bfi_b32 v18, 1, s57, v18
  v_smfmac_f32_16x16x64_bf16 v[36:39], v[68:71], v[76:83], v0
  buffer_store_dwordx2 v[18:19], v7, s[4:7], s20 offen offset:64 sc1
  v_smfmac_f32_16x16x64_bf16 v[40:43], v[104:107], a[216:223], v0
  s_waitcnt lgkmcnt(2)
  v_smfmac_f32_16x16x64_bf16 v[40:43], v[108:111], v[60:67], v0
  s_waitcnt lgkmcnt(0)
  s_nop 0
  v_cvt_pk_bf16_f32 v20, v36, v37
  v_cvt_pk_bf16_f32 v21, v38, v39
  v_bfi_b32 v20, 1, s57, v20
  v_smfmac_f32_16x16x64_bf16 v[40:43], v[68:71], v[28:35], v0
  buffer_store_dwordx2 v[20:21], v7, s[4:7], s21 offen offset:0 sc1
  s_nop 6
  v_cvt_pk_bf16_f32 v22, v40, v41
  v_cvt_pk_bf16_f32 v23, v42, v43
  v_bfi_b32 v22, 1, s57, v22
  buffer_store_dwordx2 v[22:23], v7, s[4:7], s21 offen offset:64 sc1
  ds_read_b128 v[68:71], v4 offset:0
  ds_read_b128 v[72:75], v4 offset:1024
  ds_read_b128 v[76:79], v4 offset:4096
  ds_read_b128 v[80:83], v4 offset:5120
  ds_read_b128 v[84:87], v4 offset:8192
  ds_read_b128 v[88:91], v4 offset:9216
  ds_read_b128 v[92:95], v4 offset:2048
  ds_read_b128 v[96:99], v4 offset:3072
  ds_read_b128 v[100:103], v4 offset:6144
  ds_read_b128 v[104:107], v4 offset:7168
  ds_read_b128 v[108:111], v4 offset:10240
  ds_read_b128 v[112:115], v4 offset:11264
  v_mov_b64 v[16:17], 0
  v_mov_b64 v[18:19], 0
  v_mov_b64 v[20:21], 0
  v_mov_b64 v[22:23], 0
  v_mov_b64 v[24:25], 0
  v_mov_b64 v[26:27], 0
  ds_read_b64 v[44:45], v2 offset:32256
  s_waitcnt lgkmcnt(0)
  v_readfirstlane_b32 s38, v44
  v_readfirstlane_b32 s37, v45
  s_nop 0
  s_add_u32 s37, s37, 30
  s_cmp_ge_u32 s38, 30
  s_cselect_b32 s38, s37, s38
  s_cmp_ge_u32 s38, 64
  s_cselect_b32 s38, 100, s38
  s_sub_u32 s38, s38, 1
  s_max_i32 s30, s30, s38
  s_waitcnt vmcnt(4)
  s_barrier
  ds_read_b128 v[28:31], v2 offset:18432
  ds_read_b128 v[32:35], v2 offset:22528
  ds_read_b128 v[36:39], v2 offset:8192
  ds_read_b128 v[40:43], v2 offset:9216
  ds_read_b128 v[44:47], v2 offset:10240
  ds_read_b128 v[48:51], v2 offset:11264
  buffer_load_dwordx4 v[124:127], v2, s[4:7], s24 offen offset:2048 sc1
  buffer_load_dwordx4 v[116:119], v2, s[4:7], s25 offen offset:2048 sc1
  ds_read_b128 v[52:55], v2 offset:12288
  ds_read_b128 v[56:59], v2 offset:13312
  ds_read_b128 v[60:63], v2 offset:14336
  ds_read_b128 v[64:67], v2 offset:15360
  buffer_load_dwordx4 v[124:127], v2, s[4:7], s24 offen offset:2048 sc1
  buffer_load_dwordx4 v[116:119], v2, s[4:7], s25 offen offset:2048 sc1
  s_mov_b32 s19, 0
  s_branch T_loop_163
T_kvw_167:
  s_mov_b32 s19, 0
  s_branch T_kvok_175
T_kv_174:
  s_sleep 4
  s_add_u32 s19, s19, 1
  s_cmp_gt_u32 s19, 32768
  s_cbranch_scc1 M_exit
T_kvok_175:
  s_add_u32 s39, s99, 128
  s_mov_b32 s38, 0
  s_mov_b32 s37, 0
  s_atomic_or s38, s[58:59], s99 glc
  s_atomic_or s37, s[58:59], s39 glc
  s_waitcnt lgkmcnt(0)
  s_add_u32 s37, s37, 30
  s_cmp_ge_u32 s38, 30
  s_cselect_b32 s38, s37, s38
  s_cmp_ge_u32 s38, 64
  s_cselect_b32 s38, 100, s38
  s_sub_u32 s38, s38, 1
  s_max_i32 s30, s30, s38
  s_cmp_ge_i32 s14, s30
  s_cbranch_scc1 T_kv_174
  s_branch T_kvb_168
T_slow_169:
  s_nop 7
  v_max3_f32 v100, v16, v17, v18
  v_max3_f32 v100, v100, v19, v20
  v_max3_f32 v100, v100, v21, v22
  v_max3_f32 v100, v100, v23, v112
  v_max3_f32 v100, v100, v113, v114
  v_max_f32 v100, v100, v115
  v_mov_b32 v101, v100
  s_nop 1
  v_permlane32_swap_b32 v100, v101
  s_nop 1
  v_max_f32 v100, v100, v101
  v_mov_b32 v101, v100
  s_nop 1
  v_permlane16_swap_b32 v100, v101
  s_nop 1
  v_max_f32 v100, v100, v101
  v_sub_f32 v16, v16, v100
  v_sub_f32 v17, v17, v100
  v_sub_f32 v18, v18, v100
  v_sub_f32 v19, v19, v100
  v_exp_f32 v16, v16
  v_exp_f32 v17, v17
  v_exp_f32 v18, v18
  v_exp_f32 v19, v19
  v_sub_f32 v20, v20, v100
  v_sub_f32 v21, v21, v100
  v_sub_f32 v22, v22, v100
  v_sub_f32 v23, v23, v100
  v_exp_f32 v20, v20
  v_exp_f32 v21, v21
  v_exp_f32 v22, v22
  v_exp_f32 v23, v23
  v_sub_f32 v112, v112, v100
  v_sub_f32 v113, v113, v100
  v_sub_f32 v114, v114, v100
  v_sub_f32 v115, v115, v100
  v_exp_f32 v112, v112
  v_exp_f32 v113, v113
  v_exp_f32 v114, v114
  v_exp_f32 v115, v115
  s_nop 0
  v_cvt_pk_bf16_f32 v44, v16, v17
  v_cvt_pk_bf16_f32 v45, v18, v19
  v_cvt_pk_bf16_f32 v46, v20, v21
  v_cvt_pk_bf16_f32 v47, v22, v23
  v_cvt_pk_bf16_f32 v84, v112, v113
  v_cvt_pk_bf16_f32 v85, v114, v115
  v_cndmask_b32 v48, v84, 0, s[16:17]
  v_cndmask_b32 v49, v85, 0, s[16:17]
  v_cndmask_b32 v50, 0, v84, s[16:17]
  v_cndmask_b32 v51, 0, v85, s[16:17]
  s_nop 1
  v_mfma_f32_16x16x16_bf16 v[88:91], v[12:13], v[48:49], 0
  v_mfma_f32_16x16x16_bf16 v[24:27], v[120:121], v[48:49], 0
  v_mfma_f32_16x16x16_bf16 v[116:119], v[120:121], v[50:51], 0
  v_mfma_f32_16x16x32_bf16 v[88:91], v[12:15], v[44:47], v[88:91]
  v_mfma_f32_16x16x32_bf16 v[24:27], v[28:31], v[44:47], v[24:27]
  v_mfma_f32_16x16x32_bf16 v[116:119], v[32:35], v[44:47], v[116:119]
  s_nop 7
  s_nop 1
  v_rcp_f32 v89, v88
  s_nop 0
  v_mul_f32 v24, v89, v24
  v_mul_f32 v25, v89, v25
  s_branch T_back_170
T_w_136:
  s_mov_b32 s19, 0
  v_mov_b64 v[16:17], 0
  v_mov_b64 v[18:19], 0
  v_mov_b64 v[20:21], 0
  v_mov_b64 v[22:23], 0
  v_mov_b64 v[24:25], 0
  v_mov_b64 v[26:27], 0
  buffer_load_dwordx4 v[124:127], v2, s[4:7], s24 offen offset:3072 sc1
  buffer_load_dwordx4 v[116:119], v2, s[4:7], s25 offen offset:3072 sc1
  buffer_load_dwordx4 v[124:127], v2, s[4:7], s24 offen offset:3072 sc1
  buffer_load_dwordx4 v[116:119], v2, s[4:7], s25 offen offset:3072 sc1
  s_branch T_loop_176
.p2align 6
T_retry_177:
  s_mov_b64 exec, vcc
  buffer_load_dwordx4 v[124:127], v2, s[4:7], s24 offen offset:3072 sc1
  buffer_load_dwordx4 v[116:119], v2, s[4:7], s25 offen offset:3072 sc1
  s_mov_b64 exec, -1
  s_add_u32 s19, s19, 1
  s_cmp_gt_u32 s19, 32768
  s_cbranch_scc1 M_exit
T_loop_176:
  s_waitcnt vmcnt(3) lgkmcnt(0)
  v_max3_u32 v123, v124, v125, v126
  v_max_u32 v123, v123, v127
  v_mov_b32_dpp v120, v124 row_ror:8 row_mask:0xf bank_mask:0xf
  v_mov_b32_dpp v121, v125 row_ror:8 row_mask:0xf bank_mask:0xf
  s_waitcnt vmcnt(2)
  v_max3_u32 v123, v123, v116, v117
  v_max3_u32 v123, v123, v118, v119
  v_cmp_eq_u32 vcc, -1, v123
  s_cbranch_vccnz T_retry_177
  v_smfmac_f32_16x16x64_bf16 v[16:19], v[124:127], v[68:75], v0
  s_add_u32 s14, s14, 1
  ds_write_b128 v2, v[124:127] offset:3072
  v_mov_b32_dpp v122, v126 row_ror:8 row_mask:0xf bank_mask:0xf
  v_smfmac_f32_16x16x64_bf16 v[20:23], v[124:127], v[76:83], v0
  s_and_b32 s57, s14, 1
  v_mov_b32_dpp v123, v127 row_ror:8 row_mask:0xf bank_mask:0xf
  v_smfmac_f32_16x16x64_bf16 v[24:27], v[124:127], v[84:91], v0
  s_and_b32 s36, s14, 3
  ds_write_b128 v2, v[116:119] offset:7168
  v_smfmac_f32_16x16x64_bf16 v[16:19], v[120:123], v[92:99], v0
  s_lshl_b32 s36, s36, 13
  v_mov_b32_dpp v84, v116 row_ror:8 row_mask:0xf bank_mask:0xf
  v_smfmac_f32_16x16x64_bf16 v[20:23], v[120:123], v[100:107], v0
  s_add_u32 s26, s36, s23
  ds_read_b128 v[68:71], v4 offset:12288
  v_mov_b32_dpp v85, v117 row_ror:8 row_mask:0xf bank_mask:0xf
  v_smfmac_f32_16x16x64_bf16 v[24:27], v[120:123], v[108:115], v0
  s_add_u32 s36, s36, 8192
  ds_read_b128 v[72:75], v4 offset:13312
  v_mov_b32_dpp v86, v118 row_ror:8 row_mask:0xf bank_mask:0xf
  v_smfmac_f32_16x16x64_bf16 v[16:19], v[116:119], v[224:231], v0
  s_and_b32 s36, s36, 0x7fff
  ds_read_b128 v[76:79], v4 offset:14336
  v_mov_b32_dpp v87, v119 row_ror:8 row_mask:0xf bank_mask:0xf
  v_smfmac_f32_16x16x64_bf16 v[20:23], v[116:119], v[240:247], v0
  s_waitcnt lgkmcnt(3)
  s_barrier
  ds_read_b128 v[100:103], v2 offset:2048
  v_smfmac_f32_16x16x64_bf16 v[24:27], v[116:119], a[0:7], v0
  s_mov_b32 m0, s31
  ds_read_b128 v[120:123], v1 offset:2048
  v_smfmac_f32_16x16x64_bf16 v[16:19], v[84:87], v[232:239], v0
  s_cmp_ge_i32 s14, s30
  s_cbranch_scc1 T_kvw_180
T_kvb_181:
  v_smfmac_f32_16x16x64_bf16 v[20:23], v[84:87], v[248:255], v0
  ds_read_b128 v[80:83], v4 offset:15360
  v_smfmac_f32_16x16x64_bf16 v[24:27], v[84:87], a[8:15], v0
  s_waitcnt lgkmcnt(2)
  v_smfmac_f32_16x16x64_bf16 v[16:19], v[100:103], v[128:135], v0
  ds_read_b128 v[92:95], v2 offset:1024
  v_smfmac_f32_16x16x64_bf16 v[20:23], v[100:103], v[144:151], v0
  ds_read_b128 v[96:99], v1 offset:1024
  buffer_load_dwordx4 v9, s[4:7], s27 offen sc1 lds
  v_smfmac_f32_16x16x64_bf16 v[24:27], v[100:103], v[68:75], v0
  s_waitcnt vmcnt(1) lgkmcnt(3)
  ds_read_b128 v[116:119], v2 offset:0
  s_mov_b32 m0, s32
  v_smfmac_f32_16x16x64_bf16 v[16:19], v[120:123], v[136:143], v0
  ds_read_b128 v[124:127], v1 offset:0
  v_smfmac_f32_16x16x64_bf16 v[20:23], v[120:123], v[152:159], v0
  s_waitcnt lgkmcnt(4)
  ds_read_b128 v[104:107], v2 offset:6144
  v_smfmac_f32_16x16x64_bf16 v[24:27], v[120:123], v[76:83], v0
  s_waitcnt lgkmcnt(4)
  ds_read_b128 v[108:111], v1 offset:6144
  buffer_load_dwordx4 v9, s[4:7], s27 offen offset:128 sc1 lds
  v_smfmac_f32_16x16x64_bf16 v[16:19], v[92:95], v[160:167], v0
  s_waitcnt lgkmcnt(4)
  ds_read_b128 v[112:115], v2 offset:5120
  s_mov_b32 m0, s33
  v_smfmac_f32_16x16x64_bf16 v[16:19], v[96:99], v[168:175], v0
  s_waitcnt lgkmcnt(4)
  ds_read_b128 v[84:87], v1 offset:5120
  v_smfmac_f32_16x16x64_bf16 v[16:19], v[116:119], v[192:199], v0
  s_waitcnt lgkmcnt(4)
  ds_read_b128 v[88:91], v2 offset:4096
  v_smfmac_f32_16x16x64_bf16 v[16:19], v[124:127], v[200:207], v0
  s_waitcnt lgkmcnt(4)
  ds_read_b128 v[100:103], v1 offset:4096
  buffer_load_dwordx4 v10, s[4:7], s28 offen sc1 lds
  v_smfmac_f32_16x16x64_bf16 v[16:19], v[104:107], a[16:23], v0
  s_waitcnt lgkmcnt(4)
  ds_read_b128 v[68:71], v4 offset:16384
  s_mov_b32 m0, s34
  v_smfmac_f32_16x16x64_bf16 v[16:19], v[108:111], a[24:31], v0
  s_waitcnt lgkmcnt(4)
  ds_read_b128 v[72:75], v4 offset:17408
  v_smfmac_f32_16x16x64_bf16 v[16:19], v[112:115], a[64:71], v0
  s_waitcnt lgkmcnt(4)
  ds_read_b128 v[76:79], v4 offset:18432
  v_smfmac_f32_16x16x64_bf16 v[16:19], v[84:87], a[72:79], v0
  s_waitcnt lgkmcnt(4)
  ds_read_b128 v[80:83], v4 offset:19456
  buffer_load_dwordx4 v10, s[4:7], s28 offen offset:256 sc1 lds
  v_smfmac_f32_16x16x64_bf16 v[16:19], v[88:91], a[112:119], v0
  s_waitcnt lgkmcnt(4)
  v_smfmac_f32_16x16x64_bf16 v[16:19], v[100:103], a[120:127], v0
  s_add_u32 s24, s36, 145752064
  s_add_u32 s25, s36, 145756160
  v_smfmac_f32_16x16x64_bf16 v[20:23], v[92:95], v[176:183], v0
  s_add_u32 s35, s36, s23
  v_smfmac_f32_16x16x64_bf16 v[20:23], v[96:99], v[184:191], v0
  s_waitcnt lgkmcnt(2)
  v_smfmac_f32_16x16x64_bf16 v[20:23], v[116:119], v[68:75], v0
  s_waitcnt lgkmcnt(0)
  ds_read_b128 v[68:71], v4 offset:20480
  v_mul_f32 v16, s18, v16
  v_smfmac_f32_16x16x64_bf16 v[20:23], v[124:127], v[76:83], v0
  ds_read_b128 v[72:75], v4 offset:21504
  v_mul_f32 v17, s18, v17
  v_smfmac_f32_16x16x64_bf16 v[20:23], v[104:107], a[32:39], v0
  ds_read_b128 v[76:79], v4 offset:22528
  v_mul_f32 v18, s18, v18
  v_smfmac_f32_16x16x64_bf16 v[20:23], v[108:111], a[40:47], v0
  ds_read_b128 v[80:83], v4 offset:23552
  v_mul_f32 v19, s18, v19
  v_smfmac_f32_16x16x64_bf16 v[20:23], v[112:115], a[80:87], v0
  v_cvt_pk_bf16_f32 v120, v16, v17
  v_smfmac_f32_16x16x64_bf16 v[20:23], v[84:87], a[88:95], v0
  v_cvt_pk_bf16_f32 v121, v18, v19
  v_smfmac_f32_16x16x64_bf16 v[20:23], v[88:91], a[128:135], v0
  ds_write_b64 v5, v[120:121] offset:24576
  v_smfmac_f32_16x16x64_bf16 v[20:23], v[100:103], a[136:143], v0
  s_waitcnt lgkmcnt(3)
  v_smfmac_f32_16x16x64_bf16 v[24:27], v[92:95], v[68:75], v0
  s_waitcnt lgkmcnt(1)
  v_mov_b64 v[92:93], 0
  v_smfmac_f32_16x16x64_bf16 v[24:27], v[96:99], v[76:83], v0
  s_nop 1
  v_cvt_pk_bf16_f32 v122, v20, v21
  v_cvt_pk_bf16_f32 v123, v22, v23
  v_smfmac_f32_16x16x64_bf16 v[24:27], v[116:119], v[208:215], v0
  ds_write_b64 v5, v[122:123] offset:26880
  v_mov_b64 v[94:95], 0
  v_smfmac_f32_16x16x64_bf16 v[24:27], v[124:127], v[216:223], v0
  s_waitcnt lgkmcnt(1)
  s_barrier
  ds_read_b64_tr_b16 v[68:69], v6 offset:24576
  v_smfmac_f32_16x16x64_bf16 v[24:27], v[104:107], a[48:55], v0
  s_add_u32 s27, s27, 8192
  ds_read_b64_tr_b16 v[70:71], v6 offset:24640
  ds_read_b64_tr_b16 v[72:73], v6 offset:24832
  v_smfmac_f32_16x16x64_bf16 v[24:27], v[108:111], a[56:63], v0
  s_add_u32 s28, s28, 8192
  ds_read_b64_tr_b16 v[74:75], v6 offset:24896
  ds_read_b64_tr_b16 v[76:77], v6 offset:25088
  v_smfmac_f32_16x16x64_bf16 v[24:27], v[112:115], a[96:103], v0
  s_nop 0
  ds_read_b64_tr_b16 v[78:79], v6 offset:25152
  ds_read_b64_tr_b16 v[80:81], v6 offset:25344
  v_smfmac_f32_16x16x64_bf16 v[24:27], v[84:87], a[104:111], v0
  ds_read_b64_tr_b16 v[82:83], v6 offset:25408
  v_mov_b64 v[96:97], 0
  v_smfmac_f32_16x16x64_bf16 v[24:27], v[88:91], a[144:151], v0
  s_waitcnt lgkmcnt(8)
  s_barrier
  ds_read_b64_tr_b16 v[116:117], v6 offset:26880
  v_smfmac_f32_16x16x64_bf16 v[24:27], v[100:103], a[152:159], v0
  s_waitcnt lgkmcnt(7)
  ds_read_b64_tr_b16 v[118:119], v6 offset:26944
  buffer_store_dwordx2 v[122:123], v5, s[4:7], s29 offen sc1
  v_mfma_f32_16x16x32_bf16 v[16:19], v[36:39], v[68:71], 0
  s_waitcnt lgkmcnt(6)
  ds_read_b64_tr_b16 v[124:125], v6 offset:27136
  ds_read_b64_tr_b16 v[126:127], v6 offset:27200
  v_mfma_f32_16x16x32_bf16 v[16:19], v[40:43], v[72:75], v[16:19]
  s_waitcnt lgkmcnt(6)
  ds_read_b64_tr_b16 v[104:105], v6 offset:27392
  ds_read_b64_tr_b16 v[106:107], v6 offset:27456
  v_mfma_f32_16x16x32_bf16 v[16:19], v[44:47], v[76:79], v[16:19]
  s_waitcnt lgkmcnt(6)
  ds_read_b64_tr_b16 v[108:109], v6 offset:27648
  ds_read_b64_tr_b16 v[110:111], v6 offset:27712
  v_mfma_f32_16x16x32_bf16 v[16:19], v[48:51], v[80:83], v[16:19]
  s_waitcnt lgkmcnt(6)
  s_mov_b32 m0, 32256
  v_cvt_pk_bf16_f32 v120, v24, v25
  v_cvt_pk_bf16_f32 v121, v26, v27
  v_mfma_f32_16x16x32_bf16 v[112:115], v[116:119], v[68:71], 0
  s_waitcnt lgkmcnt(4)
  buffer_load_dword v3, s[4:7], s99 offen sc1 lds
  buffer_store_dwordx2 v[120:121], v5, s[4:7], s29 offen offset:2304 sc1
  v_mov_b64 v[98:99], 0
  v_mfma_f32_16x16x32_bf16 v[112:115], v[124:127], v[72:75], v[112:115]
  s_waitcnt lgkmcnt(2)
  v_mov_b64 v[36:37], 0
  v_exp_f32 v100, v16
  v_mfma_f32_16x16x32_bf16 v[112:115], v[104:107], v[76:79], v[112:115]
  s_waitcnt lgkmcnt(0)
  v_exp_f32 v101, v17
  v_mfma_f32_16x16x32_bf16 v[112:115], v[108:111], v[80:83], v[112:115]
  s_add_u32 s29, s29, 147456
  v_exp_f32 v102, v18
  v_mfma_f32_16x16x32_bf16 v[20:23], v[52:55], v[68:71], 0
  s_cmp_eq_u32 s14, 63
  v_exp_f32 v103, v19
  v_mfma_f32_16x16x32_bf16 v[20:23], v[56:59], v[72:75], v[20:23]
  s_cbranch_scc1 M_tdone
  v_cvt_pk_bf16_f32 v44, v100, v101
  v_cvt_pk_bf16_f32 v45, v102, v103
  v_mfma_f32_16x16x32_bf16 v[20:23], v[60:63], v[76:79], v[20:23]
  v_exp_f32 v100, v112
  v_mfma_f32_16x16x32_bf16 v[20:23], v[64:67], v[80:83], v[20:23]
  v_exp_f32 v101, v113
  v_exp_f32 v102, v114
  v_exp_f32 v103, v115
  v_cvt_pk_bf16_f32 v84, v100, v101
  v_cvt_pk_bf16_f32 v85, v102, v103
  v_cndmask_b32 v48, v84, 0, s[16:17]
  v_cndmask_b32 v49, v85, 0, s[16:17]
  v_cndmask_b32 v50, 0, v84, s[16:17]
  v_cndmask_b32 v51, 0, v85, s[16:17]
  v_exp_f32 v100, v20
  v_mfma_f32_16x16x16_bf16 v[88:91], v[12:13], v[48:49], 0
  v_exp_f32 v101, v21
  v_mfma_f32_16x16x16_bf16 v[24:27], v[120:121], v[48:49], 0
  v_exp_f32 v102, v22
  v_mfma_f32_16x16x16_bf16 v[116:119], v[120:121], v[50:51], 0
  v_exp_f32 v103, v23
  v_cvt_pk_bf16_f32 v46, v100, v101
  v_cvt_pk_bf16_f32 v47, v102, v103
  v_mov_b64 v[38:39], 0
  s_nop 0
  v_mfma_f32_16x16x32_bf16 v[88:91], v[12:15], v[44:47], v[88:91]
  v_mov_b64 v[40:41], 0
  v_mov_b64 v[42:43], 0
  v_mfma_f32_16x16x32_bf16 v[24:27], v[28:31], v[44:47], v[24:27]
  ds_read_b128 v[52:55], v4 offset:24576
  ds_read_b128 v[56:59], v4 offset:25600
  v_mfma_f32_16x16x32_bf16 v[116:119], v[32:35], v[44:47], v[116:119]
  s_nop 1
  v_rcp_f32 v89, v88
  v_subrev_u32 v100, s54, v88
  v_cmp_le_u32 vcc, s55, v100
  v_mul_f32 v24, v89, v24
  v_mul_f32 v25, v89, v25
  s_cbranch_vccnz T_slow_182
T_back_183:
  v_cvt_pk_bf16_f32 v124, v24, v25
  v_pk_mul_f32 v[26:27], v[26:27], v[88:89] op_sel:[0,1] op_sel_hi:[1,1]
  v_pk_mul_f32 v[116:117], v[116:117], v[88:89] op_sel:[0,1] op_sel_hi:[1,1]
  v_pk_mul_f32 v[118:119], v[118:119], v[88:89] op_sel:[0,1] op_sel_hi:[1,1]
  v_cvt_pk_bf16_f32 v125, v26, v27
  v_cvt_pk_bf16_f32 v126, v116, v117
  v_cvt_pk_bf16_f32 v127, v118, v119
  ds_write_b128 v11, v[124:127] offset:30720
  s_nop 0
  v_smfmac_f32_16x16x64_bf16 v[92:95], v[124:127], a[160:167], v0
  v_smfmac_f32_16x16x64_bf16 v[96:99], v[124:127], a[168:175], v0
  v_smfmac_f32_16x16x64_bf16 v[36:39], v[124:127], a[176:183], v0
  v_smfmac_f32_16x16x64_bf16 v[40:43], v[124:127], a[184:191], v0
  s_waitcnt lgkmcnt(0)
  s_barrier
  ds_read_b128 v[104:107], v11 offset:30208
  ds_read_b128 v[108:111], v11 offset:29696
  ds_read_b128 v[68:71], v11 offset:29184
  s_waitcnt lgkmcnt(2)
  v_smfmac_f32_16x16x64_bf16 v[92:95], v[104:107], a[192:199], v0
  s_waitcnt lgkmcnt(1)
  ds_read_b128 v[76:79], v4 offset:28672
  v_smfmac_f32_16x16x64_bf16 v[92:95], v[108:111], a[224:231], v0
  s_waitcnt lgkmcnt(1)
  ds_read_b128 v[80:83], v4 offset:29696
  v_smfmac_f32_16x16x64_bf16 v[92:95], v[68:71], a[240:247], v0
  ds_read_b128 v[60:63], v4 offset:26624
  v_smfmac_f32_16x16x64_bf16 v[96:99], v[104:107], a[200:207], v0
  ds_read_b128 v[64:67], v4 offset:27648
  v_smfmac_f32_16x16x64_bf16 v[96:99], v[108:111], a[232:239], v0
  ds_read_b128 v[28:31], v4 offset:30720
  s_nop 0
  v_cvt_pk_bf16_f32 v16, v92, v93
  v_cvt_pk_bf16_f32 v17, v94, v95
  v_bfi_b32 v16, 1, s57, v16
  v_smfmac_f32_16x16x64_bf16 v[96:99], v[68:71], a[248:255], v0
  buffer_store_dwordx2 v[16:17], v7, s[4:7], s20 offen offset:0 sc1
  v_smfmac_f32_16x16x64_bf16 v[36:39], v[104:107], a[208:215], v0
  ds_read_b128 v[32:35], v4 offset:31744
  v_smfmac_f32_16x16x64_bf16 v[36:39], v[108:111], v[52:59], v0
  s_waitcnt lgkmcnt(4)
  s_nop 0
  v_cvt_pk_bf16_f32 v18, v96, v97
  v_cvt_pk_bf16_f32 v19, v98, v99
  v_bfi_b32 v18, 1, s57, v18
  v_smfmac_f32_16x16x64_bf16 v[36:39], v[68:71], v[76:83], v0
  buffer_store_dwordx2 v[18:19], v7, s[4:7], s20 offen offset:64 sc1
  v_smfmac_f32_16x16x64_bf16 v[40:43], v[104:107], a[216:223], v0
  s_waitcnt lgkmcnt(2)
  v_smfmac_f32_16x16x64_bf16 v[40:43], v[108:111], v[60:67], v0
  s_waitcnt lgkmcnt(0)
  s_nop 0
  v_cvt_pk_bf16_f32 v20, v36, v37
  v_cvt_pk_bf16_f32 v21, v38, v39
  v_bfi_b32 v20, 1, s57, v20
  v_smfmac_f32_16x16x64_bf16 v[40:43], v[68:71], v[28:35], v0
  buffer_store_dwordx2 v[20:21], v7, s[4:7], s21 offen offset:0 sc1
  s_nop 6
  v_cvt_pk_bf16_f32 v22, v40, v41
  v_cvt_pk_bf16_f32 v23, v42, v43
  v_bfi_b32 v22, 1, s57, v22
  buffer_store_dwordx2 v[22:23], v7, s[4:7], s21 offen offset:64 sc1
  ds_read_b128 v[68:71], v4 offset:0
  ds_read_b128 v[72:75], v4 offset:1024
  ds_read_b128 v[76:79], v4 offset:4096
  ds_read_b128 v[80:83], v4 offset:5120
  ds_read_b128 v[84:87], v4 offset:8192
  ds_read_b128 v[88:91], v4 offset:9216
  ds_read_b128 v[92:95], v4 offset:2048
  ds_read_b128 v[96:99], v4 offset:3072
  ds_read_b128 v[100:103], v4 offset:6144
  ds_read_b128 v[104:107], v4 offset:7168
  ds_read_b128 v[108:111], v4 offset:10240
  ds_read_b128 v[112:115], v4 offset:11264
  v_mov_b64 v[16:17], 0
  v_mov_b64 v[18:19], 0
  v_mov_b64 v[20:21], 0
  v_mov_b64 v[22:23], 0
  v_mov_b64 v[24:25], 0
  v_mov_b64 v[26:27], 0
  ds_read_b64 v[44:45], v2 offset:32256
  s_waitcnt lgkmcnt(0)
  v_readfirstlane_b32 s38, v44
  v_readfirstlane_b32 s37, v45
  s_nop 0
  s_add_u32 s37, s37, 30
  s_cmp_ge_u32 s38, 30
  s_cselect_b32 s38, s37, s38
  s_cmp_ge_u32 s38, 64
  s_cselect_b32 s38, 100, s38
  s_sub_u32 s38, s38, 1
  s_max_i32 s30, s30, s38
  s_waitcnt vmcnt(4)
  s_barrier
  ds_read_b128 v[28:31], v2 offset:19456
  ds_read_b128 v[32:35], v2 offset:23552
  ds_read_b128 v[36:39], v2 offset:8192
  ds_read_b128 v[40:43], v2 offset:9216
  ds_read_b128 v[44:47], v2 offset:10240
  ds_read_b128 v[48:51], v2 offset:11264
  buffer_load_dwordx4 v[124:127], v2, s[4:7], s24 offen offset:3072 sc1
  buffer_load_dwordx4 v[116:119], v2, s[4:7], s25 offen offset:3072 sc1
  ds_read_b128 v[52:55], v2 offset:12288
  ds_read_b128 v[56:59], v2 offset:13312
  ds_read_b128 v[60:63], v2 offset:14336
  ds_read_b128 v[64:67], v2 offset:15360
  buffer_load_dwordx4 v[124:127], v2, s[4:7], s24 offen offset:3072 sc1
  buffer_load_dwordx4 v[116:119], v2, s[4:7], s25 offen offset:3072 sc1
  s_mov_b32 s19, 0
  s_branch T_loop_176
T_kvw_180:
  s_mov_b32 s19, 0
  s_branch T_kvok_188
T_kv_187:
  s_sleep 4
  s_add_u32 s19, s19, 1
  s_cmp_gt_u32 s19, 32768
  s_cbranch_scc1 M_exit
T_kvok_188:
  s_add_u32 s39, s99, 128
  s_mov_b32 s38, 0
  s_mov_b32 s37, 0
  s_atomic_or s38, s[58:59], s99 glc
  s_atomic_or s37, s[58:59], s39 glc
  s_waitcnt lgkmcnt(0)
  s_add_u32 s37, s37, 30
  s_cmp_ge_u32 s38, 30
  s_cselect_b32 s38, s37, s38
  s_cmp_ge_u32 s38, 64
  s_cselect_b32 s38, 100, s38
  s_sub_u32 s38, s38, 1
  s_max_i32 s30, s30, s38
  s_cmp_ge_i32 s14, s30
  s_cbranch_scc1 T_kv_187
  s_branch T_kvb_181
T_slow_182:
  s_nop 7
  v_max3_f32 v100, v16, v17, v18
  v_max3_f32 v100, v100, v19, v20
  v_max3_f32 v100, v100, v21, v22
  v_max3_f32 v100, v100, v23, v112
  v_max3_f32 v100, v100, v113, v114
  v_max_f32 v100, v100, v115
  v_mov_b32 v101, v100
  s_nop 1
  v_permlane32_swap_b32 v100, v101
  s_nop 1
  v_max_f32 v100, v100, v101
  v_mov_b32 v101, v100
  s_nop 1
  v_permlane16_swap_b32 v100, v101
  s_nop 1
  v_max_f32 v100, v100, v101
  v_sub_f32 v16, v16, v100
  v_sub_f32 v17, v17, v100
  v_sub_f32 v18, v18, v100
  v_sub_f32 v19, v19, v100
  v_exp_f32 v16, v16
  v_exp_f32 v17, v17
  v_exp_f32 v18, v18
  v_exp_f32 v19, v19
  v_sub_f32 v20, v20, v100
  v_sub_f32 v21, v21, v100
  v_sub_f32 v22, v22, v100
  v_sub_f32 v23, v23, v100
  v_exp_f32 v20, v20
  v_exp_f32 v21, v21
  v_exp_f32 v22, v22
  v_exp_f32 v23, v23
  v_sub_f32 v112, v112, v100
  v_sub_f32 v113, v113, v100
  v_sub_f32 v114, v114, v100
  v_sub_f32 v115, v115, v100
  v_exp_f32 v112, v112
  v_exp_f32 v113, v113
  v_exp_f32 v114, v114
  v_exp_f32 v115, v115
  s_nop 0
  v_cvt_pk_bf16_f32 v44, v16, v17
  v_cvt_pk_bf16_f32 v45, v18, v19
  v_cvt_pk_bf16_f32 v46, v20, v21
  v_cvt_pk_bf16_f32 v47, v22, v23
  v_cvt_pk_bf16_f32 v84, v112, v113
  v_cvt_pk_bf16_f32 v85, v114, v115
  v_cndmask_b32 v48, v84, 0, s[16:17]
  v_cndmask_b32 v49, v85, 0, s[16:17]
  v_cndmask_b32 v50, 0, v84, s[16:17]
  v_cndmask_b32 v51, 0, v85, s[16:17]
  s_nop 1
  v_mfma_f32_16x16x16_bf16 v[88:91], v[12:13], v[48:49], 0
  v_mfma_f32_16x16x16_bf16 v[24:27], v[120:121], v[48:49], 0
  v_mfma_f32_16x16x16_bf16 v[116:119], v[120:121], v[50:51], 0
  v_mfma_f32_16x16x32_bf16 v[88:91], v[12:15], v[44:47], v[88:91]
  v_mfma_f32_16x16x32_bf16 v[24:27], v[28:31], v[44:47], v[24:27]
  v_mfma_f32_16x16x32_bf16 v[116:119], v[32:35], v[44:47], v[116:119]
  s_nop 7
  s_nop 1
  v_rcp_f32 v89, v88
  s_nop 0
  v_mul_f32 v24, v89, v24
  v_mul_f32 v25, v89, v25
  s_branch T_back_183
M_tdone:
  v_mov_b32 v16, 64
  v_or_b32 v17, s13, v2
  v_min_u32 v17, 1, v17
  v_lshlrev_b32 v17, 30, v17
  s_waitcnt vmcnt(0)
  s_barrier
  buffer_store_dword v16, v17, s[4:7], s15 offen sc1
M_done:
M_exit:
  s_endpgm
.p2align 6
.type M_table,@object
M_table:
.long 0x1, 0x3f, 0xffffffff, 0x17, 0x1, 0x7, 0x800, 0x0, 0x8, 0x0, 0x0, 0x0, 0x0, 0x0, 0x0, 0x0
.long 0x1, 0x28, 0xffffffff, 0x1b, 0x1, 0x6, 0x1000, 0x0, 0x8, 0x1, 0x0, 0x0, 0x0, 0x0, 0x0, 0x0
.long 0x2, 0x0, 0x1, 0x1e, 0x1, 0x5, 0x1800, 0x0, 0x8, 0x0, 0x0, 0x0, 0x0, 0x0, 0x0, 0x0
.long 0x2, 0x1e, 0x1, 0x22, 0x1, 0x4, 0x2000, 0x0, 0x8, 0x1, 0x0, 0x0, 0x0, 0x0, 0x0, 0x0
.long 0x0, 0x0, 0x1, 0x20, 0x2, 0x3, 0x20, 0x0, 0x8, 0x2, 0x0, 0x0, 0x0, 0x0, 0x0, 0x0
.long 0x0, 0x3f, 0xffffffff, 0x20, 0x2, 0x2, 0x18, 0x1, 0x10, 0x0, 0x0, 0x0, 0x0, 0x0, 0x0, 0x0
.long 0x1, 0xd, 0xffffffff, 0xe, 0x0, 0x0, 0x8, 0x0, 0x8, 0x2, 0x0, 0x0, 0x0, 0x0, 0x0, 0x0
.size M_table, 448
.section .rodata,"a"
.p2align 6
.amdhsa_kernel gated_mix__compressed_kv_cla__memory_aug_recurrent_mem_tr__prompt_kernel
.amdhsa_next_free_vgpr 512
.amdhsa_next_free_sgpr 102
.amdhsa_accum_offset 256
.amdhsa_group_segment_fixed_size 0
.amdhsa_kernarg_size 136
.amdhsa_user_sgpr_count 2
.amdhsa_user_sgpr_kernarg_segment_ptr 1
.amdhsa_system_sgpr_workgroup_id_x 1
.end_amdhsa_kernel
```

```asm
; @launch grid=(256,1,1) block=(256,1,1) lds=163840
.amdgcn_target "amdgcn-amd-amdhsa--gfx950"
.text
.globl gated_mix__compressed_kv_cla__memory_aug_recurrent_mem_tr__prompt_kernel
.p2align 8
.type gated_mix__compressed_kv_cla__memory_aug_recurrent_mem_tr__prompt_kernel,@function
gated_mix__compressed_kv_cla__memory_aug_recurrent_mem_tr__prompt_kernel:
  s_cmp_ge_u32 s2, 256
  s_cbranch_scc1 M_exit
  s_load_dwordx4 s[72:75], s[0:1], 120
  v_lshrrev_b32 v3, 6, v0
  v_and_b32 v1, 63, v0
  v_readfirstlane_b32 s16, v3
  v_lshlrev_b32 v2, 4, v1
  s_and_b32 s76, s2, 7
  s_lshr_b32 s77, s2, 3
  s_sub_u32 s66, s76, 1
  s_and_b32 s66, s66, 7
  s_lshl_b32 s66, s66, 5
  s_add_u32 s66, s66, s77
  s_lshl_b32 s31, s66, 7
  s_add_u32 s31, s31, 148897792
  s_waitcnt lgkmcnt(0)
  s_mov_b64 s[4:5], s[74:75]
  s_mov_b64 s[74:75], s[72:73]
  s_mov_b64 s[72:73], s[4:5]
  s_and_b32 s5, s5, 0xffff
  s_mov_b32 s6, 268435456
  s_mov_b32 s7, 0x20000
  s_cmp_eq_u32 s76, 0
  s_cbranch_scc1 M_team
  s_mul_i32 s64, s66, 9363
  s_lshr_b32 s64, s64, 16
  s_mul_i32 s67, s64, 7
  s_sub_u32 s65, s66, s67
  s_lshl_b32 s67, s67, 7
  s_add_u32 s67, s67, 148897792
  s_getpc_b64 s[76:77]
M_pc:
  s_add_u32 s76, s76, M_table-M_pc
  s_addc_u32 s77, s77, 0
  s_lshl_b32 s26, s65, 6
  s_load_dwordx16 s[48:63], s[76:77], s26
  s_waitcnt lgkmcnt(0)
  s_mov_b32 s23, s51
  s_cmp_lg_u32 s48, 1
  s_cbranch_scc1 M_nobpf
  s_load_dwordx8 s[36:43], s[0:1], 64
  s_mul_i32 s76, s64, 3
  s_add_u32 s76, s76, s57
  v_lshlrev_b32 v4, 7, v0
  s_mov_b32 s10, 4194304
  s_mov_b32 s11, 0x20000
  s_waitcnt lgkmcnt(0)
  s_mov_b32 s8, s42
  s_and_b32 s9, s43, 0xffff
  s_mul_i32 s77, s76, 43776
  s_add_u32 s77, s77, 0
  v_min_u32 v5, 32640, v4
  v_add_u32 v5, s77, v5
  s_add_u32 s77, s77, 32768
  buffer_load_dword v6, v5, s[8:11], 0 offen
  v_min_u32 v5, 10880, v4
  v_add_u32 v5, s77, v5
  s_add_u32 s77, s77, 32768
  buffer_load_dword v6, v5, s[8:11], 0 offen
  s_mov_b32 s8, s38
  s_and_b32 s9, s39, 0xffff
  s_mul_i32 s77, s76, 21888
  s_add_u32 s77, s77, 2097152
  v_min_u32 v5, 21760, v4
  v_add_u32 v5, s77, v5
  s_add_u32 s77, s77, 32768
  buffer_load_dword v6, v5, s[8:11], 0 offen
  s_mov_b32 s8, s40
  s_and_b32 s9, s41, 0xffff
  s_mul_i32 s77, s76, 21888
  s_add_u32 s77, s77, 2097152
  v_min_u32 v5, 21760, v4
  v_add_u32 v5, s77, v5
  s_add_u32 s77, s77, 32768
  buffer_load_dword v6, v5, s[8:11], 0 offen
  s_mov_b32 s8, s36
  s_and_b32 s9, s37, 0xffff
  s_mul_i32 s77, s76, 21888
  s_add_u32 s77, s77, 2097152
  v_min_u32 v5, 21760, v4
  v_add_u32 v5, s77, v5
  s_add_u32 s77, s77, 32768
  buffer_load_dword v6, v5, s[8:11], 0 offen
  s_waitcnt vmcnt(0)
M_nobpf:
  s_lshr_b32 s29, s16, 1
  s_cmp_eq_u32 s29, 0
  s_cselect_b32 s26, 2, 8
  s_cselect_b32 s27, 3, 4
  s_cselect_b32 s28, 9, 10
  s_cmp_eq_u32 s48, 1
  s_cselect_b32 s26, s27, s26
  s_cmp_eq_u32 s48, 2
  s_cselect_b32 s26, s28, s26
  s_lshl_b32 s26, s26, 3
  s_load_dwordx2 s[8:9], s[0:1], s26
  s_cmp_eq_u32 s48, 1
  s_cselect_b32 s26, 8, 0
  s_load_dwordx2 s[12:13], s[0:1], s26
  s_cmp_eq_u32 s29, 0
  s_cselect_b32 s21, 0, 3
  s_cselect_b32 s27, 1, 2
  s_cselect_b32 s28, 4, 5
  s_cmp_eq_u32 s48, 1
  s_cselect_b32 s21, s27, s21
  s_cmp_eq_u32 s48, 2
  s_cselect_b32 s21, s28, s21
  s_lshl_b32 s21, s21, 5
  s_add_u32 s21, s21, s64
  s_lshl_b32 s21, s21, 6
  s_add_u32 s21, s21, s49
  s_and_b32 s27, s16, 1
  s_lshl_b32 s21, s21, 1
  s_add_u32 s21, s21, s27
  s_lshl_b32 s21, s21, 12
  s_lshl_b32 s22, s50, 13
  s_lshl_b32 s19, s49, 15
  s_lshl_b32 s20, s50, 15
  s_lshl_b32 s17, s64, 1
  s_add_u32 s17, s17, s27
  s_lshl_b32 s17, s17, 7
  s_mov_b32 s18, 8192
  s_cmp_eq_u32 s48, 0
  s_cselect_b32 s24, 0x3e0293ee, 1.0
  s_waitcnt lgkmcnt(0)
  s_and_b32 s9, s9, 0xffff
  s_mov_b32 s10, 4194304
  s_mov_b32 s11, 0x20000
  s_and_b32 s13, s13, 0xffff
  s_mov_b32 s14, 2097152
  s_mov_b32 s15, 0x20000
  v_and_b32 v144, 31, v1
  v_lshrrev_b32 v145, 5, v1
  v_and_b32 v146, 15, v1
  v_or_b32 v147, 0, v145
  v_xor_b32 v147, v147, v146
  v_lshlrev_b32 v147, 4, v147
  v_lshl_add_u32 v8, v144, 8, v147
  v_or_b32 v147, 2, v145
  v_xor_b32 v147, v147, v146
  v_lshlrev_b32 v147, 4, v147
  v_lshl_add_u32 v9, v144, 8, v147
  v_or_b32 v147, 4, v145
  v_xor_b32 v147, v147, v146
  v_lshlrev_b32 v147, 4, v147
  v_lshl_add_u32 v10, v144, 8, v147
  v_or_b32 v147, 6, v145
  v_xor_b32 v147, v147, v146
  v_lshlrev_b32 v147, 4, v147
  v_lshl_add_u32 v11, v144, 8, v147
  v_or_b32 v147, 8, v145
  v_xor_b32 v147, v147, v146
  v_lshlrev_b32 v147, 4, v147
  v_lshl_add_u32 v12, v144, 8, v147
  v_or_b32 v147, 10, v145
  v_xor_b32 v147, v147, v146
  v_lshlrev_b32 v147, 4, v147
  v_lshl_add_u32 v13, v144, 8, v147
  v_or_b32 v147, 12, v145
  v_xor_b32 v147, v147, v146
  v_lshlrev_b32 v147, 4, v147
  v_lshl_add_u32 v14, v144, 8, v147
  v_or_b32 v147, 14, v145
  v_xor_b32 v147, v147, v146
  v_lshlrev_b32 v147, 4, v147
  v_lshl_add_u32 v15, v144, 8, v147
  v_lshrrev_b32 v144, 4, v1
  s_lshl_b32 s26, s16, 8
  v_add_u32 v145, 0, v144
  v_and_b32 v147, 15, v145
  v_xor_b32 v147, v147, v146
  v_lshlrev_b32 v147, 4, v147
  v_lshl_add_u32 v147, v145, 10, v147
  v_add_u32 v16, s26, v147
  v_add_u32 v145, 4, v144
  v_and_b32 v147, 15, v145
  v_xor_b32 v147, v147, v146
  v_lshlrev_b32 v147, 4, v147
  v_lshl_add_u32 v147, v145, 10, v147
  v_add_u32 v17, s26, v147
  v_add_u32 v145, 8, v144
  v_and_b32 v147, 15, v145
  v_xor_b32 v147, v147, v146
  v_lshlrev_b32 v147, 4, v147
  v_lshl_add_u32 v147, v145, 10, v147
  v_add_u32 v18, s26, v147
  v_add_u32 v145, 12, v144
  v_and_b32 v147, 15, v145
  v_xor_b32 v147, v147, v146
  v_lshlrev_b32 v147, 4, v147
  v_lshl_add_u32 v147, v145, 10, v147
  v_add_u32 v19, s26, v147
  v_add_u32 v145, 16, v144
  v_and_b32 v147, 15, v145
  v_xor_b32 v147, v147, v146
  v_lshlrev_b32 v147, 4, v147
  v_lshl_add_u32 v147, v145, 10, v147
  v_add_u32 v20, s26, v147
  v_add_u32 v145, 20, v144
  v_and_b32 v147, 15, v145
  v_xor_b32 v147, v147, v146
  v_lshlrev_b32 v147, 4, v147
  v_lshl_add_u32 v147, v145, 10, v147
  v_add_u32 v21, s26, v147
  v_add_u32 v145, 24, v144
  v_and_b32 v147, 15, v145
  v_xor_b32 v147, v147, v146
  v_lshlrev_b32 v147, 4, v147
  v_lshl_add_u32 v147, v145, 10, v147
  v_add_u32 v22, s26, v147
  v_add_u32 v145, 28, v144
  v_and_b32 v147, 15, v145
  v_xor_b32 v147, v147, v146
  v_lshlrev_b32 v147, 4, v147
  v_lshl_add_u32 v147, v145, 10, v147
  v_add_u32 v23, s26, v147
  v_lshrrev_b32 v144, 3, v1
  v_mul_lo_u32 v144, v144, s18
  v_and_b32 v145, 7, v1
  v_lshl_add_u32 v144, v145, 4, v144
  s_lshl_b32 s28, s16, 15
  s_add_u32 s28, s28, 32768
  s_lshl_b32 s29, s18, 3
  s_add_u32 m0, s28, 0
  s_nop 0
  buffer_load_dwordx4 v144, s[8:11], s17 offen lds
  s_add_u32 s17, s17, s29
  s_add_u32 m0, s28, 1024
  s_nop 0
  buffer_load_dwordx4 v144, s[8:11], s17 offen lds
  s_add_u32 s17, s17, s29
  s_add_u32 m0, s28, 2048
  s_nop 0
  buffer_load_dwordx4 v144, s[8:11], s17 offen lds
  s_add_u32 s17, s17, s29
  s_add_u32 m0, s28, 3072
  s_nop 0
  buffer_load_dwordx4 v144, s[8:11], s17 offen lds
  s_add_u32 s17, s17, s29
  s_add_u32 m0, s28, 4096
  s_nop 0
  buffer_load_dwordx4 v144, s[8:11], s17 offen lds
  s_add_u32 s17, s17, s29
  s_add_u32 m0, s28, 5120
  s_nop 0
  buffer_load_dwordx4 v144, s[8:11], s17 offen lds
  s_add_u32 s17, s17, s29
  s_add_u32 m0, s28, 6144
  s_nop 0
  buffer_load_dwordx4 v144, s[8:11], s17 offen lds
  s_add_u32 s17, s17, s29
  s_add_u32 m0, s28, 7168
  s_nop 0
  buffer_load_dwordx4 v144, s[8:11], s17 offen lds
  s_add_u32 s17, s17, s29
  s_add_u32 m0, s28, 8192
  s_nop 0
  buffer_load_dwordx4 v144, s[8:11], s17 offen lds
  s_add_u32 s17, s17, s29
  s_add_u32 m0, s28, 9216
  s_nop 0
  buffer_load_dwordx4 v144, s[8:11], s17 offen lds
  s_add_u32 s17, s17, s29
  s_add_u32 m0, s28, 10240
  s_nop 0
  buffer_load_dwordx4 v144, s[8:11], s17 offen lds
  s_add_u32 s17, s17, s29
  s_add_u32 m0, s28, 11264
  s_nop 0
  buffer_load_dwordx4 v144, s[8:11], s17 offen lds
  s_add_u32 s17, s17, s29
  s_add_u32 m0, s28, 12288
  s_nop 0
  buffer_load_dwordx4 v144, s[8:11], s17 offen lds
  s_add_u32 s17, s17, s29
  s_add_u32 m0, s28, 13312
  s_nop 0
  buffer_load_dwordx4 v144, s[8:11], s17 offen lds
  s_add_u32 s17, s17, s29
  s_add_u32 m0, s28, 14336
  s_nop 0
  buffer_load_dwordx4 v144, s[8:11], s17 offen lds
  s_add_u32 s17, s17, s29
  s_add_u32 m0, s28, 15360
  s_nop 0
  buffer_load_dwordx4 v144, s[8:11], s17 offen lds
  s_add_u32 s17, s17, s29
  s_add_u32 m0, s28, 16384
  s_nop 0
  buffer_load_dwordx4 v144, s[8:11], s17 offen lds
  s_add_u32 s17, s17, s29
  s_add_u32 m0, s28, 17408
  s_nop 0
  buffer_load_dwordx4 v144, s[8:11], s17 offen lds
  s_add_u32 s17, s17, s29
  s_add_u32 m0, s28, 18432
  s_nop 0
  buffer_load_dwordx4 v144, s[8:11], s17 offen lds
  s_add_u32 s17, s17, s29
  s_add_u32 m0, s28, 19456
  s_nop 0
  buffer_load_dwordx4 v144, s[8:11], s17 offen lds
  s_add_u32 s17, s17, s29
  s_add_u32 m0, s28, 20480
  s_nop 0
  buffer_load_dwordx4 v144, s[8:11], s17 offen lds
  s_add_u32 s17, s17, s29
  s_add_u32 m0, s28, 21504
  s_nop 0
  buffer_load_dwordx4 v144, s[8:11], s17 offen lds
  s_add_u32 s17, s17, s29
  s_add_u32 m0, s28, 22528
  s_nop 0
  buffer_load_dwordx4 v144, s[8:11], s17 offen lds
  s_add_u32 s17, s17, s29
  s_add_u32 m0, s28, 23552
  s_nop 0
  buffer_load_dwordx4 v144, s[8:11], s17 offen lds
  s_add_u32 s17, s17, s29
  s_add_u32 m0, s28, 24576
  s_nop 0
  buffer_load_dwordx4 v144, s[8:11], s17 offen lds
  s_add_u32 s17, s17, s29
  s_add_u32 m0, s28, 25600
  s_nop 0
  buffer_load_dwordx4 v144, s[8:11], s17 offen lds
  s_add_u32 s17, s17, s29
  s_add_u32 m0, s28, 26624
  s_nop 0
  buffer_load_dwordx4 v144, s[8:11], s17 offen lds
  s_add_u32 s17, s17, s29
  s_add_u32 m0, s28, 27648
  s_nop 0
  buffer_load_dwordx4 v144, s[8:11], s17 offen lds
  s_add_u32 s17, s17, s29
  s_add_u32 m0, s28, 28672
  s_nop 0
  buffer_load_dwordx4 v144, s[8:11], s17 offen lds
  s_add_u32 s17, s17, s29
  s_add_u32 m0, s28, 29696
  s_nop 0
  buffer_load_dwordx4 v144, s[8:11], s17 offen lds
  s_add_u32 s17, s17, s29
  s_add_u32 m0, s28, 30720
  s_nop 0
  buffer_load_dwordx4 v144, s[8:11], s17 offen lds
  s_add_u32 s17, s17, s29
  s_add_u32 m0, s28, 31744
  s_nop 0
  buffer_load_dwordx4 v144, s[8:11], s17 offen lds
  s_add_u32 s17, s17, s29
  s_lshl_b32 s25, s16, 13
  s_add_u32 m0, s25, 0
  s_nop 0
  buffer_load_dwordx4 v16, s[12:15], s19 offen lds
  s_add_u32 m0, s25, 1024
  s_nop 0
  buffer_load_dwordx4 v17, s[12:15], s19 offen lds
  s_add_u32 m0, s25, 2048
  s_nop 0
  buffer_load_dwordx4 v18, s[12:15], s19 offen lds
  s_add_u32 m0, s25, 3072
  s_nop 0
  buffer_load_dwordx4 v19, s[12:15], s19 offen lds
  s_add_u32 m0, s25, 4096
  s_nop 0
  buffer_load_dwordx4 v20, s[12:15], s19 offen lds
  s_add_u32 m0, s25, 5120
  s_nop 0
  buffer_load_dwordx4 v21, s[12:15], s19 offen lds
  s_add_u32 m0, s25, 6144
  s_nop 0
  buffer_load_dwordx4 v22, s[12:15], s19 offen lds
  s_add_u32 m0, s25, 7168
  s_nop 0
  buffer_load_dwordx4 v23, s[12:15], s19 offen lds
  s_cmp_gt_u32 s23, 1
  s_cselect_b32 s26, s20, 0
  s_add_u32 s19, s19, s26
  s_add_u32 s25, s25, 32768
  s_and_b32 s25, s25, 0x1ffff
  s_cmp_lg_u32 s16, 3
  s_cbranch_scc1 M_noinit
  s_mov_b32 s79, 0
  s_atomic_swap s79, s[72:73], s31 glc
  s_waitcnt lgkmcnt(0)
  s_mov_b32 s79, 1
  s_atomic_add s79, s[74:75], 128
M_noinit:
  s_mul_i32 s76, s64, 3
  s_add_u32 s76, s76, s57
  s_mul_i32 s76, s76, 24576
  v_lshlrev_b32 v4, 7, v0
  v_add_u32 v4, s76, v4
  buffer_load_dword v5, v4, s[12:15], 0 offen
  v_bfe_u32 v148, v1, 2, 2
  v_lshrrev_b32 v149, 5, v1
  v_lshl_add_u32 v148, v149, 3, v148
  v_lshlrev_b32 v148, 7, v148
  v_bfe_u32 v149, v1, 4, 1
  v_lshl_add_u32 v148, v149, 5, v148
  v_and_b32 v149, 3, v1
  v_lshl_add_u32 v148, v149, 3, v148
  v_add_u32 v146, s28, v148
  v_add_u32 v147, 512, v146
  s_waitcnt vmcnt(37)
  ds_read_b64_tr_b16 a[0:1], v146 offset:0
  ds_read_b64_tr_b16 a[2:3], v147 offset:0
  ds_read_b64_tr_b16 a[4:5], v146 offset:64
  ds_read_b64_tr_b16 a[6:7], v147 offset:64
  ds_read_b64_tr_b16 a[8:9], v146 offset:2048
  ds_read_b64_tr_b16 a[10:11], v147 offset:2048
  ds_read_b64_tr_b16 a[12:13], v146 offset:2112
  ds_read_b64_tr_b16 a[14:15], v147 offset:2112
  s_waitcnt lgkmcnt(0)
  s_add_u32 m0, s28, 0
  s_nop 0
  buffer_load_dwordx4 v144, s[8:11], s17 offen lds
  s_add_u32 s17, s17, s29
  s_add_u32 m0, s28, 1024
  s_nop 0
  buffer_load_dwordx4 v144, s[8:11], s17 offen lds
  s_add_u32 s17, s17, s29
  s_add_u32 m0, s28, 2048
  s_nop 0
  buffer_load_dwordx4 v144, s[8:11], s17 offen lds
  s_add_u32 s17, s17, s29
  s_add_u32 m0, s28, 3072
  s_nop 0
  buffer_load_dwordx4 v144, s[8:11], s17 offen lds
  s_add_u32 s17, s17, s29
  s_waitcnt vmcnt(37)
  ds_read_b64_tr_b16 a[16:17], v146 offset:4096
  ds_read_b64_tr_b16 a[18:19], v147 offset:4096
  ds_read_b64_tr_b16 a[20:21], v146 offset:4160
  ds_read_b64_tr_b16 a[22:23], v147 offset:4160
  ds_read_b64_tr_b16 a[24:25], v146 offset:6144
  ds_read_b64_tr_b16 a[26:27], v147 offset:6144
  ds_read_b64_tr_b16 a[28:29], v146 offset:6208
  ds_read_b64_tr_b16 a[30:31], v147 offset:6208
  s_waitcnt lgkmcnt(0)
  s_add_u32 m0, s28, 4096
  s_nop 0
  buffer_load_dwordx4 v144, s[8:11], s17 offen lds
  s_add_u32 s17, s17, s29
  s_add_u32 m0, s28, 5120
  s_nop 0
  buffer_load_dwordx4 v144, s[8:11], s17 offen lds
  s_add_u32 s17, s17, s29
  s_add_u32 m0, s28, 6144
  s_nop 0
  buffer_load_dwordx4 v144, s[8:11], s17 offen lds
  s_add_u32 s17, s17, s29
  s_add_u32 m0, s28, 7168
  s_nop 0
  buffer_load_dwordx4 v144, s[8:11], s17 offen lds
  s_add_u32 s17, s17, s29
  s_waitcnt vmcnt(37)
  ds_read_b64_tr_b16 a[32:33], v146 offset:8192
  ds_read_b64_tr_b16 a[34:35], v147 offset:8192
  ds_read_b64_tr_b16 a[36:37], v146 offset:8256
  ds_read_b64_tr_b16 a[38:39], v147 offset:8256
  ds_read_b64_tr_b16 a[40:41], v146 offset:10240
  ds_read_b64_tr_b16 a[42:43], v147 offset:10240
  ds_read_b64_tr_b16 a[44:45], v146 offset:10304
  ds_read_b64_tr_b16 a[46:47], v147 offset:10304
  s_waitcnt lgkmcnt(0)
  s_add_u32 m0, s28, 8192
  s_nop 0
  buffer_load_dwordx4 v144, s[8:11], s17 offen lds
  s_add_u32 s17, s17, s29
  s_add_u32 m0, s28, 9216
  s_nop 0
  buffer_load_dwordx4 v144, s[8:11], s17 offen lds
  s_add_u32 s17, s17, s29
  s_add_u32 m0, s28, 10240
  s_nop 0
  buffer_load_dwordx4 v144, s[8:11], s17 offen lds
  s_add_u32 s17, s17, s29
  s_add_u32 m0, s28, 11264
  s_nop 0
  buffer_load_dwordx4 v144, s[8:11], s17 offen lds
  s_add_u32 s17, s17, s29
  s_waitcnt vmcnt(37)
  ds_read_b64_tr_b16 a[48:49], v146 offset:12288
  ds_read_b64_tr_b16 a[50:51], v147 offset:12288
  ds_read_b64_tr_b16 a[52:53], v146 offset:12352
  ds_read_b64_tr_b16 a[54:55], v147 offset:12352
  ds_read_b64_tr_b16 a[56:57], v146 offset:14336
  ds_read_b64_tr_b16 a[58:59], v147 offset:14336
  ds_read_b64_tr_b16 a[60:61], v146 offset:14400
  ds_read_b64_tr_b16 a[62:63], v147 offset:14400
  s_waitcnt lgkmcnt(0)
  s_add_u32 m0, s28, 12288
  s_nop 0
  buffer_load_dwordx4 v144, s[8:11], s17 offen lds
  s_add_u32 s17, s17, s29
  s_add_u32 m0, s28, 13312
  s_nop 0
  buffer_load_dwordx4 v144, s[8:11], s17 offen lds
  s_add_u32 s17, s17, s29
  s_add_u32 m0, s28, 14336
  s_nop 0
  buffer_load_dwordx4 v144, s[8:11], s17 offen lds
  s_add_u32 s17, s17, s29
  s_add_u32 m0, s28, 15360
  s_nop 0
  buffer_load_dwordx4 v144, s[8:11], s17 offen lds
  s_add_u32 s17, s17, s29
  s_waitcnt vmcnt(37)
  ds_read_b64_tr_b16 a[64:65], v146 offset:16384
  ds_read_b64_tr_b16 a[66:67], v147 offset:16384
  ds_read_b64_tr_b16 a[68:69], v146 offset:16448
  ds_read_b64_tr_b16 a[70:71], v147 offset:16448
  ds_read_b64_tr_b16 a[72:73], v146 offset:18432
  ds_read_b64_tr_b16 a[74:75], v147 offset:18432
  ds_read_b64_tr_b16 a[76:77], v146 offset:18496
  ds_read_b64_tr_b16 a[78:79], v147 offset:18496
  s_waitcnt lgkmcnt(0)
  s_add_u32 m0, s28, 16384
  s_nop 0
  buffer_load_dwordx4 v144, s[8:11], s17 offen lds
  s_add_u32 s17, s17, s29
  s_add_u32 m0, s28, 17408
  s_nop 0
  buffer_load_dwordx4 v144, s[8:11], s17 offen lds
  s_add_u32 s17, s17, s29
  s_add_u32 m0, s28, 18432
  s_nop 0
  buffer_load_dwordx4 v144, s[8:11], s17 offen lds
  s_add_u32 s17, s17, s29
  s_add_u32 m0, s28, 19456
  s_nop 0
  buffer_load_dwordx4 v144, s[8:11], s17 offen lds
  s_add_u32 s17, s17, s29
  s_waitcnt vmcnt(37)
  ds_read_b64_tr_b16 a[80:81], v146 offset:20480
  ds_read_b64_tr_b16 a[82:83], v147 offset:20480
  ds_read_b64_tr_b16 a[84:85], v146 offset:20544
  ds_read_b64_tr_b16 a[86:87], v147 offset:20544
  ds_read_b64_tr_b16 a[88:89], v146 offset:22528
  ds_read_b64_tr_b16 a[90:91], v147 offset:22528
  ds_read_b64_tr_b16 a[92:93], v146 offset:22592
  ds_read_b64_tr_b16 a[94:95], v147 offset:22592
  s_waitcnt lgkmcnt(0)
  s_add_u32 m0, s28, 20480
  s_nop 0
  buffer_load_dwordx4 v144, s[8:11], s17 offen lds
  s_add_u32 s17, s17, s29
  s_add_u32 m0, s28, 21504
  s_nop 0
  buffer_load_dwordx4 v144, s[8:11], s17 offen lds
  s_add_u32 s17, s17, s29
  s_add_u32 m0, s28, 22528
  s_nop 0
  buffer_load_dwordx4 v144, s[8:11], s17 offen lds
  s_add_u32 s17, s17, s29
  s_add_u32 m0, s28, 23552
  s_nop 0
  buffer_load_dwordx4 v144, s[8:11], s17 offen lds
  s_add_u32 s17, s17, s29
  s_waitcnt vmcnt(37)
  ds_read_b64_tr_b16 a[96:97], v146 offset:24576
  ds_read_b64_tr_b16 a[98:99], v147 offset:24576
  ds_read_b64_tr_b16 a[100:101], v146 offset:24640
  ds_read_b64_tr_b16 a[102:103], v147 offset:24640
  ds_read_b64_tr_b16 a[104:105], v146 offset:26624
  ds_read_b64_tr_b16 a[106:107], v147 offset:26624
  ds_read_b64_tr_b16 a[108:109], v146 offset:26688
  ds_read_b64_tr_b16 a[110:111], v147 offset:26688
  s_waitcnt lgkmcnt(0)
  s_add_u32 m0, s28, 24576
  s_nop 0
  buffer_load_dwordx4 v144, s[8:11], s17 offen lds
  s_add_u32 s17, s17, s29
  s_add_u32 m0, s28, 25600
  s_nop 0
  buffer_load_dwordx4 v144, s[8:11], s17 offen lds
  s_add_u32 s17, s17, s29
  s_add_u32 m0, s28, 26624
  s_nop 0
  buffer_load_dwordx4 v144, s[8:11], s17 offen lds
  s_add_u32 s17, s17, s29
  s_add_u32 m0, s28, 27648
  s_nop 0
  buffer_load_dwordx4 v144, s[8:11], s17 offen lds
  s_add_u32 s17, s17, s29
  s_waitcnt vmcnt(37)
  ds_read_b64_tr_b16 a[112:113], v146 offset:28672
  ds_read_b64_tr_b16 a[114:115], v147 offset:28672
  ds_read_b64_tr_b16 a[116:117], v146 offset:28736
  ds_read_b64_tr_b16 a[118:119], v147 offset:28736
  ds_read_b64_tr_b16 a[120:121], v146 offset:30720
  ds_read_b64_tr_b16 a[122:123], v147 offset:30720
  ds_read_b64_tr_b16 a[124:125], v146 offset:30784
  ds_read_b64_tr_b16 a[126:127], v147 offset:30784
  s_waitcnt lgkmcnt(0)
  s_add_u32 m0, s28, 28672
  s_nop 0
  buffer_load_dwordx4 v144, s[8:11], s17 offen lds
  s_add_u32 s17, s17, s29
  s_add_u32 m0, s28, 29696
  s_nop 0
  buffer_load_dwordx4 v144, s[8:11], s17 offen lds
  s_add_u32 s17, s17, s29
  s_add_u32 m0, s28, 30720
  s_nop 0
  buffer_load_dwordx4 v144, s[8:11], s17 offen lds
  s_add_u32 s17, s17, s29
  s_add_u32 m0, s28, 31744
  s_nop 0
  buffer_load_dwordx4 v144, s[8:11], s17 offen lds
  s_add_u32 s17, s17, s29
  s_waitcnt vmcnt(28)
  ds_read_b64_tr_b16 a[128:129], v146 offset:0
  ds_read_b64_tr_b16 a[130:131], v147 offset:0
  ds_read_b64_tr_b16 a[132:133], v146 offset:64
  ds_read_b64_tr_b16 a[134:135], v147 offset:64
  ds_read_b64_tr_b16 a[136:137], v146 offset:2048
  ds_read_b64_tr_b16 a[138:139], v147 offset:2048
  ds_read_b64_tr_b16 a[140:141], v146 offset:2112
  ds_read_b64_tr_b16 a[142:143], v147 offset:2112
  s_waitcnt lgkmcnt(0)
  s_waitcnt vmcnt(24)
  ds_read_b64_tr_b16 a[144:145], v146 offset:4096
  ds_read_b64_tr_b16 a[146:147], v147 offset:4096
  ds_read_b64_tr_b16 a[148:149], v146 offset:4160
  ds_read_b64_tr_b16 a[150:151], v147 offset:4160
  ds_read_b64_tr_b16 a[152:153], v146 offset:6144
  ds_read_b64_tr_b16 a[154:155], v147 offset:6144
  ds_read_b64_tr_b16 a[156:157], v146 offset:6208
  ds_read_b64_tr_b16 a[158:159], v147 offset:6208
  s_waitcnt lgkmcnt(0)
  s_waitcnt vmcnt(20)
  ds_read_b64_tr_b16 a[160:161], v146 offset:8192
  ds_read_b64_tr_b16 a[162:163], v147 offset:8192
  ds_read_b64_tr_b16 a[164:165], v146 offset:8256
  ds_read_b64_tr_b16 a[166:167], v147 offset:8256
  ds_read_b64_tr_b16 a[168:169], v146 offset:10240
  ds_read_b64_tr_b16 a[170:171], v147 offset:10240
  ds_read_b64_tr_b16 a[172:173], v146 offset:10304
  ds_read_b64_tr_b16 a[174:175], v147 offset:10304
  s_waitcnt lgkmcnt(0)
  s_waitcnt vmcnt(16)
  ds_read_b64_tr_b16 a[176:177], v146 offset:12288
  ds_read_b64_tr_b16 a[178:179], v147 offset:12288
  ds_read_b64_tr_b16 a[180:181], v146 offset:12352
  ds_read_b64_tr_b16 a[182:183], v147 offset:12352
  ds_read_b64_tr_b16 a[184:185], v146 offset:14336
  ds_read_b64_tr_b16 a[186:187], v147 offset:14336
  ds_read_b64_tr_b16 a[188:189], v146 offset:14400
  ds_read_b64_tr_b16 a[190:191], v147 offset:14400
  s_waitcnt lgkmcnt(0)
  s_waitcnt vmcnt(12)
  ds_read_b64_tr_b16 a[192:193], v146 offset:16384
  ds_read_b64_tr_b16 a[194:195], v147 offset:16384
  ds_read_b64_tr_b16 a[196:197], v146 offset:16448
  ds_read_b64_tr_b16 a[198:199], v147 offset:16448
  ds_read_b64_tr_b16 a[200:201], v146 offset:18432
  ds_read_b64_tr_b16 a[202:203], v147 offset:18432
  ds_read_b64_tr_b16 a[204:205], v146 offset:18496
  ds_read_b64_tr_b16 a[206:207], v147 offset:18496
  s_waitcnt lgkmcnt(0)
  s_waitcnt vmcnt(8)
  ds_read_b64_tr_b16 a[208:209], v146 offset:20480
  ds_read_b64_tr_b16 a[210:211], v147 offset:20480
  ds_read_b64_tr_b16 a[212:213], v146 offset:20544
  ds_read_b64_tr_b16 a[214:215], v147 offset:20544
  ds_read_b64_tr_b16 a[216:217], v146 offset:22528
  ds_read_b64_tr_b16 a[218:219], v147 offset:22528
  ds_read_b64_tr_b16 a[220:221], v146 offset:22592
  ds_read_b64_tr_b16 a[222:223], v147 offset:22592
  s_waitcnt lgkmcnt(0)
  s_waitcnt vmcnt(4)
  ds_read_b64_tr_b16 a[224:225], v146 offset:24576
  ds_read_b64_tr_b16 a[226:227], v147 offset:24576
  ds_read_b64_tr_b16 a[228:229], v146 offset:24640
  ds_read_b64_tr_b16 a[230:231], v147 offset:24640
  ds_read_b64_tr_b16 a[232:233], v146 offset:26624
  ds_read_b64_tr_b16 a[234:235], v147 offset:26624
  ds_read_b64_tr_b16 a[236:237], v146 offset:26688
  ds_read_b64_tr_b16 a[238:239], v147 offset:26688
  s_waitcnt lgkmcnt(0)
  s_waitcnt vmcnt(0)
  ds_read_b64_tr_b16 a[240:241], v146 offset:28672
  ds_read_b64_tr_b16 a[242:243], v147 offset:28672
  ds_read_b64_tr_b16 a[244:245], v146 offset:28736
  ds_read_b64_tr_b16 a[246:247], v147 offset:28736
  ds_read_b64_tr_b16 a[248:249], v146 offset:30720
  ds_read_b64_tr_b16 a[250:251], v147 offset:30720
  ds_read_b64_tr_b16 a[252:253], v146 offset:30784
  ds_read_b64_tr_b16 a[254:255], v147 offset:30784
  s_waitcnt lgkmcnt(0)
  s_barrier
  s_add_u32 m0, s25, 0
  s_nop 0
  buffer_load_dwordx4 v16, s[12:15], s19 offen lds
  s_add_u32 m0, s25, 1024
  s_nop 0
  buffer_load_dwordx4 v17, s[12:15], s19 offen lds
  s_add_u32 m0, s25, 2048
  s_nop 0
  buffer_load_dwordx4 v18, s[12:15], s19 offen lds
  s_add_u32 m0, s25, 3072
  s_nop 0
  buffer_load_dwordx4 v19, s[12:15], s19 offen lds
  s_add_u32 m0, s25, 4096
  s_nop 0
  buffer_load_dwordx4 v20, s[12:15], s19 offen lds
  s_add_u32 m0, s25, 5120
  s_nop 0
  buffer_load_dwordx4 v21, s[12:15], s19 offen lds
  s_add_u32 m0, s25, 6144
  s_nop 0
  buffer_load_dwordx4 v22, s[12:15], s19 offen lds
  s_add_u32 m0, s25, 7168
  s_nop 0
  buffer_load_dwordx4 v23, s[12:15], s19 offen lds
  s_cmp_gt_u32 s23, 2
  s_cselect_b32 s26, s20, 0
  s_add_u32 s19, s19, s26
  s_add_u32 s25, s25, 32768
  s_and_b32 s25, s25, 0x1ffff
  s_waitcnt vmcnt(0)
  s_barrier
  s_cmp_eq_u32 s48, 0
  s_cselect_b32 s26, 0, s16
  s_cmp_ge_u32 s26, 2
  s_cbranch_scc1 P_v_1
  s_mov_b32 s27, s21
  v_mov_b32 v7, 0x40000000
  s_mov_b32 s29, -3
  v_min_u32 v145, 1, v0
  v_lshlrev_b32 v145, 30, v145
  ds_read_b128 v[24:27], v8 offset:0
  ds_read_b128 v[28:31], v9 offset:0
  ds_read_b128 v[32:35], v10 offset:0
  ds_read_b128 v[36:39], v11 offset:0
  ds_read_b128 v[40:43], v12 offset:0
  ds_read_b128 v[44:47], v13 offset:0
.p2align 6
G_top_3:
  s_waitcnt lgkmcnt(5)
  v_mfma_f32_32x32x16_bf16 v[64:79], a[0:3], v[24:27], 0
  s_add_u32 m0, s25, 0
  ds_read_b128 v[48:51], v14 offset:0
  v_mfma_f32_32x32x16_bf16 v[80:95], a[4:7], v[24:27], 0
  s_waitcnt lgkmcnt(5)
  buffer_load_dwordx4 v16, s[12:15], s19 offen lds
  v_mfma_f32_32x32x16_bf16 v[64:79], a[8:11], v[28:31], v[64:79]
  ds_read_b128 v[52:55], v15 offset:0
  v_mul_f32 v96, s24, v96
  v_mul_f32 v97, s24, v97
  v_mfma_f32_32x32x16_bf16 v[80:95], a[12:15], v[28:31], v[80:95]
  s_waitcnt lgkmcnt(5)
  v_cvt_pk_bf16_f32 v128, v96, v97
  v_mul_f32 v98, s24, v98
  v_mfma_f32_32x32x16_bf16 v[64:79], a[16:19], v[32:35], v[64:79]
  s_add_u32 m0, s25, 1024
  ds_read_b128 v[24:27], v8 offset:8192
  v_mul_f32 v99, s24, v99
  v_cvt_pk_bf16_f32 v129, v98, v99
  v_mfma_f32_32x32x16_bf16 v[80:95], a[20:23], v[32:35], v[80:95]
  s_waitcnt lgkmcnt(5)
  buffer_load_dwordx4 v17, s[12:15], s19 offen lds
  v_mul_f32 v100, s24, v100
  v_mul_f32 v101, s24, v101
  v_mfma_f32_32x32x16_bf16 v[64:79], a[24:27], v[36:39], v[64:79]
  ds_read_b128 v[28:31], v9 offset:8192
  v_cvt_pk_bf16_f32 v130, v100, v101
  v_mul_f32 v102, s24, v102
  v_mfma_f32_32x32x16_bf16 v[80:95], a[28:31], v[36:39], v[80:95]
  s_waitcnt lgkmcnt(5)
  v_mul_f32 v103, s24, v103
  v_cvt_pk_bf16_f32 v131, v102, v103
  v_mfma_f32_32x32x16_bf16 v[64:79], a[32:35], v[40:43], v[64:79]
  s_add_u32 m0, s25, 2048
  ds_read_b128 v[32:35], v10 offset:8192
  v_mul_f32 v104, s24, v104
  v_mul_f32 v105, s24, v105
  v_mfma_f32_32x32x16_bf16 v[80:95], a[36:39], v[40:43], v[80:95]
  s_waitcnt lgkmcnt(5)
  buffer_load_dwordx4 v18, s[12:15], s19 offen lds
  v_cvt_pk_bf16_f32 v132, v104, v105
  v_mul_f32 v106, s24, v106
  v_mfma_f32_32x32x16_bf16 v[64:79], a[40:43], v[44:47], v[64:79]
  ds_read_b128 v[36:39], v11 offset:8192
  v_mul_f32 v107, s24, v107
  v_cvt_pk_bf16_f32 v133, v106, v107
  v_mfma_f32_32x32x16_bf16 v[80:95], a[44:47], v[44:47], v[80:95]
  s_waitcnt lgkmcnt(5)
  v_mul_f32 v108, s24, v108
  v_mul_f32 v109, s24, v109
  v_mfma_f32_32x32x16_bf16 v[64:79], a[48:51], v[48:51], v[64:79]
  s_add_u32 m0, s25, 3072
  ds_read_b128 v[40:43], v12 offset:8192
  v_cvt_pk_bf16_f32 v134, v108, v109
  v_mul_f32 v110, s24, v110
  v_mfma_f32_32x32x16_bf16 v[80:95], a[52:55], v[48:51], v[80:95]
  s_waitcnt lgkmcnt(5)
  buffer_load_dwordx4 v19, s[12:15], s19 offen lds
  v_mul_f32 v111, s24, v111
  v_cvt_pk_bf16_f32 v135, v110, v111
  v_mfma_f32_32x32x16_bf16 v[64:79], a[56:59], v[52:55], v[64:79]
  ds_read_b128 v[44:47], v13 offset:8192
  v_mul_f32 v112, s24, v112
  v_mul_f32 v113, s24, v113
  v_mfma_f32_32x32x16_bf16 v[80:95], a[60:63], v[52:55], v[80:95]
  s_waitcnt lgkmcnt(5)
  v_cvt_pk_bf16_f32 v136, v112, v113
  v_mul_f32 v114, s24, v114
  v_mfma_f32_32x32x16_bf16 v[64:79], a[64:67], v[24:27], v[64:79]
  s_add_u32 m0, s25, 4096
  ds_read_b128 v[48:51], v14 offset:8192
  v_mul_f32 v115, s24, v115
  v_cvt_pk_bf16_f32 v137, v114, v115
  v_mfma_f32_32x32x16_bf16 v[80:95], a[68:71], v[24:27], v[80:95]
  s_waitcnt lgkmcnt(5)
  buffer_load_dwordx4 v20, s[12:15], s19 offen lds
  v_mul_f32 v116, s24, v116
  v_mul_f32 v117, s24, v117
  v_mfma_f32_32x32x16_bf16 v[64:79], a[72:75], v[28:31], v[64:79]
  ds_read_b128 v[52:55], v15 offset:8192
  v_cvt_pk_bf16_f32 v138, v116, v117
  v_mul_f32 v118, s24, v118
  v_mfma_f32_32x32x16_bf16 v[80:95], a[76:79], v[28:31], v[80:95]
  s_waitcnt lgkmcnt(5)
  v_mul_f32 v119, s24, v119
  v_cvt_pk_bf16_f32 v139, v118, v119
  v_mfma_f32_32x32x16_bf16 v[64:79], a[80:83], v[32:35], v[64:79]
  s_add_u32 m0, s25, 5120
  ds_read_b128 v[24:27], v8 offset:16384
  v_mul_f32 v120, s24, v120
  v_mul_f32 v121, s24, v121
  v_mfma_f32_32x32x16_bf16 v[80:95], a[84:87], v[32:35], v[80:95]
  s_waitcnt lgkmcnt(5)
  buffer_load_dwordx4 v21, s[12:15], s19 offen lds
  v_cvt_pk_bf16_f32 v140, v120, v121
  v_mul_f32 v122, s24, v122
  v_mfma_f32_32x32x16_bf16 v[64:79], a[88:91], v[36:39], v[64:79]
  ds_read_b128 v[28:31], v9 offset:16384
  v_mul_f32 v123, s24, v123
  v_cvt_pk_bf16_f32 v141, v122, v123
  v_mfma_f32_32x32x16_bf16 v[80:95], a[92:95], v[36:39], v[80:95]
  s_waitcnt lgkmcnt(5)
  v_mul_f32 v124, s24, v124
  v_mul_f32 v125, s24, v125
  v_mfma_f32_32x32x16_bf16 v[64:79], a[96:99], v[40:43], v[64:79]
  s_add_u32 m0, s25, 6144
  ds_read_b128 v[32:35], v10 offset:16384
  v_cvt_pk_bf16_f32 v142, v124, v125
  v_mul_f32 v126, s24, v126
  v_mfma_f32_32x32x16_bf16 v[80:95], a[100:103], v[40:43], v[80:95]
  s_waitcnt lgkmcnt(5)
  buffer_load_dwordx4 v22, s[12:15], s19 offen lds
  v_mul_f32 v127, s24, v127
  v_cvt_pk_bf16_f32 v143, v126, v127
  v_mfma_f32_32x32x16_bf16 v[64:79], a[104:107], v[44:47], v[64:79]
  ds_read_b128 v[36:39], v11 offset:16384
  v_mfma_f32_32x32x16_bf16 v[80:95], a[108:111], v[44:47], v[80:95]
  s_waitcnt lgkmcnt(5)
  v_mfma_f32_32x32x16_bf16 v[64:79], a[112:115], v[48:51], v[64:79]
  s_add_u32 m0, s25, 7168
  ds_read_b128 v[40:43], v12 offset:16384
  v_mfma_f32_32x32x16_bf16 v[80:95], a[116:119], v[48:51], v[80:95]
  s_waitcnt lgkmcnt(5)
  buffer_load_dwordx4 v23, s[12:15], s19 offen lds
  v_mfma_f32_32x32x16_bf16 v[64:79], a[120:123], v[52:55], v[64:79]
  s_cmp_gt_u32 s23, 3
  ds_read_b128 v[44:47], v13 offset:16384
  v_mfma_f32_32x32x16_bf16 v[80:95], a[124:127], v[52:55], v[80:95]
  s_waitcnt lgkmcnt(5)
  s_cselect_b32 s26, s20, 0
  v_mfma_f32_32x32x16_bf16 v[64:79], a[128:131], v[24:27], v[64:79]
  s_add_u32 s19, s19, s26
  ds_read_b128 v[48:51], v14 offset:16384
  v_mfma_f32_32x32x16_bf16 v[80:95], a[132:135], v[24:27], v[80:95]
  s_waitcnt lgkmcnt(5)
  s_add_u32 s25, s25, 32768
  v_mfma_f32_32x32x16_bf16 v[64:79], a[136:139], v[28:31], v[64:79]
  s_and_b32 s25, s25, 0x1ffff
  ds_read_b128 v[52:55], v15 offset:16384
  v_mfma_f32_32x32x16_bf16 v[80:95], a[140:143], v[28:31], v[80:95]
  s_waitcnt lgkmcnt(5)
  buffer_store_dwordx4 v[128:131], v7, s[4:7], s21 offen offset:0 sc1
  v_mfma_f32_32x32x16_bf16 v[64:79], a[144:147], v[32:35], v[64:79]
  ds_read_b128 v[24:27], v8 offset:24576
  v_mfma_f32_32x32x16_bf16 v[80:95], a[148:151], v[32:35], v[80:95]
  s_waitcnt lgkmcnt(5)
  v_mfma_f32_32x32x16_bf16 v[64:79], a[152:155], v[36:39], v[64:79]
  ds_read_b128 v[28:31], v9 offset:24576
  v_mfma_f32_32x32x16_bf16 v[80:95], a[156:159], v[36:39], v[80:95]
  s_waitcnt lgkmcnt(5)
  buffer_store_dwordx4 v[132:135], v7, s[4:7], s21 offen offset:1024 sc1
  v_mfma_f32_32x32x16_bf16 v[64:79], a[160:163], v[40:43], v[64:79]
  ds_read_b128 v[32:35], v10 offset:24576
  v_mfma_f32_32x32x16_bf16 v[80:95], a[164:167], v[40:43], v[80:95]
  s_waitcnt lgkmcnt(5)
  v_mfma_f32_32x32x16_bf16 v[64:79], a[168:171], v[44:47], v[64:79]
  ds_read_b128 v[36:39], v11 offset:24576
  v_mfma_f32_32x32x16_bf16 v[80:95], a[172:175], v[44:47], v[80:95]
  s_waitcnt lgkmcnt(5)
  buffer_store_dwordx4 v[136:139], v7, s[4:7], s21 offen offset:2048 sc1
  v_mfma_f32_32x32x16_bf16 v[64:79], a[176:179], v[48:51], v[64:79]
  ds_read_b128 v[40:43], v12 offset:24576
  v_mfma_f32_32x32x16_bf16 v[80:95], a[180:183], v[48:51], v[80:95]
  s_waitcnt lgkmcnt(5)
  v_mfma_f32_32x32x16_bf16 v[64:79], a[184:187], v[52:55], v[64:79]
  ds_read_b128 v[44:47], v13 offset:24576
  v_mfma_f32_32x32x16_bf16 v[80:95], a[188:191], v[52:55], v[80:95]
  s_waitcnt lgkmcnt(5)
  buffer_store_dwordx4 v[140:143], v7, s[4:7], s21 offen offset:3072 sc1
  v_mfma_f32_32x32x16_bf16 v[64:79], a[192:195], v[24:27], v[64:79]
  s_mov_b32 s21, s27
  ds_read_b128 v[48:51], v14 offset:24576
  v_mov_b32 v7, v2
  v_mfma_f32_32x32x16_bf16 v[80:95], a[196:199], v[24:27], v[80:95]
  s_waitcnt lgkmcnt(5)
  v_mfma_f32_32x32x16_bf16 v[64:79], a[200:203], v[28:31], v[64:79]
  s_add_u32 s27, s27, s22
  ds_read_b128 v[52:55], v15 offset:24576
  v_mfma_f32_32x32x16_bf16 v[80:95], a[204:207], v[28:31], v[80:95]
  s_waitcnt lgkmcnt(5)
  s_waitcnt vmcnt(17)
  s_barrier
  v_mfma_f32_32x32x16_bf16 v[64:79], a[208:211], v[32:35], v[64:79]
  ds_read_b128 v[24:27], v8 offset:32768
  v_mfma_f32_32x32x16_bf16 v[80:95], a[212:215], v[32:35], v[80:95]
  s_waitcnt lgkmcnt(5)
  v_mfma_f32_32x32x16_bf16 v[64:79], a[216:219], v[36:39], v[64:79]
  s_add_u32 s29, s29, 1
  ds_read_b128 v[28:31], v9 offset:32768
  v_mfma_f32_32x32x16_bf16 v[80:95], a[220:223], v[36:39], v[80:95]
  s_waitcnt lgkmcnt(5)
  s_max_i32 s30, s29, 0
  v_mov_b32 v144, s30
  v_mfma_f32_32x32x16_bf16 v[64:79], a[224:227], v[40:43], v[64:79]
  ds_read_b128 v[32:35], v10 offset:32768
  v_mfma_f32_32x32x16_bf16 v[80:95], a[228:231], v[40:43], v[80:95]
  s_waitcnt lgkmcnt(5)
  buffer_store_dword v144, v145, s[4:7], s31 offen sc1
  v_mfma_f32_32x32x16_bf16 v[64:79], a[232:235], v[44:47], v[64:79]
  ds_read_b128 v[36:39], v11 offset:32768
  v_mfma_f32_32x32x16_bf16 v[80:95], a[236:239], v[44:47], v[80:95]
  s_waitcnt lgkmcnt(5)
  v_mfma_f32_32x32x16_bf16 v[64:79], a[240:243], v[48:51], v[64:79]
  s_sub_u32 s23, s23, 1
  ds_read_b128 v[40:43], v12 offset:32768
  v_mfma_f32_32x32x16_bf16 v[80:95], a[244:247], v[48:51], v[80:95]
  s_waitcnt lgkmcnt(5)
  v_mfma_f32_32x32x16_bf16 v[64:79], a[248:251], v[52:55], v[64:79]
  s_cmp_eq_u32 s23, 0
  ds_read_b128 v[44:47], v13 offset:32768
  v_mfma_f32_32x32x16_bf16 v[80:95], a[252:255], v[52:55], v[80:95]
  s_cbranch_scc1 G_done0_4
  s_waitcnt lgkmcnt(5)
  v_mfma_f32_32x32x16_bf16 v[96:111], a[0:3], v[24:27], 0
  s_add_u32 m0, s25, 0
  ds_read_b128 v[48:51], v14 offset:32768
  v_mfma_f32_32x32x16_bf16 v[112:127], a[4:7], v[24:27], 0
  s_waitcnt lgkmcnt(5)
  buffer_load_dwordx4 v16, s[12:15], s19 offen lds
  v_mfma_f32_32x32x16_bf16 v[96:111], a[8:11], v[28:31], v[96:111]
  ds_read_b128 v[52:55], v15 offset:32768
  v_mul_f32 v64, s24, v64
  v_mul_f32 v65, s24, v65
  v_mfma_f32_32x32x16_bf16 v[112:127], a[12:15], v[28:31], v[112:127]
  s_waitcnt lgkmcnt(5)
  v_cvt_pk_bf16_f32 v128, v64, v65
  v_mul_f32 v66, s24, v66
  v_mfma_f32_32x32x16_bf16 v[96:111], a[16:19], v[32:35], v[96:111]
  s_add_u32 m0, s25, 1024
  ds_read_b128 v[24:27], v8 offset:40960
  v_mul_f32 v67, s24, v67
  v_cvt_pk_bf16_f32 v129, v66, v67
  v_mfma_f32_32x32x16_bf16 v[112:127], a[20:23], v[32:35], v[112:127]
  s_waitcnt lgkmcnt(5)
  buffer_load_dwordx4 v17, s[12:15], s19 offen lds
  v_mul_f32 v68, s24, v68
  v_mul_f32 v69, s24, v69
  v_mfma_f32_32x32x16_bf16 v[96:111], a[24:27], v[36:39], v[96:111]
  ds_read_b128 v[28:31], v9 offset:40960
  v_cvt_pk_bf16_f32 v130, v68, v69
  v_mul_f32 v70, s24, v70
  v_mfma_f32_32x32x16_bf16 v[112:127], a[28:31], v[36:39], v[112:127]
  s_waitcnt lgkmcnt(5)
  v_mul_f32 v71, s24, v71
  v_cvt_pk_bf16_f32 v131, v70, v71
  v_mfma_f32_32x32x16_bf16 v[96:111], a[32:35], v[40:43], v[96:111]
  s_add_u32 m0, s25, 2048
  ds_read_b128 v[32:35], v10 offset:40960
  v_mul_f32 v72, s24, v72
  v_mul_f32 v73, s24, v73
  v_mfma_f32_32x32x16_bf16 v[112:127], a[36:39], v[40:43], v[112:127]
  s_waitcnt lgkmcnt(5)
  buffer_load_dwordx4 v18, s[12:15], s19 offen lds
  v_cvt_pk_bf16_f32 v132, v72, v73
  v_mul_f32 v74, s24, v74
  v_mfma_f32_32x32x16_bf16 v[96:111], a[40:43], v[44:47], v[96:111]
  ds_read_b128 v[36:39], v11 offset:40960
  v_mul_f32 v75, s24, v75
  v_cvt_pk_bf16_f32 v133, v74, v75
  v_mfma_f32_32x32x16_bf16 v[112:127], a[44:47], v[44:47], v[112:127]
  s_waitcnt lgkmcnt(5)
  v_mul_f32 v76, s24, v76
  v_mul_f32 v77, s24, v77
  v_mfma_f32_32x32x16_bf16 v[96:111], a[48:51], v[48:51], v[96:111]
  s_add_u32 m0, s25, 3072
  ds_read_b128 v[40:43], v12 offset:40960
  v_cvt_pk_bf16_f32 v134, v76, v77
  v_mul_f32 v78, s24, v78
  v_mfma_f32_32x32x16_bf16 v[112:127], a[52:55], v[48:51], v[112:127]
  s_waitcnt lgkmcnt(5)
  buffer_load_dwordx4 v19, s[12:15], s19 offen lds
  v_mul_f32 v79, s24, v79
  v_cvt_pk_bf16_f32 v135, v78, v79
  v_mfma_f32_32x32x16_bf16 v[96:111], a[56:59], v[52:55], v[96:111]
  ds_read_b128 v[44:47], v13 offset:40960
  v_mul_f32 v80, s24, v80
  v_mul_f32 v81, s24, v81
  v_mfma_f32_32x32x16_bf16 v[112:127], a[60:63], v[52:55], v[112:127]
  s_waitcnt lgkmcnt(5)
  v_cvt_pk_bf16_f32 v136, v80, v81
  v_mul_f32 v82, s24, v82
  v_mfma_f32_32x32x16_bf16 v[96:111], a[64:67], v[24:27], v[96:111]
  s_add_u32 m0, s25, 4096
  ds_read_b128 v[48:51], v14 offset:40960
  v_mul_f32 v83, s24, v83
  v_cvt_pk_bf16_f32 v137, v82, v83
  v_mfma_f32_32x32x16_bf16 v[112:127], a[68:71], v[24:27], v[112:127]
  s_waitcnt lgkmcnt(5)
  buffer_load_dwordx4 v20, s[12:15], s19 offen lds
  v_mul_f32 v84, s24, v84
  v_mul_f32 v85, s24, v85
  v_mfma_f32_32x32x16_bf16 v[96:111], a[72:75], v[28:31], v[96:111]
  ds_read_b128 v[52:55], v15 offset:40960
  v_cvt_pk_bf16_f32 v138, v84, v85
  v_mul_f32 v86, s24, v86
  v_mfma_f32_32x32x16_bf16 v[112:127], a[76:79], v[28:31], v[112:127]
  s_waitcnt lgkmcnt(5)
  v_mul_f32 v87, s24, v87
  v_cvt_pk_bf16_f32 v139, v86, v87
  v_mfma_f32_32x32x16_bf16 v[96:111], a[80:83], v[32:35], v[96:111]
  s_add_u32 m0, s25, 5120
  ds_read_b128 v[24:27], v8 offset:49152
  v_mul_f32 v88, s24, v88
  v_mul_f32 v89, s24, v89
  v_mfma_f32_32x32x16_bf16 v[112:127], a[84:87], v[32:35], v[112:127]
  s_waitcnt lgkmcnt(5)
  buffer_load_dwordx4 v21, s[12:15], s19 offen lds
  v_cvt_pk_bf16_f32 v140, v88, v89
  v_mul_f32 v90, s24, v90
  v_mfma_f32_32x32x16_bf16 v[96:111], a[88:91], v[36:39], v[96:111]
  ds_read_b128 v[28:31], v9 offset:49152
  v_mul_f32 v91, s24, v91
  v_cvt_pk_bf16_f32 v141, v90, v91
  v_mfma_f32_32x32x16_bf16 v[112:127], a[92:95], v[36:39], v[112:127]
  s_waitcnt lgkmcnt(5)
  v_mul_f32 v92, s24, v92
  v_mul_f32 v93, s24, v93
  v_mfma_f32_32x32x16_bf16 v[96:111], a[96:99], v[40:43], v[96:111]
  s_add_u32 m0, s25, 6144
  ds_read_b128 v[32:35], v10 offset:49152
  v_cvt_pk_bf16_f32 v142, v92, v93
  v_mul_f32 v94, s24, v94
  v_mfma_f32_32x32x16_bf16 v[112:127], a[100:103], v[40:43], v[112:127]
  s_waitcnt lgkmcnt(5)
  buffer_load_dwordx4 v22, s[12:15], s19 offen lds
  v_mul_f32 v95, s24, v95
  v_cvt_pk_bf16_f32 v143, v94, v95
  v_mfma_f32_32x32x16_bf16 v[96:111], a[104:107], v[44:47], v[96:111]
  ds_read_b128 v[36:39], v11 offset:49152
  v_mfma_f32_32x32x16_bf16 v[112:127], a[108:111], v[44:47], v[112:127]
  s_waitcnt lgkmcnt(5)
  v_mfma_f32_32x32x16_bf16 v[96:111], a[112:115], v[48:51], v[96:111]
  s_add_u32 m0, s25, 7168
  ds_read_b128 v[40:43], v12 offset:49152
  v_mfma_f32_32x32x16_bf16 v[112:127], a[116:119], v[48:51], v[112:127]
  s_waitcnt lgkmcnt(5)
  buffer_load_dwordx4 v23, s[12:15], s19 offen lds
  v_mfma_f32_32x32x16_bf16 v[96:111], a[120:123], v[52:55], v[96:111]
  s_cmp_gt_u32 s23, 3
  ds_read_b128 v[44:47], v13 offset:49152
  v_mfma_f32_32x32x16_bf16 v[112:127], a[124:127], v[52:55], v[112:127]
  s_waitcnt lgkmcnt(5)
  s_cselect_b32 s26, s20, 0
  v_mfma_f32_32x32x16_bf16 v[96:111], a[128:131], v[24:27], v[96:111]
  s_add_u32 s19, s19, s26
  ds_read_b128 v[48:51], v14 offset:49152
  v_mfma_f32_32x32x16_bf16 v[112:127], a[132:135], v[24:27], v[112:127]
  s_waitcnt lgkmcnt(5)
  s_add_u32 s25, s25, 32768
  v_mfma_f32_32x32x16_bf16 v[96:111], a[136:139], v[28:31], v[96:111]
  s_and_b32 s25, s25, 0x1ffff
  ds_read_b128 v[52:55], v15 offset:49152
  v_mfma_f32_32x32x16_bf16 v[112:127], a[140:143], v[28:31], v[112:127]
  s_waitcnt lgkmcnt(5)
  buffer_store_dwordx4 v[128:131], v7, s[4:7], s21 offen offset:0 sc1
  v_mfma_f32_32x32x16_bf16 v[96:111], a[144:147], v[32:35], v[96:111]
  ds_read_b128 v[24:27], v8 offset:57344
  v_mfma_f32_32x32x16_bf16 v[112:127], a[148:151], v[32:35], v[112:127]
  s_waitcnt lgkmcnt(5)
  v_xor_b32 v8, 0x10000, v8
  v_mfma_f32_32x32x16_bf16 v[96:111], a[152:155], v[36:39], v[96:111]
  ds_read_b128 v[28:31], v9 offset:57344
  v_mfma_f32_32x32x16_bf16 v[112:127], a[156:159], v[36:39], v[112:127]
  s_waitcnt lgkmcnt(5)
  buffer_store_dwordx4 v[132:135], v7, s[4:7], s21 offen offset:1024 sc1
  v_xor_b32 v9, 0x10000, v9
  v_mfma_f32_32x32x16_bf16 v[96:111], a[160:163], v[40:43], v[96:111]
  ds_read_b128 v[32:35], v10 offset:57344
  v_mfma_f32_32x32x16_bf16 v[112:127], a[164:167], v[40:43], v[112:127]
  s_waitcnt lgkmcnt(5)
  v_xor_b32 v10, 0x10000, v10
  v_mfma_f32_32x32x16_bf16 v[96:111], a[168:171], v[44:47], v[96:111]
  ds_read_b128 v[36:39], v11 offset:57344
  v_mfma_f32_32x32x16_bf16 v[112:127], a[172:175], v[44:47], v[112:127]
  s_waitcnt lgkmcnt(5)
  buffer_store_dwordx4 v[136:139], v7, s[4:7], s21 offen offset:2048 sc1
  v_xor_b32 v11, 0x10000, v11
  v_mfma_f32_32x32x16_bf16 v[96:111], a[176:179], v[48:51], v[96:111]
  ds_read_b128 v[40:43], v12 offset:57344
  v_mfma_f32_32x32x16_bf16 v[112:127], a[180:183], v[48:51], v[112:127]
  s_waitcnt lgkmcnt(5)
  v_xor_b32 v12, 0x10000, v12
  v_mfma_f32_32x32x16_bf16 v[96:111], a[184:187], v[52:55], v[96:111]
  ds_read_b128 v[44:47], v13 offset:57344
  v_mfma_f32_32x32x16_bf16 v[112:127], a[188:191], v[52:55], v[112:127]
  s_waitcnt lgkmcnt(5)
  buffer_store_dwordx4 v[140:143], v7, s[4:7], s21 offen offset:3072 sc1
  v_xor_b32 v13, 0x10000, v13
  v_mfma_f32_32x32x16_bf16 v[96:111], a[192:195], v[24:27], v[96:111]
  s_mov_b32 s21, s27
  ds_read_b128 v[48:51], v14 offset:57344
  v_mov_b32 v7, v2
  v_mfma_f32_32x32x16_bf16 v[112:127], a[196:199], v[24:27], v[112:127]
  s_waitcnt lgkmcnt(5)
  v_xor_b32 v14, 0x10000, v14
  v_mfma_f32_32x32x16_bf16 v[96:111], a[200:203], v[28:31], v[96:111]
  s_add_u32 s27, s27, s22
  ds_read_b128 v[52:55], v15 offset:57344
  v_mfma_f32_32x32x16_bf16 v[112:127], a[204:207], v[28:31], v[112:127]
  s_waitcnt lgkmcnt(5)
  s_waitcnt vmcnt(17)
  s_barrier
  v_xor_b32 v15, 0x10000, v15
  v_mfma_f32_32x32x16_bf16 v[96:111], a[208:211], v[32:35], v[96:111]
  ds_read_b128 v[24:27], v8 offset:0
  v_mfma_f32_32x32x16_bf16 v[112:127], a[212:215], v[32:35], v[112:127]
  s_waitcnt lgkmcnt(5)
  v_mfma_f32_32x32x16_bf16 v[96:111], a[216:219], v[36:39], v[96:111]
  s_add_u32 s29, s29, 1
  ds_read_b128 v[28:31], v9 offset:0
  v_mfma_f32_32x32x16_bf16 v[112:127], a[220:223], v[36:39], v[112:127]
  s_waitcnt lgkmcnt(5)
  s_max_i32 s30, s29, 0
  v_mov_b32 v144, s30
  v_mfma_f32_32x32x16_bf16 v[96:111], a[224:227], v[40:43], v[96:111]
  ds_read_b128 v[32:35], v10 offset:0
  v_mfma_f32_32x32x16_bf16 v[112:127], a[228:231], v[40:43], v[112:127]
  s_waitcnt lgkmcnt(5)
  buffer_store_dword v144, v145, s[4:7], s31 offen sc1
  v_mfma_f32_32x32x16_bf16 v[96:111], a[232:235], v[44:47], v[96:111]
  ds_read_b128 v[36:39], v11 offset:0
  v_mfma_f32_32x32x16_bf16 v[112:127], a[236:239], v[44:47], v[112:127]
  s_waitcnt lgkmcnt(5)
  v_mfma_f32_32x32x16_bf16 v[96:111], a[240:243], v[48:51], v[96:111]
  s_sub_u32 s23, s23, 1
  ds_read_b128 v[40:43], v12 offset:0
  v_mfma_f32_32x32x16_bf16 v[112:127], a[244:247], v[48:51], v[112:127]
  s_waitcnt lgkmcnt(5)
  v_mfma_f32_32x32x16_bf16 v[96:111], a[248:251], v[52:55], v[96:111]
  s_cmp_eq_u32 s23, 0
  ds_read_b128 v[44:47], v13 offset:0
  v_mfma_f32_32x32x16_bf16 v[112:127], a[252:255], v[52:55], v[112:127]
  s_cbranch_scc1 G_done1_5
  s_branch G_top_3
G_done0_4:
  s_nop 7
  s_nop 3
  v_mul_f32 v64, s24, v64
  v_mul_f32 v65, s24, v65
  v_cvt_pk_bf16_f32 v128, v64, v65
  v_mul_f32 v66, s24, v66
  v_mul_f32 v67, s24, v67
  v_cvt_pk_bf16_f32 v129, v66, v67
  v_mul_f32 v68, s24, v68
  v_mul_f32 v69, s24, v69
  v_cvt_pk_bf16_f32 v130, v68, v69
  v_mul_f32 v70, s24, v70
  v_mul_f32 v71, s24, v71
  v_cvt_pk_bf16_f32 v131, v70, v71
  buffer_store_dwordx4 v[128:131], v7, s[4:7], s21 offen offset:0 sc1
  v_mul_f32 v72, s24, v72
  v_mul_f32 v73, s24, v73
  v_cvt_pk_bf16_f32 v132, v72, v73
  v_mul_f32 v74, s24, v74
  v_mul_f32 v75, s24, v75
  v_cvt_pk_bf16_f32 v133, v74, v75
  v_mul_f32 v76, s24, v76
  v_mul_f32 v77, s24, v77
  v_cvt_pk_bf16_f32 v134, v76, v77
  v_mul_f32 v78, s24, v78
  v_mul_f32 v79, s24, v79
  v_cvt_pk_bf16_f32 v135, v78, v79
  buffer_store_dwordx4 v[132:135], v7, s[4:7], s21 offen offset:1024 sc1
  v_mul_f32 v80, s24, v80
  v_mul_f32 v81, s24, v81
  v_cvt_pk_bf16_f32 v136, v80, v81
  v_mul_f32 v82, s24, v82
  v_mul_f32 v83, s24, v83
  v_cvt_pk_bf16_f32 v137, v82, v83
  v_mul_f32 v84, s24, v84
  v_mul_f32 v85, s24, v85
  v_cvt_pk_bf16_f32 v138, v84, v85
  v_mul_f32 v86, s24, v86
  v_mul_f32 v87, s24, v87
  v_cvt_pk_bf16_f32 v139, v86, v87
  buffer_store_dwordx4 v[136:139], v7, s[4:7], s21 offen offset:2048 sc1
  v_mul_f32 v88, s24, v88
  v_mul_f32 v89, s24, v89
  v_cvt_pk_bf16_f32 v140, v88, v89
  v_mul_f32 v90, s24, v90
  v_mul_f32 v91, s24, v91
  v_cvt_pk_bf16_f32 v141, v90, v91
  v_mul_f32 v92, s24, v92
  v_mul_f32 v93, s24, v93
  v_cvt_pk_bf16_f32 v142, v92, v93
  v_mul_f32 v94, s24, v94
  v_mul_f32 v95, s24, v95
  v_cvt_pk_bf16_f32 v143, v94, v95
  buffer_store_dwordx4 v[140:143], v7, s[4:7], s21 offen offset:3072 sc1
  s_branch G_fin_6
G_done1_5:
  s_nop 7
  s_nop 3
  v_mul_f32 v96, s24, v96
  v_mul_f32 v97, s24, v97
  v_cvt_pk_bf16_f32 v128, v96, v97
  v_mul_f32 v98, s24, v98
  v_mul_f32 v99, s24, v99
  v_cvt_pk_bf16_f32 v129, v98, v99
  v_mul_f32 v100, s24, v100
  v_mul_f32 v101, s24, v101
  v_cvt_pk_bf16_f32 v130, v100, v101
  v_mul_f32 v102, s24, v102
  v_mul_f32 v103, s24, v103
  v_cvt_pk_bf16_f32 v131, v102, v103
  buffer_store_dwordx4 v[128:131], v7, s[4:7], s21 offen offset:0 sc1
  v_mul_f32 v104, s24, v104
  v_mul_f32 v105, s24, v105
  v_cvt_pk_bf16_f32 v132, v104, v105
  v_mul_f32 v106, s24, v106
  v_mul_f32 v107, s24, v107
  v_cvt_pk_bf16_f32 v133, v106, v107
  v_mul_f32 v108, s24, v108
  v_mul_f32 v109, s24, v109
  v_cvt_pk_bf16_f32 v134, v108, v109
  v_mul_f32 v110, s24, v110
  v_mul_f32 v111, s24, v111
  v_cvt_pk_bf16_f32 v135, v110, v111
  buffer_store_dwordx4 v[132:135], v7, s[4:7], s21 offen offset:1024 sc1
  v_mul_f32 v112, s24, v112
  v_mul_f32 v113, s24, v113
  v_cvt_pk_bf16_f32 v136, v112, v113
  v_mul_f32 v114, s24, v114
  v_mul_f32 v115, s24, v115
  v_cvt_pk_bf16_f32 v137, v114, v115
  v_mul_f32 v116, s24, v116
  v_mul_f32 v117, s24, v117
  v_cvt_pk_bf16_f32 v138, v116, v117
  v_mul_f32 v118, s24, v118
  v_mul_f32 v119, s24, v119
  v_cvt_pk_bf16_f32 v139, v118, v119
  buffer_store_dwordx4 v[136:139], v7, s[4:7], s21 offen offset:2048 sc1
  v_mul_f32 v120, s24, v120
  v_mul_f32 v121, s24, v121
  v_cvt_pk_bf16_f32 v140, v120, v121
  v_mul_f32 v122, s24, v122
  v_mul_f32 v123, s24, v123
  v_cvt_pk_bf16_f32 v141, v122, v123
  v_mul_f32 v124, s24, v124
  v_mul_f32 v125, s24, v125
  v_cvt_pk_bf16_f32 v142, v124, v125
  v_mul_f32 v126, s24, v126
  v_mul_f32 v127, s24, v127
  v_cvt_pk_bf16_f32 v143, v126, v127
  buffer_store_dwordx4 v[140:143], v7, s[4:7], s21 offen offset:3072 sc1
G_fin_6:
  s_waitcnt vmcnt(0) lgkmcnt(0)
  s_barrier
  s_add_u32 s30, s29, 3
  v_mov_b32 v144, s30
  v_min_u32 v145, 1, v0
  v_lshlrev_b32 v145, 30, v145
  buffer_store_dword v144, v145, s[4:7], s31 offen sc1
  s_branch P_end_2
P_v_1:
  s_mov_b32 s27, s21
  v_mov_b32 v7, 0x40000000
  s_mov_b32 s29, -3
  v_min_u32 v145, 1, v0
  v_lshlrev_b32 v145, 30, v145
  ds_read_b128 v[24:27], v8 offset:0
  ds_read_b128 v[28:31], v9 offset:0
  ds_read_b128 v[32:35], v10 offset:0
  ds_read_b128 v[36:39], v11 offset:0
  ds_read_b128 v[40:43], v12 offset:0
  ds_read_b128 v[44:47], v13 offset:0
.p2align 6
G_top_7:
  s_waitcnt lgkmcnt(5)
  v_mfma_f32_32x32x16_bf16 v[64:79], v[24:27], a[0:3], 0
  s_add_u32 m0, s25, 0
  ds_read_b128 v[48:51], v14 offset:0
  v_mfma_f32_32x32x16_bf16 v[80:95], v[24:27], a[4:7], 0
  s_waitcnt lgkmcnt(5)
  buffer_load_dwordx4 v16, s[12:15], s19 offen lds
  v_mfma_f32_32x32x16_bf16 v[64:79], v[28:31], a[8:11], v[64:79]
  ds_read_b128 v[52:55], v15 offset:0
  v_mul_f32 v96, s24, v96
  v_mul_f32 v97, s24, v97
  v_mfma_f32_32x32x16_bf16 v[80:95], v[28:31], a[12:15], v[80:95]
  s_waitcnt lgkmcnt(5)
  v_cvt_pk_bf16_f32 v128, v96, v97
  v_mul_f32 v98, s24, v98
  v_mfma_f32_32x32x16_bf16 v[64:79], v[32:35], a[16:19], v[64:79]
  s_add_u32 m0, s25, 1024
  ds_read_b128 v[24:27], v8 offset:8192
  v_mul_f32 v99, s24, v99
  v_cvt_pk_bf16_f32 v129, v98, v99
  v_mfma_f32_32x32x16_bf16 v[80:95], v[32:35], a[20:23], v[80:95]
  s_waitcnt lgkmcnt(5)
  buffer_load_dwordx4 v17, s[12:15], s19 offen lds
  v_mul_f32 v100, s24, v100
  v_mul_f32 v101, s24, v101
  v_mfma_f32_32x32x16_bf16 v[64:79], v[36:39], a[24:27], v[64:79]
  ds_read_b128 v[28:31], v9 offset:8192
  v_cvt_pk_bf16_f32 v130, v100, v101
  v_mul_f32 v102, s24, v102
  v_mfma_f32_32x32x16_bf16 v[80:95], v[36:39], a[28:31], v[80:95]
  s_waitcnt lgkmcnt(5)
  v_mul_f32 v103, s24, v103
  v_cvt_pk_bf16_f32 v131, v102, v103
  v_mfma_f32_32x32x16_bf16 v[64:79], v[40:43], a[32:35], v[64:79]
  s_add_u32 m0, s25, 2048
  ds_read_b128 v[32:35], v10 offset:8192
  v_mul_f32 v104, s24, v104
  v_mul_f32 v105, s24, v105
  v_mfma_f32_32x32x16_bf16 v[80:95], v[40:43], a[36:39], v[80:95]
  s_waitcnt lgkmcnt(5)
  buffer_load_dwordx4 v18, s[12:15], s19 offen lds
  v_cvt_pk_bf16_f32 v132, v104, v105
  v_mul_f32 v106, s24, v106
  v_mfma_f32_32x32x16_bf16 v[64:79], v[44:47], a[40:43], v[64:79]
  ds_read_b128 v[36:39], v11 offset:8192
  v_mul_f32 v107, s24, v107
  v_cvt_pk_bf16_f32 v133, v106, v107
  v_mfma_f32_32x32x16_bf16 v[80:95], v[44:47], a[44:47], v[80:95]
  s_waitcnt lgkmcnt(5)
  v_mul_f32 v108, s24, v108
  v_mul_f32 v109, s24, v109
  v_mfma_f32_32x32x16_bf16 v[64:79], v[48:51], a[48:51], v[64:79]
  s_add_u32 m0, s25, 3072
  ds_read_b128 v[40:43], v12 offset:8192
  v_cvt_pk_bf16_f32 v134, v108, v109
  v_mul_f32 v110, s24, v110
  v_mfma_f32_32x32x16_bf16 v[80:95], v[48:51], a[52:55], v[80:95]
  s_waitcnt lgkmcnt(5)
  buffer_load_dwordx4 v19, s[12:15], s19 offen lds
  v_mul_f32 v111, s24, v111
  v_cvt_pk_bf16_f32 v135, v110, v111
  v_mfma_f32_32x32x16_bf16 v[64:79], v[52:55], a[56:59], v[64:79]
  ds_read_b128 v[44:47], v13 offset:8192
  v_mul_f32 v112, s24, v112
  v_mul_f32 v113, s24, v113
  v_mfma_f32_32x32x16_bf16 v[80:95], v[52:55], a[60:63], v[80:95]
  s_waitcnt lgkmcnt(5)
  v_cvt_pk_bf16_f32 v136, v112, v113
  v_mul_f32 v114, s24, v114
  v_mfma_f32_32x32x16_bf16 v[64:79], v[24:27], a[64:67], v[64:79]
  s_add_u32 m0, s25, 4096
  ds_read_b128 v[48:51], v14 offset:8192
  v_mul_f32 v115, s24, v115
  v_cvt_pk_bf16_f32 v137, v114, v115
  v_mfma_f32_32x32x16_bf16 v[80:95], v[24:27], a[68:71], v[80:95]
  s_waitcnt lgkmcnt(5)
  buffer_load_dwordx4 v20, s[12:15], s19 offen lds
  v_mul_f32 v116, s24, v116
  v_mul_f32 v117, s24, v117
  v_mfma_f32_32x32x16_bf16 v[64:79], v[28:31], a[72:75], v[64:79]
  ds_read_b128 v[52:55], v15 offset:8192
  v_cvt_pk_bf16_f32 v138, v116, v117
  v_mul_f32 v118, s24, v118
  v_mfma_f32_32x32x16_bf16 v[80:95], v[28:31], a[76:79], v[80:95]
  s_waitcnt lgkmcnt(5)
  v_mul_f32 v119, s24, v119
  v_cvt_pk_bf16_f32 v139, v118, v119
  v_mfma_f32_32x32x16_bf16 v[64:79], v[32:35], a[80:83], v[64:79]
  s_add_u32 m0, s25, 5120
  ds_read_b128 v[24:27], v8 offset:16384
  v_mul_f32 v120, s24, v120
  v_mul_f32 v121, s24, v121
  v_mfma_f32_32x32x16_bf16 v[80:95], v[32:35], a[84:87], v[80:95]
  s_waitcnt lgkmcnt(5)
  buffer_load_dwordx4 v21, s[12:15], s19 offen lds
  v_cvt_pk_bf16_f32 v140, v120, v121
  v_mul_f32 v122, s24, v122
  v_mfma_f32_32x32x16_bf16 v[64:79], v[36:39], a[88:91], v[64:79]
  ds_read_b128 v[28:31], v9 offset:16384
  v_mul_f32 v123, s24, v123
  v_cvt_pk_bf16_f32 v141, v122, v123
  v_mfma_f32_32x32x16_bf16 v[80:95], v[36:39], a[92:95], v[80:95]
  s_waitcnt lgkmcnt(5)
  v_mul_f32 v124, s24, v124
  v_mul_f32 v125, s24, v125
  v_mfma_f32_32x32x16_bf16 v[64:79], v[40:43], a[96:99], v[64:79]
  s_add_u32 m0, s25, 6144
  ds_read_b128 v[32:35], v10 offset:16384
  v_cvt_pk_bf16_f32 v142, v124, v125
  v_mul_f32 v126, s24, v126
  v_mfma_f32_32x32x16_bf16 v[80:95], v[40:43], a[100:103], v[80:95]
  s_waitcnt lgkmcnt(5)
  buffer_load_dwordx4 v22, s[12:15], s19 offen lds
  v_mul_f32 v127, s24, v127
  v_cvt_pk_bf16_f32 v143, v126, v127
  v_mfma_f32_32x32x16_bf16 v[64:79], v[44:47], a[104:107], v[64:79]
  ds_read_b128 v[36:39], v11 offset:16384
  v_mfma_f32_32x32x16_bf16 v[80:95], v[44:47], a[108:111], v[80:95]
  s_waitcnt lgkmcnt(5)
  v_mfma_f32_32x32x16_bf16 v[64:79], v[48:51], a[112:115], v[64:79]
  s_add_u32 m0, s25, 7168
  ds_read_b128 v[40:43], v12 offset:16384
  v_mfma_f32_32x32x16_bf16 v[80:95], v[48:51], a[116:119], v[80:95]
  s_waitcnt lgkmcnt(5)
  buffer_load_dwordx4 v23, s[12:15], s19 offen lds
  v_mfma_f32_32x32x16_bf16 v[64:79], v[52:55], a[120:123], v[64:79]
  s_cmp_gt_u32 s23, 3
  ds_read_b128 v[44:47], v13 offset:16384
  v_mfma_f32_32x32x16_bf16 v[80:95], v[52:55], a[124:127], v[80:95]
  s_waitcnt lgkmcnt(5)
  s_cselect_b32 s26, s20, 0
  v_mfma_f32_32x32x16_bf16 v[64:79], v[24:27], a[128:131], v[64:79]
  s_add_u32 s19, s19, s26
  ds_read_b128 v[48:51], v14 offset:16384
  v_mfma_f32_32x32x16_bf16 v[80:95], v[24:27], a[132:135], v[80:95]
  s_waitcnt lgkmcnt(5)
  s_add_u32 s25, s25, 32768
  v_mfma_f32_32x32x16_bf16 v[64:79], v[28:31], a[136:139], v[64:79]
  s_and_b32 s25, s25, 0x1ffff
  ds_read_b128 v[52:55], v15 offset:16384
  v_mfma_f32_32x32x16_bf16 v[80:95], v[28:31], a[140:143], v[80:95]
  s_waitcnt lgkmcnt(5)
  buffer_store_dwordx4 v[128:131], v7, s[4:7], s21 offen offset:0 sc1
  v_mfma_f32_32x32x16_bf16 v[64:79], v[32:35], a[144:147], v[64:79]
  ds_read_b128 v[24:27], v8 offset:24576
  v_mfma_f32_32x32x16_bf16 v[80:95], v[32:35], a[148:151], v[80:95]
  s_waitcnt lgkmcnt(5)
  v_mfma_f32_32x32x16_bf16 v[64:79], v[36:39], a[152:155], v[64:79]
  ds_read_b128 v[28:31], v9 offset:24576
  v_mfma_f32_32x32x16_bf16 v[80:95], v[36:39], a[156:159], v[80:95]
  s_waitcnt lgkmcnt(5)
  buffer_store_dwordx4 v[132:135], v7, s[4:7], s21 offen offset:1024 sc1
  v_mfma_f32_32x32x16_bf16 v[64:79], v[40:43], a[160:163], v[64:79]
  ds_read_b128 v[32:35], v10 offset:24576
  v_mfma_f32_32x32x16_bf16 v[80:95], v[40:43], a[164:167], v[80:95]
  s_waitcnt lgkmcnt(5)
  v_mfma_f32_32x32x16_bf16 v[64:79], v[44:47], a[168:171], v[64:79]
  ds_read_b128 v[36:39], v11 offset:24576
  v_mfma_f32_32x32x16_bf16 v[80:95], v[44:47], a[172:175], v[80:95]
  s_waitcnt lgkmcnt(5)
  buffer_store_dwordx4 v[136:139], v7, s[4:7], s21 offen offset:2048 sc1
  v_mfma_f32_32x32x16_bf16 v[64:79], v[48:51], a[176:179], v[64:79]
  ds_read_b128 v[40:43], v12 offset:24576
  v_mfma_f32_32x32x16_bf16 v[80:95], v[48:51], a[180:183], v[80:95]
  s_waitcnt lgkmcnt(5)
  v_mfma_f32_32x32x16_bf16 v[64:79], v[52:55], a[184:187], v[64:79]
  ds_read_b128 v[44:47], v13 offset:24576
  v_mfma_f32_32x32x16_bf16 v[80:95], v[52:55], a[188:191], v[80:95]
  s_waitcnt lgkmcnt(5)
  buffer_store_dwordx4 v[140:143], v7, s[4:7], s21 offen offset:3072 sc1
  v_mfma_f32_32x32x16_bf16 v[64:79], v[24:27], a[192:195], v[64:79]
  s_mov_b32 s21, s27
  ds_read_b128 v[48:51], v14 offset:24576
  v_mov_b32 v7, v2
  v_mfma_f32_32x32x16_bf16 v[80:95], v[24:27], a[196:199], v[80:95]
  s_waitcnt lgkmcnt(5)
  v_mfma_f32_32x32x16_bf16 v[64:79], v[28:31], a[200:203], v[64:79]
  s_add_u32 s27, s27, s22
  ds_read_b128 v[52:55], v15 offset:24576
  v_mfma_f32_32x32x16_bf16 v[80:95], v[28:31], a[204:207], v[80:95]
  s_waitcnt lgkmcnt(5)
  s_waitcnt vmcnt(17)
  s_barrier
  v_mfma_f32_32x32x16_bf16 v[64:79], v[32:35], a[208:211], v[64:79]
  ds_read_b128 v[24:27], v8 offset:32768
  v_mfma_f32_32x32x16_bf16 v[80:95], v[32:35], a[212:215], v[80:95]
  s_waitcnt lgkmcnt(5)
  v_mfma_f32_32x32x16_bf16 v[64:79], v[36:39], a[216:219], v[64:79]
  s_add_u32 s29, s29, 1
  ds_read_b128 v[28:31], v9 offset:32768
  v_mfma_f32_32x32x16_bf16 v[80:95], v[36:39], a[220:223], v[80:95]
  s_waitcnt lgkmcnt(5)
  s_max_i32 s30, s29, 0
  v_mov_b32 v144, s30
  v_mfma_f32_32x32x16_bf16 v[64:79], v[40:43], a[224:227], v[64:79]
  ds_read_b128 v[32:35], v10 offset:32768
  v_mfma_f32_32x32x16_bf16 v[80:95], v[40:43], a[228:231], v[80:95]
  s_waitcnt lgkmcnt(5)
  buffer_store_dword v144, v145, s[4:7], s31 offen sc1
  v_mfma_f32_32x32x16_bf16 v[64:79], v[44:47], a[232:235], v[64:79]
  ds_read_b128 v[36:39], v11 offset:32768
  v_mfma_f32_32x32x16_bf16 v[80:95], v[44:47], a[236:239], v[80:95]
  s_waitcnt lgkmcnt(5)
  v_mfma_f32_32x32x16_bf16 v[64:79], v[48:51], a[240:243], v[64:79]
  s_sub_u32 s23, s23, 1
  ds_read_b128 v[40:43], v12 offset:32768
  v_mfma_f32_32x32x16_bf16 v[80:95], v[48:51], a[244:247], v[80:95]
  s_waitcnt lgkmcnt(5)
  v_mfma_f32_32x32x16_bf16 v[64:79], v[52:55], a[248:251], v[64:79]
  s_cmp_eq_u32 s23, 0
  ds_read_b128 v[44:47], v13 offset:32768
  v_mfma_f32_32x32x16_bf16 v[80:95], v[52:55], a[252:255], v[80:95]
  s_cbranch_scc1 G_done0_8
  s_waitcnt lgkmcnt(5)
  v_mfma_f32_32x32x16_bf16 v[96:111], v[24:27], a[0:3], 0
  s_add_u32 m0, s25, 0
  ds_read_b128 v[48:51], v14 offset:32768
  v_mfma_f32_32x32x16_bf16 v[112:127], v[24:27], a[4:7], 0
  s_waitcnt lgkmcnt(5)
  buffer_load_dwordx4 v16, s[12:15], s19 offen lds
  v_mfma_f32_32x32x16_bf16 v[96:111], v[28:31], a[8:11], v[96:111]
  ds_read_b128 v[52:55], v15 offset:32768
  v_mul_f32 v64, s24, v64
  v_mul_f32 v65, s24, v65
  v_mfma_f32_32x32x16_bf16 v[112:127], v[28:31], a[12:15], v[112:127]
  s_waitcnt lgkmcnt(5)
  v_cvt_pk_bf16_f32 v128, v64, v65
  v_mul_f32 v66, s24, v66
  v_mfma_f32_32x32x16_bf16 v[96:111], v[32:35], a[16:19], v[96:111]
  s_add_u32 m0, s25, 1024
  ds_read_b128 v[24:27], v8 offset:40960
  v_mul_f32 v67, s24, v67
  v_cvt_pk_bf16_f32 v129, v66, v67
  v_mfma_f32_32x32x16_bf16 v[112:127], v[32:35], a[20:23], v[112:127]
  s_waitcnt lgkmcnt(5)
  buffer_load_dwordx4 v17, s[12:15], s19 offen lds
  v_mul_f32 v68, s24, v68
  v_mul_f32 v69, s24, v69
  v_mfma_f32_32x32x16_bf16 v[96:111], v[36:39], a[24:27], v[96:111]
  ds_read_b128 v[28:31], v9 offset:40960
  v_cvt_pk_bf16_f32 v130, v68, v69
  v_mul_f32 v70, s24, v70
  v_mfma_f32_32x32x16_bf16 v[112:127], v[36:39], a[28:31], v[112:127]
  s_waitcnt lgkmcnt(5)
  v_mul_f32 v71, s24, v71
  v_cvt_pk_bf16_f32 v131, v70, v71
  v_mfma_f32_32x32x16_bf16 v[96:111], v[40:43], a[32:35], v[96:111]
  s_add_u32 m0, s25, 2048
  ds_read_b128 v[32:35], v10 offset:40960
  v_mul_f32 v72, s24, v72
  v_mul_f32 v73, s24, v73
  v_mfma_f32_32x32x16_bf16 v[112:127], v[40:43], a[36:39], v[112:127]
  s_waitcnt lgkmcnt(5)
  buffer_load_dwordx4 v18, s[12:15], s19 offen lds
  v_cvt_pk_bf16_f32 v132, v72, v73
  v_mul_f32 v74, s24, v74
  v_mfma_f32_32x32x16_bf16 v[96:111], v[44:47], a[40:43], v[96:111]
  ds_read_b128 v[36:39], v11 offset:40960
  v_mul_f32 v75, s24, v75
  v_cvt_pk_bf16_f32 v133, v74, v75
  v_mfma_f32_32x32x16_bf16 v[112:127], v[44:47], a[44:47], v[112:127]
  s_waitcnt lgkmcnt(5)
  v_mul_f32 v76, s24, v76
  v_mul_f32 v77, s24, v77
  v_mfma_f32_32x32x16_bf16 v[96:111], v[48:51], a[48:51], v[96:111]
  s_add_u32 m0, s25, 3072
  ds_read_b128 v[40:43], v12 offset:40960
  v_cvt_pk_bf16_f32 v134, v76, v77
  v_mul_f32 v78, s24, v78
  v_mfma_f32_32x32x16_bf16 v[112:127], v[48:51], a[52:55], v[112:127]
  s_waitcnt lgkmcnt(5)
  buffer_load_dwordx4 v19, s[12:15], s19 offen lds
  v_mul_f32 v79, s24, v79
  v_cvt_pk_bf16_f32 v135, v78, v79
  v_mfma_f32_32x32x16_bf16 v[96:111], v[52:55], a[56:59], v[96:111]
  ds_read_b128 v[44:47], v13 offset:40960
  v_mul_f32 v80, s24, v80
  v_mul_f32 v81, s24, v81
  v_mfma_f32_32x32x16_bf16 v[112:127], v[52:55], a[60:63], v[112:127]
  s_waitcnt lgkmcnt(5)
  v_cvt_pk_bf16_f32 v136, v80, v81
  v_mul_f32 v82, s24, v82
  v_mfma_f32_32x32x16_bf16 v[96:111], v[24:27], a[64:67], v[96:111]
  s_add_u32 m0, s25, 4096
  ds_read_b128 v[48:51], v14 offset:40960
  v_mul_f32 v83, s24, v83
  v_cvt_pk_bf16_f32 v137, v82, v83
  v_mfma_f32_32x32x16_bf16 v[112:127], v[24:27], a[68:71], v[112:127]
  s_waitcnt lgkmcnt(5)
  buffer_load_dwordx4 v20, s[12:15], s19 offen lds
  v_mul_f32 v84, s24, v84
  v_mul_f32 v85, s24, v85
  v_mfma_f32_32x32x16_bf16 v[96:111], v[28:31], a[72:75], v[96:111]
  ds_read_b128 v[52:55], v15 offset:40960
  v_cvt_pk_bf16_f32 v138, v84, v85
  v_mul_f32 v86, s24, v86
  v_mfma_f32_32x32x16_bf16 v[112:127], v[28:31], a[76:79], v[112:127]
  s_waitcnt lgkmcnt(5)
  v_mul_f32 v87, s24, v87
  v_cvt_pk_bf16_f32 v139, v86, v87
  v_mfma_f32_32x32x16_bf16 v[96:111], v[32:35], a[80:83], v[96:111]
  s_add_u32 m0, s25, 5120
  ds_read_b128 v[24:27], v8 offset:49152
  v_mul_f32 v88, s24, v88
  v_mul_f32 v89, s24, v89
  v_mfma_f32_32x32x16_bf16 v[112:127], v[32:35], a[84:87], v[112:127]
  s_waitcnt lgkmcnt(5)
  buffer_load_dwordx4 v21, s[12:15], s19 offen lds
  v_cvt_pk_bf16_f32 v140, v88, v89
  v_mul_f32 v90, s24, v90
  v_mfma_f32_32x32x16_bf16 v[96:111], v[36:39], a[88:91], v[96:111]
  ds_read_b128 v[28:31], v9 offset:49152
  v_mul_f32 v91, s24, v91
  v_cvt_pk_bf16_f32 v141, v90, v91
  v_mfma_f32_32x32x16_bf16 v[112:127], v[36:39], a[92:95], v[112:127]
  s_waitcnt lgkmcnt(5)
  v_mul_f32 v92, s24, v92
  v_mul_f32 v93, s24, v93
  v_mfma_f32_32x32x16_bf16 v[96:111], v[40:43], a[96:99], v[96:111]
  s_add_u32 m0, s25, 6144
  ds_read_b128 v[32:35], v10 offset:49152
  v_cvt_pk_bf16_f32 v142, v92, v93
  v_mul_f32 v94, s24, v94
  v_mfma_f32_32x32x16_bf16 v[112:127], v[40:43], a[100:103], v[112:127]
  s_waitcnt lgkmcnt(5)
  buffer_load_dwordx4 v22, s[12:15], s19 offen lds
  v_mul_f32 v95, s24, v95
  v_cvt_pk_bf16_f32 v143, v94, v95
  v_mfma_f32_32x32x16_bf16 v[96:111], v[44:47], a[104:107], v[96:111]
  ds_read_b128 v[36:39], v11 offset:49152
  v_mfma_f32_32x32x16_bf16 v[112:127], v[44:47], a[108:111], v[112:127]
  s_waitcnt lgkmcnt(5)
  v_mfma_f32_32x32x16_bf16 v[96:111], v[48:51], a[112:115], v[96:111]
  s_add_u32 m0, s25, 7168
  ds_read_b128 v[40:43], v12 offset:49152
  v_mfma_f32_32x32x16_bf16 v[112:127], v[48:51], a[116:119], v[112:127]
  s_waitcnt lgkmcnt(5)
  buffer_load_dwordx4 v23, s[12:15], s19 offen lds
  v_mfma_f32_32x32x16_bf16 v[96:111], v[52:55], a[120:123], v[96:111]
  s_cmp_gt_u32 s23, 3
  ds_read_b128 v[44:47], v13 offset:49152
  v_mfma_f32_32x32x16_bf16 v[112:127], v[52:55], a[124:127], v[112:127]
  s_waitcnt lgkmcnt(5)
  s_cselect_b32 s26, s20, 0
  v_mfma_f32_32x32x16_bf16 v[96:111], v[24:27], a[128:131], v[96:111]
  s_add_u32 s19, s19, s26
  ds_read_b128 v[48:51], v14 offset:49152
  v_mfma_f32_32x32x16_bf16 v[112:127], v[24:27], a[132:135], v[112:127]
  s_waitcnt lgkmcnt(5)
  s_add_u32 s25, s25, 32768
  v_mfma_f32_32x32x16_bf16 v[96:111], v[28:31], a[136:139], v[96:111]
  s_and_b32 s25, s25, 0x1ffff
  ds_read_b128 v[52:55], v15 offset:49152
  v_mfma_f32_32x32x16_bf16 v[112:127], v[28:31], a[140:143], v[112:127]
  s_waitcnt lgkmcnt(5)
  buffer_store_dwordx4 v[128:131], v7, s[4:7], s21 offen offset:0 sc1
  v_mfma_f32_32x32x16_bf16 v[96:111], v[32:35], a[144:147], v[96:111]
  ds_read_b128 v[24:27], v8 offset:57344
  v_mfma_f32_32x32x16_bf16 v[112:127], v[32:35], a[148:151], v[112:127]
  s_waitcnt lgkmcnt(5)
  v_xor_b32 v8, 0x10000, v8
  v_mfma_f32_32x32x16_bf16 v[96:111], v[36:39], a[152:155], v[96:111]
  ds_read_b128 v[28:31], v9 offset:57344
  v_mfma_f32_32x32x16_bf16 v[112:127], v[36:39], a[156:159], v[112:127]
  s_waitcnt lgkmcnt(5)
  buffer_store_dwordx4 v[132:135], v7, s[4:7], s21 offen offset:1024 sc1
  v_xor_b32 v9, 0x10000, v9
  v_mfma_f32_32x32x16_bf16 v[96:111], v[40:43], a[160:163], v[96:111]
  ds_read_b128 v[32:35], v10 offset:57344
  v_mfma_f32_32x32x16_bf16 v[112:127], v[40:43], a[164:167], v[112:127]
  s_waitcnt lgkmcnt(5)
  v_xor_b32 v10, 0x10000, v10
  v_mfma_f32_32x32x16_bf16 v[96:111], v[44:47], a[168:171], v[96:111]
  ds_read_b128 v[36:39], v11 offset:57344
  v_mfma_f32_32x32x16_bf16 v[112:127], v[44:47], a[172:175], v[112:127]
  s_waitcnt lgkmcnt(5)
  buffer_store_dwordx4 v[136:139], v7, s[4:7], s21 offen offset:2048 sc1
  v_xor_b32 v11, 0x10000, v11
  v_mfma_f32_32x32x16_bf16 v[96:111], v[48:51], a[176:179], v[96:111]
  ds_read_b128 v[40:43], v12 offset:57344
  v_mfma_f32_32x32x16_bf16 v[112:127], v[48:51], a[180:183], v[112:127]
  s_waitcnt lgkmcnt(5)
  v_xor_b32 v12, 0x10000, v12
  v_mfma_f32_32x32x16_bf16 v[96:111], v[52:55], a[184:187], v[96:111]
  ds_read_b128 v[44:47], v13 offset:57344
  v_mfma_f32_32x32x16_bf16 v[112:127], v[52:55], a[188:191], v[112:127]
  s_waitcnt lgkmcnt(5)
  buffer_store_dwordx4 v[140:143], v7, s[4:7], s21 offen offset:3072 sc1
  v_xor_b32 v13, 0x10000, v13
  v_mfma_f32_32x32x16_bf16 v[96:111], v[24:27], a[192:195], v[96:111]
  s_mov_b32 s21, s27
  ds_read_b128 v[48:51], v14 offset:57344
  v_mov_b32 v7, v2
  v_mfma_f32_32x32x16_bf16 v[112:127], v[24:27], a[196:199], v[112:127]
  s_waitcnt lgkmcnt(5)
  v_xor_b32 v14, 0x10000, v14
  v_mfma_f32_32x32x16_bf16 v[96:111], v[28:31], a[200:203], v[96:111]
  s_add_u32 s27, s27, s22
  ds_read_b128 v[52:55], v15 offset:57344
  v_mfma_f32_32x32x16_bf16 v[112:127], v[28:31], a[204:207], v[112:127]
  s_waitcnt lgkmcnt(5)
  s_waitcnt vmcnt(17)
  s_barrier
  v_xor_b32 v15, 0x10000, v15
  v_mfma_f32_32x32x16_bf16 v[96:111], v[32:35], a[208:211], v[96:111]
  ds_read_b128 v[24:27], v8 offset:0
  v_mfma_f32_32x32x16_bf16 v[112:127], v[32:35], a[212:215], v[112:127]
  s_waitcnt lgkmcnt(5)
  v_mfma_f32_32x32x16_bf16 v[96:111], v[36:39], a[216:219], v[96:111]
  s_add_u32 s29, s29, 1
  ds_read_b128 v[28:31], v9 offset:0
  v_mfma_f32_32x32x16_bf16 v[112:127], v[36:39], a[220:223], v[112:127]
  s_waitcnt lgkmcnt(5)
  s_max_i32 s30, s29, 0
  v_mov_b32 v144, s30
  v_mfma_f32_32x32x16_bf16 v[96:111], v[40:43], a[224:227], v[96:111]
  ds_read_b128 v[32:35], v10 offset:0
  v_mfma_f32_32x32x16_bf16 v[112:127], v[40:43], a[228:231], v[112:127]
  s_waitcnt lgkmcnt(5)
  buffer_store_dword v144, v145, s[4:7], s31 offen sc1
  v_mfma_f32_32x32x16_bf16 v[96:111], v[44:47], a[232:235], v[96:111]
  ds_read_b128 v[36:39], v11 offset:0
  v_mfma_f32_32x32x16_bf16 v[112:127], v[44:47], a[236:239], v[112:127]
  s_waitcnt lgkmcnt(5)
  v_mfma_f32_32x32x16_bf16 v[96:111], v[48:51], a[240:243], v[96:111]
  s_sub_u32 s23, s23, 1
  ds_read_b128 v[40:43], v12 offset:0
  v_mfma_f32_32x32x16_bf16 v[112:127], v[48:51], a[244:247], v[112:127]
  s_waitcnt lgkmcnt(5)
  v_mfma_f32_32x32x16_bf16 v[96:111], v[52:55], a[248:251], v[96:111]
  s_cmp_eq_u32 s23, 0
  ds_read_b128 v[44:47], v13 offset:0
  v_mfma_f32_32x32x16_bf16 v[112:127], v[52:55], a[252:255], v[112:127]
  s_cbranch_scc1 G_done1_9
  s_branch G_top_7
G_done0_8:
  s_nop 7
  s_nop 3
  v_mul_f32 v64, s24, v64
  v_mul_f32 v65, s24, v65
  v_cvt_pk_bf16_f32 v128, v64, v65
  v_mul_f32 v66, s24, v66
  v_mul_f32 v67, s24, v67
  v_cvt_pk_bf16_f32 v129, v66, v67
  v_mul_f32 v68, s24, v68
  v_mul_f32 v69, s24, v69
  v_cvt_pk_bf16_f32 v130, v68, v69
  v_mul_f32 v70, s24, v70
  v_mul_f32 v71, s24, v71
  v_cvt_pk_bf16_f32 v131, v70, v71
  buffer_store_dwordx4 v[128:131], v7, s[4:7], s21 offen offset:0 sc1
  v_mul_f32 v72, s24, v72
  v_mul_f32 v73, s24, v73
  v_cvt_pk_bf16_f32 v132, v72, v73
  v_mul_f32 v74, s24, v74
  v_mul_f32 v75, s24, v75
  v_cvt_pk_bf16_f32 v133, v74, v75
  v_mul_f32 v76, s24, v76
  v_mul_f32 v77, s24, v77
  v_cvt_pk_bf16_f32 v134, v76, v77
  v_mul_f32 v78, s24, v78
  v_mul_f32 v79, s24, v79
  v_cvt_pk_bf16_f32 v135, v78, v79
  buffer_store_dwordx4 v[132:135], v7, s[4:7], s21 offen offset:1024 sc1
  v_mul_f32 v80, s24, v80
  v_mul_f32 v81, s24, v81
  v_cvt_pk_bf16_f32 v136, v80, v81
  v_mul_f32 v82, s24, v82
  v_mul_f32 v83, s24, v83
  v_cvt_pk_bf16_f32 v137, v82, v83
  v_mul_f32 v84, s24, v84
  v_mul_f32 v85, s24, v85
  v_cvt_pk_bf16_f32 v138, v84, v85
  v_mul_f32 v86, s24, v86
  v_mul_f32 v87, s24, v87
  v_cvt_pk_bf16_f32 v139, v86, v87
  buffer_store_dwordx4 v[136:139], v7, s[4:7], s21 offen offset:2048 sc1
  v_mul_f32 v88, s24, v88
  v_mul_f32 v89, s24, v89
  v_cvt_pk_bf16_f32 v140, v88, v89
  v_mul_f32 v90, s24, v90
  v_mul_f32 v91, s24, v91
  v_cvt_pk_bf16_f32 v141, v90, v91
  v_mul_f32 v92, s24, v92
  v_mul_f32 v93, s24, v93
  v_cvt_pk_bf16_f32 v142, v92, v93
  v_mul_f32 v94, s24, v94
  v_mul_f32 v95, s24, v95
  v_cvt_pk_bf16_f32 v143, v94, v95
  buffer_store_dwordx4 v[140:143], v7, s[4:7], s21 offen offset:3072 sc1
  s_branch G_fin_10
G_done1_9:
  s_nop 7
  s_nop 3
  v_mul_f32 v96, s24, v96
  v_mul_f32 v97, s24, v97
  v_cvt_pk_bf16_f32 v128, v96, v97
  v_mul_f32 v98, s24, v98
  v_mul_f32 v99, s24, v99
  v_cvt_pk_bf16_f32 v129, v98, v99
  v_mul_f32 v100, s24, v100
  v_mul_f32 v101, s24, v101
  v_cvt_pk_bf16_f32 v130, v100, v101
  v_mul_f32 v102, s24, v102
  v_mul_f32 v103, s24, v103
  v_cvt_pk_bf16_f32 v131, v102, v103
  buffer_store_dwordx4 v[128:131], v7, s[4:7], s21 offen offset:0 sc1
  v_mul_f32 v104, s24, v104
  v_mul_f32 v105, s24, v105
  v_cvt_pk_bf16_f32 v132, v104, v105
  v_mul_f32 v106, s24, v106
  v_mul_f32 v107, s24, v107
  v_cvt_pk_bf16_f32 v133, v106, v107
  v_mul_f32 v108, s24, v108
  v_mul_f32 v109, s24, v109
  v_cvt_pk_bf16_f32 v134, v108, v109
  v_mul_f32 v110, s24, v110
  v_mul_f32 v111, s24, v111
  v_cvt_pk_bf16_f32 v135, v110, v111
  buffer_store_dwordx4 v[132:135], v7, s[4:7], s21 offen offset:1024 sc1
  v_mul_f32 v112, s24, v112
  v_mul_f32 v113, s24, v113
  v_cvt_pk_bf16_f32 v136, v112, v113
  v_mul_f32 v114, s24, v114
  v_mul_f32 v115, s24, v115
  v_cvt_pk_bf16_f32 v137, v114, v115
  v_mul_f32 v116, s24, v116
  v_mul_f32 v117, s24, v117
  v_cvt_pk_bf16_f32 v138, v116, v117
  v_mul_f32 v118, s24, v118
  v_mul_f32 v119, s24, v119
  v_cvt_pk_bf16_f32 v139, v118, v119
  buffer_store_dwordx4 v[136:139], v7, s[4:7], s21 offen offset:2048 sc1
  v_mul_f32 v120, s24, v120
  v_mul_f32 v121, s24, v121
  v_cvt_pk_bf16_f32 v140, v120, v121
  v_mul_f32 v122, s24, v122
  v_mul_f32 v123, s24, v123
  v_cvt_pk_bf16_f32 v141, v122, v123
  v_mul_f32 v124, s24, v124
  v_mul_f32 v125, s24, v125
  v_cvt_pk_bf16_f32 v142, v124, v125
  v_mul_f32 v126, s24, v126
  v_mul_f32 v127, s24, v127
  v_cvt_pk_bf16_f32 v143, v126, v127
  buffer_store_dwordx4 v[140:143], v7, s[4:7], s21 offen offset:3072 sc1
G_fin_10:
  s_waitcnt vmcnt(0) lgkmcnt(0)
  s_barrier
  s_add_u32 s30, s29, 3
  v_mov_b32 v144, s30
  v_min_u32 v145, 1, v0
  v_lshlrev_b32 v145, 30, v145
  buffer_store_dword v144, v145, s[4:7], s31 offen sc1
P_end_2:
  s_mov_b32 s71, 0
  s_branch M_sg_12
M_sw_11:
  s_sleep 8
  s_add_u32 s71, s71, 1
  s_cmp_gt_u32 s71, 262144
  s_cbranch_scc1 M_exit
M_sg_12:
  s_mov_b32 s79, 0
  s_atomic_or s79, s[74:75], 128 glc
  s_waitcnt lgkmcnt(0)
  s_cmp_lt_u32 s79, 256
  s_cbranch_scc1 M_sw_11
  s_cmp_eq_u32 s65, 6
  s_cbranch_scc1 M_follow
  s_mov_b32 s68, 0
  s_mov_b32 s36, -1
  s_mov_b32 s69, s53
  s_mov_b32 s70, s54
M_att:
  s_mov_b32 s24, 0xf149f2ca
  s_mov_b32 s29, 0
  v_mov_b32 v6, 0
  v_mov_b32 v7, 0
  s_lshl_b32 s26, s16, 11
  v_add_u32 v3, s26, v2
  v_and_b32 v5, 31, v1
  v_lshrrev_b32 v12, 5, v1
  v_lshlrev_b32 v12, 2, v12
  v_sub_u32 v5, v5, v12
  s_lshl_b32 s26, s64, 19
  s_add_u32 s19, s26, 16777216
  s_add_u32 s20, s26, 33554432
  s_lshl_b32 s27, s69, 2
  s_add_u32 s27, s27, s16
  s_lshl_b32 s27, s27, 14
  s_add_u32 s25, s26, s27
  s_bfe_u32 s78, s70, 0x80000
  s_add_u32 s76, s67, 512
  s_mov_b32 s71, 0
  s_branch M_sg_14
M_sw_13:
  s_sleep 8
  s_add_u32 s71, s71, 1
  s_cmp_gt_u32 s71, 262144
  s_cbranch_scc1 M_exit
M_sg_14:
  s_mov_b32 s79, 0
  s_atomic_or s79, s[72:73], s76 glc
  s_waitcnt lgkmcnt(0)
  s_cmp_lt_u32 s79, s78
  s_cbranch_scc1 M_sw_13
  s_bfe_u32 s78, s70, 0x80008
  s_add_u32 s76, s67, 640
  s_mov_b32 s71, 0
  s_branch M_sg_16
M_sw_15:
  s_sleep 8
  s_add_u32 s71, s71, 1
  s_cmp_gt_u32 s71, 262144
  s_cbranch_scc1 M_exit
M_sg_16:
  s_mov_b32 s79, 0
  s_atomic_or s79, s[72:73], s76 glc
  s_waitcnt lgkmcnt(0)
  s_cmp_lt_u32 s79, s78
  s_cbranch_scc1 M_sw_15
  s_lshl_b32 s27, s69, 16
  s_add_u32 s27, s27, 16384
  s_add_u32 s17, s19, s27
M_kv_17:
  s_cmp_ge_u32 s17, s36
  s_cbranch_scc1 M_kvok_18
  s_mov_b32 s76, 0
  s_mov_b32 s78, 23
  s_mov_b32 s77, 335872
  s_cmp_eq_u32 s68, 1
  s_cmov_b32 s76, 128
  s_cmov_b32 s78, 27
  s_cmov_b32 s77, 114688
  s_cmp_eq_u32 s68, 2
  s_cmov_b32 s76, 768
  s_cmov_b32 s78, 14
  s_cmov_b32 s77, 0
  s_add_u32 s76, s76, s67
  s_mov_b32 s71, 0
  s_branch M_sg_20
M_sw_19:
  s_sleep 8
  s_add_u32 s71, s71, 1
  s_cmp_gt_u32 s71, 262144
  s_cbranch_scc1 M_exit
M_sg_20:
  s_mov_b32 s79, 0
  s_atomic_or s79, s[72:73], s76 glc
  s_waitcnt lgkmcnt(0)
  s_cmp_lt_u32 s79, s78
  s_cbranch_scc1 M_sw_19
  s_add_u32 s36, s77, s19
  s_add_u32 s68, s68, 1
  s_branch M_kv_17
M_kvok_18:
  s_add_u32 s28, s25, 0
  buffer_load_dwordx4 a[128:131], v2, s[4:7], s28 offen offset:0 sc1
  buffer_load_dwordx4 a[132:135], v2, s[4:7], s28 offen offset:1024 sc1
  buffer_load_dwordx4 a[136:139], v2, s[4:7], s28 offen offset:2048 sc1
  buffer_load_dwordx4 a[140:143], v2, s[4:7], s28 offen offset:3072 sc1
  s_add_u32 s28, s25, 4096
  buffer_load_dwordx4 a[144:147], v2, s[4:7], s28 offen offset:0 sc1
  buffer_load_dwordx4 a[148:151], v2, s[4:7], s28 offen offset:1024 sc1
  buffer_load_dwordx4 a[152:155], v2, s[4:7], s28 offen offset:2048 sc1
  buffer_load_dwordx4 a[156:159], v2, s[4:7], s28 offen offset:3072 sc1
  s_add_u32 s28, s25, 8192
  buffer_load_dwordx4 a[160:163], v2, s[4:7], s28 offen offset:0 sc1
  buffer_load_dwordx4 a[164:167], v2, s[4:7], s28 offen offset:1024 sc1
  buffer_load_dwordx4 a[168:171], v2, s[4:7], s28 offen offset:2048 sc1
  buffer_load_dwordx4 a[172:175], v2, s[4:7], s28 offen offset:3072 sc1
  s_add_u32 s28, s25, 12288
  buffer_load_dwordx4 a[176:179], v2, s[4:7], s28 offen offset:0 sc1
  buffer_load_dwordx4 a[180:183], v2, s[4:7], s28 offen offset:1024 sc1
  buffer_load_dwordx4 a[184:187], v2, s[4:7], s28 offen offset:2048 sc1
  buffer_load_dwordx4 a[188:191], v2, s[4:7], s28 offen offset:3072 sc1
A_again_21:
  s_lshl_b32 s27, s69, 16
  s_add_u32 s27, s27, 57344
  s_add_u32 s17, s19, s27
  s_add_u32 s18, s20, s27
  s_lshl_b32 s21, s16, 11
  s_mov_b32 m0, s21
  s_nop 0
  buffer_load_dwordx4 v3, s[4:7], s18 offen offset:0 sc1 lds
  buffer_load_dwordx4 v3, s[4:7], s18 offen offset:1024 sc1 lds
  s_add_u32 m0, s21, 8192
  s_nop 0
  buffer_load_dwordx4 v3, s[4:7], s17 offen offset:0 sc1 lds
  buffer_load_dwordx4 v3, s[4:7], s17 offen offset:1024 sc1 lds
  s_add_u32 s18, s18, 8192
  s_sub_u32 s18, s18, 8192
  s_max_i32 s18, s18, s20
  s_sub_u32 s17, s17, 8192
  s_max_i32 s17, s17, s19
  s_add_u32 s21, s21, 16384
  s_and_b32 s21, s21, 131071
  s_mov_b32 m0, s21
  s_nop 0
  buffer_load_dwordx4 v3, s[4:7], s18 offen offset:0 sc1 lds
  buffer_load_dwordx4 v3, s[4:7], s18 offen offset:1024 sc1 lds
  s_add_u32 m0, s21, 8192
  s_nop 0
  buffer_load_dwordx4 v3, s[4:7], s17 offen offset:0 sc1 lds
  buffer_load_dwordx4 v3, s[4:7], s17 offen offset:1024 sc1 lds
  s_sub_u32 s18, s18, 8192
  s_max_i32 s18, s18, s20
  s_sub_u32 s17, s17, 8192
  s_max_i32 s17, s17, s19
  s_add_u32 s21, s21, 16384
  s_and_b32 s21, s21, 131071
  s_mov_b32 m0, s21
  s_nop 0
  buffer_load_dwordx4 v3, s[4:7], s18 offen offset:0 sc1 lds
  buffer_load_dwordx4 v3, s[4:7], s18 offen offset:1024 sc1 lds
  s_add_u32 m0, s21, 8192
  s_nop 0
  buffer_load_dwordx4 v3, s[4:7], s17 offen offset:0 sc1 lds
  buffer_load_dwordx4 v3, s[4:7], s17 offen offset:1024 sc1 lds
  s_sub_u32 s18, s18, 8192
  s_max_i32 s18, s18, s20
  s_sub_u32 s17, s17, 8192
  s_max_i32 s17, s17, s19
  s_add_u32 s21, s21, 16384
  s_and_b32 s21, s21, 131071
  s_mov_b32 m0, s21
  s_nop 0
  buffer_load_dwordx4 v3, s[4:7], s18 offen offset:0 sc1 lds
  buffer_load_dwordx4 v3, s[4:7], s18 offen offset:1024 sc1 lds
  s_add_u32 m0, s21, 8192
  s_nop 0
  buffer_load_dwordx4 v3, s[4:7], s17 offen offset:0 sc1 lds
  buffer_load_dwordx4 v3, s[4:7], s17 offen offset:1024 sc1 lds
  s_sub_u32 s18, s18, 8192
  s_max_i32 s18, s18, s20
  s_sub_u32 s17, s17, 8192
  s_max_i32 s17, s17, s19
  s_add_u32 s21, s21, 16384
  s_and_b32 s21, s21, 131071
  s_mov_b32 m0, s21
  s_nop 0
  buffer_load_dwordx4 v3, s[4:7], s18 offen offset:0 sc1 lds
  buffer_load_dwordx4 v3, s[4:7], s18 offen offset:1024 sc1 lds
  s_add_u32 m0, s21, 8192
  s_nop 0
  buffer_load_dwordx4 v3, s[4:7], s17 offen offset:0 sc1 lds
  buffer_load_dwordx4 v3, s[4:7], s17 offen offset:1024 sc1 lds
  s_sub_u32 s18, s18, 8192
  s_max_i32 s18, s18, s20
  s_sub_u32 s17, s17, 8192
  s_max_i32 s17, s17, s19
  s_add_u32 s21, s21, 16384
  s_and_b32 s21, s21, 131071
  s_mov_b32 m0, s21
  s_nop 0
  buffer_load_dwordx4 v3, s[4:7], s18 offen offset:0 sc1 lds
  buffer_load_dwordx4 v3, s[4:7], s18 offen offset:1024 sc1 lds
  s_add_u32 m0, s21, 8192
  s_nop 0
  buffer_load_dwordx4 v3, s[4:7], s17 offen offset:0 sc1 lds
  buffer_load_dwordx4 v3, s[4:7], s17 offen offset:1024 sc1 lds
  v_accvgpr_write_b32 a0, 0
  v_accvgpr_write_b32 a1, 0
  v_accvgpr_write_b32 a2, 0
  v_accvgpr_write_b32 a3, 0
  v_accvgpr_write_b32 a4, 0
  v_accvgpr_write_b32 a5, 0
  v_accvgpr_write_b32 a6, 0
  v_accvgpr_write_b32 a7, 0
  v_accvgpr_write_b32 a8, 0
  v_accvgpr_write_b32 a9, 0
  v_accvgpr_write_b32 a10, 0
  v_accvgpr_write_b32 a11, 0
  v_accvgpr_write_b32 a12, 0
  v_accvgpr_write_b32 a13, 0
  v_accvgpr_write_b32 a14, 0
  v_accvgpr_write_b32 a15, 0
  v_accvgpr_write_b32 a16, 0
  v_accvgpr_write_b32 a17, 0
  v_accvgpr_write_b32 a18, 0
  v_accvgpr_write_b32 a19, 0
  v_accvgpr_write_b32 a20, 0
  v_accvgpr_write_b32 a21, 0
  v_accvgpr_write_b32 a22, 0
  v_accvgpr_write_b32 a23, 0
  v_accvgpr_write_b32 a24, 0
  v_accvgpr_write_b32 a25, 0
  v_accvgpr_write_b32 a26, 0
  v_accvgpr_write_b32 a27, 0
  v_accvgpr_write_b32 a28, 0
  v_accvgpr_write_b32 a29, 0
  v_accvgpr_write_b32 a30, 0
  v_accvgpr_write_b32 a31, 0
  v_accvgpr_write_b32 a32, 0
  v_accvgpr_write_b32 a33, 0
  v_accvgpr_write_b32 a34, 0
  v_accvgpr_write_b32 a35, 0
  v_accvgpr_write_b32 a36, 0
  v_accvgpr_write_b32 a37, 0
  v_accvgpr_write_b32 a38, 0
  v_accvgpr_write_b32 a39, 0
  v_accvgpr_write_b32 a40, 0
  v_accvgpr_write_b32 a41, 0
  v_accvgpr_write_b32 a42, 0
  v_accvgpr_write_b32 a43, 0
  v_accvgpr_write_b32 a44, 0
  v_accvgpr_write_b32 a45, 0
  v_accvgpr_write_b32 a46, 0
  v_accvgpr_write_b32 a47, 0
  v_accvgpr_write_b32 a48, 0
  v_accvgpr_write_b32 a49, 0
  v_accvgpr_write_b32 a50, 0
  v_accvgpr_write_b32 a51, 0
  v_accvgpr_write_b32 a52, 0
  v_accvgpr_write_b32 a53, 0
  v_accvgpr_write_b32 a54, 0
  v_accvgpr_write_b32 a55, 0
  v_accvgpr_write_b32 a56, 0
  v_accvgpr_write_b32 a57, 0
  v_accvgpr_write_b32 a58, 0
  v_accvgpr_write_b32 a59, 0
  v_accvgpr_write_b32 a60, 0
  v_accvgpr_write_b32 a61, 0
  v_accvgpr_write_b32 a62, 0
  v_accvgpr_write_b32 a63, 0
  v_accvgpr_write_b32 a64, 0
  v_accvgpr_write_b32 a65, 0
  v_accvgpr_write_b32 a66, 0
  v_accvgpr_write_b32 a67, 0
  v_accvgpr_write_b32 a68, 0
  v_accvgpr_write_b32 a69, 0
  v_accvgpr_write_b32 a70, 0
  v_accvgpr_write_b32 a71, 0
  v_accvgpr_write_b32 a72, 0
  v_accvgpr_write_b32 a73, 0
  v_accvgpr_write_b32 a74, 0
  v_accvgpr_write_b32 a75, 0
  v_accvgpr_write_b32 a76, 0
  v_accvgpr_write_b32 a77, 0
  v_accvgpr_write_b32 a78, 0
  v_accvgpr_write_b32 a79, 0
  v_accvgpr_write_b32 a80, 0
  v_accvgpr_write_b32 a81, 0
  v_accvgpr_write_b32 a82, 0
  v_accvgpr_write_b32 a83, 0
  v_accvgpr_write_b32 a84, 0
  v_accvgpr_write_b32 a85, 0
  v_accvgpr_write_b32 a86, 0
  v_accvgpr_write_b32 a87, 0
  v_accvgpr_write_b32 a88, 0
  v_accvgpr_write_b32 a89, 0
  v_accvgpr_write_b32 a90, 0
  v_accvgpr_write_b32 a91, 0
  v_accvgpr_write_b32 a92, 0
  v_accvgpr_write_b32 a93, 0
  v_accvgpr_write_b32 a94, 0
  v_accvgpr_write_b32 a95, 0
  v_accvgpr_write_b32 a96, 0
  v_accvgpr_write_b32 a97, 0
  v_accvgpr_write_b32 a98, 0
  v_accvgpr_write_b32 a99, 0
  v_accvgpr_write_b32 a100, 0
  v_accvgpr_write_b32 a101, 0
  v_accvgpr_write_b32 a102, 0
  v_accvgpr_write_b32 a103, 0
  v_accvgpr_write_b32 a104, 0
  v_accvgpr_write_b32 a105, 0
  v_accvgpr_write_b32 a106, 0
  v_accvgpr_write_b32 a107, 0
  v_accvgpr_write_b32 a108, 0
  v_accvgpr_write_b32 a109, 0
  v_accvgpr_write_b32 a110, 0
  v_accvgpr_write_b32 a111, 0
  v_accvgpr_write_b32 a112, 0
  v_accvgpr_write_b32 a113, 0
  v_accvgpr_write_b32 a114, 0
  v_accvgpr_write_b32 a115, 0
  v_accvgpr_write_b32 a116, 0
  v_accvgpr_write_b32 a117, 0
  v_accvgpr_write_b32 a118, 0
  v_accvgpr_write_b32 a119, 0
  v_accvgpr_write_b32 a120, 0
  v_accvgpr_write_b32 a121, 0
  v_accvgpr_write_b32 a122, 0
  v_accvgpr_write_b32 a123, 0
  v_accvgpr_write_b32 a124, 0
  v_accvgpr_write_b32 a125, 0
  v_accvgpr_write_b32 a126, 0
  v_accvgpr_write_b32 a127, 0
  v_mov_b32 v8, 0
  v_mov_b32 v9, 0
  v_mov_b32 v10, 0
  v_mov_b32 v11, 0
  v_mov_b32 v52, 0
  v_mov_b32 v53, 0
  v_mov_b32 v54, s24
  v_mov_b32 v55, s24
  v_mov_b32 v56, s24
  v_mov_b32 v57, s24
  v_mov_b32 v58, s24
  v_mov_b32 v59, s24
  v_mov_b32 v60, s24
  v_mov_b32 v61, s24
  v_mov_b32 v62, s24
  v_mov_b32 v63, s24
  v_mov_b32 v104, 0
  v_mov_b32 v105, 0
  v_mov_b32 v4, v2
  v_mov_b32 v64, s24
  v_mov_b32 v65, s24
  v_mov_b32 v66, s24
  v_mov_b32 v67, s24
  v_mov_b32 v68, s24
  v_mov_b32 v69, s24
  v_mov_b32 v70, s24
  v_mov_b32 v71, s24
  v_mov_b32 v72, s24
  v_mov_b32 v73, s24
  v_mov_b32 v74, s24
  v_mov_b32 v75, s24
  v_mov_b32 v76, s24
  v_mov_b32 v77, s24
  v_mov_b32 v78, s24
  v_mov_b32 v79, s24
  v_mov_b32 v12, s24
  v_cmp_le_i32 s[40:41], 0, v5
  v_cmp_le_i32 s[42:43], 1, v5
  v_cmp_le_i32 s[44:45], 2, v5
  v_cmp_le_i32 s[46:47], 3, v5
  v_cndmask_b32 v80, v12, v7, s[40:41]
  v_cndmask_b32 v81, v12, v7, s[42:43]
  v_cndmask_b32 v82, v12, v7, s[44:45]
  v_cndmask_b32 v83, v12, v7, s[46:47]
  v_cmp_le_i32 s[40:41], 8, v5
  v_cmp_le_i32 s[42:43], 9, v5
  v_cmp_le_i32 s[44:45], 10, v5
  v_cmp_le_i32 s[46:47], 11, v5
  v_cndmask_b32 v84, v12, v7, s[40:41]
  v_cndmask_b32 v85, v12, v7, s[42:43]
  v_cndmask_b32 v86, v12, v7, s[44:45]
  v_cndmask_b32 v87, v12, v7, s[46:47]
  v_cmp_le_i32 s[40:41], 16, v5
  v_cmp_le_i32 s[42:43], 17, v5
  v_cmp_le_i32 s[44:45], 18, v5
  v_cmp_le_i32 s[46:47], 19, v5
  v_cndmask_b32 v88, v12, v7, s[40:41]
  v_cndmask_b32 v89, v12, v7, s[42:43]
  v_cndmask_b32 v90, v12, v7, s[44:45]
  v_cndmask_b32 v91, v12, v7, s[46:47]
  v_cmp_le_i32 s[40:41], 24, v5
  v_cmp_le_i32 s[42:43], 25, v5
  v_cmp_le_i32 s[44:45], 26, v5
  v_cmp_le_i32 s[46:47], 27, v5
  v_cndmask_b32 v92, v12, v7, s[40:41]
  v_cndmask_b32 v93, v12, v7, s[42:43]
  v_cndmask_b32 v94, v12, v7, s[44:45]
  v_cndmask_b32 v95, v12, v7, s[46:47]
  s_lshl_b32 s22, s69, 3
  s_add_u32 s22, s22, 8
  s_lshl_b32 s26, s16, 1
  s_sub_u32 s23, 6, s26
  s_waitcnt vmcnt(20)
  s_barrier
  s_cmp_eq_u32 s23, 0
  s_cbranch_scc1 A_go_23
A_idle_22:
  s_waitcnt vmcnt(16)
  s_barrier
  s_sub_u32 s18, s18, 8192
  s_max_i32 s18, s18, s20
  s_sub_u32 s17, s17, 8192
  s_max_i32 s17, s17, s19
  s_add_u32 s21, s21, 16384
  s_and_b32 s21, s21, 131071
M_kv_24:
  s_cmp_ge_u32 s17, s36
  s_cbranch_scc1 M_kvok_25
  s_mov_b32 s76, 0
  s_mov_b32 s78, 23
  s_mov_b32 s77, 335872
  s_cmp_eq_u32 s68, 1
  s_cmov_b32 s76, 128
  s_cmov_b32 s78, 27
  s_cmov_b32 s77, 114688
  s_cmp_eq_u32 s68, 2
  s_cmov_b32 s76, 768
  s_cmov_b32 s78, 14
  s_cmov_b32 s77, 0
  s_add_u32 s76, s76, s67
  s_mov_b32 s71, 0
  s_branch M_sg_27
M_sw_26:
  s_sleep 8
  s_add_u32 s71, s71, 1
  s_cmp_gt_u32 s71, 262144
  s_cbranch_scc1 M_exit
M_sg_27:
  s_mov_b32 s79, 0
  s_atomic_or s79, s[72:73], s76 glc
  s_waitcnt lgkmcnt(0)
  s_cmp_lt_u32 s79, s78
  s_cbranch_scc1 M_sw_26
  s_add_u32 s36, s77, s19
  s_add_u32 s68, s68, 1
  s_branch M_kv_24
M_kvok_25:
  s_mov_b32 m0, s21
  s_nop 0
  buffer_load_dwordx4 v3, s[4:7], s18 offen offset:0 sc1 lds
  buffer_load_dwordx4 v3, s[4:7], s18 offen offset:1024 sc1 lds
  s_add_u32 m0, s21, 8192
  s_nop 0
  buffer_load_dwordx4 v3, s[4:7], s17 offen offset:0 sc1 lds
  buffer_load_dwordx4 v3, s[4:7], s17 offen offset:1024 sc1 lds
  v_add_u32 v4, 16384, v4
  v_and_b32 v4, 131071, v4
  s_sub_u32 s22, s22, 1
  s_sub_u32 s23, s23, 1
  s_cmp_lg_u32 s23, 0
  s_cbranch_scc1 A_idle_22
A_go_23:
  ds_read_b128 a[224:227], v4 offset:0
  ds_read_b128 a[228:231], v4 offset:2048
  ds_read_b128 a[232:235], v4 offset:4096
  ds_read_b128 a[236:239], v4 offset:6144
  ds_read_b128 a[240:243], v4 offset:1024
  ds_read_b128 a[244:247], v4 offset:3072
  ds_read_b128 a[248:251], v4 offset:5120
  ds_read_b128 a[252:255], v4 offset:7168
  ds_read_b128 a[192:195], v4 offset:8192
  ds_read_b128 a[196:199], v4 offset:9216
  ds_read_b128 a[200:203], v4 offset:10240
  ds_read_b128 a[204:207], v4 offset:11264
  ds_read_b128 a[208:211], v4 offset:12288
  ds_read_b128 a[212:215], v4 offset:13312
  ds_read_b128 a[216:219], v4 offset:14336
  ds_read_b128 a[220:223], v4 offset:15360
  v_add_u32 v4, 16384, v4
  v_and_b32 v4, 131071, v4
  s_waitcnt lgkmcnt(8)
.p2align 6
A_top_28:
  s_waitcnt lgkmcnt(7)
  v_mfma_f32_32x32x16_bf16 v[32:47], a[192:195], a[128:131], v[64:79]
  s_waitcnt lgkmcnt(6)
  v_exp_f32 v54, v54
  v_add_f32 v11, v11, v53
  v_cvt_pk_bf16_f32 v106, v52, v53
  v_mfma_f32_32x32x16_bf16 v[32:47], a[196:199], a[132:135], v[32:47]
  s_waitcnt lgkmcnt(4)
  v_exp_f32 v55, v55
  v_add_f32 v10, v10, v54
  v_mfma_f32_32x32x16_bf16 v[32:47], a[200:203], a[136:139], v[32:47]
  v_exp_f32 v56, v56
  v_add_f32 v11, v11, v55
  v_cvt_pk_bf16_f32 v107, v54, v55
  v_mfma_f32_32x32x16_bf16 v[32:47], a[204:207], a[140:143], v[32:47]
  s_waitcnt lgkmcnt(2)
  v_exp_f32 v57, v57
  v_add_f32 v10, v10, v56
  v_mfma_f32_32x32x16_bf16 v[32:47], a[208:211], a[144:147], v[32:47]
  v_exp_f32 v58, v58
  v_add_f32 v11, v11, v57
  v_cvt_pk_bf16_f32 v108, v56, v57
  v_mfma_f32_32x32x16_bf16 v[32:47], a[212:215], a[148:151], v[32:47]
  s_waitcnt lgkmcnt(0)
  v_exp_f32 v59, v59
  v_add_f32 v10, v10, v58
  v_mfma_f32_32x32x16_bf16 v[32:47], a[216:219], a[152:155], v[32:47]
  v_exp_f32 v60, v60
  v_add_f32 v11, v11, v59
  v_cvt_pk_bf16_f32 v109, v58, v59
  v_mfma_f32_32x32x16_bf16 v[32:47], a[220:223], a[156:159], v[32:47]
  s_waitcnt vmcnt(16)
  s_barrier
  v_exp_f32 v61, v61
  v_add_f32 v10, v10, v60
  v_mfma_f32_32x32x16_bf16 a[64:79], a[224:227], v[104:107], a[64:79]
  ds_read_b128 a[224:227], v4 offset:0
  v_exp_f32 v62, v62
  v_add_f32 v11, v11, v61
  v_cvt_pk_bf16_f32 v110, v60, v61
  v_mfma_f32_32x32x16_bf16 a[80:95], a[228:231], v[104:107], a[80:95]
  s_sub_u32 s18, s18, 8192
  ds_read_b128 a[228:231], v4 offset:2048
  v_exp_f32 v63, v63
  v_add_f32 v10, v10, v62
  v_mfma_f32_32x32x16_bf16 a[96:111], a[232:235], v[104:107], a[96:111]
  s_max_i32 s18, s18, s20
  ds_read_b128 a[232:235], v4 offset:4096
  v_exp_f32 v32, v32
  v_add_f32 v11, v11, v63
  v_cvt_pk_bf16_f32 v111, v62, v63
  v_mfma_f32_32x32x16_bf16 a[112:127], a[236:239], v[104:107], a[112:127]
  s_sub_u32 s17, s17, 8192
  ds_read_b128 a[236:239], v4 offset:6144
  v_exp_f32 v33, v33
  v_add_f32 v8, v8, v32
  v_mfma_f32_32x32x16_bf16 a[64:79], a[240:243], v[108:111], a[64:79]
  s_max_i32 s17, s17, s19
  ds_read_b128 a[240:243], v4 offset:1024
  v_exp_f32 v34, v34
  v_add_f32 v9, v9, v33
  v_cvt_pk_bf16_f32 v96, v32, v33
  v_mfma_f32_32x32x16_bf16 a[80:95], a[244:247], v[108:111], a[80:95]
  s_add_u32 s21, s21, 16384
  ds_read_b128 a[244:247], v4 offset:3072
  v_exp_f32 v35, v35
  v_add_f32 v8, v8, v34
  v_mfma_f32_32x32x16_bf16 a[96:111], a[248:251], v[108:111], a[96:111]
  s_and_b32 s21, s21, 131071
  ds_read_b128 a[248:251], v4 offset:5120
  v_exp_f32 v36, v36
  v_add_f32 v9, v9, v35
  v_cvt_pk_bf16_f32 v97, v34, v35
  v_mfma_f32_32x32x16_bf16 a[112:127], a[252:255], v[108:111], a[112:127]
  ds_read_b128 a[252:255], v4 offset:7168
  v_exp_f32 v37, v37
  v_add_f32 v8, v8, v36
  v_mfma_f32_32x32x16_bf16 v[48:63], a[192:195], a[160:163], v[80:95]
  s_add_u32 s23, s23, 1
  ds_read_b128 a[192:195], v4 offset:8192
  v_exp_f32 v38, v38
  v_add_f32 v9, v9, v37
  v_cvt_pk_bf16_f32 v98, v36, v37
  v_mfma_f32_32x32x16_bf16 v[48:63], a[196:199], a[164:167], v[48:63]
  s_sub_u32 s22, s22, 1
  ds_read_b128 a[196:199], v4 offset:9216
  v_exp_f32 v39, v39
  v_add_f32 v8, v8, v38
  v_mfma_f32_32x32x16_bf16 v[48:63], a[200:203], a[168:171], v[48:63]
  s_cmp_lt_u32 s23, 3
  ds_read_b128 a[200:203], v4 offset:10240
  v_exp_f32 v40, v40
  v_add_f32 v9, v9, v39
  v_cvt_pk_bf16_f32 v99, v38, v39
  v_mfma_f32_32x32x16_bf16 v[48:63], a[204:207], a[172:175], v[48:63]
  s_cbranch_scc1 A_upd_29
A_back_30:
  ds_read_b128 a[204:207], v4 offset:11264
  v_exp_f32 v41, v41
  v_add_f32 v8, v8, v40
  v_mfma_f32_32x32x16_bf16 v[48:63], a[208:211], a[176:179], v[48:63]
  s_cmp_lt_u32 s17, s36
  ds_read_b128 a[208:211], v4 offset:12288
  v_exp_f32 v42, v42
  v_add_f32 v9, v9, v41
  v_cvt_pk_bf16_f32 v100, v40, v41
  v_mfma_f32_32x32x16_bf16 v[48:63], a[212:215], a[180:183], v[48:63]
  s_cbranch_scc1 A_kvw_32
A_kvb_33:
  ds_read_b128 a[212:215], v4 offset:13312
  v_exp_f32 v43, v43
  v_add_f32 v8, v8, v42
  v_mfma_f32_32x32x16_bf16 v[48:63], a[216:219], a[184:187], v[48:63]
  s_mov_b32 m0, s21
  ds_read_b128 a[216:219], v4 offset:14336
  v_exp_f32 v44, v44
  v_add_f32 v9, v9, v43
  v_cvt_pk_bf16_f32 v101, v42, v43
  v_mfma_f32_32x32x16_bf16 v[48:63], a[220:223], a[188:191], v[48:63]
  s_waitcnt lgkmcnt(13)
  ds_read_b128 a[220:223], v4 offset:15360
  v_exp_f32 v45, v45
  v_add_f32 v8, v8, v44
  v_mfma_f32_32x32x16_bf16 a[0:15], a[224:227], v[96:99], a[0:15]
  buffer_load_dwordx4 v3, s[4:7], s18 offen offset:0 sc1 lds
  v_exp_f32 v46, v46
  v_add_f32 v9, v9, v45
  v_cvt_pk_bf16_f32 v102, v44, v45
  v_mfma_f32_32x32x16_bf16 a[16:31], a[228:231], v[96:99], a[16:31]
  s_waitcnt lgkmcnt(12)
  v_exp_f32 v47, v47
  v_add_f32 v8, v8, v46
  v_add_u32 v4, 16384, v4
  v_mfma_f32_32x32x16_bf16 a[32:47], a[232:235], v[96:99], a[32:47]
  buffer_load_dwordx4 v3, s[4:7], s18 offen offset:1024 sc1 lds
  v_exp_f32 v48, v48
  v_add_f32 v9, v9, v47
  v_cvt_pk_bf16_f32 v103, v46, v47
  v_mfma_f32_32x32x16_bf16 a[48:63], a[236:239], v[96:99], a[48:63]
  s_waitcnt lgkmcnt(10)
  s_add_u32 m0, s21, 8192
  v_exp_f32 v49, v49
  v_add_f32 v10, v10, v48
  v_and_b32 v4, 131071, v4
  v_mfma_f32_32x32x16_bf16 a[0:15], a[240:243], v[100:103], a[0:15]
  buffer_load_dwordx4 v3, s[4:7], s17 offen offset:0 sc1 lds
  v_exp_f32 v50, v50
  v_add_f32 v11, v11, v49
  v_cvt_pk_bf16_f32 v104, v48, v49
  v_mfma_f32_32x32x16_bf16 a[16:31], a[244:247], v[100:103], a[16:31]
  s_waitcnt lgkmcnt(8)
  s_cmp_lg_u32 s22, 0
  v_exp_f32 v51, v51
  v_add_f32 v10, v10, v50
  v_mfma_f32_32x32x16_bf16 a[32:47], a[248:251], v[100:103], a[32:47]
  buffer_load_dwordx4 v3, s[4:7], s17 offen offset:1024 sc1 lds
  v_exp_f32 v52, v52
  v_add_f32 v11, v11, v51
  v_cvt_pk_bf16_f32 v105, v50, v51
  v_mfma_f32_32x32x16_bf16 a[48:63], a[252:255], v[100:103], a[48:63]
  v_exp_f32 v53, v53
  v_add_f32 v10, v10, v52
  s_cbranch_scc1 A_top_28
  v_exp_f32 v54, v54
  v_add_f32 v11, v11, v53
  v_cvt_pk_bf16_f32 v106, v52, v53
  v_exp_f32 v55, v55
  v_add_f32 v10, v10, v54
  v_exp_f32 v56, v56
  v_add_f32 v11, v11, v55
  v_cvt_pk_bf16_f32 v107, v54, v55
  v_exp_f32 v57, v57
  v_add_f32 v10, v10, v56
  v_exp_f32 v58, v58
  v_add_f32 v11, v11, v57
  v_cvt_pk_bf16_f32 v108, v56, v57
  v_exp_f32 v59, v59
  v_add_f32 v10, v10, v58
  v_exp_f32 v60, v60
  v_add_f32 v11, v11, v59
  v_cvt_pk_bf16_f32 v109, v58, v59
  v_exp_f32 v61, v61
  v_add_f32 v10, v10, v60
  v_exp_f32 v62, v62
  v_add_f32 v11, v11, v61
  v_cvt_pk_bf16_f32 v110, v60, v61
  v_exp_f32 v63, v63
  v_add_f32 v10, v10, v62
  v_add_f32 v11, v11, v63
  v_cvt_pk_bf16_f32 v111, v62, v63
  s_nop 1
  v_mfma_f32_32x32x16_bf16 a[64:79], a[224:227], v[104:107], a[64:79]
  v_mfma_f32_32x32x16_bf16 a[80:95], a[228:231], v[104:107], a[80:95]
  v_mfma_f32_32x32x16_bf16 a[96:111], a[232:235], v[104:107], a[96:111]
  v_mfma_f32_32x32x16_bf16 a[112:127], a[236:239], v[104:107], a[112:127]
  v_mfma_f32_32x32x16_bf16 a[64:79], a[240:243], v[108:111], a[64:79]
  v_mfma_f32_32x32x16_bf16 a[80:95], a[244:247], v[108:111], a[80:95]
  v_mfma_f32_32x32x16_bf16 a[96:111], a[248:251], v[108:111], a[96:111]
  v_mfma_f32_32x32x16_bf16 a[112:127], a[252:255], v[108:111], a[112:127]
  v_add_f32 v8, v8, v9
  v_mov_b32 v9, v8
  s_nop 1
  v_permlane32_swap_b32 v8, v9
  s_nop 1
  v_add_f32 v8, v8, v9
  v_add_f32 v10, v10, v11
  v_mov_b32 v11, v10
  s_nop 1
  v_permlane32_swap_b32 v10, v11
  s_nop 1
  v_add_f32 v10, v10, v11
  v_subrev_u32 v12, 0x2f800000, v8
  v_subrev_u32 v13, 0x2f800000, v10
  v_max_u32 v12, v12, v13
  v_cmp_le_u32 vcc, 0x28000000, v12
  s_nop 1
  s_cmp_lg_u64 vcc, 0
  s_cselect_b32 s26, 1, 0
  v_mov_b32 v12, s26
  s_lshl_b32 s26, s16, 2
  s_add_u32 s26, s26, 131072
  v_mov_b32 v13, s26
  ds_write_b32 v13, v12
  v_mov_b32 v14, 131072
  s_waitcnt vmcnt(0) lgkmcnt(0)
  s_barrier
  ds_read_b128 v[16:19], v14
  v_rcp_f32 v8, v8
  v_rcp_f32 v10, v10
  s_waitcnt lgkmcnt(0)
  v_or3_b32 v12, v16, v17, v18
  v_or_b32 v12, v12, v19
  s_nop 0
  v_readfirstlane_b32 s26, v12
  s_nop 1
  s_cmp_gt_u32 s26, s29
  s_cbranch_scc1 A_slow_34
  s_add_u32 s28, s25, 100663296
  v_accvgpr_read_b32 v112, a0
  v_accvgpr_read_b32 v113, a1
  v_accvgpr_read_b32 v114, a2
  v_accvgpr_read_b32 v115, a3
  v_accvgpr_read_b32 v116, a4
  v_accvgpr_read_b32 v117, a5
  v_accvgpr_read_b32 v118, a6
  v_accvgpr_read_b32 v119, a7
  v_pk_mul_f32 v[112:113], v[112:113], v[8:9] op_sel_hi:[1,0]
  v_pk_mul_f32 v[114:115], v[114:115], v[8:9] op_sel_hi:[1,0]
  v_pk_mul_f32 v[116:117], v[116:117], v[8:9] op_sel_hi:[1,0]
  v_pk_mul_f32 v[118:119], v[118:119], v[8:9] op_sel_hi:[1,0]
  v_cvt_pk_bf16_f32 v120, v112, v113
  v_cvt_pk_bf16_f32 v121, v114, v115
  v_cvt_pk_bf16_f32 v122, v116, v117
  v_cvt_pk_bf16_f32 v123, v118, v119
  buffer_store_dwordx4 v[120:123], v2, s[4:7], s28 offen offset:0 sc1
  v_accvgpr_read_b32 v124, a8
  v_accvgpr_read_b32 v125, a9
  v_accvgpr_read_b32 v126, a10
  v_accvgpr_read_b32 v127, a11
  v_accvgpr_read_b32 v128, a12
  v_accvgpr_read_b32 v129, a13
  v_accvgpr_read_b32 v130, a14
  v_accvgpr_read_b32 v131, a15
  v_pk_mul_f32 v[124:125], v[124:125], v[8:9] op_sel_hi:[1,0]
  v_pk_mul_f32 v[126:127], v[126:127], v[8:9] op_sel_hi:[1,0]
  v_pk_mul_f32 v[128:129], v[128:129], v[8:9] op_sel_hi:[1,0]
  v_pk_mul_f32 v[130:131], v[130:131], v[8:9] op_sel_hi:[1,0]
  v_cvt_pk_bf16_f32 v132, v124, v125
  v_cvt_pk_bf16_f32 v133, v126, v127
  v_cvt_pk_bf16_f32 v134, v128, v129
  v_cvt_pk_bf16_f32 v135, v130, v131
  buffer_store_dwordx4 v[132:135], v2, s[4:7], s28 offen offset:1024 sc1
  v_accvgpr_read_b32 v136, a16
  v_accvgpr_read_b32 v137, a17
  v_accvgpr_read_b32 v138, a18
  v_accvgpr_read_b32 v139, a19
  v_accvgpr_read_b32 v140, a20
  v_accvgpr_read_b32 v141, a21
  v_accvgpr_read_b32 v142, a22
  v_accvgpr_read_b32 v143, a23
  v_pk_mul_f32 v[136:137], v[136:137], v[8:9] op_sel_hi:[1,0]
  v_pk_mul_f32 v[138:139], v[138:139], v[8:9] op_sel_hi:[1,0]
  v_pk_mul_f32 v[140:141], v[140:141], v[8:9] op_sel_hi:[1,0]
  v_pk_mul_f32 v[142:143], v[142:143], v[8:9] op_sel_hi:[1,0]
  v_cvt_pk_bf16_f32 v144, v136, v137
  v_cvt_pk_bf16_f32 v145, v138, v139
  v_cvt_pk_bf16_f32 v146, v140, v141
  v_cvt_pk_bf16_f32 v147, v142, v143
  buffer_store_dwordx4 v[144:147], v2, s[4:7], s28 offen offset:2048 sc1
  v_accvgpr_read_b32 v148, a24
  v_accvgpr_read_b32 v149, a25
  v_accvgpr_read_b32 v150, a26
  v_accvgpr_read_b32 v151, a27
  v_accvgpr_read_b32 v152, a28
  v_accvgpr_read_b32 v153, a29
  v_accvgpr_read_b32 v154, a30
  v_accvgpr_read_b32 v155, a31
  v_pk_mul_f32 v[148:149], v[148:149], v[8:9] op_sel_hi:[1,0]
  v_pk_mul_f32 v[150:151], v[150:151], v[8:9] op_sel_hi:[1,0]
  v_pk_mul_f32 v[152:153], v[152:153], v[8:9] op_sel_hi:[1,0]
  v_pk_mul_f32 v[154:155], v[154:155], v[8:9] op_sel_hi:[1,0]
  v_cvt_pk_bf16_f32 v156, v148, v149
  v_cvt_pk_bf16_f32 v157, v150, v151
  v_cvt_pk_bf16_f32 v158, v152, v153
  v_cvt_pk_bf16_f32 v159, v154, v155
  buffer_store_dwordx4 v[156:159], v2, s[4:7], s28 offen offset:3072 sc1
  s_add_u32 s28, s25, 100667392
  v_accvgpr_read_b32 v112, a32
  v_accvgpr_read_b32 v113, a33
  v_accvgpr_read_b32 v114, a34
  v_accvgpr_read_b32 v115, a35
  v_accvgpr_read_b32 v116, a36
  v_accvgpr_read_b32 v117, a37
  v_accvgpr_read_b32 v118, a38
  v_accvgpr_read_b32 v119, a39
  v_pk_mul_f32 v[112:113], v[112:113], v[8:9] op_sel_hi:[1,0]
  v_pk_mul_f32 v[114:115], v[114:115], v[8:9] op_sel_hi:[1,0]
  v_pk_mul_f32 v[116:117], v[116:117], v[8:9] op_sel_hi:[1,0]
  v_pk_mul_f32 v[118:119], v[118:119], v[8:9] op_sel_hi:[1,0]
  v_cvt_pk_bf16_f32 v120, v112, v113
  v_cvt_pk_bf16_f32 v121, v114, v115
  v_cvt_pk_bf16_f32 v122, v116, v117
  v_cvt_pk_bf16_f32 v123, v118, v119
  buffer_store_dwordx4 v[120:123], v2, s[4:7], s28 offen offset:0 sc1
  v_accvgpr_read_b32 v124, a40
  v_accvgpr_read_b32 v125, a41
  v_accvgpr_read_b32 v126, a42
  v_accvgpr_read_b32 v127, a43
  v_accvgpr_read_b32 v128, a44
  v_accvgpr_read_b32 v129, a45
  v_accvgpr_read_b32 v130, a46
  v_accvgpr_read_b32 v131, a47
  v_pk_mul_f32 v[124:125], v[124:125], v[8:9] op_sel_hi:[1,0]
  v_pk_mul_f32 v[126:127], v[126:127], v[8:9] op_sel_hi:[1,0]
  v_pk_mul_f32 v[128:129], v[128:129], v[8:9] op_sel_hi:[1,0]
  v_pk_mul_f32 v[130:131], v[130:131], v[8:9] op_sel_hi:[1,0]
  v_cvt_pk_bf16_f32 v132, v124, v125
  v_cvt_pk_bf16_f32 v133, v126, v127
  v_cvt_pk_bf16_f32 v134, v128, v129
  v_cvt_pk_bf16_f32 v135, v130, v131
  buffer_store_dwordx4 v[132:135], v2, s[4:7], s28 offen offset:1024 sc1
  v_accvgpr_read_b32 v136, a48
  v_accvgpr_read_b32 v137, a49
  v_accvgpr_read_b32 v138, a50
  v_accvgpr_read_b32 v139, a51
  v_accvgpr_read_b32 v140, a52
  v_accvgpr_read_b32 v141, a53
  v_accvgpr_read_b32 v142, a54
  v_accvgpr_read_b32 v143, a55
  v_pk_mul_f32 v[136:137], v[136:137], v[8:9] op_sel_hi:[1,0]
  v_pk_mul_f32 v[138:139], v[138:139], v[8:9] op_sel_hi:[1,0]
  v_pk_mul_f32 v[140:141], v[140:141], v[8:9] op_sel_hi:[1,0]
  v_pk_mul_f32 v[142:143], v[142:143], v[8:9] op_sel_hi:[1,0]
  v_cvt_pk_bf16_f32 v144, v136, v137
  v_cvt_pk_bf16_f32 v145, v138, v139
  v_cvt_pk_bf16_f32 v146, v140, v141
  v_cvt_pk_bf16_f32 v147, v142, v143
  buffer_store_dwordx4 v[144:147], v2, s[4:7], s28 offen offset:2048 sc1
  v_accvgpr_read_b32 v148, a56
  v_accvgpr_read_b32 v149, a57
  v_accvgpr_read_b32 v150, a58
  v_accvgpr_read_b32 v151, a59
  v_accvgpr_read_b32 v152, a60
  v_accvgpr_read_b32 v153, a61
  v_accvgpr_read_b32 v154, a62
  v_accvgpr_read_b32 v155, a63
  v_pk_mul_f32 v[148:149], v[148:149], v[8:9] op_sel_hi:[1,0]
  v_pk_mul_f32 v[150:151], v[150:151], v[8:9] op_sel_hi:[1,0]
  v_pk_mul_f32 v[152:153], v[152:153], v[8:9] op_sel_hi:[1,0]
  v_pk_mul_f32 v[154:155], v[154:155], v[8:9] op_sel_hi:[1,0]
  v_cvt_pk_bf16_f32 v156, v148, v149
  v_cvt_pk_bf16_f32 v157, v150, v151
  v_cvt_pk_bf16_f32 v158, v152, v153
  v_cvt_pk_bf16_f32 v159, v154, v155
  buffer_store_dwordx4 v[156:159], v2, s[4:7], s28 offen offset:3072 sc1
  s_add_u32 s28, s25, 100671488
  v_accvgpr_read_b32 v112, a64
  v_accvgpr_read_b32 v113, a65
  v_accvgpr_read_b32 v114, a66
  v_accvgpr_read_b32 v115, a67
  v_accvgpr_read_b32 v116, a68
  v_accvgpr_read_b32 v117, a69
  v_accvgpr_read_b32 v118, a70
  v_accvgpr_read_b32 v119, a71
  v_pk_mul_f32 v[112:113], v[112:113], v[10:11] op_sel_hi:[1,0]
  v_pk_mul_f32 v[114:115], v[114:115], v[10:11] op_sel_hi:[1,0]
  v_pk_mul_f32 v[116:117], v[116:117], v[10:11] op_sel_hi:[1,0]
  v_pk_mul_f32 v[118:119], v[118:119], v[10:11] op_sel_hi:[1,0]
  v_cvt_pk_bf16_f32 v120, v112, v113
  v_cvt_pk_bf16_f32 v121, v114, v115
  v_cvt_pk_bf16_f32 v122, v116, v117
  v_cvt_pk_bf16_f32 v123, v118, v119
  buffer_store_dwordx4 v[120:123], v2, s[4:7], s28 offen offset:0 sc1
  v_accvgpr_read_b32 v124, a72
  v_accvgpr_read_b32 v125, a73
  v_accvgpr_read_b32 v126, a74
  v_accvgpr_read_b32 v127, a75
  v_accvgpr_read_b32 v128, a76
  v_accvgpr_read_b32 v129, a77
  v_accvgpr_read_b32 v130, a78
  v_accvgpr_read_b32 v131, a79
  v_pk_mul_f32 v[124:125], v[124:125], v[10:11] op_sel_hi:[1,0]
  v_pk_mul_f32 v[126:127], v[126:127], v[10:11] op_sel_hi:[1,0]
  v_pk_mul_f32 v[128:129], v[128:129], v[10:11] op_sel_hi:[1,0]
  v_pk_mul_f32 v[130:131], v[130:131], v[10:11] op_sel_hi:[1,0]
  v_cvt_pk_bf16_f32 v132, v124, v125
  v_cvt_pk_bf16_f32 v133, v126, v127
  v_cvt_pk_bf16_f32 v134, v128, v129
  v_cvt_pk_bf16_f32 v135, v130, v131
  buffer_store_dwordx4 v[132:135], v2, s[4:7], s28 offen offset:1024 sc1
  v_accvgpr_read_b32 v136, a80
  v_accvgpr_read_b32 v137, a81
  v_accvgpr_read_b32 v138, a82
  v_accvgpr_read_b32 v139, a83
  v_accvgpr_read_b32 v140, a84
  v_accvgpr_read_b32 v141, a85
  v_accvgpr_read_b32 v142, a86
  v_accvgpr_read_b32 v143, a87
  v_pk_mul_f32 v[136:137], v[136:137], v[10:11] op_sel_hi:[1,0]
  v_pk_mul_f32 v[138:139], v[138:139], v[10:11] op_sel_hi:[1,0]
  v_pk_mul_f32 v[140:141], v[140:141], v[10:11] op_sel_hi:[1,0]
  v_pk_mul_f32 v[142:143], v[142:143], v[10:11] op_sel_hi:[1,0]
  v_cvt_pk_bf16_f32 v144, v136, v137
  v_cvt_pk_bf16_f32 v145, v138, v139
  v_cvt_pk_bf16_f32 v146, v140, v141
  v_cvt_pk_bf16_f32 v147, v142, v143
  buffer_store_dwordx4 v[144:147], v2, s[4:7], s28 offen offset:2048 sc1
  v_accvgpr_read_b32 v148, a88
  v_accvgpr_read_b32 v149, a89
  v_accvgpr_read_b32 v150, a90
  v_accvgpr_read_b32 v151, a91
  v_accvgpr_read_b32 v152, a92
  v_accvgpr_read_b32 v153, a93
  v_accvgpr_read_b32 v154, a94
  v_accvgpr_read_b32 v155, a95
  v_pk_mul_f32 v[148:149], v[148:149], v[10:11] op_sel_hi:[1,0]
  v_pk_mul_f32 v[150:151], v[150:151], v[10:11] op_sel_hi:[1,0]
  v_pk_mul_f32 v[152:153], v[152:153], v[10:11] op_sel_hi:[1,0]
  v_pk_mul_f32 v[154:155], v[154:155], v[10:11] op_sel_hi:[1,0]
  v_cvt_pk_bf16_f32 v156, v148, v149
  v_cvt_pk_bf16_f32 v157, v150, v151
  v_cvt_pk_bf16_f32 v158, v152, v153
  v_cvt_pk_bf16_f32 v159, v154, v155
  buffer_store_dwordx4 v[156:159], v2, s[4:7], s28 offen offset:3072 sc1
  s_add_u32 s28, s25, 100675584
  v_accvgpr_read_b32 v112, a96
  v_accvgpr_read_b32 v113, a97
  v_accvgpr_read_b32 v114, a98
  v_accvgpr_read_b32 v115, a99
  v_accvgpr_read_b32 v116, a100
  v_accvgpr_read_b32 v117, a101
  v_accvgpr_read_b32 v118, a102
  v_accvgpr_read_b32 v119, a103
  v_pk_mul_f32 v[112:113], v[112:113], v[10:11] op_sel_hi:[1,0]
  v_pk_mul_f32 v[114:115], v[114:115], v[10:11] op_sel_hi:[1,0]
  v_pk_mul_f32 v[116:117], v[116:117], v[10:11] op_sel_hi:[1,0]
  v_pk_mul_f32 v[118:119], v[118:119], v[10:11] op_sel_hi:[1,0]
  v_cvt_pk_bf16_f32 v120, v112, v113
  v_cvt_pk_bf16_f32 v121, v114, v115
  v_cvt_pk_bf16_f32 v122, v116, v117
  v_cvt_pk_bf16_f32 v123, v118, v119
  buffer_store_dwordx4 v[120:123], v2, s[4:7], s28 offen offset:0 sc1
  v_accvgpr_read_b32 v124, a104
  v_accvgpr_read_b32 v125, a105
  v_accvgpr_read_b32 v126, a106
  v_accvgpr_read_b32 v127, a107
  v_accvgpr_read_b32 v128, a108
  v_accvgpr_read_b32 v129, a109
  v_accvgpr_read_b32 v130, a110
  v_accvgpr_read_b32 v131, a111
  v_pk_mul_f32 v[124:125], v[124:125], v[10:11] op_sel_hi:[1,0]
  v_pk_mul_f32 v[126:127], v[126:127], v[10:11] op_sel_hi:[1,0]
  v_pk_mul_f32 v[128:129], v[128:129], v[10:11] op_sel_hi:[1,0]
  v_pk_mul_f32 v[130:131], v[130:131], v[10:11] op_sel_hi:[1,0]
  v_cvt_pk_bf16_f32 v132, v124, v125
  v_cvt_pk_bf16_f32 v133, v126, v127
  v_cvt_pk_bf16_f32 v134, v128, v129
  v_cvt_pk_bf16_f32 v135, v130, v131
  buffer_store_dwordx4 v[132:135], v2, s[4:7], s28 offen offset:1024 sc1
  v_accvgpr_read_b32 v136, a112
  v_accvgpr_read_b32 v137, a113
  v_accvgpr_read_b32 v138, a114
  v_accvgpr_read_b32 v139, a115
  v_accvgpr_read_b32 v140, a116
  v_accvgpr_read_b32 v141, a117
  v_accvgpr_read_b32 v142, a118
  v_accvgpr_read_b32 v143, a119
  v_pk_mul_f32 v[136:137], v[136:137], v[10:11] op_sel_hi:[1,0]
  v_pk_mul_f32 v[138:139], v[138:139], v[10:11] op_sel_hi:[1,0]
  v_pk_mul_f32 v[140:141], v[140:141], v[10:11] op_sel_hi:[1,0]
  v_pk_mul_f32 v[142:143], v[142:143], v[10:11] op_sel_hi:[1,0]
  v_cvt_pk_bf16_f32 v144, v136, v137
  v_cvt_pk_bf16_f32 v145, v138, v139
  v_cvt_pk_bf16_f32 v146, v140, v141
  v_cvt_pk_bf16_f32 v147, v142, v143
  buffer_store_dwordx4 v[144:147], v2, s[4:7], s28 offen offset:2048 sc1
  v_accvgpr_read_b32 v148, a120
  v_accvgpr_read_b32 v149, a121
  v_accvgpr_read_b32 v150, a122
  v_accvgpr_read_b32 v151, a123
  v_accvgpr_read_b32 v152, a124
  v_accvgpr_read_b32 v153, a125
  v_accvgpr_read_b32 v154, a126
  v_accvgpr_read_b32 v155, a127
  v_pk_mul_f32 v[148:149], v[148:149], v[10:11] op_sel_hi:[1,0]
  v_pk_mul_f32 v[150:151], v[150:151], v[10:11] op_sel_hi:[1,0]
  v_pk_mul_f32 v[152:153], v[152:153], v[10:11] op_sel_hi:[1,0]
  v_pk_mul_f32 v[154:155], v[154:155], v[10:11] op_sel_hi:[1,0]
  v_cvt_pk_bf16_f32 v156, v148, v149
  v_cvt_pk_bf16_f32 v157, v150, v151
  v_cvt_pk_bf16_f32 v158, v152, v153
  v_cvt_pk_bf16_f32 v159, v154, v155
  buffer_store_dwordx4 v[156:159], v2, s[4:7], s28 offen offset:3072 sc1
  s_branch A_out_31
A_kvw_32:
M_kv_35:
  s_cmp_ge_u32 s17, s36
  s_cbranch_scc1 M_kvok_36
  s_mov_b32 s76, 0
  s_mov_b32 s78, 23
  s_mov_b32 s77, 335872
  s_cmp_eq_u32 s68, 1
  s_cmov_b32 s76, 128
  s_cmov_b32 s78, 27
  s_cmov_b32 s77, 114688
  s_cmp_eq_u32 s68, 2
  s_cmov_b32 s76, 768
  s_cmov_b32 s78, 14
  s_cmov_b32 s77, 0
  s_add_u32 s76, s76, s67
  s_mov_b32 s71, 0
  s_branch M_sg_38
M_sw_37:
  s_sleep 8
  s_add_u32 s71, s71, 1
  s_cmp_gt_u32 s71, 262144
  s_cbranch_scc1 M_exit
M_sg_38:
  s_mov_b32 s79, 0
  s_atomic_or s79, s[72:73], s76 glc
  s_waitcnt lgkmcnt(0)
  s_cmp_lt_u32 s79, s78
  s_cbranch_scc1 M_sw_37
  s_add_u32 s36, s77, s19
  s_add_u32 s68, s68, 1
  s_branch M_kv_35
M_kvok_36:
  s_branch A_kvb_33
A_upd_29:
  s_cmp_eq_u32 s23, 2
  s_cbranch_scc1 A_upd2_39
  v_mov_b32 v12, s24
  v_cmp_le_i32 s[40:41], 0, v5
  v_cmp_le_i32 s[42:43], 1, v5
  v_cmp_le_i32 s[44:45], 2, v5
  v_cmp_le_i32 s[46:47], 3, v5
  v_cndmask_b32 v64, v12, v6, s[40:41]
  v_cndmask_b32 v65, v12, v6, s[42:43]
  v_cndmask_b32 v66, v12, v6, s[44:45]
  v_cndmask_b32 v67, v12, v6, s[46:47]
  v_cmp_le_i32 s[40:41], 8, v5
  v_cmp_le_i32 s[42:43], 9, v5
  v_cmp_le_i32 s[44:45], 10, v5
  v_cmp_le_i32 s[46:47], 11, v5
  v_cndmask_b32 v68, v12, v6, s[40:41]
  v_cndmask_b32 v69, v12, v6, s[42:43]
  v_cndmask_b32 v70, v12, v6, s[44:45]
  v_cndmask_b32 v71, v12, v6, s[46:47]
  v_cmp_le_i32 s[40:41], 16, v5
  v_cmp_le_i32 s[42:43], 17, v5
  v_cmp_le_i32 s[44:45], 18, v5
  v_cmp_le_i32 s[46:47], 19, v5
  v_cndmask_b32 v72, v12, v6, s[40:41]
  v_cndmask_b32 v73, v12, v6, s[42:43]
  v_cndmask_b32 v74, v12, v6, s[44:45]
  v_cndmask_b32 v75, v12, v6, s[46:47]
  v_cmp_le_i32 s[40:41], 24, v5
  v_cmp_le_i32 s[42:43], 25, v5
  v_cmp_le_i32 s[44:45], 26, v5
  v_cmp_le_i32 s[46:47], 27, v5
  v_cndmask_b32 v76, v12, v6, s[40:41]
  v_cndmask_b32 v77, v12, v6, s[42:43]
  v_cndmask_b32 v78, v12, v6, s[44:45]
  v_cndmask_b32 v79, v12, v6, s[46:47]
  v_mov_b32 v80, v7
  v_mov_b32 v81, v7
  v_mov_b32 v82, v7
  v_mov_b32 v83, v7
  v_mov_b32 v84, v7
  v_mov_b32 v85, v7
  v_mov_b32 v86, v7
  v_mov_b32 v87, v7
  v_mov_b32 v88, v7
  v_mov_b32 v89, v7
  v_mov_b32 v90, v7
  v_mov_b32 v91, v7
  v_mov_b32 v92, v7
  v_mov_b32 v93, v7
  v_mov_b32 v94, v7
  v_mov_b32 v95, v7
  s_branch A_back_30
A_upd2_39:
  v_mov_b32 v64, v6
  v_mov_b32 v65, v6
  v_mov_b32 v66, v6
  v_mov_b32 v67, v6
  v_mov_b32 v68, v6
  v_mov_b32 v69, v6
  v_mov_b32 v70, v6
  v_mov_b32 v71, v6
  v_mov_b32 v72, v6
  v_mov_b32 v73, v6
  v_mov_b32 v74, v6
  v_mov_b32 v75, v6
  v_mov_b32 v76, v6
  v_mov_b32 v77, v6
  v_mov_b32 v78, v6
  v_mov_b32 v79, v6
  s_branch A_back_30
A_slow_34:
  s_mov_b32 s29, 1
  v_mov_b32 v64, s24
  v_mov_b32 v65, s24
  v_mov_b32 v66, s24
  v_mov_b32 v67, s24
  v_mov_b32 v68, s24
  v_mov_b32 v69, s24
  v_mov_b32 v70, s24
  v_mov_b32 v71, s24
  v_mov_b32 v72, s24
  v_mov_b32 v73, s24
  v_mov_b32 v74, s24
  v_mov_b32 v75, s24
  v_mov_b32 v76, s24
  v_mov_b32 v77, s24
  v_mov_b32 v78, s24
  v_mov_b32 v79, s24
  v_mov_b32 v12, s24
  v_cmp_le_i32 s[40:41], 0, v5
  v_cmp_le_i32 s[42:43], 1, v5
  v_cmp_le_i32 s[44:45], 2, v5
  v_cmp_le_i32 s[46:47], 3, v5
  v_cndmask_b32 v80, v12, v7, s[40:41]
  v_cndmask_b32 v81, v12, v7, s[42:43]
  v_cndmask_b32 v82, v12, v7, s[44:45]
  v_cndmask_b32 v83, v12, v7, s[46:47]
  v_cmp_le_i32 s[40:41], 8, v5
  v_cmp_le_i32 s[42:43], 9, v5
  v_cmp_le_i32 s[44:45], 10, v5
  v_cmp_le_i32 s[46:47], 11, v5
  v_cndmask_b32 v84, v12, v7, s[40:41]
  v_cndmask_b32 v85, v12, v7, s[42:43]
  v_cndmask_b32 v86, v12, v7, s[44:45]
  v_cndmask_b32 v87, v12, v7, s[46:47]
  v_cmp_le_i32 s[40:41], 16, v5
  v_cmp_le_i32 s[42:43], 17, v5
  v_cmp_le_i32 s[44:45], 18, v5
  v_cmp_le_i32 s[46:47], 19, v5
  v_cndmask_b32 v88, v12, v7, s[40:41]
  v_cndmask_b32 v89, v12, v7, s[42:43]
  v_cndmask_b32 v90, v12, v7, s[44:45]
  v_cndmask_b32 v91, v12, v7, s[46:47]
  v_cmp_le_i32 s[40:41], 24, v5
  v_cmp_le_i32 s[42:43], 25, v5
  v_cmp_le_i32 s[44:45], 26, v5
  v_cmp_le_i32 s[46:47], 27, v5
  v_cndmask_b32 v92, v12, v7, s[40:41]
  v_cndmask_b32 v93, v12, v7, s[42:43]
  v_cndmask_b32 v94, v12, v7, s[44:45]
  v_cndmask_b32 v95, v12, v7, s[46:47]
  v_mov_b32 v8, s24
  v_mov_b32 v10, s24
  s_add_u32 s17, s25, 16785408
  s_mov_b32 s23, 0
A_ml_40:
  s_add_u32 s28, s17, 4096
  buffer_load_dwordx4 a[192:195], v2, s[4:7], s17 offen offset:0 sc1
  buffer_load_dwordx4 a[196:199], v2, s[4:7], s17 offen offset:1024 sc1
  buffer_load_dwordx4 a[200:203], v2, s[4:7], s17 offen offset:2048 sc1
  buffer_load_dwordx4 a[204:207], v2, s[4:7], s17 offen offset:3072 sc1
  buffer_load_dwordx4 a[208:211], v2, s[4:7], s28 offen offset:0 sc1
  buffer_load_dwordx4 a[212:215], v2, s[4:7], s28 offen offset:1024 sc1
  buffer_load_dwordx4 a[216:219], v2, s[4:7], s28 offen offset:2048 sc1
  buffer_load_dwordx4 a[220:223], v2, s[4:7], s28 offen offset:3072 sc1
  s_waitcnt vmcnt(0)
  v_mfma_f32_32x32x16_bf16 v[32:47], a[192:195], a[128:131], v[64:79]
  v_mfma_f32_32x32x16_bf16 v[32:47], a[196:199], a[132:135], v[32:47]
  v_mfma_f32_32x32x16_bf16 v[32:47], a[200:203], a[136:139], v[32:47]
  v_mfma_f32_32x32x16_bf16 v[32:47], a[204:207], a[140:143], v[32:47]
  v_mfma_f32_32x32x16_bf16 v[32:47], a[208:211], a[144:147], v[32:47]
  v_mfma_f32_32x32x16_bf16 v[32:47], a[212:215], a[148:151], v[32:47]
  v_mfma_f32_32x32x16_bf16 v[32:47], a[216:219], a[152:155], v[32:47]
  v_mfma_f32_32x32x16_bf16 v[32:47], a[220:223], a[156:159], v[32:47]
  v_mfma_f32_32x32x16_bf16 v[48:63], a[192:195], a[160:163], v[80:95]
  v_mfma_f32_32x32x16_bf16 v[48:63], a[196:199], a[164:167], v[48:63]
  v_mfma_f32_32x32x16_bf16 v[48:63], a[200:203], a[168:171], v[48:63]
  v_mfma_f32_32x32x16_bf16 v[48:63], a[204:207], a[172:175], v[48:63]
  v_mfma_f32_32x32x16_bf16 v[48:63], a[208:211], a[176:179], v[48:63]
  v_mfma_f32_32x32x16_bf16 v[48:63], a[212:215], a[180:183], v[48:63]
  v_mfma_f32_32x32x16_bf16 v[48:63], a[216:219], a[184:187], v[48:63]
  v_mfma_f32_32x32x16_bf16 v[48:63], a[220:223], a[188:191], v[48:63]
  s_nop 7
  s_nop 3
  v_max3_f32 v8, v8, v32, v33
  v_max3_f32 v8, v8, v34, v35
  v_max3_f32 v8, v8, v36, v37
  v_max3_f32 v8, v8, v38, v39
  v_max3_f32 v8, v8, v40, v41
  v_max3_f32 v8, v8, v42, v43
  v_max3_f32 v8, v8, v44, v45
  v_max3_f32 v8, v8, v46, v47
  v_max3_f32 v10, v10, v48, v49
  v_max3_f32 v10, v10, v50, v51
  v_max3_f32 v10, v10, v52, v53
  v_max3_f32 v10, v10, v54, v55
  v_max3_f32 v10, v10, v56, v57
  v_max3_f32 v10, v10, v58, v59
  v_max3_f32 v10, v10, v60, v61
  v_max3_f32 v10, v10, v62, v63
  s_add_u32 s23, s23, 1
  s_cmp_lg_u32 s23, 1
  s_cbranch_scc1 A_m2_41
  v_mov_b32 v12, s24
  v_cmp_le_i32 s[40:41], 0, v5
  v_cmp_le_i32 s[42:43], 1, v5
  v_cmp_le_i32 s[44:45], 2, v5
  v_cmp_le_i32 s[46:47], 3, v5
  v_cndmask_b32 v64, v12, v6, s[40:41]
  v_cndmask_b32 v65, v12, v6, s[42:43]
  v_cndmask_b32 v66, v12, v6, s[44:45]
  v_cndmask_b32 v67, v12, v6, s[46:47]
  v_cmp_le_i32 s[40:41], 8, v5
  v_cmp_le_i32 s[42:43], 9, v5
  v_cmp_le_i32 s[44:45], 10, v5
  v_cmp_le_i32 s[46:47], 11, v5
  v_cndmask_b32 v68, v12, v6, s[40:41]
  v_cndmask_b32 v69, v12, v6, s[42:43]
  v_cndmask_b32 v70, v12, v6, s[44:45]
  v_cndmask_b32 v71, v12, v6, s[46:47]
  v_cmp_le_i32 s[40:41], 16, v5
  v_cmp_le_i32 s[42:43], 17, v5
  v_cmp_le_i32 s[44:45], 18, v5
  v_cmp_le_i32 s[46:47], 19, v5
  v_cndmask_b32 v72, v12, v6, s[40:41]
  v_cndmask_b32 v73, v12, v6, s[42:43]
  v_cndmask_b32 v74, v12, v6, s[44:45]
  v_cndmask_b32 v75, v12, v6, s[46:47]
  v_cmp_le_i32 s[40:41], 24, v5
  v_cmp_le_i32 s[42:43], 25, v5
  v_cmp_le_i32 s[44:45], 26, v5
  v_cmp_le_i32 s[46:47], 27, v5
  v_cndmask_b32 v76, v12, v6, s[40:41]
  v_cndmask_b32 v77, v12, v6, s[42:43]
  v_cndmask_b32 v78, v12, v6, s[44:45]
  v_cndmask_b32 v79, v12, v6, s[46:47]
  v_mov_b32 v80, v7
  v_mov_b32 v81, v7
  v_mov_b32 v82, v7
  v_mov_b32 v83, v7
  v_mov_b32 v84, v7
  v_mov_b32 v85, v7
  v_mov_b32 v86, v7
  v_mov_b32 v87, v7
  v_mov_b32 v88, v7
  v_mov_b32 v89, v7
  v_mov_b32 v90, v7
  v_mov_b32 v91, v7
  v_mov_b32 v92, v7
  v_mov_b32 v93, v7
  v_mov_b32 v94, v7
  v_mov_b32 v95, v7
A_m2_41:
  s_cmp_lg_u32 s23, 2
  s_cbranch_scc1 A_m3_42
  v_mov_b32 v64, v6
  v_mov_b32 v65, v6
  v_mov_b32 v66, v6
  v_mov_b32 v67, v6
  v_mov_b32 v68, v6
  v_mov_b32 v69, v6
  v_mov_b32 v70, v6
  v_mov_b32 v71, v6
  v_mov_b32 v72, v6
  v_mov_b32 v73, v6
  v_mov_b32 v74, v6
  v_mov_b32 v75, v6
  v_mov_b32 v76, v6
  v_mov_b32 v77, v6
  v_mov_b32 v78, v6
  v_mov_b32 v79, v6
A_m3_42:
  s_sub_u32 s17, s17, 8192
  s_cmp_ge_i32 s17, s19
  s_cbranch_scc1 A_ml_40
  v_mov_b32 v9, v8
  s_nop 1
  v_permlane32_swap_b32 v8, v9
  s_nop 1
  v_max_f32 v8, v8, v9
  v_sub_f32 v6, 0, v8
  v_mov_b32 v11, v10
  s_nop 1
  v_permlane32_swap_b32 v10, v11
  s_nop 1
  v_max_f32 v10, v10, v11
  v_sub_f32 v7, 0, v10
  s_branch A_again_21
A_out_31:
  s_mov_b32 s69, s55
  s_mov_b32 s70, s56
  s_sub_u32 s52, s52, 1
  s_cmp_lg_u32 s52, 0
  s_cbranch_scc1 M_att
  s_waitcnt vmcnt(0)
  s_barrier
  s_mov_b32 s30, 512
  v_mov_b32 v144, s30
  v_min_u32 v145, 1, v0
  v_lshlrev_b32 v145, 30, v145
  buffer_store_dword v144, v145, s[4:7], s31 offen sc1
  s_lshr_b32 s48, s64, 2
  s_bfe_u32 s49, s64, 0x10001
  s_and_b32 s50, s64, 1
  s_mul_i32 s50, s50, 6
  s_add_u32 s50, s50, s65
  s_mov_b32 s51, 12
  s_cmp_lt_u32 s50, 4
  s_cselect_b32 s23, 6, 5
  s_load_dwordx2 s[8:9], s[0:1], 40
  s_lshl_b32 s17, s48, 19
  s_lshl_b32 s26, s49, 2
  s_add_u32 s26, s26, s16
  s_lshl_b32 s27, s26, 7
  s_add_u32 s17, s17, s27
  s_mov_b32 s18, 1024
  s_lshl_b32 s21, s48, 6
  s_add_u32 s21, s21, s50
  s_lshl_b32 s21, s21, 3
  s_add_u32 s21, s21, s26
  s_lshl_b32 s21, s21, 12
  s_add_u32 s21, s21, 150994944
  s_lshl_b32 s22, s51, 15
  s_mov_b32 s24, 1.0
  s_waitcnt lgkmcnt(0)
  s_and_b32 s9, s9, 0xffff
  s_mov_b32 s10, 4194304
  s_mov_b32 s11, 0x20000
  s_mov_b32 s12, s4
  s_mov_b32 s13, s5
  s_mov_b32 s14, 268435456
  s_mov_b32 s15, 0x20000
  s_lshl_b32 s19, s48, 8
  s_add_u32 s19, s19, s50
  s_lshl_b32 s19, s19, 13
  s_add_u32 s19, s19, 100663296
  s_lshl_b32 s20, s51, 13
  s_mul_i32 s26, s16, 524288
  v_add_u32 v8, 0, v2
  v_add_u32 v16, s26, v8
  v_add_u32 v9, 1024, v2
  v_add_u32 v17, s26, v9
  v_add_u32 v10, 2048, v2
  v_add_u32 v18, s26, v10
  v_add_u32 v11, 3072, v2
  v_add_u32 v19, s26, v11
  v_add_u32 v12, 4096, v2
  v_add_u32 v20, s26, v12
  v_add_u32 v13, 5120, v2
  v_add_u32 v21, s26, v13
  v_add_u32 v14, 6144, v2
  v_add_u32 v22, s26, v14
  v_add_u32 v15, 7168, v2
  v_add_u32 v23, s26, v15
  v_lshrrev_b32 v144, 3, v1
  v_mul_lo_u32 v144, v144, s18
  v_and_b32 v145, 7, v1
  v_lshl_add_u32 v144, v145, 4, v144
  s_lshl_b32 s28, s16, 15
  s_add_u32 s28, s28, 32768
  s_lshl_b32 s29, s18, 3
  s_add_u32 m0, s28, 0
  s_nop 0
  buffer_load_dwordx4 v144, s[8:11], s17 offen lds
  s_add_u32 s17, s17, s29
  s_add_u32 m0, s28, 1024
  s_nop 0
  buffer_load_dwordx4 v144, s[8:11], s17 offen lds
  s_add_u32 s17, s17, s29
  s_add_u32 m0, s28, 2048
  s_nop 0
  buffer_load_dwordx4 v144, s[8:11], s17 offen lds
  s_add_u32 s17, s17, s29
  s_add_u32 m0, s28, 3072
  s_nop 0
  buffer_load_dwordx4 v144, s[8:11], s17 offen lds
  s_add_u32 s17, s17, s29
  s_add_u32 m0, s28, 4096
  s_nop 0
  buffer_load_dwordx4 v144, s[8:11], s17 offen lds
  s_add_u32 s17, s17, s29
  s_add_u32 m0, s28, 5120
  s_nop 0
  buffer_load_dwordx4 v144, s[8:11], s17 offen lds
  s_add_u32 s17, s17, s29
  s_add_u32 m0, s28, 6144
  s_nop 0
  buffer_load_dwordx4 v144, s[8:11], s17 offen lds
  s_add_u32 s17, s17, s29
  s_add_u32 m0, s28, 7168
  s_nop 0
  buffer_load_dwordx4 v144, s[8:11], s17 offen lds
  s_add_u32 s17, s17, s29
  s_add_u32 m0, s28, 8192
  s_nop 0
  buffer_load_dwordx4 v144, s[8:11], s17 offen lds
  s_add_u32 s17, s17, s29
  s_add_u32 m0, s28, 9216
  s_nop 0
  buffer_load_dwordx4 v144, s[8:11], s17 offen lds
  s_add_u32 s17, s17, s29
  s_add_u32 m0, s28, 10240
  s_nop 0
  buffer_load_dwordx4 v144, s[8:11], s17 offen lds
  s_add_u32 s17, s17, s29
  s_add_u32 m0, s28, 11264
  s_nop 0
  buffer_load_dwordx4 v144, s[8:11], s17 offen lds
  s_add_u32 s17, s17, s29
  s_add_u32 m0, s28, 12288
  s_nop 0
  buffer_load_dwordx4 v144, s[8:11], s17 offen lds
  s_add_u32 s17, s17, s29
  s_add_u32 m0, s28, 13312
  s_nop 0
  buffer_load_dwordx4 v144, s[8:11], s17 offen lds
  s_add_u32 s17, s17, s29
  s_add_u32 m0, s28, 14336
  s_nop 0
  buffer_load_dwordx4 v144, s[8:11], s17 offen lds
  s_add_u32 s17, s17, s29
  s_add_u32 m0, s28, 15360
  s_nop 0
  buffer_load_dwordx4 v144, s[8:11], s17 offen lds
  s_add_u32 s17, s17, s29
  s_add_u32 m0, s28, 16384
  s_nop 0
  buffer_load_dwordx4 v144, s[8:11], s17 offen lds
  s_add_u32 s17, s17, s29
  s_add_u32 m0, s28, 17408
  s_nop 0
  buffer_load_dwordx4 v144, s[8:11], s17 offen lds
  s_add_u32 s17, s17, s29
  s_add_u32 m0, s28, 18432
  s_nop 0
  buffer_load_dwordx4 v144, s[8:11], s17 offen lds
  s_add_u32 s17, s17, s29
  s_add_u32 m0, s28, 19456
  s_nop 0
  buffer_load_dwordx4 v144, s[8:11], s17 offen lds
  s_add_u32 s17, s17, s29
  s_add_u32 m0, s28, 20480
  s_nop 0
  buffer_load_dwordx4 v144, s[8:11], s17 offen lds
  s_add_u32 s17, s17, s29
  s_add_u32 m0, s28, 21504
  s_nop 0
  buffer_load_dwordx4 v144, s[8:11], s17 offen lds
  s_add_u32 s17, s17, s29
  s_add_u32 m0, s28, 22528
  s_nop 0
  buffer_load_dwordx4 v144, s[8:11], s17 offen lds
  s_add_u32 s17, s17, s29
  s_add_u32 m0, s28, 23552
  s_nop 0
  buffer_load_dwordx4 v144, s[8:11], s17 offen lds
  s_add_u32 s17, s17, s29
  s_add_u32 m0, s28, 24576
  s_nop 0
  buffer_load_dwordx4 v144, s[8:11], s17 offen lds
  s_add_u32 s17, s17, s29
  s_add_u32 m0, s28, 25600
  s_nop 0
  buffer_load_dwordx4 v144, s[8:11], s17 offen lds
  s_add_u32 s17, s17, s29
  s_add_u32 m0, s28, 26624
  s_nop 0
  buffer_load_dwordx4 v144, s[8:11], s17 offen lds
  s_add_u32 s17, s17, s29
  s_add_u32 m0, s28, 27648
  s_nop 0
  buffer_load_dwordx4 v144, s[8:11], s17 offen lds
  s_add_u32 s17, s17, s29
  s_add_u32 m0, s28, 28672
  s_nop 0
  buffer_load_dwordx4 v144, s[8:11], s17 offen lds
  s_add_u32 s17, s17, s29
  s_add_u32 m0, s28, 29696
  s_nop 0
  buffer_load_dwordx4 v144, s[8:11], s17 offen lds
  s_add_u32 s17, s17, s29
  s_add_u32 m0, s28, 30720
  s_nop 0
  buffer_load_dwordx4 v144, s[8:11], s17 offen lds
  s_add_u32 s17, s17, s29
  s_add_u32 m0, s28, 31744
  s_nop 0
  buffer_load_dwordx4 v144, s[8:11], s17 offen lds
  s_add_u32 s17, s17, s29
  v_bfe_u32 v148, v1, 2, 2
  v_lshrrev_b32 v149, 5, v1
  v_lshl_add_u32 v148, v149, 2, v148
  v_lshlrev_b32 v148, 7, v148
  v_bfe_u32 v149, v1, 4, 1
  v_lshl_add_u32 v148, v149, 5, v148
  v_and_b32 v149, 1, v1
  v_lshl_add_u32 v148, v149, 4, v148
  v_bfe_u32 v149, v1, 1, 1
  v_lshl_add_u32 v148, v149, 3, v148
  v_add_u32 v146, s28, v148
  v_add_u32 v147, 1024, v146
  s_waitcnt vmcnt(28)
  ds_read_b64_tr_b16 a[0:1], v146 offset:0
  ds_read_b64_tr_b16 a[2:3], v147 offset:0
  ds_read_b64_tr_b16 a[4:5], v146 offset:64
  ds_read_b64_tr_b16 a[6:7], v147 offset:64
  ds_read_b64_tr_b16 a[8:9], v146 offset:2048
  ds_read_b64_tr_b16 a[10:11], v147 offset:2048
  ds_read_b64_tr_b16 a[12:13], v146 offset:2112
  ds_read_b64_tr_b16 a[14:15], v147 offset:2112
  s_waitcnt lgkmcnt(0)
  s_add_u32 m0, s28, 0
  s_nop 0
  buffer_load_dwordx4 v144, s[8:11], s17 offen lds
  s_add_u32 s17, s17, s29
  s_add_u32 m0, s28, 1024
  s_nop 0
  buffer_load_dwordx4 v144, s[8:11], s17 offen lds
  s_add_u32 s17, s17, s29
  s_add_u32 m0, s28, 2048
  s_nop 0
  buffer_load_dwordx4 v144, s[8:11], s17 offen lds
  s_add_u32 s17, s17, s29
  s_add_u32 m0, s28, 3072
  s_nop 0
  buffer_load_dwordx4 v144, s[8:11], s17 offen lds
  s_add_u32 s17, s17, s29
  s_waitcnt vmcnt(28)
  ds_read_b64_tr_b16 a[16:17], v146 offset:4096
  ds_read_b64_tr_b16 a[18:19], v147 offset:4096
  ds_read_b64_tr_b16 a[20:21], v146 offset:4160
  ds_read_b64_tr_b16 a[22:23], v147 offset:4160
  ds_read_b64_tr_b16 a[24:25], v146 offset:6144
  ds_read_b64_tr_b16 a[26:27], v147 offset:6144
  ds_read_b64_tr_b16 a[28:29], v146 offset:6208
  ds_read_b64_tr_b16 a[30:31], v147 offset:6208
  s_waitcnt lgkmcnt(0)
  s_add_u32 m0, s28, 4096
  s_nop 0
  buffer_load_dwordx4 v144, s[8:11], s17 offen lds
  s_add_u32 s17, s17, s29
  s_add_u32 m0, s28, 5120
  s_nop 0
  buffer_load_dwordx4 v144, s[8:11], s17 offen lds
  s_add_u32 s17, s17, s29
  s_add_u32 m0, s28, 6144
  s_nop 0
  buffer_load_dwordx4 v144, s[8:11], s17 offen lds
  s_add_u32 s17, s17, s29
  s_add_u32 m0, s28, 7168
  s_nop 0
  buffer_load_dwordx4 v144, s[8:11], s17 offen lds
  s_add_u32 s17, s17, s29
  s_waitcnt vmcnt(28)
  ds_read_b64_tr_b16 a[32:33], v146 offset:8192
  ds_read_b64_tr_b16 a[34:35], v147 offset:8192
  ds_read_b64_tr_b16 a[36:37], v146 offset:8256
  ds_read_b64_tr_b16 a[38:39], v147 offset:8256
  ds_read_b64_tr_b16 a[40:41], v146 offset:10240
  ds_read_b64_tr_b16 a[42:43], v147 offset:10240
  ds_read_b64_tr_b16 a[44:45], v146 offset:10304
  ds_read_b64_tr_b16 a[46:47], v147 offset:10304
  s_waitcnt lgkmcnt(0)
  s_add_u32 m0, s28, 8192
  s_nop 0
  buffer_load_dwordx4 v144, s[8:11], s17 offen lds
  s_add_u32 s17, s17, s29
  s_add_u32 m0, s28, 9216
  s_nop 0
  buffer_load_dwordx4 v144, s[8:11], s17 offen lds
  s_add_u32 s17, s17, s29
  s_add_u32 m0, s28, 10240
  s_nop 0
  buffer_load_dwordx4 v144, s[8:11], s17 offen lds
  s_add_u32 s17, s17, s29
  s_add_u32 m0, s28, 11264
  s_nop 0
  buffer_load_dwordx4 v144, s[8:11], s17 offen lds
  s_add_u32 s17, s17, s29
  s_waitcnt vmcnt(28)
  ds_read_b64_tr_b16 a[48:49], v146 offset:12288
  ds_read_b64_tr_b16 a[50:51], v147 offset:12288
  ds_read_b64_tr_b16 a[52:53], v146 offset:12352
  ds_read_b64_tr_b16 a[54:55], v147 offset:12352
  ds_read_b64_tr_b16 a[56:57], v146 offset:14336
  ds_read_b64_tr_b16 a[58:59], v147 offset:14336
  ds_read_b64_tr_b16 a[60:61], v146 offset:14400
  ds_read_b64_tr_b16 a[62:63], v147 offset:14400
  s_waitcnt lgkmcnt(0)
  s_add_u32 m0, s28, 12288
  s_nop 0
  buffer_load_dwordx4 v144, s[8:11], s17 offen lds
  s_add_u32 s17, s17, s29
  s_add_u32 m0, s28, 13312
  s_nop 0
  buffer_load_dwordx4 v144, s[8:11], s17 offen lds
  s_add_u32 s17, s17, s29
  s_add_u32 m0, s28, 14336
  s_nop 0
  buffer_load_dwordx4 v144, s[8:11], s17 offen lds
  s_add_u32 s17, s17, s29
  s_add_u32 m0, s28, 15360
  s_nop 0
  buffer_load_dwordx4 v144, s[8:11], s17 offen lds
  s_add_u32 s17, s17, s29
  s_waitcnt vmcnt(28)
  ds_read_b64_tr_b16 a[64:65], v146 offset:16384
  ds_read_b64_tr_b16 a[66:67], v147 offset:16384
  ds_read_b64_tr_b16 a[68:69], v146 offset:16448
  ds_read_b64_tr_b16 a[70:71], v147 offset:16448
  ds_read_b64_tr_b16 a[72:73], v146 offset:18432
  ds_read_b64_tr_b16 a[74:75], v147 offset:18432
  ds_read_b64_tr_b16 a[76:77], v146 offset:18496
  ds_read_b64_tr_b16 a[78:79], v147 offset:18496
  s_waitcnt lgkmcnt(0)
  s_add_u32 m0, s28, 16384
  s_nop 0
  buffer_load_dwordx4 v144, s[8:11], s17 offen lds
  s_add_u32 s17, s17, s29
  s_add_u32 m0, s28, 17408
  s_nop 0
  buffer_load_dwordx4 v144, s[8:11], s17 offen lds
  s_add_u32 s17, s17, s29
  s_add_u32 m0, s28, 18432
  s_nop 0
  buffer_load_dwordx4 v144, s[8:11], s17 offen lds
  s_add_u32 s17, s17, s29
  s_add_u32 m0, s28, 19456
  s_nop 0
  buffer_load_dwordx4 v144, s[8:11], s17 offen lds
  s_add_u32 s17, s17, s29
  s_waitcnt vmcnt(28)
  ds_read_b64_tr_b16 a[80:81], v146 offset:20480
  ds_read_b64_tr_b16 a[82:83], v147 offset:20480
  ds_read_b64_tr_b16 a[84:85], v146 offset:20544
  ds_read_b64_tr_b16 a[86:87], v147 offset:20544
  ds_read_b64_tr_b16 a[88:89], v146 offset:22528
  ds_read_b64_tr_b16 a[90:91], v147 offset:22528
  ds_read_b64_tr_b16 a[92:93], v146 offset:22592
  ds_read_b64_tr_b16 a[94:95], v147 offset:22592
  s_waitcnt lgkmcnt(0)
  s_add_u32 m0, s28, 20480
  s_nop 0
  buffer_load_dwordx4 v144, s[8:11], s17 offen lds
  s_add_u32 s17, s17, s29
  s_add_u32 m0, s28, 21504
  s_nop 0
  buffer_load_dwordx4 v144, s[8:11], s17 offen lds
  s_add_u32 s17, s17, s29
  s_add_u32 m0, s28, 22528
  s_nop 0
  buffer_load_dwordx4 v144, s[8:11], s17 offen lds
  s_add_u32 s17, s17, s29
  s_add_u32 m0, s28, 23552
  s_nop 0
  buffer_load_dwordx4 v144, s[8:11], s17 offen lds
  s_add_u32 s17, s17, s29
  s_waitcnt vmcnt(28)
  ds_read_b64_tr_b16 a[96:97], v146 offset:24576
  ds_read_b64_tr_b16 a[98:99], v147 offset:24576
  ds_read_b64_tr_b16 a[100:101], v146 offset:24640
  ds_read_b64_tr_b16 a[102:103], v147 offset:24640
  ds_read_b64_tr_b16 a[104:105], v146 offset:26624
  ds_read_b64_tr_b16 a[106:107], v147 offset:26624
  ds_read_b64_tr_b16 a[108:109], v146 offset:26688
  ds_read_b64_tr_b16 a[110:111], v147 offset:26688
  s_waitcnt lgkmcnt(0)
  s_add_u32 m0, s28, 24576
  s_nop 0
  buffer_load_dwordx4 v144, s[8:11], s17 offen lds
  s_add_u32 s17, s17, s29
  s_add_u32 m0, s28, 25600
  s_nop 0
  buffer_load_dwordx4 v144, s[8:11], s17 offen lds
  s_add_u32 s17, s17, s29
  s_add_u32 m0, s28, 26624
  s_nop 0
  buffer_load_dwordx4 v144, s[8:11], s17 offen lds
  s_add_u32 s17, s17, s29
  s_add_u32 m0, s28, 27648
  s_nop 0
  buffer_load_dwordx4 v144, s[8:11], s17 offen lds
  s_add_u32 s17, s17, s29
  s_waitcnt vmcnt(28)
  ds_read_b64_tr_b16 a[112:113], v146 offset:28672
  ds_read_b64_tr_b16 a[114:115], v147 offset:28672
  ds_read_b64_tr_b16 a[116:117], v146 offset:28736
  ds_read_b64_tr_b16 a[118:119], v147 offset:28736
  ds_read_b64_tr_b16 a[120:121], v146 offset:30720
  ds_read_b64_tr_b16 a[122:123], v147 offset:30720
  ds_read_b64_tr_b16 a[124:125], v146 offset:30784
  ds_read_b64_tr_b16 a[126:127], v147 offset:30784
  s_waitcnt lgkmcnt(0)
  s_add_u32 m0, s28, 28672
  s_nop 0
  buffer_load_dwordx4 v144, s[8:11], s17 offen lds
  s_add_u32 s17, s17, s29
  s_add_u32 m0, s28, 29696
  s_nop 0
  buffer_load_dwordx4 v144, s[8:11], s17 offen lds
  s_add_u32 s17, s17, s29
  s_add_u32 m0, s28, 30720
  s_nop 0
  buffer_load_dwordx4 v144, s[8:11], s17 offen lds
  s_add_u32 s17, s17, s29
  s_add_u32 m0, s28, 31744
  s_nop 0
  buffer_load_dwordx4 v144, s[8:11], s17 offen lds
  s_add_u32 s17, s17, s29
  s_waitcnt vmcnt(28)
  ds_read_b64_tr_b16 a[128:129], v146 offset:0
  ds_read_b64_tr_b16 a[130:131], v147 offset:0
  ds_read_b64_tr_b16 a[132:133], v146 offset:64
  ds_read_b64_tr_b16 a[134:135], v147 offset:64
  ds_read_b64_tr_b16 a[136:137], v146 offset:2048
  ds_read_b64_tr_b16 a[138:139], v147 offset:2048
  ds_read_b64_tr_b16 a[140:141], v146 offset:2112
  ds_read_b64_tr_b16 a[142:143], v147 offset:2112
  s_waitcnt lgkmcnt(0)
  s_waitcnt vmcnt(24)
  ds_read_b64_tr_b16 a[144:145], v146 offset:4096
  ds_read_b64_tr_b16 a[146:147], v147 offset:4096
  ds_read_b64_tr_b16 a[148:149], v146 offset:4160
  ds_read_b64_tr_b16 a[150:151], v147 offset:4160
  ds_read_b64_tr_b16 a[152:153], v146 offset:6144
  ds_read_b64_tr_b16 a[154:155], v147 offset:6144
  ds_read_b64_tr_b16 a[156:157], v146 offset:6208
  ds_read_b64_tr_b16 a[158:159], v147 offset:6208
  s_waitcnt lgkmcnt(0)
  s_waitcnt vmcnt(20)
  ds_read_b64_tr_b16 a[160:161], v146 offset:8192
  ds_read_b64_tr_b16 a[162:163], v147 offset:8192
  ds_read_b64_tr_b16 a[164:165], v146 offset:8256
  ds_read_b64_tr_b16 a[166:167], v147 offset:8256
  ds_read_b64_tr_b16 a[168:169], v146 offset:10240
  ds_read_b64_tr_b16 a[170:171], v147 offset:10240
  ds_read_b64_tr_b16 a[172:173], v146 offset:10304
  ds_read_b64_tr_b16 a[174:175], v147 offset:10304
  s_waitcnt lgkmcnt(0)
  s_waitcnt vmcnt(16)
  ds_read_b64_tr_b16 a[176:177], v146 offset:12288
  ds_read_b64_tr_b16 a[178:179], v147 offset:12288
  ds_read_b64_tr_b16 a[180:181], v146 offset:12352
  ds_read_b64_tr_b16 a[182:183], v147 offset:12352
  ds_read_b64_tr_b16 a[184:185], v146 offset:14336
  ds_read_b64_tr_b16 a[186:187], v147 offset:14336
  ds_read_b64_tr_b16 a[188:189], v146 offset:14400
  ds_read_b64_tr_b16 a[190:191], v147 offset:14400
  s_waitcnt lgkmcnt(0)
  s_waitcnt vmcnt(12)
  ds_read_b64_tr_b16 a[192:193], v146 offset:16384
  ds_read_b64_tr_b16 a[194:195], v147 offset:16384
  ds_read_b64_tr_b16 a[196:197], v146 offset:16448
  ds_read_b64_tr_b16 a[198:199], v147 offset:16448
  ds_read_b64_tr_b16 a[200:201], v146 offset:18432
  ds_read_b64_tr_b16 a[202:203], v147 offset:18432
  ds_read_b64_tr_b16 a[204:205], v146 offset:18496
  ds_read_b64_tr_b16 a[206:207], v147 offset:18496
  s_waitcnt lgkmcnt(0)
  s_waitcnt vmcnt(8)
  ds_read_b64_tr_b16 a[208:209], v146 offset:20480
  ds_read_b64_tr_b16 a[210:211], v147 offset:20480
  ds_read_b64_tr_b16 a[212:213], v146 offset:20544
  ds_read_b64_tr_b16 a[214:215], v147 offset:20544
  ds_read_b64_tr_b16 a[216:217], v146 offset:22528
  ds_read_b64_tr_b16 a[218:219], v147 offset:22528
  ds_read_b64_tr_b16 a[220:221], v146 offset:22592
  ds_read_b64_tr_b16 a[222:223], v147 offset:22592
  s_waitcnt lgkmcnt(0)
  s_waitcnt vmcnt(4)
  ds_read_b64_tr_b16 a[224:225], v146 offset:24576
  ds_read_b64_tr_b16 a[226:227], v147 offset:24576
  ds_read_b64_tr_b16 a[228:229], v146 offset:24640
  ds_read_b64_tr_b16 a[230:231], v147 offset:24640
  ds_read_b64_tr_b16 a[232:233], v146 offset:26624
  ds_read_b64_tr_b16 a[234:235], v147 offset:26624
  ds_read_b64_tr_b16 a[236:237], v146 offset:26688
  ds_read_b64_tr_b16 a[238:239], v147 offset:26688
  s_waitcnt lgkmcnt(0)
  s_waitcnt vmcnt(0)
  ds_read_b64_tr_b16 a[240:241], v146 offset:28672
  ds_read_b64_tr_b16 a[242:243], v147 offset:28672
  ds_read_b64_tr_b16 a[244:245], v146 offset:28736
  ds_read_b64_tr_b16 a[246:247], v147 offset:28736
  ds_read_b64_tr_b16 a[248:249], v146 offset:30720
  ds_read_b64_tr_b16 a[250:251], v147 offset:30720
  ds_read_b64_tr_b16 a[252:253], v146 offset:30784
  ds_read_b64_tr_b16 a[254:255], v147 offset:30784
  s_waitcnt lgkmcnt(0)
  v_min_u32 v4, 27, v1
  v_mul_u32_u24 v5, 37, v4
  v_lshrrev_b32 v5, 8, v5
  v_mul_u32_u24 v5, 7, v5
  v_sub_u32 v5, v4, v5
  v_mov_b32 v6, 0x200
  v_cmp_ne_u32 vcc, 6, v5
  s_mul_i32 s76, s48, 3584
  s_add_u32 s76, s76, 148897792
  v_cndmask_b32 v5, 0, v6, vcc
  v_lshl_add_u32 v4, v4, 7, s76
  s_mov_b32 s71, 0
  s_branch M_vg_44
M_vw_43:
  s_sleep 2
  s_add_u32 s71, s71, 1
  s_cmp_gt_u32 s71, 262144
  s_cbranch_scc1 M_exit
M_vg_44:
  buffer_load_dword v6, v4, s[4:7], 0 offen sc1
  s_waitcnt vmcnt(0)
  v_cmp_lt_u32 vcc, v6, v5
  s_cbranch_vccnz M_vw_43
  s_barrier
  s_lshl_b32 s25, s16, 13
  s_add_u32 m0, s25, 0
  s_nop 0
  buffer_load_dwordx4 v16, s[12:15], s19 offen sc1 lds
  s_add_u32 m0, s25, 1024
  s_nop 0
  buffer_load_dwordx4 v17, s[12:15], s19 offen sc1 lds
  s_add_u32 m0, s25, 2048
  s_nop 0
  buffer_load_dwordx4 v18, s[12:15], s19 offen sc1 lds
  s_add_u32 m0, s25, 3072
  s_nop 0
  buffer_load_dwordx4 v19, s[12:15], s19 offen sc1 lds
  s_add_u32 m0, s25, 4096
  s_nop 0
  buffer_load_dwordx4 v20, s[12:15], s19 offen sc1 lds
  s_add_u32 m0, s25, 5120
  s_nop 0
  buffer_load_dwordx4 v21, s[12:15], s19 offen sc1 lds
  s_add_u32 m0, s25, 6144
  s_nop 0
  buffer_load_dwordx4 v22, s[12:15], s19 offen sc1 lds
  s_add_u32 m0, s25, 7168
  s_nop 0
  buffer_load_dwordx4 v23, s[12:15], s19 offen sc1 lds
  s_cmp_gt_u32 s23, 1
  s_cselect_b32 s26, s20, 0
  s_add_u32 s19, s19, s26
  s_add_u32 s25, s25, 32768
  s_and_b32 s25, s25, 0x1ffff
  s_add_u32 m0, s25, 0
  s_nop 0
  buffer_load_dwordx4 v16, s[12:15], s19 offen sc1 lds
  s_add_u32 m0, s25, 1024
  s_nop 0
  buffer_load_dwordx4 v17, s[12:15], s19 offen sc1 lds
  s_add_u32 m0, s25, 2048
  s_nop 0
  buffer_load_dwordx4 v18, s[12:15], s19 offen sc1 lds
  s_add_u32 m0, s25, 3072
  s_nop 0
  buffer_load_dwordx4 v19, s[12:15], s19 offen sc1 lds
  s_add_u32 m0, s25, 4096
  s_nop 0
  buffer_load_dwordx4 v20, s[12:15], s19 offen sc1 lds
  s_add_u32 m0, s25, 5120
  s_nop 0
  buffer_load_dwordx4 v21, s[12:15], s19 offen sc1 lds
  s_add_u32 m0, s25, 6144
  s_nop 0
  buffer_load_dwordx4 v22, s[12:15], s19 offen sc1 lds
  s_add_u32 m0, s25, 7168
  s_nop 0
  buffer_load_dwordx4 v23, s[12:15], s19 offen sc1 lds
  s_cmp_gt_u32 s23, 2
  s_cselect_b32 s26, s20, 0
  s_add_u32 s19, s19, s26
  s_add_u32 s25, s25, 32768
  s_and_b32 s25, s25, 0x1ffff
  s_waitcnt vmcnt(0)
  s_barrier
  s_mov_b32 s27, s21
  v_mov_b32 v7, 0x40000000
  ds_read_b128 v[24:27], v8 offset:0
  ds_read_b128 v[28:31], v9 offset:0
  ds_read_b128 v[32:35], v10 offset:0
  ds_read_b128 v[36:39], v11 offset:0
  ds_read_b128 v[40:43], v12 offset:0
  ds_read_b128 v[44:47], v13 offset:0
.p2align 6
G_top_45:
  s_waitcnt lgkmcnt(5)
  v_mfma_f32_32x32x16_bf16 v[64:79], a[0:3], v[24:27], 0
  s_add_u32 m0, s25, 0
  ds_read_b128 v[48:51], v14 offset:0
  v_mfma_f32_32x32x16_bf16 v[80:95], a[4:7], v[24:27], 0
  s_waitcnt lgkmcnt(5)
  buffer_load_dwordx4 v16, s[12:15], s19 offen sc1 lds
  v_mfma_f32_32x32x16_bf16 v[64:79], a[8:11], v[28:31], v[64:79]
  ds_read_b128 v[52:55], v15 offset:0
  v_mul_f32 v96, s24, v96
  v_mul_f32 v97, s24, v97
  v_mfma_f32_32x32x16_bf16 v[80:95], a[12:15], v[28:31], v[80:95]
  s_waitcnt lgkmcnt(5)
  v_cvt_pk_bf16_f32 v128, v96, v97
  v_mul_f32 v98, s24, v98
  v_mfma_f32_32x32x16_bf16 v[64:79], a[16:19], v[32:35], v[64:79]
  s_add_u32 m0, s25, 1024
  ds_read_b128 v[24:27], v8 offset:8192
  v_mul_f32 v99, s24, v99
  v_cvt_pk_bf16_f32 v129, v98, v99
  v_mfma_f32_32x32x16_bf16 v[80:95], a[20:23], v[32:35], v[80:95]
  s_waitcnt lgkmcnt(5)
  buffer_load_dwordx4 v17, s[12:15], s19 offen sc1 lds
  v_mul_f32 v100, s24, v100
  v_mul_f32 v101, s24, v101
  v_mfma_f32_32x32x16_bf16 v[64:79], a[24:27], v[36:39], v[64:79]
  ds_read_b128 v[28:31], v9 offset:8192
  v_cvt_pk_bf16_f32 v130, v100, v101
  v_mul_f32 v102, s24, v102
  v_mfma_f32_32x32x16_bf16 v[80:95], a[28:31], v[36:39], v[80:95]
  s_waitcnt lgkmcnt(5)
  v_mul_f32 v103, s24, v103
  v_cvt_pk_bf16_f32 v131, v102, v103
  v_mfma_f32_32x32x16_bf16 v[64:79], a[32:35], v[40:43], v[64:79]
  s_add_u32 m0, s25, 2048
  ds_read_b128 v[32:35], v10 offset:8192
  v_mul_f32 v104, s24, v104
  v_mul_f32 v105, s24, v105
  v_mfma_f32_32x32x16_bf16 v[80:95], a[36:39], v[40:43], v[80:95]
  s_waitcnt lgkmcnt(5)
  buffer_load_dwordx4 v18, s[12:15], s19 offen sc1 lds
  v_cvt_pk_bf16_f32 v132, v104, v105
  v_mul_f32 v106, s24, v106
  v_mfma_f32_32x32x16_bf16 v[64:79], a[40:43], v[44:47], v[64:79]
  ds_read_b128 v[36:39], v11 offset:8192
  v_mul_f32 v107, s24, v107
  v_cvt_pk_bf16_f32 v133, v106, v107
  v_mfma_f32_32x32x16_bf16 v[80:95], a[44:47], v[44:47], v[80:95]
  s_waitcnt lgkmcnt(5)
  v_mul_f32 v108, s24, v108
  v_mul_f32 v109, s24, v109
  v_mfma_f32_32x32x16_bf16 v[64:79], a[48:51], v[48:51], v[64:79]
  s_add_u32 m0, s25, 3072
  ds_read_b128 v[40:43], v12 offset:8192
  v_cvt_pk_bf16_f32 v134, v108, v109
  v_mul_f32 v110, s24, v110
  v_mfma_f32_32x32x16_bf16 v[80:95], a[52:55], v[48:51], v[80:95]
  s_waitcnt lgkmcnt(5)
  buffer_load_dwordx4 v19, s[12:15], s19 offen sc1 lds
  v_mul_f32 v111, s24, v111
  v_cvt_pk_bf16_f32 v135, v110, v111
  v_mfma_f32_32x32x16_bf16 v[64:79], a[56:59], v[52:55], v[64:79]
  ds_read_b128 v[44:47], v13 offset:8192
  v_mul_f32 v112, s24, v112
  v_mul_f32 v113, s24, v113
  v_mfma_f32_32x32x16_bf16 v[80:95], a[60:63], v[52:55], v[80:95]
  s_waitcnt lgkmcnt(5)
  v_cvt_pk_bf16_f32 v136, v112, v113
  v_mul_f32 v114, s24, v114
  v_mfma_f32_32x32x16_bf16 v[64:79], a[64:67], v[24:27], v[64:79]
  s_add_u32 m0, s25, 4096
  ds_read_b128 v[48:51], v14 offset:8192
  v_mul_f32 v115, s24, v115
  v_cvt_pk_bf16_f32 v137, v114, v115
  v_mfma_f32_32x32x16_bf16 v[80:95], a[68:71], v[24:27], v[80:95]
  s_waitcnt lgkmcnt(5)
  buffer_load_dwordx4 v20, s[12:15], s19 offen sc1 lds
  v_mul_f32 v116, s24, v116
  v_mul_f32 v117, s24, v117
  v_mfma_f32_32x32x16_bf16 v[64:79], a[72:75], v[28:31], v[64:79]
  ds_read_b128 v[52:55], v15 offset:8192
  v_cvt_pk_bf16_f32 v138, v116, v117
  v_mul_f32 v118, s24, v118
  v_mfma_f32_32x32x16_bf16 v[80:95], a[76:79], v[28:31], v[80:95]
  s_waitcnt lgkmcnt(5)
  v_mul_f32 v119, s24, v119
  v_cvt_pk_bf16_f32 v139, v118, v119
  v_mfma_f32_32x32x16_bf16 v[64:79], a[80:83], v[32:35], v[64:79]
  s_add_u32 m0, s25, 5120
  ds_read_b128 v[24:27], v8 offset:16384
  v_mul_f32 v120, s24, v120
  v_mul_f32 v121, s24, v121
  v_mfma_f32_32x32x16_bf16 v[80:95], a[84:87], v[32:35], v[80:95]
  s_waitcnt lgkmcnt(5)
  buffer_load_dwordx4 v21, s[12:15], s19 offen sc1 lds
  v_cvt_pk_bf16_f32 v140, v120, v121
  v_mul_f32 v122, s24, v122
  v_mfma_f32_32x32x16_bf16 v[64:79], a[88:91], v[36:39], v[64:79]
  ds_read_b128 v[28:31], v9 offset:16384
  v_mul_f32 v123, s24, v123
  v_cvt_pk_bf16_f32 v141, v122, v123
  v_mfma_f32_32x32x16_bf16 v[80:95], a[92:95], v[36:39], v[80:95]
  s_waitcnt lgkmcnt(5)
  v_mul_f32 v124, s24, v124
  v_mul_f32 v125, s24, v125
  v_mfma_f32_32x32x16_bf16 v[64:79], a[96:99], v[40:43], v[64:79]
  s_add_u32 m0, s25, 6144
  ds_read_b128 v[32:35], v10 offset:16384
  v_cvt_pk_bf16_f32 v142, v124, v125
  v_mul_f32 v126, s24, v126
  v_mfma_f32_32x32x16_bf16 v[80:95], a[100:103], v[40:43], v[80:95]
  s_waitcnt lgkmcnt(5)
  buffer_load_dwordx4 v22, s[12:15], s19 offen sc1 lds
  v_mul_f32 v127, s24, v127
  v_cvt_pk_bf16_f32 v143, v126, v127
  v_mfma_f32_32x32x16_bf16 v[64:79], a[104:107], v[44:47], v[64:79]
  ds_read_b128 v[36:39], v11 offset:16384
  v_mfma_f32_32x32x16_bf16 v[80:95], a[108:111], v[44:47], v[80:95]
  s_waitcnt lgkmcnt(5)
  v_mfma_f32_32x32x16_bf16 v[64:79], a[112:115], v[48:51], v[64:79]
  s_add_u32 m0, s25, 7168
  ds_read_b128 v[40:43], v12 offset:16384
  v_mfma_f32_32x32x16_bf16 v[80:95], a[116:119], v[48:51], v[80:95]
  s_waitcnt lgkmcnt(5)
  buffer_load_dwordx4 v23, s[12:15], s19 offen sc1 lds
  v_mfma_f32_32x32x16_bf16 v[64:79], a[120:123], v[52:55], v[64:79]
  s_cmp_gt_u32 s23, 3
  ds_read_b128 v[44:47], v13 offset:16384
  v_mfma_f32_32x32x16_bf16 v[80:95], a[124:127], v[52:55], v[80:95]
  s_waitcnt lgkmcnt(5)
  s_cselect_b32 s26, s20, 0
  v_mfma_f32_32x32x16_bf16 v[64:79], a[128:131], v[24:27], v[64:79]
  s_add_u32 s19, s19, s26
  ds_read_b128 v[48:51], v14 offset:16384
  v_mfma_f32_32x32x16_bf16 v[80:95], a[132:135], v[24:27], v[80:95]
  s_waitcnt lgkmcnt(5)
  s_add_u32 s25, s25, 32768
  v_mfma_f32_32x32x16_bf16 v[64:79], a[136:139], v[28:31], v[64:79]
  s_and_b32 s25, s25, 0x1ffff
  ds_read_b128 v[52:55], v15 offset:16384
  v_mfma_f32_32x32x16_bf16 v[80:95], a[140:143], v[28:31], v[80:95]
  s_waitcnt lgkmcnt(5)
  buffer_store_dwordx4 v[128:131], v7, s[4:7], s21 offen offset:0 sc1
  v_mfma_f32_32x32x16_bf16 v[64:79], a[144:147], v[32:35], v[64:79]
  ds_read_b128 v[24:27], v8 offset:24576
  v_mfma_f32_32x32x16_bf16 v[80:95], a[148:151], v[32:35], v[80:95]
  s_waitcnt lgkmcnt(5)
  v_mfma_f32_32x32x16_bf16 v[64:79], a[152:155], v[36:39], v[64:79]
  ds_read_b128 v[28:31], v9 offset:24576
  v_mfma_f32_32x32x16_bf16 v[80:95], a[156:159], v[36:39], v[80:95]
  s_waitcnt lgkmcnt(5)
  buffer_store_dwordx4 v[132:135], v7, s[4:7], s21 offen offset:1024 sc1
  v_mfma_f32_32x32x16_bf16 v[64:79], a[160:163], v[40:43], v[64:79]
  ds_read_b128 v[32:35], v10 offset:24576
  v_mfma_f32_32x32x16_bf16 v[80:95], a[164:167], v[40:43], v[80:95]
  s_waitcnt lgkmcnt(5)
  v_mfma_f32_32x32x16_bf16 v[64:79], a[168:171], v[44:47], v[64:79]
  ds_read_b128 v[36:39], v11 offset:24576
  v_mfma_f32_32x32x16_bf16 v[80:95], a[172:175], v[44:47], v[80:95]
  s_waitcnt lgkmcnt(5)
  buffer_store_dwordx4 v[136:139], v7, s[4:7], s21 offen offset:2048 sc1
  v_mfma_f32_32x32x16_bf16 v[64:79], a[176:179], v[48:51], v[64:79]
  ds_read_b128 v[40:43], v12 offset:24576
  v_mfma_f32_32x32x16_bf16 v[80:95], a[180:183], v[48:51], v[80:95]
  s_waitcnt lgkmcnt(5)
  v_mfma_f32_32x32x16_bf16 v[64:79], a[184:187], v[52:55], v[64:79]
  ds_read_b128 v[44:47], v13 offset:24576
  v_mfma_f32_32x32x16_bf16 v[80:95], a[188:191], v[52:55], v[80:95]
  s_waitcnt lgkmcnt(5)
  buffer_store_dwordx4 v[140:143], v7, s[4:7], s21 offen offset:3072 sc1
  v_mfma_f32_32x32x16_bf16 v[64:79], a[192:195], v[24:27], v[64:79]
  s_mov_b32 s21, s27
  ds_read_b128 v[48:51], v14 offset:24576
  v_mov_b32 v7, v2
  v_mfma_f32_32x32x16_bf16 v[80:95], a[196:199], v[24:27], v[80:95]
  s_waitcnt lgkmcnt(5)
  v_mfma_f32_32x32x16_bf16 v[64:79], a[200:203], v[28:31], v[64:79]
  s_add_u32 s27, s27, s22
  ds_read_b128 v[52:55], v15 offset:24576
  v_mfma_f32_32x32x16_bf16 v[80:95], a[204:207], v[28:31], v[80:95]
  s_waitcnt lgkmcnt(5)
  s_waitcnt vmcnt(16)
  s_barrier
  v_mfma_f32_32x32x16_bf16 v[64:79], a[208:211], v[32:35], v[64:79]
  ds_read_b128 v[24:27], v8 offset:32768
  v_mfma_f32_32x32x16_bf16 v[80:95], a[212:215], v[32:35], v[80:95]
  s_waitcnt lgkmcnt(5)
  v_mfma_f32_32x32x16_bf16 v[64:79], a[216:219], v[36:39], v[64:79]
  ds_read_b128 v[28:31], v9 offset:32768
  v_mfma_f32_32x32x16_bf16 v[80:95], a[220:223], v[36:39], v[80:95]
  s_waitcnt lgkmcnt(5)
  v_mfma_f32_32x32x16_bf16 v[64:79], a[224:227], v[40:43], v[64:79]
  ds_read_b128 v[32:35], v10 offset:32768
  v_mfma_f32_32x32x16_bf16 v[80:95], a[228:231], v[40:43], v[80:95]
  s_waitcnt lgkmcnt(5)
  v_mfma_f32_32x32x16_bf16 v[64:79], a[232:235], v[44:47], v[64:79]
  ds_read_b128 v[36:39], v11 offset:32768
  v_mfma_f32_32x32x16_bf16 v[80:95], a[236:239], v[44:47], v[80:95]
  s_waitcnt lgkmcnt(5)
  v_mfma_f32_32x32x16_bf16 v[64:79], a[240:243], v[48:51], v[64:79]
  s_sub_u32 s23, s23, 1
  ds_read_b128 v[40:43], v12 offset:32768
  v_mfma_f32_32x32x16_bf16 v[80:95], a[244:247], v[48:51], v[80:95]
  s_waitcnt lgkmcnt(5)
  v_mfma_f32_32x32x16_bf16 v[64:79], a[248:251], v[52:55], v[64:79]
  s_cmp_eq_u32 s23, 0
  ds_read_b128 v[44:47], v13 offset:32768
  v_mfma_f32_32x32x16_bf16 v[80:95], a[252:255], v[52:55], v[80:95]
  s_cbranch_scc1 G_done0_46
  s_waitcnt lgkmcnt(5)
  v_mfma_f32_32x32x16_bf16 v[96:111], a[0:3], v[24:27], 0
  s_add_u32 m0, s25, 0
  ds_read_b128 v[48:51], v14 offset:32768
  v_mfma_f32_32x32x16_bf16 v[112:127], a[4:7], v[24:27], 0
  s_waitcnt lgkmcnt(5)
  buffer_load_dwordx4 v16, s[12:15], s19 offen sc1 lds
  v_mfma_f32_32x32x16_bf16 v[96:111], a[8:11], v[28:31], v[96:111]
  ds_read_b128 v[52:55], v15 offset:32768
  v_mul_f32 v64, s24, v64
  v_mul_f32 v65, s24, v65
  v_mfma_f32_32x32x16_bf16 v[112:127], a[12:15], v[28:31], v[112:127]
  s_waitcnt lgkmcnt(5)
  v_cvt_pk_bf16_f32 v128, v64, v65
  v_mul_f32 v66, s24, v66
  v_mfma_f32_32x32x16_bf16 v[96:111], a[16:19], v[32:35], v[96:111]
  s_add_u32 m0, s25, 1024
  ds_read_b128 v[24:27], v8 offset:40960
  v_mul_f32 v67, s24, v67
  v_cvt_pk_bf16_f32 v129, v66, v67
  v_mfma_f32_32x32x16_bf16 v[112:127], a[20:23], v[32:35], v[112:127]
  s_waitcnt lgkmcnt(5)
  buffer_load_dwordx4 v17, s[12:15], s19 offen sc1 lds
  v_mul_f32 v68, s24, v68
  v_mul_f32 v69, s24, v69
  v_mfma_f32_32x32x16_bf16 v[96:111], a[24:27], v[36:39], v[96:111]
  ds_read_b128 v[28:31], v9 offset:40960
  v_cvt_pk_bf16_f32 v130, v68, v69
  v_mul_f32 v70, s24, v70
  v_mfma_f32_32x32x16_bf16 v[112:127], a[28:31], v[36:39], v[112:127]
  s_waitcnt lgkmcnt(5)
  v_mul_f32 v71, s24, v71
  v_cvt_pk_bf16_f32 v131, v70, v71
  v_mfma_f32_32x32x16_bf16 v[96:111], a[32:35], v[40:43], v[96:111]
  s_add_u32 m0, s25, 2048
  ds_read_b128 v[32:35], v10 offset:40960
  v_mul_f32 v72, s24, v72
  v_mul_f32 v73, s24, v73
  v_mfma_f32_32x32x16_bf16 v[112:127], a[36:39], v[40:43], v[112:127]
  s_waitcnt lgkmcnt(5)
  buffer_load_dwordx4 v18, s[12:15], s19 offen sc1 lds
  v_cvt_pk_bf16_f32 v132, v72, v73
  v_mul_f32 v74, s24, v74
  v_mfma_f32_32x32x16_bf16 v[96:111], a[40:43], v[44:47], v[96:111]
  ds_read_b128 v[36:39], v11 offset:40960
  v_mul_f32 v75, s24, v75
  v_cvt_pk_bf16_f32 v133, v74, v75
  v_mfma_f32_32x32x16_bf16 v[112:127], a[44:47], v[44:47], v[112:127]
  s_waitcnt lgkmcnt(5)
  v_mul_f32 v76, s24, v76
  v_mul_f32 v77, s24, v77
  v_mfma_f32_32x32x16_bf16 v[96:111], a[48:51], v[48:51], v[96:111]
  s_add_u32 m0, s25, 3072
  ds_read_b128 v[40:43], v12 offset:40960
  v_cvt_pk_bf16_f32 v134, v76, v77
  v_mul_f32 v78, s24, v78
  v_mfma_f32_32x32x16_bf16 v[112:127], a[52:55], v[48:51], v[112:127]
  s_waitcnt lgkmcnt(5)
  buffer_load_dwordx4 v19, s[12:15], s19 offen sc1 lds
  v_mul_f32 v79, s24, v79
  v_cvt_pk_bf16_f32 v135, v78, v79
  v_mfma_f32_32x32x16_bf16 v[96:111], a[56:59], v[52:55], v[96:111]
  ds_read_b128 v[44:47], v13 offset:40960
  v_mul_f32 v80, s24, v80
  v_mul_f32 v81, s24, v81
  v_mfma_f32_32x32x16_bf16 v[112:127], a[60:63], v[52:55], v[112:127]
  s_waitcnt lgkmcnt(5)
  v_cvt_pk_bf16_f32 v136, v80, v81
  v_mul_f32 v82, s24, v82
  v_mfma_f32_32x32x16_bf16 v[96:111], a[64:67], v[24:27], v[96:111]
  s_add_u32 m0, s25, 4096
  ds_read_b128 v[48:51], v14 offset:40960
  v_mul_f32 v83, s24, v83
  v_cvt_pk_bf16_f32 v137, v82, v83
  v_mfma_f32_32x32x16_bf16 v[112:127], a[68:71], v[24:27], v[112:127]
  s_waitcnt lgkmcnt(5)
  buffer_load_dwordx4 v20, s[12:15], s19 offen sc1 lds
  v_mul_f32 v84, s24, v84
  v_mul_f32 v85, s24, v85
  v_mfma_f32_32x32x16_bf16 v[96:111], a[72:75], v[28:31], v[96:111]
  ds_read_b128 v[52:55], v15 offset:40960
  v_cvt_pk_bf16_f32 v138, v84, v85
  v_mul_f32 v86, s24, v86
  v_mfma_f32_32x32x16_bf16 v[112:127], a[76:79], v[28:31], v[112:127]
  s_waitcnt lgkmcnt(5)
  v_mul_f32 v87, s24, v87
  v_cvt_pk_bf16_f32 v139, v86, v87
  v_mfma_f32_32x32x16_bf16 v[96:111], a[80:83], v[32:35], v[96:111]
  s_add_u32 m0, s25, 5120
  ds_read_b128 v[24:27], v8 offset:49152
  v_mul_f32 v88, s24, v88
  v_mul_f32 v89, s24, v89
  v_mfma_f32_32x32x16_bf16 v[112:127], a[84:87], v[32:35], v[112:127]
  s_waitcnt lgkmcnt(5)
  buffer_load_dwordx4 v21, s[12:15], s19 offen sc1 lds
  v_cvt_pk_bf16_f32 v140, v88, v89
  v_mul_f32 v90, s24, v90
  v_mfma_f32_32x32x16_bf16 v[96:111], a[88:91], v[36:39], v[96:111]
  ds_read_b128 v[28:31], v9 offset:49152
  v_mul_f32 v91, s24, v91
  v_cvt_pk_bf16_f32 v141, v90, v91
  v_mfma_f32_32x32x16_bf16 v[112:127], a[92:95], v[36:39], v[112:127]
  s_waitcnt lgkmcnt(5)
  v_mul_f32 v92, s24, v92
  v_mul_f32 v93, s24, v93
  v_mfma_f32_32x32x16_bf16 v[96:111], a[96:99], v[40:43], v[96:111]
  s_add_u32 m0, s25, 6144
  ds_read_b128 v[32:35], v10 offset:49152
  v_cvt_pk_bf16_f32 v142, v92, v93
  v_mul_f32 v94, s24, v94
  v_mfma_f32_32x32x16_bf16 v[112:127], a[100:103], v[40:43], v[112:127]
  s_waitcnt lgkmcnt(5)
  buffer_load_dwordx4 v22, s[12:15], s19 offen sc1 lds
  v_mul_f32 v95, s24, v95
  v_cvt_pk_bf16_f32 v143, v94, v95
  v_mfma_f32_32x32x16_bf16 v[96:111], a[104:107], v[44:47], v[96:111]
  ds_read_b128 v[36:39], v11 offset:49152
  v_mfma_f32_32x32x16_bf16 v[112:127], a[108:111], v[44:47], v[112:127]
  s_waitcnt lgkmcnt(5)
  v_mfma_f32_32x32x16_bf16 v[96:111], a[112:115], v[48:51], v[96:111]
  s_add_u32 m0, s25, 7168
  ds_read_b128 v[40:43], v12 offset:49152
  v_mfma_f32_32x32x16_bf16 v[112:127], a[116:119], v[48:51], v[112:127]
  s_waitcnt lgkmcnt(5)
  buffer_load_dwordx4 v23, s[12:15], s19 offen sc1 lds
  v_mfma_f32_32x32x16_bf16 v[96:111], a[120:123], v[52:55], v[96:111]
  s_cmp_gt_u32 s23, 3
  ds_read_b128 v[44:47], v13 offset:49152
  v_mfma_f32_32x32x16_bf16 v[112:127], a[124:127], v[52:55], v[112:127]
  s_waitcnt lgkmcnt(5)
  s_cselect_b32 s26, s20, 0
  v_mfma_f32_32x32x16_bf16 v[96:111], a[128:131], v[24:27], v[96:111]
  s_add_u32 s19, s19, s26
  ds_read_b128 v[48:51], v14 offset:49152
  v_mfma_f32_32x32x16_bf16 v[112:127], a[132:135], v[24:27], v[112:127]
  s_waitcnt lgkmcnt(5)
  s_add_u32 s25, s25, 32768
  v_mfma_f32_32x32x16_bf16 v[96:111], a[136:139], v[28:31], v[96:111]
  s_and_b32 s25, s25, 0x1ffff
  ds_read_b128 v[52:55], v15 offset:49152
  v_mfma_f32_32x32x16_bf16 v[112:127], a[140:143], v[28:31], v[112:127]
  s_waitcnt lgkmcnt(5)
  buffer_store_dwordx4 v[128:131], v7, s[4:7], s21 offen offset:0 sc1
  v_mfma_f32_32x32x16_bf16 v[96:111], a[144:147], v[32:35], v[96:111]
  ds_read_b128 v[24:27], v8 offset:57344
  v_mfma_f32_32x32x16_bf16 v[112:127], a[148:151], v[32:35], v[112:127]
  s_waitcnt lgkmcnt(5)
  v_xor_b32 v8, 0x10000, v8
  v_mfma_f32_32x32x16_bf16 v[96:111], a[152:155], v[36:39], v[96:111]
  ds_read_b128 v[28:31], v9 offset:57344
  v_mfma_f32_32x32x16_bf16 v[112:127], a[156:159], v[36:39], v[112:127]
  s_waitcnt lgkmcnt(5)
  buffer_store_dwordx4 v[132:135], v7, s[4:7], s21 offen offset:1024 sc1
  v_xor_b32 v9, 0x10000, v9
  v_mfma_f32_32x32x16_bf16 v[96:111], a[160:163], v[40:43], v[96:111]
  ds_read_b128 v[32:35], v10 offset:57344
  v_mfma_f32_32x32x16_bf16 v[112:127], a[164:167], v[40:43], v[112:127]
  s_waitcnt lgkmcnt(5)
  v_xor_b32 v10, 0x10000, v10
  v_mfma_f32_32x32x16_bf16 v[96:111], a[168:171], v[44:47], v[96:111]
  ds_read_b128 v[36:39], v11 offset:57344
  v_mfma_f32_32x32x16_bf16 v[112:127], a[172:175], v[44:47], v[112:127]
  s_waitcnt lgkmcnt(5)
  buffer_store_dwordx4 v[136:139], v7, s[4:7], s21 offen offset:2048 sc1
  v_xor_b32 v11, 0x10000, v11
  v_mfma_f32_32x32x16_bf16 v[96:111], a[176:179], v[48:51], v[96:111]
  ds_read_b128 v[40:43], v12 offset:57344
  v_mfma_f32_32x32x16_bf16 v[112:127], a[180:183], v[48:51], v[112:127]
  s_waitcnt lgkmcnt(5)
  v_xor_b32 v12, 0x10000, v12
  v_mfma_f32_32x32x16_bf16 v[96:111], a[184:187], v[52:55], v[96:111]
  ds_read_b128 v[44:47], v13 offset:57344
  v_mfma_f32_32x32x16_bf16 v[112:127], a[188:191], v[52:55], v[112:127]
  s_waitcnt lgkmcnt(5)
  buffer_store_dwordx4 v[140:143], v7, s[4:7], s21 offen offset:3072 sc1
  v_xor_b32 v13, 0x10000, v13
  v_mfma_f32_32x32x16_bf16 v[96:111], a[192:195], v[24:27], v[96:111]
  s_mov_b32 s21, s27
  ds_read_b128 v[48:51], v14 offset:57344
  v_mov_b32 v7, v2
  v_mfma_f32_32x32x16_bf16 v[112:127], a[196:199], v[24:27], v[112:127]
  s_waitcnt lgkmcnt(5)
  v_xor_b32 v14, 0x10000, v14
  v_mfma_f32_32x32x16_bf16 v[96:111], a[200:203], v[28:31], v[96:111]
  s_add_u32 s27, s27, s22
  ds_read_b128 v[52:55], v15 offset:57344
  v_mfma_f32_32x32x16_bf16 v[112:127], a[204:207], v[28:31], v[112:127]
  s_waitcnt lgkmcnt(5)
  s_waitcnt vmcnt(16)
  s_barrier
  v_xor_b32 v15, 0x10000, v15
  v_mfma_f32_32x32x16_bf16 v[96:111], a[208:211], v[32:35], v[96:111]
  ds_read_b128 v[24:27], v8 offset:0
  v_mfma_f32_32x32x16_bf16 v[112:127], a[212:215], v[32:35], v[112:127]
  s_waitcnt lgkmcnt(5)
  v_mfma_f32_32x32x16_bf16 v[96:111], a[216:219], v[36:39], v[96:111]
  ds_read_b128 v[28:31], v9 offset:0
  v_mfma_f32_32x32x16_bf16 v[112:127], a[220:223], v[36:39], v[112:127]
  s_waitcnt lgkmcnt(5)
  v_mfma_f32_32x32x16_bf16 v[96:111], a[224:227], v[40:43], v[96:111]
  ds_read_b128 v[32:35], v10 offset:0
  v_mfma_f32_32x32x16_bf16 v[112:127], a[228:231], v[40:43], v[112:127]
  s_waitcnt lgkmcnt(5)
  v_mfma_f32_32x32x16_bf16 v[96:111], a[232:235], v[44:47], v[96:111]
  ds_read_b128 v[36:39], v11 offset:0
  v_mfma_f32_32x32x16_bf16 v[112:127], a[236:239], v[44:47], v[112:127]
  s_waitcnt lgkmcnt(5)
  v_mfma_f32_32x32x16_bf16 v[96:111], a[240:243], v[48:51], v[96:111]
  s_sub_u32 s23, s23, 1
  ds_read_b128 v[40:43], v12 offset:0
  v_mfma_f32_32x32x16_bf16 v[112:127], a[244:247], v[48:51], v[112:127]
  s_waitcnt lgkmcnt(5)
  v_mfma_f32_32x32x16_bf16 v[96:111], a[248:251], v[52:55], v[96:111]
  s_cmp_eq_u32 s23, 0
  ds_read_b128 v[44:47], v13 offset:0
  v_mfma_f32_32x32x16_bf16 v[112:127], a[252:255], v[52:55], v[112:127]
  s_cbranch_scc1 G_done1_47
  s_branch G_top_45
G_done0_46:
  s_nop 7
  s_nop 3
  v_mul_f32 v64, s24, v64
  v_mul_f32 v65, s24, v65
  v_cvt_pk_bf16_f32 v128, v64, v65
  v_mul_f32 v66, s24, v66
  v_mul_f32 v67, s24, v67
  v_cvt_pk_bf16_f32 v129, v66, v67
  v_mul_f32 v68, s24, v68
  v_mul_f32 v69, s24, v69
  v_cvt_pk_bf16_f32 v130, v68, v69
  v_mul_f32 v70, s24, v70
  v_mul_f32 v71, s24, v71
  v_cvt_pk_bf16_f32 v131, v70, v71
  buffer_store_dwordx4 v[128:131], v7, s[4:7], s21 offen offset:0 sc1
  v_mul_f32 v72, s24, v72
  v_mul_f32 v73, s24, v73
  v_cvt_pk_bf16_f32 v132, v72, v73
  v_mul_f32 v74, s24, v74
  v_mul_f32 v75, s24, v75
  v_cvt_pk_bf16_f32 v133, v74, v75
  v_mul_f32 v76, s24, v76
  v_mul_f32 v77, s24, v77
  v_cvt_pk_bf16_f32 v134, v76, v77
  v_mul_f32 v78, s24, v78
  v_mul_f32 v79, s24, v79
  v_cvt_pk_bf16_f32 v135, v78, v79
  buffer_store_dwordx4 v[132:135], v7, s[4:7], s21 offen offset:1024 sc1
  v_mul_f32 v80, s24, v80
  v_mul_f32 v81, s24, v81
  v_cvt_pk_bf16_f32 v136, v80, v81
  v_mul_f32 v82, s24, v82
  v_mul_f32 v83, s24, v83
  v_cvt_pk_bf16_f32 v137, v82, v83
  v_mul_f32 v84, s24, v84
  v_mul_f32 v85, s24, v85
  v_cvt_pk_bf16_f32 v138, v84, v85
  v_mul_f32 v86, s24, v86
  v_mul_f32 v87, s24, v87
  v_cvt_pk_bf16_f32 v139, v86, v87
  buffer_store_dwordx4 v[136:139], v7, s[4:7], s21 offen offset:2048 sc1
  v_mul_f32 v88, s24, v88
  v_mul_f32 v89, s24, v89
  v_cvt_pk_bf16_f32 v140, v88, v89
  v_mul_f32 v90, s24, v90
  v_mul_f32 v91, s24, v91
  v_cvt_pk_bf16_f32 v141, v90, v91
  v_mul_f32 v92, s24, v92
  v_mul_f32 v93, s24, v93
  v_cvt_pk_bf16_f32 v142, v92, v93
  v_mul_f32 v94, s24, v94
  v_mul_f32 v95, s24, v95
  v_cvt_pk_bf16_f32 v143, v94, v95
  buffer_store_dwordx4 v[140:143], v7, s[4:7], s21 offen offset:3072 sc1
  s_branch G_fin_48
G_done1_47:
  s_nop 7
  s_nop 3
  v_mul_f32 v96, s24, v96
  v_mul_f32 v97, s24, v97
  v_cvt_pk_bf16_f32 v128, v96, v97
  v_mul_f32 v98, s24, v98
  v_mul_f32 v99, s24, v99
  v_cvt_pk_bf16_f32 v129, v98, v99
  v_mul_f32 v100, s24, v100
  v_mul_f32 v101, s24, v101
  v_cvt_pk_bf16_f32 v130, v100, v101
  v_mul_f32 v102, s24, v102
  v_mul_f32 v103, s24, v103
  v_cvt_pk_bf16_f32 v131, v102, v103
  buffer_store_dwordx4 v[128:131], v7, s[4:7], s21 offen offset:0 sc1
  v_mul_f32 v104, s24, v104
  v_mul_f32 v105, s24, v105
  v_cvt_pk_bf16_f32 v132, v104, v105
  v_mul_f32 v106, s24, v106
  v_mul_f32 v107, s24, v107
  v_cvt_pk_bf16_f32 v133, v106, v107
  v_mul_f32 v108, s24, v108
  v_mul_f32 v109, s24, v109
  v_cvt_pk_bf16_f32 v134, v108, v109
  v_mul_f32 v110, s24, v110
  v_mul_f32 v111, s24, v111
  v_cvt_pk_bf16_f32 v135, v110, v111
  buffer_store_dwordx4 v[132:135], v7, s[4:7], s21 offen offset:1024 sc1
  v_mul_f32 v112, s24, v112
  v_mul_f32 v113, s24, v113
  v_cvt_pk_bf16_f32 v136, v112, v113
  v_mul_f32 v114, s24, v114
  v_mul_f32 v115, s24, v115
  v_cvt_pk_bf16_f32 v137, v114, v115
  v_mul_f32 v116, s24, v116
  v_mul_f32 v117, s24, v117
  v_cvt_pk_bf16_f32 v138, v116, v117
  v_mul_f32 v118, s24, v118
  v_mul_f32 v119, s24, v119
  v_cvt_pk_bf16_f32 v139, v118, v119
  buffer_store_dwordx4 v[136:139], v7, s[4:7], s21 offen offset:2048 sc1
  v_mul_f32 v120, s24, v120
  v_mul_f32 v121, s24, v121
  v_cvt_pk_bf16_f32 v140, v120, v121
  v_mul_f32 v122, s24, v122
  v_mul_f32 v123, s24, v123
  v_cvt_pk_bf16_f32 v141, v122, v123
  v_mul_f32 v124, s24, v124
  v_mul_f32 v125, s24, v125
  v_cvt_pk_bf16_f32 v142, v124, v125
  v_mul_f32 v126, s24, v126
  v_mul_f32 v127, s24, v127
  v_cvt_pk_bf16_f32 v143, v126, v127
  buffer_store_dwordx4 v[140:143], v7, s[4:7], s21 offen offset:3072 sc1
G_fin_48:
  s_waitcnt vmcnt(0) lgkmcnt(0)
  s_barrier
  s_waitcnt vmcnt(0)
  s_barrier
  s_mov_b32 s30, 768
  v_mov_b32 v144, s30
  v_min_u32 v145, 1, v0
  v_lshlrev_b32 v145, 30, v145
  buffer_store_dword v144, v145, s[4:7], s31 offen sc1
  s_mul_i32 s50, s64, 6
  s_add_u32 s50, s50, s65
  s_mul_i32 s76, s50, 21846
  s_lshr_b32 s76, s76, 16
  s_mul_i32 s77, s76, 3
  s_add_u32 s51, s50, 64
  s_cmp_eq_u32 s77, s50
  s_cselect_b32 s50, s76, s51
M_fin:
  s_lshr_b32 s48, s50, 2
  s_and_b32 s49, s50, 3
  s_load_dwordx2 s[8:9], s[0:1], 0
  s_load_dwordx2 s[12:13], s[0:1], 104
  s_load_dwordx2 s[32:33], s[0:1], 112
  v_and_b32 v4, 31, v1
  v_lshrrev_b32 v5, 5, v1
  v_lshlrev_b32 v5, 4, v5
  v_lshl_add_u32 v6, v4, 10, v5
  s_lshl_b32 s26, s16, 8
  s_lshl_b32 s27, s48, 15
  s_add_u32 s27, s27, s26
  s_waitcnt lgkmcnt(0)
  s_and_b32 s9, s9, 0xffff
  s_mov_b32 s10, 2097152
  s_mov_b32 s11, 0x20000
  s_and_b32 s13, s13, 0xffff
  s_mov_b32 s14, 1024
  s_mov_b32 s15, 0x20000
  s_and_b32 s33, s33, 0xffff
  s_mov_b32 s34, 2097152
  s_mov_b32 s35, 0x20000
  buffer_load_dwordx4 v[16:19], v6, s[8:11], s27 offen offset:0
  buffer_load_dwordx4 v[48:51], v5, s[12:15], s26 offen offset:0
  buffer_load_dwordx4 v[20:23], v6, s[8:11], s27 offen offset:32
  buffer_load_dwordx4 v[52:55], v5, s[12:15], s26 offen offset:32
  buffer_load_dwordx4 v[24:27], v6, s[8:11], s27 offen offset:64
  buffer_load_dwordx4 v[56:59], v5, s[12:15], s26 offen offset:64
  buffer_load_dwordx4 v[28:31], v6, s[8:11], s27 offen offset:96
  buffer_load_dwordx4 v[60:63], v5, s[12:15], s26 offen offset:96
  buffer_load_dwordx4 v[32:35], v6, s[8:11], s27 offen offset:128
  buffer_load_dwordx4 v[64:67], v5, s[12:15], s26 offen offset:128
  buffer_load_dwordx4 v[36:39], v6, s[8:11], s27 offen offset:160
  buffer_load_dwordx4 v[68:71], v5, s[12:15], s26 offen offset:160
  buffer_load_dwordx4 v[40:43], v6, s[8:11], s27 offen offset:192
  buffer_load_dwordx4 v[72:75], v5, s[12:15], s26 offen offset:192
  buffer_load_dwordx4 v[44:47], v6, s[8:11], s27 offen offset:224
  buffer_load_dwordx4 v[76:79], v5, s[12:15], s26 offen offset:224
  s_lshl_b32 s28, s48, 2
  s_add_u32 s28, s28, s49
  s_lshl_b32 s28, s28, 2
  s_add_u32 s28, s28, s16
  s_lshl_b32 s28, s28, 11
  s_waitcnt vmcnt(14)
  v_mfma_f32_32x32x16_bf16 v[80:95], v[48:51], v[16:19], 0
  s_waitcnt vmcnt(12)
  v_mfma_f32_32x32x16_bf16 v[80:95], v[52:55], v[20:23], v[80:95]
  s_waitcnt vmcnt(10)
  v_mfma_f32_32x32x16_bf16 v[80:95], v[56:59], v[24:27], v[80:95]
  s_waitcnt vmcnt(8)
  v_mfma_f32_32x32x16_bf16 v[80:95], v[60:63], v[28:31], v[80:95]
  s_waitcnt vmcnt(6)
  v_mfma_f32_32x32x16_bf16 v[80:95], v[64:67], v[32:35], v[80:95]
  s_waitcnt vmcnt(4)
  v_mfma_f32_32x32x16_bf16 v[80:95], v[68:71], v[36:39], v[80:95]
  s_waitcnt vmcnt(2)
  v_mfma_f32_32x32x16_bf16 v[80:95], v[72:75], v[40:43], v[80:95]
  s_waitcnt vmcnt(0)
  v_mfma_f32_32x32x16_bf16 v[80:95], v[76:79], v[44:47], v[80:95]
  s_mul_i32 s76, s48, 43
  s_lshr_b32 s76, s76, 9
  s_mul_i32 s76, s76, 12
  s_sub_u32 s76, s48, s76
  s_cmp_ge_u32 s76, 6
  s_addc_u32 s76, s76, 0
  s_and_b32 s77, s49, 2
  s_mul_i32 s77, s77, 7
  s_add_u32 s76, s76, s77
  v_mov_b32 v193, 0x300
  s_lshl_b32 s76, s76, 7
  s_add_u32 s76, s76, 148897792
  v_and_b32 v192, 7, v1
  v_mul_u32_u24 v192, 3584, v192
  v_add_u32 v192, s76, v192
  s_mov_b32 s71, 0
  s_branch M_vg_50
M_vw_49:
  s_sleep 2
  s_add_u32 s71, s71, 1
  s_cmp_gt_u32 s71, 262144
  s_cbranch_scc1 M_exit
M_vg_50:
  buffer_load_dword v194, v192, s[4:7], 0 offen sc1
  s_waitcnt vmcnt(0)
  v_cmp_lt_u32 vcc, v194, v193
  s_cbranch_vccnz M_vw_49
  s_add_u32 s29, s28, 150994944
  buffer_load_dwordx4 v[96:99], v2, s[4:7], s29 offen offset:0 sc1
  buffer_load_dwordx4 v[100:103], v2, s[4:7], s29 offen offset:1024 sc1
  s_add_u32 s29, s28, 153092096
  buffer_load_dwordx4 v[104:107], v2, s[4:7], s29 offen offset:0 sc1
  buffer_load_dwordx4 v[108:111], v2, s[4:7], s29 offen offset:1024 sc1
  s_add_u32 s29, s28, 155189248
  buffer_load_dwordx4 v[112:115], v2, s[4:7], s29 offen offset:0 sc1
  buffer_load_dwordx4 v[116:119], v2, s[4:7], s29 offen offset:1024 sc1
  s_add_u32 s29, s28, 157286400
  buffer_load_dwordx4 v[120:123], v2, s[4:7], s29 offen offset:0 sc1
  buffer_load_dwordx4 v[124:127], v2, s[4:7], s29 offen offset:1024 sc1
  s_add_u32 s29, s28, 159383552
  buffer_load_dwordx4 v[128:131], v2, s[4:7], s29 offen offset:0 sc1
  buffer_load_dwordx4 v[132:135], v2, s[4:7], s29 offen offset:1024 sc1
  s_add_u32 s29, s28, 161480704
  buffer_load_dwordx4 v[136:139], v2, s[4:7], s29 offen offset:0 sc1
  buffer_load_dwordx4 v[140:143], v2, s[4:7], s29 offen offset:1024 sc1
  s_add_u32 s29, s28, 163577856
  buffer_load_dwordx4 v[144:147], v2, s[4:7], s29 offen offset:0 sc1
  buffer_load_dwordx4 v[148:151], v2, s[4:7], s29 offen offset:1024 sc1
  s_add_u32 s29, s28, 165675008
  buffer_load_dwordx4 v[152:155], v2, s[4:7], s29 offen offset:0 sc1
  buffer_load_dwordx4 v[156:159], v2, s[4:7], s29 offen offset:1024 sc1
  v_lshlrev_b32 v7, 4, v4
  s_lshl_b32 s26, s16, 2
  v_add_u32 v4, s26, v7
  s_barrier
  ds_write_b32 v4, v80
  s_waitcnt lgkmcnt(0)
  s_barrier
  ds_read_b128 v[84:87], v7
  s_waitcnt lgkmcnt(0)
  v_add_f32 v80, v84, v85
  v_add_f32 v81, v86, v87
  v_add_f32 v80, v80, v81
  v_mul_f32 v80, 0xbfb8aa3b, v80
  v_exp_f32 v80, v80
  s_nop 0
  v_add_f32 v80, 1.0, v80
  v_rcp_f32 v80, v80
  s_nop 0
  v_sub_f32 v82, 1.0, v80
  s_waitcnt vmcnt(14)
  v_lshlrev_b32 v160, 16, v96
  v_and_b32 v161, 0xffff0000, v96
  v_lshlrev_b32 v162, 16, v97
  v_and_b32 v163, 0xffff0000, v97
  v_lshlrev_b32 v164, 16, v98
  v_and_b32 v165, 0xffff0000, v98
  v_lshlrev_b32 v166, 16, v99
  v_and_b32 v167, 0xffff0000, v99
  v_lshlrev_b32 v168, 16, v100
  v_and_b32 v169, 0xffff0000, v100
  v_lshlrev_b32 v170, 16, v101
  v_and_b32 v171, 0xffff0000, v101
  v_lshlrev_b32 v172, 16, v102
  v_and_b32 v173, 0xffff0000, v102
  v_lshlrev_b32 v174, 16, v103
  v_and_b32 v175, 0xffff0000, v103
  s_waitcnt vmcnt(12)
  v_lshlrev_b32 v8, 16, v104
  v_and_b32 v9, 0xffff0000, v104
  v_pk_add_f32 v[160:161], v[160:161], v[8:9]
  v_lshlrev_b32 v10, 16, v105
  v_and_b32 v11, 0xffff0000, v105
  v_pk_add_f32 v[162:163], v[162:163], v[10:11]
  v_lshlrev_b32 v12, 16, v106
  v_and_b32 v13, 0xffff0000, v106
  v_pk_add_f32 v[164:165], v[164:165], v[12:13]
  v_lshlrev_b32 v14, 16, v107
  v_and_b32 v15, 0xffff0000, v107
  v_pk_add_f32 v[166:167], v[166:167], v[14:15]
  v_lshlrev_b32 v8, 16, v108
  v_and_b32 v9, 0xffff0000, v108
  v_pk_add_f32 v[168:169], v[168:169], v[8:9]
  v_lshlrev_b32 v10, 16, v109
  v_and_b32 v11, 0xffff0000, v109
  v_pk_add_f32 v[170:171], v[170:171], v[10:11]
  v_lshlrev_b32 v12, 16, v110
  v_and_b32 v13, 0xffff0000, v110
  v_pk_add_f32 v[172:173], v[172:173], v[12:13]
  v_lshlrev_b32 v14, 16, v111
  v_and_b32 v15, 0xffff0000, v111
  v_pk_add_f32 v[174:175], v[174:175], v[14:15]
  s_waitcnt vmcnt(10)
  v_lshlrev_b32 v8, 16, v112
  v_and_b32 v9, 0xffff0000, v112
  v_pk_add_f32 v[160:161], v[160:161], v[8:9]
  v_lshlrev_b32 v10, 16, v113
  v_and_b32 v11, 0xffff0000, v113
  v_pk_add_f32 v[162:163], v[162:163], v[10:11]
  v_lshlrev_b32 v12, 16, v114
  v_and_b32 v13, 0xffff0000, v114
  v_pk_add_f32 v[164:165], v[164:165], v[12:13]
  v_lshlrev_b32 v14, 16, v115
  v_and_b32 v15, 0xffff0000, v115
  v_pk_add_f32 v[166:167], v[166:167], v[14:15]
  v_lshlrev_b32 v8, 16, v116
  v_and_b32 v9, 0xffff0000, v116
  v_pk_add_f32 v[168:169], v[168:169], v[8:9]
  v_lshlrev_b32 v10, 16, v117
  v_and_b32 v11, 0xffff0000, v117
  v_pk_add_f32 v[170:171], v[170:171], v[10:11]
  v_lshlrev_b32 v12, 16, v118
  v_and_b32 v13, 0xffff0000, v118
  v_pk_add_f32 v[172:173], v[172:173], v[12:13]
  v_lshlrev_b32 v14, 16, v119
  v_and_b32 v15, 0xffff0000, v119
  v_pk_add_f32 v[174:175], v[174:175], v[14:15]
  s_waitcnt vmcnt(8)
  v_lshlrev_b32 v8, 16, v120
  v_and_b32 v9, 0xffff0000, v120
  v_pk_add_f32 v[160:161], v[160:161], v[8:9]
  v_lshlrev_b32 v10, 16, v121
  v_and_b32 v11, 0xffff0000, v121
  v_pk_add_f32 v[162:163], v[162:163], v[10:11]
  v_lshlrev_b32 v12, 16, v122
  v_and_b32 v13, 0xffff0000, v122
  v_pk_add_f32 v[164:165], v[164:165], v[12:13]
  v_lshlrev_b32 v14, 16, v123
  v_and_b32 v15, 0xffff0000, v123
  v_pk_add_f32 v[166:167], v[166:167], v[14:15]
  v_lshlrev_b32 v8, 16, v124
  v_and_b32 v9, 0xffff0000, v124
  v_pk_add_f32 v[168:169], v[168:169], v[8:9]
  v_lshlrev_b32 v10, 16, v125
  v_and_b32 v11, 0xffff0000, v125
  v_pk_add_f32 v[170:171], v[170:171], v[10:11]
  v_lshlrev_b32 v12, 16, v126
  v_and_b32 v13, 0xffff0000, v126
  v_pk_add_f32 v[172:173], v[172:173], v[12:13]
  v_lshlrev_b32 v14, 16, v127
  v_and_b32 v15, 0xffff0000, v127
  v_pk_add_f32 v[174:175], v[174:175], v[14:15]
  s_waitcnt vmcnt(6)
  v_lshlrev_b32 v8, 16, v128
  v_and_b32 v9, 0xffff0000, v128
  v_pk_add_f32 v[160:161], v[160:161], v[8:9]
  v_lshlrev_b32 v10, 16, v129
  v_and_b32 v11, 0xffff0000, v129
  v_pk_add_f32 v[162:163], v[162:163], v[10:11]
  v_lshlrev_b32 v12, 16, v130
  v_and_b32 v13, 0xffff0000, v130
  v_pk_add_f32 v[164:165], v[164:165], v[12:13]
  v_lshlrev_b32 v14, 16, v131
  v_and_b32 v15, 0xffff0000, v131
  v_pk_add_f32 v[166:167], v[166:167], v[14:15]
  v_lshlrev_b32 v8, 16, v132
  v_and_b32 v9, 0xffff0000, v132
  v_pk_add_f32 v[168:169], v[168:169], v[8:9]
  v_lshlrev_b32 v10, 16, v133
  v_and_b32 v11, 0xffff0000, v133
  v_pk_add_f32 v[170:171], v[170:171], v[10:11]
  v_lshlrev_b32 v12, 16, v134
  v_and_b32 v13, 0xffff0000, v134
  v_pk_add_f32 v[172:173], v[172:173], v[12:13]
  v_lshlrev_b32 v14, 16, v135
  v_and_b32 v15, 0xffff0000, v135
  v_pk_add_f32 v[174:175], v[174:175], v[14:15]
  s_waitcnt vmcnt(4)
  v_lshlrev_b32 v8, 16, v136
  v_and_b32 v9, 0xffff0000, v136
  v_pk_add_f32 v[160:161], v[160:161], v[8:9]
  v_lshlrev_b32 v10, 16, v137
  v_and_b32 v11, 0xffff0000, v137
  v_pk_add_f32 v[162:163], v[162:163], v[10:11]
  v_lshlrev_b32 v12, 16, v138
  v_and_b32 v13, 0xffff0000, v138
  v_pk_add_f32 v[164:165], v[164:165], v[12:13]
  v_lshlrev_b32 v14, 16, v139
  v_and_b32 v15, 0xffff0000, v139
  v_pk_add_f32 v[166:167], v[166:167], v[14:15]
  v_lshlrev_b32 v8, 16, v140
  v_and_b32 v9, 0xffff0000, v140
  v_pk_add_f32 v[168:169], v[168:169], v[8:9]
  v_lshlrev_b32 v10, 16, v141
  v_and_b32 v11, 0xffff0000, v141
  v_pk_add_f32 v[170:171], v[170:171], v[10:11]
  v_lshlrev_b32 v12, 16, v142
  v_and_b32 v13, 0xffff0000, v142
  v_pk_add_f32 v[172:173], v[172:173], v[12:13]
  v_lshlrev_b32 v14, 16, v143
  v_and_b32 v15, 0xffff0000, v143
  v_pk_add_f32 v[174:175], v[174:175], v[14:15]
  s_waitcnt vmcnt(2)
  v_lshlrev_b32 v8, 16, v144
  v_and_b32 v9, 0xffff0000, v144
  v_pk_add_f32 v[160:161], v[160:161], v[8:9]
  v_lshlrev_b32 v10, 16, v145
  v_and_b32 v11, 0xffff0000, v145
  v_pk_add_f32 v[162:163], v[162:163], v[10:11]
  v_lshlrev_b32 v12, 16, v146
  v_and_b32 v13, 0xffff0000, v146
  v_pk_add_f32 v[164:165], v[164:165], v[12:13]
  v_lshlrev_b32 v14, 16, v147
  v_and_b32 v15, 0xffff0000, v147
  v_pk_add_f32 v[166:167], v[166:167], v[14:15]
  v_lshlrev_b32 v8, 16, v148
  v_and_b32 v9, 0xffff0000, v148
  v_pk_add_f32 v[168:169], v[168:169], v[8:9]
  v_lshlrev_b32 v10, 16, v149
  v_and_b32 v11, 0xffff0000, v149
  v_pk_add_f32 v[170:171], v[170:171], v[10:11]
  v_lshlrev_b32 v12, 16, v150
  v_and_b32 v13, 0xffff0000, v150
  v_pk_add_f32 v[172:173], v[172:173], v[12:13]
  v_lshlrev_b32 v14, 16, v151
  v_and_b32 v15, 0xffff0000, v151
  v_pk_add_f32 v[174:175], v[174:175], v[14:15]
  s_waitcnt vmcnt(0)
  v_lshlrev_b32 v8, 16, v152
  v_and_b32 v9, 0xffff0000, v152
  v_pk_add_f32 v[160:161], v[160:161], v[8:9]
  v_lshlrev_b32 v10, 16, v153
  v_and_b32 v11, 0xffff0000, v153
  v_pk_add_f32 v[162:163], v[162:163], v[10:11]
  v_lshlrev_b32 v12, 16, v154
  v_and_b32 v13, 0xffff0000, v154
  v_pk_add_f32 v[164:165], v[164:165], v[12:13]
  v_lshlrev_b32 v14, 16, v155
  v_and_b32 v15, 0xffff0000, v155
  v_pk_add_f32 v[166:167], v[166:167], v[14:15]
  v_lshlrev_b32 v8, 16, v156
  v_and_b32 v9, 0xffff0000, v156
  v_pk_add_f32 v[168:169], v[168:169], v[8:9]
  v_lshlrev_b32 v10, 16, v157
  v_and_b32 v11, 0xffff0000, v157
  v_pk_add_f32 v[170:171], v[170:171], v[10:11]
  v_lshlrev_b32 v12, 16, v158
  v_and_b32 v13, 0xffff0000, v158
  v_pk_add_f32 v[172:173], v[172:173], v[12:13]
  v_lshlrev_b32 v14, 16, v159
  v_and_b32 v15, 0xffff0000, v159
  v_pk_add_f32 v[174:175], v[174:175], v[14:15]
  s_and_b32 s76, s48, 1
  s_lshl_b32 s76, s76, 1
  s_lshr_b32 s77, s49, 1
  s_add_u32 s76, s76, s77
  s_mul_i32 s76, s76, 7
  s_add_u32 s76, s76, 6
  s_lshr_b32 s77, s48, 1
  s_add_u32 s77, s77, 0x201
  v_mov_b32 v193, s77
  s_lshl_b32 s76, s76, 7
  s_add_u32 s76, s76, 148897792
  v_and_b32 v192, 7, v1
  v_mul_u32_u24 v192, 3584, v192
  v_add_u32 v192, s76, v192
  s_mov_b32 s71, 0
  s_branch M_vg_52
M_vw_51:
  s_sleep 2
  s_add_u32 s71, s71, 1
  s_cmp_gt_u32 s71, 262144
  s_cbranch_scc1 M_exit
M_vg_52:
  buffer_load_dword v194, v192, s[4:7], 0 offen sc1
  s_waitcnt vmcnt(0)
  v_cmp_lt_u32 vcc, v194, v193
  s_cbranch_vccnz M_vw_51
  s_add_u32 s29, s28, 167772160
  buffer_load_dwordx4 v[96:99], v2, s[4:7], s29 offen offset:0 sc1
  buffer_load_dwordx4 v[100:103], v2, s[4:7], s29 offen offset:1024 sc1
  s_add_u32 s29, s28, 169869312
  buffer_load_dwordx4 v[104:107], v2, s[4:7], s29 offen offset:0 sc1
  buffer_load_dwordx4 v[108:111], v2, s[4:7], s29 offen offset:1024 sc1
  s_add_u32 s29, s28, 171966464
  buffer_load_dwordx4 v[112:115], v2, s[4:7], s29 offen offset:0 sc1
  buffer_load_dwordx4 v[116:119], v2, s[4:7], s29 offen offset:1024 sc1
  s_add_u32 s29, s28, 174063616
  buffer_load_dwordx4 v[120:123], v2, s[4:7], s29 offen offset:0 sc1
  buffer_load_dwordx4 v[124:127], v2, s[4:7], s29 offen offset:1024 sc1
  s_add_u32 s29, s28, 176160768
  buffer_load_dwordx4 v[128:131], v2, s[4:7], s29 offen offset:0 sc1
  buffer_load_dwordx4 v[132:135], v2, s[4:7], s29 offen offset:1024 sc1
  s_add_u32 s29, s28, 178257920
  buffer_load_dwordx4 v[136:139], v2, s[4:7], s29 offen offset:0 sc1
  buffer_load_dwordx4 v[140:143], v2, s[4:7], s29 offen offset:1024 sc1
  s_add_u32 s29, s28, 180355072
  buffer_load_dwordx4 v[144:147], v2, s[4:7], s29 offen offset:0 sc1
  buffer_load_dwordx4 v[148:151], v2, s[4:7], s29 offen offset:1024 sc1
  s_add_u32 s29, s28, 182452224
  buffer_load_dwordx4 v[152:155], v2, s[4:7], s29 offen offset:0 sc1
  buffer_load_dwordx4 v[156:159], v2, s[4:7], s29 offen offset:1024 sc1
  v_pk_mul_f32 v[160:161], v[160:161], v[80:81] op_sel_hi:[1,0]
  v_pk_mul_f32 v[162:163], v[162:163], v[80:81] op_sel_hi:[1,0]
  v_pk_mul_f32 v[164:165], v[164:165], v[80:81] op_sel_hi:[1,0]
  v_pk_mul_f32 v[166:167], v[166:167], v[80:81] op_sel_hi:[1,0]
  v_pk_mul_f32 v[168:169], v[168:169], v[80:81] op_sel_hi:[1,0]
  v_pk_mul_f32 v[170:171], v[170:171], v[80:81] op_sel_hi:[1,0]
  v_pk_mul_f32 v[172:173], v[172:173], v[80:81] op_sel_hi:[1,0]
  v_pk_mul_f32 v[174:175], v[174:175], v[80:81] op_sel_hi:[1,0]
  s_waitcnt vmcnt(14)
  v_lshlrev_b32 v176, 16, v96
  v_and_b32 v177, 0xffff0000, v96
  v_lshlrev_b32 v178, 16, v97
  v_and_b32 v179, 0xffff0000, v97
  v_lshlrev_b32 v180, 16, v98
  v_and_b32 v181, 0xffff0000, v98
  v_lshlrev_b32 v182, 16, v99
  v_and_b32 v183, 0xffff0000, v99
  v_lshlrev_b32 v184, 16, v100
  v_and_b32 v185, 0xffff0000, v100
  v_lshlrev_b32 v186, 16, v101
  v_and_b32 v187, 0xffff0000, v101
  v_lshlrev_b32 v188, 16, v102
  v_and_b32 v189, 0xffff0000, v102
  v_lshlrev_b32 v190, 16, v103
  v_and_b32 v191, 0xffff0000, v103
  s_waitcnt vmcnt(12)
  v_lshlrev_b32 v8, 16, v104
  v_and_b32 v9, 0xffff0000, v104
  v_pk_add_f32 v[176:177], v[176:177], v[8:9]
  v_lshlrev_b32 v10, 16, v105
  v_and_b32 v11, 0xffff0000, v105
  v_pk_add_f32 v[178:179], v[178:179], v[10:11]
  v_lshlrev_b32 v12, 16, v106
  v_and_b32 v13, 0xffff0000, v106
  v_pk_add_f32 v[180:181], v[180:181], v[12:13]
  v_lshlrev_b32 v14, 16, v107
  v_and_b32 v15, 0xffff0000, v107
  v_pk_add_f32 v[182:183], v[182:183], v[14:15]
  v_lshlrev_b32 v8, 16, v108
  v_and_b32 v9, 0xffff0000, v108
  v_pk_add_f32 v[184:185], v[184:185], v[8:9]
  v_lshlrev_b32 v10, 16, v109
  v_and_b32 v11, 0xffff0000, v109
  v_pk_add_f32 v[186:187], v[186:187], v[10:11]
  v_lshlrev_b32 v12, 16, v110
  v_and_b32 v13, 0xffff0000, v110
  v_pk_add_f32 v[188:189], v[188:189], v[12:13]
  v_lshlrev_b32 v14, 16, v111
  v_and_b32 v15, 0xffff0000, v111
  v_pk_add_f32 v[190:191], v[190:191], v[14:15]
  s_waitcnt vmcnt(10)
  v_lshlrev_b32 v8, 16, v112
  v_and_b32 v9, 0xffff0000, v112
  v_pk_add_f32 v[176:177], v[176:177], v[8:9]
  v_lshlrev_b32 v10, 16, v113
  v_and_b32 v11, 0xffff0000, v113
  v_pk_add_f32 v[178:179], v[178:179], v[10:11]
  v_lshlrev_b32 v12, 16, v114
  v_and_b32 v13, 0xffff0000, v114
  v_pk_add_f32 v[180:181], v[180:181], v[12:13]
  v_lshlrev_b32 v14, 16, v115
  v_and_b32 v15, 0xffff0000, v115
  v_pk_add_f32 v[182:183], v[182:183], v[14:15]
  v_lshlrev_b32 v8, 16, v116
  v_and_b32 v9, 0xffff0000, v116
  v_pk_add_f32 v[184:185], v[184:185], v[8:9]
  v_lshlrev_b32 v10, 16, v117
  v_and_b32 v11, 0xffff0000, v117
  v_pk_add_f32 v[186:187], v[186:187], v[10:11]
  v_lshlrev_b32 v12, 16, v118
  v_and_b32 v13, 0xffff0000, v118
  v_pk_add_f32 v[188:189], v[188:189], v[12:13]
  v_lshlrev_b32 v14, 16, v119
  v_and_b32 v15, 0xffff0000, v119
  v_pk_add_f32 v[190:191], v[190:191], v[14:15]
  s_waitcnt vmcnt(8)
  v_lshlrev_b32 v8, 16, v120
  v_and_b32 v9, 0xffff0000, v120
  v_pk_add_f32 v[176:177], v[176:177], v[8:9]
  v_lshlrev_b32 v10, 16, v121
  v_and_b32 v11, 0xffff0000, v121
  v_pk_add_f32 v[178:179], v[178:179], v[10:11]
  v_lshlrev_b32 v12, 16, v122
  v_and_b32 v13, 0xffff0000, v122
  v_pk_add_f32 v[180:181], v[180:181], v[12:13]
  v_lshlrev_b32 v14, 16, v123
  v_and_b32 v15, 0xffff0000, v123
  v_pk_add_f32 v[182:183], v[182:183], v[14:15]
  v_lshlrev_b32 v8, 16, v124
  v_and_b32 v9, 0xffff0000, v124
  v_pk_add_f32 v[184:185], v[184:185], v[8:9]
  v_lshlrev_b32 v10, 16, v125
  v_and_b32 v11, 0xffff0000, v125
  v_pk_add_f32 v[186:187], v[186:187], v[10:11]
  v_lshlrev_b32 v12, 16, v126
  v_and_b32 v13, 0xffff0000, v126
  v_pk_add_f32 v[188:189], v[188:189], v[12:13]
  v_lshlrev_b32 v14, 16, v127
  v_and_b32 v15, 0xffff0000, v127
  v_pk_add_f32 v[190:191], v[190:191], v[14:15]
  s_waitcnt vmcnt(6)
  v_lshlrev_b32 v8, 16, v128
  v_and_b32 v9, 0xffff0000, v128
  v_pk_add_f32 v[176:177], v[176:177], v[8:9]
  v_lshlrev_b32 v10, 16, v129
  v_and_b32 v11, 0xffff0000, v129
  v_pk_add_f32 v[178:179], v[178:179], v[10:11]
  v_lshlrev_b32 v12, 16, v130
  v_and_b32 v13, 0xffff0000, v130
  v_pk_add_f32 v[180:181], v[180:181], v[12:13]
  v_lshlrev_b32 v14, 16, v131
  v_and_b32 v15, 0xffff0000, v131
  v_pk_add_f32 v[182:183], v[182:183], v[14:15]
  v_lshlrev_b32 v8, 16, v132
  v_and_b32 v9, 0xffff0000, v132
  v_pk_add_f32 v[184:185], v[184:185], v[8:9]
  v_lshlrev_b32 v10, 16, v133
  v_and_b32 v11, 0xffff0000, v133
  v_pk_add_f32 v[186:187], v[186:187], v[10:11]
  v_lshlrev_b32 v12, 16, v134
  v_and_b32 v13, 0xffff0000, v134
  v_pk_add_f32 v[188:189], v[188:189], v[12:13]
  v_lshlrev_b32 v14, 16, v135
  v_and_b32 v15, 0xffff0000, v135
  v_pk_add_f32 v[190:191], v[190:191], v[14:15]
  s_waitcnt vmcnt(4)
  v_lshlrev_b32 v8, 16, v136
  v_and_b32 v9, 0xffff0000, v136
  v_pk_add_f32 v[176:177], v[176:177], v[8:9]
  v_lshlrev_b32 v10, 16, v137
  v_and_b32 v11, 0xffff0000, v137
  v_pk_add_f32 v[178:179], v[178:179], v[10:11]
  v_lshlrev_b32 v12, 16, v138
  v_and_b32 v13, 0xffff0000, v138
  v_pk_add_f32 v[180:181], v[180:181], v[12:13]
  v_lshlrev_b32 v14, 16, v139
  v_and_b32 v15, 0xffff0000, v139
  v_pk_add_f32 v[182:183], v[182:183], v[14:15]
  v_lshlrev_b32 v8, 16, v140
  v_and_b32 v9, 0xffff0000, v140
  v_pk_add_f32 v[184:185], v[184:185], v[8:9]
  v_lshlrev_b32 v10, 16, v141
  v_and_b32 v11, 0xffff0000, v141
  v_pk_add_f32 v[186:187], v[186:187], v[10:11]
  v_lshlrev_b32 v12, 16, v142
  v_and_b32 v13, 0xffff0000, v142
  v_pk_add_f32 v[188:189], v[188:189], v[12:13]
  v_lshlrev_b32 v14, 16, v143
  v_and_b32 v15, 0xffff0000, v143
  v_pk_add_f32 v[190:191], v[190:191], v[14:15]
  s_waitcnt vmcnt(2)
  v_lshlrev_b32 v8, 16, v144
  v_and_b32 v9, 0xffff0000, v144
  v_pk_add_f32 v[176:177], v[176:177], v[8:9]
  v_lshlrev_b32 v10, 16, v145
  v_and_b32 v11, 0xffff0000, v145
  v_pk_add_f32 v[178:179], v[178:179], v[10:11]
  v_lshlrev_b32 v12, 16, v146
  v_and_b32 v13, 0xffff0000, v146
  v_pk_add_f32 v[180:181], v[180:181], v[12:13]
  v_lshlrev_b32 v14, 16, v147
  v_and_b32 v15, 0xffff0000, v147
  v_pk_add_f32 v[182:183], v[182:183], v[14:15]
  v_lshlrev_b32 v8, 16, v148
  v_and_b32 v9, 0xffff0000, v148
  v_pk_add_f32 v[184:185], v[184:185], v[8:9]
  v_lshlrev_b32 v10, 16, v149
  v_and_b32 v11, 0xffff0000, v149
  v_pk_add_f32 v[186:187], v[186:187], v[10:11]
  v_lshlrev_b32 v12, 16, v150
  v_and_b32 v13, 0xffff0000, v150
  v_pk_add_f32 v[188:189], v[188:189], v[12:13]
  v_lshlrev_b32 v14, 16, v151
  v_and_b32 v15, 0xffff0000, v151
  v_pk_add_f32 v[190:191], v[190:191], v[14:15]
  s_waitcnt vmcnt(0)
  v_lshlrev_b32 v8, 16, v152
  v_and_b32 v9, 0xffff0000, v152
  v_pk_add_f32 v[176:177], v[176:177], v[8:9]
  v_lshlrev_b32 v10, 16, v153
  v_and_b32 v11, 0xffff0000, v153
  v_pk_add_f32 v[178:179], v[178:179], v[10:11]
  v_lshlrev_b32 v12, 16, v154
  v_and_b32 v13, 0xffff0000, v154
  v_pk_add_f32 v[180:181], v[180:181], v[12:13]
  v_lshlrev_b32 v14, 16, v155
  v_and_b32 v15, 0xffff0000, v155
  v_pk_add_f32 v[182:183], v[182:183], v[14:15]
  v_lshlrev_b32 v8, 16, v156
  v_and_b32 v9, 0xffff0000, v156
  v_pk_add_f32 v[184:185], v[184:185], v[8:9]
  v_lshlrev_b32 v10, 16, v157
  v_and_b32 v11, 0xffff0000, v157
  v_pk_add_f32 v[186:187], v[186:187], v[10:11]
  v_lshlrev_b32 v12, 16, v158
  v_and_b32 v13, 0xffff0000, v158
  v_pk_add_f32 v[188:189], v[188:189], v[12:13]
  v_lshlrev_b32 v14, 16, v159
  v_and_b32 v15, 0xffff0000, v159
  v_pk_add_f32 v[190:191], v[190:191], v[14:15]
  v_pk_fma_f32 v[160:161], v[176:177], v[82:83], v[160:161] op_sel_hi:[1,0,1]
  v_cvt_pk_bf16_f32 v16, v160, v161
  v_pk_fma_f32 v[162:163], v[178:179], v[82:83], v[162:163] op_sel_hi:[1,0,1]
  v_cvt_pk_bf16_f32 v17, v162, v163
  v_pk_fma_f32 v[164:165], v[180:181], v[82:83], v[164:165] op_sel_hi:[1,0,1]
  v_cvt_pk_bf16_f32 v18, v164, v165
  v_pk_fma_f32 v[166:167], v[182:183], v[82:83], v[166:167] op_sel_hi:[1,0,1]
  v_cvt_pk_bf16_f32 v19, v166, v167
  v_pk_fma_f32 v[168:169], v[184:185], v[82:83], v[168:169] op_sel_hi:[1,0,1]
  v_cvt_pk_bf16_f32 v20, v168, v169
  v_pk_fma_f32 v[170:171], v[186:187], v[82:83], v[170:171] op_sel_hi:[1,0,1]
  v_cvt_pk_bf16_f32 v21, v170, v171
  v_pk_fma_f32 v[172:173], v[188:189], v[82:83], v[172:173] op_sel_hi:[1,0,1]
  v_cvt_pk_bf16_f32 v22, v172, v173
  v_pk_fma_f32 v[174:175], v[190:191], v[82:83], v[174:175] op_sel_hi:[1,0,1]
  v_cvt_pk_bf16_f32 v23, v174, v175
  s_lshl_b32 s26, s49, 2
  s_add_u32 s26, s26, s16
  s_lshl_b32 s26, s26, 6
  s_lshl_b32 s27, s48, 15
  s_add_u32 s26, s26, s27
  buffer_store_dwordx4 v[16:19], v6, s[32:35], s26 offen offset:0
  buffer_store_dwordx4 v[20:23], v6, s[32:35], s26 offen offset:32
  s_cmp_lt_u32 s50, 64
  s_mov_b32 s50, s51
  s_cbranch_scc1 M_fin
  s_branch M_done
M_follow:
  s_lshr_b32 s48, s64, 2
  s_and_b32 s49, s64, 1
  s_bfe_u32 s50, s64, 0x10001
  s_mov_b32 s51, 2
  s_mov_b32 s23, 32
  s_load_dwordx2 s[8:9], s[0:1], 40
  s_lshl_b32 s77, s64, 17
  v_lshlrev_b32 v4, 7, v0
  s_waitcnt lgkmcnt(0)
  s_and_b32 s9, s9, 0xffff
  s_mov_b32 s10, 4194304
  s_mov_b32 s11, 0x20000
  buffer_load_dword v250, v4, s[8:11], s77 offen
  s_add_u32 s77, s77, 32768
  buffer_load_dword v250, v4, s[8:11], s77 offen
  s_add_u32 s77, s77, 32768
  buffer_load_dword v250, v4, s[8:11], s77 offen
  s_add_u32 s77, s77, 32768
  buffer_load_dword v250, v4, s[8:11], s77 offen
  s_add_u32 s77, s77, 32768
  s_load_dwordx2 s[8:9], s[0:1], 88
  s_lshl_b32 s17, s48, 19
  s_lshl_b32 s26, s49, 2
  s_add_u32 s26, s26, s16
  s_lshl_b32 s27, s26, 7
  s_add_u32 s17, s17, s27
  s_mov_b32 s18, 1024
  s_lshl_b32 s21, s48, 6
  s_add_u32 s21, s21, s50
  s_lshl_b32 s21, s21, 3
  s_add_u32 s21, s21, s26
  s_lshl_b32 s21, s21, 12
  s_add_u32 s21, s21, 167772160
  s_lshl_b32 s22, s51, 15
  s_mov_b32 s24, 1.0
  s_waitcnt lgkmcnt(0)
  s_and_b32 s9, s9, 0xffff
  s_mov_b32 s10, 4194304
  s_mov_b32 s11, 0x20000
  s_mul_i32 s26, s16, 0
  v_add_u32 v8, 0, v2
  v_add_u32 v16, s26, v8
  v_add_u32 v9, 1024, v2
  v_add_u32 v17, s26, v9
  v_add_u32 v10, 2048, v2
  v_add_u32 v18, s26, v10
  v_add_u32 v11, 3072, v2
  v_add_u32 v19, s26, v11
  v_add_u32 v12, 4096, v2
  v_add_u32 v20, s26, v12
  v_add_u32 v13, 5120, v2
  v_add_u32 v21, s26, v13
  v_add_u32 v14, 6144, v2
  v_add_u32 v22, s26, v14
  v_add_u32 v15, 7168, v2
  v_add_u32 v23, s26, v15
  v_lshrrev_b32 v144, 3, v1
  v_mul_lo_u32 v144, v144, s18
  v_and_b32 v145, 7, v1
  v_lshl_add_u32 v144, v145, 4, v144
  s_lshl_b32 s28, s16, 15
  s_add_u32 s28, s28, 32768
  s_lshl_b32 s29, s18, 3
  s_add_u32 m0, s28, 0
  s_nop 0
  buffer_load_dwordx4 v144, s[8:11], s17 offen lds
  s_add_u32 s17, s17, s29
  s_add_u32 m0, s28, 1024
  s_nop 0
  buffer_load_dwordx4 v144, s[8:11], s17 offen lds
  s_add_u32 s17, s17, s29
  s_add_u32 m0, s28, 2048
  s_nop 0
  buffer_load_dwordx4 v144, s[8:11], s17 offen lds
  s_add_u32 s17, s17, s29
  s_add_u32 m0, s28, 3072
  s_nop 0
  buffer_load_dwordx4 v144, s[8:11], s17 offen lds
  s_add_u32 s17, s17, s29
  s_add_u32 m0, s28, 4096
  s_nop 0
  buffer_load_dwordx4 v144, s[8:11], s17 offen lds
  s_add_u32 s17, s17, s29
  s_add_u32 m0, s28, 5120
  s_nop 0
  buffer_load_dwordx4 v144, s[8:11], s17 offen lds
  s_add_u32 s17, s17, s29
  s_add_u32 m0, s28, 6144
  s_nop 0
  buffer_load_dwordx4 v144, s[8:11], s17 offen lds
  s_add_u32 s17, s17, s29
  s_add_u32 m0, s28, 7168
  s_nop 0
  buffer_load_dwordx4 v144, s[8:11], s17 offen lds
  s_add_u32 s17, s17, s29
  s_add_u32 m0, s28, 8192
  s_nop 0
  buffer_load_dwordx4 v144, s[8:11], s17 offen lds
  s_add_u32 s17, s17, s29
  s_add_u32 m0, s28, 9216
  s_nop 0
  buffer_load_dwordx4 v144, s[8:11], s17 offen lds
  s_add_u32 s17, s17, s29
  s_add_u32 m0, s28, 10240
  s_nop 0
  buffer_load_dwordx4 v144, s[8:11], s17 offen lds
  s_add_u32 s17, s17, s29
  s_add_u32 m0, s28, 11264
  s_nop 0
  buffer_load_dwordx4 v144, s[8:11], s17 offen lds
  s_add_u32 s17, s17, s29
  s_add_u32 m0, s28, 12288
  s_nop 0
  buffer_load_dwordx4 v144, s[8:11], s17 offen lds
  s_add_u32 s17, s17, s29
  s_add_u32 m0, s28, 13312
  s_nop 0
  buffer_load_dwordx4 v144, s[8:11], s17 offen lds
  s_add_u32 s17, s17, s29
  s_add_u32 m0, s28, 14336
  s_nop 0
  buffer_load_dwordx4 v144, s[8:11], s17 offen lds
  s_add_u32 s17, s17, s29
  s_add_u32 m0, s28, 15360
  s_nop 0
  buffer_load_dwordx4 v144, s[8:11], s17 offen lds
  s_add_u32 s17, s17, s29
  s_add_u32 m0, s28, 16384
  s_nop 0
  buffer_load_dwordx4 v144, s[8:11], s17 offen lds
  s_add_u32 s17, s17, s29
  s_add_u32 m0, s28, 17408
  s_nop 0
  buffer_load_dwordx4 v144, s[8:11], s17 offen lds
  s_add_u32 s17, s17, s29
  s_add_u32 m0, s28, 18432
  s_nop 0
  buffer_load_dwordx4 v144, s[8:11], s17 offen lds
  s_add_u32 s17, s17, s29
  s_add_u32 m0, s28, 19456
  s_nop 0
  buffer_load_dwordx4 v144, s[8:11], s17 offen lds
  s_add_u32 s17, s17, s29
  s_add_u32 m0, s28, 20480
  s_nop 0
  buffer_load_dwordx4 v144, s[8:11], s17 offen lds
  s_add_u32 s17, s17, s29
  s_add_u32 m0, s28, 21504
  s_nop 0
  buffer_load_dwordx4 v144, s[8:11], s17 offen lds
  s_add_u32 s17, s17, s29
  s_add_u32 m0, s28, 22528
  s_nop 0
  buffer_load_dwordx4 v144, s[8:11], s17 offen lds
  s_add_u32 s17, s17, s29
  s_add_u32 m0, s28, 23552
  s_nop 0
  buffer_load_dwordx4 v144, s[8:11], s17 offen lds
  s_add_u32 s17, s17, s29
  s_add_u32 m0, s28, 24576
  s_nop 0
  buffer_load_dwordx4 v144, s[8:11], s17 offen lds
  s_add_u32 s17, s17, s29
  s_add_u32 m0, s28, 25600
  s_nop 0
  buffer_load_dwordx4 v144, s[8:11], s17 offen lds
  s_add_u32 s17, s17, s29
  s_add_u32 m0, s28, 26624
  s_nop 0
  buffer_load_dwordx4 v144, s[8:11], s17 offen lds
  s_add_u32 s17, s17, s29
  s_add_u32 m0, s28, 27648
  s_nop 0
  buffer_load_dwordx4 v144, s[8:11], s17 offen lds
  s_add_u32 s17, s17, s29
  s_add_u32 m0, s28, 28672
  s_nop 0
  buffer_load_dwordx4 v144, s[8:11], s17 offen lds
  s_add_u32 s17, s17, s29
  s_add_u32 m0, s28, 29696
  s_nop 0
  buffer_load_dwordx4 v144, s[8:11], s17 offen lds
  s_add_u32 s17, s17, s29
  s_add_u32 m0, s28, 30720
  s_nop 0
  buffer_load_dwordx4 v144, s[8:11], s17 offen lds
  s_add_u32 s17, s17, s29
  s_add_u32 m0, s28, 31744
  s_nop 0
  buffer_load_dwordx4 v144, s[8:11], s17 offen lds
  s_add_u32 s17, s17, s29
  v_bfe_u32 v148, v1, 2, 2
  v_lshrrev_b32 v149, 5, v1
  v_lshl_add_u32 v148, v149, 2, v148
  v_lshlrev_b32 v148, 7, v148
  v_bfe_u32 v149, v1, 4, 1
  v_lshl_add_u32 v148, v149, 5, v148
  v_and_b32 v149, 1, v1
  v_lshl_add_u32 v148, v149, 4, v148
  v_bfe_u32 v149, v1, 1, 1
  v_lshl_add_u32 v148, v149, 3, v148
  v_add_u32 v146, s28, v148
  v_add_u32 v147, 1024, v146
  s_waitcnt vmcnt(28)
  ds_read_b64_tr_b16 a[0:1], v146 offset:0
  ds_read_b64_tr_b16 a[2:3], v147 offset:0
  ds_read_b64_tr_b16 a[4:5], v146 offset:64
  ds_read_b64_tr_b16 a[6:7], v147 offset:64
  ds_read_b64_tr_b16 a[8:9], v146 offset:2048
  ds_read_b64_tr_b16 a[10:11], v147 offset:2048
  ds_read_b64_tr_b16 a[12:13], v146 offset:2112
  ds_read_b64_tr_b16 a[14:15], v147 offset:2112
  s_waitcnt lgkmcnt(0)
  s_add_u32 m0, s28, 0
  s_nop 0
  buffer_load_dwordx4 v144, s[8:11], s17 offen lds
  s_add_u32 s17, s17, s29
  s_add_u32 m0, s28, 1024
  s_nop 0
  buffer_load_dwordx4 v144, s[8:11], s17 offen lds
  s_add_u32 s17, s17, s29
  s_add_u32 m0, s28, 2048
  s_nop 0
  buffer_load_dwordx4 v144, s[8:11], s17 offen lds
  s_add_u32 s17, s17, s29
  s_add_u32 m0, s28, 3072
  s_nop 0
  buffer_load_dwordx4 v144, s[8:11], s17 offen lds
  s_add_u32 s17, s17, s29
  s_waitcnt vmcnt(28)
  ds_read_b64_tr_b16 a[16:17], v146 offset:4096
  ds_read_b64_tr_b16 a[18:19], v147 offset:4096
  ds_read_b64_tr_b16 a[20:21], v146 offset:4160
  ds_read_b64_tr_b16 a[22:23], v147 offset:4160
  ds_read_b64_tr_b16 a[24:25], v146 offset:6144
  ds_read_b64_tr_b16 a[26:27], v147 offset:6144
  ds_read_b64_tr_b16 a[28:29], v146 offset:6208
  ds_read_b64_tr_b16 a[30:31], v147 offset:6208
  s_waitcnt lgkmcnt(0)
  s_add_u32 m0, s28, 4096
  s_nop 0
  buffer_load_dwordx4 v144, s[8:11], s17 offen lds
  s_add_u32 s17, s17, s29
  s_add_u32 m0, s28, 5120
  s_nop 0
  buffer_load_dwordx4 v144, s[8:11], s17 offen lds
  s_add_u32 s17, s17, s29
  s_add_u32 m0, s28, 6144
  s_nop 0
  buffer_load_dwordx4 v144, s[8:11], s17 offen lds
  s_add_u32 s17, s17, s29
  s_add_u32 m0, s28, 7168
  s_nop 0
  buffer_load_dwordx4 v144, s[8:11], s17 offen lds
  s_add_u32 s17, s17, s29
  s_waitcnt vmcnt(28)
  ds_read_b64_tr_b16 a[32:33], v146 offset:8192
  ds_read_b64_tr_b16 a[34:35], v147 offset:8192
  ds_read_b64_tr_b16 a[36:37], v146 offset:8256
  ds_read_b64_tr_b16 a[38:39], v147 offset:8256
  ds_read_b64_tr_b16 a[40:41], v146 offset:10240
  ds_read_b64_tr_b16 a[42:43], v147 offset:10240
  ds_read_b64_tr_b16 a[44:45], v146 offset:10304
  ds_read_b64_tr_b16 a[46:47], v147 offset:10304
  s_waitcnt lgkmcnt(0)
  s_add_u32 m0, s28, 8192
  s_nop 0
  buffer_load_dwordx4 v144, s[8:11], s17 offen lds
  s_add_u32 s17, s17, s29
  s_add_u32 m0, s28, 9216
  s_nop 0
  buffer_load_dwordx4 v144, s[8:11], s17 offen lds
  s_add_u32 s17, s17, s29
  s_add_u32 m0, s28, 10240
  s_nop 0
  buffer_load_dwordx4 v144, s[8:11], s17 offen lds
  s_add_u32 s17, s17, s29
  s_add_u32 m0, s28, 11264
  s_nop 0
  buffer_load_dwordx4 v144, s[8:11], s17 offen lds
  s_add_u32 s17, s17, s29
  s_waitcnt vmcnt(28)
  ds_read_b64_tr_b16 a[48:49], v146 offset:12288
  ds_read_b64_tr_b16 a[50:51], v147 offset:12288
  ds_read_b64_tr_b16 a[52:53], v146 offset:12352
  ds_read_b64_tr_b16 a[54:55], v147 offset:12352
  ds_read_b64_tr_b16 a[56:57], v146 offset:14336
  ds_read_b64_tr_b16 a[58:59], v147 offset:14336
  ds_read_b64_tr_b16 a[60:61], v146 offset:14400
  ds_read_b64_tr_b16 a[62:63], v147 offset:14400
  s_waitcnt lgkmcnt(0)
  s_add_u32 m0, s28, 12288
  s_nop 0
  buffer_load_dwordx4 v144, s[8:11], s17 offen lds
  s_add_u32 s17, s17, s29
  s_add_u32 m0, s28, 13312
  s_nop 0
  buffer_load_dwordx4 v144, s[8:11], s17 offen lds
  s_add_u32 s17, s17, s29
  s_add_u32 m0, s28, 14336
  s_nop 0
  buffer_load_dwordx4 v144, s[8:11], s17 offen lds
  s_add_u32 s17, s17, s29
  s_add_u32 m0, s28, 15360
  s_nop 0
  buffer_load_dwordx4 v144, s[8:11], s17 offen lds
  s_add_u32 s17, s17, s29
  s_waitcnt vmcnt(28)
  ds_read_b64_tr_b16 a[64:65], v146 offset:16384
  ds_read_b64_tr_b16 a[66:67], v147 offset:16384
  ds_read_b64_tr_b16 a[68:69], v146 offset:16448
  ds_read_b64_tr_b16 a[70:71], v147 offset:16448
  ds_read_b64_tr_b16 a[72:73], v146 offset:18432
  ds_read_b64_tr_b16 a[74:75], v147 offset:18432
  ds_read_b64_tr_b16 a[76:77], v146 offset:18496
  ds_read_b64_tr_b16 a[78:79], v147 offset:18496
  s_waitcnt lgkmcnt(0)
  s_add_u32 m0, s28, 16384
  s_nop 0
  buffer_load_dwordx4 v144, s[8:11], s17 offen lds
  s_add_u32 s17, s17, s29
  s_add_u32 m0, s28, 17408
  s_nop 0
  buffer_load_dwordx4 v144, s[8:11], s17 offen lds
  s_add_u32 s17, s17, s29
  s_add_u32 m0, s28, 18432
  s_nop 0
  buffer_load_dwordx4 v144, s[8:11], s17 offen lds
  s_add_u32 s17, s17, s29
  s_add_u32 m0, s28, 19456
  s_nop 0
  buffer_load_dwordx4 v144, s[8:11], s17 offen lds
  s_add_u32 s17, s17, s29
  s_waitcnt vmcnt(28)
  ds_read_b64_tr_b16 a[80:81], v146 offset:20480
  ds_read_b64_tr_b16 a[82:83], v147 offset:20480
  ds_read_b64_tr_b16 a[84:85], v146 offset:20544
  ds_read_b64_tr_b16 a[86:87], v147 offset:20544
  ds_read_b64_tr_b16 a[88:89], v146 offset:22528
  ds_read_b64_tr_b16 a[90:91], v147 offset:22528
  ds_read_b64_tr_b16 a[92:93], v146 offset:22592
  ds_read_b64_tr_b16 a[94:95], v147 offset:22592
  s_waitcnt lgkmcnt(0)
  s_add_u32 m0, s28, 20480
  s_nop 0
  buffer_load_dwordx4 v144, s[8:11], s17 offen lds
  s_add_u32 s17, s17, s29
  s_add_u32 m0, s28, 21504
  s_nop 0
  buffer_load_dwordx4 v144, s[8:11], s17 offen lds
  s_add_u32 s17, s17, s29
  s_add_u32 m0, s28, 22528
  s_nop 0
  buffer_load_dwordx4 v144, s[8:11], s17 offen lds
  s_add_u32 s17, s17, s29
  s_add_u32 m0, s28, 23552
  s_nop 0
  buffer_load_dwordx4 v144, s[8:11], s17 offen lds
  s_add_u32 s17, s17, s29
  s_waitcnt vmcnt(28)
  ds_read_b64_tr_b16 a[96:97], v146 offset:24576
  ds_read_b64_tr_b16 a[98:99], v147 offset:24576
  ds_read_b64_tr_b16 a[100:101], v146 offset:24640
  ds_read_b64_tr_b16 a[102:103], v147 offset:24640
  ds_read_b64_tr_b16 a[104:105], v146 offset:26624
  ds_read_b64_tr_b16 a[106:107], v147 offset:26624
  ds_read_b64_tr_b16 a[108:109], v146 offset:26688
  ds_read_b64_tr_b16 a[110:111], v147 offset:26688
  s_waitcnt lgkmcnt(0)
  s_add_u32 m0, s28, 24576
  s_nop 0
  buffer_load_dwordx4 v144, s[8:11], s17 offen lds
  s_add_u32 s17, s17, s29
  s_add_u32 m0, s28, 25600
  s_nop 0
  buffer_load_dwordx4 v144, s[8:11], s17 offen lds
  s_add_u32 s17, s17, s29
  s_add_u32 m0, s28, 26624
  s_nop 0
  buffer_load_dwordx4 v144, s[8:11], s17 offen lds
  s_add_u32 s17, s17, s29
  s_add_u32 m0, s28, 27648
  s_nop 0
  buffer_load_dwordx4 v144, s[8:11], s17 offen lds
  s_add_u32 s17, s17, s29
  s_waitcnt vmcnt(28)
  ds_read_b64_tr_b16 a[112:113], v146 offset:28672
  ds_read_b64_tr_b16 a[114:115], v147 offset:28672
  ds_read_b64_tr_b16 a[116:117], v146 offset:28736
  ds_read_b64_tr_b16 a[118:119], v147 offset:28736
  ds_read_b64_tr_b16 a[120:121], v146 offset:30720
  ds_read_b64_tr_b16 a[122:123], v147 offset:30720
  ds_read_b64_tr_b16 a[124:125], v146 offset:30784
  ds_read_b64_tr_b16 a[126:127], v147 offset:30784
  s_waitcnt lgkmcnt(0)
  s_add_u32 m0, s28, 28672
  s_nop 0
  buffer_load_dwordx4 v144, s[8:11], s17 offen lds
  s_add_u32 s17, s17, s29
  s_add_u32 m0, s28, 29696
  s_nop 0
  buffer_load_dwordx4 v144, s[8:11], s17 offen lds
  s_add_u32 s17, s17, s29
  s_add_u32 m0, s28, 30720
  s_nop 0
  buffer_load_dwordx4 v144, s[8:11], s17 offen lds
  s_add_u32 s17, s17, s29
  s_add_u32 m0, s28, 31744
  s_nop 0
  buffer_load_dwordx4 v144, s[8:11], s17 offen lds
  s_add_u32 s17, s17, s29
  s_waitcnt vmcnt(28)
  ds_read_b64_tr_b16 a[128:129], v146 offset:0
  ds_read_b64_tr_b16 a[130:131], v147 offset:0
  ds_read_b64_tr_b16 a[132:133], v146 offset:64
  ds_read_b64_tr_b16 a[134:135], v147 offset:64
  ds_read_b64_tr_b16 a[136:137], v146 offset:2048
  ds_read_b64_tr_b16 a[138:139], v147 offset:2048
  ds_read_b64_tr_b16 a[140:141], v146 offset:2112
  ds_read_b64_tr_b16 a[142:143], v147 offset:2112
  s_waitcnt lgkmcnt(0)
  s_waitcnt vmcnt(24)
  ds_read_b64_tr_b16 a[144:145], v146 offset:4096
  ds_read_b64_tr_b16 a[146:147], v147 offset:4096
  ds_read_b64_tr_b16 a[148:149], v146 offset:4160
  ds_read_b64_tr_b16 a[150:151], v147 offset:4160
  ds_read_b64_tr_b16 a[152:153], v146 offset:6144
  ds_read_b64_tr_b16 a[154:155], v147 offset:6144
  ds_read_b64_tr_b16 a[156:157], v146 offset:6208
  ds_read_b64_tr_b16 a[158:159], v147 offset:6208
  s_waitcnt lgkmcnt(0)
  s_waitcnt vmcnt(20)
  ds_read_b64_tr_b16 a[160:161], v146 offset:8192
  ds_read_b64_tr_b16 a[162:163], v147 offset:8192
  ds_read_b64_tr_b16 a[164:165], v146 offset:8256
  ds_read_b64_tr_b16 a[166:167], v147 offset:8256
  ds_read_b64_tr_b16 a[168:169], v146 offset:10240
  ds_read_b64_tr_b16 a[170:171], v147 offset:10240
  ds_read_b64_tr_b16 a[172:173], v146 offset:10304
  ds_read_b64_tr_b16 a[174:175], v147 offset:10304
  s_waitcnt lgkmcnt(0)
  s_waitcnt vmcnt(16)
  ds_read_b64_tr_b16 a[176:177], v146 offset:12288
  ds_read_b64_tr_b16 a[178:179], v147 offset:12288
  ds_read_b64_tr_b16 a[180:181], v146 offset:12352
  ds_read_b64_tr_b16 a[182:183], v147 offset:12352
  ds_read_b64_tr_b16 a[184:185], v146 offset:14336
  ds_read_b64_tr_b16 a[186:187], v147 offset:14336
  ds_read_b64_tr_b16 a[188:189], v146 offset:14400
  ds_read_b64_tr_b16 a[190:191], v147 offset:14400
  s_waitcnt lgkmcnt(0)
  s_waitcnt vmcnt(12)
  ds_read_b64_tr_b16 a[192:193], v146 offset:16384
  ds_read_b64_tr_b16 a[194:195], v147 offset:16384
  ds_read_b64_tr_b16 a[196:197], v146 offset:16448
  ds_read_b64_tr_b16 a[198:199], v147 offset:16448
  ds_read_b64_tr_b16 a[200:201], v146 offset:18432
  ds_read_b64_tr_b16 a[202:203], v147 offset:18432
  ds_read_b64_tr_b16 a[204:205], v146 offset:18496
  ds_read_b64_tr_b16 a[206:207], v147 offset:18496
  s_waitcnt lgkmcnt(0)
  s_waitcnt vmcnt(8)
  ds_read_b64_tr_b16 a[208:209], v146 offset:20480
  ds_read_b64_tr_b16 a[210:211], v147 offset:20480
  ds_read_b64_tr_b16 a[212:213], v146 offset:20544
  ds_read_b64_tr_b16 a[214:215], v147 offset:20544
  ds_read_b64_tr_b16 a[216:217], v146 offset:22528
  ds_read_b64_tr_b16 a[218:219], v147 offset:22528
  ds_read_b64_tr_b16 a[220:221], v146 offset:22592
  ds_read_b64_tr_b16 a[222:223], v147 offset:22592
  s_waitcnt lgkmcnt(0)
  s_waitcnt vmcnt(4)
  ds_read_b64_tr_b16 a[224:225], v146 offset:24576
  ds_read_b64_tr_b16 a[226:227], v147 offset:24576
  ds_read_b64_tr_b16 a[228:229], v146 offset:24640
  ds_read_b64_tr_b16 a[230:231], v147 offset:24640
  ds_read_b64_tr_b16 a[232:233], v146 offset:26624
  ds_read_b64_tr_b16 a[234:235], v147 offset:26624
  ds_read_b64_tr_b16 a[236:237], v146 offset:26688
  ds_read_b64_tr_b16 a[238:239], v147 offset:26688
  s_waitcnt lgkmcnt(0)
  s_waitcnt vmcnt(0)
  ds_read_b64_tr_b16 a[240:241], v146 offset:28672
  ds_read_b64_tr_b16 a[242:243], v147 offset:28672
  ds_read_b64_tr_b16 a[244:245], v146 offset:28736
  ds_read_b64_tr_b16 a[246:247], v147 offset:28736
  ds_read_b64_tr_b16 a[248:249], v146 offset:30720
  ds_read_b64_tr_b16 a[250:251], v147 offset:30720
  ds_read_b64_tr_b16 a[252:253], v146 offset:30784
  ds_read_b64_tr_b16 a[254:255], v147 offset:30784
  s_waitcnt lgkmcnt(0)
  s_lshl_b32 s26, s48, 2
  s_add_u32 s26, s26, s16
  s_lshl_b32 s27, s26, 6
  s_add_u32 s27, s27, s50
  s_lshl_b32 s19, s27, 13
  s_lshl_b32 s27, s50, 5
  s_add_u32 s27, s27, s26
  s_mul_i32 s27, s27, 4608
  s_add_u32 s20, s27, 134217728
  s_lshl_b32 s25, s16, 12
  s_add_u32 s25, s25, 65536
  s_lshl_b32 s26, s16, 13
  v_add_u32 v3, s26, v2
  v_lshrrev_b32 v16, 5, v1
  v_and_b32 v17, 31, v1
  v_mul_u32_u24 v18, 1152, v16
  v_lshl_add_u32 v5, v17, 3, v18
  v_bfe_u32 v18, v1, 2, 2
  v_lshl_add_u32 v18, v16, 2, v18
  v_and_b32 v19, 1, v1
  v_mul_u32_u24 v19, 1152, v19
  v_lshl_add_u32 v18, v18, 3, v19
  v_add_u32 v4, s25, v18
  v_lshlrev_b32 v16, 2, v16
  v_sub_u32 v17, v17, v16
  v_mov_b32 v18, 0xf149f2ca
  v_cmp_le_i32 vcc, 0, v17
  s_nop 1
  v_cndmask_b32 v240, v18, 0, vcc
  v_cmp_le_i32 vcc, 1, v17
  s_nop 1
  v_cndmask_b32 v241, v18, 0, vcc
  v_cmp_le_i32 vcc, 2, v17
  s_nop 1
  v_cndmask_b32 v242, v18, 0, vcc
  v_cmp_le_i32 vcc, 3, v17
  s_nop 1
  v_cndmask_b32 v243, v18, 0, vcc
  v_cmp_le_i32 vcc, 8, v17
  s_nop 1
  v_cndmask_b32 v244, v18, 0, vcc
  v_cmp_le_i32 vcc, 9, v17
  s_nop 1
  v_cndmask_b32 v245, v18, 0, vcc
  v_cmp_le_i32 vcc, 10, v17
  s_nop 1
  v_cndmask_b32 v246, v18, 0, vcc
  v_cmp_le_i32 vcc, 11, v17
  s_nop 1
  v_cndmask_b32 v247, v18, 0, vcc
  v_cmp_le_i32 vcc, 16, v17
  s_nop 1
  v_cndmask_b32 v248, v18, 0, vcc
  v_cmp_le_i32 vcc, 17, v17
  s_nop 1
  v_cndmask_b32 v249, v18, 0, vcc
  v_cmp_le_i32 vcc, 18, v17
  s_nop 1
  v_cndmask_b32 v250, v18, 0, vcc
  v_cmp_le_i32 vcc, 19, v17
  s_nop 1
  v_cndmask_b32 v251, v18, 0, vcc
  v_cmp_le_i32 vcc, 24, v17
  s_nop 1
  v_cndmask_b32 v252, v18, 0, vcc
  v_cmp_le_i32 vcc, 25, v17
  s_nop 1
  v_cndmask_b32 v253, v18, 0, vcc
  v_cmp_le_i32 vcc, 26, v17
  s_nop 1
  v_cndmask_b32 v254, v18, 0, vcc
  v_cmp_le_i32 vcc, 27, v17
  s_nop 1
  v_cndmask_b32 v255, v18, 0, vcc
  v_mov_b32 v21, v2
  s_barrier
  s_lshl_b32 s77, s48, 2
  s_add_u32 s77, s77, s16
  s_mul_i32 s78, s77, 896
  s_add_u32 s76, s78, 148898304
  s_mov_b32 s71, 0
  s_branch M_sg_55
M_sw_54:
  s_sleep 8
  s_add_u32 s71, s71, 1
  s_cmp_gt_u32 s71, 262144
  s_cbranch_scc1 M_exit
M_sg_55:
  s_mov_b32 s79, 0
  s_atomic_or s79, s[72:73], s76 glc
  s_waitcnt lgkmcnt(0)
  s_cmp_lt_u32 s79, 16
  s_cbranch_scc1 M_sw_54
  s_add_u32 s76, s78, 148898048
  s_mov_b32 s71, 0
  s_branch M_sg_57
M_sw_56:
  s_sleep 8
  s_add_u32 s71, s71, 1
  s_cmp_gt_u32 s71, 262144
  s_cbranch_scc1 M_exit
M_sg_57:
  s_mov_b32 s79, 0
  s_atomic_or s79, s[72:73], s76 glc
  s_waitcnt lgkmcnt(0)
  s_cmp_lt_u32 s79, 16
  s_cbranch_scc1 M_sw_56
M_xok_53:
  s_lshl_b32 s77, s77, 7
  s_add_u32 s54, s77, 148926464
  s_add_u32 s52, s50, 1
  s_mov_b32 s53, 0
  s_mov_b32 s30, 0x200
  s_add_u32 s28, s19, 50331648
  buffer_load_dwordx4 v[144:147], v21, s[4:7], s28 offen offset:0 sc1
  buffer_load_dwordx4 v[148:151], v21, s[4:7], s28 offen offset:1024 sc1
  buffer_load_dwordx4 v[152:155], v21, s[4:7], s28 offen offset:2048 sc1
  buffer_load_dwordx4 v[156:159], v21, s[4:7], s28 offen offset:3072 sc1
  s_add_u32 s29, s19, 50335744
  buffer_load_dwordx4 v[160:163], v21, s[4:7], s29 offen offset:0 sc1
  buffer_load_dwordx4 v[164:167], v21, s[4:7], s29 offen offset:1024 sc1
  buffer_load_dwordx4 v[168:171], v21, s[4:7], s29 offen offset:2048 sc1
  buffer_load_dwordx4 v[172:175], v21, s[4:7], s29 offen offset:3072 sc1
  s_add_u32 s28, s19, 67108864
  buffer_load_dwordx4 v[176:179], v21, s[4:7], s28 offen offset:0 sc1
  buffer_load_dwordx4 v[180:183], v21, s[4:7], s28 offen offset:1024 sc1
  buffer_load_dwordx4 v[184:187], v21, s[4:7], s28 offen offset:2048 sc1
  buffer_load_dwordx4 v[188:191], v21, s[4:7], s28 offen offset:3072 sc1
  s_add_u32 s29, s19, 67112960
  buffer_load_dwordx4 v[192:195], v21, s[4:7], s29 offen offset:0 sc1
  buffer_load_dwordx4 v[196:199], v21, s[4:7], s29 offen offset:1024 sc1
  buffer_load_dwordx4 v[200:203], v21, s[4:7], s29 offen offset:2048 sc1
  buffer_load_dwordx4 v[204:207], v21, s[4:7], s29 offen offset:3072 sc1
  s_add_u32 s28, s19, 83886080
  buffer_load_dwordx4 v[208:211], v21, s[4:7], s28 offen offset:0 sc1
  buffer_load_dwordx4 v[212:215], v21, s[4:7], s28 offen offset:1024 sc1
  buffer_load_dwordx4 v[216:219], v21, s[4:7], s28 offen offset:2048 sc1
  buffer_load_dwordx4 v[220:223], v21, s[4:7], s28 offen offset:3072 sc1
  s_add_u32 s29, s19, 83890176
  buffer_load_dwordx4 v[224:227], v21, s[4:7], s29 offen offset:0 sc1
  buffer_load_dwordx4 v[228:231], v21, s[4:7], s29 offen offset:1024 sc1
  buffer_load_dwordx4 v[232:235], v21, s[4:7], s29 offen offset:2048 sc1
  buffer_load_dwordx4 v[236:239], v21, s[4:7], s29 offen offset:3072 sc1
  s_mov_b32 s24, 0
  v_mov_b32 v22, 0x40000000
  s_sub_u32 s21, s21, s22
F_top_58:
  s_waitcnt vmcnt(8)
  v_mfma_f32_32x32x16_bf16 v[24:39], v[176:179], v[144:147], v[240:255]
  s_nop 1
  v_cvt_pk_bf16_f32 v128, v64, v65
  v_cvt_pk_bf16_f32 v129, v66, v67
  v_cvt_pk_bf16_f32 v130, v68, v69
  v_cvt_pk_bf16_f32 v131, v70, v71
  v_mfma_f32_32x32x16_bf16 v[24:39], v[180:183], v[148:151], v[24:39]
  buffer_store_dwordx4 v[128:131], v22, s[4:7], s21 offen offset:0 sc1
  v_mfma_f32_32x32x16_bf16 v[24:39], v[184:187], v[152:155], v[24:39]
  v_cvt_pk_bf16_f32 v132, v72, v73
  v_cvt_pk_bf16_f32 v133, v74, v75
  v_cvt_pk_bf16_f32 v134, v76, v77
  v_cvt_pk_bf16_f32 v135, v78, v79
  v_mfma_f32_32x32x16_bf16 v[24:39], v[188:191], v[156:159], v[24:39]
  buffer_store_dwordx4 v[132:135], v22, s[4:7], s21 offen offset:1024 sc1
  v_mfma_f32_32x32x16_bf16 v[24:39], v[192:195], v[160:163], v[24:39]
  v_cvt_pk_bf16_f32 v136, v80, v81
  v_cvt_pk_bf16_f32 v137, v82, v83
  v_cvt_pk_bf16_f32 v138, v84, v85
  v_cvt_pk_bf16_f32 v139, v86, v87
  v_mfma_f32_32x32x16_bf16 v[24:39], v[196:199], v[164:167], v[24:39]
  buffer_store_dwordx4 v[136:139], v22, s[4:7], s21 offen offset:2048 sc1
  v_mfma_f32_32x32x16_bf16 v[24:39], v[200:203], v[168:171], v[24:39]
  v_cvt_pk_bf16_f32 v140, v88, v89
  v_cvt_pk_bf16_f32 v141, v90, v91
  v_cvt_pk_bf16_f32 v142, v92, v93
  v_cvt_pk_bf16_f32 v143, v94, v95
  v_mfma_f32_32x32x16_bf16 v[24:39], v[204:207], v[172:175], v[24:39]
  buffer_store_dwordx4 v[140:143], v22, s[4:7], s21 offen offset:3072 sc1
  s_add_u32 s21, s21, s22
  v_mov_b32 v22, v2
  s_cmp_lg_u32 s24, 0
  s_cbranch_scc1 F_have_59
  v_mov_b32 v16, s54
  v_mov_b32 v17, s52
  s_mov_b32 s71, 0
  s_branch M_vg_61
M_vw_60:
  s_sleep 2
  s_add_u32 s71, s71, 1
  s_cmp_gt_u32 s71, 262144
  s_cbranch_scc1 M_exit
M_vg_61:
  buffer_load_dword v23, v16, s[4:7], 0 offen sc1
  s_waitcnt vmcnt(0)
  v_cmp_lt_u32 vcc, v23, v17
  s_cbranch_vccnz M_vw_60
  s_mov_b32 m0, s25
  s_nop 0
  buffer_load_dwordx4 v2, s[4:7], s20 offen offset:0 sc1 lds
  buffer_load_dwordx4 v2, s[4:7], s20 offen offset:1152 sc1 lds
  buffer_load_dwordx2 v[56:57], v5, s[4:7], s20 offen offset:2304 sc1
  buffer_load_dwordx2 v[58:59], v5, s[4:7], s20 offen offset:2560 sc1
  buffer_load_dwordx2 v[60:61], v5, s[4:7], s20 offen offset:2816 sc1
  buffer_load_dwordx2 v[62:63], v5, s[4:7], s20 offen offset:3072 sc1
  s_waitcnt vmcnt(0)
F_have_59:
  ds_read_b64_tr_b16 v[176:177], v4 offset:0
  ds_read_b64_tr_b16 v[178:179], v4 offset:64
  ds_read_b64_tr_b16 v[180:181], v4 offset:128
  ds_read_b64_tr_b16 v[182:183], v4 offset:192
  ds_read_b64_tr_b16 v[184:185], v4 offset:256
  ds_read_b64_tr_b16 v[186:187], v4 offset:320
  ds_read_b64_tr_b16 v[188:189], v4 offset:384
  ds_read_b64_tr_b16 v[190:191], v4 offset:448
  ds_read_b64_tr_b16 v[192:193], v4 offset:512
  ds_read_b64_tr_b16 v[194:195], v4 offset:576
  ds_read_b64_tr_b16 v[196:197], v4 offset:640
  ds_read_b64_tr_b16 v[198:199], v4 offset:704
  s_sub_u32 s23, s23, 1
  s_cmp_gt_u32 s23, 0
  s_cselect_b32 s26, s51, 0
  s_cselect_b32 s27, 0, 0x40000000
  v_or_b32 v21, s27, v21
  s_lshl_b32 s27, s26, 13
  s_add_u32 s19, s19, s27
  s_mul_i32 s27, s26, 147456
  s_add_u32 s20, s20, s27
  s_cmp_lg_u32 s23, 24
  s_cbranch_scc1 M_xok_62
  s_lshl_b32 s77, s48, 2
  s_add_u32 s77, s77, s16
  s_mul_i32 s78, s77, 896
  s_add_u32 s76, s78, 148898304
  s_mov_b32 s71, 0
  s_branch M_sg_64
M_sw_63:
  s_sleep 8
  s_add_u32 s71, s71, 1
  s_cmp_gt_u32 s71, 262144
  s_cbranch_scc1 M_exit
M_sg_64:
  s_mov_b32 s79, 0
  s_atomic_or s79, s[72:73], s76 glc
  s_waitcnt lgkmcnt(0)
  s_cmp_lt_u32 s79, 32
  s_cbranch_scc1 M_sw_63
  s_add_u32 s76, s78, 148898432
  s_mov_b32 s71, 0
  s_branch M_sg_66
M_sw_65:
  s_sleep 8
  s_add_u32 s71, s71, 1
  s_cmp_gt_u32 s71, 262144
  s_cbranch_scc1 M_exit
M_sg_66:
  s_mov_b32 s79, 0
  s_atomic_or s79, s[72:73], s76 glc
  s_waitcnt lgkmcnt(0)
  s_cmp_lt_u32 s79, 32
  s_cbranch_scc1 M_sw_65
  s_add_u32 s76, s78, 148898048
  s_mov_b32 s71, 0
  s_branch M_sg_68
M_sw_67:
  s_sleep 8
  s_add_u32 s71, s71, 1
  s_cmp_gt_u32 s71, 262144
  s_cbranch_scc1 M_exit
M_sg_68:
  s_mov_b32 s79, 0
  s_atomic_or s79, s[72:73], s76 glc
  s_waitcnt lgkmcnt(0)
  s_cmp_lt_u32 s79, 30
  s_cbranch_scc1 M_sw_67
  s_add_u32 s76, s78, 148898176
  s_mov_b32 s71, 0
  s_branch M_sg_70
M_sw_69:
  s_sleep 8
  s_add_u32 s71, s71, 1
  s_cmp_gt_u32 s71, 262144
  s_cbranch_scc1 M_exit
M_sg_70:
  s_mov_b32 s79, 0
  s_atomic_or s79, s[72:73], s76 glc
  s_waitcnt lgkmcnt(0)
  s_cmp_lt_u32 s79, 34
  s_cbranch_scc1 M_sw_69
M_xok_62:
  s_waitcnt lgkmcnt(10)
  v_mfma_f32_32x32x16_bf16 v[40:55], v[176:179], v[144:147], 0
  ds_read_b64_tr_b16 v[200:201], v4 offset:768
  ds_read_b64_tr_b16 v[202:203], v4 offset:832
  v_max_f32 v6, v24, v25
  s_waitcnt lgkmcnt(10)
  v_mfma_f32_32x32x16_bf16 v[40:55], v[180:183], v[148:151], v[40:55]
  ds_read_b64_tr_b16 v[204:205], v4 offset:896
  ds_read_b64_tr_b16 v[206:207], v4 offset:960
  v_max3_f32 v6, v6, v26, v27
  s_waitcnt lgkmcnt(10)
  v_mfma_f32_32x32x16_bf16 v[40:55], v[184:187], v[152:155], v[40:55]
  v_max3_f32 v6, v6, v28, v29
  s_waitcnt lgkmcnt(8)
  v_mfma_f32_32x32x16_bf16 v[40:55], v[188:191], v[156:159], v[40:55]
  v_max3_f32 v6, v6, v30, v31
  s_waitcnt lgkmcnt(6)
  v_mfma_f32_32x32x16_bf16 v[40:55], v[192:195], v[160:163], v[40:55]
  v_max3_f32 v6, v6, v32, v33
  s_waitcnt lgkmcnt(4)
  v_mfma_f32_32x32x16_bf16 v[40:55], v[196:199], v[164:167], v[40:55]
  v_max3_f32 v6, v6, v34, v35
  s_waitcnt lgkmcnt(2)
  v_mfma_f32_32x32x16_bf16 v[40:55], v[200:203], v[168:171], v[40:55]
  v_max3_f32 v6, v6, v36, v37
  s_waitcnt lgkmcnt(0)
  v_mfma_f32_32x32x16_bf16 v[40:55], v[204:207], v[172:175], v[40:55]
  v_max3_f32 v6, v6, v38, v39
  s_add_u32 s28, s19, 50331648
  buffer_load_dwordx4 v[144:147], v21, s[4:7], s28 offen offset:0 sc1
  buffer_load_dwordx4 v[148:151], v21, s[4:7], s28 offen offset:1024 sc1
  s_nop 7
  v_max3_f32 v6, v6, v40, v41
  v_max3_f32 v6, v6, v42, v43
  v_mov_b32 v16, v6
  s_nop 1
  v_permlane32_swap_b32 v6, v16
  s_nop 1
  v_max_f32 v6, v6, v16
  v_pk_add_f32 v[24:25], v[24:25], v[6:7] op_sel_hi:[1,0] neg_lo:[0,1] neg_hi:[0,1]
  v_pk_add_f32 v[26:27], v[26:27], v[6:7] op_sel_hi:[1,0] neg_lo:[0,1] neg_hi:[0,1]
  v_pk_add_f32 v[28:29], v[28:29], v[6:7] op_sel_hi:[1,0] neg_lo:[0,1] neg_hi:[0,1]
  v_pk_add_f32 v[30:31], v[30:31], v[6:7] op_sel_hi:[1,0] neg_lo:[0,1] neg_hi:[0,1]
  v_pk_add_f32 v[32:33], v[32:33], v[6:7] op_sel_hi:[1,0] neg_lo:[0,1] neg_hi:[0,1]
  v_pk_add_f32 v[34:35], v[34:35], v[6:7] op_sel_hi:[1,0] neg_lo:[0,1] neg_hi:[0,1]
  v_pk_add_f32 v[36:37], v[36:37], v[6:7] op_sel_hi:[1,0] neg_lo:[0,1] neg_hi:[0,1]
  v_pk_add_f32 v[38:39], v[38:39], v[6:7] op_sel_hi:[1,0] neg_lo:[0,1] neg_hi:[0,1]
  v_pk_add_f32 v[40:41], v[40:41], v[6:7] op_sel_hi:[1,0] neg_lo:[0,1] neg_hi:[0,1]
  v_pk_add_f32 v[42:43], v[42:43], v[6:7] op_sel_hi:[1,0] neg_lo:[0,1] neg_hi:[0,1]
  v_exp_f32 v24, v24
  v_exp_f32 v25, v25
  v_exp_f32 v26, v26
  v_exp_f32 v27, v27
  v_exp_f32 v28, v28
  v_exp_f32 v29, v29
  v_exp_f32 v30, v30
  v_exp_f32 v31, v31
  v_exp_f32 v32, v32
  v_exp_f32 v33, v33
  buffer_load_dwordx4 v[152:155], v21, s[4:7], s28 offen offset:2048 sc1
  v_exp_f32 v34, v34
  v_exp_f32 v35, v35
  v_exp_f32 v36, v36
  v_exp_f32 v37, v37
  v_exp_f32 v38, v38
  v_exp_f32 v39, v39
  v_exp_f32 v40, v40
  v_exp_f32 v41, v41
  v_exp_f32 v42, v42
  v_exp_f32 v43, v43
  v_pk_add_f32 v[16:17], v[24:25], v[26:27]
  v_pk_add_f32 v[16:17], v[16:17], v[28:29]
  v_pk_add_f32 v[16:17], v[16:17], v[30:31]
  v_pk_add_f32 v[16:17], v[16:17], v[32:33]
  v_pk_add_f32 v[16:17], v[16:17], v[34:35]
  v_pk_add_f32 v[16:17], v[16:17], v[36:37]
  v_pk_add_f32 v[16:17], v[16:17], v[38:39]
  v_pk_add_f32 v[16:17], v[16:17], v[40:41]
  v_pk_add_f32 v[16:17], v[16:17], v[42:43]
  v_add_f32 v16, v16, v17
  v_mov_b32 v17, v16
  buffer_load_dwordx4 v[156:159], v21, s[4:7], s28 offen offset:3072 sc1
  s_nop 0
  v_permlane32_swap_b32 v16, v17
  s_nop 1
  v_add_f32 v16, v16, v17
  v_rcp_f32 v6, v16
  s_nop 0
  v_pk_mul_f32 v[24:25], v[24:25], v[6:7] op_sel_hi:[1,0]
  v_pk_mul_f32 v[26:27], v[26:27], v[6:7] op_sel_hi:[1,0]
  v_pk_mul_f32 v[28:29], v[28:29], v[6:7] op_sel_hi:[1,0]
  v_pk_mul_f32 v[30:31], v[30:31], v[6:7] op_sel_hi:[1,0]
  v_pk_mul_f32 v[32:33], v[32:33], v[6:7] op_sel_hi:[1,0]
  v_pk_mul_f32 v[34:35], v[34:35], v[6:7] op_sel_hi:[1,0]
  v_pk_mul_f32 v[36:37], v[36:37], v[6:7] op_sel_hi:[1,0]
  v_pk_mul_f32 v[38:39], v[38:39], v[6:7] op_sel_hi:[1,0]
  v_pk_mul_f32 v[40:41], v[40:41], v[6:7] op_sel_hi:[1,0]
  v_pk_mul_f32 v[42:43], v[42:43], v[6:7] op_sel_hi:[1,0]
  v_cvt_pk_bf16_f32 v128, v24, v25
  v_cvt_pk_bf16_f32 v129, v26, v27
  v_cvt_pk_bf16_f32 v130, v28, v29
  v_cvt_pk_bf16_f32 v131, v30, v31
  v_cvt_pk_bf16_f32 v132, v32, v33
  v_cvt_pk_bf16_f32 v133, v34, v35
  v_cvt_pk_bf16_f32 v134, v36, v37
  v_cvt_pk_bf16_f32 v135, v38, v39
  v_cvt_pk_bf16_f32 v136, v40, v41
  v_cvt_pk_bf16_f32 v137, v42, v43
  s_waitcnt vmcnt(8)
  v_mfma_f32_32x32x16_bf16 v[64:79], v[208:211], v[128:131], 0
  s_add_u32 s29, s19, 50335744
  buffer_load_dwordx4 v[160:163], v21, s[4:7], s29 offen offset:0 sc1
  v_mfma_f32_32x32x16_bf16 v[64:79], v[212:215], v[132:135], v[64:79]
  v_mfma_f32_32x32x8_bf16 v[64:79], v[56:57], v[136:137], v[64:79]
  v_mfma_f32_32x32x16_bf16 v[80:95], v[216:219], v[128:131], 0
  buffer_load_dwordx4 v[164:167], v21, s[4:7], s29 offen offset:1024 sc1
  v_mfma_f32_32x32x16_bf16 v[80:95], v[220:223], v[132:135], v[80:95]
  v_cvt_pk_bf16_f32 v24, v64, v65
  v_cvt_pk_bf16_f32 v25, v66, v67
  v_cvt_pk_bf16_f32 v26, v68, v69
  v_cvt_pk_bf16_f32 v27, v70, v71
  v_mfma_f32_32x32x8_bf16 v[80:95], v[58:59], v[136:137], v[80:95]
  ds_write_b128 v3, v[24:27] offset:0
  v_cvt_pk_bf16_f32 v28, v72, v73
  v_cvt_pk_bf16_f32 v29, v74, v75
  v_cvt_pk_bf16_f32 v30, v76, v77
  v_cvt_pk_bf16_f32 v31, v78, v79
  v_mfma_f32_32x32x16_bf16 v[96:111], v[224:227], v[128:131], 0
  ds_write_b128 v3, v[28:31] offset:1024
  buffer_load_dwordx4 v[168:171], v21, s[4:7], s29 offen offset:2048 sc1
  v_mfma_f32_32x32x16_bf16 v[96:111], v[228:231], v[132:135], v[96:111]
  v_cvt_pk_bf16_f32 v32, v80, v81
  v_cvt_pk_bf16_f32 v33, v82, v83
  v_cvt_pk_bf16_f32 v34, v84, v85
  v_cvt_pk_bf16_f32 v35, v86, v87
  v_mfma_f32_32x32x8_bf16 v[96:111], v[60:61], v[136:137], v[96:111]
  ds_write_b128 v3, v[32:35] offset:2048
  v_cvt_pk_bf16_f32 v36, v88, v89
  v_cvt_pk_bf16_f32 v37, v90, v91
  v_cvt_pk_bf16_f32 v38, v92, v93
  v_cvt_pk_bf16_f32 v39, v94, v95
  v_mfma_f32_32x32x16_bf16 v[112:127], v[232:235], v[128:131], 0
  ds_write_b128 v3, v[36:39] offset:3072
  buffer_load_dwordx4 v[172:175], v21, s[4:7], s29 offen offset:3072 sc1
  v_mfma_f32_32x32x16_bf16 v[112:127], v[236:239], v[132:135], v[112:127]
  v_cvt_pk_bf16_f32 v40, v96, v97
  v_cvt_pk_bf16_f32 v41, v98, v99
  v_cvt_pk_bf16_f32 v42, v100, v101
  v_cvt_pk_bf16_f32 v43, v102, v103
  v_mfma_f32_32x32x8_bf16 v[112:127], v[62:63], v[136:137], v[112:127]
  ds_write_b128 v3, v[40:43] offset:4096
  v_cvt_pk_bf16_f32 v44, v104, v105
  v_cvt_pk_bf16_f32 v45, v106, v107
  v_cvt_pk_bf16_f32 v46, v108, v109
  v_cvt_pk_bf16_f32 v47, v110, v111
  ds_write_b128 v3, v[44:47] offset:5120
  s_nop 5
  v_cvt_pk_bf16_f32 v48, v112, v113
  v_cvt_pk_bf16_f32 v49, v114, v115
  v_cvt_pk_bf16_f32 v50, v116, v117
  v_cvt_pk_bf16_f32 v51, v118, v119
  ds_write_b128 v3, v[48:51] offset:6144
  v_cvt_pk_bf16_f32 v52, v120, v121
  v_cvt_pk_bf16_f32 v53, v122, v123
  v_cvt_pk_bf16_f32 v54, v124, v125
  v_cvt_pk_bf16_f32 v55, v126, v127
  ds_write_b128 v3, v[52:55] offset:7168
  s_waitcnt vmcnt(8)
  s_waitcnt lgkmcnt(0)
  s_barrier
  ds_read_b128 v[24:27], v8 offset:0
  ds_read_b128 v[28:31], v9 offset:0
  ds_read_b128 v[32:35], v10 offset:0
  ds_read_b128 v[36:39], v11 offset:0
  ds_read_b128 v[40:43], v12 offset:0
  ds_read_b128 v[44:47], v13 offset:0
  v_readfirstlane_b32 s53, v23
  v_mov_b32 v16, s30
  v_min_u32 v17, 1, v0
  v_lshlrev_b32 v17, 30, v17
  buffer_store_dword v16, v17, s[4:7], s31 offen sc1
  s_add_u32 s30, s30, 1
  s_add_u32 s52, s52, 2
  s_cmp_ge_u32 s53, s52
  s_cselect_b32 s24, 1, 0
  buffer_load_dword v23, off, s[4:7], s54 sc1
  s_cmp_eq_u32 s24, 0
  s_cbranch_scc1 F_nopre_71
  s_mov_b32 m0, s25
  s_nop 0
  buffer_load_dwordx4 v2, s[4:7], s20 offen offset:0 sc1 lds
  buffer_load_dwordx4 v2, s[4:7], s20 offen offset:1152 sc1 lds
  buffer_load_dwordx2 v[56:57], v5, s[4:7], s20 offen offset:2304 sc1
  buffer_load_dwordx2 v[58:59], v5, s[4:7], s20 offen offset:2560 sc1
  buffer_load_dwordx2 v[60:61], v5, s[4:7], s20 offen offset:2816 sc1
  buffer_load_dwordx2 v[62:63], v5, s[4:7], s20 offen offset:3072 sc1
F_nopre_71:
  s_waitcnt lgkmcnt(5)
  v_mfma_f32_32x32x16_bf16 v[64:79], a[0:3], v[24:27], 0
  s_add_u32 s28, s19, 67108864
  ds_read_b128 v[48:51], v14 offset:0
  v_mfma_f32_32x32x16_bf16 v[80:95], a[4:7], v[24:27], 0
  s_waitcnt lgkmcnt(5)
  v_mfma_f32_32x32x16_bf16 v[64:79], a[8:11], v[28:31], v[64:79]
  ds_read_b128 v[52:55], v15 offset:0
  v_mfma_f32_32x32x16_bf16 v[80:95], a[12:15], v[28:31], v[80:95]
  s_waitcnt lgkmcnt(5)
  buffer_load_dwordx4 v[176:179], v21, s[4:7], s28 offen offset:0 sc1
  v_mfma_f32_32x32x16_bf16 v[64:79], a[16:19], v[32:35], v[64:79]
  ds_read_b128 v[24:27], v8 offset:8192
  v_mfma_f32_32x32x16_bf16 v[80:95], a[20:23], v[32:35], v[80:95]
  s_waitcnt lgkmcnt(5)
  v_mfma_f32_32x32x16_bf16 v[64:79], a[24:27], v[36:39], v[64:79]
  ds_read_b128 v[28:31], v9 offset:8192
  v_mfma_f32_32x32x16_bf16 v[80:95], a[28:31], v[36:39], v[80:95]
  s_waitcnt lgkmcnt(5)
  buffer_load_dwordx4 v[180:183], v21, s[4:7], s28 offen offset:1024 sc1
  v_mfma_f32_32x32x16_bf16 v[64:79], a[32:35], v[40:43], v[64:79]
  ds_read_b128 v[32:35], v10 offset:8192
  v_mfma_f32_32x32x16_bf16 v[80:95], a[36:39], v[40:43], v[80:95]
  s_waitcnt lgkmcnt(5)
  v_mfma_f32_32x32x16_bf16 v[64:79], a[40:43], v[44:47], v[64:79]
  ds_read_b128 v[36:39], v11 offset:8192
  v_mfma_f32_32x32x16_bf16 v[80:95], a[44:47], v[44:47], v[80:95]
  s_waitcnt lgkmcnt(5)
  buffer_load_dwordx4 v[184:187], v21, s[4:7], s28 offen offset:2048 sc1
  v_mfma_f32_32x32x16_bf16 v[64:79], a[48:51], v[48:51], v[64:79]
  ds_read_b128 v[40:43], v12 offset:8192
  v_mfma_f32_32x32x16_bf16 v[80:95], a[52:55], v[48:51], v[80:95]
  s_waitcnt lgkmcnt(5)
  v_mfma_f32_32x32x16_bf16 v[64:79], a[56:59], v[52:55], v[64:79]
  ds_read_b128 v[44:47], v13 offset:8192
  v_mfma_f32_32x32x16_bf16 v[80:95], a[60:63], v[52:55], v[80:95]
  s_waitcnt lgkmcnt(5)
  buffer_load_dwordx4 v[188:191], v21, s[4:7], s28 offen offset:3072 sc1
  v_mfma_f32_32x32x16_bf16 v[64:79], a[64:67], v[24:27], v[64:79]
  s_add_u32 s29, s19, 67112960
  ds_read_b128 v[48:51], v14 offset:8192
  v_mfma_f32_32x32x16_bf16 v[80:95], a[68:71], v[24:27], v[80:95]
  s_waitcnt lgkmcnt(5)
  v_mfma_f32_32x32x16_bf16 v[64:79], a[72:75], v[28:31], v[64:79]
  ds_read_b128 v[52:55], v15 offset:8192
  v_mfma_f32_32x32x16_bf16 v[80:95], a[76:79], v[28:31], v[80:95]
  s_waitcnt lgkmcnt(5)
  buffer_load_dwordx4 v[192:195], v21, s[4:7], s29 offen offset:0 sc1
  v_mfma_f32_32x32x16_bf16 v[64:79], a[80:83], v[32:35], v[64:79]
  ds_read_b128 v[24:27], v8 offset:16384
  v_mfma_f32_32x32x16_bf16 v[80:95], a[84:87], v[32:35], v[80:95]
  s_waitcnt lgkmcnt(5)
  v_mfma_f32_32x32x16_bf16 v[64:79], a[88:91], v[36:39], v[64:79]
  ds_read_b128 v[28:31], v9 offset:16384
  v_mfma_f32_32x32x16_bf16 v[80:95], a[92:95], v[36:39], v[80:95]
  s_waitcnt lgkmcnt(5)
  buffer_load_dwordx4 v[196:199], v21, s[4:7], s29 offen offset:1024 sc1
  v_mfma_f32_32x32x16_bf16 v[64:79], a[96:99], v[40:43], v[64:79]
  ds_read_b128 v[32:35], v10 offset:16384
  v_mfma_f32_32x32x16_bf16 v[80:95], a[100:103], v[40:43], v[80:95]
  s_waitcnt lgkmcnt(5)
  v_mfma_f32_32x32x16_bf16 v[64:79], a[104:107], v[44:47], v[64:79]
  ds_read_b128 v[36:39], v11 offset:16384
  v_mfma_f32_32x32x16_bf16 v[80:95], a[108:111], v[44:47], v[80:95]
  s_waitcnt lgkmcnt(5)
  buffer_load_dwordx4 v[200:203], v21, s[4:7], s29 offen offset:2048 sc1
  v_mfma_f32_32x32x16_bf16 v[64:79], a[112:115], v[48:51], v[64:79]
  ds_read_b128 v[40:43], v12 offset:16384
  v_mfma_f32_32x32x16_bf16 v[80:95], a[116:119], v[48:51], v[80:95]
  s_waitcnt lgkmcnt(5)
  v_mfma_f32_32x32x16_bf16 v[64:79], a[120:123], v[52:55], v[64:79]
  ds_read_b128 v[44:47], v13 offset:16384
  v_mfma_f32_32x32x16_bf16 v[80:95], a[124:127], v[52:55], v[80:95]
  s_waitcnt lgkmcnt(5)
  buffer_load_dwordx4 v[204:207], v21, s[4:7], s29 offen offset:3072 sc1
  v_mfma_f32_32x32x16_bf16 v[64:79], a[128:131], v[24:27], v[64:79]
  s_add_u32 s28, s19, 83886080
  ds_read_b128 v[48:51], v14 offset:16384
  v_mfma_f32_32x32x16_bf16 v[80:95], a[132:135], v[24:27], v[80:95]
  s_waitcnt lgkmcnt(5)
  v_mfma_f32_32x32x16_bf16 v[64:79], a[136:139], v[28:31], v[64:79]
  ds_read_b128 v[52:55], v15 offset:16384
  v_mfma_f32_32x32x16_bf16 v[80:95], a[140:143], v[28:31], v[80:95]
  s_waitcnt lgkmcnt(5)
  buffer_load_dwordx4 v[208:211], v21, s[4:7], s28 offen offset:0 sc1
  v_mfma_f32_32x32x16_bf16 v[64:79], a[144:147], v[32:35], v[64:79]
  ds_read_b128 v[24:27], v8 offset:24576
  v_mfma_f32_32x32x16_bf16 v[80:95], a[148:151], v[32:35], v[80:95]
  s_waitcnt lgkmcnt(5)
  v_mfma_f32_32x32x16_bf16 v[64:79], a[152:155], v[36:39], v[64:79]
  ds_read_b128 v[28:31], v9 offset:24576
  v_mfma_f32_32x32x16_bf16 v[80:95], a[156:159], v[36:39], v[80:95]
  s_waitcnt lgkmcnt(5)
  buffer_load_dwordx4 v[212:215], v21, s[4:7], s28 offen offset:1024 sc1
  v_mfma_f32_32x32x16_bf16 v[64:79], a[160:163], v[40:43], v[64:79]
  ds_read_b128 v[32:35], v10 offset:24576
  v_mfma_f32_32x32x16_bf16 v[80:95], a[164:167], v[40:43], v[80:95]
  s_waitcnt lgkmcnt(5)
  v_mfma_f32_32x32x16_bf16 v[64:79], a[168:171], v[44:47], v[64:79]
  ds_read_b128 v[36:39], v11 offset:24576
  v_mfma_f32_32x32x16_bf16 v[80:95], a[172:175], v[44:47], v[80:95]
  s_waitcnt lgkmcnt(5)
  buffer_load_dwordx4 v[216:219], v21, s[4:7], s28 offen offset:2048 sc1
  v_mfma_f32_32x32x16_bf16 v[64:79], a[176:179], v[48:51], v[64:79]
  ds_read_b128 v[40:43], v12 offset:24576
  v_mfma_f32_32x32x16_bf16 v[80:95], a[180:183], v[48:51], v[80:95]
  s_waitcnt lgkmcnt(5)
  v_mfma_f32_32x32x16_bf16 v[64:79], a[184:187], v[52:55], v[64:79]
  ds_read_b128 v[44:47], v13 offset:24576
  v_mfma_f32_32x32x16_bf16 v[80:95], a[188:191], v[52:55], v[80:95]
  s_waitcnt lgkmcnt(5)
  buffer_load_dwordx4 v[220:223], v21, s[4:7], s28 offen offset:3072 sc1
  v_mfma_f32_32x32x16_bf16 v[64:79], a[192:195], v[24:27], v[64:79]
  s_add_u32 s29, s19, 83890176
  ds_read_b128 v[48:51], v14 offset:24576
  v_mfma_f32_32x32x16_bf16 v[80:95], a[196:199], v[24:27], v[80:95]
  s_waitcnt lgkmcnt(5)
  v_mfma_f32_32x32x16_bf16 v[64:79], a[200:203], v[28:31], v[64:79]
  ds_read_b128 v[52:55], v15 offset:24576
  v_mfma_f32_32x32x16_bf16 v[80:95], a[204:207], v[28:31], v[80:95]
  s_waitcnt lgkmcnt(5)
  buffer_load_dwordx4 v[224:227], v21, s[4:7], s29 offen offset:0 sc1
  v_mfma_f32_32x32x16_bf16 v[64:79], a[208:211], v[32:35], v[64:79]
  v_mfma_f32_32x32x16_bf16 v[80:95], a[212:215], v[32:35], v[80:95]
  s_waitcnt lgkmcnt(4)
  v_mfma_f32_32x32x16_bf16 v[64:79], a[216:219], v[36:39], v[64:79]
  v_xor_b32 v8, 0x8000, v8
  v_mfma_f32_32x32x16_bf16 v[80:95], a[220:223], v[36:39], v[80:95]
  s_waitcnt lgkmcnt(3)
  buffer_load_dwordx4 v[228:231], v21, s[4:7], s29 offen offset:1024 sc1
  v_xor_b32 v9, 0x8000, v9
  v_mfma_f32_32x32x16_bf16 v[64:79], a[224:227], v[40:43], v[64:79]
  v_xor_b32 v10, 0x8000, v10
  v_mfma_f32_32x32x16_bf16 v[80:95], a[228:231], v[40:43], v[80:95]
  s_waitcnt lgkmcnt(2)
  v_xor_b32 v11, 0x8000, v11
  v_mfma_f32_32x32x16_bf16 v[64:79], a[232:235], v[44:47], v[64:79]
  v_xor_b32 v12, 0x8000, v12
  v_mfma_f32_32x32x16_bf16 v[80:95], a[236:239], v[44:47], v[80:95]
  s_waitcnt lgkmcnt(1)
  buffer_load_dwordx4 v[232:235], v21, s[4:7], s29 offen offset:2048 sc1
  v_xor_b32 v13, 0x8000, v13
  v_mfma_f32_32x32x16_bf16 v[64:79], a[240:243], v[48:51], v[64:79]
  v_xor_b32 v14, 0x8000, v14
  v_mfma_f32_32x32x16_bf16 v[80:95], a[244:247], v[48:51], v[80:95]
  s_waitcnt lgkmcnt(0)
  v_xor_b32 v15, 0x8000, v15
  v_mfma_f32_32x32x16_bf16 v[64:79], a[248:251], v[52:55], v[64:79]
  v_xor_b32 v3, 0x8000, v3
  v_mfma_f32_32x32x16_bf16 v[80:95], a[252:255], v[52:55], v[80:95]
  buffer_load_dwordx4 v[236:239], v21, s[4:7], s29 offen offset:3072 sc1
  s_cmp_gt_u32 s23, 0
  s_cbranch_scc1 F_top_58
  s_nop 2
  v_cvt_pk_bf16_f32 v128, v64, v65
  v_cvt_pk_bf16_f32 v129, v66, v67
  v_cvt_pk_bf16_f32 v130, v68, v69
  v_cvt_pk_bf16_f32 v131, v70, v71
  buffer_store_dwordx4 v[128:131], v22, s[4:7], s21 offen offset:0 sc1
  v_cvt_pk_bf16_f32 v132, v72, v73
  v_cvt_pk_bf16_f32 v133, v74, v75
  v_cvt_pk_bf16_f32 v134, v76, v77
  v_cvt_pk_bf16_f32 v135, v78, v79
  buffer_store_dwordx4 v[132:135], v22, s[4:7], s21 offen offset:1024 sc1
  v_cvt_pk_bf16_f32 v136, v80, v81
  v_cvt_pk_bf16_f32 v137, v82, v83
  v_cvt_pk_bf16_f32 v138, v84, v85
  v_cvt_pk_bf16_f32 v139, v86, v87
  buffer_store_dwordx4 v[136:139], v22, s[4:7], s21 offen offset:2048 sc1
  v_cvt_pk_bf16_f32 v140, v88, v89
  v_cvt_pk_bf16_f32 v141, v90, v91
  v_cvt_pk_bf16_f32 v142, v92, v93
  v_cvt_pk_bf16_f32 v143, v94, v95
  buffer_store_dwordx4 v[140:143], v22, s[4:7], s21 offen offset:3072 sc1
  s_waitcnt vmcnt(0) lgkmcnt(0)
  s_barrier
  v_mov_b32 v144, s30
  v_min_u32 v145, 1, v0
  v_lshlrev_b32 v145, 30, v145
  buffer_store_dword v144, v145, s[4:7], s31 offen sc1
  s_branch M_done
M_team:
  s_mov_b32 s12, s77
  s_load_dwordx4 s[60:63], s[0:1], 64
  s_load_dwordx4 s[64:67], s[0:1], 80
  s_load_dwordx4 s[68:71], s[0:1], 120
  s_load_dwordx2 s[72:73], s[0:1], 56
  v_lshrrev_b32 v1, 6, v0
  v_and_b32 v20, 63, v0
  v_readfirstlane_b32 s13, v1
  s_waitcnt lgkmcnt(0)
  s_mov_b32 s8, s60
  s_and_b32 s9, s61, 0xffff
  s_mov_b32 s10, 0x400000
  s_mov_b32 s11, 0x20000
  s_mov_b32 s40, s62
  s_and_b32 s41, s63, 0xffff
  s_mov_b32 s42, 0x400000
  s_mov_b32 s43, 0x20000
  s_mov_b32 s44, s64
  s_and_b32 s45, s65, 0xffff
  s_mov_b32 s46, 0x400000
  s_mov_b32 s47, 0x20000
  s_mov_b32 s48, s66
  s_and_b32 s49, s67, 0xffff
  s_mov_b32 s50, 0x400000
  s_mov_b32 s51, 0x20000
  s_mov_b32 s4, s70
  s_and_b32 s5, s71, 0xffff
  s_mov_b32 s6, 0x10000000
  s_mov_b32 s7, 0x20000
  s_mov_b32 s76, s72
  s_and_b32 s77, s73, 0xffff
  s_mov_b32 s78, 0x2000
  s_mov_b32 s79, 0x20000
  s_mov_b32 s72, s68
  s_and_b32 s73, s69, 0xffff
  s_mov_b32 s74, 0x100
  s_mov_b32 s75, 0x20000
  s_mov_b64 s[52:53], s[68:69]
  s_mov_b64 s[58:59], s[70:71]
  s_mul_i32 s99, s12, 896
  s_add_u32 s99, s99, 148898048
  s_lshl_b32 s15, s12, 7
  s_add_u32 s15, s15, 148926464
  v_lshrrev_b32 v21, 4, v20
  v_and_b32 v22, 15, v20
  v_and_b32 v23, 1, v21
  v_lshrrev_b32 v24, 1, v21
  v_lshlrev_b32 v2, 4, v20
  s_lshl_b32 s36, s13, 10
  v_add_u32 v59, s36, v2
  s_lshl_b32 s37, s13, 15
  s_add_u32 s37, s37, 32768
  v_add_u32 v4, s37, v2
  v_lshrrev_b32 v25, 2, v20
  v_lshlrev_b32 v25, 13, v25
  v_and_b32 v1, 3, v20
  v_lshl_add_u32 v25, v1, 4, v25
  s_lshl_b32 s36, s13, 6
  s_lshl_b32 s38, s12, 8
  s_add_u32 s36, s36, s38
  v_add_u32 v25, s36, v25
  v_lshrrev_b32 v26, 3, v20
  v_lshlrev_b32 v26, 10, v26
  v_and_b32 v1, 7, v20
  v_lshl_add_u32 v26, v1, 4, v26
  s_lshl_b32 s36, s13, 7
  s_lshl_b32 s38, s12, 17
  s_add_u32 s36, s36, s38
  v_add_u32 v26, s36, v26
  v_bfe_u32 v29, v20, 2, 1
  v_bfe_u32 v30, v20, 3, 1
  v_and_b32 v31, 3, v20
  v_lshl_add_u32 v27, v21, 2, v29
  v_lshlrev_b32 v27, 6, v27
  v_lshl_add_u32 v27, v30, 5, v27
  v_lshl_add_u32 v27, v31, 3, v27
  v_add_u32 v27, s37, v27
  v_xor_b32 v36, 1, v30
  v_lshl_add_u32 v36, v36, 11, v27
  v_lshl_add_u32 v27, v30, 11, v27
  v_lshl_add_u32 v28, v23, 2, v24
  v_lshl_add_u32 v28, v28, 2, v29
  v_lshlrev_b32 v28, 7, v28
  v_lshl_add_u32 v28, v30, 6, v28
  v_lshl_add_u32 v28, v31, 4, v28
  v_add_u32 v28, s37, v28
  s_mov_b32 s39, s37
  s_xor_b32 s36, s13, 0
  s_lshl_b32 s36, s36, 15
  s_add_u32 m0, s39, 0
  s_add_u32 s37, s36, 0
  buffer_load_dwordx4 v26, s[48:51], s37 offen lds
  s_add_u32 m0, s39, 1024
  s_add_u32 s37, s36, 8192
  buffer_load_dwordx4 v26, s[48:51], s37 offen lds
  s_add_u32 m0, s39, 2048
  s_add_u32 s37, s36, 16384
  buffer_load_dwordx4 v26, s[48:51], s37 offen lds
  s_add_u32 m0, s39, 3072
  s_add_u32 s37, s36, 24576
  buffer_load_dwordx4 v26, s[48:51], s37 offen lds
  s_xor_b32 s36, s13, 0
  s_lshl_b32 s36, s36, 15
  s_add_u32 m0, s39, 4096
  s_add_u32 s37, s36, 512
  buffer_load_dwordx4 v26, s[48:51], s37 offen lds
  s_add_u32 m0, s39, 5120
  s_add_u32 s37, s36, 8704
  buffer_load_dwordx4 v26, s[48:51], s37 offen lds
  s_add_u32 m0, s39, 6144
  s_add_u32 s37, s36, 16896
  buffer_load_dwordx4 v26, s[48:51], s37 offen lds
  s_add_u32 m0, s39, 7168
  s_add_u32 s37, s36, 25088
  buffer_load_dwordx4 v26, s[48:51], s37 offen lds
  v_mov_b32 v0, 0x4444
  v_mov_b32 v1, 0xeeee
  v_cmp_lt_u32 vcc, 7, v22
  s_nop 1
  v_cndmask_b32 v32, v0, v1, vcc
  v_mov_b32 v0, v32
  v_and_b32 v32, 7, v20
  v_lshlrev_b32 v32, 4, v32
  v_lshl_add_u32 v11, v21, 7, v32
  v_xor_b32 v1, 128, v2
  v_lshl_add_u32 v33, v24, 4, v22
  s_lshl_b32 s36, s13, 5
  v_add_u32 v33, s36, v33
  v_lshlrev_b32 v33, 3, v33
  v_mul_u32_u24 v34, 1152, v23
  v_add_u32 v5, v33, v34
  v_bfe_u32 v33, v20, 2, 2
  v_lshl_add_u32 v33, v23, 2, v33
  v_lshl_add_u32 v33, v24, 4, v33
  v_lshlrev_b32 v33, 3, v33
  v_and_b32 v34, 1, v20
  v_mul_u32_u24 v34, 1152, v34
  v_add_u32 v6, v33, v34
  s_lshl_b32 s36, s13, 3
  v_lshrrev_b32 v33, 3, v20
  v_add_u32 v33, s36, v33
  v_mul_u32_u24 v34, 0, v33
  v_add_u32 v34, s12, v34
  v_and_b32 v34, 31, v34
  v_lshrrev_b32 v37, 1, v32
  v_lshl_add_u32 v33, v33, 13, v37
  v_lshl_add_u32 v7, v34, 7, v33
  v_and_b32 v37, 1, v20
  v_bfe_u32 v38, v20, 1, 1
  v_lshl_add_u32 v37, v29, 1, v37
  s_lshr_b32 s36, s12, 3
  s_lshl_b32 s36, s36, 10
  s_and_b32 s37, s12, 1
  s_lshl_b32 s37, s37, 9
  s_add_u32 s36, s36, s37
  s_and_b32 s37, s12, 6
  s_lshl_b32 s37, s37, 5
  s_add_u32 s36, s36, s37
  v_lshlrev_b32 v33, 4, v21
  v_lshl_add_u32 v33, v37, 2, v33
  v_lshl_add_u32 v33, v38, 8, v33
  v_lshl_add_u32 v33, v30, 30, v33
  v_add_u32 v8, s36, v33
  s_lshr_b32 s36, s12, 2
  s_lshl_b32 s36, s36, 6
  s_and_b32 s37, s12, 1
  s_lshl_b32 s37, s37, 5
  s_add_u32 s36, s36, s37
  s_and_b32 s37, s12, 2
  s_lshl_b32 s37, s37, 11
  s_add_u32 s36, s36, s37
  v_lshlrev_b32 v35, 10, v21
  v_lshl_add_u32 v35, v37, 2, v35
  v_lshl_add_u32 v35, v38, 4, v35
  v_add_u32 v35, s36, v35
  buffer_load_ushort v44, v35, s[76:79], 0 offen offset:0
  buffer_load_ushort v45, v35, s[76:79], 0 offen offset:2
  buffer_load_ushort v46, v35, s[76:79], 0 offen offset:512
  buffer_load_ushort v47, v35, s[76:79], 0 offen offset:514
  v_lshlrev_b32 v33, 4, v29
  v_mov_b32 v34, 0x3f80
  v_lshlrev_b32 v33, v33, v34
  v_and_b32 v34, 1, v20
  v_lshl_add_u32 v34, v34, 1, v30
  v_cmp_eq_u32 vcc, 0, v34
  s_nop 1
  v_cndmask_b32 v48, 0, v33, vcc
  v_cmp_eq_u32 vcc, 1, v34
  s_nop 1
  v_cndmask_b32 v49, 0, v33, vcc
  v_cmp_eq_u32 vcc, 2, v34
  s_nop 1
  v_cndmask_b32 v50, 0, v33, vcc
  v_cmp_eq_u32 vcc, 3, v34
  s_nop 1
  v_cndmask_b32 v51, 0, v33, vcc
  ds_write_b128 v2, v[48:51] offset:31232
  v_lshlrev_b32 v33, 9, v21
  s_lshl_b32 s36, s13, 11
  v_add_u32 v33, s36, v33
  v_lshl_add_u32 v10, v22, 4, v33
  v_lshl_add_u32 v33, v30, 8, v33
  v_add_u32 v9, v33, v32
  v_mov_b32 v12, 0x3f803f80
  v_mov_b32 v13, 0x3f803f80
  v_mov_b32 v14, 0x3f803f80
  v_mov_b32 v15, 0x3f803f80
  v_and_b32 v33, 1, v20
  v_mul_u32_u24 v33, 128, v33
  v_min_u32 v34, 1, v20
  v_lshlrev_b32 v34, 30, v34
  s_cmp_eq_u32 s13, 3
  s_cselect_b64 vcc, -1, 0
  v_cndmask_b32 v3, v34, v33, vcc
  v_mov_b64 v[60:61], 0
  v_mov_b32 v62, 32256
  ds_write_b64 v62, v[60:61]
  s_mov_b32 s16, 0
  s_mov_b32 s17, -1
  s_mov_b32 s18, 0x3e0293ee
  s_mov_b32 s54, 0x2f800000
  s_mov_b32 s55, 0x28000000
  s_lshl_b32 s36, s13, 10
  s_add_u32 s31, s36, 8192
  s_add_u32 s32, s36, 12160
  s_add_u32 s33, s36, 16384
  s_add_u32 s34, s36, 20224
  s_lshl_b32 s36, s12, 19
  s_add_u32 s27, s36, 67108864
  s_add_u32 s28, s36, 83886080
  s_mul_i32 s36, s12, 4608
  s_add_u32 s29, s36, 134217728
  s_lshl_b32 s36, s12, 13
  s_add_u32 s22, s36, 144703488
  s_add_u32 s23, s36, 144707584
  s_mov_b32 s20, 144703488
  s_mov_b32 s21, 144707584
  v_mov_b32 v40, -1
  v_mov_b32 v41, -1
  v_mov_b32 v42, -1
  v_mov_b32 v43, -1
  s_lshl_b32 s36, s13, 13
  s_add_u32 s36, s36, 145752064
  s_add_u32 s37, s36, 4096
  buffer_store_dwordx4 v[40:43], v59, s[4:7], s22 offen sc1
  buffer_store_dwordx4 v[40:43], v59, s[4:7], s23 offen sc1
  buffer_store_dword v40, v8, s[4:7], s36 offen sc1
  buffer_store_dword v40, v8, s[4:7], s37 offen sc1
  v_mov_b32 v52, 0
  v_min_u32 v53, 1, v59
  v_lshlrev_b32 v53, 30, v53
  buffer_store_dword v52, v53, s[4:7], s15 offen sc1
  s_xor_b32 s36, s13, 1
  s_lshl_b32 s36, s36, 15
  s_add_u32 m0, s39, 8192
  s_add_u32 s37, s36, 0
  buffer_load_dwordx4 v26, s[48:51], s37 offen lds
  s_add_u32 m0, s39, 9216
  s_add_u32 s37, s36, 8192
  buffer_load_dwordx4 v26, s[48:51], s37 offen lds
  s_add_u32 m0, s39, 10240
  s_add_u32 s37, s36, 16384
  buffer_load_dwordx4 v26, s[48:51], s37 offen lds
  s_add_u32 m0, s39, 11264
  s_add_u32 s37, s36, 24576
  buffer_load_dwordx4 v26, s[48:51], s37 offen lds
  s_xor_b32 s36, s13, 1
  s_lshl_b32 s36, s36, 15
  s_add_u32 m0, s39, 12288
  s_add_u32 s37, s36, 512
  buffer_load_dwordx4 v26, s[48:51], s37 offen lds
  s_add_u32 m0, s39, 13312
  s_add_u32 s37, s36, 8704
  buffer_load_dwordx4 v26, s[48:51], s37 offen lds
  s_add_u32 m0, s39, 14336
  s_add_u32 s37, s36, 16896
  buffer_load_dwordx4 v26, s[48:51], s37 offen lds
  s_add_u32 m0, s39, 15360
  s_add_u32 s37, s36, 25088
  buffer_load_dwordx4 v26, s[48:51], s37 offen lds
  s_waitcnt vmcnt(21)
  ds_read_b64_tr_b16 a[160:161], v28 offset:0
  ds_read_b64_tr_b16 a[162:163], v28 offset:256
  ds_read_b64_tr_b16 a[164:165], v28 offset:1024
  ds_read_b64_tr_b16 a[166:167], v28 offset:1280
  ds_read_b64_tr_b16 a[168:169], v28 offset:8
  ds_read_b64_tr_b16 a[170:171], v28 offset:264
  ds_read_b64_tr_b16 a[172:173], v28 offset:1032
  ds_read_b64_tr_b16 a[174:175], v28 offset:1288
  s_waitcnt lgkmcnt(0)
  s_xor_b32 s36, s13, 2
  s_lshl_b32 s36, s36, 15
  s_add_u32 m0, s39, 0
  s_add_u32 s37, s36, 0
  buffer_load_dwordx4 v26, s[48:51], s37 offen lds
  s_add_u32 m0, s39, 1024
  s_add_u32 s37, s36, 8192
  buffer_load_dwordx4 v26, s[48:51], s37 offen lds
  s_add_u32 m0, s39, 2048
  s_add_u32 s37, s36, 16384
  buffer_load_dwordx4 v26, s[48:51], s37 offen lds
  s_add_u32 m0, s39, 3072
  s_add_u32 s37, s36, 24576
  buffer_load_dwordx4 v26, s[48:51], s37 offen lds
  s_waitcnt vmcnt(21)
  ds_read_b64_tr_b16 a[176:177], v28 offset:4096
  ds_read_b64_tr_b16 a[178:179], v28 offset:4352
  ds_read_b64_tr_b16 a[180:181], v28 offset:5120
  ds_read_b64_tr_b16 a[182:183], v28 offset:5376
  ds_read_b64_tr_b16 a[184:185], v28 offset:4104
  ds_read_b64_tr_b16 a[186:187], v28 offset:4360
  ds_read_b64_tr_b16 a[188:189], v28 offset:5128
  ds_read_b64_tr_b16 a[190:191], v28 offset:5384
  s_waitcnt lgkmcnt(0)
  s_xor_b32 s36, s13, 3
  s_lshl_b32 s36, s36, 15
  s_add_u32 m0, s39, 4096
  s_add_u32 s37, s36, 0
  buffer_load_dwordx4 v26, s[48:51], s37 offen lds
  s_add_u32 m0, s39, 5120
  s_add_u32 s37, s36, 8192
  buffer_load_dwordx4 v26, s[48:51], s37 offen lds
  s_add_u32 m0, s39, 6144
  s_add_u32 s37, s36, 16384
  buffer_load_dwordx4 v26, s[48:51], s37 offen lds
  s_add_u32 m0, s39, 7168
  s_add_u32 s37, s36, 24576
  buffer_load_dwordx4 v26, s[48:51], s37 offen lds
  s_waitcnt vmcnt(12)
  ds_read_b64_tr_b16 a[192:193], v28 offset:8192
  ds_read_b64_tr_b16 a[194:195], v28 offset:8448
  ds_read_b64_tr_b16 a[196:197], v28 offset:9216
  ds_read_b64_tr_b16 a[198:199], v28 offset:9472
  ds_read_b64_tr_b16 a[200:201], v28 offset:8200
  ds_read_b64_tr_b16 a[202:203], v28 offset:8456
  ds_read_b64_tr_b16 a[204:205], v28 offset:9224
  ds_read_b64_tr_b16 a[206:207], v28 offset:9480
  s_waitcnt lgkmcnt(0)
  s_xor_b32 s36, s13, 2
  s_lshl_b32 s36, s36, 19
  s_add_u32 m0, s39, 8192
  s_add_u32 s37, s36, 0
  buffer_load_dwordx4 v25, s[8:11], s37 offen lds
  s_add_u32 m0, s39, 9216
  s_add_u32 s37, s36, 131072
  buffer_load_dwordx4 v25, s[8:11], s37 offen lds
  s_add_u32 m0, s39, 10240
  s_add_u32 s37, s36, 262144
  buffer_load_dwordx4 v25, s[8:11], s37 offen lds
  s_add_u32 m0, s39, 11264
  s_add_u32 s37, s36, 393216
  buffer_load_dwordx4 v25, s[8:11], s37 offen lds
  s_barrier
  s_cmp_lg_u32 s13, 0
  s_cbranch_scc1 T_arm_72
  s_getreg_b32 s36, hwreg(HW_REG_XCC_ID, 0, 3)
  s_lshl_b32 s36, s36, 3
  s_lshl_b64 s[60:61], 1, s36
  s_mov_b32 s62, 1
  s_atomic_add_x2 s[60:61], s[52:53], 0
  s_atomic_add s62, s[52:53], 128
  v_lshl_or_b32 v44, v45, 16, v44
  v_lshl_or_b32 v46, v47, 16, v46
  v_min_u32 v44, -2, v44
  v_min_u32 v46, -2, v46
  s_mov_b32 s36, 145752064
  s_mov_b32 s37, 145756160
  buffer_store_dword v44, v8, s[4:7], s36 offen sc1
  buffer_store_dword v46, v8, s[4:7], s37 offen sc1
T_arm_72:
  s_waitcnt vmcnt(12)
  ds_read_b64_tr_b16 a[208:209], v28 offset:12288
  ds_read_b64_tr_b16 a[210:211], v28 offset:12544
  ds_read_b64_tr_b16 a[212:213], v28 offset:13312
  ds_read_b64_tr_b16 a[214:215], v28 offset:13568
  ds_read_b64_tr_b16 a[216:217], v28 offset:12296
  ds_read_b64_tr_b16 a[218:219], v28 offset:12552
  ds_read_b64_tr_b16 a[220:221], v28 offset:13320
  ds_read_b64_tr_b16 a[222:223], v28 offset:13576
  s_waitcnt lgkmcnt(0)
  s_xor_b32 s36, s13, 3
  s_lshl_b32 s36, s36, 19
  s_add_u32 m0, s39, 12288
  s_add_u32 s37, s36, 0
  buffer_load_dwordx4 v25, s[8:11], s37 offen lds
  s_add_u32 m0, s39, 13312
  s_add_u32 s37, s36, 131072
  buffer_load_dwordx4 v25, s[8:11], s37 offen lds
  s_add_u32 m0, s39, 14336
  s_add_u32 s37, s36, 262144
  buffer_load_dwordx4 v25, s[8:11], s37 offen lds
  s_add_u32 m0, s39, 15360
  s_add_u32 s37, s36, 393216
  buffer_load_dwordx4 v25, s[8:11], s37 offen lds
  s_waitcnt vmcnt(12)
  ds_read_b64_tr_b16 a[224:225], v28 offset:0
  ds_read_b64_tr_b16 a[226:227], v28 offset:256
  ds_read_b64_tr_b16 a[228:229], v28 offset:1024
  ds_read_b64_tr_b16 a[230:231], v28 offset:1280
  ds_read_b64_tr_b16 a[232:233], v28 offset:8
  ds_read_b64_tr_b16 a[234:235], v28 offset:264
  ds_read_b64_tr_b16 a[236:237], v28 offset:1032
  ds_read_b64_tr_b16 a[238:239], v28 offset:1288
  s_waitcnt lgkmcnt(0)
  s_xor_b32 s36, s13, 4
  s_lshl_b32 s36, s36, 19
  s_add_u32 m0, s39, 0
  s_add_u32 s37, s36, 0
  buffer_load_dwordx4 v25, s[8:11], s37 offen lds
  s_add_u32 m0, s39, 1024
  s_add_u32 s37, s36, 131072
  buffer_load_dwordx4 v25, s[8:11], s37 offen lds
  s_add_u32 m0, s39, 2048
  s_add_u32 s37, s36, 262144
  buffer_load_dwordx4 v25, s[8:11], s37 offen lds
  s_add_u32 m0, s39, 3072
  s_add_u32 s37, s36, 393216
  buffer_load_dwordx4 v25, s[8:11], s37 offen lds
  s_waitcnt vmcnt(12)
  ds_read_b64_tr_b16 a[240:241], v28 offset:4096
  ds_read_b64_tr_b16 a[242:243], v28 offset:4352
  ds_read_b64_tr_b16 a[244:245], v28 offset:5120
  ds_read_b64_tr_b16 a[246:247], v28 offset:5376
  ds_read_b64_tr_b16 a[248:249], v28 offset:4104
  ds_read_b64_tr_b16 a[250:251], v28 offset:4360
  ds_read_b64_tr_b16 a[252:253], v28 offset:5128
  ds_read_b64_tr_b16 a[254:255], v28 offset:5384
  s_waitcnt lgkmcnt(0)
  s_xor_b32 s36, s13, 5
  s_lshl_b32 s36, s36, 19
  s_add_u32 m0, s39, 4096
  s_add_u32 s37, s36, 0
  buffer_load_dwordx4 v25, s[8:11], s37 offen lds
  s_add_u32 m0, s39, 5120
  s_add_u32 s37, s36, 131072
  buffer_load_dwordx4 v25, s[8:11], s37 offen lds
  s_add_u32 m0, s39, 6144
  s_add_u32 s37, s36, 262144
  buffer_load_dwordx4 v25, s[8:11], s37 offen lds
  s_add_u32 m0, s39, 7168
  s_add_u32 s37, s36, 393216
  buffer_load_dwordx4 v25, s[8:11], s37 offen lds
  s_waitcnt vmcnt(12)
  ds_read_b64_tr_b16 v[160:161], v27 offset:8192
  ds_read_b64_tr_b16 v[162:163], v27 offset:8320
  ds_read_b64_tr_b16 v[164:165], v27 offset:9216
  ds_read_b64_tr_b16 v[166:167], v27 offset:9344
  ds_read_b64_tr_b16 v[168:169], v36 offset:8192
  ds_read_b64_tr_b16 v[170:171], v36 offset:8320
  ds_read_b64_tr_b16 v[172:173], v36 offset:9216
  ds_read_b64_tr_b16 v[174:175], v36 offset:9344
  s_waitcnt lgkmcnt(0)
  s_xor_b32 s36, s13, 4
  s_lshl_b32 s36, s36, 19
  s_add_u32 m0, s39, 8192
  s_add_u32 s37, s36, 0
  buffer_load_dwordx4 v25, s[40:43], s37 offen lds
  s_add_u32 m0, s39, 9216
  s_add_u32 s37, s36, 131072
  buffer_load_dwordx4 v25, s[40:43], s37 offen lds
  s_add_u32 m0, s39, 10240
  s_add_u32 s37, s36, 262144
  buffer_load_dwordx4 v25, s[40:43], s37 offen lds
  s_add_u32 m0, s39, 11264
  s_add_u32 s37, s36, 393216
  buffer_load_dwordx4 v25, s[40:43], s37 offen lds
  s_waitcnt vmcnt(12)
  ds_read_b64_tr_b16 v[192:193], v27 offset:12288
  ds_read_b64_tr_b16 v[194:195], v27 offset:12416
  ds_read_b64_tr_b16 v[196:197], v27 offset:13312
  ds_read_b64_tr_b16 v[198:199], v27 offset:13440
  ds_read_b64_tr_b16 v[200:201], v36 offset:12288
  ds_read_b64_tr_b16 v[202:203], v36 offset:12416
  ds_read_b64_tr_b16 v[204:205], v36 offset:13312
  ds_read_b64_tr_b16 v[206:207], v36 offset:13440
  s_waitcnt lgkmcnt(0)
  s_xor_b32 s36, s13, 5
  s_lshl_b32 s36, s36, 19
  s_add_u32 m0, s39, 12288
  s_add_u32 s37, s36, 0
  buffer_load_dwordx4 v25, s[40:43], s37 offen lds
  s_add_u32 m0, s39, 13312
  s_add_u32 s37, s36, 131072
  buffer_load_dwordx4 v25, s[40:43], s37 offen lds
  s_add_u32 m0, s39, 14336
  s_add_u32 s37, s36, 262144
  buffer_load_dwordx4 v25, s[40:43], s37 offen lds
  s_add_u32 m0, s39, 15360
  s_add_u32 s37, s36, 393216
  buffer_load_dwordx4 v25, s[40:43], s37 offen lds
  s_waitcnt vmcnt(12)
  ds_read_b64_tr_b16 v[224:225], v27 offset:0
  ds_read_b64_tr_b16 v[226:227], v27 offset:128
  ds_read_b64_tr_b16 v[228:229], v27 offset:1024
  ds_read_b64_tr_b16 v[230:231], v27 offset:1152
  ds_read_b64_tr_b16 v[232:233], v36 offset:0
  ds_read_b64_tr_b16 v[234:235], v36 offset:128
  ds_read_b64_tr_b16 v[236:237], v36 offset:1024
  ds_read_b64_tr_b16 v[238:239], v36 offset:1152
  s_waitcnt lgkmcnt(0)
  s_xor_b32 s36, s13, 4
  s_lshl_b32 s36, s36, 19
  s_add_u32 m0, s39, 0
  s_add_u32 s37, s36, 0
  buffer_load_dwordx4 v25, s[44:47], s37 offen lds
  s_add_u32 m0, s39, 1024
  s_add_u32 s37, s36, 131072
  buffer_load_dwordx4 v25, s[44:47], s37 offen lds
  s_add_u32 m0, s39, 2048
  s_add_u32 s37, s36, 262144
  buffer_load_dwordx4 v25, s[44:47], s37 offen lds
  s_add_u32 m0, s39, 3072
  s_add_u32 s37, s36, 393216
  buffer_load_dwordx4 v25, s[44:47], s37 offen lds
  s_waitcnt vmcnt(12)
  ds_read_b64_tr_b16 a[16:17], v27 offset:4096
  ds_read_b64_tr_b16 a[18:19], v27 offset:4224
  ds_read_b64_tr_b16 a[20:21], v27 offset:5120
  ds_read_b64_tr_b16 a[22:23], v27 offset:5248
  ds_read_b64_tr_b16 a[24:25], v36 offset:4096
  ds_read_b64_tr_b16 a[26:27], v36 offset:4224
  ds_read_b64_tr_b16 a[28:29], v36 offset:5120
  ds_read_b64_tr_b16 a[30:31], v36 offset:5248
  s_waitcnt lgkmcnt(0)
  s_xor_b32 s36, s13, 5
  s_lshl_b32 s36, s36, 19
  s_add_u32 m0, s39, 4096
  s_add_u32 s37, s36, 0
  buffer_load_dwordx4 v25, s[44:47], s37 offen lds
  s_add_u32 m0, s39, 5120
  s_add_u32 s37, s36, 131072
  buffer_load_dwordx4 v25, s[44:47], s37 offen lds
  s_add_u32 m0, s39, 6144
  s_add_u32 s37, s36, 262144
  buffer_load_dwordx4 v25, s[44:47], s37 offen lds
  s_add_u32 m0, s39, 7168
  s_add_u32 s37, s36, 393216
  buffer_load_dwordx4 v25, s[44:47], s37 offen lds
  s_waitcnt vmcnt(12)
  ds_read_b64_tr_b16 v[240:241], v27 offset:8192
  ds_read_b64_tr_b16 v[242:243], v27 offset:8320
  ds_read_b64_tr_b16 v[244:245], v27 offset:9216
  ds_read_b64_tr_b16 v[246:247], v27 offset:9344
  ds_read_b64_tr_b16 v[248:249], v36 offset:8192
  ds_read_b64_tr_b16 v[250:251], v36 offset:8320
  ds_read_b64_tr_b16 v[252:253], v36 offset:9216
  ds_read_b64_tr_b16 v[254:255], v36 offset:9344
  s_waitcnt lgkmcnt(0)
  s_xor_b32 s36, s13, 6
  s_lshl_b32 s36, s36, 19
  s_add_u32 m0, s39, 8192
  s_add_u32 s37, s36, 0
  buffer_load_dwordx4 v25, s[8:11], s37 offen lds
  s_add_u32 m0, s39, 9216
  s_add_u32 s37, s36, 131072
  buffer_load_dwordx4 v25, s[8:11], s37 offen lds
  s_add_u32 m0, s39, 10240
  s_add_u32 s37, s36, 262144
  buffer_load_dwordx4 v25, s[8:11], s37 offen lds
  s_add_u32 m0, s39, 11264
  s_add_u32 s37, s36, 393216
  buffer_load_dwordx4 v25, s[8:11], s37 offen lds
  s_waitcnt vmcnt(12)
  ds_read_b64_tr_b16 a[32:33], v27 offset:12288
  ds_read_b64_tr_b16 a[34:35], v27 offset:12416
  ds_read_b64_tr_b16 a[36:37], v27 offset:13312
  ds_read_b64_tr_b16 a[38:39], v27 offset:13440
  ds_read_b64_tr_b16 a[40:41], v36 offset:12288
  ds_read_b64_tr_b16 a[42:43], v36 offset:12416
  ds_read_b64_tr_b16 a[44:45], v36 offset:13312
  ds_read_b64_tr_b16 a[46:47], v36 offset:13440
  s_waitcnt lgkmcnt(0)
  s_xor_b32 s36, s13, 7
  s_lshl_b32 s36, s36, 19
  s_add_u32 m0, s39, 12288
  s_add_u32 s37, s36, 0
  buffer_load_dwordx4 v25, s[8:11], s37 offen lds
  s_add_u32 m0, s39, 13312
  s_add_u32 s37, s36, 131072
  buffer_load_dwordx4 v25, s[8:11], s37 offen lds
  s_add_u32 m0, s39, 14336
  s_add_u32 s37, s36, 262144
  buffer_load_dwordx4 v25, s[8:11], s37 offen lds
  s_add_u32 m0, s39, 15360
  s_add_u32 s37, s36, 393216
  buffer_load_dwordx4 v25, s[8:11], s37 offen lds
  s_waitcnt vmcnt(12)
  ds_read_b64_tr_b16 a[0:1], v27 offset:0
  ds_read_b64_tr_b16 a[2:3], v27 offset:128
  ds_read_b64_tr_b16 a[4:5], v27 offset:1024
  ds_read_b64_tr_b16 a[6:7], v27 offset:1152
  ds_read_b64_tr_b16 a[8:9], v36 offset:0
  ds_read_b64_tr_b16 a[10:11], v36 offset:128
  ds_read_b64_tr_b16 a[12:13], v36 offset:1024
  ds_read_b64_tr_b16 a[14:15], v36 offset:1152
  s_waitcnt lgkmcnt(0)
  s_xor_b32 s36, s13, 6
  s_lshl_b32 s36, s36, 19
  s_add_u32 m0, s39, 0
  s_add_u32 s37, s36, 0
  buffer_load_dwordx4 v25, s[40:43], s37 offen lds
  s_add_u32 m0, s39, 1024
  s_add_u32 s37, s36, 131072
  buffer_load_dwordx4 v25, s[40:43], s37 offen lds
  s_add_u32 m0, s39, 2048
  s_add_u32 s37, s36, 262144
  buffer_load_dwordx4 v25, s[40:43], s37 offen lds
  s_add_u32 m0, s39, 3072
  s_add_u32 s37, s36, 393216
  buffer_load_dwordx4 v25, s[40:43], s37 offen lds
  s_waitcnt vmcnt(12)
  ds_read_b64_tr_b16 a[48:49], v27 offset:4096
  ds_read_b64_tr_b16 a[50:51], v27 offset:4224
  ds_read_b64_tr_b16 a[52:53], v27 offset:5120
  ds_read_b64_tr_b16 a[54:55], v27 offset:5248
  ds_read_b64_tr_b16 a[56:57], v36 offset:4096
  ds_read_b64_tr_b16 a[58:59], v36 offset:4224
  ds_read_b64_tr_b16 a[60:61], v36 offset:5120
  ds_read_b64_tr_b16 a[62:63], v36 offset:5248
  s_waitcnt lgkmcnt(0)
  s_xor_b32 s36, s13, 7
  s_lshl_b32 s36, s36, 19
  s_add_u32 m0, s39, 4096
  s_add_u32 s37, s36, 0
  buffer_load_dwordx4 v25, s[40:43], s37 offen lds
  s_add_u32 m0, s39, 5120
  s_add_u32 s37, s36, 131072
  buffer_load_dwordx4 v25, s[40:43], s37 offen lds
  s_add_u32 m0, s39, 6144
  s_add_u32 s37, s36, 262144
  buffer_load_dwordx4 v25, s[40:43], s37 offen lds
  s_add_u32 m0, s39, 7168
  s_add_u32 s37, s36, 393216
  buffer_load_dwordx4 v25, s[40:43], s37 offen lds
  s_waitcnt vmcnt(12)
  ds_read_b64_tr_b16 a[64:65], v27 offset:8192
  ds_read_b64_tr_b16 a[66:67], v27 offset:8320
  ds_read_b64_tr_b16 a[68:69], v27 offset:9216
  ds_read_b64_tr_b16 a[70:71], v27 offset:9344
  ds_read_b64_tr_b16 a[72:73], v36 offset:8192
  ds_read_b64_tr_b16 a[74:75], v36 offset:8320
  ds_read_b64_tr_b16 a[76:77], v36 offset:9216
  ds_read_b64_tr_b16 a[78:79], v36 offset:9344
  s_waitcnt lgkmcnt(0)
  s_xor_b32 s36, s13, 6
  s_lshl_b32 s36, s36, 19
  s_add_u32 m0, s39, 8192
  s_add_u32 s37, s36, 0
  buffer_load_dwordx4 v25, s[44:47], s37 offen lds
  s_add_u32 m0, s39, 9216
  s_add_u32 s37, s36, 131072
  buffer_load_dwordx4 v25, s[44:47], s37 offen lds
  s_add_u32 m0, s39, 10240
  s_add_u32 s37, s36, 262144
  buffer_load_dwordx4 v25, s[44:47], s37 offen lds
  s_add_u32 m0, s39, 11264
  s_add_u32 s37, s36, 393216
  buffer_load_dwordx4 v25, s[44:47], s37 offen lds
  s_waitcnt vmcnt(12)
  ds_read_b64_tr_b16 a[112:113], v27 offset:12288
  ds_read_b64_tr_b16 a[114:115], v27 offset:12416
  ds_read_b64_tr_b16 a[116:117], v27 offset:13312
  ds_read_b64_tr_b16 a[118:119], v27 offset:13440
  ds_read_b64_tr_b16 a[120:121], v36 offset:12288
  ds_read_b64_tr_b16 a[122:123], v36 offset:12416
  ds_read_b64_tr_b16 a[124:125], v36 offset:13312
  ds_read_b64_tr_b16 a[126:127], v36 offset:13440
  s_waitcnt lgkmcnt(0)
  s_xor_b32 s36, s13, 7
  s_lshl_b32 s36, s36, 19
  s_add_u32 m0, s39, 12288
  s_add_u32 s37, s36, 0
  buffer_load_dwordx4 v25, s[44:47], s37 offen lds
  s_add_u32 m0, s39, 13312
  s_add_u32 s37, s36, 131072
  buffer_load_dwordx4 v25, s[44:47], s37 offen lds
  s_add_u32 m0, s39, 14336
  s_add_u32 s37, s36, 262144
  buffer_load_dwordx4 v25, s[44:47], s37 offen lds
  s_add_u32 m0, s39, 15360
  s_add_u32 s37, s36, 393216
  buffer_load_dwordx4 v25, s[44:47], s37 offen lds
  s_waitcnt vmcnt(12)
  ds_read_b64_tr_b16 a[80:81], v27 offset:0
  ds_read_b64_tr_b16 a[82:83], v27 offset:128
  ds_read_b64_tr_b16 a[84:85], v27 offset:1024
  ds_read_b64_tr_b16 a[86:87], v27 offset:1152
  ds_read_b64_tr_b16 a[88:89], v36 offset:0
  ds_read_b64_tr_b16 a[90:91], v36 offset:128
  ds_read_b64_tr_b16 a[92:93], v36 offset:1024
  ds_read_b64_tr_b16 a[94:95], v36 offset:1152
  s_waitcnt lgkmcnt(0)
  s_xor_b32 s36, s13, 1
  s_lshl_b32 s36, s36, 19
  s_add_u32 m0, s39, 16384
  s_add_u32 s37, s36, 0
  buffer_load_dwordx4 v25, s[8:11], s37 offen lds
  s_add_u32 m0, s39, 17408
  s_add_u32 s37, s36, 131072
  buffer_load_dwordx4 v25, s[8:11], s37 offen lds
  s_add_u32 m0, s39, 18432
  s_add_u32 s37, s36, 262144
  buffer_load_dwordx4 v25, s[8:11], s37 offen lds
  s_add_u32 m0, s39, 19456
  s_add_u32 s37, s36, 393216
  buffer_load_dwordx4 v25, s[8:11], s37 offen lds
  s_waitcnt vmcnt(12)
  ds_read_b64_tr_b16 a[128:129], v27 offset:4096
  ds_read_b64_tr_b16 a[130:131], v27 offset:4224
  ds_read_b64_tr_b16 a[132:133], v27 offset:5120
  ds_read_b64_tr_b16 a[134:135], v27 offset:5248
  ds_read_b64_tr_b16 a[136:137], v36 offset:4096
  ds_read_b64_tr_b16 a[138:139], v36 offset:4224
  ds_read_b64_tr_b16 a[140:141], v36 offset:5120
  ds_read_b64_tr_b16 a[142:143], v36 offset:5248
  s_waitcnt lgkmcnt(0)
  s_xor_b32 s36, s13, 0
  s_lshl_b32 s36, s36, 19
  s_add_u32 m0, s39, 0
  s_add_u32 s37, s36, 0
  buffer_load_dwordx4 v25, s[8:11], s37 offen lds
  s_add_u32 m0, s39, 1024
  s_add_u32 s37, s36, 131072
  buffer_load_dwordx4 v25, s[8:11], s37 offen lds
  s_add_u32 m0, s39, 2048
  s_add_u32 s37, s36, 262144
  buffer_load_dwordx4 v25, s[8:11], s37 offen lds
  s_add_u32 m0, s39, 3072
  s_add_u32 s37, s36, 393216
  buffer_load_dwordx4 v25, s[8:11], s37 offen lds
  s_waitcnt vmcnt(12)
  ds_read_b64_tr_b16 a[96:97], v27 offset:8192
  ds_read_b64_tr_b16 a[98:99], v27 offset:8320
  ds_read_b64_tr_b16 a[100:101], v27 offset:9216
  ds_read_b64_tr_b16 a[102:103], v27 offset:9344
  ds_read_b64_tr_b16 a[104:105], v36 offset:8192
  ds_read_b64_tr_b16 a[106:107], v36 offset:8320
  ds_read_b64_tr_b16 a[108:109], v36 offset:9216
  ds_read_b64_tr_b16 a[110:111], v36 offset:9344
  s_waitcnt lgkmcnt(0)
  s_xor_b32 s36, s13, 1
  s_lshl_b32 s36, s36, 19
  s_add_u32 m0, s39, 8192
  s_add_u32 s37, s36, 0
  buffer_load_dwordx4 v25, s[40:43], s37 offen lds
  s_add_u32 m0, s39, 9216
  s_add_u32 s37, s36, 131072
  buffer_load_dwordx4 v25, s[40:43], s37 offen lds
  s_add_u32 m0, s39, 10240
  s_add_u32 s37, s36, 262144
  buffer_load_dwordx4 v25, s[40:43], s37 offen lds
  s_add_u32 m0, s39, 11264
  s_add_u32 s37, s36, 393216
  buffer_load_dwordx4 v25, s[40:43], s37 offen lds
  s_waitcnt vmcnt(12)
  ds_read_b64_tr_b16 a[144:145], v27 offset:12288
  ds_read_b64_tr_b16 a[146:147], v27 offset:12416
  ds_read_b64_tr_b16 a[148:149], v27 offset:13312
  ds_read_b64_tr_b16 a[150:151], v27 offset:13440
  ds_read_b64_tr_b16 a[152:153], v36 offset:12288
  ds_read_b64_tr_b16 a[154:155], v36 offset:12416
  ds_read_b64_tr_b16 a[156:157], v36 offset:13312
  ds_read_b64_tr_b16 a[158:159], v36 offset:13440
  s_waitcnt lgkmcnt(0)
  s_xor_b32 s36, s13, 0
  s_lshl_b32 s36, s36, 19
  s_add_u32 m0, s39, 4096
  s_add_u32 s37, s36, 0
  buffer_load_dwordx4 v25, s[40:43], s37 offen lds
  s_add_u32 m0, s39, 5120
  s_add_u32 s37, s36, 131072
  buffer_load_dwordx4 v25, s[40:43], s37 offen lds
  s_add_u32 m0, s39, 6144
  s_add_u32 s37, s36, 262144
  buffer_load_dwordx4 v25, s[40:43], s37 offen lds
  s_add_u32 m0, s39, 7168
  s_add_u32 s37, s36, 393216
  buffer_load_dwordx4 v25, s[40:43], s37 offen lds
  s_waitcnt vmcnt(12)
  ds_read_b64_tr_b16 v[128:129], v27 offset:16384
  ds_read_b64_tr_b16 v[130:131], v27 offset:16512
  ds_read_b64_tr_b16 v[132:133], v27 offset:17408
  ds_read_b64_tr_b16 v[134:135], v27 offset:17536
  ds_read_b64_tr_b16 v[136:137], v36 offset:16384
  ds_read_b64_tr_b16 v[138:139], v36 offset:16512
  ds_read_b64_tr_b16 v[140:141], v36 offset:17408
  ds_read_b64_tr_b16 v[142:143], v36 offset:17536
  s_waitcnt lgkmcnt(0)
  s_xor_b32 s36, s13, 2
  s_lshl_b32 s36, s36, 19
  s_add_u32 m0, s39, 12288
  s_add_u32 s37, s36, 0
  buffer_load_dwordx4 v25, s[40:43], s37 offen lds
  s_add_u32 m0, s39, 13312
  s_add_u32 s37, s36, 131072
  buffer_load_dwordx4 v25, s[40:43], s37 offen lds
  s_add_u32 m0, s39, 14336
  s_add_u32 s37, s36, 262144
  buffer_load_dwordx4 v25, s[40:43], s37 offen lds
  s_add_u32 m0, s39, 15360
  s_add_u32 s37, s36, 393216
  buffer_load_dwordx4 v25, s[40:43], s37 offen lds
  s_waitcnt vmcnt(12)
  ds_read_b64_tr_b16 v[64:65], v27 offset:0
  ds_read_b64_tr_b16 v[66:67], v27 offset:128
  ds_read_b64_tr_b16 v[68:69], v27 offset:1024
  ds_read_b64_tr_b16 v[70:71], v27 offset:1152
  ds_read_b64_tr_b16 v[72:73], v36 offset:0
  ds_read_b64_tr_b16 v[74:75], v36 offset:128
  ds_read_b64_tr_b16 v[76:77], v36 offset:1024
  ds_read_b64_tr_b16 v[78:79], v36 offset:1152
  s_waitcnt lgkmcnt(0)
  ds_write_b128 v4, v[64:67] offset:0
  ds_write_b128 v4, v[68:71] offset:1024
  ds_write_b128 v4, v[72:75] offset:2048
  ds_write_b128 v4, v[76:79] offset:3072
  s_waitcnt lgkmcnt(0)
  s_xor_b32 s36, s13, 3
  s_lshl_b32 s36, s36, 19
  s_add_u32 m0, s39, 16384
  s_add_u32 s37, s36, 0
  buffer_load_dwordx4 v25, s[40:43], s37 offen lds
  s_add_u32 m0, s39, 17408
  s_add_u32 s37, s36, 131072
  buffer_load_dwordx4 v25, s[40:43], s37 offen lds
  s_add_u32 m0, s39, 18432
  s_add_u32 s37, s36, 262144
  buffer_load_dwordx4 v25, s[40:43], s37 offen lds
  s_add_u32 m0, s39, 19456
  s_add_u32 s37, s36, 393216
  buffer_load_dwordx4 v25, s[40:43], s37 offen lds
  s_waitcnt vmcnt(12)
  ds_read_b64_tr_b16 v[144:145], v27 offset:8192
  ds_read_b64_tr_b16 v[146:147], v27 offset:8320
  ds_read_b64_tr_b16 v[148:149], v27 offset:9216
  ds_read_b64_tr_b16 v[150:151], v27 offset:9344
  ds_read_b64_tr_b16 v[152:153], v36 offset:8192
  ds_read_b64_tr_b16 v[154:155], v36 offset:8320
  ds_read_b64_tr_b16 v[156:157], v36 offset:9216
  ds_read_b64_tr_b16 v[158:159], v36 offset:9344
  s_waitcnt lgkmcnt(0)
  s_xor_b32 s36, s13, 3
  s_lshl_b32 s36, s36, 19
  s_add_u32 m0, s39, 24576
  s_add_u32 s37, s36, 0
  buffer_load_dwordx4 v25, s[44:47], s37 offen lds
  s_add_u32 m0, s39, 25600
  s_add_u32 s37, s36, 131072
  buffer_load_dwordx4 v25, s[44:47], s37 offen lds
  s_add_u32 m0, s39, 26624
  s_add_u32 s37, s36, 262144
  buffer_load_dwordx4 v25, s[44:47], s37 offen lds
  s_add_u32 m0, s39, 27648
  s_add_u32 s37, s36, 393216
  buffer_load_dwordx4 v25, s[44:47], s37 offen lds
  buffer_load_dwordx2 v[54:55], off, s[72:75], 0 sc1
  buffer_load_dword v56, off, s[72:75], 0 offset:128 sc1
  s_waitcnt vmcnt(14)
  ds_read_b64_tr_b16 v[64:65], v27 offset:4096
  ds_read_b64_tr_b16 v[66:67], v27 offset:4224
  ds_read_b64_tr_b16 v[68:69], v27 offset:5120
  ds_read_b64_tr_b16 v[70:71], v27 offset:5248
  ds_read_b64_tr_b16 v[72:73], v36 offset:4096
  ds_read_b64_tr_b16 v[74:75], v36 offset:4224
  ds_read_b64_tr_b16 v[76:77], v36 offset:5120
  ds_read_b64_tr_b16 v[78:79], v36 offset:5248
  s_waitcnt lgkmcnt(0)
  ds_write_b128 v4, v[64:67] offset:4096
  ds_write_b128 v4, v[68:71] offset:5120
  ds_write_b128 v4, v[72:75] offset:6144
  ds_write_b128 v4, v[76:79] offset:7168
  s_waitcnt lgkmcnt(0)
  s_xor_b32 s36, s13, 2
  s_lshl_b32 s36, s36, 19
  s_add_u32 m0, s39, 20480
  s_add_u32 s37, s36, 0
  buffer_load_dwordx4 v25, s[44:47], s37 offen lds
  s_add_u32 m0, s39, 21504
  s_add_u32 s37, s36, 131072
  buffer_load_dwordx4 v25, s[44:47], s37 offen lds
  s_add_u32 m0, s39, 22528
  s_add_u32 s37, s36, 262144
  buffer_load_dwordx4 v25, s[44:47], s37 offen lds
  s_add_u32 m0, s39, 23552
  s_add_u32 s37, s36, 393216
  buffer_load_dwordx4 v25, s[44:47], s37 offen lds
  s_waitcnt vmcnt(14)
  ds_read_b64_tr_b16 v[176:177], v27 offset:12288
  ds_read_b64_tr_b16 v[178:179], v27 offset:12416
  ds_read_b64_tr_b16 v[180:181], v27 offset:13312
  ds_read_b64_tr_b16 v[182:183], v27 offset:13440
  ds_read_b64_tr_b16 v[184:185], v36 offset:12288
  ds_read_b64_tr_b16 v[186:187], v36 offset:12416
  ds_read_b64_tr_b16 v[188:189], v36 offset:13312
  ds_read_b64_tr_b16 v[190:191], v36 offset:13440
  s_waitcnt lgkmcnt(0)
  s_xor_b32 s36, s13, 0
  s_lshl_b32 s36, s36, 19
  s_add_u32 m0, s39, 8192
  s_add_u32 s37, s36, 0
  buffer_load_dwordx4 v25, s[44:47], s37 offen lds
  s_add_u32 m0, s39, 9216
  s_add_u32 s37, s36, 131072
  buffer_load_dwordx4 v25, s[44:47], s37 offen lds
  s_add_u32 m0, s39, 10240
  s_add_u32 s37, s36, 262144
  buffer_load_dwordx4 v25, s[44:47], s37 offen lds
  s_add_u32 m0, s39, 11264
  s_add_u32 s37, s36, 393216
  buffer_load_dwordx4 v25, s[44:47], s37 offen lds
  s_waitcnt vmcnt(14)
  ds_read_b64_tr_b16 v[64:65], v27 offset:16384
  ds_read_b64_tr_b16 v[66:67], v27 offset:16512
  ds_read_b64_tr_b16 v[68:69], v27 offset:17408
  ds_read_b64_tr_b16 v[70:71], v27 offset:17536
  ds_read_b64_tr_b16 v[72:73], v36 offset:16384
  ds_read_b64_tr_b16 v[74:75], v36 offset:16512
  ds_read_b64_tr_b16 v[76:77], v36 offset:17408
  ds_read_b64_tr_b16 v[78:79], v36 offset:17536
  s_waitcnt lgkmcnt(0)
  ds_write_b128 v4, v[64:67] offset:16384
  ds_write_b128 v4, v[68:71] offset:17408
  ds_write_b128 v4, v[72:75] offset:18432
  ds_write_b128 v4, v[76:79] offset:19456
  s_waitcnt lgkmcnt(0)
  s_xor_b32 s36, s13, 1
  s_lshl_b32 s36, s36, 19
  s_add_u32 m0, s39, 12288
  s_add_u32 s37, s36, 0
  buffer_load_dwordx4 v25, s[44:47], s37 offen lds
  s_add_u32 m0, s39, 13312
  s_add_u32 s37, s36, 131072
  buffer_load_dwordx4 v25, s[44:47], s37 offen lds
  s_add_u32 m0, s39, 14336
  s_add_u32 s37, s36, 262144
  buffer_load_dwordx4 v25, s[44:47], s37 offen lds
  s_add_u32 m0, s39, 15360
  s_add_u32 s37, s36, 393216
  buffer_load_dwordx4 v25, s[44:47], s37 offen lds
  s_waitcnt vmcnt(14)
  ds_read_b64_tr_b16 v[208:209], v27 offset:24576
  ds_read_b64_tr_b16 v[210:211], v27 offset:24704
  ds_read_b64_tr_b16 v[212:213], v27 offset:25600
  ds_read_b64_tr_b16 v[214:215], v27 offset:25728
  ds_read_b64_tr_b16 v[216:217], v36 offset:24576
  ds_read_b64_tr_b16 v[218:219], v36 offset:24704
  ds_read_b64_tr_b16 v[220:221], v36 offset:25600
  ds_read_b64_tr_b16 v[222:223], v36 offset:25728
  s_waitcnt lgkmcnt(0)
  s_xor_b32 s36, s13, 2
  s_lshl_b32 s36, s36, 15
  s_add_u32 m0, s39, 24576
  s_add_u32 s37, s36, 512
  buffer_load_dwordx4 v26, s[48:51], s37 offen lds
  s_add_u32 m0, s39, 25600
  s_add_u32 s37, s36, 8704
  buffer_load_dwordx4 v26, s[48:51], s37 offen lds
  s_add_u32 m0, s39, 26624
  s_add_u32 s37, s36, 16896
  buffer_load_dwordx4 v26, s[48:51], s37 offen lds
  s_add_u32 m0, s39, 27648
  s_add_u32 s37, s36, 25088
  buffer_load_dwordx4 v26, s[48:51], s37 offen lds
  s_waitcnt vmcnt(12)
  ds_read_b64_tr_b16 v[64:65], v27 offset:20480
  ds_read_b64_tr_b16 v[66:67], v27 offset:20608
  ds_read_b64_tr_b16 v[68:69], v27 offset:21504
  ds_read_b64_tr_b16 v[70:71], v27 offset:21632
  ds_read_b64_tr_b16 v[72:73], v36 offset:20480
  ds_read_b64_tr_b16 v[74:75], v36 offset:20608
  ds_read_b64_tr_b16 v[76:77], v36 offset:21504
  ds_read_b64_tr_b16 v[78:79], v36 offset:21632
  s_waitcnt lgkmcnt(0)
  ds_write_b128 v4, v[64:67] offset:20480
  ds_write_b128 v4, v[68:71] offset:21504
  ds_write_b128 v4, v[72:75] offset:22528
  ds_write_b128 v4, v[76:79] offset:23552
  s_waitcnt lgkmcnt(0)
  s_xor_b32 s36, s13, 3
  s_lshl_b32 s36, s36, 15
  s_add_u32 m0, s39, 28672
  s_add_u32 s37, s36, 512
  buffer_load_dwordx4 v26, s[48:51], s37 offen lds
  s_add_u32 m0, s39, 29696
  s_add_u32 s37, s36, 8704
  buffer_load_dwordx4 v26, s[48:51], s37 offen lds
  s_add_u32 m0, s39, 30720
  s_add_u32 s37, s36, 16896
  buffer_load_dwordx4 v26, s[48:51], s37 offen lds
  s_add_u32 m0, s39, 31744
  s_add_u32 s37, s36, 25088
  buffer_load_dwordx4 v26, s[48:51], s37 offen lds
  s_mov_b32 s19, 0
  s_branch T_arrgo_74
T_arr_73:
  s_add_u32 s19, s19, 1
  s_cmp_gt_u32 s19, 32768
  s_cbranch_scc1 M_exit
  buffer_load_dwordx2 v[54:55], off, s[72:75], 0 sc1
  buffer_load_dword v56, off, s[72:75], 0 offset:128 sc1
  s_waitcnt vmcnt(0)
T_arrgo_74:
  v_sad_u8 v57, v54, 0, 0
  v_sad_u8 v57, v55, 0, v57
  v_or_b32 v58, v54, v55
  v_cmp_gt_u32 vcc, 32, v57
  s_cbranch_vccnz T_arr_73
  v_cmp_gt_u32 vcc, 0x100, v56
  s_cbranch_vccnz T_arr_73
  v_readfirstlane_b32 s36, v58
  s_nop 0
  s_and_b32 s36, s36, 0x20202020
  s_cselect_b32 s56, 0, 1
  s_mov_b32 s14, -1
  s_mov_b32 s30, -1
  s_mov_b32 s19, 0
  s_branch T_kvok_76
T_kv_75:
  s_sleep 4
  s_add_u32 s19, s19, 1
  s_cmp_gt_u32 s19, 32768
  s_cbranch_scc1 M_exit
T_kvok_76:
  s_add_u32 s39, s99, 128
  s_mov_b32 s38, 0
  s_mov_b32 s37, 0
  s_atomic_or s38, s[58:59], s99 glc
  s_atomic_or s37, s[58:59], s39 glc
  s_waitcnt lgkmcnt(0)
  s_add_u32 s37, s37, 30
  s_cmp_ge_u32 s38, 30
  s_cselect_b32 s38, s37, s38
  s_cmp_ge_u32 s38, 64
  s_cselect_b32 s38, 100, s38
  s_sub_u32 s38, s38, 1
  s_max_i32 s30, s30, s38
  s_cmp_ge_i32 s14, s30
  s_cbranch_scc1 T_kv_75
  s_mov_b32 m0, s31
  s_nop 0
  buffer_load_dwordx4 v9, s[4:7], s27 offen sc1 lds
  s_mov_b32 m0, s32
  s_nop 0
  buffer_load_dwordx4 v9, s[4:7], s27 offen offset:128 sc1 lds
  s_mov_b32 m0, s33
  s_nop 0
  buffer_load_dwordx4 v10, s[4:7], s28 offen sc1 lds
  s_mov_b32 m0, s34
  s_nop 0
  buffer_load_dwordx4 v10, s[4:7], s28 offen offset:256 sc1 lds
  s_add_u32 s27, s27, 8192
  s_add_u32 s28, s28, 8192
  s_lshl_b32 s36, s12, 10
  s_add_u32 s36, s36, 145752064
  buffer_load_dwordx4 v[40:43], v2, s[4:7], s36 offen sc1
  s_waitcnt vmcnt(17)
  ds_read_b64_tr_b16 v[64:65], v27 offset:8192
  ds_read_b64_tr_b16 v[66:67], v27 offset:8320
  ds_read_b64_tr_b16 v[68:69], v27 offset:9216
  ds_read_b64_tr_b16 v[70:71], v27 offset:9344
  ds_read_b64_tr_b16 v[72:73], v36 offset:8192
  ds_read_b64_tr_b16 v[74:75], v36 offset:8320
  ds_read_b64_tr_b16 v[76:77], v36 offset:9216
  ds_read_b64_tr_b16 v[78:79], v36 offset:9344
  s_waitcnt lgkmcnt(0)
  ds_write_b128 v4, v[64:67] offset:8192
  ds_write_b128 v4, v[68:71] offset:9216
  ds_write_b128 v4, v[72:75] offset:10240
  ds_write_b128 v4, v[76:79] offset:11264
  s_waitcnt lgkmcnt(0)
  s_waitcnt vmcnt(13)
  ds_read_b64_tr_b16 v[64:65], v27 offset:12288
  ds_read_b64_tr_b16 v[66:67], v27 offset:12416
  ds_read_b64_tr_b16 v[68:69], v27 offset:13312
  ds_read_b64_tr_b16 v[70:71], v27 offset:13440
  ds_read_b64_tr_b16 v[72:73], v36 offset:12288
  ds_read_b64_tr_b16 v[74:75], v36 offset:12416
  ds_read_b64_tr_b16 v[76:77], v36 offset:13312
  ds_read_b64_tr_b16 v[78:79], v36 offset:13440
  s_waitcnt lgkmcnt(0)
  ds_write_b128 v4, v[64:67] offset:12288
  ds_write_b128 v4, v[68:71] offset:13312
  ds_write_b128 v4, v[72:75] offset:14336
  ds_write_b128 v4, v[76:79] offset:15360
  s_waitcnt lgkmcnt(0)
  s_waitcnt vmcnt(9)
  ds_read_b64_tr_b16 v[64:65], v28 offset:24576
  ds_read_b64_tr_b16 v[66:67], v28 offset:24832
  ds_read_b64_tr_b16 v[68:69], v28 offset:25600
  ds_read_b64_tr_b16 v[70:71], v28 offset:25856
  ds_read_b64_tr_b16 v[72:73], v28 offset:24584
  ds_read_b64_tr_b16 v[74:75], v28 offset:24840
  ds_read_b64_tr_b16 v[76:77], v28 offset:25608
  ds_read_b64_tr_b16 v[78:79], v28 offset:25864
  s_waitcnt lgkmcnt(0)
  ds_write_b128 v4, v[64:67] offset:24576
  ds_write_b128 v4, v[68:71] offset:25600
  ds_write_b128 v4, v[72:75] offset:26624
  ds_write_b128 v4, v[76:79] offset:27648
  s_waitcnt lgkmcnt(0)
  s_waitcnt vmcnt(5)
  ds_read_b64_tr_b16 v[64:65], v28 offset:28672
  ds_read_b64_tr_b16 v[66:67], v28 offset:28928
  ds_read_b64_tr_b16 v[68:69], v28 offset:29696
  ds_read_b64_tr_b16 v[70:71], v28 offset:29952
  ds_read_b64_tr_b16 v[72:73], v28 offset:28680
  ds_read_b64_tr_b16 v[74:75], v28 offset:28936
  ds_read_b64_tr_b16 v[76:77], v28 offset:29704
  ds_read_b64_tr_b16 v[78:79], v28 offset:29960
  s_waitcnt lgkmcnt(0)
  ds_write_b128 v4, v[64:67] offset:28672
  ds_write_b128 v4, v[68:71] offset:29696
  ds_write_b128 v4, v[72:75] offset:30720
  ds_write_b128 v4, v[76:79] offset:31744
  s_waitcnt lgkmcnt(0)
  s_waitcnt vmcnt(0) lgkmcnt(0)
  s_barrier
  ds_read_b128 v[68:71], v4 offset:0
  ds_read_b128 v[72:75], v4 offset:1024
  ds_read_b128 v[76:79], v4 offset:4096
  ds_read_b128 v[80:83], v4 offset:5120
  ds_read_b128 v[84:87], v4 offset:8192
  ds_read_b128 v[88:91], v4 offset:9216
  ds_read_b128 v[92:95], v4 offset:2048
  ds_read_b128 v[96:99], v4 offset:3072
  ds_read_b128 v[100:103], v4 offset:6144
  ds_read_b128 v[104:107], v4 offset:7168
  ds_read_b128 v[108:111], v4 offset:10240
  ds_read_b128 v[112:115], v4 offset:11264
  ds_read_b128 v[28:31], v59 offset:16384
  ds_read_b128 v[32:35], v59 offset:20480
  ds_read_b128 v[36:39], v2 offset:8192
  ds_read_b128 v[40:43], v2 offset:9216
  ds_read_b128 v[44:47], v2 offset:10240
  ds_read_b128 v[48:51], v2 offset:11264
  ds_read_b128 v[52:55], v2 offset:12288
  ds_read_b128 v[56:59], v2 offset:13312
  ds_read_b128 v[60:63], v2 offset:14336
  ds_read_b128 v[64:67], v2 offset:15360
  s_and_b32 s36, s13, 1
  s_lshl_b32 s36, s36, 12
  s_add_u32 s22, s22, s36
  s_add_u32 s23, s36, 145752064
  s_mov_b32 s14, -1
  s_and_b32 s57, s14, 1
  s_and_b32 s36, s14, 3
  s_lshl_b32 s36, s36, 13
  s_add_u32 s26, s36, s23
  s_add_u32 s36, s36, 8192
  s_and_b32 s36, s36, 0x7fff
  s_add_u32 s24, s36, 145752064
  s_add_u32 s25, s36, 145756160
  s_add_u32 s35, s36, s23
  s_waitcnt lgkmcnt(0)
  s_cmp_lg_u32 s56, 0
  s_cbranch_scc1 M_global
  s_cmp_eq_u32 s13, 1
  s_cbranch_scc1 T_w_78
  s_cmp_eq_u32 s13, 2
  s_cbranch_scc1 T_w_79
  s_cmp_eq_u32 s13, 3
  s_cbranch_scc1 T_w_80
T_w_77:
  s_mov_b32 s19, 0
  v_mov_b64 v[16:17], 0
  v_mov_b64 v[18:19], 0
  v_mov_b64 v[20:21], 0
  v_mov_b64 v[22:23], 0
  v_mov_b64 v[24:25], 0
  v_mov_b64 v[26:27], 0
  buffer_load_dwordx4 v[124:127], v2, s[4:7], s24 offen offset:0 sc1
  buffer_load_dwordx4 v[116:119], v2, s[4:7], s25 offen offset:0 sc1
  buffer_load_dwordx4 v[124:127], v2, s[4:7], s24 offen offset:0 sc1
  buffer_load_dwordx4 v[116:119], v2, s[4:7], s25 offen offset:0 sc1
  s_branch T_loop_81
.p2align 6
T_retry_82:
  s_mov_b64 exec, vcc
  buffer_load_dwordx4 v[124:127], v2, s[4:7], s24 offen offset:0 sc1
  buffer_load_dwordx4 v[116:119], v2, s[4:7], s25 offen offset:0 sc1
  s_mov_b64 exec, -1
  s_add_u32 s19, s19, 1
  s_cmp_gt_u32 s19, 32768
  s_cbranch_scc1 M_exit
T_loop_81:
  s_waitcnt vmcnt(3) lgkmcnt(0)
  v_max3_u32 v123, v124, v125, v126
  v_max_u32 v123, v123, v127
  v_mov_b32_dpp v120, v124 row_ror:8 row_mask:0xf bank_mask:0xf
  v_mov_b32_dpp v121, v125 row_ror:8 row_mask:0xf bank_mask:0xf
  s_waitcnt vmcnt(2)
  v_max3_u32 v123, v123, v116, v117
  v_max3_u32 v123, v123, v118, v119
  v_cmp_eq_u32 vcc, -1, v123
  s_cbranch_vccnz T_retry_82
  v_smfmac_f32_16x16x64_bf16 v[16:19], v[124:127], v[68:75], v0
  s_add_u32 s14, s14, 1
  ds_write_b128 v2, v[124:127] offset:0
  v_mov_b32_dpp v122, v126 row_ror:8 row_mask:0xf bank_mask:0xf
  v_smfmac_f32_16x16x64_bf16 v[20:23], v[124:127], v[76:83], v0
  s_and_b32 s57, s14, 1
  v_mov_b32_dpp v123, v127 row_ror:8 row_mask:0xf bank_mask:0xf
  v_smfmac_f32_16x16x64_bf16 v[24:27], v[124:127], v[84:91], v0
  s_and_b32 s36, s14, 3
  ds_write_b128 v2, v[116:119] offset:4096
  v_smfmac_f32_16x16x64_bf16 v[16:19], v[120:123], v[92:99], v0
  s_lshl_b32 s36, s36, 13
  v_mov_b32_dpp v84, v116 row_ror:8 row_mask:0xf bank_mask:0xf
  v_smfmac_f32_16x16x64_bf16 v[20:23], v[120:123], v[100:107], v0
  s_add_u32 s26, s36, s23
  ds_read_b128 v[68:71], v4 offset:12288
  v_mov_b32_dpp v85, v117 row_ror:8 row_mask:0xf bank_mask:0xf
  v_smfmac_f32_16x16x64_bf16 v[24:27], v[120:123], v[108:115], v0
  s_add_u32 s36, s36, 8192
  ds_read_b128 v[72:75], v4 offset:13312
  v_mov_b32_dpp v86, v118 row_ror:8 row_mask:0xf bank_mask:0xf
  v_smfmac_f32_16x16x64_bf16 v[16:19], v[116:119], v[224:231], v0
  s_and_b32 s36, s36, 0x7fff
  ds_read_b128 v[76:79], v4 offset:14336
  v_mov_b32_dpp v87, v119 row_ror:8 row_mask:0xf bank_mask:0xf
  v_smfmac_f32_16x16x64_bf16 v[20:23], v[116:119], v[240:247], v0
  s_waitcnt lgkmcnt(3)
  s_barrier
  ds_read_b128 v[100:103], v2 offset:1024
  v_smfmac_f32_16x16x64_bf16 v[24:27], v[116:119], a[0:7], v0
  s_mov_b32 m0, s31
  ds_read_b128 v[120:123], v1 offset:1024
  v_smfmac_f32_16x16x64_bf16 v[16:19], v[84:87], v[232:239], v0
  s_cmp_ge_i32 s14, s30
  s_cbranch_scc1 T_kvw_85
T_kvb_86:
  v_smfmac_f32_16x16x64_bf16 v[20:23], v[84:87], v[248:255], v0
  ds_read_b128 v[80:83], v4 offset:15360
  buffer_load_dwordx4 v9, s[4:7], s27 offen sc1 lds
  v_smfmac_f32_16x16x64_bf16 v[24:27], v[84:87], a[8:15], v0
  s_waitcnt lgkmcnt(2)
  s_mov_b32 m0, s32
  v_smfmac_f32_16x16x64_bf16 v[16:19], v[100:103], v[128:135], v0
  ds_read_b128 v[92:95], v2 offset:2048
  v_smfmac_f32_16x16x64_bf16 v[20:23], v[100:103], v[144:151], v0
  ds_read_b128 v[96:99], v1 offset:2048
  v_smfmac_f32_16x16x64_bf16 v[24:27], v[100:103], v[68:75], v0
  s_waitcnt vmcnt(1) lgkmcnt(3)
  ds_read_b128 v[116:119], v2 offset:3072
  buffer_load_dwordx4 v9, s[4:7], s27 offen offset:128 sc1 lds
  v_smfmac_f32_16x16x64_bf16 v[16:19], v[120:123], v[136:143], v0
  ds_read_b128 v[124:127], v1 offset:3072
  s_mov_b32 m0, s33
  v_smfmac_f32_16x16x64_bf16 v[20:23], v[120:123], v[152:159], v0
  s_waitcnt lgkmcnt(4)
  ds_read_b128 v[104:107], v2 offset:5120
  v_smfmac_f32_16x16x64_bf16 v[24:27], v[120:123], v[76:83], v0
  s_waitcnt lgkmcnt(4)
  ds_read_b128 v[108:111], v1 offset:5120
  v_smfmac_f32_16x16x64_bf16 v[16:19], v[92:95], v[160:167], v0
  s_waitcnt lgkmcnt(4)
  ds_read_b128 v[112:115], v2 offset:6144
  buffer_load_dwordx4 v10, s[4:7], s28 offen sc1 lds
  v_smfmac_f32_16x16x64_bf16 v[16:19], v[96:99], v[168:175], v0
  s_waitcnt lgkmcnt(4)
  ds_read_b128 v[84:87], v1 offset:6144
  s_mov_b32 m0, s34
  v_smfmac_f32_16x16x64_bf16 v[16:19], v[116:119], v[192:199], v0
  s_waitcnt lgkmcnt(4)
  ds_read_b128 v[88:91], v2 offset:7168
  v_smfmac_f32_16x16x64_bf16 v[16:19], v[124:127], v[200:207], v0
  s_waitcnt lgkmcnt(4)
  ds_read_b128 v[100:103], v1 offset:7168
  v_smfmac_f32_16x16x64_bf16 v[16:19], v[104:107], a[16:23], v0
  s_waitcnt lgkmcnt(4)
  ds_read_b128 v[68:71], v4 offset:16384
  buffer_load_dwordx4 v10, s[4:7], s28 offen offset:256 sc1 lds
  v_smfmac_f32_16x16x64_bf16 v[16:19], v[108:111], a[24:31], v0
  s_waitcnt lgkmcnt(4)
  ds_read_b128 v[72:75], v4 offset:17408
  v_smfmac_f32_16x16x64_bf16 v[16:19], v[112:115], a[64:71], v0
  s_waitcnt lgkmcnt(4)
  ds_read_b128 v[76:79], v4 offset:18432
  v_smfmac_f32_16x16x64_bf16 v[16:19], v[84:87], a[72:79], v0
  s_waitcnt lgkmcnt(4)
  ds_read_b128 v[80:83], v4 offset:19456
  v_smfmac_f32_16x16x64_bf16 v[16:19], v[88:91], a[112:119], v0
  s_waitcnt lgkmcnt(4)
  v_smfmac_f32_16x16x64_bf16 v[16:19], v[100:103], a[120:127], v0
  s_add_u32 s24, s36, 145752064
  s_add_u32 s25, s36, 145756160
  v_smfmac_f32_16x16x64_bf16 v[20:23], v[92:95], v[176:183], v0
  s_add_u32 s35, s36, s23
  v_smfmac_f32_16x16x64_bf16 v[20:23], v[96:99], v[184:191], v0
  s_waitcnt lgkmcnt(2)
  v_smfmac_f32_16x16x64_bf16 v[20:23], v[116:119], v[68:75], v0
  s_waitcnt lgkmcnt(0)
  ds_read_b128 v[68:71], v4 offset:20480
  v_mul_f32 v16, s18, v16
  v_smfmac_f32_16x16x64_bf16 v[20:23], v[124:127], v[76:83], v0
  ds_read_b128 v[72:75], v4 offset:21504
  v_mul_f32 v17, s18, v17
  v_smfmac_f32_16x16x64_bf16 v[20:23], v[104:107], a[32:39], v0
  ds_read_b128 v[76:79], v4 offset:22528
  v_mul_f32 v18, s18, v18
  v_smfmac_f32_16x16x64_bf16 v[20:23], v[108:111], a[40:47], v0
  ds_read_b128 v[80:83], v4 offset:23552
  v_mul_f32 v19, s18, v19
  v_smfmac_f32_16x16x64_bf16 v[20:23], v[112:115], a[80:87], v0
  v_cvt_pk_bf16_f32 v120, v16, v17
  v_smfmac_f32_16x16x64_bf16 v[20:23], v[84:87], a[88:95], v0
  v_cvt_pk_bf16_f32 v121, v18, v19
  v_smfmac_f32_16x16x64_bf16 v[20:23], v[88:91], a[128:135], v0
  ds_write_b64 v5, v[120:121] offset:24576
  v_smfmac_f32_16x16x64_bf16 v[20:23], v[100:103], a[136:143], v0
  s_waitcnt lgkmcnt(3)
  v_smfmac_f32_16x16x64_bf16 v[24:27], v[92:95], v[68:75], v0
  s_waitcnt lgkmcnt(1)
  v_mov_b64 v[92:93], 0
  v_smfmac_f32_16x16x64_bf16 v[24:27], v[96:99], v[76:83], v0
  s_nop 1
  v_cvt_pk_bf16_f32 v122, v20, v21
  v_cvt_pk_bf16_f32 v123, v22, v23
  v_smfmac_f32_16x16x64_bf16 v[24:27], v[116:119], v[208:215], v0
  ds_write_b64 v5, v[122:123] offset:26880
  v_mov_b64 v[94:95], 0
  v_smfmac_f32_16x16x64_bf16 v[24:27], v[124:127], v[216:223], v0
  s_waitcnt lgkmcnt(1)
  s_barrier
  ds_read_b64_tr_b16 v[68:69], v6 offset:24576
  v_smfmac_f32_16x16x64_bf16 v[24:27], v[104:107], a[48:55], v0
  s_add_u32 s27, s27, 8192
  ds_read_b64_tr_b16 v[70:71], v6 offset:24640
  ds_read_b64_tr_b16 v[72:73], v6 offset:24832
  v_smfmac_f32_16x16x64_bf16 v[24:27], v[108:111], a[56:63], v0
  s_add_u32 s28, s28, 8192
  ds_read_b64_tr_b16 v[74:75], v6 offset:24896
  ds_read_b64_tr_b16 v[76:77], v6 offset:25088
  v_smfmac_f32_16x16x64_bf16 v[24:27], v[112:115], a[96:103], v0
  s_nop 0
  ds_read_b64_tr_b16 v[78:79], v6 offset:25152
  ds_read_b64_tr_b16 v[80:81], v6 offset:25344
  v_smfmac_f32_16x16x64_bf16 v[24:27], v[84:87], a[104:111], v0
  ds_read_b64_tr_b16 v[82:83], v6 offset:25408
  v_mov_b64 v[96:97], 0
  v_smfmac_f32_16x16x64_bf16 v[24:27], v[88:91], a[144:151], v0
  s_waitcnt lgkmcnt(8)
  s_barrier
  ds_read_b64_tr_b16 v[116:117], v6 offset:26880
  v_smfmac_f32_16x16x64_bf16 v[24:27], v[100:103], a[152:159], v0
  s_waitcnt lgkmcnt(7)
  ds_read_b64_tr_b16 v[118:119], v6 offset:26944
  buffer_store_dwordx2 v[122:123], v5, s[4:7], s29 offen sc1
  v_mfma_f32_16x16x32_bf16 v[16:19], v[36:39], v[68:71], 0
  s_waitcnt lgkmcnt(6)
  ds_read_b64_tr_b16 v[124:125], v6 offset:27136
  ds_read_b64_tr_b16 v[126:127], v6 offset:27200
  v_mfma_f32_16x16x32_bf16 v[16:19], v[40:43], v[72:75], v[16:19]
  s_waitcnt lgkmcnt(6)
  ds_read_b64_tr_b16 v[104:105], v6 offset:27392
  ds_read_b64_tr_b16 v[106:107], v6 offset:27456
  v_mfma_f32_16x16x32_bf16 v[16:19], v[44:47], v[76:79], v[16:19]
  s_waitcnt lgkmcnt(6)
  ds_read_b64_tr_b16 v[108:109], v6 offset:27648
  ds_read_b64_tr_b16 v[110:111], v6 offset:27712
  v_mfma_f32_16x16x32_bf16 v[16:19], v[48:51], v[80:83], v[16:19]
  s_waitcnt lgkmcnt(6)
  v_cvt_pk_bf16_f32 v120, v24, v25
  v_cvt_pk_bf16_f32 v121, v26, v27
  v_mfma_f32_16x16x32_bf16 v[112:115], v[116:119], v[68:71], 0
  s_waitcnt lgkmcnt(4)
  buffer_store_dwordx2 v[120:121], v5, s[4:7], s29 offen offset:2304 sc1
  v_mov_b64 v[98:99], 0
  v_mfma_f32_16x16x32_bf16 v[112:115], v[124:127], v[72:75], v[112:115]
  s_waitcnt lgkmcnt(2)
  v_mov_b64 v[36:37], 0
  v_exp_f32 v100, v16
  v_mfma_f32_16x16x32_bf16 v[112:115], v[104:107], v[76:79], v[112:115]
  s_waitcnt lgkmcnt(0)
  v_exp_f32 v101, v17
  v_mfma_f32_16x16x32_bf16 v[112:115], v[108:111], v[80:83], v[112:115]
  s_add_u32 s29, s29, 147456
  v_exp_f32 v102, v18
  v_mfma_f32_16x16x32_bf16 v[20:23], v[52:55], v[68:71], 0
  s_cmp_eq_u32 s14, 63
  v_exp_f32 v103, v19
  v_mfma_f32_16x16x32_bf16 v[20:23], v[56:59], v[72:75], v[20:23]
  s_cbranch_scc1 M_tdone
  v_cvt_pk_bf16_f32 v44, v100, v101
  v_cvt_pk_bf16_f32 v45, v102, v103
  v_mfma_f32_16x16x32_bf16 v[20:23], v[60:63], v[76:79], v[20:23]
  v_exp_f32 v100, v112
  v_mfma_f32_16x16x32_bf16 v[20:23], v[64:67], v[80:83], v[20:23]
  v_exp_f32 v101, v113
  v_exp_f32 v102, v114
  v_exp_f32 v103, v115
  v_cvt_pk_bf16_f32 v84, v100, v101
  v_cvt_pk_bf16_f32 v85, v102, v103
  v_cndmask_b32 v48, v84, 0, s[16:17]
  v_cndmask_b32 v49, v85, 0, s[16:17]
  v_cndmask_b32 v50, 0, v84, s[16:17]
  v_cndmask_b32 v51, 0, v85, s[16:17]
  v_exp_f32 v100, v20
  v_mfma_f32_16x16x16_bf16 v[88:91], v[12:13], v[48:49], 0
  v_exp_f32 v101, v21
  v_mfma_f32_16x16x16_bf16 v[24:27], v[120:121], v[48:49], 0
  v_exp_f32 v102, v22
  v_mfma_f32_16x16x16_bf16 v[116:119], v[120:121], v[50:51], 0
  v_exp_f32 v103, v23
  v_cvt_pk_bf16_f32 v46, v100, v101
  v_cvt_pk_bf16_f32 v47, v102, v103
  v_mov_b64 v[38:39], 0
  s_nop 0
  v_mfma_f32_16x16x32_bf16 v[88:91], v[12:15], v[44:47], v[88:91]
  v_mov_b64 v[40:41], 0
  v_mov_b64 v[42:43], 0
  v_mfma_f32_16x16x32_bf16 v[24:27], v[28:31], v[44:47], v[24:27]
  ds_read_b128 v[52:55], v4 offset:24576
  ds_read_b128 v[56:59], v4 offset:25600
  v_mfma_f32_16x16x32_bf16 v[116:119], v[32:35], v[44:47], v[116:119]
  s_nop 1
  v_rcp_f32 v89, v88
  v_subrev_u32 v100, s54, v88
  v_cmp_le_u32 vcc, s55, v100
  v_mul_f32 v24, v89, v24
  v_mul_f32 v25, v89, v25
  s_cbranch_vccnz T_slow_87
T_back_88:
  v_cvt_pk_bf16_f32 v124, v24, v25
  v_pk_mul_f32 v[26:27], v[26:27], v[88:89] op_sel:[0,1] op_sel_hi:[1,1]
  v_pk_mul_f32 v[116:117], v[116:117], v[88:89] op_sel:[0,1] op_sel_hi:[1,1]
  v_pk_mul_f32 v[118:119], v[118:119], v[88:89] op_sel:[0,1] op_sel_hi:[1,1]
  v_cvt_pk_bf16_f32 v125, v26, v27
  v_cvt_pk_bf16_f32 v126, v116, v117
  v_cvt_pk_bf16_f32 v127, v118, v119
  ds_write_b128 v11, v[124:127] offset:29184
  s_nop 0
  v_smfmac_f32_16x16x64_bf16 v[92:95], v[124:127], a[160:167], v0
  v_smfmac_f32_16x16x64_bf16 v[96:99], v[124:127], a[168:175], v0
  v_smfmac_f32_16x16x64_bf16 v[36:39], v[124:127], a[176:183], v0
  v_smfmac_f32_16x16x64_bf16 v[40:43], v[124:127], a[184:191], v0
  s_waitcnt lgkmcnt(0)
  s_barrier
  ds_read_b128 v[104:107], v11 offset:29696
  ds_read_b128 v[108:111], v11 offset:30208
  ds_read_b128 v[68:71], v11 offset:30720
  s_waitcnt lgkmcnt(2)
  v_smfmac_f32_16x16x64_bf16 v[92:95], v[104:107], a[192:199], v0
  s_waitcnt lgkmcnt(1)
  ds_read_b128 v[76:79], v4 offset:28672
  v_smfmac_f32_16x16x64_bf16 v[92:95], v[108:111], a[224:231], v0
  s_waitcnt lgkmcnt(1)
  ds_read_b128 v[80:83], v4 offset:29696
  v_smfmac_f32_16x16x64_bf16 v[92:95], v[68:71], a[240:247], v0
  ds_read_b128 v[60:63], v4 offset:26624
  v_smfmac_f32_16x16x64_bf16 v[96:99], v[104:107], a[200:207], v0
  ds_read_b128 v[64:67], v4 offset:27648
  v_smfmac_f32_16x16x64_bf16 v[96:99], v[108:111], a[232:239], v0
  ds_read_b128 v[28:31], v4 offset:30720
  s_nop 0
  v_cvt_pk_bf16_f32 v16, v92, v93
  v_cvt_pk_bf16_f32 v17, v94, v95
  v_bfi_b32 v16, 1, s57, v16
  v_smfmac_f32_16x16x64_bf16 v[96:99], v[68:71], a[248:255], v0
  buffer_store_dwordx2 v[16:17], v7, s[4:7], s20 offen offset:0
  v_smfmac_f32_16x16x64_bf16 v[36:39], v[104:107], a[208:215], v0
  ds_read_b128 v[32:35], v4 offset:31744
  v_smfmac_f32_16x16x64_bf16 v[36:39], v[108:111], v[52:59], v0
  s_waitcnt lgkmcnt(4)
  s_nop 0
  v_cvt_pk_bf16_f32 v18, v96, v97
  v_cvt_pk_bf16_f32 v19, v98, v99
  v_bfi_b32 v18, 1, s57, v18
  v_smfmac_f32_16x16x64_bf16 v[36:39], v[68:71], v[76:83], v0
  buffer_store_dwordx2 v[18:19], v7, s[4:7], s20 offen offset:64
  v_smfmac_f32_16x16x64_bf16 v[40:43], v[104:107], a[216:223], v0
  s_waitcnt lgkmcnt(2)
  ds_read_b128 v[116:119], v2 offset:31232
  v_smfmac_f32_16x16x64_bf16 v[40:43], v[108:111], v[60:67], v0
  s_waitcnt lgkmcnt(1)
  s_nop 0
  v_cvt_pk_bf16_f32 v20, v36, v37
  v_cvt_pk_bf16_f32 v21, v38, v39
  v_bfi_b32 v20, 1, s57, v20
  v_smfmac_f32_16x16x64_bf16 v[40:43], v[68:71], v[28:35], v0
  buffer_store_dwordx2 v[20:21], v7, s[4:7], s21 offen offset:0
  s_nop 6
  v_cvt_pk_bf16_f32 v22, v40, v41
  v_cvt_pk_bf16_f32 v23, v42, v43
  v_bfi_b32 v22, 1, s57, v22
  buffer_store_dwordx2 v[22:23], v7, s[4:7], s21 offen offset:64
  ds_read_b128 v[68:71], v4 offset:0
  ds_read_b128 v[72:75], v4 offset:1024
  ds_read_b128 v[76:79], v4 offset:4096
  ds_read_b128 v[80:83], v4 offset:5120
  ds_read_b128 v[84:87], v4 offset:8192
  ds_read_b128 v[88:91], v4 offset:9216
  v_mov_b64 v[16:17], 0
  v_mov_b64 v[18:19], 0
  v_mov_b64 v[20:21], 0
  v_mov_b64 v[22:23], 0
  v_mov_b64 v[24:25], 0
  v_mov_b64 v[26:27], 0
  s_mov_b32 s19, 0
  v_mov_b32 v49, -1
  s_waitcnt vmcnt(2)
  buffer_load_dwordx4 v[52:55], v2, s[4:7], s22 offen offset:0 sc1
  buffer_load_dwordx4 v[56:59], v2, s[4:7], s22 offen offset:1024 sc1
  buffer_load_dwordx4 v[60:63], v2, s[4:7], s22 offen offset:2048 sc1
  buffer_load_dwordx4 v[64:67], v2, s[4:7], s22 offen offset:3072 sc1
  ds_read_b128 v[92:95], v4 offset:2048
  ds_read_b128 v[96:99], v4 offset:3072
  ds_read_b128 v[100:103], v4 offset:6144
  ds_read_b128 v[104:107], v4 offset:7168
  ds_read_b128 v[108:111], v4 offset:10240
  ds_read_b128 v[112:115], v4 offset:11264
  ds_read_b64 v[44:45], v2 offset:32256
  s_waitcnt lgkmcnt(0)
  v_readfirstlane_b32 s38, v44
  v_readfirstlane_b32 s37, v45
  s_nop 0
  s_add_u32 s37, s37, 30
  s_cmp_ge_u32 s38, 30
  s_cselect_b32 s38, s37, s38
  s_cmp_ge_u32 s38, 64
  s_cselect_b32 s38, 100, s38
  s_sub_u32 s38, s38, 1
  s_max_i32 s30, s30, s38
  s_waitcnt lgkmcnt(12)
  s_waitcnt vmcnt(3)
  v_mfma_f32_16x16x32_bf16 v[120:123], v[116:119], v[52:55], 0
  v_xor_b32 v48, s57, v52
  v_bitop3_b32 v48, v48, v54, s57 bitop3:0xf6
  s_waitcnt vmcnt(2)
  v_mfma_f32_16x16x32_bf16 v[120:123], v[116:119], v[56:59], v[120:123]
  v_bitop3_b32 v48, v48, v56, s57 bitop3:0xf6
  v_bitop3_b32 v48, v48, v58, s57 bitop3:0xf6
  s_waitcnt vmcnt(1)
  v_mfma_f32_16x16x32_bf16 v[120:123], v[116:119], v[60:63], v[120:123]
  v_bitop3_b32 v48, v48, v60, s57 bitop3:0xf6
  v_bitop3_b32 v48, v48, v62, s57 bitop3:0xf6
  s_waitcnt vmcnt(0)
  v_mfma_f32_16x16x32_bf16 v[120:123], v[116:119], v[64:67], v[120:123]
  v_bitop3_b32 v48, v48, v64, s57 bitop3:0xf6
  v_bitop3_b32 v48, v48, v66, s57 bitop3:0xf6
  v_and_b32 v48, 1, v48
  v_cmp_ne_u32 vcc, 0, v48
  s_cbranch_vccnz T_p1re_90
T_p1ok_91:
  s_nop 2
  v_add_f32_dpp v120, v120, v120 row_ror:8 row_mask:0xf bank_mask:0xf
  v_add_f32_dpp v121, v121, v121 row_ror:8 row_mask:0xf bank_mask:0xf
  v_cvt_pk_bf16_f32 v48, v120, v121
  v_min_u32 v48, -2, v48
  buffer_store_dword v48, v8, s[4:7], s35 offen
  buffer_store_dword v49, v8, s[4:7], s26 offen
  s_barrier
  ds_read_b128 v[28:31], v2 offset:16384
  ds_read_b128 v[32:35], v2 offset:20480
  ds_read_b128 v[36:39], v2 offset:8192
  ds_read_b128 v[40:43], v2 offset:9216
  ds_read_b128 v[44:47], v2 offset:10240
  ds_read_b128 v[48:51], v2 offset:11264
  buffer_load_dwordx4 v[124:127], v2, s[4:7], s24 offen offset:0 sc1
  buffer_load_dwordx4 v[116:119], v2, s[4:7], s25 offen offset:0 sc1
  ds_read_b128 v[52:55], v2 offset:12288
  ds_read_b128 v[56:59], v2 offset:13312
  ds_read_b128 v[60:63], v2 offset:14336
  ds_read_b128 v[64:67], v2 offset:15360
  buffer_load_dwordx4 v[124:127], v2, s[4:7], s24 offen offset:0 sc1
  buffer_load_dwordx4 v[116:119], v2, s[4:7], s25 offen offset:0 sc1
  s_mov_b32 s19, 0
  s_branch T_loop_81
T_p1re_90:
  s_mov_b64 exec, vcc
  buffer_load_dwordx4 v[52:55], v2, s[4:7], s22 offen offset:0 sc1
  buffer_load_dwordx4 v[56:59], v2, s[4:7], s22 offen offset:1024 sc1
  buffer_load_dwordx4 v[60:63], v2, s[4:7], s22 offen offset:2048 sc1
  buffer_load_dwordx4 v[64:67], v2, s[4:7], s22 offen offset:3072 sc1
  s_mov_b64 exec, -1
  s_add_u32 s19, s19, 1
  s_cmp_gt_u32 s19, 32768
  s_cbranch_scc1 M_exit
  s_waitcnt vmcnt(3)
  v_mfma_f32_16x16x32_bf16 v[120:123], v[116:119], v[52:55], 0
  v_xor_b32 v48, s57, v52
  v_bitop3_b32 v48, v48, v54, s57 bitop3:0xf6
  s_waitcnt vmcnt(2)
  v_mfma_f32_16x16x32_bf16 v[120:123], v[116:119], v[56:59], v[120:123]
  v_bitop3_b32 v48, v48, v56, s57 bitop3:0xf6
  v_bitop3_b32 v48, v48, v58, s57 bitop3:0xf6
  s_waitcnt vmcnt(1)
  v_mfma_f32_16x16x32_bf16 v[120:123], v[116:119], v[60:63], v[120:123]
  v_bitop3_b32 v48, v48, v60, s57 bitop3:0xf6
  v_bitop3_b32 v48, v48, v62, s57 bitop3:0xf6
  s_waitcnt vmcnt(0)
  v_mfma_f32_16x16x32_bf16 v[120:123], v[116:119], v[64:67], v[120:123]
  v_bitop3_b32 v48, v48, v64, s57 bitop3:0xf6
  v_bitop3_b32 v48, v48, v66, s57 bitop3:0xf6
  v_and_b32 v48, 1, v48
  v_cmp_ne_u32 vcc, 0, v48
  s_cbranch_vccnz T_p1re_90
  s_branch T_p1ok_91
T_kvw_85:
  s_mov_b32 s19, 0
  s_branch T_kvok_93
T_kv_92:
  s_sleep 4
  s_add_u32 s19, s19, 1
  s_cmp_gt_u32 s19, 32768
  s_cbranch_scc1 M_exit
T_kvok_93:
  s_add_u32 s39, s99, 128
  s_mov_b32 s38, 0
  s_mov_b32 s37, 0
  s_atomic_or s38, s[58:59], s99 glc
  s_atomic_or s37, s[58:59], s39 glc
  s_waitcnt lgkmcnt(0)
  s_add_u32 s37, s37, 30
  s_cmp_ge_u32 s38, 30
  s_cselect_b32 s38, s37, s38
  s_cmp_ge_u32 s38, 64
  s_cselect_b32 s38, 100, s38
  s_sub_u32 s38, s38, 1
  s_max_i32 s30, s30, s38
  s_cmp_ge_i32 s14, s30
  s_cbranch_scc1 T_kv_92
  s_branch T_kvb_86
T_slow_87:
  s_nop 7
  v_max3_f32 v100, v16, v17, v18
  v_max3_f32 v100, v100, v19, v20
  v_max3_f32 v100, v100, v21, v22
  v_max3_f32 v100, v100, v23, v112
  v_max3_f32 v100, v100, v113, v114
  v_max_f32 v100, v100, v115
  v_mov_b32 v101, v100
  s_nop 1
  v_permlane32_swap_b32 v100, v101
  s_nop 1
  v_max_f32 v100, v100, v101
  v_mov_b32 v101, v100
  s_nop 1
  v_permlane16_swap_b32 v100, v101
  s_nop 1
  v_max_f32 v100, v100, v101
  v_sub_f32 v16, v16, v100
  v_sub_f32 v17, v17, v100
  v_sub_f32 v18, v18, v100
  v_sub_f32 v19, v19, v100
  v_exp_f32 v16, v16
  v_exp_f32 v17, v17
  v_exp_f32 v18, v18
  v_exp_f32 v19, v19
  v_sub_f32 v20, v20, v100
  v_sub_f32 v21, v21, v100
  v_sub_f32 v22, v22, v100
  v_sub_f32 v23, v23, v100
  v_exp_f32 v20, v20
  v_exp_f32 v21, v21
  v_exp_f32 v22, v22
  v_exp_f32 v23, v23
  v_sub_f32 v112, v112, v100
  v_sub_f32 v113, v113, v100
  v_sub_f32 v114, v114, v100
  v_sub_f32 v115, v115, v100
  v_exp_f32 v112, v112
  v_exp_f32 v113, v113
  v_exp_f32 v114, v114
  v_exp_f32 v115, v115
  s_nop 0
  v_cvt_pk_bf16_f32 v44, v16, v17
  v_cvt_pk_bf16_f32 v45, v18, v19
  v_cvt_pk_bf16_f32 v46, v20, v21
  v_cvt_pk_bf16_f32 v47, v22, v23
  v_cvt_pk_bf16_f32 v84, v112, v113
  v_cvt_pk_bf16_f32 v85, v114, v115
  v_cndmask_b32 v48, v84, 0, s[16:17]
  v_cndmask_b32 v49, v85, 0, s[16:17]
  v_cndmask_b32 v50, 0, v84, s[16:17]
  v_cndmask_b32 v51, 0, v85, s[16:17]
  s_nop 1
  v_mfma_f32_16x16x16_bf16 v[88:91], v[12:13], v[48:49], 0
  v_mfma_f32_16x16x16_bf16 v[24:27], v[120:121], v[48:49], 0
  v_mfma_f32_16x16x16_bf16 v[116:119], v[120:121], v[50:51], 0
  v_mfma_f32_16x16x32_bf16 v[88:91], v[12:15], v[44:47], v[88:91]
  v_mfma_f32_16x16x32_bf16 v[24:27], v[28:31], v[44:47], v[24:27]
  v_mfma_f32_16x16x32_bf16 v[116:119], v[32:35], v[44:47], v[116:119]
  s_nop 7
  s_nop 1
  v_rcp_f32 v89, v88
  s_nop 0
  v_mul_f32 v24, v89, v24
  v_mul_f32 v25, v89, v25
  s_branch T_back_88
T_w_78:
  s_mov_b32 s19, 0
  v_mov_b64 v[16:17], 0
  v_mov_b64 v[18:19], 0
  v_mov_b64 v[20:21], 0
  v_mov_b64 v[22:23], 0
  v_mov_b64 v[24:25], 0
  v_mov_b64 v[26:27], 0
  buffer_load_dwordx4 v[124:127], v2, s[4:7], s24 offen offset:1024 sc1
  buffer_load_dwordx4 v[116:119], v2, s[4:7], s25 offen offset:1024 sc1
  buffer_load_dwordx4 v[124:127], v2, s[4:7], s24 offen offset:1024 sc1
  buffer_load_dwordx4 v[116:119], v2, s[4:7], s25 offen offset:1024 sc1
  s_branch T_loop_94
.p2align 6
T_retry_95:
  s_mov_b64 exec, vcc
  buffer_load_dwordx4 v[124:127], v2, s[4:7], s24 offen offset:1024 sc1
  buffer_load_dwordx4 v[116:119], v2, s[4:7], s25 offen offset:1024 sc1
  s_mov_b64 exec, -1
  s_add_u32 s19, s19, 1
  s_cmp_gt_u32 s19, 32768
  s_cbranch_scc1 M_exit
T_loop_94:
  s_waitcnt vmcnt(3) lgkmcnt(0)
  v_max3_u32 v123, v124, v125, v126
  v_max_u32 v123, v123, v127
  v_mov_b32_dpp v120, v124 row_ror:8 row_mask:0xf bank_mask:0xf
  v_mov_b32_dpp v121, v125 row_ror:8 row_mask:0xf bank_mask:0xf
  s_waitcnt vmcnt(2)
  v_max3_u32 v123, v123, v116, v117
  v_max3_u32 v123, v123, v118, v119
  v_cmp_eq_u32 vcc, -1, v123
  s_cbranch_vccnz T_retry_95
  v_smfmac_f32_16x16x64_bf16 v[16:19], v[124:127], v[68:75], v0
  s_add_u32 s14, s14, 1
  ds_write_b128 v2, v[124:127] offset:1024
  v_mov_b32_dpp v122, v126 row_ror:8 row_mask:0xf bank_mask:0xf
  v_smfmac_f32_16x16x64_bf16 v[20:23], v[124:127], v[76:83], v0
  s_and_b32 s57, s14, 1
  v_mov_b32_dpp v123, v127 row_ror:8 row_mask:0xf bank_mask:0xf
  v_smfmac_f32_16x16x64_bf16 v[24:27], v[124:127], v[84:91], v0
  s_and_b32 s36, s14, 3
  ds_write_b128 v2, v[116:119] offset:5120
  v_smfmac_f32_16x16x64_bf16 v[16:19], v[120:123], v[92:99], v0
  s_lshl_b32 s36, s36, 13
  v_mov_b32_dpp v84, v116 row_ror:8 row_mask:0xf bank_mask:0xf
  v_smfmac_f32_16x16x64_bf16 v[20:23], v[120:123], v[100:107], v0
  s_add_u32 s26, s36, s23
  ds_read_b128 v[68:71], v4 offset:12288
  v_mov_b32_dpp v85, v117 row_ror:8 row_mask:0xf bank_mask:0xf
  v_smfmac_f32_16x16x64_bf16 v[24:27], v[120:123], v[108:115], v0
  s_add_u32 s36, s36, 8192
  ds_read_b128 v[72:75], v4 offset:13312
  v_mov_b32_dpp v86, v118 row_ror:8 row_mask:0xf bank_mask:0xf
  v_smfmac_f32_16x16x64_bf16 v[16:19], v[116:119], v[224:231], v0
  s_and_b32 s36, s36, 0x7fff
  ds_read_b128 v[76:79], v4 offset:14336
  v_mov_b32_dpp v87, v119 row_ror:8 row_mask:0xf bank_mask:0xf
  v_smfmac_f32_16x16x64_bf16 v[20:23], v[116:119], v[240:247], v0
  s_waitcnt lgkmcnt(3)
  s_barrier
  ds_read_b128 v[100:103], v2 offset:0
  v_smfmac_f32_16x16x64_bf16 v[24:27], v[116:119], a[0:7], v0
  s_mov_b32 m0, s31
  ds_read_b128 v[120:123], v1 offset:0
  v_smfmac_f32_16x16x64_bf16 v[16:19], v[84:87], v[232:239], v0
  s_cmp_ge_i32 s14, s30
  s_cbranch_scc1 T_kvw_98
T_kvb_99:
  v_smfmac_f32_16x16x64_bf16 v[20:23], v[84:87], v[248:255], v0
  ds_read_b128 v[80:83], v4 offset:15360
  v_smfmac_f32_16x16x64_bf16 v[24:27], v[84:87], a[8:15], v0
  s_waitcnt lgkmcnt(2)
  buffer_load_dwordx4 v9, s[4:7], s27 offen sc1 lds
  v_smfmac_f32_16x16x64_bf16 v[16:19], v[100:103], v[128:135], v0
  ds_read_b128 v[92:95], v2 offset:3072
  s_mov_b32 m0, s32
  v_smfmac_f32_16x16x64_bf16 v[20:23], v[100:103], v[144:151], v0
  ds_read_b128 v[96:99], v1 offset:3072
  v_smfmac_f32_16x16x64_bf16 v[24:27], v[100:103], v[68:75], v0
  s_waitcnt vmcnt(1) lgkmcnt(3)
  ds_read_b128 v[116:119], v2 offset:2048
  v_smfmac_f32_16x16x64_bf16 v[16:19], v[120:123], v[136:143], v0
  ds_read_b128 v[124:127], v1 offset:2048
  buffer_load_dwordx4 v9, s[4:7], s27 offen offset:128 sc1 lds
  v_smfmac_f32_16x16x64_bf16 v[20:23], v[120:123], v[152:159], v0
  s_waitcnt lgkmcnt(4)
  ds_read_b128 v[104:107], v2 offset:4096
  s_mov_b32 m0, s33
  v_smfmac_f32_16x16x64_bf16 v[24:27], v[120:123], v[76:83], v0
  s_waitcnt lgkmcnt(4)
  ds_read_b128 v[108:111], v1 offset:4096
  v_smfmac_f32_16x16x64_bf16 v[16:19], v[92:95], v[160:167], v0
  s_waitcnt lgkmcnt(4)
  ds_read_b128 v[112:115], v2 offset:7168
  v_smfmac_f32_16x16x64_bf16 v[16:19], v[96:99], v[168:175], v0
  s_waitcnt lgkmcnt(4)
  ds_read_b128 v[84:87], v1 offset:7168
  buffer_load_dwordx4 v10, s[4:7], s28 offen sc1 lds
  v_smfmac_f32_16x16x64_bf16 v[16:19], v[116:119], v[192:199], v0
  s_waitcnt lgkmcnt(4)
  ds_read_b128 v[88:91], v2 offset:6144
  s_mov_b32 m0, s34
  v_smfmac_f32_16x16x64_bf16 v[16:19], v[124:127], v[200:207], v0
  s_waitcnt lgkmcnt(4)
  ds_read_b128 v[100:103], v1 offset:6144
  v_smfmac_f32_16x16x64_bf16 v[16:19], v[104:107], a[16:23], v0
  s_waitcnt lgkmcnt(4)
  ds_read_b128 v[68:71], v4 offset:16384
  v_smfmac_f32_16x16x64_bf16 v[16:19], v[108:111], a[24:31], v0
  s_waitcnt lgkmcnt(4)
  ds_read_b128 v[72:75], v4 offset:17408
  buffer_load_dwordx4 v10, s[4:7], s28 offen offset:256 sc1 lds
  v_smfmac_f32_16x16x64_bf16 v[16:19], v[112:115], a[64:71], v0
  s_waitcnt lgkmcnt(4)
  ds_read_b128 v[76:79], v4 offset:18432
  v_smfmac_f32_16x16x64_bf16 v[16:19], v[84:87], a[72:79], v0
  s_waitcnt lgkmcnt(4)
  ds_read_b128 v[80:83], v4 offset:19456
  v_smfmac_f32_16x16x64_bf16 v[16:19], v[88:91], a[112:119], v0
  s_waitcnt lgkmcnt(4)
  v_smfmac_f32_16x16x64_bf16 v[16:19], v[100:103], a[120:127], v0
  s_add_u32 s24, s36, 145752064
  s_add_u32 s25, s36, 145756160
  v_smfmac_f32_16x16x64_bf16 v[20:23], v[92:95], v[176:183], v0
  s_add_u32 s35, s36, s23
  v_smfmac_f32_16x16x64_bf16 v[20:23], v[96:99], v[184:191], v0
  s_waitcnt lgkmcnt(2)
  v_smfmac_f32_16x16x64_bf16 v[20:23], v[116:119], v[68:75], v0
  s_waitcnt lgkmcnt(0)
  ds_read_b128 v[68:71], v4 offset:20480
  v_mul_f32 v16, s18, v16
  v_smfmac_f32_16x16x64_bf16 v[20:23], v[124:127], v[76:83], v0
  ds_read_b128 v[72:75], v4 offset:21504
  v_mul_f32 v17, s18, v17
  v_smfmac_f32_16x16x64_bf16 v[20:23], v[104:107], a[32:39], v0
  ds_read_b128 v[76:79], v4 offset:22528
  v_mul_f32 v18, s18, v18
  v_smfmac_f32_16x16x64_bf16 v[20:23], v[108:111], a[40:47], v0
  ds_read_b128 v[80:83], v4 offset:23552
  v_mul_f32 v19, s18, v19
  v_smfmac_f32_16x16x64_bf16 v[20:23], v[112:115], a[80:87], v0
  v_cvt_pk_bf16_f32 v120, v16, v17
  v_smfmac_f32_16x16x64_bf16 v[20:23], v[84:87], a[88:95], v0
  v_cvt_pk_bf16_f32 v121, v18, v19
  v_smfmac_f32_16x16x64_bf16 v[20:23], v[88:91], a[128:135], v0
  ds_write_b64 v5, v[120:121] offset:24576
  v_smfmac_f32_16x16x64_bf16 v[20:23], v[100:103], a[136:143], v0
  s_waitcnt lgkmcnt(3)
  v_smfmac_f32_16x16x64_bf16 v[24:27], v[92:95], v[68:75], v0
  s_waitcnt lgkmcnt(1)
  v_mov_b64 v[92:93], 0
  v_smfmac_f32_16x16x64_bf16 v[24:27], v[96:99], v[76:83], v0
  s_nop 1
  v_cvt_pk_bf16_f32 v122, v20, v21
  v_cvt_pk_bf16_f32 v123, v22, v23
  v_smfmac_f32_16x16x64_bf16 v[24:27], v[116:119], v[208:215], v0
  ds_write_b64 v5, v[122:123] offset:26880
  v_mov_b64 v[94:95], 0
  v_smfmac_f32_16x16x64_bf16 v[24:27], v[124:127], v[216:223], v0
  s_waitcnt lgkmcnt(1)
  s_barrier
  ds_read_b64_tr_b16 v[68:69], v6 offset:24576
  v_smfmac_f32_16x16x64_bf16 v[24:27], v[104:107], a[48:55], v0
  s_add_u32 s27, s27, 8192
  ds_read_b64_tr_b16 v[70:71], v6 offset:24640
  ds_read_b64_tr_b16 v[72:73], v6 offset:24832
  v_smfmac_f32_16x16x64_bf16 v[24:27], v[108:111], a[56:63], v0
  s_add_u32 s28, s28, 8192
  ds_read_b64_tr_b16 v[74:75], v6 offset:24896
  ds_read_b64_tr_b16 v[76:77], v6 offset:25088
  v_smfmac_f32_16x16x64_bf16 v[24:27], v[112:115], a[96:103], v0
  s_nop 0
  ds_read_b64_tr_b16 v[78:79], v6 offset:25152
  ds_read_b64_tr_b16 v[80:81], v6 offset:25344
  v_smfmac_f32_16x16x64_bf16 v[24:27], v[84:87], a[104:111], v0
  ds_read_b64_tr_b16 v[82:83], v6 offset:25408
  v_mov_b64 v[96:97], 0
  v_smfmac_f32_16x16x64_bf16 v[24:27], v[88:91], a[144:151], v0
  s_waitcnt lgkmcnt(8)
  s_barrier
  ds_read_b64_tr_b16 v[116:117], v6 offset:26880
  v_smfmac_f32_16x16x64_bf16 v[24:27], v[100:103], a[152:159], v0
  s_waitcnt lgkmcnt(7)
  ds_read_b64_tr_b16 v[118:119], v6 offset:26944
  buffer_store_dwordx2 v[122:123], v5, s[4:7], s29 offen sc1
  v_mfma_f32_16x16x32_bf16 v[16:19], v[36:39], v[68:71], 0
  s_waitcnt lgkmcnt(6)
  ds_read_b64_tr_b16 v[124:125], v6 offset:27136
  ds_read_b64_tr_b16 v[126:127], v6 offset:27200
  v_mfma_f32_16x16x32_bf16 v[16:19], v[40:43], v[72:75], v[16:19]
  s_waitcnt lgkmcnt(6)
  ds_read_b64_tr_b16 v[104:105], v6 offset:27392
  ds_read_b64_tr_b16 v[106:107], v6 offset:27456
  v_mfma_f32_16x16x32_bf16 v[16:19], v[44:47], v[76:79], v[16:19]
  s_waitcnt lgkmcnt(6)
  ds_read_b64_tr_b16 v[108:109], v6 offset:27648
  ds_read_b64_tr_b16 v[110:111], v6 offset:27712
  v_mfma_f32_16x16x32_bf16 v[16:19], v[48:51], v[80:83], v[16:19]
  s_waitcnt lgkmcnt(6)
  v_cvt_pk_bf16_f32 v120, v24, v25
  v_cvt_pk_bf16_f32 v121, v26, v27
  v_mfma_f32_16x16x32_bf16 v[112:115], v[116:119], v[68:71], 0
  s_waitcnt lgkmcnt(4)
  buffer_store_dwordx2 v[120:121], v5, s[4:7], s29 offen offset:2304 sc1
  v_mov_b64 v[98:99], 0
  v_mfma_f32_16x16x32_bf16 v[112:115], v[124:127], v[72:75], v[112:115]
  s_waitcnt lgkmcnt(2)
  v_mov_b64 v[36:37], 0
  v_exp_f32 v100, v16
  v_mfma_f32_16x16x32_bf16 v[112:115], v[104:107], v[76:79], v[112:115]
  s_waitcnt lgkmcnt(0)
  v_exp_f32 v101, v17
  v_mfma_f32_16x16x32_bf16 v[112:115], v[108:111], v[80:83], v[112:115]
  s_add_u32 s29, s29, 147456
  v_exp_f32 v102, v18
  v_mfma_f32_16x16x32_bf16 v[20:23], v[52:55], v[68:71], 0
  s_cmp_eq_u32 s14, 63
  v_exp_f32 v103, v19
  v_mfma_f32_16x16x32_bf16 v[20:23], v[56:59], v[72:75], v[20:23]
  s_cbranch_scc1 M_tdone
  v_cvt_pk_bf16_f32 v44, v100, v101
  v_cvt_pk_bf16_f32 v45, v102, v103
  v_mfma_f32_16x16x32_bf16 v[20:23], v[60:63], v[76:79], v[20:23]
  v_exp_f32 v100, v112
  v_mfma_f32_16x16x32_bf16 v[20:23], v[64:67], v[80:83], v[20:23]
  v_exp_f32 v101, v113
  v_exp_f32 v102, v114
  v_exp_f32 v103, v115
  v_cvt_pk_bf16_f32 v84, v100, v101
  v_cvt_pk_bf16_f32 v85, v102, v103
  v_cndmask_b32 v48, v84, 0, s[16:17]
  v_cndmask_b32 v49, v85, 0, s[16:17]
  v_cndmask_b32 v50, 0, v84, s[16:17]
  v_cndmask_b32 v51, 0, v85, s[16:17]
  v_exp_f32 v100, v20
  v_mfma_f32_16x16x16_bf16 v[88:91], v[12:13], v[48:49], 0
  v_exp_f32 v101, v21
  v_mfma_f32_16x16x16_bf16 v[24:27], v[120:121], v[48:49], 0
  v_exp_f32 v102, v22
  v_mfma_f32_16x16x16_bf16 v[116:119], v[120:121], v[50:51], 0
  v_exp_f32 v103, v23
  v_cvt_pk_bf16_f32 v46, v100, v101
  v_cvt_pk_bf16_f32 v47, v102, v103
  v_mov_b64 v[38:39], 0
  s_nop 0
  v_mfma_f32_16x16x32_bf16 v[88:91], v[12:15], v[44:47], v[88:91]
  v_mov_b64 v[40:41], 0
  v_mov_b64 v[42:43], 0
  v_mfma_f32_16x16x32_bf16 v[24:27], v[28:31], v[44:47], v[24:27]
  ds_read_b128 v[52:55], v4 offset:24576
  ds_read_b128 v[56:59], v4 offset:25600
  v_mfma_f32_16x16x32_bf16 v[116:119], v[32:35], v[44:47], v[116:119]
  s_nop 1
  v_rcp_f32 v89, v88
  v_subrev_u32 v100, s54, v88
  v_cmp_le_u32 vcc, s55, v100
  v_mul_f32 v24, v89, v24
  v_mul_f32 v25, v89, v25
  s_cbranch_vccnz T_slow_100
T_back_101:
  v_cvt_pk_bf16_f32 v124, v24, v25
  v_pk_mul_f32 v[26:27], v[26:27], v[88:89] op_sel:[0,1] op_sel_hi:[1,1]
  v_pk_mul_f32 v[116:117], v[116:117], v[88:89] op_sel:[0,1] op_sel_hi:[1,1]
  v_pk_mul_f32 v[118:119], v[118:119], v[88:89] op_sel:[0,1] op_sel_hi:[1,1]
  v_cvt_pk_bf16_f32 v125, v26, v27
  v_cvt_pk_bf16_f32 v126, v116, v117
  v_cvt_pk_bf16_f32 v127, v118, v119
  ds_write_b128 v11, v[124:127] offset:29696
  s_nop 0
  v_smfmac_f32_16x16x64_bf16 v[92:95], v[124:127], a[160:167], v0
  v_smfmac_f32_16x16x64_bf16 v[96:99], v[124:127], a[168:175], v0
  v_smfmac_f32_16x16x64_bf16 v[36:39], v[124:127], a[176:183], v0
  v_smfmac_f32_16x16x64_bf16 v[40:43], v[124:127], a[184:191], v0
  s_waitcnt lgkmcnt(0)
  s_barrier
  ds_read_b128 v[104:107], v11 offset:29184
  ds_read_b128 v[108:111], v11 offset:30720
  ds_read_b128 v[68:71], v11 offset:30208
  s_waitcnt lgkmcnt(2)
  v_smfmac_f32_16x16x64_bf16 v[92:95], v[104:107], a[192:199], v0
  s_waitcnt lgkmcnt(1)
  ds_read_b128 v[76:79], v4 offset:28672
  v_smfmac_f32_16x16x64_bf16 v[92:95], v[108:111], a[224:231], v0
  s_waitcnt lgkmcnt(1)
  ds_read_b128 v[80:83], v4 offset:29696
  v_smfmac_f32_16x16x64_bf16 v[92:95], v[68:71], a[240:247], v0
  ds_read_b128 v[60:63], v4 offset:26624
  v_smfmac_f32_16x16x64_bf16 v[96:99], v[104:107], a[200:207], v0
  ds_read_b128 v[64:67], v4 offset:27648
  v_smfmac_f32_16x16x64_bf16 v[96:99], v[108:111], a[232:239], v0
  ds_read_b128 v[28:31], v4 offset:30720
  s_nop 0
  v_cvt_pk_bf16_f32 v16, v92, v93
  v_cvt_pk_bf16_f32 v17, v94, v95
  v_bfi_b32 v16, 1, s57, v16
  v_smfmac_f32_16x16x64_bf16 v[96:99], v[68:71], a[248:255], v0
  buffer_store_dwordx2 v[16:17], v7, s[4:7], s20 offen offset:0
  v_smfmac_f32_16x16x64_bf16 v[36:39], v[104:107], a[208:215], v0
  ds_read_b128 v[32:35], v4 offset:31744
  v_smfmac_f32_16x16x64_bf16 v[36:39], v[108:111], v[52:59], v0
  s_waitcnt lgkmcnt(4)
  s_nop 0
  v_cvt_pk_bf16_f32 v18, v96, v97
  v_cvt_pk_bf16_f32 v19, v98, v99
  v_bfi_b32 v18, 1, s57, v18
  v_smfmac_f32_16x16x64_bf16 v[36:39], v[68:71], v[76:83], v0
  buffer_store_dwordx2 v[18:19], v7, s[4:7], s20 offen offset:64
  v_smfmac_f32_16x16x64_bf16 v[40:43], v[104:107], a[216:223], v0
  s_waitcnt lgkmcnt(2)
  ds_read_b128 v[116:119], v2 offset:31232
  v_smfmac_f32_16x16x64_bf16 v[40:43], v[108:111], v[60:67], v0
  s_waitcnt lgkmcnt(1)
  s_nop 0
  v_cvt_pk_bf16_f32 v20, v36, v37
  v_cvt_pk_bf16_f32 v21, v38, v39
  v_bfi_b32 v20, 1, s57, v20
  v_smfmac_f32_16x16x64_bf16 v[40:43], v[68:71], v[28:35], v0
  buffer_store_dwordx2 v[20:21], v7, s[4:7], s21 offen offset:0
  s_nop 6
  v_cvt_pk_bf16_f32 v22, v40, v41
  v_cvt_pk_bf16_f32 v23, v42, v43
  v_bfi_b32 v22, 1, s57, v22
  buffer_store_dwordx2 v[22:23], v7, s[4:7], s21 offen offset:64
  ds_read_b128 v[68:71], v4 offset:0
  ds_read_b128 v[72:75], v4 offset:1024
  ds_read_b128 v[76:79], v4 offset:4096
  ds_read_b128 v[80:83], v4 offset:5120
  ds_read_b128 v[84:87], v4 offset:8192
  ds_read_b128 v[88:91], v4 offset:9216
  ds_read_b128 v[92:95], v4 offset:2048
  ds_read_b128 v[96:99], v4 offset:3072
  ds_read_b128 v[100:103], v4 offset:6144
  ds_read_b128 v[104:107], v4 offset:7168
  ds_read_b128 v[108:111], v4 offset:10240
  ds_read_b128 v[112:115], v4 offset:11264
  v_mov_b64 v[16:17], 0
  v_mov_b64 v[18:19], 0
  v_mov_b64 v[20:21], 0
  v_mov_b64 v[22:23], 0
  v_mov_b64 v[24:25], 0
  v_mov_b64 v[26:27], 0
  s_mov_b32 s19, 0
  v_mov_b32 v49, -1
  ds_read_b64 v[44:45], v2 offset:32256
  s_waitcnt lgkmcnt(0)
  v_readfirstlane_b32 s38, v44
  v_readfirstlane_b32 s37, v45
  s_nop 0
  s_add_u32 s37, s37, 30
  s_cmp_ge_u32 s38, 30
  s_cselect_b32 s38, s37, s38
  s_cmp_ge_u32 s38, 64
  s_cselect_b32 s38, 100, s38
  s_sub_u32 s38, s38, 1
  s_max_i32 s30, s30, s38
  s_waitcnt vmcnt(0)
  buffer_load_dwordx4 v[52:55], v2, s[4:7], s22 offen offset:0 sc1
  buffer_load_dwordx4 v[56:59], v2, s[4:7], s22 offen offset:1024 sc1
  buffer_load_dwordx4 v[60:63], v2, s[4:7], s22 offen offset:2048 sc1
  buffer_load_dwordx4 v[64:67], v2, s[4:7], s22 offen offset:3072 sc1
  s_waitcnt lgkmcnt(12)
  s_waitcnt vmcnt(3)
  v_mfma_f32_16x16x32_bf16 v[120:123], v[116:119], v[52:55], 0
  v_xor_b32 v48, s57, v52
  v_bitop3_b32 v48, v48, v54, s57 bitop3:0xf6
  s_waitcnt vmcnt(2)
  v_mfma_f32_16x16x32_bf16 v[120:123], v[116:119], v[56:59], v[120:123]
  v_bitop3_b32 v48, v48, v56, s57 bitop3:0xf6
  v_bitop3_b32 v48, v48, v58, s57 bitop3:0xf6
  s_waitcnt vmcnt(1)
  v_mfma_f32_16x16x32_bf16 v[120:123], v[116:119], v[60:63], v[120:123]
  v_bitop3_b32 v48, v48, v60, s57 bitop3:0xf6
  v_bitop3_b32 v48, v48, v62, s57 bitop3:0xf6
  s_waitcnt vmcnt(0)
  v_mfma_f32_16x16x32_bf16 v[120:123], v[116:119], v[64:67], v[120:123]
  v_bitop3_b32 v48, v48, v64, s57 bitop3:0xf6
  v_bitop3_b32 v48, v48, v66, s57 bitop3:0xf6
  v_and_b32 v48, 1, v48
  v_cmp_ne_u32 vcc, 0, v48
  s_cbranch_vccnz T_p1re_103
T_p1ok_104:
  s_nop 2
  v_add_f32_dpp v120, v120, v120 row_ror:8 row_mask:0xf bank_mask:0xf
  v_add_f32_dpp v121, v121, v121 row_ror:8 row_mask:0xf bank_mask:0xf
  v_cvt_pk_bf16_f32 v48, v120, v121
  v_min_u32 v48, -2, v48
  buffer_store_dword v48, v8, s[4:7], s35 offen
  buffer_store_dword v49, v8, s[4:7], s26 offen
  s_barrier
  ds_read_b128 v[28:31], v2 offset:17408
  ds_read_b128 v[32:35], v2 offset:21504
  ds_read_b128 v[36:39], v2 offset:8192
  ds_read_b128 v[40:43], v2 offset:9216
  ds_read_b128 v[44:47], v2 offset:10240
  ds_read_b128 v[48:51], v2 offset:11264
  buffer_load_dwordx4 v[124:127], v2, s[4:7], s24 offen offset:1024 sc1
  buffer_load_dwordx4 v[116:119], v2, s[4:7], s25 offen offset:1024 sc1
  ds_read_b128 v[52:55], v2 offset:12288
  ds_read_b128 v[56:59], v2 offset:13312
  ds_read_b128 v[60:63], v2 offset:14336
  ds_read_b128 v[64:67], v2 offset:15360
  buffer_load_dwordx4 v[124:127], v2, s[4:7], s24 offen offset:1024 sc1
  buffer_load_dwordx4 v[116:119], v2, s[4:7], s25 offen offset:1024 sc1
  s_mov_b32 s19, 0
  s_branch T_loop_94
T_p1re_103:
  s_mov_b64 exec, vcc
  buffer_load_dwordx4 v[52:55], v2, s[4:7], s22 offen offset:0 sc1
  buffer_load_dwordx4 v[56:59], v2, s[4:7], s22 offen offset:1024 sc1
  buffer_load_dwordx4 v[60:63], v2, s[4:7], s22 offen offset:2048 sc1
  buffer_load_dwordx4 v[64:67], v2, s[4:7], s22 offen offset:3072 sc1
  s_mov_b64 exec, -1
  s_add_u32 s19, s19, 1
  s_cmp_gt_u32 s19, 32768
  s_cbranch_scc1 M_exit
  s_waitcnt vmcnt(3)
  v_mfma_f32_16x16x32_bf16 v[120:123], v[116:119], v[52:55], 0
  v_xor_b32 v48, s57, v52
  v_bitop3_b32 v48, v48, v54, s57 bitop3:0xf6
  s_waitcnt vmcnt(2)
  v_mfma_f32_16x16x32_bf16 v[120:123], v[116:119], v[56:59], v[120:123]
  v_bitop3_b32 v48, v48, v56, s57 bitop3:0xf6
  v_bitop3_b32 v48, v48, v58, s57 bitop3:0xf6
  s_waitcnt vmcnt(1)
  v_mfma_f32_16x16x32_bf16 v[120:123], v[116:119], v[60:63], v[120:123]
  v_bitop3_b32 v48, v48, v60, s57 bitop3:0xf6
  v_bitop3_b32 v48, v48, v62, s57 bitop3:0xf6
  s_waitcnt vmcnt(0)
  v_mfma_f32_16x16x32_bf16 v[120:123], v[116:119], v[64:67], v[120:123]
  v_bitop3_b32 v48, v48, v64, s57 bitop3:0xf6
  v_bitop3_b32 v48, v48, v66, s57 bitop3:0xf6
  v_and_b32 v48, 1, v48
  v_cmp_ne_u32 vcc, 0, v48
  s_cbranch_vccnz T_p1re_103
  s_branch T_p1ok_104
T_kvw_98:
  s_mov_b32 s19, 0
  s_branch T_kvok_106
T_kv_105:
  s_sleep 4
  s_add_u32 s19, s19, 1
  s_cmp_gt_u32 s19, 32768
  s_cbranch_scc1 M_exit
T_kvok_106:
  s_add_u32 s39, s99, 128
  s_mov_b32 s38, 0
  s_mov_b32 s37, 0
  s_atomic_or s38, s[58:59], s99 glc
  s_atomic_or s37, s[58:59], s39 glc
  s_waitcnt lgkmcnt(0)
  s_add_u32 s37, s37, 30
  s_cmp_ge_u32 s38, 30
  s_cselect_b32 s38, s37, s38
  s_cmp_ge_u32 s38, 64
  s_cselect_b32 s38, 100, s38
  s_sub_u32 s38, s38, 1
  s_max_i32 s30, s30, s38
  s_cmp_ge_i32 s14, s30
  s_cbranch_scc1 T_kv_105
  s_branch T_kvb_99
T_slow_100:
  s_nop 7
  v_max3_f32 v100, v16, v17, v18
  v_max3_f32 v100, v100, v19, v20
  v_max3_f32 v100, v100, v21, v22
  v_max3_f32 v100, v100, v23, v112
  v_max3_f32 v100, v100, v113, v114
  v_max_f32 v100, v100, v115
  v_mov_b32 v101, v100
  s_nop 1
  v_permlane32_swap_b32 v100, v101
  s_nop 1
  v_max_f32 v100, v100, v101
  v_mov_b32 v101, v100
  s_nop 1
  v_permlane16_swap_b32 v100, v101
  s_nop 1
  v_max_f32 v100, v100, v101
  v_sub_f32 v16, v16, v100
  v_sub_f32 v17, v17, v100
  v_sub_f32 v18, v18, v100
  v_sub_f32 v19, v19, v100
  v_exp_f32 v16, v16
  v_exp_f32 v17, v17
  v_exp_f32 v18, v18
  v_exp_f32 v19, v19
  v_sub_f32 v20, v20, v100
  v_sub_f32 v21, v21, v100
  v_sub_f32 v22, v22, v100
  v_sub_f32 v23, v23, v100
  v_exp_f32 v20, v20
  v_exp_f32 v21, v21
  v_exp_f32 v22, v22
  v_exp_f32 v23, v23
  v_sub_f32 v112, v112, v100
  v_sub_f32 v113, v113, v100
  v_sub_f32 v114, v114, v100
  v_sub_f32 v115, v115, v100
  v_exp_f32 v112, v112
  v_exp_f32 v113, v113
  v_exp_f32 v114, v114
  v_exp_f32 v115, v115
  s_nop 0
  v_cvt_pk_bf16_f32 v44, v16, v17
  v_cvt_pk_bf16_f32 v45, v18, v19
  v_cvt_pk_bf16_f32 v46, v20, v21
  v_cvt_pk_bf16_f32 v47, v22, v23
  v_cvt_pk_bf16_f32 v84, v112, v113
  v_cvt_pk_bf16_f32 v85, v114, v115
  v_cndmask_b32 v48, v84, 0, s[16:17]
  v_cndmask_b32 v49, v85, 0, s[16:17]
  v_cndmask_b32 v50, 0, v84, s[16:17]
  v_cndmask_b32 v51, 0, v85, s[16:17]
  s_nop 1
  v_mfma_f32_16x16x16_bf16 v[88:91], v[12:13], v[48:49], 0
  v_mfma_f32_16x16x16_bf16 v[24:27], v[120:121], v[48:49], 0
  v_mfma_f32_16x16x16_bf16 v[116:119], v[120:121], v[50:51], 0
  v_mfma_f32_16x16x32_bf16 v[88:91], v[12:15], v[44:47], v[88:91]
  v_mfma_f32_16x16x32_bf16 v[24:27], v[28:31], v[44:47], v[24:27]
  v_mfma_f32_16x16x32_bf16 v[116:119], v[32:35], v[44:47], v[116:119]
  s_nop 7
  s_nop 1
  v_rcp_f32 v89, v88
  s_nop 0
  v_mul_f32 v24, v89, v24
  v_mul_f32 v25, v89, v25
  s_branch T_back_101
T_w_79:
  s_mov_b32 s19, 0
  v_mov_b64 v[16:17], 0
  v_mov_b64 v[18:19], 0
  v_mov_b64 v[20:21], 0
  v_mov_b64 v[22:23], 0
  v_mov_b64 v[24:25], 0
  v_mov_b64 v[26:27], 0
  buffer_load_dwordx4 v[124:127], v2, s[4:7], s24 offen offset:2048 sc1
  buffer_load_dwordx4 v[116:119], v2, s[4:7], s25 offen offset:2048 sc1
  buffer_load_dwordx4 v[124:127], v2, s[4:7], s24 offen offset:2048 sc1
  buffer_load_dwordx4 v[116:119], v2, s[4:7], s25 offen offset:2048 sc1
  s_branch T_loop_107
.p2align 6
T_retry_108:
  s_mov_b64 exec, vcc
  buffer_load_dwordx4 v[124:127], v2, s[4:7], s24 offen offset:2048 sc1
  buffer_load_dwordx4 v[116:119], v2, s[4:7], s25 offen offset:2048 sc1
  s_mov_b64 exec, -1
  s_add_u32 s19, s19, 1
  s_cmp_gt_u32 s19, 32768
  s_cbranch_scc1 M_exit
T_loop_107:
  s_waitcnt vmcnt(3) lgkmcnt(0)
  v_max3_u32 v123, v124, v125, v126
  v_max_u32 v123, v123, v127
  v_mov_b32_dpp v120, v124 row_ror:8 row_mask:0xf bank_mask:0xf
  v_mov_b32_dpp v121, v125 row_ror:8 row_mask:0xf bank_mask:0xf
  s_waitcnt vmcnt(2)
  v_max3_u32 v123, v123, v116, v117
  v_max3_u32 v123, v123, v118, v119
  v_cmp_eq_u32 vcc, -1, v123
  s_cbranch_vccnz T_retry_108
  v_smfmac_f32_16x16x64_bf16 v[16:19], v[124:127], v[68:75], v0
  s_add_u32 s14, s14, 1
  ds_write_b128 v2, v[124:127] offset:2048
  v_mov_b32_dpp v122, v126 row_ror:8 row_mask:0xf bank_mask:0xf
  v_smfmac_f32_16x16x64_bf16 v[20:23], v[124:127], v[76:83], v0
  s_and_b32 s57, s14, 1
  v_mov_b32_dpp v123, v127 row_ror:8 row_mask:0xf bank_mask:0xf
  v_smfmac_f32_16x16x64_bf16 v[24:27], v[124:127], v[84:91], v0
  s_and_b32 s36, s14, 3
  ds_write_b128 v2, v[116:119] offset:6144
  v_smfmac_f32_16x16x64_bf16 v[16:19], v[120:123], v[92:99], v0
  s_lshl_b32 s36, s36, 13
  v_mov_b32_dpp v84, v116 row_ror:8 row_mask:0xf bank_mask:0xf
  v_smfmac_f32_16x16x64_bf16 v[20:23], v[120:123], v[100:107], v0
  s_add_u32 s26, s36, s23
  ds_read_b128 v[68:71], v4 offset:12288
  v_mov_b32_dpp v85, v117 row_ror:8 row_mask:0xf bank_mask:0xf
  v_smfmac_f32_16x16x64_bf16 v[24:27], v[120:123], v[108:115], v0
  s_add_u32 s36, s36, 8192
  ds_read_b128 v[72:75], v4 offset:13312
  v_mov_b32_dpp v86, v118 row_ror:8 row_mask:0xf bank_mask:0xf
  v_smfmac_f32_16x16x64_bf16 v[16:19], v[116:119], v[224:231], v0
  s_and_b32 s36, s36, 0x7fff
  ds_read_b128 v[76:79], v4 offset:14336
  v_mov_b32_dpp v87, v119 row_ror:8 row_mask:0xf bank_mask:0xf
  v_smfmac_f32_16x16x64_bf16 v[20:23], v[116:119], v[240:247], v0
  s_waitcnt lgkmcnt(3)
  s_barrier
  ds_read_b128 v[100:103], v2 offset:3072
  v_smfmac_f32_16x16x64_bf16 v[24:27], v[116:119], a[0:7], v0
  s_mov_b32 m0, s31
  ds_read_b128 v[120:123], v1 offset:3072
  v_smfmac_f32_16x16x64_bf16 v[16:19], v[84:87], v[232:239], v0
  s_cmp_ge_i32 s14, s30
  s_cbranch_scc1 T_kvw_111
T_kvb_112:
  v_smfmac_f32_16x16x64_bf16 v[20:23], v[84:87], v[248:255], v0
  ds_read_b128 v[80:83], v4 offset:15360
  v_smfmac_f32_16x16x64_bf16 v[24:27], v[84:87], a[8:15], v0
  s_waitcnt lgkmcnt(2)
  v_smfmac_f32_16x16x64_bf16 v[16:19], v[100:103], v[128:135], v0
  ds_read_b128 v[92:95], v2 offset:0
  buffer_load_dwordx4 v9, s[4:7], s27 offen sc1 lds
  v_smfmac_f32_16x16x64_bf16 v[20:23], v[100:103], v[144:151], v0
  ds_read_b128 v[96:99], v1 offset:0
  s_mov_b32 m0, s32
  v_smfmac_f32_16x16x64_bf16 v[24:27], v[100:103], v[68:75], v0
  s_waitcnt vmcnt(1) lgkmcnt(3)
  ds_read_b128 v[116:119], v2 offset:1024
  v_smfmac_f32_16x16x64_bf16 v[16:19], v[120:123], v[136:143], v0
  ds_read_b128 v[124:127], v1 offset:1024
  v_smfmac_f32_16x16x64_bf16 v[20:23], v[120:123], v[152:159], v0
  s_waitcnt lgkmcnt(4)
  ds_read_b128 v[104:107], v2 offset:7168
  buffer_load_dwordx4 v9, s[4:7], s27 offen offset:128 sc1 lds
  v_smfmac_f32_16x16x64_bf16 v[24:27], v[120:123], v[76:83], v0
  s_waitcnt lgkmcnt(4)
  ds_read_b128 v[108:111], v1 offset:7168
  s_mov_b32 m0, s33
  v_smfmac_f32_16x16x64_bf16 v[16:19], v[92:95], v[160:167], v0
  s_waitcnt lgkmcnt(4)
  ds_read_b128 v[112:115], v2 offset:4096
  v_smfmac_f32_16x16x64_bf16 v[16:19], v[96:99], v[168:175], v0
  s_waitcnt lgkmcnt(4)
  ds_read_b128 v[84:87], v1 offset:4096
  v_smfmac_f32_16x16x64_bf16 v[16:19], v[116:119], v[192:199], v0
  s_waitcnt lgkmcnt(4)
  ds_read_b128 v[88:91], v2 offset:5120
  buffer_load_dwordx4 v10, s[4:7], s28 offen sc1 lds
  v_smfmac_f32_16x16x64_bf16 v[16:19], v[124:127], v[200:207], v0
  s_waitcnt lgkmcnt(4)
  ds_read_b128 v[100:103], v1 offset:5120
  s_mov_b32 m0, s34
  v_smfmac_f32_16x16x64_bf16 v[16:19], v[104:107], a[16:23], v0
  s_waitcnt lgkmcnt(4)
  ds_read_b128 v[68:71], v4 offset:16384
  v_smfmac_f32_16x16x64_bf16 v[16:19], v[108:111], a[24:31], v0
  s_waitcnt lgkmcnt(4)
  ds_read_b128 v[72:75], v4 offset:17408
  v_smfmac_f32_16x16x64_bf16 v[16:19], v[112:115], a[64:71], v0
  s_waitcnt lgkmcnt(4)
  ds_read_b128 v[76:79], v4 offset:18432
  buffer_load_dwordx4 v10, s[4:7], s28 offen offset:256 sc1 lds
  v_smfmac_f32_16x16x64_bf16 v[16:19], v[84:87], a[72:79], v0
  s_waitcnt lgkmcnt(4)
  ds_read_b128 v[80:83], v4 offset:19456
  v_smfmac_f32_16x16x64_bf16 v[16:19], v[88:91], a[112:119], v0
  s_waitcnt lgkmcnt(4)
  v_smfmac_f32_16x16x64_bf16 v[16:19], v[100:103], a[120:127], v0
  s_add_u32 s24, s36, 145752064
  s_add_u32 s25, s36, 145756160
  v_smfmac_f32_16x16x64_bf16 v[20:23], v[92:95], v[176:183], v0
  s_add_u32 s35, s36, s23
  v_smfmac_f32_16x16x64_bf16 v[20:23], v[96:99], v[184:191], v0
  s_waitcnt lgkmcnt(2)
  v_smfmac_f32_16x16x64_bf16 v[20:23], v[116:119], v[68:75], v0
  s_waitcnt lgkmcnt(0)
  ds_read_b128 v[68:71], v4 offset:20480
  v_mul_f32 v16, s18, v16
  v_smfmac_f32_16x16x64_bf16 v[20:23], v[124:127], v[76:83], v0
  ds_read_b128 v[72:75], v4 offset:21504
  v_mul_f32 v17, s18, v17
  v_smfmac_f32_16x16x64_bf16 v[20:23], v[104:107], a[32:39], v0
  ds_read_b128 v[76:79], v4 offset:22528
  v_mul_f32 v18, s18, v18
  v_smfmac_f32_16x16x64_bf16 v[20:23], v[108:111], a[40:47], v0
  ds_read_b128 v[80:83], v4 offset:23552
  v_mul_f32 v19, s18, v19
  v_smfmac_f32_16x16x64_bf16 v[20:23], v[112:115], a[80:87], v0
  v_cvt_pk_bf16_f32 v120, v16, v17
  v_smfmac_f32_16x16x64_bf16 v[20:23], v[84:87], a[88:95], v0
  v_cvt_pk_bf16_f32 v121, v18, v19
  v_smfmac_f32_16x16x64_bf16 v[20:23], v[88:91], a[128:135], v0
  ds_write_b64 v5, v[120:121] offset:24576
  v_smfmac_f32_16x16x64_bf16 v[20:23], v[100:103], a[136:143], v0
  s_waitcnt lgkmcnt(3)
  v_smfmac_f32_16x16x64_bf16 v[24:27], v[92:95], v[68:75], v0
  s_waitcnt lgkmcnt(1)
  v_mov_b64 v[92:93], 0
  v_smfmac_f32_16x16x64_bf16 v[24:27], v[96:99], v[76:83], v0
  s_nop 1
  v_cvt_pk_bf16_f32 v122, v20, v21
  v_cvt_pk_bf16_f32 v123, v22, v23
  v_smfmac_f32_16x16x64_bf16 v[24:27], v[116:119], v[208:215], v0
  ds_write_b64 v5, v[122:123] offset:26880
  v_mov_b64 v[94:95], 0
  v_smfmac_f32_16x16x64_bf16 v[24:27], v[124:127], v[216:223], v0
  s_waitcnt lgkmcnt(1)
  s_barrier
  ds_read_b64_tr_b16 v[68:69], v6 offset:24576
  v_smfmac_f32_16x16x64_bf16 v[24:27], v[104:107], a[48:55], v0
  s_add_u32 s27, s27, 8192
  ds_read_b64_tr_b16 v[70:71], v6 offset:24640
  ds_read_b64_tr_b16 v[72:73], v6 offset:24832
  v_smfmac_f32_16x16x64_bf16 v[24:27], v[108:111], a[56:63], v0
  s_add_u32 s28, s28, 8192
  ds_read_b64_tr_b16 v[74:75], v6 offset:24896
  ds_read_b64_tr_b16 v[76:77], v6 offset:25088
  v_smfmac_f32_16x16x64_bf16 v[24:27], v[112:115], a[96:103], v0
  s_nop 0
  ds_read_b64_tr_b16 v[78:79], v6 offset:25152
  ds_read_b64_tr_b16 v[80:81], v6 offset:25344
  v_smfmac_f32_16x16x64_bf16 v[24:27], v[84:87], a[104:111], v0
  ds_read_b64_tr_b16 v[82:83], v6 offset:25408
  v_mov_b64 v[96:97], 0
  v_smfmac_f32_16x16x64_bf16 v[24:27], v[88:91], a[144:151], v0
  s_waitcnt lgkmcnt(8)
  s_barrier
  ds_read_b64_tr_b16 v[116:117], v6 offset:26880
  v_smfmac_f32_16x16x64_bf16 v[24:27], v[100:103], a[152:159], v0
  s_waitcnt lgkmcnt(7)
  ds_read_b64_tr_b16 v[118:119], v6 offset:26944
  buffer_store_dwordx2 v[122:123], v5, s[4:7], s29 offen sc1
  v_mfma_f32_16x16x32_bf16 v[16:19], v[36:39], v[68:71], 0
  s_waitcnt lgkmcnt(6)
  ds_read_b64_tr_b16 v[124:125], v6 offset:27136
  ds_read_b64_tr_b16 v[126:127], v6 offset:27200
  v_mfma_f32_16x16x32_bf16 v[16:19], v[40:43], v[72:75], v[16:19]
  s_waitcnt lgkmcnt(6)
  ds_read_b64_tr_b16 v[104:105], v6 offset:27392
  ds_read_b64_tr_b16 v[106:107], v6 offset:27456
  v_mfma_f32_16x16x32_bf16 v[16:19], v[44:47], v[76:79], v[16:19]
  s_waitcnt lgkmcnt(6)
  ds_read_b64_tr_b16 v[108:109], v6 offset:27648
  ds_read_b64_tr_b16 v[110:111], v6 offset:27712
  v_mfma_f32_16x16x32_bf16 v[16:19], v[48:51], v[80:83], v[16:19]
  s_waitcnt lgkmcnt(6)
  v_cvt_pk_bf16_f32 v120, v24, v25
  v_cvt_pk_bf16_f32 v121, v26, v27
  v_mov_b32 v86, s14
  v_mfma_f32_16x16x32_bf16 v[112:115], v[116:119], v[68:71], 0
  s_waitcnt lgkmcnt(4)
  buffer_store_dword v86, v3, s[4:7], s15 offen sc1
  buffer_store_dwordx2 v[120:121], v5, s[4:7], s29 offen offset:2304 sc1
  v_mov_b64 v[98:99], 0
  v_mfma_f32_16x16x32_bf16 v[112:115], v[124:127], v[72:75], v[112:115]
  s_waitcnt lgkmcnt(2)
  v_mov_b64 v[36:37], 0
  v_exp_f32 v100, v16
  v_mfma_f32_16x16x32_bf16 v[112:115], v[104:107], v[76:79], v[112:115]
  s_waitcnt lgkmcnt(0)
  v_exp_f32 v101, v17
  v_mfma_f32_16x16x32_bf16 v[112:115], v[108:111], v[80:83], v[112:115]
  s_add_u32 s29, s29, 147456
  v_exp_f32 v102, v18
  v_mfma_f32_16x16x32_bf16 v[20:23], v[52:55], v[68:71], 0
  s_cmp_eq_u32 s14, 63
  v_exp_f32 v103, v19
  v_mfma_f32_16x16x32_bf16 v[20:23], v[56:59], v[72:75], v[20:23]
  s_cbranch_scc1 M_tdone
  v_cvt_pk_bf16_f32 v44, v100, v101
  v_cvt_pk_bf16_f32 v45, v102, v103
  v_mfma_f32_16x16x32_bf16 v[20:23], v[60:63], v[76:79], v[20:23]
  v_exp_f32 v100, v112
  v_mfma_f32_16x16x32_bf16 v[20:23], v[64:67], v[80:83], v[20:23]
  v_exp_f32 v101, v113
  v_exp_f32 v102, v114
  v_exp_f32 v103, v115
  v_cvt_pk_bf16_f32 v84, v100, v101
  v_cvt_pk_bf16_f32 v85, v102, v103
  v_cndmask_b32 v48, v84, 0, s[16:17]
  v_cndmask_b32 v49, v85, 0, s[16:17]
  v_cndmask_b32 v50, 0, v84, s[16:17]
  v_cndmask_b32 v51, 0, v85, s[16:17]
  v_exp_f32 v100, v20
  v_mfma_f32_16x16x16_bf16 v[88:91], v[12:13], v[48:49], 0
  v_exp_f32 v101, v21
  v_mfma_f32_16x16x16_bf16 v[24:27], v[120:121], v[48:49], 0
  v_exp_f32 v102, v22
  v_mfma_f32_16x16x16_bf16 v[116:119], v[120:121], v[50:51], 0
  v_exp_f32 v103, v23
  v_cvt_pk_bf16_f32 v46, v100, v101
  v_cvt_pk_bf16_f32 v47, v102, v103
  v_mov_b64 v[38:39], 0
  s_nop 0
  v_mfma_f32_16x16x32_bf16 v[88:91], v[12:15], v[44:47], v[88:91]
  v_mov_b64 v[40:41], 0
  v_mov_b64 v[42:43], 0
  v_mfma_f32_16x16x32_bf16 v[24:27], v[28:31], v[44:47], v[24:27]
  ds_read_b128 v[52:55], v4 offset:24576
  ds_read_b128 v[56:59], v4 offset:25600
  v_mfma_f32_16x16x32_bf16 v[116:119], v[32:35], v[44:47], v[116:119]
  s_nop 1
  v_rcp_f32 v89, v88
  v_subrev_u32 v100, s54, v88
  v_cmp_le_u32 vcc, s55, v100
  v_mul_f32 v24, v89, v24
  v_mul_f32 v25, v89, v25
  s_cbranch_vccnz T_slow_113
T_back_114:
  v_cvt_pk_bf16_f32 v124, v24, v25
  v_pk_mul_f32 v[26:27], v[26:27], v[88:89] op_sel:[0,1] op_sel_hi:[1,1]
  v_pk_mul_f32 v[116:117], v[116:117], v[88:89] op_sel:[0,1] op_sel_hi:[1,1]
  v_pk_mul_f32 v[118:119], v[118:119], v[88:89] op_sel:[0,1] op_sel_hi:[1,1]
  v_cvt_pk_bf16_f32 v125, v26, v27
  v_cvt_pk_bf16_f32 v126, v116, v117
  v_cvt_pk_bf16_f32 v127, v118, v119
  ds_write_b128 v11, v[124:127] offset:30208
  s_nop 0
  v_smfmac_f32_16x16x64_bf16 v[92:95], v[124:127], a[160:167], v0
  v_smfmac_f32_16x16x64_bf16 v[96:99], v[124:127], a[168:175], v0
  v_smfmac_f32_16x16x64_bf16 v[36:39], v[124:127], a[176:183], v0
  v_smfmac_f32_16x16x64_bf16 v[40:43], v[124:127], a[184:191], v0
  s_waitcnt lgkmcnt(0)
  s_barrier
  ds_read_b128 v[104:107], v11 offset:30720
  ds_read_b128 v[108:111], v11 offset:29184
  ds_read_b128 v[68:71], v11 offset:29696
  s_waitcnt lgkmcnt(2)
  v_smfmac_f32_16x16x64_bf16 v[92:95], v[104:107], a[192:199], v0
  s_waitcnt lgkmcnt(1)
  ds_read_b128 v[76:79], v4 offset:28672
  v_smfmac_f32_16x16x64_bf16 v[92:95], v[108:111], a[224:231], v0
  s_waitcnt lgkmcnt(1)
  ds_read_b128 v[80:83], v4 offset:29696
  v_smfmac_f32_16x16x64_bf16 v[92:95], v[68:71], a[240:247], v0
  ds_read_b128 v[60:63], v4 offset:26624
  v_smfmac_f32_16x16x64_bf16 v[96:99], v[104:107], a[200:207], v0
  ds_read_b128 v[64:67], v4 offset:27648
  v_smfmac_f32_16x16x64_bf16 v[96:99], v[108:111], a[232:239], v0
  ds_read_b128 v[28:31], v4 offset:30720
  s_nop 0
  v_cvt_pk_bf16_f32 v16, v92, v93
  v_cvt_pk_bf16_f32 v17, v94, v95
  v_bfi_b32 v16, 1, s57, v16
  v_smfmac_f32_16x16x64_bf16 v[96:99], v[68:71], a[248:255], v0
  buffer_store_dwordx2 v[16:17], v7, s[4:7], s20 offen offset:0
  v_smfmac_f32_16x16x64_bf16 v[36:39], v[104:107], a[208:215], v0
  ds_read_b128 v[32:35], v4 offset:31744
  v_smfmac_f32_16x16x64_bf16 v[36:39], v[108:111], v[52:59], v0
  s_waitcnt lgkmcnt(4)
  s_nop 0
  v_cvt_pk_bf16_f32 v18, v96, v97
  v_cvt_pk_bf16_f32 v19, v98, v99
  v_bfi_b32 v18, 1, s57, v18
  v_smfmac_f32_16x16x64_bf16 v[36:39], v[68:71], v[76:83], v0
  buffer_store_dwordx2 v[18:19], v7, s[4:7], s20 offen offset:64
  v_smfmac_f32_16x16x64_bf16 v[40:43], v[104:107], a[216:223], v0
  s_waitcnt lgkmcnt(2)
  v_smfmac_f32_16x16x64_bf16 v[40:43], v[108:111], v[60:67], v0
  s_waitcnt lgkmcnt(0)
  s_nop 0
  v_cvt_pk_bf16_f32 v20, v36, v37
  v_cvt_pk_bf16_f32 v21, v38, v39
  v_bfi_b32 v20, 1, s57, v20
  v_smfmac_f32_16x16x64_bf16 v[40:43], v[68:71], v[28:35], v0
  buffer_store_dwordx2 v[20:21], v7, s[4:7], s21 offen offset:0
  s_nop 6
  v_cvt_pk_bf16_f32 v22, v40, v41
  v_cvt_pk_bf16_f32 v23, v42, v43
  v_bfi_b32 v22, 1, s57, v22
  buffer_store_dwordx2 v[22:23], v7, s[4:7], s21 offen offset:64
  ds_read_b128 v[68:71], v4 offset:0
  ds_read_b128 v[72:75], v4 offset:1024
  ds_read_b128 v[76:79], v4 offset:4096
  ds_read_b128 v[80:83], v4 offset:5120
  ds_read_b128 v[84:87], v4 offset:8192
  ds_read_b128 v[88:91], v4 offset:9216
  ds_read_b128 v[92:95], v4 offset:2048
  ds_read_b128 v[96:99], v4 offset:3072
  ds_read_b128 v[100:103], v4 offset:6144
  ds_read_b128 v[104:107], v4 offset:7168
  ds_read_b128 v[108:111], v4 offset:10240
  ds_read_b128 v[112:115], v4 offset:11264
  v_mov_b64 v[16:17], 0
  v_mov_b64 v[18:19], 0
  v_mov_b64 v[20:21], 0
  v_mov_b64 v[22:23], 0
  v_mov_b64 v[24:25], 0
  v_mov_b64 v[26:27], 0
  ds_read_b64 v[44:45], v2 offset:32256
  s_waitcnt lgkmcnt(0)
  v_readfirstlane_b32 s38, v44
  v_readfirstlane_b32 s37, v45
  s_nop 0
  s_add_u32 s37, s37, 30
  s_cmp_ge_u32 s38, 30
  s_cselect_b32 s38, s37, s38
  s_cmp_ge_u32 s38, 64
  s_cselect_b32 s38, 100, s38
  s_sub_u32 s38, s38, 1
  s_max_i32 s30, s30, s38
  s_waitcnt vmcnt(4)
  s_barrier
  ds_read_b128 v[28:31], v2 offset:18432
  ds_read_b128 v[32:35], v2 offset:22528
  ds_read_b128 v[36:39], v2 offset:8192
  ds_read_b128 v[40:43], v2 offset:9216
  ds_read_b128 v[44:47], v2 offset:10240
  ds_read_b128 v[48:51], v2 offset:11264
  buffer_load_dwordx4 v[124:127], v2, s[4:7], s24 offen offset:2048 sc1
  buffer_load_dwordx4 v[116:119], v2, s[4:7], s25 offen offset:2048 sc1
  ds_read_b128 v[52:55], v2 offset:12288
  ds_read_b128 v[56:59], v2 offset:13312
  ds_read_b128 v[60:63], v2 offset:14336
  ds_read_b128 v[64:67], v2 offset:15360
  buffer_load_dwordx4 v[124:127], v2, s[4:7], s24 offen offset:2048 sc1
  buffer_load_dwordx4 v[116:119], v2, s[4:7], s25 offen offset:2048 sc1
  s_mov_b32 s19, 0
  s_branch T_loop_107
T_kvw_111:
  s_mov_b32 s19, 0
  s_branch T_kvok_119
T_kv_118:
  s_sleep 4
  s_add_u32 s19, s19, 1
  s_cmp_gt_u32 s19, 32768
  s_cbranch_scc1 M_exit
T_kvok_119:
  s_add_u32 s39, s99, 128
  s_mov_b32 s38, 0
  s_mov_b32 s37, 0
  s_atomic_or s38, s[58:59], s99 glc
  s_atomic_or s37, s[58:59], s39 glc
  s_waitcnt lgkmcnt(0)
  s_add_u32 s37, s37, 30
  s_cmp_ge_u32 s38, 30
  s_cselect_b32 s38, s37, s38
  s_cmp_ge_u32 s38, 64
  s_cselect_b32 s38, 100, s38
  s_sub_u32 s38, s38, 1
  s_max_i32 s30, s30, s38
  s_cmp_ge_i32 s14, s30
  s_cbranch_scc1 T_kv_118
  s_branch T_kvb_112
T_slow_113:
  s_nop 7
  v_max3_f32 v100, v16, v17, v18
  v_max3_f32 v100, v100, v19, v20
  v_max3_f32 v100, v100, v21, v22
  v_max3_f32 v100, v100, v23, v112
  v_max3_f32 v100, v100, v113, v114
  v_max_f32 v100, v100, v115
  v_mov_b32 v101, v100
  s_nop 1
  v_permlane32_swap_b32 v100, v101
  s_nop 1
  v_max_f32 v100, v100, v101
  v_mov_b32 v101, v100
  s_nop 1
  v_permlane16_swap_b32 v100, v101
  s_nop 1
  v_max_f32 v100, v100, v101
  v_sub_f32 v16, v16, v100
  v_sub_f32 v17, v17, v100
  v_sub_f32 v18, v18, v100
  v_sub_f32 v19, v19, v100
  v_exp_f32 v16, v16
  v_exp_f32 v17, v17
  v_exp_f32 v18, v18
  v_exp_f32 v19, v19
  v_sub_f32 v20, v20, v100
  v_sub_f32 v21, v21, v100
  v_sub_f32 v22, v22, v100
  v_sub_f32 v23, v23, v100
  v_exp_f32 v20, v20
  v_exp_f32 v21, v21
  v_exp_f32 v22, v22
  v_exp_f32 v23, v23
  v_sub_f32 v112, v112, v100
  v_sub_f32 v113, v113, v100
  v_sub_f32 v114, v114, v100
  v_sub_f32 v115, v115, v100
  v_exp_f32 v112, v112
  v_exp_f32 v113, v113
  v_exp_f32 v114, v114
  v_exp_f32 v115, v115
  s_nop 0
  v_cvt_pk_bf16_f32 v44, v16, v17
  v_cvt_pk_bf16_f32 v45, v18, v19
  v_cvt_pk_bf16_f32 v46, v20, v21
  v_cvt_pk_bf16_f32 v47, v22, v23
  v_cvt_pk_bf16_f32 v84, v112, v113
  v_cvt_pk_bf16_f32 v85, v114, v115
  v_cndmask_b32 v48, v84, 0, s[16:17]
  v_cndmask_b32 v49, v85, 0, s[16:17]
  v_cndmask_b32 v50, 0, v84, s[16:17]
  v_cndmask_b32 v51, 0, v85, s[16:17]
  s_nop 1
  v_mfma_f32_16x16x16_bf16 v[88:91], v[12:13], v[48:49], 0
  v_mfma_f32_16x16x16_bf16 v[24:27], v[120:121], v[48:49], 0
  v_mfma_f32_16x16x16_bf16 v[116:119], v[120:121], v[50:51], 0
  v_mfma_f32_16x16x32_bf16 v[88:91], v[12:15], v[44:47], v[88:91]
  v_mfma_f32_16x16x32_bf16 v[24:27], v[28:31], v[44:47], v[24:27]
  v_mfma_f32_16x16x32_bf16 v[116:119], v[32:35], v[44:47], v[116:119]
  s_nop 7
  s_nop 1
  v_rcp_f32 v89, v88
  s_nop 0
  v_mul_f32 v24, v89, v24
  v_mul_f32 v25, v89, v25
  s_branch T_back_114
T_w_80:
  s_mov_b32 s19, 0
  v_mov_b64 v[16:17], 0
  v_mov_b64 v[18:19], 0
  v_mov_b64 v[20:21], 0
  v_mov_b64 v[22:23], 0
  v_mov_b64 v[24:25], 0
  v_mov_b64 v[26:27], 0
  buffer_load_dwordx4 v[124:127], v2, s[4:7], s24 offen offset:3072 sc1
  buffer_load_dwordx4 v[116:119], v2, s[4:7], s25 offen offset:3072 sc1
  buffer_load_dwordx4 v[124:127], v2, s[4:7], s24 offen offset:3072 sc1
  buffer_load_dwordx4 v[116:119], v2, s[4:7], s25 offen offset:3072 sc1
  s_branch T_loop_120
.p2align 6
T_retry_121:
  s_mov_b64 exec, vcc
  buffer_load_dwordx4 v[124:127], v2, s[4:7], s24 offen offset:3072 sc1
  buffer_load_dwordx4 v[116:119], v2, s[4:7], s25 offen offset:3072 sc1
  s_mov_b64 exec, -1
  s_add_u32 s19, s19, 1
  s_cmp_gt_u32 s19, 32768
  s_cbranch_scc1 M_exit
T_loop_120:
  s_waitcnt vmcnt(3) lgkmcnt(0)
  v_max3_u32 v123, v124, v125, v126
  v_max_u32 v123, v123, v127
  v_mov_b32_dpp v120, v124 row_ror:8 row_mask:0xf bank_mask:0xf
  v_mov_b32_dpp v121, v125 row_ror:8 row_mask:0xf bank_mask:0xf
  s_waitcnt vmcnt(2)
  v_max3_u32 v123, v123, v116, v117
  v_max3_u32 v123, v123, v118, v119
  v_cmp_eq_u32 vcc, -1, v123
  s_cbranch_vccnz T_retry_121
  v_smfmac_f32_16x16x64_bf16 v[16:19], v[124:127], v[68:75], v0
  s_add_u32 s14, s14, 1
  ds_write_b128 v2, v[124:127] offset:3072
  v_mov_b32_dpp v122, v126 row_ror:8 row_mask:0xf bank_mask:0xf
  v_smfmac_f32_16x16x64_bf16 v[20:23], v[124:127], v[76:83], v0
  s_and_b32 s57, s14, 1
  v_mov_b32_dpp v123, v127 row_ror:8 row_mask:0xf bank_mask:0xf
  v_smfmac_f32_16x16x64_bf16 v[24:27], v[124:127], v[84:91], v0
  s_and_b32 s36, s14, 3
  ds_write_b128 v2, v[116:119] offset:7168
  v_smfmac_f32_16x16x64_bf16 v[16:19], v[120:123], v[92:99], v0
  s_lshl_b32 s36, s36, 13
  v_mov_b32_dpp v84, v116 row_ror:8 row_mask:0xf bank_mask:0xf
  v_smfmac_f32_16x16x64_bf16 v[20:23], v[120:123], v[100:107], v0
  s_add_u32 s26, s36, s23
  ds_read_b128 v[68:71], v4 offset:12288
  v_mov_b32_dpp v85, v117 row_ror:8 row_mask:0xf bank_mask:0xf
  v_smfmac_f32_16x16x64_bf16 v[24:27], v[120:123], v[108:115], v0
  s_add_u32 s36, s36, 8192
  ds_read_b128 v[72:75], v4 offset:13312
  v_mov_b32_dpp v86, v118 row_ror:8 row_mask:0xf bank_mask:0xf
  v_smfmac_f32_16x16x64_bf16 v[16:19], v[116:119], v[224:231], v0
  s_and_b32 s36, s36, 0x7fff
  ds_read_b128 v[76:79], v4 offset:14336
  v_mov_b32_dpp v87, v119 row_ror:8 row_mask:0xf bank_mask:0xf
  v_smfmac_f32_16x16x64_bf16 v[20:23], v[116:119], v[240:247], v0
  s_waitcnt lgkmcnt(3)
  s_barrier
  ds_read_b128 v[100:103], v2 offset:2048
  v_smfmac_f32_16x16x64_bf16 v[24:27], v[116:119], a[0:7], v0
  s_mov_b32 m0, s31
  ds_read_b128 v[120:123], v1 offset:2048
  v_smfmac_f32_16x16x64_bf16 v[16:19], v[84:87], v[232:239], v0
  s_cmp_ge_i32 s14, s30
  s_cbranch_scc1 T_kvw_124
T_kvb_125:
  v_smfmac_f32_16x16x64_bf16 v[20:23], v[84:87], v[248:255], v0
  ds_read_b128 v[80:83], v4 offset:15360
  v_smfmac_f32_16x16x64_bf16 v[24:27], v[84:87], a[8:15], v0
  s_waitcnt lgkmcnt(2)
  v_smfmac_f32_16x16x64_bf16 v[16:19], v[100:103], v[128:135], v0
  ds_read_b128 v[92:95], v2 offset:1024
  v_smfmac_f32_16x16x64_bf16 v[20:23], v[100:103], v[144:151], v0
  ds_read_b128 v[96:99], v1 offset:1024
  buffer_load_dwordx4 v9, s[4:7], s27 offen sc1 lds
  v_smfmac_f32_16x16x64_bf16 v[24:27], v[100:103], v[68:75], v0
  s_waitcnt vmcnt(1) lgkmcnt(3)
  ds_read_b128 v[116:119], v2 offset:0
  s_mov_b32 m0, s32
  v_smfmac_f32_16x16x64_bf16 v[16:19], v[120:123], v[136:143], v0
  ds_read_b128 v[124:127], v1 offset:0
  v_smfmac_f32_16x16x64_bf16 v[20:23], v[120:123], v[152:159], v0
  s_waitcnt lgkmcnt(4)
  ds_read_b128 v[104:107], v2 offset:6144
  v_smfmac_f32_16x16x64_bf16 v[24:27], v[120:123], v[76:83], v0
  s_waitcnt lgkmcnt(4)
  ds_read_b128 v[108:111], v1 offset:6144
  buffer_load_dwordx4 v9, s[4:7], s27 offen offset:128 sc1 lds
  v_smfmac_f32_16x16x64_bf16 v[16:19], v[92:95], v[160:167], v0
  s_waitcnt lgkmcnt(4)
  ds_read_b128 v[112:115], v2 offset:5120
  s_mov_b32 m0, s33
  v_smfmac_f32_16x16x64_bf16 v[16:19], v[96:99], v[168:175], v0
  s_waitcnt lgkmcnt(4)
  ds_read_b128 v[84:87], v1 offset:5120
  v_smfmac_f32_16x16x64_bf16 v[16:19], v[116:119], v[192:199], v0
  s_waitcnt lgkmcnt(4)
  ds_read_b128 v[88:91], v2 offset:4096
  v_smfmac_f32_16x16x64_bf16 v[16:19], v[124:127], v[200:207], v0
  s_waitcnt lgkmcnt(4)
  ds_read_b128 v[100:103], v1 offset:4096
  buffer_load_dwordx4 v10, s[4:7], s28 offen sc1 lds
  v_smfmac_f32_16x16x64_bf16 v[16:19], v[104:107], a[16:23], v0
  s_waitcnt lgkmcnt(4)
  ds_read_b128 v[68:71], v4 offset:16384
  s_mov_b32 m0, s34
  v_smfmac_f32_16x16x64_bf16 v[16:19], v[108:111], a[24:31], v0
  s_waitcnt lgkmcnt(4)
  ds_read_b128 v[72:75], v4 offset:17408
  v_smfmac_f32_16x16x64_bf16 v[16:19], v[112:115], a[64:71], v0
  s_waitcnt lgkmcnt(4)
  ds_read_b128 v[76:79], v4 offset:18432
  v_smfmac_f32_16x16x64_bf16 v[16:19], v[84:87], a[72:79], v0
  s_waitcnt lgkmcnt(4)
  ds_read_b128 v[80:83], v4 offset:19456
  buffer_load_dwordx4 v10, s[4:7], s28 offen offset:256 sc1 lds
  v_smfmac_f32_16x16x64_bf16 v[16:19], v[88:91], a[112:119], v0
  s_waitcnt lgkmcnt(4)
  v_smfmac_f32_16x16x64_bf16 v[16:19], v[100:103], a[120:127], v0
  s_add_u32 s24, s36, 145752064
  s_add_u32 s25, s36, 145756160
  v_smfmac_f32_16x16x64_bf16 v[20:23], v[92:95], v[176:183], v0
  s_add_u32 s35, s36, s23
  v_smfmac_f32_16x16x64_bf16 v[20:23], v[96:99], v[184:191], v0
  s_waitcnt lgkmcnt(2)
  v_smfmac_f32_16x16x64_bf16 v[20:23], v[116:119], v[68:75], v0
  s_waitcnt lgkmcnt(0)
  ds_read_b128 v[68:71], v4 offset:20480
  v_mul_f32 v16, s18, v16
  v_smfmac_f32_16x16x64_bf16 v[20:23], v[124:127], v[76:83], v0
  ds_read_b128 v[72:75], v4 offset:21504
  v_mul_f32 v17, s18, v17
  v_smfmac_f32_16x16x64_bf16 v[20:23], v[104:107], a[32:39], v0
  ds_read_b128 v[76:79], v4 offset:22528
  v_mul_f32 v18, s18, v18
  v_smfmac_f32_16x16x64_bf16 v[20:23], v[108:111], a[40:47], v0
  ds_read_b128 v[80:83], v4 offset:23552
  v_mul_f32 v19, s18, v19
  v_smfmac_f32_16x16x64_bf16 v[20:23], v[112:115], a[80:87], v0
  v_cvt_pk_bf16_f32 v120, v16, v17
  v_smfmac_f32_16x16x64_bf16 v[20:23], v[84:87], a[88:95], v0
  v_cvt_pk_bf16_f32 v121, v18, v19
  v_smfmac_f32_16x16x64_bf16 v[20:23], v[88:91], a[128:135], v0
  ds_write_b64 v5, v[120:121] offset:24576
  v_smfmac_f32_16x16x64_bf16 v[20:23], v[100:103], a[136:143], v0
  s_waitcnt lgkmcnt(3)
  v_smfmac_f32_16x16x64_bf16 v[24:27], v[92:95], v[68:75], v0
  s_waitcnt lgkmcnt(1)
  v_mov_b64 v[92:93], 0
  v_smfmac_f32_16x16x64_bf16 v[24:27], v[96:99], v[76:83], v0
  s_nop 1
  v_cvt_pk_bf16_f32 v122, v20, v21
  v_cvt_pk_bf16_f32 v123, v22, v23
  v_smfmac_f32_16x16x64_bf16 v[24:27], v[116:119], v[208:215], v0
  ds_write_b64 v5, v[122:123] offset:26880
  v_mov_b64 v[94:95], 0
  v_smfmac_f32_16x16x64_bf16 v[24:27], v[124:127], v[216:223], v0
  s_waitcnt lgkmcnt(1)
  s_barrier
  ds_read_b64_tr_b16 v[68:69], v6 offset:24576
  v_smfmac_f32_16x16x64_bf16 v[24:27], v[104:107], a[48:55], v0
  s_add_u32 s27, s27, 8192
  ds_read_b64_tr_b16 v[70:71], v6 offset:24640
  ds_read_b64_tr_b16 v[72:73], v6 offset:24832
  v_smfmac_f32_16x16x64_bf16 v[24:27], v[108:111], a[56:63], v0
  s_add_u32 s28, s28, 8192
  ds_read_b64_tr_b16 v[74:75], v6 offset:24896
  ds_read_b64_tr_b16 v[76:77], v6 offset:25088
  v_smfmac_f32_16x16x64_bf16 v[24:27], v[112:115], a[96:103], v0
  s_nop 0
  ds_read_b64_tr_b16 v[78:79], v6 offset:25152
  ds_read_b64_tr_b16 v[80:81], v6 offset:25344
  v_smfmac_f32_16x16x64_bf16 v[24:27], v[84:87], a[104:111], v0
  ds_read_b64_tr_b16 v[82:83], v6 offset:25408
  v_mov_b64 v[96:97], 0
  v_smfmac_f32_16x16x64_bf16 v[24:27], v[88:91], a[144:151], v0
  s_waitcnt lgkmcnt(8)
  s_barrier
  ds_read_b64_tr_b16 v[116:117], v6 offset:26880
  v_smfmac_f32_16x16x64_bf16 v[24:27], v[100:103], a[152:159], v0
  s_waitcnt lgkmcnt(7)
  ds_read_b64_tr_b16 v[118:119], v6 offset:26944
  buffer_store_dwordx2 v[122:123], v5, s[4:7], s29 offen sc1
  v_mfma_f32_16x16x32_bf16 v[16:19], v[36:39], v[68:71], 0
  s_waitcnt lgkmcnt(6)
  ds_read_b64_tr_b16 v[124:125], v6 offset:27136
  ds_read_b64_tr_b16 v[126:127], v6 offset:27200
  v_mfma_f32_16x16x32_bf16 v[16:19], v[40:43], v[72:75], v[16:19]
  s_waitcnt lgkmcnt(6)
  ds_read_b64_tr_b16 v[104:105], v6 offset:27392
  ds_read_b64_tr_b16 v[106:107], v6 offset:27456
  v_mfma_f32_16x16x32_bf16 v[16:19], v[44:47], v[76:79], v[16:19]
  s_waitcnt lgkmcnt(6)
  ds_read_b64_tr_b16 v[108:109], v6 offset:27648
  ds_read_b64_tr_b16 v[110:111], v6 offset:27712
  v_mfma_f32_16x16x32_bf16 v[16:19], v[48:51], v[80:83], v[16:19]
  s_waitcnt lgkmcnt(6)
  s_mov_b32 m0, 32256
  v_cvt_pk_bf16_f32 v120, v24, v25
  v_cvt_pk_bf16_f32 v121, v26, v27
  v_mfma_f32_16x16x32_bf16 v[112:115], v[116:119], v[68:71], 0
  s_waitcnt lgkmcnt(4)
  buffer_load_dword v3, s[4:7], s99 offen sc1 lds
  buffer_store_dwordx2 v[120:121], v5, s[4:7], s29 offen offset:2304 sc1
  v_mov_b64 v[98:99], 0
  v_mfma_f32_16x16x32_bf16 v[112:115], v[124:127], v[72:75], v[112:115]
  s_waitcnt lgkmcnt(2)
  v_mov_b64 v[36:37], 0
  v_exp_f32 v100, v16
  v_mfma_f32_16x16x32_bf16 v[112:115], v[104:107], v[76:79], v[112:115]
  s_waitcnt lgkmcnt(0)
  v_exp_f32 v101, v17
  v_mfma_f32_16x16x32_bf16 v[112:115], v[108:111], v[80:83], v[112:115]
  s_add_u32 s29, s29, 147456
  v_exp_f32 v102, v18
  v_mfma_f32_16x16x32_bf16 v[20:23], v[52:55], v[68:71], 0
  s_cmp_eq_u32 s14, 63
  v_exp_f32 v103, v19
  v_mfma_f32_16x16x32_bf16 v[20:23], v[56:59], v[72:75], v[20:23]
  s_cbranch_scc1 M_tdone
  v_cvt_pk_bf16_f32 v44, v100, v101
  v_cvt_pk_bf16_f32 v45, v102, v103
  v_mfma_f32_16x16x32_bf16 v[20:23], v[60:63], v[76:79], v[20:23]
  v_exp_f32 v100, v112
  v_mfma_f32_16x16x32_bf16 v[20:23], v[64:67], v[80:83], v[20:23]
  v_exp_f32 v101, v113
  v_exp_f32 v102, v114
  v_exp_f32 v103, v115
  v_cvt_pk_bf16_f32 v84, v100, v101
  v_cvt_pk_bf16_f32 v85, v102, v103
  v_cndmask_b32 v48, v84, 0, s[16:17]
  v_cndmask_b32 v49, v85, 0, s[16:17]
  v_cndmask_b32 v50, 0, v84, s[16:17]
  v_cndmask_b32 v51, 0, v85, s[16:17]
  v_exp_f32 v100, v20
  v_mfma_f32_16x16x16_bf16 v[88:91], v[12:13], v[48:49], 0
  v_exp_f32 v101, v21
  v_mfma_f32_16x16x16_bf16 v[24:27], v[120:121], v[48:49], 0
  v_exp_f32 v102, v22
  v_mfma_f32_16x16x16_bf16 v[116:119], v[120:121], v[50:51], 0
  v_exp_f32 v103, v23
  v_cvt_pk_bf16_f32 v46, v100, v101
  v_cvt_pk_bf16_f32 v47, v102, v103
  v_mov_b64 v[38:39], 0
  s_nop 0
  v_mfma_f32_16x16x32_bf16 v[88:91], v[12:15], v[44:47], v[88:91]
  v_mov_b64 v[40:41], 0
  v_mov_b64 v[42:43], 0
  v_mfma_f32_16x16x32_bf16 v[24:27], v[28:31], v[44:47], v[24:27]
  ds_read_b128 v[52:55], v4 offset:24576
  ds_read_b128 v[56:59], v4 offset:25600
  v_mfma_f32_16x16x32_bf16 v[116:119], v[32:35], v[44:47], v[116:119]
  s_nop 1
  v_rcp_f32 v89, v88
  v_subrev_u32 v100, s54, v88
  v_cmp_le_u32 vcc, s55, v100
  v_mul_f32 v24, v89, v24
  v_mul_f32 v25, v89, v25
  s_cbranch_vccnz T_slow_126
T_back_127:
  v_cvt_pk_bf16_f32 v124, v24, v25
  v_pk_mul_f32 v[26:27], v[26:27], v[88:89] op_sel:[0,1] op_sel_hi:[1,1]
  v_pk_mul_f32 v[116:117], v[116:117], v[88:89] op_sel:[0,1] op_sel_hi:[1,1]
  v_pk_mul_f32 v[118:119], v[118:119], v[88:89] op_sel:[0,1] op_sel_hi:[1,1]
  v_cvt_pk_bf16_f32 v125, v26, v27
  v_cvt_pk_bf16_f32 v126, v116, v117
  v_cvt_pk_bf16_f32 v127, v118, v119
  ds_write_b128 v11, v[124:127] offset:30720
  s_nop 0
  v_smfmac_f32_16x16x64_bf16 v[92:95], v[124:127], a[160:167], v0
  v_smfmac_f32_16x16x64_bf16 v[96:99], v[124:127], a[168:175], v0
  v_smfmac_f32_16x16x64_bf16 v[36:39], v[124:127], a[176:183], v0
  v_smfmac_f32_16x16x64_bf16 v[40:43], v[124:127], a[184:191], v0
  s_waitcnt lgkmcnt(0)
  s_barrier
  ds_read_b128 v[104:107], v11 offset:30208
  ds_read_b128 v[108:111], v11 offset:29696
  ds_read_b128 v[68:71], v11 offset:29184
  s_waitcnt lgkmcnt(2)
  v_smfmac_f32_16x16x64_bf16 v[92:95], v[104:107], a[192:199], v0
  s_waitcnt lgkmcnt(1)
  ds_read_b128 v[76:79], v4 offset:28672
  v_smfmac_f32_16x16x64_bf16 v[92:95], v[108:111], a[224:231], v0
  s_waitcnt lgkmcnt(1)
  ds_read_b128 v[80:83], v4 offset:29696
  v_smfmac_f32_16x16x64_bf16 v[92:95], v[68:71], a[240:247], v0
  ds_read_b128 v[60:63], v4 offset:26624
  v_smfmac_f32_16x16x64_bf16 v[96:99], v[104:107], a[200:207], v0
  ds_read_b128 v[64:67], v4 offset:27648
  v_smfmac_f32_16x16x64_bf16 v[96:99], v[108:111], a[232:239], v0
  ds_read_b128 v[28:31], v4 offset:30720
  s_nop 0
  v_cvt_pk_bf16_f32 v16, v92, v93
  v_cvt_pk_bf16_f32 v17, v94, v95
  v_bfi_b32 v16, 1, s57, v16
  v_smfmac_f32_16x16x64_bf16 v[96:99], v[68:71], a[248:255], v0
  buffer_store_dwordx2 v[16:17], v7, s[4:7], s20 offen offset:0
  v_smfmac_f32_16x16x64_bf16 v[36:39], v[104:107], a[208:215], v0
  ds_read_b128 v[32:35], v4 offset:31744
  v_smfmac_f32_16x16x64_bf16 v[36:39], v[108:111], v[52:59], v0
  s_waitcnt lgkmcnt(4)
  s_nop 0
  v_cvt_pk_bf16_f32 v18, v96, v97
  v_cvt_pk_bf16_f32 v19, v98, v99
  v_bfi_b32 v18, 1, s57, v18
  v_smfmac_f32_16x16x64_bf16 v[36:39], v[68:71], v[76:83], v0
  buffer_store_dwordx2 v[18:19], v7, s[4:7], s20 offen offset:64
  v_smfmac_f32_16x16x64_bf16 v[40:43], v[104:107], a[216:223], v0
  s_waitcnt lgkmcnt(2)
  v_smfmac_f32_16x16x64_bf16 v[40:43], v[108:111], v[60:67], v0
  s_waitcnt lgkmcnt(0)
  s_nop 0
  v_cvt_pk_bf16_f32 v20, v36, v37
  v_cvt_pk_bf16_f32 v21, v38, v39
  v_bfi_b32 v20, 1, s57, v20
  v_smfmac_f32_16x16x64_bf16 v[40:43], v[68:71], v[28:35], v0
  buffer_store_dwordx2 v[20:21], v7, s[4:7], s21 offen offset:0
  s_nop 6
  v_cvt_pk_bf16_f32 v22, v40, v41
  v_cvt_pk_bf16_f32 v23, v42, v43
  v_bfi_b32 v22, 1, s57, v22
  buffer_store_dwordx2 v[22:23], v7, s[4:7], s21 offen offset:64
  ds_read_b128 v[68:71], v4 offset:0
  ds_read_b128 v[72:75], v4 offset:1024
  ds_read_b128 v[76:79], v4 offset:4096
  ds_read_b128 v[80:83], v4 offset:5120
  ds_read_b128 v[84:87], v4 offset:8192
  ds_read_b128 v[88:91], v4 offset:9216
  ds_read_b128 v[92:95], v4 offset:2048
  ds_read_b128 v[96:99], v4 offset:3072
  ds_read_b128 v[100:103], v4 offset:6144
  ds_read_b128 v[104:107], v4 offset:7168
  ds_read_b128 v[108:111], v4 offset:10240
  ds_read_b128 v[112:115], v4 offset:11264
  v_mov_b64 v[16:17], 0
  v_mov_b64 v[18:19], 0
  v_mov_b64 v[20:21], 0
  v_mov_b64 v[22:23], 0
  v_mov_b64 v[24:25], 0
  v_mov_b64 v[26:27], 0
  ds_read_b64 v[44:45], v2 offset:32256
  s_waitcnt lgkmcnt(0)
  v_readfirstlane_b32 s38, v44
  v_readfirstlane_b32 s37, v45
  s_nop 0
  s_add_u32 s37, s37, 30
  s_cmp_ge_u32 s38, 30
  s_cselect_b32 s38, s37, s38
  s_cmp_ge_u32 s38, 64
  s_cselect_b32 s38, 100, s38
  s_sub_u32 s38, s38, 1
  s_max_i32 s30, s30, s38
  s_waitcnt vmcnt(4)
  s_barrier
  ds_read_b128 v[28:31], v2 offset:19456
  ds_read_b128 v[32:35], v2 offset:23552
  ds_read_b128 v[36:39], v2 offset:8192
  ds_read_b128 v[40:43], v2 offset:9216
  ds_read_b128 v[44:47], v2 offset:10240
  ds_read_b128 v[48:51], v2 offset:11264
  buffer_load_dwordx4 v[124:127], v2, s[4:7], s24 offen offset:3072 sc1
  buffer_load_dwordx4 v[116:119], v2, s[4:7], s25 offen offset:3072 sc1
  ds_read_b128 v[52:55], v2 offset:12288
  ds_read_b128 v[56:59], v2 offset:13312
  ds_read_b128 v[60:63], v2 offset:14336
  ds_read_b128 v[64:67], v2 offset:15360
  buffer_load_dwordx4 v[124:127], v2, s[4:7], s24 offen offset:3072 sc1
  buffer_load_dwordx4 v[116:119], v2, s[4:7], s25 offen offset:3072 sc1
  s_mov_b32 s19, 0
  s_branch T_loop_120
T_kvw_124:
  s_mov_b32 s19, 0
  s_branch T_kvok_132
T_kv_131:
  s_sleep 4
  s_add_u32 s19, s19, 1
  s_cmp_gt_u32 s19, 32768
  s_cbranch_scc1 M_exit
T_kvok_132:
  s_add_u32 s39, s99, 128
  s_mov_b32 s38, 0
  s_mov_b32 s37, 0
  s_atomic_or s38, s[58:59], s99 glc
  s_atomic_or s37, s[58:59], s39 glc
  s_waitcnt lgkmcnt(0)
  s_add_u32 s37, s37, 30
  s_cmp_ge_u32 s38, 30
  s_cselect_b32 s38, s37, s38
  s_cmp_ge_u32 s38, 64
  s_cselect_b32 s38, 100, s38
  s_sub_u32 s38, s38, 1
  s_max_i32 s30, s30, s38
  s_cmp_ge_i32 s14, s30
  s_cbranch_scc1 T_kv_131
  s_branch T_kvb_125
T_slow_126:
  s_nop 7
  v_max3_f32 v100, v16, v17, v18
  v_max3_f32 v100, v100, v19, v20
  v_max3_f32 v100, v100, v21, v22
  v_max3_f32 v100, v100, v23, v112
  v_max3_f32 v100, v100, v113, v114
  v_max_f32 v100, v100, v115
  v_mov_b32 v101, v100
  s_nop 1
  v_permlane32_swap_b32 v100, v101
  s_nop 1
  v_max_f32 v100, v100, v101
  v_mov_b32 v101, v100
  s_nop 1
  v_permlane16_swap_b32 v100, v101
  s_nop 1
  v_max_f32 v100, v100, v101
  v_sub_f32 v16, v16, v100
  v_sub_f32 v17, v17, v100
  v_sub_f32 v18, v18, v100
  v_sub_f32 v19, v19, v100
  v_exp_f32 v16, v16
  v_exp_f32 v17, v17
  v_exp_f32 v18, v18
  v_exp_f32 v19, v19
  v_sub_f32 v20, v20, v100
  v_sub_f32 v21, v21, v100
  v_sub_f32 v22, v22, v100
  v_sub_f32 v23, v23, v100
  v_exp_f32 v20, v20
  v_exp_f32 v21, v21
  v_exp_f32 v22, v22
  v_exp_f32 v23, v23
  v_sub_f32 v112, v112, v100
  v_sub_f32 v113, v113, v100
  v_sub_f32 v114, v114, v100
  v_sub_f32 v115, v115, v100
  v_exp_f32 v112, v112
  v_exp_f32 v113, v113
  v_exp_f32 v114, v114
  v_exp_f32 v115, v115
  s_nop 0
  v_cvt_pk_bf16_f32 v44, v16, v17
  v_cvt_pk_bf16_f32 v45, v18, v19
  v_cvt_pk_bf16_f32 v46, v20, v21
  v_cvt_pk_bf16_f32 v47, v22, v23
  v_cvt_pk_bf16_f32 v84, v112, v113
  v_cvt_pk_bf16_f32 v85, v114, v115
  v_cndmask_b32 v48, v84, 0, s[16:17]
  v_cndmask_b32 v49, v85, 0, s[16:17]
  v_cndmask_b32 v50, 0, v84, s[16:17]
  v_cndmask_b32 v51, 0, v85, s[16:17]
  s_nop 1
  v_mfma_f32_16x16x16_bf16 v[88:91], v[12:13], v[48:49], 0
  v_mfma_f32_16x16x16_bf16 v[24:27], v[120:121], v[48:49], 0
  v_mfma_f32_16x16x16_bf16 v[116:119], v[120:121], v[50:51], 0
  v_mfma_f32_16x16x32_bf16 v[88:91], v[12:15], v[44:47], v[88:91]
  v_mfma_f32_16x16x32_bf16 v[24:27], v[28:31], v[44:47], v[24:27]
  v_mfma_f32_16x16x32_bf16 v[116:119], v[32:35], v[44:47], v[116:119]
  s_nop 7
  s_nop 1
  v_rcp_f32 v89, v88
  s_nop 0
  v_mul_f32 v24, v89, v24
  v_mul_f32 v25, v89, v25
  s_branch T_back_127
M_global:
  s_cmp_eq_u32 s13, 1
  s_cbranch_scc1 T_w_134
  s_cmp_eq_u32 s13, 2
  s_cbranch_scc1 T_w_135
  s_cmp_eq_u32 s13, 3
  s_cbranch_scc1 T_w_136
T_w_133:
  s_mov_b32 s19, 0
  v_mov_b64 v[16:17], 0
  v_mov_b64 v[18:19], 0
  v_mov_b64 v[20:21], 0
  v_mov_b64 v[22:23], 0
  v_mov_b64 v[24:25], 0
  v_mov_b64 v[26:27], 0
  buffer_load_dwordx4 v[124:127], v2, s[4:7], s24 offen offset:0 sc1
  buffer_load_dwordx4 v[116:119], v2, s[4:7], s25 offen offset:0 sc1
  buffer_load_dwordx4 v[124:127], v2, s[4:7], s24 offen offset:0 sc1
  buffer_load_dwordx4 v[116:119], v2, s[4:7], s25 offen offset:0 sc1
  s_branch T_loop_137
.p2align 6
T_retry_138:
  s_mov_b64 exec, vcc
  buffer_load_dwordx4 v[124:127], v2, s[4:7], s24 offen offset:0 sc1
  buffer_load_dwordx4 v[116:119], v2, s[4:7], s25 offen offset:0 sc1
  s_mov_b64 exec, -1
  s_add_u32 s19, s19, 1
  s_cmp_gt_u32 s19, 32768
  s_cbranch_scc1 M_exit
T_loop_137:
  s_waitcnt vmcnt(3) lgkmcnt(0)
  v_max3_u32 v123, v124, v125, v126
  v_max_u32 v123, v123, v127
  v_mov_b32_dpp v120, v124 row_ror:8 row_mask:0xf bank_mask:0xf
  v_mov_b32_dpp v121, v125 row_ror:8 row_mask:0xf bank_mask:0xf
  s_waitcnt vmcnt(2)
  v_max3_u32 v123, v123, v116, v117
  v_max3_u32 v123, v123, v118, v119
  v_cmp_eq_u32 vcc, -1, v123
  s_cbranch_vccnz T_retry_138
  v_smfmac_f32_16x16x64_bf16 v[16:19], v[124:127], v[68:75], v0
  s_add_u32 s14, s14, 1
  ds_write_b128 v2, v[124:127] offset:0
  v_mov_b32_dpp v122, v126 row_ror:8 row_mask:0xf bank_mask:0xf
  v_smfmac_f32_16x16x64_bf16 v[20:23], v[124:127], v[76:83], v0
  s_and_b32 s57, s14, 1
  v_mov_b32_dpp v123, v127 row_ror:8 row_mask:0xf bank_mask:0xf
  v_smfmac_f32_16x16x64_bf16 v[24:27], v[124:127], v[84:91], v0
  s_and_b32 s36, s14, 3
  ds_write_b128 v2, v[116:119] offset:4096
  v_smfmac_f32_16x16x64_bf16 v[16:19], v[120:123], v[92:99], v0
  s_lshl_b32 s36, s36, 13
  v_mov_b32_dpp v84, v116 row_ror:8 row_mask:0xf bank_mask:0xf
  v_smfmac_f32_16x16x64_bf16 v[20:23], v[120:123], v[100:107], v0
  s_add_u32 s26, s36, s23
  ds_read_b128 v[68:71], v4 offset:12288
  v_mov_b32_dpp v85, v117 row_ror:8 row_mask:0xf bank_mask:0xf
  v_smfmac_f32_16x16x64_bf16 v[24:27], v[120:123], v[108:115], v0
  s_add_u32 s36, s36, 8192
  ds_read_b128 v[72:75], v4 offset:13312
  v_mov_b32_dpp v86, v118 row_ror:8 row_mask:0xf bank_mask:0xf
  v_smfmac_f32_16x16x64_bf16 v[16:19], v[116:119], v[224:231], v0
  s_and_b32 s36, s36, 0x7fff
  ds_read_b128 v[76:79], v4 offset:14336
  v_mov_b32_dpp v87, v119 row_ror:8 row_mask:0xf bank_mask:0xf
  v_smfmac_f32_16x16x64_bf16 v[20:23], v[116:119], v[240:247], v0
  s_waitcnt lgkmcnt(3)
  s_barrier
  ds_read_b128 v[100:103], v2 offset:1024
  v_smfmac_f32_16x16x64_bf16 v[24:27], v[116:119], a[0:7], v0
  s_mov_b32 m0, s31
  ds_read_b128 v[120:123], v1 offset:1024
  v_smfmac_f32_16x16x64_bf16 v[16:19], v[84:87], v[232:239], v0
  s_cmp_ge_i32 s14, s30
  s_cbranch_scc1 T_kvw_141
T_kvb_142:
  v_smfmac_f32_16x16x64_bf16 v[20:23], v[84:87], v[248:255], v0
  ds_read_b128 v[80:83], v4 offset:15360
  buffer_load_dwordx4 v9, s[4:7], s27 offen sc1 lds
  v_smfmac_f32_16x16x64_bf16 v[24:27], v[84:87], a[8:15], v0
  s_waitcnt lgkmcnt(2)
  s_mov_b32 m0, s32
  v_smfmac_f32_16x16x64_bf16 v[16:19], v[100:103], v[128:135], v0
  ds_read_b128 v[92:95], v2 offset:2048
  v_smfmac_f32_16x16x64_bf16 v[20:23], v[100:103], v[144:151], v0
  ds_read_b128 v[96:99], v1 offset:2048
  v_smfmac_f32_16x16x64_bf16 v[24:27], v[100:103], v[68:75], v0
  s_waitcnt vmcnt(1) lgkmcnt(3)
  ds_read_b128 v[116:119], v2 offset:3072
  buffer_load_dwordx4 v9, s[4:7], s27 offen offset:128 sc1 lds
  v_smfmac_f32_16x16x64_bf16 v[16:19], v[120:123], v[136:143], v0
  ds_read_b128 v[124:127], v1 offset:3072
  s_mov_b32 m0, s33
  v_smfmac_f32_16x16x64_bf16 v[20:23], v[120:123], v[152:159], v0
  s_waitcnt lgkmcnt(4)
  ds_read_b128 v[104:107], v2 offset:5120
  v_smfmac_f32_16x16x64_bf16 v[24:27], v[120:123], v[76:83], v0
  s_waitcnt lgkmcnt(4)
  ds_read_b128 v[108:111], v1 offset:5120
  v_smfmac_f32_16x16x64_bf16 v[16:19], v[92:95], v[160:167], v0
  s_waitcnt lgkmcnt(4)
  ds_read_b128 v[112:115], v2 offset:6144
  buffer_load_dwordx4 v10, s[4:7], s28 offen sc1 lds
  v_smfmac_f32_16x16x64_bf16 v[16:19], v[96:99], v[168:175], v0
  s_waitcnt lgkmcnt(4)
  ds_read_b128 v[84:87], v1 offset:6144
  s_mov_b32 m0, s34
  v_smfmac_f32_16x16x64_bf16 v[16:19], v[116:119], v[192:199], v0
  s_waitcnt lgkmcnt(4)
  ds_read_b128 v[88:91], v2 offset:7168
  v_smfmac_f32_16x16x64_bf16 v[16:19], v[124:127], v[200:207], v0
  s_waitcnt lgkmcnt(4)
  ds_read_b128 v[100:103], v1 offset:7168
  v_smfmac_f32_16x16x64_bf16 v[16:19], v[104:107], a[16:23], v0
  s_waitcnt lgkmcnt(4)
  ds_read_b128 v[68:71], v4 offset:16384
  buffer_load_dwordx4 v10, s[4:7], s28 offen offset:256 sc1 lds
  v_smfmac_f32_16x16x64_bf16 v[16:19], v[108:111], a[24:31], v0
  s_waitcnt lgkmcnt(4)
  ds_read_b128 v[72:75], v4 offset:17408
  v_smfmac_f32_16x16x64_bf16 v[16:19], v[112:115], a[64:71], v0
  s_waitcnt lgkmcnt(4)
  ds_read_b128 v[76:79], v4 offset:18432
  v_smfmac_f32_16x16x64_bf16 v[16:19], v[84:87], a[72:79], v0
  s_waitcnt lgkmcnt(4)
  ds_read_b128 v[80:83], v4 offset:19456
  v_smfmac_f32_16x16x64_bf16 v[16:19], v[88:91], a[112:119], v0
  s_waitcnt lgkmcnt(4)
  v_smfmac_f32_16x16x64_bf16 v[16:19], v[100:103], a[120:127], v0
  s_add_u32 s24, s36, 145752064
  s_add_u32 s25, s36, 145756160
  v_smfmac_f32_16x16x64_bf16 v[20:23], v[92:95], v[176:183], v0
  s_add_u32 s35, s36, s23
  v_smfmac_f32_16x16x64_bf16 v[20:23], v[96:99], v[184:191], v0
  s_waitcnt lgkmcnt(2)
  v_smfmac_f32_16x16x64_bf16 v[20:23], v[116:119], v[68:75], v0
  s_waitcnt lgkmcnt(0)
  ds_read_b128 v[68:71], v4 offset:20480
  v_mul_f32 v16, s18, v16
  v_smfmac_f32_16x16x64_bf16 v[20:23], v[124:127], v[76:83], v0
  ds_read_b128 v[72:75], v4 offset:21504
  v_mul_f32 v17, s18, v17
  v_smfmac_f32_16x16x64_bf16 v[20:23], v[104:107], a[32:39], v0
  ds_read_b128 v[76:79], v4 offset:22528
  v_mul_f32 v18, s18, v18
  v_smfmac_f32_16x16x64_bf16 v[20:23], v[108:111], a[40:47], v0
  ds_read_b128 v[80:83], v4 offset:23552
  v_mul_f32 v19, s18, v19
  v_smfmac_f32_16x16x64_bf16 v[20:23], v[112:115], a[80:87], v0
  v_cvt_pk_bf16_f32 v120, v16, v17
  v_smfmac_f32_16x16x64_bf16 v[20:23], v[84:87], a[88:95], v0
  v_cvt_pk_bf16_f32 v121, v18, v19
  v_smfmac_f32_16x16x64_bf16 v[20:23], v[88:91], a[128:135], v0
  ds_write_b64 v5, v[120:121] offset:24576
  v_smfmac_f32_16x16x64_bf16 v[20:23], v[100:103], a[136:143], v0
  s_waitcnt lgkmcnt(3)
  v_smfmac_f32_16x16x64_bf16 v[24:27], v[92:95], v[68:75], v0
  s_waitcnt lgkmcnt(1)
  v_mov_b64 v[92:93], 0
  v_smfmac_f32_16x16x64_bf16 v[24:27], v[96:99], v[76:83], v0
  s_nop 1
  v_cvt_pk_bf16_f32 v122, v20, v21
  v_cvt_pk_bf16_f32 v123, v22, v23
  v_smfmac_f32_16x16x64_bf16 v[24:27], v[116:119], v[208:215], v0
  ds_write_b64 v5, v[122:123] offset:26880
  v_mov_b64 v[94:95], 0
  v_smfmac_f32_16x16x64_bf16 v[24:27], v[124:127], v[216:223], v0
  s_waitcnt lgkmcnt(1)
  s_barrier
  ds_read_b64_tr_b16 v[68:69], v6 offset:24576
  v_smfmac_f32_16x16x64_bf16 v[24:27], v[104:107], a[48:55], v0
  s_add_u32 s27, s27, 8192
  ds_read_b64_tr_b16 v[70:71], v6 offset:24640
  ds_read_b64_tr_b16 v[72:73], v6 offset:24832
  v_smfmac_f32_16x16x64_bf16 v[24:27], v[108:111], a[56:63], v0
  s_add_u32 s28, s28, 8192
  ds_read_b64_tr_b16 v[74:75], v6 offset:24896
  ds_read_b64_tr_b16 v[76:77], v6 offset:25088
  v_smfmac_f32_16x16x64_bf16 v[24:27], v[112:115], a[96:103], v0
  s_nop 0
  ds_read_b64_tr_b16 v[78:79], v6 offset:25152
  ds_read_b64_tr_b16 v[80:81], v6 offset:25344
  v_smfmac_f32_16x16x64_bf16 v[24:27], v[84:87], a[104:111], v0
  ds_read_b64_tr_b16 v[82:83], v6 offset:25408
  v_mov_b64 v[96:97], 0
  v_smfmac_f32_16x16x64_bf16 v[24:27], v[88:91], a[144:151], v0
  s_waitcnt lgkmcnt(8)
  s_barrier
  ds_read_b64_tr_b16 v[116:117], v6 offset:26880
  v_smfmac_f32_16x16x64_bf16 v[24:27], v[100:103], a[152:159], v0
  s_waitcnt lgkmcnt(7)
  ds_read_b64_tr_b16 v[118:119], v6 offset:26944
  buffer_store_dwordx2 v[122:123], v5, s[4:7], s29 offen sc1
  v_mfma_f32_16x16x32_bf16 v[16:19], v[36:39], v[68:71], 0
  s_waitcnt lgkmcnt(6)
  ds_read_b64_tr_b16 v[124:125], v6 offset:27136
  ds_read_b64_tr_b16 v[126:127], v6 offset:27200
  v_mfma_f32_16x16x32_bf16 v[16:19], v[40:43], v[72:75], v[16:19]
  s_waitcnt lgkmcnt(6)
  ds_read_b64_tr_b16 v[104:105], v6 offset:27392
  ds_read_b64_tr_b16 v[106:107], v6 offset:27456
  v_mfma_f32_16x16x32_bf16 v[16:19], v[44:47], v[76:79], v[16:19]
  s_waitcnt lgkmcnt(6)
  ds_read_b64_tr_b16 v[108:109], v6 offset:27648
  ds_read_b64_tr_b16 v[110:111], v6 offset:27712
  v_mfma_f32_16x16x32_bf16 v[16:19], v[48:51], v[80:83], v[16:19]
  s_waitcnt lgkmcnt(6)
  v_cvt_pk_bf16_f32 v120, v24, v25
  v_cvt_pk_bf16_f32 v121, v26, v27
  v_mfma_f32_16x16x32_bf16 v[112:115], v[116:119], v[68:71], 0
  s_waitcnt lgkmcnt(4)
  buffer_store_dwordx2 v[120:121], v5, s[4:7], s29 offen offset:2304 sc1
  v_mov_b64 v[98:99], 0
  v_mfma_f32_16x16x32_bf16 v[112:115], v[124:127], v[72:75], v[112:115]
  s_waitcnt lgkmcnt(2)
  v_mov_b64 v[36:37], 0
  v_exp_f32 v100, v16
  v_mfma_f32_16x16x32_bf16 v[112:115], v[104:107], v[76:79], v[112:115]
  s_waitcnt lgkmcnt(0)
  v_exp_f32 v101, v17
  v_mfma_f32_16x16x32_bf16 v[112:115], v[108:111], v[80:83], v[112:115]
  s_add_u32 s29, s29, 147456
  v_exp_f32 v102, v18
  v_mfma_f32_16x16x32_bf16 v[20:23], v[52:55], v[68:71], 0
  s_cmp_eq_u32 s14, 63
  v_exp_f32 v103, v19
  v_mfma_f32_16x16x32_bf16 v[20:23], v[56:59], v[72:75], v[20:23]
  s_cbranch_scc1 M_tdone
  v_cvt_pk_bf16_f32 v44, v100, v101
  v_cvt_pk_bf16_f32 v45, v102, v103
  v_mfma_f32_16x16x32_bf16 v[20:23], v[60:63], v[76:79], v[20:23]
  v_exp_f32 v100, v112
  v_mfma_f32_16x16x32_bf16 v[20:23], v[64:67], v[80:83], v[20:23]
  v_exp_f32 v101, v113
  v_exp_f32 v102, v114
  v_exp_f32 v103, v115
  v_cvt_pk_bf16_f32 v84, v100, v101
  v_cvt_pk_bf16_f32 v85, v102, v103
  v_cndmask_b32 v48, v84, 0, s[16:17]
  v_cndmask_b32 v49, v85, 0, s[16:17]
  v_cndmask_b32 v50, 0, v84, s[16:17]
  v_cndmask_b32 v51, 0, v85, s[16:17]
  v_exp_f32 v100, v20
  v_mfma_f32_16x16x16_bf16 v[88:91], v[12:13], v[48:49], 0
  v_exp_f32 v101, v21
  v_mfma_f32_16x16x16_bf16 v[24:27], v[120:121], v[48:49], 0
  v_exp_f32 v102, v22
  v_mfma_f32_16x16x16_bf16 v[116:119], v[120:121], v[50:51], 0
  v_exp_f32 v103, v23
  v_cvt_pk_bf16_f32 v46, v100, v101
  v_cvt_pk_bf16_f32 v47, v102, v103
  v_mov_b64 v[38:39], 0
  s_nop 0
  v_mfma_f32_16x16x32_bf16 v[88:91], v[12:15], v[44:47], v[88:91]
  v_mov_b64 v[40:41], 0
  v_mov_b64 v[42:43], 0
  v_mfma_f32_16x16x32_bf16 v[24:27], v[28:31], v[44:47], v[24:27]
  ds_read_b128 v[52:55], v4 offset:24576
  ds_read_b128 v[56:59], v4 offset:25600
  v_mfma_f32_16x16x32_bf16 v[116:119], v[32:35], v[44:47], v[116:119]
  s_nop 1
  v_rcp_f32 v89, v88
  v_subrev_u32 v100, s54, v88
  v_cmp_le_u32 vcc, s55, v100
  v_mul_f32 v24, v89, v24
  v_mul_f32 v25, v89, v25
  s_cbranch_vccnz T_slow_143
T_back_144:
  v_cvt_pk_bf16_f32 v124, v24, v25
  v_pk_mul_f32 v[26:27], v[26:27], v[88:89] op_sel:[0,1] op_sel_hi:[1,1]
  v_pk_mul_f32 v[116:117], v[116:117], v[88:89] op_sel:[0,1] op_sel_hi:[1,1]
  v_pk_mul_f32 v[118:119], v[118:119], v[88:89] op_sel:[0,1] op_sel_hi:[1,1]
  v_cvt_pk_bf16_f32 v125, v26, v27
  v_cvt_pk_bf16_f32 v126, v116, v117
  v_cvt_pk_bf16_f32 v127, v118, v119
  ds_write_b128 v11, v[124:127] offset:29184
  s_nop 0
  v_smfmac_f32_16x16x64_bf16 v[92:95], v[124:127], a[160:167], v0
  v_smfmac_f32_16x16x64_bf16 v[96:99], v[124:127], a[168:175], v0
  v_smfmac_f32_16x16x64_bf16 v[36:39], v[124:127], a[176:183], v0
  v_smfmac_f32_16x16x64_bf16 v[40:43], v[124:127], a[184:191], v0
  s_waitcnt lgkmcnt(0)
  s_barrier
  ds_read_b128 v[104:107], v11 offset:29696
  ds_read_b128 v[108:111], v11 offset:30208
  ds_read_b128 v[68:71], v11 offset:30720
  s_waitcnt lgkmcnt(2)
  v_smfmac_f32_16x16x64_bf16 v[92:95], v[104:107], a[192:199], v0
  s_waitcnt lgkmcnt(1)
  ds_read_b128 v[76:79], v4 offset:28672
  v_smfmac_f32_16x16x64_bf16 v[92:95], v[108:111], a[224:231], v0
  s_waitcnt lgkmcnt(1)
  ds_read_b128 v[80:83], v4 offset:29696
  v_smfmac_f32_16x16x64_bf16 v[92:95], v[68:71], a[240:247], v0
  ds_read_b128 v[60:63], v4 offset:26624
  v_smfmac_f32_16x16x64_bf16 v[96:99], v[104:107], a[200:207], v0
  ds_read_b128 v[64:67], v4 offset:27648
  v_smfmac_f32_16x16x64_bf16 v[96:99], v[108:111], a[232:239], v0
  ds_read_b128 v[28:31], v4 offset:30720
  s_nop 0
  v_cvt_pk_bf16_f32 v16, v92, v93
  v_cvt_pk_bf16_f32 v17, v94, v95
  v_bfi_b32 v16, 1, s57, v16
  v_smfmac_f32_16x16x64_bf16 v[96:99], v[68:71], a[248:255], v0
  buffer_store_dwordx2 v[16:17], v7, s[4:7], s20 offen offset:0 sc1
  v_smfmac_f32_16x16x64_bf16 v[36:39], v[104:107], a[208:215], v0
  ds_read_b128 v[32:35], v4 offset:31744
  v_smfmac_f32_16x16x64_bf16 v[36:39], v[108:111], v[52:59], v0
  s_waitcnt lgkmcnt(4)
  s_nop 0
  v_cvt_pk_bf16_f32 v18, v96, v97
  v_cvt_pk_bf16_f32 v19, v98, v99
  v_bfi_b32 v18, 1, s57, v18
  v_smfmac_f32_16x16x64_bf16 v[36:39], v[68:71], v[76:83], v0
  buffer_store_dwordx2 v[18:19], v7, s[4:7], s20 offen offset:64 sc1
  v_smfmac_f32_16x16x64_bf16 v[40:43], v[104:107], a[216:223], v0
  s_waitcnt lgkmcnt(2)
  ds_read_b128 v[116:119], v2 offset:31232
  v_smfmac_f32_16x16x64_bf16 v[40:43], v[108:111], v[60:67], v0
  s_waitcnt lgkmcnt(1)
  s_nop 0
  v_cvt_pk_bf16_f32 v20, v36, v37
  v_cvt_pk_bf16_f32 v21, v38, v39
  v_bfi_b32 v20, 1, s57, v20
  v_smfmac_f32_16x16x64_bf16 v[40:43], v[68:71], v[28:35], v0
  buffer_store_dwordx2 v[20:21], v7, s[4:7], s21 offen offset:0 sc1
  s_nop 6
  v_cvt_pk_bf16_f32 v22, v40, v41
  v_cvt_pk_bf16_f32 v23, v42, v43
  v_bfi_b32 v22, 1, s57, v22
  buffer_store_dwordx2 v[22:23], v7, s[4:7], s21 offen offset:64 sc1
  ds_read_b128 v[68:71], v4 offset:0
  ds_read_b128 v[72:75], v4 offset:1024
  ds_read_b128 v[76:79], v4 offset:4096
  ds_read_b128 v[80:83], v4 offset:5120
  ds_read_b128 v[84:87], v4 offset:8192
  ds_read_b128 v[88:91], v4 offset:9216
  v_mov_b64 v[16:17], 0
  v_mov_b64 v[18:19], 0
  v_mov_b64 v[20:21], 0
  v_mov_b64 v[22:23], 0
  v_mov_b64 v[24:25], 0
  v_mov_b64 v[26:27], 0
  s_mov_b32 s19, 0
  v_mov_b32 v49, -1
  s_waitcnt vmcnt(2)
  buffer_load_dwordx4 v[52:55], v2, s[4:7], s22 offen offset:0 sc1
  buffer_load_dwordx4 v[56:59], v2, s[4:7], s22 offen offset:1024 sc1
  buffer_load_dwordx4 v[60:63], v2, s[4:7], s22 offen offset:2048 sc1
  buffer_load_dwordx4 v[64:67], v2, s[4:7], s22 offen offset:3072 sc1
  ds_read_b128 v[92:95], v4 offset:2048
  ds_read_b128 v[96:99], v4 offset:3072
  ds_read_b128 v[100:103], v4 offset:6144
  ds_read_b128 v[104:107], v4 offset:7168
  ds_read_b128 v[108:111], v4 offset:10240
  ds_read_b128 v[112:115], v4 offset:11264
  ds_read_b64 v[44:45], v2 offset:32256
  s_waitcnt lgkmcnt(0)
  v_readfirstlane_b32 s38, v44
  v_readfirstlane_b32 s37, v45
  s_nop 0
  s_add_u32 s37, s37, 30
  s_cmp_ge_u32 s38, 30
  s_cselect_b32 s38, s37, s38
  s_cmp_ge_u32 s38, 64
  s_cselect_b32 s38, 100, s38
  s_sub_u32 s38, s38, 1
  s_max_i32 s30, s30, s38
  s_waitcnt lgkmcnt(12)
  s_waitcnt vmcnt(3)
  v_mfma_f32_16x16x32_bf16 v[120:123], v[116:119], v[52:55], 0
  v_xor_b32 v48, s57, v52
  v_bitop3_b32 v48, v48, v54, s57 bitop3:0xf6
  s_waitcnt vmcnt(2)
  v_mfma_f32_16x16x32_bf16 v[120:123], v[116:119], v[56:59], v[120:123]
  v_bitop3_b32 v48, v48, v56, s57 bitop3:0xf6
  v_bitop3_b32 v48, v48, v58, s57 bitop3:0xf6
  s_waitcnt vmcnt(1)
  v_mfma_f32_16x16x32_bf16 v[120:123], v[116:119], v[60:63], v[120:123]
  v_bitop3_b32 v48, v48, v60, s57 bitop3:0xf6
  v_bitop3_b32 v48, v48, v62, s57 bitop3:0xf6
  s_waitcnt vmcnt(0)
  v_mfma_f32_16x16x32_bf16 v[120:123], v[116:119], v[64:67], v[120:123]
  v_bitop3_b32 v48, v48, v64, s57 bitop3:0xf6
  v_bitop3_b32 v48, v48, v66, s57 bitop3:0xf6
  v_and_b32 v48, 1, v48
  v_cmp_ne_u32 vcc, 0, v48
  s_cbranch_vccnz T_p1re_146
T_p1ok_147:
  s_nop 2
  v_add_f32_dpp v120, v120, v120 row_ror:8 row_mask:0xf bank_mask:0xf
  v_add_f32_dpp v121, v121, v121 row_ror:8 row_mask:0xf bank_mask:0xf
  v_cvt_pk_bf16_f32 v48, v120, v121
  v_min_u32 v48, -2, v48
  buffer_store_dword v48, v8, s[4:7], s35 offen sc1
  buffer_store_dword v49, v8, s[4:7], s26 offen sc1
  s_barrier
  ds_read_b128 v[28:31], v2 offset:16384
  ds_read_b128 v[32:35], v2 offset:20480
  ds_read_b128 v[36:39], v2 offset:8192
  ds_read_b128 v[40:43], v2 offset:9216
  ds_read_b128 v[44:47], v2 offset:10240
  ds_read_b128 v[48:51], v2 offset:11264
  buffer_load_dwordx4 v[124:127], v2, s[4:7], s24 offen offset:0 sc1
  buffer_load_dwordx4 v[116:119], v2, s[4:7], s25 offen offset:0 sc1
  ds_read_b128 v[52:55], v2 offset:12288
  ds_read_b128 v[56:59], v2 offset:13312
  ds_read_b128 v[60:63], v2 offset:14336
  ds_read_b128 v[64:67], v2 offset:15360
  buffer_load_dwordx4 v[124:127], v2, s[4:7], s24 offen offset:0 sc1
  buffer_load_dwordx4 v[116:119], v2, s[4:7], s25 offen offset:0 sc1
  s_mov_b32 s19, 0
  s_branch T_loop_137
T_p1re_146:
  s_mov_b64 exec, vcc
  buffer_load_dwordx4 v[52:55], v2, s[4:7], s22 offen offset:0 sc1
  buffer_load_dwordx4 v[56:59], v2, s[4:7], s22 offen offset:1024 sc1
  buffer_load_dwordx4 v[60:63], v2, s[4:7], s22 offen offset:2048 sc1
  buffer_load_dwordx4 v[64:67], v2, s[4:7], s22 offen offset:3072 sc1
  s_mov_b64 exec, -1
  s_add_u32 s19, s19, 1
  s_cmp_gt_u32 s19, 32768
  s_cbranch_scc1 M_exit
  s_waitcnt vmcnt(3)
  v_mfma_f32_16x16x32_bf16 v[120:123], v[116:119], v[52:55], 0
  v_xor_b32 v48, s57, v52
  v_bitop3_b32 v48, v48, v54, s57 bitop3:0xf6
  s_waitcnt vmcnt(2)
  v_mfma_f32_16x16x32_bf16 v[120:123], v[116:119], v[56:59], v[120:123]
  v_bitop3_b32 v48, v48, v56, s57 bitop3:0xf6
  v_bitop3_b32 v48, v48, v58, s57 bitop3:0xf6
  s_waitcnt vmcnt(1)
  v_mfma_f32_16x16x32_bf16 v[120:123], v[116:119], v[60:63], v[120:123]
  v_bitop3_b32 v48, v48, v60, s57 bitop3:0xf6
  v_bitop3_b32 v48, v48, v62, s57 bitop3:0xf6
  s_waitcnt vmcnt(0)
  v_mfma_f32_16x16x32_bf16 v[120:123], v[116:119], v[64:67], v[120:123]
  v_bitop3_b32 v48, v48, v64, s57 bitop3:0xf6
  v_bitop3_b32 v48, v48, v66, s57 bitop3:0xf6
  v_and_b32 v48, 1, v48
  v_cmp_ne_u32 vcc, 0, v48
  s_cbranch_vccnz T_p1re_146
  s_branch T_p1ok_147
T_kvw_141:
  s_mov_b32 s19, 0
  s_branch T_kvok_149
T_kv_148:
  s_sleep 4
  s_add_u32 s19, s19, 1
  s_cmp_gt_u32 s19, 32768
  s_cbranch_scc1 M_exit
T_kvok_149:
  s_add_u32 s39, s99, 128
  s_mov_b32 s38, 0
  s_mov_b32 s37, 0
  s_atomic_or s38, s[58:59], s99 glc
  s_atomic_or s37, s[58:59], s39 glc
  s_waitcnt lgkmcnt(0)
  s_add_u32 s37, s37, 30
  s_cmp_ge_u32 s38, 30
  s_cselect_b32 s38, s37, s38
  s_cmp_ge_u32 s38, 64
  s_cselect_b32 s38, 100, s38
  s_sub_u32 s38, s38, 1
  s_max_i32 s30, s30, s38
  s_cmp_ge_i32 s14, s30
  s_cbranch_scc1 T_kv_148
  s_branch T_kvb_142
T_slow_143:
  s_nop 7
  v_max3_f32 v100, v16, v17, v18
  v_max3_f32 v100, v100, v19, v20
  v_max3_f32 v100, v100, v21, v22
  v_max3_f32 v100, v100, v23, v112
  v_max3_f32 v100, v100, v113, v114
  v_max_f32 v100, v100, v115
  v_mov_b32 v101, v100
  s_nop 1
  v_permlane32_swap_b32 v100, v101
  s_nop 1
  v_max_f32 v100, v100, v101
  v_mov_b32 v101, v100
  s_nop 1
  v_permlane16_swap_b32 v100, v101
  s_nop 1
  v_max_f32 v100, v100, v101
  v_sub_f32 v16, v16, v100
  v_sub_f32 v17, v17, v100
  v_sub_f32 v18, v18, v100
  v_sub_f32 v19, v19, v100
  v_exp_f32 v16, v16
  v_exp_f32 v17, v17
  v_exp_f32 v18, v18
  v_exp_f32 v19, v19
  v_sub_f32 v20, v20, v100
  v_sub_f32 v21, v21, v100
  v_sub_f32 v22, v22, v100
  v_sub_f32 v23, v23, v100
  v_exp_f32 v20, v20
  v_exp_f32 v21, v21
  v_exp_f32 v22, v22
  v_exp_f32 v23, v23
  v_sub_f32 v112, v112, v100
  v_sub_f32 v113, v113, v100
  v_sub_f32 v114, v114, v100
  v_sub_f32 v115, v115, v100
  v_exp_f32 v112, v112
  v_exp_f32 v113, v113
  v_exp_f32 v114, v114
  v_exp_f32 v115, v115
  s_nop 0
  v_cvt_pk_bf16_f32 v44, v16, v17
  v_cvt_pk_bf16_f32 v45, v18, v19
  v_cvt_pk_bf16_f32 v46, v20, v21
  v_cvt_pk_bf16_f32 v47, v22, v23
  v_cvt_pk_bf16_f32 v84, v112, v113
  v_cvt_pk_bf16_f32 v85, v114, v115
  v_cndmask_b32 v48, v84, 0, s[16:17]
  v_cndmask_b32 v49, v85, 0, s[16:17]
  v_cndmask_b32 v50, 0, v84, s[16:17]
  v_cndmask_b32 v51, 0, v85, s[16:17]
  s_nop 1
  v_mfma_f32_16x16x16_bf16 v[88:91], v[12:13], v[48:49], 0
  v_mfma_f32_16x16x16_bf16 v[24:27], v[120:121], v[48:49], 0
  v_mfma_f32_16x16x16_bf16 v[116:119], v[120:121], v[50:51], 0
  v_mfma_f32_16x16x32_bf16 v[88:91], v[12:15], v[44:47], v[88:91]
  v_mfma_f32_16x16x32_bf16 v[24:27], v[28:31], v[44:47], v[24:27]
  v_mfma_f32_16x16x32_bf16 v[116:119], v[32:35], v[44:47], v[116:119]
  s_nop 7
  s_nop 1
  v_rcp_f32 v89, v88
  s_nop 0
  v_mul_f32 v24, v89, v24
  v_mul_f32 v25, v89, v25
  s_branch T_back_144
T_w_134:
  s_mov_b32 s19, 0
  v_mov_b64 v[16:17], 0
  v_mov_b64 v[18:19], 0
  v_mov_b64 v[20:21], 0
  v_mov_b64 v[22:23], 0
  v_mov_b64 v[24:25], 0
  v_mov_b64 v[26:27], 0
  buffer_load_dwordx4 v[124:127], v2, s[4:7], s24 offen offset:1024 sc1
  buffer_load_dwordx4 v[116:119], v2, s[4:7], s25 offen offset:1024 sc1
  buffer_load_dwordx4 v[124:127], v2, s[4:7], s24 offen offset:1024 sc1
  buffer_load_dwordx4 v[116:119], v2, s[4:7], s25 offen offset:1024 sc1
  s_branch T_loop_150
.p2align 6
T_retry_151:
  s_mov_b64 exec, vcc
  buffer_load_dwordx4 v[124:127], v2, s[4:7], s24 offen offset:1024 sc1
  buffer_load_dwordx4 v[116:119], v2, s[4:7], s25 offen offset:1024 sc1
  s_mov_b64 exec, -1
  s_add_u32 s19, s19, 1
  s_cmp_gt_u32 s19, 32768
  s_cbranch_scc1 M_exit
T_loop_150:
  s_waitcnt vmcnt(3) lgkmcnt(0)
  v_max3_u32 v123, v124, v125, v126
  v_max_u32 v123, v123, v127
  v_mov_b32_dpp v120, v124 row_ror:8 row_mask:0xf bank_mask:0xf
  v_mov_b32_dpp v121, v125 row_ror:8 row_mask:0xf bank_mask:0xf
  s_waitcnt vmcnt(2)
  v_max3_u32 v123, v123, v116, v117
  v_max3_u32 v123, v123, v118, v119
  v_cmp_eq_u32 vcc, -1, v123
  s_cbranch_vccnz T_retry_151
  v_smfmac_f32_16x16x64_bf16 v[16:19], v[124:127], v[68:75], v0
  s_add_u32 s14, s14, 1
  ds_write_b128 v2, v[124:127] offset:1024
  v_mov_b32_dpp v122, v126 row_ror:8 row_mask:0xf bank_mask:0xf
  v_smfmac_f32_16x16x64_bf16 v[20:23], v[124:127], v[76:83], v0
  s_and_b32 s57, s14, 1
  v_mov_b32_dpp v123, v127 row_ror:8 row_mask:0xf bank_mask:0xf
  v_smfmac_f32_16x16x64_bf16 v[24:27], v[124:127], v[84:91], v0
  s_and_b32 s36, s14, 3
  ds_write_b128 v2, v[116:119] offset:5120
  v_smfmac_f32_16x16x64_bf16 v[16:19], v[120:123], v[92:99], v0
  s_lshl_b32 s36, s36, 13
  v_mov_b32_dpp v84, v116 row_ror:8 row_mask:0xf bank_mask:0xf
  v_smfmac_f32_16x16x64_bf16 v[20:23], v[120:123], v[100:107], v0
  s_add_u32 s26, s36, s23
  ds_read_b128 v[68:71], v4 offset:12288
  v_mov_b32_dpp v85, v117 row_ror:8 row_mask:0xf bank_mask:0xf
  v_smfmac_f32_16x16x64_bf16 v[24:27], v[120:123], v[108:115], v0
  s_add_u32 s36, s36, 8192
  ds_read_b128 v[72:75], v4 offset:13312
  v_mov_b32_dpp v86, v118 row_ror:8 row_mask:0xf bank_mask:0xf
  v_smfmac_f32_16x16x64_bf16 v[16:19], v[116:119], v[224:231], v0
  s_and_b32 s36, s36, 0x7fff
  ds_read_b128 v[76:79], v4 offset:14336
  v_mov_b32_dpp v87, v119 row_ror:8 row_mask:0xf bank_mask:0xf
  v_smfmac_f32_16x16x64_bf16 v[20:23], v[116:119], v[240:247], v0
  s_waitcnt lgkmcnt(3)
  s_barrier
  ds_read_b128 v[100:103], v2 offset:0
  v_smfmac_f32_16x16x64_bf16 v[24:27], v[116:119], a[0:7], v0
  s_mov_b32 m0, s31
  ds_read_b128 v[120:123], v1 offset:0
  v_smfmac_f32_16x16x64_bf16 v[16:19], v[84:87], v[232:239], v0
  s_cmp_ge_i32 s14, s30
  s_cbranch_scc1 T_kvw_154
T_kvb_155:
  v_smfmac_f32_16x16x64_bf16 v[20:23], v[84:87], v[248:255], v0
  ds_read_b128 v[80:83], v4 offset:15360
  v_smfmac_f32_16x16x64_bf16 v[24:27], v[84:87], a[8:15], v0
  s_waitcnt lgkmcnt(2)
  buffer_load_dwordx4 v9, s[4:7], s27 offen sc1 lds
  v_smfmac_f32_16x16x64_bf16 v[16:19], v[100:103], v[128:135], v0
  ds_read_b128 v[92:95], v2 offset:3072
  s_mov_b32 m0, s32
  v_smfmac_f32_16x16x64_bf16 v[20:23], v[100:103], v[144:151], v0
  ds_read_b128 v[96:99], v1 offset:3072
  v_smfmac_f32_16x16x64_bf16 v[24:27], v[100:103], v[68:75], v0
  s_waitcnt vmcnt(1) lgkmcnt(3)
  ds_read_b128 v[116:119], v2 offset:2048
  v_smfmac_f32_16x16x64_bf16 v[16:19], v[120:123], v[136:143], v0
  ds_read_b128 v[124:127], v1 offset:2048
  buffer_load_dwordx4 v9, s[4:7], s27 offen offset:128 sc1 lds
  v_smfmac_f32_16x16x64_bf16 v[20:23], v[120:123], v[152:159], v0
  s_waitcnt lgkmcnt(4)
  ds_read_b128 v[104:107], v2 offset:4096
  s_mov_b32 m0, s33
  v_smfmac_f32_16x16x64_bf16 v[24:27], v[120:123], v[76:83], v0
  s_waitcnt lgkmcnt(4)
  ds_read_b128 v[108:111], v1 offset:4096
  v_smfmac_f32_16x16x64_bf16 v[16:19], v[92:95], v[160:167], v0
  s_waitcnt lgkmcnt(4)
  ds_read_b128 v[112:115], v2 offset:7168
  v_smfmac_f32_16x16x64_bf16 v[16:19], v[96:99], v[168:175], v0
  s_waitcnt lgkmcnt(4)
  ds_read_b128 v[84:87], v1 offset:7168
  buffer_load_dwordx4 v10, s[4:7], s28 offen sc1 lds
  v_smfmac_f32_16x16x64_bf16 v[16:19], v[116:119], v[192:199], v0
  s_waitcnt lgkmcnt(4)
  ds_read_b128 v[88:91], v2 offset:6144
  s_mov_b32 m0, s34
  v_smfmac_f32_16x16x64_bf16 v[16:19], v[124:127], v[200:207], v0
  s_waitcnt lgkmcnt(4)
  ds_read_b128 v[100:103], v1 offset:6144
  v_smfmac_f32_16x16x64_bf16 v[16:19], v[104:107], a[16:23], v0
  s_waitcnt lgkmcnt(4)
  ds_read_b128 v[68:71], v4 offset:16384
  v_smfmac_f32_16x16x64_bf16 v[16:19], v[108:111], a[24:31], v0
  s_waitcnt lgkmcnt(4)
  ds_read_b128 v[72:75], v4 offset:17408
  buffer_load_dwordx4 v10, s[4:7], s28 offen offset:256 sc1 lds
  v_smfmac_f32_16x16x64_bf16 v[16:19], v[112:115], a[64:71], v0
  s_waitcnt lgkmcnt(4)
  ds_read_b128 v[76:79], v4 offset:18432
  v_smfmac_f32_16x16x64_bf16 v[16:19], v[84:87], a[72:79], v0
  s_waitcnt lgkmcnt(4)
  ds_read_b128 v[80:83], v4 offset:19456
  v_smfmac_f32_16x16x64_bf16 v[16:19], v[88:91], a[112:119], v0
  s_waitcnt lgkmcnt(4)
  v_smfmac_f32_16x16x64_bf16 v[16:19], v[100:103], a[120:127], v0
  s_add_u32 s24, s36, 145752064
  s_add_u32 s25, s36, 145756160
  v_smfmac_f32_16x16x64_bf16 v[20:23], v[92:95], v[176:183], v0
  s_add_u32 s35, s36, s23
  v_smfmac_f32_16x16x64_bf16 v[20:23], v[96:99], v[184:191], v0
  s_waitcnt lgkmcnt(2)
  v_smfmac_f32_16x16x64_bf16 v[20:23], v[116:119], v[68:75], v0
  s_waitcnt lgkmcnt(0)
  ds_read_b128 v[68:71], v4 offset:20480
  v_mul_f32 v16, s18, v16
  v_smfmac_f32_16x16x64_bf16 v[20:23], v[124:127], v[76:83], v0
  ds_read_b128 v[72:75], v4 offset:21504
  v_mul_f32 v17, s18, v17
  v_smfmac_f32_16x16x64_bf16 v[20:23], v[104:107], a[32:39], v0
  ds_read_b128 v[76:79], v4 offset:22528
  v_mul_f32 v18, s18, v18
  v_smfmac_f32_16x16x64_bf16 v[20:23], v[108:111], a[40:47], v0
  ds_read_b128 v[80:83], v4 offset:23552
  v_mul_f32 v19, s18, v19
  v_smfmac_f32_16x16x64_bf16 v[20:23], v[112:115], a[80:87], v0
  v_cvt_pk_bf16_f32 v120, v16, v17
  v_smfmac_f32_16x16x64_bf16 v[20:23], v[84:87], a[88:95], v0
  v_cvt_pk_bf16_f32 v121, v18, v19
  v_smfmac_f32_16x16x64_bf16 v[20:23], v[88:91], a[128:135], v0
  ds_write_b64 v5, v[120:121] offset:24576
  v_smfmac_f32_16x16x64_bf16 v[20:23], v[100:103], a[136:143], v0
  s_waitcnt lgkmcnt(3)
  v_smfmac_f32_16x16x64_bf16 v[24:27], v[92:95], v[68:75], v0
  s_waitcnt lgkmcnt(1)
  v_mov_b64 v[92:93], 0
  v_smfmac_f32_16x16x64_bf16 v[24:27], v[96:99], v[76:83], v0
  s_nop 1
  v_cvt_pk_bf16_f32 v122, v20, v21
  v_cvt_pk_bf16_f32 v123, v22, v23
  v_smfmac_f32_16x16x64_bf16 v[24:27], v[116:119], v[208:215], v0
  ds_write_b64 v5, v[122:123] offset:26880
  v_mov_b64 v[94:95], 0
  v_smfmac_f32_16x16x64_bf16 v[24:27], v[124:127], v[216:223], v0
  s_waitcnt lgkmcnt(1)
  s_barrier
  ds_read_b64_tr_b16 v[68:69], v6 offset:24576
  v_smfmac_f32_16x16x64_bf16 v[24:27], v[104:107], a[48:55], v0
  s_add_u32 s27, s27, 8192
  ds_read_b64_tr_b16 v[70:71], v6 offset:24640
  ds_read_b64_tr_b16 v[72:73], v6 offset:24832
  v_smfmac_f32_16x16x64_bf16 v[24:27], v[108:111], a[56:63], v0
  s_add_u32 s28, s28, 8192
  ds_read_b64_tr_b16 v[74:75], v6 offset:24896
  ds_read_b64_tr_b16 v[76:77], v6 offset:25088
  v_smfmac_f32_16x16x64_bf16 v[24:27], v[112:115], a[96:103], v0
  s_nop 0
  ds_read_b64_tr_b16 v[78:79], v6 offset:25152
  ds_read_b64_tr_b16 v[80:81], v6 offset:25344
  v_smfmac_f32_16x16x64_bf16 v[24:27], v[84:87], a[104:111], v0
  ds_read_b64_tr_b16 v[82:83], v6 offset:25408
  v_mov_b64 v[96:97], 0
  v_smfmac_f32_16x16x64_bf16 v[24:27], v[88:91], a[144:151], v0
  s_waitcnt lgkmcnt(8)
  s_barrier
  ds_read_b64_tr_b16 v[116:117], v6 offset:26880
  v_smfmac_f32_16x16x64_bf16 v[24:27], v[100:103], a[152:159], v0
  s_waitcnt lgkmcnt(7)
  ds_read_b64_tr_b16 v[118:119], v6 offset:26944
  buffer_store_dwordx2 v[122:123], v5, s[4:7], s29 offen sc1
  v_mfma_f32_16x16x32_bf16 v[16:19], v[36:39], v[68:71], 0
  s_waitcnt lgkmcnt(6)
  ds_read_b64_tr_b16 v[124:125], v6 offset:27136
  ds_read_b64_tr_b16 v[126:127], v6 offset:27200
  v_mfma_f32_16x16x32_bf16 v[16:19], v[40:43], v[72:75], v[16:19]
  s_waitcnt lgkmcnt(6)
  ds_read_b64_tr_b16 v[104:105], v6 offset:27392
  ds_read_b64_tr_b16 v[106:107], v6 offset:27456
  v_mfma_f32_16x16x32_bf16 v[16:19], v[44:47], v[76:79], v[16:19]
  s_waitcnt lgkmcnt(6)
  ds_read_b64_tr_b16 v[108:109], v6 offset:27648
  ds_read_b64_tr_b16 v[110:111], v6 offset:27712
  v_mfma_f32_16x16x32_bf16 v[16:19], v[48:51], v[80:83], v[16:19]
  s_waitcnt lgkmcnt(6)
  v_cvt_pk_bf16_f32 v120, v24, v25
  v_cvt_pk_bf16_f32 v121, v26, v27
  v_mfma_f32_16x16x32_bf16 v[112:115], v[116:119], v[68:71], 0
  s_waitcnt lgkmcnt(4)
  buffer_store_dwordx2 v[120:121], v5, s[4:7], s29 offen offset:2304 sc1
  v_mov_b64 v[98:99], 0
  v_mfma_f32_16x16x32_bf16 v[112:115], v[124:127], v[72:75], v[112:115]
  s_waitcnt lgkmcnt(2)
  v_mov_b64 v[36:37], 0
  v_exp_f32 v100, v16
  v_mfma_f32_16x16x32_bf16 v[112:115], v[104:107], v[76:79], v[112:115]
  s_waitcnt lgkmcnt(0)
  v_exp_f32 v101, v17
  v_mfma_f32_16x16x32_bf16 v[112:115], v[108:111], v[80:83], v[112:115]
  s_add_u32 s29, s29, 147456
  v_exp_f32 v102, v18
  v_mfma_f32_16x16x32_bf16 v[20:23], v[52:55], v[68:71], 0
  s_cmp_eq_u32 s14, 63
  v_exp_f32 v103, v19
  v_mfma_f32_16x16x32_bf16 v[20:23], v[56:59], v[72:75], v[20:23]
  s_cbranch_scc1 M_tdone
  v_cvt_pk_bf16_f32 v44, v100, v101
  v_cvt_pk_bf16_f32 v45, v102, v103
  v_mfma_f32_16x16x32_bf16 v[20:23], v[60:63], v[76:79], v[20:23]
  v_exp_f32 v100, v112
  v_mfma_f32_16x16x32_bf16 v[20:23], v[64:67], v[80:83], v[20:23]
  v_exp_f32 v101, v113
  v_exp_f32 v102, v114
  v_exp_f32 v103, v115
  v_cvt_pk_bf16_f32 v84, v100, v101
  v_cvt_pk_bf16_f32 v85, v102, v103
  v_cndmask_b32 v48, v84, 0, s[16:17]
  v_cndmask_b32 v49, v85, 0, s[16:17]
  v_cndmask_b32 v50, 0, v84, s[16:17]
  v_cndmask_b32 v51, 0, v85, s[16:17]
  v_exp_f32 v100, v20
  v_mfma_f32_16x16x16_bf16 v[88:91], v[12:13], v[48:49], 0
  v_exp_f32 v101, v21
  v_mfma_f32_16x16x16_bf16 v[24:27], v[120:121], v[48:49], 0
  v_exp_f32 v102, v22
  v_mfma_f32_16x16x16_bf16 v[116:119], v[120:121], v[50:51], 0
  v_exp_f32 v103, v23
  v_cvt_pk_bf16_f32 v46, v100, v101
  v_cvt_pk_bf16_f32 v47, v102, v103
  v_mov_b64 v[38:39], 0
  s_nop 0
  v_mfma_f32_16x16x32_bf16 v[88:91], v[12:15], v[44:47], v[88:91]
  v_mov_b64 v[40:41], 0
  v_mov_b64 v[42:43], 0
  v_mfma_f32_16x16x32_bf16 v[24:27], v[28:31], v[44:47], v[24:27]
  ds_read_b128 v[52:55], v4 offset:24576
  ds_read_b128 v[56:59], v4 offset:25600
  v_mfma_f32_16x16x32_bf16 v[116:119], v[32:35], v[44:47], v[116:119]
  s_nop 1
  v_rcp_f32 v89, v88
  v_subrev_u32 v100, s54, v88
  v_cmp_le_u32 vcc, s55, v100
  v_mul_f32 v24, v89, v24
  v_mul_f32 v25, v89, v25
  s_cbranch_vccnz T_slow_156
T_back_157:
  v_cvt_pk_bf16_f32 v124, v24, v25
  v_pk_mul_f32 v[26:27], v[26:27], v[88:89] op_sel:[0,1] op_sel_hi:[1,1]
  v_pk_mul_f32 v[116:117], v[116:117], v[88:89] op_sel:[0,1] op_sel_hi:[1,1]
  v_pk_mul_f32 v[118:119], v[118:119], v[88:89] op_sel:[0,1] op_sel_hi:[1,1]
  v_cvt_pk_bf16_f32 v125, v26, v27
  v_cvt_pk_bf16_f32 v126, v116, v117
  v_cvt_pk_bf16_f32 v127, v118, v119
  ds_write_b128 v11, v[124:127] offset:29696
  s_nop 0
  v_smfmac_f32_16x16x64_bf16 v[92:95], v[124:127], a[160:167], v0
  v_smfmac_f32_16x16x64_bf16 v[96:99], v[124:127], a[168:175], v0
  v_smfmac_f32_16x16x64_bf16 v[36:39], v[124:127], a[176:183], v0
  v_smfmac_f32_16x16x64_bf16 v[40:43], v[124:127], a[184:191], v0
  s_waitcnt lgkmcnt(0)
  s_barrier
  ds_read_b128 v[104:107], v11 offset:29184
  ds_read_b128 v[108:111], v11 offset:30720
  ds_read_b128 v[68:71], v11 offset:30208
  s_waitcnt lgkmcnt(2)
  v_smfmac_f32_16x16x64_bf16 v[92:95], v[104:107], a[192:199], v0
  s_waitcnt lgkmcnt(1)
  ds_read_b128 v[76:79], v4 offset:28672
  v_smfmac_f32_16x16x64_bf16 v[92:95], v[108:111], a[224:231], v0
  s_waitcnt lgkmcnt(1)
  ds_read_b128 v[80:83], v4 offset:29696
  v_smfmac_f32_16x16x64_bf16 v[92:95], v[68:71], a[240:247], v0
  ds_read_b128 v[60:63], v4 offset:26624
  v_smfmac_f32_16x16x64_bf16 v[96:99], v[104:107], a[200:207], v0
  ds_read_b128 v[64:67], v4 offset:27648
  v_smfmac_f32_16x16x64_bf16 v[96:99], v[108:111], a[232:239], v0
  ds_read_b128 v[28:31], v4 offset:30720
  s_nop 0
  v_cvt_pk_bf16_f32 v16, v92, v93
  v_cvt_pk_bf16_f32 v17, v94, v95
  v_bfi_b32 v16, 1, s57, v16
  v_smfmac_f32_16x16x64_bf16 v[96:99], v[68:71], a[248:255], v0
  buffer_store_dwordx2 v[16:17], v7, s[4:7], s20 offen offset:0 sc1
  v_smfmac_f32_16x16x64_bf16 v[36:39], v[104:107], a[208:215], v0
  ds_read_b128 v[32:35], v4 offset:31744
  v_smfmac_f32_16x16x64_bf16 v[36:39], v[108:111], v[52:59], v0
  s_waitcnt lgkmcnt(4)
  s_nop 0
  v_cvt_pk_bf16_f32 v18, v96, v97
  v_cvt_pk_bf16_f32 v19, v98, v99
  v_bfi_b32 v18, 1, s57, v18
  v_smfmac_f32_16x16x64_bf16 v[36:39], v[68:71], v[76:83], v0
  buffer_store_dwordx2 v[18:19], v7, s[4:7], s20 offen offset:64 sc1
  v_smfmac_f32_16x16x64_bf16 v[40:43], v[104:107], a[216:223], v0
  s_waitcnt lgkmcnt(2)
  ds_read_b128 v[116:119], v2 offset:31232
  v_smfmac_f32_16x16x64_bf16 v[40:43], v[108:111], v[60:67], v0
  s_waitcnt lgkmcnt(1)
  s_nop 0
  v_cvt_pk_bf16_f32 v20, v36, v37
  v_cvt_pk_bf16_f32 v21, v38, v39
  v_bfi_b32 v20, 1, s57, v20
  v_smfmac_f32_16x16x64_bf16 v[40:43], v[68:71], v[28:35], v0
  buffer_store_dwordx2 v[20:21], v7, s[4:7], s21 offen offset:0 sc1
  s_nop 6
  v_cvt_pk_bf16_f32 v22, v40, v41
  v_cvt_pk_bf16_f32 v23, v42, v43
  v_bfi_b32 v22, 1, s57, v22
  buffer_store_dwordx2 v[22:23], v7, s[4:7], s21 offen offset:64 sc1
  ds_read_b128 v[68:71], v4 offset:0
  ds_read_b128 v[72:75], v4 offset:1024
  ds_read_b128 v[76:79], v4 offset:4096
  ds_read_b128 v[80:83], v4 offset:5120
  ds_read_b128 v[84:87], v4 offset:8192
  ds_read_b128 v[88:91], v4 offset:9216
  ds_read_b128 v[92:95], v4 offset:2048
  ds_read_b128 v[96:99], v4 offset:3072
  ds_read_b128 v[100:103], v4 offset:6144
  ds_read_b128 v[104:107], v4 offset:7168
  ds_read_b128 v[108:111], v4 offset:10240
  ds_read_b128 v[112:115], v4 offset:11264
  v_mov_b64 v[16:17], 0
  v_mov_b64 v[18:19], 0
  v_mov_b64 v[20:21], 0
  v_mov_b64 v[22:23], 0
  v_mov_b64 v[24:25], 0
  v_mov_b64 v[26:27], 0
  s_mov_b32 s19, 0
  v_mov_b32 v49, -1
  ds_read_b64 v[44:45], v2 offset:32256
  s_waitcnt lgkmcnt(0)
  v_readfirstlane_b32 s38, v44
  v_readfirstlane_b32 s37, v45
  s_nop 0
  s_add_u32 s37, s37, 30
  s_cmp_ge_u32 s38, 30
  s_cselect_b32 s38, s37, s38
  s_cmp_ge_u32 s38, 64
  s_cselect_b32 s38, 100, s38
  s_sub_u32 s38, s38, 1
  s_max_i32 s30, s30, s38
  s_waitcnt vmcnt(0)
  buffer_load_dwordx4 v[52:55], v2, s[4:7], s22 offen offset:0 sc1
  buffer_load_dwordx4 v[56:59], v2, s[4:7], s22 offen offset:1024 sc1
  buffer_load_dwordx4 v[60:63], v2, s[4:7], s22 offen offset:2048 sc1
  buffer_load_dwordx4 v[64:67], v2, s[4:7], s22 offen offset:3072 sc1
  s_waitcnt lgkmcnt(12)
  s_waitcnt vmcnt(3)
  v_mfma_f32_16x16x32_bf16 v[120:123], v[116:119], v[52:55], 0
  v_xor_b32 v48, s57, v52
  v_bitop3_b32 v48, v48, v54, s57 bitop3:0xf6
  s_waitcnt vmcnt(2)
  v_mfma_f32_16x16x32_bf16 v[120:123], v[116:119], v[56:59], v[120:123]
  v_bitop3_b32 v48, v48, v56, s57 bitop3:0xf6
  v_bitop3_b32 v48, v48, v58, s57 bitop3:0xf6
  s_waitcnt vmcnt(1)
  v_mfma_f32_16x16x32_bf16 v[120:123], v[116:119], v[60:63], v[120:123]
  v_bitop3_b32 v48, v48, v60, s57 bitop3:0xf6
  v_bitop3_b32 v48, v48, v62, s57 bitop3:0xf6
  s_waitcnt vmcnt(0)
  v_mfma_f32_16x16x32_bf16 v[120:123], v[116:119], v[64:67], v[120:123]
  v_bitop3_b32 v48, v48, v64, s57 bitop3:0xf6
  v_bitop3_b32 v48, v48, v66, s57 bitop3:0xf6
  v_and_b32 v48, 1, v48
  v_cmp_ne_u32 vcc, 0, v48
  s_cbranch_vccnz T_p1re_159
T_p1ok_160:
  s_nop 2
  v_add_f32_dpp v120, v120, v120 row_ror:8 row_mask:0xf bank_mask:0xf
  v_add_f32_dpp v121, v121, v121 row_ror:8 row_mask:0xf bank_mask:0xf
  v_cvt_pk_bf16_f32 v48, v120, v121
  v_min_u32 v48, -2, v48
  buffer_store_dword v48, v8, s[4:7], s35 offen sc1
  buffer_store_dword v49, v8, s[4:7], s26 offen sc1
  s_barrier
  ds_read_b128 v[28:31], v2 offset:17408
  ds_read_b128 v[32:35], v2 offset:21504
  ds_read_b128 v[36:39], v2 offset:8192
  ds_read_b128 v[40:43], v2 offset:9216
  ds_read_b128 v[44:47], v2 offset:10240
  ds_read_b128 v[48:51], v2 offset:11264
  buffer_load_dwordx4 v[124:127], v2, s[4:7], s24 offen offset:1024 sc1
  buffer_load_dwordx4 v[116:119], v2, s[4:7], s25 offen offset:1024 sc1
  ds_read_b128 v[52:55], v2 offset:12288
  ds_read_b128 v[56:59], v2 offset:13312
  ds_read_b128 v[60:63], v2 offset:14336
  ds_read_b128 v[64:67], v2 offset:15360
  buffer_load_dwordx4 v[124:127], v2, s[4:7], s24 offen offset:1024 sc1
  buffer_load_dwordx4 v[116:119], v2, s[4:7], s25 offen offset:1024 sc1
  s_mov_b32 s19, 0
  s_branch T_loop_150
T_p1re_159:
  s_mov_b64 exec, vcc
  buffer_load_dwordx4 v[52:55], v2, s[4:7], s22 offen offset:0 sc1
  buffer_load_dwordx4 v[56:59], v2, s[4:7], s22 offen offset:1024 sc1
  buffer_load_dwordx4 v[60:63], v2, s[4:7], s22 offen offset:2048 sc1
  buffer_load_dwordx4 v[64:67], v2, s[4:7], s22 offen offset:3072 sc1
  s_mov_b64 exec, -1
  s_add_u32 s19, s19, 1
  s_cmp_gt_u32 s19, 32768
  s_cbranch_scc1 M_exit
  s_waitcnt vmcnt(3)
  v_mfma_f32_16x16x32_bf16 v[120:123], v[116:119], v[52:55], 0
  v_xor_b32 v48, s57, v52
  v_bitop3_b32 v48, v48, v54, s57 bitop3:0xf6
  s_waitcnt vmcnt(2)
  v_mfma_f32_16x16x32_bf16 v[120:123], v[116:119], v[56:59], v[120:123]
  v_bitop3_b32 v48, v48, v56, s57 bitop3:0xf6
  v_bitop3_b32 v48, v48, v58, s57 bitop3:0xf6
  s_waitcnt vmcnt(1)
  v_mfma_f32_16x16x32_bf16 v[120:123], v[116:119], v[60:63], v[120:123]
  v_bitop3_b32 v48, v48, v60, s57 bitop3:0xf6
  v_bitop3_b32 v48, v48, v62, s57 bitop3:0xf6
  s_waitcnt vmcnt(0)
  v_mfma_f32_16x16x32_bf16 v[120:123], v[116:119], v[64:67], v[120:123]
  v_bitop3_b32 v48, v48, v64, s57 bitop3:0xf6
  v_bitop3_b32 v48, v48, v66, s57 bitop3:0xf6
  v_and_b32 v48, 1, v48
  v_cmp_ne_u32 vcc, 0, v48
  s_cbranch_vccnz T_p1re_159
  s_branch T_p1ok_160
T_kvw_154:
  s_mov_b32 s19, 0
  s_branch T_kvok_162
T_kv_161:
  s_sleep 4
  s_add_u32 s19, s19, 1
  s_cmp_gt_u32 s19, 32768
  s_cbranch_scc1 M_exit
T_kvok_162:
  s_add_u32 s39, s99, 128
  s_mov_b32 s38, 0
  s_mov_b32 s37, 0
  s_atomic_or s38, s[58:59], s99 glc
  s_atomic_or s37, s[58:59], s39 glc
  s_waitcnt lgkmcnt(0)
  s_add_u32 s37, s37, 30
  s_cmp_ge_u32 s38, 30
  s_cselect_b32 s38, s37, s38
  s_cmp_ge_u32 s38, 64
  s_cselect_b32 s38, 100, s38
  s_sub_u32 s38, s38, 1
  s_max_i32 s30, s30, s38
  s_cmp_ge_i32 s14, s30
  s_cbranch_scc1 T_kv_161
  s_branch T_kvb_155
T_slow_156:
  s_nop 7
  v_max3_f32 v100, v16, v17, v18
  v_max3_f32 v100, v100, v19, v20
  v_max3_f32 v100, v100, v21, v22
  v_max3_f32 v100, v100, v23, v112
  v_max3_f32 v100, v100, v113, v114
  v_max_f32 v100, v100, v115
  v_mov_b32 v101, v100
  s_nop 1
  v_permlane32_swap_b32 v100, v101
  s_nop 1
  v_max_f32 v100, v100, v101
  v_mov_b32 v101, v100
  s_nop 1
  v_permlane16_swap_b32 v100, v101
  s_nop 1
  v_max_f32 v100, v100, v101
  v_sub_f32 v16, v16, v100
  v_sub_f32 v17, v17, v100
  v_sub_f32 v18, v18, v100
  v_sub_f32 v19, v19, v100
  v_exp_f32 v16, v16
  v_exp_f32 v17, v17
  v_exp_f32 v18, v18
  v_exp_f32 v19, v19
  v_sub_f32 v20, v20, v100
  v_sub_f32 v21, v21, v100
  v_sub_f32 v22, v22, v100
  v_sub_f32 v23, v23, v100
  v_exp_f32 v20, v20
  v_exp_f32 v21, v21
  v_exp_f32 v22, v22
  v_exp_f32 v23, v23
  v_sub_f32 v112, v112, v100
  v_sub_f32 v113, v113, v100
  v_sub_f32 v114, v114, v100
  v_sub_f32 v115, v115, v100
  v_exp_f32 v112, v112
  v_exp_f32 v113, v113
  v_exp_f32 v114, v114
  v_exp_f32 v115, v115
  s_nop 0
  v_cvt_pk_bf16_f32 v44, v16, v17
  v_cvt_pk_bf16_f32 v45, v18, v19
  v_cvt_pk_bf16_f32 v46, v20, v21
  v_cvt_pk_bf16_f32 v47, v22, v23
  v_cvt_pk_bf16_f32 v84, v112, v113
  v_cvt_pk_bf16_f32 v85, v114, v115
  v_cndmask_b32 v48, v84, 0, s[16:17]
  v_cndmask_b32 v49, v85, 0, s[16:17]
  v_cndmask_b32 v50, 0, v84, s[16:17]
  v_cndmask_b32 v51, 0, v85, s[16:17]
  s_nop 1
  v_mfma_f32_16x16x16_bf16 v[88:91], v[12:13], v[48:49], 0
  v_mfma_f32_16x16x16_bf16 v[24:27], v[120:121], v[48:49], 0
  v_mfma_f32_16x16x16_bf16 v[116:119], v[120:121], v[50:51], 0
  v_mfma_f32_16x16x32_bf16 v[88:91], v[12:15], v[44:47], v[88:91]
  v_mfma_f32_16x16x32_bf16 v[24:27], v[28:31], v[44:47], v[24:27]
  v_mfma_f32_16x16x32_bf16 v[116:119], v[32:35], v[44:47], v[116:119]
  s_nop 7
  s_nop 1
  v_rcp_f32 v89, v88
  s_nop 0
  v_mul_f32 v24, v89, v24
  v_mul_f32 v25, v89, v25
  s_branch T_back_157
T_w_135:
  s_mov_b32 s19, 0
  v_mov_b64 v[16:17], 0
  v_mov_b64 v[18:19], 0
  v_mov_b64 v[20:21], 0
  v_mov_b64 v[22:23], 0
  v_mov_b64 v[24:25], 0
  v_mov_b64 v[26:27], 0
  buffer_load_dwordx4 v[124:127], v2, s[4:7], s24 offen offset:2048 sc1
  buffer_load_dwordx4 v[116:119], v2, s[4:7], s25 offen offset:2048 sc1
  buffer_load_dwordx4 v[124:127], v2, s[4:7], s24 offen offset:2048 sc1
  buffer_load_dwordx4 v[116:119], v2, s[4:7], s25 offen offset:2048 sc1
  s_branch T_loop_163
.p2align 6
T_retry_164:
  s_mov_b64 exec, vcc
  buffer_load_dwordx4 v[124:127], v2, s[4:7], s24 offen offset:2048 sc1
  buffer_load_dwordx4 v[116:119], v2, s[4:7], s25 offen offset:2048 sc1
  s_mov_b64 exec, -1
  s_add_u32 s19, s19, 1
  s_cmp_gt_u32 s19, 32768
  s_cbranch_scc1 M_exit
T_loop_163:
  s_waitcnt vmcnt(3) lgkmcnt(0)
  v_max3_u32 v123, v124, v125, v126
  v_max_u32 v123, v123, v127
  v_mov_b32_dpp v120, v124 row_ror:8 row_mask:0xf bank_mask:0xf
  v_mov_b32_dpp v121, v125 row_ror:8 row_mask:0xf bank_mask:0xf
  s_waitcnt vmcnt(2)
  v_max3_u32 v123, v123, v116, v117
  v_max3_u32 v123, v123, v118, v119
  v_cmp_eq_u32 vcc, -1, v123
  s_cbranch_vccnz T_retry_164
  v_smfmac_f32_16x16x64_bf16 v[16:19], v[124:127], v[68:75], v0
  s_add_u32 s14, s14, 1
  ds_write_b128 v2, v[124:127] offset:2048
  v_mov_b32_dpp v122, v126 row_ror:8 row_mask:0xf bank_mask:0xf
  v_smfmac_f32_16x16x64_bf16 v[20:23], v[124:127], v[76:83], v0
  s_and_b32 s57, s14, 1
  v_mov_b32_dpp v123, v127 row_ror:8 row_mask:0xf bank_mask:0xf
  v_smfmac_f32_16x16x64_bf16 v[24:27], v[124:127], v[84:91], v0
  s_and_b32 s36, s14, 3
  ds_write_b128 v2, v[116:119] offset:6144
  v_smfmac_f32_16x16x64_bf16 v[16:19], v[120:123], v[92:99], v0
  s_lshl_b32 s36, s36, 13
  v_mov_b32_dpp v84, v116 row_ror:8 row_mask:0xf bank_mask:0xf
  v_smfmac_f32_16x16x64_bf16 v[20:23], v[120:123], v[100:107], v0
  s_add_u32 s26, s36, s23
  ds_read_b128 v[68:71], v4 offset:12288
  v_mov_b32_dpp v85, v117 row_ror:8 row_mask:0xf bank_mask:0xf
  v_smfmac_f32_16x16x64_bf16 v[24:27], v[120:123], v[108:115], v0
  s_add_u32 s36, s36, 8192
  ds_read_b128 v[72:75], v4 offset:13312
  v_mov_b32_dpp v86, v118 row_ror:8 row_mask:0xf bank_mask:0xf
  v_smfmac_f32_16x16x64_bf16 v[16:19], v[116:119], v[224:231], v0
  s_and_b32 s36, s36, 0x7fff
  ds_read_b128 v[76:79], v4 offset:14336
  v_mov_b32_dpp v87, v119 row_ror:8 row_mask:0xf bank_mask:0xf
  v_smfmac_f32_16x16x64_bf16 v[20:23], v[116:119], v[240:247], v0
  s_waitcnt lgkmcnt(3)
  s_barrier
  ds_read_b128 v[100:103], v2 offset:3072
  v_smfmac_f32_16x16x64_bf16 v[24:27], v[116:119], a[0:7], v0
  s_mov_b32 m0, s31
  ds_read_b128 v[120:123], v1 offset:3072
  v_smfmac_f32_16x16x64_bf16 v[16:19], v[84:87], v[232:239], v0
  s_cmp_ge_i32 s14, s30
  s_cbranch_scc1 T_kvw_167
T_kvb_168:
  v_smfmac_f32_16x16x64_bf16 v[20:23], v[84:87], v[248:255], v0
  ds_read_b128 v[80:83], v4 offset:15360
  v_smfmac_f32_16x16x64_bf16 v[24:27], v[84:87], a[8:15], v0
  s_waitcnt lgkmcnt(2)
  v_smfmac_f32_16x16x64_bf16 v[16:19], v[100:103], v[128:135], v0
  ds_read_b128 v[92:95], v2 offset:0
  buffer_load_dwordx4 v9, s[4:7], s27 offen sc1 lds
  v_smfmac_f32_16x16x64_bf16 v[20:23], v[100:103], v[144:151], v0
  ds_read_b128 v[96:99], v1 offset:0
  s_mov_b32 m0, s32
  v_smfmac_f32_16x16x64_bf16 v[24:27], v[100:103], v[68:75], v0
  s_waitcnt vmcnt(1) lgkmcnt(3)
  ds_read_b128 v[116:119], v2 offset:1024
  v_smfmac_f32_16x16x64_bf16 v[16:19], v[120:123], v[136:143], v0
  ds_read_b128 v[124:127], v1 offset:1024
  v_smfmac_f32_16x16x64_bf16 v[20:23], v[120:123], v[152:159], v0
  s_waitcnt lgkmcnt(4)
  ds_read_b128 v[104:107], v2 offset:7168
  buffer_load_dwordx4 v9, s[4:7], s27 offen offset:128 sc1 lds
  v_smfmac_f32_16x16x64_bf16 v[24:27], v[120:123], v[76:83], v0
  s_waitcnt lgkmcnt(4)
  ds_read_b128 v[108:111], v1 offset:7168
  s_mov_b32 m0, s33
  v_smfmac_f32_16x16x64_bf16 v[16:19], v[92:95], v[160:167], v0
  s_waitcnt lgkmcnt(4)
  ds_read_b128 v[112:115], v2 offset:4096
  v_smfmac_f32_16x16x64_bf16 v[16:19], v[96:99], v[168:175], v0
  s_waitcnt lgkmcnt(4)
  ds_read_b128 v[84:87], v1 offset:4096
  v_smfmac_f32_16x16x64_bf16 v[16:19], v[116:119], v[192:199], v0
  s_waitcnt lgkmcnt(4)
  ds_read_b128 v[88:91], v2 offset:5120
  buffer_load_dwordx4 v10, s[4:7], s28 offen sc1 lds
  v_smfmac_f32_16x16x64_bf16 v[16:19], v[124:127], v[200:207], v0
  s_waitcnt lgkmcnt(4)
  ds_read_b128 v[100:103], v1 offset:5120
  s_mov_b32 m0, s34
  v_smfmac_f32_16x16x64_bf16 v[16:19], v[104:107], a[16:23], v0
  s_waitcnt lgkmcnt(4)
  ds_read_b128 v[68:71], v4 offset:16384
  v_smfmac_f32_16x16x64_bf16 v[16:19], v[108:111], a[24:31], v0
  s_waitcnt lgkmcnt(4)
  ds_read_b128 v[72:75], v4 offset:17408
  v_smfmac_f32_16x16x64_bf16 v[16:19], v[112:115], a[64:71], v0
  s_waitcnt lgkmcnt(4)
  ds_read_b128 v[76:79], v4 offset:18432
  buffer_load_dwordx4 v10, s[4:7], s28 offen offset:256 sc1 lds
  v_smfmac_f32_16x16x64_bf16 v[16:19], v[84:87], a[72:79], v0
  s_waitcnt lgkmcnt(4)
  ds_read_b128 v[80:83], v4 offset:19456
  v_smfmac_f32_16x16x64_bf16 v[16:19], v[88:91], a[112:119], v0
  s_waitcnt lgkmcnt(4)
  v_smfmac_f32_16x16x64_bf16 v[16:19], v[100:103], a[120:127], v0
  s_add_u32 s24, s36, 145752064
  s_add_u32 s25, s36, 145756160
  v_smfmac_f32_16x16x64_bf16 v[20:23], v[92:95], v[176:183], v0
  s_add_u32 s35, s36, s23
  v_smfmac_f32_16x16x64_bf16 v[20:23], v[96:99], v[184:191], v0
  s_waitcnt lgkmcnt(2)
  v_smfmac_f32_16x16x64_bf16 v[20:23], v[116:119], v[68:75], v0
  s_waitcnt lgkmcnt(0)
  ds_read_b128 v[68:71], v4 offset:20480
  v_mul_f32 v16, s18, v16
  v_smfmac_f32_16x16x64_bf16 v[20:23], v[124:127], v[76:83], v0
  ds_read_b128 v[72:75], v4 offset:21504
  v_mul_f32 v17, s18, v17
  v_smfmac_f32_16x16x64_bf16 v[20:23], v[104:107], a[32:39], v0
  ds_read_b128 v[76:79], v4 offset:22528
  v_mul_f32 v18, s18, v18
  v_smfmac_f32_16x16x64_bf16 v[20:23], v[108:111], a[40:47], v0
  ds_read_b128 v[80:83], v4 offset:23552
  v_mul_f32 v19, s18, v19
  v_smfmac_f32_16x16x64_bf16 v[20:23], v[112:115], a[80:87], v0
  v_cvt_pk_bf16_f32 v120, v16, v17
  v_smfmac_f32_16x16x64_bf16 v[20:23], v[84:87], a[88:95], v0
  v_cvt_pk_bf16_f32 v121, v18, v19
  v_smfmac_f32_16x16x64_bf16 v[20:23], v[88:91], a[128:135], v0
  ds_write_b64 v5, v[120:121] offset:24576
  v_smfmac_f32_16x16x64_bf16 v[20:23], v[100:103], a[136:143], v0
  s_waitcnt lgkmcnt(3)
  v_smfmac_f32_16x16x64_bf16 v[24:27], v[92:95], v[68:75], v0
  s_waitcnt lgkmcnt(1)
  v_mov_b64 v[92:93], 0
  v_smfmac_f32_16x16x64_bf16 v[24:27], v[96:99], v[76:83], v0
  s_nop 1
  v_cvt_pk_bf16_f32 v122, v20, v21
  v_cvt_pk_bf16_f32 v123, v22, v23
  v_smfmac_f32_16x16x64_bf16 v[24:27], v[116:119], v[208:215], v0
  ds_write_b64 v5, v[122:123] offset:26880
  v_mov_b64 v[94:95], 0
  v_smfmac_f32_16x16x64_bf16 v[24:27], v[124:127], v[216:223], v0
  s_waitcnt lgkmcnt(1)
  s_barrier
  ds_read_b64_tr_b16 v[68:69], v6 offset:24576
  v_smfmac_f32_16x16x64_bf16 v[24:27], v[104:107], a[48:55], v0
  s_add_u32 s27, s27, 8192
  ds_read_b64_tr_b16 v[70:71], v6 offset:24640
  ds_read_b64_tr_b16 v[72:73], v6 offset:24832
  v_smfmac_f32_16x16x64_bf16 v[24:27], v[108:111], a[56:63], v0
  s_add_u32 s28, s28, 8192
  ds_read_b64_tr_b16 v[74:75], v6 offset:24896
  ds_read_b64_tr_b16 v[76:77], v6 offset:25088
  v_smfmac_f32_16x16x64_bf16 v[24:27], v[112:115], a[96:103], v0
  s_nop 0
  ds_read_b64_tr_b16 v[78:79], v6 offset:25152
  ds_read_b64_tr_b16 v[80:81], v6 offset:25344
  v_smfmac_f32_16x16x64_bf16 v[24:27], v[84:87], a[104:111], v0
  ds_read_b64_tr_b16 v[82:83], v6 offset:25408
  v_mov_b64 v[96:97], 0
  v_smfmac_f32_16x16x64_bf16 v[24:27], v[88:91], a[144:151], v0
  s_waitcnt lgkmcnt(8)
  s_barrier
  ds_read_b64_tr_b16 v[116:117], v6 offset:26880
  v_smfmac_f32_16x16x64_bf16 v[24:27], v[100:103], a[152:159], v0
  s_waitcnt lgkmcnt(7)
  ds_read_b64_tr_b16 v[118:119], v6 offset:26944
  buffer_store_dwordx2 v[122:123], v5, s[4:7], s29 offen sc1
  v_mfma_f32_16x16x32_bf16 v[16:19], v[36:39], v[68:71], 0
  s_waitcnt lgkmcnt(6)
  ds_read_b64_tr_b16 v[124:125], v6 offset:27136
  ds_read_b64_tr_b16 v[126:127], v6 offset:27200
  v_mfma_f32_16x16x32_bf16 v[16:19], v[40:43], v[72:75], v[16:19]
  s_waitcnt lgkmcnt(6)
  ds_read_b64_tr_b16 v[104:105], v6 offset:27392
  ds_read_b64_tr_b16 v[106:107], v6 offset:27456
  v_mfma_f32_16x16x32_bf16 v[16:19], v[44:47], v[76:79], v[16:19]
  s_waitcnt lgkmcnt(6)
  ds_read_b64_tr_b16 v[108:109], v6 offset:27648
  ds_read_b64_tr_b16 v[110:111], v6 offset:27712
  v_mfma_f32_16x16x32_bf16 v[16:19], v[48:51], v[80:83], v[16:19]
  s_waitcnt lgkmcnt(6)
  v_cvt_pk_bf16_f32 v120, v24, v25
  v_cvt_pk_bf16_f32 v121, v26, v27
  v_mov_b32 v86, s14
  v_mfma_f32_16x16x32_bf16 v[112:115], v[116:119], v[68:71], 0
  s_waitcnt lgkmcnt(4)
  buffer_store_dword v86, v3, s[4:7], s15 offen sc1
  buffer_store_dwordx2 v[120:121], v5, s[4:7], s29 offen offset:2304 sc1
  v_mov_b64 v[98:99], 0
  v_mfma_f32_16x16x32_bf16 v[112:115], v[124:127], v[72:75], v[112:115]
  s_waitcnt lgkmcnt(2)
  v_mov_b64 v[36:37], 0
  v_exp_f32 v100, v16
  v_mfma_f32_16x16x32_bf16 v[112:115], v[104:107], v[76:79], v[112:115]
  s_waitcnt lgkmcnt(0)
  v_exp_f32 v101, v17
  v_mfma_f32_16x16x32_bf16 v[112:115], v[108:111], v[80:83], v[112:115]
  s_add_u32 s29, s29, 147456
  v_exp_f32 v102, v18
  v_mfma_f32_16x16x32_bf16 v[20:23], v[52:55], v[68:71], 0
  s_cmp_eq_u32 s14, 63
  v_exp_f32 v103, v19
  v_mfma_f32_16x16x32_bf16 v[20:23], v[56:59], v[72:75], v[20:23]
  s_cbranch_scc1 M_tdone
  v_cvt_pk_bf16_f32 v44, v100, v101
  v_cvt_pk_bf16_f32 v45, v102, v103
  v_mfma_f32_16x16x32_bf16 v[20:23], v[60:63], v[76:79], v[20:23]
  v_exp_f32 v100, v112
  v_mfma_f32_16x16x32_bf16 v[20:23], v[64:67], v[80:83], v[20:23]
  v_exp_f32 v101, v113
  v_exp_f32 v102, v114
  v_exp_f32 v103, v115
  v_cvt_pk_bf16_f32 v84, v100, v101
  v_cvt_pk_bf16_f32 v85, v102, v103
  v_cndmask_b32 v48, v84, 0, s[16:17]
  v_cndmask_b32 v49, v85, 0, s[16:17]
  v_cndmask_b32 v50, 0, v84, s[16:17]
  v_cndmask_b32 v51, 0, v85, s[16:17]
  v_exp_f32 v100, v20
  v_mfma_f32_16x16x16_bf16 v[88:91], v[12:13], v[48:49], 0
  v_exp_f32 v101, v21
  v_mfma_f32_16x16x16_bf16 v[24:27], v[120:121], v[48:49], 0
  v_exp_f32 v102, v22
  v_mfma_f32_16x16x16_bf16 v[116:119], v[120:121], v[50:51], 0
  v_exp_f32 v103, v23
  v_cvt_pk_bf16_f32 v46, v100, v101
  v_cvt_pk_bf16_f32 v47, v102, v103
  v_mov_b64 v[38:39], 0
  s_nop 0
  v_mfma_f32_16x16x32_bf16 v[88:91], v[12:15], v[44:47], v[88:91]
  v_mov_b64 v[40:41], 0
  v_mov_b64 v[42:43], 0
  v_mfma_f32_16x16x32_bf16 v[24:27], v[28:31], v[44:47], v[24:27]
  ds_read_b128 v[52:55], v4 offset:24576
  ds_read_b128 v[56:59], v4 offset:25600
  v_mfma_f32_16x16x32_bf16 v[116:119], v[32:35], v[44:47], v[116:119]
  s_nop 1
  v_rcp_f32 v89, v88
  v_subrev_u32 v100, s54, v88
  v_cmp_le_u32 vcc, s55, v100
  v_mul_f32 v24, v89, v24
  v_mul_f32 v25, v89, v25
  s_cbranch_vccnz T_slow_169
T_back_170:
  v_cvt_pk_bf16_f32 v124, v24, v25
  v_pk_mul_f32 v[26:27], v[26:27], v[88:89] op_sel:[0,1] op_sel_hi:[1,1]
  v_pk_mul_f32 v[116:117], v[116:117], v[88:89] op_sel:[0,1] op_sel_hi:[1,1]
  v_pk_mul_f32 v[118:119], v[118:119], v[88:89] op_sel:[0,1] op_sel_hi:[1,1]
  v_cvt_pk_bf16_f32 v125, v26, v27
  v_cvt_pk_bf16_f32 v126, v116, v117
  v_cvt_pk_bf16_f32 v127, v118, v119
  ds_write_b128 v11, v[124:127] offset:30208
  s_nop 0
  v_smfmac_f32_16x16x64_bf16 v[92:95], v[124:127], a[160:167], v0
  v_smfmac_f32_16x16x64_bf16 v[96:99], v[124:127], a[168:175], v0
  v_smfmac_f32_16x16x64_bf16 v[36:39], v[124:127], a[176:183], v0
  v_smfmac_f32_16x16x64_bf16 v[40:43], v[124:127], a[184:191], v0
  s_waitcnt lgkmcnt(0)
  s_barrier
  ds_read_b128 v[104:107], v11 offset:30720
  ds_read_b128 v[108:111], v11 offset:29184
  ds_read_b128 v[68:71], v11 offset:29696
  s_waitcnt lgkmcnt(2)
  v_smfmac_f32_16x16x64_bf16 v[92:95], v[104:107], a[192:199], v0
  s_waitcnt lgkmcnt(1)
  ds_read_b128 v[76:79], v4 offset:28672
  v_smfmac_f32_16x16x64_bf16 v[92:95], v[108:111], a[224:231], v0
  s_waitcnt lgkmcnt(1)
  ds_read_b128 v[80:83], v4 offset:29696
  v_smfmac_f32_16x16x64_bf16 v[92:95], v[68:71], a[240:247], v0
  ds_read_b128 v[60:63], v4 offset:26624
  v_smfmac_f32_16x16x64_bf16 v[96:99], v[104:107], a[200:207], v0
  ds_read_b128 v[64:67], v4 offset:27648
  v_smfmac_f32_16x16x64_bf16 v[96:99], v[108:111], a[232:239], v0
  ds_read_b128 v[28:31], v4 offset:30720
  s_nop 0
  v_cvt_pk_bf16_f32 v16, v92, v93
  v_cvt_pk_bf16_f32 v17, v94, v95
  v_bfi_b32 v16, 1, s57, v16
  v_smfmac_f32_16x16x64_bf16 v[96:99], v[68:71], a[248:255], v0
  buffer_store_dwordx2 v[16:17], v7, s[4:7], s20 offen offset:0 sc1
  v_smfmac_f32_16x16x64_bf16 v[36:39], v[104:107], a[208:215], v0
  ds_read_b128 v[32:35], v4 offset:31744
  v_smfmac_f32_16x16x64_bf16 v[36:39], v[108:111], v[52:59], v0
  s_waitcnt lgkmcnt(4)
  s_nop 0
  v_cvt_pk_bf16_f32 v18, v96, v97
  v_cvt_pk_bf16_f32 v19, v98, v99
  v_bfi_b32 v18, 1, s57, v18
  v_smfmac_f32_16x16x64_bf16 v[36:39], v[68:71], v[76:83], v0
  buffer_store_dwordx2 v[18:19], v7, s[4:7], s20 offen offset:64 sc1
  v_smfmac_f32_16x16x64_bf16 v[40:43], v[104:107], a[216:223], v0
  s_waitcnt lgkmcnt(2)
  v_smfmac_f32_16x16x64_bf16 v[40:43], v[108:111], v[60:67], v0
  s_waitcnt lgkmcnt(0)
  s_nop 0
  v_cvt_pk_bf16_f32 v20, v36, v37
  v_cvt_pk_bf16_f32 v21, v38, v39
  v_bfi_b32 v20, 1, s57, v20
  v_smfmac_f32_16x16x64_bf16 v[40:43], v[68:71], v[28:35], v0
  buffer_store_dwordx2 v[20:21], v7, s[4:7], s21 offen offset:0 sc1
  s_nop 6
  v_cvt_pk_bf16_f32 v22, v40, v41
  v_cvt_pk_bf16_f32 v23, v42, v43
  v_bfi_b32 v22, 1, s57, v22
  buffer_store_dwordx2 v[22:23], v7, s[4:7], s21 offen offset:64 sc1
  ds_read_b128 v[68:71], v4 offset:0
  ds_read_b128 v[72:75], v4 offset:1024
  ds_read_b128 v[76:79], v4 offset:4096
  ds_read_b128 v[80:83], v4 offset:5120
  ds_read_b128 v[84:87], v4 offset:8192
  ds_read_b128 v[88:91], v4 offset:9216
  ds_read_b128 v[92:95], v4 offset:2048
  ds_read_b128 v[96:99], v4 offset:3072
  ds_read_b128 v[100:103], v4 offset:6144
  ds_read_b128 v[104:107], v4 offset:7168
  ds_read_b128 v[108:111], v4 offset:10240
  ds_read_b128 v[112:115], v4 offset:11264
  v_mov_b64 v[16:17], 0
  v_mov_b64 v[18:19], 0
  v_mov_b64 v[20:21], 0
  v_mov_b64 v[22:23], 0
  v_mov_b64 v[24:25], 0
  v_mov_b64 v[26:27], 0
  ds_read_b64 v[44:45], v2 offset:32256
  s_waitcnt lgkmcnt(0)
  v_readfirstlane_b32 s38, v44
  v_readfirstlane_b32 s37, v45
  s_nop 0
  s_add_u32 s37, s37, 30
  s_cmp_ge_u32 s38, 30
  s_cselect_b32 s38, s37, s38
  s_cmp_ge_u32 s38, 64
  s_cselect_b32 s38, 100, s38
  s_sub_u32 s38, s38, 1
  s_max_i32 s30, s30, s38
  s_waitcnt vmcnt(4)
  s_barrier
  ds_read_b128 v[28:31], v2 offset:18432
  ds_read_b128 v[32:35], v2 offset:22528
  ds_read_b128 v[36:39], v2 offset:8192
  ds_read_b128 v[40:43], v2 offset:9216
  ds_read_b128 v[44:47], v2 offset:10240
  ds_read_b128 v[48:51], v2 offset:11264
  buffer_load_dwordx4 v[124:127], v2, s[4:7], s24 offen offset:2048 sc1
  buffer_load_dwordx4 v[116:119], v2, s[4:7], s25 offen offset:2048 sc1
  ds_read_b128 v[52:55], v2 offset:12288
  ds_read_b128 v[56:59], v2 offset:13312
  ds_read_b128 v[60:63], v2 offset:14336
  ds_read_b128 v[64:67], v2 offset:15360
  buffer_load_dwordx4 v[124:127], v2, s[4:7], s24 offen offset:2048 sc1
  buffer_load_dwordx4 v[116:119], v2, s[4:7], s25 offen offset:2048 sc1
  s_mov_b32 s19, 0
  s_branch T_loop_163
T_kvw_167:
  s_mov_b32 s19, 0
  s_branch T_kvok_175
T_kv_174:
  s_sleep 4
  s_add_u32 s19, s19, 1
  s_cmp_gt_u32 s19, 32768
  s_cbranch_scc1 M_exit
T_kvok_175:
  s_add_u32 s39, s99, 128
  s_mov_b32 s38, 0
  s_mov_b32 s37, 0
  s_atomic_or s38, s[58:59], s99 glc
  s_atomic_or s37, s[58:59], s39 glc
  s_waitcnt lgkmcnt(0)
  s_add_u32 s37, s37, 30
  s_cmp_ge_u32 s38, 30
  s_cselect_b32 s38, s37, s38
  s_cmp_ge_u32 s38, 64
  s_cselect_b32 s38, 100, s38
  s_sub_u32 s38, s38, 1
  s_max_i32 s30, s30, s38
  s_cmp_ge_i32 s14, s30
  s_cbranch_scc1 T_kv_174
  s_branch T_kvb_168
T_slow_169:
  s_nop 7
  v_max3_f32 v100, v16, v17, v18
  v_max3_f32 v100, v100, v19, v20
  v_max3_f32 v100, v100, v21, v22
  v_max3_f32 v100, v100, v23, v112
  v_max3_f32 v100, v100, v113, v114
  v_max_f32 v100, v100, v115
  v_mov_b32 v101, v100
  s_nop 1
  v_permlane32_swap_b32 v100, v101
  s_nop 1
  v_max_f32 v100, v100, v101
  v_mov_b32 v101, v100
  s_nop 1
  v_permlane16_swap_b32 v100, v101
  s_nop 1
  v_max_f32 v100, v100, v101
  v_sub_f32 v16, v16, v100
  v_sub_f32 v17, v17, v100
  v_sub_f32 v18, v18, v100
  v_sub_f32 v19, v19, v100
  v_exp_f32 v16, v16
  v_exp_f32 v17, v17
  v_exp_f32 v18, v18
  v_exp_f32 v19, v19
  v_sub_f32 v20, v20, v100
  v_sub_f32 v21, v21, v100
  v_sub_f32 v22, v22, v100
  v_sub_f32 v23, v23, v100
  v_exp_f32 v20, v20
  v_exp_f32 v21, v21
  v_exp_f32 v22, v22
  v_exp_f32 v23, v23
  v_sub_f32 v112, v112, v100
  v_sub_f32 v113, v113, v100
  v_sub_f32 v114, v114, v100
  v_sub_f32 v115, v115, v100
  v_exp_f32 v112, v112
  v_exp_f32 v113, v113
  v_exp_f32 v114, v114
  v_exp_f32 v115, v115
  s_nop 0
  v_cvt_pk_bf16_f32 v44, v16, v17
  v_cvt_pk_bf16_f32 v45, v18, v19
  v_cvt_pk_bf16_f32 v46, v20, v21
  v_cvt_pk_bf16_f32 v47, v22, v23
  v_cvt_pk_bf16_f32 v84, v112, v113
  v_cvt_pk_bf16_f32 v85, v114, v115
  v_cndmask_b32 v48, v84, 0, s[16:17]
  v_cndmask_b32 v49, v85, 0, s[16:17]
  v_cndmask_b32 v50, 0, v84, s[16:17]
  v_cndmask_b32 v51, 0, v85, s[16:17]
  s_nop 1
  v_mfma_f32_16x16x16_bf16 v[88:91], v[12:13], v[48:49], 0
  v_mfma_f32_16x16x16_bf16 v[24:27], v[120:121], v[48:49], 0
  v_mfma_f32_16x16x16_bf16 v[116:119], v[120:121], v[50:51], 0
  v_mfma_f32_16x16x32_bf16 v[88:91], v[12:15], v[44:47], v[88:91]
  v_mfma_f32_16x16x32_bf16 v[24:27], v[28:31], v[44:47], v[24:27]
  v_mfma_f32_16x16x32_bf16 v[116:119], v[32:35], v[44:47], v[116:119]
  s_nop 7
  s_nop 1
  v_rcp_f32 v89, v88
  s_nop 0
  v_mul_f32 v24, v89, v24
  v_mul_f32 v25, v89, v25
  s_branch T_back_170
T_w_136:
  s_mov_b32 s19, 0
  v_mov_b64 v[16:17], 0
  v_mov_b64 v[18:19], 0
  v_mov_b64 v[20:21], 0
  v_mov_b64 v[22:23], 0
  v_mov_b64 v[24:25], 0
  v_mov_b64 v[26:27], 0
  buffer_load_dwordx4 v[124:127], v2, s[4:7], s24 offen offset:3072 sc1
  buffer_load_dwordx4 v[116:119], v2, s[4:7], s25 offen offset:3072 sc1
  buffer_load_dwordx4 v[124:127], v2, s[4:7], s24 offen offset:3072 sc1
  buffer_load_dwordx4 v[116:119], v2, s[4:7], s25 offen offset:3072 sc1
  s_branch T_loop_176
.p2align 6
T_retry_177:
  s_mov_b64 exec, vcc
  buffer_load_dwordx4 v[124:127], v2, s[4:7], s24 offen offset:3072 sc1
  buffer_load_dwordx4 v[116:119], v2, s[4:7], s25 offen offset:3072 sc1
  s_mov_b64 exec, -1
  s_add_u32 s19, s19, 1
  s_cmp_gt_u32 s19, 32768
  s_cbranch_scc1 M_exit
T_loop_176:
  s_waitcnt vmcnt(3) lgkmcnt(0)
  v_max3_u32 v123, v124, v125, v126
  v_max_u32 v123, v123, v127
  v_mov_b32_dpp v120, v124 row_ror:8 row_mask:0xf bank_mask:0xf
  v_mov_b32_dpp v121, v125 row_ror:8 row_mask:0xf bank_mask:0xf
  s_waitcnt vmcnt(2)
  v_max3_u32 v123, v123, v116, v117
  v_max3_u32 v123, v123, v118, v119
  v_cmp_eq_u32 vcc, -1, v123
  s_cbranch_vccnz T_retry_177
  v_smfmac_f32_16x16x64_bf16 v[16:19], v[124:127], v[68:75], v0
  s_add_u32 s14, s14, 1
  ds_write_b128 v2, v[124:127] offset:3072
  v_mov_b32_dpp v122, v126 row_ror:8 row_mask:0xf bank_mask:0xf
  v_smfmac_f32_16x16x64_bf16 v[20:23], v[124:127], v[76:83], v0
  s_and_b32 s57, s14, 1
  v_mov_b32_dpp v123, v127 row_ror:8 row_mask:0xf bank_mask:0xf
  v_smfmac_f32_16x16x64_bf16 v[24:27], v[124:127], v[84:91], v0
  s_and_b32 s36, s14, 3
  ds_write_b128 v2, v[116:119] offset:7168
  v_smfmac_f32_16x16x64_bf16 v[16:19], v[120:123], v[92:99], v0
  s_lshl_b32 s36, s36, 13
  v_mov_b32_dpp v84, v116 row_ror:8 row_mask:0xf bank_mask:0xf
  v_smfmac_f32_16x16x64_bf16 v[20:23], v[120:123], v[100:107], v0
  s_add_u32 s26, s36, s23
  ds_read_b128 v[68:71], v4 offset:12288
  v_mov_b32_dpp v85, v117 row_ror:8 row_mask:0xf bank_mask:0xf
  v_smfmac_f32_16x16x64_bf16 v[24:27], v[120:123], v[108:115], v0
  s_add_u32 s36, s36, 8192
  ds_read_b128 v[72:75], v4 offset:13312
  v_mov_b32_dpp v86, v118 row_ror:8 row_mask:0xf bank_mask:0xf
  v_smfmac_f32_16x16x64_bf16 v[16:19], v[116:119], v[224:231], v0
  s_and_b32 s36, s36, 0x7fff
  ds_read_b128 v[76:79], v4 offset:14336
  v_mov_b32_dpp v87, v119 row_ror:8 row_mask:0xf bank_mask:0xf
  v_smfmac_f32_16x16x64_bf16 v[20:23], v[116:119], v[240:247], v0
  s_waitcnt lgkmcnt(3)
  s_barrier
  ds_read_b128 v[100:103], v2 offset:2048
  v_smfmac_f32_16x16x64_bf16 v[24:27], v[116:119], a[0:7], v0
  s_mov_b32 m0, s31
  ds_read_b128 v[120:123], v1 offset:2048
  v_smfmac_f32_16x16x64_bf16 v[16:19], v[84:87], v[232:239], v0
  s_cmp_ge_i32 s14, s30
  s_cbranch_scc1 T_kvw_180
T_kvb_181:
  v_smfmac_f32_16x16x64_bf16 v[20:23], v[84:87], v[248:255], v0
  ds_read_b128 v[80:83], v4 offset:15360
  v_smfmac_f32_16x16x64_bf16 v[24:27], v[84:87], a[8:15], v0
  s_waitcnt lgkmcnt(2)
  v_smfmac_f32_16x16x64_bf16 v[16:19], v[100:103], v[128:135], v0
  ds_read_b128 v[92:95], v2 offset:1024
  v_smfmac_f32_16x16x64_bf16 v[20:23], v[100:103], v[144:151], v0
  ds_read_b128 v[96:99], v1 offset:1024
  buffer_load_dwordx4 v9, s[4:7], s27 offen sc1 lds
  v_smfmac_f32_16x16x64_bf16 v[24:27], v[100:103], v[68:75], v0
  s_waitcnt vmcnt(1) lgkmcnt(3)
  ds_read_b128 v[116:119], v2 offset:0
  s_mov_b32 m0, s32
  v_smfmac_f32_16x16x64_bf16 v[16:19], v[120:123], v[136:143], v0
  ds_read_b128 v[124:127], v1 offset:0
  v_smfmac_f32_16x16x64_bf16 v[20:23], v[120:123], v[152:159], v0
  s_waitcnt lgkmcnt(4)
  ds_read_b128 v[104:107], v2 offset:6144
  v_smfmac_f32_16x16x64_bf16 v[24:27], v[120:123], v[76:83], v0
  s_waitcnt lgkmcnt(4)
  ds_read_b128 v[108:111], v1 offset:6144
  buffer_load_dwordx4 v9, s[4:7], s27 offen offset:128 sc1 lds
  v_smfmac_f32_16x16x64_bf16 v[16:19], v[92:95], v[160:167], v0
  s_waitcnt lgkmcnt(4)
  ds_read_b128 v[112:115], v2 offset:5120
  s_mov_b32 m0, s33
  v_smfmac_f32_16x16x64_bf16 v[16:19], v[96:99], v[168:175], v0
  s_waitcnt lgkmcnt(4)
  ds_read_b128 v[84:87], v1 offset:5120
  v_smfmac_f32_16x16x64_bf16 v[16:19], v[116:119], v[192:199], v0
  s_waitcnt lgkmcnt(4)
  ds_read_b128 v[88:91], v2 offset:4096
  v_smfmac_f32_16x16x64_bf16 v[16:19], v[124:127], v[200:207], v0
  s_waitcnt lgkmcnt(4)
  ds_read_b128 v[100:103], v1 offset:4096
  buffer_load_dwordx4 v10, s[4:7], s28 offen sc1 lds
  v_smfmac_f32_16x16x64_bf16 v[16:19], v[104:107], a[16:23], v0
  s_waitcnt lgkmcnt(4)
  ds_read_b128 v[68:71], v4 offset:16384
  s_mov_b32 m0, s34
  v_smfmac_f32_16x16x64_bf16 v[16:19], v[108:111], a[24:31], v0
  s_waitcnt lgkmcnt(4)
  ds_read_b128 v[72:75], v4 offset:17408
  v_smfmac_f32_16x16x64_bf16 v[16:19], v[112:115], a[64:71], v0
  s_waitcnt lgkmcnt(4)
  ds_read_b128 v[76:79], v4 offset:18432
  v_smfmac_f32_16x16x64_bf16 v[16:19], v[84:87], a[72:79], v0
  s_waitcnt lgkmcnt(4)
  ds_read_b128 v[80:83], v4 offset:19456
  buffer_load_dwordx4 v10, s[4:7], s28 offen offset:256 sc1 lds
  v_smfmac_f32_16x16x64_bf16 v[16:19], v[88:91], a[112:119], v0
  s_waitcnt lgkmcnt(4)
  v_smfmac_f32_16x16x64_bf16 v[16:19], v[100:103], a[120:127], v0
  s_add_u32 s24, s36, 145752064
  s_add_u32 s25, s36, 145756160
  v_smfmac_f32_16x16x64_bf16 v[20:23], v[92:95], v[176:183], v0
  s_add_u32 s35, s36, s23
  v_smfmac_f32_16x16x64_bf16 v[20:23], v[96:99], v[184:191], v0
  s_waitcnt lgkmcnt(2)
  v_smfmac_f32_16x16x64_bf16 v[20:23], v[116:119], v[68:75], v0
  s_waitcnt lgkmcnt(0)
  ds_read_b128 v[68:71], v4 offset:20480
  v_mul_f32 v16, s18, v16
  v_smfmac_f32_16x16x64_bf16 v[20:23], v[124:127], v[76:83], v0
  ds_read_b128 v[72:75], v4 offset:21504
  v_mul_f32 v17, s18, v17
  v_smfmac_f32_16x16x64_bf16 v[20:23], v[104:107], a[32:39], v0
  ds_read_b128 v[76:79], v4 offset:22528
  v_mul_f32 v18, s18, v18
  v_smfmac_f32_16x16x64_bf16 v[20:23], v[108:111], a[40:47], v0
  ds_read_b128 v[80:83], v4 offset:23552
  v_mul_f32 v19, s18, v19
  v_smfmac_f32_16x16x64_bf16 v[20:23], v[112:115], a[80:87], v0
  v_cvt_pk_bf16_f32 v120, v16, v17
  v_smfmac_f32_16x16x64_bf16 v[20:23], v[84:87], a[88:95], v0
  v_cvt_pk_bf16_f32 v121, v18, v19
  v_smfmac_f32_16x16x64_bf16 v[20:23], v[88:91], a[128:135], v0
  ds_write_b64 v5, v[120:121] offset:24576
  v_smfmac_f32_16x16x64_bf16 v[20:23], v[100:103], a[136:143], v0
  s_waitcnt lgkmcnt(3)
  v_smfmac_f32_16x16x64_bf16 v[24:27], v[92:95], v[68:75], v0
  s_waitcnt lgkmcnt(1)
  v_mov_b64 v[92:93], 0
  v_smfmac_f32_16x16x64_bf16 v[24:27], v[96:99], v[76:83], v0
  s_nop 1
  v_cvt_pk_bf16_f32 v122, v20, v21
  v_cvt_pk_bf16_f32 v123, v22, v23
  v_smfmac_f32_16x16x64_bf16 v[24:27], v[116:119], v[208:215], v0
  ds_write_b64 v5, v[122:123] offset:26880
  v_mov_b64 v[94:95], 0
  v_smfmac_f32_16x16x64_bf16 v[24:27], v[124:127], v[216:223], v0
  s_waitcnt lgkmcnt(1)
  s_barrier
  ds_read_b64_tr_b16 v[68:69], v6 offset:24576
  v_smfmac_f32_16x16x64_bf16 v[24:27], v[104:107], a[48:55], v0
  s_add_u32 s27, s27, 8192
  ds_read_b64_tr_b16 v[70:71], v6 offset:24640
  ds_read_b64_tr_b16 v[72:73], v6 offset:24832
  v_smfmac_f32_16x16x64_bf16 v[24:27], v[108:111], a[56:63], v0
  s_add_u32 s28, s28, 8192
  ds_read_b64_tr_b16 v[74:75], v6 offset:24896
  ds_read_b64_tr_b16 v[76:77], v6 offset:25088
  v_smfmac_f32_16x16x64_bf16 v[24:27], v[112:115], a[96:103], v0
  s_nop 0
  ds_read_b64_tr_b16 v[78:79], v6 offset:25152
  ds_read_b64_tr_b16 v[80:81], v6 offset:25344
  v_smfmac_f32_16x16x64_bf16 v[24:27], v[84:87], a[104:111], v0
  ds_read_b64_tr_b16 v[82:83], v6 offset:25408
  v_mov_b64 v[96:97], 0
  v_smfmac_f32_16x16x64_bf16 v[24:27], v[88:91], a[144:151], v0
  s_waitcnt lgkmcnt(8)
  s_barrier
  ds_read_b64_tr_b16 v[116:117], v6 offset:26880
  v_smfmac_f32_16x16x64_bf16 v[24:27], v[100:103], a[152:159], v0
  s_waitcnt lgkmcnt(7)
  ds_read_b64_tr_b16 v[118:119], v6 offset:26944
  buffer_store_dwordx2 v[122:123], v5, s[4:7], s29 offen sc1
  v_mfma_f32_16x16x32_bf16 v[16:19], v[36:39], v[68:71], 0
  s_waitcnt lgkmcnt(6)
  ds_read_b64_tr_b16 v[124:125], v6 offset:27136
  ds_read_b64_tr_b16 v[126:127], v6 offset:27200
  v_mfma_f32_16x16x32_bf16 v[16:19], v[40:43], v[72:75], v[16:19]
  s_waitcnt lgkmcnt(6)
  ds_read_b64_tr_b16 v[104:105], v6 offset:27392
  ds_read_b64_tr_b16 v[106:107], v6 offset:27456
  v_mfma_f32_16x16x32_bf16 v[16:19], v[44:47], v[76:79], v[16:19]
  s_waitcnt lgkmcnt(6)
  ds_read_b64_tr_b16 v[108:109], v6 offset:27648
  ds_read_b64_tr_b16 v[110:111], v6 offset:27712
  v_mfma_f32_16x16x32_bf16 v[16:19], v[48:51], v[80:83], v[16:19]
  s_waitcnt lgkmcnt(6)
  s_mov_b32 m0, 32256
  v_cvt_pk_bf16_f32 v120, v24, v25
  v_cvt_pk_bf16_f32 v121, v26, v27
  v_mfma_f32_16x16x32_bf16 v[112:115], v[116:119], v[68:71], 0
  s_waitcnt lgkmcnt(4)
  buffer_load_dword v3, s[4:7], s99 offen sc1 lds
  buffer_store_dwordx2 v[120:121], v5, s[4:7], s29 offen offset:2304 sc1
  v_mov_b64 v[98:99], 0
  v_mfma_f32_16x16x32_bf16 v[112:115], v[124:127], v[72:75], v[112:115]
  s_waitcnt lgkmcnt(2)
  v_mov_b64 v[36:37], 0
  v_exp_f32 v100, v16
  v_mfma_f32_16x16x32_bf16 v[112:115], v[104:107], v[76:79], v[112:115]
  s_waitcnt lgkmcnt(0)
  v_exp_f32 v101, v17
  v_mfma_f32_16x16x32_bf16 v[112:115], v[108:111], v[80:83], v[112:115]
  s_add_u32 s29, s29, 147456
  v_exp_f32 v102, v18
  v_mfma_f32_16x16x32_bf16 v[20:23], v[52:55], v[68:71], 0
  s_cmp_eq_u32 s14, 63
  v_exp_f32 v103, v19
  v_mfma_f32_16x16x32_bf16 v[20:23], v[56:59], v[72:75], v[20:23]
  s_cbranch_scc1 M_tdone
  v_cvt_pk_bf16_f32 v44, v100, v101
  v_cvt_pk_bf16_f32 v45, v102, v103
  v_mfma_f32_16x16x32_bf16 v[20:23], v[60:63], v[76:79], v[20:23]
  v_exp_f32 v100, v112
  v_mfma_f32_16x16x32_bf16 v[20:23], v[64:67], v[80:83], v[20:23]
  v_exp_f32 v101, v113
  v_exp_f32 v102, v114
  v_exp_f32 v103, v115
  v_cvt_pk_bf16_f32 v84, v100, v101
  v_cvt_pk_bf16_f32 v85, v102, v103
  v_cndmask_b32 v48, v84, 0, s[16:17]
  v_cndmask_b32 v49, v85, 0, s[16:17]
  v_cndmask_b32 v50, 0, v84, s[16:17]
  v_cndmask_b32 v51, 0, v85, s[16:17]
  v_exp_f32 v100, v20
  v_mfma_f32_16x16x16_bf16 v[88:91], v[12:13], v[48:49], 0
  v_exp_f32 v101, v21
  v_mfma_f32_16x16x16_bf16 v[24:27], v[120:121], v[48:49], 0
  v_exp_f32 v102, v22
  v_mfma_f32_16x16x16_bf16 v[116:119], v[120:121], v[50:51], 0
  v_exp_f32 v103, v23
  v_cvt_pk_bf16_f32 v46, v100, v101
  v_cvt_pk_bf16_f32 v47, v102, v103
  v_mov_b64 v[38:39], 0
  s_nop 0
  v_mfma_f32_16x16x32_bf16 v[88:91], v[12:15], v[44:47], v[88:91]
  v_mov_b64 v[40:41], 0
  v_mov_b64 v[42:43], 0
  v_mfma_f32_16x16x32_bf16 v[24:27], v[28:31], v[44:47], v[24:27]
  ds_read_b128 v[52:55], v4 offset:24576
  ds_read_b128 v[56:59], v4 offset:25600
  v_mfma_f32_16x16x32_bf16 v[116:119], v[32:35], v[44:47], v[116:119]
  s_nop 1
  v_rcp_f32 v89, v88
  v_subrev_u32 v100, s54, v88
  v_cmp_le_u32 vcc, s55, v100
  v_mul_f32 v24, v89, v24
  v_mul_f32 v25, v89, v25
  s_cbranch_vccnz T_slow_182
T_back_183:
  v_cvt_pk_bf16_f32 v124, v24, v25
  v_pk_mul_f32 v[26:27], v[26:27], v[88:89] op_sel:[0,1] op_sel_hi:[1,1]
  v_pk_mul_f32 v[116:117], v[116:117], v[88:89] op_sel:[0,1] op_sel_hi:[1,1]
  v_pk_mul_f32 v[118:119], v[118:119], v[88:89] op_sel:[0,1] op_sel_hi:[1,1]
  v_cvt_pk_bf16_f32 v125, v26, v27
  v_cvt_pk_bf16_f32 v126, v116, v117
  v_cvt_pk_bf16_f32 v127, v118, v119
  ds_write_b128 v11, v[124:127] offset:30720
  s_nop 0
  v_smfmac_f32_16x16x64_bf16 v[92:95], v[124:127], a[160:167], v0
  v_smfmac_f32_16x16x64_bf16 v[96:99], v[124:127], a[168:175], v0
  v_smfmac_f32_16x16x64_bf16 v[36:39], v[124:127], a[176:183], v0
  v_smfmac_f32_16x16x64_bf16 v[40:43], v[124:127], a[184:191], v0
  s_waitcnt lgkmcnt(0)
  s_barrier
  ds_read_b128 v[104:107], v11 offset:30208
  ds_read_b128 v[108:111], v11 offset:29696
  ds_read_b128 v[68:71], v11 offset:29184
  s_waitcnt lgkmcnt(2)
  v_smfmac_f32_16x16x64_bf16 v[92:95], v[104:107], a[192:199], v0
  s_waitcnt lgkmcnt(1)
  ds_read_b128 v[76:79], v4 offset:28672
  v_smfmac_f32_16x16x64_bf16 v[92:95], v[108:111], a[224:231], v0
  s_waitcnt lgkmcnt(1)
  ds_read_b128 v[80:83], v4 offset:29696
  v_smfmac_f32_16x16x64_bf16 v[92:95], v[68:71], a[240:247], v0
  ds_read_b128 v[60:63], v4 offset:26624
  v_smfmac_f32_16x16x64_bf16 v[96:99], v[104:107], a[200:207], v0
  ds_read_b128 v[64:67], v4 offset:27648
  v_smfmac_f32_16x16x64_bf16 v[96:99], v[108:111], a[232:239], v0
  ds_read_b128 v[28:31], v4 offset:30720
  s_nop 0
  v_cvt_pk_bf16_f32 v16, v92, v93
  v_cvt_pk_bf16_f32 v17, v94, v95
  v_bfi_b32 v16, 1, s57, v16
  v_smfmac_f32_16x16x64_bf16 v[96:99], v[68:71], a[248:255], v0
  buffer_store_dwordx2 v[16:17], v7, s[4:7], s20 offen offset:0 sc1
  v_smfmac_f32_16x16x64_bf16 v[36:39], v[104:107], a[208:215], v0
  ds_read_b128 v[32:35], v4 offset:31744
  v_smfmac_f32_16x16x64_bf16 v[36:39], v[108:111], v[52:59], v0
  s_waitcnt lgkmcnt(4)
  s_nop 0
  v_cvt_pk_bf16_f32 v18, v96, v97
  v_cvt_pk_bf16_f32 v19, v98, v99
  v_bfi_b32 v18, 1, s57, v18
  v_smfmac_f32_16x16x64_bf16 v[36:39], v[68:71], v[76:83], v0
  buffer_store_dwordx2 v[18:19], v7, s[4:7], s20 offen offset:64 sc1
  v_smfmac_f32_16x16x64_bf16 v[40:43], v[104:107], a[216:223], v0
  s_waitcnt lgkmcnt(2)
  v_smfmac_f32_16x16x64_bf16 v[40:43], v[108:111], v[60:67], v0
  s_waitcnt lgkmcnt(0)
  s_nop 0
  v_cvt_pk_bf16_f32 v20, v36, v37
  v_cvt_pk_bf16_f32 v21, v38, v39
  v_bfi_b32 v20, 1, s57, v20
  v_smfmac_f32_16x16x64_bf16 v[40:43], v[68:71], v[28:35], v0
  buffer_store_dwordx2 v[20:21], v7, s[4:7], s21 offen offset:0 sc1
  s_nop 6
  v_cvt_pk_bf16_f32 v22, v40, v41
  v_cvt_pk_bf16_f32 v23, v42, v43
  v_bfi_b32 v22, 1, s57, v22
  buffer_store_dwordx2 v[22:23], v7, s[4:7], s21 offen offset:64 sc1
  ds_read_b128 v[68:71], v4 offset:0
  ds_read_b128 v[72:75], v4 offset:1024
  ds_read_b128 v[76:79], v4 offset:4096
  ds_read_b128 v[80:83], v4 offset:5120
  ds_read_b128 v[84:87], v4 offset:8192
  ds_read_b128 v[88:91], v4 offset:9216
  ds_read_b128 v[92:95], v4 offset:2048
  ds_read_b128 v[96:99], v4 offset:3072
  ds_read_b128 v[100:103], v4 offset:6144
  ds_read_b128 v[104:107], v4 offset:7168
  ds_read_b128 v[108:111], v4 offset:10240
  ds_read_b128 v[112:115], v4 offset:11264
  v_mov_b64 v[16:17], 0
  v_mov_b64 v[18:19], 0
  v_mov_b64 v[20:21], 0
  v_mov_b64 v[22:23], 0
  v_mov_b64 v[24:25], 0
  v_mov_b64 v[26:27], 0
  ds_read_b64 v[44:45], v2 offset:32256
  s_waitcnt lgkmcnt(0)
  v_readfirstlane_b32 s38, v44
  v_readfirstlane_b32 s37, v45
  s_nop 0
  s_add_u32 s37, s37, 30
  s_cmp_ge_u32 s38, 30
  s_cselect_b32 s38, s37, s38
  s_cmp_ge_u32 s38, 64
  s_cselect_b32 s38, 100, s38
  s_sub_u32 s38, s38, 1
  s_max_i32 s30, s30, s38
  s_waitcnt vmcnt(4)
  s_barrier
  ds_read_b128 v[28:31], v2 offset:19456
  ds_read_b128 v[32:35], v2 offset:23552
  ds_read_b128 v[36:39], v2 offset:8192
  ds_read_b128 v[40:43], v2 offset:9216
  ds_read_b128 v[44:47], v2 offset:10240
  ds_read_b128 v[48:51], v2 offset:11264
  buffer_load_dwordx4 v[124:127], v2, s[4:7], s24 offen offset:3072 sc1
  buffer_load_dwordx4 v[116:119], v2, s[4:7], s25 offen offset:3072 sc1
  ds_read_b128 v[52:55], v2 offset:12288
  ds_read_b128 v[56:59], v2 offset:13312
  ds_read_b128 v[60:63], v2 offset:14336
  ds_read_b128 v[64:67], v2 offset:15360
  buffer_load_dwordx4 v[124:127], v2, s[4:7], s24 offen offset:3072 sc1
  buffer_load_dwordx4 v[116:119], v2, s[4:7], s25 offen offset:3072 sc1
  s_mov_b32 s19, 0
  s_branch T_loop_176
T_kvw_180:
  s_mov_b32 s19, 0
  s_branch T_kvok_188
T_kv_187:
  s_sleep 4
  s_add_u32 s19, s19, 1
  s_cmp_gt_u32 s19, 32768
  s_cbranch_scc1 M_exit
T_kvok_188:
  s_add_u32 s39, s99, 128
  s_mov_b32 s38, 0
  s_mov_b32 s37, 0
  s_atomic_or s38, s[58:59], s99 glc
  s_atomic_or s37, s[58:59], s39 glc
  s_waitcnt lgkmcnt(0)
  s_add_u32 s37, s37, 30
  s_cmp_ge_u32 s38, 30
  s_cselect_b32 s38, s37, s38
  s_cmp_ge_u32 s38, 64
  s_cselect_b32 s38, 100, s38
  s_sub_u32 s38, s38, 1
  s_max_i32 s30, s30, s38
  s_cmp_ge_i32 s14, s30
  s_cbranch_scc1 T_kv_187
  s_branch T_kvb_181
T_slow_182:
  s_nop 7
  v_max3_f32 v100, v16, v17, v18
  v_max3_f32 v100, v100, v19, v20
  v_max3_f32 v100, v100, v21, v22
  v_max3_f32 v100, v100, v23, v112
  v_max3_f32 v100, v100, v113, v114
  v_max_f32 v100, v100, v115
  v_mov_b32 v101, v100
  s_nop 1
  v_permlane32_swap_b32 v100, v101
  s_nop 1
  v_max_f32 v100, v100, v101
  v_mov_b32 v101, v100
  s_nop 1
  v_permlane16_swap_b32 v100, v101
  s_nop 1
  v_max_f32 v100, v100, v101
  v_sub_f32 v16, v16, v100
  v_sub_f32 v17, v17, v100
  v_sub_f32 v18, v18, v100
  v_sub_f32 v19, v19, v100
  v_exp_f32 v16, v16
  v_exp_f32 v17, v17
  v_exp_f32 v18, v18
  v_exp_f32 v19, v19
  v_sub_f32 v20, v20, v100
  v_sub_f32 v21, v21, v100
  v_sub_f32 v22, v22, v100
  v_sub_f32 v23, v23, v100
  v_exp_f32 v20, v20
  v_exp_f32 v21, v21
  v_exp_f32 v22, v22
  v_exp_f32 v23, v23
  v_sub_f32 v112, v112, v100
  v_sub_f32 v113, v113, v100
  v_sub_f32 v114, v114, v100
  v_sub_f32 v115, v115, v100
  v_exp_f32 v112, v112
  v_exp_f32 v113, v113
  v_exp_f32 v114, v114
  v_exp_f32 v115, v115
  s_nop 0
  v_cvt_pk_bf16_f32 v44, v16, v17
  v_cvt_pk_bf16_f32 v45, v18, v19
  v_cvt_pk_bf16_f32 v46, v20, v21
  v_cvt_pk_bf16_f32 v47, v22, v23
  v_cvt_pk_bf16_f32 v84, v112, v113
  v_cvt_pk_bf16_f32 v85, v114, v115
  v_cndmask_b32 v48, v84, 0, s[16:17]
  v_cndmask_b32 v49, v85, 0, s[16:17]
  v_cndmask_b32 v50, 0, v84, s[16:17]
  v_cndmask_b32 v51, 0, v85, s[16:17]
  s_nop 1
  v_mfma_f32_16x16x16_bf16 v[88:91], v[12:13], v[48:49], 0
  v_mfma_f32_16x16x16_bf16 v[24:27], v[120:121], v[48:49], 0
  v_mfma_f32_16x16x16_bf16 v[116:119], v[120:121], v[50:51], 0
  v_mfma_f32_16x16x32_bf16 v[88:91], v[12:15], v[44:47], v[88:91]
  v_mfma_f32_16x16x32_bf16 v[24:27], v[28:31], v[44:47], v[24:27]
  v_mfma_f32_16x16x32_bf16 v[116:119], v[32:35], v[44:47], v[116:119]
  s_nop 7
  s_nop 1
  v_rcp_f32 v89, v88
  s_nop 0
  v_mul_f32 v24, v89, v24
  v_mul_f32 v25, v89, v25
  s_branch T_back_183
M_tdone:
  v_mov_b32 v16, 64
  v_or_b32 v17, s13, v2
  v_min_u32 v17, 1, v17
  v_lshlrev_b32 v17, 30, v17
  s_waitcnt vmcnt(0)
  s_barrier
  buffer_store_dword v16, v17, s[4:7], s15 offen sc1
M_done:
M_exit:
  s_endpgm
.p2align 6
.type M_table,@object
M_table:
.long 0x1, 0x3f, 0xffffffff, 0x17, 0x1, 0x7, 0x800, 0x0, 0x8, 0x0, 0x0, 0x0, 0x0, 0x0, 0x0, 0x0
.long 0x1, 0x28, 0xffffffff, 0x1b, 0x1, 0x6, 0x1000, 0x0, 0x8, 0x1, 0x0, 0x0, 0x0, 0x0, 0x0, 0x0
.long 0x2, 0x0, 0x1, 0x1e, 0x1, 0x5, 0x1800, 0x0, 0x8, 0x0, 0x0, 0x0, 0x0, 0x0, 0x0, 0x0
.long 0x2, 0x1e, 0x1, 0x22, 0x1, 0x4, 0x2000, 0x0, 0x8, 0x1, 0x0, 0x0, 0x0, 0x0, 0x0, 0x0
.long 0x0, 0x0, 0x1, 0x20, 0x2, 0x3, 0x20, 0x0, 0x8, 0x2, 0x0, 0x0, 0x0, 0x0, 0x0, 0x0
.long 0x0, 0x3f, 0xffffffff, 0x20, 0x2, 0x2, 0x18, 0x1, 0x10, 0x0, 0x0, 0x0, 0x0, 0x0, 0x0, 0x0
.long 0x1, 0xd, 0xffffffff, 0xe, 0x0, 0x0, 0x8, 0x0, 0x8, 0x2, 0x0, 0x0, 0x0, 0x0, 0x0, 0x0
.size M_table, 448
.section .rodata,"a"
.p2align 6
.amdhsa_kernel gated_mix__compressed_kv_cla__memory_aug_recurrent_mem_tr__prompt_kernel
.amdhsa_next_free_vgpr 512
.amdhsa_next_free_sgpr 102
.amdhsa_accum_offset 256
.amdhsa_group_segment_fixed_size 0
.amdhsa_kernarg_size 136
.amdhsa_user_sgpr_count 2
.amdhsa_user_sgpr_kernarg_segment_ptr 1
.amdhsa_system_sgpr_workgroup_id_x 1
.end_amdhsa_kernel
```

```asm
; @launch grid=(256,1,1) block=(256,1,1) lds=163840
.amdgcn_target "amdgcn-amd-amdhsa--gfx950"
.text
.globl gated_mix__compressed_kv_cla__memory_aug_recurrent_mem_tr__prompt_kernel
.p2align 8
.type gated_mix__compressed_kv_cla__memory_aug_recurrent_mem_tr__prompt_kernel,@function
gated_mix__compressed_kv_cla__memory_aug_recurrent_mem_tr__prompt_kernel:
  s_cmp_ge_u32 s2, 256
  s_cbranch_scc1 M_exit
  s_load_dwordx4 s[72:75], s[0:1], 120
  v_lshrrev_b32 v3, 6, v0
  v_and_b32 v1, 63, v0
  v_readfirstlane_b32 s16, v3
  v_lshlrev_b32 v2, 4, v1
  s_and_b32 s76, s2, 7
  s_lshr_b32 s77, s2, 3
  s_sub_u32 s66, s76, 1
  s_and_b32 s66, s66, 7
  s_lshl_b32 s66, s66, 5
  s_add_u32 s66, s66, s77
  s_lshl_b32 s31, s66, 7
  s_add_u32 s31, s31, 148897792
  s_waitcnt lgkmcnt(0)
  s_mov_b64 s[4:5], s[74:75]
  s_mov_b64 s[74:75], s[72:73]
  s_mov_b64 s[72:73], s[4:5]
  s_and_b32 s5, s5, 0xffff
  s_mov_b32 s6, 268435456
  s_mov_b32 s7, 0x20000
  s_cmp_eq_u32 s76, 0
  s_cbranch_scc1 M_team
  s_mul_i32 s64, s66, 9363
  s_lshr_b32 s64, s64, 16
  s_mul_i32 s67, s64, 7
  s_sub_u32 s65, s66, s67
  s_lshl_b32 s67, s67, 7
  s_add_u32 s67, s67, 148897792
  s_getpc_b64 s[76:77]
M_pc:
  s_add_u32 s76, s76, M_table-M_pc
  s_addc_u32 s77, s77, 0
  s_lshl_b32 s26, s65, 6
  s_load_dwordx16 s[48:63], s[76:77], s26
  s_waitcnt lgkmcnt(0)
  s_mov_b32 s23, s51
  s_cmp_lg_u32 s48, 1
  s_cbranch_scc1 M_nobpf
  s_load_dwordx8 s[36:43], s[0:1], 64
  s_mul_i32 s76, s64, 3
  s_add_u32 s76, s76, s57
  v_lshlrev_b32 v4, 7, v0
  s_mov_b32 s10, 4194304
  s_mov_b32 s11, 0x20000
  s_waitcnt lgkmcnt(0)
  s_mov_b32 s8, s42
  s_and_b32 s9, s43, 0xffff
  s_mul_i32 s77, s76, 43776
  s_add_u32 s77, s77, 0
  v_min_u32 v5, 32640, v4
  v_add_u32 v5, s77, v5
  s_add_u32 s77, s77, 32768
  buffer_load_dword v6, v5, s[8:11], 0 offen
  v_min_u32 v5, 10880, v4
  v_add_u32 v5, s77, v5
  s_add_u32 s77, s77, 32768
  buffer_load_dword v6, v5, s[8:11], 0 offen
  s_mov_b32 s8, s38
  s_and_b32 s9, s39, 0xffff
  s_mul_i32 s77, s76, 21888
  s_add_u32 s77, s77, 2097152
  v_min_u32 v5, 21760, v4
  v_add_u32 v5, s77, v5
  s_add_u32 s77, s77, 32768
  buffer_load_dword v6, v5, s[8:11], 0 offen
  s_mov_b32 s8, s40
  s_and_b32 s9, s41, 0xffff
  s_mul_i32 s77, s76, 21888
  s_add_u32 s77, s77, 2097152
  v_min_u32 v5, 21760, v4
  v_add_u32 v5, s77, v5
  s_add_u32 s77, s77, 32768
  buffer_load_dword v6, v5, s[8:11], 0 offen
  s_mov_b32 s8, s36
  s_and_b32 s9, s37, 0xffff
  s_mul_i32 s77, s76, 21888
  s_add_u32 s77, s77, 2097152
  v_min_u32 v5, 21760, v4
  v_add_u32 v5, s77, v5
  s_add_u32 s77, s77, 32768
  buffer_load_dword v6, v5, s[8:11], 0 offen
  s_waitcnt vmcnt(0)
M_nobpf:
  s_lshr_b32 s29, s16, 1
  s_cmp_eq_u32 s29, 0
  s_cselect_b32 s26, 2, 8
  s_cselect_b32 s27, 3, 4
  s_cselect_b32 s28, 9, 10
  s_cmp_eq_u32 s48, 1
  s_cselect_b32 s26, s27, s26
  s_cmp_eq_u32 s48, 2
  s_cselect_b32 s26, s28, s26
  s_lshl_b32 s26, s26, 3
  s_load_dwordx2 s[8:9], s[0:1], s26
  s_cmp_eq_u32 s48, 1
  s_cselect_b32 s26, 8, 0
  s_load_dwordx2 s[12:13], s[0:1], s26
  s_cmp_eq_u32 s29, 0
  s_cselect_b32 s21, 0, 3
  s_cselect_b32 s27, 1, 2
  s_cselect_b32 s28, 4, 5
  s_cmp_eq_u32 s48, 1
  s_cselect_b32 s21, s27, s21
  s_cmp_eq_u32 s48, 2
  s_cselect_b32 s21, s28, s21
  s_lshl_b32 s21, s21, 5
  s_add_u32 s21, s21, s64
  s_lshl_b32 s21, s21, 6
  s_add_u32 s21, s21, s49
  s_and_b32 s27, s16, 1
  s_lshl_b32 s21, s21, 1
  s_add_u32 s21, s21, s27
  s_lshl_b32 s21, s21, 12
  s_lshl_b32 s22, s50, 13
  s_lshl_b32 s19, s49, 15
  s_lshl_b32 s20, s50, 15
  s_lshl_b32 s17, s64, 1
  s_add_u32 s17, s17, s27
  s_lshl_b32 s17, s17, 7
  s_mov_b32 s18, 8192
  s_cmp_eq_u32 s48, 0
  s_cselect_b32 s24, 0x3e0293ee, 1.0
  s_waitcnt lgkmcnt(0)
  s_and_b32 s9, s9, 0xffff
  s_mov_b32 s10, 4194304
  s_mov_b32 s11, 0x20000
  s_and_b32 s13, s13, 0xffff
  s_mov_b32 s14, 2097152
  s_mov_b32 s15, 0x20000
  v_and_b32 v144, 31, v1
  v_lshrrev_b32 v145, 5, v1
  v_and_b32 v146, 15, v1
  v_or_b32 v147, 0, v145
  v_xor_b32 v147, v147, v146
  v_lshlrev_b32 v147, 4, v147
  v_lshl_add_u32 v8, v144, 8, v147
  v_or_b32 v147, 2, v145
  v_xor_b32 v147, v147, v146
  v_lshlrev_b32 v147, 4, v147
  v_lshl_add_u32 v9, v144, 8, v147
  v_or_b32 v147, 4, v145
  v_xor_b32 v147, v147, v146
  v_lshlrev_b32 v147, 4, v147
  v_lshl_add_u32 v10, v144, 8, v147
  v_or_b32 v147, 6, v145
  v_xor_b32 v147, v147, v146
  v_lshlrev_b32 v147, 4, v147
  v_lshl_add_u32 v11, v144, 8, v147
  v_or_b32 v147, 8, v145
  v_xor_b32 v147, v147, v146
  v_lshlrev_b32 v147, 4, v147
  v_lshl_add_u32 v12, v144, 8, v147
  v_or_b32 v147, 10, v145
  v_xor_b32 v147, v147, v146
  v_lshlrev_b32 v147, 4, v147
  v_lshl_add_u32 v13, v144, 8, v147
  v_or_b32 v147, 12, v145
  v_xor_b32 v147, v147, v146
  v_lshlrev_b32 v147, 4, v147
  v_lshl_add_u32 v14, v144, 8, v147
  v_or_b32 v147, 14, v145
  v_xor_b32 v147, v147, v146
  v_lshlrev_b32 v147, 4, v147
  v_lshl_add_u32 v15, v144, 8, v147
  v_lshrrev_b32 v144, 4, v1
  s_lshl_b32 s26, s16, 8
  v_add_u32 v145, 0, v144
  v_and_b32 v147, 15, v145
  v_xor_b32 v147, v147, v146
  v_lshlrev_b32 v147, 4, v147
  v_lshl_add_u32 v147, v145, 10, v147
  v_add_u32 v16, s26, v147
  v_add_u32 v145, 4, v144
  v_and_b32 v147, 15, v145
  v_xor_b32 v147, v147, v146
  v_lshlrev_b32 v147, 4, v147
  v_lshl_add_u32 v147, v145, 10, v147
  v_add_u32 v17, s26, v147
  v_add_u32 v145, 8, v144
  v_and_b32 v147, 15, v145
  v_xor_b32 v147, v147, v146
  v_lshlrev_b32 v147, 4, v147
  v_lshl_add_u32 v147, v145, 10, v147
  v_add_u32 v18, s26, v147
  v_add_u32 v145, 12, v144
  v_and_b32 v147, 15, v145
  v_xor_b32 v147, v147, v146
  v_lshlrev_b32 v147, 4, v147
  v_lshl_add_u32 v147, v145, 10, v147
  v_add_u32 v19, s26, v147
  v_add_u32 v145, 16, v144
  v_and_b32 v147, 15, v145
  v_xor_b32 v147, v147, v146
  v_lshlrev_b32 v147, 4, v147
  v_lshl_add_u32 v147, v145, 10, v147
  v_add_u32 v20, s26, v147
  v_add_u32 v145, 20, v144
  v_and_b32 v147, 15, v145
  v_xor_b32 v147, v147, v146
  v_lshlrev_b32 v147, 4, v147
  v_lshl_add_u32 v147, v145, 10, v147
  v_add_u32 v21, s26, v147
  v_add_u32 v145, 24, v144
  v_and_b32 v147, 15, v145
  v_xor_b32 v147, v147, v146
  v_lshlrev_b32 v147, 4, v147
  v_lshl_add_u32 v147, v145, 10, v147
  v_add_u32 v22, s26, v147
  v_add_u32 v145, 28, v144
  v_and_b32 v147, 15, v145
  v_xor_b32 v147, v147, v146
  v_lshlrev_b32 v147, 4, v147
  v_lshl_add_u32 v147, v145, 10, v147
  v_add_u32 v23, s26, v147
  v_lshrrev_b32 v144, 3, v1
  v_mul_lo_u32 v144, v144, s18
  v_and_b32 v145, 7, v1
  v_lshl_add_u32 v144, v145, 4, v144
  s_lshl_b32 s28, s16, 15
  s_add_u32 s28, s28, 32768
  s_lshl_b32 s29, s18, 3
  s_add_u32 m0, s28, 0
  s_nop 0
  buffer_load_dwordx4 v144, s[8:11], s17 offen lds
  s_add_u32 s17, s17, s29
  s_add_u32 m0, s28, 1024
  s_nop 0
  buffer_load_dwordx4 v144, s[8:11], s17 offen lds
  s_add_u32 s17, s17, s29
  s_add_u32 m0, s28, 2048
  s_nop 0
  buffer_load_dwordx4 v144, s[8:11], s17 offen lds
  s_add_u32 s17, s17, s29
  s_add_u32 m0, s28, 3072
  s_nop 0
  buffer_load_dwordx4 v144, s[8:11], s17 offen lds
  s_add_u32 s17, s17, s29
  s_add_u32 m0, s28, 4096
  s_nop 0
  buffer_load_dwordx4 v144, s[8:11], s17 offen lds
  s_add_u32 s17, s17, s29
  s_add_u32 m0, s28, 5120
  s_nop 0
  buffer_load_dwordx4 v144, s[8:11], s17 offen lds
  s_add_u32 s17, s17, s29
  s_add_u32 m0, s28, 6144
  s_nop 0
  buffer_load_dwordx4 v144, s[8:11], s17 offen lds
  s_add_u32 s17, s17, s29
  s_add_u32 m0, s28, 7168
  s_nop 0
  buffer_load_dwordx4 v144, s[8:11], s17 offen lds
  s_add_u32 s17, s17, s29
  s_add_u32 m0, s28, 8192
  s_nop 0
  buffer_load_dwordx4 v144, s[8:11], s17 offen lds
  s_add_u32 s17, s17, s29
  s_add_u32 m0, s28, 9216
  s_nop 0
  buffer_load_dwordx4 v144, s[8:11], s17 offen lds
  s_add_u32 s17, s17, s29
  s_add_u32 m0, s28, 10240
  s_nop 0
  buffer_load_dwordx4 v144, s[8:11], s17 offen lds
  s_add_u32 s17, s17, s29
  s_add_u32 m0, s28, 11264
  s_nop 0
  buffer_load_dwordx4 v144, s[8:11], s17 offen lds
  s_add_u32 s17, s17, s29
  s_add_u32 m0, s28, 12288
  s_nop 0
  buffer_load_dwordx4 v144, s[8:11], s17 offen lds
  s_add_u32 s17, s17, s29
  s_add_u32 m0, s28, 13312
  s_nop 0
  buffer_load_dwordx4 v144, s[8:11], s17 offen lds
  s_add_u32 s17, s17, s29
  s_add_u32 m0, s28, 14336
  s_nop 0
  buffer_load_dwordx4 v144, s[8:11], s17 offen lds
  s_add_u32 s17, s17, s29
  s_add_u32 m0, s28, 15360
  s_nop 0
  buffer_load_dwordx4 v144, s[8:11], s17 offen lds
  s_add_u32 s17, s17, s29
  s_add_u32 m0, s28, 16384
  s_nop 0
  buffer_load_dwordx4 v144, s[8:11], s17 offen lds
  s_add_u32 s17, s17, s29
  s_add_u32 m0, s28, 17408
  s_nop 0
  buffer_load_dwordx4 v144, s[8:11], s17 offen lds
  s_add_u32 s17, s17, s29
  s_add_u32 m0, s28, 18432
  s_nop 0
  buffer_load_dwordx4 v144, s[8:11], s17 offen lds
  s_add_u32 s17, s17, s29
  s_add_u32 m0, s28, 19456
  s_nop 0
  buffer_load_dwordx4 v144, s[8:11], s17 offen lds
  s_add_u32 s17, s17, s29
  s_add_u32 m0, s28, 20480
  s_nop 0
  buffer_load_dwordx4 v144, s[8:11], s17 offen lds
  s_add_u32 s17, s17, s29
  s_add_u32 m0, s28, 21504
  s_nop 0
  buffer_load_dwordx4 v144, s[8:11], s17 offen lds
  s_add_u32 s17, s17, s29
  s_add_u32 m0, s28, 22528
  s_nop 0
  buffer_load_dwordx4 v144, s[8:11], s17 offen lds
  s_add_u32 s17, s17, s29
  s_add_u32 m0, s28, 23552
  s_nop 0
  buffer_load_dwordx4 v144, s[8:11], s17 offen lds
  s_add_u32 s17, s17, s29
  s_add_u32 m0, s28, 24576
  s_nop 0
  buffer_load_dwordx4 v144, s[8:11], s17 offen lds
  s_add_u32 s17, s17, s29
  s_add_u32 m0, s28, 25600
  s_nop 0
  buffer_load_dwordx4 v144, s[8:11], s17 offen lds
  s_add_u32 s17, s17, s29
  s_add_u32 m0, s28, 26624
  s_nop 0
  buffer_load_dwordx4 v144, s[8:11], s17 offen lds
  s_add_u32 s17, s17, s29
  s_add_u32 m0, s28, 27648
  s_nop 0
  buffer_load_dwordx4 v144, s[8:11], s17 offen lds
  s_add_u32 s17, s17, s29
  s_add_u32 m0, s28, 28672
  s_nop 0
  buffer_load_dwordx4 v144, s[8:11], s17 offen lds
  s_add_u32 s17, s17, s29
  s_add_u32 m0, s28, 29696
  s_nop 0
  buffer_load_dwordx4 v144, s[8:11], s17 offen lds
  s_add_u32 s17, s17, s29
  s_add_u32 m0, s28, 30720
  s_nop 0
  buffer_load_dwordx4 v144, s[8:11], s17 offen lds
  s_add_u32 s17, s17, s29
  s_add_u32 m0, s28, 31744
  s_nop 0
  buffer_load_dwordx4 v144, s[8:11], s17 offen lds
  s_add_u32 s17, s17, s29
  s_lshl_b32 s25, s16, 13
  s_add_u32 m0, s25, 0
  s_nop 0
  buffer_load_dwordx4 v16, s[12:15], s19 offen lds
  s_add_u32 m0, s25, 1024
  s_nop 0
  buffer_load_dwordx4 v17, s[12:15], s19 offen lds
  s_add_u32 m0, s25, 2048
  s_nop 0
  buffer_load_dwordx4 v18, s[12:15], s19 offen lds
  s_add_u32 m0, s25, 3072
  s_nop 0
  buffer_load_dwordx4 v19, s[12:15], s19 offen lds
  s_add_u32 m0, s25, 4096
  s_nop 0
  buffer_load_dwordx4 v20, s[12:15], s19 offen lds
  s_add_u32 m0, s25, 5120
  s_nop 0
  buffer_load_dwordx4 v21, s[12:15], s19 offen lds
  s_add_u32 m0, s25, 6144
  s_nop 0
  buffer_load_dwordx4 v22, s[12:15], s19 offen lds
  s_add_u32 m0, s25, 7168
  s_nop 0
  buffer_load_dwordx4 v23, s[12:15], s19 offen lds
  s_cmp_gt_u32 s23, 1
  s_cselect_b32 s26, s20, 0
  s_add_u32 s19, s19, s26
  s_add_u32 s25, s25, 32768
  s_and_b32 s25, s25, 0x1ffff
  s_cmp_lg_u32 s16, 3
  s_cbranch_scc1 M_noinit
  s_mov_b32 s79, 0
  s_atomic_swap s79, s[72:73], s31 glc
  s_waitcnt lgkmcnt(0)
  s_mov_b32 s79, 1
  s_atomic_add s79, s[74:75], 128
M_noinit:
  s_mul_i32 s76, s64, 3
  s_add_u32 s76, s76, s57
  s_mul_i32 s76, s76, 24576
  v_lshlrev_b32 v4, 7, v0
  v_add_u32 v4, s76, v4
  buffer_load_dword v5, v4, s[12:15], 0 offen
  v_bfe_u32 v148, v1, 2, 2
  v_lshrrev_b32 v149, 5, v1
  v_lshl_add_u32 v148, v149, 3, v148
  v_lshlrev_b32 v148, 7, v148
  v_bfe_u32 v149, v1, 4, 1
  v_lshl_add_u32 v148, v149, 5, v148
  v_and_b32 v149, 3, v1
  v_lshl_add_u32 v148, v149, 3, v148
  v_add_u32 v146, s28, v148
  v_add_u32 v147, 512, v146
  s_waitcnt vmcnt(37)
  ds_read_b64_tr_b16 a[0:1], v146 offset:0
  ds_read_b64_tr_b16 a[2:3], v147 offset:0
  ds_read_b64_tr_b16 a[4:5], v146 offset:64
  ds_read_b64_tr_b16 a[6:7], v147 offset:64
  ds_read_b64_tr_b16 a[8:9], v146 offset:2048
  ds_read_b64_tr_b16 a[10:11], v147 offset:2048
  ds_read_b64_tr_b16 a[12:13], v146 offset:2112
  ds_read_b64_tr_b16 a[14:15], v147 offset:2112
  s_waitcnt lgkmcnt(0)
  s_add_u32 m0, s28, 0
  s_nop 0
  buffer_load_dwordx4 v144, s[8:11], s17 offen lds
  s_add_u32 s17, s17, s29
  s_add_u32 m0, s28, 1024
  s_nop 0
  buffer_load_dwordx4 v144, s[8:11], s17 offen lds
  s_add_u32 s17, s17, s29
  s_add_u32 m0, s28, 2048
  s_nop 0
  buffer_load_dwordx4 v144, s[8:11], s17 offen lds
  s_add_u32 s17, s17, s29
  s_add_u32 m0, s28, 3072
  s_nop 0
  buffer_load_dwordx4 v144, s[8:11], s17 offen lds
  s_add_u32 s17, s17, s29
  s_waitcnt vmcnt(37)
  ds_read_b64_tr_b16 a[16:17], v146 offset:4096
  ds_read_b64_tr_b16 a[18:19], v147 offset:4096
  ds_read_b64_tr_b16 a[20:21], v146 offset:4160
  ds_read_b64_tr_b16 a[22:23], v147 offset:4160
  ds_read_b64_tr_b16 a[24:25], v146 offset:6144
  ds_read_b64_tr_b16 a[26:27], v147 offset:6144
  ds_read_b64_tr_b16 a[28:29], v146 offset:6208
  ds_read_b64_tr_b16 a[30:31], v147 offset:6208
  s_waitcnt lgkmcnt(0)
  s_add_u32 m0, s28, 4096
  s_nop 0
  buffer_load_dwordx4 v144, s[8:11], s17 offen lds
  s_add_u32 s17, s17, s29
  s_add_u32 m0, s28, 5120
  s_nop 0
  buffer_load_dwordx4 v144, s[8:11], s17 offen lds
  s_add_u32 s17, s17, s29
  s_add_u32 m0, s28, 6144
  s_nop 0
  buffer_load_dwordx4 v144, s[8:11], s17 offen lds
  s_add_u32 s17, s17, s29
  s_add_u32 m0, s28, 7168
  s_nop 0
  buffer_load_dwordx4 v144, s[8:11], s17 offen lds
  s_add_u32 s17, s17, s29
  s_waitcnt vmcnt(37)
  ds_read_b64_tr_b16 a[32:33], v146 offset:8192
  ds_read_b64_tr_b16 a[34:35], v147 offset:8192
  ds_read_b64_tr_b16 a[36:37], v146 offset:8256
  ds_read_b64_tr_b16 a[38:39], v147 offset:8256
  ds_read_b64_tr_b16 a[40:41], v146 offset:10240
  ds_read_b64_tr_b16 a[42:43], v147 offset:10240
  ds_read_b64_tr_b16 a[44:45], v146 offset:10304
  ds_read_b64_tr_b16 a[46:47], v147 offset:10304
  s_waitcnt lgkmcnt(0)
  s_add_u32 m0, s28, 8192
  s_nop 0
  buffer_load_dwordx4 v144, s[8:11], s17 offen lds
  s_add_u32 s17, s17, s29
  s_add_u32 m0, s28, 9216
  s_nop 0
  buffer_load_dwordx4 v144, s[8:11], s17 offen lds
  s_add_u32 s17, s17, s29
  s_add_u32 m0, s28, 10240
  s_nop 0
  buffer_load_dwordx4 v144, s[8:11], s17 offen lds
  s_add_u32 s17, s17, s29
  s_add_u32 m0, s28, 11264
  s_nop 0
  buffer_load_dwordx4 v144, s[8:11], s17 offen lds
  s_add_u32 s17, s17, s29
  s_waitcnt vmcnt(37)
  ds_read_b64_tr_b16 a[48:49], v146 offset:12288
  ds_read_b64_tr_b16 a[50:51], v147 offset:12288
  ds_read_b64_tr_b16 a[52:53], v146 offset:12352
  ds_read_b64_tr_b16 a[54:55], v147 offset:12352
  ds_read_b64_tr_b16 a[56:57], v146 offset:14336
  ds_read_b64_tr_b16 a[58:59], v147 offset:14336
  ds_read_b64_tr_b16 a[60:61], v146 offset:14400
  ds_read_b64_tr_b16 a[62:63], v147 offset:14400
  s_waitcnt lgkmcnt(0)
  s_add_u32 m0, s28, 12288
  s_nop 0
  buffer_load_dwordx4 v144, s[8:11], s17 offen lds
  s_add_u32 s17, s17, s29
  s_add_u32 m0, s28, 13312
  s_nop 0
  buffer_load_dwordx4 v144, s[8:11], s17 offen lds
  s_add_u32 s17, s17, s29
  s_add_u32 m0, s28, 14336
  s_nop 0
  buffer_load_dwordx4 v144, s[8:11], s17 offen lds
  s_add_u32 s17, s17, s29
  s_add_u32 m0, s28, 15360
  s_nop 0
  buffer_load_dwordx4 v144, s[8:11], s17 offen lds
  s_add_u32 s17, s17, s29
  s_waitcnt vmcnt(37)
  ds_read_b64_tr_b16 a[64:65], v146 offset:16384
  ds_read_b64_tr_b16 a[66:67], v147 offset:16384
  ds_read_b64_tr_b16 a[68:69], v146 offset:16448
  ds_read_b64_tr_b16 a[70:71], v147 offset:16448
  ds_read_b64_tr_b16 a[72:73], v146 offset:18432
  ds_read_b64_tr_b16 a[74:75], v147 offset:18432
  ds_read_b64_tr_b16 a[76:77], v146 offset:18496
  ds_read_b64_tr_b16 a[78:79], v147 offset:18496
  s_waitcnt lgkmcnt(0)
  s_add_u32 m0, s28, 16384
  s_nop 0
  buffer_load_dwordx4 v144, s[8:11], s17 offen lds
  s_add_u32 s17, s17, s29
  s_add_u32 m0, s28, 17408
  s_nop 0
  buffer_load_dwordx4 v144, s[8:11], s17 offen lds
  s_add_u32 s17, s17, s29
  s_add_u32 m0, s28, 18432
  s_nop 0
  buffer_load_dwordx4 v144, s[8:11], s17 offen lds
  s_add_u32 s17, s17, s29
  s_add_u32 m0, s28, 19456
  s_nop 0
  buffer_load_dwordx4 v144, s[8:11], s17 offen lds
  s_add_u32 s17, s17, s29
  s_waitcnt vmcnt(37)
  ds_read_b64_tr_b16 a[80:81], v146 offset:20480
  ds_read_b64_tr_b16 a[82:83], v147 offset:20480
  ds_read_b64_tr_b16 a[84:85], v146 offset:20544
  ds_read_b64_tr_b16 a[86:87], v147 offset:20544
  ds_read_b64_tr_b16 a[88:89], v146 offset:22528
  ds_read_b64_tr_b16 a[90:91], v147 offset:22528
  ds_read_b64_tr_b16 a[92:93], v146 offset:22592
  ds_read_b64_tr_b16 a[94:95], v147 offset:22592
  s_waitcnt lgkmcnt(0)
  s_add_u32 m0, s28, 20480
  s_nop 0
  buffer_load_dwordx4 v144, s[8:11], s17 offen lds
  s_add_u32 s17, s17, s29
  s_add_u32 m0, s28, 21504
  s_nop 0
  buffer_load_dwordx4 v144, s[8:11], s17 offen lds
  s_add_u32 s17, s17, s29
  s_add_u32 m0, s28, 22528
  s_nop 0
  buffer_load_dwordx4 v144, s[8:11], s17 offen lds
  s_add_u32 s17, s17, s29
  s_add_u32 m0, s28, 23552
  s_nop 0
  buffer_load_dwordx4 v144, s[8:11], s17 offen lds
  s_add_u32 s17, s17, s29
  s_waitcnt vmcnt(37)
  ds_read_b64_tr_b16 a[96:97], v146 offset:24576
  ds_read_b64_tr_b16 a[98:99], v147 offset:24576
  ds_read_b64_tr_b16 a[100:101], v146 offset:24640
  ds_read_b64_tr_b16 a[102:103], v147 offset:24640
  ds_read_b64_tr_b16 a[104:105], v146 offset:26624
  ds_read_b64_tr_b16 a[106:107], v147 offset:26624
  ds_read_b64_tr_b16 a[108:109], v146 offset:26688
  ds_read_b64_tr_b16 a[110:111], v147 offset:26688
  s_waitcnt lgkmcnt(0)
  s_add_u32 m0, s28, 24576
  s_nop 0
  buffer_load_dwordx4 v144, s[8:11], s17 offen lds
  s_add_u32 s17, s17, s29
  s_add_u32 m0, s28, 25600
  s_nop 0
  buffer_load_dwordx4 v144, s[8:11], s17 offen lds
  s_add_u32 s17, s17, s29
  s_add_u32 m0, s28, 26624
  s_nop 0
  buffer_load_dwordx4 v144, s[8:11], s17 offen lds
  s_add_u32 s17, s17, s29
  s_add_u32 m0, s28, 27648
  s_nop 0
  buffer_load_dwordx4 v144, s[8:11], s17 offen lds
  s_add_u32 s17, s17, s29
  s_waitcnt vmcnt(37)
  ds_read_b64_tr_b16 a[112:113], v146 offset:28672
  ds_read_b64_tr_b16 a[114:115], v147 offset:28672
  ds_read_b64_tr_b16 a[116:117], v146 offset:28736
  ds_read_b64_tr_b16 a[118:119], v147 offset:28736
  ds_read_b64_tr_b16 a[120:121], v146 offset:30720
  ds_read_b64_tr_b16 a[122:123], v147 offset:30720
  ds_read_b64_tr_b16 a[124:125], v146 offset:30784
  ds_read_b64_tr_b16 a[126:127], v147 offset:30784
  s_waitcnt lgkmcnt(0)
  s_add_u32 m0, s28, 28672
  s_nop 0
  buffer_load_dwordx4 v144, s[8:11], s17 offen lds
  s_add_u32 s17, s17, s29
  s_add_u32 m0, s28, 29696
  s_nop 0
  buffer_load_dwordx4 v144, s[8:11], s17 offen lds
  s_add_u32 s17, s17, s29
  s_add_u32 m0, s28, 30720
  s_nop 0
  buffer_load_dwordx4 v144, s[8:11], s17 offen lds
  s_add_u32 s17, s17, s29
  s_add_u32 m0, s28, 31744
  s_nop 0
  buffer_load_dwordx4 v144, s[8:11], s17 offen lds
  s_add_u32 s17, s17, s29
  s_waitcnt vmcnt(28)
  ds_read_b64_tr_b16 a[128:129], v146 offset:0
  ds_read_b64_tr_b16 a[130:131], v147 offset:0
  ds_read_b64_tr_b16 a[132:133], v146 offset:64
  ds_read_b64_tr_b16 a[134:135], v147 offset:64
  ds_read_b64_tr_b16 a[136:137], v146 offset:2048
  ds_read_b64_tr_b16 a[138:139], v147 offset:2048
  ds_read_b64_tr_b16 a[140:141], v146 offset:2112
  ds_read_b64_tr_b16 a[142:143], v147 offset:2112
  s_waitcnt lgkmcnt(0)
  s_waitcnt vmcnt(24)
  ds_read_b64_tr_b16 a[144:145], v146 offset:4096
  ds_read_b64_tr_b16 a[146:147], v147 offset:4096
  ds_read_b64_tr_b16 a[148:149], v146 offset:4160
  ds_read_b64_tr_b16 a[150:151], v147 offset:4160
  ds_read_b64_tr_b16 a[152:153], v146 offset:6144
  ds_read_b64_tr_b16 a[154:155], v147 offset:6144
  ds_read_b64_tr_b16 a[156:157], v146 offset:6208
  ds_read_b64_tr_b16 a[158:159], v147 offset:6208
  s_waitcnt lgkmcnt(0)
  s_waitcnt vmcnt(20)
  ds_read_b64_tr_b16 a[160:161], v146 offset:8192
  ds_read_b64_tr_b16 a[162:163], v147 offset:8192
  ds_read_b64_tr_b16 a[164:165], v146 offset:8256
  ds_read_b64_tr_b16 a[166:167], v147 offset:8256
  ds_read_b64_tr_b16 a[168:169], v146 offset:10240
  ds_read_b64_tr_b16 a[170:171], v147 offset:10240
  ds_read_b64_tr_b16 a[172:173], v146 offset:10304
  ds_read_b64_tr_b16 a[174:175], v147 offset:10304
  s_waitcnt lgkmcnt(0)
  s_waitcnt vmcnt(16)
  ds_read_b64_tr_b16 a[176:177], v146 offset:12288
  ds_read_b64_tr_b16 a[178:179], v147 offset:12288
  ds_read_b64_tr_b16 a[180:181], v146 offset:12352
  ds_read_b64_tr_b16 a[182:183], v147 offset:12352
  ds_read_b64_tr_b16 a[184:185], v146 offset:14336
  ds_read_b64_tr_b16 a[186:187], v147 offset:14336
  ds_read_b64_tr_b16 a[188:189], v146 offset:14400
  ds_read_b64_tr_b16 a[190:191], v147 offset:14400
  s_waitcnt lgkmcnt(0)
  s_waitcnt vmcnt(12)
  ds_read_b64_tr_b16 a[192:193], v146 offset:16384
  ds_read_b64_tr_b16 a[194:195], v147 offset:16384
  ds_read_b64_tr_b16 a[196:197], v146 offset:16448
  ds_read_b64_tr_b16 a[198:199], v147 offset:16448
  ds_read_b64_tr_b16 a[200:201], v146 offset:18432
  ds_read_b64_tr_b16 a[202:203], v147 offset:18432
  ds_read_b64_tr_b16 a[204:205], v146 offset:18496
  ds_read_b64_tr_b16 a[206:207], v147 offset:18496
  s_waitcnt lgkmcnt(0)
  s_waitcnt vmcnt(8)
  ds_read_b64_tr_b16 a[208:209], v146 offset:20480
  ds_read_b64_tr_b16 a[210:211], v147 offset:20480
  ds_read_b64_tr_b16 a[212:213], v146 offset:20544
  ds_read_b64_tr_b16 a[214:215], v147 offset:20544
  ds_read_b64_tr_b16 a[216:217], v146 offset:22528
  ds_read_b64_tr_b16 a[218:219], v147 offset:22528
  ds_read_b64_tr_b16 a[220:221], v146 offset:22592
  ds_read_b64_tr_b16 a[222:223], v147 offset:22592
  s_waitcnt lgkmcnt(0)
  s_waitcnt vmcnt(4)
  ds_read_b64_tr_b16 a[224:225], v146 offset:24576
  ds_read_b64_tr_b16 a[226:227], v147 offset:24576
  ds_read_b64_tr_b16 a[228:229], v146 offset:24640
  ds_read_b64_tr_b16 a[230:231], v147 offset:24640
  ds_read_b64_tr_b16 a[232:233], v146 offset:26624
  ds_read_b64_tr_b16 a[234:235], v147 offset:26624
  ds_read_b64_tr_b16 a[236:237], v146 offset:26688
  ds_read_b64_tr_b16 a[238:239], v147 offset:26688
  s_waitcnt lgkmcnt(0)
  s_waitcnt vmcnt(0)
  ds_read_b64_tr_b16 a[240:241], v146 offset:28672
  ds_read_b64_tr_b16 a[242:243], v147 offset:28672
  ds_read_b64_tr_b16 a[244:245], v146 offset:28736
  ds_read_b64_tr_b16 a[246:247], v147 offset:28736
  ds_read_b64_tr_b16 a[248:249], v146 offset:30720
  ds_read_b64_tr_b16 a[250:251], v147 offset:30720
  ds_read_b64_tr_b16 a[252:253], v146 offset:30784
  ds_read_b64_tr_b16 a[254:255], v147 offset:30784
  s_waitcnt lgkmcnt(0)
  s_barrier
  s_add_u32 m0, s25, 0
  s_nop 0
  buffer_load_dwordx4 v16, s[12:15], s19 offen lds
  s_add_u32 m0, s25, 1024
  s_nop 0
  buffer_load_dwordx4 v17, s[12:15], s19 offen lds
  s_add_u32 m0, s25, 2048
  s_nop 0
  buffer_load_dwordx4 v18, s[12:15], s19 offen lds
  s_add_u32 m0, s25, 3072
  s_nop 0
  buffer_load_dwordx4 v19, s[12:15], s19 offen lds
  s_add_u32 m0, s25, 4096
  s_nop 0
  buffer_load_dwordx4 v20, s[12:15], s19 offen lds
  s_add_u32 m0, s25, 5120
  s_nop 0
  buffer_load_dwordx4 v21, s[12:15], s19 offen lds
  s_add_u32 m0, s25, 6144
  s_nop 0
  buffer_load_dwordx4 v22, s[12:15], s19 offen lds
  s_add_u32 m0, s25, 7168
  s_nop 0
  buffer_load_dwordx4 v23, s[12:15], s19 offen lds
  s_cmp_gt_u32 s23, 2
  s_cselect_b32 s26, s20, 0
  s_add_u32 s19, s19, s26
  s_add_u32 s25, s25, 32768
  s_and_b32 s25, s25, 0x1ffff
  s_waitcnt vmcnt(0)
  s_barrier
  s_cmp_eq_u32 s48, 0
  s_cselect_b32 s26, 0, s16
  s_cmp_ge_u32 s26, 2
  s_cbranch_scc1 P_v_1
  s_mov_b32 s27, s21
  v_mov_b32 v7, 0x40000000
  s_mov_b32 s29, -3
  v_min_u32 v145, 1, v0
  v_lshlrev_b32 v145, 30, v145
  ds_read_b128 v[24:27], v8 offset:0
  ds_read_b128 v[28:31], v9 offset:0
  ds_read_b128 v[32:35], v10 offset:0
  ds_read_b128 v[36:39], v11 offset:0
  ds_read_b128 v[40:43], v12 offset:0
  ds_read_b128 v[44:47], v13 offset:0
.p2align 6
G_top_3:
  s_waitcnt lgkmcnt(5)
  v_mfma_f32_32x32x16_bf16 v[64:79], a[0:3], v[24:27], 0
  s_add_u32 m0, s25, 0
  ds_read_b128 v[48:51], v14 offset:0
  v_mfma_f32_32x32x16_bf16 v[80:95], a[4:7], v[24:27], 0
  s_waitcnt lgkmcnt(5)
  buffer_load_dwordx4 v16, s[12:15], s19 offen lds
  v_mfma_f32_32x32x16_bf16 v[64:79], a[8:11], v[28:31], v[64:79]
  ds_read_b128 v[52:55], v15 offset:0
  v_mul_f32 v96, s24, v96
  v_mul_f32 v97, s24, v97
  v_mfma_f32_32x32x16_bf16 v[80:95], a[12:15], v[28:31], v[80:95]
  s_waitcnt lgkmcnt(5)
  v_cvt_pk_bf16_f32 v128, v96, v97
  v_mul_f32 v98, s24, v98
  v_mfma_f32_32x32x16_bf16 v[64:79], a[16:19], v[32:35], v[64:79]
  s_add_u32 m0, s25, 1024
  ds_read_b128 v[24:27], v8 offset:8192
  v_mul_f32 v99, s24, v99
  v_cvt_pk_bf16_f32 v129, v98, v99
  v_mfma_f32_32x32x16_bf16 v[80:95], a[20:23], v[32:35], v[80:95]
  s_waitcnt lgkmcnt(5)
  buffer_load_dwordx4 v17, s[12:15], s19 offen lds
  v_mul_f32 v100, s24, v100
  v_mul_f32 v101, s24, v101
  v_mfma_f32_32x32x16_bf16 v[64:79], a[24:27], v[36:39], v[64:79]
  ds_read_b128 v[28:31], v9 offset:8192
  v_cvt_pk_bf16_f32 v130, v100, v101
  v_mul_f32 v102, s24, v102
  v_mfma_f32_32x32x16_bf16 v[80:95], a[28:31], v[36:39], v[80:95]
  s_waitcnt lgkmcnt(5)
  v_mul_f32 v103, s24, v103
  v_cvt_pk_bf16_f32 v131, v102, v103
  v_mfma_f32_32x32x16_bf16 v[64:79], a[32:35], v[40:43], v[64:79]
  s_add_u32 m0, s25, 2048
  ds_read_b128 v[32:35], v10 offset:8192
  v_mul_f32 v104, s24, v104
  v_mul_f32 v105, s24, v105
  v_mfma_f32_32x32x16_bf16 v[80:95], a[36:39], v[40:43], v[80:95]
  s_waitcnt lgkmcnt(5)
  buffer_load_dwordx4 v18, s[12:15], s19 offen lds
  v_cvt_pk_bf16_f32 v132, v104, v105
  v_mul_f32 v106, s24, v106
  v_mfma_f32_32x32x16_bf16 v[64:79], a[40:43], v[44:47], v[64:79]
  ds_read_b128 v[36:39], v11 offset:8192
  v_mul_f32 v107, s24, v107
  v_cvt_pk_bf16_f32 v133, v106, v107
  v_mfma_f32_32x32x16_bf16 v[80:95], a[44:47], v[44:47], v[80:95]
  s_waitcnt lgkmcnt(5)
  v_mul_f32 v108, s24, v108
  v_mul_f32 v109, s24, v109
  v_mfma_f32_32x32x16_bf16 v[64:79], a[48:51], v[48:51], v[64:79]
  s_add_u32 m0, s25, 3072
  ds_read_b128 v[40:43], v12 offset:8192
  v_cvt_pk_bf16_f32 v134, v108, v109
  v_mul_f32 v110, s24, v110
  v_mfma_f32_32x32x16_bf16 v[80:95], a[52:55], v[48:51], v[80:95]
  s_waitcnt lgkmcnt(5)
  buffer_load_dwordx4 v19, s[12:15], s19 offen lds
  v_mul_f32 v111, s24, v111
  v_cvt_pk_bf16_f32 v135, v110, v111
  v_mfma_f32_32x32x16_bf16 v[64:79], a[56:59], v[52:55], v[64:79]
  ds_read_b128 v[44:47], v13 offset:8192
  v_mul_f32 v112, s24, v112
  v_mul_f32 v113, s24, v113
  v_mfma_f32_32x32x16_bf16 v[80:95], a[60:63], v[52:55], v[80:95]
  s_waitcnt lgkmcnt(5)
  v_cvt_pk_bf16_f32 v136, v112, v113
  v_mul_f32 v114, s24, v114
  v_mfma_f32_32x32x16_bf16 v[64:79], a[64:67], v[24:27], v[64:79]
  s_add_u32 m0, s25, 4096
  ds_read_b128 v[48:51], v14 offset:8192
  v_mul_f32 v115, s24, v115
  v_cvt_pk_bf16_f32 v137, v114, v115
  v_mfma_f32_32x32x16_bf16 v[80:95], a[68:71], v[24:27], v[80:95]
  s_waitcnt lgkmcnt(5)
  buffer_load_dwordx4 v20, s[12:15], s19 offen lds
  v_mul_f32 v116, s24, v116
  v_mul_f32 v117, s24, v117
  v_mfma_f32_32x32x16_bf16 v[64:79], a[72:75], v[28:31], v[64:79]
  ds_read_b128 v[52:55], v15 offset:8192
  v_cvt_pk_bf16_f32 v138, v116, v117
  v_mul_f32 v118, s24, v118
  v_mfma_f32_32x32x16_bf16 v[80:95], a[76:79], v[28:31], v[80:95]
  s_waitcnt lgkmcnt(5)
  v_mul_f32 v119, s24, v119
  v_cvt_pk_bf16_f32 v139, v118, v119
  v_mfma_f32_32x32x16_bf16 v[64:79], a[80:83], v[32:35], v[64:79]
  s_add_u32 m0, s25, 5120
  ds_read_b128 v[24:27], v8 offset:16384
  v_mul_f32 v120, s24, v120
  v_mul_f32 v121, s24, v121
  v_mfma_f32_32x32x16_bf16 v[80:95], a[84:87], v[32:35], v[80:95]
  s_waitcnt lgkmcnt(5)
  buffer_load_dwordx4 v21, s[12:15], s19 offen lds
  v_cvt_pk_bf16_f32 v140, v120, v121
  v_mul_f32 v122, s24, v122
  v_mfma_f32_32x32x16_bf16 v[64:79], a[88:91], v[36:39], v[64:79]
  ds_read_b128 v[28:31], v9 offset:16384
  v_mul_f32 v123, s24, v123
  v_cvt_pk_bf16_f32 v141, v122, v123
  v_mfma_f32_32x32x16_bf16 v[80:95], a[92:95], v[36:39], v[80:95]
  s_waitcnt lgkmcnt(5)
  v_mul_f32 v124, s24, v124
  v_mul_f32 v125, s24, v125
  v_mfma_f32_32x32x16_bf16 v[64:79], a[96:99], v[40:43], v[64:79]
  s_add_u32 m0, s25, 6144
  ds_read_b128 v[32:35], v10 offset:16384
  v_cvt_pk_bf16_f32 v142, v124, v125
  v_mul_f32 v126, s24, v126
  v_mfma_f32_32x32x16_bf16 v[80:95], a[100:103], v[40:43], v[80:95]
  s_waitcnt lgkmcnt(5)
  buffer_load_dwordx4 v22, s[12:15], s19 offen lds
  v_mul_f32 v127, s24, v127
  v_cvt_pk_bf16_f32 v143, v126, v127
  v_mfma_f32_32x32x16_bf16 v[64:79], a[104:107], v[44:47], v[64:79]
  ds_read_b128 v[36:39], v11 offset:16384
  v_mfma_f32_32x32x16_bf16 v[80:95], a[108:111], v[44:47], v[80:95]
  s_waitcnt lgkmcnt(5)
  v_mfma_f32_32x32x16_bf16 v[64:79], a[112:115], v[48:51], v[64:79]
  s_add_u32 m0, s25, 7168
  ds_read_b128 v[40:43], v12 offset:16384
  v_mfma_f32_32x32x16_bf16 v[80:95], a[116:119], v[48:51], v[80:95]
  s_waitcnt lgkmcnt(5)
  buffer_load_dwordx4 v23, s[12:15], s19 offen lds
  v_mfma_f32_32x32x16_bf16 v[64:79], a[120:123], v[52:55], v[64:79]
  s_cmp_gt_u32 s23, 3
  ds_read_b128 v[44:47], v13 offset:16384
  v_mfma_f32_32x32x16_bf16 v[80:95], a[124:127], v[52:55], v[80:95]
  s_waitcnt lgkmcnt(5)
  s_cselect_b32 s26, s20, 0
  v_mfma_f32_32x32x16_bf16 v[64:79], a[128:131], v[24:27], v[64:79]
  s_add_u32 s19, s19, s26
  ds_read_b128 v[48:51], v14 offset:16384
  v_mfma_f32_32x32x16_bf16 v[80:95], a[132:135], v[24:27], v[80:95]
  s_waitcnt lgkmcnt(5)
  s_add_u32 s25, s25, 32768
  v_mfma_f32_32x32x16_bf16 v[64:79], a[136:139], v[28:31], v[64:79]
  s_and_b32 s25, s25, 0x1ffff
  ds_read_b128 v[52:55], v15 offset:16384
  v_mfma_f32_32x32x16_bf16 v[80:95], a[140:143], v[28:31], v[80:95]
  s_waitcnt lgkmcnt(5)
  buffer_store_dwordx4 v[128:131], v7, s[4:7], s21 offen offset:0 sc1
  v_mfma_f32_32x32x16_bf16 v[64:79], a[144:147], v[32:35], v[64:79]
  ds_read_b128 v[24:27], v8 offset:24576
  v_mfma_f32_32x32x16_bf16 v[80:95], a[148:151], v[32:35], v[80:95]
  s_waitcnt lgkmcnt(5)
  v_mfma_f32_32x32x16_bf16 v[64:79], a[152:155], v[36:39], v[64:79]
  ds_read_b128 v[28:31], v9 offset:24576
  v_mfma_f32_32x32x16_bf16 v[80:95], a[156:159], v[36:39], v[80:95]
  s_waitcnt lgkmcnt(5)
  buffer_store_dwordx4 v[132:135], v7, s[4:7], s21 offen offset:1024 sc1
  v_mfma_f32_32x32x16_bf16 v[64:79], a[160:163], v[40:43], v[64:79]
  ds_read_b128 v[32:35], v10 offset:24576
  v_mfma_f32_32x32x16_bf16 v[80:95], a[164:167], v[40:43], v[80:95]
  s_waitcnt lgkmcnt(5)
  v_mfma_f32_32x32x16_bf16 v[64:79], a[168:171], v[44:47], v[64:79]
  ds_read_b128 v[36:39], v11 offset:24576
  v_mfma_f32_32x32x16_bf16 v[80:95], a[172:175], v[44:47], v[80:95]
  s_waitcnt lgkmcnt(5)
  buffer_store_dwordx4 v[136:139], v7, s[4:7], s21 offen offset:2048 sc1
  v_mfma_f32_32x32x16_bf16 v[64:79], a[176:179], v[48:51], v[64:79]
  ds_read_b128 v[40:43], v12 offset:24576
  v_mfma_f32_32x32x16_bf16 v[80:95], a[180:183], v[48:51], v[80:95]
  s_waitcnt lgkmcnt(5)
  v_mfma_f32_32x32x16_bf16 v[64:79], a[184:187], v[52:55], v[64:79]
  ds_read_b128 v[44:47], v13 offset:24576
  v_mfma_f32_32x32x16_bf16 v[80:95], a[188:191], v[52:55], v[80:95]
  s_waitcnt lgkmcnt(5)
  buffer_store_dwordx4 v[140:143], v7, s[4:7], s21 offen offset:3072 sc1
  v_mfma_f32_32x32x16_bf16 v[64:79], a[192:195], v[24:27], v[64:79]
  s_mov_b32 s21, s27
  ds_read_b128 v[48:51], v14 offset:24576
  v_mov_b32 v7, v2
  v_mfma_f32_32x32x16_bf16 v[80:95], a[196:199], v[24:27], v[80:95]
  s_waitcnt lgkmcnt(5)
  v_mfma_f32_32x32x16_bf16 v[64:79], a[200:203], v[28:31], v[64:79]
  s_add_u32 s27, s27, s22
  ds_read_b128 v[52:55], v15 offset:24576
  v_mfma_f32_32x32x16_bf16 v[80:95], a[204:207], v[28:31], v[80:95]
  s_waitcnt lgkmcnt(5)
  s_waitcnt vmcnt(17)
  s_barrier
  v_mfma_f32_32x32x16_bf16 v[64:79], a[208:211], v[32:35], v[64:79]
  ds_read_b128 v[24:27], v8 offset:32768
  v_mfma_f32_32x32x16_bf16 v[80:95], a[212:215], v[32:35], v[80:95]
  s_waitcnt lgkmcnt(5)
  v_mfma_f32_32x32x16_bf16 v[64:79], a[216:219], v[36:39], v[64:79]
  s_add_u32 s29, s29, 1
  ds_read_b128 v[28:31], v9 offset:32768
  v_mfma_f32_32x32x16_bf16 v[80:95], a[220:223], v[36:39], v[80:95]
  s_waitcnt lgkmcnt(5)
  s_max_i32 s30, s29, 0
  v_mov_b32 v144, s30
  v_mfma_f32_32x32x16_bf16 v[64:79], a[224:227], v[40:43], v[64:79]
  ds_read_b128 v[32:35], v10 offset:32768
  v_mfma_f32_32x32x16_bf16 v[80:95], a[228:231], v[40:43], v[80:95]
  s_waitcnt lgkmcnt(5)
  buffer_store_dword v144, v145, s[4:7], s31 offen sc1
  v_mfma_f32_32x32x16_bf16 v[64:79], a[232:235], v[44:47], v[64:79]
  ds_read_b128 v[36:39], v11 offset:32768
  v_mfma_f32_32x32x16_bf16 v[80:95], a[236:239], v[44:47], v[80:95]
  s_waitcnt lgkmcnt(5)
  v_mfma_f32_32x32x16_bf16 v[64:79], a[240:243], v[48:51], v[64:79]
  s_sub_u32 s23, s23, 1
  ds_read_b128 v[40:43], v12 offset:32768
  v_mfma_f32_32x32x16_bf16 v[80:95], a[244:247], v[48:51], v[80:95]
  s_waitcnt lgkmcnt(5)
  v_mfma_f32_32x32x16_bf16 v[64:79], a[248:251], v[52:55], v[64:79]
  s_cmp_eq_u32 s23, 0
  ds_read_b128 v[44:47], v13 offset:32768
  v_mfma_f32_32x32x16_bf16 v[80:95], a[252:255], v[52:55], v[80:95]
  s_cbranch_scc1 G_done0_4
  s_waitcnt lgkmcnt(5)
  v_mfma_f32_32x32x16_bf16 v[96:111], a[0:3], v[24:27], 0
  s_add_u32 m0, s25, 0
  ds_read_b128 v[48:51], v14 offset:32768
  v_mfma_f32_32x32x16_bf16 v[112:127], a[4:7], v[24:27], 0
  s_waitcnt lgkmcnt(5)
  buffer_load_dwordx4 v16, s[12:15], s19 offen lds
  v_mfma_f32_32x32x16_bf16 v[96:111], a[8:11], v[28:31], v[96:111]
  ds_read_b128 v[52:55], v15 offset:32768
  v_mul_f32 v64, s24, v64
  v_mul_f32 v65, s24, v65
  v_mfma_f32_32x32x16_bf16 v[112:127], a[12:15], v[28:31], v[112:127]
  s_waitcnt lgkmcnt(5)
  v_cvt_pk_bf16_f32 v128, v64, v65
  v_mul_f32 v66, s24, v66
  v_mfma_f32_32x32x16_bf16 v[96:111], a[16:19], v[32:35], v[96:111]
  s_add_u32 m0, s25, 1024
  ds_read_b128 v[24:27], v8 offset:40960
  v_mul_f32 v67, s24, v67
  v_cvt_pk_bf16_f32 v129, v66, v67
  v_mfma_f32_32x32x16_bf16 v[112:127], a[20:23], v[32:35], v[112:127]
  s_waitcnt lgkmcnt(5)
  buffer_load_dwordx4 v17, s[12:15], s19 offen lds
  v_mul_f32 v68, s24, v68
  v_mul_f32 v69, s24, v69
  v_mfma_f32_32x32x16_bf16 v[96:111], a[24:27], v[36:39], v[96:111]
  ds_read_b128 v[28:31], v9 offset:40960
  v_cvt_pk_bf16_f32 v130, v68, v69
  v_mul_f32 v70, s24, v70
  v_mfma_f32_32x32x16_bf16 v[112:127], a[28:31], v[36:39], v[112:127]
  s_waitcnt lgkmcnt(5)
  v_mul_f32 v71, s24, v71
  v_cvt_pk_bf16_f32 v131, v70, v71
  v_mfma_f32_32x32x16_bf16 v[96:111], a[32:35], v[40:43], v[96:111]
  s_add_u32 m0, s25, 2048
  ds_read_b128 v[32:35], v10 offset:40960
  v_mul_f32 v72, s24, v72
  v_mul_f32 v73, s24, v73
  v_mfma_f32_32x32x16_bf16 v[112:127], a[36:39], v[40:43], v[112:127]
  s_waitcnt lgkmcnt(5)
  buffer_load_dwordx4 v18, s[12:15], s19 offen lds
  v_cvt_pk_bf16_f32 v132, v72, v73
  v_mul_f32 v74, s24, v74
  v_mfma_f32_32x32x16_bf16 v[96:111], a[40:43], v[44:47], v[96:111]
  ds_read_b128 v[36:39], v11 offset:40960
  v_mul_f32 v75, s24, v75
  v_cvt_pk_bf16_f32 v133, v74, v75
  v_mfma_f32_32x32x16_bf16 v[112:127], a[44:47], v[44:47], v[112:127]
  s_waitcnt lgkmcnt(5)
  v_mul_f32 v76, s24, v76
  v_mul_f32 v77, s24, v77
  v_mfma_f32_32x32x16_bf16 v[96:111], a[48:51], v[48:51], v[96:111]
  s_add_u32 m0, s25, 3072
  ds_read_b128 v[40:43], v12 offset:40960
  v_cvt_pk_bf16_f32 v134, v76, v77
  v_mul_f32 v78, s24, v78
  v_mfma_f32_32x32x16_bf16 v[112:127], a[52:55], v[48:51], v[112:127]
  s_waitcnt lgkmcnt(5)
  buffer_load_dwordx4 v19, s[12:15], s19 offen lds
  v_mul_f32 v79, s24, v79
  v_cvt_pk_bf16_f32 v135, v78, v79
  v_mfma_f32_32x32x16_bf16 v[96:111], a[56:59], v[52:55], v[96:111]
  ds_read_b128 v[44:47], v13 offset:40960
  v_mul_f32 v80, s24, v80
  v_mul_f32 v81, s24, v81
  v_mfma_f32_32x32x16_bf16 v[112:127], a[60:63], v[52:55], v[112:127]
  s_waitcnt lgkmcnt(5)
  v_cvt_pk_bf16_f32 v136, v80, v81
  v_mul_f32 v82, s24, v82
  v_mfma_f32_32x32x16_bf16 v[96:111], a[64:67], v[24:27], v[96:111]
  s_add_u32 m0, s25, 4096
  ds_read_b128 v[48:51], v14 offset:40960
  v_mul_f32 v83, s24, v83
  v_cvt_pk_bf16_f32 v137, v82, v83
  v_mfma_f32_32x32x16_bf16 v[112:127], a[68:71], v[24:27], v[112:127]
  s_waitcnt lgkmcnt(5)
  buffer_load_dwordx4 v20, s[12:15], s19 offen lds
  v_mul_f32 v84, s24, v84
  v_mul_f32 v85, s24, v85
  v_mfma_f32_32x32x16_bf16 v[96:111], a[72:75], v[28:31], v[96:111]
  ds_read_b128 v[52:55], v15 offset:40960
  v_cvt_pk_bf16_f32 v138, v84, v85
  v_mul_f32 v86, s24, v86
  v_mfma_f32_32x32x16_bf16 v[112:127], a[76:79], v[28:31], v[112:127]
  s_waitcnt lgkmcnt(5)
  v_mul_f32 v87, s24, v87
  v_cvt_pk_bf16_f32 v139, v86, v87
  v_mfma_f32_32x32x16_bf16 v[96:111], a[80:83], v[32:35], v[96:111]
  s_add_u32 m0, s25, 5120
  ds_read_b128 v[24:27], v8 offset:49152
  v_mul_f32 v88, s24, v88
  v_mul_f32 v89, s24, v89
  v_mfma_f32_32x32x16_bf16 v[112:127], a[84:87], v[32:35], v[112:127]
  s_waitcnt lgkmcnt(5)
  buffer_load_dwordx4 v21, s[12:15], s19 offen lds
  v_cvt_pk_bf16_f32 v140, v88, v89
  v_mul_f32 v90, s24, v90
  v_mfma_f32_32x32x16_bf16 v[96:111], a[88:91], v[36:39], v[96:111]
  ds_read_b128 v[28:31], v9 offset:49152
  v_mul_f32 v91, s24, v91
  v_cvt_pk_bf16_f32 v141, v90, v91
  v_mfma_f32_32x32x16_bf16 v[112:127], a[92:95], v[36:39], v[112:127]
  s_waitcnt lgkmcnt(5)
  v_mul_f32 v92, s24, v92
  v_mul_f32 v93, s24, v93
  v_mfma_f32_32x32x16_bf16 v[96:111], a[96:99], v[40:43], v[96:111]
  s_add_u32 m0, s25, 6144
  ds_read_b128 v[32:35], v10 offset:49152
  v_cvt_pk_bf16_f32 v142, v92, v93
  v_mul_f32 v94, s24, v94
  v_mfma_f32_32x32x16_bf16 v[112:127], a[100:103], v[40:43], v[112:127]
  s_waitcnt lgkmcnt(5)
  buffer_load_dwordx4 v22, s[12:15], s19 offen lds
  v_mul_f32 v95, s24, v95
  v_cvt_pk_bf16_f32 v143, v94, v95
  v_mfma_f32_32x32x16_bf16 v[96:111], a[104:107], v[44:47], v[96:111]
  ds_read_b128 v[36:39], v11 offset:49152
  v_mfma_f32_32x32x16_bf16 v[112:127], a[108:111], v[44:47], v[112:127]
  s_waitcnt lgkmcnt(5)
  v_mfma_f32_32x32x16_bf16 v[96:111], a[112:115], v[48:51], v[96:111]
  s_add_u32 m0, s25, 7168
  ds_read_b128 v[40:43], v12 offset:49152
  v_mfma_f32_32x32x16_bf16 v[112:127], a[116:119], v[48:51], v[112:127]
  s_waitcnt lgkmcnt(5)
  buffer_load_dwordx4 v23, s[12:15], s19 offen lds
  v_mfma_f32_32x32x16_bf16 v[96:111], a[120:123], v[52:55], v[96:111]
  s_cmp_gt_u32 s23, 3
  ds_read_b128 v[44:47], v13 offset:49152
  v_mfma_f32_32x32x16_bf16 v[112:127], a[124:127], v[52:55], v[112:127]
  s_waitcnt lgkmcnt(5)
  s_cselect_b32 s26, s20, 0
  v_mfma_f32_32x32x16_bf16 v[96:111], a[128:131], v[24:27], v[96:111]
  s_add_u32 s19, s19, s26
  ds_read_b128 v[48:51], v14 offset:49152
  v_mfma_f32_32x32x16_bf16 v[112:127], a[132:135], v[24:27], v[112:127]
  s_waitcnt lgkmcnt(5)
  s_add_u32 s25, s25, 32768
  v_mfma_f32_32x32x16_bf16 v[96:111], a[136:139], v[28:31], v[96:111]
  s_and_b32 s25, s25, 0x1ffff
  ds_read_b128 v[52:55], v15 offset:49152
  v_mfma_f32_32x32x16_bf16 v[112:127], a[140:143], v[28:31], v[112:127]
  s_waitcnt lgkmcnt(5)
  buffer_store_dwordx4 v[128:131], v7, s[4:7], s21 offen offset:0 sc1
  v_mfma_f32_32x32x16_bf16 v[96:111], a[144:147], v[32:35], v[96:111]
  ds_read_b128 v[24:27], v8 offset:57344
  v_mfma_f32_32x32x16_bf16 v[112:127], a[148:151], v[32:35], v[112:127]
  s_waitcnt lgkmcnt(5)
  v_xor_b32 v8, 0x10000, v8
  v_mfma_f32_32x32x16_bf16 v[96:111], a[152:155], v[36:39], v[96:111]
  ds_read_b128 v[28:31], v9 offset:57344
  v_mfma_f32_32x32x16_bf16 v[112:127], a[156:159], v[36:39], v[112:127]
  s_waitcnt lgkmcnt(5)
  buffer_store_dwordx4 v[132:135], v7, s[4:7], s21 offen offset:1024 sc1
  v_xor_b32 v9, 0x10000, v9
  v_mfma_f32_32x32x16_bf16 v[96:111], a[160:163], v[40:43], v[96:111]
  ds_read_b128 v[32:35], v10 offset:57344
  v_mfma_f32_32x32x16_bf16 v[112:127], a[164:167], v[40:43], v[112:127]
  s_waitcnt lgkmcnt(5)
  v_xor_b32 v10, 0x10000, v10
  v_mfma_f32_32x32x16_bf16 v[96:111], a[168:171], v[44:47], v[96:111]
  ds_read_b128 v[36:39], v11 offset:57344
  v_mfma_f32_32x32x16_bf16 v[112:127], a[172:175], v[44:47], v[112:127]
  s_waitcnt lgkmcnt(5)
  buffer_store_dwordx4 v[136:139], v7, s[4:7], s21 offen offset:2048 sc1
  v_xor_b32 v11, 0x10000, v11
  v_mfma_f32_32x32x16_bf16 v[96:111], a[176:179], v[48:51], v[96:111]
  ds_read_b128 v[40:43], v12 offset:57344
  v_mfma_f32_32x32x16_bf16 v[112:127], a[180:183], v[48:51], v[112:127]
  s_waitcnt lgkmcnt(5)
  v_xor_b32 v12, 0x10000, v12
  v_mfma_f32_32x32x16_bf16 v[96:111], a[184:187], v[52:55], v[96:111]
  ds_read_b128 v[44:47], v13 offset:57344
  v_mfma_f32_32x32x16_bf16 v[112:127], a[188:191], v[52:55], v[112:127]
  s_waitcnt lgkmcnt(5)
  buffer_store_dwordx4 v[140:143], v7, s[4:7], s21 offen offset:3072 sc1
  v_xor_b32 v13, 0x10000, v13
  v_mfma_f32_32x32x16_bf16 v[96:111], a[192:195], v[24:27], v[96:111]
  s_mov_b32 s21, s27
  ds_read_b128 v[48:51], v14 offset:57344
  v_mov_b32 v7, v2
  v_mfma_f32_32x32x16_bf16 v[112:127], a[196:199], v[24:27], v[112:127]
  s_waitcnt lgkmcnt(5)
  v_xor_b32 v14, 0x10000, v14
  v_mfma_f32_32x32x16_bf16 v[96:111], a[200:203], v[28:31], v[96:111]
  s_add_u32 s27, s27, s22
  ds_read_b128 v[52:55], v15 offset:57344
  v_mfma_f32_32x32x16_bf16 v[112:127], a[204:207], v[28:31], v[112:127]
  s_waitcnt lgkmcnt(5)
  s_waitcnt vmcnt(17)
  s_barrier
  v_xor_b32 v15, 0x10000, v15
  v_mfma_f32_32x32x16_bf16 v[96:111], a[208:211], v[32:35], v[96:111]
  ds_read_b128 v[24:27], v8 offset:0
  v_mfma_f32_32x32x16_bf16 v[112:127], a[212:215], v[32:35], v[112:127]
  s_waitcnt lgkmcnt(5)
  v_mfma_f32_32x32x16_bf16 v[96:111], a[216:219], v[36:39], v[96:111]
  s_add_u32 s29, s29, 1
  ds_read_b128 v[28:31], v9 offset:0
  v_mfma_f32_32x32x16_bf16 v[112:127], a[220:223], v[36:39], v[112:127]
  s_waitcnt lgkmcnt(5)
  s_max_i32 s30, s29, 0
  v_mov_b32 v144, s30
  v_mfma_f32_32x32x16_bf16 v[96:111], a[224:227], v[40:43], v[96:111]
  ds_read_b128 v[32:35], v10 offset:0
  v_mfma_f32_32x32x16_bf16 v[112:127], a[228:231], v[40:43], v[112:127]
  s_waitcnt lgkmcnt(5)
  buffer_store_dword v144, v145, s[4:7], s31 offen sc1
  v_mfma_f32_32x32x16_bf16 v[96:111], a[232:235], v[44:47], v[96:111]
  ds_read_b128 v[36:39], v11 offset:0
  v_mfma_f32_32x32x16_bf16 v[112:127], a[236:239], v[44:47], v[112:127]
  s_waitcnt lgkmcnt(5)
  v_mfma_f32_32x32x16_bf16 v[96:111], a[240:243], v[48:51], v[96:111]
  s_sub_u32 s23, s23, 1
  ds_read_b128 v[40:43], v12 offset:0
  v_mfma_f32_32x32x16_bf16 v[112:127], a[244:247], v[48:51], v[112:127]
  s_waitcnt lgkmcnt(5)
  v_mfma_f32_32x32x16_bf16 v[96:111], a[248:251], v[52:55], v[96:111]
  s_cmp_eq_u32 s23, 0
  ds_read_b128 v[44:47], v13 offset:0
  v_mfma_f32_32x32x16_bf16 v[112:127], a[252:255], v[52:55], v[112:127]
  s_cbranch_scc1 G_done1_5
  s_branch G_top_3
G_done0_4:
  s_nop 7
  s_nop 3
  v_mul_f32 v64, s24, v64
  v_mul_f32 v65, s24, v65
  v_cvt_pk_bf16_f32 v128, v64, v65
  v_mul_f32 v66, s24, v66
  v_mul_f32 v67, s24, v67
  v_cvt_pk_bf16_f32 v129, v66, v67
  v_mul_f32 v68, s24, v68
  v_mul_f32 v69, s24, v69
  v_cvt_pk_bf16_f32 v130, v68, v69
  v_mul_f32 v70, s24, v70
  v_mul_f32 v71, s24, v71
  v_cvt_pk_bf16_f32 v131, v70, v71
  buffer_store_dwordx4 v[128:131], v7, s[4:7], s21 offen offset:0 sc1
  v_mul_f32 v72, s24, v72
  v_mul_f32 v73, s24, v73
  v_cvt_pk_bf16_f32 v132, v72, v73
  v_mul_f32 v74, s24, v74
  v_mul_f32 v75, s24, v75
  v_cvt_pk_bf16_f32 v133, v74, v75
  v_mul_f32 v76, s24, v76
  v_mul_f32 v77, s24, v77
  v_cvt_pk_bf16_f32 v134, v76, v77
  v_mul_f32 v78, s24, v78
  v_mul_f32 v79, s24, v79
  v_cvt_pk_bf16_f32 v135, v78, v79
  buffer_store_dwordx4 v[132:135], v7, s[4:7], s21 offen offset:1024 sc1
  v_mul_f32 v80, s24, v80
  v_mul_f32 v81, s24, v81
  v_cvt_pk_bf16_f32 v136, v80, v81
  v_mul_f32 v82, s24, v82
  v_mul_f32 v83, s24, v83
  v_cvt_pk_bf16_f32 v137, v82, v83
  v_mul_f32 v84, s24, v84
  v_mul_f32 v85, s24, v85
  v_cvt_pk_bf16_f32 v138, v84, v85
  v_mul_f32 v86, s24, v86
  v_mul_f32 v87, s24, v87
  v_cvt_pk_bf16_f32 v139, v86, v87
  buffer_store_dwordx4 v[136:139], v7, s[4:7], s21 offen offset:2048 sc1
  v_mul_f32 v88, s24, v88
  v_mul_f32 v89, s24, v89
  v_cvt_pk_bf16_f32 v140, v88, v89
  v_mul_f32 v90, s24, v90
  v_mul_f32 v91, s24, v91
  v_cvt_pk_bf16_f32 v141, v90, v91
  v_mul_f32 v92, s24, v92
  v_mul_f32 v93, s24, v93
  v_cvt_pk_bf16_f32 v142, v92, v93
  v_mul_f32 v94, s24, v94
  v_mul_f32 v95, s24, v95
  v_cvt_pk_bf16_f32 v143, v94, v95
  buffer_store_dwordx4 v[140:143], v7, s[4:7], s21 offen offset:3072 sc1
  s_branch G_fin_6
G_done1_5:
  s_nop 7
  s_nop 3
  v_mul_f32 v96, s24, v96
  v_mul_f32 v97, s24, v97
  v_cvt_pk_bf16_f32 v128, v96, v97
  v_mul_f32 v98, s24, v98
  v_mul_f32 v99, s24, v99
  v_cvt_pk_bf16_f32 v129, v98, v99
  v_mul_f32 v100, s24, v100
  v_mul_f32 v101, s24, v101
  v_cvt_pk_bf16_f32 v130, v100, v101
  v_mul_f32 v102, s24, v102
  v_mul_f32 v103, s24, v103
  v_cvt_pk_bf16_f32 v131, v102, v103
  buffer_store_dwordx4 v[128:131], v7, s[4:7], s21 offen offset:0 sc1
  v_mul_f32 v104, s24, v104
  v_mul_f32 v105, s24, v105
  v_cvt_pk_bf16_f32 v132, v104, v105
  v_mul_f32 v106, s24, v106
  v_mul_f32 v107, s24, v107
  v_cvt_pk_bf16_f32 v133, v106, v107
  v_mul_f32 v108, s24, v108
  v_mul_f32 v109, s24, v109
  v_cvt_pk_bf16_f32 v134, v108, v109
  v_mul_f32 v110, s24, v110
  v_mul_f32 v111, s24, v111
  v_cvt_pk_bf16_f32 v135, v110, v111
  buffer_store_dwordx4 v[132:135], v7, s[4:7], s21 offen offset:1024 sc1
  v_mul_f32 v112, s24, v112
  v_mul_f32 v113, s24, v113
  v_cvt_pk_bf16_f32 v136, v112, v113
  v_mul_f32 v114, s24, v114
  v_mul_f32 v115, s24, v115
  v_cvt_pk_bf16_f32 v137, v114, v115
  v_mul_f32 v116, s24, v116
  v_mul_f32 v117, s24, v117
  v_cvt_pk_bf16_f32 v138, v116, v117
  v_mul_f32 v118, s24, v118
  v_mul_f32 v119, s24, v119
  v_cvt_pk_bf16_f32 v139, v118, v119
  buffer_store_dwordx4 v[136:139], v7, s[4:7], s21 offen offset:2048 sc1
  v_mul_f32 v120, s24, v120
  v_mul_f32 v121, s24, v121
  v_cvt_pk_bf16_f32 v140, v120, v121
  v_mul_f32 v122, s24, v122
  v_mul_f32 v123, s24, v123
  v_cvt_pk_bf16_f32 v141, v122, v123
  v_mul_f32 v124, s24, v124
  v_mul_f32 v125, s24, v125
  v_cvt_pk_bf16_f32 v142, v124, v125
  v_mul_f32 v126, s24, v126
  v_mul_f32 v127, s24, v127
  v_cvt_pk_bf16_f32 v143, v126, v127
  buffer_store_dwordx4 v[140:143], v7, s[4:7], s21 offen offset:3072 sc1
G_fin_6:
  s_waitcnt vmcnt(0) lgkmcnt(0)
  s_barrier
  s_add_u32 s30, s29, 3
  v_mov_b32 v144, s30
  v_min_u32 v145, 1, v0
  v_lshlrev_b32 v145, 30, v145
  buffer_store_dword v144, v145, s[4:7], s31 offen sc1
  s_branch P_end_2
P_v_1:
  s_mov_b32 s27, s21
  v_mov_b32 v7, 0x40000000
  s_mov_b32 s29, -3
  v_min_u32 v145, 1, v0
  v_lshlrev_b32 v145, 30, v145
  ds_read_b128 v[24:27], v8 offset:0
  ds_read_b128 v[28:31], v9 offset:0
  ds_read_b128 v[32:35], v10 offset:0
  ds_read_b128 v[36:39], v11 offset:0
  ds_read_b128 v[40:43], v12 offset:0
  ds_read_b128 v[44:47], v13 offset:0
.p2align 6
G_top_7:
  s_waitcnt lgkmcnt(5)
  v_mfma_f32_32x32x16_bf16 v[64:79], v[24:27], a[0:3], 0
  s_add_u32 m0, s25, 0
  ds_read_b128 v[48:51], v14 offset:0
  v_mfma_f32_32x32x16_bf16 v[80:95], v[24:27], a[4:7], 0
  s_waitcnt lgkmcnt(5)
  buffer_load_dwordx4 v16, s[12:15], s19 offen lds
  v_mfma_f32_32x32x16_bf16 v[64:79], v[28:31], a[8:11], v[64:79]
  ds_read_b128 v[52:55], v15 offset:0
  v_mul_f32 v96, s24, v96
  v_mul_f32 v97, s24, v97
  v_mfma_f32_32x32x16_bf16 v[80:95], v[28:31], a[12:15], v[80:95]
  s_waitcnt lgkmcnt(5)
  v_cvt_pk_bf16_f32 v128, v96, v97
  v_mul_f32 v98, s24, v98
  v_mfma_f32_32x32x16_bf16 v[64:79], v[32:35], a[16:19], v[64:79]
  s_add_u32 m0, s25, 1024
  ds_read_b128 v[24:27], v8 offset:8192
  v_mul_f32 v99, s24, v99
  v_cvt_pk_bf16_f32 v129, v98, v99
  v_mfma_f32_32x32x16_bf16 v[80:95], v[32:35], a[20:23], v[80:95]
  s_waitcnt lgkmcnt(5)
  buffer_load_dwordx4 v17, s[12:15], s19 offen lds
  v_mul_f32 v100, s24, v100
  v_mul_f32 v101, s24, v101
  v_mfma_f32_32x32x16_bf16 v[64:79], v[36:39], a[24:27], v[64:79]
  ds_read_b128 v[28:31], v9 offset:8192
  v_cvt_pk_bf16_f32 v130, v100, v101
  v_mul_f32 v102, s24, v102
  v_mfma_f32_32x32x16_bf16 v[80:95], v[36:39], a[28:31], v[80:95]
  s_waitcnt lgkmcnt(5)
  v_mul_f32 v103, s24, v103
  v_cvt_pk_bf16_f32 v131, v102, v103
  v_mfma_f32_32x32x16_bf16 v[64:79], v[40:43], a[32:35], v[64:79]
  s_add_u32 m0, s25, 2048
  ds_read_b128 v[32:35], v10 offset:8192
  v_mul_f32 v104, s24, v104
  v_mul_f32 v105, s24, v105
  v_mfma_f32_32x32x16_bf16 v[80:95], v[40:43], a[36:39], v[80:95]
  s_waitcnt lgkmcnt(5)
  buffer_load_dwordx4 v18, s[12:15], s19 offen lds
  v_cvt_pk_bf16_f32 v132, v104, v105
  v_mul_f32 v106, s24, v106
  v_mfma_f32_32x32x16_bf16 v[64:79], v[44:47], a[40:43], v[64:79]
  ds_read_b128 v[36:39], v11 offset:8192
  v_mul_f32 v107, s24, v107
  v_cvt_pk_bf16_f32 v133, v106, v107
  v_mfma_f32_32x32x16_bf16 v[80:95], v[44:47], a[44:47], v[80:95]
  s_waitcnt lgkmcnt(5)
  v_mul_f32 v108, s24, v108
  v_mul_f32 v109, s24, v109
  v_mfma_f32_32x32x16_bf16 v[64:79], v[48:51], a[48:51], v[64:79]
  s_add_u32 m0, s25, 3072
  ds_read_b128 v[40:43], v12 offset:8192
  v_cvt_pk_bf16_f32 v134, v108, v109
  v_mul_f32 v110, s24, v110
  v_mfma_f32_32x32x16_bf16 v[80:95], v[48:51], a[52:55], v[80:95]
  s_waitcnt lgkmcnt(5)
  buffer_load_dwordx4 v19, s[12:15], s19 offen lds
  v_mul_f32 v111, s24, v111
  v_cvt_pk_bf16_f32 v135, v110, v111
  v_mfma_f32_32x32x16_bf16 v[64:79], v[52:55], a[56:59], v[64:79]
  ds_read_b128 v[44:47], v13 offset:8192
  v_mul_f32 v112, s24, v112
  v_mul_f32 v113, s24, v113
  v_mfma_f32_32x32x16_bf16 v[80:95], v[52:55], a[60:63], v[80:95]
  s_waitcnt lgkmcnt(5)
  v_cvt_pk_bf16_f32 v136, v112, v113
  v_mul_f32 v114, s24, v114
  v_mfma_f32_32x32x16_bf16 v[64:79], v[24:27], a[64:67], v[64:79]
  s_add_u32 m0, s25, 4096
  ds_read_b128 v[48:51], v14 offset:8192
  v_mul_f32 v115, s24, v115
  v_cvt_pk_bf16_f32 v137, v114, v115
  v_mfma_f32_32x32x16_bf16 v[80:95], v[24:27], a[68:71], v[80:95]
  s_waitcnt lgkmcnt(5)
  buffer_load_dwordx4 v20, s[12:15], s19 offen lds
  v_mul_f32 v116, s24, v116
  v_mul_f32 v117, s24, v117
  v_mfma_f32_32x32x16_bf16 v[64:79], v[28:31], a[72:75], v[64:79]
  ds_read_b128 v[52:55], v15 offset:8192
  v_cvt_pk_bf16_f32 v138, v116, v117
  v_mul_f32 v118, s24, v118
  v_mfma_f32_32x32x16_bf16 v[80:95], v[28:31], a[76:79], v[80:95]
  s_waitcnt lgkmcnt(5)
  v_mul_f32 v119, s24, v119
  v_cvt_pk_bf16_f32 v139, v118, v119
  v_mfma_f32_32x32x16_bf16 v[64:79], v[32:35], a[80:83], v[64:79]
  s_add_u32 m0, s25, 5120
  ds_read_b128 v[24:27], v8 offset:16384
  v_mul_f32 v120, s24, v120
  v_mul_f32 v121, s24, v121
  v_mfma_f32_32x32x16_bf16 v[80:95], v[32:35], a[84:87], v[80:95]
  s_waitcnt lgkmcnt(5)
  buffer_load_dwordx4 v21, s[12:15], s19 offen lds
  v_cvt_pk_bf16_f32 v140, v120, v121
  v_mul_f32 v122, s24, v122
  v_mfma_f32_32x32x16_bf16 v[64:79], v[36:39], a[88:91], v[64:79]
  ds_read_b128 v[28:31], v9 offset:16384
  v_mul_f32 v123, s24, v123
  v_cvt_pk_bf16_f32 v141, v122, v123
  v_mfma_f32_32x32x16_bf16 v[80:95], v[36:39], a[92:95], v[80:95]
  s_waitcnt lgkmcnt(5)
  v_mul_f32 v124, s24, v124
  v_mul_f32 v125, s24, v125
  v_mfma_f32_32x32x16_bf16 v[64:79], v[40:43], a[96:99], v[64:79]
  s_add_u32 m0, s25, 6144
  ds_read_b128 v[32:35], v10 offset:16384
  v_cvt_pk_bf16_f32 v142, v124, v125
  v_mul_f32 v126, s24, v126
  v_mfma_f32_32x32x16_bf16 v[80:95], v[40:43], a[100:103], v[80:95]
  s_waitcnt lgkmcnt(5)
  buffer_load_dwordx4 v22, s[12:15], s19 offen lds
  v_mul_f32 v127, s24, v127
  v_cvt_pk_bf16_f32 v143, v126, v127
  v_mfma_f32_32x32x16_bf16 v[64:79], v[44:47], a[104:107], v[64:79]
  ds_read_b128 v[36:39], v11 offset:16384
  v_mfma_f32_32x32x16_bf16 v[80:95], v[44:47], a[108:111], v[80:95]
  s_waitcnt lgkmcnt(5)
  v_mfma_f32_32x32x16_bf16 v[64:79], v[48:51], a[112:115], v[64:79]
  s_add_u32 m0, s25, 7168
  ds_read_b128 v[40:43], v12 offset:16384
  v_mfma_f32_32x32x16_bf16 v[80:95], v[48:51], a[116:119], v[80:95]
  s_waitcnt lgkmcnt(5)
  buffer_load_dwordx4 v23, s[12:15], s19 offen lds
  v_mfma_f32_32x32x16_bf16 v[64:79], v[52:55], a[120:123], v[64:79]
  s_cmp_gt_u32 s23, 3
  ds_read_b128 v[44:47], v13 offset:16384
  v_mfma_f32_32x32x16_bf16 v[80:95], v[52:55], a[124:127], v[80:95]
  s_waitcnt lgkmcnt(5)
  s_cselect_b32 s26, s20, 0
  v_mfma_f32_32x32x16_bf16 v[64:79], v[24:27], a[128:131], v[64:79]
  s_add_u32 s19, s19, s26
  ds_read_b128 v[48:51], v14 offset:16384
  v_mfma_f32_32x32x16_bf16 v[80:95], v[24:27], a[132:135], v[80:95]
  s_waitcnt lgkmcnt(5)
  s_add_u32 s25, s25, 32768
  v_mfma_f32_32x32x16_bf16 v[64:79], v[28:31], a[136:139], v[64:79]
  s_and_b32 s25, s25, 0x1ffff
  ds_read_b128 v[52:55], v15 offset:16384
  v_mfma_f32_32x32x16_bf16 v[80:95], v[28:31], a[140:143], v[80:95]
  s_waitcnt lgkmcnt(5)
  buffer_store_dwordx4 v[128:131], v7, s[4:7], s21 offen offset:0 sc1
  v_mfma_f32_32x32x16_bf16 v[64:79], v[32:35], a[144:147], v[64:79]
  ds_read_b128 v[24:27], v8 offset:24576
  v_mfma_f32_32x32x16_bf16 v[80:95], v[32:35], a[148:151], v[80:95]
  s_waitcnt lgkmcnt(5)
  v_mfma_f32_32x32x16_bf16 v[64:79], v[36:39], a[152:155], v[64:79]
  ds_read_b128 v[28:31], v9 offset:24576
  v_mfma_f32_32x32x16_bf16 v[80:95], v[36:39], a[156:159], v[80:95]
  s_waitcnt lgkmcnt(5)
  buffer_store_dwordx4 v[132:135], v7, s[4:7], s21 offen offset:1024 sc1
  v_mfma_f32_32x32x16_bf16 v[64:79], v[40:43], a[160:163], v[64:79]
  ds_read_b128 v[32:35], v10 offset:24576
  v_mfma_f32_32x32x16_bf16 v[80:95], v[40:43], a[164:167], v[80:95]
  s_waitcnt lgkmcnt(5)
  v_mfma_f32_32x32x16_bf16 v[64:79], v[44:47], a[168:171], v[64:79]
  ds_read_b128 v[36:39], v11 offset:24576
  v_mfma_f32_32x32x16_bf16 v[80:95], v[44:47], a[172:175], v[80:95]
  s_waitcnt lgkmcnt(5)
  buffer_store_dwordx4 v[136:139], v7, s[4:7], s21 offen offset:2048 sc1
  v_mfma_f32_32x32x16_bf16 v[64:79], v[48:51], a[176:179], v[64:79]
  ds_read_b128 v[40:43], v12 offset:24576
  v_mfma_f32_32x32x16_bf16 v[80:95], v[48:51], a[180:183], v[80:95]
  s_waitcnt lgkmcnt(5)
  v_mfma_f32_32x32x16_bf16 v[64:79], v[52:55], a[184:187], v[64:79]
  ds_read_b128 v[44:47], v13 offset:24576
  v_mfma_f32_32x32x16_bf16 v[80:95], v[52:55], a[188:191], v[80:95]
  s_waitcnt lgkmcnt(5)
  buffer_store_dwordx4 v[140:143], v7, s[4:7], s21 offen offset:3072 sc1
  v_mfma_f32_32x32x16_bf16 v[64:79], v[24:27], a[192:195], v[64:79]
  s_mov_b32 s21, s27
  ds_read_b128 v[48:51], v14 offset:24576
  v_mov_b32 v7, v2
  v_mfma_f32_32x32x16_bf16 v[80:95], v[24:27], a[196:199], v[80:95]
  s_waitcnt lgkmcnt(5)
  v_mfma_f32_32x32x16_bf16 v[64:79], v[28:31], a[200:203], v[64:79]
  s_add_u32 s27, s27, s22
  ds_read_b128 v[52:55], v15 offset:24576
  v_mfma_f32_32x32x16_bf16 v[80:95], v[28:31], a[204:207], v[80:95]
  s_waitcnt lgkmcnt(5)
  s_waitcnt vmcnt(17)
  s_barrier
  v_mfma_f32_32x32x16_bf16 v[64:79], v[32:35], a[208:211], v[64:79]
  ds_read_b128 v[24:27], v8 offset:32768
  v_mfma_f32_32x32x16_bf16 v[80:95], v[32:35], a[212:215], v[80:95]
  s_waitcnt lgkmcnt(5)
  v_mfma_f32_32x32x16_bf16 v[64:79], v[36:39], a[216:219], v[64:79]
  s_add_u32 s29, s29, 1
  ds_read_b128 v[28:31], v9 offset:32768
  v_mfma_f32_32x32x16_bf16 v[80:95], v[36:39], a[220:223], v[80:95]
  s_waitcnt lgkmcnt(5)
  s_max_i32 s30, s29, 0
  v_mov_b32 v144, s30
  v_mfma_f32_32x32x16_bf16 v[64:79], v[40:43], a[224:227], v[64:79]
  ds_read_b128 v[32:35], v10 offset:32768
  v_mfma_f32_32x32x16_bf16 v[80:95], v[40:43], a[228:231], v[80:95]
  s_waitcnt lgkmcnt(5)
  buffer_store_dword v144, v145, s[4:7], s31 offen sc1
  v_mfma_f32_32x32x16_bf16 v[64:79], v[44:47], a[232:235], v[64:79]
  ds_read_b128 v[36:39], v11 offset:32768
  v_mfma_f32_32x32x16_bf16 v[80:95], v[44:47], a[236:239], v[80:95]
  s_waitcnt lgkmcnt(5)
  v_mfma_f32_32x32x16_bf16 v[64:79], v[48:51], a[240:243], v[64:79]
  s_sub_u32 s23, s23, 1
  ds_read_b128 v[40:43], v12 offset:32768
  v_mfma_f32_32x32x16_bf16 v[80:95], v[48:51], a[244:247], v[80:95]
  s_waitcnt lgkmcnt(5)
  v_mfma_f32_32x32x16_bf16 v[64:79], v[52:55], a[248:251], v[64:79]
  s_cmp_eq_u32 s23, 0
  ds_read_b128 v[44:47], v13 offset:32768
  v_mfma_f32_32x32x16_bf16 v[80:95], v[52:55], a[252:255], v[80:95]
  s_cbranch_scc1 G_done0_8
  s_waitcnt lgkmcnt(5)
  v_mfma_f32_32x32x16_bf16 v[96:111], v[24:27], a[0:3], 0
  s_add_u32 m0, s25, 0
  ds_read_b128 v[48:51], v14 offset:32768
  v_mfma_f32_32x32x16_bf16 v[112:127], v[24:27], a[4:7], 0
  s_waitcnt lgkmcnt(5)
  buffer_load_dwordx4 v16, s[12:15], s19 offen lds
  v_mfma_f32_32x32x16_bf16 v[96:111], v[28:31], a[8:11], v[96:111]
  ds_read_b128 v[52:55], v15 offset:32768
  v_mul_f32 v64, s24, v64
  v_mul_f32 v65, s24, v65
  v_mfma_f32_32x32x16_bf16 v[112:127], v[28:31], a[12:15], v[112:127]
  s_waitcnt lgkmcnt(5)
  v_cvt_pk_bf16_f32 v128, v64, v65
  v_mul_f32 v66, s24, v66
  v_mfma_f32_32x32x16_bf16 v[96:111], v[32:35], a[16:19], v[96:111]
  s_add_u32 m0, s25, 1024
  ds_read_b128 v[24:27], v8 offset:40960
  v_mul_f32 v67, s24, v67
  v_cvt_pk_bf16_f32 v129, v66, v67
  v_mfma_f32_32x32x16_bf16 v[112:127], v[32:35], a[20:23], v[112:127]
  s_waitcnt lgkmcnt(5)
  buffer_load_dwordx4 v17, s[12:15], s19 offen lds
  v_mul_f32 v68, s24, v68
  v_mul_f32 v69, s24, v69
  v_mfma_f32_32x32x16_bf16 v[96:111], v[36:39], a[24:27], v[96:111]
  ds_read_b128 v[28:31], v9 offset:40960
  v_cvt_pk_bf16_f32 v130, v68, v69
  v_mul_f32 v70, s24, v70
  v_mfma_f32_32x32x16_bf16 v[112:127], v[36:39], a[28:31], v[112:127]
  s_waitcnt lgkmcnt(5)
  v_mul_f32 v71, s24, v71
  v_cvt_pk_bf16_f32 v131, v70, v71
  v_mfma_f32_32x32x16_bf16 v[96:111], v[40:43], a[32:35], v[96:111]
  s_add_u32 m0, s25, 2048
  ds_read_b128 v[32:35], v10 offset:40960
  v_mul_f32 v72, s24, v72
  v_mul_f32 v73, s24, v73
  v_mfma_f32_32x32x16_bf16 v[112:127], v[40:43], a[36:39], v[112:127]
  s_waitcnt lgkmcnt(5)
  buffer_load_dwordx4 v18, s[12:15], s19 offen lds
  v_cvt_pk_bf16_f32 v132, v72, v73
  v_mul_f32 v74, s24, v74
  v_mfma_f32_32x32x16_bf16 v[96:111], v[44:47], a[40:43], v[96:111]
  ds_read_b128 v[36:39], v11 offset:40960
  v_mul_f32 v75, s24, v75
  v_cvt_pk_bf16_f32 v133, v74, v75
  v_mfma_f32_32x32x16_bf16 v[112:127], v[44:47], a[44:47], v[112:127]
  s_waitcnt lgkmcnt(5)
  v_mul_f32 v76, s24, v76
  v_mul_f32 v77, s24, v77
  v_mfma_f32_32x32x16_bf16 v[96:111], v[48:51], a[48:51], v[96:111]
  s_add_u32 m0, s25, 3072
  ds_read_b128 v[40:43], v12 offset:40960
  v_cvt_pk_bf16_f32 v134, v76, v77
  v_mul_f32 v78, s24, v78
  v_mfma_f32_32x32x16_bf16 v[112:127], v[48:51], a[52:55], v[112:127]
  s_waitcnt lgkmcnt(5)
  buffer_load_dwordx4 v19, s[12:15], s19 offen lds
  v_mul_f32 v79, s24, v79
  v_cvt_pk_bf16_f32 v135, v78, v79
  v_mfma_f32_32x32x16_bf16 v[96:111], v[52:55], a[56:59], v[96:111]
  ds_read_b128 v[44:47], v13 offset:40960
  v_mul_f32 v80, s24, v80
  v_mul_f32 v81, s24, v81
  v_mfma_f32_32x32x16_bf16 v[112:127], v[52:55], a[60:63], v[112:127]
  s_waitcnt lgkmcnt(5)
  v_cvt_pk_bf16_f32 v136, v80, v81
  v_mul_f32 v82, s24, v82
  v_mfma_f32_32x32x16_bf16 v[96:111], v[24:27], a[64:67], v[96:111]
  s_add_u32 m0, s25, 4096
  ds_read_b128 v[48:51], v14 offset:40960
  v_mul_f32 v83, s24, v83
  v_cvt_pk_bf16_f32 v137, v82, v83
  v_mfma_f32_32x32x16_bf16 v[112:127], v[24:27], a[68:71], v[112:127]
  s_waitcnt lgkmcnt(5)
  buffer_load_dwordx4 v20, s[12:15], s19 offen lds
  v_mul_f32 v84, s24, v84
  v_mul_f32 v85, s24, v85
  v_mfma_f32_32x32x16_bf16 v[96:111], v[28:31], a[72:75], v[96:111]
  ds_read_b128 v[52:55], v15 offset:40960
  v_cvt_pk_bf16_f32 v138, v84, v85
  v_mul_f32 v86, s24, v86
  v_mfma_f32_32x32x16_bf16 v[112:127], v[28:31], a[76:79], v[112:127]
  s_waitcnt lgkmcnt(5)
  v_mul_f32 v87, s24, v87
  v_cvt_pk_bf16_f32 v139, v86, v87
  v_mfma_f32_32x32x16_bf16 v[96:111], v[32:35], a[80:83], v[96:111]
  s_add_u32 m0, s25, 5120
  ds_read_b128 v[24:27], v8 offset:49152
  v_mul_f32 v88, s24, v88
  v_mul_f32 v89, s24, v89
  v_mfma_f32_32x32x16_bf16 v[112:127], v[32:35], a[84:87], v[112:127]
  s_waitcnt lgkmcnt(5)
  buffer_load_dwordx4 v21, s[12:15], s19 offen lds
  v_cvt_pk_bf16_f32 v140, v88, v89
  v_mul_f32 v90, s24, v90
  v_mfma_f32_32x32x16_bf16 v[96:111], v[36:39], a[88:91], v[96:111]
  ds_read_b128 v[28:31], v9 offset:49152
  v_mul_f32 v91, s24, v91
  v_cvt_pk_bf16_f32 v141, v90, v91
  v_mfma_f32_32x32x16_bf16 v[112:127], v[36:39], a[92:95], v[112:127]
  s_waitcnt lgkmcnt(5)
  v_mul_f32 v92, s24, v92
  v_mul_f32 v93, s24, v93
  v_mfma_f32_32x32x16_bf16 v[96:111], v[40:43], a[96:99], v[96:111]
  s_add_u32 m0, s25, 6144
  ds_read_b128 v[32:35], v10 offset:49152
  v_cvt_pk_bf16_f32 v142, v92, v93
  v_mul_f32 v94, s24, v94
  v_mfma_f32_32x32x16_bf16 v[112:127], v[40:43], a[100:103], v[112:127]
  s_waitcnt lgkmcnt(5)
  buffer_load_dwordx4 v22, s[12:15], s19 offen lds
  v_mul_f32 v95, s24, v95
  v_cvt_pk_bf16_f32 v143, v94, v95
  v_mfma_f32_32x32x16_bf16 v[96:111], v[44:47], a[104:107], v[96:111]
  ds_read_b128 v[36:39], v11 offset:49152
  v_mfma_f32_32x32x16_bf16 v[112:127], v[44:47], a[108:111], v[112:127]
  s_waitcnt lgkmcnt(5)
  v_mfma_f32_32x32x16_bf16 v[96:111], v[48:51], a[112:115], v[96:111]
  s_add_u32 m0, s25, 7168
  ds_read_b128 v[40:43], v12 offset:49152
  v_mfma_f32_32x32x16_bf16 v[112:127], v[48:51], a[116:119], v[112:127]
  s_waitcnt lgkmcnt(5)
  buffer_load_dwordx4 v23, s[12:15], s19 offen lds
  v_mfma_f32_32x32x16_bf16 v[96:111], v[52:55], a[120:123], v[96:111]
  s_cmp_gt_u32 s23, 3
  ds_read_b128 v[44:47], v13 offset:49152
  v_mfma_f32_32x32x16_bf16 v[112:127], v[52:55], a[124:127], v[112:127]
  s_waitcnt lgkmcnt(5)
  s_cselect_b32 s26, s20, 0
  v_mfma_f32_32x32x16_bf16 v[96:111], v[24:27], a[128:131], v[96:111]
  s_add_u32 s19, s19, s26
  ds_read_b128 v[48:51], v14 offset:49152
  v_mfma_f32_32x32x16_bf16 v[112:127], v[24:27], a[132:135], v[112:127]
  s_waitcnt lgkmcnt(5)
  s_add_u32 s25, s25, 32768
  v_mfma_f32_32x32x16_bf16 v[96:111], v[28:31], a[136:139], v[96:111]
  s_and_b32 s25, s25, 0x1ffff
  ds_read_b128 v[52:55], v15 offset:49152
  v_mfma_f32_32x32x16_bf16 v[112:127], v[28:31], a[140:143], v[112:127]
  s_waitcnt lgkmcnt(5)
  buffer_store_dwordx4 v[128:131], v7, s[4:7], s21 offen offset:0 sc1
  v_mfma_f32_32x32x16_bf16 v[96:111], v[32:35], a[144:147], v[96:111]
  ds_read_b128 v[24:27], v8 offset:57344
  v_mfma_f32_32x32x16_bf16 v[112:127], v[32:35], a[148:151], v[112:127]
  s_waitcnt lgkmcnt(5)
  v_xor_b32 v8, 0x10000, v8
  v_mfma_f32_32x32x16_bf16 v[96:111], v[36:39], a[152:155], v[96:111]
  ds_read_b128 v[28:31], v9 offset:57344
  v_mfma_f32_32x32x16_bf16 v[112:127], v[36:39], a[156:159], v[112:127]
  s_waitcnt lgkmcnt(5)
  buffer_store_dwordx4 v[132:135], v7, s[4:7], s21 offen offset:1024 sc1
  v_xor_b32 v9, 0x10000, v9
  v_mfma_f32_32x32x16_bf16 v[96:111], v[40:43], a[160:163], v[96:111]
  ds_read_b128 v[32:35], v10 offset:57344
  v_mfma_f32_32x32x16_bf16 v[112:127], v[40:43], a[164:167], v[112:127]
  s_waitcnt lgkmcnt(5)
  v_xor_b32 v10, 0x10000, v10
  v_mfma_f32_32x32x16_bf16 v[96:111], v[44:47], a[168:171], v[96:111]
  ds_read_b128 v[36:39], v11 offset:57344
  v_mfma_f32_32x32x16_bf16 v[112:127], v[44:47], a[172:175], v[112:127]
  s_waitcnt lgkmcnt(5)
  buffer_store_dwordx4 v[136:139], v7, s[4:7], s21 offen offset:2048 sc1
  v_xor_b32 v11, 0x10000, v11
  v_mfma_f32_32x32x16_bf16 v[96:111], v[48:51], a[176:179], v[96:111]
  ds_read_b128 v[40:43], v12 offset:57344
  v_mfma_f32_32x32x16_bf16 v[112:127], v[48:51], a[180:183], v[112:127]
  s_waitcnt lgkmcnt(5)
  v_xor_b32 v12, 0x10000, v12
  v_mfma_f32_32x32x16_bf16 v[96:111], v[52:55], a[184:187], v[96:111]
  ds_read_b128 v[44:47], v13 offset:57344
  v_mfma_f32_32x32x16_bf16 v[112:127], v[52:55], a[188:191], v[112:127]
  s_waitcnt lgkmcnt(5)
  buffer_store_dwordx4 v[140:143], v7, s[4:7], s21 offen offset:3072 sc1
  v_xor_b32 v13, 0x10000, v13
  v_mfma_f32_32x32x16_bf16 v[96:111], v[24:27], a[192:195], v[96:111]
  s_mov_b32 s21, s27
  ds_read_b128 v[48:51], v14 offset:57344
  v_mov_b32 v7, v2
  v_mfma_f32_32x32x16_bf16 v[112:127], v[24:27], a[196:199], v[112:127]
  s_waitcnt lgkmcnt(5)
  v_xor_b32 v14, 0x10000, v14
  v_mfma_f32_32x32x16_bf16 v[96:111], v[28:31], a[200:203], v[96:111]
  s_add_u32 s27, s27, s22
  ds_read_b128 v[52:55], v15 offset:57344
  v_mfma_f32_32x32x16_bf16 v[112:127], v[28:31], a[204:207], v[112:127]
  s_waitcnt lgkmcnt(5)
  s_waitcnt vmcnt(17)
  s_barrier
  v_xor_b32 v15, 0x10000, v15
  v_mfma_f32_32x32x16_bf16 v[96:111], v[32:35], a[208:211], v[96:111]
  ds_read_b128 v[24:27], v8 offset:0
  v_mfma_f32_32x32x16_bf16 v[112:127], v[32:35], a[212:215], v[112:127]
  s_waitcnt lgkmcnt(5)
  v_mfma_f32_32x32x16_bf16 v[96:111], v[36:39], a[216:219], v[96:111]
  s_add_u32 s29, s29, 1
  ds_read_b128 v[28:31], v9 offset:0
  v_mfma_f32_32x32x16_bf16 v[112:127], v[36:39], a[220:223], v[112:127]
  s_waitcnt lgkmcnt(5)
  s_max_i32 s30, s29, 0
  v_mov_b32 v144, s30
  v_mfma_f32_32x32x16_bf16 v[96:111], v[40:43], a[224:227], v[96:111]
  ds_read_b128 v[32:35], v10 offset:0
  v_mfma_f32_32x32x16_bf16 v[112:127], v[40:43], a[228:231], v[112:127]
  s_waitcnt lgkmcnt(5)
  buffer_store_dword v144, v145, s[4:7], s31 offen sc1
  v_mfma_f32_32x32x16_bf16 v[96:111], v[44:47], a[232:235], v[96:111]
  ds_read_b128 v[36:39], v11 offset:0
  v_mfma_f32_32x32x16_bf16 v[112:127], v[44:47], a[236:239], v[112:127]
  s_waitcnt lgkmcnt(5)
  v_mfma_f32_32x32x16_bf16 v[96:111], v[48:51], a[240:243], v[96:111]
  s_sub_u32 s23, s23, 1
  ds_read_b128 v[40:43], v12 offset:0
  v_mfma_f32_32x32x16_bf16 v[112:127], v[48:51], a[244:247], v[112:127]
  s_waitcnt lgkmcnt(5)
  v_mfma_f32_32x32x16_bf16 v[96:111], v[52:55], a[248:251], v[96:111]
  s_cmp_eq_u32 s23, 0
  ds_read_b128 v[44:47], v13 offset:0
  v_mfma_f32_32x32x16_bf16 v[112:127], v[52:55], a[252:255], v[112:127]
  s_cbranch_scc1 G_done1_9
  s_branch G_top_7
G_done0_8:
  s_nop 7
  s_nop 3
  v_mul_f32 v64, s24, v64
  v_mul_f32 v65, s24, v65
  v_cvt_pk_bf16_f32 v128, v64, v65
  v_mul_f32 v66, s24, v66
  v_mul_f32 v67, s24, v67
  v_cvt_pk_bf16_f32 v129, v66, v67
  v_mul_f32 v68, s24, v68
  v_mul_f32 v69, s24, v69
  v_cvt_pk_bf16_f32 v130, v68, v69
  v_mul_f32 v70, s24, v70
  v_mul_f32 v71, s24, v71
  v_cvt_pk_bf16_f32 v131, v70, v71
  buffer_store_dwordx4 v[128:131], v7, s[4:7], s21 offen offset:0 sc1
  v_mul_f32 v72, s24, v72
  v_mul_f32 v73, s24, v73
  v_cvt_pk_bf16_f32 v132, v72, v73
  v_mul_f32 v74, s24, v74
  v_mul_f32 v75, s24, v75
  v_cvt_pk_bf16_f32 v133, v74, v75
  v_mul_f32 v76, s24, v76
  v_mul_f32 v77, s24, v77
  v_cvt_pk_bf16_f32 v134, v76, v77
  v_mul_f32 v78, s24, v78
  v_mul_f32 v79, s24, v79
  v_cvt_pk_bf16_f32 v135, v78, v79
  buffer_store_dwordx4 v[132:135], v7, s[4:7], s21 offen offset:1024 sc1
  v_mul_f32 v80, s24, v80
  v_mul_f32 v81, s24, v81
  v_cvt_pk_bf16_f32 v136, v80, v81
  v_mul_f32 v82, s24, v82
  v_mul_f32 v83, s24, v83
  v_cvt_pk_bf16_f32 v137, v82, v83
  v_mul_f32 v84, s24, v84
  v_mul_f32 v85, s24, v85
  v_cvt_pk_bf16_f32 v138, v84, v85
  v_mul_f32 v86, s24, v86
  v_mul_f32 v87, s24, v87
  v_cvt_pk_bf16_f32 v139, v86, v87
  buffer_store_dwordx4 v[136:139], v7, s[4:7], s21 offen offset:2048 sc1
  v_mul_f32 v88, s24, v88
  v_mul_f32 v89, s24, v89
  v_cvt_pk_bf16_f32 v140, v88, v89
  v_mul_f32 v90, s24, v90
  v_mul_f32 v91, s24, v91
  v_cvt_pk_bf16_f32 v141, v90, v91
  v_mul_f32 v92, s24, v92
  v_mul_f32 v93, s24, v93
  v_cvt_pk_bf16_f32 v142, v92, v93
  v_mul_f32 v94, s24, v94
  v_mul_f32 v95, s24, v95
  v_cvt_pk_bf16_f32 v143, v94, v95
  buffer_store_dwordx4 v[140:143], v7, s[4:7], s21 offen offset:3072 sc1
  s_branch G_fin_10
G_done1_9:
  s_nop 7
  s_nop 3
  v_mul_f32 v96, s24, v96
  v_mul_f32 v97, s24, v97
  v_cvt_pk_bf16_f32 v128, v96, v97
  v_mul_f32 v98, s24, v98
  v_mul_f32 v99, s24, v99
  v_cvt_pk_bf16_f32 v129, v98, v99
  v_mul_f32 v100, s24, v100
  v_mul_f32 v101, s24, v101
  v_cvt_pk_bf16_f32 v130, v100, v101
  v_mul_f32 v102, s24, v102
  v_mul_f32 v103, s24, v103
  v_cvt_pk_bf16_f32 v131, v102, v103
  buffer_store_dwordx4 v[128:131], v7, s[4:7], s21 offen offset:0 sc1
  v_mul_f32 v104, s24, v104
  v_mul_f32 v105, s24, v105
  v_cvt_pk_bf16_f32 v132, v104, v105
  v_mul_f32 v106, s24, v106
  v_mul_f32 v107, s24, v107
  v_cvt_pk_bf16_f32 v133, v106, v107
  v_mul_f32 v108, s24, v108
  v_mul_f32 v109, s24, v109
  v_cvt_pk_bf16_f32 v134, v108, v109
  v_mul_f32 v110, s24, v110
  v_mul_f32 v111, s24, v111
  v_cvt_pk_bf16_f32 v135, v110, v111
  buffer_store_dwordx4 v[132:135], v7, s[4:7], s21 offen offset:1024 sc1
  v_mul_f32 v112, s24, v112
  v_mul_f32 v113, s24, v113
  v_cvt_pk_bf16_f32 v136, v112, v113
  v_mul_f32 v114, s24, v114
  v_mul_f32 v115, s24, v115
  v_cvt_pk_bf16_f32 v137, v114, v115
  v_mul_f32 v116, s24, v116
  v_mul_f32 v117, s24, v117
  v_cvt_pk_bf16_f32 v138, v116, v117
  v_mul_f32 v118, s24, v118
  v_mul_f32 v119, s24, v119
  v_cvt_pk_bf16_f32 v139, v118, v119
  buffer_store_dwordx4 v[136:139], v7, s[4:7], s21 offen offset:2048 sc1
  v_mul_f32 v120, s24, v120
  v_mul_f32 v121, s24, v121
  v_cvt_pk_bf16_f32 v140, v120, v121
  v_mul_f32 v122, s24, v122
  v_mul_f32 v123, s24, v123
  v_cvt_pk_bf16_f32 v141, v122, v123
  v_mul_f32 v124, s24, v124
  v_mul_f32 v125, s24, v125
  v_cvt_pk_bf16_f32 v142, v124, v125
  v_mul_f32 v126, s24, v126
  v_mul_f32 v127, s24, v127
  v_cvt_pk_bf16_f32 v143, v126, v127
  buffer_store_dwordx4 v[140:143], v7, s[4:7], s21 offen offset:3072 sc1
G_fin_10:
  s_waitcnt vmcnt(0) lgkmcnt(0)
  s_barrier
  s_add_u32 s30, s29, 3
  v_mov_b32 v144, s30
  v_min_u32 v145, 1, v0
  v_lshlrev_b32 v145, 30, v145
  buffer_store_dword v144, v145, s[4:7], s31 offen sc1
P_end_2:
  s_mov_b32 s71, 0
  s_branch M_sg_12
M_sw_11:
  s_sleep 8
  s_add_u32 s71, s71, 1
  s_cmp_gt_u32 s71, 262144
  s_cbranch_scc1 M_exit
M_sg_12:
  s_mov_b32 s79, 0
  s_atomic_or s79, s[74:75], 128 glc
  s_waitcnt lgkmcnt(0)
  s_cmp_lt_u32 s79, 256
  s_cbranch_scc1 M_sw_11
  s_cmp_eq_u32 s65, 6
  s_cbranch_scc1 M_follow
  s_mov_b32 s68, 0
  s_mov_b32 s36, -1
  s_mov_b32 s69, s53
  s_mov_b32 s70, s54
M_att:
  s_mov_b32 s24, 0xf149f2ca
  s_mov_b32 s29, 0
  v_mov_b32 v6, 0
  v_mov_b32 v7, 0
  s_lshl_b32 s26, s16, 11
  v_add_u32 v3, s26, v2
  v_and_b32 v5, 31, v1
  v_lshrrev_b32 v12, 5, v1
  v_lshlrev_b32 v12, 2, v12
  v_sub_u32 v5, v5, v12
  s_lshl_b32 s26, s64, 19
  s_add_u32 s19, s26, 16777216
  s_add_u32 s20, s26, 33554432
  s_lshl_b32 s27, s69, 2
  s_add_u32 s27, s27, s16
  s_lshl_b32 s27, s27, 14
  s_add_u32 s25, s26, s27
  s_bfe_u32 s78, s70, 0x80000
  s_add_u32 s76, s67, 512
  s_mov_b32 s71, 0
  s_branch M_sg_14
M_sw_13:
  s_sleep 8
  s_add_u32 s71, s71, 1
  s_cmp_gt_u32 s71, 262144
  s_cbranch_scc1 M_exit
M_sg_14:
  s_mov_b32 s79, 0
  s_atomic_or s79, s[72:73], s76 glc
  s_waitcnt lgkmcnt(0)
  s_cmp_lt_u32 s79, s78
  s_cbranch_scc1 M_sw_13
  s_bfe_u32 s78, s70, 0x80008
  s_add_u32 s76, s67, 640
  s_mov_b32 s71, 0
  s_branch M_sg_16
M_sw_15:
  s_sleep 8
  s_add_u32 s71, s71, 1
  s_cmp_gt_u32 s71, 262144
  s_cbranch_scc1 M_exit
M_sg_16:
  s_mov_b32 s79, 0
  s_atomic_or s79, s[72:73], s76 glc
  s_waitcnt lgkmcnt(0)
  s_cmp_lt_u32 s79, s78
  s_cbranch_scc1 M_sw_15
  s_lshl_b32 s27, s69, 16
  s_add_u32 s27, s27, 16384
  s_add_u32 s17, s19, s27
M_kv_17:
  s_cmp_ge_u32 s17, s36
  s_cbranch_scc1 M_kvok_18
  s_mov_b32 s76, 0
  s_mov_b32 s78, 23
  s_mov_b32 s77, 335872
  s_cmp_eq_u32 s68, 1
  s_cmov_b32 s76, 128
  s_cmov_b32 s78, 27
  s_cmov_b32 s77, 114688
  s_cmp_eq_u32 s68, 2
  s_cmov_b32 s76, 768
  s_cmov_b32 s78, 14
  s_cmov_b32 s77, 0
  s_add_u32 s76, s76, s67
  s_mov_b32 s71, 0
  s_branch M_sg_20
M_sw_19:
  s_sleep 8
  s_add_u32 s71, s71, 1
  s_cmp_gt_u32 s71, 262144
  s_cbranch_scc1 M_exit
M_sg_20:
  s_mov_b32 s79, 0
  s_atomic_or s79, s[72:73], s76 glc
  s_waitcnt lgkmcnt(0)
  s_cmp_lt_u32 s79, s78
  s_cbranch_scc1 M_sw_19
  s_add_u32 s36, s77, s19
  s_add_u32 s68, s68, 1
  s_branch M_kv_17
M_kvok_18:
  s_add_u32 s28, s25, 0
  buffer_load_dwordx4 a[128:131], v2, s[4:7], s28 offen offset:0 sc1
  buffer_load_dwordx4 a[132:135], v2, s[4:7], s28 offen offset:1024 sc1
  buffer_load_dwordx4 a[136:139], v2, s[4:7], s28 offen offset:2048 sc1
  buffer_load_dwordx4 a[140:143], v2, s[4:7], s28 offen offset:3072 sc1
  s_add_u32 s28, s25, 4096
  buffer_load_dwordx4 a[144:147], v2, s[4:7], s28 offen offset:0 sc1
  buffer_load_dwordx4 a[148:151], v2, s[4:7], s28 offen offset:1024 sc1
  buffer_load_dwordx4 a[152:155], v2, s[4:7], s28 offen offset:2048 sc1
  buffer_load_dwordx4 a[156:159], v2, s[4:7], s28 offen offset:3072 sc1
  s_add_u32 s28, s25, 8192
  buffer_load_dwordx4 a[160:163], v2, s[4:7], s28 offen offset:0 sc1
  buffer_load_dwordx4 a[164:167], v2, s[4:7], s28 offen offset:1024 sc1
  buffer_load_dwordx4 a[168:171], v2, s[4:7], s28 offen offset:2048 sc1
  buffer_load_dwordx4 a[172:175], v2, s[4:7], s28 offen offset:3072 sc1
  s_add_u32 s28, s25, 12288
  buffer_load_dwordx4 a[176:179], v2, s[4:7], s28 offen offset:0 sc1
  buffer_load_dwordx4 a[180:183], v2, s[4:7], s28 offen offset:1024 sc1
  buffer_load_dwordx4 a[184:187], v2, s[4:7], s28 offen offset:2048 sc1
  buffer_load_dwordx4 a[188:191], v2, s[4:7], s28 offen offset:3072 sc1
A_again_21:
  s_lshl_b32 s27, s69, 16
  s_add_u32 s27, s27, 57344
  s_add_u32 s17, s19, s27
  s_add_u32 s18, s20, s27
  s_lshl_b32 s21, s16, 11
  s_mov_b32 m0, s21
  s_nop 0
  buffer_load_dwordx4 v3, s[4:7], s18 offen offset:0 sc1 lds
  buffer_load_dwordx4 v3, s[4:7], s18 offen offset:1024 sc1 lds
  s_add_u32 m0, s21, 8192
  s_nop 0
  buffer_load_dwordx4 v3, s[4:7], s17 offen offset:0 sc1 lds
  buffer_load_dwordx4 v3, s[4:7], s17 offen offset:1024 sc1 lds
  s_add_u32 s18, s18, 8192
  s_sub_u32 s18, s18, 8192
  s_max_i32 s18, s18, s20
  s_sub_u32 s17, s17, 8192
  s_max_i32 s17, s17, s19
  s_add_u32 s21, s21, 16384
  s_and_b32 s21, s21, 131071
  s_mov_b32 m0, s21
  s_nop 0
  buffer_load_dwordx4 v3, s[4:7], s18 offen offset:0 sc1 lds
  buffer_load_dwordx4 v3, s[4:7], s18 offen offset:1024 sc1 lds
  s_add_u32 m0, s21, 8192
  s_nop 0
  buffer_load_dwordx4 v3, s[4:7], s17 offen offset:0 sc1 lds
  buffer_load_dwordx4 v3, s[4:7], s17 offen offset:1024 sc1 lds
  s_sub_u32 s18, s18, 8192
  s_max_i32 s18, s18, s20
  s_sub_u32 s17, s17, 8192
  s_max_i32 s17, s17, s19
  s_add_u32 s21, s21, 16384
  s_and_b32 s21, s21, 131071
  s_mov_b32 m0, s21
  s_nop 0
  buffer_load_dwordx4 v3, s[4:7], s18 offen offset:0 sc1 lds
  buffer_load_dwordx4 v3, s[4:7], s18 offen offset:1024 sc1 lds
  s_add_u32 m0, s21, 8192
  s_nop 0
  buffer_load_dwordx4 v3, s[4:7], s17 offen offset:0 sc1 lds
  buffer_load_dwordx4 v3, s[4:7], s17 offen offset:1024 sc1 lds
  s_sub_u32 s18, s18, 8192
  s_max_i32 s18, s18, s20
  s_sub_u32 s17, s17, 8192
  s_max_i32 s17, s17, s19
  s_add_u32 s21, s21, 16384
  s_and_b32 s21, s21, 131071
  s_mov_b32 m0, s21
  s_nop 0
  buffer_load_dwordx4 v3, s[4:7], s18 offen offset:0 sc1 lds
  buffer_load_dwordx4 v3, s[4:7], s18 offen offset:1024 sc1 lds
  s_add_u32 m0, s21, 8192
  s_nop 0
  buffer_load_dwordx4 v3, s[4:7], s17 offen offset:0 sc1 lds
  buffer_load_dwordx4 v3, s[4:7], s17 offen offset:1024 sc1 lds
  s_sub_u32 s18, s18, 8192
  s_max_i32 s18, s18, s20
  s_sub_u32 s17, s17, 8192
  s_max_i32 s17, s17, s19
  s_add_u32 s21, s21, 16384
  s_and_b32 s21, s21, 131071
  s_mov_b32 m0, s21
  s_nop 0
  buffer_load_dwordx4 v3, s[4:7], s18 offen offset:0 sc1 lds
  buffer_load_dwordx4 v3, s[4:7], s18 offen offset:1024 sc1 lds
  s_add_u32 m0, s21, 8192
  s_nop 0
  buffer_load_dwordx4 v3, s[4:7], s17 offen offset:0 sc1 lds
  buffer_load_dwordx4 v3, s[4:7], s17 offen offset:1024 sc1 lds
  s_sub_u32 s18, s18, 8192
  s_max_i32 s18, s18, s20
  s_sub_u32 s17, s17, 8192
  s_max_i32 s17, s17, s19
  s_add_u32 s21, s21, 16384
  s_and_b32 s21, s21, 131071
  s_mov_b32 m0, s21
  s_nop 0
  buffer_load_dwordx4 v3, s[4:7], s18 offen offset:0 sc1 lds
  buffer_load_dwordx4 v3, s[4:7], s18 offen offset:1024 sc1 lds
  s_add_u32 m0, s21, 8192
  s_nop 0
  buffer_load_dwordx4 v3, s[4:7], s17 offen offset:0 sc1 lds
  buffer_load_dwordx4 v3, s[4:7], s17 offen offset:1024 sc1 lds
  v_accvgpr_write_b32 a0, 0
  v_accvgpr_write_b32 a1, 0
  v_accvgpr_write_b32 a2, 0
  v_accvgpr_write_b32 a3, 0
  v_accvgpr_write_b32 a4, 0
  v_accvgpr_write_b32 a5, 0
  v_accvgpr_write_b32 a6, 0
  v_accvgpr_write_b32 a7, 0
  v_accvgpr_write_b32 a8, 0
  v_accvgpr_write_b32 a9, 0
  v_accvgpr_write_b32 a10, 0
  v_accvgpr_write_b32 a11, 0
  v_accvgpr_write_b32 a12, 0
  v_accvgpr_write_b32 a13, 0
  v_accvgpr_write_b32 a14, 0
  v_accvgpr_write_b32 a15, 0
  v_accvgpr_write_b32 a16, 0
  v_accvgpr_write_b32 a17, 0
  v_accvgpr_write_b32 a18, 0
  v_accvgpr_write_b32 a19, 0
  v_accvgpr_write_b32 a20, 0
  v_accvgpr_write_b32 a21, 0
  v_accvgpr_write_b32 a22, 0
  v_accvgpr_write_b32 a23, 0
  v_accvgpr_write_b32 a24, 0
  v_accvgpr_write_b32 a25, 0
  v_accvgpr_write_b32 a26, 0
  v_accvgpr_write_b32 a27, 0
  v_accvgpr_write_b32 a28, 0
  v_accvgpr_write_b32 a29, 0
  v_accvgpr_write_b32 a30, 0
  v_accvgpr_write_b32 a31, 0
  v_accvgpr_write_b32 a32, 0
  v_accvgpr_write_b32 a33, 0
  v_accvgpr_write_b32 a34, 0
  v_accvgpr_write_b32 a35, 0
  v_accvgpr_write_b32 a36, 0
  v_accvgpr_write_b32 a37, 0
  v_accvgpr_write_b32 a38, 0
  v_accvgpr_write_b32 a39, 0
  v_accvgpr_write_b32 a40, 0
  v_accvgpr_write_b32 a41, 0
  v_accvgpr_write_b32 a42, 0
  v_accvgpr_write_b32 a43, 0
  v_accvgpr_write_b32 a44, 0
  v_accvgpr_write_b32 a45, 0
  v_accvgpr_write_b32 a46, 0
  v_accvgpr_write_b32 a47, 0
  v_accvgpr_write_b32 a48, 0
  v_accvgpr_write_b32 a49, 0
  v_accvgpr_write_b32 a50, 0
  v_accvgpr_write_b32 a51, 0
  v_accvgpr_write_b32 a52, 0
  v_accvgpr_write_b32 a53, 0
  v_accvgpr_write_b32 a54, 0
  v_accvgpr_write_b32 a55, 0
  v_accvgpr_write_b32 a56, 0
  v_accvgpr_write_b32 a57, 0
  v_accvgpr_write_b32 a58, 0
  v_accvgpr_write_b32 a59, 0
  v_accvgpr_write_b32 a60, 0
  v_accvgpr_write_b32 a61, 0
  v_accvgpr_write_b32 a62, 0
  v_accvgpr_write_b32 a63, 0
  v_accvgpr_write_b32 a64, 0
  v_accvgpr_write_b32 a65, 0
  v_accvgpr_write_b32 a66, 0
  v_accvgpr_write_b32 a67, 0
  v_accvgpr_write_b32 a68, 0
  v_accvgpr_write_b32 a69, 0
  v_accvgpr_write_b32 a70, 0
  v_accvgpr_write_b32 a71, 0
  v_accvgpr_write_b32 a72, 0
  v_accvgpr_write_b32 a73, 0
  v_accvgpr_write_b32 a74, 0
  v_accvgpr_write_b32 a75, 0
  v_accvgpr_write_b32 a76, 0
  v_accvgpr_write_b32 a77, 0
  v_accvgpr_write_b32 a78, 0
  v_accvgpr_write_b32 a79, 0
  v_accvgpr_write_b32 a80, 0
  v_accvgpr_write_b32 a81, 0
  v_accvgpr_write_b32 a82, 0
  v_accvgpr_write_b32 a83, 0
  v_accvgpr_write_b32 a84, 0
  v_accvgpr_write_b32 a85, 0
  v_accvgpr_write_b32 a86, 0
  v_accvgpr_write_b32 a87, 0
  v_accvgpr_write_b32 a88, 0
  v_accvgpr_write_b32 a89, 0
  v_accvgpr_write_b32 a90, 0
  v_accvgpr_write_b32 a91, 0
  v_accvgpr_write_b32 a92, 0
  v_accvgpr_write_b32 a93, 0
  v_accvgpr_write_b32 a94, 0
  v_accvgpr_write_b32 a95, 0
  v_accvgpr_write_b32 a96, 0
  v_accvgpr_write_b32 a97, 0
  v_accvgpr_write_b32 a98, 0
  v_accvgpr_write_b32 a99, 0
  v_accvgpr_write_b32 a100, 0
  v_accvgpr_write_b32 a101, 0
  v_accvgpr_write_b32 a102, 0
  v_accvgpr_write_b32 a103, 0
  v_accvgpr_write_b32 a104, 0
  v_accvgpr_write_b32 a105, 0
  v_accvgpr_write_b32 a106, 0
  v_accvgpr_write_b32 a107, 0
  v_accvgpr_write_b32 a108, 0
  v_accvgpr_write_b32 a109, 0
  v_accvgpr_write_b32 a110, 0
  v_accvgpr_write_b32 a111, 0
  v_accvgpr_write_b32 a112, 0
  v_accvgpr_write_b32 a113, 0
  v_accvgpr_write_b32 a114, 0
  v_accvgpr_write_b32 a115, 0
  v_accvgpr_write_b32 a116, 0
  v_accvgpr_write_b32 a117, 0
  v_accvgpr_write_b32 a118, 0
  v_accvgpr_write_b32 a119, 0
  v_accvgpr_write_b32 a120, 0
  v_accvgpr_write_b32 a121, 0
  v_accvgpr_write_b32 a122, 0
  v_accvgpr_write_b32 a123, 0
  v_accvgpr_write_b32 a124, 0
  v_accvgpr_write_b32 a125, 0
  v_accvgpr_write_b32 a126, 0
  v_accvgpr_write_b32 a127, 0
  v_mov_b32 v8, 0
  v_mov_b32 v9, 0
  v_mov_b32 v10, 0
  v_mov_b32 v11, 0
  v_mov_b32 v52, 0
  v_mov_b32 v53, 0
  v_mov_b32 v54, s24
  v_mov_b32 v55, s24
  v_mov_b32 v56, s24
  v_mov_b32 v57, s24
  v_mov_b32 v58, s24
  v_mov_b32 v59, s24
  v_mov_b32 v60, s24
  v_mov_b32 v61, s24
  v_mov_b32 v62, s24
  v_mov_b32 v63, s24
  v_mov_b32 v104, 0
  v_mov_b32 v105, 0
  v_mov_b32 v4, v2
  v_mov_b32 v64, s24
  v_mov_b32 v65, s24
  v_mov_b32 v66, s24
  v_mov_b32 v67, s24
  v_mov_b32 v68, s24
  v_mov_b32 v69, s24
  v_mov_b32 v70, s24
  v_mov_b32 v71, s24
  v_mov_b32 v72, s24
  v_mov_b32 v73, s24
  v_mov_b32 v74, s24
  v_mov_b32 v75, s24
  v_mov_b32 v76, s24
  v_mov_b32 v77, s24
  v_mov_b32 v78, s24
  v_mov_b32 v79, s24
  v_mov_b32 v12, s24
  v_cmp_le_i32 s[40:41], 0, v5
  v_cmp_le_i32 s[42:43], 1, v5
  v_cmp_le_i32 s[44:45], 2, v5
  v_cmp_le_i32 s[46:47], 3, v5
  v_cndmask_b32 v80, v12, v7, s[40:41]
  v_cndmask_b32 v81, v12, v7, s[42:43]
  v_cndmask_b32 v82, v12, v7, s[44:45]
  v_cndmask_b32 v83, v12, v7, s[46:47]
  v_cmp_le_i32 s[40:41], 8, v5
  v_cmp_le_i32 s[42:43], 9, v5
  v_cmp_le_i32 s[44:45], 10, v5
  v_cmp_le_i32 s[46:47], 11, v5
  v_cndmask_b32 v84, v12, v7, s[40:41]
  v_cndmask_b32 v85, v12, v7, s[42:43]
  v_cndmask_b32 v86, v12, v7, s[44:45]
  v_cndmask_b32 v87, v12, v7, s[46:47]
  v_cmp_le_i32 s[40:41], 16, v5
  v_cmp_le_i32 s[42:43], 17, v5
  v_cmp_le_i32 s[44:45], 18, v5
  v_cmp_le_i32 s[46:47], 19, v5
  v_cndmask_b32 v88, v12, v7, s[40:41]
  v_cndmask_b32 v89, v12, v7, s[42:43]
  v_cndmask_b32 v90, v12, v7, s[44:45]
  v_cndmask_b32 v91, v12, v7, s[46:47]
  v_cmp_le_i32 s[40:41], 24, v5
  v_cmp_le_i32 s[42:43], 25, v5
  v_cmp_le_i32 s[44:45], 26, v5
  v_cmp_le_i32 s[46:47], 27, v5
  v_cndmask_b32 v92, v12, v7, s[40:41]
  v_cndmask_b32 v93, v12, v7, s[42:43]
  v_cndmask_b32 v94, v12, v7, s[44:45]
  v_cndmask_b32 v95, v12, v7, s[46:47]
  s_lshl_b32 s22, s69, 3
  s_add_u32 s22, s22, 8
  s_lshl_b32 s26, s16, 1
  s_sub_u32 s23, 6, s26
  s_waitcnt vmcnt(20)
  s_barrier
  s_cmp_eq_u32 s23, 0
  s_cbranch_scc1 A_go_23
A_idle_22:
  s_waitcnt vmcnt(16)
  s_barrier
  s_sub_u32 s18, s18, 8192
  s_max_i32 s18, s18, s20
  s_sub_u32 s17, s17, 8192
  s_max_i32 s17, s17, s19
  s_add_u32 s21, s21, 16384
  s_and_b32 s21, s21, 131071
M_kv_24:
  s_cmp_ge_u32 s17, s36
  s_cbranch_scc1 M_kvok_25
  s_mov_b32 s76, 0
  s_mov_b32 s78, 23
  s_mov_b32 s77, 335872
  s_cmp_eq_u32 s68, 1
  s_cmov_b32 s76, 128
  s_cmov_b32 s78, 27
  s_cmov_b32 s77, 114688
  s_cmp_eq_u32 s68, 2
  s_cmov_b32 s76, 768
  s_cmov_b32 s78, 14
  s_cmov_b32 s77, 0
  s_add_u32 s76, s76, s67
  s_mov_b32 s71, 0
  s_branch M_sg_27
M_sw_26:
  s_sleep 8
  s_add_u32 s71, s71, 1
  s_cmp_gt_u32 s71, 262144
  s_cbranch_scc1 M_exit
M_sg_27:
  s_mov_b32 s79, 0
  s_atomic_or s79, s[72:73], s76 glc
  s_waitcnt lgkmcnt(0)
  s_cmp_lt_u32 s79, s78
  s_cbranch_scc1 M_sw_26
  s_add_u32 s36, s77, s19
  s_add_u32 s68, s68, 1
  s_branch M_kv_24
M_kvok_25:
  s_mov_b32 m0, s21
  s_nop 0
  buffer_load_dwordx4 v3, s[4:7], s18 offen offset:0 sc1 lds
  buffer_load_dwordx4 v3, s[4:7], s18 offen offset:1024 sc1 lds
  s_add_u32 m0, s21, 8192
  s_nop 0
  buffer_load_dwordx4 v3, s[4:7], s17 offen offset:0 sc1 lds
  buffer_load_dwordx4 v3, s[4:7], s17 offen offset:1024 sc1 lds
  v_add_u32 v4, 16384, v4
  v_and_b32 v4, 131071, v4
  s_sub_u32 s22, s22, 1
  s_sub_u32 s23, s23, 1
  s_cmp_lg_u32 s23, 0
  s_cbranch_scc1 A_idle_22
A_go_23:
  ds_read_b128 a[224:227], v4 offset:0
  ds_read_b128 a[228:231], v4 offset:2048
  ds_read_b128 a[232:235], v4 offset:4096
  ds_read_b128 a[236:239], v4 offset:6144
  ds_read_b128 a[240:243], v4 offset:1024
  ds_read_b128 a[244:247], v4 offset:3072
  ds_read_b128 a[248:251], v4 offset:5120
  ds_read_b128 a[252:255], v4 offset:7168
  ds_read_b128 a[192:195], v4 offset:8192
  ds_read_b128 a[196:199], v4 offset:9216
  ds_read_b128 a[200:203], v4 offset:10240
  ds_read_b128 a[204:207], v4 offset:11264
  ds_read_b128 a[208:211], v4 offset:12288
  ds_read_b128 a[212:215], v4 offset:13312
  ds_read_b128 a[216:219], v4 offset:14336
  ds_read_b128 a[220:223], v4 offset:15360
  v_add_u32 v4, 16384, v4
  v_and_b32 v4, 131071, v4
  s_waitcnt lgkmcnt(8)
.p2align 6
A_top_28:
  s_waitcnt lgkmcnt(7)
  v_mfma_f32_32x32x16_bf16 v[32:47], a[192:195], a[128:131], v[64:79]
  s_waitcnt lgkmcnt(6)
  v_exp_f32 v54, v54
  v_add_f32 v11, v11, v53
  v_cvt_pk_bf16_f32 v106, v52, v53
  v_mfma_f32_32x32x16_bf16 v[32:47], a[196:199], a[132:135], v[32:47]
  s_waitcnt lgkmcnt(4)
  v_exp_f32 v55, v55
  v_add_f32 v10, v10, v54
  v_mfma_f32_32x32x16_bf16 v[32:47], a[200:203], a[136:139], v[32:47]
  v_exp_f32 v56, v56
  v_add_f32 v11, v11, v55
  v_cvt_pk_bf16_f32 v107, v54, v55
  v_mfma_f32_32x32x16_bf16 v[32:47], a[204:207], a[140:143], v[32:47]
  s_waitcnt lgkmcnt(2)
  v_exp_f32 v57, v57
  v_add_f32 v10, v10, v56
  v_mfma_f32_32x32x16_bf16 v[32:47], a[208:211], a[144:147], v[32:47]
  v_exp_f32 v58, v58
  v_add_f32 v11, v11, v57
  v_cvt_pk_bf16_f32 v108, v56, v57
  v_mfma_f32_32x32x16_bf16 v[32:47], a[212:215], a[148:151], v[32:47]
  s_waitcnt lgkmcnt(0)
  v_exp_f32 v59, v59
  v_add_f32 v10, v10, v58
  v_mfma_f32_32x32x16_bf16 v[32:47], a[216:219], a[152:155], v[32:47]
  v_exp_f32 v60, v60
  v_add_f32 v11, v11, v59
  v_cvt_pk_bf16_f32 v109, v58, v59
  v_mfma_f32_32x32x16_bf16 v[32:47], a[220:223], a[156:159], v[32:47]
  s_waitcnt vmcnt(16)
  s_barrier
  v_exp_f32 v61, v61
  v_add_f32 v10, v10, v60
  v_mfma_f32_32x32x16_bf16 a[64:79], a[224:227], v[104:107], a[64:79]
  ds_read_b128 a[224:227], v4 offset:0
  v_exp_f32 v62, v62
  v_add_f32 v11, v11, v61
  v_cvt_pk_bf16_f32 v110, v60, v61
  v_mfma_f32_32x32x16_bf16 a[80:95], a[228:231], v[104:107], a[80:95]
  s_sub_u32 s18, s18, 8192
  ds_read_b128 a[228:231], v4 offset:2048
  v_exp_f32 v63, v63
  v_add_f32 v10, v10, v62
  v_mfma_f32_32x32x16_bf16 a[96:111], a[232:235], v[104:107], a[96:111]
  s_max_i32 s18, s18, s20
  ds_read_b128 a[232:235], v4 offset:4096
  v_exp_f32 v32, v32
  v_add_f32 v11, v11, v63
  v_cvt_pk_bf16_f32 v111, v62, v63
  v_mfma_f32_32x32x16_bf16 a[112:127], a[236:239], v[104:107], a[112:127]
  s_sub_u32 s17, s17, 8192
  ds_read_b128 a[236:239], v4 offset:6144
  v_exp_f32 v33, v33
  v_add_f32 v8, v8, v32
  v_mfma_f32_32x32x16_bf16 a[64:79], a[240:243], v[108:111], a[64:79]
  s_max_i32 s17, s17, s19
  ds_read_b128 a[240:243], v4 offset:1024
  v_exp_f32 v34, v34
  v_add_f32 v9, v9, v33
  v_cvt_pk_bf16_f32 v96, v32, v33
  v_mfma_f32_32x32x16_bf16 a[80:95], a[244:247], v[108:111], a[80:95]
  s_add_u32 s21, s21, 16384
  ds_read_b128 a[244:247], v4 offset:3072
  v_exp_f32 v35, v35
  v_add_f32 v8, v8, v34
  v_mfma_f32_32x32x16_bf16 a[96:111], a[248:251], v[108:111], a[96:111]
  s_and_b32 s21, s21, 131071
  ds_read_b128 a[248:251], v4 offset:5120
  v_exp_f32 v36, v36
  v_add_f32 v9, v9, v35
  v_cvt_pk_bf16_f32 v97, v34, v35
  v_mfma_f32_32x32x16_bf16 a[112:127], a[252:255], v[108:111], a[112:127]
  ds_read_b128 a[252:255], v4 offset:7168
  v_exp_f32 v37, v37
  v_add_f32 v8, v8, v36
  v_mfma_f32_32x32x16_bf16 v[48:63], a[192:195], a[160:163], v[80:95]
  s_add_u32 s23, s23, 1
  ds_read_b128 a[192:195], v4 offset:8192
  v_exp_f32 v38, v38
  v_add_f32 v9, v9, v37
  v_cvt_pk_bf16_f32 v98, v36, v37
  v_mfma_f32_32x32x16_bf16 v[48:63], a[196:199], a[164:167], v[48:63]
  s_sub_u32 s22, s22, 1
  ds_read_b128 a[196:199], v4 offset:9216
  v_exp_f32 v39, v39
  v_add_f32 v8, v8, v38
  v_mfma_f32_32x32x16_bf16 v[48:63], a[200:203], a[168:171], v[48:63]
  s_cmp_lt_u32 s23, 3
  ds_read_b128 a[200:203], v4 offset:10240
  v_exp_f32 v40, v40
  v_add_f32 v9, v9, v39
  v_cvt_pk_bf16_f32 v99, v38, v39
  v_mfma_f32_32x32x16_bf16 v[48:63], a[204:207], a[172:175], v[48:63]
  s_cbranch_scc1 A_upd_29
A_back_30:
  ds_read_b128 a[204:207], v4 offset:11264
  v_exp_f32 v41, v41
  v_add_f32 v8, v8, v40
  v_mfma_f32_32x32x16_bf16 v[48:63], a[208:211], a[176:179], v[48:63]
  s_cmp_lt_u32 s17, s36
  ds_read_b128 a[208:211], v4 offset:12288
  v_exp_f32 v42, v42
  v_add_f32 v9, v9, v41
  v_cvt_pk_bf16_f32 v100, v40, v41
  v_mfma_f32_32x32x16_bf16 v[48:63], a[212:215], a[180:183], v[48:63]
  s_cbranch_scc1 A_kvw_32
A_kvb_33:
  ds_read_b128 a[212:215], v4 offset:13312
  v_exp_f32 v43, v43
  v_add_f32 v8, v8, v42
  v_mfma_f32_32x32x16_bf16 v[48:63], a[216:219], a[184:187], v[48:63]
  s_mov_b32 m0, s21
  ds_read_b128 a[216:219], v4 offset:14336
  v_exp_f32 v44, v44
  v_add_f32 v9, v9, v43
  v_cvt_pk_bf16_f32 v101, v42, v43
  v_mfma_f32_32x32x16_bf16 v[48:63], a[220:223], a[188:191], v[48:63]
  s_waitcnt lgkmcnt(13)
  ds_read_b128 a[220:223], v4 offset:15360
  v_exp_f32 v45, v45
  v_add_f32 v8, v8, v44
  v_mfma_f32_32x32x16_bf16 a[0:15], a[224:227], v[96:99], a[0:15]
  buffer_load_dwordx4 v3, s[4:7], s18 offen offset:0 sc1 lds
  v_exp_f32 v46, v46
  v_add_f32 v9, v9, v45
  v_cvt_pk_bf16_f32 v102, v44, v45
  v_mfma_f32_32x32x16_bf16 a[16:31], a[228:231], v[96:99], a[16:31]
  s_waitcnt lgkmcnt(12)
  v_exp_f32 v47, v47
  v_add_f32 v8, v8, v46
  v_add_u32 v4, 16384, v4
  v_mfma_f32_32x32x16_bf16 a[32:47], a[232:235], v[96:99], a[32:47]
  buffer_load_dwordx4 v3, s[4:7], s18 offen offset:1024 sc1 lds
  v_exp_f32 v48, v48
  v_add_f32 v9, v9, v47
  v_cvt_pk_bf16_f32 v103, v46, v47
  v_mfma_f32_32x32x16_bf16 a[48:63], a[236:239], v[96:99], a[48:63]
  s_waitcnt lgkmcnt(10)
  s_add_u32 m0, s21, 8192
  v_exp_f32 v49, v49
  v_add_f32 v10, v10, v48
  v_and_b32 v4, 131071, v4
  v_mfma_f32_32x32x16_bf16 a[0:15], a[240:243], v[100:103], a[0:15]
  buffer_load_dwordx4 v3, s[4:7], s17 offen offset:0 sc1 lds
  v_exp_f32 v50, v50
  v_add_f32 v11, v11, v49
  v_cvt_pk_bf16_f32 v104, v48, v49
  v_mfma_f32_32x32x16_bf16 a[16:31], a[244:247], v[100:103], a[16:31]
  s_waitcnt lgkmcnt(8)
  s_cmp_lg_u32 s22, 0
  v_exp_f32 v51, v51
  v_add_f32 v10, v10, v50
  v_mfma_f32_32x32x16_bf16 a[32:47], a[248:251], v[100:103], a[32:47]
  buffer_load_dwordx4 v3, s[4:7], s17 offen offset:1024 sc1 lds
  v_exp_f32 v52, v52
  v_add_f32 v11, v11, v51
  v_cvt_pk_bf16_f32 v105, v50, v51
  v_mfma_f32_32x32x16_bf16 a[48:63], a[252:255], v[100:103], a[48:63]
  v_exp_f32 v53, v53
  v_add_f32 v10, v10, v52
  s_cbranch_scc1 A_top_28
  v_exp_f32 v54, v54
  v_add_f32 v11, v11, v53
  v_cvt_pk_bf16_f32 v106, v52, v53
  v_exp_f32 v55, v55
  v_add_f32 v10, v10, v54
  v_exp_f32 v56, v56
  v_add_f32 v11, v11, v55
  v_cvt_pk_bf16_f32 v107, v54, v55
  v_exp_f32 v57, v57
  v_add_f32 v10, v10, v56
  v_exp_f32 v58, v58
  v_add_f32 v11, v11, v57
  v_cvt_pk_bf16_f32 v108, v56, v57
  v_exp_f32 v59, v59
  v_add_f32 v10, v10, v58
  v_exp_f32 v60, v60
  v_add_f32 v11, v11, v59
  v_cvt_pk_bf16_f32 v109, v58, v59
  v_exp_f32 v61, v61
  v_add_f32 v10, v10, v60
  v_exp_f32 v62, v62
  v_add_f32 v11, v11, v61
  v_cvt_pk_bf16_f32 v110, v60, v61
  v_exp_f32 v63, v63
  v_add_f32 v10, v10, v62
  v_add_f32 v11, v11, v63
  v_cvt_pk_bf16_f32 v111, v62, v63
  s_nop 1
  v_mfma_f32_32x32x16_bf16 a[64:79], a[224:227], v[104:107], a[64:79]
  v_mfma_f32_32x32x16_bf16 a[80:95], a[228:231], v[104:107], a[80:95]
  v_mfma_f32_32x32x16_bf16 a[96:111], a[232:235], v[104:107], a[96:111]
  v_mfma_f32_32x32x16_bf16 a[112:127], a[236:239], v[104:107], a[112:127]
  v_mfma_f32_32x32x16_bf16 a[64:79], a[240:243], v[108:111], a[64:79]
  v_mfma_f32_32x32x16_bf16 a[80:95], a[244:247], v[108:111], a[80:95]
  v_mfma_f32_32x32x16_bf16 a[96:111], a[248:251], v[108:111], a[96:111]
  v_mfma_f32_32x32x16_bf16 a[112:127], a[252:255], v[108:111], a[112:127]
  v_add_f32 v8, v8, v9
  v_mov_b32 v9, v8
  s_nop 1
  v_permlane32_swap_b32 v8, v9
  s_nop 1
  v_add_f32 v8, v8, v9
  v_add_f32 v10, v10, v11
  v_mov_b32 v11, v10
  s_nop 1
  v_permlane32_swap_b32 v10, v11
  s_nop 1
  v_add_f32 v10, v10, v11
  v_subrev_u32 v12, 0x2f800000, v8
  v_subrev_u32 v13, 0x2f800000, v10
  v_max_u32 v12, v12, v13
  v_cmp_le_u32 vcc, 0x28000000, v12
  s_nop 1
  s_cmp_lg_u64 vcc, 0
  s_cselect_b32 s26, 1, 0
  v_mov_b32 v12, s26
  s_lshl_b32 s26, s16, 2
  s_add_u32 s26, s26, 131072
  v_mov_b32 v13, s26
  ds_write_b32 v13, v12
  v_mov_b32 v14, 131072
  s_waitcnt vmcnt(0) lgkmcnt(0)
  s_barrier
  ds_read_b128 v[16:19], v14
  v_rcp_f32 v8, v8
  v_rcp_f32 v10, v10
  s_waitcnt lgkmcnt(0)
  v_or3_b32 v12, v16, v17, v18
  v_or_b32 v12, v12, v19
  s_nop 0
  v_readfirstlane_b32 s26, v12
  s_nop 1
  s_cmp_gt_u32 s26, s29
  s_cbranch_scc1 A_slow_34
  s_add_u32 s28, s25, 100663296
  v_accvgpr_read_b32 v112, a0
  v_accvgpr_read_b32 v113, a1
  v_accvgpr_read_b32 v114, a2
  v_accvgpr_read_b32 v115, a3
  v_accvgpr_read_b32 v116, a4
  v_accvgpr_read_b32 v117, a5
  v_accvgpr_read_b32 v118, a6
  v_accvgpr_read_b32 v119, a7
  v_pk_mul_f32 v[112:113], v[112:113], v[8:9] op_sel_hi:[1,0]
  v_pk_mul_f32 v[114:115], v[114:115], v[8:9] op_sel_hi:[1,0]
  v_pk_mul_f32 v[116:117], v[116:117], v[8:9] op_sel_hi:[1,0]
  v_pk_mul_f32 v[118:119], v[118:119], v[8:9] op_sel_hi:[1,0]
  v_cvt_pk_bf16_f32 v120, v112, v113
  v_cvt_pk_bf16_f32 v121, v114, v115
  v_cvt_pk_bf16_f32 v122, v116, v117
  v_cvt_pk_bf16_f32 v123, v118, v119
  buffer_store_dwordx4 v[120:123], v2, s[4:7], s28 offen offset:0 sc1
  v_accvgpr_read_b32 v124, a8
  v_accvgpr_read_b32 v125, a9
  v_accvgpr_read_b32 v126, a10
  v_accvgpr_read_b32 v127, a11
  v_accvgpr_read_b32 v128, a12
  v_accvgpr_read_b32 v129, a13
  v_accvgpr_read_b32 v130, a14
  v_accvgpr_read_b32 v131, a15
  v_pk_mul_f32 v[124:125], v[124:125], v[8:9] op_sel_hi:[1,0]
  v_pk_mul_f32 v[126:127], v[126:127], v[8:9] op_sel_hi:[1,0]
  v_pk_mul_f32 v[128:129], v[128:129], v[8:9] op_sel_hi:[1,0]
  v_pk_mul_f32 v[130:131], v[130:131], v[8:9] op_sel_hi:[1,0]
  v_cvt_pk_bf16_f32 v132, v124, v125
  v_cvt_pk_bf16_f32 v133, v126, v127
  v_cvt_pk_bf16_f32 v134, v128, v129
  v_cvt_pk_bf16_f32 v135, v130, v131
  buffer_store_dwordx4 v[132:135], v2, s[4:7], s28 offen offset:1024 sc1
  v_accvgpr_read_b32 v136, a16
  v_accvgpr_read_b32 v137, a17
  v_accvgpr_read_b32 v138, a18
  v_accvgpr_read_b32 v139, a19
  v_accvgpr_read_b32 v140, a20
  v_accvgpr_read_b32 v141, a21
  v_accvgpr_read_b32 v142, a22
  v_accvgpr_read_b32 v143, a23
  v_pk_mul_f32 v[136:137], v[136:137], v[8:9] op_sel_hi:[1,0]
  v_pk_mul_f32 v[138:139], v[138:139], v[8:9] op_sel_hi:[1,0]
  v_pk_mul_f32 v[140:141], v[140:141], v[8:9] op_sel_hi:[1,0]
  v_pk_mul_f32 v[142:143], v[142:143], v[8:9] op_sel_hi:[1,0]
  v_cvt_pk_bf16_f32 v144, v136, v137
  v_cvt_pk_bf16_f32 v145, v138, v139
  v_cvt_pk_bf16_f32 v146, v140, v141
  v_cvt_pk_bf16_f32 v147, v142, v143
  buffer_store_dwordx4 v[144:147], v2, s[4:7], s28 offen offset:2048 sc1
  v_accvgpr_read_b32 v148, a24
  v_accvgpr_read_b32 v149, a25
  v_accvgpr_read_b32 v150, a26
  v_accvgpr_read_b32 v151, a27
  v_accvgpr_read_b32 v152, a28
  v_accvgpr_read_b32 v153, a29
  v_accvgpr_read_b32 v154, a30
  v_accvgpr_read_b32 v155, a31
  v_pk_mul_f32 v[148:149], v[148:149], v[8:9] op_sel_hi:[1,0]
  v_pk_mul_f32 v[150:151], v[150:151], v[8:9] op_sel_hi:[1,0]
  v_pk_mul_f32 v[152:153], v[152:153], v[8:9] op_sel_hi:[1,0]
  v_pk_mul_f32 v[154:155], v[154:155], v[8:9] op_sel_hi:[1,0]
  v_cvt_pk_bf16_f32 v156, v148, v149
  v_cvt_pk_bf16_f32 v157, v150, v151
  v_cvt_pk_bf16_f32 v158, v152, v153
  v_cvt_pk_bf16_f32 v159, v154, v155
  buffer_store_dwordx4 v[156:159], v2, s[4:7], s28 offen offset:3072 sc1
  s_add_u32 s28, s25, 100667392
  v_accvgpr_read_b32 v112, a32
  v_accvgpr_read_b32 v113, a33
  v_accvgpr_read_b32 v114, a34
  v_accvgpr_read_b32 v115, a35
  v_accvgpr_read_b32 v116, a36
  v_accvgpr_read_b32 v117, a37
  v_accvgpr_read_b32 v118, a38
  v_accvgpr_read_b32 v119, a39
  v_pk_mul_f32 v[112:113], v[112:113], v[8:9] op_sel_hi:[1,0]
  v_pk_mul_f32 v[114:115], v[114:115], v[8:9] op_sel_hi:[1,0]
  v_pk_mul_f32 v[116:117], v[116:117], v[8:9] op_sel_hi:[1,0]
  v_pk_mul_f32 v[118:119], v[118:119], v[8:9] op_sel_hi:[1,0]
  v_cvt_pk_bf16_f32 v120, v112, v113
  v_cvt_pk_bf16_f32 v121, v114, v115
  v_cvt_pk_bf16_f32 v122, v116, v117
  v_cvt_pk_bf16_f32 v123, v118, v119
  buffer_store_dwordx4 v[120:123], v2, s[4:7], s28 offen offset:0 sc1
  v_accvgpr_read_b32 v124, a40
  v_accvgpr_read_b32 v125, a41
  v_accvgpr_read_b32 v126, a42
  v_accvgpr_read_b32 v127, a43
  v_accvgpr_read_b32 v128, a44
  v_accvgpr_read_b32 v129, a45
  v_accvgpr_read_b32 v130, a46
  v_accvgpr_read_b32 v131, a47
  v_pk_mul_f32 v[124:125], v[124:125], v[8:9] op_sel_hi:[1,0]
  v_pk_mul_f32 v[126:127], v[126:127], v[8:9] op_sel_hi:[1,0]
  v_pk_mul_f32 v[128:129], v[128:129], v[8:9] op_sel_hi:[1,0]
  v_pk_mul_f32 v[130:131], v[130:131], v[8:9] op_sel_hi:[1,0]
  v_cvt_pk_bf16_f32 v132, v124, v125
  v_cvt_pk_bf16_f32 v133, v126, v127
  v_cvt_pk_bf16_f32 v134, v128, v129
  v_cvt_pk_bf16_f32 v135, v130, v131
  buffer_store_dwordx4 v[132:135], v2, s[4:7], s28 offen offset:1024 sc1
  v_accvgpr_read_b32 v136, a48
  v_accvgpr_read_b32 v137, a49
  v_accvgpr_read_b32 v138, a50
  v_accvgpr_read_b32 v139, a51
  v_accvgpr_read_b32 v140, a52
  v_accvgpr_read_b32 v141, a53
  v_accvgpr_read_b32 v142, a54
  v_accvgpr_read_b32 v143, a55
  v_pk_mul_f32 v[136:137], v[136:137], v[8:9] op_sel_hi:[1,0]
  v_pk_mul_f32 v[138:139], v[138:139], v[8:9] op_sel_hi:[1,0]
  v_pk_mul_f32 v[140:141], v[140:141], v[8:9] op_sel_hi:[1,0]
  v_pk_mul_f32 v[142:143], v[142:143], v[8:9] op_sel_hi:[1,0]
  v_cvt_pk_bf16_f32 v144, v136, v137
  v_cvt_pk_bf16_f32 v145, v138, v139
  v_cvt_pk_bf16_f32 v146, v140, v141
  v_cvt_pk_bf16_f32 v147, v142, v143
  buffer_store_dwordx4 v[144:147], v2, s[4:7], s28 offen offset:2048 sc1
  v_accvgpr_read_b32 v148, a56
  v_accvgpr_read_b32 v149, a57
  v_accvgpr_read_b32 v150, a58
  v_accvgpr_read_b32 v151, a59
  v_accvgpr_read_b32 v152, a60
  v_accvgpr_read_b32 v153, a61
  v_accvgpr_read_b32 v154, a62
  v_accvgpr_read_b32 v155, a63
  v_pk_mul_f32 v[148:149], v[148:149], v[8:9] op_sel_hi:[1,0]
  v_pk_mul_f32 v[150:151], v[150:151], v[8:9] op_sel_hi:[1,0]
  v_pk_mul_f32 v[152:153], v[152:153], v[8:9] op_sel_hi:[1,0]
  v_pk_mul_f32 v[154:155], v[154:155], v[8:9] op_sel_hi:[1,0]
  v_cvt_pk_bf16_f32 v156, v148, v149
  v_cvt_pk_bf16_f32 v157, v150, v151
  v_cvt_pk_bf16_f32 v158, v152, v153
  v_cvt_pk_bf16_f32 v159, v154, v155
  buffer_store_dwordx4 v[156:159], v2, s[4:7], s28 offen offset:3072 sc1
  s_add_u32 s28, s25, 100671488
  v_accvgpr_read_b32 v112, a64
  v_accvgpr_read_b32 v113, a65
  v_accvgpr_read_b32 v114, a66
  v_accvgpr_read_b32 v115, a67
  v_accvgpr_read_b32 v116, a68
  v_accvgpr_read_b32 v117, a69
  v_accvgpr_read_b32 v118, a70
  v_accvgpr_read_b32 v119, a71
  v_pk_mul_f32 v[112:113], v[112:113], v[10:11] op_sel_hi:[1,0]
  v_pk_mul_f32 v[114:115], v[114:115], v[10:11] op_sel_hi:[1,0]
  v_pk_mul_f32 v[116:117], v[116:117], v[10:11] op_sel_hi:[1,0]
  v_pk_mul_f32 v[118:119], v[118:119], v[10:11] op_sel_hi:[1,0]
  v_cvt_pk_bf16_f32 v120, v112, v113
  v_cvt_pk_bf16_f32 v121, v114, v115
  v_cvt_pk_bf16_f32 v122, v116, v117
  v_cvt_pk_bf16_f32 v123, v118, v119
  buffer_store_dwordx4 v[120:123], v2, s[4:7], s28 offen offset:0 sc1
  v_accvgpr_read_b32 v124, a72
  v_accvgpr_read_b32 v125, a73
  v_accvgpr_read_b32 v126, a74
  v_accvgpr_read_b32 v127, a75
  v_accvgpr_read_b32 v128, a76
  v_accvgpr_read_b32 v129, a77
  v_accvgpr_read_b32 v130, a78
  v_accvgpr_read_b32 v131, a79
  v_pk_mul_f32 v[124:125], v[124:125], v[10:11] op_sel_hi:[1,0]
  v_pk_mul_f32 v[126:127], v[126:127], v[10:11] op_sel_hi:[1,0]
  v_pk_mul_f32 v[128:129], v[128:129], v[10:11] op_sel_hi:[1,0]
  v_pk_mul_f32 v[130:131], v[130:131], v[10:11] op_sel_hi:[1,0]
  v_cvt_pk_bf16_f32 v132, v124, v125
  v_cvt_pk_bf16_f32 v133, v126, v127
  v_cvt_pk_bf16_f32 v134, v128, v129
  v_cvt_pk_bf16_f32 v135, v130, v131
  buffer_store_dwordx4 v[132:135], v2, s[4:7], s28 offen offset:1024 sc1
  v_accvgpr_read_b32 v136, a80
  v_accvgpr_read_b32 v137, a81
  v_accvgpr_read_b32 v138, a82
  v_accvgpr_read_b32 v139, a83
  v_accvgpr_read_b32 v140, a84
  v_accvgpr_read_b32 v141, a85
  v_accvgpr_read_b32 v142, a86
  v_accvgpr_read_b32 v143, a87
  v_pk_mul_f32 v[136:137], v[136:137], v[10:11] op_sel_hi:[1,0]
  v_pk_mul_f32 v[138:139], v[138:139], v[10:11] op_sel_hi:[1,0]
  v_pk_mul_f32 v[140:141], v[140:141], v[10:11] op_sel_hi:[1,0]
  v_pk_mul_f32 v[142:143], v[142:143], v[10:11] op_sel_hi:[1,0]
  v_cvt_pk_bf16_f32 v144, v136, v137
  v_cvt_pk_bf16_f32 v145, v138, v139
  v_cvt_pk_bf16_f32 v146, v140, v141
  v_cvt_pk_bf16_f32 v147, v142, v143
  buffer_store_dwordx4 v[144:147], v2, s[4:7], s28 offen offset:2048 sc1
  v_accvgpr_read_b32 v148, a88
  v_accvgpr_read_b32 v149, a89
  v_accvgpr_read_b32 v150, a90
  v_accvgpr_read_b32 v151, a91
  v_accvgpr_read_b32 v152, a92
  v_accvgpr_read_b32 v153, a93
  v_accvgpr_read_b32 v154, a94
  v_accvgpr_read_b32 v155, a95
  v_pk_mul_f32 v[148:149], v[148:149], v[10:11] op_sel_hi:[1,0]
  v_pk_mul_f32 v[150:151], v[150:151], v[10:11] op_sel_hi:[1,0]
  v_pk_mul_f32 v[152:153], v[152:153], v[10:11] op_sel_hi:[1,0]
  v_pk_mul_f32 v[154:155], v[154:155], v[10:11] op_sel_hi:[1,0]
  v_cvt_pk_bf16_f32 v156, v148, v149
  v_cvt_pk_bf16_f32 v157, v150, v151
  v_cvt_pk_bf16_f32 v158, v152, v153
  v_cvt_pk_bf16_f32 v159, v154, v155
  buffer_store_dwordx4 v[156:159], v2, s[4:7], s28 offen offset:3072 sc1
  s_add_u32 s28, s25, 100675584
  v_accvgpr_read_b32 v112, a96
  v_accvgpr_read_b32 v113, a97
  v_accvgpr_read_b32 v114, a98
  v_accvgpr_read_b32 v115, a99
  v_accvgpr_read_b32 v116, a100
  v_accvgpr_read_b32 v117, a101
  v_accvgpr_read_b32 v118, a102
  v_accvgpr_read_b32 v119, a103
  v_pk_mul_f32 v[112:113], v[112:113], v[10:11] op_sel_hi:[1,0]
  v_pk_mul_f32 v[114:115], v[114:115], v[10:11] op_sel_hi:[1,0]
  v_pk_mul_f32 v[116:117], v[116:117], v[10:11] op_sel_hi:[1,0]
  v_pk_mul_f32 v[118:119], v[118:119], v[10:11] op_sel_hi:[1,0]
  v_cvt_pk_bf16_f32 v120, v112, v113
  v_cvt_pk_bf16_f32 v121, v114, v115
  v_cvt_pk_bf16_f32 v122, v116, v117
  v_cvt_pk_bf16_f32 v123, v118, v119
  buffer_store_dwordx4 v[120:123], v2, s[4:7], s28 offen offset:0 sc1
  v_accvgpr_read_b32 v124, a104
  v_accvgpr_read_b32 v125, a105
  v_accvgpr_read_b32 v126, a106
  v_accvgpr_read_b32 v127, a107
  v_accvgpr_read_b32 v128, a108
  v_accvgpr_read_b32 v129, a109
  v_accvgpr_read_b32 v130, a110
  v_accvgpr_read_b32 v131, a111
  v_pk_mul_f32 v[124:125], v[124:125], v[10:11] op_sel_hi:[1,0]
  v_pk_mul_f32 v[126:127], v[126:127], v[10:11] op_sel_hi:[1,0]
  v_pk_mul_f32 v[128:129], v[128:129], v[10:11] op_sel_hi:[1,0]
  v_pk_mul_f32 v[130:131], v[130:131], v[10:11] op_sel_hi:[1,0]
  v_cvt_pk_bf16_f32 v132, v124, v125
  v_cvt_pk_bf16_f32 v133, v126, v127
  v_cvt_pk_bf16_f32 v134, v128, v129
  v_cvt_pk_bf16_f32 v135, v130, v131
  buffer_store_dwordx4 v[132:135], v2, s[4:7], s28 offen offset:1024 sc1
  v_accvgpr_read_b32 v136, a112
  v_accvgpr_read_b32 v137, a113
  v_accvgpr_read_b32 v138, a114
  v_accvgpr_read_b32 v139, a115
  v_accvgpr_read_b32 v140, a116
  v_accvgpr_read_b32 v141, a117
  v_accvgpr_read_b32 v142, a118
  v_accvgpr_read_b32 v143, a119
  v_pk_mul_f32 v[136:137], v[136:137], v[10:11] op_sel_hi:[1,0]
  v_pk_mul_f32 v[138:139], v[138:139], v[10:11] op_sel_hi:[1,0]
  v_pk_mul_f32 v[140:141], v[140:141], v[10:11] op_sel_hi:[1,0]
  v_pk_mul_f32 v[142:143], v[142:143], v[10:11] op_sel_hi:[1,0]
  v_cvt_pk_bf16_f32 v144, v136, v137
  v_cvt_pk_bf16_f32 v145, v138, v139
  v_cvt_pk_bf16_f32 v146, v140, v141
  v_cvt_pk_bf16_f32 v147, v142, v143
  buffer_store_dwordx4 v[144:147], v2, s[4:7], s28 offen offset:2048 sc1
  v_accvgpr_read_b32 v148, a120
  v_accvgpr_read_b32 v149, a121
  v_accvgpr_read_b32 v150, a122
  v_accvgpr_read_b32 v151, a123
  v_accvgpr_read_b32 v152, a124
  v_accvgpr_read_b32 v153, a125
  v_accvgpr_read_b32 v154, a126
  v_accvgpr_read_b32 v155, a127
  v_pk_mul_f32 v[148:149], v[148:149], v[10:11] op_sel_hi:[1,0]
  v_pk_mul_f32 v[150:151], v[150:151], v[10:11] op_sel_hi:[1,0]
  v_pk_mul_f32 v[152:153], v[152:153], v[10:11] op_sel_hi:[1,0]
  v_pk_mul_f32 v[154:155], v[154:155], v[10:11] op_sel_hi:[1,0]
  v_cvt_pk_bf16_f32 v156, v148, v149
  v_cvt_pk_bf16_f32 v157, v150, v151
  v_cvt_pk_bf16_f32 v158, v152, v153
  v_cvt_pk_bf16_f32 v159, v154, v155
  buffer_store_dwordx4 v[156:159], v2, s[4:7], s28 offen offset:3072 sc1
  s_branch A_out_31
A_kvw_32:
M_kv_35:
  s_cmp_ge_u32 s17, s36
  s_cbranch_scc1 M_kvok_36
  s_mov_b32 s76, 0
  s_mov_b32 s78, 23
  s_mov_b32 s77, 335872
  s_cmp_eq_u32 s68, 1
  s_cmov_b32 s76, 128
  s_cmov_b32 s78, 27
  s_cmov_b32 s77, 114688
  s_cmp_eq_u32 s68, 2
  s_cmov_b32 s76, 768
  s_cmov_b32 s78, 14
  s_cmov_b32 s77, 0
  s_add_u32 s76, s76, s67
  s_mov_b32 s71, 0
  s_branch M_sg_38
M_sw_37:
  s_sleep 8
  s_add_u32 s71, s71, 1
  s_cmp_gt_u32 s71, 262144
  s_cbranch_scc1 M_exit
M_sg_38:
  s_mov_b32 s79, 0
  s_atomic_or s79, s[72:73], s76 glc
  s_waitcnt lgkmcnt(0)
  s_cmp_lt_u32 s79, s78
  s_cbranch_scc1 M_sw_37
  s_add_u32 s36, s77, s19
  s_add_u32 s68, s68, 1
  s_branch M_kv_35
M_kvok_36:
  s_branch A_kvb_33
A_upd_29:
  s_cmp_eq_u32 s23, 2
  s_cbranch_scc1 A_upd2_39
  v_mov_b32 v12, s24
  v_cmp_le_i32 s[40:41], 0, v5
  v_cmp_le_i32 s[42:43], 1, v5
  v_cmp_le_i32 s[44:45], 2, v5
  v_cmp_le_i32 s[46:47], 3, v5
  v_cndmask_b32 v64, v12, v6, s[40:41]
  v_cndmask_b32 v65, v12, v6, s[42:43]
  v_cndmask_b32 v66, v12, v6, s[44:45]
  v_cndmask_b32 v67, v12, v6, s[46:47]
  v_cmp_le_i32 s[40:41], 8, v5
  v_cmp_le_i32 s[42:43], 9, v5
  v_cmp_le_i32 s[44:45], 10, v5
  v_cmp_le_i32 s[46:47], 11, v5
  v_cndmask_b32 v68, v12, v6, s[40:41]
  v_cndmask_b32 v69, v12, v6, s[42:43]
  v_cndmask_b32 v70, v12, v6, s[44:45]
  v_cndmask_b32 v71, v12, v6, s[46:47]
  v_cmp_le_i32 s[40:41], 16, v5
  v_cmp_le_i32 s[42:43], 17, v5
  v_cmp_le_i32 s[44:45], 18, v5
  v_cmp_le_i32 s[46:47], 19, v5
  v_cndmask_b32 v72, v12, v6, s[40:41]
  v_cndmask_b32 v73, v12, v6, s[42:43]
  v_cndmask_b32 v74, v12, v6, s[44:45]
  v_cndmask_b32 v75, v12, v6, s[46:47]
  v_cmp_le_i32 s[40:41], 24, v5
  v_cmp_le_i32 s[42:43], 25, v5
  v_cmp_le_i32 s[44:45], 26, v5
  v_cmp_le_i32 s[46:47], 27, v5
  v_cndmask_b32 v76, v12, v6, s[40:41]
  v_cndmask_b32 v77, v12, v6, s[42:43]
  v_cndmask_b32 v78, v12, v6, s[44:45]
  v_cndmask_b32 v79, v12, v6, s[46:47]
  v_mov_b32 v80, v7
  v_mov_b32 v81, v7
  v_mov_b32 v82, v7
  v_mov_b32 v83, v7
  v_mov_b32 v84, v7
  v_mov_b32 v85, v7
  v_mov_b32 v86, v7
  v_mov_b32 v87, v7
  v_mov_b32 v88, v7
  v_mov_b32 v89, v7
  v_mov_b32 v90, v7
  v_mov_b32 v91, v7
  v_mov_b32 v92, v7
  v_mov_b32 v93, v7
  v_mov_b32 v94, v7
  v_mov_b32 v95, v7
  s_branch A_back_30
A_upd2_39:
  v_mov_b32 v64, v6
  v_mov_b32 v65, v6
  v_mov_b32 v66, v6
  v_mov_b32 v67, v6
  v_mov_b32 v68, v6
  v_mov_b32 v69, v6
  v_mov_b32 v70, v6
  v_mov_b32 v71, v6
  v_mov_b32 v72, v6
  v_mov_b32 v73, v6
  v_mov_b32 v74, v6
  v_mov_b32 v75, v6
  v_mov_b32 v76, v6
  v_mov_b32 v77, v6
  v_mov_b32 v78, v6
  v_mov_b32 v79, v6
  s_branch A_back_30
A_slow_34:
  s_mov_b32 s29, 1
  v_mov_b32 v64, s24
  v_mov_b32 v65, s24
  v_mov_b32 v66, s24
  v_mov_b32 v67, s24
  v_mov_b32 v68, s24
  v_mov_b32 v69, s24
  v_mov_b32 v70, s24
  v_mov_b32 v71, s24
  v_mov_b32 v72, s24
  v_mov_b32 v73, s24
  v_mov_b32 v74, s24
  v_mov_b32 v75, s24
  v_mov_b32 v76, s24
  v_mov_b32 v77, s24
  v_mov_b32 v78, s24
  v_mov_b32 v79, s24
  v_mov_b32 v12, s24
  v_cmp_le_i32 s[40:41], 0, v5
  v_cmp_le_i32 s[42:43], 1, v5
  v_cmp_le_i32 s[44:45], 2, v5
  v_cmp_le_i32 s[46:47], 3, v5
  v_cndmask_b32 v80, v12, v7, s[40:41]
  v_cndmask_b32 v81, v12, v7, s[42:43]
  v_cndmask_b32 v82, v12, v7, s[44:45]
  v_cndmask_b32 v83, v12, v7, s[46:47]
  v_cmp_le_i32 s[40:41], 8, v5
  v_cmp_le_i32 s[42:43], 9, v5
  v_cmp_le_i32 s[44:45], 10, v5
  v_cmp_le_i32 s[46:47], 11, v5
  v_cndmask_b32 v84, v12, v7, s[40:41]
  v_cndmask_b32 v85, v12, v7, s[42:43]
  v_cndmask_b32 v86, v12, v7, s[44:45]
  v_cndmask_b32 v87, v12, v7, s[46:47]
  v_cmp_le_i32 s[40:41], 16, v5
  v_cmp_le_i32 s[42:43], 17, v5
  v_cmp_le_i32 s[44:45], 18, v5
  v_cmp_le_i32 s[46:47], 19, v5
  v_cndmask_b32 v88, v12, v7, s[40:41]
  v_cndmask_b32 v89, v12, v7, s[42:43]
  v_cndmask_b32 v90, v12, v7, s[44:45]
  v_cndmask_b32 v91, v12, v7, s[46:47]
  v_cmp_le_i32 s[40:41], 24, v5
  v_cmp_le_i32 s[42:43], 25, v5
  v_cmp_le_i32 s[44:45], 26, v5
  v_cmp_le_i32 s[46:47], 27, v5
  v_cndmask_b32 v92, v12, v7, s[40:41]
  v_cndmask_b32 v93, v12, v7, s[42:43]
  v_cndmask_b32 v94, v12, v7, s[44:45]
  v_cndmask_b32 v95, v12, v7, s[46:47]
  v_mov_b32 v8, s24
  v_mov_b32 v10, s24
  s_add_u32 s17, s25, 16785408
  s_mov_b32 s23, 0
A_ml_40:
  s_add_u32 s28, s17, 4096
  buffer_load_dwordx4 a[192:195], v2, s[4:7], s17 offen offset:0 sc1
  buffer_load_dwordx4 a[196:199], v2, s[4:7], s17 offen offset:1024 sc1
  buffer_load_dwordx4 a[200:203], v2, s[4:7], s17 offen offset:2048 sc1
  buffer_load_dwordx4 a[204:207], v2, s[4:7], s17 offen offset:3072 sc1
  buffer_load_dwordx4 a[208:211], v2, s[4:7], s28 offen offset:0 sc1
  buffer_load_dwordx4 a[212:215], v2, s[4:7], s28 offen offset:1024 sc1
  buffer_load_dwordx4 a[216:219], v2, s[4:7], s28 offen offset:2048 sc1
  buffer_load_dwordx4 a[220:223], v2, s[4:7], s28 offen offset:3072 sc1
  s_waitcnt vmcnt(0)
  v_mfma_f32_32x32x16_bf16 v[32:47], a[192:195], a[128:131], v[64:79]
  v_mfma_f32_32x32x16_bf16 v[32:47], a[196:199], a[132:135], v[32:47]
  v_mfma_f32_32x32x16_bf16 v[32:47], a[200:203], a[136:139], v[32:47]
  v_mfma_f32_32x32x16_bf16 v[32:47], a[204:207], a[140:143], v[32:47]
  v_mfma_f32_32x32x16_bf16 v[32:47], a[208:211], a[144:147], v[32:47]
  v_mfma_f32_32x32x16_bf16 v[32:47], a[212:215], a[148:151], v[32:47]
  v_mfma_f32_32x32x16_bf16 v[32:47], a[216:219], a[152:155], v[32:47]
  v_mfma_f32_32x32x16_bf16 v[32:47], a[220:223], a[156:159], v[32:47]
  v_mfma_f32_32x32x16_bf16 v[48:63], a[192:195], a[160:163], v[80:95]
  v_mfma_f32_32x32x16_bf16 v[48:63], a[196:199], a[164:167], v[48:63]
  v_mfma_f32_32x32x16_bf16 v[48:63], a[200:203], a[168:171], v[48:63]
  v_mfma_f32_32x32x16_bf16 v[48:63], a[204:207], a[172:175], v[48:63]
  v_mfma_f32_32x32x16_bf16 v[48:63], a[208:211], a[176:179], v[48:63]
  v_mfma_f32_32x32x16_bf16 v[48:63], a[212:215], a[180:183], v[48:63]
  v_mfma_f32_32x32x16_bf16 v[48:63], a[216:219], a[184:187], v[48:63]
  v_mfma_f32_32x32x16_bf16 v[48:63], a[220:223], a[188:191], v[48:63]
  s_nop 7
  s_nop 3
  v_max3_f32 v8, v8, v32, v33
  v_max3_f32 v8, v8, v34, v35
  v_max3_f32 v8, v8, v36, v37
  v_max3_f32 v8, v8, v38, v39
  v_max3_f32 v8, v8, v40, v41
  v_max3_f32 v8, v8, v42, v43
  v_max3_f32 v8, v8, v44, v45
  v_max3_f32 v8, v8, v46, v47
  v_max3_f32 v10, v10, v48, v49
  v_max3_f32 v10, v10, v50, v51
  v_max3_f32 v10, v10, v52, v53
  v_max3_f32 v10, v10, v54, v55
  v_max3_f32 v10, v10, v56, v57
  v_max3_f32 v10, v10, v58, v59
  v_max3_f32 v10, v10, v60, v61
  v_max3_f32 v10, v10, v62, v63
  s_add_u32 s23, s23, 1
  s_cmp_lg_u32 s23, 1
  s_cbranch_scc1 A_m2_41
  v_mov_b32 v12, s24
  v_cmp_le_i32 s[40:41], 0, v5
  v_cmp_le_i32 s[42:43], 1, v5
  v_cmp_le_i32 s[44:45], 2, v5
  v_cmp_le_i32 s[46:47], 3, v5
  v_cndmask_b32 v64, v12, v6, s[40:41]
  v_cndmask_b32 v65, v12, v6, s[42:43]
  v_cndmask_b32 v66, v12, v6, s[44:45]
  v_cndmask_b32 v67, v12, v6, s[46:47]
  v_cmp_le_i32 s[40:41], 8, v5
  v_cmp_le_i32 s[42:43], 9, v5
  v_cmp_le_i32 s[44:45], 10, v5
  v_cmp_le_i32 s[46:47], 11, v5
  v_cndmask_b32 v68, v12, v6, s[40:41]
  v_cndmask_b32 v69, v12, v6, s[42:43]
  v_cndmask_b32 v70, v12, v6, s[44:45]
  v_cndmask_b32 v71, v12, v6, s[46:47]
  v_cmp_le_i32 s[40:41], 16, v5
  v_cmp_le_i32 s[42:43], 17, v5
  v_cmp_le_i32 s[44:45], 18, v5
  v_cmp_le_i32 s[46:47], 19, v5
  v_cndmask_b32 v72, v12, v6, s[40:41]
  v_cndmask_b32 v73, v12, v6, s[42:43]
  v_cndmask_b32 v74, v12, v6, s[44:45]
  v_cndmask_b32 v75, v12, v6, s[46:47]
  v_cmp_le_i32 s[40:41], 24, v5
  v_cmp_le_i32 s[42:43], 25, v5
  v_cmp_le_i32 s[44:45], 26, v5
  v_cmp_le_i32 s[46:47], 27, v5
  v_cndmask_b32 v76, v12, v6, s[40:41]
  v_cndmask_b32 v77, v12, v6, s[42:43]
  v_cndmask_b32 v78, v12, v6, s[44:45]
  v_cndmask_b32 v79, v12, v6, s[46:47]
  v_mov_b32 v80, v7
  v_mov_b32 v81, v7
  v_mov_b32 v82, v7
  v_mov_b32 v83, v7
  v_mov_b32 v84, v7
  v_mov_b32 v85, v7
  v_mov_b32 v86, v7
  v_mov_b32 v87, v7
  v_mov_b32 v88, v7
  v_mov_b32 v89, v7
  v_mov_b32 v90, v7
  v_mov_b32 v91, v7
  v_mov_b32 v92, v7
  v_mov_b32 v93, v7
  v_mov_b32 v94, v7
  v_mov_b32 v95, v7
A_m2_41:
  s_cmp_lg_u32 s23, 2
  s_cbranch_scc1 A_m3_42
  v_mov_b32 v64, v6
  v_mov_b32 v65, v6
  v_mov_b32 v66, v6
  v_mov_b32 v67, v6
  v_mov_b32 v68, v6
  v_mov_b32 v69, v6
  v_mov_b32 v70, v6
  v_mov_b32 v71, v6
  v_mov_b32 v72, v6
  v_mov_b32 v73, v6
  v_mov_b32 v74, v6
  v_mov_b32 v75, v6
  v_mov_b32 v76, v6
  v_mov_b32 v77, v6
  v_mov_b32 v78, v6
  v_mov_b32 v79, v6
A_m3_42:
  s_sub_u32 s17, s17, 8192
  s_cmp_ge_i32 s17, s19
  s_cbranch_scc1 A_ml_40
  v_mov_b32 v9, v8
  s_nop 1
  v_permlane32_swap_b32 v8, v9
  s_nop 1
  v_max_f32 v8, v8, v9
  v_sub_f32 v6, 0, v8
  v_mov_b32 v11, v10
  s_nop 1
  v_permlane32_swap_b32 v10, v11
  s_nop 1
  v_max_f32 v10, v10, v11
  v_sub_f32 v7, 0, v10
  s_branch A_again_21
A_out_31:
  s_mov_b32 s69, s55
  s_mov_b32 s70, s56
  s_sub_u32 s52, s52, 1
  s_cmp_lg_u32 s52, 0
  s_cbranch_scc1 M_att
  s_waitcnt vmcnt(0)
  s_barrier
  s_mov_b32 s30, 512
  v_mov_b32 v144, s30
  v_min_u32 v145, 1, v0
  v_lshlrev_b32 v145, 30, v145
  buffer_store_dword v144, v145, s[4:7], s31 offen sc1
  s_lshr_b32 s48, s64, 2
  s_bfe_u32 s49, s64, 0x10001
  s_and_b32 s50, s64, 1
  s_mul_i32 s50, s50, 6
  s_add_u32 s50, s50, s65
  s_mov_b32 s51, 12
  s_cmp_lt_u32 s50, 4
  s_cselect_b32 s23, 6, 5
  s_load_dwordx2 s[8:9], s[0:1], 40
  s_lshl_b32 s17, s48, 19
  s_lshl_b32 s26, s49, 2
  s_add_u32 s26, s26, s16
  s_lshl_b32 s27, s26, 7
  s_add_u32 s17, s17, s27
  s_mov_b32 s18, 1024
  s_lshl_b32 s21, s48, 6
  s_add_u32 s21, s21, s50
  s_lshl_b32 s21, s21, 3
  s_add_u32 s21, s21, s26
  s_lshl_b32 s21, s21, 12
  s_add_u32 s21, s21, 150994944
  s_lshl_b32 s22, s51, 15
  s_mov_b32 s24, 1.0
  s_waitcnt lgkmcnt(0)
  s_and_b32 s9, s9, 0xffff
  s_mov_b32 s10, 4194304
  s_mov_b32 s11, 0x20000
  s_mov_b32 s12, s4
  s_mov_b32 s13, s5
  s_mov_b32 s14, 268435456
  s_mov_b32 s15, 0x20000
  s_lshl_b32 s19, s48, 8
  s_add_u32 s19, s19, s50
  s_lshl_b32 s19, s19, 13
  s_add_u32 s19, s19, 100663296
  s_lshl_b32 s20, s51, 13
  s_mul_i32 s26, s16, 524288
  v_add_u32 v8, 0, v2
  v_add_u32 v16, s26, v8
  v_add_u32 v9, 1024, v2
  v_add_u32 v17, s26, v9
  v_add_u32 v10, 2048, v2
  v_add_u32 v18, s26, v10
  v_add_u32 v11, 3072, v2
  v_add_u32 v19, s26, v11
  v_add_u32 v12, 4096, v2
  v_add_u32 v20, s26, v12
  v_add_u32 v13, 5120, v2
  v_add_u32 v21, s26, v13
  v_add_u32 v14, 6144, v2
  v_add_u32 v22, s26, v14
  v_add_u32 v15, 7168, v2
  v_add_u32 v23, s26, v15
  v_lshrrev_b32 v144, 3, v1
  v_mul_lo_u32 v144, v144, s18
  v_and_b32 v145, 7, v1
  v_lshl_add_u32 v144, v145, 4, v144
  s_lshl_b32 s28, s16, 15
  s_add_u32 s28, s28, 32768
  s_lshl_b32 s29, s18, 3
  s_add_u32 m0, s28, 0
  s_nop 0
  buffer_load_dwordx4 v144, s[8:11], s17 offen lds
  s_add_u32 s17, s17, s29
  s_add_u32 m0, s28, 1024
  s_nop 0
  buffer_load_dwordx4 v144, s[8:11], s17 offen lds
  s_add_u32 s17, s17, s29
  s_add_u32 m0, s28, 2048
  s_nop 0
  buffer_load_dwordx4 v144, s[8:11], s17 offen lds
  s_add_u32 s17, s17, s29
  s_add_u32 m0, s28, 3072
  s_nop 0
  buffer_load_dwordx4 v144, s[8:11], s17 offen lds
  s_add_u32 s17, s17, s29
  s_add_u32 m0, s28, 4096
  s_nop 0
  buffer_load_dwordx4 v144, s[8:11], s17 offen lds
  s_add_u32 s17, s17, s29
  s_add_u32 m0, s28, 5120
  s_nop 0
  buffer_load_dwordx4 v144, s[8:11], s17 offen lds
  s_add_u32 s17, s17, s29
  s_add_u32 m0, s28, 6144
  s_nop 0
  buffer_load_dwordx4 v144, s[8:11], s17 offen lds
  s_add_u32 s17, s17, s29
  s_add_u32 m0, s28, 7168
  s_nop 0
  buffer_load_dwordx4 v144, s[8:11], s17 offen lds
  s_add_u32 s17, s17, s29
  s_add_u32 m0, s28, 8192
  s_nop 0
  buffer_load_dwordx4 v144, s[8:11], s17 offen lds
  s_add_u32 s17, s17, s29
  s_add_u32 m0, s28, 9216
  s_nop 0
  buffer_load_dwordx4 v144, s[8:11], s17 offen lds
  s_add_u32 s17, s17, s29
  s_add_u32 m0, s28, 10240
  s_nop 0
  buffer_load_dwordx4 v144, s[8:11], s17 offen lds
  s_add_u32 s17, s17, s29
  s_add_u32 m0, s28, 11264
  s_nop 0
  buffer_load_dwordx4 v144, s[8:11], s17 offen lds
  s_add_u32 s17, s17, s29
  s_add_u32 m0, s28, 12288
  s_nop 0
  buffer_load_dwordx4 v144, s[8:11], s17 offen lds
  s_add_u32 s17, s17, s29
  s_add_u32 m0, s28, 13312
  s_nop 0
  buffer_load_dwordx4 v144, s[8:11], s17 offen lds
  s_add_u32 s17, s17, s29
  s_add_u32 m0, s28, 14336
  s_nop 0
  buffer_load_dwordx4 v144, s[8:11], s17 offen lds
  s_add_u32 s17, s17, s29
  s_add_u32 m0, s28, 15360
  s_nop 0
  buffer_load_dwordx4 v144, s[8:11], s17 offen lds
  s_add_u32 s17, s17, s29
  s_add_u32 m0, s28, 16384
  s_nop 0
  buffer_load_dwordx4 v144, s[8:11], s17 offen lds
  s_add_u32 s17, s17, s29
  s_add_u32 m0, s28, 17408
  s_nop 0
  buffer_load_dwordx4 v144, s[8:11], s17 offen lds
  s_add_u32 s17, s17, s29
  s_add_u32 m0, s28, 18432
  s_nop 0
  buffer_load_dwordx4 v144, s[8:11], s17 offen lds
  s_add_u32 s17, s17, s29
  s_add_u32 m0, s28, 19456
  s_nop 0
  buffer_load_dwordx4 v144, s[8:11], s17 offen lds
  s_add_u32 s17, s17, s29
  s_add_u32 m0, s28, 20480
  s_nop 0
  buffer_load_dwordx4 v144, s[8:11], s17 offen lds
  s_add_u32 s17, s17, s29
  s_add_u32 m0, s28, 21504
  s_nop 0
  buffer_load_dwordx4 v144, s[8:11], s17 offen lds
  s_add_u32 s17, s17, s29
  s_add_u32 m0, s28, 22528
  s_nop 0
  buffer_load_dwordx4 v144, s[8:11], s17 offen lds
  s_add_u32 s17, s17, s29
  s_add_u32 m0, s28, 23552
  s_nop 0
  buffer_load_dwordx4 v144, s[8:11], s17 offen lds
  s_add_u32 s17, s17, s29
  s_add_u32 m0, s28, 24576
  s_nop 0
  buffer_load_dwordx4 v144, s[8:11], s17 offen lds
  s_add_u32 s17, s17, s29
  s_add_u32 m0, s28, 25600
  s_nop 0
  buffer_load_dwordx4 v144, s[8:11], s17 offen lds
  s_add_u32 s17, s17, s29
  s_add_u32 m0, s28, 26624
  s_nop 0
  buffer_load_dwordx4 v144, s[8:11], s17 offen lds
  s_add_u32 s17, s17, s29
  s_add_u32 m0, s28, 27648
  s_nop 0
  buffer_load_dwordx4 v144, s[8:11], s17 offen lds
  s_add_u32 s17, s17, s29
  s_add_u32 m0, s28, 28672
  s_nop 0
  buffer_load_dwordx4 v144, s[8:11], s17 offen lds
  s_add_u32 s17, s17, s29
  s_add_u32 m0, s28, 29696
  s_nop 0
  buffer_load_dwordx4 v144, s[8:11], s17 offen lds
  s_add_u32 s17, s17, s29
  s_add_u32 m0, s28, 30720
  s_nop 0
  buffer_load_dwordx4 v144, s[8:11], s17 offen lds
  s_add_u32 s17, s17, s29
  s_add_u32 m0, s28, 31744
  s_nop 0
  buffer_load_dwordx4 v144, s[8:11], s17 offen lds
  s_add_u32 s17, s17, s29
  v_bfe_u32 v148, v1, 2, 2
  v_lshrrev_b32 v149, 5, v1
  v_lshl_add_u32 v148, v149, 2, v148
  v_lshlrev_b32 v148, 7, v148
  v_bfe_u32 v149, v1, 4, 1
  v_lshl_add_u32 v148, v149, 5, v148
  v_and_b32 v149, 1, v1
  v_lshl_add_u32 v148, v149, 4, v148
  v_bfe_u32 v149, v1, 1, 1
  v_lshl_add_u32 v148, v149, 3, v148
  v_add_u32 v146, s28, v148
  v_add_u32 v147, 1024, v146
  s_waitcnt vmcnt(28)
  ds_read_b64_tr_b16 a[0:1], v146 offset:0
  ds_read_b64_tr_b16 a[2:3], v147 offset:0
  ds_read_b64_tr_b16 a[4:5], v146 offset:64
  ds_read_b64_tr_b16 a[6:7], v147 offset:64
  ds_read_b64_tr_b16 a[8:9], v146 offset:2048
  ds_read_b64_tr_b16 a[10:11], v147 offset:2048
  ds_read_b64_tr_b16 a[12:13], v146 offset:2112
  ds_read_b64_tr_b16 a[14:15], v147 offset:2112
  s_waitcnt lgkmcnt(0)
  s_add_u32 m0, s28, 0
  s_nop 0
  buffer_load_dwordx4 v144, s[8:11], s17 offen lds
  s_add_u32 s17, s17, s29
  s_add_u32 m0, s28, 1024
  s_nop 0
  buffer_load_dwordx4 v144, s[8:11], s17 offen lds
  s_add_u32 s17, s17, s29
  s_add_u32 m0, s28, 2048
  s_nop 0
  buffer_load_dwordx4 v144, s[8:11], s17 offen lds
  s_add_u32 s17, s17, s29
  s_add_u32 m0, s28, 3072
  s_nop 0
  buffer_load_dwordx4 v144, s[8:11], s17 offen lds
  s_add_u32 s17, s17, s29
  s_waitcnt vmcnt(28)
  ds_read_b64_tr_b16 a[16:17], v146 offset:4096
  ds_read_b64_tr_b16 a[18:19], v147 offset:4096
  ds_read_b64_tr_b16 a[20:21], v146 offset:4160
  ds_read_b64_tr_b16 a[22:23], v147 offset:4160
  ds_read_b64_tr_b16 a[24:25], v146 offset:6144
  ds_read_b64_tr_b16 a[26:27], v147 offset:6144
  ds_read_b64_tr_b16 a[28:29], v146 offset:6208
  ds_read_b64_tr_b16 a[30:31], v147 offset:6208
  s_waitcnt lgkmcnt(0)
  s_add_u32 m0, s28, 4096
  s_nop 0
  buffer_load_dwordx4 v144, s[8:11], s17 offen lds
  s_add_u32 s17, s17, s29
  s_add_u32 m0, s28, 5120
  s_nop 0
  buffer_load_dwordx4 v144, s[8:11], s17 offen lds
  s_add_u32 s17, s17, s29
  s_add_u32 m0, s28, 6144
  s_nop 0
  buffer_load_dwordx4 v144, s[8:11], s17 offen lds
  s_add_u32 s17, s17, s29
  s_add_u32 m0, s28, 7168
  s_nop 0
  buffer_load_dwordx4 v144, s[8:11], s17 offen lds
  s_add_u32 s17, s17, s29
  s_waitcnt vmcnt(28)
  ds_read_b64_tr_b16 a[32:33], v146 offset:8192
  ds_read_b64_tr_b16 a[34:35], v147 offset:8192
  ds_read_b64_tr_b16 a[36:37], v146 offset:8256
  ds_read_b64_tr_b16 a[38:39], v147 offset:8256
  ds_read_b64_tr_b16 a[40:41], v146 offset:10240
  ds_read_b64_tr_b16 a[42:43], v147 offset:10240
  ds_read_b64_tr_b16 a[44:45], v146 offset:10304
  ds_read_b64_tr_b16 a[46:47], v147 offset:10304
  s_waitcnt lgkmcnt(0)
  s_add_u32 m0, s28, 8192
  s_nop 0
  buffer_load_dwordx4 v144, s[8:11], s17 offen lds
  s_add_u32 s17, s17, s29
  s_add_u32 m0, s28, 9216
  s_nop 0
  buffer_load_dwordx4 v144, s[8:11], s17 offen lds
  s_add_u32 s17, s17, s29
  s_add_u32 m0, s28, 10240
  s_nop 0
  buffer_load_dwordx4 v144, s[8:11], s17 offen lds
  s_add_u32 s17, s17, s29
  s_add_u32 m0, s28, 11264
  s_nop 0
  buffer_load_dwordx4 v144, s[8:11], s17 offen lds
  s_add_u32 s17, s17, s29
  s_waitcnt vmcnt(28)
  ds_read_b64_tr_b16 a[48:49], v146 offset:12288
  ds_read_b64_tr_b16 a[50:51], v147 offset:12288
  ds_read_b64_tr_b16 a[52:53], v146 offset:12352
  ds_read_b64_tr_b16 a[54:55], v147 offset:12352
  ds_read_b64_tr_b16 a[56:57], v146 offset:14336
  ds_read_b64_tr_b16 a[58:59], v147 offset:14336
  ds_read_b64_tr_b16 a[60:61], v146 offset:14400
  ds_read_b64_tr_b16 a[62:63], v147 offset:14400
  s_waitcnt lgkmcnt(0)
  s_add_u32 m0, s28, 12288
  s_nop 0
  buffer_load_dwordx4 v144, s[8:11], s17 offen lds
  s_add_u32 s17, s17, s29
  s_add_u32 m0, s28, 13312
  s_nop 0
  buffer_load_dwordx4 v144, s[8:11], s17 offen lds
  s_add_u32 s17, s17, s29
  s_add_u32 m0, s28, 14336
  s_nop 0
  buffer_load_dwordx4 v144, s[8:11], s17 offen lds
  s_add_u32 s17, s17, s29
  s_add_u32 m0, s28, 15360
  s_nop 0
  buffer_load_dwordx4 v144, s[8:11], s17 offen lds
  s_add_u32 s17, s17, s29
  s_waitcnt vmcnt(28)
  ds_read_b64_tr_b16 a[64:65], v146 offset:16384
  ds_read_b64_tr_b16 a[66:67], v147 offset:16384
  ds_read_b64_tr_b16 a[68:69], v146 offset:16448
  ds_read_b64_tr_b16 a[70:71], v147 offset:16448
  ds_read_b64_tr_b16 a[72:73], v146 offset:18432
  ds_read_b64_tr_b16 a[74:75], v147 offset:18432
  ds_read_b64_tr_b16 a[76:77], v146 offset:18496
  ds_read_b64_tr_b16 a[78:79], v147 offset:18496
  s_waitcnt lgkmcnt(0)
  s_add_u32 m0, s28, 16384
  s_nop 0
  buffer_load_dwordx4 v144, s[8:11], s17 offen lds
  s_add_u32 s17, s17, s29
  s_add_u32 m0, s28, 17408
  s_nop 0
  buffer_load_dwordx4 v144, s[8:11], s17 offen lds
  s_add_u32 s17, s17, s29
  s_add_u32 m0, s28, 18432
  s_nop 0
  buffer_load_dwordx4 v144, s[8:11], s17 offen lds
  s_add_u32 s17, s17, s29
  s_add_u32 m0, s28, 19456
  s_nop 0
  buffer_load_dwordx4 v144, s[8:11], s17 offen lds
  s_add_u32 s17, s17, s29
  s_waitcnt vmcnt(28)
  ds_read_b64_tr_b16 a[80:81], v146 offset:20480
  ds_read_b64_tr_b16 a[82:83], v147 offset:20480
  ds_read_b64_tr_b16 a[84:85], v146 offset:20544
  ds_read_b64_tr_b16 a[86:87], v147 offset:20544
  ds_read_b64_tr_b16 a[88:89], v146 offset:22528
  ds_read_b64_tr_b16 a[90:91], v147 offset:22528
  ds_read_b64_tr_b16 a[92:93], v146 offset:22592
  ds_read_b64_tr_b16 a[94:95], v147 offset:22592
  s_waitcnt lgkmcnt(0)
  s_add_u32 m0, s28, 20480
  s_nop 0
  buffer_load_dwordx4 v144, s[8:11], s17 offen lds
  s_add_u32 s17, s17, s29
  s_add_u32 m0, s28, 21504
  s_nop 0
  buffer_load_dwordx4 v144, s[8:11], s17 offen lds
  s_add_u32 s17, s17, s29
  s_add_u32 m0, s28, 22528
  s_nop 0
  buffer_load_dwordx4 v144, s[8:11], s17 offen lds
  s_add_u32 s17, s17, s29
  s_add_u32 m0, s28, 23552
  s_nop 0
  buffer_load_dwordx4 v144, s[8:11], s17 offen lds
  s_add_u32 s17, s17, s29
  s_waitcnt vmcnt(28)
  ds_read_b64_tr_b16 a[96:97], v146 offset:24576
  ds_read_b64_tr_b16 a[98:99], v147 offset:24576
  ds_read_b64_tr_b16 a[100:101], v146 offset:24640
  ds_read_b64_tr_b16 a[102:103], v147 offset:24640
  ds_read_b64_tr_b16 a[104:105], v146 offset:26624
  ds_read_b64_tr_b16 a[106:107], v147 offset:26624
  ds_read_b64_tr_b16 a[108:109], v146 offset:26688
  ds_read_b64_tr_b16 a[110:111], v147 offset:26688
  s_waitcnt lgkmcnt(0)
  s_add_u32 m0, s28, 24576
  s_nop 0
  buffer_load_dwordx4 v144, s[8:11], s17 offen lds
  s_add_u32 s17, s17, s29
  s_add_u32 m0, s28, 25600
  s_nop 0
  buffer_load_dwordx4 v144, s[8:11], s17 offen lds
  s_add_u32 s17, s17, s29
  s_add_u32 m0, s28, 26624
  s_nop 0
  buffer_load_dwordx4 v144, s[8:11], s17 offen lds
  s_add_u32 s17, s17, s29
  s_add_u32 m0, s28, 27648
  s_nop 0
  buffer_load_dwordx4 v144, s[8:11], s17 offen lds
  s_add_u32 s17, s17, s29
  s_waitcnt vmcnt(28)
  ds_read_b64_tr_b16 a[112:113], v146 offset:28672
  ds_read_b64_tr_b16 a[114:115], v147 offset:28672
  ds_read_b64_tr_b16 a[116:117], v146 offset:28736
  ds_read_b64_tr_b16 a[118:119], v147 offset:28736
  ds_read_b64_tr_b16 a[120:121], v146 offset:30720
  ds_read_b64_tr_b16 a[122:123], v147 offset:30720
  ds_read_b64_tr_b16 a[124:125], v146 offset:30784
  ds_read_b64_tr_b16 a[126:127], v147 offset:30784
  s_waitcnt lgkmcnt(0)
  s_add_u32 m0, s28, 28672
  s_nop 0
  buffer_load_dwordx4 v144, s[8:11], s17 offen lds
  s_add_u32 s17, s17, s29
  s_add_u32 m0, s28, 29696
  s_nop 0
  buffer_load_dwordx4 v144, s[8:11], s17 offen lds
  s_add_u32 s17, s17, s29
  s_add_u32 m0, s28, 30720
  s_nop 0
  buffer_load_dwordx4 v144, s[8:11], s17 offen lds
  s_add_u32 s17, s17, s29
  s_add_u32 m0, s28, 31744
  s_nop 0
  buffer_load_dwordx4 v144, s[8:11], s17 offen lds
  s_add_u32 s17, s17, s29
  s_waitcnt vmcnt(28)
  ds_read_b64_tr_b16 a[128:129], v146 offset:0
  ds_read_b64_tr_b16 a[130:131], v147 offset:0
  ds_read_b64_tr_b16 a[132:133], v146 offset:64
  ds_read_b64_tr_b16 a[134:135], v147 offset:64
  ds_read_b64_tr_b16 a[136:137], v146 offset:2048
  ds_read_b64_tr_b16 a[138:139], v147 offset:2048
  ds_read_b64_tr_b16 a[140:141], v146 offset:2112
  ds_read_b64_tr_b16 a[142:143], v147 offset:2112
  s_waitcnt lgkmcnt(0)
  s_waitcnt vmcnt(24)
  ds_read_b64_tr_b16 a[144:145], v146 offset:4096
  ds_read_b64_tr_b16 a[146:147], v147 offset:4096
  ds_read_b64_tr_b16 a[148:149], v146 offset:4160
  ds_read_b64_tr_b16 a[150:151], v147 offset:4160
  ds_read_b64_tr_b16 a[152:153], v146 offset:6144
  ds_read_b64_tr_b16 a[154:155], v147 offset:6144
  ds_read_b64_tr_b16 a[156:157], v146 offset:6208
  ds_read_b64_tr_b16 a[158:159], v147 offset:6208
  s_waitcnt lgkmcnt(0)
  s_waitcnt vmcnt(20)
  ds_read_b64_tr_b16 a[160:161], v146 offset:8192
  ds_read_b64_tr_b16 a[162:163], v147 offset:8192
  ds_read_b64_tr_b16 a[164:165], v146 offset:8256
  ds_read_b64_tr_b16 a[166:167], v147 offset:8256
  ds_read_b64_tr_b16 a[168:169], v146 offset:10240
  ds_read_b64_tr_b16 a[170:171], v147 offset:10240
  ds_read_b64_tr_b16 a[172:173], v146 offset:10304
  ds_read_b64_tr_b16 a[174:175], v147 offset:10304
  s_waitcnt lgkmcnt(0)
  s_waitcnt vmcnt(16)
  ds_read_b64_tr_b16 a[176:177], v146 offset:12288
  ds_read_b64_tr_b16 a[178:179], v147 offset:12288
  ds_read_b64_tr_b16 a[180:181], v146 offset:12352
  ds_read_b64_tr_b16 a[182:183], v147 offset:12352
  ds_read_b64_tr_b16 a[184:185], v146 offset:14336
  ds_read_b64_tr_b16 a[186:187], v147 offset:14336
  ds_read_b64_tr_b16 a[188:189], v146 offset:14400
  ds_read_b64_tr_b16 a[190:191], v147 offset:14400
  s_waitcnt lgkmcnt(0)
  s_waitcnt vmcnt(12)
  ds_read_b64_tr_b16 a[192:193], v146 offset:16384
  ds_read_b64_tr_b16 a[194:195], v147 offset:16384
  ds_read_b64_tr_b16 a[196:197], v146 offset:16448
  ds_read_b64_tr_b16 a[198:199], v147 offset:16448
  ds_read_b64_tr_b16 a[200:201], v146 offset:18432
  ds_read_b64_tr_b16 a[202:203], v147 offset:18432
  ds_read_b64_tr_b16 a[204:205], v146 offset:18496
  ds_read_b64_tr_b16 a[206:207], v147 offset:18496
  s_waitcnt lgkmcnt(0)
  s_waitcnt vmcnt(8)
  ds_read_b64_tr_b16 a[208:209], v146 offset:20480
  ds_read_b64_tr_b16 a[210:211], v147 offset:20480
  ds_read_b64_tr_b16 a[212:213], v146 offset:20544
  ds_read_b64_tr_b16 a[214:215], v147 offset:20544
  ds_read_b64_tr_b16 a[216:217], v146 offset:22528
  ds_read_b64_tr_b16 a[218:219], v147 offset:22528
  ds_read_b64_tr_b16 a[220:221], v146 offset:22592
  ds_read_b64_tr_b16 a[222:223], v147 offset:22592
  s_waitcnt lgkmcnt(0)
  s_waitcnt vmcnt(4)
  ds_read_b64_tr_b16 a[224:225], v146 offset:24576
  ds_read_b64_tr_b16 a[226:227], v147 offset:24576
  ds_read_b64_tr_b16 a[228:229], v146 offset:24640
  ds_read_b64_tr_b16 a[230:231], v147 offset:24640
  ds_read_b64_tr_b16 a[232:233], v146 offset:26624
  ds_read_b64_tr_b16 a[234:235], v147 offset:26624
  ds_read_b64_tr_b16 a[236:237], v146 offset:26688
  ds_read_b64_tr_b16 a[238:239], v147 offset:26688
  s_waitcnt lgkmcnt(0)
  s_waitcnt vmcnt(0)
  ds_read_b64_tr_b16 a[240:241], v146 offset:28672
  ds_read_b64_tr_b16 a[242:243], v147 offset:28672
  ds_read_b64_tr_b16 a[244:245], v146 offset:28736
  ds_read_b64_tr_b16 a[246:247], v147 offset:28736
  ds_read_b64_tr_b16 a[248:249], v146 offset:30720
  ds_read_b64_tr_b16 a[250:251], v147 offset:30720
  ds_read_b64_tr_b16 a[252:253], v146 offset:30784
  ds_read_b64_tr_b16 a[254:255], v147 offset:30784
  s_waitcnt lgkmcnt(0)
  v_min_u32 v4, 27, v1
  v_mul_u32_u24 v5, 37, v4
  v_lshrrev_b32 v5, 8, v5
  v_mul_u32_u24 v5, 7, v5
  v_sub_u32 v5, v4, v5
  v_mov_b32 v6, 0x200
  v_cmp_ne_u32 vcc, 6, v5
  s_mul_i32 s76, s48, 3584
  s_add_u32 s76, s76, 148897792
  v_cndmask_b32 v5, 0, v6, vcc
  v_lshl_add_u32 v4, v4, 7, s76
  s_mov_b32 s71, 0
  s_branch M_vg_44
M_vw_43:
  s_sleep 2
  s_add_u32 s71, s71, 1
  s_cmp_gt_u32 s71, 262144
  s_cbranch_scc1 M_exit
M_vg_44:
  buffer_load_dword v6, v4, s[4:7], 0 offen sc1
  s_waitcnt vmcnt(0)
  v_cmp_lt_u32 vcc, v6, v5
  s_cbranch_vccnz M_vw_43
  s_barrier
  s_lshl_b32 s25, s16, 13
  s_add_u32 m0, s25, 0
  s_nop 0
  buffer_load_dwordx4 v16, s[12:15], s19 offen sc1 lds
  s_add_u32 m0, s25, 1024
  s_nop 0
  buffer_load_dwordx4 v17, s[12:15], s19 offen sc1 lds
  s_add_u32 m0, s25, 2048
  s_nop 0
  buffer_load_dwordx4 v18, s[12:15], s19 offen sc1 lds
  s_add_u32 m0, s25, 3072
  s_nop 0
  buffer_load_dwordx4 v19, s[12:15], s19 offen sc1 lds
  s_add_u32 m0, s25, 4096
  s_nop 0
  buffer_load_dwordx4 v20, s[12:15], s19 offen sc1 lds
  s_add_u32 m0, s25, 5120
  s_nop 0
  buffer_load_dwordx4 v21, s[12:15], s19 offen sc1 lds
  s_add_u32 m0, s25, 6144
  s_nop 0
  buffer_load_dwordx4 v22, s[12:15], s19 offen sc1 lds
  s_add_u32 m0, s25, 7168
  s_nop 0
  buffer_load_dwordx4 v23, s[12:15], s19 offen sc1 lds
  s_cmp_gt_u32 s23, 1
  s_cselect_b32 s26, s20, 0
  s_add_u32 s19, s19, s26
  s_add_u32 s25, s25, 32768
  s_and_b32 s25, s25, 0x1ffff
  s_add_u32 m0, s25, 0
  s_nop 0
  buffer_load_dwordx4 v16, s[12:15], s19 offen sc1 lds
  s_add_u32 m0, s25, 1024
  s_nop 0
  buffer_load_dwordx4 v17, s[12:15], s19 offen sc1 lds
  s_add_u32 m0, s25, 2048
  s_nop 0
  buffer_load_dwordx4 v18, s[12:15], s19 offen sc1 lds
  s_add_u32 m0, s25, 3072
  s_nop 0
  buffer_load_dwordx4 v19, s[12:15], s19 offen sc1 lds
  s_add_u32 m0, s25, 4096
  s_nop 0
  buffer_load_dwordx4 v20, s[12:15], s19 offen sc1 lds
  s_add_u32 m0, s25, 5120
  s_nop 0
  buffer_load_dwordx4 v21, s[12:15], s19 offen sc1 lds
  s_add_u32 m0, s25, 6144
  s_nop 0
  buffer_load_dwordx4 v22, s[12:15], s19 offen sc1 lds
  s_add_u32 m0, s25, 7168
  s_nop 0
  buffer_load_dwordx4 v23, s[12:15], s19 offen sc1 lds
  s_cmp_gt_u32 s23, 2
  s_cselect_b32 s26, s20, 0
  s_add_u32 s19, s19, s26
  s_add_u32 s25, s25, 32768
  s_and_b32 s25, s25, 0x1ffff
  s_waitcnt vmcnt(0)
  s_barrier
  s_mov_b32 s27, s21
  v_mov_b32 v7, 0x40000000
  ds_read_b128 v[24:27], v8 offset:0
  ds_read_b128 v[28:31], v9 offset:0
  ds_read_b128 v[32:35], v10 offset:0
  ds_read_b128 v[36:39], v11 offset:0
  ds_read_b128 v[40:43], v12 offset:0
  ds_read_b128 v[44:47], v13 offset:0
.p2align 6
G_top_45:
  s_waitcnt lgkmcnt(5)
  v_mfma_f32_32x32x16_bf16 v[64:79], a[0:3], v[24:27], 0
  s_add_u32 m0, s25, 0
  ds_read_b128 v[48:51], v14 offset:0
  v_mfma_f32_32x32x16_bf16 v[80:95], a[4:7], v[24:27], 0
  s_waitcnt lgkmcnt(5)
  buffer_load_dwordx4 v16, s[12:15], s19 offen sc1 lds
  v_mfma_f32_32x32x16_bf16 v[64:79], a[8:11], v[28:31], v[64:79]
  ds_read_b128 v[52:55], v15 offset:0
  v_mul_f32 v96, s24, v96
  v_mul_f32 v97, s24, v97
  v_mfma_f32_32x32x16_bf16 v[80:95], a[12:15], v[28:31], v[80:95]
  s_waitcnt lgkmcnt(5)
  v_cvt_pk_bf16_f32 v128, v96, v97
  v_mul_f32 v98, s24, v98
  v_mfma_f32_32x32x16_bf16 v[64:79], a[16:19], v[32:35], v[64:79]
  s_add_u32 m0, s25, 1024
  ds_read_b128 v[24:27], v8 offset:8192
  v_mul_f32 v99, s24, v99
  v_cvt_pk_bf16_f32 v129, v98, v99
  v_mfma_f32_32x32x16_bf16 v[80:95], a[20:23], v[32:35], v[80:95]
  s_waitcnt lgkmcnt(5)
  buffer_load_dwordx4 v17, s[12:15], s19 offen sc1 lds
  v_mul_f32 v100, s24, v100
  v_mul_f32 v101, s24, v101
  v_mfma_f32_32x32x16_bf16 v[64:79], a[24:27], v[36:39], v[64:79]
  ds_read_b128 v[28:31], v9 offset:8192
  v_cvt_pk_bf16_f32 v130, v100, v101
  v_mul_f32 v102, s24, v102
  v_mfma_f32_32x32x16_bf16 v[80:95], a[28:31], v[36:39], v[80:95]
  s_waitcnt lgkmcnt(5)
  v_mul_f32 v103, s24, v103
  v_cvt_pk_bf16_f32 v131, v102, v103
  v_mfma_f32_32x32x16_bf16 v[64:79], a[32:35], v[40:43], v[64:79]
  s_add_u32 m0, s25, 2048
  ds_read_b128 v[32:35], v10 offset:8192
  v_mul_f32 v104, s24, v104
  v_mul_f32 v105, s24, v105
  v_mfma_f32_32x32x16_bf16 v[80:95], a[36:39], v[40:43], v[80:95]
  s_waitcnt lgkmcnt(5)
  buffer_load_dwordx4 v18, s[12:15], s19 offen sc1 lds
  v_cvt_pk_bf16_f32 v132, v104, v105
  v_mul_f32 v106, s24, v106
  v_mfma_f32_32x32x16_bf16 v[64:79], a[40:43], v[44:47], v[64:79]
  ds_read_b128 v[36:39], v11 offset:8192
  v_mul_f32 v107, s24, v107
  v_cvt_pk_bf16_f32 v133, v106, v107
  v_mfma_f32_32x32x16_bf16 v[80:95], a[44:47], v[44:47], v[80:95]
  s_waitcnt lgkmcnt(5)
  v_mul_f32 v108, s24, v108
  v_mul_f32 v109, s24, v109
  v_mfma_f32_32x32x16_bf16 v[64:79], a[48:51], v[48:51], v[64:79]
  s_add_u32 m0, s25, 3072
  ds_read_b128 v[40:43], v12 offset:8192
  v_cvt_pk_bf16_f32 v134, v108, v109
  v_mul_f32 v110, s24, v110
  v_mfma_f32_32x32x16_bf16 v[80:95], a[52:55], v[48:51], v[80:95]
  s_waitcnt lgkmcnt(5)
  buffer_load_dwordx4 v19, s[12:15], s19 offen sc1 lds
  v_mul_f32 v111, s24, v111
  v_cvt_pk_bf16_f32 v135, v110, v111
  v_mfma_f32_32x32x16_bf16 v[64:79], a[56:59], v[52:55], v[64:79]
  ds_read_b128 v[44:47], v13 offset:8192
  v_mul_f32 v112, s24, v112
  v_mul_f32 v113, s24, v113
  v_mfma_f32_32x32x16_bf16 v[80:95], a[60:63], v[52:55], v[80:95]
  s_waitcnt lgkmcnt(5)
  v_cvt_pk_bf16_f32 v136, v112, v113
  v_mul_f32 v114, s24, v114
  v_mfma_f32_32x32x16_bf16 v[64:79], a[64:67], v[24:27], v[64:79]
  s_add_u32 m0, s25, 4096
  ds_read_b128 v[48:51], v14 offset:8192
  v_mul_f32 v115, s24, v115
  v_cvt_pk_bf16_f32 v137, v114, v115
  v_mfma_f32_32x32x16_bf16 v[80:95], a[68:71], v[24:27], v[80:95]
  s_waitcnt lgkmcnt(5)
  buffer_load_dwordx4 v20, s[12:15], s19 offen sc1 lds
  v_mul_f32 v116, s24, v116
  v_mul_f32 v117, s24, v117
  v_mfma_f32_32x32x16_bf16 v[64:79], a[72:75], v[28:31], v[64:79]
  ds_read_b128 v[52:55], v15 offset:8192
  v_cvt_pk_bf16_f32 v138, v116, v117
  v_mul_f32 v118, s24, v118
  v_mfma_f32_32x32x16_bf16 v[80:95], a[76:79], v[28:31], v[80:95]
  s_waitcnt lgkmcnt(5)
  v_mul_f32 v119, s24, v119
  v_cvt_pk_bf16_f32 v139, v118, v119
  v_mfma_f32_32x32x16_bf16 v[64:79], a[80:83], v[32:35], v[64:79]
  s_add_u32 m0, s25, 5120
  ds_read_b128 v[24:27], v8 offset:16384
  v_mul_f32 v120, s24, v120
  v_mul_f32 v121, s24, v121
  v_mfma_f32_32x32x16_bf16 v[80:95], a[84:87], v[32:35], v[80:95]
  s_waitcnt lgkmcnt(5)
  buffer_load_dwordx4 v21, s[12:15], s19 offen sc1 lds
  v_cvt_pk_bf16_f32 v140, v120, v121
  v_mul_f32 v122, s24, v122
  v_mfma_f32_32x32x16_bf16 v[64:79], a[88:91], v[36:39], v[64:79]
  ds_read_b128 v[28:31], v9 offset:16384
  v_mul_f32 v123, s24, v123
  v_cvt_pk_bf16_f32 v141, v122, v123
  v_mfma_f32_32x32x16_bf16 v[80:95], a[92:95], v[36:39], v[80:95]
  s_waitcnt lgkmcnt(5)
  v_mul_f32 v124, s24, v124
  v_mul_f32 v125, s24, v125
  v_mfma_f32_32x32x16_bf16 v[64:79], a[96:99], v[40:43], v[64:79]
  s_add_u32 m0, s25, 6144
  ds_read_b128 v[32:35], v10 offset:16384
  v_cvt_pk_bf16_f32 v142, v124, v125
  v_mul_f32 v126, s24, v126
  v_mfma_f32_32x32x16_bf16 v[80:95], a[100:103], v[40:43], v[80:95]
  s_waitcnt lgkmcnt(5)
  buffer_load_dwordx4 v22, s[12:15], s19 offen sc1 lds
  v_mul_f32 v127, s24, v127
  v_cvt_pk_bf16_f32 v143, v126, v127
  v_mfma_f32_32x32x16_bf16 v[64:79], a[104:107], v[44:47], v[64:79]
  ds_read_b128 v[36:39], v11 offset:16384
  v_mfma_f32_32x32x16_bf16 v[80:95], a[108:111], v[44:47], v[80:95]
  s_waitcnt lgkmcnt(5)
  v_mfma_f32_32x32x16_bf16 v[64:79], a[112:115], v[48:51], v[64:79]
  s_add_u32 m0, s25, 7168
  ds_read_b128 v[40:43], v12 offset:16384
  v_mfma_f32_32x32x16_bf16 v[80:95], a[116:119], v[48:51], v[80:95]
  s_waitcnt lgkmcnt(5)
  buffer_load_dwordx4 v23, s[12:15], s19 offen sc1 lds
  v_mfma_f32_32x32x16_bf16 v[64:79], a[120:123], v[52:55], v[64:79]
  s_cmp_gt_u32 s23, 3
  ds_read_b128 v[44:47], v13 offset:16384
  v_mfma_f32_32x32x16_bf16 v[80:95], a[124:127], v[52:55], v[80:95]
  s_waitcnt lgkmcnt(5)
  s_cselect_b32 s26, s20, 0
  v_mfma_f32_32x32x16_bf16 v[64:79], a[128:131], v[24:27], v[64:79]
  s_add_u32 s19, s19, s26
  ds_read_b128 v[48:51], v14 offset:16384
  v_mfma_f32_32x32x16_bf16 v[80:95], a[132:135], v[24:27], v[80:95]
  s_waitcnt lgkmcnt(5)
  s_add_u32 s25, s25, 32768
  v_mfma_f32_32x32x16_bf16 v[64:79], a[136:139], v[28:31], v[64:79]
  s_and_b32 s25, s25, 0x1ffff
  ds_read_b128 v[52:55], v15 offset:16384
  v_mfma_f32_32x32x16_bf16 v[80:95], a[140:143], v[28:31], v[80:95]
  s_waitcnt lgkmcnt(5)
  buffer_store_dwordx4 v[128:131], v7, s[4:7], s21 offen offset:0 sc1
  v_mfma_f32_32x32x16_bf16 v[64:79], a[144:147], v[32:35], v[64:79]
  ds_read_b128 v[24:27], v8 offset:24576
  v_mfma_f32_32x32x16_bf16 v[80:95], a[148:151], v[32:35], v[80:95]
  s_waitcnt lgkmcnt(5)
  v_mfma_f32_32x32x16_bf16 v[64:79], a[152:155], v[36:39], v[64:79]
  ds_read_b128 v[28:31], v9 offset:24576
  v_mfma_f32_32x32x16_bf16 v[80:95], a[156:159], v[36:39], v[80:95]
  s_waitcnt lgkmcnt(5)
  buffer_store_dwordx4 v[132:135], v7, s[4:7], s21 offen offset:1024 sc1
  v_mfma_f32_32x32x16_bf16 v[64:79], a[160:163], v[40:43], v[64:79]
  ds_read_b128 v[32:35], v10 offset:24576
  v_mfma_f32_32x32x16_bf16 v[80:95], a[164:167], v[40:43], v[80:95]
  s_waitcnt lgkmcnt(5)
  v_mfma_f32_32x32x16_bf16 v[64:79], a[168:171], v[44:47], v[64:79]
  ds_read_b128 v[36:39], v11 offset:24576
  v_mfma_f32_32x32x16_bf16 v[80:95], a[172:175], v[44:47], v[80:95]
  s_waitcnt lgkmcnt(5)
  buffer_store_dwordx4 v[136:139], v7, s[4:7], s21 offen offset:2048 sc1
  v_mfma_f32_32x32x16_bf16 v[64:79], a[176:179], v[48:51], v[64:79]
  ds_read_b128 v[40:43], v12 offset:24576
  v_mfma_f32_32x32x16_bf16 v[80:95], a[180:183], v[48:51], v[80:95]
  s_waitcnt lgkmcnt(5)
  v_mfma_f32_32x32x16_bf16 v[64:79], a[184:187], v[52:55], v[64:79]
  ds_read_b128 v[44:47], v13 offset:24576
  v_mfma_f32_32x32x16_bf16 v[80:95], a[188:191], v[52:55], v[80:95]
  s_waitcnt lgkmcnt(5)
  buffer_store_dwordx4 v[140:143], v7, s[4:7], s21 offen offset:3072 sc1
  v_mfma_f32_32x32x16_bf16 v[64:79], a[192:195], v[24:27], v[64:79]
  s_mov_b32 s21, s27
  ds_read_b128 v[48:51], v14 offset:24576
  v_mov_b32 v7, v2
  v_mfma_f32_32x32x16_bf16 v[80:95], a[196:199], v[24:27], v[80:95]
  s_waitcnt lgkmcnt(5)
  v_mfma_f32_32x32x16_bf16 v[64:79], a[200:203], v[28:31], v[64:79]
  s_add_u32 s27, s27, s22
  ds_read_b128 v[52:55], v15 offset:24576
  v_mfma_f32_32x32x16_bf16 v[80:95], a[204:207], v[28:31], v[80:95]
  s_waitcnt lgkmcnt(5)
  s_waitcnt vmcnt(16)
  s_barrier
  v_mfma_f32_32x32x16_bf16 v[64:79], a[208:211], v[32:35], v[64:79]
  ds_read_b128 v[24:27], v8 offset:32768
  v_mfma_f32_32x32x16_bf16 v[80:95], a[212:215], v[32:35], v[80:95]
  s_waitcnt lgkmcnt(5)
  v_mfma_f32_32x32x16_bf16 v[64:79], a[216:219], v[36:39], v[64:79]
  ds_read_b128 v[28:31], v9 offset:32768
  v_mfma_f32_32x32x16_bf16 v[80:95], a[220:223], v[36:39], v[80:95]
  s_waitcnt lgkmcnt(5)
  v_mfma_f32_32x32x16_bf16 v[64:79], a[224:227], v[40:43], v[64:79]
  ds_read_b128 v[32:35], v10 offset:32768
  v_mfma_f32_32x32x16_bf16 v[80:95], a[228:231], v[40:43], v[80:95]
  s_waitcnt lgkmcnt(5)
  v_mfma_f32_32x32x16_bf16 v[64:79], a[232:235], v[44:47], v[64:79]
  ds_read_b128 v[36:39], v11 offset:32768
  v_mfma_f32_32x32x16_bf16 v[80:95], a[236:239], v[44:47], v[80:95]
  s_waitcnt lgkmcnt(5)
  v_mfma_f32_32x32x16_bf16 v[64:79], a[240:243], v[48:51], v[64:79]
  s_sub_u32 s23, s23, 1
  ds_read_b128 v[40:43], v12 offset:32768
  v_mfma_f32_32x32x16_bf16 v[80:95], a[244:247], v[48:51], v[80:95]
  s_waitcnt lgkmcnt(5)
  v_mfma_f32_32x32x16_bf16 v[64:79], a[248:251], v[52:55], v[64:79]
  s_cmp_eq_u32 s23, 0
  ds_read_b128 v[44:47], v13 offset:32768
  v_mfma_f32_32x32x16_bf16 v[80:95], a[252:255], v[52:55], v[80:95]
  s_cbranch_scc1 G_done0_46
  s_waitcnt lgkmcnt(5)
  v_mfma_f32_32x32x16_bf16 v[96:111], a[0:3], v[24:27], 0
  s_add_u32 m0, s25, 0
  ds_read_b128 v[48:51], v14 offset:32768
  v_mfma_f32_32x32x16_bf16 v[112:127], a[4:7], v[24:27], 0
  s_waitcnt lgkmcnt(5)
  buffer_load_dwordx4 v16, s[12:15], s19 offen sc1 lds
  v_mfma_f32_32x32x16_bf16 v[96:111], a[8:11], v[28:31], v[96:111]
  ds_read_b128 v[52:55], v15 offset:32768
  v_mul_f32 v64, s24, v64
  v_mul_f32 v65, s24, v65
  v_mfma_f32_32x32x16_bf16 v[112:127], a[12:15], v[28:31], v[112:127]
  s_waitcnt lgkmcnt(5)
  v_cvt_pk_bf16_f32 v128, v64, v65
  v_mul_f32 v66, s24, v66
  v_mfma_f32_32x32x16_bf16 v[96:111], a[16:19], v[32:35], v[96:111]
  s_add_u32 m0, s25, 1024
  ds_read_b128 v[24:27], v8 offset:40960
  v_mul_f32 v67, s24, v67
  v_cvt_pk_bf16_f32 v129, v66, v67
  v_mfma_f32_32x32x16_bf16 v[112:127], a[20:23], v[32:35], v[112:127]
  s_waitcnt lgkmcnt(5)
  buffer_load_dwordx4 v17, s[12:15], s19 offen sc1 lds
  v_mul_f32 v68, s24, v68
  v_mul_f32 v69, s24, v69
  v_mfma_f32_32x32x16_bf16 v[96:111], a[24:27], v[36:39], v[96:111]
  ds_read_b128 v[28:31], v9 offset:40960
  v_cvt_pk_bf16_f32 v130, v68, v69
  v_mul_f32 v70, s24, v70
  v_mfma_f32_32x32x16_bf16 v[112:127], a[28:31], v[36:39], v[112:127]
  s_waitcnt lgkmcnt(5)
  v_mul_f32 v71, s24, v71
  v_cvt_pk_bf16_f32 v131, v70, v71
  v_mfma_f32_32x32x16_bf16 v[96:111], a[32:35], v[40:43], v[96:111]
  s_add_u32 m0, s25, 2048
  ds_read_b128 v[32:35], v10 offset:40960
  v_mul_f32 v72, s24, v72
  v_mul_f32 v73, s24, v73
  v_mfma_f32_32x32x16_bf16 v[112:127], a[36:39], v[40:43], v[112:127]
  s_waitcnt lgkmcnt(5)
  buffer_load_dwordx4 v18, s[12:15], s19 offen sc1 lds
  v_cvt_pk_bf16_f32 v132, v72, v73
  v_mul_f32 v74, s24, v74
  v_mfma_f32_32x32x16_bf16 v[96:111], a[40:43], v[44:47], v[96:111]
  ds_read_b128 v[36:39], v11 offset:40960
  v_mul_f32 v75, s24, v75
  v_cvt_pk_bf16_f32 v133, v74, v75
  v_mfma_f32_32x32x16_bf16 v[112:127], a[44:47], v[44:47], v[112:127]
  s_waitcnt lgkmcnt(5)
  v_mul_f32 v76, s24, v76
  v_mul_f32 v77, s24, v77
  v_mfma_f32_32x32x16_bf16 v[96:111], a[48:51], v[48:51], v[96:111]
  s_add_u32 m0, s25, 3072
  ds_read_b128 v[40:43], v12 offset:40960
  v_cvt_pk_bf16_f32 v134, v76, v77
  v_mul_f32 v78, s24, v78
  v_mfma_f32_32x32x16_bf16 v[112:127], a[52:55], v[48:51], v[112:127]
  s_waitcnt lgkmcnt(5)
  buffer_load_dwordx4 v19, s[12:15], s19 offen sc1 lds
  v_mul_f32 v79, s24, v79
  v_cvt_pk_bf16_f32 v135, v78, v79
  v_mfma_f32_32x32x16_bf16 v[96:111], a[56:59], v[52:55], v[96:111]
  ds_read_b128 v[44:47], v13 offset:40960
  v_mul_f32 v80, s24, v80
  v_mul_f32 v81, s24, v81
  v_mfma_f32_32x32x16_bf16 v[112:127], a[60:63], v[52:55], v[112:127]
  s_waitcnt lgkmcnt(5)
  v_cvt_pk_bf16_f32 v136, v80, v81
  v_mul_f32 v82, s24, v82
  v_mfma_f32_32x32x16_bf16 v[96:111], a[64:67], v[24:27], v[96:111]
  s_add_u32 m0, s25, 4096
  ds_read_b128 v[48:51], v14 offset:40960
  v_mul_f32 v83, s24, v83
  v_cvt_pk_bf16_f32 v137, v82, v83
  v_mfma_f32_32x32x16_bf16 v[112:127], a[68:71], v[24:27], v[112:127]
  s_waitcnt lgkmcnt(5)
  buffer_load_dwordx4 v20, s[12:15], s19 offen sc1 lds
  v_mul_f32 v84, s24, v84
  v_mul_f32 v85, s24, v85
  v_mfma_f32_32x32x16_bf16 v[96:111], a[72:75], v[28:31], v[96:111]
  ds_read_b128 v[52:55], v15 offset:40960
  v_cvt_pk_bf16_f32 v138, v84, v85
  v_mul_f32 v86, s24, v86
  v_mfma_f32_32x32x16_bf16 v[112:127], a[76:79], v[28:31], v[112:127]
  s_waitcnt lgkmcnt(5)
  v_mul_f32 v87, s24, v87
  v_cvt_pk_bf16_f32 v139, v86, v87
  v_mfma_f32_32x32x16_bf16 v[96:111], a[80:83], v[32:35], v[96:111]
  s_add_u32 m0, s25, 5120
  ds_read_b128 v[24:27], v8 offset:49152
  v_mul_f32 v88, s24, v88
  v_mul_f32 v89, s24, v89
  v_mfma_f32_32x32x16_bf16 v[112:127], a[84:87], v[32:35], v[112:127]
  s_waitcnt lgkmcnt(5)
  buffer_load_dwordx4 v21, s[12:15], s19 offen sc1 lds
  v_cvt_pk_bf16_f32 v140, v88, v89
  v_mul_f32 v90, s24, v90
  v_mfma_f32_32x32x16_bf16 v[96:111], a[88:91], v[36:39], v[96:111]
  ds_read_b128 v[28:31], v9 offset:49152
  v_mul_f32 v91, s24, v91
  v_cvt_pk_bf16_f32 v141, v90, v91
  v_mfma_f32_32x32x16_bf16 v[112:127], a[92:95], v[36:39], v[112:127]
  s_waitcnt lgkmcnt(5)
  v_mul_f32 v92, s24, v92
  v_mul_f32 v93, s24, v93
  v_mfma_f32_32x32x16_bf16 v[96:111], a[96:99], v[40:43], v[96:111]
  s_add_u32 m0, s25, 6144
  ds_read_b128 v[32:35], v10 offset:49152
  v_cvt_pk_bf16_f32 v142, v92, v93
  v_mul_f32 v94, s24, v94
  v_mfma_f32_32x32x16_bf16 v[112:127], a[100:103], v[40:43], v[112:127]
  s_waitcnt lgkmcnt(5)
  buffer_load_dwordx4 v22, s[12:15], s19 offen sc1 lds
  v_mul_f32 v95, s24, v95
  v_cvt_pk_bf16_f32 v143, v94, v95
  v_mfma_f32_32x32x16_bf16 v[96:111], a[104:107], v[44:47], v[96:111]
  ds_read_b128 v[36:39], v11 offset:49152
  v_mfma_f32_32x32x16_bf16 v[112:127], a[108:111], v[44:47], v[112:127]
  s_waitcnt lgkmcnt(5)
  v_mfma_f32_32x32x16_bf16 v[96:111], a[112:115], v[48:51], v[96:111]
  s_add_u32 m0, s25, 7168
  ds_read_b128 v[40:43], v12 offset:49152
  v_mfma_f32_32x32x16_bf16 v[112:127], a[116:119], v[48:51], v[112:127]
  s_waitcnt lgkmcnt(5)
  buffer_load_dwordx4 v23, s[12:15], s19 offen sc1 lds
  v_mfma_f32_32x32x16_bf16 v[96:111], a[120:123], v[52:55], v[96:111]
  s_cmp_gt_u32 s23, 3
  ds_read_b128 v[44:47], v13 offset:49152
  v_mfma_f32_32x32x16_bf16 v[112:127], a[124:127], v[52:55], v[112:127]
  s_waitcnt lgkmcnt(5)
  s_cselect_b32 s26, s20, 0
  v_mfma_f32_32x32x16_bf16 v[96:111], a[128:131], v[24:27], v[96:111]
  s_add_u32 s19, s19, s26
  ds_read_b128 v[48:51], v14 offset:49152
  v_mfma_f32_32x32x16_bf16 v[112:127], a[132:135], v[24:27], v[112:127]
  s_waitcnt lgkmcnt(5)
  s_add_u32 s25, s25, 32768
  v_mfma_f32_32x32x16_bf16 v[96:111], a[136:139], v[28:31], v[96:111]
  s_and_b32 s25, s25, 0x1ffff
  ds_read_b128 v[52:55], v15 offset:49152
  v_mfma_f32_32x32x16_bf16 v[112:127], a[140:143], v[28:31], v[112:127]
  s_waitcnt lgkmcnt(5)
  buffer_store_dwordx4 v[128:131], v7, s[4:7], s21 offen offset:0 sc1
  v_mfma_f32_32x32x16_bf16 v[96:111], a[144:147], v[32:35], v[96:111]
  ds_read_b128 v[24:27], v8 offset:57344
  v_mfma_f32_32x32x16_bf16 v[112:127], a[148:151], v[32:35], v[112:127]
  s_waitcnt lgkmcnt(5)
  v_xor_b32 v8, 0x10000, v8
  v_mfma_f32_32x32x16_bf16 v[96:111], a[152:155], v[36:39], v[96:111]
  ds_read_b128 v[28:31], v9 offset:57344
  v_mfma_f32_32x32x16_bf16 v[112:127], a[156:159], v[36:39], v[112:127]
  s_waitcnt lgkmcnt(5)
  buffer_store_dwordx4 v[132:135], v7, s[4:7], s21 offen offset:1024 sc1
  v_xor_b32 v9, 0x10000, v9
  v_mfma_f32_32x32x16_bf16 v[96:111], a[160:163], v[40:43], v[96:111]
  ds_read_b128 v[32:35], v10 offset:57344
  v_mfma_f32_32x32x16_bf16 v[112:127], a[164:167], v[40:43], v[112:127]
  s_waitcnt lgkmcnt(5)
  v_xor_b32 v10, 0x10000, v10
  v_mfma_f32_32x32x16_bf16 v[96:111], a[168:171], v[44:47], v[96:111]
  ds_read_b128 v[36:39], v11 offset:57344
  v_mfma_f32_32x32x16_bf16 v[112:127], a[172:175], v[44:47], v[112:127]
  s_waitcnt lgkmcnt(5)
  buffer_store_dwordx4 v[136:139], v7, s[4:7], s21 offen offset:2048 sc1
  v_xor_b32 v11, 0x10000, v11
  v_mfma_f32_32x32x16_bf16 v[96:111], a[176:179], v[48:51], v[96:111]
  ds_read_b128 v[40:43], v12 offset:57344
  v_mfma_f32_32x32x16_bf16 v[112:127], a[180:183], v[48:51], v[112:127]
  s_waitcnt lgkmcnt(5)
  v_xor_b32 v12, 0x10000, v12
  v_mfma_f32_32x32x16_bf16 v[96:111], a[184:187], v[52:55], v[96:111]
  ds_read_b128 v[44:47], v13 offset:57344
  v_mfma_f32_32x32x16_bf16 v[112:127], a[188:191], v[52:55], v[112:127]
  s_waitcnt lgkmcnt(5)
  buffer_store_dwordx4 v[140:143], v7, s[4:7], s21 offen offset:3072 sc1
  v_xor_b32 v13, 0x10000, v13
  v_mfma_f32_32x32x16_bf16 v[96:111], a[192:195], v[24:27], v[96:111]
  s_mov_b32 s21, s27
  ds_read_b128 v[48:51], v14 offset:57344
  v_mov_b32 v7, v2
  v_mfma_f32_32x32x16_bf16 v[112:127], a[196:199], v[24:27], v[112:127]
  s_waitcnt lgkmcnt(5)
  v_xor_b32 v14, 0x10000, v14
  v_mfma_f32_32x32x16_bf16 v[96:111], a[200:203], v[28:31], v[96:111]
  s_add_u32 s27, s27, s22
  ds_read_b128 v[52:55], v15 offset:57344
  v_mfma_f32_32x32x16_bf16 v[112:127], a[204:207], v[28:31], v[112:127]
  s_waitcnt lgkmcnt(5)
  s_waitcnt vmcnt(16)
  s_barrier
  v_xor_b32 v15, 0x10000, v15
  v_mfma_f32_32x32x16_bf16 v[96:111], a[208:211], v[32:35], v[96:111]
  ds_read_b128 v[24:27], v8 offset:0
  v_mfma_f32_32x32x16_bf16 v[112:127], a[212:215], v[32:35], v[112:127]
  s_waitcnt lgkmcnt(5)
  v_mfma_f32_32x32x16_bf16 v[96:111], a[216:219], v[36:39], v[96:111]
  ds_read_b128 v[28:31], v9 offset:0
  v_mfma_f32_32x32x16_bf16 v[112:127], a[220:223], v[36:39], v[112:127]
  s_waitcnt lgkmcnt(5)
  v_mfma_f32_32x32x16_bf16 v[96:111], a[224:227], v[40:43], v[96:111]
  ds_read_b128 v[32:35], v10 offset:0
  v_mfma_f32_32x32x16_bf16 v[112:127], a[228:231], v[40:43], v[112:127]
  s_waitcnt lgkmcnt(5)
  v_mfma_f32_32x32x16_bf16 v[96:111], a[232:235], v[44:47], v[96:111]
  ds_read_b128 v[36:39], v11 offset:0
  v_mfma_f32_32x32x16_bf16 v[112:127], a[236:239], v[44:47], v[112:127]
  s_waitcnt lgkmcnt(5)
  v_mfma_f32_32x32x16_bf16 v[96:111], a[240:243], v[48:51], v[96:111]
  s_sub_u32 s23, s23, 1
  ds_read_b128 v[40:43], v12 offset:0
  v_mfma_f32_32x32x16_bf16 v[112:127], a[244:247], v[48:51], v[112:127]
  s_waitcnt lgkmcnt(5)
  v_mfma_f32_32x32x16_bf16 v[96:111], a[248:251], v[52:55], v[96:111]
  s_cmp_eq_u32 s23, 0
  ds_read_b128 v[44:47], v13 offset:0
  v_mfma_f32_32x32x16_bf16 v[112:127], a[252:255], v[52:55], v[112:127]
  s_cbranch_scc1 G_done1_47
  s_branch G_top_45
G_done0_46:
  s_nop 7
  s_nop 3
  v_mul_f32 v64, s24, v64
  v_mul_f32 v65, s24, v65
  v_cvt_pk_bf16_f32 v128, v64, v65
  v_mul_f32 v66, s24, v66
  v_mul_f32 v67, s24, v67
  v_cvt_pk_bf16_f32 v129, v66, v67
  v_mul_f32 v68, s24, v68
  v_mul_f32 v69, s24, v69
  v_cvt_pk_bf16_f32 v130, v68, v69
  v_mul_f32 v70, s24, v70
  v_mul_f32 v71, s24, v71
  v_cvt_pk_bf16_f32 v131, v70, v71
  buffer_store_dwordx4 v[128:131], v7, s[4:7], s21 offen offset:0 sc1
  v_mul_f32 v72, s24, v72
  v_mul_f32 v73, s24, v73
  v_cvt_pk_bf16_f32 v132, v72, v73
  v_mul_f32 v74, s24, v74
  v_mul_f32 v75, s24, v75
  v_cvt_pk_bf16_f32 v133, v74, v75
  v_mul_f32 v76, s24, v76
  v_mul_f32 v77, s24, v77
  v_cvt_pk_bf16_f32 v134, v76, v77
  v_mul_f32 v78, s24, v78
  v_mul_f32 v79, s24, v79
  v_cvt_pk_bf16_f32 v135, v78, v79
  buffer_store_dwordx4 v[132:135], v7, s[4:7], s21 offen offset:1024 sc1
  v_mul_f32 v80, s24, v80
  v_mul_f32 v81, s24, v81
  v_cvt_pk_bf16_f32 v136, v80, v81
  v_mul_f32 v82, s24, v82
  v_mul_f32 v83, s24, v83
  v_cvt_pk_bf16_f32 v137, v82, v83
  v_mul_f32 v84, s24, v84
  v_mul_f32 v85, s24, v85
  v_cvt_pk_bf16_f32 v138, v84, v85
  v_mul_f32 v86, s24, v86
  v_mul_f32 v87, s24, v87
  v_cvt_pk_bf16_f32 v139, v86, v87
  buffer_store_dwordx4 v[136:139], v7, s[4:7], s21 offen offset:2048 sc1
  v_mul_f32 v88, s24, v88
  v_mul_f32 v89, s24, v89
  v_cvt_pk_bf16_f32 v140, v88, v89
  v_mul_f32 v90, s24, v90
  v_mul_f32 v91, s24, v91
  v_cvt_pk_bf16_f32 v141, v90, v91
  v_mul_f32 v92, s24, v92
  v_mul_f32 v93, s24, v93
  v_cvt_pk_bf16_f32 v142, v92, v93
  v_mul_f32 v94, s24, v94
  v_mul_f32 v95, s24, v95
  v_cvt_pk_bf16_f32 v143, v94, v95
  buffer_store_dwordx4 v[140:143], v7, s[4:7], s21 offen offset:3072 sc1
  s_branch G_fin_48
G_done1_47:
  s_nop 7
  s_nop 3
  v_mul_f32 v96, s24, v96
  v_mul_f32 v97, s24, v97
  v_cvt_pk_bf16_f32 v128, v96, v97
  v_mul_f32 v98, s24, v98
  v_mul_f32 v99, s24, v99
  v_cvt_pk_bf16_f32 v129, v98, v99
  v_mul_f32 v100, s24, v100
  v_mul_f32 v101, s24, v101
  v_cvt_pk_bf16_f32 v130, v100, v101
  v_mul_f32 v102, s24, v102
  v_mul_f32 v103, s24, v103
  v_cvt_pk_bf16_f32 v131, v102, v103
  buffer_store_dwordx4 v[128:131], v7, s[4:7], s21 offen offset:0 sc1
  v_mul_f32 v104, s24, v104
  v_mul_f32 v105, s24, v105
  v_cvt_pk_bf16_f32 v132, v104, v105
  v_mul_f32 v106, s24, v106
  v_mul_f32 v107, s24, v107
  v_cvt_pk_bf16_f32 v133, v106, v107
  v_mul_f32 v108, s24, v108
  v_mul_f32 v109, s24, v109
  v_cvt_pk_bf16_f32 v134, v108, v109
  v_mul_f32 v110, s24, v110
  v_mul_f32 v111, s24, v111
  v_cvt_pk_bf16_f32 v135, v110, v111
  buffer_store_dwordx4 v[132:135], v7, s[4:7], s21 offen offset:1024 sc1
  v_mul_f32 v112, s24, v112
  v_mul_f32 v113, s24, v113
  v_cvt_pk_bf16_f32 v136, v112, v113
  v_mul_f32 v114, s24, v114
  v_mul_f32 v115, s24, v115
  v_cvt_pk_bf16_f32 v137, v114, v115
  v_mul_f32 v116, s24, v116
  v_mul_f32 v117, s24, v117
  v_cvt_pk_bf16_f32 v138, v116, v117
  v_mul_f32 v118, s24, v118
  v_mul_f32 v119, s24, v119
  v_cvt_pk_bf16_f32 v139, v118, v119
  buffer_store_dwordx4 v[136:139], v7, s[4:7], s21 offen offset:2048 sc1
  v_mul_f32 v120, s24, v120
  v_mul_f32 v121, s24, v121
  v_cvt_pk_bf16_f32 v140, v120, v121
  v_mul_f32 v122, s24, v122
  v_mul_f32 v123, s24, v123
  v_cvt_pk_bf16_f32 v141, v122, v123
  v_mul_f32 v124, s24, v124
  v_mul_f32 v125, s24, v125
  v_cvt_pk_bf16_f32 v142, v124, v125
  v_mul_f32 v126, s24, v126
  v_mul_f32 v127, s24, v127
  v_cvt_pk_bf16_f32 v143, v126, v127
  buffer_store_dwordx4 v[140:143], v7, s[4:7], s21 offen offset:3072 sc1
G_fin_48:
  s_waitcnt vmcnt(0) lgkmcnt(0)
  s_barrier
  s_waitcnt vmcnt(0)
  s_barrier
  s_mov_b32 s30, 768
  v_mov_b32 v144, s30
  v_min_u32 v145, 1, v0
  v_lshlrev_b32 v145, 30, v145
  buffer_store_dword v144, v145, s[4:7], s31 offen sc1
  s_mul_i32 s50, s64, 6
  s_add_u32 s50, s50, s65
  s_mul_i32 s76, s50, 21846
  s_lshr_b32 s76, s76, 16
  s_mul_i32 s77, s76, 3
  s_add_u32 s51, s50, 64
  s_cmp_eq_u32 s77, s50
  s_cselect_b32 s50, s76, s51
M_fin:
  s_lshr_b32 s48, s50, 2
  s_and_b32 s49, s50, 3
  s_load_dwordx2 s[8:9], s[0:1], 0
  s_load_dwordx2 s[12:13], s[0:1], 104
  s_load_dwordx2 s[32:33], s[0:1], 112
  v_and_b32 v4, 31, v1
  v_lshrrev_b32 v5, 5, v1
  v_lshlrev_b32 v5, 4, v5
  v_lshl_add_u32 v6, v4, 10, v5
  s_lshl_b32 s26, s16, 8
  s_lshl_b32 s27, s48, 15
  s_add_u32 s27, s27, s26
  s_waitcnt lgkmcnt(0)
  s_and_b32 s9, s9, 0xffff
  s_mov_b32 s10, 2097152
  s_mov_b32 s11, 0x20000
  s_and_b32 s13, s13, 0xffff
  s_mov_b32 s14, 1024
  s_mov_b32 s15, 0x20000
  s_and_b32 s33, s33, 0xffff
  s_mov_b32 s34, 2097152
  s_mov_b32 s35, 0x20000
  buffer_load_dwordx4 v[16:19], v6, s[8:11], s27 offen offset:0
  buffer_load_dwordx4 v[48:51], v5, s[12:15], s26 offen offset:0
  buffer_load_dwordx4 v[20:23], v6, s[8:11], s27 offen offset:32
  buffer_load_dwordx4 v[52:55], v5, s[12:15], s26 offen offset:32
  buffer_load_dwordx4 v[24:27], v6, s[8:11], s27 offen offset:64
  buffer_load_dwordx4 v[56:59], v5, s[12:15], s26 offen offset:64
  buffer_load_dwordx4 v[28:31], v6, s[8:11], s27 offen offset:96
  buffer_load_dwordx4 v[60:63], v5, s[12:15], s26 offen offset:96
  buffer_load_dwordx4 v[32:35], v6, s[8:11], s27 offen offset:128
  buffer_load_dwordx4 v[64:67], v5, s[12:15], s26 offen offset:128
  buffer_load_dwordx4 v[36:39], v6, s[8:11], s27 offen offset:160
  buffer_load_dwordx4 v[68:71], v5, s[12:15], s26 offen offset:160
  buffer_load_dwordx4 v[40:43], v6, s[8:11], s27 offen offset:192
  buffer_load_dwordx4 v[72:75], v5, s[12:15], s26 offen offset:192
  buffer_load_dwordx4 v[44:47], v6, s[8:11], s27 offen offset:224
  buffer_load_dwordx4 v[76:79], v5, s[12:15], s26 offen offset:224
  s_lshl_b32 s28, s48, 2
  s_add_u32 s28, s28, s49
  s_lshl_b32 s28, s28, 2
  s_add_u32 s28, s28, s16
  s_lshl_b32 s28, s28, 11
  s_waitcnt vmcnt(14)
  v_mfma_f32_32x32x16_bf16 v[80:95], v[48:51], v[16:19], 0
  s_waitcnt vmcnt(12)
  v_mfma_f32_32x32x16_bf16 v[80:95], v[52:55], v[20:23], v[80:95]
  s_waitcnt vmcnt(10)
  v_mfma_f32_32x32x16_bf16 v[80:95], v[56:59], v[24:27], v[80:95]
  s_waitcnt vmcnt(8)
  v_mfma_f32_32x32x16_bf16 v[80:95], v[60:63], v[28:31], v[80:95]
  s_waitcnt vmcnt(6)
  v_mfma_f32_32x32x16_bf16 v[80:95], v[64:67], v[32:35], v[80:95]
  s_waitcnt vmcnt(4)
  v_mfma_f32_32x32x16_bf16 v[80:95], v[68:71], v[36:39], v[80:95]
  s_waitcnt vmcnt(2)
  v_mfma_f32_32x32x16_bf16 v[80:95], v[72:75], v[40:43], v[80:95]
  s_waitcnt vmcnt(0)
  v_mfma_f32_32x32x16_bf16 v[80:95], v[76:79], v[44:47], v[80:95]
  s_mul_i32 s76, s48, 43
  s_lshr_b32 s76, s76, 9
  s_mul_i32 s76, s76, 12
  s_sub_u32 s76, s48, s76
  s_cmp_ge_u32 s76, 6
  s_addc_u32 s76, s76, 0
  s_and_b32 s77, s49, 2
  s_mul_i32 s77, s77, 7
  s_add_u32 s76, s76, s77
  v_mov_b32 v193, 0x300
  s_lshl_b32 s76, s76, 7
  s_add_u32 s76, s76, 148897792
  v_and_b32 v192, 7, v1
  v_mul_u32_u24 v192, 3584, v192
  v_add_u32 v192, s76, v192
  s_mov_b32 s71, 0
  s_branch M_vg_50
M_vw_49:
  s_sleep 2
  s_add_u32 s71, s71, 1
  s_cmp_gt_u32 s71, 262144
  s_cbranch_scc1 M_exit
M_vg_50:
  buffer_load_dword v194, v192, s[4:7], 0 offen sc1
  s_waitcnt vmcnt(0)
  v_cmp_lt_u32 vcc, v194, v193
  s_cbranch_vccnz M_vw_49
  s_add_u32 s29, s28, 150994944
  buffer_load_dwordx4 v[96:99], v2, s[4:7], s29 offen offset:0 sc1
  buffer_load_dwordx4 v[100:103], v2, s[4:7], s29 offen offset:1024 sc1
  s_add_u32 s29, s28, 153092096
  buffer_load_dwordx4 v[104:107], v2, s[4:7], s29 offen offset:0 sc1
  buffer_load_dwordx4 v[108:111], v2, s[4:7], s29 offen offset:1024 sc1
  s_add_u32 s29, s28, 155189248
  buffer_load_dwordx4 v[112:115], v2, s[4:7], s29 offen offset:0 sc1
  buffer_load_dwordx4 v[116:119], v2, s[4:7], s29 offen offset:1024 sc1
  s_add_u32 s29, s28, 157286400
  buffer_load_dwordx4 v[120:123], v2, s[4:7], s29 offen offset:0 sc1
  buffer_load_dwordx4 v[124:127], v2, s[4:7], s29 offen offset:1024 sc1
  s_add_u32 s29, s28, 159383552
  buffer_load_dwordx4 v[128:131], v2, s[4:7], s29 offen offset:0 sc1
  buffer_load_dwordx4 v[132:135], v2, s[4:7], s29 offen offset:1024 sc1
  s_add_u32 s29, s28, 161480704
  buffer_load_dwordx4 v[136:139], v2, s[4:7], s29 offen offset:0 sc1
  buffer_load_dwordx4 v[140:143], v2, s[4:7], s29 offen offset:1024 sc1
  s_add_u32 s29, s28, 163577856
  buffer_load_dwordx4 v[144:147], v2, s[4:7], s29 offen offset:0 sc1
  buffer_load_dwordx4 v[148:151], v2, s[4:7], s29 offen offset:1024 sc1
  s_add_u32 s29, s28, 165675008
  buffer_load_dwordx4 v[152:155], v2, s[4:7], s29 offen offset:0 sc1
  buffer_load_dwordx4 v[156:159], v2, s[4:7], s29 offen offset:1024 sc1
  v_lshlrev_b32 v7, 4, v4
  s_lshl_b32 s26, s16, 2
  v_add_u32 v4, s26, v7
  s_barrier
  ds_write_b32 v4, v80
  s_waitcnt lgkmcnt(0)
  s_barrier
  ds_read_b128 v[84:87], v7
  s_waitcnt lgkmcnt(0)
  v_add_f32 v80, v84, v85
  v_add_f32 v81, v86, v87
  v_add_f32 v80, v80, v81
  v_mul_f32 v80, 0xbfb8aa3b, v80
  v_exp_f32 v80, v80
  s_nop 0
  v_add_f32 v80, 1.0, v80
  v_rcp_f32 v80, v80
  s_nop 0
  v_sub_f32 v82, 1.0, v80
  s_waitcnt vmcnt(14)
  v_lshlrev_b32 v160, 16, v96
  v_and_b32 v161, 0xffff0000, v96
  v_lshlrev_b32 v162, 16, v97
  v_and_b32 v163, 0xffff0000, v97
  v_lshlrev_b32 v164, 16, v98
  v_and_b32 v165, 0xffff0000, v98
  v_lshlrev_b32 v166, 16, v99
  v_and_b32 v167, 0xffff0000, v99
  v_lshlrev_b32 v168, 16, v100
  v_and_b32 v169, 0xffff0000, v100
  v_lshlrev_b32 v170, 16, v101
  v_and_b32 v171, 0xffff0000, v101
  v_lshlrev_b32 v172, 16, v102
  v_and_b32 v173, 0xffff0000, v102
  v_lshlrev_b32 v174, 16, v103
  v_and_b32 v175, 0xffff0000, v103
  s_waitcnt vmcnt(12)
  v_lshlrev_b32 v8, 16, v104
  v_and_b32 v9, 0xffff0000, v104
  v_pk_add_f32 v[160:161], v[160:161], v[8:9]
  v_lshlrev_b32 v10, 16, v105
  v_and_b32 v11, 0xffff0000, v105
  v_pk_add_f32 v[162:163], v[162:163], v[10:11]
  v_lshlrev_b32 v12, 16, v106
  v_and_b32 v13, 0xffff0000, v106
  v_pk_add_f32 v[164:165], v[164:165], v[12:13]
  v_lshlrev_b32 v14, 16, v107
  v_and_b32 v15, 0xffff0000, v107
  v_pk_add_f32 v[166:167], v[166:167], v[14:15]
  v_lshlrev_b32 v8, 16, v108
  v_and_b32 v9, 0xffff0000, v108
  v_pk_add_f32 v[168:169], v[168:169], v[8:9]
  v_lshlrev_b32 v10, 16, v109
  v_and_b32 v11, 0xffff0000, v109
  v_pk_add_f32 v[170:171], v[170:171], v[10:11]
  v_lshlrev_b32 v12, 16, v110
  v_and_b32 v13, 0xffff0000, v110
  v_pk_add_f32 v[172:173], v[172:173], v[12:13]
  v_lshlrev_b32 v14, 16, v111
  v_and_b32 v15, 0xffff0000, v111
  v_pk_add_f32 v[174:175], v[174:175], v[14:15]
  s_waitcnt vmcnt(10)
  v_lshlrev_b32 v8, 16, v112
  v_and_b32 v9, 0xffff0000, v112
  v_pk_add_f32 v[160:161], v[160:161], v[8:9]
  v_lshlrev_b32 v10, 16, v113
  v_and_b32 v11, 0xffff0000, v113
  v_pk_add_f32 v[162:163], v[162:163], v[10:11]
  v_lshlrev_b32 v12, 16, v114
  v_and_b32 v13, 0xffff0000, v114
  v_pk_add_f32 v[164:165], v[164:165], v[12:13]
  v_lshlrev_b32 v14, 16, v115
  v_and_b32 v15, 0xffff0000, v115
  v_pk_add_f32 v[166:167], v[166:167], v[14:15]
  v_lshlrev_b32 v8, 16, v116
  v_and_b32 v9, 0xffff0000, v116
  v_pk_add_f32 v[168:169], v[168:169], v[8:9]
  v_lshlrev_b32 v10, 16, v117
  v_and_b32 v11, 0xffff0000, v117
  v_pk_add_f32 v[170:171], v[170:171], v[10:11]
  v_lshlrev_b32 v12, 16, v118
  v_and_b32 v13, 0xffff0000, v118
  v_pk_add_f32 v[172:173], v[172:173], v[12:13]
  v_lshlrev_b32 v14, 16, v119
  v_and_b32 v15, 0xffff0000, v119
  v_pk_add_f32 v[174:175], v[174:175], v[14:15]
  s_waitcnt vmcnt(8)
  v_lshlrev_b32 v8, 16, v120
  v_and_b32 v9, 0xffff0000, v120
  v_pk_add_f32 v[160:161], v[160:161], v[8:9]
  v_lshlrev_b32 v10, 16, v121
  v_and_b32 v11, 0xffff0000, v121
  v_pk_add_f32 v[162:163], v[162:163], v[10:11]
  v_lshlrev_b32 v12, 16, v122
  v_and_b32 v13, 0xffff0000, v122
  v_pk_add_f32 v[164:165], v[164:165], v[12:13]
  v_lshlrev_b32 v14, 16, v123
  v_and_b32 v15, 0xffff0000, v123
  v_pk_add_f32 v[166:167], v[166:167], v[14:15]
  v_lshlrev_b32 v8, 16, v124
  v_and_b32 v9, 0xffff0000, v124
  v_pk_add_f32 v[168:169], v[168:169], v[8:9]
  v_lshlrev_b32 v10, 16, v125
  v_and_b32 v11, 0xffff0000, v125
  v_pk_add_f32 v[170:171], v[170:171], v[10:11]
  v_lshlrev_b32 v12, 16, v126
  v_and_b32 v13, 0xffff0000, v126
  v_pk_add_f32 v[172:173], v[172:173], v[12:13]
  v_lshlrev_b32 v14, 16, v127
  v_and_b32 v15, 0xffff0000, v127
  v_pk_add_f32 v[174:175], v[174:175], v[14:15]
  s_waitcnt vmcnt(6)
  v_lshlrev_b32 v8, 16, v128
  v_and_b32 v9, 0xffff0000, v128
  v_pk_add_f32 v[160:161], v[160:161], v[8:9]
  v_lshlrev_b32 v10, 16, v129
  v_and_b32 v11, 0xffff0000, v129
  v_pk_add_f32 v[162:163], v[162:163], v[10:11]
  v_lshlrev_b32 v12, 16, v130
  v_and_b32 v13, 0xffff0000, v130
  v_pk_add_f32 v[164:165], v[164:165], v[12:13]
  v_lshlrev_b32 v14, 16, v131
  v_and_b32 v15, 0xffff0000, v131
  v_pk_add_f32 v[166:167], v[166:167], v[14:15]
  v_lshlrev_b32 v8, 16, v132
  v_and_b32 v9, 0xffff0000, v132
  v_pk_add_f32 v[168:169], v[168:169], v[8:9]
  v_lshlrev_b32 v10, 16, v133
  v_and_b32 v11, 0xffff0000, v133
  v_pk_add_f32 v[170:171], v[170:171], v[10:11]
  v_lshlrev_b32 v12, 16, v134
  v_and_b32 v13, 0xffff0000, v134
  v_pk_add_f32 v[172:173], v[172:173], v[12:13]
  v_lshlrev_b32 v14, 16, v135
  v_and_b32 v15, 0xffff0000, v135
  v_pk_add_f32 v[174:175], v[174:175], v[14:15]
  s_waitcnt vmcnt(4)
  v_lshlrev_b32 v8, 16, v136
  v_and_b32 v9, 0xffff0000, v136
  v_pk_add_f32 v[160:161], v[160:161], v[8:9]
  v_lshlrev_b32 v10, 16, v137
  v_and_b32 v11, 0xffff0000, v137
  v_pk_add_f32 v[162:163], v[162:163], v[10:11]
  v_lshlrev_b32 v12, 16, v138
  v_and_b32 v13, 0xffff0000, v138
  v_pk_add_f32 v[164:165], v[164:165], v[12:13]
  v_lshlrev_b32 v14, 16, v139
  v_and_b32 v15, 0xffff0000, v139
  v_pk_add_f32 v[166:167], v[166:167], v[14:15]
  v_lshlrev_b32 v8, 16, v140
  v_and_b32 v9, 0xffff0000, v140
  v_pk_add_f32 v[168:169], v[168:169], v[8:9]
  v_lshlrev_b32 v10, 16, v141
  v_and_b32 v11, 0xffff0000, v141
  v_pk_add_f32 v[170:171], v[170:171], v[10:11]
  v_lshlrev_b32 v12, 16, v142
  v_and_b32 v13, 0xffff0000, v142
  v_pk_add_f32 v[172:173], v[172:173], v[12:13]
  v_lshlrev_b32 v14, 16, v143
  v_and_b32 v15, 0xffff0000, v143
  v_pk_add_f32 v[174:175], v[174:175], v[14:15]
  s_waitcnt vmcnt(2)
  v_lshlrev_b32 v8, 16, v144
  v_and_b32 v9, 0xffff0000, v144
  v_pk_add_f32 v[160:161], v[160:161], v[8:9]
  v_lshlrev_b32 v10, 16, v145
  v_and_b32 v11, 0xffff0000, v145
  v_pk_add_f32 v[162:163], v[162:163], v[10:11]
  v_lshlrev_b32 v12, 16, v146
  v_and_b32 v13, 0xffff0000, v146
  v_pk_add_f32 v[164:165], v[164:165], v[12:13]
  v_lshlrev_b32 v14, 16, v147
  v_and_b32 v15, 0xffff0000, v147
  v_pk_add_f32 v[166:167], v[166:167], v[14:15]
  v_lshlrev_b32 v8, 16, v148
  v_and_b32 v9, 0xffff0000, v148
  v_pk_add_f32 v[168:169], v[168:169], v[8:9]
  v_lshlrev_b32 v10, 16, v149
  v_and_b32 v11, 0xffff0000, v149
  v_pk_add_f32 v[170:171], v[170:171], v[10:11]
  v_lshlrev_b32 v12, 16, v150
  v_and_b32 v13, 0xffff0000, v150
  v_pk_add_f32 v[172:173], v[172:173], v[12:13]
  v_lshlrev_b32 v14, 16, v151
  v_and_b32 v15, 0xffff0000, v151
  v_pk_add_f32 v[174:175], v[174:175], v[14:15]
  s_waitcnt vmcnt(0)
  v_lshlrev_b32 v8, 16, v152
  v_and_b32 v9, 0xffff0000, v152
  v_pk_add_f32 v[160:161], v[160:161], v[8:9]
  v_lshlrev_b32 v10, 16, v153
  v_and_b32 v11, 0xffff0000, v153
  v_pk_add_f32 v[162:163], v[162:163], v[10:11]
  v_lshlrev_b32 v12, 16, v154
  v_and_b32 v13, 0xffff0000, v154
  v_pk_add_f32 v[164:165], v[164:165], v[12:13]
  v_lshlrev_b32 v14, 16, v155
  v_and_b32 v15, 0xffff0000, v155
  v_pk_add_f32 v[166:167], v[166:167], v[14:15]
  v_lshlrev_b32 v8, 16, v156
  v_and_b32 v9, 0xffff0000, v156
  v_pk_add_f32 v[168:169], v[168:169], v[8:9]
  v_lshlrev_b32 v10, 16, v157
  v_and_b32 v11, 0xffff0000, v157
  v_pk_add_f32 v[170:171], v[170:171], v[10:11]
  v_lshlrev_b32 v12, 16, v158
  v_and_b32 v13, 0xffff0000, v158
  v_pk_add_f32 v[172:173], v[172:173], v[12:13]
  v_lshlrev_b32 v14, 16, v159
  v_and_b32 v15, 0xffff0000, v159
  v_pk_add_f32 v[174:175], v[174:175], v[14:15]
  s_and_b32 s76, s48, 1
  s_lshl_b32 s76, s76, 1
  s_lshr_b32 s77, s49, 1
  s_add_u32 s76, s76, s77
  s_mul_i32 s76, s76, 7
  s_add_u32 s76, s76, 6
  s_lshr_b32 s77, s48, 1
  s_add_u32 s77, s77, 0x201
  v_mov_b32 v193, s77
  s_lshl_b32 s76, s76, 7
  s_add_u32 s76, s76, 148897792
  v_and_b32 v192, 7, v1
  v_mul_u32_u24 v192, 3584, v192
  v_add_u32 v192, s76, v192
  s_mov_b32 s71, 0
  s_branch M_vg_52
M_vw_51:
  s_sleep 2
  s_add_u32 s71, s71, 1
  s_cmp_gt_u32 s71, 262144
  s_cbranch_scc1 M_exit
M_vg_52:
  buffer_load_dword v194, v192, s[4:7], 0 offen sc1
  s_waitcnt vmcnt(0)
  v_cmp_lt_u32 vcc, v194, v193
  s_cbranch_vccnz M_vw_51
  s_add_u32 s29, s28, 167772160
  buffer_load_dwordx4 v[96:99], v2, s[4:7], s29 offen offset:0 sc1
  buffer_load_dwordx4 v[100:103], v2, s[4:7], s29 offen offset:1024 sc1
  s_add_u32 s29, s28, 169869312
  buffer_load_dwordx4 v[104:107], v2, s[4:7], s29 offen offset:0 sc1
  buffer_load_dwordx4 v[108:111], v2, s[4:7], s29 offen offset:1024 sc1
  s_add_u32 s29, s28, 171966464
  buffer_load_dwordx4 v[112:115], v2, s[4:7], s29 offen offset:0 sc1
  buffer_load_dwordx4 v[116:119], v2, s[4:7], s29 offen offset:1024 sc1
  s_add_u32 s29, s28, 174063616
  buffer_load_dwordx4 v[120:123], v2, s[4:7], s29 offen offset:0 sc1
  buffer_load_dwordx4 v[124:127], v2, s[4:7], s29 offen offset:1024 sc1
  s_add_u32 s29, s28, 176160768
  buffer_load_dwordx4 v[128:131], v2, s[4:7], s29 offen offset:0 sc1
  buffer_load_dwordx4 v[132:135], v2, s[4:7], s29 offen offset:1024 sc1
  s_add_u32 s29, s28, 178257920
  buffer_load_dwordx4 v[136:139], v2, s[4:7], s29 offen offset:0 sc1
  buffer_load_dwordx4 v[140:143], v2, s[4:7], s29 offen offset:1024 sc1
  s_add_u32 s29, s28, 180355072
  buffer_load_dwordx4 v[144:147], v2, s[4:7], s29 offen offset:0 sc1
  buffer_load_dwordx4 v[148:151], v2, s[4:7], s29 offen offset:1024 sc1
  s_add_u32 s29, s28, 182452224
  buffer_load_dwordx4 v[152:155], v2, s[4:7], s29 offen offset:0 sc1
  buffer_load_dwordx4 v[156:159], v2, s[4:7], s29 offen offset:1024 sc1
  v_pk_mul_f32 v[160:161], v[160:161], v[80:81] op_sel_hi:[1,0]
  v_pk_mul_f32 v[162:163], v[162:163], v[80:81] op_sel_hi:[1,0]
  v_pk_mul_f32 v[164:165], v[164:165], v[80:81] op_sel_hi:[1,0]
  v_pk_mul_f32 v[166:167], v[166:167], v[80:81] op_sel_hi:[1,0]
  v_pk_mul_f32 v[168:169], v[168:169], v[80:81] op_sel_hi:[1,0]
  v_pk_mul_f32 v[170:171], v[170:171], v[80:81] op_sel_hi:[1,0]
  v_pk_mul_f32 v[172:173], v[172:173], v[80:81] op_sel_hi:[1,0]
  v_pk_mul_f32 v[174:175], v[174:175], v[80:81] op_sel_hi:[1,0]
  s_waitcnt vmcnt(14)
  v_lshlrev_b32 v176, 16, v96
  v_and_b32 v177, 0xffff0000, v96
  v_lshlrev_b32 v178, 16, v97
  v_and_b32 v179, 0xffff0000, v97
  v_lshlrev_b32 v180, 16, v98
  v_and_b32 v181, 0xffff0000, v98
  v_lshlrev_b32 v182, 16, v99
  v_and_b32 v183, 0xffff0000, v99
  v_lshlrev_b32 v184, 16, v100
  v_and_b32 v185, 0xffff0000, v100
  v_lshlrev_b32 v186, 16, v101
  v_and_b32 v187, 0xffff0000, v101
  v_lshlrev_b32 v188, 16, v102
  v_and_b32 v189, 0xffff0000, v102
  v_lshlrev_b32 v190, 16, v103
  v_and_b32 v191, 0xffff0000, v103
  s_waitcnt vmcnt(12)
  v_lshlrev_b32 v8, 16, v104
  v_and_b32 v9, 0xffff0000, v104
  v_pk_add_f32 v[176:177], v[176:177], v[8:9]
  v_lshlrev_b32 v10, 16, v105
  v_and_b32 v11, 0xffff0000, v105
  v_pk_add_f32 v[178:179], v[178:179], v[10:11]
  v_lshlrev_b32 v12, 16, v106
  v_and_b32 v13, 0xffff0000, v106
  v_pk_add_f32 v[180:181], v[180:181], v[12:13]
  v_lshlrev_b32 v14, 16, v107
  v_and_b32 v15, 0xffff0000, v107
  v_pk_add_f32 v[182:183], v[182:183], v[14:15]
  v_lshlrev_b32 v8, 16, v108
  v_and_b32 v9, 0xffff0000, v108
  v_pk_add_f32 v[184:185], v[184:185], v[8:9]
  v_lshlrev_b32 v10, 16, v109
  v_and_b32 v11, 0xffff0000, v109
  v_pk_add_f32 v[186:187], v[186:187], v[10:11]
  v_lshlrev_b32 v12, 16, v110
  v_and_b32 v13, 0xffff0000, v110
  v_pk_add_f32 v[188:189], v[188:189], v[12:13]
  v_lshlrev_b32 v14, 16, v111
  v_and_b32 v15, 0xffff0000, v111
  v_pk_add_f32 v[190:191], v[190:191], v[14:15]
  s_waitcnt vmcnt(10)
  v_lshlrev_b32 v8, 16, v112
  v_and_b32 v9, 0xffff0000, v112
  v_pk_add_f32 v[176:177], v[176:177], v[8:9]
  v_lshlrev_b32 v10, 16, v113
  v_and_b32 v11, 0xffff0000, v113
  v_pk_add_f32 v[178:179], v[178:179], v[10:11]
  v_lshlrev_b32 v12, 16, v114
  v_and_b32 v13, 0xffff0000, v114
  v_pk_add_f32 v[180:181], v[180:181], v[12:13]
  v_lshlrev_b32 v14, 16, v115
  v_and_b32 v15, 0xffff0000, v115
  v_pk_add_f32 v[182:183], v[182:183], v[14:15]
  v_lshlrev_b32 v8, 16, v116
  v_and_b32 v9, 0xffff0000, v116
  v_pk_add_f32 v[184:185], v[184:185], v[8:9]
  v_lshlrev_b32 v10, 16, v117
  v_and_b32 v11, 0xffff0000, v117
  v_pk_add_f32 v[186:187], v[186:187], v[10:11]
  v_lshlrev_b32 v12, 16, v118
  v_and_b32 v13, 0xffff0000, v118
  v_pk_add_f32 v[188:189], v[188:189], v[12:13]
  v_lshlrev_b32 v14, 16, v119
  v_and_b32 v15, 0xffff0000, v119
  v_pk_add_f32 v[190:191], v[190:191], v[14:15]
  s_waitcnt vmcnt(8)
  v_lshlrev_b32 v8, 16, v120
  v_and_b32 v9, 0xffff0000, v120
  v_pk_add_f32 v[176:177], v[176:177], v[8:9]
  v_lshlrev_b32 v10, 16, v121
  v_and_b32 v11, 0xffff0000, v121
  v_pk_add_f32 v[178:179], v[178:179], v[10:11]
  v_lshlrev_b32 v12, 16, v122
  v_and_b32 v13, 0xffff0000, v122
  v_pk_add_f32 v[180:181], v[180:181], v[12:13]
  v_lshlrev_b32 v14, 16, v123
  v_and_b32 v15, 0xffff0000, v123
  v_pk_add_f32 v[182:183], v[182:183], v[14:15]
  v_lshlrev_b32 v8, 16, v124
  v_and_b32 v9, 0xffff0000, v124
  v_pk_add_f32 v[184:185], v[184:185], v[8:9]
  v_lshlrev_b32 v10, 16, v125
  v_and_b32 v11, 0xffff0000, v125
  v_pk_add_f32 v[186:187], v[186:187], v[10:11]
  v_lshlrev_b32 v12, 16, v126
  v_and_b32 v13, 0xffff0000, v126
  v_pk_add_f32 v[188:189], v[188:189], v[12:13]
  v_lshlrev_b32 v14, 16, v127
  v_and_b32 v15, 0xffff0000, v127
  v_pk_add_f32 v[190:191], v[190:191], v[14:15]
  s_waitcnt vmcnt(6)
  v_lshlrev_b32 v8, 16, v128
  v_and_b32 v9, 0xffff0000, v128
  v_pk_add_f32 v[176:177], v[176:177], v[8:9]
  v_lshlrev_b32 v10, 16, v129
  v_and_b32 v11, 0xffff0000, v129
  v_pk_add_f32 v[178:179], v[178:179], v[10:11]
  v_lshlrev_b32 v12, 16, v130
  v_and_b32 v13, 0xffff0000, v130
  v_pk_add_f32 v[180:181], v[180:181], v[12:13]
  v_lshlrev_b32 v14, 16, v131
  v_and_b32 v15, 0xffff0000, v131
  v_pk_add_f32 v[182:183], v[182:183], v[14:15]
  v_lshlrev_b32 v8, 16, v132
  v_and_b32 v9, 0xffff0000, v132
  v_pk_add_f32 v[184:185], v[184:185], v[8:9]
  v_lshlrev_b32 v10, 16, v133
  v_and_b32 v11, 0xffff0000, v133
  v_pk_add_f32 v[186:187], v[186:187], v[10:11]
  v_lshlrev_b32 v12, 16, v134
  v_and_b32 v13, 0xffff0000, v134
  v_pk_add_f32 v[188:189], v[188:189], v[12:13]
  v_lshlrev_b32 v14, 16, v135
  v_and_b32 v15, 0xffff0000, v135
  v_pk_add_f32 v[190:191], v[190:191], v[14:15]
  s_waitcnt vmcnt(4)
  v_lshlrev_b32 v8, 16, v136
  v_and_b32 v9, 0xffff0000, v136
  v_pk_add_f32 v[176:177], v[176:177], v[8:9]
  v_lshlrev_b32 v10, 16, v137
  v_and_b32 v11, 0xffff0000, v137
  v_pk_add_f32 v[178:179], v[178:179], v[10:11]
  v_lshlrev_b32 v12, 16, v138
  v_and_b32 v13, 0xffff0000, v138
  v_pk_add_f32 v[180:181], v[180:181], v[12:13]
  v_lshlrev_b32 v14, 16, v139
  v_and_b32 v15, 0xffff0000, v139
  v_pk_add_f32 v[182:183], v[182:183], v[14:15]
  v_lshlrev_b32 v8, 16, v140
  v_and_b32 v9, 0xffff0000, v140
  v_pk_add_f32 v[184:185], v[184:185], v[8:9]
  v_lshlrev_b32 v10, 16, v141
  v_and_b32 v11, 0xffff0000, v141
  v_pk_add_f32 v[186:187], v[186:187], v[10:11]
  v_lshlrev_b32 v12, 16, v142
  v_and_b32 v13, 0xffff0000, v142
  v_pk_add_f32 v[188:189], v[188:189], v[12:13]
  v_lshlrev_b32 v14, 16, v143
  v_and_b32 v15, 0xffff0000, v143
  v_pk_add_f32 v[190:191], v[190:191], v[14:15]
  s_waitcnt vmcnt(2)
  v_lshlrev_b32 v8, 16, v144
  v_and_b32 v9, 0xffff0000, v144
  v_pk_add_f32 v[176:177], v[176:177], v[8:9]
  v_lshlrev_b32 v10, 16, v145
  v_and_b32 v11, 0xffff0000, v145
  v_pk_add_f32 v[178:179], v[178:179], v[10:11]
  v_lshlrev_b32 v12, 16, v146
  v_and_b32 v13, 0xffff0000, v146
  v_pk_add_f32 v[180:181], v[180:181], v[12:13]
  v_lshlrev_b32 v14, 16, v147
  v_and_b32 v15, 0xffff0000, v147
  v_pk_add_f32 v[182:183], v[182:183], v[14:15]
  v_lshlrev_b32 v8, 16, v148
  v_and_b32 v9, 0xffff0000, v148
  v_pk_add_f32 v[184:185], v[184:185], v[8:9]
  v_lshlrev_b32 v10, 16, v149
  v_and_b32 v11, 0xffff0000, v149
  v_pk_add_f32 v[186:187], v[186:187], v[10:11]
  v_lshlrev_b32 v12, 16, v150
  v_and_b32 v13, 0xffff0000, v150
  v_pk_add_f32 v[188:189], v[188:189], v[12:13]
  v_lshlrev_b32 v14, 16, v151
  v_and_b32 v15, 0xffff0000, v151
  v_pk_add_f32 v[190:191], v[190:191], v[14:15]
  s_waitcnt vmcnt(0)
  v_lshlrev_b32 v8, 16, v152
  v_and_b32 v9, 0xffff0000, v152
  v_pk_add_f32 v[176:177], v[176:177], v[8:9]
  v_lshlrev_b32 v10, 16, v153
  v_and_b32 v11, 0xffff0000, v153
  v_pk_add_f32 v[178:179], v[178:179], v[10:11]
  v_lshlrev_b32 v12, 16, v154
  v_and_b32 v13, 0xffff0000, v154
  v_pk_add_f32 v[180:181], v[180:181], v[12:13]
  v_lshlrev_b32 v14, 16, v155
  v_and_b32 v15, 0xffff0000, v155
  v_pk_add_f32 v[182:183], v[182:183], v[14:15]
  v_lshlrev_b32 v8, 16, v156
  v_and_b32 v9, 0xffff0000, v156
  v_pk_add_f32 v[184:185], v[184:185], v[8:9]
  v_lshlrev_b32 v10, 16, v157
  v_and_b32 v11, 0xffff0000, v157
  v_pk_add_f32 v[186:187], v[186:187], v[10:11]
  v_lshlrev_b32 v12, 16, v158
  v_and_b32 v13, 0xffff0000, v158
  v_pk_add_f32 v[188:189], v[188:189], v[12:13]
  v_lshlrev_b32 v14, 16, v159
  v_and_b32 v15, 0xffff0000, v159
  v_pk_add_f32 v[190:191], v[190:191], v[14:15]
  v_pk_fma_f32 v[160:161], v[176:177], v[82:83], v[160:161] op_sel_hi:[1,0,1]
  v_cvt_pk_bf16_f32 v16, v160, v161
  v_pk_fma_f32 v[162:163], v[178:179], v[82:83], v[162:163] op_sel_hi:[1,0,1]
  v_cvt_pk_bf16_f32 v17, v162, v163
  v_pk_fma_f32 v[164:165], v[180:181], v[82:83], v[164:165] op_sel_hi:[1,0,1]
  v_cvt_pk_bf16_f32 v18, v164, v165
  v_pk_fma_f32 v[166:167], v[182:183], v[82:83], v[166:167] op_sel_hi:[1,0,1]
  v_cvt_pk_bf16_f32 v19, v166, v167
  v_pk_fma_f32 v[168:169], v[184:185], v[82:83], v[168:169] op_sel_hi:[1,0,1]
  v_cvt_pk_bf16_f32 v20, v168, v169
  v_pk_fma_f32 v[170:171], v[186:187], v[82:83], v[170:171] op_sel_hi:[1,0,1]
  v_cvt_pk_bf16_f32 v21, v170, v171
  v_pk_fma_f32 v[172:173], v[188:189], v[82:83], v[172:173] op_sel_hi:[1,0,1]
  v_cvt_pk_bf16_f32 v22, v172, v173
  v_pk_fma_f32 v[174:175], v[190:191], v[82:83], v[174:175] op_sel_hi:[1,0,1]
  v_cvt_pk_bf16_f32 v23, v174, v175
  s_lshl_b32 s26, s49, 2
  s_add_u32 s26, s26, s16
  s_lshl_b32 s26, s26, 6
  s_lshl_b32 s27, s48, 15
  s_add_u32 s26, s26, s27
  buffer_store_dwordx4 v[16:19], v6, s[32:35], s26 offen offset:0
  buffer_store_dwordx4 v[20:23], v6, s[32:35], s26 offen offset:32
  s_cmp_lt_u32 s50, 64
  s_mov_b32 s50, s51
  s_cbranch_scc1 M_fin
  s_branch M_done
M_follow:
  s_lshr_b32 s48, s64, 2
  s_and_b32 s49, s64, 1
  s_bfe_u32 s50, s64, 0x10001
  s_mov_b32 s51, 2
  s_mov_b32 s23, 32
  s_load_dwordx2 s[8:9], s[0:1], 40
  s_lshl_b32 s77, s64, 17
  v_lshlrev_b32 v4, 7, v0
  s_waitcnt lgkmcnt(0)
  s_and_b32 s9, s9, 0xffff
  s_mov_b32 s10, 4194304
  s_mov_b32 s11, 0x20000
  buffer_load_dword v250, v4, s[8:11], s77 offen
  s_add_u32 s77, s77, 32768
  buffer_load_dword v250, v4, s[8:11], s77 offen
  s_add_u32 s77, s77, 32768
  buffer_load_dword v250, v4, s[8:11], s77 offen
  s_add_u32 s77, s77, 32768
  buffer_load_dword v250, v4, s[8:11], s77 offen
  s_add_u32 s77, s77, 32768
  s_load_dwordx2 s[8:9], s[0:1], 88
  s_lshl_b32 s17, s48, 19
  s_lshl_b32 s26, s49, 2
  s_add_u32 s26, s26, s16
  s_lshl_b32 s27, s26, 7
  s_add_u32 s17, s17, s27
  s_mov_b32 s18, 1024
  s_lshl_b32 s21, s48, 6
  s_add_u32 s21, s21, s50
  s_lshl_b32 s21, s21, 3
  s_add_u32 s21, s21, s26
  s_lshl_b32 s21, s21, 12
  s_add_u32 s21, s21, 167772160
  s_lshl_b32 s22, s51, 15
  s_mov_b32 s24, 1.0
  s_waitcnt lgkmcnt(0)
  s_and_b32 s9, s9, 0xffff
  s_mov_b32 s10, 4194304
  s_mov_b32 s11, 0x20000
  s_mul_i32 s26, s16, 0
  v_add_u32 v8, 0, v2
  v_add_u32 v16, s26, v8
  v_add_u32 v9, 1024, v2
  v_add_u32 v17, s26, v9
  v_add_u32 v10, 2048, v2
  v_add_u32 v18, s26, v10
  v_add_u32 v11, 3072, v2
  v_add_u32 v19, s26, v11
  v_add_u32 v12, 4096, v2
  v_add_u32 v20, s26, v12
  v_add_u32 v13, 5120, v2
  v_add_u32 v21, s26, v13
  v_add_u32 v14, 6144, v2
  v_add_u32 v22, s26, v14
  v_add_u32 v15, 7168, v2
  v_add_u32 v23, s26, v15
  v_lshrrev_b32 v144, 3, v1
  v_mul_lo_u32 v144, v144, s18
  v_and_b32 v145, 7, v1
  v_lshl_add_u32 v144, v145, 4, v144
  s_lshl_b32 s28, s16, 15
  s_add_u32 s28, s28, 32768
  s_lshl_b32 s29, s18, 3
  s_add_u32 m0, s28, 0
  s_nop 0
  buffer_load_dwordx4 v144, s[8:11], s17 offen lds
  s_add_u32 s17, s17, s29
  s_add_u32 m0, s28, 1024
  s_nop 0
  buffer_load_dwordx4 v144, s[8:11], s17 offen lds
  s_add_u32 s17, s17, s29
  s_add_u32 m0, s28, 2048
  s_nop 0
  buffer_load_dwordx4 v144, s[8:11], s17 offen lds
  s_add_u32 s17, s17, s29
  s_add_u32 m0, s28, 3072
  s_nop 0
  buffer_load_dwordx4 v144, s[8:11], s17 offen lds
  s_add_u32 s17, s17, s29
  s_add_u32 m0, s28, 4096
  s_nop 0
  buffer_load_dwordx4 v144, s[8:11], s17 offen lds
  s_add_u32 s17, s17, s29
  s_add_u32 m0, s28, 5120
  s_nop 0
  buffer_load_dwordx4 v144, s[8:11], s17 offen lds
  s_add_u32 s17, s17, s29
  s_add_u32 m0, s28, 6144
  s_nop 0
  buffer_load_dwordx4 v144, s[8:11], s17 offen lds
  s_add_u32 s17, s17, s29
  s_add_u32 m0, s28, 7168
  s_nop 0
  buffer_load_dwordx4 v144, s[8:11], s17 offen lds
  s_add_u32 s17, s17, s29
  s_add_u32 m0, s28, 8192
  s_nop 0
  buffer_load_dwordx4 v144, s[8:11], s17 offen lds
  s_add_u32 s17, s17, s29
  s_add_u32 m0, s28, 9216
  s_nop 0
  buffer_load_dwordx4 v144, s[8:11], s17 offen lds
  s_add_u32 s17, s17, s29
  s_add_u32 m0, s28, 10240
  s_nop 0
  buffer_load_dwordx4 v144, s[8:11], s17 offen lds
  s_add_u32 s17, s17, s29
  s_add_u32 m0, s28, 11264
  s_nop 0
  buffer_load_dwordx4 v144, s[8:11], s17 offen lds
  s_add_u32 s17, s17, s29
  s_add_u32 m0, s28, 12288
  s_nop 0
  buffer_load_dwordx4 v144, s[8:11], s17 offen lds
  s_add_u32 s17, s17, s29
  s_add_u32 m0, s28, 13312
  s_nop 0
  buffer_load_dwordx4 v144, s[8:11], s17 offen lds
  s_add_u32 s17, s17, s29
  s_add_u32 m0, s28, 14336
  s_nop 0
  buffer_load_dwordx4 v144, s[8:11], s17 offen lds
  s_add_u32 s17, s17, s29
  s_add_u32 m0, s28, 15360
  s_nop 0
  buffer_load_dwordx4 v144, s[8:11], s17 offen lds
  s_add_u32 s17, s17, s29
  s_add_u32 m0, s28, 16384
  s_nop 0
  buffer_load_dwordx4 v144, s[8:11], s17 offen lds
  s_add_u32 s17, s17, s29
  s_add_u32 m0, s28, 17408
  s_nop 0
  buffer_load_dwordx4 v144, s[8:11], s17 offen lds
  s_add_u32 s17, s17, s29
  s_add_u32 m0, s28, 18432
  s_nop 0
  buffer_load_dwordx4 v144, s[8:11], s17 offen lds
  s_add_u32 s17, s17, s29
  s_add_u32 m0, s28, 19456
  s_nop 0
  buffer_load_dwordx4 v144, s[8:11], s17 offen lds
  s_add_u32 s17, s17, s29
  s_add_u32 m0, s28, 20480
  s_nop 0
  buffer_load_dwordx4 v144, s[8:11], s17 offen lds
  s_add_u32 s17, s17, s29
  s_add_u32 m0, s28, 21504
  s_nop 0
  buffer_load_dwordx4 v144, s[8:11], s17 offen lds
  s_add_u32 s17, s17, s29
  s_add_u32 m0, s28, 22528
  s_nop 0
  buffer_load_dwordx4 v144, s[8:11], s17 offen lds
  s_add_u32 s17, s17, s29
  s_add_u32 m0, s28, 23552
  s_nop 0
  buffer_load_dwordx4 v144, s[8:11], s17 offen lds
  s_add_u32 s17, s17, s29
  s_add_u32 m0, s28, 24576
  s_nop 0
  buffer_load_dwordx4 v144, s[8:11], s17 offen lds
  s_add_u32 s17, s17, s29
  s_add_u32 m0, s28, 25600
  s_nop 0
  buffer_load_dwordx4 v144, s[8:11], s17 offen lds
  s_add_u32 s17, s17, s29
  s_add_u32 m0, s28, 26624
  s_nop 0
  buffer_load_dwordx4 v144, s[8:11], s17 offen lds
  s_add_u32 s17, s17, s29
  s_add_u32 m0, s28, 27648
  s_nop 0
  buffer_load_dwordx4 v144, s[8:11], s17 offen lds
  s_add_u32 s17, s17, s29
  s_add_u32 m0, s28, 28672
  s_nop 0
  buffer_load_dwordx4 v144, s[8:11], s17 offen lds
  s_add_u32 s17, s17, s29
  s_add_u32 m0, s28, 29696
  s_nop 0
  buffer_load_dwordx4 v144, s[8:11], s17 offen lds
  s_add_u32 s17, s17, s29
  s_add_u32 m0, s28, 30720
  s_nop 0
  buffer_load_dwordx4 v144, s[8:11], s17 offen lds
  s_add_u32 s17, s17, s29
  s_add_u32 m0, s28, 31744
  s_nop 0
  buffer_load_dwordx4 v144, s[8:11], s17 offen lds
  s_add_u32 s17, s17, s29
  v_bfe_u32 v148, v1, 2, 2
  v_lshrrev_b32 v149, 5, v1
  v_lshl_add_u32 v148, v149, 2, v148
  v_lshlrev_b32 v148, 7, v148
  v_bfe_u32 v149, v1, 4, 1
  v_lshl_add_u32 v148, v149, 5, v148
  v_and_b32 v149, 1, v1
  v_lshl_add_u32 v148, v149, 4, v148
  v_bfe_u32 v149, v1, 1, 1
  v_lshl_add_u32 v148, v149, 3, v148
  v_add_u32 v146, s28, v148
  v_add_u32 v147, 1024, v146
  s_waitcnt vmcnt(28)
  ds_read_b64_tr_b16 a[0:1], v146 offset:0
  ds_read_b64_tr_b16 a[2:3], v147 offset:0
  ds_read_b64_tr_b16 a[4:5], v146 offset:64
  ds_read_b64_tr_b16 a[6:7], v147 offset:64
  ds_read_b64_tr_b16 a[8:9], v146 offset:2048
  ds_read_b64_tr_b16 a[10:11], v147 offset:2048
  ds_read_b64_tr_b16 a[12:13], v146 offset:2112
  ds_read_b64_tr_b16 a[14:15], v147 offset:2112
  s_waitcnt lgkmcnt(0)
  s_add_u32 m0, s28, 0
  s_nop 0
  buffer_load_dwordx4 v144, s[8:11], s17 offen lds
  s_add_u32 s17, s17, s29
  s_add_u32 m0, s28, 1024
  s_nop 0
  buffer_load_dwordx4 v144, s[8:11], s17 offen lds
  s_add_u32 s17, s17, s29
  s_add_u32 m0, s28, 2048
  s_nop 0
  buffer_load_dwordx4 v144, s[8:11], s17 offen lds
  s_add_u32 s17, s17, s29
  s_add_u32 m0, s28, 3072
  s_nop 0
  buffer_load_dwordx4 v144, s[8:11], s17 offen lds
  s_add_u32 s17, s17, s29
  s_waitcnt vmcnt(28)
  ds_read_b64_tr_b16 a[16:17], v146 offset:4096
  ds_read_b64_tr_b16 a[18:19], v147 offset:4096
  ds_read_b64_tr_b16 a[20:21], v146 offset:4160
  ds_read_b64_tr_b16 a[22:23], v147 offset:4160
  ds_read_b64_tr_b16 a[24:25], v146 offset:6144
  ds_read_b64_tr_b16 a[26:27], v147 offset:6144
  ds_read_b64_tr_b16 a[28:29], v146 offset:6208
  ds_read_b64_tr_b16 a[30:31], v147 offset:6208
  s_waitcnt lgkmcnt(0)
  s_add_u32 m0, s28, 4096
  s_nop 0
  buffer_load_dwordx4 v144, s[8:11], s17 offen lds
  s_add_u32 s17, s17, s29
  s_add_u32 m0, s28, 5120
  s_nop 0
  buffer_load_dwordx4 v144, s[8:11], s17 offen lds
  s_add_u32 s17, s17, s29
  s_add_u32 m0, s28, 6144
  s_nop 0
  buffer_load_dwordx4 v144, s[8:11], s17 offen lds
  s_add_u32 s17, s17, s29
  s_add_u32 m0, s28, 7168
  s_nop 0
  buffer_load_dwordx4 v144, s[8:11], s17 offen lds
  s_add_u32 s17, s17, s29
  s_waitcnt vmcnt(28)
  ds_read_b64_tr_b16 a[32:33], v146 offset:8192
  ds_read_b64_tr_b16 a[34:35], v147 offset:8192
  ds_read_b64_tr_b16 a[36:37], v146 offset:8256
  ds_read_b64_tr_b16 a[38:39], v147 offset:8256
  ds_read_b64_tr_b16 a[40:41], v146 offset:10240
  ds_read_b64_tr_b16 a[42:43], v147 offset:10240
  ds_read_b64_tr_b16 a[44:45], v146 offset:10304
  ds_read_b64_tr_b16 a[46:47], v147 offset:10304
  s_waitcnt lgkmcnt(0)
  s_add_u32 m0, s28, 8192
  s_nop 0
  buffer_load_dwordx4 v144, s[8:11], s17 offen lds
  s_add_u32 s17, s17, s29
  s_add_u32 m0, s28, 9216
  s_nop 0
  buffer_load_dwordx4 v144, s[8:11], s17 offen lds
  s_add_u32 s17, s17, s29
  s_add_u32 m0, s28, 10240
  s_nop 0
  buffer_load_dwordx4 v144, s[8:11], s17 offen lds
  s_add_u32 s17, s17, s29
  s_add_u32 m0, s28, 11264
  s_nop 0
  buffer_load_dwordx4 v144, s[8:11], s17 offen lds
  s_add_u32 s17, s17, s29
  s_waitcnt vmcnt(28)
  ds_read_b64_tr_b16 a[48:49], v146 offset:12288
  ds_read_b64_tr_b16 a[50:51], v147 offset:12288
  ds_read_b64_tr_b16 a[52:53], v146 offset:12352
  ds_read_b64_tr_b16 a[54:55], v147 offset:12352
  ds_read_b64_tr_b16 a[56:57], v146 offset:14336
  ds_read_b64_tr_b16 a[58:59], v147 offset:14336
  ds_read_b64_tr_b16 a[60:61], v146 offset:14400
  ds_read_b64_tr_b16 a[62:63], v147 offset:14400
  s_waitcnt lgkmcnt(0)
  s_add_u32 m0, s28, 12288
  s_nop 0
  buffer_load_dwordx4 v144, s[8:11], s17 offen lds
  s_add_u32 s17, s17, s29
  s_add_u32 m0, s28, 13312
  s_nop 0
  buffer_load_dwordx4 v144, s[8:11], s17 offen lds
  s_add_u32 s17, s17, s29
  s_add_u32 m0, s28, 14336
  s_nop 0
  buffer_load_dwordx4 v144, s[8:11], s17 offen lds
  s_add_u32 s17, s17, s29
  s_add_u32 m0, s28, 15360
  s_nop 0
  buffer_load_dwordx4 v144, s[8:11], s17 offen lds
  s_add_u32 s17, s17, s29
  s_waitcnt vmcnt(28)
  ds_read_b64_tr_b16 a[64:65], v146 offset:16384
  ds_read_b64_tr_b16 a[66:67], v147 offset:16384
  ds_read_b64_tr_b16 a[68:69], v146 offset:16448
  ds_read_b64_tr_b16 a[70:71], v147 offset:16448
  ds_read_b64_tr_b16 a[72:73], v146 offset:18432
  ds_read_b64_tr_b16 a[74:75], v147 offset:18432
  ds_read_b64_tr_b16 a[76:77], v146 offset:18496
  ds_read_b64_tr_b16 a[78:79], v147 offset:18496
  s_waitcnt lgkmcnt(0)
  s_add_u32 m0, s28, 16384
  s_nop 0
  buffer_load_dwordx4 v144, s[8:11], s17 offen lds
  s_add_u32 s17, s17, s29
  s_add_u32 m0, s28, 17408
  s_nop 0
  buffer_load_dwordx4 v144, s[8:11], s17 offen lds
  s_add_u32 s17, s17, s29
  s_add_u32 m0, s28, 18432
  s_nop 0
  buffer_load_dwordx4 v144, s[8:11], s17 offen lds
  s_add_u32 s17, s17, s29
  s_add_u32 m0, s28, 19456
  s_nop 0
  buffer_load_dwordx4 v144, s[8:11], s17 offen lds
  s_add_u32 s17, s17, s29
  s_waitcnt vmcnt(28)
  ds_read_b64_tr_b16 a[80:81], v146 offset:20480
  ds_read_b64_tr_b16 a[82:83], v147 offset:20480
  ds_read_b64_tr_b16 a[84:85], v146 offset:20544
  ds_read_b64_tr_b16 a[86:87], v147 offset:20544
  ds_read_b64_tr_b16 a[88:89], v146 offset:22528
  ds_read_b64_tr_b16 a[90:91], v147 offset:22528
  ds_read_b64_tr_b16 a[92:93], v146 offset:22592
  ds_read_b64_tr_b16 a[94:95], v147 offset:22592
  s_waitcnt lgkmcnt(0)
  s_add_u32 m0, s28, 20480
  s_nop 0
  buffer_load_dwordx4 v144, s[8:11], s17 offen lds
  s_add_u32 s17, s17, s29
  s_add_u32 m0, s28, 21504
  s_nop 0
  buffer_load_dwordx4 v144, s[8:11], s17 offen lds
  s_add_u32 s17, s17, s29
  s_add_u32 m0, s28, 22528
  s_nop 0
  buffer_load_dwordx4 v144, s[8:11], s17 offen lds
  s_add_u32 s17, s17, s29
  s_add_u32 m0, s28, 23552
  s_nop 0
  buffer_load_dwordx4 v144, s[8:11], s17 offen lds
  s_add_u32 s17, s17, s29
  s_waitcnt vmcnt(28)
  ds_read_b64_tr_b16 a[96:97], v146 offset:24576
  ds_read_b64_tr_b16 a[98:99], v147 offset:24576
  ds_read_b64_tr_b16 a[100:101], v146 offset:24640
  ds_read_b64_tr_b16 a[102:103], v147 offset:24640
  ds_read_b64_tr_b16 a[104:105], v146 offset:26624
  ds_read_b64_tr_b16 a[106:107], v147 offset:26624
  ds_read_b64_tr_b16 a[108:109], v146 offset:26688
  ds_read_b64_tr_b16 a[110:111], v147 offset:26688
  s_waitcnt lgkmcnt(0)
  s_add_u32 m0, s28, 24576
  s_nop 0
  buffer_load_dwordx4 v144, s[8:11], s17 offen lds
  s_add_u32 s17, s17, s29
  s_add_u32 m0, s28, 25600
  s_nop 0
  buffer_load_dwordx4 v144, s[8:11], s17 offen lds
  s_add_u32 s17, s17, s29
  s_add_u32 m0, s28, 26624
  s_nop 0
  buffer_load_dwordx4 v144, s[8:11], s17 offen lds
  s_add_u32 s17, s17, s29
  s_add_u32 m0, s28, 27648
  s_nop 0
  buffer_load_dwordx4 v144, s[8:11], s17 offen lds
  s_add_u32 s17, s17, s29
  s_waitcnt vmcnt(28)
  ds_read_b64_tr_b16 a[112:113], v146 offset:28672
  ds_read_b64_tr_b16 a[114:115], v147 offset:28672
  ds_read_b64_tr_b16 a[116:117], v146 offset:28736
  ds_read_b64_tr_b16 a[118:119], v147 offset:28736
  ds_read_b64_tr_b16 a[120:121], v146 offset:30720
  ds_read_b64_tr_b16 a[122:123], v147 offset:30720
  ds_read_b64_tr_b16 a[124:125], v146 offset:30784
  ds_read_b64_tr_b16 a[126:127], v147 offset:30784
  s_waitcnt lgkmcnt(0)
  s_add_u32 m0, s28, 28672
  s_nop 0
  buffer_load_dwordx4 v144, s[8:11], s17 offen lds
  s_add_u32 s17, s17, s29
  s_add_u32 m0, s28, 29696
  s_nop 0
  buffer_load_dwordx4 v144, s[8:11], s17 offen lds
  s_add_u32 s17, s17, s29
  s_add_u32 m0, s28, 30720
  s_nop 0
  buffer_load_dwordx4 v144, s[8:11], s17 offen lds
  s_add_u32 s17, s17, s29
  s_add_u32 m0, s28, 31744
  s_nop 0
  buffer_load_dwordx4 v144, s[8:11], s17 offen lds
  s_add_u32 s17, s17, s29
  s_waitcnt vmcnt(28)
  ds_read_b64_tr_b16 a[128:129], v146 offset:0
  ds_read_b64_tr_b16 a[130:131], v147 offset:0
  ds_read_b64_tr_b16 a[132:133], v146 offset:64
  ds_read_b64_tr_b16 a[134:135], v147 offset:64
  ds_read_b64_tr_b16 a[136:137], v146 offset:2048
  ds_read_b64_tr_b16 a[138:139], v147 offset:2048
  ds_read_b64_tr_b16 a[140:141], v146 offset:2112
  ds_read_b64_tr_b16 a[142:143], v147 offset:2112
  s_waitcnt lgkmcnt(0)
  s_waitcnt vmcnt(24)
  ds_read_b64_tr_b16 a[144:145], v146 offset:4096
  ds_read_b64_tr_b16 a[146:147], v147 offset:4096
  ds_read_b64_tr_b16 a[148:149], v146 offset:4160
  ds_read_b64_tr_b16 a[150:151], v147 offset:4160
  ds_read_b64_tr_b16 a[152:153], v146 offset:6144
  ds_read_b64_tr_b16 a[154:155], v147 offset:6144
  ds_read_b64_tr_b16 a[156:157], v146 offset:6208
  ds_read_b64_tr_b16 a[158:159], v147 offset:6208
  s_waitcnt lgkmcnt(0)
  s_waitcnt vmcnt(20)
  ds_read_b64_tr_b16 a[160:161], v146 offset:8192
  ds_read_b64_tr_b16 a[162:163], v147 offset:8192
  ds_read_b64_tr_b16 a[164:165], v146 offset:8256
  ds_read_b64_tr_b16 a[166:167], v147 offset:8256
  ds_read_b64_tr_b16 a[168:169], v146 offset:10240
  ds_read_b64_tr_b16 a[170:171], v147 offset:10240
  ds_read_b64_tr_b16 a[172:173], v146 offset:10304
  ds_read_b64_tr_b16 a[174:175], v147 offset:10304
  s_waitcnt lgkmcnt(0)
  s_waitcnt vmcnt(16)
  ds_read_b64_tr_b16 a[176:177], v146 offset:12288
  ds_read_b64_tr_b16 a[178:179], v147 offset:12288
  ds_read_b64_tr_b16 a[180:181], v146 offset:12352
  ds_read_b64_tr_b16 a[182:183], v147 offset:12352
  ds_read_b64_tr_b16 a[184:185], v146 offset:14336
  ds_read_b64_tr_b16 a[186:187], v147 offset:14336
  ds_read_b64_tr_b16 a[188:189], v146 offset:14400
  ds_read_b64_tr_b16 a[190:191], v147 offset:14400
  s_waitcnt lgkmcnt(0)
  s_waitcnt vmcnt(12)
  ds_read_b64_tr_b16 a[192:193], v146 offset:16384
  ds_read_b64_tr_b16 a[194:195], v147 offset:16384
  ds_read_b64_tr_b16 a[196:197], v146 offset:16448
  ds_read_b64_tr_b16 a[198:199], v147 offset:16448
  ds_read_b64_tr_b16 a[200:201], v146 offset:18432
  ds_read_b64_tr_b16 a[202:203], v147 offset:18432
  ds_read_b64_tr_b16 a[204:205], v146 offset:18496
  ds_read_b64_tr_b16 a[206:207], v147 offset:18496
  s_waitcnt lgkmcnt(0)
  s_waitcnt vmcnt(8)
  ds_read_b64_tr_b16 a[208:209], v146 offset:20480
  ds_read_b64_tr_b16 a[210:211], v147 offset:20480
  ds_read_b64_tr_b16 a[212:213], v146 offset:20544
  ds_read_b64_tr_b16 a[214:215], v147 offset:20544
  ds_read_b64_tr_b16 a[216:217], v146 offset:22528
  ds_read_b64_tr_b16 a[218:219], v147 offset:22528
  ds_read_b64_tr_b16 a[220:221], v146 offset:22592
  ds_read_b64_tr_b16 a[222:223], v147 offset:22592
  s_waitcnt lgkmcnt(0)
  s_waitcnt vmcnt(4)
  ds_read_b64_tr_b16 a[224:225], v146 offset:24576
  ds_read_b64_tr_b16 a[226:227], v147 offset:24576
  ds_read_b64_tr_b16 a[228:229], v146 offset:24640
  ds_read_b64_tr_b16 a[230:231], v147 offset:24640
  ds_read_b64_tr_b16 a[232:233], v146 offset:26624
  ds_read_b64_tr_b16 a[234:235], v147 offset:26624
  ds_read_b64_tr_b16 a[236:237], v146 offset:26688
  ds_read_b64_tr_b16 a[238:239], v147 offset:26688
  s_waitcnt lgkmcnt(0)
  s_waitcnt vmcnt(0)
  ds_read_b64_tr_b16 a[240:241], v146 offset:28672
  ds_read_b64_tr_b16 a[242:243], v147 offset:28672
  ds_read_b64_tr_b16 a[244:245], v146 offset:28736
  ds_read_b64_tr_b16 a[246:247], v147 offset:28736
  ds_read_b64_tr_b16 a[248:249], v146 offset:30720
  ds_read_b64_tr_b16 a[250:251], v147 offset:30720
  ds_read_b64_tr_b16 a[252:253], v146 offset:30784
  ds_read_b64_tr_b16 a[254:255], v147 offset:30784
  s_waitcnt lgkmcnt(0)
  s_lshl_b32 s26, s48, 2
  s_add_u32 s26, s26, s16
  s_lshl_b32 s27, s26, 6
  s_add_u32 s27, s27, s50
  s_lshl_b32 s19, s27, 13
  s_lshl_b32 s27, s50, 5
  s_add_u32 s27, s27, s26
  s_mul_i32 s27, s27, 4608
  s_add_u32 s20, s27, 134217728
  s_lshl_b32 s25, s16, 12
  s_add_u32 s25, s25, 65536
  s_lshl_b32 s26, s16, 13
  v_add_u32 v3, s26, v2
  v_lshrrev_b32 v16, 5, v1
  v_and_b32 v17, 31, v1
  v_mul_u32_u24 v18, 1152, v16
  v_lshl_add_u32 v5, v17, 3, v18
  v_bfe_u32 v18, v1, 2, 2
  v_lshl_add_u32 v18, v16, 2, v18
  v_and_b32 v19, 1, v1
  v_mul_u32_u24 v19, 1152, v19
  v_lshl_add_u32 v18, v18, 3, v19
  v_add_u32 v4, s25, v18
  v_lshlrev_b32 v16, 2, v16
  v_sub_u32 v17, v17, v16
  v_mov_b32 v18, 0xf149f2ca
  v_cmp_le_i32 vcc, 0, v17
  s_nop 1
  v_cndmask_b32 v240, v18, 0, vcc
  v_cmp_le_i32 vcc, 1, v17
  s_nop 1
  v_cndmask_b32 v241, v18, 0, vcc
  v_cmp_le_i32 vcc, 2, v17
  s_nop 1
  v_cndmask_b32 v242, v18, 0, vcc
  v_cmp_le_i32 vcc, 3, v17
  s_nop 1
  v_cndmask_b32 v243, v18, 0, vcc
  v_cmp_le_i32 vcc, 8, v17
  s_nop 1
  v_cndmask_b32 v244, v18, 0, vcc
  v_cmp_le_i32 vcc, 9, v17
  s_nop 1
  v_cndmask_b32 v245, v18, 0, vcc
  v_cmp_le_i32 vcc, 10, v17
  s_nop 1
  v_cndmask_b32 v246, v18, 0, vcc
  v_cmp_le_i32 vcc, 11, v17
  s_nop 1
  v_cndmask_b32 v247, v18, 0, vcc
  v_cmp_le_i32 vcc, 16, v17
  s_nop 1
  v_cndmask_b32 v248, v18, 0, vcc
  v_cmp_le_i32 vcc, 17, v17
  s_nop 1
  v_cndmask_b32 v249, v18, 0, vcc
  v_cmp_le_i32 vcc, 18, v17
  s_nop 1
  v_cndmask_b32 v250, v18, 0, vcc
  v_cmp_le_i32 vcc, 19, v17
  s_nop 1
  v_cndmask_b32 v251, v18, 0, vcc
  v_cmp_le_i32 vcc, 24, v17
  s_nop 1
  v_cndmask_b32 v252, v18, 0, vcc
  v_cmp_le_i32 vcc, 25, v17
  s_nop 1
  v_cndmask_b32 v253, v18, 0, vcc
  v_cmp_le_i32 vcc, 26, v17
  s_nop 1
  v_cndmask_b32 v254, v18, 0, vcc
  v_cmp_le_i32 vcc, 27, v17
  s_nop 1
  v_cndmask_b32 v255, v18, 0, vcc
  v_mov_b32 v21, v2
  s_barrier
  s_lshl_b32 s77, s48, 2
  s_add_u32 s77, s77, s16
  s_mul_i32 s78, s77, 896
  s_add_u32 s76, s78, 148898304
  s_mov_b32 s71, 0
  s_branch M_sg_55
M_sw_54:
  s_sleep 8
  s_add_u32 s71, s71, 1
  s_cmp_gt_u32 s71, 262144
  s_cbranch_scc1 M_exit
M_sg_55:
  s_mov_b32 s79, 0
  s_atomic_or s79, s[72:73], s76 glc
  s_waitcnt lgkmcnt(0)
  s_cmp_lt_u32 s79, 16
  s_cbranch_scc1 M_sw_54
  s_add_u32 s76, s78, 148898048
  s_mov_b32 s71, 0
  s_branch M_sg_57
M_sw_56:
  s_sleep 8
  s_add_u32 s71, s71, 1
  s_cmp_gt_u32 s71, 262144
  s_cbranch_scc1 M_exit
M_sg_57:
  s_mov_b32 s79, 0
  s_atomic_or s79, s[72:73], s76 glc
  s_waitcnt lgkmcnt(0)
  s_cmp_lt_u32 s79, 16
  s_cbranch_scc1 M_sw_56
M_xok_53:
  s_lshl_b32 s77, s77, 7
  s_add_u32 s54, s77, 148926464
  s_add_u32 s52, s50, 1
  s_mov_b32 s53, 0
  s_mov_b32 s30, 0x200
  s_add_u32 s28, s19, 50331648
  buffer_load_dwordx4 v[144:147], v21, s[4:7], s28 offen offset:0 sc1
  buffer_load_dwordx4 v[148:151], v21, s[4:7], s28 offen offset:1024 sc1
  buffer_load_dwordx4 v[152:155], v21, s[4:7], s28 offen offset:2048 sc1
  buffer_load_dwordx4 v[156:159], v21, s[4:7], s28 offen offset:3072 sc1
  s_add_u32 s29, s19, 50335744
  buffer_load_dwordx4 v[160:163], v21, s[4:7], s29 offen offset:0 sc1
  buffer_load_dwordx4 v[164:167], v21, s[4:7], s29 offen offset:1024 sc1
  buffer_load_dwordx4 v[168:171], v21, s[4:7], s29 offen offset:2048 sc1
  buffer_load_dwordx4 v[172:175], v21, s[4:7], s29 offen offset:3072 sc1
  s_add_u32 s28, s19, 67108864
  buffer_load_dwordx4 v[176:179], v21, s[4:7], s28 offen offset:0 sc1
  buffer_load_dwordx4 v[180:183], v21, s[4:7], s28 offen offset:1024 sc1
  buffer_load_dwordx4 v[184:187], v21, s[4:7], s28 offen offset:2048 sc1
  buffer_load_dwordx4 v[188:191], v21, s[4:7], s28 offen offset:3072 sc1
  s_add_u32 s29, s19, 67112960
  buffer_load_dwordx4 v[192:195], v21, s[4:7], s29 offen offset:0 sc1
  buffer_load_dwordx4 v[196:199], v21, s[4:7], s29 offen offset:1024 sc1
  buffer_load_dwordx4 v[200:203], v21, s[4:7], s29 offen offset:2048 sc1
  buffer_load_dwordx4 v[204:207], v21, s[4:7], s29 offen offset:3072 sc1
  s_add_u32 s28, s19, 83886080
  buffer_load_dwordx4 v[208:211], v21, s[4:7], s28 offen offset:0 sc1
  buffer_load_dwordx4 v[212:215], v21, s[4:7], s28 offen offset:1024 sc1
  buffer_load_dwordx4 v[216:219], v21, s[4:7], s28 offen offset:2048 sc1
  buffer_load_dwordx4 v[220:223], v21, s[4:7], s28 offen offset:3072 sc1
  s_add_u32 s29, s19, 83890176
  buffer_load_dwordx4 v[224:227], v21, s[4:7], s29 offen offset:0 sc1
  buffer_load_dwordx4 v[228:231], v21, s[4:7], s29 offen offset:1024 sc1
  buffer_load_dwordx4 v[232:235], v21, s[4:7], s29 offen offset:2048 sc1
  buffer_load_dwordx4 v[236:239], v21, s[4:7], s29 offen offset:3072 sc1
  s_mov_b32 s24, 0
  v_mov_b32 v22, 0x40000000
  s_sub_u32 s21, s21, s22
F_top_58:
  s_waitcnt vmcnt(8)
  v_mfma_f32_32x32x16_bf16 v[24:39], v[176:179], v[144:147], v[240:255]
  s_nop 1
  v_cvt_pk_bf16_f32 v128, v64, v65
  v_cvt_pk_bf16_f32 v129, v66, v67
  v_cvt_pk_bf16_f32 v130, v68, v69
  v_cvt_pk_bf16_f32 v131, v70, v71
  v_mfma_f32_32x32x16_bf16 v[24:39], v[180:183], v[148:151], v[24:39]
  buffer_store_dwordx4 v[128:131], v22, s[4:7], s21 offen offset:0 sc1
  v_mfma_f32_32x32x16_bf16 v[24:39], v[184:187], v[152:155], v[24:39]
  v_cvt_pk_bf16_f32 v132, v72, v73
  v_cvt_pk_bf16_f32 v133, v74, v75
  v_cvt_pk_bf16_f32 v134, v76, v77
  v_cvt_pk_bf16_f32 v135, v78, v79
  v_mfma_f32_32x32x16_bf16 v[24:39], v[188:191], v[156:159], v[24:39]
  buffer_store_dwordx4 v[132:135], v22, s[4:7], s21 offen offset:1024 sc1
  v_mfma_f32_32x32x16_bf16 v[24:39], v[192:195], v[160:163], v[24:39]
  v_cvt_pk_bf16_f32 v136, v80, v81
  v_cvt_pk_bf16_f32 v137, v82, v83
  v_cvt_pk_bf16_f32 v138, v84, v85
  v_cvt_pk_bf16_f32 v139, v86, v87
  v_mfma_f32_32x32x16_bf16 v[24:39], v[196:199], v[164:167], v[24:39]
  buffer_store_dwordx4 v[136:139], v22, s[4:7], s21 offen offset:2048 sc1
  v_mfma_f32_32x32x16_bf16 v[24:39], v[200:203], v[168:171], v[24:39]
  v_cvt_pk_bf16_f32 v140, v88, v89
  v_cvt_pk_bf16_f32 v141, v90, v91
  v_cvt_pk_bf16_f32 v142, v92, v93
  v_cvt_pk_bf16_f32 v143, v94, v95
  v_mfma_f32_32x32x16_bf16 v[24:39], v[204:207], v[172:175], v[24:39]
  buffer_store_dwordx4 v[140:143], v22, s[4:7], s21 offen offset:3072 sc1
  s_add_u32 s21, s21, s22
  v_mov_b32 v22, v2
  s_cmp_lg_u32 s24, 0
  s_cbranch_scc1 F_have_59
  v_mov_b32 v16, s54
  v_mov_b32 v17, s52
  s_mov_b32 s71, 0
  s_branch M_vg_61
M_vw_60:
  s_sleep 2
  s_add_u32 s71, s71, 1
  s_cmp_gt_u32 s71, 262144
  s_cbranch_scc1 M_exit
M_vg_61:
  buffer_load_dword v23, v16, s[4:7], 0 offen sc1
  s_waitcnt vmcnt(0)
  v_cmp_lt_u32 vcc, v23, v17
  s_cbranch_vccnz M_vw_60
  s_mov_b32 m0, s25
  s_nop 0
  buffer_load_dwordx4 v2, s[4:7], s20 offen offset:0 sc1 lds
  buffer_load_dwordx4 v2, s[4:7], s20 offen offset:1152 sc1 lds
  buffer_load_dwordx2 v[56:57], v5, s[4:7], s20 offen offset:2304 sc1
  buffer_load_dwordx2 v[58:59], v5, s[4:7], s20 offen offset:2560 sc1
  buffer_load_dwordx2 v[60:61], v5, s[4:7], s20 offen offset:2816 sc1
  buffer_load_dwordx2 v[62:63], v5, s[4:7], s20 offen offset:3072 sc1
  s_waitcnt vmcnt(0)
F_have_59:
  ds_read_b64_tr_b16 v[176:177], v4 offset:0
  ds_read_b64_tr_b16 v[178:179], v4 offset:64
  ds_read_b64_tr_b16 v[180:181], v4 offset:128
  ds_read_b64_tr_b16 v[182:183], v4 offset:192
  ds_read_b64_tr_b16 v[184:185], v4 offset:256
  ds_read_b64_tr_b16 v[186:187], v4 offset:320
  ds_read_b64_tr_b16 v[188:189], v4 offset:384
  ds_read_b64_tr_b16 v[190:191], v4 offset:448
  ds_read_b64_tr_b16 v[192:193], v4 offset:512
  ds_read_b64_tr_b16 v[194:195], v4 offset:576
  ds_read_b64_tr_b16 v[196:197], v4 offset:640
  ds_read_b64_tr_b16 v[198:199], v4 offset:704
  s_sub_u32 s23, s23, 1
  s_cmp_gt_u32 s23, 0
  s_cselect_b32 s26, s51, 0
  s_cselect_b32 s27, 0, 0x40000000
  v_or_b32 v21, s27, v21
  s_lshl_b32 s27, s26, 13
  s_add_u32 s19, s19, s27
  s_mul_i32 s27, s26, 147456
  s_add_u32 s20, s20, s27
  s_cmp_lg_u32 s23, 24
  s_cbranch_scc1 M_xok_62
  s_lshl_b32 s77, s48, 2
  s_add_u32 s77, s77, s16
  s_mul_i32 s78, s77, 896
  s_add_u32 s76, s78, 148898304
  s_mov_b32 s71, 0
  s_branch M_sg_64
M_sw_63:
  s_sleep 8
  s_add_u32 s71, s71, 1
  s_cmp_gt_u32 s71, 262144
  s_cbranch_scc1 M_exit
M_sg_64:
  s_mov_b32 s79, 0
  s_atomic_or s79, s[72:73], s76 glc
  s_waitcnt lgkmcnt(0)
  s_cmp_lt_u32 s79, 32
  s_cbranch_scc1 M_sw_63
  s_add_u32 s76, s78, 148898432
  s_mov_b32 s71, 0
  s_branch M_sg_66
M_sw_65:
  s_sleep 8
  s_add_u32 s71, s71, 1
  s_cmp_gt_u32 s71, 262144
  s_cbranch_scc1 M_exit
M_sg_66:
  s_mov_b32 s79, 0
  s_atomic_or s79, s[72:73], s76 glc
  s_waitcnt lgkmcnt(0)
  s_cmp_lt_u32 s79, 32
  s_cbranch_scc1 M_sw_65
  s_add_u32 s76, s78, 148898048
  s_mov_b32 s71, 0
  s_branch M_sg_68
M_sw_67:
  s_sleep 8
  s_add_u32 s71, s71, 1
  s_cmp_gt_u32 s71, 262144
  s_cbranch_scc1 M_exit
M_sg_68:
  s_mov_b32 s79, 0
  s_atomic_or s79, s[72:73], s76 glc
  s_waitcnt lgkmcnt(0)
  s_cmp_lt_u32 s79, 30
  s_cbranch_scc1 M_sw_67
  s_add_u32 s76, s78, 148898176
  s_mov_b32 s71, 0
  s_branch M_sg_70
M_sw_69:
  s_sleep 8
  s_add_u32 s71, s71, 1
  s_cmp_gt_u32 s71, 262144
  s_cbranch_scc1 M_exit
M_sg_70:
  s_mov_b32 s79, 0
  s_atomic_or s79, s[72:73], s76 glc
  s_waitcnt lgkmcnt(0)
  s_cmp_lt_u32 s79, 34
  s_cbranch_scc1 M_sw_69
M_xok_62:
  s_waitcnt lgkmcnt(10)
  v_mfma_f32_32x32x16_bf16 v[40:55], v[176:179], v[144:147], 0
  ds_read_b64_tr_b16 v[200:201], v4 offset:768
  ds_read_b64_tr_b16 v[202:203], v4 offset:832
  v_max_f32 v6, v24, v25
  s_waitcnt lgkmcnt(10)
  v_mfma_f32_32x32x16_bf16 v[40:55], v[180:183], v[148:151], v[40:55]
  ds_read_b64_tr_b16 v[204:205], v4 offset:896
  ds_read_b64_tr_b16 v[206:207], v4 offset:960
  v_max3_f32 v6, v6, v26, v27
  s_waitcnt lgkmcnt(10)
  v_mfma_f32_32x32x16_bf16 v[40:55], v[184:187], v[152:155], v[40:55]
  v_max3_f32 v6, v6, v28, v29
  s_waitcnt lgkmcnt(8)
  v_mfma_f32_32x32x16_bf16 v[40:55], v[188:191], v[156:159], v[40:55]
  v_max3_f32 v6, v6, v30, v31
  s_waitcnt lgkmcnt(6)
  v_mfma_f32_32x32x16_bf16 v[40:55], v[192:195], v[160:163], v[40:55]
  v_max3_f32 v6, v6, v32, v33
  s_waitcnt lgkmcnt(4)
  v_mfma_f32_32x32x16_bf16 v[40:55], v[196:199], v[164:167], v[40:55]
  v_max3_f32 v6, v6, v34, v35
  s_waitcnt lgkmcnt(2)
  v_mfma_f32_32x32x16_bf16 v[40:55], v[200:203], v[168:171], v[40:55]
  v_max3_f32 v6, v6, v36, v37
  s_waitcnt lgkmcnt(0)
  v_mfma_f32_32x32x16_bf16 v[40:55], v[204:207], v[172:175], v[40:55]
  v_max3_f32 v6, v6, v38, v39
  s_add_u32 s28, s19, 50331648
  buffer_load_dwordx4 v[144:147], v21, s[4:7], s28 offen offset:0 sc1
  buffer_load_dwordx4 v[148:151], v21, s[4:7], s28 offen offset:1024 sc1
  s_nop 7
  v_max3_f32 v6, v6, v40, v41
  v_max3_f32 v6, v6, v42, v43
  v_mov_b32 v16, v6
  s_nop 1
  v_permlane32_swap_b32 v6, v16
  s_nop 1
  v_max_f32 v6, v6, v16
  v_pk_add_f32 v[24:25], v[24:25], v[6:7] op_sel_hi:[1,0] neg_lo:[0,1] neg_hi:[0,1]
  v_pk_add_f32 v[26:27], v[26:27], v[6:7] op_sel_hi:[1,0] neg_lo:[0,1] neg_hi:[0,1]
  v_pk_add_f32 v[28:29], v[28:29], v[6:7] op_sel_hi:[1,0] neg_lo:[0,1] neg_hi:[0,1]
  v_pk_add_f32 v[30:31], v[30:31], v[6:7] op_sel_hi:[1,0] neg_lo:[0,1] neg_hi:[0,1]
  v_pk_add_f32 v[32:33], v[32:33], v[6:7] op_sel_hi:[1,0] neg_lo:[0,1] neg_hi:[0,1]
  v_pk_add_f32 v[34:35], v[34:35], v[6:7] op_sel_hi:[1,0] neg_lo:[0,1] neg_hi:[0,1]
  v_pk_add_f32 v[36:37], v[36:37], v[6:7] op_sel_hi:[1,0] neg_lo:[0,1] neg_hi:[0,1]
  v_pk_add_f32 v[38:39], v[38:39], v[6:7] op_sel_hi:[1,0] neg_lo:[0,1] neg_hi:[0,1]
  v_pk_add_f32 v[40:41], v[40:41], v[6:7] op_sel_hi:[1,0] neg_lo:[0,1] neg_hi:[0,1]
  v_pk_add_f32 v[42:43], v[42:43], v[6:7] op_sel_hi:[1,0] neg_lo:[0,1] neg_hi:[0,1]
  v_exp_f32 v24, v24
  v_exp_f32 v25, v25
  v_exp_f32 v26, v26
  v_exp_f32 v27, v27
  v_exp_f32 v28, v28
  v_exp_f32 v29, v29
  v_exp_f32 v30, v30
  v_exp_f32 v31, v31
  v_exp_f32 v32, v32
  v_exp_f32 v33, v33
  buffer_load_dwordx4 v[152:155], v21, s[4:7], s28 offen offset:2048 sc1
  v_exp_f32 v34, v34
  v_exp_f32 v35, v35
  v_exp_f32 v36, v36
  v_exp_f32 v37, v37
  v_exp_f32 v38, v38
  v_exp_f32 v39, v39
  v_exp_f32 v40, v40
  v_exp_f32 v41, v41
  v_exp_f32 v42, v42
  v_exp_f32 v43, v43
  v_pk_add_f32 v[16:17], v[24:25], v[26:27]
  v_pk_add_f32 v[16:17], v[16:17], v[28:29]
  v_pk_add_f32 v[16:17], v[16:17], v[30:31]
  v_pk_add_f32 v[16:17], v[16:17], v[32:33]
  v_pk_add_f32 v[16:17], v[16:17], v[34:35]
  v_pk_add_f32 v[16:17], v[16:17], v[36:37]
  v_pk_add_f32 v[16:17], v[16:17], v[38:39]
  v_pk_add_f32 v[16:17], v[16:17], v[40:41]
  v_pk_add_f32 v[16:17], v[16:17], v[42:43]
  v_add_f32 v16, v16, v17
  v_mov_b32 v17, v16
  buffer_load_dwordx4 v[156:159], v21, s[4:7], s28 offen offset:3072 sc1
  s_nop 0
  v_permlane32_swap_b32 v16, v17
  s_nop 1
  v_add_f32 v16, v16, v17
  v_rcp_f32 v6, v16
  s_nop 0
  v_pk_mul_f32 v[24:25], v[24:25], v[6:7] op_sel_hi:[1,0]
  v_pk_mul_f32 v[26:27], v[26:27], v[6:7] op_sel_hi:[1,0]
  v_pk_mul_f32 v[28:29], v[28:29], v[6:7] op_sel_hi:[1,0]
  v_pk_mul_f32 v[30:31], v[30:31], v[6:7] op_sel_hi:[1,0]
  v_pk_mul_f32 v[32:33], v[32:33], v[6:7] op_sel_hi:[1,0]
  v_pk_mul_f32 v[34:35], v[34:35], v[6:7] op_sel_hi:[1,0]
  v_pk_mul_f32 v[36:37], v[36:37], v[6:7] op_sel_hi:[1,0]
  v_pk_mul_f32 v[38:39], v[38:39], v[6:7] op_sel_hi:[1,0]
  v_pk_mul_f32 v[40:41], v[40:41], v[6:7] op_sel_hi:[1,0]
  v_pk_mul_f32 v[42:43], v[42:43], v[6:7] op_sel_hi:[1,0]
  v_cvt_pk_bf16_f32 v128, v24, v25
  v_cvt_pk_bf16_f32 v129, v26, v27
  v_cvt_pk_bf16_f32 v130, v28, v29
  v_cvt_pk_bf16_f32 v131, v30, v31
  v_cvt_pk_bf16_f32 v132, v32, v33
  v_cvt_pk_bf16_f32 v133, v34, v35
  v_cvt_pk_bf16_f32 v134, v36, v37
  v_cvt_pk_bf16_f32 v135, v38, v39
  v_cvt_pk_bf16_f32 v136, v40, v41
  v_cvt_pk_bf16_f32 v137, v42, v43
  s_waitcnt vmcnt(8)
  v_mfma_f32_32x32x16_bf16 v[64:79], v[208:211], v[128:131], 0
  s_add_u32 s29, s19, 50335744
  buffer_load_dwordx4 v[160:163], v21, s[4:7], s29 offen offset:0 sc1
  v_mfma_f32_32x32x16_bf16 v[64:79], v[212:215], v[132:135], v[64:79]
  v_mfma_f32_32x32x8_bf16 v[64:79], v[56:57], v[136:137], v[64:79]
  v_mfma_f32_32x32x16_bf16 v[80:95], v[216:219], v[128:131], 0
  buffer_load_dwordx4 v[164:167], v21, s[4:7], s29 offen offset:1024 sc1
  v_mfma_f32_32x32x16_bf16 v[80:95], v[220:223], v[132:135], v[80:95]
  v_cvt_pk_bf16_f32 v24, v64, v65
  v_cvt_pk_bf16_f32 v25, v66, v67
  v_cvt_pk_bf16_f32 v26, v68, v69
  v_cvt_pk_bf16_f32 v27, v70, v71
  v_mfma_f32_32x32x8_bf16 v[80:95], v[58:59], v[136:137], v[80:95]
  ds_write_b128 v3, v[24:27] offset:0
  v_cvt_pk_bf16_f32 v28, v72, v73
  v_cvt_pk_bf16_f32 v29, v74, v75
  v_cvt_pk_bf16_f32 v30, v76, v77
  v_cvt_pk_bf16_f32 v31, v78, v79
  v_mfma_f32_32x32x16_bf16 v[96:111], v[224:227], v[128:131], 0
  ds_write_b128 v3, v[28:31] offset:1024
  buffer_load_dwordx4 v[168:171], v21, s[4:7], s29 offen offset:2048 sc1
  v_mfma_f32_32x32x16_bf16 v[96:111], v[228:231], v[132:135], v[96:111]
  v_cvt_pk_bf16_f32 v32, v80, v81
  v_cvt_pk_bf16_f32 v33, v82, v83
  v_cvt_pk_bf16_f32 v34, v84, v85
  v_cvt_pk_bf16_f32 v35, v86, v87
  v_mfma_f32_32x32x8_bf16 v[96:111], v[60:61], v[136:137], v[96:111]
  ds_write_b128 v3, v[32:35] offset:2048
  v_cvt_pk_bf16_f32 v36, v88, v89
  v_cvt_pk_bf16_f32 v37, v90, v91
  v_cvt_pk_bf16_f32 v38, v92, v93
  v_cvt_pk_bf16_f32 v39, v94, v95
  v_mfma_f32_32x32x16_bf16 v[112:127], v[232:235], v[128:131], 0
  ds_write_b128 v3, v[36:39] offset:3072
  buffer_load_dwordx4 v[172:175], v21, s[4:7], s29 offen offset:3072 sc1
  v_mfma_f32_32x32x16_bf16 v[112:127], v[236:239], v[132:135], v[112:127]
  v_cvt_pk_bf16_f32 v40, v96, v97
  v_cvt_pk_bf16_f32 v41, v98, v99
  v_cvt_pk_bf16_f32 v42, v100, v101
  v_cvt_pk_bf16_f32 v43, v102, v103
  v_mfma_f32_32x32x8_bf16 v[112:127], v[62:63], v[136:137], v[112:127]
  ds_write_b128 v3, v[40:43] offset:4096
  v_cvt_pk_bf16_f32 v44, v104, v105
  v_cvt_pk_bf16_f32 v45, v106, v107
  v_cvt_pk_bf16_f32 v46, v108, v109
  v_cvt_pk_bf16_f32 v47, v110, v111
  ds_write_b128 v3, v[44:47] offset:5120
  s_nop 5
  v_cvt_pk_bf16_f32 v48, v112, v113
  v_cvt_pk_bf16_f32 v49, v114, v115
  v_cvt_pk_bf16_f32 v50, v116, v117
  v_cvt_pk_bf16_f32 v51, v118, v119
  ds_write_b128 v3, v[48:51] offset:6144
  v_cvt_pk_bf16_f32 v52, v120, v121
  v_cvt_pk_bf16_f32 v53, v122, v123
  v_cvt_pk_bf16_f32 v54, v124, v125
  v_cvt_pk_bf16_f32 v55, v126, v127
  ds_write_b128 v3, v[52:55] offset:7168
  s_waitcnt vmcnt(8)
  s_waitcnt lgkmcnt(0)
  s_barrier
  ds_read_b128 v[24:27], v8 offset:0
  ds_read_b128 v[28:31], v9 offset:0
  ds_read_b128 v[32:35], v10 offset:0
  ds_read_b128 v[36:39], v11 offset:0
  ds_read_b128 v[40:43], v12 offset:0
  ds_read_b128 v[44:47], v13 offset:0
  v_readfirstlane_b32 s53, v23
  v_mov_b32 v16, s30
  v_min_u32 v17, 1, v0
  v_lshlrev_b32 v17, 30, v17
  buffer_store_dword v16, v17, s[4:7], s31 offen sc1
  s_add_u32 s30, s30, 1
  s_add_u32 s52, s52, 2
  s_cmp_ge_u32 s53, s52
  s_cselect_b32 s24, 1, 0
  buffer_load_dword v23, off, s[4:7], s54 sc1
  s_cmp_eq_u32 s24, 0
  s_cbranch_scc1 F_nopre_71
  s_mov_b32 m0, s25
  s_nop 0
  buffer_load_dwordx4 v2, s[4:7], s20 offen offset:0 sc1 lds
  buffer_load_dwordx4 v2, s[4:7], s20 offen offset:1152 sc1 lds
  buffer_load_dwordx2 v[56:57], v5, s[4:7], s20 offen offset:2304 sc1
  buffer_load_dwordx2 v[58:59], v5, s[4:7], s20 offen offset:2560 sc1
  buffer_load_dwordx2 v[60:61], v5, s[4:7], s20 offen offset:2816 sc1
  buffer_load_dwordx2 v[62:63], v5, s[4:7], s20 offen offset:3072 sc1
F_nopre_71:
  s_waitcnt lgkmcnt(5)
  v_mfma_f32_32x32x16_bf16 v[64:79], a[0:3], v[24:27], 0
  s_add_u32 s28, s19, 67108864
  ds_read_b128 v[48:51], v14 offset:0
  v_mfma_f32_32x32x16_bf16 v[80:95], a[4:7], v[24:27], 0
  s_waitcnt lgkmcnt(5)
  v_mfma_f32_32x32x16_bf16 v[64:79], a[8:11], v[28:31], v[64:79]
  ds_read_b128 v[52:55], v15 offset:0
  v_mfma_f32_32x32x16_bf16 v[80:95], a[12:15], v[28:31], v[80:95]
  s_waitcnt lgkmcnt(5)
  buffer_load_dwordx4 v[176:179], v21, s[4:7], s28 offen offset:0 sc1
  v_mfma_f32_32x32x16_bf16 v[64:79], a[16:19], v[32:35], v[64:79]
  ds_read_b128 v[24:27], v8 offset:8192
  v_mfma_f32_32x32x16_bf16 v[80:95], a[20:23], v[32:35], v[80:95]
  s_waitcnt lgkmcnt(5)
  v_mfma_f32_32x32x16_bf16 v[64:79], a[24:27], v[36:39], v[64:79]
  ds_read_b128 v[28:31], v9 offset:8192
  v_mfma_f32_32x32x16_bf16 v[80:95], a[28:31], v[36:39], v[80:95]
  s_waitcnt lgkmcnt(5)
  buffer_load_dwordx4 v[180:183], v21, s[4:7], s28 offen offset:1024 sc1
  v_mfma_f32_32x32x16_bf16 v[64:79], a[32:35], v[40:43], v[64:79]
  ds_read_b128 v[32:35], v10 offset:8192
  v_mfma_f32_32x32x16_bf16 v[80:95], a[36:39], v[40:43], v[80:95]
  s_waitcnt lgkmcnt(5)
  v_mfma_f32_32x32x16_bf16 v[64:79], a[40:43], v[44:47], v[64:79]
  ds_read_b128 v[36:39], v11 offset:8192
  v_mfma_f32_32x32x16_bf16 v[80:95], a[44:47], v[44:47], v[80:95]
  s_waitcnt lgkmcnt(5)
  buffer_load_dwordx4 v[184:187], v21, s[4:7], s28 offen offset:2048 sc1
  v_mfma_f32_32x32x16_bf16 v[64:79], a[48:51], v[48:51], v[64:79]
  ds_read_b128 v[40:43], v12 offset:8192
  v_mfma_f32_32x32x16_bf16 v[80:95], a[52:55], v[48:51], v[80:95]
  s_waitcnt lgkmcnt(5)
  v_mfma_f32_32x32x16_bf16 v[64:79], a[56:59], v[52:55], v[64:79]
  ds_read_b128 v[44:47], v13 offset:8192
  v_mfma_f32_32x32x16_bf16 v[80:95], a[60:63], v[52:55], v[80:95]
  s_waitcnt lgkmcnt(5)
  buffer_load_dwordx4 v[188:191], v21, s[4:7], s28 offen offset:3072 sc1
  v_mfma_f32_32x32x16_bf16 v[64:79], a[64:67], v[24:27], v[64:79]
  s_add_u32 s29, s19, 67112960
  ds_read_b128 v[48:51], v14 offset:8192
  v_mfma_f32_32x32x16_bf16 v[80:95], a[68:71], v[24:27], v[80:95]
  s_waitcnt lgkmcnt(5)
  v_mfma_f32_32x32x16_bf16 v[64:79], a[72:75], v[28:31], v[64:79]
  ds_read_b128 v[52:55], v15 offset:8192
  v_mfma_f32_32x32x16_bf16 v[80:95], a[76:79], v[28:31], v[80:95]
  s_waitcnt lgkmcnt(5)
  buffer_load_dwordx4 v[192:195], v21, s[4:7], s29 offen offset:0 sc1
  v_mfma_f32_32x32x16_bf16 v[64:79], a[80:83], v[32:35], v[64:79]
  ds_read_b128 v[24:27], v8 offset:16384
  v_mfma_f32_32x32x16_bf16 v[80:95], a[84:87], v[32:35], v[80:95]
  s_waitcnt lgkmcnt(5)
  v_mfma_f32_32x32x16_bf16 v[64:79], a[88:91], v[36:39], v[64:79]
  ds_read_b128 v[28:31], v9 offset:16384
  v_mfma_f32_32x32x16_bf16 v[80:95], a[92:95], v[36:39], v[80:95]
  s_waitcnt lgkmcnt(5)
  buffer_load_dwordx4 v[196:199], v21, s[4:7], s29 offen offset:1024 sc1
  v_mfma_f32_32x32x16_bf16 v[64:79], a[96:99], v[40:43], v[64:79]
  ds_read_b128 v[32:35], v10 offset:16384
  v_mfma_f32_32x32x16_bf16 v[80:95], a[100:103], v[40:43], v[80:95]
  s_waitcnt lgkmcnt(5)
  v_mfma_f32_32x32x16_bf16 v[64:79], a[104:107], v[44:47], v[64:79]
  ds_read_b128 v[36:39], v11 offset:16384
  v_mfma_f32_32x32x16_bf16 v[80:95], a[108:111], v[44:47], v[80:95]
  s_waitcnt lgkmcnt(5)
  buffer_load_dwordx4 v[200:203], v21, s[4:7], s29 offen offset:2048 sc1
  v_mfma_f32_32x32x16_bf16 v[64:79], a[112:115], v[48:51], v[64:79]
  ds_read_b128 v[40:43], v12 offset:16384
  v_mfma_f32_32x32x16_bf16 v[80:95], a[116:119], v[48:51], v[80:95]
  s_waitcnt lgkmcnt(5)
  v_mfma_f32_32x32x16_bf16 v[64:79], a[120:123], v[52:55], v[64:79]
  ds_read_b128 v[44:47], v13 offset:16384
  v_mfma_f32_32x32x16_bf16 v[80:95], a[124:127], v[52:55], v[80:95]
  s_waitcnt lgkmcnt(5)
  buffer_load_dwordx4 v[204:207], v21, s[4:7], s29 offen offset:3072 sc1
  v_mfma_f32_32x32x16_bf16 v[64:79], a[128:131], v[24:27], v[64:79]
  s_add_u32 s28, s19, 83886080
  ds_read_b128 v[48:51], v14 offset:16384
  v_mfma_f32_32x32x16_bf16 v[80:95], a[132:135], v[24:27], v[80:95]
  s_waitcnt lgkmcnt(5)
  v_mfma_f32_32x32x16_bf16 v[64:79], a[136:139], v[28:31], v[64:79]
  ds_read_b128 v[52:55], v15 offset:16384
  v_mfma_f32_32x32x16_bf16 v[80:95], a[140:143], v[28:31], v[80:95]
  s_waitcnt lgkmcnt(5)
  buffer_load_dwordx4 v[208:211], v21, s[4:7], s28 offen offset:0 sc1
  v_mfma_f32_32x32x16_bf16 v[64:79], a[144:147], v[32:35], v[64:79]
  ds_read_b128 v[24:27], v8 offset:24576
  v_mfma_f32_32x32x16_bf16 v[80:95], a[148:151], v[32:35], v[80:95]
  s_waitcnt lgkmcnt(5)
  v_mfma_f32_32x32x16_bf16 v[64:79], a[152:155], v[36:39], v[64:79]
  ds_read_b128 v[28:31], v9 offset:24576
  v_mfma_f32_32x32x16_bf16 v[80:95], a[156:159], v[36:39], v[80:95]
  s_waitcnt lgkmcnt(5)
  buffer_load_dwordx4 v[212:215], v21, s[4:7], s28 offen offset:1024 sc1
  v_mfma_f32_32x32x16_bf16 v[64:79], a[160:163], v[40:43], v[64:79]
  ds_read_b128 v[32:35], v10 offset:24576
  v_mfma_f32_32x32x16_bf16 v[80:95], a[164:167], v[40:43], v[80:95]
  s_waitcnt lgkmcnt(5)
  v_mfma_f32_32x32x16_bf16 v[64:79], a[168:171], v[44:47], v[64:79]
  ds_read_b128 v[36:39], v11 offset:24576
  v_mfma_f32_32x32x16_bf16 v[80:95], a[172:175], v[44:47], v[80:95]
  s_waitcnt lgkmcnt(5)
  buffer_load_dwordx4 v[216:219], v21, s[4:7], s28 offen offset:2048 sc1
  v_mfma_f32_32x32x16_bf16 v[64:79], a[176:179], v[48:51], v[64:79]
  ds_read_b128 v[40:43], v12 offset:24576
  v_mfma_f32_32x32x16_bf16 v[80:95], a[180:183], v[48:51], v[80:95]
  s_waitcnt lgkmcnt(5)
  v_mfma_f32_32x32x16_bf16 v[64:79], a[184:187], v[52:55], v[64:79]
  ds_read_b128 v[44:47], v13 offset:24576
  v_mfma_f32_32x32x16_bf16 v[80:95], a[188:191], v[52:55], v[80:95]
  s_waitcnt lgkmcnt(5)
  buffer_load_dwordx4 v[220:223], v21, s[4:7], s28 offen offset:3072 sc1
  v_mfma_f32_32x32x16_bf16 v[64:79], a[192:195], v[24:27], v[64:79]
  s_add_u32 s29, s19, 83890176
  ds_read_b128 v[48:51], v14 offset:24576
  v_mfma_f32_32x32x16_bf16 v[80:95], a[196:199], v[24:27], v[80:95]
  s_waitcnt lgkmcnt(5)
  v_mfma_f32_32x32x16_bf16 v[64:79], a[200:203], v[28:31], v[64:79]
  ds_read_b128 v[52:55], v15 offset:24576
  v_mfma_f32_32x32x16_bf16 v[80:95], a[204:207], v[28:31], v[80:95]
  s_waitcnt lgkmcnt(5)
  buffer_load_dwordx4 v[224:227], v21, s[4:7], s29 offen offset:0 sc1
  v_mfma_f32_32x32x16_bf16 v[64:79], a[208:211], v[32:35], v[64:79]
  v_mfma_f32_32x32x16_bf16 v[80:95], a[212:215], v[32:35], v[80:95]
  s_waitcnt lgkmcnt(4)
  v_mfma_f32_32x32x16_bf16 v[64:79], a[216:219], v[36:39], v[64:79]
  v_xor_b32 v8, 0x8000, v8
  v_mfma_f32_32x32x16_bf16 v[80:95], a[220:223], v[36:39], v[80:95]
  s_waitcnt lgkmcnt(3)
  buffer_load_dwordx4 v[228:231], v21, s[4:7], s29 offen offset:1024 sc1
  v_xor_b32 v9, 0x8000, v9
  v_mfma_f32_32x32x16_bf16 v[64:79], a[224:227], v[40:43], v[64:79]
  v_xor_b32 v10, 0x8000, v10
  v_mfma_f32_32x32x16_bf16 v[80:95], a[228:231], v[40:43], v[80:95]
  s_waitcnt lgkmcnt(2)
  v_xor_b32 v11, 0x8000, v11
  v_mfma_f32_32x32x16_bf16 v[64:79], a[232:235], v[44:47], v[64:79]
  v_xor_b32 v12, 0x8000, v12
  v_mfma_f32_32x32x16_bf16 v[80:95], a[236:239], v[44:47], v[80:95]
  s_waitcnt lgkmcnt(1)
  buffer_load_dwordx4 v[232:235], v21, s[4:7], s29 offen offset:2048 sc1
  v_xor_b32 v13, 0x8000, v13
  v_mfma_f32_32x32x16_bf16 v[64:79], a[240:243], v[48:51], v[64:79]
  v_xor_b32 v14, 0x8000, v14
  v_mfma_f32_32x32x16_bf16 v[80:95], a[244:247], v[48:51], v[80:95]
  s_waitcnt lgkmcnt(0)
  v_xor_b32 v15, 0x8000, v15
  v_mfma_f32_32x32x16_bf16 v[64:79], a[248:251], v[52:55], v[64:79]
  v_xor_b32 v3, 0x8000, v3
  v_mfma_f32_32x32x16_bf16 v[80:95], a[252:255], v[52:55], v[80:95]
  buffer_load_dwordx4 v[236:239], v21, s[4:7], s29 offen offset:3072 sc1
  s_cmp_gt_u32 s23, 0
  s_cbranch_scc1 F_top_58
  s_nop 2
  v_cvt_pk_bf16_f32 v128, v64, v65
  v_cvt_pk_bf16_f32 v129, v66, v67
  v_cvt_pk_bf16_f32 v130, v68, v69
  v_cvt_pk_bf16_f32 v131, v70, v71
  buffer_store_dwordx4 v[128:131], v22, s[4:7], s21 offen offset:0 sc1
  v_cvt_pk_bf16_f32 v132, v72, v73
  v_cvt_pk_bf16_f32 v133, v74, v75
  v_cvt_pk_bf16_f32 v134, v76, v77
  v_cvt_pk_bf16_f32 v135, v78, v79
  buffer_store_dwordx4 v[132:135], v22, s[4:7], s21 offen offset:1024 sc1
  v_cvt_pk_bf16_f32 v136, v80, v81
  v_cvt_pk_bf16_f32 v137, v82, v83
  v_cvt_pk_bf16_f32 v138, v84, v85
  v_cvt_pk_bf16_f32 v139, v86, v87
  buffer_store_dwordx4 v[136:139], v22, s[4:7], s21 offen offset:2048 sc1
  v_cvt_pk_bf16_f32 v140, v88, v89
  v_cvt_pk_bf16_f32 v141, v90, v91
  v_cvt_pk_bf16_f32 v142, v92, v93
  v_cvt_pk_bf16_f32 v143, v94, v95
  buffer_store_dwordx4 v[140:143], v22, s[4:7], s21 offen offset:3072 sc1
  s_waitcnt vmcnt(0) lgkmcnt(0)
  s_barrier
  v_mov_b32 v144, s30
  v_min_u32 v145, 1, v0
  v_lshlrev_b32 v145, 30, v145
  buffer_store_dword v144, v145, s[4:7], s31 offen sc1
  s_branch M_done
M_team:
  s_mov_b32 s12, s77
  s_load_dwordx4 s[60:63], s[0:1], 64
  s_load_dwordx4 s[64:67], s[0:1], 80
  s_load_dwordx4 s[68:71], s[0:1], 120
  s_load_dwordx2 s[72:73], s[0:1], 56
  v_lshrrev_b32 v1, 6, v0
  v_and_b32 v20, 63, v0
  v_readfirstlane_b32 s13, v1
  s_waitcnt lgkmcnt(0)
  s_mov_b32 s8, s60
  s_and_b32 s9, s61, 0xffff
  s_mov_b32 s10, 0x400000
  s_mov_b32 s11, 0x20000
  s_mov_b32 s40, s62
  s_and_b32 s41, s63, 0xffff
  s_mov_b32 s42, 0x400000
  s_mov_b32 s43, 0x20000
  s_mov_b32 s44, s64
  s_and_b32 s45, s65, 0xffff
  s_mov_b32 s46, 0x400000
  s_mov_b32 s47, 0x20000
  s_mov_b32 s48, s66
  s_and_b32 s49, s67, 0xffff
  s_mov_b32 s50, 0x400000
  s_mov_b32 s51, 0x20000
  s_mov_b32 s4, s70
  s_and_b32 s5, s71, 0xffff
  s_mov_b32 s6, 0x10000000
  s_mov_b32 s7, 0x20000
  s_mov_b32 s76, s72
  s_and_b32 s77, s73, 0xffff
  s_mov_b32 s78, 0x2000
  s_mov_b32 s79, 0x20000
  s_mov_b32 s72, s68
  s_and_b32 s73, s69, 0xffff
  s_mov_b32 s74, 0x100
  s_mov_b32 s75, 0x20000
  s_mov_b64 s[52:53], s[68:69]
  s_mov_b64 s[58:59], s[70:71]
  s_mul_i32 s99, s12, 896
  s_add_u32 s99, s99, 148898048
  s_lshl_b32 s15, s12, 7
  s_add_u32 s15, s15, 148926464
  v_lshrrev_b32 v21, 4, v20
  v_and_b32 v22, 15, v20
  v_and_b32 v23, 1, v21
  v_lshrrev_b32 v24, 1, v21
  v_lshlrev_b32 v2, 4, v20
  s_lshl_b32 s36, s13, 10
  v_add_u32 v59, s36, v2
  s_lshl_b32 s37, s13, 15
  s_add_u32 s37, s37, 32768
  v_add_u32 v4, s37, v2
  v_lshrrev_b32 v25, 2, v20
  v_lshlrev_b32 v25, 13, v25
  v_and_b32 v1, 3, v20
  v_lshl_add_u32 v25, v1, 4, v25
  s_lshl_b32 s36, s13, 6
  s_lshl_b32 s38, s12, 8
  s_add_u32 s36, s36, s38
  v_add_u32 v25, s36, v25
  v_lshrrev_b32 v26, 3, v20
  v_lshlrev_b32 v26, 10, v26
  v_and_b32 v1, 7, v20
  v_lshl_add_u32 v26, v1, 4, v26
  s_lshl_b32 s36, s13, 7
  s_lshl_b32 s38, s12, 17
  s_add_u32 s36, s36, s38
  v_add_u32 v26, s36, v26
  v_bfe_u32 v29, v20, 2, 1
  v_bfe_u32 v30, v20, 3, 1
  v_and_b32 v31, 3, v20
  v_lshl_add_u32 v27, v21, 2, v29
  v_lshlrev_b32 v27, 6, v27
  v_lshl_add_u32 v27, v30, 5, v27
  v_lshl_add_u32 v27, v31, 3, v27
  v_add_u32 v27, s37, v27
  v_xor_b32 v36, 1, v30
  v_lshl_add_u32 v36, v36, 11, v27
  v_lshl_add_u32 v27, v30, 11, v27
  v_lshl_add_u32 v28, v23, 2, v24
  v_lshl_add_u32 v28, v28, 2, v29
  v_lshlrev_b32 v28, 7, v28
  v_lshl_add_u32 v28, v30, 6, v28
  v_lshl_add_u32 v28, v31, 4, v28
  v_add_u32 v28, s37, v28
  s_mov_b32 s39, s37
  s_xor_b32 s36, s13, 0
  s_lshl_b32 s36, s36, 15
  s_add_u32 m0, s39, 0
  s_add_u32 s37, s36, 0
  buffer_load_dwordx4 v26, s[48:51], s37 offen lds
  s_add_u32 m0, s39, 1024
  s_add_u32 s37, s36, 8192
  buffer_load_dwordx4 v26, s[48:51], s37 offen lds
  s_add_u32 m0, s39, 2048
  s_add_u32 s37, s36, 16384
  buffer_load_dwordx4 v26, s[48:51], s37 offen lds
  s_add_u32 m0, s39, 3072
  s_add_u32 s37, s36, 24576
  buffer_load_dwordx4 v26, s[48:51], s37 offen lds
  s_xor_b32 s36, s13, 0
  s_lshl_b32 s36, s36, 15
  s_add_u32 m0, s39, 4096
  s_add_u32 s37, s36, 512
  buffer_load_dwordx4 v26, s[48:51], s37 offen lds
  s_add_u32 m0, s39, 5120
  s_add_u32 s37, s36, 8704
  buffer_load_dwordx4 v26, s[48:51], s37 offen lds
  s_add_u32 m0, s39, 6144
  s_add_u32 s37, s36, 16896
  buffer_load_dwordx4 v26, s[48:51], s37 offen lds
  s_add_u32 m0, s39, 7168
  s_add_u32 s37, s36, 25088
  buffer_load_dwordx4 v26, s[48:51], s37 offen lds
  v_mov_b32 v0, 0x4444
  v_mov_b32 v1, 0xeeee
  v_cmp_lt_u32 vcc, 7, v22
  s_nop 1
  v_cndmask_b32 v32, v0, v1, vcc
  v_mov_b32 v0, v32
  v_and_b32 v32, 7, v20
  v_lshlrev_b32 v32, 4, v32
  v_lshl_add_u32 v11, v21, 7, v32
  v_xor_b32 v1, 128, v2
  v_lshl_add_u32 v33, v24, 4, v22
  s_lshl_b32 s36, s13, 5
  v_add_u32 v33, s36, v33
  v_lshlrev_b32 v33, 3, v33
  v_mul_u32_u24 v34, 1152, v23
  v_add_u32 v5, v33, v34
  v_bfe_u32 v33, v20, 2, 2
  v_lshl_add_u32 v33, v23, 2, v33
  v_lshl_add_u32 v33, v24, 4, v33
  v_lshlrev_b32 v33, 3, v33
  v_and_b32 v34, 1, v20
  v_mul_u32_u24 v34, 1152, v34
  v_add_u32 v6, v33, v34
  s_lshl_b32 s36, s13, 3
  v_lshrrev_b32 v33, 3, v20
  v_add_u32 v33, s36, v33
  v_mul_u32_u24 v34, 0, v33
  v_add_u32 v34, s12, v34
  v_and_b32 v34, 31, v34
  v_lshrrev_b32 v37, 1, v32
  v_lshl_add_u32 v33, v33, 13, v37
  v_lshl_add_u32 v7, v34, 7, v33
  v_and_b32 v37, 1, v20
  v_bfe_u32 v38, v20, 1, 1
  v_lshl_add_u32 v37, v29, 1, v37
  s_lshr_b32 s36, s12, 3
  s_lshl_b32 s36, s36, 10
  s_and_b32 s37, s12, 1
  s_lshl_b32 s37, s37, 9
  s_add_u32 s36, s36, s37
  s_and_b32 s37, s12, 6
  s_lshl_b32 s37, s37, 5
  s_add_u32 s36, s36, s37
  v_lshlrev_b32 v33, 4, v21
  v_lshl_add_u32 v33, v37, 2, v33
  v_lshl_add_u32 v33, v38, 8, v33
  v_lshl_add_u32 v33, v30, 30, v33
  v_add_u32 v8, s36, v33
  v_mov_b32 v3, v2
  v_mov_b32 v39, v21
  s_lshr_b32 s36, s12, 2
  s_lshl_b32 s36, s36, 6
  s_and_b32 s37, s12, 1
  s_lshl_b32 s37, s37, 5
  s_add_u32 s36, s36, s37
  s_and_b32 s37, s12, 2
  s_lshl_b32 s37, s37, 11
  s_add_u32 s36, s36, s37
  v_lshlrev_b32 v35, 10, v39
  v_lshl_add_u32 v35, v37, 2, v35
  v_lshl_add_u32 v35, v38, 4, v35
  v_add_u32 v35, s36, v35
  buffer_load_ushort v44, v35, s[76:79], 0 offen offset:0
  buffer_load_ushort v45, v35, s[76:79], 0 offen offset:2
  buffer_load_ushort v46, v35, s[76:79], 0 offen offset:512
  buffer_load_ushort v47, v35, s[76:79], 0 offen offset:514
  v_lshlrev_b32 v33, 4, v29
  v_mov_b32 v34, 0x3f80
  v_lshlrev_b32 v33, v33, v34
  v_and_b32 v34, 1, v20
  v_lshl_add_u32 v34, v34, 1, v30
  v_cmp_eq_u32 vcc, 0, v34
  s_nop 1
  v_cndmask_b32 v48, 0, v33, vcc
  v_cmp_eq_u32 vcc, 1, v34
  s_nop 1
  v_cndmask_b32 v49, 0, v33, vcc
  v_cmp_eq_u32 vcc, 2, v34
  s_nop 1
  v_cndmask_b32 v50, 0, v33, vcc
  v_cmp_eq_u32 vcc, 3, v34
  s_nop 1
  v_cndmask_b32 v51, 0, v33, vcc
  ds_write_b128 v2, v[48:51] offset:31232
  v_lshlrev_b32 v33, 9, v21
  s_lshl_b32 s36, s13, 11
  v_add_u32 v33, s36, v33
  v_lshl_add_u32 v10, v22, 4, v33
  v_lshl_add_u32 v33, v30, 8, v33
  v_add_u32 v9, v33, v32
  v_mov_b32 v12, 0x3f803f80
  v_mov_b32 v13, 0x3f803f80
  v_mov_b32 v14, 0x3f803f80
  v_mov_b32 v15, 0x3f803f80
  v_and_b32 v33, 1, v20
  v_mul_u32_u24 v33, 128, v33
  v_min_u32 v34, 1, v20
  v_lshlrev_b32 v34, 30, v34
  s_cmp_eq_u32 s13, 3
  s_cselect_b64 vcc, -1, 0
  v_cndmask_b32 v19, v34, v33, vcc
  v_mov_b64 v[60:61], 0
  v_mov_b32 v62, 32256
  ds_write_b64 v62, v[60:61]
  s_mov_b32 s16, 0
  s_mov_b32 s17, -1
  s_mov_b32 s18, 0x3e0293ee
  s_mov_b32 s54, 0x2f800000
  s_mov_b32 s55, 0x28000000
  s_lshl_b32 s36, s13, 10
  s_add_u32 s31, s36, 8192
  s_add_u32 s32, s36, 12160
  s_add_u32 s33, s36, 16384
  s_add_u32 s34, s36, 20224
  s_lshl_b32 s36, s12, 19
  s_add_u32 s27, s36, 67108864
  s_add_u32 s28, s36, 83886080
  s_mul_i32 s36, s12, 4608
  s_add_u32 s29, s36, 134217728
  s_lshl_b32 s36, s12, 13
  s_add_u32 s22, s36, 144703488
  s_add_u32 s23, s36, 144707584
  s_mov_b32 s20, 144703488
  s_mov_b32 s21, 144707584
  v_mov_b32 v40, -1
  v_mov_b32 v41, -1
  v_mov_b32 v42, -1
  v_mov_b32 v43, -1
  s_lshl_b32 s36, s13, 13
  s_add_u32 s36, s36, 145752064
  s_add_u32 s37, s36, 4096
  buffer_store_dwordx4 v[40:43], v59, s[4:7], s22 offen sc1
  buffer_store_dwordx4 v[40:43], v59, s[4:7], s23 offen sc1
  buffer_store_dword v40, v8, s[4:7], s36 offen sc1
  buffer_store_dword v40, v8, s[4:7], s37 offen sc1
  v_mov_b32 v52, 0
  v_min_u32 v53, 1, v59
  v_lshlrev_b32 v53, 30, v53
  buffer_store_dword v52, v53, s[4:7], s15 offen sc1
  s_xor_b32 s36, s13, 1
  s_lshl_b32 s36, s36, 15
  s_add_u32 m0, s39, 8192
  s_add_u32 s37, s36, 0
  buffer_load_dwordx4 v26, s[48:51], s37 offen lds
  s_add_u32 m0, s39, 9216
  s_add_u32 s37, s36, 8192
  buffer_load_dwordx4 v26, s[48:51], s37 offen lds
  s_add_u32 m0, s39, 10240
  s_add_u32 s37, s36, 16384
  buffer_load_dwordx4 v26, s[48:51], s37 offen lds
  s_add_u32 m0, s39, 11264
  s_add_u32 s37, s36, 24576
  buffer_load_dwordx4 v26, s[48:51], s37 offen lds
  s_xor_b32 s36, s13, 1
  s_lshl_b32 s36, s36, 15
  s_add_u32 m0, s39, 12288
  s_add_u32 s37, s36, 512
  buffer_load_dwordx4 v26, s[48:51], s37 offen lds
  s_add_u32 m0, s39, 13312
  s_add_u32 s37, s36, 8704
  buffer_load_dwordx4 v26, s[48:51], s37 offen lds
  s_add_u32 m0, s39, 14336
  s_add_u32 s37, s36, 16896
  buffer_load_dwordx4 v26, s[48:51], s37 offen lds
  s_add_u32 m0, s39, 15360
  s_add_u32 s37, s36, 25088
  buffer_load_dwordx4 v26, s[48:51], s37 offen lds
  s_waitcnt vmcnt(21)
  ds_read_b64_tr_b16 a[160:161], v28 offset:0
  ds_read_b64_tr_b16 a[162:163], v28 offset:256
  ds_read_b64_tr_b16 a[164:165], v28 offset:1024
  ds_read_b64_tr_b16 a[166:167], v28 offset:1280
  ds_read_b64_tr_b16 a[168:169], v28 offset:8
  ds_read_b64_tr_b16 a[170:171], v28 offset:264
  ds_read_b64_tr_b16 a[172:173], v28 offset:1032
  ds_read_b64_tr_b16 a[174:175], v28 offset:1288
  s_waitcnt lgkmcnt(0)
  s_xor_b32 s36, s13, 2
  s_lshl_b32 s36, s36, 15
  s_add_u32 m0, s39, 0
  s_add_u32 s37, s36, 0
  buffer_load_dwordx4 v26, s[48:51], s37 offen lds
  s_add_u32 m0, s39, 1024
  s_add_u32 s37, s36, 8192
  buffer_load_dwordx4 v26, s[48:51], s37 offen lds
  s_add_u32 m0, s39, 2048
  s_add_u32 s37, s36, 16384
  buffer_load_dwordx4 v26, s[48:51], s37 offen lds
  s_add_u32 m0, s39, 3072
  s_add_u32 s37, s36, 24576
  buffer_load_dwordx4 v26, s[48:51], s37 offen lds
  s_waitcnt vmcnt(21)
  ds_read_b64_tr_b16 a[176:177], v28 offset:4096
  ds_read_b64_tr_b16 a[178:179], v28 offset:4352
  ds_read_b64_tr_b16 a[180:181], v28 offset:5120
  ds_read_b64_tr_b16 a[182:183], v28 offset:5376
  ds_read_b64_tr_b16 a[184:185], v28 offset:4104
  ds_read_b64_tr_b16 a[186:187], v28 offset:4360
  ds_read_b64_tr_b16 a[188:189], v28 offset:5128
  ds_read_b64_tr_b16 a[190:191], v28 offset:5384
  s_waitcnt lgkmcnt(0)
  s_xor_b32 s36, s13, 3
  s_lshl_b32 s36, s36, 15
  s_add_u32 m0, s39, 4096
  s_add_u32 s37, s36, 0
  buffer_load_dwordx4 v26, s[48:51], s37 offen lds
  s_add_u32 m0, s39, 5120
  s_add_u32 s37, s36, 8192
  buffer_load_dwordx4 v26, s[48:51], s37 offen lds
  s_add_u32 m0, s39, 6144
  s_add_u32 s37, s36, 16384
  buffer_load_dwordx4 v26, s[48:51], s37 offen lds
  s_add_u32 m0, s39, 7168
  s_add_u32 s37, s36, 24576
  buffer_load_dwordx4 v26, s[48:51], s37 offen lds
  s_waitcnt vmcnt(12)
  ds_read_b64_tr_b16 a[192:193], v28 offset:8192
  ds_read_b64_tr_b16 a[194:195], v28 offset:8448
  ds_read_b64_tr_b16 a[196:197], v28 offset:9216
  ds_read_b64_tr_b16 a[198:199], v28 offset:9472
  ds_read_b64_tr_b16 a[200:201], v28 offset:8200
  ds_read_b64_tr_b16 a[202:203], v28 offset:8456
  ds_read_b64_tr_b16 a[204:205], v28 offset:9224
  ds_read_b64_tr_b16 a[206:207], v28 offset:9480
  s_waitcnt lgkmcnt(0)
  s_xor_b32 s36, s13, 2
  s_lshl_b32 s36, s36, 19
  s_add_u32 m0, s39, 8192
  s_add_u32 s37, s36, 0
  buffer_load_dwordx4 v25, s[8:11], s37 offen lds
  s_add_u32 m0, s39, 9216
  s_add_u32 s37, s36, 131072
  buffer_load_dwordx4 v25, s[8:11], s37 offen lds
  s_add_u32 m0, s39, 10240
  s_add_u32 s37, s36, 262144
  buffer_load_dwordx4 v25, s[8:11], s37 offen lds
  s_add_u32 m0, s39, 11264
  s_add_u32 s37, s36, 393216
  buffer_load_dwordx4 v25, s[8:11], s37 offen lds
  s_barrier
  s_cmp_lg_u32 s13, 0
  s_cbranch_scc1 T_arm_72
  s_getreg_b32 s36, hwreg(HW_REG_XCC_ID, 0, 3)
  s_lshl_b32 s36, s36, 3
  s_lshl_b64 s[60:61], 1, s36
  s_mov_b32 s62, 1
  s_atomic_add_x2 s[60:61], s[52:53], 0
  s_atomic_add s62, s[52:53], 128
  v_lshl_or_b32 v44, v45, 16, v44
  v_lshl_or_b32 v46, v47, 16, v46
  v_min_u32 v44, -2, v44
  v_min_u32 v46, -2, v46
  s_mov_b32 s36, 145752064
  s_mov_b32 s37, 145756160
  buffer_store_dword v44, v8, s[4:7], s36 offen sc1
  buffer_store_dword v46, v8, s[4:7], s37 offen sc1
T_arm_72:
  s_waitcnt vmcnt(12)
  ds_read_b64_tr_b16 a[208:209], v28 offset:12288
  ds_read_b64_tr_b16 a[210:211], v28 offset:12544
  ds_read_b64_tr_b16 a[212:213], v28 offset:13312
  ds_read_b64_tr_b16 a[214:215], v28 offset:13568
  ds_read_b64_tr_b16 a[216:217], v28 offset:12296
  ds_read_b64_tr_b16 a[218:219], v28 offset:12552
  ds_read_b64_tr_b16 a[220:221], v28 offset:13320
  ds_read_b64_tr_b16 a[222:223], v28 offset:13576
  s_waitcnt lgkmcnt(0)
  s_xor_b32 s36, s13, 3
  s_lshl_b32 s36, s36, 19
  s_add_u32 m0, s39, 12288
  s_add_u32 s37, s36, 0
  buffer_load_dwordx4 v25, s[8:11], s37 offen lds
  s_add_u32 m0, s39, 13312
  s_add_u32 s37, s36, 131072
  buffer_load_dwordx4 v25, s[8:11], s37 offen lds
  s_add_u32 m0, s39, 14336
  s_add_u32 s37, s36, 262144
  buffer_load_dwordx4 v25, s[8:11], s37 offen lds
  s_add_u32 m0, s39, 15360
  s_add_u32 s37, s36, 393216
  buffer_load_dwordx4 v25, s[8:11], s37 offen lds
  s_waitcnt vmcnt(12)
  ds_read_b64_tr_b16 a[224:225], v28 offset:0
  ds_read_b64_tr_b16 a[226:227], v28 offset:256
  ds_read_b64_tr_b16 a[228:229], v28 offset:1024
  ds_read_b64_tr_b16 a[230:231], v28 offset:1280
  ds_read_b64_tr_b16 a[232:233], v28 offset:8
  ds_read_b64_tr_b16 a[234:235], v28 offset:264
  ds_read_b64_tr_b16 a[236:237], v28 offset:1032
  ds_read_b64_tr_b16 a[238:239], v28 offset:1288
  s_waitcnt lgkmcnt(0)
  s_xor_b32 s36, s13, 4
  s_lshl_b32 s36, s36, 19
  s_add_u32 m0, s39, 0
  s_add_u32 s37, s36, 0
  buffer_load_dwordx4 v25, s[8:11], s37 offen lds
  s_add_u32 m0, s39, 1024
  s_add_u32 s37, s36, 131072
  buffer_load_dwordx4 v25, s[8:11], s37 offen lds
  s_add_u32 m0, s39, 2048
  s_add_u32 s37, s36, 262144
  buffer_load_dwordx4 v25, s[8:11], s37 offen lds
  s_add_u32 m0, s39, 3072
  s_add_u32 s37, s36, 393216
  buffer_load_dwordx4 v25, s[8:11], s37 offen lds
  s_waitcnt vmcnt(12)
  ds_read_b64_tr_b16 a[240:241], v28 offset:4096
  ds_read_b64_tr_b16 a[242:243], v28 offset:4352
  ds_read_b64_tr_b16 a[244:245], v28 offset:5120
  ds_read_b64_tr_b16 a[246:247], v28 offset:5376
  ds_read_b64_tr_b16 a[248:249], v28 offset:4104
  ds_read_b64_tr_b16 a[250:251], v28 offset:4360
  ds_read_b64_tr_b16 a[252:253], v28 offset:5128
  ds_read_b64_tr_b16 a[254:255], v28 offset:5384
  s_waitcnt lgkmcnt(0)
  s_xor_b32 s36, s13, 5
  s_lshl_b32 s36, s36, 19
  s_add_u32 m0, s39, 4096
  s_add_u32 s37, s36, 0
  buffer_load_dwordx4 v25, s[8:11], s37 offen lds
  s_add_u32 m0, s39, 5120
  s_add_u32 s37, s36, 131072
  buffer_load_dwordx4 v25, s[8:11], s37 offen lds
  s_add_u32 m0, s39, 6144
  s_add_u32 s37, s36, 262144
  buffer_load_dwordx4 v25, s[8:11], s37 offen lds
  s_add_u32 m0, s39, 7168
  s_add_u32 s37, s36, 393216
  buffer_load_dwordx4 v25, s[8:11], s37 offen lds
  s_waitcnt vmcnt(12)
  ds_read_b64_tr_b16 v[160:161], v27 offset:8192
  ds_read_b64_tr_b16 v[162:163], v27 offset:8320
  ds_read_b64_tr_b16 v[164:165], v27 offset:9216
  ds_read_b64_tr_b16 v[166:167], v27 offset:9344
  ds_read_b64_tr_b16 v[168:169], v36 offset:8192
  ds_read_b64_tr_b16 v[170:171], v36 offset:8320
  ds_read_b64_tr_b16 v[172:173], v36 offset:9216
  ds_read_b64_tr_b16 v[174:175], v36 offset:9344
  s_waitcnt lgkmcnt(0)
  s_xor_b32 s36, s13, 4
  s_lshl_b32 s36, s36, 19
  s_add_u32 m0, s39, 8192
  s_add_u32 s37, s36, 0
  buffer_load_dwordx4 v25, s[40:43], s37 offen lds
  s_add_u32 m0, s39, 9216
  s_add_u32 s37, s36, 131072
  buffer_load_dwordx4 v25, s[40:43], s37 offen lds
  s_add_u32 m0, s39, 10240
  s_add_u32 s37, s36, 262144
  buffer_load_dwordx4 v25, s[40:43], s37 offen lds
  s_add_u32 m0, s39, 11264
  s_add_u32 s37, s36, 393216
  buffer_load_dwordx4 v25, s[40:43], s37 offen lds
  s_waitcnt vmcnt(12)
  ds_read_b64_tr_b16 v[192:193], v27 offset:12288
  ds_read_b64_tr_b16 v[194:195], v27 offset:12416
  ds_read_b64_tr_b16 v[196:197], v27 offset:13312
  ds_read_b64_tr_b16 v[198:199], v27 offset:13440
  ds_read_b64_tr_b16 v[200:201], v36 offset:12288
  ds_read_b64_tr_b16 v[202:203], v36 offset:12416
  ds_read_b64_tr_b16 v[204:205], v36 offset:13312
  ds_read_b64_tr_b16 v[206:207], v36 offset:13440
  s_waitcnt lgkmcnt(0)
  s_xor_b32 s36, s13, 5
  s_lshl_b32 s36, s36, 19
  s_add_u32 m0, s39, 12288
  s_add_u32 s37, s36, 0
  buffer_load_dwordx4 v25, s[40:43], s37 offen lds
  s_add_u32 m0, s39, 13312
  s_add_u32 s37, s36, 131072
  buffer_load_dwordx4 v25, s[40:43], s37 offen lds
  s_add_u32 m0, s39, 14336
  s_add_u32 s37, s36, 262144
  buffer_load_dwordx4 v25, s[40:43], s37 offen lds
  s_add_u32 m0, s39, 15360
  s_add_u32 s37, s36, 393216
  buffer_load_dwordx4 v25, s[40:43], s37 offen lds
  s_waitcnt vmcnt(12)
  ds_read_b64_tr_b16 v[224:225], v27 offset:0
  ds_read_b64_tr_b16 v[226:227], v27 offset:128
  ds_read_b64_tr_b16 v[228:229], v27 offset:1024
  ds_read_b64_tr_b16 v[230:231], v27 offset:1152
  ds_read_b64_tr_b16 v[232:233], v36 offset:0
  ds_read_b64_tr_b16 v[234:235], v36 offset:128
  ds_read_b64_tr_b16 v[236:237], v36 offset:1024
  ds_read_b64_tr_b16 v[238:239], v36 offset:1152
  s_waitcnt lgkmcnt(0)
  s_xor_b32 s36, s13, 4
  s_lshl_b32 s36, s36, 19
  s_add_u32 m0, s39, 0
  s_add_u32 s37, s36, 0
  buffer_load_dwordx4 v25, s[44:47], s37 offen lds
  s_add_u32 m0, s39, 1024
  s_add_u32 s37, s36, 131072
  buffer_load_dwordx4 v25, s[44:47], s37 offen lds
  s_add_u32 m0, s39, 2048
  s_add_u32 s37, s36, 262144
  buffer_load_dwordx4 v25, s[44:47], s37 offen lds
  s_add_u32 m0, s39, 3072
  s_add_u32 s37, s36, 393216
  buffer_load_dwordx4 v25, s[44:47], s37 offen lds
  s_waitcnt vmcnt(12)
  ds_read_b64_tr_b16 a[16:17], v27 offset:4096
  ds_read_b64_tr_b16 a[18:19], v27 offset:4224
  ds_read_b64_tr_b16 a[20:21], v27 offset:5120
  ds_read_b64_tr_b16 a[22:23], v27 offset:5248
  ds_read_b64_tr_b16 a[24:25], v36 offset:4096
  ds_read_b64_tr_b16 a[26:27], v36 offset:4224
  ds_read_b64_tr_b16 a[28:29], v36 offset:5120
  ds_read_b64_tr_b16 a[30:31], v36 offset:5248
  s_waitcnt lgkmcnt(0)
  s_xor_b32 s36, s13, 5
  s_lshl_b32 s36, s36, 19
  s_add_u32 m0, s39, 4096
  s_add_u32 s37, s36, 0
  buffer_load_dwordx4 v25, s[44:47], s37 offen lds
  s_add_u32 m0, s39, 5120
  s_add_u32 s37, s36, 131072
  buffer_load_dwordx4 v25, s[44:47], s37 offen lds
  s_add_u32 m0, s39, 6144
  s_add_u32 s37, s36, 262144
  buffer_load_dwordx4 v25, s[44:47], s37 offen lds
  s_add_u32 m0, s39, 7168
  s_add_u32 s37, s36, 393216
  buffer_load_dwordx4 v25, s[44:47], s37 offen lds
  s_waitcnt vmcnt(12)
  ds_read_b64_tr_b16 v[240:241], v27 offset:8192
  ds_read_b64_tr_b16 v[242:243], v27 offset:8320
  ds_read_b64_tr_b16 v[244:245], v27 offset:9216
  ds_read_b64_tr_b16 v[246:247], v27 offset:9344
  ds_read_b64_tr_b16 v[248:249], v36 offset:8192
  ds_read_b64_tr_b16 v[250:251], v36 offset:8320
  ds_read_b64_tr_b16 v[252:253], v36 offset:9216
  ds_read_b64_tr_b16 v[254:255], v36 offset:9344
  s_waitcnt lgkmcnt(0)
  s_xor_b32 s36, s13, 6
  s_lshl_b32 s36, s36, 19
  s_add_u32 m0, s39, 8192
  s_add_u32 s37, s36, 0
  buffer_load_dwordx4 v25, s[8:11], s37 offen lds
  s_add_u32 m0, s39, 9216
  s_add_u32 s37, s36, 131072
  buffer_load_dwordx4 v25, s[8:11], s37 offen lds
  s_add_u32 m0, s39, 10240
  s_add_u32 s37, s36, 262144
  buffer_load_dwordx4 v25, s[8:11], s37 offen lds
  s_add_u32 m0, s39, 11264
  s_add_u32 s37, s36, 393216
  buffer_load_dwordx4 v25, s[8:11], s37 offen lds
  s_waitcnt vmcnt(12)
  ds_read_b64_tr_b16 a[32:33], v27 offset:12288
  ds_read_b64_tr_b16 a[34:35], v27 offset:12416
  ds_read_b64_tr_b16 a[36:37], v27 offset:13312
  ds_read_b64_tr_b16 a[38:39], v27 offset:13440
  ds_read_b64_tr_b16 a[40:41], v36 offset:12288
  ds_read_b64_tr_b16 a[42:43], v36 offset:12416
  ds_read_b64_tr_b16 a[44:45], v36 offset:13312
  ds_read_b64_tr_b16 a[46:47], v36 offset:13440
  s_waitcnt lgkmcnt(0)
  s_xor_b32 s36, s13, 7
  s_lshl_b32 s36, s36, 19
  s_add_u32 m0, s39, 12288
  s_add_u32 s37, s36, 0
  buffer_load_dwordx4 v25, s[8:11], s37 offen lds
  s_add_u32 m0, s39, 13312
  s_add_u32 s37, s36, 131072
  buffer_load_dwordx4 v25, s[8:11], s37 offen lds
  s_add_u32 m0, s39, 14336
  s_add_u32 s37, s36, 262144
  buffer_load_dwordx4 v25, s[8:11], s37 offen lds
  s_add_u32 m0, s39, 15360
  s_add_u32 s37, s36, 393216
  buffer_load_dwordx4 v25, s[8:11], s37 offen lds
  s_waitcnt vmcnt(12)
  ds_read_b64_tr_b16 a[0:1], v27 offset:0
  ds_read_b64_tr_b16 a[2:3], v27 offset:128
  ds_read_b64_tr_b16 a[4:5], v27 offset:1024
  ds_read_b64_tr_b16 a[6:7], v27 offset:1152
  ds_read_b64_tr_b16 a[8:9], v36 offset:0
  ds_read_b64_tr_b16 a[10:11], v36 offset:128
  ds_read_b64_tr_b16 a[12:13], v36 offset:1024
  ds_read_b64_tr_b16 a[14:15], v36 offset:1152
  s_waitcnt lgkmcnt(0)
  s_xor_b32 s36, s13, 6
  s_lshl_b32 s36, s36, 19
  s_add_u32 m0, s39, 0
  s_add_u32 s37, s36, 0
  buffer_load_dwordx4 v25, s[40:43], s37 offen lds
  s_add_u32 m0, s39, 1024
  s_add_u32 s37, s36, 131072
  buffer_load_dwordx4 v25, s[40:43], s37 offen lds
  s_add_u32 m0, s39, 2048
  s_add_u32 s37, s36, 262144
  buffer_load_dwordx4 v25, s[40:43], s37 offen lds
  s_add_u32 m0, s39, 3072
  s_add_u32 s37, s36, 393216
  buffer_load_dwordx4 v25, s[40:43], s37 offen lds
  s_waitcnt vmcnt(12)
  ds_read_b64_tr_b16 a[48:49], v27 offset:4096
  ds_read_b64_tr_b16 a[50:51], v27 offset:4224
  ds_read_b64_tr_b16 a[52:53], v27 offset:5120
  ds_read_b64_tr_b16 a[54:55], v27 offset:5248
  ds_read_b64_tr_b16 a[56:57], v36 offset:4096
  ds_read_b64_tr_b16 a[58:59], v36 offset:4224
  ds_read_b64_tr_b16 a[60:61], v36 offset:5120
  ds_read_b64_tr_b16 a[62:63], v36 offset:5248
  s_waitcnt lgkmcnt(0)
  s_xor_b32 s36, s13, 7
  s_lshl_b32 s36, s36, 19
  s_add_u32 m0, s39, 4096
  s_add_u32 s37, s36, 0
  buffer_load_dwordx4 v25, s[40:43], s37 offen lds
  s_add_u32 m0, s39, 5120
  s_add_u32 s37, s36, 131072
  buffer_load_dwordx4 v25, s[40:43], s37 offen lds
  s_add_u32 m0, s39, 6144
  s_add_u32 s37, s36, 262144
  buffer_load_dwordx4 v25, s[40:43], s37 offen lds
  s_add_u32 m0, s39, 7168
  s_add_u32 s37, s36, 393216
  buffer_load_dwordx4 v25, s[40:43], s37 offen lds
  s_waitcnt vmcnt(12)
  ds_read_b64_tr_b16 a[64:65], v27 offset:8192
  ds_read_b64_tr_b16 a[66:67], v27 offset:8320
  ds_read_b64_tr_b16 a[68:69], v27 offset:9216
  ds_read_b64_tr_b16 a[70:71], v27 offset:9344
  ds_read_b64_tr_b16 a[72:73], v36 offset:8192
  ds_read_b64_tr_b16 a[74:75], v36 offset:8320
  ds_read_b64_tr_b16 a[76:77], v36 offset:9216
  ds_read_b64_tr_b16 a[78:79], v36 offset:9344
  s_waitcnt lgkmcnt(0)
  s_xor_b32 s36, s13, 6
  s_lshl_b32 s36, s36, 19
  s_add_u32 m0, s39, 8192
  s_add_u32 s37, s36, 0
  buffer_load_dwordx4 v25, s[44:47], s37 offen lds
  s_add_u32 m0, s39, 9216
  s_add_u32 s37, s36, 131072
  buffer_load_dwordx4 v25, s[44:47], s37 offen lds
  s_add_u32 m0, s39, 10240
  s_add_u32 s37, s36, 262144
  buffer_load_dwordx4 v25, s[44:47], s37 offen lds
  s_add_u32 m0, s39, 11264
  s_add_u32 s37, s36, 393216
  buffer_load_dwordx4 v25, s[44:47], s37 offen lds
  s_waitcnt vmcnt(12)
  ds_read_b64_tr_b16 a[112:113], v27 offset:12288
  ds_read_b64_tr_b16 a[114:115], v27 offset:12416
  ds_read_b64_tr_b16 a[116:117], v27 offset:13312
  ds_read_b64_tr_b16 a[118:119], v27 offset:13440
  ds_read_b64_tr_b16 a[120:121], v36 offset:12288
  ds_read_b64_tr_b16 a[122:123], v36 offset:12416
  ds_read_b64_tr_b16 a[124:125], v36 offset:13312
  ds_read_b64_tr_b16 a[126:127], v36 offset:13440
  s_waitcnt lgkmcnt(0)
  s_xor_b32 s36, s13, 7
  s_lshl_b32 s36, s36, 19
  s_add_u32 m0, s39, 12288
  s_add_u32 s37, s36, 0
  buffer_load_dwordx4 v25, s[44:47], s37 offen lds
  s_add_u32 m0, s39, 13312
  s_add_u32 s37, s36, 131072
  buffer_load_dwordx4 v25, s[44:47], s37 offen lds
  s_add_u32 m0, s39, 14336
  s_add_u32 s37, s36, 262144
  buffer_load_dwordx4 v25, s[44:47], s37 offen lds
  s_add_u32 m0, s39, 15360
  s_add_u32 s37, s36, 393216
  buffer_load_dwordx4 v25, s[44:47], s37 offen lds
  s_waitcnt vmcnt(12)
  ds_read_b64_tr_b16 a[80:81], v27 offset:0
  ds_read_b64_tr_b16 a[82:83], v27 offset:128
  ds_read_b64_tr_b16 a[84:85], v27 offset:1024
  ds_read_b64_tr_b16 a[86:87], v27 offset:1152
  ds_read_b64_tr_b16 a[88:89], v36 offset:0
  ds_read_b64_tr_b16 a[90:91], v36 offset:128
  ds_read_b64_tr_b16 a[92:93], v36 offset:1024
  ds_read_b64_tr_b16 a[94:95], v36 offset:1152
  s_waitcnt lgkmcnt(0)
  s_xor_b32 s36, s13, 1
  s_lshl_b32 s36, s36, 19
  s_add_u32 m0, s39, 16384
  s_add_u32 s37, s36, 0
  buffer_load_dwordx4 v25, s[8:11], s37 offen lds
  s_add_u32 m0, s39, 17408
  s_add_u32 s37, s36, 131072
  buffer_load_dwordx4 v25, s[8:11], s37 offen lds
  s_add_u32 m0, s39, 18432
  s_add_u32 s37, s36, 262144
  buffer_load_dwordx4 v25, s[8:11], s37 offen lds
  s_add_u32 m0, s39, 19456
  s_add_u32 s37, s36, 393216
  buffer_load_dwordx4 v25, s[8:11], s37 offen lds
  s_waitcnt vmcnt(12)
  ds_read_b64_tr_b16 a[128:129], v27 offset:4096
  ds_read_b64_tr_b16 a[130:131], v27 offset:4224
  ds_read_b64_tr_b16 a[132:133], v27 offset:5120
  ds_read_b64_tr_b16 a[134:135], v27 offset:5248
  ds_read_b64_tr_b16 a[136:137], v36 offset:4096
  ds_read_b64_tr_b16 a[138:139], v36 offset:4224
  ds_read_b64_tr_b16 a[140:141], v36 offset:5120
  ds_read_b64_tr_b16 a[142:143], v36 offset:5248
  s_waitcnt lgkmcnt(0)
  s_xor_b32 s36, s13, 0
  s_lshl_b32 s36, s36, 19
  s_add_u32 m0, s39, 0
  s_add_u32 s37, s36, 0
  buffer_load_dwordx4 v25, s[8:11], s37 offen lds
  s_add_u32 m0, s39, 1024
  s_add_u32 s37, s36, 131072
  buffer_load_dwordx4 v25, s[8:11], s37 offen lds
  s_add_u32 m0, s39, 2048
  s_add_u32 s37, s36, 262144
  buffer_load_dwordx4 v25, s[8:11], s37 offen lds
  s_add_u32 m0, s39, 3072
  s_add_u32 s37, s36, 393216
  buffer_load_dwordx4 v25, s[8:11], s37 offen lds
  s_waitcnt vmcnt(12)
  ds_read_b64_tr_b16 a[96:97], v27 offset:8192
  ds_read_b64_tr_b16 a[98:99], v27 offset:8320
  ds_read_b64_tr_b16 a[100:101], v27 offset:9216
  ds_read_b64_tr_b16 a[102:103], v27 offset:9344
  ds_read_b64_tr_b16 a[104:105], v36 offset:8192
  ds_read_b64_tr_b16 a[106:107], v36 offset:8320
  ds_read_b64_tr_b16 a[108:109], v36 offset:9216
  ds_read_b64_tr_b16 a[110:111], v36 offset:9344
  s_waitcnt lgkmcnt(0)
  s_xor_b32 s36, s13, 1
  s_lshl_b32 s36, s36, 19
  s_add_u32 m0, s39, 8192
  s_add_u32 s37, s36, 0
  buffer_load_dwordx4 v25, s[40:43], s37 offen lds
  s_add_u32 m0, s39, 9216
  s_add_u32 s37, s36, 131072
  buffer_load_dwordx4 v25, s[40:43], s37 offen lds
  s_add_u32 m0, s39, 10240
  s_add_u32 s37, s36, 262144
  buffer_load_dwordx4 v25, s[40:43], s37 offen lds
  s_add_u32 m0, s39, 11264
  s_add_u32 s37, s36, 393216
  buffer_load_dwordx4 v25, s[40:43], s37 offen lds
  s_waitcnt vmcnt(12)
  ds_read_b64_tr_b16 a[144:145], v27 offset:12288
  ds_read_b64_tr_b16 a[146:147], v27 offset:12416
  ds_read_b64_tr_b16 a[148:149], v27 offset:13312
  ds_read_b64_tr_b16 a[150:151], v27 offset:13440
  ds_read_b64_tr_b16 a[152:153], v36 offset:12288
  ds_read_b64_tr_b16 a[154:155], v36 offset:12416
  ds_read_b64_tr_b16 a[156:157], v36 offset:13312
  ds_read_b64_tr_b16 a[158:159], v36 offset:13440
  s_waitcnt lgkmcnt(0)
  s_xor_b32 s36, s13, 0
  s_lshl_b32 s36, s36, 19
  s_add_u32 m0, s39, 4096
  s_add_u32 s37, s36, 0
  buffer_load_dwordx4 v25, s[40:43], s37 offen lds
  s_add_u32 m0, s39, 5120
  s_add_u32 s37, s36, 131072
  buffer_load_dwordx4 v25, s[40:43], s37 offen lds
  s_add_u32 m0, s39, 6144
  s_add_u32 s37, s36, 262144
  buffer_load_dwordx4 v25, s[40:43], s37 offen lds
  s_add_u32 m0, s39, 7168
  s_add_u32 s37, s36, 393216
  buffer_load_dwordx4 v25, s[40:43], s37 offen lds
  s_waitcnt vmcnt(12)
  ds_read_b64_tr_b16 v[128:129], v27 offset:16384
  ds_read_b64_tr_b16 v[130:131], v27 offset:16512
  ds_read_b64_tr_b16 v[132:133], v27 offset:17408
  ds_read_b64_tr_b16 v[134:135], v27 offset:17536
  ds_read_b64_tr_b16 v[136:137], v36 offset:16384
  ds_read_b64_tr_b16 v[138:139], v36 offset:16512
  ds_read_b64_tr_b16 v[140:141], v36 offset:17408
  ds_read_b64_tr_b16 v[142:143], v36 offset:17536
  s_waitcnt lgkmcnt(0)
  s_xor_b32 s36, s13, 2
  s_lshl_b32 s36, s36, 19
  s_add_u32 m0, s39, 12288
  s_add_u32 s37, s36, 0
  buffer_load_dwordx4 v25, s[40:43], s37 offen lds
  s_add_u32 m0, s39, 13312
  s_add_u32 s37, s36, 131072
  buffer_load_dwordx4 v25, s[40:43], s37 offen lds
  s_add_u32 m0, s39, 14336
  s_add_u32 s37, s36, 262144
  buffer_load_dwordx4 v25, s[40:43], s37 offen lds
  s_add_u32 m0, s39, 15360
  s_add_u32 s37, s36, 393216
  buffer_load_dwordx4 v25, s[40:43], s37 offen lds
  s_waitcnt vmcnt(12)
  ds_read_b64_tr_b16 v[64:65], v27 offset:0
  ds_read_b64_tr_b16 v[66:67], v27 offset:128
  ds_read_b64_tr_b16 v[68:69], v27 offset:1024
  ds_read_b64_tr_b16 v[70:71], v27 offset:1152
  ds_read_b64_tr_b16 v[72:73], v36 offset:0
  ds_read_b64_tr_b16 v[74:75], v36 offset:128
  ds_read_b64_tr_b16 v[76:77], v36 offset:1024
  ds_read_b64_tr_b16 v[78:79], v36 offset:1152
  s_waitcnt lgkmcnt(0)
  ds_write_b128 v4, v[64:67] offset:0
  ds_write_b128 v4, v[68:71] offset:1024
  ds_write_b128 v4, v[72:75] offset:2048
  ds_write_b128 v4, v[76:79] offset:3072
  s_waitcnt lgkmcnt(0)
  s_xor_b32 s36, s13, 3
  s_lshl_b32 s36, s36, 19
  s_add_u32 m0, s39, 16384
  s_add_u32 s37, s36, 0
  buffer_load_dwordx4 v25, s[40:43], s37 offen lds
  s_add_u32 m0, s39, 17408
  s_add_u32 s37, s36, 131072
  buffer_load_dwordx4 v25, s[40:43], s37 offen lds
  s_add_u32 m0, s39, 18432
  s_add_u32 s37, s36, 262144
  buffer_load_dwordx4 v25, s[40:43], s37 offen lds
  s_add_u32 m0, s39, 19456
  s_add_u32 s37, s36, 393216
  buffer_load_dwordx4 v25, s[40:43], s37 offen lds
  s_waitcnt vmcnt(12)
  ds_read_b64_tr_b16 v[144:145], v27 offset:8192
  ds_read_b64_tr_b16 v[146:147], v27 offset:8320
  ds_read_b64_tr_b16 v[148:149], v27 offset:9216
  ds_read_b64_tr_b16 v[150:151], v27 offset:9344
  ds_read_b64_tr_b16 v[152:153], v36 offset:8192
  ds_read_b64_tr_b16 v[154:155], v36 offset:8320
  ds_read_b64_tr_b16 v[156:157], v36 offset:9216
  ds_read_b64_tr_b16 v[158:159], v36 offset:9344
  s_waitcnt lgkmcnt(0)
  s_xor_b32 s36, s13, 3
  s_lshl_b32 s36, s36, 19
  s_add_u32 m0, s39, 24576
  s_add_u32 s37, s36, 0
  buffer_load_dwordx4 v25, s[44:47], s37 offen lds
  s_add_u32 m0, s39, 25600
  s_add_u32 s37, s36, 131072
  buffer_load_dwordx4 v25, s[44:47], s37 offen lds
  s_add_u32 m0, s39, 26624
  s_add_u32 s37, s36, 262144
  buffer_load_dwordx4 v25, s[44:47], s37 offen lds
  s_add_u32 m0, s39, 27648
  s_add_u32 s37, s36, 393216
  buffer_load_dwordx4 v25, s[44:47], s37 offen lds
  buffer_load_dwordx2 v[54:55], off, s[72:75], 0 sc1
  buffer_load_dword v56, off, s[72:75], 0 offset:128 sc1
  s_waitcnt vmcnt(14)
  ds_read_b64_tr_b16 v[64:65], v27 offset:4096
  ds_read_b64_tr_b16 v[66:67], v27 offset:4224
  ds_read_b64_tr_b16 v[68:69], v27 offset:5120
  ds_read_b64_tr_b16 v[70:71], v27 offset:5248
  ds_read_b64_tr_b16 v[72:73], v36 offset:4096
  ds_read_b64_tr_b16 v[74:75], v36 offset:4224
  ds_read_b64_tr_b16 v[76:77], v36 offset:5120
  ds_read_b64_tr_b16 v[78:79], v36 offset:5248
  s_waitcnt lgkmcnt(0)
  ds_write_b128 v4, v[64:67] offset:4096
  ds_write_b128 v4, v[68:71] offset:5120
  ds_write_b128 v4, v[72:75] offset:6144
  ds_write_b128 v4, v[76:79] offset:7168
  s_waitcnt lgkmcnt(0)
  s_xor_b32 s36, s13, 2
  s_lshl_b32 s36, s36, 19
  s_add_u32 m0, s39, 20480
  s_add_u32 s37, s36, 0
  buffer_load_dwordx4 v25, s[44:47], s37 offen lds
  s_add_u32 m0, s39, 21504
  s_add_u32 s37, s36, 131072
  buffer_load_dwordx4 v25, s[44:47], s37 offen lds
  s_add_u32 m0, s39, 22528
  s_add_u32 s37, s36, 262144
  buffer_load_dwordx4 v25, s[44:47], s37 offen lds
  s_add_u32 m0, s39, 23552
  s_add_u32 s37, s36, 393216
  buffer_load_dwordx4 v25, s[44:47], s37 offen lds
  s_waitcnt vmcnt(14)
  ds_read_b64_tr_b16 v[176:177], v27 offset:12288
  ds_read_b64_tr_b16 v[178:179], v27 offset:12416
  ds_read_b64_tr_b16 v[180:181], v27 offset:13312
  ds_read_b64_tr_b16 v[182:183], v27 offset:13440
  ds_read_b64_tr_b16 v[184:185], v36 offset:12288
  ds_read_b64_tr_b16 v[186:187], v36 offset:12416
  ds_read_b64_tr_b16 v[188:189], v36 offset:13312
  ds_read_b64_tr_b16 v[190:191], v36 offset:13440
  s_waitcnt lgkmcnt(0)
  s_xor_b32 s36, s13, 0
  s_lshl_b32 s36, s36, 19
  s_add_u32 m0, s39, 8192
  s_add_u32 s37, s36, 0
  buffer_load_dwordx4 v25, s[44:47], s37 offen lds
  s_add_u32 m0, s39, 9216
  s_add_u32 s37, s36, 131072
  buffer_load_dwordx4 v25, s[44:47], s37 offen lds
  s_add_u32 m0, s39, 10240
  s_add_u32 s37, s36, 262144
  buffer_load_dwordx4 v25, s[44:47], s37 offen lds
  s_add_u32 m0, s39, 11264
  s_add_u32 s37, s36, 393216
  buffer_load_dwordx4 v25, s[44:47], s37 offen lds
  s_waitcnt vmcnt(14)
  ds_read_b64_tr_b16 v[64:65], v27 offset:16384
  ds_read_b64_tr_b16 v[66:67], v27 offset:16512
  ds_read_b64_tr_b16 v[68:69], v27 offset:17408
  ds_read_b64_tr_b16 v[70:71], v27 offset:17536
  ds_read_b64_tr_b16 v[72:73], v36 offset:16384
  ds_read_b64_tr_b16 v[74:75], v36 offset:16512
  ds_read_b64_tr_b16 v[76:77], v36 offset:17408
  ds_read_b64_tr_b16 v[78:79], v36 offset:17536
  s_waitcnt lgkmcnt(0)
  ds_write_b128 v4, v[64:67] offset:16384
  ds_write_b128 v4, v[68:71] offset:17408
  ds_write_b128 v4, v[72:75] offset:18432
  ds_write_b128 v4, v[76:79] offset:19456
  s_waitcnt lgkmcnt(0)
  s_xor_b32 s36, s13, 1
  s_lshl_b32 s36, s36, 19
  s_add_u32 m0, s39, 12288
  s_add_u32 s37, s36, 0
  buffer_load_dwordx4 v25, s[44:47], s37 offen lds
  s_add_u32 m0, s39, 13312
  s_add_u32 s37, s36, 131072
  buffer_load_dwordx4 v25, s[44:47], s37 offen lds
  s_add_u32 m0, s39, 14336
  s_add_u32 s37, s36, 262144
  buffer_load_dwordx4 v25, s[44:47], s37 offen lds
  s_add_u32 m0, s39, 15360
  s_add_u32 s37, s36, 393216
  buffer_load_dwordx4 v25, s[44:47], s37 offen lds
  s_waitcnt vmcnt(14)
  ds_read_b64_tr_b16 v[208:209], v27 offset:24576
  ds_read_b64_tr_b16 v[210:211], v27 offset:24704
  ds_read_b64_tr_b16 v[212:213], v27 offset:25600
  ds_read_b64_tr_b16 v[214:215], v27 offset:25728
  ds_read_b64_tr_b16 v[216:217], v36 offset:24576
  ds_read_b64_tr_b16 v[218:219], v36 offset:24704
  ds_read_b64_tr_b16 v[220:221], v36 offset:25600
  ds_read_b64_tr_b16 v[222:223], v36 offset:25728
  s_waitcnt lgkmcnt(0)
  s_xor_b32 s36, s13, 2
  s_lshl_b32 s36, s36, 15
  s_add_u32 m0, s39, 24576
  s_add_u32 s37, s36, 512
  buffer_load_dwordx4 v26, s[48:51], s37 offen lds
  s_add_u32 m0, s39, 25600
  s_add_u32 s37, s36, 8704
  buffer_load_dwordx4 v26, s[48:51], s37 offen lds
  s_add_u32 m0, s39, 26624
  s_add_u32 s37, s36, 16896
  buffer_load_dwordx4 v26, s[48:51], s37 offen lds
  s_add_u32 m0, s39, 27648
  s_add_u32 s37, s36, 25088
  buffer_load_dwordx4 v26, s[48:51], s37 offen lds
  s_waitcnt vmcnt(12)
  ds_read_b64_tr_b16 v[64:65], v27 offset:20480
  ds_read_b64_tr_b16 v[66:67], v27 offset:20608
  ds_read_b64_tr_b16 v[68:69], v27 offset:21504
  ds_read_b64_tr_b16 v[70:71], v27 offset:21632
  ds_read_b64_tr_b16 v[72:73], v36 offset:20480
  ds_read_b64_tr_b16 v[74:75], v36 offset:20608
  ds_read_b64_tr_b16 v[76:77], v36 offset:21504
  ds_read_b64_tr_b16 v[78:79], v36 offset:21632
  s_waitcnt lgkmcnt(0)
  ds_write_b128 v4, v[64:67] offset:20480
  ds_write_b128 v4, v[68:71] offset:21504
  ds_write_b128 v4, v[72:75] offset:22528
  ds_write_b128 v4, v[76:79] offset:23552
  s_waitcnt lgkmcnt(0)
  s_xor_b32 s36, s13, 3
  s_lshl_b32 s36, s36, 15
  s_add_u32 m0, s39, 28672
  s_add_u32 s37, s36, 512
  buffer_load_dwordx4 v26, s[48:51], s37 offen lds
  s_add_u32 m0, s39, 29696
  s_add_u32 s37, s36, 8704
  buffer_load_dwordx4 v26, s[48:51], s37 offen lds
  s_add_u32 m0, s39, 30720
  s_add_u32 s37, s36, 16896
  buffer_load_dwordx4 v26, s[48:51], s37 offen lds
  s_add_u32 m0, s39, 31744
  s_add_u32 s37, s36, 25088
  buffer_load_dwordx4 v26, s[48:51], s37 offen lds
  s_mov_b32 s19, 0
  s_branch T_arrgo_74
T_arr_73:
  s_add_u32 s19, s19, 1
  s_cmp_gt_u32 s19, 32768
  s_cbranch_scc1 M_exit
  buffer_load_dwordx2 v[54:55], off, s[72:75], 0 sc1
  buffer_load_dword v56, off, s[72:75], 0 offset:128 sc1
  s_waitcnt vmcnt(0)
T_arrgo_74:
  v_sad_u8 v57, v54, 0, 0
  v_sad_u8 v57, v55, 0, v57
  v_or_b32 v58, v54, v55
  v_cmp_gt_u32 vcc, 32, v57
  s_cbranch_vccnz T_arr_73
  v_cmp_gt_u32 vcc, 0x100, v56
  s_cbranch_vccnz T_arr_73
  v_readfirstlane_b32 s36, v58
  s_nop 0
  s_and_b32 s36, s36, 0x20202020
  s_cselect_b32 s56, 0, 1
  s_mov_b32 s14, -1
  s_mov_b32 s30, -1
  s_mov_b32 s19, 0
  s_branch T_kvok_76
T_kv_75:
  s_sleep 4
  s_add_u32 s19, s19, 1
  s_cmp_gt_u32 s19, 32768
  s_cbranch_scc1 M_exit
T_kvok_76:
  s_add_u32 s39, s99, 128
  s_mov_b32 s38, 0
  s_mov_b32 s37, 0
  s_atomic_or s38, s[58:59], s99 glc
  s_atomic_or s37, s[58:59], s39 glc
  s_waitcnt lgkmcnt(0)
  s_add_u32 s37, s37, 30
  s_cmp_ge_u32 s38, 30
  s_cselect_b32 s38, s37, s38
  s_cmp_ge_u32 s38, 64
  s_cselect_b32 s38, 100, s38
  s_sub_u32 s38, s38, 1
  s_max_i32 s30, s30, s38
  s_cmp_ge_i32 s14, s30
  s_cbranch_scc1 T_kv_75
  s_mov_b32 m0, s31
  s_nop 0
  buffer_load_dwordx4 v9, s[4:7], s27 offen sc1 lds
  s_mov_b32 m0, s32
  s_nop 0
  buffer_load_dwordx4 v9, s[4:7], s27 offen offset:128 sc1 lds
  s_mov_b32 m0, s33
  s_nop 0
  buffer_load_dwordx4 v10, s[4:7], s28 offen sc1 lds
  s_mov_b32 m0, s34
  s_nop 0
  buffer_load_dwordx4 v10, s[4:7], s28 offen offset:256 sc1 lds
  s_add_u32 s27, s27, 8192
  s_add_u32 s28, s28, 8192
  s_lshl_b32 s36, s12, 10
  s_add_u32 s36, s36, 145752064
  buffer_load_dwordx4 v[40:43], v2, s[4:7], s36 offen sc1
  s_waitcnt vmcnt(17)
  ds_read_b64_tr_b16 v[64:65], v27 offset:8192
  ds_read_b64_tr_b16 v[66:67], v27 offset:8320
  ds_read_b64_tr_b16 v[68:69], v27 offset:9216
  ds_read_b64_tr_b16 v[70:71], v27 offset:9344
  ds_read_b64_tr_b16 v[72:73], v36 offset:8192
  ds_read_b64_tr_b16 v[74:75], v36 offset:8320
  ds_read_b64_tr_b16 v[76:77], v36 offset:9216
  ds_read_b64_tr_b16 v[78:79], v36 offset:9344
  s_waitcnt lgkmcnt(0)
  ds_write_b128 v4, v[64:67] offset:8192
  ds_write_b128 v4, v[68:71] offset:9216
  ds_write_b128 v4, v[72:75] offset:10240
  ds_write_b128 v4, v[76:79] offset:11264
  s_waitcnt lgkmcnt(0)
  s_waitcnt vmcnt(13)
  ds_read_b64_tr_b16 v[64:65], v27 offset:12288
  ds_read_b64_tr_b16 v[66:67], v27 offset:12416
  ds_read_b64_tr_b16 v[68:69], v27 offset:13312
  ds_read_b64_tr_b16 v[70:71], v27 offset:13440
  ds_read_b64_tr_b16 v[72:73], v36 offset:12288
  ds_read_b64_tr_b16 v[74:75], v36 offset:12416
  ds_read_b64_tr_b16 v[76:77], v36 offset:13312
  ds_read_b64_tr_b16 v[78:79], v36 offset:13440
  s_waitcnt lgkmcnt(0)
  ds_write_b128 v4, v[64:67] offset:12288
  ds_write_b128 v4, v[68:71] offset:13312
  ds_write_b128 v4, v[72:75] offset:14336
  ds_write_b128 v4, v[76:79] offset:15360
  s_waitcnt lgkmcnt(0)
  s_waitcnt vmcnt(9)
  ds_read_b64_tr_b16 v[64:65], v28 offset:24576
  ds_read_b64_tr_b16 v[66:67], v28 offset:24832
  ds_read_b64_tr_b16 v[68:69], v28 offset:25600
  ds_read_b64_tr_b16 v[70:71], v28 offset:25856
  ds_read_b64_tr_b16 v[72:73], v28 offset:24584
  ds_read_b64_tr_b16 v[74:75], v28 offset:24840
  ds_read_b64_tr_b16 v[76:77], v28 offset:25608
  ds_read_b64_tr_b16 v[78:79], v28 offset:25864
  s_waitcnt lgkmcnt(0)
  ds_write_b128 v4, v[64:67] offset:24576
  ds_write_b128 v4, v[68:71] offset:25600
  ds_write_b128 v4, v[72:75] offset:26624
  ds_write_b128 v4, v[76:79] offset:27648
  s_waitcnt lgkmcnt(0)
  s_waitcnt vmcnt(5)
  ds_read_b64_tr_b16 v[64:65], v28 offset:28672
  ds_read_b64_tr_b16 v[66:67], v28 offset:28928
  ds_read_b64_tr_b16 v[68:69], v28 offset:29696
  ds_read_b64_tr_b16 v[70:71], v28 offset:29952
  ds_read_b64_tr_b16 v[72:73], v28 offset:28680
  ds_read_b64_tr_b16 v[74:75], v28 offset:28936
  ds_read_b64_tr_b16 v[76:77], v28 offset:29704
  ds_read_b64_tr_b16 v[78:79], v28 offset:29960
  s_waitcnt lgkmcnt(0)
  ds_write_b128 v4, v[64:67] offset:28672
  ds_write_b128 v4, v[68:71] offset:29696
  ds_write_b128 v4, v[72:75] offset:30720
  ds_write_b128 v4, v[76:79] offset:31744
  s_waitcnt lgkmcnt(0)
  s_waitcnt vmcnt(0) lgkmcnt(0)
  s_barrier
  s_cmp_ge_u32 s13, 2
  s_cselect_b64 vcc, -1, 0
  v_cndmask_b32 v8, v8, v19, vcc
  ds_read_b128 v[68:71], v4 offset:0
  ds_read_b128 v[72:75], v4 offset:1024
  ds_read_b128 v[76:79], v4 offset:4096
  ds_read_b128 v[80:83], v4 offset:5120
  ds_read_b128 v[84:87], v4 offset:8192
  ds_read_b128 v[88:91], v4 offset:9216
  ds_read_b128 v[92:95], v4 offset:2048
  ds_read_b128 v[96:99], v4 offset:3072
  ds_read_b128 v[100:103], v4 offset:6144
  ds_read_b128 v[104:107], v4 offset:7168
  ds_read_b128 v[108:111], v4 offset:10240
  ds_read_b128 v[112:115], v4 offset:11264
  ds_read_b128 v[28:31], v59 offset:16384
  ds_read_b128 v[32:35], v59 offset:20480
  ds_read_b128 v[36:39], v2 offset:8192
  ds_read_b128 v[40:43], v2 offset:9216
  ds_read_b128 v[44:47], v2 offset:10240
  ds_read_b128 v[48:51], v2 offset:11264
  ds_read_b128 v[52:55], v2 offset:12288
  ds_read_b128 v[56:59], v2 offset:13312
  ds_read_b128 v[60:63], v2 offset:14336
  ds_read_b128 v[64:67], v2 offset:15360
  s_and_b32 s36, s13, 1
  s_lshl_b32 s36, s36, 12
  s_add_u32 s22, s22, s36
  s_add_u32 s23, s36, 145752064
  s_mov_b32 s14, -1
  s_and_b32 s57, s14, 1
  s_and_b32 s36, s14, 3
  s_lshl_b32 s36, s36, 13
  s_add_u32 s26, s36, s23
  s_add_u32 s36, s36, 8192
  s_and_b32 s36, s36, 0x7fff
  s_add_u32 s24, s36, 145752064
  s_add_u32 s25, s36, 145756160
  s_add_u32 s35, s36, s23
  s_waitcnt lgkmcnt(0)
  s_cmp_lg_u32 s56, 0
  s_cbranch_scc1 M_global
  s_cmp_eq_u32 s13, 1
  s_cbranch_scc1 T_w_78
  s_cmp_eq_u32 s13, 2
  s_cbranch_scc1 T_w_79
  s_cmp_eq_u32 s13, 3
  s_cbranch_scc1 T_w_80
T_w_77:
  s_mov_b32 s19, 0
  v_mov_b64 v[16:17], 0
  v_mov_b64 v[18:19], 0
  v_mov_b64 v[20:21], 0
  v_mov_b64 v[22:23], 0
  v_mov_b64 v[24:25], 0
  v_mov_b64 v[26:27], 0
  buffer_load_dwordx4 v[124:127], v3, s[4:7], s24 offen offset:0 sc1
  buffer_load_dwordx4 v[116:119], v3, s[4:7], s25 offen offset:0 sc1
  buffer_load_dwordx4 v[124:127], v3, s[4:7], s24 offen offset:0 sc1
  buffer_load_dwordx4 v[116:119], v3, s[4:7], s25 offen offset:0 sc1
  s_branch T_loop_81
.p2align 6
T_retry_82:
  s_mov_b64 exec, vcc
  buffer_load_dwordx4 v[124:127], v3, s[4:7], s24 offen offset:0 sc1
  buffer_load_dwordx4 v[116:119], v3, s[4:7], s25 offen offset:0 sc1
  s_mov_b64 exec, -1
  s_add_u32 s19, s19, 1
  s_cmp_gt_u32 s19, 32768
  s_cbranch_scc1 M_exit
T_loop_81:
  s_waitcnt vmcnt(3) lgkmcnt(0)
  v_max3_u32 v123, v124, v125, v126
  v_max_u32 v123, v123, v127
  v_mov_b32_dpp v120, v124 row_ror:8 row_mask:0xf bank_mask:0xf
  v_mov_b32_dpp v121, v125 row_ror:8 row_mask:0xf bank_mask:0xf
  s_waitcnt vmcnt(2)
  v_max3_u32 v123, v123, v116, v117
  v_max3_u32 v123, v123, v118, v119
  v_cmp_eq_u32 vcc, -1, v123
  s_cbranch_vccnz T_retry_82
  v_smfmac_f32_16x16x64_bf16 v[16:19], v[124:127], v[68:75], v0
  s_add_u32 s14, s14, 1
  ds_write_b128 v2, v[124:127] offset:0
  v_mov_b32_dpp v122, v126 row_ror:8 row_mask:0xf bank_mask:0xf
  v_smfmac_f32_16x16x64_bf16 v[20:23], v[124:127], v[76:83], v0
  s_and_b32 s57, s14, 1
  v_mov_b32_dpp v123, v127 row_ror:8 row_mask:0xf bank_mask:0xf
  v_smfmac_f32_16x16x64_bf16 v[24:27], v[124:127], v[84:91], v0
  s_and_b32 s36, s14, 3
  ds_write_b128 v2, v[116:119] offset:4096
  v_smfmac_f32_16x16x64_bf16 v[16:19], v[120:123], v[92:99], v0
  s_lshl_b32 s36, s36, 13
  v_mov_b32_dpp v84, v116 row_ror:8 row_mask:0xf bank_mask:0xf
  v_smfmac_f32_16x16x64_bf16 v[20:23], v[120:123], v[100:107], v0
  s_add_u32 s26, s36, s23
  ds_read_b128 v[68:71], v4 offset:12288
  v_mov_b32_dpp v85, v117 row_ror:8 row_mask:0xf bank_mask:0xf
  v_smfmac_f32_16x16x64_bf16 v[24:27], v[120:123], v[108:115], v0
  s_add_u32 s36, s36, 8192
  ds_read_b128 v[72:75], v4 offset:13312
  v_mov_b32_dpp v86, v118 row_ror:8 row_mask:0xf bank_mask:0xf
  v_smfmac_f32_16x16x64_bf16 v[16:19], v[116:119], v[224:231], v0
  s_and_b32 s36, s36, 0x7fff
  ds_read_b128 v[76:79], v4 offset:14336
  v_mov_b32_dpp v87, v119 row_ror:8 row_mask:0xf bank_mask:0xf
  v_smfmac_f32_16x16x64_bf16 v[20:23], v[116:119], v[240:247], v0
  s_waitcnt lgkmcnt(3)
  s_barrier
  ds_read_b128 v[100:103], v2 offset:1024
  v_smfmac_f32_16x16x64_bf16 v[24:27], v[116:119], a[0:7], v0
  s_mov_b32 m0, s31
  ds_read_b128 v[120:123], v1 offset:1024
  v_smfmac_f32_16x16x64_bf16 v[16:19], v[84:87], v[232:239], v0
  s_cmp_ge_i32 s14, s30
  s_cbranch_scc1 T_kvw_85
T_kvb_86:
  v_smfmac_f32_16x16x64_bf16 v[20:23], v[84:87], v[248:255], v0
  ds_read_b128 v[80:83], v4 offset:15360
  buffer_load_dwordx4 v9, s[4:7], s27 offen sc1 lds
  v_smfmac_f32_16x16x64_bf16 v[24:27], v[84:87], a[8:15], v0
  s_waitcnt lgkmcnt(2)
  s_mov_b32 m0, s32
  v_smfmac_f32_16x16x64_bf16 v[16:19], v[100:103], v[128:135], v0
  ds_read_b128 v[92:95], v2 offset:2048
  v_smfmac_f32_16x16x64_bf16 v[20:23], v[100:103], v[144:151], v0
  ds_read_b128 v[96:99], v1 offset:2048
  v_smfmac_f32_16x16x64_bf16 v[24:27], v[100:103], v[68:75], v0
  s_waitcnt vmcnt(1) lgkmcnt(3)
  ds_read_b128 v[116:119], v2 offset:3072
  buffer_load_dwordx4 v9, s[4:7], s27 offen offset:128 sc1 lds
  v_smfmac_f32_16x16x64_bf16 v[16:19], v[120:123], v[136:143], v0
  ds_read_b128 v[124:127], v1 offset:3072
  s_mov_b32 m0, s33
  v_smfmac_f32_16x16x64_bf16 v[20:23], v[120:123], v[152:159], v0
  s_waitcnt lgkmcnt(4)
  ds_read_b128 v[104:107], v2 offset:5120
  v_smfmac_f32_16x16x64_bf16 v[24:27], v[120:123], v[76:83], v0
  s_waitcnt lgkmcnt(4)
  ds_read_b128 v[108:111], v1 offset:5120
  v_smfmac_f32_16x16x64_bf16 v[16:19], v[92:95], v[160:167], v0
  s_waitcnt lgkmcnt(4)
  ds_read_b128 v[112:115], v2 offset:6144
  buffer_load_dwordx4 v10, s[4:7], s28 offen sc1 lds
  v_smfmac_f32_16x16x64_bf16 v[16:19], v[96:99], v[168:175], v0
  s_waitcnt lgkmcnt(4)
  ds_read_b128 v[84:87], v1 offset:6144
  s_mov_b32 m0, s34
  v_smfmac_f32_16x16x64_bf16 v[16:19], v[116:119], v[192:199], v0
  s_waitcnt lgkmcnt(4)
  ds_read_b128 v[88:91], v2 offset:7168
  v_smfmac_f32_16x16x64_bf16 v[16:19], v[124:127], v[200:207], v0
  s_waitcnt lgkmcnt(4)
  ds_read_b128 v[100:103], v1 offset:7168
  v_smfmac_f32_16x16x64_bf16 v[16:19], v[104:107], a[16:23], v0
  s_waitcnt lgkmcnt(4)
  ds_read_b128 v[68:71], v4 offset:16384
  buffer_load_dwordx4 v10, s[4:7], s28 offen offset:256 sc1 lds
  v_smfmac_f32_16x16x64_bf16 v[16:19], v[108:111], a[24:31], v0
  s_waitcnt lgkmcnt(4)
  ds_read_b128 v[72:75], v4 offset:17408
  v_smfmac_f32_16x16x64_bf16 v[16:19], v[112:115], a[64:71], v0
  s_waitcnt lgkmcnt(4)
  ds_read_b128 v[76:79], v4 offset:18432
  v_smfmac_f32_16x16x64_bf16 v[16:19], v[84:87], a[72:79], v0
  s_waitcnt lgkmcnt(4)
  ds_read_b128 v[80:83], v4 offset:19456
  v_smfmac_f32_16x16x64_bf16 v[16:19], v[88:91], a[112:119], v0
  s_waitcnt lgkmcnt(4)
  v_smfmac_f32_16x16x64_bf16 v[16:19], v[100:103], a[120:127], v0
  s_add_u32 s24, s36, 145752064
  s_add_u32 s25, s36, 145756160
  v_smfmac_f32_16x16x64_bf16 v[20:23], v[92:95], v[176:183], v0
  s_add_u32 s35, s36, s23
  v_smfmac_f32_16x16x64_bf16 v[20:23], v[96:99], v[184:191], v0
  s_waitcnt lgkmcnt(2)
  v_smfmac_f32_16x16x64_bf16 v[20:23], v[116:119], v[68:75], v0
  s_waitcnt lgkmcnt(0)
  ds_read_b128 v[68:71], v4 offset:20480
  v_mul_f32 v16, s18, v16
  v_smfmac_f32_16x16x64_bf16 v[20:23], v[124:127], v[76:83], v0
  ds_read_b128 v[72:75], v4 offset:21504
  v_mul_f32 v17, s18, v17
  v_smfmac_f32_16x16x64_bf16 v[20:23], v[104:107], a[32:39], v0
  ds_read_b128 v[76:79], v4 offset:22528
  v_mul_f32 v18, s18, v18
  v_smfmac_f32_16x16x64_bf16 v[20:23], v[108:111], a[40:47], v0
  ds_read_b128 v[80:83], v4 offset:23552
  v_mul_f32 v19, s18, v19
  v_smfmac_f32_16x16x64_bf16 v[20:23], v[112:115], a[80:87], v0
  v_cvt_pk_bf16_f32 v120, v16, v17
  v_smfmac_f32_16x16x64_bf16 v[20:23], v[84:87], a[88:95], v0
  v_cvt_pk_bf16_f32 v121, v18, v19
  v_smfmac_f32_16x16x64_bf16 v[20:23], v[88:91], a[128:135], v0
  ds_write_b64 v5, v[120:121] offset:24576
  v_smfmac_f32_16x16x64_bf16 v[20:23], v[100:103], a[136:143], v0
  s_waitcnt lgkmcnt(3)
  v_smfmac_f32_16x16x64_bf16 v[24:27], v[92:95], v[68:75], v0
  s_waitcnt lgkmcnt(1)
  v_mov_b64 v[92:93], 0
  v_smfmac_f32_16x16x64_bf16 v[24:27], v[96:99], v[76:83], v0
  s_nop 1
  v_cvt_pk_bf16_f32 v122, v20, v21
  v_cvt_pk_bf16_f32 v123, v22, v23
  v_smfmac_f32_16x16x64_bf16 v[24:27], v[116:119], v[208:215], v0
  ds_write_b64 v5, v[122:123] offset:26880
  v_mov_b64 v[94:95], 0
  v_smfmac_f32_16x16x64_bf16 v[24:27], v[124:127], v[216:223], v0
  s_waitcnt lgkmcnt(1)
  s_barrier
  ds_read_b64_tr_b16 v[68:69], v6 offset:24576
  v_smfmac_f32_16x16x64_bf16 v[24:27], v[104:107], a[48:55], v0
  s_add_u32 s27, s27, 8192
  ds_read_b64_tr_b16 v[70:71], v6 offset:24640
  ds_read_b64_tr_b16 v[72:73], v6 offset:24832
  v_smfmac_f32_16x16x64_bf16 v[24:27], v[108:111], a[56:63], v0
  s_add_u32 s28, s28, 8192
  ds_read_b64_tr_b16 v[74:75], v6 offset:24896
  ds_read_b64_tr_b16 v[76:77], v6 offset:25088
  v_smfmac_f32_16x16x64_bf16 v[24:27], v[112:115], a[96:103], v0
  s_nop 0
  ds_read_b64_tr_b16 v[78:79], v6 offset:25152
  ds_read_b64_tr_b16 v[80:81], v6 offset:25344
  v_smfmac_f32_16x16x64_bf16 v[24:27], v[84:87], a[104:111], v0
  ds_read_b64_tr_b16 v[82:83], v6 offset:25408
  v_mov_b64 v[96:97], 0
  v_smfmac_f32_16x16x64_bf16 v[24:27], v[88:91], a[144:151], v0
  s_waitcnt lgkmcnt(8)
  s_barrier
  ds_read_b64_tr_b16 v[116:117], v6 offset:26880
  v_smfmac_f32_16x16x64_bf16 v[24:27], v[100:103], a[152:159], v0
  s_waitcnt lgkmcnt(7)
  ds_read_b64_tr_b16 v[118:119], v6 offset:26944
  buffer_store_dwordx2 v[122:123], v5, s[4:7], s29 offen sc1
  v_mfma_f32_16x16x32_bf16 v[16:19], v[36:39], v[68:71], 0
  s_waitcnt lgkmcnt(6)
  ds_read_b64_tr_b16 v[124:125], v6 offset:27136
  ds_read_b64_tr_b16 v[126:127], v6 offset:27200
  v_mfma_f32_16x16x32_bf16 v[16:19], v[40:43], v[72:75], v[16:19]
  s_waitcnt lgkmcnt(6)
  ds_read_b64_tr_b16 v[104:105], v6 offset:27392
  ds_read_b64_tr_b16 v[106:107], v6 offset:27456
  v_mfma_f32_16x16x32_bf16 v[16:19], v[44:47], v[76:79], v[16:19]
  s_waitcnt lgkmcnt(6)
  ds_read_b64_tr_b16 v[108:109], v6 offset:27648
  ds_read_b64_tr_b16 v[110:111], v6 offset:27712
  v_mfma_f32_16x16x32_bf16 v[16:19], v[48:51], v[80:83], v[16:19]
  s_waitcnt lgkmcnt(6)
  v_cvt_pk_bf16_f32 v120, v24, v25
  v_cvt_pk_bf16_f32 v121, v26, v27
  v_mfma_f32_16x16x32_bf16 v[112:115], v[116:119], v[68:71], 0
  s_waitcnt lgkmcnt(4)
  buffer_store_dwordx2 v[120:121], v5, s[4:7], s29 offen offset:2304 sc1
  v_mov_b64 v[98:99], 0
  v_mfma_f32_16x16x32_bf16 v[112:115], v[124:127], v[72:75], v[112:115]
  s_waitcnt lgkmcnt(2)
  v_mov_b64 v[36:37], 0
  v_exp_f32 v100, v16
  v_mfma_f32_16x16x32_bf16 v[112:115], v[104:107], v[76:79], v[112:115]
  s_waitcnt lgkmcnt(0)
  v_exp_f32 v101, v17
  v_mfma_f32_16x16x32_bf16 v[112:115], v[108:111], v[80:83], v[112:115]
  s_add_u32 s29, s29, 147456
  v_exp_f32 v102, v18
  v_mfma_f32_16x16x32_bf16 v[20:23], v[52:55], v[68:71], 0
  s_cmp_eq_u32 s14, 63
  v_exp_f32 v103, v19
  v_mfma_f32_16x16x32_bf16 v[20:23], v[56:59], v[72:75], v[20:23]
  s_cbranch_scc1 M_tdone
  v_cvt_pk_bf16_f32 v44, v100, v101
  v_cvt_pk_bf16_f32 v45, v102, v103
  v_mfma_f32_16x16x32_bf16 v[20:23], v[60:63], v[76:79], v[20:23]
  v_exp_f32 v100, v112
  v_mfma_f32_16x16x32_bf16 v[20:23], v[64:67], v[80:83], v[20:23]
  v_exp_f32 v101, v113
  v_exp_f32 v102, v114
  v_exp_f32 v103, v115
  v_cvt_pk_bf16_f32 v84, v100, v101
  v_cvt_pk_bf16_f32 v85, v102, v103
  v_cndmask_b32 v48, v84, 0, s[16:17]
  v_cndmask_b32 v49, v85, 0, s[16:17]
  v_cndmask_b32 v50, 0, v84, s[16:17]
  v_cndmask_b32 v51, 0, v85, s[16:17]
  v_exp_f32 v100, v20
  v_mfma_f32_16x16x16_bf16 v[88:91], v[12:13], v[48:49], 0
  v_exp_f32 v101, v21
  v_mfma_f32_16x16x16_bf16 v[24:27], v[120:121], v[48:49], 0
  v_exp_f32 v102, v22
  v_mfma_f32_16x16x16_bf16 v[116:119], v[120:121], v[50:51], 0
  v_exp_f32 v103, v23
  v_cvt_pk_bf16_f32 v46, v100, v101
  v_cvt_pk_bf16_f32 v47, v102, v103
  v_mov_b64 v[38:39], 0
  s_nop 0
  v_mfma_f32_16x16x32_bf16 v[88:91], v[12:15], v[44:47], v[88:91]
  v_mov_b64 v[40:41], 0
  v_mov_b64 v[42:43], 0
  v_mfma_f32_16x16x32_bf16 v[24:27], v[28:31], v[44:47], v[24:27]
  ds_read_b128 v[52:55], v4 offset:24576
  ds_read_b128 v[56:59], v4 offset:25600
  v_mfma_f32_16x16x32_bf16 v[116:119], v[32:35], v[44:47], v[116:119]
  s_nop 1
  v_rcp_f32 v89, v88
  v_subrev_u32 v100, s54, v88
  v_cmp_le_u32 vcc, s55, v100
  v_mul_f32 v24, v89, v24
  v_mul_f32 v25, v89, v25
  s_cbranch_vccnz T_slow_87
T_back_88:
  v_cvt_pk_bf16_f32 v124, v24, v25
  v_pk_mul_f32 v[26:27], v[26:27], v[88:89] op_sel:[0,1] op_sel_hi:[1,1]
  v_pk_mul_f32 v[116:117], v[116:117], v[88:89] op_sel:[0,1] op_sel_hi:[1,1]
  v_pk_mul_f32 v[118:119], v[118:119], v[88:89] op_sel:[0,1] op_sel_hi:[1,1]
  v_cvt_pk_bf16_f32 v125, v26, v27
  v_cvt_pk_bf16_f32 v126, v116, v117
  v_cvt_pk_bf16_f32 v127, v118, v119
  ds_write_b128 v11, v[124:127] offset:29184
  s_nop 0
  v_smfmac_f32_16x16x64_bf16 v[92:95], v[124:127], a[160:167], v0
  v_smfmac_f32_16x16x64_bf16 v[96:99], v[124:127], a[168:175], v0
  v_smfmac_f32_16x16x64_bf16 v[36:39], v[124:127], a[176:183], v0
  v_smfmac_f32_16x16x64_bf16 v[40:43], v[124:127], a[184:191], v0
  s_waitcnt lgkmcnt(0)
  s_barrier
  ds_read_b128 v[104:107], v11 offset:29696
  ds_read_b128 v[108:111], v11 offset:30208
  ds_read_b128 v[68:71], v11 offset:30720
  s_waitcnt lgkmcnt(2)
  v_smfmac_f32_16x16x64_bf16 v[92:95], v[104:107], a[192:199], v0
  s_waitcnt lgkmcnt(1)
  ds_read_b128 v[76:79], v4 offset:28672
  v_smfmac_f32_16x16x64_bf16 v[92:95], v[108:111], a[224:231], v0
  s_waitcnt lgkmcnt(1)
  ds_read_b128 v[80:83], v4 offset:29696
  v_smfmac_f32_16x16x64_bf16 v[92:95], v[68:71], a[240:247], v0
  ds_read_b128 v[60:63], v4 offset:26624
  v_smfmac_f32_16x16x64_bf16 v[96:99], v[104:107], a[200:207], v0
  ds_read_b128 v[64:67], v4 offset:27648
  v_smfmac_f32_16x16x64_bf16 v[96:99], v[108:111], a[232:239], v0
  ds_read_b128 v[28:31], v4 offset:30720
  s_nop 0
  v_cvt_pk_bf16_f32 v16, v92, v93
  v_cvt_pk_bf16_f32 v17, v94, v95
  v_bfi_b32 v16, 1, s57, v16
  v_smfmac_f32_16x16x64_bf16 v[96:99], v[68:71], a[248:255], v0
  buffer_store_dwordx2 v[16:17], v7, s[4:7], s20 offen offset:0
  v_smfmac_f32_16x16x64_bf16 v[36:39], v[104:107], a[208:215], v0
  ds_read_b128 v[32:35], v4 offset:31744
  v_smfmac_f32_16x16x64_bf16 v[36:39], v[108:111], v[52:59], v0
  s_waitcnt lgkmcnt(4)
  s_nop 0
  v_cvt_pk_bf16_f32 v18, v96, v97
  v_cvt_pk_bf16_f32 v19, v98, v99
  v_bfi_b32 v18, 1, s57, v18
  v_smfmac_f32_16x16x64_bf16 v[36:39], v[68:71], v[76:83], v0
  buffer_store_dwordx2 v[18:19], v7, s[4:7], s20 offen offset:64
  v_smfmac_f32_16x16x64_bf16 v[40:43], v[104:107], a[216:223], v0
  s_waitcnt lgkmcnt(2)
  ds_read_b128 v[116:119], v2 offset:31232
  v_smfmac_f32_16x16x64_bf16 v[40:43], v[108:111], v[60:67], v0
  s_waitcnt lgkmcnt(1)
  s_nop 0
  v_cvt_pk_bf16_f32 v20, v36, v37
  v_cvt_pk_bf16_f32 v21, v38, v39
  v_bfi_b32 v20, 1, s57, v20
  v_smfmac_f32_16x16x64_bf16 v[40:43], v[68:71], v[28:35], v0
  buffer_store_dwordx2 v[20:21], v7, s[4:7], s21 offen offset:0
  s_nop 6
  v_cvt_pk_bf16_f32 v22, v40, v41
  v_cvt_pk_bf16_f32 v23, v42, v43
  v_bfi_b32 v22, 1, s57, v22
  buffer_store_dwordx2 v[22:23], v7, s[4:7], s21 offen offset:64
  ds_read_b128 v[68:71], v4 offset:0
  ds_read_b128 v[72:75], v4 offset:1024
  ds_read_b128 v[76:79], v4 offset:4096
  ds_read_b128 v[80:83], v4 offset:5120
  ds_read_b128 v[84:87], v4 offset:8192
  ds_read_b128 v[88:91], v4 offset:9216
  v_mov_b64 v[16:17], 0
  v_mov_b64 v[18:19], 0
  v_mov_b64 v[20:21], 0
  v_mov_b64 v[22:23], 0
  v_mov_b64 v[24:25], 0
  v_mov_b64 v[26:27], 0
  s_mov_b32 s19, 0
  v_mov_b32 v49, -1
  s_waitcnt vmcnt(2)
  buffer_load_dwordx4 v[52:55], v2, s[4:7], s22 offen offset:0 sc1
  buffer_load_dwordx4 v[56:59], v2, s[4:7], s22 offen offset:1024 sc1
  buffer_load_dwordx4 v[60:63], v2, s[4:7], s22 offen offset:2048 sc1
  buffer_load_dwordx4 v[64:67], v2, s[4:7], s22 offen offset:3072 sc1
  ds_read_b128 v[92:95], v4 offset:2048
  ds_read_b128 v[96:99], v4 offset:3072
  ds_read_b128 v[100:103], v4 offset:6144
  ds_read_b128 v[104:107], v4 offset:7168
  ds_read_b128 v[108:111], v4 offset:10240
  ds_read_b128 v[112:115], v4 offset:11264
  ds_read_b64 v[44:45], v2 offset:32256
  s_waitcnt lgkmcnt(0)
  v_readfirstlane_b32 s38, v44
  v_readfirstlane_b32 s37, v45
  s_nop 0
  s_add_u32 s37, s37, 30
  s_cmp_ge_u32 s38, 30
  s_cselect_b32 s38, s37, s38
  s_cmp_ge_u32 s38, 64
  s_cselect_b32 s38, 100, s38
  s_sub_u32 s38, s38, 1
  s_max_i32 s30, s30, s38
  s_waitcnt lgkmcnt(12)
  s_waitcnt vmcnt(3)
  v_mfma_f32_16x16x32_bf16 v[120:123], v[116:119], v[52:55], 0
  v_xor_b32 v48, s57, v52
  v_bitop3_b32 v48, v48, v54, s57 bitop3:0xf6
  s_waitcnt vmcnt(2)
  v_mfma_f32_16x16x32_bf16 v[120:123], v[116:119], v[56:59], v[120:123]
  v_bitop3_b32 v48, v48, v56, s57 bitop3:0xf6
  v_bitop3_b32 v48, v48, v58, s57 bitop3:0xf6
  s_waitcnt vmcnt(1)
  v_mfma_f32_16x16x32_bf16 v[120:123], v[116:119], v[60:63], v[120:123]
  v_bitop3_b32 v48, v48, v60, s57 bitop3:0xf6
  v_bitop3_b32 v48, v48, v62, s57 bitop3:0xf6
  s_waitcnt vmcnt(0)
  v_mfma_f32_16x16x32_bf16 v[120:123], v[116:119], v[64:67], v[120:123]
  v_bitop3_b32 v48, v48, v64, s57 bitop3:0xf6
  v_bitop3_b32 v48, v48, v66, s57 bitop3:0xf6
  v_and_b32 v48, 1, v48
  v_cmp_ne_u32 vcc, 0, v48
  s_cbranch_vccnz T_p1re_90
T_p1ok_91:
  s_nop 2
  v_add_f32_dpp v120, v120, v120 row_ror:8 row_mask:0xf bank_mask:0xf
  v_add_f32_dpp v121, v121, v121 row_ror:8 row_mask:0xf bank_mask:0xf
  v_cvt_pk_bf16_f32 v48, v120, v121
  v_min_u32 v48, -2, v48
  buffer_store_dword v48, v8, s[4:7], s35 offen
  buffer_store_dword v49, v8, s[4:7], s26 offen
  s_barrier
  ds_read_b128 v[28:31], v2 offset:16384
  ds_read_b128 v[32:35], v2 offset:20480
  ds_read_b128 v[36:39], v2 offset:8192
  ds_read_b128 v[40:43], v2 offset:9216
  ds_read_b128 v[44:47], v2 offset:10240
  ds_read_b128 v[48:51], v2 offset:11264
  buffer_load_dwordx4 v[124:127], v3, s[4:7], s24 offen offset:0 sc1
  buffer_load_dwordx4 v[116:119], v3, s[4:7], s25 offen offset:0 sc1
  ds_read_b128 v[52:55], v2 offset:12288
  ds_read_b128 v[56:59], v2 offset:13312
  ds_read_b128 v[60:63], v2 offset:14336
  ds_read_b128 v[64:67], v2 offset:15360
  buffer_load_dwordx4 v[124:127], v3, s[4:7], s24 offen offset:0 sc1
  buffer_load_dwordx4 v[116:119], v3, s[4:7], s25 offen offset:0 sc1
  s_mov_b32 s19, 0
  s_branch T_loop_81
T_p1re_90:
  s_mov_b64 exec, vcc
  buffer_load_dwordx4 v[52:55], v2, s[4:7], s22 offen offset:0 sc1
  buffer_load_dwordx4 v[56:59], v2, s[4:7], s22 offen offset:1024 sc1
  buffer_load_dwordx4 v[60:63], v2, s[4:7], s22 offen offset:2048 sc1
  buffer_load_dwordx4 v[64:67], v2, s[4:7], s22 offen offset:3072 sc1
  s_mov_b64 exec, -1
  s_add_u32 s19, s19, 1
  s_cmp_gt_u32 s19, 32768
  s_cbranch_scc1 M_exit
  s_waitcnt vmcnt(3)
  v_mfma_f32_16x16x32_bf16 v[120:123], v[116:119], v[52:55], 0
  v_xor_b32 v48, s57, v52
  v_bitop3_b32 v48, v48, v54, s57 bitop3:0xf6
  s_waitcnt vmcnt(2)
  v_mfma_f32_16x16x32_bf16 v[120:123], v[116:119], v[56:59], v[120:123]
  v_bitop3_b32 v48, v48, v56, s57 bitop3:0xf6
  v_bitop3_b32 v48, v48, v58, s57 bitop3:0xf6
  s_waitcnt vmcnt(1)
  v_mfma_f32_16x16x32_bf16 v[120:123], v[116:119], v[60:63], v[120:123]
  v_bitop3_b32 v48, v48, v60, s57 bitop3:0xf6
  v_bitop3_b32 v48, v48, v62, s57 bitop3:0xf6
  s_waitcnt vmcnt(0)
  v_mfma_f32_16x16x32_bf16 v[120:123], v[116:119], v[64:67], v[120:123]
  v_bitop3_b32 v48, v48, v64, s57 bitop3:0xf6
  v_bitop3_b32 v48, v48, v66, s57 bitop3:0xf6
  v_and_b32 v48, 1, v48
  v_cmp_ne_u32 vcc, 0, v48
  s_cbranch_vccnz T_p1re_90
  s_branch T_p1ok_91
T_kvw_85:
  s_mov_b32 s19, 0
  s_branch T_kvok_93
T_kv_92:
  s_sleep 4
  s_add_u32 s19, s19, 1
  s_cmp_gt_u32 s19, 32768
  s_cbranch_scc1 M_exit
T_kvok_93:
  s_add_u32 s39, s99, 128
  s_mov_b32 s38, 0
  s_mov_b32 s37, 0
  s_atomic_or s38, s[58:59], s99 glc
  s_atomic_or s37, s[58:59], s39 glc
  s_waitcnt lgkmcnt(0)
  s_add_u32 s37, s37, 30
  s_cmp_ge_u32 s38, 30
  s_cselect_b32 s38, s37, s38
  s_cmp_ge_u32 s38, 64
  s_cselect_b32 s38, 100, s38
  s_sub_u32 s38, s38, 1
  s_max_i32 s30, s30, s38
  s_cmp_ge_i32 s14, s30
  s_cbranch_scc1 T_kv_92
  s_branch T_kvb_86
T_slow_87:
  s_nop 7
  v_max3_f32 v100, v16, v17, v18
  v_max3_f32 v100, v100, v19, v20
  v_max3_f32 v100, v100, v21, v22
  v_max3_f32 v100, v100, v23, v112
  v_max3_f32 v100, v100, v113, v114
  v_max_f32 v100, v100, v115
  v_mov_b32 v101, v100
  s_nop 1
  v_permlane32_swap_b32 v100, v101
  s_nop 1
  v_max_f32 v100, v100, v101
  v_mov_b32 v101, v100
  s_nop 1
  v_permlane16_swap_b32 v100, v101
  s_nop 1
  v_max_f32 v100, v100, v101
  v_sub_f32 v16, v16, v100
  v_sub_f32 v17, v17, v100
  v_sub_f32 v18, v18, v100
  v_sub_f32 v19, v19, v100
  v_exp_f32 v16, v16
  v_exp_f32 v17, v17
  v_exp_f32 v18, v18
  v_exp_f32 v19, v19
  v_sub_f32 v20, v20, v100
  v_sub_f32 v21, v21, v100
  v_sub_f32 v22, v22, v100
  v_sub_f32 v23, v23, v100
  v_exp_f32 v20, v20
  v_exp_f32 v21, v21
  v_exp_f32 v22, v22
  v_exp_f32 v23, v23
  v_sub_f32 v112, v112, v100
  v_sub_f32 v113, v113, v100
  v_sub_f32 v114, v114, v100
  v_sub_f32 v115, v115, v100
  v_exp_f32 v112, v112
  v_exp_f32 v113, v113
  v_exp_f32 v114, v114
  v_exp_f32 v115, v115
  s_nop 0
  v_cvt_pk_bf16_f32 v44, v16, v17
  v_cvt_pk_bf16_f32 v45, v18, v19
  v_cvt_pk_bf16_f32 v46, v20, v21
  v_cvt_pk_bf16_f32 v47, v22, v23
  v_cvt_pk_bf16_f32 v84, v112, v113
  v_cvt_pk_bf16_f32 v85, v114, v115
  v_cndmask_b32 v48, v84, 0, s[16:17]
  v_cndmask_b32 v49, v85, 0, s[16:17]
  v_cndmask_b32 v50, 0, v84, s[16:17]
  v_cndmask_b32 v51, 0, v85, s[16:17]
  s_nop 1
  v_mfma_f32_16x16x16_bf16 v[88:91], v[12:13], v[48:49], 0
  v_mfma_f32_16x16x16_bf16 v[24:27], v[120:121], v[48:49], 0
  v_mfma_f32_16x16x16_bf16 v[116:119], v[120:121], v[50:51], 0
  v_mfma_f32_16x16x32_bf16 v[88:91], v[12:15], v[44:47], v[88:91]
  v_mfma_f32_16x16x32_bf16 v[24:27], v[28:31], v[44:47], v[24:27]
  v_mfma_f32_16x16x32_bf16 v[116:119], v[32:35], v[44:47], v[116:119]
  s_nop 7
  s_nop 1
  v_rcp_f32 v89, v88
  s_nop 0
  v_mul_f32 v24, v89, v24
  v_mul_f32 v25, v89, v25
  s_branch T_back_88
T_w_78:
  s_mov_b32 s19, 0
  v_mov_b64 v[16:17], 0
  v_mov_b64 v[18:19], 0
  v_mov_b64 v[20:21], 0
  v_mov_b64 v[22:23], 0
  v_mov_b64 v[24:25], 0
  v_mov_b64 v[26:27], 0
  buffer_load_dwordx4 v[124:127], v3, s[4:7], s24 offen offset:1024 sc1
  buffer_load_dwordx4 v[116:119], v3, s[4:7], s25 offen offset:1024 sc1
  buffer_load_dwordx4 v[124:127], v3, s[4:7], s24 offen offset:1024 sc1
  buffer_load_dwordx4 v[116:119], v3, s[4:7], s25 offen offset:1024 sc1
  s_branch T_loop_94
.p2align 6
T_retry_95:
  s_mov_b64 exec, vcc
  buffer_load_dwordx4 v[124:127], v3, s[4:7], s24 offen offset:1024 sc1
  buffer_load_dwordx4 v[116:119], v3, s[4:7], s25 offen offset:1024 sc1
  s_mov_b64 exec, -1
  s_add_u32 s19, s19, 1
  s_cmp_gt_u32 s19, 32768
  s_cbranch_scc1 M_exit
T_loop_94:
  s_waitcnt vmcnt(3) lgkmcnt(0)
  v_max3_u32 v123, v124, v125, v126
  v_max_u32 v123, v123, v127
  v_mov_b32_dpp v120, v124 row_ror:8 row_mask:0xf bank_mask:0xf
  v_mov_b32_dpp v121, v125 row_ror:8 row_mask:0xf bank_mask:0xf
  s_waitcnt vmcnt(2)
  v_max3_u32 v123, v123, v116, v117
  v_max3_u32 v123, v123, v118, v119
  v_cmp_eq_u32 vcc, -1, v123
  s_cbranch_vccnz T_retry_95
  v_smfmac_f32_16x16x64_bf16 v[16:19], v[124:127], v[68:75], v0
  s_add_u32 s14, s14, 1
  ds_write_b128 v2, v[124:127] offset:1024
  v_mov_b32_dpp v122, v126 row_ror:8 row_mask:0xf bank_mask:0xf
  v_smfmac_f32_16x16x64_bf16 v[20:23], v[124:127], v[76:83], v0
  s_and_b32 s57, s14, 1
  v_mov_b32_dpp v123, v127 row_ror:8 row_mask:0xf bank_mask:0xf
  v_smfmac_f32_16x16x64_bf16 v[24:27], v[124:127], v[84:91], v0
  s_and_b32 s36, s14, 3
  ds_write_b128 v2, v[116:119] offset:5120
  v_smfmac_f32_16x16x64_bf16 v[16:19], v[120:123], v[92:99], v0
  s_lshl_b32 s36, s36, 13
  v_mov_b32_dpp v84, v116 row_ror:8 row_mask:0xf bank_mask:0xf
  v_smfmac_f32_16x16x64_bf16 v[20:23], v[120:123], v[100:107], v0
  s_add_u32 s26, s36, s23
  ds_read_b128 v[68:71], v4 offset:12288
  v_mov_b32_dpp v85, v117 row_ror:8 row_mask:0xf bank_mask:0xf
  v_smfmac_f32_16x16x64_bf16 v[24:27], v[120:123], v[108:115], v0
  s_add_u32 s36, s36, 8192
  ds_read_b128 v[72:75], v4 offset:13312
  v_mov_b32_dpp v86, v118 row_ror:8 row_mask:0xf bank_mask:0xf
  v_smfmac_f32_16x16x64_bf16 v[16:19], v[116:119], v[224:231], v0
  s_and_b32 s36, s36, 0x7fff
  ds_read_b128 v[76:79], v4 offset:14336
  v_mov_b32_dpp v87, v119 row_ror:8 row_mask:0xf bank_mask:0xf
  v_smfmac_f32_16x16x64_bf16 v[20:23], v[116:119], v[240:247], v0
  s_waitcnt lgkmcnt(3)
  s_barrier
  ds_read_b128 v[100:103], v2 offset:0
  v_smfmac_f32_16x16x64_bf16 v[24:27], v[116:119], a[0:7], v0
  s_mov_b32 m0, s31
  ds_read_b128 v[120:123], v1 offset:0
  v_smfmac_f32_16x16x64_bf16 v[16:19], v[84:87], v[232:239], v0
  s_cmp_ge_i32 s14, s30
  s_cbranch_scc1 T_kvw_98
T_kvb_99:
  v_smfmac_f32_16x16x64_bf16 v[20:23], v[84:87], v[248:255], v0
  ds_read_b128 v[80:83], v4 offset:15360
  v_smfmac_f32_16x16x64_bf16 v[24:27], v[84:87], a[8:15], v0
  s_waitcnt lgkmcnt(2)
  buffer_load_dwordx4 v9, s[4:7], s27 offen sc1 lds
  v_smfmac_f32_16x16x64_bf16 v[16:19], v[100:103], v[128:135], v0
  ds_read_b128 v[92:95], v2 offset:3072
  s_mov_b32 m0, s32
  v_smfmac_f32_16x16x64_bf16 v[20:23], v[100:103], v[144:151], v0
  ds_read_b128 v[96:99], v1 offset:3072
  v_smfmac_f32_16x16x64_bf16 v[24:27], v[100:103], v[68:75], v0
  s_waitcnt vmcnt(1) lgkmcnt(3)
  ds_read_b128 v[116:119], v2 offset:2048
  v_smfmac_f32_16x16x64_bf16 v[16:19], v[120:123], v[136:143], v0
  ds_read_b128 v[124:127], v1 offset:2048
  buffer_load_dwordx4 v9, s[4:7], s27 offen offset:128 sc1 lds
  v_smfmac_f32_16x16x64_bf16 v[20:23], v[120:123], v[152:159], v0
  s_waitcnt lgkmcnt(4)
  ds_read_b128 v[104:107], v2 offset:4096
  s_mov_b32 m0, s33
  v_smfmac_f32_16x16x64_bf16 v[24:27], v[120:123], v[76:83], v0
  s_waitcnt lgkmcnt(4)
  ds_read_b128 v[108:111], v1 offset:4096
  v_smfmac_f32_16x16x64_bf16 v[16:19], v[92:95], v[160:167], v0
  s_waitcnt lgkmcnt(4)
  ds_read_b128 v[112:115], v2 offset:7168
  v_smfmac_f32_16x16x64_bf16 v[16:19], v[96:99], v[168:175], v0
  s_waitcnt lgkmcnt(4)
  ds_read_b128 v[84:87], v1 offset:7168
  buffer_load_dwordx4 v10, s[4:7], s28 offen sc1 lds
  v_smfmac_f32_16x16x64_bf16 v[16:19], v[116:119], v[192:199], v0
  s_waitcnt lgkmcnt(4)
  ds_read_b128 v[88:91], v2 offset:6144
  s_mov_b32 m0, s34
  v_smfmac_f32_16x16x64_bf16 v[16:19], v[124:127], v[200:207], v0
  s_waitcnt lgkmcnt(4)
  ds_read_b128 v[100:103], v1 offset:6144
  v_smfmac_f32_16x16x64_bf16 v[16:19], v[104:107], a[16:23], v0
  s_waitcnt lgkmcnt(4)
  ds_read_b128 v[68:71], v4 offset:16384
  v_smfmac_f32_16x16x64_bf16 v[16:19], v[108:111], a[24:31], v0
  s_waitcnt lgkmcnt(4)
  ds_read_b128 v[72:75], v4 offset:17408
  buffer_load_dwordx4 v10, s[4:7], s28 offen offset:256 sc1 lds
  v_smfmac_f32_16x16x64_bf16 v[16:19], v[112:115], a[64:71], v0
  s_waitcnt lgkmcnt(4)
  ds_read_b128 v[76:79], v4 offset:18432
  v_smfmac_f32_16x16x64_bf16 v[16:19], v[84:87], a[72:79], v0
  s_waitcnt lgkmcnt(4)
  ds_read_b128 v[80:83], v4 offset:19456
  v_smfmac_f32_16x16x64_bf16 v[16:19], v[88:91], a[112:119], v0
  s_waitcnt lgkmcnt(4)
  v_smfmac_f32_16x16x64_bf16 v[16:19], v[100:103], a[120:127], v0
  s_add_u32 s24, s36, 145752064
  s_add_u32 s25, s36, 145756160
  v_smfmac_f32_16x16x64_bf16 v[20:23], v[92:95], v[176:183], v0
  s_add_u32 s35, s36, s23
  v_smfmac_f32_16x16x64_bf16 v[20:23], v[96:99], v[184:191], v0
  s_waitcnt lgkmcnt(2)
  v_smfmac_f32_16x16x64_bf16 v[20:23], v[116:119], v[68:75], v0
  s_waitcnt lgkmcnt(0)
  ds_read_b128 v[68:71], v4 offset:20480
  v_mul_f32 v16, s18, v16
  v_smfmac_f32_16x16x64_bf16 v[20:23], v[124:127], v[76:83], v0
  ds_read_b128 v[72:75], v4 offset:21504
  v_mul_f32 v17, s18, v17
  v_smfmac_f32_16x16x64_bf16 v[20:23], v[104:107], a[32:39], v0
  ds_read_b128 v[76:79], v4 offset:22528
  v_mul_f32 v18, s18, v18
  v_smfmac_f32_16x16x64_bf16 v[20:23], v[108:111], a[40:47], v0
  ds_read_b128 v[80:83], v4 offset:23552
  v_mul_f32 v19, s18, v19
  v_smfmac_f32_16x16x64_bf16 v[20:23], v[112:115], a[80:87], v0
  v_cvt_pk_bf16_f32 v120, v16, v17
  v_smfmac_f32_16x16x64_bf16 v[20:23], v[84:87], a[88:95], v0
  v_cvt_pk_bf16_f32 v121, v18, v19
  v_smfmac_f32_16x16x64_bf16 v[20:23], v[88:91], a[128:135], v0
  ds_write_b64 v5, v[120:121] offset:24576
  v_smfmac_f32_16x16x64_bf16 v[20:23], v[100:103], a[136:143], v0
  s_waitcnt lgkmcnt(3)
  v_smfmac_f32_16x16x64_bf16 v[24:27], v[92:95], v[68:75], v0
  s_waitcnt lgkmcnt(1)
  v_mov_b64 v[92:93], 0
  v_smfmac_f32_16x16x64_bf16 v[24:27], v[96:99], v[76:83], v0
  s_nop 1
  v_cvt_pk_bf16_f32 v122, v20, v21
  v_cvt_pk_bf16_f32 v123, v22, v23
  v_smfmac_f32_16x16x64_bf16 v[24:27], v[116:119], v[208:215], v0
  ds_write_b64 v5, v[122:123] offset:26880
  v_mov_b64 v[94:95], 0
  v_smfmac_f32_16x16x64_bf16 v[24:27], v[124:127], v[216:223], v0
  s_waitcnt lgkmcnt(1)
  s_barrier
  ds_read_b64_tr_b16 v[68:69], v6 offset:24576
  v_smfmac_f32_16x16x64_bf16 v[24:27], v[104:107], a[48:55], v0
  s_add_u32 s27, s27, 8192
  ds_read_b64_tr_b16 v[70:71], v6 offset:24640
  ds_read_b64_tr_b16 v[72:73], v6 offset:24832
  v_smfmac_f32_16x16x64_bf16 v[24:27], v[108:111], a[56:63], v0
  s_add_u32 s28, s28, 8192
  ds_read_b64_tr_b16 v[74:75], v6 offset:24896
  ds_read_b64_tr_b16 v[76:77], v6 offset:25088
  v_smfmac_f32_16x16x64_bf16 v[24:27], v[112:115], a[96:103], v0
  s_nop 0
  ds_read_b64_tr_b16 v[78:79], v6 offset:25152
  ds_read_b64_tr_b16 v[80:81], v6 offset:25344
  v_smfmac_f32_16x16x64_bf16 v[24:27], v[84:87], a[104:111], v0
  ds_read_b64_tr_b16 v[82:83], v6 offset:25408
  v_mov_b64 v[96:97], 0
  v_smfmac_f32_16x16x64_bf16 v[24:27], v[88:91], a[144:151], v0
  s_waitcnt lgkmcnt(8)
  s_barrier
  ds_read_b64_tr_b16 v[116:117], v6 offset:26880
  v_smfmac_f32_16x16x64_bf16 v[24:27], v[100:103], a[152:159], v0
  s_waitcnt lgkmcnt(7)
  ds_read_b64_tr_b16 v[118:119], v6 offset:26944
  buffer_store_dwordx2 v[122:123], v5, s[4:7], s29 offen sc1
  v_mfma_f32_16x16x32_bf16 v[16:19], v[36:39], v[68:71], 0
  s_waitcnt lgkmcnt(6)
  ds_read_b64_tr_b16 v[124:125], v6 offset:27136
  ds_read_b64_tr_b16 v[126:127], v6 offset:27200
  v_mfma_f32_16x16x32_bf16 v[16:19], v[40:43], v[72:75], v[16:19]
  s_waitcnt lgkmcnt(6)
  ds_read_b64_tr_b16 v[104:105], v6 offset:27392
  ds_read_b64_tr_b16 v[106:107], v6 offset:27456
  v_mfma_f32_16x16x32_bf16 v[16:19], v[44:47], v[76:79], v[16:19]
  s_waitcnt lgkmcnt(6)
  ds_read_b64_tr_b16 v[108:109], v6 offset:27648
  ds_read_b64_tr_b16 v[110:111], v6 offset:27712
  v_mfma_f32_16x16x32_bf16 v[16:19], v[48:51], v[80:83], v[16:19]
  s_waitcnt lgkmcnt(6)
  v_cvt_pk_bf16_f32 v120, v24, v25
  v_cvt_pk_bf16_f32 v121, v26, v27
  v_mfma_f32_16x16x32_bf16 v[112:115], v[116:119], v[68:71], 0
  s_waitcnt lgkmcnt(4)
  buffer_store_dwordx2 v[120:121], v5, s[4:7], s29 offen offset:2304 sc1
  v_mov_b64 v[98:99], 0
  v_mfma_f32_16x16x32_bf16 v[112:115], v[124:127], v[72:75], v[112:115]
  s_waitcnt lgkmcnt(2)
  v_mov_b64 v[36:37], 0
  v_exp_f32 v100, v16
  v_mfma_f32_16x16x32_bf16 v[112:115], v[104:107], v[76:79], v[112:115]
  s_waitcnt lgkmcnt(0)
  v_exp_f32 v101, v17
  v_mfma_f32_16x16x32_bf16 v[112:115], v[108:111], v[80:83], v[112:115]
  s_add_u32 s29, s29, 147456
  v_exp_f32 v102, v18
  v_mfma_f32_16x16x32_bf16 v[20:23], v[52:55], v[68:71], 0
  s_cmp_eq_u32 s14, 63
  v_exp_f32 v103, v19
  v_mfma_f32_16x16x32_bf16 v[20:23], v[56:59], v[72:75], v[20:23]
  s_cbranch_scc1 M_tdone
  v_cvt_pk_bf16_f32 v44, v100, v101
  v_cvt_pk_bf16_f32 v45, v102, v103
  v_mfma_f32_16x16x32_bf16 v[20:23], v[60:63], v[76:79], v[20:23]
  v_exp_f32 v100, v112
  v_mfma_f32_16x16x32_bf16 v[20:23], v[64:67], v[80:83], v[20:23]
  v_exp_f32 v101, v113
  v_exp_f32 v102, v114
  v_exp_f32 v103, v115
  v_cvt_pk_bf16_f32 v84, v100, v101
  v_cvt_pk_bf16_f32 v85, v102, v103
  v_cndmask_b32 v48, v84, 0, s[16:17]
  v_cndmask_b32 v49, v85, 0, s[16:17]
  v_cndmask_b32 v50, 0, v84, s[16:17]
  v_cndmask_b32 v51, 0, v85, s[16:17]
  v_exp_f32 v100, v20
  v_mfma_f32_16x16x16_bf16 v[88:91], v[12:13], v[48:49], 0
  v_exp_f32 v101, v21
  v_mfma_f32_16x16x16_bf16 v[24:27], v[120:121], v[48:49], 0
  v_exp_f32 v102, v22
  v_mfma_f32_16x16x16_bf16 v[116:119], v[120:121], v[50:51], 0
  v_exp_f32 v103, v23
  v_cvt_pk_bf16_f32 v46, v100, v101
  v_cvt_pk_bf16_f32 v47, v102, v103
  v_mov_b64 v[38:39], 0
  s_nop 0
  v_mfma_f32_16x16x32_bf16 v[88:91], v[12:15], v[44:47], v[88:91]
  v_mov_b64 v[40:41], 0
  v_mov_b64 v[42:43], 0
  v_mfma_f32_16x16x32_bf16 v[24:27], v[28:31], v[44:47], v[24:27]
  ds_read_b128 v[52:55], v4 offset:24576
  ds_read_b128 v[56:59], v4 offset:25600
  v_mfma_f32_16x16x32_bf16 v[116:119], v[32:35], v[44:47], v[116:119]
  s_nop 1
  v_rcp_f32 v89, v88
  v_subrev_u32 v100, s54, v88
  v_cmp_le_u32 vcc, s55, v100
  v_mul_f32 v24, v89, v24
  v_mul_f32 v25, v89, v25
  s_cbranch_vccnz T_slow_100
T_back_101:
  v_cvt_pk_bf16_f32 v124, v24, v25
  v_pk_mul_f32 v[26:27], v[26:27], v[88:89] op_sel:[0,1] op_sel_hi:[1,1]
  v_pk_mul_f32 v[116:117], v[116:117], v[88:89] op_sel:[0,1] op_sel_hi:[1,1]
  v_pk_mul_f32 v[118:119], v[118:119], v[88:89] op_sel:[0,1] op_sel_hi:[1,1]
  v_cvt_pk_bf16_f32 v125, v26, v27
  v_cvt_pk_bf16_f32 v126, v116, v117
  v_cvt_pk_bf16_f32 v127, v118, v119
  ds_write_b128 v11, v[124:127] offset:29696
  s_nop 0
  v_smfmac_f32_16x16x64_bf16 v[92:95], v[124:127], a[160:167], v0
  v_smfmac_f32_16x16x64_bf16 v[96:99], v[124:127], a[168:175], v0
  v_smfmac_f32_16x16x64_bf16 v[36:39], v[124:127], a[176:183], v0
  v_smfmac_f32_16x16x64_bf16 v[40:43], v[124:127], a[184:191], v0
  s_waitcnt lgkmcnt(0)
  s_barrier
  ds_read_b128 v[104:107], v11 offset:29184
  ds_read_b128 v[108:111], v11 offset:30720
  ds_read_b128 v[68:71], v11 offset:30208
  s_waitcnt lgkmcnt(2)
  v_smfmac_f32_16x16x64_bf16 v[92:95], v[104:107], a[192:199], v0
  s_waitcnt lgkmcnt(1)
  ds_read_b128 v[76:79], v4 offset:28672
  v_smfmac_f32_16x16x64_bf16 v[92:95], v[108:111], a[224:231], v0
  s_waitcnt lgkmcnt(1)
  ds_read_b128 v[80:83], v4 offset:29696
  v_smfmac_f32_16x16x64_bf16 v[92:95], v[68:71], a[240:247], v0
  ds_read_b128 v[60:63], v4 offset:26624
  v_smfmac_f32_16x16x64_bf16 v[96:99], v[104:107], a[200:207], v0
  ds_read_b128 v[64:67], v4 offset:27648
  v_smfmac_f32_16x16x64_bf16 v[96:99], v[108:111], a[232:239], v0
  ds_read_b128 v[28:31], v4 offset:30720
  s_nop 0
  v_cvt_pk_bf16_f32 v16, v92, v93
  v_cvt_pk_bf16_f32 v17, v94, v95
  v_bfi_b32 v16, 1, s57, v16
  v_smfmac_f32_16x16x64_bf16 v[96:99], v[68:71], a[248:255], v0
  buffer_store_dwordx2 v[16:17], v7, s[4:7], s20 offen offset:0
  v_smfmac_f32_16x16x64_bf16 v[36:39], v[104:107], a[208:215], v0
  ds_read_b128 v[32:35], v4 offset:31744
  v_smfmac_f32_16x16x64_bf16 v[36:39], v[108:111], v[52:59], v0
  s_waitcnt lgkmcnt(4)
  s_nop 0
  v_cvt_pk_bf16_f32 v18, v96, v97
  v_cvt_pk_bf16_f32 v19, v98, v99
  v_bfi_b32 v18, 1, s57, v18
  v_smfmac_f32_16x16x64_bf16 v[36:39], v[68:71], v[76:83], v0
  buffer_store_dwordx2 v[18:19], v7, s[4:7], s20 offen offset:64
  v_smfmac_f32_16x16x64_bf16 v[40:43], v[104:107], a[216:223], v0
  s_waitcnt lgkmcnt(2)
  ds_read_b128 v[116:119], v2 offset:31232
  v_smfmac_f32_16x16x64_bf16 v[40:43], v[108:111], v[60:67], v0
  s_waitcnt lgkmcnt(1)
  s_nop 0
  v_cvt_pk_bf16_f32 v20, v36, v37
  v_cvt_pk_bf16_f32 v21, v38, v39
  v_bfi_b32 v20, 1, s57, v20
  v_smfmac_f32_16x16x64_bf16 v[40:43], v[68:71], v[28:35], v0
  buffer_store_dwordx2 v[20:21], v7, s[4:7], s21 offen offset:0
  s_nop 6
  v_cvt_pk_bf16_f32 v22, v40, v41
  v_cvt_pk_bf16_f32 v23, v42, v43
  v_bfi_b32 v22, 1, s57, v22
  buffer_store_dwordx2 v[22:23], v7, s[4:7], s21 offen offset:64
  ds_read_b128 v[68:71], v4 offset:0
  ds_read_b128 v[72:75], v4 offset:1024
  ds_read_b128 v[76:79], v4 offset:4096
  ds_read_b128 v[80:83], v4 offset:5120
  ds_read_b128 v[84:87], v4 offset:8192
  ds_read_b128 v[88:91], v4 offset:9216
  ds_read_b128 v[92:95], v4 offset:2048
  ds_read_b128 v[96:99], v4 offset:3072
  ds_read_b128 v[100:103], v4 offset:6144
  ds_read_b128 v[104:107], v4 offset:7168
  ds_read_b128 v[108:111], v4 offset:10240
  ds_read_b128 v[112:115], v4 offset:11264
  v_mov_b64 v[16:17], 0
  v_mov_b64 v[18:19], 0
  v_mov_b64 v[20:21], 0
  v_mov_b64 v[22:23], 0
  v_mov_b64 v[24:25], 0
  v_mov_b64 v[26:27], 0
  s_mov_b32 s19, 0
  v_mov_b32 v49, -1
  ds_read_b64 v[44:45], v2 offset:32256
  s_waitcnt lgkmcnt(0)
  v_readfirstlane_b32 s38, v44
  v_readfirstlane_b32 s37, v45
  s_nop 0
  s_add_u32 s37, s37, 30
  s_cmp_ge_u32 s38, 30
  s_cselect_b32 s38, s37, s38
  s_cmp_ge_u32 s38, 64
  s_cselect_b32 s38, 100, s38
  s_sub_u32 s38, s38, 1
  s_max_i32 s30, s30, s38
  s_waitcnt vmcnt(0)
  buffer_load_dwordx4 v[52:55], v2, s[4:7], s22 offen offset:0 sc1
  buffer_load_dwordx4 v[56:59], v2, s[4:7], s22 offen offset:1024 sc1
  buffer_load_dwordx4 v[60:63], v2, s[4:7], s22 offen offset:2048 sc1
  buffer_load_dwordx4 v[64:67], v2, s[4:7], s22 offen offset:3072 sc1
  s_waitcnt lgkmcnt(12)
  s_waitcnt vmcnt(3)
  v_mfma_f32_16x16x32_bf16 v[120:123], v[116:119], v[52:55], 0
  v_xor_b32 v48, s57, v52
  v_bitop3_b32 v48, v48, v54, s57 bitop3:0xf6
  s_waitcnt vmcnt(2)
  v_mfma_f32_16x16x32_bf16 v[120:123], v[116:119], v[56:59], v[120:123]
  v_bitop3_b32 v48, v48, v56, s57 bitop3:0xf6
  v_bitop3_b32 v48, v48, v58, s57 bitop3:0xf6
  s_waitcnt vmcnt(1)
  v_mfma_f32_16x16x32_bf16 v[120:123], v[116:119], v[60:63], v[120:123]
  v_bitop3_b32 v48, v48, v60, s57 bitop3:0xf6
  v_bitop3_b32 v48, v48, v62, s57 bitop3:0xf6
  s_waitcnt vmcnt(0)
  v_mfma_f32_16x16x32_bf16 v[120:123], v[116:119], v[64:67], v[120:123]
  v_bitop3_b32 v48, v48, v64, s57 bitop3:0xf6
  v_bitop3_b32 v48, v48, v66, s57 bitop3:0xf6
  v_and_b32 v48, 1, v48
  v_cmp_ne_u32 vcc, 0, v48
  s_cbranch_vccnz T_p1re_103
T_p1ok_104:
  s_nop 2
  v_add_f32_dpp v120, v120, v120 row_ror:8 row_mask:0xf bank_mask:0xf
  v_add_f32_dpp v121, v121, v121 row_ror:8 row_mask:0xf bank_mask:0xf
  v_cvt_pk_bf16_f32 v48, v120, v121
  v_min_u32 v48, -2, v48
  buffer_store_dword v48, v8, s[4:7], s35 offen
  buffer_store_dword v49, v8, s[4:7], s26 offen
  s_barrier
  ds_read_b128 v[28:31], v2 offset:17408
  ds_read_b128 v[32:35], v2 offset:21504
  ds_read_b128 v[36:39], v2 offset:8192
  ds_read_b128 v[40:43], v2 offset:9216
  ds_read_b128 v[44:47], v2 offset:10240
  ds_read_b128 v[48:51], v2 offset:11264
  buffer_load_dwordx4 v[124:127], v3, s[4:7], s24 offen offset:1024 sc1
  buffer_load_dwordx4 v[116:119], v3, s[4:7], s25 offen offset:1024 sc1
  ds_read_b128 v[52:55], v2 offset:12288
  ds_read_b128 v[56:59], v2 offset:13312
  ds_read_b128 v[60:63], v2 offset:14336
  ds_read_b128 v[64:67], v2 offset:15360
  buffer_load_dwordx4 v[124:127], v3, s[4:7], s24 offen offset:1024 sc1
  buffer_load_dwordx4 v[116:119], v3, s[4:7], s25 offen offset:1024 sc1
  s_mov_b32 s19, 0
  s_branch T_loop_94
T_p1re_103:
  s_mov_b64 exec, vcc
  buffer_load_dwordx4 v[52:55], v2, s[4:7], s22 offen offset:0 sc1
  buffer_load_dwordx4 v[56:59], v2, s[4:7], s22 offen offset:1024 sc1
  buffer_load_dwordx4 v[60:63], v2, s[4:7], s22 offen offset:2048 sc1
  buffer_load_dwordx4 v[64:67], v2, s[4:7], s22 offen offset:3072 sc1
  s_mov_b64 exec, -1
  s_add_u32 s19, s19, 1
  s_cmp_gt_u32 s19, 32768
  s_cbranch_scc1 M_exit
  s_waitcnt vmcnt(3)
  v_mfma_f32_16x16x32_bf16 v[120:123], v[116:119], v[52:55], 0
  v_xor_b32 v48, s57, v52
  v_bitop3_b32 v48, v48, v54, s57 bitop3:0xf6
  s_waitcnt vmcnt(2)
  v_mfma_f32_16x16x32_bf16 v[120:123], v[116:119], v[56:59], v[120:123]
  v_bitop3_b32 v48, v48, v56, s57 bitop3:0xf6
  v_bitop3_b32 v48, v48, v58, s57 bitop3:0xf6
  s_waitcnt vmcnt(1)
  v_mfma_f32_16x16x32_bf16 v[120:123], v[116:119], v[60:63], v[120:123]
  v_bitop3_b32 v48, v48, v60, s57 bitop3:0xf6
  v_bitop3_b32 v48, v48, v62, s57 bitop3:0xf6
  s_waitcnt vmcnt(0)
  v_mfma_f32_16x16x32_bf16 v[120:123], v[116:119], v[64:67], v[120:123]
  v_bitop3_b32 v48, v48, v64, s57 bitop3:0xf6
  v_bitop3_b32 v48, v48, v66, s57 bitop3:0xf6
  v_and_b32 v48, 1, v48
  v_cmp_ne_u32 vcc, 0, v48
  s_cbranch_vccnz T_p1re_103
  s_branch T_p1ok_104
T_kvw_98:
  s_mov_b32 s19, 0
  s_branch T_kvok_106
T_kv_105:
  s_sleep 4
  s_add_u32 s19, s19, 1
  s_cmp_gt_u32 s19, 32768
  s_cbranch_scc1 M_exit
T_kvok_106:
  s_add_u32 s39, s99, 128
  s_mov_b32 s38, 0
  s_mov_b32 s37, 0
  s_atomic_or s38, s[58:59], s99 glc
  s_atomic_or s37, s[58:59], s39 glc
  s_waitcnt lgkmcnt(0)
  s_add_u32 s37, s37, 30
  s_cmp_ge_u32 s38, 30
  s_cselect_b32 s38, s37, s38
  s_cmp_ge_u32 s38, 64
  s_cselect_b32 s38, 100, s38
  s_sub_u32 s38, s38, 1
  s_max_i32 s30, s30, s38
  s_cmp_ge_i32 s14, s30
  s_cbranch_scc1 T_kv_105
  s_branch T_kvb_99
T_slow_100:
  s_nop 7
  v_max3_f32 v100, v16, v17, v18
  v_max3_f32 v100, v100, v19, v20
  v_max3_f32 v100, v100, v21, v22
  v_max3_f32 v100, v100, v23, v112
  v_max3_f32 v100, v100, v113, v114
  v_max_f32 v100, v100, v115
  v_mov_b32 v101, v100
  s_nop 1
  v_permlane32_swap_b32 v100, v101
  s_nop 1
  v_max_f32 v100, v100, v101
  v_mov_b32 v101, v100
  s_nop 1
  v_permlane16_swap_b32 v100, v101
  s_nop 1
  v_max_f32 v100, v100, v101
  v_sub_f32 v16, v16, v100
  v_sub_f32 v17, v17, v100
  v_sub_f32 v18, v18, v100
  v_sub_f32 v19, v19, v100
  v_exp_f32 v16, v16
  v_exp_f32 v17, v17
  v_exp_f32 v18, v18
  v_exp_f32 v19, v19
  v_sub_f32 v20, v20, v100
  v_sub_f32 v21, v21, v100
  v_sub_f32 v22, v22, v100
  v_sub_f32 v23, v23, v100
  v_exp_f32 v20, v20
  v_exp_f32 v21, v21
  v_exp_f32 v22, v22
  v_exp_f32 v23, v23
  v_sub_f32 v112, v112, v100
  v_sub_f32 v113, v113, v100
  v_sub_f32 v114, v114, v100
  v_sub_f32 v115, v115, v100
  v_exp_f32 v112, v112
  v_exp_f32 v113, v113
  v_exp_f32 v114, v114
  v_exp_f32 v115, v115
  s_nop 0
  v_cvt_pk_bf16_f32 v44, v16, v17
  v_cvt_pk_bf16_f32 v45, v18, v19
  v_cvt_pk_bf16_f32 v46, v20, v21
  v_cvt_pk_bf16_f32 v47, v22, v23
  v_cvt_pk_bf16_f32 v84, v112, v113
  v_cvt_pk_bf16_f32 v85, v114, v115
  v_cndmask_b32 v48, v84, 0, s[16:17]
  v_cndmask_b32 v49, v85, 0, s[16:17]
  v_cndmask_b32 v50, 0, v84, s[16:17]
  v_cndmask_b32 v51, 0, v85, s[16:17]
  s_nop 1
  v_mfma_f32_16x16x16_bf16 v[88:91], v[12:13], v[48:49], 0
  v_mfma_f32_16x16x16_bf16 v[24:27], v[120:121], v[48:49], 0
  v_mfma_f32_16x16x16_bf16 v[116:119], v[120:121], v[50:51], 0
  v_mfma_f32_16x16x32_bf16 v[88:91], v[12:15], v[44:47], v[88:91]
  v_mfma_f32_16x16x32_bf16 v[24:27], v[28:31], v[44:47], v[24:27]
  v_mfma_f32_16x16x32_bf16 v[116:119], v[32:35], v[44:47], v[116:119]
  s_nop 7
  s_nop 1
  v_rcp_f32 v89, v88
  s_nop 0
  v_mul_f32 v24, v89, v24
  v_mul_f32 v25, v89, v25
  s_branch T_back_101
T_w_79:
  s_mov_b32 s19, 0
  v_mov_b64 v[16:17], 0
  v_mov_b64 v[18:19], 0
  v_mov_b64 v[20:21], 0
  v_mov_b64 v[22:23], 0
  v_mov_b64 v[24:25], 0
  v_mov_b64 v[26:27], 0
  buffer_load_dwordx4 v[124:127], v3, s[4:7], s24 offen offset:2048 sc1
  buffer_load_dwordx4 v[116:119], v3, s[4:7], s25 offen offset:2048 sc1
  buffer_load_dwordx4 v[124:127], v3, s[4:7], s24 offen offset:2048 sc1
  buffer_load_dwordx4 v[116:119], v3, s[4:7], s25 offen offset:2048 sc1
  s_branch T_loop_107
.p2align 6
T_retry_108:
  s_mov_b64 exec, vcc
  buffer_load_dwordx4 v[124:127], v3, s[4:7], s24 offen offset:2048 sc1
  buffer_load_dwordx4 v[116:119], v3, s[4:7], s25 offen offset:2048 sc1
  s_mov_b64 exec, -1
  s_add_u32 s19, s19, 1
  s_cmp_gt_u32 s19, 32768
  s_cbranch_scc1 M_exit
T_loop_107:
  s_waitcnt vmcnt(3) lgkmcnt(0)
  v_max3_u32 v123, v124, v125, v126
  v_max_u32 v123, v123, v127
  v_mov_b32_dpp v120, v124 row_ror:8 row_mask:0xf bank_mask:0xf
  v_mov_b32_dpp v121, v125 row_ror:8 row_mask:0xf bank_mask:0xf
  s_waitcnt vmcnt(2)
  v_max3_u32 v123, v123, v116, v117
  v_max3_u32 v123, v123, v118, v119
  v_cmp_eq_u32 vcc, -1, v123
  s_cbranch_vccnz T_retry_108
  v_smfmac_f32_16x16x64_bf16 v[16:19], v[124:127], v[68:75], v0
  s_add_u32 s14, s14, 1
  ds_write_b128 v2, v[124:127] offset:2048
  v_mov_b32_dpp v122, v126 row_ror:8 row_mask:0xf bank_mask:0xf
  v_smfmac_f32_16x16x64_bf16 v[20:23], v[124:127], v[76:83], v0
  s_and_b32 s57, s14, 1
  v_mov_b32_dpp v123, v127 row_ror:8 row_mask:0xf bank_mask:0xf
  v_smfmac_f32_16x16x64_bf16 v[24:27], v[124:127], v[84:91], v0
  s_and_b32 s36, s14, 3
  ds_write_b128 v2, v[116:119] offset:6144
  v_smfmac_f32_16x16x64_bf16 v[16:19], v[120:123], v[92:99], v0
  s_lshl_b32 s36, s36, 13
  v_mov_b32_dpp v84, v116 row_ror:8 row_mask:0xf bank_mask:0xf
  v_smfmac_f32_16x16x64_bf16 v[20:23], v[120:123], v[100:107], v0
  s_add_u32 s26, s36, s23
  ds_read_b128 v[68:71], v4 offset:12288
  v_mov_b32_dpp v85, v117 row_ror:8 row_mask:0xf bank_mask:0xf
  v_smfmac_f32_16x16x64_bf16 v[24:27], v[120:123], v[108:115], v0
  s_add_u32 s36, s36, 8192
  ds_read_b128 v[72:75], v4 offset:13312
  v_mov_b32_dpp v86, v118 row_ror:8 row_mask:0xf bank_mask:0xf
  v_smfmac_f32_16x16x64_bf16 v[16:19], v[116:119], v[224:231], v0
  s_and_b32 s36, s36, 0x7fff
  ds_read_b128 v[76:79], v4 offset:14336
  v_mov_b32_dpp v87, v119 row_ror:8 row_mask:0xf bank_mask:0xf
  v_smfmac_f32_16x16x64_bf16 v[20:23], v[116:119], v[240:247], v0
  s_waitcnt lgkmcnt(3)
  s_barrier
  ds_read_b128 v[100:103], v2 offset:3072
  v_smfmac_f32_16x16x64_bf16 v[24:27], v[116:119], a[0:7], v0
  s_mov_b32 m0, s31
  ds_read_b128 v[120:123], v1 offset:3072
  v_smfmac_f32_16x16x64_bf16 v[16:19], v[84:87], v[232:239], v0
  s_cmp_ge_i32 s14, s30
  s_cbranch_scc1 T_kvw_111
T_kvb_112:
  v_smfmac_f32_16x16x64_bf16 v[20:23], v[84:87], v[248:255], v0
  ds_read_b128 v[80:83], v4 offset:15360
  v_smfmac_f32_16x16x64_bf16 v[24:27], v[84:87], a[8:15], v0
  s_waitcnt lgkmcnt(2)
  v_smfmac_f32_16x16x64_bf16 v[16:19], v[100:103], v[128:135], v0
  ds_read_b128 v[92:95], v2 offset:0
  buffer_load_dwordx4 v9, s[4:7], s27 offen sc1 lds
  v_smfmac_f32_16x16x64_bf16 v[20:23], v[100:103], v[144:151], v0
  ds_read_b128 v[96:99], v1 offset:0
  s_mov_b32 m0, s32
  v_smfmac_f32_16x16x64_bf16 v[24:27], v[100:103], v[68:75], v0
  s_waitcnt vmcnt(1) lgkmcnt(3)
  ds_read_b128 v[116:119], v2 offset:1024
  v_smfmac_f32_16x16x64_bf16 v[16:19], v[120:123], v[136:143], v0
  ds_read_b128 v[124:127], v1 offset:1024
  v_smfmac_f32_16x16x64_bf16 v[20:23], v[120:123], v[152:159], v0
  s_waitcnt lgkmcnt(4)
  ds_read_b128 v[104:107], v2 offset:7168
  buffer_load_dwordx4 v9, s[4:7], s27 offen offset:128 sc1 lds
  v_smfmac_f32_16x16x64_bf16 v[24:27], v[120:123], v[76:83], v0
  s_waitcnt lgkmcnt(4)
  ds_read_b128 v[108:111], v1 offset:7168
  s_mov_b32 m0, s33
  v_smfmac_f32_16x16x64_bf16 v[16:19], v[92:95], v[160:167], v0
  s_waitcnt lgkmcnt(4)
  ds_read_b128 v[112:115], v2 offset:4096
  v_smfmac_f32_16x16x64_bf16 v[16:19], v[96:99], v[168:175], v0
  s_waitcnt lgkmcnt(4)
  ds_read_b128 v[84:87], v1 offset:4096
  v_smfmac_f32_16x16x64_bf16 v[16:19], v[116:119], v[192:199], v0
  s_waitcnt lgkmcnt(4)
  ds_read_b128 v[88:91], v2 offset:5120
  buffer_load_dwordx4 v10, s[4:7], s28 offen sc1 lds
  v_smfmac_f32_16x16x64_bf16 v[16:19], v[124:127], v[200:207], v0
  s_waitcnt lgkmcnt(4)
  ds_read_b128 v[100:103], v1 offset:5120
  s_mov_b32 m0, s34
  v_smfmac_f32_16x16x64_bf16 v[16:19], v[104:107], a[16:23], v0
  s_waitcnt lgkmcnt(4)
  ds_read_b128 v[68:71], v4 offset:16384
  v_smfmac_f32_16x16x64_bf16 v[16:19], v[108:111], a[24:31], v0
  s_waitcnt lgkmcnt(4)
  ds_read_b128 v[72:75], v4 offset:17408
  v_smfmac_f32_16x16x64_bf16 v[16:19], v[112:115], a[64:71], v0
  s_waitcnt lgkmcnt(4)
  ds_read_b128 v[76:79], v4 offset:18432
  buffer_load_dwordx4 v10, s[4:7], s28 offen offset:256 sc1 lds
  v_smfmac_f32_16x16x64_bf16 v[16:19], v[84:87], a[72:79], v0
  s_waitcnt lgkmcnt(4)
  ds_read_b128 v[80:83], v4 offset:19456
  v_smfmac_f32_16x16x64_bf16 v[16:19], v[88:91], a[112:119], v0
  s_waitcnt lgkmcnt(4)
  v_smfmac_f32_16x16x64_bf16 v[16:19], v[100:103], a[120:127], v0
  s_add_u32 s24, s36, 145752064
  s_add_u32 s25, s36, 145756160
  v_smfmac_f32_16x16x64_bf16 v[20:23], v[92:95], v[176:183], v0
  s_add_u32 s35, s36, s23
  v_smfmac_f32_16x16x64_bf16 v[20:23], v[96:99], v[184:191], v0
  s_waitcnt lgkmcnt(2)
  v_smfmac_f32_16x16x64_bf16 v[20:23], v[116:119], v[68:75], v0
  s_waitcnt lgkmcnt(0)
  ds_read_b128 v[68:71], v4 offset:20480
  v_mul_f32 v16, s18, v16
  v_smfmac_f32_16x16x64_bf16 v[20:23], v[124:127], v[76:83], v0
  ds_read_b128 v[72:75], v4 offset:21504
  v_mul_f32 v17, s18, v17
  v_smfmac_f32_16x16x64_bf16 v[20:23], v[104:107], a[32:39], v0
  ds_read_b128 v[76:79], v4 offset:22528
  v_mul_f32 v18, s18, v18
  v_smfmac_f32_16x16x64_bf16 v[20:23], v[108:111], a[40:47], v0
  ds_read_b128 v[80:83], v4 offset:23552
  v_mul_f32 v19, s18, v19
  v_smfmac_f32_16x16x64_bf16 v[20:23], v[112:115], a[80:87], v0
  v_cvt_pk_bf16_f32 v120, v16, v17
  v_smfmac_f32_16x16x64_bf16 v[20:23], v[84:87], a[88:95], v0
  v_cvt_pk_bf16_f32 v121, v18, v19
  v_smfmac_f32_16x16x64_bf16 v[20:23], v[88:91], a[128:135], v0
  ds_write_b64 v5, v[120:121] offset:24576
  v_smfmac_f32_16x16x64_bf16 v[20:23], v[100:103], a[136:143], v0
  s_waitcnt lgkmcnt(3)
  v_smfmac_f32_16x16x64_bf16 v[24:27], v[92:95], v[68:75], v0
  s_waitcnt lgkmcnt(1)
  v_mov_b64 v[92:93], 0
  v_smfmac_f32_16x16x64_bf16 v[24:27], v[96:99], v[76:83], v0
  s_nop 1
  v_cvt_pk_bf16_f32 v122, v20, v21
  v_cvt_pk_bf16_f32 v123, v22, v23
  v_smfmac_f32_16x16x64_bf16 v[24:27], v[116:119], v[208:215], v0
  ds_write_b64 v5, v[122:123] offset:26880
  v_mov_b64 v[94:95], 0
  v_smfmac_f32_16x16x64_bf16 v[24:27], v[124:127], v[216:223], v0
  s_waitcnt lgkmcnt(1)
  s_barrier
  ds_read_b64_tr_b16 v[68:69], v6 offset:24576
  v_smfmac_f32_16x16x64_bf16 v[24:27], v[104:107], a[48:55], v0
  s_add_u32 s27, s27, 8192
  ds_read_b64_tr_b16 v[70:71], v6 offset:24640
  ds_read_b64_tr_b16 v[72:73], v6 offset:24832
  v_smfmac_f32_16x16x64_bf16 v[24:27], v[108:111], a[56:63], v0
  s_add_u32 s28, s28, 8192
  ds_read_b64_tr_b16 v[74:75], v6 offset:24896
  ds_read_b64_tr_b16 v[76:77], v6 offset:25088
  v_smfmac_f32_16x16x64_bf16 v[24:27], v[112:115], a[96:103], v0
  s_nop 0
  ds_read_b64_tr_b16 v[78:79], v6 offset:25152
  ds_read_b64_tr_b16 v[80:81], v6 offset:25344
  v_smfmac_f32_16x16x64_bf16 v[24:27], v[84:87], a[104:111], v0
  ds_read_b64_tr_b16 v[82:83], v6 offset:25408
  v_mov_b64 v[96:97], 0
  v_smfmac_f32_16x16x64_bf16 v[24:27], v[88:91], a[144:151], v0
  s_waitcnt lgkmcnt(8)
  s_barrier
  ds_read_b64_tr_b16 v[116:117], v6 offset:26880
  v_smfmac_f32_16x16x64_bf16 v[24:27], v[100:103], a[152:159], v0
  s_waitcnt lgkmcnt(7)
  ds_read_b64_tr_b16 v[118:119], v6 offset:26944
  buffer_store_dwordx2 v[122:123], v5, s[4:7], s29 offen sc1
  v_mfma_f32_16x16x32_bf16 v[16:19], v[36:39], v[68:71], 0
  s_waitcnt lgkmcnt(6)
  ds_read_b64_tr_b16 v[124:125], v6 offset:27136
  ds_read_b64_tr_b16 v[126:127], v6 offset:27200
  v_mfma_f32_16x16x32_bf16 v[16:19], v[40:43], v[72:75], v[16:19]
  s_waitcnt lgkmcnt(6)
  ds_read_b64_tr_b16 v[104:105], v6 offset:27392
  ds_read_b64_tr_b16 v[106:107], v6 offset:27456
  v_mfma_f32_16x16x32_bf16 v[16:19], v[44:47], v[76:79], v[16:19]
  s_waitcnt lgkmcnt(6)
  ds_read_b64_tr_b16 v[108:109], v6 offset:27648
  ds_read_b64_tr_b16 v[110:111], v6 offset:27712
  v_mfma_f32_16x16x32_bf16 v[16:19], v[48:51], v[80:83], v[16:19]
  s_waitcnt lgkmcnt(6)
  v_cvt_pk_bf16_f32 v120, v24, v25
  v_cvt_pk_bf16_f32 v121, v26, v27
  v_mov_b32 v86, s14
  v_mfma_f32_16x16x32_bf16 v[112:115], v[116:119], v[68:71], 0
  s_waitcnt lgkmcnt(4)
  buffer_store_dword v86, v8, s[4:7], s15 offen sc1
  buffer_store_dwordx2 v[120:121], v5, s[4:7], s29 offen offset:2304 sc1
  v_mov_b64 v[98:99], 0
  v_mfma_f32_16x16x32_bf16 v[112:115], v[124:127], v[72:75], v[112:115]
  s_waitcnt lgkmcnt(2)
  v_mov_b64 v[36:37], 0
  v_exp_f32 v100, v16
  v_mfma_f32_16x16x32_bf16 v[112:115], v[104:107], v[76:79], v[112:115]
  s_waitcnt lgkmcnt(0)
  v_exp_f32 v101, v17
  v_mfma_f32_16x16x32_bf16 v[112:115], v[108:111], v[80:83], v[112:115]
  s_add_u32 s29, s29, 147456
  v_exp_f32 v102, v18
  v_mfma_f32_16x16x32_bf16 v[20:23], v[52:55], v[68:71], 0
  s_cmp_eq_u32 s14, 63
  v_exp_f32 v103, v19
  v_mfma_f32_16x16x32_bf16 v[20:23], v[56:59], v[72:75], v[20:23]
  s_cbranch_scc1 M_tdone
  v_cvt_pk_bf16_f32 v44, v100, v101
  v_cvt_pk_bf16_f32 v45, v102, v103
  v_mfma_f32_16x16x32_bf16 v[20:23], v[60:63], v[76:79], v[20:23]
  v_exp_f32 v100, v112
  v_mfma_f32_16x16x32_bf16 v[20:23], v[64:67], v[80:83], v[20:23]
  v_exp_f32 v101, v113
  v_exp_f32 v102, v114
  v_exp_f32 v103, v115
  v_cvt_pk_bf16_f32 v84, v100, v101
  v_cvt_pk_bf16_f32 v85, v102, v103
  v_cndmask_b32 v48, v84, 0, s[16:17]
  v_cndmask_b32 v49, v85, 0, s[16:17]
  v_cndmask_b32 v50, 0, v84, s[16:17]
  v_cndmask_b32 v51, 0, v85, s[16:17]
  v_exp_f32 v100, v20
  v_mfma_f32_16x16x16_bf16 v[88:91], v[12:13], v[48:49], 0
  v_exp_f32 v101, v21
  v_mfma_f32_16x16x16_bf16 v[24:27], v[120:121], v[48:49], 0
  v_exp_f32 v102, v22
  v_mfma_f32_16x16x16_bf16 v[116:119], v[120:121], v[50:51], 0
  v_exp_f32 v103, v23
  v_cvt_pk_bf16_f32 v46, v100, v101
  v_cvt_pk_bf16_f32 v47, v102, v103
  v_mov_b64 v[38:39], 0
  s_nop 0
  v_mfma_f32_16x16x32_bf16 v[88:91], v[12:15], v[44:47], v[88:91]
  v_mov_b64 v[40:41], 0
  v_mov_b64 v[42:43], 0
  v_mfma_f32_16x16x32_bf16 v[24:27], v[28:31], v[44:47], v[24:27]
  ds_read_b128 v[52:55], v4 offset:24576
  ds_read_b128 v[56:59], v4 offset:25600
  v_mfma_f32_16x16x32_bf16 v[116:119], v[32:35], v[44:47], v[116:119]
  s_nop 1
  v_rcp_f32 v89, v88
  v_subrev_u32 v100, s54, v88
  v_cmp_le_u32 vcc, s55, v100
  v_mul_f32 v24, v89, v24
  v_mul_f32 v25, v89, v25
  s_cbranch_vccnz T_slow_113
T_back_114:
  v_cvt_pk_bf16_f32 v124, v24, v25
  v_pk_mul_f32 v[26:27], v[26:27], v[88:89] op_sel:[0,1] op_sel_hi:[1,1]
  v_pk_mul_f32 v[116:117], v[116:117], v[88:89] op_sel:[0,1] op_sel_hi:[1,1]
  v_pk_mul_f32 v[118:119], v[118:119], v[88:89] op_sel:[0,1] op_sel_hi:[1,1]
  v_cvt_pk_bf16_f32 v125, v26, v27
  v_cvt_pk_bf16_f32 v126, v116, v117
  v_cvt_pk_bf16_f32 v127, v118, v119
  ds_write_b128 v11, v[124:127] offset:30208
  s_nop 0
  v_smfmac_f32_16x16x64_bf16 v[92:95], v[124:127], a[160:167], v0
  v_smfmac_f32_16x16x64_bf16 v[96:99], v[124:127], a[168:175], v0
  v_smfmac_f32_16x16x64_bf16 v[36:39], v[124:127], a[176:183], v0
  v_smfmac_f32_16x16x64_bf16 v[40:43], v[124:127], a[184:191], v0
  s_waitcnt lgkmcnt(0)
  s_barrier
  ds_read_b128 v[104:107], v11 offset:30720
  ds_read_b128 v[108:111], v11 offset:29184
  ds_read_b128 v[68:71], v11 offset:29696
  s_waitcnt lgkmcnt(2)
  v_smfmac_f32_16x16x64_bf16 v[92:95], v[104:107], a[192:199], v0
  s_waitcnt lgkmcnt(1)
  ds_read_b128 v[76:79], v4 offset:28672
  v_smfmac_f32_16x16x64_bf16 v[92:95], v[108:111], a[224:231], v0
  s_waitcnt lgkmcnt(1)
  ds_read_b128 v[80:83], v4 offset:29696
  v_smfmac_f32_16x16x64_bf16 v[92:95], v[68:71], a[240:247], v0
  ds_read_b128 v[60:63], v4 offset:26624
  v_smfmac_f32_16x16x64_bf16 v[96:99], v[104:107], a[200:207], v0
  ds_read_b128 v[64:67], v4 offset:27648
  v_smfmac_f32_16x16x64_bf16 v[96:99], v[108:111], a[232:239], v0
  ds_read_b128 v[28:31], v4 offset:30720
  s_nop 0
  v_cvt_pk_bf16_f32 v16, v92, v93
  v_cvt_pk_bf16_f32 v17, v94, v95
  v_bfi_b32 v16, 1, s57, v16
  v_smfmac_f32_16x16x64_bf16 v[96:99], v[68:71], a[248:255], v0
  buffer_store_dwordx2 v[16:17], v7, s[4:7], s20 offen offset:0
  v_smfmac_f32_16x16x64_bf16 v[36:39], v[104:107], a[208:215], v0
  ds_read_b128 v[32:35], v4 offset:31744
  v_smfmac_f32_16x16x64_bf16 v[36:39], v[108:111], v[52:59], v0
  s_waitcnt lgkmcnt(4)
  s_nop 0
  v_cvt_pk_bf16_f32 v18, v96, v97
  v_cvt_pk_bf16_f32 v19, v98, v99
  v_bfi_b32 v18, 1, s57, v18
  v_smfmac_f32_16x16x64_bf16 v[36:39], v[68:71], v[76:83], v0
  buffer_store_dwordx2 v[18:19], v7, s[4:7], s20 offen offset:64
  v_smfmac_f32_16x16x64_bf16 v[40:43], v[104:107], a[216:223], v0
  s_waitcnt lgkmcnt(2)
  v_smfmac_f32_16x16x64_bf16 v[40:43], v[108:111], v[60:67], v0
  s_waitcnt lgkmcnt(0)
  s_nop 0
  v_cvt_pk_bf16_f32 v20, v36, v37
  v_cvt_pk_bf16_f32 v21, v38, v39
  v_bfi_b32 v20, 1, s57, v20
  v_smfmac_f32_16x16x64_bf16 v[40:43], v[68:71], v[28:35], v0
  buffer_store_dwordx2 v[20:21], v7, s[4:7], s21 offen offset:0
  s_nop 6
  v_cvt_pk_bf16_f32 v22, v40, v41
  v_cvt_pk_bf16_f32 v23, v42, v43
  v_bfi_b32 v22, 1, s57, v22
  buffer_store_dwordx2 v[22:23], v7, s[4:7], s21 offen offset:64
  ds_read_b128 v[68:71], v4 offset:0
  ds_read_b128 v[72:75], v4 offset:1024
  ds_read_b128 v[76:79], v4 offset:4096
  ds_read_b128 v[80:83], v4 offset:5120
  ds_read_b128 v[84:87], v4 offset:8192
  ds_read_b128 v[88:91], v4 offset:9216
  ds_read_b128 v[92:95], v4 offset:2048
  ds_read_b128 v[96:99], v4 offset:3072
  ds_read_b128 v[100:103], v4 offset:6144
  ds_read_b128 v[104:107], v4 offset:7168
  ds_read_b128 v[108:111], v4 offset:10240
  ds_read_b128 v[112:115], v4 offset:11264
  v_mov_b64 v[16:17], 0
  v_mov_b64 v[18:19], 0
  v_mov_b64 v[20:21], 0
  v_mov_b64 v[22:23], 0
  v_mov_b64 v[24:25], 0
  v_mov_b64 v[26:27], 0
  ds_read_b64 v[44:45], v2 offset:32256
  s_waitcnt lgkmcnt(0)
  v_readfirstlane_b32 s38, v44
  v_readfirstlane_b32 s37, v45
  s_nop 0
  s_add_u32 s37, s37, 30
  s_cmp_ge_u32 s38, 30
  s_cselect_b32 s38, s37, s38
  s_cmp_ge_u32 s38, 64
  s_cselect_b32 s38, 100, s38
  s_sub_u32 s38, s38, 1
  s_max_i32 s30, s30, s38
  s_waitcnt vmcnt(4)
  s_barrier
  ds_read_b128 v[28:31], v2 offset:18432
  ds_read_b128 v[32:35], v2 offset:22528
  ds_read_b128 v[36:39], v2 offset:8192
  ds_read_b128 v[40:43], v2 offset:9216
  ds_read_b128 v[44:47], v2 offset:10240
  ds_read_b128 v[48:51], v2 offset:11264
  buffer_load_dwordx4 v[124:127], v3, s[4:7], s24 offen offset:2048 sc1
  buffer_load_dwordx4 v[116:119], v3, s[4:7], s25 offen offset:2048 sc1
  ds_read_b128 v[52:55], v2 offset:12288
  ds_read_b128 v[56:59], v2 offset:13312
  ds_read_b128 v[60:63], v2 offset:14336
  ds_read_b128 v[64:67], v2 offset:15360
  buffer_load_dwordx4 v[124:127], v3, s[4:7], s24 offen offset:2048 sc1
  buffer_load_dwordx4 v[116:119], v3, s[4:7], s25 offen offset:2048 sc1
  s_mov_b32 s19, 0
  s_branch T_loop_107
T_kvw_111:
  s_mov_b32 s19, 0
  s_branch T_kvok_119
T_kv_118:
  s_sleep 4
  s_add_u32 s19, s19, 1
  s_cmp_gt_u32 s19, 32768
  s_cbranch_scc1 M_exit
T_kvok_119:
  s_add_u32 s39, s99, 128
  s_mov_b32 s38, 0
  s_mov_b32 s37, 0
  s_atomic_or s38, s[58:59], s99 glc
  s_atomic_or s37, s[58:59], s39 glc
  s_waitcnt lgkmcnt(0)
  s_add_u32 s37, s37, 30
  s_cmp_ge_u32 s38, 30
  s_cselect_b32 s38, s37, s38
  s_cmp_ge_u32 s38, 64
  s_cselect_b32 s38, 100, s38
  s_sub_u32 s38, s38, 1
  s_max_i32 s30, s30, s38
  s_cmp_ge_i32 s14, s30
  s_cbranch_scc1 T_kv_118
  s_branch T_kvb_112
T_slow_113:
  s_nop 7
  v_max3_f32 v100, v16, v17, v18
  v_max3_f32 v100, v100, v19, v20
  v_max3_f32 v100, v100, v21, v22
  v_max3_f32 v100, v100, v23, v112
  v_max3_f32 v100, v100, v113, v114
  v_max_f32 v100, v100, v115
  v_mov_b32 v101, v100
  s_nop 1
  v_permlane32_swap_b32 v100, v101
  s_nop 1
  v_max_f32 v100, v100, v101
  v_mov_b32 v101, v100
  s_nop 1
  v_permlane16_swap_b32 v100, v101
  s_nop 1
  v_max_f32 v100, v100, v101
  v_sub_f32 v16, v16, v100
  v_sub_f32 v17, v17, v100
  v_sub_f32 v18, v18, v100
  v_sub_f32 v19, v19, v100
  v_exp_f32 v16, v16
  v_exp_f32 v17, v17
  v_exp_f32 v18, v18
  v_exp_f32 v19, v19
  v_sub_f32 v20, v20, v100
  v_sub_f32 v21, v21, v100
  v_sub_f32 v22, v22, v100
  v_sub_f32 v23, v23, v100
  v_exp_f32 v20, v20
  v_exp_f32 v21, v21
  v_exp_f32 v22, v22
  v_exp_f32 v23, v23
  v_sub_f32 v112, v112, v100
  v_sub_f32 v113, v113, v100
  v_sub_f32 v114, v114, v100
  v_sub_f32 v115, v115, v100
  v_exp_f32 v112, v112
  v_exp_f32 v113, v113
  v_exp_f32 v114, v114
  v_exp_f32 v115, v115
  s_nop 0
  v_cvt_pk_bf16_f32 v44, v16, v17
  v_cvt_pk_bf16_f32 v45, v18, v19
  v_cvt_pk_bf16_f32 v46, v20, v21
  v_cvt_pk_bf16_f32 v47, v22, v23
  v_cvt_pk_bf16_f32 v84, v112, v113
  v_cvt_pk_bf16_f32 v85, v114, v115
  v_cndmask_b32 v48, v84, 0, s[16:17]
  v_cndmask_b32 v49, v85, 0, s[16:17]
  v_cndmask_b32 v50, 0, v84, s[16:17]
  v_cndmask_b32 v51, 0, v85, s[16:17]
  s_nop 1
  v_mfma_f32_16x16x16_bf16 v[88:91], v[12:13], v[48:49], 0
  v_mfma_f32_16x16x16_bf16 v[24:27], v[120:121], v[48:49], 0
  v_mfma_f32_16x16x16_bf16 v[116:119], v[120:121], v[50:51], 0
  v_mfma_f32_16x16x32_bf16 v[88:91], v[12:15], v[44:47], v[88:91]
  v_mfma_f32_16x16x32_bf16 v[24:27], v[28:31], v[44:47], v[24:27]
  v_mfma_f32_16x16x32_bf16 v[116:119], v[32:35], v[44:47], v[116:119]
  s_nop 7
  s_nop 1
  v_rcp_f32 v89, v88
  s_nop 0
  v_mul_f32 v24, v89, v24
  v_mul_f32 v25, v89, v25
  s_branch T_back_114
T_w_80:
  s_mov_b32 s19, 0
  v_mov_b64 v[16:17], 0
  v_mov_b64 v[18:19], 0
  v_mov_b64 v[20:21], 0
  v_mov_b64 v[22:23], 0
  v_mov_b64 v[24:25], 0
  v_mov_b64 v[26:27], 0
  buffer_load_dwordx4 v[124:127], v3, s[4:7], s24 offen offset:3072 sc1
  buffer_load_dwordx4 v[116:119], v3, s[4:7], s25 offen offset:3072 sc1
  buffer_load_dwordx4 v[124:127], v3, s[4:7], s24 offen offset:3072 sc1
  buffer_load_dwordx4 v[116:119], v3, s[4:7], s25 offen offset:3072 sc1
  s_branch T_loop_120
.p2align 6
T_retry_121:
  s_mov_b64 exec, vcc
  buffer_load_dwordx4 v[124:127], v3, s[4:7], s24 offen offset:3072 sc1
  buffer_load_dwordx4 v[116:119], v3, s[4:7], s25 offen offset:3072 sc1
  s_mov_b64 exec, -1
  s_add_u32 s19, s19, 1
  s_cmp_gt_u32 s19, 32768
  s_cbranch_scc1 M_exit
T_loop_120:
  s_waitcnt vmcnt(3) lgkmcnt(0)
  v_max3_u32 v123, v124, v125, v126
  v_max_u32 v123, v123, v127
  v_mov_b32_dpp v120, v124 row_ror:8 row_mask:0xf bank_mask:0xf
  v_mov_b32_dpp v121, v125 row_ror:8 row_mask:0xf bank_mask:0xf
  s_waitcnt vmcnt(2)
  v_max3_u32 v123, v123, v116, v117
  v_max3_u32 v123, v123, v118, v119
  v_cmp_eq_u32 vcc, -1, v123
  s_cbranch_vccnz T_retry_121
  v_smfmac_f32_16x16x64_bf16 v[16:19], v[124:127], v[68:75], v0
  s_add_u32 s14, s14, 1
  ds_write_b128 v2, v[124:127] offset:3072
  v_mov_b32_dpp v122, v126 row_ror:8 row_mask:0xf bank_mask:0xf
  v_smfmac_f32_16x16x64_bf16 v[20:23], v[124:127], v[76:83], v0
  s_and_b32 s57, s14, 1
  v_mov_b32_dpp v123, v127 row_ror:8 row_mask:0xf bank_mask:0xf
  v_smfmac_f32_16x16x64_bf16 v[24:27], v[124:127], v[84:91], v0
  s_and_b32 s36, s14, 3
  ds_write_b128 v2, v[116:119] offset:7168
  v_smfmac_f32_16x16x64_bf16 v[16:19], v[120:123], v[92:99], v0
  s_lshl_b32 s36, s36, 13
  v_mov_b32_dpp v84, v116 row_ror:8 row_mask:0xf bank_mask:0xf
  v_smfmac_f32_16x16x64_bf16 v[20:23], v[120:123], v[100:107], v0
  s_add_u32 s26, s36, s23
  ds_read_b128 v[68:71], v4 offset:12288
  v_mov_b32_dpp v85, v117 row_ror:8 row_mask:0xf bank_mask:0xf
  v_smfmac_f32_16x16x64_bf16 v[24:27], v[120:123], v[108:115], v0
  s_add_u32 s36, s36, 8192
  ds_read_b128 v[72:75], v4 offset:13312
  v_mov_b32_dpp v86, v118 row_ror:8 row_mask:0xf bank_mask:0xf
  v_smfmac_f32_16x16x64_bf16 v[16:19], v[116:119], v[224:231], v0
  s_and_b32 s36, s36, 0x7fff
  ds_read_b128 v[76:79], v4 offset:14336
  v_mov_b32_dpp v87, v119 row_ror:8 row_mask:0xf bank_mask:0xf
  v_smfmac_f32_16x16x64_bf16 v[20:23], v[116:119], v[240:247], v0
  s_waitcnt lgkmcnt(3)
  s_barrier
  ds_read_b128 v[100:103], v2 offset:2048
  v_smfmac_f32_16x16x64_bf16 v[24:27], v[116:119], a[0:7], v0
  s_mov_b32 m0, s31
  ds_read_b128 v[120:123], v1 offset:2048
  v_smfmac_f32_16x16x64_bf16 v[16:19], v[84:87], v[232:239], v0
  s_cmp_ge_i32 s14, s30
  s_cbranch_scc1 T_kvw_124
T_kvb_125:
  v_smfmac_f32_16x16x64_bf16 v[20:23], v[84:87], v[248:255], v0
  ds_read_b128 v[80:83], v4 offset:15360
  v_smfmac_f32_16x16x64_bf16 v[24:27], v[84:87], a[8:15], v0
  s_waitcnt lgkmcnt(2)
  v_smfmac_f32_16x16x64_bf16 v[16:19], v[100:103], v[128:135], v0
  ds_read_b128 v[92:95], v2 offset:1024
  v_smfmac_f32_16x16x64_bf16 v[20:23], v[100:103], v[144:151], v0
  ds_read_b128 v[96:99], v1 offset:1024
  buffer_load_dwordx4 v9, s[4:7], s27 offen sc1 lds
  v_smfmac_f32_16x16x64_bf16 v[24:27], v[100:103], v[68:75], v0
  s_waitcnt vmcnt(1) lgkmcnt(3)
  ds_read_b128 v[116:119], v2 offset:0
  s_mov_b32 m0, s32
  v_smfmac_f32_16x16x64_bf16 v[16:19], v[120:123], v[136:143], v0
  ds_read_b128 v[124:127], v1 offset:0
  v_smfmac_f32_16x16x64_bf16 v[20:23], v[120:123], v[152:159], v0
  s_waitcnt lgkmcnt(4)
  ds_read_b128 v[104:107], v2 offset:6144
  v_smfmac_f32_16x16x64_bf16 v[24:27], v[120:123], v[76:83], v0
  s_waitcnt lgkmcnt(4)
  ds_read_b128 v[108:111], v1 offset:6144
  buffer_load_dwordx4 v9, s[4:7], s27 offen offset:128 sc1 lds
  v_smfmac_f32_16x16x64_bf16 v[16:19], v[92:95], v[160:167], v0
  s_waitcnt lgkmcnt(4)
  ds_read_b128 v[112:115], v2 offset:5120
  s_mov_b32 m0, s33
  v_smfmac_f32_16x16x64_bf16 v[16:19], v[96:99], v[168:175], v0
  s_waitcnt lgkmcnt(4)
  ds_read_b128 v[84:87], v1 offset:5120
  v_smfmac_f32_16x16x64_bf16 v[16:19], v[116:119], v[192:199], v0
  s_waitcnt lgkmcnt(4)
  ds_read_b128 v[88:91], v2 offset:4096
  v_smfmac_f32_16x16x64_bf16 v[16:19], v[124:127], v[200:207], v0
  s_waitcnt lgkmcnt(4)
  ds_read_b128 v[100:103], v1 offset:4096
  buffer_load_dwordx4 v10, s[4:7], s28 offen sc1 lds
  v_smfmac_f32_16x16x64_bf16 v[16:19], v[104:107], a[16:23], v0
  s_waitcnt lgkmcnt(4)
  ds_read_b128 v[68:71], v4 offset:16384
  s_mov_b32 m0, s34
  v_smfmac_f32_16x16x64_bf16 v[16:19], v[108:111], a[24:31], v0
  s_waitcnt lgkmcnt(4)
  ds_read_b128 v[72:75], v4 offset:17408
  v_smfmac_f32_16x16x64_bf16 v[16:19], v[112:115], a[64:71], v0
  s_waitcnt lgkmcnt(4)
  ds_read_b128 v[76:79], v4 offset:18432
  v_smfmac_f32_16x16x64_bf16 v[16:19], v[84:87], a[72:79], v0
  s_waitcnt lgkmcnt(4)
  ds_read_b128 v[80:83], v4 offset:19456
  buffer_load_dwordx4 v10, s[4:7], s28 offen offset:256 sc1 lds
  v_smfmac_f32_16x16x64_bf16 v[16:19], v[88:91], a[112:119], v0
  s_waitcnt lgkmcnt(4)
  v_smfmac_f32_16x16x64_bf16 v[16:19], v[100:103], a[120:127], v0
  s_add_u32 s24, s36, 145752064
  s_add_u32 s25, s36, 145756160
  v_smfmac_f32_16x16x64_bf16 v[20:23], v[92:95], v[176:183], v0
  s_add_u32 s35, s36, s23
  v_smfmac_f32_16x16x64_bf16 v[20:23], v[96:99], v[184:191], v0
  s_waitcnt lgkmcnt(2)
  v_smfmac_f32_16x16x64_bf16 v[20:23], v[116:119], v[68:75], v0
  s_waitcnt lgkmcnt(0)
  ds_read_b128 v[68:71], v4 offset:20480
  v_mul_f32 v16, s18, v16
  v_smfmac_f32_16x16x64_bf16 v[20:23], v[124:127], v[76:83], v0
  ds_read_b128 v[72:75], v4 offset:21504
  v_mul_f32 v17, s18, v17
  v_smfmac_f32_16x16x64_bf16 v[20:23], v[104:107], a[32:39], v0
  ds_read_b128 v[76:79], v4 offset:22528
  v_mul_f32 v18, s18, v18
  v_smfmac_f32_16x16x64_bf16 v[20:23], v[108:111], a[40:47], v0
  ds_read_b128 v[80:83], v4 offset:23552
  v_mul_f32 v19, s18, v19
  v_smfmac_f32_16x16x64_bf16 v[20:23], v[112:115], a[80:87], v0
  v_cvt_pk_bf16_f32 v120, v16, v17
  v_smfmac_f32_16x16x64_bf16 v[20:23], v[84:87], a[88:95], v0
  v_cvt_pk_bf16_f32 v121, v18, v19
  v_smfmac_f32_16x16x64_bf16 v[20:23], v[88:91], a[128:135], v0
  ds_write_b64 v5, v[120:121] offset:24576
  v_smfmac_f32_16x16x64_bf16 v[20:23], v[100:103], a[136:143], v0
  s_waitcnt lgkmcnt(3)
  v_smfmac_f32_16x16x64_bf16 v[24:27], v[92:95], v[68:75], v0
  s_waitcnt lgkmcnt(1)
  v_mov_b64 v[92:93], 0
  v_smfmac_f32_16x16x64_bf16 v[24:27], v[96:99], v[76:83], v0
  s_nop 1
  v_cvt_pk_bf16_f32 v122, v20, v21
  v_cvt_pk_bf16_f32 v123, v22, v23
  v_smfmac_f32_16x16x64_bf16 v[24:27], v[116:119], v[208:215], v0
  ds_write_b64 v5, v[122:123] offset:26880
  v_mov_b64 v[94:95], 0
  v_smfmac_f32_16x16x64_bf16 v[24:27], v[124:127], v[216:223], v0
  s_waitcnt lgkmcnt(1)
  s_barrier
  ds_read_b64_tr_b16 v[68:69], v6 offset:24576
  v_smfmac_f32_16x16x64_bf16 v[24:27], v[104:107], a[48:55], v0
  s_add_u32 s27, s27, 8192
  ds_read_b64_tr_b16 v[70:71], v6 offset:24640
  ds_read_b64_tr_b16 v[72:73], v6 offset:24832
  v_smfmac_f32_16x16x64_bf16 v[24:27], v[108:111], a[56:63], v0
  s_add_u32 s28, s28, 8192
  ds_read_b64_tr_b16 v[74:75], v6 offset:24896
  ds_read_b64_tr_b16 v[76:77], v6 offset:25088
  v_smfmac_f32_16x16x64_bf16 v[24:27], v[112:115], a[96:103], v0
  s_nop 0
  ds_read_b64_tr_b16 v[78:79], v6 offset:25152
  ds_read_b64_tr_b16 v[80:81], v6 offset:25344
  v_smfmac_f32_16x16x64_bf16 v[24:27], v[84:87], a[104:111], v0
  ds_read_b64_tr_b16 v[82:83], v6 offset:25408
  v_mov_b64 v[96:97], 0
  v_smfmac_f32_16x16x64_bf16 v[24:27], v[88:91], a[144:151], v0
  s_waitcnt lgkmcnt(8)
  s_barrier
  ds_read_b64_tr_b16 v[116:117], v6 offset:26880
  v_smfmac_f32_16x16x64_bf16 v[24:27], v[100:103], a[152:159], v0
  s_waitcnt lgkmcnt(7)
  ds_read_b64_tr_b16 v[118:119], v6 offset:26944
  buffer_store_dwordx2 v[122:123], v5, s[4:7], s29 offen sc1
  v_mfma_f32_16x16x32_bf16 v[16:19], v[36:39], v[68:71], 0
  s_waitcnt lgkmcnt(6)
  ds_read_b64_tr_b16 v[124:125], v6 offset:27136
  ds_read_b64_tr_b16 v[126:127], v6 offset:27200
  v_mfma_f32_16x16x32_bf16 v[16:19], v[40:43], v[72:75], v[16:19]
  s_waitcnt lgkmcnt(6)
  ds_read_b64_tr_b16 v[104:105], v6 offset:27392
  ds_read_b64_tr_b16 v[106:107], v6 offset:27456
  v_mfma_f32_16x16x32_bf16 v[16:19], v[44:47], v[76:79], v[16:19]
  s_waitcnt lgkmcnt(6)
  ds_read_b64_tr_b16 v[108:109], v6 offset:27648
  ds_read_b64_tr_b16 v[110:111], v6 offset:27712
  v_mfma_f32_16x16x32_bf16 v[16:19], v[48:51], v[80:83], v[16:19]
  s_waitcnt lgkmcnt(6)
  s_mov_b32 m0, 32256
  v_cvt_pk_bf16_f32 v120, v24, v25
  v_cvt_pk_bf16_f32 v121, v26, v27
  v_mfma_f32_16x16x32_bf16 v[112:115], v[116:119], v[68:71], 0
  s_waitcnt lgkmcnt(4)
  buffer_load_dword v8, s[4:7], s99 offen sc1 lds
  buffer_store_dwordx2 v[120:121], v5, s[4:7], s29 offen offset:2304 sc1
  v_mov_b64 v[98:99], 0
  v_mfma_f32_16x16x32_bf16 v[112:115], v[124:127], v[72:75], v[112:115]
  s_waitcnt lgkmcnt(2)
  v_mov_b64 v[36:37], 0
  v_exp_f32 v100, v16
  v_mfma_f32_16x16x32_bf16 v[112:115], v[104:107], v[76:79], v[112:115]
  s_waitcnt lgkmcnt(0)
  v_exp_f32 v101, v17
  v_mfma_f32_16x16x32_bf16 v[112:115], v[108:111], v[80:83], v[112:115]
  s_add_u32 s29, s29, 147456
  v_exp_f32 v102, v18
  v_mfma_f32_16x16x32_bf16 v[20:23], v[52:55], v[68:71], 0
  s_cmp_eq_u32 s14, 63
  v_exp_f32 v103, v19
  v_mfma_f32_16x16x32_bf16 v[20:23], v[56:59], v[72:75], v[20:23]
  s_cbranch_scc1 M_tdone
  v_cvt_pk_bf16_f32 v44, v100, v101
  v_cvt_pk_bf16_f32 v45, v102, v103
  v_mfma_f32_16x16x32_bf16 v[20:23], v[60:63], v[76:79], v[20:23]
  v_exp_f32 v100, v112
  v_mfma_f32_16x16x32_bf16 v[20:23], v[64:67], v[80:83], v[20:23]
  v_exp_f32 v101, v113
  v_exp_f32 v102, v114
  v_exp_f32 v103, v115
  v_cvt_pk_bf16_f32 v84, v100, v101
  v_cvt_pk_bf16_f32 v85, v102, v103
  v_cndmask_b32 v48, v84, 0, s[16:17]
  v_cndmask_b32 v49, v85, 0, s[16:17]
  v_cndmask_b32 v50, 0, v84, s[16:17]
  v_cndmask_b32 v51, 0, v85, s[16:17]
  v_exp_f32 v100, v20
  v_mfma_f32_16x16x16_bf16 v[88:91], v[12:13], v[48:49], 0
  v_exp_f32 v101, v21
  v_mfma_f32_16x16x16_bf16 v[24:27], v[120:121], v[48:49], 0
  v_exp_f32 v102, v22
  v_mfma_f32_16x16x16_bf16 v[116:119], v[120:121], v[50:51], 0
  v_exp_f32 v103, v23
  v_cvt_pk_bf16_f32 v46, v100, v101
  v_cvt_pk_bf16_f32 v47, v102, v103
  v_mov_b64 v[38:39], 0
  s_nop 0
  v_mfma_f32_16x16x32_bf16 v[88:91], v[12:15], v[44:47], v[88:91]
  v_mov_b64 v[40:41], 0
  v_mov_b64 v[42:43], 0
  v_mfma_f32_16x16x32_bf16 v[24:27], v[28:31], v[44:47], v[24:27]
  ds_read_b128 v[52:55], v4 offset:24576
  ds_read_b128 v[56:59], v4 offset:25600
  v_mfma_f32_16x16x32_bf16 v[116:119], v[32:35], v[44:47], v[116:119]
  s_nop 1
  v_rcp_f32 v89, v88
  v_subrev_u32 v100, s54, v88
  v_cmp_le_u32 vcc, s55, v100
  v_mul_f32 v24, v89, v24
  v_mul_f32 v25, v89, v25
  s_cbranch_vccnz T_slow_126
T_back_127:
  v_cvt_pk_bf16_f32 v124, v24, v25
  v_pk_mul_f32 v[26:27], v[26:27], v[88:89] op_sel:[0,1] op_sel_hi:[1,1]
  v_pk_mul_f32 v[116:117], v[116:117], v[88:89] op_sel:[0,1] op_sel_hi:[1,1]
  v_pk_mul_f32 v[118:119], v[118:119], v[88:89] op_sel:[0,1] op_sel_hi:[1,1]
  v_cvt_pk_bf16_f32 v125, v26, v27
  v_cvt_pk_bf16_f32 v126, v116, v117
  v_cvt_pk_bf16_f32 v127, v118, v119
  ds_write_b128 v11, v[124:127] offset:30720
  s_nop 0
  v_smfmac_f32_16x16x64_bf16 v[92:95], v[124:127], a[160:167], v0
  v_smfmac_f32_16x16x64_bf16 v[96:99], v[124:127], a[168:175], v0
  v_smfmac_f32_16x16x64_bf16 v[36:39], v[124:127], a[176:183], v0
  v_smfmac_f32_16x16x64_bf16 v[40:43], v[124:127], a[184:191], v0
  s_waitcnt lgkmcnt(0)
  s_barrier
  ds_read_b128 v[104:107], v11 offset:30208
  ds_read_b128 v[108:111], v11 offset:29696
  ds_read_b128 v[68:71], v11 offset:29184
  s_waitcnt lgkmcnt(2)
  v_smfmac_f32_16x16x64_bf16 v[92:95], v[104:107], a[192:199], v0
  s_waitcnt lgkmcnt(1)
  ds_read_b128 v[76:79], v4 offset:28672
  v_smfmac_f32_16x16x64_bf16 v[92:95], v[108:111], a[224:231], v0
  s_waitcnt lgkmcnt(1)
  ds_read_b128 v[80:83], v4 offset:29696
  v_smfmac_f32_16x16x64_bf16 v[92:95], v[68:71], a[240:247], v0
  ds_read_b128 v[60:63], v4 offset:26624
  v_smfmac_f32_16x16x64_bf16 v[96:99], v[104:107], a[200:207], v0
  ds_read_b128 v[64:67], v4 offset:27648
  v_smfmac_f32_16x16x64_bf16 v[96:99], v[108:111], a[232:239], v0
  ds_read_b128 v[28:31], v4 offset:30720
  s_nop 0
  v_cvt_pk_bf16_f32 v16, v92, v93
  v_cvt_pk_bf16_f32 v17, v94, v95
  v_bfi_b32 v16, 1, s57, v16
  v_smfmac_f32_16x16x64_bf16 v[96:99], v[68:71], a[248:255], v0
  buffer_store_dwordx2 v[16:17], v7, s[4:7], s20 offen offset:0
  v_smfmac_f32_16x16x64_bf16 v[36:39], v[104:107], a[208:215], v0
  ds_read_b128 v[32:35], v4 offset:31744
  v_smfmac_f32_16x16x64_bf16 v[36:39], v[108:111], v[52:59], v0
  s_waitcnt lgkmcnt(4)
  s_nop 0
  v_cvt_pk_bf16_f32 v18, v96, v97
  v_cvt_pk_bf16_f32 v19, v98, v99
  v_bfi_b32 v18, 1, s57, v18
  v_smfmac_f32_16x16x64_bf16 v[36:39], v[68:71], v[76:83], v0
  buffer_store_dwordx2 v[18:19], v7, s[4:7], s20 offen offset:64
  v_smfmac_f32_16x16x64_bf16 v[40:43], v[104:107], a[216:223], v0
  s_waitcnt lgkmcnt(2)
  v_smfmac_f32_16x16x64_bf16 v[40:43], v[108:111], v[60:67], v0
  s_waitcnt lgkmcnt(0)
  s_nop 0
  v_cvt_pk_bf16_f32 v20, v36, v37
  v_cvt_pk_bf16_f32 v21, v38, v39
  v_bfi_b32 v20, 1, s57, v20
  v_smfmac_f32_16x16x64_bf16 v[40:43], v[68:71], v[28:35], v0
  buffer_store_dwordx2 v[20:21], v7, s[4:7], s21 offen offset:0
  s_nop 6
  v_cvt_pk_bf16_f32 v22, v40, v41
  v_cvt_pk_bf16_f32 v23, v42, v43
  v_bfi_b32 v22, 1, s57, v22
  buffer_store_dwordx2 v[22:23], v7, s[4:7], s21 offen offset:64
  ds_read_b128 v[68:71], v4 offset:0
  ds_read_b128 v[72:75], v4 offset:1024
  ds_read_b128 v[76:79], v4 offset:4096
  ds_read_b128 v[80:83], v4 offset:5120
  ds_read_b128 v[84:87], v4 offset:8192
  ds_read_b128 v[88:91], v4 offset:9216
  ds_read_b128 v[92:95], v4 offset:2048
  ds_read_b128 v[96:99], v4 offset:3072
  ds_read_b128 v[100:103], v4 offset:6144
  ds_read_b128 v[104:107], v4 offset:7168
  ds_read_b128 v[108:111], v4 offset:10240
  ds_read_b128 v[112:115], v4 offset:11264
  v_mov_b64 v[16:17], 0
  v_mov_b64 v[18:19], 0
  v_mov_b64 v[20:21], 0
  v_mov_b64 v[22:23], 0
  v_mov_b64 v[24:25], 0
  v_mov_b64 v[26:27], 0
  ds_read_b64 v[44:45], v2 offset:32256
  s_waitcnt lgkmcnt(0)
  v_readfirstlane_b32 s38, v44
  v_readfirstlane_b32 s37, v45
  s_nop 0
  s_add_u32 s37, s37, 30
  s_cmp_ge_u32 s38, 30
  s_cselect_b32 s38, s37, s38
  s_cmp_ge_u32 s38, 64
  s_cselect_b32 s38, 100, s38
  s_sub_u32 s38, s38, 1
  s_max_i32 s30, s30, s38
  s_waitcnt vmcnt(4)
  s_barrier
  ds_read_b128 v[28:31], v2 offset:19456
  ds_read_b128 v[32:35], v2 offset:23552
  ds_read_b128 v[36:39], v2 offset:8192
  ds_read_b128 v[40:43], v2 offset:9216
  ds_read_b128 v[44:47], v2 offset:10240
  ds_read_b128 v[48:51], v2 offset:11264
  buffer_load_dwordx4 v[124:127], v3, s[4:7], s24 offen offset:3072 sc1
  buffer_load_dwordx4 v[116:119], v3, s[4:7], s25 offen offset:3072 sc1
  ds_read_b128 v[52:55], v2 offset:12288
  ds_read_b128 v[56:59], v2 offset:13312
  ds_read_b128 v[60:63], v2 offset:14336
  ds_read_b128 v[64:67], v2 offset:15360
  buffer_load_dwordx4 v[124:127], v3, s[4:7], s24 offen offset:3072 sc1
  buffer_load_dwordx4 v[116:119], v3, s[4:7], s25 offen offset:3072 sc1
  s_mov_b32 s19, 0
  s_branch T_loop_120
T_kvw_124:
  s_mov_b32 s19, 0
  s_branch T_kvok_132
T_kv_131:
  s_sleep 4
  s_add_u32 s19, s19, 1
  s_cmp_gt_u32 s19, 32768
  s_cbranch_scc1 M_exit
T_kvok_132:
  s_add_u32 s39, s99, 128
  s_mov_b32 s38, 0
  s_mov_b32 s37, 0
  s_atomic_or s38, s[58:59], s99 glc
  s_atomic_or s37, s[58:59], s39 glc
  s_waitcnt lgkmcnt(0)
  s_add_u32 s37, s37, 30
  s_cmp_ge_u32 s38, 30
  s_cselect_b32 s38, s37, s38
  s_cmp_ge_u32 s38, 64
  s_cselect_b32 s38, 100, s38
  s_sub_u32 s38, s38, 1
  s_max_i32 s30, s30, s38
  s_cmp_ge_i32 s14, s30
  s_cbranch_scc1 T_kv_131
  s_branch T_kvb_125
T_slow_126:
  s_nop 7
  v_max3_f32 v100, v16, v17, v18
  v_max3_f32 v100, v100, v19, v20
  v_max3_f32 v100, v100, v21, v22
  v_max3_f32 v100, v100, v23, v112
  v_max3_f32 v100, v100, v113, v114
  v_max_f32 v100, v100, v115
  v_mov_b32 v101, v100
  s_nop 1
  v_permlane32_swap_b32 v100, v101
  s_nop 1
  v_max_f32 v100, v100, v101
  v_mov_b32 v101, v100
  s_nop 1
  v_permlane16_swap_b32 v100, v101
  s_nop 1
  v_max_f32 v100, v100, v101
  v_sub_f32 v16, v16, v100
  v_sub_f32 v17, v17, v100
  v_sub_f32 v18, v18, v100
  v_sub_f32 v19, v19, v100
  v_exp_f32 v16, v16
  v_exp_f32 v17, v17
  v_exp_f32 v18, v18
  v_exp_f32 v19, v19
  v_sub_f32 v20, v20, v100
  v_sub_f32 v21, v21, v100
  v_sub_f32 v22, v22, v100
  v_sub_f32 v23, v23, v100
  v_exp_f32 v20, v20
  v_exp_f32 v21, v21
  v_exp_f32 v22, v22
  v_exp_f32 v23, v23
  v_sub_f32 v112, v112, v100
  v_sub_f32 v113, v113, v100
  v_sub_f32 v114, v114, v100
  v_sub_f32 v115, v115, v100
  v_exp_f32 v112, v112
  v_exp_f32 v113, v113
  v_exp_f32 v114, v114
  v_exp_f32 v115, v115
  s_nop 0
  v_cvt_pk_bf16_f32 v44, v16, v17
  v_cvt_pk_bf16_f32 v45, v18, v19
  v_cvt_pk_bf16_f32 v46, v20, v21
  v_cvt_pk_bf16_f32 v47, v22, v23
  v_cvt_pk_bf16_f32 v84, v112, v113
  v_cvt_pk_bf16_f32 v85, v114, v115
  v_cndmask_b32 v48, v84, 0, s[16:17]
  v_cndmask_b32 v49, v85, 0, s[16:17]
  v_cndmask_b32 v50, 0, v84, s[16:17]
  v_cndmask_b32 v51, 0, v85, s[16:17]
  s_nop 1
  v_mfma_f32_16x16x16_bf16 v[88:91], v[12:13], v[48:49], 0
  v_mfma_f32_16x16x16_bf16 v[24:27], v[120:121], v[48:49], 0
  v_mfma_f32_16x16x16_bf16 v[116:119], v[120:121], v[50:51], 0
  v_mfma_f32_16x16x32_bf16 v[88:91], v[12:15], v[44:47], v[88:91]
  v_mfma_f32_16x16x32_bf16 v[24:27], v[28:31], v[44:47], v[24:27]
  v_mfma_f32_16x16x32_bf16 v[116:119], v[32:35], v[44:47], v[116:119]
  s_nop 7
  s_nop 1
  v_rcp_f32 v89, v88
  s_nop 0
  v_mul_f32 v24, v89, v24
  v_mul_f32 v25, v89, v25
  s_branch T_back_127
M_global:
  s_cmp_eq_u32 s13, 1
  s_cbranch_scc1 T_w_134
  s_cmp_eq_u32 s13, 2
  s_cbranch_scc1 T_w_135
  s_cmp_eq_u32 s13, 3
  s_cbranch_scc1 T_w_136
T_w_133:
  s_mov_b32 s19, 0
  v_mov_b64 v[16:17], 0
  v_mov_b64 v[18:19], 0
  v_mov_b64 v[20:21], 0
  v_mov_b64 v[22:23], 0
  v_mov_b64 v[24:25], 0
  v_mov_b64 v[26:27], 0
  buffer_load_dwordx4 v[124:127], v3, s[4:7], s24 offen offset:0 sc1
  buffer_load_dwordx4 v[116:119], v3, s[4:7], s25 offen offset:0 sc1
  buffer_load_dwordx4 v[124:127], v3, s[4:7], s24 offen offset:0 sc1
  buffer_load_dwordx4 v[116:119], v3, s[4:7], s25 offen offset:0 sc1
  s_branch T_loop_137
.p2align 6
T_retry_138:
  s_mov_b64 exec, vcc
  buffer_load_dwordx4 v[124:127], v3, s[4:7], s24 offen offset:0 sc1
  buffer_load_dwordx4 v[116:119], v3, s[4:7], s25 offen offset:0 sc1
  s_mov_b64 exec, -1
  s_add_u32 s19, s19, 1
  s_cmp_gt_u32 s19, 32768
  s_cbranch_scc1 M_exit
T_loop_137:
  s_waitcnt vmcnt(3) lgkmcnt(0)
  v_max3_u32 v123, v124, v125, v126
  v_max_u32 v123, v123, v127
  v_mov_b32_dpp v120, v124 row_ror:8 row_mask:0xf bank_mask:0xf
  v_mov_b32_dpp v121, v125 row_ror:8 row_mask:0xf bank_mask:0xf
  s_waitcnt vmcnt(2)
  v_max3_u32 v123, v123, v116, v117
  v_max3_u32 v123, v123, v118, v119
  v_cmp_eq_u32 vcc, -1, v123
  s_cbranch_vccnz T_retry_138
  v_smfmac_f32_16x16x64_bf16 v[16:19], v[124:127], v[68:75], v0
  s_add_u32 s14, s14, 1
  ds_write_b128 v2, v[124:127] offset:0
  v_mov_b32_dpp v122, v126 row_ror:8 row_mask:0xf bank_mask:0xf
  v_smfmac_f32_16x16x64_bf16 v[20:23], v[124:127], v[76:83], v0
  s_and_b32 s57, s14, 1
  v_mov_b32_dpp v123, v127 row_ror:8 row_mask:0xf bank_mask:0xf
  v_smfmac_f32_16x16x64_bf16 v[24:27], v[124:127], v[84:91], v0
  s_and_b32 s36, s14, 3
  ds_write_b128 v2, v[116:119] offset:4096
  v_smfmac_f32_16x16x64_bf16 v[16:19], v[120:123], v[92:99], v0
  s_lshl_b32 s36, s36, 13
  v_mov_b32_dpp v84, v116 row_ror:8 row_mask:0xf bank_mask:0xf
  v_smfmac_f32_16x16x64_bf16 v[20:23], v[120:123], v[100:107], v0
  s_add_u32 s26, s36, s23
  ds_read_b128 v[68:71], v4 offset:12288
  v_mov_b32_dpp v85, v117 row_ror:8 row_mask:0xf bank_mask:0xf
  v_smfmac_f32_16x16x64_bf16 v[24:27], v[120:123], v[108:115], v0
  s_add_u32 s36, s36, 8192
  ds_read_b128 v[72:75], v4 offset:13312
  v_mov_b32_dpp v86, v118 row_ror:8 row_mask:0xf bank_mask:0xf
  v_smfmac_f32_16x16x64_bf16 v[16:19], v[116:119], v[224:231], v0
  s_and_b32 s36, s36, 0x7fff
  ds_read_b128 v[76:79], v4 offset:14336
  v_mov_b32_dpp v87, v119 row_ror:8 row_mask:0xf bank_mask:0xf
  v_smfmac_f32_16x16x64_bf16 v[20:23], v[116:119], v[240:247], v0
  s_waitcnt lgkmcnt(3)
  s_barrier
  ds_read_b128 v[100:103], v2 offset:1024
  v_smfmac_f32_16x16x64_bf16 v[24:27], v[116:119], a[0:7], v0
  s_mov_b32 m0, s31
  ds_read_b128 v[120:123], v1 offset:1024
  v_smfmac_f32_16x16x64_bf16 v[16:19], v[84:87], v[232:239], v0
  s_cmp_ge_i32 s14, s30
  s_cbranch_scc1 T_kvw_141
T_kvb_142:
  v_smfmac_f32_16x16x64_bf16 v[20:23], v[84:87], v[248:255], v0
  ds_read_b128 v[80:83], v4 offset:15360
  buffer_load_dwordx4 v9, s[4:7], s27 offen sc1 lds
  v_smfmac_f32_16x16x64_bf16 v[24:27], v[84:87], a[8:15], v0
  s_waitcnt lgkmcnt(2)
  s_mov_b32 m0, s32
  v_smfmac_f32_16x16x64_bf16 v[16:19], v[100:103], v[128:135], v0
  ds_read_b128 v[92:95], v2 offset:2048
  v_smfmac_f32_16x16x64_bf16 v[20:23], v[100:103], v[144:151], v0
  ds_read_b128 v[96:99], v1 offset:2048
  v_smfmac_f32_16x16x64_bf16 v[24:27], v[100:103], v[68:75], v0
  s_waitcnt vmcnt(1) lgkmcnt(3)
  ds_read_b128 v[116:119], v2 offset:3072
  buffer_load_dwordx4 v9, s[4:7], s27 offen offset:128 sc1 lds
  v_smfmac_f32_16x16x64_bf16 v[16:19], v[120:123], v[136:143], v0
  ds_read_b128 v[124:127], v1 offset:3072
  s_mov_b32 m0, s33
  v_smfmac_f32_16x16x64_bf16 v[20:23], v[120:123], v[152:159], v0
  s_waitcnt lgkmcnt(4)
  ds_read_b128 v[104:107], v2 offset:5120
  v_smfmac_f32_16x16x64_bf16 v[24:27], v[120:123], v[76:83], v0
  s_waitcnt lgkmcnt(4)
  ds_read_b128 v[108:111], v1 offset:5120
  v_smfmac_f32_16x16x64_bf16 v[16:19], v[92:95], v[160:167], v0
  s_waitcnt lgkmcnt(4)
  ds_read_b128 v[112:115], v2 offset:6144
  buffer_load_dwordx4 v10, s[4:7], s28 offen sc1 lds
  v_smfmac_f32_16x16x64_bf16 v[16:19], v[96:99], v[168:175], v0
  s_waitcnt lgkmcnt(4)
  ds_read_b128 v[84:87], v1 offset:6144
  s_mov_b32 m0, s34
  v_smfmac_f32_16x16x64_bf16 v[16:19], v[116:119], v[192:199], v0
  s_waitcnt lgkmcnt(4)
  ds_read_b128 v[88:91], v2 offset:7168
  v_smfmac_f32_16x16x64_bf16 v[16:19], v[124:127], v[200:207], v0
  s_waitcnt lgkmcnt(4)
  ds_read_b128 v[100:103], v1 offset:7168
  v_smfmac_f32_16x16x64_bf16 v[16:19], v[104:107], a[16:23], v0
  s_waitcnt lgkmcnt(4)
  ds_read_b128 v[68:71], v4 offset:16384
  buffer_load_dwordx4 v10, s[4:7], s28 offen offset:256 sc1 lds
  v_smfmac_f32_16x16x64_bf16 v[16:19], v[108:111], a[24:31], v0
  s_waitcnt lgkmcnt(4)
  ds_read_b128 v[72:75], v4 offset:17408
  v_smfmac_f32_16x16x64_bf16 v[16:19], v[112:115], a[64:71], v0
  s_waitcnt lgkmcnt(4)
  ds_read_b128 v[76:79], v4 offset:18432
  v_smfmac_f32_16x16x64_bf16 v[16:19], v[84:87], a[72:79], v0
  s_waitcnt lgkmcnt(4)
  ds_read_b128 v[80:83], v4 offset:19456
  v_smfmac_f32_16x16x64_bf16 v[16:19], v[88:91], a[112:119], v0
  s_waitcnt lgkmcnt(4)
  v_smfmac_f32_16x16x64_bf16 v[16:19], v[100:103], a[120:127], v0
  s_add_u32 s24, s36, 145752064
  s_add_u32 s25, s36, 145756160
  v_smfmac_f32_16x16x64_bf16 v[20:23], v[92:95], v[176:183], v0
  s_add_u32 s35, s36, s23
  v_smfmac_f32_16x16x64_bf16 v[20:23], v[96:99], v[184:191], v0
  s_waitcnt lgkmcnt(2)
  v_smfmac_f32_16x16x64_bf16 v[20:23], v[116:119], v[68:75], v0
  s_waitcnt lgkmcnt(0)
  ds_read_b128 v[68:71], v4 offset:20480
  v_mul_f32 v16, s18, v16
  v_smfmac_f32_16x16x64_bf16 v[20:23], v[124:127], v[76:83], v0
  ds_read_b128 v[72:75], v4 offset:21504
  v_mul_f32 v17, s18, v17
  v_smfmac_f32_16x16x64_bf16 v[20:23], v[104:107], a[32:39], v0
  ds_read_b128 v[76:79], v4 offset:22528
  v_mul_f32 v18, s18, v18
  v_smfmac_f32_16x16x64_bf16 v[20:23], v[108:111], a[40:47], v0
  ds_read_b128 v[80:83], v4 offset:23552
  v_mul_f32 v19, s18, v19
  v_smfmac_f32_16x16x64_bf16 v[20:23], v[112:115], a[80:87], v0
  v_cvt_pk_bf16_f32 v120, v16, v17
  v_smfmac_f32_16x16x64_bf16 v[20:23], v[84:87], a[88:95], v0
  v_cvt_pk_bf16_f32 v121, v18, v19
  v_smfmac_f32_16x16x64_bf16 v[20:23], v[88:91], a[128:135], v0
  ds_write_b64 v5, v[120:121] offset:24576
  v_smfmac_f32_16x16x64_bf16 v[20:23], v[100:103], a[136:143], v0
  s_waitcnt lgkmcnt(3)
  v_smfmac_f32_16x16x64_bf16 v[24:27], v[92:95], v[68:75], v0
  s_waitcnt lgkmcnt(1)
  v_mov_b64 v[92:93], 0
  v_smfmac_f32_16x16x64_bf16 v[24:27], v[96:99], v[76:83], v0
  s_nop 1
  v_cvt_pk_bf16_f32 v122, v20, v21
  v_cvt_pk_bf16_f32 v123, v22, v23
  v_smfmac_f32_16x16x64_bf16 v[24:27], v[116:119], v[208:215], v0
  ds_write_b64 v5, v[122:123] offset:26880
  v_mov_b64 v[94:95], 0
  v_smfmac_f32_16x16x64_bf16 v[24:27], v[124:127], v[216:223], v0
  s_waitcnt lgkmcnt(1)
  s_barrier
  ds_read_b64_tr_b16 v[68:69], v6 offset:24576
  v_smfmac_f32_16x16x64_bf16 v[24:27], v[104:107], a[48:55], v0
  s_add_u32 s27, s27, 8192
  ds_read_b64_tr_b16 v[70:71], v6 offset:24640
  ds_read_b64_tr_b16 v[72:73], v6 offset:24832
  v_smfmac_f32_16x16x64_bf16 v[24:27], v[108:111], a[56:63], v0
  s_add_u32 s28, s28, 8192
  ds_read_b64_tr_b16 v[74:75], v6 offset:24896
  ds_read_b64_tr_b16 v[76:77], v6 offset:25088
  v_smfmac_f32_16x16x64_bf16 v[24:27], v[112:115], a[96:103], v0
  s_nop 0
  ds_read_b64_tr_b16 v[78:79], v6 offset:25152
  ds_read_b64_tr_b16 v[80:81], v6 offset:25344
  v_smfmac_f32_16x16x64_bf16 v[24:27], v[84:87], a[104:111], v0
  ds_read_b64_tr_b16 v[82:83], v6 offset:25408
  v_mov_b64 v[96:97], 0
  v_smfmac_f32_16x16x64_bf16 v[24:27], v[88:91], a[144:151], v0
  s_waitcnt lgkmcnt(8)
  s_barrier
  ds_read_b64_tr_b16 v[116:117], v6 offset:26880
  v_smfmac_f32_16x16x64_bf16 v[24:27], v[100:103], a[152:159], v0
  s_waitcnt lgkmcnt(7)
  ds_read_b64_tr_b16 v[118:119], v6 offset:26944
  buffer_store_dwordx2 v[122:123], v5, s[4:7], s29 offen sc1
  v_mfma_f32_16x16x32_bf16 v[16:19], v[36:39], v[68:71], 0
  s_waitcnt lgkmcnt(6)
  ds_read_b64_tr_b16 v[124:125], v6 offset:27136
  ds_read_b64_tr_b16 v[126:127], v6 offset:27200
  v_mfma_f32_16x16x32_bf16 v[16:19], v[40:43], v[72:75], v[16:19]
  s_waitcnt lgkmcnt(6)
  ds_read_b64_tr_b16 v[104:105], v6 offset:27392
  ds_read_b64_tr_b16 v[106:107], v6 offset:27456
  v_mfma_f32_16x16x32_bf16 v[16:19], v[44:47], v[76:79], v[16:19]
  s_waitcnt lgkmcnt(6)
  ds_read_b64_tr_b16 v[108:109], v6 offset:27648
  ds_read_b64_tr_b16 v[110:111], v6 offset:27712
  v_mfma_f32_16x16x32_bf16 v[16:19], v[48:51], v[80:83], v[16:19]
  s_waitcnt lgkmcnt(6)
  v_cvt_pk_bf16_f32 v120, v24, v25
  v_cvt_pk_bf16_f32 v121, v26, v27
  v_mfma_f32_16x16x32_bf16 v[112:115], v[116:119], v[68:71], 0
  s_waitcnt lgkmcnt(4)
  buffer_store_dwordx2 v[120:121], v5, s[4:7], s29 offen offset:2304 sc1
  v_mov_b64 v[98:99], 0
  v_mfma_f32_16x16x32_bf16 v[112:115], v[124:127], v[72:75], v[112:115]
  s_waitcnt lgkmcnt(2)
  v_mov_b64 v[36:37], 0
  v_exp_f32 v100, v16
  v_mfma_f32_16x16x32_bf16 v[112:115], v[104:107], v[76:79], v[112:115]
  s_waitcnt lgkmcnt(0)
  v_exp_f32 v101, v17
  v_mfma_f32_16x16x32_bf16 v[112:115], v[108:111], v[80:83], v[112:115]
  s_add_u32 s29, s29, 147456
  v_exp_f32 v102, v18
  v_mfma_f32_16x16x32_bf16 v[20:23], v[52:55], v[68:71], 0
  s_cmp_eq_u32 s14, 63
  v_exp_f32 v103, v19
  v_mfma_f32_16x16x32_bf16 v[20:23], v[56:59], v[72:75], v[20:23]
  s_cbranch_scc1 M_tdone
  v_cvt_pk_bf16_f32 v44, v100, v101
  v_cvt_pk_bf16_f32 v45, v102, v103
  v_mfma_f32_16x16x32_bf16 v[20:23], v[60:63], v[76:79], v[20:23]
  v_exp_f32 v100, v112
  v_mfma_f32_16x16x32_bf16 v[20:23], v[64:67], v[80:83], v[20:23]
  v_exp_f32 v101, v113
  v_exp_f32 v102, v114
  v_exp_f32 v103, v115
  v_cvt_pk_bf16_f32 v84, v100, v101
  v_cvt_pk_bf16_f32 v85, v102, v103
  v_cndmask_b32 v48, v84, 0, s[16:17]
  v_cndmask_b32 v49, v85, 0, s[16:17]
  v_cndmask_b32 v50, 0, v84, s[16:17]
  v_cndmask_b32 v51, 0, v85, s[16:17]
  v_exp_f32 v100, v20
  v_mfma_f32_16x16x16_bf16 v[88:91], v[12:13], v[48:49], 0
  v_exp_f32 v101, v21
  v_mfma_f32_16x16x16_bf16 v[24:27], v[120:121], v[48:49], 0
  v_exp_f32 v102, v22
  v_mfma_f32_16x16x16_bf16 v[116:119], v[120:121], v[50:51], 0
  v_exp_f32 v103, v23
  v_cvt_pk_bf16_f32 v46, v100, v101
  v_cvt_pk_bf16_f32 v47, v102, v103
  v_mov_b64 v[38:39], 0
  s_nop 0
  v_mfma_f32_16x16x32_bf16 v[88:91], v[12:15], v[44:47], v[88:91]
  v_mov_b64 v[40:41], 0
  v_mov_b64 v[42:43], 0
  v_mfma_f32_16x16x32_bf16 v[24:27], v[28:31], v[44:47], v[24:27]
  ds_read_b128 v[52:55], v4 offset:24576
  ds_read_b128 v[56:59], v4 offset:25600
  v_mfma_f32_16x16x32_bf16 v[116:119], v[32:35], v[44:47], v[116:119]
  s_nop 1
  v_rcp_f32 v89, v88
  v_subrev_u32 v100, s54, v88
  v_cmp_le_u32 vcc, s55, v100
  v_mul_f32 v24, v89, v24
  v_mul_f32 v25, v89, v25
  s_cbranch_vccnz T_slow_143
T_back_144:
  v_cvt_pk_bf16_f32 v124, v24, v25
  v_pk_mul_f32 v[26:27], v[26:27], v[88:89] op_sel:[0,1] op_sel_hi:[1,1]
  v_pk_mul_f32 v[116:117], v[116:117], v[88:89] op_sel:[0,1] op_sel_hi:[1,1]
  v_pk_mul_f32 v[118:119], v[118:119], v[88:89] op_sel:[0,1] op_sel_hi:[1,1]
  v_cvt_pk_bf16_f32 v125, v26, v27
  v_cvt_pk_bf16_f32 v126, v116, v117
  v_cvt_pk_bf16_f32 v127, v118, v119
  ds_write_b128 v11, v[124:127] offset:29184
  s_nop 0
  v_smfmac_f32_16x16x64_bf16 v[92:95], v[124:127], a[160:167], v0
  v_smfmac_f32_16x16x64_bf16 v[96:99], v[124:127], a[168:175], v0
  v_smfmac_f32_16x16x64_bf16 v[36:39], v[124:127], a[176:183], v0
  v_smfmac_f32_16x16x64_bf16 v[40:43], v[124:127], a[184:191], v0
  s_waitcnt lgkmcnt(0)
  s_barrier
  ds_read_b128 v[104:107], v11 offset:29696
  ds_read_b128 v[108:111], v11 offset:30208
  ds_read_b128 v[68:71], v11 offset:30720
  s_waitcnt lgkmcnt(2)
  v_smfmac_f32_16x16x64_bf16 v[92:95], v[104:107], a[192:199], v0
  s_waitcnt lgkmcnt(1)
  ds_read_b128 v[76:79], v4 offset:28672
  v_smfmac_f32_16x16x64_bf16 v[92:95], v[108:111], a[224:231], v0
  s_waitcnt lgkmcnt(1)
  ds_read_b128 v[80:83], v4 offset:29696
  v_smfmac_f32_16x16x64_bf16 v[92:95], v[68:71], a[240:247], v0
  ds_read_b128 v[60:63], v4 offset:26624
  v_smfmac_f32_16x16x64_bf16 v[96:99], v[104:107], a[200:207], v0
  ds_read_b128 v[64:67], v4 offset:27648
  v_smfmac_f32_16x16x64_bf16 v[96:99], v[108:111], a[232:239], v0
  ds_read_b128 v[28:31], v4 offset:30720
  s_nop 0
  v_cvt_pk_bf16_f32 v16, v92, v93
  v_cvt_pk_bf16_f32 v17, v94, v95
  v_bfi_b32 v16, 1, s57, v16
  v_smfmac_f32_16x16x64_bf16 v[96:99], v[68:71], a[248:255], v0
  buffer_store_dwordx2 v[16:17], v7, s[4:7], s20 offen offset:0 sc1
  v_smfmac_f32_16x16x64_bf16 v[36:39], v[104:107], a[208:215], v0
  ds_read_b128 v[32:35], v4 offset:31744
  v_smfmac_f32_16x16x64_bf16 v[36:39], v[108:111], v[52:59], v0
  s_waitcnt lgkmcnt(4)
  s_nop 0
  v_cvt_pk_bf16_f32 v18, v96, v97
  v_cvt_pk_bf16_f32 v19, v98, v99
  v_bfi_b32 v18, 1, s57, v18
  v_smfmac_f32_16x16x64_bf16 v[36:39], v[68:71], v[76:83], v0
  buffer_store_dwordx2 v[18:19], v7, s[4:7], s20 offen offset:64 sc1
  v_smfmac_f32_16x16x64_bf16 v[40:43], v[104:107], a[216:223], v0
  s_waitcnt lgkmcnt(2)
  ds_read_b128 v[116:119], v2 offset:31232
  v_smfmac_f32_16x16x64_bf16 v[40:43], v[108:111], v[60:67], v0
  s_waitcnt lgkmcnt(1)
  s_nop 0
  v_cvt_pk_bf16_f32 v20, v36, v37
  v_cvt_pk_bf16_f32 v21, v38, v39
  v_bfi_b32 v20, 1, s57, v20
  v_smfmac_f32_16x16x64_bf16 v[40:43], v[68:71], v[28:35], v0
  buffer_store_dwordx2 v[20:21], v7, s[4:7], s21 offen offset:0 sc1
  s_nop 6
  v_cvt_pk_bf16_f32 v22, v40, v41
  v_cvt_pk_bf16_f32 v23, v42, v43
  v_bfi_b32 v22, 1, s57, v22
  buffer_store_dwordx2 v[22:23], v7, s[4:7], s21 offen offset:64 sc1
  ds_read_b128 v[68:71], v4 offset:0
  ds_read_b128 v[72:75], v4 offset:1024
  ds_read_b128 v[76:79], v4 offset:4096
  ds_read_b128 v[80:83], v4 offset:5120
  ds_read_b128 v[84:87], v4 offset:8192
  ds_read_b128 v[88:91], v4 offset:9216
  v_mov_b64 v[16:17], 0
  v_mov_b64 v[18:19], 0
  v_mov_b64 v[20:21], 0
  v_mov_b64 v[22:23], 0
  v_mov_b64 v[24:25], 0
  v_mov_b64 v[26:27], 0
  s_mov_b32 s19, 0
  v_mov_b32 v49, -1
  s_waitcnt vmcnt(2)
  buffer_load_dwordx4 v[52:55], v2, s[4:7], s22 offen offset:0 sc1
  buffer_load_dwordx4 v[56:59], v2, s[4:7], s22 offen offset:1024 sc1
  buffer_load_dwordx4 v[60:63], v2, s[4:7], s22 offen offset:2048 sc1
  buffer_load_dwordx4 v[64:67], v2, s[4:7], s22 offen offset:3072 sc1
  ds_read_b128 v[92:95], v4 offset:2048
  ds_read_b128 v[96:99], v4 offset:3072
  ds_read_b128 v[100:103], v4 offset:6144
  ds_read_b128 v[104:107], v4 offset:7168
  ds_read_b128 v[108:111], v4 offset:10240
  ds_read_b128 v[112:115], v4 offset:11264
  ds_read_b64 v[44:45], v2 offset:32256
  s_waitcnt lgkmcnt(0)
  v_readfirstlane_b32 s38, v44
  v_readfirstlane_b32 s37, v45
  s_nop 0
  s_add_u32 s37, s37, 30
  s_cmp_ge_u32 s38, 30
  s_cselect_b32 s38, s37, s38
  s_cmp_ge_u32 s38, 64
  s_cselect_b32 s38, 100, s38
  s_sub_u32 s38, s38, 1
  s_max_i32 s30, s30, s38
  s_waitcnt lgkmcnt(12)
  s_waitcnt vmcnt(3)
  v_mfma_f32_16x16x32_bf16 v[120:123], v[116:119], v[52:55], 0
  v_xor_b32 v48, s57, v52
  v_bitop3_b32 v48, v48, v54, s57 bitop3:0xf6
  s_waitcnt vmcnt(2)
  v_mfma_f32_16x16x32_bf16 v[120:123], v[116:119], v[56:59], v[120:123]
  v_bitop3_b32 v48, v48, v56, s57 bitop3:0xf6
  v_bitop3_b32 v48, v48, v58, s57 bitop3:0xf6
  s_waitcnt vmcnt(1)
  v_mfma_f32_16x16x32_bf16 v[120:123], v[116:119], v[60:63], v[120:123]
  v_bitop3_b32 v48, v48, v60, s57 bitop3:0xf6
  v_bitop3_b32 v48, v48, v62, s57 bitop3:0xf6
  s_waitcnt vmcnt(0)
  v_mfma_f32_16x16x32_bf16 v[120:123], v[116:119], v[64:67], v[120:123]
  v_bitop3_b32 v48, v48, v64, s57 bitop3:0xf6
  v_bitop3_b32 v48, v48, v66, s57 bitop3:0xf6
  v_and_b32 v48, 1, v48
  v_cmp_ne_u32 vcc, 0, v48
  s_cbranch_vccnz T_p1re_146
T_p1ok_147:
  s_nop 2
  v_add_f32_dpp v120, v120, v120 row_ror:8 row_mask:0xf bank_mask:0xf
  v_add_f32_dpp v121, v121, v121 row_ror:8 row_mask:0xf bank_mask:0xf
  v_cvt_pk_bf16_f32 v48, v120, v121
  v_min_u32 v48, -2, v48
  buffer_store_dword v48, v8, s[4:7], s35 offen sc1
  buffer_store_dword v49, v8, s[4:7], s26 offen sc1
  s_barrier
  ds_read_b128 v[28:31], v2 offset:16384
  ds_read_b128 v[32:35], v2 offset:20480
  ds_read_b128 v[36:39], v2 offset:8192
  ds_read_b128 v[40:43], v2 offset:9216
  ds_read_b128 v[44:47], v2 offset:10240
  ds_read_b128 v[48:51], v2 offset:11264
  buffer_load_dwordx4 v[124:127], v3, s[4:7], s24 offen offset:0 sc1
  buffer_load_dwordx4 v[116:119], v3, s[4:7], s25 offen offset:0 sc1
  ds_read_b128 v[52:55], v2 offset:12288
  ds_read_b128 v[56:59], v2 offset:13312
  ds_read_b128 v[60:63], v2 offset:14336
  ds_read_b128 v[64:67], v2 offset:15360
  buffer_load_dwordx4 v[124:127], v3, s[4:7], s24 offen offset:0 sc1
  buffer_load_dwordx4 v[116:119], v3, s[4:7], s25 offen offset:0 sc1
  s_mov_b32 s19, 0
  s_branch T_loop_137
T_p1re_146:
  s_mov_b64 exec, vcc
  buffer_load_dwordx4 v[52:55], v2, s[4:7], s22 offen offset:0 sc1
  buffer_load_dwordx4 v[56:59], v2, s[4:7], s22 offen offset:1024 sc1
  buffer_load_dwordx4 v[60:63], v2, s[4:7], s22 offen offset:2048 sc1
  buffer_load_dwordx4 v[64:67], v2, s[4:7], s22 offen offset:3072 sc1
  s_mov_b64 exec, -1
  s_add_u32 s19, s19, 1
  s_cmp_gt_u32 s19, 32768
  s_cbranch_scc1 M_exit
  s_waitcnt vmcnt(3)
  v_mfma_f32_16x16x32_bf16 v[120:123], v[116:119], v[52:55], 0
  v_xor_b32 v48, s57, v52
  v_bitop3_b32 v48, v48, v54, s57 bitop3:0xf6
  s_waitcnt vmcnt(2)
  v_mfma_f32_16x16x32_bf16 v[120:123], v[116:119], v[56:59], v[120:123]
  v_bitop3_b32 v48, v48, v56, s57 bitop3:0xf6
  v_bitop3_b32 v48, v48, v58, s57 bitop3:0xf6
  s_waitcnt vmcnt(1)
  v_mfma_f32_16x16x32_bf16 v[120:123], v[116:119], v[60:63], v[120:123]
  v_bitop3_b32 v48, v48, v60, s57 bitop3:0xf6
  v_bitop3_b32 v48, v48, v62, s57 bitop3:0xf6
  s_waitcnt vmcnt(0)
  v_mfma_f32_16x16x32_bf16 v[120:123], v[116:119], v[64:67], v[120:123]
  v_bitop3_b32 v48, v48, v64, s57 bitop3:0xf6
  v_bitop3_b32 v48, v48, v66, s57 bitop3:0xf6
  v_and_b32 v48, 1, v48
  v_cmp_ne_u32 vcc, 0, v48
  s_cbranch_vccnz T_p1re_146
  s_branch T_p1ok_147
T_kvw_141:
  s_mov_b32 s19, 0
  s_branch T_kvok_149
T_kv_148:
  s_sleep 4
  s_add_u32 s19, s19, 1
  s_cmp_gt_u32 s19, 32768
  s_cbranch_scc1 M_exit
T_kvok_149:
  s_add_u32 s39, s99, 128
  s_mov_b32 s38, 0
  s_mov_b32 s37, 0
  s_atomic_or s38, s[58:59], s99 glc
  s_atomic_or s37, s[58:59], s39 glc
  s_waitcnt lgkmcnt(0)
  s_add_u32 s37, s37, 30
  s_cmp_ge_u32 s38, 30
  s_cselect_b32 s38, s37, s38
  s_cmp_ge_u32 s38, 64
  s_cselect_b32 s38, 100, s38
  s_sub_u32 s38, s38, 1
  s_max_i32 s30, s30, s38
  s_cmp_ge_i32 s14, s30
  s_cbranch_scc1 T_kv_148
  s_branch T_kvb_142
T_slow_143:
  s_nop 7
  v_max3_f32 v100, v16, v17, v18
  v_max3_f32 v100, v100, v19, v20
  v_max3_f32 v100, v100, v21, v22
  v_max3_f32 v100, v100, v23, v112
  v_max3_f32 v100, v100, v113, v114
  v_max_f32 v100, v100, v115
  v_mov_b32 v101, v100
  s_nop 1
  v_permlane32_swap_b32 v100, v101
  s_nop 1
  v_max_f32 v100, v100, v101
  v_mov_b32 v101, v100
  s_nop 1
  v_permlane16_swap_b32 v100, v101
  s_nop 1
  v_max_f32 v100, v100, v101
  v_sub_f32 v16, v16, v100
  v_sub_f32 v17, v17, v100
  v_sub_f32 v18, v18, v100
  v_sub_f32 v19, v19, v100
  v_exp_f32 v16, v16
  v_exp_f32 v17, v17
  v_exp_f32 v18, v18
  v_exp_f32 v19, v19
  v_sub_f32 v20, v20, v100
  v_sub_f32 v21, v21, v100
  v_sub_f32 v22, v22, v100
  v_sub_f32 v23, v23, v100
  v_exp_f32 v20, v20
  v_exp_f32 v21, v21
  v_exp_f32 v22, v22
  v_exp_f32 v23, v23
  v_sub_f32 v112, v112, v100
  v_sub_f32 v113, v113, v100
  v_sub_f32 v114, v114, v100
  v_sub_f32 v115, v115, v100
  v_exp_f32 v112, v112
  v_exp_f32 v113, v113
  v_exp_f32 v114, v114
  v_exp_f32 v115, v115
  s_nop 0
  v_cvt_pk_bf16_f32 v44, v16, v17
  v_cvt_pk_bf16_f32 v45, v18, v19
  v_cvt_pk_bf16_f32 v46, v20, v21
  v_cvt_pk_bf16_f32 v47, v22, v23
  v_cvt_pk_bf16_f32 v84, v112, v113
  v_cvt_pk_bf16_f32 v85, v114, v115
  v_cndmask_b32 v48, v84, 0, s[16:17]
  v_cndmask_b32 v49, v85, 0, s[16:17]
  v_cndmask_b32 v50, 0, v84, s[16:17]
  v_cndmask_b32 v51, 0, v85, s[16:17]
  s_nop 1
  v_mfma_f32_16x16x16_bf16 v[88:91], v[12:13], v[48:49], 0
  v_mfma_f32_16x16x16_bf16 v[24:27], v[120:121], v[48:49], 0
  v_mfma_f32_16x16x16_bf16 v[116:119], v[120:121], v[50:51], 0
  v_mfma_f32_16x16x32_bf16 v[88:91], v[12:15], v[44:47], v[88:91]
  v_mfma_f32_16x16x32_bf16 v[24:27], v[28:31], v[44:47], v[24:27]
  v_mfma_f32_16x16x32_bf16 v[116:119], v[32:35], v[44:47], v[116:119]
  s_nop 7
  s_nop 1
  v_rcp_f32 v89, v88
  s_nop 0
  v_mul_f32 v24, v89, v24
  v_mul_f32 v25, v89, v25
  s_branch T_back_144
T_w_134:
  s_mov_b32 s19, 0
  v_mov_b64 v[16:17], 0
  v_mov_b64 v[18:19], 0
  v_mov_b64 v[20:21], 0
  v_mov_b64 v[22:23], 0
  v_mov_b64 v[24:25], 0
  v_mov_b64 v[26:27], 0
  buffer_load_dwordx4 v[124:127], v3, s[4:7], s24 offen offset:1024 sc1
  buffer_load_dwordx4 v[116:119], v3, s[4:7], s25 offen offset:1024 sc1
  buffer_load_dwordx4 v[124:127], v3, s[4:7], s24 offen offset:1024 sc1
  buffer_load_dwordx4 v[116:119], v3, s[4:7], s25 offen offset:1024 sc1
  s_branch T_loop_150
.p2align 6
T_retry_151:
  s_mov_b64 exec, vcc
  buffer_load_dwordx4 v[124:127], v3, s[4:7], s24 offen offset:1024 sc1
  buffer_load_dwordx4 v[116:119], v3, s[4:7], s25 offen offset:1024 sc1
  s_mov_b64 exec, -1
  s_add_u32 s19, s19, 1
  s_cmp_gt_u32 s19, 32768
  s_cbranch_scc1 M_exit
T_loop_150:
  s_waitcnt vmcnt(3) lgkmcnt(0)
  v_max3_u32 v123, v124, v125, v126
  v_max_u32 v123, v123, v127
  v_mov_b32_dpp v120, v124 row_ror:8 row_mask:0xf bank_mask:0xf
  v_mov_b32_dpp v121, v125 row_ror:8 row_mask:0xf bank_mask:0xf
  s_waitcnt vmcnt(2)
  v_max3_u32 v123, v123, v116, v117
  v_max3_u32 v123, v123, v118, v119
  v_cmp_eq_u32 vcc, -1, v123
  s_cbranch_vccnz T_retry_151
  v_smfmac_f32_16x16x64_bf16 v[16:19], v[124:127], v[68:75], v0
  s_add_u32 s14, s14, 1
  ds_write_b128 v2, v[124:127] offset:1024
  v_mov_b32_dpp v122, v126 row_ror:8 row_mask:0xf bank_mask:0xf
  v_smfmac_f32_16x16x64_bf16 v[20:23], v[124:127], v[76:83], v0
  s_and_b32 s57, s14, 1
  v_mov_b32_dpp v123, v127 row_ror:8 row_mask:0xf bank_mask:0xf
  v_smfmac_f32_16x16x64_bf16 v[24:27], v[124:127], v[84:91], v0
  s_and_b32 s36, s14, 3
  ds_write_b128 v2, v[116:119] offset:5120
  v_smfmac_f32_16x16x64_bf16 v[16:19], v[120:123], v[92:99], v0
  s_lshl_b32 s36, s36, 13
  v_mov_b32_dpp v84, v116 row_ror:8 row_mask:0xf bank_mask:0xf
  v_smfmac_f32_16x16x64_bf16 v[20:23], v[120:123], v[100:107], v0
  s_add_u32 s26, s36, s23
  ds_read_b128 v[68:71], v4 offset:12288
  v_mov_b32_dpp v85, v117 row_ror:8 row_mask:0xf bank_mask:0xf
  v_smfmac_f32_16x16x64_bf16 v[24:27], v[120:123], v[108:115], v0
  s_add_u32 s36, s36, 8192
  ds_read_b128 v[72:75], v4 offset:13312
  v_mov_b32_dpp v86, v118 row_ror:8 row_mask:0xf bank_mask:0xf
  v_smfmac_f32_16x16x64_bf16 v[16:19], v[116:119], v[224:231], v0
  s_and_b32 s36, s36, 0x7fff
  ds_read_b128 v[76:79], v4 offset:14336
  v_mov_b32_dpp v87, v119 row_ror:8 row_mask:0xf bank_mask:0xf
  v_smfmac_f32_16x16x64_bf16 v[20:23], v[116:119], v[240:247], v0
  s_waitcnt lgkmcnt(3)
  s_barrier
  ds_read_b128 v[100:103], v2 offset:0
  v_smfmac_f32_16x16x64_bf16 v[24:27], v[116:119], a[0:7], v0
  s_mov_b32 m0, s31
  ds_read_b128 v[120:123], v1 offset:0
  v_smfmac_f32_16x16x64_bf16 v[16:19], v[84:87], v[232:239], v0
  s_cmp_ge_i32 s14, s30
  s_cbranch_scc1 T_kvw_154
T_kvb_155:
  v_smfmac_f32_16x16x64_bf16 v[20:23], v[84:87], v[248:255], v0
  ds_read_b128 v[80:83], v4 offset:15360
  v_smfmac_f32_16x16x64_bf16 v[24:27], v[84:87], a[8:15], v0
  s_waitcnt lgkmcnt(2)
  buffer_load_dwordx4 v9, s[4:7], s27 offen sc1 lds
  v_smfmac_f32_16x16x64_bf16 v[16:19], v[100:103], v[128:135], v0
  ds_read_b128 v[92:95], v2 offset:3072
  s_mov_b32 m0, s32
  v_smfmac_f32_16x16x64_bf16 v[20:23], v[100:103], v[144:151], v0
  ds_read_b128 v[96:99], v1 offset:3072
  v_smfmac_f32_16x16x64_bf16 v[24:27], v[100:103], v[68:75], v0
  s_waitcnt vmcnt(1) lgkmcnt(3)
  ds_read_b128 v[116:119], v2 offset:2048
  v_smfmac_f32_16x16x64_bf16 v[16:19], v[120:123], v[136:143], v0
  ds_read_b128 v[124:127], v1 offset:2048
  buffer_load_dwordx4 v9, s[4:7], s27 offen offset:128 sc1 lds
  v_smfmac_f32_16x16x64_bf16 v[20:23], v[120:123], v[152:159], v0
  s_waitcnt lgkmcnt(4)
  ds_read_b128 v[104:107], v2 offset:4096
  s_mov_b32 m0, s33
  v_smfmac_f32_16x16x64_bf16 v[24:27], v[120:123], v[76:83], v0
  s_waitcnt lgkmcnt(4)
  ds_read_b128 v[108:111], v1 offset:4096
  v_smfmac_f32_16x16x64_bf16 v[16:19], v[92:95], v[160:167], v0
  s_waitcnt lgkmcnt(4)
  ds_read_b128 v[112:115], v2 offset:7168
  v_smfmac_f32_16x16x64_bf16 v[16:19], v[96:99], v[168:175], v0
  s_waitcnt lgkmcnt(4)
  ds_read_b128 v[84:87], v1 offset:7168
  buffer_load_dwordx4 v10, s[4:7], s28 offen sc1 lds
  v_smfmac_f32_16x16x64_bf16 v[16:19], v[116:119], v[192:199], v0
  s_waitcnt lgkmcnt(4)
  ds_read_b128 v[88:91], v2 offset:6144
  s_mov_b32 m0, s34
  v_smfmac_f32_16x16x64_bf16 v[16:19], v[124:127], v[200:207], v0
  s_waitcnt lgkmcnt(4)
  ds_read_b128 v[100:103], v1 offset:6144
  v_smfmac_f32_16x16x64_bf16 v[16:19], v[104:107], a[16:23], v0
  s_waitcnt lgkmcnt(4)
  ds_read_b128 v[68:71], v4 offset:16384
  v_smfmac_f32_16x16x64_bf16 v[16:19], v[108:111], a[24:31], v0
  s_waitcnt lgkmcnt(4)
  ds_read_b128 v[72:75], v4 offset:17408
  buffer_load_dwordx4 v10, s[4:7], s28 offen offset:256 sc1 lds
  v_smfmac_f32_16x16x64_bf16 v[16:19], v[112:115], a[64:71], v0
  s_waitcnt lgkmcnt(4)
  ds_read_b128 v[76:79], v4 offset:18432
  v_smfmac_f32_16x16x64_bf16 v[16:19], v[84:87], a[72:79], v0
  s_waitcnt lgkmcnt(4)
  ds_read_b128 v[80:83], v4 offset:19456
  v_smfmac_f32_16x16x64_bf16 v[16:19], v[88:91], a[112:119], v0
  s_waitcnt lgkmcnt(4)
  v_smfmac_f32_16x16x64_bf16 v[16:19], v[100:103], a[120:127], v0
  s_add_u32 s24, s36, 145752064
  s_add_u32 s25, s36, 145756160
  v_smfmac_f32_16x16x64_bf16 v[20:23], v[92:95], v[176:183], v0
  s_add_u32 s35, s36, s23
  v_smfmac_f32_16x16x64_bf16 v[20:23], v[96:99], v[184:191], v0
  s_waitcnt lgkmcnt(2)
  v_smfmac_f32_16x16x64_bf16 v[20:23], v[116:119], v[68:75], v0
  s_waitcnt lgkmcnt(0)
  ds_read_b128 v[68:71], v4 offset:20480
  v_mul_f32 v16, s18, v16
  v_smfmac_f32_16x16x64_bf16 v[20:23], v[124:127], v[76:83], v0
  ds_read_b128 v[72:75], v4 offset:21504
  v_mul_f32 v17, s18, v17
  v_smfmac_f32_16x16x64_bf16 v[20:23], v[104:107], a[32:39], v0
  ds_read_b128 v[76:79], v4 offset:22528
  v_mul_f32 v18, s18, v18
  v_smfmac_f32_16x16x64_bf16 v[20:23], v[108:111], a[40:47], v0
  ds_read_b128 v[80:83], v4 offset:23552
  v_mul_f32 v19, s18, v19
  v_smfmac_f32_16x16x64_bf16 v[20:23], v[112:115], a[80:87], v0
  v_cvt_pk_bf16_f32 v120, v16, v17
  v_smfmac_f32_16x16x64_bf16 v[20:23], v[84:87], a[88:95], v0
  v_cvt_pk_bf16_f32 v121, v18, v19
  v_smfmac_f32_16x16x64_bf16 v[20:23], v[88:91], a[128:135], v0
  ds_write_b64 v5, v[120:121] offset:24576
  v_smfmac_f32_16x16x64_bf16 v[20:23], v[100:103], a[136:143], v0
  s_waitcnt lgkmcnt(3)
  v_smfmac_f32_16x16x64_bf16 v[24:27], v[92:95], v[68:75], v0
  s_waitcnt lgkmcnt(1)
  v_mov_b64 v[92:93], 0
  v_smfmac_f32_16x16x64_bf16 v[24:27], v[96:99], v[76:83], v0
  s_nop 1
  v_cvt_pk_bf16_f32 v122, v20, v21
  v_cvt_pk_bf16_f32 v123, v22, v23
  v_smfmac_f32_16x16x64_bf16 v[24:27], v[116:119], v[208:215], v0
  ds_write_b64 v5, v[122:123] offset:26880
  v_mov_b64 v[94:95], 0
  v_smfmac_f32_16x16x64_bf16 v[24:27], v[124:127], v[216:223], v0
  s_waitcnt lgkmcnt(1)
  s_barrier
  ds_read_b64_tr_b16 v[68:69], v6 offset:24576
  v_smfmac_f32_16x16x64_bf16 v[24:27], v[104:107], a[48:55], v0
  s_add_u32 s27, s27, 8192
  ds_read_b64_tr_b16 v[70:71], v6 offset:24640
  ds_read_b64_tr_b16 v[72:73], v6 offset:24832
  v_smfmac_f32_16x16x64_bf16 v[24:27], v[108:111], a[56:63], v0
  s_add_u32 s28, s28, 8192
  ds_read_b64_tr_b16 v[74:75], v6 offset:24896
  ds_read_b64_tr_b16 v[76:77], v6 offset:25088
  v_smfmac_f32_16x16x64_bf16 v[24:27], v[112:115], a[96:103], v0
  s_nop 0
  ds_read_b64_tr_b16 v[78:79], v6 offset:25152
  ds_read_b64_tr_b16 v[80:81], v6 offset:25344
  v_smfmac_f32_16x16x64_bf16 v[24:27], v[84:87], a[104:111], v0
  ds_read_b64_tr_b16 v[82:83], v6 offset:25408
  v_mov_b64 v[96:97], 0
  v_smfmac_f32_16x16x64_bf16 v[24:27], v[88:91], a[144:151], v0
  s_waitcnt lgkmcnt(8)
  s_barrier
  ds_read_b64_tr_b16 v[116:117], v6 offset:26880
  v_smfmac_f32_16x16x64_bf16 v[24:27], v[100:103], a[152:159], v0
  s_waitcnt lgkmcnt(7)
  ds_read_b64_tr_b16 v[118:119], v6 offset:26944
  buffer_store_dwordx2 v[122:123], v5, s[4:7], s29 offen sc1
  v_mfma_f32_16x16x32_bf16 v[16:19], v[36:39], v[68:71], 0
  s_waitcnt lgkmcnt(6)
  ds_read_b64_tr_b16 v[124:125], v6 offset:27136
  ds_read_b64_tr_b16 v[126:127], v6 offset:27200
  v_mfma_f32_16x16x32_bf16 v[16:19], v[40:43], v[72:75], v[16:19]
  s_waitcnt lgkmcnt(6)
  ds_read_b64_tr_b16 v[104:105], v6 offset:27392
  ds_read_b64_tr_b16 v[106:107], v6 offset:27456
  v_mfma_f32_16x16x32_bf16 v[16:19], v[44:47], v[76:79], v[16:19]
  s_waitcnt lgkmcnt(6)
  ds_read_b64_tr_b16 v[108:109], v6 offset:27648
  ds_read_b64_tr_b16 v[110:111], v6 offset:27712
  v_mfma_f32_16x16x32_bf16 v[16:19], v[48:51], v[80:83], v[16:19]
  s_waitcnt lgkmcnt(6)
  v_cvt_pk_bf16_f32 v120, v24, v25
  v_cvt_pk_bf16_f32 v121, v26, v27
  v_mfma_f32_16x16x32_bf16 v[112:115], v[116:119], v[68:71], 0
  s_waitcnt lgkmcnt(4)
  buffer_store_dwordx2 v[120:121], v5, s[4:7], s29 offen offset:2304 sc1
  v_mov_b64 v[98:99], 0
  v_mfma_f32_16x16x32_bf16 v[112:115], v[124:127], v[72:75], v[112:115]
  s_waitcnt lgkmcnt(2)
  v_mov_b64 v[36:37], 0
  v_exp_f32 v100, v16
  v_mfma_f32_16x16x32_bf16 v[112:115], v[104:107], v[76:79], v[112:115]
  s_waitcnt lgkmcnt(0)
  v_exp_f32 v101, v17
  v_mfma_f32_16x16x32_bf16 v[112:115], v[108:111], v[80:83], v[112:115]
  s_add_u32 s29, s29, 147456
  v_exp_f32 v102, v18
  v_mfma_f32_16x16x32_bf16 v[20:23], v[52:55], v[68:71], 0
  s_cmp_eq_u32 s14, 63
  v_exp_f32 v103, v19
  v_mfma_f32_16x16x32_bf16 v[20:23], v[56:59], v[72:75], v[20:23]
  s_cbranch_scc1 M_tdone
  v_cvt_pk_bf16_f32 v44, v100, v101
  v_cvt_pk_bf16_f32 v45, v102, v103
  v_mfma_f32_16x16x32_bf16 v[20:23], v[60:63], v[76:79], v[20:23]
  v_exp_f32 v100, v112
  v_mfma_f32_16x16x32_bf16 v[20:23], v[64:67], v[80:83], v[20:23]
  v_exp_f32 v101, v113
  v_exp_f32 v102, v114
  v_exp_f32 v103, v115
  v_cvt_pk_bf16_f32 v84, v100, v101
  v_cvt_pk_bf16_f32 v85, v102, v103
  v_cndmask_b32 v48, v84, 0, s[16:17]
  v_cndmask_b32 v49, v85, 0, s[16:17]
  v_cndmask_b32 v50, 0, v84, s[16:17]
  v_cndmask_b32 v51, 0, v85, s[16:17]
  v_exp_f32 v100, v20
  v_mfma_f32_16x16x16_bf16 v[88:91], v[12:13], v[48:49], 0
  v_exp_f32 v101, v21
  v_mfma_f32_16x16x16_bf16 v[24:27], v[120:121], v[48:49], 0
  v_exp_f32 v102, v22
  v_mfma_f32_16x16x16_bf16 v[116:119], v[120:121], v[50:51], 0
  v_exp_f32 v103, v23
  v_cvt_pk_bf16_f32 v46, v100, v101
  v_cvt_pk_bf16_f32 v47, v102, v103
  v_mov_b64 v[38:39], 0
  s_nop 0
  v_mfma_f32_16x16x32_bf16 v[88:91], v[12:15], v[44:47], v[88:91]
  v_mov_b64 v[40:41], 0
  v_mov_b64 v[42:43], 0
  v_mfma_f32_16x16x32_bf16 v[24:27], v[28:31], v[44:47], v[24:27]
  ds_read_b128 v[52:55], v4 offset:24576
  ds_read_b128 v[56:59], v4 offset:25600
  v_mfma_f32_16x16x32_bf16 v[116:119], v[32:35], v[44:47], v[116:119]
  s_nop 1
  v_rcp_f32 v89, v88
  v_subrev_u32 v100, s54, v88
  v_cmp_le_u32 vcc, s55, v100
  v_mul_f32 v24, v89, v24
  v_mul_f32 v25, v89, v25
  s_cbranch_vccnz T_slow_156
T_back_157:
  v_cvt_pk_bf16_f32 v124, v24, v25
  v_pk_mul_f32 v[26:27], v[26:27], v[88:89] op_sel:[0,1] op_sel_hi:[1,1]
  v_pk_mul_f32 v[116:117], v[116:117], v[88:89] op_sel:[0,1] op_sel_hi:[1,1]
  v_pk_mul_f32 v[118:119], v[118:119], v[88:89] op_sel:[0,1] op_sel_hi:[1,1]
  v_cvt_pk_bf16_f32 v125, v26, v27
  v_cvt_pk_bf16_f32 v126, v116, v117
  v_cvt_pk_bf16_f32 v127, v118, v119
  ds_write_b128 v11, v[124:127] offset:29696
  s_nop 0
  v_smfmac_f32_16x16x64_bf16 v[92:95], v[124:127], a[160:167], v0
  v_smfmac_f32_16x16x64_bf16 v[96:99], v[124:127], a[168:175], v0
  v_smfmac_f32_16x16x64_bf16 v[36:39], v[124:127], a[176:183], v0
  v_smfmac_f32_16x16x64_bf16 v[40:43], v[124:127], a[184:191], v0
  s_waitcnt lgkmcnt(0)
  s_barrier
  ds_read_b128 v[104:107], v11 offset:29184
  ds_read_b128 v[108:111], v11 offset:30720
  ds_read_b128 v[68:71], v11 offset:30208
  s_waitcnt lgkmcnt(2)
  v_smfmac_f32_16x16x64_bf16 v[92:95], v[104:107], a[192:199], v0
  s_waitcnt lgkmcnt(1)
  ds_read_b128 v[76:79], v4 offset:28672
  v_smfmac_f32_16x16x64_bf16 v[92:95], v[108:111], a[224:231], v0
  s_waitcnt lgkmcnt(1)
  ds_read_b128 v[80:83], v4 offset:29696
  v_smfmac_f32_16x16x64_bf16 v[92:95], v[68:71], a[240:247], v0
  ds_read_b128 v[60:63], v4 offset:26624
  v_smfmac_f32_16x16x64_bf16 v[96:99], v[104:107], a[200:207], v0
  ds_read_b128 v[64:67], v4 offset:27648
  v_smfmac_f32_16x16x64_bf16 v[96:99], v[108:111], a[232:239], v0
  ds_read_b128 v[28:31], v4 offset:30720
  s_nop 0
  v_cvt_pk_bf16_f32 v16, v92, v93
  v_cvt_pk_bf16_f32 v17, v94, v95
  v_bfi_b32 v16, 1, s57, v16
  v_smfmac_f32_16x16x64_bf16 v[96:99], v[68:71], a[248:255], v0
  buffer_store_dwordx2 v[16:17], v7, s[4:7], s20 offen offset:0 sc1
  v_smfmac_f32_16x16x64_bf16 v[36:39], v[104:107], a[208:215], v0
  ds_read_b128 v[32:35], v4 offset:31744
  v_smfmac_f32_16x16x64_bf16 v[36:39], v[108:111], v[52:59], v0
  s_waitcnt lgkmcnt(4)
  s_nop 0
  v_cvt_pk_bf16_f32 v18, v96, v97
  v_cvt_pk_bf16_f32 v19, v98, v99
  v_bfi_b32 v18, 1, s57, v18
  v_smfmac_f32_16x16x64_bf16 v[36:39], v[68:71], v[76:83], v0
  buffer_store_dwordx2 v[18:19], v7, s[4:7], s20 offen offset:64 sc1
  v_smfmac_f32_16x16x64_bf16 v[40:43], v[104:107], a[216:223], v0
  s_waitcnt lgkmcnt(2)
  ds_read_b128 v[116:119], v2 offset:31232
  v_smfmac_f32_16x16x64_bf16 v[40:43], v[108:111], v[60:67], v0
  s_waitcnt lgkmcnt(1)
  s_nop 0
  v_cvt_pk_bf16_f32 v20, v36, v37
  v_cvt_pk_bf16_f32 v21, v38, v39
  v_bfi_b32 v20, 1, s57, v20
  v_smfmac_f32_16x16x64_bf16 v[40:43], v[68:71], v[28:35], v0
  buffer_store_dwordx2 v[20:21], v7, s[4:7], s21 offen offset:0 sc1
  s_nop 6
  v_cvt_pk_bf16_f32 v22, v40, v41
  v_cvt_pk_bf16_f32 v23, v42, v43
  v_bfi_b32 v22, 1, s57, v22
  buffer_store_dwordx2 v[22:23], v7, s[4:7], s21 offen offset:64 sc1
  ds_read_b128 v[68:71], v4 offset:0
  ds_read_b128 v[72:75], v4 offset:1024
  ds_read_b128 v[76:79], v4 offset:4096
  ds_read_b128 v[80:83], v4 offset:5120
  ds_read_b128 v[84:87], v4 offset:8192
  ds_read_b128 v[88:91], v4 offset:9216
  ds_read_b128 v[92:95], v4 offset:2048
  ds_read_b128 v[96:99], v4 offset:3072
  ds_read_b128 v[100:103], v4 offset:6144
  ds_read_b128 v[104:107], v4 offset:7168
  ds_read_b128 v[108:111], v4 offset:10240
  ds_read_b128 v[112:115], v4 offset:11264
  v_mov_b64 v[16:17], 0
  v_mov_b64 v[18:19], 0
  v_mov_b64 v[20:21], 0
  v_mov_b64 v[22:23], 0
  v_mov_b64 v[24:25], 0
  v_mov_b64 v[26:27], 0
  s_mov_b32 s19, 0
  v_mov_b32 v49, -1
  ds_read_b64 v[44:45], v2 offset:32256
  s_waitcnt lgkmcnt(0)
  v_readfirstlane_b32 s38, v44
  v_readfirstlane_b32 s37, v45
  s_nop 0
  s_add_u32 s37, s37, 30
  s_cmp_ge_u32 s38, 30
  s_cselect_b32 s38, s37, s38
  s_cmp_ge_u32 s38, 64
  s_cselect_b32 s38, 100, s38
  s_sub_u32 s38, s38, 1
  s_max_i32 s30, s30, s38
  s_waitcnt vmcnt(0)
  buffer_load_dwordx4 v[52:55], v2, s[4:7], s22 offen offset:0 sc1
  buffer_load_dwordx4 v[56:59], v2, s[4:7], s22 offen offset:1024 sc1
  buffer_load_dwordx4 v[60:63], v2, s[4:7], s22 offen offset:2048 sc1
  buffer_load_dwordx4 v[64:67], v2, s[4:7], s22 offen offset:3072 sc1
  s_waitcnt lgkmcnt(12)
  s_waitcnt vmcnt(3)
  v_mfma_f32_16x16x32_bf16 v[120:123], v[116:119], v[52:55], 0
  v_xor_b32 v48, s57, v52
  v_bitop3_b32 v48, v48, v54, s57 bitop3:0xf6
  s_waitcnt vmcnt(2)
  v_mfma_f32_16x16x32_bf16 v[120:123], v[116:119], v[56:59], v[120:123]
  v_bitop3_b32 v48, v48, v56, s57 bitop3:0xf6
  v_bitop3_b32 v48, v48, v58, s57 bitop3:0xf6
  s_waitcnt vmcnt(1)
  v_mfma_f32_16x16x32_bf16 v[120:123], v[116:119], v[60:63], v[120:123]
  v_bitop3_b32 v48, v48, v60, s57 bitop3:0xf6
  v_bitop3_b32 v48, v48, v62, s57 bitop3:0xf6
  s_waitcnt vmcnt(0)
  v_mfma_f32_16x16x32_bf16 v[120:123], v[116:119], v[64:67], v[120:123]
  v_bitop3_b32 v48, v48, v64, s57 bitop3:0xf6
  v_bitop3_b32 v48, v48, v66, s57 bitop3:0xf6
  v_and_b32 v48, 1, v48
  v_cmp_ne_u32 vcc, 0, v48
  s_cbranch_vccnz T_p1re_159
T_p1ok_160:
  s_nop 2
  v_add_f32_dpp v120, v120, v120 row_ror:8 row_mask:0xf bank_mask:0xf
  v_add_f32_dpp v121, v121, v121 row_ror:8 row_mask:0xf bank_mask:0xf
  v_cvt_pk_bf16_f32 v48, v120, v121
  v_min_u32 v48, -2, v48
  buffer_store_dword v48, v8, s[4:7], s35 offen sc1
  buffer_store_dword v49, v8, s[4:7], s26 offen sc1
  s_barrier
  ds_read_b128 v[28:31], v2 offset:17408
  ds_read_b128 v[32:35], v2 offset:21504
  ds_read_b128 v[36:39], v2 offset:8192
  ds_read_b128 v[40:43], v2 offset:9216
  ds_read_b128 v[44:47], v2 offset:10240
  ds_read_b128 v[48:51], v2 offset:11264
  buffer_load_dwordx4 v[124:127], v3, s[4:7], s24 offen offset:1024 sc1
  buffer_load_dwordx4 v[116:119], v3, s[4:7], s25 offen offset:1024 sc1
  ds_read_b128 v[52:55], v2 offset:12288
  ds_read_b128 v[56:59], v2 offset:13312
  ds_read_b128 v[60:63], v2 offset:14336
  ds_read_b128 v[64:67], v2 offset:15360
  buffer_load_dwordx4 v[124:127], v3, s[4:7], s24 offen offset:1024 sc1
  buffer_load_dwordx4 v[116:119], v3, s[4:7], s25 offen offset:1024 sc1
  s_mov_b32 s19, 0
  s_branch T_loop_150
T_p1re_159:
  s_mov_b64 exec, vcc
  buffer_load_dwordx4 v[52:55], v2, s[4:7], s22 offen offset:0 sc1
  buffer_load_dwordx4 v[56:59], v2, s[4:7], s22 offen offset:1024 sc1
  buffer_load_dwordx4 v[60:63], v2, s[4:7], s22 offen offset:2048 sc1
  buffer_load_dwordx4 v[64:67], v2, s[4:7], s22 offen offset:3072 sc1
  s_mov_b64 exec, -1
  s_add_u32 s19, s19, 1
  s_cmp_gt_u32 s19, 32768
  s_cbranch_scc1 M_exit
  s_waitcnt vmcnt(3)
  v_mfma_f32_16x16x32_bf16 v[120:123], v[116:119], v[52:55], 0
  v_xor_b32 v48, s57, v52
  v_bitop3_b32 v48, v48, v54, s57 bitop3:0xf6
  s_waitcnt vmcnt(2)
  v_mfma_f32_16x16x32_bf16 v[120:123], v[116:119], v[56:59], v[120:123]
  v_bitop3_b32 v48, v48, v56, s57 bitop3:0xf6
  v_bitop3_b32 v48, v48, v58, s57 bitop3:0xf6
  s_waitcnt vmcnt(1)
  v_mfma_f32_16x16x32_bf16 v[120:123], v[116:119], v[60:63], v[120:123]
  v_bitop3_b32 v48, v48, v60, s57 bitop3:0xf6
  v_bitop3_b32 v48, v48, v62, s57 bitop3:0xf6
  s_waitcnt vmcnt(0)
  v_mfma_f32_16x16x32_bf16 v[120:123], v[116:119], v[64:67], v[120:123]
  v_bitop3_b32 v48, v48, v64, s57 bitop3:0xf6
  v_bitop3_b32 v48, v48, v66, s57 bitop3:0xf6
  v_and_b32 v48, 1, v48
  v_cmp_ne_u32 vcc, 0, v48
  s_cbranch_vccnz T_p1re_159
  s_branch T_p1ok_160
T_kvw_154:
  s_mov_b32 s19, 0
  s_branch T_kvok_162
T_kv_161:
  s_sleep 4
  s_add_u32 s19, s19, 1
  s_cmp_gt_u32 s19, 32768
  s_cbranch_scc1 M_exit
T_kvok_162:
  s_add_u32 s39, s99, 128
  s_mov_b32 s38, 0
  s_mov_b32 s37, 0
  s_atomic_or s38, s[58:59], s99 glc
  s_atomic_or s37, s[58:59], s39 glc
  s_waitcnt lgkmcnt(0)
  s_add_u32 s37, s37, 30
  s_cmp_ge_u32 s38, 30
  s_cselect_b32 s38, s37, s38
  s_cmp_ge_u32 s38, 64
  s_cselect_b32 s38, 100, s38
  s_sub_u32 s38, s38, 1
  s_max_i32 s30, s30, s38
  s_cmp_ge_i32 s14, s30
  s_cbranch_scc1 T_kv_161
  s_branch T_kvb_155
T_slow_156:
  s_nop 7
  v_max3_f32 v100, v16, v17, v18
  v_max3_f32 v100, v100, v19, v20
  v_max3_f32 v100, v100, v21, v22
  v_max3_f32 v100, v100, v23, v112
  v_max3_f32 v100, v100, v113, v114
  v_max_f32 v100, v100, v115
  v_mov_b32 v101, v100
  s_nop 1
  v_permlane32_swap_b32 v100, v101
  s_nop 1
  v_max_f32 v100, v100, v101
  v_mov_b32 v101, v100
  s_nop 1
  v_permlane16_swap_b32 v100, v101
  s_nop 1
  v_max_f32 v100, v100, v101
  v_sub_f32 v16, v16, v100
  v_sub_f32 v17, v17, v100
  v_sub_f32 v18, v18, v100
  v_sub_f32 v19, v19, v100
  v_exp_f32 v16, v16
  v_exp_f32 v17, v17
  v_exp_f32 v18, v18
  v_exp_f32 v19, v19
  v_sub_f32 v20, v20, v100
  v_sub_f32 v21, v21, v100
  v_sub_f32 v22, v22, v100
  v_sub_f32 v23, v23, v100
  v_exp_f32 v20, v20
  v_exp_f32 v21, v21
  v_exp_f32 v22, v22
  v_exp_f32 v23, v23
  v_sub_f32 v112, v112, v100
  v_sub_f32 v113, v113, v100
  v_sub_f32 v114, v114, v100
  v_sub_f32 v115, v115, v100
  v_exp_f32 v112, v112
  v_exp_f32 v113, v113
  v_exp_f32 v114, v114
  v_exp_f32 v115, v115
  s_nop 0
  v_cvt_pk_bf16_f32 v44, v16, v17
  v_cvt_pk_bf16_f32 v45, v18, v19
  v_cvt_pk_bf16_f32 v46, v20, v21
  v_cvt_pk_bf16_f32 v47, v22, v23
  v_cvt_pk_bf16_f32 v84, v112, v113
  v_cvt_pk_bf16_f32 v85, v114, v115
  v_cndmask_b32 v48, v84, 0, s[16:17]
  v_cndmask_b32 v49, v85, 0, s[16:17]
  v_cndmask_b32 v50, 0, v84, s[16:17]
  v_cndmask_b32 v51, 0, v85, s[16:17]
  s_nop 1
  v_mfma_f32_16x16x16_bf16 v[88:91], v[12:13], v[48:49], 0
  v_mfma_f32_16x16x16_bf16 v[24:27], v[120:121], v[48:49], 0
  v_mfma_f32_16x16x16_bf16 v[116:119], v[120:121], v[50:51], 0
  v_mfma_f32_16x16x32_bf16 v[88:91], v[12:15], v[44:47], v[88:91]
  v_mfma_f32_16x16x32_bf16 v[24:27], v[28:31], v[44:47], v[24:27]
  v_mfma_f32_16x16x32_bf16 v[116:119], v[32:35], v[44:47], v[116:119]
  s_nop 7
  s_nop 1
  v_rcp_f32 v89, v88
  s_nop 0
  v_mul_f32 v24, v89, v24
  v_mul_f32 v25, v89, v25
  s_branch T_back_157
T_w_135:
  s_mov_b32 s19, 0
  v_mov_b64 v[16:17], 0
  v_mov_b64 v[18:19], 0
  v_mov_b64 v[20:21], 0
  v_mov_b64 v[22:23], 0
  v_mov_b64 v[24:25], 0
  v_mov_b64 v[26:27], 0
  buffer_load_dwordx4 v[124:127], v3, s[4:7], s24 offen offset:2048 sc1
  buffer_load_dwordx4 v[116:119], v3, s[4:7], s25 offen offset:2048 sc1
  buffer_load_dwordx4 v[124:127], v3, s[4:7], s24 offen offset:2048 sc1
  buffer_load_dwordx4 v[116:119], v3, s[4:7], s25 offen offset:2048 sc1
  s_branch T_loop_163
.p2align 6
T_retry_164:
  s_mov_b64 exec, vcc
  buffer_load_dwordx4 v[124:127], v3, s[4:7], s24 offen offset:2048 sc1
  buffer_load_dwordx4 v[116:119], v3, s[4:7], s25 offen offset:2048 sc1
  s_mov_b64 exec, -1
  s_add_u32 s19, s19, 1
  s_cmp_gt_u32 s19, 32768
  s_cbranch_scc1 M_exit
T_loop_163:
  s_waitcnt vmcnt(3) lgkmcnt(0)
  v_max3_u32 v123, v124, v125, v126
  v_max_u32 v123, v123, v127
  v_mov_b32_dpp v120, v124 row_ror:8 row_mask:0xf bank_mask:0xf
  v_mov_b32_dpp v121, v125 row_ror:8 row_mask:0xf bank_mask:0xf
  s_waitcnt vmcnt(2)
  v_max3_u32 v123, v123, v116, v117
  v_max3_u32 v123, v123, v118, v119
  v_cmp_eq_u32 vcc, -1, v123
  s_cbranch_vccnz T_retry_164
  v_smfmac_f32_16x16x64_bf16 v[16:19], v[124:127], v[68:75], v0
  s_add_u32 s14, s14, 1
  ds_write_b128 v2, v[124:127] offset:2048
  v_mov_b32_dpp v122, v126 row_ror:8 row_mask:0xf bank_mask:0xf
  v_smfmac_f32_16x16x64_bf16 v[20:23], v[124:127], v[76:83], v0
  s_and_b32 s57, s14, 1
  v_mov_b32_dpp v123, v127 row_ror:8 row_mask:0xf bank_mask:0xf
  v_smfmac_f32_16x16x64_bf16 v[24:27], v[124:127], v[84:91], v0
  s_and_b32 s36, s14, 3
  ds_write_b128 v2, v[116:119] offset:6144
  v_smfmac_f32_16x16x64_bf16 v[16:19], v[120:123], v[92:99], v0
  s_lshl_b32 s36, s36, 13
  v_mov_b32_dpp v84, v116 row_ror:8 row_mask:0xf bank_mask:0xf
  v_smfmac_f32_16x16x64_bf16 v[20:23], v[120:123], v[100:107], v0
  s_add_u32 s26, s36, s23
  ds_read_b128 v[68:71], v4 offset:12288
  v_mov_b32_dpp v85, v117 row_ror:8 row_mask:0xf bank_mask:0xf
  v_smfmac_f32_16x16x64_bf16 v[24:27], v[120:123], v[108:115], v0
  s_add_u32 s36, s36, 8192
  ds_read_b128 v[72:75], v4 offset:13312
  v_mov_b32_dpp v86, v118 row_ror:8 row_mask:0xf bank_mask:0xf
  v_smfmac_f32_16x16x64_bf16 v[16:19], v[116:119], v[224:231], v0
  s_and_b32 s36, s36, 0x7fff
  ds_read_b128 v[76:79], v4 offset:14336
  v_mov_b32_dpp v87, v119 row_ror:8 row_mask:0xf bank_mask:0xf
  v_smfmac_f32_16x16x64_bf16 v[20:23], v[116:119], v[240:247], v0
  s_waitcnt lgkmcnt(3)
  s_barrier
  ds_read_b128 v[100:103], v2 offset:3072
  v_smfmac_f32_16x16x64_bf16 v[24:27], v[116:119], a[0:7], v0
  s_mov_b32 m0, s31
  ds_read_b128 v[120:123], v1 offset:3072
  v_smfmac_f32_16x16x64_bf16 v[16:19], v[84:87], v[232:239], v0
  s_cmp_ge_i32 s14, s30
  s_cbranch_scc1 T_kvw_167
T_kvb_168:
  v_smfmac_f32_16x16x64_bf16 v[20:23], v[84:87], v[248:255], v0
  ds_read_b128 v[80:83], v4 offset:15360
  v_smfmac_f32_16x16x64_bf16 v[24:27], v[84:87], a[8:15], v0
  s_waitcnt lgkmcnt(2)
  v_smfmac_f32_16x16x64_bf16 v[16:19], v[100:103], v[128:135], v0
  ds_read_b128 v[92:95], v2 offset:0
  buffer_load_dwordx4 v9, s[4:7], s27 offen sc1 lds
  v_smfmac_f32_16x16x64_bf16 v[20:23], v[100:103], v[144:151], v0
  ds_read_b128 v[96:99], v1 offset:0
  s_mov_b32 m0, s32
  v_smfmac_f32_16x16x64_bf16 v[24:27], v[100:103], v[68:75], v0
  s_waitcnt vmcnt(1) lgkmcnt(3)
  ds_read_b128 v[116:119], v2 offset:1024
  v_smfmac_f32_16x16x64_bf16 v[16:19], v[120:123], v[136:143], v0
  ds_read_b128 v[124:127], v1 offset:1024
  v_smfmac_f32_16x16x64_bf16 v[20:23], v[120:123], v[152:159], v0
  s_waitcnt lgkmcnt(4)
  ds_read_b128 v[104:107], v2 offset:7168
  buffer_load_dwordx4 v9, s[4:7], s27 offen offset:128 sc1 lds
  v_smfmac_f32_16x16x64_bf16 v[24:27], v[120:123], v[76:83], v0
  s_waitcnt lgkmcnt(4)
  ds_read_b128 v[108:111], v1 offset:7168
  s_mov_b32 m0, s33
  v_smfmac_f32_16x16x64_bf16 v[16:19], v[92:95], v[160:167], v0
  s_waitcnt lgkmcnt(4)
  ds_read_b128 v[112:115], v2 offset:4096
  v_smfmac_f32_16x16x64_bf16 v[16:19], v[96:99], v[168:175], v0
  s_waitcnt lgkmcnt(4)
  ds_read_b128 v[84:87], v1 offset:4096
  v_smfmac_f32_16x16x64_bf16 v[16:19], v[116:119], v[192:199], v0
  s_waitcnt lgkmcnt(4)
  ds_read_b128 v[88:91], v2 offset:5120
  buffer_load_dwordx4 v10, s[4:7], s28 offen sc1 lds
  v_smfmac_f32_16x16x64_bf16 v[16:19], v[124:127], v[200:207], v0
  s_waitcnt lgkmcnt(4)
  ds_read_b128 v[100:103], v1 offset:5120
  s_mov_b32 m0, s34
  v_smfmac_f32_16x16x64_bf16 v[16:19], v[104:107], a[16:23], v0
  s_waitcnt lgkmcnt(4)
  ds_read_b128 v[68:71], v4 offset:16384
  v_smfmac_f32_16x16x64_bf16 v[16:19], v[108:111], a[24:31], v0
  s_waitcnt lgkmcnt(4)
  ds_read_b128 v[72:75], v4 offset:17408
  v_smfmac_f32_16x16x64_bf16 v[16:19], v[112:115], a[64:71], v0
  s_waitcnt lgkmcnt(4)
  ds_read_b128 v[76:79], v4 offset:18432
  buffer_load_dwordx4 v10, s[4:7], s28 offen offset:256 sc1 lds
  v_smfmac_f32_16x16x64_bf16 v[16:19], v[84:87], a[72:79], v0
  s_waitcnt lgkmcnt(4)
  ds_read_b128 v[80:83], v4 offset:19456
  v_smfmac_f32_16x16x64_bf16 v[16:19], v[88:91], a[112:119], v0
  s_waitcnt lgkmcnt(4)
  v_smfmac_f32_16x16x64_bf16 v[16:19], v[100:103], a[120:127], v0
  s_add_u32 s24, s36, 145752064
  s_add_u32 s25, s36, 145756160
  v_smfmac_f32_16x16x64_bf16 v[20:23], v[92:95], v[176:183], v0
  s_add_u32 s35, s36, s23
  v_smfmac_f32_16x16x64_bf16 v[20:23], v[96:99], v[184:191], v0
  s_waitcnt lgkmcnt(2)
  v_smfmac_f32_16x16x64_bf16 v[20:23], v[116:119], v[68:75], v0
  s_waitcnt lgkmcnt(0)
  ds_read_b128 v[68:71], v4 offset:20480
  v_mul_f32 v16, s18, v16
  v_smfmac_f32_16x16x64_bf16 v[20:23], v[124:127], v[76:83], v0
  ds_read_b128 v[72:75], v4 offset:21504
  v_mul_f32 v17, s18, v17
  v_smfmac_f32_16x16x64_bf16 v[20:23], v[104:107], a[32:39], v0
  ds_read_b128 v[76:79], v4 offset:22528
  v_mul_f32 v18, s18, v18
  v_smfmac_f32_16x16x64_bf16 v[20:23], v[108:111], a[40:47], v0
  ds_read_b128 v[80:83], v4 offset:23552
  v_mul_f32 v19, s18, v19
  v_smfmac_f32_16x16x64_bf16 v[20:23], v[112:115], a[80:87], v0
  v_cvt_pk_bf16_f32 v120, v16, v17
  v_smfmac_f32_16x16x64_bf16 v[20:23], v[84:87], a[88:95], v0
  v_cvt_pk_bf16_f32 v121, v18, v19
  v_smfmac_f32_16x16x64_bf16 v[20:23], v[88:91], a[128:135], v0
  ds_write_b64 v5, v[120:121] offset:24576
  v_smfmac_f32_16x16x64_bf16 v[20:23], v[100:103], a[136:143], v0
  s_waitcnt lgkmcnt(3)
  v_smfmac_f32_16x16x64_bf16 v[24:27], v[92:95], v[68:75], v0
  s_waitcnt lgkmcnt(1)
  v_mov_b64 v[92:93], 0
  v_smfmac_f32_16x16x64_bf16 v[24:27], v[96:99], v[76:83], v0
  s_nop 1
  v_cvt_pk_bf16_f32 v122, v20, v21
  v_cvt_pk_bf16_f32 v123, v22, v23
  v_smfmac_f32_16x16x64_bf16 v[24:27], v[116:119], v[208:215], v0
  ds_write_b64 v5, v[122:123] offset:26880
  v_mov_b64 v[94:95], 0
  v_smfmac_f32_16x16x64_bf16 v[24:27], v[124:127], v[216:223], v0
  s_waitcnt lgkmcnt(1)
  s_barrier
  ds_read_b64_tr_b16 v[68:69], v6 offset:24576
  v_smfmac_f32_16x16x64_bf16 v[24:27], v[104:107], a[48:55], v0
  s_add_u32 s27, s27, 8192
  ds_read_b64_tr_b16 v[70:71], v6 offset:24640
  ds_read_b64_tr_b16 v[72:73], v6 offset:24832
  v_smfmac_f32_16x16x64_bf16 v[24:27], v[108:111], a[56:63], v0
  s_add_u32 s28, s28, 8192
  ds_read_b64_tr_b16 v[74:75], v6 offset:24896
  ds_read_b64_tr_b16 v[76:77], v6 offset:25088
  v_smfmac_f32_16x16x64_bf16 v[24:27], v[112:115], a[96:103], v0
  s_nop 0
  ds_read_b64_tr_b16 v[78:79], v6 offset:25152
  ds_read_b64_tr_b16 v[80:81], v6 offset:25344
  v_smfmac_f32_16x16x64_bf16 v[24:27], v[84:87], a[104:111], v0
  ds_read_b64_tr_b16 v[82:83], v6 offset:25408
  v_mov_b64 v[96:97], 0
  v_smfmac_f32_16x16x64_bf16 v[24:27], v[88:91], a[144:151], v0
  s_waitcnt lgkmcnt(8)
  s_barrier
  ds_read_b64_tr_b16 v[116:117], v6 offset:26880
  v_smfmac_f32_16x16x64_bf16 v[24:27], v[100:103], a[152:159], v0
  s_waitcnt lgkmcnt(7)
  ds_read_b64_tr_b16 v[118:119], v6 offset:26944
  buffer_store_dwordx2 v[122:123], v5, s[4:7], s29 offen sc1
  v_mfma_f32_16x16x32_bf16 v[16:19], v[36:39], v[68:71], 0
  s_waitcnt lgkmcnt(6)
  ds_read_b64_tr_b16 v[124:125], v6 offset:27136
  ds_read_b64_tr_b16 v[126:127], v6 offset:27200
  v_mfma_f32_16x16x32_bf16 v[16:19], v[40:43], v[72:75], v[16:19]
  s_waitcnt lgkmcnt(6)
  ds_read_b64_tr_b16 v[104:105], v6 offset:27392
  ds_read_b64_tr_b16 v[106:107], v6 offset:27456
  v_mfma_f32_16x16x32_bf16 v[16:19], v[44:47], v[76:79], v[16:19]
  s_waitcnt lgkmcnt(6)
  ds_read_b64_tr_b16 v[108:109], v6 offset:27648
  ds_read_b64_tr_b16 v[110:111], v6 offset:27712
  v_mfma_f32_16x16x32_bf16 v[16:19], v[48:51], v[80:83], v[16:19]
  s_waitcnt lgkmcnt(6)
  v_cvt_pk_bf16_f32 v120, v24, v25
  v_cvt_pk_bf16_f32 v121, v26, v27
  v_mov_b32 v86, s14
  v_mfma_f32_16x16x32_bf16 v[112:115], v[116:119], v[68:71], 0
  s_waitcnt lgkmcnt(4)
  buffer_store_dword v86, v8, s[4:7], s15 offen sc1
  buffer_store_dwordx2 v[120:121], v5, s[4:7], s29 offen offset:2304 sc1
  v_mov_b64 v[98:99], 0
  v_mfma_f32_16x16x32_bf16 v[112:115], v[124:127], v[72:75], v[112:115]
  s_waitcnt lgkmcnt(2)
  v_mov_b64 v[36:37], 0
  v_exp_f32 v100, v16
  v_mfma_f32_16x16x32_bf16 v[112:115], v[104:107], v[76:79], v[112:115]
  s_waitcnt lgkmcnt(0)
  v_exp_f32 v101, v17
  v_mfma_f32_16x16x32_bf16 v[112:115], v[108:111], v[80:83], v[112:115]
  s_add_u32 s29, s29, 147456
  v_exp_f32 v102, v18
  v_mfma_f32_16x16x32_bf16 v[20:23], v[52:55], v[68:71], 0
  s_cmp_eq_u32 s14, 63
  v_exp_f32 v103, v19
  v_mfma_f32_16x16x32_bf16 v[20:23], v[56:59], v[72:75], v[20:23]
  s_cbranch_scc1 M_tdone
  v_cvt_pk_bf16_f32 v44, v100, v101
  v_cvt_pk_bf16_f32 v45, v102, v103
  v_mfma_f32_16x16x32_bf16 v[20:23], v[60:63], v[76:79], v[20:23]
  v_exp_f32 v100, v112
  v_mfma_f32_16x16x32_bf16 v[20:23], v[64:67], v[80:83], v[20:23]
  v_exp_f32 v101, v113
  v_exp_f32 v102, v114
  v_exp_f32 v103, v115
  v_cvt_pk_bf16_f32 v84, v100, v101
  v_cvt_pk_bf16_f32 v85, v102, v103
  v_cndmask_b32 v48, v84, 0, s[16:17]
  v_cndmask_b32 v49, v85, 0, s[16:17]
  v_cndmask_b32 v50, 0, v84, s[16:17]
  v_cndmask_b32 v51, 0, v85, s[16:17]
  v_exp_f32 v100, v20
  v_mfma_f32_16x16x16_bf16 v[88:91], v[12:13], v[48:49], 0
  v_exp_f32 v101, v21
  v_mfma_f32_16x16x16_bf16 v[24:27], v[120:121], v[48:49], 0
  v_exp_f32 v102, v22
  v_mfma_f32_16x16x16_bf16 v[116:119], v[120:121], v[50:51], 0
  v_exp_f32 v103, v23
  v_cvt_pk_bf16_f32 v46, v100, v101
  v_cvt_pk_bf16_f32 v47, v102, v103
  v_mov_b64 v[38:39], 0
  s_nop 0
  v_mfma_f32_16x16x32_bf16 v[88:91], v[12:15], v[44:47], v[88:91]
  v_mov_b64 v[40:41], 0
  v_mov_b64 v[42:43], 0
  v_mfma_f32_16x16x32_bf16 v[24:27], v[28:31], v[44:47], v[24:27]
  ds_read_b128 v[52:55], v4 offset:24576
  ds_read_b128 v[56:59], v4 offset:25600
  v_mfma_f32_16x16x32_bf16 v[116:119], v[32:35], v[44:47], v[116:119]
  s_nop 1
  v_rcp_f32 v89, v88
  v_subrev_u32 v100, s54, v88
  v_cmp_le_u32 vcc, s55, v100
  v_mul_f32 v24, v89, v24
  v_mul_f32 v25, v89, v25
  s_cbranch_vccnz T_slow_169
T_back_170:
  v_cvt_pk_bf16_f32 v124, v24, v25
  v_pk_mul_f32 v[26:27], v[26:27], v[88:89] op_sel:[0,1] op_sel_hi:[1,1]
  v_pk_mul_f32 v[116:117], v[116:117], v[88:89] op_sel:[0,1] op_sel_hi:[1,1]
  v_pk_mul_f32 v[118:119], v[118:119], v[88:89] op_sel:[0,1] op_sel_hi:[1,1]
  v_cvt_pk_bf16_f32 v125, v26, v27
  v_cvt_pk_bf16_f32 v126, v116, v117
  v_cvt_pk_bf16_f32 v127, v118, v119
  ds_write_b128 v11, v[124:127] offset:30208
  s_nop 0
  v_smfmac_f32_16x16x64_bf16 v[92:95], v[124:127], a[160:167], v0
  v_smfmac_f32_16x16x64_bf16 v[96:99], v[124:127], a[168:175], v0
  v_smfmac_f32_16x16x64_bf16 v[36:39], v[124:127], a[176:183], v0
  v_smfmac_f32_16x16x64_bf16 v[40:43], v[124:127], a[184:191], v0
  s_waitcnt lgkmcnt(0)
  s_barrier
  ds_read_b128 v[104:107], v11 offset:30720
  ds_read_b128 v[108:111], v11 offset:29184
  ds_read_b128 v[68:71], v11 offset:29696
  s_waitcnt lgkmcnt(2)
  v_smfmac_f32_16x16x64_bf16 v[92:95], v[104:107], a[192:199], v0
  s_waitcnt lgkmcnt(1)
  ds_read_b128 v[76:79], v4 offset:28672
  v_smfmac_f32_16x16x64_bf16 v[92:95], v[108:111], a[224:231], v0
  s_waitcnt lgkmcnt(1)
  ds_read_b128 v[80:83], v4 offset:29696
  v_smfmac_f32_16x16x64_bf16 v[92:95], v[68:71], a[240:247], v0
  ds_read_b128 v[60:63], v4 offset:26624
  v_smfmac_f32_16x16x64_bf16 v[96:99], v[104:107], a[200:207], v0
  ds_read_b128 v[64:67], v4 offset:27648
  v_smfmac_f32_16x16x64_bf16 v[96:99], v[108:111], a[232:239], v0
  ds_read_b128 v[28:31], v4 offset:30720
  s_nop 0
  v_cvt_pk_bf16_f32 v16, v92, v93
  v_cvt_pk_bf16_f32 v17, v94, v95
  v_bfi_b32 v16, 1, s57, v16
  v_smfmac_f32_16x16x64_bf16 v[96:99], v[68:71], a[248:255], v0
  buffer_store_dwordx2 v[16:17], v7, s[4:7], s20 offen offset:0 sc1
  v_smfmac_f32_16x16x64_bf16 v[36:39], v[104:107], a[208:215], v0
  ds_read_b128 v[32:35], v4 offset:31744
  v_smfmac_f32_16x16x64_bf16 v[36:39], v[108:111], v[52:59], v0
  s_waitcnt lgkmcnt(4)
  s_nop 0
  v_cvt_pk_bf16_f32 v18, v96, v97
  v_cvt_pk_bf16_f32 v19, v98, v99
  v_bfi_b32 v18, 1, s57, v18
  v_smfmac_f32_16x16x64_bf16 v[36:39], v[68:71], v[76:83], v0
  buffer_store_dwordx2 v[18:19], v7, s[4:7], s20 offen offset:64 sc1
  v_smfmac_f32_16x16x64_bf16 v[40:43], v[104:107], a[216:223], v0
  s_waitcnt lgkmcnt(2)
  v_smfmac_f32_16x16x64_bf16 v[40:43], v[108:111], v[60:67], v0
  s_waitcnt lgkmcnt(0)
  s_nop 0
  v_cvt_pk_bf16_f32 v20, v36, v37
  v_cvt_pk_bf16_f32 v21, v38, v39
  v_bfi_b32 v20, 1, s57, v20
  v_smfmac_f32_16x16x64_bf16 v[40:43], v[68:71], v[28:35], v0
  buffer_store_dwordx2 v[20:21], v7, s[4:7], s21 offen offset:0 sc1
  s_nop 6
  v_cvt_pk_bf16_f32 v22, v40, v41
  v_cvt_pk_bf16_f32 v23, v42, v43
  v_bfi_b32 v22, 1, s57, v22
  buffer_store_dwordx2 v[22:23], v7, s[4:7], s21 offen offset:64 sc1
  ds_read_b128 v[68:71], v4 offset:0
  ds_read_b128 v[72:75], v4 offset:1024
  ds_read_b128 v[76:79], v4 offset:4096
  ds_read_b128 v[80:83], v4 offset:5120
  ds_read_b128 v[84:87], v4 offset:8192
  ds_read_b128 v[88:91], v4 offset:9216
  ds_read_b128 v[92:95], v4 offset:2048
  ds_read_b128 v[96:99], v4 offset:3072
  ds_read_b128 v[100:103], v4 offset:6144
  ds_read_b128 v[104:107], v4 offset:7168
  ds_read_b128 v[108:111], v4 offset:10240
  ds_read_b128 v[112:115], v4 offset:11264
  v_mov_b64 v[16:17], 0
  v_mov_b64 v[18:19], 0
  v_mov_b64 v[20:21], 0
  v_mov_b64 v[22:23], 0
  v_mov_b64 v[24:25], 0
  v_mov_b64 v[26:27], 0
  ds_read_b64 v[44:45], v2 offset:32256
  s_waitcnt lgkmcnt(0)
  v_readfirstlane_b32 s38, v44
  v_readfirstlane_b32 s37, v45
  s_nop 0
  s_add_u32 s37, s37, 30
  s_cmp_ge_u32 s38, 30
  s_cselect_b32 s38, s37, s38
  s_cmp_ge_u32 s38, 64
  s_cselect_b32 s38, 100, s38
  s_sub_u32 s38, s38, 1
  s_max_i32 s30, s30, s38
  s_waitcnt vmcnt(4)
  s_barrier
  ds_read_b128 v[28:31], v2 offset:18432
  ds_read_b128 v[32:35], v2 offset:22528
  ds_read_b128 v[36:39], v2 offset:8192
  ds_read_b128 v[40:43], v2 offset:9216
  ds_read_b128 v[44:47], v2 offset:10240
  ds_read_b128 v[48:51], v2 offset:11264
  buffer_load_dwordx4 v[124:127], v3, s[4:7], s24 offen offset:2048 sc1
  buffer_load_dwordx4 v[116:119], v3, s[4:7], s25 offen offset:2048 sc1
  ds_read_b128 v[52:55], v2 offset:12288
  ds_read_b128 v[56:59], v2 offset:13312
  ds_read_b128 v[60:63], v2 offset:14336
  ds_read_b128 v[64:67], v2 offset:15360
  buffer_load_dwordx4 v[124:127], v3, s[4:7], s24 offen offset:2048 sc1
  buffer_load_dwordx4 v[116:119], v3, s[4:7], s25 offen offset:2048 sc1
  s_mov_b32 s19, 0
  s_branch T_loop_163
T_kvw_167:
  s_mov_b32 s19, 0
  s_branch T_kvok_175
T_kv_174:
  s_sleep 4
  s_add_u32 s19, s19, 1
  s_cmp_gt_u32 s19, 32768
  s_cbranch_scc1 M_exit
T_kvok_175:
  s_add_u32 s39, s99, 128
  s_mov_b32 s38, 0
  s_mov_b32 s37, 0
  s_atomic_or s38, s[58:59], s99 glc
  s_atomic_or s37, s[58:59], s39 glc
  s_waitcnt lgkmcnt(0)
  s_add_u32 s37, s37, 30
  s_cmp_ge_u32 s38, 30
  s_cselect_b32 s38, s37, s38
  s_cmp_ge_u32 s38, 64
  s_cselect_b32 s38, 100, s38
  s_sub_u32 s38, s38, 1
  s_max_i32 s30, s30, s38
  s_cmp_ge_i32 s14, s30
  s_cbranch_scc1 T_kv_174
  s_branch T_kvb_168
T_slow_169:
  s_nop 7
  v_max3_f32 v100, v16, v17, v18
  v_max3_f32 v100, v100, v19, v20
  v_max3_f32 v100, v100, v21, v22
  v_max3_f32 v100, v100, v23, v112
  v_max3_f32 v100, v100, v113, v114
  v_max_f32 v100, v100, v115
  v_mov_b32 v101, v100
  s_nop 1
  v_permlane32_swap_b32 v100, v101
  s_nop 1
  v_max_f32 v100, v100, v101
  v_mov_b32 v101, v100
  s_nop 1
  v_permlane16_swap_b32 v100, v101
  s_nop 1
  v_max_f32 v100, v100, v101
  v_sub_f32 v16, v16, v100
  v_sub_f32 v17, v17, v100
  v_sub_f32 v18, v18, v100
  v_sub_f32 v19, v19, v100
  v_exp_f32 v16, v16
  v_exp_f32 v17, v17
  v_exp_f32 v18, v18
  v_exp_f32 v19, v19
  v_sub_f32 v20, v20, v100
  v_sub_f32 v21, v21, v100
  v_sub_f32 v22, v22, v100
  v_sub_f32 v23, v23, v100
  v_exp_f32 v20, v20
  v_exp_f32 v21, v21
  v_exp_f32 v22, v22
  v_exp_f32 v23, v23
  v_sub_f32 v112, v112, v100
  v_sub_f32 v113, v113, v100
  v_sub_f32 v114, v114, v100
  v_sub_f32 v115, v115, v100
  v_exp_f32 v112, v112
  v_exp_f32 v113, v113
  v_exp_f32 v114, v114
  v_exp_f32 v115, v115
  s_nop 0
  v_cvt_pk_bf16_f32 v44, v16, v17
  v_cvt_pk_bf16_f32 v45, v18, v19
  v_cvt_pk_bf16_f32 v46, v20, v21
  v_cvt_pk_bf16_f32 v47, v22, v23
  v_cvt_pk_bf16_f32 v84, v112, v113
  v_cvt_pk_bf16_f32 v85, v114, v115
  v_cndmask_b32 v48, v84, 0, s[16:17]
  v_cndmask_b32 v49, v85, 0, s[16:17]
  v_cndmask_b32 v50, 0, v84, s[16:17]
  v_cndmask_b32 v51, 0, v85, s[16:17]
  s_nop 1
  v_mfma_f32_16x16x16_bf16 v[88:91], v[12:13], v[48:49], 0
  v_mfma_f32_16x16x16_bf16 v[24:27], v[120:121], v[48:49], 0
  v_mfma_f32_16x16x16_bf16 v[116:119], v[120:121], v[50:51], 0
  v_mfma_f32_16x16x32_bf16 v[88:91], v[12:15], v[44:47], v[88:91]
  v_mfma_f32_16x16x32_bf16 v[24:27], v[28:31], v[44:47], v[24:27]
  v_mfma_f32_16x16x32_bf16 v[116:119], v[32:35], v[44:47], v[116:119]
  s_nop 7
  s_nop 1
  v_rcp_f32 v89, v88
  s_nop 0
  v_mul_f32 v24, v89, v24
  v_mul_f32 v25, v89, v25
  s_branch T_back_170
T_w_136:
  s_mov_b32 s19, 0
  v_mov_b64 v[16:17], 0
  v_mov_b64 v[18:19], 0
  v_mov_b64 v[20:21], 0
  v_mov_b64 v[22:23], 0
  v_mov_b64 v[24:25], 0
  v_mov_b64 v[26:27], 0
  buffer_load_dwordx4 v[124:127], v3, s[4:7], s24 offen offset:3072 sc1
  buffer_load_dwordx4 v[116:119], v3, s[4:7], s25 offen offset:3072 sc1
  buffer_load_dwordx4 v[124:127], v3, s[4:7], s24 offen offset:3072 sc1
  buffer_load_dwordx4 v[116:119], v3, s[4:7], s25 offen offset:3072 sc1
  s_branch T_loop_176
.p2align 6
T_retry_177:
  s_mov_b64 exec, vcc
  buffer_load_dwordx4 v[124:127], v3, s[4:7], s24 offen offset:3072 sc1
  buffer_load_dwordx4 v[116:119], v3, s[4:7], s25 offen offset:3072 sc1
  s_mov_b64 exec, -1
  s_add_u32 s19, s19, 1
  s_cmp_gt_u32 s19, 32768
  s_cbranch_scc1 M_exit
T_loop_176:
  s_waitcnt vmcnt(3) lgkmcnt(0)
  v_max3_u32 v123, v124, v125, v126
  v_max_u32 v123, v123, v127
  v_mov_b32_dpp v120, v124 row_ror:8 row_mask:0xf bank_mask:0xf
  v_mov_b32_dpp v121, v125 row_ror:8 row_mask:0xf bank_mask:0xf
  s_waitcnt vmcnt(2)
  v_max3_u32 v123, v123, v116, v117
  v_max3_u32 v123, v123, v118, v119
  v_cmp_eq_u32 vcc, -1, v123
  s_cbranch_vccnz T_retry_177
  v_smfmac_f32_16x16x64_bf16 v[16:19], v[124:127], v[68:75], v0
  s_add_u32 s14, s14, 1
  ds_write_b128 v2, v[124:127] offset:3072
  v_mov_b32_dpp v122, v126 row_ror:8 row_mask:0xf bank_mask:0xf
  v_smfmac_f32_16x16x64_bf16 v[20:23], v[124:127], v[76:83], v0
  s_and_b32 s57, s14, 1
  v_mov_b32_dpp v123, v127 row_ror:8 row_mask:0xf bank_mask:0xf
  v_smfmac_f32_16x16x64_bf16 v[24:27], v[124:127], v[84:91], v0
  s_and_b32 s36, s14, 3
  ds_write_b128 v2, v[116:119] offset:7168
  v_smfmac_f32_16x16x64_bf16 v[16:19], v[120:123], v[92:99], v0
  s_lshl_b32 s36, s36, 13
  v_mov_b32_dpp v84, v116 row_ror:8 row_mask:0xf bank_mask:0xf
  v_smfmac_f32_16x16x64_bf16 v[20:23], v[120:123], v[100:107], v0
  s_add_u32 s26, s36, s23
  ds_read_b128 v[68:71], v4 offset:12288
  v_mov_b32_dpp v85, v117 row_ror:8 row_mask:0xf bank_mask:0xf
  v_smfmac_f32_16x16x64_bf16 v[24:27], v[120:123], v[108:115], v0
  s_add_u32 s36, s36, 8192
  ds_read_b128 v[72:75], v4 offset:13312
  v_mov_b32_dpp v86, v118 row_ror:8 row_mask:0xf bank_mask:0xf
  v_smfmac_f32_16x16x64_bf16 v[16:19], v[116:119], v[224:231], v0
  s_and_b32 s36, s36, 0x7fff
  ds_read_b128 v[76:79], v4 offset:14336
  v_mov_b32_dpp v87, v119 row_ror:8 row_mask:0xf bank_mask:0xf
  v_smfmac_f32_16x16x64_bf16 v[20:23], v[116:119], v[240:247], v0
  s_waitcnt lgkmcnt(3)
  s_barrier
  ds_read_b128 v[100:103], v2 offset:2048
  v_smfmac_f32_16x16x64_bf16 v[24:27], v[116:119], a[0:7], v0
  s_mov_b32 m0, s31
  ds_read_b128 v[120:123], v1 offset:2048
  v_smfmac_f32_16x16x64_bf16 v[16:19], v[84:87], v[232:239], v0
  s_cmp_ge_i32 s14, s30
  s_cbranch_scc1 T_kvw_180
T_kvb_181:
  v_smfmac_f32_16x16x64_bf16 v[20:23], v[84:87], v[248:255], v0
  ds_read_b128 v[80:83], v4 offset:15360
  v_smfmac_f32_16x16x64_bf16 v[24:27], v[84:87], a[8:15], v0
  s_waitcnt lgkmcnt(2)
  v_smfmac_f32_16x16x64_bf16 v[16:19], v[100:103], v[128:135], v0
  ds_read_b128 v[92:95], v2 offset:1024
  v_smfmac_f32_16x16x64_bf16 v[20:23], v[100:103], v[144:151], v0
  ds_read_b128 v[96:99], v1 offset:1024
  buffer_load_dwordx4 v9, s[4:7], s27 offen sc1 lds
  v_smfmac_f32_16x16x64_bf16 v[24:27], v[100:103], v[68:75], v0
  s_waitcnt vmcnt(1) lgkmcnt(3)
  ds_read_b128 v[116:119], v2 offset:0
  s_mov_b32 m0, s32
  v_smfmac_f32_16x16x64_bf16 v[16:19], v[120:123], v[136:143], v0
  ds_read_b128 v[124:127], v1 offset:0
  v_smfmac_f32_16x16x64_bf16 v[20:23], v[120:123], v[152:159], v0
  s_waitcnt lgkmcnt(4)
  ds_read_b128 v[104:107], v2 offset:6144
  v_smfmac_f32_16x16x64_bf16 v[24:27], v[120:123], v[76:83], v0
  s_waitcnt lgkmcnt(4)
  ds_read_b128 v[108:111], v1 offset:6144
  buffer_load_dwordx4 v9, s[4:7], s27 offen offset:128 sc1 lds
  v_smfmac_f32_16x16x64_bf16 v[16:19], v[92:95], v[160:167], v0
  s_waitcnt lgkmcnt(4)
  ds_read_b128 v[112:115], v2 offset:5120
  s_mov_b32 m0, s33
  v_smfmac_f32_16x16x64_bf16 v[16:19], v[96:99], v[168:175], v0
  s_waitcnt lgkmcnt(4)
  ds_read_b128 v[84:87], v1 offset:5120
  v_smfmac_f32_16x16x64_bf16 v[16:19], v[116:119], v[192:199], v0
  s_waitcnt lgkmcnt(4)
  ds_read_b128 v[88:91], v2 offset:4096
  v_smfmac_f32_16x16x64_bf16 v[16:19], v[124:127], v[200:207], v0
  s_waitcnt lgkmcnt(4)
  ds_read_b128 v[100:103], v1 offset:4096
  buffer_load_dwordx4 v10, s[4:7], s28 offen sc1 lds
  v_smfmac_f32_16x16x64_bf16 v[16:19], v[104:107], a[16:23], v0
  s_waitcnt lgkmcnt(4)
  ds_read_b128 v[68:71], v4 offset:16384
  s_mov_b32 m0, s34
  v_smfmac_f32_16x16x64_bf16 v[16:19], v[108:111], a[24:31], v0
  s_waitcnt lgkmcnt(4)
  ds_read_b128 v[72:75], v4 offset:17408
  v_smfmac_f32_16x16x64_bf16 v[16:19], v[112:115], a[64:71], v0
  s_waitcnt lgkmcnt(4)
  ds_read_b128 v[76:79], v4 offset:18432
  v_smfmac_f32_16x16x64_bf16 v[16:19], v[84:87], a[72:79], v0
  s_waitcnt lgkmcnt(4)
  ds_read_b128 v[80:83], v4 offset:19456
  buffer_load_dwordx4 v10, s[4:7], s28 offen offset:256 sc1 lds
  v_smfmac_f32_16x16x64_bf16 v[16:19], v[88:91], a[112:119], v0
  s_waitcnt lgkmcnt(4)
  v_smfmac_f32_16x16x64_bf16 v[16:19], v[100:103], a[120:127], v0
  s_add_u32 s24, s36, 145752064
  s_add_u32 s25, s36, 145756160
  v_smfmac_f32_16x16x64_bf16 v[20:23], v[92:95], v[176:183], v0
  s_add_u32 s35, s36, s23
  v_smfmac_f32_16x16x64_bf16 v[20:23], v[96:99], v[184:191], v0
  s_waitcnt lgkmcnt(2)
  v_smfmac_f32_16x16x64_bf16 v[20:23], v[116:119], v[68:75], v0
  s_waitcnt lgkmcnt(0)
  ds_read_b128 v[68:71], v4 offset:20480
  v_mul_f32 v16, s18, v16
  v_smfmac_f32_16x16x64_bf16 v[20:23], v[124:127], v[76:83], v0
  ds_read_b128 v[72:75], v4 offset:21504
  v_mul_f32 v17, s18, v17
  v_smfmac_f32_16x16x64_bf16 v[20:23], v[104:107], a[32:39], v0
  ds_read_b128 v[76:79], v4 offset:22528
  v_mul_f32 v18, s18, v18
  v_smfmac_f32_16x16x64_bf16 v[20:23], v[108:111], a[40:47], v0
  ds_read_b128 v[80:83], v4 offset:23552
  v_mul_f32 v19, s18, v19
  v_smfmac_f32_16x16x64_bf16 v[20:23], v[112:115], a[80:87], v0
  v_cvt_pk_bf16_f32 v120, v16, v17
  v_smfmac_f32_16x16x64_bf16 v[20:23], v[84:87], a[88:95], v0
  v_cvt_pk_bf16_f32 v121, v18, v19
  v_smfmac_f32_16x16x64_bf16 v[20:23], v[88:91], a[128:135], v0
  ds_write_b64 v5, v[120:121] offset:24576
  v_smfmac_f32_16x16x64_bf16 v[20:23], v[100:103], a[136:143], v0
  s_waitcnt lgkmcnt(3)
  v_smfmac_f32_16x16x64_bf16 v[24:27], v[92:95], v[68:75], v0
  s_waitcnt lgkmcnt(1)
  v_mov_b64 v[92:93], 0
  v_smfmac_f32_16x16x64_bf16 v[24:27], v[96:99], v[76:83], v0
  s_nop 1
  v_cvt_pk_bf16_f32 v122, v20, v21
  v_cvt_pk_bf16_f32 v123, v22, v23
  v_smfmac_f32_16x16x64_bf16 v[24:27], v[116:119], v[208:215], v0
  ds_write_b64 v5, v[122:123] offset:26880
  v_mov_b64 v[94:95], 0
  v_smfmac_f32_16x16x64_bf16 v[24:27], v[124:127], v[216:223], v0
  s_waitcnt lgkmcnt(1)
  s_barrier
  ds_read_b64_tr_b16 v[68:69], v6 offset:24576
  v_smfmac_f32_16x16x64_bf16 v[24:27], v[104:107], a[48:55], v0
  s_add_u32 s27, s27, 8192
  ds_read_b64_tr_b16 v[70:71], v6 offset:24640
  ds_read_b64_tr_b16 v[72:73], v6 offset:24832
  v_smfmac_f32_16x16x64_bf16 v[24:27], v[108:111], a[56:63], v0
  s_add_u32 s28, s28, 8192
  ds_read_b64_tr_b16 v[74:75], v6 offset:24896
  ds_read_b64_tr_b16 v[76:77], v6 offset:25088
  v_smfmac_f32_16x16x64_bf16 v[24:27], v[112:115], a[96:103], v0
  s_nop 0
  ds_read_b64_tr_b16 v[78:79], v6 offset:25152
  ds_read_b64_tr_b16 v[80:81], v6 offset:25344
  v_smfmac_f32_16x16x64_bf16 v[24:27], v[84:87], a[104:111], v0
  ds_read_b64_tr_b16 v[82:83], v6 offset:25408
  v_mov_b64 v[96:97], 0
  v_smfmac_f32_16x16x64_bf16 v[24:27], v[88:91], a[144:151], v0
  s_waitcnt lgkmcnt(8)
  s_barrier
  ds_read_b64_tr_b16 v[116:117], v6 offset:26880
  v_smfmac_f32_16x16x64_bf16 v[24:27], v[100:103], a[152:159], v0
  s_waitcnt lgkmcnt(7)
  ds_read_b64_tr_b16 v[118:119], v6 offset:26944
  buffer_store_dwordx2 v[122:123], v5, s[4:7], s29 offen sc1
  v_mfma_f32_16x16x32_bf16 v[16:19], v[36:39], v[68:71], 0
  s_waitcnt lgkmcnt(6)
  ds_read_b64_tr_b16 v[124:125], v6 offset:27136
  ds_read_b64_tr_b16 v[126:127], v6 offset:27200
  v_mfma_f32_16x16x32_bf16 v[16:19], v[40:43], v[72:75], v[16:19]
  s_waitcnt lgkmcnt(6)
  ds_read_b64_tr_b16 v[104:105], v6 offset:27392
  ds_read_b64_tr_b16 v[106:107], v6 offset:27456
  v_mfma_f32_16x16x32_bf16 v[16:19], v[44:47], v[76:79], v[16:19]
  s_waitcnt lgkmcnt(6)
  ds_read_b64_tr_b16 v[108:109], v6 offset:27648
  ds_read_b64_tr_b16 v[110:111], v6 offset:27712
  v_mfma_f32_16x16x32_bf16 v[16:19], v[48:51], v[80:83], v[16:19]
  s_waitcnt lgkmcnt(6)
  s_mov_b32 m0, 32256
  v_cvt_pk_bf16_f32 v120, v24, v25
  v_cvt_pk_bf16_f32 v121, v26, v27
  v_mfma_f32_16x16x32_bf16 v[112:115], v[116:119], v[68:71], 0
  s_waitcnt lgkmcnt(4)
  buffer_load_dword v8, s[4:7], s99 offen sc1 lds
  buffer_store_dwordx2 v[120:121], v5, s[4:7], s29 offen offset:2304 sc1
  v_mov_b64 v[98:99], 0
  v_mfma_f32_16x16x32_bf16 v[112:115], v[124:127], v[72:75], v[112:115]
  s_waitcnt lgkmcnt(2)
  v_mov_b64 v[36:37], 0
  v_exp_f32 v100, v16
  v_mfma_f32_16x16x32_bf16 v[112:115], v[104:107], v[76:79], v[112:115]
  s_waitcnt lgkmcnt(0)
  v_exp_f32 v101, v17
  v_mfma_f32_16x16x32_bf16 v[112:115], v[108:111], v[80:83], v[112:115]
  s_add_u32 s29, s29, 147456
  v_exp_f32 v102, v18
  v_mfma_f32_16x16x32_bf16 v[20:23], v[52:55], v[68:71], 0
  s_cmp_eq_u32 s14, 63
  v_exp_f32 v103, v19
  v_mfma_f32_16x16x32_bf16 v[20:23], v[56:59], v[72:75], v[20:23]
  s_cbranch_scc1 M_tdone
  v_cvt_pk_bf16_f32 v44, v100, v101
  v_cvt_pk_bf16_f32 v45, v102, v103
  v_mfma_f32_16x16x32_bf16 v[20:23], v[60:63], v[76:79], v[20:23]
  v_exp_f32 v100, v112
  v_mfma_f32_16x16x32_bf16 v[20:23], v[64:67], v[80:83], v[20:23]
  v_exp_f32 v101, v113
  v_exp_f32 v102, v114
  v_exp_f32 v103, v115
  v_cvt_pk_bf16_f32 v84, v100, v101
  v_cvt_pk_bf16_f32 v85, v102, v103
  v_cndmask_b32 v48, v84, 0, s[16:17]
  v_cndmask_b32 v49, v85, 0, s[16:17]
  v_cndmask_b32 v50, 0, v84, s[16:17]
  v_cndmask_b32 v51, 0, v85, s[16:17]
  v_exp_f32 v100, v20
  v_mfma_f32_16x16x16_bf16 v[88:91], v[12:13], v[48:49], 0
  v_exp_f32 v101, v21
  v_mfma_f32_16x16x16_bf16 v[24:27], v[120:121], v[48:49], 0
  v_exp_f32 v102, v22
  v_mfma_f32_16x16x16_bf16 v[116:119], v[120:121], v[50:51], 0
  v_exp_f32 v103, v23
  v_cvt_pk_bf16_f32 v46, v100, v101
  v_cvt_pk_bf16_f32 v47, v102, v103
  v_mov_b64 v[38:39], 0
  s_nop 0
  v_mfma_f32_16x16x32_bf16 v[88:91], v[12:15], v[44:47], v[88:91]
  v_mov_b64 v[40:41], 0
  v_mov_b64 v[42:43], 0
  v_mfma_f32_16x16x32_bf16 v[24:27], v[28:31], v[44:47], v[24:27]
  ds_read_b128 v[52:55], v4 offset:24576
  ds_read_b128 v[56:59], v4 offset:25600
  v_mfma_f32_16x16x32_bf16 v[116:119], v[32:35], v[44:47], v[116:119]
  s_nop 1
  v_rcp_f32 v89, v88
  v_subrev_u32 v100, s54, v88
  v_cmp_le_u32 vcc, s55, v100
  v_mul_f32 v24, v89, v24
  v_mul_f32 v25, v89, v25
  s_cbranch_vccnz T_slow_182
T_back_183:
  v_cvt_pk_bf16_f32 v124, v24, v25
  v_pk_mul_f32 v[26:27], v[26:27], v[88:89] op_sel:[0,1] op_sel_hi:[1,1]
  v_pk_mul_f32 v[116:117], v[116:117], v[88:89] op_sel:[0,1] op_sel_hi:[1,1]
  v_pk_mul_f32 v[118:119], v[118:119], v[88:89] op_sel:[0,1] op_sel_hi:[1,1]
  v_cvt_pk_bf16_f32 v125, v26, v27
  v_cvt_pk_bf16_f32 v126, v116, v117
  v_cvt_pk_bf16_f32 v127, v118, v119
  ds_write_b128 v11, v[124:127] offset:30720
  s_nop 0
  v_smfmac_f32_16x16x64_bf16 v[92:95], v[124:127], a[160:167], v0
  v_smfmac_f32_16x16x64_bf16 v[96:99], v[124:127], a[168:175], v0
  v_smfmac_f32_16x16x64_bf16 v[36:39], v[124:127], a[176:183], v0
  v_smfmac_f32_16x16x64_bf16 v[40:43], v[124:127], a[184:191], v0
  s_waitcnt lgkmcnt(0)
  s_barrier
  ds_read_b128 v[104:107], v11 offset:30208
  ds_read_b128 v[108:111], v11 offset:29696
  ds_read_b128 v[68:71], v11 offset:29184
  s_waitcnt lgkmcnt(2)
  v_smfmac_f32_16x16x64_bf16 v[92:95], v[104:107], a[192:199], v0
  s_waitcnt lgkmcnt(1)
  ds_read_b128 v[76:79], v4 offset:28672
  v_smfmac_f32_16x16x64_bf16 v[92:95], v[108:111], a[224:231], v0
  s_waitcnt lgkmcnt(1)
  ds_read_b128 v[80:83], v4 offset:29696
  v_smfmac_f32_16x16x64_bf16 v[92:95], v[68:71], a[240:247], v0
  ds_read_b128 v[60:63], v4 offset:26624
  v_smfmac_f32_16x16x64_bf16 v[96:99], v[104:107], a[200:207], v0
  ds_read_b128 v[64:67], v4 offset:27648
  v_smfmac_f32_16x16x64_bf16 v[96:99], v[108:111], a[232:239], v0
  ds_read_b128 v[28:31], v4 offset:30720
  s_nop 0
  v_cvt_pk_bf16_f32 v16, v92, v93
  v_cvt_pk_bf16_f32 v17, v94, v95
  v_bfi_b32 v16, 1, s57, v16
  v_smfmac_f32_16x16x64_bf16 v[96:99], v[68:71], a[248:255], v0
  buffer_store_dwordx2 v[16:17], v7, s[4:7], s20 offen offset:0 sc1
  v_smfmac_f32_16x16x64_bf16 v[36:39], v[104:107], a[208:215], v0
  ds_read_b128 v[32:35], v4 offset:31744
  v_smfmac_f32_16x16x64_bf16 v[36:39], v[108:111], v[52:59], v0
  s_waitcnt lgkmcnt(4)
  s_nop 0
  v_cvt_pk_bf16_f32 v18, v96, v97
  v_cvt_pk_bf16_f32 v19, v98, v99
  v_bfi_b32 v18, 1, s57, v18
  v_smfmac_f32_16x16x64_bf16 v[36:39], v[68:71], v[76:83], v0
  buffer_store_dwordx2 v[18:19], v7, s[4:7], s20 offen offset:64 sc1
  v_smfmac_f32_16x16x64_bf16 v[40:43], v[104:107], a[216:223], v0
  s_waitcnt lgkmcnt(2)
  v_smfmac_f32_16x16x64_bf16 v[40:43], v[108:111], v[60:67], v0
  s_waitcnt lgkmcnt(0)
  s_nop 0
  v_cvt_pk_bf16_f32 v20, v36, v37
  v_cvt_pk_bf16_f32 v21, v38, v39
  v_bfi_b32 v20, 1, s57, v20
  v_smfmac_f32_16x16x64_bf16 v[40:43], v[68:71], v[28:35], v0
  buffer_store_dwordx2 v[20:21], v7, s[4:7], s21 offen offset:0 sc1
  s_nop 6
  v_cvt_pk_bf16_f32 v22, v40, v41
  v_cvt_pk_bf16_f32 v23, v42, v43
  v_bfi_b32 v22, 1, s57, v22
  buffer_store_dwordx2 v[22:23], v7, s[4:7], s21 offen offset:64 sc1
  ds_read_b128 v[68:71], v4 offset:0
  ds_read_b128 v[72:75], v4 offset:1024
  ds_read_b128 v[76:79], v4 offset:4096
  ds_read_b128 v[80:83], v4 offset:5120
  ds_read_b128 v[84:87], v4 offset:8192
  ds_read_b128 v[88:91], v4 offset:9216
  ds_read_b128 v[92:95], v4 offset:2048
  ds_read_b128 v[96:99], v4 offset:3072
  ds_read_b128 v[100:103], v4 offset:6144
  ds_read_b128 v[104:107], v4 offset:7168
  ds_read_b128 v[108:111], v4 offset:10240
  ds_read_b128 v[112:115], v4 offset:11264
  v_mov_b64 v[16:17], 0
  v_mov_b64 v[18:19], 0
  v_mov_b64 v[20:21], 0
  v_mov_b64 v[22:23], 0
  v_mov_b64 v[24:25], 0
  v_mov_b64 v[26:27], 0
  ds_read_b64 v[44:45], v2 offset:32256
  s_waitcnt lgkmcnt(0)
  v_readfirstlane_b32 s38, v44
  v_readfirstlane_b32 s37, v45
  s_nop 0
  s_add_u32 s37, s37, 30
  s_cmp_ge_u32 s38, 30
  s_cselect_b32 s38, s37, s38
  s_cmp_ge_u32 s38, 64
  s_cselect_b32 s38, 100, s38
  s_sub_u32 s38, s38, 1
  s_max_i32 s30, s30, s38
  s_waitcnt vmcnt(4)
  s_barrier
  ds_read_b128 v[28:31], v2 offset:19456
  ds_read_b128 v[32:35], v2 offset:23552
  ds_read_b128 v[36:39], v2 offset:8192
  ds_read_b128 v[40:43], v2 offset:9216
  ds_read_b128 v[44:47], v2 offset:10240
  ds_read_b128 v[48:51], v2 offset:11264
  buffer_load_dwordx4 v[124:127], v3, s[4:7], s24 offen offset:3072 sc1
  buffer_load_dwordx4 v[116:119], v3, s[4:7], s25 offen offset:3072 sc1
  ds_read_b128 v[52:55], v2 offset:12288
  ds_read_b128 v[56:59], v2 offset:13312
  ds_read_b128 v[60:63], v2 offset:14336
  ds_read_b128 v[64:67], v2 offset:15360
  buffer_load_dwordx4 v[124:127], v3, s[4:7], s24 offen offset:3072 sc1
  buffer_load_dwordx4 v[116:119], v3, s[4:7], s25 offen offset:3072 sc1
  s_mov_b32 s19, 0
  s_branch T_loop_176
T_kvw_180:
  s_mov_b32 s19, 0
  s_branch T_kvok_188
T_kv_187:
  s_sleep 4
  s_add_u32 s19, s19, 1
  s_cmp_gt_u32 s19, 32768
  s_cbranch_scc1 M_exit
T_kvok_188:
  s_add_u32 s39, s99, 128
  s_mov_b32 s38, 0
  s_mov_b32 s37, 0
  s_atomic_or s38, s[58:59], s99 glc
  s_atomic_or s37, s[58:59], s39 glc
  s_waitcnt lgkmcnt(0)
  s_add_u32 s37, s37, 30
  s_cmp_ge_u32 s38, 30
  s_cselect_b32 s38, s37, s38
  s_cmp_ge_u32 s38, 64
  s_cselect_b32 s38, 100, s38
  s_sub_u32 s38, s38, 1
  s_max_i32 s30, s30, s38
  s_cmp_ge_i32 s14, s30
  s_cbranch_scc1 T_kv_187
  s_branch T_kvb_181
T_slow_182:
  s_nop 7
  v_max3_f32 v100, v16, v17, v18
  v_max3_f32 v100, v100, v19, v20
  v_max3_f32 v100, v100, v21, v22
  v_max3_f32 v100, v100, v23, v112
  v_max3_f32 v100, v100, v113, v114
  v_max_f32 v100, v100, v115
  v_mov_b32 v101, v100
  s_nop 1
  v_permlane32_swap_b32 v100, v101
  s_nop 1
  v_max_f32 v100, v100, v101
  v_mov_b32 v101, v100
  s_nop 1
  v_permlane16_swap_b32 v100, v101
  s_nop 1
  v_max_f32 v100, v100, v101
  v_sub_f32 v16, v16, v100
  v_sub_f32 v17, v17, v100
  v_sub_f32 v18, v18, v100
  v_sub_f32 v19, v19, v100
  v_exp_f32 v16, v16
  v_exp_f32 v17, v17
  v_exp_f32 v18, v18
  v_exp_f32 v19, v19
  v_sub_f32 v20, v20, v100
  v_sub_f32 v21, v21, v100
  v_sub_f32 v22, v22, v100
  v_sub_f32 v23, v23, v100
  v_exp_f32 v20, v20
  v_exp_f32 v21, v21
  v_exp_f32 v22, v22
  v_exp_f32 v23, v23
  v_sub_f32 v112, v112, v100
  v_sub_f32 v113, v113, v100
  v_sub_f32 v114, v114, v100
  v_sub_f32 v115, v115, v100
  v_exp_f32 v112, v112
  v_exp_f32 v113, v113
  v_exp_f32 v114, v114
  v_exp_f32 v115, v115
  s_nop 0
  v_cvt_pk_bf16_f32 v44, v16, v17
  v_cvt_pk_bf16_f32 v45, v18, v19
  v_cvt_pk_bf16_f32 v46, v20, v21
  v_cvt_pk_bf16_f32 v47, v22, v23
  v_cvt_pk_bf16_f32 v84, v112, v113
  v_cvt_pk_bf16_f32 v85, v114, v115
  v_cndmask_b32 v48, v84, 0, s[16:17]
  v_cndmask_b32 v49, v85, 0, s[16:17]
  v_cndmask_b32 v50, 0, v84, s[16:17]
  v_cndmask_b32 v51, 0, v85, s[16:17]
  s_nop 1
  v_mfma_f32_16x16x16_bf16 v[88:91], v[12:13], v[48:49], 0
  v_mfma_f32_16x16x16_bf16 v[24:27], v[120:121], v[48:49], 0
  v_mfma_f32_16x16x16_bf16 v[116:119], v[120:121], v[50:51], 0
  v_mfma_f32_16x16x32_bf16 v[88:91], v[12:15], v[44:47], v[88:91]
  v_mfma_f32_16x16x32_bf16 v[24:27], v[28:31], v[44:47], v[24:27]
  v_mfma_f32_16x16x32_bf16 v[116:119], v[32:35], v[44:47], v[116:119]
  s_nop 7
  s_nop 1
  v_rcp_f32 v89, v88
  s_nop 0
  v_mul_f32 v24, v89, v24
  v_mul_f32 v25, v89, v25
  s_branch T_back_183
M_tdone:
  v_mov_b32 v16, 64
  v_or_b32 v17, s13, v2
  v_min_u32 v17, 1, v17
  v_lshlrev_b32 v17, 30, v17
  s_waitcnt vmcnt(0)
  s_barrier
  buffer_store_dword v16, v17, s[4:7], s15 offen sc1
M_done:
M_exit:
  s_endpgm
.p2align 6
.type M_table,@object
M_table:
.long 0x1, 0x3f, 0xffffffff, 0x17, 0x1, 0x7, 0x800, 0x0, 0x8, 0x0, 0x0, 0x0, 0x0, 0x0, 0x0, 0x0
.long 0x1, 0x28, 0xffffffff, 0x1b, 0x1, 0x6, 0x1000, 0x0, 0x8, 0x1, 0x0, 0x0, 0x0, 0x0, 0x0, 0x0
.long 0x2, 0x0, 0x1, 0x1e, 0x1, 0x5, 0x1800, 0x0, 0x8, 0x0, 0x0, 0x0, 0x0, 0x0, 0x0, 0x0
.long 0x2, 0x1e, 0x1, 0x22, 0x1, 0x4, 0x2000, 0x0, 0x8, 0x1, 0x0, 0x0, 0x0, 0x0, 0x0, 0x0
.long 0x0, 0x0, 0x1, 0x20, 0x2, 0x3, 0x20, 0x0, 0x8, 0x2, 0x0, 0x0, 0x0, 0x0, 0x0, 0x0
.long 0x0, 0x3f, 0xffffffff, 0x20, 0x2, 0x2, 0x18, 0x1, 0x10, 0x0, 0x0, 0x0, 0x0, 0x0, 0x0, 0x0
.long 0x1, 0xd, 0xffffffff, 0xe, 0x0, 0x0, 0x8, 0x0, 0x8, 0x2, 0x0, 0x0, 0x0, 0x0, 0x0, 0x0
.size M_table, 448
.section .rodata,"a"
.p2align 6
.amdhsa_kernel gated_mix__compressed_kv_cla__memory_aug_recurrent_mem_tr__prompt_kernel
.amdhsa_next_free_vgpr 512
.amdhsa_next_free_sgpr 102
.amdhsa_accum_offset 256
.amdhsa_group_segment_fixed_size 0
.amdhsa_kernarg_size 136
.amdhsa_user_sgpr_count 2
.amdhsa_user_sgpr_kernarg_segment_ptr 1
.amdhsa_system_sgpr_workgroup_id_x 1
.end_amdhsa_kernel
```

```asm
; @launch grid=(256,1,1) block=(256,1,1) lds=163840
.amdgcn_target "amdgcn-amd-amdhsa--gfx950"
.text
.globl gated_mix__compressed_kv_cla__memory_aug_recurrent_mem_tr__prompt_kernel
.p2align 8
.type gated_mix__compressed_kv_cla__memory_aug_recurrent_mem_tr__prompt_kernel,@function
gated_mix__compressed_kv_cla__memory_aug_recurrent_mem_tr__prompt_kernel:
  s_cmp_ge_u32 s2, 256
  s_cbranch_scc1 M_exit
  s_load_dwordx4 s[72:75], s[0:1], 120
  v_lshrrev_b32 v3, 6, v0
  v_and_b32 v1, 63, v0
  v_readfirstlane_b32 s16, v3
  v_lshlrev_b32 v2, 4, v1
  s_and_b32 s76, s2, 7
  s_lshr_b32 s77, s2, 3
  s_sub_u32 s66, s76, 1
  s_and_b32 s66, s66, 7
  s_lshl_b32 s66, s66, 5
  s_add_u32 s66, s66, s77
  s_lshl_b32 s31, s66, 7
  s_add_u32 s31, s31, 148897792
  s_waitcnt lgkmcnt(0)
  s_mov_b64 s[4:5], s[74:75]
  s_mov_b64 s[74:75], s[72:73]
  s_mov_b64 s[72:73], s[4:5]
  s_and_b32 s5, s5, 0xffff
  s_mov_b32 s6, 268435456
  s_mov_b32 s7, 0x20000
  s_cmp_eq_u32 s76, 0
  s_cbranch_scc1 M_team
  s_mul_i32 s64, s66, 9363
  s_lshr_b32 s64, s64, 16
  s_mul_i32 s67, s64, 7
  s_sub_u32 s65, s66, s67
  s_lshl_b32 s67, s67, 7
  s_add_u32 s67, s67, 148897792
  s_getpc_b64 s[76:77]
M_pc:
  s_add_u32 s76, s76, M_table-M_pc
  s_addc_u32 s77, s77, 0
  s_lshl_b32 s26, s65, 6
  s_load_dwordx16 s[48:63], s[76:77], s26
  s_waitcnt lgkmcnt(0)
  s_mov_b32 s23, s51
  s_cmp_lg_u32 s48, 1
  s_cbranch_scc1 M_nobpf
  s_load_dwordx8 s[36:43], s[0:1], 64
  s_mul_i32 s76, s64, 3
  s_add_u32 s76, s76, s57
  v_lshlrev_b32 v4, 7, v0
  s_mov_b32 s10, 4194304
  s_mov_b32 s11, 0x20000
  s_waitcnt lgkmcnt(0)
  s_mov_b32 s8, s42
  s_and_b32 s9, s43, 0xffff
  s_mul_i32 s77, s76, 43776
  s_add_u32 s77, s77, 0
  v_min_u32 v5, 32640, v4
  v_add_u32 v5, s77, v5
  s_add_u32 s77, s77, 32768
  buffer_load_dword v6, v5, s[8:11], 0 offen
  v_min_u32 v5, 10880, v4
  v_add_u32 v5, s77, v5
  s_add_u32 s77, s77, 32768
  buffer_load_dword v6, v5, s[8:11], 0 offen
  s_mov_b32 s8, s38
  s_and_b32 s9, s39, 0xffff
  s_mul_i32 s77, s76, 21888
  s_add_u32 s77, s77, 2097152
  v_min_u32 v5, 21760, v4
  v_add_u32 v5, s77, v5
  s_add_u32 s77, s77, 32768
  buffer_load_dword v6, v5, s[8:11], 0 offen
  s_mov_b32 s8, s40
  s_and_b32 s9, s41, 0xffff
  s_mul_i32 s77, s76, 21888
  s_add_u32 s77, s77, 2097152
  v_min_u32 v5, 21760, v4
  v_add_u32 v5, s77, v5
  s_add_u32 s77, s77, 32768
  buffer_load_dword v6, v5, s[8:11], 0 offen
  s_mov_b32 s8, s36
  s_and_b32 s9, s37, 0xffff
  s_mul_i32 s77, s76, 21888
  s_add_u32 s77, s77, 2097152
  v_min_u32 v5, 21760, v4
  v_add_u32 v5, s77, v5
  s_add_u32 s77, s77, 32768
  buffer_load_dword v6, v5, s[8:11], 0 offen
  s_waitcnt vmcnt(0)
M_nobpf:
  s_lshr_b32 s29, s16, 1
  s_cmp_eq_u32 s29, 0
  s_cselect_b32 s26, 2, 8
  s_cselect_b32 s27, 3, 4
  s_cselect_b32 s28, 9, 10
  s_cmp_eq_u32 s48, 1
  s_cselect_b32 s26, s27, s26
  s_cmp_eq_u32 s48, 2
  s_cselect_b32 s26, s28, s26
  s_lshl_b32 s26, s26, 3
  s_load_dwordx2 s[8:9], s[0:1], s26
  s_cmp_eq_u32 s48, 1
  s_cselect_b32 s26, 8, 0
  s_load_dwordx2 s[12:13], s[0:1], s26
  s_cmp_eq_u32 s29, 0
  s_cselect_b32 s21, 0, 3
  s_cselect_b32 s27, 1, 2
  s_cselect_b32 s28, 4, 5
  s_cmp_eq_u32 s48, 1
  s_cselect_b32 s21, s27, s21
  s_cmp_eq_u32 s48, 2
  s_cselect_b32 s21, s28, s21
  s_lshl_b32 s21, s21, 5
  s_add_u32 s21, s21, s64
  s_lshl_b32 s21, s21, 6
  s_add_u32 s21, s21, s49
  s_and_b32 s27, s16, 1
  s_lshl_b32 s21, s21, 1
  s_add_u32 s21, s21, s27
  s_lshl_b32 s21, s21, 12
  s_lshl_b32 s22, s50, 13
  s_lshl_b32 s19, s49, 15
  s_lshl_b32 s20, s50, 15
  s_lshl_b32 s17, s64, 1
  s_add_u32 s17, s17, s27
  s_lshl_b32 s17, s17, 7
  s_mov_b32 s18, 8192
  s_cmp_eq_u32 s48, 0
  s_cselect_b32 s24, 0x3e0293ee, 1.0
  s_waitcnt lgkmcnt(0)
  s_and_b32 s9, s9, 0xffff
  s_mov_b32 s10, 4194304
  s_mov_b32 s11, 0x20000
  s_and_b32 s13, s13, 0xffff
  s_mov_b32 s14, 2097152
  s_mov_b32 s15, 0x20000
  v_and_b32 v144, 31, v1
  v_lshrrev_b32 v145, 5, v1
  v_and_b32 v146, 15, v1
  v_or_b32 v147, 0, v145
  v_xor_b32 v147, v147, v146
  v_lshlrev_b32 v147, 4, v147
  v_lshl_add_u32 v8, v144, 8, v147
  v_or_b32 v147, 2, v145
  v_xor_b32 v147, v147, v146
  v_lshlrev_b32 v147, 4, v147
  v_lshl_add_u32 v9, v144, 8, v147
  v_or_b32 v147, 4, v145
  v_xor_b32 v147, v147, v146
  v_lshlrev_b32 v147, 4, v147
  v_lshl_add_u32 v10, v144, 8, v147
  v_or_b32 v147, 6, v145
  v_xor_b32 v147, v147, v146
  v_lshlrev_b32 v147, 4, v147
  v_lshl_add_u32 v11, v144, 8, v147
  v_or_b32 v147, 8, v145
  v_xor_b32 v147, v147, v146
  v_lshlrev_b32 v147, 4, v147
  v_lshl_add_u32 v12, v144, 8, v147
  v_or_b32 v147, 10, v145
  v_xor_b32 v147, v147, v146
  v_lshlrev_b32 v147, 4, v147
  v_lshl_add_u32 v13, v144, 8, v147
  v_or_b32 v147, 12, v145
  v_xor_b32 v147, v147, v146
  v_lshlrev_b32 v147, 4, v147
  v_lshl_add_u32 v14, v144, 8, v147
  v_or_b32 v147, 14, v145
  v_xor_b32 v147, v147, v146
  v_lshlrev_b32 v147, 4, v147
  v_lshl_add_u32 v15, v144, 8, v147
  v_lshrrev_b32 v144, 4, v1
  s_lshl_b32 s26, s16, 8
  v_add_u32 v145, 0, v144
  v_and_b32 v147, 15, v145
  v_xor_b32 v147, v147, v146
  v_lshlrev_b32 v147, 4, v147
  v_lshl_add_u32 v147, v145, 10, v147
  v_add_u32 v16, s26, v147
  v_add_u32 v145, 4, v144
  v_and_b32 v147, 15, v145
  v_xor_b32 v147, v147, v146
  v_lshlrev_b32 v147, 4, v147
  v_lshl_add_u32 v147, v145, 10, v147
  v_add_u32 v17, s26, v147
  v_add_u32 v145, 8, v144
  v_and_b32 v147, 15, v145
  v_xor_b32 v147, v147, v146
  v_lshlrev_b32 v147, 4, v147
  v_lshl_add_u32 v147, v145, 10, v147
  v_add_u32 v18, s26, v147
  v_add_u32 v145, 12, v144
  v_and_b32 v147, 15, v145
  v_xor_b32 v147, v147, v146
  v_lshlrev_b32 v147, 4, v147
  v_lshl_add_u32 v147, v145, 10, v147
  v_add_u32 v19, s26, v147
  v_add_u32 v145, 16, v144
  v_and_b32 v147, 15, v145
  v_xor_b32 v147, v147, v146
  v_lshlrev_b32 v147, 4, v147
  v_lshl_add_u32 v147, v145, 10, v147
  v_add_u32 v20, s26, v147
  v_add_u32 v145, 20, v144
  v_and_b32 v147, 15, v145
  v_xor_b32 v147, v147, v146
  v_lshlrev_b32 v147, 4, v147
  v_lshl_add_u32 v147, v145, 10, v147
  v_add_u32 v21, s26, v147
  v_add_u32 v145, 24, v144
  v_and_b32 v147, 15, v145
  v_xor_b32 v147, v147, v146
  v_lshlrev_b32 v147, 4, v147
  v_lshl_add_u32 v147, v145, 10, v147
  v_add_u32 v22, s26, v147
  v_add_u32 v145, 28, v144
  v_and_b32 v147, 15, v145
  v_xor_b32 v147, v147, v146
  v_lshlrev_b32 v147, 4, v147
  v_lshl_add_u32 v147, v145, 10, v147
  v_add_u32 v23, s26, v147
  v_lshrrev_b32 v144, 3, v1
  v_mul_lo_u32 v144, v144, s18
  v_and_b32 v145, 7, v1
  v_lshl_add_u32 v144, v145, 4, v144
  s_lshl_b32 s28, s16, 15
  s_add_u32 s28, s28, 32768
  s_lshl_b32 s29, s18, 3
  s_add_u32 m0, s28, 0
  s_nop 0
  buffer_load_dwordx4 v144, s[8:11], s17 offen lds
  s_add_u32 s17, s17, s29
  s_add_u32 m0, s28, 1024
  s_nop 0
  buffer_load_dwordx4 v144, s[8:11], s17 offen lds
  s_add_u32 s17, s17, s29
  s_add_u32 m0, s28, 2048
  s_nop 0
  buffer_load_dwordx4 v144, s[8:11], s17 offen lds
  s_add_u32 s17, s17, s29
  s_add_u32 m0, s28, 3072
  s_nop 0
  buffer_load_dwordx4 v144, s[8:11], s17 offen lds
  s_add_u32 s17, s17, s29
  s_add_u32 m0, s28, 4096
  s_nop 0
  buffer_load_dwordx4 v144, s[8:11], s17 offen lds
  s_add_u32 s17, s17, s29
  s_add_u32 m0, s28, 5120
  s_nop 0
  buffer_load_dwordx4 v144, s[8:11], s17 offen lds
  s_add_u32 s17, s17, s29
  s_add_u32 m0, s28, 6144
  s_nop 0
  buffer_load_dwordx4 v144, s[8:11], s17 offen lds
  s_add_u32 s17, s17, s29
  s_add_u32 m0, s28, 7168
  s_nop 0
  buffer_load_dwordx4 v144, s[8:11], s17 offen lds
  s_add_u32 s17, s17, s29
  s_add_u32 m0, s28, 8192
  s_nop 0
  buffer_load_dwordx4 v144, s[8:11], s17 offen lds
  s_add_u32 s17, s17, s29
  s_add_u32 m0, s28, 9216
  s_nop 0
  buffer_load_dwordx4 v144, s[8:11], s17 offen lds
  s_add_u32 s17, s17, s29
  s_add_u32 m0, s28, 10240
  s_nop 0
  buffer_load_dwordx4 v144, s[8:11], s17 offen lds
  s_add_u32 s17, s17, s29
  s_add_u32 m0, s28, 11264
  s_nop 0
  buffer_load_dwordx4 v144, s[8:11], s17 offen lds
  s_add_u32 s17, s17, s29
  s_add_u32 m0, s28, 12288
  s_nop 0
  buffer_load_dwordx4 v144, s[8:11], s17 offen lds
  s_add_u32 s17, s17, s29
  s_add_u32 m0, s28, 13312
  s_nop 0
  buffer_load_dwordx4 v144, s[8:11], s17 offen lds
  s_add_u32 s17, s17, s29
  s_add_u32 m0, s28, 14336
  s_nop 0
  buffer_load_dwordx4 v144, s[8:11], s17 offen lds
  s_add_u32 s17, s17, s29
  s_add_u32 m0, s28, 15360
  s_nop 0
  buffer_load_dwordx4 v144, s[8:11], s17 offen lds
  s_add_u32 s17, s17, s29
  s_add_u32 m0, s28, 16384
  s_nop 0
  buffer_load_dwordx4 v144, s[8:11], s17 offen lds
  s_add_u32 s17, s17, s29
  s_add_u32 m0, s28, 17408
  s_nop 0
  buffer_load_dwordx4 v144, s[8:11], s17 offen lds
  s_add_u32 s17, s17, s29
  s_add_u32 m0, s28, 18432
  s_nop 0
  buffer_load_dwordx4 v144, s[8:11], s17 offen lds
  s_add_u32 s17, s17, s29
  s_add_u32 m0, s28, 19456
  s_nop 0
  buffer_load_dwordx4 v144, s[8:11], s17 offen lds
  s_add_u32 s17, s17, s29
  s_add_u32 m0, s28, 20480
  s_nop 0
  buffer_load_dwordx4 v144, s[8:11], s17 offen lds
  s_add_u32 s17, s17, s29
  s_add_u32 m0, s28, 21504
  s_nop 0
  buffer_load_dwordx4 v144, s[8:11], s17 offen lds
  s_add_u32 s17, s17, s29
  s_add_u32 m0, s28, 22528
  s_nop 0
  buffer_load_dwordx4 v144, s[8:11], s17 offen lds
  s_add_u32 s17, s17, s29
  s_add_u32 m0, s28, 23552
  s_nop 0
  buffer_load_dwordx4 v144, s[8:11], s17 offen lds
  s_add_u32 s17, s17, s29
  s_add_u32 m0, s28, 24576
  s_nop 0
  buffer_load_dwordx4 v144, s[8:11], s17 offen lds
  s_add_u32 s17, s17, s29
  s_add_u32 m0, s28, 25600
  s_nop 0
  buffer_load_dwordx4 v144, s[8:11], s17 offen lds
  s_add_u32 s17, s17, s29
  s_add_u32 m0, s28, 26624
  s_nop 0
  buffer_load_dwordx4 v144, s[8:11], s17 offen lds
  s_add_u32 s17, s17, s29
  s_add_u32 m0, s28, 27648
  s_nop 0
  buffer_load_dwordx4 v144, s[8:11], s17 offen lds
  s_add_u32 s17, s17, s29
  s_add_u32 m0, s28, 28672
  s_nop 0
  buffer_load_dwordx4 v144, s[8:11], s17 offen lds
  s_add_u32 s17, s17, s29
  s_add_u32 m0, s28, 29696
  s_nop 0
  buffer_load_dwordx4 v144, s[8:11], s17 offen lds
  s_add_u32 s17, s17, s29
  s_add_u32 m0, s28, 30720
  s_nop 0
  buffer_load_dwordx4 v144, s[8:11], s17 offen lds
  s_add_u32 s17, s17, s29
  s_add_u32 m0, s28, 31744
  s_nop 0
  buffer_load_dwordx4 v144, s[8:11], s17 offen lds
  s_add_u32 s17, s17, s29
  s_lshl_b32 s25, s16, 13
  s_add_u32 m0, s25, 0
  s_nop 0
  buffer_load_dwordx4 v16, s[12:15], s19 offen lds
  s_add_u32 m0, s25, 1024
  s_nop 0
  buffer_load_dwordx4 v17, s[12:15], s19 offen lds
  s_add_u32 m0, s25, 2048
  s_nop 0
  buffer_load_dwordx4 v18, s[12:15], s19 offen lds
  s_add_u32 m0, s25, 3072
  s_nop 0
  buffer_load_dwordx4 v19, s[12:15], s19 offen lds
  s_add_u32 m0, s25, 4096
  s_nop 0
  buffer_load_dwordx4 v20, s[12:15], s19 offen lds
  s_add_u32 m0, s25, 5120
  s_nop 0
  buffer_load_dwordx4 v21, s[12:15], s19 offen lds
  s_add_u32 m0, s25, 6144
  s_nop 0
  buffer_load_dwordx4 v22, s[12:15], s19 offen lds
  s_add_u32 m0, s25, 7168
  s_nop 0
  buffer_load_dwordx4 v23, s[12:15], s19 offen lds
  s_cmp_gt_u32 s23, 1
  s_cselect_b32 s26, s20, 0
  s_add_u32 s19, s19, s26
  s_add_u32 s25, s25, 32768
  s_and_b32 s25, s25, 0x1ffff
  s_cmp_lg_u32 s16, 3
  s_cbranch_scc1 M_noinit
  s_mov_b32 s79, 0
  s_atomic_swap s79, s[72:73], s31 glc
  s_waitcnt lgkmcnt(0)
  s_mov_b32 s79, 1
  s_atomic_add s79, s[74:75], 128
M_noinit:
  s_mul_i32 s76, s64, 3
  s_add_u32 s76, s76, s57
  s_mul_i32 s76, s76, 24576
  v_lshlrev_b32 v4, 7, v0
  v_add_u32 v4, s76, v4
  buffer_load_dword v5, v4, s[12:15], 0 offen
  v_bfe_u32 v148, v1, 2, 2
  v_lshrrev_b32 v149, 5, v1
  v_lshl_add_u32 v148, v149, 3, v148
  v_lshlrev_b32 v148, 7, v148
  v_bfe_u32 v149, v1, 4, 1
  v_lshl_add_u32 v148, v149, 5, v148
  v_and_b32 v149, 3, v1
  v_lshl_add_u32 v148, v149, 3, v148
  v_add_u32 v146, s28, v148
  v_add_u32 v147, 512, v146
  s_waitcnt vmcnt(37)
  ds_read_b64_tr_b16 a[0:1], v146 offset:0
  ds_read_b64_tr_b16 a[2:3], v147 offset:0
  ds_read_b64_tr_b16 a[4:5], v146 offset:64
  ds_read_b64_tr_b16 a[6:7], v147 offset:64
  ds_read_b64_tr_b16 a[8:9], v146 offset:2048
  ds_read_b64_tr_b16 a[10:11], v147 offset:2048
  ds_read_b64_tr_b16 a[12:13], v146 offset:2112
  ds_read_b64_tr_b16 a[14:15], v147 offset:2112
  s_waitcnt lgkmcnt(0)
  s_add_u32 m0, s28, 0
  s_nop 0
  buffer_load_dwordx4 v144, s[8:11], s17 offen lds
  s_add_u32 s17, s17, s29
  s_add_u32 m0, s28, 1024
  s_nop 0
  buffer_load_dwordx4 v144, s[8:11], s17 offen lds
  s_add_u32 s17, s17, s29
  s_add_u32 m0, s28, 2048
  s_nop 0
  buffer_load_dwordx4 v144, s[8:11], s17 offen lds
  s_add_u32 s17, s17, s29
  s_add_u32 m0, s28, 3072
  s_nop 0
  buffer_load_dwordx4 v144, s[8:11], s17 offen lds
  s_add_u32 s17, s17, s29
  s_waitcnt vmcnt(37)
  ds_read_b64_tr_b16 a[16:17], v146 offset:4096
  ds_read_b64_tr_b16 a[18:19], v147 offset:4096
  ds_read_b64_tr_b16 a[20:21], v146 offset:4160
  ds_read_b64_tr_b16 a[22:23], v147 offset:4160
  ds_read_b64_tr_b16 a[24:25], v146 offset:6144
  ds_read_b64_tr_b16 a[26:27], v147 offset:6144
  ds_read_b64_tr_b16 a[28:29], v146 offset:6208
  ds_read_b64_tr_b16 a[30:31], v147 offset:6208
  s_waitcnt lgkmcnt(0)
  s_add_u32 m0, s28, 4096
  s_nop 0
  buffer_load_dwordx4 v144, s[8:11], s17 offen lds
  s_add_u32 s17, s17, s29
  s_add_u32 m0, s28, 5120
  s_nop 0
  buffer_load_dwordx4 v144, s[8:11], s17 offen lds
  s_add_u32 s17, s17, s29
  s_add_u32 m0, s28, 6144
  s_nop 0
  buffer_load_dwordx4 v144, s[8:11], s17 offen lds
  s_add_u32 s17, s17, s29
  s_add_u32 m0, s28, 7168
  s_nop 0
  buffer_load_dwordx4 v144, s[8:11], s17 offen lds
  s_add_u32 s17, s17, s29
  s_waitcnt vmcnt(37)
  ds_read_b64_tr_b16 a[32:33], v146 offset:8192
  ds_read_b64_tr_b16 a[34:35], v147 offset:8192
  ds_read_b64_tr_b16 a[36:37], v146 offset:8256
  ds_read_b64_tr_b16 a[38:39], v147 offset:8256
  ds_read_b64_tr_b16 a[40:41], v146 offset:10240
  ds_read_b64_tr_b16 a[42:43], v147 offset:10240
  ds_read_b64_tr_b16 a[44:45], v146 offset:10304
  ds_read_b64_tr_b16 a[46:47], v147 offset:10304
  s_waitcnt lgkmcnt(0)
  s_add_u32 m0, s28, 8192
  s_nop 0
  buffer_load_dwordx4 v144, s[8:11], s17 offen lds
  s_add_u32 s17, s17, s29
  s_add_u32 m0, s28, 9216
  s_nop 0
  buffer_load_dwordx4 v144, s[8:11], s17 offen lds
  s_add_u32 s17, s17, s29
  s_add_u32 m0, s28, 10240
  s_nop 0
  buffer_load_dwordx4 v144, s[8:11], s17 offen lds
  s_add_u32 s17, s17, s29
  s_add_u32 m0, s28, 11264
  s_nop 0
  buffer_load_dwordx4 v144, s[8:11], s17 offen lds
  s_add_u32 s17, s17, s29
  s_waitcnt vmcnt(37)
  ds_read_b64_tr_b16 a[48:49], v146 offset:12288
  ds_read_b64_tr_b16 a[50:51], v147 offset:12288
  ds_read_b64_tr_b16 a[52:53], v146 offset:12352
  ds_read_b64_tr_b16 a[54:55], v147 offset:12352
  ds_read_b64_tr_b16 a[56:57], v146 offset:14336
  ds_read_b64_tr_b16 a[58:59], v147 offset:14336
  ds_read_b64_tr_b16 a[60:61], v146 offset:14400
  ds_read_b64_tr_b16 a[62:63], v147 offset:14400
  s_waitcnt lgkmcnt(0)
  s_add_u32 m0, s28, 12288
  s_nop 0
  buffer_load_dwordx4 v144, s[8:11], s17 offen lds
  s_add_u32 s17, s17, s29
  s_add_u32 m0, s28, 13312
  s_nop 0
  buffer_load_dwordx4 v144, s[8:11], s17 offen lds
  s_add_u32 s17, s17, s29
  s_add_u32 m0, s28, 14336
  s_nop 0
  buffer_load_dwordx4 v144, s[8:11], s17 offen lds
  s_add_u32 s17, s17, s29
  s_add_u32 m0, s28, 15360
  s_nop 0
  buffer_load_dwordx4 v144, s[8:11], s17 offen lds
  s_add_u32 s17, s17, s29
  s_waitcnt vmcnt(37)
  ds_read_b64_tr_b16 a[64:65], v146 offset:16384
  ds_read_b64_tr_b16 a[66:67], v147 offset:16384
  ds_read_b64_tr_b16 a[68:69], v146 offset:16448
  ds_read_b64_tr_b16 a[70:71], v147 offset:16448
  ds_read_b64_tr_b16 a[72:73], v146 offset:18432
  ds_read_b64_tr_b16 a[74:75], v147 offset:18432
  ds_read_b64_tr_b16 a[76:77], v146 offset:18496
  ds_read_b64_tr_b16 a[78:79], v147 offset:18496
  s_waitcnt lgkmcnt(0)
  s_add_u32 m0, s28, 16384
  s_nop 0
  buffer_load_dwordx4 v144, s[8:11], s17 offen lds
  s_add_u32 s17, s17, s29
  s_add_u32 m0, s28, 17408
  s_nop 0
  buffer_load_dwordx4 v144, s[8:11], s17 offen lds
  s_add_u32 s17, s17, s29
  s_add_u32 m0, s28, 18432
  s_nop 0
  buffer_load_dwordx4 v144, s[8:11], s17 offen lds
  s_add_u32 s17, s17, s29
  s_add_u32 m0, s28, 19456
  s_nop 0
  buffer_load_dwordx4 v144, s[8:11], s17 offen lds
  s_add_u32 s17, s17, s29
  s_waitcnt vmcnt(37)
  ds_read_b64_tr_b16 a[80:81], v146 offset:20480
  ds_read_b64_tr_b16 a[82:83], v147 offset:20480
  ds_read_b64_tr_b16 a[84:85], v146 offset:20544
  ds_read_b64_tr_b16 a[86:87], v147 offset:20544
  ds_read_b64_tr_b16 a[88:89], v146 offset:22528
  ds_read_b64_tr_b16 a[90:91], v147 offset:22528
  ds_read_b64_tr_b16 a[92:93], v146 offset:22592
  ds_read_b64_tr_b16 a[94:95], v147 offset:22592
  s_waitcnt lgkmcnt(0)
  s_add_u32 m0, s28, 20480
  s_nop 0
  buffer_load_dwordx4 v144, s[8:11], s17 offen lds
  s_add_u32 s17, s17, s29
  s_add_u32 m0, s28, 21504
  s_nop 0
  buffer_load_dwordx4 v144, s[8:11], s17 offen lds
  s_add_u32 s17, s17, s29
  s_add_u32 m0, s28, 22528
  s_nop 0
  buffer_load_dwordx4 v144, s[8:11], s17 offen lds
  s_add_u32 s17, s17, s29
  s_add_u32 m0, s28, 23552
  s_nop 0
  buffer_load_dwordx4 v144, s[8:11], s17 offen lds
  s_add_u32 s17, s17, s29
  s_waitcnt vmcnt(37)
  ds_read_b64_tr_b16 a[96:97], v146 offset:24576
  ds_read_b64_tr_b16 a[98:99], v147 offset:24576
  ds_read_b64_tr_b16 a[100:101], v146 offset:24640
  ds_read_b64_tr_b16 a[102:103], v147 offset:24640
  ds_read_b64_tr_b16 a[104:105], v146 offset:26624
  ds_read_b64_tr_b16 a[106:107], v147 offset:26624
  ds_read_b64_tr_b16 a[108:109], v146 offset:26688
  ds_read_b64_tr_b16 a[110:111], v147 offset:26688
  s_waitcnt lgkmcnt(0)
  s_add_u32 m0, s28, 24576
  s_nop 0
  buffer_load_dwordx4 v144, s[8:11], s17 offen lds
  s_add_u32 s17, s17, s29
  s_add_u32 m0, s28, 25600
  s_nop 0
  buffer_load_dwordx4 v144, s[8:11], s17 offen lds
  s_add_u32 s17, s17, s29
  s_add_u32 m0, s28, 26624
  s_nop 0
  buffer_load_dwordx4 v144, s[8:11], s17 offen lds
  s_add_u32 s17, s17, s29
  s_add_u32 m0, s28, 27648
  s_nop 0
  buffer_load_dwordx4 v144, s[8:11], s17 offen lds
  s_add_u32 s17, s17, s29
  s_waitcnt vmcnt(37)
  ds_read_b64_tr_b16 a[112:113], v146 offset:28672
  ds_read_b64_tr_b16 a[114:115], v147 offset:28672
  ds_read_b64_tr_b16 a[116:117], v146 offset:28736
  ds_read_b64_tr_b16 a[118:119], v147 offset:28736
  ds_read_b64_tr_b16 a[120:121], v146 offset:30720
  ds_read_b64_tr_b16 a[122:123], v147 offset:30720
  ds_read_b64_tr_b16 a[124:125], v146 offset:30784
  ds_read_b64_tr_b16 a[126:127], v147 offset:30784
  s_waitcnt lgkmcnt(0)
  s_add_u32 m0, s28, 28672
  s_nop 0
  buffer_load_dwordx4 v144, s[8:11], s17 offen lds
  s_add_u32 s17, s17, s29
  s_add_u32 m0, s28, 29696
  s_nop 0
  buffer_load_dwordx4 v144, s[8:11], s17 offen lds
  s_add_u32 s17, s17, s29
  s_add_u32 m0, s28, 30720
  s_nop 0
  buffer_load_dwordx4 v144, s[8:11], s17 offen lds
  s_add_u32 s17, s17, s29
  s_add_u32 m0, s28, 31744
  s_nop 0
  buffer_load_dwordx4 v144, s[8:11], s17 offen lds
  s_add_u32 s17, s17, s29
  s_waitcnt vmcnt(28)
  ds_read_b64_tr_b16 a[128:129], v146 offset:0
  ds_read_b64_tr_b16 a[130:131], v147 offset:0
  ds_read_b64_tr_b16 a[132:133], v146 offset:64
  ds_read_b64_tr_b16 a[134:135], v147 offset:64
  ds_read_b64_tr_b16 a[136:137], v146 offset:2048
  ds_read_b64_tr_b16 a[138:139], v147 offset:2048
  ds_read_b64_tr_b16 a[140:141], v146 offset:2112
  ds_read_b64_tr_b16 a[142:143], v147 offset:2112
  s_waitcnt lgkmcnt(0)
  s_waitcnt vmcnt(24)
  ds_read_b64_tr_b16 a[144:145], v146 offset:4096
  ds_read_b64_tr_b16 a[146:147], v147 offset:4096
  ds_read_b64_tr_b16 a[148:149], v146 offset:4160
  ds_read_b64_tr_b16 a[150:151], v147 offset:4160
  ds_read_b64_tr_b16 a[152:153], v146 offset:6144
  ds_read_b64_tr_b16 a[154:155], v147 offset:6144
  ds_read_b64_tr_b16 a[156:157], v146 offset:6208
  ds_read_b64_tr_b16 a[158:159], v147 offset:6208
  s_waitcnt lgkmcnt(0)
  s_waitcnt vmcnt(20)
  ds_read_b64_tr_b16 a[160:161], v146 offset:8192
  ds_read_b64_tr_b16 a[162:163], v147 offset:8192
  ds_read_b64_tr_b16 a[164:165], v146 offset:8256
  ds_read_b64_tr_b16 a[166:167], v147 offset:8256
  ds_read_b64_tr_b16 a[168:169], v146 offset:10240
  ds_read_b64_tr_b16 a[170:171], v147 offset:10240
  ds_read_b64_tr_b16 a[172:173], v146 offset:10304
  ds_read_b64_tr_b16 a[174:175], v147 offset:10304
  s_waitcnt lgkmcnt(0)
  s_waitcnt vmcnt(16)
  ds_read_b64_tr_b16 a[176:177], v146 offset:12288
  ds_read_b64_tr_b16 a[178:179], v147 offset:12288
  ds_read_b64_tr_b16 a[180:181], v146 offset:12352
  ds_read_b64_tr_b16 a[182:183], v147 offset:12352
  ds_read_b64_tr_b16 a[184:185], v146 offset:14336
  ds_read_b64_tr_b16 a[186:187], v147 offset:14336
  ds_read_b64_tr_b16 a[188:189], v146 offset:14400
  ds_read_b64_tr_b16 a[190:191], v147 offset:14400
  s_waitcnt lgkmcnt(0)
  s_waitcnt vmcnt(12)
  ds_read_b64_tr_b16 a[192:193], v146 offset:16384
  ds_read_b64_tr_b16 a[194:195], v147 offset:16384
  ds_read_b64_tr_b16 a[196:197], v146 offset:16448
  ds_read_b64_tr_b16 a[198:199], v147 offset:16448
  ds_read_b64_tr_b16 a[200:201], v146 offset:18432
  ds_read_b64_tr_b16 a[202:203], v147 offset:18432
  ds_read_b64_tr_b16 a[204:205], v146 offset:18496
  ds_read_b64_tr_b16 a[206:207], v147 offset:18496
  s_waitcnt lgkmcnt(0)
  s_waitcnt vmcnt(8)
  ds_read_b64_tr_b16 a[208:209], v146 offset:20480
  ds_read_b64_tr_b16 a[210:211], v147 offset:20480
  ds_read_b64_tr_b16 a[212:213], v146 offset:20544
  ds_read_b64_tr_b16 a[214:215], v147 offset:20544
  ds_read_b64_tr_b16 a[216:217], v146 offset:22528
  ds_read_b64_tr_b16 a[218:219], v147 offset:22528
  ds_read_b64_tr_b16 a[220:221], v146 offset:22592
  ds_read_b64_tr_b16 a[222:223], v147 offset:22592
  s_waitcnt lgkmcnt(0)
  s_waitcnt vmcnt(4)
  ds_read_b64_tr_b16 a[224:225], v146 offset:24576
  ds_read_b64_tr_b16 a[226:227], v147 offset:24576
  ds_read_b64_tr_b16 a[228:229], v146 offset:24640
  ds_read_b64_tr_b16 a[230:231], v147 offset:24640
  ds_read_b64_tr_b16 a[232:233], v146 offset:26624
  ds_read_b64_tr_b16 a[234:235], v147 offset:26624
  ds_read_b64_tr_b16 a[236:237], v146 offset:26688
  ds_read_b64_tr_b16 a[238:239], v147 offset:26688
  s_waitcnt lgkmcnt(0)
  s_waitcnt vmcnt(0)
  ds_read_b64_tr_b16 a[240:241], v146 offset:28672
  ds_read_b64_tr_b16 a[242:243], v147 offset:28672
  ds_read_b64_tr_b16 a[244:245], v146 offset:28736
  ds_read_b64_tr_b16 a[246:247], v147 offset:28736
  ds_read_b64_tr_b16 a[248:249], v146 offset:30720
  ds_read_b64_tr_b16 a[250:251], v147 offset:30720
  ds_read_b64_tr_b16 a[252:253], v146 offset:30784
  ds_read_b64_tr_b16 a[254:255], v147 offset:30784
  s_waitcnt lgkmcnt(0)
  s_barrier
  s_add_u32 m0, s25, 0
  s_nop 0
  buffer_load_dwordx4 v16, s[12:15], s19 offen lds
  s_add_u32 m0, s25, 1024
  s_nop 0
  buffer_load_dwordx4 v17, s[12:15], s19 offen lds
  s_add_u32 m0, s25, 2048
  s_nop 0
  buffer_load_dwordx4 v18, s[12:15], s19 offen lds
  s_add_u32 m0, s25, 3072
  s_nop 0
  buffer_load_dwordx4 v19, s[12:15], s19 offen lds
  s_add_u32 m0, s25, 4096
  s_nop 0
  buffer_load_dwordx4 v20, s[12:15], s19 offen lds
  s_add_u32 m0, s25, 5120
  s_nop 0
  buffer_load_dwordx4 v21, s[12:15], s19 offen lds
  s_add_u32 m0, s25, 6144
  s_nop 0
  buffer_load_dwordx4 v22, s[12:15], s19 offen lds
  s_add_u32 m0, s25, 7168
  s_nop 0
  buffer_load_dwordx4 v23, s[12:15], s19 offen lds
  s_cmp_gt_u32 s23, 2
  s_cselect_b32 s26, s20, 0
  s_add_u32 s19, s19, s26
  s_add_u32 s25, s25, 32768
  s_and_b32 s25, s25, 0x1ffff
  s_waitcnt vmcnt(0)
  s_barrier
  s_cmp_eq_u32 s48, 0
  s_cselect_b32 s26, 0, s16
  s_cmp_ge_u32 s26, 2
  s_cbranch_scc1 P_v_1
  s_mov_b32 s27, s21
  v_mov_b32 v7, 0x40000000
  s_mov_b32 s29, -3
  v_min_u32 v145, 1, v0
  v_lshlrev_b32 v145, 30, v145
  ds_read_b128 v[24:27], v8 offset:0
  ds_read_b128 v[28:31], v9 offset:0
  ds_read_b128 v[32:35], v10 offset:0
  ds_read_b128 v[36:39], v11 offset:0
  ds_read_b128 v[40:43], v12 offset:0
  ds_read_b128 v[44:47], v13 offset:0
.p2align 6
G_top_3:
  s_waitcnt lgkmcnt(5)
  v_mfma_f32_32x32x16_bf16 v[64:79], a[0:3], v[24:27], 0
  s_add_u32 m0, s25, 0
  ds_read_b128 v[48:51], v14 offset:0
  v_mfma_f32_32x32x16_bf16 v[80:95], a[4:7], v[24:27], 0
  s_waitcnt lgkmcnt(5)
  buffer_load_dwordx4 v16, s[12:15], s19 offen lds
  v_mfma_f32_32x32x16_bf16 v[64:79], a[8:11], v[28:31], v[64:79]
  ds_read_b128 v[52:55], v15 offset:0
  v_mul_f32 v96, s24, v96
  v_mul_f32 v97, s24, v97
  v_mfma_f32_32x32x16_bf16 v[80:95], a[12:15], v[28:31], v[80:95]
  s_waitcnt lgkmcnt(5)
  v_cvt_pk_bf16_f32 v128, v96, v97
  v_mul_f32 v98, s24, v98
  v_mfma_f32_32x32x16_bf16 v[64:79], a[16:19], v[32:35], v[64:79]
  s_add_u32 m0, s25, 1024
  ds_read_b128 v[24:27], v8 offset:8192
  v_mul_f32 v99, s24, v99
  v_cvt_pk_bf16_f32 v129, v98, v99
  v_mfma_f32_32x32x16_bf16 v[80:95], a[20:23], v[32:35], v[80:95]
  s_waitcnt lgkmcnt(5)
  buffer_load_dwordx4 v17, s[12:15], s19 offen lds
  v_mul_f32 v100, s24, v100
  v_mul_f32 v101, s24, v101
  v_mfma_f32_32x32x16_bf16 v[64:79], a[24:27], v[36:39], v[64:79]
  ds_read_b128 v[28:31], v9 offset:8192
  v_cvt_pk_bf16_f32 v130, v100, v101
  v_mul_f32 v102, s24, v102
  v_mfma_f32_32x32x16_bf16 v[80:95], a[28:31], v[36:39], v[80:95]
  s_waitcnt lgkmcnt(5)
  v_mul_f32 v103, s24, v103
  v_cvt_pk_bf16_f32 v131, v102, v103
  v_mfma_f32_32x32x16_bf16 v[64:79], a[32:35], v[40:43], v[64:79]
  s_add_u32 m0, s25, 2048
  ds_read_b128 v[32:35], v10 offset:8192
  v_mul_f32 v104, s24, v104
  v_mul_f32 v105, s24, v105
  v_mfma_f32_32x32x16_bf16 v[80:95], a[36:39], v[40:43], v[80:95]
  s_waitcnt lgkmcnt(5)
  buffer_load_dwordx4 v18, s[12:15], s19 offen lds
  v_cvt_pk_bf16_f32 v132, v104, v105
  v_mul_f32 v106, s24, v106
  v_mfma_f32_32x32x16_bf16 v[64:79], a[40:43], v[44:47], v[64:79]
  ds_read_b128 v[36:39], v11 offset:8192
  v_mul_f32 v107, s24, v107
  v_cvt_pk_bf16_f32 v133, v106, v107
  v_mfma_f32_32x32x16_bf16 v[80:95], a[44:47], v[44:47], v[80:95]
  s_waitcnt lgkmcnt(5)
  v_mul_f32 v108, s24, v108
  v_mul_f32 v109, s24, v109
  v_mfma_f32_32x32x16_bf16 v[64:79], a[48:51], v[48:51], v[64:79]
  s_add_u32 m0, s25, 3072
  ds_read_b128 v[40:43], v12 offset:8192
  v_cvt_pk_bf16_f32 v134, v108, v109
  v_mul_f32 v110, s24, v110
  v_mfma_f32_32x32x16_bf16 v[80:95], a[52:55], v[48:51], v[80:95]
  s_waitcnt lgkmcnt(5)
  buffer_load_dwordx4 v19, s[12:15], s19 offen lds
  v_mul_f32 v111, s24, v111
  v_cvt_pk_bf16_f32 v135, v110, v111
  v_mfma_f32_32x32x16_bf16 v[64:79], a[56:59], v[52:55], v[64:79]
  ds_read_b128 v[44:47], v13 offset:8192
  v_mul_f32 v112, s24, v112
  v_mul_f32 v113, s24, v113
  v_mfma_f32_32x32x16_bf16 v[80:95], a[60:63], v[52:55], v[80:95]
  s_waitcnt lgkmcnt(5)
  v_cvt_pk_bf16_f32 v136, v112, v113
  v_mul_f32 v114, s24, v114
  v_mfma_f32_32x32x16_bf16 v[64:79], a[64:67], v[24:27], v[64:79]
  s_add_u32 m0, s25, 4096
  ds_read_b128 v[48:51], v14 offset:8192
  v_mul_f32 v115, s24, v115
  v_cvt_pk_bf16_f32 v137, v114, v115
  v_mfma_f32_32x32x16_bf16 v[80:95], a[68:71], v[24:27], v[80:95]
  s_waitcnt lgkmcnt(5)
  buffer_load_dwordx4 v20, s[12:15], s19 offen lds
  v_mul_f32 v116, s24, v116
  v_mul_f32 v117, s24, v117
  v_mfma_f32_32x32x16_bf16 v[64:79], a[72:75], v[28:31], v[64:79]
  ds_read_b128 v[52:55], v15 offset:8192
  v_cvt_pk_bf16_f32 v138, v116, v117
  v_mul_f32 v118, s24, v118
  v_mfma_f32_32x32x16_bf16 v[80:95], a[76:79], v[28:31], v[80:95]
  s_waitcnt lgkmcnt(5)
  v_mul_f32 v119, s24, v119
  v_cvt_pk_bf16_f32 v139, v118, v119
  v_mfma_f32_32x32x16_bf16 v[64:79], a[80:83], v[32:35], v[64:79]
  s_add_u32 m0, s25, 5120
  ds_read_b128 v[24:27], v8 offset:16384
  v_mul_f32 v120, s24, v120
  v_mul_f32 v121, s24, v121
  v_mfma_f32_32x32x16_bf16 v[80:95], a[84:87], v[32:35], v[80:95]
  s_waitcnt lgkmcnt(5)
  buffer_load_dwordx4 v21, s[12:15], s19 offen lds
  v_cvt_pk_bf16_f32 v140, v120, v121
  v_mul_f32 v122, s24, v122
  v_mfma_f32_32x32x16_bf16 v[64:79], a[88:91], v[36:39], v[64:79]
  ds_read_b128 v[28:31], v9 offset:16384
  v_mul_f32 v123, s24, v123
  v_cvt_pk_bf16_f32 v141, v122, v123
  v_mfma_f32_32x32x16_bf16 v[80:95], a[92:95], v[36:39], v[80:95]
  s_waitcnt lgkmcnt(5)
  v_mul_f32 v124, s24, v124
  v_mul_f32 v125, s24, v125
  v_mfma_f32_32x32x16_bf16 v[64:79], a[96:99], v[40:43], v[64:79]
  s_add_u32 m0, s25, 6144
  ds_read_b128 v[32:35], v10 offset:16384
  v_cvt_pk_bf16_f32 v142, v124, v125
  v_mul_f32 v126, s24, v126
  v_mfma_f32_32x32x16_bf16 v[80:95], a[100:103], v[40:43], v[80:95]
  s_waitcnt lgkmcnt(5)
  buffer_load_dwordx4 v22, s[12:15], s19 offen lds
  v_mul_f32 v127, s24, v127
  v_cvt_pk_bf16_f32 v143, v126, v127
  v_mfma_f32_32x32x16_bf16 v[64:79], a[104:107], v[44:47], v[64:79]
  ds_read_b128 v[36:39], v11 offset:16384
  v_mfma_f32_32x32x16_bf16 v[80:95], a[108:111], v[44:47], v[80:95]
  s_waitcnt lgkmcnt(5)
  v_mfma_f32_32x32x16_bf16 v[64:79], a[112:115], v[48:51], v[64:79]
  s_add_u32 m0, s25, 7168
  ds_read_b128 v[40:43], v12 offset:16384
  v_mfma_f32_32x32x16_bf16 v[80:95], a[116:119], v[48:51], v[80:95]
  s_waitcnt lgkmcnt(5)
  buffer_load_dwordx4 v23, s[12:15], s19 offen lds
  v_mfma_f32_32x32x16_bf16 v[64:79], a[120:123], v[52:55], v[64:79]
  s_cmp_gt_u32 s23, 3
  ds_read_b128 v[44:47], v13 offset:16384
  v_mfma_f32_32x32x16_bf16 v[80:95], a[124:127], v[52:55], v[80:95]
  s_waitcnt lgkmcnt(5)
  s_cselect_b32 s26, s20, 0
  v_mfma_f32_32x32x16_bf16 v[64:79], a[128:131], v[24:27], v[64:79]
  s_add_u32 s19, s19, s26
  ds_read_b128 v[48:51], v14 offset:16384
  v_mfma_f32_32x32x16_bf16 v[80:95], a[132:135], v[24:27], v[80:95]
  s_waitcnt lgkmcnt(5)
  s_add_u32 s25, s25, 32768
  v_mfma_f32_32x32x16_bf16 v[64:79], a[136:139], v[28:31], v[64:79]
  s_and_b32 s25, s25, 0x1ffff
  ds_read_b128 v[52:55], v15 offset:16384
  v_mfma_f32_32x32x16_bf16 v[80:95], a[140:143], v[28:31], v[80:95]
  s_waitcnt lgkmcnt(5)
  buffer_store_dwordx4 v[128:131], v7, s[4:7], s21 offen offset:0 sc1
  v_mfma_f32_32x32x16_bf16 v[64:79], a[144:147], v[32:35], v[64:79]
  ds_read_b128 v[24:27], v8 offset:24576
  v_mfma_f32_32x32x16_bf16 v[80:95], a[148:151], v[32:35], v[80:95]
  s_waitcnt lgkmcnt(5)
  v_mfma_f32_32x32x16_bf16 v[64:79], a[152:155], v[36:39], v[64:79]
  ds_read_b128 v[28:31], v9 offset:24576
  v_mfma_f32_32x32x16_bf16 v[80:95], a[156:159], v[36:39], v[80:95]
  s_waitcnt lgkmcnt(5)
  buffer_store_dwordx4 v[132:135], v7, s[4:7], s21 offen offset:1024 sc1
  v_mfma_f32_32x32x16_bf16 v[64:79], a[160:163], v[40:43], v[64:79]
  ds_read_b128 v[32:35], v10 offset:24576
  v_mfma_f32_32x32x16_bf16 v[80:95], a[164:167], v[40:43], v[80:95]
  s_waitcnt lgkmcnt(5)
  v_mfma_f32_32x32x16_bf16 v[64:79], a[168:171], v[44:47], v[64:79]
  ds_read_b128 v[36:39], v11 offset:24576
  v_mfma_f32_32x32x16_bf16 v[80:95], a[172:175], v[44:47], v[80:95]
  s_waitcnt lgkmcnt(5)
  buffer_store_dwordx4 v[136:139], v7, s[4:7], s21 offen offset:2048 sc1
  v_mfma_f32_32x32x16_bf16 v[64:79], a[176:179], v[48:51], v[64:79]
  ds_read_b128 v[40:43], v12 offset:24576
  v_mfma_f32_32x32x16_bf16 v[80:95], a[180:183], v[48:51], v[80:95]
  s_waitcnt lgkmcnt(5)
  v_mfma_f32_32x32x16_bf16 v[64:79], a[184:187], v[52:55], v[64:79]
  ds_read_b128 v[44:47], v13 offset:24576
  v_mfma_f32_32x32x16_bf16 v[80:95], a[188:191], v[52:55], v[80:95]
  s_waitcnt lgkmcnt(5)
  buffer_store_dwordx4 v[140:143], v7, s[4:7], s21 offen offset:3072 sc1
  v_mfma_f32_32x32x16_bf16 v[64:79], a[192:195], v[24:27], v[64:79]
  s_mov_b32 s21, s27
  ds_read_b128 v[48:51], v14 offset:24576
  v_mov_b32 v7, v2
  v_mfma_f32_32x32x16_bf16 v[80:95], a[196:199], v[24:27], v[80:95]
  s_waitcnt lgkmcnt(5)
  v_mfma_f32_32x32x16_bf16 v[64:79], a[200:203], v[28:31], v[64:79]
  s_add_u32 s27, s27, s22
  ds_read_b128 v[52:55], v15 offset:24576
  v_mfma_f32_32x32x16_bf16 v[80:95], a[204:207], v[28:31], v[80:95]
  s_waitcnt lgkmcnt(5)
  s_waitcnt vmcnt(17)
  s_barrier
  v_mfma_f32_32x32x16_bf16 v[64:79], a[208:211], v[32:35], v[64:79]
  ds_read_b128 v[24:27], v8 offset:32768
  v_mfma_f32_32x32x16_bf16 v[80:95], a[212:215], v[32:35], v[80:95]
  s_waitcnt lgkmcnt(5)
  v_mfma_f32_32x32x16_bf16 v[64:79], a[216:219], v[36:39], v[64:79]
  s_add_u32 s29, s29, 1
  ds_read_b128 v[28:31], v9 offset:32768
  v_mfma_f32_32x32x16_bf16 v[80:95], a[220:223], v[36:39], v[80:95]
  s_waitcnt lgkmcnt(5)
  s_max_i32 s30, s29, 0
  v_mov_b32 v144, s30
  v_mfma_f32_32x32x16_bf16 v[64:79], a[224:227], v[40:43], v[64:79]
  ds_read_b128 v[32:35], v10 offset:32768
  v_mfma_f32_32x32x16_bf16 v[80:95], a[228:231], v[40:43], v[80:95]
  s_waitcnt lgkmcnt(5)
  buffer_store_dword v144, v145, s[4:7], s31 offen sc1
  v_mfma_f32_32x32x16_bf16 v[64:79], a[232:235], v[44:47], v[64:79]
  ds_read_b128 v[36:39], v11 offset:32768
  v_mfma_f32_32x32x16_bf16 v[80:95], a[236:239], v[44:47], v[80:95]
  s_waitcnt lgkmcnt(5)
  v_mfma_f32_32x32x16_bf16 v[64:79], a[240:243], v[48:51], v[64:79]
  s_sub_u32 s23, s23, 1
  ds_read_b128 v[40:43], v12 offset:32768
  v_mfma_f32_32x32x16_bf16 v[80:95], a[244:247], v[48:51], v[80:95]
  s_waitcnt lgkmcnt(5)
  v_mfma_f32_32x32x16_bf16 v[64:79], a[248:251], v[52:55], v[64:79]
  s_cmp_eq_u32 s23, 0
  ds_read_b128 v[44:47], v13 offset:32768
  v_mfma_f32_32x32x16_bf16 v[80:95], a[252:255], v[52:55], v[80:95]
  s_cbranch_scc1 G_done0_4
  s_waitcnt lgkmcnt(5)
  v_mfma_f32_32x32x16_bf16 v[96:111], a[0:3], v[24:27], 0
  s_add_u32 m0, s25, 0
  ds_read_b128 v[48:51], v14 offset:32768
  v_mfma_f32_32x32x16_bf16 v[112:127], a[4:7], v[24:27], 0
  s_waitcnt lgkmcnt(5)
  buffer_load_dwordx4 v16, s[12:15], s19 offen lds
  v_mfma_f32_32x32x16_bf16 v[96:111], a[8:11], v[28:31], v[96:111]
  ds_read_b128 v[52:55], v15 offset:32768
  v_mul_f32 v64, s24, v64
  v_mul_f32 v65, s24, v65
  v_mfma_f32_32x32x16_bf16 v[112:127], a[12:15], v[28:31], v[112:127]
  s_waitcnt lgkmcnt(5)
  v_cvt_pk_bf16_f32 v128, v64, v65
  v_mul_f32 v66, s24, v66
  v_mfma_f32_32x32x16_bf16 v[96:111], a[16:19], v[32:35], v[96:111]
  s_add_u32 m0, s25, 1024
  ds_read_b128 v[24:27], v8 offset:40960
  v_mul_f32 v67, s24, v67
  v_cvt_pk_bf16_f32 v129, v66, v67
  v_mfma_f32_32x32x16_bf16 v[112:127], a[20:23], v[32:35], v[112:127]
  s_waitcnt lgkmcnt(5)
  buffer_load_dwordx4 v17, s[12:15], s19 offen lds
  v_mul_f32 v68, s24, v68
  v_mul_f32 v69, s24, v69
  v_mfma_f32_32x32x16_bf16 v[96:111], a[24:27], v[36:39], v[96:111]
  ds_read_b128 v[28:31], v9 offset:40960
  v_cvt_pk_bf16_f32 v130, v68, v69
  v_mul_f32 v70, s24, v70
  v_mfma_f32_32x32x16_bf16 v[112:127], a[28:31], v[36:39], v[112:127]
  s_waitcnt lgkmcnt(5)
  v_mul_f32 v71, s24, v71
  v_cvt_pk_bf16_f32 v131, v70, v71
  v_mfma_f32_32x32x16_bf16 v[96:111], a[32:35], v[40:43], v[96:111]
  s_add_u32 m0, s25, 2048
  ds_read_b128 v[32:35], v10 offset:40960
  v_mul_f32 v72, s24, v72
  v_mul_f32 v73, s24, v73
  v_mfma_f32_32x32x16_bf16 v[112:127], a[36:39], v[40:43], v[112:127]
  s_waitcnt lgkmcnt(5)
  buffer_load_dwordx4 v18, s[12:15], s19 offen lds
  v_cvt_pk_bf16_f32 v132, v72, v73
  v_mul_f32 v74, s24, v74
  v_mfma_f32_32x32x16_bf16 v[96:111], a[40:43], v[44:47], v[96:111]
  ds_read_b128 v[36:39], v11 offset:40960
  v_mul_f32 v75, s24, v75
  v_cvt_pk_bf16_f32 v133, v74, v75
  v_mfma_f32_32x32x16_bf16 v[112:127], a[44:47], v[44:47], v[112:127]
  s_waitcnt lgkmcnt(5)
  v_mul_f32 v76, s24, v76
  v_mul_f32 v77, s24, v77
  v_mfma_f32_32x32x16_bf16 v[96:111], a[48:51], v[48:51], v[96:111]
  s_add_u32 m0, s25, 3072
  ds_read_b128 v[40:43], v12 offset:40960
  v_cvt_pk_bf16_f32 v134, v76, v77
  v_mul_f32 v78, s24, v78
  v_mfma_f32_32x32x16_bf16 v[112:127], a[52:55], v[48:51], v[112:127]
  s_waitcnt lgkmcnt(5)
  buffer_load_dwordx4 v19, s[12:15], s19 offen lds
  v_mul_f32 v79, s24, v79
  v_cvt_pk_bf16_f32 v135, v78, v79
  v_mfma_f32_32x32x16_bf16 v[96:111], a[56:59], v[52:55], v[96:111]
  ds_read_b128 v[44:47], v13 offset:40960
  v_mul_f32 v80, s24, v80
  v_mul_f32 v81, s24, v81
  v_mfma_f32_32x32x16_bf16 v[112:127], a[60:63], v[52:55], v[112:127]
  s_waitcnt lgkmcnt(5)
  v_cvt_pk_bf16_f32 v136, v80, v81
  v_mul_f32 v82, s24, v82
  v_mfma_f32_32x32x16_bf16 v[96:111], a[64:67], v[24:27], v[96:111]
  s_add_u32 m0, s25, 4096
  ds_read_b128 v[48:51], v14 offset:40960
  v_mul_f32 v83, s24, v83
  v_cvt_pk_bf16_f32 v137, v82, v83
  v_mfma_f32_32x32x16_bf16 v[112:127], a[68:71], v[24:27], v[112:127]
  s_waitcnt lgkmcnt(5)
  buffer_load_dwordx4 v20, s[12:15], s19 offen lds
  v_mul_f32 v84, s24, v84
  v_mul_f32 v85, s24, v85
  v_mfma_f32_32x32x16_bf16 v[96:111], a[72:75], v[28:31], v[96:111]
  ds_read_b128 v[52:55], v15 offset:40960
  v_cvt_pk_bf16_f32 v138, v84, v85
  v_mul_f32 v86, s24, v86
  v_mfma_f32_32x32x16_bf16 v[112:127], a[76:79], v[28:31], v[112:127]
  s_waitcnt lgkmcnt(5)
  v_mul_f32 v87, s24, v87
  v_cvt_pk_bf16_f32 v139, v86, v87
  v_mfma_f32_32x32x16_bf16 v[96:111], a[80:83], v[32:35], v[96:111]
  s_add_u32 m0, s25, 5120
  ds_read_b128 v[24:27], v8 offset:49152
  v_mul_f32 v88, s24, v88
  v_mul_f32 v89, s24, v89
  v_mfma_f32_32x32x16_bf16 v[112:127], a[84:87], v[32:35], v[112:127]
  s_waitcnt lgkmcnt(5)
  buffer_load_dwordx4 v21, s[12:15], s19 offen lds
  v_cvt_pk_bf16_f32 v140, v88, v89
  v_mul_f32 v90, s24, v90
  v_mfma_f32_32x32x16_bf16 v[96:111], a[88:91], v[36:39], v[96:111]
  ds_read_b128 v[28:31], v9 offset:49152
  v_mul_f32 v91, s24, v91
  v_cvt_pk_bf16_f32 v141, v90, v91
  v_mfma_f32_32x32x16_bf16 v[112:127], a[92:95], v[36:39], v[112:127]
  s_waitcnt lgkmcnt(5)
  v_mul_f32 v92, s24, v92
  v_mul_f32 v93, s24, v93
  v_mfma_f32_32x32x16_bf16 v[96:111], a[96:99], v[40:43], v[96:111]
  s_add_u32 m0, s25, 6144
  ds_read_b128 v[32:35], v10 offset:49152
  v_cvt_pk_bf16_f32 v142, v92, v93
  v_mul_f32 v94, s24, v94
  v_mfma_f32_32x32x16_bf16 v[112:127], a[100:103], v[40:43], v[112:127]
  s_waitcnt lgkmcnt(5)
  buffer_load_dwordx4 v22, s[12:15], s19 offen lds
  v_mul_f32 v95, s24, v95
  v_cvt_pk_bf16_f32 v143, v94, v95
  v_mfma_f32_32x32x16_bf16 v[96:111], a[104:107], v[44:47], v[96:111]
  ds_read_b128 v[36:39], v11 offset:49152
  v_mfma_f32_32x32x16_bf16 v[112:127], a[108:111], v[44:47], v[112:127]
  s_waitcnt lgkmcnt(5)
  v_mfma_f32_32x32x16_bf16 v[96:111], a[112:115], v[48:51], v[96:111]
  s_add_u32 m0, s25, 7168
  ds_read_b128 v[40:43], v12 offset:49152
  v_mfma_f32_32x32x16_bf16 v[112:127], a[116:119], v[48:51], v[112:127]
  s_waitcnt lgkmcnt(5)
  buffer_load_dwordx4 v23, s[12:15], s19 offen lds
  v_mfma_f32_32x32x16_bf16 v[96:111], a[120:123], v[52:55], v[96:111]
  s_cmp_gt_u32 s23, 3
  ds_read_b128 v[44:47], v13 offset:49152
  v_mfma_f32_32x32x16_bf16 v[112:127], a[124:127], v[52:55], v[112:127]
  s_waitcnt lgkmcnt(5)
  s_cselect_b32 s26, s20, 0
  v_mfma_f32_32x32x16_bf16 v[96:111], a[128:131], v[24:27], v[96:111]
  s_add_u32 s19, s19, s26
  ds_read_b128 v[48:51], v14 offset:49152
  v_mfma_f32_32x32x16_bf16 v[112:127], a[132:135], v[24:27], v[112:127]
  s_waitcnt lgkmcnt(5)
  s_add_u32 s25, s25, 32768
  v_mfma_f32_32x32x16_bf16 v[96:111], a[136:139], v[28:31], v[96:111]
  s_and_b32 s25, s25, 0x1ffff
  ds_read_b128 v[52:55], v15 offset:49152
  v_mfma_f32_32x32x16_bf16 v[112:127], a[140:143], v[28:31], v[112:127]
  s_waitcnt lgkmcnt(5)
  buffer_store_dwordx4 v[128:131], v7, s[4:7], s21 offen offset:0 sc1
  v_mfma_f32_32x32x16_bf16 v[96:111], a[144:147], v[32:35], v[96:111]
  ds_read_b128 v[24:27], v8 offset:57344
  v_mfma_f32_32x32x16_bf16 v[112:127], a[148:151], v[32:35], v[112:127]
  s_waitcnt lgkmcnt(5)
  v_xor_b32 v8, 0x10000, v8
  v_mfma_f32_32x32x16_bf16 v[96:111], a[152:155], v[36:39], v[96:111]
  ds_read_b128 v[28:31], v9 offset:57344
  v_mfma_f32_32x32x16_bf16 v[112:127], a[156:159], v[36:39], v[112:127]
  s_waitcnt lgkmcnt(5)
  buffer_store_dwordx4 v[132:135], v7, s[4:7], s21 offen offset:1024 sc1
  v_xor_b32 v9, 0x10000, v9
  v_mfma_f32_32x32x16_bf16 v[96:111], a[160:163], v[40:43], v[96:111]
  ds_read_b128 v[32:35], v10 offset:57344
  v_mfma_f32_32x32x16_bf16 v[112:127], a[164:167], v[40:43], v[112:127]
  s_waitcnt lgkmcnt(5)
  v_xor_b32 v10, 0x10000, v10
  v_mfma_f32_32x32x16_bf16 v[96:111], a[168:171], v[44:47], v[96:111]
  ds_read_b128 v[36:39], v11 offset:57344
  v_mfma_f32_32x32x16_bf16 v[112:127], a[172:175], v[44:47], v[112:127]
  s_waitcnt lgkmcnt(5)
  buffer_store_dwordx4 v[136:139], v7, s[4:7], s21 offen offset:2048 sc1
  v_xor_b32 v11, 0x10000, v11
  v_mfma_f32_32x32x16_bf16 v[96:111], a[176:179], v[48:51], v[96:111]
  ds_read_b128 v[40:43], v12 offset:57344
  v_mfma_f32_32x32x16_bf16 v[112:127], a[180:183], v[48:51], v[112:127]
  s_waitcnt lgkmcnt(5)
  v_xor_b32 v12, 0x10000, v12
  v_mfma_f32_32x32x16_bf16 v[96:111], a[184:187], v[52:55], v[96:111]
  ds_read_b128 v[44:47], v13 offset:57344
  v_mfma_f32_32x32x16_bf16 v[112:127], a[188:191], v[52:55], v[112:127]
  s_waitcnt lgkmcnt(5)
  buffer_store_dwordx4 v[140:143], v7, s[4:7], s21 offen offset:3072 sc1
  v_xor_b32 v13, 0x10000, v13
  v_mfma_f32_32x32x16_bf16 v[96:111], a[192:195], v[24:27], v[96:111]
  s_mov_b32 s21, s27
  ds_read_b128 v[48:51], v14 offset:57344
  v_mov_b32 v7, v2
  v_mfma_f32_32x32x16_bf16 v[112:127], a[196:199], v[24:27], v[112:127]
  s_waitcnt lgkmcnt(5)
  v_xor_b32 v14, 0x10000, v14
  v_mfma_f32_32x32x16_bf16 v[96:111], a[200:203], v[28:31], v[96:111]
  s_add_u32 s27, s27, s22
  ds_read_b128 v[52:55], v15 offset:57344
  v_mfma_f32_32x32x16_bf16 v[112:127], a[204:207], v[28:31], v[112:127]
  s_waitcnt lgkmcnt(5)
  s_waitcnt vmcnt(17)
  s_barrier
  v_xor_b32 v15, 0x10000, v15
  v_mfma_f32_32x32x16_bf16 v[96:111], a[208:211], v[32:35], v[96:111]
  ds_read_b128 v[24:27], v8 offset:0
  v_mfma_f32_32x32x16_bf16 v[112:127], a[212:215], v[32:35], v[112:127]
  s_waitcnt lgkmcnt(5)
  v_mfma_f32_32x32x16_bf16 v[96:111], a[216:219], v[36:39], v[96:111]
  s_add_u32 s29, s29, 1
  ds_read_b128 v[28:31], v9 offset:0
  v_mfma_f32_32x32x16_bf16 v[112:127], a[220:223], v[36:39], v[112:127]
  s_waitcnt lgkmcnt(5)
  s_max_i32 s30, s29, 0
  v_mov_b32 v144, s30
  v_mfma_f32_32x32x16_bf16 v[96:111], a[224:227], v[40:43], v[96:111]
  ds_read_b128 v[32:35], v10 offset:0
  v_mfma_f32_32x32x16_bf16 v[112:127], a[228:231], v[40:43], v[112:127]
  s_waitcnt lgkmcnt(5)
  buffer_store_dword v144, v145, s[4:7], s31 offen sc1
  v_mfma_f32_32x32x16_bf16 v[96:111], a[232:235], v[44:47], v[96:111]
  ds_read_b128 v[36:39], v11 offset:0
  v_mfma_f32_32x32x16_bf16 v[112:127], a[236:239], v[44:47], v[112:127]
  s_waitcnt lgkmcnt(5)
  v_mfma_f32_32x32x16_bf16 v[96:111], a[240:243], v[48:51], v[96:111]
  s_sub_u32 s23, s23, 1
  ds_read_b128 v[40:43], v12 offset:0
  v_mfma_f32_32x32x16_bf16 v[112:127], a[244:247], v[48:51], v[112:127]
  s_waitcnt lgkmcnt(5)
  v_mfma_f32_32x32x16_bf16 v[96:111], a[248:251], v[52:55], v[96:111]
  s_cmp_eq_u32 s23, 0
  ds_read_b128 v[44:47], v13 offset:0
  v_mfma_f32_32x32x16_bf16 v[112:127], a[252:255], v[52:55], v[112:127]
  s_cbranch_scc1 G_done1_5
  s_branch G_top_3
G_done0_4:
  s_nop 7
  s_nop 3
  v_mul_f32 v64, s24, v64
  v_mul_f32 v65, s24, v65
  v_cvt_pk_bf16_f32 v128, v64, v65
  v_mul_f32 v66, s24, v66
  v_mul_f32 v67, s24, v67
  v_cvt_pk_bf16_f32 v129, v66, v67
  v_mul_f32 v68, s24, v68
  v_mul_f32 v69, s24, v69
  v_cvt_pk_bf16_f32 v130, v68, v69
  v_mul_f32 v70, s24, v70
  v_mul_f32 v71, s24, v71
  v_cvt_pk_bf16_f32 v131, v70, v71
  buffer_store_dwordx4 v[128:131], v7, s[4:7], s21 offen offset:0 sc1
  v_mul_f32 v72, s24, v72
  v_mul_f32 v73, s24, v73
  v_cvt_pk_bf16_f32 v132, v72, v73
  v_mul_f32 v74, s24, v74
  v_mul_f32 v75, s24, v75
  v_cvt_pk_bf16_f32 v133, v74, v75
  v_mul_f32 v76, s24, v76
  v_mul_f32 v77, s24, v77
  v_cvt_pk_bf16_f32 v134, v76, v77
  v_mul_f32 v78, s24, v78
  v_mul_f32 v79, s24, v79
  v_cvt_pk_bf16_f32 v135, v78, v79
  buffer_store_dwordx4 v[132:135], v7, s[4:7], s21 offen offset:1024 sc1
  v_mul_f32 v80, s24, v80
  v_mul_f32 v81, s24, v81
  v_cvt_pk_bf16_f32 v136, v80, v81
  v_mul_f32 v82, s24, v82
  v_mul_f32 v83, s24, v83
  v_cvt_pk_bf16_f32 v137, v82, v83
  v_mul_f32 v84, s24, v84
  v_mul_f32 v85, s24, v85
  v_cvt_pk_bf16_f32 v138, v84, v85
  v_mul_f32 v86, s24, v86
  v_mul_f32 v87, s24, v87
  v_cvt_pk_bf16_f32 v139, v86, v87
  buffer_store_dwordx4 v[136:139], v7, s[4:7], s21 offen offset:2048 sc1
  v_mul_f32 v88, s24, v88
  v_mul_f32 v89, s24, v89
  v_cvt_pk_bf16_f32 v140, v88, v89
  v_mul_f32 v90, s24, v90
  v_mul_f32 v91, s24, v91
  v_cvt_pk_bf16_f32 v141, v90, v91
  v_mul_f32 v92, s24, v92
  v_mul_f32 v93, s24, v93
  v_cvt_pk_bf16_f32 v142, v92, v93
  v_mul_f32 v94, s24, v94
  v_mul_f32 v95, s24, v95
  v_cvt_pk_bf16_f32 v143, v94, v95
  buffer_store_dwordx4 v[140:143], v7, s[4:7], s21 offen offset:3072 sc1
  s_branch G_fin_6
G_done1_5:
  s_nop 7
  s_nop 3
  v_mul_f32 v96, s24, v96
  v_mul_f32 v97, s24, v97
  v_cvt_pk_bf16_f32 v128, v96, v97
  v_mul_f32 v98, s24, v98
  v_mul_f32 v99, s24, v99
  v_cvt_pk_bf16_f32 v129, v98, v99
  v_mul_f32 v100, s24, v100
  v_mul_f32 v101, s24, v101
  v_cvt_pk_bf16_f32 v130, v100, v101
  v_mul_f32 v102, s24, v102
  v_mul_f32 v103, s24, v103
  v_cvt_pk_bf16_f32 v131, v102, v103
  buffer_store_dwordx4 v[128:131], v7, s[4:7], s21 offen offset:0 sc1
  v_mul_f32 v104, s24, v104
  v_mul_f32 v105, s24, v105
  v_cvt_pk_bf16_f32 v132, v104, v105
  v_mul_f32 v106, s24, v106
  v_mul_f32 v107, s24, v107
  v_cvt_pk_bf16_f32 v133, v106, v107
  v_mul_f32 v108, s24, v108
  v_mul_f32 v109, s24, v109
  v_cvt_pk_bf16_f32 v134, v108, v109
  v_mul_f32 v110, s24, v110
  v_mul_f32 v111, s24, v111
  v_cvt_pk_bf16_f32 v135, v110, v111
  buffer_store_dwordx4 v[132:135], v7, s[4:7], s21 offen offset:1024 sc1
  v_mul_f32 v112, s24, v112
  v_mul_f32 v113, s24, v113
  v_cvt_pk_bf16_f32 v136, v112, v113
  v_mul_f32 v114, s24, v114
  v_mul_f32 v115, s24, v115
  v_cvt_pk_bf16_f32 v137, v114, v115
  v_mul_f32 v116, s24, v116
  v_mul_f32 v117, s24, v117
  v_cvt_pk_bf16_f32 v138, v116, v117
  v_mul_f32 v118, s24, v118
  v_mul_f32 v119, s24, v119
  v_cvt_pk_bf16_f32 v139, v118, v119
  buffer_store_dwordx4 v[136:139], v7, s[4:7], s21 offen offset:2048 sc1
  v_mul_f32 v120, s24, v120
  v_mul_f32 v121, s24, v121
  v_cvt_pk_bf16_f32 v140, v120, v121
  v_mul_f32 v122, s24, v122
  v_mul_f32 v123, s24, v123
  v_cvt_pk_bf16_f32 v141, v122, v123
  v_mul_f32 v124, s24, v124
  v_mul_f32 v125, s24, v125
  v_cvt_pk_bf16_f32 v142, v124, v125
  v_mul_f32 v126, s24, v126
  v_mul_f32 v127, s24, v127
  v_cvt_pk_bf16_f32 v143, v126, v127
  buffer_store_dwordx4 v[140:143], v7, s[4:7], s21 offen offset:3072 sc1
G_fin_6:
  s_waitcnt vmcnt(0) lgkmcnt(0)
  s_barrier
  s_add_u32 s30, s29, 3
  v_mov_b32 v144, s30
  v_min_u32 v145, 1, v0
  v_lshlrev_b32 v145, 30, v145
  buffer_store_dword v144, v145, s[4:7], s31 offen sc1
  s_branch P_end_2
P_v_1:
  s_mov_b32 s27, s21
  v_mov_b32 v7, 0x40000000
  s_mov_b32 s29, -3
  v_min_u32 v145, 1, v0
  v_lshlrev_b32 v145, 30, v145
  ds_read_b128 v[24:27], v8 offset:0
  ds_read_b128 v[28:31], v9 offset:0
  ds_read_b128 v[32:35], v10 offset:0
  ds_read_b128 v[36:39], v11 offset:0
  ds_read_b128 v[40:43], v12 offset:0
  ds_read_b128 v[44:47], v13 offset:0
.p2align 6
G_top_7:
  s_waitcnt lgkmcnt(5)
  v_mfma_f32_32x32x16_bf16 v[64:79], v[24:27], a[0:3], 0
  s_add_u32 m0, s25, 0
  ds_read_b128 v[48:51], v14 offset:0
  v_mfma_f32_32x32x16_bf16 v[80:95], v[24:27], a[4:7], 0
  s_waitcnt lgkmcnt(5)
  buffer_load_dwordx4 v16, s[12:15], s19 offen lds
  v_mfma_f32_32x32x16_bf16 v[64:79], v[28:31], a[8:11], v[64:79]
  ds_read_b128 v[52:55], v15 offset:0
  v_mul_f32 v96, s24, v96
  v_mul_f32 v97, s24, v97
  v_mfma_f32_32x32x16_bf16 v[80:95], v[28:31], a[12:15], v[80:95]
  s_waitcnt lgkmcnt(5)
  v_cvt_pk_bf16_f32 v128, v96, v97
  v_mul_f32 v98, s24, v98
  v_mfma_f32_32x32x16_bf16 v[64:79], v[32:35], a[16:19], v[64:79]
  s_add_u32 m0, s25, 1024
  ds_read_b128 v[24:27], v8 offset:8192
  v_mul_f32 v99, s24, v99
  v_cvt_pk_bf16_f32 v129, v98, v99
  v_mfma_f32_32x32x16_bf16 v[80:95], v[32:35], a[20:23], v[80:95]
  s_waitcnt lgkmcnt(5)
  buffer_load_dwordx4 v17, s[12:15], s19 offen lds
  v_mul_f32 v100, s24, v100
  v_mul_f32 v101, s24, v101
  v_mfma_f32_32x32x16_bf16 v[64:79], v[36:39], a[24:27], v[64:79]
  ds_read_b128 v[28:31], v9 offset:8192
  v_cvt_pk_bf16_f32 v130, v100, v101
  v_mul_f32 v102, s24, v102
  v_mfma_f32_32x32x16_bf16 v[80:95], v[36:39], a[28:31], v[80:95]
  s_waitcnt lgkmcnt(5)
  v_mul_f32 v103, s24, v103
  v_cvt_pk_bf16_f32 v131, v102, v103
  v_mfma_f32_32x32x16_bf16 v[64:79], v[40:43], a[32:35], v[64:79]
  s_add_u32 m0, s25, 2048
  ds_read_b128 v[32:35], v10 offset:8192
  v_mul_f32 v104, s24, v104
  v_mul_f32 v105, s24, v105
  v_mfma_f32_32x32x16_bf16 v[80:95], v[40:43], a[36:39], v[80:95]
  s_waitcnt lgkmcnt(5)
  buffer_load_dwordx4 v18, s[12:15], s19 offen lds
  v_cvt_pk_bf16_f32 v132, v104, v105
  v_mul_f32 v106, s24, v106
  v_mfma_f32_32x32x16_bf16 v[64:79], v[44:47], a[40:43], v[64:79]
  ds_read_b128 v[36:39], v11 offset:8192
  v_mul_f32 v107, s24, v107
  v_cvt_pk_bf16_f32 v133, v106, v107
  v_mfma_f32_32x32x16_bf16 v[80:95], v[44:47], a[44:47], v[80:95]
  s_waitcnt lgkmcnt(5)
  v_mul_f32 v108, s24, v108
  v_mul_f32 v109, s24, v109
  v_mfma_f32_32x32x16_bf16 v[64:79], v[48:51], a[48:51], v[64:79]
  s_add_u32 m0, s25, 3072
  ds_read_b128 v[40:43], v12 offset:8192
  v_cvt_pk_bf16_f32 v134, v108, v109
  v_mul_f32 v110, s24, v110
  v_mfma_f32_32x32x16_bf16 v[80:95], v[48:51], a[52:55], v[80:95]
  s_waitcnt lgkmcnt(5)
  buffer_load_dwordx4 v19, s[12:15], s19 offen lds
  v_mul_f32 v111, s24, v111
  v_cvt_pk_bf16_f32 v135, v110, v111
  v_mfma_f32_32x32x16_bf16 v[64:79], v[52:55], a[56:59], v[64:79]
  ds_read_b128 v[44:47], v13 offset:8192
  v_mul_f32 v112, s24, v112
  v_mul_f32 v113, s24, v113
  v_mfma_f32_32x32x16_bf16 v[80:95], v[52:55], a[60:63], v[80:95]
  s_waitcnt lgkmcnt(5)
  v_cvt_pk_bf16_f32 v136, v112, v113
  v_mul_f32 v114, s24, v114
  v_mfma_f32_32x32x16_bf16 v[64:79], v[24:27], a[64:67], v[64:79]
  s_add_u32 m0, s25, 4096
  ds_read_b128 v[48:51], v14 offset:8192
  v_mul_f32 v115, s24, v115
  v_cvt_pk_bf16_f32 v137, v114, v115
  v_mfma_f32_32x32x16_bf16 v[80:95], v[24:27], a[68:71], v[80:95]
  s_waitcnt lgkmcnt(5)
  buffer_load_dwordx4 v20, s[12:15], s19 offen lds
  v_mul_f32 v116, s24, v116
  v_mul_f32 v117, s24, v117
  v_mfma_f32_32x32x16_bf16 v[64:79], v[28:31], a[72:75], v[64:79]
  ds_read_b128 v[52:55], v15 offset:8192
  v_cvt_pk_bf16_f32 v138, v116, v117
  v_mul_f32 v118, s24, v118
  v_mfma_f32_32x32x16_bf16 v[80:95], v[28:31], a[76:79], v[80:95]
  s_waitcnt lgkmcnt(5)
  v_mul_f32 v119, s24, v119
  v_cvt_pk_bf16_f32 v139, v118, v119
  v_mfma_f32_32x32x16_bf16 v[64:79], v[32:35], a[80:83], v[64:79]
  s_add_u32 m0, s25, 5120
  ds_read_b128 v[24:27], v8 offset:16384
  v_mul_f32 v120, s24, v120
  v_mul_f32 v121, s24, v121
  v_mfma_f32_32x32x16_bf16 v[80:95], v[32:35], a[84:87], v[80:95]
  s_waitcnt lgkmcnt(5)
  buffer_load_dwordx4 v21, s[12:15], s19 offen lds
  v_cvt_pk_bf16_f32 v140, v120, v121
  v_mul_f32 v122, s24, v122
  v_mfma_f32_32x32x16_bf16 v[64:79], v[36:39], a[88:91], v[64:79]
  ds_read_b128 v[28:31], v9 offset:16384
  v_mul_f32 v123, s24, v123
  v_cvt_pk_bf16_f32 v141, v122, v123
  v_mfma_f32_32x32x16_bf16 v[80:95], v[36:39], a[92:95], v[80:95]
  s_waitcnt lgkmcnt(5)
  v_mul_f32 v124, s24, v124
  v_mul_f32 v125, s24, v125
  v_mfma_f32_32x32x16_bf16 v[64:79], v[40:43], a[96:99], v[64:79]
  s_add_u32 m0, s25, 6144
  ds_read_b128 v[32:35], v10 offset:16384
  v_cvt_pk_bf16_f32 v142, v124, v125
  v_mul_f32 v126, s24, v126
  v_mfma_f32_32x32x16_bf16 v[80:95], v[40:43], a[100:103], v[80:95]
  s_waitcnt lgkmcnt(5)
  buffer_load_dwordx4 v22, s[12:15], s19 offen lds
  v_mul_f32 v127, s24, v127
  v_cvt_pk_bf16_f32 v143, v126, v127
  v_mfma_f32_32x32x16_bf16 v[64:79], v[44:47], a[104:107], v[64:79]
  ds_read_b128 v[36:39], v11 offset:16384
  v_mfma_f32_32x32x16_bf16 v[80:95], v[44:47], a[108:111], v[80:95]
  s_waitcnt lgkmcnt(5)
  v_mfma_f32_32x32x16_bf16 v[64:79], v[48:51], a[112:115], v[64:79]
  s_add_u32 m0, s25, 7168
  ds_read_b128 v[40:43], v12 offset:16384
  v_mfma_f32_32x32x16_bf16 v[80:95], v[48:51], a[116:119], v[80:95]
  s_waitcnt lgkmcnt(5)
  buffer_load_dwordx4 v23, s[12:15], s19 offen lds
  v_mfma_f32_32x32x16_bf16 v[64:79], v[52:55], a[120:123], v[64:79]
  s_cmp_gt_u32 s23, 3
  ds_read_b128 v[44:47], v13 offset:16384
  v_mfma_f32_32x32x16_bf16 v[80:95], v[52:55], a[124:127], v[80:95]
  s_waitcnt lgkmcnt(5)
  s_cselect_b32 s26, s20, 0
  v_mfma_f32_32x32x16_bf16 v[64:79], v[24:27], a[128:131], v[64:79]
  s_add_u32 s19, s19, s26
  ds_read_b128 v[48:51], v14 offset:16384
  v_mfma_f32_32x32x16_bf16 v[80:95], v[24:27], a[132:135], v[80:95]
  s_waitcnt lgkmcnt(5)
  s_add_u32 s25, s25, 32768
  v_mfma_f32_32x32x16_bf16 v[64:79], v[28:31], a[136:139], v[64:79]
  s_and_b32 s25, s25, 0x1ffff
  ds_read_b128 v[52:55], v15 offset:16384
  v_mfma_f32_32x32x16_bf16 v[80:95], v[28:31], a[140:143], v[80:95]
  s_waitcnt lgkmcnt(5)
  buffer_store_dwordx4 v[128:131], v7, s[4:7], s21 offen offset:0 sc1
  v_mfma_f32_32x32x16_bf16 v[64:79], v[32:35], a[144:147], v[64:79]
  ds_read_b128 v[24:27], v8 offset:24576
  v_mfma_f32_32x32x16_bf16 v[80:95], v[32:35], a[148:151], v[80:95]
  s_waitcnt lgkmcnt(5)
  v_mfma_f32_32x32x16_bf16 v[64:79], v[36:39], a[152:155], v[64:79]
  ds_read_b128 v[28:31], v9 offset:24576
  v_mfma_f32_32x32x16_bf16 v[80:95], v[36:39], a[156:159], v[80:95]
  s_waitcnt lgkmcnt(5)
  buffer_store_dwordx4 v[132:135], v7, s[4:7], s21 offen offset:1024 sc1
  v_mfma_f32_32x32x16_bf16 v[64:79], v[40:43], a[160:163], v[64:79]
  ds_read_b128 v[32:35], v10 offset:24576
  v_mfma_f32_32x32x16_bf16 v[80:95], v[40:43], a[164:167], v[80:95]
  s_waitcnt lgkmcnt(5)
  v_mfma_f32_32x32x16_bf16 v[64:79], v[44:47], a[168:171], v[64:79]
  ds_read_b128 v[36:39], v11 offset:24576
  v_mfma_f32_32x32x16_bf16 v[80:95], v[44:47], a[172:175], v[80:95]
  s_waitcnt lgkmcnt(5)
  buffer_store_dwordx4 v[136:139], v7, s[4:7], s21 offen offset:2048 sc1
  v_mfma_f32_32x32x16_bf16 v[64:79], v[48:51], a[176:179], v[64:79]
  ds_read_b128 v[40:43], v12 offset:24576
  v_mfma_f32_32x32x16_bf16 v[80:95], v[48:51], a[180:183], v[80:95]
  s_waitcnt lgkmcnt(5)
  v_mfma_f32_32x32x16_bf16 v[64:79], v[52:55], a[184:187], v[64:79]
  ds_read_b128 v[44:47], v13 offset:24576
  v_mfma_f32_32x32x16_bf16 v[80:95], v[52:55], a[188:191], v[80:95]
  s_waitcnt lgkmcnt(5)
  buffer_store_dwordx4 v[140:143], v7, s[4:7], s21 offen offset:3072 sc1
  v_mfma_f32_32x32x16_bf16 v[64:79], v[24:27], a[192:195], v[64:79]
  s_mov_b32 s21, s27
  ds_read_b128 v[48:51], v14 offset:24576
  v_mov_b32 v7, v2
  v_mfma_f32_32x32x16_bf16 v[80:95], v[24:27], a[196:199], v[80:95]
  s_waitcnt lgkmcnt(5)
  v_mfma_f32_32x32x16_bf16 v[64:79], v[28:31], a[200:203], v[64:79]
  s_add_u32 s27, s27, s22
  ds_read_b128 v[52:55], v15 offset:24576
  v_mfma_f32_32x32x16_bf16 v[80:95], v[28:31], a[204:207], v[80:95]
  s_waitcnt lgkmcnt(5)
  s_waitcnt vmcnt(17)
  s_barrier
  v_mfma_f32_32x32x16_bf16 v[64:79], v[32:35], a[208:211], v[64:79]
  ds_read_b128 v[24:27], v8 offset:32768
  v_mfma_f32_32x32x16_bf16 v[80:95], v[32:35], a[212:215], v[80:95]
  s_waitcnt lgkmcnt(5)
  v_mfma_f32_32x32x16_bf16 v[64:79], v[36:39], a[216:219], v[64:79]
  s_add_u32 s29, s29, 1
  ds_read_b128 v[28:31], v9 offset:32768
  v_mfma_f32_32x32x16_bf16 v[80:95], v[36:39], a[220:223], v[80:95]
  s_waitcnt lgkmcnt(5)
  s_max_i32 s30, s29, 0
  v_mov_b32 v144, s30
  v_mfma_f32_32x32x16_bf16 v[64:79], v[40:43], a[224:227], v[64:79]
  ds_read_b128 v[32:35], v10 offset:32768
  v_mfma_f32_32x32x16_bf16 v[80:95], v[40:43], a[228:231], v[80:95]
  s_waitcnt lgkmcnt(5)
  buffer_store_dword v144, v145, s[4:7], s31 offen sc1
  v_mfma_f32_32x32x16_bf16 v[64:79], v[44:47], a[232:235], v[64:79]
  ds_read_b128 v[36:39], v11 offset:32768
  v_mfma_f32_32x32x16_bf16 v[80:95], v[44:47], a[236:239], v[80:95]
  s_waitcnt lgkmcnt(5)
  v_mfma_f32_32x32x16_bf16 v[64:79], v[48:51], a[240:243], v[64:79]
  s_sub_u32 s23, s23, 1
  ds_read_b128 v[40:43], v12 offset:32768
  v_mfma_f32_32x32x16_bf16 v[80:95], v[48:51], a[244:247], v[80:95]
  s_waitcnt lgkmcnt(5)
  v_mfma_f32_32x32x16_bf16 v[64:79], v[52:55], a[248:251], v[64:79]
  s_cmp_eq_u32 s23, 0
  ds_read_b128 v[44:47], v13 offset:32768
  v_mfma_f32_32x32x16_bf16 v[80:95], v[52:55], a[252:255], v[80:95]
  s_cbranch_scc1 G_done0_8
  s_waitcnt lgkmcnt(5)
  v_mfma_f32_32x32x16_bf16 v[96:111], v[24:27], a[0:3], 0
  s_add_u32 m0, s25, 0
  ds_read_b128 v[48:51], v14 offset:32768
  v_mfma_f32_32x32x16_bf16 v[112:127], v[24:27], a[4:7], 0
  s_waitcnt lgkmcnt(5)
  buffer_load_dwordx4 v16, s[12:15], s19 offen lds
  v_mfma_f32_32x32x16_bf16 v[96:111], v[28:31], a[8:11], v[96:111]
  ds_read_b128 v[52:55], v15 offset:32768
  v_mul_f32 v64, s24, v64
  v_mul_f32 v65, s24, v65
  v_mfma_f32_32x32x16_bf16 v[112:127], v[28:31], a[12:15], v[112:127]
  s_waitcnt lgkmcnt(5)
  v_cvt_pk_bf16_f32 v128, v64, v65
  v_mul_f32 v66, s24, v66
  v_mfma_f32_32x32x16_bf16 v[96:111], v[32:35], a[16:19], v[96:111]
  s_add_u32 m0, s25, 1024
  ds_read_b128 v[24:27], v8 offset:40960
  v_mul_f32 v67, s24, v67
  v_cvt_pk_bf16_f32 v129, v66, v67
  v_mfma_f32_32x32x16_bf16 v[112:127], v[32:35], a[20:23], v[112:127]
  s_waitcnt lgkmcnt(5)
  buffer_load_dwordx4 v17, s[12:15], s19 offen lds
  v_mul_f32 v68, s24, v68
  v_mul_f32 v69, s24, v69
  v_mfma_f32_32x32x16_bf16 v[96:111], v[36:39], a[24:27], v[96:111]
  ds_read_b128 v[28:31], v9 offset:40960
  v_cvt_pk_bf16_f32 v130, v68, v69
  v_mul_f32 v70, s24, v70
  v_mfma_f32_32x32x16_bf16 v[112:127], v[36:39], a[28:31], v[112:127]
  s_waitcnt lgkmcnt(5)
  v_mul_f32 v71, s24, v71
  v_cvt_pk_bf16_f32 v131, v70, v71
  v_mfma_f32_32x32x16_bf16 v[96:111], v[40:43], a[32:35], v[96:111]
  s_add_u32 m0, s25, 2048
  ds_read_b128 v[32:35], v10 offset:40960
  v_mul_f32 v72, s24, v72
  v_mul_f32 v73, s24, v73
  v_mfma_f32_32x32x16_bf16 v[112:127], v[40:43], a[36:39], v[112:127]
  s_waitcnt lgkmcnt(5)
  buffer_load_dwordx4 v18, s[12:15], s19 offen lds
  v_cvt_pk_bf16_f32 v132, v72, v73
  v_mul_f32 v74, s24, v74
  v_mfma_f32_32x32x16_bf16 v[96:111], v[44:47], a[40:43], v[96:111]
  ds_read_b128 v[36:39], v11 offset:40960
  v_mul_f32 v75, s24, v75
  v_cvt_pk_bf16_f32 v133, v74, v75
  v_mfma_f32_32x32x16_bf16 v[112:127], v[44:47], a[44:47], v[112:127]
  s_waitcnt lgkmcnt(5)
  v_mul_f32 v76, s24, v76
  v_mul_f32 v77, s24, v77
  v_mfma_f32_32x32x16_bf16 v[96:111], v[48:51], a[48:51], v[96:111]
  s_add_u32 m0, s25, 3072
  ds_read_b128 v[40:43], v12 offset:40960
  v_cvt_pk_bf16_f32 v134, v76, v77
  v_mul_f32 v78, s24, v78
  v_mfma_f32_32x32x16_bf16 v[112:127], v[48:51], a[52:55], v[112:127]
  s_waitcnt lgkmcnt(5)
  buffer_load_dwordx4 v19, s[12:15], s19 offen lds
  v_mul_f32 v79, s24, v79
  v_cvt_pk_bf16_f32 v135, v78, v79
  v_mfma_f32_32x32x16_bf16 v[96:111], v[52:55], a[56:59], v[96:111]
  ds_read_b128 v[44:47], v13 offset:40960
  v_mul_f32 v80, s24, v80
  v_mul_f32 v81, s24, v81
  v_mfma_f32_32x32x16_bf16 v[112:127], v[52:55], a[60:63], v[112:127]
  s_waitcnt lgkmcnt(5)
  v_cvt_pk_bf16_f32 v136, v80, v81
  v_mul_f32 v82, s24, v82
  v_mfma_f32_32x32x16_bf16 v[96:111], v[24:27], a[64:67], v[96:111]
  s_add_u32 m0, s25, 4096
  ds_read_b128 v[48:51], v14 offset:40960
  v_mul_f32 v83, s24, v83
  v_cvt_pk_bf16_f32 v137, v82, v83
  v_mfma_f32_32x32x16_bf16 v[112:127], v[24:27], a[68:71], v[112:127]
  s_waitcnt lgkmcnt(5)
  buffer_load_dwordx4 v20, s[12:15], s19 offen lds
  v_mul_f32 v84, s24, v84
  v_mul_f32 v85, s24, v85
  v_mfma_f32_32x32x16_bf16 v[96:111], v[28:31], a[72:75], v[96:111]
  ds_read_b128 v[52:55], v15 offset:40960
  v_cvt_pk_bf16_f32 v138, v84, v85
  v_mul_f32 v86, s24, v86
  v_mfma_f32_32x32x16_bf16 v[112:127], v[28:31], a[76:79], v[112:127]
  s_waitcnt lgkmcnt(5)
  v_mul_f32 v87, s24, v87
  v_cvt_pk_bf16_f32 v139, v86, v87
  v_mfma_f32_32x32x16_bf16 v[96:111], v[32:35], a[80:83], v[96:111]
  s_add_u32 m0, s25, 5120
  ds_read_b128 v[24:27], v8 offset:49152
  v_mul_f32 v88, s24, v88
  v_mul_f32 v89, s24, v89
  v_mfma_f32_32x32x16_bf16 v[112:127], v[32:35], a[84:87], v[112:127]
  s_waitcnt lgkmcnt(5)
  buffer_load_dwordx4 v21, s[12:15], s19 offen lds
  v_cvt_pk_bf16_f32 v140, v88, v89
  v_mul_f32 v90, s24, v90
  v_mfma_f32_32x32x16_bf16 v[96:111], v[36:39], a[88:91], v[96:111]
  ds_read_b128 v[28:31], v9 offset:49152
  v_mul_f32 v91, s24, v91
  v_cvt_pk_bf16_f32 v141, v90, v91
  v_mfma_f32_32x32x16_bf16 v[112:127], v[36:39], a[92:95], v[112:127]
  s_waitcnt lgkmcnt(5)
  v_mul_f32 v92, s24, v92
  v_mul_f32 v93, s24, v93
  v_mfma_f32_32x32x16_bf16 v[96:111], v[40:43], a[96:99], v[96:111]
  s_add_u32 m0, s25, 6144
  ds_read_b128 v[32:35], v10 offset:49152
  v_cvt_pk_bf16_f32 v142, v92, v93
  v_mul_f32 v94, s24, v94
  v_mfma_f32_32x32x16_bf16 v[112:127], v[40:43], a[100:103], v[112:127]
  s_waitcnt lgkmcnt(5)
  buffer_load_dwordx4 v22, s[12:15], s19 offen lds
  v_mul_f32 v95, s24, v95
  v_cvt_pk_bf16_f32 v143, v94, v95
  v_mfma_f32_32x32x16_bf16 v[96:111], v[44:47], a[104:107], v[96:111]
  ds_read_b128 v[36:39], v11 offset:49152
  v_mfma_f32_32x32x16_bf16 v[112:127], v[44:47], a[108:111], v[112:127]
  s_waitcnt lgkmcnt(5)
  v_mfma_f32_32x32x16_bf16 v[96:111], v[48:51], a[112:115], v[96:111]
  s_add_u32 m0, s25, 7168
  ds_read_b128 v[40:43], v12 offset:49152
  v_mfma_f32_32x32x16_bf16 v[112:127], v[48:51], a[116:119], v[112:127]
  s_waitcnt lgkmcnt(5)
  buffer_load_dwordx4 v23, s[12:15], s19 offen lds
  v_mfma_f32_32x32x16_bf16 v[96:111], v[52:55], a[120:123], v[96:111]
  s_cmp_gt_u32 s23, 3
  ds_read_b128 v[44:47], v13 offset:49152
  v_mfma_f32_32x32x16_bf16 v[112:127], v[52:55], a[124:127], v[112:127]
  s_waitcnt lgkmcnt(5)
  s_cselect_b32 s26, s20, 0
  v_mfma_f32_32x32x16_bf16 v[96:111], v[24:27], a[128:131], v[96:111]
  s_add_u32 s19, s19, s26
  ds_read_b128 v[48:51], v14 offset:49152
  v_mfma_f32_32x32x16_bf16 v[112:127], v[24:27], a[132:135], v[112:127]
  s_waitcnt lgkmcnt(5)
  s_add_u32 s25, s25, 32768
  v_mfma_f32_32x32x16_bf16 v[96:111], v[28:31], a[136:139], v[96:111]
  s_and_b32 s25, s25, 0x1ffff
  ds_read_b128 v[52:55], v15 offset:49152
  v_mfma_f32_32x32x16_bf16 v[112:127], v[28:31], a[140:143], v[112:127]
  s_waitcnt lgkmcnt(5)
  buffer_store_dwordx4 v[128:131], v7, s[4:7], s21 offen offset:0 sc1
  v_mfma_f32_32x32x16_bf16 v[96:111], v[32:35], a[144:147], v[96:111]
  ds_read_b128 v[24:27], v8 offset:57344
  v_mfma_f32_32x32x16_bf16 v[112:127], v[32:35], a[148:151], v[112:127]
  s_waitcnt lgkmcnt(5)
  v_xor_b32 v8, 0x10000, v8
  v_mfma_f32_32x32x16_bf16 v[96:111], v[36:39], a[152:155], v[96:111]
  ds_read_b128 v[28:31], v9 offset:57344
  v_mfma_f32_32x32x16_bf16 v[112:127], v[36:39], a[156:159], v[112:127]
  s_waitcnt lgkmcnt(5)
  buffer_store_dwordx4 v[132:135], v7, s[4:7], s21 offen offset:1024 sc1
  v_xor_b32 v9, 0x10000, v9
  v_mfma_f32_32x32x16_bf16 v[96:111], v[40:43], a[160:163], v[96:111]
  ds_read_b128 v[32:35], v10 offset:57344
  v_mfma_f32_32x32x16_bf16 v[112:127], v[40:43], a[164:167], v[112:127]
  s_waitcnt lgkmcnt(5)
  v_xor_b32 v10, 0x10000, v10
  v_mfma_f32_32x32x16_bf16 v[96:111], v[44:47], a[168:171], v[96:111]
  ds_read_b128 v[36:39], v11 offset:57344
  v_mfma_f32_32x32x16_bf16 v[112:127], v[44:47], a[172:175], v[112:127]
  s_waitcnt lgkmcnt(5)
  buffer_store_dwordx4 v[136:139], v7, s[4:7], s21 offen offset:2048 sc1
  v_xor_b32 v11, 0x10000, v11
  v_mfma_f32_32x32x16_bf16 v[96:111], v[48:51], a[176:179], v[96:111]
  ds_read_b128 v[40:43], v12 offset:57344
  v_mfma_f32_32x32x16_bf16 v[112:127], v[48:51], a[180:183], v[112:127]
  s_waitcnt lgkmcnt(5)
  v_xor_b32 v12, 0x10000, v12
  v_mfma_f32_32x32x16_bf16 v[96:111], v[52:55], a[184:187], v[96:111]
  ds_read_b128 v[44:47], v13 offset:57344
  v_mfma_f32_32x32x16_bf16 v[112:127], v[52:55], a[188:191], v[112:127]
  s_waitcnt lgkmcnt(5)
  buffer_store_dwordx4 v[140:143], v7, s[4:7], s21 offen offset:3072 sc1
  v_xor_b32 v13, 0x10000, v13
  v_mfma_f32_32x32x16_bf16 v[96:111], v[24:27], a[192:195], v[96:111]
  s_mov_b32 s21, s27
  ds_read_b128 v[48:51], v14 offset:57344
  v_mov_b32 v7, v2
  v_mfma_f32_32x32x16_bf16 v[112:127], v[24:27], a[196:199], v[112:127]
  s_waitcnt lgkmcnt(5)
  v_xor_b32 v14, 0x10000, v14
  v_mfma_f32_32x32x16_bf16 v[96:111], v[28:31], a[200:203], v[96:111]
  s_add_u32 s27, s27, s22
  ds_read_b128 v[52:55], v15 offset:57344
  v_mfma_f32_32x32x16_bf16 v[112:127], v[28:31], a[204:207], v[112:127]
  s_waitcnt lgkmcnt(5)
  s_waitcnt vmcnt(17)
  s_barrier
  v_xor_b32 v15, 0x10000, v15
  v_mfma_f32_32x32x16_bf16 v[96:111], v[32:35], a[208:211], v[96:111]
  ds_read_b128 v[24:27], v8 offset:0
  v_mfma_f32_32x32x16_bf16 v[112:127], v[32:35], a[212:215], v[112:127]
  s_waitcnt lgkmcnt(5)
  v_mfma_f32_32x32x16_bf16 v[96:111], v[36:39], a[216:219], v[96:111]
  s_add_u32 s29, s29, 1
  ds_read_b128 v[28:31], v9 offset:0
  v_mfma_f32_32x32x16_bf16 v[112:127], v[36:39], a[220:223], v[112:127]
  s_waitcnt lgkmcnt(5)
  s_max_i32 s30, s29, 0
  v_mov_b32 v144, s30
  v_mfma_f32_32x32x16_bf16 v[96:111], v[40:43], a[224:227], v[96:111]
  ds_read_b128 v[32:35], v10 offset:0
  v_mfma_f32_32x32x16_bf16 v[112:127], v[40:43], a[228:231], v[112:127]
  s_waitcnt lgkmcnt(5)
  buffer_store_dword v144, v145, s[4:7], s31 offen sc1
  v_mfma_f32_32x32x16_bf16 v[96:111], v[44:47], a[232:235], v[96:111]
  ds_read_b128 v[36:39], v11 offset:0
  v_mfma_f32_32x32x16_bf16 v[112:127], v[44:47], a[236:239], v[112:127]
  s_waitcnt lgkmcnt(5)
  v_mfma_f32_32x32x16_bf16 v[96:111], v[48:51], a[240:243], v[96:111]
  s_sub_u32 s23, s23, 1
  ds_read_b128 v[40:43], v12 offset:0
  v_mfma_f32_32x32x16_bf16 v[112:127], v[48:51], a[244:247], v[112:127]
  s_waitcnt lgkmcnt(5)
  v_mfma_f32_32x32x16_bf16 v[96:111], v[52:55], a[248:251], v[96:111]
  s_cmp_eq_u32 s23, 0
  ds_read_b128 v[44:47], v13 offset:0
  v_mfma_f32_32x32x16_bf16 v[112:127], v[52:55], a[252:255], v[112:127]
  s_cbranch_scc1 G_done1_9
  s_branch G_top_7
G_done0_8:
  s_nop 7
  s_nop 3
  v_mul_f32 v64, s24, v64
  v_mul_f32 v65, s24, v65
  v_cvt_pk_bf16_f32 v128, v64, v65
  v_mul_f32 v66, s24, v66
  v_mul_f32 v67, s24, v67
  v_cvt_pk_bf16_f32 v129, v66, v67
  v_mul_f32 v68, s24, v68
  v_mul_f32 v69, s24, v69
  v_cvt_pk_bf16_f32 v130, v68, v69
  v_mul_f32 v70, s24, v70
  v_mul_f32 v71, s24, v71
  v_cvt_pk_bf16_f32 v131, v70, v71
  buffer_store_dwordx4 v[128:131], v7, s[4:7], s21 offen offset:0 sc1
  v_mul_f32 v72, s24, v72
  v_mul_f32 v73, s24, v73
  v_cvt_pk_bf16_f32 v132, v72, v73
  v_mul_f32 v74, s24, v74
  v_mul_f32 v75, s24, v75
  v_cvt_pk_bf16_f32 v133, v74, v75
  v_mul_f32 v76, s24, v76
  v_mul_f32 v77, s24, v77
  v_cvt_pk_bf16_f32 v134, v76, v77
  v_mul_f32 v78, s24, v78
  v_mul_f32 v79, s24, v79
  v_cvt_pk_bf16_f32 v135, v78, v79
  buffer_store_dwordx4 v[132:135], v7, s[4:7], s21 offen offset:1024 sc1
  v_mul_f32 v80, s24, v80
  v_mul_f32 v81, s24, v81
  v_cvt_pk_bf16_f32 v136, v80, v81
  v_mul_f32 v82, s24, v82
  v_mul_f32 v83, s24, v83
  v_cvt_pk_bf16_f32 v137, v82, v83
  v_mul_f32 v84, s24, v84
  v_mul_f32 v85, s24, v85
  v_cvt_pk_bf16_f32 v138, v84, v85
  v_mul_f32 v86, s24, v86
  v_mul_f32 v87, s24, v87
  v_cvt_pk_bf16_f32 v139, v86, v87
  buffer_store_dwordx4 v[136:139], v7, s[4:7], s21 offen offset:2048 sc1
  v_mul_f32 v88, s24, v88
  v_mul_f32 v89, s24, v89
  v_cvt_pk_bf16_f32 v140, v88, v89
  v_mul_f32 v90, s24, v90
  v_mul_f32 v91, s24, v91
  v_cvt_pk_bf16_f32 v141, v90, v91
  v_mul_f32 v92, s24, v92
  v_mul_f32 v93, s24, v93
  v_cvt_pk_bf16_f32 v142, v92, v93
  v_mul_f32 v94, s24, v94
  v_mul_f32 v95, s24, v95
  v_cvt_pk_bf16_f32 v143, v94, v95
  buffer_store_dwordx4 v[140:143], v7, s[4:7], s21 offen offset:3072 sc1
  s_branch G_fin_10
G_done1_9:
  s_nop 7
  s_nop 3
  v_mul_f32 v96, s24, v96
  v_mul_f32 v97, s24, v97
  v_cvt_pk_bf16_f32 v128, v96, v97
  v_mul_f32 v98, s24, v98
  v_mul_f32 v99, s24, v99
  v_cvt_pk_bf16_f32 v129, v98, v99
  v_mul_f32 v100, s24, v100
  v_mul_f32 v101, s24, v101
  v_cvt_pk_bf16_f32 v130, v100, v101
  v_mul_f32 v102, s24, v102
  v_mul_f32 v103, s24, v103
  v_cvt_pk_bf16_f32 v131, v102, v103
  buffer_store_dwordx4 v[128:131], v7, s[4:7], s21 offen offset:0 sc1
  v_mul_f32 v104, s24, v104
  v_mul_f32 v105, s24, v105
  v_cvt_pk_bf16_f32 v132, v104, v105
  v_mul_f32 v106, s24, v106
  v_mul_f32 v107, s24, v107
  v_cvt_pk_bf16_f32 v133, v106, v107
  v_mul_f32 v108, s24, v108
  v_mul_f32 v109, s24, v109
  v_cvt_pk_bf16_f32 v134, v108, v109
  v_mul_f32 v110, s24, v110
  v_mul_f32 v111, s24, v111
  v_cvt_pk_bf16_f32 v135, v110, v111
  buffer_store_dwordx4 v[132:135], v7, s[4:7], s21 offen offset:1024 sc1
  v_mul_f32 v112, s24, v112
  v_mul_f32 v113, s24, v113
  v_cvt_pk_bf16_f32 v136, v112, v113
  v_mul_f32 v114, s24, v114
  v_mul_f32 v115, s24, v115
  v_cvt_pk_bf16_f32 v137, v114, v115
  v_mul_f32 v116, s24, v116
  v_mul_f32 v117, s24, v117
  v_cvt_pk_bf16_f32 v138, v116, v117
  v_mul_f32 v118, s24, v118
  v_mul_f32 v119, s24, v119
  v_cvt_pk_bf16_f32 v139, v118, v119
  buffer_store_dwordx4 v[136:139], v7, s[4:7], s21 offen offset:2048 sc1
  v_mul_f32 v120, s24, v120
  v_mul_f32 v121, s24, v121
  v_cvt_pk_bf16_f32 v140, v120, v121
  v_mul_f32 v122, s24, v122
  v_mul_f32 v123, s24, v123
  v_cvt_pk_bf16_f32 v141, v122, v123
  v_mul_f32 v124, s24, v124
  v_mul_f32 v125, s24, v125
  v_cvt_pk_bf16_f32 v142, v124, v125
  v_mul_f32 v126, s24, v126
  v_mul_f32 v127, s24, v127
  v_cvt_pk_bf16_f32 v143, v126, v127
  buffer_store_dwordx4 v[140:143], v7, s[4:7], s21 offen offset:3072 sc1
G_fin_10:
  s_waitcnt vmcnt(0) lgkmcnt(0)
  s_barrier
  s_add_u32 s30, s29, 3
  v_mov_b32 v144, s30
  v_min_u32 v145, 1, v0
  v_lshlrev_b32 v145, 30, v145
  buffer_store_dword v144, v145, s[4:7], s31 offen sc1
P_end_2:
  s_mov_b32 s71, 0
  s_branch M_sg_12
M_sw_11:
  s_sleep 8
  s_add_u32 s71, s71, 1
  s_cmp_gt_u32 s71, 262144
  s_cbranch_scc1 M_exit
M_sg_12:
  s_mov_b32 s79, 0
  s_atomic_or s79, s[74:75], 128 glc
  s_waitcnt lgkmcnt(0)
  s_cmp_lt_u32 s79, 256
  s_cbranch_scc1 M_sw_11
  s_cmp_eq_u32 s65, 6
  s_cbranch_scc1 M_follow
  s_mov_b32 s68, 0
  s_mov_b32 s36, -1
  s_mov_b32 s69, s53
  s_mov_b32 s70, s54
M_att:
  s_mov_b32 s24, 0xf149f2ca
  s_mov_b32 s29, 0
  v_mov_b32 v6, 0
  v_mov_b32 v7, 0
  s_lshl_b32 s26, s16, 11
  v_add_u32 v3, s26, v2
  v_and_b32 v5, 31, v1
  v_lshrrev_b32 v12, 5, v1
  v_lshlrev_b32 v12, 2, v12
  v_sub_u32 v5, v5, v12
  s_lshl_b32 s26, s64, 19
  s_add_u32 s19, s26, 16777216
  s_add_u32 s20, s26, 33554432
  s_lshl_b32 s27, s69, 2
  s_add_u32 s27, s27, s16
  s_lshl_b32 s27, s27, 14
  s_add_u32 s25, s26, s27
  s_bfe_u32 s78, s70, 0x80000
  s_add_u32 s76, s67, 512
  s_mov_b32 s71, 0
  s_branch M_sg_14
M_sw_13:
  s_sleep 8
  s_add_u32 s71, s71, 1
  s_cmp_gt_u32 s71, 262144
  s_cbranch_scc1 M_exit
M_sg_14:
  s_mov_b32 s79, 0
  s_atomic_or s79, s[72:73], s76 glc
  s_waitcnt lgkmcnt(0)
  s_cmp_lt_u32 s79, s78
  s_cbranch_scc1 M_sw_13
  s_bfe_u32 s78, s70, 0x80008
  s_add_u32 s76, s67, 640
  s_mov_b32 s71, 0
  s_branch M_sg_16
M_sw_15:
  s_sleep 8
  s_add_u32 s71, s71, 1
  s_cmp_gt_u32 s71, 262144
  s_cbranch_scc1 M_exit
M_sg_16:
  s_mov_b32 s79, 0
  s_atomic_or s79, s[72:73], s76 glc
  s_waitcnt lgkmcnt(0)
  s_cmp_lt_u32 s79, s78
  s_cbranch_scc1 M_sw_15
  s_lshl_b32 s27, s69, 16
  s_add_u32 s27, s27, 16384
  s_add_u32 s17, s19, s27
M_kv_17:
  s_cmp_ge_u32 s17, s36
  s_cbranch_scc1 M_kvok_18
  s_mov_b32 s76, 0
  s_mov_b32 s78, 23
  s_mov_b32 s77, 335872
  s_cmp_eq_u32 s68, 1
  s_cmov_b32 s76, 128
  s_cmov_b32 s78, 27
  s_cmov_b32 s77, 114688
  s_cmp_eq_u32 s68, 2
  s_cmov_b32 s76, 768
  s_cmov_b32 s78, 14
  s_cmov_b32 s77, 0
  s_add_u32 s76, s76, s67
  s_mov_b32 s71, 0
  s_branch M_sg_20
M_sw_19:
  s_sleep 8
  s_add_u32 s71, s71, 1
  s_cmp_gt_u32 s71, 262144
  s_cbranch_scc1 M_exit
M_sg_20:
  s_mov_b32 s79, 0
  s_atomic_or s79, s[72:73], s76 glc
  s_waitcnt lgkmcnt(0)
  s_cmp_lt_u32 s79, s78
  s_cbranch_scc1 M_sw_19
  s_add_u32 s36, s77, s19
  s_add_u32 s68, s68, 1
  s_branch M_kv_17
M_kvok_18:
  s_add_u32 s28, s25, 0
  buffer_load_dwordx4 a[128:131], v2, s[4:7], s28 offen offset:0 sc1
  buffer_load_dwordx4 a[132:135], v2, s[4:7], s28 offen offset:1024 sc1
  buffer_load_dwordx4 a[136:139], v2, s[4:7], s28 offen offset:2048 sc1
  buffer_load_dwordx4 a[140:143], v2, s[4:7], s28 offen offset:3072 sc1
  s_add_u32 s28, s25, 4096
  buffer_load_dwordx4 a[144:147], v2, s[4:7], s28 offen offset:0 sc1
  buffer_load_dwordx4 a[148:151], v2, s[4:7], s28 offen offset:1024 sc1
  buffer_load_dwordx4 a[152:155], v2, s[4:7], s28 offen offset:2048 sc1
  buffer_load_dwordx4 a[156:159], v2, s[4:7], s28 offen offset:3072 sc1
  s_add_u32 s28, s25, 8192
  buffer_load_dwordx4 a[160:163], v2, s[4:7], s28 offen offset:0 sc1
  buffer_load_dwordx4 a[164:167], v2, s[4:7], s28 offen offset:1024 sc1
  buffer_load_dwordx4 a[168:171], v2, s[4:7], s28 offen offset:2048 sc1
  buffer_load_dwordx4 a[172:175], v2, s[4:7], s28 offen offset:3072 sc1
  s_add_u32 s28, s25, 12288
  buffer_load_dwordx4 a[176:179], v2, s[4:7], s28 offen offset:0 sc1
  buffer_load_dwordx4 a[180:183], v2, s[4:7], s28 offen offset:1024 sc1
  buffer_load_dwordx4 a[184:187], v2, s[4:7], s28 offen offset:2048 sc1
  buffer_load_dwordx4 a[188:191], v2, s[4:7], s28 offen offset:3072 sc1
A_again_21:
  s_lshl_b32 s27, s69, 16
  s_add_u32 s27, s27, 57344
  s_add_u32 s17, s19, s27
  s_add_u32 s18, s20, s27
  s_lshl_b32 s21, s16, 11
  s_mov_b32 m0, s21
  s_nop 0
  buffer_load_dwordx4 v3, s[4:7], s18 offen offset:0 sc1 lds
  buffer_load_dwordx4 v3, s[4:7], s18 offen offset:1024 sc1 lds
  s_add_u32 m0, s21, 8192
  s_nop 0
  buffer_load_dwordx4 v3, s[4:7], s17 offen offset:0 sc1 lds
  buffer_load_dwordx4 v3, s[4:7], s17 offen offset:1024 sc1 lds
  s_add_u32 s18, s18, 8192
  s_sub_u32 s18, s18, 8192
  s_max_i32 s18, s18, s20
  s_sub_u32 s17, s17, 8192
  s_max_i32 s17, s17, s19
  s_add_u32 s21, s21, 16384
  s_and_b32 s21, s21, 131071
  s_mov_b32 m0, s21
  s_nop 0
  buffer_load_dwordx4 v3, s[4:7], s18 offen offset:0 sc1 lds
  buffer_load_dwordx4 v3, s[4:7], s18 offen offset:1024 sc1 lds
  s_add_u32 m0, s21, 8192
  s_nop 0
  buffer_load_dwordx4 v3, s[4:7], s17 offen offset:0 sc1 lds
  buffer_load_dwordx4 v3, s[4:7], s17 offen offset:1024 sc1 lds
  s_sub_u32 s18, s18, 8192
  s_max_i32 s18, s18, s20
  s_sub_u32 s17, s17, 8192
  s_max_i32 s17, s17, s19
  s_add_u32 s21, s21, 16384
  s_and_b32 s21, s21, 131071
  s_mov_b32 m0, s21
  s_nop 0
  buffer_load_dwordx4 v3, s[4:7], s18 offen offset:0 sc1 lds
  buffer_load_dwordx4 v3, s[4:7], s18 offen offset:1024 sc1 lds
  s_add_u32 m0, s21, 8192
  s_nop 0
  buffer_load_dwordx4 v3, s[4:7], s17 offen offset:0 sc1 lds
  buffer_load_dwordx4 v3, s[4:7], s17 offen offset:1024 sc1 lds
  s_sub_u32 s18, s18, 8192
  s_max_i32 s18, s18, s20
  s_sub_u32 s17, s17, 8192
  s_max_i32 s17, s17, s19
  s_add_u32 s21, s21, 16384
  s_and_b32 s21, s21, 131071
  s_mov_b32 m0, s21
  s_nop 0
  buffer_load_dwordx4 v3, s[4:7], s18 offen offset:0 sc1 lds
  buffer_load_dwordx4 v3, s[4:7], s18 offen offset:1024 sc1 lds
  s_add_u32 m0, s21, 8192
  s_nop 0
  buffer_load_dwordx4 v3, s[4:7], s17 offen offset:0 sc1 lds
  buffer_load_dwordx4 v3, s[4:7], s17 offen offset:1024 sc1 lds
  s_sub_u32 s18, s18, 8192
  s_max_i32 s18, s18, s20
  s_sub_u32 s17, s17, 8192
  s_max_i32 s17, s17, s19
  s_add_u32 s21, s21, 16384
  s_and_b32 s21, s21, 131071
  s_mov_b32 m0, s21
  s_nop 0
  buffer_load_dwordx4 v3, s[4:7], s18 offen offset:0 sc1 lds
  buffer_load_dwordx4 v3, s[4:7], s18 offen offset:1024 sc1 lds
  s_add_u32 m0, s21, 8192
  s_nop 0
  buffer_load_dwordx4 v3, s[4:7], s17 offen offset:0 sc1 lds
  buffer_load_dwordx4 v3, s[4:7], s17 offen offset:1024 sc1 lds
  s_sub_u32 s18, s18, 8192
  s_max_i32 s18, s18, s20
  s_sub_u32 s17, s17, 8192
  s_max_i32 s17, s17, s19
  s_add_u32 s21, s21, 16384
  s_and_b32 s21, s21, 131071
  s_mov_b32 m0, s21
  s_nop 0
  buffer_load_dwordx4 v3, s[4:7], s18 offen offset:0 sc1 lds
  buffer_load_dwordx4 v3, s[4:7], s18 offen offset:1024 sc1 lds
  s_add_u32 m0, s21, 8192
  s_nop 0
  buffer_load_dwordx4 v3, s[4:7], s17 offen offset:0 sc1 lds
  buffer_load_dwordx4 v3, s[4:7], s17 offen offset:1024 sc1 lds
  v_accvgpr_write_b32 a0, 0
  v_accvgpr_write_b32 a1, 0
  v_accvgpr_write_b32 a2, 0
  v_accvgpr_write_b32 a3, 0
  v_accvgpr_write_b32 a4, 0
  v_accvgpr_write_b32 a5, 0
  v_accvgpr_write_b32 a6, 0
  v_accvgpr_write_b32 a7, 0
  v_accvgpr_write_b32 a8, 0
  v_accvgpr_write_b32 a9, 0
  v_accvgpr_write_b32 a10, 0
  v_accvgpr_write_b32 a11, 0
  v_accvgpr_write_b32 a12, 0
  v_accvgpr_write_b32 a13, 0
  v_accvgpr_write_b32 a14, 0
  v_accvgpr_write_b32 a15, 0
  v_accvgpr_write_b32 a16, 0
  v_accvgpr_write_b32 a17, 0
  v_accvgpr_write_b32 a18, 0
  v_accvgpr_write_b32 a19, 0
  v_accvgpr_write_b32 a20, 0
  v_accvgpr_write_b32 a21, 0
  v_accvgpr_write_b32 a22, 0
  v_accvgpr_write_b32 a23, 0
  v_accvgpr_write_b32 a24, 0
  v_accvgpr_write_b32 a25, 0
  v_accvgpr_write_b32 a26, 0
  v_accvgpr_write_b32 a27, 0
  v_accvgpr_write_b32 a28, 0
  v_accvgpr_write_b32 a29, 0
  v_accvgpr_write_b32 a30, 0
  v_accvgpr_write_b32 a31, 0
  v_accvgpr_write_b32 a32, 0
  v_accvgpr_write_b32 a33, 0
  v_accvgpr_write_b32 a34, 0
  v_accvgpr_write_b32 a35, 0
  v_accvgpr_write_b32 a36, 0
  v_accvgpr_write_b32 a37, 0
  v_accvgpr_write_b32 a38, 0
  v_accvgpr_write_b32 a39, 0
  v_accvgpr_write_b32 a40, 0
  v_accvgpr_write_b32 a41, 0
  v_accvgpr_write_b32 a42, 0
  v_accvgpr_write_b32 a43, 0
  v_accvgpr_write_b32 a44, 0
  v_accvgpr_write_b32 a45, 0
  v_accvgpr_write_b32 a46, 0
  v_accvgpr_write_b32 a47, 0
  v_accvgpr_write_b32 a48, 0
  v_accvgpr_write_b32 a49, 0
  v_accvgpr_write_b32 a50, 0
  v_accvgpr_write_b32 a51, 0
  v_accvgpr_write_b32 a52, 0
  v_accvgpr_write_b32 a53, 0
  v_accvgpr_write_b32 a54, 0
  v_accvgpr_write_b32 a55, 0
  v_accvgpr_write_b32 a56, 0
  v_accvgpr_write_b32 a57, 0
  v_accvgpr_write_b32 a58, 0
  v_accvgpr_write_b32 a59, 0
  v_accvgpr_write_b32 a60, 0
  v_accvgpr_write_b32 a61, 0
  v_accvgpr_write_b32 a62, 0
  v_accvgpr_write_b32 a63, 0
  v_accvgpr_write_b32 a64, 0
  v_accvgpr_write_b32 a65, 0
  v_accvgpr_write_b32 a66, 0
  v_accvgpr_write_b32 a67, 0
  v_accvgpr_write_b32 a68, 0
  v_accvgpr_write_b32 a69, 0
  v_accvgpr_write_b32 a70, 0
  v_accvgpr_write_b32 a71, 0
  v_accvgpr_write_b32 a72, 0
  v_accvgpr_write_b32 a73, 0
  v_accvgpr_write_b32 a74, 0
  v_accvgpr_write_b32 a75, 0
  v_accvgpr_write_b32 a76, 0
  v_accvgpr_write_b32 a77, 0
  v_accvgpr_write_b32 a78, 0
  v_accvgpr_write_b32 a79, 0
  v_accvgpr_write_b32 a80, 0
  v_accvgpr_write_b32 a81, 0
  v_accvgpr_write_b32 a82, 0
  v_accvgpr_write_b32 a83, 0
  v_accvgpr_write_b32 a84, 0
  v_accvgpr_write_b32 a85, 0
  v_accvgpr_write_b32 a86, 0
  v_accvgpr_write_b32 a87, 0
  v_accvgpr_write_b32 a88, 0
  v_accvgpr_write_b32 a89, 0
  v_accvgpr_write_b32 a90, 0
  v_accvgpr_write_b32 a91, 0
  v_accvgpr_write_b32 a92, 0
  v_accvgpr_write_b32 a93, 0
  v_accvgpr_write_b32 a94, 0
  v_accvgpr_write_b32 a95, 0
  v_accvgpr_write_b32 a96, 0
  v_accvgpr_write_b32 a97, 0
  v_accvgpr_write_b32 a98, 0
  v_accvgpr_write_b32 a99, 0
  v_accvgpr_write_b32 a100, 0
  v_accvgpr_write_b32 a101, 0
  v_accvgpr_write_b32 a102, 0
  v_accvgpr_write_b32 a103, 0
  v_accvgpr_write_b32 a104, 0
  v_accvgpr_write_b32 a105, 0
  v_accvgpr_write_b32 a106, 0
  v_accvgpr_write_b32 a107, 0
  v_accvgpr_write_b32 a108, 0
  v_accvgpr_write_b32 a109, 0
  v_accvgpr_write_b32 a110, 0
  v_accvgpr_write_b32 a111, 0
  v_accvgpr_write_b32 a112, 0
  v_accvgpr_write_b32 a113, 0
  v_accvgpr_write_b32 a114, 0
  v_accvgpr_write_b32 a115, 0
  v_accvgpr_write_b32 a116, 0
  v_accvgpr_write_b32 a117, 0
  v_accvgpr_write_b32 a118, 0
  v_accvgpr_write_b32 a119, 0
  v_accvgpr_write_b32 a120, 0
  v_accvgpr_write_b32 a121, 0
  v_accvgpr_write_b32 a122, 0
  v_accvgpr_write_b32 a123, 0
  v_accvgpr_write_b32 a124, 0
  v_accvgpr_write_b32 a125, 0
  v_accvgpr_write_b32 a126, 0
  v_accvgpr_write_b32 a127, 0
  v_mov_b32 v8, 0
  v_mov_b32 v9, 0
  v_mov_b32 v10, 0
  v_mov_b32 v11, 0
  v_mov_b32 v52, 0
  v_mov_b32 v53, 0
  v_mov_b32 v54, s24
  v_mov_b32 v55, s24
  v_mov_b32 v56, s24
  v_mov_b32 v57, s24
  v_mov_b32 v58, s24
  v_mov_b32 v59, s24
  v_mov_b32 v60, s24
  v_mov_b32 v61, s24
  v_mov_b32 v62, s24
  v_mov_b32 v63, s24
  v_mov_b32 v104, 0
  v_mov_b32 v105, 0
  v_mov_b32 v4, v2
  v_mov_b32 v64, s24
  v_mov_b32 v65, s24
  v_mov_b32 v66, s24
  v_mov_b32 v67, s24
  v_mov_b32 v68, s24
  v_mov_b32 v69, s24
  v_mov_b32 v70, s24
  v_mov_b32 v71, s24
  v_mov_b32 v72, s24
  v_mov_b32 v73, s24
  v_mov_b32 v74, s24
  v_mov_b32 v75, s24
  v_mov_b32 v76, s24
  v_mov_b32 v77, s24
  v_mov_b32 v78, s24
  v_mov_b32 v79, s24
  v_mov_b32 v12, s24
  v_cmp_le_i32 s[40:41], 0, v5
  v_cmp_le_i32 s[42:43], 1, v5
  v_cmp_le_i32 s[44:45], 2, v5
  v_cmp_le_i32 s[46:47], 3, v5
  v_cndmask_b32 v80, v12, v7, s[40:41]
  v_cndmask_b32 v81, v12, v7, s[42:43]
  v_cndmask_b32 v82, v12, v7, s[44:45]
  v_cndmask_b32 v83, v12, v7, s[46:47]
  v_cmp_le_i32 s[40:41], 8, v5
  v_cmp_le_i32 s[42:43], 9, v5
  v_cmp_le_i32 s[44:45], 10, v5
  v_cmp_le_i32 s[46:47], 11, v5
  v_cndmask_b32 v84, v12, v7, s[40:41]
  v_cndmask_b32 v85, v12, v7, s[42:43]
  v_cndmask_b32 v86, v12, v7, s[44:45]
  v_cndmask_b32 v87, v12, v7, s[46:47]
  v_cmp_le_i32 s[40:41], 16, v5
  v_cmp_le_i32 s[42:43], 17, v5
  v_cmp_le_i32 s[44:45], 18, v5
  v_cmp_le_i32 s[46:47], 19, v5
  v_cndmask_b32 v88, v12, v7, s[40:41]
  v_cndmask_b32 v89, v12, v7, s[42:43]
  v_cndmask_b32 v90, v12, v7, s[44:45]
  v_cndmask_b32 v91, v12, v7, s[46:47]
  v_cmp_le_i32 s[40:41], 24, v5
  v_cmp_le_i32 s[42:43], 25, v5
  v_cmp_le_i32 s[44:45], 26, v5
  v_cmp_le_i32 s[46:47], 27, v5
  v_cndmask_b32 v92, v12, v7, s[40:41]
  v_cndmask_b32 v93, v12, v7, s[42:43]
  v_cndmask_b32 v94, v12, v7, s[44:45]
  v_cndmask_b32 v95, v12, v7, s[46:47]
  s_lshl_b32 s22, s69, 3
  s_add_u32 s22, s22, 8
  s_lshl_b32 s26, s16, 1
  s_sub_u32 s23, 6, s26
  s_waitcnt vmcnt(20)
  s_barrier
  s_cmp_eq_u32 s23, 0
  s_cbranch_scc1 A_go_23
A_idle_22:
  s_waitcnt vmcnt(16)
  s_barrier
  s_sub_u32 s18, s18, 8192
  s_max_i32 s18, s18, s20
  s_sub_u32 s17, s17, 8192
  s_max_i32 s17, s17, s19
  s_add_u32 s21, s21, 16384
  s_and_b32 s21, s21, 131071
M_kv_24:
  s_cmp_ge_u32 s17, s36
  s_cbranch_scc1 M_kvok_25
  s_mov_b32 s76, 0
  s_mov_b32 s78, 23
  s_mov_b32 s77, 335872
  s_cmp_eq_u32 s68, 1
  s_cmov_b32 s76, 128
  s_cmov_b32 s78, 27
  s_cmov_b32 s77, 114688
  s_cmp_eq_u32 s68, 2
  s_cmov_b32 s76, 768
  s_cmov_b32 s78, 14
  s_cmov_b32 s77, 0
  s_add_u32 s76, s76, s67
  s_mov_b32 s71, 0
  s_branch M_sg_27
M_sw_26:
  s_sleep 8
  s_add_u32 s71, s71, 1
  s_cmp_gt_u32 s71, 262144
  s_cbranch_scc1 M_exit
M_sg_27:
  s_mov_b32 s79, 0
  s_atomic_or s79, s[72:73], s76 glc
  s_waitcnt lgkmcnt(0)
  s_cmp_lt_u32 s79, s78
  s_cbranch_scc1 M_sw_26
  s_add_u32 s36, s77, s19
  s_add_u32 s68, s68, 1
  s_branch M_kv_24
M_kvok_25:
  s_mov_b32 m0, s21
  s_nop 0
  buffer_load_dwordx4 v3, s[4:7], s18 offen offset:0 sc1 lds
  buffer_load_dwordx4 v3, s[4:7], s18 offen offset:1024 sc1 lds
  s_add_u32 m0, s21, 8192
  s_nop 0
  buffer_load_dwordx4 v3, s[4:7], s17 offen offset:0 sc1 lds
  buffer_load_dwordx4 v3, s[4:7], s17 offen offset:1024 sc1 lds
  v_add_u32 v4, 16384, v4
  v_and_b32 v4, 131071, v4
  s_sub_u32 s22, s22, 1
  s_sub_u32 s23, s23, 1
  s_cmp_lg_u32 s23, 0
  s_cbranch_scc1 A_idle_22
A_go_23:
  ds_read_b128 a[224:227], v4 offset:0
  ds_read_b128 a[228:231], v4 offset:2048
  ds_read_b128 a[232:235], v4 offset:4096
  ds_read_b128 a[236:239], v4 offset:6144
  ds_read_b128 a[240:243], v4 offset:1024
  ds_read_b128 a[244:247], v4 offset:3072
  ds_read_b128 a[248:251], v4 offset:5120
  ds_read_b128 a[252:255], v4 offset:7168
  ds_read_b128 a[192:195], v4 offset:8192
  ds_read_b128 a[196:199], v4 offset:9216
  ds_read_b128 a[200:203], v4 offset:10240
  ds_read_b128 a[204:207], v4 offset:11264
  ds_read_b128 a[208:211], v4 offset:12288
  ds_read_b128 a[212:215], v4 offset:13312
  ds_read_b128 a[216:219], v4 offset:14336
  ds_read_b128 a[220:223], v4 offset:15360
  v_add_u32 v4, 16384, v4
  v_and_b32 v4, 131071, v4
  s_waitcnt lgkmcnt(8)
.p2align 6
A_top_28:
  s_waitcnt lgkmcnt(7)
  v_mfma_f32_32x32x16_bf16 v[32:47], a[192:195], a[128:131], v[64:79]
  s_waitcnt lgkmcnt(6)
  v_exp_f32 v54, v54
  v_add_f32 v11, v11, v53
  v_cvt_pk_bf16_f32 v106, v52, v53
  v_mfma_f32_32x32x16_bf16 v[32:47], a[196:199], a[132:135], v[32:47]
  s_waitcnt lgkmcnt(4)
  v_exp_f32 v55, v55
  v_add_f32 v10, v10, v54
  v_mfma_f32_32x32x16_bf16 v[32:47], a[200:203], a[136:139], v[32:47]
  v_exp_f32 v56, v56
  v_add_f32 v11, v11, v55
  v_cvt_pk_bf16_f32 v107, v54, v55
  v_mfma_f32_32x32x16_bf16 v[32:47], a[204:207], a[140:143], v[32:47]
  s_waitcnt lgkmcnt(2)
  v_exp_f32 v57, v57
  v_add_f32 v10, v10, v56
  v_mfma_f32_32x32x16_bf16 v[32:47], a[208:211], a[144:147], v[32:47]
  v_exp_f32 v58, v58
  v_add_f32 v11, v11, v57
  v_cvt_pk_bf16_f32 v108, v56, v57
  v_mfma_f32_32x32x16_bf16 v[32:47], a[212:215], a[148:151], v[32:47]
  s_waitcnt lgkmcnt(0)
  v_exp_f32 v59, v59
  v_add_f32 v10, v10, v58
  v_mfma_f32_32x32x16_bf16 v[32:47], a[216:219], a[152:155], v[32:47]
  v_exp_f32 v60, v60
  v_add_f32 v11, v11, v59
  v_cvt_pk_bf16_f32 v109, v58, v59
  v_mfma_f32_32x32x16_bf16 v[32:47], a[220:223], a[156:159], v[32:47]
  s_waitcnt vmcnt(16)
  s_barrier
  v_exp_f32 v61, v61
  v_add_f32 v10, v10, v60
  v_mfma_f32_32x32x16_bf16 a[64:79], a[224:227], v[104:107], a[64:79]
  ds_read_b128 a[224:227], v4 offset:0
  v_exp_f32 v62, v62
  v_add_f32 v11, v11, v61
  v_cvt_pk_bf16_f32 v110, v60, v61
  v_mfma_f32_32x32x16_bf16 a[80:95], a[228:231], v[104:107], a[80:95]
  s_sub_u32 s18, s18, 8192
  ds_read_b128 a[228:231], v4 offset:2048
  v_exp_f32 v63, v63
  v_add_f32 v10, v10, v62
  v_mfma_f32_32x32x16_bf16 a[96:111], a[232:235], v[104:107], a[96:111]
  s_max_i32 s18, s18, s20
  ds_read_b128 a[232:235], v4 offset:4096
  v_exp_f32 v32, v32
  v_add_f32 v11, v11, v63
  v_cvt_pk_bf16_f32 v111, v62, v63
  v_mfma_f32_32x32x16_bf16 a[112:127], a[236:239], v[104:107], a[112:127]
  s_sub_u32 s17, s17, 8192
  ds_read_b128 a[236:239], v4 offset:6144
  v_exp_f32 v33, v33
  v_add_f32 v8, v8, v32
  v_mfma_f32_32x32x16_bf16 a[64:79], a[240:243], v[108:111], a[64:79]
  s_max_i32 s17, s17, s19
  ds_read_b128 a[240:243], v4 offset:1024
  v_exp_f32 v34, v34
  v_add_f32 v9, v9, v33
  v_cvt_pk_bf16_f32 v96, v32, v33
  v_mfma_f32_32x32x16_bf16 a[80:95], a[244:247], v[108:111], a[80:95]
  s_add_u32 s21, s21, 16384
  ds_read_b128 a[244:247], v4 offset:3072
  v_exp_f32 v35, v35
  v_add_f32 v8, v8, v34
  v_mfma_f32_32x32x16_bf16 a[96:111], a[248:251], v[108:111], a[96:111]
  s_and_b32 s21, s21, 131071
  ds_read_b128 a[248:251], v4 offset:5120
  v_exp_f32 v36, v36
  v_add_f32 v9, v9, v35
  v_cvt_pk_bf16_f32 v97, v34, v35
  v_mfma_f32_32x32x16_bf16 a[112:127], a[252:255], v[108:111], a[112:127]
  ds_read_b128 a[252:255], v4 offset:7168
  v_exp_f32 v37, v37
  v_add_f32 v8, v8, v36
  v_mfma_f32_32x32x16_bf16 v[48:63], a[192:195], a[160:163], v[80:95]
  s_add_u32 s23, s23, 1
  ds_read_b128 a[192:195], v4 offset:8192
  v_exp_f32 v38, v38
  v_add_f32 v9, v9, v37
  v_cvt_pk_bf16_f32 v98, v36, v37
  v_mfma_f32_32x32x16_bf16 v[48:63], a[196:199], a[164:167], v[48:63]
  s_sub_u32 s22, s22, 1
  ds_read_b128 a[196:199], v4 offset:9216
  v_exp_f32 v39, v39
  v_add_f32 v8, v8, v38
  v_mfma_f32_32x32x16_bf16 v[48:63], a[200:203], a[168:171], v[48:63]
  s_cmp_lt_u32 s23, 3
  ds_read_b128 a[200:203], v4 offset:10240
  v_exp_f32 v40, v40
  v_add_f32 v9, v9, v39
  v_cvt_pk_bf16_f32 v99, v38, v39
  v_mfma_f32_32x32x16_bf16 v[48:63], a[204:207], a[172:175], v[48:63]
  s_cbranch_scc1 A_upd_29
A_back_30:
  ds_read_b128 a[204:207], v4 offset:11264
  v_exp_f32 v41, v41
  v_add_f32 v8, v8, v40
  v_mfma_f32_32x32x16_bf16 v[48:63], a[208:211], a[176:179], v[48:63]
  s_cmp_lt_u32 s17, s36
  ds_read_b128 a[208:211], v4 offset:12288
  v_exp_f32 v42, v42
  v_add_f32 v9, v9, v41
  v_cvt_pk_bf16_f32 v100, v40, v41
  v_mfma_f32_32x32x16_bf16 v[48:63], a[212:215], a[180:183], v[48:63]
  s_cbranch_scc1 A_kvw_32
A_kvb_33:
  ds_read_b128 a[212:215], v4 offset:13312
  v_exp_f32 v43, v43
  v_add_f32 v8, v8, v42
  v_mfma_f32_32x32x16_bf16 v[48:63], a[216:219], a[184:187], v[48:63]
  s_mov_b32 m0, s21
  ds_read_b128 a[216:219], v4 offset:14336
  v_exp_f32 v44, v44
  v_add_f32 v9, v9, v43
  v_cvt_pk_bf16_f32 v101, v42, v43
  v_mfma_f32_32x32x16_bf16 v[48:63], a[220:223], a[188:191], v[48:63]
  s_waitcnt lgkmcnt(13)
  ds_read_b128 a[220:223], v4 offset:15360
  v_exp_f32 v45, v45
  v_add_f32 v8, v8, v44
  v_mfma_f32_32x32x16_bf16 a[0:15], a[224:227], v[96:99], a[0:15]
  buffer_load_dwordx4 v3, s[4:7], s18 offen offset:0 sc1 lds
  v_exp_f32 v46, v46
  v_add_f32 v9, v9, v45
  v_cvt_pk_bf16_f32 v102, v44, v45
  v_mfma_f32_32x32x16_bf16 a[16:31], a[228:231], v[96:99], a[16:31]
  s_waitcnt lgkmcnt(12)
  v_exp_f32 v47, v47
  v_add_f32 v8, v8, v46
  v_add_u32 v4, 16384, v4
  v_mfma_f32_32x32x16_bf16 a[32:47], a[232:235], v[96:99], a[32:47]
  buffer_load_dwordx4 v3, s[4:7], s18 offen offset:1024 sc1 lds
  v_exp_f32 v48, v48
  v_add_f32 v9, v9, v47
  v_cvt_pk_bf16_f32 v103, v46, v47
  v_mfma_f32_32x32x16_bf16 a[48:63], a[236:239], v[96:99], a[48:63]
  s_waitcnt lgkmcnt(10)
  s_add_u32 m0, s21, 8192
  v_exp_f32 v49, v49
  v_add_f32 v10, v10, v48
  v_and_b32 v4, 131071, v4
  v_mfma_f32_32x32x16_bf16 a[0:15], a[240:243], v[100:103], a[0:15]
  buffer_load_dwordx4 v3, s[4:7], s17 offen offset:0 sc1 lds
  v_exp_f32 v50, v50
  v_add_f32 v11, v11, v49
  v_cvt_pk_bf16_f32 v104, v48, v49
  v_mfma_f32_32x32x16_bf16 a[16:31], a[244:247], v[100:103], a[16:31]
  s_waitcnt lgkmcnt(8)
  s_cmp_lg_u32 s22, 0
  v_exp_f32 v51, v51
  v_add_f32 v10, v10, v50
  v_mfma_f32_32x32x16_bf16 a[32:47], a[248:251], v[100:103], a[32:47]
  buffer_load_dwordx4 v3, s[4:7], s17 offen offset:1024 sc1 lds
  v_exp_f32 v52, v52
  v_add_f32 v11, v11, v51
  v_cvt_pk_bf16_f32 v105, v50, v51
  v_mfma_f32_32x32x16_bf16 a[48:63], a[252:255], v[100:103], a[48:63]
  v_exp_f32 v53, v53
  v_add_f32 v10, v10, v52
  s_cbranch_scc1 A_top_28
  v_exp_f32 v54, v54
  v_add_f32 v11, v11, v53
  v_cvt_pk_bf16_f32 v106, v52, v53
  v_exp_f32 v55, v55
  v_add_f32 v10, v10, v54
  v_exp_f32 v56, v56
  v_add_f32 v11, v11, v55
  v_cvt_pk_bf16_f32 v107, v54, v55
  v_exp_f32 v57, v57
  v_add_f32 v10, v10, v56
  v_exp_f32 v58, v58
  v_add_f32 v11, v11, v57
  v_cvt_pk_bf16_f32 v108, v56, v57
  v_exp_f32 v59, v59
  v_add_f32 v10, v10, v58
  v_exp_f32 v60, v60
  v_add_f32 v11, v11, v59
  v_cvt_pk_bf16_f32 v109, v58, v59
  v_exp_f32 v61, v61
  v_add_f32 v10, v10, v60
  v_exp_f32 v62, v62
  v_add_f32 v11, v11, v61
  v_cvt_pk_bf16_f32 v110, v60, v61
  v_exp_f32 v63, v63
  v_add_f32 v10, v10, v62
  v_add_f32 v11, v11, v63
  v_cvt_pk_bf16_f32 v111, v62, v63
  s_nop 1
  v_mfma_f32_32x32x16_bf16 a[64:79], a[224:227], v[104:107], a[64:79]
  v_mfma_f32_32x32x16_bf16 a[80:95], a[228:231], v[104:107], a[80:95]
  v_mfma_f32_32x32x16_bf16 a[96:111], a[232:235], v[104:107], a[96:111]
  v_mfma_f32_32x32x16_bf16 a[112:127], a[236:239], v[104:107], a[112:127]
  v_mfma_f32_32x32x16_bf16 a[64:79], a[240:243], v[108:111], a[64:79]
  v_mfma_f32_32x32x16_bf16 a[80:95], a[244:247], v[108:111], a[80:95]
  v_mfma_f32_32x32x16_bf16 a[96:111], a[248:251], v[108:111], a[96:111]
  v_mfma_f32_32x32x16_bf16 a[112:127], a[252:255], v[108:111], a[112:127]
  v_add_f32 v8, v8, v9
  v_mov_b32 v9, v8
  s_nop 1
  v_permlane32_swap_b32 v8, v9
  s_nop 1
  v_add_f32 v8, v8, v9
  v_add_f32 v10, v10, v11
  v_mov_b32 v11, v10
  s_nop 1
  v_permlane32_swap_b32 v10, v11
  s_nop 1
  v_add_f32 v10, v10, v11
  v_subrev_u32 v12, 0x2f800000, v8
  v_subrev_u32 v13, 0x2f800000, v10
  v_max_u32 v12, v12, v13
  v_cmp_le_u32 vcc, 0x28000000, v12
  s_nop 1
  s_cmp_lg_u64 vcc, 0
  s_cselect_b32 s26, 1, 0
  v_mov_b32 v12, s26
  s_lshl_b32 s26, s16, 2
  s_add_u32 s26, s26, 131072
  v_mov_b32 v13, s26
  ds_write_b32 v13, v12
  v_mov_b32 v14, 131072
  s_waitcnt vmcnt(0) lgkmcnt(0)
  s_barrier
  ds_read_b128 v[16:19], v14
  v_rcp_f32 v8, v8
  v_rcp_f32 v10, v10
  s_waitcnt lgkmcnt(0)
  v_or3_b32 v12, v16, v17, v18
  v_or_b32 v12, v12, v19
  s_nop 0
  v_readfirstlane_b32 s26, v12
  s_nop 1
  s_cmp_gt_u32 s26, s29
  s_cbranch_scc1 A_slow_34
  s_add_u32 s28, s25, 100663296
  v_accvgpr_read_b32 v112, a0
  v_accvgpr_read_b32 v113, a1
  v_accvgpr_read_b32 v114, a2
  v_accvgpr_read_b32 v115, a3
  v_accvgpr_read_b32 v116, a4
  v_accvgpr_read_b32 v117, a5
  v_accvgpr_read_b32 v118, a6
  v_accvgpr_read_b32 v119, a7
  v_pk_mul_f32 v[112:113], v[112:113], v[8:9] op_sel_hi:[1,0]
  v_pk_mul_f32 v[114:115], v[114:115], v[8:9] op_sel_hi:[1,0]
  v_pk_mul_f32 v[116:117], v[116:117], v[8:9] op_sel_hi:[1,0]
  v_pk_mul_f32 v[118:119], v[118:119], v[8:9] op_sel_hi:[1,0]
  v_cvt_pk_bf16_f32 v120, v112, v113
  v_cvt_pk_bf16_f32 v121, v114, v115
  v_cvt_pk_bf16_f32 v122, v116, v117
  v_cvt_pk_bf16_f32 v123, v118, v119
  buffer_store_dwordx4 v[120:123], v2, s[4:7], s28 offen offset:0 sc1
  v_accvgpr_read_b32 v124, a8
  v_accvgpr_read_b32 v125, a9
  v_accvgpr_read_b32 v126, a10
  v_accvgpr_read_b32 v127, a11
  v_accvgpr_read_b32 v128, a12
  v_accvgpr_read_b32 v129, a13
  v_accvgpr_read_b32 v130, a14
  v_accvgpr_read_b32 v131, a15
  v_pk_mul_f32 v[124:125], v[124:125], v[8:9] op_sel_hi:[1,0]
  v_pk_mul_f32 v[126:127], v[126:127], v[8:9] op_sel_hi:[1,0]
  v_pk_mul_f32 v[128:129], v[128:129], v[8:9] op_sel_hi:[1,0]
  v_pk_mul_f32 v[130:131], v[130:131], v[8:9] op_sel_hi:[1,0]
  v_cvt_pk_bf16_f32 v132, v124, v125
  v_cvt_pk_bf16_f32 v133, v126, v127
  v_cvt_pk_bf16_f32 v134, v128, v129
  v_cvt_pk_bf16_f32 v135, v130, v131
  buffer_store_dwordx4 v[132:135], v2, s[4:7], s28 offen offset:1024 sc1
  v_accvgpr_read_b32 v136, a16
  v_accvgpr_read_b32 v137, a17
  v_accvgpr_read_b32 v138, a18
  v_accvgpr_read_b32 v139, a19
  v_accvgpr_read_b32 v140, a20
  v_accvgpr_read_b32 v141, a21
  v_accvgpr_read_b32 v142, a22
  v_accvgpr_read_b32 v143, a23
  v_pk_mul_f32 v[136:137], v[136:137], v[8:9] op_sel_hi:[1,0]
  v_pk_mul_f32 v[138:139], v[138:139], v[8:9] op_sel_hi:[1,0]
  v_pk_mul_f32 v[140:141], v[140:141], v[8:9] op_sel_hi:[1,0]
  v_pk_mul_f32 v[142:143], v[142:143], v[8:9] op_sel_hi:[1,0]
  v_cvt_pk_bf16_f32 v144, v136, v137
  v_cvt_pk_bf16_f32 v145, v138, v139
  v_cvt_pk_bf16_f32 v146, v140, v141
  v_cvt_pk_bf16_f32 v147, v142, v143
  buffer_store_dwordx4 v[144:147], v2, s[4:7], s28 offen offset:2048 sc1
  v_accvgpr_read_b32 v148, a24
  v_accvgpr_read_b32 v149, a25
  v_accvgpr_read_b32 v150, a26
  v_accvgpr_read_b32 v151, a27
  v_accvgpr_read_b32 v152, a28
  v_accvgpr_read_b32 v153, a29
  v_accvgpr_read_b32 v154, a30
  v_accvgpr_read_b32 v155, a31
  v_pk_mul_f32 v[148:149], v[148:149], v[8:9] op_sel_hi:[1,0]
  v_pk_mul_f32 v[150:151], v[150:151], v[8:9] op_sel_hi:[1,0]
  v_pk_mul_f32 v[152:153], v[152:153], v[8:9] op_sel_hi:[1,0]
  v_pk_mul_f32 v[154:155], v[154:155], v[8:9] op_sel_hi:[1,0]
  v_cvt_pk_bf16_f32 v156, v148, v149
  v_cvt_pk_bf16_f32 v157, v150, v151
  v_cvt_pk_bf16_f32 v158, v152, v153
  v_cvt_pk_bf16_f32 v159, v154, v155
  buffer_store_dwordx4 v[156:159], v2, s[4:7], s28 offen offset:3072 sc1
  s_add_u32 s28, s25, 100667392
  v_accvgpr_read_b32 v112, a32
  v_accvgpr_read_b32 v113, a33
  v_accvgpr_read_b32 v114, a34
  v_accvgpr_read_b32 v115, a35
  v_accvgpr_read_b32 v116, a36
  v_accvgpr_read_b32 v117, a37
  v_accvgpr_read_b32 v118, a38
  v_accvgpr_read_b32 v119, a39
  v_pk_mul_f32 v[112:113], v[112:113], v[8:9] op_sel_hi:[1,0]
  v_pk_mul_f32 v[114:115], v[114:115], v[8:9] op_sel_hi:[1,0]
  v_pk_mul_f32 v[116:117], v[116:117], v[8:9] op_sel_hi:[1,0]
  v_pk_mul_f32 v[118:119], v[118:119], v[8:9] op_sel_hi:[1,0]
  v_cvt_pk_bf16_f32 v120, v112, v113
  v_cvt_pk_bf16_f32 v121, v114, v115
  v_cvt_pk_bf16_f32 v122, v116, v117
  v_cvt_pk_bf16_f32 v123, v118, v119
  buffer_store_dwordx4 v[120:123], v2, s[4:7], s28 offen offset:0 sc1
  v_accvgpr_read_b32 v124, a40
  v_accvgpr_read_b32 v125, a41
  v_accvgpr_read_b32 v126, a42
  v_accvgpr_read_b32 v127, a43
  v_accvgpr_read_b32 v128, a44
  v_accvgpr_read_b32 v129, a45
  v_accvgpr_read_b32 v130, a46
  v_accvgpr_read_b32 v131, a47
  v_pk_mul_f32 v[124:125], v[124:125], v[8:9] op_sel_hi:[1,0]
  v_pk_mul_f32 v[126:127], v[126:127], v[8:9] op_sel_hi:[1,0]
  v_pk_mul_f32 v[128:129], v[128:129], v[8:9] op_sel_hi:[1,0]
  v_pk_mul_f32 v[130:131], v[130:131], v[8:9] op_sel_hi:[1,0]
  v_cvt_pk_bf16_f32 v132, v124, v125
  v_cvt_pk_bf16_f32 v133, v126, v127
  v_cvt_pk_bf16_f32 v134, v128, v129
  v_cvt_pk_bf16_f32 v135, v130, v131
  buffer_store_dwordx4 v[132:135], v2, s[4:7], s28 offen offset:1024 sc1
  v_accvgpr_read_b32 v136, a48
  v_accvgpr_read_b32 v137, a49
  v_accvgpr_read_b32 v138, a50
  v_accvgpr_read_b32 v139, a51
  v_accvgpr_read_b32 v140, a52
  v_accvgpr_read_b32 v141, a53
  v_accvgpr_read_b32 v142, a54
  v_accvgpr_read_b32 v143, a55
  v_pk_mul_f32 v[136:137], v[136:137], v[8:9] op_sel_hi:[1,0]
  v_pk_mul_f32 v[138:139], v[138:139], v[8:9] op_sel_hi:[1,0]
  v_pk_mul_f32 v[140:141], v[140:141], v[8:9] op_sel_hi:[1,0]
  v_pk_mul_f32 v[142:143], v[142:143], v[8:9] op_sel_hi:[1,0]
  v_cvt_pk_bf16_f32 v144, v136, v137
  v_cvt_pk_bf16_f32 v145, v138, v139
  v_cvt_pk_bf16_f32 v146, v140, v141
  v_cvt_pk_bf16_f32 v147, v142, v143
  buffer_store_dwordx4 v[144:147], v2, s[4:7], s28 offen offset:2048 sc1
  v_accvgpr_read_b32 v148, a56
  v_accvgpr_read_b32 v149, a57
  v_accvgpr_read_b32 v150, a58
  v_accvgpr_read_b32 v151, a59
  v_accvgpr_read_b32 v152, a60
  v_accvgpr_read_b32 v153, a61
  v_accvgpr_read_b32 v154, a62
  v_accvgpr_read_b32 v155, a63
  v_pk_mul_f32 v[148:149], v[148:149], v[8:9] op_sel_hi:[1,0]
  v_pk_mul_f32 v[150:151], v[150:151], v[8:9] op_sel_hi:[1,0]
  v_pk_mul_f32 v[152:153], v[152:153], v[8:9] op_sel_hi:[1,0]
  v_pk_mul_f32 v[154:155], v[154:155], v[8:9] op_sel_hi:[1,0]
  v_cvt_pk_bf16_f32 v156, v148, v149
  v_cvt_pk_bf16_f32 v157, v150, v151
  v_cvt_pk_bf16_f32 v158, v152, v153
  v_cvt_pk_bf16_f32 v159, v154, v155
  buffer_store_dwordx4 v[156:159], v2, s[4:7], s28 offen offset:3072 sc1
  s_add_u32 s28, s25, 100671488
  v_accvgpr_read_b32 v112, a64
  v_accvgpr_read_b32 v113, a65
  v_accvgpr_read_b32 v114, a66
  v_accvgpr_read_b32 v115, a67
  v_accvgpr_read_b32 v116, a68
  v_accvgpr_read_b32 v117, a69
  v_accvgpr_read_b32 v118, a70
  v_accvgpr_read_b32 v119, a71
  v_pk_mul_f32 v[112:113], v[112:113], v[10:11] op_sel_hi:[1,0]
  v_pk_mul_f32 v[114:115], v[114:115], v[10:11] op_sel_hi:[1,0]
  v_pk_mul_f32 v[116:117], v[116:117], v[10:11] op_sel_hi:[1,0]
  v_pk_mul_f32 v[118:119], v[118:119], v[10:11] op_sel_hi:[1,0]
  v_cvt_pk_bf16_f32 v120, v112, v113
  v_cvt_pk_bf16_f32 v121, v114, v115
  v_cvt_pk_bf16_f32 v122, v116, v117
  v_cvt_pk_bf16_f32 v123, v118, v119
  buffer_store_dwordx4 v[120:123], v2, s[4:7], s28 offen offset:0 sc1
  v_accvgpr_read_b32 v124, a72
  v_accvgpr_read_b32 v125, a73
  v_accvgpr_read_b32 v126, a74
  v_accvgpr_read_b32 v127, a75
  v_accvgpr_read_b32 v128, a76
  v_accvgpr_read_b32 v129, a77
  v_accvgpr_read_b32 v130, a78
  v_accvgpr_read_b32 v131, a79
  v_pk_mul_f32 v[124:125], v[124:125], v[10:11] op_sel_hi:[1,0]
  v_pk_mul_f32 v[126:127], v[126:127], v[10:11] op_sel_hi:[1,0]
  v_pk_mul_f32 v[128:129], v[128:129], v[10:11] op_sel_hi:[1,0]
  v_pk_mul_f32 v[130:131], v[130:131], v[10:11] op_sel_hi:[1,0]
  v_cvt_pk_bf16_f32 v132, v124, v125
  v_cvt_pk_bf16_f32 v133, v126, v127
  v_cvt_pk_bf16_f32 v134, v128, v129
  v_cvt_pk_bf16_f32 v135, v130, v131
  buffer_store_dwordx4 v[132:135], v2, s[4:7], s28 offen offset:1024 sc1
  v_accvgpr_read_b32 v136, a80
  v_accvgpr_read_b32 v137, a81
  v_accvgpr_read_b32 v138, a82
  v_accvgpr_read_b32 v139, a83
  v_accvgpr_read_b32 v140, a84
  v_accvgpr_read_b32 v141, a85
  v_accvgpr_read_b32 v142, a86
  v_accvgpr_read_b32 v143, a87
  v_pk_mul_f32 v[136:137], v[136:137], v[10:11] op_sel_hi:[1,0]
  v_pk_mul_f32 v[138:139], v[138:139], v[10:11] op_sel_hi:[1,0]
  v_pk_mul_f32 v[140:141], v[140:141], v[10:11] op_sel_hi:[1,0]
  v_pk_mul_f32 v[142:143], v[142:143], v[10:11] op_sel_hi:[1,0]
  v_cvt_pk_bf16_f32 v144, v136, v137
  v_cvt_pk_bf16_f32 v145, v138, v139
  v_cvt_pk_bf16_f32 v146, v140, v141
  v_cvt_pk_bf16_f32 v147, v142, v143
  buffer_store_dwordx4 v[144:147], v2, s[4:7], s28 offen offset:2048 sc1
  v_accvgpr_read_b32 v148, a88
  v_accvgpr_read_b32 v149, a89
  v_accvgpr_read_b32 v150, a90
  v_accvgpr_read_b32 v151, a91
  v_accvgpr_read_b32 v152, a92
  v_accvgpr_read_b32 v153, a93
  v_accvgpr_read_b32 v154, a94
  v_accvgpr_read_b32 v155, a95
  v_pk_mul_f32 v[148:149], v[148:149], v[10:11] op_sel_hi:[1,0]
  v_pk_mul_f32 v[150:151], v[150:151], v[10:11] op_sel_hi:[1,0]
  v_pk_mul_f32 v[152:153], v[152:153], v[10:11] op_sel_hi:[1,0]
  v_pk_mul_f32 v[154:155], v[154:155], v[10:11] op_sel_hi:[1,0]
  v_cvt_pk_bf16_f32 v156, v148, v149
  v_cvt_pk_bf16_f32 v157, v150, v151
  v_cvt_pk_bf16_f32 v158, v152, v153
  v_cvt_pk_bf16_f32 v159, v154, v155
  buffer_store_dwordx4 v[156:159], v2, s[4:7], s28 offen offset:3072 sc1
  s_add_u32 s28, s25, 100675584
  v_accvgpr_read_b32 v112, a96
  v_accvgpr_read_b32 v113, a97
  v_accvgpr_read_b32 v114, a98
  v_accvgpr_read_b32 v115, a99
  v_accvgpr_read_b32 v116, a100
  v_accvgpr_read_b32 v117, a101
  v_accvgpr_read_b32 v118, a102
  v_accvgpr_read_b32 v119, a103
  v_pk_mul_f32 v[112:113], v[112:113], v[10:11] op_sel_hi:[1,0]
  v_pk_mul_f32 v[114:115], v[114:115], v[10:11] op_sel_hi:[1,0]
  v_pk_mul_f32 v[116:117], v[116:117], v[10:11] op_sel_hi:[1,0]
  v_pk_mul_f32 v[118:119], v[118:119], v[10:11] op_sel_hi:[1,0]
  v_cvt_pk_bf16_f32 v120, v112, v113
  v_cvt_pk_bf16_f32 v121, v114, v115
  v_cvt_pk_bf16_f32 v122, v116, v117
  v_cvt_pk_bf16_f32 v123, v118, v119
  buffer_store_dwordx4 v[120:123], v2, s[4:7], s28 offen offset:0 sc1
  v_accvgpr_read_b32 v124, a104
  v_accvgpr_read_b32 v125, a105
  v_accvgpr_read_b32 v126, a106
  v_accvgpr_read_b32 v127, a107
  v_accvgpr_read_b32 v128, a108
  v_accvgpr_read_b32 v129, a109
  v_accvgpr_read_b32 v130, a110
  v_accvgpr_read_b32 v131, a111
  v_pk_mul_f32 v[124:125], v[124:125], v[10:11] op_sel_hi:[1,0]
  v_pk_mul_f32 v[126:127], v[126:127], v[10:11] op_sel_hi:[1,0]
  v_pk_mul_f32 v[128:129], v[128:129], v[10:11] op_sel_hi:[1,0]
  v_pk_mul_f32 v[130:131], v[130:131], v[10:11] op_sel_hi:[1,0]
  v_cvt_pk_bf16_f32 v132, v124, v125
  v_cvt_pk_bf16_f32 v133, v126, v127
  v_cvt_pk_bf16_f32 v134, v128, v129
  v_cvt_pk_bf16_f32 v135, v130, v131
  buffer_store_dwordx4 v[132:135], v2, s[4:7], s28 offen offset:1024 sc1
  v_accvgpr_read_b32 v136, a112
  v_accvgpr_read_b32 v137, a113
  v_accvgpr_read_b32 v138, a114
  v_accvgpr_read_b32 v139, a115
  v_accvgpr_read_b32 v140, a116
  v_accvgpr_read_b32 v141, a117
  v_accvgpr_read_b32 v142, a118
  v_accvgpr_read_b32 v143, a119
  v_pk_mul_f32 v[136:137], v[136:137], v[10:11] op_sel_hi:[1,0]
  v_pk_mul_f32 v[138:139], v[138:139], v[10:11] op_sel_hi:[1,0]
  v_pk_mul_f32 v[140:141], v[140:141], v[10:11] op_sel_hi:[1,0]
  v_pk_mul_f32 v[142:143], v[142:143], v[10:11] op_sel_hi:[1,0]
  v_cvt_pk_bf16_f32 v144, v136, v137
  v_cvt_pk_bf16_f32 v145, v138, v139
  v_cvt_pk_bf16_f32 v146, v140, v141
  v_cvt_pk_bf16_f32 v147, v142, v143
  buffer_store_dwordx4 v[144:147], v2, s[4:7], s28 offen offset:2048 sc1
  v_accvgpr_read_b32 v148, a120
  v_accvgpr_read_b32 v149, a121
  v_accvgpr_read_b32 v150, a122
  v_accvgpr_read_b32 v151, a123
  v_accvgpr_read_b32 v152, a124
  v_accvgpr_read_b32 v153, a125
  v_accvgpr_read_b32 v154, a126
  v_accvgpr_read_b32 v155, a127
  v_pk_mul_f32 v[148:149], v[148:149], v[10:11] op_sel_hi:[1,0]
  v_pk_mul_f32 v[150:151], v[150:151], v[10:11] op_sel_hi:[1,0]
  v_pk_mul_f32 v[152:153], v[152:153], v[10:11] op_sel_hi:[1,0]
  v_pk_mul_f32 v[154:155], v[154:155], v[10:11] op_sel_hi:[1,0]
  v_cvt_pk_bf16_f32 v156, v148, v149
  v_cvt_pk_bf16_f32 v157, v150, v151
  v_cvt_pk_bf16_f32 v158, v152, v153
  v_cvt_pk_bf16_f32 v159, v154, v155
  buffer_store_dwordx4 v[156:159], v2, s[4:7], s28 offen offset:3072 sc1
  s_branch A_out_31
A_kvw_32:
M_kv_35:
  s_cmp_ge_u32 s17, s36
  s_cbranch_scc1 M_kvok_36
  s_mov_b32 s76, 0
  s_mov_b32 s78, 23
  s_mov_b32 s77, 335872
  s_cmp_eq_u32 s68, 1
  s_cmov_b32 s76, 128
  s_cmov_b32 s78, 27
  s_cmov_b32 s77, 114688
  s_cmp_eq_u32 s68, 2
  s_cmov_b32 s76, 768
  s_cmov_b32 s78, 14
  s_cmov_b32 s77, 0
  s_add_u32 s76, s76, s67
  s_mov_b32 s71, 0
  s_branch M_sg_38
M_sw_37:
  s_sleep 8
  s_add_u32 s71, s71, 1
  s_cmp_gt_u32 s71, 262144
  s_cbranch_scc1 M_exit
M_sg_38:
  s_mov_b32 s79, 0
  s_atomic_or s79, s[72:73], s76 glc
  s_waitcnt lgkmcnt(0)
  s_cmp_lt_u32 s79, s78
  s_cbranch_scc1 M_sw_37
  s_add_u32 s36, s77, s19
  s_add_u32 s68, s68, 1
  s_branch M_kv_35
M_kvok_36:
  s_branch A_kvb_33
A_upd_29:
  s_cmp_eq_u32 s23, 2
  s_cbranch_scc1 A_upd2_39
  v_mov_b32 v12, s24
  v_cmp_le_i32 s[40:41], 0, v5
  v_cmp_le_i32 s[42:43], 1, v5
  v_cmp_le_i32 s[44:45], 2, v5
  v_cmp_le_i32 s[46:47], 3, v5
  v_cndmask_b32 v64, v12, v6, s[40:41]
  v_cndmask_b32 v65, v12, v6, s[42:43]
  v_cndmask_b32 v66, v12, v6, s[44:45]
  v_cndmask_b32 v67, v12, v6, s[46:47]
  v_cmp_le_i32 s[40:41], 8, v5
  v_cmp_le_i32 s[42:43], 9, v5
  v_cmp_le_i32 s[44:45], 10, v5
  v_cmp_le_i32 s[46:47], 11, v5
  v_cndmask_b32 v68, v12, v6, s[40:41]
  v_cndmask_b32 v69, v12, v6, s[42:43]
  v_cndmask_b32 v70, v12, v6, s[44:45]
  v_cndmask_b32 v71, v12, v6, s[46:47]
  v_cmp_le_i32 s[40:41], 16, v5
  v_cmp_le_i32 s[42:43], 17, v5
  v_cmp_le_i32 s[44:45], 18, v5
  v_cmp_le_i32 s[46:47], 19, v5
  v_cndmask_b32 v72, v12, v6, s[40:41]
  v_cndmask_b32 v73, v12, v6, s[42:43]
  v_cndmask_b32 v74, v12, v6, s[44:45]
  v_cndmask_b32 v75, v12, v6, s[46:47]
  v_cmp_le_i32 s[40:41], 24, v5
  v_cmp_le_i32 s[42:43], 25, v5
  v_cmp_le_i32 s[44:45], 26, v5
  v_cmp_le_i32 s[46:47], 27, v5
  v_cndmask_b32 v76, v12, v6, s[40:41]
  v_cndmask_b32 v77, v12, v6, s[42:43]
  v_cndmask_b32 v78, v12, v6, s[44:45]
  v_cndmask_b32 v79, v12, v6, s[46:47]
  v_mov_b32 v80, v7
  v_mov_b32 v81, v7
  v_mov_b32 v82, v7
  v_mov_b32 v83, v7
  v_mov_b32 v84, v7
  v_mov_b32 v85, v7
  v_mov_b32 v86, v7
  v_mov_b32 v87, v7
  v_mov_b32 v88, v7
  v_mov_b32 v89, v7
  v_mov_b32 v90, v7
  v_mov_b32 v91, v7
  v_mov_b32 v92, v7
  v_mov_b32 v93, v7
  v_mov_b32 v94, v7
  v_mov_b32 v95, v7
  s_branch A_back_30
A_upd2_39:
  v_mov_b32 v64, v6
  v_mov_b32 v65, v6
  v_mov_b32 v66, v6
  v_mov_b32 v67, v6
  v_mov_b32 v68, v6
  v_mov_b32 v69, v6
  v_mov_b32 v70, v6
  v_mov_b32 v71, v6
  v_mov_b32 v72, v6
  v_mov_b32 v73, v6
  v_mov_b32 v74, v6
  v_mov_b32 v75, v6
  v_mov_b32 v76, v6
  v_mov_b32 v77, v6
  v_mov_b32 v78, v6
  v_mov_b32 v79, v6
  s_branch A_back_30
A_slow_34:
  s_mov_b32 s29, 1
  v_mov_b32 v64, s24
  v_mov_b32 v65, s24
  v_mov_b32 v66, s24
  v_mov_b32 v67, s24
  v_mov_b32 v68, s24
  v_mov_b32 v69, s24
  v_mov_b32 v70, s24
  v_mov_b32 v71, s24
  v_mov_b32 v72, s24
  v_mov_b32 v73, s24
  v_mov_b32 v74, s24
  v_mov_b32 v75, s24
  v_mov_b32 v76, s24
  v_mov_b32 v77, s24
  v_mov_b32 v78, s24
  v_mov_b32 v79, s24
  v_mov_b32 v12, s24
  v_cmp_le_i32 s[40:41], 0, v5
  v_cmp_le_i32 s[42:43], 1, v5
  v_cmp_le_i32 s[44:45], 2, v5
  v_cmp_le_i32 s[46:47], 3, v5
  v_cndmask_b32 v80, v12, v7, s[40:41]
  v_cndmask_b32 v81, v12, v7, s[42:43]
  v_cndmask_b32 v82, v12, v7, s[44:45]
  v_cndmask_b32 v83, v12, v7, s[46:47]
  v_cmp_le_i32 s[40:41], 8, v5
  v_cmp_le_i32 s[42:43], 9, v5
  v_cmp_le_i32 s[44:45], 10, v5
  v_cmp_le_i32 s[46:47], 11, v5
  v_cndmask_b32 v84, v12, v7, s[40:41]
  v_cndmask_b32 v85, v12, v7, s[42:43]
  v_cndmask_b32 v86, v12, v7, s[44:45]
  v_cndmask_b32 v87, v12, v7, s[46:47]
  v_cmp_le_i32 s[40:41], 16, v5
  v_cmp_le_i32 s[42:43], 17, v5
  v_cmp_le_i32 s[44:45], 18, v5
  v_cmp_le_i32 s[46:47], 19, v5
  v_cndmask_b32 v88, v12, v7, s[40:41]
  v_cndmask_b32 v89, v12, v7, s[42:43]
  v_cndmask_b32 v90, v12, v7, s[44:45]
  v_cndmask_b32 v91, v12, v7, s[46:47]
  v_cmp_le_i32 s[40:41], 24, v5
  v_cmp_le_i32 s[42:43], 25, v5
  v_cmp_le_i32 s[44:45], 26, v5
  v_cmp_le_i32 s[46:47], 27, v5
  v_cndmask_b32 v92, v12, v7, s[40:41]
  v_cndmask_b32 v93, v12, v7, s[42:43]
  v_cndmask_b32 v94, v12, v7, s[44:45]
  v_cndmask_b32 v95, v12, v7, s[46:47]
  v_mov_b32 v8, s24
  v_mov_b32 v10, s24
  s_add_u32 s17, s25, 16785408
  s_mov_b32 s23, 0
A_ml_40:
  s_add_u32 s28, s17, 4096
  buffer_load_dwordx4 a[192:195], v2, s[4:7], s17 offen offset:0 sc1
  buffer_load_dwordx4 a[196:199], v2, s[4:7], s17 offen offset:1024 sc1
  buffer_load_dwordx4 a[200:203], v2, s[4:7], s17 offen offset:2048 sc1
  buffer_load_dwordx4 a[204:207], v2, s[4:7], s17 offen offset:3072 sc1
  buffer_load_dwordx4 a[208:211], v2, s[4:7], s28 offen offset:0 sc1
  buffer_load_dwordx4 a[212:215], v2, s[4:7], s28 offen offset:1024 sc1
  buffer_load_dwordx4 a[216:219], v2, s[4:7], s28 offen offset:2048 sc1
  buffer_load_dwordx4 a[220:223], v2, s[4:7], s28 offen offset:3072 sc1
  s_waitcnt vmcnt(0)
  v_mfma_f32_32x32x16_bf16 v[32:47], a[192:195], a[128:131], v[64:79]
  v_mfma_f32_32x32x16_bf16 v[32:47], a[196:199], a[132:135], v[32:47]
  v_mfma_f32_32x32x16_bf16 v[32:47], a[200:203], a[136:139], v[32:47]
  v_mfma_f32_32x32x16_bf16 v[32:47], a[204:207], a[140:143], v[32:47]
  v_mfma_f32_32x32x16_bf16 v[32:47], a[208:211], a[144:147], v[32:47]
  v_mfma_f32_32x32x16_bf16 v[32:47], a[212:215], a[148:151], v[32:47]
  v_mfma_f32_32x32x16_bf16 v[32:47], a[216:219], a[152:155], v[32:47]
  v_mfma_f32_32x32x16_bf16 v[32:47], a[220:223], a[156:159], v[32:47]
  v_mfma_f32_32x32x16_bf16 v[48:63], a[192:195], a[160:163], v[80:95]
  v_mfma_f32_32x32x16_bf16 v[48:63], a[196:199], a[164:167], v[48:63]
  v_mfma_f32_32x32x16_bf16 v[48:63], a[200:203], a[168:171], v[48:63]
  v_mfma_f32_32x32x16_bf16 v[48:63], a[204:207], a[172:175], v[48:63]
  v_mfma_f32_32x32x16_bf16 v[48:63], a[208:211], a[176:179], v[48:63]
  v_mfma_f32_32x32x16_bf16 v[48:63], a[212:215], a[180:183], v[48:63]
  v_mfma_f32_32x32x16_bf16 v[48:63], a[216:219], a[184:187], v[48:63]
  v_mfma_f32_32x32x16_bf16 v[48:63], a[220:223], a[188:191], v[48:63]
  s_nop 7
  s_nop 3
  v_max3_f32 v8, v8, v32, v33
  v_max3_f32 v8, v8, v34, v35
  v_max3_f32 v8, v8, v36, v37
  v_max3_f32 v8, v8, v38, v39
  v_max3_f32 v8, v8, v40, v41
  v_max3_f32 v8, v8, v42, v43
  v_max3_f32 v8, v8, v44, v45
  v_max3_f32 v8, v8, v46, v47
  v_max3_f32 v10, v10, v48, v49
  v_max3_f32 v10, v10, v50, v51
  v_max3_f32 v10, v10, v52, v53
  v_max3_f32 v10, v10, v54, v55
  v_max3_f32 v10, v10, v56, v57
  v_max3_f32 v10, v10, v58, v59
  v_max3_f32 v10, v10, v60, v61
  v_max3_f32 v10, v10, v62, v63
  s_add_u32 s23, s23, 1
  s_cmp_lg_u32 s23, 1
  s_cbranch_scc1 A_m2_41
  v_mov_b32 v12, s24
  v_cmp_le_i32 s[40:41], 0, v5
  v_cmp_le_i32 s[42:43], 1, v5
  v_cmp_le_i32 s[44:45], 2, v5
  v_cmp_le_i32 s[46:47], 3, v5
  v_cndmask_b32 v64, v12, v6, s[40:41]
  v_cndmask_b32 v65, v12, v6, s[42:43]
  v_cndmask_b32 v66, v12, v6, s[44:45]
  v_cndmask_b32 v67, v12, v6, s[46:47]
  v_cmp_le_i32 s[40:41], 8, v5
  v_cmp_le_i32 s[42:43], 9, v5
  v_cmp_le_i32 s[44:45], 10, v5
  v_cmp_le_i32 s[46:47], 11, v5
  v_cndmask_b32 v68, v12, v6, s[40:41]
  v_cndmask_b32 v69, v12, v6, s[42:43]
  v_cndmask_b32 v70, v12, v6, s[44:45]
  v_cndmask_b32 v71, v12, v6, s[46:47]
  v_cmp_le_i32 s[40:41], 16, v5
  v_cmp_le_i32 s[42:43], 17, v5
  v_cmp_le_i32 s[44:45], 18, v5
  v_cmp_le_i32 s[46:47], 19, v5
  v_cndmask_b32 v72, v12, v6, s[40:41]
  v_cndmask_b32 v73, v12, v6, s[42:43]
  v_cndmask_b32 v74, v12, v6, s[44:45]
  v_cndmask_b32 v75, v12, v6, s[46:47]
  v_cmp_le_i32 s[40:41], 24, v5
  v_cmp_le_i32 s[42:43], 25, v5
  v_cmp_le_i32 s[44:45], 26, v5
  v_cmp_le_i32 s[46:47], 27, v5
  v_cndmask_b32 v76, v12, v6, s[40:41]
  v_cndmask_b32 v77, v12, v6, s[42:43]
  v_cndmask_b32 v78, v12, v6, s[44:45]
  v_cndmask_b32 v79, v12, v6, s[46:47]
  v_mov_b32 v80, v7
  v_mov_b32 v81, v7
  v_mov_b32 v82, v7
  v_mov_b32 v83, v7
  v_mov_b32 v84, v7
  v_mov_b32 v85, v7
  v_mov_b32 v86, v7
  v_mov_b32 v87, v7
  v_mov_b32 v88, v7
  v_mov_b32 v89, v7
  v_mov_b32 v90, v7
  v_mov_b32 v91, v7
  v_mov_b32 v92, v7
  v_mov_b32 v93, v7
  v_mov_b32 v94, v7
  v_mov_b32 v95, v7
A_m2_41:
  s_cmp_lg_u32 s23, 2
  s_cbranch_scc1 A_m3_42
  v_mov_b32 v64, v6
  v_mov_b32 v65, v6
  v_mov_b32 v66, v6
  v_mov_b32 v67, v6
  v_mov_b32 v68, v6
  v_mov_b32 v69, v6
  v_mov_b32 v70, v6
  v_mov_b32 v71, v6
  v_mov_b32 v72, v6
  v_mov_b32 v73, v6
  v_mov_b32 v74, v6
  v_mov_b32 v75, v6
  v_mov_b32 v76, v6
  v_mov_b32 v77, v6
  v_mov_b32 v78, v6
  v_mov_b32 v79, v6
A_m3_42:
  s_sub_u32 s17, s17, 8192
  s_cmp_ge_i32 s17, s19
  s_cbranch_scc1 A_ml_40
  v_mov_b32 v9, v8
  s_nop 1
  v_permlane32_swap_b32 v8, v9
  s_nop 1
  v_max_f32 v8, v8, v9
  v_sub_f32 v6, 0, v8
  v_mov_b32 v11, v10
  s_nop 1
  v_permlane32_swap_b32 v10, v11
  s_nop 1
  v_max_f32 v10, v10, v11
  v_sub_f32 v7, 0, v10
  s_branch A_again_21
A_out_31:
  s_mov_b32 s69, s55
  s_mov_b32 s70, s56
  s_sub_u32 s52, s52, 1
  s_cmp_lg_u32 s52, 0
  s_cbranch_scc1 M_att
  s_waitcnt vmcnt(0)
  s_barrier
  s_mov_b32 s30, 512
  v_mov_b32 v144, s30
  v_min_u32 v145, 1, v0
  v_lshlrev_b32 v145, 30, v145
  buffer_store_dword v144, v145, s[4:7], s31 offen sc1
  s_lshr_b32 s48, s64, 2
  s_bfe_u32 s49, s64, 0x10001
  s_and_b32 s50, s64, 1
  s_mul_i32 s50, s50, 6
  s_add_u32 s50, s50, s65
  s_mov_b32 s51, 12
  s_cmp_lt_u32 s50, 4
  s_cselect_b32 s23, 6, 5
  s_load_dwordx2 s[8:9], s[0:1], 40
  s_lshl_b32 s17, s48, 19
  s_lshl_b32 s26, s49, 2
  s_add_u32 s26, s26, s16
  s_lshl_b32 s27, s26, 7
  s_add_u32 s17, s17, s27
  s_mov_b32 s18, 1024
  s_lshl_b32 s21, s48, 6
  s_add_u32 s21, s21, s50
  s_lshl_b32 s21, s21, 3
  s_add_u32 s21, s21, s26
  s_lshl_b32 s21, s21, 12
  s_add_u32 s21, s21, 150994944
  s_lshl_b32 s22, s51, 15
  s_mov_b32 s24, 1.0
  s_waitcnt lgkmcnt(0)
  s_and_b32 s9, s9, 0xffff
  s_mov_b32 s10, 4194304
  s_mov_b32 s11, 0x20000
  s_mov_b32 s12, s4
  s_mov_b32 s13, s5
  s_mov_b32 s14, 268435456
  s_mov_b32 s15, 0x20000
  s_lshl_b32 s19, s48, 8
  s_add_u32 s19, s19, s50
  s_lshl_b32 s19, s19, 13
  s_add_u32 s19, s19, 100663296
  s_lshl_b32 s20, s51, 13
  s_mul_i32 s26, s16, 524288
  v_add_u32 v8, 0, v2
  v_add_u32 v16, s26, v8
  v_add_u32 v9, 1024, v2
  v_add_u32 v17, s26, v9
  v_add_u32 v10, 2048, v2
  v_add_u32 v18, s26, v10
  v_add_u32 v11, 3072, v2
  v_add_u32 v19, s26, v11
  v_add_u32 v12, 4096, v2
  v_add_u32 v20, s26, v12
  v_add_u32 v13, 5120, v2
  v_add_u32 v21, s26, v13
  v_add_u32 v14, 6144, v2
  v_add_u32 v22, s26, v14
  v_add_u32 v15, 7168, v2
  v_add_u32 v23, s26, v15
  v_lshrrev_b32 v144, 3, v1
  v_mul_lo_u32 v144, v144, s18
  v_and_b32 v145, 7, v1
  v_lshl_add_u32 v144, v145, 4, v144
  s_lshl_b32 s28, s16, 15
  s_add_u32 s28, s28, 32768
  s_lshl_b32 s29, s18, 3
  s_add_u32 m0, s28, 0
  s_nop 0
  buffer_load_dwordx4 v144, s[8:11], s17 offen lds
  s_add_u32 s17, s17, s29
  s_add_u32 m0, s28, 1024
  s_nop 0
  buffer_load_dwordx4 v144, s[8:11], s17 offen lds
  s_add_u32 s17, s17, s29
  s_add_u32 m0, s28, 2048
  s_nop 0
  buffer_load_dwordx4 v144, s[8:11], s17 offen lds
  s_add_u32 s17, s17, s29
  s_add_u32 m0, s28, 3072
  s_nop 0
  buffer_load_dwordx4 v144, s[8:11], s17 offen lds
  s_add_u32 s17, s17, s29
  s_add_u32 m0, s28, 4096
  s_nop 0
  buffer_load_dwordx4 v144, s[8:11], s17 offen lds
  s_add_u32 s17, s17, s29
  s_add_u32 m0, s28, 5120
  s_nop 0
  buffer_load_dwordx4 v144, s[8:11], s17 offen lds
  s_add_u32 s17, s17, s29
  s_add_u32 m0, s28, 6144
  s_nop 0
  buffer_load_dwordx4 v144, s[8:11], s17 offen lds
  s_add_u32 s17, s17, s29
  s_add_u32 m0, s28, 7168
  s_nop 0
  buffer_load_dwordx4 v144, s[8:11], s17 offen lds
  s_add_u32 s17, s17, s29
  s_add_u32 m0, s28, 8192
  s_nop 0
  buffer_load_dwordx4 v144, s[8:11], s17 offen lds
  s_add_u32 s17, s17, s29
  s_add_u32 m0, s28, 9216
  s_nop 0
  buffer_load_dwordx4 v144, s[8:11], s17 offen lds
  s_add_u32 s17, s17, s29
  s_add_u32 m0, s28, 10240
  s_nop 0
  buffer_load_dwordx4 v144, s[8:11], s17 offen lds
  s_add_u32 s17, s17, s29
  s_add_u32 m0, s28, 11264
  s_nop 0
  buffer_load_dwordx4 v144, s[8:11], s17 offen lds
  s_add_u32 s17, s17, s29
  s_add_u32 m0, s28, 12288
  s_nop 0
  buffer_load_dwordx4 v144, s[8:11], s17 offen lds
  s_add_u32 s17, s17, s29
  s_add_u32 m0, s28, 13312
  s_nop 0
  buffer_load_dwordx4 v144, s[8:11], s17 offen lds
  s_add_u32 s17, s17, s29
  s_add_u32 m0, s28, 14336
  s_nop 0
  buffer_load_dwordx4 v144, s[8:11], s17 offen lds
  s_add_u32 s17, s17, s29
  s_add_u32 m0, s28, 15360
  s_nop 0
  buffer_load_dwordx4 v144, s[8:11], s17 offen lds
  s_add_u32 s17, s17, s29
  s_add_u32 m0, s28, 16384
  s_nop 0
  buffer_load_dwordx4 v144, s[8:11], s17 offen lds
  s_add_u32 s17, s17, s29
  s_add_u32 m0, s28, 17408
  s_nop 0
  buffer_load_dwordx4 v144, s[8:11], s17 offen lds
  s_add_u32 s17, s17, s29
  s_add_u32 m0, s28, 18432
  s_nop 0
  buffer_load_dwordx4 v144, s[8:11], s17 offen lds
  s_add_u32 s17, s17, s29
  s_add_u32 m0, s28, 19456
  s_nop 0
  buffer_load_dwordx4 v144, s[8:11], s17 offen lds
  s_add_u32 s17, s17, s29
  s_add_u32 m0, s28, 20480
  s_nop 0
  buffer_load_dwordx4 v144, s[8:11], s17 offen lds
  s_add_u32 s17, s17, s29
  s_add_u32 m0, s28, 21504
  s_nop 0
  buffer_load_dwordx4 v144, s[8:11], s17 offen lds
  s_add_u32 s17, s17, s29
  s_add_u32 m0, s28, 22528
  s_nop 0
  buffer_load_dwordx4 v144, s[8:11], s17 offen lds
  s_add_u32 s17, s17, s29
  s_add_u32 m0, s28, 23552
  s_nop 0
  buffer_load_dwordx4 v144, s[8:11], s17 offen lds
  s_add_u32 s17, s17, s29
  s_add_u32 m0, s28, 24576
  s_nop 0
  buffer_load_dwordx4 v144, s[8:11], s17 offen lds
  s_add_u32 s17, s17, s29
  s_add_u32 m0, s28, 25600
  s_nop 0
  buffer_load_dwordx4 v144, s[8:11], s17 offen lds
  s_add_u32 s17, s17, s29
  s_add_u32 m0, s28, 26624
  s_nop 0
  buffer_load_dwordx4 v144, s[8:11], s17 offen lds
  s_add_u32 s17, s17, s29
  s_add_u32 m0, s28, 27648
  s_nop 0
  buffer_load_dwordx4 v144, s[8:11], s17 offen lds
  s_add_u32 s17, s17, s29
  s_add_u32 m0, s28, 28672
  s_nop 0
  buffer_load_dwordx4 v144, s[8:11], s17 offen lds
  s_add_u32 s17, s17, s29
  s_add_u32 m0, s28, 29696
  s_nop 0
  buffer_load_dwordx4 v144, s[8:11], s17 offen lds
  s_add_u32 s17, s17, s29
  s_add_u32 m0, s28, 30720
  s_nop 0
  buffer_load_dwordx4 v144, s[8:11], s17 offen lds
  s_add_u32 s17, s17, s29
  s_add_u32 m0, s28, 31744
  s_nop 0
  buffer_load_dwordx4 v144, s[8:11], s17 offen lds
  s_add_u32 s17, s17, s29
  v_bfe_u32 v148, v1, 2, 2
  v_lshrrev_b32 v149, 5, v1
  v_lshl_add_u32 v148, v149, 2, v148
  v_lshlrev_b32 v148, 7, v148
  v_bfe_u32 v149, v1, 4, 1
  v_lshl_add_u32 v148, v149, 5, v148
  v_and_b32 v149, 1, v1
  v_lshl_add_u32 v148, v149, 4, v148
  v_bfe_u32 v149, v1, 1, 1
  v_lshl_add_u32 v148, v149, 3, v148
  v_add_u32 v146, s28, v148
  v_add_u32 v147, 1024, v146
  s_waitcnt vmcnt(28)
  ds_read_b64_tr_b16 a[0:1], v146 offset:0
  ds_read_b64_tr_b16 a[2:3], v147 offset:0
  ds_read_b64_tr_b16 a[4:5], v146 offset:64
  ds_read_b64_tr_b16 a[6:7], v147 offset:64
  ds_read_b64_tr_b16 a[8:9], v146 offset:2048
  ds_read_b64_tr_b16 a[10:11], v147 offset:2048
  ds_read_b64_tr_b16 a[12:13], v146 offset:2112
  ds_read_b64_tr_b16 a[14:15], v147 offset:2112
  s_waitcnt lgkmcnt(0)
  s_add_u32 m0, s28, 0
  s_nop 0
  buffer_load_dwordx4 v144, s[8:11], s17 offen lds
  s_add_u32 s17, s17, s29
  s_add_u32 m0, s28, 1024
  s_nop 0
  buffer_load_dwordx4 v144, s[8:11], s17 offen lds
  s_add_u32 s17, s17, s29
  s_add_u32 m0, s28, 2048
  s_nop 0
  buffer_load_dwordx4 v144, s[8:11], s17 offen lds
  s_add_u32 s17, s17, s29
  s_add_u32 m0, s28, 3072
  s_nop 0
  buffer_load_dwordx4 v144, s[8:11], s17 offen lds
  s_add_u32 s17, s17, s29
  s_waitcnt vmcnt(28)
  ds_read_b64_tr_b16 a[16:17], v146 offset:4096
  ds_read_b64_tr_b16 a[18:19], v147 offset:4096
  ds_read_b64_tr_b16 a[20:21], v146 offset:4160
  ds_read_b64_tr_b16 a[22:23], v147 offset:4160
  ds_read_b64_tr_b16 a[24:25], v146 offset:6144
  ds_read_b64_tr_b16 a[26:27], v147 offset:6144
  ds_read_b64_tr_b16 a[28:29], v146 offset:6208
  ds_read_b64_tr_b16 a[30:31], v147 offset:6208
  s_waitcnt lgkmcnt(0)
  s_add_u32 m0, s28, 4096
  s_nop 0
  buffer_load_dwordx4 v144, s[8:11], s17 offen lds
  s_add_u32 s17, s17, s29
  s_add_u32 m0, s28, 5120
  s_nop 0
  buffer_load_dwordx4 v144, s[8:11], s17 offen lds
  s_add_u32 s17, s17, s29
  s_add_u32 m0, s28, 6144
  s_nop 0
  buffer_load_dwordx4 v144, s[8:11], s17 offen lds
  s_add_u32 s17, s17, s29
  s_add_u32 m0, s28, 7168
  s_nop 0
  buffer_load_dwordx4 v144, s[8:11], s17 offen lds
  s_add_u32 s17, s17, s29
  s_waitcnt vmcnt(28)
  ds_read_b64_tr_b16 a[32:33], v146 offset:8192
  ds_read_b64_tr_b16 a[34:35], v147 offset:8192
  ds_read_b64_tr_b16 a[36:37], v146 offset:8256
  ds_read_b64_tr_b16 a[38:39], v147 offset:8256
  ds_read_b64_tr_b16 a[40:41], v146 offset:10240
  ds_read_b64_tr_b16 a[42:43], v147 offset:10240
  ds_read_b64_tr_b16 a[44:45], v146 offset:10304
  ds_read_b64_tr_b16 a[46:47], v147 offset:10304
  s_waitcnt lgkmcnt(0)
  s_add_u32 m0, s28, 8192
  s_nop 0
  buffer_load_dwordx4 v144, s[8:11], s17 offen lds
  s_add_u32 s17, s17, s29
  s_add_u32 m0, s28, 9216
  s_nop 0
  buffer_load_dwordx4 v144, s[8:11], s17 offen lds
  s_add_u32 s17, s17, s29
  s_add_u32 m0, s28, 10240
  s_nop 0
  buffer_load_dwordx4 v144, s[8:11], s17 offen lds
  s_add_u32 s17, s17, s29
  s_add_u32 m0, s28, 11264
  s_nop 0
  buffer_load_dwordx4 v144, s[8:11], s17 offen lds
  s_add_u32 s17, s17, s29
  s_waitcnt vmcnt(28)
  ds_read_b64_tr_b16 a[48:49], v146 offset:12288
  ds_read_b64_tr_b16 a[50:51], v147 offset:12288
  ds_read_b64_tr_b16 a[52:53], v146 offset:12352
  ds_read_b64_tr_b16 a[54:55], v147 offset:12352
  ds_read_b64_tr_b16 a[56:57], v146 offset:14336
  ds_read_b64_tr_b16 a[58:59], v147 offset:14336
  ds_read_b64_tr_b16 a[60:61], v146 offset:14400
  ds_read_b64_tr_b16 a[62:63], v147 offset:14400
  s_waitcnt lgkmcnt(0)
  s_add_u32 m0, s28, 12288
  s_nop 0
  buffer_load_dwordx4 v144, s[8:11], s17 offen lds
  s_add_u32 s17, s17, s29
  s_add_u32 m0, s28, 13312
  s_nop 0
  buffer_load_dwordx4 v144, s[8:11], s17 offen lds
  s_add_u32 s17, s17, s29
  s_add_u32 m0, s28, 14336
  s_nop 0
  buffer_load_dwordx4 v144, s[8:11], s17 offen lds
  s_add_u32 s17, s17, s29
  s_add_u32 m0, s28, 15360
  s_nop 0
  buffer_load_dwordx4 v144, s[8:11], s17 offen lds
  s_add_u32 s17, s17, s29
  s_waitcnt vmcnt(28)
  ds_read_b64_tr_b16 a[64:65], v146 offset:16384
  ds_read_b64_tr_b16 a[66:67], v147 offset:16384
  ds_read_b64_tr_b16 a[68:69], v146 offset:16448
  ds_read_b64_tr_b16 a[70:71], v147 offset:16448
  ds_read_b64_tr_b16 a[72:73], v146 offset:18432
  ds_read_b64_tr_b16 a[74:75], v147 offset:18432
  ds_read_b64_tr_b16 a[76:77], v146 offset:18496
  ds_read_b64_tr_b16 a[78:79], v147 offset:18496
  s_waitcnt lgkmcnt(0)
  s_add_u32 m0, s28, 16384
  s_nop 0
  buffer_load_dwordx4 v144, s[8:11], s17 offen lds
  s_add_u32 s17, s17, s29
  s_add_u32 m0, s28, 17408
  s_nop 0
  buffer_load_dwordx4 v144, s[8:11], s17 offen lds
  s_add_u32 s17, s17, s29
  s_add_u32 m0, s28, 18432
  s_nop 0
  buffer_load_dwordx4 v144, s[8:11], s17 offen lds
  s_add_u32 s17, s17, s29
  s_add_u32 m0, s28, 19456
  s_nop 0
  buffer_load_dwordx4 v144, s[8:11], s17 offen lds
  s_add_u32 s17, s17, s29
  s_waitcnt vmcnt(28)
  ds_read_b64_tr_b16 a[80:81], v146 offset:20480
  ds_read_b64_tr_b16 a[82:83], v147 offset:20480
  ds_read_b64_tr_b16 a[84:85], v146 offset:20544
  ds_read_b64_tr_b16 a[86:87], v147 offset:20544
  ds_read_b64_tr_b16 a[88:89], v146 offset:22528
  ds_read_b64_tr_b16 a[90:91], v147 offset:22528
  ds_read_b64_tr_b16 a[92:93], v146 offset:22592
  ds_read_b64_tr_b16 a[94:95], v147 offset:22592
  s_waitcnt lgkmcnt(0)
  s_add_u32 m0, s28, 20480
  s_nop 0
  buffer_load_dwordx4 v144, s[8:11], s17 offen lds
  s_add_u32 s17, s17, s29
  s_add_u32 m0, s28, 21504
  s_nop 0
  buffer_load_dwordx4 v144, s[8:11], s17 offen lds
  s_add_u32 s17, s17, s29
  s_add_u32 m0, s28, 22528
  s_nop 0
  buffer_load_dwordx4 v144, s[8:11], s17 offen lds
  s_add_u32 s17, s17, s29
  s_add_u32 m0, s28, 23552
  s_nop 0
  buffer_load_dwordx4 v144, s[8:11], s17 offen lds
  s_add_u32 s17, s17, s29
  s_waitcnt vmcnt(28)
  ds_read_b64_tr_b16 a[96:97], v146 offset:24576
  ds_read_b64_tr_b16 a[98:99], v147 offset:24576
  ds_read_b64_tr_b16 a[100:101], v146 offset:24640
  ds_read_b64_tr_b16 a[102:103], v147 offset:24640
  ds_read_b64_tr_b16 a[104:105], v146 offset:26624
  ds_read_b64_tr_b16 a[106:107], v147 offset:26624
  ds_read_b64_tr_b16 a[108:109], v146 offset:26688
  ds_read_b64_tr_b16 a[110:111], v147 offset:26688
  s_waitcnt lgkmcnt(0)
  s_add_u32 m0, s28, 24576
  s_nop 0
  buffer_load_dwordx4 v144, s[8:11], s17 offen lds
  s_add_u32 s17, s17, s29
  s_add_u32 m0, s28, 25600
  s_nop 0
  buffer_load_dwordx4 v144, s[8:11], s17 offen lds
  s_add_u32 s17, s17, s29
  s_add_u32 m0, s28, 26624
  s_nop 0
  buffer_load_dwordx4 v144, s[8:11], s17 offen lds
  s_add_u32 s17, s17, s29
  s_add_u32 m0, s28, 27648
  s_nop 0
  buffer_load_dwordx4 v144, s[8:11], s17 offen lds
  s_add_u32 s17, s17, s29
  s_waitcnt vmcnt(28)
  ds_read_b64_tr_b16 a[112:113], v146 offset:28672
  ds_read_b64_tr_b16 a[114:115], v147 offset:28672
  ds_read_b64_tr_b16 a[116:117], v146 offset:28736
  ds_read_b64_tr_b16 a[118:119], v147 offset:28736
  ds_read_b64_tr_b16 a[120:121], v146 offset:30720
  ds_read_b64_tr_b16 a[122:123], v147 offset:30720
  ds_read_b64_tr_b16 a[124:125], v146 offset:30784
  ds_read_b64_tr_b16 a[126:127], v147 offset:30784
  s_waitcnt lgkmcnt(0)
  s_add_u32 m0, s28, 28672
  s_nop 0
  buffer_load_dwordx4 v144, s[8:11], s17 offen lds
  s_add_u32 s17, s17, s29
  s_add_u32 m0, s28, 29696
  s_nop 0
  buffer_load_dwordx4 v144, s[8:11], s17 offen lds
  s_add_u32 s17, s17, s29
  s_add_u32 m0, s28, 30720
  s_nop 0
  buffer_load_dwordx4 v144, s[8:11], s17 offen lds
  s_add_u32 s17, s17, s29
  s_add_u32 m0, s28, 31744
  s_nop 0
  buffer_load_dwordx4 v144, s[8:11], s17 offen lds
  s_add_u32 s17, s17, s29
  s_waitcnt vmcnt(28)
  ds_read_b64_tr_b16 a[128:129], v146 offset:0
  ds_read_b64_tr_b16 a[130:131], v147 offset:0
  ds_read_b64_tr_b16 a[132:133], v146 offset:64
  ds_read_b64_tr_b16 a[134:135], v147 offset:64
  ds_read_b64_tr_b16 a[136:137], v146 offset:2048
  ds_read_b64_tr_b16 a[138:139], v147 offset:2048
  ds_read_b64_tr_b16 a[140:141], v146 offset:2112
  ds_read_b64_tr_b16 a[142:143], v147 offset:2112
  s_waitcnt lgkmcnt(0)
  s_waitcnt vmcnt(24)
  ds_read_b64_tr_b16 a[144:145], v146 offset:4096
  ds_read_b64_tr_b16 a[146:147], v147 offset:4096
  ds_read_b64_tr_b16 a[148:149], v146 offset:4160
  ds_read_b64_tr_b16 a[150:151], v147 offset:4160
  ds_read_b64_tr_b16 a[152:153], v146 offset:6144
  ds_read_b64_tr_b16 a[154:155], v147 offset:6144
  ds_read_b64_tr_b16 a[156:157], v146 offset:6208
  ds_read_b64_tr_b16 a[158:159], v147 offset:6208
  s_waitcnt lgkmcnt(0)
  s_waitcnt vmcnt(20)
  ds_read_b64_tr_b16 a[160:161], v146 offset:8192
  ds_read_b64_tr_b16 a[162:163], v147 offset:8192
  ds_read_b64_tr_b16 a[164:165], v146 offset:8256
  ds_read_b64_tr_b16 a[166:167], v147 offset:8256
  ds_read_b64_tr_b16 a[168:169], v146 offset:10240
  ds_read_b64_tr_b16 a[170:171], v147 offset:10240
  ds_read_b64_tr_b16 a[172:173], v146 offset:10304
  ds_read_b64_tr_b16 a[174:175], v147 offset:10304
  s_waitcnt lgkmcnt(0)
  s_waitcnt vmcnt(16)
  ds_read_b64_tr_b16 a[176:177], v146 offset:12288
  ds_read_b64_tr_b16 a[178:179], v147 offset:12288
  ds_read_b64_tr_b16 a[180:181], v146 offset:12352
  ds_read_b64_tr_b16 a[182:183], v147 offset:12352
  ds_read_b64_tr_b16 a[184:185], v146 offset:14336
  ds_read_b64_tr_b16 a[186:187], v147 offset:14336
  ds_read_b64_tr_b16 a[188:189], v146 offset:14400
  ds_read_b64_tr_b16 a[190:191], v147 offset:14400
  s_waitcnt lgkmcnt(0)
  s_waitcnt vmcnt(12)
  ds_read_b64_tr_b16 a[192:193], v146 offset:16384
  ds_read_b64_tr_b16 a[194:195], v147 offset:16384
  ds_read_b64_tr_b16 a[196:197], v146 offset:16448
  ds_read_b64_tr_b16 a[198:199], v147 offset:16448
  ds_read_b64_tr_b16 a[200:201], v146 offset:18432
  ds_read_b64_tr_b16 a[202:203], v147 offset:18432
  ds_read_b64_tr_b16 a[204:205], v146 offset:18496
  ds_read_b64_tr_b16 a[206:207], v147 offset:18496
  s_waitcnt lgkmcnt(0)
  s_waitcnt vmcnt(8)
  ds_read_b64_tr_b16 a[208:209], v146 offset:20480
  ds_read_b64_tr_b16 a[210:211], v147 offset:20480
  ds_read_b64_tr_b16 a[212:213], v146 offset:20544
  ds_read_b64_tr_b16 a[214:215], v147 offset:20544
  ds_read_b64_tr_b16 a[216:217], v146 offset:22528
  ds_read_b64_tr_b16 a[218:219], v147 offset:22528
  ds_read_b64_tr_b16 a[220:221], v146 offset:22592
  ds_read_b64_tr_b16 a[222:223], v147 offset:22592
  s_waitcnt lgkmcnt(0)
  s_waitcnt vmcnt(4)
  ds_read_b64_tr_b16 a[224:225], v146 offset:24576
  ds_read_b64_tr_b16 a[226:227], v147 offset:24576
  ds_read_b64_tr_b16 a[228:229], v146 offset:24640
  ds_read_b64_tr_b16 a[230:231], v147 offset:24640
  ds_read_b64_tr_b16 a[232:233], v146 offset:26624
  ds_read_b64_tr_b16 a[234:235], v147 offset:26624
  ds_read_b64_tr_b16 a[236:237], v146 offset:26688
  ds_read_b64_tr_b16 a[238:239], v147 offset:26688
  s_waitcnt lgkmcnt(0)
  s_waitcnt vmcnt(0)
  ds_read_b64_tr_b16 a[240:241], v146 offset:28672
  ds_read_b64_tr_b16 a[242:243], v147 offset:28672
  ds_read_b64_tr_b16 a[244:245], v146 offset:28736
  ds_read_b64_tr_b16 a[246:247], v147 offset:28736
  ds_read_b64_tr_b16 a[248:249], v146 offset:30720
  ds_read_b64_tr_b16 a[250:251], v147 offset:30720
  ds_read_b64_tr_b16 a[252:253], v146 offset:30784
  ds_read_b64_tr_b16 a[254:255], v147 offset:30784
  s_waitcnt lgkmcnt(0)
  v_min_u32 v4, 27, v1
  v_mul_u32_u24 v5, 37, v4
  v_lshrrev_b32 v5, 8, v5
  v_mul_u32_u24 v5, 7, v5
  v_sub_u32 v5, v4, v5
  v_mov_b32 v6, 0x200
  v_cmp_ne_u32 vcc, 6, v5
  s_mul_i32 s76, s48, 3584
  s_add_u32 s76, s76, 148897792
  v_cndmask_b32 v5, 0, v6, vcc
  v_lshl_add_u32 v4, v4, 7, s76
  s_mov_b32 s71, 0
  s_branch M_vg_44
M_vw_43:
  s_sleep 2
  s_add_u32 s71, s71, 1
  s_cmp_gt_u32 s71, 262144
  s_cbranch_scc1 M_exit
M_vg_44:
  buffer_load_dword v6, v4, s[4:7], 0 offen sc1
  s_waitcnt vmcnt(0)
  v_cmp_lt_u32 vcc, v6, v5
  s_cbranch_vccnz M_vw_43
  s_barrier
  s_lshl_b32 s25, s16, 13
  s_add_u32 m0, s25, 0
  s_nop 0
  buffer_load_dwordx4 v16, s[12:15], s19 offen sc1 lds
  s_add_u32 m0, s25, 1024
  s_nop 0
  buffer_load_dwordx4 v17, s[12:15], s19 offen sc1 lds
  s_add_u32 m0, s25, 2048
  s_nop 0
  buffer_load_dwordx4 v18, s[12:15], s19 offen sc1 lds
  s_add_u32 m0, s25, 3072
  s_nop 0
  buffer_load_dwordx4 v19, s[12:15], s19 offen sc1 lds
  s_add_u32 m0, s25, 4096
  s_nop 0
  buffer_load_dwordx4 v20, s[12:15], s19 offen sc1 lds
  s_add_u32 m0, s25, 5120
  s_nop 0
  buffer_load_dwordx4 v21, s[12:15], s19 offen sc1 lds
  s_add_u32 m0, s25, 6144
  s_nop 0
  buffer_load_dwordx4 v22, s[12:15], s19 offen sc1 lds
  s_add_u32 m0, s25, 7168
  s_nop 0
  buffer_load_dwordx4 v23, s[12:15], s19 offen sc1 lds
  s_cmp_gt_u32 s23, 1
  s_cselect_b32 s26, s20, 0
  s_add_u32 s19, s19, s26
  s_add_u32 s25, s25, 32768
  s_and_b32 s25, s25, 0x1ffff
  s_add_u32 m0, s25, 0
  s_nop 0
  buffer_load_dwordx4 v16, s[12:15], s19 offen sc1 lds
  s_add_u32 m0, s25, 1024
  s_nop 0
  buffer_load_dwordx4 v17, s[12:15], s19 offen sc1 lds
  s_add_u32 m0, s25, 2048
  s_nop 0
  buffer_load_dwordx4 v18, s[12:15], s19 offen sc1 lds
  s_add_u32 m0, s25, 3072
  s_nop 0
  buffer_load_dwordx4 v19, s[12:15], s19 offen sc1 lds
  s_add_u32 m0, s25, 4096
  s_nop 0
  buffer_load_dwordx4 v20, s[12:15], s19 offen sc1 lds
  s_add_u32 m0, s25, 5120
  s_nop 0
  buffer_load_dwordx4 v21, s[12:15], s19 offen sc1 lds
  s_add_u32 m0, s25, 6144
  s_nop 0
  buffer_load_dwordx4 v22, s[12:15], s19 offen sc1 lds
  s_add_u32 m0, s25, 7168
  s_nop 0
  buffer_load_dwordx4 v23, s[12:15], s19 offen sc1 lds
  s_cmp_gt_u32 s23, 2
  s_cselect_b32 s26, s20, 0
  s_add_u32 s19, s19, s26
  s_add_u32 s25, s25, 32768
  s_and_b32 s25, s25, 0x1ffff
  s_waitcnt vmcnt(0)
  s_barrier
  s_mov_b32 s27, s21
  v_mov_b32 v7, 0x40000000
  ds_read_b128 v[24:27], v8 offset:0
  ds_read_b128 v[28:31], v9 offset:0
  ds_read_b128 v[32:35], v10 offset:0
  ds_read_b128 v[36:39], v11 offset:0
  ds_read_b128 v[40:43], v12 offset:0
  ds_read_b128 v[44:47], v13 offset:0
.p2align 6
G_top_45:
  s_waitcnt lgkmcnt(5)
  v_mfma_f32_32x32x16_bf16 v[64:79], a[0:3], v[24:27], 0
  s_add_u32 m0, s25, 0
  ds_read_b128 v[48:51], v14 offset:0
  v_mfma_f32_32x32x16_bf16 v[80:95], a[4:7], v[24:27], 0
  s_waitcnt lgkmcnt(5)
  buffer_load_dwordx4 v16, s[12:15], s19 offen sc1 lds
  v_mfma_f32_32x32x16_bf16 v[64:79], a[8:11], v[28:31], v[64:79]
  ds_read_b128 v[52:55], v15 offset:0
  v_mul_f32 v96, s24, v96
  v_mul_f32 v97, s24, v97
  v_mfma_f32_32x32x16_bf16 v[80:95], a[12:15], v[28:31], v[80:95]
  s_waitcnt lgkmcnt(5)
  v_cvt_pk_bf16_f32 v128, v96, v97
  v_mul_f32 v98, s24, v98
  v_mfma_f32_32x32x16_bf16 v[64:79], a[16:19], v[32:35], v[64:79]
  s_add_u32 m0, s25, 1024
  ds_read_b128 v[24:27], v8 offset:8192
  v_mul_f32 v99, s24, v99
  v_cvt_pk_bf16_f32 v129, v98, v99
  v_mfma_f32_32x32x16_bf16 v[80:95], a[20:23], v[32:35], v[80:95]
  s_waitcnt lgkmcnt(5)
  buffer_load_dwordx4 v17, s[12:15], s19 offen sc1 lds
  v_mul_f32 v100, s24, v100
  v_mul_f32 v101, s24, v101
  v_mfma_f32_32x32x16_bf16 v[64:79], a[24:27], v[36:39], v[64:79]
  ds_read_b128 v[28:31], v9 offset:8192
  v_cvt_pk_bf16_f32 v130, v100, v101
  v_mul_f32 v102, s24, v102
  v_mfma_f32_32x32x16_bf16 v[80:95], a[28:31], v[36:39], v[80:95]
  s_waitcnt lgkmcnt(5)
  v_mul_f32 v103, s24, v103
  v_cvt_pk_bf16_f32 v131, v102, v103
  v_mfma_f32_32x32x16_bf16 v[64:79], a[32:35], v[40:43], v[64:79]
  s_add_u32 m0, s25, 2048
  ds_read_b128 v[32:35], v10 offset:8192
  v_mul_f32 v104, s24, v104
  v_mul_f32 v105, s24, v105
  v_mfma_f32_32x32x16_bf16 v[80:95], a[36:39], v[40:43], v[80:95]
  s_waitcnt lgkmcnt(5)
  buffer_load_dwordx4 v18, s[12:15], s19 offen sc1 lds
  v_cvt_pk_bf16_f32 v132, v104, v105
  v_mul_f32 v106, s24, v106
  v_mfma_f32_32x32x16_bf16 v[64:79], a[40:43], v[44:47], v[64:79]
  ds_read_b128 v[36:39], v11 offset:8192
  v_mul_f32 v107, s24, v107
  v_cvt_pk_bf16_f32 v133, v106, v107
  v_mfma_f32_32x32x16_bf16 v[80:95], a[44:47], v[44:47], v[80:95]
  s_waitcnt lgkmcnt(5)
  v_mul_f32 v108, s24, v108
  v_mul_f32 v109, s24, v109
  v_mfma_f32_32x32x16_bf16 v[64:79], a[48:51], v[48:51], v[64:79]
  s_add_u32 m0, s25, 3072
  ds_read_b128 v[40:43], v12 offset:8192
  v_cvt_pk_bf16_f32 v134, v108, v109
  v_mul_f32 v110, s24, v110
  v_mfma_f32_32x32x16_bf16 v[80:95], a[52:55], v[48:51], v[80:95]
  s_waitcnt lgkmcnt(5)
  buffer_load_dwordx4 v19, s[12:15], s19 offen sc1 lds
  v_mul_f32 v111, s24, v111
  v_cvt_pk_bf16_f32 v135, v110, v111
  v_mfma_f32_32x32x16_bf16 v[64:79], a[56:59], v[52:55], v[64:79]
  ds_read_b128 v[44:47], v13 offset:8192
  v_mul_f32 v112, s24, v112
  v_mul_f32 v113, s24, v113
  v_mfma_f32_32x32x16_bf16 v[80:95], a[60:63], v[52:55], v[80:95]
  s_waitcnt lgkmcnt(5)
  v_cvt_pk_bf16_f32 v136, v112, v113
  v_mul_f32 v114, s24, v114
  v_mfma_f32_32x32x16_bf16 v[64:79], a[64:67], v[24:27], v[64:79]
  s_add_u32 m0, s25, 4096
  ds_read_b128 v[48:51], v14 offset:8192
  v_mul_f32 v115, s24, v115
  v_cvt_pk_bf16_f32 v137, v114, v115
  v_mfma_f32_32x32x16_bf16 v[80:95], a[68:71], v[24:27], v[80:95]
  s_waitcnt lgkmcnt(5)
  buffer_load_dwordx4 v20, s[12:15], s19 offen sc1 lds
  v_mul_f32 v116, s24, v116
  v_mul_f32 v117, s24, v117
  v_mfma_f32_32x32x16_bf16 v[64:79], a[72:75], v[28:31], v[64:79]
  ds_read_b128 v[52:55], v15 offset:8192
  v_cvt_pk_bf16_f32 v138, v116, v117
  v_mul_f32 v118, s24, v118
  v_mfma_f32_32x32x16_bf16 v[80:95], a[76:79], v[28:31], v[80:95]
  s_waitcnt lgkmcnt(5)
  v_mul_f32 v119, s24, v119
  v_cvt_pk_bf16_f32 v139, v118, v119
  v_mfma_f32_32x32x16_bf16 v[64:79], a[80:83], v[32:35], v[64:79]
  s_add_u32 m0, s25, 5120
  ds_read_b128 v[24:27], v8 offset:16384
  v_mul_f32 v120, s24, v120
  v_mul_f32 v121, s24, v121
  v_mfma_f32_32x32x16_bf16 v[80:95], a[84:87], v[32:35], v[80:95]
  s_waitcnt lgkmcnt(5)
  buffer_load_dwordx4 v21, s[12:15], s19 offen sc1 lds
  v_cvt_pk_bf16_f32 v140, v120, v121
  v_mul_f32 v122, s24, v122
  v_mfma_f32_32x32x16_bf16 v[64:79], a[88:91], v[36:39], v[64:79]
  ds_read_b128 v[28:31], v9 offset:16384
  v_mul_f32 v123, s24, v123
  v_cvt_pk_bf16_f32 v141, v122, v123
  v_mfma_f32_32x32x16_bf16 v[80:95], a[92:95], v[36:39], v[80:95]
  s_waitcnt lgkmcnt(5)
  v_mul_f32 v124, s24, v124
  v_mul_f32 v125, s24, v125
  v_mfma_f32_32x32x16_bf16 v[64:79], a[96:99], v[40:43], v[64:79]
  s_add_u32 m0, s25, 6144
  ds_read_b128 v[32:35], v10 offset:16384
  v_cvt_pk_bf16_f32 v142, v124, v125
  v_mul_f32 v126, s24, v126
  v_mfma_f32_32x32x16_bf16 v[80:95], a[100:103], v[40:43], v[80:95]
  s_waitcnt lgkmcnt(5)
  buffer_load_dwordx4 v22, s[12:15], s19 offen sc1 lds
  v_mul_f32 v127, s24, v127
  v_cvt_pk_bf16_f32 v143, v126, v127
  v_mfma_f32_32x32x16_bf16 v[64:79], a[104:107], v[44:47], v[64:79]
  ds_read_b128 v[36:39], v11 offset:16384
  v_mfma_f32_32x32x16_bf16 v[80:95], a[108:111], v[44:47], v[80:95]
  s_waitcnt lgkmcnt(5)
  v_mfma_f32_32x32x16_bf16 v[64:79], a[112:115], v[48:51], v[64:79]
  s_add_u32 m0, s25, 7168
  ds_read_b128 v[40:43], v12 offset:16384
  v_mfma_f32_32x32x16_bf16 v[80:95], a[116:119], v[48:51], v[80:95]
  s_waitcnt lgkmcnt(5)
  buffer_load_dwordx4 v23, s[12:15], s19 offen sc1 lds
  v_mfma_f32_32x32x16_bf16 v[64:79], a[120:123], v[52:55], v[64:79]
  s_cmp_gt_u32 s23, 3
  ds_read_b128 v[44:47], v13 offset:16384
  v_mfma_f32_32x32x16_bf16 v[80:95], a[124:127], v[52:55], v[80:95]
  s_waitcnt lgkmcnt(5)
  s_cselect_b32 s26, s20, 0
  v_mfma_f32_32x32x16_bf16 v[64:79], a[128:131], v[24:27], v[64:79]
  s_add_u32 s19, s19, s26
  ds_read_b128 v[48:51], v14 offset:16384
  v_mfma_f32_32x32x16_bf16 v[80:95], a[132:135], v[24:27], v[80:95]
  s_waitcnt lgkmcnt(5)
  s_add_u32 s25, s25, 32768
  v_mfma_f32_32x32x16_bf16 v[64:79], a[136:139], v[28:31], v[64:79]
  s_and_b32 s25, s25, 0x1ffff
  ds_read_b128 v[52:55], v15 offset:16384
  v_mfma_f32_32x32x16_bf16 v[80:95], a[140:143], v[28:31], v[80:95]
  s_waitcnt lgkmcnt(5)
  buffer_store_dwordx4 v[128:131], v7, s[4:7], s21 offen offset:0 sc1
  v_mfma_f32_32x32x16_bf16 v[64:79], a[144:147], v[32:35], v[64:79]
  ds_read_b128 v[24:27], v8 offset:24576
  v_mfma_f32_32x32x16_bf16 v[80:95], a[148:151], v[32:35], v[80:95]
  s_waitcnt lgkmcnt(5)
  v_mfma_f32_32x32x16_bf16 v[64:79], a[152:155], v[36:39], v[64:79]
  ds_read_b128 v[28:31], v9 offset:24576
  v_mfma_f32_32x32x16_bf16 v[80:95], a[156:159], v[36:39], v[80:95]
  s_waitcnt lgkmcnt(5)
  buffer_store_dwordx4 v[132:135], v7, s[4:7], s21 offen offset:1024 sc1
  v_mfma_f32_32x32x16_bf16 v[64:79], a[160:163], v[40:43], v[64:79]
  ds_read_b128 v[32:35], v10 offset:24576
  v_mfma_f32_32x32x16_bf16 v[80:95], a[164:167], v[40:43], v[80:95]
  s_waitcnt lgkmcnt(5)
  v_mfma_f32_32x32x16_bf16 v[64:79], a[168:171], v[44:47], v[64:79]
  ds_read_b128 v[36:39], v11 offset:24576
  v_mfma_f32_32x32x16_bf16 v[80:95], a[172:175], v[44:47], v[80:95]
  s_waitcnt lgkmcnt(5)
  buffer_store_dwordx4 v[136:139], v7, s[4:7], s21 offen offset:2048 sc1
  v_mfma_f32_32x32x16_bf16 v[64:79], a[176:179], v[48:51], v[64:79]
  ds_read_b128 v[40:43], v12 offset:24576
  v_mfma_f32_32x32x16_bf16 v[80:95], a[180:183], v[48:51], v[80:95]
  s_waitcnt lgkmcnt(5)
  v_mfma_f32_32x32x16_bf16 v[64:79], a[184:187], v[52:55], v[64:79]
  ds_read_b128 v[44:47], v13 offset:24576
  v_mfma_f32_32x32x16_bf16 v[80:95], a[188:191], v[52:55], v[80:95]
  s_waitcnt lgkmcnt(5)
  buffer_store_dwordx4 v[140:143], v7, s[4:7], s21 offen offset:3072 sc1
  v_mfma_f32_32x32x16_bf16 v[64:79], a[192:195], v[24:27], v[64:79]
  s_mov_b32 s21, s27
  ds_read_b128 v[48:51], v14 offset:24576
  v_mov_b32 v7, v2
  v_mfma_f32_32x32x16_bf16 v[80:95], a[196:199], v[24:27], v[80:95]
  s_waitcnt lgkmcnt(5)
  v_mfma_f32_32x32x16_bf16 v[64:79], a[200:203], v[28:31], v[64:79]
  s_add_u32 s27, s27, s22
  ds_read_b128 v[52:55], v15 offset:24576
  v_mfma_f32_32x32x16_bf16 v[80:95], a[204:207], v[28:31], v[80:95]
  s_waitcnt lgkmcnt(5)
  s_waitcnt vmcnt(16)
  s_barrier
  v_mfma_f32_32x32x16_bf16 v[64:79], a[208:211], v[32:35], v[64:79]
  ds_read_b128 v[24:27], v8 offset:32768
  v_mfma_f32_32x32x16_bf16 v[80:95], a[212:215], v[32:35], v[80:95]
  s_waitcnt lgkmcnt(5)
  v_mfma_f32_32x32x16_bf16 v[64:79], a[216:219], v[36:39], v[64:79]
  ds_read_b128 v[28:31], v9 offset:32768
  v_mfma_f32_32x32x16_bf16 v[80:95], a[220:223], v[36:39], v[80:95]
  s_waitcnt lgkmcnt(5)
  v_mfma_f32_32x32x16_bf16 v[64:79], a[224:227], v[40:43], v[64:79]
  ds_read_b128 v[32:35], v10 offset:32768
  v_mfma_f32_32x32x16_bf16 v[80:95], a[228:231], v[40:43], v[80:95]
  s_waitcnt lgkmcnt(5)
  v_mfma_f32_32x32x16_bf16 v[64:79], a[232:235], v[44:47], v[64:79]
  ds_read_b128 v[36:39], v11 offset:32768
  v_mfma_f32_32x32x16_bf16 v[80:95], a[236:239], v[44:47], v[80:95]
  s_waitcnt lgkmcnt(5)
  v_mfma_f32_32x32x16_bf16 v[64:79], a[240:243], v[48:51], v[64:79]
  s_sub_u32 s23, s23, 1
  ds_read_b128 v[40:43], v12 offset:32768
  v_mfma_f32_32x32x16_bf16 v[80:95], a[244:247], v[48:51], v[80:95]
  s_waitcnt lgkmcnt(5)
  v_mfma_f32_32x32x16_bf16 v[64:79], a[248:251], v[52:55], v[64:79]
  s_cmp_eq_u32 s23, 0
  ds_read_b128 v[44:47], v13 offset:32768
  v_mfma_f32_32x32x16_bf16 v[80:95], a[252:255], v[52:55], v[80:95]
  s_cbranch_scc1 G_done0_46
  s_waitcnt lgkmcnt(5)
  v_mfma_f32_32x32x16_bf16 v[96:111], a[0:3], v[24:27], 0
  s_add_u32 m0, s25, 0
  ds_read_b128 v[48:51], v14 offset:32768
  v_mfma_f32_32x32x16_bf16 v[112:127], a[4:7], v[24:27], 0
  s_waitcnt lgkmcnt(5)
  buffer_load_dwordx4 v16, s[12:15], s19 offen sc1 lds
  v_mfma_f32_32x32x16_bf16 v[96:111], a[8:11], v[28:31], v[96:111]
  ds_read_b128 v[52:55], v15 offset:32768
  v_mul_f32 v64, s24, v64
  v_mul_f32 v65, s24, v65
  v_mfma_f32_32x32x16_bf16 v[112:127], a[12:15], v[28:31], v[112:127]
  s_waitcnt lgkmcnt(5)
  v_cvt_pk_bf16_f32 v128, v64, v65
  v_mul_f32 v66, s24, v66
  v_mfma_f32_32x32x16_bf16 v[96:111], a[16:19], v[32:35], v[96:111]
  s_add_u32 m0, s25, 1024
  ds_read_b128 v[24:27], v8 offset:40960
  v_mul_f32 v67, s24, v67
  v_cvt_pk_bf16_f32 v129, v66, v67
  v_mfma_f32_32x32x16_bf16 v[112:127], a[20:23], v[32:35], v[112:127]
  s_waitcnt lgkmcnt(5)
  buffer_load_dwordx4 v17, s[12:15], s19 offen sc1 lds
  v_mul_f32 v68, s24, v68
  v_mul_f32 v69, s24, v69
  v_mfma_f32_32x32x16_bf16 v[96:111], a[24:27], v[36:39], v[96:111]
  ds_read_b128 v[28:31], v9 offset:40960
  v_cvt_pk_bf16_f32 v130, v68, v69
  v_mul_f32 v70, s24, v70
  v_mfma_f32_32x32x16_bf16 v[112:127], a[28:31], v[36:39], v[112:127]
  s_waitcnt lgkmcnt(5)
  v_mul_f32 v71, s24, v71
  v_cvt_pk_bf16_f32 v131, v70, v71
  v_mfma_f32_32x32x16_bf16 v[96:111], a[32:35], v[40:43], v[96:111]
  s_add_u32 m0, s25, 2048
  ds_read_b128 v[32:35], v10 offset:40960
  v_mul_f32 v72, s24, v72
  v_mul_f32 v73, s24, v73
  v_mfma_f32_32x32x16_bf16 v[112:127], a[36:39], v[40:43], v[112:127]
  s_waitcnt lgkmcnt(5)
  buffer_load_dwordx4 v18, s[12:15], s19 offen sc1 lds
  v_cvt_pk_bf16_f32 v132, v72, v73
  v_mul_f32 v74, s24, v74
  v_mfma_f32_32x32x16_bf16 v[96:111], a[40:43], v[44:47], v[96:111]
  ds_read_b128 v[36:39], v11 offset:40960
  v_mul_f32 v75, s24, v75
  v_cvt_pk_bf16_f32 v133, v74, v75
  v_mfma_f32_32x32x16_bf16 v[112:127], a[44:47], v[44:47], v[112:127]
  s_waitcnt lgkmcnt(5)
  v_mul_f32 v76, s24, v76
  v_mul_f32 v77, s24, v77
  v_mfma_f32_32x32x16_bf16 v[96:111], a[48:51], v[48:51], v[96:111]
  s_add_u32 m0, s25, 3072
  ds_read_b128 v[40:43], v12 offset:40960
  v_cvt_pk_bf16_f32 v134, v76, v77
  v_mul_f32 v78, s24, v78
  v_mfma_f32_32x32x16_bf16 v[112:127], a[52:55], v[48:51], v[112:127]
  s_waitcnt lgkmcnt(5)
  buffer_load_dwordx4 v19, s[12:15], s19 offen sc1 lds
  v_mul_f32 v79, s24, v79
  v_cvt_pk_bf16_f32 v135, v78, v79
  v_mfma_f32_32x32x16_bf16 v[96:111], a[56:59], v[52:55], v[96:111]
  ds_read_b128 v[44:47], v13 offset:40960
  v_mul_f32 v80, s24, v80
  v_mul_f32 v81, s24, v81
  v_mfma_f32_32x32x16_bf16 v[112:127], a[60:63], v[52:55], v[112:127]
  s_waitcnt lgkmcnt(5)
  v_cvt_pk_bf16_f32 v136, v80, v81
  v_mul_f32 v82, s24, v82
  v_mfma_f32_32x32x16_bf16 v[96:111], a[64:67], v[24:27], v[96:111]
  s_add_u32 m0, s25, 4096
  ds_read_b128 v[48:51], v14 offset:40960
  v_mul_f32 v83, s24, v83
  v_cvt_pk_bf16_f32 v137, v82, v83
  v_mfma_f32_32x32x16_bf16 v[112:127], a[68:71], v[24:27], v[112:127]
  s_waitcnt lgkmcnt(5)
  buffer_load_dwordx4 v20, s[12:15], s19 offen sc1 lds
  v_mul_f32 v84, s24, v84
  v_mul_f32 v85, s24, v85
  v_mfma_f32_32x32x16_bf16 v[96:111], a[72:75], v[28:31], v[96:111]
  ds_read_b128 v[52:55], v15 offset:40960
  v_cvt_pk_bf16_f32 v138, v84, v85
  v_mul_f32 v86, s24, v86
  v_mfma_f32_32x32x16_bf16 v[112:127], a[76:79], v[28:31], v[112:127]
  s_waitcnt lgkmcnt(5)
  v_mul_f32 v87, s24, v87
  v_cvt_pk_bf16_f32 v139, v86, v87
  v_mfma_f32_32x32x16_bf16 v[96:111], a[80:83], v[32:35], v[96:111]
  s_add_u32 m0, s25, 5120
  ds_read_b128 v[24:27], v8 offset:49152
  v_mul_f32 v88, s24, v88
  v_mul_f32 v89, s24, v89
  v_mfma_f32_32x32x16_bf16 v[112:127], a[84:87], v[32:35], v[112:127]
  s_waitcnt lgkmcnt(5)
  buffer_load_dwordx4 v21, s[12:15], s19 offen sc1 lds
  v_cvt_pk_bf16_f32 v140, v88, v89
  v_mul_f32 v90, s24, v90
  v_mfma_f32_32x32x16_bf16 v[96:111], a[88:91], v[36:39], v[96:111]
  ds_read_b128 v[28:31], v9 offset:49152
  v_mul_f32 v91, s24, v91
  v_cvt_pk_bf16_f32 v141, v90, v91
  v_mfma_f32_32x32x16_bf16 v[112:127], a[92:95], v[36:39], v[112:127]
  s_waitcnt lgkmcnt(5)
  v_mul_f32 v92, s24, v92
  v_mul_f32 v93, s24, v93
  v_mfma_f32_32x32x16_bf16 v[96:111], a[96:99], v[40:43], v[96:111]
  s_add_u32 m0, s25, 6144
  ds_read_b128 v[32:35], v10 offset:49152
  v_cvt_pk_bf16_f32 v142, v92, v93
  v_mul_f32 v94, s24, v94
  v_mfma_f32_32x32x16_bf16 v[112:127], a[100:103], v[40:43], v[112:127]
  s_waitcnt lgkmcnt(5)
  buffer_load_dwordx4 v22, s[12:15], s19 offen sc1 lds
  v_mul_f32 v95, s24, v95
  v_cvt_pk_bf16_f32 v143, v94, v95
  v_mfma_f32_32x32x16_bf16 v[96:111], a[104:107], v[44:47], v[96:111]
  ds_read_b128 v[36:39], v11 offset:49152
  v_mfma_f32_32x32x16_bf16 v[112:127], a[108:111], v[44:47], v[112:127]
  s_waitcnt lgkmcnt(5)
  v_mfma_f32_32x32x16_bf16 v[96:111], a[112:115], v[48:51], v[96:111]
  s_add_u32 m0, s25, 7168
  ds_read_b128 v[40:43], v12 offset:49152
  v_mfma_f32_32x32x16_bf16 v[112:127], a[116:119], v[48:51], v[112:127]
  s_waitcnt lgkmcnt(5)
  buffer_load_dwordx4 v23, s[12:15], s19 offen sc1 lds
  v_mfma_f32_32x32x16_bf16 v[96:111], a[120:123], v[52:55], v[96:111]
  s_cmp_gt_u32 s23, 3
  ds_read_b128 v[44:47], v13 offset:49152
  v_mfma_f32_32x32x16_bf16 v[112:127], a[124:127], v[52:55], v[112:127]
  s_waitcnt lgkmcnt(5)
  s_cselect_b32 s26, s20, 0
  v_mfma_f32_32x32x16_bf16 v[96:111], a[128:131], v[24:27], v[96:111]
  s_add_u32 s19, s19, s26
  ds_read_b128 v[48:51], v14 offset:49152
  v_mfma_f32_32x32x16_bf16 v[112:127], a[132:135], v[24:27], v[112:127]
  s_waitcnt lgkmcnt(5)
  s_add_u32 s25, s25, 32768
  v_mfma_f32_32x32x16_bf16 v[96:111], a[136:139], v[28:31], v[96:111]
  s_and_b32 s25, s25, 0x1ffff
  ds_read_b128 v[52:55], v15 offset:49152
  v_mfma_f32_32x32x16_bf16 v[112:127], a[140:143], v[28:31], v[112:127]
  s_waitcnt lgkmcnt(5)
  buffer_store_dwordx4 v[128:131], v7, s[4:7], s21 offen offset:0 sc1
  v_mfma_f32_32x32x16_bf16 v[96:111], a[144:147], v[32:35], v[96:111]
  ds_read_b128 v[24:27], v8 offset:57344
  v_mfma_f32_32x32x16_bf16 v[112:127], a[148:151], v[32:35], v[112:127]
  s_waitcnt lgkmcnt(5)
  v_xor_b32 v8, 0x10000, v8
  v_mfma_f32_32x32x16_bf16 v[96:111], a[152:155], v[36:39], v[96:111]
  ds_read_b128 v[28:31], v9 offset:57344
  v_mfma_f32_32x32x16_bf16 v[112:127], a[156:159], v[36:39], v[112:127]
  s_waitcnt lgkmcnt(5)
  buffer_store_dwordx4 v[132:135], v7, s[4:7], s21 offen offset:1024 sc1
  v_xor_b32 v9, 0x10000, v9
  v_mfma_f32_32x32x16_bf16 v[96:111], a[160:163], v[40:43], v[96:111]
  ds_read_b128 v[32:35], v10 offset:57344
  v_mfma_f32_32x32x16_bf16 v[112:127], a[164:167], v[40:43], v[112:127]
  s_waitcnt lgkmcnt(5)
  v_xor_b32 v10, 0x10000, v10
  v_mfma_f32_32x32x16_bf16 v[96:111], a[168:171], v[44:47], v[96:111]
  ds_read_b128 v[36:39], v11 offset:57344
  v_mfma_f32_32x32x16_bf16 v[112:127], a[172:175], v[44:47], v[112:127]
  s_waitcnt lgkmcnt(5)
  buffer_store_dwordx4 v[136:139], v7, s[4:7], s21 offen offset:2048 sc1
  v_xor_b32 v11, 0x10000, v11
  v_mfma_f32_32x32x16_bf16 v[96:111], a[176:179], v[48:51], v[96:111]
  ds_read_b128 v[40:43], v12 offset:57344
  v_mfma_f32_32x32x16_bf16 v[112:127], a[180:183], v[48:51], v[112:127]
  s_waitcnt lgkmcnt(5)
  v_xor_b32 v12, 0x10000, v12
  v_mfma_f32_32x32x16_bf16 v[96:111], a[184:187], v[52:55], v[96:111]
  ds_read_b128 v[44:47], v13 offset:57344
  v_mfma_f32_32x32x16_bf16 v[112:127], a[188:191], v[52:55], v[112:127]
  s_waitcnt lgkmcnt(5)
  buffer_store_dwordx4 v[140:143], v7, s[4:7], s21 offen offset:3072 sc1
  v_xor_b32 v13, 0x10000, v13
  v_mfma_f32_32x32x16_bf16 v[96:111], a[192:195], v[24:27], v[96:111]
  s_mov_b32 s21, s27
  ds_read_b128 v[48:51], v14 offset:57344
  v_mov_b32 v7, v2
  v_mfma_f32_32x32x16_bf16 v[112:127], a[196:199], v[24:27], v[112:127]
  s_waitcnt lgkmcnt(5)
  v_xor_b32 v14, 0x10000, v14
  v_mfma_f32_32x32x16_bf16 v[96:111], a[200:203], v[28:31], v[96:111]
  s_add_u32 s27, s27, s22
  ds_read_b128 v[52:55], v15 offset:57344
  v_mfma_f32_32x32x16_bf16 v[112:127], a[204:207], v[28:31], v[112:127]
  s_waitcnt lgkmcnt(5)
  s_waitcnt vmcnt(16)
  s_barrier
  v_xor_b32 v15, 0x10000, v15
  v_mfma_f32_32x32x16_bf16 v[96:111], a[208:211], v[32:35], v[96:111]
  ds_read_b128 v[24:27], v8 offset:0
  v_mfma_f32_32x32x16_bf16 v[112:127], a[212:215], v[32:35], v[112:127]
  s_waitcnt lgkmcnt(5)
  v_mfma_f32_32x32x16_bf16 v[96:111], a[216:219], v[36:39], v[96:111]
  ds_read_b128 v[28:31], v9 offset:0
  v_mfma_f32_32x32x16_bf16 v[112:127], a[220:223], v[36:39], v[112:127]
  s_waitcnt lgkmcnt(5)
  v_mfma_f32_32x32x16_bf16 v[96:111], a[224:227], v[40:43], v[96:111]
  ds_read_b128 v[32:35], v10 offset:0
  v_mfma_f32_32x32x16_bf16 v[112:127], a[228:231], v[40:43], v[112:127]
  s_waitcnt lgkmcnt(5)
  v_mfma_f32_32x32x16_bf16 v[96:111], a[232:235], v[44:47], v[96:111]
  ds_read_b128 v[36:39], v11 offset:0
  v_mfma_f32_32x32x16_bf16 v[112:127], a[236:239], v[44:47], v[112:127]
  s_waitcnt lgkmcnt(5)
  v_mfma_f32_32x32x16_bf16 v[96:111], a[240:243], v[48:51], v[96:111]
  s_sub_u32 s23, s23, 1
  ds_read_b128 v[40:43], v12 offset:0
  v_mfma_f32_32x32x16_bf16 v[112:127], a[244:247], v[48:51], v[112:127]
  s_waitcnt lgkmcnt(5)
  v_mfma_f32_32x32x16_bf16 v[96:111], a[248:251], v[52:55], v[96:111]
  s_cmp_eq_u32 s23, 0
  ds_read_b128 v[44:47], v13 offset:0
  v_mfma_f32_32x32x16_bf16 v[112:127], a[252:255], v[52:55], v[112:127]
  s_cbranch_scc1 G_done1_47
  s_branch G_top_45
G_done0_46:
  s_nop 7
  s_nop 3
  v_mul_f32 v64, s24, v64
  v_mul_f32 v65, s24, v65
  v_cvt_pk_bf16_f32 v128, v64, v65
  v_mul_f32 v66, s24, v66
  v_mul_f32 v67, s24, v67
  v_cvt_pk_bf16_f32 v129, v66, v67
  v_mul_f32 v68, s24, v68
  v_mul_f32 v69, s24, v69
  v_cvt_pk_bf16_f32 v130, v68, v69
  v_mul_f32 v70, s24, v70
  v_mul_f32 v71, s24, v71
  v_cvt_pk_bf16_f32 v131, v70, v71
  buffer_store_dwordx4 v[128:131], v7, s[4:7], s21 offen offset:0 sc1
  v_mul_f32 v72, s24, v72
  v_mul_f32 v73, s24, v73
  v_cvt_pk_bf16_f32 v132, v72, v73
  v_mul_f32 v74, s24, v74
  v_mul_f32 v75, s24, v75
  v_cvt_pk_bf16_f32 v133, v74, v75
  v_mul_f32 v76, s24, v76
  v_mul_f32 v77, s24, v77
  v_cvt_pk_bf16_f32 v134, v76, v77
  v_mul_f32 v78, s24, v78
  v_mul_f32 v79, s24, v79
  v_cvt_pk_bf16_f32 v135, v78, v79
  buffer_store_dwordx4 v[132:135], v7, s[4:7], s21 offen offset:1024 sc1
  v_mul_f32 v80, s24, v80
  v_mul_f32 v81, s24, v81
  v_cvt_pk_bf16_f32 v136, v80, v81
  v_mul_f32 v82, s24, v82
  v_mul_f32 v83, s24, v83
  v_cvt_pk_bf16_f32 v137, v82, v83
  v_mul_f32 v84, s24, v84
  v_mul_f32 v85, s24, v85
  v_cvt_pk_bf16_f32 v138, v84, v85
  v_mul_f32 v86, s24, v86
  v_mul_f32 v87, s24, v87
  v_cvt_pk_bf16_f32 v139, v86, v87
  buffer_store_dwordx4 v[136:139], v7, s[4:7], s21 offen offset:2048 sc1
  v_mul_f32 v88, s24, v88
  v_mul_f32 v89, s24, v89
  v_cvt_pk_bf16_f32 v140, v88, v89
  v_mul_f32 v90, s24, v90
  v_mul_f32 v91, s24, v91
  v_cvt_pk_bf16_f32 v141, v90, v91
  v_mul_f32 v92, s24, v92
  v_mul_f32 v93, s24, v93
  v_cvt_pk_bf16_f32 v142, v92, v93
  v_mul_f32 v94, s24, v94
  v_mul_f32 v95, s24, v95
  v_cvt_pk_bf16_f32 v143, v94, v95
  buffer_store_dwordx4 v[140:143], v7, s[4:7], s21 offen offset:3072 sc1
  s_branch G_fin_48
G_done1_47:
  s_nop 7
  s_nop 3
  v_mul_f32 v96, s24, v96
  v_mul_f32 v97, s24, v97
  v_cvt_pk_bf16_f32 v128, v96, v97
  v_mul_f32 v98, s24, v98
  v_mul_f32 v99, s24, v99
  v_cvt_pk_bf16_f32 v129, v98, v99
  v_mul_f32 v100, s24, v100
  v_mul_f32 v101, s24, v101
  v_cvt_pk_bf16_f32 v130, v100, v101
  v_mul_f32 v102, s24, v102
  v_mul_f32 v103, s24, v103
  v_cvt_pk_bf16_f32 v131, v102, v103
  buffer_store_dwordx4 v[128:131], v7, s[4:7], s21 offen offset:0 sc1
  v_mul_f32 v104, s24, v104
  v_mul_f32 v105, s24, v105
  v_cvt_pk_bf16_f32 v132, v104, v105
  v_mul_f32 v106, s24, v106
  v_mul_f32 v107, s24, v107
  v_cvt_pk_bf16_f32 v133, v106, v107
  v_mul_f32 v108, s24, v108
  v_mul_f32 v109, s24, v109
  v_cvt_pk_bf16_f32 v134, v108, v109
  v_mul_f32 v110, s24, v110
  v_mul_f32 v111, s24, v111
  v_cvt_pk_bf16_f32 v135, v110, v111
  buffer_store_dwordx4 v[132:135], v7, s[4:7], s21 offen offset:1024 sc1
  v_mul_f32 v112, s24, v112
  v_mul_f32 v113, s24, v113
  v_cvt_pk_bf16_f32 v136, v112, v113
  v_mul_f32 v114, s24, v114
  v_mul_f32 v115, s24, v115
  v_cvt_pk_bf16_f32 v137, v114, v115
  v_mul_f32 v116, s24, v116
  v_mul_f32 v117, s24, v117
  v_cvt_pk_bf16_f32 v138, v116, v117
  v_mul_f32 v118, s24, v118
  v_mul_f32 v119, s24, v119
  v_cvt_pk_bf16_f32 v139, v118, v119
  buffer_store_dwordx4 v[136:139], v7, s[4:7], s21 offen offset:2048 sc1
  v_mul_f32 v120, s24, v120
  v_mul_f32 v121, s24, v121
  v_cvt_pk_bf16_f32 v140, v120, v121
  v_mul_f32 v122, s24, v122
  v_mul_f32 v123, s24, v123
  v_cvt_pk_bf16_f32 v141, v122, v123
  v_mul_f32 v124, s24, v124
  v_mul_f32 v125, s24, v125
  v_cvt_pk_bf16_f32 v142, v124, v125
  v_mul_f32 v126, s24, v126
  v_mul_f32 v127, s24, v127
  v_cvt_pk_bf16_f32 v143, v126, v127
  buffer_store_dwordx4 v[140:143], v7, s[4:7], s21 offen offset:3072 sc1
G_fin_48:
  s_waitcnt vmcnt(0) lgkmcnt(0)
  s_barrier
  s_waitcnt vmcnt(0)
  s_barrier
  s_mov_b32 s30, 768
  v_mov_b32 v144, s30
  v_min_u32 v145, 1, v0
  v_lshlrev_b32 v145, 30, v145
  buffer_store_dword v144, v145, s[4:7], s31 offen sc1
  s_mul_i32 s50, s64, 6
  s_add_u32 s50, s50, s65
  s_mul_i32 s76, s50, 21846
  s_lshr_b32 s76, s76, 16
  s_mul_i32 s77, s76, 3
  s_add_u32 s51, s50, 64
  s_cmp_eq_u32 s77, s50
  s_cselect_b32 s50, s76, s51
M_fin:
  s_lshr_b32 s48, s50, 2
  s_and_b32 s49, s50, 3
  s_load_dwordx2 s[8:9], s[0:1], 0
  s_load_dwordx2 s[12:13], s[0:1], 104
  s_load_dwordx2 s[32:33], s[0:1], 112
  v_and_b32 v4, 31, v1
  v_lshrrev_b32 v5, 5, v1
  v_lshlrev_b32 v5, 4, v5
  v_lshl_add_u32 v6, v4, 10, v5
  s_lshl_b32 s26, s16, 8
  s_lshl_b32 s27, s48, 15
  s_add_u32 s27, s27, s26
  s_waitcnt lgkmcnt(0)
  s_and_b32 s9, s9, 0xffff
  s_mov_b32 s10, 2097152
  s_mov_b32 s11, 0x20000
  s_and_b32 s13, s13, 0xffff
  s_mov_b32 s14, 1024
  s_mov_b32 s15, 0x20000
  s_and_b32 s33, s33, 0xffff
  s_mov_b32 s34, 2097152
  s_mov_b32 s35, 0x20000
  buffer_load_dwordx4 v[16:19], v6, s[8:11], s27 offen offset:0
  buffer_load_dwordx4 v[48:51], v5, s[12:15], s26 offen offset:0
  buffer_load_dwordx4 v[20:23], v6, s[8:11], s27 offen offset:32
  buffer_load_dwordx4 v[52:55], v5, s[12:15], s26 offen offset:32
  buffer_load_dwordx4 v[24:27], v6, s[8:11], s27 offen offset:64
  buffer_load_dwordx4 v[56:59], v5, s[12:15], s26 offen offset:64
  buffer_load_dwordx4 v[28:31], v6, s[8:11], s27 offen offset:96
  buffer_load_dwordx4 v[60:63], v5, s[12:15], s26 offen offset:96
  buffer_load_dwordx4 v[32:35], v6, s[8:11], s27 offen offset:128
  buffer_load_dwordx4 v[64:67], v5, s[12:15], s26 offen offset:128
  buffer_load_dwordx4 v[36:39], v6, s[8:11], s27 offen offset:160
  buffer_load_dwordx4 v[68:71], v5, s[12:15], s26 offen offset:160
  buffer_load_dwordx4 v[40:43], v6, s[8:11], s27 offen offset:192
  buffer_load_dwordx4 v[72:75], v5, s[12:15], s26 offen offset:192
  buffer_load_dwordx4 v[44:47], v6, s[8:11], s27 offen offset:224
  buffer_load_dwordx4 v[76:79], v5, s[12:15], s26 offen offset:224
  s_lshl_b32 s28, s48, 2
  s_add_u32 s28, s28, s49
  s_lshl_b32 s28, s28, 2
  s_add_u32 s28, s28, s16
  s_lshl_b32 s28, s28, 11
  s_waitcnt vmcnt(14)
  v_mfma_f32_32x32x16_bf16 v[80:95], v[48:51], v[16:19], 0
  s_waitcnt vmcnt(12)
  v_mfma_f32_32x32x16_bf16 v[80:95], v[52:55], v[20:23], v[80:95]
  s_waitcnt vmcnt(10)
  v_mfma_f32_32x32x16_bf16 v[80:95], v[56:59], v[24:27], v[80:95]
  s_waitcnt vmcnt(8)
  v_mfma_f32_32x32x16_bf16 v[80:95], v[60:63], v[28:31], v[80:95]
  s_waitcnt vmcnt(6)
  v_mfma_f32_32x32x16_bf16 v[80:95], v[64:67], v[32:35], v[80:95]
  s_waitcnt vmcnt(4)
  v_mfma_f32_32x32x16_bf16 v[80:95], v[68:71], v[36:39], v[80:95]
  s_waitcnt vmcnt(2)
  v_mfma_f32_32x32x16_bf16 v[80:95], v[72:75], v[40:43], v[80:95]
  s_waitcnt vmcnt(0)
  v_mfma_f32_32x32x16_bf16 v[80:95], v[76:79], v[44:47], v[80:95]
  s_mul_i32 s76, s48, 43
  s_lshr_b32 s76, s76, 9
  s_mul_i32 s76, s76, 12
  s_sub_u32 s76, s48, s76
  s_cmp_ge_u32 s76, 6
  s_addc_u32 s76, s76, 0
  s_and_b32 s77, s49, 2
  s_mul_i32 s77, s77, 7
  s_add_u32 s76, s76, s77
  v_mov_b32 v193, 0x300
  s_lshl_b32 s76, s76, 7
  s_add_u32 s76, s76, 148897792
  v_and_b32 v192, 7, v1
  v_mul_u32_u24 v192, 3584, v192
  v_add_u32 v192, s76, v192
  s_mov_b32 s71, 0
  s_branch M_vg_50
M_vw_49:
  s_sleep 2
  s_add_u32 s71, s71, 1
  s_cmp_gt_u32 s71, 262144
  s_cbranch_scc1 M_exit
M_vg_50:
  buffer_load_dword v194, v192, s[4:7], 0 offen sc1
  s_waitcnt vmcnt(0)
  v_cmp_lt_u32 vcc, v194, v193
  s_cbranch_vccnz M_vw_49
  s_add_u32 s29, s28, 150994944
  buffer_load_dwordx4 v[96:99], v2, s[4:7], s29 offen offset:0 sc1
  buffer_load_dwordx4 v[100:103], v2, s[4:7], s29 offen offset:1024 sc1
  s_add_u32 s29, s28, 153092096
  buffer_load_dwordx4 v[104:107], v2, s[4:7], s29 offen offset:0 sc1
  buffer_load_dwordx4 v[108:111], v2, s[4:7], s29 offen offset:1024 sc1
  s_add_u32 s29, s28, 155189248
  buffer_load_dwordx4 v[112:115], v2, s[4:7], s29 offen offset:0 sc1
  buffer_load_dwordx4 v[116:119], v2, s[4:7], s29 offen offset:1024 sc1
  s_add_u32 s29, s28, 157286400
  buffer_load_dwordx4 v[120:123], v2, s[4:7], s29 offen offset:0 sc1
  buffer_load_dwordx4 v[124:127], v2, s[4:7], s29 offen offset:1024 sc1
  s_add_u32 s29, s28, 159383552
  buffer_load_dwordx4 v[128:131], v2, s[4:7], s29 offen offset:0 sc1
  buffer_load_dwordx4 v[132:135], v2, s[4:7], s29 offen offset:1024 sc1
  s_add_u32 s29, s28, 161480704
  buffer_load_dwordx4 v[136:139], v2, s[4:7], s29 offen offset:0 sc1
  buffer_load_dwordx4 v[140:143], v2, s[4:7], s29 offen offset:1024 sc1
  s_add_u32 s29, s28, 163577856
  buffer_load_dwordx4 v[144:147], v2, s[4:7], s29 offen offset:0 sc1
  buffer_load_dwordx4 v[148:151], v2, s[4:7], s29 offen offset:1024 sc1
  s_add_u32 s29, s28, 165675008
  buffer_load_dwordx4 v[152:155], v2, s[4:7], s29 offen offset:0 sc1
  buffer_load_dwordx4 v[156:159], v2, s[4:7], s29 offen offset:1024 sc1
  v_lshlrev_b32 v7, 4, v4
  s_lshl_b32 s26, s16, 2
  v_add_u32 v4, s26, v7
  s_barrier
  ds_write_b32 v4, v80
  s_waitcnt lgkmcnt(0)
  s_barrier
  ds_read_b128 v[84:87], v7
  s_waitcnt lgkmcnt(0)
  v_add_f32 v80, v84, v85
  v_add_f32 v81, v86, v87
  v_add_f32 v80, v80, v81
  v_mul_f32 v80, 0xbfb8aa3b, v80
  v_exp_f32 v80, v80
  s_nop 0
  v_add_f32 v80, 1.0, v80
  v_rcp_f32 v80, v80
  s_nop 0
  v_sub_f32 v82, 1.0, v80
  s_waitcnt vmcnt(14)
  v_lshlrev_b32 v160, 16, v96
  v_and_b32 v161, 0xffff0000, v96
  v_lshlrev_b32 v162, 16, v97
  v_and_b32 v163, 0xffff0000, v97
  v_lshlrev_b32 v164, 16, v98
  v_and_b32 v165, 0xffff0000, v98
  v_lshlrev_b32 v166, 16, v99
  v_and_b32 v167, 0xffff0000, v99
  v_lshlrev_b32 v168, 16, v100
  v_and_b32 v169, 0xffff0000, v100
  v_lshlrev_b32 v170, 16, v101
  v_and_b32 v171, 0xffff0000, v101
  v_lshlrev_b32 v172, 16, v102
  v_and_b32 v173, 0xffff0000, v102
  v_lshlrev_b32 v174, 16, v103
  v_and_b32 v175, 0xffff0000, v103
  s_waitcnt vmcnt(12)
  v_lshlrev_b32 v8, 16, v104
  v_and_b32 v9, 0xffff0000, v104
  v_pk_add_f32 v[160:161], v[160:161], v[8:9]
  v_lshlrev_b32 v10, 16, v105
  v_and_b32 v11, 0xffff0000, v105
  v_pk_add_f32 v[162:163], v[162:163], v[10:11]
  v_lshlrev_b32 v12, 16, v106
  v_and_b32 v13, 0xffff0000, v106
  v_pk_add_f32 v[164:165], v[164:165], v[12:13]
  v_lshlrev_b32 v14, 16, v107
  v_and_b32 v15, 0xffff0000, v107
  v_pk_add_f32 v[166:167], v[166:167], v[14:15]
  v_lshlrev_b32 v8, 16, v108
  v_and_b32 v9, 0xffff0000, v108
  v_pk_add_f32 v[168:169], v[168:169], v[8:9]
  v_lshlrev_b32 v10, 16, v109
  v_and_b32 v11, 0xffff0000, v109
  v_pk_add_f32 v[170:171], v[170:171], v[10:11]
  v_lshlrev_b32 v12, 16, v110
  v_and_b32 v13, 0xffff0000, v110
  v_pk_add_f32 v[172:173], v[172:173], v[12:13]
  v_lshlrev_b32 v14, 16, v111
  v_and_b32 v15, 0xffff0000, v111
  v_pk_add_f32 v[174:175], v[174:175], v[14:15]
  s_waitcnt vmcnt(10)
  v_lshlrev_b32 v8, 16, v112
  v_and_b32 v9, 0xffff0000, v112
  v_pk_add_f32 v[160:161], v[160:161], v[8:9]
  v_lshlrev_b32 v10, 16, v113
  v_and_b32 v11, 0xffff0000, v113
  v_pk_add_f32 v[162:163], v[162:163], v[10:11]
  v_lshlrev_b32 v12, 16, v114
  v_and_b32 v13, 0xffff0000, v114
  v_pk_add_f32 v[164:165], v[164:165], v[12:13]
  v_lshlrev_b32 v14, 16, v115
  v_and_b32 v15, 0xffff0000, v115
  v_pk_add_f32 v[166:167], v[166:167], v[14:15]
  v_lshlrev_b32 v8, 16, v116
  v_and_b32 v9, 0xffff0000, v116
  v_pk_add_f32 v[168:169], v[168:169], v[8:9]
  v_lshlrev_b32 v10, 16, v117
  v_and_b32 v11, 0xffff0000, v117
  v_pk_add_f32 v[170:171], v[170:171], v[10:11]
  v_lshlrev_b32 v12, 16, v118
  v_and_b32 v13, 0xffff0000, v118
  v_pk_add_f32 v[172:173], v[172:173], v[12:13]
  v_lshlrev_b32 v14, 16, v119
  v_and_b32 v15, 0xffff0000, v119
  v_pk_add_f32 v[174:175], v[174:175], v[14:15]
  s_waitcnt vmcnt(8)
  v_lshlrev_b32 v8, 16, v120
  v_and_b32 v9, 0xffff0000, v120
  v_pk_add_f32 v[160:161], v[160:161], v[8:9]
  v_lshlrev_b32 v10, 16, v121
  v_and_b32 v11, 0xffff0000, v121
  v_pk_add_f32 v[162:163], v[162:163], v[10:11]
  v_lshlrev_b32 v12, 16, v122
  v_and_b32 v13, 0xffff0000, v122
  v_pk_add_f32 v[164:165], v[164:165], v[12:13]
  v_lshlrev_b32 v14, 16, v123
  v_and_b32 v15, 0xffff0000, v123
  v_pk_add_f32 v[166:167], v[166:167], v[14:15]
  v_lshlrev_b32 v8, 16, v124
  v_and_b32 v9, 0xffff0000, v124
  v_pk_add_f32 v[168:169], v[168:169], v[8:9]
  v_lshlrev_b32 v10, 16, v125
  v_and_b32 v11, 0xffff0000, v125
  v_pk_add_f32 v[170:171], v[170:171], v[10:11]
  v_lshlrev_b32 v12, 16, v126
  v_and_b32 v13, 0xffff0000, v126
  v_pk_add_f32 v[172:173], v[172:173], v[12:13]
  v_lshlrev_b32 v14, 16, v127
  v_and_b32 v15, 0xffff0000, v127
  v_pk_add_f32 v[174:175], v[174:175], v[14:15]
  s_waitcnt vmcnt(6)
  v_lshlrev_b32 v8, 16, v128
  v_and_b32 v9, 0xffff0000, v128
  v_pk_add_f32 v[160:161], v[160:161], v[8:9]
  v_lshlrev_b32 v10, 16, v129
  v_and_b32 v11, 0xffff0000, v129
  v_pk_add_f32 v[162:163], v[162:163], v[10:11]
  v_lshlrev_b32 v12, 16, v130
  v_and_b32 v13, 0xffff0000, v130
  v_pk_add_f32 v[164:165], v[164:165], v[12:13]
  v_lshlrev_b32 v14, 16, v131
  v_and_b32 v15, 0xffff0000, v131
  v_pk_add_f32 v[166:167], v[166:167], v[14:15]
  v_lshlrev_b32 v8, 16, v132
  v_and_b32 v9, 0xffff0000, v132
  v_pk_add_f32 v[168:169], v[168:169], v[8:9]
  v_lshlrev_b32 v10, 16, v133
  v_and_b32 v11, 0xffff0000, v133
  v_pk_add_f32 v[170:171], v[170:171], v[10:11]
  v_lshlrev_b32 v12, 16, v134
  v_and_b32 v13, 0xffff0000, v134
  v_pk_add_f32 v[172:173], v[172:173], v[12:13]
  v_lshlrev_b32 v14, 16, v135
  v_and_b32 v15, 0xffff0000, v135
  v_pk_add_f32 v[174:175], v[174:175], v[14:15]
  s_waitcnt vmcnt(4)
  v_lshlrev_b32 v8, 16, v136
  v_and_b32 v9, 0xffff0000, v136
  v_pk_add_f32 v[160:161], v[160:161], v[8:9]
  v_lshlrev_b32 v10, 16, v137
  v_and_b32 v11, 0xffff0000, v137
  v_pk_add_f32 v[162:163], v[162:163], v[10:11]
  v_lshlrev_b32 v12, 16, v138
  v_and_b32 v13, 0xffff0000, v138
  v_pk_add_f32 v[164:165], v[164:165], v[12:13]
  v_lshlrev_b32 v14, 16, v139
  v_and_b32 v15, 0xffff0000, v139
  v_pk_add_f32 v[166:167], v[166:167], v[14:15]
  v_lshlrev_b32 v8, 16, v140
  v_and_b32 v9, 0xffff0000, v140
  v_pk_add_f32 v[168:169], v[168:169], v[8:9]
  v_lshlrev_b32 v10, 16, v141
  v_and_b32 v11, 0xffff0000, v141
  v_pk_add_f32 v[170:171], v[170:171], v[10:11]
  v_lshlrev_b32 v12, 16, v142
  v_and_b32 v13, 0xffff0000, v142
  v_pk_add_f32 v[172:173], v[172:173], v[12:13]
  v_lshlrev_b32 v14, 16, v143
  v_and_b32 v15, 0xffff0000, v143
  v_pk_add_f32 v[174:175], v[174:175], v[14:15]
  s_waitcnt vmcnt(2)
  v_lshlrev_b32 v8, 16, v144
  v_and_b32 v9, 0xffff0000, v144
  v_pk_add_f32 v[160:161], v[160:161], v[8:9]
  v_lshlrev_b32 v10, 16, v145
  v_and_b32 v11, 0xffff0000, v145
  v_pk_add_f32 v[162:163], v[162:163], v[10:11]
  v_lshlrev_b32 v12, 16, v146
  v_and_b32 v13, 0xffff0000, v146
  v_pk_add_f32 v[164:165], v[164:165], v[12:13]
  v_lshlrev_b32 v14, 16, v147
  v_and_b32 v15, 0xffff0000, v147
  v_pk_add_f32 v[166:167], v[166:167], v[14:15]
  v_lshlrev_b32 v8, 16, v148
  v_and_b32 v9, 0xffff0000, v148
  v_pk_add_f32 v[168:169], v[168:169], v[8:9]
  v_lshlrev_b32 v10, 16, v149
  v_and_b32 v11, 0xffff0000, v149
  v_pk_add_f32 v[170:171], v[170:171], v[10:11]
  v_lshlrev_b32 v12, 16, v150
  v_and_b32 v13, 0xffff0000, v150
  v_pk_add_f32 v[172:173], v[172:173], v[12:13]
  v_lshlrev_b32 v14, 16, v151
  v_and_b32 v15, 0xffff0000, v151
  v_pk_add_f32 v[174:175], v[174:175], v[14:15]
  s_waitcnt vmcnt(0)
  v_lshlrev_b32 v8, 16, v152
  v_and_b32 v9, 0xffff0000, v152
  v_pk_add_f32 v[160:161], v[160:161], v[8:9]
  v_lshlrev_b32 v10, 16, v153
  v_and_b32 v11, 0xffff0000, v153
  v_pk_add_f32 v[162:163], v[162:163], v[10:11]
  v_lshlrev_b32 v12, 16, v154
  v_and_b32 v13, 0xffff0000, v154
  v_pk_add_f32 v[164:165], v[164:165], v[12:13]
  v_lshlrev_b32 v14, 16, v155
  v_and_b32 v15, 0xffff0000, v155
  v_pk_add_f32 v[166:167], v[166:167], v[14:15]
  v_lshlrev_b32 v8, 16, v156
  v_and_b32 v9, 0xffff0000, v156
  v_pk_add_f32 v[168:169], v[168:169], v[8:9]
  v_lshlrev_b32 v10, 16, v157
  v_and_b32 v11, 0xffff0000, v157
  v_pk_add_f32 v[170:171], v[170:171], v[10:11]
  v_lshlrev_b32 v12, 16, v158
  v_and_b32 v13, 0xffff0000, v158
  v_pk_add_f32 v[172:173], v[172:173], v[12:13]
  v_lshlrev_b32 v14, 16, v159
  v_and_b32 v15, 0xffff0000, v159
  v_pk_add_f32 v[174:175], v[174:175], v[14:15]
  s_and_b32 s76, s48, 1
  s_lshl_b32 s76, s76, 1
  s_lshr_b32 s77, s49, 1
  s_add_u32 s76, s76, s77
  s_mul_i32 s76, s76, 7
  s_add_u32 s76, s76, 6
  s_lshr_b32 s77, s48, 1
  s_add_u32 s77, s77, 0x201
  v_mov_b32 v193, s77
  s_lshl_b32 s76, s76, 7
  s_add_u32 s76, s76, 148897792
  v_and_b32 v192, 7, v1
  v_mul_u32_u24 v192, 3584, v192
  v_add_u32 v192, s76, v192
  s_mov_b32 s71, 0
  s_branch M_vg_52
M_vw_51:
  s_sleep 2
  s_add_u32 s71, s71, 1
  s_cmp_gt_u32 s71, 262144
  s_cbranch_scc1 M_exit
M_vg_52:
  buffer_load_dword v194, v192, s[4:7], 0 offen sc1
  s_waitcnt vmcnt(0)
  v_cmp_lt_u32 vcc, v194, v193
  s_cbranch_vccnz M_vw_51
  s_add_u32 s29, s28, 167772160
  buffer_load_dwordx4 v[96:99], v2, s[4:7], s29 offen offset:0 sc1
  buffer_load_dwordx4 v[100:103], v2, s[4:7], s29 offen offset:1024 sc1
  s_add_u32 s29, s28, 169869312
  buffer_load_dwordx4 v[104:107], v2, s[4:7], s29 offen offset:0 sc1
  buffer_load_dwordx4 v[108:111], v2, s[4:7], s29 offen offset:1024 sc1
  s_add_u32 s29, s28, 171966464
  buffer_load_dwordx4 v[112:115], v2, s[4:7], s29 offen offset:0 sc1
  buffer_load_dwordx4 v[116:119], v2, s[4:7], s29 offen offset:1024 sc1
  s_add_u32 s29, s28, 174063616
  buffer_load_dwordx4 v[120:123], v2, s[4:7], s29 offen offset:0 sc1
  buffer_load_dwordx4 v[124:127], v2, s[4:7], s29 offen offset:1024 sc1
  s_add_u32 s29, s28, 176160768
  buffer_load_dwordx4 v[128:131], v2, s[4:7], s29 offen offset:0 sc1
  buffer_load_dwordx4 v[132:135], v2, s[4:7], s29 offen offset:1024 sc1
  s_add_u32 s29, s28, 178257920
  buffer_load_dwordx4 v[136:139], v2, s[4:7], s29 offen offset:0 sc1
  buffer_load_dwordx4 v[140:143], v2, s[4:7], s29 offen offset:1024 sc1
  s_add_u32 s29, s28, 180355072
  buffer_load_dwordx4 v[144:147], v2, s[4:7], s29 offen offset:0 sc1
  buffer_load_dwordx4 v[148:151], v2, s[4:7], s29 offen offset:1024 sc1
  s_add_u32 s29, s28, 182452224
  buffer_load_dwordx4 v[152:155], v2, s[4:7], s29 offen offset:0 sc1
  buffer_load_dwordx4 v[156:159], v2, s[4:7], s29 offen offset:1024 sc1
  v_pk_mul_f32 v[160:161], v[160:161], v[80:81] op_sel_hi:[1,0]
  v_pk_mul_f32 v[162:163], v[162:163], v[80:81] op_sel_hi:[1,0]
  v_pk_mul_f32 v[164:165], v[164:165], v[80:81] op_sel_hi:[1,0]
  v_pk_mul_f32 v[166:167], v[166:167], v[80:81] op_sel_hi:[1,0]
  v_pk_mul_f32 v[168:169], v[168:169], v[80:81] op_sel_hi:[1,0]
  v_pk_mul_f32 v[170:171], v[170:171], v[80:81] op_sel_hi:[1,0]
  v_pk_mul_f32 v[172:173], v[172:173], v[80:81] op_sel_hi:[1,0]
  v_pk_mul_f32 v[174:175], v[174:175], v[80:81] op_sel_hi:[1,0]
  s_waitcnt vmcnt(14)
  v_lshlrev_b32 v176, 16, v96
  v_and_b32 v177, 0xffff0000, v96
  v_lshlrev_b32 v178, 16, v97
  v_and_b32 v179, 0xffff0000, v97
  v_lshlrev_b32 v180, 16, v98
  v_and_b32 v181, 0xffff0000, v98
  v_lshlrev_b32 v182, 16, v99
  v_and_b32 v183, 0xffff0000, v99
  v_lshlrev_b32 v184, 16, v100
  v_and_b32 v185, 0xffff0000, v100
  v_lshlrev_b32 v186, 16, v101
  v_and_b32 v187, 0xffff0000, v101
  v_lshlrev_b32 v188, 16, v102
  v_and_b32 v189, 0xffff0000, v102
  v_lshlrev_b32 v190, 16, v103
  v_and_b32 v191, 0xffff0000, v103
  s_waitcnt vmcnt(12)
  v_lshlrev_b32 v8, 16, v104
  v_and_b32 v9, 0xffff0000, v104
  v_pk_add_f32 v[176:177], v[176:177], v[8:9]
  v_lshlrev_b32 v10, 16, v105
  v_and_b32 v11, 0xffff0000, v105
  v_pk_add_f32 v[178:179], v[178:179], v[10:11]
  v_lshlrev_b32 v12, 16, v106
  v_and_b32 v13, 0xffff0000, v106
  v_pk_add_f32 v[180:181], v[180:181], v[12:13]
  v_lshlrev_b32 v14, 16, v107
  v_and_b32 v15, 0xffff0000, v107
  v_pk_add_f32 v[182:183], v[182:183], v[14:15]
  v_lshlrev_b32 v8, 16, v108
  v_and_b32 v9, 0xffff0000, v108
  v_pk_add_f32 v[184:185], v[184:185], v[8:9]
  v_lshlrev_b32 v10, 16, v109
  v_and_b32 v11, 0xffff0000, v109
  v_pk_add_f32 v[186:187], v[186:187], v[10:11]
  v_lshlrev_b32 v12, 16, v110
  v_and_b32 v13, 0xffff0000, v110
  v_pk_add_f32 v[188:189], v[188:189], v[12:13]
  v_lshlrev_b32 v14, 16, v111
  v_and_b32 v15, 0xffff0000, v111
  v_pk_add_f32 v[190:191], v[190:191], v[14:15]
  s_waitcnt vmcnt(10)
  v_lshlrev_b32 v8, 16, v112
  v_and_b32 v9, 0xffff0000, v112
  v_pk_add_f32 v[176:177], v[176:177], v[8:9]
  v_lshlrev_b32 v10, 16, v113
  v_and_b32 v11, 0xffff0000, v113
  v_pk_add_f32 v[178:179], v[178:179], v[10:11]
  v_lshlrev_b32 v12, 16, v114
  v_and_b32 v13, 0xffff0000, v114
  v_pk_add_f32 v[180:181], v[180:181], v[12:13]
  v_lshlrev_b32 v14, 16, v115
  v_and_b32 v15, 0xffff0000, v115
  v_pk_add_f32 v[182:183], v[182:183], v[14:15]
  v_lshlrev_b32 v8, 16, v116
  v_and_b32 v9, 0xffff0000, v116
  v_pk_add_f32 v[184:185], v[184:185], v[8:9]
  v_lshlrev_b32 v10, 16, v117
  v_and_b32 v11, 0xffff0000, v117
  v_pk_add_f32 v[186:187], v[186:187], v[10:11]
  v_lshlrev_b32 v12, 16, v118
  v_and_b32 v13, 0xffff0000, v118
  v_pk_add_f32 v[188:189], v[188:189], v[12:13]
  v_lshlrev_b32 v14, 16, v119
  v_and_b32 v15, 0xffff0000, v119
  v_pk_add_f32 v[190:191], v[190:191], v[14:15]
  s_waitcnt vmcnt(8)
  v_lshlrev_b32 v8, 16, v120
  v_and_b32 v9, 0xffff0000, v120
  v_pk_add_f32 v[176:177], v[176:177], v[8:9]
  v_lshlrev_b32 v10, 16, v121
  v_and_b32 v11, 0xffff0000, v121
  v_pk_add_f32 v[178:179], v[178:179], v[10:11]
  v_lshlrev_b32 v12, 16, v122
  v_and_b32 v13, 0xffff0000, v122
  v_pk_add_f32 v[180:181], v[180:181], v[12:13]
  v_lshlrev_b32 v14, 16, v123
  v_and_b32 v15, 0xffff0000, v123
  v_pk_add_f32 v[182:183], v[182:183], v[14:15]
  v_lshlrev_b32 v8, 16, v124
  v_and_b32 v9, 0xffff0000, v124
  v_pk_add_f32 v[184:185], v[184:185], v[8:9]
  v_lshlrev_b32 v10, 16, v125
  v_and_b32 v11, 0xffff0000, v125
  v_pk_add_f32 v[186:187], v[186:187], v[10:11]
  v_lshlrev_b32 v12, 16, v126
  v_and_b32 v13, 0xffff0000, v126
  v_pk_add_f32 v[188:189], v[188:189], v[12:13]
  v_lshlrev_b32 v14, 16, v127
  v_and_b32 v15, 0xffff0000, v127
  v_pk_add_f32 v[190:191], v[190:191], v[14:15]
  s_waitcnt vmcnt(6)
  v_lshlrev_b32 v8, 16, v128
  v_and_b32 v9, 0xffff0000, v128
  v_pk_add_f32 v[176:177], v[176:177], v[8:9]
  v_lshlrev_b32 v10, 16, v129
  v_and_b32 v11, 0xffff0000, v129
  v_pk_add_f32 v[178:179], v[178:179], v[10:11]
  v_lshlrev_b32 v12, 16, v130
  v_and_b32 v13, 0xffff0000, v130
  v_pk_add_f32 v[180:181], v[180:181], v[12:13]
  v_lshlrev_b32 v14, 16, v131
  v_and_b32 v15, 0xffff0000, v131
  v_pk_add_f32 v[182:183], v[182:183], v[14:15]
  v_lshlrev_b32 v8, 16, v132
  v_and_b32 v9, 0xffff0000, v132
  v_pk_add_f32 v[184:185], v[184:185], v[8:9]
  v_lshlrev_b32 v10, 16, v133
  v_and_b32 v11, 0xffff0000, v133
  v_pk_add_f32 v[186:187], v[186:187], v[10:11]
  v_lshlrev_b32 v12, 16, v134
  v_and_b32 v13, 0xffff0000, v134
  v_pk_add_f32 v[188:189], v[188:189], v[12:13]
  v_lshlrev_b32 v14, 16, v135
  v_and_b32 v15, 0xffff0000, v135
  v_pk_add_f32 v[190:191], v[190:191], v[14:15]
  s_waitcnt vmcnt(4)
  v_lshlrev_b32 v8, 16, v136
  v_and_b32 v9, 0xffff0000, v136
  v_pk_add_f32 v[176:177], v[176:177], v[8:9]
  v_lshlrev_b32 v10, 16, v137
  v_and_b32 v11, 0xffff0000, v137
  v_pk_add_f32 v[178:179], v[178:179], v[10:11]
  v_lshlrev_b32 v12, 16, v138
  v_and_b32 v13, 0xffff0000, v138
  v_pk_add_f32 v[180:181], v[180:181], v[12:13]
  v_lshlrev_b32 v14, 16, v139
  v_and_b32 v15, 0xffff0000, v139
  v_pk_add_f32 v[182:183], v[182:183], v[14:15]
  v_lshlrev_b32 v8, 16, v140
  v_and_b32 v9, 0xffff0000, v140
  v_pk_add_f32 v[184:185], v[184:185], v[8:9]
  v_lshlrev_b32 v10, 16, v141
  v_and_b32 v11, 0xffff0000, v141
  v_pk_add_f32 v[186:187], v[186:187], v[10:11]
  v_lshlrev_b32 v12, 16, v142
  v_and_b32 v13, 0xffff0000, v142
  v_pk_add_f32 v[188:189], v[188:189], v[12:13]
  v_lshlrev_b32 v14, 16, v143
  v_and_b32 v15, 0xffff0000, v143
  v_pk_add_f32 v[190:191], v[190:191], v[14:15]
  s_waitcnt vmcnt(2)
  v_lshlrev_b32 v8, 16, v144
  v_and_b32 v9, 0xffff0000, v144
  v_pk_add_f32 v[176:177], v[176:177], v[8:9]
  v_lshlrev_b32 v10, 16, v145
  v_and_b32 v11, 0xffff0000, v145
  v_pk_add_f32 v[178:179], v[178:179], v[10:11]
  v_lshlrev_b32 v12, 16, v146
  v_and_b32 v13, 0xffff0000, v146
  v_pk_add_f32 v[180:181], v[180:181], v[12:13]
  v_lshlrev_b32 v14, 16, v147
  v_and_b32 v15, 0xffff0000, v147
  v_pk_add_f32 v[182:183], v[182:183], v[14:15]
  v_lshlrev_b32 v8, 16, v148
  v_and_b32 v9, 0xffff0000, v148
  v_pk_add_f32 v[184:185], v[184:185], v[8:9]
  v_lshlrev_b32 v10, 16, v149
  v_and_b32 v11, 0xffff0000, v149
  v_pk_add_f32 v[186:187], v[186:187], v[10:11]
  v_lshlrev_b32 v12, 16, v150
  v_and_b32 v13, 0xffff0000, v150
  v_pk_add_f32 v[188:189], v[188:189], v[12:13]
  v_lshlrev_b32 v14, 16, v151
  v_and_b32 v15, 0xffff0000, v151
  v_pk_add_f32 v[190:191], v[190:191], v[14:15]
  s_waitcnt vmcnt(0)
  v_lshlrev_b32 v8, 16, v152
  v_and_b32 v9, 0xffff0000, v152
  v_pk_add_f32 v[176:177], v[176:177], v[8:9]
  v_lshlrev_b32 v10, 16, v153
  v_and_b32 v11, 0xffff0000, v153
  v_pk_add_f32 v[178:179], v[178:179], v[10:11]
  v_lshlrev_b32 v12, 16, v154
  v_and_b32 v13, 0xffff0000, v154
  v_pk_add_f32 v[180:181], v[180:181], v[12:13]
  v_lshlrev_b32 v14, 16, v155
  v_and_b32 v15, 0xffff0000, v155
  v_pk_add_f32 v[182:183], v[182:183], v[14:15]
  v_lshlrev_b32 v8, 16, v156
  v_and_b32 v9, 0xffff0000, v156
  v_pk_add_f32 v[184:185], v[184:185], v[8:9]
  v_lshlrev_b32 v10, 16, v157
  v_and_b32 v11, 0xffff0000, v157
  v_pk_add_f32 v[186:187], v[186:187], v[10:11]
  v_lshlrev_b32 v12, 16, v158
  v_and_b32 v13, 0xffff0000, v158
  v_pk_add_f32 v[188:189], v[188:189], v[12:13]
  v_lshlrev_b32 v14, 16, v159
  v_and_b32 v15, 0xffff0000, v159
  v_pk_add_f32 v[190:191], v[190:191], v[14:15]
  v_pk_fma_f32 v[160:161], v[176:177], v[82:83], v[160:161] op_sel_hi:[1,0,1]
  v_cvt_pk_bf16_f32 v16, v160, v161
  v_pk_fma_f32 v[162:163], v[178:179], v[82:83], v[162:163] op_sel_hi:[1,0,1]
  v_cvt_pk_bf16_f32 v17, v162, v163
  v_pk_fma_f32 v[164:165], v[180:181], v[82:83], v[164:165] op_sel_hi:[1,0,1]
  v_cvt_pk_bf16_f32 v18, v164, v165
  v_pk_fma_f32 v[166:167], v[182:183], v[82:83], v[166:167] op_sel_hi:[1,0,1]
  v_cvt_pk_bf16_f32 v19, v166, v167
  v_pk_fma_f32 v[168:169], v[184:185], v[82:83], v[168:169] op_sel_hi:[1,0,1]
  v_cvt_pk_bf16_f32 v20, v168, v169
  v_pk_fma_f32 v[170:171], v[186:187], v[82:83], v[170:171] op_sel_hi:[1,0,1]
  v_cvt_pk_bf16_f32 v21, v170, v171
  v_pk_fma_f32 v[172:173], v[188:189], v[82:83], v[172:173] op_sel_hi:[1,0,1]
  v_cvt_pk_bf16_f32 v22, v172, v173
  v_pk_fma_f32 v[174:175], v[190:191], v[82:83], v[174:175] op_sel_hi:[1,0,1]
  v_cvt_pk_bf16_f32 v23, v174, v175
  s_lshl_b32 s26, s49, 2
  s_add_u32 s26, s26, s16
  s_lshl_b32 s26, s26, 6
  s_lshl_b32 s27, s48, 15
  s_add_u32 s26, s26, s27
  buffer_store_dwordx4 v[16:19], v6, s[32:35], s26 offen offset:0
  buffer_store_dwordx4 v[20:23], v6, s[32:35], s26 offen offset:32
  s_cmp_lt_u32 s50, 64
  s_mov_b32 s50, s51
  s_cbranch_scc1 M_fin
  s_branch M_done
M_follow:
  s_lshr_b32 s48, s64, 2
  s_and_b32 s49, s64, 1
  s_bfe_u32 s50, s64, 0x10001
  s_mov_b32 s51, 2
  s_mov_b32 s23, 32
  s_load_dwordx2 s[8:9], s[0:1], 40
  s_lshl_b32 s77, s64, 17
  v_lshlrev_b32 v4, 7, v0
  s_waitcnt lgkmcnt(0)
  s_and_b32 s9, s9, 0xffff
  s_mov_b32 s10, 4194304
  s_mov_b32 s11, 0x20000
  buffer_load_dword v250, v4, s[8:11], s77 offen
  s_add_u32 s77, s77, 32768
  buffer_load_dword v250, v4, s[8:11], s77 offen
  s_add_u32 s77, s77, 32768
  buffer_load_dword v250, v4, s[8:11], s77 offen
  s_add_u32 s77, s77, 32768
  buffer_load_dword v250, v4, s[8:11], s77 offen
  s_add_u32 s77, s77, 32768
  s_load_dwordx2 s[8:9], s[0:1], 88
  s_lshl_b32 s17, s48, 19
  s_lshl_b32 s26, s49, 2
  s_add_u32 s26, s26, s16
  s_lshl_b32 s27, s26, 7
  s_add_u32 s17, s17, s27
  s_mov_b32 s18, 1024
  s_lshl_b32 s21, s48, 6
  s_add_u32 s21, s21, s50
  s_lshl_b32 s21, s21, 3
  s_add_u32 s21, s21, s26
  s_lshl_b32 s21, s21, 12
  s_add_u32 s21, s21, 167772160
  s_lshl_b32 s22, s51, 15
  s_mov_b32 s24, 1.0
  s_waitcnt lgkmcnt(0)
  s_and_b32 s9, s9, 0xffff
  s_mov_b32 s10, 4194304
  s_mov_b32 s11, 0x20000
  s_mul_i32 s26, s16, 0
  v_add_u32 v8, 0, v2
  v_add_u32 v16, s26, v8
  v_add_u32 v9, 1024, v2
  v_add_u32 v17, s26, v9
  v_add_u32 v10, 2048, v2
  v_add_u32 v18, s26, v10
  v_add_u32 v11, 3072, v2
  v_add_u32 v19, s26, v11
  v_add_u32 v12, 4096, v2
  v_add_u32 v20, s26, v12
  v_add_u32 v13, 5120, v2
  v_add_u32 v21, s26, v13
  v_add_u32 v14, 6144, v2
  v_add_u32 v22, s26, v14
  v_add_u32 v15, 7168, v2
  v_add_u32 v23, s26, v15
  v_lshrrev_b32 v144, 3, v1
  v_mul_lo_u32 v144, v144, s18
  v_and_b32 v145, 7, v1
  v_lshl_add_u32 v144, v145, 4, v144
  s_lshl_b32 s28, s16, 15
  s_add_u32 s28, s28, 32768
  s_lshl_b32 s29, s18, 3
  s_add_u32 m0, s28, 0
  s_nop 0
  buffer_load_dwordx4 v144, s[8:11], s17 offen lds
  s_add_u32 s17, s17, s29
  s_add_u32 m0, s28, 1024
  s_nop 0
  buffer_load_dwordx4 v144, s[8:11], s17 offen lds
  s_add_u32 s17, s17, s29
  s_add_u32 m0, s28, 2048
  s_nop 0
  buffer_load_dwordx4 v144, s[8:11], s17 offen lds
  s_add_u32 s17, s17, s29
  s_add_u32 m0, s28, 3072
  s_nop 0
  buffer_load_dwordx4 v144, s[8:11], s17 offen lds
  s_add_u32 s17, s17, s29
  s_add_u32 m0, s28, 4096
  s_nop 0
  buffer_load_dwordx4 v144, s[8:11], s17 offen lds
  s_add_u32 s17, s17, s29
  s_add_u32 m0, s28, 5120
  s_nop 0
  buffer_load_dwordx4 v144, s[8:11], s17 offen lds
  s_add_u32 s17, s17, s29
  s_add_u32 m0, s28, 6144
  s_nop 0
  buffer_load_dwordx4 v144, s[8:11], s17 offen lds
  s_add_u32 s17, s17, s29
  s_add_u32 m0, s28, 7168
  s_nop 0
  buffer_load_dwordx4 v144, s[8:11], s17 offen lds
  s_add_u32 s17, s17, s29
  s_add_u32 m0, s28, 8192
  s_nop 0
  buffer_load_dwordx4 v144, s[8:11], s17 offen lds
  s_add_u32 s17, s17, s29
  s_add_u32 m0, s28, 9216
  s_nop 0
  buffer_load_dwordx4 v144, s[8:11], s17 offen lds
  s_add_u32 s17, s17, s29
  s_add_u32 m0, s28, 10240
  s_nop 0
  buffer_load_dwordx4 v144, s[8:11], s17 offen lds
  s_add_u32 s17, s17, s29
  s_add_u32 m0, s28, 11264
  s_nop 0
  buffer_load_dwordx4 v144, s[8:11], s17 offen lds
  s_add_u32 s17, s17, s29
  s_add_u32 m0, s28, 12288
  s_nop 0
  buffer_load_dwordx4 v144, s[8:11], s17 offen lds
  s_add_u32 s17, s17, s29
  s_add_u32 m0, s28, 13312
  s_nop 0
  buffer_load_dwordx4 v144, s[8:11], s17 offen lds
  s_add_u32 s17, s17, s29
  s_add_u32 m0, s28, 14336
  s_nop 0
  buffer_load_dwordx4 v144, s[8:11], s17 offen lds
  s_add_u32 s17, s17, s29
  s_add_u32 m0, s28, 15360
  s_nop 0
  buffer_load_dwordx4 v144, s[8:11], s17 offen lds
  s_add_u32 s17, s17, s29
  s_add_u32 m0, s28, 16384
  s_nop 0
  buffer_load_dwordx4 v144, s[8:11], s17 offen lds
  s_add_u32 s17, s17, s29
  s_add_u32 m0, s28, 17408
  s_nop 0
  buffer_load_dwordx4 v144, s[8:11], s17 offen lds
  s_add_u32 s17, s17, s29
  s_add_u32 m0, s28, 18432
  s_nop 0
  buffer_load_dwordx4 v144, s[8:11], s17 offen lds
  s_add_u32 s17, s17, s29
  s_add_u32 m0, s28, 19456
  s_nop 0
  buffer_load_dwordx4 v144, s[8:11], s17 offen lds
  s_add_u32 s17, s17, s29
  s_add_u32 m0, s28, 20480
  s_nop 0
  buffer_load_dwordx4 v144, s[8:11], s17 offen lds
  s_add_u32 s17, s17, s29
  s_add_u32 m0, s28, 21504
  s_nop 0
  buffer_load_dwordx4 v144, s[8:11], s17 offen lds
  s_add_u32 s17, s17, s29
  s_add_u32 m0, s28, 22528
  s_nop 0
  buffer_load_dwordx4 v144, s[8:11], s17 offen lds
  s_add_u32 s17, s17, s29
  s_add_u32 m0, s28, 23552
  s_nop 0
  buffer_load_dwordx4 v144, s[8:11], s17 offen lds
  s_add_u32 s17, s17, s29
  s_add_u32 m0, s28, 24576
  s_nop 0
  buffer_load_dwordx4 v144, s[8:11], s17 offen lds
  s_add_u32 s17, s17, s29
  s_add_u32 m0, s28, 25600
  s_nop 0
  buffer_load_dwordx4 v144, s[8:11], s17 offen lds
  s_add_u32 s17, s17, s29
  s_add_u32 m0, s28, 26624
  s_nop 0
  buffer_load_dwordx4 v144, s[8:11], s17 offen lds
  s_add_u32 s17, s17, s29
  s_add_u32 m0, s28, 27648
  s_nop 0
  buffer_load_dwordx4 v144, s[8:11], s17 offen lds
  s_add_u32 s17, s17, s29
  s_add_u32 m0, s28, 28672
  s_nop 0
  buffer_load_dwordx4 v144, s[8:11], s17 offen lds
  s_add_u32 s17, s17, s29
  s_add_u32 m0, s28, 29696
  s_nop 0
  buffer_load_dwordx4 v144, s[8:11], s17 offen lds
  s_add_u32 s17, s17, s29
  s_add_u32 m0, s28, 30720
  s_nop 0
  buffer_load_dwordx4 v144, s[8:11], s17 offen lds
  s_add_u32 s17, s17, s29
  s_add_u32 m0, s28, 31744
  s_nop 0
  buffer_load_dwordx4 v144, s[8:11], s17 offen lds
  s_add_u32 s17, s17, s29
  v_bfe_u32 v148, v1, 2, 2
  v_lshrrev_b32 v149, 5, v1
  v_lshl_add_u32 v148, v149, 2, v148
  v_lshlrev_b32 v148, 7, v148
  v_bfe_u32 v149, v1, 4, 1
  v_lshl_add_u32 v148, v149, 5, v148
  v_and_b32 v149, 1, v1
  v_lshl_add_u32 v148, v149, 4, v148
  v_bfe_u32 v149, v1, 1, 1
  v_lshl_add_u32 v148, v149, 3, v148
  v_add_u32 v146, s28, v148
  v_add_u32 v147, 1024, v146
  s_waitcnt vmcnt(28)
  ds_read_b64_tr_b16 a[0:1], v146 offset:0
  ds_read_b64_tr_b16 a[2:3], v147 offset:0
  ds_read_b64_tr_b16 a[4:5], v146 offset:64
  ds_read_b64_tr_b16 a[6:7], v147 offset:64
  ds_read_b64_tr_b16 a[8:9], v146 offset:2048
  ds_read_b64_tr_b16 a[10:11], v147 offset:2048
  ds_read_b64_tr_b16 a[12:13], v146 offset:2112
  ds_read_b64_tr_b16 a[14:15], v147 offset:2112
  s_waitcnt lgkmcnt(0)
  s_add_u32 m0, s28, 0
  s_nop 0
  buffer_load_dwordx4 v144, s[8:11], s17 offen lds
  s_add_u32 s17, s17, s29
  s_add_u32 m0, s28, 1024
  s_nop 0
  buffer_load_dwordx4 v144, s[8:11], s17 offen lds
  s_add_u32 s17, s17, s29
  s_add_u32 m0, s28, 2048
  s_nop 0
  buffer_load_dwordx4 v144, s[8:11], s17 offen lds
  s_add_u32 s17, s17, s29
  s_add_u32 m0, s28, 3072
  s_nop 0
  buffer_load_dwordx4 v144, s[8:11], s17 offen lds
  s_add_u32 s17, s17, s29
  s_waitcnt vmcnt(28)
  ds_read_b64_tr_b16 a[16:17], v146 offset:4096
  ds_read_b64_tr_b16 a[18:19], v147 offset:4096
  ds_read_b64_tr_b16 a[20:21], v146 offset:4160
  ds_read_b64_tr_b16 a[22:23], v147 offset:4160
  ds_read_b64_tr_b16 a[24:25], v146 offset:6144
  ds_read_b64_tr_b16 a[26:27], v147 offset:6144
  ds_read_b64_tr_b16 a[28:29], v146 offset:6208
  ds_read_b64_tr_b16 a[30:31], v147 offset:6208
  s_waitcnt lgkmcnt(0)
  s_add_u32 m0, s28, 4096
  s_nop 0
  buffer_load_dwordx4 v144, s[8:11], s17 offen lds
  s_add_u32 s17, s17, s29
  s_add_u32 m0, s28, 5120
  s_nop 0
  buffer_load_dwordx4 v144, s[8:11], s17 offen lds
  s_add_u32 s17, s17, s29
  s_add_u32 m0, s28, 6144
  s_nop 0
  buffer_load_dwordx4 v144, s[8:11], s17 offen lds
  s_add_u32 s17, s17, s29
  s_add_u32 m0, s28, 7168
  s_nop 0
  buffer_load_dwordx4 v144, s[8:11], s17 offen lds
  s_add_u32 s17, s17, s29
  s_waitcnt vmcnt(28)
  ds_read_b64_tr_b16 a[32:33], v146 offset:8192
  ds_read_b64_tr_b16 a[34:35], v147 offset:8192
  ds_read_b64_tr_b16 a[36:37], v146 offset:8256
  ds_read_b64_tr_b16 a[38:39], v147 offset:8256
  ds_read_b64_tr_b16 a[40:41], v146 offset:10240
  ds_read_b64_tr_b16 a[42:43], v147 offset:10240
  ds_read_b64_tr_b16 a[44:45], v146 offset:10304
  ds_read_b64_tr_b16 a[46:47], v147 offset:10304
  s_waitcnt lgkmcnt(0)
  s_add_u32 m0, s28, 8192
  s_nop 0
  buffer_load_dwordx4 v144, s[8:11], s17 offen lds
  s_add_u32 s17, s17, s29
  s_add_u32 m0, s28, 9216
  s_nop 0
  buffer_load_dwordx4 v144, s[8:11], s17 offen lds
  s_add_u32 s17, s17, s29
  s_add_u32 m0, s28, 10240
  s_nop 0
  buffer_load_dwordx4 v144, s[8:11], s17 offen lds
  s_add_u32 s17, s17, s29
  s_add_u32 m0, s28, 11264
  s_nop 0
  buffer_load_dwordx4 v144, s[8:11], s17 offen lds
  s_add_u32 s17, s17, s29
  s_waitcnt vmcnt(28)
  ds_read_b64_tr_b16 a[48:49], v146 offset:12288
  ds_read_b64_tr_b16 a[50:51], v147 offset:12288
  ds_read_b64_tr_b16 a[52:53], v146 offset:12352
  ds_read_b64_tr_b16 a[54:55], v147 offset:12352
  ds_read_b64_tr_b16 a[56:57], v146 offset:14336
  ds_read_b64_tr_b16 a[58:59], v147 offset:14336
  ds_read_b64_tr_b16 a[60:61], v146 offset:14400
  ds_read_b64_tr_b16 a[62:63], v147 offset:14400
  s_waitcnt lgkmcnt(0)
  s_add_u32 m0, s28, 12288
  s_nop 0
  buffer_load_dwordx4 v144, s[8:11], s17 offen lds
  s_add_u32 s17, s17, s29
  s_add_u32 m0, s28, 13312
  s_nop 0
  buffer_load_dwordx4 v144, s[8:11], s17 offen lds
  s_add_u32 s17, s17, s29
  s_add_u32 m0, s28, 14336
  s_nop 0
  buffer_load_dwordx4 v144, s[8:11], s17 offen lds
  s_add_u32 s17, s17, s29
  s_add_u32 m0, s28, 15360
  s_nop 0
  buffer_load_dwordx4 v144, s[8:11], s17 offen lds
  s_add_u32 s17, s17, s29
  s_waitcnt vmcnt(28)
  ds_read_b64_tr_b16 a[64:65], v146 offset:16384
  ds_read_b64_tr_b16 a[66:67], v147 offset:16384
  ds_read_b64_tr_b16 a[68:69], v146 offset:16448
  ds_read_b64_tr_b16 a[70:71], v147 offset:16448
  ds_read_b64_tr_b16 a[72:73], v146 offset:18432
  ds_read_b64_tr_b16 a[74:75], v147 offset:18432
  ds_read_b64_tr_b16 a[76:77], v146 offset:18496
  ds_read_b64_tr_b16 a[78:79], v147 offset:18496
  s_waitcnt lgkmcnt(0)
  s_add_u32 m0, s28, 16384
  s_nop 0
  buffer_load_dwordx4 v144, s[8:11], s17 offen lds
  s_add_u32 s17, s17, s29
  s_add_u32 m0, s28, 17408
  s_nop 0
  buffer_load_dwordx4 v144, s[8:11], s17 offen lds
  s_add_u32 s17, s17, s29
  s_add_u32 m0, s28, 18432
  s_nop 0
  buffer_load_dwordx4 v144, s[8:11], s17 offen lds
  s_add_u32 s17, s17, s29
  s_add_u32 m0, s28, 19456
  s_nop 0
  buffer_load_dwordx4 v144, s[8:11], s17 offen lds
  s_add_u32 s17, s17, s29
  s_waitcnt vmcnt(28)
  ds_read_b64_tr_b16 a[80:81], v146 offset:20480
  ds_read_b64_tr_b16 a[82:83], v147 offset:20480
  ds_read_b64_tr_b16 a[84:85], v146 offset:20544
  ds_read_b64_tr_b16 a[86:87], v147 offset:20544
  ds_read_b64_tr_b16 a[88:89], v146 offset:22528
  ds_read_b64_tr_b16 a[90:91], v147 offset:22528
  ds_read_b64_tr_b16 a[92:93], v146 offset:22592
  ds_read_b64_tr_b16 a[94:95], v147 offset:22592
  s_waitcnt lgkmcnt(0)
  s_add_u32 m0, s28, 20480
  s_nop 0
  buffer_load_dwordx4 v144, s[8:11], s17 offen lds
  s_add_u32 s17, s17, s29
  s_add_u32 m0, s28, 21504
  s_nop 0
  buffer_load_dwordx4 v144, s[8:11], s17 offen lds
  s_add_u32 s17, s17, s29
  s_add_u32 m0, s28, 22528
  s_nop 0
  buffer_load_dwordx4 v144, s[8:11], s17 offen lds
  s_add_u32 s17, s17, s29
  s_add_u32 m0, s28, 23552
  s_nop 0
  buffer_load_dwordx4 v144, s[8:11], s17 offen lds
  s_add_u32 s17, s17, s29
  s_waitcnt vmcnt(28)
  ds_read_b64_tr_b16 a[96:97], v146 offset:24576
  ds_read_b64_tr_b16 a[98:99], v147 offset:24576
  ds_read_b64_tr_b16 a[100:101], v146 offset:24640
  ds_read_b64_tr_b16 a[102:103], v147 offset:24640
  ds_read_b64_tr_b16 a[104:105], v146 offset:26624
  ds_read_b64_tr_b16 a[106:107], v147 offset:26624
  ds_read_b64_tr_b16 a[108:109], v146 offset:26688
  ds_read_b64_tr_b16 a[110:111], v147 offset:26688
  s_waitcnt lgkmcnt(0)
  s_add_u32 m0, s28, 24576
  s_nop 0
  buffer_load_dwordx4 v144, s[8:11], s17 offen lds
  s_add_u32 s17, s17, s29
  s_add_u32 m0, s28, 25600
  s_nop 0
  buffer_load_dwordx4 v144, s[8:11], s17 offen lds
  s_add_u32 s17, s17, s29
  s_add_u32 m0, s28, 26624
  s_nop 0
  buffer_load_dwordx4 v144, s[8:11], s17 offen lds
  s_add_u32 s17, s17, s29
  s_add_u32 m0, s28, 27648
  s_nop 0
  buffer_load_dwordx4 v144, s[8:11], s17 offen lds
  s_add_u32 s17, s17, s29
  s_waitcnt vmcnt(28)
  ds_read_b64_tr_b16 a[112:113], v146 offset:28672
  ds_read_b64_tr_b16 a[114:115], v147 offset:28672
  ds_read_b64_tr_b16 a[116:117], v146 offset:28736
  ds_read_b64_tr_b16 a[118:119], v147 offset:28736
  ds_read_b64_tr_b16 a[120:121], v146 offset:30720
  ds_read_b64_tr_b16 a[122:123], v147 offset:30720
  ds_read_b64_tr_b16 a[124:125], v146 offset:30784
  ds_read_b64_tr_b16 a[126:127], v147 offset:30784
  s_waitcnt lgkmcnt(0)
  s_add_u32 m0, s28, 28672
  s_nop 0
  buffer_load_dwordx4 v144, s[8:11], s17 offen lds
  s_add_u32 s17, s17, s29
  s_add_u32 m0, s28, 29696
  s_nop 0
  buffer_load_dwordx4 v144, s[8:11], s17 offen lds
  s_add_u32 s17, s17, s29
  s_add_u32 m0, s28, 30720
  s_nop 0
  buffer_load_dwordx4 v144, s[8:11], s17 offen lds
  s_add_u32 s17, s17, s29
  s_add_u32 m0, s28, 31744
  s_nop 0
  buffer_load_dwordx4 v144, s[8:11], s17 offen lds
  s_add_u32 s17, s17, s29
  s_waitcnt vmcnt(28)
  ds_read_b64_tr_b16 a[128:129], v146 offset:0
  ds_read_b64_tr_b16 a[130:131], v147 offset:0
  ds_read_b64_tr_b16 a[132:133], v146 offset:64
  ds_read_b64_tr_b16 a[134:135], v147 offset:64
  ds_read_b64_tr_b16 a[136:137], v146 offset:2048
  ds_read_b64_tr_b16 a[138:139], v147 offset:2048
  ds_read_b64_tr_b16 a[140:141], v146 offset:2112
  ds_read_b64_tr_b16 a[142:143], v147 offset:2112
  s_waitcnt lgkmcnt(0)
  s_waitcnt vmcnt(24)
  ds_read_b64_tr_b16 a[144:145], v146 offset:4096
  ds_read_b64_tr_b16 a[146:147], v147 offset:4096
  ds_read_b64_tr_b16 a[148:149], v146 offset:4160
  ds_read_b64_tr_b16 a[150:151], v147 offset:4160
  ds_read_b64_tr_b16 a[152:153], v146 offset:6144
  ds_read_b64_tr_b16 a[154:155], v147 offset:6144
  ds_read_b64_tr_b16 a[156:157], v146 offset:6208
  ds_read_b64_tr_b16 a[158:159], v147 offset:6208
  s_waitcnt lgkmcnt(0)
  s_waitcnt vmcnt(20)
  ds_read_b64_tr_b16 a[160:161], v146 offset:8192
  ds_read_b64_tr_b16 a[162:163], v147 offset:8192
  ds_read_b64_tr_b16 a[164:165], v146 offset:8256
  ds_read_b64_tr_b16 a[166:167], v147 offset:8256
  ds_read_b64_tr_b16 a[168:169], v146 offset:10240
  ds_read_b64_tr_b16 a[170:171], v147 offset:10240
  ds_read_b64_tr_b16 a[172:173], v146 offset:10304
  ds_read_b64_tr_b16 a[174:175], v147 offset:10304
  s_waitcnt lgkmcnt(0)
  s_waitcnt vmcnt(16)
  ds_read_b64_tr_b16 a[176:177], v146 offset:12288
  ds_read_b64_tr_b16 a[178:179], v147 offset:12288
  ds_read_b64_tr_b16 a[180:181], v146 offset:12352
  ds_read_b64_tr_b16 a[182:183], v147 offset:12352
  ds_read_b64_tr_b16 a[184:185], v146 offset:14336
  ds_read_b64_tr_b16 a[186:187], v147 offset:14336
  ds_read_b64_tr_b16 a[188:189], v146 offset:14400
  ds_read_b64_tr_b16 a[190:191], v147 offset:14400
  s_waitcnt lgkmcnt(0)
  s_waitcnt vmcnt(12)
  ds_read_b64_tr_b16 a[192:193], v146 offset:16384
  ds_read_b64_tr_b16 a[194:195], v147 offset:16384
  ds_read_b64_tr_b16 a[196:197], v146 offset:16448
  ds_read_b64_tr_b16 a[198:199], v147 offset:16448
  ds_read_b64_tr_b16 a[200:201], v146 offset:18432
  ds_read_b64_tr_b16 a[202:203], v147 offset:18432
  ds_read_b64_tr_b16 a[204:205], v146 offset:18496
  ds_read_b64_tr_b16 a[206:207], v147 offset:18496
  s_waitcnt lgkmcnt(0)
  s_waitcnt vmcnt(8)
  ds_read_b64_tr_b16 a[208:209], v146 offset:20480
  ds_read_b64_tr_b16 a[210:211], v147 offset:20480
  ds_read_b64_tr_b16 a[212:213], v146 offset:20544
  ds_read_b64_tr_b16 a[214:215], v147 offset:20544
  ds_read_b64_tr_b16 a[216:217], v146 offset:22528
  ds_read_b64_tr_b16 a[218:219], v147 offset:22528
  ds_read_b64_tr_b16 a[220:221], v146 offset:22592
  ds_read_b64_tr_b16 a[222:223], v147 offset:22592
  s_waitcnt lgkmcnt(0)
  s_waitcnt vmcnt(4)
  ds_read_b64_tr_b16 a[224:225], v146 offset:24576
  ds_read_b64_tr_b16 a[226:227], v147 offset:24576
  ds_read_b64_tr_b16 a[228:229], v146 offset:24640
  ds_read_b64_tr_b16 a[230:231], v147 offset:24640
  ds_read_b64_tr_b16 a[232:233], v146 offset:26624
  ds_read_b64_tr_b16 a[234:235], v147 offset:26624
  ds_read_b64_tr_b16 a[236:237], v146 offset:26688
  ds_read_b64_tr_b16 a[238:239], v147 offset:26688
  s_waitcnt lgkmcnt(0)
  s_waitcnt vmcnt(0)
  ds_read_b64_tr_b16 a[240:241], v146 offset:28672
  ds_read_b64_tr_b16 a[242:243], v147 offset:28672
  ds_read_b64_tr_b16 a[244:245], v146 offset:28736
  ds_read_b64_tr_b16 a[246:247], v147 offset:28736
  ds_read_b64_tr_b16 a[248:249], v146 offset:30720
  ds_read_b64_tr_b16 a[250:251], v147 offset:30720
  ds_read_b64_tr_b16 a[252:253], v146 offset:30784
  ds_read_b64_tr_b16 a[254:255], v147 offset:30784
  s_waitcnt lgkmcnt(0)
  s_lshl_b32 s26, s48, 2
  s_add_u32 s26, s26, s16
  s_lshl_b32 s27, s26, 6
  s_add_u32 s27, s27, s50
  s_lshl_b32 s19, s27, 13
  s_lshl_b32 s27, s50, 5
  s_add_u32 s27, s27, s26
  s_mul_i32 s27, s27, 4096
  s_add_u32 s20, s27, 135266304
  s_lshl_b32 s25, s16, 12
  s_add_u32 s25, s25, 65536
  s_lshl_b32 s26, s16, 13
  v_add_u32 v3, s26, v2
  v_lshrrev_b32 v16, 5, v1
  v_and_b32 v17, 31, v1
  v_bfe_u32 v18, v1, 4, 1
  v_lshl_add_u32 v18, v18, 1, v16
  v_and_b32 v19, 15, v1
  v_lshl_add_u32 v18, v18, 4, v19
  v_lshl_add_u32 v5, v18, 4, s25
  v_bfe_u32 v18, v1, 2, 2
  v_lshl_add_u32 v18, v16, 2, v18
  v_and_b32 v19, 1, v1
  v_lshl_add_u32 v18, v19, 4, v18
  v_lshl_add_u32 v4, v18, 4, s25
  v_lshlrev_b32 v16, 2, v16
  v_sub_u32 v17, v17, v16
  v_mov_b32 v18, 0xf149f2ca
  v_cmp_le_i32 vcc, 0, v17
  s_nop 1
  v_cndmask_b32 v240, v18, 0, vcc
  v_cmp_le_i32 vcc, 1, v17
  s_nop 1
  v_cndmask_b32 v241, v18, 0, vcc
  v_cmp_le_i32 vcc, 2, v17
  s_nop 1
  v_cndmask_b32 v242, v18, 0, vcc
  v_cmp_le_i32 vcc, 3, v17
  s_nop 1
  v_cndmask_b32 v243, v18, 0, vcc
  v_cmp_le_i32 vcc, 8, v17
  s_nop 1
  v_cndmask_b32 v244, v18, 0, vcc
  v_cmp_le_i32 vcc, 9, v17
  s_nop 1
  v_cndmask_b32 v245, v18, 0, vcc
  v_cmp_le_i32 vcc, 10, v17
  s_nop 1
  v_cndmask_b32 v246, v18, 0, vcc
  v_cmp_le_i32 vcc, 11, v17
  s_nop 1
  v_cndmask_b32 v247, v18, 0, vcc
  v_cmp_le_i32 vcc, 16, v17
  s_nop 1
  v_cndmask_b32 v248, v18, 0, vcc
  v_cmp_le_i32 vcc, 17, v17
  s_nop 1
  v_cndmask_b32 v249, v18, 0, vcc
  v_cmp_le_i32 vcc, 18, v17
  s_nop 1
  v_cndmask_b32 v250, v18, 0, vcc
  v_cmp_le_i32 vcc, 19, v17
  s_nop 1
  v_cndmask_b32 v251, v18, 0, vcc
  v_cmp_le_i32 vcc, 24, v17
  s_nop 1
  v_cndmask_b32 v252, v18, 0, vcc
  v_cmp_le_i32 vcc, 25, v17
  s_nop 1
  v_cndmask_b32 v253, v18, 0, vcc
  v_cmp_le_i32 vcc, 26, v17
  s_nop 1
  v_cndmask_b32 v254, v18, 0, vcc
  v_cmp_le_i32 vcc, 27, v17
  s_nop 1
  v_cndmask_b32 v255, v18, 0, vcc
  v_mov_b32 v21, v2
  s_barrier
  s_lshl_b32 s77, s48, 2
  s_add_u32 s77, s77, s16
  s_mul_i32 s78, s77, 896
  s_add_u32 s76, s78, 148898304
  s_mov_b32 s71, 0
  s_branch M_sg_55
M_sw_54:
  s_sleep 8
  s_add_u32 s71, s71, 1
  s_cmp_gt_u32 s71, 262144
  s_cbranch_scc1 M_exit
M_sg_55:
  s_mov_b32 s79, 0
  s_atomic_or s79, s[72:73], s76 glc
  s_waitcnt lgkmcnt(0)
  s_cmp_lt_u32 s79, 16
  s_cbranch_scc1 M_sw_54
  s_add_u32 s76, s78, 148898048
  s_mov_b32 s71, 0
  s_branch M_sg_57
M_sw_56:
  s_sleep 8
  s_add_u32 s71, s71, 1
  s_cmp_gt_u32 s71, 262144
  s_cbranch_scc1 M_exit
M_sg_57:
  s_mov_b32 s79, 0
  s_atomic_or s79, s[72:73], s76 glc
  s_waitcnt lgkmcnt(0)
  s_cmp_lt_u32 s79, 16
  s_cbranch_scc1 M_sw_56
M_xok_53:
  s_lshl_b32 s77, s77, 7
  s_add_u32 s54, s77, 148926464
  s_add_u32 s52, s50, 1
  s_mov_b32 s53, 0
  s_mov_b32 s30, 0x200
  s_add_u32 s28, s19, 50331648
  buffer_load_dwordx4 v[144:147], v21, s[4:7], s28 offen offset:0 sc1
  buffer_load_dwordx4 v[148:151], v21, s[4:7], s28 offen offset:1024 sc1
  buffer_load_dwordx4 v[152:155], v21, s[4:7], s28 offen offset:2048 sc1
  buffer_load_dwordx4 v[156:159], v21, s[4:7], s28 offen offset:3072 sc1
  s_add_u32 s29, s19, 50335744
  buffer_load_dwordx4 v[160:163], v21, s[4:7], s29 offen offset:0 sc1
  buffer_load_dwordx4 v[164:167], v21, s[4:7], s29 offen offset:1024 sc1
  buffer_load_dwordx4 v[168:171], v21, s[4:7], s29 offen offset:2048 sc1
  buffer_load_dwordx4 v[172:175], v21, s[4:7], s29 offen offset:3072 sc1
  s_add_u32 s28, s19, 67108864
  buffer_load_dwordx4 v[176:179], v21, s[4:7], s28 offen offset:0 sc1
  buffer_load_dwordx4 v[180:183], v21, s[4:7], s28 offen offset:1024 sc1
  buffer_load_dwordx4 v[184:187], v21, s[4:7], s28 offen offset:2048 sc1
  buffer_load_dwordx4 v[188:191], v21, s[4:7], s28 offen offset:3072 sc1
  s_add_u32 s29, s19, 67112960
  buffer_load_dwordx4 v[192:195], v21, s[4:7], s29 offen offset:0 sc1
  buffer_load_dwordx4 v[196:199], v21, s[4:7], s29 offen offset:1024 sc1
  buffer_load_dwordx4 v[200:203], v21, s[4:7], s29 offen offset:2048 sc1
  buffer_load_dwordx4 v[204:207], v21, s[4:7], s29 offen offset:3072 sc1
  s_add_u32 s28, s19, 83886080
  buffer_load_dwordx4 v[208:211], v21, s[4:7], s28 offen offset:0 sc1
  buffer_load_dwordx4 v[212:215], v21, s[4:7], s28 offen offset:1024 sc1
  buffer_load_dwordx4 v[216:219], v21, s[4:7], s28 offen offset:2048 sc1
  buffer_load_dwordx4 v[220:223], v21, s[4:7], s28 offen offset:3072 sc1
  s_add_u32 s29, s19, 83890176
  buffer_load_dwordx4 v[224:227], v21, s[4:7], s29 offen offset:0 sc1
  buffer_load_dwordx4 v[228:231], v21, s[4:7], s29 offen offset:1024 sc1
  buffer_load_dwordx4 v[232:235], v21, s[4:7], s29 offen offset:2048 sc1
  buffer_load_dwordx4 v[236:239], v21, s[4:7], s29 offen offset:3072 sc1
  s_mov_b32 s24, 0
  v_mov_b32 v22, 0x40000000
  s_sub_u32 s21, s21, s22
F_top_58:
  s_waitcnt vmcnt(8)
  v_mfma_f32_32x32x16_bf16 v[24:39], v[176:179], v[144:147], v[240:255]
  s_nop 1
  v_cvt_pk_bf16_f32 v128, v64, v65
  v_cvt_pk_bf16_f32 v129, v66, v67
  v_cvt_pk_bf16_f32 v130, v68, v69
  v_cvt_pk_bf16_f32 v131, v70, v71
  v_mfma_f32_32x32x16_bf16 v[24:39], v[180:183], v[148:151], v[24:39]
  buffer_store_dwordx4 v[128:131], v22, s[4:7], s21 offen offset:0 sc1
  v_mfma_f32_32x32x16_bf16 v[24:39], v[184:187], v[152:155], v[24:39]
  v_cvt_pk_bf16_f32 v132, v72, v73
  v_cvt_pk_bf16_f32 v133, v74, v75
  v_cvt_pk_bf16_f32 v134, v76, v77
  v_cvt_pk_bf16_f32 v135, v78, v79
  v_mfma_f32_32x32x16_bf16 v[24:39], v[188:191], v[156:159], v[24:39]
  buffer_store_dwordx4 v[132:135], v22, s[4:7], s21 offen offset:1024 sc1
  v_mfma_f32_32x32x16_bf16 v[24:39], v[192:195], v[160:163], v[24:39]
  v_cvt_pk_bf16_f32 v136, v80, v81
  v_cvt_pk_bf16_f32 v137, v82, v83
  v_cvt_pk_bf16_f32 v138, v84, v85
  v_cvt_pk_bf16_f32 v139, v86, v87
  v_mfma_f32_32x32x16_bf16 v[24:39], v[196:199], v[164:167], v[24:39]
  buffer_store_dwordx4 v[136:139], v22, s[4:7], s21 offen offset:2048 sc1
  v_mfma_f32_32x32x16_bf16 v[24:39], v[200:203], v[168:171], v[24:39]
  v_cvt_pk_bf16_f32 v140, v88, v89
  v_cvt_pk_bf16_f32 v141, v90, v91
  v_cvt_pk_bf16_f32 v142, v92, v93
  v_cvt_pk_bf16_f32 v143, v94, v95
  v_mfma_f32_32x32x16_bf16 v[24:39], v[204:207], v[172:175], v[24:39]
  buffer_store_dwordx4 v[140:143], v22, s[4:7], s21 offen offset:3072 sc1
  s_add_u32 s21, s21, s22
  v_mov_b32 v22, v2
  s_cmp_lg_u32 s24, 0
  s_cbranch_scc1 F_have_59
  v_mov_b32 v16, s54
  v_mov_b32 v17, s52
  s_mov_b32 s71, 0
  s_branch M_vg_61
M_vw_60:
  s_sleep 2
  s_add_u32 s71, s71, 1
  s_cmp_gt_u32 s71, 262144
  s_cbranch_scc1 M_exit
M_vg_61:
  buffer_load_dword v23, v16, s[4:7], 0 offen sc1
  s_waitcnt vmcnt(0)
  v_cmp_lt_u32 vcc, v23, v17
  s_cbranch_vccnz M_vw_60
  s_mov_b32 m0, s25
  s_nop 0
  buffer_load_dwordx4 v2, s[4:7], s20 offen offset:0 sc1 lds
  buffer_load_dwordx4 v2, s[4:7], s20 offen offset:1024 sc1 lds
  buffer_load_dwordx4 v2, s[4:7], s20 offen offset:2048 sc1 lds
  buffer_load_dwordx4 v2, s[4:7], s20 offen offset:3072 sc1 lds
  s_waitcnt vmcnt(0)
F_have_59:
  ds_read_b64_tr_b16 v[176:177], v4 offset:8
  ds_read_b64_tr_b16 v[178:179], v4 offset:136
  ds_read_b64_tr_b16 v[180:181], v4 offset:520
  ds_read_b64_tr_b16 v[182:183], v4 offset:648
  ds_read_b64_tr_b16 v[184:185], v4 offset:1032
  ds_read_b64_tr_b16 v[186:187], v4 offset:1160
  ds_read_b64_tr_b16 v[188:189], v4 offset:1544
  ds_read_b64_tr_b16 v[190:191], v4 offset:1672
  ds_read_b64_tr_b16 v[192:193], v4 offset:2056
  ds_read_b64_tr_b16 v[194:195], v4 offset:2184
  ds_read_b64_tr_b16 v[196:197], v4 offset:2568
  ds_read_b64_tr_b16 v[198:199], v4 offset:2696
  s_sub_u32 s23, s23, 1
  s_cmp_gt_u32 s23, 0
  s_cselect_b32 s26, s51, 0
  s_cselect_b32 s27, 0, 0x40000000
  v_or_b32 v21, s27, v21
  s_lshl_b32 s27, s26, 13
  s_add_u32 s19, s19, s27
  s_mul_i32 s27, s26, 131072
  s_add_u32 s20, s20, s27
  s_cmp_lg_u32 s23, 24
  s_cbranch_scc1 M_xok_62
  s_lshl_b32 s77, s48, 2
  s_add_u32 s77, s77, s16
  s_mul_i32 s78, s77, 896
  s_add_u32 s76, s78, 148898304
  s_mov_b32 s71, 0
  s_branch M_sg_64
M_sw_63:
  s_sleep 8
  s_add_u32 s71, s71, 1
  s_cmp_gt_u32 s71, 262144
  s_cbranch_scc1 M_exit
M_sg_64:
  s_mov_b32 s79, 0
  s_atomic_or s79, s[72:73], s76 glc
  s_waitcnt lgkmcnt(0)
  s_cmp_lt_u32 s79, 32
  s_cbranch_scc1 M_sw_63
  s_add_u32 s76, s78, 148898432
  s_mov_b32 s71, 0
  s_branch M_sg_66
M_sw_65:
  s_sleep 8
  s_add_u32 s71, s71, 1
  s_cmp_gt_u32 s71, 262144
  s_cbranch_scc1 M_exit
M_sg_66:
  s_mov_b32 s79, 0
  s_atomic_or s79, s[72:73], s76 glc
  s_waitcnt lgkmcnt(0)
  s_cmp_lt_u32 s79, 32
  s_cbranch_scc1 M_sw_65
  s_add_u32 s76, s78, 148898048
  s_mov_b32 s71, 0
  s_branch M_sg_68
M_sw_67:
  s_sleep 8
  s_add_u32 s71, s71, 1
  s_cmp_gt_u32 s71, 262144
  s_cbranch_scc1 M_exit
M_sg_68:
  s_mov_b32 s79, 0
  s_atomic_or s79, s[72:73], s76 glc
  s_waitcnt lgkmcnt(0)
  s_cmp_lt_u32 s79, 30
  s_cbranch_scc1 M_sw_67
  s_add_u32 s76, s78, 148898176
  s_mov_b32 s71, 0
  s_branch M_sg_70
M_sw_69:
  s_sleep 8
  s_add_u32 s71, s71, 1
  s_cmp_gt_u32 s71, 262144
  s_cbranch_scc1 M_exit
M_sg_70:
  s_mov_b32 s79, 0
  s_atomic_or s79, s[72:73], s76 glc
  s_waitcnt lgkmcnt(0)
  s_cmp_lt_u32 s79, 34
  s_cbranch_scc1 M_sw_69
M_xok_62:
  s_waitcnt lgkmcnt(10)
  v_mfma_f32_32x32x16_bf16 v[40:55], v[176:179], v[144:147], 0
  ds_read_b64_tr_b16 v[200:201], v4 offset:3080
  ds_read_b64_tr_b16 v[202:203], v4 offset:3208
  v_max_f32 v6, v24, v25
  s_waitcnt lgkmcnt(10)
  v_mfma_f32_32x32x16_bf16 v[40:55], v[180:183], v[148:151], v[40:55]
  ds_read_b64_tr_b16 v[204:205], v4 offset:3592
  ds_read_b64_tr_b16 v[206:207], v4 offset:3720
  v_max3_f32 v6, v6, v26, v27
  s_waitcnt lgkmcnt(10)
  v_mfma_f32_32x32x16_bf16 v[40:55], v[184:187], v[152:155], v[40:55]
  ds_read_b64 v[56:57], v5 offset:0
  ds_read_b64 v[58:59], v5 offset:1024
  v_max3_f32 v6, v6, v28, v29
  s_waitcnt lgkmcnt(10)
  v_mfma_f32_32x32x16_bf16 v[40:55], v[188:191], v[156:159], v[40:55]
  ds_read_b64 v[60:61], v5 offset:2048
  ds_read_b64 v[62:63], v5 offset:3072
  v_max3_f32 v6, v6, v30, v31
  s_waitcnt lgkmcnt(10)
  v_mfma_f32_32x32x16_bf16 v[40:55], v[192:195], v[160:163], v[40:55]
  v_max3_f32 v6, v6, v32, v33
  s_waitcnt lgkmcnt(8)
  v_mfma_f32_32x32x16_bf16 v[40:55], v[196:199], v[164:167], v[40:55]
  v_max3_f32 v6, v6, v34, v35
  s_waitcnt lgkmcnt(6)
  v_mfma_f32_32x32x16_bf16 v[40:55], v[200:203], v[168:171], v[40:55]
  v_max3_f32 v6, v6, v36, v37
  s_waitcnt lgkmcnt(4)
  v_mfma_f32_32x32x16_bf16 v[40:55], v[204:207], v[172:175], v[40:55]
  v_max3_f32 v6, v6, v38, v39
  s_add_u32 s28, s19, 50331648
  buffer_load_dwordx4 v[144:147], v21, s[4:7], s28 offen offset:0 sc1
  buffer_load_dwordx4 v[148:151], v21, s[4:7], s28 offen offset:1024 sc1
  s_nop 7
  v_max3_f32 v6, v6, v40, v41
  v_max3_f32 v6, v6, v42, v43
  v_mov_b32 v16, v6
  s_nop 1
  v_permlane32_swap_b32 v6, v16
  s_nop 1
  v_max_f32 v6, v6, v16
  v_pk_add_f32 v[24:25], v[24:25], v[6:7] op_sel_hi:[1,0] neg_lo:[0,1] neg_hi:[0,1]
  v_pk_add_f32 v[26:27], v[26:27], v[6:7] op_sel_hi:[1,0] neg_lo:[0,1] neg_hi:[0,1]
  v_pk_add_f32 v[28:29], v[28:29], v[6:7] op_sel_hi:[1,0] neg_lo:[0,1] neg_hi:[0,1]
  v_pk_add_f32 v[30:31], v[30:31], v[6:7] op_sel_hi:[1,0] neg_lo:[0,1] neg_hi:[0,1]
  v_pk_add_f32 v[32:33], v[32:33], v[6:7] op_sel_hi:[1,0] neg_lo:[0,1] neg_hi:[0,1]
  v_pk_add_f32 v[34:35], v[34:35], v[6:7] op_sel_hi:[1,0] neg_lo:[0,1] neg_hi:[0,1]
  v_pk_add_f32 v[36:37], v[36:37], v[6:7] op_sel_hi:[1,0] neg_lo:[0,1] neg_hi:[0,1]
  v_pk_add_f32 v[38:39], v[38:39], v[6:7] op_sel_hi:[1,0] neg_lo:[0,1] neg_hi:[0,1]
  v_pk_add_f32 v[40:41], v[40:41], v[6:7] op_sel_hi:[1,0] neg_lo:[0,1] neg_hi:[0,1]
  v_pk_add_f32 v[42:43], v[42:43], v[6:7] op_sel_hi:[1,0] neg_lo:[0,1] neg_hi:[0,1]
  v_exp_f32 v24, v24
  v_exp_f32 v25, v25
  v_exp_f32 v26, v26
  v_exp_f32 v27, v27
  v_exp_f32 v28, v28
  v_exp_f32 v29, v29
  v_exp_f32 v30, v30
  v_exp_f32 v31, v31
  v_exp_f32 v32, v32
  v_exp_f32 v33, v33
  buffer_load_dwordx4 v[152:155], v21, s[4:7], s28 offen offset:2048 sc1
  v_exp_f32 v34, v34
  v_exp_f32 v35, v35
  v_exp_f32 v36, v36
  v_exp_f32 v37, v37
  v_exp_f32 v38, v38
  v_exp_f32 v39, v39
  v_exp_f32 v40, v40
  v_exp_f32 v41, v41
  v_exp_f32 v42, v42
  v_exp_f32 v43, v43
  v_pk_add_f32 v[16:17], v[24:25], v[26:27]
  v_pk_add_f32 v[16:17], v[16:17], v[28:29]
  v_pk_add_f32 v[16:17], v[16:17], v[30:31]
  v_pk_add_f32 v[16:17], v[16:17], v[32:33]
  v_pk_add_f32 v[16:17], v[16:17], v[34:35]
  v_pk_add_f32 v[16:17], v[16:17], v[36:37]
  v_pk_add_f32 v[16:17], v[16:17], v[38:39]
  v_pk_add_f32 v[16:17], v[16:17], v[40:41]
  v_pk_add_f32 v[16:17], v[16:17], v[42:43]
  v_add_f32 v16, v16, v17
  v_mov_b32 v17, v16
  buffer_load_dwordx4 v[156:159], v21, s[4:7], s28 offen offset:3072 sc1
  s_nop 0
  v_permlane32_swap_b32 v16, v17
  s_nop 1
  v_add_f32 v16, v16, v17
  v_rcp_f32 v6, v16
  s_nop 0
  v_pk_mul_f32 v[24:25], v[24:25], v[6:7] op_sel_hi:[1,0]
  v_pk_mul_f32 v[26:27], v[26:27], v[6:7] op_sel_hi:[1,0]
  v_pk_mul_f32 v[28:29], v[28:29], v[6:7] op_sel_hi:[1,0]
  v_pk_mul_f32 v[30:31], v[30:31], v[6:7] op_sel_hi:[1,0]
  v_pk_mul_f32 v[32:33], v[32:33], v[6:7] op_sel_hi:[1,0]
  v_pk_mul_f32 v[34:35], v[34:35], v[6:7] op_sel_hi:[1,0]
  v_pk_mul_f32 v[36:37], v[36:37], v[6:7] op_sel_hi:[1,0]
  v_pk_mul_f32 v[38:39], v[38:39], v[6:7] op_sel_hi:[1,0]
  v_pk_mul_f32 v[40:41], v[40:41], v[6:7] op_sel_hi:[1,0]
  v_pk_mul_f32 v[42:43], v[42:43], v[6:7] op_sel_hi:[1,0]
  v_cvt_pk_bf16_f32 v128, v24, v25
  v_cvt_pk_bf16_f32 v129, v26, v27
  v_cvt_pk_bf16_f32 v130, v28, v29
  v_cvt_pk_bf16_f32 v131, v30, v31
  v_cvt_pk_bf16_f32 v132, v32, v33
  v_cvt_pk_bf16_f32 v133, v34, v35
  v_cvt_pk_bf16_f32 v134, v36, v37
  v_cvt_pk_bf16_f32 v135, v38, v39
  v_cvt_pk_bf16_f32 v136, v40, v41
  v_cvt_pk_bf16_f32 v137, v42, v43
  s_waitcnt vmcnt(8) lgkmcnt(0)
  v_mfma_f32_32x32x16_bf16 v[64:79], v[208:211], v[128:131], 0
  s_add_u32 s29, s19, 50335744
  buffer_load_dwordx4 v[160:163], v21, s[4:7], s29 offen offset:0 sc1
  v_mfma_f32_32x32x16_bf16 v[64:79], v[212:215], v[132:135], v[64:79]
  v_mfma_f32_32x32x8_bf16 v[64:79], v[56:57], v[136:137], v[64:79]
  v_mfma_f32_32x32x16_bf16 v[80:95], v[216:219], v[128:131], 0
  buffer_load_dwordx4 v[164:167], v21, s[4:7], s29 offen offset:1024 sc1
  v_mfma_f32_32x32x16_bf16 v[80:95], v[220:223], v[132:135], v[80:95]
  v_cvt_pk_bf16_f32 v24, v64, v65
  v_cvt_pk_bf16_f32 v25, v66, v67
  v_cvt_pk_bf16_f32 v26, v68, v69
  v_cvt_pk_bf16_f32 v27, v70, v71
  v_mfma_f32_32x32x8_bf16 v[80:95], v[58:59], v[136:137], v[80:95]
  ds_write_b128 v3, v[24:27] offset:0
  v_cvt_pk_bf16_f32 v28, v72, v73
  v_cvt_pk_bf16_f32 v29, v74, v75
  v_cvt_pk_bf16_f32 v30, v76, v77
  v_cvt_pk_bf16_f32 v31, v78, v79
  v_mfma_f32_32x32x16_bf16 v[96:111], v[224:227], v[128:131], 0
  ds_write_b128 v3, v[28:31] offset:1024
  buffer_load_dwordx4 v[168:171], v21, s[4:7], s29 offen offset:2048 sc1
  v_mfma_f32_32x32x16_bf16 v[96:111], v[228:231], v[132:135], v[96:111]
  v_cvt_pk_bf16_f32 v32, v80, v81
  v_cvt_pk_bf16_f32 v33, v82, v83
  v_cvt_pk_bf16_f32 v34, v84, v85
  v_cvt_pk_bf16_f32 v35, v86, v87
  v_mfma_f32_32x32x8_bf16 v[96:111], v[60:61], v[136:137], v[96:111]
  ds_write_b128 v3, v[32:35] offset:2048
  v_cvt_pk_bf16_f32 v36, v88, v89
  v_cvt_pk_bf16_f32 v37, v90, v91
  v_cvt_pk_bf16_f32 v38, v92, v93
  v_cvt_pk_bf16_f32 v39, v94, v95
  v_mfma_f32_32x32x16_bf16 v[112:127], v[232:235], v[128:131], 0
  ds_write_b128 v3, v[36:39] offset:3072
  buffer_load_dwordx4 v[172:175], v21, s[4:7], s29 offen offset:3072 sc1
  v_mfma_f32_32x32x16_bf16 v[112:127], v[236:239], v[132:135], v[112:127]
  v_cvt_pk_bf16_f32 v40, v96, v97
  v_cvt_pk_bf16_f32 v41, v98, v99
  v_cvt_pk_bf16_f32 v42, v100, v101
  v_cvt_pk_bf16_f32 v43, v102, v103
  v_mfma_f32_32x32x8_bf16 v[112:127], v[62:63], v[136:137], v[112:127]
  ds_write_b128 v3, v[40:43] offset:4096
  v_cvt_pk_bf16_f32 v44, v104, v105
  v_cvt_pk_bf16_f32 v45, v106, v107
  v_cvt_pk_bf16_f32 v46, v108, v109
  v_cvt_pk_bf16_f32 v47, v110, v111
  ds_write_b128 v3, v[44:47] offset:5120
  s_nop 5
  v_cvt_pk_bf16_f32 v48, v112, v113
  v_cvt_pk_bf16_f32 v49, v114, v115
  v_cvt_pk_bf16_f32 v50, v116, v117
  v_cvt_pk_bf16_f32 v51, v118, v119
  ds_write_b128 v3, v[48:51] offset:6144
  v_cvt_pk_bf16_f32 v52, v120, v121
  v_cvt_pk_bf16_f32 v53, v122, v123
  v_cvt_pk_bf16_f32 v54, v124, v125
  v_cvt_pk_bf16_f32 v55, v126, v127
  ds_write_b128 v3, v[52:55] offset:7168
  s_waitcnt vmcnt(8)
  s_waitcnt lgkmcnt(0)
  s_barrier
  ds_read_b128 v[24:27], v8 offset:0
  ds_read_b128 v[28:31], v9 offset:0
  ds_read_b128 v[32:35], v10 offset:0
  ds_read_b128 v[36:39], v11 offset:0
  ds_read_b128 v[40:43], v12 offset:0
  ds_read_b128 v[44:47], v13 offset:0
  v_readfirstlane_b32 s53, v23
  v_mov_b32 v16, s30
  v_min_u32 v17, 1, v0
  v_lshlrev_b32 v17, 30, v17
  buffer_store_dword v16, v17, s[4:7], s31 offen sc1
  s_add_u32 s30, s30, 1
  s_add_u32 s52, s52, 2
  s_cmp_ge_u32 s53, s52
  s_cselect_b32 s24, 1, 0
  buffer_load_dword v23, off, s[4:7], s54 sc1
  s_cmp_eq_u32 s24, 0
  s_cbranch_scc1 F_nopre_71
  s_mov_b32 m0, s25
  s_nop 0
  buffer_load_dwordx4 v2, s[4:7], s20 offen offset:0 sc1 lds
  buffer_load_dwordx4 v2, s[4:7], s20 offen offset:1024 sc1 lds
  buffer_load_dwordx4 v2, s[4:7], s20 offen offset:2048 sc1 lds
  buffer_load_dwordx4 v2, s[4:7], s20 offen offset:3072 sc1 lds
F_nopre_71:
  s_waitcnt lgkmcnt(5)
  v_mfma_f32_32x32x16_bf16 v[64:79], a[0:3], v[24:27], 0
  s_add_u32 s28, s19, 67108864
  ds_read_b128 v[48:51], v14 offset:0
  v_mfma_f32_32x32x16_bf16 v[80:95], a[4:7], v[24:27], 0
  s_waitcnt lgkmcnt(5)
  v_mfma_f32_32x32x16_bf16 v[64:79], a[8:11], v[28:31], v[64:79]
  ds_read_b128 v[52:55], v15 offset:0
  v_mfma_f32_32x32x16_bf16 v[80:95], a[12:15], v[28:31], v[80:95]
  s_waitcnt lgkmcnt(5)
  buffer_load_dwordx4 v[176:179], v21, s[4:7], s28 offen offset:0 sc1
  v_mfma_f32_32x32x16_bf16 v[64:79], a[16:19], v[32:35], v[64:79]
  ds_read_b128 v[24:27], v8 offset:8192
  v_mfma_f32_32x32x16_bf16 v[80:95], a[20:23], v[32:35], v[80:95]
  s_waitcnt lgkmcnt(5)
  v_mfma_f32_32x32x16_bf16 v[64:79], a[24:27], v[36:39], v[64:79]
  ds_read_b128 v[28:31], v9 offset:8192
  v_mfma_f32_32x32x16_bf16 v[80:95], a[28:31], v[36:39], v[80:95]
  s_waitcnt lgkmcnt(5)
  buffer_load_dwordx4 v[180:183], v21, s[4:7], s28 offen offset:1024 sc1
  v_mfma_f32_32x32x16_bf16 v[64:79], a[32:35], v[40:43], v[64:79]
  ds_read_b128 v[32:35], v10 offset:8192
  v_mfma_f32_32x32x16_bf16 v[80:95], a[36:39], v[40:43], v[80:95]
  s_waitcnt lgkmcnt(5)
  v_mfma_f32_32x32x16_bf16 v[64:79], a[40:43], v[44:47], v[64:79]
  ds_read_b128 v[36:39], v11 offset:8192
  v_mfma_f32_32x32x16_bf16 v[80:95], a[44:47], v[44:47], v[80:95]
  s_waitcnt lgkmcnt(5)
  buffer_load_dwordx4 v[184:187], v21, s[4:7], s28 offen offset:2048 sc1
  v_mfma_f32_32x32x16_bf16 v[64:79], a[48:51], v[48:51], v[64:79]
  ds_read_b128 v[40:43], v12 offset:8192
  v_mfma_f32_32x32x16_bf16 v[80:95], a[52:55], v[48:51], v[80:95]
  s_waitcnt lgkmcnt(5)
  v_mfma_f32_32x32x16_bf16 v[64:79], a[56:59], v[52:55], v[64:79]
  ds_read_b128 v[44:47], v13 offset:8192
  v_mfma_f32_32x32x16_bf16 v[80:95], a[60:63], v[52:55], v[80:95]
  s_waitcnt lgkmcnt(5)
  buffer_load_dwordx4 v[188:191], v21, s[4:7], s28 offen offset:3072 sc1
  v_mfma_f32_32x32x16_bf16 v[64:79], a[64:67], v[24:27], v[64:79]
  s_add_u32 s29, s19, 67112960
  ds_read_b128 v[48:51], v14 offset:8192
  v_mfma_f32_32x32x16_bf16 v[80:95], a[68:71], v[24:27], v[80:95]
  s_waitcnt lgkmcnt(5)
  v_mfma_f32_32x32x16_bf16 v[64:79], a[72:75], v[28:31], v[64:79]
  ds_read_b128 v[52:55], v15 offset:8192
  v_mfma_f32_32x32x16_bf16 v[80:95], a[76:79], v[28:31], v[80:95]
  s_waitcnt lgkmcnt(5)
  buffer_load_dwordx4 v[192:195], v21, s[4:7], s29 offen offset:0 sc1
  v_mfma_f32_32x32x16_bf16 v[64:79], a[80:83], v[32:35], v[64:79]
  ds_read_b128 v[24:27], v8 offset:16384
  v_mfma_f32_32x32x16_bf16 v[80:95], a[84:87], v[32:35], v[80:95]
  s_waitcnt lgkmcnt(5)
  v_mfma_f32_32x32x16_bf16 v[64:79], a[88:91], v[36:39], v[64:79]
  ds_read_b128 v[28:31], v9 offset:16384
  v_mfma_f32_32x32x16_bf16 v[80:95], a[92:95], v[36:39], v[80:95]
  s_waitcnt lgkmcnt(5)
  buffer_load_dwordx4 v[196:199], v21, s[4:7], s29 offen offset:1024 sc1
  v_mfma_f32_32x32x16_bf16 v[64:79], a[96:99], v[40:43], v[64:79]
  ds_read_b128 v[32:35], v10 offset:16384
  v_mfma_f32_32x32x16_bf16 v[80:95], a[100:103], v[40:43], v[80:95]
  s_waitcnt lgkmcnt(5)
  v_mfma_f32_32x32x16_bf16 v[64:79], a[104:107], v[44:47], v[64:79]
  ds_read_b128 v[36:39], v11 offset:16384
  v_mfma_f32_32x32x16_bf16 v[80:95], a[108:111], v[44:47], v[80:95]
  s_waitcnt lgkmcnt(5)
  buffer_load_dwordx4 v[200:203], v21, s[4:7], s29 offen offset:2048 sc1
  v_mfma_f32_32x32x16_bf16 v[64:79], a[112:115], v[48:51], v[64:79]
  ds_read_b128 v[40:43], v12 offset:16384
  v_mfma_f32_32x32x16_bf16 v[80:95], a[116:119], v[48:51], v[80:95]
  s_waitcnt lgkmcnt(5)
  v_mfma_f32_32x32x16_bf16 v[64:79], a[120:123], v[52:55], v[64:79]
  ds_read_b128 v[44:47], v13 offset:16384
  v_mfma_f32_32x32x16_bf16 v[80:95], a[124:127], v[52:55], v[80:95]
  s_waitcnt lgkmcnt(5)
  buffer_load_dwordx4 v[204:207], v21, s[4:7], s29 offen offset:3072 sc1
  v_mfma_f32_32x32x16_bf16 v[64:79], a[128:131], v[24:27], v[64:79]
  s_add_u32 s28, s19, 83886080
  ds_read_b128 v[48:51], v14 offset:16384
  v_mfma_f32_32x32x16_bf16 v[80:95], a[132:135], v[24:27], v[80:95]
  s_waitcnt lgkmcnt(5)
  v_mfma_f32_32x32x16_bf16 v[64:79], a[136:139], v[28:31], v[64:79]
  ds_read_b128 v[52:55], v15 offset:16384
  v_mfma_f32_32x32x16_bf16 v[80:95], a[140:143], v[28:31], v[80:95]
  s_waitcnt lgkmcnt(5)
  buffer_load_dwordx4 v[208:211], v21, s[4:7], s28 offen offset:0 sc1
  v_mfma_f32_32x32x16_bf16 v[64:79], a[144:147], v[32:35], v[64:79]
  ds_read_b128 v[24:27], v8 offset:24576
  v_mfma_f32_32x32x16_bf16 v[80:95], a[148:151], v[32:35], v[80:95]
  s_waitcnt lgkmcnt(5)
  v_mfma_f32_32x32x16_bf16 v[64:79], a[152:155], v[36:39], v[64:79]
  ds_read_b128 v[28:31], v9 offset:24576
  v_mfma_f32_32x32x16_bf16 v[80:95], a[156:159], v[36:39], v[80:95]
  s_waitcnt lgkmcnt(5)
  buffer_load_dwordx4 v[212:215], v21, s[4:7], s28 offen offset:1024 sc1
  v_mfma_f32_32x32x16_bf16 v[64:79], a[160:163], v[40:43], v[64:79]
  ds_read_b128 v[32:35], v10 offset:24576
  v_mfma_f32_32x32x16_bf16 v[80:95], a[164:167], v[40:43], v[80:95]
  s_waitcnt lgkmcnt(5)
  v_mfma_f32_32x32x16_bf16 v[64:79], a[168:171], v[44:47], v[64:79]
  ds_read_b128 v[36:39], v11 offset:24576
  v_mfma_f32_32x32x16_bf16 v[80:95], a[172:175], v[44:47], v[80:95]
  s_waitcnt lgkmcnt(5)
  buffer_load_dwordx4 v[216:219], v21, s[4:7], s28 offen offset:2048 sc1
  v_mfma_f32_32x32x16_bf16 v[64:79], a[176:179], v[48:51], v[64:79]
  ds_read_b128 v[40:43], v12 offset:24576
  v_mfma_f32_32x32x16_bf16 v[80:95], a[180:183], v[48:51], v[80:95]
  s_waitcnt lgkmcnt(5)
  v_mfma_f32_32x32x16_bf16 v[64:79], a[184:187], v[52:55], v[64:79]
  ds_read_b128 v[44:47], v13 offset:24576
  v_mfma_f32_32x32x16_bf16 v[80:95], a[188:191], v[52:55], v[80:95]
  s_waitcnt lgkmcnt(5)
  buffer_load_dwordx4 v[220:223], v21, s[4:7], s28 offen offset:3072 sc1
  v_mfma_f32_32x32x16_bf16 v[64:79], a[192:195], v[24:27], v[64:79]
  s_add_u32 s29, s19, 83890176
  ds_read_b128 v[48:51], v14 offset:24576
  v_mfma_f32_32x32x16_bf16 v[80:95], a[196:199], v[24:27], v[80:95]
  s_waitcnt lgkmcnt(5)
  v_mfma_f32_32x32x16_bf16 v[64:79], a[200:203], v[28:31], v[64:79]
  ds_read_b128 v[52:55], v15 offset:24576
  v_mfma_f32_32x32x16_bf16 v[80:95], a[204:207], v[28:31], v[80:95]
  s_waitcnt lgkmcnt(5)
  buffer_load_dwordx4 v[224:227], v21, s[4:7], s29 offen offset:0 sc1
  v_mfma_f32_32x32x16_bf16 v[64:79], a[208:211], v[32:35], v[64:79]
  v_mfma_f32_32x32x16_bf16 v[80:95], a[212:215], v[32:35], v[80:95]
  s_waitcnt lgkmcnt(4)
  v_mfma_f32_32x32x16_bf16 v[64:79], a[216:219], v[36:39], v[64:79]
  v_xor_b32 v8, 0x8000, v8
  v_mfma_f32_32x32x16_bf16 v[80:95], a[220:223], v[36:39], v[80:95]
  s_waitcnt lgkmcnt(3)
  buffer_load_dwordx4 v[228:231], v21, s[4:7], s29 offen offset:1024 sc1
  v_xor_b32 v9, 0x8000, v9
  v_mfma_f32_32x32x16_bf16 v[64:79], a[224:227], v[40:43], v[64:79]
  v_xor_b32 v10, 0x8000, v10
  v_mfma_f32_32x32x16_bf16 v[80:95], a[228:231], v[40:43], v[80:95]
  s_waitcnt lgkmcnt(2)
  v_xor_b32 v11, 0x8000, v11
  v_mfma_f32_32x32x16_bf16 v[64:79], a[232:235], v[44:47], v[64:79]
  v_xor_b32 v12, 0x8000, v12
  v_mfma_f32_32x32x16_bf16 v[80:95], a[236:239], v[44:47], v[80:95]
  s_waitcnt lgkmcnt(1)
  buffer_load_dwordx4 v[232:235], v21, s[4:7], s29 offen offset:2048 sc1
  v_xor_b32 v13, 0x8000, v13
  v_mfma_f32_32x32x16_bf16 v[64:79], a[240:243], v[48:51], v[64:79]
  v_xor_b32 v14, 0x8000, v14
  v_mfma_f32_32x32x16_bf16 v[80:95], a[244:247], v[48:51], v[80:95]
  s_waitcnt lgkmcnt(0)
  v_xor_b32 v15, 0x8000, v15
  v_mfma_f32_32x32x16_bf16 v[64:79], a[248:251], v[52:55], v[64:79]
  v_xor_b32 v3, 0x8000, v3
  v_mfma_f32_32x32x16_bf16 v[80:95], a[252:255], v[52:55], v[80:95]
  buffer_load_dwordx4 v[236:239], v21, s[4:7], s29 offen offset:3072 sc1
  s_cmp_gt_u32 s23, 0
  s_cbranch_scc1 F_top_58
  s_nop 2
  v_cvt_pk_bf16_f32 v128, v64, v65
  v_cvt_pk_bf16_f32 v129, v66, v67
  v_cvt_pk_bf16_f32 v130, v68, v69
  v_cvt_pk_bf16_f32 v131, v70, v71
  buffer_store_dwordx4 v[128:131], v22, s[4:7], s21 offen offset:0 sc1
  v_cvt_pk_bf16_f32 v132, v72, v73
  v_cvt_pk_bf16_f32 v133, v74, v75
  v_cvt_pk_bf16_f32 v134, v76, v77
  v_cvt_pk_bf16_f32 v135, v78, v79
  buffer_store_dwordx4 v[132:135], v22, s[4:7], s21 offen offset:1024 sc1
  v_cvt_pk_bf16_f32 v136, v80, v81
  v_cvt_pk_bf16_f32 v137, v82, v83
  v_cvt_pk_bf16_f32 v138, v84, v85
  v_cvt_pk_bf16_f32 v139, v86, v87
  buffer_store_dwordx4 v[136:139], v22, s[4:7], s21 offen offset:2048 sc1
  v_cvt_pk_bf16_f32 v140, v88, v89
  v_cvt_pk_bf16_f32 v141, v90, v91
  v_cvt_pk_bf16_f32 v142, v92, v93
  v_cvt_pk_bf16_f32 v143, v94, v95
  buffer_store_dwordx4 v[140:143], v22, s[4:7], s21 offen offset:3072 sc1
  s_waitcnt vmcnt(0) lgkmcnt(0)
  s_barrier
  v_mov_b32 v144, s30
  v_min_u32 v145, 1, v0
  v_lshlrev_b32 v145, 30, v145
  buffer_store_dword v144, v145, s[4:7], s31 offen sc1
  s_branch M_done
M_team:
  s_mov_b32 s12, s77
  s_load_dwordx4 s[60:63], s[0:1], 64
  s_load_dwordx4 s[64:67], s[0:1], 80
  s_load_dwordx4 s[68:71], s[0:1], 120
  s_load_dwordx2 s[72:73], s[0:1], 56
  v_lshrrev_b32 v1, 6, v0
  v_and_b32 v20, 63, v0
  v_readfirstlane_b32 s13, v1
  s_waitcnt lgkmcnt(0)
  s_mov_b32 s8, s60
  s_and_b32 s9, s61, 0xffff
  s_mov_b32 s10, 0x400000
  s_mov_b32 s11, 0x20000
  s_mov_b32 s40, s62
  s_and_b32 s41, s63, 0xffff
  s_mov_b32 s42, 0x400000
  s_mov_b32 s43, 0x20000
  s_mov_b32 s44, s64
  s_and_b32 s45, s65, 0xffff
  s_mov_b32 s46, 0x400000
  s_mov_b32 s47, 0x20000
  s_mov_b32 s48, s66
  s_and_b32 s49, s67, 0xffff
  s_mov_b32 s50, 0x400000
  s_mov_b32 s51, 0x20000
  s_mov_b32 s4, s70
  s_and_b32 s5, s71, 0xffff
  s_mov_b32 s6, 0x10000000
  s_mov_b32 s7, 0x20000
  s_mov_b32 s76, s72
  s_and_b32 s77, s73, 0xffff
  s_mov_b32 s78, 0x2000
  s_mov_b32 s79, 0x20000
  s_mov_b32 s72, s68
  s_and_b32 s73, s69, 0xffff
  s_mov_b32 s74, 0x100
  s_mov_b32 s75, 0x20000
  s_mov_b64 s[52:53], s[68:69]
  s_mov_b64 s[58:59], s[70:71]
  s_mul_i32 s99, s12, 896
  s_add_u32 s99, s99, 148898048
  s_lshl_b32 s15, s12, 7
  s_add_u32 s15, s15, 148926464
  v_lshrrev_b32 v21, 4, v20
  v_and_b32 v22, 15, v20
  v_and_b32 v23, 1, v21
  v_lshrrev_b32 v24, 1, v21
  v_lshlrev_b32 v2, 4, v20
  s_lshl_b32 s36, s13, 10
  v_add_u32 v59, s36, v2
  s_lshl_b32 s37, s13, 15
  s_add_u32 s37, s37, 32768
  v_add_u32 v4, s37, v2
  v_lshrrev_b32 v25, 2, v20
  v_lshlrev_b32 v25, 13, v25
  v_and_b32 v1, 3, v20
  v_lshl_add_u32 v25, v1, 4, v25
  s_lshl_b32 s36, s13, 6
  s_lshl_b32 s38, s12, 8
  s_add_u32 s36, s36, s38
  v_add_u32 v25, s36, v25
  v_lshrrev_b32 v26, 3, v20
  v_lshlrev_b32 v26, 10, v26
  v_and_b32 v1, 7, v20
  v_lshl_add_u32 v26, v1, 4, v26
  s_lshl_b32 s36, s13, 7
  s_lshl_b32 s38, s12, 17
  s_add_u32 s36, s36, s38
  v_add_u32 v26, s36, v26
  v_bfe_u32 v29, v20, 2, 1
  v_bfe_u32 v30, v20, 3, 1
  v_and_b32 v31, 3, v20
  v_lshl_add_u32 v27, v21, 2, v29
  v_lshlrev_b32 v27, 6, v27
  v_lshl_add_u32 v27, v30, 5, v27
  v_lshl_add_u32 v27, v31, 3, v27
  v_add_u32 v27, s37, v27
  v_xor_b32 v36, 1, v30
  v_lshl_add_u32 v36, v36, 11, v27
  v_lshl_add_u32 v27, v30, 11, v27
  v_lshl_add_u32 v28, v23, 2, v24
  v_lshl_add_u32 v28, v28, 2, v29
  v_lshlrev_b32 v28, 7, v28
  v_lshl_add_u32 v28, v30, 6, v28
  v_lshl_add_u32 v28, v31, 4, v28
  v_add_u32 v28, s37, v28
  s_mov_b32 s39, s37
  s_xor_b32 s36, s13, 0
  s_lshl_b32 s36, s36, 15
  s_add_u32 m0, s39, 0
  s_add_u32 s37, s36, 0
  buffer_load_dwordx4 v26, s[48:51], s37 offen lds
  s_add_u32 m0, s39, 1024
  s_add_u32 s37, s36, 8192
  buffer_load_dwordx4 v26, s[48:51], s37 offen lds
  s_add_u32 m0, s39, 2048
  s_add_u32 s37, s36, 16384
  buffer_load_dwordx4 v26, s[48:51], s37 offen lds
  s_add_u32 m0, s39, 3072
  s_add_u32 s37, s36, 24576
  buffer_load_dwordx4 v26, s[48:51], s37 offen lds
  s_xor_b32 s36, s13, 0
  s_lshl_b32 s36, s36, 15
  s_add_u32 m0, s39, 4096
  s_add_u32 s37, s36, 512
  buffer_load_dwordx4 v26, s[48:51], s37 offen lds
  s_add_u32 m0, s39, 5120
  s_add_u32 s37, s36, 8704
  buffer_load_dwordx4 v26, s[48:51], s37 offen lds
  s_add_u32 m0, s39, 6144
  s_add_u32 s37, s36, 16896
  buffer_load_dwordx4 v26, s[48:51], s37 offen lds
  s_add_u32 m0, s39, 7168
  s_add_u32 s37, s36, 25088
  buffer_load_dwordx4 v26, s[48:51], s37 offen lds
  v_mov_b32 v0, 0x4444
  v_mov_b32 v1, 0xeeee
  v_cmp_lt_u32 vcc, 7, v22
  s_nop 1
  v_cndmask_b32 v32, v0, v1, vcc
  v_mov_b32 v0, v32
  v_and_b32 v32, 7, v20
  v_lshlrev_b32 v32, 4, v32
  v_lshl_add_u32 v11, v21, 7, v32
  v_xor_b32 v1, 128, v2
  v_lshl_add_u32 v33, v24, 4, v22
  s_lshl_b32 s36, s13, 5
  v_add_u32 v33, s36, v33
  v_lshlrev_b32 v33, 3, v33
  v_mul_u32_u24 v34, 1152, v23
  v_add_u32 v5, v33, v34
  v_bfe_u32 v33, v20, 2, 2
  v_lshl_add_u32 v33, v23, 2, v33
  v_lshl_add_u32 v33, v24, 4, v33
  v_lshlrev_b32 v33, 3, v33
  v_and_b32 v34, 1, v20
  v_mul_u32_u24 v34, 1152, v34
  v_add_u32 v6, v33, v34
  s_lshl_b32 s36, s13, 3
  v_lshrrev_b32 v33, 3, v20
  v_add_u32 v33, s36, v33
  v_mul_u32_u24 v34, 0, v33
  v_add_u32 v34, s12, v34
  v_and_b32 v34, 31, v34
  v_lshrrev_b32 v37, 1, v32
  v_lshl_add_u32 v33, v33, 13, v37
  v_lshl_add_u32 v7, v34, 7, v33
  v_and_b32 v37, 1, v20
  v_bfe_u32 v38, v20, 1, 1
  v_lshl_add_u32 v37, v29, 1, v37
  s_lshr_b32 s36, s12, 3
  s_lshl_b32 s36, s36, 10
  s_and_b32 s37, s12, 1
  s_lshl_b32 s37, s37, 9
  s_add_u32 s36, s36, s37
  s_and_b32 s37, s12, 6
  s_lshl_b32 s37, s37, 5
  s_add_u32 s36, s36, s37
  v_lshlrev_b32 v33, 4, v21
  v_lshl_add_u32 v33, v37, 2, v33
  v_lshl_add_u32 v33, v38, 8, v33
  v_lshl_add_u32 v33, v30, 30, v33
  v_add_u32 v8, s36, v33
  v_mov_b32 v3, v2
  v_mov_b32 v39, v21
  s_lshr_b32 s36, s12, 2
  s_lshl_b32 s36, s36, 6
  s_and_b32 s37, s12, 1
  s_lshl_b32 s37, s37, 5
  s_add_u32 s36, s36, s37
  s_and_b32 s37, s12, 2
  s_lshl_b32 s37, s37, 11
  s_add_u32 s36, s36, s37
  v_lshlrev_b32 v35, 10, v39
  v_lshl_add_u32 v35, v37, 2, v35
  v_lshl_add_u32 v35, v38, 4, v35
  v_add_u32 v35, s36, v35
  buffer_load_ushort v44, v35, s[76:79], 0 offen offset:0
  buffer_load_ushort v45, v35, s[76:79], 0 offen offset:2
  buffer_load_ushort v46, v35, s[76:79], 0 offen offset:512
  buffer_load_ushort v47, v35, s[76:79], 0 offen offset:514
  v_lshlrev_b32 v33, 4, v29
  v_mov_b32 v34, 0x3f80
  v_lshlrev_b32 v33, v33, v34
  v_and_b32 v34, 1, v20
  v_lshl_add_u32 v34, v34, 1, v30
  v_cmp_eq_u32 vcc, 0, v34
  s_nop 1
  v_cndmask_b32 v48, 0, v33, vcc
  v_cmp_eq_u32 vcc, 1, v34
  s_nop 1
  v_cndmask_b32 v49, 0, v33, vcc
  v_cmp_eq_u32 vcc, 2, v34
  s_nop 1
  v_cndmask_b32 v50, 0, v33, vcc
  v_cmp_eq_u32 vcc, 3, v34
  s_nop 1
  v_cndmask_b32 v51, 0, v33, vcc
  ds_write_b128 v2, v[48:51] offset:31232
  v_lshlrev_b32 v33, 9, v21
  s_lshl_b32 s36, s13, 11
  v_add_u32 v33, s36, v33
  v_lshl_add_u32 v10, v22, 4, v33
  v_lshl_add_u32 v33, v30, 8, v33
  v_add_u32 v9, v33, v32
  v_mov_b32 v12, 0x3f803f80
  v_mov_b32 v13, 0x3f803f80
  v_mov_b32 v14, 0x3f803f80
  v_mov_b32 v15, 0x3f803f80
  s_mov_b32 s2, 0x3f803f80
  s_mov_b32 s3, 0x3f803f80
  s_mov_b32 s98, 0
  v_and_b32 v33, 1, v20
  v_mul_u32_u24 v33, 128, v33
  v_min_u32 v34, 1, v20
  v_lshlrev_b32 v34, 30, v34
  s_cmp_eq_u32 s13, 3
  s_cselect_b64 vcc, -1, 0
  v_cndmask_b32 v19, v34, v33, vcc
  v_mov_b64 v[60:61], 0
  v_mov_b32 v62, 32256
  ds_write_b64 v62, v[60:61]
  s_mov_b32 s16, 0
  s_mov_b32 s17, -1
  s_mov_b32 s18, 0x3e0293ee
  s_mov_b32 s54, 0x2f800000
  s_mov_b32 s55, 0x28000000
  s_lshl_b32 s36, s13, 10
  s_add_u32 s31, s36, 8192
  s_add_u32 s32, s36, 12160
  s_add_u32 s33, s36, 16384
  s_add_u32 s34, s36, 20224
  s_lshl_b32 s36, s12, 19
  s_add_u32 s27, s36, 67108864
  s_add_u32 s28, s36, 83886080
  s_mul_i32 s36, s12, 4096
  s_add_u32 s29, s36, 135266304
  s_lshl_b32 s36, s12, 13
  s_add_u32 s22, s36, 144703488
  s_add_u32 s23, s36, 144707584
  s_mov_b32 s20, 144703488
  s_mov_b32 s21, 144707584
  v_mov_b32 v40, -1
  v_mov_b32 v41, -1
  v_mov_b32 v42, -1
  v_mov_b32 v43, -1
  s_lshl_b32 s36, s13, 13
  s_add_u32 s36, s36, 145752064
  s_add_u32 s37, s36, 4096
  buffer_store_dwordx4 v[40:43], v59, s[4:7], s22 offen sc1
  buffer_store_dwordx4 v[40:43], v59, s[4:7], s23 offen sc1
  buffer_store_dword v40, v8, s[4:7], s36 offen sc1
  buffer_store_dword v40, v8, s[4:7], s37 offen sc1
  v_mov_b32 v52, 0
  v_min_u32 v53, 1, v59
  v_lshlrev_b32 v53, 30, v53
  buffer_store_dword v52, v53, s[4:7], s15 offen sc1
  s_xor_b32 s36, s13, 1
  s_lshl_b32 s36, s36, 15
  s_add_u32 m0, s39, 8192
  s_add_u32 s37, s36, 0
  buffer_load_dwordx4 v26, s[48:51], s37 offen lds
  s_add_u32 m0, s39, 9216
  s_add_u32 s37, s36, 8192
  buffer_load_dwordx4 v26, s[48:51], s37 offen lds
  s_add_u32 m0, s39, 10240
  s_add_u32 s37, s36, 16384
  buffer_load_dwordx4 v26, s[48:51], s37 offen lds
  s_add_u32 m0, s39, 11264
  s_add_u32 s37, s36, 24576
  buffer_load_dwordx4 v26, s[48:51], s37 offen lds
  s_xor_b32 s36, s13, 1
  s_lshl_b32 s36, s36, 15
  s_add_u32 m0, s39, 12288
  s_add_u32 s37, s36, 512
  buffer_load_dwordx4 v26, s[48:51], s37 offen lds
  s_add_u32 m0, s39, 13312
  s_add_u32 s37, s36, 8704
  buffer_load_dwordx4 v26, s[48:51], s37 offen lds
  s_add_u32 m0, s39, 14336
  s_add_u32 s37, s36, 16896
  buffer_load_dwordx4 v26, s[48:51], s37 offen lds
  s_add_u32 m0, s39, 15360
  s_add_u32 s37, s36, 25088
  buffer_load_dwordx4 v26, s[48:51], s37 offen lds
  s_waitcnt vmcnt(21)
  ds_read_b64_tr_b16 a[160:161], v28 offset:0
  ds_read_b64_tr_b16 a[162:163], v28 offset:256
  ds_read_b64_tr_b16 a[164:165], v28 offset:1024
  ds_read_b64_tr_b16 a[166:167], v28 offset:1280
  ds_read_b64_tr_b16 a[168:169], v28 offset:8
  ds_read_b64_tr_b16 a[170:171], v28 offset:264
  ds_read_b64_tr_b16 a[172:173], v28 offset:1032
  ds_read_b64_tr_b16 a[174:175], v28 offset:1288
  s_waitcnt lgkmcnt(0)
  s_xor_b32 s36, s13, 2
  s_lshl_b32 s36, s36, 15
  s_add_u32 m0, s39, 0
  s_add_u32 s37, s36, 0
  buffer_load_dwordx4 v26, s[48:51], s37 offen lds
  s_add_u32 m0, s39, 1024
  s_add_u32 s37, s36, 8192
  buffer_load_dwordx4 v26, s[48:51], s37 offen lds
  s_add_u32 m0, s39, 2048
  s_add_u32 s37, s36, 16384
  buffer_load_dwordx4 v26, s[48:51], s37 offen lds
  s_add_u32 m0, s39, 3072
  s_add_u32 s37, s36, 24576
  buffer_load_dwordx4 v26, s[48:51], s37 offen lds
  s_waitcnt vmcnt(21)
  ds_read_b64_tr_b16 a[176:177], v28 offset:4096
  ds_read_b64_tr_b16 a[178:179], v28 offset:4352
  ds_read_b64_tr_b16 a[180:181], v28 offset:5120
  ds_read_b64_tr_b16 a[182:183], v28 offset:5376
  ds_read_b64_tr_b16 a[184:185], v28 offset:4104
  ds_read_b64_tr_b16 a[186:187], v28 offset:4360
  ds_read_b64_tr_b16 a[188:189], v28 offset:5128
  ds_read_b64_tr_b16 a[190:191], v28 offset:5384
  s_waitcnt lgkmcnt(0)
  s_xor_b32 s36, s13, 3
  s_lshl_b32 s36, s36, 15
  s_add_u32 m0, s39, 4096
  s_add_u32 s37, s36, 0
  buffer_load_dwordx4 v26, s[48:51], s37 offen lds
  s_add_u32 m0, s39, 5120
  s_add_u32 s37, s36, 8192
  buffer_load_dwordx4 v26, s[48:51], s37 offen lds
  s_add_u32 m0, s39, 6144
  s_add_u32 s37, s36, 16384
  buffer_load_dwordx4 v26, s[48:51], s37 offen lds
  s_add_u32 m0, s39, 7168
  s_add_u32 s37, s36, 24576
  buffer_load_dwordx4 v26, s[48:51], s37 offen lds
  s_waitcnt vmcnt(12)
  ds_read_b64_tr_b16 a[192:193], v28 offset:8192
  ds_read_b64_tr_b16 a[194:195], v28 offset:8448
  ds_read_b64_tr_b16 a[196:197], v28 offset:9216
  ds_read_b64_tr_b16 a[198:199], v28 offset:9472
  ds_read_b64_tr_b16 a[200:201], v28 offset:8200
  ds_read_b64_tr_b16 a[202:203], v28 offset:8456
  ds_read_b64_tr_b16 a[204:205], v28 offset:9224
  ds_read_b64_tr_b16 a[206:207], v28 offset:9480
  s_waitcnt lgkmcnt(0)
  s_xor_b32 s36, s13, 2
  s_lshl_b32 s36, s36, 19
  s_add_u32 m0, s39, 8192
  s_add_u32 s37, s36, 0
  buffer_load_dwordx4 v25, s[8:11], s37 offen lds
  s_add_u32 m0, s39, 9216
  s_add_u32 s37, s36, 131072
  buffer_load_dwordx4 v25, s[8:11], s37 offen lds
  s_add_u32 m0, s39, 10240
  s_add_u32 s37, s36, 262144
  buffer_load_dwordx4 v25, s[8:11], s37 offen lds
  s_add_u32 m0, s39, 11264
  s_add_u32 s37, s36, 393216
  buffer_load_dwordx4 v25, s[8:11], s37 offen lds
  s_barrier
  s_cmp_lg_u32 s13, 0
  s_cbranch_scc1 T_arm_72
  s_getreg_b32 s36, hwreg(HW_REG_XCC_ID, 0, 3)
  s_lshl_b32 s36, s36, 3
  s_lshl_b64 s[60:61], 1, s36
  s_mov_b32 s62, 1
  s_atomic_add_x2 s[60:61], s[52:53], 0
  s_atomic_add s62, s[52:53], 128
  v_lshl_or_b32 v44, v45, 16, v44
  v_lshl_or_b32 v46, v47, 16, v46
  v_min_u32 v44, -2, v44
  v_min_u32 v46, -2, v46
  s_mov_b32 s36, 145752064
  s_mov_b32 s37, 145756160
  buffer_store_dword v44, v8, s[4:7], s36 offen sc1
  buffer_store_dword v46, v8, s[4:7], s37 offen sc1
T_arm_72:
  s_waitcnt vmcnt(12)
  ds_read_b64_tr_b16 a[208:209], v28 offset:12288
  ds_read_b64_tr_b16 a[210:211], v28 offset:12544
  ds_read_b64_tr_b16 a[212:213], v28 offset:13312
  ds_read_b64_tr_b16 a[214:215], v28 offset:13568
  ds_read_b64_tr_b16 a[216:217], v28 offset:12296
  ds_read_b64_tr_b16 a[218:219], v28 offset:12552
  ds_read_b64_tr_b16 a[220:221], v28 offset:13320
  ds_read_b64_tr_b16 a[222:223], v28 offset:13576
  s_waitcnt lgkmcnt(0)
  s_xor_b32 s36, s13, 3
  s_lshl_b32 s36, s36, 19
  s_add_u32 m0, s39, 12288
  s_add_u32 s37, s36, 0
  buffer_load_dwordx4 v25, s[8:11], s37 offen lds
  s_add_u32 m0, s39, 13312
  s_add_u32 s37, s36, 131072
  buffer_load_dwordx4 v25, s[8:11], s37 offen lds
  s_add_u32 m0, s39, 14336
  s_add_u32 s37, s36, 262144
  buffer_load_dwordx4 v25, s[8:11], s37 offen lds
  s_add_u32 m0, s39, 15360
  s_add_u32 s37, s36, 393216
  buffer_load_dwordx4 v25, s[8:11], s37 offen lds
  s_waitcnt vmcnt(12)
  ds_read_b64_tr_b16 a[224:225], v28 offset:0
  ds_read_b64_tr_b16 a[226:227], v28 offset:256
  ds_read_b64_tr_b16 a[228:229], v28 offset:1024
  ds_read_b64_tr_b16 a[230:231], v28 offset:1280
  ds_read_b64_tr_b16 a[232:233], v28 offset:8
  ds_read_b64_tr_b16 a[234:235], v28 offset:264
  ds_read_b64_tr_b16 a[236:237], v28 offset:1032
  ds_read_b64_tr_b16 a[238:239], v28 offset:1288
  s_waitcnt lgkmcnt(0)
  s_xor_b32 s36, s13, 4
  s_lshl_b32 s36, s36, 19
  s_add_u32 m0, s39, 0
  s_add_u32 s37, s36, 0
  buffer_load_dwordx4 v25, s[8:11], s37 offen lds
  s_add_u32 m0, s39, 1024
  s_add_u32 s37, s36, 131072
  buffer_load_dwordx4 v25, s[8:11], s37 offen lds
  s_add_u32 m0, s39, 2048
  s_add_u32 s37, s36, 262144
  buffer_load_dwordx4 v25, s[8:11], s37 offen lds
  s_add_u32 m0, s39, 3072
  s_add_u32 s37, s36, 393216
  buffer_load_dwordx4 v25, s[8:11], s37 offen lds
  s_waitcnt vmcnt(12)
  ds_read_b64_tr_b16 a[240:241], v28 offset:4096
  ds_read_b64_tr_b16 a[242:243], v28 offset:4352
  ds_read_b64_tr_b16 a[244:245], v28 offset:5120
  ds_read_b64_tr_b16 a[246:247], v28 offset:5376
  ds_read_b64_tr_b16 a[248:249], v28 offset:4104
  ds_read_b64_tr_b16 a[250:251], v28 offset:4360
  ds_read_b64_tr_b16 a[252:253], v28 offset:5128
  ds_read_b64_tr_b16 a[254:255], v28 offset:5384
  s_waitcnt lgkmcnt(0)
  s_xor_b32 s36, s13, 5
  s_lshl_b32 s36, s36, 19
  s_add_u32 m0, s39, 4096
  s_add_u32 s37, s36, 0
  buffer_load_dwordx4 v25, s[8:11], s37 offen lds
  s_add_u32 m0, s39, 5120
  s_add_u32 s37, s36, 131072
  buffer_load_dwordx4 v25, s[8:11], s37 offen lds
  s_add_u32 m0, s39, 6144
  s_add_u32 s37, s36, 262144
  buffer_load_dwordx4 v25, s[8:11], s37 offen lds
  s_add_u32 m0, s39, 7168
  s_add_u32 s37, s36, 393216
  buffer_load_dwordx4 v25, s[8:11], s37 offen lds
  s_waitcnt vmcnt(12)
  ds_read_b64_tr_b16 v[160:161], v27 offset:8192
  ds_read_b64_tr_b16 v[162:163], v27 offset:8320
  ds_read_b64_tr_b16 v[164:165], v27 offset:9216
  ds_read_b64_tr_b16 v[166:167], v27 offset:9344
  ds_read_b64_tr_b16 v[168:169], v36 offset:8192
  ds_read_b64_tr_b16 v[170:171], v36 offset:8320
  ds_read_b64_tr_b16 v[172:173], v36 offset:9216
  ds_read_b64_tr_b16 v[174:175], v36 offset:9344
  s_waitcnt lgkmcnt(0)
  s_xor_b32 s36, s13, 4
  s_lshl_b32 s36, s36, 19
  s_add_u32 m0, s39, 8192
  s_add_u32 s37, s36, 0
  buffer_load_dwordx4 v25, s[40:43], s37 offen lds
  s_add_u32 m0, s39, 9216
  s_add_u32 s37, s36, 131072
  buffer_load_dwordx4 v25, s[40:43], s37 offen lds
  s_add_u32 m0, s39, 10240
  s_add_u32 s37, s36, 262144
  buffer_load_dwordx4 v25, s[40:43], s37 offen lds
  s_add_u32 m0, s39, 11264
  s_add_u32 s37, s36, 393216
  buffer_load_dwordx4 v25, s[40:43], s37 offen lds
  s_waitcnt vmcnt(12)
  ds_read_b64_tr_b16 v[192:193], v27 offset:12288
  ds_read_b64_tr_b16 v[194:195], v27 offset:12416
  ds_read_b64_tr_b16 v[196:197], v27 offset:13312
  ds_read_b64_tr_b16 v[198:199], v27 offset:13440
  ds_read_b64_tr_b16 v[200:201], v36 offset:12288
  ds_read_b64_tr_b16 v[202:203], v36 offset:12416
  ds_read_b64_tr_b16 v[204:205], v36 offset:13312
  ds_read_b64_tr_b16 v[206:207], v36 offset:13440
  s_waitcnt lgkmcnt(0)
  s_xor_b32 s36, s13, 5
  s_lshl_b32 s36, s36, 19
  s_add_u32 m0, s39, 12288
  s_add_u32 s37, s36, 0
  buffer_load_dwordx4 v25, s[40:43], s37 offen lds
  s_add_u32 m0, s39, 13312
  s_add_u32 s37, s36, 131072
  buffer_load_dwordx4 v25, s[40:43], s37 offen lds
  s_add_u32 m0, s39, 14336
  s_add_u32 s37, s36, 262144
  buffer_load_dwordx4 v25, s[40:43], s37 offen lds
  s_add_u32 m0, s39, 15360
  s_add_u32 s37, s36, 393216
  buffer_load_dwordx4 v25, s[40:43], s37 offen lds
  s_waitcnt vmcnt(12)
  ds_read_b64_tr_b16 v[224:225], v27 offset:0
  ds_read_b64_tr_b16 v[226:227], v27 offset:128
  ds_read_b64_tr_b16 v[228:229], v27 offset:1024
  ds_read_b64_tr_b16 v[230:231], v27 offset:1152
  ds_read_b64_tr_b16 v[232:233], v36 offset:0
  ds_read_b64_tr_b16 v[234:235], v36 offset:128
  ds_read_b64_tr_b16 v[236:237], v36 offset:1024
  ds_read_b64_tr_b16 v[238:239], v36 offset:1152
  s_waitcnt lgkmcnt(0)
  s_xor_b32 s36, s13, 4
  s_lshl_b32 s36, s36, 19
  s_add_u32 m0, s39, 0
  s_add_u32 s37, s36, 0
  buffer_load_dwordx4 v25, s[44:47], s37 offen lds
  s_add_u32 m0, s39, 1024
  s_add_u32 s37, s36, 131072
  buffer_load_dwordx4 v25, s[44:47], s37 offen lds
  s_add_u32 m0, s39, 2048
  s_add_u32 s37, s36, 262144
  buffer_load_dwordx4 v25, s[44:47], s37 offen lds
  s_add_u32 m0, s39, 3072
  s_add_u32 s37, s36, 393216
  buffer_load_dwordx4 v25, s[44:47], s37 offen lds
  s_waitcnt vmcnt(12)
  ds_read_b64_tr_b16 a[16:17], v27 offset:4096
  ds_read_b64_tr_b16 a[18:19], v27 offset:4224
  ds_read_b64_tr_b16 a[20:21], v27 offset:5120
  ds_read_b64_tr_b16 a[22:23], v27 offset:5248
  ds_read_b64_tr_b16 a[24:25], v36 offset:4096
  ds_read_b64_tr_b16 a[26:27], v36 offset:4224
  ds_read_b64_tr_b16 a[28:29], v36 offset:5120
  ds_read_b64_tr_b16 a[30:31], v36 offset:5248
  s_waitcnt lgkmcnt(0)
  s_xor_b32 s36, s13, 5
  s_lshl_b32 s36, s36, 19
  s_add_u32 m0, s39, 4096
  s_add_u32 s37, s36, 0
  buffer_load_dwordx4 v25, s[44:47], s37 offen lds
  s_add_u32 m0, s39, 5120
  s_add_u32 s37, s36, 131072
  buffer_load_dwordx4 v25, s[44:47], s37 offen lds
  s_add_u32 m0, s39, 6144
  s_add_u32 s37, s36, 262144
  buffer_load_dwordx4 v25, s[44:47], s37 offen lds
  s_add_u32 m0, s39, 7168
  s_add_u32 s37, s36, 393216
  buffer_load_dwordx4 v25, s[44:47], s37 offen lds
  s_waitcnt vmcnt(12)
  ds_read_b64_tr_b16 v[240:241], v27 offset:8192
  ds_read_b64_tr_b16 v[242:243], v27 offset:8320
  ds_read_b64_tr_b16 v[244:245], v27 offset:9216
  ds_read_b64_tr_b16 v[246:247], v27 offset:9344
  ds_read_b64_tr_b16 v[248:249], v36 offset:8192
  ds_read_b64_tr_b16 v[250:251], v36 offset:8320
  ds_read_b64_tr_b16 v[252:253], v36 offset:9216
  ds_read_b64_tr_b16 v[254:255], v36 offset:9344
  s_waitcnt lgkmcnt(0)
  s_xor_b32 s36, s13, 6
  s_lshl_b32 s36, s36, 19
  s_add_u32 m0, s39, 8192
  s_add_u32 s37, s36, 0
  buffer_load_dwordx4 v25, s[8:11], s37 offen lds
  s_add_u32 m0, s39, 9216
  s_add_u32 s37, s36, 131072
  buffer_load_dwordx4 v25, s[8:11], s37 offen lds
  s_add_u32 m0, s39, 10240
  s_add_u32 s37, s36, 262144
  buffer_load_dwordx4 v25, s[8:11], s37 offen lds
  s_add_u32 m0, s39, 11264
  s_add_u32 s37, s36, 393216
  buffer_load_dwordx4 v25, s[8:11], s37 offen lds
  s_waitcnt vmcnt(12)
  ds_read_b64_tr_b16 a[32:33], v27 offset:12288
  ds_read_b64_tr_b16 a[34:35], v27 offset:12416
  ds_read_b64_tr_b16 a[36:37], v27 offset:13312
  ds_read_b64_tr_b16 a[38:39], v27 offset:13440
  ds_read_b64_tr_b16 a[40:41], v36 offset:12288
  ds_read_b64_tr_b16 a[42:43], v36 offset:12416
  ds_read_b64_tr_b16 a[44:45], v36 offset:13312
  ds_read_b64_tr_b16 a[46:47], v36 offset:13440
  s_waitcnt lgkmcnt(0)
  s_xor_b32 s36, s13, 7
  s_lshl_b32 s36, s36, 19
  s_add_u32 m0, s39, 12288
  s_add_u32 s37, s36, 0
  buffer_load_dwordx4 v25, s[8:11], s37 offen lds
  s_add_u32 m0, s39, 13312
  s_add_u32 s37, s36, 131072
  buffer_load_dwordx4 v25, s[8:11], s37 offen lds
  s_add_u32 m0, s39, 14336
  s_add_u32 s37, s36, 262144
  buffer_load_dwordx4 v25, s[8:11], s37 offen lds
  s_add_u32 m0, s39, 15360
  s_add_u32 s37, s36, 393216
  buffer_load_dwordx4 v25, s[8:11], s37 offen lds
  s_waitcnt vmcnt(12)
  ds_read_b64_tr_b16 a[0:1], v27 offset:0
  ds_read_b64_tr_b16 a[2:3], v27 offset:128
  ds_read_b64_tr_b16 a[4:5], v27 offset:1024
  ds_read_b64_tr_b16 a[6:7], v27 offset:1152
  ds_read_b64_tr_b16 a[8:9], v36 offset:0
  ds_read_b64_tr_b16 a[10:11], v36 offset:128
  ds_read_b64_tr_b16 a[12:13], v36 offset:1024
  ds_read_b64_tr_b16 a[14:15], v36 offset:1152
  s_waitcnt lgkmcnt(0)
  s_xor_b32 s36, s13, 6
  s_lshl_b32 s36, s36, 19
  s_add_u32 m0, s39, 0
  s_add_u32 s37, s36, 0
  buffer_load_dwordx4 v25, s[40:43], s37 offen lds
  s_add_u32 m0, s39, 1024
  s_add_u32 s37, s36, 131072
  buffer_load_dwordx4 v25, s[40:43], s37 offen lds
  s_add_u32 m0, s39, 2048
  s_add_u32 s37, s36, 262144
  buffer_load_dwordx4 v25, s[40:43], s37 offen lds
  s_add_u32 m0, s39, 3072
  s_add_u32 s37, s36, 393216
  buffer_load_dwordx4 v25, s[40:43], s37 offen lds
  s_waitcnt vmcnt(12)
  ds_read_b64_tr_b16 a[48:49], v27 offset:4096
  ds_read_b64_tr_b16 a[50:51], v27 offset:4224
  ds_read_b64_tr_b16 a[52:53], v27 offset:5120
  ds_read_b64_tr_b16 a[54:55], v27 offset:5248
  ds_read_b64_tr_b16 a[56:57], v36 offset:4096
  ds_read_b64_tr_b16 a[58:59], v36 offset:4224
  ds_read_b64_tr_b16 a[60:61], v36 offset:5120
  ds_read_b64_tr_b16 a[62:63], v36 offset:5248
  s_waitcnt lgkmcnt(0)
  s_xor_b32 s36, s13, 7
  s_lshl_b32 s36, s36, 19
  s_add_u32 m0, s39, 4096
  s_add_u32 s37, s36, 0
  buffer_load_dwordx4 v25, s[40:43], s37 offen lds
  s_add_u32 m0, s39, 5120
  s_add_u32 s37, s36, 131072
  buffer_load_dwordx4 v25, s[40:43], s37 offen lds
  s_add_u32 m0, s39, 6144
  s_add_u32 s37, s36, 262144
  buffer_load_dwordx4 v25, s[40:43], s37 offen lds
  s_add_u32 m0, s39, 7168
  s_add_u32 s37, s36, 393216
  buffer_load_dwordx4 v25, s[40:43], s37 offen lds
  s_waitcnt vmcnt(12)
  ds_read_b64_tr_b16 a[64:65], v27 offset:8192
  ds_read_b64_tr_b16 a[66:67], v27 offset:8320
  ds_read_b64_tr_b16 a[68:69], v27 offset:9216
  ds_read_b64_tr_b16 a[70:71], v27 offset:9344
  ds_read_b64_tr_b16 a[72:73], v36 offset:8192
  ds_read_b64_tr_b16 a[74:75], v36 offset:8320
  ds_read_b64_tr_b16 a[76:77], v36 offset:9216
  ds_read_b64_tr_b16 a[78:79], v36 offset:9344
  s_waitcnt lgkmcnt(0)
  s_xor_b32 s36, s13, 6
  s_lshl_b32 s36, s36, 19
  s_add_u32 m0, s39, 8192
  s_add_u32 s37, s36, 0
  buffer_load_dwordx4 v25, s[44:47], s37 offen lds
  s_add_u32 m0, s39, 9216
  s_add_u32 s37, s36, 131072
  buffer_load_dwordx4 v25, s[44:47], s37 offen lds
  s_add_u32 m0, s39, 10240
  s_add_u32 s37, s36, 262144
  buffer_load_dwordx4 v25, s[44:47], s37 offen lds
  s_add_u32 m0, s39, 11264
  s_add_u32 s37, s36, 393216
  buffer_load_dwordx4 v25, s[44:47], s37 offen lds
  s_waitcnt vmcnt(12)
  ds_read_b64_tr_b16 a[112:113], v27 offset:12288
  ds_read_b64_tr_b16 a[114:115], v27 offset:12416
  ds_read_b64_tr_b16 a[116:117], v27 offset:13312
  ds_read_b64_tr_b16 a[118:119], v27 offset:13440
  ds_read_b64_tr_b16 a[120:121], v36 offset:12288
  ds_read_b64_tr_b16 a[122:123], v36 offset:12416
  ds_read_b64_tr_b16 a[124:125], v36 offset:13312
  ds_read_b64_tr_b16 a[126:127], v36 offset:13440
  s_waitcnt lgkmcnt(0)
  s_xor_b32 s36, s13, 7
  s_lshl_b32 s36, s36, 19
  s_add_u32 m0, s39, 12288
  s_add_u32 s37, s36, 0
  buffer_load_dwordx4 v25, s[44:47], s37 offen lds
  s_add_u32 m0, s39, 13312
  s_add_u32 s37, s36, 131072
  buffer_load_dwordx4 v25, s[44:47], s37 offen lds
  s_add_u32 m0, s39, 14336
  s_add_u32 s37, s36, 262144
  buffer_load_dwordx4 v25, s[44:47], s37 offen lds
  s_add_u32 m0, s39, 15360
  s_add_u32 s37, s36, 393216
  buffer_load_dwordx4 v25, s[44:47], s37 offen lds
  s_waitcnt vmcnt(12)
  ds_read_b64_tr_b16 a[80:81], v27 offset:0
  ds_read_b64_tr_b16 a[82:83], v27 offset:128
  ds_read_b64_tr_b16 a[84:85], v27 offset:1024
  ds_read_b64_tr_b16 a[86:87], v27 offset:1152
  ds_read_b64_tr_b16 a[88:89], v36 offset:0
  ds_read_b64_tr_b16 a[90:91], v36 offset:128
  ds_read_b64_tr_b16 a[92:93], v36 offset:1024
  ds_read_b64_tr_b16 a[94:95], v36 offset:1152
  s_waitcnt lgkmcnt(0)
  s_xor_b32 s36, s13, 1
  s_lshl_b32 s36, s36, 19
  s_add_u32 m0, s39, 16384
  s_add_u32 s37, s36, 0
  buffer_load_dwordx4 v25, s[8:11], s37 offen lds
  s_add_u32 m0, s39, 17408
  s_add_u32 s37, s36, 131072
  buffer_load_dwordx4 v25, s[8:11], s37 offen lds
  s_add_u32 m0, s39, 18432
  s_add_u32 s37, s36, 262144
  buffer_load_dwordx4 v25, s[8:11], s37 offen lds
  s_add_u32 m0, s39, 19456
  s_add_u32 s37, s36, 393216
  buffer_load_dwordx4 v25, s[8:11], s37 offen lds
  s_waitcnt vmcnt(12)
  ds_read_b64_tr_b16 a[128:129], v27 offset:4096
  ds_read_b64_tr_b16 a[130:131], v27 offset:4224
  ds_read_b64_tr_b16 a[132:133], v27 offset:5120
  ds_read_b64_tr_b16 a[134:135], v27 offset:5248
  ds_read_b64_tr_b16 a[136:137], v36 offset:4096
  ds_read_b64_tr_b16 a[138:139], v36 offset:4224
  ds_read_b64_tr_b16 a[140:141], v36 offset:5120
  ds_read_b64_tr_b16 a[142:143], v36 offset:5248
  s_waitcnt lgkmcnt(0)
  s_xor_b32 s36, s13, 0
  s_lshl_b32 s36, s36, 19
  s_add_u32 m0, s39, 0
  s_add_u32 s37, s36, 0
  buffer_load_dwordx4 v25, s[8:11], s37 offen lds
  s_add_u32 m0, s39, 1024
  s_add_u32 s37, s36, 131072
  buffer_load_dwordx4 v25, s[8:11], s37 offen lds
  s_add_u32 m0, s39, 2048
  s_add_u32 s37, s36, 262144
  buffer_load_dwordx4 v25, s[8:11], s37 offen lds
  s_add_u32 m0, s39, 3072
  s_add_u32 s37, s36, 393216
  buffer_load_dwordx4 v25, s[8:11], s37 offen lds
  s_waitcnt vmcnt(12)
  ds_read_b64_tr_b16 a[96:97], v27 offset:8192
  ds_read_b64_tr_b16 a[98:99], v27 offset:8320
  ds_read_b64_tr_b16 a[100:101], v27 offset:9216
  ds_read_b64_tr_b16 a[102:103], v27 offset:9344
  ds_read_b64_tr_b16 a[104:105], v36 offset:8192
  ds_read_b64_tr_b16 a[106:107], v36 offset:8320
  ds_read_b64_tr_b16 a[108:109], v36 offset:9216
  ds_read_b64_tr_b16 a[110:111], v36 offset:9344
  s_waitcnt lgkmcnt(0)
  s_xor_b32 s36, s13, 1
  s_lshl_b32 s36, s36, 19
  s_add_u32 m0, s39, 8192
  s_add_u32 s37, s36, 0
  buffer_load_dwordx4 v25, s[40:43], s37 offen lds
  s_add_u32 m0, s39, 9216
  s_add_u32 s37, s36, 131072
  buffer_load_dwordx4 v25, s[40:43], s37 offen lds
  s_add_u32 m0, s39, 10240
  s_add_u32 s37, s36, 262144
  buffer_load_dwordx4 v25, s[40:43], s37 offen lds
  s_add_u32 m0, s39, 11264
  s_add_u32 s37, s36, 393216
  buffer_load_dwordx4 v25, s[40:43], s37 offen lds
  s_waitcnt vmcnt(12)
  ds_read_b64_tr_b16 a[144:145], v27 offset:12288
  ds_read_b64_tr_b16 a[146:147], v27 offset:12416
  ds_read_b64_tr_b16 a[148:149], v27 offset:13312
  ds_read_b64_tr_b16 a[150:151], v27 offset:13440
  ds_read_b64_tr_b16 a[152:153], v36 offset:12288
  ds_read_b64_tr_b16 a[154:155], v36 offset:12416
  ds_read_b64_tr_b16 a[156:157], v36 offset:13312
  ds_read_b64_tr_b16 a[158:159], v36 offset:13440
  s_waitcnt lgkmcnt(0)
  s_xor_b32 s36, s13, 0
  s_lshl_b32 s36, s36, 19
  s_add_u32 m0, s39, 4096
  s_add_u32 s37, s36, 0
  buffer_load_dwordx4 v25, s[40:43], s37 offen lds
  s_add_u32 m0, s39, 5120
  s_add_u32 s37, s36, 131072
  buffer_load_dwordx4 v25, s[40:43], s37 offen lds
  s_add_u32 m0, s39, 6144
  s_add_u32 s37, s36, 262144
  buffer_load_dwordx4 v25, s[40:43], s37 offen lds
  s_add_u32 m0, s39, 7168
  s_add_u32 s37, s36, 393216
  buffer_load_dwordx4 v25, s[40:43], s37 offen lds
  s_waitcnt vmcnt(12)
  ds_read_b64_tr_b16 v[128:129], v27 offset:16384
  ds_read_b64_tr_b16 v[130:131], v27 offset:16512
  ds_read_b64_tr_b16 v[132:133], v27 offset:17408
  ds_read_b64_tr_b16 v[134:135], v27 offset:17536
  ds_read_b64_tr_b16 v[136:137], v36 offset:16384
  ds_read_b64_tr_b16 v[138:139], v36 offset:16512
  ds_read_b64_tr_b16 v[140:141], v36 offset:17408
  ds_read_b64_tr_b16 v[142:143], v36 offset:17536
  s_waitcnt lgkmcnt(0)
  s_xor_b32 s36, s13, 2
  s_lshl_b32 s36, s36, 19
  s_add_u32 m0, s39, 12288
  s_add_u32 s37, s36, 0
  buffer_load_dwordx4 v25, s[40:43], s37 offen lds
  s_add_u32 m0, s39, 13312
  s_add_u32 s37, s36, 131072
  buffer_load_dwordx4 v25, s[40:43], s37 offen lds
  s_add_u32 m0, s39, 14336
  s_add_u32 s37, s36, 262144
  buffer_load_dwordx4 v25, s[40:43], s37 offen lds
  s_add_u32 m0, s39, 15360
  s_add_u32 s37, s36, 393216
  buffer_load_dwordx4 v25, s[40:43], s37 offen lds
  s_waitcnt vmcnt(12)
  ds_read_b64_tr_b16 v[64:65], v27 offset:0
  ds_read_b64_tr_b16 v[66:67], v27 offset:128
  ds_read_b64_tr_b16 v[68:69], v27 offset:1024
  ds_read_b64_tr_b16 v[70:71], v27 offset:1152
  ds_read_b64_tr_b16 v[72:73], v36 offset:0
  ds_read_b64_tr_b16 v[74:75], v36 offset:128
  ds_read_b64_tr_b16 v[76:77], v36 offset:1024
  ds_read_b64_tr_b16 v[78:79], v36 offset:1152
  s_waitcnt lgkmcnt(0)
  ds_write_b128 v4, v[64:67] offset:0
  ds_write_b128 v4, v[68:71] offset:1024
  ds_write_b128 v4, v[72:75] offset:2048
  ds_write_b128 v4, v[76:79] offset:3072
  s_waitcnt lgkmcnt(0)
  s_xor_b32 s36, s13, 3
  s_lshl_b32 s36, s36, 19
  s_add_u32 m0, s39, 16384
  s_add_u32 s37, s36, 0
  buffer_load_dwordx4 v25, s[40:43], s37 offen lds
  s_add_u32 m0, s39, 17408
  s_add_u32 s37, s36, 131072
  buffer_load_dwordx4 v25, s[40:43], s37 offen lds
  s_add_u32 m0, s39, 18432
  s_add_u32 s37, s36, 262144
  buffer_load_dwordx4 v25, s[40:43], s37 offen lds
  s_add_u32 m0, s39, 19456
  s_add_u32 s37, s36, 393216
  buffer_load_dwordx4 v25, s[40:43], s37 offen lds
  s_waitcnt vmcnt(12)
  ds_read_b64_tr_b16 v[144:145], v27 offset:8192
  ds_read_b64_tr_b16 v[146:147], v27 offset:8320
  ds_read_b64_tr_b16 v[148:149], v27 offset:9216
  ds_read_b64_tr_b16 v[150:151], v27 offset:9344
  ds_read_b64_tr_b16 v[152:153], v36 offset:8192
  ds_read_b64_tr_b16 v[154:155], v36 offset:8320
  ds_read_b64_tr_b16 v[156:157], v36 offset:9216
  ds_read_b64_tr_b16 v[158:159], v36 offset:9344
  s_waitcnt lgkmcnt(0)
  s_xor_b32 s36, s13, 3
  s_lshl_b32 s36, s36, 19
  s_add_u32 m0, s39, 24576
  s_add_u32 s37, s36, 0
  buffer_load_dwordx4 v25, s[44:47], s37 offen lds
  s_add_u32 m0, s39, 25600
  s_add_u32 s37, s36, 131072
  buffer_load_dwordx4 v25, s[44:47], s37 offen lds
  s_add_u32 m0, s39, 26624
  s_add_u32 s37, s36, 262144
  buffer_load_dwordx4 v25, s[44:47], s37 offen lds
  s_add_u32 m0, s39, 27648
  s_add_u32 s37, s36, 393216
  buffer_load_dwordx4 v25, s[44:47], s37 offen lds
  buffer_load_dwordx2 v[54:55], off, s[72:75], 0 sc1
  buffer_load_dword v56, off, s[72:75], 0 offset:128 sc1
  s_waitcnt vmcnt(14)
  ds_read_b64_tr_b16 v[64:65], v27 offset:4096
  ds_read_b64_tr_b16 v[66:67], v27 offset:4224
  ds_read_b64_tr_b16 v[68:69], v27 offset:5120
  ds_read_b64_tr_b16 v[70:71], v27 offset:5248
  ds_read_b64_tr_b16 v[72:73], v36 offset:4096
  ds_read_b64_tr_b16 v[74:75], v36 offset:4224
  ds_read_b64_tr_b16 v[76:77], v36 offset:5120
  ds_read_b64_tr_b16 v[78:79], v36 offset:5248
  s_waitcnt lgkmcnt(0)
  ds_write_b128 v4, v[64:67] offset:4096
  ds_write_b128 v4, v[68:71] offset:5120
  ds_write_b128 v4, v[72:75] offset:6144
  ds_write_b128 v4, v[76:79] offset:7168
  s_waitcnt lgkmcnt(0)
  s_xor_b32 s36, s13, 2
  s_lshl_b32 s36, s36, 19
  s_add_u32 m0, s39, 20480
  s_add_u32 s37, s36, 0
  buffer_load_dwordx4 v25, s[44:47], s37 offen lds
  s_add_u32 m0, s39, 21504
  s_add_u32 s37, s36, 131072
  buffer_load_dwordx4 v25, s[44:47], s37 offen lds
  s_add_u32 m0, s39, 22528
  s_add_u32 s37, s36, 262144
  buffer_load_dwordx4 v25, s[44:47], s37 offen lds
  s_add_u32 m0, s39, 23552
  s_add_u32 s37, s36, 393216
  buffer_load_dwordx4 v25, s[44:47], s37 offen lds
  s_waitcnt vmcnt(14)
  ds_read_b64_tr_b16 v[176:177], v27 offset:12288
  ds_read_b64_tr_b16 v[178:179], v27 offset:12416
  ds_read_b64_tr_b16 v[180:181], v27 offset:13312
  ds_read_b64_tr_b16 v[182:183], v27 offset:13440
  ds_read_b64_tr_b16 v[184:185], v36 offset:12288
  ds_read_b64_tr_b16 v[186:187], v36 offset:12416
  ds_read_b64_tr_b16 v[188:189], v36 offset:13312
  ds_read_b64_tr_b16 v[190:191], v36 offset:13440
  s_waitcnt lgkmcnt(0)
  s_xor_b32 s36, s13, 0
  s_lshl_b32 s36, s36, 19
  s_add_u32 m0, s39, 8192
  s_add_u32 s37, s36, 0
  buffer_load_dwordx4 v25, s[44:47], s37 offen lds
  s_add_u32 m0, s39, 9216
  s_add_u32 s37, s36, 131072
  buffer_load_dwordx4 v25, s[44:47], s37 offen lds
  s_add_u32 m0, s39, 10240
  s_add_u32 s37, s36, 262144
  buffer_load_dwordx4 v25, s[44:47], s37 offen lds
  s_add_u32 m0, s39, 11264
  s_add_u32 s37, s36, 393216
  buffer_load_dwordx4 v25, s[44:47], s37 offen lds
  s_waitcnt vmcnt(14)
  ds_read_b64_tr_b16 v[64:65], v27 offset:16384
  ds_read_b64_tr_b16 v[66:67], v27 offset:16512
  ds_read_b64_tr_b16 v[68:69], v27 offset:17408
  ds_read_b64_tr_b16 v[70:71], v27 offset:17536
  ds_read_b64_tr_b16 v[72:73], v36 offset:16384
  ds_read_b64_tr_b16 v[74:75], v36 offset:16512
  ds_read_b64_tr_b16 v[76:77], v36 offset:17408
  ds_read_b64_tr_b16 v[78:79], v36 offset:17536
  s_waitcnt lgkmcnt(0)
  ds_write_b128 v4, v[64:67] offset:16384
  ds_write_b128 v4, v[68:71] offset:17408
  ds_write_b128 v4, v[72:75] offset:18432
  ds_write_b128 v4, v[76:79] offset:19456
  s_waitcnt lgkmcnt(0)
  s_xor_b32 s36, s13, 1
  s_lshl_b32 s36, s36, 19
  s_add_u32 m0, s39, 12288
  s_add_u32 s37, s36, 0
  buffer_load_dwordx4 v25, s[44:47], s37 offen lds
  s_add_u32 m0, s39, 13312
  s_add_u32 s37, s36, 131072
  buffer_load_dwordx4 v25, s[44:47], s37 offen lds
  s_add_u32 m0, s39, 14336
  s_add_u32 s37, s36, 262144
  buffer_load_dwordx4 v25, s[44:47], s37 offen lds
  s_add_u32 m0, s39, 15360
  s_add_u32 s37, s36, 393216
  buffer_load_dwordx4 v25, s[44:47], s37 offen lds
  s_waitcnt vmcnt(14)
  ds_read_b64_tr_b16 v[208:209], v27 offset:24576
  ds_read_b64_tr_b16 v[210:211], v27 offset:24704
  ds_read_b64_tr_b16 v[212:213], v27 offset:25600
  ds_read_b64_tr_b16 v[214:215], v27 offset:25728
  ds_read_b64_tr_b16 v[216:217], v36 offset:24576
  ds_read_b64_tr_b16 v[218:219], v36 offset:24704
  ds_read_b64_tr_b16 v[220:221], v36 offset:25600
  ds_read_b64_tr_b16 v[222:223], v36 offset:25728
  s_waitcnt lgkmcnt(0)
  s_xor_b32 s36, s13, 2
  s_lshl_b32 s36, s36, 15
  s_add_u32 m0, s39, 24576
  s_add_u32 s37, s36, 512
  buffer_load_dwordx4 v26, s[48:51], s37 offen lds
  s_add_u32 m0, s39, 25600
  s_add_u32 s37, s36, 8704
  buffer_load_dwordx4 v26, s[48:51], s37 offen lds
  s_add_u32 m0, s39, 26624
  s_add_u32 s37, s36, 16896
  buffer_load_dwordx4 v26, s[48:51], s37 offen lds
  s_add_u32 m0, s39, 27648
  s_add_u32 s37, s36, 25088
  buffer_load_dwordx4 v26, s[48:51], s37 offen lds
  s_waitcnt vmcnt(12)
  ds_read_b64_tr_b16 v[64:65], v27 offset:20480
  ds_read_b64_tr_b16 v[66:67], v27 offset:20608
  ds_read_b64_tr_b16 v[68:69], v27 offset:21504
  ds_read_b64_tr_b16 v[70:71], v27 offset:21632
  ds_read_b64_tr_b16 v[72:73], v36 offset:20480
  ds_read_b64_tr_b16 v[74:75], v36 offset:20608
  ds_read_b64_tr_b16 v[76:77], v36 offset:21504
  ds_read_b64_tr_b16 v[78:79], v36 offset:21632
  s_waitcnt lgkmcnt(0)
  ds_write_b128 v4, v[64:67] offset:20480
  ds_write_b128 v4, v[68:71] offset:21504
  ds_write_b128 v4, v[72:75] offset:22528
  ds_write_b128 v4, v[76:79] offset:23552
  s_waitcnt lgkmcnt(0)
  s_xor_b32 s36, s13, 3
  s_lshl_b32 s36, s36, 15
  s_add_u32 m0, s39, 28672
  s_add_u32 s37, s36, 512
  buffer_load_dwordx4 v26, s[48:51], s37 offen lds
  s_add_u32 m0, s39, 29696
  s_add_u32 s37, s36, 8704
  buffer_load_dwordx4 v26, s[48:51], s37 offen lds
  s_add_u32 m0, s39, 30720
  s_add_u32 s37, s36, 16896
  buffer_load_dwordx4 v26, s[48:51], s37 offen lds
  s_add_u32 m0, s39, 31744
  s_add_u32 s37, s36, 25088
  buffer_load_dwordx4 v26, s[48:51], s37 offen lds
  s_mov_b32 s19, 0
  s_branch T_arrgo_74
T_arr_73:
  s_add_u32 s19, s19, 1
  s_cmp_gt_u32 s19, 32768
  s_cbranch_scc1 M_exit
  buffer_load_dwordx2 v[54:55], off, s[72:75], 0 sc1
  buffer_load_dword v56, off, s[72:75], 0 offset:128 sc1
  s_waitcnt vmcnt(0)
T_arrgo_74:
  v_sad_u8 v57, v54, 0, 0
  v_sad_u8 v57, v55, 0, v57
  v_or_b32 v58, v54, v55
  v_cmp_gt_u32 vcc, 32, v57
  s_cbranch_vccnz T_arr_73
  v_cmp_gt_u32 vcc, 0x100, v56
  s_cbranch_vccnz T_arr_73
  v_readfirstlane_b32 s36, v58
  s_nop 0
  s_and_b32 s36, s36, 0x20202020
  s_cselect_b32 s56, 0, 1
  s_mov_b32 s14, -1
  s_mov_b32 s30, -1
  s_mov_b32 s19, 0
  s_branch T_kvok_76
T_kv_75:
  s_sleep 4
  s_add_u32 s19, s19, 1
  s_cmp_gt_u32 s19, 32768
  s_cbranch_scc1 M_exit
T_kvok_76:
  s_add_u32 s39, s99, 128
  s_mov_b32 s38, 0
  s_mov_b32 s37, 0
  s_atomic_or s38, s[58:59], s99 glc
  s_atomic_or s37, s[58:59], s39 glc
  s_waitcnt lgkmcnt(0)
  s_add_u32 s37, s37, 30
  s_cmp_ge_u32 s38, 30
  s_cselect_b32 s38, s37, s38
  s_cmp_ge_u32 s38, 64
  s_cselect_b32 s38, 100, s38
  s_sub_u32 s38, s38, 1
  s_max_i32 s30, s30, s38
  s_cmp_ge_i32 s14, s30
  s_cbranch_scc1 T_kv_75
  s_mov_b32 m0, s31
  s_nop 0
  buffer_load_dwordx4 v9, s[4:7], s27 offen sc1 lds
  s_mov_b32 m0, s32
  s_nop 0
  buffer_load_dwordx4 v9, s[4:7], s27 offen offset:128 sc1 lds
  s_mov_b32 m0, s33
  s_nop 0
  buffer_load_dwordx4 v10, s[4:7], s28 offen sc1 lds
  s_mov_b32 m0, s34
  s_nop 0
  buffer_load_dwordx4 v10, s[4:7], s28 offen offset:256 sc1 lds
  s_add_u32 s27, s27, 8192
  s_add_u32 s28, s28, 8192
  s_lshl_b32 s36, s12, 10
  s_add_u32 s36, s36, 145752064
  buffer_load_dwordx4 v[40:43], v2, s[4:7], s36 offen sc1
  s_waitcnt vmcnt(17)
  ds_read_b64_tr_b16 v[64:65], v27 offset:8192
  ds_read_b64_tr_b16 v[66:67], v27 offset:8320
  ds_read_b64_tr_b16 v[68:69], v27 offset:9216
  ds_read_b64_tr_b16 v[70:71], v27 offset:9344
  ds_read_b64_tr_b16 v[72:73], v36 offset:8192
  ds_read_b64_tr_b16 v[74:75], v36 offset:8320
  ds_read_b64_tr_b16 v[76:77], v36 offset:9216
  ds_read_b64_tr_b16 v[78:79], v36 offset:9344
  s_waitcnt lgkmcnt(0)
  ds_write_b128 v4, v[64:67] offset:8192
  ds_write_b128 v4, v[68:71] offset:9216
  ds_write_b128 v4, v[72:75] offset:10240
  ds_write_b128 v4, v[76:79] offset:11264
  s_waitcnt lgkmcnt(0)
  s_waitcnt vmcnt(13)
  ds_read_b64_tr_b16 v[64:65], v27 offset:12288
  ds_read_b64_tr_b16 v[66:67], v27 offset:12416
  ds_read_b64_tr_b16 v[68:69], v27 offset:13312
  ds_read_b64_tr_b16 v[70:71], v27 offset:13440
  ds_read_b64_tr_b16 v[72:73], v36 offset:12288
  ds_read_b64_tr_b16 v[74:75], v36 offset:12416
  ds_read_b64_tr_b16 v[76:77], v36 offset:13312
  ds_read_b64_tr_b16 v[78:79], v36 offset:13440
  s_waitcnt lgkmcnt(0)
  ds_write_b128 v4, v[64:67] offset:12288
  ds_write_b128 v4, v[68:71] offset:13312
  ds_write_b128 v4, v[72:75] offset:14336
  ds_write_b128 v4, v[76:79] offset:15360
  s_waitcnt lgkmcnt(0)
  s_waitcnt vmcnt(9)
  ds_read_b64_tr_b16 v[64:65], v28 offset:24576
  ds_read_b64_tr_b16 v[66:67], v28 offset:24832
  ds_read_b64_tr_b16 v[68:69], v28 offset:25600
  ds_read_b64_tr_b16 v[70:71], v28 offset:25856
  ds_read_b64_tr_b16 v[72:73], v28 offset:24584
  ds_read_b64_tr_b16 v[74:75], v28 offset:24840
  ds_read_b64_tr_b16 v[76:77], v28 offset:25608
  ds_read_b64_tr_b16 v[78:79], v28 offset:25864
  s_waitcnt lgkmcnt(0)
  ds_write_b128 v4, v[64:67] offset:24576
  ds_write_b128 v4, v[68:71] offset:25600
  ds_write_b128 v4, v[72:75] offset:26624
  ds_write_b128 v4, v[76:79] offset:27648
  s_waitcnt lgkmcnt(0)
  s_waitcnt vmcnt(5)
  ds_read_b64_tr_b16 v[64:65], v28 offset:28672
  ds_read_b64_tr_b16 v[66:67], v28 offset:28928
  ds_read_b64_tr_b16 v[68:69], v28 offset:29696
  ds_read_b64_tr_b16 v[70:71], v28 offset:29952
  ds_read_b64_tr_b16 v[72:73], v28 offset:28680
  ds_read_b64_tr_b16 v[74:75], v28 offset:28936
  ds_read_b64_tr_b16 v[76:77], v28 offset:29704
  ds_read_b64_tr_b16 v[78:79], v28 offset:29960
  s_waitcnt lgkmcnt(0)
  ds_write_b128 v4, v[64:67] offset:28672
  ds_write_b128 v4, v[68:71] offset:29696
  ds_write_b128 v4, v[72:75] offset:30720
  ds_write_b128 v4, v[76:79] offset:31744
  s_waitcnt lgkmcnt(0)
  s_waitcnt vmcnt(0) lgkmcnt(0)
  s_barrier
  s_cmp_ge_u32 s13, 2
  s_cselect_b64 vcc, -1, 0
  v_cndmask_b32 v8, v8, v19, vcc
  ds_read_b128 v[68:71], v4 offset:0
  ds_read_b128 v[72:75], v4 offset:1024
  ds_read_b128 v[76:79], v4 offset:4096
  ds_read_b128 v[80:83], v4 offset:5120
  ds_read_b128 v[84:87], v4 offset:8192
  ds_read_b128 v[88:91], v4 offset:9216
  ds_read_b128 v[92:95], v4 offset:2048
  ds_read_b128 v[96:99], v4 offset:3072
  ds_read_b128 v[100:103], v4 offset:6144
  ds_read_b128 v[104:107], v4 offset:7168
  ds_read_b128 v[108:111], v4 offset:10240
  ds_read_b128 v[112:115], v4 offset:11264
  ds_read_b128 v[28:31], v59 offset:16384
  ds_read_b128 v[32:35], v59 offset:20480
  ds_read_b128 v[36:39], v2 offset:8192
  ds_read_b128 v[40:43], v2 offset:9216
  ds_read_b128 v[44:47], v2 offset:10240
  ds_read_b128 v[48:51], v2 offset:11264
  ds_read_b128 v[52:55], v2 offset:12288
  ds_read_b128 v[56:59], v2 offset:13312
  ds_read_b128 v[60:63], v2 offset:14336
  ds_read_b128 v[64:67], v2 offset:15360
  s_and_b32 s36, s13, 1
  s_lshl_b32 s36, s36, 12
  s_add_u32 s22, s22, s36
  s_add_u32 s23, s36, 145752064
  s_mov_b32 s14, -1
  s_and_b32 s57, s14, 1
  s_and_b32 s36, s14, 3
  s_lshl_b32 s36, s36, 13
  s_add_u32 s26, s36, s23
  s_add_u32 s36, s36, 8192
  s_and_b32 s36, s36, 0x7fff
  s_add_u32 s24, s36, 145752064
  s_add_u32 s25, s36, 145756160
  s_add_u32 s35, s36, s23
  s_waitcnt lgkmcnt(0)
  s_cmp_lg_u32 s56, 0
  s_cbranch_scc1 M_global
  s_cmp_eq_u32 s13, 1
  s_cbranch_scc1 T_w_78
  s_cmp_eq_u32 s13, 2
  s_cbranch_scc1 T_w_79
  s_cmp_eq_u32 s13, 3
  s_cbranch_scc1 T_w_80
T_w_77:
  s_mov_b32 s19, 0
  v_mov_b64 v[16:17], 0
  v_mov_b64 v[18:19], 0
  v_mov_b64 v[20:21], 0
  v_mov_b64 v[22:23], 0
  v_mov_b64 v[24:25], 0
  v_mov_b64 v[26:27], 0
  buffer_load_dwordx4 v[124:127], v3, s[4:7], s24 offen offset:0 sc1
  buffer_load_dwordx4 v[116:119], v3, s[4:7], s25 offen offset:0 sc1
  buffer_load_dwordx4 v[124:127], v3, s[4:7], s24 offen offset:0 sc1
  buffer_load_dwordx4 v[116:119], v3, s[4:7], s25 offen offset:0 sc1
  s_branch T_loop_81
.p2align 6
T_retry_82:
  s_mov_b64 exec, vcc
  buffer_load_dwordx4 v[124:127], v3, s[4:7], s24 offen offset:0 sc1
  buffer_load_dwordx4 v[116:119], v3, s[4:7], s25 offen offset:0 sc1
  s_mov_b64 exec, -1
  s_add_u32 s19, s19, 1
  s_cmp_gt_u32 s19, 32768
  s_cbranch_scc1 M_exit
T_loop_81:
  s_waitcnt vmcnt(3) lgkmcnt(0)
  v_max3_u32 v123, v124, v125, v126
  v_max_u32 v123, v123, v127
  v_mov_b32_dpp v120, v124 row_ror:8 row_mask:0xf bank_mask:0xf
  v_mov_b32_dpp v121, v125 row_ror:8 row_mask:0xf bank_mask:0xf
  s_waitcnt vmcnt(2)
  v_max3_u32 v123, v123, v116, v117
  v_max3_u32 v123, v123, v118, v119
  v_cmp_eq_u32 vcc, -1, v123
  s_cbranch_vccnz T_retry_82
  v_smfmac_f32_16x16x64_bf16 v[16:19], v[124:127], v[68:75], v0
  s_add_u32 s14, s14, 1
  ds_write_b128 v2, v[124:127] offset:0
  v_mov_b32_dpp v122, v126 row_ror:8 row_mask:0xf bank_mask:0xf
  v_smfmac_f32_16x16x64_bf16 v[20:23], v[124:127], v[76:83], v0
  s_and_b32 s57, s14, 1
  v_mov_b32_dpp v123, v127 row_ror:8 row_mask:0xf bank_mask:0xf
  v_smfmac_f32_16x16x64_bf16 v[24:27], v[124:127], v[84:91], v0
  s_and_b32 s36, s14, 3
  ds_write_b128 v2, v[116:119] offset:4096
  v_smfmac_f32_16x16x64_bf16 v[16:19], v[120:123], v[92:99], v0
  s_lshl_b32 s36, s36, 13
  v_mov_b32_dpp v84, v116 row_ror:8 row_mask:0xf bank_mask:0xf
  v_smfmac_f32_16x16x64_bf16 v[20:23], v[120:123], v[100:107], v0
  s_add_u32 s26, s36, s23
  ds_read_b128 v[68:71], v4 offset:12288
  v_mov_b32_dpp v85, v117 row_ror:8 row_mask:0xf bank_mask:0xf
  v_smfmac_f32_16x16x64_bf16 v[24:27], v[120:123], v[108:115], v0
  s_add_u32 s36, s36, 8192
  ds_read_b128 v[72:75], v4 offset:13312
  v_mov_b32_dpp v86, v118 row_ror:8 row_mask:0xf bank_mask:0xf
  v_smfmac_f32_16x16x64_bf16 v[16:19], v[116:119], v[224:231], v0
  s_and_b32 s36, s36, 0x7fff
  ds_read_b128 v[76:79], v4 offset:14336
  v_mov_b32_dpp v87, v119 row_ror:8 row_mask:0xf bank_mask:0xf
  v_smfmac_f32_16x16x64_bf16 v[20:23], v[116:119], v[240:247], v0
  s_waitcnt lgkmcnt(3)
  s_barrier
  ds_read_b128 v[100:103], v2 offset:1024
  v_smfmac_f32_16x16x64_bf16 v[24:27], v[116:119], a[0:7], v0
  s_mov_b32 m0, s31
  ds_read_b128 v[120:123], v1 offset:1024
  v_smfmac_f32_16x16x64_bf16 v[16:19], v[84:87], v[232:239], v0
  s_cmp_ge_i32 s14, s30
  s_cbranch_scc1 T_kvw_85
T_kvb_86:
  v_smfmac_f32_16x16x64_bf16 v[20:23], v[84:87], v[248:255], v0
  ds_read_b128 v[80:83], v4 offset:15360
  buffer_load_dwordx4 v9, s[4:7], s27 offen sc1 lds
  v_smfmac_f32_16x16x64_bf16 v[24:27], v[84:87], a[8:15], v0
  s_waitcnt lgkmcnt(2)
  s_mov_b32 m0, s32
  v_smfmac_f32_16x16x64_bf16 v[16:19], v[100:103], v[128:135], v0
  ds_read_b128 v[92:95], v2 offset:2048
  v_smfmac_f32_16x16x64_bf16 v[20:23], v[100:103], v[144:151], v0
  ds_read_b128 v[96:99], v1 offset:2048
  v_smfmac_f32_16x16x64_bf16 v[24:27], v[100:103], v[68:75], v0
  s_waitcnt vmcnt(1) lgkmcnt(3)
  ds_read_b128 v[116:119], v2 offset:3072
  buffer_load_dwordx4 v9, s[4:7], s27 offen offset:128 sc1 lds
  v_smfmac_f32_16x16x64_bf16 v[16:19], v[120:123], v[136:143], v0
  ds_read_b128 v[124:127], v1 offset:3072
  s_mov_b32 m0, s33
  v_smfmac_f32_16x16x64_bf16 v[20:23], v[120:123], v[152:159], v0
  s_waitcnt lgkmcnt(4)
  ds_read_b128 v[104:107], v2 offset:5120
  v_smfmac_f32_16x16x64_bf16 v[24:27], v[120:123], v[76:83], v0
  s_waitcnt lgkmcnt(4)
  ds_read_b128 v[108:111], v1 offset:5120
  v_smfmac_f32_16x16x64_bf16 v[16:19], v[92:95], v[160:167], v0
  s_waitcnt lgkmcnt(4)
  ds_read_b128 v[112:115], v2 offset:6144
  buffer_load_dwordx4 v10, s[4:7], s28 offen sc1 lds
  v_smfmac_f32_16x16x64_bf16 v[16:19], v[96:99], v[168:175], v0
  s_waitcnt lgkmcnt(4)
  ds_read_b128 v[84:87], v1 offset:6144
  s_mov_b32 m0, s34
  v_smfmac_f32_16x16x64_bf16 v[16:19], v[116:119], v[192:199], v0
  s_waitcnt lgkmcnt(4)
  ds_read_b128 v[88:91], v2 offset:7168
  v_smfmac_f32_16x16x64_bf16 v[16:19], v[124:127], v[200:207], v0
  s_waitcnt lgkmcnt(4)
  ds_read_b128 v[100:103], v1 offset:7168
  v_smfmac_f32_16x16x64_bf16 v[16:19], v[104:107], a[16:23], v0
  s_waitcnt lgkmcnt(4)
  ds_read_b128 v[68:71], v4 offset:16384
  buffer_load_dwordx4 v10, s[4:7], s28 offen offset:256 sc1 lds
  v_smfmac_f32_16x16x64_bf16 v[16:19], v[108:111], a[24:31], v0
  s_waitcnt lgkmcnt(4)
  ds_read_b128 v[72:75], v4 offset:17408
  v_smfmac_f32_16x16x64_bf16 v[16:19], v[112:115], a[64:71], v0
  s_waitcnt lgkmcnt(4)
  ds_read_b128 v[76:79], v4 offset:18432
  v_smfmac_f32_16x16x64_bf16 v[16:19], v[84:87], a[72:79], v0
  s_waitcnt lgkmcnt(4)
  ds_read_b128 v[80:83], v4 offset:19456
  v_smfmac_f32_16x16x64_bf16 v[16:19], v[88:91], a[112:119], v0
  s_waitcnt lgkmcnt(4)
  v_smfmac_f32_16x16x64_bf16 v[16:19], v[100:103], a[120:127], v0
  s_add_u32 s24, s36, 145752064
  s_add_u32 s25, s36, 145756160
  v_smfmac_f32_16x16x64_bf16 v[20:23], v[92:95], v[176:183], v0
  s_add_u32 s35, s36, s23
  v_smfmac_f32_16x16x64_bf16 v[20:23], v[96:99], v[184:191], v0
  s_waitcnt lgkmcnt(2)
  v_smfmac_f32_16x16x64_bf16 v[20:23], v[116:119], v[68:75], v0
  s_waitcnt lgkmcnt(0)
  ds_read_b128 v[68:71], v4 offset:20480
  v_mul_f32 v16, s18, v16
  v_smfmac_f32_16x16x64_bf16 v[20:23], v[124:127], v[76:83], v0
  ds_read_b128 v[72:75], v4 offset:21504
  v_mul_f32 v17, s18, v17
  v_smfmac_f32_16x16x64_bf16 v[20:23], v[104:107], a[32:39], v0
  ds_read_b128 v[76:79], v4 offset:22528
  v_mul_f32 v18, s18, v18
  v_smfmac_f32_16x16x64_bf16 v[20:23], v[108:111], a[40:47], v0
  ds_read_b128 v[80:83], v4 offset:23552
  v_mul_f32 v19, s18, v19
  v_smfmac_f32_16x16x64_bf16 v[20:23], v[112:115], a[80:87], v0
  v_cvt_pk_bf16_f32 v120, v16, v17
  v_smfmac_f32_16x16x64_bf16 v[20:23], v[84:87], a[88:95], v0
  v_cvt_pk_bf16_f32 v121, v18, v19
  v_smfmac_f32_16x16x64_bf16 v[20:23], v[88:91], a[128:135], v0
  ds_write_b64 v5, v[120:121] offset:24576
  v_smfmac_f32_16x16x64_bf16 v[20:23], v[100:103], a[136:143], v0
  s_waitcnt lgkmcnt(3)
  v_smfmac_f32_16x16x64_bf16 v[24:27], v[92:95], v[68:75], v0
  s_waitcnt lgkmcnt(1)
  v_mov_b64 v[92:93], 0
  v_smfmac_f32_16x16x64_bf16 v[24:27], v[96:99], v[76:83], v0
  s_nop 1
  v_cvt_pk_bf16_f32 v122, v20, v21
  v_cvt_pk_bf16_f32 v123, v22, v23
  v_smfmac_f32_16x16x64_bf16 v[24:27], v[116:119], v[208:215], v0
  ds_write_b64 v5, v[122:123] offset:26880
  v_mov_b64 v[94:95], 0
  v_smfmac_f32_16x16x64_bf16 v[24:27], v[124:127], v[216:223], v0
  s_waitcnt lgkmcnt(1)
  s_barrier
  ds_read_b64_tr_b16 v[68:69], v6 offset:24576
  v_smfmac_f32_16x16x64_bf16 v[24:27], v[104:107], a[48:55], v0
  s_add_u32 s27, s27, 8192
  ds_read_b64_tr_b16 v[70:71], v6 offset:24640
  ds_read_b64_tr_b16 v[72:73], v6 offset:24832
  v_smfmac_f32_16x16x64_bf16 v[24:27], v[108:111], a[56:63], v0
  s_add_u32 s28, s28, 8192
  ds_read_b64_tr_b16 v[74:75], v6 offset:24896
  ds_read_b64_tr_b16 v[76:77], v6 offset:25088
  v_smfmac_f32_16x16x64_bf16 v[24:27], v[112:115], a[96:103], v0
  s_nop 0
  ds_read_b64_tr_b16 v[78:79], v6 offset:25152
  ds_read_b64_tr_b16 v[80:81], v6 offset:25344
  v_smfmac_f32_16x16x64_bf16 v[24:27], v[84:87], a[104:111], v0
  ds_read_b64_tr_b16 v[82:83], v6 offset:25408
  v_mov_b64 v[96:97], 0
  v_smfmac_f32_16x16x64_bf16 v[24:27], v[88:91], a[144:151], v0
  s_waitcnt lgkmcnt(8)
  s_barrier
  ds_read_b64_tr_b16 v[116:117], v6 offset:26880
  v_smfmac_f32_16x16x64_bf16 v[24:27], v[100:103], a[152:159], v0
  s_waitcnt lgkmcnt(7)
  ds_read_b64_tr_b16 v[118:119], v6 offset:26944
  v_mfma_f32_16x16x32_bf16 v[16:19], v[36:39], v[68:71], 0
  s_waitcnt lgkmcnt(6)
  ds_read_b64_tr_b16 v[124:125], v6 offset:27136
  ds_read_b64_tr_b16 v[126:127], v6 offset:27200
  v_mfma_f32_16x16x32_bf16 v[16:19], v[40:43], v[72:75], v[16:19]
  s_waitcnt lgkmcnt(6)
  ds_read_b64_tr_b16 v[104:105], v6 offset:27392
  ds_read_b64_tr_b16 v[106:107], v6 offset:27456
  v_mfma_f32_16x16x32_bf16 v[16:19], v[44:47], v[76:79], v[16:19]
  s_waitcnt lgkmcnt(6)
  ds_read_b64_tr_b16 v[108:109], v6 offset:27648
  ds_read_b64_tr_b16 v[110:111], v6 offset:27712
  v_mfma_f32_16x16x32_bf16 v[16:19], v[48:51], v[80:83], v[16:19]
  s_waitcnt lgkmcnt(6)
  v_cvt_pk_bf16_f32 v120, v24, v25
  v_cvt_pk_bf16_f32 v121, v26, v27
  v_mfma_f32_16x16x32_bf16 v[112:115], v[116:119], v[68:71], 0
  s_waitcnt lgkmcnt(4)
  buffer_store_dwordx4 v[120:123], v2, s[4:7], s29 offen offset:0 sc1
  v_mov_b64 v[98:99], 0
  v_mfma_f32_16x16x32_bf16 v[112:115], v[124:127], v[72:75], v[112:115]
  s_waitcnt lgkmcnt(2)
  v_mov_b64 v[36:37], 0
  v_exp_f32 v100, v16
  v_mfma_f32_16x16x32_bf16 v[112:115], v[104:107], v[76:79], v[112:115]
  s_waitcnt lgkmcnt(0)
  v_exp_f32 v101, v17
  v_mfma_f32_16x16x32_bf16 v[112:115], v[108:111], v[80:83], v[112:115]
  s_add_u32 s29, s29, 131072
  v_exp_f32 v102, v18
  v_mfma_f32_16x16x32_bf16 v[20:23], v[52:55], v[68:71], 0
  s_cmp_eq_u32 s14, 63
  v_exp_f32 v103, v19
  v_mfma_f32_16x16x32_bf16 v[20:23], v[56:59], v[72:75], v[20:23]
  s_cbranch_scc1 M_tdone
  v_cvt_pk_bf16_f32 v44, v100, v101
  v_cvt_pk_bf16_f32 v45, v102, v103
  v_mfma_f32_16x16x32_bf16 v[20:23], v[60:63], v[76:79], v[20:23]
  v_exp_f32 v100, v112
  v_mfma_f32_16x16x32_bf16 v[20:23], v[64:67], v[80:83], v[20:23]
  v_exp_f32 v101, v113
  v_exp_f32 v102, v114
  v_exp_f32 v103, v115
  v_cvt_pk_bf16_f32 v84, v100, v101
  v_cvt_pk_bf16_f32 v85, v102, v103
  v_cndmask_b32 v48, v84, 0, s[16:17]
  v_cndmask_b32 v49, v85, 0, s[16:17]
  v_cndmask_b32 v50, 0, v84, s[16:17]
  v_cndmask_b32 v51, 0, v85, s[16:17]
  v_exp_f32 v100, v20
  v_mfma_f32_16x16x16_bf16 v[88:91], v[12:13], v[48:49], 0
  v_exp_f32 v101, v21
  v_mfma_f32_16x16x16_bf16 v[24:27], v[120:121], v[48:49], 0
  v_exp_f32 v102, v22
  v_mfma_f32_16x16x16_bf16 v[116:119], v[120:121], v[50:51], 0
  v_exp_f32 v103, v23
  v_cvt_pk_bf16_f32 v46, v100, v101
  v_cvt_pk_bf16_f32 v47, v102, v103
  v_mov_b64 v[38:39], 0
  s_nop 0
  v_mfma_f32_16x16x32_bf16 v[88:91], v[12:15], v[44:47], v[88:91]
  v_mov_b64 v[40:41], 0
  v_mov_b64 v[42:43], 0
  v_mfma_f32_16x16x32_bf16 v[24:27], v[28:31], v[44:47], v[24:27]
  ds_read_b128 v[52:55], v4 offset:24576
  ds_read_b128 v[56:59], v4 offset:25600
  v_mfma_f32_16x16x32_bf16 v[116:119], v[32:35], v[44:47], v[116:119]
  s_nop 1
  v_rcp_f32 v89, v88
  v_subrev_u32 v100, s54, v88
  v_cmp_le_u32 vcc, s55, v100
  v_mul_f32 v24, v89, v24
  v_mul_f32 v25, v89, v25
  s_cbranch_vccnz T_slow_88
T_back_89:
  v_cvt_pk_bf16_f32 v124, v24, v25
  v_pk_mul_f32 v[26:27], v[26:27], v[88:89] op_sel:[0,1] op_sel_hi:[1,1]
  v_pk_mul_f32 v[116:117], v[116:117], v[88:89] op_sel:[0,1] op_sel_hi:[1,1]
  v_pk_mul_f32 v[118:119], v[118:119], v[88:89] op_sel:[0,1] op_sel_hi:[1,1]
  v_cvt_pk_bf16_f32 v125, v26, v27
  v_cvt_pk_bf16_f32 v126, v116, v117
  v_cvt_pk_bf16_f32 v127, v118, v119
  ds_write_b128 v11, v[124:127] offset:29184
  s_nop 0
  v_smfmac_f32_16x16x64_bf16 v[92:95], v[124:127], a[160:167], v0
  v_smfmac_f32_16x16x64_bf16 v[96:99], v[124:127], a[168:175], v0
  v_smfmac_f32_16x16x64_bf16 v[36:39], v[124:127], a[176:183], v0
  v_smfmac_f32_16x16x64_bf16 v[40:43], v[124:127], a[184:191], v0
  s_waitcnt lgkmcnt(0)
  s_barrier
  ds_read_b128 v[104:107], v11 offset:29696
  ds_read_b128 v[108:111], v11 offset:30208
  ds_read_b128 v[68:71], v11 offset:30720
  s_waitcnt lgkmcnt(2)
  v_smfmac_f32_16x16x64_bf16 v[92:95], v[104:107], a[192:199], v0
  s_waitcnt lgkmcnt(1)
  ds_read_b128 v[76:79], v4 offset:28672
  v_smfmac_f32_16x16x64_bf16 v[92:95], v[108:111], a[224:231], v0
  s_waitcnt lgkmcnt(1)
  ds_read_b128 v[80:83], v4 offset:29696
  v_smfmac_f32_16x16x64_bf16 v[92:95], v[68:71], a[240:247], v0
  ds_read_b128 v[60:63], v4 offset:26624
  v_smfmac_f32_16x16x64_bf16 v[96:99], v[104:107], a[200:207], v0
  ds_read_b128 v[64:67], v4 offset:27648
  v_smfmac_f32_16x16x64_bf16 v[96:99], v[108:111], a[232:239], v0
  ds_read_b128 v[28:31], v4 offset:30720
  s_nop 0
  v_cvt_pk_bf16_f32 v16, v92, v93
  v_cvt_pk_bf16_f32 v17, v94, v95
  v_bfi_b32 v16, 1, s57, v16
  v_smfmac_f32_16x16x64_bf16 v[96:99], v[68:71], a[248:255], v0
  buffer_store_dwordx2 v[16:17], v7, s[4:7], s20 offen offset:0
  v_smfmac_f32_16x16x64_bf16 v[36:39], v[104:107], a[208:215], v0
  ds_read_b128 v[32:35], v4 offset:31744
  v_smfmac_f32_16x16x64_bf16 v[36:39], v[108:111], v[52:59], v0
  s_waitcnt lgkmcnt(4)
  s_nop 0
  v_cvt_pk_bf16_f32 v18, v96, v97
  v_cvt_pk_bf16_f32 v19, v98, v99
  v_bfi_b32 v18, 1, s57, v18
  v_smfmac_f32_16x16x64_bf16 v[36:39], v[68:71], v[76:83], v0
  buffer_store_dwordx2 v[18:19], v7, s[4:7], s20 offen offset:64
  v_smfmac_f32_16x16x64_bf16 v[40:43], v[104:107], a[216:223], v0
  s_waitcnt lgkmcnt(2)
  ds_read_b128 v[116:119], v2 offset:31232
  v_smfmac_f32_16x16x64_bf16 v[40:43], v[108:111], v[60:67], v0
  s_waitcnt lgkmcnt(1)
  s_nop 0
  v_cvt_pk_bf16_f32 v20, v36, v37
  v_cvt_pk_bf16_f32 v21, v38, v39
  v_bfi_b32 v20, 1, s57, v20
  v_smfmac_f32_16x16x64_bf16 v[40:43], v[68:71], v[28:35], v0
  buffer_store_dwordx2 v[20:21], v7, s[4:7], s21 offen offset:0
  s_nop 6
  v_cvt_pk_bf16_f32 v22, v40, v41
  v_cvt_pk_bf16_f32 v23, v42, v43
  v_bfi_b32 v22, 1, s57, v22
  buffer_store_dwordx2 v[22:23], v7, s[4:7], s21 offen offset:64
  ds_read_b128 v[68:71], v4 offset:0
  ds_read_b128 v[72:75], v4 offset:1024
  ds_read_b128 v[76:79], v4 offset:4096
  ds_read_b128 v[80:83], v4 offset:5120
  ds_read_b128 v[84:87], v4 offset:8192
  ds_read_b128 v[88:91], v4 offset:9216
  v_mov_b64 v[16:17], 0
  v_mov_b64 v[18:19], 0
  v_mov_b64 v[20:21], 0
  v_mov_b64 v[22:23], 0
  v_mov_b64 v[24:25], 0
  v_mov_b64 v[26:27], 0
  s_mov_b32 s19, 0
  v_mov_b32 v49, -1
  s_waitcnt vmcnt(2)
  buffer_load_dwordx4 v[52:55], v2, s[4:7], s22 offen offset:0 sc1
  buffer_load_dwordx4 v[56:59], v2, s[4:7], s22 offen offset:1024 sc1
  buffer_load_dwordx4 v[60:63], v2, s[4:7], s22 offen offset:2048 sc1
  buffer_load_dwordx4 v[64:67], v2, s[4:7], s22 offen offset:3072 sc1
  ds_read_b128 v[92:95], v4 offset:2048
  ds_read_b128 v[96:99], v4 offset:3072
  ds_read_b128 v[100:103], v4 offset:6144
  ds_read_b128 v[104:107], v4 offset:7168
  ds_read_b128 v[108:111], v4 offset:10240
  ds_read_b128 v[112:115], v4 offset:11264
  ds_read_b64 v[44:45], v2 offset:32256
  s_waitcnt lgkmcnt(0)
  v_readfirstlane_b32 s38, v44
  v_readfirstlane_b32 s37, v45
  s_nop 0
  s_add_u32 s37, s37, 30
  s_cmp_ge_u32 s38, 30
  s_cselect_b32 s38, s37, s38
  s_cmp_ge_u32 s38, 64
  s_cselect_b32 s38, 100, s38
  s_sub_u32 s38, s38, 1
  s_max_i32 s30, s30, s38
  s_waitcnt lgkmcnt(12)
  s_waitcnt vmcnt(3)
  v_mfma_f32_16x16x32_bf16 v[120:123], v[116:119], v[52:55], 0
  v_xor_b32 v48, s57, v52
  v_bitop3_b32 v48, v48, v54, s57 bitop3:0xf6
  s_waitcnt vmcnt(2)
  v_mfma_f32_16x16x32_bf16 v[120:123], v[116:119], v[56:59], v[120:123]
  v_bitop3_b32 v48, v48, v56, s57 bitop3:0xf6
  v_bitop3_b32 v48, v48, v58, s57 bitop3:0xf6
  s_waitcnt vmcnt(1)
  v_mfma_f32_16x16x32_bf16 v[120:123], v[116:119], v[60:63], v[120:123]
  v_bitop3_b32 v48, v48, v60, s57 bitop3:0xf6
  v_bitop3_b32 v48, v48, v62, s57 bitop3:0xf6
  s_waitcnt vmcnt(0)
  v_mfma_f32_16x16x32_bf16 v[120:123], v[116:119], v[64:67], v[120:123]
  v_bitop3_b32 v48, v48, v64, s57 bitop3:0xf6
  v_bitop3_b32 v48, v48, v66, s57 bitop3:0xf6
  v_and_b32 v48, 1, v48
  v_cmp_ne_u32 vcc, 0, v48
  s_cbranch_vccnz T_p1re_91
T_p1ok_92:
  s_nop 2
  v_add_f32_dpp v120, v120, v120 row_ror:8 row_mask:0xf bank_mask:0xf
  v_add_f32_dpp v121, v121, v121 row_ror:8 row_mask:0xf bank_mask:0xf
  v_cvt_pk_bf16_f32 v48, v120, v121
  v_min_u32 v48, -2, v48
  buffer_store_dword v48, v8, s[4:7], s35 offen
  buffer_store_dword v49, v8, s[4:7], s26 offen
  s_barrier
  ds_read_b128 v[28:31], v2 offset:16384
  ds_read_b128 v[32:35], v2 offset:20480
  ds_read_b128 v[36:39], v2 offset:8192
  ds_read_b128 v[40:43], v2 offset:9216
  ds_read_b128 v[44:47], v2 offset:10240
  ds_read_b128 v[48:51], v2 offset:11264
  buffer_load_dwordx4 v[124:127], v3, s[4:7], s24 offen offset:0 sc1
  buffer_load_dwordx4 v[116:119], v3, s[4:7], s25 offen offset:0 sc1
  ds_read_b128 v[52:55], v2 offset:12288
  ds_read_b128 v[56:59], v2 offset:13312
  ds_read_b128 v[60:63], v2 offset:14336
  ds_read_b128 v[64:67], v2 offset:15360
  buffer_load_dwordx4 v[124:127], v3, s[4:7], s24 offen offset:0 sc1
  buffer_load_dwordx4 v[116:119], v3, s[4:7], s25 offen offset:0 sc1
  s_mov_b32 s19, 0
  s_branch T_loop_81
T_p1re_91:
  s_mov_b64 exec, vcc
  buffer_load_dwordx4 v[52:55], v2, s[4:7], s22 offen offset:0 sc1
  buffer_load_dwordx4 v[56:59], v2, s[4:7], s22 offen offset:1024 sc1
  buffer_load_dwordx4 v[60:63], v2, s[4:7], s22 offen offset:2048 sc1
  buffer_load_dwordx4 v[64:67], v2, s[4:7], s22 offen offset:3072 sc1
  s_mov_b64 exec, -1
  s_add_u32 s19, s19, 1
  s_cmp_gt_u32 s19, 32768
  s_cbranch_scc1 M_exit
  s_waitcnt vmcnt(3)
  v_mfma_f32_16x16x32_bf16 v[120:123], v[116:119], v[52:55], 0
  v_xor_b32 v48, s57, v52
  v_bitop3_b32 v48, v48, v54, s57 bitop3:0xf6
  s_waitcnt vmcnt(2)
  v_mfma_f32_16x16x32_bf16 v[120:123], v[116:119], v[56:59], v[120:123]
  v_bitop3_b32 v48, v48, v56, s57 bitop3:0xf6
  v_bitop3_b32 v48, v48, v58, s57 bitop3:0xf6
  s_waitcnt vmcnt(1)
  v_mfma_f32_16x16x32_bf16 v[120:123], v[116:119], v[60:63], v[120:123]
  v_bitop3_b32 v48, v48, v60, s57 bitop3:0xf6
  v_bitop3_b32 v48, v48, v62, s57 bitop3:0xf6
  s_waitcnt vmcnt(0)
  v_mfma_f32_16x16x32_bf16 v[120:123], v[116:119], v[64:67], v[120:123]
  v_bitop3_b32 v48, v48, v64, s57 bitop3:0xf6
  v_bitop3_b32 v48, v48, v66, s57 bitop3:0xf6
  v_and_b32 v48, 1, v48
  v_cmp_ne_u32 vcc, 0, v48
  s_cbranch_vccnz T_p1re_91
  s_branch T_p1ok_92
T_kvw_85:
  s_mov_b32 s19, 0
  s_branch T_kvok_94
T_kv_93:
  s_sleep 4
  s_add_u32 s19, s19, 1
  s_cmp_gt_u32 s19, 32768
  s_cbranch_scc1 M_exit
T_kvok_94:
  s_add_u32 s39, s99, 128
  s_mov_b32 s38, 0
  s_mov_b32 s37, 0
  s_atomic_or s38, s[58:59], s99 glc
  s_atomic_or s37, s[58:59], s39 glc
  s_waitcnt lgkmcnt(0)
  s_add_u32 s37, s37, 30
  s_cmp_ge_u32 s38, 30
  s_cselect_b32 s38, s37, s38
  s_cmp_ge_u32 s38, 64
  s_cselect_b32 s38, 100, s38
  s_sub_u32 s38, s38, 1
  s_max_i32 s30, s30, s38
  s_cmp_ge_i32 s14, s30
  s_cbranch_scc1 T_kv_93
  s_branch T_kvb_86
T_slow_88:
  s_nop 7
  v_max3_f32 v100, v16, v17, v18
  v_max3_f32 v100, v100, v19, v20
  v_max3_f32 v100, v100, v21, v22
  v_max3_f32 v100, v100, v23, v112
  v_max3_f32 v100, v100, v113, v114
  v_max_f32 v100, v100, v115
  v_mov_b32 v101, v100
  s_nop 1
  v_permlane32_swap_b32 v100, v101
  s_nop 1
  v_max_f32 v100, v100, v101
  v_mov_b32 v101, v100
  s_nop 1
  v_permlane16_swap_b32 v100, v101
  s_nop 1
  v_max_f32 v100, v100, v101
  v_sub_f32 v16, v16, v100
  v_sub_f32 v17, v17, v100
  v_sub_f32 v18, v18, v100
  v_sub_f32 v19, v19, v100
  v_exp_f32 v16, v16
  v_exp_f32 v17, v17
  v_exp_f32 v18, v18
  v_exp_f32 v19, v19
  v_sub_f32 v20, v20, v100
  v_sub_f32 v21, v21, v100
  v_sub_f32 v22, v22, v100
  v_sub_f32 v23, v23, v100
  v_exp_f32 v20, v20
  v_exp_f32 v21, v21
  v_exp_f32 v22, v22
  v_exp_f32 v23, v23
  v_sub_f32 v112, v112, v100
  v_sub_f32 v113, v113, v100
  v_sub_f32 v114, v114, v100
  v_sub_f32 v115, v115, v100
  v_exp_f32 v112, v112
  v_exp_f32 v113, v113
  v_exp_f32 v114, v114
  v_exp_f32 v115, v115
  s_nop 0
  v_cvt_pk_bf16_f32 v44, v16, v17
  v_cvt_pk_bf16_f32 v45, v18, v19
  v_cvt_pk_bf16_f32 v46, v20, v21
  v_cvt_pk_bf16_f32 v47, v22, v23
  v_cvt_pk_bf16_f32 v84, v112, v113
  v_cvt_pk_bf16_f32 v85, v114, v115
  v_cndmask_b32 v48, v84, 0, s[16:17]
  v_cndmask_b32 v49, v85, 0, s[16:17]
  v_cndmask_b32 v50, 0, v84, s[16:17]
  v_cndmask_b32 v51, 0, v85, s[16:17]
  s_nop 1
  v_mfma_f32_16x16x16_bf16 v[88:91], v[12:13], v[48:49], 0
  v_mfma_f32_16x16x16_bf16 v[24:27], v[120:121], v[48:49], 0
  v_mfma_f32_16x16x16_bf16 v[116:119], v[120:121], v[50:51], 0
  v_mfma_f32_16x16x32_bf16 v[88:91], v[12:15], v[44:47], v[88:91]
  v_mfma_f32_16x16x32_bf16 v[24:27], v[28:31], v[44:47], v[24:27]
  v_mfma_f32_16x16x32_bf16 v[116:119], v[32:35], v[44:47], v[116:119]
  s_nop 7
  s_nop 1
  v_rcp_f32 v89, v88
  s_nop 0
  v_mul_f32 v24, v89, v24
  v_mul_f32 v25, v89, v25
  s_branch T_back_89
T_w_78:
  s_mov_b32 s19, 0
  v_mov_b64 v[16:17], 0
  v_mov_b64 v[18:19], 0
  v_mov_b64 v[20:21], 0
  v_mov_b64 v[22:23], 0
  v_mov_b64 v[24:25], 0
  v_mov_b64 v[26:27], 0
  buffer_load_dwordx4 v[124:127], v3, s[4:7], s24 offen offset:1024 sc1
  buffer_load_dwordx4 v[116:119], v3, s[4:7], s25 offen offset:1024 sc1
  buffer_load_dwordx4 v[124:127], v3, s[4:7], s24 offen offset:1024 sc1
  buffer_load_dwordx4 v[116:119], v3, s[4:7], s25 offen offset:1024 sc1
  s_branch T_loop_95
.p2align 6
T_retry_96:
  s_mov_b64 exec, vcc
  buffer_load_dwordx4 v[124:127], v3, s[4:7], s24 offen offset:1024 sc1
  buffer_load_dwordx4 v[116:119], v3, s[4:7], s25 offen offset:1024 sc1
  s_mov_b64 exec, -1
  s_add_u32 s19, s19, 1
  s_cmp_gt_u32 s19, 32768
  s_cbranch_scc1 M_exit
T_loop_95:
  s_waitcnt vmcnt(3) lgkmcnt(0)
  v_max3_u32 v123, v124, v125, v126
  v_max_u32 v123, v123, v127
  v_mov_b32_dpp v120, v124 row_ror:8 row_mask:0xf bank_mask:0xf
  v_mov_b32_dpp v121, v125 row_ror:8 row_mask:0xf bank_mask:0xf
  s_waitcnt vmcnt(2)
  v_max3_u32 v123, v123, v116, v117
  v_max3_u32 v123, v123, v118, v119
  v_cmp_eq_u32 vcc, -1, v123
  s_cbranch_vccnz T_retry_96
  v_smfmac_f32_16x16x64_bf16 v[16:19], v[124:127], v[68:75], v0
  s_add_u32 s14, s14, 1
  ds_write_b128 v2, v[124:127] offset:1024
  v_mov_b32_dpp v122, v126 row_ror:8 row_mask:0xf bank_mask:0xf
  v_smfmac_f32_16x16x64_bf16 v[20:23], v[124:127], v[76:83], v0
  s_and_b32 s57, s14, 1
  v_mov_b32_dpp v123, v127 row_ror:8 row_mask:0xf bank_mask:0xf
  v_smfmac_f32_16x16x64_bf16 v[24:27], v[124:127], v[84:91], v0
  s_and_b32 s36, s14, 3
  ds_write_b128 v2, v[116:119] offset:5120
  v_smfmac_f32_16x16x64_bf16 v[16:19], v[120:123], v[92:99], v0
  s_lshl_b32 s36, s36, 13
  v_mov_b32_dpp v84, v116 row_ror:8 row_mask:0xf bank_mask:0xf
  v_smfmac_f32_16x16x64_bf16 v[20:23], v[120:123], v[100:107], v0
  s_add_u32 s26, s36, s23
  ds_read_b128 v[68:71], v4 offset:12288
  v_mov_b32_dpp v85, v117 row_ror:8 row_mask:0xf bank_mask:0xf
  v_smfmac_f32_16x16x64_bf16 v[24:27], v[120:123], v[108:115], v0
  s_add_u32 s36, s36, 8192
  ds_read_b128 v[72:75], v4 offset:13312
  v_mov_b32_dpp v86, v118 row_ror:8 row_mask:0xf bank_mask:0xf
  v_smfmac_f32_16x16x64_bf16 v[16:19], v[116:119], v[224:231], v0
  s_and_b32 s36, s36, 0x7fff
  ds_read_b128 v[76:79], v4 offset:14336
  v_mov_b32_dpp v87, v119 row_ror:8 row_mask:0xf bank_mask:0xf
  v_smfmac_f32_16x16x64_bf16 v[20:23], v[116:119], v[240:247], v0
  s_waitcnt lgkmcnt(3)
  s_barrier
  ds_read_b128 v[100:103], v2 offset:0
  v_smfmac_f32_16x16x64_bf16 v[24:27], v[116:119], a[0:7], v0
  s_mov_b32 m0, s31
  ds_read_b128 v[120:123], v1 offset:0
  v_smfmac_f32_16x16x64_bf16 v[16:19], v[84:87], v[232:239], v0
  s_cmp_ge_i32 s14, s30
  s_cbranch_scc1 T_kvw_99
T_kvb_100:
  v_smfmac_f32_16x16x64_bf16 v[20:23], v[84:87], v[248:255], v0
  ds_read_b128 v[80:83], v4 offset:15360
  v_smfmac_f32_16x16x64_bf16 v[24:27], v[84:87], a[8:15], v0
  s_waitcnt lgkmcnt(2)
  buffer_load_dwordx4 v9, s[4:7], s27 offen sc1 lds
  v_smfmac_f32_16x16x64_bf16 v[16:19], v[100:103], v[128:135], v0
  ds_read_b128 v[92:95], v2 offset:3072
  s_mov_b32 m0, s32
  v_smfmac_f32_16x16x64_bf16 v[20:23], v[100:103], v[144:151], v0
  ds_read_b128 v[96:99], v1 offset:3072
  v_smfmac_f32_16x16x64_bf16 v[24:27], v[100:103], v[68:75], v0
  s_waitcnt vmcnt(1) lgkmcnt(3)
  ds_read_b128 v[116:119], v2 offset:2048
  v_smfmac_f32_16x16x64_bf16 v[16:19], v[120:123], v[136:143], v0
  ds_read_b128 v[124:127], v1 offset:2048
  buffer_load_dwordx4 v9, s[4:7], s27 offen offset:128 sc1 lds
  v_smfmac_f32_16x16x64_bf16 v[20:23], v[120:123], v[152:159], v0
  s_waitcnt lgkmcnt(4)
  ds_read_b128 v[104:107], v2 offset:4096
  s_mov_b32 m0, s33
  v_smfmac_f32_16x16x64_bf16 v[24:27], v[120:123], v[76:83], v0
  s_waitcnt lgkmcnt(4)
  ds_read_b128 v[108:111], v1 offset:4096
  v_smfmac_f32_16x16x64_bf16 v[16:19], v[92:95], v[160:167], v0
  s_waitcnt lgkmcnt(4)
  ds_read_b128 v[112:115], v2 offset:7168
  v_smfmac_f32_16x16x64_bf16 v[16:19], v[96:99], v[168:175], v0
  s_waitcnt lgkmcnt(4)
  ds_read_b128 v[84:87], v1 offset:7168
  buffer_load_dwordx4 v10, s[4:7], s28 offen sc1 lds
  v_smfmac_f32_16x16x64_bf16 v[16:19], v[116:119], v[192:199], v0
  s_waitcnt lgkmcnt(4)
  ds_read_b128 v[88:91], v2 offset:6144
  s_mov_b32 m0, s34
  v_smfmac_f32_16x16x64_bf16 v[16:19], v[124:127], v[200:207], v0
  s_waitcnt lgkmcnt(4)
  ds_read_b128 v[100:103], v1 offset:6144
  v_smfmac_f32_16x16x64_bf16 v[16:19], v[104:107], a[16:23], v0
  s_waitcnt lgkmcnt(4)
  ds_read_b128 v[68:71], v4 offset:16384
  v_smfmac_f32_16x16x64_bf16 v[16:19], v[108:111], a[24:31], v0
  s_waitcnt lgkmcnt(4)
  ds_read_b128 v[72:75], v4 offset:17408
  buffer_load_dwordx4 v10, s[4:7], s28 offen offset:256 sc1 lds
  v_smfmac_f32_16x16x64_bf16 v[16:19], v[112:115], a[64:71], v0
  s_waitcnt lgkmcnt(4)
  ds_read_b128 v[76:79], v4 offset:18432
  v_smfmac_f32_16x16x64_bf16 v[16:19], v[84:87], a[72:79], v0
  s_waitcnt lgkmcnt(4)
  ds_read_b128 v[80:83], v4 offset:19456
  v_smfmac_f32_16x16x64_bf16 v[16:19], v[88:91], a[112:119], v0
  s_waitcnt lgkmcnt(4)
  v_smfmac_f32_16x16x64_bf16 v[16:19], v[100:103], a[120:127], v0
  s_add_u32 s24, s36, 145752064
  s_add_u32 s25, s36, 145756160
  v_smfmac_f32_16x16x64_bf16 v[20:23], v[92:95], v[176:183], v0
  s_add_u32 s35, s36, s23
  v_smfmac_f32_16x16x64_bf16 v[20:23], v[96:99], v[184:191], v0
  s_waitcnt lgkmcnt(2)
  v_smfmac_f32_16x16x64_bf16 v[20:23], v[116:119], v[68:75], v0
  s_waitcnt lgkmcnt(0)
  ds_read_b128 v[68:71], v4 offset:20480
  v_mul_f32 v16, s18, v16
  v_smfmac_f32_16x16x64_bf16 v[20:23], v[124:127], v[76:83], v0
  ds_read_b128 v[72:75], v4 offset:21504
  v_mul_f32 v17, s18, v17
  v_smfmac_f32_16x16x64_bf16 v[20:23], v[104:107], a[32:39], v0
  ds_read_b128 v[76:79], v4 offset:22528
  v_mul_f32 v18, s18, v18
  v_smfmac_f32_16x16x64_bf16 v[20:23], v[108:111], a[40:47], v0
  ds_read_b128 v[80:83], v4 offset:23552
  v_mul_f32 v19, s18, v19
  v_smfmac_f32_16x16x64_bf16 v[20:23], v[112:115], a[80:87], v0
  v_cvt_pk_bf16_f32 v120, v16, v17
  v_smfmac_f32_16x16x64_bf16 v[20:23], v[84:87], a[88:95], v0
  v_cvt_pk_bf16_f32 v121, v18, v19
  v_smfmac_f32_16x16x64_bf16 v[20:23], v[88:91], a[128:135], v0
  ds_write_b64 v5, v[120:121] offset:24576
  v_smfmac_f32_16x16x64_bf16 v[20:23], v[100:103], a[136:143], v0
  s_waitcnt lgkmcnt(3)
  v_smfmac_f32_16x16x64_bf16 v[24:27], v[92:95], v[68:75], v0
  s_waitcnt lgkmcnt(1)
  v_mov_b64 v[92:93], 0
  v_smfmac_f32_16x16x64_bf16 v[24:27], v[96:99], v[76:83], v0
  s_nop 1
  v_cvt_pk_bf16_f32 v122, v20, v21
  v_cvt_pk_bf16_f32 v123, v22, v23
  v_smfmac_f32_16x16x64_bf16 v[24:27], v[116:119], v[208:215], v0
  ds_write_b64 v5, v[122:123] offset:26880
  v_mov_b64 v[94:95], 0
  v_smfmac_f32_16x16x64_bf16 v[24:27], v[124:127], v[216:223], v0
  s_waitcnt lgkmcnt(1)
  s_barrier
  ds_read_b64_tr_b16 v[68:69], v6 offset:24576
  v_smfmac_f32_16x16x64_bf16 v[24:27], v[104:107], a[48:55], v0
  s_add_u32 s27, s27, 8192
  ds_read_b64_tr_b16 v[70:71], v6 offset:24640
  ds_read_b64_tr_b16 v[72:73], v6 offset:24832
  v_smfmac_f32_16x16x64_bf16 v[24:27], v[108:111], a[56:63], v0
  s_add_u32 s28, s28, 8192
  ds_read_b64_tr_b16 v[74:75], v6 offset:24896
  ds_read_b64_tr_b16 v[76:77], v6 offset:25088
  v_smfmac_f32_16x16x64_bf16 v[24:27], v[112:115], a[96:103], v0
  s_nop 0
  ds_read_b64_tr_b16 v[78:79], v6 offset:25152
  ds_read_b64_tr_b16 v[80:81], v6 offset:25344
  v_smfmac_f32_16x16x64_bf16 v[24:27], v[84:87], a[104:111], v0
  ds_read_b64_tr_b16 v[82:83], v6 offset:25408
  v_mov_b64 v[96:97], 0
  v_smfmac_f32_16x16x64_bf16 v[24:27], v[88:91], a[144:151], v0
  s_waitcnt lgkmcnt(8)
  s_barrier
  ds_read_b64_tr_b16 v[116:117], v6 offset:26880
  v_smfmac_f32_16x16x64_bf16 v[24:27], v[100:103], a[152:159], v0
  s_waitcnt lgkmcnt(7)
  ds_read_b64_tr_b16 v[118:119], v6 offset:26944
  v_mfma_f32_16x16x32_bf16 v[16:19], v[36:39], v[68:71], 0
  s_waitcnt lgkmcnt(6)
  ds_read_b64_tr_b16 v[124:125], v6 offset:27136
  ds_read_b64_tr_b16 v[126:127], v6 offset:27200
  v_mfma_f32_16x16x32_bf16 v[16:19], v[40:43], v[72:75], v[16:19]
  s_waitcnt lgkmcnt(6)
  ds_read_b64_tr_b16 v[104:105], v6 offset:27392
  ds_read_b64_tr_b16 v[106:107], v6 offset:27456
  v_mfma_f32_16x16x32_bf16 v[16:19], v[44:47], v[76:79], v[16:19]
  s_waitcnt lgkmcnt(6)
  ds_read_b64_tr_b16 v[108:109], v6 offset:27648
  ds_read_b64_tr_b16 v[110:111], v6 offset:27712
  v_mfma_f32_16x16x32_bf16 v[16:19], v[48:51], v[80:83], v[16:19]
  s_waitcnt lgkmcnt(6)
  v_cvt_pk_bf16_f32 v120, v24, v25
  v_cvt_pk_bf16_f32 v121, v26, v27
  v_mfma_f32_16x16x32_bf16 v[112:115], v[116:119], v[68:71], 0
  s_waitcnt lgkmcnt(4)
  buffer_store_dwordx4 v[120:123], v2, s[4:7], s29 offen offset:1024 sc1
  v_mov_b64 v[98:99], 0
  v_mfma_f32_16x16x32_bf16 v[112:115], v[124:127], v[72:75], v[112:115]
  s_waitcnt lgkmcnt(2)
  v_mov_b64 v[36:37], 0
  v_exp_f32 v100, v16
  v_mfma_f32_16x16x32_bf16 v[112:115], v[104:107], v[76:79], v[112:115]
  s_waitcnt lgkmcnt(0)
  v_exp_f32 v101, v17
  v_mfma_f32_16x16x32_bf16 v[112:115], v[108:111], v[80:83], v[112:115]
  s_add_u32 s29, s29, 131072
  v_exp_f32 v102, v18
  v_mfma_f32_16x16x32_bf16 v[20:23], v[52:55], v[68:71], 0
  s_cmp_eq_u32 s14, 63
  v_exp_f32 v103, v19
  v_mfma_f32_16x16x32_bf16 v[20:23], v[56:59], v[72:75], v[20:23]
  s_cbranch_scc1 M_tdone
  v_cvt_pk_bf16_f32 v44, v100, v101
  v_cvt_pk_bf16_f32 v45, v102, v103
  v_mfma_f32_16x16x32_bf16 v[20:23], v[60:63], v[76:79], v[20:23]
  v_exp_f32 v100, v112
  v_mfma_f32_16x16x32_bf16 v[20:23], v[64:67], v[80:83], v[20:23]
  v_exp_f32 v101, v113
  v_exp_f32 v102, v114
  v_exp_f32 v103, v115
  v_cvt_pk_bf16_f32 v84, v100, v101
  v_cvt_pk_bf16_f32 v85, v102, v103
  v_cndmask_b32 v48, v84, 0, s[16:17]
  v_cndmask_b32 v49, v85, 0, s[16:17]
  v_cndmask_b32 v50, 0, v84, s[16:17]
  v_cndmask_b32 v51, 0, v85, s[16:17]
  v_exp_f32 v100, v20
  v_mfma_f32_16x16x16_bf16 v[88:91], v[12:13], v[48:49], 0
  v_exp_f32 v101, v21
  v_mfma_f32_16x16x16_bf16 v[24:27], v[120:121], v[48:49], 0
  v_exp_f32 v102, v22
  v_mfma_f32_16x16x16_bf16 v[116:119], v[120:121], v[50:51], 0
  v_exp_f32 v103, v23
  v_cvt_pk_bf16_f32 v46, v100, v101
  v_cvt_pk_bf16_f32 v47, v102, v103
  v_mov_b64 v[38:39], 0
  s_nop 0
  v_mfma_f32_16x16x32_bf16 v[88:91], v[12:15], v[44:47], v[88:91]
  v_mov_b64 v[40:41], 0
  v_mov_b64 v[42:43], 0
  v_mfma_f32_16x16x32_bf16 v[24:27], v[28:31], v[44:47], v[24:27]
  ds_read_b128 v[52:55], v4 offset:24576
  ds_read_b128 v[56:59], v4 offset:25600
  v_mfma_f32_16x16x32_bf16 v[116:119], v[32:35], v[44:47], v[116:119]
  s_nop 1
  v_rcp_f32 v89, v88
  v_subrev_u32 v100, s54, v88
  v_cmp_le_u32 vcc, s55, v100
  v_mul_f32 v24, v89, v24
  v_mul_f32 v25, v89, v25
  s_cbranch_vccnz T_slow_102
T_back_103:
  v_cvt_pk_bf16_f32 v124, v24, v25
  v_pk_mul_f32 v[26:27], v[26:27], v[88:89] op_sel:[0,1] op_sel_hi:[1,1]
  v_pk_mul_f32 v[116:117], v[116:117], v[88:89] op_sel:[0,1] op_sel_hi:[1,1]
  v_pk_mul_f32 v[118:119], v[118:119], v[88:89] op_sel:[0,1] op_sel_hi:[1,1]
  v_cvt_pk_bf16_f32 v125, v26, v27
  v_cvt_pk_bf16_f32 v126, v116, v117
  v_cvt_pk_bf16_f32 v127, v118, v119
  ds_write_b128 v11, v[124:127] offset:29696
  s_nop 0
  v_smfmac_f32_16x16x64_bf16 v[92:95], v[124:127], a[160:167], v0
  v_smfmac_f32_16x16x64_bf16 v[96:99], v[124:127], a[168:175], v0
  v_smfmac_f32_16x16x64_bf16 v[36:39], v[124:127], a[176:183], v0
  v_smfmac_f32_16x16x64_bf16 v[40:43], v[124:127], a[184:191], v0
  s_waitcnt lgkmcnt(0)
  s_barrier
  ds_read_b128 v[104:107], v11 offset:29184
  ds_read_b128 v[108:111], v11 offset:30720
  ds_read_b128 v[68:71], v11 offset:30208
  s_waitcnt lgkmcnt(2)
  v_smfmac_f32_16x16x64_bf16 v[92:95], v[104:107], a[192:199], v0
  s_waitcnt lgkmcnt(1)
  ds_read_b128 v[76:79], v4 offset:28672
  v_smfmac_f32_16x16x64_bf16 v[92:95], v[108:111], a[224:231], v0
  s_waitcnt lgkmcnt(1)
  ds_read_b128 v[80:83], v4 offset:29696
  v_smfmac_f32_16x16x64_bf16 v[92:95], v[68:71], a[240:247], v0
  ds_read_b128 v[60:63], v4 offset:26624
  v_smfmac_f32_16x16x64_bf16 v[96:99], v[104:107], a[200:207], v0
  ds_read_b128 v[64:67], v4 offset:27648
  v_smfmac_f32_16x16x64_bf16 v[96:99], v[108:111], a[232:239], v0
  ds_read_b128 v[28:31], v4 offset:30720
  s_nop 0
  v_cvt_pk_bf16_f32 v16, v92, v93
  v_cvt_pk_bf16_f32 v17, v94, v95
  v_bfi_b32 v16, 1, s57, v16
  v_smfmac_f32_16x16x64_bf16 v[96:99], v[68:71], a[248:255], v0
  buffer_store_dwordx2 v[16:17], v7, s[4:7], s20 offen offset:0
  v_smfmac_f32_16x16x64_bf16 v[36:39], v[104:107], a[208:215], v0
  ds_read_b128 v[32:35], v4 offset:31744
  v_smfmac_f32_16x16x64_bf16 v[36:39], v[108:111], v[52:59], v0
  s_waitcnt lgkmcnt(4)
  s_nop 0
  v_cvt_pk_bf16_f32 v18, v96, v97
  v_cvt_pk_bf16_f32 v19, v98, v99
  v_bfi_b32 v18, 1, s57, v18
  v_smfmac_f32_16x16x64_bf16 v[36:39], v[68:71], v[76:83], v0
  buffer_store_dwordx2 v[18:19], v7, s[4:7], s20 offen offset:64
  v_smfmac_f32_16x16x64_bf16 v[40:43], v[104:107], a[216:223], v0
  s_waitcnt lgkmcnt(2)
  ds_read_b128 v[116:119], v2 offset:31232
  v_smfmac_f32_16x16x64_bf16 v[40:43], v[108:111], v[60:67], v0
  s_waitcnt lgkmcnt(1)
  s_nop 0
  v_cvt_pk_bf16_f32 v20, v36, v37
  v_cvt_pk_bf16_f32 v21, v38, v39
  v_bfi_b32 v20, 1, s57, v20
  v_smfmac_f32_16x16x64_bf16 v[40:43], v[68:71], v[28:35], v0
  buffer_store_dwordx2 v[20:21], v7, s[4:7], s21 offen offset:0
  s_nop 6
  v_cvt_pk_bf16_f32 v22, v40, v41
  v_cvt_pk_bf16_f32 v23, v42, v43
  v_bfi_b32 v22, 1, s57, v22
  buffer_store_dwordx2 v[22:23], v7, s[4:7], s21 offen offset:64
  ds_read_b128 v[68:71], v4 offset:0
  ds_read_b128 v[72:75], v4 offset:1024
  ds_read_b128 v[76:79], v4 offset:4096
  ds_read_b128 v[80:83], v4 offset:5120
  ds_read_b128 v[84:87], v4 offset:8192
  ds_read_b128 v[88:91], v4 offset:9216
  ds_read_b128 v[92:95], v4 offset:2048
  ds_read_b128 v[96:99], v4 offset:3072
  ds_read_b128 v[100:103], v4 offset:6144
  ds_read_b128 v[104:107], v4 offset:7168
  ds_read_b128 v[108:111], v4 offset:10240
  ds_read_b128 v[112:115], v4 offset:11264
  v_mov_b64 v[16:17], 0
  v_mov_b64 v[18:19], 0
  v_mov_b64 v[20:21], 0
  v_mov_b64 v[22:23], 0
  v_mov_b64 v[24:25], 0
  v_mov_b64 v[26:27], 0
  s_mov_b32 s19, 0
  v_mov_b32 v49, -1
  ds_read_b64 v[44:45], v2 offset:32256
  s_waitcnt lgkmcnt(0)
  v_readfirstlane_b32 s38, v44
  v_readfirstlane_b32 s37, v45
  s_nop 0
  s_add_u32 s37, s37, 30
  s_cmp_ge_u32 s38, 30
  s_cselect_b32 s38, s37, s38
  s_cmp_ge_u32 s38, 64
  s_cselect_b32 s38, 100, s38
  s_sub_u32 s38, s38, 1
  s_max_i32 s30, s30, s38
  s_waitcnt vmcnt(0)
  buffer_load_dwordx4 v[52:55], v2, s[4:7], s22 offen offset:0 sc1
  buffer_load_dwordx4 v[56:59], v2, s[4:7], s22 offen offset:1024 sc1
  buffer_load_dwordx4 v[60:63], v2, s[4:7], s22 offen offset:2048 sc1
  buffer_load_dwordx4 v[64:67], v2, s[4:7], s22 offen offset:3072 sc1
  s_waitcnt lgkmcnt(12)
  s_waitcnt vmcnt(3)
  v_mfma_f32_16x16x32_bf16 v[120:123], v[116:119], v[52:55], 0
  v_xor_b32 v48, s57, v52
  v_bitop3_b32 v48, v48, v54, s57 bitop3:0xf6
  s_waitcnt vmcnt(2)
  v_mfma_f32_16x16x32_bf16 v[120:123], v[116:119], v[56:59], v[120:123]
  v_bitop3_b32 v48, v48, v56, s57 bitop3:0xf6
  v_bitop3_b32 v48, v48, v58, s57 bitop3:0xf6
  s_waitcnt vmcnt(1)
  v_mfma_f32_16x16x32_bf16 v[120:123], v[116:119], v[60:63], v[120:123]
  v_bitop3_b32 v48, v48, v60, s57 bitop3:0xf6
  v_bitop3_b32 v48, v48, v62, s57 bitop3:0xf6
  s_waitcnt vmcnt(0)
  v_mfma_f32_16x16x32_bf16 v[120:123], v[116:119], v[64:67], v[120:123]
  v_bitop3_b32 v48, v48, v64, s57 bitop3:0xf6
  v_bitop3_b32 v48, v48, v66, s57 bitop3:0xf6
  v_and_b32 v48, 1, v48
  v_cmp_ne_u32 vcc, 0, v48
  s_cbranch_vccnz T_p1re_105
T_p1ok_106:
  s_nop 2
  v_add_f32_dpp v120, v120, v120 row_ror:8 row_mask:0xf bank_mask:0xf
  v_add_f32_dpp v121, v121, v121 row_ror:8 row_mask:0xf bank_mask:0xf
  v_cvt_pk_bf16_f32 v48, v120, v121
  v_min_u32 v48, -2, v48
  buffer_store_dword v48, v8, s[4:7], s35 offen
  buffer_store_dword v49, v8, s[4:7], s26 offen
  s_barrier
  ds_read_b128 v[28:31], v2 offset:17408
  ds_read_b128 v[32:35], v2 offset:21504
  ds_read_b128 v[36:39], v2 offset:8192
  ds_read_b128 v[40:43], v2 offset:9216
  ds_read_b128 v[44:47], v2 offset:10240
  ds_read_b128 v[48:51], v2 offset:11264
  buffer_load_dwordx4 v[124:127], v3, s[4:7], s24 offen offset:1024 sc1
  buffer_load_dwordx4 v[116:119], v3, s[4:7], s25 offen offset:1024 sc1
  ds_read_b128 v[52:55], v2 offset:12288
  ds_read_b128 v[56:59], v2 offset:13312
  ds_read_b128 v[60:63], v2 offset:14336
  ds_read_b128 v[64:67], v2 offset:15360
  buffer_load_dwordx4 v[124:127], v3, s[4:7], s24 offen offset:1024 sc1
  buffer_load_dwordx4 v[116:119], v3, s[4:7], s25 offen offset:1024 sc1
  s_mov_b32 s19, 0
  s_branch T_loop_95
T_p1re_105:
  s_mov_b64 exec, vcc
  buffer_load_dwordx4 v[52:55], v2, s[4:7], s22 offen offset:0 sc1
  buffer_load_dwordx4 v[56:59], v2, s[4:7], s22 offen offset:1024 sc1
  buffer_load_dwordx4 v[60:63], v2, s[4:7], s22 offen offset:2048 sc1
  buffer_load_dwordx4 v[64:67], v2, s[4:7], s22 offen offset:3072 sc1
  s_mov_b64 exec, -1
  s_add_u32 s19, s19, 1
  s_cmp_gt_u32 s19, 32768
  s_cbranch_scc1 M_exit
  s_waitcnt vmcnt(3)
  v_mfma_f32_16x16x32_bf16 v[120:123], v[116:119], v[52:55], 0
  v_xor_b32 v48, s57, v52
  v_bitop3_b32 v48, v48, v54, s57 bitop3:0xf6
  s_waitcnt vmcnt(2)
  v_mfma_f32_16x16x32_bf16 v[120:123], v[116:119], v[56:59], v[120:123]
  v_bitop3_b32 v48, v48, v56, s57 bitop3:0xf6
  v_bitop3_b32 v48, v48, v58, s57 bitop3:0xf6
  s_waitcnt vmcnt(1)
  v_mfma_f32_16x16x32_bf16 v[120:123], v[116:119], v[60:63], v[120:123]
  v_bitop3_b32 v48, v48, v60, s57 bitop3:0xf6
  v_bitop3_b32 v48, v48, v62, s57 bitop3:0xf6
  s_waitcnt vmcnt(0)
  v_mfma_f32_16x16x32_bf16 v[120:123], v[116:119], v[64:67], v[120:123]
  v_bitop3_b32 v48, v48, v64, s57 bitop3:0xf6
  v_bitop3_b32 v48, v48, v66, s57 bitop3:0xf6
  v_and_b32 v48, 1, v48
  v_cmp_ne_u32 vcc, 0, v48
  s_cbranch_vccnz T_p1re_105
  s_branch T_p1ok_106
T_kvw_99:
  s_mov_b32 s19, 0
  s_branch T_kvok_108
T_kv_107:
  s_sleep 4
  s_add_u32 s19, s19, 1
  s_cmp_gt_u32 s19, 32768
  s_cbranch_scc1 M_exit
T_kvok_108:
  s_add_u32 s39, s99, 128
  s_mov_b32 s38, 0
  s_mov_b32 s37, 0
  s_atomic_or s38, s[58:59], s99 glc
  s_atomic_or s37, s[58:59], s39 glc
  s_waitcnt lgkmcnt(0)
  s_add_u32 s37, s37, 30
  s_cmp_ge_u32 s38, 30
  s_cselect_b32 s38, s37, s38
  s_cmp_ge_u32 s38, 64
  s_cselect_b32 s38, 100, s38
  s_sub_u32 s38, s38, 1
  s_max_i32 s30, s30, s38
  s_cmp_ge_i32 s14, s30
  s_cbranch_scc1 T_kv_107
  s_branch T_kvb_100
T_slow_102:
  s_nop 7
  v_max3_f32 v100, v16, v17, v18
  v_max3_f32 v100, v100, v19, v20
  v_max3_f32 v100, v100, v21, v22
  v_max3_f32 v100, v100, v23, v112
  v_max3_f32 v100, v100, v113, v114
  v_max_f32 v100, v100, v115
  v_mov_b32 v101, v100
  s_nop 1
  v_permlane32_swap_b32 v100, v101
  s_nop 1
  v_max_f32 v100, v100, v101
  v_mov_b32 v101, v100
  s_nop 1
  v_permlane16_swap_b32 v100, v101
  s_nop 1
  v_max_f32 v100, v100, v101
  v_sub_f32 v16, v16, v100
  v_sub_f32 v17, v17, v100
  v_sub_f32 v18, v18, v100
  v_sub_f32 v19, v19, v100
  v_exp_f32 v16, v16
  v_exp_f32 v17, v17
  v_exp_f32 v18, v18
  v_exp_f32 v19, v19
  v_sub_f32 v20, v20, v100
  v_sub_f32 v21, v21, v100
  v_sub_f32 v22, v22, v100
  v_sub_f32 v23, v23, v100
  v_exp_f32 v20, v20
  v_exp_f32 v21, v21
  v_exp_f32 v22, v22
  v_exp_f32 v23, v23
  v_sub_f32 v112, v112, v100
  v_sub_f32 v113, v113, v100
  v_sub_f32 v114, v114, v100
  v_sub_f32 v115, v115, v100
  v_exp_f32 v112, v112
  v_exp_f32 v113, v113
  v_exp_f32 v114, v114
  v_exp_f32 v115, v115
  s_nop 0
  v_cvt_pk_bf16_f32 v44, v16, v17
  v_cvt_pk_bf16_f32 v45, v18, v19
  v_cvt_pk_bf16_f32 v46, v20, v21
  v_cvt_pk_bf16_f32 v47, v22, v23
  v_cvt_pk_bf16_f32 v84, v112, v113
  v_cvt_pk_bf16_f32 v85, v114, v115
  v_cndmask_b32 v48, v84, 0, s[16:17]
  v_cndmask_b32 v49, v85, 0, s[16:17]
  v_cndmask_b32 v50, 0, v84, s[16:17]
  v_cndmask_b32 v51, 0, v85, s[16:17]
  s_nop 1
  v_mfma_f32_16x16x16_bf16 v[88:91], v[12:13], v[48:49], 0
  v_mfma_f32_16x16x16_bf16 v[24:27], v[120:121], v[48:49], 0
  v_mfma_f32_16x16x16_bf16 v[116:119], v[120:121], v[50:51], 0
  v_mfma_f32_16x16x32_bf16 v[88:91], v[12:15], v[44:47], v[88:91]
  v_mfma_f32_16x16x32_bf16 v[24:27], v[28:31], v[44:47], v[24:27]
  v_mfma_f32_16x16x32_bf16 v[116:119], v[32:35], v[44:47], v[116:119]
  s_nop 7
  s_nop 1
  v_rcp_f32 v89, v88
  s_nop 0
  v_mul_f32 v24, v89, v24
  v_mul_f32 v25, v89, v25
  s_branch T_back_103
T_w_79:
  s_mov_b32 s19, 0
  v_mov_b64 v[16:17], 0
  v_mov_b64 v[18:19], 0
  v_mov_b64 v[20:21], 0
  v_mov_b64 v[22:23], 0
  v_mov_b64 v[24:25], 0
  v_mov_b64 v[26:27], 0
  buffer_load_dwordx4 v[124:127], v3, s[4:7], s24 offen offset:2048 sc1
  buffer_load_dwordx4 v[116:119], v3, s[4:7], s25 offen offset:2048 sc1
  buffer_load_dwordx4 v[124:127], v3, s[4:7], s24 offen offset:2048 sc1
  buffer_load_dwordx4 v[116:119], v3, s[4:7], s25 offen offset:2048 sc1
  s_branch T_loop_109
.p2align 6
T_retry_110:
  s_mov_b64 exec, vcc
  buffer_load_dwordx4 v[124:127], v3, s[4:7], s24 offen offset:2048 sc1
  buffer_load_dwordx4 v[116:119], v3, s[4:7], s25 offen offset:2048 sc1
  s_mov_b64 exec, -1
  s_add_u32 s19, s19, 1
  s_cmp_gt_u32 s19, 32768
  s_cbranch_scc1 M_exit
T_loop_109:
  s_waitcnt vmcnt(3) lgkmcnt(0)
  v_max3_u32 v123, v124, v125, v126
  v_max_u32 v123, v123, v127
  v_mov_b32_dpp v120, v124 row_ror:8 row_mask:0xf bank_mask:0xf
  v_mov_b32_dpp v121, v125 row_ror:8 row_mask:0xf bank_mask:0xf
  s_waitcnt vmcnt(2)
  v_max3_u32 v123, v123, v116, v117
  v_max3_u32 v123, v123, v118, v119
  v_cmp_eq_u32 vcc, -1, v123
  s_cbranch_vccnz T_retry_110
  v_smfmac_f32_16x16x64_bf16 v[16:19], v[124:127], v[68:75], v0
  s_add_u32 s14, s14, 1
  ds_write_b128 v2, v[124:127] offset:2048
  v_mov_b32_dpp v122, v126 row_ror:8 row_mask:0xf bank_mask:0xf
  v_smfmac_f32_16x16x64_bf16 v[20:23], v[124:127], v[76:83], v0
  s_and_b32 s57, s14, 1
  v_mov_b32_dpp v123, v127 row_ror:8 row_mask:0xf bank_mask:0xf
  v_smfmac_f32_16x16x64_bf16 v[24:27], v[124:127], v[84:91], v0
  s_and_b32 s36, s14, 3
  ds_write_b128 v2, v[116:119] offset:6144
  v_smfmac_f32_16x16x64_bf16 v[16:19], v[120:123], v[92:99], v0
  s_lshl_b32 s36, s36, 13
  v_mov_b32_dpp v84, v116 row_ror:8 row_mask:0xf bank_mask:0xf
  v_smfmac_f32_16x16x64_bf16 v[20:23], v[120:123], v[100:107], v0
  s_add_u32 s26, s36, s23
  ds_read_b128 v[68:71], v4 offset:12288
  v_mov_b32_dpp v85, v117 row_ror:8 row_mask:0xf bank_mask:0xf
  v_smfmac_f32_16x16x64_bf16 v[24:27], v[120:123], v[108:115], v0
  s_add_u32 s36, s36, 8192
  ds_read_b128 v[72:75], v4 offset:13312
  v_mov_b32_dpp v86, v118 row_ror:8 row_mask:0xf bank_mask:0xf
  v_smfmac_f32_16x16x64_bf16 v[16:19], v[116:119], v[224:231], v0
  s_and_b32 s36, s36, 0x7fff
  ds_read_b128 v[76:79], v4 offset:14336
  v_mov_b32_dpp v87, v119 row_ror:8 row_mask:0xf bank_mask:0xf
  v_smfmac_f32_16x16x64_bf16 v[20:23], v[116:119], v[240:247], v0
  s_waitcnt lgkmcnt(3)
  s_barrier
  ds_read_b128 v[100:103], v2 offset:3072
  v_smfmac_f32_16x16x64_bf16 v[24:27], v[116:119], a[0:7], v0
  s_mov_b32 m0, s31
  ds_read_b128 v[120:123], v1 offset:3072
  v_smfmac_f32_16x16x64_bf16 v[16:19], v[84:87], v[232:239], v0
  s_cmp_ge_i32 s14, s30
  s_cbranch_scc1 T_kvw_113
T_kvb_114:
  v_smfmac_f32_16x16x64_bf16 v[20:23], v[84:87], v[248:255], v0
  ds_read_b128 v[80:83], v4 offset:15360
  v_smfmac_f32_16x16x64_bf16 v[24:27], v[84:87], a[8:15], v0
  s_waitcnt lgkmcnt(2)
  v_smfmac_f32_16x16x64_bf16 v[16:19], v[100:103], v[128:135], v0
  ds_read_b128 v[92:95], v2 offset:0
  buffer_load_dwordx4 v9, s[4:7], s27 offen sc1 lds
  v_smfmac_f32_16x16x64_bf16 v[20:23], v[100:103], v[144:151], v0
  ds_read_b128 v[96:99], v1 offset:0
  s_mov_b32 m0, s32
  v_smfmac_f32_16x16x64_bf16 v[24:27], v[100:103], v[68:75], v0
  s_waitcnt vmcnt(1) lgkmcnt(3)
  ds_read_b128 v[116:119], v2 offset:1024
  v_smfmac_f32_16x16x64_bf16 v[16:19], v[120:123], v[136:143], v0
  ds_read_b128 v[124:127], v1 offset:1024
  v_smfmac_f32_16x16x64_bf16 v[20:23], v[120:123], v[152:159], v0
  s_waitcnt lgkmcnt(4)
  ds_read_b128 v[104:107], v2 offset:7168
  buffer_load_dwordx4 v9, s[4:7], s27 offen offset:128 sc1 lds
  v_smfmac_f32_16x16x64_bf16 v[24:27], v[120:123], v[76:83], v0
  s_waitcnt lgkmcnt(4)
  ds_read_b128 v[108:111], v1 offset:7168
  s_mov_b32 m0, s33
  v_smfmac_f32_16x16x64_bf16 v[16:19], v[92:95], v[160:167], v0
  s_waitcnt lgkmcnt(4)
  ds_read_b128 v[112:115], v2 offset:4096
  v_mov_b32 v122, s98
  v_smfmac_f32_16x16x64_bf16 v[16:19], v[96:99], v[168:175], v0
  s_waitcnt lgkmcnt(4)
  ds_read_b128 v[84:87], v1 offset:4096
  v_smfmac_f32_16x16x64_bf16 v[16:19], v[116:119], v[192:199], v0
  s_waitcnt lgkmcnt(4)
  ds_read_b128 v[88:91], v2 offset:5120
  buffer_load_dwordx4 v10, s[4:7], s28 offen sc1 lds
  v_smfmac_f32_16x16x64_bf16 v[16:19], v[124:127], v[200:207], v0
  s_waitcnt lgkmcnt(4)
  ds_read_b128 v[100:103], v1 offset:5120
  s_mov_b32 m0, s34
  v_smfmac_f32_16x16x64_bf16 v[16:19], v[104:107], a[16:23], v0
  s_waitcnt lgkmcnt(4)
  ds_read_b128 v[68:71], v4 offset:16384
  v_smfmac_f32_16x16x64_bf16 v[16:19], v[108:111], a[24:31], v0
  s_waitcnt lgkmcnt(4)
  ds_read_b128 v[72:75], v4 offset:17408
  v_smfmac_f32_16x16x64_bf16 v[16:19], v[112:115], a[64:71], v0
  s_waitcnt lgkmcnt(4)
  ds_read_b128 v[76:79], v4 offset:18432
  buffer_load_dwordx4 v10, s[4:7], s28 offen offset:256 sc1 lds
  v_smfmac_f32_16x16x64_bf16 v[16:19], v[84:87], a[72:79], v0
  s_waitcnt lgkmcnt(4)
  ds_read_b128 v[80:83], v4 offset:19456
  v_smfmac_f32_16x16x64_bf16 v[16:19], v[88:91], a[112:119], v0
  s_waitcnt lgkmcnt(4)
  v_smfmac_f32_16x16x64_bf16 v[16:19], v[100:103], a[120:127], v0
  s_add_u32 s24, s36, 145752064
  s_add_u32 s25, s36, 145756160
  v_smfmac_f32_16x16x64_bf16 v[20:23], v[92:95], v[176:183], v0
  buffer_store_dword v122, v8, s[4:7], s15 offen sc1
  s_add_u32 s35, s36, s23
  v_smfmac_f32_16x16x64_bf16 v[20:23], v[96:99], v[184:191], v0
  s_waitcnt lgkmcnt(2)
  s_add_u32 s98, s14, 1
  v_smfmac_f32_16x16x64_bf16 v[20:23], v[116:119], v[68:75], v0
  s_waitcnt lgkmcnt(0)
  ds_read_b128 v[68:71], v4 offset:20480
  v_mul_f32 v16, s18, v16
  v_smfmac_f32_16x16x64_bf16 v[20:23], v[124:127], v[76:83], v0
  ds_read_b128 v[72:75], v4 offset:21504
  v_mul_f32 v17, s18, v17
  v_smfmac_f32_16x16x64_bf16 v[20:23], v[104:107], a[32:39], v0
  ds_read_b128 v[76:79], v4 offset:22528
  v_mul_f32 v18, s18, v18
  v_smfmac_f32_16x16x64_bf16 v[20:23], v[108:111], a[40:47], v0
  ds_read_b128 v[80:83], v4 offset:23552
  v_mul_f32 v19, s18, v19
  v_smfmac_f32_16x16x64_bf16 v[20:23], v[112:115], a[80:87], v0
  v_cvt_pk_bf16_f32 v120, v16, v17
  v_smfmac_f32_16x16x64_bf16 v[20:23], v[84:87], a[88:95], v0
  v_cvt_pk_bf16_f32 v121, v18, v19
  v_smfmac_f32_16x16x64_bf16 v[20:23], v[88:91], a[128:135], v0
  ds_write_b64 v5, v[120:121] offset:24576
  v_smfmac_f32_16x16x64_bf16 v[20:23], v[100:103], a[136:143], v0
  s_waitcnt lgkmcnt(3)
  v_smfmac_f32_16x16x64_bf16 v[24:27], v[92:95], v[68:75], v0
  s_waitcnt lgkmcnt(1)
  v_mov_b64 v[92:93], 0
  v_smfmac_f32_16x16x64_bf16 v[24:27], v[96:99], v[76:83], v0
  s_nop 1
  v_cvt_pk_bf16_f32 v122, v20, v21
  v_cvt_pk_bf16_f32 v123, v22, v23
  v_smfmac_f32_16x16x64_bf16 v[24:27], v[116:119], v[208:215], v0
  ds_write_b64 v5, v[122:123] offset:26880
  v_mov_b64 v[94:95], 0
  v_smfmac_f32_16x16x64_bf16 v[24:27], v[124:127], v[216:223], v0
  s_waitcnt lgkmcnt(1)
  s_barrier
  ds_read_b64_tr_b16 v[68:69], v6 offset:24576
  v_smfmac_f32_16x16x64_bf16 v[24:27], v[104:107], a[48:55], v0
  s_add_u32 s27, s27, 8192
  ds_read_b64_tr_b16 v[70:71], v6 offset:24640
  ds_read_b64_tr_b16 v[72:73], v6 offset:24832
  v_smfmac_f32_16x16x64_bf16 v[24:27], v[108:111], a[56:63], v0
  s_add_u32 s28, s28, 8192
  ds_read_b64_tr_b16 v[74:75], v6 offset:24896
  ds_read_b64_tr_b16 v[76:77], v6 offset:25088
  v_smfmac_f32_16x16x64_bf16 v[24:27], v[112:115], a[96:103], v0
  s_nop 0
  ds_read_b64_tr_b16 v[78:79], v6 offset:25152
  ds_read_b64_tr_b16 v[80:81], v6 offset:25344
  v_smfmac_f32_16x16x64_bf16 v[24:27], v[84:87], a[104:111], v0
  ds_read_b64_tr_b16 v[82:83], v6 offset:25408
  v_mov_b64 v[96:97], 0
  v_smfmac_f32_16x16x64_bf16 v[24:27], v[88:91], a[144:151], v0
  s_waitcnt lgkmcnt(8)
  s_barrier
  ds_read_b64_tr_b16 v[116:117], v6 offset:26880
  v_smfmac_f32_16x16x64_bf16 v[24:27], v[100:103], a[152:159], v0
  s_waitcnt lgkmcnt(7)
  ds_read_b64_tr_b16 v[118:119], v6 offset:26944
  v_mfma_f32_16x16x32_bf16 v[16:19], v[36:39], v[68:71], 0
  s_waitcnt lgkmcnt(6)
  ds_read_b64_tr_b16 v[124:125], v6 offset:27136
  ds_read_b64_tr_b16 v[126:127], v6 offset:27200
  v_mfma_f32_16x16x32_bf16 v[16:19], v[40:43], v[72:75], v[16:19]
  s_waitcnt lgkmcnt(6)
  ds_read_b64_tr_b16 v[104:105], v6 offset:27392
  ds_read_b64_tr_b16 v[106:107], v6 offset:27456
  v_mfma_f32_16x16x32_bf16 v[16:19], v[44:47], v[76:79], v[16:19]
  s_waitcnt lgkmcnt(6)
  ds_read_b64_tr_b16 v[108:109], v6 offset:27648
  ds_read_b64_tr_b16 v[110:111], v6 offset:27712
  v_mfma_f32_16x16x32_bf16 v[16:19], v[48:51], v[80:83], v[16:19]
  s_waitcnt lgkmcnt(6)
  v_cvt_pk_bf16_f32 v120, v24, v25
  v_cvt_pk_bf16_f32 v121, v26, v27
  v_mfma_f32_16x16x32_bf16 v[112:115], v[116:119], v[68:71], 0
  s_waitcnt lgkmcnt(4)
  buffer_store_dwordx4 v[120:123], v2, s[4:7], s29 offen offset:2048 sc1
  v_mov_b64 v[98:99], 0
  v_mfma_f32_16x16x32_bf16 v[112:115], v[124:127], v[72:75], v[112:115]
  s_waitcnt lgkmcnt(2)
  v_mov_b64 v[36:37], 0
  v_exp_f32 v100, v16
  v_mfma_f32_16x16x32_bf16 v[112:115], v[104:107], v[76:79], v[112:115]
  s_waitcnt lgkmcnt(0)
  v_exp_f32 v101, v17
  v_mfma_f32_16x16x32_bf16 v[112:115], v[108:111], v[80:83], v[112:115]
  s_add_u32 s29, s29, 131072
  v_exp_f32 v102, v18
  v_mfma_f32_16x16x32_bf16 v[20:23], v[52:55], v[68:71], 0
  s_cmp_eq_u32 s14, 63
  v_exp_f32 v103, v19
  v_mfma_f32_16x16x32_bf16 v[20:23], v[56:59], v[72:75], v[20:23]
  s_cbranch_scc1 M_tdone
  v_cvt_pk_bf16_f32 v44, v100, v101
  v_cvt_pk_bf16_f32 v45, v102, v103
  v_mfma_f32_16x16x32_bf16 v[20:23], v[60:63], v[76:79], v[20:23]
  v_exp_f32 v100, v112
  v_mfma_f32_16x16x32_bf16 v[20:23], v[64:67], v[80:83], v[20:23]
  v_exp_f32 v101, v113
  v_exp_f32 v102, v114
  v_exp_f32 v103, v115
  v_cvt_pk_bf16_f32 v84, v100, v101
  v_cvt_pk_bf16_f32 v85, v102, v103
  v_cndmask_b32 v48, v84, 0, s[16:17]
  v_cndmask_b32 v49, v85, 0, s[16:17]
  v_cndmask_b32 v50, 0, v84, s[16:17]
  v_cndmask_b32 v51, 0, v85, s[16:17]
  v_exp_f32 v100, v20
  v_mfma_f32_16x16x16_bf16 v[88:91], v[12:13], v[48:49], 0
  v_exp_f32 v101, v21
  v_mfma_f32_16x16x16_bf16 v[24:27], v[120:121], v[48:49], 0
  v_exp_f32 v102, v22
  v_mfma_f32_16x16x16_bf16 v[116:119], v[120:121], v[50:51], 0
  v_exp_f32 v103, v23
  v_cvt_pk_bf16_f32 v46, v100, v101
  v_cvt_pk_bf16_f32 v47, v102, v103
  v_mov_b64 v[38:39], 0
  s_nop 0
  v_mfma_f32_16x16x32_bf16 v[88:91], v[12:15], v[44:47], v[88:91]
  v_mov_b64 v[40:41], 0
  v_mov_b64 v[42:43], 0
  v_mfma_f32_16x16x32_bf16 v[24:27], v[28:31], v[44:47], v[24:27]
  ds_read_b128 v[52:55], v4 offset:24576
  ds_read_b128 v[56:59], v4 offset:25600
  v_mfma_f32_16x16x32_bf16 v[116:119], v[32:35], v[44:47], v[116:119]
  s_nop 1
  v_rcp_f32 v89, v88
  v_subrev_u32 v100, s54, v88
  v_cmp_le_u32 vcc, s55, v100
  v_mul_f32 v24, v89, v24
  v_mul_f32 v25, v89, v25
  s_cbranch_vccnz T_slow_116
T_back_117:
  v_cvt_pk_bf16_f32 v124, v24, v25
  v_pk_mul_f32 v[26:27], v[26:27], v[88:89] op_sel:[0,1] op_sel_hi:[1,1]
  v_pk_mul_f32 v[116:117], v[116:117], v[88:89] op_sel:[0,1] op_sel_hi:[1,1]
  v_pk_mul_f32 v[118:119], v[118:119], v[88:89] op_sel:[0,1] op_sel_hi:[1,1]
  v_cvt_pk_bf16_f32 v125, v26, v27
  v_cvt_pk_bf16_f32 v126, v116, v117
  v_cvt_pk_bf16_f32 v127, v118, v119
  ds_write_b128 v11, v[124:127] offset:30208
  s_nop 0
  v_smfmac_f32_16x16x64_bf16 v[92:95], v[124:127], a[160:167], v0
  v_smfmac_f32_16x16x64_bf16 v[96:99], v[124:127], a[168:175], v0
  v_smfmac_f32_16x16x64_bf16 v[36:39], v[124:127], a[176:183], v0
  v_smfmac_f32_16x16x64_bf16 v[40:43], v[124:127], a[184:191], v0
  s_waitcnt lgkmcnt(0)
  s_barrier
  ds_read_b128 v[104:107], v11 offset:30720
  ds_read_b128 v[108:111], v11 offset:29184
  ds_read_b128 v[68:71], v11 offset:29696
  s_waitcnt lgkmcnt(2)
  v_smfmac_f32_16x16x64_bf16 v[92:95], v[104:107], a[192:199], v0
  s_waitcnt lgkmcnt(1)
  ds_read_b128 v[76:79], v4 offset:28672
  v_smfmac_f32_16x16x64_bf16 v[92:95], v[108:111], a[224:231], v0
  s_waitcnt lgkmcnt(1)
  ds_read_b128 v[80:83], v4 offset:29696
  v_smfmac_f32_16x16x64_bf16 v[92:95], v[68:71], a[240:247], v0
  ds_read_b128 v[60:63], v4 offset:26624
  v_smfmac_f32_16x16x64_bf16 v[96:99], v[104:107], a[200:207], v0
  ds_read_b128 v[64:67], v4 offset:27648
  v_smfmac_f32_16x16x64_bf16 v[96:99], v[108:111], a[232:239], v0
  ds_read_b128 v[28:31], v4 offset:30720
  s_nop 0
  v_cvt_pk_bf16_f32 v16, v92, v93
  v_cvt_pk_bf16_f32 v17, v94, v95
  v_bfi_b32 v16, 1, s57, v16
  v_smfmac_f32_16x16x64_bf16 v[96:99], v[68:71], a[248:255], v0
  buffer_store_dwordx2 v[16:17], v7, s[4:7], s20 offen offset:0
  v_smfmac_f32_16x16x64_bf16 v[36:39], v[104:107], a[208:215], v0
  ds_read_b128 v[32:35], v4 offset:31744
  v_smfmac_f32_16x16x64_bf16 v[36:39], v[108:111], v[52:59], v0
  s_waitcnt lgkmcnt(4)
  s_nop 0
  v_cvt_pk_bf16_f32 v18, v96, v97
  v_cvt_pk_bf16_f32 v19, v98, v99
  v_bfi_b32 v18, 1, s57, v18
  v_smfmac_f32_16x16x64_bf16 v[36:39], v[68:71], v[76:83], v0
  buffer_store_dwordx2 v[18:19], v7, s[4:7], s20 offen offset:64
  v_smfmac_f32_16x16x64_bf16 v[40:43], v[104:107], a[216:223], v0
  s_waitcnt lgkmcnt(2)
  v_smfmac_f32_16x16x64_bf16 v[40:43], v[108:111], v[60:67], v0
  s_waitcnt lgkmcnt(0)
  s_nop 0
  v_cvt_pk_bf16_f32 v20, v36, v37
  v_cvt_pk_bf16_f32 v21, v38, v39
  v_bfi_b32 v20, 1, s57, v20
  v_smfmac_f32_16x16x64_bf16 v[40:43], v[68:71], v[28:35], v0
  buffer_store_dwordx2 v[20:21], v7, s[4:7], s21 offen offset:0
  s_nop 6
  v_cvt_pk_bf16_f32 v22, v40, v41
  v_cvt_pk_bf16_f32 v23, v42, v43
  v_bfi_b32 v22, 1, s57, v22
  buffer_store_dwordx2 v[22:23], v7, s[4:7], s21 offen offset:64
  ds_read_b128 v[68:71], v4 offset:0
  ds_read_b128 v[72:75], v4 offset:1024
  ds_read_b128 v[76:79], v4 offset:4096
  ds_read_b128 v[80:83], v4 offset:5120
  ds_read_b128 v[84:87], v4 offset:8192
  ds_read_b128 v[88:91], v4 offset:9216
  ds_read_b128 v[92:95], v4 offset:2048
  ds_read_b128 v[96:99], v4 offset:3072
  ds_read_b128 v[100:103], v4 offset:6144
  ds_read_b128 v[104:107], v4 offset:7168
  ds_read_b128 v[108:111], v4 offset:10240
  ds_read_b128 v[112:115], v4 offset:11264
  v_mov_b64 v[16:17], 0
  v_mov_b64 v[18:19], 0
  v_mov_b64 v[20:21], 0
  v_mov_b64 v[22:23], 0
  v_mov_b64 v[24:25], 0
  v_mov_b64 v[26:27], 0
  ds_read_b64 v[44:45], v2 offset:32256
  s_waitcnt lgkmcnt(0)
  v_readfirstlane_b32 s38, v44
  v_readfirstlane_b32 s37, v45
  s_nop 0
  s_add_u32 s37, s37, 30
  s_cmp_ge_u32 s38, 30
  s_cselect_b32 s38, s37, s38
  s_cmp_ge_u32 s38, 64
  s_cselect_b32 s38, 100, s38
  s_sub_u32 s38, s38, 1
  s_max_i32 s30, s30, s38
  s_waitcnt vmcnt(4)
  s_barrier
  ds_read_b128 v[28:31], v2 offset:18432
  ds_read_b128 v[32:35], v2 offset:22528
  ds_read_b128 v[36:39], v2 offset:8192
  ds_read_b128 v[40:43], v2 offset:9216
  ds_read_b128 v[44:47], v2 offset:10240
  ds_read_b128 v[48:51], v2 offset:11264
  buffer_load_dwordx4 v[124:127], v3, s[4:7], s24 offen offset:2048 sc1
  buffer_load_dwordx4 v[116:119], v3, s[4:7], s25 offen offset:2048 sc1
  ds_read_b128 v[52:55], v2 offset:12288
  ds_read_b128 v[56:59], v2 offset:13312
  ds_read_b128 v[60:63], v2 offset:14336
  ds_read_b128 v[64:67], v2 offset:15360
  buffer_load_dwordx4 v[124:127], v3, s[4:7], s24 offen offset:2048 sc1
  buffer_load_dwordx4 v[116:119], v3, s[4:7], s25 offen offset:2048 sc1
  s_mov_b32 s19, 0
  s_branch T_loop_109
T_kvw_113:
  s_mov_b32 s19, 0
  s_branch T_kvok_122
T_kv_121:
  s_sleep 4
  s_add_u32 s19, s19, 1
  s_cmp_gt_u32 s19, 32768
  s_cbranch_scc1 M_exit
T_kvok_122:
  s_add_u32 s39, s99, 128
  s_mov_b32 s38, 0
  s_mov_b32 s37, 0
  s_atomic_or s38, s[58:59], s99 glc
  s_atomic_or s37, s[58:59], s39 glc
  s_waitcnt lgkmcnt(0)
  s_add_u32 s37, s37, 30
  s_cmp_ge_u32 s38, 30
  s_cselect_b32 s38, s37, s38
  s_cmp_ge_u32 s38, 64
  s_cselect_b32 s38, 100, s38
  s_sub_u32 s38, s38, 1
  s_max_i32 s30, s30, s38
  s_cmp_ge_i32 s14, s30
  s_cbranch_scc1 T_kv_121
  s_branch T_kvb_114
T_slow_116:
  s_nop 7
  v_max3_f32 v100, v16, v17, v18
  v_max3_f32 v100, v100, v19, v20
  v_max3_f32 v100, v100, v21, v22
  v_max3_f32 v100, v100, v23, v112
  v_max3_f32 v100, v100, v113, v114
  v_max_f32 v100, v100, v115
  v_mov_b32 v101, v100
  s_nop 1
  v_permlane32_swap_b32 v100, v101
  s_nop 1
  v_max_f32 v100, v100, v101
  v_mov_b32 v101, v100
  s_nop 1
  v_permlane16_swap_b32 v100, v101
  s_nop 1
  v_max_f32 v100, v100, v101
  v_sub_f32 v16, v16, v100
  v_sub_f32 v17, v17, v100
  v_sub_f32 v18, v18, v100
  v_sub_f32 v19, v19, v100
  v_exp_f32 v16, v16
  v_exp_f32 v17, v17
  v_exp_f32 v18, v18
  v_exp_f32 v19, v19
  v_sub_f32 v20, v20, v100
  v_sub_f32 v21, v21, v100
  v_sub_f32 v22, v22, v100
  v_sub_f32 v23, v23, v100
  v_exp_f32 v20, v20
  v_exp_f32 v21, v21
  v_exp_f32 v22, v22
  v_exp_f32 v23, v23
  v_sub_f32 v112, v112, v100
  v_sub_f32 v113, v113, v100
  v_sub_f32 v114, v114, v100
  v_sub_f32 v115, v115, v100
  v_exp_f32 v112, v112
  v_exp_f32 v113, v113
  v_exp_f32 v114, v114
  v_exp_f32 v115, v115
  s_nop 0
  v_cvt_pk_bf16_f32 v44, v16, v17
  v_cvt_pk_bf16_f32 v45, v18, v19
  v_cvt_pk_bf16_f32 v46, v20, v21
  v_cvt_pk_bf16_f32 v47, v22, v23
  v_cvt_pk_bf16_f32 v84, v112, v113
  v_cvt_pk_bf16_f32 v85, v114, v115
  v_cndmask_b32 v48, v84, 0, s[16:17]
  v_cndmask_b32 v49, v85, 0, s[16:17]
  v_cndmask_b32 v50, 0, v84, s[16:17]
  v_cndmask_b32 v51, 0, v85, s[16:17]
  s_nop 1
  v_mfma_f32_16x16x16_bf16 v[88:91], v[12:13], v[48:49], 0
  v_mfma_f32_16x16x16_bf16 v[24:27], v[120:121], v[48:49], 0
  v_mfma_f32_16x16x16_bf16 v[116:119], v[120:121], v[50:51], 0
  v_mfma_f32_16x16x32_bf16 v[88:91], v[12:15], v[44:47], v[88:91]
  v_mfma_f32_16x16x32_bf16 v[24:27], v[28:31], v[44:47], v[24:27]
  v_mfma_f32_16x16x32_bf16 v[116:119], v[32:35], v[44:47], v[116:119]
  s_nop 7
  s_nop 1
  v_rcp_f32 v89, v88
  s_nop 0
  v_mul_f32 v24, v89, v24
  v_mul_f32 v25, v89, v25
  s_branch T_back_117
T_w_80:
  s_mov_b32 s19, 0
  v_mov_b64 v[16:17], 0
  v_mov_b64 v[18:19], 0
  v_mov_b64 v[20:21], 0
  v_mov_b64 v[22:23], 0
  v_mov_b64 v[24:25], 0
  v_mov_b64 v[26:27], 0
  buffer_load_dwordx4 v[124:127], v3, s[4:7], s24 offen offset:3072 sc1
  buffer_load_dwordx4 v[116:119], v3, s[4:7], s25 offen offset:3072 sc1
  buffer_load_dwordx4 v[124:127], v3, s[4:7], s24 offen offset:3072 sc1
  buffer_load_dwordx4 v[116:119], v3, s[4:7], s25 offen offset:3072 sc1
  s_branch T_loop_123
.p2align 6
T_retry_124:
  s_mov_b64 exec, vcc
  buffer_load_dwordx4 v[124:127], v3, s[4:7], s24 offen offset:3072 sc1
  buffer_load_dwordx4 v[116:119], v3, s[4:7], s25 offen offset:3072 sc1
  s_mov_b64 exec, -1
  s_add_u32 s19, s19, 1
  s_cmp_gt_u32 s19, 32768
  s_cbranch_scc1 M_exit
T_loop_123:
  s_waitcnt vmcnt(3) lgkmcnt(0)
  v_max3_u32 v123, v124, v125, v126
  v_max_u32 v123, v123, v127
  v_mov_b32_dpp v120, v124 row_ror:8 row_mask:0xf bank_mask:0xf
  v_mov_b32_dpp v121, v125 row_ror:8 row_mask:0xf bank_mask:0xf
  s_waitcnt vmcnt(2)
  v_max3_u32 v123, v123, v116, v117
  v_max3_u32 v123, v123, v118, v119
  v_cmp_eq_u32 vcc, -1, v123
  s_cbranch_vccnz T_retry_124
  v_smfmac_f32_16x16x64_bf16 v[16:19], v[124:127], v[68:75], v0
  s_add_u32 s14, s14, 1
  ds_write_b128 v2, v[124:127] offset:3072
  v_mov_b32_dpp v122, v126 row_ror:8 row_mask:0xf bank_mask:0xf
  v_smfmac_f32_16x16x64_bf16 v[20:23], v[124:127], v[76:83], v0
  s_and_b32 s57, s14, 1
  v_mov_b32_dpp v123, v127 row_ror:8 row_mask:0xf bank_mask:0xf
  v_smfmac_f32_16x16x64_bf16 v[24:27], v[124:127], v[84:91], v0
  s_and_b32 s36, s14, 3
  ds_write_b128 v2, v[116:119] offset:7168
  v_smfmac_f32_16x16x64_bf16 v[16:19], v[120:123], v[92:99], v0
  s_lshl_b32 s36, s36, 13
  v_mov_b32_dpp v84, v116 row_ror:8 row_mask:0xf bank_mask:0xf
  v_smfmac_f32_16x16x64_bf16 v[20:23], v[120:123], v[100:107], v0
  s_add_u32 s26, s36, s23
  ds_read_b128 v[68:71], v4 offset:12288
  v_mov_b32_dpp v85, v117 row_ror:8 row_mask:0xf bank_mask:0xf
  v_smfmac_f32_16x16x64_bf16 v[24:27], v[120:123], v[108:115], v0
  s_add_u32 s36, s36, 8192
  ds_read_b128 v[72:75], v4 offset:13312
  v_mov_b32_dpp v86, v118 row_ror:8 row_mask:0xf bank_mask:0xf
  v_smfmac_f32_16x16x64_bf16 v[16:19], v[116:119], v[224:231], v0
  s_and_b32 s36, s36, 0x7fff
  ds_read_b128 v[76:79], v4 offset:14336
  v_mov_b32_dpp v87, v119 row_ror:8 row_mask:0xf bank_mask:0xf
  v_smfmac_f32_16x16x64_bf16 v[20:23], v[116:119], v[240:247], v0
  s_waitcnt lgkmcnt(3)
  s_barrier
  ds_read_b128 v[100:103], v2 offset:2048
  v_smfmac_f32_16x16x64_bf16 v[24:27], v[116:119], a[0:7], v0
  s_mov_b32 m0, s31
  ds_read_b128 v[120:123], v1 offset:2048
  v_smfmac_f32_16x16x64_bf16 v[16:19], v[84:87], v[232:239], v0
  s_cmp_ge_i32 s14, s30
  s_cbranch_scc1 T_kvw_127
T_kvb_128:
  v_smfmac_f32_16x16x64_bf16 v[20:23], v[84:87], v[248:255], v0
  ds_read_b128 v[80:83], v4 offset:15360
  v_smfmac_f32_16x16x64_bf16 v[24:27], v[84:87], a[8:15], v0
  s_waitcnt lgkmcnt(2)
  v_smfmac_f32_16x16x64_bf16 v[16:19], v[100:103], v[128:135], v0
  ds_read_b128 v[92:95], v2 offset:1024
  v_smfmac_f32_16x16x64_bf16 v[20:23], v[100:103], v[144:151], v0
  ds_read_b128 v[96:99], v1 offset:1024
  buffer_load_dwordx4 v9, s[4:7], s27 offen sc1 lds
  v_smfmac_f32_16x16x64_bf16 v[24:27], v[100:103], v[68:75], v0
  s_waitcnt vmcnt(1) lgkmcnt(3)
  ds_read_b128 v[116:119], v2 offset:0
  s_mov_b32 m0, s32
  v_smfmac_f32_16x16x64_bf16 v[16:19], v[120:123], v[136:143], v0
  ds_read_b128 v[124:127], v1 offset:0
  v_smfmac_f32_16x16x64_bf16 v[20:23], v[120:123], v[152:159], v0
  s_waitcnt lgkmcnt(4)
  ds_read_b128 v[104:107], v2 offset:6144
  v_smfmac_f32_16x16x64_bf16 v[24:27], v[120:123], v[76:83], v0
  s_waitcnt lgkmcnt(4)
  ds_read_b128 v[108:111], v1 offset:6144
  buffer_load_dwordx4 v9, s[4:7], s27 offen offset:128 sc1 lds
  v_smfmac_f32_16x16x64_bf16 v[16:19], v[92:95], v[160:167], v0
  s_waitcnt lgkmcnt(4)
  ds_read_b128 v[112:115], v2 offset:5120
  s_mov_b32 m0, s33
  v_smfmac_f32_16x16x64_bf16 v[16:19], v[96:99], v[168:175], v0
  s_waitcnt lgkmcnt(4)
  ds_read_b128 v[84:87], v1 offset:5120
  v_smfmac_f32_16x16x64_bf16 v[16:19], v[116:119], v[192:199], v0
  s_waitcnt lgkmcnt(4)
  ds_read_b128 v[88:91], v2 offset:4096
  v_smfmac_f32_16x16x64_bf16 v[16:19], v[124:127], v[200:207], v0
  s_waitcnt lgkmcnt(4)
  ds_read_b128 v[100:103], v1 offset:4096
  buffer_load_dwordx4 v10, s[4:7], s28 offen sc1 lds
  v_smfmac_f32_16x16x64_bf16 v[16:19], v[104:107], a[16:23], v0
  s_waitcnt lgkmcnt(4)
  ds_read_b128 v[68:71], v4 offset:16384
  s_mov_b32 m0, s34
  v_smfmac_f32_16x16x64_bf16 v[16:19], v[108:111], a[24:31], v0
  s_waitcnt lgkmcnt(4)
  ds_read_b128 v[72:75], v4 offset:17408
  v_smfmac_f32_16x16x64_bf16 v[16:19], v[112:115], a[64:71], v0
  s_waitcnt lgkmcnt(4)
  ds_read_b128 v[76:79], v4 offset:18432
  v_smfmac_f32_16x16x64_bf16 v[16:19], v[84:87], a[72:79], v0
  s_waitcnt lgkmcnt(4)
  ds_read_b128 v[80:83], v4 offset:19456
  buffer_load_dwordx4 v10, s[4:7], s28 offen offset:256 sc1 lds
  v_smfmac_f32_16x16x64_bf16 v[16:19], v[88:91], a[112:119], v0
  s_waitcnt lgkmcnt(4)
  s_mov_b32 m0, 32256
  v_smfmac_f32_16x16x64_bf16 v[16:19], v[100:103], a[120:127], v0
  s_add_u32 s24, s36, 145752064
  s_add_u32 s25, s36, 145756160
  v_smfmac_f32_16x16x64_bf16 v[20:23], v[92:95], v[176:183], v0
  s_add_u32 s35, s36, s23
  v_smfmac_f32_16x16x64_bf16 v[20:23], v[96:99], v[184:191], v0
  s_waitcnt lgkmcnt(2)
  buffer_load_dword v8, s[4:7], s99 offen sc1 lds
  v_smfmac_f32_16x16x64_bf16 v[20:23], v[116:119], v[68:75], v0
  s_waitcnt lgkmcnt(0)
  ds_read_b128 v[68:71], v4 offset:20480
  v_mul_f32 v16, s18, v16
  v_smfmac_f32_16x16x64_bf16 v[20:23], v[124:127], v[76:83], v0
  ds_read_b128 v[72:75], v4 offset:21504
  v_mul_f32 v17, s18, v17
  v_smfmac_f32_16x16x64_bf16 v[20:23], v[104:107], a[32:39], v0
  ds_read_b128 v[76:79], v4 offset:22528
  v_mul_f32 v18, s18, v18
  v_smfmac_f32_16x16x64_bf16 v[20:23], v[108:111], a[40:47], v0
  ds_read_b128 v[80:83], v4 offset:23552
  v_mul_f32 v19, s18, v19
  v_smfmac_f32_16x16x64_bf16 v[20:23], v[112:115], a[80:87], v0
  v_cvt_pk_bf16_f32 v120, v16, v17
  v_smfmac_f32_16x16x64_bf16 v[20:23], v[84:87], a[88:95], v0
  v_cvt_pk_bf16_f32 v121, v18, v19
  v_smfmac_f32_16x16x64_bf16 v[20:23], v[88:91], a[128:135], v0
  ds_write_b64 v5, v[120:121] offset:24576
  v_smfmac_f32_16x16x64_bf16 v[20:23], v[100:103], a[136:143], v0
  s_waitcnt lgkmcnt(3)
  v_smfmac_f32_16x16x64_bf16 v[24:27], v[92:95], v[68:75], v0
  s_waitcnt lgkmcnt(1)
  v_mov_b64 v[92:93], 0
  v_smfmac_f32_16x16x64_bf16 v[24:27], v[96:99], v[76:83], v0
  s_nop 1
  v_cvt_pk_bf16_f32 v122, v20, v21
  v_cvt_pk_bf16_f32 v123, v22, v23
  v_smfmac_f32_16x16x64_bf16 v[24:27], v[116:119], v[208:215], v0
  ds_write_b64 v5, v[122:123] offset:26880
  v_mov_b64 v[94:95], 0
  v_smfmac_f32_16x16x64_bf16 v[24:27], v[124:127], v[216:223], v0
  s_waitcnt lgkmcnt(1)
  s_barrier
  ds_read_b64_tr_b16 v[68:69], v6 offset:24576
  v_smfmac_f32_16x16x64_bf16 v[24:27], v[104:107], a[48:55], v0
  s_add_u32 s27, s27, 8192
  ds_read_b64_tr_b16 v[70:71], v6 offset:24640
  ds_read_b64_tr_b16 v[72:73], v6 offset:24832
  v_smfmac_f32_16x16x64_bf16 v[24:27], v[108:111], a[56:63], v0
  s_add_u32 s28, s28, 8192
  ds_read_b64_tr_b16 v[74:75], v6 offset:24896
  ds_read_b64_tr_b16 v[76:77], v6 offset:25088
  v_smfmac_f32_16x16x64_bf16 v[24:27], v[112:115], a[96:103], v0
  s_nop 0
  ds_read_b64_tr_b16 v[78:79], v6 offset:25152
  ds_read_b64_tr_b16 v[80:81], v6 offset:25344
  v_smfmac_f32_16x16x64_bf16 v[24:27], v[84:87], a[104:111], v0
  ds_read_b64_tr_b16 v[82:83], v6 offset:25408
  v_mov_b64 v[96:97], 0
  v_smfmac_f32_16x16x64_bf16 v[24:27], v[88:91], a[144:151], v0
  s_waitcnt lgkmcnt(8)
  s_barrier
  ds_read_b64_tr_b16 v[116:117], v6 offset:26880
  v_smfmac_f32_16x16x64_bf16 v[24:27], v[100:103], a[152:159], v0
  s_waitcnt lgkmcnt(7)
  ds_read_b64_tr_b16 v[118:119], v6 offset:26944
  v_mfma_f32_16x16x32_bf16 v[16:19], v[36:39], v[68:71], 0
  s_waitcnt lgkmcnt(6)
  ds_read_b64_tr_b16 v[124:125], v6 offset:27136
  ds_read_b64_tr_b16 v[126:127], v6 offset:27200
  v_mfma_f32_16x16x32_bf16 v[16:19], v[40:43], v[72:75], v[16:19]
  s_waitcnt lgkmcnt(6)
  ds_read_b64_tr_b16 v[104:105], v6 offset:27392
  ds_read_b64_tr_b16 v[106:107], v6 offset:27456
  v_mfma_f32_16x16x32_bf16 v[16:19], v[44:47], v[76:79], v[16:19]
  s_waitcnt lgkmcnt(6)
  ds_read_b64_tr_b16 v[108:109], v6 offset:27648
  ds_read_b64_tr_b16 v[110:111], v6 offset:27712
  v_mfma_f32_16x16x32_bf16 v[16:19], v[48:51], v[80:83], v[16:19]
  s_waitcnt lgkmcnt(6)
  v_cvt_pk_bf16_f32 v120, v24, v25
  v_cvt_pk_bf16_f32 v121, v26, v27
  v_mfma_f32_16x16x32_bf16 v[112:115], v[116:119], v[68:71], 0
  s_waitcnt lgkmcnt(4)
  buffer_store_dwordx4 v[120:123], v2, s[4:7], s29 offen offset:3072 sc1
  v_mov_b64 v[98:99], 0
  v_mfma_f32_16x16x32_bf16 v[112:115], v[124:127], v[72:75], v[112:115]
  s_waitcnt lgkmcnt(2)
  v_mov_b64 v[36:37], 0
  v_exp_f32 v100, v16
  v_mfma_f32_16x16x32_bf16 v[112:115], v[104:107], v[76:79], v[112:115]
  s_waitcnt lgkmcnt(0)
  v_exp_f32 v101, v17
  v_mfma_f32_16x16x32_bf16 v[112:115], v[108:111], v[80:83], v[112:115]
  s_add_u32 s29, s29, 131072
  v_exp_f32 v102, v18
  v_mfma_f32_16x16x32_bf16 v[20:23], v[52:55], v[68:71], 0
  s_cmp_eq_u32 s14, 63
  v_exp_f32 v103, v19
  v_mfma_f32_16x16x32_bf16 v[20:23], v[56:59], v[72:75], v[20:23]
  s_cbranch_scc1 M_tdone
  v_cvt_pk_bf16_f32 v44, v100, v101
  v_cvt_pk_bf16_f32 v45, v102, v103
  v_mfma_f32_16x16x32_bf16 v[20:23], v[60:63], v[76:79], v[20:23]
  v_exp_f32 v100, v112
  v_mfma_f32_16x16x32_bf16 v[20:23], v[64:67], v[80:83], v[20:23]
  v_exp_f32 v101, v113
  v_exp_f32 v102, v114
  v_exp_f32 v103, v115
  v_cvt_pk_bf16_f32 v84, v100, v101
  v_cvt_pk_bf16_f32 v85, v102, v103
  v_cndmask_b32 v48, v84, 0, s[16:17]
  v_cndmask_b32 v49, v85, 0, s[16:17]
  v_cndmask_b32 v50, 0, v84, s[16:17]
  v_cndmask_b32 v51, 0, v85, s[16:17]
  v_exp_f32 v100, v20
  v_mfma_f32_16x16x16_bf16 v[88:91], v[12:13], v[48:49], 0
  v_exp_f32 v101, v21
  v_mfma_f32_16x16x16_bf16 v[24:27], v[120:121], v[48:49], 0
  v_exp_f32 v102, v22
  v_mfma_f32_16x16x16_bf16 v[116:119], v[120:121], v[50:51], 0
  v_exp_f32 v103, v23
  v_cvt_pk_bf16_f32 v46, v100, v101
  v_cvt_pk_bf16_f32 v47, v102, v103
  v_mov_b64 v[38:39], 0
  s_nop 0
  v_mfma_f32_16x16x32_bf16 v[88:91], v[12:15], v[44:47], v[88:91]
  v_mov_b64 v[40:41], 0
  v_mov_b64 v[42:43], 0
  v_mfma_f32_16x16x32_bf16 v[24:27], v[28:31], v[44:47], v[24:27]
  ds_read_b128 v[52:55], v4 offset:24576
  ds_read_b128 v[56:59], v4 offset:25600
  v_mfma_f32_16x16x32_bf16 v[116:119], v[32:35], v[44:47], v[116:119]
  s_nop 1
  v_rcp_f32 v89, v88
  v_subrev_u32 v100, s54, v88
  v_cmp_le_u32 vcc, s55, v100
  v_mul_f32 v24, v89, v24
  v_mul_f32 v25, v89, v25
  s_cbranch_vccnz T_slow_130
T_back_131:
  v_cvt_pk_bf16_f32 v124, v24, v25
  v_pk_mul_f32 v[26:27], v[26:27], v[88:89] op_sel:[0,1] op_sel_hi:[1,1]
  v_pk_mul_f32 v[116:117], v[116:117], v[88:89] op_sel:[0,1] op_sel_hi:[1,1]
  v_pk_mul_f32 v[118:119], v[118:119], v[88:89] op_sel:[0,1] op_sel_hi:[1,1]
  v_cvt_pk_bf16_f32 v125, v26, v27
  v_cvt_pk_bf16_f32 v126, v116, v117
  v_cvt_pk_bf16_f32 v127, v118, v119
  ds_write_b128 v11, v[124:127] offset:30720
  s_nop 0
  v_smfmac_f32_16x16x64_bf16 v[92:95], v[124:127], a[160:167], v0
  v_smfmac_f32_16x16x64_bf16 v[96:99], v[124:127], a[168:175], v0
  v_smfmac_f32_16x16x64_bf16 v[36:39], v[124:127], a[176:183], v0
  v_smfmac_f32_16x16x64_bf16 v[40:43], v[124:127], a[184:191], v0
  s_waitcnt lgkmcnt(0)
  s_barrier
  ds_read_b128 v[104:107], v11 offset:30208
  ds_read_b128 v[108:111], v11 offset:29696
  ds_read_b128 v[68:71], v11 offset:29184
  s_waitcnt lgkmcnt(2)
  v_smfmac_f32_16x16x64_bf16 v[92:95], v[104:107], a[192:199], v0
  s_waitcnt lgkmcnt(1)
  ds_read_b128 v[76:79], v4 offset:28672
  v_smfmac_f32_16x16x64_bf16 v[92:95], v[108:111], a[224:231], v0
  s_waitcnt lgkmcnt(1)
  ds_read_b128 v[80:83], v4 offset:29696
  v_smfmac_f32_16x16x64_bf16 v[92:95], v[68:71], a[240:247], v0
  ds_read_b128 v[60:63], v4 offset:26624
  v_smfmac_f32_16x16x64_bf16 v[96:99], v[104:107], a[200:207], v0
  ds_read_b128 v[64:67], v4 offset:27648
  v_smfmac_f32_16x16x64_bf16 v[96:99], v[108:111], a[232:239], v0
  ds_read_b128 v[28:31], v4 offset:30720
  s_nop 0
  v_cvt_pk_bf16_f32 v16, v92, v93
  v_cvt_pk_bf16_f32 v17, v94, v95
  v_bfi_b32 v16, 1, s57, v16
  v_smfmac_f32_16x16x64_bf16 v[96:99], v[68:71], a[248:255], v0
  buffer_store_dwordx2 v[16:17], v7, s[4:7], s20 offen offset:0
  v_smfmac_f32_16x16x64_bf16 v[36:39], v[104:107], a[208:215], v0
  ds_read_b128 v[32:35], v4 offset:31744
  v_smfmac_f32_16x16x64_bf16 v[36:39], v[108:111], v[52:59], v0
  s_waitcnt lgkmcnt(4)
  s_nop 0
  v_cvt_pk_bf16_f32 v18, v96, v97
  v_cvt_pk_bf16_f32 v19, v98, v99
  v_bfi_b32 v18, 1, s57, v18
  v_smfmac_f32_16x16x64_bf16 v[36:39], v[68:71], v[76:83], v0
  buffer_store_dwordx2 v[18:19], v7, s[4:7], s20 offen offset:64
  v_smfmac_f32_16x16x64_bf16 v[40:43], v[104:107], a[216:223], v0
  s_waitcnt lgkmcnt(2)
  v_smfmac_f32_16x16x64_bf16 v[40:43], v[108:111], v[60:67], v0
  s_waitcnt lgkmcnt(0)
  s_nop 0
  v_cvt_pk_bf16_f32 v20, v36, v37
  v_cvt_pk_bf16_f32 v21, v38, v39
  v_bfi_b32 v20, 1, s57, v20
  v_smfmac_f32_16x16x64_bf16 v[40:43], v[68:71], v[28:35], v0
  buffer_store_dwordx2 v[20:21], v7, s[4:7], s21 offen offset:0
  s_nop 6
  v_cvt_pk_bf16_f32 v22, v40, v41
  v_cvt_pk_bf16_f32 v23, v42, v43
  v_bfi_b32 v22, 1, s57, v22
  buffer_store_dwordx2 v[22:23], v7, s[4:7], s21 offen offset:64
  ds_read_b128 v[68:71], v4 offset:0
  ds_read_b128 v[72:75], v4 offset:1024
  ds_read_b128 v[76:79], v4 offset:4096
  ds_read_b128 v[80:83], v4 offset:5120
  ds_read_b128 v[84:87], v4 offset:8192
  ds_read_b128 v[88:91], v4 offset:9216
  ds_read_b128 v[92:95], v4 offset:2048
  ds_read_b128 v[96:99], v4 offset:3072
  ds_read_b128 v[100:103], v4 offset:6144
  ds_read_b128 v[104:107], v4 offset:7168
  ds_read_b128 v[108:111], v4 offset:10240
  ds_read_b128 v[112:115], v4 offset:11264
  v_mov_b64 v[16:17], 0
  v_mov_b64 v[18:19], 0
  v_mov_b64 v[20:21], 0
  v_mov_b64 v[22:23], 0
  v_mov_b64 v[24:25], 0
  v_mov_b64 v[26:27], 0
  ds_read_b64 v[44:45], v2 offset:32256
  s_waitcnt lgkmcnt(0)
  v_readfirstlane_b32 s38, v44
  v_readfirstlane_b32 s37, v45
  s_nop 0
  s_add_u32 s37, s37, 30
  s_cmp_ge_u32 s38, 30
  s_cselect_b32 s38, s37, s38
  s_cmp_ge_u32 s38, 64
  s_cselect_b32 s38, 100, s38
  s_sub_u32 s38, s38, 1
  s_max_i32 s30, s30, s38
  s_waitcnt vmcnt(4)
  s_barrier
  ds_read_b128 v[28:31], v2 offset:19456
  ds_read_b128 v[32:35], v2 offset:23552
  ds_read_b128 v[36:39], v2 offset:8192
  ds_read_b128 v[40:43], v2 offset:9216
  ds_read_b128 v[44:47], v2 offset:10240
  ds_read_b128 v[48:51], v2 offset:11264
  buffer_load_dwordx4 v[124:127], v3, s[4:7], s24 offen offset:3072 sc1
  buffer_load_dwordx4 v[116:119], v3, s[4:7], s25 offen offset:3072 sc1
  ds_read_b128 v[52:55], v2 offset:12288
  ds_read_b128 v[56:59], v2 offset:13312
  ds_read_b128 v[60:63], v2 offset:14336
  ds_read_b128 v[64:67], v2 offset:15360
  buffer_load_dwordx4 v[124:127], v3, s[4:7], s24 offen offset:3072 sc1
  buffer_load_dwordx4 v[116:119], v3, s[4:7], s25 offen offset:3072 sc1
  s_mov_b32 s19, 0
  s_branch T_loop_123
T_kvw_127:
  s_mov_b32 s19, 0
  s_branch T_kvok_136
T_kv_135:
  s_sleep 4
  s_add_u32 s19, s19, 1
  s_cmp_gt_u32 s19, 32768
  s_cbranch_scc1 M_exit
T_kvok_136:
  s_add_u32 s39, s99, 128
  s_mov_b32 s38, 0
  s_mov_b32 s37, 0
  s_atomic_or s38, s[58:59], s99 glc
  s_atomic_or s37, s[58:59], s39 glc
  s_waitcnt lgkmcnt(0)
  s_add_u32 s37, s37, 30
  s_cmp_ge_u32 s38, 30
  s_cselect_b32 s38, s37, s38
  s_cmp_ge_u32 s38, 64
  s_cselect_b32 s38, 100, s38
  s_sub_u32 s38, s38, 1
  s_max_i32 s30, s30, s38
  s_cmp_ge_i32 s14, s30
  s_cbranch_scc1 T_kv_135
  s_branch T_kvb_128
T_slow_130:
  s_nop 7
  v_max3_f32 v100, v16, v17, v18
  v_max3_f32 v100, v100, v19, v20
  v_max3_f32 v100, v100, v21, v22
  v_max3_f32 v100, v100, v23, v112
  v_max3_f32 v100, v100, v113, v114
  v_max_f32 v100, v100, v115
  v_mov_b32 v101, v100
  s_nop 1
  v_permlane32_swap_b32 v100, v101
  s_nop 1
  v_max_f32 v100, v100, v101
  v_mov_b32 v101, v100
  s_nop 1
  v_permlane16_swap_b32 v100, v101
  s_nop 1
  v_max_f32 v100, v100, v101
  v_sub_f32 v16, v16, v100
  v_sub_f32 v17, v17, v100
  v_sub_f32 v18, v18, v100
  v_sub_f32 v19, v19, v100
  v_exp_f32 v16, v16
  v_exp_f32 v17, v17
  v_exp_f32 v18, v18
  v_exp_f32 v19, v19
  v_sub_f32 v20, v20, v100
  v_sub_f32 v21, v21, v100
  v_sub_f32 v22, v22, v100
  v_sub_f32 v23, v23, v100
  v_exp_f32 v20, v20
  v_exp_f32 v21, v21
  v_exp_f32 v22, v22
  v_exp_f32 v23, v23
  v_sub_f32 v112, v112, v100
  v_sub_f32 v113, v113, v100
  v_sub_f32 v114, v114, v100
  v_sub_f32 v115, v115, v100
  v_exp_f32 v112, v112
  v_exp_f32 v113, v113
  v_exp_f32 v114, v114
  v_exp_f32 v115, v115
  s_nop 0
  v_cvt_pk_bf16_f32 v44, v16, v17
  v_cvt_pk_bf16_f32 v45, v18, v19
  v_cvt_pk_bf16_f32 v46, v20, v21
  v_cvt_pk_bf16_f32 v47, v22, v23
  v_cvt_pk_bf16_f32 v84, v112, v113
  v_cvt_pk_bf16_f32 v85, v114, v115
  v_cndmask_b32 v48, v84, 0, s[16:17]
  v_cndmask_b32 v49, v85, 0, s[16:17]
  v_cndmask_b32 v50, 0, v84, s[16:17]
  v_cndmask_b32 v51, 0, v85, s[16:17]
  s_nop 1
  v_mfma_f32_16x16x16_bf16 v[88:91], v[12:13], v[48:49], 0
  v_mfma_f32_16x16x16_bf16 v[24:27], v[120:121], v[48:49], 0
  v_mfma_f32_16x16x16_bf16 v[116:119], v[120:121], v[50:51], 0
  v_mfma_f32_16x16x32_bf16 v[88:91], v[12:15], v[44:47], v[88:91]
  v_mfma_f32_16x16x32_bf16 v[24:27], v[28:31], v[44:47], v[24:27]
  v_mfma_f32_16x16x32_bf16 v[116:119], v[32:35], v[44:47], v[116:119]
  s_nop 7
  s_nop 1
  v_rcp_f32 v89, v88
  s_nop 0
  v_mul_f32 v24, v89, v24
  v_mul_f32 v25, v89, v25
  s_branch T_back_131
M_global:
  s_cmp_eq_u32 s13, 1
  s_cbranch_scc1 T_w_138
  s_cmp_eq_u32 s13, 2
  s_cbranch_scc1 T_w_139
  s_cmp_eq_u32 s13, 3
  s_cbranch_scc1 T_w_140
T_w_137:
  s_mov_b32 s19, 0
  v_mov_b64 v[16:17], 0
  v_mov_b64 v[18:19], 0
  v_mov_b64 v[20:21], 0
  v_mov_b64 v[22:23], 0
  v_mov_b64 v[24:25], 0
  v_mov_b64 v[26:27], 0
  buffer_load_dwordx4 v[124:127], v3, s[4:7], s24 offen offset:0 sc1
  buffer_load_dwordx4 v[116:119], v3, s[4:7], s25 offen offset:0 sc1
  buffer_load_dwordx4 v[124:127], v3, s[4:7], s24 offen offset:0 sc1
  buffer_load_dwordx4 v[116:119], v3, s[4:7], s25 offen offset:0 sc1
  s_branch T_loop_141
.p2align 6
T_retry_142:
  s_mov_b64 exec, vcc
  buffer_load_dwordx4 v[124:127], v3, s[4:7], s24 offen offset:0 sc1
  buffer_load_dwordx4 v[116:119], v3, s[4:7], s25 offen offset:0 sc1
  s_mov_b64 exec, -1
  s_add_u32 s19, s19, 1
  s_cmp_gt_u32 s19, 32768
  s_cbranch_scc1 M_exit
T_loop_141:
  s_waitcnt vmcnt(3) lgkmcnt(0)
  v_max3_u32 v123, v124, v125, v126
  v_max_u32 v123, v123, v127
  v_mov_b32_dpp v120, v124 row_ror:8 row_mask:0xf bank_mask:0xf
  v_mov_b32_dpp v121, v125 row_ror:8 row_mask:0xf bank_mask:0xf
  s_waitcnt vmcnt(2)
  v_max3_u32 v123, v123, v116, v117
  v_max3_u32 v123, v123, v118, v119
  v_cmp_eq_u32 vcc, -1, v123
  s_cbranch_vccnz T_retry_142
  v_smfmac_f32_16x16x64_bf16 v[16:19], v[124:127], v[68:75], v0
  s_add_u32 s14, s14, 1
  ds_write_b128 v2, v[124:127] offset:0
  v_mov_b32_dpp v122, v126 row_ror:8 row_mask:0xf bank_mask:0xf
  v_smfmac_f32_16x16x64_bf16 v[20:23], v[124:127], v[76:83], v0
  s_and_b32 s57, s14, 1
  v_mov_b32_dpp v123, v127 row_ror:8 row_mask:0xf bank_mask:0xf
  v_smfmac_f32_16x16x64_bf16 v[24:27], v[124:127], v[84:91], v0
  s_and_b32 s36, s14, 3
  ds_write_b128 v2, v[116:119] offset:4096
  v_smfmac_f32_16x16x64_bf16 v[16:19], v[120:123], v[92:99], v0
  s_lshl_b32 s36, s36, 13
  v_mov_b32_dpp v84, v116 row_ror:8 row_mask:0xf bank_mask:0xf
  v_smfmac_f32_16x16x64_bf16 v[20:23], v[120:123], v[100:107], v0
  s_add_u32 s26, s36, s23
  ds_read_b128 v[68:71], v4 offset:12288
  v_mov_b32_dpp v85, v117 row_ror:8 row_mask:0xf bank_mask:0xf
  v_smfmac_f32_16x16x64_bf16 v[24:27], v[120:123], v[108:115], v0
  s_add_u32 s36, s36, 8192
  ds_read_b128 v[72:75], v4 offset:13312
  v_mov_b32_dpp v86, v118 row_ror:8 row_mask:0xf bank_mask:0xf
  v_smfmac_f32_16x16x64_bf16 v[16:19], v[116:119], v[224:231], v0
  s_and_b32 s36, s36, 0x7fff
  ds_read_b128 v[76:79], v4 offset:14336
  v_mov_b32_dpp v87, v119 row_ror:8 row_mask:0xf bank_mask:0xf
  v_smfmac_f32_16x16x64_bf16 v[20:23], v[116:119], v[240:247], v0
  s_waitcnt lgkmcnt(3)
  s_barrier
  ds_read_b128 v[100:103], v2 offset:1024
  v_smfmac_f32_16x16x64_bf16 v[24:27], v[116:119], a[0:7], v0
  s_mov_b32 m0, s31
  ds_read_b128 v[120:123], v1 offset:1024
  v_smfmac_f32_16x16x64_bf16 v[16:19], v[84:87], v[232:239], v0
  s_cmp_ge_i32 s14, s30
  s_cbranch_scc1 T_kvw_145
T_kvb_146:
  v_smfmac_f32_16x16x64_bf16 v[20:23], v[84:87], v[248:255], v0
  ds_read_b128 v[80:83], v4 offset:15360
  buffer_load_dwordx4 v9, s[4:7], s27 offen sc1 lds
  v_smfmac_f32_16x16x64_bf16 v[24:27], v[84:87], a[8:15], v0
  s_waitcnt lgkmcnt(2)
  s_mov_b32 m0, s32
  v_smfmac_f32_16x16x64_bf16 v[16:19], v[100:103], v[128:135], v0
  ds_read_b128 v[92:95], v2 offset:2048
  v_smfmac_f32_16x16x64_bf16 v[20:23], v[100:103], v[144:151], v0
  ds_read_b128 v[96:99], v1 offset:2048
  v_smfmac_f32_16x16x64_bf16 v[24:27], v[100:103], v[68:75], v0
  s_waitcnt vmcnt(1) lgkmcnt(3)
  ds_read_b128 v[116:119], v2 offset:3072
  buffer_load_dwordx4 v9, s[4:7], s27 offen offset:128 sc1 lds
  v_smfmac_f32_16x16x64_bf16 v[16:19], v[120:123], v[136:143], v0
  ds_read_b128 v[124:127], v1 offset:3072
  s_mov_b32 m0, s33
  v_smfmac_f32_16x16x64_bf16 v[20:23], v[120:123], v[152:159], v0
  s_waitcnt lgkmcnt(4)
  ds_read_b128 v[104:107], v2 offset:5120
  v_smfmac_f32_16x16x64_bf16 v[24:27], v[120:123], v[76:83], v0
  s_waitcnt lgkmcnt(4)
  ds_read_b128 v[108:111], v1 offset:5120
  v_smfmac_f32_16x16x64_bf16 v[16:19], v[92:95], v[160:167], v0
  s_waitcnt lgkmcnt(4)
  ds_read_b128 v[112:115], v2 offset:6144
  buffer_load_dwordx4 v10, s[4:7], s28 offen sc1 lds
  v_smfmac_f32_16x16x64_bf16 v[16:19], v[96:99], v[168:175], v0
  s_waitcnt lgkmcnt(4)
  ds_read_b128 v[84:87], v1 offset:6144
  s_mov_b32 m0, s34
  v_smfmac_f32_16x16x64_bf16 v[16:19], v[116:119], v[192:199], v0
  s_waitcnt lgkmcnt(4)
  ds_read_b128 v[88:91], v2 offset:7168
  v_smfmac_f32_16x16x64_bf16 v[16:19], v[124:127], v[200:207], v0
  s_waitcnt lgkmcnt(4)
  ds_read_b128 v[100:103], v1 offset:7168
  v_smfmac_f32_16x16x64_bf16 v[16:19], v[104:107], a[16:23], v0
  s_waitcnt lgkmcnt(4)
  ds_read_b128 v[68:71], v4 offset:16384
  buffer_load_dwordx4 v10, s[4:7], s28 offen offset:256 sc1 lds
  v_smfmac_f32_16x16x64_bf16 v[16:19], v[108:111], a[24:31], v0
  s_waitcnt lgkmcnt(4)
  ds_read_b128 v[72:75], v4 offset:17408
  v_smfmac_f32_16x16x64_bf16 v[16:19], v[112:115], a[64:71], v0
  s_waitcnt lgkmcnt(4)
  ds_read_b128 v[76:79], v4 offset:18432
  v_smfmac_f32_16x16x64_bf16 v[16:19], v[84:87], a[72:79], v0
  s_waitcnt lgkmcnt(4)
  ds_read_b128 v[80:83], v4 offset:19456
  v_smfmac_f32_16x16x64_bf16 v[16:19], v[88:91], a[112:119], v0
  s_waitcnt lgkmcnt(4)
  v_smfmac_f32_16x16x64_bf16 v[16:19], v[100:103], a[120:127], v0
  s_add_u32 s24, s36, 145752064
  s_add_u32 s25, s36, 145756160
  v_smfmac_f32_16x16x64_bf16 v[20:23], v[92:95], v[176:183], v0
  s_add_u32 s35, s36, s23
  v_smfmac_f32_16x16x64_bf16 v[20:23], v[96:99], v[184:191], v0
  s_waitcnt lgkmcnt(2)
  v_smfmac_f32_16x16x64_bf16 v[20:23], v[116:119], v[68:75], v0
  s_waitcnt lgkmcnt(0)
  ds_read_b128 v[68:71], v4 offset:20480
  v_mul_f32 v16, s18, v16
  v_smfmac_f32_16x16x64_bf16 v[20:23], v[124:127], v[76:83], v0
  ds_read_b128 v[72:75], v4 offset:21504
  v_mul_f32 v17, s18, v17
  v_smfmac_f32_16x16x64_bf16 v[20:23], v[104:107], a[32:39], v0
  ds_read_b128 v[76:79], v4 offset:22528
  v_mul_f32 v18, s18, v18
  v_smfmac_f32_16x16x64_bf16 v[20:23], v[108:111], a[40:47], v0
  ds_read_b128 v[80:83], v4 offset:23552
  v_mul_f32 v19, s18, v19
  v_smfmac_f32_16x16x64_bf16 v[20:23], v[112:115], a[80:87], v0
  v_cvt_pk_bf16_f32 v120, v16, v17
  v_smfmac_f32_16x16x64_bf16 v[20:23], v[84:87], a[88:95], v0
  v_cvt_pk_bf16_f32 v121, v18, v19
  v_smfmac_f32_16x16x64_bf16 v[20:23], v[88:91], a[128:135], v0
  ds_write_b64 v5, v[120:121] offset:24576
  v_smfmac_f32_16x16x64_bf16 v[20:23], v[100:103], a[136:143], v0
  s_waitcnt lgkmcnt(3)
  v_smfmac_f32_16x16x64_bf16 v[24:27], v[92:95], v[68:75], v0
  s_waitcnt lgkmcnt(1)
  v_mov_b64 v[92:93], 0
  v_smfmac_f32_16x16x64_bf16 v[24:27], v[96:99], v[76:83], v0
  s_nop 1
  v_cvt_pk_bf16_f32 v122, v20, v21
  v_cvt_pk_bf16_f32 v123, v22, v23
  v_smfmac_f32_16x16x64_bf16 v[24:27], v[116:119], v[208:215], v0
  ds_write_b64 v5, v[122:123] offset:26880
  v_mov_b64 v[94:95], 0
  v_smfmac_f32_16x16x64_bf16 v[24:27], v[124:127], v[216:223], v0
  s_waitcnt lgkmcnt(1)
  s_barrier
  ds_read_b64_tr_b16 v[68:69], v6 offset:24576
  v_smfmac_f32_16x16x64_bf16 v[24:27], v[104:107], a[48:55], v0
  s_add_u32 s27, s27, 8192
  ds_read_b64_tr_b16 v[70:71], v6 offset:24640
  ds_read_b64_tr_b16 v[72:73], v6 offset:24832
  v_smfmac_f32_16x16x64_bf16 v[24:27], v[108:111], a[56:63], v0
  s_add_u32 s28, s28, 8192
  ds_read_b64_tr_b16 v[74:75], v6 offset:24896
  ds_read_b64_tr_b16 v[76:77], v6 offset:25088
  v_smfmac_f32_16x16x64_bf16 v[24:27], v[112:115], a[96:103], v0
  s_nop 0
  ds_read_b64_tr_b16 v[78:79], v6 offset:25152
  ds_read_b64_tr_b16 v[80:81], v6 offset:25344
  v_smfmac_f32_16x16x64_bf16 v[24:27], v[84:87], a[104:111], v0
  ds_read_b64_tr_b16 v[82:83], v6 offset:25408
  v_mov_b64 v[96:97], 0
  v_smfmac_f32_16x16x64_bf16 v[24:27], v[88:91], a[144:151], v0
  s_waitcnt lgkmcnt(8)
  s_barrier
  ds_read_b64_tr_b16 v[116:117], v6 offset:26880
  v_smfmac_f32_16x16x64_bf16 v[24:27], v[100:103], a[152:159], v0
  s_waitcnt lgkmcnt(7)
  ds_read_b64_tr_b16 v[118:119], v6 offset:26944
  v_mfma_f32_16x16x32_bf16 v[16:19], v[36:39], v[68:71], 0
  s_waitcnt lgkmcnt(6)
  ds_read_b64_tr_b16 v[124:125], v6 offset:27136
  ds_read_b64_tr_b16 v[126:127], v6 offset:27200
  v_mfma_f32_16x16x32_bf16 v[16:19], v[40:43], v[72:75], v[16:19]
  s_waitcnt lgkmcnt(6)
  ds_read_b64_tr_b16 v[104:105], v6 offset:27392
  ds_read_b64_tr_b16 v[106:107], v6 offset:27456
  v_mfma_f32_16x16x32_bf16 v[16:19], v[44:47], v[76:79], v[16:19]
  s_waitcnt lgkmcnt(6)
  ds_read_b64_tr_b16 v[108:109], v6 offset:27648
  ds_read_b64_tr_b16 v[110:111], v6 offset:27712
  v_mfma_f32_16x16x32_bf16 v[16:19], v[48:51], v[80:83], v[16:19]
  s_waitcnt lgkmcnt(6)
  v_cvt_pk_bf16_f32 v120, v24, v25
  v_cvt_pk_bf16_f32 v121, v26, v27
  v_mfma_f32_16x16x32_bf16 v[112:115], v[116:119], v[68:71], 0
  s_waitcnt lgkmcnt(4)
  buffer_store_dwordx4 v[120:123], v2, s[4:7], s29 offen offset:0 sc1
  v_mov_b64 v[98:99], 0
  v_mfma_f32_16x16x32_bf16 v[112:115], v[124:127], v[72:75], v[112:115]
  s_waitcnt lgkmcnt(2)
  v_mov_b64 v[36:37], 0
  v_exp_f32 v100, v16
  v_mfma_f32_16x16x32_bf16 v[112:115], v[104:107], v[76:79], v[112:115]
  s_waitcnt lgkmcnt(0)
  v_exp_f32 v101, v17
  v_mfma_f32_16x16x32_bf16 v[112:115], v[108:111], v[80:83], v[112:115]
  s_add_u32 s29, s29, 131072
  v_exp_f32 v102, v18
  v_mfma_f32_16x16x32_bf16 v[20:23], v[52:55], v[68:71], 0
  s_cmp_eq_u32 s14, 63
  v_exp_f32 v103, v19
  v_mfma_f32_16x16x32_bf16 v[20:23], v[56:59], v[72:75], v[20:23]
  s_cbranch_scc1 M_tdone
  v_cvt_pk_bf16_f32 v44, v100, v101
  v_cvt_pk_bf16_f32 v45, v102, v103
  v_mfma_f32_16x16x32_bf16 v[20:23], v[60:63], v[76:79], v[20:23]
  v_exp_f32 v100, v112
  v_mfma_f32_16x16x32_bf16 v[20:23], v[64:67], v[80:83], v[20:23]
  v_exp_f32 v101, v113
  v_exp_f32 v102, v114
  v_exp_f32 v103, v115
  v_cvt_pk_bf16_f32 v84, v100, v101
  v_cvt_pk_bf16_f32 v85, v102, v103
  v_cndmask_b32 v48, v84, 0, s[16:17]
  v_cndmask_b32 v49, v85, 0, s[16:17]
  v_cndmask_b32 v50, 0, v84, s[16:17]
  v_cndmask_b32 v51, 0, v85, s[16:17]
  v_exp_f32 v100, v20
  v_mfma_f32_16x16x16_bf16 v[88:91], v[12:13], v[48:49], 0
  v_exp_f32 v101, v21
  v_mfma_f32_16x16x16_bf16 v[24:27], v[120:121], v[48:49], 0
  v_exp_f32 v102, v22
  v_mfma_f32_16x16x16_bf16 v[116:119], v[120:121], v[50:51], 0
  v_exp_f32 v103, v23
  v_cvt_pk_bf16_f32 v46, v100, v101
  v_cvt_pk_bf16_f32 v47, v102, v103
  v_mov_b64 v[38:39], 0
  s_nop 0
  v_mfma_f32_16x16x32_bf16 v[88:91], v[12:15], v[44:47], v[88:91]
  v_mov_b64 v[40:41], 0
  v_mov_b64 v[42:43], 0
  v_mfma_f32_16x16x32_bf16 v[24:27], v[28:31], v[44:47], v[24:27]
  ds_read_b128 v[52:55], v4 offset:24576
  ds_read_b128 v[56:59], v4 offset:25600
  v_mfma_f32_16x16x32_bf16 v[116:119], v[32:35], v[44:47], v[116:119]
  s_nop 1
  v_rcp_f32 v89, v88
  v_subrev_u32 v100, s54, v88
  v_cmp_le_u32 vcc, s55, v100
  v_mul_f32 v24, v89, v24
  v_mul_f32 v25, v89, v25
  s_cbranch_vccnz T_slow_148
T_back_149:
  v_cvt_pk_bf16_f32 v124, v24, v25
  v_pk_mul_f32 v[26:27], v[26:27], v[88:89] op_sel:[0,1] op_sel_hi:[1,1]
  v_pk_mul_f32 v[116:117], v[116:117], v[88:89] op_sel:[0,1] op_sel_hi:[1,1]
  v_pk_mul_f32 v[118:119], v[118:119], v[88:89] op_sel:[0,1] op_sel_hi:[1,1]
  v_cvt_pk_bf16_f32 v125, v26, v27
  v_cvt_pk_bf16_f32 v126, v116, v117
  v_cvt_pk_bf16_f32 v127, v118, v119
  ds_write_b128 v11, v[124:127] offset:29184
  s_nop 0
  v_smfmac_f32_16x16x64_bf16 v[92:95], v[124:127], a[160:167], v0
  v_smfmac_f32_16x16x64_bf16 v[96:99], v[124:127], a[168:175], v0
  v_smfmac_f32_16x16x64_bf16 v[36:39], v[124:127], a[176:183], v0
  v_smfmac_f32_16x16x64_bf16 v[40:43], v[124:127], a[184:191], v0
  s_waitcnt lgkmcnt(0)
  s_barrier
  ds_read_b128 v[104:107], v11 offset:29696
  ds_read_b128 v[108:111], v11 offset:30208
  ds_read_b128 v[68:71], v11 offset:30720
  s_waitcnt lgkmcnt(2)
  v_smfmac_f32_16x16x64_bf16 v[92:95], v[104:107], a[192:199], v0
  s_waitcnt lgkmcnt(1)
  ds_read_b128 v[76:79], v4 offset:28672
  v_smfmac_f32_16x16x64_bf16 v[92:95], v[108:111], a[224:231], v0
  s_waitcnt lgkmcnt(1)
  ds_read_b128 v[80:83], v4 offset:29696
  v_smfmac_f32_16x16x64_bf16 v[92:95], v[68:71], a[240:247], v0
  ds_read_b128 v[60:63], v4 offset:26624
  v_smfmac_f32_16x16x64_bf16 v[96:99], v[104:107], a[200:207], v0
  ds_read_b128 v[64:67], v4 offset:27648
  v_smfmac_f32_16x16x64_bf16 v[96:99], v[108:111], a[232:239], v0
  ds_read_b128 v[28:31], v4 offset:30720
  s_nop 0
  v_cvt_pk_bf16_f32 v16, v92, v93
  v_cvt_pk_bf16_f32 v17, v94, v95
  v_bfi_b32 v16, 1, s57, v16
  v_smfmac_f32_16x16x64_bf16 v[96:99], v[68:71], a[248:255], v0
  buffer_store_dwordx2 v[16:17], v7, s[4:7], s20 offen offset:0 sc1
  v_smfmac_f32_16x16x64_bf16 v[36:39], v[104:107], a[208:215], v0
  ds_read_b128 v[32:35], v4 offset:31744
  v_smfmac_f32_16x16x64_bf16 v[36:39], v[108:111], v[52:59], v0
  s_waitcnt lgkmcnt(4)
  s_nop 0
  v_cvt_pk_bf16_f32 v18, v96, v97
  v_cvt_pk_bf16_f32 v19, v98, v99
  v_bfi_b32 v18, 1, s57, v18
  v_smfmac_f32_16x16x64_bf16 v[36:39], v[68:71], v[76:83], v0
  buffer_store_dwordx2 v[18:19], v7, s[4:7], s20 offen offset:64 sc1
  v_smfmac_f32_16x16x64_bf16 v[40:43], v[104:107], a[216:223], v0
  s_waitcnt lgkmcnt(2)
  ds_read_b128 v[116:119], v2 offset:31232
  v_smfmac_f32_16x16x64_bf16 v[40:43], v[108:111], v[60:67], v0
  s_waitcnt lgkmcnt(1)
  s_nop 0
  v_cvt_pk_bf16_f32 v20, v36, v37
  v_cvt_pk_bf16_f32 v21, v38, v39
  v_bfi_b32 v20, 1, s57, v20
  v_smfmac_f32_16x16x64_bf16 v[40:43], v[68:71], v[28:35], v0
  buffer_store_dwordx2 v[20:21], v7, s[4:7], s21 offen offset:0 sc1
  s_nop 6
  v_cvt_pk_bf16_f32 v22, v40, v41
  v_cvt_pk_bf16_f32 v23, v42, v43
  v_bfi_b32 v22, 1, s57, v22
  buffer_store_dwordx2 v[22:23], v7, s[4:7], s21 offen offset:64 sc1
  ds_read_b128 v[68:71], v4 offset:0
  ds_read_b128 v[72:75], v4 offset:1024
  ds_read_b128 v[76:79], v4 offset:4096
  ds_read_b128 v[80:83], v4 offset:5120
  ds_read_b128 v[84:87], v4 offset:8192
  ds_read_b128 v[88:91], v4 offset:9216
  v_mov_b64 v[16:17], 0
  v_mov_b64 v[18:19], 0
  v_mov_b64 v[20:21], 0
  v_mov_b64 v[22:23], 0
  v_mov_b64 v[24:25], 0
  v_mov_b64 v[26:27], 0
  s_mov_b32 s19, 0
  v_mov_b32 v49, -1
  s_waitcnt vmcnt(2)
  buffer_load_dwordx4 v[52:55], v2, s[4:7], s22 offen offset:0 sc1
  buffer_load_dwordx4 v[56:59], v2, s[4:7], s22 offen offset:1024 sc1
  buffer_load_dwordx4 v[60:63], v2, s[4:7], s22 offen offset:2048 sc1
  buffer_load_dwordx4 v[64:67], v2, s[4:7], s22 offen offset:3072 sc1
  ds_read_b128 v[92:95], v4 offset:2048
  ds_read_b128 v[96:99], v4 offset:3072
  ds_read_b128 v[100:103], v4 offset:6144
  ds_read_b128 v[104:107], v4 offset:7168
  ds_read_b128 v[108:111], v4 offset:10240
  ds_read_b128 v[112:115], v4 offset:11264
  ds_read_b64 v[44:45], v2 offset:32256
  s_waitcnt lgkmcnt(0)
  v_readfirstlane_b32 s38, v44
  v_readfirstlane_b32 s37, v45
  s_nop 0
  s_add_u32 s37, s37, 30
  s_cmp_ge_u32 s38, 30
  s_cselect_b32 s38, s37, s38
  s_cmp_ge_u32 s38, 64
  s_cselect_b32 s38, 100, s38
  s_sub_u32 s38, s38, 1
  s_max_i32 s30, s30, s38
  s_waitcnt lgkmcnt(12)
  s_waitcnt vmcnt(3)
  v_mfma_f32_16x16x32_bf16 v[120:123], v[116:119], v[52:55], 0
  v_xor_b32 v48, s57, v52
  v_bitop3_b32 v48, v48, v54, s57 bitop3:0xf6
  s_waitcnt vmcnt(2)
  v_mfma_f32_16x16x32_bf16 v[120:123], v[116:119], v[56:59], v[120:123]
  v_bitop3_b32 v48, v48, v56, s57 bitop3:0xf6
  v_bitop3_b32 v48, v48, v58, s57 bitop3:0xf6
  s_waitcnt vmcnt(1)
  v_mfma_f32_16x16x32_bf16 v[120:123], v[116:119], v[60:63], v[120:123]
  v_bitop3_b32 v48, v48, v60, s57 bitop3:0xf6
  v_bitop3_b32 v48, v48, v62, s57 bitop3:0xf6
  s_waitcnt vmcnt(0)
  v_mfma_f32_16x16x32_bf16 v[120:123], v[116:119], v[64:67], v[120:123]
  v_bitop3_b32 v48, v48, v64, s57 bitop3:0xf6
  v_bitop3_b32 v48, v48, v66, s57 bitop3:0xf6
  v_and_b32 v48, 1, v48
  v_cmp_ne_u32 vcc, 0, v48
  s_cbranch_vccnz T_p1re_151
T_p1ok_152:
  s_nop 2
  v_add_f32_dpp v120, v120, v120 row_ror:8 row_mask:0xf bank_mask:0xf
  v_add_f32_dpp v121, v121, v121 row_ror:8 row_mask:0xf bank_mask:0xf
  v_cvt_pk_bf16_f32 v48, v120, v121
  v_min_u32 v48, -2, v48
  buffer_store_dword v48, v8, s[4:7], s35 offen sc1
  buffer_store_dword v49, v8, s[4:7], s26 offen sc1
  s_barrier
  ds_read_b128 v[28:31], v2 offset:16384
  ds_read_b128 v[32:35], v2 offset:20480
  ds_read_b128 v[36:39], v2 offset:8192
  ds_read_b128 v[40:43], v2 offset:9216
  ds_read_b128 v[44:47], v2 offset:10240
  ds_read_b128 v[48:51], v2 offset:11264
  buffer_load_dwordx4 v[124:127], v3, s[4:7], s24 offen offset:0 sc1
  buffer_load_dwordx4 v[116:119], v3, s[4:7], s25 offen offset:0 sc1
  ds_read_b128 v[52:55], v2 offset:12288
  ds_read_b128 v[56:59], v2 offset:13312
  ds_read_b128 v[60:63], v2 offset:14336
  ds_read_b128 v[64:67], v2 offset:15360
  buffer_load_dwordx4 v[124:127], v3, s[4:7], s24 offen offset:0 sc1
  buffer_load_dwordx4 v[116:119], v3, s[4:7], s25 offen offset:0 sc1
  s_mov_b32 s19, 0
  s_branch T_loop_141
T_p1re_151:
  s_mov_b64 exec, vcc
  buffer_load_dwordx4 v[52:55], v2, s[4:7], s22 offen offset:0 sc1
  buffer_load_dwordx4 v[56:59], v2, s[4:7], s22 offen offset:1024 sc1
  buffer_load_dwordx4 v[60:63], v2, s[4:7], s22 offen offset:2048 sc1
  buffer_load_dwordx4 v[64:67], v2, s[4:7], s22 offen offset:3072 sc1
  s_mov_b64 exec, -1
  s_add_u32 s19, s19, 1
  s_cmp_gt_u32 s19, 32768
  s_cbranch_scc1 M_exit
  s_waitcnt vmcnt(3)
  v_mfma_f32_16x16x32_bf16 v[120:123], v[116:119], v[52:55], 0
  v_xor_b32 v48, s57, v52
  v_bitop3_b32 v48, v48, v54, s57 bitop3:0xf6
  s_waitcnt vmcnt(2)
  v_mfma_f32_16x16x32_bf16 v[120:123], v[116:119], v[56:59], v[120:123]
  v_bitop3_b32 v48, v48, v56, s57 bitop3:0xf6
  v_bitop3_b32 v48, v48, v58, s57 bitop3:0xf6
  s_waitcnt vmcnt(1)
  v_mfma_f32_16x16x32_bf16 v[120:123], v[116:119], v[60:63], v[120:123]
  v_bitop3_b32 v48, v48, v60, s57 bitop3:0xf6
  v_bitop3_b32 v48, v48, v62, s57 bitop3:0xf6
  s_waitcnt vmcnt(0)
  v_mfma_f32_16x16x32_bf16 v[120:123], v[116:119], v[64:67], v[120:123]
  v_bitop3_b32 v48, v48, v64, s57 bitop3:0xf6
  v_bitop3_b32 v48, v48, v66, s57 bitop3:0xf6
  v_and_b32 v48, 1, v48
  v_cmp_ne_u32 vcc, 0, v48
  s_cbranch_vccnz T_p1re_151
  s_branch T_p1ok_152
T_kvw_145:
  s_mov_b32 s19, 0
  s_branch T_kvok_154
T_kv_153:
  s_sleep 4
  s_add_u32 s19, s19, 1
  s_cmp_gt_u32 s19, 32768
  s_cbranch_scc1 M_exit
T_kvok_154:
  s_add_u32 s39, s99, 128
  s_mov_b32 s38, 0
  s_mov_b32 s37, 0
  s_atomic_or s38, s[58:59], s99 glc
  s_atomic_or s37, s[58:59], s39 glc
  s_waitcnt lgkmcnt(0)
  s_add_u32 s37, s37, 30
  s_cmp_ge_u32 s38, 30
  s_cselect_b32 s38, s37, s38
  s_cmp_ge_u32 s38, 64
  s_cselect_b32 s38, 100, s38
  s_sub_u32 s38, s38, 1
  s_max_i32 s30, s30, s38
  s_cmp_ge_i32 s14, s30
  s_cbranch_scc1 T_kv_153
  s_branch T_kvb_146
T_slow_148:
  s_nop 7
  v_max3_f32 v100, v16, v17, v18
  v_max3_f32 v100, v100, v19, v20
  v_max3_f32 v100, v100, v21, v22
  v_max3_f32 v100, v100, v23, v112
  v_max3_f32 v100, v100, v113, v114
  v_max_f32 v100, v100, v115
  v_mov_b32 v101, v100
  s_nop 1
  v_permlane32_swap_b32 v100, v101
  s_nop 1
  v_max_f32 v100, v100, v101
  v_mov_b32 v101, v100
  s_nop 1
  v_permlane16_swap_b32 v100, v101
  s_nop 1
  v_max_f32 v100, v100, v101
  v_sub_f32 v16, v16, v100
  v_sub_f32 v17, v17, v100
  v_sub_f32 v18, v18, v100
  v_sub_f32 v19, v19, v100
  v_exp_f32 v16, v16
  v_exp_f32 v17, v17
  v_exp_f32 v18, v18
  v_exp_f32 v19, v19
  v_sub_f32 v20, v20, v100
  v_sub_f32 v21, v21, v100
  v_sub_f32 v22, v22, v100
  v_sub_f32 v23, v23, v100
  v_exp_f32 v20, v20
  v_exp_f32 v21, v21
  v_exp_f32 v22, v22
  v_exp_f32 v23, v23
  v_sub_f32 v112, v112, v100
  v_sub_f32 v113, v113, v100
  v_sub_f32 v114, v114, v100
  v_sub_f32 v115, v115, v100
  v_exp_f32 v112, v112
  v_exp_f32 v113, v113
  v_exp_f32 v114, v114
  v_exp_f32 v115, v115
  s_nop 0
  v_cvt_pk_bf16_f32 v44, v16, v17
  v_cvt_pk_bf16_f32 v45, v18, v19
  v_cvt_pk_bf16_f32 v46, v20, v21
  v_cvt_pk_bf16_f32 v47, v22, v23
  v_cvt_pk_bf16_f32 v84, v112, v113
  v_cvt_pk_bf16_f32 v85, v114, v115
  v_cndmask_b32 v48, v84, 0, s[16:17]
  v_cndmask_b32 v49, v85, 0, s[16:17]
  v_cndmask_b32 v50, 0, v84, s[16:17]
  v_cndmask_b32 v51, 0, v85, s[16:17]
  s_nop 1
  v_mfma_f32_16x16x16_bf16 v[88:91], v[12:13], v[48:49], 0
  v_mfma_f32_16x16x16_bf16 v[24:27], v[120:121], v[48:49], 0
  v_mfma_f32_16x16x16_bf16 v[116:119], v[120:121], v[50:51], 0
  v_mfma_f32_16x16x32_bf16 v[88:91], v[12:15], v[44:47], v[88:91]
  v_mfma_f32_16x16x32_bf16 v[24:27], v[28:31], v[44:47], v[24:27]
  v_mfma_f32_16x16x32_bf16 v[116:119], v[32:35], v[44:47], v[116:119]
  s_nop 7
  s_nop 1
  v_rcp_f32 v89, v88
  s_nop 0
  v_mul_f32 v24, v89, v24
  v_mul_f32 v25, v89, v25
  s_branch T_back_149
T_w_138:
  s_mov_b32 s19, 0
  v_mov_b64 v[16:17], 0
  v_mov_b64 v[18:19], 0
  v_mov_b64 v[20:21], 0
  v_mov_b64 v[22:23], 0
  v_mov_b64 v[24:25], 0
  v_mov_b64 v[26:27], 0
  buffer_load_dwordx4 v[124:127], v3, s[4:7], s24 offen offset:1024 sc1
  buffer_load_dwordx4 v[116:119], v3, s[4:7], s25 offen offset:1024 sc1
  buffer_load_dwordx4 v[124:127], v3, s[4:7], s24 offen offset:1024 sc1
  buffer_load_dwordx4 v[116:119], v3, s[4:7], s25 offen offset:1024 sc1
  s_branch T_loop_155
.p2align 6
T_retry_156:
  s_mov_b64 exec, vcc
  buffer_load_dwordx4 v[124:127], v3, s[4:7], s24 offen offset:1024 sc1
  buffer_load_dwordx4 v[116:119], v3, s[4:7], s25 offen offset:1024 sc1
  s_mov_b64 exec, -1
  s_add_u32 s19, s19, 1
  s_cmp_gt_u32 s19, 32768
  s_cbranch_scc1 M_exit
T_loop_155:
  s_waitcnt vmcnt(3) lgkmcnt(0)
  v_max3_u32 v123, v124, v125, v126
  v_max_u32 v123, v123, v127
  v_mov_b32_dpp v120, v124 row_ror:8 row_mask:0xf bank_mask:0xf
  v_mov_b32_dpp v121, v125 row_ror:8 row_mask:0xf bank_mask:0xf
  s_waitcnt vmcnt(2)
  v_max3_u32 v123, v123, v116, v117
  v_max3_u32 v123, v123, v118, v119
  v_cmp_eq_u32 vcc, -1, v123
  s_cbranch_vccnz T_retry_156
  v_smfmac_f32_16x16x64_bf16 v[16:19], v[124:127], v[68:75], v0
  s_add_u32 s14, s14, 1
  ds_write_b128 v2, v[124:127] offset:1024
  v_mov_b32_dpp v122, v126 row_ror:8 row_mask:0xf bank_mask:0xf
  v_smfmac_f32_16x16x64_bf16 v[20:23], v[124:127], v[76:83], v0
  s_and_b32 s57, s14, 1
  v_mov_b32_dpp v123, v127 row_ror:8 row_mask:0xf bank_mask:0xf
  v_smfmac_f32_16x16x64_bf16 v[24:27], v[124:127], v[84:91], v0
  s_and_b32 s36, s14, 3
  ds_write_b128 v2, v[116:119] offset:5120
  v_smfmac_f32_16x16x64_bf16 v[16:19], v[120:123], v[92:99], v0
  s_lshl_b32 s36, s36, 13
  v_mov_b32_dpp v84, v116 row_ror:8 row_mask:0xf bank_mask:0xf
  v_smfmac_f32_16x16x64_bf16 v[20:23], v[120:123], v[100:107], v0
  s_add_u32 s26, s36, s23
  ds_read_b128 v[68:71], v4 offset:12288
  v_mov_b32_dpp v85, v117 row_ror:8 row_mask:0xf bank_mask:0xf
  v_smfmac_f32_16x16x64_bf16 v[24:27], v[120:123], v[108:115], v0
  s_add_u32 s36, s36, 8192
  ds_read_b128 v[72:75], v4 offset:13312
  v_mov_b32_dpp v86, v118 row_ror:8 row_mask:0xf bank_mask:0xf
  v_smfmac_f32_16x16x64_bf16 v[16:19], v[116:119], v[224:231], v0
  s_and_b32 s36, s36, 0x7fff
  ds_read_b128 v[76:79], v4 offset:14336
  v_mov_b32_dpp v87, v119 row_ror:8 row_mask:0xf bank_mask:0xf
  v_smfmac_f32_16x16x64_bf16 v[20:23], v[116:119], v[240:247], v0
  s_waitcnt lgkmcnt(3)
  s_barrier
  ds_read_b128 v[100:103], v2 offset:0
  v_smfmac_f32_16x16x64_bf16 v[24:27], v[116:119], a[0:7], v0
  s_mov_b32 m0, s31
  ds_read_b128 v[120:123], v1 offset:0
  v_smfmac_f32_16x16x64_bf16 v[16:19], v[84:87], v[232:239], v0
  s_cmp_ge_i32 s14, s30
  s_cbranch_scc1 T_kvw_159
T_kvb_160:
  v_smfmac_f32_16x16x64_bf16 v[20:23], v[84:87], v[248:255], v0
  ds_read_b128 v[80:83], v4 offset:15360
  v_smfmac_f32_16x16x64_bf16 v[24:27], v[84:87], a[8:15], v0
  s_waitcnt lgkmcnt(2)
  buffer_load_dwordx4 v9, s[4:7], s27 offen sc1 lds
  v_smfmac_f32_16x16x64_bf16 v[16:19], v[100:103], v[128:135], v0
  ds_read_b128 v[92:95], v2 offset:3072
  s_mov_b32 m0, s32
  v_smfmac_f32_16x16x64_bf16 v[20:23], v[100:103], v[144:151], v0
  ds_read_b128 v[96:99], v1 offset:3072
  v_smfmac_f32_16x16x64_bf16 v[24:27], v[100:103], v[68:75], v0
  s_waitcnt vmcnt(1) lgkmcnt(3)
  ds_read_b128 v[116:119], v2 offset:2048
  v_smfmac_f32_16x16x64_bf16 v[16:19], v[120:123], v[136:143], v0
  ds_read_b128 v[124:127], v1 offset:2048
  buffer_load_dwordx4 v9, s[4:7], s27 offen offset:128 sc1 lds
  v_smfmac_f32_16x16x64_bf16 v[20:23], v[120:123], v[152:159], v0
  s_waitcnt lgkmcnt(4)
  ds_read_b128 v[104:107], v2 offset:4096
  s_mov_b32 m0, s33
  v_smfmac_f32_16x16x64_bf16 v[24:27], v[120:123], v[76:83], v0
  s_waitcnt lgkmcnt(4)
  ds_read_b128 v[108:111], v1 offset:4096
  v_smfmac_f32_16x16x64_bf16 v[16:19], v[92:95], v[160:167], v0
  s_waitcnt lgkmcnt(4)
  ds_read_b128 v[112:115], v2 offset:7168
  v_smfmac_f32_16x16x64_bf16 v[16:19], v[96:99], v[168:175], v0
  s_waitcnt lgkmcnt(4)
  ds_read_b128 v[84:87], v1 offset:7168
  buffer_load_dwordx4 v10, s[4:7], s28 offen sc1 lds
  v_smfmac_f32_16x16x64_bf16 v[16:19], v[116:119], v[192:199], v0
  s_waitcnt lgkmcnt(4)
  ds_read_b128 v[88:91], v2 offset:6144
  s_mov_b32 m0, s34
  v_smfmac_f32_16x16x64_bf16 v[16:19], v[124:127], v[200:207], v0
  s_waitcnt lgkmcnt(4)
  ds_read_b128 v[100:103], v1 offset:6144
  v_smfmac_f32_16x16x64_bf16 v[16:19], v[104:107], a[16:23], v0
  s_waitcnt lgkmcnt(4)
  ds_read_b128 v[68:71], v4 offset:16384
  v_smfmac_f32_16x16x64_bf16 v[16:19], v[108:111], a[24:31], v0
  s_waitcnt lgkmcnt(4)
  ds_read_b128 v[72:75], v4 offset:17408
  buffer_load_dwordx4 v10, s[4:7], s28 offen offset:256 sc1 lds
  v_smfmac_f32_16x16x64_bf16 v[16:19], v[112:115], a[64:71], v0
  s_waitcnt lgkmcnt(4)
  ds_read_b128 v[76:79], v4 offset:18432
  v_smfmac_f32_16x16x64_bf16 v[16:19], v[84:87], a[72:79], v0
  s_waitcnt lgkmcnt(4)
  ds_read_b128 v[80:83], v4 offset:19456
  v_smfmac_f32_16x16x64_bf16 v[16:19], v[88:91], a[112:119], v0
  s_waitcnt lgkmcnt(4)
  v_smfmac_f32_16x16x64_bf16 v[16:19], v[100:103], a[120:127], v0
  s_add_u32 s24, s36, 145752064
  s_add_u32 s25, s36, 145756160
  v_smfmac_f32_16x16x64_bf16 v[20:23], v[92:95], v[176:183], v0
  s_add_u32 s35, s36, s23
  v_smfmac_f32_16x16x64_bf16 v[20:23], v[96:99], v[184:191], v0
  s_waitcnt lgkmcnt(2)
  v_smfmac_f32_16x16x64_bf16 v[20:23], v[116:119], v[68:75], v0
  s_waitcnt lgkmcnt(0)
  ds_read_b128 v[68:71], v4 offset:20480
  v_mul_f32 v16, s18, v16
  v_smfmac_f32_16x16x64_bf16 v[20:23], v[124:127], v[76:83], v0
  ds_read_b128 v[72:75], v4 offset:21504
  v_mul_f32 v17, s18, v17
  v_smfmac_f32_16x16x64_bf16 v[20:23], v[104:107], a[32:39], v0
  ds_read_b128 v[76:79], v4 offset:22528
  v_mul_f32 v18, s18, v18
  v_smfmac_f32_16x16x64_bf16 v[20:23], v[108:111], a[40:47], v0
  ds_read_b128 v[80:83], v4 offset:23552
  v_mul_f32 v19, s18, v19
  v_smfmac_f32_16x16x64_bf16 v[20:23], v[112:115], a[80:87], v0
  v_cvt_pk_bf16_f32 v120, v16, v17
  v_smfmac_f32_16x16x64_bf16 v[20:23], v[84:87], a[88:95], v0
  v_cvt_pk_bf16_f32 v121, v18, v19
  v_smfmac_f32_16x16x64_bf16 v[20:23], v[88:91], a[128:135], v0
  ds_write_b64 v5, v[120:121] offset:24576
  v_smfmac_f32_16x16x64_bf16 v[20:23], v[100:103], a[136:143], v0
  s_waitcnt lgkmcnt(3)
  v_smfmac_f32_16x16x64_bf16 v[24:27], v[92:95], v[68:75], v0
  s_waitcnt lgkmcnt(1)
  v_mov_b64 v[92:93], 0
  v_smfmac_f32_16x16x64_bf16 v[24:27], v[96:99], v[76:83], v0
  s_nop 1
  v_cvt_pk_bf16_f32 v122, v20, v21
  v_cvt_pk_bf16_f32 v123, v22, v23
  v_smfmac_f32_16x16x64_bf16 v[24:27], v[116:119], v[208:215], v0
  ds_write_b64 v5, v[122:123] offset:26880
  v_mov_b64 v[94:95], 0
  v_smfmac_f32_16x16x64_bf16 v[24:27], v[124:127], v[216:223], v0
  s_waitcnt lgkmcnt(1)
  s_barrier
  ds_read_b64_tr_b16 v[68:69], v6 offset:24576
  v_smfmac_f32_16x16x64_bf16 v[24:27], v[104:107], a[48:55], v0
  s_add_u32 s27, s27, 8192
  ds_read_b64_tr_b16 v[70:71], v6 offset:24640
  ds_read_b64_tr_b16 v[72:73], v6 offset:24832
  v_smfmac_f32_16x16x64_bf16 v[24:27], v[108:111], a[56:63], v0
  s_add_u32 s28, s28, 8192
  ds_read_b64_tr_b16 v[74:75], v6 offset:24896
  ds_read_b64_tr_b16 v[76:77], v6 offset:25088
  v_smfmac_f32_16x16x64_bf16 v[24:27], v[112:115], a[96:103], v0
  s_nop 0
  ds_read_b64_tr_b16 v[78:79], v6 offset:25152
  ds_read_b64_tr_b16 v[80:81], v6 offset:25344
  v_smfmac_f32_16x16x64_bf16 v[24:27], v[84:87], a[104:111], v0
  ds_read_b64_tr_b16 v[82:83], v6 offset:25408
  v_mov_b64 v[96:97], 0
  v_smfmac_f32_16x16x64_bf16 v[24:27], v[88:91], a[144:151], v0
  s_waitcnt lgkmcnt(8)
  s_barrier
  ds_read_b64_tr_b16 v[116:117], v6 offset:26880
  v_smfmac_f32_16x16x64_bf16 v[24:27], v[100:103], a[152:159], v0
  s_waitcnt lgkmcnt(7)
  ds_read_b64_tr_b16 v[118:119], v6 offset:26944
  v_mfma_f32_16x16x32_bf16 v[16:19], v[36:39], v[68:71], 0
  s_waitcnt lgkmcnt(6)
  ds_read_b64_tr_b16 v[124:125], v6 offset:27136
  ds_read_b64_tr_b16 v[126:127], v6 offset:27200
  v_mfma_f32_16x16x32_bf16 v[16:19], v[40:43], v[72:75], v[16:19]
  s_waitcnt lgkmcnt(6)
  ds_read_b64_tr_b16 v[104:105], v6 offset:27392
  ds_read_b64_tr_b16 v[106:107], v6 offset:27456
  v_mfma_f32_16x16x32_bf16 v[16:19], v[44:47], v[76:79], v[16:19]
  s_waitcnt lgkmcnt(6)
  ds_read_b64_tr_b16 v[108:109], v6 offset:27648
  ds_read_b64_tr_b16 v[110:111], v6 offset:27712
  v_mfma_f32_16x16x32_bf16 v[16:19], v[48:51], v[80:83], v[16:19]
  s_waitcnt lgkmcnt(6)
  v_cvt_pk_bf16_f32 v120, v24, v25
  v_cvt_pk_bf16_f32 v121, v26, v27
  v_mfma_f32_16x16x32_bf16 v[112:115], v[116:119], v[68:71], 0
  s_waitcnt lgkmcnt(4)
  buffer_store_dwordx4 v[120:123], v2, s[4:7], s29 offen offset:1024 sc1
  v_mov_b64 v[98:99], 0
  v_mfma_f32_16x16x32_bf16 v[112:115], v[124:127], v[72:75], v[112:115]
  s_waitcnt lgkmcnt(2)
  v_mov_b64 v[36:37], 0
  v_exp_f32 v100, v16
  v_mfma_f32_16x16x32_bf16 v[112:115], v[104:107], v[76:79], v[112:115]
  s_waitcnt lgkmcnt(0)
  v_exp_f32 v101, v17
  v_mfma_f32_16x16x32_bf16 v[112:115], v[108:111], v[80:83], v[112:115]
  s_add_u32 s29, s29, 131072
  v_exp_f32 v102, v18
  v_mfma_f32_16x16x32_bf16 v[20:23], v[52:55], v[68:71], 0
  s_cmp_eq_u32 s14, 63
  v_exp_f32 v103, v19
  v_mfma_f32_16x16x32_bf16 v[20:23], v[56:59], v[72:75], v[20:23]
  s_cbranch_scc1 M_tdone
  v_cvt_pk_bf16_f32 v44, v100, v101
  v_cvt_pk_bf16_f32 v45, v102, v103
  v_mfma_f32_16x16x32_bf16 v[20:23], v[60:63], v[76:79], v[20:23]
  v_exp_f32 v100, v112
  v_mfma_f32_16x16x32_bf16 v[20:23], v[64:67], v[80:83], v[20:23]
  v_exp_f32 v101, v113
  v_exp_f32 v102, v114
  v_exp_f32 v103, v115
  v_cvt_pk_bf16_f32 v84, v100, v101
  v_cvt_pk_bf16_f32 v85, v102, v103
  v_cndmask_b32 v48, v84, 0, s[16:17]
  v_cndmask_b32 v49, v85, 0, s[16:17]
  v_cndmask_b32 v50, 0, v84, s[16:17]
  v_cndmask_b32 v51, 0, v85, s[16:17]
  v_exp_f32 v100, v20
  v_mfma_f32_16x16x16_bf16 v[88:91], v[12:13], v[48:49], 0
  v_exp_f32 v101, v21
  v_mfma_f32_16x16x16_bf16 v[24:27], v[120:121], v[48:49], 0
  v_exp_f32 v102, v22
  v_mfma_f32_16x16x16_bf16 v[116:119], v[120:121], v[50:51], 0
  v_exp_f32 v103, v23
  v_cvt_pk_bf16_f32 v46, v100, v101
  v_cvt_pk_bf16_f32 v47, v102, v103
  v_mov_b64 v[38:39], 0
  s_nop 0
  v_mfma_f32_16x16x32_bf16 v[88:91], v[12:15], v[44:47], v[88:91]
  v_mov_b64 v[40:41], 0
  v_mov_b64 v[42:43], 0
  v_mfma_f32_16x16x32_bf16 v[24:27], v[28:31], v[44:47], v[24:27]
  ds_read_b128 v[52:55], v4 offset:24576
  ds_read_b128 v[56:59], v4 offset:25600
  v_mfma_f32_16x16x32_bf16 v[116:119], v[32:35], v[44:47], v[116:119]
  s_nop 1
  v_rcp_f32 v89, v88
  v_subrev_u32 v100, s54, v88
  v_cmp_le_u32 vcc, s55, v100
  v_mul_f32 v24, v89, v24
  v_mul_f32 v25, v89, v25
  s_cbranch_vccnz T_slow_162
T_back_163:
  v_cvt_pk_bf16_f32 v124, v24, v25
  v_pk_mul_f32 v[26:27], v[26:27], v[88:89] op_sel:[0,1] op_sel_hi:[1,1]
  v_pk_mul_f32 v[116:117], v[116:117], v[88:89] op_sel:[0,1] op_sel_hi:[1,1]
  v_pk_mul_f32 v[118:119], v[118:119], v[88:89] op_sel:[0,1] op_sel_hi:[1,1]
  v_cvt_pk_bf16_f32 v125, v26, v27
  v_cvt_pk_bf16_f32 v126, v116, v117
  v_cvt_pk_bf16_f32 v127, v118, v119
  ds_write_b128 v11, v[124:127] offset:29696
  s_nop 0
  v_smfmac_f32_16x16x64_bf16 v[92:95], v[124:127], a[160:167], v0
  v_smfmac_f32_16x16x64_bf16 v[96:99], v[124:127], a[168:175], v0
  v_smfmac_f32_16x16x64_bf16 v[36:39], v[124:127], a[176:183], v0
  v_smfmac_f32_16x16x64_bf16 v[40:43], v[124:127], a[184:191], v0
  s_waitcnt lgkmcnt(0)
  s_barrier
  ds_read_b128 v[104:107], v11 offset:29184
  ds_read_b128 v[108:111], v11 offset:30720
  ds_read_b128 v[68:71], v11 offset:30208
  s_waitcnt lgkmcnt(2)
  v_smfmac_f32_16x16x64_bf16 v[92:95], v[104:107], a[192:199], v0
  s_waitcnt lgkmcnt(1)
  ds_read_b128 v[76:79], v4 offset:28672
  v_smfmac_f32_16x16x64_bf16 v[92:95], v[108:111], a[224:231], v0
  s_waitcnt lgkmcnt(1)
  ds_read_b128 v[80:83], v4 offset:29696
  v_smfmac_f32_16x16x64_bf16 v[92:95], v[68:71], a[240:247], v0
  ds_read_b128 v[60:63], v4 offset:26624
  v_smfmac_f32_16x16x64_bf16 v[96:99], v[104:107], a[200:207], v0
  ds_read_b128 v[64:67], v4 offset:27648
  v_smfmac_f32_16x16x64_bf16 v[96:99], v[108:111], a[232:239], v0
  ds_read_b128 v[28:31], v4 offset:30720
  s_nop 0
  v_cvt_pk_bf16_f32 v16, v92, v93
  v_cvt_pk_bf16_f32 v17, v94, v95
  v_bfi_b32 v16, 1, s57, v16
  v_smfmac_f32_16x16x64_bf16 v[96:99], v[68:71], a[248:255], v0
  buffer_store_dwordx2 v[16:17], v7, s[4:7], s20 offen offset:0 sc1
  v_smfmac_f32_16x16x64_bf16 v[36:39], v[104:107], a[208:215], v0
  ds_read_b128 v[32:35], v4 offset:31744
  v_smfmac_f32_16x16x64_bf16 v[36:39], v[108:111], v[52:59], v0
  s_waitcnt lgkmcnt(4)
  s_nop 0
  v_cvt_pk_bf16_f32 v18, v96, v97
  v_cvt_pk_bf16_f32 v19, v98, v99
  v_bfi_b32 v18, 1, s57, v18
  v_smfmac_f32_16x16x64_bf16 v[36:39], v[68:71], v[76:83], v0
  buffer_store_dwordx2 v[18:19], v7, s[4:7], s20 offen offset:64 sc1
  v_smfmac_f32_16x16x64_bf16 v[40:43], v[104:107], a[216:223], v0
  s_waitcnt lgkmcnt(2)
  ds_read_b128 v[116:119], v2 offset:31232
  v_smfmac_f32_16x16x64_bf16 v[40:43], v[108:111], v[60:67], v0
  s_waitcnt lgkmcnt(1)
  s_nop 0
  v_cvt_pk_bf16_f32 v20, v36, v37
  v_cvt_pk_bf16_f32 v21, v38, v39
  v_bfi_b32 v20, 1, s57, v20
  v_smfmac_f32_16x16x64_bf16 v[40:43], v[68:71], v[28:35], v0
  buffer_store_dwordx2 v[20:21], v7, s[4:7], s21 offen offset:0 sc1
  s_nop 6
  v_cvt_pk_bf16_f32 v22, v40, v41
  v_cvt_pk_bf16_f32 v23, v42, v43
  v_bfi_b32 v22, 1, s57, v22
  buffer_store_dwordx2 v[22:23], v7, s[4:7], s21 offen offset:64 sc1
  ds_read_b128 v[68:71], v4 offset:0
  ds_read_b128 v[72:75], v4 offset:1024
  ds_read_b128 v[76:79], v4 offset:4096
  ds_read_b128 v[80:83], v4 offset:5120
  ds_read_b128 v[84:87], v4 offset:8192
  ds_read_b128 v[88:91], v4 offset:9216
  ds_read_b128 v[92:95], v4 offset:2048
  ds_read_b128 v[96:99], v4 offset:3072
  ds_read_b128 v[100:103], v4 offset:6144
  ds_read_b128 v[104:107], v4 offset:7168
  ds_read_b128 v[108:111], v4 offset:10240
  ds_read_b128 v[112:115], v4 offset:11264
  v_mov_b64 v[16:17], 0
  v_mov_b64 v[18:19], 0
  v_mov_b64 v[20:21], 0
  v_mov_b64 v[22:23], 0
  v_mov_b64 v[24:25], 0
  v_mov_b64 v[26:27], 0
  s_mov_b32 s19, 0
  v_mov_b32 v49, -1
  ds_read_b64 v[44:45], v2 offset:32256
  s_waitcnt lgkmcnt(0)
  v_readfirstlane_b32 s38, v44
  v_readfirstlane_b32 s37, v45
  s_nop 0
  s_add_u32 s37, s37, 30
  s_cmp_ge_u32 s38, 30
  s_cselect_b32 s38, s37, s38
  s_cmp_ge_u32 s38, 64
  s_cselect_b32 s38, 100, s38
  s_sub_u32 s38, s38, 1
  s_max_i32 s30, s30, s38
  s_waitcnt vmcnt(0)
  buffer_load_dwordx4 v[52:55], v2, s[4:7], s22 offen offset:0 sc1
  buffer_load_dwordx4 v[56:59], v2, s[4:7], s22 offen offset:1024 sc1
  buffer_load_dwordx4 v[60:63], v2, s[4:7], s22 offen offset:2048 sc1
  buffer_load_dwordx4 v[64:67], v2, s[4:7], s22 offen offset:3072 sc1
  s_waitcnt lgkmcnt(12)
  s_waitcnt vmcnt(3)
  v_mfma_f32_16x16x32_bf16 v[120:123], v[116:119], v[52:55], 0
  v_xor_b32 v48, s57, v52
  v_bitop3_b32 v48, v48, v54, s57 bitop3:0xf6
  s_waitcnt vmcnt(2)
  v_mfma_f32_16x16x32_bf16 v[120:123], v[116:119], v[56:59], v[120:123]
  v_bitop3_b32 v48, v48, v56, s57 bitop3:0xf6
  v_bitop3_b32 v48, v48, v58, s57 bitop3:0xf6
  s_waitcnt vmcnt(1)
  v_mfma_f32_16x16x32_bf16 v[120:123], v[116:119], v[60:63], v[120:123]
  v_bitop3_b32 v48, v48, v60, s57 bitop3:0xf6
  v_bitop3_b32 v48, v48, v62, s57 bitop3:0xf6
  s_waitcnt vmcnt(0)
  v_mfma_f32_16x16x32_bf16 v[120:123], v[116:119], v[64:67], v[120:123]
  v_bitop3_b32 v48, v48, v64, s57 bitop3:0xf6
  v_bitop3_b32 v48, v48, v66, s57 bitop3:0xf6
  v_and_b32 v48, 1, v48
  v_cmp_ne_u32 vcc, 0, v48
  s_cbranch_vccnz T_p1re_165
T_p1ok_166:
  s_nop 2
  v_add_f32_dpp v120, v120, v120 row_ror:8 row_mask:0xf bank_mask:0xf
  v_add_f32_dpp v121, v121, v121 row_ror:8 row_mask:0xf bank_mask:0xf
  v_cvt_pk_bf16_f32 v48, v120, v121
  v_min_u32 v48, -2, v48
  buffer_store_dword v48, v8, s[4:7], s35 offen sc1
  buffer_store_dword v49, v8, s[4:7], s26 offen sc1
  s_barrier
  ds_read_b128 v[28:31], v2 offset:17408
  ds_read_b128 v[32:35], v2 offset:21504
  ds_read_b128 v[36:39], v2 offset:8192
  ds_read_b128 v[40:43], v2 offset:9216
  ds_read_b128 v[44:47], v2 offset:10240
  ds_read_b128 v[48:51], v2 offset:11264
  buffer_load_dwordx4 v[124:127], v3, s[4:7], s24 offen offset:1024 sc1
  buffer_load_dwordx4 v[116:119], v3, s[4:7], s25 offen offset:1024 sc1
  ds_read_b128 v[52:55], v2 offset:12288
  ds_read_b128 v[56:59], v2 offset:13312
  ds_read_b128 v[60:63], v2 offset:14336
  ds_read_b128 v[64:67], v2 offset:15360
  buffer_load_dwordx4 v[124:127], v3, s[4:7], s24 offen offset:1024 sc1
  buffer_load_dwordx4 v[116:119], v3, s[4:7], s25 offen offset:1024 sc1
  s_mov_b32 s19, 0
  s_branch T_loop_155
T_p1re_165:
  s_mov_b64 exec, vcc
  buffer_load_dwordx4 v[52:55], v2, s[4:7], s22 offen offset:0 sc1
  buffer_load_dwordx4 v[56:59], v2, s[4:7], s22 offen offset:1024 sc1
  buffer_load_dwordx4 v[60:63], v2, s[4:7], s22 offen offset:2048 sc1
  buffer_load_dwordx4 v[64:67], v2, s[4:7], s22 offen offset:3072 sc1
  s_mov_b64 exec, -1
  s_add_u32 s19, s19, 1
  s_cmp_gt_u32 s19, 32768
  s_cbranch_scc1 M_exit
  s_waitcnt vmcnt(3)
  v_mfma_f32_16x16x32_bf16 v[120:123], v[116:119], v[52:55], 0
  v_xor_b32 v48, s57, v52
  v_bitop3_b32 v48, v48, v54, s57 bitop3:0xf6
  s_waitcnt vmcnt(2)
  v_mfma_f32_16x16x32_bf16 v[120:123], v[116:119], v[56:59], v[120:123]
  v_bitop3_b32 v48, v48, v56, s57 bitop3:0xf6
  v_bitop3_b32 v48, v48, v58, s57 bitop3:0xf6
  s_waitcnt vmcnt(1)
  v_mfma_f32_16x16x32_bf16 v[120:123], v[116:119], v[60:63], v[120:123]
  v_bitop3_b32 v48, v48, v60, s57 bitop3:0xf6
  v_bitop3_b32 v48, v48, v62, s57 bitop3:0xf6
  s_waitcnt vmcnt(0)
  v_mfma_f32_16x16x32_bf16 v[120:123], v[116:119], v[64:67], v[120:123]
  v_bitop3_b32 v48, v48, v64, s57 bitop3:0xf6
  v_bitop3_b32 v48, v48, v66, s57 bitop3:0xf6
  v_and_b32 v48, 1, v48
  v_cmp_ne_u32 vcc, 0, v48
  s_cbranch_vccnz T_p1re_165
  s_branch T_p1ok_166
T_kvw_159:
  s_mov_b32 s19, 0
  s_branch T_kvok_168
T_kv_167:
  s_sleep 4
  s_add_u32 s19, s19, 1
  s_cmp_gt_u32 s19, 32768
  s_cbranch_scc1 M_exit
T_kvok_168:
  s_add_u32 s39, s99, 128
  s_mov_b32 s38, 0
  s_mov_b32 s37, 0
  s_atomic_or s38, s[58:59], s99 glc
  s_atomic_or s37, s[58:59], s39 glc
  s_waitcnt lgkmcnt(0)
  s_add_u32 s37, s37, 30
  s_cmp_ge_u32 s38, 30
  s_cselect_b32 s38, s37, s38
  s_cmp_ge_u32 s38, 64
  s_cselect_b32 s38, 100, s38
  s_sub_u32 s38, s38, 1
  s_max_i32 s30, s30, s38
  s_cmp_ge_i32 s14, s30
  s_cbranch_scc1 T_kv_167
  s_branch T_kvb_160
T_slow_162:
  s_nop 7
  v_max3_f32 v100, v16, v17, v18
  v_max3_f32 v100, v100, v19, v20
  v_max3_f32 v100, v100, v21, v22
  v_max3_f32 v100, v100, v23, v112
  v_max3_f32 v100, v100, v113, v114
  v_max_f32 v100, v100, v115
  v_mov_b32 v101, v100
  s_nop 1
  v_permlane32_swap_b32 v100, v101
  s_nop 1
  v_max_f32 v100, v100, v101
  v_mov_b32 v101, v100
  s_nop 1
  v_permlane16_swap_b32 v100, v101
  s_nop 1
  v_max_f32 v100, v100, v101
  v_sub_f32 v16, v16, v100
  v_sub_f32 v17, v17, v100
  v_sub_f32 v18, v18, v100
  v_sub_f32 v19, v19, v100
  v_exp_f32 v16, v16
  v_exp_f32 v17, v17
  v_exp_f32 v18, v18
  v_exp_f32 v19, v19
  v_sub_f32 v20, v20, v100
  v_sub_f32 v21, v21, v100
  v_sub_f32 v22, v22, v100
  v_sub_f32 v23, v23, v100
  v_exp_f32 v20, v20
  v_exp_f32 v21, v21
  v_exp_f32 v22, v22
  v_exp_f32 v23, v23
  v_sub_f32 v112, v112, v100
  v_sub_f32 v113, v113, v100
  v_sub_f32 v114, v114, v100
  v_sub_f32 v115, v115, v100
  v_exp_f32 v112, v112
  v_exp_f32 v113, v113
  v_exp_f32 v114, v114
  v_exp_f32 v115, v115
  s_nop 0
  v_cvt_pk_bf16_f32 v44, v16, v17
  v_cvt_pk_bf16_f32 v45, v18, v19
  v_cvt_pk_bf16_f32 v46, v20, v21
  v_cvt_pk_bf16_f32 v47, v22, v23
  v_cvt_pk_bf16_f32 v84, v112, v113
  v_cvt_pk_bf16_f32 v85, v114, v115
  v_cndmask_b32 v48, v84, 0, s[16:17]
  v_cndmask_b32 v49, v85, 0, s[16:17]
  v_cndmask_b32 v50, 0, v84, s[16:17]
  v_cndmask_b32 v51, 0, v85, s[16:17]
  s_nop 1
  v_mfma_f32_16x16x16_bf16 v[88:91], v[12:13], v[48:49], 0
  v_mfma_f32_16x16x16_bf16 v[24:27], v[120:121], v[48:49], 0
  v_mfma_f32_16x16x16_bf16 v[116:119], v[120:121], v[50:51], 0
  v_mfma_f32_16x16x32_bf16 v[88:91], v[12:15], v[44:47], v[88:91]
  v_mfma_f32_16x16x32_bf16 v[24:27], v[28:31], v[44:47], v[24:27]
  v_mfma_f32_16x16x32_bf16 v[116:119], v[32:35], v[44:47], v[116:119]
  s_nop 7
  s_nop 1
  v_rcp_f32 v89, v88
  s_nop 0
  v_mul_f32 v24, v89, v24
  v_mul_f32 v25, v89, v25
  s_branch T_back_163
T_w_139:
  s_mov_b32 s19, 0
  v_mov_b64 v[16:17], 0
  v_mov_b64 v[18:19], 0
  v_mov_b64 v[20:21], 0
  v_mov_b64 v[22:23], 0
  v_mov_b64 v[24:25], 0
  v_mov_b64 v[26:27], 0
  buffer_load_dwordx4 v[124:127], v3, s[4:7], s24 offen offset:2048 sc1
  buffer_load_dwordx4 v[116:119], v3, s[4:7], s25 offen offset:2048 sc1
  buffer_load_dwordx4 v[124:127], v3, s[4:7], s24 offen offset:2048 sc1
  buffer_load_dwordx4 v[116:119], v3, s[4:7], s25 offen offset:2048 sc1
  s_branch T_loop_169
.p2align 6
T_retry_170:
  s_mov_b64 exec, vcc
  buffer_load_dwordx4 v[124:127], v3, s[4:7], s24 offen offset:2048 sc1
  buffer_load_dwordx4 v[116:119], v3, s[4:7], s25 offen offset:2048 sc1
  s_mov_b64 exec, -1
  s_add_u32 s19, s19, 1
  s_cmp_gt_u32 s19, 32768
  s_cbranch_scc1 M_exit
T_loop_169:
  s_waitcnt vmcnt(3) lgkmcnt(0)
  v_max3_u32 v123, v124, v125, v126
  v_max_u32 v123, v123, v127
  v_mov_b32_dpp v120, v124 row_ror:8 row_mask:0xf bank_mask:0xf
  v_mov_b32_dpp v121, v125 row_ror:8 row_mask:0xf bank_mask:0xf
  s_waitcnt vmcnt(2)
  v_max3_u32 v123, v123, v116, v117
  v_max3_u32 v123, v123, v118, v119
  v_cmp_eq_u32 vcc, -1, v123
  s_cbranch_vccnz T_retry_170
  v_smfmac_f32_16x16x64_bf16 v[16:19], v[124:127], v[68:75], v0
  s_add_u32 s14, s14, 1
  ds_write_b128 v2, v[124:127] offset:2048
  v_mov_b32_dpp v122, v126 row_ror:8 row_mask:0xf bank_mask:0xf
  v_smfmac_f32_16x16x64_bf16 v[20:23], v[124:127], v[76:83], v0
  s_and_b32 s57, s14, 1
  v_mov_b32_dpp v123, v127 row_ror:8 row_mask:0xf bank_mask:0xf
  v_smfmac_f32_16x16x64_bf16 v[24:27], v[124:127], v[84:91], v0
  s_and_b32 s36, s14, 3
  ds_write_b128 v2, v[116:119] offset:6144
  v_smfmac_f32_16x16x64_bf16 v[16:19], v[120:123], v[92:99], v0
  s_lshl_b32 s36, s36, 13
  v_mov_b32_dpp v84, v116 row_ror:8 row_mask:0xf bank_mask:0xf
  v_smfmac_f32_16x16x64_bf16 v[20:23], v[120:123], v[100:107], v0
  s_add_u32 s26, s36, s23
  ds_read_b128 v[68:71], v4 offset:12288
  v_mov_b32_dpp v85, v117 row_ror:8 row_mask:0xf bank_mask:0xf
  v_smfmac_f32_16x16x64_bf16 v[24:27], v[120:123], v[108:115], v0
  s_add_u32 s36, s36, 8192
  ds_read_b128 v[72:75], v4 offset:13312
  v_mov_b32_dpp v86, v118 row_ror:8 row_mask:0xf bank_mask:0xf
  v_smfmac_f32_16x16x64_bf16 v[16:19], v[116:119], v[224:231], v0
  s_and_b32 s36, s36, 0x7fff
  ds_read_b128 v[76:79], v4 offset:14336
  v_mov_b32_dpp v87, v119 row_ror:8 row_mask:0xf bank_mask:0xf
  v_smfmac_f32_16x16x64_bf16 v[20:23], v[116:119], v[240:247], v0
  s_waitcnt lgkmcnt(3)
  s_barrier
  ds_read_b128 v[100:103], v2 offset:3072
  v_smfmac_f32_16x16x64_bf16 v[24:27], v[116:119], a[0:7], v0
  s_mov_b32 m0, s31
  ds_read_b128 v[120:123], v1 offset:3072
  v_smfmac_f32_16x16x64_bf16 v[16:19], v[84:87], v[232:239], v0
  s_cmp_ge_i32 s14, s30
  s_cbranch_scc1 T_kvw_173
T_kvb_174:
  v_smfmac_f32_16x16x64_bf16 v[20:23], v[84:87], v[248:255], v0
  ds_read_b128 v[80:83], v4 offset:15360
  v_smfmac_f32_16x16x64_bf16 v[24:27], v[84:87], a[8:15], v0
  s_waitcnt lgkmcnt(2)
  v_smfmac_f32_16x16x64_bf16 v[16:19], v[100:103], v[128:135], v0
  ds_read_b128 v[92:95], v2 offset:0
  buffer_load_dwordx4 v9, s[4:7], s27 offen sc1 lds
  v_smfmac_f32_16x16x64_bf16 v[20:23], v[100:103], v[144:151], v0
  ds_read_b128 v[96:99], v1 offset:0
  s_mov_b32 m0, s32
  v_smfmac_f32_16x16x64_bf16 v[24:27], v[100:103], v[68:75], v0
  s_waitcnt vmcnt(1) lgkmcnt(3)
  ds_read_b128 v[116:119], v2 offset:1024
  v_smfmac_f32_16x16x64_bf16 v[16:19], v[120:123], v[136:143], v0
  ds_read_b128 v[124:127], v1 offset:1024
  v_smfmac_f32_16x16x64_bf16 v[20:23], v[120:123], v[152:159], v0
  s_waitcnt lgkmcnt(4)
  ds_read_b128 v[104:107], v2 offset:7168
  buffer_load_dwordx4 v9, s[4:7], s27 offen offset:128 sc1 lds
  v_smfmac_f32_16x16x64_bf16 v[24:27], v[120:123], v[76:83], v0
  s_waitcnt lgkmcnt(4)
  ds_read_b128 v[108:111], v1 offset:7168
  s_mov_b32 m0, s33
  v_smfmac_f32_16x16x64_bf16 v[16:19], v[92:95], v[160:167], v0
  s_waitcnt lgkmcnt(4)
  ds_read_b128 v[112:115], v2 offset:4096
  v_mov_b32 v122, s98
  v_smfmac_f32_16x16x64_bf16 v[16:19], v[96:99], v[168:175], v0
  s_waitcnt lgkmcnt(4)
  ds_read_b128 v[84:87], v1 offset:4096
  v_smfmac_f32_16x16x64_bf16 v[16:19], v[116:119], v[192:199], v0
  s_waitcnt lgkmcnt(4)
  ds_read_b128 v[88:91], v2 offset:5120
  buffer_load_dwordx4 v10, s[4:7], s28 offen sc1 lds
  v_smfmac_f32_16x16x64_bf16 v[16:19], v[124:127], v[200:207], v0
  s_waitcnt lgkmcnt(4)
  ds_read_b128 v[100:103], v1 offset:5120
  s_mov_b32 m0, s34
  v_smfmac_f32_16x16x64_bf16 v[16:19], v[104:107], a[16:23], v0
  s_waitcnt lgkmcnt(4)
  ds_read_b128 v[68:71], v4 offset:16384
  v_smfmac_f32_16x16x64_bf16 v[16:19], v[108:111], a[24:31], v0
  s_waitcnt lgkmcnt(4)
  ds_read_b128 v[72:75], v4 offset:17408
  v_smfmac_f32_16x16x64_bf16 v[16:19], v[112:115], a[64:71], v0
  s_waitcnt lgkmcnt(4)
  ds_read_b128 v[76:79], v4 offset:18432
  buffer_load_dwordx4 v10, s[4:7], s28 offen offset:256 sc1 lds
  v_smfmac_f32_16x16x64_bf16 v[16:19], v[84:87], a[72:79], v0
  s_waitcnt lgkmcnt(4)
  ds_read_b128 v[80:83], v4 offset:19456
  v_smfmac_f32_16x16x64_bf16 v[16:19], v[88:91], a[112:119], v0
  s_waitcnt lgkmcnt(4)
  v_smfmac_f32_16x16x64_bf16 v[16:19], v[100:103], a[120:127], v0
  s_add_u32 s24, s36, 145752064
  s_add_u32 s25, s36, 145756160
  v_smfmac_f32_16x16x64_bf16 v[20:23], v[92:95], v[176:183], v0
  buffer_store_dword v122, v8, s[4:7], s15 offen sc1
  s_add_u32 s35, s36, s23
  v_smfmac_f32_16x16x64_bf16 v[20:23], v[96:99], v[184:191], v0
  s_waitcnt lgkmcnt(2)
  s_add_u32 s98, s14, 1
  v_smfmac_f32_16x16x64_bf16 v[20:23], v[116:119], v[68:75], v0
  s_waitcnt lgkmcnt(0)
  ds_read_b128 v[68:71], v4 offset:20480
  v_mul_f32 v16, s18, v16
  v_smfmac_f32_16x16x64_bf16 v[20:23], v[124:127], v[76:83], v0
  ds_read_b128 v[72:75], v4 offset:21504
  v_mul_f32 v17, s18, v17
  v_smfmac_f32_16x16x64_bf16 v[20:23], v[104:107], a[32:39], v0
  ds_read_b128 v[76:79], v4 offset:22528
  v_mul_f32 v18, s18, v18
  v_smfmac_f32_16x16x64_bf16 v[20:23], v[108:111], a[40:47], v0
  ds_read_b128 v[80:83], v4 offset:23552
  v_mul_f32 v19, s18, v19
  v_smfmac_f32_16x16x64_bf16 v[20:23], v[112:115], a[80:87], v0
  v_cvt_pk_bf16_f32 v120, v16, v17
  v_smfmac_f32_16x16x64_bf16 v[20:23], v[84:87], a[88:95], v0
  v_cvt_pk_bf16_f32 v121, v18, v19
  v_smfmac_f32_16x16x64_bf16 v[20:23], v[88:91], a[128:135], v0
  ds_write_b64 v5, v[120:121] offset:24576
  v_smfmac_f32_16x16x64_bf16 v[20:23], v[100:103], a[136:143], v0
  s_waitcnt lgkmcnt(3)
  v_smfmac_f32_16x16x64_bf16 v[24:27], v[92:95], v[68:75], v0
  s_waitcnt lgkmcnt(1)
  v_mov_b64 v[92:93], 0
  v_smfmac_f32_16x16x64_bf16 v[24:27], v[96:99], v[76:83], v0
  s_nop 1
  v_cvt_pk_bf16_f32 v122, v20, v21
  v_cvt_pk_bf16_f32 v123, v22, v23
  v_smfmac_f32_16x16x64_bf16 v[24:27], v[116:119], v[208:215], v0
  ds_write_b64 v5, v[122:123] offset:26880
  v_mov_b64 v[94:95], 0
  v_smfmac_f32_16x16x64_bf16 v[24:27], v[124:127], v[216:223], v0
  s_waitcnt lgkmcnt(1)
  s_barrier
  ds_read_b64_tr_b16 v[68:69], v6 offset:24576
  v_smfmac_f32_16x16x64_bf16 v[24:27], v[104:107], a[48:55], v0
  s_add_u32 s27, s27, 8192
  ds_read_b64_tr_b16 v[70:71], v6 offset:24640
  ds_read_b64_tr_b16 v[72:73], v6 offset:24832
  v_smfmac_f32_16x16x64_bf16 v[24:27], v[108:111], a[56:63], v0
  s_add_u32 s28, s28, 8192
  ds_read_b64_tr_b16 v[74:75], v6 offset:24896
  ds_read_b64_tr_b16 v[76:77], v6 offset:25088
  v_smfmac_f32_16x16x64_bf16 v[24:27], v[112:115], a[96:103], v0
  s_nop 0
  ds_read_b64_tr_b16 v[78:79], v6 offset:25152
  ds_read_b64_tr_b16 v[80:81], v6 offset:25344
  v_smfmac_f32_16x16x64_bf16 v[24:27], v[84:87], a[104:111], v0
  ds_read_b64_tr_b16 v[82:83], v6 offset:25408
  v_mov_b64 v[96:97], 0
  v_smfmac_f32_16x16x64_bf16 v[24:27], v[88:91], a[144:151], v0
  s_waitcnt lgkmcnt(8)
  s_barrier
  ds_read_b64_tr_b16 v[116:117], v6 offset:26880
  v_smfmac_f32_16x16x64_bf16 v[24:27], v[100:103], a[152:159], v0
  s_waitcnt lgkmcnt(7)
  ds_read_b64_tr_b16 v[118:119], v6 offset:26944
  v_mfma_f32_16x16x32_bf16 v[16:19], v[36:39], v[68:71], 0
  s_waitcnt lgkmcnt(6)
  ds_read_b64_tr_b16 v[124:125], v6 offset:27136
  ds_read_b64_tr_b16 v[126:127], v6 offset:27200
  v_mfma_f32_16x16x32_bf16 v[16:19], v[40:43], v[72:75], v[16:19]
  s_waitcnt lgkmcnt(6)
  ds_read_b64_tr_b16 v[104:105], v6 offset:27392
  ds_read_b64_tr_b16 v[106:107], v6 offset:27456
  v_mfma_f32_16x16x32_bf16 v[16:19], v[44:47], v[76:79], v[16:19]
  s_waitcnt lgkmcnt(6)
  ds_read_b64_tr_b16 v[108:109], v6 offset:27648
  ds_read_b64_tr_b16 v[110:111], v6 offset:27712
  v_mfma_f32_16x16x32_bf16 v[16:19], v[48:51], v[80:83], v[16:19]
  s_waitcnt lgkmcnt(6)
  v_cvt_pk_bf16_f32 v120, v24, v25
  v_cvt_pk_bf16_f32 v121, v26, v27
  v_mfma_f32_16x16x32_bf16 v[112:115], v[116:119], v[68:71], 0
  s_waitcnt lgkmcnt(4)
  buffer_store_dwordx4 v[120:123], v2, s[4:7], s29 offen offset:2048 sc1
  v_mov_b64 v[98:99], 0
  v_mfma_f32_16x16x32_bf16 v[112:115], v[124:127], v[72:75], v[112:115]
  s_waitcnt lgkmcnt(2)
  v_mov_b64 v[36:37], 0
  v_exp_f32 v100, v16
  v_mfma_f32_16x16x32_bf16 v[112:115], v[104:107], v[76:79], v[112:115]
  s_waitcnt lgkmcnt(0)
  v_exp_f32 v101, v17
  v_mfma_f32_16x16x32_bf16 v[112:115], v[108:111], v[80:83], v[112:115]
  s_add_u32 s29, s29, 131072
  v_exp_f32 v102, v18
  v_mfma_f32_16x16x32_bf16 v[20:23], v[52:55], v[68:71], 0
  s_cmp_eq_u32 s14, 63
  v_exp_f32 v103, v19
  v_mfma_f32_16x16x32_bf16 v[20:23], v[56:59], v[72:75], v[20:23]
  s_cbranch_scc1 M_tdone
  v_cvt_pk_bf16_f32 v44, v100, v101
  v_cvt_pk_bf16_f32 v45, v102, v103
  v_mfma_f32_16x16x32_bf16 v[20:23], v[60:63], v[76:79], v[20:23]
  v_exp_f32 v100, v112
  v_mfma_f32_16x16x32_bf16 v[20:23], v[64:67], v[80:83], v[20:23]
  v_exp_f32 v101, v113
  v_exp_f32 v102, v114
  v_exp_f32 v103, v115
  v_cvt_pk_bf16_f32 v84, v100, v101
  v_cvt_pk_bf16_f32 v85, v102, v103
  v_cndmask_b32 v48, v84, 0, s[16:17]
  v_cndmask_b32 v49, v85, 0, s[16:17]
  v_cndmask_b32 v50, 0, v84, s[16:17]
  v_cndmask_b32 v51, 0, v85, s[16:17]
  v_exp_f32 v100, v20
  v_mfma_f32_16x16x16_bf16 v[88:91], v[12:13], v[48:49], 0
  v_exp_f32 v101, v21
  v_mfma_f32_16x16x16_bf16 v[24:27], v[120:121], v[48:49], 0
  v_exp_f32 v102, v22
  v_mfma_f32_16x16x16_bf16 v[116:119], v[120:121], v[50:51], 0
  v_exp_f32 v103, v23
  v_cvt_pk_bf16_f32 v46, v100, v101
  v_cvt_pk_bf16_f32 v47, v102, v103
  v_mov_b64 v[38:39], 0
  s_nop 0
  v_mfma_f32_16x16x32_bf16 v[88:91], v[12:15], v[44:47], v[88:91]
  v_mov_b64 v[40:41], 0
  v_mov_b64 v[42:43], 0
  v_mfma_f32_16x16x32_bf16 v[24:27], v[28:31], v[44:47], v[24:27]
  ds_read_b128 v[52:55], v4 offset:24576
  ds_read_b128 v[56:59], v4 offset:25600
  v_mfma_f32_16x16x32_bf16 v[116:119], v[32:35], v[44:47], v[116:119]
  s_nop 1
  v_rcp_f32 v89, v88
  v_subrev_u32 v100, s54, v88
  v_cmp_le_u32 vcc, s55, v100
  v_mul_f32 v24, v89, v24
  v_mul_f32 v25, v89, v25
  s_cbranch_vccnz T_slow_176
T_back_177:
  v_cvt_pk_bf16_f32 v124, v24, v25
  v_pk_mul_f32 v[26:27], v[26:27], v[88:89] op_sel:[0,1] op_sel_hi:[1,1]
  v_pk_mul_f32 v[116:117], v[116:117], v[88:89] op_sel:[0,1] op_sel_hi:[1,1]
  v_pk_mul_f32 v[118:119], v[118:119], v[88:89] op_sel:[0,1] op_sel_hi:[1,1]
  v_cvt_pk_bf16_f32 v125, v26, v27
  v_cvt_pk_bf16_f32 v126, v116, v117
  v_cvt_pk_bf16_f32 v127, v118, v119
  ds_write_b128 v11, v[124:127] offset:30208
  s_nop 0
  v_smfmac_f32_16x16x64_bf16 v[92:95], v[124:127], a[160:167], v0
  v_smfmac_f32_16x16x64_bf16 v[96:99], v[124:127], a[168:175], v0
  v_smfmac_f32_16x16x64_bf16 v[36:39], v[124:127], a[176:183], v0
  v_smfmac_f32_16x16x64_bf16 v[40:43], v[124:127], a[184:191], v0
  s_waitcnt lgkmcnt(0)
  s_barrier
  ds_read_b128 v[104:107], v11 offset:30720
  ds_read_b128 v[108:111], v11 offset:29184
  ds_read_b128 v[68:71], v11 offset:29696
  s_waitcnt lgkmcnt(2)
  v_smfmac_f32_16x16x64_bf16 v[92:95], v[104:107], a[192:199], v0
  s_waitcnt lgkmcnt(1)
  ds_read_b128 v[76:79], v4 offset:28672
  v_smfmac_f32_16x16x64_bf16 v[92:95], v[108:111], a[224:231], v0
  s_waitcnt lgkmcnt(1)
  ds_read_b128 v[80:83], v4 offset:29696
  v_smfmac_f32_16x16x64_bf16 v[92:95], v[68:71], a[240:247], v0
  ds_read_b128 v[60:63], v4 offset:26624
  v_smfmac_f32_16x16x64_bf16 v[96:99], v[104:107], a[200:207], v0
  ds_read_b128 v[64:67], v4 offset:27648
  v_smfmac_f32_16x16x64_bf16 v[96:99], v[108:111], a[232:239], v0
  ds_read_b128 v[28:31], v4 offset:30720
  s_nop 0
  v_cvt_pk_bf16_f32 v16, v92, v93
  v_cvt_pk_bf16_f32 v17, v94, v95
  v_bfi_b32 v16, 1, s57, v16
  v_smfmac_f32_16x16x64_bf16 v[96:99], v[68:71], a[248:255], v0
  buffer_store_dwordx2 v[16:17], v7, s[4:7], s20 offen offset:0 sc1
  v_smfmac_f32_16x16x64_bf16 v[36:39], v[104:107], a[208:215], v0
  ds_read_b128 v[32:35], v4 offset:31744
  v_smfmac_f32_16x16x64_bf16 v[36:39], v[108:111], v[52:59], v0
  s_waitcnt lgkmcnt(4)
  s_nop 0
  v_cvt_pk_bf16_f32 v18, v96, v97
  v_cvt_pk_bf16_f32 v19, v98, v99
  v_bfi_b32 v18, 1, s57, v18
  v_smfmac_f32_16x16x64_bf16 v[36:39], v[68:71], v[76:83], v0
  buffer_store_dwordx2 v[18:19], v7, s[4:7], s20 offen offset:64 sc1
  v_smfmac_f32_16x16x64_bf16 v[40:43], v[104:107], a[216:223], v0
  s_waitcnt lgkmcnt(2)
  v_smfmac_f32_16x16x64_bf16 v[40:43], v[108:111], v[60:67], v0
  s_waitcnt lgkmcnt(0)
  s_nop 0
  v_cvt_pk_bf16_f32 v20, v36, v37
  v_cvt_pk_bf16_f32 v21, v38, v39
  v_bfi_b32 v20, 1, s57, v20
  v_smfmac_f32_16x16x64_bf16 v[40:43], v[68:71], v[28:35], v0
  buffer_store_dwordx2 v[20:21], v7, s[4:7], s21 offen offset:0 sc1
  s_nop 6
  v_cvt_pk_bf16_f32 v22, v40, v41
  v_cvt_pk_bf16_f32 v23, v42, v43
  v_bfi_b32 v22, 1, s57, v22
  buffer_store_dwordx2 v[22:23], v7, s[4:7], s21 offen offset:64 sc1
  ds_read_b128 v[68:71], v4 offset:0
  ds_read_b128 v[72:75], v4 offset:1024
  ds_read_b128 v[76:79], v4 offset:4096
  ds_read_b128 v[80:83], v4 offset:5120
  ds_read_b128 v[84:87], v4 offset:8192
  ds_read_b128 v[88:91], v4 offset:9216
  ds_read_b128 v[92:95], v4 offset:2048
  ds_read_b128 v[96:99], v4 offset:3072
  ds_read_b128 v[100:103], v4 offset:6144
  ds_read_b128 v[104:107], v4 offset:7168
  ds_read_b128 v[108:111], v4 offset:10240
  ds_read_b128 v[112:115], v4 offset:11264
  v_mov_b64 v[16:17], 0
  v_mov_b64 v[18:19], 0
  v_mov_b64 v[20:21], 0
  v_mov_b64 v[22:23], 0
  v_mov_b64 v[24:25], 0
  v_mov_b64 v[26:27], 0
  ds_read_b64 v[44:45], v2 offset:32256
  s_waitcnt lgkmcnt(0)
  v_readfirstlane_b32 s38, v44
  v_readfirstlane_b32 s37, v45
  s_nop 0
  s_add_u32 s37, s37, 30
  s_cmp_ge_u32 s38, 30
  s_cselect_b32 s38, s37, s38
  s_cmp_ge_u32 s38, 64
  s_cselect_b32 s38, 100, s38
  s_sub_u32 s38, s38, 1
  s_max_i32 s30, s30, s38
  s_waitcnt vmcnt(4)
  s_barrier
  ds_read_b128 v[28:31], v2 offset:18432
  ds_read_b128 v[32:35], v2 offset:22528
  ds_read_b128 v[36:39], v2 offset:8192
  ds_read_b128 v[40:43], v2 offset:9216
  ds_read_b128 v[44:47], v2 offset:10240
  ds_read_b128 v[48:51], v2 offset:11264
  buffer_load_dwordx4 v[124:127], v3, s[4:7], s24 offen offset:2048 sc1
  buffer_load_dwordx4 v[116:119], v3, s[4:7], s25 offen offset:2048 sc1
  ds_read_b128 v[52:55], v2 offset:12288
  ds_read_b128 v[56:59], v2 offset:13312
  ds_read_b128 v[60:63], v2 offset:14336
  ds_read_b128 v[64:67], v2 offset:15360
  buffer_load_dwordx4 v[124:127], v3, s[4:7], s24 offen offset:2048 sc1
  buffer_load_dwordx4 v[116:119], v3, s[4:7], s25 offen offset:2048 sc1
  s_mov_b32 s19, 0
  s_branch T_loop_169
T_kvw_173:
  s_mov_b32 s19, 0
  s_branch T_kvok_182
T_kv_181:
  s_sleep 4
  s_add_u32 s19, s19, 1
  s_cmp_gt_u32 s19, 32768
  s_cbranch_scc1 M_exit
T_kvok_182:
  s_add_u32 s39, s99, 128
  s_mov_b32 s38, 0
  s_mov_b32 s37, 0
  s_atomic_or s38, s[58:59], s99 glc
  s_atomic_or s37, s[58:59], s39 glc
  s_waitcnt lgkmcnt(0)
  s_add_u32 s37, s37, 30
  s_cmp_ge_u32 s38, 30
  s_cselect_b32 s38, s37, s38
  s_cmp_ge_u32 s38, 64
  s_cselect_b32 s38, 100, s38
  s_sub_u32 s38, s38, 1
  s_max_i32 s30, s30, s38
  s_cmp_ge_i32 s14, s30
  s_cbranch_scc1 T_kv_181
  s_branch T_kvb_174
T_slow_176:
  s_nop 7
  v_max3_f32 v100, v16, v17, v18
  v_max3_f32 v100, v100, v19, v20
  v_max3_f32 v100, v100, v21, v22
  v_max3_f32 v100, v100, v23, v112
  v_max3_f32 v100, v100, v113, v114
  v_max_f32 v100, v100, v115
  v_mov_b32 v101, v100
  s_nop 1
  v_permlane32_swap_b32 v100, v101
  s_nop 1
  v_max_f32 v100, v100, v101
  v_mov_b32 v101, v100
  s_nop 1
  v_permlane16_swap_b32 v100, v101
  s_nop 1
  v_max_f32 v100, v100, v101
  v_sub_f32 v16, v16, v100
  v_sub_f32 v17, v17, v100
  v_sub_f32 v18, v18, v100
  v_sub_f32 v19, v19, v100
  v_exp_f32 v16, v16
  v_exp_f32 v17, v17
  v_exp_f32 v18, v18
  v_exp_f32 v19, v19
  v_sub_f32 v20, v20, v100
  v_sub_f32 v21, v21, v100
  v_sub_f32 v22, v22, v100
  v_sub_f32 v23, v23, v100
  v_exp_f32 v20, v20
  v_exp_f32 v21, v21
  v_exp_f32 v22, v22
  v_exp_f32 v23, v23
  v_sub_f32 v112, v112, v100
  v_sub_f32 v113, v113, v100
  v_sub_f32 v114, v114, v100
  v_sub_f32 v115, v115, v100
  v_exp_f32 v112, v112
  v_exp_f32 v113, v113
  v_exp_f32 v114, v114
  v_exp_f32 v115, v115
  s_nop 0
  v_cvt_pk_bf16_f32 v44, v16, v17
  v_cvt_pk_bf16_f32 v45, v18, v19
  v_cvt_pk_bf16_f32 v46, v20, v21
  v_cvt_pk_bf16_f32 v47, v22, v23
  v_cvt_pk_bf16_f32 v84, v112, v113
  v_cvt_pk_bf16_f32 v85, v114, v115
  v_cndmask_b32 v48, v84, 0, s[16:17]
  v_cndmask_b32 v49, v85, 0, s[16:17]
  v_cndmask_b32 v50, 0, v84, s[16:17]
  v_cndmask_b32 v51, 0, v85, s[16:17]
  s_nop 1
  v_mfma_f32_16x16x16_bf16 v[88:91], v[12:13], v[48:49], 0
  v_mfma_f32_16x16x16_bf16 v[24:27], v[120:121], v[48:49], 0
  v_mfma_f32_16x16x16_bf16 v[116:119], v[120:121], v[50:51], 0
  v_mfma_f32_16x16x32_bf16 v[88:91], v[12:15], v[44:47], v[88:91]
  v_mfma_f32_16x16x32_bf16 v[24:27], v[28:31], v[44:47], v[24:27]
  v_mfma_f32_16x16x32_bf16 v[116:119], v[32:35], v[44:47], v[116:119]
  s_nop 7
  s_nop 1
  v_rcp_f32 v89, v88
  s_nop 0
  v_mul_f32 v24, v89, v24
  v_mul_f32 v25, v89, v25
  s_branch T_back_177
T_w_140:
  s_mov_b32 s19, 0
  v_mov_b64 v[16:17], 0
  v_mov_b64 v[18:19], 0
  v_mov_b64 v[20:21], 0
  v_mov_b64 v[22:23], 0
  v_mov_b64 v[24:25], 0
  v_mov_b64 v[26:27], 0
  buffer_load_dwordx4 v[124:127], v3, s[4:7], s24 offen offset:3072 sc1
  buffer_load_dwordx4 v[116:119], v3, s[4:7], s25 offen offset:3072 sc1
  buffer_load_dwordx4 v[124:127], v3, s[4:7], s24 offen offset:3072 sc1
  buffer_load_dwordx4 v[116:119], v3, s[4:7], s25 offen offset:3072 sc1
  s_branch T_loop_183
.p2align 6
T_retry_184:
  s_mov_b64 exec, vcc
  buffer_load_dwordx4 v[124:127], v3, s[4:7], s24 offen offset:3072 sc1
  buffer_load_dwordx4 v[116:119], v3, s[4:7], s25 offen offset:3072 sc1
  s_mov_b64 exec, -1
  s_add_u32 s19, s19, 1
  s_cmp_gt_u32 s19, 32768
  s_cbranch_scc1 M_exit
T_loop_183:
  s_waitcnt vmcnt(3) lgkmcnt(0)
  v_max3_u32 v123, v124, v125, v126
  v_max_u32 v123, v123, v127
  v_mov_b32_dpp v120, v124 row_ror:8 row_mask:0xf bank_mask:0xf
  v_mov_b32_dpp v121, v125 row_ror:8 row_mask:0xf bank_mask:0xf
  s_waitcnt vmcnt(2)
  v_max3_u32 v123, v123, v116, v117
  v_max3_u32 v123, v123, v118, v119
  v_cmp_eq_u32 vcc, -1, v123
  s_cbranch_vccnz T_retry_184
  v_smfmac_f32_16x16x64_bf16 v[16:19], v[124:127], v[68:75], v0
  s_add_u32 s14, s14, 1
  ds_write_b128 v2, v[124:127] offset:3072
  v_mov_b32_dpp v122, v126 row_ror:8 row_mask:0xf bank_mask:0xf
  v_smfmac_f32_16x16x64_bf16 v[20:23], v[124:127], v[76:83], v0
  s_and_b32 s57, s14, 1
  v_mov_b32_dpp v123, v127 row_ror:8 row_mask:0xf bank_mask:0xf
  v_smfmac_f32_16x16x64_bf16 v[24:27], v[124:127], v[84:91], v0
  s_and_b32 s36, s14, 3
  ds_write_b128 v2, v[116:119] offset:7168
  v_smfmac_f32_16x16x64_bf16 v[16:19], v[120:123], v[92:99], v0
  s_lshl_b32 s36, s36, 13
  v_mov_b32_dpp v84, v116 row_ror:8 row_mask:0xf bank_mask:0xf
  v_smfmac_f32_16x16x64_bf16 v[20:23], v[120:123], v[100:107], v0
  s_add_u32 s26, s36, s23
  ds_read_b128 v[68:71], v4 offset:12288
  v_mov_b32_dpp v85, v117 row_ror:8 row_mask:0xf bank_mask:0xf
  v_smfmac_f32_16x16x64_bf16 v[24:27], v[120:123], v[108:115], v0
  s_add_u32 s36, s36, 8192
  ds_read_b128 v[72:75], v4 offset:13312
  v_mov_b32_dpp v86, v118 row_ror:8 row_mask:0xf bank_mask:0xf
  v_smfmac_f32_16x16x64_bf16 v[16:19], v[116:119], v[224:231], v0
  s_and_b32 s36, s36, 0x7fff
  ds_read_b128 v[76:79], v4 offset:14336
  v_mov_b32_dpp v87, v119 row_ror:8 row_mask:0xf bank_mask:0xf
  v_smfmac_f32_16x16x64_bf16 v[20:23], v[116:119], v[240:247], v0
  s_waitcnt lgkmcnt(3)
  s_barrier
  ds_read_b128 v[100:103], v2 offset:2048
  v_smfmac_f32_16x16x64_bf16 v[24:27], v[116:119], a[0:7], v0
  s_mov_b32 m0, s31
  ds_read_b128 v[120:123], v1 offset:2048
  v_smfmac_f32_16x16x64_bf16 v[16:19], v[84:87], v[232:239], v0
  s_cmp_ge_i32 s14, s30
  s_cbranch_scc1 T_kvw_187
T_kvb_188:
  v_smfmac_f32_16x16x64_bf16 v[20:23], v[84:87], v[248:255], v0
  ds_read_b128 v[80:83], v4 offset:15360
  v_smfmac_f32_16x16x64_bf16 v[24:27], v[84:87], a[8:15], v0
  s_waitcnt lgkmcnt(2)
  v_smfmac_f32_16x16x64_bf16 v[16:19], v[100:103], v[128:135], v0
  ds_read_b128 v[92:95], v2 offset:1024
  v_smfmac_f32_16x16x64_bf16 v[20:23], v[100:103], v[144:151], v0
  ds_read_b128 v[96:99], v1 offset:1024
  buffer_load_dwordx4 v9, s[4:7], s27 offen sc1 lds
  v_smfmac_f32_16x16x64_bf16 v[24:27], v[100:103], v[68:75], v0
  s_waitcnt vmcnt(1) lgkmcnt(3)
  ds_read_b128 v[116:119], v2 offset:0
  s_mov_b32 m0, s32
  v_smfmac_f32_16x16x64_bf16 v[16:19], v[120:123], v[136:143], v0
  ds_read_b128 v[124:127], v1 offset:0
  v_smfmac_f32_16x16x64_bf16 v[20:23], v[120:123], v[152:159], v0
  s_waitcnt lgkmcnt(4)
  ds_read_b128 v[104:107], v2 offset:6144
  v_smfmac_f32_16x16x64_bf16 v[24:27], v[120:123], v[76:83], v0
  s_waitcnt lgkmcnt(4)
  ds_read_b128 v[108:111], v1 offset:6144
  buffer_load_dwordx4 v9, s[4:7], s27 offen offset:128 sc1 lds
  v_smfmac_f32_16x16x64_bf16 v[16:19], v[92:95], v[160:167], v0
  s_waitcnt lgkmcnt(4)
  ds_read_b128 v[112:115], v2 offset:5120
  s_mov_b32 m0, s33
  v_smfmac_f32_16x16x64_bf16 v[16:19], v[96:99], v[168:175], v0
  s_waitcnt lgkmcnt(4)
  ds_read_b128 v[84:87], v1 offset:5120
  v_smfmac_f32_16x16x64_bf16 v[16:19], v[116:119], v[192:199], v0
  s_waitcnt lgkmcnt(4)
  ds_read_b128 v[88:91], v2 offset:4096
  v_smfmac_f32_16x16x64_bf16 v[16:19], v[124:127], v[200:207], v0
  s_waitcnt lgkmcnt(4)
  ds_read_b128 v[100:103], v1 offset:4096
  buffer_load_dwordx4 v10, s[4:7], s28 offen sc1 lds
  v_smfmac_f32_16x16x64_bf16 v[16:19], v[104:107], a[16:23], v0
  s_waitcnt lgkmcnt(4)
  ds_read_b128 v[68:71], v4 offset:16384
  s_mov_b32 m0, s34
  v_smfmac_f32_16x16x64_bf16 v[16:19], v[108:111], a[24:31], v0
  s_waitcnt lgkmcnt(4)
  ds_read_b128 v[72:75], v4 offset:17408
  v_smfmac_f32_16x16x64_bf16 v[16:19], v[112:115], a[64:71], v0
  s_waitcnt lgkmcnt(4)
  ds_read_b128 v[76:79], v4 offset:18432
  v_smfmac_f32_16x16x64_bf16 v[16:19], v[84:87], a[72:79], v0
  s_waitcnt lgkmcnt(4)
  ds_read_b128 v[80:83], v4 offset:19456
  buffer_load_dwordx4 v10, s[4:7], s28 offen offset:256 sc1 lds
  v_smfmac_f32_16x16x64_bf16 v[16:19], v[88:91], a[112:119], v0
  s_waitcnt lgkmcnt(4)
  s_mov_b32 m0, 32256
  v_smfmac_f32_16x16x64_bf16 v[16:19], v[100:103], a[120:127], v0
  s_add_u32 s24, s36, 145752064
  s_add_u32 s25, s36, 145756160
  v_smfmac_f32_16x16x64_bf16 v[20:23], v[92:95], v[176:183], v0
  s_add_u32 s35, s36, s23
  v_smfmac_f32_16x16x64_bf16 v[20:23], v[96:99], v[184:191], v0
  s_waitcnt lgkmcnt(2)
  buffer_load_dword v8, s[4:7], s99 offen sc1 lds
  v_smfmac_f32_16x16x64_bf16 v[20:23], v[116:119], v[68:75], v0
  s_waitcnt lgkmcnt(0)
  ds_read_b128 v[68:71], v4 offset:20480
  v_mul_f32 v16, s18, v16
  v_smfmac_f32_16x16x64_bf16 v[20:23], v[124:127], v[76:83], v0
  ds_read_b128 v[72:75], v4 offset:21504
  v_mul_f32 v17, s18, v17
  v_smfmac_f32_16x16x64_bf16 v[20:23], v[104:107], a[32:39], v0
  ds_read_b128 v[76:79], v4 offset:22528
  v_mul_f32 v18, s18, v18
  v_smfmac_f32_16x16x64_bf16 v[20:23], v[108:111], a[40:47], v0
  ds_read_b128 v[80:83], v4 offset:23552
  v_mul_f32 v19, s18, v19
  v_smfmac_f32_16x16x64_bf16 v[20:23], v[112:115], a[80:87], v0
  v_cvt_pk_bf16_f32 v120, v16, v17
  v_smfmac_f32_16x16x64_bf16 v[20:23], v[84:87], a[88:95], v0
  v_cvt_pk_bf16_f32 v121, v18, v19
  v_smfmac_f32_16x16x64_bf16 v[20:23], v[88:91], a[128:135], v0
  ds_write_b64 v5, v[120:121] offset:24576
  v_smfmac_f32_16x16x64_bf16 v[20:23], v[100:103], a[136:143], v0
  s_waitcnt lgkmcnt(3)
  v_smfmac_f32_16x16x64_bf16 v[24:27], v[92:95], v[68:75], v0
  s_waitcnt lgkmcnt(1)
  v_mov_b64 v[92:93], 0
  v_smfmac_f32_16x16x64_bf16 v[24:27], v[96:99], v[76:83], v0
  s_nop 1
  v_cvt_pk_bf16_f32 v122, v20, v21
  v_cvt_pk_bf16_f32 v123, v22, v23
  v_smfmac_f32_16x16x64_bf16 v[24:27], v[116:119], v[208:215], v0
  ds_write_b64 v5, v[122:123] offset:26880
  v_mov_b64 v[94:95], 0
  v_smfmac_f32_16x16x64_bf16 v[24:27], v[124:127], v[216:223], v0
  s_waitcnt lgkmcnt(1)
  s_barrier
  ds_read_b64_tr_b16 v[68:69], v6 offset:24576
  v_smfmac_f32_16x16x64_bf16 v[24:27], v[104:107], a[48:55], v0
  s_add_u32 s27, s27, 8192
  ds_read_b64_tr_b16 v[70:71], v6 offset:24640
  ds_read_b64_tr_b16 v[72:73], v6 offset:24832
  v_smfmac_f32_16x16x64_bf16 v[24:27], v[108:111], a[56:63], v0
  s_add_u32 s28, s28, 8192
  ds_read_b64_tr_b16 v[74:75], v6 offset:24896
  ds_read_b64_tr_b16 v[76:77], v6 offset:25088
  v_smfmac_f32_16x16x64_bf16 v[24:27], v[112:115], a[96:103], v0
  s_nop 0
  ds_read_b64_tr_b16 v[78:79], v6 offset:25152
  ds_read_b64_tr_b16 v[80:81], v6 offset:25344
  v_smfmac_f32_16x16x64_bf16 v[24:27], v[84:87], a[104:111], v0
  ds_read_b64_tr_b16 v[82:83], v6 offset:25408
  v_mov_b64 v[96:97], 0
  v_smfmac_f32_16x16x64_bf16 v[24:27], v[88:91], a[144:151], v0
  s_waitcnt lgkmcnt(8)
  s_barrier
  ds_read_b64_tr_b16 v[116:117], v6 offset:26880
  v_smfmac_f32_16x16x64_bf16 v[24:27], v[100:103], a[152:159], v0
  s_waitcnt lgkmcnt(7)
  ds_read_b64_tr_b16 v[118:119], v6 offset:26944
  v_mfma_f32_16x16x32_bf16 v[16:19], v[36:39], v[68:71], 0
  s_waitcnt lgkmcnt(6)
  ds_read_b64_tr_b16 v[124:125], v6 offset:27136
  ds_read_b64_tr_b16 v[126:127], v6 offset:27200
  v_mfma_f32_16x16x32_bf16 v[16:19], v[40:43], v[72:75], v[16:19]
  s_waitcnt lgkmcnt(6)
  ds_read_b64_tr_b16 v[104:105], v6 offset:27392
  ds_read_b64_tr_b16 v[106:107], v6 offset:27456
  v_mfma_f32_16x16x32_bf16 v[16:19], v[44:47], v[76:79], v[16:19]
  s_waitcnt lgkmcnt(6)
  ds_read_b64_tr_b16 v[108:109], v6 offset:27648
  ds_read_b64_tr_b16 v[110:111], v6 offset:27712
  v_mfma_f32_16x16x32_bf16 v[16:19], v[48:51], v[80:83], v[16:19]
  s_waitcnt lgkmcnt(6)
  v_cvt_pk_bf16_f32 v120, v24, v25
  v_cvt_pk_bf16_f32 v121, v26, v27
  v_mfma_f32_16x16x32_bf16 v[112:115], v[116:119], v[68:71], 0
  s_waitcnt lgkmcnt(4)
  buffer_store_dwordx4 v[120:123], v2, s[4:7], s29 offen offset:3072 sc1
  v_mov_b64 v[98:99], 0
  v_mfma_f32_16x16x32_bf16 v[112:115], v[124:127], v[72:75], v[112:115]
  s_waitcnt lgkmcnt(2)
  v_mov_b64 v[36:37], 0
  v_exp_f32 v100, v16
  v_mfma_f32_16x16x32_bf16 v[112:115], v[104:107], v[76:79], v[112:115]
  s_waitcnt lgkmcnt(0)
  v_exp_f32 v101, v17
  v_mfma_f32_16x16x32_bf16 v[112:115], v[108:111], v[80:83], v[112:115]
  s_add_u32 s29, s29, 131072
  v_exp_f32 v102, v18
  v_mfma_f32_16x16x32_bf16 v[20:23], v[52:55], v[68:71], 0
  s_cmp_eq_u32 s14, 63
  v_exp_f32 v103, v19
  v_mfma_f32_16x16x32_bf16 v[20:23], v[56:59], v[72:75], v[20:23]
  s_cbranch_scc1 M_tdone
  v_cvt_pk_bf16_f32 v44, v100, v101
  v_cvt_pk_bf16_f32 v45, v102, v103
  v_mfma_f32_16x16x32_bf16 v[20:23], v[60:63], v[76:79], v[20:23]
  v_exp_f32 v100, v112
  v_mfma_f32_16x16x32_bf16 v[20:23], v[64:67], v[80:83], v[20:23]
  v_exp_f32 v101, v113
  v_exp_f32 v102, v114
  v_exp_f32 v103, v115
  v_cvt_pk_bf16_f32 v84, v100, v101
  v_cvt_pk_bf16_f32 v85, v102, v103
  v_cndmask_b32 v48, v84, 0, s[16:17]
  v_cndmask_b32 v49, v85, 0, s[16:17]
  v_cndmask_b32 v50, 0, v84, s[16:17]
  v_cndmask_b32 v51, 0, v85, s[16:17]
  v_exp_f32 v100, v20
  v_mfma_f32_16x16x16_bf16 v[88:91], v[12:13], v[48:49], 0
  v_exp_f32 v101, v21
  v_mfma_f32_16x16x16_bf16 v[24:27], v[120:121], v[48:49], 0
  v_exp_f32 v102, v22
  v_mfma_f32_16x16x16_bf16 v[116:119], v[120:121], v[50:51], 0
  v_exp_f32 v103, v23
  v_cvt_pk_bf16_f32 v46, v100, v101
  v_cvt_pk_bf16_f32 v47, v102, v103
  v_mov_b64 v[38:39], 0
  s_nop 0
  v_mfma_f32_16x16x32_bf16 v[88:91], v[12:15], v[44:47], v[88:91]
  v_mov_b64 v[40:41], 0
  v_mov_b64 v[42:43], 0
  v_mfma_f32_16x16x32_bf16 v[24:27], v[28:31], v[44:47], v[24:27]
  ds_read_b128 v[52:55], v4 offset:24576
  ds_read_b128 v[56:59], v4 offset:25600
  v_mfma_f32_16x16x32_bf16 v[116:119], v[32:35], v[44:47], v[116:119]
  s_nop 1
  v_rcp_f32 v89, v88
  v_subrev_u32 v100, s54, v88
  v_cmp_le_u32 vcc, s55, v100
  v_mul_f32 v24, v89, v24
  v_mul_f32 v25, v89, v25
  s_cbranch_vccnz T_slow_190
T_back_191:
  v_cvt_pk_bf16_f32 v124, v24, v25
  v_pk_mul_f32 v[26:27], v[26:27], v[88:89] op_sel:[0,1] op_sel_hi:[1,1]
  v_pk_mul_f32 v[116:117], v[116:117], v[88:89] op_sel:[0,1] op_sel_hi:[1,1]
  v_pk_mul_f32 v[118:119], v[118:119], v[88:89] op_sel:[0,1] op_sel_hi:[1,1]
  v_cvt_pk_bf16_f32 v125, v26, v27
  v_cvt_pk_bf16_f32 v126, v116, v117
  v_cvt_pk_bf16_f32 v127, v118, v119
  ds_write_b128 v11, v[124:127] offset:30720
  s_nop 0
  v_smfmac_f32_16x16x64_bf16 v[92:95], v[124:127], a[160:167], v0
  v_smfmac_f32_16x16x64_bf16 v[96:99], v[124:127], a[168:175], v0
  v_smfmac_f32_16x16x64_bf16 v[36:39], v[124:127], a[176:183], v0
  v_smfmac_f32_16x16x64_bf16 v[40:43], v[124:127], a[184:191], v0
  s_waitcnt lgkmcnt(0)
  s_barrier
  ds_read_b128 v[104:107], v11 offset:30208
  ds_read_b128 v[108:111], v11 offset:29696
  ds_read_b128 v[68:71], v11 offset:29184
  s_waitcnt lgkmcnt(2)
  v_smfmac_f32_16x16x64_bf16 v[92:95], v[104:107], a[192:199], v0
  s_waitcnt lgkmcnt(1)
  ds_read_b128 v[76:79], v4 offset:28672
  v_smfmac_f32_16x16x64_bf16 v[92:95], v[108:111], a[224:231], v0
  s_waitcnt lgkmcnt(1)
  ds_read_b128 v[80:83], v4 offset:29696
  v_smfmac_f32_16x16x64_bf16 v[92:95], v[68:71], a[240:247], v0
  ds_read_b128 v[60:63], v4 offset:26624
  v_smfmac_f32_16x16x64_bf16 v[96:99], v[104:107], a[200:207], v0
  ds_read_b128 v[64:67], v4 offset:27648
  v_smfmac_f32_16x16x64_bf16 v[96:99], v[108:111], a[232:239], v0
  ds_read_b128 v[28:31], v4 offset:30720
  s_nop 0
  v_cvt_pk_bf16_f32 v16, v92, v93
  v_cvt_pk_bf16_f32 v17, v94, v95
  v_bfi_b32 v16, 1, s57, v16
  v_smfmac_f32_16x16x64_bf16 v[96:99], v[68:71], a[248:255], v0
  buffer_store_dwordx2 v[16:17], v7, s[4:7], s20 offen offset:0 sc1
  v_smfmac_f32_16x16x64_bf16 v[36:39], v[104:107], a[208:215], v0
  ds_read_b128 v[32:35], v4 offset:31744
  v_smfmac_f32_16x16x64_bf16 v[36:39], v[108:111], v[52:59], v0
  s_waitcnt lgkmcnt(4)
  s_nop 0
  v_cvt_pk_bf16_f32 v18, v96, v97
  v_cvt_pk_bf16_f32 v19, v98, v99
  v_bfi_b32 v18, 1, s57, v18
  v_smfmac_f32_16x16x64_bf16 v[36:39], v[68:71], v[76:83], v0
  buffer_store_dwordx2 v[18:19], v7, s[4:7], s20 offen offset:64 sc1
  v_smfmac_f32_16x16x64_bf16 v[40:43], v[104:107], a[216:223], v0
  s_waitcnt lgkmcnt(2)
  v_smfmac_f32_16x16x64_bf16 v[40:43], v[108:111], v[60:67], v0
  s_waitcnt lgkmcnt(0)
  s_nop 0
  v_cvt_pk_bf16_f32 v20, v36, v37
  v_cvt_pk_bf16_f32 v21, v38, v39
  v_bfi_b32 v20, 1, s57, v20
  v_smfmac_f32_16x16x64_bf16 v[40:43], v[68:71], v[28:35], v0
  buffer_store_dwordx2 v[20:21], v7, s[4:7], s21 offen offset:0 sc1
  s_nop 6
  v_cvt_pk_bf16_f32 v22, v40, v41
  v_cvt_pk_bf16_f32 v23, v42, v43
  v_bfi_b32 v22, 1, s57, v22
  buffer_store_dwordx2 v[22:23], v7, s[4:7], s21 offen offset:64 sc1
  ds_read_b128 v[68:71], v4 offset:0
  ds_read_b128 v[72:75], v4 offset:1024
  ds_read_b128 v[76:79], v4 offset:4096
  ds_read_b128 v[80:83], v4 offset:5120
  ds_read_b128 v[84:87], v4 offset:8192
  ds_read_b128 v[88:91], v4 offset:9216
  ds_read_b128 v[92:95], v4 offset:2048
  ds_read_b128 v[96:99], v4 offset:3072
  ds_read_b128 v[100:103], v4 offset:6144
  ds_read_b128 v[104:107], v4 offset:7168
  ds_read_b128 v[108:111], v4 offset:10240
  ds_read_b128 v[112:115], v4 offset:11264
  v_mov_b64 v[16:17], 0
  v_mov_b64 v[18:19], 0
  v_mov_b64 v[20:21], 0
  v_mov_b64 v[22:23], 0
  v_mov_b64 v[24:25], 0
  v_mov_b64 v[26:27], 0
  ds_read_b64 v[44:45], v2 offset:32256
  s_waitcnt lgkmcnt(0)
  v_readfirstlane_b32 s38, v44
  v_readfirstlane_b32 s37, v45
  s_nop 0
  s_add_u32 s37, s37, 30
  s_cmp_ge_u32 s38, 30
  s_cselect_b32 s38, s37, s38
  s_cmp_ge_u32 s38, 64
  s_cselect_b32 s38, 100, s38
  s_sub_u32 s38, s38, 1
  s_max_i32 s30, s30, s38
  s_waitcnt vmcnt(4)
  s_barrier
  ds_read_b128 v[28:31], v2 offset:19456
  ds_read_b128 v[32:35], v2 offset:23552
  ds_read_b128 v[36:39], v2 offset:8192
  ds_read_b128 v[40:43], v2 offset:9216
  ds_read_b128 v[44:47], v2 offset:10240
  ds_read_b128 v[48:51], v2 offset:11264
  buffer_load_dwordx4 v[124:127], v3, s[4:7], s24 offen offset:3072 sc1
  buffer_load_dwordx4 v[116:119], v3, s[4:7], s25 offen offset:3072 sc1
  ds_read_b128 v[52:55], v2 offset:12288
  ds_read_b128 v[56:59], v2 offset:13312
  ds_read_b128 v[60:63], v2 offset:14336
  ds_read_b128 v[64:67], v2 offset:15360
  buffer_load_dwordx4 v[124:127], v3, s[4:7], s24 offen offset:3072 sc1
  buffer_load_dwordx4 v[116:119], v3, s[4:7], s25 offen offset:3072 sc1
  s_mov_b32 s19, 0
  s_branch T_loop_183
T_kvw_187:
  s_mov_b32 s19, 0
  s_branch T_kvok_196
T_kv_195:
  s_sleep 4
  s_add_u32 s19, s19, 1
  s_cmp_gt_u32 s19, 32768
  s_cbranch_scc1 M_exit
T_kvok_196:
  s_add_u32 s39, s99, 128
  s_mov_b32 s38, 0
  s_mov_b32 s37, 0
  s_atomic_or s38, s[58:59], s99 glc
  s_atomic_or s37, s[58:59], s39 glc
  s_waitcnt lgkmcnt(0)
  s_add_u32 s37, s37, 30
  s_cmp_ge_u32 s38, 30
  s_cselect_b32 s38, s37, s38
  s_cmp_ge_u32 s38, 64
  s_cselect_b32 s38, 100, s38
  s_sub_u32 s38, s38, 1
  s_max_i32 s30, s30, s38
  s_cmp_ge_i32 s14, s30
  s_cbranch_scc1 T_kv_195
  s_branch T_kvb_188
T_slow_190:
  s_nop 7
  v_max3_f32 v100, v16, v17, v18
  v_max3_f32 v100, v100, v19, v20
  v_max3_f32 v100, v100, v21, v22
  v_max3_f32 v100, v100, v23, v112
  v_max3_f32 v100, v100, v113, v114
  v_max_f32 v100, v100, v115
  v_mov_b32 v101, v100
  s_nop 1
  v_permlane32_swap_b32 v100, v101
  s_nop 1
  v_max_f32 v100, v100, v101
  v_mov_b32 v101, v100
  s_nop 1
  v_permlane16_swap_b32 v100, v101
  s_nop 1
  v_max_f32 v100, v100, v101
  v_sub_f32 v16, v16, v100
  v_sub_f32 v17, v17, v100
  v_sub_f32 v18, v18, v100
  v_sub_f32 v19, v19, v100
  v_exp_f32 v16, v16
  v_exp_f32 v17, v17
  v_exp_f32 v18, v18
  v_exp_f32 v19, v19
  v_sub_f32 v20, v20, v100
  v_sub_f32 v21, v21, v100
  v_sub_f32 v22, v22, v100
  v_sub_f32 v23, v23, v100
  v_exp_f32 v20, v20
  v_exp_f32 v21, v21
  v_exp_f32 v22, v22
  v_exp_f32 v23, v23
  v_sub_f32 v112, v112, v100
  v_sub_f32 v113, v113, v100
  v_sub_f32 v114, v114, v100
  v_sub_f32 v115, v115, v100
  v_exp_f32 v112, v112
  v_exp_f32 v113, v113
  v_exp_f32 v114, v114
  v_exp_f32 v115, v115
  s_nop 0
  v_cvt_pk_bf16_f32 v44, v16, v17
  v_cvt_pk_bf16_f32 v45, v18, v19
  v_cvt_pk_bf16_f32 v46, v20, v21
  v_cvt_pk_bf16_f32 v47, v22, v23
  v_cvt_pk_bf16_f32 v84, v112, v113
  v_cvt_pk_bf16_f32 v85, v114, v115
  v_cndmask_b32 v48, v84, 0, s[16:17]
  v_cndmask_b32 v49, v85, 0, s[16:17]
  v_cndmask_b32 v50, 0, v84, s[16:17]
  v_cndmask_b32 v51, 0, v85, s[16:17]
  s_nop 1
  v_mfma_f32_16x16x16_bf16 v[88:91], v[12:13], v[48:49], 0
  v_mfma_f32_16x16x16_bf16 v[24:27], v[120:121], v[48:49], 0
  v_mfma_f32_16x16x16_bf16 v[116:119], v[120:121], v[50:51], 0
  v_mfma_f32_16x16x32_bf16 v[88:91], v[12:15], v[44:47], v[88:91]
  v_mfma_f32_16x16x32_bf16 v[24:27], v[28:31], v[44:47], v[24:27]
  v_mfma_f32_16x16x32_bf16 v[116:119], v[32:35], v[44:47], v[116:119]
  s_nop 7
  s_nop 1
  v_rcp_f32 v89, v88
  s_nop 0
  v_mul_f32 v24, v89, v24
  v_mul_f32 v25, v89, v25
  s_branch T_back_191
M_tdone:
  v_mov_b32 v16, 64
  v_or_b32 v17, s13, v2
  v_min_u32 v17, 1, v17
  v_lshlrev_b32 v17, 30, v17
  s_waitcnt vmcnt(0)
  s_barrier
  buffer_store_dword v16, v17, s[4:7], s15 offen sc1
M_done:
M_exit:
  s_endpgm
.p2align 6
.type M_table,@object
M_table:
.long 0x1, 0x3f, 0xffffffff, 0x17, 0x1, 0x7, 0x800, 0x0, 0x8, 0x0, 0x0, 0x0, 0x0, 0x0, 0x0, 0x0
.long 0x1, 0x28, 0xffffffff, 0x1b, 0x1, 0x6, 0x1000, 0x0, 0x8, 0x1, 0x0, 0x0, 0x0, 0x0, 0x0, 0x0
.long 0x2, 0x0, 0x1, 0x1e, 0x1, 0x5, 0x1800, 0x0, 0x8, 0x0, 0x0, 0x0, 0x0, 0x0, 0x0, 0x0
.long 0x2, 0x1e, 0x1, 0x22, 0x1, 0x4, 0x2000, 0x0, 0x8, 0x1, 0x0, 0x0, 0x0, 0x0, 0x0, 0x0
.long 0x0, 0x0, 0x1, 0x20, 0x2, 0x3, 0x20, 0x0, 0x8, 0x2, 0x0, 0x0, 0x0, 0x0, 0x0, 0x0
.long 0x0, 0x3f, 0xffffffff, 0x20, 0x2, 0x2, 0x18, 0x1, 0x10, 0x0, 0x0, 0x0, 0x0, 0x0, 0x0, 0x0
.long 0x1, 0xd, 0xffffffff, 0xe, 0x0, 0x0, 0x8, 0x0, 0x8, 0x2, 0x0, 0x0, 0x0, 0x0, 0x0, 0x0
.size M_table, 448
.section .rodata,"a"
.p2align 6
.amdhsa_kernel gated_mix__compressed_kv_cla__memory_aug_recurrent_mem_tr__prompt_kernel
.amdhsa_next_free_vgpr 512
.amdhsa_next_free_sgpr 102
.amdhsa_accum_offset 256
.amdhsa_group_segment_fixed_size 0
.amdhsa_kernarg_size 136
.amdhsa_user_sgpr_count 2
.amdhsa_user_sgpr_kernarg_segment_ptr 1
.amdhsa_system_sgpr_workgroup_id_x 1
.end_amdhsa_kernel
```

```asm
; @launch grid=(256,1,1) block=(256,1,1) lds=163840
.amdgcn_target "amdgcn-amd-amdhsa--gfx950"
.text
.globl gated_mix__compressed_kv_cla__memory_aug_recurrent_mem_tr__prompt_kernel
.p2align 8
.type gated_mix__compressed_kv_cla__memory_aug_recurrent_mem_tr__prompt_kernel,@function
gated_mix__compressed_kv_cla__memory_aug_recurrent_mem_tr__prompt_kernel:
  s_cmp_ge_u32 s2, 256
  s_cbranch_scc1 M_exit
  s_load_dwordx4 s[72:75], s[0:1], 120
  v_lshrrev_b32 v3, 6, v0
  v_and_b32 v1, 63, v0
  v_readfirstlane_b32 s16, v3
  v_lshlrev_b32 v2, 4, v1
  s_and_b32 s76, s2, 7
  s_lshr_b32 s77, s2, 3
  s_sub_u32 s66, s76, 1
  s_and_b32 s66, s66, 7
  s_lshl_b32 s66, s66, 5
  s_add_u32 s66, s66, s77
  s_lshl_b32 s31, s66, 7
  s_add_u32 s31, s31, 148897792
  s_waitcnt lgkmcnt(0)
  s_mov_b64 s[4:5], s[74:75]
  s_mov_b64 s[74:75], s[72:73]
  s_mov_b64 s[72:73], s[4:5]
  s_and_b32 s5, s5, 0xffff
  s_mov_b32 s6, 268435456
  s_mov_b32 s7, 0x20000
  s_cmp_eq_u32 s76, 0
  s_cbranch_scc1 M_team
  s_mul_i32 s64, s66, 9363
  s_lshr_b32 s64, s64, 16
  s_mul_i32 s67, s64, 7
  s_sub_u32 s65, s66, s67
  s_lshl_b32 s67, s67, 7
  s_add_u32 s67, s67, 148897792
  s_getpc_b64 s[76:77]
M_pc:
  s_add_u32 s76, s76, M_table-M_pc
  s_addc_u32 s77, s77, 0
  s_lshl_b32 s26, s65, 6
  s_load_dwordx16 s[48:63], s[76:77], s26
  s_waitcnt lgkmcnt(0)
  s_mov_b32 s23, s51
  s_cmp_lg_u32 s48, 1
  s_cbranch_scc1 M_nobpf
  s_load_dwordx8 s[36:43], s[0:1], 64
  s_mul_i32 s76, s64, 3
  s_add_u32 s76, s76, s57
  v_lshlrev_b32 v4, 7, v0
  s_mov_b32 s10, 4194304
  s_mov_b32 s11, 0x20000
  s_waitcnt lgkmcnt(0)
  s_mov_b32 s8, s42
  s_and_b32 s9, s43, 0xffff
  s_mul_i32 s77, s76, 43776
  s_add_u32 s77, s77, 0
  v_min_u32 v5, 32640, v4
  v_add_u32 v5, s77, v5
  s_add_u32 s77, s77, 32768
  buffer_load_dword v6, v5, s[8:11], 0 offen
  v_min_u32 v5, 10880, v4
  v_add_u32 v5, s77, v5
  s_add_u32 s77, s77, 32768
  buffer_load_dword v6, v5, s[8:11], 0 offen
  s_mov_b32 s8, s38
  s_and_b32 s9, s39, 0xffff
  s_mul_i32 s77, s76, 21888
  s_add_u32 s77, s77, 2097152
  v_min_u32 v5, 21760, v4
  v_add_u32 v5, s77, v5
  s_add_u32 s77, s77, 32768
  buffer_load_dword v6, v5, s[8:11], 0 offen
  s_mov_b32 s8, s40
  s_and_b32 s9, s41, 0xffff
  s_mul_i32 s77, s76, 21888
  s_add_u32 s77, s77, 2097152
  v_min_u32 v5, 21760, v4
  v_add_u32 v5, s77, v5
  s_add_u32 s77, s77, 32768
  buffer_load_dword v6, v5, s[8:11], 0 offen
  s_mov_b32 s8, s36
  s_and_b32 s9, s37, 0xffff
  s_mul_i32 s77, s76, 21888
  s_add_u32 s77, s77, 2097152
  v_min_u32 v5, 21760, v4
  v_add_u32 v5, s77, v5
  s_add_u32 s77, s77, 32768
  buffer_load_dword v6, v5, s[8:11], 0 offen
  s_waitcnt vmcnt(0)
M_nobpf:
  s_lshr_b32 s29, s16, 1
  s_cmp_eq_u32 s29, 0
  s_cselect_b32 s26, 2, 8
  s_cselect_b32 s27, 3, 4
  s_cselect_b32 s28, 9, 10
  s_cmp_eq_u32 s48, 1
  s_cselect_b32 s26, s27, s26
  s_cmp_eq_u32 s48, 2
  s_cselect_b32 s26, s28, s26
  s_lshl_b32 s26, s26, 3
  s_load_dwordx2 s[8:9], s[0:1], s26
  s_cmp_eq_u32 s48, 1
  s_cselect_b32 s26, 8, 0
  s_load_dwordx2 s[12:13], s[0:1], s26
  s_cmp_eq_u32 s29, 0
  s_cselect_b32 s21, 0, 3
  s_cselect_b32 s27, 1, 2
  s_cselect_b32 s28, 4, 5
  s_cmp_eq_u32 s48, 1
  s_cselect_b32 s21, s27, s21
  s_cmp_eq_u32 s48, 2
  s_cselect_b32 s21, s28, s21
  s_lshl_b32 s21, s21, 5
  s_add_u32 s21, s21, s64
  s_lshl_b32 s21, s21, 6
  s_add_u32 s21, s21, s49
  s_and_b32 s27, s16, 1
  s_lshl_b32 s21, s21, 1
  s_add_u32 s21, s21, s27
  s_lshl_b32 s21, s21, 12
  s_lshl_b32 s22, s50, 13
  s_lshl_b32 s19, s49, 15
  s_lshl_b32 s20, s50, 15
  s_lshl_b32 s17, s64, 1
  s_add_u32 s17, s17, s27
  s_lshl_b32 s17, s17, 7
  s_mov_b32 s18, 8192
  s_cmp_eq_u32 s48, 0
  s_cselect_b32 s24, 0x3e0293ee, 1.0
  s_waitcnt lgkmcnt(0)
  s_and_b32 s9, s9, 0xffff
  s_mov_b32 s10, 4194304
  s_mov_b32 s11, 0x20000
  s_and_b32 s13, s13, 0xffff
  s_mov_b32 s14, 2097152
  s_mov_b32 s15, 0x20000
  v_and_b32 v144, 31, v1
  v_lshrrev_b32 v145, 5, v1
  v_and_b32 v146, 15, v1
  v_or_b32 v147, 0, v145
  v_xor_b32 v147, v147, v146
  v_lshlrev_b32 v147, 4, v147
  v_lshl_add_u32 v8, v144, 8, v147
  v_or_b32 v147, 2, v145
  v_xor_b32 v147, v147, v146
  v_lshlrev_b32 v147, 4, v147
  v_lshl_add_u32 v9, v144, 8, v147
  v_or_b32 v147, 4, v145
  v_xor_b32 v147, v147, v146
  v_lshlrev_b32 v147, 4, v147
  v_lshl_add_u32 v10, v144, 8, v147
  v_or_b32 v147, 6, v145
  v_xor_b32 v147, v147, v146
  v_lshlrev_b32 v147, 4, v147
  v_lshl_add_u32 v11, v144, 8, v147
  v_or_b32 v147, 8, v145
  v_xor_b32 v147, v147, v146
  v_lshlrev_b32 v147, 4, v147
  v_lshl_add_u32 v12, v144, 8, v147
  v_or_b32 v147, 10, v145
  v_xor_b32 v147, v147, v146
  v_lshlrev_b32 v147, 4, v147
  v_lshl_add_u32 v13, v144, 8, v147
  v_or_b32 v147, 12, v145
  v_xor_b32 v147, v147, v146
  v_lshlrev_b32 v147, 4, v147
  v_lshl_add_u32 v14, v144, 8, v147
  v_or_b32 v147, 14, v145
  v_xor_b32 v147, v147, v146
  v_lshlrev_b32 v147, 4, v147
  v_lshl_add_u32 v15, v144, 8, v147
  v_lshrrev_b32 v144, 4, v1
  s_lshl_b32 s26, s16, 8
  v_add_u32 v145, 0, v144
  v_and_b32 v147, 15, v145
  v_xor_b32 v147, v147, v146
  v_lshlrev_b32 v147, 4, v147
  v_lshl_add_u32 v147, v145, 10, v147
  v_add_u32 v16, s26, v147
  v_add_u32 v145, 4, v144
  v_and_b32 v147, 15, v145
  v_xor_b32 v147, v147, v146
  v_lshlrev_b32 v147, 4, v147
  v_lshl_add_u32 v147, v145, 10, v147
  v_add_u32 v17, s26, v147
  v_add_u32 v145, 8, v144
  v_and_b32 v147, 15, v145
  v_xor_b32 v147, v147, v146
  v_lshlrev_b32 v147, 4, v147
  v_lshl_add_u32 v147, v145, 10, v147
  v_add_u32 v18, s26, v147
  v_add_u32 v145, 12, v144
  v_and_b32 v147, 15, v145
  v_xor_b32 v147, v147, v146
  v_lshlrev_b32 v147, 4, v147
  v_lshl_add_u32 v147, v145, 10, v147
  v_add_u32 v19, s26, v147
  v_add_u32 v145, 16, v144
  v_and_b32 v147, 15, v145
  v_xor_b32 v147, v147, v146
  v_lshlrev_b32 v147, 4, v147
  v_lshl_add_u32 v147, v145, 10, v147
  v_add_u32 v20, s26, v147
  v_add_u32 v145, 20, v144
  v_and_b32 v147, 15, v145
  v_xor_b32 v147, v147, v146
  v_lshlrev_b32 v147, 4, v147
  v_lshl_add_u32 v147, v145, 10, v147
  v_add_u32 v21, s26, v147
  v_add_u32 v145, 24, v144
  v_and_b32 v147, 15, v145
  v_xor_b32 v147, v147, v146
  v_lshlrev_b32 v147, 4, v147
  v_lshl_add_u32 v147, v145, 10, v147
  v_add_u32 v22, s26, v147
  v_add_u32 v145, 28, v144
  v_and_b32 v147, 15, v145
  v_xor_b32 v147, v147, v146
  v_lshlrev_b32 v147, 4, v147
  v_lshl_add_u32 v147, v145, 10, v147
  v_add_u32 v23, s26, v147
  v_lshrrev_b32 v144, 3, v1
  v_mul_lo_u32 v144, v144, s18
  v_and_b32 v145, 7, v1
  v_lshl_add_u32 v144, v145, 4, v144
  s_lshl_b32 s28, s16, 15
  s_add_u32 s28, s28, 32768
  s_lshl_b32 s29, s18, 3
  s_add_u32 m0, s28, 0
  s_nop 0
  buffer_load_dwordx4 v144, s[8:11], s17 offen lds
  s_add_u32 s17, s17, s29
  s_add_u32 m0, s28, 1024
  s_nop 0
  buffer_load_dwordx4 v144, s[8:11], s17 offen lds
  s_add_u32 s17, s17, s29
  s_add_u32 m0, s28, 2048
  s_nop 0
  buffer_load_dwordx4 v144, s[8:11], s17 offen lds
  s_add_u32 s17, s17, s29
  s_add_u32 m0, s28, 3072
  s_nop 0
  buffer_load_dwordx4 v144, s[8:11], s17 offen lds
  s_add_u32 s17, s17, s29
  s_add_u32 m0, s28, 4096
  s_nop 0
  buffer_load_dwordx4 v144, s[8:11], s17 offen lds
  s_add_u32 s17, s17, s29
  s_add_u32 m0, s28, 5120
  s_nop 0
  buffer_load_dwordx4 v144, s[8:11], s17 offen lds
  s_add_u32 s17, s17, s29
  s_add_u32 m0, s28, 6144
  s_nop 0
  buffer_load_dwordx4 v144, s[8:11], s17 offen lds
  s_add_u32 s17, s17, s29
  s_add_u32 m0, s28, 7168
  s_nop 0
  buffer_load_dwordx4 v144, s[8:11], s17 offen lds
  s_add_u32 s17, s17, s29
  s_add_u32 m0, s28, 8192
  s_nop 0
  buffer_load_dwordx4 v144, s[8:11], s17 offen lds
  s_add_u32 s17, s17, s29
  s_add_u32 m0, s28, 9216
  s_nop 0
  buffer_load_dwordx4 v144, s[8:11], s17 offen lds
  s_add_u32 s17, s17, s29
  s_add_u32 m0, s28, 10240
  s_nop 0
  buffer_load_dwordx4 v144, s[8:11], s17 offen lds
  s_add_u32 s17, s17, s29
  s_add_u32 m0, s28, 11264
  s_nop 0
  buffer_load_dwordx4 v144, s[8:11], s17 offen lds
  s_add_u32 s17, s17, s29
  s_add_u32 m0, s28, 12288
  s_nop 0
  buffer_load_dwordx4 v144, s[8:11], s17 offen lds
  s_add_u32 s17, s17, s29
  s_add_u32 m0, s28, 13312
  s_nop 0
  buffer_load_dwordx4 v144, s[8:11], s17 offen lds
  s_add_u32 s17, s17, s29
  s_add_u32 m0, s28, 14336
  s_nop 0
  buffer_load_dwordx4 v144, s[8:11], s17 offen lds
  s_add_u32 s17, s17, s29
  s_add_u32 m0, s28, 15360
  s_nop 0
  buffer_load_dwordx4 v144, s[8:11], s17 offen lds
  s_add_u32 s17, s17, s29
  s_add_u32 m0, s28, 16384
  s_nop 0
  buffer_load_dwordx4 v144, s[8:11], s17 offen lds
  s_add_u32 s17, s17, s29
  s_add_u32 m0, s28, 17408
  s_nop 0
  buffer_load_dwordx4 v144, s[8:11], s17 offen lds
  s_add_u32 s17, s17, s29
  s_add_u32 m0, s28, 18432
  s_nop 0
  buffer_load_dwordx4 v144, s[8:11], s17 offen lds
  s_add_u32 s17, s17, s29
  s_add_u32 m0, s28, 19456
  s_nop 0
  buffer_load_dwordx4 v144, s[8:11], s17 offen lds
  s_add_u32 s17, s17, s29
  s_add_u32 m0, s28, 20480
  s_nop 0
  buffer_load_dwordx4 v144, s[8:11], s17 offen lds
  s_add_u32 s17, s17, s29
  s_add_u32 m0, s28, 21504
  s_nop 0
  buffer_load_dwordx4 v144, s[8:11], s17 offen lds
  s_add_u32 s17, s17, s29
  s_add_u32 m0, s28, 22528
  s_nop 0
  buffer_load_dwordx4 v144, s[8:11], s17 offen lds
  s_add_u32 s17, s17, s29
  s_add_u32 m0, s28, 23552
  s_nop 0
  buffer_load_dwordx4 v144, s[8:11], s17 offen lds
  s_add_u32 s17, s17, s29
  s_add_u32 m0, s28, 24576
  s_nop 0
  buffer_load_dwordx4 v144, s[8:11], s17 offen lds
  s_add_u32 s17, s17, s29
  s_add_u32 m0, s28, 25600
  s_nop 0
  buffer_load_dwordx4 v144, s[8:11], s17 offen lds
  s_add_u32 s17, s17, s29
  s_add_u32 m0, s28, 26624
  s_nop 0
  buffer_load_dwordx4 v144, s[8:11], s17 offen lds
  s_add_u32 s17, s17, s29
  s_add_u32 m0, s28, 27648
  s_nop 0
  buffer_load_dwordx4 v144, s[8:11], s17 offen lds
  s_add_u32 s17, s17, s29
  s_add_u32 m0, s28, 28672
  s_nop 0
  buffer_load_dwordx4 v144, s[8:11], s17 offen lds
  s_add_u32 s17, s17, s29
  s_add_u32 m0, s28, 29696
  s_nop 0
  buffer_load_dwordx4 v144, s[8:11], s17 offen lds
  s_add_u32 s17, s17, s29
  s_add_u32 m0, s28, 30720
  s_nop 0
  buffer_load_dwordx4 v144, s[8:11], s17 offen lds
  s_add_u32 s17, s17, s29
  s_add_u32 m0, s28, 31744
  s_nop 0
  buffer_load_dwordx4 v144, s[8:11], s17 offen lds
  s_add_u32 s17, s17, s29
  s_lshl_b32 s25, s16, 13
  s_add_u32 m0, s25, 0
  s_nop 0
  buffer_load_dwordx4 v16, s[12:15], s19 offen lds
  s_add_u32 m0, s25, 1024
  s_nop 0
  buffer_load_dwordx4 v17, s[12:15], s19 offen lds
  s_add_u32 m0, s25, 2048
  s_nop 0
  buffer_load_dwordx4 v18, s[12:15], s19 offen lds
  s_add_u32 m0, s25, 3072
  s_nop 0
  buffer_load_dwordx4 v19, s[12:15], s19 offen lds
  s_add_u32 m0, s25, 4096
  s_nop 0
  buffer_load_dwordx4 v20, s[12:15], s19 offen lds
  s_add_u32 m0, s25, 5120
  s_nop 0
  buffer_load_dwordx4 v21, s[12:15], s19 offen lds
  s_add_u32 m0, s25, 6144
  s_nop 0
  buffer_load_dwordx4 v22, s[12:15], s19 offen lds
  s_add_u32 m0, s25, 7168
  s_nop 0
  buffer_load_dwordx4 v23, s[12:15], s19 offen lds
  s_cmp_gt_u32 s23, 1
  s_cselect_b32 s26, s20, 0
  s_add_u32 s19, s19, s26
  s_add_u32 s25, s25, 32768
  s_and_b32 s25, s25, 0x1ffff
  s_cmp_lg_u32 s16, 3
  s_cbranch_scc1 M_noinit
  s_mov_b32 s79, 0
  s_atomic_swap s79, s[72:73], s31 glc
  s_waitcnt lgkmcnt(0)
  s_mov_b32 s79, 1
  s_atomic_add s79, s[74:75], 128
M_noinit:
  s_mul_i32 s76, s64, 3
  s_add_u32 s76, s76, s57
  s_mul_i32 s76, s76, 24576
  v_lshlrev_b32 v4, 7, v0
  v_add_u32 v4, s76, v4
  buffer_load_dword v5, v4, s[12:15], 0 offen
  v_bfe_u32 v148, v1, 2, 2
  v_lshrrev_b32 v149, 5, v1
  v_lshl_add_u32 v148, v149, 3, v148
  v_lshlrev_b32 v148, 7, v148
  v_bfe_u32 v149, v1, 4, 1
  v_lshl_add_u32 v148, v149, 5, v148
  v_and_b32 v149, 3, v1
  v_lshl_add_u32 v148, v149, 3, v148
  v_add_u32 v146, s28, v148
  v_add_u32 v147, 512, v146
  s_waitcnt vmcnt(37)
  ds_read_b64_tr_b16 a[0:1], v146 offset:0
  ds_read_b64_tr_b16 a[2:3], v147 offset:0
  ds_read_b64_tr_b16 a[4:5], v146 offset:64
  ds_read_b64_tr_b16 a[6:7], v147 offset:64
  ds_read_b64_tr_b16 a[8:9], v146 offset:2048
  ds_read_b64_tr_b16 a[10:11], v147 offset:2048
  ds_read_b64_tr_b16 a[12:13], v146 offset:2112
  ds_read_b64_tr_b16 a[14:15], v147 offset:2112
  s_waitcnt lgkmcnt(0)
  s_add_u32 m0, s28, 0
  s_nop 0
  buffer_load_dwordx4 v144, s[8:11], s17 offen lds
  s_add_u32 s17, s17, s29
  s_add_u32 m0, s28, 1024
  s_nop 0
  buffer_load_dwordx4 v144, s[8:11], s17 offen lds
  s_add_u32 s17, s17, s29
  s_add_u32 m0, s28, 2048
  s_nop 0
  buffer_load_dwordx4 v144, s[8:11], s17 offen lds
  s_add_u32 s17, s17, s29
  s_add_u32 m0, s28, 3072
  s_nop 0
  buffer_load_dwordx4 v144, s[8:11], s17 offen lds
  s_add_u32 s17, s17, s29
  s_waitcnt vmcnt(37)
  ds_read_b64_tr_b16 a[16:17], v146 offset:4096
  ds_read_b64_tr_b16 a[18:19], v147 offset:4096
  ds_read_b64_tr_b16 a[20:21], v146 offset:4160
  ds_read_b64_tr_b16 a[22:23], v147 offset:4160
  ds_read_b64_tr_b16 a[24:25], v146 offset:6144
  ds_read_b64_tr_b16 a[26:27], v147 offset:6144
  ds_read_b64_tr_b16 a[28:29], v146 offset:6208
  ds_read_b64_tr_b16 a[30:31], v147 offset:6208
  s_waitcnt lgkmcnt(0)
  s_add_u32 m0, s28, 4096
  s_nop 0
  buffer_load_dwordx4 v144, s[8:11], s17 offen lds
  s_add_u32 s17, s17, s29
  s_add_u32 m0, s28, 5120
  s_nop 0
  buffer_load_dwordx4 v144, s[8:11], s17 offen lds
  s_add_u32 s17, s17, s29
  s_add_u32 m0, s28, 6144
  s_nop 0
  buffer_load_dwordx4 v144, s[8:11], s17 offen lds
  s_add_u32 s17, s17, s29
  s_add_u32 m0, s28, 7168
  s_nop 0
  buffer_load_dwordx4 v144, s[8:11], s17 offen lds
  s_add_u32 s17, s17, s29
  s_waitcnt vmcnt(37)
  ds_read_b64_tr_b16 a[32:33], v146 offset:8192
  ds_read_b64_tr_b16 a[34:35], v147 offset:8192
  ds_read_b64_tr_b16 a[36:37], v146 offset:8256
  ds_read_b64_tr_b16 a[38:39], v147 offset:8256
  ds_read_b64_tr_b16 a[40:41], v146 offset:10240
  ds_read_b64_tr_b16 a[42:43], v147 offset:10240
  ds_read_b64_tr_b16 a[44:45], v146 offset:10304
  ds_read_b64_tr_b16 a[46:47], v147 offset:10304
  s_waitcnt lgkmcnt(0)
  s_add_u32 m0, s28, 8192
  s_nop 0
  buffer_load_dwordx4 v144, s[8:11], s17 offen lds
  s_add_u32 s17, s17, s29
  s_add_u32 m0, s28, 9216
  s_nop 0
  buffer_load_dwordx4 v144, s[8:11], s17 offen lds
  s_add_u32 s17, s17, s29
  s_add_u32 m0, s28, 10240
  s_nop 0
  buffer_load_dwordx4 v144, s[8:11], s17 offen lds
  s_add_u32 s17, s17, s29
  s_add_u32 m0, s28, 11264
  s_nop 0
  buffer_load_dwordx4 v144, s[8:11], s17 offen lds
  s_add_u32 s17, s17, s29
  s_waitcnt vmcnt(37)
  ds_read_b64_tr_b16 a[48:49], v146 offset:12288
  ds_read_b64_tr_b16 a[50:51], v147 offset:12288
  ds_read_b64_tr_b16 a[52:53], v146 offset:12352
  ds_read_b64_tr_b16 a[54:55], v147 offset:12352
  ds_read_b64_tr_b16 a[56:57], v146 offset:14336
  ds_read_b64_tr_b16 a[58:59], v147 offset:14336
  ds_read_b64_tr_b16 a[60:61], v146 offset:14400
  ds_read_b64_tr_b16 a[62:63], v147 offset:14400
  s_waitcnt lgkmcnt(0)
  s_add_u32 m0, s28, 12288
  s_nop 0
  buffer_load_dwordx4 v144, s[8:11], s17 offen lds
  s_add_u32 s17, s17, s29
  s_add_u32 m0, s28, 13312
  s_nop 0
  buffer_load_dwordx4 v144, s[8:11], s17 offen lds
  s_add_u32 s17, s17, s29
  s_add_u32 m0, s28, 14336
  s_nop 0
  buffer_load_dwordx4 v144, s[8:11], s17 offen lds
  s_add_u32 s17, s17, s29
  s_add_u32 m0, s28, 15360
  s_nop 0
  buffer_load_dwordx4 v144, s[8:11], s17 offen lds
  s_add_u32 s17, s17, s29
  s_waitcnt vmcnt(37)
  ds_read_b64_tr_b16 a[64:65], v146 offset:16384
  ds_read_b64_tr_b16 a[66:67], v147 offset:16384
  ds_read_b64_tr_b16 a[68:69], v146 offset:16448
  ds_read_b64_tr_b16 a[70:71], v147 offset:16448
  ds_read_b64_tr_b16 a[72:73], v146 offset:18432
  ds_read_b64_tr_b16 a[74:75], v147 offset:18432
  ds_read_b64_tr_b16 a[76:77], v146 offset:18496
  ds_read_b64_tr_b16 a[78:79], v147 offset:18496
  s_waitcnt lgkmcnt(0)
  s_add_u32 m0, s28, 16384
  s_nop 0
  buffer_load_dwordx4 v144, s[8:11], s17 offen lds
  s_add_u32 s17, s17, s29
  s_add_u32 m0, s28, 17408
  s_nop 0
  buffer_load_dwordx4 v144, s[8:11], s17 offen lds
  s_add_u32 s17, s17, s29
  s_add_u32 m0, s28, 18432
  s_nop 0
  buffer_load_dwordx4 v144, s[8:11], s17 offen lds
  s_add_u32 s17, s17, s29
  s_add_u32 m0, s28, 19456
  s_nop 0
  buffer_load_dwordx4 v144, s[8:11], s17 offen lds
  s_add_u32 s17, s17, s29
  s_waitcnt vmcnt(37)
  ds_read_b64_tr_b16 a[80:81], v146 offset:20480
  ds_read_b64_tr_b16 a[82:83], v147 offset:20480
  ds_read_b64_tr_b16 a[84:85], v146 offset:20544
  ds_read_b64_tr_b16 a[86:87], v147 offset:20544
  ds_read_b64_tr_b16 a[88:89], v146 offset:22528
  ds_read_b64_tr_b16 a[90:91], v147 offset:22528
  ds_read_b64_tr_b16 a[92:93], v146 offset:22592
  ds_read_b64_tr_b16 a[94:95], v147 offset:22592
  s_waitcnt lgkmcnt(0)
  s_add_u32 m0, s28, 20480
  s_nop 0
  buffer_load_dwordx4 v144, s[8:11], s17 offen lds
  s_add_u32 s17, s17, s29
  s_add_u32 m0, s28, 21504
  s_nop 0
  buffer_load_dwordx4 v144, s[8:11], s17 offen lds
  s_add_u32 s17, s17, s29
  s_add_u32 m0, s28, 22528
  s_nop 0
  buffer_load_dwordx4 v144, s[8:11], s17 offen lds
  s_add_u32 s17, s17, s29
  s_add_u32 m0, s28, 23552
  s_nop 0
  buffer_load_dwordx4 v144, s[8:11], s17 offen lds
  s_add_u32 s17, s17, s29
  s_waitcnt vmcnt(37)
  ds_read_b64_tr_b16 a[96:97], v146 offset:24576
  ds_read_b64_tr_b16 a[98:99], v147 offset:24576
  ds_read_b64_tr_b16 a[100:101], v146 offset:24640
  ds_read_b64_tr_b16 a[102:103], v147 offset:24640
  ds_read_b64_tr_b16 a[104:105], v146 offset:26624
  ds_read_b64_tr_b16 a[106:107], v147 offset:26624
  ds_read_b64_tr_b16 a[108:109], v146 offset:26688
  ds_read_b64_tr_b16 a[110:111], v147 offset:26688
  s_waitcnt lgkmcnt(0)
  s_add_u32 m0, s28, 24576
  s_nop 0
  buffer_load_dwordx4 v144, s[8:11], s17 offen lds
  s_add_u32 s17, s17, s29
  s_add_u32 m0, s28, 25600
  s_nop 0
  buffer_load_dwordx4 v144, s[8:11], s17 offen lds
  s_add_u32 s17, s17, s29
  s_add_u32 m0, s28, 26624
  s_nop 0
  buffer_load_dwordx4 v144, s[8:11], s17 offen lds
  s_add_u32 s17, s17, s29
  s_add_u32 m0, s28, 27648
  s_nop 0
  buffer_load_dwordx4 v144, s[8:11], s17 offen lds
  s_add_u32 s17, s17, s29
  s_waitcnt vmcnt(37)
  ds_read_b64_tr_b16 a[112:113], v146 offset:28672
  ds_read_b64_tr_b16 a[114:115], v147 offset:28672
  ds_read_b64_tr_b16 a[116:117], v146 offset:28736
  ds_read_b64_tr_b16 a[118:119], v147 offset:28736
  ds_read_b64_tr_b16 a[120:121], v146 offset:30720
  ds_read_b64_tr_b16 a[122:123], v147 offset:30720
  ds_read_b64_tr_b16 a[124:125], v146 offset:30784
  ds_read_b64_tr_b16 a[126:127], v147 offset:30784
  s_waitcnt lgkmcnt(0)
  s_add_u32 m0, s28, 28672
  s_nop 0
  buffer_load_dwordx4 v144, s[8:11], s17 offen lds
  s_add_u32 s17, s17, s29
  s_add_u32 m0, s28, 29696
  s_nop 0
  buffer_load_dwordx4 v144, s[8:11], s17 offen lds
  s_add_u32 s17, s17, s29
  s_add_u32 m0, s28, 30720
  s_nop 0
  buffer_load_dwordx4 v144, s[8:11], s17 offen lds
  s_add_u32 s17, s17, s29
  s_add_u32 m0, s28, 31744
  s_nop 0
  buffer_load_dwordx4 v144, s[8:11], s17 offen lds
  s_add_u32 s17, s17, s29
  s_waitcnt vmcnt(28)
  ds_read_b64_tr_b16 a[128:129], v146 offset:0
  ds_read_b64_tr_b16 a[130:131], v147 offset:0
  ds_read_b64_tr_b16 a[132:133], v146 offset:64
  ds_read_b64_tr_b16 a[134:135], v147 offset:64
  ds_read_b64_tr_b16 a[136:137], v146 offset:2048
  ds_read_b64_tr_b16 a[138:139], v147 offset:2048
  ds_read_b64_tr_b16 a[140:141], v146 offset:2112
  ds_read_b64_tr_b16 a[142:143], v147 offset:2112
  s_waitcnt lgkmcnt(0)
  s_waitcnt vmcnt(24)
  ds_read_b64_tr_b16 a[144:145], v146 offset:4096
  ds_read_b64_tr_b16 a[146:147], v147 offset:4096
  ds_read_b64_tr_b16 a[148:149], v146 offset:4160
  ds_read_b64_tr_b16 a[150:151], v147 offset:4160
  ds_read_b64_tr_b16 a[152:153], v146 offset:6144
  ds_read_b64_tr_b16 a[154:155], v147 offset:6144
  ds_read_b64_tr_b16 a[156:157], v146 offset:6208
  ds_read_b64_tr_b16 a[158:159], v147 offset:6208
  s_waitcnt lgkmcnt(0)
  s_waitcnt vmcnt(20)
  ds_read_b64_tr_b16 a[160:161], v146 offset:8192
  ds_read_b64_tr_b16 a[162:163], v147 offset:8192
  ds_read_b64_tr_b16 a[164:165], v146 offset:8256
  ds_read_b64_tr_b16 a[166:167], v147 offset:8256
  ds_read_b64_tr_b16 a[168:169], v146 offset:10240
  ds_read_b64_tr_b16 a[170:171], v147 offset:10240
  ds_read_b64_tr_b16 a[172:173], v146 offset:10304
  ds_read_b64_tr_b16 a[174:175], v147 offset:10304
  s_waitcnt lgkmcnt(0)
  s_waitcnt vmcnt(16)
  ds_read_b64_tr_b16 a[176:177], v146 offset:12288
  ds_read_b64_tr_b16 a[178:179], v147 offset:12288
  ds_read_b64_tr_b16 a[180:181], v146 offset:12352
  ds_read_b64_tr_b16 a[182:183], v147 offset:12352
  ds_read_b64_tr_b16 a[184:185], v146 offset:14336
  ds_read_b64_tr_b16 a[186:187], v147 offset:14336
  ds_read_b64_tr_b16 a[188:189], v146 offset:14400
  ds_read_b64_tr_b16 a[190:191], v147 offset:14400
  s_waitcnt lgkmcnt(0)
  s_waitcnt vmcnt(12)
  ds_read_b64_tr_b16 a[192:193], v146 offset:16384
  ds_read_b64_tr_b16 a[194:195], v147 offset:16384
  ds_read_b64_tr_b16 a[196:197], v146 offset:16448
  ds_read_b64_tr_b16 a[198:199], v147 offset:16448
  ds_read_b64_tr_b16 a[200:201], v146 offset:18432
  ds_read_b64_tr_b16 a[202:203], v147 offset:18432
  ds_read_b64_tr_b16 a[204:205], v146 offset:18496
  ds_read_b64_tr_b16 a[206:207], v147 offset:18496
  s_waitcnt lgkmcnt(0)
  s_waitcnt vmcnt(8)
  ds_read_b64_tr_b16 a[208:209], v146 offset:20480
  ds_read_b64_tr_b16 a[210:211], v147 offset:20480
  ds_read_b64_tr_b16 a[212:213], v146 offset:20544
  ds_read_b64_tr_b16 a[214:215], v147 offset:20544
  ds_read_b64_tr_b16 a[216:217], v146 offset:22528
  ds_read_b64_tr_b16 a[218:219], v147 offset:22528
  ds_read_b64_tr_b16 a[220:221], v146 offset:22592
  ds_read_b64_tr_b16 a[222:223], v147 offset:22592
  s_waitcnt lgkmcnt(0)
  s_waitcnt vmcnt(4)
  ds_read_b64_tr_b16 a[224:225], v146 offset:24576
  ds_read_b64_tr_b16 a[226:227], v147 offset:24576
  ds_read_b64_tr_b16 a[228:229], v146 offset:24640
  ds_read_b64_tr_b16 a[230:231], v147 offset:24640
  ds_read_b64_tr_b16 a[232:233], v146 offset:26624
  ds_read_b64_tr_b16 a[234:235], v147 offset:26624
  ds_read_b64_tr_b16 a[236:237], v146 offset:26688
  ds_read_b64_tr_b16 a[238:239], v147 offset:26688
  s_waitcnt lgkmcnt(0)
  s_waitcnt vmcnt(0)
  ds_read_b64_tr_b16 a[240:241], v146 offset:28672
  ds_read_b64_tr_b16 a[242:243], v147 offset:28672
  ds_read_b64_tr_b16 a[244:245], v146 offset:28736
  ds_read_b64_tr_b16 a[246:247], v147 offset:28736
  ds_read_b64_tr_b16 a[248:249], v146 offset:30720
  ds_read_b64_tr_b16 a[250:251], v147 offset:30720
  ds_read_b64_tr_b16 a[252:253], v146 offset:30784
  ds_read_b64_tr_b16 a[254:255], v147 offset:30784
  s_waitcnt lgkmcnt(0)
  s_barrier
  s_add_u32 m0, s25, 0
  s_nop 0
  buffer_load_dwordx4 v16, s[12:15], s19 offen lds
  s_add_u32 m0, s25, 1024
  s_nop 0
  buffer_load_dwordx4 v17, s[12:15], s19 offen lds
  s_add_u32 m0, s25, 2048
  s_nop 0
  buffer_load_dwordx4 v18, s[12:15], s19 offen lds
  s_add_u32 m0, s25, 3072
  s_nop 0
  buffer_load_dwordx4 v19, s[12:15], s19 offen lds
  s_add_u32 m0, s25, 4096
  s_nop 0
  buffer_load_dwordx4 v20, s[12:15], s19 offen lds
  s_add_u32 m0, s25, 5120
  s_nop 0
  buffer_load_dwordx4 v21, s[12:15], s19 offen lds
  s_add_u32 m0, s25, 6144
  s_nop 0
  buffer_load_dwordx4 v22, s[12:15], s19 offen lds
  s_add_u32 m0, s25, 7168
  s_nop 0
  buffer_load_dwordx4 v23, s[12:15], s19 offen lds
  s_cmp_gt_u32 s23, 2
  s_cselect_b32 s26, s20, 0
  s_add_u32 s19, s19, s26
  s_add_u32 s25, s25, 32768
  s_and_b32 s25, s25, 0x1ffff
  s_waitcnt vmcnt(0)
  s_barrier
  s_cmp_eq_u32 s48, 0
  s_cselect_b32 s26, 0, s16
  s_cmp_ge_u32 s26, 2
  s_cbranch_scc1 P_v_1
  s_mov_b32 s27, s21
  v_mov_b32 v7, 0x40000000
  s_mov_b32 s29, -3
  v_min_u32 v145, 1, v0
  v_lshlrev_b32 v145, 30, v145
  ds_read_b128 v[24:27], v8 offset:0
  ds_read_b128 v[28:31], v9 offset:0
  ds_read_b128 v[32:35], v10 offset:0
  ds_read_b128 v[36:39], v11 offset:0
  ds_read_b128 v[40:43], v12 offset:0
  ds_read_b128 v[44:47], v13 offset:0
.p2align 6
G_top_3:
  s_waitcnt lgkmcnt(5)
  v_mfma_f32_32x32x16_bf16 v[64:79], a[0:3], v[24:27], 0
  s_add_u32 m0, s25, 0
  ds_read_b128 v[48:51], v14 offset:0
  v_mfma_f32_32x32x16_bf16 v[80:95], a[4:7], v[24:27], 0
  s_waitcnt lgkmcnt(5)
  buffer_load_dwordx4 v16, s[12:15], s19 offen lds
  v_mfma_f32_32x32x16_bf16 v[64:79], a[8:11], v[28:31], v[64:79]
  ds_read_b128 v[52:55], v15 offset:0
  v_mul_f32 v96, s24, v96
  v_mul_f32 v97, s24, v97
  v_mfma_f32_32x32x16_bf16 v[80:95], a[12:15], v[28:31], v[80:95]
  s_waitcnt lgkmcnt(5)
  v_cvt_pk_bf16_f32 v128, v96, v97
  v_mul_f32 v98, s24, v98
  v_mfma_f32_32x32x16_bf16 v[64:79], a[16:19], v[32:35], v[64:79]
  s_add_u32 m0, s25, 1024
  ds_read_b128 v[24:27], v8 offset:8192
  v_mul_f32 v99, s24, v99
  v_cvt_pk_bf16_f32 v129, v98, v99
  v_mfma_f32_32x32x16_bf16 v[80:95], a[20:23], v[32:35], v[80:95]
  s_waitcnt lgkmcnt(5)
  buffer_load_dwordx4 v17, s[12:15], s19 offen lds
  v_mul_f32 v100, s24, v100
  v_mul_f32 v101, s24, v101
  v_mfma_f32_32x32x16_bf16 v[64:79], a[24:27], v[36:39], v[64:79]
  ds_read_b128 v[28:31], v9 offset:8192
  v_cvt_pk_bf16_f32 v130, v100, v101
  v_mul_f32 v102, s24, v102
  v_mfma_f32_32x32x16_bf16 v[80:95], a[28:31], v[36:39], v[80:95]
  s_waitcnt lgkmcnt(5)
  v_mul_f32 v103, s24, v103
  v_cvt_pk_bf16_f32 v131, v102, v103
  v_mfma_f32_32x32x16_bf16 v[64:79], a[32:35], v[40:43], v[64:79]
  s_add_u32 m0, s25, 2048
  ds_read_b128 v[32:35], v10 offset:8192
  v_mul_f32 v104, s24, v104
  v_mul_f32 v105, s24, v105
  v_mfma_f32_32x32x16_bf16 v[80:95], a[36:39], v[40:43], v[80:95]
  s_waitcnt lgkmcnt(5)
  buffer_load_dwordx4 v18, s[12:15], s19 offen lds
  v_cvt_pk_bf16_f32 v132, v104, v105
  v_mul_f32 v106, s24, v106
  v_mfma_f32_32x32x16_bf16 v[64:79], a[40:43], v[44:47], v[64:79]
  ds_read_b128 v[36:39], v11 offset:8192
  v_mul_f32 v107, s24, v107
  v_cvt_pk_bf16_f32 v133, v106, v107
  v_mfma_f32_32x32x16_bf16 v[80:95], a[44:47], v[44:47], v[80:95]
  s_waitcnt lgkmcnt(5)
  v_mul_f32 v108, s24, v108
  v_mul_f32 v109, s24, v109
  v_mfma_f32_32x32x16_bf16 v[64:79], a[48:51], v[48:51], v[64:79]
  s_add_u32 m0, s25, 3072
  ds_read_b128 v[40:43], v12 offset:8192
  v_cvt_pk_bf16_f32 v134, v108, v109
  v_mul_f32 v110, s24, v110
  v_mfma_f32_32x32x16_bf16 v[80:95], a[52:55], v[48:51], v[80:95]
  s_waitcnt lgkmcnt(5)
  buffer_load_dwordx4 v19, s[12:15], s19 offen lds
  v_mul_f32 v111, s24, v111
  v_cvt_pk_bf16_f32 v135, v110, v111
  v_mfma_f32_32x32x16_bf16 v[64:79], a[56:59], v[52:55], v[64:79]
  ds_read_b128 v[44:47], v13 offset:8192
  v_mul_f32 v112, s24, v112
  v_mul_f32 v113, s24, v113
  v_mfma_f32_32x32x16_bf16 v[80:95], a[60:63], v[52:55], v[80:95]
  s_waitcnt lgkmcnt(5)
  v_cvt_pk_bf16_f32 v136, v112, v113
  v_mul_f32 v114, s24, v114
  v_mfma_f32_32x32x16_bf16 v[64:79], a[64:67], v[24:27], v[64:79]
  s_add_u32 m0, s25, 4096
  ds_read_b128 v[48:51], v14 offset:8192
  v_mul_f32 v115, s24, v115
  v_cvt_pk_bf16_f32 v137, v114, v115
  v_mfma_f32_32x32x16_bf16 v[80:95], a[68:71], v[24:27], v[80:95]
  s_waitcnt lgkmcnt(5)
  buffer_load_dwordx4 v20, s[12:15], s19 offen lds
  v_mul_f32 v116, s24, v116
  v_mul_f32 v117, s24, v117
  v_mfma_f32_32x32x16_bf16 v[64:79], a[72:75], v[28:31], v[64:79]
  ds_read_b128 v[52:55], v15 offset:8192
  v_cvt_pk_bf16_f32 v138, v116, v117
  v_mul_f32 v118, s24, v118
  v_mfma_f32_32x32x16_bf16 v[80:95], a[76:79], v[28:31], v[80:95]
  s_waitcnt lgkmcnt(5)
  v_mul_f32 v119, s24, v119
  v_cvt_pk_bf16_f32 v139, v118, v119
  v_mfma_f32_32x32x16_bf16 v[64:79], a[80:83], v[32:35], v[64:79]
  s_add_u32 m0, s25, 5120
  ds_read_b128 v[24:27], v8 offset:16384
  v_mul_f32 v120, s24, v120
  v_mul_f32 v121, s24, v121
  v_mfma_f32_32x32x16_bf16 v[80:95], a[84:87], v[32:35], v[80:95]
  s_waitcnt lgkmcnt(5)
  buffer_load_dwordx4 v21, s[12:15], s19 offen lds
  v_cvt_pk_bf16_f32 v140, v120, v121
  v_mul_f32 v122, s24, v122
  v_mfma_f32_32x32x16_bf16 v[64:79], a[88:91], v[36:39], v[64:79]
  ds_read_b128 v[28:31], v9 offset:16384
  v_mul_f32 v123, s24, v123
  v_cvt_pk_bf16_f32 v141, v122, v123
  v_mfma_f32_32x32x16_bf16 v[80:95], a[92:95], v[36:39], v[80:95]
  s_waitcnt lgkmcnt(5)
  v_mul_f32 v124, s24, v124
  v_mul_f32 v125, s24, v125
  v_mfma_f32_32x32x16_bf16 v[64:79], a[96:99], v[40:43], v[64:79]
  s_add_u32 m0, s25, 6144
  ds_read_b128 v[32:35], v10 offset:16384
  v_cvt_pk_bf16_f32 v142, v124, v125
  v_mul_f32 v126, s24, v126
  v_mfma_f32_32x32x16_bf16 v[80:95], a[100:103], v[40:43], v[80:95]
  s_waitcnt lgkmcnt(5)
  buffer_load_dwordx4 v22, s[12:15], s19 offen lds
  v_mul_f32 v127, s24, v127
  v_cvt_pk_bf16_f32 v143, v126, v127
  v_mfma_f32_32x32x16_bf16 v[64:79], a[104:107], v[44:47], v[64:79]
  ds_read_b128 v[36:39], v11 offset:16384
  v_mfma_f32_32x32x16_bf16 v[80:95], a[108:111], v[44:47], v[80:95]
  s_waitcnt lgkmcnt(5)
  v_mfma_f32_32x32x16_bf16 v[64:79], a[112:115], v[48:51], v[64:79]
  s_add_u32 m0, s25, 7168
  ds_read_b128 v[40:43], v12 offset:16384
  v_mfma_f32_32x32x16_bf16 v[80:95], a[116:119], v[48:51], v[80:95]
  s_waitcnt lgkmcnt(5)
  buffer_load_dwordx4 v23, s[12:15], s19 offen lds
  v_mfma_f32_32x32x16_bf16 v[64:79], a[120:123], v[52:55], v[64:79]
  s_cmp_gt_u32 s23, 3
  ds_read_b128 v[44:47], v13 offset:16384
  v_mfma_f32_32x32x16_bf16 v[80:95], a[124:127], v[52:55], v[80:95]
  s_waitcnt lgkmcnt(5)
  s_cselect_b32 s26, s20, 0
  v_mfma_f32_32x32x16_bf16 v[64:79], a[128:131], v[24:27], v[64:79]
  s_add_u32 s19, s19, s26
  ds_read_b128 v[48:51], v14 offset:16384
  v_mfma_f32_32x32x16_bf16 v[80:95], a[132:135], v[24:27], v[80:95]
  s_waitcnt lgkmcnt(5)
  s_add_u32 s25, s25, 32768
  v_mfma_f32_32x32x16_bf16 v[64:79], a[136:139], v[28:31], v[64:79]
  s_and_b32 s25, s25, 0x1ffff
  ds_read_b128 v[52:55], v15 offset:16384
  v_mfma_f32_32x32x16_bf16 v[80:95], a[140:143], v[28:31], v[80:95]
  s_waitcnt lgkmcnt(5)
  buffer_store_dwordx4 v[128:131], v7, s[4:7], s21 offen offset:0 sc1
  v_mfma_f32_32x32x16_bf16 v[64:79], a[144:147], v[32:35], v[64:79]
  ds_read_b128 v[24:27], v8 offset:24576
  v_mfma_f32_32x32x16_bf16 v[80:95], a[148:151], v[32:35], v[80:95]
  s_waitcnt lgkmcnt(5)
  v_mfma_f32_32x32x16_bf16 v[64:79], a[152:155], v[36:39], v[64:79]
  ds_read_b128 v[28:31], v9 offset:24576
  v_mfma_f32_32x32x16_bf16 v[80:95], a[156:159], v[36:39], v[80:95]
  s_waitcnt lgkmcnt(5)
  buffer_store_dwordx4 v[132:135], v7, s[4:7], s21 offen offset:1024 sc1
  v_mfma_f32_32x32x16_bf16 v[64:79], a[160:163], v[40:43], v[64:79]
  ds_read_b128 v[32:35], v10 offset:24576
  v_mfma_f32_32x32x16_bf16 v[80:95], a[164:167], v[40:43], v[80:95]
  s_waitcnt lgkmcnt(5)
  v_mfma_f32_32x32x16_bf16 v[64:79], a[168:171], v[44:47], v[64:79]
  ds_read_b128 v[36:39], v11 offset:24576
  v_mfma_f32_32x32x16_bf16 v[80:95], a[172:175], v[44:47], v[80:95]
  s_waitcnt lgkmcnt(5)
  buffer_store_dwordx4 v[136:139], v7, s[4:7], s21 offen offset:2048 sc1
  v_mfma_f32_32x32x16_bf16 v[64:79], a[176:179], v[48:51], v[64:79]
  ds_read_b128 v[40:43], v12 offset:24576
  v_mfma_f32_32x32x16_bf16 v[80:95], a[180:183], v[48:51], v[80:95]
  s_waitcnt lgkmcnt(5)
  v_mfma_f32_32x32x16_bf16 v[64:79], a[184:187], v[52:55], v[64:79]
  ds_read_b128 v[44:47], v13 offset:24576
  v_mfma_f32_32x32x16_bf16 v[80:95], a[188:191], v[52:55], v[80:95]
  s_waitcnt lgkmcnt(5)
  buffer_store_dwordx4 v[140:143], v7, s[4:7], s21 offen offset:3072 sc1
  v_mfma_f32_32x32x16_bf16 v[64:79], a[192:195], v[24:27], v[64:79]
  s_mov_b32 s21, s27
  ds_read_b128 v[48:51], v14 offset:24576
  v_mov_b32 v7, v2
  v_mfma_f32_32x32x16_bf16 v[80:95], a[196:199], v[24:27], v[80:95]
  s_waitcnt lgkmcnt(5)
  v_mfma_f32_32x32x16_bf16 v[64:79], a[200:203], v[28:31], v[64:79]
  s_add_u32 s27, s27, s22
  ds_read_b128 v[52:55], v15 offset:24576
  v_mfma_f32_32x32x16_bf16 v[80:95], a[204:207], v[28:31], v[80:95]
  s_waitcnt lgkmcnt(5)
  s_waitcnt vmcnt(17)
  s_barrier
  v_mfma_f32_32x32x16_bf16 v[64:79], a[208:211], v[32:35], v[64:79]
  ds_read_b128 v[24:27], v8 offset:32768
  v_mfma_f32_32x32x16_bf16 v[80:95], a[212:215], v[32:35], v[80:95]
  s_waitcnt lgkmcnt(5)
  v_mfma_f32_32x32x16_bf16 v[64:79], a[216:219], v[36:39], v[64:79]
  s_add_u32 s29, s29, 1
  ds_read_b128 v[28:31], v9 offset:32768
  v_mfma_f32_32x32x16_bf16 v[80:95], a[220:223], v[36:39], v[80:95]
  s_waitcnt lgkmcnt(5)
  s_max_i32 s30, s29, 0
  v_mov_b32 v144, s30
  v_mfma_f32_32x32x16_bf16 v[64:79], a[224:227], v[40:43], v[64:79]
  ds_read_b128 v[32:35], v10 offset:32768
  v_mfma_f32_32x32x16_bf16 v[80:95], a[228:231], v[40:43], v[80:95]
  s_waitcnt lgkmcnt(5)
  buffer_store_dword v144, v145, s[4:7], s31 offen sc1
  v_mfma_f32_32x32x16_bf16 v[64:79], a[232:235], v[44:47], v[64:79]
  ds_read_b128 v[36:39], v11 offset:32768
  v_mfma_f32_32x32x16_bf16 v[80:95], a[236:239], v[44:47], v[80:95]
  s_waitcnt lgkmcnt(5)
  v_mfma_f32_32x32x16_bf16 v[64:79], a[240:243], v[48:51], v[64:79]
  s_sub_u32 s23, s23, 1
  ds_read_b128 v[40:43], v12 offset:32768
  v_mfma_f32_32x32x16_bf16 v[80:95], a[244:247], v[48:51], v[80:95]
  s_waitcnt lgkmcnt(5)
  v_mfma_f32_32x32x16_bf16 v[64:79], a[248:251], v[52:55], v[64:79]
  s_cmp_eq_u32 s23, 0
  ds_read_b128 v[44:47], v13 offset:32768
  v_mfma_f32_32x32x16_bf16 v[80:95], a[252:255], v[52:55], v[80:95]
  s_cbranch_scc1 G_done0_4
  s_waitcnt lgkmcnt(5)
  v_mfma_f32_32x32x16_bf16 v[96:111], a[0:3], v[24:27], 0
  s_add_u32 m0, s25, 0
  ds_read_b128 v[48:51], v14 offset:32768
  v_mfma_f32_32x32x16_bf16 v[112:127], a[4:7], v[24:27], 0
  s_waitcnt lgkmcnt(5)
  buffer_load_dwordx4 v16, s[12:15], s19 offen lds
  v_mfma_f32_32x32x16_bf16 v[96:111], a[8:11], v[28:31], v[96:111]
  ds_read_b128 v[52:55], v15 offset:32768
  v_mul_f32 v64, s24, v64
  v_mul_f32 v65, s24, v65
  v_mfma_f32_32x32x16_bf16 v[112:127], a[12:15], v[28:31], v[112:127]
  s_waitcnt lgkmcnt(5)
  v_cvt_pk_bf16_f32 v128, v64, v65
  v_mul_f32 v66, s24, v66
  v_mfma_f32_32x32x16_bf16 v[96:111], a[16:19], v[32:35], v[96:111]
  s_add_u32 m0, s25, 1024
  ds_read_b128 v[24:27], v8 offset:40960
  v_mul_f32 v67, s24, v67
  v_cvt_pk_bf16_f32 v129, v66, v67
  v_mfma_f32_32x32x16_bf16 v[112:127], a[20:23], v[32:35], v[112:127]
  s_waitcnt lgkmcnt(5)
  buffer_load_dwordx4 v17, s[12:15], s19 offen lds
  v_mul_f32 v68, s24, v68
  v_mul_f32 v69, s24, v69
  v_mfma_f32_32x32x16_bf16 v[96:111], a[24:27], v[36:39], v[96:111]
  ds_read_b128 v[28:31], v9 offset:40960
  v_cvt_pk_bf16_f32 v130, v68, v69
  v_mul_f32 v70, s24, v70
  v_mfma_f32_32x32x16_bf16 v[112:127], a[28:31], v[36:39], v[112:127]
  s_waitcnt lgkmcnt(5)
  v_mul_f32 v71, s24, v71
  v_cvt_pk_bf16_f32 v131, v70, v71
  v_mfma_f32_32x32x16_bf16 v[96:111], a[32:35], v[40:43], v[96:111]
  s_add_u32 m0, s25, 2048
  ds_read_b128 v[32:35], v10 offset:40960
  v_mul_f32 v72, s24, v72
  v_mul_f32 v73, s24, v73
  v_mfma_f32_32x32x16_bf16 v[112:127], a[36:39], v[40:43], v[112:127]
  s_waitcnt lgkmcnt(5)
  buffer_load_dwordx4 v18, s[12:15], s19 offen lds
  v_cvt_pk_bf16_f32 v132, v72, v73
  v_mul_f32 v74, s24, v74
  v_mfma_f32_32x32x16_bf16 v[96:111], a[40:43], v[44:47], v[96:111]
  ds_read_b128 v[36:39], v11 offset:40960
  v_mul_f32 v75, s24, v75
  v_cvt_pk_bf16_f32 v133, v74, v75
  v_mfma_f32_32x32x16_bf16 v[112:127], a[44:47], v[44:47], v[112:127]
  s_waitcnt lgkmcnt(5)
  v_mul_f32 v76, s24, v76
  v_mul_f32 v77, s24, v77
  v_mfma_f32_32x32x16_bf16 v[96:111], a[48:51], v[48:51], v[96:111]
  s_add_u32 m0, s25, 3072
  ds_read_b128 v[40:43], v12 offset:40960
  v_cvt_pk_bf16_f32 v134, v76, v77
  v_mul_f32 v78, s24, v78
  v_mfma_f32_32x32x16_bf16 v[112:127], a[52:55], v[48:51], v[112:127]
  s_waitcnt lgkmcnt(5)
  buffer_load_dwordx4 v19, s[12:15], s19 offen lds
  v_mul_f32 v79, s24, v79
  v_cvt_pk_bf16_f32 v135, v78, v79
  v_mfma_f32_32x32x16_bf16 v[96:111], a[56:59], v[52:55], v[96:111]
  ds_read_b128 v[44:47], v13 offset:40960
  v_mul_f32 v80, s24, v80
  v_mul_f32 v81, s24, v81
  v_mfma_f32_32x32x16_bf16 v[112:127], a[60:63], v[52:55], v[112:127]
  s_waitcnt lgkmcnt(5)
  v_cvt_pk_bf16_f32 v136, v80, v81
  v_mul_f32 v82, s24, v82
  v_mfma_f32_32x32x16_bf16 v[96:111], a[64:67], v[24:27], v[96:111]
  s_add_u32 m0, s25, 4096
  ds_read_b128 v[48:51], v14 offset:40960
  v_mul_f32 v83, s24, v83
  v_cvt_pk_bf16_f32 v137, v82, v83
  v_mfma_f32_32x32x16_bf16 v[112:127], a[68:71], v[24:27], v[112:127]
  s_waitcnt lgkmcnt(5)
  buffer_load_dwordx4 v20, s[12:15], s19 offen lds
  v_mul_f32 v84, s24, v84
  v_mul_f32 v85, s24, v85
  v_mfma_f32_32x32x16_bf16 v[96:111], a[72:75], v[28:31], v[96:111]
  ds_read_b128 v[52:55], v15 offset:40960
  v_cvt_pk_bf16_f32 v138, v84, v85
  v_mul_f32 v86, s24, v86
  v_mfma_f32_32x32x16_bf16 v[112:127], a[76:79], v[28:31], v[112:127]
  s_waitcnt lgkmcnt(5)
  v_mul_f32 v87, s24, v87
  v_cvt_pk_bf16_f32 v139, v86, v87
  v_mfma_f32_32x32x16_bf16 v[96:111], a[80:83], v[32:35], v[96:111]
  s_add_u32 m0, s25, 5120
  ds_read_b128 v[24:27], v8 offset:49152
  v_mul_f32 v88, s24, v88
  v_mul_f32 v89, s24, v89
  v_mfma_f32_32x32x16_bf16 v[112:127], a[84:87], v[32:35], v[112:127]
  s_waitcnt lgkmcnt(5)
  buffer_load_dwordx4 v21, s[12:15], s19 offen lds
  v_cvt_pk_bf16_f32 v140, v88, v89
  v_mul_f32 v90, s24, v90
  v_mfma_f32_32x32x16_bf16 v[96:111], a[88:91], v[36:39], v[96:111]
  ds_read_b128 v[28:31], v9 offset:49152
  v_mul_f32 v91, s24, v91
  v_cvt_pk_bf16_f32 v141, v90, v91
  v_mfma_f32_32x32x16_bf16 v[112:127], a[92:95], v[36:39], v[112:127]
  s_waitcnt lgkmcnt(5)
  v_mul_f32 v92, s24, v92
  v_mul_f32 v93, s24, v93
  v_mfma_f32_32x32x16_bf16 v[96:111], a[96:99], v[40:43], v[96:111]
  s_add_u32 m0, s25, 6144
  ds_read_b128 v[32:35], v10 offset:49152
  v_cvt_pk_bf16_f32 v142, v92, v93
  v_mul_f32 v94, s24, v94
  v_mfma_f32_32x32x16_bf16 v[112:127], a[100:103], v[40:43], v[112:127]
  s_waitcnt lgkmcnt(5)
  buffer_load_dwordx4 v22, s[12:15], s19 offen lds
  v_mul_f32 v95, s24, v95
  v_cvt_pk_bf16_f32 v143, v94, v95
  v_mfma_f32_32x32x16_bf16 v[96:111], a[104:107], v[44:47], v[96:111]
  ds_read_b128 v[36:39], v11 offset:49152
  v_mfma_f32_32x32x16_bf16 v[112:127], a[108:111], v[44:47], v[112:127]
  s_waitcnt lgkmcnt(5)
  v_mfma_f32_32x32x16_bf16 v[96:111], a[112:115], v[48:51], v[96:111]
  s_add_u32 m0, s25, 7168
  ds_read_b128 v[40:43], v12 offset:49152
  v_mfma_f32_32x32x16_bf16 v[112:127], a[116:119], v[48:51], v[112:127]
  s_waitcnt lgkmcnt(5)
  buffer_load_dwordx4 v23, s[12:15], s19 offen lds
  v_mfma_f32_32x32x16_bf16 v[96:111], a[120:123], v[52:55], v[96:111]
  s_cmp_gt_u32 s23, 3
  ds_read_b128 v[44:47], v13 offset:49152
  v_mfma_f32_32x32x16_bf16 v[112:127], a[124:127], v[52:55], v[112:127]
  s_waitcnt lgkmcnt(5)
  s_cselect_b32 s26, s20, 0
  v_mfma_f32_32x32x16_bf16 v[96:111], a[128:131], v[24:27], v[96:111]
  s_add_u32 s19, s19, s26
  ds_read_b128 v[48:51], v14 offset:49152
  v_mfma_f32_32x32x16_bf16 v[112:127], a[132:135], v[24:27], v[112:127]
  s_waitcnt lgkmcnt(5)
  s_add_u32 s25, s25, 32768
  v_mfma_f32_32x32x16_bf16 v[96:111], a[136:139], v[28:31], v[96:111]
  s_and_b32 s25, s25, 0x1ffff
  ds_read_b128 v[52:55], v15 offset:49152
  v_mfma_f32_32x32x16_bf16 v[112:127], a[140:143], v[28:31], v[112:127]
  s_waitcnt lgkmcnt(5)
  buffer_store_dwordx4 v[128:131], v7, s[4:7], s21 offen offset:0 sc1
  v_mfma_f32_32x32x16_bf16 v[96:111], a[144:147], v[32:35], v[96:111]
  ds_read_b128 v[24:27], v8 offset:57344
  v_mfma_f32_32x32x16_bf16 v[112:127], a[148:151], v[32:35], v[112:127]
  s_waitcnt lgkmcnt(5)
  v_xor_b32 v8, 0x10000, v8
  v_mfma_f32_32x32x16_bf16 v[96:111], a[152:155], v[36:39], v[96:111]
  ds_read_b128 v[28:31], v9 offset:57344
  v_mfma_f32_32x32x16_bf16 v[112:127], a[156:159], v[36:39], v[112:127]
  s_waitcnt lgkmcnt(5)
  buffer_store_dwordx4 v[132:135], v7, s[4:7], s21 offen offset:1024 sc1
  v_xor_b32 v9, 0x10000, v9
  v_mfma_f32_32x32x16_bf16 v[96:111], a[160:163], v[40:43], v[96:111]
  ds_read_b128 v[32:35], v10 offset:57344
  v_mfma_f32_32x32x16_bf16 v[112:127], a[164:167], v[40:43], v[112:127]
  s_waitcnt lgkmcnt(5)
  v_xor_b32 v10, 0x10000, v10
  v_mfma_f32_32x32x16_bf16 v[96:111], a[168:171], v[44:47], v[96:111]
  ds_read_b128 v[36:39], v11 offset:57344
  v_mfma_f32_32x32x16_bf16 v[112:127], a[172:175], v[44:47], v[112:127]
  s_waitcnt lgkmcnt(5)
  buffer_store_dwordx4 v[136:139], v7, s[4:7], s21 offen offset:2048 sc1
  v_xor_b32 v11, 0x10000, v11
  v_mfma_f32_32x32x16_bf16 v[96:111], a[176:179], v[48:51], v[96:111]
  ds_read_b128 v[40:43], v12 offset:57344
  v_mfma_f32_32x32x16_bf16 v[112:127], a[180:183], v[48:51], v[112:127]
  s_waitcnt lgkmcnt(5)
  v_xor_b32 v12, 0x10000, v12
  v_mfma_f32_32x32x16_bf16 v[96:111], a[184:187], v[52:55], v[96:111]
  ds_read_b128 v[44:47], v13 offset:57344
  v_mfma_f32_32x32x16_bf16 v[112:127], a[188:191], v[52:55], v[112:127]
  s_waitcnt lgkmcnt(5)
  buffer_store_dwordx4 v[140:143], v7, s[4:7], s21 offen offset:3072 sc1
  v_xor_b32 v13, 0x10000, v13
  v_mfma_f32_32x32x16_bf16 v[96:111], a[192:195], v[24:27], v[96:111]
  s_mov_b32 s21, s27
  ds_read_b128 v[48:51], v14 offset:57344
  v_mov_b32 v7, v2
  v_mfma_f32_32x32x16_bf16 v[112:127], a[196:199], v[24:27], v[112:127]
  s_waitcnt lgkmcnt(5)
  v_xor_b32 v14, 0x10000, v14
  v_mfma_f32_32x32x16_bf16 v[96:111], a[200:203], v[28:31], v[96:111]
  s_add_u32 s27, s27, s22
  ds_read_b128 v[52:55], v15 offset:57344
  v_mfma_f32_32x32x16_bf16 v[112:127], a[204:207], v[28:31], v[112:127]
  s_waitcnt lgkmcnt(5)
  s_waitcnt vmcnt(17)
  s_barrier
  v_xor_b32 v15, 0x10000, v15
  v_mfma_f32_32x32x16_bf16 v[96:111], a[208:211], v[32:35], v[96:111]
  ds_read_b128 v[24:27], v8 offset:0
  v_mfma_f32_32x32x16_bf16 v[112:127], a[212:215], v[32:35], v[112:127]
  s_waitcnt lgkmcnt(5)
  v_mfma_f32_32x32x16_bf16 v[96:111], a[216:219], v[36:39], v[96:111]
  s_add_u32 s29, s29, 1
  ds_read_b128 v[28:31], v9 offset:0
  v_mfma_f32_32x32x16_bf16 v[112:127], a[220:223], v[36:39], v[112:127]
  s_waitcnt lgkmcnt(5)
  s_max_i32 s30, s29, 0
  v_mov_b32 v144, s30
  v_mfma_f32_32x32x16_bf16 v[96:111], a[224:227], v[40:43], v[96:111]
  ds_read_b128 v[32:35], v10 offset:0
  v_mfma_f32_32x32x16_bf16 v[112:127], a[228:231], v[40:43], v[112:127]
  s_waitcnt lgkmcnt(5)
  buffer_store_dword v144, v145, s[4:7], s31 offen sc1
  v_mfma_f32_32x32x16_bf16 v[96:111], a[232:235], v[44:47], v[96:111]
  ds_read_b128 v[36:39], v11 offset:0
  v_mfma_f32_32x32x16_bf16 v[112:127], a[236:239], v[44:47], v[112:127]
  s_waitcnt lgkmcnt(5)
  v_mfma_f32_32x32x16_bf16 v[96:111], a[240:243], v[48:51], v[96:111]
  s_sub_u32 s23, s23, 1
  ds_read_b128 v[40:43], v12 offset:0
  v_mfma_f32_32x32x16_bf16 v[112:127], a[244:247], v[48:51], v[112:127]
  s_waitcnt lgkmcnt(5)
  v_mfma_f32_32x32x16_bf16 v[96:111], a[248:251], v[52:55], v[96:111]
  s_cmp_eq_u32 s23, 0
  ds_read_b128 v[44:47], v13 offset:0
  v_mfma_f32_32x32x16_bf16 v[112:127], a[252:255], v[52:55], v[112:127]
  s_cbranch_scc1 G_done1_5
  s_branch G_top_3
G_done0_4:
  s_nop 7
  s_nop 3
  v_mul_f32 v64, s24, v64
  v_mul_f32 v65, s24, v65
  v_cvt_pk_bf16_f32 v128, v64, v65
  v_mul_f32 v66, s24, v66
  v_mul_f32 v67, s24, v67
  v_cvt_pk_bf16_f32 v129, v66, v67
  v_mul_f32 v68, s24, v68
  v_mul_f32 v69, s24, v69
  v_cvt_pk_bf16_f32 v130, v68, v69
  v_mul_f32 v70, s24, v70
  v_mul_f32 v71, s24, v71
  v_cvt_pk_bf16_f32 v131, v70, v71
  buffer_store_dwordx4 v[128:131], v7, s[4:7], s21 offen offset:0 sc1
  v_mul_f32 v72, s24, v72
  v_mul_f32 v73, s24, v73
  v_cvt_pk_bf16_f32 v132, v72, v73
  v_mul_f32 v74, s24, v74
  v_mul_f32 v75, s24, v75
  v_cvt_pk_bf16_f32 v133, v74, v75
  v_mul_f32 v76, s24, v76
  v_mul_f32 v77, s24, v77
  v_cvt_pk_bf16_f32 v134, v76, v77
  v_mul_f32 v78, s24, v78
  v_mul_f32 v79, s24, v79
  v_cvt_pk_bf16_f32 v135, v78, v79
  buffer_store_dwordx4 v[132:135], v7, s[4:7], s21 offen offset:1024 sc1
  v_mul_f32 v80, s24, v80
  v_mul_f32 v81, s24, v81
  v_cvt_pk_bf16_f32 v136, v80, v81
  v_mul_f32 v82, s24, v82
  v_mul_f32 v83, s24, v83
  v_cvt_pk_bf16_f32 v137, v82, v83
  v_mul_f32 v84, s24, v84
  v_mul_f32 v85, s24, v85
  v_cvt_pk_bf16_f32 v138, v84, v85
  v_mul_f32 v86, s24, v86
  v_mul_f32 v87, s24, v87
  v_cvt_pk_bf16_f32 v139, v86, v87
  buffer_store_dwordx4 v[136:139], v7, s[4:7], s21 offen offset:2048 sc1
  v_mul_f32 v88, s24, v88
  v_mul_f32 v89, s24, v89
  v_cvt_pk_bf16_f32 v140, v88, v89
  v_mul_f32 v90, s24, v90
  v_mul_f32 v91, s24, v91
  v_cvt_pk_bf16_f32 v141, v90, v91
  v_mul_f32 v92, s24, v92
  v_mul_f32 v93, s24, v93
  v_cvt_pk_bf16_f32 v142, v92, v93
  v_mul_f32 v94, s24, v94
  v_mul_f32 v95, s24, v95
  v_cvt_pk_bf16_f32 v143, v94, v95
  buffer_store_dwordx4 v[140:143], v7, s[4:7], s21 offen offset:3072 sc1
  s_branch G_fin_6
G_done1_5:
  s_nop 7
  s_nop 3
  v_mul_f32 v96, s24, v96
  v_mul_f32 v97, s24, v97
  v_cvt_pk_bf16_f32 v128, v96, v97
  v_mul_f32 v98, s24, v98
  v_mul_f32 v99, s24, v99
  v_cvt_pk_bf16_f32 v129, v98, v99
  v_mul_f32 v100, s24, v100
  v_mul_f32 v101, s24, v101
  v_cvt_pk_bf16_f32 v130, v100, v101
  v_mul_f32 v102, s24, v102
  v_mul_f32 v103, s24, v103
  v_cvt_pk_bf16_f32 v131, v102, v103
  buffer_store_dwordx4 v[128:131], v7, s[4:7], s21 offen offset:0 sc1
  v_mul_f32 v104, s24, v104
  v_mul_f32 v105, s24, v105
  v_cvt_pk_bf16_f32 v132, v104, v105
  v_mul_f32 v106, s24, v106
  v_mul_f32 v107, s24, v107
  v_cvt_pk_bf16_f32 v133, v106, v107
  v_mul_f32 v108, s24, v108
  v_mul_f32 v109, s24, v109
  v_cvt_pk_bf16_f32 v134, v108, v109
  v_mul_f32 v110, s24, v110
  v_mul_f32 v111, s24, v111
  v_cvt_pk_bf16_f32 v135, v110, v111
  buffer_store_dwordx4 v[132:135], v7, s[4:7], s21 offen offset:1024 sc1
  v_mul_f32 v112, s24, v112
  v_mul_f32 v113, s24, v113
  v_cvt_pk_bf16_f32 v136, v112, v113
  v_mul_f32 v114, s24, v114
  v_mul_f32 v115, s24, v115
  v_cvt_pk_bf16_f32 v137, v114, v115
  v_mul_f32 v116, s24, v116
  v_mul_f32 v117, s24, v117
  v_cvt_pk_bf16_f32 v138, v116, v117
  v_mul_f32 v118, s24, v118
  v_mul_f32 v119, s24, v119
  v_cvt_pk_bf16_f32 v139, v118, v119
  buffer_store_dwordx4 v[136:139], v7, s[4:7], s21 offen offset:2048 sc1
  v_mul_f32 v120, s24, v120
  v_mul_f32 v121, s24, v121
  v_cvt_pk_bf16_f32 v140, v120, v121
  v_mul_f32 v122, s24, v122
  v_mul_f32 v123, s24, v123
  v_cvt_pk_bf16_f32 v141, v122, v123
  v_mul_f32 v124, s24, v124
  v_mul_f32 v125, s24, v125
  v_cvt_pk_bf16_f32 v142, v124, v125
  v_mul_f32 v126, s24, v126
  v_mul_f32 v127, s24, v127
  v_cvt_pk_bf16_f32 v143, v126, v127
  buffer_store_dwordx4 v[140:143], v7, s[4:7], s21 offen offset:3072 sc1
G_fin_6:
  s_waitcnt vmcnt(0) lgkmcnt(0)
  s_barrier
  s_add_u32 s30, s29, 3
  v_mov_b32 v144, s30
  v_min_u32 v145, 1, v0
  v_lshlrev_b32 v145, 30, v145
  buffer_store_dword v144, v145, s[4:7], s31 offen sc1
  s_branch P_end_2
P_v_1:
  s_mov_b32 s27, s21
  v_mov_b32 v7, 0x40000000
  s_mov_b32 s29, -3
  v_min_u32 v145, 1, v0
  v_lshlrev_b32 v145, 30, v145
  ds_read_b128 v[24:27], v8 offset:0
  ds_read_b128 v[28:31], v9 offset:0
  ds_read_b128 v[32:35], v10 offset:0
  ds_read_b128 v[36:39], v11 offset:0
  ds_read_b128 v[40:43], v12 offset:0
  ds_read_b128 v[44:47], v13 offset:0
.p2align 6
G_top_7:
  s_waitcnt lgkmcnt(5)
  v_mfma_f32_32x32x16_bf16 v[64:79], v[24:27], a[0:3], 0
  s_add_u32 m0, s25, 0
  ds_read_b128 v[48:51], v14 offset:0
  v_mfma_f32_32x32x16_bf16 v[80:95], v[24:27], a[4:7], 0
  s_waitcnt lgkmcnt(5)
  buffer_load_dwordx4 v16, s[12:15], s19 offen lds
  v_mfma_f32_32x32x16_bf16 v[64:79], v[28:31], a[8:11], v[64:79]
  ds_read_b128 v[52:55], v15 offset:0
  v_mul_f32 v96, s24, v96
  v_mul_f32 v97, s24, v97
  v_mfma_f32_32x32x16_bf16 v[80:95], v[28:31], a[12:15], v[80:95]
  s_waitcnt lgkmcnt(5)
  v_cvt_pk_bf16_f32 v128, v96, v97
  v_mul_f32 v98, s24, v98
  v_mfma_f32_32x32x16_bf16 v[64:79], v[32:35], a[16:19], v[64:79]
  s_add_u32 m0, s25, 1024
  ds_read_b128 v[24:27], v8 offset:8192
  v_mul_f32 v99, s24, v99
  v_cvt_pk_bf16_f32 v129, v98, v99
  v_mfma_f32_32x32x16_bf16 v[80:95], v[32:35], a[20:23], v[80:95]
  s_waitcnt lgkmcnt(5)
  buffer_load_dwordx4 v17, s[12:15], s19 offen lds
  v_mul_f32 v100, s24, v100
  v_mul_f32 v101, s24, v101
  v_mfma_f32_32x32x16_bf16 v[64:79], v[36:39], a[24:27], v[64:79]
  ds_read_b128 v[28:31], v9 offset:8192
  v_cvt_pk_bf16_f32 v130, v100, v101
  v_mul_f32 v102, s24, v102
  v_mfma_f32_32x32x16_bf16 v[80:95], v[36:39], a[28:31], v[80:95]
  s_waitcnt lgkmcnt(5)
  v_mul_f32 v103, s24, v103
  v_cvt_pk_bf16_f32 v131, v102, v103
  v_mfma_f32_32x32x16_bf16 v[64:79], v[40:43], a[32:35], v[64:79]
  s_add_u32 m0, s25, 2048
  ds_read_b128 v[32:35], v10 offset:8192
  v_mul_f32 v104, s24, v104
  v_mul_f32 v105, s24, v105
  v_mfma_f32_32x32x16_bf16 v[80:95], v[40:43], a[36:39], v[80:95]
  s_waitcnt lgkmcnt(5)
  buffer_load_dwordx4 v18, s[12:15], s19 offen lds
  v_cvt_pk_bf16_f32 v132, v104, v105
  v_mul_f32 v106, s24, v106
  v_mfma_f32_32x32x16_bf16 v[64:79], v[44:47], a[40:43], v[64:79]
  ds_read_b128 v[36:39], v11 offset:8192
  v_mul_f32 v107, s24, v107
  v_cvt_pk_bf16_f32 v133, v106, v107
  v_mfma_f32_32x32x16_bf16 v[80:95], v[44:47], a[44:47], v[80:95]
  s_waitcnt lgkmcnt(5)
  v_mul_f32 v108, s24, v108
  v_mul_f32 v109, s24, v109
  v_mfma_f32_32x32x16_bf16 v[64:79], v[48:51], a[48:51], v[64:79]
  s_add_u32 m0, s25, 3072
  ds_read_b128 v[40:43], v12 offset:8192
  v_cvt_pk_bf16_f32 v134, v108, v109
  v_mul_f32 v110, s24, v110
  v_mfma_f32_32x32x16_bf16 v[80:95], v[48:51], a[52:55], v[80:95]
  s_waitcnt lgkmcnt(5)
  buffer_load_dwordx4 v19, s[12:15], s19 offen lds
  v_mul_f32 v111, s24, v111
  v_cvt_pk_bf16_f32 v135, v110, v111
  v_mfma_f32_32x32x16_bf16 v[64:79], v[52:55], a[56:59], v[64:79]
  ds_read_b128 v[44:47], v13 offset:8192
  v_mul_f32 v112, s24, v112
  v_mul_f32 v113, s24, v113
  v_mfma_f32_32x32x16_bf16 v[80:95], v[52:55], a[60:63], v[80:95]
  s_waitcnt lgkmcnt(5)
  v_cvt_pk_bf16_f32 v136, v112, v113
  v_mul_f32 v114, s24, v114
  v_mfma_f32_32x32x16_bf16 v[64:79], v[24:27], a[64:67], v[64:79]
  s_add_u32 m0, s25, 4096
  ds_read_b128 v[48:51], v14 offset:8192
  v_mul_f32 v115, s24, v115
  v_cvt_pk_bf16_f32 v137, v114, v115
  v_mfma_f32_32x32x16_bf16 v[80:95], v[24:27], a[68:71], v[80:95]
  s_waitcnt lgkmcnt(5)
  buffer_load_dwordx4 v20, s[12:15], s19 offen lds
  v_mul_f32 v116, s24, v116
  v_mul_f32 v117, s24, v117
  v_mfma_f32_32x32x16_bf16 v[64:79], v[28:31], a[72:75], v[64:79]
  ds_read_b128 v[52:55], v15 offset:8192
  v_cvt_pk_bf16_f32 v138, v116, v117
  v_mul_f32 v118, s24, v118
  v_mfma_f32_32x32x16_bf16 v[80:95], v[28:31], a[76:79], v[80:95]
  s_waitcnt lgkmcnt(5)
  v_mul_f32 v119, s24, v119
  v_cvt_pk_bf16_f32 v139, v118, v119
  v_mfma_f32_32x32x16_bf16 v[64:79], v[32:35], a[80:83], v[64:79]
  s_add_u32 m0, s25, 5120
  ds_read_b128 v[24:27], v8 offset:16384
  v_mul_f32 v120, s24, v120
  v_mul_f32 v121, s24, v121
  v_mfma_f32_32x32x16_bf16 v[80:95], v[32:35], a[84:87], v[80:95]
  s_waitcnt lgkmcnt(5)
  buffer_load_dwordx4 v21, s[12:15], s19 offen lds
  v_cvt_pk_bf16_f32 v140, v120, v121
  v_mul_f32 v122, s24, v122
  v_mfma_f32_32x32x16_bf16 v[64:79], v[36:39], a[88:91], v[64:79]
  ds_read_b128 v[28:31], v9 offset:16384
  v_mul_f32 v123, s24, v123
  v_cvt_pk_bf16_f32 v141, v122, v123
  v_mfma_f32_32x32x16_bf16 v[80:95], v[36:39], a[92:95], v[80:95]
  s_waitcnt lgkmcnt(5)
  v_mul_f32 v124, s24, v124
  v_mul_f32 v125, s24, v125
  v_mfma_f32_32x32x16_bf16 v[64:79], v[40:43], a[96:99], v[64:79]
  s_add_u32 m0, s25, 6144
  ds_read_b128 v[32:35], v10 offset:16384
  v_cvt_pk_bf16_f32 v142, v124, v125
  v_mul_f32 v126, s24, v126
  v_mfma_f32_32x32x16_bf16 v[80:95], v[40:43], a[100:103], v[80:95]
  s_waitcnt lgkmcnt(5)
  buffer_load_dwordx4 v22, s[12:15], s19 offen lds
  v_mul_f32 v127, s24, v127
  v_cvt_pk_bf16_f32 v143, v126, v127
  v_mfma_f32_32x32x16_bf16 v[64:79], v[44:47], a[104:107], v[64:79]
  ds_read_b128 v[36:39], v11 offset:16384
  v_mfma_f32_32x32x16_bf16 v[80:95], v[44:47], a[108:111], v[80:95]
  s_waitcnt lgkmcnt(5)
  v_mfma_f32_32x32x16_bf16 v[64:79], v[48:51], a[112:115], v[64:79]
  s_add_u32 m0, s25, 7168
  ds_read_b128 v[40:43], v12 offset:16384
  v_mfma_f32_32x32x16_bf16 v[80:95], v[48:51], a[116:119], v[80:95]
  s_waitcnt lgkmcnt(5)
  buffer_load_dwordx4 v23, s[12:15], s19 offen lds
  v_mfma_f32_32x32x16_bf16 v[64:79], v[52:55], a[120:123], v[64:79]
  s_cmp_gt_u32 s23, 3
  ds_read_b128 v[44:47], v13 offset:16384
  v_mfma_f32_32x32x16_bf16 v[80:95], v[52:55], a[124:127], v[80:95]
  s_waitcnt lgkmcnt(5)
  s_cselect_b32 s26, s20, 0
  v_mfma_f32_32x32x16_bf16 v[64:79], v[24:27], a[128:131], v[64:79]
  s_add_u32 s19, s19, s26
  ds_read_b128 v[48:51], v14 offset:16384
  v_mfma_f32_32x32x16_bf16 v[80:95], v[24:27], a[132:135], v[80:95]
  s_waitcnt lgkmcnt(5)
  s_add_u32 s25, s25, 32768
  v_mfma_f32_32x32x16_bf16 v[64:79], v[28:31], a[136:139], v[64:79]
  s_and_b32 s25, s25, 0x1ffff
  ds_read_b128 v[52:55], v15 offset:16384
  v_mfma_f32_32x32x16_bf16 v[80:95], v[28:31], a[140:143], v[80:95]
  s_waitcnt lgkmcnt(5)
  buffer_store_dwordx4 v[128:131], v7, s[4:7], s21 offen offset:0 sc1
  v_mfma_f32_32x32x16_bf16 v[64:79], v[32:35], a[144:147], v[64:79]
  ds_read_b128 v[24:27], v8 offset:24576
  v_mfma_f32_32x32x16_bf16 v[80:95], v[32:35], a[148:151], v[80:95]
  s_waitcnt lgkmcnt(5)
  v_mfma_f32_32x32x16_bf16 v[64:79], v[36:39], a[152:155], v[64:79]
  ds_read_b128 v[28:31], v9 offset:24576
  v_mfma_f32_32x32x16_bf16 v[80:95], v[36:39], a[156:159], v[80:95]
  s_waitcnt lgkmcnt(5)
  buffer_store_dwordx4 v[132:135], v7, s[4:7], s21 offen offset:1024 sc1
  v_mfma_f32_32x32x16_bf16 v[64:79], v[40:43], a[160:163], v[64:79]
  ds_read_b128 v[32:35], v10 offset:24576
  v_mfma_f32_32x32x16_bf16 v[80:95], v[40:43], a[164:167], v[80:95]
  s_waitcnt lgkmcnt(5)
  v_mfma_f32_32x32x16_bf16 v[64:79], v[44:47], a[168:171], v[64:79]
  ds_read_b128 v[36:39], v11 offset:24576
  v_mfma_f32_32x32x16_bf16 v[80:95], v[44:47], a[172:175], v[80:95]
  s_waitcnt lgkmcnt(5)
  buffer_store_dwordx4 v[136:139], v7, s[4:7], s21 offen offset:2048 sc1
  v_mfma_f32_32x32x16_bf16 v[64:79], v[48:51], a[176:179], v[64:79]
  ds_read_b128 v[40:43], v12 offset:24576
  v_mfma_f32_32x32x16_bf16 v[80:95], v[48:51], a[180:183], v[80:95]
  s_waitcnt lgkmcnt(5)
  v_mfma_f32_32x32x16_bf16 v[64:79], v[52:55], a[184:187], v[64:79]
  ds_read_b128 v[44:47], v13 offset:24576
  v_mfma_f32_32x32x16_bf16 v[80:95], v[52:55], a[188:191], v[80:95]
  s_waitcnt lgkmcnt(5)
  buffer_store_dwordx4 v[140:143], v7, s[4:7], s21 offen offset:3072 sc1
  v_mfma_f32_32x32x16_bf16 v[64:79], v[24:27], a[192:195], v[64:79]
  s_mov_b32 s21, s27
  ds_read_b128 v[48:51], v14 offset:24576
  v_mov_b32 v7, v2
  v_mfma_f32_32x32x16_bf16 v[80:95], v[24:27], a[196:199], v[80:95]
  s_waitcnt lgkmcnt(5)
  v_mfma_f32_32x32x16_bf16 v[64:79], v[28:31], a[200:203], v[64:79]
  s_add_u32 s27, s27, s22
  ds_read_b128 v[52:55], v15 offset:24576
  v_mfma_f32_32x32x16_bf16 v[80:95], v[28:31], a[204:207], v[80:95]
  s_waitcnt lgkmcnt(5)
  s_waitcnt vmcnt(17)
  s_barrier
  v_mfma_f32_32x32x16_bf16 v[64:79], v[32:35], a[208:211], v[64:79]
  ds_read_b128 v[24:27], v8 offset:32768
  v_mfma_f32_32x32x16_bf16 v[80:95], v[32:35], a[212:215], v[80:95]
  s_waitcnt lgkmcnt(5)
  v_mfma_f32_32x32x16_bf16 v[64:79], v[36:39], a[216:219], v[64:79]
  s_add_u32 s29, s29, 1
  ds_read_b128 v[28:31], v9 offset:32768
  v_mfma_f32_32x32x16_bf16 v[80:95], v[36:39], a[220:223], v[80:95]
  s_waitcnt lgkmcnt(5)
  s_max_i32 s30, s29, 0
  v_mov_b32 v144, s30
  v_mfma_f32_32x32x16_bf16 v[64:79], v[40:43], a[224:227], v[64:79]
  ds_read_b128 v[32:35], v10 offset:32768
  v_mfma_f32_32x32x16_bf16 v[80:95], v[40:43], a[228:231], v[80:95]
  s_waitcnt lgkmcnt(5)
  buffer_store_dword v144, v145, s[4:7], s31 offen sc1
  v_mfma_f32_32x32x16_bf16 v[64:79], v[44:47], a[232:235], v[64:79]
  ds_read_b128 v[36:39], v11 offset:32768
  v_mfma_f32_32x32x16_bf16 v[80:95], v[44:47], a[236:239], v[80:95]
  s_waitcnt lgkmcnt(5)
  v_mfma_f32_32x32x16_bf16 v[64:79], v[48:51], a[240:243], v[64:79]
  s_sub_u32 s23, s23, 1
  ds_read_b128 v[40:43], v12 offset:32768
  v_mfma_f32_32x32x16_bf16 v[80:95], v[48:51], a[244:247], v[80:95]
  s_waitcnt lgkmcnt(5)
  v_mfma_f32_32x32x16_bf16 v[64:79], v[52:55], a[248:251], v[64:79]
  s_cmp_eq_u32 s23, 0
  ds_read_b128 v[44:47], v13 offset:32768
  v_mfma_f32_32x32x16_bf16 v[80:95], v[52:55], a[252:255], v[80:95]
  s_cbranch_scc1 G_done0_8
  s_waitcnt lgkmcnt(5)
  v_mfma_f32_32x32x16_bf16 v[96:111], v[24:27], a[0:3], 0
  s_add_u32 m0, s25, 0
  ds_read_b128 v[48:51], v14 offset:32768
  v_mfma_f32_32x32x16_bf16 v[112:127], v[24:27], a[4:7], 0
  s_waitcnt lgkmcnt(5)
  buffer_load_dwordx4 v16, s[12:15], s19 offen lds
  v_mfma_f32_32x32x16_bf16 v[96:111], v[28:31], a[8:11], v[96:111]
  ds_read_b128 v[52:55], v15 offset:32768
  v_mul_f32 v64, s24, v64
  v_mul_f32 v65, s24, v65
  v_mfma_f32_32x32x16_bf16 v[112:127], v[28:31], a[12:15], v[112:127]
  s_waitcnt lgkmcnt(5)
  v_cvt_pk_bf16_f32 v128, v64, v65
  v_mul_f32 v66, s24, v66
  v_mfma_f32_32x32x16_bf16 v[96:111], v[32:35], a[16:19], v[96:111]
  s_add_u32 m0, s25, 1024
  ds_read_b128 v[24:27], v8 offset:40960
  v_mul_f32 v67, s24, v67
  v_cvt_pk_bf16_f32 v129, v66, v67
  v_mfma_f32_32x32x16_bf16 v[112:127], v[32:35], a[20:23], v[112:127]
  s_waitcnt lgkmcnt(5)
  buffer_load_dwordx4 v17, s[12:15], s19 offen lds
  v_mul_f32 v68, s24, v68
  v_mul_f32 v69, s24, v69
  v_mfma_f32_32x32x16_bf16 v[96:111], v[36:39], a[24:27], v[96:111]
  ds_read_b128 v[28:31], v9 offset:40960
  v_cvt_pk_bf16_f32 v130, v68, v69
  v_mul_f32 v70, s24, v70
  v_mfma_f32_32x32x16_bf16 v[112:127], v[36:39], a[28:31], v[112:127]
  s_waitcnt lgkmcnt(5)
  v_mul_f32 v71, s24, v71
  v_cvt_pk_bf16_f32 v131, v70, v71
  v_mfma_f32_32x32x16_bf16 v[96:111], v[40:43], a[32:35], v[96:111]
  s_add_u32 m0, s25, 2048
  ds_read_b128 v[32:35], v10 offset:40960
  v_mul_f32 v72, s24, v72
  v_mul_f32 v73, s24, v73
  v_mfma_f32_32x32x16_bf16 v[112:127], v[40:43], a[36:39], v[112:127]
  s_waitcnt lgkmcnt(5)
  buffer_load_dwordx4 v18, s[12:15], s19 offen lds
  v_cvt_pk_bf16_f32 v132, v72, v73
  v_mul_f32 v74, s24, v74
  v_mfma_f32_32x32x16_bf16 v[96:111], v[44:47], a[40:43], v[96:111]
  ds_read_b128 v[36:39], v11 offset:40960
  v_mul_f32 v75, s24, v75
  v_cvt_pk_bf16_f32 v133, v74, v75
  v_mfma_f32_32x32x16_bf16 v[112:127], v[44:47], a[44:47], v[112:127]
  s_waitcnt lgkmcnt(5)
  v_mul_f32 v76, s24, v76
  v_mul_f32 v77, s24, v77
  v_mfma_f32_32x32x16_bf16 v[96:111], v[48:51], a[48:51], v[96:111]
  s_add_u32 m0, s25, 3072
  ds_read_b128 v[40:43], v12 offset:40960
  v_cvt_pk_bf16_f32 v134, v76, v77
  v_mul_f32 v78, s24, v78
  v_mfma_f32_32x32x16_bf16 v[112:127], v[48:51], a[52:55], v[112:127]
  s_waitcnt lgkmcnt(5)
  buffer_load_dwordx4 v19, s[12:15], s19 offen lds
  v_mul_f32 v79, s24, v79
  v_cvt_pk_bf16_f32 v135, v78, v79
  v_mfma_f32_32x32x16_bf16 v[96:111], v[52:55], a[56:59], v[96:111]
  ds_read_b128 v[44:47], v13 offset:40960
  v_mul_f32 v80, s24, v80
  v_mul_f32 v81, s24, v81
  v_mfma_f32_32x32x16_bf16 v[112:127], v[52:55], a[60:63], v[112:127]
  s_waitcnt lgkmcnt(5)
  v_cvt_pk_bf16_f32 v136, v80, v81
  v_mul_f32 v82, s24, v82
  v_mfma_f32_32x32x16_bf16 v[96:111], v[24:27], a[64:67], v[96:111]
  s_add_u32 m0, s25, 4096
  ds_read_b128 v[48:51], v14 offset:40960
  v_mul_f32 v83, s24, v83
  v_cvt_pk_bf16_f32 v137, v82, v83
  v_mfma_f32_32x32x16_bf16 v[112:127], v[24:27], a[68:71], v[112:127]
  s_waitcnt lgkmcnt(5)
  buffer_load_dwordx4 v20, s[12:15], s19 offen lds
  v_mul_f32 v84, s24, v84
  v_mul_f32 v85, s24, v85
  v_mfma_f32_32x32x16_bf16 v[96:111], v[28:31], a[72:75], v[96:111]
  ds_read_b128 v[52:55], v15 offset:40960
  v_cvt_pk_bf16_f32 v138, v84, v85
  v_mul_f32 v86, s24, v86
  v_mfma_f32_32x32x16_bf16 v[112:127], v[28:31], a[76:79], v[112:127]
  s_waitcnt lgkmcnt(5)
  v_mul_f32 v87, s24, v87
  v_cvt_pk_bf16_f32 v139, v86, v87
  v_mfma_f32_32x32x16_bf16 v[96:111], v[32:35], a[80:83], v[96:111]
  s_add_u32 m0, s25, 5120
  ds_read_b128 v[24:27], v8 offset:49152
  v_mul_f32 v88, s24, v88
  v_mul_f32 v89, s24, v89
  v_mfma_f32_32x32x16_bf16 v[112:127], v[32:35], a[84:87], v[112:127]
  s_waitcnt lgkmcnt(5)
  buffer_load_dwordx4 v21, s[12:15], s19 offen lds
  v_cvt_pk_bf16_f32 v140, v88, v89
  v_mul_f32 v90, s24, v90
  v_mfma_f32_32x32x16_bf16 v[96:111], v[36:39], a[88:91], v[96:111]
  ds_read_b128 v[28:31], v9 offset:49152
  v_mul_f32 v91, s24, v91
  v_cvt_pk_bf16_f32 v141, v90, v91
  v_mfma_f32_32x32x16_bf16 v[112:127], v[36:39], a[92:95], v[112:127]
  s_waitcnt lgkmcnt(5)
  v_mul_f32 v92, s24, v92
  v_mul_f32 v93, s24, v93
  v_mfma_f32_32x32x16_bf16 v[96:111], v[40:43], a[96:99], v[96:111]
  s_add_u32 m0, s25, 6144
  ds_read_b128 v[32:35], v10 offset:49152
  v_cvt_pk_bf16_f32 v142, v92, v93
  v_mul_f32 v94, s24, v94
  v_mfma_f32_32x32x16_bf16 v[112:127], v[40:43], a[100:103], v[112:127]
  s_waitcnt lgkmcnt(5)
  buffer_load_dwordx4 v22, s[12:15], s19 offen lds
  v_mul_f32 v95, s24, v95
  v_cvt_pk_bf16_f32 v143, v94, v95
  v_mfma_f32_32x32x16_bf16 v[96:111], v[44:47], a[104:107], v[96:111]
  ds_read_b128 v[36:39], v11 offset:49152
  v_mfma_f32_32x32x16_bf16 v[112:127], v[44:47], a[108:111], v[112:127]
  s_waitcnt lgkmcnt(5)
  v_mfma_f32_32x32x16_bf16 v[96:111], v[48:51], a[112:115], v[96:111]
  s_add_u32 m0, s25, 7168
  ds_read_b128 v[40:43], v12 offset:49152
  v_mfma_f32_32x32x16_bf16 v[112:127], v[48:51], a[116:119], v[112:127]
  s_waitcnt lgkmcnt(5)
  buffer_load_dwordx4 v23, s[12:15], s19 offen lds
  v_mfma_f32_32x32x16_bf16 v[96:111], v[52:55], a[120:123], v[96:111]
  s_cmp_gt_u32 s23, 3
  ds_read_b128 v[44:47], v13 offset:49152
  v_mfma_f32_32x32x16_bf16 v[112:127], v[52:55], a[124:127], v[112:127]
  s_waitcnt lgkmcnt(5)
  s_cselect_b32 s26, s20, 0
  v_mfma_f32_32x32x16_bf16 v[96:111], v[24:27], a[128:131], v[96:111]
  s_add_u32 s19, s19, s26
  ds_read_b128 v[48:51], v14 offset:49152
  v_mfma_f32_32x32x16_bf16 v[112:127], v[24:27], a[132:135], v[112:127]
  s_waitcnt lgkmcnt(5)
  s_add_u32 s25, s25, 32768
  v_mfma_f32_32x32x16_bf16 v[96:111], v[28:31], a[136:139], v[96:111]
  s_and_b32 s25, s25, 0x1ffff
  ds_read_b128 v[52:55], v15 offset:49152
  v_mfma_f32_32x32x16_bf16 v[112:127], v[28:31], a[140:143], v[112:127]
  s_waitcnt lgkmcnt(5)
  buffer_store_dwordx4 v[128:131], v7, s[4:7], s21 offen offset:0 sc1
  v_mfma_f32_32x32x16_bf16 v[96:111], v[32:35], a[144:147], v[96:111]
  ds_read_b128 v[24:27], v8 offset:57344
  v_mfma_f32_32x32x16_bf16 v[112:127], v[32:35], a[148:151], v[112:127]
  s_waitcnt lgkmcnt(5)
  v_xor_b32 v8, 0x10000, v8
  v_mfma_f32_32x32x16_bf16 v[96:111], v[36:39], a[152:155], v[96:111]
  ds_read_b128 v[28:31], v9 offset:57344
  v_mfma_f32_32x32x16_bf16 v[112:127], v[36:39], a[156:159], v[112:127]
  s_waitcnt lgkmcnt(5)
  buffer_store_dwordx4 v[132:135], v7, s[4:7], s21 offen offset:1024 sc1
  v_xor_b32 v9, 0x10000, v9
  v_mfma_f32_32x32x16_bf16 v[96:111], v[40:43], a[160:163], v[96:111]
  ds_read_b128 v[32:35], v10 offset:57344
  v_mfma_f32_32x32x16_bf16 v[112:127], v[40:43], a[164:167], v[112:127]
  s_waitcnt lgkmcnt(5)
  v_xor_b32 v10, 0x10000, v10
  v_mfma_f32_32x32x16_bf16 v[96:111], v[44:47], a[168:171], v[96:111]
  ds_read_b128 v[36:39], v11 offset:57344
  v_mfma_f32_32x32x16_bf16 v[112:127], v[44:47], a[172:175], v[112:127]
  s_waitcnt lgkmcnt(5)
  buffer_store_dwordx4 v[136:139], v7, s[4:7], s21 offen offset:2048 sc1
  v_xor_b32 v11, 0x10000, v11
  v_mfma_f32_32x32x16_bf16 v[96:111], v[48:51], a[176:179], v[96:111]
  ds_read_b128 v[40:43], v12 offset:57344
  v_mfma_f32_32x32x16_bf16 v[112:127], v[48:51], a[180:183], v[112:127]
  s_waitcnt lgkmcnt(5)
  v_xor_b32 v12, 0x10000, v12
  v_mfma_f32_32x32x16_bf16 v[96:111], v[52:55], a[184:187], v[96:111]
  ds_read_b128 v[44:47], v13 offset:57344
  v_mfma_f32_32x32x16_bf16 v[112:127], v[52:55], a[188:191], v[112:127]
  s_waitcnt lgkmcnt(5)
  buffer_store_dwordx4 v[140:143], v7, s[4:7], s21 offen offset:3072 sc1
  v_xor_b32 v13, 0x10000, v13
  v_mfma_f32_32x32x16_bf16 v[96:111], v[24:27], a[192:195], v[96:111]
  s_mov_b32 s21, s27
  ds_read_b128 v[48:51], v14 offset:57344
  v_mov_b32 v7, v2
  v_mfma_f32_32x32x16_bf16 v[112:127], v[24:27], a[196:199], v[112:127]
  s_waitcnt lgkmcnt(5)
  v_xor_b32 v14, 0x10000, v14
  v_mfma_f32_32x32x16_bf16 v[96:111], v[28:31], a[200:203], v[96:111]
  s_add_u32 s27, s27, s22
  ds_read_b128 v[52:55], v15 offset:57344
  v_mfma_f32_32x32x16_bf16 v[112:127], v[28:31], a[204:207], v[112:127]
  s_waitcnt lgkmcnt(5)
  s_waitcnt vmcnt(17)
  s_barrier
  v_xor_b32 v15, 0x10000, v15
  v_mfma_f32_32x32x16_bf16 v[96:111], v[32:35], a[208:211], v[96:111]
  ds_read_b128 v[24:27], v8 offset:0
  v_mfma_f32_32x32x16_bf16 v[112:127], v[32:35], a[212:215], v[112:127]
  s_waitcnt lgkmcnt(5)
  v_mfma_f32_32x32x16_bf16 v[96:111], v[36:39], a[216:219], v[96:111]
  s_add_u32 s29, s29, 1
  ds_read_b128 v[28:31], v9 offset:0
  v_mfma_f32_32x32x16_bf16 v[112:127], v[36:39], a[220:223], v[112:127]
  s_waitcnt lgkmcnt(5)
  s_max_i32 s30, s29, 0
  v_mov_b32 v144, s30
  v_mfma_f32_32x32x16_bf16 v[96:111], v[40:43], a[224:227], v[96:111]
  ds_read_b128 v[32:35], v10 offset:0
  v_mfma_f32_32x32x16_bf16 v[112:127], v[40:43], a[228:231], v[112:127]
  s_waitcnt lgkmcnt(5)
  buffer_store_dword v144, v145, s[4:7], s31 offen sc1
  v_mfma_f32_32x32x16_bf16 v[96:111], v[44:47], a[232:235], v[96:111]
  ds_read_b128 v[36:39], v11 offset:0
  v_mfma_f32_32x32x16_bf16 v[112:127], v[44:47], a[236:239], v[112:127]
  s_waitcnt lgkmcnt(5)
  v_mfma_f32_32x32x16_bf16 v[96:111], v[48:51], a[240:243], v[96:111]
  s_sub_u32 s23, s23, 1
  ds_read_b128 v[40:43], v12 offset:0
  v_mfma_f32_32x32x16_bf16 v[112:127], v[48:51], a[244:247], v[112:127]
  s_waitcnt lgkmcnt(5)
  v_mfma_f32_32x32x16_bf16 v[96:111], v[52:55], a[248:251], v[96:111]
  s_cmp_eq_u32 s23, 0
  ds_read_b128 v[44:47], v13 offset:0
  v_mfma_f32_32x32x16_bf16 v[112:127], v[52:55], a[252:255], v[112:127]
  s_cbranch_scc1 G_done1_9
  s_branch G_top_7
G_done0_8:
  s_nop 7
  s_nop 3
  v_mul_f32 v64, s24, v64
  v_mul_f32 v65, s24, v65
  v_cvt_pk_bf16_f32 v128, v64, v65
  v_mul_f32 v66, s24, v66
  v_mul_f32 v67, s24, v67
  v_cvt_pk_bf16_f32 v129, v66, v67
  v_mul_f32 v68, s24, v68
  v_mul_f32 v69, s24, v69
  v_cvt_pk_bf16_f32 v130, v68, v69
  v_mul_f32 v70, s24, v70
  v_mul_f32 v71, s24, v71
  v_cvt_pk_bf16_f32 v131, v70, v71
  buffer_store_dwordx4 v[128:131], v7, s[4:7], s21 offen offset:0 sc1
  v_mul_f32 v72, s24, v72
  v_mul_f32 v73, s24, v73
  v_cvt_pk_bf16_f32 v132, v72, v73
  v_mul_f32 v74, s24, v74
  v_mul_f32 v75, s24, v75
  v_cvt_pk_bf16_f32 v133, v74, v75
  v_mul_f32 v76, s24, v76
  v_mul_f32 v77, s24, v77
  v_cvt_pk_bf16_f32 v134, v76, v77
  v_mul_f32 v78, s24, v78
  v_mul_f32 v79, s24, v79
  v_cvt_pk_bf16_f32 v135, v78, v79
  buffer_store_dwordx4 v[132:135], v7, s[4:7], s21 offen offset:1024 sc1
  v_mul_f32 v80, s24, v80
  v_mul_f32 v81, s24, v81
  v_cvt_pk_bf16_f32 v136, v80, v81
  v_mul_f32 v82, s24, v82
  v_mul_f32 v83, s24, v83
  v_cvt_pk_bf16_f32 v137, v82, v83
  v_mul_f32 v84, s24, v84
  v_mul_f32 v85, s24, v85
  v_cvt_pk_bf16_f32 v138, v84, v85
  v_mul_f32 v86, s24, v86
  v_mul_f32 v87, s24, v87
  v_cvt_pk_bf16_f32 v139, v86, v87
  buffer_store_dwordx4 v[136:139], v7, s[4:7], s21 offen offset:2048 sc1
  v_mul_f32 v88, s24, v88
  v_mul_f32 v89, s24, v89
  v_cvt_pk_bf16_f32 v140, v88, v89
  v_mul_f32 v90, s24, v90
  v_mul_f32 v91, s24, v91
  v_cvt_pk_bf16_f32 v141, v90, v91
  v_mul_f32 v92, s24, v92
  v_mul_f32 v93, s24, v93
  v_cvt_pk_bf16_f32 v142, v92, v93
  v_mul_f32 v94, s24, v94
  v_mul_f32 v95, s24, v95
  v_cvt_pk_bf16_f32 v143, v94, v95
  buffer_store_dwordx4 v[140:143], v7, s[4:7], s21 offen offset:3072 sc1
  s_branch G_fin_10
G_done1_9:
  s_nop 7
  s_nop 3
  v_mul_f32 v96, s24, v96
  v_mul_f32 v97, s24, v97
  v_cvt_pk_bf16_f32 v128, v96, v97
  v_mul_f32 v98, s24, v98
  v_mul_f32 v99, s24, v99
  v_cvt_pk_bf16_f32 v129, v98, v99
  v_mul_f32 v100, s24, v100
  v_mul_f32 v101, s24, v101
  v_cvt_pk_bf16_f32 v130, v100, v101
  v_mul_f32 v102, s24, v102
  v_mul_f32 v103, s24, v103
  v_cvt_pk_bf16_f32 v131, v102, v103
  buffer_store_dwordx4 v[128:131], v7, s[4:7], s21 offen offset:0 sc1
  v_mul_f32 v104, s24, v104
  v_mul_f32 v105, s24, v105
  v_cvt_pk_bf16_f32 v132, v104, v105
  v_mul_f32 v106, s24, v106
  v_mul_f32 v107, s24, v107
  v_cvt_pk_bf16_f32 v133, v106, v107
  v_mul_f32 v108, s24, v108
  v_mul_f32 v109, s24, v109
  v_cvt_pk_bf16_f32 v134, v108, v109
  v_mul_f32 v110, s24, v110
  v_mul_f32 v111, s24, v111
  v_cvt_pk_bf16_f32 v135, v110, v111
  buffer_store_dwordx4 v[132:135], v7, s[4:7], s21 offen offset:1024 sc1
  v_mul_f32 v112, s24, v112
  v_mul_f32 v113, s24, v113
  v_cvt_pk_bf16_f32 v136, v112, v113
  v_mul_f32 v114, s24, v114
  v_mul_f32 v115, s24, v115
  v_cvt_pk_bf16_f32 v137, v114, v115
  v_mul_f32 v116, s24, v116
  v_mul_f32 v117, s24, v117
  v_cvt_pk_bf16_f32 v138, v116, v117
  v_mul_f32 v118, s24, v118
  v_mul_f32 v119, s24, v119
  v_cvt_pk_bf16_f32 v139, v118, v119
  buffer_store_dwordx4 v[136:139], v7, s[4:7], s21 offen offset:2048 sc1
  v_mul_f32 v120, s24, v120
  v_mul_f32 v121, s24, v121
  v_cvt_pk_bf16_f32 v140, v120, v121
  v_mul_f32 v122, s24, v122
  v_mul_f32 v123, s24, v123
  v_cvt_pk_bf16_f32 v141, v122, v123
  v_mul_f32 v124, s24, v124
  v_mul_f32 v125, s24, v125
  v_cvt_pk_bf16_f32 v142, v124, v125
  v_mul_f32 v126, s24, v126
  v_mul_f32 v127, s24, v127
  v_cvt_pk_bf16_f32 v143, v126, v127
  buffer_store_dwordx4 v[140:143], v7, s[4:7], s21 offen offset:3072 sc1
G_fin_10:
  s_waitcnt vmcnt(0) lgkmcnt(0)
  s_barrier
  s_add_u32 s30, s29, 3
  v_mov_b32 v144, s30
  v_min_u32 v145, 1, v0
  v_lshlrev_b32 v145, 30, v145
  buffer_store_dword v144, v145, s[4:7], s31 offen sc1
P_end_2:
  s_mov_b32 s71, 0
  s_branch M_sg_12
M_sw_11:
  s_sleep 8
  s_add_u32 s71, s71, 1
  s_cmp_gt_u32 s71, 262144
  s_cbranch_scc1 M_exit
M_sg_12:
  s_mov_b32 s79, 0
  s_atomic_or s79, s[74:75], 128 glc
  s_waitcnt lgkmcnt(0)
  s_cmp_lt_u32 s79, 256
  s_cbranch_scc1 M_sw_11
  s_cmp_eq_u32 s65, 6
  s_cbranch_scc1 M_follow
  s_mov_b32 s68, 0
  s_mov_b32 s36, -1
  s_mov_b32 s69, s53
  s_mov_b32 s70, s54
  s_load_dwordx2 s[8:9], s[0:1], 40
  s_mul_i32 s76, s64, 6
  s_add_u32 s76, s76, s65
  s_mul_i32 s76, s76, 21888
  v_min_u32 v200, 170, v0
  v_lshl_add_u32 v200, v200, 7, s76
  s_waitcnt lgkmcnt(0)
  s_and_b32 s9, s9, 0xffff
  s_mov_b32 s10, 4194304
  s_mov_b32 s11, 0x20000
M_att:
  s_mov_b32 s24, 0xf149f2ca
  s_mov_b32 s29, 0
  v_mov_b32 v6, 0
  v_mov_b32 v7, 0
  s_lshl_b32 s26, s16, 11
  v_add_u32 v3, s26, v2
  v_and_b32 v5, 31, v1
  v_lshrrev_b32 v12, 5, v1
  v_lshlrev_b32 v12, 2, v12
  v_sub_u32 v5, v5, v12
  s_lshl_b32 s26, s64, 19
  s_add_u32 s19, s26, 16777216
  s_add_u32 s20, s26, 33554432
  s_lshl_b32 s27, s69, 2
  s_add_u32 s27, s27, s16
  s_lshl_b32 s27, s27, 14
  s_add_u32 s25, s26, s27
  s_bfe_u32 s78, s70, 0x80000
  s_add_u32 s76, s67, 512
  s_mov_b32 s71, 0
  s_branch M_sg_14
M_sw_13:
  s_sleep 8
  s_add_u32 s71, s71, 1
  s_cmp_gt_u32 s71, 262144
  s_cbranch_scc1 M_exit
M_sg_14:
  s_mov_b32 s79, 0
  s_atomic_or s79, s[72:73], s76 glc
  s_waitcnt lgkmcnt(0)
  s_cmp_lt_u32 s79, s78
  s_cbranch_scc1 M_sw_13
  s_bfe_u32 s78, s70, 0x80008
  s_add_u32 s76, s67, 640
  s_mov_b32 s71, 0
  s_branch M_sg_16
M_sw_15:
  s_sleep 8
  s_add_u32 s71, s71, 1
  s_cmp_gt_u32 s71, 262144
  s_cbranch_scc1 M_exit
M_sg_16:
  s_mov_b32 s79, 0
  s_atomic_or s79, s[72:73], s76 glc
  s_waitcnt lgkmcnt(0)
  s_cmp_lt_u32 s79, s78
  s_cbranch_scc1 M_sw_15
  s_lshl_b32 s27, s69, 16
  s_add_u32 s27, s27, 16384
  s_add_u32 s17, s19, s27
M_kv_17:
  s_cmp_ge_u32 s17, s36
  s_cbranch_scc1 M_kvok_18
  s_mov_b32 s76, 0
  s_mov_b32 s78, 23
  s_mov_b32 s77, 335872
  s_cmp_eq_u32 s68, 1
  s_cmov_b32 s76, 128
  s_cmov_b32 s78, 27
  s_cmov_b32 s77, 114688
  s_cmp_eq_u32 s68, 2
  s_cmov_b32 s76, 768
  s_cmov_b32 s78, 14
  s_cmov_b32 s77, 0
  s_add_u32 s76, s76, s67
  s_mov_b32 s71, 0
  s_branch M_sg_20
M_sw_19:
  s_sleep 8
  s_add_u32 s71, s71, 1
  s_cmp_gt_u32 s71, 262144
  s_cbranch_scc1 M_exit
M_sg_20:
  s_mov_b32 s79, 0
  s_atomic_or s79, s[72:73], s76 glc
  s_waitcnt lgkmcnt(0)
  s_cmp_lt_u32 s79, s78
  s_cbranch_scc1 M_sw_19
  s_add_u32 s36, s77, s19
  s_add_u32 s68, s68, 1
  s_branch M_kv_17
M_kvok_18:
  s_add_u32 s28, s25, 0
  buffer_load_dwordx4 a[128:131], v2, s[4:7], s28 offen offset:0 sc1
  buffer_load_dwordx4 a[132:135], v2, s[4:7], s28 offen offset:1024 sc1
  buffer_load_dwordx4 a[136:139], v2, s[4:7], s28 offen offset:2048 sc1
  buffer_load_dwordx4 a[140:143], v2, s[4:7], s28 offen offset:3072 sc1
  s_add_u32 s28, s25, 4096
  buffer_load_dwordx4 a[144:147], v2, s[4:7], s28 offen offset:0 sc1
  buffer_load_dwordx4 a[148:151], v2, s[4:7], s28 offen offset:1024 sc1
  buffer_load_dwordx4 a[152:155], v2, s[4:7], s28 offen offset:2048 sc1
  buffer_load_dwordx4 a[156:159], v2, s[4:7], s28 offen offset:3072 sc1
  s_add_u32 s28, s25, 8192
  buffer_load_dwordx4 a[160:163], v2, s[4:7], s28 offen offset:0 sc1
  buffer_load_dwordx4 a[164:167], v2, s[4:7], s28 offen offset:1024 sc1
  buffer_load_dwordx4 a[168:171], v2, s[4:7], s28 offen offset:2048 sc1
  buffer_load_dwordx4 a[172:175], v2, s[4:7], s28 offen offset:3072 sc1
  s_add_u32 s28, s25, 12288
  buffer_load_dwordx4 a[176:179], v2, s[4:7], s28 offen offset:0 sc1
  buffer_load_dwordx4 a[180:183], v2, s[4:7], s28 offen offset:1024 sc1
  buffer_load_dwordx4 a[184:187], v2, s[4:7], s28 offen offset:2048 sc1
  buffer_load_dwordx4 a[188:191], v2, s[4:7], s28 offen offset:3072 sc1
A_again_21:
  s_lshl_b32 s27, s69, 16
  s_add_u32 s27, s27, 57344
  s_add_u32 s17, s19, s27
  s_add_u32 s18, s20, s27
  s_lshl_b32 s21, s16, 11
  s_mov_b32 m0, s21
  s_nop 0
  buffer_load_dwordx4 v3, s[4:7], s18 offen offset:0 sc1 lds
  buffer_load_dwordx4 v3, s[4:7], s18 offen offset:1024 sc1 lds
  s_add_u32 m0, s21, 8192
  s_nop 0
  buffer_load_dwordx4 v3, s[4:7], s17 offen offset:0 sc1 lds
  buffer_load_dwordx4 v3, s[4:7], s17 offen offset:1024 sc1 lds
  s_add_u32 s18, s18, 8192
  s_sub_u32 s18, s18, 8192
  s_max_i32 s18, s18, s20
  s_sub_u32 s17, s17, 8192
  s_max_i32 s17, s17, s19
  s_add_u32 s21, s21, 16384
  s_and_b32 s21, s21, 131071
  s_mov_b32 m0, s21
  s_nop 0
  buffer_load_dwordx4 v3, s[4:7], s18 offen offset:0 sc1 lds
  buffer_load_dwordx4 v3, s[4:7], s18 offen offset:1024 sc1 lds
  s_add_u32 m0, s21, 8192
  s_nop 0
  buffer_load_dwordx4 v3, s[4:7], s17 offen offset:0 sc1 lds
  buffer_load_dwordx4 v3, s[4:7], s17 offen offset:1024 sc1 lds
  s_sub_u32 s18, s18, 8192
  s_max_i32 s18, s18, s20
  s_sub_u32 s17, s17, 8192
  s_max_i32 s17, s17, s19
  s_add_u32 s21, s21, 16384
  s_and_b32 s21, s21, 131071
  s_mov_b32 m0, s21
  s_nop 0
  buffer_load_dwordx4 v3, s[4:7], s18 offen offset:0 sc1 lds
  buffer_load_dwordx4 v3, s[4:7], s18 offen offset:1024 sc1 lds
  s_add_u32 m0, s21, 8192
  s_nop 0
  buffer_load_dwordx4 v3, s[4:7], s17 offen offset:0 sc1 lds
  buffer_load_dwordx4 v3, s[4:7], s17 offen offset:1024 sc1 lds
  s_sub_u32 s18, s18, 8192
  s_max_i32 s18, s18, s20
  s_sub_u32 s17, s17, 8192
  s_max_i32 s17, s17, s19
  s_add_u32 s21, s21, 16384
  s_and_b32 s21, s21, 131071
  s_mov_b32 m0, s21
  s_nop 0
  buffer_load_dwordx4 v3, s[4:7], s18 offen offset:0 sc1 lds
  buffer_load_dwordx4 v3, s[4:7], s18 offen offset:1024 sc1 lds
  s_add_u32 m0, s21, 8192
  s_nop 0
  buffer_load_dwordx4 v3, s[4:7], s17 offen offset:0 sc1 lds
  buffer_load_dwordx4 v3, s[4:7], s17 offen offset:1024 sc1 lds
  s_sub_u32 s18, s18, 8192
  s_max_i32 s18, s18, s20
  s_sub_u32 s17, s17, 8192
  s_max_i32 s17, s17, s19
  s_add_u32 s21, s21, 16384
  s_and_b32 s21, s21, 131071
  s_mov_b32 m0, s21
  s_nop 0
  buffer_load_dwordx4 v3, s[4:7], s18 offen offset:0 sc1 lds
  buffer_load_dwordx4 v3, s[4:7], s18 offen offset:1024 sc1 lds
  s_add_u32 m0, s21, 8192
  s_nop 0
  buffer_load_dwordx4 v3, s[4:7], s17 offen offset:0 sc1 lds
  buffer_load_dwordx4 v3, s[4:7], s17 offen offset:1024 sc1 lds
  s_sub_u32 s18, s18, 8192
  s_max_i32 s18, s18, s20
  s_sub_u32 s17, s17, 8192
  s_max_i32 s17, s17, s19
  s_add_u32 s21, s21, 16384
  s_and_b32 s21, s21, 131071
  s_mov_b32 m0, s21
  s_nop 0
  buffer_load_dwordx4 v3, s[4:7], s18 offen offset:0 sc1 lds
  buffer_load_dwordx4 v3, s[4:7], s18 offen offset:1024 sc1 lds
  s_add_u32 m0, s21, 8192
  s_nop 0
  buffer_load_dwordx4 v3, s[4:7], s17 offen offset:0 sc1 lds
  buffer_load_dwordx4 v3, s[4:7], s17 offen offset:1024 sc1 lds
  v_accvgpr_write_b32 a0, 0
  v_accvgpr_write_b32 a1, 0
  v_accvgpr_write_b32 a2, 0
  v_accvgpr_write_b32 a3, 0
  v_accvgpr_write_b32 a4, 0
  v_accvgpr_write_b32 a5, 0
  v_accvgpr_write_b32 a6, 0
  v_accvgpr_write_b32 a7, 0
  v_accvgpr_write_b32 a8, 0
  v_accvgpr_write_b32 a9, 0
  v_accvgpr_write_b32 a10, 0
  v_accvgpr_write_b32 a11, 0
  v_accvgpr_write_b32 a12, 0
  v_accvgpr_write_b32 a13, 0
  v_accvgpr_write_b32 a14, 0
  v_accvgpr_write_b32 a15, 0
  v_accvgpr_write_b32 a16, 0
  v_accvgpr_write_b32 a17, 0
  v_accvgpr_write_b32 a18, 0
  v_accvgpr_write_b32 a19, 0
  v_accvgpr_write_b32 a20, 0
  v_accvgpr_write_b32 a21, 0
  v_accvgpr_write_b32 a22, 0
  v_accvgpr_write_b32 a23, 0
  v_accvgpr_write_b32 a24, 0
  v_accvgpr_write_b32 a25, 0
  v_accvgpr_write_b32 a26, 0
  v_accvgpr_write_b32 a27, 0
  v_accvgpr_write_b32 a28, 0
  v_accvgpr_write_b32 a29, 0
  v_accvgpr_write_b32 a30, 0
  v_accvgpr_write_b32 a31, 0
  v_accvgpr_write_b32 a32, 0
  v_accvgpr_write_b32 a33, 0
  v_accvgpr_write_b32 a34, 0
  v_accvgpr_write_b32 a35, 0
  v_accvgpr_write_b32 a36, 0
  v_accvgpr_write_b32 a37, 0
  v_accvgpr_write_b32 a38, 0
  v_accvgpr_write_b32 a39, 0
  v_accvgpr_write_b32 a40, 0
  v_accvgpr_write_b32 a41, 0
  v_accvgpr_write_b32 a42, 0
  v_accvgpr_write_b32 a43, 0
  v_accvgpr_write_b32 a44, 0
  v_accvgpr_write_b32 a45, 0
  v_accvgpr_write_b32 a46, 0
  v_accvgpr_write_b32 a47, 0
  v_accvgpr_write_b32 a48, 0
  v_accvgpr_write_b32 a49, 0
  v_accvgpr_write_b32 a50, 0
  v_accvgpr_write_b32 a51, 0
  v_accvgpr_write_b32 a52, 0
  v_accvgpr_write_b32 a53, 0
  v_accvgpr_write_b32 a54, 0
  v_accvgpr_write_b32 a55, 0
  v_accvgpr_write_b32 a56, 0
  v_accvgpr_write_b32 a57, 0
  v_accvgpr_write_b32 a58, 0
  v_accvgpr_write_b32 a59, 0
  v_accvgpr_write_b32 a60, 0
  v_accvgpr_write_b32 a61, 0
  v_accvgpr_write_b32 a62, 0
  v_accvgpr_write_b32 a63, 0
  v_accvgpr_write_b32 a64, 0
  v_accvgpr_write_b32 a65, 0
  v_accvgpr_write_b32 a66, 0
  v_accvgpr_write_b32 a67, 0
  v_accvgpr_write_b32 a68, 0
  v_accvgpr_write_b32 a69, 0
  v_accvgpr_write_b32 a70, 0
  v_accvgpr_write_b32 a71, 0
  v_accvgpr_write_b32 a72, 0
  v_accvgpr_write_b32 a73, 0
  v_accvgpr_write_b32 a74, 0
  v_accvgpr_write_b32 a75, 0
  v_accvgpr_write_b32 a76, 0
  v_accvgpr_write_b32 a77, 0
  v_accvgpr_write_b32 a78, 0
  v_accvgpr_write_b32 a79, 0
  v_accvgpr_write_b32 a80, 0
  v_accvgpr_write_b32 a81, 0
  v_accvgpr_write_b32 a82, 0
  v_accvgpr_write_b32 a83, 0
  v_accvgpr_write_b32 a84, 0
  v_accvgpr_write_b32 a85, 0
  v_accvgpr_write_b32 a86, 0
  v_accvgpr_write_b32 a87, 0
  v_accvgpr_write_b32 a88, 0
  v_accvgpr_write_b32 a89, 0
  v_accvgpr_write_b32 a90, 0
  v_accvgpr_write_b32 a91, 0
  v_accvgpr_write_b32 a92, 0
  v_accvgpr_write_b32 a93, 0
  v_accvgpr_write_b32 a94, 0
  v_accvgpr_write_b32 a95, 0
  v_accvgpr_write_b32 a96, 0
  v_accvgpr_write_b32 a97, 0
  v_accvgpr_write_b32 a98, 0
  v_accvgpr_write_b32 a99, 0
  v_accvgpr_write_b32 a100, 0
  v_accvgpr_write_b32 a101, 0
  v_accvgpr_write_b32 a102, 0
  v_accvgpr_write_b32 a103, 0
  v_accvgpr_write_b32 a104, 0
  v_accvgpr_write_b32 a105, 0
  v_accvgpr_write_b32 a106, 0
  v_accvgpr_write_b32 a107, 0
  v_accvgpr_write_b32 a108, 0
  v_accvgpr_write_b32 a109, 0
  v_accvgpr_write_b32 a110, 0
  v_accvgpr_write_b32 a111, 0
  v_accvgpr_write_b32 a112, 0
  v_accvgpr_write_b32 a113, 0
  v_accvgpr_write_b32 a114, 0
  v_accvgpr_write_b32 a115, 0
  v_accvgpr_write_b32 a116, 0
  v_accvgpr_write_b32 a117, 0
  v_accvgpr_write_b32 a118, 0
  v_accvgpr_write_b32 a119, 0
  v_accvgpr_write_b32 a120, 0
  v_accvgpr_write_b32 a121, 0
  v_accvgpr_write_b32 a122, 0
  v_accvgpr_write_b32 a123, 0
  v_accvgpr_write_b32 a124, 0
  v_accvgpr_write_b32 a125, 0
  v_accvgpr_write_b32 a126, 0
  v_accvgpr_write_b32 a127, 0
  v_mov_b32 v8, 0
  v_mov_b32 v9, 0
  v_mov_b32 v10, 0
  v_mov_b32 v11, 0
  v_mov_b32 v52, 0
  v_mov_b32 v53, 0
  v_mov_b32 v54, s24
  v_mov_b32 v55, s24
  v_mov_b32 v56, s24
  v_mov_b32 v57, s24
  v_mov_b32 v58, s24
  v_mov_b32 v59, s24
  v_mov_b32 v60, s24
  v_mov_b32 v61, s24
  v_mov_b32 v62, s24
  v_mov_b32 v63, s24
  v_mov_b32 v104, 0
  v_mov_b32 v105, 0
  v_mov_b32 v4, v2
  v_mov_b32 v64, s24
  v_mov_b32 v65, s24
  v_mov_b32 v66, s24
  v_mov_b32 v67, s24
  v_mov_b32 v68, s24
  v_mov_b32 v69, s24
  v_mov_b32 v70, s24
  v_mov_b32 v71, s24
  v_mov_b32 v72, s24
  v_mov_b32 v73, s24
  v_mov_b32 v74, s24
  v_mov_b32 v75, s24
  v_mov_b32 v76, s24
  v_mov_b32 v77, s24
  v_mov_b32 v78, s24
  v_mov_b32 v79, s24
  v_mov_b32 v12, s24
  v_cmp_le_i32 s[40:41], 0, v5
  v_cmp_le_i32 s[42:43], 1, v5
  v_cmp_le_i32 s[44:45], 2, v5
  v_cmp_le_i32 s[46:47], 3, v5
  v_cndmask_b32 v80, v12, v7, s[40:41]
  v_cndmask_b32 v81, v12, v7, s[42:43]
  v_cndmask_b32 v82, v12, v7, s[44:45]
  v_cndmask_b32 v83, v12, v7, s[46:47]
  v_cmp_le_i32 s[40:41], 8, v5
  v_cmp_le_i32 s[42:43], 9, v5
  v_cmp_le_i32 s[44:45], 10, v5
  v_cmp_le_i32 s[46:47], 11, v5
  v_cndmask_b32 v84, v12, v7, s[40:41]
  v_cndmask_b32 v85, v12, v7, s[42:43]
  v_cndmask_b32 v86, v12, v7, s[44:45]
  v_cndmask_b32 v87, v12, v7, s[46:47]
  v_cmp_le_i32 s[40:41], 16, v5
  v_cmp_le_i32 s[42:43], 17, v5
  v_cmp_le_i32 s[44:45], 18, v5
  v_cmp_le_i32 s[46:47], 19, v5
  v_cndmask_b32 v88, v12, v7, s[40:41]
  v_cndmask_b32 v89, v12, v7, s[42:43]
  v_cndmask_b32 v90, v12, v7, s[44:45]
  v_cndmask_b32 v91, v12, v7, s[46:47]
  v_cmp_le_i32 s[40:41], 24, v5
  v_cmp_le_i32 s[42:43], 25, v5
  v_cmp_le_i32 s[44:45], 26, v5
  v_cmp_le_i32 s[46:47], 27, v5
  v_cndmask_b32 v92, v12, v7, s[40:41]
  v_cndmask_b32 v93, v12, v7, s[42:43]
  v_cndmask_b32 v94, v12, v7, s[44:45]
  v_cndmask_b32 v95, v12, v7, s[46:47]
  s_lshl_b32 s22, s69, 3
  s_add_u32 s22, s22, 8
  s_lshl_b32 s26, s16, 1
  s_sub_u32 s23, 6, s26
  s_waitcnt vmcnt(20)
  s_barrier
  buffer_load_dword v201, v200, s[8:11], 0 offen
  s_cmp_eq_u32 s23, 0
  s_cbranch_scc1 A_go_23
A_idle_22:
  s_waitcnt vmcnt(16)
  s_barrier
  s_sub_u32 s18, s18, 8192
  s_max_i32 s18, s18, s20
  s_sub_u32 s17, s17, 8192
  s_max_i32 s17, s17, s19
  s_add_u32 s21, s21, 16384
  s_and_b32 s21, s21, 131071
M_kv_24:
  s_cmp_ge_u32 s17, s36
  s_cbranch_scc1 M_kvok_25
  s_mov_b32 s76, 0
  s_mov_b32 s78, 23
  s_mov_b32 s77, 335872
  s_cmp_eq_u32 s68, 1
  s_cmov_b32 s76, 128
  s_cmov_b32 s78, 27
  s_cmov_b32 s77, 114688
  s_cmp_eq_u32 s68, 2
  s_cmov_b32 s76, 768
  s_cmov_b32 s78, 14
  s_cmov_b32 s77, 0
  s_add_u32 s76, s76, s67
  s_mov_b32 s71, 0
  s_branch M_sg_27
M_sw_26:
  s_sleep 8
  s_add_u32 s71, s71, 1
  s_cmp_gt_u32 s71, 262144
  s_cbranch_scc1 M_exit
M_sg_27:
  s_mov_b32 s79, 0
  s_atomic_or s79, s[72:73], s76 glc
  s_waitcnt lgkmcnt(0)
  s_cmp_lt_u32 s79, s78
  s_cbranch_scc1 M_sw_26
  s_add_u32 s36, s77, s19
  s_add_u32 s68, s68, 1
  s_branch M_kv_24
M_kvok_25:
  s_mov_b32 m0, s21
  s_nop 0
  buffer_load_dwordx4 v3, s[4:7], s18 offen offset:0 sc1 lds
  buffer_load_dwordx4 v3, s[4:7], s18 offen offset:1024 sc1 lds
  s_add_u32 m0, s21, 8192
  s_nop 0
  buffer_load_dwordx4 v3, s[4:7], s17 offen offset:0 sc1 lds
  buffer_load_dwordx4 v3, s[4:7], s17 offen offset:1024 sc1 lds
  v_add_u32 v4, 16384, v4
  v_and_b32 v4, 131071, v4
  s_sub_u32 s22, s22, 1
  s_sub_u32 s23, s23, 1
  s_cmp_lg_u32 s23, 0
  s_cbranch_scc1 A_idle_22
A_go_23:
  ds_read_b128 a[224:227], v4 offset:0
  ds_read_b128 a[228:231], v4 offset:2048
  ds_read_b128 a[232:235], v4 offset:4096
  ds_read_b128 a[236:239], v4 offset:6144
  ds_read_b128 a[240:243], v4 offset:1024
  ds_read_b128 a[244:247], v4 offset:3072
  ds_read_b128 a[248:251], v4 offset:5120
  ds_read_b128 a[252:255], v4 offset:7168
  ds_read_b128 a[192:195], v4 offset:8192
  ds_read_b128 a[196:199], v4 offset:9216
  ds_read_b128 a[200:203], v4 offset:10240
  ds_read_b128 a[204:207], v4 offset:11264
  ds_read_b128 a[208:211], v4 offset:12288
  ds_read_b128 a[212:215], v4 offset:13312
  ds_read_b128 a[216:219], v4 offset:14336
  ds_read_b128 a[220:223], v4 offset:15360
  v_add_u32 v4, 16384, v4
  v_and_b32 v4, 131071, v4
  s_waitcnt lgkmcnt(8)
.p2align 6
A_top_28:
  s_waitcnt lgkmcnt(7)
  v_mfma_f32_32x32x16_bf16 v[32:47], a[192:195], a[128:131], v[64:79]
  s_waitcnt lgkmcnt(6)
  v_exp_f32 v54, v54
  v_add_f32 v11, v11, v53
  v_cvt_pk_bf16_f32 v106, v52, v53
  v_mfma_f32_32x32x16_bf16 v[32:47], a[196:199], a[132:135], v[32:47]
  s_waitcnt lgkmcnt(4)
  v_exp_f32 v55, v55
  v_add_f32 v10, v10, v54
  v_mfma_f32_32x32x16_bf16 v[32:47], a[200:203], a[136:139], v[32:47]
  v_exp_f32 v56, v56
  v_add_f32 v11, v11, v55
  v_cvt_pk_bf16_f32 v107, v54, v55
  v_mfma_f32_32x32x16_bf16 v[32:47], a[204:207], a[140:143], v[32:47]
  s_waitcnt lgkmcnt(2)
  v_exp_f32 v57, v57
  v_add_f32 v10, v10, v56
  v_mfma_f32_32x32x16_bf16 v[32:47], a[208:211], a[144:147], v[32:47]
  v_exp_f32 v58, v58
  v_add_f32 v11, v11, v57
  v_cvt_pk_bf16_f32 v108, v56, v57
  v_mfma_f32_32x32x16_bf16 v[32:47], a[212:215], a[148:151], v[32:47]
  s_waitcnt lgkmcnt(0)
  v_exp_f32 v59, v59
  v_add_f32 v10, v10, v58
  v_mfma_f32_32x32x16_bf16 v[32:47], a[216:219], a[152:155], v[32:47]
  v_exp_f32 v60, v60
  v_add_f32 v11, v11, v59
  v_cvt_pk_bf16_f32 v109, v58, v59
  v_mfma_f32_32x32x16_bf16 v[32:47], a[220:223], a[156:159], v[32:47]
  s_waitcnt vmcnt(16)
  s_barrier
  v_exp_f32 v61, v61
  v_add_f32 v10, v10, v60
  v_mfma_f32_32x32x16_bf16 a[64:79], a[224:227], v[104:107], a[64:79]
  ds_read_b128 a[224:227], v4 offset:0
  v_exp_f32 v62, v62
  v_add_f32 v11, v11, v61
  v_cvt_pk_bf16_f32 v110, v60, v61
  v_mfma_f32_32x32x16_bf16 a[80:95], a[228:231], v[104:107], a[80:95]
  s_sub_u32 s18, s18, 8192
  ds_read_b128 a[228:231], v4 offset:2048
  v_exp_f32 v63, v63
  v_add_f32 v10, v10, v62
  v_mfma_f32_32x32x16_bf16 a[96:111], a[232:235], v[104:107], a[96:111]
  s_max_i32 s18, s18, s20
  ds_read_b128 a[232:235], v4 offset:4096
  v_exp_f32 v32, v32
  v_add_f32 v11, v11, v63
  v_cvt_pk_bf16_f32 v111, v62, v63
  v_mfma_f32_32x32x16_bf16 a[112:127], a[236:239], v[104:107], a[112:127]
  s_sub_u32 s17, s17, 8192
  ds_read_b128 a[236:239], v4 offset:6144
  v_exp_f32 v33, v33
  v_add_f32 v8, v8, v32
  v_mfma_f32_32x32x16_bf16 a[64:79], a[240:243], v[108:111], a[64:79]
  s_max_i32 s17, s17, s19
  ds_read_b128 a[240:243], v4 offset:1024
  v_exp_f32 v34, v34
  v_add_f32 v9, v9, v33
  v_cvt_pk_bf16_f32 v96, v32, v33
  v_mfma_f32_32x32x16_bf16 a[80:95], a[244:247], v[108:111], a[80:95]
  s_add_u32 s21, s21, 16384
  ds_read_b128 a[244:247], v4 offset:3072
  v_exp_f32 v35, v35
  v_add_f32 v8, v8, v34
  v_mfma_f32_32x32x16_bf16 a[96:111], a[248:251], v[108:111], a[96:111]
  s_and_b32 s21, s21, 131071
  ds_read_b128 a[248:251], v4 offset:5120
  v_exp_f32 v36, v36
  v_add_f32 v9, v9, v35
  v_cvt_pk_bf16_f32 v97, v34, v35
  v_mfma_f32_32x32x16_bf16 a[112:127], a[252:255], v[108:111], a[112:127]
  ds_read_b128 a[252:255], v4 offset:7168
  v_exp_f32 v37, v37
  v_add_f32 v8, v8, v36
  v_mfma_f32_32x32x16_bf16 v[48:63], a[192:195], a[160:163], v[80:95]
  s_add_u32 s23, s23, 1
  ds_read_b128 a[192:195], v4 offset:8192
  v_exp_f32 v38, v38
  v_add_f32 v9, v9, v37
  v_cvt_pk_bf16_f32 v98, v36, v37
  v_mfma_f32_32x32x16_bf16 v[48:63], a[196:199], a[164:167], v[48:63]
  s_sub_u32 s22, s22, 1
  ds_read_b128 a[196:199], v4 offset:9216
  v_exp_f32 v39, v39
  v_add_f32 v8, v8, v38
  v_mfma_f32_32x32x16_bf16 v[48:63], a[200:203], a[168:171], v[48:63]
  s_cmp_lt_u32 s23, 3
  ds_read_b128 a[200:203], v4 offset:10240
  v_exp_f32 v40, v40
  v_add_f32 v9, v9, v39
  v_cvt_pk_bf16_f32 v99, v38, v39
  v_mfma_f32_32x32x16_bf16 v[48:63], a[204:207], a[172:175], v[48:63]
  s_cbranch_scc1 A_upd_29
A_back_30:
  ds_read_b128 a[204:207], v4 offset:11264
  v_exp_f32 v41, v41
  v_add_f32 v8, v8, v40
  v_mfma_f32_32x32x16_bf16 v[48:63], a[208:211], a[176:179], v[48:63]
  s_cmp_lt_u32 s17, s36
  ds_read_b128 a[208:211], v4 offset:12288
  v_exp_f32 v42, v42
  v_add_f32 v9, v9, v41
  v_cvt_pk_bf16_f32 v100, v40, v41
  v_mfma_f32_32x32x16_bf16 v[48:63], a[212:215], a[180:183], v[48:63]
  s_cbranch_scc1 A_kvw_32
A_kvb_33:
  ds_read_b128 a[212:215], v4 offset:13312
  v_exp_f32 v43, v43
  v_add_f32 v8, v8, v42
  v_mfma_f32_32x32x16_bf16 v[48:63], a[216:219], a[184:187], v[48:63]
  s_mov_b32 m0, s21
  ds_read_b128 a[216:219], v4 offset:14336
  v_exp_f32 v44, v44
  v_add_f32 v9, v9, v43
  v_cvt_pk_bf16_f32 v101, v42, v43
  v_mfma_f32_32x32x16_bf16 v[48:63], a[220:223], a[188:191], v[48:63]
  s_waitcnt lgkmcnt(13)
  ds_read_b128 a[220:223], v4 offset:15360
  v_exp_f32 v45, v45
  v_add_f32 v8, v8, v44
  v_mfma_f32_32x32x16_bf16 a[0:15], a[224:227], v[96:99], a[0:15]
  buffer_load_dwordx4 v3, s[4:7], s18 offen offset:0 sc1 lds
  v_exp_f32 v46, v46
  v_add_f32 v9, v9, v45
  v_cvt_pk_bf16_f32 v102, v44, v45
  v_mfma_f32_32x32x16_bf16 a[16:31], a[228:231], v[96:99], a[16:31]
  s_waitcnt lgkmcnt(12)
  v_exp_f32 v47, v47
  v_add_f32 v8, v8, v46
  v_add_u32 v4, 16384, v4
  v_mfma_f32_32x32x16_bf16 a[32:47], a[232:235], v[96:99], a[32:47]
  buffer_load_dwordx4 v3, s[4:7], s18 offen offset:1024 sc1 lds
  v_exp_f32 v48, v48
  v_add_f32 v9, v9, v47
  v_cvt_pk_bf16_f32 v103, v46, v47
  v_mfma_f32_32x32x16_bf16 a[48:63], a[236:239], v[96:99], a[48:63]
  s_waitcnt lgkmcnt(10)
  s_add_u32 m0, s21, 8192
  v_exp_f32 v49, v49
  v_add_f32 v10, v10, v48
  v_and_b32 v4, 131071, v4
  v_mfma_f32_32x32x16_bf16 a[0:15], a[240:243], v[100:103], a[0:15]
  buffer_load_dwordx4 v3, s[4:7], s17 offen offset:0 sc1 lds
  v_exp_f32 v50, v50
  v_add_f32 v11, v11, v49
  v_cvt_pk_bf16_f32 v104, v48, v49
  v_mfma_f32_32x32x16_bf16 a[16:31], a[244:247], v[100:103], a[16:31]
  s_waitcnt lgkmcnt(8)
  s_cmp_lg_u32 s22, 0
  v_exp_f32 v51, v51
  v_add_f32 v10, v10, v50
  v_mfma_f32_32x32x16_bf16 a[32:47], a[248:251], v[100:103], a[32:47]
  buffer_load_dwordx4 v3, s[4:7], s17 offen offset:1024 sc1 lds
  v_exp_f32 v52, v52
  v_add_f32 v11, v11, v51
  v_cvt_pk_bf16_f32 v105, v50, v51
  v_mfma_f32_32x32x16_bf16 a[48:63], a[252:255], v[100:103], a[48:63]
  v_exp_f32 v53, v53
  v_add_f32 v10, v10, v52
  s_cbranch_scc1 A_top_28
  v_exp_f32 v54, v54
  v_add_f32 v11, v11, v53
  v_cvt_pk_bf16_f32 v106, v52, v53
  v_exp_f32 v55, v55
  v_add_f32 v10, v10, v54
  v_exp_f32 v56, v56
  v_add_f32 v11, v11, v55
  v_cvt_pk_bf16_f32 v107, v54, v55
  v_exp_f32 v57, v57
  v_add_f32 v10, v10, v56
  v_exp_f32 v58, v58
  v_add_f32 v11, v11, v57
  v_cvt_pk_bf16_f32 v108, v56, v57
  v_exp_f32 v59, v59
  v_add_f32 v10, v10, v58
  v_exp_f32 v60, v60
  v_add_f32 v11, v11, v59
  v_cvt_pk_bf16_f32 v109, v58, v59
  v_exp_f32 v61, v61
  v_add_f32 v10, v10, v60
  v_exp_f32 v62, v62
  v_add_f32 v11, v11, v61
  v_cvt_pk_bf16_f32 v110, v60, v61
  v_exp_f32 v63, v63
  v_add_f32 v10, v10, v62
  v_add_f32 v11, v11, v63
  v_cvt_pk_bf16_f32 v111, v62, v63
  s_nop 1
  v_mfma_f32_32x32x16_bf16 a[64:79], a[224:227], v[104:107], a[64:79]
  v_mfma_f32_32x32x16_bf16 a[80:95], a[228:231], v[104:107], a[80:95]
  v_mfma_f32_32x32x16_bf16 a[96:111], a[232:235], v[104:107], a[96:111]
  v_mfma_f32_32x32x16_bf16 a[112:127], a[236:239], v[104:107], a[112:127]
  v_mfma_f32_32x32x16_bf16 a[64:79], a[240:243], v[108:111], a[64:79]
  v_mfma_f32_32x32x16_bf16 a[80:95], a[244:247], v[108:111], a[80:95]
  v_mfma_f32_32x32x16_bf16 a[96:111], a[248:251], v[108:111], a[96:111]
  v_mfma_f32_32x32x16_bf16 a[112:127], a[252:255], v[108:111], a[112:127]
  v_add_f32 v8, v8, v9
  v_mov_b32 v9, v8
  s_nop 1
  v_permlane32_swap_b32 v8, v9
  s_nop 1
  v_add_f32 v8, v8, v9
  v_add_f32 v10, v10, v11
  v_mov_b32 v11, v10
  s_nop 1
  v_permlane32_swap_b32 v10, v11
  s_nop 1
  v_add_f32 v10, v10, v11
  v_subrev_u32 v12, 0x2f800000, v8
  v_subrev_u32 v13, 0x2f800000, v10
  v_max_u32 v12, v12, v13
  v_cmp_le_u32 vcc, 0x28000000, v12
  s_nop 1
  s_cmp_lg_u64 vcc, 0
  s_cselect_b32 s26, 1, 0
  v_mov_b32 v12, s26
  s_lshl_b32 s26, s16, 2
  s_add_u32 s26, s26, 131072
  v_mov_b32 v13, s26
  ds_write_b32 v13, v12
  v_mov_b32 v14, 131072
  s_waitcnt vmcnt(0) lgkmcnt(0)
  s_barrier
  ds_read_b128 v[16:19], v14
  v_rcp_f32 v8, v8
  v_rcp_f32 v10, v10
  s_waitcnt lgkmcnt(0)
  v_or3_b32 v12, v16, v17, v18
  v_or_b32 v12, v12, v19
  s_nop 0
  v_readfirstlane_b32 s26, v12
  s_nop 1
  s_cmp_gt_u32 s26, s29
  s_cbranch_scc1 A_slow_34
  s_add_u32 s28, s25, 100663296
  v_accvgpr_read_b32 v112, a0
  v_accvgpr_read_b32 v113, a1
  v_accvgpr_read_b32 v114, a2
  v_accvgpr_read_b32 v115, a3
  v_accvgpr_read_b32 v116, a4
  v_accvgpr_read_b32 v117, a5
  v_accvgpr_read_b32 v118, a6
  v_accvgpr_read_b32 v119, a7
  v_pk_mul_f32 v[112:113], v[112:113], v[8:9] op_sel_hi:[1,0]
  v_pk_mul_f32 v[114:115], v[114:115], v[8:9] op_sel_hi:[1,0]
  v_pk_mul_f32 v[116:117], v[116:117], v[8:9] op_sel_hi:[1,0]
  v_pk_mul_f32 v[118:119], v[118:119], v[8:9] op_sel_hi:[1,0]
  v_cvt_pk_bf16_f32 v120, v112, v113
  v_cvt_pk_bf16_f32 v121, v114, v115
  v_cvt_pk_bf16_f32 v122, v116, v117
  v_cvt_pk_bf16_f32 v123, v118, v119
  buffer_store_dwordx4 v[120:123], v2, s[4:7], s28 offen offset:0 sc1
  v_accvgpr_read_b32 v124, a8
  v_accvgpr_read_b32 v125, a9
  v_accvgpr_read_b32 v126, a10
  v_accvgpr_read_b32 v127, a11
  v_accvgpr_read_b32 v128, a12
  v_accvgpr_read_b32 v129, a13
  v_accvgpr_read_b32 v130, a14
  v_accvgpr_read_b32 v131, a15
  v_pk_mul_f32 v[124:125], v[124:125], v[8:9] op_sel_hi:[1,0]
  v_pk_mul_f32 v[126:127], v[126:127], v[8:9] op_sel_hi:[1,0]
  v_pk_mul_f32 v[128:129], v[128:129], v[8:9] op_sel_hi:[1,0]
  v_pk_mul_f32 v[130:131], v[130:131], v[8:9] op_sel_hi:[1,0]
  v_cvt_pk_bf16_f32 v132, v124, v125
  v_cvt_pk_bf16_f32 v133, v126, v127
  v_cvt_pk_bf16_f32 v134, v128, v129
  v_cvt_pk_bf16_f32 v135, v130, v131
  buffer_store_dwordx4 v[132:135], v2, s[4:7], s28 offen offset:1024 sc1
  v_accvgpr_read_b32 v136, a16
  v_accvgpr_read_b32 v137, a17
  v_accvgpr_read_b32 v138, a18
  v_accvgpr_read_b32 v139, a19
  v_accvgpr_read_b32 v140, a20
  v_accvgpr_read_b32 v141, a21
  v_accvgpr_read_b32 v142, a22
  v_accvgpr_read_b32 v143, a23
  v_pk_mul_f32 v[136:137], v[136:137], v[8:9] op_sel_hi:[1,0]
  v_pk_mul_f32 v[138:139], v[138:139], v[8:9] op_sel_hi:[1,0]
  v_pk_mul_f32 v[140:141], v[140:141], v[8:9] op_sel_hi:[1,0]
  v_pk_mul_f32 v[142:143], v[142:143], v[8:9] op_sel_hi:[1,0]
  v_cvt_pk_bf16_f32 v144, v136, v137
  v_cvt_pk_bf16_f32 v145, v138, v139
  v_cvt_pk_bf16_f32 v146, v140, v141
  v_cvt_pk_bf16_f32 v147, v142, v143
  buffer_store_dwordx4 v[144:147], v2, s[4:7], s28 offen offset:2048 sc1
  v_accvgpr_read_b32 v148, a24
  v_accvgpr_read_b32 v149, a25
  v_accvgpr_read_b32 v150, a26
  v_accvgpr_read_b32 v151, a27
  v_accvgpr_read_b32 v152, a28
  v_accvgpr_read_b32 v153, a29
  v_accvgpr_read_b32 v154, a30
  v_accvgpr_read_b32 v155, a31
  v_pk_mul_f32 v[148:149], v[148:149], v[8:9] op_sel_hi:[1,0]
  v_pk_mul_f32 v[150:151], v[150:151], v[8:9] op_sel_hi:[1,0]
  v_pk_mul_f32 v[152:153], v[152:153], v[8:9] op_sel_hi:[1,0]
  v_pk_mul_f32 v[154:155], v[154:155], v[8:9] op_sel_hi:[1,0]
  v_cvt_pk_bf16_f32 v156, v148, v149
  v_cvt_pk_bf16_f32 v157, v150, v151
  v_cvt_pk_bf16_f32 v158, v152, v153
  v_cvt_pk_bf16_f32 v159, v154, v155
  buffer_store_dwordx4 v[156:159], v2, s[4:7], s28 offen offset:3072 sc1
  s_add_u32 s28, s25, 100667392
  v_accvgpr_read_b32 v112, a32
  v_accvgpr_read_b32 v113, a33
  v_accvgpr_read_b32 v114, a34
  v_accvgpr_read_b32 v115, a35
  v_accvgpr_read_b32 v116, a36
  v_accvgpr_read_b32 v117, a37
  v_accvgpr_read_b32 v118, a38
  v_accvgpr_read_b32 v119, a39
  v_pk_mul_f32 v[112:113], v[112:113], v[8:9] op_sel_hi:[1,0]
  v_pk_mul_f32 v[114:115], v[114:115], v[8:9] op_sel_hi:[1,0]
  v_pk_mul_f32 v[116:117], v[116:117], v[8:9] op_sel_hi:[1,0]
  v_pk_mul_f32 v[118:119], v[118:119], v[8:9] op_sel_hi:[1,0]
  v_cvt_pk_bf16_f32 v120, v112, v113
  v_cvt_pk_bf16_f32 v121, v114, v115
  v_cvt_pk_bf16_f32 v122, v116, v117
  v_cvt_pk_bf16_f32 v123, v118, v119
  buffer_store_dwordx4 v[120:123], v2, s[4:7], s28 offen offset:0 sc1
  v_accvgpr_read_b32 v124, a40
  v_accvgpr_read_b32 v125, a41
  v_accvgpr_read_b32 v126, a42
  v_accvgpr_read_b32 v127, a43
  v_accvgpr_read_b32 v128, a44
  v_accvgpr_read_b32 v129, a45
  v_accvgpr_read_b32 v130, a46
  v_accvgpr_read_b32 v131, a47
  v_pk_mul_f32 v[124:125], v[124:125], v[8:9] op_sel_hi:[1,0]
  v_pk_mul_f32 v[126:127], v[126:127], v[8:9] op_sel_hi:[1,0]
  v_pk_mul_f32 v[128:129], v[128:129], v[8:9] op_sel_hi:[1,0]
  v_pk_mul_f32 v[130:131], v[130:131], v[8:9] op_sel_hi:[1,0]
  v_cvt_pk_bf16_f32 v132, v124, v125
  v_cvt_pk_bf16_f32 v133, v126, v127
  v_cvt_pk_bf16_f32 v134, v128, v129
  v_cvt_pk_bf16_f32 v135, v130, v131
  buffer_store_dwordx4 v[132:135], v2, s[4:7], s28 offen offset:1024 sc1
  v_accvgpr_read_b32 v136, a48
  v_accvgpr_read_b32 v137, a49
  v_accvgpr_read_b32 v138, a50
  v_accvgpr_read_b32 v139, a51
  v_accvgpr_read_b32 v140, a52
  v_accvgpr_read_b32 v141, a53
  v_accvgpr_read_b32 v142, a54
  v_accvgpr_read_b32 v143, a55
  v_pk_mul_f32 v[136:137], v[136:137], v[8:9] op_sel_hi:[1,0]
  v_pk_mul_f32 v[138:139], v[138:139], v[8:9] op_sel_hi:[1,0]
  v_pk_mul_f32 v[140:141], v[140:141], v[8:9] op_sel_hi:[1,0]
  v_pk_mul_f32 v[142:143], v[142:143], v[8:9] op_sel_hi:[1,0]
  v_cvt_pk_bf16_f32 v144, v136, v137
  v_cvt_pk_bf16_f32 v145, v138, v139
  v_cvt_pk_bf16_f32 v146, v140, v141
  v_cvt_pk_bf16_f32 v147, v142, v143
  buffer_store_dwordx4 v[144:147], v2, s[4:7], s28 offen offset:2048 sc1
  v_accvgpr_read_b32 v148, a56
  v_accvgpr_read_b32 v149, a57
  v_accvgpr_read_b32 v150, a58
  v_accvgpr_read_b32 v151, a59
  v_accvgpr_read_b32 v152, a60
  v_accvgpr_read_b32 v153, a61
  v_accvgpr_read_b32 v154, a62
  v_accvgpr_read_b32 v155, a63
  v_pk_mul_f32 v[148:149], v[148:149], v[8:9] op_sel_hi:[1,0]
  v_pk_mul_f32 v[150:151], v[150:151], v[8:9] op_sel_hi:[1,0]
  v_pk_mul_f32 v[152:153], v[152:153], v[8:9] op_sel_hi:[1,0]
  v_pk_mul_f32 v[154:155], v[154:155], v[8:9] op_sel_hi:[1,0]
  v_cvt_pk_bf16_f32 v156, v148, v149
  v_cvt_pk_bf16_f32 v157, v150, v151
  v_cvt_pk_bf16_f32 v158, v152, v153
  v_cvt_pk_bf16_f32 v159, v154, v155
  buffer_store_dwordx4 v[156:159], v2, s[4:7], s28 offen offset:3072 sc1
  s_add_u32 s28, s25, 100671488
  v_accvgpr_read_b32 v112, a64
  v_accvgpr_read_b32 v113, a65
  v_accvgpr_read_b32 v114, a66
  v_accvgpr_read_b32 v115, a67
  v_accvgpr_read_b32 v116, a68
  v_accvgpr_read_b32 v117, a69
  v_accvgpr_read_b32 v118, a70
  v_accvgpr_read_b32 v119, a71
  v_pk_mul_f32 v[112:113], v[112:113], v[10:11] op_sel_hi:[1,0]
  v_pk_mul_f32 v[114:115], v[114:115], v[10:11] op_sel_hi:[1,0]
  v_pk_mul_f32 v[116:117], v[116:117], v[10:11] op_sel_hi:[1,0]
  v_pk_mul_f32 v[118:119], v[118:119], v[10:11] op_sel_hi:[1,0]
  v_cvt_pk_bf16_f32 v120, v112, v113
  v_cvt_pk_bf16_f32 v121, v114, v115
  v_cvt_pk_bf16_f32 v122, v116, v117
  v_cvt_pk_bf16_f32 v123, v118, v119
  buffer_store_dwordx4 v[120:123], v2, s[4:7], s28 offen offset:0 sc1
  v_accvgpr_read_b32 v124, a72
  v_accvgpr_read_b32 v125, a73
  v_accvgpr_read_b32 v126, a74
  v_accvgpr_read_b32 v127, a75
  v_accvgpr_read_b32 v128, a76
  v_accvgpr_read_b32 v129, a77
  v_accvgpr_read_b32 v130, a78
  v_accvgpr_read_b32 v131, a79
  v_pk_mul_f32 v[124:125], v[124:125], v[10:11] op_sel_hi:[1,0]
  v_pk_mul_f32 v[126:127], v[126:127], v[10:11] op_sel_hi:[1,0]
  v_pk_mul_f32 v[128:129], v[128:129], v[10:11] op_sel_hi:[1,0]
  v_pk_mul_f32 v[130:131], v[130:131], v[10:11] op_sel_hi:[1,0]
  v_cvt_pk_bf16_f32 v132, v124, v125
  v_cvt_pk_bf16_f32 v133, v126, v127
  v_cvt_pk_bf16_f32 v134, v128, v129
  v_cvt_pk_bf16_f32 v135, v130, v131
  buffer_store_dwordx4 v[132:135], v2, s[4:7], s28 offen offset:1024 sc1
  v_accvgpr_read_b32 v136, a80
  v_accvgpr_read_b32 v137, a81
  v_accvgpr_read_b32 v138, a82
  v_accvgpr_read_b32 v139, a83
  v_accvgpr_read_b32 v140, a84
  v_accvgpr_read_b32 v141, a85
  v_accvgpr_read_b32 v142, a86
  v_accvgpr_read_b32 v143, a87
  v_pk_mul_f32 v[136:137], v[136:137], v[10:11] op_sel_hi:[1,0]
  v_pk_mul_f32 v[138:139], v[138:139], v[10:11] op_sel_hi:[1,0]
  v_pk_mul_f32 v[140:141], v[140:141], v[10:11] op_sel_hi:[1,0]
  v_pk_mul_f32 v[142:143], v[142:143], v[10:11] op_sel_hi:[1,0]
  v_cvt_pk_bf16_f32 v144, v136, v137
  v_cvt_pk_bf16_f32 v145, v138, v139
  v_cvt_pk_bf16_f32 v146, v140, v141
  v_cvt_pk_bf16_f32 v147, v142, v143
  buffer_store_dwordx4 v[144:147], v2, s[4:7], s28 offen offset:2048 sc1
  v_accvgpr_read_b32 v148, a88
  v_accvgpr_read_b32 v149, a89
  v_accvgpr_read_b32 v150, a90
  v_accvgpr_read_b32 v151, a91
  v_accvgpr_read_b32 v152, a92
  v_accvgpr_read_b32 v153, a93
  v_accvgpr_read_b32 v154, a94
  v_accvgpr_read_b32 v155, a95
  v_pk_mul_f32 v[148:149], v[148:149], v[10:11] op_sel_hi:[1,0]
  v_pk_mul_f32 v[150:151], v[150:151], v[10:11] op_sel_hi:[1,0]
  v_pk_mul_f32 v[152:153], v[152:153], v[10:11] op_sel_hi:[1,0]
  v_pk_mul_f32 v[154:155], v[154:155], v[10:11] op_sel_hi:[1,0]
  v_cvt_pk_bf16_f32 v156, v148, v149
  v_cvt_pk_bf16_f32 v157, v150, v151
  v_cvt_pk_bf16_f32 v158, v152, v153
  v_cvt_pk_bf16_f32 v159, v154, v155
  buffer_store_dwordx4 v[156:159], v2, s[4:7], s28 offen offset:3072 sc1
  s_add_u32 s28, s25, 100675584
  v_accvgpr_read_b32 v112, a96
  v_accvgpr_read_b32 v113, a97
  v_accvgpr_read_b32 v114, a98
  v_accvgpr_read_b32 v115, a99
  v_accvgpr_read_b32 v116, a100
  v_accvgpr_read_b32 v117, a101
  v_accvgpr_read_b32 v118, a102
  v_accvgpr_read_b32 v119, a103
  v_pk_mul_f32 v[112:113], v[112:113], v[10:11] op_sel_hi:[1,0]
  v_pk_mul_f32 v[114:115], v[114:115], v[10:11] op_sel_hi:[1,0]
  v_pk_mul_f32 v[116:117], v[116:117], v[10:11] op_sel_hi:[1,0]
  v_pk_mul_f32 v[118:119], v[118:119], v[10:11] op_sel_hi:[1,0]
  v_cvt_pk_bf16_f32 v120, v112, v113
  v_cvt_pk_bf16_f32 v121, v114, v115
  v_cvt_pk_bf16_f32 v122, v116, v117
  v_cvt_pk_bf16_f32 v123, v118, v119
  buffer_store_dwordx4 v[120:123], v2, s[4:7], s28 offen offset:0 sc1
  v_accvgpr_read_b32 v124, a104
  v_accvgpr_read_b32 v125, a105
  v_accvgpr_read_b32 v126, a106
  v_accvgpr_read_b32 v127, a107
  v_accvgpr_read_b32 v128, a108
  v_accvgpr_read_b32 v129, a109
  v_accvgpr_read_b32 v130, a110
  v_accvgpr_read_b32 v131, a111
  v_pk_mul_f32 v[124:125], v[124:125], v[10:11] op_sel_hi:[1,0]
  v_pk_mul_f32 v[126:127], v[126:127], v[10:11] op_sel_hi:[1,0]
  v_pk_mul_f32 v[128:129], v[128:129], v[10:11] op_sel_hi:[1,0]
  v_pk_mul_f32 v[130:131], v[130:131], v[10:11] op_sel_hi:[1,0]
  v_cvt_pk_bf16_f32 v132, v124, v125
  v_cvt_pk_bf16_f32 v133, v126, v127
  v_cvt_pk_bf16_f32 v134, v128, v129
  v_cvt_pk_bf16_f32 v135, v130, v131
  buffer_store_dwordx4 v[132:135], v2, s[4:7], s28 offen offset:1024 sc1
  v_accvgpr_read_b32 v136, a112
  v_accvgpr_read_b32 v137, a113
  v_accvgpr_read_b32 v138, a114
  v_accvgpr_read_b32 v139, a115
  v_accvgpr_read_b32 v140, a116
  v_accvgpr_read_b32 v141, a117
  v_accvgpr_read_b32 v142, a118
  v_accvgpr_read_b32 v143, a119
  v_pk_mul_f32 v[136:137], v[136:137], v[10:11] op_sel_hi:[1,0]
  v_pk_mul_f32 v[138:139], v[138:139], v[10:11] op_sel_hi:[1,0]
  v_pk_mul_f32 v[140:141], v[140:141], v[10:11] op_sel_hi:[1,0]
  v_pk_mul_f32 v[142:143], v[142:143], v[10:11] op_sel_hi:[1,0]
  v_cvt_pk_bf16_f32 v144, v136, v137
  v_cvt_pk_bf16_f32 v145, v138, v139
  v_cvt_pk_bf16_f32 v146, v140, v141
  v_cvt_pk_bf16_f32 v147, v142, v143
  buffer_store_dwordx4 v[144:147], v2, s[4:7], s28 offen offset:2048 sc1
  v_accvgpr_read_b32 v148, a120
  v_accvgpr_read_b32 v149, a121
  v_accvgpr_read_b32 v150, a122
  v_accvgpr_read_b32 v151, a123
  v_accvgpr_read_b32 v152, a124
  v_accvgpr_read_b32 v153, a125
  v_accvgpr_read_b32 v154, a126
  v_accvgpr_read_b32 v155, a127
  v_pk_mul_f32 v[148:149], v[148:149], v[10:11] op_sel_hi:[1,0]
  v_pk_mul_f32 v[150:151], v[150:151], v[10:11] op_sel_hi:[1,0]
  v_pk_mul_f32 v[152:153], v[152:153], v[10:11] op_sel_hi:[1,0]
  v_pk_mul_f32 v[154:155], v[154:155], v[10:11] op_sel_hi:[1,0]
  v_cvt_pk_bf16_f32 v156, v148, v149
  v_cvt_pk_bf16_f32 v157, v150, v151
  v_cvt_pk_bf16_f32 v158, v152, v153
  v_cvt_pk_bf16_f32 v159, v154, v155
  buffer_store_dwordx4 v[156:159], v2, s[4:7], s28 offen offset:3072 sc1
  s_branch A_out_31
A_kvw_32:
M_kv_35:
  s_cmp_ge_u32 s17, s36
  s_cbranch_scc1 M_kvok_36
  s_mov_b32 s76, 0
  s_mov_b32 s78, 23
  s_mov_b32 s77, 335872
  s_cmp_eq_u32 s68, 1
  s_cmov_b32 s76, 128
  s_cmov_b32 s78, 27
  s_cmov_b32 s77, 114688
  s_cmp_eq_u32 s68, 2
  s_cmov_b32 s76, 768
  s_cmov_b32 s78, 14
  s_cmov_b32 s77, 0
  s_add_u32 s76, s76, s67
  s_mov_b32 s71, 0
  s_branch M_sg_38
M_sw_37:
  s_sleep 8
  s_add_u32 s71, s71, 1
  s_cmp_gt_u32 s71, 262144
  s_cbranch_scc1 M_exit
M_sg_38:
  s_mov_b32 s79, 0
  s_atomic_or s79, s[72:73], s76 glc
  s_waitcnt lgkmcnt(0)
  s_cmp_lt_u32 s79, s78
  s_cbranch_scc1 M_sw_37
  s_add_u32 s36, s77, s19
  s_add_u32 s68, s68, 1
  s_branch M_kv_35
M_kvok_36:
  s_branch A_kvb_33
A_upd_29:
  s_cmp_eq_u32 s23, 2
  s_cbranch_scc1 A_upd2_39
  v_mov_b32 v12, s24
  v_cmp_le_i32 s[40:41], 0, v5
  v_cmp_le_i32 s[42:43], 1, v5
  v_cmp_le_i32 s[44:45], 2, v5
  v_cmp_le_i32 s[46:47], 3, v5
  v_cndmask_b32 v64, v12, v6, s[40:41]
  v_cndmask_b32 v65, v12, v6, s[42:43]
  v_cndmask_b32 v66, v12, v6, s[44:45]
  v_cndmask_b32 v67, v12, v6, s[46:47]
  v_cmp_le_i32 s[40:41], 8, v5
  v_cmp_le_i32 s[42:43], 9, v5
  v_cmp_le_i32 s[44:45], 10, v5
  v_cmp_le_i32 s[46:47], 11, v5
  v_cndmask_b32 v68, v12, v6, s[40:41]
  v_cndmask_b32 v69, v12, v6, s[42:43]
  v_cndmask_b32 v70, v12, v6, s[44:45]
  v_cndmask_b32 v71, v12, v6, s[46:47]
  v_cmp_le_i32 s[40:41], 16, v5
  v_cmp_le_i32 s[42:43], 17, v5
  v_cmp_le_i32 s[44:45], 18, v5
  v_cmp_le_i32 s[46:47], 19, v5
  v_cndmask_b32 v72, v12, v6, s[40:41]
  v_cndmask_b32 v73, v12, v6, s[42:43]
  v_cndmask_b32 v74, v12, v6, s[44:45]
  v_cndmask_b32 v75, v12, v6, s[46:47]
  v_cmp_le_i32 s[40:41], 24, v5
  v_cmp_le_i32 s[42:43], 25, v5
  v_cmp_le_i32 s[44:45], 26, v5
  v_cmp_le_i32 s[46:47], 27, v5
  v_cndmask_b32 v76, v12, v6, s[40:41]
  v_cndmask_b32 v77, v12, v6, s[42:43]
  v_cndmask_b32 v78, v12, v6, s[44:45]
  v_cndmask_b32 v79, v12, v6, s[46:47]
  v_mov_b32 v80, v7
  v_mov_b32 v81, v7
  v_mov_b32 v82, v7
  v_mov_b32 v83, v7
  v_mov_b32 v84, v7
  v_mov_b32 v85, v7
  v_mov_b32 v86, v7
  v_mov_b32 v87, v7
  v_mov_b32 v88, v7
  v_mov_b32 v89, v7
  v_mov_b32 v90, v7
  v_mov_b32 v91, v7
  v_mov_b32 v92, v7
  v_mov_b32 v93, v7
  v_mov_b32 v94, v7
  v_mov_b32 v95, v7
  s_branch A_back_30
A_upd2_39:
  v_mov_b32 v64, v6
  v_mov_b32 v65, v6
  v_mov_b32 v66, v6
  v_mov_b32 v67, v6
  v_mov_b32 v68, v6
  v_mov_b32 v69, v6
  v_mov_b32 v70, v6
  v_mov_b32 v71, v6
  v_mov_b32 v72, v6
  v_mov_b32 v73, v6
  v_mov_b32 v74, v6
  v_mov_b32 v75, v6
  v_mov_b32 v76, v6
  v_mov_b32 v77, v6
  v_mov_b32 v78, v6
  v_mov_b32 v79, v6
  s_branch A_back_30
A_slow_34:
  s_mov_b32 s29, 1
  v_mov_b32 v64, s24
  v_mov_b32 v65, s24
  v_mov_b32 v66, s24
  v_mov_b32 v67, s24
  v_mov_b32 v68, s24
  v_mov_b32 v69, s24
  v_mov_b32 v70, s24
  v_mov_b32 v71, s24
  v_mov_b32 v72, s24
  v_mov_b32 v73, s24
  v_mov_b32 v74, s24
  v_mov_b32 v75, s24
  v_mov_b32 v76, s24
  v_mov_b32 v77, s24
  v_mov_b32 v78, s24
  v_mov_b32 v79, s24
  v_mov_b32 v12, s24
  v_cmp_le_i32 s[40:41], 0, v5
  v_cmp_le_i32 s[42:43], 1, v5
  v_cmp_le_i32 s[44:45], 2, v5
  v_cmp_le_i32 s[46:47], 3, v5
  v_cndmask_b32 v80, v12, v7, s[40:41]
  v_cndmask_b32 v81, v12, v7, s[42:43]
  v_cndmask_b32 v82, v12, v7, s[44:45]
  v_cndmask_b32 v83, v12, v7, s[46:47]
  v_cmp_le_i32 s[40:41], 8, v5
  v_cmp_le_i32 s[42:43], 9, v5
  v_cmp_le_i32 s[44:45], 10, v5
  v_cmp_le_i32 s[46:47], 11, v5
  v_cndmask_b32 v84, v12, v7, s[40:41]
  v_cndmask_b32 v85, v12, v7, s[42:43]
  v_cndmask_b32 v86, v12, v7, s[44:45]
  v_cndmask_b32 v87, v12, v7, s[46:47]
  v_cmp_le_i32 s[40:41], 16, v5
  v_cmp_le_i32 s[42:43], 17, v5
  v_cmp_le_i32 s[44:45], 18, v5
  v_cmp_le_i32 s[46:47], 19, v5
  v_cndmask_b32 v88, v12, v7, s[40:41]
  v_cndmask_b32 v89, v12, v7, s[42:43]
  v_cndmask_b32 v90, v12, v7, s[44:45]
  v_cndmask_b32 v91, v12, v7, s[46:47]
  v_cmp_le_i32 s[40:41], 24, v5
  v_cmp_le_i32 s[42:43], 25, v5
  v_cmp_le_i32 s[44:45], 26, v5
  v_cmp_le_i32 s[46:47], 27, v5
  v_cndmask_b32 v92, v12, v7, s[40:41]
  v_cndmask_b32 v93, v12, v7, s[42:43]
  v_cndmask_b32 v94, v12, v7, s[44:45]
  v_cndmask_b32 v95, v12, v7, s[46:47]
  v_mov_b32 v8, s24
  v_mov_b32 v10, s24
  s_add_u32 s17, s25, 16785408
  s_mov_b32 s23, 0
A_ml_40:
  s_add_u32 s28, s17, 4096
  buffer_load_dwordx4 a[192:195], v2, s[4:7], s17 offen offset:0 sc1
  buffer_load_dwordx4 a[196:199], v2, s[4:7], s17 offen offset:1024 sc1
  buffer_load_dwordx4 a[200:203], v2, s[4:7], s17 offen offset:2048 sc1
  buffer_load_dwordx4 a[204:207], v2, s[4:7], s17 offen offset:3072 sc1
  buffer_load_dwordx4 a[208:211], v2, s[4:7], s28 offen offset:0 sc1
  buffer_load_dwordx4 a[212:215], v2, s[4:7], s28 offen offset:1024 sc1
  buffer_load_dwordx4 a[216:219], v2, s[4:7], s28 offen offset:2048 sc1
  buffer_load_dwordx4 a[220:223], v2, s[4:7], s28 offen offset:3072 sc1
  s_waitcnt vmcnt(0)
  v_mfma_f32_32x32x16_bf16 v[32:47], a[192:195], a[128:131], v[64:79]
  v_mfma_f32_32x32x16_bf16 v[32:47], a[196:199], a[132:135], v[32:47]
  v_mfma_f32_32x32x16_bf16 v[32:47], a[200:203], a[136:139], v[32:47]
  v_mfma_f32_32x32x16_bf16 v[32:47], a[204:207], a[140:143], v[32:47]
  v_mfma_f32_32x32x16_bf16 v[32:47], a[208:211], a[144:147], v[32:47]
  v_mfma_f32_32x32x16_bf16 v[32:47], a[212:215], a[148:151], v[32:47]
  v_mfma_f32_32x32x16_bf16 v[32:47], a[216:219], a[152:155], v[32:47]
  v_mfma_f32_32x32x16_bf16 v[32:47], a[220:223], a[156:159], v[32:47]
  v_mfma_f32_32x32x16_bf16 v[48:63], a[192:195], a[160:163], v[80:95]
  v_mfma_f32_32x32x16_bf16 v[48:63], a[196:199], a[164:167], v[48:63]
  v_mfma_f32_32x32x16_bf16 v[48:63], a[200:203], a[168:171], v[48:63]
  v_mfma_f32_32x32x16_bf16 v[48:63], a[204:207], a[172:175], v[48:63]
  v_mfma_f32_32x32x16_bf16 v[48:63], a[208:211], a[176:179], v[48:63]
  v_mfma_f32_32x32x16_bf16 v[48:63], a[212:215], a[180:183], v[48:63]
  v_mfma_f32_32x32x16_bf16 v[48:63], a[216:219], a[184:187], v[48:63]
  v_mfma_f32_32x32x16_bf16 v[48:63], a[220:223], a[188:191], v[48:63]
  s_nop 7
  s_nop 3
  v_max3_f32 v8, v8, v32, v33
  v_max3_f32 v8, v8, v34, v35
  v_max3_f32 v8, v8, v36, v37
  v_max3_f32 v8, v8, v38, v39
  v_max3_f32 v8, v8, v40, v41
  v_max3_f32 v8, v8, v42, v43
  v_max3_f32 v8, v8, v44, v45
  v_max3_f32 v8, v8, v46, v47
  v_max3_f32 v10, v10, v48, v49
  v_max3_f32 v10, v10, v50, v51
  v_max3_f32 v10, v10, v52, v53
  v_max3_f32 v10, v10, v54, v55
  v_max3_f32 v10, v10, v56, v57
  v_max3_f32 v10, v10, v58, v59
  v_max3_f32 v10, v10, v60, v61
  v_max3_f32 v10, v10, v62, v63
  s_add_u32 s23, s23, 1
  s_cmp_lg_u32 s23, 1
  s_cbranch_scc1 A_m2_41
  v_mov_b32 v12, s24
  v_cmp_le_i32 s[40:41], 0, v5
  v_cmp_le_i32 s[42:43], 1, v5
  v_cmp_le_i32 s[44:45], 2, v5
  v_cmp_le_i32 s[46:47], 3, v5
  v_cndmask_b32 v64, v12, v6, s[40:41]
  v_cndmask_b32 v65, v12, v6, s[42:43]
  v_cndmask_b32 v66, v12, v6, s[44:45]
  v_cndmask_b32 v67, v12, v6, s[46:47]
  v_cmp_le_i32 s[40:41], 8, v5
  v_cmp_le_i32 s[42:43], 9, v5
  v_cmp_le_i32 s[44:45], 10, v5
  v_cmp_le_i32 s[46:47], 11, v5
  v_cndmask_b32 v68, v12, v6, s[40:41]
  v_cndmask_b32 v69, v12, v6, s[42:43]
  v_cndmask_b32 v70, v12, v6, s[44:45]
  v_cndmask_b32 v71, v12, v6, s[46:47]
  v_cmp_le_i32 s[40:41], 16, v5
  v_cmp_le_i32 s[42:43], 17, v5
  v_cmp_le_i32 s[44:45], 18, v5
  v_cmp_le_i32 s[46:47], 19, v5
  v_cndmask_b32 v72, v12, v6, s[40:41]
  v_cndmask_b32 v73, v12, v6, s[42:43]
  v_cndmask_b32 v74, v12, v6, s[44:45]
  v_cndmask_b32 v75, v12, v6, s[46:47]
  v_cmp_le_i32 s[40:41], 24, v5
  v_cmp_le_i32 s[42:43], 25, v5
  v_cmp_le_i32 s[44:45], 26, v5
  v_cmp_le_i32 s[46:47], 27, v5
  v_cndmask_b32 v76, v12, v6, s[40:41]
  v_cndmask_b32 v77, v12, v6, s[42:43]
  v_cndmask_b32 v78, v12, v6, s[44:45]
  v_cndmask_b32 v79, v12, v6, s[46:47]
  v_mov_b32 v80, v7
  v_mov_b32 v81, v7
  v_mov_b32 v82, v7
  v_mov_b32 v83, v7
  v_mov_b32 v84, v7
  v_mov_b32 v85, v7
  v_mov_b32 v86, v7
  v_mov_b32 v87, v7
  v_mov_b32 v88, v7
  v_mov_b32 v89, v7
  v_mov_b32 v90, v7
  v_mov_b32 v91, v7
  v_mov_b32 v92, v7
  v_mov_b32 v93, v7
  v_mov_b32 v94, v7
  v_mov_b32 v95, v7
A_m2_41:
  s_cmp_lg_u32 s23, 2
  s_cbranch_scc1 A_m3_42
  v_mov_b32 v64, v6
  v_mov_b32 v65, v6
  v_mov_b32 v66, v6
  v_mov_b32 v67, v6
  v_mov_b32 v68, v6
  v_mov_b32 v69, v6
  v_mov_b32 v70, v6
  v_mov_b32 v71, v6
  v_mov_b32 v72, v6
  v_mov_b32 v73, v6
  v_mov_b32 v74, v6
  v_mov_b32 v75, v6
  v_mov_b32 v76, v6
  v_mov_b32 v77, v6
  v_mov_b32 v78, v6
  v_mov_b32 v79, v6
A_m3_42:
  s_sub_u32 s17, s17, 8192
  s_cmp_ge_i32 s17, s19
  s_cbranch_scc1 A_ml_40
  v_mov_b32 v9, v8
  s_nop 1
  v_permlane32_swap_b32 v8, v9
  s_nop 1
  v_max_f32 v8, v8, v9
  v_sub_f32 v6, 0, v8
  v_mov_b32 v11, v10
  s_nop 1
  v_permlane32_swap_b32 v10, v11
  s_nop 1
  v_max_f32 v10, v10, v11
  v_sub_f32 v7, 0, v10
  s_branch A_again_21
A_out_31:
  s_mov_b32 s69, s55
  s_mov_b32 s70, s56
  s_sub_u32 s52, s52, 1
  s_cmp_lg_u32 s52, 0
  s_cbranch_scc1 M_att
  s_waitcnt vmcnt(0)
  s_barrier
  s_mov_b32 s30, 512
  v_mov_b32 v144, s30
  v_min_u32 v145, 1, v0
  v_lshlrev_b32 v145, 30, v145
  buffer_store_dword v144, v145, s[4:7], s31 offen sc1
  s_lshr_b32 s48, s64, 2
  s_bfe_u32 s49, s64, 0x10001
  s_and_b32 s50, s64, 1
  s_mul_i32 s50, s50, 6
  s_add_u32 s50, s50, s65
  s_mov_b32 s51, 12
  s_cmp_lt_u32 s50, 4
  s_cselect_b32 s23, 6, 5
  s_load_dwordx2 s[8:9], s[0:1], 40
  s_lshl_b32 s17, s48, 19
  s_lshl_b32 s26, s49, 2
  s_add_u32 s26, s26, s16
  s_lshl_b32 s27, s26, 7
  s_add_u32 s17, s17, s27
  s_mov_b32 s18, 1024
  s_lshl_b32 s21, s48, 6
  s_add_u32 s21, s21, s50
  s_lshl_b32 s21, s21, 3
  s_add_u32 s21, s21, s26
  s_lshl_b32 s21, s21, 12
  s_add_u32 s21, s21, 150994944
  s_lshl_b32 s22, s51, 15
  s_mov_b32 s24, 1.0
  s_waitcnt lgkmcnt(0)
  s_and_b32 s9, s9, 0xffff
  s_mov_b32 s10, 4194304
  s_mov_b32 s11, 0x20000
  s_mov_b32 s12, s4
  s_mov_b32 s13, s5
  s_mov_b32 s14, 268435456
  s_mov_b32 s15, 0x20000
  s_lshl_b32 s19, s48, 8
  s_add_u32 s19, s19, s50
  s_lshl_b32 s19, s19, 13
  s_add_u32 s19, s19, 100663296
  s_lshl_b32 s20, s51, 13
  s_mul_i32 s26, s16, 524288
  v_add_u32 v8, 0, v2
  v_add_u32 v16, s26, v8
  v_add_u32 v9, 1024, v2
  v_add_u32 v17, s26, v9
  v_add_u32 v10, 2048, v2
  v_add_u32 v18, s26, v10
  v_add_u32 v11, 3072, v2
  v_add_u32 v19, s26, v11
  v_add_u32 v12, 4096, v2
  v_add_u32 v20, s26, v12
  v_add_u32 v13, 5120, v2
  v_add_u32 v21, s26, v13
  v_add_u32 v14, 6144, v2
  v_add_u32 v22, s26, v14
  v_add_u32 v15, 7168, v2
  v_add_u32 v23, s26, v15
  v_lshrrev_b32 v144, 3, v1
  v_mul_lo_u32 v144, v144, s18
  v_and_b32 v145, 7, v1
  v_lshl_add_u32 v144, v145, 4, v144
  s_lshl_b32 s28, s16, 15
  s_add_u32 s28, s28, 32768
  s_lshl_b32 s29, s18, 3
  s_add_u32 m0, s28, 0
  s_nop 0
  buffer_load_dwordx4 v144, s[8:11], s17 offen lds
  s_add_u32 s17, s17, s29
  s_add_u32 m0, s28, 1024
  s_nop 0
  buffer_load_dwordx4 v144, s[8:11], s17 offen lds
  s_add_u32 s17, s17, s29
  s_add_u32 m0, s28, 2048
  s_nop 0
  buffer_load_dwordx4 v144, s[8:11], s17 offen lds
  s_add_u32 s17, s17, s29
  s_add_u32 m0, s28, 3072
  s_nop 0
  buffer_load_dwordx4 v144, s[8:11], s17 offen lds
  s_add_u32 s17, s17, s29
  s_add_u32 m0, s28, 4096
  s_nop 0
  buffer_load_dwordx4 v144, s[8:11], s17 offen lds
  s_add_u32 s17, s17, s29
  s_add_u32 m0, s28, 5120
  s_nop 0
  buffer_load_dwordx4 v144, s[8:11], s17 offen lds
  s_add_u32 s17, s17, s29
  s_add_u32 m0, s28, 6144
  s_nop 0
  buffer_load_dwordx4 v144, s[8:11], s17 offen lds
  s_add_u32 s17, s17, s29
  s_add_u32 m0, s28, 7168
  s_nop 0
  buffer_load_dwordx4 v144, s[8:11], s17 offen lds
  s_add_u32 s17, s17, s29
  s_add_u32 m0, s28, 8192
  s_nop 0
  buffer_load_dwordx4 v144, s[8:11], s17 offen lds
  s_add_u32 s17, s17, s29
  s_add_u32 m0, s28, 9216
  s_nop 0
  buffer_load_dwordx4 v144, s[8:11], s17 offen lds
  s_add_u32 s17, s17, s29
  s_add_u32 m0, s28, 10240
  s_nop 0
  buffer_load_dwordx4 v144, s[8:11], s17 offen lds
  s_add_u32 s17, s17, s29
  s_add_u32 m0, s28, 11264
  s_nop 0
  buffer_load_dwordx4 v144, s[8:11], s17 offen lds
  s_add_u32 s17, s17, s29
  s_add_u32 m0, s28, 12288
  s_nop 0
  buffer_load_dwordx4 v144, s[8:11], s17 offen lds
  s_add_u32 s17, s17, s29
  s_add_u32 m0, s28, 13312
  s_nop 0
  buffer_load_dwordx4 v144, s[8:11], s17 offen lds
  s_add_u32 s17, s17, s29
  s_add_u32 m0, s28, 14336
  s_nop 0
  buffer_load_dwordx4 v144, s[8:11], s17 offen lds
  s_add_u32 s17, s17, s29
  s_add_u32 m0, s28, 15360
  s_nop 0
  buffer_load_dwordx4 v144, s[8:11], s17 offen lds
  s_add_u32 s17, s17, s29
  s_add_u32 m0, s28, 16384
  s_nop 0
  buffer_load_dwordx4 v144, s[8:11], s17 offen lds
  s_add_u32 s17, s17, s29
  s_add_u32 m0, s28, 17408
  s_nop 0
  buffer_load_dwordx4 v144, s[8:11], s17 offen lds
  s_add_u32 s17, s17, s29
  s_add_u32 m0, s28, 18432
  s_nop 0
  buffer_load_dwordx4 v144, s[8:11], s17 offen lds
  s_add_u32 s17, s17, s29
  s_add_u32 m0, s28, 19456
  s_nop 0
  buffer_load_dwordx4 v144, s[8:11], s17 offen lds
  s_add_u32 s17, s17, s29
  s_add_u32 m0, s28, 20480
  s_nop 0
  buffer_load_dwordx4 v144, s[8:11], s17 offen lds
  s_add_u32 s17, s17, s29
  s_add_u32 m0, s28, 21504
  s_nop 0
  buffer_load_dwordx4 v144, s[8:11], s17 offen lds
  s_add_u32 s17, s17, s29
  s_add_u32 m0, s28, 22528
  s_nop 0
  buffer_load_dwordx4 v144, s[8:11], s17 offen lds
  s_add_u32 s17, s17, s29
  s_add_u32 m0, s28, 23552
  s_nop 0
  buffer_load_dwordx4 v144, s[8:11], s17 offen lds
  s_add_u32 s17, s17, s29
  s_add_u32 m0, s28, 24576
  s_nop 0
  buffer_load_dwordx4 v144, s[8:11], s17 offen lds
  s_add_u32 s17, s17, s29
  s_add_u32 m0, s28, 25600
  s_nop 0
  buffer_load_dwordx4 v144, s[8:11], s17 offen lds
  s_add_u32 s17, s17, s29
  s_add_u32 m0, s28, 26624
  s_nop 0
  buffer_load_dwordx4 v144, s[8:11], s17 offen lds
  s_add_u32 s17, s17, s29
  s_add_u32 m0, s28, 27648
  s_nop 0
  buffer_load_dwordx4 v144, s[8:11], s17 offen lds
  s_add_u32 s17, s17, s29
  s_add_u32 m0, s28, 28672
  s_nop 0
  buffer_load_dwordx4 v144, s[8:11], s17 offen lds
  s_add_u32 s17, s17, s29
  s_add_u32 m0, s28, 29696
  s_nop 0
  buffer_load_dwordx4 v144, s[8:11], s17 offen lds
  s_add_u32 s17, s17, s29
  s_add_u32 m0, s28, 30720
  s_nop 0
  buffer_load_dwordx4 v144, s[8:11], s17 offen lds
  s_add_u32 s17, s17, s29
  s_add_u32 m0, s28, 31744
  s_nop 0
  buffer_load_dwordx4 v144, s[8:11], s17 offen lds
  s_add_u32 s17, s17, s29
  v_bfe_u32 v148, v1, 2, 2
  v_lshrrev_b32 v149, 5, v1
  v_lshl_add_u32 v148, v149, 2, v148
  v_lshlrev_b32 v148, 7, v148
  v_bfe_u32 v149, v1, 4, 1
  v_lshl_add_u32 v148, v149, 5, v148
  v_and_b32 v149, 1, v1
  v_lshl_add_u32 v148, v149, 4, v148
  v_bfe_u32 v149, v1, 1, 1
  v_lshl_add_u32 v148, v149, 3, v148
  v_add_u32 v146, s28, v148
  v_add_u32 v147, 1024, v146
  s_waitcnt vmcnt(28)
  ds_read_b64_tr_b16 a[0:1], v146 offset:0
  ds_read_b64_tr_b16 a[2:3], v147 offset:0
  ds_read_b64_tr_b16 a[4:5], v146 offset:64
  ds_read_b64_tr_b16 a[6:7], v147 offset:64
  ds_read_b64_tr_b16 a[8:9], v146 offset:2048
  ds_read_b64_tr_b16 a[10:11], v147 offset:2048
  ds_read_b64_tr_b16 a[12:13], v146 offset:2112
  ds_read_b64_tr_b16 a[14:15], v147 offset:2112
  s_waitcnt lgkmcnt(0)
  s_add_u32 m0, s28, 0
  s_nop 0
  buffer_load_dwordx4 v144, s[8:11], s17 offen lds
  s_add_u32 s17, s17, s29
  s_add_u32 m0, s28, 1024
  s_nop 0
  buffer_load_dwordx4 v144, s[8:11], s17 offen lds
  s_add_u32 s17, s17, s29
  s_add_u32 m0, s28, 2048
  s_nop 0
  buffer_load_dwordx4 v144, s[8:11], s17 offen lds
  s_add_u32 s17, s17, s29
  s_add_u32 m0, s28, 3072
  s_nop 0
  buffer_load_dwordx4 v144, s[8:11], s17 offen lds
  s_add_u32 s17, s17, s29
  s_waitcnt vmcnt(28)
  ds_read_b64_tr_b16 a[16:17], v146 offset:4096
  ds_read_b64_tr_b16 a[18:19], v147 offset:4096
  ds_read_b64_tr_b16 a[20:21], v146 offset:4160
  ds_read_b64_tr_b16 a[22:23], v147 offset:4160
  ds_read_b64_tr_b16 a[24:25], v146 offset:6144
  ds_read_b64_tr_b16 a[26:27], v147 offset:6144
  ds_read_b64_tr_b16 a[28:29], v146 offset:6208
  ds_read_b64_tr_b16 a[30:31], v147 offset:6208
  s_waitcnt lgkmcnt(0)
  s_add_u32 m0, s28, 4096
  s_nop 0
  buffer_load_dwordx4 v144, s[8:11], s17 offen lds
  s_add_u32 s17, s17, s29
  s_add_u32 m0, s28, 5120
  s_nop 0
  buffer_load_dwordx4 v144, s[8:11], s17 offen lds
  s_add_u32 s17, s17, s29
  s_add_u32 m0, s28, 6144
  s_nop 0
  buffer_load_dwordx4 v144, s[8:11], s17 offen lds
  s_add_u32 s17, s17, s29
  s_add_u32 m0, s28, 7168
  s_nop 0
  buffer_load_dwordx4 v144, s[8:11], s17 offen lds
  s_add_u32 s17, s17, s29
  s_waitcnt vmcnt(28)
  ds_read_b64_tr_b16 a[32:33], v146 offset:8192
  ds_read_b64_tr_b16 a[34:35], v147 offset:8192
  ds_read_b64_tr_b16 a[36:37], v146 offset:8256
  ds_read_b64_tr_b16 a[38:39], v147 offset:8256
  ds_read_b64_tr_b16 a[40:41], v146 offset:10240
  ds_read_b64_tr_b16 a[42:43], v147 offset:10240
  ds_read_b64_tr_b16 a[44:45], v146 offset:10304
  ds_read_b64_tr_b16 a[46:47], v147 offset:10304
  s_waitcnt lgkmcnt(0)
  s_add_u32 m0, s28, 8192
  s_nop 0
  buffer_load_dwordx4 v144, s[8:11], s17 offen lds
  s_add_u32 s17, s17, s29
  s_add_u32 m0, s28, 9216
  s_nop 0
  buffer_load_dwordx4 v144, s[8:11], s17 offen lds
  s_add_u32 s17, s17, s29
  s_add_u32 m0, s28, 10240
  s_nop 0
  buffer_load_dwordx4 v144, s[8:11], s17 offen lds
  s_add_u32 s17, s17, s29
  s_add_u32 m0, s28, 11264
  s_nop 0
  buffer_load_dwordx4 v144, s[8:11], s17 offen lds
  s_add_u32 s17, s17, s29
  s_waitcnt vmcnt(28)
  ds_read_b64_tr_b16 a[48:49], v146 offset:12288
  ds_read_b64_tr_b16 a[50:51], v147 offset:12288
  ds_read_b64_tr_b16 a[52:53], v146 offset:12352
  ds_read_b64_tr_b16 a[54:55], v147 offset:12352
  ds_read_b64_tr_b16 a[56:57], v146 offset:14336
  ds_read_b64_tr_b16 a[58:59], v147 offset:14336
  ds_read_b64_tr_b16 a[60:61], v146 offset:14400
  ds_read_b64_tr_b16 a[62:63], v147 offset:14400
  s_waitcnt lgkmcnt(0)
  s_add_u32 m0, s28, 12288
  s_nop 0
  buffer_load_dwordx4 v144, s[8:11], s17 offen lds
  s_add_u32 s17, s17, s29
  s_add_u32 m0, s28, 13312
  s_nop 0
  buffer_load_dwordx4 v144, s[8:11], s17 offen lds
  s_add_u32 s17, s17, s29
  s_add_u32 m0, s28, 14336
  s_nop 0
  buffer_load_dwordx4 v144, s[8:11], s17 offen lds
  s_add_u32 s17, s17, s29
  s_add_u32 m0, s28, 15360
  s_nop 0
  buffer_load_dwordx4 v144, s[8:11], s17 offen lds
  s_add_u32 s17, s17, s29
  s_waitcnt vmcnt(28)
  ds_read_b64_tr_b16 a[64:65], v146 offset:16384
  ds_read_b64_tr_b16 a[66:67], v147 offset:16384
  ds_read_b64_tr_b16 a[68:69], v146 offset:16448
  ds_read_b64_tr_b16 a[70:71], v147 offset:16448
  ds_read_b64_tr_b16 a[72:73], v146 offset:18432
  ds_read_b64_tr_b16 a[74:75], v147 offset:18432
  ds_read_b64_tr_b16 a[76:77], v146 offset:18496
  ds_read_b64_tr_b16 a[78:79], v147 offset:18496
  s_waitcnt lgkmcnt(0)
  s_add_u32 m0, s28, 16384
  s_nop 0
  buffer_load_dwordx4 v144, s[8:11], s17 offen lds
  s_add_u32 s17, s17, s29
  s_add_u32 m0, s28, 17408
  s_nop 0
  buffer_load_dwordx4 v144, s[8:11], s17 offen lds
  s_add_u32 s17, s17, s29
  s_add_u32 m0, s28, 18432
  s_nop 0
  buffer_load_dwordx4 v144, s[8:11], s17 offen lds
  s_add_u32 s17, s17, s29
  s_add_u32 m0, s28, 19456
  s_nop 0
  buffer_load_dwordx4 v144, s[8:11], s17 offen lds
  s_add_u32 s17, s17, s29
  s_waitcnt vmcnt(28)
  ds_read_b64_tr_b16 a[80:81], v146 offset:20480
  ds_read_b64_tr_b16 a[82:83], v147 offset:20480
  ds_read_b64_tr_b16 a[84:85], v146 offset:20544
  ds_read_b64_tr_b16 a[86:87], v147 offset:20544
  ds_read_b64_tr_b16 a[88:89], v146 offset:22528
  ds_read_b64_tr_b16 a[90:91], v147 offset:22528
  ds_read_b64_tr_b16 a[92:93], v146 offset:22592
  ds_read_b64_tr_b16 a[94:95], v147 offset:22592
  s_waitcnt lgkmcnt(0)
  s_add_u32 m0, s28, 20480
  s_nop 0
  buffer_load_dwordx4 v144, s[8:11], s17 offen lds
  s_add_u32 s17, s17, s29
  s_add_u32 m0, s28, 21504
  s_nop 0
  buffer_load_dwordx4 v144, s[8:11], s17 offen lds
  s_add_u32 s17, s17, s29
  s_add_u32 m0, s28, 22528
  s_nop 0
  buffer_load_dwordx4 v144, s[8:11], s17 offen lds
  s_add_u32 s17, s17, s29
  s_add_u32 m0, s28, 23552
  s_nop 0
  buffer_load_dwordx4 v144, s[8:11], s17 offen lds
  s_add_u32 s17, s17, s29
  s_waitcnt vmcnt(28)
  ds_read_b64_tr_b16 a[96:97], v146 offset:24576
  ds_read_b64_tr_b16 a[98:99], v147 offset:24576
  ds_read_b64_tr_b16 a[100:101], v146 offset:24640
  ds_read_b64_tr_b16 a[102:103], v147 offset:24640
  ds_read_b64_tr_b16 a[104:105], v146 offset:26624
  ds_read_b64_tr_b16 a[106:107], v147 offset:26624
  ds_read_b64_tr_b16 a[108:109], v146 offset:26688
  ds_read_b64_tr_b16 a[110:111], v147 offset:26688
  s_waitcnt lgkmcnt(0)
  s_add_u32 m0, s28, 24576
  s_nop 0
  buffer_load_dwordx4 v144, s[8:11], s17 offen lds
  s_add_u32 s17, s17, s29
  s_add_u32 m0, s28, 25600
  s_nop 0
  buffer_load_dwordx4 v144, s[8:11], s17 offen lds
  s_add_u32 s17, s17, s29
  s_add_u32 m0, s28, 26624
  s_nop 0
  buffer_load_dwordx4 v144, s[8:11], s17 offen lds
  s_add_u32 s17, s17, s29
  s_add_u32 m0, s28, 27648
  s_nop 0
  buffer_load_dwordx4 v144, s[8:11], s17 offen lds
  s_add_u32 s17, s17, s29
  s_waitcnt vmcnt(28)
  ds_read_b64_tr_b16 a[112:113], v146 offset:28672
  ds_read_b64_tr_b16 a[114:115], v147 offset:28672
  ds_read_b64_tr_b16 a[116:117], v146 offset:28736
  ds_read_b64_tr_b16 a[118:119], v147 offset:28736
  ds_read_b64_tr_b16 a[120:121], v146 offset:30720
  ds_read_b64_tr_b16 a[122:123], v147 offset:30720
  ds_read_b64_tr_b16 a[124:125], v146 offset:30784
  ds_read_b64_tr_b16 a[126:127], v147 offset:30784
  s_waitcnt lgkmcnt(0)
  s_add_u32 m0, s28, 28672
  s_nop 0
  buffer_load_dwordx4 v144, s[8:11], s17 offen lds
  s_add_u32 s17, s17, s29
  s_add_u32 m0, s28, 29696
  s_nop 0
  buffer_load_dwordx4 v144, s[8:11], s17 offen lds
  s_add_u32 s17, s17, s29
  s_add_u32 m0, s28, 30720
  s_nop 0
  buffer_load_dwordx4 v144, s[8:11], s17 offen lds
  s_add_u32 s17, s17, s29
  s_add_u32 m0, s28, 31744
  s_nop 0
  buffer_load_dwordx4 v144, s[8:11], s17 offen lds
  s_add_u32 s17, s17, s29
  s_waitcnt vmcnt(28)
  ds_read_b64_tr_b16 a[128:129], v146 offset:0
  ds_read_b64_tr_b16 a[130:131], v147 offset:0
  ds_read_b64_tr_b16 a[132:133], v146 offset:64
  ds_read_b64_tr_b16 a[134:135], v147 offset:64
  ds_read_b64_tr_b16 a[136:137], v146 offset:2048
  ds_read_b64_tr_b16 a[138:139], v147 offset:2048
  ds_read_b64_tr_b16 a[140:141], v146 offset:2112
  ds_read_b64_tr_b16 a[142:143], v147 offset:2112
  s_waitcnt lgkmcnt(0)
  s_waitcnt vmcnt(24)
  ds_read_b64_tr_b16 a[144:145], v146 offset:4096
  ds_read_b64_tr_b16 a[146:147], v147 offset:4096
  ds_read_b64_tr_b16 a[148:149], v146 offset:4160
  ds_read_b64_tr_b16 a[150:151], v147 offset:4160
  ds_read_b64_tr_b16 a[152:153], v146 offset:6144
  ds_read_b64_tr_b16 a[154:155], v147 offset:6144
  ds_read_b64_tr_b16 a[156:157], v146 offset:6208
  ds_read_b64_tr_b16 a[158:159], v147 offset:6208
  s_waitcnt lgkmcnt(0)
  s_waitcnt vmcnt(20)
  ds_read_b64_tr_b16 a[160:161], v146 offset:8192
  ds_read_b64_tr_b16 a[162:163], v147 offset:8192
  ds_read_b64_tr_b16 a[164:165], v146 offset:8256
  ds_read_b64_tr_b16 a[166:167], v147 offset:8256
  ds_read_b64_tr_b16 a[168:169], v146 offset:10240
  ds_read_b64_tr_b16 a[170:171], v147 offset:10240
  ds_read_b64_tr_b16 a[172:173], v146 offset:10304
  ds_read_b64_tr_b16 a[174:175], v147 offset:10304
  s_waitcnt lgkmcnt(0)
  s_waitcnt vmcnt(16)
  ds_read_b64_tr_b16 a[176:177], v146 offset:12288
  ds_read_b64_tr_b16 a[178:179], v147 offset:12288
  ds_read_b64_tr_b16 a[180:181], v146 offset:12352
  ds_read_b64_tr_b16 a[182:183], v147 offset:12352
  ds_read_b64_tr_b16 a[184:185], v146 offset:14336
  ds_read_b64_tr_b16 a[186:187], v147 offset:14336
  ds_read_b64_tr_b16 a[188:189], v146 offset:14400
  ds_read_b64_tr_b16 a[190:191], v147 offset:14400
  s_waitcnt lgkmcnt(0)
  s_waitcnt vmcnt(12)
  ds_read_b64_tr_b16 a[192:193], v146 offset:16384
  ds_read_b64_tr_b16 a[194:195], v147 offset:16384
  ds_read_b64_tr_b16 a[196:197], v146 offset:16448
  ds_read_b64_tr_b16 a[198:199], v147 offset:16448
  ds_read_b64_tr_b16 a[200:201], v146 offset:18432
  ds_read_b64_tr_b16 a[202:203], v147 offset:18432
  ds_read_b64_tr_b16 a[204:205], v146 offset:18496
  ds_read_b64_tr_b16 a[206:207], v147 offset:18496
  s_waitcnt lgkmcnt(0)
  s_waitcnt vmcnt(8)
  ds_read_b64_tr_b16 a[208:209], v146 offset:20480
  ds_read_b64_tr_b16 a[210:211], v147 offset:20480
  ds_read_b64_tr_b16 a[212:213], v146 offset:20544
  ds_read_b64_tr_b16 a[214:215], v147 offset:20544
  ds_read_b64_tr_b16 a[216:217], v146 offset:22528
  ds_read_b64_tr_b16 a[218:219], v147 offset:22528
  ds_read_b64_tr_b16 a[220:221], v146 offset:22592
  ds_read_b64_tr_b16 a[222:223], v147 offset:22592
  s_waitcnt lgkmcnt(0)
  s_waitcnt vmcnt(4)
  ds_read_b64_tr_b16 a[224:225], v146 offset:24576
  ds_read_b64_tr_b16 a[226:227], v147 offset:24576
  ds_read_b64_tr_b16 a[228:229], v146 offset:24640
  ds_read_b64_tr_b16 a[230:231], v147 offset:24640
  ds_read_b64_tr_b16 a[232:233], v146 offset:26624
  ds_read_b64_tr_b16 a[234:235], v147 offset:26624
  ds_read_b64_tr_b16 a[236:237], v146 offset:26688
  ds_read_b64_tr_b16 a[238:239], v147 offset:26688
  s_waitcnt lgkmcnt(0)
  s_waitcnt vmcnt(0)
  ds_read_b64_tr_b16 a[240:241], v146 offset:28672
  ds_read_b64_tr_b16 a[242:243], v147 offset:28672
  ds_read_b64_tr_b16 a[244:245], v146 offset:28736
  ds_read_b64_tr_b16 a[246:247], v147 offset:28736
  ds_read_b64_tr_b16 a[248:249], v146 offset:30720
  ds_read_b64_tr_b16 a[250:251], v147 offset:30720
  ds_read_b64_tr_b16 a[252:253], v146 offset:30784
  ds_read_b64_tr_b16 a[254:255], v147 offset:30784
  s_waitcnt lgkmcnt(0)
  v_min_u32 v4, 27, v1
  v_mul_u32_u24 v5, 37, v4
  v_lshrrev_b32 v5, 8, v5
  v_mul_u32_u24 v5, 7, v5
  v_sub_u32 v5, v4, v5
  v_mov_b32 v6, 0x200
  v_cmp_ne_u32 vcc, 6, v5
  s_mul_i32 s76, s48, 3584
  s_add_u32 s76, s76, 148897792
  v_cndmask_b32 v5, 0, v6, vcc
  v_lshl_add_u32 v4, v4, 7, s76
  s_mov_b32 s71, 0
  s_branch M_vg_44
M_vw_43:
  s_sleep 2
  s_add_u32 s71, s71, 1
  s_cmp_gt_u32 s71, 262144
  s_cbranch_scc1 M_exit
M_vg_44:
  buffer_load_dword v6, v4, s[4:7], 0 offen sc1
  s_waitcnt vmcnt(0)
  v_cmp_lt_u32 vcc, v6, v5
  s_cbranch_vccnz M_vw_43
  s_barrier
  s_lshl_b32 s25, s16, 13
  s_add_u32 m0, s25, 0
  s_nop 0
  buffer_load_dwordx4 v16, s[12:15], s19 offen sc1 lds
  s_add_u32 m0, s25, 1024
  s_nop 0
  buffer_load_dwordx4 v17, s[12:15], s19 offen sc1 lds
  s_add_u32 m0, s25, 2048
  s_nop 0
  buffer_load_dwordx4 v18, s[12:15], s19 offen sc1 lds
  s_add_u32 m0, s25, 3072
  s_nop 0
  buffer_load_dwordx4 v19, s[12:15], s19 offen sc1 lds
  s_add_u32 m0, s25, 4096
  s_nop 0
  buffer_load_dwordx4 v20, s[12:15], s19 offen sc1 lds
  s_add_u32 m0, s25, 5120
  s_nop 0
  buffer_load_dwordx4 v21, s[12:15], s19 offen sc1 lds
  s_add_u32 m0, s25, 6144
  s_nop 0
  buffer_load_dwordx4 v22, s[12:15], s19 offen sc1 lds
  s_add_u32 m0, s25, 7168
  s_nop 0
  buffer_load_dwordx4 v23, s[12:15], s19 offen sc1 lds
  s_cmp_gt_u32 s23, 1
  s_cselect_b32 s26, s20, 0
  s_add_u32 s19, s19, s26
  s_add_u32 s25, s25, 32768
  s_and_b32 s25, s25, 0x1ffff
  s_add_u32 m0, s25, 0
  s_nop 0
  buffer_load_dwordx4 v16, s[12:15], s19 offen sc1 lds
  s_add_u32 m0, s25, 1024
  s_nop 0
  buffer_load_dwordx4 v17, s[12:15], s19 offen sc1 lds
  s_add_u32 m0, s25, 2048
  s_nop 0
  buffer_load_dwordx4 v18, s[12:15], s19 offen sc1 lds
  s_add_u32 m0, s25, 3072
  s_nop 0
  buffer_load_dwordx4 v19, s[12:15], s19 offen sc1 lds
  s_add_u32 m0, s25, 4096
  s_nop 0
  buffer_load_dwordx4 v20, s[12:15], s19 offen sc1 lds
  s_add_u32 m0, s25, 5120
  s_nop 0
  buffer_load_dwordx4 v21, s[12:15], s19 offen sc1 lds
  s_add_u32 m0, s25, 6144
  s_nop 0
  buffer_load_dwordx4 v22, s[12:15], s19 offen sc1 lds
  s_add_u32 m0, s25, 7168
  s_nop 0
  buffer_load_dwordx4 v23, s[12:15], s19 offen sc1 lds
  s_cmp_gt_u32 s23, 2
  s_cselect_b32 s26, s20, 0
  s_add_u32 s19, s19, s26
  s_add_u32 s25, s25, 32768
  s_and_b32 s25, s25, 0x1ffff
  s_waitcnt vmcnt(0)
  s_barrier
  s_mov_b32 s27, s21
  v_mov_b32 v7, 0x40000000
  ds_read_b128 v[24:27], v8 offset:0
  ds_read_b128 v[28:31], v9 offset:0
  ds_read_b128 v[32:35], v10 offset:0
  ds_read_b128 v[36:39], v11 offset:0
  ds_read_b128 v[40:43], v12 offset:0
  ds_read_b128 v[44:47], v13 offset:0
.p2align 6
G_top_45:
  s_waitcnt lgkmcnt(5)
  v_mfma_f32_32x32x16_bf16 v[64:79], a[0:3], v[24:27], 0
  s_add_u32 m0, s25, 0
  ds_read_b128 v[48:51], v14 offset:0
  v_mfma_f32_32x32x16_bf16 v[80:95], a[4:7], v[24:27], 0
  s_waitcnt lgkmcnt(5)
  buffer_load_dwordx4 v16, s[12:15], s19 offen sc1 lds
  v_mfma_f32_32x32x16_bf16 v[64:79], a[8:11], v[28:31], v[64:79]
  ds_read_b128 v[52:55], v15 offset:0
  v_mul_f32 v96, s24, v96
  v_mul_f32 v97, s24, v97
  v_mfma_f32_32x32x16_bf16 v[80:95], a[12:15], v[28:31], v[80:95]
  s_waitcnt lgkmcnt(5)
  v_cvt_pk_bf16_f32 v128, v96, v97
  v_mul_f32 v98, s24, v98
  v_mfma_f32_32x32x16_bf16 v[64:79], a[16:19], v[32:35], v[64:79]
  s_add_u32 m0, s25, 1024
  ds_read_b128 v[24:27], v8 offset:8192
  v_mul_f32 v99, s24, v99
  v_cvt_pk_bf16_f32 v129, v98, v99
  v_mfma_f32_32x32x16_bf16 v[80:95], a[20:23], v[32:35], v[80:95]
  s_waitcnt lgkmcnt(5)
  buffer_load_dwordx4 v17, s[12:15], s19 offen sc1 lds
  v_mul_f32 v100, s24, v100
  v_mul_f32 v101, s24, v101
  v_mfma_f32_32x32x16_bf16 v[64:79], a[24:27], v[36:39], v[64:79]
  ds_read_b128 v[28:31], v9 offset:8192
  v_cvt_pk_bf16_f32 v130, v100, v101
  v_mul_f32 v102, s24, v102
  v_mfma_f32_32x32x16_bf16 v[80:95], a[28:31], v[36:39], v[80:95]
  s_waitcnt lgkmcnt(5)
  v_mul_f32 v103, s24, v103
  v_cvt_pk_bf16_f32 v131, v102, v103
  v_mfma_f32_32x32x16_bf16 v[64:79], a[32:35], v[40:43], v[64:79]
  s_add_u32 m0, s25, 2048
  ds_read_b128 v[32:35], v10 offset:8192
  v_mul_f32 v104, s24, v104
  v_mul_f32 v105, s24, v105
  v_mfma_f32_32x32x16_bf16 v[80:95], a[36:39], v[40:43], v[80:95]
  s_waitcnt lgkmcnt(5)
  buffer_load_dwordx4 v18, s[12:15], s19 offen sc1 lds
  v_cvt_pk_bf16_f32 v132, v104, v105
  v_mul_f32 v106, s24, v106
  v_mfma_f32_32x32x16_bf16 v[64:79], a[40:43], v[44:47], v[64:79]
  ds_read_b128 v[36:39], v11 offset:8192
  v_mul_f32 v107, s24, v107
  v_cvt_pk_bf16_f32 v133, v106, v107
  v_mfma_f32_32x32x16_bf16 v[80:95], a[44:47], v[44:47], v[80:95]
  s_waitcnt lgkmcnt(5)
  v_mul_f32 v108, s24, v108
  v_mul_f32 v109, s24, v109
  v_mfma_f32_32x32x16_bf16 v[64:79], a[48:51], v[48:51], v[64:79]
  s_add_u32 m0, s25, 3072
  ds_read_b128 v[40:43], v12 offset:8192
  v_cvt_pk_bf16_f32 v134, v108, v109
  v_mul_f32 v110, s24, v110
  v_mfma_f32_32x32x16_bf16 v[80:95], a[52:55], v[48:51], v[80:95]
  s_waitcnt lgkmcnt(5)
  buffer_load_dwordx4 v19, s[12:15], s19 offen sc1 lds
  v_mul_f32 v111, s24, v111
  v_cvt_pk_bf16_f32 v135, v110, v111
  v_mfma_f32_32x32x16_bf16 v[64:79], a[56:59], v[52:55], v[64:79]
  ds_read_b128 v[44:47], v13 offset:8192
  v_mul_f32 v112, s24, v112
  v_mul_f32 v113, s24, v113
  v_mfma_f32_32x32x16_bf16 v[80:95], a[60:63], v[52:55], v[80:95]
  s_waitcnt lgkmcnt(5)
  v_cvt_pk_bf16_f32 v136, v112, v113
  v_mul_f32 v114, s24, v114
  v_mfma_f32_32x32x16_bf16 v[64:79], a[64:67], v[24:27], v[64:79]
  s_add_u32 m0, s25, 4096
  ds_read_b128 v[48:51], v14 offset:8192
  v_mul_f32 v115, s24, v115
  v_cvt_pk_bf16_f32 v137, v114, v115
  v_mfma_f32_32x32x16_bf16 v[80:95], a[68:71], v[24:27], v[80:95]
  s_waitcnt lgkmcnt(5)
  buffer_load_dwordx4 v20, s[12:15], s19 offen sc1 lds
  v_mul_f32 v116, s24, v116
  v_mul_f32 v117, s24, v117
  v_mfma_f32_32x32x16_bf16 v[64:79], a[72:75], v[28:31], v[64:79]
  ds_read_b128 v[52:55], v15 offset:8192
  v_cvt_pk_bf16_f32 v138, v116, v117
  v_mul_f32 v118, s24, v118
  v_mfma_f32_32x32x16_bf16 v[80:95], a[76:79], v[28:31], v[80:95]
  s_waitcnt lgkmcnt(5)
  v_mul_f32 v119, s24, v119
  v_cvt_pk_bf16_f32 v139, v118, v119
  v_mfma_f32_32x32x16_bf16 v[64:79], a[80:83], v[32:35], v[64:79]
  s_add_u32 m0, s25, 5120
  ds_read_b128 v[24:27], v8 offset:16384
  v_mul_f32 v120, s24, v120
  v_mul_f32 v121, s24, v121
  v_mfma_f32_32x32x16_bf16 v[80:95], a[84:87], v[32:35], v[80:95]
  s_waitcnt lgkmcnt(5)
  buffer_load_dwordx4 v21, s[12:15], s19 offen sc1 lds
  v_cvt_pk_bf16_f32 v140, v120, v121
  v_mul_f32 v122, s24, v122
  v_mfma_f32_32x32x16_bf16 v[64:79], a[88:91], v[36:39], v[64:79]
  ds_read_b128 v[28:31], v9 offset:16384
  v_mul_f32 v123, s24, v123
  v_cvt_pk_bf16_f32 v141, v122, v123
  v_mfma_f32_32x32x16_bf16 v[80:95], a[92:95], v[36:39], v[80:95]
  s_waitcnt lgkmcnt(5)
  v_mul_f32 v124, s24, v124
  v_mul_f32 v125, s24, v125
  v_mfma_f32_32x32x16_bf16 v[64:79], a[96:99], v[40:43], v[64:79]
  s_add_u32 m0, s25, 6144
  ds_read_b128 v[32:35], v10 offset:16384
  v_cvt_pk_bf16_f32 v142, v124, v125
  v_mul_f32 v126, s24, v126
  v_mfma_f32_32x32x16_bf16 v[80:95], a[100:103], v[40:43], v[80:95]
  s_waitcnt lgkmcnt(5)
  buffer_load_dwordx4 v22, s[12:15], s19 offen sc1 lds
  v_mul_f32 v127, s24, v127
  v_cvt_pk_bf16_f32 v143, v126, v127
  v_mfma_f32_32x32x16_bf16 v[64:79], a[104:107], v[44:47], v[64:79]
  ds_read_b128 v[36:39], v11 offset:16384
  v_mfma_f32_32x32x16_bf16 v[80:95], a[108:111], v[44:47], v[80:95]
  s_waitcnt lgkmcnt(5)
  v_mfma_f32_32x32x16_bf16 v[64:79], a[112:115], v[48:51], v[64:79]
  s_add_u32 m0, s25, 7168
  ds_read_b128 v[40:43], v12 offset:16384
  v_mfma_f32_32x32x16_bf16 v[80:95], a[116:119], v[48:51], v[80:95]
  s_waitcnt lgkmcnt(5)
  buffer_load_dwordx4 v23, s[12:15], s19 offen sc1 lds
  v_mfma_f32_32x32x16_bf16 v[64:79], a[120:123], v[52:55], v[64:79]
  s_cmp_gt_u32 s23, 3
  ds_read_b128 v[44:47], v13 offset:16384
  v_mfma_f32_32x32x16_bf16 v[80:95], a[124:127], v[52:55], v[80:95]
  s_waitcnt lgkmcnt(5)
  s_cselect_b32 s26, s20, 0
  v_mfma_f32_32x32x16_bf16 v[64:79], a[128:131], v[24:27], v[64:79]
  s_add_u32 s19, s19, s26
  ds_read_b128 v[48:51], v14 offset:16384
  v_mfma_f32_32x32x16_bf16 v[80:95], a[132:135], v[24:27], v[80:95]
  s_waitcnt lgkmcnt(5)
  s_add_u32 s25, s25, 32768
  v_mfma_f32_32x32x16_bf16 v[64:79], a[136:139], v[28:31], v[64:79]
  s_and_b32 s25, s25, 0x1ffff
  ds_read_b128 v[52:55], v15 offset:16384
  v_mfma_f32_32x32x16_bf16 v[80:95], a[140:143], v[28:31], v[80:95]
  s_waitcnt lgkmcnt(5)
  buffer_store_dwordx4 v[128:131], v7, s[4:7], s21 offen offset:0 sc1
  v_mfma_f32_32x32x16_bf16 v[64:79], a[144:147], v[32:35], v[64:79]
  ds_read_b128 v[24:27], v8 offset:24576
  v_mfma_f32_32x32x16_bf16 v[80:95], a[148:151], v[32:35], v[80:95]
  s_waitcnt lgkmcnt(5)
  v_mfma_f32_32x32x16_bf16 v[64:79], a[152:155], v[36:39], v[64:79]
  ds_read_b128 v[28:31], v9 offset:24576
  v_mfma_f32_32x32x16_bf16 v[80:95], a[156:159], v[36:39], v[80:95]
  s_waitcnt lgkmcnt(5)
  buffer_store_dwordx4 v[132:135], v7, s[4:7], s21 offen offset:1024 sc1
  v_mfma_f32_32x32x16_bf16 v[64:79], a[160:163], v[40:43], v[64:79]
  ds_read_b128 v[32:35], v10 offset:24576
  v_mfma_f32_32x32x16_bf16 v[80:95], a[164:167], v[40:43], v[80:95]
  s_waitcnt lgkmcnt(5)
  v_mfma_f32_32x32x16_bf16 v[64:79], a[168:171], v[44:47], v[64:79]
  ds_read_b128 v[36:39], v11 offset:24576
  v_mfma_f32_32x32x16_bf16 v[80:95], a[172:175], v[44:47], v[80:95]
  s_waitcnt lgkmcnt(5)
  buffer_store_dwordx4 v[136:139], v7, s[4:7], s21 offen offset:2048 sc1
  v_mfma_f32_32x32x16_bf16 v[64:79], a[176:179], v[48:51], v[64:79]
  ds_read_b128 v[40:43], v12 offset:24576
  v_mfma_f32_32x32x16_bf16 v[80:95], a[180:183], v[48:51], v[80:95]
  s_waitcnt lgkmcnt(5)
  v_mfma_f32_32x32x16_bf16 v[64:79], a[184:187], v[52:55], v[64:79]
  ds_read_b128 v[44:47], v13 offset:24576
  v_mfma_f32_32x32x16_bf16 v[80:95], a[188:191], v[52:55], v[80:95]
  s_waitcnt lgkmcnt(5)
  buffer_store_dwordx4 v[140:143], v7, s[4:7], s21 offen offset:3072 sc1
  v_mfma_f32_32x32x16_bf16 v[64:79], a[192:195], v[24:27], v[64:79]
  s_mov_b32 s21, s27
  ds_read_b128 v[48:51], v14 offset:24576
  v_mov_b32 v7, v2
  v_mfma_f32_32x32x16_bf16 v[80:95], a[196:199], v[24:27], v[80:95]
  s_waitcnt lgkmcnt(5)
  v_mfma_f32_32x32x16_bf16 v[64:79], a[200:203], v[28:31], v[64:79]
  s_add_u32 s27, s27, s22
  ds_read_b128 v[52:55], v15 offset:24576
  v_mfma_f32_32x32x16_bf16 v[80:95], a[204:207], v[28:31], v[80:95]
  s_waitcnt lgkmcnt(5)
  s_waitcnt vmcnt(16)
  s_barrier
  v_mfma_f32_32x32x16_bf16 v[64:79], a[208:211], v[32:35], v[64:79]
  ds_read_b128 v[24:27], v8 offset:32768
  v_mfma_f32_32x32x16_bf16 v[80:95], a[212:215], v[32:35], v[80:95]
  s_waitcnt lgkmcnt(5)
  v_mfma_f32_32x32x16_bf16 v[64:79], a[216:219], v[36:39], v[64:79]
  ds_read_b128 v[28:31], v9 offset:32768
  v_mfma_f32_32x32x16_bf16 v[80:95], a[220:223], v[36:39], v[80:95]
  s_waitcnt lgkmcnt(5)
  v_mfma_f32_32x32x16_bf16 v[64:79], a[224:227], v[40:43], v[64:79]
  ds_read_b128 v[32:35], v10 offset:32768
  v_mfma_f32_32x32x16_bf16 v[80:95], a[228:231], v[40:43], v[80:95]
  s_waitcnt lgkmcnt(5)
  v_mfma_f32_32x32x16_bf16 v[64:79], a[232:235], v[44:47], v[64:79]
  ds_read_b128 v[36:39], v11 offset:32768
  v_mfma_f32_32x32x16_bf16 v[80:95], a[236:239], v[44:47], v[80:95]
  s_waitcnt lgkmcnt(5)
  v_mfma_f32_32x32x16_bf16 v[64:79], a[240:243], v[48:51], v[64:79]
  s_sub_u32 s23, s23, 1
  ds_read_b128 v[40:43], v12 offset:32768
  v_mfma_f32_32x32x16_bf16 v[80:95], a[244:247], v[48:51], v[80:95]
  s_waitcnt lgkmcnt(5)
  v_mfma_f32_32x32x16_bf16 v[64:79], a[248:251], v[52:55], v[64:79]
  s_cmp_eq_u32 s23, 0
  ds_read_b128 v[44:47], v13 offset:32768
  v_mfma_f32_32x32x16_bf16 v[80:95], a[252:255], v[52:55], v[80:95]
  s_cbranch_scc1 G_done0_46
  s_waitcnt lgkmcnt(5)
  v_mfma_f32_32x32x16_bf16 v[96:111], a[0:3], v[24:27], 0
  s_add_u32 m0, s25, 0
  ds_read_b128 v[48:51], v14 offset:32768
  v_mfma_f32_32x32x16_bf16 v[112:127], a[4:7], v[24:27], 0
  s_waitcnt lgkmcnt(5)
  buffer_load_dwordx4 v16, s[12:15], s19 offen sc1 lds
  v_mfma_f32_32x32x16_bf16 v[96:111], a[8:11], v[28:31], v[96:111]
  ds_read_b128 v[52:55], v15 offset:32768
  v_mul_f32 v64, s24, v64
  v_mul_f32 v65, s24, v65
  v_mfma_f32_32x32x16_bf16 v[112:127], a[12:15], v[28:31], v[112:127]
  s_waitcnt lgkmcnt(5)
  v_cvt_pk_bf16_f32 v128, v64, v65
  v_mul_f32 v66, s24, v66
  v_mfma_f32_32x32x16_bf16 v[96:111], a[16:19], v[32:35], v[96:111]
  s_add_u32 m0, s25, 1024
  ds_read_b128 v[24:27], v8 offset:40960
  v_mul_f32 v67, s24, v67
  v_cvt_pk_bf16_f32 v129, v66, v67
  v_mfma_f32_32x32x16_bf16 v[112:127], a[20:23], v[32:35], v[112:127]
  s_waitcnt lgkmcnt(5)
  buffer_load_dwordx4 v17, s[12:15], s19 offen sc1 lds
  v_mul_f32 v68, s24, v68
  v_mul_f32 v69, s24, v69
  v_mfma_f32_32x32x16_bf16 v[96:111], a[24:27], v[36:39], v[96:111]
  ds_read_b128 v[28:31], v9 offset:40960
  v_cvt_pk_bf16_f32 v130, v68, v69
  v_mul_f32 v70, s24, v70
  v_mfma_f32_32x32x16_bf16 v[112:127], a[28:31], v[36:39], v[112:127]
  s_waitcnt lgkmcnt(5)
  v_mul_f32 v71, s24, v71
  v_cvt_pk_bf16_f32 v131, v70, v71
  v_mfma_f32_32x32x16_bf16 v[96:111], a[32:35], v[40:43], v[96:111]
  s_add_u32 m0, s25, 2048
  ds_read_b128 v[32:35], v10 offset:40960
  v_mul_f32 v72, s24, v72
  v_mul_f32 v73, s24, v73
  v_mfma_f32_32x32x16_bf16 v[112:127], a[36:39], v[40:43], v[112:127]
  s_waitcnt lgkmcnt(5)
  buffer_load_dwordx4 v18, s[12:15], s19 offen sc1 lds
  v_cvt_pk_bf16_f32 v132, v72, v73
  v_mul_f32 v74, s24, v74
  v_mfma_f32_32x32x16_bf16 v[96:111], a[40:43], v[44:47], v[96:111]
  ds_read_b128 v[36:39], v11 offset:40960
  v_mul_f32 v75, s24, v75
  v_cvt_pk_bf16_f32 v133, v74, v75
  v_mfma_f32_32x32x16_bf16 v[112:127], a[44:47], v[44:47], v[112:127]
  s_waitcnt lgkmcnt(5)
  v_mul_f32 v76, s24, v76
  v_mul_f32 v77, s24, v77
  v_mfma_f32_32x32x16_bf16 v[96:111], a[48:51], v[48:51], v[96:111]
  s_add_u32 m0, s25, 3072
  ds_read_b128 v[40:43], v12 offset:40960
  v_cvt_pk_bf16_f32 v134, v76, v77
  v_mul_f32 v78, s24, v78
  v_mfma_f32_32x32x16_bf16 v[112:127], a[52:55], v[48:51], v[112:127]
  s_waitcnt lgkmcnt(5)
  buffer_load_dwordx4 v19, s[12:15], s19 offen sc1 lds
  v_mul_f32 v79, s24, v79
  v_cvt_pk_bf16_f32 v135, v78, v79
  v_mfma_f32_32x32x16_bf16 v[96:111], a[56:59], v[52:55], v[96:111]
  ds_read_b128 v[44:47], v13 offset:40960
  v_mul_f32 v80, s24, v80
  v_mul_f32 v81, s24, v81
  v_mfma_f32_32x32x16_bf16 v[112:127], a[60:63], v[52:55], v[112:127]
  s_waitcnt lgkmcnt(5)
  v_cvt_pk_bf16_f32 v136, v80, v81
  v_mul_f32 v82, s24, v82
  v_mfma_f32_32x32x16_bf16 v[96:111], a[64:67], v[24:27], v[96:111]
  s_add_u32 m0, s25, 4096
  ds_read_b128 v[48:51], v14 offset:40960
  v_mul_f32 v83, s24, v83
  v_cvt_pk_bf16_f32 v137, v82, v83
  v_mfma_f32_32x32x16_bf16 v[112:127], a[68:71], v[24:27], v[112:127]
  s_waitcnt lgkmcnt(5)
  buffer_load_dwordx4 v20, s[12:15], s19 offen sc1 lds
  v_mul_f32 v84, s24, v84
  v_mul_f32 v85, s24, v85
  v_mfma_f32_32x32x16_bf16 v[96:111], a[72:75], v[28:31], v[96:111]
  ds_read_b128 v[52:55], v15 offset:40960
  v_cvt_pk_bf16_f32 v138, v84, v85
  v_mul_f32 v86, s24, v86
  v_mfma_f32_32x32x16_bf16 v[112:127], a[76:79], v[28:31], v[112:127]
  s_waitcnt lgkmcnt(5)
  v_mul_f32 v87, s24, v87
  v_cvt_pk_bf16_f32 v139, v86, v87
  v_mfma_f32_32x32x16_bf16 v[96:111], a[80:83], v[32:35], v[96:111]
  s_add_u32 m0, s25, 5120
  ds_read_b128 v[24:27], v8 offset:49152
  v_mul_f32 v88, s24, v88
  v_mul_f32 v89, s24, v89
  v_mfma_f32_32x32x16_bf16 v[112:127], a[84:87], v[32:35], v[112:127]
  s_waitcnt lgkmcnt(5)
  buffer_load_dwordx4 v21, s[12:15], s19 offen sc1 lds
  v_cvt_pk_bf16_f32 v140, v88, v89
  v_mul_f32 v90, s24, v90
  v_mfma_f32_32x32x16_bf16 v[96:111], a[88:91], v[36:39], v[96:111]
  ds_read_b128 v[28:31], v9 offset:49152
  v_mul_f32 v91, s24, v91
  v_cvt_pk_bf16_f32 v141, v90, v91
  v_mfma_f32_32x32x16_bf16 v[112:127], a[92:95], v[36:39], v[112:127]
  s_waitcnt lgkmcnt(5)
  v_mul_f32 v92, s24, v92
  v_mul_f32 v93, s24, v93
  v_mfma_f32_32x32x16_bf16 v[96:111], a[96:99], v[40:43], v[96:111]
  s_add_u32 m0, s25, 6144
  ds_read_b128 v[32:35], v10 offset:49152
  v_cvt_pk_bf16_f32 v142, v92, v93
  v_mul_f32 v94, s24, v94
  v_mfma_f32_32x32x16_bf16 v[112:127], a[100:103], v[40:43], v[112:127]
  s_waitcnt lgkmcnt(5)
  buffer_load_dwordx4 v22, s[12:15], s19 offen sc1 lds
  v_mul_f32 v95, s24, v95
  v_cvt_pk_bf16_f32 v143, v94, v95
  v_mfma_f32_32x32x16_bf16 v[96:111], a[104:107], v[44:47], v[96:111]
  ds_read_b128 v[36:39], v11 offset:49152
  v_mfma_f32_32x32x16_bf16 v[112:127], a[108:111], v[44:47], v[112:127]
  s_waitcnt lgkmcnt(5)
  v_mfma_f32_32x32x16_bf16 v[96:111], a[112:115], v[48:51], v[96:111]
  s_add_u32 m0, s25, 7168
  ds_read_b128 v[40:43], v12 offset:49152
  v_mfma_f32_32x32x16_bf16 v[112:127], a[116:119], v[48:51], v[112:127]
  s_waitcnt lgkmcnt(5)
  buffer_load_dwordx4 v23, s[12:15], s19 offen sc1 lds
  v_mfma_f32_32x32x16_bf16 v[96:111], a[120:123], v[52:55], v[96:111]
  s_cmp_gt_u32 s23, 3
  ds_read_b128 v[44:47], v13 offset:49152
  v_mfma_f32_32x32x16_bf16 v[112:127], a[124:127], v[52:55], v[112:127]
  s_waitcnt lgkmcnt(5)
  s_cselect_b32 s26, s20, 0
  v_mfma_f32_32x32x16_bf16 v[96:111], a[128:131], v[24:27], v[96:111]
  s_add_u32 s19, s19, s26
  ds_read_b128 v[48:51], v14 offset:49152
  v_mfma_f32_32x32x16_bf16 v[112:127], a[132:135], v[24:27], v[112:127]
  s_waitcnt lgkmcnt(5)
  s_add_u32 s25, s25, 32768
  v_mfma_f32_32x32x16_bf16 v[96:111], a[136:139], v[28:31], v[96:111]
  s_and_b32 s25, s25, 0x1ffff
  ds_read_b128 v[52:55], v15 offset:49152
  v_mfma_f32_32x32x16_bf16 v[112:127], a[140:143], v[28:31], v[112:127]
  s_waitcnt lgkmcnt(5)
  buffer_store_dwordx4 v[128:131], v7, s[4:7], s21 offen offset:0 sc1
  v_mfma_f32_32x32x16_bf16 v[96:111], a[144:147], v[32:35], v[96:111]
  ds_read_b128 v[24:27], v8 offset:57344
  v_mfma_f32_32x32x16_bf16 v[112:127], a[148:151], v[32:35], v[112:127]
  s_waitcnt lgkmcnt(5)
  v_xor_b32 v8, 0x10000, v8
  v_mfma_f32_32x32x16_bf16 v[96:111], a[152:155], v[36:39], v[96:111]
  ds_read_b128 v[28:31], v9 offset:57344
  v_mfma_f32_32x32x16_bf16 v[112:127], a[156:159], v[36:39], v[112:127]
  s_waitcnt lgkmcnt(5)
  buffer_store_dwordx4 v[132:135], v7, s[4:7], s21 offen offset:1024 sc1
  v_xor_b32 v9, 0x10000, v9
  v_mfma_f32_32x32x16_bf16 v[96:111], a[160:163], v[40:43], v[96:111]
  ds_read_b128 v[32:35], v10 offset:57344
  v_mfma_f32_32x32x16_bf16 v[112:127], a[164:167], v[40:43], v[112:127]
  s_waitcnt lgkmcnt(5)
  v_xor_b32 v10, 0x10000, v10
  v_mfma_f32_32x32x16_bf16 v[96:111], a[168:171], v[44:47], v[96:111]
  ds_read_b128 v[36:39], v11 offset:57344
  v_mfma_f32_32x32x16_bf16 v[112:127], a[172:175], v[44:47], v[112:127]
  s_waitcnt lgkmcnt(5)
  buffer_store_dwordx4 v[136:139], v7, s[4:7], s21 offen offset:2048 sc1
  v_xor_b32 v11, 0x10000, v11
  v_mfma_f32_32x32x16_bf16 v[96:111], a[176:179], v[48:51], v[96:111]
  ds_read_b128 v[40:43], v12 offset:57344
  v_mfma_f32_32x32x16_bf16 v[112:127], a[180:183], v[48:51], v[112:127]
  s_waitcnt lgkmcnt(5)
  v_xor_b32 v12, 0x10000, v12
  v_mfma_f32_32x32x16_bf16 v[96:111], a[184:187], v[52:55], v[96:111]
  ds_read_b128 v[44:47], v13 offset:57344
  v_mfma_f32_32x32x16_bf16 v[112:127], a[188:191], v[52:55], v[112:127]
  s_waitcnt lgkmcnt(5)
  buffer_store_dwordx4 v[140:143], v7, s[4:7], s21 offen offset:3072 sc1
  v_xor_b32 v13, 0x10000, v13
  v_mfma_f32_32x32x16_bf16 v[96:111], a[192:195], v[24:27], v[96:111]
  s_mov_b32 s21, s27
  ds_read_b128 v[48:51], v14 offset:57344
  v_mov_b32 v7, v2
  v_mfma_f32_32x32x16_bf16 v[112:127], a[196:199], v[24:27], v[112:127]
  s_waitcnt lgkmcnt(5)
  v_xor_b32 v14, 0x10000, v14
  v_mfma_f32_32x32x16_bf16 v[96:111], a[200:203], v[28:31], v[96:111]
  s_add_u32 s27, s27, s22
  ds_read_b128 v[52:55], v15 offset:57344
  v_mfma_f32_32x32x16_bf16 v[112:127], a[204:207], v[28:31], v[112:127]
  s_waitcnt lgkmcnt(5)
  s_waitcnt vmcnt(16)
  s_barrier
  v_xor_b32 v15, 0x10000, v15
  v_mfma_f32_32x32x16_bf16 v[96:111], a[208:211], v[32:35], v[96:111]
  ds_read_b128 v[24:27], v8 offset:0
  v_mfma_f32_32x32x16_bf16 v[112:127], a[212:215], v[32:35], v[112:127]
  s_waitcnt lgkmcnt(5)
  v_mfma_f32_32x32x16_bf16 v[96:111], a[216:219], v[36:39], v[96:111]
  ds_read_b128 v[28:31], v9 offset:0
  v_mfma_f32_32x32x16_bf16 v[112:127], a[220:223], v[36:39], v[112:127]
  s_waitcnt lgkmcnt(5)
  v_mfma_f32_32x32x16_bf16 v[96:111], a[224:227], v[40:43], v[96:111]
  ds_read_b128 v[32:35], v10 offset:0
  v_mfma_f32_32x32x16_bf16 v[112:127], a[228:231], v[40:43], v[112:127]
  s_waitcnt lgkmcnt(5)
  v_mfma_f32_32x32x16_bf16 v[96:111], a[232:235], v[44:47], v[96:111]
  ds_read_b128 v[36:39], v11 offset:0
  v_mfma_f32_32x32x16_bf16 v[112:127], a[236:239], v[44:47], v[112:127]
  s_waitcnt lgkmcnt(5)
  v_mfma_f32_32x32x16_bf16 v[96:111], a[240:243], v[48:51], v[96:111]
  s_sub_u32 s23, s23, 1
  ds_read_b128 v[40:43], v12 offset:0
  v_mfma_f32_32x32x16_bf16 v[112:127], a[244:247], v[48:51], v[112:127]
  s_waitcnt lgkmcnt(5)
  v_mfma_f32_32x32x16_bf16 v[96:111], a[248:251], v[52:55], v[96:111]
  s_cmp_eq_u32 s23, 0
  ds_read_b128 v[44:47], v13 offset:0
  v_mfma_f32_32x32x16_bf16 v[112:127], a[252:255], v[52:55], v[112:127]
  s_cbranch_scc1 G_done1_47
  s_branch G_top_45
G_done0_46:
  s_nop 7
  s_nop 3
  v_mul_f32 v64, s24, v64
  v_mul_f32 v65, s24, v65
  v_cvt_pk_bf16_f32 v128, v64, v65
  v_mul_f32 v66, s24, v66
  v_mul_f32 v67, s24, v67
  v_cvt_pk_bf16_f32 v129, v66, v67
  v_mul_f32 v68, s24, v68
  v_mul_f32 v69, s24, v69
  v_cvt_pk_bf16_f32 v130, v68, v69
  v_mul_f32 v70, s24, v70
  v_mul_f32 v71, s24, v71
  v_cvt_pk_bf16_f32 v131, v70, v71
  buffer_store_dwordx4 v[128:131], v7, s[4:7], s21 offen offset:0 sc1
  v_mul_f32 v72, s24, v72
  v_mul_f32 v73, s24, v73
  v_cvt_pk_bf16_f32 v132, v72, v73
  v_mul_f32 v74, s24, v74
  v_mul_f32 v75, s24, v75
  v_cvt_pk_bf16_f32 v133, v74, v75
  v_mul_f32 v76, s24, v76
  v_mul_f32 v77, s24, v77
  v_cvt_pk_bf16_f32 v134, v76, v77
  v_mul_f32 v78, s24, v78
  v_mul_f32 v79, s24, v79
  v_cvt_pk_bf16_f32 v135, v78, v79
  buffer_store_dwordx4 v[132:135], v7, s[4:7], s21 offen offset:1024 sc1
  v_mul_f32 v80, s24, v80
  v_mul_f32 v81, s24, v81
  v_cvt_pk_bf16_f32 v136, v80, v81
  v_mul_f32 v82, s24, v82
  v_mul_f32 v83, s24, v83
  v_cvt_pk_bf16_f32 v137, v82, v83
  v_mul_f32 v84, s24, v84
  v_mul_f32 v85, s24, v85
  v_cvt_pk_bf16_f32 v138, v84, v85
  v_mul_f32 v86, s24, v86
  v_mul_f32 v87, s24, v87
  v_cvt_pk_bf16_f32 v139, v86, v87
  buffer_store_dwordx4 v[136:139], v7, s[4:7], s21 offen offset:2048 sc1
  v_mul_f32 v88, s24, v88
  v_mul_f32 v89, s24, v89
  v_cvt_pk_bf16_f32 v140, v88, v89
  v_mul_f32 v90, s24, v90
  v_mul_f32 v91, s24, v91
  v_cvt_pk_bf16_f32 v141, v90, v91
  v_mul_f32 v92, s24, v92
  v_mul_f32 v93, s24, v93
  v_cvt_pk_bf16_f32 v142, v92, v93
  v_mul_f32 v94, s24, v94
  v_mul_f32 v95, s24, v95
  v_cvt_pk_bf16_f32 v143, v94, v95
  buffer_store_dwordx4 v[140:143], v7, s[4:7], s21 offen offset:3072 sc1
  s_branch G_fin_48
G_done1_47:
  s_nop 7
  s_nop 3
  v_mul_f32 v96, s24, v96
  v_mul_f32 v97, s24, v97
  v_cvt_pk_bf16_f32 v128, v96, v97
  v_mul_f32 v98, s24, v98
  v_mul_f32 v99, s24, v99
  v_cvt_pk_bf16_f32 v129, v98, v99
  v_mul_f32 v100, s24, v100
  v_mul_f32 v101, s24, v101
  v_cvt_pk_bf16_f32 v130, v100, v101
  v_mul_f32 v102, s24, v102
  v_mul_f32 v103, s24, v103
  v_cvt_pk_bf16_f32 v131, v102, v103
  buffer_store_dwordx4 v[128:131], v7, s[4:7], s21 offen offset:0 sc1
  v_mul_f32 v104, s24, v104
  v_mul_f32 v105, s24, v105
  v_cvt_pk_bf16_f32 v132, v104, v105
  v_mul_f32 v106, s24, v106
  v_mul_f32 v107, s24, v107
  v_cvt_pk_bf16_f32 v133, v106, v107
  v_mul_f32 v108, s24, v108
  v_mul_f32 v109, s24, v109
  v_cvt_pk_bf16_f32 v134, v108, v109
  v_mul_f32 v110, s24, v110
  v_mul_f32 v111, s24, v111
  v_cvt_pk_bf16_f32 v135, v110, v111
  buffer_store_dwordx4 v[132:135], v7, s[4:7], s21 offen offset:1024 sc1
  v_mul_f32 v112, s24, v112
  v_mul_f32 v113, s24, v113
  v_cvt_pk_bf16_f32 v136, v112, v113
  v_mul_f32 v114, s24, v114
  v_mul_f32 v115, s24, v115
  v_cvt_pk_bf16_f32 v137, v114, v115
  v_mul_f32 v116, s24, v116
  v_mul_f32 v117, s24, v117
  v_cvt_pk_bf16_f32 v138, v116, v117
  v_mul_f32 v118, s24, v118
  v_mul_f32 v119, s24, v119
  v_cvt_pk_bf16_f32 v139, v118, v119
  buffer_store_dwordx4 v[136:139], v7, s[4:7], s21 offen offset:2048 sc1
  v_mul_f32 v120, s24, v120
  v_mul_f32 v121, s24, v121
  v_cvt_pk_bf16_f32 v140, v120, v121
  v_mul_f32 v122, s24, v122
  v_mul_f32 v123, s24, v123
  v_cvt_pk_bf16_f32 v141, v122, v123
  v_mul_f32 v124, s24, v124
  v_mul_f32 v125, s24, v125
  v_cvt_pk_bf16_f32 v142, v124, v125
  v_mul_f32 v126, s24, v126
  v_mul_f32 v127, s24, v127
  v_cvt_pk_bf16_f32 v143, v126, v127
  buffer_store_dwordx4 v[140:143], v7, s[4:7], s21 offen offset:3072 sc1
G_fin_48:
  s_waitcnt vmcnt(0) lgkmcnt(0)
  s_barrier
  s_waitcnt vmcnt(0)
  s_barrier
  s_mov_b32 s30, 768
  v_mov_b32 v144, s30
  v_min_u32 v145, 1, v0
  v_lshlrev_b32 v145, 30, v145
  buffer_store_dword v144, v145, s[4:7], s31 offen sc1
  s_mul_i32 s50, s64, 6
  s_add_u32 s50, s50, s65
  s_mul_i32 s76, s50, 21846
  s_lshr_b32 s76, s76, 16
  s_mul_i32 s77, s76, 3
  s_add_u32 s51, s50, 64
  s_cmp_eq_u32 s77, s50
  s_cselect_b32 s50, s76, s51
M_fin:
  s_lshr_b32 s48, s50, 2
  s_and_b32 s49, s50, 3
  s_load_dwordx2 s[8:9], s[0:1], 0
  s_load_dwordx2 s[12:13], s[0:1], 104
  s_load_dwordx2 s[32:33], s[0:1], 112
  v_and_b32 v4, 31, v1
  v_lshrrev_b32 v5, 5, v1
  v_lshlrev_b32 v5, 4, v5
  v_lshl_add_u32 v6, v4, 10, v5
  s_lshl_b32 s26, s16, 8
  s_lshl_b32 s27, s48, 15
  s_add_u32 s27, s27, s26
  s_waitcnt lgkmcnt(0)
  s_and_b32 s9, s9, 0xffff
  s_mov_b32 s10, 2097152
  s_mov_b32 s11, 0x20000
  s_and_b32 s13, s13, 0xffff
  s_mov_b32 s14, 1024
  s_mov_b32 s15, 0x20000
  s_and_b32 s33, s33, 0xffff
  s_mov_b32 s34, 2097152
  s_mov_b32 s35, 0x20000
  buffer_load_dwordx4 v[16:19], v6, s[8:11], s27 offen offset:0
  buffer_load_dwordx4 v[48:51], v5, s[12:15], s26 offen offset:0
  buffer_load_dwordx4 v[20:23], v6, s[8:11], s27 offen offset:32
  buffer_load_dwordx4 v[52:55], v5, s[12:15], s26 offen offset:32
  buffer_load_dwordx4 v[24:27], v6, s[8:11], s27 offen offset:64
  buffer_load_dwordx4 v[56:59], v5, s[12:15], s26 offen offset:64
  buffer_load_dwordx4 v[28:31], v6, s[8:11], s27 offen offset:96
  buffer_load_dwordx4 v[60:63], v5, s[12:15], s26 offen offset:96
  buffer_load_dwordx4 v[32:35], v6, s[8:11], s27 offen offset:128
  buffer_load_dwordx4 v[64:67], v5, s[12:15], s26 offen offset:128
  buffer_load_dwordx4 v[36:39], v6, s[8:11], s27 offen offset:160
  buffer_load_dwordx4 v[68:71], v5, s[12:15], s26 offen offset:160
  buffer_load_dwordx4 v[40:43], v6, s[8:11], s27 offen offset:192
  buffer_load_dwordx4 v[72:75], v5, s[12:15], s26 offen offset:192
  buffer_load_dwordx4 v[44:47], v6, s[8:11], s27 offen offset:224
  buffer_load_dwordx4 v[76:79], v5, s[12:15], s26 offen offset:224
  s_lshl_b32 s28, s48, 2
  s_add_u32 s28, s28, s49
  s_lshl_b32 s28, s28, 2
  s_add_u32 s28, s28, s16
  s_lshl_b32 s28, s28, 11
  s_waitcnt vmcnt(14)
  v_mfma_f32_32x32x16_bf16 v[80:95], v[48:51], v[16:19], 0
  s_waitcnt vmcnt(12)
  v_mfma_f32_32x32x16_bf16 v[80:95], v[52:55], v[20:23], v[80:95]
  s_waitcnt vmcnt(10)
  v_mfma_f32_32x32x16_bf16 v[80:95], v[56:59], v[24:27], v[80:95]
  s_waitcnt vmcnt(8)
  v_mfma_f32_32x32x16_bf16 v[80:95], v[60:63], v[28:31], v[80:95]
  s_waitcnt vmcnt(6)
  v_mfma_f32_32x32x16_bf16 v[80:95], v[64:67], v[32:35], v[80:95]
  s_waitcnt vmcnt(4)
  v_mfma_f32_32x32x16_bf16 v[80:95], v[68:71], v[36:39], v[80:95]
  s_waitcnt vmcnt(2)
  v_mfma_f32_32x32x16_bf16 v[80:95], v[72:75], v[40:43], v[80:95]
  s_waitcnt vmcnt(0)
  v_mfma_f32_32x32x16_bf16 v[80:95], v[76:79], v[44:47], v[80:95]
  s_mul_i32 s76, s48, 43
  s_lshr_b32 s76, s76, 9
  s_mul_i32 s76, s76, 12
  s_sub_u32 s76, s48, s76
  s_cmp_ge_u32 s76, 6
  s_addc_u32 s76, s76, 0
  s_and_b32 s77, s49, 2
  s_mul_i32 s77, s77, 7
  s_add_u32 s76, s76, s77
  v_mov_b32 v193, 0x300
  s_lshl_b32 s76, s76, 7
  s_add_u32 s76, s76, 148897792
  v_and_b32 v192, 7, v1
  v_mul_u32_u24 v192, 3584, v192
  v_add_u32 v192, s76, v192
  s_mov_b32 s71, 0
  s_branch M_vg_50
M_vw_49:
  s_sleep 2
  s_add_u32 s71, s71, 1
  s_cmp_gt_u32 s71, 262144
  s_cbranch_scc1 M_exit
M_vg_50:
  buffer_load_dword v194, v192, s[4:7], 0 offen sc1
  s_waitcnt vmcnt(0)
  v_cmp_lt_u32 vcc, v194, v193
  s_cbranch_vccnz M_vw_49
  s_add_u32 s29, s28, 150994944
  buffer_load_dwordx4 v[96:99], v2, s[4:7], s29 offen offset:0 sc1
  buffer_load_dwordx4 v[100:103], v2, s[4:7], s29 offen offset:1024 sc1
  s_add_u32 s29, s28, 153092096
  buffer_load_dwordx4 v[104:107], v2, s[4:7], s29 offen offset:0 sc1
  buffer_load_dwordx4 v[108:111], v2, s[4:7], s29 offen offset:1024 sc1
  s_add_u32 s29, s28, 155189248
  buffer_load_dwordx4 v[112:115], v2, s[4:7], s29 offen offset:0 sc1
  buffer_load_dwordx4 v[116:119], v2, s[4:7], s29 offen offset:1024 sc1
  s_add_u32 s29, s28, 157286400
  buffer_load_dwordx4 v[120:123], v2, s[4:7], s29 offen offset:0 sc1
  buffer_load_dwordx4 v[124:127], v2, s[4:7], s29 offen offset:1024 sc1
  s_add_u32 s29, s28, 159383552
  buffer_load_dwordx4 v[128:131], v2, s[4:7], s29 offen offset:0 sc1
  buffer_load_dwordx4 v[132:135], v2, s[4:7], s29 offen offset:1024 sc1
  s_add_u32 s29, s28, 161480704
  buffer_load_dwordx4 v[136:139], v2, s[4:7], s29 offen offset:0 sc1
  buffer_load_dwordx4 v[140:143], v2, s[4:7], s29 offen offset:1024 sc1
  s_add_u32 s29, s28, 163577856
  buffer_load_dwordx4 v[144:147], v2, s[4:7], s29 offen offset:0 sc1
  buffer_load_dwordx4 v[148:151], v2, s[4:7], s29 offen offset:1024 sc1
  s_add_u32 s29, s28, 165675008
  buffer_load_dwordx4 v[152:155], v2, s[4:7], s29 offen offset:0 sc1
  buffer_load_dwordx4 v[156:159], v2, s[4:7], s29 offen offset:1024 sc1
  v_lshlrev_b32 v7, 4, v4
  s_lshl_b32 s26, s16, 2
  v_add_u32 v4, s26, v7
  s_barrier
  ds_write_b32 v4, v80
  s_waitcnt lgkmcnt(0)
  s_barrier
  ds_read_b128 v[84:87], v7
  s_waitcnt lgkmcnt(0)
  v_add_f32 v80, v84, v85
  v_add_f32 v81, v86, v87
  v_add_f32 v80, v80, v81
  v_mul_f32 v80, 0xbfb8aa3b, v80
  v_exp_f32 v80, v80
  s_nop 0
  v_add_f32 v80, 1.0, v80
  v_rcp_f32 v80, v80
  s_nop 0
  v_sub_f32 v82, 1.0, v80
  s_waitcnt vmcnt(14)
  v_lshlrev_b32 v160, 16, v96
  v_and_b32 v161, 0xffff0000, v96
  v_lshlrev_b32 v162, 16, v97
  v_and_b32 v163, 0xffff0000, v97
  v_lshlrev_b32 v164, 16, v98
  v_and_b32 v165, 0xffff0000, v98
  v_lshlrev_b32 v166, 16, v99
  v_and_b32 v167, 0xffff0000, v99
  v_lshlrev_b32 v168, 16, v100
  v_and_b32 v169, 0xffff0000, v100
  v_lshlrev_b32 v170, 16, v101
  v_and_b32 v171, 0xffff0000, v101
  v_lshlrev_b32 v172, 16, v102
  v_and_b32 v173, 0xffff0000, v102
  v_lshlrev_b32 v174, 16, v103
  v_and_b32 v175, 0xffff0000, v103
  s_waitcnt vmcnt(12)
  v_lshlrev_b32 v8, 16, v104
  v_and_b32 v9, 0xffff0000, v104
  v_pk_add_f32 v[160:161], v[160:161], v[8:9]
  v_lshlrev_b32 v10, 16, v105
  v_and_b32 v11, 0xffff0000, v105
  v_pk_add_f32 v[162:163], v[162:163], v[10:11]
  v_lshlrev_b32 v12, 16, v106
  v_and_b32 v13, 0xffff0000, v106
  v_pk_add_f32 v[164:165], v[164:165], v[12:13]
  v_lshlrev_b32 v14, 16, v107
  v_and_b32 v15, 0xffff0000, v107
  v_pk_add_f32 v[166:167], v[166:167], v[14:15]
  v_lshlrev_b32 v8, 16, v108
  v_and_b32 v9, 0xffff0000, v108
  v_pk_add_f32 v[168:169], v[168:169], v[8:9]
  v_lshlrev_b32 v10, 16, v109
  v_and_b32 v11, 0xffff0000, v109
  v_pk_add_f32 v[170:171], v[170:171], v[10:11]
  v_lshlrev_b32 v12, 16, v110
  v_and_b32 v13, 0xffff0000, v110
  v_pk_add_f32 v[172:173], v[172:173], v[12:13]
  v_lshlrev_b32 v14, 16, v111
  v_and_b32 v15, 0xffff0000, v111
  v_pk_add_f32 v[174:175], v[174:175], v[14:15]
  s_waitcnt vmcnt(10)
  v_lshlrev_b32 v8, 16, v112
  v_and_b32 v9, 0xffff0000, v112
  v_pk_add_f32 v[160:161], v[160:161], v[8:9]
  v_lshlrev_b32 v10, 16, v113
  v_and_b32 v11, 0xffff0000, v113
  v_pk_add_f32 v[162:163], v[162:163], v[10:11]
  v_lshlrev_b32 v12, 16, v114
  v_and_b32 v13, 0xffff0000, v114
  v_pk_add_f32 v[164:165], v[164:165], v[12:13]
  v_lshlrev_b32 v14, 16, v115
  v_and_b32 v15, 0xffff0000, v115
  v_pk_add_f32 v[166:167], v[166:167], v[14:15]
  v_lshlrev_b32 v8, 16, v116
  v_and_b32 v9, 0xffff0000, v116
  v_pk_add_f32 v[168:169], v[168:169], v[8:9]
  v_lshlrev_b32 v10, 16, v117
  v_and_b32 v11, 0xffff0000, v117
  v_pk_add_f32 v[170:171], v[170:171], v[10:11]
  v_lshlrev_b32 v12, 16, v118
  v_and_b32 v13, 0xffff0000, v118
  v_pk_add_f32 v[172:173], v[172:173], v[12:13]
  v_lshlrev_b32 v14, 16, v119
  v_and_b32 v15, 0xffff0000, v119
  v_pk_add_f32 v[174:175], v[174:175], v[14:15]
  s_waitcnt vmcnt(8)
  v_lshlrev_b32 v8, 16, v120
  v_and_b32 v9, 0xffff0000, v120
  v_pk_add_f32 v[160:161], v[160:161], v[8:9]
  v_lshlrev_b32 v10, 16, v121
  v_and_b32 v11, 0xffff0000, v121
  v_pk_add_f32 v[162:163], v[162:163], v[10:11]
  v_lshlrev_b32 v12, 16, v122
  v_and_b32 v13, 0xffff0000, v122
  v_pk_add_f32 v[164:165], v[164:165], v[12:13]
  v_lshlrev_b32 v14, 16, v123
  v_and_b32 v15, 0xffff0000, v123
  v_pk_add_f32 v[166:167], v[166:167], v[14:15]
  v_lshlrev_b32 v8, 16, v124
  v_and_b32 v9, 0xffff0000, v124
  v_pk_add_f32 v[168:169], v[168:169], v[8:9]
  v_lshlrev_b32 v10, 16, v125
  v_and_b32 v11, 0xffff0000, v125
  v_pk_add_f32 v[170:171], v[170:171], v[10:11]
  v_lshlrev_b32 v12, 16, v126
  v_and_b32 v13, 0xffff0000, v126
  v_pk_add_f32 v[172:173], v[172:173], v[12:13]
  v_lshlrev_b32 v14, 16, v127
  v_and_b32 v15, 0xffff0000, v127
  v_pk_add_f32 v[174:175], v[174:175], v[14:15]
  s_waitcnt vmcnt(6)
  v_lshlrev_b32 v8, 16, v128
  v_and_b32 v9, 0xffff0000, v128
  v_pk_add_f32 v[160:161], v[160:161], v[8:9]
  v_lshlrev_b32 v10, 16, v129
  v_and_b32 v11, 0xffff0000, v129
  v_pk_add_f32 v[162:163], v[162:163], v[10:11]
  v_lshlrev_b32 v12, 16, v130
  v_and_b32 v13, 0xffff0000, v130
  v_pk_add_f32 v[164:165], v[164:165], v[12:13]
  v_lshlrev_b32 v14, 16, v131
  v_and_b32 v15, 0xffff0000, v131
  v_pk_add_f32 v[166:167], v[166:167], v[14:15]
  v_lshlrev_b32 v8, 16, v132
  v_and_b32 v9, 0xffff0000, v132
  v_pk_add_f32 v[168:169], v[168:169], v[8:9]
  v_lshlrev_b32 v10, 16, v133
  v_and_b32 v11, 0xffff0000, v133
  v_pk_add_f32 v[170:171], v[170:171], v[10:11]
  v_lshlrev_b32 v12, 16, v134
  v_and_b32 v13, 0xffff0000, v134
  v_pk_add_f32 v[172:173], v[172:173], v[12:13]
  v_lshlrev_b32 v14, 16, v135
  v_and_b32 v15, 0xffff0000, v135
  v_pk_add_f32 v[174:175], v[174:175], v[14:15]
  s_waitcnt vmcnt(4)
  v_lshlrev_b32 v8, 16, v136
  v_and_b32 v9, 0xffff0000, v136
  v_pk_add_f32 v[160:161], v[160:161], v[8:9]
  v_lshlrev_b32 v10, 16, v137
  v_and_b32 v11, 0xffff0000, v137
  v_pk_add_f32 v[162:163], v[162:163], v[10:11]
  v_lshlrev_b32 v12, 16, v138
  v_and_b32 v13, 0xffff0000, v138
  v_pk_add_f32 v[164:165], v[164:165], v[12:13]
  v_lshlrev_b32 v14, 16, v139
  v_and_b32 v15, 0xffff0000, v139
  v_pk_add_f32 v[166:167], v[166:167], v[14:15]
  v_lshlrev_b32 v8, 16, v140
  v_and_b32 v9, 0xffff0000, v140
  v_pk_add_f32 v[168:169], v[168:169], v[8:9]
  v_lshlrev_b32 v10, 16, v141
  v_and_b32 v11, 0xffff0000, v141
  v_pk_add_f32 v[170:171], v[170:171], v[10:11]
  v_lshlrev_b32 v12, 16, v142
  v_and_b32 v13, 0xffff0000, v142
  v_pk_add_f32 v[172:173], v[172:173], v[12:13]
  v_lshlrev_b32 v14, 16, v143
  v_and_b32 v15, 0xffff0000, v143
  v_pk_add_f32 v[174:175], v[174:175], v[14:15]
  s_waitcnt vmcnt(2)
  v_lshlrev_b32 v8, 16, v144
  v_and_b32 v9, 0xffff0000, v144
  v_pk_add_f32 v[160:161], v[160:161], v[8:9]
  v_lshlrev_b32 v10, 16, v145
  v_and_b32 v11, 0xffff0000, v145
  v_pk_add_f32 v[162:163], v[162:163], v[10:11]
  v_lshlrev_b32 v12, 16, v146
  v_and_b32 v13, 0xffff0000, v146
  v_pk_add_f32 v[164:165], v[164:165], v[12:13]
  v_lshlrev_b32 v14, 16, v147
  v_and_b32 v15, 0xffff0000, v147
  v_pk_add_f32 v[166:167], v[166:167], v[14:15]
  v_lshlrev_b32 v8, 16, v148
  v_and_b32 v9, 0xffff0000, v148
  v_pk_add_f32 v[168:169], v[168:169], v[8:9]
  v_lshlrev_b32 v10, 16, v149
  v_and_b32 v11, 0xffff0000, v149
  v_pk_add_f32 v[170:171], v[170:171], v[10:11]
  v_lshlrev_b32 v12, 16, v150
  v_and_b32 v13, 0xffff0000, v150
  v_pk_add_f32 v[172:173], v[172:173], v[12:13]
  v_lshlrev_b32 v14, 16, v151
  v_and_b32 v15, 0xffff0000, v151
  v_pk_add_f32 v[174:175], v[174:175], v[14:15]
  s_waitcnt vmcnt(0)
  v_lshlrev_b32 v8, 16, v152
  v_and_b32 v9, 0xffff0000, v152
  v_pk_add_f32 v[160:161], v[160:161], v[8:9]
  v_lshlrev_b32 v10, 16, v153
  v_and_b32 v11, 0xffff0000, v153
  v_pk_add_f32 v[162:163], v[162:163], v[10:11]
  v_lshlrev_b32 v12, 16, v154
  v_and_b32 v13, 0xffff0000, v154
  v_pk_add_f32 v[164:165], v[164:165], v[12:13]
  v_lshlrev_b32 v14, 16, v155
  v_and_b32 v15, 0xffff0000, v155
  v_pk_add_f32 v[166:167], v[166:167], v[14:15]
  v_lshlrev_b32 v8, 16, v156
  v_and_b32 v9, 0xffff0000, v156
  v_pk_add_f32 v[168:169], v[168:169], v[8:9]
  v_lshlrev_b32 v10, 16, v157
  v_and_b32 v11, 0xffff0000, v157
  v_pk_add_f32 v[170:171], v[170:171], v[10:11]
  v_lshlrev_b32 v12, 16, v158
  v_and_b32 v13, 0xffff0000, v158
  v_pk_add_f32 v[172:173], v[172:173], v[12:13]
  v_lshlrev_b32 v14, 16, v159
  v_and_b32 v15, 0xffff0000, v159
  v_pk_add_f32 v[174:175], v[174:175], v[14:15]
  s_and_b32 s76, s48, 1
  s_lshl_b32 s76, s76, 1
  s_lshr_b32 s77, s49, 1
  s_add_u32 s76, s76, s77
  s_mul_i32 s76, s76, 7
  s_add_u32 s76, s76, 6
  s_lshr_b32 s77, s48, 1
  s_add_u32 s77, s77, 0x201
  v_mov_b32 v193, s77
  s_lshl_b32 s76, s76, 7
  s_add_u32 s76, s76, 148897792
  v_and_b32 v192, 7, v1
  v_mul_u32_u24 v192, 3584, v192
  v_add_u32 v192, s76, v192
  s_mov_b32 s71, 0
  s_branch M_vg_52
M_vw_51:
  s_sleep 2
  s_add_u32 s71, s71, 1
  s_cmp_gt_u32 s71, 262144
  s_cbranch_scc1 M_exit
M_vg_52:
  buffer_load_dword v194, v192, s[4:7], 0 offen sc1
  s_waitcnt vmcnt(0)
  v_cmp_lt_u32 vcc, v194, v193
  s_cbranch_vccnz M_vw_51
  s_add_u32 s29, s28, 167772160
  buffer_load_dwordx4 v[96:99], v2, s[4:7], s29 offen offset:0 sc1
  buffer_load_dwordx4 v[100:103], v2, s[4:7], s29 offen offset:1024 sc1
  s_add_u32 s29, s28, 169869312
  buffer_load_dwordx4 v[104:107], v2, s[4:7], s29 offen offset:0 sc1
  buffer_load_dwordx4 v[108:111], v2, s[4:7], s29 offen offset:1024 sc1
  s_add_u32 s29, s28, 171966464
  buffer_load_dwordx4 v[112:115], v2, s[4:7], s29 offen offset:0 sc1
  buffer_load_dwordx4 v[116:119], v2, s[4:7], s29 offen offset:1024 sc1
  s_add_u32 s29, s28, 174063616
  buffer_load_dwordx4 v[120:123], v2, s[4:7], s29 offen offset:0 sc1
  buffer_load_dwordx4 v[124:127], v2, s[4:7], s29 offen offset:1024 sc1
  s_add_u32 s29, s28, 176160768
  buffer_load_dwordx4 v[128:131], v2, s[4:7], s29 offen offset:0 sc1
  buffer_load_dwordx4 v[132:135], v2, s[4:7], s29 offen offset:1024 sc1
  s_add_u32 s29, s28, 178257920
  buffer_load_dwordx4 v[136:139], v2, s[4:7], s29 offen offset:0 sc1
  buffer_load_dwordx4 v[140:143], v2, s[4:7], s29 offen offset:1024 sc1
  s_add_u32 s29, s28, 180355072
  buffer_load_dwordx4 v[144:147], v2, s[4:7], s29 offen offset:0 sc1
  buffer_load_dwordx4 v[148:151], v2, s[4:7], s29 offen offset:1024 sc1
  s_add_u32 s29, s28, 182452224
  buffer_load_dwordx4 v[152:155], v2, s[4:7], s29 offen offset:0 sc1
  buffer_load_dwordx4 v[156:159], v2, s[4:7], s29 offen offset:1024 sc1
  v_pk_mul_f32 v[160:161], v[160:161], v[80:81] op_sel_hi:[1,0]
  v_pk_mul_f32 v[162:163], v[162:163], v[80:81] op_sel_hi:[1,0]
  v_pk_mul_f32 v[164:165], v[164:165], v[80:81] op_sel_hi:[1,0]
  v_pk_mul_f32 v[166:167], v[166:167], v[80:81] op_sel_hi:[1,0]
  v_pk_mul_f32 v[168:169], v[168:169], v[80:81] op_sel_hi:[1,0]
  v_pk_mul_f32 v[170:171], v[170:171], v[80:81] op_sel_hi:[1,0]
  v_pk_mul_f32 v[172:173], v[172:173], v[80:81] op_sel_hi:[1,0]
  v_pk_mul_f32 v[174:175], v[174:175], v[80:81] op_sel_hi:[1,0]
  s_waitcnt vmcnt(14)
  v_lshlrev_b32 v176, 16, v96
  v_and_b32 v177, 0xffff0000, v96
  v_lshlrev_b32 v178, 16, v97
  v_and_b32 v179, 0xffff0000, v97
  v_lshlrev_b32 v180, 16, v98
  v_and_b32 v181, 0xffff0000, v98
  v_lshlrev_b32 v182, 16, v99
  v_and_b32 v183, 0xffff0000, v99
  v_lshlrev_b32 v184, 16, v100
  v_and_b32 v185, 0xffff0000, v100
  v_lshlrev_b32 v186, 16, v101
  v_and_b32 v187, 0xffff0000, v101
  v_lshlrev_b32 v188, 16, v102
  v_and_b32 v189, 0xffff0000, v102
  v_lshlrev_b32 v190, 16, v103
  v_and_b32 v191, 0xffff0000, v103
  s_waitcnt vmcnt(12)
  v_lshlrev_b32 v8, 16, v104
  v_and_b32 v9, 0xffff0000, v104
  v_pk_add_f32 v[176:177], v[176:177], v[8:9]
  v_lshlrev_b32 v10, 16, v105
  v_and_b32 v11, 0xffff0000, v105
  v_pk_add_f32 v[178:179], v[178:179], v[10:11]
  v_lshlrev_b32 v12, 16, v106
  v_and_b32 v13, 0xffff0000, v106
  v_pk_add_f32 v[180:181], v[180:181], v[12:13]
  v_lshlrev_b32 v14, 16, v107
  v_and_b32 v15, 0xffff0000, v107
  v_pk_add_f32 v[182:183], v[182:183], v[14:15]
  v_lshlrev_b32 v8, 16, v108
  v_and_b32 v9, 0xffff0000, v108
  v_pk_add_f32 v[184:185], v[184:185], v[8:9]
  v_lshlrev_b32 v10, 16, v109
  v_and_b32 v11, 0xffff0000, v109
  v_pk_add_f32 v[186:187], v[186:187], v[10:11]
  v_lshlrev_b32 v12, 16, v110
  v_and_b32 v13, 0xffff0000, v110
  v_pk_add_f32 v[188:189], v[188:189], v[12:13]
  v_lshlrev_b32 v14, 16, v111
  v_and_b32 v15, 0xffff0000, v111
  v_pk_add_f32 v[190:191], v[190:191], v[14:15]
  s_waitcnt vmcnt(10)
  v_lshlrev_b32 v8, 16, v112
  v_and_b32 v9, 0xffff0000, v112
  v_pk_add_f32 v[176:177], v[176:177], v[8:9]
  v_lshlrev_b32 v10, 16, v113
  v_and_b32 v11, 0xffff0000, v113
  v_pk_add_f32 v[178:179], v[178:179], v[10:11]
  v_lshlrev_b32 v12, 16, v114
  v_and_b32 v13, 0xffff0000, v114
  v_pk_add_f32 v[180:181], v[180:181], v[12:13]
  v_lshlrev_b32 v14, 16, v115
  v_and_b32 v15, 0xffff0000, v115
  v_pk_add_f32 v[182:183], v[182:183], v[14:15]
  v_lshlrev_b32 v8, 16, v116
  v_and_b32 v9, 0xffff0000, v116
  v_pk_add_f32 v[184:185], v[184:185], v[8:9]
  v_lshlrev_b32 v10, 16, v117
  v_and_b32 v11, 0xffff0000, v117
  v_pk_add_f32 v[186:187], v[186:187], v[10:11]
  v_lshlrev_b32 v12, 16, v118
  v_and_b32 v13, 0xffff0000, v118
  v_pk_add_f32 v[188:189], v[188:189], v[12:13]
  v_lshlrev_b32 v14, 16, v119
  v_and_b32 v15, 0xffff0000, v119
  v_pk_add_f32 v[190:191], v[190:191], v[14:15]
  s_waitcnt vmcnt(8)
  v_lshlrev_b32 v8, 16, v120
  v_and_b32 v9, 0xffff0000, v120
  v_pk_add_f32 v[176:177], v[176:177], v[8:9]
  v_lshlrev_b32 v10, 16, v121
  v_and_b32 v11, 0xffff0000, v121
  v_pk_add_f32 v[178:179], v[178:179], v[10:11]
  v_lshlrev_b32 v12, 16, v122
  v_and_b32 v13, 0xffff0000, v122
  v_pk_add_f32 v[180:181], v[180:181], v[12:13]
  v_lshlrev_b32 v14, 16, v123
  v_and_b32 v15, 0xffff0000, v123
  v_pk_add_f32 v[182:183], v[182:183], v[14:15]
  v_lshlrev_b32 v8, 16, v124
  v_and_b32 v9, 0xffff0000, v124
  v_pk_add_f32 v[184:185], v[184:185], v[8:9]
  v_lshlrev_b32 v10, 16, v125
  v_and_b32 v11, 0xffff0000, v125
  v_pk_add_f32 v[186:187], v[186:187], v[10:11]
  v_lshlrev_b32 v12, 16, v126
  v_and_b32 v13, 0xffff0000, v126
  v_pk_add_f32 v[188:189], v[188:189], v[12:13]
  v_lshlrev_b32 v14, 16, v127
  v_and_b32 v15, 0xffff0000, v127
  v_pk_add_f32 v[190:191], v[190:191], v[14:15]
  s_waitcnt vmcnt(6)
  v_lshlrev_b32 v8, 16, v128
  v_and_b32 v9, 0xffff0000, v128
  v_pk_add_f32 v[176:177], v[176:177], v[8:9]
  v_lshlrev_b32 v10, 16, v129
  v_and_b32 v11, 0xffff0000, v129
  v_pk_add_f32 v[178:179], v[178:179], v[10:11]
  v_lshlrev_b32 v12, 16, v130
  v_and_b32 v13, 0xffff0000, v130
  v_pk_add_f32 v[180:181], v[180:181], v[12:13]
  v_lshlrev_b32 v14, 16, v131
  v_and_b32 v15, 0xffff0000, v131
  v_pk_add_f32 v[182:183], v[182:183], v[14:15]
  v_lshlrev_b32 v8, 16, v132
  v_and_b32 v9, 0xffff0000, v132
  v_pk_add_f32 v[184:185], v[184:185], v[8:9]
  v_lshlrev_b32 v10, 16, v133
  v_and_b32 v11, 0xffff0000, v133
  v_pk_add_f32 v[186:187], v[186:187], v[10:11]
  v_lshlrev_b32 v12, 16, v134
  v_and_b32 v13, 0xffff0000, v134
  v_pk_add_f32 v[188:189], v[188:189], v[12:13]
  v_lshlrev_b32 v14, 16, v135
  v_and_b32 v15, 0xffff0000, v135
  v_pk_add_f32 v[190:191], v[190:191], v[14:15]
  s_waitcnt vmcnt(4)
  v_lshlrev_b32 v8, 16, v136
  v_and_b32 v9, 0xffff0000, v136
  v_pk_add_f32 v[176:177], v[176:177], v[8:9]
  v_lshlrev_b32 v10, 16, v137
  v_and_b32 v11, 0xffff0000, v137
  v_pk_add_f32 v[178:179], v[178:179], v[10:11]
  v_lshlrev_b32 v12, 16, v138
  v_and_b32 v13, 0xffff0000, v138
  v_pk_add_f32 v[180:181], v[180:181], v[12:13]
  v_lshlrev_b32 v14, 16, v139
  v_and_b32 v15, 0xffff0000, v139
  v_pk_add_f32 v[182:183], v[182:183], v[14:15]
  v_lshlrev_b32 v8, 16, v140
  v_and_b32 v9, 0xffff0000, v140
  v_pk_add_f32 v[184:185], v[184:185], v[8:9]
  v_lshlrev_b32 v10, 16, v141
  v_and_b32 v11, 0xffff0000, v141
  v_pk_add_f32 v[186:187], v[186:187], v[10:11]
  v_lshlrev_b32 v12, 16, v142
  v_and_b32 v13, 0xffff0000, v142
  v_pk_add_f32 v[188:189], v[188:189], v[12:13]
  v_lshlrev_b32 v14, 16, v143
  v_and_b32 v15, 0xffff0000, v143
  v_pk_add_f32 v[190:191], v[190:191], v[14:15]
  s_waitcnt vmcnt(2)
  v_lshlrev_b32 v8, 16, v144
  v_and_b32 v9, 0xffff0000, v144
  v_pk_add_f32 v[176:177], v[176:177], v[8:9]
  v_lshlrev_b32 v10, 16, v145
  v_and_b32 v11, 0xffff0000, v145
  v_pk_add_f32 v[178:179], v[178:179], v[10:11]
  v_lshlrev_b32 v12, 16, v146
  v_and_b32 v13, 0xffff0000, v146
  v_pk_add_f32 v[180:181], v[180:181], v[12:13]
  v_lshlrev_b32 v14, 16, v147
  v_and_b32 v15, 0xffff0000, v147
  v_pk_add_f32 v[182:183], v[182:183], v[14:15]
  v_lshlrev_b32 v8, 16, v148
  v_and_b32 v9, 0xffff0000, v148
  v_pk_add_f32 v[184:185], v[184:185], v[8:9]
  v_lshlrev_b32 v10, 16, v149
  v_and_b32 v11, 0xffff0000, v149
  v_pk_add_f32 v[186:187], v[186:187], v[10:11]
  v_lshlrev_b32 v12, 16, v150
  v_and_b32 v13, 0xffff0000, v150
  v_pk_add_f32 v[188:189], v[188:189], v[12:13]
  v_lshlrev_b32 v14, 16, v151
  v_and_b32 v15, 0xffff0000, v151
  v_pk_add_f32 v[190:191], v[190:191], v[14:15]
  s_waitcnt vmcnt(0)
  v_lshlrev_b32 v8, 16, v152
  v_and_b32 v9, 0xffff0000, v152
  v_pk_add_f32 v[176:177], v[176:177], v[8:9]
  v_lshlrev_b32 v10, 16, v153
  v_and_b32 v11, 0xffff0000, v153
  v_pk_add_f32 v[178:179], v[178:179], v[10:11]
  v_lshlrev_b32 v12, 16, v154
  v_and_b32 v13, 0xffff0000, v154
  v_pk_add_f32 v[180:181], v[180:181], v[12:13]
  v_lshlrev_b32 v14, 16, v155
  v_and_b32 v15, 0xffff0000, v155
  v_pk_add_f32 v[182:183], v[182:183], v[14:15]
  v_lshlrev_b32 v8, 16, v156
  v_and_b32 v9, 0xffff0000, v156
  v_pk_add_f32 v[184:185], v[184:185], v[8:9]
  v_lshlrev_b32 v10, 16, v157
  v_and_b32 v11, 0xffff0000, v157
  v_pk_add_f32 v[186:187], v[186:187], v[10:11]
  v_lshlrev_b32 v12, 16, v158
  v_and_b32 v13, 0xffff0000, v158
  v_pk_add_f32 v[188:189], v[188:189], v[12:13]
  v_lshlrev_b32 v14, 16, v159
  v_and_b32 v15, 0xffff0000, v159
  v_pk_add_f32 v[190:191], v[190:191], v[14:15]
  v_pk_fma_f32 v[160:161], v[176:177], v[82:83], v[160:161] op_sel_hi:[1,0,1]
  v_cvt_pk_bf16_f32 v16, v160, v161
  v_pk_fma_f32 v[162:163], v[178:179], v[82:83], v[162:163] op_sel_hi:[1,0,1]
  v_cvt_pk_bf16_f32 v17, v162, v163
  v_pk_fma_f32 v[164:165], v[180:181], v[82:83], v[164:165] op_sel_hi:[1,0,1]
  v_cvt_pk_bf16_f32 v18, v164, v165
  v_pk_fma_f32 v[166:167], v[182:183], v[82:83], v[166:167] op_sel_hi:[1,0,1]
  v_cvt_pk_bf16_f32 v19, v166, v167
  v_pk_fma_f32 v[168:169], v[184:185], v[82:83], v[168:169] op_sel_hi:[1,0,1]
  v_cvt_pk_bf16_f32 v20, v168, v169
  v_pk_fma_f32 v[170:171], v[186:187], v[82:83], v[170:171] op_sel_hi:[1,0,1]
  v_cvt_pk_bf16_f32 v21, v170, v171
  v_pk_fma_f32 v[172:173], v[188:189], v[82:83], v[172:173] op_sel_hi:[1,0,1]
  v_cvt_pk_bf16_f32 v22, v172, v173
  v_pk_fma_f32 v[174:175], v[190:191], v[82:83], v[174:175] op_sel_hi:[1,0,1]
  v_cvt_pk_bf16_f32 v23, v174, v175
  s_lshl_b32 s26, s49, 2
  s_add_u32 s26, s26, s16
  s_lshl_b32 s26, s26, 6
  s_lshl_b32 s27, s48, 15
  s_add_u32 s26, s26, s27
  buffer_store_dwordx4 v[16:19], v6, s[32:35], s26 offen offset:0
  buffer_store_dwordx4 v[20:23], v6, s[32:35], s26 offen offset:32
  s_cmp_lt_u32 s50, 64
  s_mov_b32 s50, s51
  s_cbranch_scc1 M_fin
  s_branch M_done
M_follow:
  s_lshr_b32 s48, s64, 2
  s_and_b32 s49, s64, 1
  s_bfe_u32 s50, s64, 0x10001
  s_mov_b32 s51, 2
  s_mov_b32 s23, 32
  s_load_dwordx2 s[8:9], s[0:1], 88
  s_lshl_b32 s17, s48, 19
  s_lshl_b32 s26, s49, 2
  s_add_u32 s26, s26, s16
  s_lshl_b32 s27, s26, 7
  s_add_u32 s17, s17, s27
  s_mov_b32 s18, 1024
  s_lshl_b32 s21, s48, 6
  s_add_u32 s21, s21, s50
  s_lshl_b32 s21, s21, 3
  s_add_u32 s21, s21, s26
  s_lshl_b32 s21, s21, 12
  s_add_u32 s21, s21, 167772160
  s_lshl_b32 s22, s51, 15
  s_mov_b32 s24, 1.0
  s_waitcnt lgkmcnt(0)
  s_and_b32 s9, s9, 0xffff
  s_mov_b32 s10, 4194304
  s_mov_b32 s11, 0x20000
  s_mul_i32 s26, s16, 0
  v_add_u32 v8, 0, v2
  v_add_u32 v16, s26, v8
  v_add_u32 v9, 1024, v2
  v_add_u32 v17, s26, v9
  v_add_u32 v10, 2048, v2
  v_add_u32 v18, s26, v10
  v_add_u32 v11, 3072, v2
  v_add_u32 v19, s26, v11
  v_add_u32 v12, 4096, v2
  v_add_u32 v20, s26, v12
  v_add_u32 v13, 5120, v2
  v_add_u32 v21, s26, v13
  v_add_u32 v14, 6144, v2
  v_add_u32 v22, s26, v14
  v_add_u32 v15, 7168, v2
  v_add_u32 v23, s26, v15
  v_lshrrev_b32 v144, 3, v1
  v_mul_lo_u32 v144, v144, s18
  v_and_b32 v145, 7, v1
  v_lshl_add_u32 v144, v145, 4, v144
  s_lshl_b32 s28, s16, 15
  s_add_u32 s28, s28, 32768
  s_lshl_b32 s29, s18, 3
  s_add_u32 m0, s28, 0
  s_nop 0
  buffer_load_dwordx4 v144, s[8:11], s17 offen lds
  s_add_u32 s17, s17, s29
  s_add_u32 m0, s28, 1024
  s_nop 0
  buffer_load_dwordx4 v144, s[8:11], s17 offen lds
  s_add_u32 s17, s17, s29
  s_add_u32 m0, s28, 2048
  s_nop 0
  buffer_load_dwordx4 v144, s[8:11], s17 offen lds
  s_add_u32 s17, s17, s29
  s_add_u32 m0, s28, 3072
  s_nop 0
  buffer_load_dwordx4 v144, s[8:11], s17 offen lds
  s_add_u32 s17, s17, s29
  s_add_u32 m0, s28, 4096
  s_nop 0
  buffer_load_dwordx4 v144, s[8:11], s17 offen lds
  s_add_u32 s17, s17, s29
  s_add_u32 m0, s28, 5120
  s_nop 0
  buffer_load_dwordx4 v144, s[8:11], s17 offen lds
  s_add_u32 s17, s17, s29
  s_add_u32 m0, s28, 6144
  s_nop 0
  buffer_load_dwordx4 v144, s[8:11], s17 offen lds
  s_add_u32 s17, s17, s29
  s_add_u32 m0, s28, 7168
  s_nop 0
  buffer_load_dwordx4 v144, s[8:11], s17 offen lds
  s_add_u32 s17, s17, s29
  s_add_u32 m0, s28, 8192
  s_nop 0
  buffer_load_dwordx4 v144, s[8:11], s17 offen lds
  s_add_u32 s17, s17, s29
  s_add_u32 m0, s28, 9216
  s_nop 0
  buffer_load_dwordx4 v144, s[8:11], s17 offen lds
  s_add_u32 s17, s17, s29
  s_add_u32 m0, s28, 10240
  s_nop 0
  buffer_load_dwordx4 v144, s[8:11], s17 offen lds
  s_add_u32 s17, s17, s29
  s_add_u32 m0, s28, 11264
  s_nop 0
  buffer_load_dwordx4 v144, s[8:11], s17 offen lds
  s_add_u32 s17, s17, s29
  s_add_u32 m0, s28, 12288
  s_nop 0
  buffer_load_dwordx4 v144, s[8:11], s17 offen lds
  s_add_u32 s17, s17, s29
  s_add_u32 m0, s28, 13312
  s_nop 0
  buffer_load_dwordx4 v144, s[8:11], s17 offen lds
  s_add_u32 s17, s17, s29
  s_add_u32 m0, s28, 14336
  s_nop 0
  buffer_load_dwordx4 v144, s[8:11], s17 offen lds
  s_add_u32 s17, s17, s29
  s_add_u32 m0, s28, 15360
  s_nop 0
  buffer_load_dwordx4 v144, s[8:11], s17 offen lds
  s_add_u32 s17, s17, s29
  s_add_u32 m0, s28, 16384
  s_nop 0
  buffer_load_dwordx4 v144, s[8:11], s17 offen lds
  s_add_u32 s17, s17, s29
  s_add_u32 m0, s28, 17408
  s_nop 0
  buffer_load_dwordx4 v144, s[8:11], s17 offen lds
  s_add_u32 s17, s17, s29
  s_add_u32 m0, s28, 18432
  s_nop 0
  buffer_load_dwordx4 v144, s[8:11], s17 offen lds
  s_add_u32 s17, s17, s29
  s_add_u32 m0, s28, 19456
  s_nop 0
  buffer_load_dwordx4 v144, s[8:11], s17 offen lds
  s_add_u32 s17, s17, s29
  s_add_u32 m0, s28, 20480
  s_nop 0
  buffer_load_dwordx4 v144, s[8:11], s17 offen lds
  s_add_u32 s17, s17, s29
  s_add_u32 m0, s28, 21504
  s_nop 0
  buffer_load_dwordx4 v144, s[8:11], s17 offen lds
  s_add_u32 s17, s17, s29
  s_add_u32 m0, s28, 22528
  s_nop 0
  buffer_load_dwordx4 v144, s[8:11], s17 offen lds
  s_add_u32 s17, s17, s29
  s_add_u32 m0, s28, 23552
  s_nop 0
  buffer_load_dwordx4 v144, s[8:11], s17 offen lds
  s_add_u32 s17, s17, s29
  s_add_u32 m0, s28, 24576
  s_nop 0
  buffer_load_dwordx4 v144, s[8:11], s17 offen lds
  s_add_u32 s17, s17, s29
  s_add_u32 m0, s28, 25600
  s_nop 0
  buffer_load_dwordx4 v144, s[8:11], s17 offen lds
  s_add_u32 s17, s17, s29
  s_add_u32 m0, s28, 26624
  s_nop 0
  buffer_load_dwordx4 v144, s[8:11], s17 offen lds
  s_add_u32 s17, s17, s29
  s_add_u32 m0, s28, 27648
  s_nop 0
  buffer_load_dwordx4 v144, s[8:11], s17 offen lds
  s_add_u32 s17, s17, s29
  s_add_u32 m0, s28, 28672
  s_nop 0
  buffer_load_dwordx4 v144, s[8:11], s17 offen lds
  s_add_u32 s17, s17, s29
  s_add_u32 m0, s28, 29696
  s_nop 0
  buffer_load_dwordx4 v144, s[8:11], s17 offen lds
  s_add_u32 s17, s17, s29
  s_add_u32 m0, s28, 30720
  s_nop 0
  buffer_load_dwordx4 v144, s[8:11], s17 offen lds
  s_add_u32 s17, s17, s29
  s_add_u32 m0, s28, 31744
  s_nop 0
  buffer_load_dwordx4 v144, s[8:11], s17 offen lds
  s_add_u32 s17, s17, s29
  v_bfe_u32 v148, v1, 2, 2
  v_lshrrev_b32 v149, 5, v1
  v_lshl_add_u32 v148, v149, 2, v148
  v_lshlrev_b32 v148, 7, v148
  v_bfe_u32 v149, v1, 4, 1
  v_lshl_add_u32 v148, v149, 5, v148
  v_and_b32 v149, 1, v1
  v_lshl_add_u32 v148, v149, 4, v148
  v_bfe_u32 v149, v1, 1, 1
  v_lshl_add_u32 v148, v149, 3, v148
  v_add_u32 v146, s28, v148
  v_add_u32 v147, 1024, v146
  s_waitcnt vmcnt(28)
  ds_read_b64_tr_b16 a[0:1], v146 offset:0
  ds_read_b64_tr_b16 a[2:3], v147 offset:0
  ds_read_b64_tr_b16 a[4:5], v146 offset:64
  ds_read_b64_tr_b16 a[6:7], v147 offset:64
  ds_read_b64_tr_b16 a[8:9], v146 offset:2048
  ds_read_b64_tr_b16 a[10:11], v147 offset:2048
  ds_read_b64_tr_b16 a[12:13], v146 offset:2112
  ds_read_b64_tr_b16 a[14:15], v147 offset:2112
  s_waitcnt lgkmcnt(0)
  s_add_u32 m0, s28, 0
  s_nop 0
  buffer_load_dwordx4 v144, s[8:11], s17 offen lds
  s_add_u32 s17, s17, s29
  s_add_u32 m0, s28, 1024
  s_nop 0
  buffer_load_dwordx4 v144, s[8:11], s17 offen lds
  s_add_u32 s17, s17, s29
  s_add_u32 m0, s28, 2048
  s_nop 0
  buffer_load_dwordx4 v144, s[8:11], s17 offen lds
  s_add_u32 s17, s17, s29
  s_add_u32 m0, s28, 3072
  s_nop 0
  buffer_load_dwordx4 v144, s[8:11], s17 offen lds
  s_add_u32 s17, s17, s29
  s_waitcnt vmcnt(28)
  ds_read_b64_tr_b16 a[16:17], v146 offset:4096
  ds_read_b64_tr_b16 a[18:19], v147 offset:4096
  ds_read_b64_tr_b16 a[20:21], v146 offset:4160
  ds_read_b64_tr_b16 a[22:23], v147 offset:4160
  ds_read_b64_tr_b16 a[24:25], v146 offset:6144
  ds_read_b64_tr_b16 a[26:27], v147 offset:6144
  ds_read_b64_tr_b16 a[28:29], v146 offset:6208
  ds_read_b64_tr_b16 a[30:31], v147 offset:6208
  s_waitcnt lgkmcnt(0)
  s_add_u32 m0, s28, 4096
  s_nop 0
  buffer_load_dwordx4 v144, s[8:11], s17 offen lds
  s_add_u32 s17, s17, s29
  s_add_u32 m0, s28, 5120
  s_nop 0
  buffer_load_dwordx4 v144, s[8:11], s17 offen lds
  s_add_u32 s17, s17, s29
  s_add_u32 m0, s28, 6144
  s_nop 0
  buffer_load_dwordx4 v144, s[8:11], s17 offen lds
  s_add_u32 s17, s17, s29
  s_add_u32 m0, s28, 7168
  s_nop 0
  buffer_load_dwordx4 v144, s[8:11], s17 offen lds
  s_add_u32 s17, s17, s29
  s_waitcnt vmcnt(28)
  ds_read_b64_tr_b16 a[32:33], v146 offset:8192
  ds_read_b64_tr_b16 a[34:35], v147 offset:8192
  ds_read_b64_tr_b16 a[36:37], v146 offset:8256
  ds_read_b64_tr_b16 a[38:39], v147 offset:8256
  ds_read_b64_tr_b16 a[40:41], v146 offset:10240
  ds_read_b64_tr_b16 a[42:43], v147 offset:10240
  ds_read_b64_tr_b16 a[44:45], v146 offset:10304
  ds_read_b64_tr_b16 a[46:47], v147 offset:10304
  s_waitcnt lgkmcnt(0)
  s_add_u32 m0, s28, 8192
  s_nop 0
  buffer_load_dwordx4 v144, s[8:11], s17 offen lds
  s_add_u32 s17, s17, s29
  s_add_u32 m0, s28, 9216
  s_nop 0
  buffer_load_dwordx4 v144, s[8:11], s17 offen lds
  s_add_u32 s17, s17, s29
  s_add_u32 m0, s28, 10240
  s_nop 0
  buffer_load_dwordx4 v144, s[8:11], s17 offen lds
  s_add_u32 s17, s17, s29
  s_add_u32 m0, s28, 11264
  s_nop 0
  buffer_load_dwordx4 v144, s[8:11], s17 offen lds
  s_add_u32 s17, s17, s29
  s_waitcnt vmcnt(28)
  ds_read_b64_tr_b16 a[48:49], v146 offset:12288
  ds_read_b64_tr_b16 a[50:51], v147 offset:12288
  ds_read_b64_tr_b16 a[52:53], v146 offset:12352
  ds_read_b64_tr_b16 a[54:55], v147 offset:12352
  ds_read_b64_tr_b16 a[56:57], v146 offset:14336
  ds_read_b64_tr_b16 a[58:59], v147 offset:14336
  ds_read_b64_tr_b16 a[60:61], v146 offset:14400
  ds_read_b64_tr_b16 a[62:63], v147 offset:14400
  s_waitcnt lgkmcnt(0)
  s_add_u32 m0, s28, 12288
  s_nop 0
  buffer_load_dwordx4 v144, s[8:11], s17 offen lds
  s_add_u32 s17, s17, s29
  s_add_u32 m0, s28, 13312
  s_nop 0
  buffer_load_dwordx4 v144, s[8:11], s17 offen lds
  s_add_u32 s17, s17, s29
  s_add_u32 m0, s28, 14336
  s_nop 0
  buffer_load_dwordx4 v144, s[8:11], s17 offen lds
  s_add_u32 s17, s17, s29
  s_add_u32 m0, s28, 15360
  s_nop 0
  buffer_load_dwordx4 v144, s[8:11], s17 offen lds
  s_add_u32 s17, s17, s29
  s_waitcnt vmcnt(28)
  ds_read_b64_tr_b16 a[64:65], v146 offset:16384
  ds_read_b64_tr_b16 a[66:67], v147 offset:16384
  ds_read_b64_tr_b16 a[68:69], v146 offset:16448
  ds_read_b64_tr_b16 a[70:71], v147 offset:16448
  ds_read_b64_tr_b16 a[72:73], v146 offset:18432
  ds_read_b64_tr_b16 a[74:75], v147 offset:18432
  ds_read_b64_tr_b16 a[76:77], v146 offset:18496
  ds_read_b64_tr_b16 a[78:79], v147 offset:18496
  s_waitcnt lgkmcnt(0)
  s_add_u32 m0, s28, 16384
  s_nop 0
  buffer_load_dwordx4 v144, s[8:11], s17 offen lds
  s_add_u32 s17, s17, s29
  s_add_u32 m0, s28, 17408
  s_nop 0
  buffer_load_dwordx4 v144, s[8:11], s17 offen lds
  s_add_u32 s17, s17, s29
  s_add_u32 m0, s28, 18432
  s_nop 0
  buffer_load_dwordx4 v144, s[8:11], s17 offen lds
  s_add_u32 s17, s17, s29
  s_add_u32 m0, s28, 19456
  s_nop 0
  buffer_load_dwordx4 v144, s[8:11], s17 offen lds
  s_add_u32 s17, s17, s29
  s_waitcnt vmcnt(28)
  ds_read_b64_tr_b16 a[80:81], v146 offset:20480
  ds_read_b64_tr_b16 a[82:83], v147 offset:20480
  ds_read_b64_tr_b16 a[84:85], v146 offset:20544
  ds_read_b64_tr_b16 a[86:87], v147 offset:20544
  ds_read_b64_tr_b16 a[88:89], v146 offset:22528
  ds_read_b64_tr_b16 a[90:91], v147 offset:22528
  ds_read_b64_tr_b16 a[92:93], v146 offset:22592
  ds_read_b64_tr_b16 a[94:95], v147 offset:22592
  s_waitcnt lgkmcnt(0)
  s_add_u32 m0, s28, 20480
  s_nop 0
  buffer_load_dwordx4 v144, s[8:11], s17 offen lds
  s_add_u32 s17, s17, s29
  s_add_u32 m0, s28, 21504
  s_nop 0
  buffer_load_dwordx4 v144, s[8:11], s17 offen lds
  s_add_u32 s17, s17, s29
  s_add_u32 m0, s28, 22528
  s_nop 0
  buffer_load_dwordx4 v144, s[8:11], s17 offen lds
  s_add_u32 s17, s17, s29
  s_add_u32 m0, s28, 23552
  s_nop 0
  buffer_load_dwordx4 v144, s[8:11], s17 offen lds
  s_add_u32 s17, s17, s29
  s_waitcnt vmcnt(28)
  ds_read_b64_tr_b16 a[96:97], v146 offset:24576
  ds_read_b64_tr_b16 a[98:99], v147 offset:24576
  ds_read_b64_tr_b16 a[100:101], v146 offset:24640
  ds_read_b64_tr_b16 a[102:103], v147 offset:24640
  ds_read_b64_tr_b16 a[104:105], v146 offset:26624
  ds_read_b64_tr_b16 a[106:107], v147 offset:26624
  ds_read_b64_tr_b16 a[108:109], v146 offset:26688
  ds_read_b64_tr_b16 a[110:111], v147 offset:26688
  s_waitcnt lgkmcnt(0)
  s_add_u32 m0, s28, 24576
  s_nop 0
  buffer_load_dwordx4 v144, s[8:11], s17 offen lds
  s_add_u32 s17, s17, s29
  s_add_u32 m0, s28, 25600
  s_nop 0
  buffer_load_dwordx4 v144, s[8:11], s17 offen lds
  s_add_u32 s17, s17, s29
  s_add_u32 m0, s28, 26624
  s_nop 0
  buffer_load_dwordx4 v144, s[8:11], s17 offen lds
  s_add_u32 s17, s17, s29
  s_add_u32 m0, s28, 27648
  s_nop 0
  buffer_load_dwordx4 v144, s[8:11], s17 offen lds
  s_add_u32 s17, s17, s29
  s_waitcnt vmcnt(28)
  ds_read_b64_tr_b16 a[112:113], v146 offset:28672
  ds_read_b64_tr_b16 a[114:115], v147 offset:28672
  ds_read_b64_tr_b16 a[116:117], v146 offset:28736
  ds_read_b64_tr_b16 a[118:119], v147 offset:28736
  ds_read_b64_tr_b16 a[120:121], v146 offset:30720
  ds_read_b64_tr_b16 a[122:123], v147 offset:30720
  ds_read_b64_tr_b16 a[124:125], v146 offset:30784
  ds_read_b64_tr_b16 a[126:127], v147 offset:30784
  s_waitcnt lgkmcnt(0)
  s_add_u32 m0, s28, 28672
  s_nop 0
  buffer_load_dwordx4 v144, s[8:11], s17 offen lds
  s_add_u32 s17, s17, s29
  s_add_u32 m0, s28, 29696
  s_nop 0
  buffer_load_dwordx4 v144, s[8:11], s17 offen lds
  s_add_u32 s17, s17, s29
  s_add_u32 m0, s28, 30720
  s_nop 0
  buffer_load_dwordx4 v144, s[8:11], s17 offen lds
  s_add_u32 s17, s17, s29
  s_add_u32 m0, s28, 31744
  s_nop 0
  buffer_load_dwordx4 v144, s[8:11], s17 offen lds
  s_add_u32 s17, s17, s29
  s_waitcnt vmcnt(28)
  ds_read_b64_tr_b16 a[128:129], v146 offset:0
  ds_read_b64_tr_b16 a[130:131], v147 offset:0
  ds_read_b64_tr_b16 a[132:133], v146 offset:64
  ds_read_b64_tr_b16 a[134:135], v147 offset:64
  ds_read_b64_tr_b16 a[136:137], v146 offset:2048
  ds_read_b64_tr_b16 a[138:139], v147 offset:2048
  ds_read_b64_tr_b16 a[140:141], v146 offset:2112
  ds_read_b64_tr_b16 a[142:143], v147 offset:2112
  s_waitcnt lgkmcnt(0)
  s_waitcnt vmcnt(24)
  ds_read_b64_tr_b16 a[144:145], v146 offset:4096
  ds_read_b64_tr_b16 a[146:147], v147 offset:4096
  ds_read_b64_tr_b16 a[148:149], v146 offset:4160
  ds_read_b64_tr_b16 a[150:151], v147 offset:4160
  ds_read_b64_tr_b16 a[152:153], v146 offset:6144
  ds_read_b64_tr_b16 a[154:155], v147 offset:6144
  ds_read_b64_tr_b16 a[156:157], v146 offset:6208
  ds_read_b64_tr_b16 a[158:159], v147 offset:6208
  s_waitcnt lgkmcnt(0)
  s_waitcnt vmcnt(20)
  ds_read_b64_tr_b16 a[160:161], v146 offset:8192
  ds_read_b64_tr_b16 a[162:163], v147 offset:8192
  ds_read_b64_tr_b16 a[164:165], v146 offset:8256
  ds_read_b64_tr_b16 a[166:167], v147 offset:8256
  ds_read_b64_tr_b16 a[168:169], v146 offset:10240
  ds_read_b64_tr_b16 a[170:171], v147 offset:10240
  ds_read_b64_tr_b16 a[172:173], v146 offset:10304
  ds_read_b64_tr_b16 a[174:175], v147 offset:10304
  s_waitcnt lgkmcnt(0)
  s_waitcnt vmcnt(16)
  ds_read_b64_tr_b16 a[176:177], v146 offset:12288
  ds_read_b64_tr_b16 a[178:179], v147 offset:12288
  ds_read_b64_tr_b16 a[180:181], v146 offset:12352
  ds_read_b64_tr_b16 a[182:183], v147 offset:12352
  ds_read_b64_tr_b16 a[184:185], v146 offset:14336
  ds_read_b64_tr_b16 a[186:187], v147 offset:14336
  ds_read_b64_tr_b16 a[188:189], v146 offset:14400
  ds_read_b64_tr_b16 a[190:191], v147 offset:14400
  s_waitcnt lgkmcnt(0)
  s_waitcnt vmcnt(12)
  ds_read_b64_tr_b16 a[192:193], v146 offset:16384
  ds_read_b64_tr_b16 a[194:195], v147 offset:16384
  ds_read_b64_tr_b16 a[196:197], v146 offset:16448
  ds_read_b64_tr_b16 a[198:199], v147 offset:16448
  ds_read_b64_tr_b16 a[200:201], v146 offset:18432
  ds_read_b64_tr_b16 a[202:203], v147 offset:18432
  ds_read_b64_tr_b16 a[204:205], v146 offset:18496
  ds_read_b64_tr_b16 a[206:207], v147 offset:18496
  s_waitcnt lgkmcnt(0)
  s_waitcnt vmcnt(8)
  ds_read_b64_tr_b16 a[208:209], v146 offset:20480
  ds_read_b64_tr_b16 a[210:211], v147 offset:20480
  ds_read_b64_tr_b16 a[212:213], v146 offset:20544
  ds_read_b64_tr_b16 a[214:215], v147 offset:20544
  ds_read_b64_tr_b16 a[216:217], v146 offset:22528
  ds_read_b64_tr_b16 a[218:219], v147 offset:22528
  ds_read_b64_tr_b16 a[220:221], v146 offset:22592
  ds_read_b64_tr_b16 a[222:223], v147 offset:22592
  s_waitcnt lgkmcnt(0)
  s_waitcnt vmcnt(4)
  ds_read_b64_tr_b16 a[224:225], v146 offset:24576
  ds_read_b64_tr_b16 a[226:227], v147 offset:24576
  ds_read_b64_tr_b16 a[228:229], v146 offset:24640
  ds_read_b64_tr_b16 a[230:231], v147 offset:24640
  ds_read_b64_tr_b16 a[232:233], v146 offset:26624
  ds_read_b64_tr_b16 a[234:235], v147 offset:26624
  ds_read_b64_tr_b16 a[236:237], v146 offset:26688
  ds_read_b64_tr_b16 a[238:239], v147 offset:26688
  s_waitcnt lgkmcnt(0)
  s_waitcnt vmcnt(0)
  ds_read_b64_tr_b16 a[240:241], v146 offset:28672
  ds_read_b64_tr_b16 a[242:243], v147 offset:28672
  ds_read_b64_tr_b16 a[244:245], v146 offset:28736
  ds_read_b64_tr_b16 a[246:247], v147 offset:28736
  ds_read_b64_tr_b16 a[248:249], v146 offset:30720
  ds_read_b64_tr_b16 a[250:251], v147 offset:30720
  ds_read_b64_tr_b16 a[252:253], v146 offset:30784
  ds_read_b64_tr_b16 a[254:255], v147 offset:30784
  s_waitcnt lgkmcnt(0)
  s_lshl_b32 s26, s48, 2
  s_add_u32 s26, s26, s16
  s_lshl_b32 s27, s26, 6
  s_add_u32 s27, s27, s50
  s_lshl_b32 s19, s27, 13
  s_lshl_b32 s27, s50, 5
  s_add_u32 s27, s27, s26
  s_mul_i32 s27, s27, 4096
  s_add_u32 s20, s27, 135266304
  s_lshl_b32 s25, s16, 12
  s_add_u32 s25, s25, 65536
  s_lshl_b32 s26, s16, 13
  v_add_u32 v3, s26, v2
  v_lshrrev_b32 v16, 5, v1
  v_and_b32 v17, 31, v1
  v_bfe_u32 v18, v1, 4, 1
  v_lshl_add_u32 v18, v18, 1, v16
  v_and_b32 v19, 15, v1
  v_lshl_add_u32 v18, v18, 4, v19
  v_lshl_add_u32 v5, v18, 4, s25
  v_bfe_u32 v18, v1, 2, 2
  v_lshl_add_u32 v18, v16, 2, v18
  v_and_b32 v19, 1, v1
  v_lshl_add_u32 v18, v19, 4, v18
  v_lshl_add_u32 v4, v18, 4, s25
  v_lshlrev_b32 v16, 2, v16
  v_sub_u32 v17, v17, v16
  v_mov_b32 v18, 0xf149f2ca
  v_cmp_le_i32 vcc, 0, v17
  s_nop 1
  v_cndmask_b32 v240, v18, 0, vcc
  v_cmp_le_i32 vcc, 1, v17
  s_nop 1
  v_cndmask_b32 v241, v18, 0, vcc
  v_cmp_le_i32 vcc, 2, v17
  s_nop 1
  v_cndmask_b32 v242, v18, 0, vcc
  v_cmp_le_i32 vcc, 3, v17
  s_nop 1
  v_cndmask_b32 v243, v18, 0, vcc
  v_cmp_le_i32 vcc, 8, v17
  s_nop 1
  v_cndmask_b32 v244, v18, 0, vcc
  v_cmp_le_i32 vcc, 9, v17
  s_nop 1
  v_cndmask_b32 v245, v18, 0, vcc
  v_cmp_le_i32 vcc, 10, v17
  s_nop 1
  v_cndmask_b32 v246, v18, 0, vcc
  v_cmp_le_i32 vcc, 11, v17
  s_nop 1
  v_cndmask_b32 v247, v18, 0, vcc
  v_cmp_le_i32 vcc, 16, v17
  s_nop 1
  v_cndmask_b32 v248, v18, 0, vcc
  v_cmp_le_i32 vcc, 17, v17
  s_nop 1
  v_cndmask_b32 v249, v18, 0, vcc
  v_cmp_le_i32 vcc, 18, v17
  s_nop 1
  v_cndmask_b32 v250, v18, 0, vcc
  v_cmp_le_i32 vcc, 19, v17
  s_nop 1
  v_cndmask_b32 v251, v18, 0, vcc
  v_cmp_le_i32 vcc, 24, v17
  s_nop 1
  v_cndmask_b32 v252, v18, 0, vcc
  v_cmp_le_i32 vcc, 25, v17
  s_nop 1
  v_cndmask_b32 v253, v18, 0, vcc
  v_cmp_le_i32 vcc, 26, v17
  s_nop 1
  v_cndmask_b32 v254, v18, 0, vcc
  v_cmp_le_i32 vcc, 27, v17
  s_nop 1
  v_cndmask_b32 v255, v18, 0, vcc
  v_mov_b32 v21, v2
  s_barrier
  s_lshl_b32 s77, s48, 2
  s_add_u32 s77, s77, s16
  s_mul_i32 s78, s77, 896
  s_add_u32 s76, s78, 148898304
  s_mov_b32 s71, 0
  s_branch M_sg_55
M_sw_54:
  s_sleep 8
  s_add_u32 s71, s71, 1
  s_cmp_gt_u32 s71, 262144
  s_cbranch_scc1 M_exit
M_sg_55:
  s_mov_b32 s79, 0
  s_atomic_or s79, s[72:73], s76 glc
  s_waitcnt lgkmcnt(0)
  s_cmp_lt_u32 s79, 16
  s_cbranch_scc1 M_sw_54
  s_add_u32 s76, s78, 148898048
  s_mov_b32 s71, 0
  s_branch M_sg_57
M_sw_56:
  s_sleep 8
  s_add_u32 s71, s71, 1
  s_cmp_gt_u32 s71, 262144
  s_cbranch_scc1 M_exit
M_sg_57:
  s_mov_b32 s79, 0
  s_atomic_or s79, s[72:73], s76 glc
  s_waitcnt lgkmcnt(0)
  s_cmp_lt_u32 s79, 16
  s_cbranch_scc1 M_sw_56
M_xok_53:
  s_lshl_b32 s77, s77, 7
  s_add_u32 s54, s77, 148926464
  s_add_u32 s52, s50, 1
  s_mov_b32 s53, 0
  s_mov_b32 s30, 0x200
  s_add_u32 s28, s19, 50331648
  buffer_load_dwordx4 v[144:147], v21, s[4:7], s28 offen offset:0 sc1
  buffer_load_dwordx4 v[148:151], v21, s[4:7], s28 offen offset:1024 sc1
  buffer_load_dwordx4 v[152:155], v21, s[4:7], s28 offen offset:2048 sc1
  buffer_load_dwordx4 v[156:159], v21, s[4:7], s28 offen offset:3072 sc1
  s_add_u32 s29, s19, 50335744
  buffer_load_dwordx4 v[160:163], v21, s[4:7], s29 offen offset:0 sc1
  buffer_load_dwordx4 v[164:167], v21, s[4:7], s29 offen offset:1024 sc1
  buffer_load_dwordx4 v[168:171], v21, s[4:7], s29 offen offset:2048 sc1
  buffer_load_dwordx4 v[172:175], v21, s[4:7], s29 offen offset:3072 sc1
  s_add_u32 s28, s19, 67108864
  buffer_load_dwordx4 v[176:179], v21, s[4:7], s28 offen offset:0 sc1
  buffer_load_dwordx4 v[180:183], v21, s[4:7], s28 offen offset:1024 sc1
  buffer_load_dwordx4 v[184:187], v21, s[4:7], s28 offen offset:2048 sc1
  buffer_load_dwordx4 v[188:191], v21, s[4:7], s28 offen offset:3072 sc1
  s_add_u32 s29, s19, 67112960
  buffer_load_dwordx4 v[192:195], v21, s[4:7], s29 offen offset:0 sc1
  buffer_load_dwordx4 v[196:199], v21, s[4:7], s29 offen offset:1024 sc1
  buffer_load_dwordx4 v[200:203], v21, s[4:7], s29 offen offset:2048 sc1
  buffer_load_dwordx4 v[204:207], v21, s[4:7], s29 offen offset:3072 sc1
  s_add_u32 s28, s19, 83886080
  buffer_load_dwordx4 v[208:211], v21, s[4:7], s28 offen offset:0 sc1
  buffer_load_dwordx4 v[212:215], v21, s[4:7], s28 offen offset:1024 sc1
  buffer_load_dwordx4 v[216:219], v21, s[4:7], s28 offen offset:2048 sc1
  buffer_load_dwordx4 v[220:223], v21, s[4:7], s28 offen offset:3072 sc1
  s_add_u32 s29, s19, 83890176
  buffer_load_dwordx4 v[224:227], v21, s[4:7], s29 offen offset:0 sc1
  buffer_load_dwordx4 v[228:231], v21, s[4:7], s29 offen offset:1024 sc1
  buffer_load_dwordx4 v[232:235], v21, s[4:7], s29 offen offset:2048 sc1
  buffer_load_dwordx4 v[236:239], v21, s[4:7], s29 offen offset:3072 sc1
  s_mov_b32 s24, 0
  v_mov_b32 v22, 0x40000000
  s_sub_u32 s21, s21, s22
F_top_58:
  s_waitcnt vmcnt(8)
  v_mfma_f32_32x32x16_bf16 v[24:39], v[176:179], v[144:147], v[240:255]
  s_nop 1
  v_cvt_pk_bf16_f32 v128, v64, v65
  v_cvt_pk_bf16_f32 v129, v66, v67
  v_cvt_pk_bf16_f32 v130, v68, v69
  v_cvt_pk_bf16_f32 v131, v70, v71
  v_mfma_f32_32x32x16_bf16 v[24:39], v[180:183], v[148:151], v[24:39]
  buffer_store_dwordx4 v[128:131], v22, s[4:7], s21 offen offset:0 sc1
  v_mfma_f32_32x32x16_bf16 v[24:39], v[184:187], v[152:155], v[24:39]
  v_cvt_pk_bf16_f32 v132, v72, v73
  v_cvt_pk_bf16_f32 v133, v74, v75
  v_cvt_pk_bf16_f32 v134, v76, v77
  v_cvt_pk_bf16_f32 v135, v78, v79
  v_mfma_f32_32x32x16_bf16 v[24:39], v[188:191], v[156:159], v[24:39]
  buffer_store_dwordx4 v[132:135], v22, s[4:7], s21 offen offset:1024 sc1
  v_mfma_f32_32x32x16_bf16 v[24:39], v[192:195], v[160:163], v[24:39]
  v_cvt_pk_bf16_f32 v136, v80, v81
  v_cvt_pk_bf16_f32 v137, v82, v83
  v_cvt_pk_bf16_f32 v138, v84, v85
  v_cvt_pk_bf16_f32 v139, v86, v87
  v_mfma_f32_32x32x16_bf16 v[24:39], v[196:199], v[164:167], v[24:39]
  buffer_store_dwordx4 v[136:139], v22, s[4:7], s21 offen offset:2048 sc1
  v_mfma_f32_32x32x16_bf16 v[24:39], v[200:203], v[168:171], v[24:39]
  v_cvt_pk_bf16_f32 v140, v88, v89
  v_cvt_pk_bf16_f32 v141, v90, v91
  v_cvt_pk_bf16_f32 v142, v92, v93
  v_cvt_pk_bf16_f32 v143, v94, v95
  v_mfma_f32_32x32x16_bf16 v[24:39], v[204:207], v[172:175], v[24:39]
  buffer_store_dwordx4 v[140:143], v22, s[4:7], s21 offen offset:3072 sc1
  s_add_u32 s21, s21, s22
  v_mov_b32 v22, v2
  s_cmp_lg_u32 s24, 0
  s_cbranch_scc1 F_have_59
  v_mov_b32 v16, s54
  v_mov_b32 v17, s52
  s_mov_b32 s71, 0
  s_branch M_vg_61
M_vw_60:
  s_sleep 2
  s_add_u32 s71, s71, 1
  s_cmp_gt_u32 s71, 262144
  s_cbranch_scc1 M_exit
M_vg_61:
  buffer_load_dword v23, v16, s[4:7], 0 offen sc1
  s_waitcnt vmcnt(0)
  v_cmp_lt_u32 vcc, v23, v17
  s_cbranch_vccnz M_vw_60
  s_mov_b32 m0, s25
  s_nop 0
  buffer_load_dwordx4 v2, s[4:7], s20 offen offset:0 sc1 lds
  buffer_load_dwordx4 v2, s[4:7], s20 offen offset:1024 sc1 lds
  buffer_load_dwordx4 v2, s[4:7], s20 offen offset:2048 sc1 lds
  buffer_load_dwordx4 v2, s[4:7], s20 offen offset:3072 sc1 lds
  s_waitcnt vmcnt(0)
F_have_59:
  ds_read_b64_tr_b16 v[176:177], v4 offset:8
  ds_read_b64_tr_b16 v[178:179], v4 offset:136
  ds_read_b64_tr_b16 v[180:181], v4 offset:520
  ds_read_b64_tr_b16 v[182:183], v4 offset:648
  ds_read_b64_tr_b16 v[184:185], v4 offset:1032
  ds_read_b64_tr_b16 v[186:187], v4 offset:1160
  ds_read_b64_tr_b16 v[188:189], v4 offset:1544
  ds_read_b64_tr_b16 v[190:191], v4 offset:1672
  ds_read_b64_tr_b16 v[192:193], v4 offset:2056
  ds_read_b64_tr_b16 v[194:195], v4 offset:2184
  ds_read_b64_tr_b16 v[196:197], v4 offset:2568
  ds_read_b64_tr_b16 v[198:199], v4 offset:2696
  s_sub_u32 s23, s23, 1
  s_cmp_gt_u32 s23, 0
  s_cselect_b32 s26, s51, 0
  s_cselect_b32 s27, 0, 0x40000000
  v_or_b32 v21, s27, v21
  s_lshl_b32 s27, s26, 13
  s_add_u32 s19, s19, s27
  s_mul_i32 s27, s26, 131072
  s_add_u32 s20, s20, s27
  s_cmp_lg_u32 s23, 24
  s_cbranch_scc1 M_xok_62
  s_lshl_b32 s77, s48, 2
  s_add_u32 s77, s77, s16
  s_mul_i32 s78, s77, 896
  s_add_u32 s76, s78, 148898304
  s_mov_b32 s71, 0
  s_branch M_sg_64
M_sw_63:
  s_sleep 8
  s_add_u32 s71, s71, 1
  s_cmp_gt_u32 s71, 262144
  s_cbranch_scc1 M_exit
M_sg_64:
  s_mov_b32 s79, 0
  s_atomic_or s79, s[72:73], s76 glc
  s_waitcnt lgkmcnt(0)
  s_cmp_lt_u32 s79, 32
  s_cbranch_scc1 M_sw_63
  s_add_u32 s76, s78, 148898432
  s_mov_b32 s71, 0
  s_branch M_sg_66
M_sw_65:
  s_sleep 8
  s_add_u32 s71, s71, 1
  s_cmp_gt_u32 s71, 262144
  s_cbranch_scc1 M_exit
M_sg_66:
  s_mov_b32 s79, 0
  s_atomic_or s79, s[72:73], s76 glc
  s_waitcnt lgkmcnt(0)
  s_cmp_lt_u32 s79, 32
  s_cbranch_scc1 M_sw_65
  s_add_u32 s76, s78, 148898048
  s_mov_b32 s71, 0
  s_branch M_sg_68
M_sw_67:
  s_sleep 8
  s_add_u32 s71, s71, 1
  s_cmp_gt_u32 s71, 262144
  s_cbranch_scc1 M_exit
M_sg_68:
  s_mov_b32 s79, 0
  s_atomic_or s79, s[72:73], s76 glc
  s_waitcnt lgkmcnt(0)
  s_cmp_lt_u32 s79, 30
  s_cbranch_scc1 M_sw_67
  s_add_u32 s76, s78, 148898176
  s_mov_b32 s71, 0
  s_branch M_sg_70
M_sw_69:
  s_sleep 8
  s_add_u32 s71, s71, 1
  s_cmp_gt_u32 s71, 262144
  s_cbranch_scc1 M_exit
M_sg_70:
  s_mov_b32 s79, 0
  s_atomic_or s79, s[72:73], s76 glc
  s_waitcnt lgkmcnt(0)
  s_cmp_lt_u32 s79, 34
  s_cbranch_scc1 M_sw_69
M_xok_62:
  s_waitcnt lgkmcnt(10)
  v_mfma_f32_32x32x16_bf16 v[40:55], v[176:179], v[144:147], 0
  ds_read_b64_tr_b16 v[200:201], v4 offset:3080
  ds_read_b64_tr_b16 v[202:203], v4 offset:3208
  v_max_f32 v6, v24, v25
  s_waitcnt lgkmcnt(10)
  v_mfma_f32_32x32x16_bf16 v[40:55], v[180:183], v[148:151], v[40:55]
  ds_read_b64_tr_b16 v[204:205], v4 offset:3592
  ds_read_b64_tr_b16 v[206:207], v4 offset:3720
  v_max3_f32 v6, v6, v26, v27
  s_waitcnt lgkmcnt(10)
  v_mfma_f32_32x32x16_bf16 v[40:55], v[184:187], v[152:155], v[40:55]
  ds_read_b64 v[56:57], v5 offset:0
  ds_read_b64 v[58:59], v5 offset:1024
  v_max3_f32 v6, v6, v28, v29
  s_waitcnt lgkmcnt(10)
  v_mfma_f32_32x32x16_bf16 v[40:55], v[188:191], v[156:159], v[40:55]
  ds_read_b64 v[60:61], v5 offset:2048
  ds_read_b64 v[62:63], v5 offset:3072
  v_max3_f32 v6, v6, v30, v31
  s_waitcnt lgkmcnt(10)
  v_mfma_f32_32x32x16_bf16 v[40:55], v[192:195], v[160:163], v[40:55]
  v_max3_f32 v6, v6, v32, v33
  s_waitcnt lgkmcnt(8)
  v_mfma_f32_32x32x16_bf16 v[40:55], v[196:199], v[164:167], v[40:55]
  v_max3_f32 v6, v6, v34, v35
  s_waitcnt lgkmcnt(6)
  v_mfma_f32_32x32x16_bf16 v[40:55], v[200:203], v[168:171], v[40:55]
  v_max3_f32 v6, v6, v36, v37
  s_waitcnt lgkmcnt(4)
  v_mfma_f32_32x32x16_bf16 v[40:55], v[204:207], v[172:175], v[40:55]
  v_max3_f32 v6, v6, v38, v39
  s_add_u32 s28, s19, 50331648
  buffer_load_dwordx4 v[144:147], v21, s[4:7], s28 offen offset:0 sc1
  buffer_load_dwordx4 v[148:151], v21, s[4:7], s28 offen offset:1024 sc1
  s_nop 7
  v_max3_f32 v6, v6, v40, v41
  v_max3_f32 v6, v6, v42, v43
  v_mov_b32 v16, v6
  s_nop 1
  v_permlane32_swap_b32 v6, v16
  s_nop 1
  v_max_f32 v6, v6, v16
  v_pk_add_f32 v[24:25], v[24:25], v[6:7] op_sel_hi:[1,0] neg_lo:[0,1] neg_hi:[0,1]
  v_pk_add_f32 v[26:27], v[26:27], v[6:7] op_sel_hi:[1,0] neg_lo:[0,1] neg_hi:[0,1]
  v_pk_add_f32 v[28:29], v[28:29], v[6:7] op_sel_hi:[1,0] neg_lo:[0,1] neg_hi:[0,1]
  v_pk_add_f32 v[30:31], v[30:31], v[6:7] op_sel_hi:[1,0] neg_lo:[0,1] neg_hi:[0,1]
  v_pk_add_f32 v[32:33], v[32:33], v[6:7] op_sel_hi:[1,0] neg_lo:[0,1] neg_hi:[0,1]
  v_pk_add_f32 v[34:35], v[34:35], v[6:7] op_sel_hi:[1,0] neg_lo:[0,1] neg_hi:[0,1]
  v_pk_add_f32 v[36:37], v[36:37], v[6:7] op_sel_hi:[1,0] neg_lo:[0,1] neg_hi:[0,1]
  v_pk_add_f32 v[38:39], v[38:39], v[6:7] op_sel_hi:[1,0] neg_lo:[0,1] neg_hi:[0,1]
  v_pk_add_f32 v[40:41], v[40:41], v[6:7] op_sel_hi:[1,0] neg_lo:[0,1] neg_hi:[0,1]
  v_pk_add_f32 v[42:43], v[42:43], v[6:7] op_sel_hi:[1,0] neg_lo:[0,1] neg_hi:[0,1]
  v_exp_f32 v24, v24
  v_exp_f32 v25, v25
  v_exp_f32 v26, v26
  v_exp_f32 v27, v27
  v_exp_f32 v28, v28
  v_exp_f32 v29, v29
  v_exp_f32 v30, v30
  v_exp_f32 v31, v31
  v_exp_f32 v32, v32
  v_exp_f32 v33, v33
  buffer_load_dwordx4 v[152:155], v21, s[4:7], s28 offen offset:2048 sc1
  v_exp_f32 v34, v34
  v_exp_f32 v35, v35
  v_exp_f32 v36, v36
  v_exp_f32 v37, v37
  v_exp_f32 v38, v38
  v_exp_f32 v39, v39
  v_exp_f32 v40, v40
  v_exp_f32 v41, v41
  v_exp_f32 v42, v42
  v_exp_f32 v43, v43
  v_pk_add_f32 v[16:17], v[24:25], v[26:27]
  v_pk_add_f32 v[16:17], v[16:17], v[28:29]
  v_pk_add_f32 v[16:17], v[16:17], v[30:31]
  v_pk_add_f32 v[16:17], v[16:17], v[32:33]
  v_pk_add_f32 v[16:17], v[16:17], v[34:35]
  v_pk_add_f32 v[16:17], v[16:17], v[36:37]
  v_pk_add_f32 v[16:17], v[16:17], v[38:39]
  v_pk_add_f32 v[16:17], v[16:17], v[40:41]
  v_pk_add_f32 v[16:17], v[16:17], v[42:43]
  v_add_f32 v16, v16, v17
  v_mov_b32 v17, v16
  buffer_load_dwordx4 v[156:159], v21, s[4:7], s28 offen offset:3072 sc1
  s_nop 0
  v_permlane32_swap_b32 v16, v17
  s_nop 1
  v_add_f32 v16, v16, v17
  v_rcp_f32 v6, v16
  s_nop 0
  v_pk_mul_f32 v[24:25], v[24:25], v[6:7] op_sel_hi:[1,0]
  v_pk_mul_f32 v[26:27], v[26:27], v[6:7] op_sel_hi:[1,0]
  v_pk_mul_f32 v[28:29], v[28:29], v[6:7] op_sel_hi:[1,0]
  v_pk_mul_f32 v[30:31], v[30:31], v[6:7] op_sel_hi:[1,0]
  v_pk_mul_f32 v[32:33], v[32:33], v[6:7] op_sel_hi:[1,0]
  v_pk_mul_f32 v[34:35], v[34:35], v[6:7] op_sel_hi:[1,0]
  v_pk_mul_f32 v[36:37], v[36:37], v[6:7] op_sel_hi:[1,0]
  v_pk_mul_f32 v[38:39], v[38:39], v[6:7] op_sel_hi:[1,0]
  v_pk_mul_f32 v[40:41], v[40:41], v[6:7] op_sel_hi:[1,0]
  v_pk_mul_f32 v[42:43], v[42:43], v[6:7] op_sel_hi:[1,0]
  v_cvt_pk_bf16_f32 v128, v24, v25
  v_cvt_pk_bf16_f32 v129, v26, v27
  v_cvt_pk_bf16_f32 v130, v28, v29
  v_cvt_pk_bf16_f32 v131, v30, v31
  v_cvt_pk_bf16_f32 v132, v32, v33
  v_cvt_pk_bf16_f32 v133, v34, v35
  v_cvt_pk_bf16_f32 v134, v36, v37
  v_cvt_pk_bf16_f32 v135, v38, v39
  v_cvt_pk_bf16_f32 v136, v40, v41
  v_cvt_pk_bf16_f32 v137, v42, v43
  s_waitcnt vmcnt(8) lgkmcnt(0)
  v_mfma_f32_32x32x16_bf16 v[64:79], v[208:211], v[128:131], 0
  s_add_u32 s29, s19, 50335744
  buffer_load_dwordx4 v[160:163], v21, s[4:7], s29 offen offset:0 sc1
  v_mfma_f32_32x32x16_bf16 v[64:79], v[212:215], v[132:135], v[64:79]
  v_mfma_f32_32x32x8_bf16 v[64:79], v[56:57], v[136:137], v[64:79]
  v_mfma_f32_32x32x16_bf16 v[80:95], v[216:219], v[128:131], 0
  buffer_load_dwordx4 v[164:167], v21, s[4:7], s29 offen offset:1024 sc1
  v_mfma_f32_32x32x16_bf16 v[80:95], v[220:223], v[132:135], v[80:95]
  v_cvt_pk_bf16_f32 v24, v64, v65
  v_cvt_pk_bf16_f32 v25, v66, v67
  v_cvt_pk_bf16_f32 v26, v68, v69
  v_cvt_pk_bf16_f32 v27, v70, v71
  v_mfma_f32_32x32x8_bf16 v[80:95], v[58:59], v[136:137], v[80:95]
  ds_write_b128 v3, v[24:27] offset:0
  v_cvt_pk_bf16_f32 v28, v72, v73
  v_cvt_pk_bf16_f32 v29, v74, v75
  v_cvt_pk_bf16_f32 v30, v76, v77
  v_cvt_pk_bf16_f32 v31, v78, v79
  v_mfma_f32_32x32x16_bf16 v[96:111], v[224:227], v[128:131], 0
  ds_write_b128 v3, v[28:31] offset:1024
  buffer_load_dwordx4 v[168:171], v21, s[4:7], s29 offen offset:2048 sc1
  v_mfma_f32_32x32x16_bf16 v[96:111], v[228:231], v[132:135], v[96:111]
  v_cvt_pk_bf16_f32 v32, v80, v81
  v_cvt_pk_bf16_f32 v33, v82, v83
  v_cvt_pk_bf16_f32 v34, v84, v85
  v_cvt_pk_bf16_f32 v35, v86, v87
  v_mfma_f32_32x32x8_bf16 v[96:111], v[60:61], v[136:137], v[96:111]
  ds_write_b128 v3, v[32:35] offset:2048
  v_cvt_pk_bf16_f32 v36, v88, v89
  v_cvt_pk_bf16_f32 v37, v90, v91
  v_cvt_pk_bf16_f32 v38, v92, v93
  v_cvt_pk_bf16_f32 v39, v94, v95
  v_mfma_f32_32x32x16_bf16 v[112:127], v[232:235], v[128:131], 0
  ds_write_b128 v3, v[36:39] offset:3072
  buffer_load_dwordx4 v[172:175], v21, s[4:7], s29 offen offset:3072 sc1
  v_mfma_f32_32x32x16_bf16 v[112:127], v[236:239], v[132:135], v[112:127]
  v_cvt_pk_bf16_f32 v40, v96, v97
  v_cvt_pk_bf16_f32 v41, v98, v99
  v_cvt_pk_bf16_f32 v42, v100, v101
  v_cvt_pk_bf16_f32 v43, v102, v103
  v_mfma_f32_32x32x8_bf16 v[112:127], v[62:63], v[136:137], v[112:127]
  ds_write_b128 v3, v[40:43] offset:4096
  v_cvt_pk_bf16_f32 v44, v104, v105
  v_cvt_pk_bf16_f32 v45, v106, v107
  v_cvt_pk_bf16_f32 v46, v108, v109
  v_cvt_pk_bf16_f32 v47, v110, v111
  ds_write_b128 v3, v[44:47] offset:5120
  s_nop 5
  v_cvt_pk_bf16_f32 v48, v112, v113
  v_cvt_pk_bf16_f32 v49, v114, v115
  v_cvt_pk_bf16_f32 v50, v116, v117
  v_cvt_pk_bf16_f32 v51, v118, v119
  ds_write_b128 v3, v[48:51] offset:6144
  v_cvt_pk_bf16_f32 v52, v120, v121
  v_cvt_pk_bf16_f32 v53, v122, v123
  v_cvt_pk_bf16_f32 v54, v124, v125
  v_cvt_pk_bf16_f32 v55, v126, v127
  ds_write_b128 v3, v[52:55] offset:7168
  s_waitcnt vmcnt(8)
  s_waitcnt lgkmcnt(0)
  s_barrier
  ds_read_b128 v[24:27], v8 offset:0
  ds_read_b128 v[28:31], v9 offset:0
  ds_read_b128 v[32:35], v10 offset:0
  ds_read_b128 v[36:39], v11 offset:0
  ds_read_b128 v[40:43], v12 offset:0
  ds_read_b128 v[44:47], v13 offset:0
  buffer_load_dword v23, off, s[4:7], s54 sc1
  v_mov_b32 v16, s30
  v_min_u32 v17, 1, v0
  v_lshlrev_b32 v17, 30, v17
  buffer_store_dword v16, v17, s[4:7], s31 offen sc1
  s_add_u32 s30, s30, 1
  s_add_u32 s52, s52, 2
  s_waitcnt lgkmcnt(5)
  v_mfma_f32_32x32x16_bf16 v[64:79], a[0:3], v[24:27], 0
  s_add_u32 s28, s19, 67108864
  ds_read_b128 v[48:51], v14 offset:0
  v_mfma_f32_32x32x16_bf16 v[80:95], a[4:7], v[24:27], 0
  s_waitcnt lgkmcnt(5)
  v_mfma_f32_32x32x16_bf16 v[64:79], a[8:11], v[28:31], v[64:79]
  ds_read_b128 v[52:55], v15 offset:0
  v_mfma_f32_32x32x16_bf16 v[80:95], a[12:15], v[28:31], v[80:95]
  s_waitcnt lgkmcnt(5)
  buffer_load_dwordx4 v[176:179], v21, s[4:7], s28 offen offset:0 sc1
  v_mfma_f32_32x32x16_bf16 v[64:79], a[16:19], v[32:35], v[64:79]
  ds_read_b128 v[24:27], v8 offset:8192
  v_mfma_f32_32x32x16_bf16 v[80:95], a[20:23], v[32:35], v[80:95]
  s_waitcnt lgkmcnt(5)
  v_mfma_f32_32x32x16_bf16 v[64:79], a[24:27], v[36:39], v[64:79]
  ds_read_b128 v[28:31], v9 offset:8192
  v_mfma_f32_32x32x16_bf16 v[80:95], a[28:31], v[36:39], v[80:95]
  s_waitcnt lgkmcnt(5)
  buffer_load_dwordx4 v[180:183], v21, s[4:7], s28 offen offset:1024 sc1
  v_mfma_f32_32x32x16_bf16 v[64:79], a[32:35], v[40:43], v[64:79]
  ds_read_b128 v[32:35], v10 offset:8192
  v_mfma_f32_32x32x16_bf16 v[80:95], a[36:39], v[40:43], v[80:95]
  s_waitcnt lgkmcnt(5)
  v_mfma_f32_32x32x16_bf16 v[64:79], a[40:43], v[44:47], v[64:79]
  ds_read_b128 v[36:39], v11 offset:8192
  v_mfma_f32_32x32x16_bf16 v[80:95], a[44:47], v[44:47], v[80:95]
  s_waitcnt lgkmcnt(5)
  buffer_load_dwordx4 v[184:187], v21, s[4:7], s28 offen offset:2048 sc1
  v_mfma_f32_32x32x16_bf16 v[64:79], a[48:51], v[48:51], v[64:79]
  ds_read_b128 v[40:43], v12 offset:8192
  v_mfma_f32_32x32x16_bf16 v[80:95], a[52:55], v[48:51], v[80:95]
  s_waitcnt lgkmcnt(5)
  v_mfma_f32_32x32x16_bf16 v[64:79], a[56:59], v[52:55], v[64:79]
  ds_read_b128 v[44:47], v13 offset:8192
  v_mfma_f32_32x32x16_bf16 v[80:95], a[60:63], v[52:55], v[80:95]
  s_waitcnt lgkmcnt(5)
  buffer_load_dwordx4 v[188:191], v21, s[4:7], s28 offen offset:3072 sc1
  v_mfma_f32_32x32x16_bf16 v[64:79], a[64:67], v[24:27], v[64:79]
  s_add_u32 s29, s19, 67112960
  ds_read_b128 v[48:51], v14 offset:8192
  v_mfma_f32_32x32x16_bf16 v[80:95], a[68:71], v[24:27], v[80:95]
  s_waitcnt lgkmcnt(5)
  v_mfma_f32_32x32x16_bf16 v[64:79], a[72:75], v[28:31], v[64:79]
  ds_read_b128 v[52:55], v15 offset:8192
  v_mfma_f32_32x32x16_bf16 v[80:95], a[76:79], v[28:31], v[80:95]
  s_waitcnt lgkmcnt(5)
  buffer_load_dwordx4 v[192:195], v21, s[4:7], s29 offen offset:0 sc1
  v_mfma_f32_32x32x16_bf16 v[64:79], a[80:83], v[32:35], v[64:79]
  ds_read_b128 v[24:27], v8 offset:16384
  v_mfma_f32_32x32x16_bf16 v[80:95], a[84:87], v[32:35], v[80:95]
  s_waitcnt lgkmcnt(5)
  v_mfma_f32_32x32x16_bf16 v[64:79], a[88:91], v[36:39], v[64:79]
  ds_read_b128 v[28:31], v9 offset:16384
  v_mfma_f32_32x32x16_bf16 v[80:95], a[92:95], v[36:39], v[80:95]
  s_waitcnt lgkmcnt(5)
  buffer_load_dwordx4 v[196:199], v21, s[4:7], s29 offen offset:1024 sc1
  v_mfma_f32_32x32x16_bf16 v[64:79], a[96:99], v[40:43], v[64:79]
  ds_read_b128 v[32:35], v10 offset:16384
  v_mfma_f32_32x32x16_bf16 v[80:95], a[100:103], v[40:43], v[80:95]
  s_waitcnt lgkmcnt(5)
  s_waitcnt vmcnt(7)
  v_readfirstlane_b32 s53, v23
  s_nop 0
  s_cmp_ge_u32 s53, s52
  s_cselect_b32 s24, 1, 0
  s_cbranch_scc0 F_nopre_71
  s_mov_b32 m0, s25
  s_nop 0
  buffer_load_dwordx4 v2, s[4:7], s20 offen offset:0 sc1 lds
  buffer_load_dwordx4 v2, s[4:7], s20 offen offset:1024 sc1 lds
  buffer_load_dwordx4 v2, s[4:7], s20 offen offset:2048 sc1 lds
  buffer_load_dwordx4 v2, s[4:7], s20 offen offset:3072 sc1 lds
F_nopre_71:
  v_mfma_f32_32x32x16_bf16 v[64:79], a[104:107], v[44:47], v[64:79]
  ds_read_b128 v[36:39], v11 offset:16384
  v_mfma_f32_32x32x16_bf16 v[80:95], a[108:111], v[44:47], v[80:95]
  s_waitcnt lgkmcnt(5)
  buffer_load_dwordx4 v[200:203], v21, s[4:7], s29 offen offset:2048 sc1
  v_mfma_f32_32x32x16_bf16 v[64:79], a[112:115], v[48:51], v[64:79]
  ds_read_b128 v[40:43], v12 offset:16384
  v_mfma_f32_32x32x16_bf16 v[80:95], a[116:119], v[48:51], v[80:95]
  s_waitcnt lgkmcnt(5)
  v_mfma_f32_32x32x16_bf16 v[64:79], a[120:123], v[52:55], v[64:79]
  ds_read_b128 v[44:47], v13 offset:16384
  v_mfma_f32_32x32x16_bf16 v[80:95], a[124:127], v[52:55], v[80:95]
  s_waitcnt lgkmcnt(5)
  buffer_load_dwordx4 v[204:207], v21, s[4:7], s29 offen offset:3072 sc1
  v_mfma_f32_32x32x16_bf16 v[64:79], a[128:131], v[24:27], v[64:79]
  s_add_u32 s28, s19, 83886080
  ds_read_b128 v[48:51], v14 offset:16384
  v_mfma_f32_32x32x16_bf16 v[80:95], a[132:135], v[24:27], v[80:95]
  s_waitcnt lgkmcnt(5)
  v_mfma_f32_32x32x16_bf16 v[64:79], a[136:139], v[28:31], v[64:79]
  ds_read_b128 v[52:55], v15 offset:16384
  v_mfma_f32_32x32x16_bf16 v[80:95], a[140:143], v[28:31], v[80:95]
  s_waitcnt lgkmcnt(5)
  buffer_load_dwordx4 v[208:211], v21, s[4:7], s28 offen offset:0 sc1
  v_mfma_f32_32x32x16_bf16 v[64:79], a[144:147], v[32:35], v[64:79]
  ds_read_b128 v[24:27], v8 offset:24576
  v_mfma_f32_32x32x16_bf16 v[80:95], a[148:151], v[32:35], v[80:95]
  s_waitcnt lgkmcnt(5)
  v_mfma_f32_32x32x16_bf16 v[64:79], a[152:155], v[36:39], v[64:79]
  ds_read_b128 v[28:31], v9 offset:24576
  v_mfma_f32_32x32x16_bf16 v[80:95], a[156:159], v[36:39], v[80:95]
  s_waitcnt lgkmcnt(5)
  buffer_load_dwordx4 v[212:215], v21, s[4:7], s28 offen offset:1024 sc1
  v_mfma_f32_32x32x16_bf16 v[64:79], a[160:163], v[40:43], v[64:79]
  ds_read_b128 v[32:35], v10 offset:24576
  v_mfma_f32_32x32x16_bf16 v[80:95], a[164:167], v[40:43], v[80:95]
  s_waitcnt lgkmcnt(5)
  v_mfma_f32_32x32x16_bf16 v[64:79], a[168:171], v[44:47], v[64:79]
  ds_read_b128 v[36:39], v11 offset:24576
  v_mfma_f32_32x32x16_bf16 v[80:95], a[172:175], v[44:47], v[80:95]
  s_waitcnt lgkmcnt(5)
  buffer_load_dwordx4 v[216:219], v21, s[4:7], s28 offen offset:2048 sc1
  v_mfma_f32_32x32x16_bf16 v[64:79], a[176:179], v[48:51], v[64:79]
  ds_read_b128 v[40:43], v12 offset:24576
  v_mfma_f32_32x32x16_bf16 v[80:95], a[180:183], v[48:51], v[80:95]
  s_waitcnt lgkmcnt(5)
  v_mfma_f32_32x32x16_bf16 v[64:79], a[184:187], v[52:55], v[64:79]
  ds_read_b128 v[44:47], v13 offset:24576
  v_mfma_f32_32x32x16_bf16 v[80:95], a[188:191], v[52:55], v[80:95]
  s_waitcnt lgkmcnt(5)
  buffer_load_dwordx4 v[220:223], v21, s[4:7], s28 offen offset:3072 sc1
  v_mfma_f32_32x32x16_bf16 v[64:79], a[192:195], v[24:27], v[64:79]
  s_add_u32 s29, s19, 83890176
  ds_read_b128 v[48:51], v14 offset:24576
  v_mfma_f32_32x32x16_bf16 v[80:95], a[196:199], v[24:27], v[80:95]
  s_waitcnt lgkmcnt(5)
  v_mfma_f32_32x32x16_bf16 v[64:79], a[200:203], v[28:31], v[64:79]
  ds_read_b128 v[52:55], v15 offset:24576
  v_mfma_f32_32x32x16_bf16 v[80:95], a[204:207], v[28:31], v[80:95]
  s_waitcnt lgkmcnt(5)
  buffer_load_dwordx4 v[224:227], v21, s[4:7], s29 offen offset:0 sc1
  v_mfma_f32_32x32x16_bf16 v[64:79], a[208:211], v[32:35], v[64:79]
  v_mfma_f32_32x32x16_bf16 v[80:95], a[212:215], v[32:35], v[80:95]
  s_waitcnt lgkmcnt(4)
  v_mfma_f32_32x32x16_bf16 v[64:79], a[216:219], v[36:39], v[64:79]
  v_xor_b32 v8, 0x8000, v8
  v_mfma_f32_32x32x16_bf16 v[80:95], a[220:223], v[36:39], v[80:95]
  s_waitcnt lgkmcnt(3)
  buffer_load_dwordx4 v[228:231], v21, s[4:7], s29 offen offset:1024 sc1
  v_xor_b32 v9, 0x8000, v9
  v_mfma_f32_32x32x16_bf16 v[64:79], a[224:227], v[40:43], v[64:79]
  v_xor_b32 v10, 0x8000, v10
  v_mfma_f32_32x32x16_bf16 v[80:95], a[228:231], v[40:43], v[80:95]
  s_waitcnt lgkmcnt(2)
  v_xor_b32 v11, 0x8000, v11
  v_mfma_f32_32x32x16_bf16 v[64:79], a[232:235], v[44:47], v[64:79]
  v_xor_b32 v12, 0x8000, v12
  v_mfma_f32_32x32x16_bf16 v[80:95], a[236:239], v[44:47], v[80:95]
  s_waitcnt lgkmcnt(1)
  buffer_load_dwordx4 v[232:235], v21, s[4:7], s29 offen offset:2048 sc1
  v_xor_b32 v13, 0x8000, v13
  v_mfma_f32_32x32x16_bf16 v[64:79], a[240:243], v[48:51], v[64:79]
  v_xor_b32 v14, 0x8000, v14
  v_mfma_f32_32x32x16_bf16 v[80:95], a[244:247], v[48:51], v[80:95]
  s_waitcnt lgkmcnt(0)
  v_xor_b32 v15, 0x8000, v15
  v_mfma_f32_32x32x16_bf16 v[64:79], a[248:251], v[52:55], v[64:79]
  v_xor_b32 v3, 0x8000, v3
  v_mfma_f32_32x32x16_bf16 v[80:95], a[252:255], v[52:55], v[80:95]
  buffer_load_dwordx4 v[236:239], v21, s[4:7], s29 offen offset:3072 sc1
  s_cmp_gt_u32 s23, 0
  s_cbranch_scc1 F_top_58
  s_nop 2
  v_cvt_pk_bf16_f32 v128, v64, v65
  v_cvt_pk_bf16_f32 v129, v66, v67
  v_cvt_pk_bf16_f32 v130, v68, v69
  v_cvt_pk_bf16_f32 v131, v70, v71
  buffer_store_dwordx4 v[128:131], v22, s[4:7], s21 offen offset:0 sc1
  v_cvt_pk_bf16_f32 v132, v72, v73
  v_cvt_pk_bf16_f32 v133, v74, v75
  v_cvt_pk_bf16_f32 v134, v76, v77
  v_cvt_pk_bf16_f32 v135, v78, v79
  buffer_store_dwordx4 v[132:135], v22, s[4:7], s21 offen offset:1024 sc1
  v_cvt_pk_bf16_f32 v136, v80, v81
  v_cvt_pk_bf16_f32 v137, v82, v83
  v_cvt_pk_bf16_f32 v138, v84, v85
  v_cvt_pk_bf16_f32 v139, v86, v87
  buffer_store_dwordx4 v[136:139], v22, s[4:7], s21 offen offset:2048 sc1
  v_cvt_pk_bf16_f32 v140, v88, v89
  v_cvt_pk_bf16_f32 v141, v90, v91
  v_cvt_pk_bf16_f32 v142, v92, v93
  v_cvt_pk_bf16_f32 v143, v94, v95
  buffer_store_dwordx4 v[140:143], v22, s[4:7], s21 offen offset:3072 sc1
  s_waitcnt vmcnt(0) lgkmcnt(0)
  s_barrier
  v_mov_b32 v144, s30
  v_min_u32 v145, 1, v0
  v_lshlrev_b32 v145, 30, v145
  buffer_store_dword v144, v145, s[4:7], s31 offen sc1
  s_branch M_done
M_team:
  s_mov_b32 s12, s77
  s_load_dwordx4 s[60:63], s[0:1], 64
  s_load_dwordx4 s[64:67], s[0:1], 80
  s_load_dwordx4 s[68:71], s[0:1], 120
  s_load_dwordx2 s[72:73], s[0:1], 56
  v_lshrrev_b32 v1, 6, v0
  v_and_b32 v20, 63, v0
  v_readfirstlane_b32 s13, v1
  s_waitcnt lgkmcnt(0)
  s_mov_b32 s8, s60
  s_and_b32 s9, s61, 0xffff
  s_mov_b32 s10, 0x400000
  s_mov_b32 s11, 0x20000
  s_mov_b32 s40, s62
  s_and_b32 s41, s63, 0xffff
  s_mov_b32 s42, 0x400000
  s_mov_b32 s43, 0x20000
  s_mov_b32 s44, s64
  s_and_b32 s45, s65, 0xffff
  s_mov_b32 s46, 0x400000
  s_mov_b32 s47, 0x20000
  s_mov_b32 s48, s66
  s_and_b32 s49, s67, 0xffff
  s_mov_b32 s50, 0x400000
  s_mov_b32 s51, 0x20000
  s_mov_b32 s4, s70
  s_and_b32 s5, s71, 0xffff
  s_mov_b32 s6, 0x10000000
  s_mov_b32 s7, 0x20000
  s_mov_b32 s76, s72
  s_and_b32 s77, s73, 0xffff
  s_mov_b32 s78, 0x2000
  s_mov_b32 s79, 0x20000
  s_mov_b32 s72, s68
  s_and_b32 s73, s69, 0xffff
  s_mov_b32 s74, 0x100
  s_mov_b32 s75, 0x20000
  s_mov_b64 s[52:53], s[68:69]
  s_mov_b64 s[58:59], s[70:71]
  s_mul_i32 s99, s12, 896
  s_add_u32 s99, s99, 148898048
  s_lshl_b32 s15, s12, 7
  s_add_u32 s15, s15, 148926464
  v_lshrrev_b32 v21, 4, v20
  v_and_b32 v22, 15, v20
  v_and_b32 v23, 1, v21
  v_lshrrev_b32 v24, 1, v21
  v_lshlrev_b32 v2, 4, v20
  s_lshl_b32 s36, s13, 10
  v_add_u32 v59, s36, v2
  s_lshl_b32 s37, s13, 15
  s_add_u32 s37, s37, 32768
  v_add_u32 v4, s37, v2
  v_lshrrev_b32 v25, 2, v20
  v_lshlrev_b32 v25, 13, v25
  v_and_b32 v1, 3, v20
  v_lshl_add_u32 v25, v1, 4, v25
  s_lshl_b32 s36, s13, 6
  s_lshl_b32 s38, s12, 8
  s_add_u32 s36, s36, s38
  v_add_u32 v25, s36, v25
  v_lshrrev_b32 v26, 3, v20
  v_lshlrev_b32 v26, 10, v26
  v_and_b32 v1, 7, v20
  v_lshl_add_u32 v26, v1, 4, v26
  s_lshl_b32 s36, s13, 7
  s_lshl_b32 s38, s12, 17
  s_add_u32 s36, s36, s38
  v_add_u32 v26, s36, v26
  v_bfe_u32 v29, v20, 2, 1
  v_bfe_u32 v30, v20, 3, 1
  v_and_b32 v31, 3, v20
  v_lshl_add_u32 v27, v21, 2, v29
  v_lshlrev_b32 v27, 6, v27
  v_lshl_add_u32 v27, v30, 5, v27
  v_lshl_add_u32 v27, v31, 3, v27
  v_add_u32 v27, s37, v27
  v_xor_b32 v36, 1, v30
  v_lshl_add_u32 v36, v36, 11, v27
  v_lshl_add_u32 v27, v30, 11, v27
  v_lshl_add_u32 v28, v23, 2, v24
  v_lshl_add_u32 v28, v28, 2, v29
  v_lshlrev_b32 v28, 7, v28
  v_lshl_add_u32 v28, v30, 6, v28
  v_lshl_add_u32 v28, v31, 4, v28
  v_add_u32 v28, s37, v28
  s_mov_b32 s39, s37
  s_xor_b32 s36, s13, 0
  s_lshl_b32 s36, s36, 15
  s_add_u32 m0, s39, 0
  s_add_u32 s37, s36, 0
  buffer_load_dwordx4 v26, s[48:51], s37 offen lds
  s_add_u32 m0, s39, 1024
  s_add_u32 s37, s36, 8192
  buffer_load_dwordx4 v26, s[48:51], s37 offen lds
  s_add_u32 m0, s39, 2048
  s_add_u32 s37, s36, 16384
  buffer_load_dwordx4 v26, s[48:51], s37 offen lds
  s_add_u32 m0, s39, 3072
  s_add_u32 s37, s36, 24576
  buffer_load_dwordx4 v26, s[48:51], s37 offen lds
  s_xor_b32 s36, s13, 0
  s_lshl_b32 s36, s36, 15
  s_add_u32 m0, s39, 4096
  s_add_u32 s37, s36, 512
  buffer_load_dwordx4 v26, s[48:51], s37 offen lds
  s_add_u32 m0, s39, 5120
  s_add_u32 s37, s36, 8704
  buffer_load_dwordx4 v26, s[48:51], s37 offen lds
  s_add_u32 m0, s39, 6144
  s_add_u32 s37, s36, 16896
  buffer_load_dwordx4 v26, s[48:51], s37 offen lds
  s_add_u32 m0, s39, 7168
  s_add_u32 s37, s36, 25088
  buffer_load_dwordx4 v26, s[48:51], s37 offen lds
  v_mov_b32 v0, 0x4444
  v_mov_b32 v1, 0xeeee
  v_cmp_lt_u32 vcc, 7, v22
  s_nop 1
  v_cndmask_b32 v32, v0, v1, vcc
  v_mov_b32 v0, v32
  v_and_b32 v32, 7, v20
  v_lshlrev_b32 v32, 4, v32
  v_lshl_add_u32 v11, v21, 7, v32
  v_xor_b32 v1, 128, v2
  v_lshl_add_u32 v33, v24, 4, v22
  s_lshl_b32 s36, s13, 5
  v_add_u32 v33, s36, v33
  v_lshlrev_b32 v33, 3, v33
  v_mul_u32_u24 v34, 1152, v23
  v_add_u32 v5, v33, v34
  v_bfe_u32 v33, v20, 2, 2
  v_lshl_add_u32 v33, v23, 2, v33
  v_lshl_add_u32 v33, v24, 4, v33
  v_lshlrev_b32 v33, 3, v33
  v_and_b32 v34, 1, v20
  v_mul_u32_u24 v34, 1152, v34
  v_add_u32 v6, v33, v34
  s_lshl_b32 s36, s13, 3
  v_lshrrev_b32 v33, 3, v20
  v_add_u32 v33, s36, v33
  v_mul_u32_u24 v34, 0, v33
  v_add_u32 v34, s12, v34
  v_and_b32 v34, 31, v34
  v_lshrrev_b32 v37, 1, v32
  v_lshl_add_u32 v33, v33, 13, v37
  v_lshl_add_u32 v7, v34, 7, v33
  v_and_b32 v37, 1, v20
  v_bfe_u32 v38, v20, 1, 1
  v_lshl_add_u32 v37, v29, 1, v37
  s_lshr_b32 s36, s12, 3
  s_lshl_b32 s36, s36, 10
  s_and_b32 s37, s12, 1
  s_lshl_b32 s37, s37, 9
  s_add_u32 s36, s36, s37
  s_and_b32 s37, s12, 6
  s_lshl_b32 s37, s37, 5
  s_add_u32 s36, s36, s37
  v_lshlrev_b32 v33, 4, v21
  v_lshl_add_u32 v33, v37, 2, v33
  v_lshl_add_u32 v33, v38, 8, v33
  v_lshl_add_u32 v33, v30, 30, v33
  v_add_u32 v8, s36, v33
  v_mov_b32 v3, v2
  v_mov_b32 v39, v21
  s_lshr_b32 s36, s12, 2
  s_lshl_b32 s36, s36, 6
  s_and_b32 s37, s12, 1
  s_lshl_b32 s37, s37, 5
  s_add_u32 s36, s36, s37
  s_and_b32 s37, s12, 2
  s_lshl_b32 s37, s37, 11
  s_add_u32 s36, s36, s37
  v_lshlrev_b32 v35, 10, v39
  v_lshl_add_u32 v35, v37, 2, v35
  v_lshl_add_u32 v35, v38, 4, v35
  v_add_u32 v35, s36, v35
  buffer_load_ushort v44, v35, s[76:79], 0 offen offset:0
  buffer_load_ushort v45, v35, s[76:79], 0 offen offset:2
  buffer_load_ushort v46, v35, s[76:79], 0 offen offset:512
  buffer_load_ushort v47, v35, s[76:79], 0 offen offset:514
  v_lshlrev_b32 v33, 4, v29
  v_mov_b32 v34, 0x3f80
  v_lshlrev_b32 v33, v33, v34
  v_and_b32 v34, 1, v20
  v_lshl_add_u32 v34, v34, 1, v30
  v_cmp_eq_u32 vcc, 0, v34
  s_nop 1
  v_cndmask_b32 v48, 0, v33, vcc
  v_cmp_eq_u32 vcc, 1, v34
  s_nop 1
  v_cndmask_b32 v49, 0, v33, vcc
  v_cmp_eq_u32 vcc, 2, v34
  s_nop 1
  v_cndmask_b32 v50, 0, v33, vcc
  v_cmp_eq_u32 vcc, 3, v34
  s_nop 1
  v_cndmask_b32 v51, 0, v33, vcc
  ds_write_b128 v2, v[48:51] offset:31232
  v_lshlrev_b32 v33, 9, v21
  s_lshl_b32 s36, s13, 11
  v_add_u32 v33, s36, v33
  v_lshl_add_u32 v10, v22, 4, v33
  v_lshl_add_u32 v33, v30, 8, v33
  v_add_u32 v9, v33, v32
  v_mov_b32 v12, 0x3f803f80
  v_mov_b32 v13, 0x3f803f80
  v_mov_b32 v14, 0x3f803f80
  v_mov_b32 v15, 0x3f803f80
  s_mov_b32 s2, 0x3f803f80
  s_mov_b32 s3, 0x3f803f80
  s_mov_b32 s98, 0
  v_and_b32 v33, 1, v20
  v_mul_u32_u24 v33, 128, v33
  v_min_u32 v34, 1, v20
  v_lshlrev_b32 v34, 30, v34
  s_cmp_eq_u32 s13, 3
  s_cselect_b64 vcc, -1, 0
  v_cndmask_b32 v19, v34, v33, vcc
  v_mov_b64 v[60:61], 0
  v_mov_b32 v62, 32256
  ds_write_b64 v62, v[60:61]
  s_mov_b32 s16, 0
  s_mov_b32 s17, -1
  s_mov_b32 s18, 0x3e0293ee
  s_mov_b32 s54, 0x2f800000
  s_mov_b32 s55, 0x28000000
  s_lshl_b32 s36, s13, 10
  s_add_u32 s31, s36, 8192
  s_add_u32 s32, s36, 12160
  s_add_u32 s33, s36, 16384
  s_add_u32 s34, s36, 20224
  s_lshl_b32 s36, s12, 19
  s_add_u32 s27, s36, 67108864
  s_add_u32 s28, s36, 83886080
  s_mul_i32 s36, s12, 4096
  s_add_u32 s29, s36, 135266304
  s_lshl_b32 s36, s12, 13
  s_add_u32 s22, s36, 144703488
  s_add_u32 s23, s36, 144707584
  s_mov_b32 s20, 144703488
  s_mov_b32 s21, 144707584
  v_mov_b32 v40, -1
  v_mov_b32 v41, -1
  v_mov_b32 v42, -1
  v_mov_b32 v43, -1
  s_lshl_b32 s36, s13, 13
  s_add_u32 s36, s36, 145752064
  s_add_u32 s37, s36, 4096
  buffer_store_dwordx4 v[40:43], v59, s[4:7], s22 offen sc1
  buffer_store_dwordx4 v[40:43], v59, s[4:7], s23 offen sc1
  buffer_store_dword v40, v8, s[4:7], s36 offen sc1
  buffer_store_dword v40, v8, s[4:7], s37 offen sc1
  v_mov_b32 v52, 0
  v_min_u32 v53, 1, v59
  v_lshlrev_b32 v53, 30, v53
  buffer_store_dword v52, v53, s[4:7], s15 offen sc1
  s_xor_b32 s36, s13, 1
  s_lshl_b32 s36, s36, 15
  s_add_u32 m0, s39, 8192
  s_add_u32 s37, s36, 0
  buffer_load_dwordx4 v26, s[48:51], s37 offen lds
  s_add_u32 m0, s39, 9216
  s_add_u32 s37, s36, 8192
  buffer_load_dwordx4 v26, s[48:51], s37 offen lds
  s_add_u32 m0, s39, 10240
  s_add_u32 s37, s36, 16384
  buffer_load_dwordx4 v26, s[48:51], s37 offen lds
  s_add_u32 m0, s39, 11264
  s_add_u32 s37, s36, 24576
  buffer_load_dwordx4 v26, s[48:51], s37 offen lds
  s_xor_b32 s36, s13, 1
  s_lshl_b32 s36, s36, 15
  s_add_u32 m0, s39, 12288
  s_add_u32 s37, s36, 512
  buffer_load_dwordx4 v26, s[48:51], s37 offen lds
  s_add_u32 m0, s39, 13312
  s_add_u32 s37, s36, 8704
  buffer_load_dwordx4 v26, s[48:51], s37 offen lds
  s_add_u32 m0, s39, 14336
  s_add_u32 s37, s36, 16896
  buffer_load_dwordx4 v26, s[48:51], s37 offen lds
  s_add_u32 m0, s39, 15360
  s_add_u32 s37, s36, 25088
  buffer_load_dwordx4 v26, s[48:51], s37 offen lds
  s_waitcnt vmcnt(21)
  ds_read_b64_tr_b16 a[160:161], v28 offset:0
  ds_read_b64_tr_b16 a[162:163], v28 offset:256
  ds_read_b64_tr_b16 a[164:165], v28 offset:1024
  ds_read_b64_tr_b16 a[166:167], v28 offset:1280
  ds_read_b64_tr_b16 a[168:169], v28 offset:8
  ds_read_b64_tr_b16 a[170:171], v28 offset:264
  ds_read_b64_tr_b16 a[172:173], v28 offset:1032
  ds_read_b64_tr_b16 a[174:175], v28 offset:1288
  s_waitcnt lgkmcnt(0)
  s_xor_b32 s36, s13, 2
  s_lshl_b32 s36, s36, 15
  s_add_u32 m0, s39, 0
  s_add_u32 s37, s36, 0
  buffer_load_dwordx4 v26, s[48:51], s37 offen lds
  s_add_u32 m0, s39, 1024
  s_add_u32 s37, s36, 8192
  buffer_load_dwordx4 v26, s[48:51], s37 offen lds
  s_add_u32 m0, s39, 2048
  s_add_u32 s37, s36, 16384
  buffer_load_dwordx4 v26, s[48:51], s37 offen lds
  s_add_u32 m0, s39, 3072
  s_add_u32 s37, s36, 24576
  buffer_load_dwordx4 v26, s[48:51], s37 offen lds
  s_waitcnt vmcnt(21)
  ds_read_b64_tr_b16 a[176:177], v28 offset:4096
  ds_read_b64_tr_b16 a[178:179], v28 offset:4352
  ds_read_b64_tr_b16 a[180:181], v28 offset:5120
  ds_read_b64_tr_b16 a[182:183], v28 offset:5376
  ds_read_b64_tr_b16 a[184:185], v28 offset:4104
  ds_read_b64_tr_b16 a[186:187], v28 offset:4360
  ds_read_b64_tr_b16 a[188:189], v28 offset:5128
  ds_read_b64_tr_b16 a[190:191], v28 offset:5384
  s_waitcnt lgkmcnt(0)
  s_xor_b32 s36, s13, 3
  s_lshl_b32 s36, s36, 15
  s_add_u32 m0, s39, 4096
  s_add_u32 s37, s36, 0
  buffer_load_dwordx4 v26, s[48:51], s37 offen lds
  s_add_u32 m0, s39, 5120
  s_add_u32 s37, s36, 8192
  buffer_load_dwordx4 v26, s[48:51], s37 offen lds
  s_add_u32 m0, s39, 6144
  s_add_u32 s37, s36, 16384
  buffer_load_dwordx4 v26, s[48:51], s37 offen lds
  s_add_u32 m0, s39, 7168
  s_add_u32 s37, s36, 24576
  buffer_load_dwordx4 v26, s[48:51], s37 offen lds
  s_waitcnt vmcnt(12)
  ds_read_b64_tr_b16 a[192:193], v28 offset:8192
  ds_read_b64_tr_b16 a[194:195], v28 offset:8448
  ds_read_b64_tr_b16 a[196:197], v28 offset:9216
  ds_read_b64_tr_b16 a[198:199], v28 offset:9472
  ds_read_b64_tr_b16 a[200:201], v28 offset:8200
  ds_read_b64_tr_b16 a[202:203], v28 offset:8456
  ds_read_b64_tr_b16 a[204:205], v28 offset:9224
  ds_read_b64_tr_b16 a[206:207], v28 offset:9480
  s_waitcnt lgkmcnt(0)
  s_xor_b32 s36, s13, 2
  s_lshl_b32 s36, s36, 19
  s_add_u32 m0, s39, 8192
  s_add_u32 s37, s36, 0
  buffer_load_dwordx4 v25, s[8:11], s37 offen lds
  s_add_u32 m0, s39, 9216
  s_add_u32 s37, s36, 131072
  buffer_load_dwordx4 v25, s[8:11], s37 offen lds
  s_add_u32 m0, s39, 10240
  s_add_u32 s37, s36, 262144
  buffer_load_dwordx4 v25, s[8:11], s37 offen lds
  s_add_u32 m0, s39, 11264
  s_add_u32 s37, s36, 393216
  buffer_load_dwordx4 v25, s[8:11], s37 offen lds
  s_barrier
  s_cmp_lg_u32 s13, 0
  s_cbranch_scc1 T_arm_72
  s_getreg_b32 s36, hwreg(HW_REG_XCC_ID, 0, 3)
  s_lshl_b32 s36, s36, 3
  s_lshl_b64 s[60:61], 1, s36
  s_mov_b32 s62, 1
  s_atomic_add_x2 s[60:61], s[52:53], 0
  s_atomic_add s62, s[52:53], 128
  v_lshl_or_b32 v44, v45, 16, v44
  v_lshl_or_b32 v46, v47, 16, v46
  v_min_u32 v44, -2, v44
  v_min_u32 v46, -2, v46
  s_mov_b32 s36, 145752064
  s_mov_b32 s37, 145756160
  buffer_store_dword v44, v8, s[4:7], s36 offen sc1
  buffer_store_dword v46, v8, s[4:7], s37 offen sc1
T_arm_72:
  s_waitcnt vmcnt(12)
  ds_read_b64_tr_b16 a[208:209], v28 offset:12288
  ds_read_b64_tr_b16 a[210:211], v28 offset:12544
  ds_read_b64_tr_b16 a[212:213], v28 offset:13312
  ds_read_b64_tr_b16 a[214:215], v28 offset:13568
  ds_read_b64_tr_b16 a[216:217], v28 offset:12296
  ds_read_b64_tr_b16 a[218:219], v28 offset:12552
  ds_read_b64_tr_b16 a[220:221], v28 offset:13320
  ds_read_b64_tr_b16 a[222:223], v28 offset:13576
  s_waitcnt lgkmcnt(0)
  s_xor_b32 s36, s13, 3
  s_lshl_b32 s36, s36, 19
  s_add_u32 m0, s39, 12288
  s_add_u32 s37, s36, 0
  buffer_load_dwordx4 v25, s[8:11], s37 offen lds
  s_add_u32 m0, s39, 13312
  s_add_u32 s37, s36, 131072
  buffer_load_dwordx4 v25, s[8:11], s37 offen lds
  s_add_u32 m0, s39, 14336
  s_add_u32 s37, s36, 262144
  buffer_load_dwordx4 v25, s[8:11], s37 offen lds
  s_add_u32 m0, s39, 15360
  s_add_u32 s37, s36, 393216
  buffer_load_dwordx4 v25, s[8:11], s37 offen lds
  s_waitcnt vmcnt(12)
  ds_read_b64_tr_b16 a[224:225], v28 offset:0
  ds_read_b64_tr_b16 a[226:227], v28 offset:256
  ds_read_b64_tr_b16 a[228:229], v28 offset:1024
  ds_read_b64_tr_b16 a[230:231], v28 offset:1280
  ds_read_b64_tr_b16 a[232:233], v28 offset:8
  ds_read_b64_tr_b16 a[234:235], v28 offset:264
  ds_read_b64_tr_b16 a[236:237], v28 offset:1032
  ds_read_b64_tr_b16 a[238:239], v28 offset:1288
  s_waitcnt lgkmcnt(0)
  s_xor_b32 s36, s13, 4
  s_lshl_b32 s36, s36, 19
  s_add_u32 m0, s39, 0
  s_add_u32 s37, s36, 0
  buffer_load_dwordx4 v25, s[8:11], s37 offen lds
  s_add_u32 m0, s39, 1024
  s_add_u32 s37, s36, 131072
  buffer_load_dwordx4 v25, s[8:11], s37 offen lds
  s_add_u32 m0, s39, 2048
  s_add_u32 s37, s36, 262144
  buffer_load_dwordx4 v25, s[8:11], s37 offen lds
  s_add_u32 m0, s39, 3072
  s_add_u32 s37, s36, 393216
  buffer_load_dwordx4 v25, s[8:11], s37 offen lds
  s_waitcnt vmcnt(12)
  ds_read_b64_tr_b16 a[240:241], v28 offset:4096
  ds_read_b64_tr_b16 a[242:243], v28 offset:4352
  ds_read_b64_tr_b16 a[244:245], v28 offset:5120
  ds_read_b64_tr_b16 a[246:247], v28 offset:5376
  ds_read_b64_tr_b16 a[248:249], v28 offset:4104
  ds_read_b64_tr_b16 a[250:251], v28 offset:4360
  ds_read_b64_tr_b16 a[252:253], v28 offset:5128
  ds_read_b64_tr_b16 a[254:255], v28 offset:5384
  s_waitcnt lgkmcnt(0)
  s_xor_b32 s36, s13, 5
  s_lshl_b32 s36, s36, 19
  s_add_u32 m0, s39, 4096
  s_add_u32 s37, s36, 0
  buffer_load_dwordx4 v25, s[8:11], s37 offen lds
  s_add_u32 m0, s39, 5120
  s_add_u32 s37, s36, 131072
  buffer_load_dwordx4 v25, s[8:11], s37 offen lds
  s_add_u32 m0, s39, 6144
  s_add_u32 s37, s36, 262144
  buffer_load_dwordx4 v25, s[8:11], s37 offen lds
  s_add_u32 m0, s39, 7168
  s_add_u32 s37, s36, 393216
  buffer_load_dwordx4 v25, s[8:11], s37 offen lds
  s_waitcnt vmcnt(12)
  ds_read_b64_tr_b16 v[160:161], v27 offset:8192
  ds_read_b64_tr_b16 v[162:163], v27 offset:8320
  ds_read_b64_tr_b16 v[164:165], v27 offset:9216
  ds_read_b64_tr_b16 v[166:167], v27 offset:9344
  ds_read_b64_tr_b16 v[168:169], v36 offset:8192
  ds_read_b64_tr_b16 v[170:171], v36 offset:8320
  ds_read_b64_tr_b16 v[172:173], v36 offset:9216
  ds_read_b64_tr_b16 v[174:175], v36 offset:9344
  s_waitcnt lgkmcnt(0)
  s_xor_b32 s36, s13, 4
  s_lshl_b32 s36, s36, 19
  s_add_u32 m0, s39, 8192
  s_add_u32 s37, s36, 0
  buffer_load_dwordx4 v25, s[40:43], s37 offen lds
  s_add_u32 m0, s39, 9216
  s_add_u32 s37, s36, 131072
  buffer_load_dwordx4 v25, s[40:43], s37 offen lds
  s_add_u32 m0, s39, 10240
  s_add_u32 s37, s36, 262144
  buffer_load_dwordx4 v25, s[40:43], s37 offen lds
  s_add_u32 m0, s39, 11264
  s_add_u32 s37, s36, 393216
  buffer_load_dwordx4 v25, s[40:43], s37 offen lds
  s_waitcnt vmcnt(12)
  ds_read_b64_tr_b16 v[192:193], v27 offset:12288
  ds_read_b64_tr_b16 v[194:195], v27 offset:12416
  ds_read_b64_tr_b16 v[196:197], v27 offset:13312
  ds_read_b64_tr_b16 v[198:199], v27 offset:13440
  ds_read_b64_tr_b16 v[200:201], v36 offset:12288
  ds_read_b64_tr_b16 v[202:203], v36 offset:12416
  ds_read_b64_tr_b16 v[204:205], v36 offset:13312
  ds_read_b64_tr_b16 v[206:207], v36 offset:13440
  s_waitcnt lgkmcnt(0)
  s_xor_b32 s36, s13, 5
  s_lshl_b32 s36, s36, 19
  s_add_u32 m0, s39, 12288
  s_add_u32 s37, s36, 0
  buffer_load_dwordx4 v25, s[40:43], s37 offen lds
  s_add_u32 m0, s39, 13312
  s_add_u32 s37, s36, 131072
  buffer_load_dwordx4 v25, s[40:43], s37 offen lds
  s_add_u32 m0, s39, 14336
  s_add_u32 s37, s36, 262144
  buffer_load_dwordx4 v25, s[40:43], s37 offen lds
  s_add_u32 m0, s39, 15360
  s_add_u32 s37, s36, 393216
  buffer_load_dwordx4 v25, s[40:43], s37 offen lds
  s_waitcnt vmcnt(12)
  ds_read_b64_tr_b16 v[224:225], v27 offset:0
  ds_read_b64_tr_b16 v[226:227], v27 offset:128
  ds_read_b64_tr_b16 v[228:229], v27 offset:1024
  ds_read_b64_tr_b16 v[230:231], v27 offset:1152
  ds_read_b64_tr_b16 v[232:233], v36 offset:0
  ds_read_b64_tr_b16 v[234:235], v36 offset:128
  ds_read_b64_tr_b16 v[236:237], v36 offset:1024
  ds_read_b64_tr_b16 v[238:239], v36 offset:1152
  s_waitcnt lgkmcnt(0)
  s_xor_b32 s36, s13, 4
  s_lshl_b32 s36, s36, 19
  s_add_u32 m0, s39, 0
  s_add_u32 s37, s36, 0
  buffer_load_dwordx4 v25, s[44:47], s37 offen lds
  s_add_u32 m0, s39, 1024
  s_add_u32 s37, s36, 131072
  buffer_load_dwordx4 v25, s[44:47], s37 offen lds
  s_add_u32 m0, s39, 2048
  s_add_u32 s37, s36, 262144
  buffer_load_dwordx4 v25, s[44:47], s37 offen lds
  s_add_u32 m0, s39, 3072
  s_add_u32 s37, s36, 393216
  buffer_load_dwordx4 v25, s[44:47], s37 offen lds
  s_waitcnt vmcnt(12)
  ds_read_b64_tr_b16 a[16:17], v27 offset:4096
  ds_read_b64_tr_b16 a[18:19], v27 offset:4224
  ds_read_b64_tr_b16 a[20:21], v27 offset:5120
  ds_read_b64_tr_b16 a[22:23], v27 offset:5248
  ds_read_b64_tr_b16 a[24:25], v36 offset:4096
  ds_read_b64_tr_b16 a[26:27], v36 offset:4224
  ds_read_b64_tr_b16 a[28:29], v36 offset:5120
  ds_read_b64_tr_b16 a[30:31], v36 offset:5248
  s_waitcnt lgkmcnt(0)
  s_xor_b32 s36, s13, 5
  s_lshl_b32 s36, s36, 19
  s_add_u32 m0, s39, 4096
  s_add_u32 s37, s36, 0
  buffer_load_dwordx4 v25, s[44:47], s37 offen lds
  s_add_u32 m0, s39, 5120
  s_add_u32 s37, s36, 131072
  buffer_load_dwordx4 v25, s[44:47], s37 offen lds
  s_add_u32 m0, s39, 6144
  s_add_u32 s37, s36, 262144
  buffer_load_dwordx4 v25, s[44:47], s37 offen lds
  s_add_u32 m0, s39, 7168
  s_add_u32 s37, s36, 393216
  buffer_load_dwordx4 v25, s[44:47], s37 offen lds
  s_waitcnt vmcnt(12)
  ds_read_b64_tr_b16 v[240:241], v27 offset:8192
  ds_read_b64_tr_b16 v[242:243], v27 offset:8320
  ds_read_b64_tr_b16 v[244:245], v27 offset:9216
  ds_read_b64_tr_b16 v[246:247], v27 offset:9344
  ds_read_b64_tr_b16 v[248:249], v36 offset:8192
  ds_read_b64_tr_b16 v[250:251], v36 offset:8320
  ds_read_b64_tr_b16 v[252:253], v36 offset:9216
  ds_read_b64_tr_b16 v[254:255], v36 offset:9344
  s_waitcnt lgkmcnt(0)
  s_xor_b32 s36, s13, 6
  s_lshl_b32 s36, s36, 19
  s_add_u32 m0, s39, 8192
  s_add_u32 s37, s36, 0
  buffer_load_dwordx4 v25, s[8:11], s37 offen lds
  s_add_u32 m0, s39, 9216
  s_add_u32 s37, s36, 131072
  buffer_load_dwordx4 v25, s[8:11], s37 offen lds
  s_add_u32 m0, s39, 10240
  s_add_u32 s37, s36, 262144
  buffer_load_dwordx4 v25, s[8:11], s37 offen lds
  s_add_u32 m0, s39, 11264
  s_add_u32 s37, s36, 393216
  buffer_load_dwordx4 v25, s[8:11], s37 offen lds
  s_waitcnt vmcnt(12)
  ds_read_b64_tr_b16 a[32:33], v27 offset:12288
  ds_read_b64_tr_b16 a[34:35], v27 offset:12416
  ds_read_b64_tr_b16 a[36:37], v27 offset:13312
  ds_read_b64_tr_b16 a[38:39], v27 offset:13440
  ds_read_b64_tr_b16 a[40:41], v36 offset:12288
  ds_read_b64_tr_b16 a[42:43], v36 offset:12416
  ds_read_b64_tr_b16 a[44:45], v36 offset:13312
  ds_read_b64_tr_b16 a[46:47], v36 offset:13440
  s_waitcnt lgkmcnt(0)
  s_xor_b32 s36, s13, 7
  s_lshl_b32 s36, s36, 19
  s_add_u32 m0, s39, 12288
  s_add_u32 s37, s36, 0
  buffer_load_dwordx4 v25, s[8:11], s37 offen lds
  s_add_u32 m0, s39, 13312
  s_add_u32 s37, s36, 131072
  buffer_load_dwordx4 v25, s[8:11], s37 offen lds
  s_add_u32 m0, s39, 14336
  s_add_u32 s37, s36, 262144
  buffer_load_dwordx4 v25, s[8:11], s37 offen lds
  s_add_u32 m0, s39, 15360
  s_add_u32 s37, s36, 393216
  buffer_load_dwordx4 v25, s[8:11], s37 offen lds
  s_waitcnt vmcnt(12)
  ds_read_b64_tr_b16 a[0:1], v27 offset:0
  ds_read_b64_tr_b16 a[2:3], v27 offset:128
  ds_read_b64_tr_b16 a[4:5], v27 offset:1024
  ds_read_b64_tr_b16 a[6:7], v27 offset:1152
  ds_read_b64_tr_b16 a[8:9], v36 offset:0
  ds_read_b64_tr_b16 a[10:11], v36 offset:128
  ds_read_b64_tr_b16 a[12:13], v36 offset:1024
  ds_read_b64_tr_b16 a[14:15], v36 offset:1152
  s_waitcnt lgkmcnt(0)
  s_xor_b32 s36, s13, 6
  s_lshl_b32 s36, s36, 19
  s_add_u32 m0, s39, 0
  s_add_u32 s37, s36, 0
  buffer_load_dwordx4 v25, s[40:43], s37 offen lds
  s_add_u32 m0, s39, 1024
  s_add_u32 s37, s36, 131072
  buffer_load_dwordx4 v25, s[40:43], s37 offen lds
  s_add_u32 m0, s39, 2048
  s_add_u32 s37, s36, 262144
  buffer_load_dwordx4 v25, s[40:43], s37 offen lds
  s_add_u32 m0, s39, 3072
  s_add_u32 s37, s36, 393216
  buffer_load_dwordx4 v25, s[40:43], s37 offen lds
  s_waitcnt vmcnt(12)
  ds_read_b64_tr_b16 a[48:49], v27 offset:4096
  ds_read_b64_tr_b16 a[50:51], v27 offset:4224
  ds_read_b64_tr_b16 a[52:53], v27 offset:5120
  ds_read_b64_tr_b16 a[54:55], v27 offset:5248
  ds_read_b64_tr_b16 a[56:57], v36 offset:4096
  ds_read_b64_tr_b16 a[58:59], v36 offset:4224
  ds_read_b64_tr_b16 a[60:61], v36 offset:5120
  ds_read_b64_tr_b16 a[62:63], v36 offset:5248
  s_waitcnt lgkmcnt(0)
  s_xor_b32 s36, s13, 7
  s_lshl_b32 s36, s36, 19
  s_add_u32 m0, s39, 4096
  s_add_u32 s37, s36, 0
  buffer_load_dwordx4 v25, s[40:43], s37 offen lds
  s_add_u32 m0, s39, 5120
  s_add_u32 s37, s36, 131072
  buffer_load_dwordx4 v25, s[40:43], s37 offen lds
  s_add_u32 m0, s39, 6144
  s_add_u32 s37, s36, 262144
  buffer_load_dwordx4 v25, s[40:43], s37 offen lds
  s_add_u32 m0, s39, 7168
  s_add_u32 s37, s36, 393216
  buffer_load_dwordx4 v25, s[40:43], s37 offen lds
  s_waitcnt vmcnt(12)
  ds_read_b64_tr_b16 a[64:65], v27 offset:8192
  ds_read_b64_tr_b16 a[66:67], v27 offset:8320
  ds_read_b64_tr_b16 a[68:69], v27 offset:9216
  ds_read_b64_tr_b16 a[70:71], v27 offset:9344
  ds_read_b64_tr_b16 a[72:73], v36 offset:8192
  ds_read_b64_tr_b16 a[74:75], v36 offset:8320
  ds_read_b64_tr_b16 a[76:77], v36 offset:9216
  ds_read_b64_tr_b16 a[78:79], v36 offset:9344
  s_waitcnt lgkmcnt(0)
  s_xor_b32 s36, s13, 6
  s_lshl_b32 s36, s36, 19
  s_add_u32 m0, s39, 8192
  s_add_u32 s37, s36, 0
  buffer_load_dwordx4 v25, s[44:47], s37 offen lds
  s_add_u32 m0, s39, 9216
  s_add_u32 s37, s36, 131072
  buffer_load_dwordx4 v25, s[44:47], s37 offen lds
  s_add_u32 m0, s39, 10240
  s_add_u32 s37, s36, 262144
  buffer_load_dwordx4 v25, s[44:47], s37 offen lds
  s_add_u32 m0, s39, 11264
  s_add_u32 s37, s36, 393216
  buffer_load_dwordx4 v25, s[44:47], s37 offen lds
  s_waitcnt vmcnt(12)
  ds_read_b64_tr_b16 a[112:113], v27 offset:12288
  ds_read_b64_tr_b16 a[114:115], v27 offset:12416
  ds_read_b64_tr_b16 a[116:117], v27 offset:13312
  ds_read_b64_tr_b16 a[118:119], v27 offset:13440
  ds_read_b64_tr_b16 a[120:121], v36 offset:12288
  ds_read_b64_tr_b16 a[122:123], v36 offset:12416
  ds_read_b64_tr_b16 a[124:125], v36 offset:13312
  ds_read_b64_tr_b16 a[126:127], v36 offset:13440
  s_waitcnt lgkmcnt(0)
  s_xor_b32 s36, s13, 7
  s_lshl_b32 s36, s36, 19
  s_add_u32 m0, s39, 12288
  s_add_u32 s37, s36, 0
  buffer_load_dwordx4 v25, s[44:47], s37 offen lds
  s_add_u32 m0, s39, 13312
  s_add_u32 s37, s36, 131072
  buffer_load_dwordx4 v25, s[44:47], s37 offen lds
  s_add_u32 m0, s39, 14336
  s_add_u32 s37, s36, 262144
  buffer_load_dwordx4 v25, s[44:47], s37 offen lds
  s_add_u32 m0, s39, 15360
  s_add_u32 s37, s36, 393216
  buffer_load_dwordx4 v25, s[44:47], s37 offen lds
  s_waitcnt vmcnt(12)
  ds_read_b64_tr_b16 a[80:81], v27 offset:0
  ds_read_b64_tr_b16 a[82:83], v27 offset:128
  ds_read_b64_tr_b16 a[84:85], v27 offset:1024
  ds_read_b64_tr_b16 a[86:87], v27 offset:1152
  ds_read_b64_tr_b16 a[88:89], v36 offset:0
  ds_read_b64_tr_b16 a[90:91], v36 offset:128
  ds_read_b64_tr_b16 a[92:93], v36 offset:1024
  ds_read_b64_tr_b16 a[94:95], v36 offset:1152
  s_waitcnt lgkmcnt(0)
  s_xor_b32 s36, s13, 1
  s_lshl_b32 s36, s36, 19
  s_add_u32 m0, s39, 16384
  s_add_u32 s37, s36, 0
  buffer_load_dwordx4 v25, s[8:11], s37 offen lds
  s_add_u32 m0, s39, 17408
  s_add_u32 s37, s36, 131072
  buffer_load_dwordx4 v25, s[8:11], s37 offen lds
  s_add_u32 m0, s39, 18432
  s_add_u32 s37, s36, 262144
  buffer_load_dwordx4 v25, s[8:11], s37 offen lds
  s_add_u32 m0, s39, 19456
  s_add_u32 s37, s36, 393216
  buffer_load_dwordx4 v25, s[8:11], s37 offen lds
  s_waitcnt vmcnt(12)
  ds_read_b64_tr_b16 a[128:129], v27 offset:4096
  ds_read_b64_tr_b16 a[130:131], v27 offset:4224
  ds_read_b64_tr_b16 a[132:133], v27 offset:5120
  ds_read_b64_tr_b16 a[134:135], v27 offset:5248
  ds_read_b64_tr_b16 a[136:137], v36 offset:4096
  ds_read_b64_tr_b16 a[138:139], v36 offset:4224
  ds_read_b64_tr_b16 a[140:141], v36 offset:5120
  ds_read_b64_tr_b16 a[142:143], v36 offset:5248
  s_waitcnt lgkmcnt(0)
  s_xor_b32 s36, s13, 0
  s_lshl_b32 s36, s36, 19
  s_add_u32 m0, s39, 0
  s_add_u32 s37, s36, 0
  buffer_load_dwordx4 v25, s[8:11], s37 offen lds
  s_add_u32 m0, s39, 1024
  s_add_u32 s37, s36, 131072
  buffer_load_dwordx4 v25, s[8:11], s37 offen lds
  s_add_u32 m0, s39, 2048
  s_add_u32 s37, s36, 262144
  buffer_load_dwordx4 v25, s[8:11], s37 offen lds
  s_add_u32 m0, s39, 3072
  s_add_u32 s37, s36, 393216
  buffer_load_dwordx4 v25, s[8:11], s37 offen lds
  s_waitcnt vmcnt(12)
  ds_read_b64_tr_b16 a[96:97], v27 offset:8192
  ds_read_b64_tr_b16 a[98:99], v27 offset:8320
  ds_read_b64_tr_b16 a[100:101], v27 offset:9216
  ds_read_b64_tr_b16 a[102:103], v27 offset:9344
  ds_read_b64_tr_b16 a[104:105], v36 offset:8192
  ds_read_b64_tr_b16 a[106:107], v36 offset:8320
  ds_read_b64_tr_b16 a[108:109], v36 offset:9216
  ds_read_b64_tr_b16 a[110:111], v36 offset:9344
  s_waitcnt lgkmcnt(0)
  s_xor_b32 s36, s13, 1
  s_lshl_b32 s36, s36, 19
  s_add_u32 m0, s39, 8192
  s_add_u32 s37, s36, 0
  buffer_load_dwordx4 v25, s[40:43], s37 offen lds
  s_add_u32 m0, s39, 9216
  s_add_u32 s37, s36, 131072
  buffer_load_dwordx4 v25, s[40:43], s37 offen lds
  s_add_u32 m0, s39, 10240
  s_add_u32 s37, s36, 262144
  buffer_load_dwordx4 v25, s[40:43], s37 offen lds
  s_add_u32 m0, s39, 11264
  s_add_u32 s37, s36, 393216
  buffer_load_dwordx4 v25, s[40:43], s37 offen lds
  s_waitcnt vmcnt(12)
  ds_read_b64_tr_b16 a[144:145], v27 offset:12288
  ds_read_b64_tr_b16 a[146:147], v27 offset:12416
  ds_read_b64_tr_b16 a[148:149], v27 offset:13312
  ds_read_b64_tr_b16 a[150:151], v27 offset:13440
  ds_read_b64_tr_b16 a[152:153], v36 offset:12288
  ds_read_b64_tr_b16 a[154:155], v36 offset:12416
  ds_read_b64_tr_b16 a[156:157], v36 offset:13312
  ds_read_b64_tr_b16 a[158:159], v36 offset:13440
  s_waitcnt lgkmcnt(0)
  s_xor_b32 s36, s13, 0
  s_lshl_b32 s36, s36, 19
  s_add_u32 m0, s39, 4096
  s_add_u32 s37, s36, 0
  buffer_load_dwordx4 v25, s[40:43], s37 offen lds
  s_add_u32 m0, s39, 5120
  s_add_u32 s37, s36, 131072
  buffer_load_dwordx4 v25, s[40:43], s37 offen lds
  s_add_u32 m0, s39, 6144
  s_add_u32 s37, s36, 262144
  buffer_load_dwordx4 v25, s[40:43], s37 offen lds
  s_add_u32 m0, s39, 7168
  s_add_u32 s37, s36, 393216
  buffer_load_dwordx4 v25, s[40:43], s37 offen lds
  s_waitcnt vmcnt(12)
  ds_read_b64_tr_b16 v[128:129], v27 offset:16384
  ds_read_b64_tr_b16 v[130:131], v27 offset:16512
  ds_read_b64_tr_b16 v[132:133], v27 offset:17408
  ds_read_b64_tr_b16 v[134:135], v27 offset:17536
  ds_read_b64_tr_b16 v[136:137], v36 offset:16384
  ds_read_b64_tr_b16 v[138:139], v36 offset:16512
  ds_read_b64_tr_b16 v[140:141], v36 offset:17408
  ds_read_b64_tr_b16 v[142:143], v36 offset:17536
  s_waitcnt lgkmcnt(0)
  s_xor_b32 s36, s13, 2
  s_lshl_b32 s36, s36, 19
  s_add_u32 m0, s39, 12288
  s_add_u32 s37, s36, 0
  buffer_load_dwordx4 v25, s[40:43], s37 offen lds
  s_add_u32 m0, s39, 13312
  s_add_u32 s37, s36, 131072
  buffer_load_dwordx4 v25, s[40:43], s37 offen lds
  s_add_u32 m0, s39, 14336
  s_add_u32 s37, s36, 262144
  buffer_load_dwordx4 v25, s[40:43], s37 offen lds
  s_add_u32 m0, s39, 15360
  s_add_u32 s37, s36, 393216
  buffer_load_dwordx4 v25, s[40:43], s37 offen lds
  s_waitcnt vmcnt(12)
  ds_read_b64_tr_b16 v[64:65], v27 offset:0
  ds_read_b64_tr_b16 v[66:67], v27 offset:128
  ds_read_b64_tr_b16 v[68:69], v27 offset:1024
  ds_read_b64_tr_b16 v[70:71], v27 offset:1152
  ds_read_b64_tr_b16 v[72:73], v36 offset:0
  ds_read_b64_tr_b16 v[74:75], v36 offset:128
  ds_read_b64_tr_b16 v[76:77], v36 offset:1024
  ds_read_b64_tr_b16 v[78:79], v36 offset:1152
  s_waitcnt lgkmcnt(0)
  ds_write_b128 v4, v[64:67] offset:0
  ds_write_b128 v4, v[68:71] offset:1024
  ds_write_b128 v4, v[72:75] offset:2048
  ds_write_b128 v4, v[76:79] offset:3072
  s_waitcnt lgkmcnt(0)
  s_xor_b32 s36, s13, 3
  s_lshl_b32 s36, s36, 19
  s_add_u32 m0, s39, 16384
  s_add_u32 s37, s36, 0
  buffer_load_dwordx4 v25, s[40:43], s37 offen lds
  s_add_u32 m0, s39, 17408
  s_add_u32 s37, s36, 131072
  buffer_load_dwordx4 v25, s[40:43], s37 offen lds
  s_add_u32 m0, s39, 18432
  s_add_u32 s37, s36, 262144
  buffer_load_dwordx4 v25, s[40:43], s37 offen lds
  s_add_u32 m0, s39, 19456
  s_add_u32 s37, s36, 393216
  buffer_load_dwordx4 v25, s[40:43], s37 offen lds
  s_waitcnt vmcnt(12)
  ds_read_b64_tr_b16 v[144:145], v27 offset:8192
  ds_read_b64_tr_b16 v[146:147], v27 offset:8320
  ds_read_b64_tr_b16 v[148:149], v27 offset:9216
  ds_read_b64_tr_b16 v[150:151], v27 offset:9344
  ds_read_b64_tr_b16 v[152:153], v36 offset:8192
  ds_read_b64_tr_b16 v[154:155], v36 offset:8320
  ds_read_b64_tr_b16 v[156:157], v36 offset:9216
  ds_read_b64_tr_b16 v[158:159], v36 offset:9344
  s_waitcnt lgkmcnt(0)
  s_xor_b32 s36, s13, 3
  s_lshl_b32 s36, s36, 19
  s_add_u32 m0, s39, 24576
  s_add_u32 s37, s36, 0
  buffer_load_dwordx4 v25, s[44:47], s37 offen lds
  s_add_u32 m0, s39, 25600
  s_add_u32 s37, s36, 131072
  buffer_load_dwordx4 v25, s[44:47], s37 offen lds
  s_add_u32 m0, s39, 26624
  s_add_u32 s37, s36, 262144
  buffer_load_dwordx4 v25, s[44:47], s37 offen lds
  s_add_u32 m0, s39, 27648
  s_add_u32 s37, s36, 393216
  buffer_load_dwordx4 v25, s[44:47], s37 offen lds
  buffer_load_dwordx2 v[54:55], off, s[72:75], 0 sc1
  buffer_load_dword v56, off, s[72:75], 0 offset:128 sc1
  s_waitcnt vmcnt(14)
  ds_read_b64_tr_b16 v[64:65], v27 offset:4096
  ds_read_b64_tr_b16 v[66:67], v27 offset:4224
  ds_read_b64_tr_b16 v[68:69], v27 offset:5120
  ds_read_b64_tr_b16 v[70:71], v27 offset:5248
  ds_read_b64_tr_b16 v[72:73], v36 offset:4096
  ds_read_b64_tr_b16 v[74:75], v36 offset:4224
  ds_read_b64_tr_b16 v[76:77], v36 offset:5120
  ds_read_b64_tr_b16 v[78:79], v36 offset:5248
  s_waitcnt lgkmcnt(0)
  ds_write_b128 v4, v[64:67] offset:4096
  ds_write_b128 v4, v[68:71] offset:5120
  ds_write_b128 v4, v[72:75] offset:6144
  ds_write_b128 v4, v[76:79] offset:7168
  s_waitcnt lgkmcnt(0)
  s_xor_b32 s36, s13, 2
  s_lshl_b32 s36, s36, 19
  s_add_u32 m0, s39, 20480
  s_add_u32 s37, s36, 0
  buffer_load_dwordx4 v25, s[44:47], s37 offen lds
  s_add_u32 m0, s39, 21504
  s_add_u32 s37, s36, 131072
  buffer_load_dwordx4 v25, s[44:47], s37 offen lds
  s_add_u32 m0, s39, 22528
  s_add_u32 s37, s36, 262144
  buffer_load_dwordx4 v25, s[44:47], s37 offen lds
  s_add_u32 m0, s39, 23552
  s_add_u32 s37, s36, 393216
  buffer_load_dwordx4 v25, s[44:47], s37 offen lds
  s_waitcnt vmcnt(14)
  ds_read_b64_tr_b16 v[176:177], v27 offset:12288
  ds_read_b64_tr_b16 v[178:179], v27 offset:12416
  ds_read_b64_tr_b16 v[180:181], v27 offset:13312
  ds_read_b64_tr_b16 v[182:183], v27 offset:13440
  ds_read_b64_tr_b16 v[184:185], v36 offset:12288
  ds_read_b64_tr_b16 v[186:187], v36 offset:12416
  ds_read_b64_tr_b16 v[188:189], v36 offset:13312
  ds_read_b64_tr_b16 v[190:191], v36 offset:13440
  s_waitcnt lgkmcnt(0)
  s_xor_b32 s36, s13, 0
  s_lshl_b32 s36, s36, 19
  s_add_u32 m0, s39, 8192
  s_add_u32 s37, s36, 0
  buffer_load_dwordx4 v25, s[44:47], s37 offen lds
  s_add_u32 m0, s39, 9216
  s_add_u32 s37, s36, 131072
  buffer_load_dwordx4 v25, s[44:47], s37 offen lds
  s_add_u32 m0, s39, 10240
  s_add_u32 s37, s36, 262144
  buffer_load_dwordx4 v25, s[44:47], s37 offen lds
  s_add_u32 m0, s39, 11264
  s_add_u32 s37, s36, 393216
  buffer_load_dwordx4 v25, s[44:47], s37 offen lds
  s_waitcnt vmcnt(14)
  ds_read_b64_tr_b16 v[64:65], v27 offset:16384
  ds_read_b64_tr_b16 v[66:67], v27 offset:16512
  ds_read_b64_tr_b16 v[68:69], v27 offset:17408
  ds_read_b64_tr_b16 v[70:71], v27 offset:17536
  ds_read_b64_tr_b16 v[72:73], v36 offset:16384
  ds_read_b64_tr_b16 v[74:75], v36 offset:16512
  ds_read_b64_tr_b16 v[76:77], v36 offset:17408
  ds_read_b64_tr_b16 v[78:79], v36 offset:17536
  s_waitcnt lgkmcnt(0)
  ds_write_b128 v4, v[64:67] offset:16384
  ds_write_b128 v4, v[68:71] offset:17408
  ds_write_b128 v4, v[72:75] offset:18432
  ds_write_b128 v4, v[76:79] offset:19456
  s_waitcnt lgkmcnt(0)
  s_xor_b32 s36, s13, 1
  s_lshl_b32 s36, s36, 19
  s_add_u32 m0, s39, 12288
  s_add_u32 s37, s36, 0
  buffer_load_dwordx4 v25, s[44:47], s37 offen lds
  s_add_u32 m0, s39, 13312
  s_add_u32 s37, s36, 131072
  buffer_load_dwordx4 v25, s[44:47], s37 offen lds
  s_add_u32 m0, s39, 14336
  s_add_u32 s37, s36, 262144
  buffer_load_dwordx4 v25, s[44:47], s37 offen lds
  s_add_u32 m0, s39, 15360
  s_add_u32 s37, s36, 393216
  buffer_load_dwordx4 v25, s[44:47], s37 offen lds
  s_waitcnt vmcnt(14)
  ds_read_b64_tr_b16 v[208:209], v27 offset:24576
  ds_read_b64_tr_b16 v[210:211], v27 offset:24704
  ds_read_b64_tr_b16 v[212:213], v27 offset:25600
  ds_read_b64_tr_b16 v[214:215], v27 offset:25728
  ds_read_b64_tr_b16 v[216:217], v36 offset:24576
  ds_read_b64_tr_b16 v[218:219], v36 offset:24704
  ds_read_b64_tr_b16 v[220:221], v36 offset:25600
  ds_read_b64_tr_b16 v[222:223], v36 offset:25728
  s_waitcnt lgkmcnt(0)
  s_xor_b32 s36, s13, 2
  s_lshl_b32 s36, s36, 15
  s_add_u32 m0, s39, 24576
  s_add_u32 s37, s36, 512
  buffer_load_dwordx4 v26, s[48:51], s37 offen lds
  s_add_u32 m0, s39, 25600
  s_add_u32 s37, s36, 8704
  buffer_load_dwordx4 v26, s[48:51], s37 offen lds
  s_add_u32 m0, s39, 26624
  s_add_u32 s37, s36, 16896
  buffer_load_dwordx4 v26, s[48:51], s37 offen lds
  s_add_u32 m0, s39, 27648
  s_add_u32 s37, s36, 25088
  buffer_load_dwordx4 v26, s[48:51], s37 offen lds
  s_waitcnt vmcnt(12)
  ds_read_b64_tr_b16 v[64:65], v27 offset:20480
  ds_read_b64_tr_b16 v[66:67], v27 offset:20608
  ds_read_b64_tr_b16 v[68:69], v27 offset:21504
  ds_read_b64_tr_b16 v[70:71], v27 offset:21632
  ds_read_b64_tr_b16 v[72:73], v36 offset:20480
  ds_read_b64_tr_b16 v[74:75], v36 offset:20608
  ds_read_b64_tr_b16 v[76:77], v36 offset:21504
  ds_read_b64_tr_b16 v[78:79], v36 offset:21632
  s_waitcnt lgkmcnt(0)
  ds_write_b128 v4, v[64:67] offset:20480
  ds_write_b128 v4, v[68:71] offset:21504
  ds_write_b128 v4, v[72:75] offset:22528
  ds_write_b128 v4, v[76:79] offset:23552
  s_waitcnt lgkmcnt(0)
  s_xor_b32 s36, s13, 3
  s_lshl_b32 s36, s36, 15
  s_add_u32 m0, s39, 28672
  s_add_u32 s37, s36, 512
  buffer_load_dwordx4 v26, s[48:51], s37 offen lds
  s_add_u32 m0, s39, 29696
  s_add_u32 s37, s36, 8704
  buffer_load_dwordx4 v26, s[48:51], s37 offen lds
  s_add_u32 m0, s39, 30720
  s_add_u32 s37, s36, 16896
  buffer_load_dwordx4 v26, s[48:51], s37 offen lds
  s_add_u32 m0, s39, 31744
  s_add_u32 s37, s36, 25088
  buffer_load_dwordx4 v26, s[48:51], s37 offen lds
  s_mov_b32 s19, 0
  s_branch T_arrgo_74
T_arr_73:
  s_add_u32 s19, s19, 1
  s_cmp_gt_u32 s19, 32768
  s_cbranch_scc1 M_exit
  buffer_load_dwordx2 v[54:55], off, s[72:75], 0 sc1
  buffer_load_dword v56, off, s[72:75], 0 offset:128 sc1
  s_waitcnt vmcnt(0)
T_arrgo_74:
  v_sad_u8 v57, v54, 0, 0
  v_sad_u8 v57, v55, 0, v57
  v_or_b32 v58, v54, v55
  v_cmp_gt_u32 vcc, 32, v57
  s_cbranch_vccnz T_arr_73
  v_cmp_gt_u32 vcc, 0x100, v56
  s_cbranch_vccnz T_arr_73
  v_readfirstlane_b32 s36, v58
  s_nop 0
  s_and_b32 s36, s36, 0x20202020
  s_cselect_b32 s56, 0, 1
  s_mov_b32 s14, -1
  s_mov_b32 s30, -1
  s_mov_b32 s19, 0
  s_branch T_kvok_76
T_kv_75:
  s_sleep 4
  s_add_u32 s19, s19, 1
  s_cmp_gt_u32 s19, 32768
  s_cbranch_scc1 M_exit
T_kvok_76:
  s_add_u32 s39, s99, 128
  s_mov_b32 s38, 0
  s_mov_b32 s37, 0
  s_atomic_or s38, s[58:59], s99 glc
  s_atomic_or s37, s[58:59], s39 glc
  s_waitcnt lgkmcnt(0)
  s_add_u32 s37, s37, 30
  s_cmp_ge_u32 s38, 30
  s_cselect_b32 s38, s37, s38
  s_cmp_ge_u32 s38, 64
  s_cselect_b32 s38, 100, s38
  s_sub_u32 s38, s38, 1
  s_max_i32 s30, s30, s38
  s_cmp_ge_i32 s14, s30
  s_cbranch_scc1 T_kv_75
  s_mov_b32 m0, s31
  s_nop 0
  buffer_load_dwordx4 v9, s[4:7], s27 offen sc1 lds
  s_mov_b32 m0, s32
  s_nop 0
  buffer_load_dwordx4 v9, s[4:7], s27 offen offset:128 sc1 lds
  s_mov_b32 m0, s33
  s_nop 0
  buffer_load_dwordx4 v10, s[4:7], s28 offen sc1 lds
  s_mov_b32 m0, s34
  s_nop 0
  buffer_load_dwordx4 v10, s[4:7], s28 offen offset:256 sc1 lds
  s_add_u32 s27, s27, 8192
  s_add_u32 s28, s28, 8192
  s_lshl_b32 s36, s12, 10
  s_add_u32 s36, s36, 145752064
  buffer_load_dwordx4 v[40:43], v2, s[4:7], s36 offen sc1
  s_waitcnt vmcnt(17)
  ds_read_b64_tr_b16 v[64:65], v27 offset:8192
  ds_read_b64_tr_b16 v[66:67], v27 offset:8320
  ds_read_b64_tr_b16 v[68:69], v27 offset:9216
  ds_read_b64_tr_b16 v[70:71], v27 offset:9344
  ds_read_b64_tr_b16 v[72:73], v36 offset:8192
  ds_read_b64_tr_b16 v[74:75], v36 offset:8320
  ds_read_b64_tr_b16 v[76:77], v36 offset:9216
  ds_read_b64_tr_b16 v[78:79], v36 offset:9344
  s_waitcnt lgkmcnt(0)
  ds_write_b128 v4, v[64:67] offset:8192
  ds_write_b128 v4, v[68:71] offset:9216
  ds_write_b128 v4, v[72:75] offset:10240
  ds_write_b128 v4, v[76:79] offset:11264
  s_waitcnt lgkmcnt(0)
  s_waitcnt vmcnt(13)
  ds_read_b64_tr_b16 v[64:65], v27 offset:12288
  ds_read_b64_tr_b16 v[66:67], v27 offset:12416
  ds_read_b64_tr_b16 v[68:69], v27 offset:13312
  ds_read_b64_tr_b16 v[70:71], v27 offset:13440
  ds_read_b64_tr_b16 v[72:73], v36 offset:12288
  ds_read_b64_tr_b16 v[74:75], v36 offset:12416
  ds_read_b64_tr_b16 v[76:77], v36 offset:13312
  ds_read_b64_tr_b16 v[78:79], v36 offset:13440
  s_waitcnt lgkmcnt(0)
  ds_write_b128 v4, v[64:67] offset:12288
  ds_write_b128 v4, v[68:71] offset:13312
  ds_write_b128 v4, v[72:75] offset:14336
  ds_write_b128 v4, v[76:79] offset:15360
  s_waitcnt lgkmcnt(0)
  s_waitcnt vmcnt(9)
  ds_read_b64_tr_b16 v[64:65], v28 offset:24576
  ds_read_b64_tr_b16 v[66:67], v28 offset:24832
  ds_read_b64_tr_b16 v[68:69], v28 offset:25600
  ds_read_b64_tr_b16 v[70:71], v28 offset:25856
  ds_read_b64_tr_b16 v[72:73], v28 offset:24584
  ds_read_b64_tr_b16 v[74:75], v28 offset:24840
  ds_read_b64_tr_b16 v[76:77], v28 offset:25608
  ds_read_b64_tr_b16 v[78:79], v28 offset:25864
  s_waitcnt lgkmcnt(0)
  ds_write_b128 v4, v[64:67] offset:24576
  ds_write_b128 v4, v[68:71] offset:25600
  ds_write_b128 v4, v[72:75] offset:26624
  ds_write_b128 v4, v[76:79] offset:27648
  s_waitcnt lgkmcnt(0)
  s_waitcnt vmcnt(5)
  ds_read_b64_tr_b16 v[64:65], v28 offset:28672
  ds_read_b64_tr_b16 v[66:67], v28 offset:28928
  ds_read_b64_tr_b16 v[68:69], v28 offset:29696
  ds_read_b64_tr_b16 v[70:71], v28 offset:29952
  ds_read_b64_tr_b16 v[72:73], v28 offset:28680
  ds_read_b64_tr_b16 v[74:75], v28 offset:28936
  ds_read_b64_tr_b16 v[76:77], v28 offset:29704
  ds_read_b64_tr_b16 v[78:79], v28 offset:29960
  s_waitcnt lgkmcnt(0)
  ds_write_b128 v4, v[64:67] offset:28672
  ds_write_b128 v4, v[68:71] offset:29696
  ds_write_b128 v4, v[72:75] offset:30720
  ds_write_b128 v4, v[76:79] offset:31744
  s_waitcnt lgkmcnt(0)
  s_waitcnt vmcnt(0) lgkmcnt(0)
  s_barrier
  s_cmp_ge_u32 s13, 2
  s_cselect_b64 vcc, -1, 0
  v_cndmask_b32 v8, v8, v19, vcc
  ds_read_b128 v[68:71], v4 offset:0
  ds_read_b128 v[72:75], v4 offset:1024
  ds_read_b128 v[76:79], v4 offset:4096
  ds_read_b128 v[80:83], v4 offset:5120
  ds_read_b128 v[84:87], v4 offset:8192
  ds_read_b128 v[88:91], v4 offset:9216
  ds_read_b128 v[92:95], v4 offset:2048
  ds_read_b128 v[96:99], v4 offset:3072
  ds_read_b128 v[100:103], v4 offset:6144
  ds_read_b128 v[104:107], v4 offset:7168
  ds_read_b128 v[108:111], v4 offset:10240
  ds_read_b128 v[112:115], v4 offset:11264
  ds_read_b128 v[28:31], v59 offset:16384
  ds_read_b128 v[32:35], v59 offset:20480
  ds_read_b128 v[36:39], v2 offset:8192
  ds_read_b128 v[40:43], v2 offset:9216
  ds_read_b128 v[44:47], v2 offset:10240
  ds_read_b128 v[48:51], v2 offset:11264
  ds_read_b128 v[52:55], v2 offset:12288
  ds_read_b128 v[56:59], v2 offset:13312
  ds_read_b128 v[60:63], v2 offset:14336
  ds_read_b128 v[64:67], v2 offset:15360
  s_and_b32 s36, s13, 1
  s_lshl_b32 s36, s36, 12
  s_add_u32 s22, s22, s36
  s_add_u32 s23, s36, 145752064
  s_mov_b32 s14, -1
  s_and_b32 s57, s14, 1
  s_and_b32 s36, s14, 3
  s_lshl_b32 s36, s36, 13
  s_add_u32 s26, s36, s23
  s_add_u32 s36, s36, 8192
  s_and_b32 s36, s36, 0x7fff
  s_add_u32 s24, s36, 145752064
  s_add_u32 s25, s36, 145756160
  s_add_u32 s35, s36, s23
  s_waitcnt lgkmcnt(0)
  s_cmp_lg_u32 s56, 0
  s_cbranch_scc1 M_global
  s_cmp_eq_u32 s13, 1
  s_cbranch_scc1 T_w_78
  s_cmp_eq_u32 s13, 2
  s_cbranch_scc1 T_w_79
  s_cmp_eq_u32 s13, 3
  s_cbranch_scc1 T_w_80
T_w_77:
  s_mov_b32 s19, 0
  v_mov_b64 v[16:17], 0
  v_mov_b64 v[18:19], 0
  v_mov_b64 v[20:21], 0
  v_mov_b64 v[22:23], 0
  v_mov_b64 v[24:25], 0
  v_mov_b64 v[26:27], 0
  buffer_load_dwordx4 v[124:127], v3, s[4:7], s24 offen offset:0 sc1
  buffer_load_dwordx4 v[116:119], v3, s[4:7], s25 offen offset:0 sc1
  buffer_load_dwordx4 v[124:127], v3, s[4:7], s24 offen offset:0 sc1
  buffer_load_dwordx4 v[116:119], v3, s[4:7], s25 offen offset:0 sc1
  s_branch T_loop_81
.p2align 6
T_retry_82:
  s_mov_b64 exec, vcc
  buffer_load_dwordx4 v[124:127], v3, s[4:7], s24 offen offset:0 sc1
  buffer_load_dwordx4 v[116:119], v3, s[4:7], s25 offen offset:0 sc1
  s_mov_b64 exec, -1
  s_add_u32 s19, s19, 1
  s_cmp_gt_u32 s19, 32768
  s_cbranch_scc1 M_exit
T_loop_81:
  s_waitcnt vmcnt(3) lgkmcnt(0)
  v_max3_u32 v123, v124, v125, v126
  v_max_u32 v123, v123, v127
  v_mov_b32_dpp v120, v124 row_ror:8 row_mask:0xf bank_mask:0xf
  v_mov_b32_dpp v121, v125 row_ror:8 row_mask:0xf bank_mask:0xf
  s_waitcnt vmcnt(2)
  v_max3_u32 v123, v123, v116, v117
  v_max3_u32 v123, v123, v118, v119
  v_cmp_eq_u32 vcc, -1, v123
  s_cbranch_vccnz T_retry_82
  v_smfmac_f32_16x16x64_bf16 v[16:19], v[124:127], v[68:75], v0
  s_add_u32 s14, s14, 1
  ds_write_b128 v2, v[124:127] offset:0
  v_mov_b32_dpp v122, v126 row_ror:8 row_mask:0xf bank_mask:0xf
  v_smfmac_f32_16x16x64_bf16 v[20:23], v[124:127], v[76:83], v0
  s_and_b32 s57, s14, 1
  v_mov_b32_dpp v123, v127 row_ror:8 row_mask:0xf bank_mask:0xf
  v_smfmac_f32_16x16x64_bf16 v[24:27], v[124:127], v[84:91], v0
  s_and_b32 s36, s14, 3
  ds_write_b128 v2, v[116:119] offset:4096
  v_smfmac_f32_16x16x64_bf16 v[16:19], v[120:123], v[92:99], v0
  s_lshl_b32 s36, s36, 13
  v_mov_b32_dpp v84, v116 row_ror:8 row_mask:0xf bank_mask:0xf
  v_smfmac_f32_16x16x64_bf16 v[20:23], v[120:123], v[100:107], v0
  s_add_u32 s26, s36, s23
  ds_read_b128 v[68:71], v4 offset:12288
  v_mov_b32_dpp v85, v117 row_ror:8 row_mask:0xf bank_mask:0xf
  v_smfmac_f32_16x16x64_bf16 v[24:27], v[120:123], v[108:115], v0
  s_add_u32 s36, s36, 8192
  ds_read_b128 v[72:75], v4 offset:13312
  v_mov_b32_dpp v86, v118 row_ror:8 row_mask:0xf bank_mask:0xf
  v_smfmac_f32_16x16x64_bf16 v[16:19], v[116:119], v[224:231], v0
  s_and_b32 s36, s36, 0x7fff
  ds_read_b128 v[76:79], v4 offset:14336
  v_mov_b32_dpp v87, v119 row_ror:8 row_mask:0xf bank_mask:0xf
  v_smfmac_f32_16x16x64_bf16 v[20:23], v[116:119], v[240:247], v0
  s_waitcnt lgkmcnt(3)
  s_barrier
  ds_read_b128 v[100:103], v2 offset:1024
  v_smfmac_f32_16x16x64_bf16 v[24:27], v[116:119], a[0:7], v0
  s_mov_b32 m0, s31
  ds_read_b128 v[120:123], v1 offset:1024
  v_smfmac_f32_16x16x64_bf16 v[16:19], v[84:87], v[232:239], v0
  s_cmp_ge_i32 s14, s30
  s_cbranch_scc1 T_kvw_85
T_kvb_86:
  v_smfmac_f32_16x16x64_bf16 v[20:23], v[84:87], v[248:255], v0
  ds_read_b128 v[80:83], v4 offset:15360
  buffer_load_dwordx4 v9, s[4:7], s27 offen sc1 lds
  v_smfmac_f32_16x16x64_bf16 v[24:27], v[84:87], a[8:15], v0
  s_waitcnt lgkmcnt(2)
  s_mov_b32 m0, s32
  v_smfmac_f32_16x16x64_bf16 v[16:19], v[100:103], v[128:135], v0
  ds_read_b128 v[92:95], v2 offset:2048
  v_smfmac_f32_16x16x64_bf16 v[20:23], v[100:103], v[144:151], v0
  ds_read_b128 v[96:99], v1 offset:2048
  v_smfmac_f32_16x16x64_bf16 v[24:27], v[100:103], v[68:75], v0
  s_waitcnt vmcnt(1) lgkmcnt(3)
  ds_read_b128 v[116:119], v2 offset:3072
  buffer_load_dwordx4 v9, s[4:7], s27 offen offset:128 sc1 lds
  v_smfmac_f32_16x16x64_bf16 v[16:19], v[120:123], v[136:143], v0
  ds_read_b128 v[124:127], v1 offset:3072
  s_mov_b32 m0, s33
  v_smfmac_f32_16x16x64_bf16 v[20:23], v[120:123], v[152:159], v0
  s_waitcnt lgkmcnt(4)
  ds_read_b128 v[104:107], v2 offset:5120
  v_smfmac_f32_16x16x64_bf16 v[24:27], v[120:123], v[76:83], v0
  s_waitcnt lgkmcnt(4)
  ds_read_b128 v[108:111], v1 offset:5120
  v_smfmac_f32_16x16x64_bf16 v[16:19], v[92:95], v[160:167], v0
  s_waitcnt lgkmcnt(4)
  ds_read_b128 v[112:115], v2 offset:6144
  buffer_load_dwordx4 v10, s[4:7], s28 offen sc1 lds
  v_smfmac_f32_16x16x64_bf16 v[16:19], v[96:99], v[168:175], v0
  s_waitcnt lgkmcnt(4)
  ds_read_b128 v[84:87], v1 offset:6144
  s_mov_b32 m0, s34
  v_smfmac_f32_16x16x64_bf16 v[16:19], v[116:119], v[192:199], v0
  s_waitcnt lgkmcnt(4)
  ds_read_b128 v[88:91], v2 offset:7168
  v_smfmac_f32_16x16x64_bf16 v[16:19], v[124:127], v[200:207], v0
  s_waitcnt lgkmcnt(4)
  ds_read_b128 v[100:103], v1 offset:7168
  v_smfmac_f32_16x16x64_bf16 v[16:19], v[104:107], a[16:23], v0
  s_waitcnt lgkmcnt(4)
  ds_read_b128 v[68:71], v4 offset:16384
  buffer_load_dwordx4 v10, s[4:7], s28 offen offset:256 sc1 lds
  v_smfmac_f32_16x16x64_bf16 v[16:19], v[108:111], a[24:31], v0
  s_waitcnt lgkmcnt(4)
  ds_read_b128 v[72:75], v4 offset:17408
  v_smfmac_f32_16x16x64_bf16 v[16:19], v[112:115], a[64:71], v0
  s_waitcnt lgkmcnt(4)
  ds_read_b128 v[76:79], v4 offset:18432
  v_smfmac_f32_16x16x64_bf16 v[16:19], v[84:87], a[72:79], v0
  s_waitcnt lgkmcnt(4)
  ds_read_b128 v[80:83], v4 offset:19456
  v_smfmac_f32_16x16x64_bf16 v[16:19], v[88:91], a[112:119], v0
  s_waitcnt lgkmcnt(4)
  v_smfmac_f32_16x16x64_bf16 v[16:19], v[100:103], a[120:127], v0
  s_add_u32 s24, s36, 145752064
  s_add_u32 s25, s36, 145756160
  v_smfmac_f32_16x16x64_bf16 v[20:23], v[92:95], v[176:183], v0
  s_add_u32 s35, s36, s23
  v_smfmac_f32_16x16x64_bf16 v[20:23], v[96:99], v[184:191], v0
  s_waitcnt lgkmcnt(2)
  v_smfmac_f32_16x16x64_bf16 v[20:23], v[116:119], v[68:75], v0
  s_waitcnt lgkmcnt(0)
  ds_read_b128 v[68:71], v4 offset:20480
  v_mul_f32 v16, s18, v16
  v_smfmac_f32_16x16x64_bf16 v[20:23], v[124:127], v[76:83], v0
  ds_read_b128 v[72:75], v4 offset:21504
  v_mul_f32 v17, s18, v17
  v_smfmac_f32_16x16x64_bf16 v[20:23], v[104:107], a[32:39], v0
  ds_read_b128 v[76:79], v4 offset:22528
  v_mul_f32 v18, s18, v18
  v_smfmac_f32_16x16x64_bf16 v[20:23], v[108:111], a[40:47], v0
  ds_read_b128 v[80:83], v4 offset:23552
  v_mul_f32 v19, s18, v19
  v_smfmac_f32_16x16x64_bf16 v[20:23], v[112:115], a[80:87], v0
  v_cvt_pk_bf16_f32 v120, v16, v17
  v_smfmac_f32_16x16x64_bf16 v[20:23], v[84:87], a[88:95], v0
  v_cvt_pk_bf16_f32 v121, v18, v19
  v_smfmac_f32_16x16x64_bf16 v[20:23], v[88:91], a[128:135], v0
  ds_write_b64 v5, v[120:121] offset:24576
  v_smfmac_f32_16x16x64_bf16 v[20:23], v[100:103], a[136:143], v0
  s_waitcnt lgkmcnt(3)
  v_smfmac_f32_16x16x64_bf16 v[24:27], v[92:95], v[68:75], v0
  s_waitcnt lgkmcnt(1)
  v_mov_b64 v[92:93], 0
  v_smfmac_f32_16x16x64_bf16 v[24:27], v[96:99], v[76:83], v0
  s_nop 1
  v_cvt_pk_bf16_f32 v122, v20, v21
  v_cvt_pk_bf16_f32 v123, v22, v23
  v_smfmac_f32_16x16x64_bf16 v[24:27], v[116:119], v[208:215], v0
  ds_write_b64 v5, v[122:123] offset:26880
  v_mov_b64 v[94:95], 0
  v_smfmac_f32_16x16x64_bf16 v[24:27], v[124:127], v[216:223], v0
  s_waitcnt lgkmcnt(1)
  s_barrier
  ds_read_b64_tr_b16 v[68:69], v6 offset:24576
  v_smfmac_f32_16x16x64_bf16 v[24:27], v[104:107], a[48:55], v0
  s_add_u32 s27, s27, 8192
  ds_read_b64_tr_b16 v[70:71], v6 offset:24640
  ds_read_b64_tr_b16 v[72:73], v6 offset:24832
  v_smfmac_f32_16x16x64_bf16 v[24:27], v[108:111], a[56:63], v0
  s_add_u32 s28, s28, 8192
  ds_read_b64_tr_b16 v[74:75], v6 offset:24896
  ds_read_b64_tr_b16 v[76:77], v6 offset:25088
  v_smfmac_f32_16x16x64_bf16 v[24:27], v[112:115], a[96:103], v0
  s_nop 0
  ds_read_b64_tr_b16 v[78:79], v6 offset:25152
  ds_read_b64_tr_b16 v[80:81], v6 offset:25344
  v_smfmac_f32_16x16x64_bf16 v[24:27], v[84:87], a[104:111], v0
  ds_read_b64_tr_b16 v[82:83], v6 offset:25408
  v_mov_b64 v[96:97], 0
  v_smfmac_f32_16x16x64_bf16 v[24:27], v[88:91], a[144:151], v0
  s_waitcnt lgkmcnt(8)
  s_barrier
  ds_read_b64_tr_b16 v[116:117], v6 offset:26880
  v_smfmac_f32_16x16x64_bf16 v[24:27], v[100:103], a[152:159], v0
  s_waitcnt lgkmcnt(7)
  ds_read_b64_tr_b16 v[118:119], v6 offset:26944
  v_mfma_f32_16x16x32_bf16 v[16:19], v[36:39], v[68:71], 0
  s_waitcnt lgkmcnt(6)
  ds_read_b64_tr_b16 v[124:125], v6 offset:27136
  ds_read_b64_tr_b16 v[126:127], v6 offset:27200
  v_mfma_f32_16x16x32_bf16 v[16:19], v[40:43], v[72:75], v[16:19]
  s_waitcnt lgkmcnt(6)
  ds_read_b64_tr_b16 v[104:105], v6 offset:27392
  ds_read_b64_tr_b16 v[106:107], v6 offset:27456
  v_mfma_f32_16x16x32_bf16 v[16:19], v[44:47], v[76:79], v[16:19]
  s_waitcnt lgkmcnt(6)
  ds_read_b64_tr_b16 v[108:109], v6 offset:27648
  ds_read_b64_tr_b16 v[110:111], v6 offset:27712
  v_mfma_f32_16x16x32_bf16 v[16:19], v[48:51], v[80:83], v[16:19]
  s_waitcnt lgkmcnt(6)
  v_cvt_pk_bf16_f32 v120, v24, v25
  v_cvt_pk_bf16_f32 v121, v26, v27
  v_mfma_f32_16x16x32_bf16 v[112:115], v[116:119], v[68:71], 0
  s_waitcnt lgkmcnt(4)
  buffer_store_dwordx4 v[120:123], v2, s[4:7], s29 offen offset:0 sc1
  v_mov_b64 v[98:99], 0
  v_mfma_f32_16x16x32_bf16 v[112:115], v[124:127], v[72:75], v[112:115]
  s_waitcnt lgkmcnt(2)
  v_mov_b64 v[36:37], 0
  v_exp_f32 v100, v16
  v_mfma_f32_16x16x32_bf16 v[112:115], v[104:107], v[76:79], v[112:115]
  s_waitcnt lgkmcnt(0)
  v_exp_f32 v101, v17
  v_mfma_f32_16x16x32_bf16 v[112:115], v[108:111], v[80:83], v[112:115]
  s_add_u32 s29, s29, 131072
  v_exp_f32 v102, v18
  v_mfma_f32_16x16x32_bf16 v[20:23], v[52:55], v[68:71], 0
  s_cmp_eq_u32 s14, 63
  v_exp_f32 v103, v19
  v_mfma_f32_16x16x32_bf16 v[20:23], v[56:59], v[72:75], v[20:23]
  s_cbranch_scc1 M_tdone
  v_cvt_pk_bf16_f32 v44, v100, v101
  v_cvt_pk_bf16_f32 v45, v102, v103
  v_mfma_f32_16x16x32_bf16 v[20:23], v[60:63], v[76:79], v[20:23]
  v_exp_f32 v100, v112
  v_mfma_f32_16x16x32_bf16 v[20:23], v[64:67], v[80:83], v[20:23]
  v_exp_f32 v101, v113
  v_exp_f32 v102, v114
  v_exp_f32 v103, v115
  v_cvt_pk_bf16_f32 v84, v100, v101
  v_cvt_pk_bf16_f32 v85, v102, v103
  v_cndmask_b32 v48, v84, 0, s[16:17]
  v_cndmask_b32 v49, v85, 0, s[16:17]
  v_cndmask_b32 v50, 0, v84, s[16:17]
  v_cndmask_b32 v51, 0, v85, s[16:17]
  v_exp_f32 v100, v20
  v_mfma_f32_16x16x16_bf16 v[88:91], v[12:13], v[48:49], 0
  v_exp_f32 v101, v21
  v_mfma_f32_16x16x16_bf16 v[24:27], v[120:121], v[48:49], 0
  v_exp_f32 v102, v22
  v_mfma_f32_16x16x16_bf16 v[116:119], v[120:121], v[50:51], 0
  v_exp_f32 v103, v23
  v_cvt_pk_bf16_f32 v46, v100, v101
  v_cvt_pk_bf16_f32 v47, v102, v103
  v_mov_b64 v[38:39], 0
  s_nop 0
  v_mfma_f32_16x16x32_bf16 v[88:91], v[12:15], v[44:47], v[88:91]
  v_mov_b64 v[40:41], 0
  v_mov_b64 v[42:43], 0
  v_mfma_f32_16x16x32_bf16 v[24:27], v[28:31], v[44:47], v[24:27]
  ds_read_b128 v[52:55], v4 offset:24576
  ds_read_b128 v[56:59], v4 offset:25600
  v_mfma_f32_16x16x32_bf16 v[116:119], v[32:35], v[44:47], v[116:119]
  s_nop 1
  v_rcp_f32 v89, v88
  v_subrev_u32 v100, s54, v88
  v_cmp_le_u32 vcc, s55, v100
  v_mul_f32 v24, v89, v24
  v_mul_f32 v25, v89, v25
  s_cbranch_vccnz T_slow_88
T_back_89:
  v_cvt_pk_bf16_f32 v124, v24, v25
  v_pk_mul_f32 v[26:27], v[26:27], v[88:89] op_sel:[0,1] op_sel_hi:[1,1]
  v_pk_mul_f32 v[116:117], v[116:117], v[88:89] op_sel:[0,1] op_sel_hi:[1,1]
  v_pk_mul_f32 v[118:119], v[118:119], v[88:89] op_sel:[0,1] op_sel_hi:[1,1]
  v_cvt_pk_bf16_f32 v125, v26, v27
  v_cvt_pk_bf16_f32 v126, v116, v117
  v_cvt_pk_bf16_f32 v127, v118, v119
  ds_write_b128 v11, v[124:127] offset:29184
  s_nop 0
  v_smfmac_f32_16x16x64_bf16 v[92:95], v[124:127], a[160:167], v0
  v_smfmac_f32_16x16x64_bf16 v[96:99], v[124:127], a[168:175], v0
  v_smfmac_f32_16x16x64_bf16 v[36:39], v[124:127], a[176:183], v0
  v_smfmac_f32_16x16x64_bf16 v[40:43], v[124:127], a[184:191], v0
  s_waitcnt lgkmcnt(0)
  s_barrier
  ds_read_b128 v[104:107], v11 offset:29696
  ds_read_b128 v[108:111], v11 offset:30208
  ds_read_b128 v[68:71], v11 offset:30720
  s_waitcnt lgkmcnt(2)
  v_smfmac_f32_16x16x64_bf16 v[92:95], v[104:107], a[192:199], v0
  s_waitcnt lgkmcnt(1)
  ds_read_b128 v[76:79], v4 offset:28672
  v_smfmac_f32_16x16x64_bf16 v[92:95], v[108:111], a[224:231], v0
  s_waitcnt lgkmcnt(1)
  ds_read_b128 v[80:83], v4 offset:29696
  v_smfmac_f32_16x16x64_bf16 v[92:95], v[68:71], a[240:247], v0
  ds_read_b128 v[60:63], v4 offset:26624
  v_smfmac_f32_16x16x64_bf16 v[96:99], v[104:107], a[200:207], v0
  ds_read_b128 v[64:67], v4 offset:27648
  v_smfmac_f32_16x16x64_bf16 v[96:99], v[108:111], a[232:239], v0
  ds_read_b128 v[28:31], v4 offset:30720
  s_nop 0
  v_cvt_pk_bf16_f32 v16, v92, v93
  v_cvt_pk_bf16_f32 v17, v94, v95
  v_bfi_b32 v16, 1, s57, v16
  v_smfmac_f32_16x16x64_bf16 v[96:99], v[68:71], a[248:255], v0
  buffer_store_dwordx2 v[16:17], v7, s[4:7], s20 offen offset:0
  v_smfmac_f32_16x16x64_bf16 v[36:39], v[104:107], a[208:215], v0
  ds_read_b128 v[32:35], v4 offset:31744
  v_smfmac_f32_16x16x64_bf16 v[36:39], v[108:111], v[52:59], v0
  s_waitcnt lgkmcnt(4)
  s_nop 0
  v_cvt_pk_bf16_f32 v18, v96, v97
  v_cvt_pk_bf16_f32 v19, v98, v99
  v_bfi_b32 v18, 1, s57, v18
  v_smfmac_f32_16x16x64_bf16 v[36:39], v[68:71], v[76:83], v0
  buffer_store_dwordx2 v[18:19], v7, s[4:7], s20 offen offset:64
  v_smfmac_f32_16x16x64_bf16 v[40:43], v[104:107], a[216:223], v0
  s_waitcnt lgkmcnt(2)
  ds_read_b128 v[116:119], v2 offset:31232
  v_smfmac_f32_16x16x64_bf16 v[40:43], v[108:111], v[60:67], v0
  s_waitcnt lgkmcnt(1)
  s_nop 0
  v_cvt_pk_bf16_f32 v20, v36, v37
  v_cvt_pk_bf16_f32 v21, v38, v39
  v_bfi_b32 v20, 1, s57, v20
  v_smfmac_f32_16x16x64_bf16 v[40:43], v[68:71], v[28:35], v0
  buffer_store_dwordx2 v[20:21], v7, s[4:7], s21 offen offset:0
  s_nop 6
  v_cvt_pk_bf16_f32 v22, v40, v41
  v_cvt_pk_bf16_f32 v23, v42, v43
  v_bfi_b32 v22, 1, s57, v22
  buffer_store_dwordx2 v[22:23], v7, s[4:7], s21 offen offset:64
  ds_read_b128 v[68:71], v4 offset:0
  ds_read_b128 v[72:75], v4 offset:1024
  ds_read_b128 v[76:79], v4 offset:4096
  ds_read_b128 v[80:83], v4 offset:5120
  ds_read_b128 v[84:87], v4 offset:8192
  ds_read_b128 v[88:91], v4 offset:9216
  v_mov_b64 v[16:17], 0
  v_mov_b64 v[18:19], 0
  v_mov_b64 v[20:21], 0
  v_mov_b64 v[22:23], 0
  v_mov_b64 v[24:25], 0
  v_mov_b64 v[26:27], 0
  s_mov_b32 s19, 0
  v_mov_b32 v49, -1
  s_waitcnt vmcnt(2)
  buffer_load_dwordx4 v[52:55], v2, s[4:7], s22 offen offset:0 sc1
  buffer_load_dwordx4 v[56:59], v2, s[4:7], s22 offen offset:1024 sc1
  buffer_load_dwordx4 v[60:63], v2, s[4:7], s22 offen offset:2048 sc1
  buffer_load_dwordx4 v[64:67], v2, s[4:7], s22 offen offset:3072 sc1
  ds_read_b128 v[92:95], v4 offset:2048
  ds_read_b128 v[96:99], v4 offset:3072
  ds_read_b128 v[100:103], v4 offset:6144
  ds_read_b128 v[104:107], v4 offset:7168
  ds_read_b128 v[108:111], v4 offset:10240
  ds_read_b128 v[112:115], v4 offset:11264
  ds_read_b64 v[44:45], v2 offset:32256
  s_waitcnt lgkmcnt(0)
  v_readfirstlane_b32 s38, v44
  v_readfirstlane_b32 s37, v45
  s_nop 0
  s_add_u32 s37, s37, 30
  s_cmp_ge_u32 s38, 30
  s_cselect_b32 s38, s37, s38
  s_cmp_ge_u32 s38, 64
  s_cselect_b32 s38, 100, s38
  s_sub_u32 s38, s38, 1
  s_max_i32 s30, s30, s38
  s_waitcnt lgkmcnt(12)
  s_waitcnt vmcnt(3)
  v_mfma_f32_16x16x32_bf16 v[120:123], v[116:119], v[52:55], 0
  v_xor_b32 v48, s57, v52
  v_bitop3_b32 v48, v48, v54, s57 bitop3:0xf6
  s_waitcnt vmcnt(2)
  v_mfma_f32_16x16x32_bf16 v[120:123], v[116:119], v[56:59], v[120:123]
  v_bitop3_b32 v48, v48, v56, s57 bitop3:0xf6
  v_bitop3_b32 v48, v48, v58, s57 bitop3:0xf6
  s_waitcnt vmcnt(1)
  v_mfma_f32_16x16x32_bf16 v[120:123], v[116:119], v[60:63], v[120:123]
  v_bitop3_b32 v48, v48, v60, s57 bitop3:0xf6
  v_bitop3_b32 v48, v48, v62, s57 bitop3:0xf6
  s_waitcnt vmcnt(0)
  v_mfma_f32_16x16x32_bf16 v[120:123], v[116:119], v[64:67], v[120:123]
  v_bitop3_b32 v48, v48, v64, s57 bitop3:0xf6
  v_bitop3_b32 v48, v48, v66, s57 bitop3:0xf6
  v_and_b32 v48, 1, v48
  v_cmp_ne_u32 vcc, 0, v48
  s_cbranch_vccnz T_p1re_91
T_p1ok_92:
  s_nop 2
  v_add_f32_dpp v120, v120, v120 row_ror:8 row_mask:0xf bank_mask:0xf
  v_add_f32_dpp v121, v121, v121 row_ror:8 row_mask:0xf bank_mask:0xf
  v_cvt_pk_bf16_f32 v48, v120, v121
  v_min_u32 v48, -2, v48
  buffer_store_dword v48, v8, s[4:7], s35 offen
  buffer_store_dword v49, v8, s[4:7], s26 offen
  s_barrier
  ds_read_b128 v[28:31], v2 offset:16384
  ds_read_b128 v[32:35], v2 offset:20480
  ds_read_b128 v[36:39], v2 offset:8192
  ds_read_b128 v[40:43], v2 offset:9216
  ds_read_b128 v[44:47], v2 offset:10240
  ds_read_b128 v[48:51], v2 offset:11264
  buffer_load_dwordx4 v[124:127], v3, s[4:7], s24 offen offset:0 sc1
  buffer_load_dwordx4 v[116:119], v3, s[4:7], s25 offen offset:0 sc1
  ds_read_b128 v[52:55], v2 offset:12288
  ds_read_b128 v[56:59], v2 offset:13312
  ds_read_b128 v[60:63], v2 offset:14336
  ds_read_b128 v[64:67], v2 offset:15360
  buffer_load_dwordx4 v[124:127], v3, s[4:7], s24 offen offset:0 sc1
  buffer_load_dwordx4 v[116:119], v3, s[4:7], s25 offen offset:0 sc1
  s_mov_b32 s19, 0
  s_branch T_loop_81
T_p1re_91:
  s_mov_b64 exec, vcc
  buffer_load_dwordx4 v[52:55], v2, s[4:7], s22 offen offset:0 sc1
  buffer_load_dwordx4 v[56:59], v2, s[4:7], s22 offen offset:1024 sc1
  buffer_load_dwordx4 v[60:63], v2, s[4:7], s22 offen offset:2048 sc1
  buffer_load_dwordx4 v[64:67], v2, s[4:7], s22 offen offset:3072 sc1
  s_mov_b64 exec, -1
  s_add_u32 s19, s19, 1
  s_cmp_gt_u32 s19, 32768
  s_cbranch_scc1 M_exit
  s_waitcnt vmcnt(3)
  v_mfma_f32_16x16x32_bf16 v[120:123], v[116:119], v[52:55], 0
  v_xor_b32 v48, s57, v52
  v_bitop3_b32 v48, v48, v54, s57 bitop3:0xf6
  s_waitcnt vmcnt(2)
  v_mfma_f32_16x16x32_bf16 v[120:123], v[116:119], v[56:59], v[120:123]
  v_bitop3_b32 v48, v48, v56, s57 bitop3:0xf6
  v_bitop3_b32 v48, v48, v58, s57 bitop3:0xf6
  s_waitcnt vmcnt(1)
  v_mfma_f32_16x16x32_bf16 v[120:123], v[116:119], v[60:63], v[120:123]
  v_bitop3_b32 v48, v48, v60, s57 bitop3:0xf6
  v_bitop3_b32 v48, v48, v62, s57 bitop3:0xf6
  s_waitcnt vmcnt(0)
  v_mfma_f32_16x16x32_bf16 v[120:123], v[116:119], v[64:67], v[120:123]
  v_bitop3_b32 v48, v48, v64, s57 bitop3:0xf6
  v_bitop3_b32 v48, v48, v66, s57 bitop3:0xf6
  v_and_b32 v48, 1, v48
  v_cmp_ne_u32 vcc, 0, v48
  s_cbranch_vccnz T_p1re_91
  s_branch T_p1ok_92
T_kvw_85:
  s_mov_b32 s19, 0
  s_branch T_kvok_94
T_kv_93:
  s_sleep 4
  s_add_u32 s19, s19, 1
  s_cmp_gt_u32 s19, 32768
  s_cbranch_scc1 M_exit
T_kvok_94:
  s_add_u32 s39, s99, 128
  s_mov_b32 s38, 0
  s_mov_b32 s37, 0
  s_atomic_or s38, s[58:59], s99 glc
  s_atomic_or s37, s[58:59], s39 glc
  s_waitcnt lgkmcnt(0)
  s_add_u32 s37, s37, 30
  s_cmp_ge_u32 s38, 30
  s_cselect_b32 s38, s37, s38
  s_cmp_ge_u32 s38, 64
  s_cselect_b32 s38, 100, s38
  s_sub_u32 s38, s38, 1
  s_max_i32 s30, s30, s38
  s_cmp_ge_i32 s14, s30
  s_cbranch_scc1 T_kv_93
  s_branch T_kvb_86
T_slow_88:
  s_nop 7
  v_max3_f32 v100, v16, v17, v18
  v_max3_f32 v100, v100, v19, v20
  v_max3_f32 v100, v100, v21, v22
  v_max3_f32 v100, v100, v23, v112
  v_max3_f32 v100, v100, v113, v114
  v_max_f32 v100, v100, v115
  v_mov_b32 v101, v100
  s_nop 1
  v_permlane32_swap_b32 v100, v101
  s_nop 1
  v_max_f32 v100, v100, v101
  v_mov_b32 v101, v100
  s_nop 1
  v_permlane16_swap_b32 v100, v101
  s_nop 1
  v_max_f32 v100, v100, v101
  v_sub_f32 v16, v16, v100
  v_sub_f32 v17, v17, v100
  v_sub_f32 v18, v18, v100
  v_sub_f32 v19, v19, v100
  v_exp_f32 v16, v16
  v_exp_f32 v17, v17
  v_exp_f32 v18, v18
  v_exp_f32 v19, v19
  v_sub_f32 v20, v20, v100
  v_sub_f32 v21, v21, v100
  v_sub_f32 v22, v22, v100
  v_sub_f32 v23, v23, v100
  v_exp_f32 v20, v20
  v_exp_f32 v21, v21
  v_exp_f32 v22, v22
  v_exp_f32 v23, v23
  v_sub_f32 v112, v112, v100
  v_sub_f32 v113, v113, v100
  v_sub_f32 v114, v114, v100
  v_sub_f32 v115, v115, v100
  v_exp_f32 v112, v112
  v_exp_f32 v113, v113
  v_exp_f32 v114, v114
  v_exp_f32 v115, v115
  s_nop 0
  v_cvt_pk_bf16_f32 v44, v16, v17
  v_cvt_pk_bf16_f32 v45, v18, v19
  v_cvt_pk_bf16_f32 v46, v20, v21
  v_cvt_pk_bf16_f32 v47, v22, v23
  v_cvt_pk_bf16_f32 v84, v112, v113
  v_cvt_pk_bf16_f32 v85, v114, v115
  v_cndmask_b32 v48, v84, 0, s[16:17]
  v_cndmask_b32 v49, v85, 0, s[16:17]
  v_cndmask_b32 v50, 0, v84, s[16:17]
  v_cndmask_b32 v51, 0, v85, s[16:17]
  s_nop 1
  v_mfma_f32_16x16x16_bf16 v[88:91], v[12:13], v[48:49], 0
  v_mfma_f32_16x16x16_bf16 v[24:27], v[120:121], v[48:49], 0
  v_mfma_f32_16x16x16_bf16 v[116:119], v[120:121], v[50:51], 0
  v_mfma_f32_16x16x32_bf16 v[88:91], v[12:15], v[44:47], v[88:91]
  v_mfma_f32_16x16x32_bf16 v[24:27], v[28:31], v[44:47], v[24:27]
  v_mfma_f32_16x16x32_bf16 v[116:119], v[32:35], v[44:47], v[116:119]
  s_nop 7
  s_nop 1
  v_rcp_f32 v89, v88
  s_nop 0
  v_mul_f32 v24, v89, v24
  v_mul_f32 v25, v89, v25
  s_branch T_back_89
T_w_78:
  s_mov_b32 s19, 0
  v_mov_b64 v[16:17], 0
  v_mov_b64 v[18:19], 0
  v_mov_b64 v[20:21], 0
  v_mov_b64 v[22:23], 0
  v_mov_b64 v[24:25], 0
  v_mov_b64 v[26:27], 0
  buffer_load_dwordx4 v[124:127], v3, s[4:7], s24 offen offset:1024 sc1
  buffer_load_dwordx4 v[116:119], v3, s[4:7], s25 offen offset:1024 sc1
  buffer_load_dwordx4 v[124:127], v3, s[4:7], s24 offen offset:1024 sc1
  buffer_load_dwordx4 v[116:119], v3, s[4:7], s25 offen offset:1024 sc1
  s_branch T_loop_95
.p2align 6
T_retry_96:
  s_mov_b64 exec, vcc
  buffer_load_dwordx4 v[124:127], v3, s[4:7], s24 offen offset:1024 sc1
  buffer_load_dwordx4 v[116:119], v3, s[4:7], s25 offen offset:1024 sc1
  s_mov_b64 exec, -1
  s_add_u32 s19, s19, 1
  s_cmp_gt_u32 s19, 32768
  s_cbranch_scc1 M_exit
T_loop_95:
  s_waitcnt vmcnt(3) lgkmcnt(0)
  v_max3_u32 v123, v124, v125, v126
  v_max_u32 v123, v123, v127
  v_mov_b32_dpp v120, v124 row_ror:8 row_mask:0xf bank_mask:0xf
  v_mov_b32_dpp v121, v125 row_ror:8 row_mask:0xf bank_mask:0xf
  s_waitcnt vmcnt(2)
  v_max3_u32 v123, v123, v116, v117
  v_max3_u32 v123, v123, v118, v119
  v_cmp_eq_u32 vcc, -1, v123
  s_cbranch_vccnz T_retry_96
  v_smfmac_f32_16x16x64_bf16 v[16:19], v[124:127], v[68:75], v0
  s_add_u32 s14, s14, 1
  ds_write_b128 v2, v[124:127] offset:1024
  v_mov_b32_dpp v122, v126 row_ror:8 row_mask:0xf bank_mask:0xf
  v_smfmac_f32_16x16x64_bf16 v[20:23], v[124:127], v[76:83], v0
  s_and_b32 s57, s14, 1
  v_mov_b32_dpp v123, v127 row_ror:8 row_mask:0xf bank_mask:0xf
  v_smfmac_f32_16x16x64_bf16 v[24:27], v[124:127], v[84:91], v0
  s_and_b32 s36, s14, 3
  ds_write_b128 v2, v[116:119] offset:5120
  v_smfmac_f32_16x16x64_bf16 v[16:19], v[120:123], v[92:99], v0
  s_lshl_b32 s36, s36, 13
  v_mov_b32_dpp v84, v116 row_ror:8 row_mask:0xf bank_mask:0xf
  v_smfmac_f32_16x16x64_bf16 v[20:23], v[120:123], v[100:107], v0
  s_add_u32 s26, s36, s23
  ds_read_b128 v[68:71], v4 offset:12288
  v_mov_b32_dpp v85, v117 row_ror:8 row_mask:0xf bank_mask:0xf
  v_smfmac_f32_16x16x64_bf16 v[24:27], v[120:123], v[108:115], v0
  s_add_u32 s36, s36, 8192
  ds_read_b128 v[72:75], v4 offset:13312
  v_mov_b32_dpp v86, v118 row_ror:8 row_mask:0xf bank_mask:0xf
  v_smfmac_f32_16x16x64_bf16 v[16:19], v[116:119], v[224:231], v0
  s_and_b32 s36, s36, 0x7fff
  ds_read_b128 v[76:79], v4 offset:14336
  v_mov_b32_dpp v87, v119 row_ror:8 row_mask:0xf bank_mask:0xf
  v_smfmac_f32_16x16x64_bf16 v[20:23], v[116:119], v[240:247], v0
  s_waitcnt lgkmcnt(3)
  s_barrier
  ds_read_b128 v[100:103], v2 offset:0
  v_smfmac_f32_16x16x64_bf16 v[24:27], v[116:119], a[0:7], v0
  s_mov_b32 m0, s31
  ds_read_b128 v[120:123], v1 offset:0
  v_smfmac_f32_16x16x64_bf16 v[16:19], v[84:87], v[232:239], v0
  s_cmp_ge_i32 s14, s30
  s_cbranch_scc1 T_kvw_99
T_kvb_100:
  v_smfmac_f32_16x16x64_bf16 v[20:23], v[84:87], v[248:255], v0
  ds_read_b128 v[80:83], v4 offset:15360
  v_smfmac_f32_16x16x64_bf16 v[24:27], v[84:87], a[8:15], v0
  s_waitcnt lgkmcnt(2)
  buffer_load_dwordx4 v9, s[4:7], s27 offen sc1 lds
  v_smfmac_f32_16x16x64_bf16 v[16:19], v[100:103], v[128:135], v0
  ds_read_b128 v[92:95], v2 offset:3072
  s_mov_b32 m0, s32
  v_smfmac_f32_16x16x64_bf16 v[20:23], v[100:103], v[144:151], v0
  ds_read_b128 v[96:99], v1 offset:3072
  v_smfmac_f32_16x16x64_bf16 v[24:27], v[100:103], v[68:75], v0
  s_waitcnt vmcnt(1) lgkmcnt(3)
  ds_read_b128 v[116:119], v2 offset:2048
  v_smfmac_f32_16x16x64_bf16 v[16:19], v[120:123], v[136:143], v0
  ds_read_b128 v[124:127], v1 offset:2048
  buffer_load_dwordx4 v9, s[4:7], s27 offen offset:128 sc1 lds
  v_smfmac_f32_16x16x64_bf16 v[20:23], v[120:123], v[152:159], v0
  s_waitcnt lgkmcnt(4)
  ds_read_b128 v[104:107], v2 offset:4096
  s_mov_b32 m0, s33
  v_smfmac_f32_16x16x64_bf16 v[24:27], v[120:123], v[76:83], v0
  s_waitcnt lgkmcnt(4)
  ds_read_b128 v[108:111], v1 offset:4096
  v_smfmac_f32_16x16x64_bf16 v[16:19], v[92:95], v[160:167], v0
  s_waitcnt lgkmcnt(4)
  ds_read_b128 v[112:115], v2 offset:7168
  v_smfmac_f32_16x16x64_bf16 v[16:19], v[96:99], v[168:175], v0
  s_waitcnt lgkmcnt(4)
  ds_read_b128 v[84:87], v1 offset:7168
  buffer_load_dwordx4 v10, s[4:7], s28 offen sc1 lds
  v_smfmac_f32_16x16x64_bf16 v[16:19], v[116:119], v[192:199], v0
  s_waitcnt lgkmcnt(4)
  ds_read_b128 v[88:91], v2 offset:6144
  s_mov_b32 m0, s34
  v_smfmac_f32_16x16x64_bf16 v[16:19], v[124:127], v[200:207], v0
  s_waitcnt lgkmcnt(4)
  ds_read_b128 v[100:103], v1 offset:6144
  v_smfmac_f32_16x16x64_bf16 v[16:19], v[104:107], a[16:23], v0
  s_waitcnt lgkmcnt(4)
  ds_read_b128 v[68:71], v4 offset:16384
  v_smfmac_f32_16x16x64_bf16 v[16:19], v[108:111], a[24:31], v0
  s_waitcnt lgkmcnt(4)
  ds_read_b128 v[72:75], v4 offset:17408
  buffer_load_dwordx4 v10, s[4:7], s28 offen offset:256 sc1 lds
  v_smfmac_f32_16x16x64_bf16 v[16:19], v[112:115], a[64:71], v0
  s_waitcnt lgkmcnt(4)
  ds_read_b128 v[76:79], v4 offset:18432
  v_smfmac_f32_16x16x64_bf16 v[16:19], v[84:87], a[72:79], v0
  s_waitcnt lgkmcnt(4)
  ds_read_b128 v[80:83], v4 offset:19456
  v_smfmac_f32_16x16x64_bf16 v[16:19], v[88:91], a[112:119], v0
  s_waitcnt lgkmcnt(4)
  v_smfmac_f32_16x16x64_bf16 v[16:19], v[100:103], a[120:127], v0
  s_add_u32 s24, s36, 145752064
  s_add_u32 s25, s36, 145756160
  v_smfmac_f32_16x16x64_bf16 v[20:23], v[92:95], v[176:183], v0
  s_add_u32 s35, s36, s23
  v_smfmac_f32_16x16x64_bf16 v[20:23], v[96:99], v[184:191], v0
  s_waitcnt lgkmcnt(2)
  v_smfmac_f32_16x16x64_bf16 v[20:23], v[116:119], v[68:75], v0
  s_waitcnt lgkmcnt(0)
  ds_read_b128 v[68:71], v4 offset:20480
  v_mul_f32 v16, s18, v16
  v_smfmac_f32_16x16x64_bf16 v[20:23], v[124:127], v[76:83], v0
  ds_read_b128 v[72:75], v4 offset:21504
  v_mul_f32 v17, s18, v17
  v_smfmac_f32_16x16x64_bf16 v[20:23], v[104:107], a[32:39], v0
  ds_read_b128 v[76:79], v4 offset:22528
  v_mul_f32 v18, s18, v18
  v_smfmac_f32_16x16x64_bf16 v[20:23], v[108:111], a[40:47], v0
  ds_read_b128 v[80:83], v4 offset:23552
  v_mul_f32 v19, s18, v19
  v_smfmac_f32_16x16x64_bf16 v[20:23], v[112:115], a[80:87], v0
  v_cvt_pk_bf16_f32 v120, v16, v17
  v_smfmac_f32_16x16x64_bf16 v[20:23], v[84:87], a[88:95], v0
  v_cvt_pk_bf16_f32 v121, v18, v19
  v_smfmac_f32_16x16x64_bf16 v[20:23], v[88:91], a[128:135], v0
  ds_write_b64 v5, v[120:121] offset:24576
  v_smfmac_f32_16x16x64_bf16 v[20:23], v[100:103], a[136:143], v0
  s_waitcnt lgkmcnt(3)
  v_smfmac_f32_16x16x64_bf16 v[24:27], v[92:95], v[68:75], v0
  s_waitcnt lgkmcnt(1)
  v_mov_b64 v[92:93], 0
  v_smfmac_f32_16x16x64_bf16 v[24:27], v[96:99], v[76:83], v0
  s_nop 1
  v_cvt_pk_bf16_f32 v122, v20, v21
  v_cvt_pk_bf16_f32 v123, v22, v23
  v_smfmac_f32_16x16x64_bf16 v[24:27], v[116:119], v[208:215], v0
  ds_write_b64 v5, v[122:123] offset:26880
  v_mov_b64 v[94:95], 0
  v_smfmac_f32_16x16x64_bf16 v[24:27], v[124:127], v[216:223], v0
  s_waitcnt lgkmcnt(1)
  s_barrier
  ds_read_b64_tr_b16 v[68:69], v6 offset:24576
  v_smfmac_f32_16x16x64_bf16 v[24:27], v[104:107], a[48:55], v0
  s_add_u32 s27, s27, 8192
  ds_read_b64_tr_b16 v[70:71], v6 offset:24640
  ds_read_b64_tr_b16 v[72:73], v6 offset:24832
  v_smfmac_f32_16x16x64_bf16 v[24:27], v[108:111], a[56:63], v0
  s_add_u32 s28, s28, 8192
  ds_read_b64_tr_b16 v[74:75], v6 offset:24896
  ds_read_b64_tr_b16 v[76:77], v6 offset:25088
  v_smfmac_f32_16x16x64_bf16 v[24:27], v[112:115], a[96:103], v0
  s_nop 0
  ds_read_b64_tr_b16 v[78:79], v6 offset:25152
  ds_read_b64_tr_b16 v[80:81], v6 offset:25344
  v_smfmac_f32_16x16x64_bf16 v[24:27], v[84:87], a[104:111], v0
  ds_read_b64_tr_b16 v[82:83], v6 offset:25408
  v_mov_b64 v[96:97], 0
  v_smfmac_f32_16x16x64_bf16 v[24:27], v[88:91], a[144:151], v0
  s_waitcnt lgkmcnt(8)
  s_barrier
  ds_read_b64_tr_b16 v[116:117], v6 offset:26880
  v_smfmac_f32_16x16x64_bf16 v[24:27], v[100:103], a[152:159], v0
  s_waitcnt lgkmcnt(7)
  ds_read_b64_tr_b16 v[118:119], v6 offset:26944
  v_mfma_f32_16x16x32_bf16 v[16:19], v[36:39], v[68:71], 0
  s_waitcnt lgkmcnt(6)
  ds_read_b64_tr_b16 v[124:125], v6 offset:27136
  ds_read_b64_tr_b16 v[126:127], v6 offset:27200
  v_mfma_f32_16x16x32_bf16 v[16:19], v[40:43], v[72:75], v[16:19]
  s_waitcnt lgkmcnt(6)
  ds_read_b64_tr_b16 v[104:105], v6 offset:27392
  ds_read_b64_tr_b16 v[106:107], v6 offset:27456
  v_mfma_f32_16x16x32_bf16 v[16:19], v[44:47], v[76:79], v[16:19]
  s_waitcnt lgkmcnt(6)
  ds_read_b64_tr_b16 v[108:109], v6 offset:27648
  ds_read_b64_tr_b16 v[110:111], v6 offset:27712
  v_mfma_f32_16x16x32_bf16 v[16:19], v[48:51], v[80:83], v[16:19]
  s_waitcnt lgkmcnt(6)
  v_cvt_pk_bf16_f32 v120, v24, v25
  v_cvt_pk_bf16_f32 v121, v26, v27
  v_mfma_f32_16x16x32_bf16 v[112:115], v[116:119], v[68:71], 0
  s_waitcnt lgkmcnt(4)
  buffer_store_dwordx4 v[120:123], v2, s[4:7], s29 offen offset:1024 sc1
  v_mov_b64 v[98:99], 0
  v_mfma_f32_16x16x32_bf16 v[112:115], v[124:127], v[72:75], v[112:115]
  s_waitcnt lgkmcnt(2)
  v_mov_b64 v[36:37], 0
  v_exp_f32 v100, v16
  v_mfma_f32_16x16x32_bf16 v[112:115], v[104:107], v[76:79], v[112:115]
  s_waitcnt lgkmcnt(0)
  v_exp_f32 v101, v17
  v_mfma_f32_16x16x32_bf16 v[112:115], v[108:111], v[80:83], v[112:115]
  s_add_u32 s29, s29, 131072
  v_exp_f32 v102, v18
  v_mfma_f32_16x16x32_bf16 v[20:23], v[52:55], v[68:71], 0
  s_cmp_eq_u32 s14, 63
  v_exp_f32 v103, v19
  v_mfma_f32_16x16x32_bf16 v[20:23], v[56:59], v[72:75], v[20:23]
  s_cbranch_scc1 M_tdone
  v_cvt_pk_bf16_f32 v44, v100, v101
  v_cvt_pk_bf16_f32 v45, v102, v103
  v_mfma_f32_16x16x32_bf16 v[20:23], v[60:63], v[76:79], v[20:23]
  v_exp_f32 v100, v112
  v_mfma_f32_16x16x32_bf16 v[20:23], v[64:67], v[80:83], v[20:23]
  v_exp_f32 v101, v113
  v_exp_f32 v102, v114
  v_exp_f32 v103, v115
  v_cvt_pk_bf16_f32 v84, v100, v101
  v_cvt_pk_bf16_f32 v85, v102, v103
  v_cndmask_b32 v48, v84, 0, s[16:17]
  v_cndmask_b32 v49, v85, 0, s[16:17]
  v_cndmask_b32 v50, 0, v84, s[16:17]
  v_cndmask_b32 v51, 0, v85, s[16:17]
  v_exp_f32 v100, v20
  v_mfma_f32_16x16x16_bf16 v[88:91], v[12:13], v[48:49], 0
  v_exp_f32 v101, v21
  v_mfma_f32_16x16x16_bf16 v[24:27], v[120:121], v[48:49], 0
  v_exp_f32 v102, v22
  v_mfma_f32_16x16x16_bf16 v[116:119], v[120:121], v[50:51], 0
  v_exp_f32 v103, v23
  v_cvt_pk_bf16_f32 v46, v100, v101
  v_cvt_pk_bf16_f32 v47, v102, v103
  v_mov_b64 v[38:39], 0
  s_nop 0
  v_mfma_f32_16x16x32_bf16 v[88:91], v[12:15], v[44:47], v[88:91]
  v_mov_b64 v[40:41], 0
  v_mov_b64 v[42:43], 0
  v_mfma_f32_16x16x32_bf16 v[24:27], v[28:31], v[44:47], v[24:27]
  ds_read_b128 v[52:55], v4 offset:24576
  ds_read_b128 v[56:59], v4 offset:25600
  v_mfma_f32_16x16x32_bf16 v[116:119], v[32:35], v[44:47], v[116:119]
  s_nop 1
  v_rcp_f32 v89, v88
  v_subrev_u32 v100, s54, v88
  v_cmp_le_u32 vcc, s55, v100
  v_mul_f32 v24, v89, v24
  v_mul_f32 v25, v89, v25
  s_cbranch_vccnz T_slow_102
T_back_103:
  v_cvt_pk_bf16_f32 v124, v24, v25
  v_pk_mul_f32 v[26:27], v[26:27], v[88:89] op_sel:[0,1] op_sel_hi:[1,1]
  v_pk_mul_f32 v[116:117], v[116:117], v[88:89] op_sel:[0,1] op_sel_hi:[1,1]
  v_pk_mul_f32 v[118:119], v[118:119], v[88:89] op_sel:[0,1] op_sel_hi:[1,1]
  v_cvt_pk_bf16_f32 v125, v26, v27
  v_cvt_pk_bf16_f32 v126, v116, v117
  v_cvt_pk_bf16_f32 v127, v118, v119
  ds_write_b128 v11, v[124:127] offset:29696
  s_nop 0
  v_smfmac_f32_16x16x64_bf16 v[92:95], v[124:127], a[160:167], v0
  v_smfmac_f32_16x16x64_bf16 v[96:99], v[124:127], a[168:175], v0
  v_smfmac_f32_16x16x64_bf16 v[36:39], v[124:127], a[176:183], v0
  v_smfmac_f32_16x16x64_bf16 v[40:43], v[124:127], a[184:191], v0
  s_waitcnt lgkmcnt(0)
  s_barrier
  ds_read_b128 v[104:107], v11 offset:29184
  ds_read_b128 v[108:111], v11 offset:30720
  ds_read_b128 v[68:71], v11 offset:30208
  s_waitcnt lgkmcnt(2)
  v_smfmac_f32_16x16x64_bf16 v[92:95], v[104:107], a[192:199], v0
  s_waitcnt lgkmcnt(1)
  ds_read_b128 v[76:79], v4 offset:28672
  v_smfmac_f32_16x16x64_bf16 v[92:95], v[108:111], a[224:231], v0
  s_waitcnt lgkmcnt(1)
  ds_read_b128 v[80:83], v4 offset:29696
  v_smfmac_f32_16x16x64_bf16 v[92:95], v[68:71], a[240:247], v0
  ds_read_b128 v[60:63], v4 offset:26624
  v_smfmac_f32_16x16x64_bf16 v[96:99], v[104:107], a[200:207], v0
  ds_read_b128 v[64:67], v4 offset:27648
  v_smfmac_f32_16x16x64_bf16 v[96:99], v[108:111], a[232:239], v0
  ds_read_b128 v[28:31], v4 offset:30720
  s_nop 0
  v_cvt_pk_bf16_f32 v16, v92, v93
  v_cvt_pk_bf16_f32 v17, v94, v95
  v_bfi_b32 v16, 1, s57, v16
  v_smfmac_f32_16x16x64_bf16 v[96:99], v[68:71], a[248:255], v0
  buffer_store_dwordx2 v[16:17], v7, s[4:7], s20 offen offset:0
  v_smfmac_f32_16x16x64_bf16 v[36:39], v[104:107], a[208:215], v0
  ds_read_b128 v[32:35], v4 offset:31744
  v_smfmac_f32_16x16x64_bf16 v[36:39], v[108:111], v[52:59], v0
  s_waitcnt lgkmcnt(4)
  s_nop 0
  v_cvt_pk_bf16_f32 v18, v96, v97
  v_cvt_pk_bf16_f32 v19, v98, v99
  v_bfi_b32 v18, 1, s57, v18
  v_smfmac_f32_16x16x64_bf16 v[36:39], v[68:71], v[76:83], v0
  buffer_store_dwordx2 v[18:19], v7, s[4:7], s20 offen offset:64
  v_smfmac_f32_16x16x64_bf16 v[40:43], v[104:107], a[216:223], v0
  s_waitcnt lgkmcnt(2)
  ds_read_b128 v[116:119], v2 offset:31232
  v_smfmac_f32_16x16x64_bf16 v[40:43], v[108:111], v[60:67], v0
  s_waitcnt lgkmcnt(1)
  s_nop 0
  v_cvt_pk_bf16_f32 v20, v36, v37
  v_cvt_pk_bf16_f32 v21, v38, v39
  v_bfi_b32 v20, 1, s57, v20
  v_smfmac_f32_16x16x64_bf16 v[40:43], v[68:71], v[28:35], v0
  buffer_store_dwordx2 v[20:21], v7, s[4:7], s21 offen offset:0
  s_nop 6
  v_cvt_pk_bf16_f32 v22, v40, v41
  v_cvt_pk_bf16_f32 v23, v42, v43
  v_bfi_b32 v22, 1, s57, v22
  buffer_store_dwordx2 v[22:23], v7, s[4:7], s21 offen offset:64
  ds_read_b128 v[68:71], v4 offset:0
  ds_read_b128 v[72:75], v4 offset:1024
  ds_read_b128 v[76:79], v4 offset:4096
  ds_read_b128 v[80:83], v4 offset:5120
  ds_read_b128 v[84:87], v4 offset:8192
  ds_read_b128 v[88:91], v4 offset:9216
  ds_read_b128 v[92:95], v4 offset:2048
  ds_read_b128 v[96:99], v4 offset:3072
  ds_read_b128 v[100:103], v4 offset:6144
  ds_read_b128 v[104:107], v4 offset:7168
  ds_read_b128 v[108:111], v4 offset:10240
  ds_read_b128 v[112:115], v4 offset:11264
  v_mov_b64 v[16:17], 0
  v_mov_b64 v[18:19], 0
  v_mov_b64 v[20:21], 0
  v_mov_b64 v[22:23], 0
  v_mov_b64 v[24:25], 0
  v_mov_b64 v[26:27], 0
  s_mov_b32 s19, 0
  v_mov_b32 v49, -1
  ds_read_b64 v[44:45], v2 offset:32256
  s_waitcnt lgkmcnt(0)
  v_readfirstlane_b32 s38, v44
  v_readfirstlane_b32 s37, v45
  s_nop 0
  s_add_u32 s37, s37, 30
  s_cmp_ge_u32 s38, 30
  s_cselect_b32 s38, s37, s38
  s_cmp_ge_u32 s38, 64
  s_cselect_b32 s38, 100, s38
  s_sub_u32 s38, s38, 1
  s_max_i32 s30, s30, s38
  s_waitcnt vmcnt(0)
  buffer_load_dwordx4 v[52:55], v2, s[4:7], s22 offen offset:0 sc1
  buffer_load_dwordx4 v[56:59], v2, s[4:7], s22 offen offset:1024 sc1
  buffer_load_dwordx4 v[60:63], v2, s[4:7], s22 offen offset:2048 sc1
  buffer_load_dwordx4 v[64:67], v2, s[4:7], s22 offen offset:3072 sc1
  s_waitcnt lgkmcnt(12)
  s_waitcnt vmcnt(3)
  v_mfma_f32_16x16x32_bf16 v[120:123], v[116:119], v[52:55], 0
  v_xor_b32 v48, s57, v52
  v_bitop3_b32 v48, v48, v54, s57 bitop3:0xf6
  s_waitcnt vmcnt(2)
  v_mfma_f32_16x16x32_bf16 v[120:123], v[116:119], v[56:59], v[120:123]
  v_bitop3_b32 v48, v48, v56, s57 bitop3:0xf6
  v_bitop3_b32 v48, v48, v58, s57 bitop3:0xf6
  s_waitcnt vmcnt(1)
  v_mfma_f32_16x16x32_bf16 v[120:123], v[116:119], v[60:63], v[120:123]
  v_bitop3_b32 v48, v48, v60, s57 bitop3:0xf6
  v_bitop3_b32 v48, v48, v62, s57 bitop3:0xf6
  s_waitcnt vmcnt(0)
  v_mfma_f32_16x16x32_bf16 v[120:123], v[116:119], v[64:67], v[120:123]
  v_bitop3_b32 v48, v48, v64, s57 bitop3:0xf6
  v_bitop3_b32 v48, v48, v66, s57 bitop3:0xf6
  v_and_b32 v48, 1, v48
  v_cmp_ne_u32 vcc, 0, v48
  s_cbranch_vccnz T_p1re_105
T_p1ok_106:
  s_nop 2
  v_add_f32_dpp v120, v120, v120 row_ror:8 row_mask:0xf bank_mask:0xf
  v_add_f32_dpp v121, v121, v121 row_ror:8 row_mask:0xf bank_mask:0xf
  v_cvt_pk_bf16_f32 v48, v120, v121
  v_min_u32 v48, -2, v48
  buffer_store_dword v48, v8, s[4:7], s35 offen
  buffer_store_dword v49, v8, s[4:7], s26 offen
  s_barrier
  ds_read_b128 v[28:31], v2 offset:17408
  ds_read_b128 v[32:35], v2 offset:21504
  ds_read_b128 v[36:39], v2 offset:8192
  ds_read_b128 v[40:43], v2 offset:9216
  ds_read_b128 v[44:47], v2 offset:10240
  ds_read_b128 v[48:51], v2 offset:11264
  buffer_load_dwordx4 v[124:127], v3, s[4:7], s24 offen offset:1024 sc1
  buffer_load_dwordx4 v[116:119], v3, s[4:7], s25 offen offset:1024 sc1
  ds_read_b128 v[52:55], v2 offset:12288
  ds_read_b128 v[56:59], v2 offset:13312
  ds_read_b128 v[60:63], v2 offset:14336
  ds_read_b128 v[64:67], v2 offset:15360
  buffer_load_dwordx4 v[124:127], v3, s[4:7], s24 offen offset:1024 sc1
  buffer_load_dwordx4 v[116:119], v3, s[4:7], s25 offen offset:1024 sc1
  s_mov_b32 s19, 0
  s_branch T_loop_95
T_p1re_105:
  s_mov_b64 exec, vcc
  buffer_load_dwordx4 v[52:55], v2, s[4:7], s22 offen offset:0 sc1
  buffer_load_dwordx4 v[56:59], v2, s[4:7], s22 offen offset:1024 sc1
  buffer_load_dwordx4 v[60:63], v2, s[4:7], s22 offen offset:2048 sc1
  buffer_load_dwordx4 v[64:67], v2, s[4:7], s22 offen offset:3072 sc1
  s_mov_b64 exec, -1
  s_add_u32 s19, s19, 1
  s_cmp_gt_u32 s19, 32768
  s_cbranch_scc1 M_exit
  s_waitcnt vmcnt(3)
  v_mfma_f32_16x16x32_bf16 v[120:123], v[116:119], v[52:55], 0
  v_xor_b32 v48, s57, v52
  v_bitop3_b32 v48, v48, v54, s57 bitop3:0xf6
  s_waitcnt vmcnt(2)
  v_mfma_f32_16x16x32_bf16 v[120:123], v[116:119], v[56:59], v[120:123]
  v_bitop3_b32 v48, v48, v56, s57 bitop3:0xf6
  v_bitop3_b32 v48, v48, v58, s57 bitop3:0xf6
  s_waitcnt vmcnt(1)
  v_mfma_f32_16x16x32_bf16 v[120:123], v[116:119], v[60:63], v[120:123]
  v_bitop3_b32 v48, v48, v60, s57 bitop3:0xf6
  v_bitop3_b32 v48, v48, v62, s57 bitop3:0xf6
  s_waitcnt vmcnt(0)
  v_mfma_f32_16x16x32_bf16 v[120:123], v[116:119], v[64:67], v[120:123]
  v_bitop3_b32 v48, v48, v64, s57 bitop3:0xf6
  v_bitop3_b32 v48, v48, v66, s57 bitop3:0xf6
  v_and_b32 v48, 1, v48
  v_cmp_ne_u32 vcc, 0, v48
  s_cbranch_vccnz T_p1re_105
  s_branch T_p1ok_106
T_kvw_99:
  s_mov_b32 s19, 0
  s_branch T_kvok_108
T_kv_107:
  s_sleep 4
  s_add_u32 s19, s19, 1
  s_cmp_gt_u32 s19, 32768
  s_cbranch_scc1 M_exit
T_kvok_108:
  s_add_u32 s39, s99, 128
  s_mov_b32 s38, 0
  s_mov_b32 s37, 0
  s_atomic_or s38, s[58:59], s99 glc
  s_atomic_or s37, s[58:59], s39 glc
  s_waitcnt lgkmcnt(0)
  s_add_u32 s37, s37, 30
  s_cmp_ge_u32 s38, 30
  s_cselect_b32 s38, s37, s38
  s_cmp_ge_u32 s38, 64
  s_cselect_b32 s38, 100, s38
  s_sub_u32 s38, s38, 1
  s_max_i32 s30, s30, s38
  s_cmp_ge_i32 s14, s30
  s_cbranch_scc1 T_kv_107
  s_branch T_kvb_100
T_slow_102:
  s_nop 7
  v_max3_f32 v100, v16, v17, v18
  v_max3_f32 v100, v100, v19, v20
  v_max3_f32 v100, v100, v21, v22
  v_max3_f32 v100, v100, v23, v112
  v_max3_f32 v100, v100, v113, v114
  v_max_f32 v100, v100, v115
  v_mov_b32 v101, v100
  s_nop 1
  v_permlane32_swap_b32 v100, v101
  s_nop 1
  v_max_f32 v100, v100, v101
  v_mov_b32 v101, v100
  s_nop 1
  v_permlane16_swap_b32 v100, v101
  s_nop 1
  v_max_f32 v100, v100, v101
  v_sub_f32 v16, v16, v100
  v_sub_f32 v17, v17, v100
  v_sub_f32 v18, v18, v100
  v_sub_f32 v19, v19, v100
  v_exp_f32 v16, v16
  v_exp_f32 v17, v17
  v_exp_f32 v18, v18
  v_exp_f32 v19, v19
  v_sub_f32 v20, v20, v100
  v_sub_f32 v21, v21, v100
  v_sub_f32 v22, v22, v100
  v_sub_f32 v23, v23, v100
  v_exp_f32 v20, v20
  v_exp_f32 v21, v21
  v_exp_f32 v22, v22
  v_exp_f32 v23, v23
  v_sub_f32 v112, v112, v100
  v_sub_f32 v113, v113, v100
  v_sub_f32 v114, v114, v100
  v_sub_f32 v115, v115, v100
  v_exp_f32 v112, v112
  v_exp_f32 v113, v113
  v_exp_f32 v114, v114
  v_exp_f32 v115, v115
  s_nop 0
  v_cvt_pk_bf16_f32 v44, v16, v17
  v_cvt_pk_bf16_f32 v45, v18, v19
  v_cvt_pk_bf16_f32 v46, v20, v21
  v_cvt_pk_bf16_f32 v47, v22, v23
  v_cvt_pk_bf16_f32 v84, v112, v113
  v_cvt_pk_bf16_f32 v85, v114, v115
  v_cndmask_b32 v48, v84, 0, s[16:17]
  v_cndmask_b32 v49, v85, 0, s[16:17]
  v_cndmask_b32 v50, 0, v84, s[16:17]
  v_cndmask_b32 v51, 0, v85, s[16:17]
  s_nop 1
  v_mfma_f32_16x16x16_bf16 v[88:91], v[12:13], v[48:49], 0
  v_mfma_f32_16x16x16_bf16 v[24:27], v[120:121], v[48:49], 0
  v_mfma_f32_16x16x16_bf16 v[116:119], v[120:121], v[50:51], 0
  v_mfma_f32_16x16x32_bf16 v[88:91], v[12:15], v[44:47], v[88:91]
  v_mfma_f32_16x16x32_bf16 v[24:27], v[28:31], v[44:47], v[24:27]
  v_mfma_f32_16x16x32_bf16 v[116:119], v[32:35], v[44:47], v[116:119]
  s_nop 7
  s_nop 1
  v_rcp_f32 v89, v88
  s_nop 0
  v_mul_f32 v24, v89, v24
  v_mul_f32 v25, v89, v25
  s_branch T_back_103
T_w_79:
  s_mov_b32 s19, 0
  v_mov_b64 v[16:17], 0
  v_mov_b64 v[18:19], 0
  v_mov_b64 v[20:21], 0
  v_mov_b64 v[22:23], 0
  v_mov_b64 v[24:25], 0
  v_mov_b64 v[26:27], 0
  buffer_load_dwordx4 v[124:127], v3, s[4:7], s24 offen offset:2048 sc1
  buffer_load_dwordx4 v[116:119], v3, s[4:7], s25 offen offset:2048 sc1
  buffer_load_dwordx4 v[124:127], v3, s[4:7], s24 offen offset:2048 sc1
  buffer_load_dwordx4 v[116:119], v3, s[4:7], s25 offen offset:2048 sc1
  s_branch T_loop_109
.p2align 6
T_retry_110:
  s_mov_b64 exec, vcc
  buffer_load_dwordx4 v[124:127], v3, s[4:7], s24 offen offset:2048 sc1
  buffer_load_dwordx4 v[116:119], v3, s[4:7], s25 offen offset:2048 sc1
  s_mov_b64 exec, -1
  s_add_u32 s19, s19, 1
  s_cmp_gt_u32 s19, 32768
  s_cbranch_scc1 M_exit
T_loop_109:
  s_waitcnt vmcnt(3) lgkmcnt(0)
  v_max3_u32 v123, v124, v125, v126
  v_max_u32 v123, v123, v127
  v_mov_b32_dpp v120, v124 row_ror:8 row_mask:0xf bank_mask:0xf
  v_mov_b32_dpp v121, v125 row_ror:8 row_mask:0xf bank_mask:0xf
  s_waitcnt vmcnt(2)
  v_max3_u32 v123, v123, v116, v117
  v_max3_u32 v123, v123, v118, v119
  v_cmp_eq_u32 vcc, -1, v123
  s_cbranch_vccnz T_retry_110
  v_smfmac_f32_16x16x64_bf16 v[16:19], v[124:127], v[68:75], v0
  s_add_u32 s14, s14, 1
  ds_write_b128 v2, v[124:127] offset:2048
  v_mov_b32_dpp v122, v126 row_ror:8 row_mask:0xf bank_mask:0xf
  v_smfmac_f32_16x16x64_bf16 v[20:23], v[124:127], v[76:83], v0
  s_and_b32 s57, s14, 1
  v_mov_b32_dpp v123, v127 row_ror:8 row_mask:0xf bank_mask:0xf
  v_smfmac_f32_16x16x64_bf16 v[24:27], v[124:127], v[84:91], v0
  s_and_b32 s36, s14, 3
  ds_write_b128 v2, v[116:119] offset:6144
  v_smfmac_f32_16x16x64_bf16 v[16:19], v[120:123], v[92:99], v0
  s_lshl_b32 s36, s36, 13
  v_mov_b32_dpp v84, v116 row_ror:8 row_mask:0xf bank_mask:0xf
  v_smfmac_f32_16x16x64_bf16 v[20:23], v[120:123], v[100:107], v0
  s_add_u32 s26, s36, s23
  ds_read_b128 v[68:71], v4 offset:12288
  v_mov_b32_dpp v85, v117 row_ror:8 row_mask:0xf bank_mask:0xf
  v_smfmac_f32_16x16x64_bf16 v[24:27], v[120:123], v[108:115], v0
  s_add_u32 s36, s36, 8192
  ds_read_b128 v[72:75], v4 offset:13312
  v_mov_b32_dpp v86, v118 row_ror:8 row_mask:0xf bank_mask:0xf
  v_smfmac_f32_16x16x64_bf16 v[16:19], v[116:119], v[224:231], v0
  s_and_b32 s36, s36, 0x7fff
  ds_read_b128 v[76:79], v4 offset:14336
  v_mov_b32_dpp v87, v119 row_ror:8 row_mask:0xf bank_mask:0xf
  v_smfmac_f32_16x16x64_bf16 v[20:23], v[116:119], v[240:247], v0
  s_waitcnt lgkmcnt(3)
  s_barrier
  ds_read_b128 v[100:103], v2 offset:3072
  v_smfmac_f32_16x16x64_bf16 v[24:27], v[116:119], a[0:7], v0
  s_mov_b32 m0, s31
  ds_read_b128 v[120:123], v1 offset:3072
  v_smfmac_f32_16x16x64_bf16 v[16:19], v[84:87], v[232:239], v0
  s_cmp_ge_i32 s14, s30
  s_cbranch_scc1 T_kvw_113
T_kvb_114:
  v_smfmac_f32_16x16x64_bf16 v[20:23], v[84:87], v[248:255], v0
  ds_read_b128 v[80:83], v4 offset:15360
  v_smfmac_f32_16x16x64_bf16 v[24:27], v[84:87], a[8:15], v0
  s_waitcnt lgkmcnt(2)
  v_smfmac_f32_16x16x64_bf16 v[16:19], v[100:103], v[128:135], v0
  ds_read_b128 v[92:95], v2 offset:0
  buffer_load_dwordx4 v9, s[4:7], s27 offen sc1 lds
  v_smfmac_f32_16x16x64_bf16 v[20:23], v[100:103], v[144:151], v0
  ds_read_b128 v[96:99], v1 offset:0
  s_mov_b32 m0, s32
  v_smfmac_f32_16x16x64_bf16 v[24:27], v[100:103], v[68:75], v0
  s_waitcnt vmcnt(1) lgkmcnt(3)
  ds_read_b128 v[116:119], v2 offset:1024
  v_smfmac_f32_16x16x64_bf16 v[16:19], v[120:123], v[136:143], v0
  ds_read_b128 v[124:127], v1 offset:1024
  v_smfmac_f32_16x16x64_bf16 v[20:23], v[120:123], v[152:159], v0
  s_waitcnt lgkmcnt(4)
  ds_read_b128 v[104:107], v2 offset:7168
  buffer_load_dwordx4 v9, s[4:7], s27 offen offset:128 sc1 lds
  v_smfmac_f32_16x16x64_bf16 v[24:27], v[120:123], v[76:83], v0
  s_waitcnt lgkmcnt(4)
  ds_read_b128 v[108:111], v1 offset:7168
  s_mov_b32 m0, s33
  v_smfmac_f32_16x16x64_bf16 v[16:19], v[92:95], v[160:167], v0
  s_waitcnt lgkmcnt(4)
  ds_read_b128 v[112:115], v2 offset:4096
  v_mov_b32 v122, s98
  v_smfmac_f32_16x16x64_bf16 v[16:19], v[96:99], v[168:175], v0
  s_waitcnt lgkmcnt(4)
  ds_read_b128 v[84:87], v1 offset:4096
  v_smfmac_f32_16x16x64_bf16 v[16:19], v[116:119], v[192:199], v0
  s_waitcnt lgkmcnt(4)
  ds_read_b128 v[88:91], v2 offset:5120
  buffer_load_dwordx4 v10, s[4:7], s28 offen sc1 lds
  v_smfmac_f32_16x16x64_bf16 v[16:19], v[124:127], v[200:207], v0
  s_waitcnt lgkmcnt(4)
  ds_read_b128 v[100:103], v1 offset:5120
  s_mov_b32 m0, s34
  v_smfmac_f32_16x16x64_bf16 v[16:19], v[104:107], a[16:23], v0
  s_waitcnt lgkmcnt(4)
  ds_read_b128 v[68:71], v4 offset:16384
  v_smfmac_f32_16x16x64_bf16 v[16:19], v[108:111], a[24:31], v0
  s_waitcnt lgkmcnt(4)
  ds_read_b128 v[72:75], v4 offset:17408
  v_smfmac_f32_16x16x64_bf16 v[16:19], v[112:115], a[64:71], v0
  s_waitcnt lgkmcnt(4)
  ds_read_b128 v[76:79], v4 offset:18432
  buffer_load_dwordx4 v10, s[4:7], s28 offen offset:256 sc1 lds
  v_smfmac_f32_16x16x64_bf16 v[16:19], v[84:87], a[72:79], v0
  s_waitcnt lgkmcnt(4)
  ds_read_b128 v[80:83], v4 offset:19456
  v_smfmac_f32_16x16x64_bf16 v[16:19], v[88:91], a[112:119], v0
  s_waitcnt lgkmcnt(4)
  v_smfmac_f32_16x16x64_bf16 v[16:19], v[100:103], a[120:127], v0
  s_add_u32 s24, s36, 145752064
  s_add_u32 s25, s36, 145756160
  v_smfmac_f32_16x16x64_bf16 v[20:23], v[92:95], v[176:183], v0
  buffer_store_dword v122, v8, s[4:7], s15 offen sc1
  s_add_u32 s35, s36, s23
  v_smfmac_f32_16x16x64_bf16 v[20:23], v[96:99], v[184:191], v0
  s_waitcnt lgkmcnt(2)
  s_add_u32 s98, s14, 1
  v_smfmac_f32_16x16x64_bf16 v[20:23], v[116:119], v[68:75], v0
  s_waitcnt lgkmcnt(0)
  ds_read_b128 v[68:71], v4 offset:20480
  v_mul_f32 v16, s18, v16
  v_smfmac_f32_16x16x64_bf16 v[20:23], v[124:127], v[76:83], v0
  ds_read_b128 v[72:75], v4 offset:21504
  v_mul_f32 v17, s18, v17
  v_smfmac_f32_16x16x64_bf16 v[20:23], v[104:107], a[32:39], v0
  ds_read_b128 v[76:79], v4 offset:22528
  v_mul_f32 v18, s18, v18
  v_smfmac_f32_16x16x64_bf16 v[20:23], v[108:111], a[40:47], v0
  ds_read_b128 v[80:83], v4 offset:23552
  v_mul_f32 v19, s18, v19
  v_smfmac_f32_16x16x64_bf16 v[20:23], v[112:115], a[80:87], v0
  v_cvt_pk_bf16_f32 v120, v16, v17
  v_smfmac_f32_16x16x64_bf16 v[20:23], v[84:87], a[88:95], v0
  v_cvt_pk_bf16_f32 v121, v18, v19
  v_smfmac_f32_16x16x64_bf16 v[20:23], v[88:91], a[128:135], v0
  ds_write_b64 v5, v[120:121] offset:24576
  v_smfmac_f32_16x16x64_bf16 v[20:23], v[100:103], a[136:143], v0
  s_waitcnt lgkmcnt(3)
  v_smfmac_f32_16x16x64_bf16 v[24:27], v[92:95], v[68:75], v0
  s_waitcnt lgkmcnt(1)
  v_mov_b64 v[92:93], 0
  v_smfmac_f32_16x16x64_bf16 v[24:27], v[96:99], v[76:83], v0
  s_nop 1
  v_cvt_pk_bf16_f32 v122, v20, v21
  v_cvt_pk_bf16_f32 v123, v22, v23
  v_smfmac_f32_16x16x64_bf16 v[24:27], v[116:119], v[208:215], v0
  ds_write_b64 v5, v[122:123] offset:26880
  v_mov_b64 v[94:95], 0
  v_smfmac_f32_16x16x64_bf16 v[24:27], v[124:127], v[216:223], v0
  s_waitcnt lgkmcnt(1)
  s_barrier
  ds_read_b64_tr_b16 v[68:69], v6 offset:24576
  v_smfmac_f32_16x16x64_bf16 v[24:27], v[104:107], a[48:55], v0
  s_add_u32 s27, s27, 8192
  ds_read_b64_tr_b16 v[70:71], v6 offset:24640
  ds_read_b64_tr_b16 v[72:73], v6 offset:24832
  v_smfmac_f32_16x16x64_bf16 v[24:27], v[108:111], a[56:63], v0
  s_add_u32 s28, s28, 8192
  ds_read_b64_tr_b16 v[74:75], v6 offset:24896
  ds_read_b64_tr_b16 v[76:77], v6 offset:25088
  v_smfmac_f32_16x16x64_bf16 v[24:27], v[112:115], a[96:103], v0
  s_nop 0
  ds_read_b64_tr_b16 v[78:79], v6 offset:25152
  ds_read_b64_tr_b16 v[80:81], v6 offset:25344
  v_smfmac_f32_16x16x64_bf16 v[24:27], v[84:87], a[104:111], v0
  ds_read_b64_tr_b16 v[82:83], v6 offset:25408
  v_mov_b64 v[96:97], 0
  v_smfmac_f32_16x16x64_bf16 v[24:27], v[88:91], a[144:151], v0
  s_waitcnt lgkmcnt(8)
  s_barrier
  ds_read_b64_tr_b16 v[116:117], v6 offset:26880
  v_smfmac_f32_16x16x64_bf16 v[24:27], v[100:103], a[152:159], v0
  s_waitcnt lgkmcnt(7)
  ds_read_b64_tr_b16 v[118:119], v6 offset:26944
  v_mfma_f32_16x16x32_bf16 v[16:19], v[36:39], v[68:71], 0
  s_waitcnt lgkmcnt(6)
  ds_read_b64_tr_b16 v[124:125], v6 offset:27136
  ds_read_b64_tr_b16 v[126:127], v6 offset:27200
  v_mfma_f32_16x16x32_bf16 v[16:19], v[40:43], v[72:75], v[16:19]
  s_waitcnt lgkmcnt(6)
  ds_read_b64_tr_b16 v[104:105], v6 offset:27392
  ds_read_b64_tr_b16 v[106:107], v6 offset:27456
  v_mfma_f32_16x16x32_bf16 v[16:19], v[44:47], v[76:79], v[16:19]
  s_waitcnt lgkmcnt(6)
  ds_read_b64_tr_b16 v[108:109], v6 offset:27648
  ds_read_b64_tr_b16 v[110:111], v6 offset:27712
  v_mfma_f32_16x16x32_bf16 v[16:19], v[48:51], v[80:83], v[16:19]
  s_waitcnt lgkmcnt(6)
  v_cvt_pk_bf16_f32 v120, v24, v25
  v_cvt_pk_bf16_f32 v121, v26, v27
  v_mfma_f32_16x16x32_bf16 v[112:115], v[116:119], v[68:71], 0
  s_waitcnt lgkmcnt(4)
  buffer_store_dwordx4 v[120:123], v2, s[4:7], s29 offen offset:2048 sc1
  v_mov_b64 v[98:99], 0
  v_mfma_f32_16x16x32_bf16 v[112:115], v[124:127], v[72:75], v[112:115]
  s_waitcnt lgkmcnt(2)
  v_mov_b64 v[36:37], 0
  v_exp_f32 v100, v16
  v_mfma_f32_16x16x32_bf16 v[112:115], v[104:107], v[76:79], v[112:115]
  s_waitcnt lgkmcnt(0)
  v_exp_f32 v101, v17
  v_mfma_f32_16x16x32_bf16 v[112:115], v[108:111], v[80:83], v[112:115]
  s_add_u32 s29, s29, 131072
  v_exp_f32 v102, v18
  v_mfma_f32_16x16x32_bf16 v[20:23], v[52:55], v[68:71], 0
  s_cmp_eq_u32 s14, 63
  v_exp_f32 v103, v19
  v_mfma_f32_16x16x32_bf16 v[20:23], v[56:59], v[72:75], v[20:23]
  s_cbranch_scc1 M_tdone
  v_cvt_pk_bf16_f32 v44, v100, v101
  v_cvt_pk_bf16_f32 v45, v102, v103
  v_mfma_f32_16x16x32_bf16 v[20:23], v[60:63], v[76:79], v[20:23]
  v_exp_f32 v100, v112
  v_mfma_f32_16x16x32_bf16 v[20:23], v[64:67], v[80:83], v[20:23]
  v_exp_f32 v101, v113
  v_exp_f32 v102, v114
  v_exp_f32 v103, v115
  v_cvt_pk_bf16_f32 v84, v100, v101
  v_cvt_pk_bf16_f32 v85, v102, v103
  v_cndmask_b32 v48, v84, 0, s[16:17]
  v_cndmask_b32 v49, v85, 0, s[16:17]
  v_cndmask_b32 v50, 0, v84, s[16:17]
  v_cndmask_b32 v51, 0, v85, s[16:17]
  v_exp_f32 v100, v20
  v_mfma_f32_16x16x16_bf16 v[88:91], v[12:13], v[48:49], 0
  v_exp_f32 v101, v21
  v_mfma_f32_16x16x16_bf16 v[24:27], v[120:121], v[48:49], 0
  v_exp_f32 v102, v22
  v_mfma_f32_16x16x16_bf16 v[116:119], v[120:121], v[50:51], 0
  v_exp_f32 v103, v23
  v_cvt_pk_bf16_f32 v46, v100, v101
  v_cvt_pk_bf16_f32 v47, v102, v103
  v_mov_b64 v[38:39], 0
  s_nop 0
  v_mfma_f32_16x16x32_bf16 v[88:91], v[12:15], v[44:47], v[88:91]
  v_mov_b64 v[40:41], 0
  v_mov_b64 v[42:43], 0
  v_mfma_f32_16x16x32_bf16 v[24:27], v[28:31], v[44:47], v[24:27]
  ds_read_b128 v[52:55], v4 offset:24576
  ds_read_b128 v[56:59], v4 offset:25600
  v_mfma_f32_16x16x32_bf16 v[116:119], v[32:35], v[44:47], v[116:119]
  s_nop 1
  v_rcp_f32 v89, v88
  v_subrev_u32 v100, s54, v88
  v_cmp_le_u32 vcc, s55, v100
  v_mul_f32 v24, v89, v24
  v_mul_f32 v25, v89, v25
  s_cbranch_vccnz T_slow_116
T_back_117:
  v_cvt_pk_bf16_f32 v124, v24, v25
  v_pk_mul_f32 v[26:27], v[26:27], v[88:89] op_sel:[0,1] op_sel_hi:[1,1]
  v_pk_mul_f32 v[116:117], v[116:117], v[88:89] op_sel:[0,1] op_sel_hi:[1,1]
  v_pk_mul_f32 v[118:119], v[118:119], v[88:89] op_sel:[0,1] op_sel_hi:[1,1]
  v_cvt_pk_bf16_f32 v125, v26, v27
  v_cvt_pk_bf16_f32 v126, v116, v117
  v_cvt_pk_bf16_f32 v127, v118, v119
  ds_write_b128 v11, v[124:127] offset:30208
  s_nop 0
  v_smfmac_f32_16x16x64_bf16 v[92:95], v[124:127], a[160:167], v0
  v_smfmac_f32_16x16x64_bf16 v[96:99], v[124:127], a[168:175], v0
  v_smfmac_f32_16x16x64_bf16 v[36:39], v[124:127], a[176:183], v0
  v_smfmac_f32_16x16x64_bf16 v[40:43], v[124:127], a[184:191], v0
  s_waitcnt lgkmcnt(0)
  s_barrier
  ds_read_b128 v[104:107], v11 offset:30720
  ds_read_b128 v[108:111], v11 offset:29184
  ds_read_b128 v[68:71], v11 offset:29696
  s_waitcnt lgkmcnt(2)
  v_smfmac_f32_16x16x64_bf16 v[92:95], v[104:107], a[192:199], v0
  s_waitcnt lgkmcnt(1)
  ds_read_b128 v[76:79], v4 offset:28672
  v_smfmac_f32_16x16x64_bf16 v[92:95], v[108:111], a[224:231], v0
  s_waitcnt lgkmcnt(1)
  ds_read_b128 v[80:83], v4 offset:29696
  v_smfmac_f32_16x16x64_bf16 v[92:95], v[68:71], a[240:247], v0
  ds_read_b128 v[60:63], v4 offset:26624
  v_smfmac_f32_16x16x64_bf16 v[96:99], v[104:107], a[200:207], v0
  ds_read_b128 v[64:67], v4 offset:27648
  v_smfmac_f32_16x16x64_bf16 v[96:99], v[108:111], a[232:239], v0
  ds_read_b128 v[28:31], v4 offset:30720
  s_nop 0
  v_cvt_pk_bf16_f32 v16, v92, v93
  v_cvt_pk_bf16_f32 v17, v94, v95
  v_bfi_b32 v16, 1, s57, v16
  v_smfmac_f32_16x16x64_bf16 v[96:99], v[68:71], a[248:255], v0
  buffer_store_dwordx2 v[16:17], v7, s[4:7], s20 offen offset:0
  v_smfmac_f32_16x16x64_bf16 v[36:39], v[104:107], a[208:215], v0
  ds_read_b128 v[32:35], v4 offset:31744
  v_smfmac_f32_16x16x64_bf16 v[36:39], v[108:111], v[52:59], v0
  s_waitcnt lgkmcnt(4)
  s_nop 0
  v_cvt_pk_bf16_f32 v18, v96, v97
  v_cvt_pk_bf16_f32 v19, v98, v99
  v_bfi_b32 v18, 1, s57, v18
  v_smfmac_f32_16x16x64_bf16 v[36:39], v[68:71], v[76:83], v0
  buffer_store_dwordx2 v[18:19], v7, s[4:7], s20 offen offset:64
  v_smfmac_f32_16x16x64_bf16 v[40:43], v[104:107], a[216:223], v0
  s_waitcnt lgkmcnt(2)
  v_smfmac_f32_16x16x64_bf16 v[40:43], v[108:111], v[60:67], v0
  s_waitcnt lgkmcnt(0)
  s_nop 0
  v_cvt_pk_bf16_f32 v20, v36, v37
  v_cvt_pk_bf16_f32 v21, v38, v39
  v_bfi_b32 v20, 1, s57, v20
  v_smfmac_f32_16x16x64_bf16 v[40:43], v[68:71], v[28:35], v0
  buffer_store_dwordx2 v[20:21], v7, s[4:7], s21 offen offset:0
  s_nop 6
  v_cvt_pk_bf16_f32 v22, v40, v41
  v_cvt_pk_bf16_f32 v23, v42, v43
  v_bfi_b32 v22, 1, s57, v22
  buffer_store_dwordx2 v[22:23], v7, s[4:7], s21 offen offset:64
  ds_read_b128 v[68:71], v4 offset:0
  ds_read_b128 v[72:75], v4 offset:1024
  ds_read_b128 v[76:79], v4 offset:4096
  ds_read_b128 v[80:83], v4 offset:5120
  ds_read_b128 v[84:87], v4 offset:8192
  ds_read_b128 v[88:91], v4 offset:9216
  ds_read_b128 v[92:95], v4 offset:2048
  ds_read_b128 v[96:99], v4 offset:3072
  ds_read_b128 v[100:103], v4 offset:6144
  ds_read_b128 v[104:107], v4 offset:7168
  ds_read_b128 v[108:111], v4 offset:10240
  ds_read_b128 v[112:115], v4 offset:11264
  v_mov_b64 v[16:17], 0
  v_mov_b64 v[18:19], 0
  v_mov_b64 v[20:21], 0
  v_mov_b64 v[22:23], 0
  v_mov_b64 v[24:25], 0
  v_mov_b64 v[26:27], 0
  ds_read_b64 v[44:45], v2 offset:32256
  s_waitcnt lgkmcnt(0)
  v_readfirstlane_b32 s38, v44
  v_readfirstlane_b32 s37, v45
  s_nop 0
  s_add_u32 s37, s37, 30
  s_cmp_ge_u32 s38, 30
  s_cselect_b32 s38, s37, s38
  s_cmp_ge_u32 s38, 64
  s_cselect_b32 s38, 100, s38
  s_sub_u32 s38, s38, 1
  s_max_i32 s30, s30, s38
  s_waitcnt vmcnt(4)
  s_barrier
  ds_read_b128 v[28:31], v2 offset:18432
  ds_read_b128 v[32:35], v2 offset:22528
  ds_read_b128 v[36:39], v2 offset:8192
  ds_read_b128 v[40:43], v2 offset:9216
  ds_read_b128 v[44:47], v2 offset:10240
  ds_read_b128 v[48:51], v2 offset:11264
  buffer_load_dwordx4 v[124:127], v3, s[4:7], s24 offen offset:2048 sc1
  buffer_load_dwordx4 v[116:119], v3, s[4:7], s25 offen offset:2048 sc1
  ds_read_b128 v[52:55], v2 offset:12288
  ds_read_b128 v[56:59], v2 offset:13312
  ds_read_b128 v[60:63], v2 offset:14336
  ds_read_b128 v[64:67], v2 offset:15360
  buffer_load_dwordx4 v[124:127], v3, s[4:7], s24 offen offset:2048 sc1
  buffer_load_dwordx4 v[116:119], v3, s[4:7], s25 offen offset:2048 sc1
  s_mov_b32 s19, 0
  s_branch T_loop_109
T_kvw_113:
  s_mov_b32 s19, 0
  s_branch T_kvok_122
T_kv_121:
  s_sleep 4
  s_add_u32 s19, s19, 1
  s_cmp_gt_u32 s19, 32768
  s_cbranch_scc1 M_exit
T_kvok_122:
  s_add_u32 s39, s99, 128
  s_mov_b32 s38, 0
  s_mov_b32 s37, 0
  s_atomic_or s38, s[58:59], s99 glc
  s_atomic_or s37, s[58:59], s39 glc
  s_waitcnt lgkmcnt(0)
  s_add_u32 s37, s37, 30
  s_cmp_ge_u32 s38, 30
  s_cselect_b32 s38, s37, s38
  s_cmp_ge_u32 s38, 64
  s_cselect_b32 s38, 100, s38
  s_sub_u32 s38, s38, 1
  s_max_i32 s30, s30, s38
  s_cmp_ge_i32 s14, s30
  s_cbranch_scc1 T_kv_121
  s_branch T_kvb_114
T_slow_116:
  s_nop 7
  v_max3_f32 v100, v16, v17, v18
  v_max3_f32 v100, v100, v19, v20
  v_max3_f32 v100, v100, v21, v22
  v_max3_f32 v100, v100, v23, v112
  v_max3_f32 v100, v100, v113, v114
  v_max_f32 v100, v100, v115
  v_mov_b32 v101, v100
  s_nop 1
  v_permlane32_swap_b32 v100, v101
  s_nop 1
  v_max_f32 v100, v100, v101
  v_mov_b32 v101, v100
  s_nop 1
  v_permlane16_swap_b32 v100, v101
  s_nop 1
  v_max_f32 v100, v100, v101
  v_sub_f32 v16, v16, v100
  v_sub_f32 v17, v17, v100
  v_sub_f32 v18, v18, v100
  v_sub_f32 v19, v19, v100
  v_exp_f32 v16, v16
  v_exp_f32 v17, v17
  v_exp_f32 v18, v18
  v_exp_f32 v19, v19
  v_sub_f32 v20, v20, v100
  v_sub_f32 v21, v21, v100
  v_sub_f32 v22, v22, v100
  v_sub_f32 v23, v23, v100
  v_exp_f32 v20, v20
  v_exp_f32 v21, v21
  v_exp_f32 v22, v22
  v_exp_f32 v23, v23
  v_sub_f32 v112, v112, v100
  v_sub_f32 v113, v113, v100
  v_sub_f32 v114, v114, v100
  v_sub_f32 v115, v115, v100
  v_exp_f32 v112, v112
  v_exp_f32 v113, v113
  v_exp_f32 v114, v114
  v_exp_f32 v115, v115
  s_nop 0
  v_cvt_pk_bf16_f32 v44, v16, v17
  v_cvt_pk_bf16_f32 v45, v18, v19
  v_cvt_pk_bf16_f32 v46, v20, v21
  v_cvt_pk_bf16_f32 v47, v22, v23
  v_cvt_pk_bf16_f32 v84, v112, v113
  v_cvt_pk_bf16_f32 v85, v114, v115
  v_cndmask_b32 v48, v84, 0, s[16:17]
  v_cndmask_b32 v49, v85, 0, s[16:17]
  v_cndmask_b32 v50, 0, v84, s[16:17]
  v_cndmask_b32 v51, 0, v85, s[16:17]
  s_nop 1
  v_mfma_f32_16x16x16_bf16 v[88:91], v[12:13], v[48:49], 0
  v_mfma_f32_16x16x16_bf16 v[24:27], v[120:121], v[48:49], 0
  v_mfma_f32_16x16x16_bf16 v[116:119], v[120:121], v[50:51], 0
  v_mfma_f32_16x16x32_bf16 v[88:91], v[12:15], v[44:47], v[88:91]
  v_mfma_f32_16x16x32_bf16 v[24:27], v[28:31], v[44:47], v[24:27]
  v_mfma_f32_16x16x32_bf16 v[116:119], v[32:35], v[44:47], v[116:119]
  s_nop 7
  s_nop 1
  v_rcp_f32 v89, v88
  s_nop 0
  v_mul_f32 v24, v89, v24
  v_mul_f32 v25, v89, v25
  s_branch T_back_117
T_w_80:
  s_mov_b32 s19, 0
  v_mov_b64 v[16:17], 0
  v_mov_b64 v[18:19], 0
  v_mov_b64 v[20:21], 0
  v_mov_b64 v[22:23], 0
  v_mov_b64 v[24:25], 0
  v_mov_b64 v[26:27], 0
  buffer_load_dwordx4 v[124:127], v3, s[4:7], s24 offen offset:3072 sc1
  buffer_load_dwordx4 v[116:119], v3, s[4:7], s25 offen offset:3072 sc1
  buffer_load_dwordx4 v[124:127], v3, s[4:7], s24 offen offset:3072 sc1
  buffer_load_dwordx4 v[116:119], v3, s[4:7], s25 offen offset:3072 sc1
  s_branch T_loop_123
.p2align 6
T_retry_124:
  s_mov_b64 exec, vcc
  buffer_load_dwordx4 v[124:127], v3, s[4:7], s24 offen offset:3072 sc1
  buffer_load_dwordx4 v[116:119], v3, s[4:7], s25 offen offset:3072 sc1
  s_mov_b64 exec, -1
  s_add_u32 s19, s19, 1
  s_cmp_gt_u32 s19, 32768
  s_cbranch_scc1 M_exit
T_loop_123:
  s_waitcnt vmcnt(3) lgkmcnt(0)
  v_max3_u32 v123, v124, v125, v126
  v_max_u32 v123, v123, v127
  v_mov_b32_dpp v120, v124 row_ror:8 row_mask:0xf bank_mask:0xf
  v_mov_b32_dpp v121, v125 row_ror:8 row_mask:0xf bank_mask:0xf
  s_waitcnt vmcnt(2)
  v_max3_u32 v123, v123, v116, v117
  v_max3_u32 v123, v123, v118, v119
  v_cmp_eq_u32 vcc, -1, v123
  s_cbranch_vccnz T_retry_124
  v_smfmac_f32_16x16x64_bf16 v[16:19], v[124:127], v[68:75], v0
  s_add_u32 s14, s14, 1
  ds_write_b128 v2, v[124:127] offset:3072
  v_mov_b32_dpp v122, v126 row_ror:8 row_mask:0xf bank_mask:0xf
  v_smfmac_f32_16x16x64_bf16 v[20:23], v[124:127], v[76:83], v0
  s_and_b32 s57, s14, 1
  v_mov_b32_dpp v123, v127 row_ror:8 row_mask:0xf bank_mask:0xf
  v_smfmac_f32_16x16x64_bf16 v[24:27], v[124:127], v[84:91], v0
  s_and_b32 s36, s14, 3
  ds_write_b128 v2, v[116:119] offset:7168
  v_smfmac_f32_16x16x64_bf16 v[16:19], v[120:123], v[92:99], v0
  s_lshl_b32 s36, s36, 13
  v_mov_b32_dpp v84, v116 row_ror:8 row_mask:0xf bank_mask:0xf
  v_smfmac_f32_16x16x64_bf16 v[20:23], v[120:123], v[100:107], v0
  s_add_u32 s26, s36, s23
  ds_read_b128 v[68:71], v4 offset:12288
  v_mov_b32_dpp v85, v117 row_ror:8 row_mask:0xf bank_mask:0xf
  v_smfmac_f32_16x16x64_bf16 v[24:27], v[120:123], v[108:115], v0
  s_add_u32 s36, s36, 8192
  ds_read_b128 v[72:75], v4 offset:13312
  v_mov_b32_dpp v86, v118 row_ror:8 row_mask:0xf bank_mask:0xf
  v_smfmac_f32_16x16x64_bf16 v[16:19], v[116:119], v[224:231], v0
  s_and_b32 s36, s36, 0x7fff
  ds_read_b128 v[76:79], v4 offset:14336
  v_mov_b32_dpp v87, v119 row_ror:8 row_mask:0xf bank_mask:0xf
  v_smfmac_f32_16x16x64_bf16 v[20:23], v[116:119], v[240:247], v0
  s_waitcnt lgkmcnt(3)
  s_barrier
  ds_read_b128 v[100:103], v2 offset:2048
  v_smfmac_f32_16x16x64_bf16 v[24:27], v[116:119], a[0:7], v0
  s_mov_b32 m0, s31
  ds_read_b128 v[120:123], v1 offset:2048
  v_smfmac_f32_16x16x64_bf16 v[16:19], v[84:87], v[232:239], v0
  s_cmp_ge_i32 s14, s30
  s_cbranch_scc1 T_kvw_127
T_kvb_128:
  v_smfmac_f32_16x16x64_bf16 v[20:23], v[84:87], v[248:255], v0
  ds_read_b128 v[80:83], v4 offset:15360
  v_smfmac_f32_16x16x64_bf16 v[24:27], v[84:87], a[8:15], v0
  s_waitcnt lgkmcnt(2)
  v_smfmac_f32_16x16x64_bf16 v[16:19], v[100:103], v[128:135], v0
  ds_read_b128 v[92:95], v2 offset:1024
  v_smfmac_f32_16x16x64_bf16 v[20:23], v[100:103], v[144:151], v0
  ds_read_b128 v[96:99], v1 offset:1024
  buffer_load_dwordx4 v9, s[4:7], s27 offen sc1 lds
  v_smfmac_f32_16x16x64_bf16 v[24:27], v[100:103], v[68:75], v0
  s_waitcnt vmcnt(1) lgkmcnt(3)
  ds_read_b128 v[116:119], v2 offset:0
  s_mov_b32 m0, s32
  v_smfmac_f32_16x16x64_bf16 v[16:19], v[120:123], v[136:143], v0
  ds_read_b128 v[124:127], v1 offset:0
  v_smfmac_f32_16x16x64_bf16 v[20:23], v[120:123], v[152:159], v0
  s_waitcnt lgkmcnt(4)
  ds_read_b128 v[104:107], v2 offset:6144
  v_smfmac_f32_16x16x64_bf16 v[24:27], v[120:123], v[76:83], v0
  s_waitcnt lgkmcnt(4)
  ds_read_b128 v[108:111], v1 offset:6144
  buffer_load_dwordx4 v9, s[4:7], s27 offen offset:128 sc1 lds
  v_smfmac_f32_16x16x64_bf16 v[16:19], v[92:95], v[160:167], v0
  s_waitcnt lgkmcnt(4)
  ds_read_b128 v[112:115], v2 offset:5120
  s_mov_b32 m0, s33
  v_smfmac_f32_16x16x64_bf16 v[16:19], v[96:99], v[168:175], v0
  s_waitcnt lgkmcnt(4)
  ds_read_b128 v[84:87], v1 offset:5120
  v_smfmac_f32_16x16x64_bf16 v[16:19], v[116:119], v[192:199], v0
  s_waitcnt lgkmcnt(4)
  ds_read_b128 v[88:91], v2 offset:4096
  v_smfmac_f32_16x16x64_bf16 v[16:19], v[124:127], v[200:207], v0
  s_waitcnt lgkmcnt(4)
  ds_read_b128 v[100:103], v1 offset:4096
  buffer_load_dwordx4 v10, s[4:7], s28 offen sc1 lds
  v_smfmac_f32_16x16x64_bf16 v[16:19], v[104:107], a[16:23], v0
  s_waitcnt lgkmcnt(4)
  ds_read_b128 v[68:71], v4 offset:16384
  s_mov_b32 m0, s34
  v_smfmac_f32_16x16x64_bf16 v[16:19], v[108:111], a[24:31], v0
  s_waitcnt lgkmcnt(4)
  ds_read_b128 v[72:75], v4 offset:17408
  v_smfmac_f32_16x16x64_bf16 v[16:19], v[112:115], a[64:71], v0
  s_waitcnt lgkmcnt(4)
  ds_read_b128 v[76:79], v4 offset:18432
  v_smfmac_f32_16x16x64_bf16 v[16:19], v[84:87], a[72:79], v0
  s_waitcnt lgkmcnt(4)
  ds_read_b128 v[80:83], v4 offset:19456
  buffer_load_dwordx4 v10, s[4:7], s28 offen offset:256 sc1 lds
  v_smfmac_f32_16x16x64_bf16 v[16:19], v[88:91], a[112:119], v0
  s_waitcnt lgkmcnt(4)
  s_mov_b32 m0, 32256
  v_smfmac_f32_16x16x64_bf16 v[16:19], v[100:103], a[120:127], v0
  s_add_u32 s24, s36, 145752064
  s_add_u32 s25, s36, 145756160
  v_smfmac_f32_16x16x64_bf16 v[20:23], v[92:95], v[176:183], v0
  s_add_u32 s35, s36, s23
  v_smfmac_f32_16x16x64_bf16 v[20:23], v[96:99], v[184:191], v0
  s_waitcnt lgkmcnt(2)
  buffer_load_dword v8, s[4:7], s99 offen sc1 lds
  v_smfmac_f32_16x16x64_bf16 v[20:23], v[116:119], v[68:75], v0
  s_waitcnt lgkmcnt(0)
  ds_read_b128 v[68:71], v4 offset:20480
  v_mul_f32 v16, s18, v16
  v_smfmac_f32_16x16x64_bf16 v[20:23], v[124:127], v[76:83], v0
  ds_read_b128 v[72:75], v4 offset:21504
  v_mul_f32 v17, s18, v17
  v_smfmac_f32_16x16x64_bf16 v[20:23], v[104:107], a[32:39], v0
  ds_read_b128 v[76:79], v4 offset:22528
  v_mul_f32 v18, s18, v18
  v_smfmac_f32_16x16x64_bf16 v[20:23], v[108:111], a[40:47], v0
  ds_read_b128 v[80:83], v4 offset:23552
  v_mul_f32 v19, s18, v19
  v_smfmac_f32_16x16x64_bf16 v[20:23], v[112:115], a[80:87], v0
  v_cvt_pk_bf16_f32 v120, v16, v17
  v_smfmac_f32_16x16x64_bf16 v[20:23], v[84:87], a[88:95], v0
  v_cvt_pk_bf16_f32 v121, v18, v19
  v_smfmac_f32_16x16x64_bf16 v[20:23], v[88:91], a[128:135], v0
  ds_write_b64 v5, v[120:121] offset:24576
  v_smfmac_f32_16x16x64_bf16 v[20:23], v[100:103], a[136:143], v0
  s_waitcnt lgkmcnt(3)
  v_smfmac_f32_16x16x64_bf16 v[24:27], v[92:95], v[68:75], v0
  s_waitcnt lgkmcnt(1)
  v_mov_b64 v[92:93], 0
  v_smfmac_f32_16x16x64_bf16 v[24:27], v[96:99], v[76:83], v0
  s_nop 1
  v_cvt_pk_bf16_f32 v122, v20, v21
  v_cvt_pk_bf16_f32 v123, v22, v23
  v_smfmac_f32_16x16x64_bf16 v[24:27], v[116:119], v[208:215], v0
  ds_write_b64 v5, v[122:123] offset:26880
  v_mov_b64 v[94:95], 0
  v_smfmac_f32_16x16x64_bf16 v[24:27], v[124:127], v[216:223], v0
  s_waitcnt lgkmcnt(1)
  s_barrier
  ds_read_b64_tr_b16 v[68:69], v6 offset:24576
  v_smfmac_f32_16x16x64_bf16 v[24:27], v[104:107], a[48:55], v0
  s_add_u32 s27, s27, 8192
  ds_read_b64_tr_b16 v[70:71], v6 offset:24640
  ds_read_b64_tr_b16 v[72:73], v6 offset:24832
  v_smfmac_f32_16x16x64_bf16 v[24:27], v[108:111], a[56:63], v0
  s_add_u32 s28, s28, 8192
  ds_read_b64_tr_b16 v[74:75], v6 offset:24896
  ds_read_b64_tr_b16 v[76:77], v6 offset:25088
  v_smfmac_f32_16x16x64_bf16 v[24:27], v[112:115], a[96:103], v0
  s_nop 0
  ds_read_b64_tr_b16 v[78:79], v6 offset:25152
  ds_read_b64_tr_b16 v[80:81], v6 offset:25344
  v_smfmac_f32_16x16x64_bf16 v[24:27], v[84:87], a[104:111], v0
  ds_read_b64_tr_b16 v[82:83], v6 offset:25408
  v_mov_b64 v[96:97], 0
  v_smfmac_f32_16x16x64_bf16 v[24:27], v[88:91], a[144:151], v0
  s_waitcnt lgkmcnt(8)
  s_barrier
  ds_read_b64_tr_b16 v[116:117], v6 offset:26880
  v_smfmac_f32_16x16x64_bf16 v[24:27], v[100:103], a[152:159], v0
  s_waitcnt lgkmcnt(7)
  ds_read_b64_tr_b16 v[118:119], v6 offset:26944
  v_mfma_f32_16x16x32_bf16 v[16:19], v[36:39], v[68:71], 0
  s_waitcnt lgkmcnt(6)
  ds_read_b64_tr_b16 v[124:125], v6 offset:27136
  ds_read_b64_tr_b16 v[126:127], v6 offset:27200
  v_mfma_f32_16x16x32_bf16 v[16:19], v[40:43], v[72:75], v[16:19]
  s_waitcnt lgkmcnt(6)
  ds_read_b64_tr_b16 v[104:105], v6 offset:27392
  ds_read_b64_tr_b16 v[106:107], v6 offset:27456
  v_mfma_f32_16x16x32_bf16 v[16:19], v[44:47], v[76:79], v[16:19]
  s_waitcnt lgkmcnt(6)
  ds_read_b64_tr_b16 v[108:109], v6 offset:27648
  ds_read_b64_tr_b16 v[110:111], v6 offset:27712
  v_mfma_f32_16x16x32_bf16 v[16:19], v[48:51], v[80:83], v[16:19]
  s_waitcnt lgkmcnt(6)
  v_cvt_pk_bf16_f32 v120, v24, v25
  v_cvt_pk_bf16_f32 v121, v26, v27
  v_mfma_f32_16x16x32_bf16 v[112:115], v[116:119], v[68:71], 0
  s_waitcnt lgkmcnt(4)
  buffer_store_dwordx4 v[120:123], v2, s[4:7], s29 offen offset:3072 sc1
  v_mov_b64 v[98:99], 0
  v_mfma_f32_16x16x32_bf16 v[112:115], v[124:127], v[72:75], v[112:115]
  s_waitcnt lgkmcnt(2)
  v_mov_b64 v[36:37], 0
  v_exp_f32 v100, v16
  v_mfma_f32_16x16x32_bf16 v[112:115], v[104:107], v[76:79], v[112:115]
  s_waitcnt lgkmcnt(0)
  v_exp_f32 v101, v17
  v_mfma_f32_16x16x32_bf16 v[112:115], v[108:111], v[80:83], v[112:115]
  s_add_u32 s29, s29, 131072
  v_exp_f32 v102, v18
  v_mfma_f32_16x16x32_bf16 v[20:23], v[52:55], v[68:71], 0
  s_cmp_eq_u32 s14, 63
  v_exp_f32 v103, v19
  v_mfma_f32_16x16x32_bf16 v[20:23], v[56:59], v[72:75], v[20:23]
  s_cbranch_scc1 M_tdone
  v_cvt_pk_bf16_f32 v44, v100, v101
  v_cvt_pk_bf16_f32 v45, v102, v103
  v_mfma_f32_16x16x32_bf16 v[20:23], v[60:63], v[76:79], v[20:23]
  v_exp_f32 v100, v112
  v_mfma_f32_16x16x32_bf16 v[20:23], v[64:67], v[80:83], v[20:23]
  v_exp_f32 v101, v113
  v_exp_f32 v102, v114
  v_exp_f32 v103, v115
  v_cvt_pk_bf16_f32 v84, v100, v101
  v_cvt_pk_bf16_f32 v85, v102, v103
  v_cndmask_b32 v48, v84, 0, s[16:17]
  v_cndmask_b32 v49, v85, 0, s[16:17]
  v_cndmask_b32 v50, 0, v84, s[16:17]
  v_cndmask_b32 v51, 0, v85, s[16:17]
  v_exp_f32 v100, v20
  v_mfma_f32_16x16x16_bf16 v[88:91], v[12:13], v[48:49], 0
  v_exp_f32 v101, v21
  v_mfma_f32_16x16x16_bf16 v[24:27], v[120:121], v[48:49], 0
  v_exp_f32 v102, v22
  v_mfma_f32_16x16x16_bf16 v[116:119], v[120:121], v[50:51], 0
  v_exp_f32 v103, v23
  v_cvt_pk_bf16_f32 v46, v100, v101
  v_cvt_pk_bf16_f32 v47, v102, v103
  v_mov_b64 v[38:39], 0
  s_nop 0
  v_mfma_f32_16x16x32_bf16 v[88:91], v[12:15], v[44:47], v[88:91]
  v_mov_b64 v[40:41], 0
  v_mov_b64 v[42:43], 0
  v_mfma_f32_16x16x32_bf16 v[24:27], v[28:31], v[44:47], v[24:27]
  ds_read_b128 v[52:55], v4 offset:24576
  ds_read_b128 v[56:59], v4 offset:25600
  v_mfma_f32_16x16x32_bf16 v[116:119], v[32:35], v[44:47], v[116:119]
  s_nop 1
  v_rcp_f32 v89, v88
  v_subrev_u32 v100, s54, v88
  v_cmp_le_u32 vcc, s55, v100
  v_mul_f32 v24, v89, v24
  v_mul_f32 v25, v89, v25
  s_cbranch_vccnz T_slow_130
T_back_131:
  v_cvt_pk_bf16_f32 v124, v24, v25
  v_pk_mul_f32 v[26:27], v[26:27], v[88:89] op_sel:[0,1] op_sel_hi:[1,1]
  v_pk_mul_f32 v[116:117], v[116:117], v[88:89] op_sel:[0,1] op_sel_hi:[1,1]
  v_pk_mul_f32 v[118:119], v[118:119], v[88:89] op_sel:[0,1] op_sel_hi:[1,1]
  v_cvt_pk_bf16_f32 v125, v26, v27
  v_cvt_pk_bf16_f32 v126, v116, v117
  v_cvt_pk_bf16_f32 v127, v118, v119
  ds_write_b128 v11, v[124:127] offset:30720
  s_nop 0
  v_smfmac_f32_16x16x64_bf16 v[92:95], v[124:127], a[160:167], v0
  v_smfmac_f32_16x16x64_bf16 v[96:99], v[124:127], a[168:175], v0
  v_smfmac_f32_16x16x64_bf16 v[36:39], v[124:127], a[176:183], v0
  v_smfmac_f32_16x16x64_bf16 v[40:43], v[124:127], a[184:191], v0
  s_waitcnt lgkmcnt(0)
  s_barrier
  ds_read_b128 v[104:107], v11 offset:30208
  ds_read_b128 v[108:111], v11 offset:29696
  ds_read_b128 v[68:71], v11 offset:29184
  s_waitcnt lgkmcnt(2)
  v_smfmac_f32_16x16x64_bf16 v[92:95], v[104:107], a[192:199], v0
  s_waitcnt lgkmcnt(1)
  ds_read_b128 v[76:79], v4 offset:28672
  v_smfmac_f32_16x16x64_bf16 v[92:95], v[108:111], a[224:231], v0
  s_waitcnt lgkmcnt(1)
  ds_read_b128 v[80:83], v4 offset:29696
  v_smfmac_f32_16x16x64_bf16 v[92:95], v[68:71], a[240:247], v0
  ds_read_b128 v[60:63], v4 offset:26624
  v_smfmac_f32_16x16x64_bf16 v[96:99], v[104:107], a[200:207], v0
  ds_read_b128 v[64:67], v4 offset:27648
  v_smfmac_f32_16x16x64_bf16 v[96:99], v[108:111], a[232:239], v0
  ds_read_b128 v[28:31], v4 offset:30720
  s_nop 0
  v_cvt_pk_bf16_f32 v16, v92, v93
  v_cvt_pk_bf16_f32 v17, v94, v95
  v_bfi_b32 v16, 1, s57, v16
  v_smfmac_f32_16x16x64_bf16 v[96:99], v[68:71], a[248:255], v0
  buffer_store_dwordx2 v[16:17], v7, s[4:7], s20 offen offset:0
  v_smfmac_f32_16x16x64_bf16 v[36:39], v[104:107], a[208:215], v0
  ds_read_b128 v[32:35], v4 offset:31744
  v_smfmac_f32_16x16x64_bf16 v[36:39], v[108:111], v[52:59], v0
  s_waitcnt lgkmcnt(4)
  s_nop 0
  v_cvt_pk_bf16_f32 v18, v96, v97
  v_cvt_pk_bf16_f32 v19, v98, v99
  v_bfi_b32 v18, 1, s57, v18
  v_smfmac_f32_16x16x64_bf16 v[36:39], v[68:71], v[76:83], v0
  buffer_store_dwordx2 v[18:19], v7, s[4:7], s20 offen offset:64
  v_smfmac_f32_16x16x64_bf16 v[40:43], v[104:107], a[216:223], v0
  s_waitcnt lgkmcnt(2)
  v_smfmac_f32_16x16x64_bf16 v[40:43], v[108:111], v[60:67], v0
  s_waitcnt lgkmcnt(0)
  s_nop 0
  v_cvt_pk_bf16_f32 v20, v36, v37
  v_cvt_pk_bf16_f32 v21, v38, v39
  v_bfi_b32 v20, 1, s57, v20
  v_smfmac_f32_16x16x64_bf16 v[40:43], v[68:71], v[28:35], v0
  buffer_store_dwordx2 v[20:21], v7, s[4:7], s21 offen offset:0
  s_nop 6
  v_cvt_pk_bf16_f32 v22, v40, v41
  v_cvt_pk_bf16_f32 v23, v42, v43
  v_bfi_b32 v22, 1, s57, v22
  buffer_store_dwordx2 v[22:23], v7, s[4:7], s21 offen offset:64
  ds_read_b128 v[68:71], v4 offset:0
  ds_read_b128 v[72:75], v4 offset:1024
  ds_read_b128 v[76:79], v4 offset:4096
  ds_read_b128 v[80:83], v4 offset:5120
  ds_read_b128 v[84:87], v4 offset:8192
  ds_read_b128 v[88:91], v4 offset:9216
  ds_read_b128 v[92:95], v4 offset:2048
  ds_read_b128 v[96:99], v4 offset:3072
  ds_read_b128 v[100:103], v4 offset:6144
  ds_read_b128 v[104:107], v4 offset:7168
  ds_read_b128 v[108:111], v4 offset:10240
  ds_read_b128 v[112:115], v4 offset:11264
  v_mov_b64 v[16:17], 0
  v_mov_b64 v[18:19], 0
  v_mov_b64 v[20:21], 0
  v_mov_b64 v[22:23], 0
  v_mov_b64 v[24:25], 0
  v_mov_b64 v[26:27], 0
  ds_read_b64 v[44:45], v2 offset:32256
  s_waitcnt lgkmcnt(0)
  v_readfirstlane_b32 s38, v44
  v_readfirstlane_b32 s37, v45
  s_nop 0
  s_add_u32 s37, s37, 30
  s_cmp_ge_u32 s38, 30
  s_cselect_b32 s38, s37, s38
  s_cmp_ge_u32 s38, 64
  s_cselect_b32 s38, 100, s38
  s_sub_u32 s38, s38, 1
  s_max_i32 s30, s30, s38
  s_waitcnt vmcnt(4)
  s_barrier
  ds_read_b128 v[28:31], v2 offset:19456
  ds_read_b128 v[32:35], v2 offset:23552
  ds_read_b128 v[36:39], v2 offset:8192
  ds_read_b128 v[40:43], v2 offset:9216
  ds_read_b128 v[44:47], v2 offset:10240
  ds_read_b128 v[48:51], v2 offset:11264
  buffer_load_dwordx4 v[124:127], v3, s[4:7], s24 offen offset:3072 sc1
  buffer_load_dwordx4 v[116:119], v3, s[4:7], s25 offen offset:3072 sc1
  ds_read_b128 v[52:55], v2 offset:12288
  ds_read_b128 v[56:59], v2 offset:13312
  ds_read_b128 v[60:63], v2 offset:14336
  ds_read_b128 v[64:67], v2 offset:15360
  buffer_load_dwordx4 v[124:127], v3, s[4:7], s24 offen offset:3072 sc1
  buffer_load_dwordx4 v[116:119], v3, s[4:7], s25 offen offset:3072 sc1
  s_mov_b32 s19, 0
  s_branch T_loop_123
T_kvw_127:
  s_mov_b32 s19, 0
  s_branch T_kvok_136
T_kv_135:
  s_sleep 4
  s_add_u32 s19, s19, 1
  s_cmp_gt_u32 s19, 32768
  s_cbranch_scc1 M_exit
T_kvok_136:
  s_add_u32 s39, s99, 128
  s_mov_b32 s38, 0
  s_mov_b32 s37, 0
  s_atomic_or s38, s[58:59], s99 glc
  s_atomic_or s37, s[58:59], s39 glc
  s_waitcnt lgkmcnt(0)
  s_add_u32 s37, s37, 30
  s_cmp_ge_u32 s38, 30
  s_cselect_b32 s38, s37, s38
  s_cmp_ge_u32 s38, 64
  s_cselect_b32 s38, 100, s38
  s_sub_u32 s38, s38, 1
  s_max_i32 s30, s30, s38
  s_cmp_ge_i32 s14, s30
  s_cbranch_scc1 T_kv_135
  s_branch T_kvb_128
T_slow_130:
  s_nop 7
  v_max3_f32 v100, v16, v17, v18
  v_max3_f32 v100, v100, v19, v20
  v_max3_f32 v100, v100, v21, v22
  v_max3_f32 v100, v100, v23, v112
  v_max3_f32 v100, v100, v113, v114
  v_max_f32 v100, v100, v115
  v_mov_b32 v101, v100
  s_nop 1
  v_permlane32_swap_b32 v100, v101
  s_nop 1
  v_max_f32 v100, v100, v101
  v_mov_b32 v101, v100
  s_nop 1
  v_permlane16_swap_b32 v100, v101
  s_nop 1
  v_max_f32 v100, v100, v101
  v_sub_f32 v16, v16, v100
  v_sub_f32 v17, v17, v100
  v_sub_f32 v18, v18, v100
  v_sub_f32 v19, v19, v100
  v_exp_f32 v16, v16
  v_exp_f32 v17, v17
  v_exp_f32 v18, v18
  v_exp_f32 v19, v19
  v_sub_f32 v20, v20, v100
  v_sub_f32 v21, v21, v100
  v_sub_f32 v22, v22, v100
  v_sub_f32 v23, v23, v100
  v_exp_f32 v20, v20
  v_exp_f32 v21, v21
  v_exp_f32 v22, v22
  v_exp_f32 v23, v23
  v_sub_f32 v112, v112, v100
  v_sub_f32 v113, v113, v100
  v_sub_f32 v114, v114, v100
  v_sub_f32 v115, v115, v100
  v_exp_f32 v112, v112
  v_exp_f32 v113, v113
  v_exp_f32 v114, v114
  v_exp_f32 v115, v115
  s_nop 0
  v_cvt_pk_bf16_f32 v44, v16, v17
  v_cvt_pk_bf16_f32 v45, v18, v19
  v_cvt_pk_bf16_f32 v46, v20, v21
  v_cvt_pk_bf16_f32 v47, v22, v23
  v_cvt_pk_bf16_f32 v84, v112, v113
  v_cvt_pk_bf16_f32 v85, v114, v115
  v_cndmask_b32 v48, v84, 0, s[16:17]
  v_cndmask_b32 v49, v85, 0, s[16:17]
  v_cndmask_b32 v50, 0, v84, s[16:17]
  v_cndmask_b32 v51, 0, v85, s[16:17]
  s_nop 1
  v_mfma_f32_16x16x16_bf16 v[88:91], v[12:13], v[48:49], 0
  v_mfma_f32_16x16x16_bf16 v[24:27], v[120:121], v[48:49], 0
  v_mfma_f32_16x16x16_bf16 v[116:119], v[120:121], v[50:51], 0
  v_mfma_f32_16x16x32_bf16 v[88:91], v[12:15], v[44:47], v[88:91]
  v_mfma_f32_16x16x32_bf16 v[24:27], v[28:31], v[44:47], v[24:27]
  v_mfma_f32_16x16x32_bf16 v[116:119], v[32:35], v[44:47], v[116:119]
  s_nop 7
  s_nop 1
  v_rcp_f32 v89, v88
  s_nop 0
  v_mul_f32 v24, v89, v24
  v_mul_f32 v25, v89, v25
  s_branch T_back_131
M_global:
  s_cmp_eq_u32 s13, 1
  s_cbranch_scc1 T_w_138
  s_cmp_eq_u32 s13, 2
  s_cbranch_scc1 T_w_139
  s_cmp_eq_u32 s13, 3
  s_cbranch_scc1 T_w_140
T_w_137:
  s_mov_b32 s19, 0
  v_mov_b64 v[16:17], 0
  v_mov_b64 v[18:19], 0
  v_mov_b64 v[20:21], 0
  v_mov_b64 v[22:23], 0
  v_mov_b64 v[24:25], 0
  v_mov_b64 v[26:27], 0
  buffer_load_dwordx4 v[124:127], v3, s[4:7], s24 offen offset:0 sc1
  buffer_load_dwordx4 v[116:119], v3, s[4:7], s25 offen offset:0 sc1
  buffer_load_dwordx4 v[124:127], v3, s[4:7], s24 offen offset:0 sc1
  buffer_load_dwordx4 v[116:119], v3, s[4:7], s25 offen offset:0 sc1
  s_branch T_loop_141
.p2align 6
T_retry_142:
  s_mov_b64 exec, vcc
  buffer_load_dwordx4 v[124:127], v3, s[4:7], s24 offen offset:0 sc1
  buffer_load_dwordx4 v[116:119], v3, s[4:7], s25 offen offset:0 sc1
  s_mov_b64 exec, -1
  s_add_u32 s19, s19, 1
  s_cmp_gt_u32 s19, 32768
  s_cbranch_scc1 M_exit
T_loop_141:
  s_waitcnt vmcnt(3) lgkmcnt(0)
  v_max3_u32 v123, v124, v125, v126
  v_max_u32 v123, v123, v127
  v_mov_b32_dpp v120, v124 row_ror:8 row_mask:0xf bank_mask:0xf
  v_mov_b32_dpp v121, v125 row_ror:8 row_mask:0xf bank_mask:0xf
  s_waitcnt vmcnt(2)
  v_max3_u32 v123, v123, v116, v117
  v_max3_u32 v123, v123, v118, v119
  v_cmp_eq_u32 vcc, -1, v123
  s_cbranch_vccnz T_retry_142
  v_smfmac_f32_16x16x64_bf16 v[16:19], v[124:127], v[68:75], v0
  s_add_u32 s14, s14, 1
  ds_write_b128 v2, v[124:127] offset:0
  v_mov_b32_dpp v122, v126 row_ror:8 row_mask:0xf bank_mask:0xf
  v_smfmac_f32_16x16x64_bf16 v[20:23], v[124:127], v[76:83], v0
  s_and_b32 s57, s14, 1
  v_mov_b32_dpp v123, v127 row_ror:8 row_mask:0xf bank_mask:0xf
  v_smfmac_f32_16x16x64_bf16 v[24:27], v[124:127], v[84:91], v0
  s_and_b32 s36, s14, 3
  ds_write_b128 v2, v[116:119] offset:4096
  v_smfmac_f32_16x16x64_bf16 v[16:19], v[120:123], v[92:99], v0
  s_lshl_b32 s36, s36, 13
  v_mov_b32_dpp v84, v116 row_ror:8 row_mask:0xf bank_mask:0xf
  v_smfmac_f32_16x16x64_bf16 v[20:23], v[120:123], v[100:107], v0
  s_add_u32 s26, s36, s23
  ds_read_b128 v[68:71], v4 offset:12288
  v_mov_b32_dpp v85, v117 row_ror:8 row_mask:0xf bank_mask:0xf
  v_smfmac_f32_16x16x64_bf16 v[24:27], v[120:123], v[108:115], v0
  s_add_u32 s36, s36, 8192
  ds_read_b128 v[72:75], v4 offset:13312
  v_mov_b32_dpp v86, v118 row_ror:8 row_mask:0xf bank_mask:0xf
  v_smfmac_f32_16x16x64_bf16 v[16:19], v[116:119], v[224:231], v0
  s_and_b32 s36, s36, 0x7fff
  ds_read_b128 v[76:79], v4 offset:14336
  v_mov_b32_dpp v87, v119 row_ror:8 row_mask:0xf bank_mask:0xf
  v_smfmac_f32_16x16x64_bf16 v[20:23], v[116:119], v[240:247], v0
  s_waitcnt lgkmcnt(3)
  s_barrier
  ds_read_b128 v[100:103], v2 offset:1024
  v_smfmac_f32_16x16x64_bf16 v[24:27], v[116:119], a[0:7], v0
  s_mov_b32 m0, s31
  ds_read_b128 v[120:123], v1 offset:1024
  v_smfmac_f32_16x16x64_bf16 v[16:19], v[84:87], v[232:239], v0
  s_cmp_ge_i32 s14, s30
  s_cbranch_scc1 T_kvw_145
T_kvb_146:
  v_smfmac_f32_16x16x64_bf16 v[20:23], v[84:87], v[248:255], v0
  ds_read_b128 v[80:83], v4 offset:15360
  buffer_load_dwordx4 v9, s[4:7], s27 offen sc1 lds
  v_smfmac_f32_16x16x64_bf16 v[24:27], v[84:87], a[8:15], v0
  s_waitcnt lgkmcnt(2)
  s_mov_b32 m0, s32
  v_smfmac_f32_16x16x64_bf16 v[16:19], v[100:103], v[128:135], v0
  ds_read_b128 v[92:95], v2 offset:2048
  v_smfmac_f32_16x16x64_bf16 v[20:23], v[100:103], v[144:151], v0
  ds_read_b128 v[96:99], v1 offset:2048
  v_smfmac_f32_16x16x64_bf16 v[24:27], v[100:103], v[68:75], v0
  s_waitcnt vmcnt(1) lgkmcnt(3)
  ds_read_b128 v[116:119], v2 offset:3072
  buffer_load_dwordx4 v9, s[4:7], s27 offen offset:128 sc1 lds
  v_smfmac_f32_16x16x64_bf16 v[16:19], v[120:123], v[136:143], v0
  ds_read_b128 v[124:127], v1 offset:3072
  s_mov_b32 m0, s33
  v_smfmac_f32_16x16x64_bf16 v[20:23], v[120:123], v[152:159], v0
  s_waitcnt lgkmcnt(4)
  ds_read_b128 v[104:107], v2 offset:5120
  v_smfmac_f32_16x16x64_bf16 v[24:27], v[120:123], v[76:83], v0
  s_waitcnt lgkmcnt(4)
  ds_read_b128 v[108:111], v1 offset:5120
  v_smfmac_f32_16x16x64_bf16 v[16:19], v[92:95], v[160:167], v0
  s_waitcnt lgkmcnt(4)
  ds_read_b128 v[112:115], v2 offset:6144
  buffer_load_dwordx4 v10, s[4:7], s28 offen sc1 lds
  v_smfmac_f32_16x16x64_bf16 v[16:19], v[96:99], v[168:175], v0
  s_waitcnt lgkmcnt(4)
  ds_read_b128 v[84:87], v1 offset:6144
  s_mov_b32 m0, s34
  v_smfmac_f32_16x16x64_bf16 v[16:19], v[116:119], v[192:199], v0
  s_waitcnt lgkmcnt(4)
  ds_read_b128 v[88:91], v2 offset:7168
  v_smfmac_f32_16x16x64_bf16 v[16:19], v[124:127], v[200:207], v0
  s_waitcnt lgkmcnt(4)
  ds_read_b128 v[100:103], v1 offset:7168
  v_smfmac_f32_16x16x64_bf16 v[16:19], v[104:107], a[16:23], v0
  s_waitcnt lgkmcnt(4)
  ds_read_b128 v[68:71], v4 offset:16384
  buffer_load_dwordx4 v10, s[4:7], s28 offen offset:256 sc1 lds
  v_smfmac_f32_16x16x64_bf16 v[16:19], v[108:111], a[24:31], v0
  s_waitcnt lgkmcnt(4)
  ds_read_b128 v[72:75], v4 offset:17408
  v_smfmac_f32_16x16x64_bf16 v[16:19], v[112:115], a[64:71], v0
  s_waitcnt lgkmcnt(4)
  ds_read_b128 v[76:79], v4 offset:18432
  v_smfmac_f32_16x16x64_bf16 v[16:19], v[84:87], a[72:79], v0
  s_waitcnt lgkmcnt(4)
  ds_read_b128 v[80:83], v4 offset:19456
  v_smfmac_f32_16x16x64_bf16 v[16:19], v[88:91], a[112:119], v0
  s_waitcnt lgkmcnt(4)
  v_smfmac_f32_16x16x64_bf16 v[16:19], v[100:103], a[120:127], v0
  s_add_u32 s24, s36, 145752064
  s_add_u32 s25, s36, 145756160
  v_smfmac_f32_16x16x64_bf16 v[20:23], v[92:95], v[176:183], v0
  s_add_u32 s35, s36, s23
  v_smfmac_f32_16x16x64_bf16 v[20:23], v[96:99], v[184:191], v0
  s_waitcnt lgkmcnt(2)
  v_smfmac_f32_16x16x64_bf16 v[20:23], v[116:119], v[68:75], v0
  s_waitcnt lgkmcnt(0)
  ds_read_b128 v[68:71], v4 offset:20480
  v_mul_f32 v16, s18, v16
  v_smfmac_f32_16x16x64_bf16 v[20:23], v[124:127], v[76:83], v0
  ds_read_b128 v[72:75], v4 offset:21504
  v_mul_f32 v17, s18, v17
  v_smfmac_f32_16x16x64_bf16 v[20:23], v[104:107], a[32:39], v0
  ds_read_b128 v[76:79], v4 offset:22528
  v_mul_f32 v18, s18, v18
  v_smfmac_f32_16x16x64_bf16 v[20:23], v[108:111], a[40:47], v0
  ds_read_b128 v[80:83], v4 offset:23552
  v_mul_f32 v19, s18, v19
  v_smfmac_f32_16x16x64_bf16 v[20:23], v[112:115], a[80:87], v0
  v_cvt_pk_bf16_f32 v120, v16, v17
  v_smfmac_f32_16x16x64_bf16 v[20:23], v[84:87], a[88:95], v0
  v_cvt_pk_bf16_f32 v121, v18, v19
  v_smfmac_f32_16x16x64_bf16 v[20:23], v[88:91], a[128:135], v0
  ds_write_b64 v5, v[120:121] offset:24576
  v_smfmac_f32_16x16x64_bf16 v[20:23], v[100:103], a[136:143], v0
  s_waitcnt lgkmcnt(3)
  v_smfmac_f32_16x16x64_bf16 v[24:27], v[92:95], v[68:75], v0
  s_waitcnt lgkmcnt(1)
  v_mov_b64 v[92:93], 0
  v_smfmac_f32_16x16x64_bf16 v[24:27], v[96:99], v[76:83], v0
  s_nop 1
  v_cvt_pk_bf16_f32 v122, v20, v21
  v_cvt_pk_bf16_f32 v123, v22, v23
  v_smfmac_f32_16x16x64_bf16 v[24:27], v[116:119], v[208:215], v0
  ds_write_b64 v5, v[122:123] offset:26880
  v_mov_b64 v[94:95], 0
  v_smfmac_f32_16x16x64_bf16 v[24:27], v[124:127], v[216:223], v0
  s_waitcnt lgkmcnt(1)
  s_barrier
  ds_read_b64_tr_b16 v[68:69], v6 offset:24576
  v_smfmac_f32_16x16x64_bf16 v[24:27], v[104:107], a[48:55], v0
  s_add_u32 s27, s27, 8192
  ds_read_b64_tr_b16 v[70:71], v6 offset:24640
  ds_read_b64_tr_b16 v[72:73], v6 offset:24832
  v_smfmac_f32_16x16x64_bf16 v[24:27], v[108:111], a[56:63], v0
  s_add_u32 s28, s28, 8192
  ds_read_b64_tr_b16 v[74:75], v6 offset:24896
  ds_read_b64_tr_b16 v[76:77], v6 offset:25088
  v_smfmac_f32_16x16x64_bf16 v[24:27], v[112:115], a[96:103], v0
  s_nop 0
  ds_read_b64_tr_b16 v[78:79], v6 offset:25152
  ds_read_b64_tr_b16 v[80:81], v6 offset:25344
  v_smfmac_f32_16x16x64_bf16 v[24:27], v[84:87], a[104:111], v0
  ds_read_b64_tr_b16 v[82:83], v6 offset:25408
  v_mov_b64 v[96:97], 0
  v_smfmac_f32_16x16x64_bf16 v[24:27], v[88:91], a[144:151], v0
  s_waitcnt lgkmcnt(8)
  s_barrier
  ds_read_b64_tr_b16 v[116:117], v6 offset:26880
  v_smfmac_f32_16x16x64_bf16 v[24:27], v[100:103], a[152:159], v0
  s_waitcnt lgkmcnt(7)
  ds_read_b64_tr_b16 v[118:119], v6 offset:26944
  v_mfma_f32_16x16x32_bf16 v[16:19], v[36:39], v[68:71], 0
  s_waitcnt lgkmcnt(6)
  ds_read_b64_tr_b16 v[124:125], v6 offset:27136
  ds_read_b64_tr_b16 v[126:127], v6 offset:27200
  v_mfma_f32_16x16x32_bf16 v[16:19], v[40:43], v[72:75], v[16:19]
  s_waitcnt lgkmcnt(6)
  ds_read_b64_tr_b16 v[104:105], v6 offset:27392
  ds_read_b64_tr_b16 v[106:107], v6 offset:27456
  v_mfma_f32_16x16x32_bf16 v[16:19], v[44:47], v[76:79], v[16:19]
  s_waitcnt lgkmcnt(6)
  ds_read_b64_tr_b16 v[108:109], v6 offset:27648
  ds_read_b64_tr_b16 v[110:111], v6 offset:27712
  v_mfma_f32_16x16x32_bf16 v[16:19], v[48:51], v[80:83], v[16:19]
  s_waitcnt lgkmcnt(6)
  v_cvt_pk_bf16_f32 v120, v24, v25
  v_cvt_pk_bf16_f32 v121, v26, v27
  v_mfma_f32_16x16x32_bf16 v[112:115], v[116:119], v[68:71], 0
  s_waitcnt lgkmcnt(4)
  buffer_store_dwordx4 v[120:123], v2, s[4:7], s29 offen offset:0 sc1
  v_mov_b64 v[98:99], 0
  v_mfma_f32_16x16x32_bf16 v[112:115], v[124:127], v[72:75], v[112:115]
  s_waitcnt lgkmcnt(2)
  v_mov_b64 v[36:37], 0
  v_exp_f32 v100, v16
  v_mfma_f32_16x16x32_bf16 v[112:115], v[104:107], v[76:79], v[112:115]
  s_waitcnt lgkmcnt(0)
  v_exp_f32 v101, v17
  v_mfma_f32_16x16x32_bf16 v[112:115], v[108:111], v[80:83], v[112:115]
  s_add_u32 s29, s29, 131072
  v_exp_f32 v102, v18
  v_mfma_f32_16x16x32_bf16 v[20:23], v[52:55], v[68:71], 0
  s_cmp_eq_u32 s14, 63
  v_exp_f32 v103, v19
  v_mfma_f32_16x16x32_bf16 v[20:23], v[56:59], v[72:75], v[20:23]
  s_cbranch_scc1 M_tdone
  v_cvt_pk_bf16_f32 v44, v100, v101
  v_cvt_pk_bf16_f32 v45, v102, v103
  v_mfma_f32_16x16x32_bf16 v[20:23], v[60:63], v[76:79], v[20:23]
  v_exp_f32 v100, v112
  v_mfma_f32_16x16x32_bf16 v[20:23], v[64:67], v[80:83], v[20:23]
  v_exp_f32 v101, v113
  v_exp_f32 v102, v114
  v_exp_f32 v103, v115
  v_cvt_pk_bf16_f32 v84, v100, v101
  v_cvt_pk_bf16_f32 v85, v102, v103
  v_cndmask_b32 v48, v84, 0, s[16:17]
  v_cndmask_b32 v49, v85, 0, s[16:17]
  v_cndmask_b32 v50, 0, v84, s[16:17]
  v_cndmask_b32 v51, 0, v85, s[16:17]
  v_exp_f32 v100, v20
  v_mfma_f32_16x16x16_bf16 v[88:91], v[12:13], v[48:49], 0
  v_exp_f32 v101, v21
  v_mfma_f32_16x16x16_bf16 v[24:27], v[120:121], v[48:49], 0
  v_exp_f32 v102, v22
  v_mfma_f32_16x16x16_bf16 v[116:119], v[120:121], v[50:51], 0
  v_exp_f32 v103, v23
  v_cvt_pk_bf16_f32 v46, v100, v101
  v_cvt_pk_bf16_f32 v47, v102, v103
  v_mov_b64 v[38:39], 0
  s_nop 0
  v_mfma_f32_16x16x32_bf16 v[88:91], v[12:15], v[44:47], v[88:91]
  v_mov_b64 v[40:41], 0
  v_mov_b64 v[42:43], 0
  v_mfma_f32_16x16x32_bf16 v[24:27], v[28:31], v[44:47], v[24:27]
  ds_read_b128 v[52:55], v4 offset:24576
  ds_read_b128 v[56:59], v4 offset:25600
  v_mfma_f32_16x16x32_bf16 v[116:119], v[32:35], v[44:47], v[116:119]
  s_nop 1
  v_rcp_f32 v89, v88
  v_subrev_u32 v100, s54, v88
  v_cmp_le_u32 vcc, s55, v100
  v_mul_f32 v24, v89, v24
  v_mul_f32 v25, v89, v25
  s_cbranch_vccnz T_slow_148
T_back_149:
  v_cvt_pk_bf16_f32 v124, v24, v25
  v_pk_mul_f32 v[26:27], v[26:27], v[88:89] op_sel:[0,1] op_sel_hi:[1,1]
  v_pk_mul_f32 v[116:117], v[116:117], v[88:89] op_sel:[0,1] op_sel_hi:[1,1]
  v_pk_mul_f32 v[118:119], v[118:119], v[88:89] op_sel:[0,1] op_sel_hi:[1,1]
  v_cvt_pk_bf16_f32 v125, v26, v27
  v_cvt_pk_bf16_f32 v126, v116, v117
  v_cvt_pk_bf16_f32 v127, v118, v119
  ds_write_b128 v11, v[124:127] offset:29184
  s_nop 0
  v_smfmac_f32_16x16x64_bf16 v[92:95], v[124:127], a[160:167], v0
  v_smfmac_f32_16x16x64_bf16 v[96:99], v[124:127], a[168:175], v0
  v_smfmac_f32_16x16x64_bf16 v[36:39], v[124:127], a[176:183], v0
  v_smfmac_f32_16x16x64_bf16 v[40:43], v[124:127], a[184:191], v0
  s_waitcnt lgkmcnt(0)
  s_barrier
  ds_read_b128 v[104:107], v11 offset:29696
  ds_read_b128 v[108:111], v11 offset:30208
  ds_read_b128 v[68:71], v11 offset:30720
  s_waitcnt lgkmcnt(2)
  v_smfmac_f32_16x16x64_bf16 v[92:95], v[104:107], a[192:199], v0
  s_waitcnt lgkmcnt(1)
  ds_read_b128 v[76:79], v4 offset:28672
  v_smfmac_f32_16x16x64_bf16 v[92:95], v[108:111], a[224:231], v0
  s_waitcnt lgkmcnt(1)
  ds_read_b128 v[80:83], v4 offset:29696
  v_smfmac_f32_16x16x64_bf16 v[92:95], v[68:71], a[240:247], v0
  ds_read_b128 v[60:63], v4 offset:26624
  v_smfmac_f32_16x16x64_bf16 v[96:99], v[104:107], a[200:207], v0
  ds_read_b128 v[64:67], v4 offset:27648
  v_smfmac_f32_16x16x64_bf16 v[96:99], v[108:111], a[232:239], v0
  ds_read_b128 v[28:31], v4 offset:30720
  s_nop 0
  v_cvt_pk_bf16_f32 v16, v92, v93
  v_cvt_pk_bf16_f32 v17, v94, v95
  v_bfi_b32 v16, 1, s57, v16
  v_smfmac_f32_16x16x64_bf16 v[96:99], v[68:71], a[248:255], v0
  buffer_store_dwordx2 v[16:17], v7, s[4:7], s20 offen offset:0 sc1
  v_smfmac_f32_16x16x64_bf16 v[36:39], v[104:107], a[208:215], v0
  ds_read_b128 v[32:35], v4 offset:31744
  v_smfmac_f32_16x16x64_bf16 v[36:39], v[108:111], v[52:59], v0
  s_waitcnt lgkmcnt(4)
  s_nop 0
  v_cvt_pk_bf16_f32 v18, v96, v97
  v_cvt_pk_bf16_f32 v19, v98, v99
  v_bfi_b32 v18, 1, s57, v18
  v_smfmac_f32_16x16x64_bf16 v[36:39], v[68:71], v[76:83], v0
  buffer_store_dwordx2 v[18:19], v7, s[4:7], s20 offen offset:64 sc1
  v_smfmac_f32_16x16x64_bf16 v[40:43], v[104:107], a[216:223], v0
  s_waitcnt lgkmcnt(2)
  ds_read_b128 v[116:119], v2 offset:31232
  v_smfmac_f32_16x16x64_bf16 v[40:43], v[108:111], v[60:67], v0
  s_waitcnt lgkmcnt(1)
  s_nop 0
  v_cvt_pk_bf16_f32 v20, v36, v37
  v_cvt_pk_bf16_f32 v21, v38, v39
  v_bfi_b32 v20, 1, s57, v20
  v_smfmac_f32_16x16x64_bf16 v[40:43], v[68:71], v[28:35], v0
  buffer_store_dwordx2 v[20:21], v7, s[4:7], s21 offen offset:0 sc1
  s_nop 6
  v_cvt_pk_bf16_f32 v22, v40, v41
  v_cvt_pk_bf16_f32 v23, v42, v43
  v_bfi_b32 v22, 1, s57, v22
  buffer_store_dwordx2 v[22:23], v7, s[4:7], s21 offen offset:64 sc1
  ds_read_b128 v[68:71], v4 offset:0
  ds_read_b128 v[72:75], v4 offset:1024
  ds_read_b128 v[76:79], v4 offset:4096
  ds_read_b128 v[80:83], v4 offset:5120
  ds_read_b128 v[84:87], v4 offset:8192
  ds_read_b128 v[88:91], v4 offset:9216
  v_mov_b64 v[16:17], 0
  v_mov_b64 v[18:19], 0
  v_mov_b64 v[20:21], 0
  v_mov_b64 v[22:23], 0
  v_mov_b64 v[24:25], 0
  v_mov_b64 v[26:27], 0
  s_mov_b32 s19, 0
  v_mov_b32 v49, -1
  s_waitcnt vmcnt(2)
  buffer_load_dwordx4 v[52:55], v2, s[4:7], s22 offen offset:0 sc1
  buffer_load_dwordx4 v[56:59], v2, s[4:7], s22 offen offset:1024 sc1
  buffer_load_dwordx4 v[60:63], v2, s[4:7], s22 offen offset:2048 sc1
  buffer_load_dwordx4 v[64:67], v2, s[4:7], s22 offen offset:3072 sc1
  ds_read_b128 v[92:95], v4 offset:2048
  ds_read_b128 v[96:99], v4 offset:3072
  ds_read_b128 v[100:103], v4 offset:6144
  ds_read_b128 v[104:107], v4 offset:7168
  ds_read_b128 v[108:111], v4 offset:10240
  ds_read_b128 v[112:115], v4 offset:11264
  ds_read_b64 v[44:45], v2 offset:32256
  s_waitcnt lgkmcnt(0)
  v_readfirstlane_b32 s38, v44
  v_readfirstlane_b32 s37, v45
  s_nop 0
  s_add_u32 s37, s37, 30
  s_cmp_ge_u32 s38, 30
  s_cselect_b32 s38, s37, s38
  s_cmp_ge_u32 s38, 64
  s_cselect_b32 s38, 100, s38
  s_sub_u32 s38, s38, 1
  s_max_i32 s30, s30, s38
  s_waitcnt lgkmcnt(12)
  s_waitcnt vmcnt(3)
  v_mfma_f32_16x16x32_bf16 v[120:123], v[116:119], v[52:55], 0
  v_xor_b32 v48, s57, v52
  v_bitop3_b32 v48, v48, v54, s57 bitop3:0xf6
  s_waitcnt vmcnt(2)
  v_mfma_f32_16x16x32_bf16 v[120:123], v[116:119], v[56:59], v[120:123]
  v_bitop3_b32 v48, v48, v56, s57 bitop3:0xf6
  v_bitop3_b32 v48, v48, v58, s57 bitop3:0xf6
  s_waitcnt vmcnt(1)
  v_mfma_f32_16x16x32_bf16 v[120:123], v[116:119], v[60:63], v[120:123]
  v_bitop3_b32 v48, v48, v60, s57 bitop3:0xf6
  v_bitop3_b32 v48, v48, v62, s57 bitop3:0xf6
  s_waitcnt vmcnt(0)
  v_mfma_f32_16x16x32_bf16 v[120:123], v[116:119], v[64:67], v[120:123]
  v_bitop3_b32 v48, v48, v64, s57 bitop3:0xf6
  v_bitop3_b32 v48, v48, v66, s57 bitop3:0xf6
  v_and_b32 v48, 1, v48
  v_cmp_ne_u32 vcc, 0, v48
  s_cbranch_vccnz T_p1re_151
T_p1ok_152:
  s_nop 2
  v_add_f32_dpp v120, v120, v120 row_ror:8 row_mask:0xf bank_mask:0xf
  v_add_f32_dpp v121, v121, v121 row_ror:8 row_mask:0xf bank_mask:0xf
  v_cvt_pk_bf16_f32 v48, v120, v121
  v_min_u32 v48, -2, v48
  buffer_store_dword v48, v8, s[4:7], s35 offen sc1
  buffer_store_dword v49, v8, s[4:7], s26 offen sc1
  s_barrier
  ds_read_b128 v[28:31], v2 offset:16384
  ds_read_b128 v[32:35], v2 offset:20480
  ds_read_b128 v[36:39], v2 offset:8192
  ds_read_b128 v[40:43], v2 offset:9216
  ds_read_b128 v[44:47], v2 offset:10240
  ds_read_b128 v[48:51], v2 offset:11264
  buffer_load_dwordx4 v[124:127], v3, s[4:7], s24 offen offset:0 sc1
  buffer_load_dwordx4 v[116:119], v3, s[4:7], s25 offen offset:0 sc1
  ds_read_b128 v[52:55], v2 offset:12288
  ds_read_b128 v[56:59], v2 offset:13312
  ds_read_b128 v[60:63], v2 offset:14336
  ds_read_b128 v[64:67], v2 offset:15360
  buffer_load_dwordx4 v[124:127], v3, s[4:7], s24 offen offset:0 sc1
  buffer_load_dwordx4 v[116:119], v3, s[4:7], s25 offen offset:0 sc1
  s_mov_b32 s19, 0
  s_branch T_loop_141
T_p1re_151:
  s_mov_b64 exec, vcc
  buffer_load_dwordx4 v[52:55], v2, s[4:7], s22 offen offset:0 sc1
  buffer_load_dwordx4 v[56:59], v2, s[4:7], s22 offen offset:1024 sc1
  buffer_load_dwordx4 v[60:63], v2, s[4:7], s22 offen offset:2048 sc1
  buffer_load_dwordx4 v[64:67], v2, s[4:7], s22 offen offset:3072 sc1
  s_mov_b64 exec, -1
  s_add_u32 s19, s19, 1
  s_cmp_gt_u32 s19, 32768
  s_cbranch_scc1 M_exit
  s_waitcnt vmcnt(3)
  v_mfma_f32_16x16x32_bf16 v[120:123], v[116:119], v[52:55], 0
  v_xor_b32 v48, s57, v52
  v_bitop3_b32 v48, v48, v54, s57 bitop3:0xf6
  s_waitcnt vmcnt(2)
  v_mfma_f32_16x16x32_bf16 v[120:123], v[116:119], v[56:59], v[120:123]
  v_bitop3_b32 v48, v48, v56, s57 bitop3:0xf6
  v_bitop3_b32 v48, v48, v58, s57 bitop3:0xf6
  s_waitcnt vmcnt(1)
  v_mfma_f32_16x16x32_bf16 v[120:123], v[116:119], v[60:63], v[120:123]
  v_bitop3_b32 v48, v48, v60, s57 bitop3:0xf6
  v_bitop3_b32 v48, v48, v62, s57 bitop3:0xf6
  s_waitcnt vmcnt(0)
  v_mfma_f32_16x16x32_bf16 v[120:123], v[116:119], v[64:67], v[120:123]
  v_bitop3_b32 v48, v48, v64, s57 bitop3:0xf6
  v_bitop3_b32 v48, v48, v66, s57 bitop3:0xf6
  v_and_b32 v48, 1, v48
  v_cmp_ne_u32 vcc, 0, v48
  s_cbranch_vccnz T_p1re_151
  s_branch T_p1ok_152
T_kvw_145:
  s_mov_b32 s19, 0
  s_branch T_kvok_154
T_kv_153:
  s_sleep 4
  s_add_u32 s19, s19, 1
  s_cmp_gt_u32 s19, 32768
  s_cbranch_scc1 M_exit
T_kvok_154:
  s_add_u32 s39, s99, 128
  s_mov_b32 s38, 0
  s_mov_b32 s37, 0
  s_atomic_or s38, s[58:59], s99 glc
  s_atomic_or s37, s[58:59], s39 glc
  s_waitcnt lgkmcnt(0)
  s_add_u32 s37, s37, 30
  s_cmp_ge_u32 s38, 30
  s_cselect_b32 s38, s37, s38
  s_cmp_ge_u32 s38, 64
  s_cselect_b32 s38, 100, s38
  s_sub_u32 s38, s38, 1
  s_max_i32 s30, s30, s38
  s_cmp_ge_i32 s14, s30
  s_cbranch_scc1 T_kv_153
  s_branch T_kvb_146
T_slow_148:
  s_nop 7
  v_max3_f32 v100, v16, v17, v18
  v_max3_f32 v100, v100, v19, v20
  v_max3_f32 v100, v100, v21, v22
  v_max3_f32 v100, v100, v23, v112
  v_max3_f32 v100, v100, v113, v114
  v_max_f32 v100, v100, v115
  v_mov_b32 v101, v100
  s_nop 1
  v_permlane32_swap_b32 v100, v101
  s_nop 1
  v_max_f32 v100, v100, v101
  v_mov_b32 v101, v100
  s_nop 1
  v_permlane16_swap_b32 v100, v101
  s_nop 1
  v_max_f32 v100, v100, v101
  v_sub_f32 v16, v16, v100
  v_sub_f32 v17, v17, v100
  v_sub_f32 v18, v18, v100
  v_sub_f32 v19, v19, v100
  v_exp_f32 v16, v16
  v_exp_f32 v17, v17
  v_exp_f32 v18, v18
  v_exp_f32 v19, v19
  v_sub_f32 v20, v20, v100
  v_sub_f32 v21, v21, v100
  v_sub_f32 v22, v22, v100
  v_sub_f32 v23, v23, v100
  v_exp_f32 v20, v20
  v_exp_f32 v21, v21
  v_exp_f32 v22, v22
  v_exp_f32 v23, v23
  v_sub_f32 v112, v112, v100
  v_sub_f32 v113, v113, v100
  v_sub_f32 v114, v114, v100
  v_sub_f32 v115, v115, v100
  v_exp_f32 v112, v112
  v_exp_f32 v113, v113
  v_exp_f32 v114, v114
  v_exp_f32 v115, v115
  s_nop 0
  v_cvt_pk_bf16_f32 v44, v16, v17
  v_cvt_pk_bf16_f32 v45, v18, v19
  v_cvt_pk_bf16_f32 v46, v20, v21
  v_cvt_pk_bf16_f32 v47, v22, v23
  v_cvt_pk_bf16_f32 v84, v112, v113
  v_cvt_pk_bf16_f32 v85, v114, v115
  v_cndmask_b32 v48, v84, 0, s[16:17]
  v_cndmask_b32 v49, v85, 0, s[16:17]
  v_cndmask_b32 v50, 0, v84, s[16:17]
  v_cndmask_b32 v51, 0, v85, s[16:17]
  s_nop 1
  v_mfma_f32_16x16x16_bf16 v[88:91], v[12:13], v[48:49], 0
  v_mfma_f32_16x16x16_bf16 v[24:27], v[120:121], v[48:49], 0
  v_mfma_f32_16x16x16_bf16 v[116:119], v[120:121], v[50:51], 0
  v_mfma_f32_16x16x32_bf16 v[88:91], v[12:15], v[44:47], v[88:91]
  v_mfma_f32_16x16x32_bf16 v[24:27], v[28:31], v[44:47], v[24:27]
  v_mfma_f32_16x16x32_bf16 v[116:119], v[32:35], v[44:47], v[116:119]
  s_nop 7
  s_nop 1
  v_rcp_f32 v89, v88
  s_nop 0
  v_mul_f32 v24, v89, v24
  v_mul_f32 v25, v89, v25
  s_branch T_back_149
T_w_138:
  s_mov_b32 s19, 0
  v_mov_b64 v[16:17], 0
  v_mov_b64 v[18:19], 0
  v_mov_b64 v[20:21], 0
  v_mov_b64 v[22:23], 0
  v_mov_b64 v[24:25], 0
  v_mov_b64 v[26:27], 0
  buffer_load_dwordx4 v[124:127], v3, s[4:7], s24 offen offset:1024 sc1
  buffer_load_dwordx4 v[116:119], v3, s[4:7], s25 offen offset:1024 sc1
  buffer_load_dwordx4 v[124:127], v3, s[4:7], s24 offen offset:1024 sc1
  buffer_load_dwordx4 v[116:119], v3, s[4:7], s25 offen offset:1024 sc1
  s_branch T_loop_155
.p2align 6
T_retry_156:
  s_mov_b64 exec, vcc
  buffer_load_dwordx4 v[124:127], v3, s[4:7], s24 offen offset:1024 sc1
  buffer_load_dwordx4 v[116:119], v3, s[4:7], s25 offen offset:1024 sc1
  s_mov_b64 exec, -1
  s_add_u32 s19, s19, 1
  s_cmp_gt_u32 s19, 32768
  s_cbranch_scc1 M_exit
T_loop_155:
  s_waitcnt vmcnt(3) lgkmcnt(0)
  v_max3_u32 v123, v124, v125, v126
  v_max_u32 v123, v123, v127
  v_mov_b32_dpp v120, v124 row_ror:8 row_mask:0xf bank_mask:0xf
  v_mov_b32_dpp v121, v125 row_ror:8 row_mask:0xf bank_mask:0xf
  s_waitcnt vmcnt(2)
  v_max3_u32 v123, v123, v116, v117
  v_max3_u32 v123, v123, v118, v119
  v_cmp_eq_u32 vcc, -1, v123
  s_cbranch_vccnz T_retry_156
  v_smfmac_f32_16x16x64_bf16 v[16:19], v[124:127], v[68:75], v0
  s_add_u32 s14, s14, 1
  ds_write_b128 v2, v[124:127] offset:1024
  v_mov_b32_dpp v122, v126 row_ror:8 row_mask:0xf bank_mask:0xf
  v_smfmac_f32_16x16x64_bf16 v[20:23], v[124:127], v[76:83], v0
  s_and_b32 s57, s14, 1
  v_mov_b32_dpp v123, v127 row_ror:8 row_mask:0xf bank_mask:0xf
  v_smfmac_f32_16x16x64_bf16 v[24:27], v[124:127], v[84:91], v0
  s_and_b32 s36, s14, 3
  ds_write_b128 v2, v[116:119] offset:5120
  v_smfmac_f32_16x16x64_bf16 v[16:19], v[120:123], v[92:99], v0
  s_lshl_b32 s36, s36, 13
  v_mov_b32_dpp v84, v116 row_ror:8 row_mask:0xf bank_mask:0xf
  v_smfmac_f32_16x16x64_bf16 v[20:23], v[120:123], v[100:107], v0
  s_add_u32 s26, s36, s23
  ds_read_b128 v[68:71], v4 offset:12288
  v_mov_b32_dpp v85, v117 row_ror:8 row_mask:0xf bank_mask:0xf
  v_smfmac_f32_16x16x64_bf16 v[24:27], v[120:123], v[108:115], v0
  s_add_u32 s36, s36, 8192
  ds_read_b128 v[72:75], v4 offset:13312
  v_mov_b32_dpp v86, v118 row_ror:8 row_mask:0xf bank_mask:0xf
  v_smfmac_f32_16x16x64_bf16 v[16:19], v[116:119], v[224:231], v0
  s_and_b32 s36, s36, 0x7fff
  ds_read_b128 v[76:79], v4 offset:14336
  v_mov_b32_dpp v87, v119 row_ror:8 row_mask:0xf bank_mask:0xf
  v_smfmac_f32_16x16x64_bf16 v[20:23], v[116:119], v[240:247], v0
  s_waitcnt lgkmcnt(3)
  s_barrier
  ds_read_b128 v[100:103], v2 offset:0
  v_smfmac_f32_16x16x64_bf16 v[24:27], v[116:119], a[0:7], v0
  s_mov_b32 m0, s31
  ds_read_b128 v[120:123], v1 offset:0
  v_smfmac_f32_16x16x64_bf16 v[16:19], v[84:87], v[232:239], v0
  s_cmp_ge_i32 s14, s30
  s_cbranch_scc1 T_kvw_159
T_kvb_160:
  v_smfmac_f32_16x16x64_bf16 v[20:23], v[84:87], v[248:255], v0
  ds_read_b128 v[80:83], v4 offset:15360
  v_smfmac_f32_16x16x64_bf16 v[24:27], v[84:87], a[8:15], v0
  s_waitcnt lgkmcnt(2)
  buffer_load_dwordx4 v9, s[4:7], s27 offen sc1 lds
  v_smfmac_f32_16x16x64_bf16 v[16:19], v[100:103], v[128:135], v0
  ds_read_b128 v[92:95], v2 offset:3072
  s_mov_b32 m0, s32
  v_smfmac_f32_16x16x64_bf16 v[20:23], v[100:103], v[144:151], v0
  ds_read_b128 v[96:99], v1 offset:3072
  v_smfmac_f32_16x16x64_bf16 v[24:27], v[100:103], v[68:75], v0
  s_waitcnt vmcnt(1) lgkmcnt(3)
  ds_read_b128 v[116:119], v2 offset:2048
  v_smfmac_f32_16x16x64_bf16 v[16:19], v[120:123], v[136:143], v0
  ds_read_b128 v[124:127], v1 offset:2048
  buffer_load_dwordx4 v9, s[4:7], s27 offen offset:128 sc1 lds
  v_smfmac_f32_16x16x64_bf16 v[20:23], v[120:123], v[152:159], v0
  s_waitcnt lgkmcnt(4)
  ds_read_b128 v[104:107], v2 offset:4096
  s_mov_b32 m0, s33
  v_smfmac_f32_16x16x64_bf16 v[24:27], v[120:123], v[76:83], v0
  s_waitcnt lgkmcnt(4)
  ds_read_b128 v[108:111], v1 offset:4096
  v_smfmac_f32_16x16x64_bf16 v[16:19], v[92:95], v[160:167], v0
  s_waitcnt lgkmcnt(4)
  ds_read_b128 v[112:115], v2 offset:7168
  v_smfmac_f32_16x16x64_bf16 v[16:19], v[96:99], v[168:175], v0
  s_waitcnt lgkmcnt(4)
  ds_read_b128 v[84:87], v1 offset:7168
  buffer_load_dwordx4 v10, s[4:7], s28 offen sc1 lds
  v_smfmac_f32_16x16x64_bf16 v[16:19], v[116:119], v[192:199], v0
  s_waitcnt lgkmcnt(4)
  ds_read_b128 v[88:91], v2 offset:6144
  s_mov_b32 m0, s34
  v_smfmac_f32_16x16x64_bf16 v[16:19], v[124:127], v[200:207], v0
  s_waitcnt lgkmcnt(4)
  ds_read_b128 v[100:103], v1 offset:6144
  v_smfmac_f32_16x16x64_bf16 v[16:19], v[104:107], a[16:23], v0
  s_waitcnt lgkmcnt(4)
  ds_read_b128 v[68:71], v4 offset:16384
  v_smfmac_f32_16x16x64_bf16 v[16:19], v[108:111], a[24:31], v0
  s_waitcnt lgkmcnt(4)
  ds_read_b128 v[72:75], v4 offset:17408
  buffer_load_dwordx4 v10, s[4:7], s28 offen offset:256 sc1 lds
  v_smfmac_f32_16x16x64_bf16 v[16:19], v[112:115], a[64:71], v0
  s_waitcnt lgkmcnt(4)
  ds_read_b128 v[76:79], v4 offset:18432
  v_smfmac_f32_16x16x64_bf16 v[16:19], v[84:87], a[72:79], v0
  s_waitcnt lgkmcnt(4)
  ds_read_b128 v[80:83], v4 offset:19456
  v_smfmac_f32_16x16x64_bf16 v[16:19], v[88:91], a[112:119], v0
  s_waitcnt lgkmcnt(4)
  v_smfmac_f32_16x16x64_bf16 v[16:19], v[100:103], a[120:127], v0
  s_add_u32 s24, s36, 145752064
  s_add_u32 s25, s36, 145756160
  v_smfmac_f32_16x16x64_bf16 v[20:23], v[92:95], v[176:183], v0
  s_add_u32 s35, s36, s23
  v_smfmac_f32_16x16x64_bf16 v[20:23], v[96:99], v[184:191], v0
  s_waitcnt lgkmcnt(2)
  v_smfmac_f32_16x16x64_bf16 v[20:23], v[116:119], v[68:75], v0
  s_waitcnt lgkmcnt(0)
  ds_read_b128 v[68:71], v4 offset:20480
  v_mul_f32 v16, s18, v16
  v_smfmac_f32_16x16x64_bf16 v[20:23], v[124:127], v[76:83], v0
  ds_read_b128 v[72:75], v4 offset:21504
  v_mul_f32 v17, s18, v17
  v_smfmac_f32_16x16x64_bf16 v[20:23], v[104:107], a[32:39], v0
  ds_read_b128 v[76:79], v4 offset:22528
  v_mul_f32 v18, s18, v18
  v_smfmac_f32_16x16x64_bf16 v[20:23], v[108:111], a[40:47], v0
  ds_read_b128 v[80:83], v4 offset:23552
  v_mul_f32 v19, s18, v19
  v_smfmac_f32_16x16x64_bf16 v[20:23], v[112:115], a[80:87], v0
  v_cvt_pk_bf16_f32 v120, v16, v17
  v_smfmac_f32_16x16x64_bf16 v[20:23], v[84:87], a[88:95], v0
  v_cvt_pk_bf16_f32 v121, v18, v19
  v_smfmac_f32_16x16x64_bf16 v[20:23], v[88:91], a[128:135], v0
  ds_write_b64 v5, v[120:121] offset:24576
  v_smfmac_f32_16x16x64_bf16 v[20:23], v[100:103], a[136:143], v0
  s_waitcnt lgkmcnt(3)
  v_smfmac_f32_16x16x64_bf16 v[24:27], v[92:95], v[68:75], v0
  s_waitcnt lgkmcnt(1)
  v_mov_b64 v[92:93], 0
  v_smfmac_f32_16x16x64_bf16 v[24:27], v[96:99], v[76:83], v0
  s_nop 1
  v_cvt_pk_bf16_f32 v122, v20, v21
  v_cvt_pk_bf16_f32 v123, v22, v23
  v_smfmac_f32_16x16x64_bf16 v[24:27], v[116:119], v[208:215], v0
  ds_write_b64 v5, v[122:123] offset:26880
  v_mov_b64 v[94:95], 0
  v_smfmac_f32_16x16x64_bf16 v[24:27], v[124:127], v[216:223], v0
  s_waitcnt lgkmcnt(1)
  s_barrier
  ds_read_b64_tr_b16 v[68:69], v6 offset:24576
  v_smfmac_f32_16x16x64_bf16 v[24:27], v[104:107], a[48:55], v0
  s_add_u32 s27, s27, 8192
  ds_read_b64_tr_b16 v[70:71], v6 offset:24640
  ds_read_b64_tr_b16 v[72:73], v6 offset:24832
  v_smfmac_f32_16x16x64_bf16 v[24:27], v[108:111], a[56:63], v0
  s_add_u32 s28, s28, 8192
  ds_read_b64_tr_b16 v[74:75], v6 offset:24896
  ds_read_b64_tr_b16 v[76:77], v6 offset:25088
  v_smfmac_f32_16x16x64_bf16 v[24:27], v[112:115], a[96:103], v0
  s_nop 0
  ds_read_b64_tr_b16 v[78:79], v6 offset:25152
  ds_read_b64_tr_b16 v[80:81], v6 offset:25344
  v_smfmac_f32_16x16x64_bf16 v[24:27], v[84:87], a[104:111], v0
  ds_read_b64_tr_b16 v[82:83], v6 offset:25408
  v_mov_b64 v[96:97], 0
  v_smfmac_f32_16x16x64_bf16 v[24:27], v[88:91], a[144:151], v0
  s_waitcnt lgkmcnt(8)
  s_barrier
  ds_read_b64_tr_b16 v[116:117], v6 offset:26880
  v_smfmac_f32_16x16x64_bf16 v[24:27], v[100:103], a[152:159], v0
  s_waitcnt lgkmcnt(7)
  ds_read_b64_tr_b16 v[118:119], v6 offset:26944
  v_mfma_f32_16x16x32_bf16 v[16:19], v[36:39], v[68:71], 0
  s_waitcnt lgkmcnt(6)
  ds_read_b64_tr_b16 v[124:125], v6 offset:27136
  ds_read_b64_tr_b16 v[126:127], v6 offset:27200
  v_mfma_f32_16x16x32_bf16 v[16:19], v[40:43], v[72:75], v[16:19]
  s_waitcnt lgkmcnt(6)
  ds_read_b64_tr_b16 v[104:105], v6 offset:27392
  ds_read_b64_tr_b16 v[106:107], v6 offset:27456
  v_mfma_f32_16x16x32_bf16 v[16:19], v[44:47], v[76:79], v[16:19]
  s_waitcnt lgkmcnt(6)
  ds_read_b64_tr_b16 v[108:109], v6 offset:27648
  ds_read_b64_tr_b16 v[110:111], v6 offset:27712
  v_mfma_f32_16x16x32_bf16 v[16:19], v[48:51], v[80:83], v[16:19]
  s_waitcnt lgkmcnt(6)
  v_cvt_pk_bf16_f32 v120, v24, v25
  v_cvt_pk_bf16_f32 v121, v26, v27
  v_mfma_f32_16x16x32_bf16 v[112:115], v[116:119], v[68:71], 0
  s_waitcnt lgkmcnt(4)
  buffer_store_dwordx4 v[120:123], v2, s[4:7], s29 offen offset:1024 sc1
  v_mov_b64 v[98:99], 0
  v_mfma_f32_16x16x32_bf16 v[112:115], v[124:127], v[72:75], v[112:115]
  s_waitcnt lgkmcnt(2)
  v_mov_b64 v[36:37], 0
  v_exp_f32 v100, v16
  v_mfma_f32_16x16x32_bf16 v[112:115], v[104:107], v[76:79], v[112:115]
  s_waitcnt lgkmcnt(0)
  v_exp_f32 v101, v17
  v_mfma_f32_16x16x32_bf16 v[112:115], v[108:111], v[80:83], v[112:115]
  s_add_u32 s29, s29, 131072
  v_exp_f32 v102, v18
  v_mfma_f32_16x16x32_bf16 v[20:23], v[52:55], v[68:71], 0
  s_cmp_eq_u32 s14, 63
  v_exp_f32 v103, v19
  v_mfma_f32_16x16x32_bf16 v[20:23], v[56:59], v[72:75], v[20:23]
  s_cbranch_scc1 M_tdone
  v_cvt_pk_bf16_f32 v44, v100, v101
  v_cvt_pk_bf16_f32 v45, v102, v103
  v_mfma_f32_16x16x32_bf16 v[20:23], v[60:63], v[76:79], v[20:23]
  v_exp_f32 v100, v112
  v_mfma_f32_16x16x32_bf16 v[20:23], v[64:67], v[80:83], v[20:23]
  v_exp_f32 v101, v113
  v_exp_f32 v102, v114
  v_exp_f32 v103, v115
  v_cvt_pk_bf16_f32 v84, v100, v101
  v_cvt_pk_bf16_f32 v85, v102, v103
  v_cndmask_b32 v48, v84, 0, s[16:17]
  v_cndmask_b32 v49, v85, 0, s[16:17]
  v_cndmask_b32 v50, 0, v84, s[16:17]
  v_cndmask_b32 v51, 0, v85, s[16:17]
  v_exp_f32 v100, v20
  v_mfma_f32_16x16x16_bf16 v[88:91], v[12:13], v[48:49], 0
  v_exp_f32 v101, v21
  v_mfma_f32_16x16x16_bf16 v[24:27], v[120:121], v[48:49], 0
  v_exp_f32 v102, v22
  v_mfma_f32_16x16x16_bf16 v[116:119], v[120:121], v[50:51], 0
  v_exp_f32 v103, v23
  v_cvt_pk_bf16_f32 v46, v100, v101
  v_cvt_pk_bf16_f32 v47, v102, v103
  v_mov_b64 v[38:39], 0
  s_nop 0
  v_mfma_f32_16x16x32_bf16 v[88:91], v[12:15], v[44:47], v[88:91]
  v_mov_b64 v[40:41], 0
  v_mov_b64 v[42:43], 0
  v_mfma_f32_16x16x32_bf16 v[24:27], v[28:31], v[44:47], v[24:27]
  ds_read_b128 v[52:55], v4 offset:24576
  ds_read_b128 v[56:59], v4 offset:25600
  v_mfma_f32_16x16x32_bf16 v[116:119], v[32:35], v[44:47], v[116:119]
  s_nop 1
  v_rcp_f32 v89, v88
  v_subrev_u32 v100, s54, v88
  v_cmp_le_u32 vcc, s55, v100
  v_mul_f32 v24, v89, v24
  v_mul_f32 v25, v89, v25
  s_cbranch_vccnz T_slow_162
T_back_163:
  v_cvt_pk_bf16_f32 v124, v24, v25
  v_pk_mul_f32 v[26:27], v[26:27], v[88:89] op_sel:[0,1] op_sel_hi:[1,1]
  v_pk_mul_f32 v[116:117], v[116:117], v[88:89] op_sel:[0,1] op_sel_hi:[1,1]
  v_pk_mul_f32 v[118:119], v[118:119], v[88:89] op_sel:[0,1] op_sel_hi:[1,1]
  v_cvt_pk_bf16_f32 v125, v26, v27
  v_cvt_pk_bf16_f32 v126, v116, v117
  v_cvt_pk_bf16_f32 v127, v118, v119
  ds_write_b128 v11, v[124:127] offset:29696
  s_nop 0
  v_smfmac_f32_16x16x64_bf16 v[92:95], v[124:127], a[160:167], v0
  v_smfmac_f32_16x16x64_bf16 v[96:99], v[124:127], a[168:175], v0
  v_smfmac_f32_16x16x64_bf16 v[36:39], v[124:127], a[176:183], v0
  v_smfmac_f32_16x16x64_bf16 v[40:43], v[124:127], a[184:191], v0
  s_waitcnt lgkmcnt(0)
  s_barrier
  ds_read_b128 v[104:107], v11 offset:29184
  ds_read_b128 v[108:111], v11 offset:30720
  ds_read_b128 v[68:71], v11 offset:30208
  s_waitcnt lgkmcnt(2)
  v_smfmac_f32_16x16x64_bf16 v[92:95], v[104:107], a[192:199], v0
  s_waitcnt lgkmcnt(1)
  ds_read_b128 v[76:79], v4 offset:28672
  v_smfmac_f32_16x16x64_bf16 v[92:95], v[108:111], a[224:231], v0
  s_waitcnt lgkmcnt(1)
  ds_read_b128 v[80:83], v4 offset:29696
  v_smfmac_f32_16x16x64_bf16 v[92:95], v[68:71], a[240:247], v0
  ds_read_b128 v[60:63], v4 offset:26624
  v_smfmac_f32_16x16x64_bf16 v[96:99], v[104:107], a[200:207], v0
  ds_read_b128 v[64:67], v4 offset:27648
  v_smfmac_f32_16x16x64_bf16 v[96:99], v[108:111], a[232:239], v0
  ds_read_b128 v[28:31], v4 offset:30720
  s_nop 0
  v_cvt_pk_bf16_f32 v16, v92, v93
  v_cvt_pk_bf16_f32 v17, v94, v95
  v_bfi_b32 v16, 1, s57, v16
  v_smfmac_f32_16x16x64_bf16 v[96:99], v[68:71], a[248:255], v0
  buffer_store_dwordx2 v[16:17], v7, s[4:7], s20 offen offset:0 sc1
  v_smfmac_f32_16x16x64_bf16 v[36:39], v[104:107], a[208:215], v0
  ds_read_b128 v[32:35], v4 offset:31744
  v_smfmac_f32_16x16x64_bf16 v[36:39], v[108:111], v[52:59], v0
  s_waitcnt lgkmcnt(4)
  s_nop 0
  v_cvt_pk_bf16_f32 v18, v96, v97
  v_cvt_pk_bf16_f32 v19, v98, v99
  v_bfi_b32 v18, 1, s57, v18
  v_smfmac_f32_16x16x64_bf16 v[36:39], v[68:71], v[76:83], v0
  buffer_store_dwordx2 v[18:19], v7, s[4:7], s20 offen offset:64 sc1
  v_smfmac_f32_16x16x64_bf16 v[40:43], v[104:107], a[216:223], v0
  s_waitcnt lgkmcnt(2)
  ds_read_b128 v[116:119], v2 offset:31232
  v_smfmac_f32_16x16x64_bf16 v[40:43], v[108:111], v[60:67], v0
  s_waitcnt lgkmcnt(1)
  s_nop 0
  v_cvt_pk_bf16_f32 v20, v36, v37
  v_cvt_pk_bf16_f32 v21, v38, v39
  v_bfi_b32 v20, 1, s57, v20
  v_smfmac_f32_16x16x64_bf16 v[40:43], v[68:71], v[28:35], v0
  buffer_store_dwordx2 v[20:21], v7, s[4:7], s21 offen offset:0 sc1
  s_nop 6
  v_cvt_pk_bf16_f32 v22, v40, v41
  v_cvt_pk_bf16_f32 v23, v42, v43
  v_bfi_b32 v22, 1, s57, v22
  buffer_store_dwordx2 v[22:23], v7, s[4:7], s21 offen offset:64 sc1
  ds_read_b128 v[68:71], v4 offset:0
  ds_read_b128 v[72:75], v4 offset:1024
  ds_read_b128 v[76:79], v4 offset:4096
  ds_read_b128 v[80:83], v4 offset:5120
  ds_read_b128 v[84:87], v4 offset:8192
  ds_read_b128 v[88:91], v4 offset:9216
  ds_read_b128 v[92:95], v4 offset:2048
  ds_read_b128 v[96:99], v4 offset:3072
  ds_read_b128 v[100:103], v4 offset:6144
  ds_read_b128 v[104:107], v4 offset:7168
  ds_read_b128 v[108:111], v4 offset:10240
  ds_read_b128 v[112:115], v4 offset:11264
  v_mov_b64 v[16:17], 0
  v_mov_b64 v[18:19], 0
  v_mov_b64 v[20:21], 0
  v_mov_b64 v[22:23], 0
  v_mov_b64 v[24:25], 0
  v_mov_b64 v[26:27], 0
  s_mov_b32 s19, 0
  v_mov_b32 v49, -1
  ds_read_b64 v[44:45], v2 offset:32256
  s_waitcnt lgkmcnt(0)
  v_readfirstlane_b32 s38, v44
  v_readfirstlane_b32 s37, v45
  s_nop 0
  s_add_u32 s37, s37, 30
  s_cmp_ge_u32 s38, 30
  s_cselect_b32 s38, s37, s38
  s_cmp_ge_u32 s38, 64
  s_cselect_b32 s38, 100, s38
  s_sub_u32 s38, s38, 1
  s_max_i32 s30, s30, s38
  s_waitcnt vmcnt(0)
  buffer_load_dwordx4 v[52:55], v2, s[4:7], s22 offen offset:0 sc1
  buffer_load_dwordx4 v[56:59], v2, s[4:7], s22 offen offset:1024 sc1
  buffer_load_dwordx4 v[60:63], v2, s[4:7], s22 offen offset:2048 sc1
  buffer_load_dwordx4 v[64:67], v2, s[4:7], s22 offen offset:3072 sc1
  s_waitcnt lgkmcnt(12)
  s_waitcnt vmcnt(3)
  v_mfma_f32_16x16x32_bf16 v[120:123], v[116:119], v[52:55], 0
  v_xor_b32 v48, s57, v52
  v_bitop3_b32 v48, v48, v54, s57 bitop3:0xf6
  s_waitcnt vmcnt(2)
  v_mfma_f32_16x16x32_bf16 v[120:123], v[116:119], v[56:59], v[120:123]
  v_bitop3_b32 v48, v48, v56, s57 bitop3:0xf6
  v_bitop3_b32 v48, v48, v58, s57 bitop3:0xf6
  s_waitcnt vmcnt(1)
  v_mfma_f32_16x16x32_bf16 v[120:123], v[116:119], v[60:63], v[120:123]
  v_bitop3_b32 v48, v48, v60, s57 bitop3:0xf6
  v_bitop3_b32 v48, v48, v62, s57 bitop3:0xf6
  s_waitcnt vmcnt(0)
  v_mfma_f32_16x16x32_bf16 v[120:123], v[116:119], v[64:67], v[120:123]
  v_bitop3_b32 v48, v48, v64, s57 bitop3:0xf6
  v_bitop3_b32 v48, v48, v66, s57 bitop3:0xf6
  v_and_b32 v48, 1, v48
  v_cmp_ne_u32 vcc, 0, v48
  s_cbranch_vccnz T_p1re_165
T_p1ok_166:
  s_nop 2
  v_add_f32_dpp v120, v120, v120 row_ror:8 row_mask:0xf bank_mask:0xf
  v_add_f32_dpp v121, v121, v121 row_ror:8 row_mask:0xf bank_mask:0xf
  v_cvt_pk_bf16_f32 v48, v120, v121
  v_min_u32 v48, -2, v48
  buffer_store_dword v48, v8, s[4:7], s35 offen sc1
  buffer_store_dword v49, v8, s[4:7], s26 offen sc1
  s_barrier
  ds_read_b128 v[28:31], v2 offset:17408
  ds_read_b128 v[32:35], v2 offset:21504
  ds_read_b128 v[36:39], v2 offset:8192
  ds_read_b128 v[40:43], v2 offset:9216
  ds_read_b128 v[44:47], v2 offset:10240
  ds_read_b128 v[48:51], v2 offset:11264
  buffer_load_dwordx4 v[124:127], v3, s[4:7], s24 offen offset:1024 sc1
  buffer_load_dwordx4 v[116:119], v3, s[4:7], s25 offen offset:1024 sc1
  ds_read_b128 v[52:55], v2 offset:12288
  ds_read_b128 v[56:59], v2 offset:13312
  ds_read_b128 v[60:63], v2 offset:14336
  ds_read_b128 v[64:67], v2 offset:15360
  buffer_load_dwordx4 v[124:127], v3, s[4:7], s24 offen offset:1024 sc1
  buffer_load_dwordx4 v[116:119], v3, s[4:7], s25 offen offset:1024 sc1
  s_mov_b32 s19, 0
  s_branch T_loop_155
T_p1re_165:
  s_mov_b64 exec, vcc
  buffer_load_dwordx4 v[52:55], v2, s[4:7], s22 offen offset:0 sc1
  buffer_load_dwordx4 v[56:59], v2, s[4:7], s22 offen offset:1024 sc1
  buffer_load_dwordx4 v[60:63], v2, s[4:7], s22 offen offset:2048 sc1
  buffer_load_dwordx4 v[64:67], v2, s[4:7], s22 offen offset:3072 sc1
  s_mov_b64 exec, -1
  s_add_u32 s19, s19, 1
  s_cmp_gt_u32 s19, 32768
  s_cbranch_scc1 M_exit
  s_waitcnt vmcnt(3)
  v_mfma_f32_16x16x32_bf16 v[120:123], v[116:119], v[52:55], 0
  v_xor_b32 v48, s57, v52
  v_bitop3_b32 v48, v48, v54, s57 bitop3:0xf6
  s_waitcnt vmcnt(2)
  v_mfma_f32_16x16x32_bf16 v[120:123], v[116:119], v[56:59], v[120:123]
  v_bitop3_b32 v48, v48, v56, s57 bitop3:0xf6
  v_bitop3_b32 v48, v48, v58, s57 bitop3:0xf6
  s_waitcnt vmcnt(1)
  v_mfma_f32_16x16x32_bf16 v[120:123], v[116:119], v[60:63], v[120:123]
  v_bitop3_b32 v48, v48, v60, s57 bitop3:0xf6
  v_bitop3_b32 v48, v48, v62, s57 bitop3:0xf6
  s_waitcnt vmcnt(0)
  v_mfma_f32_16x16x32_bf16 v[120:123], v[116:119], v[64:67], v[120:123]
  v_bitop3_b32 v48, v48, v64, s57 bitop3:0xf6
  v_bitop3_b32 v48, v48, v66, s57 bitop3:0xf6
  v_and_b32 v48, 1, v48
  v_cmp_ne_u32 vcc, 0, v48
  s_cbranch_vccnz T_p1re_165
  s_branch T_p1ok_166
T_kvw_159:
  s_mov_b32 s19, 0
  s_branch T_kvok_168
T_kv_167:
  s_sleep 4
  s_add_u32 s19, s19, 1
  s_cmp_gt_u32 s19, 32768
  s_cbranch_scc1 M_exit
T_kvok_168:
  s_add_u32 s39, s99, 128
  s_mov_b32 s38, 0
  s_mov_b32 s37, 0
  s_atomic_or s38, s[58:59], s99 glc
  s_atomic_or s37, s[58:59], s39 glc
  s_waitcnt lgkmcnt(0)
  s_add_u32 s37, s37, 30
  s_cmp_ge_u32 s38, 30
  s_cselect_b32 s38, s37, s38
  s_cmp_ge_u32 s38, 64
  s_cselect_b32 s38, 100, s38
  s_sub_u32 s38, s38, 1
  s_max_i32 s30, s30, s38
  s_cmp_ge_i32 s14, s30
  s_cbranch_scc1 T_kv_167
  s_branch T_kvb_160
T_slow_162:
  s_nop 7
  v_max3_f32 v100, v16, v17, v18
  v_max3_f32 v100, v100, v19, v20
  v_max3_f32 v100, v100, v21, v22
  v_max3_f32 v100, v100, v23, v112
  v_max3_f32 v100, v100, v113, v114
  v_max_f32 v100, v100, v115
  v_mov_b32 v101, v100
  s_nop 1
  v_permlane32_swap_b32 v100, v101
  s_nop 1
  v_max_f32 v100, v100, v101
  v_mov_b32 v101, v100
  s_nop 1
  v_permlane16_swap_b32 v100, v101
  s_nop 1
  v_max_f32 v100, v100, v101
  v_sub_f32 v16, v16, v100
  v_sub_f32 v17, v17, v100
  v_sub_f32 v18, v18, v100
  v_sub_f32 v19, v19, v100
  v_exp_f32 v16, v16
  v_exp_f32 v17, v17
  v_exp_f32 v18, v18
  v_exp_f32 v19, v19
  v_sub_f32 v20, v20, v100
  v_sub_f32 v21, v21, v100
  v_sub_f32 v22, v22, v100
  v_sub_f32 v23, v23, v100
  v_exp_f32 v20, v20
  v_exp_f32 v21, v21
  v_exp_f32 v22, v22
  v_exp_f32 v23, v23
  v_sub_f32 v112, v112, v100
  v_sub_f32 v113, v113, v100
  v_sub_f32 v114, v114, v100
  v_sub_f32 v115, v115, v100
  v_exp_f32 v112, v112
  v_exp_f32 v113, v113
  v_exp_f32 v114, v114
  v_exp_f32 v115, v115
  s_nop 0
  v_cvt_pk_bf16_f32 v44, v16, v17
  v_cvt_pk_bf16_f32 v45, v18, v19
  v_cvt_pk_bf16_f32 v46, v20, v21
  v_cvt_pk_bf16_f32 v47, v22, v23
  v_cvt_pk_bf16_f32 v84, v112, v113
  v_cvt_pk_bf16_f32 v85, v114, v115
  v_cndmask_b32 v48, v84, 0, s[16:17]
  v_cndmask_b32 v49, v85, 0, s[16:17]
  v_cndmask_b32 v50, 0, v84, s[16:17]
  v_cndmask_b32 v51, 0, v85, s[16:17]
  s_nop 1
  v_mfma_f32_16x16x16_bf16 v[88:91], v[12:13], v[48:49], 0
  v_mfma_f32_16x16x16_bf16 v[24:27], v[120:121], v[48:49], 0
  v_mfma_f32_16x16x16_bf16 v[116:119], v[120:121], v[50:51], 0
  v_mfma_f32_16x16x32_bf16 v[88:91], v[12:15], v[44:47], v[88:91]
  v_mfma_f32_16x16x32_bf16 v[24:27], v[28:31], v[44:47], v[24:27]
  v_mfma_f32_16x16x32_bf16 v[116:119], v[32:35], v[44:47], v[116:119]
  s_nop 7
  s_nop 1
  v_rcp_f32 v89, v88
  s_nop 0
  v_mul_f32 v24, v89, v24
  v_mul_f32 v25, v89, v25
  s_branch T_back_163
T_w_139:
  s_mov_b32 s19, 0
  v_mov_b64 v[16:17], 0
  v_mov_b64 v[18:19], 0
  v_mov_b64 v[20:21], 0
  v_mov_b64 v[22:23], 0
  v_mov_b64 v[24:25], 0
  v_mov_b64 v[26:27], 0
  buffer_load_dwordx4 v[124:127], v3, s[4:7], s24 offen offset:2048 sc1
  buffer_load_dwordx4 v[116:119], v3, s[4:7], s25 offen offset:2048 sc1
  buffer_load_dwordx4 v[124:127], v3, s[4:7], s24 offen offset:2048 sc1
  buffer_load_dwordx4 v[116:119], v3, s[4:7], s25 offen offset:2048 sc1
  s_branch T_loop_169
.p2align 6
T_retry_170:
  s_mov_b64 exec, vcc
  buffer_load_dwordx4 v[124:127], v3, s[4:7], s24 offen offset:2048 sc1
  buffer_load_dwordx4 v[116:119], v3, s[4:7], s25 offen offset:2048 sc1
  s_mov_b64 exec, -1
  s_add_u32 s19, s19, 1
  s_cmp_gt_u32 s19, 32768
  s_cbranch_scc1 M_exit
T_loop_169:
  s_waitcnt vmcnt(3) lgkmcnt(0)
  v_max3_u32 v123, v124, v125, v126
  v_max_u32 v123, v123, v127
  v_mov_b32_dpp v120, v124 row_ror:8 row_mask:0xf bank_mask:0xf
  v_mov_b32_dpp v121, v125 row_ror:8 row_mask:0xf bank_mask:0xf
  s_waitcnt vmcnt(2)
  v_max3_u32 v123, v123, v116, v117
  v_max3_u32 v123, v123, v118, v119
  v_cmp_eq_u32 vcc, -1, v123
  s_cbranch_vccnz T_retry_170
  v_smfmac_f32_16x16x64_bf16 v[16:19], v[124:127], v[68:75], v0
  s_add_u32 s14, s14, 1
  ds_write_b128 v2, v[124:127] offset:2048
  v_mov_b32_dpp v122, v126 row_ror:8 row_mask:0xf bank_mask:0xf
  v_smfmac_f32_16x16x64_bf16 v[20:23], v[124:127], v[76:83], v0
  s_and_b32 s57, s14, 1
  v_mov_b32_dpp v123, v127 row_ror:8 row_mask:0xf bank_mask:0xf
  v_smfmac_f32_16x16x64_bf16 v[24:27], v[124:127], v[84:91], v0
  s_and_b32 s36, s14, 3
  ds_write_b128 v2, v[116:119] offset:6144
  v_smfmac_f32_16x16x64_bf16 v[16:19], v[120:123], v[92:99], v0
  s_lshl_b32 s36, s36, 13
  v_mov_b32_dpp v84, v116 row_ror:8 row_mask:0xf bank_mask:0xf
  v_smfmac_f32_16x16x64_bf16 v[20:23], v[120:123], v[100:107], v0
  s_add_u32 s26, s36, s23
  ds_read_b128 v[68:71], v4 offset:12288
  v_mov_b32_dpp v85, v117 row_ror:8 row_mask:0xf bank_mask:0xf
  v_smfmac_f32_16x16x64_bf16 v[24:27], v[120:123], v[108:115], v0
  s_add_u32 s36, s36, 8192
  ds_read_b128 v[72:75], v4 offset:13312
  v_mov_b32_dpp v86, v118 row_ror:8 row_mask:0xf bank_mask:0xf
  v_smfmac_f32_16x16x64_bf16 v[16:19], v[116:119], v[224:231], v0
  s_and_b32 s36, s36, 0x7fff
  ds_read_b128 v[76:79], v4 offset:14336
  v_mov_b32_dpp v87, v119 row_ror:8 row_mask:0xf bank_mask:0xf
  v_smfmac_f32_16x16x64_bf16 v[20:23], v[116:119], v[240:247], v0
  s_waitcnt lgkmcnt(3)
  s_barrier
  ds_read_b128 v[100:103], v2 offset:3072
  v_smfmac_f32_16x16x64_bf16 v[24:27], v[116:119], a[0:7], v0
  s_mov_b32 m0, s31
  ds_read_b128 v[120:123], v1 offset:3072
  v_smfmac_f32_16x16x64_bf16 v[16:19], v[84:87], v[232:239], v0
  s_cmp_ge_i32 s14, s30
  s_cbranch_scc1 T_kvw_173
T_kvb_174:
  v_smfmac_f32_16x16x64_bf16 v[20:23], v[84:87], v[248:255], v0
  ds_read_b128 v[80:83], v4 offset:15360
  v_smfmac_f32_16x16x64_bf16 v[24:27], v[84:87], a[8:15], v0
  s_waitcnt lgkmcnt(2)
  v_smfmac_f32_16x16x64_bf16 v[16:19], v[100:103], v[128:135], v0
  ds_read_b128 v[92:95], v2 offset:0
  buffer_load_dwordx4 v9, s[4:7], s27 offen sc1 lds
  v_smfmac_f32_16x16x64_bf16 v[20:23], v[100:103], v[144:151], v0
  ds_read_b128 v[96:99], v1 offset:0
  s_mov_b32 m0, s32
  v_smfmac_f32_16x16x64_bf16 v[24:27], v[100:103], v[68:75], v0
  s_waitcnt vmcnt(1) lgkmcnt(3)
  ds_read_b128 v[116:119], v2 offset:1024
  v_smfmac_f32_16x16x64_bf16 v[16:19], v[120:123], v[136:143], v0
  ds_read_b128 v[124:127], v1 offset:1024
  v_smfmac_f32_16x16x64_bf16 v[20:23], v[120:123], v[152:159], v0
  s_waitcnt lgkmcnt(4)
  ds_read_b128 v[104:107], v2 offset:7168
  buffer_load_dwordx4 v9, s[4:7], s27 offen offset:128 sc1 lds
  v_smfmac_f32_16x16x64_bf16 v[24:27], v[120:123], v[76:83], v0
  s_waitcnt lgkmcnt(4)
  ds_read_b128 v[108:111], v1 offset:7168
  s_mov_b32 m0, s33
  v_smfmac_f32_16x16x64_bf16 v[16:19], v[92:95], v[160:167], v0
  s_waitcnt lgkmcnt(4)
  ds_read_b128 v[112:115], v2 offset:4096
  v_mov_b32 v122, s98
  v_smfmac_f32_16x16x64_bf16 v[16:19], v[96:99], v[168:175], v0
  s_waitcnt lgkmcnt(4)
  ds_read_b128 v[84:87], v1 offset:4096
  v_smfmac_f32_16x16x64_bf16 v[16:19], v[116:119], v[192:199], v0
  s_waitcnt lgkmcnt(4)
  ds_read_b128 v[88:91], v2 offset:5120
  buffer_load_dwordx4 v10, s[4:7], s28 offen sc1 lds
  v_smfmac_f32_16x16x64_bf16 v[16:19], v[124:127], v[200:207], v0
  s_waitcnt lgkmcnt(4)
  ds_read_b128 v[100:103], v1 offset:5120
  s_mov_b32 m0, s34
  v_smfmac_f32_16x16x64_bf16 v[16:19], v[104:107], a[16:23], v0
  s_waitcnt lgkmcnt(4)
  ds_read_b128 v[68:71], v4 offset:16384
  v_smfmac_f32_16x16x64_bf16 v[16:19], v[108:111], a[24:31], v0
  s_waitcnt lgkmcnt(4)
  ds_read_b128 v[72:75], v4 offset:17408
  v_smfmac_f32_16x16x64_bf16 v[16:19], v[112:115], a[64:71], v0
  s_waitcnt lgkmcnt(4)
  ds_read_b128 v[76:79], v4 offset:18432
  buffer_load_dwordx4 v10, s[4:7], s28 offen offset:256 sc1 lds
  v_smfmac_f32_16x16x64_bf16 v[16:19], v[84:87], a[72:79], v0
  s_waitcnt lgkmcnt(4)
  ds_read_b128 v[80:83], v4 offset:19456
  v_smfmac_f32_16x16x64_bf16 v[16:19], v[88:91], a[112:119], v0
  s_waitcnt lgkmcnt(4)
  v_smfmac_f32_16x16x64_bf16 v[16:19], v[100:103], a[120:127], v0
  s_add_u32 s24, s36, 145752064
  s_add_u32 s25, s36, 145756160
  v_smfmac_f32_16x16x64_bf16 v[20:23], v[92:95], v[176:183], v0
  buffer_store_dword v122, v8, s[4:7], s15 offen sc1
  s_add_u32 s35, s36, s23
  v_smfmac_f32_16x16x64_bf16 v[20:23], v[96:99], v[184:191], v0
  s_waitcnt lgkmcnt(2)
  s_add_u32 s98, s14, 1
  v_smfmac_f32_16x16x64_bf16 v[20:23], v[116:119], v[68:75], v0
  s_waitcnt lgkmcnt(0)
  ds_read_b128 v[68:71], v4 offset:20480
  v_mul_f32 v16, s18, v16
  v_smfmac_f32_16x16x64_bf16 v[20:23], v[124:127], v[76:83], v0
  ds_read_b128 v[72:75], v4 offset:21504
  v_mul_f32 v17, s18, v17
  v_smfmac_f32_16x16x64_bf16 v[20:23], v[104:107], a[32:39], v0
  ds_read_b128 v[76:79], v4 offset:22528
  v_mul_f32 v18, s18, v18
  v_smfmac_f32_16x16x64_bf16 v[20:23], v[108:111], a[40:47], v0
  ds_read_b128 v[80:83], v4 offset:23552
  v_mul_f32 v19, s18, v19
  v_smfmac_f32_16x16x64_bf16 v[20:23], v[112:115], a[80:87], v0
  v_cvt_pk_bf16_f32 v120, v16, v17
  v_smfmac_f32_16x16x64_bf16 v[20:23], v[84:87], a[88:95], v0
  v_cvt_pk_bf16_f32 v121, v18, v19
  v_smfmac_f32_16x16x64_bf16 v[20:23], v[88:91], a[128:135], v0
  ds_write_b64 v5, v[120:121] offset:24576
  v_smfmac_f32_16x16x64_bf16 v[20:23], v[100:103], a[136:143], v0
  s_waitcnt lgkmcnt(3)
  v_smfmac_f32_16x16x64_bf16 v[24:27], v[92:95], v[68:75], v0
  s_waitcnt lgkmcnt(1)
  v_mov_b64 v[92:93], 0
  v_smfmac_f32_16x16x64_bf16 v[24:27], v[96:99], v[76:83], v0
  s_nop 1
  v_cvt_pk_bf16_f32 v122, v20, v21
  v_cvt_pk_bf16_f32 v123, v22, v23
  v_smfmac_f32_16x16x64_bf16 v[24:27], v[116:119], v[208:215], v0
  ds_write_b64 v5, v[122:123] offset:26880
  v_mov_b64 v[94:95], 0
  v_smfmac_f32_16x16x64_bf16 v[24:27], v[124:127], v[216:223], v0
  s_waitcnt lgkmcnt(1)
  s_barrier
  ds_read_b64_tr_b16 v[68:69], v6 offset:24576
  v_smfmac_f32_16x16x64_bf16 v[24:27], v[104:107], a[48:55], v0
  s_add_u32 s27, s27, 8192
  ds_read_b64_tr_b16 v[70:71], v6 offset:24640
  ds_read_b64_tr_b16 v[72:73], v6 offset:24832
  v_smfmac_f32_16x16x64_bf16 v[24:27], v[108:111], a[56:63], v0
  s_add_u32 s28, s28, 8192
  ds_read_b64_tr_b16 v[74:75], v6 offset:24896
  ds_read_b64_tr_b16 v[76:77], v6 offset:25088
  v_smfmac_f32_16x16x64_bf16 v[24:27], v[112:115], a[96:103], v0
  s_nop 0
  ds_read_b64_tr_b16 v[78:79], v6 offset:25152
  ds_read_b64_tr_b16 v[80:81], v6 offset:25344
  v_smfmac_f32_16x16x64_bf16 v[24:27], v[84:87], a[104:111], v0
  ds_read_b64_tr_b16 v[82:83], v6 offset:25408
  v_mov_b64 v[96:97], 0
  v_smfmac_f32_16x16x64_bf16 v[24:27], v[88:91], a[144:151], v0
  s_waitcnt lgkmcnt(8)
  s_barrier
  ds_read_b64_tr_b16 v[116:117], v6 offset:26880
  v_smfmac_f32_16x16x64_bf16 v[24:27], v[100:103], a[152:159], v0
  s_waitcnt lgkmcnt(7)
  ds_read_b64_tr_b16 v[118:119], v6 offset:26944
  v_mfma_f32_16x16x32_bf16 v[16:19], v[36:39], v[68:71], 0
  s_waitcnt lgkmcnt(6)
  ds_read_b64_tr_b16 v[124:125], v6 offset:27136
  ds_read_b64_tr_b16 v[126:127], v6 offset:27200
  v_mfma_f32_16x16x32_bf16 v[16:19], v[40:43], v[72:75], v[16:19]
  s_waitcnt lgkmcnt(6)
  ds_read_b64_tr_b16 v[104:105], v6 offset:27392
  ds_read_b64_tr_b16 v[106:107], v6 offset:27456
  v_mfma_f32_16x16x32_bf16 v[16:19], v[44:47], v[76:79], v[16:19]
  s_waitcnt lgkmcnt(6)
  ds_read_b64_tr_b16 v[108:109], v6 offset:27648
  ds_read_b64_tr_b16 v[110:111], v6 offset:27712
  v_mfma_f32_16x16x32_bf16 v[16:19], v[48:51], v[80:83], v[16:19]
  s_waitcnt lgkmcnt(6)
  v_cvt_pk_bf16_f32 v120, v24, v25
  v_cvt_pk_bf16_f32 v121, v26, v27
  v_mfma_f32_16x16x32_bf16 v[112:115], v[116:119], v[68:71], 0
  s_waitcnt lgkmcnt(4)
  buffer_store_dwordx4 v[120:123], v2, s[4:7], s29 offen offset:2048 sc1
  v_mov_b64 v[98:99], 0
  v_mfma_f32_16x16x32_bf16 v[112:115], v[124:127], v[72:75], v[112:115]
  s_waitcnt lgkmcnt(2)
  v_mov_b64 v[36:37], 0
  v_exp_f32 v100, v16
  v_mfma_f32_16x16x32_bf16 v[112:115], v[104:107], v[76:79], v[112:115]
  s_waitcnt lgkmcnt(0)
  v_exp_f32 v101, v17
  v_mfma_f32_16x16x32_bf16 v[112:115], v[108:111], v[80:83], v[112:115]
  s_add_u32 s29, s29, 131072
  v_exp_f32 v102, v18
  v_mfma_f32_16x16x32_bf16 v[20:23], v[52:55], v[68:71], 0
  s_cmp_eq_u32 s14, 63
  v_exp_f32 v103, v19
  v_mfma_f32_16x16x32_bf16 v[20:23], v[56:59], v[72:75], v[20:23]
  s_cbranch_scc1 M_tdone
  v_cvt_pk_bf16_f32 v44, v100, v101
  v_cvt_pk_bf16_f32 v45, v102, v103
  v_mfma_f32_16x16x32_bf16 v[20:23], v[60:63], v[76:79], v[20:23]
  v_exp_f32 v100, v112
  v_mfma_f32_16x16x32_bf16 v[20:23], v[64:67], v[80:83], v[20:23]
  v_exp_f32 v101, v113
  v_exp_f32 v102, v114
  v_exp_f32 v103, v115
  v_cvt_pk_bf16_f32 v84, v100, v101
  v_cvt_pk_bf16_f32 v85, v102, v103
  v_cndmask_b32 v48, v84, 0, s[16:17]
  v_cndmask_b32 v49, v85, 0, s[16:17]
  v_cndmask_b32 v50, 0, v84, s[16:17]
  v_cndmask_b32 v51, 0, v85, s[16:17]
  v_exp_f32 v100, v20
  v_mfma_f32_16x16x16_bf16 v[88:91], v[12:13], v[48:49], 0
  v_exp_f32 v101, v21
  v_mfma_f32_16x16x16_bf16 v[24:27], v[120:121], v[48:49], 0
  v_exp_f32 v102, v22
  v_mfma_f32_16x16x16_bf16 v[116:119], v[120:121], v[50:51], 0
  v_exp_f32 v103, v23
  v_cvt_pk_bf16_f32 v46, v100, v101
  v_cvt_pk_bf16_f32 v47, v102, v103
  v_mov_b64 v[38:39], 0
  s_nop 0
  v_mfma_f32_16x16x32_bf16 v[88:91], v[12:15], v[44:47], v[88:91]
  v_mov_b64 v[40:41], 0
  v_mov_b64 v[42:43], 0
  v_mfma_f32_16x16x32_bf16 v[24:27], v[28:31], v[44:47], v[24:27]
  ds_read_b128 v[52:55], v4 offset:24576
  ds_read_b128 v[56:59], v4 offset:25600
  v_mfma_f32_16x16x32_bf16 v[116:119], v[32:35], v[44:47], v[116:119]
  s_nop 1
  v_rcp_f32 v89, v88
  v_subrev_u32 v100, s54, v88
  v_cmp_le_u32 vcc, s55, v100
  v_mul_f32 v24, v89, v24
  v_mul_f32 v25, v89, v25
  s_cbranch_vccnz T_slow_176
T_back_177:
  v_cvt_pk_bf16_f32 v124, v24, v25
  v_pk_mul_f32 v[26:27], v[26:27], v[88:89] op_sel:[0,1] op_sel_hi:[1,1]
  v_pk_mul_f32 v[116:117], v[116:117], v[88:89] op_sel:[0,1] op_sel_hi:[1,1]
  v_pk_mul_f32 v[118:119], v[118:119], v[88:89] op_sel:[0,1] op_sel_hi:[1,1]
  v_cvt_pk_bf16_f32 v125, v26, v27
  v_cvt_pk_bf16_f32 v126, v116, v117
  v_cvt_pk_bf16_f32 v127, v118, v119
  ds_write_b128 v11, v[124:127] offset:30208
  s_nop 0
  v_smfmac_f32_16x16x64_bf16 v[92:95], v[124:127], a[160:167], v0
  v_smfmac_f32_16x16x64_bf16 v[96:99], v[124:127], a[168:175], v0
  v_smfmac_f32_16x16x64_bf16 v[36:39], v[124:127], a[176:183], v0
  v_smfmac_f32_16x16x64_bf16 v[40:43], v[124:127], a[184:191], v0
  s_waitcnt lgkmcnt(0)
  s_barrier
  ds_read_b128 v[104:107], v11 offset:30720
  ds_read_b128 v[108:111], v11 offset:29184
  ds_read_b128 v[68:71], v11 offset:29696
  s_waitcnt lgkmcnt(2)
  v_smfmac_f32_16x16x64_bf16 v[92:95], v[104:107], a[192:199], v0
  s_waitcnt lgkmcnt(1)
  ds_read_b128 v[76:79], v4 offset:28672
  v_smfmac_f32_16x16x64_bf16 v[92:95], v[108:111], a[224:231], v0
  s_waitcnt lgkmcnt(1)
  ds_read_b128 v[80:83], v4 offset:29696
  v_smfmac_f32_16x16x64_bf16 v[92:95], v[68:71], a[240:247], v0
  ds_read_b128 v[60:63], v4 offset:26624
  v_smfmac_f32_16x16x64_bf16 v[96:99], v[104:107], a[200:207], v0
  ds_read_b128 v[64:67], v4 offset:27648
  v_smfmac_f32_16x16x64_bf16 v[96:99], v[108:111], a[232:239], v0
  ds_read_b128 v[28:31], v4 offset:30720
  s_nop 0
  v_cvt_pk_bf16_f32 v16, v92, v93
  v_cvt_pk_bf16_f32 v17, v94, v95
  v_bfi_b32 v16, 1, s57, v16
  v_smfmac_f32_16x16x64_bf16 v[96:99], v[68:71], a[248:255], v0
  buffer_store_dwordx2 v[16:17], v7, s[4:7], s20 offen offset:0 sc1
  v_smfmac_f32_16x16x64_bf16 v[36:39], v[104:107], a[208:215], v0
  ds_read_b128 v[32:35], v4 offset:31744
  v_smfmac_f32_16x16x64_bf16 v[36:39], v[108:111], v[52:59], v0
  s_waitcnt lgkmcnt(4)
  s_nop 0
  v_cvt_pk_bf16_f32 v18, v96, v97
  v_cvt_pk_bf16_f32 v19, v98, v99
  v_bfi_b32 v18, 1, s57, v18
  v_smfmac_f32_16x16x64_bf16 v[36:39], v[68:71], v[76:83], v0
  buffer_store_dwordx2 v[18:19], v7, s[4:7], s20 offen offset:64 sc1
  v_smfmac_f32_16x16x64_bf16 v[40:43], v[104:107], a[216:223], v0
  s_waitcnt lgkmcnt(2)
  v_smfmac_f32_16x16x64_bf16 v[40:43], v[108:111], v[60:67], v0
  s_waitcnt lgkmcnt(0)
  s_nop 0
  v_cvt_pk_bf16_f32 v20, v36, v37
  v_cvt_pk_bf16_f32 v21, v38, v39
  v_bfi_b32 v20, 1, s57, v20
  v_smfmac_f32_16x16x64_bf16 v[40:43], v[68:71], v[28:35], v0
  buffer_store_dwordx2 v[20:21], v7, s[4:7], s21 offen offset:0 sc1
  s_nop 6
  v_cvt_pk_bf16_f32 v22, v40, v41
  v_cvt_pk_bf16_f32 v23, v42, v43
  v_bfi_b32 v22, 1, s57, v22
  buffer_store_dwordx2 v[22:23], v7, s[4:7], s21 offen offset:64 sc1
  ds_read_b128 v[68:71], v4 offset:0
  ds_read_b128 v[72:75], v4 offset:1024
  ds_read_b128 v[76:79], v4 offset:4096
  ds_read_b128 v[80:83], v4 offset:5120
  ds_read_b128 v[84:87], v4 offset:8192
  ds_read_b128 v[88:91], v4 offset:9216
  ds_read_b128 v[92:95], v4 offset:2048
  ds_read_b128 v[96:99], v4 offset:3072
  ds_read_b128 v[100:103], v4 offset:6144
  ds_read_b128 v[104:107], v4 offset:7168
  ds_read_b128 v[108:111], v4 offset:10240
  ds_read_b128 v[112:115], v4 offset:11264
  v_mov_b64 v[16:17], 0
  v_mov_b64 v[18:19], 0
  v_mov_b64 v[20:21], 0
  v_mov_b64 v[22:23], 0
  v_mov_b64 v[24:25], 0
  v_mov_b64 v[26:27], 0
  ds_read_b64 v[44:45], v2 offset:32256
  s_waitcnt lgkmcnt(0)
  v_readfirstlane_b32 s38, v44
  v_readfirstlane_b32 s37, v45
  s_nop 0
  s_add_u32 s37, s37, 30
  s_cmp_ge_u32 s38, 30
  s_cselect_b32 s38, s37, s38
  s_cmp_ge_u32 s38, 64
  s_cselect_b32 s38, 100, s38
  s_sub_u32 s38, s38, 1
  s_max_i32 s30, s30, s38
  s_waitcnt vmcnt(4)
  s_barrier
  ds_read_b128 v[28:31], v2 offset:18432
  ds_read_b128 v[32:35], v2 offset:22528
  ds_read_b128 v[36:39], v2 offset:8192
  ds_read_b128 v[40:43], v2 offset:9216
  ds_read_b128 v[44:47], v2 offset:10240
  ds_read_b128 v[48:51], v2 offset:11264
  buffer_load_dwordx4 v[124:127], v3, s[4:7], s24 offen offset:2048 sc1
  buffer_load_dwordx4 v[116:119], v3, s[4:7], s25 offen offset:2048 sc1
  ds_read_b128 v[52:55], v2 offset:12288
  ds_read_b128 v[56:59], v2 offset:13312
  ds_read_b128 v[60:63], v2 offset:14336
  ds_read_b128 v[64:67], v2 offset:15360
  buffer_load_dwordx4 v[124:127], v3, s[4:7], s24 offen offset:2048 sc1
  buffer_load_dwordx4 v[116:119], v3, s[4:7], s25 offen offset:2048 sc1
  s_mov_b32 s19, 0
  s_branch T_loop_169
T_kvw_173:
  s_mov_b32 s19, 0
  s_branch T_kvok_182
T_kv_181:
  s_sleep 4
  s_add_u32 s19, s19, 1
  s_cmp_gt_u32 s19, 32768
  s_cbranch_scc1 M_exit
T_kvok_182:
  s_add_u32 s39, s99, 128
  s_mov_b32 s38, 0
  s_mov_b32 s37, 0
  s_atomic_or s38, s[58:59], s99 glc
  s_atomic_or s37, s[58:59], s39 glc
  s_waitcnt lgkmcnt(0)
  s_add_u32 s37, s37, 30
  s_cmp_ge_u32 s38, 30
  s_cselect_b32 s38, s37, s38
  s_cmp_ge_u32 s38, 64
  s_cselect_b32 s38, 100, s38
  s_sub_u32 s38, s38, 1
  s_max_i32 s30, s30, s38
  s_cmp_ge_i32 s14, s30
  s_cbranch_scc1 T_kv_181
  s_branch T_kvb_174
T_slow_176:
  s_nop 7
  v_max3_f32 v100, v16, v17, v18
  v_max3_f32 v100, v100, v19, v20
  v_max3_f32 v100, v100, v21, v22
  v_max3_f32 v100, v100, v23, v112
  v_max3_f32 v100, v100, v113, v114
  v_max_f32 v100, v100, v115
  v_mov_b32 v101, v100
  s_nop 1
  v_permlane32_swap_b32 v100, v101
  s_nop 1
  v_max_f32 v100, v100, v101
  v_mov_b32 v101, v100
  s_nop 1
  v_permlane16_swap_b32 v100, v101
  s_nop 1
  v_max_f32 v100, v100, v101
  v_sub_f32 v16, v16, v100
  v_sub_f32 v17, v17, v100
  v_sub_f32 v18, v18, v100
  v_sub_f32 v19, v19, v100
  v_exp_f32 v16, v16
  v_exp_f32 v17, v17
  v_exp_f32 v18, v18
  v_exp_f32 v19, v19
  v_sub_f32 v20, v20, v100
  v_sub_f32 v21, v21, v100
  v_sub_f32 v22, v22, v100
  v_sub_f32 v23, v23, v100
  v_exp_f32 v20, v20
  v_exp_f32 v21, v21
  v_exp_f32 v22, v22
  v_exp_f32 v23, v23
  v_sub_f32 v112, v112, v100
  v_sub_f32 v113, v113, v100
  v_sub_f32 v114, v114, v100
  v_sub_f32 v115, v115, v100
  v_exp_f32 v112, v112
  v_exp_f32 v113, v113
  v_exp_f32 v114, v114
  v_exp_f32 v115, v115
  s_nop 0
  v_cvt_pk_bf16_f32 v44, v16, v17
  v_cvt_pk_bf16_f32 v45, v18, v19
  v_cvt_pk_bf16_f32 v46, v20, v21
  v_cvt_pk_bf16_f32 v47, v22, v23
  v_cvt_pk_bf16_f32 v84, v112, v113
  v_cvt_pk_bf16_f32 v85, v114, v115
  v_cndmask_b32 v48, v84, 0, s[16:17]
  v_cndmask_b32 v49, v85, 0, s[16:17]
  v_cndmask_b32 v50, 0, v84, s[16:17]
  v_cndmask_b32 v51, 0, v85, s[16:17]
  s_nop 1
  v_mfma_f32_16x16x16_bf16 v[88:91], v[12:13], v[48:49], 0
  v_mfma_f32_16x16x16_bf16 v[24:27], v[120:121], v[48:49], 0
  v_mfma_f32_16x16x16_bf16 v[116:119], v[120:121], v[50:51], 0
  v_mfma_f32_16x16x32_bf16 v[88:91], v[12:15], v[44:47], v[88:91]
  v_mfma_f32_16x16x32_bf16 v[24:27], v[28:31], v[44:47], v[24:27]
  v_mfma_f32_16x16x32_bf16 v[116:119], v[32:35], v[44:47], v[116:119]
  s_nop 7
  s_nop 1
  v_rcp_f32 v89, v88
  s_nop 0
  v_mul_f32 v24, v89, v24
  v_mul_f32 v25, v89, v25
  s_branch T_back_177
T_w_140:
  s_mov_b32 s19, 0
  v_mov_b64 v[16:17], 0
  v_mov_b64 v[18:19], 0
  v_mov_b64 v[20:21], 0
  v_mov_b64 v[22:23], 0
  v_mov_b64 v[24:25], 0
  v_mov_b64 v[26:27], 0
  buffer_load_dwordx4 v[124:127], v3, s[4:7], s24 offen offset:3072 sc1
  buffer_load_dwordx4 v[116:119], v3, s[4:7], s25 offen offset:3072 sc1
  buffer_load_dwordx4 v[124:127], v3, s[4:7], s24 offen offset:3072 sc1
  buffer_load_dwordx4 v[116:119], v3, s[4:7], s25 offen offset:3072 sc1
  s_branch T_loop_183
.p2align 6
T_retry_184:
  s_mov_b64 exec, vcc
  buffer_load_dwordx4 v[124:127], v3, s[4:7], s24 offen offset:3072 sc1
  buffer_load_dwordx4 v[116:119], v3, s[4:7], s25 offen offset:3072 sc1
  s_mov_b64 exec, -1
  s_add_u32 s19, s19, 1
  s_cmp_gt_u32 s19, 32768
  s_cbranch_scc1 M_exit
T_loop_183:
  s_waitcnt vmcnt(3) lgkmcnt(0)
  v_max3_u32 v123, v124, v125, v126
  v_max_u32 v123, v123, v127
  v_mov_b32_dpp v120, v124 row_ror:8 row_mask:0xf bank_mask:0xf
  v_mov_b32_dpp v121, v125 row_ror:8 row_mask:0xf bank_mask:0xf
  s_waitcnt vmcnt(2)
  v_max3_u32 v123, v123, v116, v117
  v_max3_u32 v123, v123, v118, v119
  v_cmp_eq_u32 vcc, -1, v123
  s_cbranch_vccnz T_retry_184
  v_smfmac_f32_16x16x64_bf16 v[16:19], v[124:127], v[68:75], v0
  s_add_u32 s14, s14, 1
  ds_write_b128 v2, v[124:127] offset:3072
  v_mov_b32_dpp v122, v126 row_ror:8 row_mask:0xf bank_mask:0xf
  v_smfmac_f32_16x16x64_bf16 v[20:23], v[124:127], v[76:83], v0
  s_and_b32 s57, s14, 1
  v_mov_b32_dpp v123, v127 row_ror:8 row_mask:0xf bank_mask:0xf
  v_smfmac_f32_16x16x64_bf16 v[24:27], v[124:127], v[84:91], v0
  s_and_b32 s36, s14, 3
  ds_write_b128 v2, v[116:119] offset:7168
  v_smfmac_f32_16x16x64_bf16 v[16:19], v[120:123], v[92:99], v0
  s_lshl_b32 s36, s36, 13
  v_mov_b32_dpp v84, v116 row_ror:8 row_mask:0xf bank_mask:0xf
  v_smfmac_f32_16x16x64_bf16 v[20:23], v[120:123], v[100:107], v0
  s_add_u32 s26, s36, s23
  ds_read_b128 v[68:71], v4 offset:12288
  v_mov_b32_dpp v85, v117 row_ror:8 row_mask:0xf bank_mask:0xf
  v_smfmac_f32_16x16x64_bf16 v[24:27], v[120:123], v[108:115], v0
  s_add_u32 s36, s36, 8192
  ds_read_b128 v[72:75], v4 offset:13312
  v_mov_b32_dpp v86, v118 row_ror:8 row_mask:0xf bank_mask:0xf
  v_smfmac_f32_16x16x64_bf16 v[16:19], v[116:119], v[224:231], v0
  s_and_b32 s36, s36, 0x7fff
  ds_read_b128 v[76:79], v4 offset:14336
  v_mov_b32_dpp v87, v119 row_ror:8 row_mask:0xf bank_mask:0xf
  v_smfmac_f32_16x16x64_bf16 v[20:23], v[116:119], v[240:247], v0
  s_waitcnt lgkmcnt(3)
  s_barrier
  ds_read_b128 v[100:103], v2 offset:2048
  v_smfmac_f32_16x16x64_bf16 v[24:27], v[116:119], a[0:7], v0
  s_mov_b32 m0, s31
  ds_read_b128 v[120:123], v1 offset:2048
  v_smfmac_f32_16x16x64_bf16 v[16:19], v[84:87], v[232:239], v0
  s_cmp_ge_i32 s14, s30
  s_cbranch_scc1 T_kvw_187
T_kvb_188:
  v_smfmac_f32_16x16x64_bf16 v[20:23], v[84:87], v[248:255], v0
  ds_read_b128 v[80:83], v4 offset:15360
  v_smfmac_f32_16x16x64_bf16 v[24:27], v[84:87], a[8:15], v0
  s_waitcnt lgkmcnt(2)
  v_smfmac_f32_16x16x64_bf16 v[16:19], v[100:103], v[128:135], v0
  ds_read_b128 v[92:95], v2 offset:1024
  v_smfmac_f32_16x16x64_bf16 v[20:23], v[100:103], v[144:151], v0
  ds_read_b128 v[96:99], v1 offset:1024
  buffer_load_dwordx4 v9, s[4:7], s27 offen sc1 lds
  v_smfmac_f32_16x16x64_bf16 v[24:27], v[100:103], v[68:75], v0
  s_waitcnt vmcnt(1) lgkmcnt(3)
  ds_read_b128 v[116:119], v2 offset:0
  s_mov_b32 m0, s32
  v_smfmac_f32_16x16x64_bf16 v[16:19], v[120:123], v[136:143], v0
  ds_read_b128 v[124:127], v1 offset:0
  v_smfmac_f32_16x16x64_bf16 v[20:23], v[120:123], v[152:159], v0
  s_waitcnt lgkmcnt(4)
  ds_read_b128 v[104:107], v2 offset:6144
  v_smfmac_f32_16x16x64_bf16 v[24:27], v[120:123], v[76:83], v0
  s_waitcnt lgkmcnt(4)
  ds_read_b128 v[108:111], v1 offset:6144
  buffer_load_dwordx4 v9, s[4:7], s27 offen offset:128 sc1 lds
  v_smfmac_f32_16x16x64_bf16 v[16:19], v[92:95], v[160:167], v0
  s_waitcnt lgkmcnt(4)
  ds_read_b128 v[112:115], v2 offset:5120
  s_mov_b32 m0, s33
  v_smfmac_f32_16x16x64_bf16 v[16:19], v[96:99], v[168:175], v0
  s_waitcnt lgkmcnt(4)
  ds_read_b128 v[84:87], v1 offset:5120
  v_smfmac_f32_16x16x64_bf16 v[16:19], v[116:119], v[192:199], v0
  s_waitcnt lgkmcnt(4)
  ds_read_b128 v[88:91], v2 offset:4096
  v_smfmac_f32_16x16x64_bf16 v[16:19], v[124:127], v[200:207], v0
  s_waitcnt lgkmcnt(4)
  ds_read_b128 v[100:103], v1 offset:4096
  buffer_load_dwordx4 v10, s[4:7], s28 offen sc1 lds
  v_smfmac_f32_16x16x64_bf16 v[16:19], v[104:107], a[16:23], v0
  s_waitcnt lgkmcnt(4)
  ds_read_b128 v[68:71], v4 offset:16384
  s_mov_b32 m0, s34
  v_smfmac_f32_16x16x64_bf16 v[16:19], v[108:111], a[24:31], v0
  s_waitcnt lgkmcnt(4)
  ds_read_b128 v[72:75], v4 offset:17408
  v_smfmac_f32_16x16x64_bf16 v[16:19], v[112:115], a[64:71], v0
  s_waitcnt lgkmcnt(4)
  ds_read_b128 v[76:79], v4 offset:18432
  v_smfmac_f32_16x16x64_bf16 v[16:19], v[84:87], a[72:79], v0
  s_waitcnt lgkmcnt(4)
  ds_read_b128 v[80:83], v4 offset:19456
  buffer_load_dwordx4 v10, s[4:7], s28 offen offset:256 sc1 lds
  v_smfmac_f32_16x16x64_bf16 v[16:19], v[88:91], a[112:119], v0
  s_waitcnt lgkmcnt(4)
  s_mov_b32 m0, 32256
  v_smfmac_f32_16x16x64_bf16 v[16:19], v[100:103], a[120:127], v0
  s_add_u32 s24, s36, 145752064
  s_add_u32 s25, s36, 145756160
  v_smfmac_f32_16x16x64_bf16 v[20:23], v[92:95], v[176:183], v0
  s_add_u32 s35, s36, s23
  v_smfmac_f32_16x16x64_bf16 v[20:23], v[96:99], v[184:191], v0
  s_waitcnt lgkmcnt(2)
  buffer_load_dword v8, s[4:7], s99 offen sc1 lds
  v_smfmac_f32_16x16x64_bf16 v[20:23], v[116:119], v[68:75], v0
  s_waitcnt lgkmcnt(0)
  ds_read_b128 v[68:71], v4 offset:20480
  v_mul_f32 v16, s18, v16
  v_smfmac_f32_16x16x64_bf16 v[20:23], v[124:127], v[76:83], v0
  ds_read_b128 v[72:75], v4 offset:21504
  v_mul_f32 v17, s18, v17
  v_smfmac_f32_16x16x64_bf16 v[20:23], v[104:107], a[32:39], v0
  ds_read_b128 v[76:79], v4 offset:22528
  v_mul_f32 v18, s18, v18
  v_smfmac_f32_16x16x64_bf16 v[20:23], v[108:111], a[40:47], v0
  ds_read_b128 v[80:83], v4 offset:23552
  v_mul_f32 v19, s18, v19
  v_smfmac_f32_16x16x64_bf16 v[20:23], v[112:115], a[80:87], v0
  v_cvt_pk_bf16_f32 v120, v16, v17
  v_smfmac_f32_16x16x64_bf16 v[20:23], v[84:87], a[88:95], v0
  v_cvt_pk_bf16_f32 v121, v18, v19
  v_smfmac_f32_16x16x64_bf16 v[20:23], v[88:91], a[128:135], v0
  ds_write_b64 v5, v[120:121] offset:24576
  v_smfmac_f32_16x16x64_bf16 v[20:23], v[100:103], a[136:143], v0
  s_waitcnt lgkmcnt(3)
  v_smfmac_f32_16x16x64_bf16 v[24:27], v[92:95], v[68:75], v0
  s_waitcnt lgkmcnt(1)
  v_mov_b64 v[92:93], 0
  v_smfmac_f32_16x16x64_bf16 v[24:27], v[96:99], v[76:83], v0
  s_nop 1
  v_cvt_pk_bf16_f32 v122, v20, v21
  v_cvt_pk_bf16_f32 v123, v22, v23
  v_smfmac_f32_16x16x64_bf16 v[24:27], v[116:119], v[208:215], v0
  ds_write_b64 v5, v[122:123] offset:26880
  v_mov_b64 v[94:95], 0
  v_smfmac_f32_16x16x64_bf16 v[24:27], v[124:127], v[216:223], v0
  s_waitcnt lgkmcnt(1)
  s_barrier
  ds_read_b64_tr_b16 v[68:69], v6 offset:24576
  v_smfmac_f32_16x16x64_bf16 v[24:27], v[104:107], a[48:55], v0
  s_add_u32 s27, s27, 8192
  ds_read_b64_tr_b16 v[70:71], v6 offset:24640
  ds_read_b64_tr_b16 v[72:73], v6 offset:24832
  v_smfmac_f32_16x16x64_bf16 v[24:27], v[108:111], a[56:63], v0
  s_add_u32 s28, s28, 8192
  ds_read_b64_tr_b16 v[74:75], v6 offset:24896
  ds_read_b64_tr_b16 v[76:77], v6 offset:25088
  v_smfmac_f32_16x16x64_bf16 v[24:27], v[112:115], a[96:103], v0
  s_nop 0
  ds_read_b64_tr_b16 v[78:79], v6 offset:25152
  ds_read_b64_tr_b16 v[80:81], v6 offset:25344
  v_smfmac_f32_16x16x64_bf16 v[24:27], v[84:87], a[104:111], v0
  ds_read_b64_tr_b16 v[82:83], v6 offset:25408
  v_mov_b64 v[96:97], 0
  v_smfmac_f32_16x16x64_bf16 v[24:27], v[88:91], a[144:151], v0
  s_waitcnt lgkmcnt(8)
  s_barrier
  ds_read_b64_tr_b16 v[116:117], v6 offset:26880
  v_smfmac_f32_16x16x64_bf16 v[24:27], v[100:103], a[152:159], v0
  s_waitcnt lgkmcnt(7)
  ds_read_b64_tr_b16 v[118:119], v6 offset:26944
  v_mfma_f32_16x16x32_bf16 v[16:19], v[36:39], v[68:71], 0
  s_waitcnt lgkmcnt(6)
  ds_read_b64_tr_b16 v[124:125], v6 offset:27136
  ds_read_b64_tr_b16 v[126:127], v6 offset:27200
  v_mfma_f32_16x16x32_bf16 v[16:19], v[40:43], v[72:75], v[16:19]
  s_waitcnt lgkmcnt(6)
  ds_read_b64_tr_b16 v[104:105], v6 offset:27392
  ds_read_b64_tr_b16 v[106:107], v6 offset:27456
  v_mfma_f32_16x16x32_bf16 v[16:19], v[44:47], v[76:79], v[16:19]
  s_waitcnt lgkmcnt(6)
  ds_read_b64_tr_b16 v[108:109], v6 offset:27648
  ds_read_b64_tr_b16 v[110:111], v6 offset:27712
  v_mfma_f32_16x16x32_bf16 v[16:19], v[48:51], v[80:83], v[16:19]
  s_waitcnt lgkmcnt(6)
  v_cvt_pk_bf16_f32 v120, v24, v25
  v_cvt_pk_bf16_f32 v121, v26, v27
  v_mfma_f32_16x16x32_bf16 v[112:115], v[116:119], v[68:71], 0
  s_waitcnt lgkmcnt(4)
  buffer_store_dwordx4 v[120:123], v2, s[4:7], s29 offen offset:3072 sc1
  v_mov_b64 v[98:99], 0
  v_mfma_f32_16x16x32_bf16 v[112:115], v[124:127], v[72:75], v[112:115]
  s_waitcnt lgkmcnt(2)
  v_mov_b64 v[36:37], 0
  v_exp_f32 v100, v16
  v_mfma_f32_16x16x32_bf16 v[112:115], v[104:107], v[76:79], v[112:115]
  s_waitcnt lgkmcnt(0)
  v_exp_f32 v101, v17
  v_mfma_f32_16x16x32_bf16 v[112:115], v[108:111], v[80:83], v[112:115]
  s_add_u32 s29, s29, 131072
  v_exp_f32 v102, v18
  v_mfma_f32_16x16x32_bf16 v[20:23], v[52:55], v[68:71], 0
  s_cmp_eq_u32 s14, 63
  v_exp_f32 v103, v19
  v_mfma_f32_16x16x32_bf16 v[20:23], v[56:59], v[72:75], v[20:23]
  s_cbranch_scc1 M_tdone
  v_cvt_pk_bf16_f32 v44, v100, v101
  v_cvt_pk_bf16_f32 v45, v102, v103
  v_mfma_f32_16x16x32_bf16 v[20:23], v[60:63], v[76:79], v[20:23]
  v_exp_f32 v100, v112
  v_mfma_f32_16x16x32_bf16 v[20:23], v[64:67], v[80:83], v[20:23]
  v_exp_f32 v101, v113
  v_exp_f32 v102, v114
  v_exp_f32 v103, v115
  v_cvt_pk_bf16_f32 v84, v100, v101
  v_cvt_pk_bf16_f32 v85, v102, v103
  v_cndmask_b32 v48, v84, 0, s[16:17]
  v_cndmask_b32 v49, v85, 0, s[16:17]
  v_cndmask_b32 v50, 0, v84, s[16:17]
  v_cndmask_b32 v51, 0, v85, s[16:17]
  v_exp_f32 v100, v20
  v_mfma_f32_16x16x16_bf16 v[88:91], v[12:13], v[48:49], 0
  v_exp_f32 v101, v21
  v_mfma_f32_16x16x16_bf16 v[24:27], v[120:121], v[48:49], 0
  v_exp_f32 v102, v22
  v_mfma_f32_16x16x16_bf16 v[116:119], v[120:121], v[50:51], 0
  v_exp_f32 v103, v23
  v_cvt_pk_bf16_f32 v46, v100, v101
  v_cvt_pk_bf16_f32 v47, v102, v103
  v_mov_b64 v[38:39], 0
  s_nop 0
  v_mfma_f32_16x16x32_bf16 v[88:91], v[12:15], v[44:47], v[88:91]
  v_mov_b64 v[40:41], 0
  v_mov_b64 v[42:43], 0
  v_mfma_f32_16x16x32_bf16 v[24:27], v[28:31], v[44:47], v[24:27]
  ds_read_b128 v[52:55], v4 offset:24576
  ds_read_b128 v[56:59], v4 offset:25600
  v_mfma_f32_16x16x32_bf16 v[116:119], v[32:35], v[44:47], v[116:119]
  s_nop 1
  v_rcp_f32 v89, v88
  v_subrev_u32 v100, s54, v88
  v_cmp_le_u32 vcc, s55, v100
  v_mul_f32 v24, v89, v24
  v_mul_f32 v25, v89, v25
  s_cbranch_vccnz T_slow_190
T_back_191:
  v_cvt_pk_bf16_f32 v124, v24, v25
  v_pk_mul_f32 v[26:27], v[26:27], v[88:89] op_sel:[0,1] op_sel_hi:[1,1]
  v_pk_mul_f32 v[116:117], v[116:117], v[88:89] op_sel:[0,1] op_sel_hi:[1,1]
  v_pk_mul_f32 v[118:119], v[118:119], v[88:89] op_sel:[0,1] op_sel_hi:[1,1]
  v_cvt_pk_bf16_f32 v125, v26, v27
  v_cvt_pk_bf16_f32 v126, v116, v117
  v_cvt_pk_bf16_f32 v127, v118, v119
  ds_write_b128 v11, v[124:127] offset:30720
  s_nop 0
  v_smfmac_f32_16x16x64_bf16 v[92:95], v[124:127], a[160:167], v0
  v_smfmac_f32_16x16x64_bf16 v[96:99], v[124:127], a[168:175], v0
  v_smfmac_f32_16x16x64_bf16 v[36:39], v[124:127], a[176:183], v0
  v_smfmac_f32_16x16x64_bf16 v[40:43], v[124:127], a[184:191], v0
  s_waitcnt lgkmcnt(0)
  s_barrier
  ds_read_b128 v[104:107], v11 offset:30208
  ds_read_b128 v[108:111], v11 offset:29696
  ds_read_b128 v[68:71], v11 offset:29184
  s_waitcnt lgkmcnt(2)
  v_smfmac_f32_16x16x64_bf16 v[92:95], v[104:107], a[192:199], v0
  s_waitcnt lgkmcnt(1)
  ds_read_b128 v[76:79], v4 offset:28672
  v_smfmac_f32_16x16x64_bf16 v[92:95], v[108:111], a[224:231], v0
  s_waitcnt lgkmcnt(1)
  ds_read_b128 v[80:83], v4 offset:29696
  v_smfmac_f32_16x16x64_bf16 v[92:95], v[68:71], a[240:247], v0
  ds_read_b128 v[60:63], v4 offset:26624
  v_smfmac_f32_16x16x64_bf16 v[96:99], v[104:107], a[200:207], v0
  ds_read_b128 v[64:67], v4 offset:27648
  v_smfmac_f32_16x16x64_bf16 v[96:99], v[108:111], a[232:239], v0
  ds_read_b128 v[28:31], v4 offset:30720
  s_nop 0
  v_cvt_pk_bf16_f32 v16, v92, v93
  v_cvt_pk_bf16_f32 v17, v94, v95
  v_bfi_b32 v16, 1, s57, v16
  v_smfmac_f32_16x16x64_bf16 v[96:99], v[68:71], a[248:255], v0
  buffer_store_dwordx2 v[16:17], v7, s[4:7], s20 offen offset:0 sc1
  v_smfmac_f32_16x16x64_bf16 v[36:39], v[104:107], a[208:215], v0
  ds_read_b128 v[32:35], v4 offset:31744
  v_smfmac_f32_16x16x64_bf16 v[36:39], v[108:111], v[52:59], v0
  s_waitcnt lgkmcnt(4)
  s_nop 0
  v_cvt_pk_bf16_f32 v18, v96, v97
  v_cvt_pk_bf16_f32 v19, v98, v99
  v_bfi_b32 v18, 1, s57, v18
  v_smfmac_f32_16x16x64_bf16 v[36:39], v[68:71], v[76:83], v0
  buffer_store_dwordx2 v[18:19], v7, s[4:7], s20 offen offset:64 sc1
  v_smfmac_f32_16x16x64_bf16 v[40:43], v[104:107], a[216:223], v0
  s_waitcnt lgkmcnt(2)
  v_smfmac_f32_16x16x64_bf16 v[40:43], v[108:111], v[60:67], v0
  s_waitcnt lgkmcnt(0)
  s_nop 0
  v_cvt_pk_bf16_f32 v20, v36, v37
  v_cvt_pk_bf16_f32 v21, v38, v39
  v_bfi_b32 v20, 1, s57, v20
  v_smfmac_f32_16x16x64_bf16 v[40:43], v[68:71], v[28:35], v0
  buffer_store_dwordx2 v[20:21], v7, s[4:7], s21 offen offset:0 sc1
  s_nop 6
  v_cvt_pk_bf16_f32 v22, v40, v41
  v_cvt_pk_bf16_f32 v23, v42, v43
  v_bfi_b32 v22, 1, s57, v22
  buffer_store_dwordx2 v[22:23], v7, s[4:7], s21 offen offset:64 sc1
  ds_read_b128 v[68:71], v4 offset:0
  ds_read_b128 v[72:75], v4 offset:1024
  ds_read_b128 v[76:79], v4 offset:4096
  ds_read_b128 v[80:83], v4 offset:5120
  ds_read_b128 v[84:87], v4 offset:8192
  ds_read_b128 v[88:91], v4 offset:9216
  ds_read_b128 v[92:95], v4 offset:2048
  ds_read_b128 v[96:99], v4 offset:3072
  ds_read_b128 v[100:103], v4 offset:6144
  ds_read_b128 v[104:107], v4 offset:7168
  ds_read_b128 v[108:111], v4 offset:10240
  ds_read_b128 v[112:115], v4 offset:11264
  v_mov_b64 v[16:17], 0
  v_mov_b64 v[18:19], 0
  v_mov_b64 v[20:21], 0
  v_mov_b64 v[22:23], 0
  v_mov_b64 v[24:25], 0
  v_mov_b64 v[26:27], 0
  ds_read_b64 v[44:45], v2 offset:32256
  s_waitcnt lgkmcnt(0)
  v_readfirstlane_b32 s38, v44
  v_readfirstlane_b32 s37, v45
  s_nop 0
  s_add_u32 s37, s37, 30
  s_cmp_ge_u32 s38, 30
  s_cselect_b32 s38, s37, s38
  s_cmp_ge_u32 s38, 64
  s_cselect_b32 s38, 100, s38
  s_sub_u32 s38, s38, 1
  s_max_i32 s30, s30, s38
  s_waitcnt vmcnt(4)
  s_barrier
  ds_read_b128 v[28:31], v2 offset:19456
  ds_read_b128 v[32:35], v2 offset:23552
  ds_read_b128 v[36:39], v2 offset:8192
  ds_read_b128 v[40:43], v2 offset:9216
  ds_read_b128 v[44:47], v2 offset:10240
  ds_read_b128 v[48:51], v2 offset:11264
  buffer_load_dwordx4 v[124:127], v3, s[4:7], s24 offen offset:3072 sc1
  buffer_load_dwordx4 v[116:119], v3, s[4:7], s25 offen offset:3072 sc1
  ds_read_b128 v[52:55], v2 offset:12288
  ds_read_b128 v[56:59], v2 offset:13312
  ds_read_b128 v[60:63], v2 offset:14336
  ds_read_b128 v[64:67], v2 offset:15360
  buffer_load_dwordx4 v[124:127], v3, s[4:7], s24 offen offset:3072 sc1
  buffer_load_dwordx4 v[116:119], v3, s[4:7], s25 offen offset:3072 sc1
  s_mov_b32 s19, 0
  s_branch T_loop_183
T_kvw_187:
  s_mov_b32 s19, 0
  s_branch T_kvok_196
T_kv_195:
  s_sleep 4
  s_add_u32 s19, s19, 1
  s_cmp_gt_u32 s19, 32768
  s_cbranch_scc1 M_exit
T_kvok_196:
  s_add_u32 s39, s99, 128
  s_mov_b32 s38, 0
  s_mov_b32 s37, 0
  s_atomic_or s38, s[58:59], s99 glc
  s_atomic_or s37, s[58:59], s39 glc
  s_waitcnt lgkmcnt(0)
  s_add_u32 s37, s37, 30
  s_cmp_ge_u32 s38, 30
  s_cselect_b32 s38, s37, s38
  s_cmp_ge_u32 s38, 64
  s_cselect_b32 s38, 100, s38
  s_sub_u32 s38, s38, 1
  s_max_i32 s30, s30, s38
  s_cmp_ge_i32 s14, s30
  s_cbranch_scc1 T_kv_195
  s_branch T_kvb_188
T_slow_190:
  s_nop 7
  v_max3_f32 v100, v16, v17, v18
  v_max3_f32 v100, v100, v19, v20
  v_max3_f32 v100, v100, v21, v22
  v_max3_f32 v100, v100, v23, v112
  v_max3_f32 v100, v100, v113, v114
  v_max_f32 v100, v100, v115
  v_mov_b32 v101, v100
  s_nop 1
  v_permlane32_swap_b32 v100, v101
  s_nop 1
  v_max_f32 v100, v100, v101
  v_mov_b32 v101, v100
  s_nop 1
  v_permlane16_swap_b32 v100, v101
  s_nop 1
  v_max_f32 v100, v100, v101
  v_sub_f32 v16, v16, v100
  v_sub_f32 v17, v17, v100
  v_sub_f32 v18, v18, v100
  v_sub_f32 v19, v19, v100
  v_exp_f32 v16, v16
  v_exp_f32 v17, v17
  v_exp_f32 v18, v18
  v_exp_f32 v19, v19
  v_sub_f32 v20, v20, v100
  v_sub_f32 v21, v21, v100
  v_sub_f32 v22, v22, v100
  v_sub_f32 v23, v23, v100
  v_exp_f32 v20, v20
  v_exp_f32 v21, v21
  v_exp_f32 v22, v22
  v_exp_f32 v23, v23
  v_sub_f32 v112, v112, v100
  v_sub_f32 v113, v113, v100
  v_sub_f32 v114, v114, v100
  v_sub_f32 v115, v115, v100
  v_exp_f32 v112, v112
  v_exp_f32 v113, v113
  v_exp_f32 v114, v114
  v_exp_f32 v115, v115
  s_nop 0
  v_cvt_pk_bf16_f32 v44, v16, v17
  v_cvt_pk_bf16_f32 v45, v18, v19
  v_cvt_pk_bf16_f32 v46, v20, v21
  v_cvt_pk_bf16_f32 v47, v22, v23
  v_cvt_pk_bf16_f32 v84, v112, v113
  v_cvt_pk_bf16_f32 v85, v114, v115
  v_cndmask_b32 v48, v84, 0, s[16:17]
  v_cndmask_b32 v49, v85, 0, s[16:17]
  v_cndmask_b32 v50, 0, v84, s[16:17]
  v_cndmask_b32 v51, 0, v85, s[16:17]
  s_nop 1
  v_mfma_f32_16x16x16_bf16 v[88:91], v[12:13], v[48:49], 0
  v_mfma_f32_16x16x16_bf16 v[24:27], v[120:121], v[48:49], 0
  v_mfma_f32_16x16x16_bf16 v[116:119], v[120:121], v[50:51], 0
  v_mfma_f32_16x16x32_bf16 v[88:91], v[12:15], v[44:47], v[88:91]
  v_mfma_f32_16x16x32_bf16 v[24:27], v[28:31], v[44:47], v[24:27]
  v_mfma_f32_16x16x32_bf16 v[116:119], v[32:35], v[44:47], v[116:119]
  s_nop 7
  s_nop 1
  v_rcp_f32 v89, v88
  s_nop 0
  v_mul_f32 v24, v89, v24
  v_mul_f32 v25, v89, v25
  s_branch T_back_191
M_tdone:
  v_mov_b32 v16, 64
  v_or_b32 v17, s13, v2
  v_min_u32 v17, 1, v17
  v_lshlrev_b32 v17, 30, v17
  s_waitcnt vmcnt(0)
  s_barrier
  buffer_store_dword v16, v17, s[4:7], s15 offen sc1
M_done:
M_exit:
  s_endpgm
.p2align 6
.type M_table,@object
M_table:
.long 0x1, 0x3f, 0xffffffff, 0x17, 0x1, 0x7, 0x800, 0x0, 0x8, 0x0, 0x0, 0x0, 0x0, 0x0, 0x0, 0x0
.long 0x1, 0x28, 0xffffffff, 0x1b, 0x1, 0x6, 0x1000, 0x0, 0x8, 0x1, 0x0, 0x0, 0x0, 0x0, 0x0, 0x0
.long 0x2, 0x0, 0x1, 0x1e, 0x1, 0x5, 0x1800, 0x0, 0x8, 0x0, 0x0, 0x0, 0x0, 0x0, 0x0, 0x0
.long 0x2, 0x1e, 0x1, 0x22, 0x1, 0x4, 0x2000, 0x0, 0x8, 0x1, 0x0, 0x0, 0x0, 0x0, 0x0, 0x0
.long 0x0, 0x0, 0x1, 0x20, 0x2, 0x3, 0x20, 0x0, 0x8, 0x2, 0x0, 0x0, 0x0, 0x0, 0x0, 0x0
.long 0x0, 0x3f, 0xffffffff, 0x20, 0x2, 0x2, 0x18, 0x1, 0x10, 0x0, 0x0, 0x0, 0x0, 0x0, 0x0, 0x0
.long 0x1, 0xd, 0xffffffff, 0xe, 0x0, 0x0, 0x8, 0x0, 0x8, 0x2, 0x0, 0x0, 0x0, 0x0, 0x0, 0x0
.size M_table, 448
.section .rodata,"a"
.p2align 6
.amdhsa_kernel gated_mix__compressed_kv_cla__memory_aug_recurrent_mem_tr__prompt_kernel
.amdhsa_next_free_vgpr 512
.amdhsa_next_free_sgpr 102
.amdhsa_accum_offset 256
.amdhsa_group_segment_fixed_size 0
.amdhsa_kernarg_size 136
.amdhsa_user_sgpr_count 2
.amdhsa_user_sgpr_kernarg_segment_ptr 1
.amdhsa_system_sgpr_workgroup_id_x 1
.end_amdhsa_kernel
```

```asm
; @launch grid=(256,1,1) block=(256,1,1) lds=163840
.amdgcn_target "amdgcn-amd-amdhsa--gfx950"
.text
.globl gated_mix__compressed_kv_cla__memory_aug_recurrent_mem_tr__prompt_kernel
.p2align 8
.type gated_mix__compressed_kv_cla__memory_aug_recurrent_mem_tr__prompt_kernel,@function
gated_mix__compressed_kv_cla__memory_aug_recurrent_mem_tr__prompt_kernel:
  s_cmp_ge_u32 s2, 256
  s_cbranch_scc1 M_exit
  s_load_dwordx4 s[72:75], s[0:1], 120
  v_lshrrev_b32 v3, 6, v0
  v_and_b32 v1, 63, v0
  v_readfirstlane_b32 s16, v3
  v_lshlrev_b32 v2, 4, v1
  s_and_b32 s76, s2, 7
  s_lshr_b32 s77, s2, 3
  s_sub_u32 s66, s76, 1
  s_and_b32 s66, s66, 7
  s_lshl_b32 s66, s66, 5
  s_add_u32 s66, s66, s77
  s_lshl_b32 s31, s66, 7
  s_add_u32 s31, s31, 148897792
  s_waitcnt lgkmcnt(0)
  s_mov_b64 s[4:5], s[74:75]
  s_mov_b64 s[74:75], s[72:73]
  s_mov_b64 s[72:73], s[4:5]
  s_and_b32 s5, s5, 0xffff
  s_mov_b32 s6, 268435456
  s_mov_b32 s7, 0x20000
  s_cmp_eq_u32 s76, 0
  s_cbranch_scc1 M_team
  s_mul_i32 s64, s66, 9363
  s_lshr_b32 s64, s64, 16
  s_mul_i32 s67, s64, 7
  s_sub_u32 s65, s66, s67
  s_lshl_b32 s67, s67, 7
  s_add_u32 s67, s67, 148897792
  s_getpc_b64 s[76:77]
M_pc:
  s_add_u32 s76, s76, M_table-M_pc
  s_addc_u32 s77, s77, 0
  s_lshl_b32 s26, s65, 6
  s_load_dwordx16 s[48:63], s[76:77], s26
  s_waitcnt lgkmcnt(0)
  s_mov_b32 s23, s51
  s_cmp_lg_u32 s48, 1
  s_cbranch_scc1 M_nobpf
  s_load_dwordx8 s[36:43], s[0:1], 64
  s_mul_i32 s76, s64, 3
  s_add_u32 s76, s76, s57
  v_lshlrev_b32 v4, 7, v0
  s_mov_b32 s10, 4194304
  s_mov_b32 s11, 0x20000
  s_waitcnt lgkmcnt(0)
  s_mov_b32 s8, s42
  s_and_b32 s9, s43, 0xffff
  s_mul_i32 s77, s76, 43776
  s_add_u32 s77, s77, 0
  v_min_u32 v5, 32640, v4
  v_add_u32 v5, s77, v5
  s_add_u32 s77, s77, 32768
  buffer_load_dword v6, v5, s[8:11], 0 offen
  v_min_u32 v5, 10880, v4
  v_add_u32 v5, s77, v5
  s_add_u32 s77, s77, 32768
  buffer_load_dword v6, v5, s[8:11], 0 offen
  s_mov_b32 s8, s38
  s_and_b32 s9, s39, 0xffff
  s_mul_i32 s77, s76, 21888
  s_add_u32 s77, s77, 2097152
  v_min_u32 v5, 21760, v4
  v_add_u32 v5, s77, v5
  s_add_u32 s77, s77, 32768
  buffer_load_dword v6, v5, s[8:11], 0 offen
  s_mov_b32 s8, s40
  s_and_b32 s9, s41, 0xffff
  s_mul_i32 s77, s76, 21888
  s_add_u32 s77, s77, 2097152
  v_min_u32 v5, 21760, v4
  v_add_u32 v5, s77, v5
  s_add_u32 s77, s77, 32768
  buffer_load_dword v6, v5, s[8:11], 0 offen
  s_mov_b32 s8, s36
  s_and_b32 s9, s37, 0xffff
  s_mul_i32 s77, s76, 21888
  s_add_u32 s77, s77, 2097152
  v_min_u32 v5, 21760, v4
  v_add_u32 v5, s77, v5
  s_add_u32 s77, s77, 32768
  buffer_load_dword v6, v5, s[8:11], 0 offen
  s_waitcnt vmcnt(0)
M_nobpf:
  s_lshr_b32 s29, s16, 1
  s_cmp_eq_u32 s29, 0
  s_cselect_b32 s26, 2, 8
  s_cselect_b32 s27, 3, 4
  s_cselect_b32 s28, 9, 10
  s_cmp_eq_u32 s48, 1
  s_cselect_b32 s26, s27, s26
  s_cmp_eq_u32 s48, 2
  s_cselect_b32 s26, s28, s26
  s_lshl_b32 s26, s26, 3
  s_load_dwordx2 s[8:9], s[0:1], s26
  s_cmp_eq_u32 s48, 1
  s_cselect_b32 s26, 8, 0
  s_load_dwordx2 s[12:13], s[0:1], s26
  s_cmp_eq_u32 s29, 0
  s_cselect_b32 s21, 0, 3
  s_cselect_b32 s27, 1, 2
  s_cselect_b32 s28, 4, 5
  s_cmp_eq_u32 s48, 1
  s_cselect_b32 s21, s27, s21
  s_cmp_eq_u32 s48, 2
  s_cselect_b32 s21, s28, s21
  s_lshl_b32 s21, s21, 5
  s_add_u32 s21, s21, s64
  s_lshl_b32 s21, s21, 6
  s_add_u32 s21, s21, s49
  s_and_b32 s27, s16, 1
  s_lshl_b32 s21, s21, 1
  s_add_u32 s21, s21, s27
  s_lshl_b32 s21, s21, 12
  s_lshl_b32 s22, s50, 13
  s_lshl_b32 s19, s49, 15
  s_lshl_b32 s20, s50, 15
  s_lshl_b32 s17, s64, 1
  s_add_u32 s17, s17, s27
  s_lshl_b32 s17, s17, 7
  s_mov_b32 s18, 8192
  s_cmp_eq_u32 s48, 0
  s_cselect_b32 s24, 0x3e0293ee, 1.0
  s_waitcnt lgkmcnt(0)
  s_and_b32 s9, s9, 0xffff
  s_mov_b32 s10, 4194304
  s_mov_b32 s11, 0x20000
  s_and_b32 s13, s13, 0xffff
  s_mov_b32 s14, 2097152
  s_mov_b32 s15, 0x20000
  v_and_b32 v144, 31, v1
  v_lshrrev_b32 v145, 5, v1
  v_and_b32 v146, 15, v1
  v_or_b32 v147, 0, v145
  v_xor_b32 v147, v147, v146
  v_lshlrev_b32 v147, 4, v147
  v_lshl_add_u32 v8, v144, 8, v147
  v_or_b32 v147, 2, v145
  v_xor_b32 v147, v147, v146
  v_lshlrev_b32 v147, 4, v147
  v_lshl_add_u32 v9, v144, 8, v147
  v_or_b32 v147, 4, v145
  v_xor_b32 v147, v147, v146
  v_lshlrev_b32 v147, 4, v147
  v_lshl_add_u32 v10, v144, 8, v147
  v_or_b32 v147, 6, v145
  v_xor_b32 v147, v147, v146
  v_lshlrev_b32 v147, 4, v147
  v_lshl_add_u32 v11, v144, 8, v147
  v_or_b32 v147, 8, v145
  v_xor_b32 v147, v147, v146
  v_lshlrev_b32 v147, 4, v147
  v_lshl_add_u32 v12, v144, 8, v147
  v_or_b32 v147, 10, v145
  v_xor_b32 v147, v147, v146
  v_lshlrev_b32 v147, 4, v147
  v_lshl_add_u32 v13, v144, 8, v147
  v_or_b32 v147, 12, v145
  v_xor_b32 v147, v147, v146
  v_lshlrev_b32 v147, 4, v147
  v_lshl_add_u32 v14, v144, 8, v147
  v_or_b32 v147, 14, v145
  v_xor_b32 v147, v147, v146
  v_lshlrev_b32 v147, 4, v147
  v_lshl_add_u32 v15, v144, 8, v147
  v_lshrrev_b32 v144, 4, v1
  s_lshl_b32 s26, s16, 8
  v_add_u32 v145, 0, v144
  v_and_b32 v147, 15, v145
  v_xor_b32 v147, v147, v146
  v_lshlrev_b32 v147, 4, v147
  v_lshl_add_u32 v147, v145, 10, v147
  v_add_u32 v16, s26, v147
  v_add_u32 v145, 4, v144
  v_and_b32 v147, 15, v145
  v_xor_b32 v147, v147, v146
  v_lshlrev_b32 v147, 4, v147
  v_lshl_add_u32 v147, v145, 10, v147
  v_add_u32 v17, s26, v147
  v_add_u32 v145, 8, v144
  v_and_b32 v147, 15, v145
  v_xor_b32 v147, v147, v146
  v_lshlrev_b32 v147, 4, v147
  v_lshl_add_u32 v147, v145, 10, v147
  v_add_u32 v18, s26, v147
  v_add_u32 v145, 12, v144
  v_and_b32 v147, 15, v145
  v_xor_b32 v147, v147, v146
  v_lshlrev_b32 v147, 4, v147
  v_lshl_add_u32 v147, v145, 10, v147
  v_add_u32 v19, s26, v147
  v_add_u32 v145, 16, v144
  v_and_b32 v147, 15, v145
  v_xor_b32 v147, v147, v146
  v_lshlrev_b32 v147, 4, v147
  v_lshl_add_u32 v147, v145, 10, v147
  v_add_u32 v20, s26, v147
  v_add_u32 v145, 20, v144
  v_and_b32 v147, 15, v145
  v_xor_b32 v147, v147, v146
  v_lshlrev_b32 v147, 4, v147
  v_lshl_add_u32 v147, v145, 10, v147
  v_add_u32 v21, s26, v147
  v_add_u32 v145, 24, v144
  v_and_b32 v147, 15, v145
  v_xor_b32 v147, v147, v146
  v_lshlrev_b32 v147, 4, v147
  v_lshl_add_u32 v147, v145, 10, v147
  v_add_u32 v22, s26, v147
  v_add_u32 v145, 28, v144
  v_and_b32 v147, 15, v145
  v_xor_b32 v147, v147, v146
  v_lshlrev_b32 v147, 4, v147
  v_lshl_add_u32 v147, v145, 10, v147
  v_add_u32 v23, s26, v147
  v_lshrrev_b32 v144, 3, v1
  v_mul_lo_u32 v144, v144, s18
  v_and_b32 v145, 7, v1
  v_lshl_add_u32 v144, v145, 4, v144
  s_lshl_b32 s28, s16, 15
  s_add_u32 s28, s28, 32768
  s_lshl_b32 s29, s18, 3
  s_add_u32 m0, s28, 0
  s_nop 0
  buffer_load_dwordx4 v144, s[8:11], s17 offen lds
  s_add_u32 s17, s17, s29
  s_add_u32 m0, s28, 1024
  s_nop 0
  buffer_load_dwordx4 v144, s[8:11], s17 offen lds
  s_add_u32 s17, s17, s29
  s_add_u32 m0, s28, 2048
  s_nop 0
  buffer_load_dwordx4 v144, s[8:11], s17 offen lds
  s_add_u32 s17, s17, s29
  s_add_u32 m0, s28, 3072
  s_nop 0
  buffer_load_dwordx4 v144, s[8:11], s17 offen lds
  s_add_u32 s17, s17, s29
  s_add_u32 m0, s28, 4096
  s_nop 0
  buffer_load_dwordx4 v144, s[8:11], s17 offen lds
  s_add_u32 s17, s17, s29
  s_add_u32 m0, s28, 5120
  s_nop 0
  buffer_load_dwordx4 v144, s[8:11], s17 offen lds
  s_add_u32 s17, s17, s29
  s_add_u32 m0, s28, 6144
  s_nop 0
  buffer_load_dwordx4 v144, s[8:11], s17 offen lds
  s_add_u32 s17, s17, s29
  s_add_u32 m0, s28, 7168
  s_nop 0
  buffer_load_dwordx4 v144, s[8:11], s17 offen lds
  s_add_u32 s17, s17, s29
  s_add_u32 m0, s28, 8192
  s_nop 0
  buffer_load_dwordx4 v144, s[8:11], s17 offen lds
  s_add_u32 s17, s17, s29
  s_add_u32 m0, s28, 9216
  s_nop 0
  buffer_load_dwordx4 v144, s[8:11], s17 offen lds
  s_add_u32 s17, s17, s29
  s_add_u32 m0, s28, 10240
  s_nop 0
  buffer_load_dwordx4 v144, s[8:11], s17 offen lds
  s_add_u32 s17, s17, s29
  s_add_u32 m0, s28, 11264
  s_nop 0
  buffer_load_dwordx4 v144, s[8:11], s17 offen lds
  s_add_u32 s17, s17, s29
  s_add_u32 m0, s28, 12288
  s_nop 0
  buffer_load_dwordx4 v144, s[8:11], s17 offen lds
  s_add_u32 s17, s17, s29
  s_add_u32 m0, s28, 13312
  s_nop 0
  buffer_load_dwordx4 v144, s[8:11], s17 offen lds
  s_add_u32 s17, s17, s29
  s_add_u32 m0, s28, 14336
  s_nop 0
  buffer_load_dwordx4 v144, s[8:11], s17 offen lds
  s_add_u32 s17, s17, s29
  s_add_u32 m0, s28, 15360
  s_nop 0
  buffer_load_dwordx4 v144, s[8:11], s17 offen lds
  s_add_u32 s17, s17, s29
  s_add_u32 m0, s28, 16384
  s_nop 0
  buffer_load_dwordx4 v144, s[8:11], s17 offen lds
  s_add_u32 s17, s17, s29
  s_add_u32 m0, s28, 17408
  s_nop 0
  buffer_load_dwordx4 v144, s[8:11], s17 offen lds
  s_add_u32 s17, s17, s29
  s_add_u32 m0, s28, 18432
  s_nop 0
  buffer_load_dwordx4 v144, s[8:11], s17 offen lds
  s_add_u32 s17, s17, s29
  s_add_u32 m0, s28, 19456
  s_nop 0
  buffer_load_dwordx4 v144, s[8:11], s17 offen lds
  s_add_u32 s17, s17, s29
  s_add_u32 m0, s28, 20480
  s_nop 0
  buffer_load_dwordx4 v144, s[8:11], s17 offen lds
  s_add_u32 s17, s17, s29
  s_add_u32 m0, s28, 21504
  s_nop 0
  buffer_load_dwordx4 v144, s[8:11], s17 offen lds
  s_add_u32 s17, s17, s29
  s_add_u32 m0, s28, 22528
  s_nop 0
  buffer_load_dwordx4 v144, s[8:11], s17 offen lds
  s_add_u32 s17, s17, s29
  s_add_u32 m0, s28, 23552
  s_nop 0
  buffer_load_dwordx4 v144, s[8:11], s17 offen lds
  s_add_u32 s17, s17, s29
  s_add_u32 m0, s28, 24576
  s_nop 0
  buffer_load_dwordx4 v144, s[8:11], s17 offen lds
  s_add_u32 s17, s17, s29
  s_add_u32 m0, s28, 25600
  s_nop 0
  buffer_load_dwordx4 v144, s[8:11], s17 offen lds
  s_add_u32 s17, s17, s29
  s_add_u32 m0, s28, 26624
  s_nop 0
  buffer_load_dwordx4 v144, s[8:11], s17 offen lds
  s_add_u32 s17, s17, s29
  s_add_u32 m0, s28, 27648
  s_nop 0
  buffer_load_dwordx4 v144, s[8:11], s17 offen lds
  s_add_u32 s17, s17, s29
  s_add_u32 m0, s28, 28672
  s_nop 0
  buffer_load_dwordx4 v144, s[8:11], s17 offen lds
  s_add_u32 s17, s17, s29
  s_add_u32 m0, s28, 29696
  s_nop 0
  buffer_load_dwordx4 v144, s[8:11], s17 offen lds
  s_add_u32 s17, s17, s29
  s_add_u32 m0, s28, 30720
  s_nop 0
  buffer_load_dwordx4 v144, s[8:11], s17 offen lds
  s_add_u32 s17, s17, s29
  s_add_u32 m0, s28, 31744
  s_nop 0
  buffer_load_dwordx4 v144, s[8:11], s17 offen lds
  s_add_u32 s17, s17, s29
  s_lshl_b32 s25, s16, 13
  s_add_u32 m0, s25, 0
  s_nop 0
  buffer_load_dwordx4 v16, s[12:15], s19 offen lds
  s_add_u32 m0, s25, 1024
  s_nop 0
  buffer_load_dwordx4 v17, s[12:15], s19 offen lds
  s_add_u32 m0, s25, 2048
  s_nop 0
  buffer_load_dwordx4 v18, s[12:15], s19 offen lds
  s_add_u32 m0, s25, 3072
  s_nop 0
  buffer_load_dwordx4 v19, s[12:15], s19 offen lds
  s_add_u32 m0, s25, 4096
  s_nop 0
  buffer_load_dwordx4 v20, s[12:15], s19 offen lds
  s_add_u32 m0, s25, 5120
  s_nop 0
  buffer_load_dwordx4 v21, s[12:15], s19 offen lds
  s_add_u32 m0, s25, 6144
  s_nop 0
  buffer_load_dwordx4 v22, s[12:15], s19 offen lds
  s_add_u32 m0, s25, 7168
  s_nop 0
  buffer_load_dwordx4 v23, s[12:15], s19 offen lds
  s_cmp_gt_u32 s23, 1
  s_cselect_b32 s26, s20, 0
  s_add_u32 s19, s19, s26
  s_add_u32 s25, s25, 32768
  s_and_b32 s25, s25, 0x1ffff
  s_cmp_lg_u32 s16, 3
  s_cbranch_scc1 M_noinit
  s_mov_b32 s79, 0
  s_atomic_swap s79, s[72:73], s31 glc
  s_waitcnt lgkmcnt(0)
  s_mov_b32 s79, 1
  s_atomic_add s79, s[74:75], 128
M_noinit:
  s_cmp_lg_u32 s65, 3
  s_cbranch_scc1 M_noarm
  v_lshlrev_b32 v4, 4, v0
  v_mov_b64 v[60:61], -1
  v_mov_b64 v[62:63], -1
  s_mul_i32 s76, s64, 4096
  s_add_u32 s77, s76, 142868480
  buffer_store_dwordx4 v[60:63], v4, s[4:7], s77 offen sc1
  s_add_u32 s77, s76, 142999552
  buffer_store_dwordx4 v[60:63], v4, s[4:7], s77 offen sc1
  s_add_u32 s77, s76, 143130624
  buffer_store_dwordx4 v[60:63], v4, s[4:7], s77 offen sc1
  s_add_u32 s77, s76, 143261696
  buffer_store_dwordx4 v[60:63], v4, s[4:7], s77 offen sc1
  s_add_u32 s77, s76, 143392768
  buffer_store_dwordx4 v[60:63], v4, s[4:7], s77 offen sc1
  s_add_u32 s77, s76, 143523840
  buffer_store_dwordx4 v[60:63], v4, s[4:7], s77 offen sc1
M_noarm:
  s_mul_i32 s76, s64, 3
  s_add_u32 s76, s76, s57
  s_mul_i32 s76, s76, 24576
  v_lshlrev_b32 v4, 7, v0
  v_add_u32 v4, s76, v4
  buffer_load_dword v5, v4, s[12:15], 0 offen
  v_bfe_u32 v148, v1, 2, 2
  v_lshrrev_b32 v149, 5, v1
  v_lshl_add_u32 v148, v149, 3, v148
  v_lshlrev_b32 v148, 7, v148
  v_bfe_u32 v149, v1, 4, 1
  v_lshl_add_u32 v148, v149, 5, v148
  v_and_b32 v149, 3, v1
  v_lshl_add_u32 v148, v149, 3, v148
  v_add_u32 v146, s28, v148
  v_add_u32 v147, 512, v146
  s_waitcnt vmcnt(37)
  ds_read_b64_tr_b16 a[0:1], v146 offset:0
  ds_read_b64_tr_b16 a[2:3], v147 offset:0
  ds_read_b64_tr_b16 a[4:5], v146 offset:64
  ds_read_b64_tr_b16 a[6:7], v147 offset:64
  ds_read_b64_tr_b16 a[8:9], v146 offset:2048
  ds_read_b64_tr_b16 a[10:11], v147 offset:2048
  ds_read_b64_tr_b16 a[12:13], v146 offset:2112
  ds_read_b64_tr_b16 a[14:15], v147 offset:2112
  s_waitcnt lgkmcnt(0)
  s_add_u32 m0, s28, 0
  s_nop 0
  buffer_load_dwordx4 v144, s[8:11], s17 offen lds
  s_add_u32 s17, s17, s29
  s_add_u32 m0, s28, 1024
  s_nop 0
  buffer_load_dwordx4 v144, s[8:11], s17 offen lds
  s_add_u32 s17, s17, s29
  s_add_u32 m0, s28, 2048
  s_nop 0
  buffer_load_dwordx4 v144, s[8:11], s17 offen lds
  s_add_u32 s17, s17, s29
  s_add_u32 m0, s28, 3072
  s_nop 0
  buffer_load_dwordx4 v144, s[8:11], s17 offen lds
  s_add_u32 s17, s17, s29
  s_waitcnt vmcnt(37)
  ds_read_b64_tr_b16 a[16:17], v146 offset:4096
  ds_read_b64_tr_b16 a[18:19], v147 offset:4096
  ds_read_b64_tr_b16 a[20:21], v146 offset:4160
  ds_read_b64_tr_b16 a[22:23], v147 offset:4160
  ds_read_b64_tr_b16 a[24:25], v146 offset:6144
  ds_read_b64_tr_b16 a[26:27], v147 offset:6144
  ds_read_b64_tr_b16 a[28:29], v146 offset:6208
  ds_read_b64_tr_b16 a[30:31], v147 offset:6208
  s_waitcnt lgkmcnt(0)
  s_add_u32 m0, s28, 4096
  s_nop 0
  buffer_load_dwordx4 v144, s[8:11], s17 offen lds
  s_add_u32 s17, s17, s29
  s_add_u32 m0, s28, 5120
  s_nop 0
  buffer_load_dwordx4 v144, s[8:11], s17 offen lds
  s_add_u32 s17, s17, s29
  s_add_u32 m0, s28, 6144
  s_nop 0
  buffer_load_dwordx4 v144, s[8:11], s17 offen lds
  s_add_u32 s17, s17, s29
  s_add_u32 m0, s28, 7168
  s_nop 0
  buffer_load_dwordx4 v144, s[8:11], s17 offen lds
  s_add_u32 s17, s17, s29
  s_waitcnt vmcnt(37)
  ds_read_b64_tr_b16 a[32:33], v146 offset:8192
  ds_read_b64_tr_b16 a[34:35], v147 offset:8192
  ds_read_b64_tr_b16 a[36:37], v146 offset:8256
  ds_read_b64_tr_b16 a[38:39], v147 offset:8256
  ds_read_b64_tr_b16 a[40:41], v146 offset:10240
  ds_read_b64_tr_b16 a[42:43], v147 offset:10240
  ds_read_b64_tr_b16 a[44:45], v146 offset:10304
  ds_read_b64_tr_b16 a[46:47], v147 offset:10304
  s_waitcnt lgkmcnt(0)
  s_add_u32 m0, s28, 8192
  s_nop 0
  buffer_load_dwordx4 v144, s[8:11], s17 offen lds
  s_add_u32 s17, s17, s29
  s_add_u32 m0, s28, 9216
  s_nop 0
  buffer_load_dwordx4 v144, s[8:11], s17 offen lds
  s_add_u32 s17, s17, s29
  s_add_u32 m0, s28, 10240
  s_nop 0
  buffer_load_dwordx4 v144, s[8:11], s17 offen lds
  s_add_u32 s17, s17, s29
  s_add_u32 m0, s28, 11264
  s_nop 0
  buffer_load_dwordx4 v144, s[8:11], s17 offen lds
  s_add_u32 s17, s17, s29
  s_waitcnt vmcnt(37)
  ds_read_b64_tr_b16 a[48:49], v146 offset:12288
  ds_read_b64_tr_b16 a[50:51], v147 offset:12288
  ds_read_b64_tr_b16 a[52:53], v146 offset:12352
  ds_read_b64_tr_b16 a[54:55], v147 offset:12352
  ds_read_b64_tr_b16 a[56:57], v146 offset:14336
  ds_read_b64_tr_b16 a[58:59], v147 offset:14336
  ds_read_b64_tr_b16 a[60:61], v146 offset:14400
  ds_read_b64_tr_b16 a[62:63], v147 offset:14400
  s_waitcnt lgkmcnt(0)
  s_add_u32 m0, s28, 12288
  s_nop 0
  buffer_load_dwordx4 v144, s[8:11], s17 offen lds
  s_add_u32 s17, s17, s29
  s_add_u32 m0, s28, 13312
  s_nop 0
  buffer_load_dwordx4 v144, s[8:11], s17 offen lds
  s_add_u32 s17, s17, s29
  s_add_u32 m0, s28, 14336
  s_nop 0
  buffer_load_dwordx4 v144, s[8:11], s17 offen lds
  s_add_u32 s17, s17, s29
  s_add_u32 m0, s28, 15360
  s_nop 0
  buffer_load_dwordx4 v144, s[8:11], s17 offen lds
  s_add_u32 s17, s17, s29
  s_waitcnt vmcnt(37)
  ds_read_b64_tr_b16 a[64:65], v146 offset:16384
  ds_read_b64_tr_b16 a[66:67], v147 offset:16384
  ds_read_b64_tr_b16 a[68:69], v146 offset:16448
  ds_read_b64_tr_b16 a[70:71], v147 offset:16448
  ds_read_b64_tr_b16 a[72:73], v146 offset:18432
  ds_read_b64_tr_b16 a[74:75], v147 offset:18432
  ds_read_b64_tr_b16 a[76:77], v146 offset:18496
  ds_read_b64_tr_b16 a[78:79], v147 offset:18496
  s_waitcnt lgkmcnt(0)
  s_add_u32 m0, s28, 16384
  s_nop 0
  buffer_load_dwordx4 v144, s[8:11], s17 offen lds
  s_add_u32 s17, s17, s29
  s_add_u32 m0, s28, 17408
  s_nop 0
  buffer_load_dwordx4 v144, s[8:11], s17 offen lds
  s_add_u32 s17, s17, s29
  s_add_u32 m0, s28, 18432
  s_nop 0
  buffer_load_dwordx4 v144, s[8:11], s17 offen lds
  s_add_u32 s17, s17, s29
  s_add_u32 m0, s28, 19456
  s_nop 0
  buffer_load_dwordx4 v144, s[8:11], s17 offen lds
  s_add_u32 s17, s17, s29
  s_waitcnt vmcnt(37)
  ds_read_b64_tr_b16 a[80:81], v146 offset:20480
  ds_read_b64_tr_b16 a[82:83], v147 offset:20480
  ds_read_b64_tr_b16 a[84:85], v146 offset:20544
  ds_read_b64_tr_b16 a[86:87], v147 offset:20544
  ds_read_b64_tr_b16 a[88:89], v146 offset:22528
  ds_read_b64_tr_b16 a[90:91], v147 offset:22528
  ds_read_b64_tr_b16 a[92:93], v146 offset:22592
  ds_read_b64_tr_b16 a[94:95], v147 offset:22592
  s_waitcnt lgkmcnt(0)
  s_add_u32 m0, s28, 20480
  s_nop 0
  buffer_load_dwordx4 v144, s[8:11], s17 offen lds
  s_add_u32 s17, s17, s29
  s_add_u32 m0, s28, 21504
  s_nop 0
  buffer_load_dwordx4 v144, s[8:11], s17 offen lds
  s_add_u32 s17, s17, s29
  s_add_u32 m0, s28, 22528
  s_nop 0
  buffer_load_dwordx4 v144, s[8:11], s17 offen lds
  s_add_u32 s17, s17, s29
  s_add_u32 m0, s28, 23552
  s_nop 0
  buffer_load_dwordx4 v144, s[8:11], s17 offen lds
  s_add_u32 s17, s17, s29
  s_waitcnt vmcnt(37)
  ds_read_b64_tr_b16 a[96:97], v146 offset:24576
  ds_read_b64_tr_b16 a[98:99], v147 offset:24576
  ds_read_b64_tr_b16 a[100:101], v146 offset:24640
  ds_read_b64_tr_b16 a[102:103], v147 offset:24640
  ds_read_b64_tr_b16 a[104:105], v146 offset:26624
  ds_read_b64_tr_b16 a[106:107], v147 offset:26624
  ds_read_b64_tr_b16 a[108:109], v146 offset:26688
  ds_read_b64_tr_b16 a[110:111], v147 offset:26688
  s_waitcnt lgkmcnt(0)
  s_add_u32 m0, s28, 24576
  s_nop 0
  buffer_load_dwordx4 v144, s[8:11], s17 offen lds
  s_add_u32 s17, s17, s29
  s_add_u32 m0, s28, 25600
  s_nop 0
  buffer_load_dwordx4 v144, s[8:11], s17 offen lds
  s_add_u32 s17, s17, s29
  s_add_u32 m0, s28, 26624
  s_nop 0
  buffer_load_dwordx4 v144, s[8:11], s17 offen lds
  s_add_u32 s17, s17, s29
  s_add_u32 m0, s28, 27648
  s_nop 0
  buffer_load_dwordx4 v144, s[8:11], s17 offen lds
  s_add_u32 s17, s17, s29
  s_waitcnt vmcnt(37)
  ds_read_b64_tr_b16 a[112:113], v146 offset:28672
  ds_read_b64_tr_b16 a[114:115], v147 offset:28672
  ds_read_b64_tr_b16 a[116:117], v146 offset:28736
  ds_read_b64_tr_b16 a[118:119], v147 offset:28736
  ds_read_b64_tr_b16 a[120:121], v146 offset:30720
  ds_read_b64_tr_b16 a[122:123], v147 offset:30720
  ds_read_b64_tr_b16 a[124:125], v146 offset:30784
  ds_read_b64_tr_b16 a[126:127], v147 offset:30784
  s_waitcnt lgkmcnt(0)
  s_add_u32 m0, s28, 28672
  s_nop 0
  buffer_load_dwordx4 v144, s[8:11], s17 offen lds
  s_add_u32 s17, s17, s29
  s_add_u32 m0, s28, 29696
  s_nop 0
  buffer_load_dwordx4 v144, s[8:11], s17 offen lds
  s_add_u32 s17, s17, s29
  s_add_u32 m0, s28, 30720
  s_nop 0
  buffer_load_dwordx4 v144, s[8:11], s17 offen lds
  s_add_u32 s17, s17, s29
  s_add_u32 m0, s28, 31744
  s_nop 0
  buffer_load_dwordx4 v144, s[8:11], s17 offen lds
  s_add_u32 s17, s17, s29
  s_waitcnt vmcnt(28)
  ds_read_b64_tr_b16 a[128:129], v146 offset:0
  ds_read_b64_tr_b16 a[130:131], v147 offset:0
  ds_read_b64_tr_b16 a[132:133], v146 offset:64
  ds_read_b64_tr_b16 a[134:135], v147 offset:64
  ds_read_b64_tr_b16 a[136:137], v146 offset:2048
  ds_read_b64_tr_b16 a[138:139], v147 offset:2048
  ds_read_b64_tr_b16 a[140:141], v146 offset:2112
  ds_read_b64_tr_b16 a[142:143], v147 offset:2112
  s_waitcnt lgkmcnt(0)
  s_waitcnt vmcnt(24)
  ds_read_b64_tr_b16 a[144:145], v146 offset:4096
  ds_read_b64_tr_b16 a[146:147], v147 offset:4096
  ds_read_b64_tr_b16 a[148:149], v146 offset:4160
  ds_read_b64_tr_b16 a[150:151], v147 offset:4160
  ds_read_b64_tr_b16 a[152:153], v146 offset:6144
  ds_read_b64_tr_b16 a[154:155], v147 offset:6144
  ds_read_b64_tr_b16 a[156:157], v146 offset:6208
  ds_read_b64_tr_b16 a[158:159], v147 offset:6208
  s_waitcnt lgkmcnt(0)
  s_waitcnt vmcnt(20)
  ds_read_b64_tr_b16 a[160:161], v146 offset:8192
  ds_read_b64_tr_b16 a[162:163], v147 offset:8192
  ds_read_b64_tr_b16 a[164:165], v146 offset:8256
  ds_read_b64_tr_b16 a[166:167], v147 offset:8256
  ds_read_b64_tr_b16 a[168:169], v146 offset:10240
  ds_read_b64_tr_b16 a[170:171], v147 offset:10240
  ds_read_b64_tr_b16 a[172:173], v146 offset:10304
  ds_read_b64_tr_b16 a[174:175], v147 offset:10304
  s_waitcnt lgkmcnt(0)
  s_waitcnt vmcnt(16)
  ds_read_b64_tr_b16 a[176:177], v146 offset:12288
  ds_read_b64_tr_b16 a[178:179], v147 offset:12288
  ds_read_b64_tr_b16 a[180:181], v146 offset:12352
  ds_read_b64_tr_b16 a[182:183], v147 offset:12352
  ds_read_b64_tr_b16 a[184:185], v146 offset:14336
  ds_read_b64_tr_b16 a[186:187], v147 offset:14336
  ds_read_b64_tr_b16 a[188:189], v146 offset:14400
  ds_read_b64_tr_b16 a[190:191], v147 offset:14400
  s_waitcnt lgkmcnt(0)
  s_waitcnt vmcnt(12)
  ds_read_b64_tr_b16 a[192:193], v146 offset:16384
  ds_read_b64_tr_b16 a[194:195], v147 offset:16384
  ds_read_b64_tr_b16 a[196:197], v146 offset:16448
  ds_read_b64_tr_b16 a[198:199], v147 offset:16448
  ds_read_b64_tr_b16 a[200:201], v146 offset:18432
  ds_read_b64_tr_b16 a[202:203], v147 offset:18432
  ds_read_b64_tr_b16 a[204:205], v146 offset:18496
  ds_read_b64_tr_b16 a[206:207], v147 offset:18496
  s_waitcnt lgkmcnt(0)
  s_waitcnt vmcnt(8)
  ds_read_b64_tr_b16 a[208:209], v146 offset:20480
  ds_read_b64_tr_b16 a[210:211], v147 offset:20480
  ds_read_b64_tr_b16 a[212:213], v146 offset:20544
  ds_read_b64_tr_b16 a[214:215], v147 offset:20544
  ds_read_b64_tr_b16 a[216:217], v146 offset:22528
  ds_read_b64_tr_b16 a[218:219], v147 offset:22528
  ds_read_b64_tr_b16 a[220:221], v146 offset:22592
  ds_read_b64_tr_b16 a[222:223], v147 offset:22592
  s_waitcnt lgkmcnt(0)
  s_waitcnt vmcnt(4)
  ds_read_b64_tr_b16 a[224:225], v146 offset:24576
  ds_read_b64_tr_b16 a[226:227], v147 offset:24576
  ds_read_b64_tr_b16 a[228:229], v146 offset:24640
  ds_read_b64_tr_b16 a[230:231], v147 offset:24640
  ds_read_b64_tr_b16 a[232:233], v146 offset:26624
  ds_read_b64_tr_b16 a[234:235], v147 offset:26624
  ds_read_b64_tr_b16 a[236:237], v146 offset:26688
  ds_read_b64_tr_b16 a[238:239], v147 offset:26688
  s_waitcnt lgkmcnt(0)
  s_waitcnt vmcnt(0)
  ds_read_b64_tr_b16 a[240:241], v146 offset:28672
  ds_read_b64_tr_b16 a[242:243], v147 offset:28672
  ds_read_b64_tr_b16 a[244:245], v146 offset:28736
  ds_read_b64_tr_b16 a[246:247], v147 offset:28736
  ds_read_b64_tr_b16 a[248:249], v146 offset:30720
  ds_read_b64_tr_b16 a[250:251], v147 offset:30720
  ds_read_b64_tr_b16 a[252:253], v146 offset:30784
  ds_read_b64_tr_b16 a[254:255], v147 offset:30784
  s_waitcnt lgkmcnt(0)
  s_barrier
  s_add_u32 m0, s25, 0
  s_nop 0
  buffer_load_dwordx4 v16, s[12:15], s19 offen lds
  s_add_u32 m0, s25, 1024
  s_nop 0
  buffer_load_dwordx4 v17, s[12:15], s19 offen lds
  s_add_u32 m0, s25, 2048
  s_nop 0
  buffer_load_dwordx4 v18, s[12:15], s19 offen lds
  s_add_u32 m0, s25, 3072
  s_nop 0
  buffer_load_dwordx4 v19, s[12:15], s19 offen lds
  s_add_u32 m0, s25, 4096
  s_nop 0
  buffer_load_dwordx4 v20, s[12:15], s19 offen lds
  s_add_u32 m0, s25, 5120
  s_nop 0
  buffer_load_dwordx4 v21, s[12:15], s19 offen lds
  s_add_u32 m0, s25, 6144
  s_nop 0
  buffer_load_dwordx4 v22, s[12:15], s19 offen lds
  s_add_u32 m0, s25, 7168
  s_nop 0
  buffer_load_dwordx4 v23, s[12:15], s19 offen lds
  s_cmp_gt_u32 s23, 2
  s_cselect_b32 s26, s20, 0
  s_add_u32 s19, s19, s26
  s_add_u32 s25, s25, 32768
  s_and_b32 s25, s25, 0x1ffff
  s_waitcnt vmcnt(0)
  s_barrier
  s_cmp_eq_u32 s48, 0
  s_cselect_b32 s26, 0, s16
  s_cmp_ge_u32 s26, 2
  s_cbranch_scc1 P_v_1
  s_mov_b32 s27, s21
  v_mov_b32 v7, 0x40000000
  s_mov_b32 s29, -3
  v_min_u32 v145, 1, v0
  v_lshlrev_b32 v145, 30, v145
  ds_read_b128 v[24:27], v8 offset:0
  ds_read_b128 v[28:31], v9 offset:0
  ds_read_b128 v[32:35], v10 offset:0
  ds_read_b128 v[36:39], v11 offset:0
  ds_read_b128 v[40:43], v12 offset:0
  ds_read_b128 v[44:47], v13 offset:0
.p2align 6
G_top_3:
  s_waitcnt lgkmcnt(5)
  v_mfma_f32_32x32x16_bf16 v[64:79], a[0:3], v[24:27], 0
  s_add_u32 m0, s25, 0
  ds_read_b128 v[48:51], v14 offset:0
  v_mfma_f32_32x32x16_bf16 v[80:95], a[4:7], v[24:27], 0
  s_waitcnt lgkmcnt(5)
  buffer_load_dwordx4 v16, s[12:15], s19 offen lds
  v_mfma_f32_32x32x16_bf16 v[64:79], a[8:11], v[28:31], v[64:79]
  ds_read_b128 v[52:55], v15 offset:0
  v_mul_f32 v96, s24, v96
  v_mul_f32 v97, s24, v97
  v_mfma_f32_32x32x16_bf16 v[80:95], a[12:15], v[28:31], v[80:95]
  s_waitcnt lgkmcnt(5)
  v_cvt_pk_bf16_f32 v128, v96, v97
  v_mul_f32 v98, s24, v98
  v_mfma_f32_32x32x16_bf16 v[64:79], a[16:19], v[32:35], v[64:79]
  s_add_u32 m0, s25, 1024
  ds_read_b128 v[24:27], v8 offset:8192
  v_mul_f32 v99, s24, v99
  v_cvt_pk_bf16_f32 v129, v98, v99
  v_mfma_f32_32x32x16_bf16 v[80:95], a[20:23], v[32:35], v[80:95]
  s_waitcnt lgkmcnt(5)
  buffer_load_dwordx4 v17, s[12:15], s19 offen lds
  v_mul_f32 v100, s24, v100
  v_mul_f32 v101, s24, v101
  v_mfma_f32_32x32x16_bf16 v[64:79], a[24:27], v[36:39], v[64:79]
  ds_read_b128 v[28:31], v9 offset:8192
  v_cvt_pk_bf16_f32 v130, v100, v101
  v_mul_f32 v102, s24, v102
  v_mfma_f32_32x32x16_bf16 v[80:95], a[28:31], v[36:39], v[80:95]
  s_waitcnt lgkmcnt(5)
  v_mul_f32 v103, s24, v103
  v_cvt_pk_bf16_f32 v131, v102, v103
  v_mfma_f32_32x32x16_bf16 v[64:79], a[32:35], v[40:43], v[64:79]
  s_add_u32 m0, s25, 2048
  ds_read_b128 v[32:35], v10 offset:8192
  v_mul_f32 v104, s24, v104
  v_mul_f32 v105, s24, v105
  v_mfma_f32_32x32x16_bf16 v[80:95], a[36:39], v[40:43], v[80:95]
  s_waitcnt lgkmcnt(5)
  buffer_load_dwordx4 v18, s[12:15], s19 offen lds
  v_cvt_pk_bf16_f32 v132, v104, v105
  v_mul_f32 v106, s24, v106
  v_mfma_f32_32x32x16_bf16 v[64:79], a[40:43], v[44:47], v[64:79]
  ds_read_b128 v[36:39], v11 offset:8192
  v_mul_f32 v107, s24, v107
  v_cvt_pk_bf16_f32 v133, v106, v107
  v_mfma_f32_32x32x16_bf16 v[80:95], a[44:47], v[44:47], v[80:95]
  s_waitcnt lgkmcnt(5)
  v_mul_f32 v108, s24, v108
  v_mul_f32 v109, s24, v109
  v_mfma_f32_32x32x16_bf16 v[64:79], a[48:51], v[48:51], v[64:79]
  s_add_u32 m0, s25, 3072
  ds_read_b128 v[40:43], v12 offset:8192
  v_cvt_pk_bf16_f32 v134, v108, v109
  v_mul_f32 v110, s24, v110
  v_mfma_f32_32x32x16_bf16 v[80:95], a[52:55], v[48:51], v[80:95]
  s_waitcnt lgkmcnt(5)
  buffer_load_dwordx4 v19, s[12:15], s19 offen lds
  v_mul_f32 v111, s24, v111
  v_cvt_pk_bf16_f32 v135, v110, v111
  v_mfma_f32_32x32x16_bf16 v[64:79], a[56:59], v[52:55], v[64:79]
  ds_read_b128 v[44:47], v13 offset:8192
  v_mul_f32 v112, s24, v112
  v_mul_f32 v113, s24, v113
  v_mfma_f32_32x32x16_bf16 v[80:95], a[60:63], v[52:55], v[80:95]
  s_waitcnt lgkmcnt(5)
  v_cvt_pk_bf16_f32 v136, v112, v113
  v_mul_f32 v114, s24, v114
  v_mfma_f32_32x32x16_bf16 v[64:79], a[64:67], v[24:27], v[64:79]
  s_add_u32 m0, s25, 4096
  ds_read_b128 v[48:51], v14 offset:8192
  v_mul_f32 v115, s24, v115
  v_cvt_pk_bf16_f32 v137, v114, v115
  v_mfma_f32_32x32x16_bf16 v[80:95], a[68:71], v[24:27], v[80:95]
  s_waitcnt lgkmcnt(5)
  buffer_load_dwordx4 v20, s[12:15], s19 offen lds
  v_mul_f32 v116, s24, v116
  v_mul_f32 v117, s24, v117
  v_mfma_f32_32x32x16_bf16 v[64:79], a[72:75], v[28:31], v[64:79]
  ds_read_b128 v[52:55], v15 offset:8192
  v_cvt_pk_bf16_f32 v138, v116, v117
  v_mul_f32 v118, s24, v118
  v_mfma_f32_32x32x16_bf16 v[80:95], a[76:79], v[28:31], v[80:95]
  s_waitcnt lgkmcnt(5)
  v_mul_f32 v119, s24, v119
  v_cvt_pk_bf16_f32 v139, v118, v119
  v_mfma_f32_32x32x16_bf16 v[64:79], a[80:83], v[32:35], v[64:79]
  s_add_u32 m0, s25, 5120
  ds_read_b128 v[24:27], v8 offset:16384
  v_mul_f32 v120, s24, v120
  v_mul_f32 v121, s24, v121
  v_mfma_f32_32x32x16_bf16 v[80:95], a[84:87], v[32:35], v[80:95]
  s_waitcnt lgkmcnt(5)
  buffer_load_dwordx4 v21, s[12:15], s19 offen lds
  v_cvt_pk_bf16_f32 v140, v120, v121
  v_mul_f32 v122, s24, v122
  v_mfma_f32_32x32x16_bf16 v[64:79], a[88:91], v[36:39], v[64:79]
  ds_read_b128 v[28:31], v9 offset:16384
  v_mul_f32 v123, s24, v123
  v_cvt_pk_bf16_f32 v141, v122, v123
  v_mfma_f32_32x32x16_bf16 v[80:95], a[92:95], v[36:39], v[80:95]
  s_waitcnt lgkmcnt(5)
  v_mul_f32 v124, s24, v124
  v_mul_f32 v125, s24, v125
  v_mfma_f32_32x32x16_bf16 v[64:79], a[96:99], v[40:43], v[64:79]
  s_add_u32 m0, s25, 6144
  ds_read_b128 v[32:35], v10 offset:16384
  v_cvt_pk_bf16_f32 v142, v124, v125
  v_mul_f32 v126, s24, v126
  v_mfma_f32_32x32x16_bf16 v[80:95], a[100:103], v[40:43], v[80:95]
  s_waitcnt lgkmcnt(5)
  buffer_load_dwordx4 v22, s[12:15], s19 offen lds
  v_mul_f32 v127, s24, v127
  v_cvt_pk_bf16_f32 v143, v126, v127
  v_mfma_f32_32x32x16_bf16 v[64:79], a[104:107], v[44:47], v[64:79]
  ds_read_b128 v[36:39], v11 offset:16384
  v_mfma_f32_32x32x16_bf16 v[80:95], a[108:111], v[44:47], v[80:95]
  s_waitcnt lgkmcnt(5)
  v_mfma_f32_32x32x16_bf16 v[64:79], a[112:115], v[48:51], v[64:79]
  s_add_u32 m0, s25, 7168
  ds_read_b128 v[40:43], v12 offset:16384
  v_mfma_f32_32x32x16_bf16 v[80:95], a[116:119], v[48:51], v[80:95]
  s_waitcnt lgkmcnt(5)
  buffer_load_dwordx4 v23, s[12:15], s19 offen lds
  v_mfma_f32_32x32x16_bf16 v[64:79], a[120:123], v[52:55], v[64:79]
  s_cmp_gt_u32 s23, 3
  ds_read_b128 v[44:47], v13 offset:16384
  v_mfma_f32_32x32x16_bf16 v[80:95], a[124:127], v[52:55], v[80:95]
  s_waitcnt lgkmcnt(5)
  s_cselect_b32 s26, s20, 0
  v_mfma_f32_32x32x16_bf16 v[64:79], a[128:131], v[24:27], v[64:79]
  s_add_u32 s19, s19, s26
  ds_read_b128 v[48:51], v14 offset:16384
  v_mfma_f32_32x32x16_bf16 v[80:95], a[132:135], v[24:27], v[80:95]
  s_waitcnt lgkmcnt(5)
  s_add_u32 s25, s25, 32768
  v_mfma_f32_32x32x16_bf16 v[64:79], a[136:139], v[28:31], v[64:79]
  s_and_b32 s25, s25, 0x1ffff
  ds_read_b128 v[52:55], v15 offset:16384
  v_mfma_f32_32x32x16_bf16 v[80:95], a[140:143], v[28:31], v[80:95]
  s_waitcnt lgkmcnt(5)
  buffer_store_dwordx4 v[128:131], v7, s[4:7], s21 offen offset:0 sc1
  v_mfma_f32_32x32x16_bf16 v[64:79], a[144:147], v[32:35], v[64:79]
  ds_read_b128 v[24:27], v8 offset:24576
  v_mfma_f32_32x32x16_bf16 v[80:95], a[148:151], v[32:35], v[80:95]
  s_waitcnt lgkmcnt(5)
  v_mfma_f32_32x32x16_bf16 v[64:79], a[152:155], v[36:39], v[64:79]
  ds_read_b128 v[28:31], v9 offset:24576
  v_mfma_f32_32x32x16_bf16 v[80:95], a[156:159], v[36:39], v[80:95]
  s_waitcnt lgkmcnt(5)
  buffer_store_dwordx4 v[132:135], v7, s[4:7], s21 offen offset:1024 sc1
  v_mfma_f32_32x32x16_bf16 v[64:79], a[160:163], v[40:43], v[64:79]
  ds_read_b128 v[32:35], v10 offset:24576
  v_mfma_f32_32x32x16_bf16 v[80:95], a[164:167], v[40:43], v[80:95]
  s_waitcnt lgkmcnt(5)
  v_mfma_f32_32x32x16_bf16 v[64:79], a[168:171], v[44:47], v[64:79]
  ds_read_b128 v[36:39], v11 offset:24576
  v_mfma_f32_32x32x16_bf16 v[80:95], a[172:175], v[44:47], v[80:95]
  s_waitcnt lgkmcnt(5)
  buffer_store_dwordx4 v[136:139], v7, s[4:7], s21 offen offset:2048 sc1
  v_mfma_f32_32x32x16_bf16 v[64:79], a[176:179], v[48:51], v[64:79]
  ds_read_b128 v[40:43], v12 offset:24576
  v_mfma_f32_32x32x16_bf16 v[80:95], a[180:183], v[48:51], v[80:95]
  s_waitcnt lgkmcnt(5)
  v_mfma_f32_32x32x16_bf16 v[64:79], a[184:187], v[52:55], v[64:79]
  ds_read_b128 v[44:47], v13 offset:24576
  v_mfma_f32_32x32x16_bf16 v[80:95], a[188:191], v[52:55], v[80:95]
  s_waitcnt lgkmcnt(5)
  buffer_store_dwordx4 v[140:143], v7, s[4:7], s21 offen offset:3072 sc1
  v_mfma_f32_32x32x16_bf16 v[64:79], a[192:195], v[24:27], v[64:79]
  s_mov_b32 s21, s27
  ds_read_b128 v[48:51], v14 offset:24576
  v_mov_b32 v7, v2
  v_mfma_f32_32x32x16_bf16 v[80:95], a[196:199], v[24:27], v[80:95]
  s_waitcnt lgkmcnt(5)
  v_mfma_f32_32x32x16_bf16 v[64:79], a[200:203], v[28:31], v[64:79]
  s_add_u32 s27, s27, s22
  ds_read_b128 v[52:55], v15 offset:24576
  v_mfma_f32_32x32x16_bf16 v[80:95], a[204:207], v[28:31], v[80:95]
  s_waitcnt lgkmcnt(5)
  s_waitcnt vmcnt(17)
  s_barrier
  v_mfma_f32_32x32x16_bf16 v[64:79], a[208:211], v[32:35], v[64:79]
  ds_read_b128 v[24:27], v8 offset:32768
  v_mfma_f32_32x32x16_bf16 v[80:95], a[212:215], v[32:35], v[80:95]
  s_waitcnt lgkmcnt(5)
  v_mfma_f32_32x32x16_bf16 v[64:79], a[216:219], v[36:39], v[64:79]
  s_add_u32 s29, s29, 1
  ds_read_b128 v[28:31], v9 offset:32768
  v_mfma_f32_32x32x16_bf16 v[80:95], a[220:223], v[36:39], v[80:95]
  s_waitcnt lgkmcnt(5)
  s_max_i32 s30, s29, 0
  v_mov_b32 v144, s30
  v_mfma_f32_32x32x16_bf16 v[64:79], a[224:227], v[40:43], v[64:79]
  ds_read_b128 v[32:35], v10 offset:32768
  v_mfma_f32_32x32x16_bf16 v[80:95], a[228:231], v[40:43], v[80:95]
  s_waitcnt lgkmcnt(5)
  buffer_store_dword v144, v145, s[4:7], s31 offen sc1
  v_mfma_f32_32x32x16_bf16 v[64:79], a[232:235], v[44:47], v[64:79]
  ds_read_b128 v[36:39], v11 offset:32768
  v_mfma_f32_32x32x16_bf16 v[80:95], a[236:239], v[44:47], v[80:95]
  s_waitcnt lgkmcnt(5)
  v_mfma_f32_32x32x16_bf16 v[64:79], a[240:243], v[48:51], v[64:79]
  s_sub_u32 s23, s23, 1
  ds_read_b128 v[40:43], v12 offset:32768
  v_mfma_f32_32x32x16_bf16 v[80:95], a[244:247], v[48:51], v[80:95]
  s_waitcnt lgkmcnt(5)
  v_mfma_f32_32x32x16_bf16 v[64:79], a[248:251], v[52:55], v[64:79]
  s_cmp_eq_u32 s23, 0
  ds_read_b128 v[44:47], v13 offset:32768
  v_mfma_f32_32x32x16_bf16 v[80:95], a[252:255], v[52:55], v[80:95]
  s_cbranch_scc1 G_done0_4
  s_waitcnt lgkmcnt(5)
  v_mfma_f32_32x32x16_bf16 v[96:111], a[0:3], v[24:27], 0
  s_add_u32 m0, s25, 0
  ds_read_b128 v[48:51], v14 offset:32768
  v_mfma_f32_32x32x16_bf16 v[112:127], a[4:7], v[24:27], 0
  s_waitcnt lgkmcnt(5)
  buffer_load_dwordx4 v16, s[12:15], s19 offen lds
  v_mfma_f32_32x32x16_bf16 v[96:111], a[8:11], v[28:31], v[96:111]
  ds_read_b128 v[52:55], v15 offset:32768
  v_mul_f32 v64, s24, v64
  v_mul_f32 v65, s24, v65
  v_mfma_f32_32x32x16_bf16 v[112:127], a[12:15], v[28:31], v[112:127]
  s_waitcnt lgkmcnt(5)
  v_cvt_pk_bf16_f32 v128, v64, v65
  v_mul_f32 v66, s24, v66
  v_mfma_f32_32x32x16_bf16 v[96:111], a[16:19], v[32:35], v[96:111]
  s_add_u32 m0, s25, 1024
  ds_read_b128 v[24:27], v8 offset:40960
  v_mul_f32 v67, s24, v67
  v_cvt_pk_bf16_f32 v129, v66, v67
  v_mfma_f32_32x32x16_bf16 v[112:127], a[20:23], v[32:35], v[112:127]
  s_waitcnt lgkmcnt(5)
  buffer_load_dwordx4 v17, s[12:15], s19 offen lds
  v_mul_f32 v68, s24, v68
  v_mul_f32 v69, s24, v69
  v_mfma_f32_32x32x16_bf16 v[96:111], a[24:27], v[36:39], v[96:111]
  ds_read_b128 v[28:31], v9 offset:40960
  v_cvt_pk_bf16_f32 v130, v68, v69
  v_mul_f32 v70, s24, v70
  v_mfma_f32_32x32x16_bf16 v[112:127], a[28:31], v[36:39], v[112:127]
  s_waitcnt lgkmcnt(5)
  v_mul_f32 v71, s24, v71
  v_cvt_pk_bf16_f32 v131, v70, v71
  v_mfma_f32_32x32x16_bf16 v[96:111], a[32:35], v[40:43], v[96:111]
  s_add_u32 m0, s25, 2048
  ds_read_b128 v[32:35], v10 offset:40960
  v_mul_f32 v72, s24, v72
  v_mul_f32 v73, s24, v73
  v_mfma_f32_32x32x16_bf16 v[112:127], a[36:39], v[40:43], v[112:127]
  s_waitcnt lgkmcnt(5)
  buffer_load_dwordx4 v18, s[12:15], s19 offen lds
  v_cvt_pk_bf16_f32 v132, v72, v73
  v_mul_f32 v74, s24, v74
  v_mfma_f32_32x32x16_bf16 v[96:111], a[40:43], v[44:47], v[96:111]
  ds_read_b128 v[36:39], v11 offset:40960
  v_mul_f32 v75, s24, v75
  v_cvt_pk_bf16_f32 v133, v74, v75
  v_mfma_f32_32x32x16_bf16 v[112:127], a[44:47], v[44:47], v[112:127]
  s_waitcnt lgkmcnt(5)
  v_mul_f32 v76, s24, v76
  v_mul_f32 v77, s24, v77
  v_mfma_f32_32x32x16_bf16 v[96:111], a[48:51], v[48:51], v[96:111]
  s_add_u32 m0, s25, 3072
  ds_read_b128 v[40:43], v12 offset:40960
  v_cvt_pk_bf16_f32 v134, v76, v77
  v_mul_f32 v78, s24, v78
  v_mfma_f32_32x32x16_bf16 v[112:127], a[52:55], v[48:51], v[112:127]
  s_waitcnt lgkmcnt(5)
  buffer_load_dwordx4 v19, s[12:15], s19 offen lds
  v_mul_f32 v79, s24, v79
  v_cvt_pk_bf16_f32 v135, v78, v79
  v_mfma_f32_32x32x16_bf16 v[96:111], a[56:59], v[52:55], v[96:111]
  ds_read_b128 v[44:47], v13 offset:40960
  v_mul_f32 v80, s24, v80
  v_mul_f32 v81, s24, v81
  v_mfma_f32_32x32x16_bf16 v[112:127], a[60:63], v[52:55], v[112:127]
  s_waitcnt lgkmcnt(5)
  v_cvt_pk_bf16_f32 v136, v80, v81
  v_mul_f32 v82, s24, v82
  v_mfma_f32_32x32x16_bf16 v[96:111], a[64:67], v[24:27], v[96:111]
  s_add_u32 m0, s25, 4096
  ds_read_b128 v[48:51], v14 offset:40960
  v_mul_f32 v83, s24, v83
  v_cvt_pk_bf16_f32 v137, v82, v83
  v_mfma_f32_32x32x16_bf16 v[112:127], a[68:71], v[24:27], v[112:127]
  s_waitcnt lgkmcnt(5)
  buffer_load_dwordx4 v20, s[12:15], s19 offen lds
  v_mul_f32 v84, s24, v84
  v_mul_f32 v85, s24, v85
  v_mfma_f32_32x32x16_bf16 v[96:111], a[72:75], v[28:31], v[96:111]
  ds_read_b128 v[52:55], v15 offset:40960
  v_cvt_pk_bf16_f32 v138, v84, v85
  v_mul_f32 v86, s24, v86
  v_mfma_f32_32x32x16_bf16 v[112:127], a[76:79], v[28:31], v[112:127]
  s_waitcnt lgkmcnt(5)
  v_mul_f32 v87, s24, v87
  v_cvt_pk_bf16_f32 v139, v86, v87
  v_mfma_f32_32x32x16_bf16 v[96:111], a[80:83], v[32:35], v[96:111]
  s_add_u32 m0, s25, 5120
  ds_read_b128 v[24:27], v8 offset:49152
  v_mul_f32 v88, s24, v88
  v_mul_f32 v89, s24, v89
  v_mfma_f32_32x32x16_bf16 v[112:127], a[84:87], v[32:35], v[112:127]
  s_waitcnt lgkmcnt(5)
  buffer_load_dwordx4 v21, s[12:15], s19 offen lds
  v_cvt_pk_bf16_f32 v140, v88, v89
  v_mul_f32 v90, s24, v90
  v_mfma_f32_32x32x16_bf16 v[96:111], a[88:91], v[36:39], v[96:111]
  ds_read_b128 v[28:31], v9 offset:49152
  v_mul_f32 v91, s24, v91
  v_cvt_pk_bf16_f32 v141, v90, v91
  v_mfma_f32_32x32x16_bf16 v[112:127], a[92:95], v[36:39], v[112:127]
  s_waitcnt lgkmcnt(5)
  v_mul_f32 v92, s24, v92
  v_mul_f32 v93, s24, v93
  v_mfma_f32_32x32x16_bf16 v[96:111], a[96:99], v[40:43], v[96:111]
  s_add_u32 m0, s25, 6144
  ds_read_b128 v[32:35], v10 offset:49152
  v_cvt_pk_bf16_f32 v142, v92, v93
  v_mul_f32 v94, s24, v94
  v_mfma_f32_32x32x16_bf16 v[112:127], a[100:103], v[40:43], v[112:127]
  s_waitcnt lgkmcnt(5)
  buffer_load_dwordx4 v22, s[12:15], s19 offen lds
  v_mul_f32 v95, s24, v95
  v_cvt_pk_bf16_f32 v143, v94, v95
  v_mfma_f32_32x32x16_bf16 v[96:111], a[104:107], v[44:47], v[96:111]
  ds_read_b128 v[36:39], v11 offset:49152
  v_mfma_f32_32x32x16_bf16 v[112:127], a[108:111], v[44:47], v[112:127]
  s_waitcnt lgkmcnt(5)
  v_mfma_f32_32x32x16_bf16 v[96:111], a[112:115], v[48:51], v[96:111]
  s_add_u32 m0, s25, 7168
  ds_read_b128 v[40:43], v12 offset:49152
  v_mfma_f32_32x32x16_bf16 v[112:127], a[116:119], v[48:51], v[112:127]
  s_waitcnt lgkmcnt(5)
  buffer_load_dwordx4 v23, s[12:15], s19 offen lds
  v_mfma_f32_32x32x16_bf16 v[96:111], a[120:123], v[52:55], v[96:111]
  s_cmp_gt_u32 s23, 3
  ds_read_b128 v[44:47], v13 offset:49152
  v_mfma_f32_32x32x16_bf16 v[112:127], a[124:127], v[52:55], v[112:127]
  s_waitcnt lgkmcnt(5)
  s_cselect_b32 s26, s20, 0
  v_mfma_f32_32x32x16_bf16 v[96:111], a[128:131], v[24:27], v[96:111]
  s_add_u32 s19, s19, s26
  ds_read_b128 v[48:51], v14 offset:49152
  v_mfma_f32_32x32x16_bf16 v[112:127], a[132:135], v[24:27], v[112:127]
  s_waitcnt lgkmcnt(5)
  s_add_u32 s25, s25, 32768
  v_mfma_f32_32x32x16_bf16 v[96:111], a[136:139], v[28:31], v[96:111]
  s_and_b32 s25, s25, 0x1ffff
  ds_read_b128 v[52:55], v15 offset:49152
  v_mfma_f32_32x32x16_bf16 v[112:127], a[140:143], v[28:31], v[112:127]
  s_waitcnt lgkmcnt(5)
  buffer_store_dwordx4 v[128:131], v7, s[4:7], s21 offen offset:0 sc1
  v_mfma_f32_32x32x16_bf16 v[96:111], a[144:147], v[32:35], v[96:111]
  ds_read_b128 v[24:27], v8 offset:57344
  v_mfma_f32_32x32x16_bf16 v[112:127], a[148:151], v[32:35], v[112:127]
  s_waitcnt lgkmcnt(5)
  v_xor_b32 v8, 0x10000, v8
  v_mfma_f32_32x32x16_bf16 v[96:111], a[152:155], v[36:39], v[96:111]
  ds_read_b128 v[28:31], v9 offset:57344
  v_mfma_f32_32x32x16_bf16 v[112:127], a[156:159], v[36:39], v[112:127]
  s_waitcnt lgkmcnt(5)
  buffer_store_dwordx4 v[132:135], v7, s[4:7], s21 offen offset:1024 sc1
  v_xor_b32 v9, 0x10000, v9
  v_mfma_f32_32x32x16_bf16 v[96:111], a[160:163], v[40:43], v[96:111]
  ds_read_b128 v[32:35], v10 offset:57344
  v_mfma_f32_32x32x16_bf16 v[112:127], a[164:167], v[40:43], v[112:127]
  s_waitcnt lgkmcnt(5)
  v_xor_b32 v10, 0x10000, v10
  v_mfma_f32_32x32x16_bf16 v[96:111], a[168:171], v[44:47], v[96:111]
  ds_read_b128 v[36:39], v11 offset:57344
  v_mfma_f32_32x32x16_bf16 v[112:127], a[172:175], v[44:47], v[112:127]
  s_waitcnt lgkmcnt(5)
  buffer_store_dwordx4 v[136:139], v7, s[4:7], s21 offen offset:2048 sc1
  v_xor_b32 v11, 0x10000, v11
  v_mfma_f32_32x32x16_bf16 v[96:111], a[176:179], v[48:51], v[96:111]
  ds_read_b128 v[40:43], v12 offset:57344
  v_mfma_f32_32x32x16_bf16 v[112:127], a[180:183], v[48:51], v[112:127]
  s_waitcnt lgkmcnt(5)
  v_xor_b32 v12, 0x10000, v12
  v_mfma_f32_32x32x16_bf16 v[96:111], a[184:187], v[52:55], v[96:111]
  ds_read_b128 v[44:47], v13 offset:57344
  v_mfma_f32_32x32x16_bf16 v[112:127], a[188:191], v[52:55], v[112:127]
  s_waitcnt lgkmcnt(5)
  buffer_store_dwordx4 v[140:143], v7, s[4:7], s21 offen offset:3072 sc1
  v_xor_b32 v13, 0x10000, v13
  v_mfma_f32_32x32x16_bf16 v[96:111], a[192:195], v[24:27], v[96:111]
  s_mov_b32 s21, s27
  ds_read_b128 v[48:51], v14 offset:57344
  v_mov_b32 v7, v2
  v_mfma_f32_32x32x16_bf16 v[112:127], a[196:199], v[24:27], v[112:127]
  s_waitcnt lgkmcnt(5)
  v_xor_b32 v14, 0x10000, v14
  v_mfma_f32_32x32x16_bf16 v[96:111], a[200:203], v[28:31], v[96:111]
  s_add_u32 s27, s27, s22
  ds_read_b128 v[52:55], v15 offset:57344
  v_mfma_f32_32x32x16_bf16 v[112:127], a[204:207], v[28:31], v[112:127]
  s_waitcnt lgkmcnt(5)
  s_waitcnt vmcnt(17)
  s_barrier
  v_xor_b32 v15, 0x10000, v15
  v_mfma_f32_32x32x16_bf16 v[96:111], a[208:211], v[32:35], v[96:111]
  ds_read_b128 v[24:27], v8 offset:0
  v_mfma_f32_32x32x16_bf16 v[112:127], a[212:215], v[32:35], v[112:127]
  s_waitcnt lgkmcnt(5)
  v_mfma_f32_32x32x16_bf16 v[96:111], a[216:219], v[36:39], v[96:111]
  s_add_u32 s29, s29, 1
  ds_read_b128 v[28:31], v9 offset:0
  v_mfma_f32_32x32x16_bf16 v[112:127], a[220:223], v[36:39], v[112:127]
  s_waitcnt lgkmcnt(5)
  s_max_i32 s30, s29, 0
  v_mov_b32 v144, s30
  v_mfma_f32_32x32x16_bf16 v[96:111], a[224:227], v[40:43], v[96:111]
  ds_read_b128 v[32:35], v10 offset:0
  v_mfma_f32_32x32x16_bf16 v[112:127], a[228:231], v[40:43], v[112:127]
  s_waitcnt lgkmcnt(5)
  buffer_store_dword v144, v145, s[4:7], s31 offen sc1
  v_mfma_f32_32x32x16_bf16 v[96:111], a[232:235], v[44:47], v[96:111]
  ds_read_b128 v[36:39], v11 offset:0
  v_mfma_f32_32x32x16_bf16 v[112:127], a[236:239], v[44:47], v[112:127]
  s_waitcnt lgkmcnt(5)
  v_mfma_f32_32x32x16_bf16 v[96:111], a[240:243], v[48:51], v[96:111]
  s_sub_u32 s23, s23, 1
  ds_read_b128 v[40:43], v12 offset:0
  v_mfma_f32_32x32x16_bf16 v[112:127], a[244:247], v[48:51], v[112:127]
  s_waitcnt lgkmcnt(5)
  v_mfma_f32_32x32x16_bf16 v[96:111], a[248:251], v[52:55], v[96:111]
  s_cmp_eq_u32 s23, 0
  ds_read_b128 v[44:47], v13 offset:0
  v_mfma_f32_32x32x16_bf16 v[112:127], a[252:255], v[52:55], v[112:127]
  s_cbranch_scc1 G_done1_5
  s_branch G_top_3
G_done0_4:
  s_nop 7
  s_nop 3
  v_mul_f32 v64, s24, v64
  v_mul_f32 v65, s24, v65
  v_cvt_pk_bf16_f32 v128, v64, v65
  v_mul_f32 v66, s24, v66
  v_mul_f32 v67, s24, v67
  v_cvt_pk_bf16_f32 v129, v66, v67
  v_mul_f32 v68, s24, v68
  v_mul_f32 v69, s24, v69
  v_cvt_pk_bf16_f32 v130, v68, v69
  v_mul_f32 v70, s24, v70
  v_mul_f32 v71, s24, v71
  v_cvt_pk_bf16_f32 v131, v70, v71
  buffer_store_dwordx4 v[128:131], v7, s[4:7], s21 offen offset:0 sc1
  v_mul_f32 v72, s24, v72
  v_mul_f32 v73, s24, v73
  v_cvt_pk_bf16_f32 v132, v72, v73
  v_mul_f32 v74, s24, v74
  v_mul_f32 v75, s24, v75
  v_cvt_pk_bf16_f32 v133, v74, v75
  v_mul_f32 v76, s24, v76
  v_mul_f32 v77, s24, v77
  v_cvt_pk_bf16_f32 v134, v76, v77
  v_mul_f32 v78, s24, v78
  v_mul_f32 v79, s24, v79
  v_cvt_pk_bf16_f32 v135, v78, v79
  buffer_store_dwordx4 v[132:135], v7, s[4:7], s21 offen offset:1024 sc1
  v_mul_f32 v80, s24, v80
  v_mul_f32 v81, s24, v81
  v_cvt_pk_bf16_f32 v136, v80, v81
  v_mul_f32 v82, s24, v82
  v_mul_f32 v83, s24, v83
  v_cvt_pk_bf16_f32 v137, v82, v83
  v_mul_f32 v84, s24, v84
  v_mul_f32 v85, s24, v85
  v_cvt_pk_bf16_f32 v138, v84, v85
  v_mul_f32 v86, s24, v86
  v_mul_f32 v87, s24, v87
  v_cvt_pk_bf16_f32 v139, v86, v87
  buffer_store_dwordx4 v[136:139], v7, s[4:7], s21 offen offset:2048 sc1
  v_mul_f32 v88, s24, v88
  v_mul_f32 v89, s24, v89
  v_cvt_pk_bf16_f32 v140, v88, v89
  v_mul_f32 v90, s24, v90
  v_mul_f32 v91, s24, v91
  v_cvt_pk_bf16_f32 v141, v90, v91
  v_mul_f32 v92, s24, v92
  v_mul_f32 v93, s24, v93
  v_cvt_pk_bf16_f32 v142, v92, v93
  v_mul_f32 v94, s24, v94
  v_mul_f32 v95, s24, v95
  v_cvt_pk_bf16_f32 v143, v94, v95
  buffer_store_dwordx4 v[140:143], v7, s[4:7], s21 offen offset:3072 sc1
  s_branch G_fin_6
G_done1_5:
  s_nop 7
  s_nop 3
  v_mul_f32 v96, s24, v96
  v_mul_f32 v97, s24, v97
  v_cvt_pk_bf16_f32 v128, v96, v97
  v_mul_f32 v98, s24, v98
  v_mul_f32 v99, s24, v99
  v_cvt_pk_bf16_f32 v129, v98, v99
  v_mul_f32 v100, s24, v100
  v_mul_f32 v101, s24, v101
  v_cvt_pk_bf16_f32 v130, v100, v101
  v_mul_f32 v102, s24, v102
  v_mul_f32 v103, s24, v103
  v_cvt_pk_bf16_f32 v131, v102, v103
  buffer_store_dwordx4 v[128:131], v7, s[4:7], s21 offen offset:0 sc1
  v_mul_f32 v104, s24, v104
  v_mul_f32 v105, s24, v105
  v_cvt_pk_bf16_f32 v132, v104, v105
  v_mul_f32 v106, s24, v106
  v_mul_f32 v107, s24, v107
  v_cvt_pk_bf16_f32 v133, v106, v107
  v_mul_f32 v108, s24, v108
  v_mul_f32 v109, s24, v109
  v_cvt_pk_bf16_f32 v134, v108, v109
  v_mul_f32 v110, s24, v110
  v_mul_f32 v111, s24, v111
  v_cvt_pk_bf16_f32 v135, v110, v111
  buffer_store_dwordx4 v[132:135], v7, s[4:7], s21 offen offset:1024 sc1
  v_mul_f32 v112, s24, v112
  v_mul_f32 v113, s24, v113
  v_cvt_pk_bf16_f32 v136, v112, v113
  v_mul_f32 v114, s24, v114
  v_mul_f32 v115, s24, v115
  v_cvt_pk_bf16_f32 v137, v114, v115
  v_mul_f32 v116, s24, v116
  v_mul_f32 v117, s24, v117
  v_cvt_pk_bf16_f32 v138, v116, v117
  v_mul_f32 v118, s24, v118
  v_mul_f32 v119, s24, v119
  v_cvt_pk_bf16_f32 v139, v118, v119
  buffer_store_dwordx4 v[136:139], v7, s[4:7], s21 offen offset:2048 sc1
  v_mul_f32 v120, s24, v120
  v_mul_f32 v121, s24, v121
  v_cvt_pk_bf16_f32 v140, v120, v121
  v_mul_f32 v122, s24, v122
  v_mul_f32 v123, s24, v123
  v_cvt_pk_bf16_f32 v141, v122, v123
  v_mul_f32 v124, s24, v124
  v_mul_f32 v125, s24, v125
  v_cvt_pk_bf16_f32 v142, v124, v125
  v_mul_f32 v126, s24, v126
  v_mul_f32 v127, s24, v127
  v_cvt_pk_bf16_f32 v143, v126, v127
  buffer_store_dwordx4 v[140:143], v7, s[4:7], s21 offen offset:3072 sc1
G_fin_6:
  s_waitcnt vmcnt(0) lgkmcnt(0)
  s_barrier
  s_add_u32 s30, s29, 3
  v_mov_b32 v144, s30
  v_min_u32 v145, 1, v0
  v_lshlrev_b32 v145, 30, v145
  buffer_store_dword v144, v145, s[4:7], s31 offen sc1
  s_branch P_end_2
P_v_1:
  s_mov_b32 s27, s21
  v_mov_b32 v7, 0x40000000
  s_mov_b32 s29, -3
  v_min_u32 v145, 1, v0
  v_lshlrev_b32 v145, 30, v145
  ds_read_b128 v[24:27], v8 offset:0
  ds_read_b128 v[28:31], v9 offset:0
  ds_read_b128 v[32:35], v10 offset:0
  ds_read_b128 v[36:39], v11 offset:0
  ds_read_b128 v[40:43], v12 offset:0
  ds_read_b128 v[44:47], v13 offset:0
.p2align 6
G_top_7:
  s_waitcnt lgkmcnt(5)
  v_mfma_f32_32x32x16_bf16 v[64:79], v[24:27], a[0:3], 0
  s_add_u32 m0, s25, 0
  ds_read_b128 v[48:51], v14 offset:0
  v_mfma_f32_32x32x16_bf16 v[80:95], v[24:27], a[4:7], 0
  s_waitcnt lgkmcnt(5)
  buffer_load_dwordx4 v16, s[12:15], s19 offen lds
  v_mfma_f32_32x32x16_bf16 v[64:79], v[28:31], a[8:11], v[64:79]
  ds_read_b128 v[52:55], v15 offset:0
  v_mul_f32 v96, s24, v96
  v_mul_f32 v97, s24, v97
  v_mfma_f32_32x32x16_bf16 v[80:95], v[28:31], a[12:15], v[80:95]
  s_waitcnt lgkmcnt(5)
  v_cvt_pk_bf16_f32 v128, v96, v97
  v_mul_f32 v98, s24, v98
  v_mfma_f32_32x32x16_bf16 v[64:79], v[32:35], a[16:19], v[64:79]
  s_add_u32 m0, s25, 1024
  ds_read_b128 v[24:27], v8 offset:8192
  v_mul_f32 v99, s24, v99
  v_cvt_pk_bf16_f32 v129, v98, v99
  v_mfma_f32_32x32x16_bf16 v[80:95], v[32:35], a[20:23], v[80:95]
  s_waitcnt lgkmcnt(5)
  buffer_load_dwordx4 v17, s[12:15], s19 offen lds
  v_mul_f32 v100, s24, v100
  v_mul_f32 v101, s24, v101
  v_mfma_f32_32x32x16_bf16 v[64:79], v[36:39], a[24:27], v[64:79]
  ds_read_b128 v[28:31], v9 offset:8192
  v_cvt_pk_bf16_f32 v130, v100, v101
  v_mul_f32 v102, s24, v102
  v_mfma_f32_32x32x16_bf16 v[80:95], v[36:39], a[28:31], v[80:95]
  s_waitcnt lgkmcnt(5)
  v_mul_f32 v103, s24, v103
  v_cvt_pk_bf16_f32 v131, v102, v103
  v_mfma_f32_32x32x16_bf16 v[64:79], v[40:43], a[32:35], v[64:79]
  s_add_u32 m0, s25, 2048
  ds_read_b128 v[32:35], v10 offset:8192
  v_mul_f32 v104, s24, v104
  v_mul_f32 v105, s24, v105
  v_mfma_f32_32x32x16_bf16 v[80:95], v[40:43], a[36:39], v[80:95]
  s_waitcnt lgkmcnt(5)
  buffer_load_dwordx4 v18, s[12:15], s19 offen lds
  v_cvt_pk_bf16_f32 v132, v104, v105
  v_mul_f32 v106, s24, v106
  v_mfma_f32_32x32x16_bf16 v[64:79], v[44:47], a[40:43], v[64:79]
  ds_read_b128 v[36:39], v11 offset:8192
  v_mul_f32 v107, s24, v107
  v_cvt_pk_bf16_f32 v133, v106, v107
  v_mfma_f32_32x32x16_bf16 v[80:95], v[44:47], a[44:47], v[80:95]
  s_waitcnt lgkmcnt(5)
  v_mul_f32 v108, s24, v108
  v_mul_f32 v109, s24, v109
  v_mfma_f32_32x32x16_bf16 v[64:79], v[48:51], a[48:51], v[64:79]
  s_add_u32 m0, s25, 3072
  ds_read_b128 v[40:43], v12 offset:8192
  v_cvt_pk_bf16_f32 v134, v108, v109
  v_mul_f32 v110, s24, v110
  v_mfma_f32_32x32x16_bf16 v[80:95], v[48:51], a[52:55], v[80:95]
  s_waitcnt lgkmcnt(5)
  buffer_load_dwordx4 v19, s[12:15], s19 offen lds
  v_mul_f32 v111, s24, v111
  v_cvt_pk_bf16_f32 v135, v110, v111
  v_mfma_f32_32x32x16_bf16 v[64:79], v[52:55], a[56:59], v[64:79]
  ds_read_b128 v[44:47], v13 offset:8192
  v_mul_f32 v112, s24, v112
  v_mul_f32 v113, s24, v113
  v_mfma_f32_32x32x16_bf16 v[80:95], v[52:55], a[60:63], v[80:95]
  s_waitcnt lgkmcnt(5)
  v_cvt_pk_bf16_f32 v136, v112, v113
  v_mul_f32 v114, s24, v114
  v_mfma_f32_32x32x16_bf16 v[64:79], v[24:27], a[64:67], v[64:79]
  s_add_u32 m0, s25, 4096
  ds_read_b128 v[48:51], v14 offset:8192
  v_mul_f32 v115, s24, v115
  v_cvt_pk_bf16_f32 v137, v114, v115
  v_mfma_f32_32x32x16_bf16 v[80:95], v[24:27], a[68:71], v[80:95]
  s_waitcnt lgkmcnt(5)
  buffer_load_dwordx4 v20, s[12:15], s19 offen lds
  v_mul_f32 v116, s24, v116
  v_mul_f32 v117, s24, v117
  v_mfma_f32_32x32x16_bf16 v[64:79], v[28:31], a[72:75], v[64:79]
  ds_read_b128 v[52:55], v15 offset:8192
  v_cvt_pk_bf16_f32 v138, v116, v117
  v_mul_f32 v118, s24, v118
  v_mfma_f32_32x32x16_bf16 v[80:95], v[28:31], a[76:79], v[80:95]
  s_waitcnt lgkmcnt(5)
  v_mul_f32 v119, s24, v119
  v_cvt_pk_bf16_f32 v139, v118, v119
  v_mfma_f32_32x32x16_bf16 v[64:79], v[32:35], a[80:83], v[64:79]
  s_add_u32 m0, s25, 5120
  ds_read_b128 v[24:27], v8 offset:16384
  v_mul_f32 v120, s24, v120
  v_mul_f32 v121, s24, v121
  v_mfma_f32_32x32x16_bf16 v[80:95], v[32:35], a[84:87], v[80:95]
  s_waitcnt lgkmcnt(5)
  buffer_load_dwordx4 v21, s[12:15], s19 offen lds
  v_cvt_pk_bf16_f32 v140, v120, v121
  v_mul_f32 v122, s24, v122
  v_mfma_f32_32x32x16_bf16 v[64:79], v[36:39], a[88:91], v[64:79]
  ds_read_b128 v[28:31], v9 offset:16384
  v_mul_f32 v123, s24, v123
  v_cvt_pk_bf16_f32 v141, v122, v123
  v_mfma_f32_32x32x16_bf16 v[80:95], v[36:39], a[92:95], v[80:95]
  s_waitcnt lgkmcnt(5)
  v_mul_f32 v124, s24, v124
  v_mul_f32 v125, s24, v125
  v_mfma_f32_32x32x16_bf16 v[64:79], v[40:43], a[96:99], v[64:79]
  s_add_u32 m0, s25, 6144
  ds_read_b128 v[32:35], v10 offset:16384
  v_cvt_pk_bf16_f32 v142, v124, v125
  v_mul_f32 v126, s24, v126
  v_mfma_f32_32x32x16_bf16 v[80:95], v[40:43], a[100:103], v[80:95]
  s_waitcnt lgkmcnt(5)
  buffer_load_dwordx4 v22, s[12:15], s19 offen lds
  v_mul_f32 v127, s24, v127
  v_cvt_pk_bf16_f32 v143, v126, v127
  v_mfma_f32_32x32x16_bf16 v[64:79], v[44:47], a[104:107], v[64:79]
  ds_read_b128 v[36:39], v11 offset:16384
  v_mfma_f32_32x32x16_bf16 v[80:95], v[44:47], a[108:111], v[80:95]
  s_waitcnt lgkmcnt(5)
  v_mfma_f32_32x32x16_bf16 v[64:79], v[48:51], a[112:115], v[64:79]
  s_add_u32 m0, s25, 7168
  ds_read_b128 v[40:43], v12 offset:16384
  v_mfma_f32_32x32x16_bf16 v[80:95], v[48:51], a[116:119], v[80:95]
  s_waitcnt lgkmcnt(5)
  buffer_load_dwordx4 v23, s[12:15], s19 offen lds
  v_mfma_f32_32x32x16_bf16 v[64:79], v[52:55], a[120:123], v[64:79]
  s_cmp_gt_u32 s23, 3
  ds_read_b128 v[44:47], v13 offset:16384
  v_mfma_f32_32x32x16_bf16 v[80:95], v[52:55], a[124:127], v[80:95]
  s_waitcnt lgkmcnt(5)
  s_cselect_b32 s26, s20, 0
  v_mfma_f32_32x32x16_bf16 v[64:79], v[24:27], a[128:131], v[64:79]
  s_add_u32 s19, s19, s26
  ds_read_b128 v[48:51], v14 offset:16384
  v_mfma_f32_32x32x16_bf16 v[80:95], v[24:27], a[132:135], v[80:95]
  s_waitcnt lgkmcnt(5)
  s_add_u32 s25, s25, 32768
  v_mfma_f32_32x32x16_bf16 v[64:79], v[28:31], a[136:139], v[64:79]
  s_and_b32 s25, s25, 0x1ffff
  ds_read_b128 v[52:55], v15 offset:16384
  v_mfma_f32_32x32x16_bf16 v[80:95], v[28:31], a[140:143], v[80:95]
  s_waitcnt lgkmcnt(5)
  buffer_store_dwordx4 v[128:131], v7, s[4:7], s21 offen offset:0 sc1
  v_mfma_f32_32x32x16_bf16 v[64:79], v[32:35], a[144:147], v[64:79]
  ds_read_b128 v[24:27], v8 offset:24576
  v_mfma_f32_32x32x16_bf16 v[80:95], v[32:35], a[148:151], v[80:95]
  s_waitcnt lgkmcnt(5)
  v_mfma_f32_32x32x16_bf16 v[64:79], v[36:39], a[152:155], v[64:79]
  ds_read_b128 v[28:31], v9 offset:24576
  v_mfma_f32_32x32x16_bf16 v[80:95], v[36:39], a[156:159], v[80:95]
  s_waitcnt lgkmcnt(5)
  buffer_store_dwordx4 v[132:135], v7, s[4:7], s21 offen offset:1024 sc1
  v_mfma_f32_32x32x16_bf16 v[64:79], v[40:43], a[160:163], v[64:79]
  ds_read_b128 v[32:35], v10 offset:24576
  v_mfma_f32_32x32x16_bf16 v[80:95], v[40:43], a[164:167], v[80:95]
  s_waitcnt lgkmcnt(5)
  v_mfma_f32_32x32x16_bf16 v[64:79], v[44:47], a[168:171], v[64:79]
  ds_read_b128 v[36:39], v11 offset:24576
  v_mfma_f32_32x32x16_bf16 v[80:95], v[44:47], a[172:175], v[80:95]
  s_waitcnt lgkmcnt(5)
  buffer_store_dwordx4 v[136:139], v7, s[4:7], s21 offen offset:2048 sc1
  v_mfma_f32_32x32x16_bf16 v[64:79], v[48:51], a[176:179], v[64:79]
  ds_read_b128 v[40:43], v12 offset:24576
  v_mfma_f32_32x32x16_bf16 v[80:95], v[48:51], a[180:183], v[80:95]
  s_waitcnt lgkmcnt(5)
  v_mfma_f32_32x32x16_bf16 v[64:79], v[52:55], a[184:187], v[64:79]
  ds_read_b128 v[44:47], v13 offset:24576
  v_mfma_f32_32x32x16_bf16 v[80:95], v[52:55], a[188:191], v[80:95]
  s_waitcnt lgkmcnt(5)
  buffer_store_dwordx4 v[140:143], v7, s[4:7], s21 offen offset:3072 sc1
  v_mfma_f32_32x32x16_bf16 v[64:79], v[24:27], a[192:195], v[64:79]
  s_mov_b32 s21, s27
  ds_read_b128 v[48:51], v14 offset:24576
  v_mov_b32 v7, v2
  v_mfma_f32_32x32x16_bf16 v[80:95], v[24:27], a[196:199], v[80:95]
  s_waitcnt lgkmcnt(5)
  v_mfma_f32_32x32x16_bf16 v[64:79], v[28:31], a[200:203], v[64:79]
  s_add_u32 s27, s27, s22
  ds_read_b128 v[52:55], v15 offset:24576
  v_mfma_f32_32x32x16_bf16 v[80:95], v[28:31], a[204:207], v[80:95]
  s_waitcnt lgkmcnt(5)
  s_waitcnt vmcnt(17)
  s_barrier
  v_mfma_f32_32x32x16_bf16 v[64:79], v[32:35], a[208:211], v[64:79]
  ds_read_b128 v[24:27], v8 offset:32768
  v_mfma_f32_32x32x16_bf16 v[80:95], v[32:35], a[212:215], v[80:95]
  s_waitcnt lgkmcnt(5)
  v_mfma_f32_32x32x16_bf16 v[64:79], v[36:39], a[216:219], v[64:79]
  s_add_u32 s29, s29, 1
  ds_read_b128 v[28:31], v9 offset:32768
  v_mfma_f32_32x32x16_bf16 v[80:95], v[36:39], a[220:223], v[80:95]
  s_waitcnt lgkmcnt(5)
  s_max_i32 s30, s29, 0
  v_mov_b32 v144, s30
  v_mfma_f32_32x32x16_bf16 v[64:79], v[40:43], a[224:227], v[64:79]
  ds_read_b128 v[32:35], v10 offset:32768
  v_mfma_f32_32x32x16_bf16 v[80:95], v[40:43], a[228:231], v[80:95]
  s_waitcnt lgkmcnt(5)
  buffer_store_dword v144, v145, s[4:7], s31 offen sc1
  v_mfma_f32_32x32x16_bf16 v[64:79], v[44:47], a[232:235], v[64:79]
  ds_read_b128 v[36:39], v11 offset:32768
  v_mfma_f32_32x32x16_bf16 v[80:95], v[44:47], a[236:239], v[80:95]
  s_waitcnt lgkmcnt(5)
  v_mfma_f32_32x32x16_bf16 v[64:79], v[48:51], a[240:243], v[64:79]
  s_sub_u32 s23, s23, 1
  ds_read_b128 v[40:43], v12 offset:32768
  v_mfma_f32_32x32x16_bf16 v[80:95], v[48:51], a[244:247], v[80:95]
  s_waitcnt lgkmcnt(5)
  v_mfma_f32_32x32x16_bf16 v[64:79], v[52:55], a[248:251], v[64:79]
  s_cmp_eq_u32 s23, 0
  ds_read_b128 v[44:47], v13 offset:32768
  v_mfma_f32_32x32x16_bf16 v[80:95], v[52:55], a[252:255], v[80:95]
  s_cbranch_scc1 G_done0_8
  s_waitcnt lgkmcnt(5)
  v_mfma_f32_32x32x16_bf16 v[96:111], v[24:27], a[0:3], 0
  s_add_u32 m0, s25, 0
  ds_read_b128 v[48:51], v14 offset:32768
  v_mfma_f32_32x32x16_bf16 v[112:127], v[24:27], a[4:7], 0
  s_waitcnt lgkmcnt(5)
  buffer_load_dwordx4 v16, s[12:15], s19 offen lds
  v_mfma_f32_32x32x16_bf16 v[96:111], v[28:31], a[8:11], v[96:111]
  ds_read_b128 v[52:55], v15 offset:32768
  v_mul_f32 v64, s24, v64
  v_mul_f32 v65, s24, v65
  v_mfma_f32_32x32x16_bf16 v[112:127], v[28:31], a[12:15], v[112:127]
  s_waitcnt lgkmcnt(5)
  v_cvt_pk_bf16_f32 v128, v64, v65
  v_mul_f32 v66, s24, v66
  v_mfma_f32_32x32x16_bf16 v[96:111], v[32:35], a[16:19], v[96:111]
  s_add_u32 m0, s25, 1024
  ds_read_b128 v[24:27], v8 offset:40960
  v_mul_f32 v67, s24, v67
  v_cvt_pk_bf16_f32 v129, v66, v67
  v_mfma_f32_32x32x16_bf16 v[112:127], v[32:35], a[20:23], v[112:127]
  s_waitcnt lgkmcnt(5)
  buffer_load_dwordx4 v17, s[12:15], s19 offen lds
  v_mul_f32 v68, s24, v68
  v_mul_f32 v69, s24, v69
  v_mfma_f32_32x32x16_bf16 v[96:111], v[36:39], a[24:27], v[96:111]
  ds_read_b128 v[28:31], v9 offset:40960
  v_cvt_pk_bf16_f32 v130, v68, v69
  v_mul_f32 v70, s24, v70
  v_mfma_f32_32x32x16_bf16 v[112:127], v[36:39], a[28:31], v[112:127]
  s_waitcnt lgkmcnt(5)
  v_mul_f32 v71, s24, v71
  v_cvt_pk_bf16_f32 v131, v70, v71
  v_mfma_f32_32x32x16_bf16 v[96:111], v[40:43], a[32:35], v[96:111]
  s_add_u32 m0, s25, 2048
  ds_read_b128 v[32:35], v10 offset:40960
  v_mul_f32 v72, s24, v72
  v_mul_f32 v73, s24, v73
  v_mfma_f32_32x32x16_bf16 v[112:127], v[40:43], a[36:39], v[112:127]
  s_waitcnt lgkmcnt(5)
  buffer_load_dwordx4 v18, s[12:15], s19 offen lds
  v_cvt_pk_bf16_f32 v132, v72, v73
  v_mul_f32 v74, s24, v74
  v_mfma_f32_32x32x16_bf16 v[96:111], v[44:47], a[40:43], v[96:111]
  ds_read_b128 v[36:39], v11 offset:40960
  v_mul_f32 v75, s24, v75
  v_cvt_pk_bf16_f32 v133, v74, v75
  v_mfma_f32_32x32x16_bf16 v[112:127], v[44:47], a[44:47], v[112:127]
  s_waitcnt lgkmcnt(5)
  v_mul_f32 v76, s24, v76
  v_mul_f32 v77, s24, v77
  v_mfma_f32_32x32x16_bf16 v[96:111], v[48:51], a[48:51], v[96:111]
  s_add_u32 m0, s25, 3072
  ds_read_b128 v[40:43], v12 offset:40960
  v_cvt_pk_bf16_f32 v134, v76, v77
  v_mul_f32 v78, s24, v78
  v_mfma_f32_32x32x16_bf16 v[112:127], v[48:51], a[52:55], v[112:127]
  s_waitcnt lgkmcnt(5)
  buffer_load_dwordx4 v19, s[12:15], s19 offen lds
  v_mul_f32 v79, s24, v79
  v_cvt_pk_bf16_f32 v135, v78, v79
  v_mfma_f32_32x32x16_bf16 v[96:111], v[52:55], a[56:59], v[96:111]
  ds_read_b128 v[44:47], v13 offset:40960
  v_mul_f32 v80, s24, v80
  v_mul_f32 v81, s24, v81
  v_mfma_f32_32x32x16_bf16 v[112:127], v[52:55], a[60:63], v[112:127]
  s_waitcnt lgkmcnt(5)
  v_cvt_pk_bf16_f32 v136, v80, v81
  v_mul_f32 v82, s24, v82
  v_mfma_f32_32x32x16_bf16 v[96:111], v[24:27], a[64:67], v[96:111]
  s_add_u32 m0, s25, 4096
  ds_read_b128 v[48:51], v14 offset:40960
  v_mul_f32 v83, s24, v83
  v_cvt_pk_bf16_f32 v137, v82, v83
  v_mfma_f32_32x32x16_bf16 v[112:127], v[24:27], a[68:71], v[112:127]
  s_waitcnt lgkmcnt(5)
  buffer_load_dwordx4 v20, s[12:15], s19 offen lds
  v_mul_f32 v84, s24, v84
  v_mul_f32 v85, s24, v85
  v_mfma_f32_32x32x16_bf16 v[96:111], v[28:31], a[72:75], v[96:111]
  ds_read_b128 v[52:55], v15 offset:40960
  v_cvt_pk_bf16_f32 v138, v84, v85
  v_mul_f32 v86, s24, v86
  v_mfma_f32_32x32x16_bf16 v[112:127], v[28:31], a[76:79], v[112:127]
  s_waitcnt lgkmcnt(5)
  v_mul_f32 v87, s24, v87
  v_cvt_pk_bf16_f32 v139, v86, v87
  v_mfma_f32_32x32x16_bf16 v[96:111], v[32:35], a[80:83], v[96:111]
  s_add_u32 m0, s25, 5120
  ds_read_b128 v[24:27], v8 offset:49152
  v_mul_f32 v88, s24, v88
  v_mul_f32 v89, s24, v89
  v_mfma_f32_32x32x16_bf16 v[112:127], v[32:35], a[84:87], v[112:127]
  s_waitcnt lgkmcnt(5)
  buffer_load_dwordx4 v21, s[12:15], s19 offen lds
  v_cvt_pk_bf16_f32 v140, v88, v89
  v_mul_f32 v90, s24, v90
  v_mfma_f32_32x32x16_bf16 v[96:111], v[36:39], a[88:91], v[96:111]
  ds_read_b128 v[28:31], v9 offset:49152
  v_mul_f32 v91, s24, v91
  v_cvt_pk_bf16_f32 v141, v90, v91
  v_mfma_f32_32x32x16_bf16 v[112:127], v[36:39], a[92:95], v[112:127]
  s_waitcnt lgkmcnt(5)
  v_mul_f32 v92, s24, v92
  v_mul_f32 v93, s24, v93
  v_mfma_f32_32x32x16_bf16 v[96:111], v[40:43], a[96:99], v[96:111]
  s_add_u32 m0, s25, 6144
  ds_read_b128 v[32:35], v10 offset:49152
  v_cvt_pk_bf16_f32 v142, v92, v93
  v_mul_f32 v94, s24, v94
  v_mfma_f32_32x32x16_bf16 v[112:127], v[40:43], a[100:103], v[112:127]
  s_waitcnt lgkmcnt(5)
  buffer_load_dwordx4 v22, s[12:15], s19 offen lds
  v_mul_f32 v95, s24, v95
  v_cvt_pk_bf16_f32 v143, v94, v95
  v_mfma_f32_32x32x16_bf16 v[96:111], v[44:47], a[104:107], v[96:111]
  ds_read_b128 v[36:39], v11 offset:49152
  v_mfma_f32_32x32x16_bf16 v[112:127], v[44:47], a[108:111], v[112:127]
  s_waitcnt lgkmcnt(5)
  v_mfma_f32_32x32x16_bf16 v[96:111], v[48:51], a[112:115], v[96:111]
  s_add_u32 m0, s25, 7168
  ds_read_b128 v[40:43], v12 offset:49152
  v_mfma_f32_32x32x16_bf16 v[112:127], v[48:51], a[116:119], v[112:127]
  s_waitcnt lgkmcnt(5)
  buffer_load_dwordx4 v23, s[12:15], s19 offen lds
  v_mfma_f32_32x32x16_bf16 v[96:111], v[52:55], a[120:123], v[96:111]
  s_cmp_gt_u32 s23, 3
  ds_read_b128 v[44:47], v13 offset:49152
  v_mfma_f32_32x32x16_bf16 v[112:127], v[52:55], a[124:127], v[112:127]
  s_waitcnt lgkmcnt(5)
  s_cselect_b32 s26, s20, 0
  v_mfma_f32_32x32x16_bf16 v[96:111], v[24:27], a[128:131], v[96:111]
  s_add_u32 s19, s19, s26
  ds_read_b128 v[48:51], v14 offset:49152
  v_mfma_f32_32x32x16_bf16 v[112:127], v[24:27], a[132:135], v[112:127]
  s_waitcnt lgkmcnt(5)
  s_add_u32 s25, s25, 32768
  v_mfma_f32_32x32x16_bf16 v[96:111], v[28:31], a[136:139], v[96:111]
  s_and_b32 s25, s25, 0x1ffff
  ds_read_b128 v[52:55], v15 offset:49152
  v_mfma_f32_32x32x16_bf16 v[112:127], v[28:31], a[140:143], v[112:127]
  s_waitcnt lgkmcnt(5)
  buffer_store_dwordx4 v[128:131], v7, s[4:7], s21 offen offset:0 sc1
  v_mfma_f32_32x32x16_bf16 v[96:111], v[32:35], a[144:147], v[96:111]
  ds_read_b128 v[24:27], v8 offset:57344
  v_mfma_f32_32x32x16_bf16 v[112:127], v[32:35], a[148:151], v[112:127]
  s_waitcnt lgkmcnt(5)
  v_xor_b32 v8, 0x10000, v8
  v_mfma_f32_32x32x16_bf16 v[96:111], v[36:39], a[152:155], v[96:111]
  ds_read_b128 v[28:31], v9 offset:57344
  v_mfma_f32_32x32x16_bf16 v[112:127], v[36:39], a[156:159], v[112:127]
  s_waitcnt lgkmcnt(5)
  buffer_store_dwordx4 v[132:135], v7, s[4:7], s21 offen offset:1024 sc1
  v_xor_b32 v9, 0x10000, v9
  v_mfma_f32_32x32x16_bf16 v[96:111], v[40:43], a[160:163], v[96:111]
  ds_read_b128 v[32:35], v10 offset:57344
  v_mfma_f32_32x32x16_bf16 v[112:127], v[40:43], a[164:167], v[112:127]
  s_waitcnt lgkmcnt(5)
  v_xor_b32 v10, 0x10000, v10
  v_mfma_f32_32x32x16_bf16 v[96:111], v[44:47], a[168:171], v[96:111]
  ds_read_b128 v[36:39], v11 offset:57344
  v_mfma_f32_32x32x16_bf16 v[112:127], v[44:47], a[172:175], v[112:127]
  s_waitcnt lgkmcnt(5)
  buffer_store_dwordx4 v[136:139], v7, s[4:7], s21 offen offset:2048 sc1
  v_xor_b32 v11, 0x10000, v11
  v_mfma_f32_32x32x16_bf16 v[96:111], v[48:51], a[176:179], v[96:111]
  ds_read_b128 v[40:43], v12 offset:57344
  v_mfma_f32_32x32x16_bf16 v[112:127], v[48:51], a[180:183], v[112:127]
  s_waitcnt lgkmcnt(5)
  v_xor_b32 v12, 0x10000, v12
  v_mfma_f32_32x32x16_bf16 v[96:111], v[52:55], a[184:187], v[96:111]
  ds_read_b128 v[44:47], v13 offset:57344
  v_mfma_f32_32x32x16_bf16 v[112:127], v[52:55], a[188:191], v[112:127]
  s_waitcnt lgkmcnt(5)
  buffer_store_dwordx4 v[140:143], v7, s[4:7], s21 offen offset:3072 sc1
  v_xor_b32 v13, 0x10000, v13
  v_mfma_f32_32x32x16_bf16 v[96:111], v[24:27], a[192:195], v[96:111]
  s_mov_b32 s21, s27
  ds_read_b128 v[48:51], v14 offset:57344
  v_mov_b32 v7, v2
  v_mfma_f32_32x32x16_bf16 v[112:127], v[24:27], a[196:199], v[112:127]
  s_waitcnt lgkmcnt(5)
  v_xor_b32 v14, 0x10000, v14
  v_mfma_f32_32x32x16_bf16 v[96:111], v[28:31], a[200:203], v[96:111]
  s_add_u32 s27, s27, s22
  ds_read_b128 v[52:55], v15 offset:57344
  v_mfma_f32_32x32x16_bf16 v[112:127], v[28:31], a[204:207], v[112:127]
  s_waitcnt lgkmcnt(5)
  s_waitcnt vmcnt(17)
  s_barrier
  v_xor_b32 v15, 0x10000, v15
  v_mfma_f32_32x32x16_bf16 v[96:111], v[32:35], a[208:211], v[96:111]
  ds_read_b128 v[24:27], v8 offset:0
  v_mfma_f32_32x32x16_bf16 v[112:127], v[32:35], a[212:215], v[112:127]
  s_waitcnt lgkmcnt(5)
  v_mfma_f32_32x32x16_bf16 v[96:111], v[36:39], a[216:219], v[96:111]
  s_add_u32 s29, s29, 1
  ds_read_b128 v[28:31], v9 offset:0
  v_mfma_f32_32x32x16_bf16 v[112:127], v[36:39], a[220:223], v[112:127]
  s_waitcnt lgkmcnt(5)
  s_max_i32 s30, s29, 0
  v_mov_b32 v144, s30
  v_mfma_f32_32x32x16_bf16 v[96:111], v[40:43], a[224:227], v[96:111]
  ds_read_b128 v[32:35], v10 offset:0
  v_mfma_f32_32x32x16_bf16 v[112:127], v[40:43], a[228:231], v[112:127]
  s_waitcnt lgkmcnt(5)
  buffer_store_dword v144, v145, s[4:7], s31 offen sc1
  v_mfma_f32_32x32x16_bf16 v[96:111], v[44:47], a[232:235], v[96:111]
  ds_read_b128 v[36:39], v11 offset:0
  v_mfma_f32_32x32x16_bf16 v[112:127], v[44:47], a[236:239], v[112:127]
  s_waitcnt lgkmcnt(5)
  v_mfma_f32_32x32x16_bf16 v[96:111], v[48:51], a[240:243], v[96:111]
  s_sub_u32 s23, s23, 1
  ds_read_b128 v[40:43], v12 offset:0
  v_mfma_f32_32x32x16_bf16 v[112:127], v[48:51], a[244:247], v[112:127]
  s_waitcnt lgkmcnt(5)
  v_mfma_f32_32x32x16_bf16 v[96:111], v[52:55], a[248:251], v[96:111]
  s_cmp_eq_u32 s23, 0
  ds_read_b128 v[44:47], v13 offset:0
  v_mfma_f32_32x32x16_bf16 v[112:127], v[52:55], a[252:255], v[112:127]
  s_cbranch_scc1 G_done1_9
  s_branch G_top_7
G_done0_8:
  s_nop 7
  s_nop 3
  v_mul_f32 v64, s24, v64
  v_mul_f32 v65, s24, v65
  v_cvt_pk_bf16_f32 v128, v64, v65
  v_mul_f32 v66, s24, v66
  v_mul_f32 v67, s24, v67
  v_cvt_pk_bf16_f32 v129, v66, v67
  v_mul_f32 v68, s24, v68
  v_mul_f32 v69, s24, v69
  v_cvt_pk_bf16_f32 v130, v68, v69
  v_mul_f32 v70, s24, v70
  v_mul_f32 v71, s24, v71
  v_cvt_pk_bf16_f32 v131, v70, v71
  buffer_store_dwordx4 v[128:131], v7, s[4:7], s21 offen offset:0 sc1
  v_mul_f32 v72, s24, v72
  v_mul_f32 v73, s24, v73
  v_cvt_pk_bf16_f32 v132, v72, v73
  v_mul_f32 v74, s24, v74
  v_mul_f32 v75, s24, v75
  v_cvt_pk_bf16_f32 v133, v74, v75
  v_mul_f32 v76, s24, v76
  v_mul_f32 v77, s24, v77
  v_cvt_pk_bf16_f32 v134, v76, v77
  v_mul_f32 v78, s24, v78
  v_mul_f32 v79, s24, v79
  v_cvt_pk_bf16_f32 v135, v78, v79
  buffer_store_dwordx4 v[132:135], v7, s[4:7], s21 offen offset:1024 sc1
  v_mul_f32 v80, s24, v80
  v_mul_f32 v81, s24, v81
  v_cvt_pk_bf16_f32 v136, v80, v81
  v_mul_f32 v82, s24, v82
  v_mul_f32 v83, s24, v83
  v_cvt_pk_bf16_f32 v137, v82, v83
  v_mul_f32 v84, s24, v84
  v_mul_f32 v85, s24, v85
  v_cvt_pk_bf16_f32 v138, v84, v85
  v_mul_f32 v86, s24, v86
  v_mul_f32 v87, s24, v87
  v_cvt_pk_bf16_f32 v139, v86, v87
  buffer_store_dwordx4 v[136:139], v7, s[4:7], s21 offen offset:2048 sc1
  v_mul_f32 v88, s24, v88
  v_mul_f32 v89, s24, v89
  v_cvt_pk_bf16_f32 v140, v88, v89
  v_mul_f32 v90, s24, v90
  v_mul_f32 v91, s24, v91
  v_cvt_pk_bf16_f32 v141, v90, v91
  v_mul_f32 v92, s24, v92
  v_mul_f32 v93, s24, v93
  v_cvt_pk_bf16_f32 v142, v92, v93
  v_mul_f32 v94, s24, v94
  v_mul_f32 v95, s24, v95
  v_cvt_pk_bf16_f32 v143, v94, v95
  buffer_store_dwordx4 v[140:143], v7, s[4:7], s21 offen offset:3072 sc1
  s_branch G_fin_10
G_done1_9:
  s_nop 7
  s_nop 3
  v_mul_f32 v96, s24, v96
  v_mul_f32 v97, s24, v97
  v_cvt_pk_bf16_f32 v128, v96, v97
  v_mul_f32 v98, s24, v98
  v_mul_f32 v99, s24, v99
  v_cvt_pk_bf16_f32 v129, v98, v99
  v_mul_f32 v100, s24, v100
  v_mul_f32 v101, s24, v101
  v_cvt_pk_bf16_f32 v130, v100, v101
  v_mul_f32 v102, s24, v102
  v_mul_f32 v103, s24, v103
  v_cvt_pk_bf16_f32 v131, v102, v103
  buffer_store_dwordx4 v[128:131], v7, s[4:7], s21 offen offset:0 sc1
  v_mul_f32 v104, s24, v104
  v_mul_f32 v105, s24, v105
  v_cvt_pk_bf16_f32 v132, v104, v105
  v_mul_f32 v106, s24, v106
  v_mul_f32 v107, s24, v107
  v_cvt_pk_bf16_f32 v133, v106, v107
  v_mul_f32 v108, s24, v108
  v_mul_f32 v109, s24, v109
  v_cvt_pk_bf16_f32 v134, v108, v109
  v_mul_f32 v110, s24, v110
  v_mul_f32 v111, s24, v111
  v_cvt_pk_bf16_f32 v135, v110, v111
  buffer_store_dwordx4 v[132:135], v7, s[4:7], s21 offen offset:1024 sc1
  v_mul_f32 v112, s24, v112
  v_mul_f32 v113, s24, v113
  v_cvt_pk_bf16_f32 v136, v112, v113
  v_mul_f32 v114, s24, v114
  v_mul_f32 v115, s24, v115
  v_cvt_pk_bf16_f32 v137, v114, v115
  v_mul_f32 v116, s24, v116
  v_mul_f32 v117, s24, v117
  v_cvt_pk_bf16_f32 v138, v116, v117
  v_mul_f32 v118, s24, v118
  v_mul_f32 v119, s24, v119
  v_cvt_pk_bf16_f32 v139, v118, v119
  buffer_store_dwordx4 v[136:139], v7, s[4:7], s21 offen offset:2048 sc1
  v_mul_f32 v120, s24, v120
  v_mul_f32 v121, s24, v121
  v_cvt_pk_bf16_f32 v140, v120, v121
  v_mul_f32 v122, s24, v122
  v_mul_f32 v123, s24, v123
  v_cvt_pk_bf16_f32 v141, v122, v123
  v_mul_f32 v124, s24, v124
  v_mul_f32 v125, s24, v125
  v_cvt_pk_bf16_f32 v142, v124, v125
  v_mul_f32 v126, s24, v126
  v_mul_f32 v127, s24, v127
  v_cvt_pk_bf16_f32 v143, v126, v127
  buffer_store_dwordx4 v[140:143], v7, s[4:7], s21 offen offset:3072 sc1
G_fin_10:
  s_waitcnt vmcnt(0) lgkmcnt(0)
  s_barrier
  s_add_u32 s30, s29, 3
  v_mov_b32 v144, s30
  v_min_u32 v145, 1, v0
  v_lshlrev_b32 v145, 30, v145
  buffer_store_dword v144, v145, s[4:7], s31 offen sc1
P_end_2:
  s_mov_b32 s71, 0
  s_branch M_sg_12
M_sw_11:
  s_sleep 8
  s_add_u32 s71, s71, 1
  s_cmp_gt_u32 s71, 262144
  s_cbranch_scc1 M_exit
M_sg_12:
  s_mov_b32 s79, 0
  s_atomic_or s79, s[74:75], 128 glc
  s_waitcnt lgkmcnt(0)
  s_cmp_lt_u32 s79, 256
  s_cbranch_scc1 M_sw_11
  s_cmp_eq_u32 s65, 6
  s_cbranch_scc1 M_follow
  s_mov_b32 s68, 0
  s_mov_b32 s36, -1
  s_mov_b32 s69, s53
  s_mov_b32 s70, s54
  s_load_dwordx2 s[8:9], s[0:1], 40
  s_mul_i32 s76, s64, 6
  s_add_u32 s76, s76, s65
  s_mul_i32 s76, s76, 21888
  v_min_u32 v200, 170, v0
  v_lshl_add_u32 v200, v200, 7, s76
  s_waitcnt lgkmcnt(0)
  s_and_b32 s9, s9, 0xffff
  s_mov_b32 s10, 4194304
  s_mov_b32 s11, 0x20000
M_att:
  s_mov_b32 s24, 0xf149f2ca
  s_mov_b32 s29, 0
  v_mov_b32 v6, 0
  v_mov_b32 v7, 0
  s_lshl_b32 s26, s16, 11
  v_add_u32 v3, s26, v2
  v_and_b32 v5, 31, v1
  v_lshrrev_b32 v12, 5, v1
  v_lshlrev_b32 v12, 2, v12
  v_sub_u32 v5, v5, v12
  s_lshl_b32 s26, s64, 19
  s_add_u32 s19, s26, 16777216
  s_add_u32 s20, s26, 33554432
  s_lshl_b32 s27, s69, 2
  s_add_u32 s27, s27, s16
  s_lshl_b32 s27, s27, 14
  s_add_u32 s25, s26, s27
  s_bfe_u32 s78, s70, 0x80000
  s_add_u32 s76, s67, 512
  s_mov_b32 s71, 0
  s_branch M_sg_14
M_sw_13:
  s_sleep 8
  s_add_u32 s71, s71, 1
  s_cmp_gt_u32 s71, 262144
  s_cbranch_scc1 M_exit
M_sg_14:
  s_mov_b32 s79, 0
  s_atomic_or s79, s[72:73], s76 glc
  s_waitcnt lgkmcnt(0)
  s_cmp_lt_u32 s79, s78
  s_cbranch_scc1 M_sw_13
  s_bfe_u32 s78, s70, 0x80008
  s_add_u32 s76, s67, 640
  s_mov_b32 s71, 0
  s_branch M_sg_16
M_sw_15:
  s_sleep 8
  s_add_u32 s71, s71, 1
  s_cmp_gt_u32 s71, 262144
  s_cbranch_scc1 M_exit
M_sg_16:
  s_mov_b32 s79, 0
  s_atomic_or s79, s[72:73], s76 glc
  s_waitcnt lgkmcnt(0)
  s_cmp_lt_u32 s79, s78
  s_cbranch_scc1 M_sw_15
  s_lshl_b32 s27, s69, 16
  s_add_u32 s27, s27, 16384
  s_add_u32 s17, s19, s27
M_kv_17:
  s_cmp_ge_u32 s17, s36
  s_cbranch_scc1 M_kvok_18
  s_mov_b32 s76, 0
  s_mov_b32 s78, 23
  s_mov_b32 s77, 335872
  s_cmp_eq_u32 s68, 1
  s_cmov_b32 s76, 128
  s_cmov_b32 s78, 27
  s_cmov_b32 s77, 114688
  s_cmp_eq_u32 s68, 2
  s_cmov_b32 s76, 768
  s_cmov_b32 s78, 14
  s_cmov_b32 s77, 0
  s_add_u32 s76, s76, s67
  s_mov_b32 s71, 0
  s_branch M_sg_20
M_sw_19:
  s_sleep 8
  s_add_u32 s71, s71, 1
  s_cmp_gt_u32 s71, 262144
  s_cbranch_scc1 M_exit
M_sg_20:
  s_mov_b32 s79, 0
  s_atomic_or s79, s[72:73], s76 glc
  s_waitcnt lgkmcnt(0)
  s_cmp_lt_u32 s79, s78
  s_cbranch_scc1 M_sw_19
  s_add_u32 s36, s77, s19
  s_add_u32 s68, s68, 1
  s_branch M_kv_17
M_kvok_18:
  s_add_u32 s28, s25, 0
  buffer_load_dwordx4 a[128:131], v2, s[4:7], s28 offen offset:0 sc1
  buffer_load_dwordx4 a[132:135], v2, s[4:7], s28 offen offset:1024 sc1
  buffer_load_dwordx4 a[136:139], v2, s[4:7], s28 offen offset:2048 sc1
  buffer_load_dwordx4 a[140:143], v2, s[4:7], s28 offen offset:3072 sc1
  s_add_u32 s28, s25, 4096
  buffer_load_dwordx4 a[144:147], v2, s[4:7], s28 offen offset:0 sc1
  buffer_load_dwordx4 a[148:151], v2, s[4:7], s28 offen offset:1024 sc1
  buffer_load_dwordx4 a[152:155], v2, s[4:7], s28 offen offset:2048 sc1
  buffer_load_dwordx4 a[156:159], v2, s[4:7], s28 offen offset:3072 sc1
  s_add_u32 s28, s25, 8192
  buffer_load_dwordx4 a[160:163], v2, s[4:7], s28 offen offset:0 sc1
  buffer_load_dwordx4 a[164:167], v2, s[4:7], s28 offen offset:1024 sc1
  buffer_load_dwordx4 a[168:171], v2, s[4:7], s28 offen offset:2048 sc1
  buffer_load_dwordx4 a[172:175], v2, s[4:7], s28 offen offset:3072 sc1
  s_add_u32 s28, s25, 12288
  buffer_load_dwordx4 a[176:179], v2, s[4:7], s28 offen offset:0 sc1
  buffer_load_dwordx4 a[180:183], v2, s[4:7], s28 offen offset:1024 sc1
  buffer_load_dwordx4 a[184:187], v2, s[4:7], s28 offen offset:2048 sc1
  buffer_load_dwordx4 a[188:191], v2, s[4:7], s28 offen offset:3072 sc1
A_again_21:
  s_lshl_b32 s27, s69, 16
  s_add_u32 s27, s27, 57344
  s_add_u32 s17, s19, s27
  s_add_u32 s18, s20, s27
  s_lshl_b32 s21, s16, 11
  s_mov_b32 m0, s21
  s_nop 0
  buffer_load_dwordx4 v3, s[4:7], s18 offen offset:0 sc1 lds
  buffer_load_dwordx4 v3, s[4:7], s18 offen offset:1024 sc1 lds
  s_add_u32 m0, s21, 8192
  s_nop 0
  buffer_load_dwordx4 v3, s[4:7], s17 offen offset:0 sc1 lds
  buffer_load_dwordx4 v3, s[4:7], s17 offen offset:1024 sc1 lds
  s_add_u32 s18, s18, 8192
  s_sub_u32 s18, s18, 8192
  s_max_i32 s18, s18, s20
  s_sub_u32 s17, s17, 8192
  s_max_i32 s17, s17, s19
  s_add_u32 s21, s21, 16384
  s_and_b32 s21, s21, 131071
  s_mov_b32 m0, s21
  s_nop 0
  buffer_load_dwordx4 v3, s[4:7], s18 offen offset:0 sc1 lds
  buffer_load_dwordx4 v3, s[4:7], s18 offen offset:1024 sc1 lds
  s_add_u32 m0, s21, 8192
  s_nop 0
  buffer_load_dwordx4 v3, s[4:7], s17 offen offset:0 sc1 lds
  buffer_load_dwordx4 v3, s[4:7], s17 offen offset:1024 sc1 lds
  s_sub_u32 s18, s18, 8192
  s_max_i32 s18, s18, s20
  s_sub_u32 s17, s17, 8192
  s_max_i32 s17, s17, s19
  s_add_u32 s21, s21, 16384
  s_and_b32 s21, s21, 131071
  s_mov_b32 m0, s21
  s_nop 0
  buffer_load_dwordx4 v3, s[4:7], s18 offen offset:0 sc1 lds
  buffer_load_dwordx4 v3, s[4:7], s18 offen offset:1024 sc1 lds
  s_add_u32 m0, s21, 8192
  s_nop 0
  buffer_load_dwordx4 v3, s[4:7], s17 offen offset:0 sc1 lds
  buffer_load_dwordx4 v3, s[4:7], s17 offen offset:1024 sc1 lds
  s_sub_u32 s18, s18, 8192
  s_max_i32 s18, s18, s20
  s_sub_u32 s17, s17, 8192
  s_max_i32 s17, s17, s19
  s_add_u32 s21, s21, 16384
  s_and_b32 s21, s21, 131071
  s_mov_b32 m0, s21
  s_nop 0
  buffer_load_dwordx4 v3, s[4:7], s18 offen offset:0 sc1 lds
  buffer_load_dwordx4 v3, s[4:7], s18 offen offset:1024 sc1 lds
  s_add_u32 m0, s21, 8192
  s_nop 0
  buffer_load_dwordx4 v3, s[4:7], s17 offen offset:0 sc1 lds
  buffer_load_dwordx4 v3, s[4:7], s17 offen offset:1024 sc1 lds
  s_sub_u32 s18, s18, 8192
  s_max_i32 s18, s18, s20
  s_sub_u32 s17, s17, 8192
  s_max_i32 s17, s17, s19
  s_add_u32 s21, s21, 16384
  s_and_b32 s21, s21, 131071
  s_mov_b32 m0, s21
  s_nop 0
  buffer_load_dwordx4 v3, s[4:7], s18 offen offset:0 sc1 lds
  buffer_load_dwordx4 v3, s[4:7], s18 offen offset:1024 sc1 lds
  s_add_u32 m0, s21, 8192
  s_nop 0
  buffer_load_dwordx4 v3, s[4:7], s17 offen offset:0 sc1 lds
  buffer_load_dwordx4 v3, s[4:7], s17 offen offset:1024 sc1 lds
  s_sub_u32 s18, s18, 8192
  s_max_i32 s18, s18, s20
  s_sub_u32 s17, s17, 8192
  s_max_i32 s17, s17, s19
  s_add_u32 s21, s21, 16384
  s_and_b32 s21, s21, 131071
  s_mov_b32 m0, s21
  s_nop 0
  buffer_load_dwordx4 v3, s[4:7], s18 offen offset:0 sc1 lds
  buffer_load_dwordx4 v3, s[4:7], s18 offen offset:1024 sc1 lds
  s_add_u32 m0, s21, 8192
  s_nop 0
  buffer_load_dwordx4 v3, s[4:7], s17 offen offset:0 sc1 lds
  buffer_load_dwordx4 v3, s[4:7], s17 offen offset:1024 sc1 lds
  v_accvgpr_write_b32 a0, 0
  v_accvgpr_write_b32 a1, 0
  v_accvgpr_write_b32 a2, 0
  v_accvgpr_write_b32 a3, 0
  v_accvgpr_write_b32 a4, 0
  v_accvgpr_write_b32 a5, 0
  v_accvgpr_write_b32 a6, 0
  v_accvgpr_write_b32 a7, 0
  v_accvgpr_write_b32 a8, 0
  v_accvgpr_write_b32 a9, 0
  v_accvgpr_write_b32 a10, 0
  v_accvgpr_write_b32 a11, 0
  v_accvgpr_write_b32 a12, 0
  v_accvgpr_write_b32 a13, 0
  v_accvgpr_write_b32 a14, 0
  v_accvgpr_write_b32 a15, 0
  v_accvgpr_write_b32 a16, 0
  v_accvgpr_write_b32 a17, 0
  v_accvgpr_write_b32 a18, 0
  v_accvgpr_write_b32 a19, 0
  v_accvgpr_write_b32 a20, 0
  v_accvgpr_write_b32 a21, 0
  v_accvgpr_write_b32 a22, 0
  v_accvgpr_write_b32 a23, 0
  v_accvgpr_write_b32 a24, 0
  v_accvgpr_write_b32 a25, 0
  v_accvgpr_write_b32 a26, 0
  v_accvgpr_write_b32 a27, 0
  v_accvgpr_write_b32 a28, 0
  v_accvgpr_write_b32 a29, 0
  v_accvgpr_write_b32 a30, 0
  v_accvgpr_write_b32 a31, 0
  v_accvgpr_write_b32 a32, 0
  v_accvgpr_write_b32 a33, 0
  v_accvgpr_write_b32 a34, 0
  v_accvgpr_write_b32 a35, 0
  v_accvgpr_write_b32 a36, 0
  v_accvgpr_write_b32 a37, 0
  v_accvgpr_write_b32 a38, 0
  v_accvgpr_write_b32 a39, 0
  v_accvgpr_write_b32 a40, 0
  v_accvgpr_write_b32 a41, 0
  v_accvgpr_write_b32 a42, 0
  v_accvgpr_write_b32 a43, 0
  v_accvgpr_write_b32 a44, 0
  v_accvgpr_write_b32 a45, 0
  v_accvgpr_write_b32 a46, 0
  v_accvgpr_write_b32 a47, 0
  v_accvgpr_write_b32 a48, 0
  v_accvgpr_write_b32 a49, 0
  v_accvgpr_write_b32 a50, 0
  v_accvgpr_write_b32 a51, 0
  v_accvgpr_write_b32 a52, 0
  v_accvgpr_write_b32 a53, 0
  v_accvgpr_write_b32 a54, 0
  v_accvgpr_write_b32 a55, 0
  v_accvgpr_write_b32 a56, 0
  v_accvgpr_write_b32 a57, 0
  v_accvgpr_write_b32 a58, 0
  v_accvgpr_write_b32 a59, 0
  v_accvgpr_write_b32 a60, 0
  v_accvgpr_write_b32 a61, 0
  v_accvgpr_write_b32 a62, 0
  v_accvgpr_write_b32 a63, 0
  v_accvgpr_write_b32 a64, 0
  v_accvgpr_write_b32 a65, 0
  v_accvgpr_write_b32 a66, 0
  v_accvgpr_write_b32 a67, 0
  v_accvgpr_write_b32 a68, 0
  v_accvgpr_write_b32 a69, 0
  v_accvgpr_write_b32 a70, 0
  v_accvgpr_write_b32 a71, 0
  v_accvgpr_write_b32 a72, 0
  v_accvgpr_write_b32 a73, 0
  v_accvgpr_write_b32 a74, 0
  v_accvgpr_write_b32 a75, 0
  v_accvgpr_write_b32 a76, 0
  v_accvgpr_write_b32 a77, 0
  v_accvgpr_write_b32 a78, 0
  v_accvgpr_write_b32 a79, 0
  v_accvgpr_write_b32 a80, 0
  v_accvgpr_write_b32 a81, 0
  v_accvgpr_write_b32 a82, 0
  v_accvgpr_write_b32 a83, 0
  v_accvgpr_write_b32 a84, 0
  v_accvgpr_write_b32 a85, 0
  v_accvgpr_write_b32 a86, 0
  v_accvgpr_write_b32 a87, 0
  v_accvgpr_write_b32 a88, 0
  v_accvgpr_write_b32 a89, 0
  v_accvgpr_write_b32 a90, 0
  v_accvgpr_write_b32 a91, 0
  v_accvgpr_write_b32 a92, 0
  v_accvgpr_write_b32 a93, 0
  v_accvgpr_write_b32 a94, 0
  v_accvgpr_write_b32 a95, 0
  v_accvgpr_write_b32 a96, 0
  v_accvgpr_write_b32 a97, 0
  v_accvgpr_write_b32 a98, 0
  v_accvgpr_write_b32 a99, 0
  v_accvgpr_write_b32 a100, 0
  v_accvgpr_write_b32 a101, 0
  v_accvgpr_write_b32 a102, 0
  v_accvgpr_write_b32 a103, 0
  v_accvgpr_write_b32 a104, 0
  v_accvgpr_write_b32 a105, 0
  v_accvgpr_write_b32 a106, 0
  v_accvgpr_write_b32 a107, 0
  v_accvgpr_write_b32 a108, 0
  v_accvgpr_write_b32 a109, 0
  v_accvgpr_write_b32 a110, 0
  v_accvgpr_write_b32 a111, 0
  v_accvgpr_write_b32 a112, 0
  v_accvgpr_write_b32 a113, 0
  v_accvgpr_write_b32 a114, 0
  v_accvgpr_write_b32 a115, 0
  v_accvgpr_write_b32 a116, 0
  v_accvgpr_write_b32 a117, 0
  v_accvgpr_write_b32 a118, 0
  v_accvgpr_write_b32 a119, 0
  v_accvgpr_write_b32 a120, 0
  v_accvgpr_write_b32 a121, 0
  v_accvgpr_write_b32 a122, 0
  v_accvgpr_write_b32 a123, 0
  v_accvgpr_write_b32 a124, 0
  v_accvgpr_write_b32 a125, 0
  v_accvgpr_write_b32 a126, 0
  v_accvgpr_write_b32 a127, 0
  v_mov_b32 v8, 0
  v_mov_b32 v9, 0
  v_mov_b32 v10, 0
  v_mov_b32 v11, 0
  v_mov_b32 v52, 0
  v_mov_b32 v53, 0
  v_mov_b32 v54, s24
  v_mov_b32 v55, s24
  v_mov_b32 v56, s24
  v_mov_b32 v57, s24
  v_mov_b32 v58, s24
  v_mov_b32 v59, s24
  v_mov_b32 v60, s24
  v_mov_b32 v61, s24
  v_mov_b32 v62, s24
  v_mov_b32 v63, s24
  v_mov_b32 v104, 0
  v_mov_b32 v105, 0
  v_mov_b32 v4, v2
  v_mov_b32 v64, s24
  v_mov_b32 v65, s24
  v_mov_b32 v66, s24
  v_mov_b32 v67, s24
  v_mov_b32 v68, s24
  v_mov_b32 v69, s24
  v_mov_b32 v70, s24
  v_mov_b32 v71, s24
  v_mov_b32 v72, s24
  v_mov_b32 v73, s24
  v_mov_b32 v74, s24
  v_mov_b32 v75, s24
  v_mov_b32 v76, s24
  v_mov_b32 v77, s24
  v_mov_b32 v78, s24
  v_mov_b32 v79, s24
  v_mov_b32 v12, s24
  v_cmp_le_i32 s[40:41], 0, v5
  v_cmp_le_i32 s[42:43], 1, v5
  v_cmp_le_i32 s[44:45], 2, v5
  v_cmp_le_i32 s[46:47], 3, v5
  v_cndmask_b32 v80, v12, v7, s[40:41]
  v_cndmask_b32 v81, v12, v7, s[42:43]
  v_cndmask_b32 v82, v12, v7, s[44:45]
  v_cndmask_b32 v83, v12, v7, s[46:47]
  v_cmp_le_i32 s[40:41], 8, v5
  v_cmp_le_i32 s[42:43], 9, v5
  v_cmp_le_i32 s[44:45], 10, v5
  v_cmp_le_i32 s[46:47], 11, v5
  v_cndmask_b32 v84, v12, v7, s[40:41]
  v_cndmask_b32 v85, v12, v7, s[42:43]
  v_cndmask_b32 v86, v12, v7, s[44:45]
  v_cndmask_b32 v87, v12, v7, s[46:47]
  v_cmp_le_i32 s[40:41], 16, v5
  v_cmp_le_i32 s[42:43], 17, v5
  v_cmp_le_i32 s[44:45], 18, v5
  v_cmp_le_i32 s[46:47], 19, v5
  v_cndmask_b32 v88, v12, v7, s[40:41]
  v_cndmask_b32 v89, v12, v7, s[42:43]
  v_cndmask_b32 v90, v12, v7, s[44:45]
  v_cndmask_b32 v91, v12, v7, s[46:47]
  v_cmp_le_i32 s[40:41], 24, v5
  v_cmp_le_i32 s[42:43], 25, v5
  v_cmp_le_i32 s[44:45], 26, v5
  v_cmp_le_i32 s[46:47], 27, v5
  v_cndmask_b32 v92, v12, v7, s[40:41]
  v_cndmask_b32 v93, v12, v7, s[42:43]
  v_cndmask_b32 v94, v12, v7, s[44:45]
  v_cndmask_b32 v95, v12, v7, s[46:47]
  s_lshl_b32 s22, s69, 3
  s_add_u32 s22, s22, 8
  s_lshl_b32 s26, s16, 1
  s_sub_u32 s23, 6, s26
  s_waitcnt vmcnt(20)
  s_barrier
  buffer_load_dword v201, v200, s[8:11], 0 offen
  s_cmp_eq_u32 s23, 0
  s_cbranch_scc1 A_go_23
A_idle_22:
  s_waitcnt vmcnt(16)
  s_barrier
  s_sub_u32 s18, s18, 8192
  s_max_i32 s18, s18, s20
  s_sub_u32 s17, s17, 8192
  s_max_i32 s17, s17, s19
  s_add_u32 s21, s21, 16384
  s_and_b32 s21, s21, 131071
M_kv_24:
  s_cmp_ge_u32 s17, s36
  s_cbranch_scc1 M_kvok_25
  s_mov_b32 s76, 0
  s_mov_b32 s78, 23
  s_mov_b32 s77, 335872
  s_cmp_eq_u32 s68, 1
  s_cmov_b32 s76, 128
  s_cmov_b32 s78, 27
  s_cmov_b32 s77, 114688
  s_cmp_eq_u32 s68, 2
  s_cmov_b32 s76, 768
  s_cmov_b32 s78, 14
  s_cmov_b32 s77, 0
  s_add_u32 s76, s76, s67
  s_mov_b32 s71, 0
  s_branch M_sg_27
M_sw_26:
  s_sleep 8
  s_add_u32 s71, s71, 1
  s_cmp_gt_u32 s71, 262144
  s_cbranch_scc1 M_exit
M_sg_27:
  s_mov_b32 s79, 0
  s_atomic_or s79, s[72:73], s76 glc
  s_waitcnt lgkmcnt(0)
  s_cmp_lt_u32 s79, s78
  s_cbranch_scc1 M_sw_26
  s_add_u32 s36, s77, s19
  s_add_u32 s68, s68, 1
  s_branch M_kv_24
M_kvok_25:
  s_mov_b32 m0, s21
  s_nop 0
  buffer_load_dwordx4 v3, s[4:7], s18 offen offset:0 sc1 lds
  buffer_load_dwordx4 v3, s[4:7], s18 offen offset:1024 sc1 lds
  s_add_u32 m0, s21, 8192
  s_nop 0
  buffer_load_dwordx4 v3, s[4:7], s17 offen offset:0 sc1 lds
  buffer_load_dwordx4 v3, s[4:7], s17 offen offset:1024 sc1 lds
  v_add_u32 v4, 16384, v4
  v_and_b32 v4, 131071, v4
  s_sub_u32 s22, s22, 1
  s_sub_u32 s23, s23, 1
  s_cmp_lg_u32 s23, 0
  s_cbranch_scc1 A_idle_22
A_go_23:
  ds_read_b128 a[224:227], v4 offset:0
  ds_read_b128 a[228:231], v4 offset:2048
  ds_read_b128 a[232:235], v4 offset:4096
  ds_read_b128 a[236:239], v4 offset:6144
  ds_read_b128 a[240:243], v4 offset:1024
  ds_read_b128 a[244:247], v4 offset:3072
  ds_read_b128 a[248:251], v4 offset:5120
  ds_read_b128 a[252:255], v4 offset:7168
  ds_read_b128 a[192:195], v4 offset:8192
  ds_read_b128 a[196:199], v4 offset:9216
  ds_read_b128 a[200:203], v4 offset:10240
  ds_read_b128 a[204:207], v4 offset:11264
  ds_read_b128 a[208:211], v4 offset:12288
  ds_read_b128 a[212:215], v4 offset:13312
  ds_read_b128 a[216:219], v4 offset:14336
  ds_read_b128 a[220:223], v4 offset:15360
  v_add_u32 v4, 16384, v4
  v_and_b32 v4, 131071, v4
  s_waitcnt lgkmcnt(8)
.p2align 6
A_top_28:
  s_waitcnt lgkmcnt(7)
  v_mfma_f32_32x32x16_bf16 v[32:47], a[192:195], a[128:131], v[64:79]
  s_waitcnt lgkmcnt(6)
  v_exp_f32 v54, v54
  v_add_f32 v11, v11, v53
  v_cvt_pk_bf16_f32 v106, v52, v53
  v_mfma_f32_32x32x16_bf16 v[32:47], a[196:199], a[132:135], v[32:47]
  s_waitcnt lgkmcnt(4)
  v_exp_f32 v55, v55
  v_add_f32 v10, v10, v54
  v_mfma_f32_32x32x16_bf16 v[32:47], a[200:203], a[136:139], v[32:47]
  v_exp_f32 v56, v56
  v_add_f32 v11, v11, v55
  v_cvt_pk_bf16_f32 v107, v54, v55
  v_mfma_f32_32x32x16_bf16 v[32:47], a[204:207], a[140:143], v[32:47]
  s_waitcnt lgkmcnt(2)
  v_exp_f32 v57, v57
  v_add_f32 v10, v10, v56
  v_mfma_f32_32x32x16_bf16 v[32:47], a[208:211], a[144:147], v[32:47]
  v_exp_f32 v58, v58
  v_add_f32 v11, v11, v57
  v_cvt_pk_bf16_f32 v108, v56, v57
  v_mfma_f32_32x32x16_bf16 v[32:47], a[212:215], a[148:151], v[32:47]
  s_waitcnt lgkmcnt(0)
  v_exp_f32 v59, v59
  v_add_f32 v10, v10, v58
  v_mfma_f32_32x32x16_bf16 v[32:47], a[216:219], a[152:155], v[32:47]
  v_exp_f32 v60, v60
  v_add_f32 v11, v11, v59
  v_cvt_pk_bf16_f32 v109, v58, v59
  v_mfma_f32_32x32x16_bf16 v[32:47], a[220:223], a[156:159], v[32:47]
  s_waitcnt vmcnt(16)
  s_barrier
  v_exp_f32 v61, v61
  v_add_f32 v10, v10, v60
  v_mfma_f32_32x32x16_bf16 a[64:79], a[224:227], v[104:107], a[64:79]
  ds_read_b128 a[224:227], v4 offset:0
  v_exp_f32 v62, v62
  v_add_f32 v11, v11, v61
  v_cvt_pk_bf16_f32 v110, v60, v61
  v_mfma_f32_32x32x16_bf16 a[80:95], a[228:231], v[104:107], a[80:95]
  s_sub_u32 s18, s18, 8192
  ds_read_b128 a[228:231], v4 offset:2048
  v_exp_f32 v63, v63
  v_add_f32 v10, v10, v62
  v_mfma_f32_32x32x16_bf16 a[96:111], a[232:235], v[104:107], a[96:111]
  s_max_i32 s18, s18, s20
  ds_read_b128 a[232:235], v4 offset:4096
  v_exp_f32 v32, v32
  v_add_f32 v11, v11, v63
  v_cvt_pk_bf16_f32 v111, v62, v63
  v_mfma_f32_32x32x16_bf16 a[112:127], a[236:239], v[104:107], a[112:127]
  s_sub_u32 s17, s17, 8192
  ds_read_b128 a[236:239], v4 offset:6144
  v_exp_f32 v33, v33
  v_add_f32 v8, v8, v32
  v_mfma_f32_32x32x16_bf16 a[64:79], a[240:243], v[108:111], a[64:79]
  s_max_i32 s17, s17, s19
  ds_read_b128 a[240:243], v4 offset:1024
  v_exp_f32 v34, v34
  v_add_f32 v9, v9, v33
  v_cvt_pk_bf16_f32 v96, v32, v33
  v_mfma_f32_32x32x16_bf16 a[80:95], a[244:247], v[108:111], a[80:95]
  s_add_u32 s21, s21, 16384
  ds_read_b128 a[244:247], v4 offset:3072
  v_exp_f32 v35, v35
  v_add_f32 v8, v8, v34
  v_mfma_f32_32x32x16_bf16 a[96:111], a[248:251], v[108:111], a[96:111]
  s_and_b32 s21, s21, 131071
  ds_read_b128 a[248:251], v4 offset:5120
  v_exp_f32 v36, v36
  v_add_f32 v9, v9, v35
  v_cvt_pk_bf16_f32 v97, v34, v35
  v_mfma_f32_32x32x16_bf16 a[112:127], a[252:255], v[108:111], a[112:127]
  ds_read_b128 a[252:255], v4 offset:7168
  v_exp_f32 v37, v37
  v_add_f32 v8, v8, v36
  v_mfma_f32_32x32x16_bf16 v[48:63], a[192:195], a[160:163], v[80:95]
  s_add_u32 s23, s23, 1
  ds_read_b128 a[192:195], v4 offset:8192
  v_exp_f32 v38, v38
  v_add_f32 v9, v9, v37
  v_cvt_pk_bf16_f32 v98, v36, v37
  v_mfma_f32_32x32x16_bf16 v[48:63], a[196:199], a[164:167], v[48:63]
  s_sub_u32 s22, s22, 1
  ds_read_b128 a[196:199], v4 offset:9216
  v_exp_f32 v39, v39
  v_add_f32 v8, v8, v38
  v_mfma_f32_32x32x16_bf16 v[48:63], a[200:203], a[168:171], v[48:63]
  s_cmp_lt_u32 s23, 3
  ds_read_b128 a[200:203], v4 offset:10240
  v_exp_f32 v40, v40
  v_add_f32 v9, v9, v39
  v_cvt_pk_bf16_f32 v99, v38, v39
  v_mfma_f32_32x32x16_bf16 v[48:63], a[204:207], a[172:175], v[48:63]
  s_cbranch_scc1 A_upd_29
A_back_30:
  ds_read_b128 a[204:207], v4 offset:11264
  v_exp_f32 v41, v41
  v_add_f32 v8, v8, v40
  v_mfma_f32_32x32x16_bf16 v[48:63], a[208:211], a[176:179], v[48:63]
  s_cmp_lt_u32 s17, s36
  ds_read_b128 a[208:211], v4 offset:12288
  v_exp_f32 v42, v42
  v_add_f32 v9, v9, v41
  v_cvt_pk_bf16_f32 v100, v40, v41
  v_mfma_f32_32x32x16_bf16 v[48:63], a[212:215], a[180:183], v[48:63]
  s_cbranch_scc1 A_kvw_32
A_kvb_33:
  ds_read_b128 a[212:215], v4 offset:13312
  v_exp_f32 v43, v43
  v_add_f32 v8, v8, v42
  v_mfma_f32_32x32x16_bf16 v[48:63], a[216:219], a[184:187], v[48:63]
  s_mov_b32 m0, s21
  ds_read_b128 a[216:219], v4 offset:14336
  v_exp_f32 v44, v44
  v_add_f32 v9, v9, v43
  v_cvt_pk_bf16_f32 v101, v42, v43
  v_mfma_f32_32x32x16_bf16 v[48:63], a[220:223], a[188:191], v[48:63]
  s_waitcnt lgkmcnt(13)
  ds_read_b128 a[220:223], v4 offset:15360
  v_exp_f32 v45, v45
  v_add_f32 v8, v8, v44
  v_mfma_f32_32x32x16_bf16 a[0:15], a[224:227], v[96:99], a[0:15]
  buffer_load_dwordx4 v3, s[4:7], s18 offen offset:0 sc1 lds
  v_exp_f32 v46, v46
  v_add_f32 v9, v9, v45
  v_cvt_pk_bf16_f32 v102, v44, v45
  v_mfma_f32_32x32x16_bf16 a[16:31], a[228:231], v[96:99], a[16:31]
  s_waitcnt lgkmcnt(12)
  v_exp_f32 v47, v47
  v_add_f32 v8, v8, v46
  v_add_u32 v4, 16384, v4
  v_mfma_f32_32x32x16_bf16 a[32:47], a[232:235], v[96:99], a[32:47]
  buffer_load_dwordx4 v3, s[4:7], s18 offen offset:1024 sc1 lds
  v_exp_f32 v48, v48
  v_add_f32 v9, v9, v47
  v_cvt_pk_bf16_f32 v103, v46, v47
  v_mfma_f32_32x32x16_bf16 a[48:63], a[236:239], v[96:99], a[48:63]
  s_waitcnt lgkmcnt(10)
  s_add_u32 m0, s21, 8192
  v_exp_f32 v49, v49
  v_add_f32 v10, v10, v48
  v_and_b32 v4, 131071, v4
  v_mfma_f32_32x32x16_bf16 a[0:15], a[240:243], v[100:103], a[0:15]
  buffer_load_dwordx4 v3, s[4:7], s17 offen offset:0 sc1 lds
  v_exp_f32 v50, v50
  v_add_f32 v11, v11, v49
  v_cvt_pk_bf16_f32 v104, v48, v49
  v_mfma_f32_32x32x16_bf16 a[16:31], a[244:247], v[100:103], a[16:31]
  s_waitcnt lgkmcnt(8)
  s_cmp_lg_u32 s22, 0
  v_exp_f32 v51, v51
  v_add_f32 v10, v10, v50
  v_mfma_f32_32x32x16_bf16 a[32:47], a[248:251], v[100:103], a[32:47]
  buffer_load_dwordx4 v3, s[4:7], s17 offen offset:1024 sc1 lds
  v_exp_f32 v52, v52
  v_add_f32 v11, v11, v51
  v_cvt_pk_bf16_f32 v105, v50, v51
  v_mfma_f32_32x32x16_bf16 a[48:63], a[252:255], v[100:103], a[48:63]
  v_exp_f32 v53, v53
  v_add_f32 v10, v10, v52
  s_cbranch_scc1 A_top_28
  v_exp_f32 v54, v54
  v_add_f32 v11, v11, v53
  v_cvt_pk_bf16_f32 v106, v52, v53
  v_exp_f32 v55, v55
  v_add_f32 v10, v10, v54
  v_exp_f32 v56, v56
  v_add_f32 v11, v11, v55
  v_cvt_pk_bf16_f32 v107, v54, v55
  v_exp_f32 v57, v57
  v_add_f32 v10, v10, v56
  v_exp_f32 v58, v58
  v_add_f32 v11, v11, v57
  v_cvt_pk_bf16_f32 v108, v56, v57
  v_exp_f32 v59, v59
  v_add_f32 v10, v10, v58
  v_exp_f32 v60, v60
  v_add_f32 v11, v11, v59
  v_cvt_pk_bf16_f32 v109, v58, v59
  v_exp_f32 v61, v61
  v_add_f32 v10, v10, v60
  v_exp_f32 v62, v62
  v_add_f32 v11, v11, v61
  v_cvt_pk_bf16_f32 v110, v60, v61
  v_exp_f32 v63, v63
  v_add_f32 v10, v10, v62
  v_add_f32 v11, v11, v63
  v_cvt_pk_bf16_f32 v111, v62, v63
  s_nop 1
  v_mfma_f32_32x32x16_bf16 a[64:79], a[224:227], v[104:107], a[64:79]
  v_mfma_f32_32x32x16_bf16 a[80:95], a[228:231], v[104:107], a[80:95]
  v_mfma_f32_32x32x16_bf16 a[96:111], a[232:235], v[104:107], a[96:111]
  v_mfma_f32_32x32x16_bf16 a[112:127], a[236:239], v[104:107], a[112:127]
  v_mfma_f32_32x32x16_bf16 a[64:79], a[240:243], v[108:111], a[64:79]
  v_mfma_f32_32x32x16_bf16 a[80:95], a[244:247], v[108:111], a[80:95]
  v_mfma_f32_32x32x16_bf16 a[96:111], a[248:251], v[108:111], a[96:111]
  v_mfma_f32_32x32x16_bf16 a[112:127], a[252:255], v[108:111], a[112:127]
  v_add_f32 v8, v8, v9
  v_mov_b32 v9, v8
  s_nop 1
  v_permlane32_swap_b32 v8, v9
  s_nop 1
  v_add_f32 v8, v8, v9
  v_add_f32 v10, v10, v11
  v_mov_b32 v11, v10
  s_nop 1
  v_permlane32_swap_b32 v10, v11
  s_nop 1
  v_add_f32 v10, v10, v11
  v_subrev_u32 v12, 0x2f800000, v8
  v_subrev_u32 v13, 0x2f800000, v10
  v_max_u32 v12, v12, v13
  v_cmp_le_u32 vcc, 0x28000000, v12
  s_nop 1
  s_cmp_lg_u64 vcc, 0
  s_cselect_b32 s26, 1, 0
  v_mov_b32 v12, s26
  s_lshl_b32 s26, s16, 2
  s_add_u32 s26, s26, 131072
  v_mov_b32 v13, s26
  ds_write_b32 v13, v12
  v_mov_b32 v14, 131072
  s_waitcnt vmcnt(0) lgkmcnt(0)
  s_barrier
  ds_read_b128 v[16:19], v14
  v_rcp_f32 v8, v8
  v_rcp_f32 v10, v10
  s_waitcnt lgkmcnt(0)
  v_or3_b32 v12, v16, v17, v18
  v_or_b32 v12, v12, v19
  s_nop 0
  v_readfirstlane_b32 s26, v12
  s_nop 1
  s_cmp_gt_u32 s26, s29
  s_cbranch_scc1 A_slow_34
  s_add_u32 s28, s25, 100663296
  v_accvgpr_read_b32 v112, a0
  v_accvgpr_read_b32 v113, a1
  v_accvgpr_read_b32 v114, a2
  v_accvgpr_read_b32 v115, a3
  v_accvgpr_read_b32 v116, a4
  v_accvgpr_read_b32 v117, a5
  v_accvgpr_read_b32 v118, a6
  v_accvgpr_read_b32 v119, a7
  v_pk_mul_f32 v[112:113], v[112:113], v[8:9] op_sel_hi:[1,0]
  v_pk_mul_f32 v[114:115], v[114:115], v[8:9] op_sel_hi:[1,0]
  v_pk_mul_f32 v[116:117], v[116:117], v[8:9] op_sel_hi:[1,0]
  v_pk_mul_f32 v[118:119], v[118:119], v[8:9] op_sel_hi:[1,0]
  v_cvt_pk_bf16_f32 v120, v112, v113
  v_cvt_pk_bf16_f32 v121, v114, v115
  v_cvt_pk_bf16_f32 v122, v116, v117
  v_cvt_pk_bf16_f32 v123, v118, v119
  buffer_store_dwordx4 v[120:123], v2, s[4:7], s28 offen offset:0 sc1
  v_accvgpr_read_b32 v124, a8
  v_accvgpr_read_b32 v125, a9
  v_accvgpr_read_b32 v126, a10
  v_accvgpr_read_b32 v127, a11
  v_accvgpr_read_b32 v128, a12
  v_accvgpr_read_b32 v129, a13
  v_accvgpr_read_b32 v130, a14
  v_accvgpr_read_b32 v131, a15
  v_pk_mul_f32 v[124:125], v[124:125], v[8:9] op_sel_hi:[1,0]
  v_pk_mul_f32 v[126:127], v[126:127], v[8:9] op_sel_hi:[1,0]
  v_pk_mul_f32 v[128:129], v[128:129], v[8:9] op_sel_hi:[1,0]
  v_pk_mul_f32 v[130:131], v[130:131], v[8:9] op_sel_hi:[1,0]
  v_cvt_pk_bf16_f32 v132, v124, v125
  v_cvt_pk_bf16_f32 v133, v126, v127
  v_cvt_pk_bf16_f32 v134, v128, v129
  v_cvt_pk_bf16_f32 v135, v130, v131
  buffer_store_dwordx4 v[132:135], v2, s[4:7], s28 offen offset:1024 sc1
  v_accvgpr_read_b32 v136, a16
  v_accvgpr_read_b32 v137, a17
  v_accvgpr_read_b32 v138, a18
  v_accvgpr_read_b32 v139, a19
  v_accvgpr_read_b32 v140, a20
  v_accvgpr_read_b32 v141, a21
  v_accvgpr_read_b32 v142, a22
  v_accvgpr_read_b32 v143, a23
  v_pk_mul_f32 v[136:137], v[136:137], v[8:9] op_sel_hi:[1,0]
  v_pk_mul_f32 v[138:139], v[138:139], v[8:9] op_sel_hi:[1,0]
  v_pk_mul_f32 v[140:141], v[140:141], v[8:9] op_sel_hi:[1,0]
  v_pk_mul_f32 v[142:143], v[142:143], v[8:9] op_sel_hi:[1,0]
  v_cvt_pk_bf16_f32 v144, v136, v137
  v_cvt_pk_bf16_f32 v145, v138, v139
  v_cvt_pk_bf16_f32 v146, v140, v141
  v_cvt_pk_bf16_f32 v147, v142, v143
  buffer_store_dwordx4 v[144:147], v2, s[4:7], s28 offen offset:2048 sc1
  v_accvgpr_read_b32 v148, a24
  v_accvgpr_read_b32 v149, a25
  v_accvgpr_read_b32 v150, a26
  v_accvgpr_read_b32 v151, a27
  v_accvgpr_read_b32 v152, a28
  v_accvgpr_read_b32 v153, a29
  v_accvgpr_read_b32 v154, a30
  v_accvgpr_read_b32 v155, a31
  v_pk_mul_f32 v[148:149], v[148:149], v[8:9] op_sel_hi:[1,0]
  v_pk_mul_f32 v[150:151], v[150:151], v[8:9] op_sel_hi:[1,0]
  v_pk_mul_f32 v[152:153], v[152:153], v[8:9] op_sel_hi:[1,0]
  v_pk_mul_f32 v[154:155], v[154:155], v[8:9] op_sel_hi:[1,0]
  v_cvt_pk_bf16_f32 v156, v148, v149
  v_cvt_pk_bf16_f32 v157, v150, v151
  v_cvt_pk_bf16_f32 v158, v152, v153
  v_cvt_pk_bf16_f32 v159, v154, v155
  buffer_store_dwordx4 v[156:159], v2, s[4:7], s28 offen offset:3072 sc1
  s_add_u32 s28, s25, 100667392
  v_accvgpr_read_b32 v112, a32
  v_accvgpr_read_b32 v113, a33
  v_accvgpr_read_b32 v114, a34
  v_accvgpr_read_b32 v115, a35
  v_accvgpr_read_b32 v116, a36
  v_accvgpr_read_b32 v117, a37
  v_accvgpr_read_b32 v118, a38
  v_accvgpr_read_b32 v119, a39
  v_pk_mul_f32 v[112:113], v[112:113], v[8:9] op_sel_hi:[1,0]
  v_pk_mul_f32 v[114:115], v[114:115], v[8:9] op_sel_hi:[1,0]
  v_pk_mul_f32 v[116:117], v[116:117], v[8:9] op_sel_hi:[1,0]
  v_pk_mul_f32 v[118:119], v[118:119], v[8:9] op_sel_hi:[1,0]
  v_cvt_pk_bf16_f32 v120, v112, v113
  v_cvt_pk_bf16_f32 v121, v114, v115
  v_cvt_pk_bf16_f32 v122, v116, v117
  v_cvt_pk_bf16_f32 v123, v118, v119
  buffer_store_dwordx4 v[120:123], v2, s[4:7], s28 offen offset:0 sc1
  v_accvgpr_read_b32 v124, a40
  v_accvgpr_read_b32 v125, a41
  v_accvgpr_read_b32 v126, a42
  v_accvgpr_read_b32 v127, a43
  v_accvgpr_read_b32 v128, a44
  v_accvgpr_read_b32 v129, a45
  v_accvgpr_read_b32 v130, a46
  v_accvgpr_read_b32 v131, a47
  v_pk_mul_f32 v[124:125], v[124:125], v[8:9] op_sel_hi:[1,0]
  v_pk_mul_f32 v[126:127], v[126:127], v[8:9] op_sel_hi:[1,0]
  v_pk_mul_f32 v[128:129], v[128:129], v[8:9] op_sel_hi:[1,0]
  v_pk_mul_f32 v[130:131], v[130:131], v[8:9] op_sel_hi:[1,0]
  v_cvt_pk_bf16_f32 v132, v124, v125
  v_cvt_pk_bf16_f32 v133, v126, v127
  v_cvt_pk_bf16_f32 v134, v128, v129
  v_cvt_pk_bf16_f32 v135, v130, v131
  buffer_store_dwordx4 v[132:135], v2, s[4:7], s28 offen offset:1024 sc1
  v_accvgpr_read_b32 v136, a48
  v_accvgpr_read_b32 v137, a49
  v_accvgpr_read_b32 v138, a50
  v_accvgpr_read_b32 v139, a51
  v_accvgpr_read_b32 v140, a52
  v_accvgpr_read_b32 v141, a53
  v_accvgpr_read_b32 v142, a54
  v_accvgpr_read_b32 v143, a55
  v_pk_mul_f32 v[136:137], v[136:137], v[8:9] op_sel_hi:[1,0]
  v_pk_mul_f32 v[138:139], v[138:139], v[8:9] op_sel_hi:[1,0]
  v_pk_mul_f32 v[140:141], v[140:141], v[8:9] op_sel_hi:[1,0]
  v_pk_mul_f32 v[142:143], v[142:143], v[8:9] op_sel_hi:[1,0]
  v_cvt_pk_bf16_f32 v144, v136, v137
  v_cvt_pk_bf16_f32 v145, v138, v139
  v_cvt_pk_bf16_f32 v146, v140, v141
  v_cvt_pk_bf16_f32 v147, v142, v143
  buffer_store_dwordx4 v[144:147], v2, s[4:7], s28 offen offset:2048 sc1
  v_accvgpr_read_b32 v148, a56
  v_accvgpr_read_b32 v149, a57
  v_accvgpr_read_b32 v150, a58
  v_accvgpr_read_b32 v151, a59
  v_accvgpr_read_b32 v152, a60
  v_accvgpr_read_b32 v153, a61
  v_accvgpr_read_b32 v154, a62
  v_accvgpr_read_b32 v155, a63
  v_pk_mul_f32 v[148:149], v[148:149], v[8:9] op_sel_hi:[1,0]
  v_pk_mul_f32 v[150:151], v[150:151], v[8:9] op_sel_hi:[1,0]
  v_pk_mul_f32 v[152:153], v[152:153], v[8:9] op_sel_hi:[1,0]
  v_pk_mul_f32 v[154:155], v[154:155], v[8:9] op_sel_hi:[1,0]
  v_cvt_pk_bf16_f32 v156, v148, v149
  v_cvt_pk_bf16_f32 v157, v150, v151
  v_cvt_pk_bf16_f32 v158, v152, v153
  v_cvt_pk_bf16_f32 v159, v154, v155
  buffer_store_dwordx4 v[156:159], v2, s[4:7], s28 offen offset:3072 sc1
  s_add_u32 s28, s25, 100671488
  v_accvgpr_read_b32 v112, a64
  v_accvgpr_read_b32 v113, a65
  v_accvgpr_read_b32 v114, a66
  v_accvgpr_read_b32 v115, a67
  v_accvgpr_read_b32 v116, a68
  v_accvgpr_read_b32 v117, a69
  v_accvgpr_read_b32 v118, a70
  v_accvgpr_read_b32 v119, a71
  v_pk_mul_f32 v[112:113], v[112:113], v[10:11] op_sel_hi:[1,0]
  v_pk_mul_f32 v[114:115], v[114:115], v[10:11] op_sel_hi:[1,0]
  v_pk_mul_f32 v[116:117], v[116:117], v[10:11] op_sel_hi:[1,0]
  v_pk_mul_f32 v[118:119], v[118:119], v[10:11] op_sel_hi:[1,0]
  v_cvt_pk_bf16_f32 v120, v112, v113
  v_cvt_pk_bf16_f32 v121, v114, v115
  v_cvt_pk_bf16_f32 v122, v116, v117
  v_cvt_pk_bf16_f32 v123, v118, v119
  buffer_store_dwordx4 v[120:123], v2, s[4:7], s28 offen offset:0 sc1
  v_accvgpr_read_b32 v124, a72
  v_accvgpr_read_b32 v125, a73
  v_accvgpr_read_b32 v126, a74
  v_accvgpr_read_b32 v127, a75
  v_accvgpr_read_b32 v128, a76
  v_accvgpr_read_b32 v129, a77
  v_accvgpr_read_b32 v130, a78
  v_accvgpr_read_b32 v131, a79
  v_pk_mul_f32 v[124:125], v[124:125], v[10:11] op_sel_hi:[1,0]
  v_pk_mul_f32 v[126:127], v[126:127], v[10:11] op_sel_hi:[1,0]
  v_pk_mul_f32 v[128:129], v[128:129], v[10:11] op_sel_hi:[1,0]
  v_pk_mul_f32 v[130:131], v[130:131], v[10:11] op_sel_hi:[1,0]
  v_cvt_pk_bf16_f32 v132, v124, v125
  v_cvt_pk_bf16_f32 v133, v126, v127
  v_cvt_pk_bf16_f32 v134, v128, v129
  v_cvt_pk_bf16_f32 v135, v130, v131
  buffer_store_dwordx4 v[132:135], v2, s[4:7], s28 offen offset:1024 sc1
  v_accvgpr_read_b32 v136, a80
  v_accvgpr_read_b32 v137, a81
  v_accvgpr_read_b32 v138, a82
  v_accvgpr_read_b32 v139, a83
  v_accvgpr_read_b32 v140, a84
  v_accvgpr_read_b32 v141, a85
  v_accvgpr_read_b32 v142, a86
  v_accvgpr_read_b32 v143, a87
  v_pk_mul_f32 v[136:137], v[136:137], v[10:11] op_sel_hi:[1,0]
  v_pk_mul_f32 v[138:139], v[138:139], v[10:11] op_sel_hi:[1,0]
  v_pk_mul_f32 v[140:141], v[140:141], v[10:11] op_sel_hi:[1,0]
  v_pk_mul_f32 v[142:143], v[142:143], v[10:11] op_sel_hi:[1,0]
  v_cvt_pk_bf16_f32 v144, v136, v137
  v_cvt_pk_bf16_f32 v145, v138, v139
  v_cvt_pk_bf16_f32 v146, v140, v141
  v_cvt_pk_bf16_f32 v147, v142, v143
  buffer_store_dwordx4 v[144:147], v2, s[4:7], s28 offen offset:2048 sc1
  v_accvgpr_read_b32 v148, a88
  v_accvgpr_read_b32 v149, a89
  v_accvgpr_read_b32 v150, a90
  v_accvgpr_read_b32 v151, a91
  v_accvgpr_read_b32 v152, a92
  v_accvgpr_read_b32 v153, a93
  v_accvgpr_read_b32 v154, a94
  v_accvgpr_read_b32 v155, a95
  v_pk_mul_f32 v[148:149], v[148:149], v[10:11] op_sel_hi:[1,0]
  v_pk_mul_f32 v[150:151], v[150:151], v[10:11] op_sel_hi:[1,0]
  v_pk_mul_f32 v[152:153], v[152:153], v[10:11] op_sel_hi:[1,0]
  v_pk_mul_f32 v[154:155], v[154:155], v[10:11] op_sel_hi:[1,0]
  v_cvt_pk_bf16_f32 v156, v148, v149
  v_cvt_pk_bf16_f32 v157, v150, v151
  v_cvt_pk_bf16_f32 v158, v152, v153
  v_cvt_pk_bf16_f32 v159, v154, v155
  buffer_store_dwordx4 v[156:159], v2, s[4:7], s28 offen offset:3072 sc1
  s_add_u32 s28, s25, 100675584
  v_accvgpr_read_b32 v112, a96
  v_accvgpr_read_b32 v113, a97
  v_accvgpr_read_b32 v114, a98
  v_accvgpr_read_b32 v115, a99
  v_accvgpr_read_b32 v116, a100
  v_accvgpr_read_b32 v117, a101
  v_accvgpr_read_b32 v118, a102
  v_accvgpr_read_b32 v119, a103
  v_pk_mul_f32 v[112:113], v[112:113], v[10:11] op_sel_hi:[1,0]
  v_pk_mul_f32 v[114:115], v[114:115], v[10:11] op_sel_hi:[1,0]
  v_pk_mul_f32 v[116:117], v[116:117], v[10:11] op_sel_hi:[1,0]
  v_pk_mul_f32 v[118:119], v[118:119], v[10:11] op_sel_hi:[1,0]
  v_cvt_pk_bf16_f32 v120, v112, v113
  v_cvt_pk_bf16_f32 v121, v114, v115
  v_cvt_pk_bf16_f32 v122, v116, v117
  v_cvt_pk_bf16_f32 v123, v118, v119
  buffer_store_dwordx4 v[120:123], v2, s[4:7], s28 offen offset:0 sc1
  v_accvgpr_read_b32 v124, a104
  v_accvgpr_read_b32 v125, a105
  v_accvgpr_read_b32 v126, a106
  v_accvgpr_read_b32 v127, a107
  v_accvgpr_read_b32 v128, a108
  v_accvgpr_read_b32 v129, a109
  v_accvgpr_read_b32 v130, a110
  v_accvgpr_read_b32 v131, a111
  v_pk_mul_f32 v[124:125], v[124:125], v[10:11] op_sel_hi:[1,0]
  v_pk_mul_f32 v[126:127], v[126:127], v[10:11] op_sel_hi:[1,0]
  v_pk_mul_f32 v[128:129], v[128:129], v[10:11] op_sel_hi:[1,0]
  v_pk_mul_f32 v[130:131], v[130:131], v[10:11] op_sel_hi:[1,0]
  v_cvt_pk_bf16_f32 v132, v124, v125
  v_cvt_pk_bf16_f32 v133, v126, v127
  v_cvt_pk_bf16_f32 v134, v128, v129
  v_cvt_pk_bf16_f32 v135, v130, v131
  buffer_store_dwordx4 v[132:135], v2, s[4:7], s28 offen offset:1024 sc1
  v_accvgpr_read_b32 v136, a112
  v_accvgpr_read_b32 v137, a113
  v_accvgpr_read_b32 v138, a114
  v_accvgpr_read_b32 v139, a115
  v_accvgpr_read_b32 v140, a116
  v_accvgpr_read_b32 v141, a117
  v_accvgpr_read_b32 v142, a118
  v_accvgpr_read_b32 v143, a119
  v_pk_mul_f32 v[136:137], v[136:137], v[10:11] op_sel_hi:[1,0]
  v_pk_mul_f32 v[138:139], v[138:139], v[10:11] op_sel_hi:[1,0]
  v_pk_mul_f32 v[140:141], v[140:141], v[10:11] op_sel_hi:[1,0]
  v_pk_mul_f32 v[142:143], v[142:143], v[10:11] op_sel_hi:[1,0]
  v_cvt_pk_bf16_f32 v144, v136, v137
  v_cvt_pk_bf16_f32 v145, v138, v139
  v_cvt_pk_bf16_f32 v146, v140, v141
  v_cvt_pk_bf16_f32 v147, v142, v143
  buffer_store_dwordx4 v[144:147], v2, s[4:7], s28 offen offset:2048 sc1
  v_accvgpr_read_b32 v148, a120
  v_accvgpr_read_b32 v149, a121
  v_accvgpr_read_b32 v150, a122
  v_accvgpr_read_b32 v151, a123
  v_accvgpr_read_b32 v152, a124
  v_accvgpr_read_b32 v153, a125
  v_accvgpr_read_b32 v154, a126
  v_accvgpr_read_b32 v155, a127
  v_pk_mul_f32 v[148:149], v[148:149], v[10:11] op_sel_hi:[1,0]
  v_pk_mul_f32 v[150:151], v[150:151], v[10:11] op_sel_hi:[1,0]
  v_pk_mul_f32 v[152:153], v[152:153], v[10:11] op_sel_hi:[1,0]
  v_pk_mul_f32 v[154:155], v[154:155], v[10:11] op_sel_hi:[1,0]
  v_cvt_pk_bf16_f32 v156, v148, v149
  v_cvt_pk_bf16_f32 v157, v150, v151
  v_cvt_pk_bf16_f32 v158, v152, v153
  v_cvt_pk_bf16_f32 v159, v154, v155
  buffer_store_dwordx4 v[156:159], v2, s[4:7], s28 offen offset:3072 sc1
  s_branch A_out_31
A_kvw_32:
M_kv_35:
  s_cmp_ge_u32 s17, s36
  s_cbranch_scc1 M_kvok_36
  s_mov_b32 s76, 0
  s_mov_b32 s78, 23
  s_mov_b32 s77, 335872
  s_cmp_eq_u32 s68, 1
  s_cmov_b32 s76, 128
  s_cmov_b32 s78, 27
  s_cmov_b32 s77, 114688
  s_cmp_eq_u32 s68, 2
  s_cmov_b32 s76, 768
  s_cmov_b32 s78, 14
  s_cmov_b32 s77, 0
  s_add_u32 s76, s76, s67
  s_mov_b32 s71, 0
  s_branch M_sg_38
M_sw_37:
  s_sleep 8
  s_add_u32 s71, s71, 1
  s_cmp_gt_u32 s71, 262144
  s_cbranch_scc1 M_exit
M_sg_38:
  s_mov_b32 s79, 0
  s_atomic_or s79, s[72:73], s76 glc
  s_waitcnt lgkmcnt(0)
  s_cmp_lt_u32 s79, s78
  s_cbranch_scc1 M_sw_37
  s_add_u32 s36, s77, s19
  s_add_u32 s68, s68, 1
  s_branch M_kv_35
M_kvok_36:
  s_branch A_kvb_33
A_upd_29:
  s_cmp_eq_u32 s23, 2
  s_cbranch_scc1 A_upd2_39
  v_mov_b32 v12, s24
  v_cmp_le_i32 s[40:41], 0, v5
  v_cmp_le_i32 s[42:43], 1, v5
  v_cmp_le_i32 s[44:45], 2, v5
  v_cmp_le_i32 s[46:47], 3, v5
  v_cndmask_b32 v64, v12, v6, s[40:41]
  v_cndmask_b32 v65, v12, v6, s[42:43]
  v_cndmask_b32 v66, v12, v6, s[44:45]
  v_cndmask_b32 v67, v12, v6, s[46:47]
  v_cmp_le_i32 s[40:41], 8, v5
  v_cmp_le_i32 s[42:43], 9, v5
  v_cmp_le_i32 s[44:45], 10, v5
  v_cmp_le_i32 s[46:47], 11, v5
  v_cndmask_b32 v68, v12, v6, s[40:41]
  v_cndmask_b32 v69, v12, v6, s[42:43]
  v_cndmask_b32 v70, v12, v6, s[44:45]
  v_cndmask_b32 v71, v12, v6, s[46:47]
  v_cmp_le_i32 s[40:41], 16, v5
  v_cmp_le_i32 s[42:43], 17, v5
  v_cmp_le_i32 s[44:45], 18, v5
  v_cmp_le_i32 s[46:47], 19, v5
  v_cndmask_b32 v72, v12, v6, s[40:41]
  v_cndmask_b32 v73, v12, v6, s[42:43]
  v_cndmask_b32 v74, v12, v6, s[44:45]
  v_cndmask_b32 v75, v12, v6, s[46:47]
  v_cmp_le_i32 s[40:41], 24, v5
  v_cmp_le_i32 s[42:43], 25, v5
  v_cmp_le_i32 s[44:45], 26, v5
  v_cmp_le_i32 s[46:47], 27, v5
  v_cndmask_b32 v76, v12, v6, s[40:41]
  v_cndmask_b32 v77, v12, v6, s[42:43]
  v_cndmask_b32 v78, v12, v6, s[44:45]
  v_cndmask_b32 v79, v12, v6, s[46:47]
  v_mov_b32 v80, v7
  v_mov_b32 v81, v7
  v_mov_b32 v82, v7
  v_mov_b32 v83, v7
  v_mov_b32 v84, v7
  v_mov_b32 v85, v7
  v_mov_b32 v86, v7
  v_mov_b32 v87, v7
  v_mov_b32 v88, v7
  v_mov_b32 v89, v7
  v_mov_b32 v90, v7
  v_mov_b32 v91, v7
  v_mov_b32 v92, v7
  v_mov_b32 v93, v7
  v_mov_b32 v94, v7
  v_mov_b32 v95, v7
  s_branch A_back_30
A_upd2_39:
  v_mov_b32 v64, v6
  v_mov_b32 v65, v6
  v_mov_b32 v66, v6
  v_mov_b32 v67, v6
  v_mov_b32 v68, v6
  v_mov_b32 v69, v6
  v_mov_b32 v70, v6
  v_mov_b32 v71, v6
  v_mov_b32 v72, v6
  v_mov_b32 v73, v6
  v_mov_b32 v74, v6
  v_mov_b32 v75, v6
  v_mov_b32 v76, v6
  v_mov_b32 v77, v6
  v_mov_b32 v78, v6
  v_mov_b32 v79, v6
  s_branch A_back_30
A_slow_34:
  s_mov_b32 s29, 1
  v_mov_b32 v64, s24
  v_mov_b32 v65, s24
  v_mov_b32 v66, s24
  v_mov_b32 v67, s24
  v_mov_b32 v68, s24
  v_mov_b32 v69, s24
  v_mov_b32 v70, s24
  v_mov_b32 v71, s24
  v_mov_b32 v72, s24
  v_mov_b32 v73, s24
  v_mov_b32 v74, s24
  v_mov_b32 v75, s24
  v_mov_b32 v76, s24
  v_mov_b32 v77, s24
  v_mov_b32 v78, s24
  v_mov_b32 v79, s24
  v_mov_b32 v12, s24
  v_cmp_le_i32 s[40:41], 0, v5
  v_cmp_le_i32 s[42:43], 1, v5
  v_cmp_le_i32 s[44:45], 2, v5
  v_cmp_le_i32 s[46:47], 3, v5
  v_cndmask_b32 v80, v12, v7, s[40:41]
  v_cndmask_b32 v81, v12, v7, s[42:43]
  v_cndmask_b32 v82, v12, v7, s[44:45]
  v_cndmask_b32 v83, v12, v7, s[46:47]
  v_cmp_le_i32 s[40:41], 8, v5
  v_cmp_le_i32 s[42:43], 9, v5
  v_cmp_le_i32 s[44:45], 10, v5
  v_cmp_le_i32 s[46:47], 11, v5
  v_cndmask_b32 v84, v12, v7, s[40:41]
  v_cndmask_b32 v85, v12, v7, s[42:43]
  v_cndmask_b32 v86, v12, v7, s[44:45]
  v_cndmask_b32 v87, v12, v7, s[46:47]
  v_cmp_le_i32 s[40:41], 16, v5
  v_cmp_le_i32 s[42:43], 17, v5
  v_cmp_le_i32 s[44:45], 18, v5
  v_cmp_le_i32 s[46:47], 19, v5
  v_cndmask_b32 v88, v12, v7, s[40:41]
  v_cndmask_b32 v89, v12, v7, s[42:43]
  v_cndmask_b32 v90, v12, v7, s[44:45]
  v_cndmask_b32 v91, v12, v7, s[46:47]
  v_cmp_le_i32 s[40:41], 24, v5
  v_cmp_le_i32 s[42:43], 25, v5
  v_cmp_le_i32 s[44:45], 26, v5
  v_cmp_le_i32 s[46:47], 27, v5
  v_cndmask_b32 v92, v12, v7, s[40:41]
  v_cndmask_b32 v93, v12, v7, s[42:43]
  v_cndmask_b32 v94, v12, v7, s[44:45]
  v_cndmask_b32 v95, v12, v7, s[46:47]
  v_mov_b32 v8, s24
  v_mov_b32 v10, s24
  s_add_u32 s17, s25, 16785408
  s_mov_b32 s23, 0
A_ml_40:
  s_add_u32 s28, s17, 4096
  buffer_load_dwordx4 a[192:195], v2, s[4:7], s17 offen offset:0 sc1
  buffer_load_dwordx4 a[196:199], v2, s[4:7], s17 offen offset:1024 sc1
  buffer_load_dwordx4 a[200:203], v2, s[4:7], s17 offen offset:2048 sc1
  buffer_load_dwordx4 a[204:207], v2, s[4:7], s17 offen offset:3072 sc1
  buffer_load_dwordx4 a[208:211], v2, s[4:7], s28 offen offset:0 sc1
  buffer_load_dwordx4 a[212:215], v2, s[4:7], s28 offen offset:1024 sc1
  buffer_load_dwordx4 a[216:219], v2, s[4:7], s28 offen offset:2048 sc1
  buffer_load_dwordx4 a[220:223], v2, s[4:7], s28 offen offset:3072 sc1
  s_waitcnt vmcnt(0)
  v_mfma_f32_32x32x16_bf16 v[32:47], a[192:195], a[128:131], v[64:79]
  v_mfma_f32_32x32x16_bf16 v[32:47], a[196:199], a[132:135], v[32:47]
  v_mfma_f32_32x32x16_bf16 v[32:47], a[200:203], a[136:139], v[32:47]
  v_mfma_f32_32x32x16_bf16 v[32:47], a[204:207], a[140:143], v[32:47]
  v_mfma_f32_32x32x16_bf16 v[32:47], a[208:211], a[144:147], v[32:47]
  v_mfma_f32_32x32x16_bf16 v[32:47], a[212:215], a[148:151], v[32:47]
  v_mfma_f32_32x32x16_bf16 v[32:47], a[216:219], a[152:155], v[32:47]
  v_mfma_f32_32x32x16_bf16 v[32:47], a[220:223], a[156:159], v[32:47]
  v_mfma_f32_32x32x16_bf16 v[48:63], a[192:195], a[160:163], v[80:95]
  v_mfma_f32_32x32x16_bf16 v[48:63], a[196:199], a[164:167], v[48:63]
  v_mfma_f32_32x32x16_bf16 v[48:63], a[200:203], a[168:171], v[48:63]
  v_mfma_f32_32x32x16_bf16 v[48:63], a[204:207], a[172:175], v[48:63]
  v_mfma_f32_32x32x16_bf16 v[48:63], a[208:211], a[176:179], v[48:63]
  v_mfma_f32_32x32x16_bf16 v[48:63], a[212:215], a[180:183], v[48:63]
  v_mfma_f32_32x32x16_bf16 v[48:63], a[216:219], a[184:187], v[48:63]
  v_mfma_f32_32x32x16_bf16 v[48:63], a[220:223], a[188:191], v[48:63]
  s_nop 7
  s_nop 3
  v_max3_f32 v8, v8, v32, v33
  v_max3_f32 v8, v8, v34, v35
  v_max3_f32 v8, v8, v36, v37
  v_max3_f32 v8, v8, v38, v39
  v_max3_f32 v8, v8, v40, v41
  v_max3_f32 v8, v8, v42, v43
  v_max3_f32 v8, v8, v44, v45
  v_max3_f32 v8, v8, v46, v47
  v_max3_f32 v10, v10, v48, v49
  v_max3_f32 v10, v10, v50, v51
  v_max3_f32 v10, v10, v52, v53
  v_max3_f32 v10, v10, v54, v55
  v_max3_f32 v10, v10, v56, v57
  v_max3_f32 v10, v10, v58, v59
  v_max3_f32 v10, v10, v60, v61
  v_max3_f32 v10, v10, v62, v63
  s_add_u32 s23, s23, 1
  s_cmp_lg_u32 s23, 1
  s_cbranch_scc1 A_m2_41
  v_mov_b32 v12, s24
  v_cmp_le_i32 s[40:41], 0, v5
  v_cmp_le_i32 s[42:43], 1, v5
  v_cmp_le_i32 s[44:45], 2, v5
  v_cmp_le_i32 s[46:47], 3, v5
  v_cndmask_b32 v64, v12, v6, s[40:41]
  v_cndmask_b32 v65, v12, v6, s[42:43]
  v_cndmask_b32 v66, v12, v6, s[44:45]
  v_cndmask_b32 v67, v12, v6, s[46:47]
  v_cmp_le_i32 s[40:41], 8, v5
  v_cmp_le_i32 s[42:43], 9, v5
  v_cmp_le_i32 s[44:45], 10, v5
  v_cmp_le_i32 s[46:47], 11, v5
  v_cndmask_b32 v68, v12, v6, s[40:41]
  v_cndmask_b32 v69, v12, v6, s[42:43]
  v_cndmask_b32 v70, v12, v6, s[44:45]
  v_cndmask_b32 v71, v12, v6, s[46:47]
  v_cmp_le_i32 s[40:41], 16, v5
  v_cmp_le_i32 s[42:43], 17, v5
  v_cmp_le_i32 s[44:45], 18, v5
  v_cmp_le_i32 s[46:47], 19, v5
  v_cndmask_b32 v72, v12, v6, s[40:41]
  v_cndmask_b32 v73, v12, v6, s[42:43]
  v_cndmask_b32 v74, v12, v6, s[44:45]
  v_cndmask_b32 v75, v12, v6, s[46:47]
  v_cmp_le_i32 s[40:41], 24, v5
  v_cmp_le_i32 s[42:43], 25, v5
  v_cmp_le_i32 s[44:45], 26, v5
  v_cmp_le_i32 s[46:47], 27, v5
  v_cndmask_b32 v76, v12, v6, s[40:41]
  v_cndmask_b32 v77, v12, v6, s[42:43]
  v_cndmask_b32 v78, v12, v6, s[44:45]
  v_cndmask_b32 v79, v12, v6, s[46:47]
  v_mov_b32 v80, v7
  v_mov_b32 v81, v7
  v_mov_b32 v82, v7
  v_mov_b32 v83, v7
  v_mov_b32 v84, v7
  v_mov_b32 v85, v7
  v_mov_b32 v86, v7
  v_mov_b32 v87, v7
  v_mov_b32 v88, v7
  v_mov_b32 v89, v7
  v_mov_b32 v90, v7
  v_mov_b32 v91, v7
  v_mov_b32 v92, v7
  v_mov_b32 v93, v7
  v_mov_b32 v94, v7
  v_mov_b32 v95, v7
A_m2_41:
  s_cmp_lg_u32 s23, 2
  s_cbranch_scc1 A_m3_42
  v_mov_b32 v64, v6
  v_mov_b32 v65, v6
  v_mov_b32 v66, v6
  v_mov_b32 v67, v6
  v_mov_b32 v68, v6
  v_mov_b32 v69, v6
  v_mov_b32 v70, v6
  v_mov_b32 v71, v6
  v_mov_b32 v72, v6
  v_mov_b32 v73, v6
  v_mov_b32 v74, v6
  v_mov_b32 v75, v6
  v_mov_b32 v76, v6
  v_mov_b32 v77, v6
  v_mov_b32 v78, v6
  v_mov_b32 v79, v6
A_m3_42:
  s_sub_u32 s17, s17, 8192
  s_cmp_ge_i32 s17, s19
  s_cbranch_scc1 A_ml_40
  v_mov_b32 v9, v8
  s_nop 1
  v_permlane32_swap_b32 v8, v9
  s_nop 1
  v_max_f32 v8, v8, v9
  v_sub_f32 v6, 0, v8
  v_mov_b32 v11, v10
  s_nop 1
  v_permlane32_swap_b32 v10, v11
  s_nop 1
  v_max_f32 v10, v10, v11
  v_sub_f32 v7, 0, v10
  s_branch A_again_21
A_out_31:
  s_mov_b32 s69, s55
  s_mov_b32 s70, s56
  s_sub_u32 s52, s52, 1
  s_cmp_lg_u32 s52, 0
  s_cbranch_scc1 M_att
  s_waitcnt vmcnt(0)
  s_barrier
  s_mov_b32 s30, 512
  v_mov_b32 v144, s30
  v_min_u32 v145, 1, v0
  v_lshlrev_b32 v145, 30, v145
  buffer_store_dword v144, v145, s[4:7], s31 offen sc1
  s_lshr_b32 s48, s64, 2
  s_bfe_u32 s49, s64, 0x10001
  s_and_b32 s50, s64, 1
  s_mul_i32 s50, s50, 6
  s_add_u32 s50, s50, s65
  s_mov_b32 s51, 12
  s_cmp_lt_u32 s50, 4
  s_cselect_b32 s23, 6, 5
  s_load_dwordx2 s[8:9], s[0:1], 40
  s_lshl_b32 s17, s48, 19
  s_lshl_b32 s26, s49, 2
  s_add_u32 s26, s26, s16
  s_lshl_b32 s27, s26, 7
  s_add_u32 s17, s17, s27
  s_mov_b32 s18, 1024
  s_lshl_b32 s21, s48, 6
  s_add_u32 s21, s21, s50
  s_lshl_b32 s21, s21, 3
  s_add_u32 s21, s21, s26
  s_lshl_b32 s21, s21, 12
  s_add_u32 s21, s21, 150994944
  s_lshl_b32 s22, s51, 15
  s_mov_b32 s24, 1.0
  s_waitcnt lgkmcnt(0)
  s_and_b32 s9, s9, 0xffff
  s_mov_b32 s10, 4194304
  s_mov_b32 s11, 0x20000
  s_mov_b32 s12, s4
  s_mov_b32 s13, s5
  s_mov_b32 s14, 268435456
  s_mov_b32 s15, 0x20000
  s_lshl_b32 s19, s48, 8
  s_add_u32 s19, s19, s50
  s_lshl_b32 s19, s19, 13
  s_add_u32 s19, s19, 100663296
  s_lshl_b32 s20, s51, 13
  s_mul_i32 s26, s16, 524288
  v_add_u32 v8, 0, v2
  v_add_u32 v16, s26, v8
  v_add_u32 v9, 1024, v2
  v_add_u32 v17, s26, v9
  v_add_u32 v10, 2048, v2
  v_add_u32 v18, s26, v10
  v_add_u32 v11, 3072, v2
  v_add_u32 v19, s26, v11
  v_add_u32 v12, 4096, v2
  v_add_u32 v20, s26, v12
  v_add_u32 v13, 5120, v2
  v_add_u32 v21, s26, v13
  v_add_u32 v14, 6144, v2
  v_add_u32 v22, s26, v14
  v_add_u32 v15, 7168, v2
  v_add_u32 v23, s26, v15
  v_lshrrev_b32 v144, 3, v1
  v_mul_lo_u32 v144, v144, s18
  v_and_b32 v145, 7, v1
  v_lshl_add_u32 v144, v145, 4, v144
  s_lshl_b32 s28, s16, 15
  s_add_u32 s28, s28, 32768
  s_lshl_b32 s29, s18, 3
  s_add_u32 m0, s28, 0
  s_nop 0
  buffer_load_dwordx4 v144, s[8:11], s17 offen lds
  s_add_u32 s17, s17, s29
  s_add_u32 m0, s28, 1024
  s_nop 0
  buffer_load_dwordx4 v144, s[8:11], s17 offen lds
  s_add_u32 s17, s17, s29
  s_add_u32 m0, s28, 2048
  s_nop 0
  buffer_load_dwordx4 v144, s[8:11], s17 offen lds
  s_add_u32 s17, s17, s29
  s_add_u32 m0, s28, 3072
  s_nop 0
  buffer_load_dwordx4 v144, s[8:11], s17 offen lds
  s_add_u32 s17, s17, s29
  s_add_u32 m0, s28, 4096
  s_nop 0
  buffer_load_dwordx4 v144, s[8:11], s17 offen lds
  s_add_u32 s17, s17, s29
  s_add_u32 m0, s28, 5120
  s_nop 0
  buffer_load_dwordx4 v144, s[8:11], s17 offen lds
  s_add_u32 s17, s17, s29
  s_add_u32 m0, s28, 6144
  s_nop 0
  buffer_load_dwordx4 v144, s[8:11], s17 offen lds
  s_add_u32 s17, s17, s29
  s_add_u32 m0, s28, 7168
  s_nop 0
  buffer_load_dwordx4 v144, s[8:11], s17 offen lds
  s_add_u32 s17, s17, s29
  s_add_u32 m0, s28, 8192
  s_nop 0
  buffer_load_dwordx4 v144, s[8:11], s17 offen lds
  s_add_u32 s17, s17, s29
  s_add_u32 m0, s28, 9216
  s_nop 0
  buffer_load_dwordx4 v144, s[8:11], s17 offen lds
  s_add_u32 s17, s17, s29
  s_add_u32 m0, s28, 10240
  s_nop 0
  buffer_load_dwordx4 v144, s[8:11], s17 offen lds
  s_add_u32 s17, s17, s29
  s_add_u32 m0, s28, 11264
  s_nop 0
  buffer_load_dwordx4 v144, s[8:11], s17 offen lds
  s_add_u32 s17, s17, s29
  s_add_u32 m0, s28, 12288
  s_nop 0
  buffer_load_dwordx4 v144, s[8:11], s17 offen lds
  s_add_u32 s17, s17, s29
  s_add_u32 m0, s28, 13312
  s_nop 0
  buffer_load_dwordx4 v144, s[8:11], s17 offen lds
  s_add_u32 s17, s17, s29
  s_add_u32 m0, s28, 14336
  s_nop 0
  buffer_load_dwordx4 v144, s[8:11], s17 offen lds
  s_add_u32 s17, s17, s29
  s_add_u32 m0, s28, 15360
  s_nop 0
  buffer_load_dwordx4 v144, s[8:11], s17 offen lds
  s_add_u32 s17, s17, s29
  s_add_u32 m0, s28, 16384
  s_nop 0
  buffer_load_dwordx4 v144, s[8:11], s17 offen lds
  s_add_u32 s17, s17, s29
  s_add_u32 m0, s28, 17408
  s_nop 0
  buffer_load_dwordx4 v144, s[8:11], s17 offen lds
  s_add_u32 s17, s17, s29
  s_add_u32 m0, s28, 18432
  s_nop 0
  buffer_load_dwordx4 v144, s[8:11], s17 offen lds
  s_add_u32 s17, s17, s29
  s_add_u32 m0, s28, 19456
  s_nop 0
  buffer_load_dwordx4 v144, s[8:11], s17 offen lds
  s_add_u32 s17, s17, s29
  s_add_u32 m0, s28, 20480
  s_nop 0
  buffer_load_dwordx4 v144, s[8:11], s17 offen lds
  s_add_u32 s17, s17, s29
  s_add_u32 m0, s28, 21504
  s_nop 0
  buffer_load_dwordx4 v144, s[8:11], s17 offen lds
  s_add_u32 s17, s17, s29
  s_add_u32 m0, s28, 22528
  s_nop 0
  buffer_load_dwordx4 v144, s[8:11], s17 offen lds
  s_add_u32 s17, s17, s29
  s_add_u32 m0, s28, 23552
  s_nop 0
  buffer_load_dwordx4 v144, s[8:11], s17 offen lds
  s_add_u32 s17, s17, s29
  s_add_u32 m0, s28, 24576
  s_nop 0
  buffer_load_dwordx4 v144, s[8:11], s17 offen lds
  s_add_u32 s17, s17, s29
  s_add_u32 m0, s28, 25600
  s_nop 0
  buffer_load_dwordx4 v144, s[8:11], s17 offen lds
  s_add_u32 s17, s17, s29
  s_add_u32 m0, s28, 26624
  s_nop 0
  buffer_load_dwordx4 v144, s[8:11], s17 offen lds
  s_add_u32 s17, s17, s29
  s_add_u32 m0, s28, 27648
  s_nop 0
  buffer_load_dwordx4 v144, s[8:11], s17 offen lds
  s_add_u32 s17, s17, s29
  s_add_u32 m0, s28, 28672
  s_nop 0
  buffer_load_dwordx4 v144, s[8:11], s17 offen lds
  s_add_u32 s17, s17, s29
  s_add_u32 m0, s28, 29696
  s_nop 0
  buffer_load_dwordx4 v144, s[8:11], s17 offen lds
  s_add_u32 s17, s17, s29
  s_add_u32 m0, s28, 30720
  s_nop 0
  buffer_load_dwordx4 v144, s[8:11], s17 offen lds
  s_add_u32 s17, s17, s29
  s_add_u32 m0, s28, 31744
  s_nop 0
  buffer_load_dwordx4 v144, s[8:11], s17 offen lds
  s_add_u32 s17, s17, s29
  v_bfe_u32 v148, v1, 2, 2
  v_lshrrev_b32 v149, 5, v1
  v_lshl_add_u32 v148, v149, 2, v148
  v_lshlrev_b32 v148, 7, v148
  v_bfe_u32 v149, v1, 4, 1
  v_lshl_add_u32 v148, v149, 5, v148
  v_and_b32 v149, 1, v1
  v_lshl_add_u32 v148, v149, 4, v148
  v_bfe_u32 v149, v1, 1, 1
  v_lshl_add_u32 v148, v149, 3, v148
  v_add_u32 v146, s28, v148
  v_add_u32 v147, 1024, v146
  s_waitcnt vmcnt(28)
  ds_read_b64_tr_b16 a[0:1], v146 offset:0
  ds_read_b64_tr_b16 a[2:3], v147 offset:0
  ds_read_b64_tr_b16 a[4:5], v146 offset:64
  ds_read_b64_tr_b16 a[6:7], v147 offset:64
  ds_read_b64_tr_b16 a[8:9], v146 offset:2048
  ds_read_b64_tr_b16 a[10:11], v147 offset:2048
  ds_read_b64_tr_b16 a[12:13], v146 offset:2112
  ds_read_b64_tr_b16 a[14:15], v147 offset:2112
  s_waitcnt lgkmcnt(0)
  s_add_u32 m0, s28, 0
  s_nop 0
  buffer_load_dwordx4 v144, s[8:11], s17 offen lds
  s_add_u32 s17, s17, s29
  s_add_u32 m0, s28, 1024
  s_nop 0
  buffer_load_dwordx4 v144, s[8:11], s17 offen lds
  s_add_u32 s17, s17, s29
  s_add_u32 m0, s28, 2048
  s_nop 0
  buffer_load_dwordx4 v144, s[8:11], s17 offen lds
  s_add_u32 s17, s17, s29
  s_add_u32 m0, s28, 3072
  s_nop 0
  buffer_load_dwordx4 v144, s[8:11], s17 offen lds
  s_add_u32 s17, s17, s29
  s_waitcnt vmcnt(28)
  ds_read_b64_tr_b16 a[16:17], v146 offset:4096
  ds_read_b64_tr_b16 a[18:19], v147 offset:4096
  ds_read_b64_tr_b16 a[20:21], v146 offset:4160
  ds_read_b64_tr_b16 a[22:23], v147 offset:4160
  ds_read_b64_tr_b16 a[24:25], v146 offset:6144
  ds_read_b64_tr_b16 a[26:27], v147 offset:6144
  ds_read_b64_tr_b16 a[28:29], v146 offset:6208
  ds_read_b64_tr_b16 a[30:31], v147 offset:6208
  s_waitcnt lgkmcnt(0)
  s_add_u32 m0, s28, 4096
  s_nop 0
  buffer_load_dwordx4 v144, s[8:11], s17 offen lds
  s_add_u32 s17, s17, s29
  s_add_u32 m0, s28, 5120
  s_nop 0
  buffer_load_dwordx4 v144, s[8:11], s17 offen lds
  s_add_u32 s17, s17, s29
  s_add_u32 m0, s28, 6144
  s_nop 0
  buffer_load_dwordx4 v144, s[8:11], s17 offen lds
  s_add_u32 s17, s17, s29
  s_add_u32 m0, s28, 7168
  s_nop 0
  buffer_load_dwordx4 v144, s[8:11], s17 offen lds
  s_add_u32 s17, s17, s29
  s_waitcnt vmcnt(28)
  ds_read_b64_tr_b16 a[32:33], v146 offset:8192
  ds_read_b64_tr_b16 a[34:35], v147 offset:8192
  ds_read_b64_tr_b16 a[36:37], v146 offset:8256
  ds_read_b64_tr_b16 a[38:39], v147 offset:8256
  ds_read_b64_tr_b16 a[40:41], v146 offset:10240
  ds_read_b64_tr_b16 a[42:43], v147 offset:10240
  ds_read_b64_tr_b16 a[44:45], v146 offset:10304
  ds_read_b64_tr_b16 a[46:47], v147 offset:10304
  s_waitcnt lgkmcnt(0)
  s_add_u32 m0, s28, 8192
  s_nop 0
  buffer_load_dwordx4 v144, s[8:11], s17 offen lds
  s_add_u32 s17, s17, s29
  s_add_u32 m0, s28, 9216
  s_nop 0
  buffer_load_dwordx4 v144, s[8:11], s17 offen lds
  s_add_u32 s17, s17, s29
  s_add_u32 m0, s28, 10240
  s_nop 0
  buffer_load_dwordx4 v144, s[8:11], s17 offen lds
  s_add_u32 s17, s17, s29
  s_add_u32 m0, s28, 11264
  s_nop 0
  buffer_load_dwordx4 v144, s[8:11], s17 offen lds
  s_add_u32 s17, s17, s29
  s_waitcnt vmcnt(28)
  ds_read_b64_tr_b16 a[48:49], v146 offset:12288
  ds_read_b64_tr_b16 a[50:51], v147 offset:12288
  ds_read_b64_tr_b16 a[52:53], v146 offset:12352
  ds_read_b64_tr_b16 a[54:55], v147 offset:12352
  ds_read_b64_tr_b16 a[56:57], v146 offset:14336
  ds_read_b64_tr_b16 a[58:59], v147 offset:14336
  ds_read_b64_tr_b16 a[60:61], v146 offset:14400
  ds_read_b64_tr_b16 a[62:63], v147 offset:14400
  s_waitcnt lgkmcnt(0)
  s_add_u32 m0, s28, 12288
  s_nop 0
  buffer_load_dwordx4 v144, s[8:11], s17 offen lds
  s_add_u32 s17, s17, s29
  s_add_u32 m0, s28, 13312
  s_nop 0
  buffer_load_dwordx4 v144, s[8:11], s17 offen lds
  s_add_u32 s17, s17, s29
  s_add_u32 m0, s28, 14336
  s_nop 0
  buffer_load_dwordx4 v144, s[8:11], s17 offen lds
  s_add_u32 s17, s17, s29
  s_add_u32 m0, s28, 15360
  s_nop 0
  buffer_load_dwordx4 v144, s[8:11], s17 offen lds
  s_add_u32 s17, s17, s29
  s_waitcnt vmcnt(28)
  ds_read_b64_tr_b16 a[64:65], v146 offset:16384
  ds_read_b64_tr_b16 a[66:67], v147 offset:16384
  ds_read_b64_tr_b16 a[68:69], v146 offset:16448
  ds_read_b64_tr_b16 a[70:71], v147 offset:16448
  ds_read_b64_tr_b16 a[72:73], v146 offset:18432
  ds_read_b64_tr_b16 a[74:75], v147 offset:18432
  ds_read_b64_tr_b16 a[76:77], v146 offset:18496
  ds_read_b64_tr_b16 a[78:79], v147 offset:18496
  s_waitcnt lgkmcnt(0)
  s_add_u32 m0, s28, 16384
  s_nop 0
  buffer_load_dwordx4 v144, s[8:11], s17 offen lds
  s_add_u32 s17, s17, s29
  s_add_u32 m0, s28, 17408
  s_nop 0
  buffer_load_dwordx4 v144, s[8:11], s17 offen lds
  s_add_u32 s17, s17, s29
  s_add_u32 m0, s28, 18432
  s_nop 0
  buffer_load_dwordx4 v144, s[8:11], s17 offen lds
  s_add_u32 s17, s17, s29
  s_add_u32 m0, s28, 19456
  s_nop 0
  buffer_load_dwordx4 v144, s[8:11], s17 offen lds
  s_add_u32 s17, s17, s29
  s_waitcnt vmcnt(28)
  ds_read_b64_tr_b16 a[80:81], v146 offset:20480
  ds_read_b64_tr_b16 a[82:83], v147 offset:20480
  ds_read_b64_tr_b16 a[84:85], v146 offset:20544
  ds_read_b64_tr_b16 a[86:87], v147 offset:20544
  ds_read_b64_tr_b16 a[88:89], v146 offset:22528
  ds_read_b64_tr_b16 a[90:91], v147 offset:22528
  ds_read_b64_tr_b16 a[92:93], v146 offset:22592
  ds_read_b64_tr_b16 a[94:95], v147 offset:22592
  s_waitcnt lgkmcnt(0)
  s_add_u32 m0, s28, 20480
  s_nop 0
  buffer_load_dwordx4 v144, s[8:11], s17 offen lds
  s_add_u32 s17, s17, s29
  s_add_u32 m0, s28, 21504
  s_nop 0
  buffer_load_dwordx4 v144, s[8:11], s17 offen lds
  s_add_u32 s17, s17, s29
  s_add_u32 m0, s28, 22528
  s_nop 0
  buffer_load_dwordx4 v144, s[8:11], s17 offen lds
  s_add_u32 s17, s17, s29
  s_add_u32 m0, s28, 23552
  s_nop 0
  buffer_load_dwordx4 v144, s[8:11], s17 offen lds
  s_add_u32 s17, s17, s29
  s_waitcnt vmcnt(28)
  ds_read_b64_tr_b16 a[96:97], v146 offset:24576
  ds_read_b64_tr_b16 a[98:99], v147 offset:24576
  ds_read_b64_tr_b16 a[100:101], v146 offset:24640
  ds_read_b64_tr_b16 a[102:103], v147 offset:24640
  ds_read_b64_tr_b16 a[104:105], v146 offset:26624
  ds_read_b64_tr_b16 a[106:107], v147 offset:26624
  ds_read_b64_tr_b16 a[108:109], v146 offset:26688
  ds_read_b64_tr_b16 a[110:111], v147 offset:26688
  s_waitcnt lgkmcnt(0)
  s_add_u32 m0, s28, 24576
  s_nop 0
  buffer_load_dwordx4 v144, s[8:11], s17 offen lds
  s_add_u32 s17, s17, s29
  s_add_u32 m0, s28, 25600
  s_nop 0
  buffer_load_dwordx4 v144, s[8:11], s17 offen lds
  s_add_u32 s17, s17, s29
  s_add_u32 m0, s28, 26624
  s_nop 0
  buffer_load_dwordx4 v144, s[8:11], s17 offen lds
  s_add_u32 s17, s17, s29
  s_add_u32 m0, s28, 27648
  s_nop 0
  buffer_load_dwordx4 v144, s[8:11], s17 offen lds
  s_add_u32 s17, s17, s29
  s_waitcnt vmcnt(28)
  ds_read_b64_tr_b16 a[112:113], v146 offset:28672
  ds_read_b64_tr_b16 a[114:115], v147 offset:28672
  ds_read_b64_tr_b16 a[116:117], v146 offset:28736
  ds_read_b64_tr_b16 a[118:119], v147 offset:28736
  ds_read_b64_tr_b16 a[120:121], v146 offset:30720
  ds_read_b64_tr_b16 a[122:123], v147 offset:30720
  ds_read_b64_tr_b16 a[124:125], v146 offset:30784
  ds_read_b64_tr_b16 a[126:127], v147 offset:30784
  s_waitcnt lgkmcnt(0)
  s_add_u32 m0, s28, 28672
  s_nop 0
  buffer_load_dwordx4 v144, s[8:11], s17 offen lds
  s_add_u32 s17, s17, s29
  s_add_u32 m0, s28, 29696
  s_nop 0
  buffer_load_dwordx4 v144, s[8:11], s17 offen lds
  s_add_u32 s17, s17, s29
  s_add_u32 m0, s28, 30720
  s_nop 0
  buffer_load_dwordx4 v144, s[8:11], s17 offen lds
  s_add_u32 s17, s17, s29
  s_add_u32 m0, s28, 31744
  s_nop 0
  buffer_load_dwordx4 v144, s[8:11], s17 offen lds
  s_add_u32 s17, s17, s29
  s_waitcnt vmcnt(28)
  ds_read_b64_tr_b16 a[128:129], v146 offset:0
  ds_read_b64_tr_b16 a[130:131], v147 offset:0
  ds_read_b64_tr_b16 a[132:133], v146 offset:64
  ds_read_b64_tr_b16 a[134:135], v147 offset:64
  ds_read_b64_tr_b16 a[136:137], v146 offset:2048
  ds_read_b64_tr_b16 a[138:139], v147 offset:2048
  ds_read_b64_tr_b16 a[140:141], v146 offset:2112
  ds_read_b64_tr_b16 a[142:143], v147 offset:2112
  s_waitcnt lgkmcnt(0)
  s_waitcnt vmcnt(24)
  ds_read_b64_tr_b16 a[144:145], v146 offset:4096
  ds_read_b64_tr_b16 a[146:147], v147 offset:4096
  ds_read_b64_tr_b16 a[148:149], v146 offset:4160
  ds_read_b64_tr_b16 a[150:151], v147 offset:4160
  ds_read_b64_tr_b16 a[152:153], v146 offset:6144
  ds_read_b64_tr_b16 a[154:155], v147 offset:6144
  ds_read_b64_tr_b16 a[156:157], v146 offset:6208
  ds_read_b64_tr_b16 a[158:159], v147 offset:6208
  s_waitcnt lgkmcnt(0)
  s_waitcnt vmcnt(20)
  ds_read_b64_tr_b16 a[160:161], v146 offset:8192
  ds_read_b64_tr_b16 a[162:163], v147 offset:8192
  ds_read_b64_tr_b16 a[164:165], v146 offset:8256
  ds_read_b64_tr_b16 a[166:167], v147 offset:8256
  ds_read_b64_tr_b16 a[168:169], v146 offset:10240
  ds_read_b64_tr_b16 a[170:171], v147 offset:10240
  ds_read_b64_tr_b16 a[172:173], v146 offset:10304
  ds_read_b64_tr_b16 a[174:175], v147 offset:10304
  s_waitcnt lgkmcnt(0)
  s_waitcnt vmcnt(16)
  ds_read_b64_tr_b16 a[176:177], v146 offset:12288
  ds_read_b64_tr_b16 a[178:179], v147 offset:12288
  ds_read_b64_tr_b16 a[180:181], v146 offset:12352
  ds_read_b64_tr_b16 a[182:183], v147 offset:12352
  ds_read_b64_tr_b16 a[184:185], v146 offset:14336
  ds_read_b64_tr_b16 a[186:187], v147 offset:14336
  ds_read_b64_tr_b16 a[188:189], v146 offset:14400
  ds_read_b64_tr_b16 a[190:191], v147 offset:14400
  s_waitcnt lgkmcnt(0)
  s_waitcnt vmcnt(12)
  ds_read_b64_tr_b16 a[192:193], v146 offset:16384
  ds_read_b64_tr_b16 a[194:195], v147 offset:16384
  ds_read_b64_tr_b16 a[196:197], v146 offset:16448
  ds_read_b64_tr_b16 a[198:199], v147 offset:16448
  ds_read_b64_tr_b16 a[200:201], v146 offset:18432
  ds_read_b64_tr_b16 a[202:203], v147 offset:18432
  ds_read_b64_tr_b16 a[204:205], v146 offset:18496
  ds_read_b64_tr_b16 a[206:207], v147 offset:18496
  s_waitcnt lgkmcnt(0)
  s_waitcnt vmcnt(8)
  ds_read_b64_tr_b16 a[208:209], v146 offset:20480
  ds_read_b64_tr_b16 a[210:211], v147 offset:20480
  ds_read_b64_tr_b16 a[212:213], v146 offset:20544
  ds_read_b64_tr_b16 a[214:215], v147 offset:20544
  ds_read_b64_tr_b16 a[216:217], v146 offset:22528
  ds_read_b64_tr_b16 a[218:219], v147 offset:22528
  ds_read_b64_tr_b16 a[220:221], v146 offset:22592
  ds_read_b64_tr_b16 a[222:223], v147 offset:22592
  s_waitcnt lgkmcnt(0)
  s_waitcnt vmcnt(4)
  ds_read_b64_tr_b16 a[224:225], v146 offset:24576
  ds_read_b64_tr_b16 a[226:227], v147 offset:24576
  ds_read_b64_tr_b16 a[228:229], v146 offset:24640
  ds_read_b64_tr_b16 a[230:231], v147 offset:24640
  ds_read_b64_tr_b16 a[232:233], v146 offset:26624
  ds_read_b64_tr_b16 a[234:235], v147 offset:26624
  ds_read_b64_tr_b16 a[236:237], v146 offset:26688
  ds_read_b64_tr_b16 a[238:239], v147 offset:26688
  s_waitcnt lgkmcnt(0)
  s_waitcnt vmcnt(0)
  ds_read_b64_tr_b16 a[240:241], v146 offset:28672
  ds_read_b64_tr_b16 a[242:243], v147 offset:28672
  ds_read_b64_tr_b16 a[244:245], v146 offset:28736
  ds_read_b64_tr_b16 a[246:247], v147 offset:28736
  ds_read_b64_tr_b16 a[248:249], v146 offset:30720
  ds_read_b64_tr_b16 a[250:251], v147 offset:30720
  ds_read_b64_tr_b16 a[252:253], v146 offset:30784
  ds_read_b64_tr_b16 a[254:255], v147 offset:30784
  s_waitcnt lgkmcnt(0)
  v_min_u32 v4, 27, v1
  v_mul_u32_u24 v5, 37, v4
  v_lshrrev_b32 v5, 8, v5
  v_mul_u32_u24 v5, 7, v5
  v_sub_u32 v5, v4, v5
  v_mov_b32 v6, 0x200
  v_cmp_ne_u32 vcc, 6, v5
  s_mul_i32 s76, s48, 3584
  s_add_u32 s76, s76, 148897792
  v_cndmask_b32 v5, 0, v6, vcc
  v_lshl_add_u32 v4, v4, 7, s76
  s_mov_b32 s71, 0
  s_branch M_vg_44
M_vw_43:
  s_sleep 2
  s_add_u32 s71, s71, 1
  s_cmp_gt_u32 s71, 262144
  s_cbranch_scc1 M_exit
M_vg_44:
  buffer_load_dword v6, v4, s[4:7], 0 offen sc1
  s_waitcnt vmcnt(0)
  v_cmp_lt_u32 vcc, v6, v5
  s_cbranch_vccnz M_vw_43
  s_barrier
  s_lshl_b32 s25, s16, 13
  s_add_u32 m0, s25, 0
  s_nop 0
  buffer_load_dwordx4 v16, s[12:15], s19 offen sc1 lds
  s_add_u32 m0, s25, 1024
  s_nop 0
  buffer_load_dwordx4 v17, s[12:15], s19 offen sc1 lds
  s_add_u32 m0, s25, 2048
  s_nop 0
  buffer_load_dwordx4 v18, s[12:15], s19 offen sc1 lds
  s_add_u32 m0, s25, 3072
  s_nop 0
  buffer_load_dwordx4 v19, s[12:15], s19 offen sc1 lds
  s_add_u32 m0, s25, 4096
  s_nop 0
  buffer_load_dwordx4 v20, s[12:15], s19 offen sc1 lds
  s_add_u32 m0, s25, 5120
  s_nop 0
  buffer_load_dwordx4 v21, s[12:15], s19 offen sc1 lds
  s_add_u32 m0, s25, 6144
  s_nop 0
  buffer_load_dwordx4 v22, s[12:15], s19 offen sc1 lds
  s_add_u32 m0, s25, 7168
  s_nop 0
  buffer_load_dwordx4 v23, s[12:15], s19 offen sc1 lds
  s_cmp_gt_u32 s23, 1
  s_cselect_b32 s26, s20, 0
  s_add_u32 s19, s19, s26
  s_add_u32 s25, s25, 32768
  s_and_b32 s25, s25, 0x1ffff
  s_add_u32 m0, s25, 0
  s_nop 0
  buffer_load_dwordx4 v16, s[12:15], s19 offen sc1 lds
  s_add_u32 m0, s25, 1024
  s_nop 0
  buffer_load_dwordx4 v17, s[12:15], s19 offen sc1 lds
  s_add_u32 m0, s25, 2048
  s_nop 0
  buffer_load_dwordx4 v18, s[12:15], s19 offen sc1 lds
  s_add_u32 m0, s25, 3072
  s_nop 0
  buffer_load_dwordx4 v19, s[12:15], s19 offen sc1 lds
  s_add_u32 m0, s25, 4096
  s_nop 0
  buffer_load_dwordx4 v20, s[12:15], s19 offen sc1 lds
  s_add_u32 m0, s25, 5120
  s_nop 0
  buffer_load_dwordx4 v21, s[12:15], s19 offen sc1 lds
  s_add_u32 m0, s25, 6144
  s_nop 0
  buffer_load_dwordx4 v22, s[12:15], s19 offen sc1 lds
  s_add_u32 m0, s25, 7168
  s_nop 0
  buffer_load_dwordx4 v23, s[12:15], s19 offen sc1 lds
  s_cmp_gt_u32 s23, 2
  s_cselect_b32 s26, s20, 0
  s_add_u32 s19, s19, s26
  s_add_u32 s25, s25, 32768
  s_and_b32 s25, s25, 0x1ffff
  s_waitcnt vmcnt(0)
  s_barrier
  s_mov_b32 s27, s21
  v_mov_b32 v7, 0x40000000
  ds_read_b128 v[24:27], v8 offset:0
  ds_read_b128 v[28:31], v9 offset:0
  ds_read_b128 v[32:35], v10 offset:0
  ds_read_b128 v[36:39], v11 offset:0
  ds_read_b128 v[40:43], v12 offset:0
  ds_read_b128 v[44:47], v13 offset:0
.p2align 6
G_top_45:
  s_waitcnt lgkmcnt(5)
  v_mfma_f32_32x32x16_bf16 v[64:79], a[0:3], v[24:27], 0
  s_add_u32 m0, s25, 0
  ds_read_b128 v[48:51], v14 offset:0
  v_mfma_f32_32x32x16_bf16 v[80:95], a[4:7], v[24:27], 0
  s_waitcnt lgkmcnt(5)
  buffer_load_dwordx4 v16, s[12:15], s19 offen sc1 lds
  v_mfma_f32_32x32x16_bf16 v[64:79], a[8:11], v[28:31], v[64:79]
  ds_read_b128 v[52:55], v15 offset:0
  v_mul_f32 v96, s24, v96
  v_mul_f32 v97, s24, v97
  v_mfma_f32_32x32x16_bf16 v[80:95], a[12:15], v[28:31], v[80:95]
  s_waitcnt lgkmcnt(5)
  v_cvt_pk_bf16_f32 v128, v96, v97
  v_mul_f32 v98, s24, v98
  v_mfma_f32_32x32x16_bf16 v[64:79], a[16:19], v[32:35], v[64:79]
  s_add_u32 m0, s25, 1024
  ds_read_b128 v[24:27], v8 offset:8192
  v_mul_f32 v99, s24, v99
  v_cvt_pk_bf16_f32 v129, v98, v99
  v_mfma_f32_32x32x16_bf16 v[80:95], a[20:23], v[32:35], v[80:95]
  s_waitcnt lgkmcnt(5)
  buffer_load_dwordx4 v17, s[12:15], s19 offen sc1 lds
  v_mul_f32 v100, s24, v100
  v_mul_f32 v101, s24, v101
  v_mfma_f32_32x32x16_bf16 v[64:79], a[24:27], v[36:39], v[64:79]
  ds_read_b128 v[28:31], v9 offset:8192
  v_cvt_pk_bf16_f32 v130, v100, v101
  v_mul_f32 v102, s24, v102
  v_mfma_f32_32x32x16_bf16 v[80:95], a[28:31], v[36:39], v[80:95]
  s_waitcnt lgkmcnt(5)
  v_mul_f32 v103, s24, v103
  v_cvt_pk_bf16_f32 v131, v102, v103
  v_mfma_f32_32x32x16_bf16 v[64:79], a[32:35], v[40:43], v[64:79]
  s_add_u32 m0, s25, 2048
  ds_read_b128 v[32:35], v10 offset:8192
  v_mul_f32 v104, s24, v104
  v_mul_f32 v105, s24, v105
  v_mfma_f32_32x32x16_bf16 v[80:95], a[36:39], v[40:43], v[80:95]
  s_waitcnt lgkmcnt(5)
  buffer_load_dwordx4 v18, s[12:15], s19 offen sc1 lds
  v_cvt_pk_bf16_f32 v132, v104, v105
  v_mul_f32 v106, s24, v106
  v_mfma_f32_32x32x16_bf16 v[64:79], a[40:43], v[44:47], v[64:79]
  ds_read_b128 v[36:39], v11 offset:8192
  v_mul_f32 v107, s24, v107
  v_cvt_pk_bf16_f32 v133, v106, v107
  v_mfma_f32_32x32x16_bf16 v[80:95], a[44:47], v[44:47], v[80:95]
  s_waitcnt lgkmcnt(5)
  v_mul_f32 v108, s24, v108
  v_mul_f32 v109, s24, v109
  v_mfma_f32_32x32x16_bf16 v[64:79], a[48:51], v[48:51], v[64:79]
  s_add_u32 m0, s25, 3072
  ds_read_b128 v[40:43], v12 offset:8192
  v_cvt_pk_bf16_f32 v134, v108, v109
  v_mul_f32 v110, s24, v110
  v_mfma_f32_32x32x16_bf16 v[80:95], a[52:55], v[48:51], v[80:95]
  s_waitcnt lgkmcnt(5)
  buffer_load_dwordx4 v19, s[12:15], s19 offen sc1 lds
  v_mul_f32 v111, s24, v111
  v_cvt_pk_bf16_f32 v135, v110, v111
  v_mfma_f32_32x32x16_bf16 v[64:79], a[56:59], v[52:55], v[64:79]
  ds_read_b128 v[44:47], v13 offset:8192
  v_mul_f32 v112, s24, v112
  v_mul_f32 v113, s24, v113
  v_mfma_f32_32x32x16_bf16 v[80:95], a[60:63], v[52:55], v[80:95]
  s_waitcnt lgkmcnt(5)
  v_cvt_pk_bf16_f32 v136, v112, v113
  v_mul_f32 v114, s24, v114
  v_mfma_f32_32x32x16_bf16 v[64:79], a[64:67], v[24:27], v[64:79]
  s_add_u32 m0, s25, 4096
  ds_read_b128 v[48:51], v14 offset:8192
  v_mul_f32 v115, s24, v115
  v_cvt_pk_bf16_f32 v137, v114, v115
  v_mfma_f32_32x32x16_bf16 v[80:95], a[68:71], v[24:27], v[80:95]
  s_waitcnt lgkmcnt(5)
  buffer_load_dwordx4 v20, s[12:15], s19 offen sc1 lds
  v_mul_f32 v116, s24, v116
  v_mul_f32 v117, s24, v117
  v_mfma_f32_32x32x16_bf16 v[64:79], a[72:75], v[28:31], v[64:79]
  ds_read_b128 v[52:55], v15 offset:8192
  v_cvt_pk_bf16_f32 v138, v116, v117
  v_mul_f32 v118, s24, v118
  v_mfma_f32_32x32x16_bf16 v[80:95], a[76:79], v[28:31], v[80:95]
  s_waitcnt lgkmcnt(5)
  v_mul_f32 v119, s24, v119
  v_cvt_pk_bf16_f32 v139, v118, v119
  v_mfma_f32_32x32x16_bf16 v[64:79], a[80:83], v[32:35], v[64:79]
  s_add_u32 m0, s25, 5120
  ds_read_b128 v[24:27], v8 offset:16384
  v_mul_f32 v120, s24, v120
  v_mul_f32 v121, s24, v121
  v_mfma_f32_32x32x16_bf16 v[80:95], a[84:87], v[32:35], v[80:95]
  s_waitcnt lgkmcnt(5)
  buffer_load_dwordx4 v21, s[12:15], s19 offen sc1 lds
  v_cvt_pk_bf16_f32 v140, v120, v121
  v_mul_f32 v122, s24, v122
  v_mfma_f32_32x32x16_bf16 v[64:79], a[88:91], v[36:39], v[64:79]
  ds_read_b128 v[28:31], v9 offset:16384
  v_mul_f32 v123, s24, v123
  v_cvt_pk_bf16_f32 v141, v122, v123
  v_mfma_f32_32x32x16_bf16 v[80:95], a[92:95], v[36:39], v[80:95]
  s_waitcnt lgkmcnt(5)
  v_mul_f32 v124, s24, v124
  v_mul_f32 v125, s24, v125
  v_mfma_f32_32x32x16_bf16 v[64:79], a[96:99], v[40:43], v[64:79]
  s_add_u32 m0, s25, 6144
  ds_read_b128 v[32:35], v10 offset:16384
  v_cvt_pk_bf16_f32 v142, v124, v125
  v_mul_f32 v126, s24, v126
  v_mfma_f32_32x32x16_bf16 v[80:95], a[100:103], v[40:43], v[80:95]
  s_waitcnt lgkmcnt(5)
  buffer_load_dwordx4 v22, s[12:15], s19 offen sc1 lds
  v_mul_f32 v127, s24, v127
  v_cvt_pk_bf16_f32 v143, v126, v127
  v_mfma_f32_32x32x16_bf16 v[64:79], a[104:107], v[44:47], v[64:79]
  ds_read_b128 v[36:39], v11 offset:16384
  v_mfma_f32_32x32x16_bf16 v[80:95], a[108:111], v[44:47], v[80:95]
  s_waitcnt lgkmcnt(5)
  v_mfma_f32_32x32x16_bf16 v[64:79], a[112:115], v[48:51], v[64:79]
  s_add_u32 m0, s25, 7168
  ds_read_b128 v[40:43], v12 offset:16384
  v_mfma_f32_32x32x16_bf16 v[80:95], a[116:119], v[48:51], v[80:95]
  s_waitcnt lgkmcnt(5)
  buffer_load_dwordx4 v23, s[12:15], s19 offen sc1 lds
  v_mfma_f32_32x32x16_bf16 v[64:79], a[120:123], v[52:55], v[64:79]
  s_cmp_gt_u32 s23, 3
  ds_read_b128 v[44:47], v13 offset:16384
  v_mfma_f32_32x32x16_bf16 v[80:95], a[124:127], v[52:55], v[80:95]
  s_waitcnt lgkmcnt(5)
  s_cselect_b32 s26, s20, 0
  v_mfma_f32_32x32x16_bf16 v[64:79], a[128:131], v[24:27], v[64:79]
  s_add_u32 s19, s19, s26
  ds_read_b128 v[48:51], v14 offset:16384
  v_mfma_f32_32x32x16_bf16 v[80:95], a[132:135], v[24:27], v[80:95]
  s_waitcnt lgkmcnt(5)
  s_add_u32 s25, s25, 32768
  v_mfma_f32_32x32x16_bf16 v[64:79], a[136:139], v[28:31], v[64:79]
  s_and_b32 s25, s25, 0x1ffff
  ds_read_b128 v[52:55], v15 offset:16384
  v_mfma_f32_32x32x16_bf16 v[80:95], a[140:143], v[28:31], v[80:95]
  s_waitcnt lgkmcnt(5)
  buffer_store_dwordx4 v[128:131], v7, s[4:7], s21 offen offset:0 sc1
  v_mfma_f32_32x32x16_bf16 v[64:79], a[144:147], v[32:35], v[64:79]
  ds_read_b128 v[24:27], v8 offset:24576
  v_mfma_f32_32x32x16_bf16 v[80:95], a[148:151], v[32:35], v[80:95]
  s_waitcnt lgkmcnt(5)
  v_mfma_f32_32x32x16_bf16 v[64:79], a[152:155], v[36:39], v[64:79]
  ds_read_b128 v[28:31], v9 offset:24576
  v_mfma_f32_32x32x16_bf16 v[80:95], a[156:159], v[36:39], v[80:95]
  s_waitcnt lgkmcnt(5)
  buffer_store_dwordx4 v[132:135], v7, s[4:7], s21 offen offset:1024 sc1
  v_mfma_f32_32x32x16_bf16 v[64:79], a[160:163], v[40:43], v[64:79]
  ds_read_b128 v[32:35], v10 offset:24576
  v_mfma_f32_32x32x16_bf16 v[80:95], a[164:167], v[40:43], v[80:95]
  s_waitcnt lgkmcnt(5)
  v_mfma_f32_32x32x16_bf16 v[64:79], a[168:171], v[44:47], v[64:79]
  ds_read_b128 v[36:39], v11 offset:24576
  v_mfma_f32_32x32x16_bf16 v[80:95], a[172:175], v[44:47], v[80:95]
  s_waitcnt lgkmcnt(5)
  buffer_store_dwordx4 v[136:139], v7, s[4:7], s21 offen offset:2048 sc1
  v_mfma_f32_32x32x16_bf16 v[64:79], a[176:179], v[48:51], v[64:79]
  ds_read_b128 v[40:43], v12 offset:24576
  v_mfma_f32_32x32x16_bf16 v[80:95], a[180:183], v[48:51], v[80:95]
  s_waitcnt lgkmcnt(5)
  v_mfma_f32_32x32x16_bf16 v[64:79], a[184:187], v[52:55], v[64:79]
  ds_read_b128 v[44:47], v13 offset:24576
  v_mfma_f32_32x32x16_bf16 v[80:95], a[188:191], v[52:55], v[80:95]
  s_waitcnt lgkmcnt(5)
  buffer_store_dwordx4 v[140:143], v7, s[4:7], s21 offen offset:3072 sc1
  v_mfma_f32_32x32x16_bf16 v[64:79], a[192:195], v[24:27], v[64:79]
  s_mov_b32 s21, s27
  ds_read_b128 v[48:51], v14 offset:24576
  v_mov_b32 v7, v2
  v_mfma_f32_32x32x16_bf16 v[80:95], a[196:199], v[24:27], v[80:95]
  s_waitcnt lgkmcnt(5)
  v_mfma_f32_32x32x16_bf16 v[64:79], a[200:203], v[28:31], v[64:79]
  s_add_u32 s27, s27, s22
  ds_read_b128 v[52:55], v15 offset:24576
  v_mfma_f32_32x32x16_bf16 v[80:95], a[204:207], v[28:31], v[80:95]
  s_waitcnt lgkmcnt(5)
  s_waitcnt vmcnt(16)
  s_barrier
  v_mfma_f32_32x32x16_bf16 v[64:79], a[208:211], v[32:35], v[64:79]
  ds_read_b128 v[24:27], v8 offset:32768
  v_mfma_f32_32x32x16_bf16 v[80:95], a[212:215], v[32:35], v[80:95]
  s_waitcnt lgkmcnt(5)
  v_mfma_f32_32x32x16_bf16 v[64:79], a[216:219], v[36:39], v[64:79]
  ds_read_b128 v[28:31], v9 offset:32768
  v_mfma_f32_32x32x16_bf16 v[80:95], a[220:223], v[36:39], v[80:95]
  s_waitcnt lgkmcnt(5)
  v_mfma_f32_32x32x16_bf16 v[64:79], a[224:227], v[40:43], v[64:79]
  ds_read_b128 v[32:35], v10 offset:32768
  v_mfma_f32_32x32x16_bf16 v[80:95], a[228:231], v[40:43], v[80:95]
  s_waitcnt lgkmcnt(5)
  v_mfma_f32_32x32x16_bf16 v[64:79], a[232:235], v[44:47], v[64:79]
  ds_read_b128 v[36:39], v11 offset:32768
  v_mfma_f32_32x32x16_bf16 v[80:95], a[236:239], v[44:47], v[80:95]
  s_waitcnt lgkmcnt(5)
  v_mfma_f32_32x32x16_bf16 v[64:79], a[240:243], v[48:51], v[64:79]
  s_sub_u32 s23, s23, 1
  ds_read_b128 v[40:43], v12 offset:32768
  v_mfma_f32_32x32x16_bf16 v[80:95], a[244:247], v[48:51], v[80:95]
  s_waitcnt lgkmcnt(5)
  v_mfma_f32_32x32x16_bf16 v[64:79], a[248:251], v[52:55], v[64:79]
  s_cmp_eq_u32 s23, 0
  ds_read_b128 v[44:47], v13 offset:32768
  v_mfma_f32_32x32x16_bf16 v[80:95], a[252:255], v[52:55], v[80:95]
  s_cbranch_scc1 G_done0_46
  s_waitcnt lgkmcnt(5)
  v_mfma_f32_32x32x16_bf16 v[96:111], a[0:3], v[24:27], 0
  s_add_u32 m0, s25, 0
  ds_read_b128 v[48:51], v14 offset:32768
  v_mfma_f32_32x32x16_bf16 v[112:127], a[4:7], v[24:27], 0
  s_waitcnt lgkmcnt(5)
  buffer_load_dwordx4 v16, s[12:15], s19 offen sc1 lds
  v_mfma_f32_32x32x16_bf16 v[96:111], a[8:11], v[28:31], v[96:111]
  ds_read_b128 v[52:55], v15 offset:32768
  v_mul_f32 v64, s24, v64
  v_mul_f32 v65, s24, v65
  v_mfma_f32_32x32x16_bf16 v[112:127], a[12:15], v[28:31], v[112:127]
  s_waitcnt lgkmcnt(5)
  v_cvt_pk_bf16_f32 v128, v64, v65
  v_mul_f32 v66, s24, v66
  v_mfma_f32_32x32x16_bf16 v[96:111], a[16:19], v[32:35], v[96:111]
  s_add_u32 m0, s25, 1024
  ds_read_b128 v[24:27], v8 offset:40960
  v_mul_f32 v67, s24, v67
  v_cvt_pk_bf16_f32 v129, v66, v67
  v_mfma_f32_32x32x16_bf16 v[112:127], a[20:23], v[32:35], v[112:127]
  s_waitcnt lgkmcnt(5)
  buffer_load_dwordx4 v17, s[12:15], s19 offen sc1 lds
  v_mul_f32 v68, s24, v68
  v_mul_f32 v69, s24, v69
  v_mfma_f32_32x32x16_bf16 v[96:111], a[24:27], v[36:39], v[96:111]
  ds_read_b128 v[28:31], v9 offset:40960
  v_cvt_pk_bf16_f32 v130, v68, v69
  v_mul_f32 v70, s24, v70
  v_mfma_f32_32x32x16_bf16 v[112:127], a[28:31], v[36:39], v[112:127]
  s_waitcnt lgkmcnt(5)
  v_mul_f32 v71, s24, v71
  v_cvt_pk_bf16_f32 v131, v70, v71
  v_mfma_f32_32x32x16_bf16 v[96:111], a[32:35], v[40:43], v[96:111]
  s_add_u32 m0, s25, 2048
  ds_read_b128 v[32:35], v10 offset:40960
  v_mul_f32 v72, s24, v72
  v_mul_f32 v73, s24, v73
  v_mfma_f32_32x32x16_bf16 v[112:127], a[36:39], v[40:43], v[112:127]
  s_waitcnt lgkmcnt(5)
  buffer_load_dwordx4 v18, s[12:15], s19 offen sc1 lds
  v_cvt_pk_bf16_f32 v132, v72, v73
  v_mul_f32 v74, s24, v74
  v_mfma_f32_32x32x16_bf16 v[96:111], a[40:43], v[44:47], v[96:111]
  ds_read_b128 v[36:39], v11 offset:40960
  v_mul_f32 v75, s24, v75
  v_cvt_pk_bf16_f32 v133, v74, v75
  v_mfma_f32_32x32x16_bf16 v[112:127], a[44:47], v[44:47], v[112:127]
  s_waitcnt lgkmcnt(5)
  v_mul_f32 v76, s24, v76
  v_mul_f32 v77, s24, v77
  v_mfma_f32_32x32x16_bf16 v[96:111], a[48:51], v[48:51], v[96:111]
  s_add_u32 m0, s25, 3072
  ds_read_b128 v[40:43], v12 offset:40960
  v_cvt_pk_bf16_f32 v134, v76, v77
  v_mul_f32 v78, s24, v78
  v_mfma_f32_32x32x16_bf16 v[112:127], a[52:55], v[48:51], v[112:127]
  s_waitcnt lgkmcnt(5)
  buffer_load_dwordx4 v19, s[12:15], s19 offen sc1 lds
  v_mul_f32 v79, s24, v79
  v_cvt_pk_bf16_f32 v135, v78, v79
  v_mfma_f32_32x32x16_bf16 v[96:111], a[56:59], v[52:55], v[96:111]
  ds_read_b128 v[44:47], v13 offset:40960
  v_mul_f32 v80, s24, v80
  v_mul_f32 v81, s24, v81
  v_mfma_f32_32x32x16_bf16 v[112:127], a[60:63], v[52:55], v[112:127]
  s_waitcnt lgkmcnt(5)
  v_cvt_pk_bf16_f32 v136, v80, v81
  v_mul_f32 v82, s24, v82
  v_mfma_f32_32x32x16_bf16 v[96:111], a[64:67], v[24:27], v[96:111]
  s_add_u32 m0, s25, 4096
  ds_read_b128 v[48:51], v14 offset:40960
  v_mul_f32 v83, s24, v83
  v_cvt_pk_bf16_f32 v137, v82, v83
  v_mfma_f32_32x32x16_bf16 v[112:127], a[68:71], v[24:27], v[112:127]
  s_waitcnt lgkmcnt(5)
  buffer_load_dwordx4 v20, s[12:15], s19 offen sc1 lds
  v_mul_f32 v84, s24, v84
  v_mul_f32 v85, s24, v85
  v_mfma_f32_32x32x16_bf16 v[96:111], a[72:75], v[28:31], v[96:111]
  ds_read_b128 v[52:55], v15 offset:40960
  v_cvt_pk_bf16_f32 v138, v84, v85
  v_mul_f32 v86, s24, v86
  v_mfma_f32_32x32x16_bf16 v[112:127], a[76:79], v[28:31], v[112:127]
  s_waitcnt lgkmcnt(5)
  v_mul_f32 v87, s24, v87
  v_cvt_pk_bf16_f32 v139, v86, v87
  v_mfma_f32_32x32x16_bf16 v[96:111], a[80:83], v[32:35], v[96:111]
  s_add_u32 m0, s25, 5120
  ds_read_b128 v[24:27], v8 offset:49152
  v_mul_f32 v88, s24, v88
  v_mul_f32 v89, s24, v89
  v_mfma_f32_32x32x16_bf16 v[112:127], a[84:87], v[32:35], v[112:127]
  s_waitcnt lgkmcnt(5)
  buffer_load_dwordx4 v21, s[12:15], s19 offen sc1 lds
  v_cvt_pk_bf16_f32 v140, v88, v89
  v_mul_f32 v90, s24, v90
  v_mfma_f32_32x32x16_bf16 v[96:111], a[88:91], v[36:39], v[96:111]
  ds_read_b128 v[28:31], v9 offset:49152
  v_mul_f32 v91, s24, v91
  v_cvt_pk_bf16_f32 v141, v90, v91
  v_mfma_f32_32x32x16_bf16 v[112:127], a[92:95], v[36:39], v[112:127]
  s_waitcnt lgkmcnt(5)
  v_mul_f32 v92, s24, v92
  v_mul_f32 v93, s24, v93
  v_mfma_f32_32x32x16_bf16 v[96:111], a[96:99], v[40:43], v[96:111]
  s_add_u32 m0, s25, 6144
  ds_read_b128 v[32:35], v10 offset:49152
  v_cvt_pk_bf16_f32 v142, v92, v93
  v_mul_f32 v94, s24, v94
  v_mfma_f32_32x32x16_bf16 v[112:127], a[100:103], v[40:43], v[112:127]
  s_waitcnt lgkmcnt(5)
  buffer_load_dwordx4 v22, s[12:15], s19 offen sc1 lds
  v_mul_f32 v95, s24, v95
  v_cvt_pk_bf16_f32 v143, v94, v95
  v_mfma_f32_32x32x16_bf16 v[96:111], a[104:107], v[44:47], v[96:111]
  ds_read_b128 v[36:39], v11 offset:49152
  v_mfma_f32_32x32x16_bf16 v[112:127], a[108:111], v[44:47], v[112:127]
  s_waitcnt lgkmcnt(5)
  v_mfma_f32_32x32x16_bf16 v[96:111], a[112:115], v[48:51], v[96:111]
  s_add_u32 m0, s25, 7168
  ds_read_b128 v[40:43], v12 offset:49152
  v_mfma_f32_32x32x16_bf16 v[112:127], a[116:119], v[48:51], v[112:127]
  s_waitcnt lgkmcnt(5)
  buffer_load_dwordx4 v23, s[12:15], s19 offen sc1 lds
  v_mfma_f32_32x32x16_bf16 v[96:111], a[120:123], v[52:55], v[96:111]
  s_cmp_gt_u32 s23, 3
  ds_read_b128 v[44:47], v13 offset:49152
  v_mfma_f32_32x32x16_bf16 v[112:127], a[124:127], v[52:55], v[112:127]
  s_waitcnt lgkmcnt(5)
  s_cselect_b32 s26, s20, 0
  v_mfma_f32_32x32x16_bf16 v[96:111], a[128:131], v[24:27], v[96:111]
  s_add_u32 s19, s19, s26
  ds_read_b128 v[48:51], v14 offset:49152
  v_mfma_f32_32x32x16_bf16 v[112:127], a[132:135], v[24:27], v[112:127]
  s_waitcnt lgkmcnt(5)
  s_add_u32 s25, s25, 32768
  v_mfma_f32_32x32x16_bf16 v[96:111], a[136:139], v[28:31], v[96:111]
  s_and_b32 s25, s25, 0x1ffff
  ds_read_b128 v[52:55], v15 offset:49152
  v_mfma_f32_32x32x16_bf16 v[112:127], a[140:143], v[28:31], v[112:127]
  s_waitcnt lgkmcnt(5)
  buffer_store_dwordx4 v[128:131], v7, s[4:7], s21 offen offset:0 sc1
  v_mfma_f32_32x32x16_bf16 v[96:111], a[144:147], v[32:35], v[96:111]
  ds_read_b128 v[24:27], v8 offset:57344
  v_mfma_f32_32x32x16_bf16 v[112:127], a[148:151], v[32:35], v[112:127]
  s_waitcnt lgkmcnt(5)
  v_xor_b32 v8, 0x10000, v8
  v_mfma_f32_32x32x16_bf16 v[96:111], a[152:155], v[36:39], v[96:111]
  ds_read_b128 v[28:31], v9 offset:57344
  v_mfma_f32_32x32x16_bf16 v[112:127], a[156:159], v[36:39], v[112:127]
  s_waitcnt lgkmcnt(5)
  buffer_store_dwordx4 v[132:135], v7, s[4:7], s21 offen offset:1024 sc1
  v_xor_b32 v9, 0x10000, v9
  v_mfma_f32_32x32x16_bf16 v[96:111], a[160:163], v[40:43], v[96:111]
  ds_read_b128 v[32:35], v10 offset:57344
  v_mfma_f32_32x32x16_bf16 v[112:127], a[164:167], v[40:43], v[112:127]
  s_waitcnt lgkmcnt(5)
  v_xor_b32 v10, 0x10000, v10
  v_mfma_f32_32x32x16_bf16 v[96:111], a[168:171], v[44:47], v[96:111]
  ds_read_b128 v[36:39], v11 offset:57344
  v_mfma_f32_32x32x16_bf16 v[112:127], a[172:175], v[44:47], v[112:127]
  s_waitcnt lgkmcnt(5)
  buffer_store_dwordx4 v[136:139], v7, s[4:7], s21 offen offset:2048 sc1
  v_xor_b32 v11, 0x10000, v11
  v_mfma_f32_32x32x16_bf16 v[96:111], a[176:179], v[48:51], v[96:111]
  ds_read_b128 v[40:43], v12 offset:57344
  v_mfma_f32_32x32x16_bf16 v[112:127], a[180:183], v[48:51], v[112:127]
  s_waitcnt lgkmcnt(5)
  v_xor_b32 v12, 0x10000, v12
  v_mfma_f32_32x32x16_bf16 v[96:111], a[184:187], v[52:55], v[96:111]
  ds_read_b128 v[44:47], v13 offset:57344
  v_mfma_f32_32x32x16_bf16 v[112:127], a[188:191], v[52:55], v[112:127]
  s_waitcnt lgkmcnt(5)
  buffer_store_dwordx4 v[140:143], v7, s[4:7], s21 offen offset:3072 sc1
  v_xor_b32 v13, 0x10000, v13
  v_mfma_f32_32x32x16_bf16 v[96:111], a[192:195], v[24:27], v[96:111]
  s_mov_b32 s21, s27
  ds_read_b128 v[48:51], v14 offset:57344
  v_mov_b32 v7, v2
  v_mfma_f32_32x32x16_bf16 v[112:127], a[196:199], v[24:27], v[112:127]
  s_waitcnt lgkmcnt(5)
  v_xor_b32 v14, 0x10000, v14
  v_mfma_f32_32x32x16_bf16 v[96:111], a[200:203], v[28:31], v[96:111]
  s_add_u32 s27, s27, s22
  ds_read_b128 v[52:55], v15 offset:57344
  v_mfma_f32_32x32x16_bf16 v[112:127], a[204:207], v[28:31], v[112:127]
  s_waitcnt lgkmcnt(5)
  s_waitcnt vmcnt(16)
  s_barrier
  v_xor_b32 v15, 0x10000, v15
  v_mfma_f32_32x32x16_bf16 v[96:111], a[208:211], v[32:35], v[96:111]
  ds_read_b128 v[24:27], v8 offset:0
  v_mfma_f32_32x32x16_bf16 v[112:127], a[212:215], v[32:35], v[112:127]
  s_waitcnt lgkmcnt(5)
  v_mfma_f32_32x32x16_bf16 v[96:111], a[216:219], v[36:39], v[96:111]
  ds_read_b128 v[28:31], v9 offset:0
  v_mfma_f32_32x32x16_bf16 v[112:127], a[220:223], v[36:39], v[112:127]
  s_waitcnt lgkmcnt(5)
  v_mfma_f32_32x32x16_bf16 v[96:111], a[224:227], v[40:43], v[96:111]
  ds_read_b128 v[32:35], v10 offset:0
  v_mfma_f32_32x32x16_bf16 v[112:127], a[228:231], v[40:43], v[112:127]
  s_waitcnt lgkmcnt(5)
  v_mfma_f32_32x32x16_bf16 v[96:111], a[232:235], v[44:47], v[96:111]
  ds_read_b128 v[36:39], v11 offset:0
  v_mfma_f32_32x32x16_bf16 v[112:127], a[236:239], v[44:47], v[112:127]
  s_waitcnt lgkmcnt(5)
  v_mfma_f32_32x32x16_bf16 v[96:111], a[240:243], v[48:51], v[96:111]
  s_sub_u32 s23, s23, 1
  ds_read_b128 v[40:43], v12 offset:0
  v_mfma_f32_32x32x16_bf16 v[112:127], a[244:247], v[48:51], v[112:127]
  s_waitcnt lgkmcnt(5)
  v_mfma_f32_32x32x16_bf16 v[96:111], a[248:251], v[52:55], v[96:111]
  s_cmp_eq_u32 s23, 0
  ds_read_b128 v[44:47], v13 offset:0
  v_mfma_f32_32x32x16_bf16 v[112:127], a[252:255], v[52:55], v[112:127]
  s_cbranch_scc1 G_done1_47
  s_branch G_top_45
G_done0_46:
  s_nop 7
  s_nop 3
  v_mul_f32 v64, s24, v64
  v_mul_f32 v65, s24, v65
  v_cvt_pk_bf16_f32 v128, v64, v65
  v_mul_f32 v66, s24, v66
  v_mul_f32 v67, s24, v67
  v_cvt_pk_bf16_f32 v129, v66, v67
  v_mul_f32 v68, s24, v68
  v_mul_f32 v69, s24, v69
  v_cvt_pk_bf16_f32 v130, v68, v69
  v_mul_f32 v70, s24, v70
  v_mul_f32 v71, s24, v71
  v_cvt_pk_bf16_f32 v131, v70, v71
  buffer_store_dwordx4 v[128:131], v7, s[4:7], s21 offen offset:0 sc1
  v_mul_f32 v72, s24, v72
  v_mul_f32 v73, s24, v73
  v_cvt_pk_bf16_f32 v132, v72, v73
  v_mul_f32 v74, s24, v74
  v_mul_f32 v75, s24, v75
  v_cvt_pk_bf16_f32 v133, v74, v75
  v_mul_f32 v76, s24, v76
  v_mul_f32 v77, s24, v77
  v_cvt_pk_bf16_f32 v134, v76, v77
  v_mul_f32 v78, s24, v78
  v_mul_f32 v79, s24, v79
  v_cvt_pk_bf16_f32 v135, v78, v79
  buffer_store_dwordx4 v[132:135], v7, s[4:7], s21 offen offset:1024 sc1
  v_mul_f32 v80, s24, v80
  v_mul_f32 v81, s24, v81
  v_cvt_pk_bf16_f32 v136, v80, v81
  v_mul_f32 v82, s24, v82
  v_mul_f32 v83, s24, v83
  v_cvt_pk_bf16_f32 v137, v82, v83
  v_mul_f32 v84, s24, v84
  v_mul_f32 v85, s24, v85
  v_cvt_pk_bf16_f32 v138, v84, v85
  v_mul_f32 v86, s24, v86
  v_mul_f32 v87, s24, v87
  v_cvt_pk_bf16_f32 v139, v86, v87
  buffer_store_dwordx4 v[136:139], v7, s[4:7], s21 offen offset:2048 sc1
  v_mul_f32 v88, s24, v88
  v_mul_f32 v89, s24, v89
  v_cvt_pk_bf16_f32 v140, v88, v89
  v_mul_f32 v90, s24, v90
  v_mul_f32 v91, s24, v91
  v_cvt_pk_bf16_f32 v141, v90, v91
  v_mul_f32 v92, s24, v92
  v_mul_f32 v93, s24, v93
  v_cvt_pk_bf16_f32 v142, v92, v93
  v_mul_f32 v94, s24, v94
  v_mul_f32 v95, s24, v95
  v_cvt_pk_bf16_f32 v143, v94, v95
  buffer_store_dwordx4 v[140:143], v7, s[4:7], s21 offen offset:3072 sc1
  s_branch G_fin_48
G_done1_47:
  s_nop 7
  s_nop 3
  v_mul_f32 v96, s24, v96
  v_mul_f32 v97, s24, v97
  v_cvt_pk_bf16_f32 v128, v96, v97
  v_mul_f32 v98, s24, v98
  v_mul_f32 v99, s24, v99
  v_cvt_pk_bf16_f32 v129, v98, v99
  v_mul_f32 v100, s24, v100
  v_mul_f32 v101, s24, v101
  v_cvt_pk_bf16_f32 v130, v100, v101
  v_mul_f32 v102, s24, v102
  v_mul_f32 v103, s24, v103
  v_cvt_pk_bf16_f32 v131, v102, v103
  buffer_store_dwordx4 v[128:131], v7, s[4:7], s21 offen offset:0 sc1
  v_mul_f32 v104, s24, v104
  v_mul_f32 v105, s24, v105
  v_cvt_pk_bf16_f32 v132, v104, v105
  v_mul_f32 v106, s24, v106
  v_mul_f32 v107, s24, v107
  v_cvt_pk_bf16_f32 v133, v106, v107
  v_mul_f32 v108, s24, v108
  v_mul_f32 v109, s24, v109
  v_cvt_pk_bf16_f32 v134, v108, v109
  v_mul_f32 v110, s24, v110
  v_mul_f32 v111, s24, v111
  v_cvt_pk_bf16_f32 v135, v110, v111
  buffer_store_dwordx4 v[132:135], v7, s[4:7], s21 offen offset:1024 sc1
  v_mul_f32 v112, s24, v112
  v_mul_f32 v113, s24, v113
  v_cvt_pk_bf16_f32 v136, v112, v113
  v_mul_f32 v114, s24, v114
  v_mul_f32 v115, s24, v115
  v_cvt_pk_bf16_f32 v137, v114, v115
  v_mul_f32 v116, s24, v116
  v_mul_f32 v117, s24, v117
  v_cvt_pk_bf16_f32 v138, v116, v117
  v_mul_f32 v118, s24, v118
  v_mul_f32 v119, s24, v119
  v_cvt_pk_bf16_f32 v139, v118, v119
  buffer_store_dwordx4 v[136:139], v7, s[4:7], s21 offen offset:2048 sc1
  v_mul_f32 v120, s24, v120
  v_mul_f32 v121, s24, v121
  v_cvt_pk_bf16_f32 v140, v120, v121
  v_mul_f32 v122, s24, v122
  v_mul_f32 v123, s24, v123
  v_cvt_pk_bf16_f32 v141, v122, v123
  v_mul_f32 v124, s24, v124
  v_mul_f32 v125, s24, v125
  v_cvt_pk_bf16_f32 v142, v124, v125
  v_mul_f32 v126, s24, v126
  v_mul_f32 v127, s24, v127
  v_cvt_pk_bf16_f32 v143, v126, v127
  buffer_store_dwordx4 v[140:143], v7, s[4:7], s21 offen offset:3072 sc1
G_fin_48:
  s_waitcnt vmcnt(0) lgkmcnt(0)
  s_barrier
  s_waitcnt vmcnt(0)
  s_barrier
  s_mov_b32 s30, 768
  v_mov_b32 v144, s30
  v_min_u32 v145, 1, v0
  v_lshlrev_b32 v145, 30, v145
  buffer_store_dword v144, v145, s[4:7], s31 offen sc1
  s_mul_i32 s50, s64, 6
  s_add_u32 s50, s50, s65
  s_mul_i32 s76, s50, 21846
  s_lshr_b32 s76, s76, 16
  s_mul_i32 s77, s76, 3
  s_add_u32 s51, s50, 64
  s_cmp_eq_u32 s77, s50
  s_cselect_b32 s50, s76, s51
M_fin:
  s_lshr_b32 s48, s50, 2
  s_and_b32 s49, s50, 3
  s_load_dwordx2 s[8:9], s[0:1], 0
  s_load_dwordx2 s[12:13], s[0:1], 104
  s_load_dwordx2 s[32:33], s[0:1], 112
  v_and_b32 v4, 31, v1
  v_lshrrev_b32 v5, 5, v1
  v_lshlrev_b32 v5, 4, v5
  v_lshl_add_u32 v6, v4, 10, v5
  s_lshl_b32 s26, s16, 8
  s_lshl_b32 s27, s48, 15
  s_add_u32 s27, s27, s26
  s_waitcnt lgkmcnt(0)
  s_and_b32 s9, s9, 0xffff
  s_mov_b32 s10, 2097152
  s_mov_b32 s11, 0x20000
  s_and_b32 s13, s13, 0xffff
  s_mov_b32 s14, 1024
  s_mov_b32 s15, 0x20000
  s_and_b32 s33, s33, 0xffff
  s_mov_b32 s34, 2097152
  s_mov_b32 s35, 0x20000
  buffer_load_dwordx4 v[16:19], v6, s[8:11], s27 offen offset:0
  buffer_load_dwordx4 v[48:51], v5, s[12:15], s26 offen offset:0
  buffer_load_dwordx4 v[20:23], v6, s[8:11], s27 offen offset:32
  buffer_load_dwordx4 v[52:55], v5, s[12:15], s26 offen offset:32
  buffer_load_dwordx4 v[24:27], v6, s[8:11], s27 offen offset:64
  buffer_load_dwordx4 v[56:59], v5, s[12:15], s26 offen offset:64
  buffer_load_dwordx4 v[28:31], v6, s[8:11], s27 offen offset:96
  buffer_load_dwordx4 v[60:63], v5, s[12:15], s26 offen offset:96
  buffer_load_dwordx4 v[32:35], v6, s[8:11], s27 offen offset:128
  buffer_load_dwordx4 v[64:67], v5, s[12:15], s26 offen offset:128
  buffer_load_dwordx4 v[36:39], v6, s[8:11], s27 offen offset:160
  buffer_load_dwordx4 v[68:71], v5, s[12:15], s26 offen offset:160
  buffer_load_dwordx4 v[40:43], v6, s[8:11], s27 offen offset:192
  buffer_load_dwordx4 v[72:75], v5, s[12:15], s26 offen offset:192
  buffer_load_dwordx4 v[44:47], v6, s[8:11], s27 offen offset:224
  buffer_load_dwordx4 v[76:79], v5, s[12:15], s26 offen offset:224
  s_lshl_b32 s28, s48, 2
  s_add_u32 s28, s28, s49
  s_lshl_b32 s28, s28, 2
  s_add_u32 s28, s28, s16
  s_lshl_b32 s28, s28, 11
  s_waitcnt vmcnt(14)
  v_mfma_f32_32x32x16_bf16 v[80:95], v[48:51], v[16:19], 0
  s_waitcnt vmcnt(12)
  v_mfma_f32_32x32x16_bf16 v[80:95], v[52:55], v[20:23], v[80:95]
  s_waitcnt vmcnt(10)
  v_mfma_f32_32x32x16_bf16 v[80:95], v[56:59], v[24:27], v[80:95]
  s_waitcnt vmcnt(8)
  v_mfma_f32_32x32x16_bf16 v[80:95], v[60:63], v[28:31], v[80:95]
  s_waitcnt vmcnt(6)
  v_mfma_f32_32x32x16_bf16 v[80:95], v[64:67], v[32:35], v[80:95]
  s_waitcnt vmcnt(4)
  v_mfma_f32_32x32x16_bf16 v[80:95], v[68:71], v[36:39], v[80:95]
  s_waitcnt vmcnt(2)
  v_mfma_f32_32x32x16_bf16 v[80:95], v[72:75], v[40:43], v[80:95]
  s_waitcnt vmcnt(0)
  v_mfma_f32_32x32x16_bf16 v[80:95], v[76:79], v[44:47], v[80:95]
  s_mul_i32 s76, s48, 43
  s_lshr_b32 s76, s76, 9
  s_mul_i32 s76, s76, 12
  s_sub_u32 s76, s48, s76
  s_cmp_ge_u32 s76, 6
  s_addc_u32 s76, s76, 0
  s_and_b32 s77, s49, 2
  s_mul_i32 s77, s77, 7
  s_add_u32 s76, s76, s77
  v_mov_b32 v193, 0x300
  s_lshl_b32 s76, s76, 7
  s_add_u32 s76, s76, 148897792
  v_and_b32 v192, 7, v1
  v_mul_u32_u24 v192, 3584, v192
  v_add_u32 v192, s76, v192
  s_mov_b32 s71, 0
  s_branch M_vg_50
M_vw_49:
  s_sleep 2
  s_add_u32 s71, s71, 1
  s_cmp_gt_u32 s71, 262144
  s_cbranch_scc1 M_exit
M_vg_50:
  buffer_load_dword v194, v192, s[4:7], 0 offen sc1
  s_waitcnt vmcnt(0)
  v_cmp_lt_u32 vcc, v194, v193
  s_cbranch_vccnz M_vw_49
  s_add_u32 s29, s28, 150994944
  buffer_load_dwordx4 v[96:99], v2, s[4:7], s29 offen offset:0 sc1
  buffer_load_dwordx4 v[100:103], v2, s[4:7], s29 offen offset:1024 sc1
  s_add_u32 s29, s28, 153092096
  buffer_load_dwordx4 v[104:107], v2, s[4:7], s29 offen offset:0 sc1
  buffer_load_dwordx4 v[108:111], v2, s[4:7], s29 offen offset:1024 sc1
  s_add_u32 s29, s28, 155189248
  buffer_load_dwordx4 v[112:115], v2, s[4:7], s29 offen offset:0 sc1
  buffer_load_dwordx4 v[116:119], v2, s[4:7], s29 offen offset:1024 sc1
  s_add_u32 s29, s28, 157286400
  buffer_load_dwordx4 v[120:123], v2, s[4:7], s29 offen offset:0 sc1
  buffer_load_dwordx4 v[124:127], v2, s[4:7], s29 offen offset:1024 sc1
  s_add_u32 s29, s28, 159383552
  buffer_load_dwordx4 v[128:131], v2, s[4:7], s29 offen offset:0 sc1
  buffer_load_dwordx4 v[132:135], v2, s[4:7], s29 offen offset:1024 sc1
  s_add_u32 s29, s28, 161480704
  buffer_load_dwordx4 v[136:139], v2, s[4:7], s29 offen offset:0 sc1
  buffer_load_dwordx4 v[140:143], v2, s[4:7], s29 offen offset:1024 sc1
  s_add_u32 s29, s28, 163577856
  buffer_load_dwordx4 v[144:147], v2, s[4:7], s29 offen offset:0 sc1
  buffer_load_dwordx4 v[148:151], v2, s[4:7], s29 offen offset:1024 sc1
  s_add_u32 s29, s28, 165675008
  buffer_load_dwordx4 v[152:155], v2, s[4:7], s29 offen offset:0 sc1
  buffer_load_dwordx4 v[156:159], v2, s[4:7], s29 offen offset:1024 sc1
  v_lshlrev_b32 v7, 4, v4
  s_lshl_b32 s26, s16, 2
  v_add_u32 v4, s26, v7
  s_barrier
  ds_write_b32 v4, v80
  s_waitcnt lgkmcnt(0)
  s_barrier
  ds_read_b128 v[84:87], v7
  s_waitcnt lgkmcnt(0)
  v_add_f32 v80, v84, v85
  v_add_f32 v81, v86, v87
  v_add_f32 v80, v80, v81
  v_mul_f32 v80, 0xbfb8aa3b, v80
  v_exp_f32 v80, v80
  s_nop 0
  v_add_f32 v80, 1.0, v80
  v_rcp_f32 v80, v80
  s_nop 0
  v_sub_f32 v82, 1.0, v80
  s_waitcnt vmcnt(14)
  v_lshlrev_b32 v160, 16, v96
  v_and_b32 v161, 0xffff0000, v96
  v_lshlrev_b32 v162, 16, v97
  v_and_b32 v163, 0xffff0000, v97
  v_lshlrev_b32 v164, 16, v98
  v_and_b32 v165, 0xffff0000, v98
  v_lshlrev_b32 v166, 16, v99
  v_and_b32 v167, 0xffff0000, v99
  v_lshlrev_b32 v168, 16, v100
  v_and_b32 v169, 0xffff0000, v100
  v_lshlrev_b32 v170, 16, v101
  v_and_b32 v171, 0xffff0000, v101
  v_lshlrev_b32 v172, 16, v102
  v_and_b32 v173, 0xffff0000, v102
  v_lshlrev_b32 v174, 16, v103
  v_and_b32 v175, 0xffff0000, v103
  s_waitcnt vmcnt(12)
  v_lshlrev_b32 v8, 16, v104
  v_and_b32 v9, 0xffff0000, v104
  v_pk_add_f32 v[160:161], v[160:161], v[8:9]
  v_lshlrev_b32 v10, 16, v105
  v_and_b32 v11, 0xffff0000, v105
  v_pk_add_f32 v[162:163], v[162:163], v[10:11]
  v_lshlrev_b32 v12, 16, v106
  v_and_b32 v13, 0xffff0000, v106
  v_pk_add_f32 v[164:165], v[164:165], v[12:13]
  v_lshlrev_b32 v14, 16, v107
  v_and_b32 v15, 0xffff0000, v107
  v_pk_add_f32 v[166:167], v[166:167], v[14:15]
  v_lshlrev_b32 v8, 16, v108
  v_and_b32 v9, 0xffff0000, v108
  v_pk_add_f32 v[168:169], v[168:169], v[8:9]
  v_lshlrev_b32 v10, 16, v109
  v_and_b32 v11, 0xffff0000, v109
  v_pk_add_f32 v[170:171], v[170:171], v[10:11]
  v_lshlrev_b32 v12, 16, v110
  v_and_b32 v13, 0xffff0000, v110
  v_pk_add_f32 v[172:173], v[172:173], v[12:13]
  v_lshlrev_b32 v14, 16, v111
  v_and_b32 v15, 0xffff0000, v111
  v_pk_add_f32 v[174:175], v[174:175], v[14:15]
  s_waitcnt vmcnt(10)
  v_lshlrev_b32 v8, 16, v112
  v_and_b32 v9, 0xffff0000, v112
  v_pk_add_f32 v[160:161], v[160:161], v[8:9]
  v_lshlrev_b32 v10, 16, v113
  v_and_b32 v11, 0xffff0000, v113
  v_pk_add_f32 v[162:163], v[162:163], v[10:11]
  v_lshlrev_b32 v12, 16, v114
  v_and_b32 v13, 0xffff0000, v114
  v_pk_add_f32 v[164:165], v[164:165], v[12:13]
  v_lshlrev_b32 v14, 16, v115
  v_and_b32 v15, 0xffff0000, v115
  v_pk_add_f32 v[166:167], v[166:167], v[14:15]
  v_lshlrev_b32 v8, 16, v116
  v_and_b32 v9, 0xffff0000, v116
  v_pk_add_f32 v[168:169], v[168:169], v[8:9]
  v_lshlrev_b32 v10, 16, v117
  v_and_b32 v11, 0xffff0000, v117
  v_pk_add_f32 v[170:171], v[170:171], v[10:11]
  v_lshlrev_b32 v12, 16, v118
  v_and_b32 v13, 0xffff0000, v118
  v_pk_add_f32 v[172:173], v[172:173], v[12:13]
  v_lshlrev_b32 v14, 16, v119
  v_and_b32 v15, 0xffff0000, v119
  v_pk_add_f32 v[174:175], v[174:175], v[14:15]
  s_waitcnt vmcnt(8)
  v_lshlrev_b32 v8, 16, v120
  v_and_b32 v9, 0xffff0000, v120
  v_pk_add_f32 v[160:161], v[160:161], v[8:9]
  v_lshlrev_b32 v10, 16, v121
  v_and_b32 v11, 0xffff0000, v121
  v_pk_add_f32 v[162:163], v[162:163], v[10:11]
  v_lshlrev_b32 v12, 16, v122
  v_and_b32 v13, 0xffff0000, v122
  v_pk_add_f32 v[164:165], v[164:165], v[12:13]
  v_lshlrev_b32 v14, 16, v123
  v_and_b32 v15, 0xffff0000, v123
  v_pk_add_f32 v[166:167], v[166:167], v[14:15]
  v_lshlrev_b32 v8, 16, v124
  v_and_b32 v9, 0xffff0000, v124
  v_pk_add_f32 v[168:169], v[168:169], v[8:9]
  v_lshlrev_b32 v10, 16, v125
  v_and_b32 v11, 0xffff0000, v125
  v_pk_add_f32 v[170:171], v[170:171], v[10:11]
  v_lshlrev_b32 v12, 16, v126
  v_and_b32 v13, 0xffff0000, v126
  v_pk_add_f32 v[172:173], v[172:173], v[12:13]
  v_lshlrev_b32 v14, 16, v127
  v_and_b32 v15, 0xffff0000, v127
  v_pk_add_f32 v[174:175], v[174:175], v[14:15]
  s_waitcnt vmcnt(6)
  v_lshlrev_b32 v8, 16, v128
  v_and_b32 v9, 0xffff0000, v128
  v_pk_add_f32 v[160:161], v[160:161], v[8:9]
  v_lshlrev_b32 v10, 16, v129
  v_and_b32 v11, 0xffff0000, v129
  v_pk_add_f32 v[162:163], v[162:163], v[10:11]
  v_lshlrev_b32 v12, 16, v130
  v_and_b32 v13, 0xffff0000, v130
  v_pk_add_f32 v[164:165], v[164:165], v[12:13]
  v_lshlrev_b32 v14, 16, v131
  v_and_b32 v15, 0xffff0000, v131
  v_pk_add_f32 v[166:167], v[166:167], v[14:15]
  v_lshlrev_b32 v8, 16, v132
  v_and_b32 v9, 0xffff0000, v132
  v_pk_add_f32 v[168:169], v[168:169], v[8:9]
  v_lshlrev_b32 v10, 16, v133
  v_and_b32 v11, 0xffff0000, v133
  v_pk_add_f32 v[170:171], v[170:171], v[10:11]
  v_lshlrev_b32 v12, 16, v134
  v_and_b32 v13, 0xffff0000, v134
  v_pk_add_f32 v[172:173], v[172:173], v[12:13]
  v_lshlrev_b32 v14, 16, v135
  v_and_b32 v15, 0xffff0000, v135
  v_pk_add_f32 v[174:175], v[174:175], v[14:15]
  s_waitcnt vmcnt(4)
  v_lshlrev_b32 v8, 16, v136
  v_and_b32 v9, 0xffff0000, v136
  v_pk_add_f32 v[160:161], v[160:161], v[8:9]
  v_lshlrev_b32 v10, 16, v137
  v_and_b32 v11, 0xffff0000, v137
  v_pk_add_f32 v[162:163], v[162:163], v[10:11]
  v_lshlrev_b32 v12, 16, v138
  v_and_b32 v13, 0xffff0000, v138
  v_pk_add_f32 v[164:165], v[164:165], v[12:13]
  v_lshlrev_b32 v14, 16, v139
  v_and_b32 v15, 0xffff0000, v139
  v_pk_add_f32 v[166:167], v[166:167], v[14:15]
  v_lshlrev_b32 v8, 16, v140
  v_and_b32 v9, 0xffff0000, v140
  v_pk_add_f32 v[168:169], v[168:169], v[8:9]
  v_lshlrev_b32 v10, 16, v141
  v_and_b32 v11, 0xffff0000, v141
  v_pk_add_f32 v[170:171], v[170:171], v[10:11]
  v_lshlrev_b32 v12, 16, v142
  v_and_b32 v13, 0xffff0000, v142
  v_pk_add_f32 v[172:173], v[172:173], v[12:13]
  v_lshlrev_b32 v14, 16, v143
  v_and_b32 v15, 0xffff0000, v143
  v_pk_add_f32 v[174:175], v[174:175], v[14:15]
  s_waitcnt vmcnt(2)
  v_lshlrev_b32 v8, 16, v144
  v_and_b32 v9, 0xffff0000, v144
  v_pk_add_f32 v[160:161], v[160:161], v[8:9]
  v_lshlrev_b32 v10, 16, v145
  v_and_b32 v11, 0xffff0000, v145
  v_pk_add_f32 v[162:163], v[162:163], v[10:11]
  v_lshlrev_b32 v12, 16, v146
  v_and_b32 v13, 0xffff0000, v146
  v_pk_add_f32 v[164:165], v[164:165], v[12:13]
  v_lshlrev_b32 v14, 16, v147
  v_and_b32 v15, 0xffff0000, v147
  v_pk_add_f32 v[166:167], v[166:167], v[14:15]
  v_lshlrev_b32 v8, 16, v148
  v_and_b32 v9, 0xffff0000, v148
  v_pk_add_f32 v[168:169], v[168:169], v[8:9]
  v_lshlrev_b32 v10, 16, v149
  v_and_b32 v11, 0xffff0000, v149
  v_pk_add_f32 v[170:171], v[170:171], v[10:11]
  v_lshlrev_b32 v12, 16, v150
  v_and_b32 v13, 0xffff0000, v150
  v_pk_add_f32 v[172:173], v[172:173], v[12:13]
  v_lshlrev_b32 v14, 16, v151
  v_and_b32 v15, 0xffff0000, v151
  v_pk_add_f32 v[174:175], v[174:175], v[14:15]
  s_waitcnt vmcnt(0)
  v_lshlrev_b32 v8, 16, v152
  v_and_b32 v9, 0xffff0000, v152
  v_pk_add_f32 v[160:161], v[160:161], v[8:9]
  v_lshlrev_b32 v10, 16, v153
  v_and_b32 v11, 0xffff0000, v153
  v_pk_add_f32 v[162:163], v[162:163], v[10:11]
  v_lshlrev_b32 v12, 16, v154
  v_and_b32 v13, 0xffff0000, v154
  v_pk_add_f32 v[164:165], v[164:165], v[12:13]
  v_lshlrev_b32 v14, 16, v155
  v_and_b32 v15, 0xffff0000, v155
  v_pk_add_f32 v[166:167], v[166:167], v[14:15]
  v_lshlrev_b32 v8, 16, v156
  v_and_b32 v9, 0xffff0000, v156
  v_pk_add_f32 v[168:169], v[168:169], v[8:9]
  v_lshlrev_b32 v10, 16, v157
  v_and_b32 v11, 0xffff0000, v157
  v_pk_add_f32 v[170:171], v[170:171], v[10:11]
  v_lshlrev_b32 v12, 16, v158
  v_and_b32 v13, 0xffff0000, v158
  v_pk_add_f32 v[172:173], v[172:173], v[12:13]
  v_lshlrev_b32 v14, 16, v159
  v_and_b32 v15, 0xffff0000, v159
  v_pk_add_f32 v[174:175], v[174:175], v[14:15]
  s_and_b32 s76, s48, 1
  s_lshl_b32 s76, s76, 1
  s_lshr_b32 s77, s49, 1
  s_add_u32 s76, s76, s77
  s_mul_i32 s76, s76, 7
  s_add_u32 s76, s76, 6
  s_lshr_b32 s77, s48, 1
  s_add_u32 s77, s77, 0x201
  v_mov_b32 v193, s77
  s_lshl_b32 s76, s76, 7
  s_add_u32 s76, s76, 148897792
  v_and_b32 v192, 7, v1
  v_mul_u32_u24 v192, 3584, v192
  v_add_u32 v192, s76, v192
  s_mov_b32 s71, 0
  s_branch M_vg_52
M_vw_51:
  s_sleep 2
  s_add_u32 s71, s71, 1
  s_cmp_gt_u32 s71, 262144
  s_cbranch_scc1 M_exit
M_vg_52:
  buffer_load_dword v194, v192, s[4:7], 0 offen sc1
  s_waitcnt vmcnt(0)
  v_cmp_lt_u32 vcc, v194, v193
  s_cbranch_vccnz M_vw_51
  s_add_u32 s29, s28, 167772160
  buffer_load_dwordx4 v[96:99], v2, s[4:7], s29 offen offset:0 sc1
  buffer_load_dwordx4 v[100:103], v2, s[4:7], s29 offen offset:1024 sc1
  s_add_u32 s29, s28, 169869312
  buffer_load_dwordx4 v[104:107], v2, s[4:7], s29 offen offset:0 sc1
  buffer_load_dwordx4 v[108:111], v2, s[4:7], s29 offen offset:1024 sc1
  s_add_u32 s29, s28, 171966464
  buffer_load_dwordx4 v[112:115], v2, s[4:7], s29 offen offset:0 sc1
  buffer_load_dwordx4 v[116:119], v2, s[4:7], s29 offen offset:1024 sc1
  s_add_u32 s29, s28, 174063616
  buffer_load_dwordx4 v[120:123], v2, s[4:7], s29 offen offset:0 sc1
  buffer_load_dwordx4 v[124:127], v2, s[4:7], s29 offen offset:1024 sc1
  s_add_u32 s29, s28, 176160768
  buffer_load_dwordx4 v[128:131], v2, s[4:7], s29 offen offset:0 sc1
  buffer_load_dwordx4 v[132:135], v2, s[4:7], s29 offen offset:1024 sc1
  s_add_u32 s29, s28, 178257920
  buffer_load_dwordx4 v[136:139], v2, s[4:7], s29 offen offset:0 sc1
  buffer_load_dwordx4 v[140:143], v2, s[4:7], s29 offen offset:1024 sc1
  s_add_u32 s29, s28, 180355072
  buffer_load_dwordx4 v[144:147], v2, s[4:7], s29 offen offset:0 sc1
  buffer_load_dwordx4 v[148:151], v2, s[4:7], s29 offen offset:1024 sc1
  s_add_u32 s29, s28, 182452224
  buffer_load_dwordx4 v[152:155], v2, s[4:7], s29 offen offset:0 sc1
  buffer_load_dwordx4 v[156:159], v2, s[4:7], s29 offen offset:1024 sc1
  v_pk_mul_f32 v[160:161], v[160:161], v[80:81] op_sel_hi:[1,0]
  v_pk_mul_f32 v[162:163], v[162:163], v[80:81] op_sel_hi:[1,0]
  v_pk_mul_f32 v[164:165], v[164:165], v[80:81] op_sel_hi:[1,0]
  v_pk_mul_f32 v[166:167], v[166:167], v[80:81] op_sel_hi:[1,0]
  v_pk_mul_f32 v[168:169], v[168:169], v[80:81] op_sel_hi:[1,0]
  v_pk_mul_f32 v[170:171], v[170:171], v[80:81] op_sel_hi:[1,0]
  v_pk_mul_f32 v[172:173], v[172:173], v[80:81] op_sel_hi:[1,0]
  v_pk_mul_f32 v[174:175], v[174:175], v[80:81] op_sel_hi:[1,0]
  s_waitcnt vmcnt(14)
  v_lshlrev_b32 v176, 16, v96
  v_and_b32 v177, 0xffff0000, v96
  v_lshlrev_b32 v178, 16, v97
  v_and_b32 v179, 0xffff0000, v97
  v_lshlrev_b32 v180, 16, v98
  v_and_b32 v181, 0xffff0000, v98
  v_lshlrev_b32 v182, 16, v99
  v_and_b32 v183, 0xffff0000, v99
  v_lshlrev_b32 v184, 16, v100
  v_and_b32 v185, 0xffff0000, v100
  v_lshlrev_b32 v186, 16, v101
  v_and_b32 v187, 0xffff0000, v101
  v_lshlrev_b32 v188, 16, v102
  v_and_b32 v189, 0xffff0000, v102
  v_lshlrev_b32 v190, 16, v103
  v_and_b32 v191, 0xffff0000, v103
  s_waitcnt vmcnt(12)
  v_lshlrev_b32 v8, 16, v104
  v_and_b32 v9, 0xffff0000, v104
  v_pk_add_f32 v[176:177], v[176:177], v[8:9]
  v_lshlrev_b32 v10, 16, v105
  v_and_b32 v11, 0xffff0000, v105
  v_pk_add_f32 v[178:179], v[178:179], v[10:11]
  v_lshlrev_b32 v12, 16, v106
  v_and_b32 v13, 0xffff0000, v106
  v_pk_add_f32 v[180:181], v[180:181], v[12:13]
  v_lshlrev_b32 v14, 16, v107
  v_and_b32 v15, 0xffff0000, v107
  v_pk_add_f32 v[182:183], v[182:183], v[14:15]
  v_lshlrev_b32 v8, 16, v108
  v_and_b32 v9, 0xffff0000, v108
  v_pk_add_f32 v[184:185], v[184:185], v[8:9]
  v_lshlrev_b32 v10, 16, v109
  v_and_b32 v11, 0xffff0000, v109
  v_pk_add_f32 v[186:187], v[186:187], v[10:11]
  v_lshlrev_b32 v12, 16, v110
  v_and_b32 v13, 0xffff0000, v110
  v_pk_add_f32 v[188:189], v[188:189], v[12:13]
  v_lshlrev_b32 v14, 16, v111
  v_and_b32 v15, 0xffff0000, v111
  v_pk_add_f32 v[190:191], v[190:191], v[14:15]
  s_waitcnt vmcnt(10)
  v_lshlrev_b32 v8, 16, v112
  v_and_b32 v9, 0xffff0000, v112
  v_pk_add_f32 v[176:177], v[176:177], v[8:9]
  v_lshlrev_b32 v10, 16, v113
  v_and_b32 v11, 0xffff0000, v113
  v_pk_add_f32 v[178:179], v[178:179], v[10:11]
  v_lshlrev_b32 v12, 16, v114
  v_and_b32 v13, 0xffff0000, v114
  v_pk_add_f32 v[180:181], v[180:181], v[12:13]
  v_lshlrev_b32 v14, 16, v115
  v_and_b32 v15, 0xffff0000, v115
  v_pk_add_f32 v[182:183], v[182:183], v[14:15]
  v_lshlrev_b32 v8, 16, v116
  v_and_b32 v9, 0xffff0000, v116
  v_pk_add_f32 v[184:185], v[184:185], v[8:9]
  v_lshlrev_b32 v10, 16, v117
  v_and_b32 v11, 0xffff0000, v117
  v_pk_add_f32 v[186:187], v[186:187], v[10:11]
  v_lshlrev_b32 v12, 16, v118
  v_and_b32 v13, 0xffff0000, v118
  v_pk_add_f32 v[188:189], v[188:189], v[12:13]
  v_lshlrev_b32 v14, 16, v119
  v_and_b32 v15, 0xffff0000, v119
  v_pk_add_f32 v[190:191], v[190:191], v[14:15]
  s_waitcnt vmcnt(8)
  v_lshlrev_b32 v8, 16, v120
  v_and_b32 v9, 0xffff0000, v120
  v_pk_add_f32 v[176:177], v[176:177], v[8:9]
  v_lshlrev_b32 v10, 16, v121
  v_and_b32 v11, 0xffff0000, v121
  v_pk_add_f32 v[178:179], v[178:179], v[10:11]
  v_lshlrev_b32 v12, 16, v122
  v_and_b32 v13, 0xffff0000, v122
  v_pk_add_f32 v[180:181], v[180:181], v[12:13]
  v_lshlrev_b32 v14, 16, v123
  v_and_b32 v15, 0xffff0000, v123
  v_pk_add_f32 v[182:183], v[182:183], v[14:15]
  v_lshlrev_b32 v8, 16, v124
  v_and_b32 v9, 0xffff0000, v124
  v_pk_add_f32 v[184:185], v[184:185], v[8:9]
  v_lshlrev_b32 v10, 16, v125
  v_and_b32 v11, 0xffff0000, v125
  v_pk_add_f32 v[186:187], v[186:187], v[10:11]
  v_lshlrev_b32 v12, 16, v126
  v_and_b32 v13, 0xffff0000, v126
  v_pk_add_f32 v[188:189], v[188:189], v[12:13]
  v_lshlrev_b32 v14, 16, v127
  v_and_b32 v15, 0xffff0000, v127
  v_pk_add_f32 v[190:191], v[190:191], v[14:15]
  s_waitcnt vmcnt(6)
  v_lshlrev_b32 v8, 16, v128
  v_and_b32 v9, 0xffff0000, v128
  v_pk_add_f32 v[176:177], v[176:177], v[8:9]
  v_lshlrev_b32 v10, 16, v129
  v_and_b32 v11, 0xffff0000, v129
  v_pk_add_f32 v[178:179], v[178:179], v[10:11]
  v_lshlrev_b32 v12, 16, v130
  v_and_b32 v13, 0xffff0000, v130
  v_pk_add_f32 v[180:181], v[180:181], v[12:13]
  v_lshlrev_b32 v14, 16, v131
  v_and_b32 v15, 0xffff0000, v131
  v_pk_add_f32 v[182:183], v[182:183], v[14:15]
  v_lshlrev_b32 v8, 16, v132
  v_and_b32 v9, 0xffff0000, v132
  v_pk_add_f32 v[184:185], v[184:185], v[8:9]
  v_lshlrev_b32 v10, 16, v133
  v_and_b32 v11, 0xffff0000, v133
  v_pk_add_f32 v[186:187], v[186:187], v[10:11]
  v_lshlrev_b32 v12, 16, v134
  v_and_b32 v13, 0xffff0000, v134
  v_pk_add_f32 v[188:189], v[188:189], v[12:13]
  v_lshlrev_b32 v14, 16, v135
  v_and_b32 v15, 0xffff0000, v135
  v_pk_add_f32 v[190:191], v[190:191], v[14:15]
  s_waitcnt vmcnt(4)
  v_lshlrev_b32 v8, 16, v136
  v_and_b32 v9, 0xffff0000, v136
  v_pk_add_f32 v[176:177], v[176:177], v[8:9]
  v_lshlrev_b32 v10, 16, v137
  v_and_b32 v11, 0xffff0000, v137
  v_pk_add_f32 v[178:179], v[178:179], v[10:11]
  v_lshlrev_b32 v12, 16, v138
  v_and_b32 v13, 0xffff0000, v138
  v_pk_add_f32 v[180:181], v[180:181], v[12:13]
  v_lshlrev_b32 v14, 16, v139
  v_and_b32 v15, 0xffff0000, v139
  v_pk_add_f32 v[182:183], v[182:183], v[14:15]
  v_lshlrev_b32 v8, 16, v140
  v_and_b32 v9, 0xffff0000, v140
  v_pk_add_f32 v[184:185], v[184:185], v[8:9]
  v_lshlrev_b32 v10, 16, v141
  v_and_b32 v11, 0xffff0000, v141
  v_pk_add_f32 v[186:187], v[186:187], v[10:11]
  v_lshlrev_b32 v12, 16, v142
  v_and_b32 v13, 0xffff0000, v142
  v_pk_add_f32 v[188:189], v[188:189], v[12:13]
  v_lshlrev_b32 v14, 16, v143
  v_and_b32 v15, 0xffff0000, v143
  v_pk_add_f32 v[190:191], v[190:191], v[14:15]
  s_waitcnt vmcnt(2)
  v_lshlrev_b32 v8, 16, v144
  v_and_b32 v9, 0xffff0000, v144
  v_pk_add_f32 v[176:177], v[176:177], v[8:9]
  v_lshlrev_b32 v10, 16, v145
  v_and_b32 v11, 0xffff0000, v145
  v_pk_add_f32 v[178:179], v[178:179], v[10:11]
  v_lshlrev_b32 v12, 16, v146
  v_and_b32 v13, 0xffff0000, v146
  v_pk_add_f32 v[180:181], v[180:181], v[12:13]
  v_lshlrev_b32 v14, 16, v147
  v_and_b32 v15, 0xffff0000, v147
  v_pk_add_f32 v[182:183], v[182:183], v[14:15]
  v_lshlrev_b32 v8, 16, v148
  v_and_b32 v9, 0xffff0000, v148
  v_pk_add_f32 v[184:185], v[184:185], v[8:9]
  v_lshlrev_b32 v10, 16, v149
  v_and_b32 v11, 0xffff0000, v149
  v_pk_add_f32 v[186:187], v[186:187], v[10:11]
  v_lshlrev_b32 v12, 16, v150
  v_and_b32 v13, 0xffff0000, v150
  v_pk_add_f32 v[188:189], v[188:189], v[12:13]
  v_lshlrev_b32 v14, 16, v151
  v_and_b32 v15, 0xffff0000, v151
  v_pk_add_f32 v[190:191], v[190:191], v[14:15]
  s_waitcnt vmcnt(0)
  v_lshlrev_b32 v8, 16, v152
  v_and_b32 v9, 0xffff0000, v152
  v_pk_add_f32 v[176:177], v[176:177], v[8:9]
  v_lshlrev_b32 v10, 16, v153
  v_and_b32 v11, 0xffff0000, v153
  v_pk_add_f32 v[178:179], v[178:179], v[10:11]
  v_lshlrev_b32 v12, 16, v154
  v_and_b32 v13, 0xffff0000, v154
  v_pk_add_f32 v[180:181], v[180:181], v[12:13]
  v_lshlrev_b32 v14, 16, v155
  v_and_b32 v15, 0xffff0000, v155
  v_pk_add_f32 v[182:183], v[182:183], v[14:15]
  v_lshlrev_b32 v8, 16, v156
  v_and_b32 v9, 0xffff0000, v156
  v_pk_add_f32 v[184:185], v[184:185], v[8:9]
  v_lshlrev_b32 v10, 16, v157
  v_and_b32 v11, 0xffff0000, v157
  v_pk_add_f32 v[186:187], v[186:187], v[10:11]
  v_lshlrev_b32 v12, 16, v158
  v_and_b32 v13, 0xffff0000, v158
  v_pk_add_f32 v[188:189], v[188:189], v[12:13]
  v_lshlrev_b32 v14, 16, v159
  v_and_b32 v15, 0xffff0000, v159
  v_pk_add_f32 v[190:191], v[190:191], v[14:15]
  v_pk_fma_f32 v[160:161], v[176:177], v[82:83], v[160:161] op_sel_hi:[1,0,1]
  v_cvt_pk_bf16_f32 v16, v160, v161
  v_pk_fma_f32 v[162:163], v[178:179], v[82:83], v[162:163] op_sel_hi:[1,0,1]
  v_cvt_pk_bf16_f32 v17, v162, v163
  v_pk_fma_f32 v[164:165], v[180:181], v[82:83], v[164:165] op_sel_hi:[1,0,1]
  v_cvt_pk_bf16_f32 v18, v164, v165
  v_pk_fma_f32 v[166:167], v[182:183], v[82:83], v[166:167] op_sel_hi:[1,0,1]
  v_cvt_pk_bf16_f32 v19, v166, v167
  v_pk_fma_f32 v[168:169], v[184:185], v[82:83], v[168:169] op_sel_hi:[1,0,1]
  v_cvt_pk_bf16_f32 v20, v168, v169
  v_pk_fma_f32 v[170:171], v[186:187], v[82:83], v[170:171] op_sel_hi:[1,0,1]
  v_cvt_pk_bf16_f32 v21, v170, v171
  v_pk_fma_f32 v[172:173], v[188:189], v[82:83], v[172:173] op_sel_hi:[1,0,1]
  v_cvt_pk_bf16_f32 v22, v172, v173
  v_pk_fma_f32 v[174:175], v[190:191], v[82:83], v[174:175] op_sel_hi:[1,0,1]
  v_cvt_pk_bf16_f32 v23, v174, v175
  s_lshl_b32 s26, s49, 2
  s_add_u32 s26, s26, s16
  s_lshl_b32 s26, s26, 6
  s_lshl_b32 s27, s48, 15
  s_add_u32 s26, s26, s27
  buffer_store_dwordx4 v[16:19], v6, s[32:35], s26 offen offset:0
  buffer_store_dwordx4 v[20:23], v6, s[32:35], s26 offen offset:32
  s_cmp_lt_u32 s50, 64
  s_mov_b32 s50, s51
  s_cbranch_scc1 M_fin
  s_branch M_done
M_follow:
  s_lshr_b32 s48, s64, 2
  s_and_b32 s49, s64, 1
  s_bfe_u32 s50, s64, 0x10001
  s_mov_b32 s51, 2
  s_mov_b32 s23, 32
  s_load_dwordx2 s[8:9], s[0:1], 88
  s_lshl_b32 s17, s48, 19
  s_lshl_b32 s26, s49, 2
  s_add_u32 s26, s26, s16
  s_lshl_b32 s27, s26, 7
  s_add_u32 s17, s17, s27
  s_mov_b32 s18, 1024
  s_lshl_b32 s21, s48, 6
  s_add_u32 s21, s21, s50
  s_lshl_b32 s21, s21, 3
  s_add_u32 s21, s21, s26
  s_lshl_b32 s21, s21, 12
  s_add_u32 s21, s21, 167772160
  s_lshl_b32 s22, s51, 15
  s_mov_b32 s24, 1.0
  s_waitcnt lgkmcnt(0)
  s_and_b32 s9, s9, 0xffff
  s_mov_b32 s10, 4194304
  s_mov_b32 s11, 0x20000
  s_mul_i32 s26, s16, 0
  v_add_u32 v8, 0, v2
  v_add_u32 v16, s26, v8
  v_add_u32 v9, 1024, v2
  v_add_u32 v17, s26, v9
  v_add_u32 v10, 2048, v2
  v_add_u32 v18, s26, v10
  v_add_u32 v11, 3072, v2
  v_add_u32 v19, s26, v11
  v_add_u32 v12, 4096, v2
  v_add_u32 v20, s26, v12
  v_add_u32 v13, 5120, v2
  v_add_u32 v21, s26, v13
  v_add_u32 v14, 6144, v2
  v_add_u32 v22, s26, v14
  v_add_u32 v15, 7168, v2
  v_add_u32 v23, s26, v15
  v_lshrrev_b32 v144, 3, v1
  v_mul_lo_u32 v144, v144, s18
  v_and_b32 v145, 7, v1
  v_lshl_add_u32 v144, v145, 4, v144
  s_lshl_b32 s28, s16, 15
  s_add_u32 s28, s28, 32768
  s_lshl_b32 s29, s18, 3
  s_add_u32 m0, s28, 0
  s_nop 0
  buffer_load_dwordx4 v144, s[8:11], s17 offen lds
  s_add_u32 s17, s17, s29
  s_add_u32 m0, s28, 1024
  s_nop 0
  buffer_load_dwordx4 v144, s[8:11], s17 offen lds
  s_add_u32 s17, s17, s29
  s_add_u32 m0, s28, 2048
  s_nop 0
  buffer_load_dwordx4 v144, s[8:11], s17 offen lds
  s_add_u32 s17, s17, s29
  s_add_u32 m0, s28, 3072
  s_nop 0
  buffer_load_dwordx4 v144, s[8:11], s17 offen lds
  s_add_u32 s17, s17, s29
  s_add_u32 m0, s28, 4096
  s_nop 0
  buffer_load_dwordx4 v144, s[8:11], s17 offen lds
  s_add_u32 s17, s17, s29
  s_add_u32 m0, s28, 5120
  s_nop 0
  buffer_load_dwordx4 v144, s[8:11], s17 offen lds
  s_add_u32 s17, s17, s29
  s_add_u32 m0, s28, 6144
  s_nop 0
  buffer_load_dwordx4 v144, s[8:11], s17 offen lds
  s_add_u32 s17, s17, s29
  s_add_u32 m0, s28, 7168
  s_nop 0
  buffer_load_dwordx4 v144, s[8:11], s17 offen lds
  s_add_u32 s17, s17, s29
  s_add_u32 m0, s28, 8192
  s_nop 0
  buffer_load_dwordx4 v144, s[8:11], s17 offen lds
  s_add_u32 s17, s17, s29
  s_add_u32 m0, s28, 9216
  s_nop 0
  buffer_load_dwordx4 v144, s[8:11], s17 offen lds
  s_add_u32 s17, s17, s29
  s_add_u32 m0, s28, 10240
  s_nop 0
  buffer_load_dwordx4 v144, s[8:11], s17 offen lds
  s_add_u32 s17, s17, s29
  s_add_u32 m0, s28, 11264
  s_nop 0
  buffer_load_dwordx4 v144, s[8:11], s17 offen lds
  s_add_u32 s17, s17, s29
  s_add_u32 m0, s28, 12288
  s_nop 0
  buffer_load_dwordx4 v144, s[8:11], s17 offen lds
  s_add_u32 s17, s17, s29
  s_add_u32 m0, s28, 13312
  s_nop 0
  buffer_load_dwordx4 v144, s[8:11], s17 offen lds
  s_add_u32 s17, s17, s29
  s_add_u32 m0, s28, 14336
  s_nop 0
  buffer_load_dwordx4 v144, s[8:11], s17 offen lds
  s_add_u32 s17, s17, s29
  s_add_u32 m0, s28, 15360
  s_nop 0
  buffer_load_dwordx4 v144, s[8:11], s17 offen lds
  s_add_u32 s17, s17, s29
  s_add_u32 m0, s28, 16384
  s_nop 0
  buffer_load_dwordx4 v144, s[8:11], s17 offen lds
  s_add_u32 s17, s17, s29
  s_add_u32 m0, s28, 17408
  s_nop 0
  buffer_load_dwordx4 v144, s[8:11], s17 offen lds
  s_add_u32 s17, s17, s29
  s_add_u32 m0, s28, 18432
  s_nop 0
  buffer_load_dwordx4 v144, s[8:11], s17 offen lds
  s_add_u32 s17, s17, s29
  s_add_u32 m0, s28, 19456
  s_nop 0
  buffer_load_dwordx4 v144, s[8:11], s17 offen lds
  s_add_u32 s17, s17, s29
  s_add_u32 m0, s28, 20480
  s_nop 0
  buffer_load_dwordx4 v144, s[8:11], s17 offen lds
  s_add_u32 s17, s17, s29
  s_add_u32 m0, s28, 21504
  s_nop 0
  buffer_load_dwordx4 v144, s[8:11], s17 offen lds
  s_add_u32 s17, s17, s29
  s_add_u32 m0, s28, 22528
  s_nop 0
  buffer_load_dwordx4 v144, s[8:11], s17 offen lds
  s_add_u32 s17, s17, s29
  s_add_u32 m0, s28, 23552
  s_nop 0
  buffer_load_dwordx4 v144, s[8:11], s17 offen lds
  s_add_u32 s17, s17, s29
  s_add_u32 m0, s28, 24576
  s_nop 0
  buffer_load_dwordx4 v144, s[8:11], s17 offen lds
  s_add_u32 s17, s17, s29
  s_add_u32 m0, s28, 25600
  s_nop 0
  buffer_load_dwordx4 v144, s[8:11], s17 offen lds
  s_add_u32 s17, s17, s29
  s_add_u32 m0, s28, 26624
  s_nop 0
  buffer_load_dwordx4 v144, s[8:11], s17 offen lds
  s_add_u32 s17, s17, s29
  s_add_u32 m0, s28, 27648
  s_nop 0
  buffer_load_dwordx4 v144, s[8:11], s17 offen lds
  s_add_u32 s17, s17, s29
  s_add_u32 m0, s28, 28672
  s_nop 0
  buffer_load_dwordx4 v144, s[8:11], s17 offen lds
  s_add_u32 s17, s17, s29
  s_add_u32 m0, s28, 29696
  s_nop 0
  buffer_load_dwordx4 v144, s[8:11], s17 offen lds
  s_add_u32 s17, s17, s29
  s_add_u32 m0, s28, 30720
  s_nop 0
  buffer_load_dwordx4 v144, s[8:11], s17 offen lds
  s_add_u32 s17, s17, s29
  s_add_u32 m0, s28, 31744
  s_nop 0
  buffer_load_dwordx4 v144, s[8:11], s17 offen lds
  s_add_u32 s17, s17, s29
  v_bfe_u32 v148, v1, 2, 2
  v_lshrrev_b32 v149, 5, v1
  v_lshl_add_u32 v148, v149, 2, v148
  v_lshlrev_b32 v148, 7, v148
  v_bfe_u32 v149, v1, 4, 1
  v_lshl_add_u32 v148, v149, 5, v148
  v_and_b32 v149, 1, v1
  v_lshl_add_u32 v148, v149, 4, v148
  v_bfe_u32 v149, v1, 1, 1
  v_lshl_add_u32 v148, v149, 3, v148
  v_add_u32 v146, s28, v148
  v_add_u32 v147, 1024, v146
  s_waitcnt vmcnt(28)
  ds_read_b64_tr_b16 a[0:1], v146 offset:0
  ds_read_b64_tr_b16 a[2:3], v147 offset:0
  ds_read_b64_tr_b16 a[4:5], v146 offset:64
  ds_read_b64_tr_b16 a[6:7], v147 offset:64
  ds_read_b64_tr_b16 a[8:9], v146 offset:2048
  ds_read_b64_tr_b16 a[10:11], v147 offset:2048
  ds_read_b64_tr_b16 a[12:13], v146 offset:2112
  ds_read_b64_tr_b16 a[14:15], v147 offset:2112
  s_waitcnt lgkmcnt(0)
  s_add_u32 m0, s28, 0
  s_nop 0
  buffer_load_dwordx4 v144, s[8:11], s17 offen lds
  s_add_u32 s17, s17, s29
  s_add_u32 m0, s28, 1024
  s_nop 0
  buffer_load_dwordx4 v144, s[8:11], s17 offen lds
  s_add_u32 s17, s17, s29
  s_add_u32 m0, s28, 2048
  s_nop 0
  buffer_load_dwordx4 v144, s[8:11], s17 offen lds
  s_add_u32 s17, s17, s29
  s_add_u32 m0, s28, 3072
  s_nop 0
  buffer_load_dwordx4 v144, s[8:11], s17 offen lds
  s_add_u32 s17, s17, s29
  s_waitcnt vmcnt(28)
  ds_read_b64_tr_b16 a[16:17], v146 offset:4096
  ds_read_b64_tr_b16 a[18:19], v147 offset:4096
  ds_read_b64_tr_b16 a[20:21], v146 offset:4160
  ds_read_b64_tr_b16 a[22:23], v147 offset:4160
  ds_read_b64_tr_b16 a[24:25], v146 offset:6144
  ds_read_b64_tr_b16 a[26:27], v147 offset:6144
  ds_read_b64_tr_b16 a[28:29], v146 offset:6208
  ds_read_b64_tr_b16 a[30:31], v147 offset:6208
  s_waitcnt lgkmcnt(0)
  s_add_u32 m0, s28, 4096
  s_nop 0
  buffer_load_dwordx4 v144, s[8:11], s17 offen lds
  s_add_u32 s17, s17, s29
  s_add_u32 m0, s28, 5120
  s_nop 0
  buffer_load_dwordx4 v144, s[8:11], s17 offen lds
  s_add_u32 s17, s17, s29
  s_add_u32 m0, s28, 6144
  s_nop 0
  buffer_load_dwordx4 v144, s[8:11], s17 offen lds
  s_add_u32 s17, s17, s29
  s_add_u32 m0, s28, 7168
  s_nop 0
  buffer_load_dwordx4 v144, s[8:11], s17 offen lds
  s_add_u32 s17, s17, s29
  s_waitcnt vmcnt(28)
  ds_read_b64_tr_b16 a[32:33], v146 offset:8192
  ds_read_b64_tr_b16 a[34:35], v147 offset:8192
  ds_read_b64_tr_b16 a[36:37], v146 offset:8256
  ds_read_b64_tr_b16 a[38:39], v147 offset:8256
  ds_read_b64_tr_b16 a[40:41], v146 offset:10240
  ds_read_b64_tr_b16 a[42:43], v147 offset:10240
  ds_read_b64_tr_b16 a[44:45], v146 offset:10304
  ds_read_b64_tr_b16 a[46:47], v147 offset:10304
  s_waitcnt lgkmcnt(0)
  s_add_u32 m0, s28, 8192
  s_nop 0
  buffer_load_dwordx4 v144, s[8:11], s17 offen lds
  s_add_u32 s17, s17, s29
  s_add_u32 m0, s28, 9216
  s_nop 0
  buffer_load_dwordx4 v144, s[8:11], s17 offen lds
  s_add_u32 s17, s17, s29
  s_add_u32 m0, s28, 10240
  s_nop 0
  buffer_load_dwordx4 v144, s[8:11], s17 offen lds
  s_add_u32 s17, s17, s29
  s_add_u32 m0, s28, 11264
  s_nop 0
  buffer_load_dwordx4 v144, s[8:11], s17 offen lds
  s_add_u32 s17, s17, s29
  s_waitcnt vmcnt(28)
  ds_read_b64_tr_b16 a[48:49], v146 offset:12288
  ds_read_b64_tr_b16 a[50:51], v147 offset:12288
  ds_read_b64_tr_b16 a[52:53], v146 offset:12352
  ds_read_b64_tr_b16 a[54:55], v147 offset:12352
  ds_read_b64_tr_b16 a[56:57], v146 offset:14336
  ds_read_b64_tr_b16 a[58:59], v147 offset:14336
  ds_read_b64_tr_b16 a[60:61], v146 offset:14400
  ds_read_b64_tr_b16 a[62:63], v147 offset:14400
  s_waitcnt lgkmcnt(0)
  s_add_u32 m0, s28, 12288
  s_nop 0
  buffer_load_dwordx4 v144, s[8:11], s17 offen lds
  s_add_u32 s17, s17, s29
  s_add_u32 m0, s28, 13312
  s_nop 0
  buffer_load_dwordx4 v144, s[8:11], s17 offen lds
  s_add_u32 s17, s17, s29
  s_add_u32 m0, s28, 14336
  s_nop 0
  buffer_load_dwordx4 v144, s[8:11], s17 offen lds
  s_add_u32 s17, s17, s29
  s_add_u32 m0, s28, 15360
  s_nop 0
  buffer_load_dwordx4 v144, s[8:11], s17 offen lds
  s_add_u32 s17, s17, s29
  s_waitcnt vmcnt(28)
  ds_read_b64_tr_b16 a[64:65], v146 offset:16384
  ds_read_b64_tr_b16 a[66:67], v147 offset:16384
  ds_read_b64_tr_b16 a[68:69], v146 offset:16448
  ds_read_b64_tr_b16 a[70:71], v147 offset:16448
  ds_read_b64_tr_b16 a[72:73], v146 offset:18432
  ds_read_b64_tr_b16 a[74:75], v147 offset:18432
  ds_read_b64_tr_b16 a[76:77], v146 offset:18496
  ds_read_b64_tr_b16 a[78:79], v147 offset:18496
  s_waitcnt lgkmcnt(0)
  s_add_u32 m0, s28, 16384
  s_nop 0
  buffer_load_dwordx4 v144, s[8:11], s17 offen lds
  s_add_u32 s17, s17, s29
  s_add_u32 m0, s28, 17408
  s_nop 0
  buffer_load_dwordx4 v144, s[8:11], s17 offen lds
  s_add_u32 s17, s17, s29
  s_add_u32 m0, s28, 18432
  s_nop 0
  buffer_load_dwordx4 v144, s[8:11], s17 offen lds
  s_add_u32 s17, s17, s29
  s_add_u32 m0, s28, 19456
  s_nop 0
  buffer_load_dwordx4 v144, s[8:11], s17 offen lds
  s_add_u32 s17, s17, s29
  s_waitcnt vmcnt(28)
  ds_read_b64_tr_b16 a[80:81], v146 offset:20480
  ds_read_b64_tr_b16 a[82:83], v147 offset:20480
  ds_read_b64_tr_b16 a[84:85], v146 offset:20544
  ds_read_b64_tr_b16 a[86:87], v147 offset:20544
  ds_read_b64_tr_b16 a[88:89], v146 offset:22528
  ds_read_b64_tr_b16 a[90:91], v147 offset:22528
  ds_read_b64_tr_b16 a[92:93], v146 offset:22592
  ds_read_b64_tr_b16 a[94:95], v147 offset:22592
  s_waitcnt lgkmcnt(0)
  s_add_u32 m0, s28, 20480
  s_nop 0
  buffer_load_dwordx4 v144, s[8:11], s17 offen lds
  s_add_u32 s17, s17, s29
  s_add_u32 m0, s28, 21504
  s_nop 0
  buffer_load_dwordx4 v144, s[8:11], s17 offen lds
  s_add_u32 s17, s17, s29
  s_add_u32 m0, s28, 22528
  s_nop 0
  buffer_load_dwordx4 v144, s[8:11], s17 offen lds
  s_add_u32 s17, s17, s29
  s_add_u32 m0, s28, 23552
  s_nop 0
  buffer_load_dwordx4 v144, s[8:11], s17 offen lds
  s_add_u32 s17, s17, s29
  s_waitcnt vmcnt(28)
  ds_read_b64_tr_b16 a[96:97], v146 offset:24576
  ds_read_b64_tr_b16 a[98:99], v147 offset:24576
  ds_read_b64_tr_b16 a[100:101], v146 offset:24640
  ds_read_b64_tr_b16 a[102:103], v147 offset:24640
  ds_read_b64_tr_b16 a[104:105], v146 offset:26624
  ds_read_b64_tr_b16 a[106:107], v147 offset:26624
  ds_read_b64_tr_b16 a[108:109], v146 offset:26688
  ds_read_b64_tr_b16 a[110:111], v147 offset:26688
  s_waitcnt lgkmcnt(0)
  s_add_u32 m0, s28, 24576
  s_nop 0
  buffer_load_dwordx4 v144, s[8:11], s17 offen lds
  s_add_u32 s17, s17, s29
  s_add_u32 m0, s28, 25600
  s_nop 0
  buffer_load_dwordx4 v144, s[8:11], s17 offen lds
  s_add_u32 s17, s17, s29
  s_add_u32 m0, s28, 26624
  s_nop 0
  buffer_load_dwordx4 v144, s[8:11], s17 offen lds
  s_add_u32 s17, s17, s29
  s_add_u32 m0, s28, 27648
  s_nop 0
  buffer_load_dwordx4 v144, s[8:11], s17 offen lds
  s_add_u32 s17, s17, s29
  s_waitcnt vmcnt(28)
  ds_read_b64_tr_b16 a[112:113], v146 offset:28672
  ds_read_b64_tr_b16 a[114:115], v147 offset:28672
  ds_read_b64_tr_b16 a[116:117], v146 offset:28736
  ds_read_b64_tr_b16 a[118:119], v147 offset:28736
  ds_read_b64_tr_b16 a[120:121], v146 offset:30720
  ds_read_b64_tr_b16 a[122:123], v147 offset:30720
  ds_read_b64_tr_b16 a[124:125], v146 offset:30784
  ds_read_b64_tr_b16 a[126:127], v147 offset:30784
  s_waitcnt lgkmcnt(0)
  s_add_u32 m0, s28, 28672
  s_nop 0
  buffer_load_dwordx4 v144, s[8:11], s17 offen lds
  s_add_u32 s17, s17, s29
  s_add_u32 m0, s28, 29696
  s_nop 0
  buffer_load_dwordx4 v144, s[8:11], s17 offen lds
  s_add_u32 s17, s17, s29
  s_add_u32 m0, s28, 30720
  s_nop 0
  buffer_load_dwordx4 v144, s[8:11], s17 offen lds
  s_add_u32 s17, s17, s29
  s_add_u32 m0, s28, 31744
  s_nop 0
  buffer_load_dwordx4 v144, s[8:11], s17 offen lds
  s_add_u32 s17, s17, s29
  s_waitcnt vmcnt(28)
  ds_read_b64_tr_b16 a[128:129], v146 offset:0
  ds_read_b64_tr_b16 a[130:131], v147 offset:0
  ds_read_b64_tr_b16 a[132:133], v146 offset:64
  ds_read_b64_tr_b16 a[134:135], v147 offset:64
  ds_read_b64_tr_b16 a[136:137], v146 offset:2048
  ds_read_b64_tr_b16 a[138:139], v147 offset:2048
  ds_read_b64_tr_b16 a[140:141], v146 offset:2112
  ds_read_b64_tr_b16 a[142:143], v147 offset:2112
  s_waitcnt lgkmcnt(0)
  s_waitcnt vmcnt(24)
  ds_read_b64_tr_b16 a[144:145], v146 offset:4096
  ds_read_b64_tr_b16 a[146:147], v147 offset:4096
  ds_read_b64_tr_b16 a[148:149], v146 offset:4160
  ds_read_b64_tr_b16 a[150:151], v147 offset:4160
  ds_read_b64_tr_b16 a[152:153], v146 offset:6144
  ds_read_b64_tr_b16 a[154:155], v147 offset:6144
  ds_read_b64_tr_b16 a[156:157], v146 offset:6208
  ds_read_b64_tr_b16 a[158:159], v147 offset:6208
  s_waitcnt lgkmcnt(0)
  s_waitcnt vmcnt(20)
  ds_read_b64_tr_b16 a[160:161], v146 offset:8192
  ds_read_b64_tr_b16 a[162:163], v147 offset:8192
  ds_read_b64_tr_b16 a[164:165], v146 offset:8256
  ds_read_b64_tr_b16 a[166:167], v147 offset:8256
  ds_read_b64_tr_b16 a[168:169], v146 offset:10240
  ds_read_b64_tr_b16 a[170:171], v147 offset:10240
  ds_read_b64_tr_b16 a[172:173], v146 offset:10304
  ds_read_b64_tr_b16 a[174:175], v147 offset:10304
  s_waitcnt lgkmcnt(0)
  s_waitcnt vmcnt(16)
  ds_read_b64_tr_b16 a[176:177], v146 offset:12288
  ds_read_b64_tr_b16 a[178:179], v147 offset:12288
  ds_read_b64_tr_b16 a[180:181], v146 offset:12352
  ds_read_b64_tr_b16 a[182:183], v147 offset:12352
  ds_read_b64_tr_b16 a[184:185], v146 offset:14336
  ds_read_b64_tr_b16 a[186:187], v147 offset:14336
  ds_read_b64_tr_b16 a[188:189], v146 offset:14400
  ds_read_b64_tr_b16 a[190:191], v147 offset:14400
  s_waitcnt lgkmcnt(0)
  s_waitcnt vmcnt(12)
  ds_read_b64_tr_b16 a[192:193], v146 offset:16384
  ds_read_b64_tr_b16 a[194:195], v147 offset:16384
  ds_read_b64_tr_b16 a[196:197], v146 offset:16448
  ds_read_b64_tr_b16 a[198:199], v147 offset:16448
  ds_read_b64_tr_b16 a[200:201], v146 offset:18432
  ds_read_b64_tr_b16 a[202:203], v147 offset:18432
  ds_read_b64_tr_b16 a[204:205], v146 offset:18496
  ds_read_b64_tr_b16 a[206:207], v147 offset:18496
  s_waitcnt lgkmcnt(0)
  s_waitcnt vmcnt(8)
  ds_read_b64_tr_b16 a[208:209], v146 offset:20480
  ds_read_b64_tr_b16 a[210:211], v147 offset:20480
  ds_read_b64_tr_b16 a[212:213], v146 offset:20544
  ds_read_b64_tr_b16 a[214:215], v147 offset:20544
  ds_read_b64_tr_b16 a[216:217], v146 offset:22528
  ds_read_b64_tr_b16 a[218:219], v147 offset:22528
  ds_read_b64_tr_b16 a[220:221], v146 offset:22592
  ds_read_b64_tr_b16 a[222:223], v147 offset:22592
  s_waitcnt lgkmcnt(0)
  s_waitcnt vmcnt(4)
  ds_read_b64_tr_b16 a[224:225], v146 offset:24576
  ds_read_b64_tr_b16 a[226:227], v147 offset:24576
  ds_read_b64_tr_b16 a[228:229], v146 offset:24640
  ds_read_b64_tr_b16 a[230:231], v147 offset:24640
  ds_read_b64_tr_b16 a[232:233], v146 offset:26624
  ds_read_b64_tr_b16 a[234:235], v147 offset:26624
  ds_read_b64_tr_b16 a[236:237], v146 offset:26688
  ds_read_b64_tr_b16 a[238:239], v147 offset:26688
  s_waitcnt lgkmcnt(0)
  s_waitcnt vmcnt(0)
  ds_read_b64_tr_b16 a[240:241], v146 offset:28672
  ds_read_b64_tr_b16 a[242:243], v147 offset:28672
  ds_read_b64_tr_b16 a[244:245], v146 offset:28736
  ds_read_b64_tr_b16 a[246:247], v147 offset:28736
  ds_read_b64_tr_b16 a[248:249], v146 offset:30720
  ds_read_b64_tr_b16 a[250:251], v147 offset:30720
  ds_read_b64_tr_b16 a[252:253], v146 offset:30784
  ds_read_b64_tr_b16 a[254:255], v147 offset:30784
  s_waitcnt lgkmcnt(0)
  s_lshl_b32 s26, s48, 2
  s_add_u32 s26, s26, s16
  s_lshl_b32 s27, s26, 6
  s_add_u32 s27, s27, s50
  s_lshl_b32 s19, s27, 13
  s_lshl_b32 s27, s50, 5
  s_add_u32 s27, s27, s26
  s_mul_i32 s27, s27, 4096
  s_add_u32 s20, s27, 135266304
  s_lshl_b32 s25, s16, 12
  s_add_u32 s25, s25, 65536
  s_lshl_b32 s26, s16, 13
  v_add_u32 v3, s26, v2
  v_lshrrev_b32 v16, 5, v1
  v_and_b32 v17, 31, v1
  v_bfe_u32 v18, v1, 4, 1
  v_lshl_add_u32 v18, v18, 1, v16
  v_and_b32 v19, 15, v1
  v_lshl_add_u32 v18, v18, 4, v19
  v_lshl_add_u32 v5, v18, 4, s25
  v_bfe_u32 v18, v1, 2, 2
  v_lshl_add_u32 v18, v16, 2, v18
  v_and_b32 v19, 1, v1
  v_lshl_add_u32 v18, v19, 4, v18
  v_lshl_add_u32 v4, v18, 4, s25
  v_lshlrev_b32 v16, 2, v16
  v_sub_u32 v17, v17, v16
  v_mov_b32 v18, 0xf149f2ca
  v_cmp_le_i32 vcc, 0, v17
  s_nop 1
  v_cndmask_b32 v240, v18, 0, vcc
  v_cmp_le_i32 vcc, 1, v17
  s_nop 1
  v_cndmask_b32 v241, v18, 0, vcc
  v_cmp_le_i32 vcc, 2, v17
  s_nop 1
  v_cndmask_b32 v242, v18, 0, vcc
  v_cmp_le_i32 vcc, 3, v17
  s_nop 1
  v_cndmask_b32 v243, v18, 0, vcc
  v_cmp_le_i32 vcc, 8, v17
  s_nop 1
  v_cndmask_b32 v244, v18, 0, vcc
  v_cmp_le_i32 vcc, 9, v17
  s_nop 1
  v_cndmask_b32 v245, v18, 0, vcc
  v_cmp_le_i32 vcc, 10, v17
  s_nop 1
  v_cndmask_b32 v246, v18, 0, vcc
  v_cmp_le_i32 vcc, 11, v17
  s_nop 1
  v_cndmask_b32 v247, v18, 0, vcc
  v_cmp_le_i32 vcc, 16, v17
  s_nop 1
  v_cndmask_b32 v248, v18, 0, vcc
  v_cmp_le_i32 vcc, 17, v17
  s_nop 1
  v_cndmask_b32 v249, v18, 0, vcc
  v_cmp_le_i32 vcc, 18, v17
  s_nop 1
  v_cndmask_b32 v250, v18, 0, vcc
  v_cmp_le_i32 vcc, 19, v17
  s_nop 1
  v_cndmask_b32 v251, v18, 0, vcc
  v_cmp_le_i32 vcc, 24, v17
  s_nop 1
  v_cndmask_b32 v252, v18, 0, vcc
  v_cmp_le_i32 vcc, 25, v17
  s_nop 1
  v_cndmask_b32 v253, v18, 0, vcc
  v_cmp_le_i32 vcc, 26, v17
  s_nop 1
  v_cndmask_b32 v254, v18, 0, vcc
  v_cmp_le_i32 vcc, 27, v17
  s_nop 1
  v_cndmask_b32 v255, v18, 0, vcc
  v_mov_b32 v21, v2
  s_barrier
  s_lshl_b32 s77, s48, 2
  s_add_u32 s77, s77, s16
  s_mul_i32 s78, s77, 896
  s_add_u32 s76, s78, 148898304
  s_mov_b32 s71, 0
  s_branch M_sg_55
M_sw_54:
  s_sleep 8
  s_add_u32 s71, s71, 1
  s_cmp_gt_u32 s71, 262144
  s_cbranch_scc1 M_exit
M_sg_55:
  s_mov_b32 s79, 0
  s_atomic_or s79, s[72:73], s76 glc
  s_waitcnt lgkmcnt(0)
  s_cmp_lt_u32 s79, 16
  s_cbranch_scc1 M_sw_54
  s_add_u32 s76, s78, 148898048
  s_mov_b32 s71, 0
  s_branch M_sg_57
M_sw_56:
  s_sleep 8
  s_add_u32 s71, s71, 1
  s_cmp_gt_u32 s71, 262144
  s_cbranch_scc1 M_exit
M_sg_57:
  s_mov_b32 s79, 0
  s_atomic_or s79, s[72:73], s76 glc
  s_waitcnt lgkmcnt(0)
  s_cmp_lt_u32 s79, 16
  s_cbranch_scc1 M_sw_56
M_xok_53:
  s_lshl_b32 s77, s77, 7
  s_add_u32 s54, s77, 148926464
  s_add_u32 s52, s50, 1
  s_mov_b32 s53, 0
  s_mov_b32 s30, 0x200
  s_add_u32 s28, s19, 50331648
  buffer_load_dwordx4 v[144:147], v21, s[4:7], s28 offen offset:0 sc1
  buffer_load_dwordx4 v[148:151], v21, s[4:7], s28 offen offset:1024 sc1
  buffer_load_dwordx4 v[152:155], v21, s[4:7], s28 offen offset:2048 sc1
  buffer_load_dwordx4 v[156:159], v21, s[4:7], s28 offen offset:3072 sc1
  s_add_u32 s29, s19, 50335744
  buffer_load_dwordx4 v[160:163], v21, s[4:7], s29 offen offset:0 sc1
  buffer_load_dwordx4 v[164:167], v21, s[4:7], s29 offen offset:1024 sc1
  buffer_load_dwordx4 v[168:171], v21, s[4:7], s29 offen offset:2048 sc1
  buffer_load_dwordx4 v[172:175], v21, s[4:7], s29 offen offset:3072 sc1
  s_add_u32 s28, s19, 67108864
  buffer_load_dwordx4 v[176:179], v21, s[4:7], s28 offen offset:0 sc1
  buffer_load_dwordx4 v[180:183], v21, s[4:7], s28 offen offset:1024 sc1
  buffer_load_dwordx4 v[184:187], v21, s[4:7], s28 offen offset:2048 sc1
  buffer_load_dwordx4 v[188:191], v21, s[4:7], s28 offen offset:3072 sc1
  s_add_u32 s29, s19, 67112960
  buffer_load_dwordx4 v[192:195], v21, s[4:7], s29 offen offset:0 sc1
  buffer_load_dwordx4 v[196:199], v21, s[4:7], s29 offen offset:1024 sc1
  buffer_load_dwordx4 v[200:203], v21, s[4:7], s29 offen offset:2048 sc1
  buffer_load_dwordx4 v[204:207], v21, s[4:7], s29 offen offset:3072 sc1
  s_add_u32 s28, s19, 83886080
  buffer_load_dwordx4 v[208:211], v21, s[4:7], s28 offen offset:0 sc1
  buffer_load_dwordx4 v[212:215], v21, s[4:7], s28 offen offset:1024 sc1
  buffer_load_dwordx4 v[216:219], v21, s[4:7], s28 offen offset:2048 sc1
  buffer_load_dwordx4 v[220:223], v21, s[4:7], s28 offen offset:3072 sc1
  s_add_u32 s29, s19, 83890176
  buffer_load_dwordx4 v[224:227], v21, s[4:7], s29 offen offset:0 sc1
  buffer_load_dwordx4 v[228:231], v21, s[4:7], s29 offen offset:1024 sc1
  buffer_load_dwordx4 v[232:235], v21, s[4:7], s29 offen offset:2048 sc1
  buffer_load_dwordx4 v[236:239], v21, s[4:7], s29 offen offset:3072 sc1
  s_mov_b32 s24, 0
  v_mov_b32 v22, 0x40000000
  s_sub_u32 s21, s21, s22
F_top_58:
  s_waitcnt vmcnt(8)
  v_mfma_f32_32x32x16_bf16 v[24:39], v[176:179], v[144:147], v[240:255]
  s_nop 1
  v_cvt_pk_bf16_f32 v128, v64, v65
  v_cvt_pk_bf16_f32 v129, v66, v67
  v_cvt_pk_bf16_f32 v130, v68, v69
  v_cvt_pk_bf16_f32 v131, v70, v71
  v_mfma_f32_32x32x16_bf16 v[24:39], v[180:183], v[148:151], v[24:39]
  buffer_store_dwordx4 v[128:131], v22, s[4:7], s21 offen offset:0 sc1
  v_mfma_f32_32x32x16_bf16 v[24:39], v[184:187], v[152:155], v[24:39]
  v_cvt_pk_bf16_f32 v132, v72, v73
  v_cvt_pk_bf16_f32 v133, v74, v75
  v_cvt_pk_bf16_f32 v134, v76, v77
  v_cvt_pk_bf16_f32 v135, v78, v79
  v_mfma_f32_32x32x16_bf16 v[24:39], v[188:191], v[156:159], v[24:39]
  buffer_store_dwordx4 v[132:135], v22, s[4:7], s21 offen offset:1024 sc1
  v_mfma_f32_32x32x16_bf16 v[24:39], v[192:195], v[160:163], v[24:39]
  v_cvt_pk_bf16_f32 v136, v80, v81
  v_cvt_pk_bf16_f32 v137, v82, v83
  v_cvt_pk_bf16_f32 v138, v84, v85
  v_cvt_pk_bf16_f32 v139, v86, v87
  v_mfma_f32_32x32x16_bf16 v[24:39], v[196:199], v[164:167], v[24:39]
  buffer_store_dwordx4 v[136:139], v22, s[4:7], s21 offen offset:2048 sc1
  v_mfma_f32_32x32x16_bf16 v[24:39], v[200:203], v[168:171], v[24:39]
  v_cvt_pk_bf16_f32 v140, v88, v89
  v_cvt_pk_bf16_f32 v141, v90, v91
  v_cvt_pk_bf16_f32 v142, v92, v93
  v_cvt_pk_bf16_f32 v143, v94, v95
  v_mfma_f32_32x32x16_bf16 v[24:39], v[204:207], v[172:175], v[24:39]
  buffer_store_dwordx4 v[140:143], v22, s[4:7], s21 offen offset:3072 sc1
  s_add_u32 s21, s21, s22
  v_mov_b32 v22, v2
  s_cmp_lg_u32 s24, 0
  s_cbranch_scc1 F_have_59
  s_cmp_le_u32 s52, 58
  s_cbranch_scc1 M_dp_60
  s_mov_b32 s71, 0
  v_add_u32 v16, s25, v2
  s_branch M_dp_62
M_dp_61:
  s_sleep 1
  s_add_u32 s71, s71, 1
  s_cmp_gt_u32 s71, 262144
  s_cbranch_scc1 M_exit
M_dp_62:
  buffer_load_dword v23, off, s[4:7], s54 sc1
  buffer_load_dwordx4 v[96:99], v2, s[4:7], s20 offen offset:0 sc1
  buffer_load_dwordx4 v[100:103], v2, s[4:7], s20 offen offset:1024 sc1
  buffer_load_dwordx4 v[104:107], v2, s[4:7], s20 offen offset:2048 sc1
  buffer_load_dwordx4 v[108:111], v2, s[4:7], s20 offen offset:3072 sc1
  s_waitcnt vmcnt(3)
  v_max_u32 v17, v96, v97
  v_max3_u32 v17, v17, v98, v99
  s_waitcnt vmcnt(2)
  v_max3_u32 v17, v17, v100, v101
  v_max3_u32 v17, v17, v102, v103
  s_waitcnt vmcnt(1)
  v_max3_u32 v17, v17, v104, v105
  v_max3_u32 v17, v17, v106, v107
  s_waitcnt vmcnt(0)
  v_max3_u32 v17, v17, v108, v109
  v_max3_u32 v17, v17, v110, v111
  v_cmp_eq_u32 vcc, -1, v17
  s_cbranch_vccz M_dp_63
  v_cmp_gt_u32 vcc, s52, v23
  s_cbranch_vccnz M_dp_61
  s_branch M_dp_60
M_dp_63:
  ds_write_b128 v16, v[96:99] offset:0
  ds_write_b128 v16, v[100:103] offset:1024
  ds_write_b128 v16, v[104:107] offset:2048
  ds_write_b128 v16, v[108:111] offset:3072
  s_branch F_have_59
M_dp_60:
  v_mov_b32 v16, s54
  v_mov_b32 v17, s52
  s_mov_b32 s71, 0
  s_branch M_vg_65
M_vw_64:
  s_sleep 2
  s_add_u32 s71, s71, 1
  s_cmp_gt_u32 s71, 262144
  s_cbranch_scc1 M_exit
M_vg_65:
  buffer_load_dword v23, v16, s[4:7], 0 offen sc1
  s_waitcnt vmcnt(0)
  v_cmp_lt_u32 vcc, v23, v17
  s_cbranch_vccnz M_vw_64
  s_mov_b32 m0, s25
  s_nop 0
  buffer_load_dwordx4 v2, s[4:7], s20 offen offset:0 sc1 lds
  buffer_load_dwordx4 v2, s[4:7], s20 offen offset:1024 sc1 lds
  buffer_load_dwordx4 v2, s[4:7], s20 offen offset:2048 sc1 lds
  buffer_load_dwordx4 v2, s[4:7], s20 offen offset:3072 sc1 lds
  s_waitcnt vmcnt(0)
F_have_59:
  ds_read_b64_tr_b16 v[176:177], v4 offset:8
  ds_read_b64_tr_b16 v[178:179], v4 offset:136
  ds_read_b64_tr_b16 v[180:181], v4 offset:520
  ds_read_b64_tr_b16 v[182:183], v4 offset:648
  ds_read_b64_tr_b16 v[184:185], v4 offset:1032
  ds_read_b64_tr_b16 v[186:187], v4 offset:1160
  ds_read_b64_tr_b16 v[188:189], v4 offset:1544
  ds_read_b64_tr_b16 v[190:191], v4 offset:1672
  ds_read_b64_tr_b16 v[192:193], v4 offset:2056
  ds_read_b64_tr_b16 v[194:195], v4 offset:2184
  ds_read_b64_tr_b16 v[196:197], v4 offset:2568
  ds_read_b64_tr_b16 v[198:199], v4 offset:2696
  s_sub_u32 s23, s23, 1
  s_cmp_gt_u32 s23, 0
  s_cselect_b32 s26, s51, 0
  s_cselect_b32 s27, 0, 0x40000000
  v_or_b32 v21, s27, v21
  s_lshl_b32 s27, s26, 13
  s_add_u32 s19, s19, s27
  s_mul_i32 s27, s26, 131072
  s_add_u32 s20, s20, s27
  s_cmp_lg_u32 s23, 24
  s_cbranch_scc1 M_xok_66
  s_lshl_b32 s77, s48, 2
  s_add_u32 s77, s77, s16
  s_mul_i32 s78, s77, 896
  s_add_u32 s76, s78, 148898304
  s_mov_b32 s71, 0
  s_branch M_sg_68
M_sw_67:
  s_sleep 8
  s_add_u32 s71, s71, 1
  s_cmp_gt_u32 s71, 262144
  s_cbranch_scc1 M_exit
M_sg_68:
  s_mov_b32 s79, 0
  s_atomic_or s79, s[72:73], s76 glc
  s_waitcnt lgkmcnt(0)
  s_cmp_lt_u32 s79, 32
  s_cbranch_scc1 M_sw_67
  s_add_u32 s76, s78, 148898432
  s_mov_b32 s71, 0
  s_branch M_sg_70
M_sw_69:
  s_sleep 8
  s_add_u32 s71, s71, 1
  s_cmp_gt_u32 s71, 262144
  s_cbranch_scc1 M_exit
M_sg_70:
  s_mov_b32 s79, 0
  s_atomic_or s79, s[72:73], s76 glc
  s_waitcnt lgkmcnt(0)
  s_cmp_lt_u32 s79, 32
  s_cbranch_scc1 M_sw_69
  s_add_u32 s76, s78, 148898048
  s_mov_b32 s71, 0
  s_branch M_sg_72
M_sw_71:
  s_sleep 8
  s_add_u32 s71, s71, 1
  s_cmp_gt_u32 s71, 262144
  s_cbranch_scc1 M_exit
M_sg_72:
  s_mov_b32 s79, 0
  s_atomic_or s79, s[72:73], s76 glc
  s_waitcnt lgkmcnt(0)
  s_cmp_lt_u32 s79, 30
  s_cbranch_scc1 M_sw_71
  s_add_u32 s76, s78, 148898176
  s_mov_b32 s71, 0
  s_branch M_sg_74
M_sw_73:
  s_sleep 8
  s_add_u32 s71, s71, 1
  s_cmp_gt_u32 s71, 262144
  s_cbranch_scc1 M_exit
M_sg_74:
  s_mov_b32 s79, 0
  s_atomic_or s79, s[72:73], s76 glc
  s_waitcnt lgkmcnt(0)
  s_cmp_lt_u32 s79, 34
  s_cbranch_scc1 M_sw_73
M_xok_66:
  s_waitcnt lgkmcnt(10)
  v_mfma_f32_32x32x16_bf16 v[40:55], v[176:179], v[144:147], 0
  ds_read_b64_tr_b16 v[200:201], v4 offset:3080
  ds_read_b64_tr_b16 v[202:203], v4 offset:3208
  v_max_f32 v6, v24, v25
  s_waitcnt lgkmcnt(10)
  v_mfma_f32_32x32x16_bf16 v[40:55], v[180:183], v[148:151], v[40:55]
  ds_read_b64_tr_b16 v[204:205], v4 offset:3592
  ds_read_b64_tr_b16 v[206:207], v4 offset:3720
  v_max3_f32 v6, v6, v26, v27
  s_waitcnt lgkmcnt(10)
  v_mfma_f32_32x32x16_bf16 v[40:55], v[184:187], v[152:155], v[40:55]
  ds_read_b64 v[56:57], v5 offset:0
  ds_read_b64 v[58:59], v5 offset:1024
  v_max3_f32 v6, v6, v28, v29
  s_waitcnt lgkmcnt(10)
  v_mfma_f32_32x32x16_bf16 v[40:55], v[188:191], v[156:159], v[40:55]
  ds_read_b64 v[60:61], v5 offset:2048
  ds_read_b64 v[62:63], v5 offset:3072
  v_max3_f32 v6, v6, v30, v31
  s_waitcnt lgkmcnt(10)
  v_mfma_f32_32x32x16_bf16 v[40:55], v[192:195], v[160:163], v[40:55]
  v_max3_f32 v6, v6, v32, v33
  s_waitcnt lgkmcnt(8)
  v_mfma_f32_32x32x16_bf16 v[40:55], v[196:199], v[164:167], v[40:55]
  v_max3_f32 v6, v6, v34, v35
  s_waitcnt lgkmcnt(6)
  v_mfma_f32_32x32x16_bf16 v[40:55], v[200:203], v[168:171], v[40:55]
  v_max3_f32 v6, v6, v36, v37
  s_waitcnt lgkmcnt(4)
  v_mfma_f32_32x32x16_bf16 v[40:55], v[204:207], v[172:175], v[40:55]
  v_max3_f32 v6, v6, v38, v39
  s_add_u32 s28, s19, 50331648
  buffer_load_dwordx4 v[144:147], v21, s[4:7], s28 offen offset:0 sc1
  buffer_load_dwordx4 v[148:151], v21, s[4:7], s28 offen offset:1024 sc1
  s_nop 7
  v_max3_f32 v6, v6, v40, v41
  v_max3_f32 v6, v6, v42, v43
  v_mov_b32 v16, v6
  s_nop 1
  v_permlane32_swap_b32 v6, v16
  s_nop 1
  v_max_f32 v6, v6, v16
  v_pk_add_f32 v[24:25], v[24:25], v[6:7] op_sel_hi:[1,0] neg_lo:[0,1] neg_hi:[0,1]
  v_pk_add_f32 v[26:27], v[26:27], v[6:7] op_sel_hi:[1,0] neg_lo:[0,1] neg_hi:[0,1]
  v_pk_add_f32 v[28:29], v[28:29], v[6:7] op_sel_hi:[1,0] neg_lo:[0,1] neg_hi:[0,1]
  v_pk_add_f32 v[30:31], v[30:31], v[6:7] op_sel_hi:[1,0] neg_lo:[0,1] neg_hi:[0,1]
  v_pk_add_f32 v[32:33], v[32:33], v[6:7] op_sel_hi:[1,0] neg_lo:[0,1] neg_hi:[0,1]
  v_pk_add_f32 v[34:35], v[34:35], v[6:7] op_sel_hi:[1,0] neg_lo:[0,1] neg_hi:[0,1]
  v_pk_add_f32 v[36:37], v[36:37], v[6:7] op_sel_hi:[1,0] neg_lo:[0,1] neg_hi:[0,1]
  v_pk_add_f32 v[38:39], v[38:39], v[6:7] op_sel_hi:[1,0] neg_lo:[0,1] neg_hi:[0,1]
  v_pk_add_f32 v[40:41], v[40:41], v[6:7] op_sel_hi:[1,0] neg_lo:[0,1] neg_hi:[0,1]
  v_pk_add_f32 v[42:43], v[42:43], v[6:7] op_sel_hi:[1,0] neg_lo:[0,1] neg_hi:[0,1]
  v_exp_f32 v24, v24
  v_exp_f32 v25, v25
  v_exp_f32 v26, v26
  v_exp_f32 v27, v27
  v_exp_f32 v28, v28
  v_exp_f32 v29, v29
  v_exp_f32 v30, v30
  v_exp_f32 v31, v31
  v_exp_f32 v32, v32
  v_exp_f32 v33, v33
  buffer_load_dwordx4 v[152:155], v21, s[4:7], s28 offen offset:2048 sc1
  v_exp_f32 v34, v34
  v_exp_f32 v35, v35
  v_exp_f32 v36, v36
  v_exp_f32 v37, v37
  v_exp_f32 v38, v38
  v_exp_f32 v39, v39
  v_exp_f32 v40, v40
  v_exp_f32 v41, v41
  v_exp_f32 v42, v42
  v_exp_f32 v43, v43
  v_pk_add_f32 v[16:17], v[24:25], v[26:27]
  v_pk_add_f32 v[16:17], v[16:17], v[28:29]
  v_pk_add_f32 v[16:17], v[16:17], v[30:31]
  v_pk_add_f32 v[16:17], v[16:17], v[32:33]
  v_pk_add_f32 v[16:17], v[16:17], v[34:35]
  v_pk_add_f32 v[16:17], v[16:17], v[36:37]
  v_pk_add_f32 v[16:17], v[16:17], v[38:39]
  v_pk_add_f32 v[16:17], v[16:17], v[40:41]
  v_pk_add_f32 v[16:17], v[16:17], v[42:43]
  v_add_f32 v16, v16, v17
  v_mov_b32 v17, v16
  buffer_load_dwordx4 v[156:159], v21, s[4:7], s28 offen offset:3072 sc1
  s_nop 0
  v_permlane32_swap_b32 v16, v17
  s_nop 1
  v_add_f32 v16, v16, v17
  v_rcp_f32 v6, v16
  s_nop 0
  v_pk_mul_f32 v[24:25], v[24:25], v[6:7] op_sel_hi:[1,0]
  v_pk_mul_f32 v[26:27], v[26:27], v[6:7] op_sel_hi:[1,0]
  v_pk_mul_f32 v[28:29], v[28:29], v[6:7] op_sel_hi:[1,0]
  v_pk_mul_f32 v[30:31], v[30:31], v[6:7] op_sel_hi:[1,0]
  v_pk_mul_f32 v[32:33], v[32:33], v[6:7] op_sel_hi:[1,0]
  v_pk_mul_f32 v[34:35], v[34:35], v[6:7] op_sel_hi:[1,0]
  v_pk_mul_f32 v[36:37], v[36:37], v[6:7] op_sel_hi:[1,0]
  v_pk_mul_f32 v[38:39], v[38:39], v[6:7] op_sel_hi:[1,0]
  v_pk_mul_f32 v[40:41], v[40:41], v[6:7] op_sel_hi:[1,0]
  v_pk_mul_f32 v[42:43], v[42:43], v[6:7] op_sel_hi:[1,0]
  v_cvt_pk_bf16_f32 v128, v24, v25
  v_cvt_pk_bf16_f32 v129, v26, v27
  v_cvt_pk_bf16_f32 v130, v28, v29
  v_cvt_pk_bf16_f32 v131, v30, v31
  v_cvt_pk_bf16_f32 v132, v32, v33
  v_cvt_pk_bf16_f32 v133, v34, v35
  v_cvt_pk_bf16_f32 v134, v36, v37
  v_cvt_pk_bf16_f32 v135, v38, v39
  v_cvt_pk_bf16_f32 v136, v40, v41
  v_cvt_pk_bf16_f32 v137, v42, v43
  s_waitcnt vmcnt(8) lgkmcnt(0)
  v_mfma_f32_32x32x16_bf16 v[64:79], v[208:211], v[128:131], 0
  s_add_u32 s29, s19, 50335744
  buffer_load_dwordx4 v[160:163], v21, s[4:7], s29 offen offset:0 sc1
  v_mfma_f32_32x32x16_bf16 v[64:79], v[212:215], v[132:135], v[64:79]
  v_mfma_f32_32x32x8_bf16 v[64:79], v[56:57], v[136:137], v[64:79]
  v_mfma_f32_32x32x16_bf16 v[80:95], v[216:219], v[128:131], 0
  buffer_load_dwordx4 v[164:167], v21, s[4:7], s29 offen offset:1024 sc1
  v_mfma_f32_32x32x16_bf16 v[80:95], v[220:223], v[132:135], v[80:95]
  v_cvt_pk_bf16_f32 v24, v64, v65
  v_cvt_pk_bf16_f32 v25, v66, v67
  v_cvt_pk_bf16_f32 v26, v68, v69
  v_cvt_pk_bf16_f32 v27, v70, v71
  v_mfma_f32_32x32x8_bf16 v[80:95], v[58:59], v[136:137], v[80:95]
  ds_write_b128 v3, v[24:27] offset:0
  v_cvt_pk_bf16_f32 v28, v72, v73
  v_cvt_pk_bf16_f32 v29, v74, v75
  v_cvt_pk_bf16_f32 v30, v76, v77
  v_cvt_pk_bf16_f32 v31, v78, v79
  v_mfma_f32_32x32x16_bf16 v[96:111], v[224:227], v[128:131], 0
  ds_write_b128 v3, v[28:31] offset:1024
  buffer_load_dwordx4 v[168:171], v21, s[4:7], s29 offen offset:2048 sc1
  v_mfma_f32_32x32x16_bf16 v[96:111], v[228:231], v[132:135], v[96:111]
  v_cvt_pk_bf16_f32 v32, v80, v81
  v_cvt_pk_bf16_f32 v33, v82, v83
  v_cvt_pk_bf16_f32 v34, v84, v85
  v_cvt_pk_bf16_f32 v35, v86, v87
  v_mfma_f32_32x32x8_bf16 v[96:111], v[60:61], v[136:137], v[96:111]
  ds_write_b128 v3, v[32:35] offset:2048
  v_cvt_pk_bf16_f32 v36, v88, v89
  v_cvt_pk_bf16_f32 v37, v90, v91
  v_cvt_pk_bf16_f32 v38, v92, v93
  v_cvt_pk_bf16_f32 v39, v94, v95
  v_mfma_f32_32x32x16_bf16 v[112:127], v[232:235], v[128:131], 0
  ds_write_b128 v3, v[36:39] offset:3072
  buffer_load_dwordx4 v[172:175], v21, s[4:7], s29 offen offset:3072 sc1
  v_mfma_f32_32x32x16_bf16 v[112:127], v[236:239], v[132:135], v[112:127]
  v_cvt_pk_bf16_f32 v40, v96, v97
  v_cvt_pk_bf16_f32 v41, v98, v99
  v_cvt_pk_bf16_f32 v42, v100, v101
  v_cvt_pk_bf16_f32 v43, v102, v103
  v_mfma_f32_32x32x8_bf16 v[112:127], v[62:63], v[136:137], v[112:127]
  ds_write_b128 v3, v[40:43] offset:4096
  v_cvt_pk_bf16_f32 v44, v104, v105
  v_cvt_pk_bf16_f32 v45, v106, v107
  v_cvt_pk_bf16_f32 v46, v108, v109
  v_cvt_pk_bf16_f32 v47, v110, v111
  ds_write_b128 v3, v[44:47] offset:5120
  s_nop 5
  v_cvt_pk_bf16_f32 v48, v112, v113
  v_cvt_pk_bf16_f32 v49, v114, v115
  v_cvt_pk_bf16_f32 v50, v116, v117
  v_cvt_pk_bf16_f32 v51, v118, v119
  ds_write_b128 v3, v[48:51] offset:6144
  v_cvt_pk_bf16_f32 v52, v120, v121
  v_cvt_pk_bf16_f32 v53, v122, v123
  v_cvt_pk_bf16_f32 v54, v124, v125
  v_cvt_pk_bf16_f32 v55, v126, v127
  ds_write_b128 v3, v[52:55] offset:7168
  s_waitcnt vmcnt(8)
  s_waitcnt lgkmcnt(0)
  s_barrier
  ds_read_b128 v[24:27], v8 offset:0
  ds_read_b128 v[28:31], v9 offset:0
  ds_read_b128 v[32:35], v10 offset:0
  ds_read_b128 v[36:39], v11 offset:0
  ds_read_b128 v[40:43], v12 offset:0
  ds_read_b128 v[44:47], v13 offset:0
  buffer_load_dword v23, off, s[4:7], s54 sc1
  v_mov_b32 v16, s30
  v_min_u32 v17, 1, v0
  v_lshlrev_b32 v17, 30, v17
  buffer_store_dword v16, v17, s[4:7], s31 offen sc1
  s_add_u32 s30, s30, 1
  s_add_u32 s52, s52, 2
  s_waitcnt lgkmcnt(5)
  v_mfma_f32_32x32x16_bf16 v[64:79], a[0:3], v[24:27], 0
  s_add_u32 s28, s19, 67108864
  ds_read_b128 v[48:51], v14 offset:0
  v_mfma_f32_32x32x16_bf16 v[80:95], a[4:7], v[24:27], 0
  s_waitcnt lgkmcnt(5)
  v_mfma_f32_32x32x16_bf16 v[64:79], a[8:11], v[28:31], v[64:79]
  ds_read_b128 v[52:55], v15 offset:0
  v_mfma_f32_32x32x16_bf16 v[80:95], a[12:15], v[28:31], v[80:95]
  s_waitcnt lgkmcnt(5)
  buffer_load_dwordx4 v[176:179], v21, s[4:7], s28 offen offset:0 sc1
  v_mfma_f32_32x32x16_bf16 v[64:79], a[16:19], v[32:35], v[64:79]
  ds_read_b128 v[24:27], v8 offset:8192
  v_mfma_f32_32x32x16_bf16 v[80:95], a[20:23], v[32:35], v[80:95]
  s_waitcnt lgkmcnt(5)
  v_mfma_f32_32x32x16_bf16 v[64:79], a[24:27], v[36:39], v[64:79]
  ds_read_b128 v[28:31], v9 offset:8192
  v_mfma_f32_32x32x16_bf16 v[80:95], a[28:31], v[36:39], v[80:95]
  s_waitcnt lgkmcnt(5)
  buffer_load_dwordx4 v[180:183], v21, s[4:7], s28 offen offset:1024 sc1
  v_mfma_f32_32x32x16_bf16 v[64:79], a[32:35], v[40:43], v[64:79]
  ds_read_b128 v[32:35], v10 offset:8192
  v_mfma_f32_32x32x16_bf16 v[80:95], a[36:39], v[40:43], v[80:95]
  s_waitcnt lgkmcnt(5)
  v_mfma_f32_32x32x16_bf16 v[64:79], a[40:43], v[44:47], v[64:79]
  ds_read_b128 v[36:39], v11 offset:8192
  v_mfma_f32_32x32x16_bf16 v[80:95], a[44:47], v[44:47], v[80:95]
  s_waitcnt lgkmcnt(5)
  buffer_load_dwordx4 v[184:187], v21, s[4:7], s28 offen offset:2048 sc1
  v_mfma_f32_32x32x16_bf16 v[64:79], a[48:51], v[48:51], v[64:79]
  ds_read_b128 v[40:43], v12 offset:8192
  v_mfma_f32_32x32x16_bf16 v[80:95], a[52:55], v[48:51], v[80:95]
  s_waitcnt lgkmcnt(5)
  v_mfma_f32_32x32x16_bf16 v[64:79], a[56:59], v[52:55], v[64:79]
  ds_read_b128 v[44:47], v13 offset:8192
  v_mfma_f32_32x32x16_bf16 v[80:95], a[60:63], v[52:55], v[80:95]
  s_waitcnt lgkmcnt(5)
  buffer_load_dwordx4 v[188:191], v21, s[4:7], s28 offen offset:3072 sc1
  v_mfma_f32_32x32x16_bf16 v[64:79], a[64:67], v[24:27], v[64:79]
  s_add_u32 s29, s19, 67112960
  ds_read_b128 v[48:51], v14 offset:8192
  v_mfma_f32_32x32x16_bf16 v[80:95], a[68:71], v[24:27], v[80:95]
  s_waitcnt lgkmcnt(5)
  v_mfma_f32_32x32x16_bf16 v[64:79], a[72:75], v[28:31], v[64:79]
  ds_read_b128 v[52:55], v15 offset:8192
  v_mfma_f32_32x32x16_bf16 v[80:95], a[76:79], v[28:31], v[80:95]
  s_waitcnt lgkmcnt(5)
  buffer_load_dwordx4 v[192:195], v21, s[4:7], s29 offen offset:0 sc1
  v_mfma_f32_32x32x16_bf16 v[64:79], a[80:83], v[32:35], v[64:79]
  ds_read_b128 v[24:27], v8 offset:16384
  v_mfma_f32_32x32x16_bf16 v[80:95], a[84:87], v[32:35], v[80:95]
  s_waitcnt lgkmcnt(5)
  v_mfma_f32_32x32x16_bf16 v[64:79], a[88:91], v[36:39], v[64:79]
  ds_read_b128 v[28:31], v9 offset:16384
  v_mfma_f32_32x32x16_bf16 v[80:95], a[92:95], v[36:39], v[80:95]
  s_waitcnt lgkmcnt(5)
  buffer_load_dwordx4 v[196:199], v21, s[4:7], s29 offen offset:1024 sc1
  v_mfma_f32_32x32x16_bf16 v[64:79], a[96:99], v[40:43], v[64:79]
  ds_read_b128 v[32:35], v10 offset:16384
  v_mfma_f32_32x32x16_bf16 v[80:95], a[100:103], v[40:43], v[80:95]
  s_waitcnt lgkmcnt(5)
  s_waitcnt vmcnt(7)
  v_readfirstlane_b32 s53, v23
  s_nop 0
  s_cmp_ge_u32 s53, s52
  s_cselect_b32 s24, 1, 0
  s_cbranch_scc0 F_nopre_75
  s_mov_b32 m0, s25
  s_nop 0
  buffer_load_dwordx4 v2, s[4:7], s20 offen offset:0 sc1 lds
  buffer_load_dwordx4 v2, s[4:7], s20 offen offset:1024 sc1 lds
  buffer_load_dwordx4 v2, s[4:7], s20 offen offset:2048 sc1 lds
  buffer_load_dwordx4 v2, s[4:7], s20 offen offset:3072 sc1 lds
F_nopre_75:
  v_mfma_f32_32x32x16_bf16 v[64:79], a[104:107], v[44:47], v[64:79]
  ds_read_b128 v[36:39], v11 offset:16384
  v_mfma_f32_32x32x16_bf16 v[80:95], a[108:111], v[44:47], v[80:95]
  s_waitcnt lgkmcnt(5)
  buffer_load_dwordx4 v[200:203], v21, s[4:7], s29 offen offset:2048 sc1
  v_mfma_f32_32x32x16_bf16 v[64:79], a[112:115], v[48:51], v[64:79]
  ds_read_b128 v[40:43], v12 offset:16384
  v_mfma_f32_32x32x16_bf16 v[80:95], a[116:119], v[48:51], v[80:95]
  s_waitcnt lgkmcnt(5)
  v_mfma_f32_32x32x16_bf16 v[64:79], a[120:123], v[52:55], v[64:79]
  ds_read_b128 v[44:47], v13 offset:16384
  v_mfma_f32_32x32x16_bf16 v[80:95], a[124:127], v[52:55], v[80:95]
  s_waitcnt lgkmcnt(5)
  buffer_load_dwordx4 v[204:207], v21, s[4:7], s29 offen offset:3072 sc1
  v_mfma_f32_32x32x16_bf16 v[64:79], a[128:131], v[24:27], v[64:79]
  s_add_u32 s28, s19, 83886080
  ds_read_b128 v[48:51], v14 offset:16384
  v_mfma_f32_32x32x16_bf16 v[80:95], a[132:135], v[24:27], v[80:95]
  s_waitcnt lgkmcnt(5)
  v_mfma_f32_32x32x16_bf16 v[64:79], a[136:139], v[28:31], v[64:79]
  ds_read_b128 v[52:55], v15 offset:16384
  v_mfma_f32_32x32x16_bf16 v[80:95], a[140:143], v[28:31], v[80:95]
  s_waitcnt lgkmcnt(5)
  buffer_load_dwordx4 v[208:211], v21, s[4:7], s28 offen offset:0 sc1
  v_mfma_f32_32x32x16_bf16 v[64:79], a[144:147], v[32:35], v[64:79]
  ds_read_b128 v[24:27], v8 offset:24576
  v_mfma_f32_32x32x16_bf16 v[80:95], a[148:151], v[32:35], v[80:95]
  s_waitcnt lgkmcnt(5)
  v_mfma_f32_32x32x16_bf16 v[64:79], a[152:155], v[36:39], v[64:79]
  ds_read_b128 v[28:31], v9 offset:24576
  v_mfma_f32_32x32x16_bf16 v[80:95], a[156:159], v[36:39], v[80:95]
  s_waitcnt lgkmcnt(5)
  buffer_load_dwordx4 v[212:215], v21, s[4:7], s28 offen offset:1024 sc1
  v_mfma_f32_32x32x16_bf16 v[64:79], a[160:163], v[40:43], v[64:79]
  ds_read_b128 v[32:35], v10 offset:24576
  v_mfma_f32_32x32x16_bf16 v[80:95], a[164:167], v[40:43], v[80:95]
  s_waitcnt lgkmcnt(5)
  v_mfma_f32_32x32x16_bf16 v[64:79], a[168:171], v[44:47], v[64:79]
  ds_read_b128 v[36:39], v11 offset:24576
  v_mfma_f32_32x32x16_bf16 v[80:95], a[172:175], v[44:47], v[80:95]
  s_waitcnt lgkmcnt(5)
  buffer_load_dwordx4 v[216:219], v21, s[4:7], s28 offen offset:2048 sc1
  v_mfma_f32_32x32x16_bf16 v[64:79], a[176:179], v[48:51], v[64:79]
  ds_read_b128 v[40:43], v12 offset:24576
  v_mfma_f32_32x32x16_bf16 v[80:95], a[180:183], v[48:51], v[80:95]
  s_waitcnt lgkmcnt(5)
  v_mfma_f32_32x32x16_bf16 v[64:79], a[184:187], v[52:55], v[64:79]
  ds_read_b128 v[44:47], v13 offset:24576
  v_mfma_f32_32x32x16_bf16 v[80:95], a[188:191], v[52:55], v[80:95]
  s_waitcnt lgkmcnt(5)
  buffer_load_dwordx4 v[220:223], v21, s[4:7], s28 offen offset:3072 sc1
  v_mfma_f32_32x32x16_bf16 v[64:79], a[192:195], v[24:27], v[64:79]
  s_add_u32 s29, s19, 83890176
  ds_read_b128 v[48:51], v14 offset:24576
  v_mfma_f32_32x32x16_bf16 v[80:95], a[196:199], v[24:27], v[80:95]
  s_waitcnt lgkmcnt(5)
  v_mfma_f32_32x32x16_bf16 v[64:79], a[200:203], v[28:31], v[64:79]
  ds_read_b128 v[52:55], v15 offset:24576
  v_mfma_f32_32x32x16_bf16 v[80:95], a[204:207], v[28:31], v[80:95]
  s_waitcnt lgkmcnt(5)
  buffer_load_dwordx4 v[224:227], v21, s[4:7], s29 offen offset:0 sc1
  v_mfma_f32_32x32x16_bf16 v[64:79], a[208:211], v[32:35], v[64:79]
  v_mfma_f32_32x32x16_bf16 v[80:95], a[212:215], v[32:35], v[80:95]
  s_waitcnt lgkmcnt(4)
  v_mfma_f32_32x32x16_bf16 v[64:79], a[216:219], v[36:39], v[64:79]
  v_xor_b32 v8, 0x8000, v8
  v_mfma_f32_32x32x16_bf16 v[80:95], a[220:223], v[36:39], v[80:95]
  s_waitcnt lgkmcnt(3)
  buffer_load_dwordx4 v[228:231], v21, s[4:7], s29 offen offset:1024 sc1
  v_xor_b32 v9, 0x8000, v9
  v_mfma_f32_32x32x16_bf16 v[64:79], a[224:227], v[40:43], v[64:79]
  v_xor_b32 v10, 0x8000, v10
  v_mfma_f32_32x32x16_bf16 v[80:95], a[228:231], v[40:43], v[80:95]
  s_waitcnt lgkmcnt(2)
  v_xor_b32 v11, 0x8000, v11
  v_mfma_f32_32x32x16_bf16 v[64:79], a[232:235], v[44:47], v[64:79]
  v_xor_b32 v12, 0x8000, v12
  v_mfma_f32_32x32x16_bf16 v[80:95], a[236:239], v[44:47], v[80:95]
  s_waitcnt lgkmcnt(1)
  buffer_load_dwordx4 v[232:235], v21, s[4:7], s29 offen offset:2048 sc1
  v_xor_b32 v13, 0x8000, v13
  v_mfma_f32_32x32x16_bf16 v[64:79], a[240:243], v[48:51], v[64:79]
  v_xor_b32 v14, 0x8000, v14
  v_mfma_f32_32x32x16_bf16 v[80:95], a[244:247], v[48:51], v[80:95]
  s_waitcnt lgkmcnt(0)
  v_xor_b32 v15, 0x8000, v15
  v_mfma_f32_32x32x16_bf16 v[64:79], a[248:251], v[52:55], v[64:79]
  v_xor_b32 v3, 0x8000, v3
  v_mfma_f32_32x32x16_bf16 v[80:95], a[252:255], v[52:55], v[80:95]
  buffer_load_dwordx4 v[236:239], v21, s[4:7], s29 offen offset:3072 sc1
  s_cmp_gt_u32 s23, 0
  s_cbranch_scc1 F_top_58
  s_nop 2
  v_cvt_pk_bf16_f32 v128, v64, v65
  v_cvt_pk_bf16_f32 v129, v66, v67
  v_cvt_pk_bf16_f32 v130, v68, v69
  v_cvt_pk_bf16_f32 v131, v70, v71
  buffer_store_dwordx4 v[128:131], v22, s[4:7], s21 offen offset:0 sc1
  v_cvt_pk_bf16_f32 v132, v72, v73
  v_cvt_pk_bf16_f32 v133, v74, v75
  v_cvt_pk_bf16_f32 v134, v76, v77
  v_cvt_pk_bf16_f32 v135, v78, v79
  buffer_store_dwordx4 v[132:135], v22, s[4:7], s21 offen offset:1024 sc1
  v_cvt_pk_bf16_f32 v136, v80, v81
  v_cvt_pk_bf16_f32 v137, v82, v83
  v_cvt_pk_bf16_f32 v138, v84, v85
  v_cvt_pk_bf16_f32 v139, v86, v87
  buffer_store_dwordx4 v[136:139], v22, s[4:7], s21 offen offset:2048 sc1
  v_cvt_pk_bf16_f32 v140, v88, v89
  v_cvt_pk_bf16_f32 v141, v90, v91
  v_cvt_pk_bf16_f32 v142, v92, v93
  v_cvt_pk_bf16_f32 v143, v94, v95
  buffer_store_dwordx4 v[140:143], v22, s[4:7], s21 offen offset:3072 sc1
  s_waitcnt vmcnt(0) lgkmcnt(0)
  s_barrier
  v_mov_b32 v144, s30
  v_min_u32 v145, 1, v0
  v_lshlrev_b32 v145, 30, v145
  buffer_store_dword v144, v145, s[4:7], s31 offen sc1
  s_branch M_done
M_team:
  s_mov_b32 s12, s77
  s_load_dwordx4 s[60:63], s[0:1], 64
  s_load_dwordx4 s[64:67], s[0:1], 80
  s_load_dwordx4 s[68:71], s[0:1], 120
  s_load_dwordx2 s[72:73], s[0:1], 56
  v_lshrrev_b32 v1, 6, v0
  v_and_b32 v20, 63, v0
  v_readfirstlane_b32 s13, v1
  s_waitcnt lgkmcnt(0)
  s_mov_b32 s8, s60
  s_and_b32 s9, s61, 0xffff
  s_mov_b32 s10, 0x400000
  s_mov_b32 s11, 0x20000
  s_mov_b32 s40, s62
  s_and_b32 s41, s63, 0xffff
  s_mov_b32 s42, 0x400000
  s_mov_b32 s43, 0x20000
  s_mov_b32 s44, s64
  s_and_b32 s45, s65, 0xffff
  s_mov_b32 s46, 0x400000
  s_mov_b32 s47, 0x20000
  s_mov_b32 s48, s66
  s_and_b32 s49, s67, 0xffff
  s_mov_b32 s50, 0x400000
  s_mov_b32 s51, 0x20000
  s_mov_b32 s4, s70
  s_and_b32 s5, s71, 0xffff
  s_mov_b32 s6, 0x10000000
  s_mov_b32 s7, 0x20000
  s_mov_b32 s76, s72
  s_and_b32 s77, s73, 0xffff
  s_mov_b32 s78, 0x2000
  s_mov_b32 s79, 0x20000
  s_mov_b32 s72, s68
  s_and_b32 s73, s69, 0xffff
  s_mov_b32 s74, 0x100
  s_mov_b32 s75, 0x20000
  s_mov_b64 s[52:53], s[68:69]
  s_mov_b64 s[58:59], s[70:71]
  s_mul_i32 s99, s12, 896
  s_add_u32 s99, s99, 148898048
  s_lshl_b32 s15, s12, 7
  s_add_u32 s15, s15, 148926464
  v_lshrrev_b32 v21, 4, v20
  v_and_b32 v22, 15, v20
  v_and_b32 v23, 1, v21
  v_lshrrev_b32 v24, 1, v21
  v_lshlrev_b32 v2, 4, v20
  s_lshl_b32 s36, s13, 10
  v_add_u32 v59, s36, v2
  s_lshl_b32 s37, s13, 15
  s_add_u32 s37, s37, 32768
  v_add_u32 v4, s37, v2
  v_lshrrev_b32 v25, 2, v20
  v_lshlrev_b32 v25, 13, v25
  v_and_b32 v1, 3, v20
  v_lshl_add_u32 v25, v1, 4, v25
  s_lshl_b32 s36, s13, 6
  s_lshl_b32 s38, s12, 8
  s_add_u32 s36, s36, s38
  v_add_u32 v25, s36, v25
  v_lshrrev_b32 v26, 3, v20
  v_lshlrev_b32 v26, 10, v26
  v_and_b32 v1, 7, v20
  v_lshl_add_u32 v26, v1, 4, v26
  s_lshl_b32 s36, s13, 7
  s_lshl_b32 s38, s12, 17
  s_add_u32 s36, s36, s38
  v_add_u32 v26, s36, v26
  v_bfe_u32 v29, v20, 2, 1
  v_bfe_u32 v30, v20, 3, 1
  v_and_b32 v31, 3, v20
  v_lshl_add_u32 v27, v21, 2, v29
  v_lshlrev_b32 v27, 6, v27
  v_lshl_add_u32 v27, v30, 5, v27
  v_lshl_add_u32 v27, v31, 3, v27
  v_add_u32 v27, s37, v27
  v_xor_b32 v36, 1, v30
  v_lshl_add_u32 v36, v36, 11, v27
  v_lshl_add_u32 v27, v30, 11, v27
  v_lshl_add_u32 v28, v23, 2, v24
  v_lshl_add_u32 v28, v28, 2, v29
  v_lshlrev_b32 v28, 7, v28
  v_lshl_add_u32 v28, v30, 6, v28
  v_lshl_add_u32 v28, v31, 4, v28
  v_add_u32 v28, s37, v28
  s_mov_b32 s39, s37
  s_xor_b32 s36, s13, 0
  s_lshl_b32 s36, s36, 15
  s_add_u32 m0, s39, 0
  s_add_u32 s37, s36, 0
  buffer_load_dwordx4 v26, s[48:51], s37 offen lds
  s_add_u32 m0, s39, 1024
  s_add_u32 s37, s36, 8192
  buffer_load_dwordx4 v26, s[48:51], s37 offen lds
  s_add_u32 m0, s39, 2048
  s_add_u32 s37, s36, 16384
  buffer_load_dwordx4 v26, s[48:51], s37 offen lds
  s_add_u32 m0, s39, 3072
  s_add_u32 s37, s36, 24576
  buffer_load_dwordx4 v26, s[48:51], s37 offen lds
  s_xor_b32 s36, s13, 0
  s_lshl_b32 s36, s36, 15
  s_add_u32 m0, s39, 4096
  s_add_u32 s37, s36, 512
  buffer_load_dwordx4 v26, s[48:51], s37 offen lds
  s_add_u32 m0, s39, 5120
  s_add_u32 s37, s36, 8704
  buffer_load_dwordx4 v26, s[48:51], s37 offen lds
  s_add_u32 m0, s39, 6144
  s_add_u32 s37, s36, 16896
  buffer_load_dwordx4 v26, s[48:51], s37 offen lds
  s_add_u32 m0, s39, 7168
  s_add_u32 s37, s36, 25088
  buffer_load_dwordx4 v26, s[48:51], s37 offen lds
  v_mov_b32 v0, 0x4444
  v_mov_b32 v1, 0xeeee
  v_cmp_lt_u32 vcc, 7, v22
  s_nop 1
  v_cndmask_b32 v32, v0, v1, vcc
  v_mov_b32 v0, v32
  v_and_b32 v32, 7, v20
  v_lshlrev_b32 v32, 4, v32
  v_lshl_add_u32 v11, v21, 7, v32
  v_xor_b32 v1, 128, v2
  v_lshl_add_u32 v33, v24, 4, v22
  s_lshl_b32 s36, s13, 5
  v_add_u32 v33, s36, v33
  v_lshlrev_b32 v33, 3, v33
  v_mul_u32_u24 v34, 1152, v23
  v_add_u32 v5, v33, v34
  v_bfe_u32 v33, v20, 2, 2
  v_lshl_add_u32 v33, v23, 2, v33
  v_lshl_add_u32 v33, v24, 4, v33
  v_lshlrev_b32 v33, 3, v33
  v_and_b32 v34, 1, v20
  v_mul_u32_u24 v34, 1152, v34
  v_add_u32 v6, v33, v34
  s_lshl_b32 s36, s13, 3
  v_lshrrev_b32 v33, 3, v20
  v_add_u32 v33, s36, v33
  v_mul_u32_u24 v34, 0, v33
  v_add_u32 v34, s12, v34
  v_and_b32 v34, 31, v34
  v_lshrrev_b32 v37, 1, v32
  v_lshl_add_u32 v33, v33, 13, v37
  v_lshl_add_u32 v7, v34, 7, v33
  v_and_b32 v37, 1, v20
  v_bfe_u32 v38, v20, 1, 1
  v_lshl_add_u32 v37, v29, 1, v37
  s_lshr_b32 s36, s12, 3
  s_lshl_b32 s36, s36, 10
  s_and_b32 s37, s12, 1
  s_lshl_b32 s37, s37, 9
  s_add_u32 s36, s36, s37
  s_and_b32 s37, s12, 6
  s_lshl_b32 s37, s37, 5
  s_add_u32 s36, s36, s37
  v_lshlrev_b32 v33, 4, v21
  v_lshl_add_u32 v33, v37, 2, v33
  v_lshl_add_u32 v33, v38, 8, v33
  v_lshl_add_u32 v33, v30, 30, v33
  v_add_u32 v8, s36, v33
  v_mov_b32 v3, v2
  v_mov_b32 v39, v21
  s_lshr_b32 s36, s12, 2
  s_lshl_b32 s36, s36, 6
  s_and_b32 s37, s12, 1
  s_lshl_b32 s37, s37, 5
  s_add_u32 s36, s36, s37
  s_and_b32 s37, s12, 2
  s_lshl_b32 s37, s37, 11
  s_add_u32 s36, s36, s37
  v_lshlrev_b32 v35, 10, v39
  v_lshl_add_u32 v35, v37, 2, v35
  v_lshl_add_u32 v35, v38, 4, v35
  v_add_u32 v35, s36, v35
  buffer_load_ushort v44, v35, s[76:79], 0 offen offset:0
  buffer_load_ushort v45, v35, s[76:79], 0 offen offset:2
  buffer_load_ushort v46, v35, s[76:79], 0 offen offset:512
  buffer_load_ushort v47, v35, s[76:79], 0 offen offset:514
  v_lshlrev_b32 v33, 4, v29
  v_mov_b32 v34, 0x3f80
  v_lshlrev_b32 v33, v33, v34
  v_and_b32 v34, 1, v20
  v_lshl_add_u32 v34, v34, 1, v30
  v_cmp_eq_u32 vcc, 0, v34
  s_nop 1
  v_cndmask_b32 v48, 0, v33, vcc
  v_cmp_eq_u32 vcc, 1, v34
  s_nop 1
  v_cndmask_b32 v49, 0, v33, vcc
  v_cmp_eq_u32 vcc, 2, v34
  s_nop 1
  v_cndmask_b32 v50, 0, v33, vcc
  v_cmp_eq_u32 vcc, 3, v34
  s_nop 1
  v_cndmask_b32 v51, 0, v33, vcc
  ds_write_b128 v2, v[48:51] offset:31232
  v_lshlrev_b32 v33, 9, v21
  s_lshl_b32 s36, s13, 11
  v_add_u32 v33, s36, v33
  v_lshl_add_u32 v10, v22, 4, v33
  v_lshl_add_u32 v33, v30, 8, v33
  v_add_u32 v9, v33, v32
  v_mov_b32 v12, 0x3f803f80
  v_mov_b32 v13, 0x3f803f80
  v_mov_b32 v14, 0x3f803f80
  v_mov_b32 v15, 0x3f803f80
  s_mov_b32 s2, 0x3f803f80
  s_mov_b32 s3, 0x3f803f80
  s_mov_b32 s98, 0
  v_and_b32 v33, 1, v20
  v_mul_u32_u24 v33, 128, v33
  v_min_u32 v34, 1, v20
  v_lshlrev_b32 v34, 30, v34
  s_cmp_eq_u32 s13, 3
  s_cselect_b64 vcc, -1, 0
  v_cndmask_b32 v19, v34, v33, vcc
  v_mov_b64 v[60:61], 0
  v_mov_b32 v62, 32256
  ds_write_b64 v62, v[60:61]
  s_mov_b32 s16, 0
  s_mov_b32 s17, -1
  s_mov_b32 s18, 0x3e0293ee
  s_mov_b32 s54, 0x2f800000
  s_mov_b32 s55, 0x28000000
  s_lshl_b32 s36, s13, 10
  s_add_u32 s31, s36, 8192
  s_add_u32 s32, s36, 12160
  s_add_u32 s33, s36, 16384
  s_add_u32 s34, s36, 20224
  s_lshl_b32 s36, s12, 19
  s_add_u32 s27, s36, 67108864
  s_add_u32 s28, s36, 83886080
  s_mul_i32 s36, s12, 4096
  s_add_u32 s29, s36, 135266304
  s_lshl_b32 s36, s12, 13
  s_add_u32 s22, s36, 144703488
  s_add_u32 s23, s36, 144707584
  s_mov_b32 s20, 144703488
  s_mov_b32 s21, 144707584
  v_mov_b32 v40, -1
  v_mov_b32 v41, -1
  v_mov_b32 v42, -1
  v_mov_b32 v43, -1
  s_lshl_b32 s36, s13, 13
  s_add_u32 s36, s36, 145752064
  s_add_u32 s37, s36, 4096
  buffer_store_dwordx4 v[40:43], v59, s[4:7], s22 offen sc1
  buffer_store_dwordx4 v[40:43], v59, s[4:7], s23 offen sc1
  buffer_store_dword v40, v8, s[4:7], s36 offen sc1
  buffer_store_dword v40, v8, s[4:7], s37 offen sc1
  v_mov_b32 v52, 0
  v_min_u32 v53, 1, v59
  v_lshlrev_b32 v53, 30, v53
  buffer_store_dword v52, v53, s[4:7], s15 offen sc1
  s_xor_b32 s36, s13, 1
  s_lshl_b32 s36, s36, 15
  s_add_u32 m0, s39, 8192
  s_add_u32 s37, s36, 0
  buffer_load_dwordx4 v26, s[48:51], s37 offen lds
  s_add_u32 m0, s39, 9216
  s_add_u32 s37, s36, 8192
  buffer_load_dwordx4 v26, s[48:51], s37 offen lds
  s_add_u32 m0, s39, 10240
  s_add_u32 s37, s36, 16384
  buffer_load_dwordx4 v26, s[48:51], s37 offen lds
  s_add_u32 m0, s39, 11264
  s_add_u32 s37, s36, 24576
  buffer_load_dwordx4 v26, s[48:51], s37 offen lds
  s_xor_b32 s36, s13, 1
  s_lshl_b32 s36, s36, 15
  s_add_u32 m0, s39, 12288
  s_add_u32 s37, s36, 512
  buffer_load_dwordx4 v26, s[48:51], s37 offen lds
  s_add_u32 m0, s39, 13312
  s_add_u32 s37, s36, 8704
  buffer_load_dwordx4 v26, s[48:51], s37 offen lds
  s_add_u32 m0, s39, 14336
  s_add_u32 s37, s36, 16896
  buffer_load_dwordx4 v26, s[48:51], s37 offen lds
  s_add_u32 m0, s39, 15360
  s_add_u32 s37, s36, 25088
  buffer_load_dwordx4 v26, s[48:51], s37 offen lds
  s_waitcnt vmcnt(21)
  ds_read_b64_tr_b16 a[160:161], v28 offset:0
  ds_read_b64_tr_b16 a[162:163], v28 offset:256
  ds_read_b64_tr_b16 a[164:165], v28 offset:1024
  ds_read_b64_tr_b16 a[166:167], v28 offset:1280
  ds_read_b64_tr_b16 a[168:169], v28 offset:8
  ds_read_b64_tr_b16 a[170:171], v28 offset:264
  ds_read_b64_tr_b16 a[172:173], v28 offset:1032
  ds_read_b64_tr_b16 a[174:175], v28 offset:1288
  s_waitcnt lgkmcnt(0)
  s_xor_b32 s36, s13, 2
  s_lshl_b32 s36, s36, 15
  s_add_u32 m0, s39, 0
  s_add_u32 s37, s36, 0
  buffer_load_dwordx4 v26, s[48:51], s37 offen lds
  s_add_u32 m0, s39, 1024
  s_add_u32 s37, s36, 8192
  buffer_load_dwordx4 v26, s[48:51], s37 offen lds
  s_add_u32 m0, s39, 2048
  s_add_u32 s37, s36, 16384
  buffer_load_dwordx4 v26, s[48:51], s37 offen lds
  s_add_u32 m0, s39, 3072
  s_add_u32 s37, s36, 24576
  buffer_load_dwordx4 v26, s[48:51], s37 offen lds
  s_waitcnt vmcnt(21)
  ds_read_b64_tr_b16 a[176:177], v28 offset:4096
  ds_read_b64_tr_b16 a[178:179], v28 offset:4352
  ds_read_b64_tr_b16 a[180:181], v28 offset:5120
  ds_read_b64_tr_b16 a[182:183], v28 offset:5376
  ds_read_b64_tr_b16 a[184:185], v28 offset:4104
  ds_read_b64_tr_b16 a[186:187], v28 offset:4360
  ds_read_b64_tr_b16 a[188:189], v28 offset:5128
  ds_read_b64_tr_b16 a[190:191], v28 offset:5384
  s_waitcnt lgkmcnt(0)
  s_xor_b32 s36, s13, 3
  s_lshl_b32 s36, s36, 15
  s_add_u32 m0, s39, 4096
  s_add_u32 s37, s36, 0
  buffer_load_dwordx4 v26, s[48:51], s37 offen lds
  s_add_u32 m0, s39, 5120
  s_add_u32 s37, s36, 8192
  buffer_load_dwordx4 v26, s[48:51], s37 offen lds
  s_add_u32 m0, s39, 6144
  s_add_u32 s37, s36, 16384
  buffer_load_dwordx4 v26, s[48:51], s37 offen lds
  s_add_u32 m0, s39, 7168
  s_add_u32 s37, s36, 24576
  buffer_load_dwordx4 v26, s[48:51], s37 offen lds
  s_waitcnt vmcnt(12)
  ds_read_b64_tr_b16 a[192:193], v28 offset:8192
  ds_read_b64_tr_b16 a[194:195], v28 offset:8448
  ds_read_b64_tr_b16 a[196:197], v28 offset:9216
  ds_read_b64_tr_b16 a[198:199], v28 offset:9472
  ds_read_b64_tr_b16 a[200:201], v28 offset:8200
  ds_read_b64_tr_b16 a[202:203], v28 offset:8456
  ds_read_b64_tr_b16 a[204:205], v28 offset:9224
  ds_read_b64_tr_b16 a[206:207], v28 offset:9480
  s_waitcnt lgkmcnt(0)
  s_xor_b32 s36, s13, 2
  s_lshl_b32 s36, s36, 19
  s_add_u32 m0, s39, 8192
  s_add_u32 s37, s36, 0
  buffer_load_dwordx4 v25, s[8:11], s37 offen lds
  s_add_u32 m0, s39, 9216
  s_add_u32 s37, s36, 131072
  buffer_load_dwordx4 v25, s[8:11], s37 offen lds
  s_add_u32 m0, s39, 10240
  s_add_u32 s37, s36, 262144
  buffer_load_dwordx4 v25, s[8:11], s37 offen lds
  s_add_u32 m0, s39, 11264
  s_add_u32 s37, s36, 393216
  buffer_load_dwordx4 v25, s[8:11], s37 offen lds
  s_barrier
  s_cmp_lg_u32 s13, 0
  s_cbranch_scc1 T_arm_76
  s_getreg_b32 s36, hwreg(HW_REG_XCC_ID, 0, 3)
  s_lshl_b32 s36, s36, 3
  s_lshl_b64 s[60:61], 1, s36
  s_mov_b32 s62, 1
  s_atomic_add_x2 s[60:61], s[52:53], 0
  s_atomic_add s62, s[52:53], 128
  v_lshl_or_b32 v44, v45, 16, v44
  v_lshl_or_b32 v46, v47, 16, v46
  v_min_u32 v44, -2, v44
  v_min_u32 v46, -2, v46
  s_mov_b32 s36, 145752064
  s_mov_b32 s37, 145756160
  buffer_store_dword v44, v8, s[4:7], s36 offen sc1
  buffer_store_dword v46, v8, s[4:7], s37 offen sc1
T_arm_76:
  s_waitcnt vmcnt(12)
  ds_read_b64_tr_b16 a[208:209], v28 offset:12288
  ds_read_b64_tr_b16 a[210:211], v28 offset:12544
  ds_read_b64_tr_b16 a[212:213], v28 offset:13312
  ds_read_b64_tr_b16 a[214:215], v28 offset:13568
  ds_read_b64_tr_b16 a[216:217], v28 offset:12296
  ds_read_b64_tr_b16 a[218:219], v28 offset:12552
  ds_read_b64_tr_b16 a[220:221], v28 offset:13320
  ds_read_b64_tr_b16 a[222:223], v28 offset:13576
  s_waitcnt lgkmcnt(0)
  s_xor_b32 s36, s13, 3
  s_lshl_b32 s36, s36, 19
  s_add_u32 m0, s39, 12288
  s_add_u32 s37, s36, 0
  buffer_load_dwordx4 v25, s[8:11], s37 offen lds
  s_add_u32 m0, s39, 13312
  s_add_u32 s37, s36, 131072
  buffer_load_dwordx4 v25, s[8:11], s37 offen lds
  s_add_u32 m0, s39, 14336
  s_add_u32 s37, s36, 262144
  buffer_load_dwordx4 v25, s[8:11], s37 offen lds
  s_add_u32 m0, s39, 15360
  s_add_u32 s37, s36, 393216
  buffer_load_dwordx4 v25, s[8:11], s37 offen lds
  s_waitcnt vmcnt(12)
  ds_read_b64_tr_b16 a[224:225], v28 offset:0
  ds_read_b64_tr_b16 a[226:227], v28 offset:256
  ds_read_b64_tr_b16 a[228:229], v28 offset:1024
  ds_read_b64_tr_b16 a[230:231], v28 offset:1280
  ds_read_b64_tr_b16 a[232:233], v28 offset:8
  ds_read_b64_tr_b16 a[234:235], v28 offset:264
  ds_read_b64_tr_b16 a[236:237], v28 offset:1032
  ds_read_b64_tr_b16 a[238:239], v28 offset:1288
  s_waitcnt lgkmcnt(0)
  s_xor_b32 s36, s13, 4
  s_lshl_b32 s36, s36, 19
  s_add_u32 m0, s39, 0
  s_add_u32 s37, s36, 0
  buffer_load_dwordx4 v25, s[8:11], s37 offen lds
  s_add_u32 m0, s39, 1024
  s_add_u32 s37, s36, 131072
  buffer_load_dwordx4 v25, s[8:11], s37 offen lds
  s_add_u32 m0, s39, 2048
  s_add_u32 s37, s36, 262144
  buffer_load_dwordx4 v25, s[8:11], s37 offen lds
  s_add_u32 m0, s39, 3072
  s_add_u32 s37, s36, 393216
  buffer_load_dwordx4 v25, s[8:11], s37 offen lds
  s_waitcnt vmcnt(12)
  ds_read_b64_tr_b16 a[240:241], v28 offset:4096
  ds_read_b64_tr_b16 a[242:243], v28 offset:4352
  ds_read_b64_tr_b16 a[244:245], v28 offset:5120
  ds_read_b64_tr_b16 a[246:247], v28 offset:5376
  ds_read_b64_tr_b16 a[248:249], v28 offset:4104
  ds_read_b64_tr_b16 a[250:251], v28 offset:4360
  ds_read_b64_tr_b16 a[252:253], v28 offset:5128
  ds_read_b64_tr_b16 a[254:255], v28 offset:5384
  s_waitcnt lgkmcnt(0)
  s_xor_b32 s36, s13, 5
  s_lshl_b32 s36, s36, 19
  s_add_u32 m0, s39, 4096
  s_add_u32 s37, s36, 0
  buffer_load_dwordx4 v25, s[8:11], s37 offen lds
  s_add_u32 m0, s39, 5120
  s_add_u32 s37, s36, 131072
  buffer_load_dwordx4 v25, s[8:11], s37 offen lds
  s_add_u32 m0, s39, 6144
  s_add_u32 s37, s36, 262144
  buffer_load_dwordx4 v25, s[8:11], s37 offen lds
  s_add_u32 m0, s39, 7168
  s_add_u32 s37, s36, 393216
  buffer_load_dwordx4 v25, s[8:11], s37 offen lds
  s_waitcnt vmcnt(12)
  ds_read_b64_tr_b16 v[160:161], v27 offset:8192
  ds_read_b64_tr_b16 v[162:163], v27 offset:8320
  ds_read_b64_tr_b16 v[164:165], v27 offset:9216
  ds_read_b64_tr_b16 v[166:167], v27 offset:9344
  ds_read_b64_tr_b16 v[168:169], v36 offset:8192
  ds_read_b64_tr_b16 v[170:171], v36 offset:8320
  ds_read_b64_tr_b16 v[172:173], v36 offset:9216
  ds_read_b64_tr_b16 v[174:175], v36 offset:9344
  s_waitcnt lgkmcnt(0)
  s_xor_b32 s36, s13, 4
  s_lshl_b32 s36, s36, 19
  s_add_u32 m0, s39, 8192
  s_add_u32 s37, s36, 0
  buffer_load_dwordx4 v25, s[40:43], s37 offen lds
  s_add_u32 m0, s39, 9216
  s_add_u32 s37, s36, 131072
  buffer_load_dwordx4 v25, s[40:43], s37 offen lds
  s_add_u32 m0, s39, 10240
  s_add_u32 s37, s36, 262144
  buffer_load_dwordx4 v25, s[40:43], s37 offen lds
  s_add_u32 m0, s39, 11264
  s_add_u32 s37, s36, 393216
  buffer_load_dwordx4 v25, s[40:43], s37 offen lds
  s_waitcnt vmcnt(12)
  ds_read_b64_tr_b16 v[192:193], v27 offset:12288
  ds_read_b64_tr_b16 v[194:195], v27 offset:12416
  ds_read_b64_tr_b16 v[196:197], v27 offset:13312
  ds_read_b64_tr_b16 v[198:199], v27 offset:13440
  ds_read_b64_tr_b16 v[200:201], v36 offset:12288
  ds_read_b64_tr_b16 v[202:203], v36 offset:12416
  ds_read_b64_tr_b16 v[204:205], v36 offset:13312
  ds_read_b64_tr_b16 v[206:207], v36 offset:13440
  s_waitcnt lgkmcnt(0)
  s_xor_b32 s36, s13, 5
  s_lshl_b32 s36, s36, 19
  s_add_u32 m0, s39, 12288
  s_add_u32 s37, s36, 0
  buffer_load_dwordx4 v25, s[40:43], s37 offen lds
  s_add_u32 m0, s39, 13312
  s_add_u32 s37, s36, 131072
  buffer_load_dwordx4 v25, s[40:43], s37 offen lds
  s_add_u32 m0, s39, 14336
  s_add_u32 s37, s36, 262144
  buffer_load_dwordx4 v25, s[40:43], s37 offen lds
  s_add_u32 m0, s39, 15360
  s_add_u32 s37, s36, 393216
  buffer_load_dwordx4 v25, s[40:43], s37 offen lds
  s_waitcnt vmcnt(12)
  ds_read_b64_tr_b16 v[224:225], v27 offset:0
  ds_read_b64_tr_b16 v[226:227], v27 offset:128
  ds_read_b64_tr_b16 v[228:229], v27 offset:1024
  ds_read_b64_tr_b16 v[230:231], v27 offset:1152
  ds_read_b64_tr_b16 v[232:233], v36 offset:0
  ds_read_b64_tr_b16 v[234:235], v36 offset:128
  ds_read_b64_tr_b16 v[236:237], v36 offset:1024
  ds_read_b64_tr_b16 v[238:239], v36 offset:1152
  s_waitcnt lgkmcnt(0)
  s_xor_b32 s36, s13, 4
  s_lshl_b32 s36, s36, 19
  s_add_u32 m0, s39, 0
  s_add_u32 s37, s36, 0
  buffer_load_dwordx4 v25, s[44:47], s37 offen lds
  s_add_u32 m0, s39, 1024
  s_add_u32 s37, s36, 131072
  buffer_load_dwordx4 v25, s[44:47], s37 offen lds
  s_add_u32 m0, s39, 2048
  s_add_u32 s37, s36, 262144
  buffer_load_dwordx4 v25, s[44:47], s37 offen lds
  s_add_u32 m0, s39, 3072
  s_add_u32 s37, s36, 393216
  buffer_load_dwordx4 v25, s[44:47], s37 offen lds
  s_waitcnt vmcnt(12)
  ds_read_b64_tr_b16 a[16:17], v27 offset:4096
  ds_read_b64_tr_b16 a[18:19], v27 offset:4224
  ds_read_b64_tr_b16 a[20:21], v27 offset:5120
  ds_read_b64_tr_b16 a[22:23], v27 offset:5248
  ds_read_b64_tr_b16 a[24:25], v36 offset:4096
  ds_read_b64_tr_b16 a[26:27], v36 offset:4224
  ds_read_b64_tr_b16 a[28:29], v36 offset:5120
  ds_read_b64_tr_b16 a[30:31], v36 offset:5248
  s_waitcnt lgkmcnt(0)
  s_xor_b32 s36, s13, 5
  s_lshl_b32 s36, s36, 19
  s_add_u32 m0, s39, 4096
  s_add_u32 s37, s36, 0
  buffer_load_dwordx4 v25, s[44:47], s37 offen lds
  s_add_u32 m0, s39, 5120
  s_add_u32 s37, s36, 131072
  buffer_load_dwordx4 v25, s[44:47], s37 offen lds
  s_add_u32 m0, s39, 6144
  s_add_u32 s37, s36, 262144
  buffer_load_dwordx4 v25, s[44:47], s37 offen lds
  s_add_u32 m0, s39, 7168
  s_add_u32 s37, s36, 393216
  buffer_load_dwordx4 v25, s[44:47], s37 offen lds
  s_waitcnt vmcnt(12)
  ds_read_b64_tr_b16 v[240:241], v27 offset:8192
  ds_read_b64_tr_b16 v[242:243], v27 offset:8320
  ds_read_b64_tr_b16 v[244:245], v27 offset:9216
  ds_read_b64_tr_b16 v[246:247], v27 offset:9344
  ds_read_b64_tr_b16 v[248:249], v36 offset:8192
  ds_read_b64_tr_b16 v[250:251], v36 offset:8320
  ds_read_b64_tr_b16 v[252:253], v36 offset:9216
  ds_read_b64_tr_b16 v[254:255], v36 offset:9344
  s_waitcnt lgkmcnt(0)
  s_xor_b32 s36, s13, 6
  s_lshl_b32 s36, s36, 19
  s_add_u32 m0, s39, 8192
  s_add_u32 s37, s36, 0
  buffer_load_dwordx4 v25, s[8:11], s37 offen lds
  s_add_u32 m0, s39, 9216
  s_add_u32 s37, s36, 131072
  buffer_load_dwordx4 v25, s[8:11], s37 offen lds
  s_add_u32 m0, s39, 10240
  s_add_u32 s37, s36, 262144
  buffer_load_dwordx4 v25, s[8:11], s37 offen lds
  s_add_u32 m0, s39, 11264
  s_add_u32 s37, s36, 393216
  buffer_load_dwordx4 v25, s[8:11], s37 offen lds
  s_waitcnt vmcnt(12)
  ds_read_b64_tr_b16 a[32:33], v27 offset:12288
  ds_read_b64_tr_b16 a[34:35], v27 offset:12416
  ds_read_b64_tr_b16 a[36:37], v27 offset:13312
  ds_read_b64_tr_b16 a[38:39], v27 offset:13440
  ds_read_b64_tr_b16 a[40:41], v36 offset:12288
  ds_read_b64_tr_b16 a[42:43], v36 offset:12416
  ds_read_b64_tr_b16 a[44:45], v36 offset:13312
  ds_read_b64_tr_b16 a[46:47], v36 offset:13440
  s_waitcnt lgkmcnt(0)
  s_xor_b32 s36, s13, 7
  s_lshl_b32 s36, s36, 19
  s_add_u32 m0, s39, 12288
  s_add_u32 s37, s36, 0
  buffer_load_dwordx4 v25, s[8:11], s37 offen lds
  s_add_u32 m0, s39, 13312
  s_add_u32 s37, s36, 131072
  buffer_load_dwordx4 v25, s[8:11], s37 offen lds
  s_add_u32 m0, s39, 14336
  s_add_u32 s37, s36, 262144
  buffer_load_dwordx4 v25, s[8:11], s37 offen lds
  s_add_u32 m0, s39, 15360
  s_add_u32 s37, s36, 393216
  buffer_load_dwordx4 v25, s[8:11], s37 offen lds
  s_waitcnt vmcnt(12)
  ds_read_b64_tr_b16 a[0:1], v27 offset:0
  ds_read_b64_tr_b16 a[2:3], v27 offset:128
  ds_read_b64_tr_b16 a[4:5], v27 offset:1024
  ds_read_b64_tr_b16 a[6:7], v27 offset:1152
  ds_read_b64_tr_b16 a[8:9], v36 offset:0
  ds_read_b64_tr_b16 a[10:11], v36 offset:128
  ds_read_b64_tr_b16 a[12:13], v36 offset:1024
  ds_read_b64_tr_b16 a[14:15], v36 offset:1152
  s_waitcnt lgkmcnt(0)
  s_xor_b32 s36, s13, 6
  s_lshl_b32 s36, s36, 19
  s_add_u32 m0, s39, 0
  s_add_u32 s37, s36, 0
  buffer_load_dwordx4 v25, s[40:43], s37 offen lds
  s_add_u32 m0, s39, 1024
  s_add_u32 s37, s36, 131072
  buffer_load_dwordx4 v25, s[40:43], s37 offen lds
  s_add_u32 m0, s39, 2048
  s_add_u32 s37, s36, 262144
  buffer_load_dwordx4 v25, s[40:43], s37 offen lds
  s_add_u32 m0, s39, 3072
  s_add_u32 s37, s36, 393216
  buffer_load_dwordx4 v25, s[40:43], s37 offen lds
  s_waitcnt vmcnt(12)
  ds_read_b64_tr_b16 a[48:49], v27 offset:4096
  ds_read_b64_tr_b16 a[50:51], v27 offset:4224
  ds_read_b64_tr_b16 a[52:53], v27 offset:5120
  ds_read_b64_tr_b16 a[54:55], v27 offset:5248
  ds_read_b64_tr_b16 a[56:57], v36 offset:4096
  ds_read_b64_tr_b16 a[58:59], v36 offset:4224
  ds_read_b64_tr_b16 a[60:61], v36 offset:5120
  ds_read_b64_tr_b16 a[62:63], v36 offset:5248
  s_waitcnt lgkmcnt(0)
  s_xor_b32 s36, s13, 7
  s_lshl_b32 s36, s36, 19
  s_add_u32 m0, s39, 4096
  s_add_u32 s37, s36, 0
  buffer_load_dwordx4 v25, s[40:43], s37 offen lds
  s_add_u32 m0, s39, 5120
  s_add_u32 s37, s36, 131072
  buffer_load_dwordx4 v25, s[40:43], s37 offen lds
  s_add_u32 m0, s39, 6144
  s_add_u32 s37, s36, 262144
  buffer_load_dwordx4 v25, s[40:43], s37 offen lds
  s_add_u32 m0, s39, 7168
  s_add_u32 s37, s36, 393216
  buffer_load_dwordx4 v25, s[40:43], s37 offen lds
  s_waitcnt vmcnt(12)
  ds_read_b64_tr_b16 a[64:65], v27 offset:8192
  ds_read_b64_tr_b16 a[66:67], v27 offset:8320
  ds_read_b64_tr_b16 a[68:69], v27 offset:9216
  ds_read_b64_tr_b16 a[70:71], v27 offset:9344
  ds_read_b64_tr_b16 a[72:73], v36 offset:8192
  ds_read_b64_tr_b16 a[74:75], v36 offset:8320
  ds_read_b64_tr_b16 a[76:77], v36 offset:9216
  ds_read_b64_tr_b16 a[78:79], v36 offset:9344
  s_waitcnt lgkmcnt(0)
  s_xor_b32 s36, s13, 6
  s_lshl_b32 s36, s36, 19
  s_add_u32 m0, s39, 8192
  s_add_u32 s37, s36, 0
  buffer_load_dwordx4 v25, s[44:47], s37 offen lds
  s_add_u32 m0, s39, 9216
  s_add_u32 s37, s36, 131072
  buffer_load_dwordx4 v25, s[44:47], s37 offen lds
  s_add_u32 m0, s39, 10240
  s_add_u32 s37, s36, 262144
  buffer_load_dwordx4 v25, s[44:47], s37 offen lds
  s_add_u32 m0, s39, 11264
  s_add_u32 s37, s36, 393216
  buffer_load_dwordx4 v25, s[44:47], s37 offen lds
  s_waitcnt vmcnt(12)
  ds_read_b64_tr_b16 a[112:113], v27 offset:12288
  ds_read_b64_tr_b16 a[114:115], v27 offset:12416
  ds_read_b64_tr_b16 a[116:117], v27 offset:13312
  ds_read_b64_tr_b16 a[118:119], v27 offset:13440
  ds_read_b64_tr_b16 a[120:121], v36 offset:12288
  ds_read_b64_tr_b16 a[122:123], v36 offset:12416
  ds_read_b64_tr_b16 a[124:125], v36 offset:13312
  ds_read_b64_tr_b16 a[126:127], v36 offset:13440
  s_waitcnt lgkmcnt(0)
  s_xor_b32 s36, s13, 7
  s_lshl_b32 s36, s36, 19
  s_add_u32 m0, s39, 12288
  s_add_u32 s37, s36, 0
  buffer_load_dwordx4 v25, s[44:47], s37 offen lds
  s_add_u32 m0, s39, 13312
  s_add_u32 s37, s36, 131072
  buffer_load_dwordx4 v25, s[44:47], s37 offen lds
  s_add_u32 m0, s39, 14336
  s_add_u32 s37, s36, 262144
  buffer_load_dwordx4 v25, s[44:47], s37 offen lds
  s_add_u32 m0, s39, 15360
  s_add_u32 s37, s36, 393216
  buffer_load_dwordx4 v25, s[44:47], s37 offen lds
  s_waitcnt vmcnt(12)
  ds_read_b64_tr_b16 a[80:81], v27 offset:0
  ds_read_b64_tr_b16 a[82:83], v27 offset:128
  ds_read_b64_tr_b16 a[84:85], v27 offset:1024
  ds_read_b64_tr_b16 a[86:87], v27 offset:1152
  ds_read_b64_tr_b16 a[88:89], v36 offset:0
  ds_read_b64_tr_b16 a[90:91], v36 offset:128
  ds_read_b64_tr_b16 a[92:93], v36 offset:1024
  ds_read_b64_tr_b16 a[94:95], v36 offset:1152
  s_waitcnt lgkmcnt(0)
  s_xor_b32 s36, s13, 1
  s_lshl_b32 s36, s36, 19
  s_add_u32 m0, s39, 16384
  s_add_u32 s37, s36, 0
  buffer_load_dwordx4 v25, s[8:11], s37 offen lds
  s_add_u32 m0, s39, 17408
  s_add_u32 s37, s36, 131072
  buffer_load_dwordx4 v25, s[8:11], s37 offen lds
  s_add_u32 m0, s39, 18432
  s_add_u32 s37, s36, 262144
  buffer_load_dwordx4 v25, s[8:11], s37 offen lds
  s_add_u32 m0, s39, 19456
  s_add_u32 s37, s36, 393216
  buffer_load_dwordx4 v25, s[8:11], s37 offen lds
  s_waitcnt vmcnt(12)
  ds_read_b64_tr_b16 a[128:129], v27 offset:4096
  ds_read_b64_tr_b16 a[130:131], v27 offset:4224
  ds_read_b64_tr_b16 a[132:133], v27 offset:5120
  ds_read_b64_tr_b16 a[134:135], v27 offset:5248
  ds_read_b64_tr_b16 a[136:137], v36 offset:4096
  ds_read_b64_tr_b16 a[138:139], v36 offset:4224
  ds_read_b64_tr_b16 a[140:141], v36 offset:5120
  ds_read_b64_tr_b16 a[142:143], v36 offset:5248
  s_waitcnt lgkmcnt(0)
  s_xor_b32 s36, s13, 0
  s_lshl_b32 s36, s36, 19
  s_add_u32 m0, s39, 0
  s_add_u32 s37, s36, 0
  buffer_load_dwordx4 v25, s[8:11], s37 offen lds
  s_add_u32 m0, s39, 1024
  s_add_u32 s37, s36, 131072
  buffer_load_dwordx4 v25, s[8:11], s37 offen lds
  s_add_u32 m0, s39, 2048
  s_add_u32 s37, s36, 262144
  buffer_load_dwordx4 v25, s[8:11], s37 offen lds
  s_add_u32 m0, s39, 3072
  s_add_u32 s37, s36, 393216
  buffer_load_dwordx4 v25, s[8:11], s37 offen lds
  s_waitcnt vmcnt(12)
  ds_read_b64_tr_b16 a[96:97], v27 offset:8192
  ds_read_b64_tr_b16 a[98:99], v27 offset:8320
  ds_read_b64_tr_b16 a[100:101], v27 offset:9216
  ds_read_b64_tr_b16 a[102:103], v27 offset:9344
  ds_read_b64_tr_b16 a[104:105], v36 offset:8192
  ds_read_b64_tr_b16 a[106:107], v36 offset:8320
  ds_read_b64_tr_b16 a[108:109], v36 offset:9216
  ds_read_b64_tr_b16 a[110:111], v36 offset:9344
  s_waitcnt lgkmcnt(0)
  s_xor_b32 s36, s13, 1
  s_lshl_b32 s36, s36, 19
  s_add_u32 m0, s39, 8192
  s_add_u32 s37, s36, 0
  buffer_load_dwordx4 v25, s[40:43], s37 offen lds
  s_add_u32 m0, s39, 9216
  s_add_u32 s37, s36, 131072
  buffer_load_dwordx4 v25, s[40:43], s37 offen lds
  s_add_u32 m0, s39, 10240
  s_add_u32 s37, s36, 262144
  buffer_load_dwordx4 v25, s[40:43], s37 offen lds
  s_add_u32 m0, s39, 11264
  s_add_u32 s37, s36, 393216
  buffer_load_dwordx4 v25, s[40:43], s37 offen lds
  s_waitcnt vmcnt(12)
  ds_read_b64_tr_b16 a[144:145], v27 offset:12288
  ds_read_b64_tr_b16 a[146:147], v27 offset:12416
  ds_read_b64_tr_b16 a[148:149], v27 offset:13312
  ds_read_b64_tr_b16 a[150:151], v27 offset:13440
  ds_read_b64_tr_b16 a[152:153], v36 offset:12288
  ds_read_b64_tr_b16 a[154:155], v36 offset:12416
  ds_read_b64_tr_b16 a[156:157], v36 offset:13312
  ds_read_b64_tr_b16 a[158:159], v36 offset:13440
  s_waitcnt lgkmcnt(0)
  s_xor_b32 s36, s13, 0
  s_lshl_b32 s36, s36, 19
  s_add_u32 m0, s39, 4096
  s_add_u32 s37, s36, 0
  buffer_load_dwordx4 v25, s[40:43], s37 offen lds
  s_add_u32 m0, s39, 5120
  s_add_u32 s37, s36, 131072
  buffer_load_dwordx4 v25, s[40:43], s37 offen lds
  s_add_u32 m0, s39, 6144
  s_add_u32 s37, s36, 262144
  buffer_load_dwordx4 v25, s[40:43], s37 offen lds
  s_add_u32 m0, s39, 7168
  s_add_u32 s37, s36, 393216
  buffer_load_dwordx4 v25, s[40:43], s37 offen lds
  s_waitcnt vmcnt(12)
  ds_read_b64_tr_b16 v[128:129], v27 offset:16384
  ds_read_b64_tr_b16 v[130:131], v27 offset:16512
  ds_read_b64_tr_b16 v[132:133], v27 offset:17408
  ds_read_b64_tr_b16 v[134:135], v27 offset:17536
  ds_read_b64_tr_b16 v[136:137], v36 offset:16384
  ds_read_b64_tr_b16 v[138:139], v36 offset:16512
  ds_read_b64_tr_b16 v[140:141], v36 offset:17408
  ds_read_b64_tr_b16 v[142:143], v36 offset:17536
  s_waitcnt lgkmcnt(0)
  s_xor_b32 s36, s13, 2
  s_lshl_b32 s36, s36, 19
  s_add_u32 m0, s39, 12288
  s_add_u32 s37, s36, 0
  buffer_load_dwordx4 v25, s[40:43], s37 offen lds
  s_add_u32 m0, s39, 13312
  s_add_u32 s37, s36, 131072
  buffer_load_dwordx4 v25, s[40:43], s37 offen lds
  s_add_u32 m0, s39, 14336
  s_add_u32 s37, s36, 262144
  buffer_load_dwordx4 v25, s[40:43], s37 offen lds
  s_add_u32 m0, s39, 15360
  s_add_u32 s37, s36, 393216
  buffer_load_dwordx4 v25, s[40:43], s37 offen lds
  s_waitcnt vmcnt(12)
  ds_read_b64_tr_b16 v[64:65], v27 offset:0
  ds_read_b64_tr_b16 v[66:67], v27 offset:128
  ds_read_b64_tr_b16 v[68:69], v27 offset:1024
  ds_read_b64_tr_b16 v[70:71], v27 offset:1152
  ds_read_b64_tr_b16 v[72:73], v36 offset:0
  ds_read_b64_tr_b16 v[74:75], v36 offset:128
  ds_read_b64_tr_b16 v[76:77], v36 offset:1024
  ds_read_b64_tr_b16 v[78:79], v36 offset:1152
  s_waitcnt lgkmcnt(0)
  ds_write_b128 v4, v[64:67] offset:0
  ds_write_b128 v4, v[68:71] offset:1024
  ds_write_b128 v4, v[72:75] offset:2048
  ds_write_b128 v4, v[76:79] offset:3072
  s_waitcnt lgkmcnt(0)
  s_xor_b32 s36, s13, 3
  s_lshl_b32 s36, s36, 19
  s_add_u32 m0, s39, 16384
  s_add_u32 s37, s36, 0
  buffer_load_dwordx4 v25, s[40:43], s37 offen lds
  s_add_u32 m0, s39, 17408
  s_add_u32 s37, s36, 131072
  buffer_load_dwordx4 v25, s[40:43], s37 offen lds
  s_add_u32 m0, s39, 18432
  s_add_u32 s37, s36, 262144
  buffer_load_dwordx4 v25, s[40:43], s37 offen lds
  s_add_u32 m0, s39, 19456
  s_add_u32 s37, s36, 393216
  buffer_load_dwordx4 v25, s[40:43], s37 offen lds
  s_waitcnt vmcnt(12)
  ds_read_b64_tr_b16 v[144:145], v27 offset:8192
  ds_read_b64_tr_b16 v[146:147], v27 offset:8320
  ds_read_b64_tr_b16 v[148:149], v27 offset:9216
  ds_read_b64_tr_b16 v[150:151], v27 offset:9344
  ds_read_b64_tr_b16 v[152:153], v36 offset:8192
  ds_read_b64_tr_b16 v[154:155], v36 offset:8320
  ds_read_b64_tr_b16 v[156:157], v36 offset:9216
  ds_read_b64_tr_b16 v[158:159], v36 offset:9344
  s_waitcnt lgkmcnt(0)
  s_xor_b32 s36, s13, 3
  s_lshl_b32 s36, s36, 19
  s_add_u32 m0, s39, 24576
  s_add_u32 s37, s36, 0
  buffer_load_dwordx4 v25, s[44:47], s37 offen lds
  s_add_u32 m0, s39, 25600
  s_add_u32 s37, s36, 131072
  buffer_load_dwordx4 v25, s[44:47], s37 offen lds
  s_add_u32 m0, s39, 26624
  s_add_u32 s37, s36, 262144
  buffer_load_dwordx4 v25, s[44:47], s37 offen lds
  s_add_u32 m0, s39, 27648
  s_add_u32 s37, s36, 393216
  buffer_load_dwordx4 v25, s[44:47], s37 offen lds
  buffer_load_dwordx2 v[54:55], off, s[72:75], 0 sc1
  buffer_load_dword v56, off, s[72:75], 0 offset:128 sc1
  s_waitcnt vmcnt(14)
  ds_read_b64_tr_b16 v[64:65], v27 offset:4096
  ds_read_b64_tr_b16 v[66:67], v27 offset:4224
  ds_read_b64_tr_b16 v[68:69], v27 offset:5120
  ds_read_b64_tr_b16 v[70:71], v27 offset:5248
  ds_read_b64_tr_b16 v[72:73], v36 offset:4096
  ds_read_b64_tr_b16 v[74:75], v36 offset:4224
  ds_read_b64_tr_b16 v[76:77], v36 offset:5120
  ds_read_b64_tr_b16 v[78:79], v36 offset:5248
  s_waitcnt lgkmcnt(0)
  ds_write_b128 v4, v[64:67] offset:4096
  ds_write_b128 v4, v[68:71] offset:5120
  ds_write_b128 v4, v[72:75] offset:6144
  ds_write_b128 v4, v[76:79] offset:7168
  s_waitcnt lgkmcnt(0)
  s_xor_b32 s36, s13, 2
  s_lshl_b32 s36, s36, 19
  s_add_u32 m0, s39, 20480
  s_add_u32 s37, s36, 0
  buffer_load_dwordx4 v25, s[44:47], s37 offen lds
  s_add_u32 m0, s39, 21504
  s_add_u32 s37, s36, 131072
  buffer_load_dwordx4 v25, s[44:47], s37 offen lds
  s_add_u32 m0, s39, 22528
  s_add_u32 s37, s36, 262144
  buffer_load_dwordx4 v25, s[44:47], s37 offen lds
  s_add_u32 m0, s39, 23552
  s_add_u32 s37, s36, 393216
  buffer_load_dwordx4 v25, s[44:47], s37 offen lds
  s_waitcnt vmcnt(14)
  ds_read_b64_tr_b16 v[176:177], v27 offset:12288
  ds_read_b64_tr_b16 v[178:179], v27 offset:12416
  ds_read_b64_tr_b16 v[180:181], v27 offset:13312
  ds_read_b64_tr_b16 v[182:183], v27 offset:13440
  ds_read_b64_tr_b16 v[184:185], v36 offset:12288
  ds_read_b64_tr_b16 v[186:187], v36 offset:12416
  ds_read_b64_tr_b16 v[188:189], v36 offset:13312
  ds_read_b64_tr_b16 v[190:191], v36 offset:13440
  s_waitcnt lgkmcnt(0)
  s_xor_b32 s36, s13, 0
  s_lshl_b32 s36, s36, 19
  s_add_u32 m0, s39, 8192
  s_add_u32 s37, s36, 0
  buffer_load_dwordx4 v25, s[44:47], s37 offen lds
  s_add_u32 m0, s39, 9216
  s_add_u32 s37, s36, 131072
  buffer_load_dwordx4 v25, s[44:47], s37 offen lds
  s_add_u32 m0, s39, 10240
  s_add_u32 s37, s36, 262144
  buffer_load_dwordx4 v25, s[44:47], s37 offen lds
  s_add_u32 m0, s39, 11264
  s_add_u32 s37, s36, 393216
  buffer_load_dwordx4 v25, s[44:47], s37 offen lds
  s_waitcnt vmcnt(14)
  ds_read_b64_tr_b16 v[64:65], v27 offset:16384
  ds_read_b64_tr_b16 v[66:67], v27 offset:16512
  ds_read_b64_tr_b16 v[68:69], v27 offset:17408
  ds_read_b64_tr_b16 v[70:71], v27 offset:17536
  ds_read_b64_tr_b16 v[72:73], v36 offset:16384
  ds_read_b64_tr_b16 v[74:75], v36 offset:16512
  ds_read_b64_tr_b16 v[76:77], v36 offset:17408
  ds_read_b64_tr_b16 v[78:79], v36 offset:17536
  s_waitcnt lgkmcnt(0)
  ds_write_b128 v4, v[64:67] offset:16384
  ds_write_b128 v4, v[68:71] offset:17408
  ds_write_b128 v4, v[72:75] offset:18432
  ds_write_b128 v4, v[76:79] offset:19456
  s_waitcnt lgkmcnt(0)
  s_xor_b32 s36, s13, 1
  s_lshl_b32 s36, s36, 19
  s_add_u32 m0, s39, 12288
  s_add_u32 s37, s36, 0
  buffer_load_dwordx4 v25, s[44:47], s37 offen lds
  s_add_u32 m0, s39, 13312
  s_add_u32 s37, s36, 131072
  buffer_load_dwordx4 v25, s[44:47], s37 offen lds
  s_add_u32 m0, s39, 14336
  s_add_u32 s37, s36, 262144
  buffer_load_dwordx4 v25, s[44:47], s37 offen lds
  s_add_u32 m0, s39, 15360
  s_add_u32 s37, s36, 393216
  buffer_load_dwordx4 v25, s[44:47], s37 offen lds
  s_waitcnt vmcnt(14)
  ds_read_b64_tr_b16 v[208:209], v27 offset:24576
  ds_read_b64_tr_b16 v[210:211], v27 offset:24704
  ds_read_b64_tr_b16 v[212:213], v27 offset:25600
  ds_read_b64_tr_b16 v[214:215], v27 offset:25728
  ds_read_b64_tr_b16 v[216:217], v36 offset:24576
  ds_read_b64_tr_b16 v[218:219], v36 offset:24704
  ds_read_b64_tr_b16 v[220:221], v36 offset:25600
  ds_read_b64_tr_b16 v[222:223], v36 offset:25728
  s_waitcnt lgkmcnt(0)
  s_xor_b32 s36, s13, 2
  s_lshl_b32 s36, s36, 15
  s_add_u32 m0, s39, 24576
  s_add_u32 s37, s36, 512
  buffer_load_dwordx4 v26, s[48:51], s37 offen lds
  s_add_u32 m0, s39, 25600
  s_add_u32 s37, s36, 8704
  buffer_load_dwordx4 v26, s[48:51], s37 offen lds
  s_add_u32 m0, s39, 26624
  s_add_u32 s37, s36, 16896
  buffer_load_dwordx4 v26, s[48:51], s37 offen lds
  s_add_u32 m0, s39, 27648
  s_add_u32 s37, s36, 25088
  buffer_load_dwordx4 v26, s[48:51], s37 offen lds
  s_waitcnt vmcnt(12)
  ds_read_b64_tr_b16 v[64:65], v27 offset:20480
  ds_read_b64_tr_b16 v[66:67], v27 offset:20608
  ds_read_b64_tr_b16 v[68:69], v27 offset:21504
  ds_read_b64_tr_b16 v[70:71], v27 offset:21632
  ds_read_b64_tr_b16 v[72:73], v36 offset:20480
  ds_read_b64_tr_b16 v[74:75], v36 offset:20608
  ds_read_b64_tr_b16 v[76:77], v36 offset:21504
  ds_read_b64_tr_b16 v[78:79], v36 offset:21632
  s_waitcnt lgkmcnt(0)
  ds_write_b128 v4, v[64:67] offset:20480
  ds_write_b128 v4, v[68:71] offset:21504
  ds_write_b128 v4, v[72:75] offset:22528
  ds_write_b128 v4, v[76:79] offset:23552
  s_waitcnt lgkmcnt(0)
  s_xor_b32 s36, s13, 3
  s_lshl_b32 s36, s36, 15
  s_add_u32 m0, s39, 28672
  s_add_u32 s37, s36, 512
  buffer_load_dwordx4 v26, s[48:51], s37 offen lds
  s_add_u32 m0, s39, 29696
  s_add_u32 s37, s36, 8704
  buffer_load_dwordx4 v26, s[48:51], s37 offen lds
  s_add_u32 m0, s39, 30720
  s_add_u32 s37, s36, 16896
  buffer_load_dwordx4 v26, s[48:51], s37 offen lds
  s_add_u32 m0, s39, 31744
  s_add_u32 s37, s36, 25088
  buffer_load_dwordx4 v26, s[48:51], s37 offen lds
  s_mov_b32 s19, 0
  s_branch T_arrgo_78
T_arr_77:
  s_add_u32 s19, s19, 1
  s_cmp_gt_u32 s19, 32768
  s_cbranch_scc1 M_exit
  buffer_load_dwordx2 v[54:55], off, s[72:75], 0 sc1
  buffer_load_dword v56, off, s[72:75], 0 offset:128 sc1
  s_waitcnt vmcnt(0)
T_arrgo_78:
  v_sad_u8 v57, v54, 0, 0
  v_sad_u8 v57, v55, 0, v57
  v_or_b32 v58, v54, v55
  v_cmp_gt_u32 vcc, 32, v57
  s_cbranch_vccnz T_arr_77
  v_cmp_gt_u32 vcc, 0x100, v56
  s_cbranch_vccnz T_arr_77
  v_readfirstlane_b32 s36, v58
  s_nop 0
  s_and_b32 s36, s36, 0x20202020
  s_cselect_b32 s56, 0, 1
  s_mov_b32 s14, -1
  s_mov_b32 s30, -1
  s_mov_b32 s19, 0
  s_branch T_kvok_80
T_kv_79:
  s_sleep 4
  s_add_u32 s19, s19, 1
  s_cmp_gt_u32 s19, 32768
  s_cbranch_scc1 M_exit
T_kvok_80:
  s_add_u32 s39, s99, 128
  s_mov_b32 s38, 0
  s_mov_b32 s37, 0
  s_atomic_or s38, s[58:59], s99 glc
  s_atomic_or s37, s[58:59], s39 glc
  s_waitcnt lgkmcnt(0)
  s_add_u32 s37, s37, 30
  s_cmp_ge_u32 s38, 30
  s_cselect_b32 s38, s37, s38
  s_cmp_ge_u32 s38, 64
  s_cselect_b32 s38, 100, s38
  s_sub_u32 s38, s38, 1
  s_max_i32 s30, s30, s38
  s_cmp_ge_i32 s14, s30
  s_cbranch_scc1 T_kv_79
  s_mov_b32 m0, s31
  s_nop 0
  buffer_load_dwordx4 v9, s[4:7], s27 offen sc1 lds
  s_mov_b32 m0, s32
  s_nop 0
  buffer_load_dwordx4 v9, s[4:7], s27 offen offset:128 sc1 lds
  s_mov_b32 m0, s33
  s_nop 0
  buffer_load_dwordx4 v10, s[4:7], s28 offen sc1 lds
  s_mov_b32 m0, s34
  s_nop 0
  buffer_load_dwordx4 v10, s[4:7], s28 offen offset:256 sc1 lds
  s_add_u32 s27, s27, 8192
  s_add_u32 s28, s28, 8192
  s_lshl_b32 s36, s12, 10
  s_add_u32 s36, s36, 145752064
  buffer_load_dwordx4 v[40:43], v2, s[4:7], s36 offen sc1
  s_waitcnt vmcnt(17)
  ds_read_b64_tr_b16 v[64:65], v27 offset:8192
  ds_read_b64_tr_b16 v[66:67], v27 offset:8320
  ds_read_b64_tr_b16 v[68:69], v27 offset:9216
  ds_read_b64_tr_b16 v[70:71], v27 offset:9344
  ds_read_b64_tr_b16 v[72:73], v36 offset:8192
  ds_read_b64_tr_b16 v[74:75], v36 offset:8320
  ds_read_b64_tr_b16 v[76:77], v36 offset:9216
  ds_read_b64_tr_b16 v[78:79], v36 offset:9344
  s_waitcnt lgkmcnt(0)
  ds_write_b128 v4, v[64:67] offset:8192
  ds_write_b128 v4, v[68:71] offset:9216
  ds_write_b128 v4, v[72:75] offset:10240
  ds_write_b128 v4, v[76:79] offset:11264
  s_waitcnt lgkmcnt(0)
  s_waitcnt vmcnt(13)
  ds_read_b64_tr_b16 v[64:65], v27 offset:12288
  ds_read_b64_tr_b16 v[66:67], v27 offset:12416
  ds_read_b64_tr_b16 v[68:69], v27 offset:13312
  ds_read_b64_tr_b16 v[70:71], v27 offset:13440
  ds_read_b64_tr_b16 v[72:73], v36 offset:12288
  ds_read_b64_tr_b16 v[74:75], v36 offset:12416
  ds_read_b64_tr_b16 v[76:77], v36 offset:13312
  ds_read_b64_tr_b16 v[78:79], v36 offset:13440
  s_waitcnt lgkmcnt(0)
  ds_write_b128 v4, v[64:67] offset:12288
  ds_write_b128 v4, v[68:71] offset:13312
  ds_write_b128 v4, v[72:75] offset:14336
  ds_write_b128 v4, v[76:79] offset:15360
  s_waitcnt lgkmcnt(0)
  s_waitcnt vmcnt(9)
  ds_read_b64_tr_b16 v[64:65], v28 offset:24576
  ds_read_b64_tr_b16 v[66:67], v28 offset:24832
  ds_read_b64_tr_b16 v[68:69], v28 offset:25600
  ds_read_b64_tr_b16 v[70:71], v28 offset:25856
  ds_read_b64_tr_b16 v[72:73], v28 offset:24584
  ds_read_b64_tr_b16 v[74:75], v28 offset:24840
  ds_read_b64_tr_b16 v[76:77], v28 offset:25608
  ds_read_b64_tr_b16 v[78:79], v28 offset:25864
  s_waitcnt lgkmcnt(0)
  ds_write_b128 v4, v[64:67] offset:24576
  ds_write_b128 v4, v[68:71] offset:25600
  ds_write_b128 v4, v[72:75] offset:26624
  ds_write_b128 v4, v[76:79] offset:27648
  s_waitcnt lgkmcnt(0)
  s_waitcnt vmcnt(5)
  ds_read_b64_tr_b16 v[64:65], v28 offset:28672
  ds_read_b64_tr_b16 v[66:67], v28 offset:28928
  ds_read_b64_tr_b16 v[68:69], v28 offset:29696
  ds_read_b64_tr_b16 v[70:71], v28 offset:29952
  ds_read_b64_tr_b16 v[72:73], v28 offset:28680
  ds_read_b64_tr_b16 v[74:75], v28 offset:28936
  ds_read_b64_tr_b16 v[76:77], v28 offset:29704
  ds_read_b64_tr_b16 v[78:79], v28 offset:29960
  s_waitcnt lgkmcnt(0)
  ds_write_b128 v4, v[64:67] offset:28672
  ds_write_b128 v4, v[68:71] offset:29696
  ds_write_b128 v4, v[72:75] offset:30720
  ds_write_b128 v4, v[76:79] offset:31744
  s_waitcnt lgkmcnt(0)
  s_waitcnt vmcnt(0) lgkmcnt(0)
  s_barrier
  s_cmp_ge_u32 s13, 2
  s_cselect_b64 vcc, -1, 0
  v_cndmask_b32 v8, v8, v19, vcc
  ds_read_b128 v[68:71], v4 offset:0
  ds_read_b128 v[72:75], v4 offset:1024
  ds_read_b128 v[76:79], v4 offset:4096
  ds_read_b128 v[80:83], v4 offset:5120
  ds_read_b128 v[84:87], v4 offset:8192
  ds_read_b128 v[88:91], v4 offset:9216
  ds_read_b128 v[92:95], v4 offset:2048
  ds_read_b128 v[96:99], v4 offset:3072
  ds_read_b128 v[100:103], v4 offset:6144
  ds_read_b128 v[104:107], v4 offset:7168
  ds_read_b128 v[108:111], v4 offset:10240
  ds_read_b128 v[112:115], v4 offset:11264
  ds_read_b128 v[28:31], v59 offset:16384
  ds_read_b128 v[32:35], v59 offset:20480
  ds_read_b128 v[36:39], v2 offset:8192
  ds_read_b128 v[40:43], v2 offset:9216
  ds_read_b128 v[44:47], v2 offset:10240
  ds_read_b128 v[48:51], v2 offset:11264
  ds_read_b128 v[52:55], v2 offset:12288
  ds_read_b128 v[56:59], v2 offset:13312
  ds_read_b128 v[60:63], v2 offset:14336
  ds_read_b128 v[64:67], v2 offset:15360
  s_and_b32 s36, s13, 1
  s_lshl_b32 s36, s36, 12
  s_add_u32 s22, s22, s36
  s_add_u32 s23, s36, 145752064
  s_mov_b32 s14, -1
  s_and_b32 s57, s14, 1
  s_and_b32 s36, s14, 3
  s_lshl_b32 s36, s36, 13
  s_add_u32 s26, s36, s23
  s_add_u32 s36, s36, 8192
  s_and_b32 s36, s36, 0x7fff
  s_add_u32 s24, s36, 145752064
  s_add_u32 s25, s36, 145756160
  s_add_u32 s35, s36, s23
  s_waitcnt lgkmcnt(0)
  s_cmp_lg_u32 s56, 0
  s_cbranch_scc1 M_global
  s_cmp_eq_u32 s13, 1
  s_cbranch_scc1 T_w_82
  s_cmp_eq_u32 s13, 2
  s_cbranch_scc1 T_w_83
  s_cmp_eq_u32 s13, 3
  s_cbranch_scc1 T_w_84
T_w_81:
  s_mov_b32 s19, 0
  v_mov_b64 v[16:17], 0
  v_mov_b64 v[18:19], 0
  v_mov_b64 v[20:21], 0
  v_mov_b64 v[22:23], 0
  v_mov_b64 v[24:25], 0
  v_mov_b64 v[26:27], 0
  buffer_load_dwordx4 v[124:127], v3, s[4:7], s24 offen offset:0 sc1
  buffer_load_dwordx4 v[116:119], v3, s[4:7], s25 offen offset:0 sc1
  buffer_load_dwordx4 v[124:127], v3, s[4:7], s24 offen offset:0 sc1
  buffer_load_dwordx4 v[116:119], v3, s[4:7], s25 offen offset:0 sc1
  s_branch T_loop_85
.p2align 6
T_retry_86:
  s_mov_b64 exec, vcc
  buffer_load_dwordx4 v[124:127], v3, s[4:7], s24 offen offset:0 sc1
  buffer_load_dwordx4 v[116:119], v3, s[4:7], s25 offen offset:0 sc1
  s_mov_b64 exec, -1
  s_add_u32 s19, s19, 1
  s_cmp_gt_u32 s19, 32768
  s_cbranch_scc1 M_exit
T_loop_85:
  s_waitcnt vmcnt(3) lgkmcnt(0)
  v_max3_u32 v123, v124, v125, v126
  v_max_u32 v123, v123, v127
  v_mov_b32_dpp v120, v124 row_ror:8 row_mask:0xf bank_mask:0xf
  v_mov_b32_dpp v121, v125 row_ror:8 row_mask:0xf bank_mask:0xf
  s_waitcnt vmcnt(2)
  v_max3_u32 v123, v123, v116, v117
  v_max3_u32 v123, v123, v118, v119
  v_cmp_eq_u32 vcc, -1, v123
  s_cbranch_vccnz T_retry_86
  v_smfmac_f32_16x16x64_bf16 v[16:19], v[124:127], v[68:75], v0
  s_add_u32 s14, s14, 1
  ds_write_b128 v2, v[124:127] offset:0
  v_mov_b32_dpp v122, v126 row_ror:8 row_mask:0xf bank_mask:0xf
  v_smfmac_f32_16x16x64_bf16 v[20:23], v[124:127], v[76:83], v0
  s_and_b32 s57, s14, 1
  v_mov_b32_dpp v123, v127 row_ror:8 row_mask:0xf bank_mask:0xf
  v_smfmac_f32_16x16x64_bf16 v[24:27], v[124:127], v[84:91], v0
  s_and_b32 s36, s14, 3
  ds_write_b128 v2, v[116:119] offset:4096
  v_smfmac_f32_16x16x64_bf16 v[16:19], v[120:123], v[92:99], v0
  s_lshl_b32 s36, s36, 13
  v_mov_b32_dpp v84, v116 row_ror:8 row_mask:0xf bank_mask:0xf
  v_smfmac_f32_16x16x64_bf16 v[20:23], v[120:123], v[100:107], v0
  s_add_u32 s26, s36, s23
  ds_read_b128 v[68:71], v4 offset:12288
  v_mov_b32_dpp v85, v117 row_ror:8 row_mask:0xf bank_mask:0xf
  v_smfmac_f32_16x16x64_bf16 v[24:27], v[120:123], v[108:115], v0
  s_add_u32 s36, s36, 8192
  ds_read_b128 v[72:75], v4 offset:13312
  v_mov_b32_dpp v86, v118 row_ror:8 row_mask:0xf bank_mask:0xf
  v_smfmac_f32_16x16x64_bf16 v[16:19], v[116:119], v[224:231], v0
  s_and_b32 s36, s36, 0x7fff
  ds_read_b128 v[76:79], v4 offset:14336
  v_mov_b32_dpp v87, v119 row_ror:8 row_mask:0xf bank_mask:0xf
  v_smfmac_f32_16x16x64_bf16 v[20:23], v[116:119], v[240:247], v0
  s_waitcnt lgkmcnt(3)
  s_barrier
  ds_read_b128 v[100:103], v2 offset:1024
  v_smfmac_f32_16x16x64_bf16 v[24:27], v[116:119], a[0:7], v0
  s_mov_b32 m0, s31
  ds_read_b128 v[120:123], v1 offset:1024
  v_smfmac_f32_16x16x64_bf16 v[16:19], v[84:87], v[232:239], v0
  s_cmp_ge_i32 s14, s30
  s_cbranch_scc1 T_kvw_89
T_kvb_90:
  v_smfmac_f32_16x16x64_bf16 v[20:23], v[84:87], v[248:255], v0
  ds_read_b128 v[80:83], v4 offset:15360
  buffer_load_dwordx4 v9, s[4:7], s27 offen sc1 lds
  v_smfmac_f32_16x16x64_bf16 v[24:27], v[84:87], a[8:15], v0
  s_waitcnt lgkmcnt(2)
  s_mov_b32 m0, s32
  v_smfmac_f32_16x16x64_bf16 v[16:19], v[100:103], v[128:135], v0
  ds_read_b128 v[92:95], v2 offset:2048
  v_smfmac_f32_16x16x64_bf16 v[20:23], v[100:103], v[144:151], v0
  ds_read_b128 v[96:99], v1 offset:2048
  v_smfmac_f32_16x16x64_bf16 v[24:27], v[100:103], v[68:75], v0
  s_waitcnt vmcnt(1) lgkmcnt(3)
  ds_read_b128 v[116:119], v2 offset:3072
  buffer_load_dwordx4 v9, s[4:7], s27 offen offset:128 sc1 lds
  v_smfmac_f32_16x16x64_bf16 v[16:19], v[120:123], v[136:143], v0
  ds_read_b128 v[124:127], v1 offset:3072
  s_mov_b32 m0, s33
  v_smfmac_f32_16x16x64_bf16 v[20:23], v[120:123], v[152:159], v0
  s_waitcnt lgkmcnt(4)
  ds_read_b128 v[104:107], v2 offset:5120
  v_smfmac_f32_16x16x64_bf16 v[24:27], v[120:123], v[76:83], v0
  s_waitcnt lgkmcnt(4)
  ds_read_b128 v[108:111], v1 offset:5120
  v_smfmac_f32_16x16x64_bf16 v[16:19], v[92:95], v[160:167], v0
  s_waitcnt lgkmcnt(4)
  ds_read_b128 v[112:115], v2 offset:6144
  buffer_load_dwordx4 v10, s[4:7], s28 offen sc1 lds
  v_smfmac_f32_16x16x64_bf16 v[16:19], v[96:99], v[168:175], v0
  s_waitcnt lgkmcnt(4)
  ds_read_b128 v[84:87], v1 offset:6144
  s_mov_b32 m0, s34
  v_smfmac_f32_16x16x64_bf16 v[16:19], v[116:119], v[192:199], v0
  s_waitcnt lgkmcnt(4)
  ds_read_b128 v[88:91], v2 offset:7168
  v_smfmac_f32_16x16x64_bf16 v[16:19], v[124:127], v[200:207], v0
  s_waitcnt lgkmcnt(4)
  ds_read_b128 v[100:103], v1 offset:7168
  v_smfmac_f32_16x16x64_bf16 v[16:19], v[104:107], a[16:23], v0
  s_waitcnt lgkmcnt(4)
  ds_read_b128 v[68:71], v4 offset:16384
  buffer_load_dwordx4 v10, s[4:7], s28 offen offset:256 sc1 lds
  v_smfmac_f32_16x16x64_bf16 v[16:19], v[108:111], a[24:31], v0
  s_waitcnt lgkmcnt(4)
  ds_read_b128 v[72:75], v4 offset:17408
  v_smfmac_f32_16x16x64_bf16 v[16:19], v[112:115], a[64:71], v0
  s_waitcnt lgkmcnt(4)
  ds_read_b128 v[76:79], v4 offset:18432
  v_smfmac_f32_16x16x64_bf16 v[16:19], v[84:87], a[72:79], v0
  s_waitcnt lgkmcnt(4)
  ds_read_b128 v[80:83], v4 offset:19456
  v_smfmac_f32_16x16x64_bf16 v[16:19], v[88:91], a[112:119], v0
  s_waitcnt lgkmcnt(4)
  v_smfmac_f32_16x16x64_bf16 v[16:19], v[100:103], a[120:127], v0
  s_add_u32 s24, s36, 145752064
  s_add_u32 s25, s36, 145756160
  v_smfmac_f32_16x16x64_bf16 v[20:23], v[92:95], v[176:183], v0
  s_add_u32 s35, s36, s23
  v_smfmac_f32_16x16x64_bf16 v[20:23], v[96:99], v[184:191], v0
  s_waitcnt lgkmcnt(2)
  v_smfmac_f32_16x16x64_bf16 v[20:23], v[116:119], v[68:75], v0
  s_waitcnt lgkmcnt(0)
  ds_read_b128 v[68:71], v4 offset:20480
  v_mul_f32 v16, s18, v16
  v_smfmac_f32_16x16x64_bf16 v[20:23], v[124:127], v[76:83], v0
  ds_read_b128 v[72:75], v4 offset:21504
  v_mul_f32 v17, s18, v17
  v_smfmac_f32_16x16x64_bf16 v[20:23], v[104:107], a[32:39], v0
  ds_read_b128 v[76:79], v4 offset:22528
  v_mul_f32 v18, s18, v18
  v_smfmac_f32_16x16x64_bf16 v[20:23], v[108:111], a[40:47], v0
  ds_read_b128 v[80:83], v4 offset:23552
  v_mul_f32 v19, s18, v19
  v_smfmac_f32_16x16x64_bf16 v[20:23], v[112:115], a[80:87], v0
  v_cvt_pk_bf16_f32 v120, v16, v17
  v_smfmac_f32_16x16x64_bf16 v[20:23], v[84:87], a[88:95], v0
  v_cvt_pk_bf16_f32 v121, v18, v19
  v_smfmac_f32_16x16x64_bf16 v[20:23], v[88:91], a[128:135], v0
  ds_write_b64 v5, v[120:121] offset:24576
  v_smfmac_f32_16x16x64_bf16 v[20:23], v[100:103], a[136:143], v0
  s_waitcnt lgkmcnt(3)
  v_smfmac_f32_16x16x64_bf16 v[24:27], v[92:95], v[68:75], v0
  s_waitcnt lgkmcnt(1)
  v_mov_b64 v[92:93], 0
  v_smfmac_f32_16x16x64_bf16 v[24:27], v[96:99], v[76:83], v0
  s_nop 1
  v_cvt_pk_bf16_f32 v122, v20, v21
  v_cvt_pk_bf16_f32 v123, v22, v23
  v_smfmac_f32_16x16x64_bf16 v[24:27], v[116:119], v[208:215], v0
  ds_write_b64 v5, v[122:123] offset:26880
  v_mov_b64 v[94:95], 0
  v_smfmac_f32_16x16x64_bf16 v[24:27], v[124:127], v[216:223], v0
  s_waitcnt lgkmcnt(1)
  s_barrier
  ds_read_b64_tr_b16 v[68:69], v6 offset:24576
  v_smfmac_f32_16x16x64_bf16 v[24:27], v[104:107], a[48:55], v0
  s_add_u32 s27, s27, 8192
  ds_read_b64_tr_b16 v[70:71], v6 offset:24640
  ds_read_b64_tr_b16 v[72:73], v6 offset:24832
  v_smfmac_f32_16x16x64_bf16 v[24:27], v[108:111], a[56:63], v0
  s_add_u32 s28, s28, 8192
  ds_read_b64_tr_b16 v[74:75], v6 offset:24896
  ds_read_b64_tr_b16 v[76:77], v6 offset:25088
  v_smfmac_f32_16x16x64_bf16 v[24:27], v[112:115], a[96:103], v0
  s_nop 0
  ds_read_b64_tr_b16 v[78:79], v6 offset:25152
  ds_read_b64_tr_b16 v[80:81], v6 offset:25344
  v_smfmac_f32_16x16x64_bf16 v[24:27], v[84:87], a[104:111], v0
  ds_read_b64_tr_b16 v[82:83], v6 offset:25408
  v_mov_b64 v[96:97], 0
  v_smfmac_f32_16x16x64_bf16 v[24:27], v[88:91], a[144:151], v0
  s_waitcnt lgkmcnt(8)
  s_barrier
  ds_read_b64_tr_b16 v[116:117], v6 offset:26880
  v_smfmac_f32_16x16x64_bf16 v[24:27], v[100:103], a[152:159], v0
  s_waitcnt lgkmcnt(7)
  ds_read_b64_tr_b16 v[118:119], v6 offset:26944
  v_mfma_f32_16x16x32_bf16 v[16:19], v[36:39], v[68:71], 0
  s_waitcnt lgkmcnt(6)
  ds_read_b64_tr_b16 v[124:125], v6 offset:27136
  ds_read_b64_tr_b16 v[126:127], v6 offset:27200
  v_mfma_f32_16x16x32_bf16 v[16:19], v[40:43], v[72:75], v[16:19]
  s_waitcnt lgkmcnt(6)
  ds_read_b64_tr_b16 v[104:105], v6 offset:27392
  ds_read_b64_tr_b16 v[106:107], v6 offset:27456
  v_mfma_f32_16x16x32_bf16 v[16:19], v[44:47], v[76:79], v[16:19]
  s_waitcnt lgkmcnt(6)
  ds_read_b64_tr_b16 v[108:109], v6 offset:27648
  ds_read_b64_tr_b16 v[110:111], v6 offset:27712
  v_mfma_f32_16x16x32_bf16 v[16:19], v[48:51], v[80:83], v[16:19]
  s_waitcnt lgkmcnt(6)
  v_cvt_pk_bf16_f32 v120, v24, v25
  v_cvt_pk_bf16_f32 v121, v26, v27
  v_mfma_f32_16x16x32_bf16 v[112:115], v[116:119], v[68:71], 0
  s_waitcnt lgkmcnt(4)
  buffer_store_dwordx4 v[120:123], v2, s[4:7], s29 offen offset:0 sc1
  v_mov_b64 v[98:99], 0
  v_mfma_f32_16x16x32_bf16 v[112:115], v[124:127], v[72:75], v[112:115]
  s_waitcnt lgkmcnt(2)
  v_mov_b64 v[36:37], 0
  v_exp_f32 v100, v16
  v_mfma_f32_16x16x32_bf16 v[112:115], v[104:107], v[76:79], v[112:115]
  s_waitcnt lgkmcnt(0)
  v_exp_f32 v101, v17
  v_mfma_f32_16x16x32_bf16 v[112:115], v[108:111], v[80:83], v[112:115]
  s_add_u32 s29, s29, 131072
  v_exp_f32 v102, v18
  v_mfma_f32_16x16x32_bf16 v[20:23], v[52:55], v[68:71], 0
  s_cmp_eq_u32 s14, 63
  v_exp_f32 v103, v19
  v_mfma_f32_16x16x32_bf16 v[20:23], v[56:59], v[72:75], v[20:23]
  s_cbranch_scc1 M_tdone
  v_cvt_pk_bf16_f32 v44, v100, v101
  v_cvt_pk_bf16_f32 v45, v102, v103
  v_mfma_f32_16x16x32_bf16 v[20:23], v[60:63], v[76:79], v[20:23]
  v_exp_f32 v100, v112
  v_mfma_f32_16x16x32_bf16 v[20:23], v[64:67], v[80:83], v[20:23]
  v_exp_f32 v101, v113
  v_exp_f32 v102, v114
  v_exp_f32 v103, v115
  v_cvt_pk_bf16_f32 v84, v100, v101
  v_cvt_pk_bf16_f32 v85, v102, v103
  v_cndmask_b32 v48, v84, 0, s[16:17]
  v_cndmask_b32 v49, v85, 0, s[16:17]
  v_cndmask_b32 v50, 0, v84, s[16:17]
  v_cndmask_b32 v51, 0, v85, s[16:17]
  v_exp_f32 v100, v20
  v_mfma_f32_16x16x16_bf16 v[88:91], v[12:13], v[48:49], 0
  v_exp_f32 v101, v21
  v_mfma_f32_16x16x16_bf16 v[24:27], v[120:121], v[48:49], 0
  v_exp_f32 v102, v22
  v_mfma_f32_16x16x16_bf16 v[116:119], v[120:121], v[50:51], 0
  v_exp_f32 v103, v23
  v_cvt_pk_bf16_f32 v46, v100, v101
  v_cvt_pk_bf16_f32 v47, v102, v103
  v_mov_b64 v[38:39], 0
  s_nop 0
  v_mfma_f32_16x16x32_bf16 v[88:91], v[12:15], v[44:47], v[88:91]
  v_mov_b64 v[40:41], 0
  v_mov_b64 v[42:43], 0
  v_mfma_f32_16x16x32_bf16 v[24:27], v[28:31], v[44:47], v[24:27]
  ds_read_b128 v[52:55], v4 offset:24576
  ds_read_b128 v[56:59], v4 offset:25600
  v_mfma_f32_16x16x32_bf16 v[116:119], v[32:35], v[44:47], v[116:119]
  s_nop 1
  v_rcp_f32 v89, v88
  v_subrev_u32 v100, s54, v88
  v_cmp_le_u32 vcc, s55, v100
  v_mul_f32 v24, v89, v24
  v_mul_f32 v25, v89, v25
  s_cbranch_vccnz T_slow_92
T_back_93:
  v_cvt_pk_bf16_f32 v124, v24, v25
  v_pk_mul_f32 v[26:27], v[26:27], v[88:89] op_sel:[0,1] op_sel_hi:[1,1]
  v_pk_mul_f32 v[116:117], v[116:117], v[88:89] op_sel:[0,1] op_sel_hi:[1,1]
  v_pk_mul_f32 v[118:119], v[118:119], v[88:89] op_sel:[0,1] op_sel_hi:[1,1]
  v_cvt_pk_bf16_f32 v125, v26, v27
  v_cvt_pk_bf16_f32 v126, v116, v117
  v_cvt_pk_bf16_f32 v127, v118, v119
  ds_write_b128 v11, v[124:127] offset:29184
  s_nop 0
  v_smfmac_f32_16x16x64_bf16 v[92:95], v[124:127], a[160:167], v0
  v_smfmac_f32_16x16x64_bf16 v[96:99], v[124:127], a[168:175], v0
  v_smfmac_f32_16x16x64_bf16 v[36:39], v[124:127], a[176:183], v0
  v_smfmac_f32_16x16x64_bf16 v[40:43], v[124:127], a[184:191], v0
  s_waitcnt lgkmcnt(0)
  s_barrier
  ds_read_b128 v[104:107], v11 offset:29696
  ds_read_b128 v[108:111], v11 offset:30208
  ds_read_b128 v[68:71], v11 offset:30720
  s_waitcnt lgkmcnt(2)
  v_smfmac_f32_16x16x64_bf16 v[92:95], v[104:107], a[192:199], v0
  s_waitcnt lgkmcnt(1)
  ds_read_b128 v[76:79], v4 offset:28672
  v_smfmac_f32_16x16x64_bf16 v[92:95], v[108:111], a[224:231], v0
  s_waitcnt lgkmcnt(1)
  ds_read_b128 v[80:83], v4 offset:29696
  v_smfmac_f32_16x16x64_bf16 v[92:95], v[68:71], a[240:247], v0
  ds_read_b128 v[60:63], v4 offset:26624
  v_smfmac_f32_16x16x64_bf16 v[96:99], v[104:107], a[200:207], v0
  ds_read_b128 v[64:67], v4 offset:27648
  v_smfmac_f32_16x16x64_bf16 v[96:99], v[108:111], a[232:239], v0
  ds_read_b128 v[28:31], v4 offset:30720
  s_nop 0
  v_cvt_pk_bf16_f32 v16, v92, v93
  v_cvt_pk_bf16_f32 v17, v94, v95
  v_bfi_b32 v16, 1, s57, v16
  v_smfmac_f32_16x16x64_bf16 v[96:99], v[68:71], a[248:255], v0
  buffer_store_dwordx2 v[16:17], v7, s[4:7], s20 offen offset:0
  v_smfmac_f32_16x16x64_bf16 v[36:39], v[104:107], a[208:215], v0
  ds_read_b128 v[32:35], v4 offset:31744
  v_smfmac_f32_16x16x64_bf16 v[36:39], v[108:111], v[52:59], v0
  s_waitcnt lgkmcnt(4)
  s_nop 0
  v_cvt_pk_bf16_f32 v18, v96, v97
  v_cvt_pk_bf16_f32 v19, v98, v99
  v_bfi_b32 v18, 1, s57, v18
  v_smfmac_f32_16x16x64_bf16 v[36:39], v[68:71], v[76:83], v0
  buffer_store_dwordx2 v[18:19], v7, s[4:7], s20 offen offset:64
  v_smfmac_f32_16x16x64_bf16 v[40:43], v[104:107], a[216:223], v0
  s_waitcnt lgkmcnt(2)
  ds_read_b128 v[116:119], v2 offset:31232
  v_smfmac_f32_16x16x64_bf16 v[40:43], v[108:111], v[60:67], v0
  s_waitcnt lgkmcnt(1)
  s_nop 0
  v_cvt_pk_bf16_f32 v20, v36, v37
  v_cvt_pk_bf16_f32 v21, v38, v39
  v_bfi_b32 v20, 1, s57, v20
  v_smfmac_f32_16x16x64_bf16 v[40:43], v[68:71], v[28:35], v0
  buffer_store_dwordx2 v[20:21], v7, s[4:7], s21 offen offset:0
  s_nop 6
  v_cvt_pk_bf16_f32 v22, v40, v41
  v_cvt_pk_bf16_f32 v23, v42, v43
  v_bfi_b32 v22, 1, s57, v22
  buffer_store_dwordx2 v[22:23], v7, s[4:7], s21 offen offset:64
  ds_read_b128 v[68:71], v4 offset:0
  ds_read_b128 v[72:75], v4 offset:1024
  ds_read_b128 v[76:79], v4 offset:4096
  ds_read_b128 v[80:83], v4 offset:5120
  ds_read_b128 v[84:87], v4 offset:8192
  ds_read_b128 v[88:91], v4 offset:9216
  v_mov_b64 v[16:17], 0
  v_mov_b64 v[18:19], 0
  v_mov_b64 v[20:21], 0
  v_mov_b64 v[22:23], 0
  v_mov_b64 v[24:25], 0
  v_mov_b64 v[26:27], 0
  s_mov_b32 s19, 0
  v_mov_b32 v49, -1
  s_waitcnt vmcnt(2)
  buffer_load_dwordx4 v[52:55], v2, s[4:7], s22 offen offset:0 sc1
  buffer_load_dwordx4 v[56:59], v2, s[4:7], s22 offen offset:1024 sc1
  buffer_load_dwordx4 v[60:63], v2, s[4:7], s22 offen offset:2048 sc1
  buffer_load_dwordx4 v[64:67], v2, s[4:7], s22 offen offset:3072 sc1
  ds_read_b128 v[92:95], v4 offset:2048
  ds_read_b128 v[96:99], v4 offset:3072
  ds_read_b128 v[100:103], v4 offset:6144
  ds_read_b128 v[104:107], v4 offset:7168
  ds_read_b128 v[108:111], v4 offset:10240
  ds_read_b128 v[112:115], v4 offset:11264
  ds_read_b64 v[44:45], v2 offset:32256
  s_waitcnt lgkmcnt(0)
  v_readfirstlane_b32 s38, v44
  v_readfirstlane_b32 s37, v45
  s_nop 0
  s_add_u32 s37, s37, 30
  s_cmp_ge_u32 s38, 30
  s_cselect_b32 s38, s37, s38
  s_cmp_ge_u32 s38, 64
  s_cselect_b32 s38, 100, s38
  s_sub_u32 s38, s38, 1
  s_max_i32 s30, s30, s38
  s_waitcnt lgkmcnt(12)
  s_waitcnt vmcnt(3)
  v_mfma_f32_16x16x32_bf16 v[120:123], v[116:119], v[52:55], 0
  v_xor_b32 v48, s57, v52
  v_bitop3_b32 v48, v48, v54, s57 bitop3:0xf6
  s_waitcnt vmcnt(2)
  v_mfma_f32_16x16x32_bf16 v[120:123], v[116:119], v[56:59], v[120:123]
  v_bitop3_b32 v48, v48, v56, s57 bitop3:0xf6
  v_bitop3_b32 v48, v48, v58, s57 bitop3:0xf6
  s_waitcnt vmcnt(1)
  v_mfma_f32_16x16x32_bf16 v[120:123], v[116:119], v[60:63], v[120:123]
  v_bitop3_b32 v48, v48, v60, s57 bitop3:0xf6
  v_bitop3_b32 v48, v48, v62, s57 bitop3:0xf6
  s_waitcnt vmcnt(0)
  v_mfma_f32_16x16x32_bf16 v[120:123], v[116:119], v[64:67], v[120:123]
  v_bitop3_b32 v48, v48, v64, s57 bitop3:0xf6
  v_bitop3_b32 v48, v48, v66, s57 bitop3:0xf6
  v_and_b32 v48, 1, v48
  v_cmp_ne_u32 vcc, 0, v48
  s_cbranch_vccnz T_p1re_95
T_p1ok_96:
  s_nop 2
  v_add_f32_dpp v120, v120, v120 row_ror:8 row_mask:0xf bank_mask:0xf
  v_add_f32_dpp v121, v121, v121 row_ror:8 row_mask:0xf bank_mask:0xf
  v_cvt_pk_bf16_f32 v48, v120, v121
  v_min_u32 v48, -2, v48
  buffer_store_dword v48, v8, s[4:7], s35 offen
  buffer_store_dword v49, v8, s[4:7], s26 offen
  s_barrier
  ds_read_b128 v[28:31], v2 offset:16384
  ds_read_b128 v[32:35], v2 offset:20480
  ds_read_b128 v[36:39], v2 offset:8192
  ds_read_b128 v[40:43], v2 offset:9216
  ds_read_b128 v[44:47], v2 offset:10240
  ds_read_b128 v[48:51], v2 offset:11264
  buffer_load_dwordx4 v[124:127], v3, s[4:7], s24 offen offset:0 sc1
  buffer_load_dwordx4 v[116:119], v3, s[4:7], s25 offen offset:0 sc1
  ds_read_b128 v[52:55], v2 offset:12288
  ds_read_b128 v[56:59], v2 offset:13312
  ds_read_b128 v[60:63], v2 offset:14336
  ds_read_b128 v[64:67], v2 offset:15360
  buffer_load_dwordx4 v[124:127], v3, s[4:7], s24 offen offset:0 sc1
  buffer_load_dwordx4 v[116:119], v3, s[4:7], s25 offen offset:0 sc1
  s_mov_b32 s19, 0
  s_branch T_loop_85
T_p1re_95:
  s_mov_b64 exec, vcc
  buffer_load_dwordx4 v[52:55], v2, s[4:7], s22 offen offset:0 sc1
  buffer_load_dwordx4 v[56:59], v2, s[4:7], s22 offen offset:1024 sc1
  buffer_load_dwordx4 v[60:63], v2, s[4:7], s22 offen offset:2048 sc1
  buffer_load_dwordx4 v[64:67], v2, s[4:7], s22 offen offset:3072 sc1
  s_mov_b64 exec, -1
  s_add_u32 s19, s19, 1
  s_cmp_gt_u32 s19, 32768
  s_cbranch_scc1 M_exit
  s_waitcnt vmcnt(3)
  v_mfma_f32_16x16x32_bf16 v[120:123], v[116:119], v[52:55], 0
  v_xor_b32 v48, s57, v52
  v_bitop3_b32 v48, v48, v54, s57 bitop3:0xf6
  s_waitcnt vmcnt(2)
  v_mfma_f32_16x16x32_bf16 v[120:123], v[116:119], v[56:59], v[120:123]
  v_bitop3_b32 v48, v48, v56, s57 bitop3:0xf6
  v_bitop3_b32 v48, v48, v58, s57 bitop3:0xf6
  s_waitcnt vmcnt(1)
  v_mfma_f32_16x16x32_bf16 v[120:123], v[116:119], v[60:63], v[120:123]
  v_bitop3_b32 v48, v48, v60, s57 bitop3:0xf6
  v_bitop3_b32 v48, v48, v62, s57 bitop3:0xf6
  s_waitcnt vmcnt(0)
  v_mfma_f32_16x16x32_bf16 v[120:123], v[116:119], v[64:67], v[120:123]
  v_bitop3_b32 v48, v48, v64, s57 bitop3:0xf6
  v_bitop3_b32 v48, v48, v66, s57 bitop3:0xf6
  v_and_b32 v48, 1, v48
  v_cmp_ne_u32 vcc, 0, v48
  s_cbranch_vccnz T_p1re_95
  s_branch T_p1ok_96
T_kvw_89:
  s_mov_b32 s19, 0
  s_branch T_kvok_98
T_kv_97:
  s_sleep 4
  s_add_u32 s19, s19, 1
  s_cmp_gt_u32 s19, 32768
  s_cbranch_scc1 M_exit
T_kvok_98:
  s_add_u32 s39, s99, 128
  s_mov_b32 s38, 0
  s_mov_b32 s37, 0
  s_atomic_or s38, s[58:59], s99 glc
  s_atomic_or s37, s[58:59], s39 glc
  s_waitcnt lgkmcnt(0)
  s_add_u32 s37, s37, 30
  s_cmp_ge_u32 s38, 30
  s_cselect_b32 s38, s37, s38
  s_cmp_ge_u32 s38, 64
  s_cselect_b32 s38, 100, s38
  s_sub_u32 s38, s38, 1
  s_max_i32 s30, s30, s38
  s_cmp_ge_i32 s14, s30
  s_cbranch_scc1 T_kv_97
  s_branch T_kvb_90
T_slow_92:
  s_nop 7
  v_max3_f32 v100, v16, v17, v18
  v_max3_f32 v100, v100, v19, v20
  v_max3_f32 v100, v100, v21, v22
  v_max3_f32 v100, v100, v23, v112
  v_max3_f32 v100, v100, v113, v114
  v_max_f32 v100, v100, v115
  v_mov_b32 v101, v100
  s_nop 1
  v_permlane32_swap_b32 v100, v101
  s_nop 1
  v_max_f32 v100, v100, v101
  v_mov_b32 v101, v100
  s_nop 1
  v_permlane16_swap_b32 v100, v101
  s_nop 1
  v_max_f32 v100, v100, v101
  v_sub_f32 v16, v16, v100
  v_sub_f32 v17, v17, v100
  v_sub_f32 v18, v18, v100
  v_sub_f32 v19, v19, v100
  v_exp_f32 v16, v16
  v_exp_f32 v17, v17
  v_exp_f32 v18, v18
  v_exp_f32 v19, v19
  v_sub_f32 v20, v20, v100
  v_sub_f32 v21, v21, v100
  v_sub_f32 v22, v22, v100
  v_sub_f32 v23, v23, v100
  v_exp_f32 v20, v20
  v_exp_f32 v21, v21
  v_exp_f32 v22, v22
  v_exp_f32 v23, v23
  v_sub_f32 v112, v112, v100
  v_sub_f32 v113, v113, v100
  v_sub_f32 v114, v114, v100
  v_sub_f32 v115, v115, v100
  v_exp_f32 v112, v112
  v_exp_f32 v113, v113
  v_exp_f32 v114, v114
  v_exp_f32 v115, v115
  s_nop 0
  v_cvt_pk_bf16_f32 v44, v16, v17
  v_cvt_pk_bf16_f32 v45, v18, v19
  v_cvt_pk_bf16_f32 v46, v20, v21
  v_cvt_pk_bf16_f32 v47, v22, v23
  v_cvt_pk_bf16_f32 v84, v112, v113
  v_cvt_pk_bf16_f32 v85, v114, v115
  v_cndmask_b32 v48, v84, 0, s[16:17]
  v_cndmask_b32 v49, v85, 0, s[16:17]
  v_cndmask_b32 v50, 0, v84, s[16:17]
  v_cndmask_b32 v51, 0, v85, s[16:17]
  s_nop 1
  v_mfma_f32_16x16x16_bf16 v[88:91], v[12:13], v[48:49], 0
  v_mfma_f32_16x16x16_bf16 v[24:27], v[120:121], v[48:49], 0
  v_mfma_f32_16x16x16_bf16 v[116:119], v[120:121], v[50:51], 0
  v_mfma_f32_16x16x32_bf16 v[88:91], v[12:15], v[44:47], v[88:91]
  v_mfma_f32_16x16x32_bf16 v[24:27], v[28:31], v[44:47], v[24:27]
  v_mfma_f32_16x16x32_bf16 v[116:119], v[32:35], v[44:47], v[116:119]
  s_nop 7
  s_nop 1
  v_rcp_f32 v89, v88
  s_nop 0
  v_mul_f32 v24, v89, v24
  v_mul_f32 v25, v89, v25
  s_branch T_back_93
T_w_82:
  s_mov_b32 s19, 0
  v_mov_b64 v[16:17], 0
  v_mov_b64 v[18:19], 0
  v_mov_b64 v[20:21], 0
  v_mov_b64 v[22:23], 0
  v_mov_b64 v[24:25], 0
  v_mov_b64 v[26:27], 0
  buffer_load_dwordx4 v[124:127], v3, s[4:7], s24 offen offset:1024 sc1
  buffer_load_dwordx4 v[116:119], v3, s[4:7], s25 offen offset:1024 sc1
  buffer_load_dwordx4 v[124:127], v3, s[4:7], s24 offen offset:1024 sc1
  buffer_load_dwordx4 v[116:119], v3, s[4:7], s25 offen offset:1024 sc1
  s_branch T_loop_99
.p2align 6
T_retry_100:
  s_mov_b64 exec, vcc
  buffer_load_dwordx4 v[124:127], v3, s[4:7], s24 offen offset:1024 sc1
  buffer_load_dwordx4 v[116:119], v3, s[4:7], s25 offen offset:1024 sc1
  s_mov_b64 exec, -1
  s_add_u32 s19, s19, 1
  s_cmp_gt_u32 s19, 32768
  s_cbranch_scc1 M_exit
T_loop_99:
  s_waitcnt vmcnt(3) lgkmcnt(0)
  v_max3_u32 v123, v124, v125, v126
  v_max_u32 v123, v123, v127
  v_mov_b32_dpp v120, v124 row_ror:8 row_mask:0xf bank_mask:0xf
  v_mov_b32_dpp v121, v125 row_ror:8 row_mask:0xf bank_mask:0xf
  s_waitcnt vmcnt(2)
  v_max3_u32 v123, v123, v116, v117
  v_max3_u32 v123, v123, v118, v119
  v_cmp_eq_u32 vcc, -1, v123
  s_cbranch_vccnz T_retry_100
  v_smfmac_f32_16x16x64_bf16 v[16:19], v[124:127], v[68:75], v0
  s_add_u32 s14, s14, 1
  ds_write_b128 v2, v[124:127] offset:1024
  v_mov_b32_dpp v122, v126 row_ror:8 row_mask:0xf bank_mask:0xf
  v_smfmac_f32_16x16x64_bf16 v[20:23], v[124:127], v[76:83], v0
  s_and_b32 s57, s14, 1
  v_mov_b32_dpp v123, v127 row_ror:8 row_mask:0xf bank_mask:0xf
  v_smfmac_f32_16x16x64_bf16 v[24:27], v[124:127], v[84:91], v0
  s_and_b32 s36, s14, 3
  ds_write_b128 v2, v[116:119] offset:5120
  v_smfmac_f32_16x16x64_bf16 v[16:19], v[120:123], v[92:99], v0
  s_lshl_b32 s36, s36, 13
  v_mov_b32_dpp v84, v116 row_ror:8 row_mask:0xf bank_mask:0xf
  v_smfmac_f32_16x16x64_bf16 v[20:23], v[120:123], v[100:107], v0
  s_add_u32 s26, s36, s23
  ds_read_b128 v[68:71], v4 offset:12288
  v_mov_b32_dpp v85, v117 row_ror:8 row_mask:0xf bank_mask:0xf
  v_smfmac_f32_16x16x64_bf16 v[24:27], v[120:123], v[108:115], v0
  s_add_u32 s36, s36, 8192
  ds_read_b128 v[72:75], v4 offset:13312
  v_mov_b32_dpp v86, v118 row_ror:8 row_mask:0xf bank_mask:0xf
  v_smfmac_f32_16x16x64_bf16 v[16:19], v[116:119], v[224:231], v0
  s_and_b32 s36, s36, 0x7fff
  ds_read_b128 v[76:79], v4 offset:14336
  v_mov_b32_dpp v87, v119 row_ror:8 row_mask:0xf bank_mask:0xf
  v_smfmac_f32_16x16x64_bf16 v[20:23], v[116:119], v[240:247], v0
  s_waitcnt lgkmcnt(3)
  s_barrier
  ds_read_b128 v[100:103], v2 offset:0
  v_smfmac_f32_16x16x64_bf16 v[24:27], v[116:119], a[0:7], v0
  s_mov_b32 m0, s31
  ds_read_b128 v[120:123], v1 offset:0
  v_smfmac_f32_16x16x64_bf16 v[16:19], v[84:87], v[232:239], v0
  s_cmp_ge_i32 s14, s30
  s_cbranch_scc1 T_kvw_103
T_kvb_104:
  v_smfmac_f32_16x16x64_bf16 v[20:23], v[84:87], v[248:255], v0
  ds_read_b128 v[80:83], v4 offset:15360
  v_smfmac_f32_16x16x64_bf16 v[24:27], v[84:87], a[8:15], v0
  s_waitcnt lgkmcnt(2)
  buffer_load_dwordx4 v9, s[4:7], s27 offen sc1 lds
  v_smfmac_f32_16x16x64_bf16 v[16:19], v[100:103], v[128:135], v0
  ds_read_b128 v[92:95], v2 offset:3072
  s_mov_b32 m0, s32
  v_smfmac_f32_16x16x64_bf16 v[20:23], v[100:103], v[144:151], v0
  ds_read_b128 v[96:99], v1 offset:3072
  v_smfmac_f32_16x16x64_bf16 v[24:27], v[100:103], v[68:75], v0
  s_waitcnt vmcnt(1) lgkmcnt(3)
  ds_read_b128 v[116:119], v2 offset:2048
  v_smfmac_f32_16x16x64_bf16 v[16:19], v[120:123], v[136:143], v0
  ds_read_b128 v[124:127], v1 offset:2048
  buffer_load_dwordx4 v9, s[4:7], s27 offen offset:128 sc1 lds
  v_smfmac_f32_16x16x64_bf16 v[20:23], v[120:123], v[152:159], v0
  s_waitcnt lgkmcnt(4)
  ds_read_b128 v[104:107], v2 offset:4096
  s_mov_b32 m0, s33
  v_smfmac_f32_16x16x64_bf16 v[24:27], v[120:123], v[76:83], v0
  s_waitcnt lgkmcnt(4)
  ds_read_b128 v[108:111], v1 offset:4096
  v_smfmac_f32_16x16x64_bf16 v[16:19], v[92:95], v[160:167], v0
  s_waitcnt lgkmcnt(4)
  ds_read_b128 v[112:115], v2 offset:7168
  v_smfmac_f32_16x16x64_bf16 v[16:19], v[96:99], v[168:175], v0
  s_waitcnt lgkmcnt(4)
  ds_read_b128 v[84:87], v1 offset:7168
  buffer_load_dwordx4 v10, s[4:7], s28 offen sc1 lds
  v_smfmac_f32_16x16x64_bf16 v[16:19], v[116:119], v[192:199], v0
  s_waitcnt lgkmcnt(4)
  ds_read_b128 v[88:91], v2 offset:6144
  s_mov_b32 m0, s34
  v_smfmac_f32_16x16x64_bf16 v[16:19], v[124:127], v[200:207], v0
  s_waitcnt lgkmcnt(4)
  ds_read_b128 v[100:103], v1 offset:6144
  v_smfmac_f32_16x16x64_bf16 v[16:19], v[104:107], a[16:23], v0
  s_waitcnt lgkmcnt(4)
  ds_read_b128 v[68:71], v4 offset:16384
  v_smfmac_f32_16x16x64_bf16 v[16:19], v[108:111], a[24:31], v0
  s_waitcnt lgkmcnt(4)
  ds_read_b128 v[72:75], v4 offset:17408
  buffer_load_dwordx4 v10, s[4:7], s28 offen offset:256 sc1 lds
  v_smfmac_f32_16x16x64_bf16 v[16:19], v[112:115], a[64:71], v0
  s_waitcnt lgkmcnt(4)
  ds_read_b128 v[76:79], v4 offset:18432
  v_smfmac_f32_16x16x64_bf16 v[16:19], v[84:87], a[72:79], v0
  s_waitcnt lgkmcnt(4)
  ds_read_b128 v[80:83], v4 offset:19456
  v_smfmac_f32_16x16x64_bf16 v[16:19], v[88:91], a[112:119], v0
  s_waitcnt lgkmcnt(4)
  v_smfmac_f32_16x16x64_bf16 v[16:19], v[100:103], a[120:127], v0
  s_add_u32 s24, s36, 145752064
  s_add_u32 s25, s36, 145756160
  v_smfmac_f32_16x16x64_bf16 v[20:23], v[92:95], v[176:183], v0
  s_add_u32 s35, s36, s23
  v_smfmac_f32_16x16x64_bf16 v[20:23], v[96:99], v[184:191], v0
  s_waitcnt lgkmcnt(2)
  v_smfmac_f32_16x16x64_bf16 v[20:23], v[116:119], v[68:75], v0
  s_waitcnt lgkmcnt(0)
  ds_read_b128 v[68:71], v4 offset:20480
  v_mul_f32 v16, s18, v16
  v_smfmac_f32_16x16x64_bf16 v[20:23], v[124:127], v[76:83], v0
  ds_read_b128 v[72:75], v4 offset:21504
  v_mul_f32 v17, s18, v17
  v_smfmac_f32_16x16x64_bf16 v[20:23], v[104:107], a[32:39], v0
  ds_read_b128 v[76:79], v4 offset:22528
  v_mul_f32 v18, s18, v18
  v_smfmac_f32_16x16x64_bf16 v[20:23], v[108:111], a[40:47], v0
  ds_read_b128 v[80:83], v4 offset:23552
  v_mul_f32 v19, s18, v19
  v_smfmac_f32_16x16x64_bf16 v[20:23], v[112:115], a[80:87], v0
  v_cvt_pk_bf16_f32 v120, v16, v17
  v_smfmac_f32_16x16x64_bf16 v[20:23], v[84:87], a[88:95], v0
  v_cvt_pk_bf16_f32 v121, v18, v19
  v_smfmac_f32_16x16x64_bf16 v[20:23], v[88:91], a[128:135], v0
  ds_write_b64 v5, v[120:121] offset:24576
  v_smfmac_f32_16x16x64_bf16 v[20:23], v[100:103], a[136:143], v0
  s_waitcnt lgkmcnt(3)
  v_smfmac_f32_16x16x64_bf16 v[24:27], v[92:95], v[68:75], v0
  s_waitcnt lgkmcnt(1)
  v_mov_b64 v[92:93], 0
  v_smfmac_f32_16x16x64_bf16 v[24:27], v[96:99], v[76:83], v0
  s_nop 1
  v_cvt_pk_bf16_f32 v122, v20, v21
  v_cvt_pk_bf16_f32 v123, v22, v23
  v_smfmac_f32_16x16x64_bf16 v[24:27], v[116:119], v[208:215], v0
  ds_write_b64 v5, v[122:123] offset:26880
  v_mov_b64 v[94:95], 0
  v_smfmac_f32_16x16x64_bf16 v[24:27], v[124:127], v[216:223], v0
  s_waitcnt lgkmcnt(1)
  s_barrier
  ds_read_b64_tr_b16 v[68:69], v6 offset:24576
  v_smfmac_f32_16x16x64_bf16 v[24:27], v[104:107], a[48:55], v0
  s_add_u32 s27, s27, 8192
  ds_read_b64_tr_b16 v[70:71], v6 offset:24640
  ds_read_b64_tr_b16 v[72:73], v6 offset:24832
  v_smfmac_f32_16x16x64_bf16 v[24:27], v[108:111], a[56:63], v0
  s_add_u32 s28, s28, 8192
  ds_read_b64_tr_b16 v[74:75], v6 offset:24896
  ds_read_b64_tr_b16 v[76:77], v6 offset:25088
  v_smfmac_f32_16x16x64_bf16 v[24:27], v[112:115], a[96:103], v0
  s_nop 0
  ds_read_b64_tr_b16 v[78:79], v6 offset:25152
  ds_read_b64_tr_b16 v[80:81], v6 offset:25344
  v_smfmac_f32_16x16x64_bf16 v[24:27], v[84:87], a[104:111], v0
  ds_read_b64_tr_b16 v[82:83], v6 offset:25408
  v_mov_b64 v[96:97], 0
  v_smfmac_f32_16x16x64_bf16 v[24:27], v[88:91], a[144:151], v0
  s_waitcnt lgkmcnt(8)
  s_barrier
  ds_read_b64_tr_b16 v[116:117], v6 offset:26880
  v_smfmac_f32_16x16x64_bf16 v[24:27], v[100:103], a[152:159], v0
  s_waitcnt lgkmcnt(7)
  ds_read_b64_tr_b16 v[118:119], v6 offset:26944
  v_mfma_f32_16x16x32_bf16 v[16:19], v[36:39], v[68:71], 0
  s_waitcnt lgkmcnt(6)
  ds_read_b64_tr_b16 v[124:125], v6 offset:27136
  ds_read_b64_tr_b16 v[126:127], v6 offset:27200
  v_mfma_f32_16x16x32_bf16 v[16:19], v[40:43], v[72:75], v[16:19]
  s_waitcnt lgkmcnt(6)
  ds_read_b64_tr_b16 v[104:105], v6 offset:27392
  ds_read_b64_tr_b16 v[106:107], v6 offset:27456
  v_mfma_f32_16x16x32_bf16 v[16:19], v[44:47], v[76:79], v[16:19]
  s_waitcnt lgkmcnt(6)
  ds_read_b64_tr_b16 v[108:109], v6 offset:27648
  ds_read_b64_tr_b16 v[110:111], v6 offset:27712
  v_mfma_f32_16x16x32_bf16 v[16:19], v[48:51], v[80:83], v[16:19]
  s_waitcnt lgkmcnt(6)
  v_cvt_pk_bf16_f32 v120, v24, v25
  v_cvt_pk_bf16_f32 v121, v26, v27
  v_mfma_f32_16x16x32_bf16 v[112:115], v[116:119], v[68:71], 0
  s_waitcnt lgkmcnt(4)
  buffer_store_dwordx4 v[120:123], v2, s[4:7], s29 offen offset:1024 sc1
  v_mov_b64 v[98:99], 0
  v_mfma_f32_16x16x32_bf16 v[112:115], v[124:127], v[72:75], v[112:115]
  s_waitcnt lgkmcnt(2)
  v_mov_b64 v[36:37], 0
  v_exp_f32 v100, v16
  v_mfma_f32_16x16x32_bf16 v[112:115], v[104:107], v[76:79], v[112:115]
  s_waitcnt lgkmcnt(0)
  v_exp_f32 v101, v17
  v_mfma_f32_16x16x32_bf16 v[112:115], v[108:111], v[80:83], v[112:115]
  s_add_u32 s29, s29, 131072
  v_exp_f32 v102, v18
  v_mfma_f32_16x16x32_bf16 v[20:23], v[52:55], v[68:71], 0
  s_cmp_eq_u32 s14, 63
  v_exp_f32 v103, v19
  v_mfma_f32_16x16x32_bf16 v[20:23], v[56:59], v[72:75], v[20:23]
  s_cbranch_scc1 M_tdone
  v_cvt_pk_bf16_f32 v44, v100, v101
  v_cvt_pk_bf16_f32 v45, v102, v103
  v_mfma_f32_16x16x32_bf16 v[20:23], v[60:63], v[76:79], v[20:23]
  v_exp_f32 v100, v112
  v_mfma_f32_16x16x32_bf16 v[20:23], v[64:67], v[80:83], v[20:23]
  v_exp_f32 v101, v113
  v_exp_f32 v102, v114
  v_exp_f32 v103, v115
  v_cvt_pk_bf16_f32 v84, v100, v101
  v_cvt_pk_bf16_f32 v85, v102, v103
  v_cndmask_b32 v48, v84, 0, s[16:17]
  v_cndmask_b32 v49, v85, 0, s[16:17]
  v_cndmask_b32 v50, 0, v84, s[16:17]
  v_cndmask_b32 v51, 0, v85, s[16:17]
  v_exp_f32 v100, v20
  v_mfma_f32_16x16x16_bf16 v[88:91], v[12:13], v[48:49], 0
  v_exp_f32 v101, v21
  v_mfma_f32_16x16x16_bf16 v[24:27], v[120:121], v[48:49], 0
  v_exp_f32 v102, v22
  v_mfma_f32_16x16x16_bf16 v[116:119], v[120:121], v[50:51], 0
  v_exp_f32 v103, v23
  v_cvt_pk_bf16_f32 v46, v100, v101
  v_cvt_pk_bf16_f32 v47, v102, v103
  v_mov_b64 v[38:39], 0
  s_nop 0
  v_mfma_f32_16x16x32_bf16 v[88:91], v[12:15], v[44:47], v[88:91]
  v_mov_b64 v[40:41], 0
  v_mov_b64 v[42:43], 0
  v_mfma_f32_16x16x32_bf16 v[24:27], v[28:31], v[44:47], v[24:27]
  ds_read_b128 v[52:55], v4 offset:24576
  ds_read_b128 v[56:59], v4 offset:25600
  v_mfma_f32_16x16x32_bf16 v[116:119], v[32:35], v[44:47], v[116:119]
  s_nop 1
  v_rcp_f32 v89, v88
  v_subrev_u32 v100, s54, v88
  v_cmp_le_u32 vcc, s55, v100
  v_mul_f32 v24, v89, v24
  v_mul_f32 v25, v89, v25
  s_cbranch_vccnz T_slow_106
T_back_107:
  v_cvt_pk_bf16_f32 v124, v24, v25
  v_pk_mul_f32 v[26:27], v[26:27], v[88:89] op_sel:[0,1] op_sel_hi:[1,1]
  v_pk_mul_f32 v[116:117], v[116:117], v[88:89] op_sel:[0,1] op_sel_hi:[1,1]
  v_pk_mul_f32 v[118:119], v[118:119], v[88:89] op_sel:[0,1] op_sel_hi:[1,1]
  v_cvt_pk_bf16_f32 v125, v26, v27
  v_cvt_pk_bf16_f32 v126, v116, v117
  v_cvt_pk_bf16_f32 v127, v118, v119
  ds_write_b128 v11, v[124:127] offset:29696
  s_nop 0
  v_smfmac_f32_16x16x64_bf16 v[92:95], v[124:127], a[160:167], v0
  v_smfmac_f32_16x16x64_bf16 v[96:99], v[124:127], a[168:175], v0
  v_smfmac_f32_16x16x64_bf16 v[36:39], v[124:127], a[176:183], v0
  v_smfmac_f32_16x16x64_bf16 v[40:43], v[124:127], a[184:191], v0
  s_waitcnt lgkmcnt(0)
  s_barrier
  ds_read_b128 v[104:107], v11 offset:29184
  ds_read_b128 v[108:111], v11 offset:30720
  ds_read_b128 v[68:71], v11 offset:30208
  s_waitcnt lgkmcnt(2)
  v_smfmac_f32_16x16x64_bf16 v[92:95], v[104:107], a[192:199], v0
  s_waitcnt lgkmcnt(1)
  ds_read_b128 v[76:79], v4 offset:28672
  v_smfmac_f32_16x16x64_bf16 v[92:95], v[108:111], a[224:231], v0
  s_waitcnt lgkmcnt(1)
  ds_read_b128 v[80:83], v4 offset:29696
  v_smfmac_f32_16x16x64_bf16 v[92:95], v[68:71], a[240:247], v0
  ds_read_b128 v[60:63], v4 offset:26624
  v_smfmac_f32_16x16x64_bf16 v[96:99], v[104:107], a[200:207], v0
  ds_read_b128 v[64:67], v4 offset:27648
  v_smfmac_f32_16x16x64_bf16 v[96:99], v[108:111], a[232:239], v0
  ds_read_b128 v[28:31], v4 offset:30720
  s_nop 0
  v_cvt_pk_bf16_f32 v16, v92, v93
  v_cvt_pk_bf16_f32 v17, v94, v95
  v_bfi_b32 v16, 1, s57, v16
  v_smfmac_f32_16x16x64_bf16 v[96:99], v[68:71], a[248:255], v0
  buffer_store_dwordx2 v[16:17], v7, s[4:7], s20 offen offset:0
  v_smfmac_f32_16x16x64_bf16 v[36:39], v[104:107], a[208:215], v0
  ds_read_b128 v[32:35], v4 offset:31744
  v_smfmac_f32_16x16x64_bf16 v[36:39], v[108:111], v[52:59], v0
  s_waitcnt lgkmcnt(4)
  s_nop 0
  v_cvt_pk_bf16_f32 v18, v96, v97
  v_cvt_pk_bf16_f32 v19, v98, v99
  v_bfi_b32 v18, 1, s57, v18
  v_smfmac_f32_16x16x64_bf16 v[36:39], v[68:71], v[76:83], v0
  buffer_store_dwordx2 v[18:19], v7, s[4:7], s20 offen offset:64
  v_smfmac_f32_16x16x64_bf16 v[40:43], v[104:107], a[216:223], v0
  s_waitcnt lgkmcnt(2)
  ds_read_b128 v[116:119], v2 offset:31232
  v_smfmac_f32_16x16x64_bf16 v[40:43], v[108:111], v[60:67], v0
  s_waitcnt lgkmcnt(1)
  s_nop 0
  v_cvt_pk_bf16_f32 v20, v36, v37
  v_cvt_pk_bf16_f32 v21, v38, v39
  v_bfi_b32 v20, 1, s57, v20
  v_smfmac_f32_16x16x64_bf16 v[40:43], v[68:71], v[28:35], v0
  buffer_store_dwordx2 v[20:21], v7, s[4:7], s21 offen offset:0
  s_nop 6
  v_cvt_pk_bf16_f32 v22, v40, v41
  v_cvt_pk_bf16_f32 v23, v42, v43
  v_bfi_b32 v22, 1, s57, v22
  buffer_store_dwordx2 v[22:23], v7, s[4:7], s21 offen offset:64
  ds_read_b128 v[68:71], v4 offset:0
  ds_read_b128 v[72:75], v4 offset:1024
  ds_read_b128 v[76:79], v4 offset:4096
  ds_read_b128 v[80:83], v4 offset:5120
  ds_read_b128 v[84:87], v4 offset:8192
  ds_read_b128 v[88:91], v4 offset:9216
  ds_read_b128 v[92:95], v4 offset:2048
  ds_read_b128 v[96:99], v4 offset:3072
  ds_read_b128 v[100:103], v4 offset:6144
  ds_read_b128 v[104:107], v4 offset:7168
  ds_read_b128 v[108:111], v4 offset:10240
  ds_read_b128 v[112:115], v4 offset:11264
  v_mov_b64 v[16:17], 0
  v_mov_b64 v[18:19], 0
  v_mov_b64 v[20:21], 0
  v_mov_b64 v[22:23], 0
  v_mov_b64 v[24:25], 0
  v_mov_b64 v[26:27], 0
  s_mov_b32 s19, 0
  v_mov_b32 v49, -1
  ds_read_b64 v[44:45], v2 offset:32256
  s_waitcnt lgkmcnt(0)
  v_readfirstlane_b32 s38, v44
  v_readfirstlane_b32 s37, v45
  s_nop 0
  s_add_u32 s37, s37, 30
  s_cmp_ge_u32 s38, 30
  s_cselect_b32 s38, s37, s38
  s_cmp_ge_u32 s38, 64
  s_cselect_b32 s38, 100, s38
  s_sub_u32 s38, s38, 1
  s_max_i32 s30, s30, s38
  s_waitcnt vmcnt(0)
  buffer_load_dwordx4 v[52:55], v2, s[4:7], s22 offen offset:0 sc1
  buffer_load_dwordx4 v[56:59], v2, s[4:7], s22 offen offset:1024 sc1
  buffer_load_dwordx4 v[60:63], v2, s[4:7], s22 offen offset:2048 sc1
  buffer_load_dwordx4 v[64:67], v2, s[4:7], s22 offen offset:3072 sc1
  s_waitcnt lgkmcnt(12)
  s_waitcnt vmcnt(3)
  v_mfma_f32_16x16x32_bf16 v[120:123], v[116:119], v[52:55], 0
  v_xor_b32 v48, s57, v52
  v_bitop3_b32 v48, v48, v54, s57 bitop3:0xf6
  s_waitcnt vmcnt(2)
  v_mfma_f32_16x16x32_bf16 v[120:123], v[116:119], v[56:59], v[120:123]
  v_bitop3_b32 v48, v48, v56, s57 bitop3:0xf6
  v_bitop3_b32 v48, v48, v58, s57 bitop3:0xf6
  s_waitcnt vmcnt(1)
  v_mfma_f32_16x16x32_bf16 v[120:123], v[116:119], v[60:63], v[120:123]
  v_bitop3_b32 v48, v48, v60, s57 bitop3:0xf6
  v_bitop3_b32 v48, v48, v62, s57 bitop3:0xf6
  s_waitcnt vmcnt(0)
  v_mfma_f32_16x16x32_bf16 v[120:123], v[116:119], v[64:67], v[120:123]
  v_bitop3_b32 v48, v48, v64, s57 bitop3:0xf6
  v_bitop3_b32 v48, v48, v66, s57 bitop3:0xf6
  v_and_b32 v48, 1, v48
  v_cmp_ne_u32 vcc, 0, v48
  s_cbranch_vccnz T_p1re_109
T_p1ok_110:
  s_nop 2
  v_add_f32_dpp v120, v120, v120 row_ror:8 row_mask:0xf bank_mask:0xf
  v_add_f32_dpp v121, v121, v121 row_ror:8 row_mask:0xf bank_mask:0xf
  v_cvt_pk_bf16_f32 v48, v120, v121
  v_min_u32 v48, -2, v48
  buffer_store_dword v48, v8, s[4:7], s35 offen
  buffer_store_dword v49, v8, s[4:7], s26 offen
  s_barrier
  ds_read_b128 v[28:31], v2 offset:17408
  ds_read_b128 v[32:35], v2 offset:21504
  ds_read_b128 v[36:39], v2 offset:8192
  ds_read_b128 v[40:43], v2 offset:9216
  ds_read_b128 v[44:47], v2 offset:10240
  ds_read_b128 v[48:51], v2 offset:11264
  buffer_load_dwordx4 v[124:127], v3, s[4:7], s24 offen offset:1024 sc1
  buffer_load_dwordx4 v[116:119], v3, s[4:7], s25 offen offset:1024 sc1
  ds_read_b128 v[52:55], v2 offset:12288
  ds_read_b128 v[56:59], v2 offset:13312
  ds_read_b128 v[60:63], v2 offset:14336
  ds_read_b128 v[64:67], v2 offset:15360
  buffer_load_dwordx4 v[124:127], v3, s[4:7], s24 offen offset:1024 sc1
  buffer_load_dwordx4 v[116:119], v3, s[4:7], s25 offen offset:1024 sc1
  s_mov_b32 s19, 0
  s_branch T_loop_99
T_p1re_109:
  s_mov_b64 exec, vcc
  buffer_load_dwordx4 v[52:55], v2, s[4:7], s22 offen offset:0 sc1
  buffer_load_dwordx4 v[56:59], v2, s[4:7], s22 offen offset:1024 sc1
  buffer_load_dwordx4 v[60:63], v2, s[4:7], s22 offen offset:2048 sc1
  buffer_load_dwordx4 v[64:67], v2, s[4:7], s22 offen offset:3072 sc1
  s_mov_b64 exec, -1
  s_add_u32 s19, s19, 1
  s_cmp_gt_u32 s19, 32768
  s_cbranch_scc1 M_exit
  s_waitcnt vmcnt(3)
  v_mfma_f32_16x16x32_bf16 v[120:123], v[116:119], v[52:55], 0
  v_xor_b32 v48, s57, v52
  v_bitop3_b32 v48, v48, v54, s57 bitop3:0xf6
  s_waitcnt vmcnt(2)
  v_mfma_f32_16x16x32_bf16 v[120:123], v[116:119], v[56:59], v[120:123]
  v_bitop3_b32 v48, v48, v56, s57 bitop3:0xf6
  v_bitop3_b32 v48, v48, v58, s57 bitop3:0xf6
  s_waitcnt vmcnt(1)
  v_mfma_f32_16x16x32_bf16 v[120:123], v[116:119], v[60:63], v[120:123]
  v_bitop3_b32 v48, v48, v60, s57 bitop3:0xf6
  v_bitop3_b32 v48, v48, v62, s57 bitop3:0xf6
  s_waitcnt vmcnt(0)
  v_mfma_f32_16x16x32_bf16 v[120:123], v[116:119], v[64:67], v[120:123]
  v_bitop3_b32 v48, v48, v64, s57 bitop3:0xf6
  v_bitop3_b32 v48, v48, v66, s57 bitop3:0xf6
  v_and_b32 v48, 1, v48
  v_cmp_ne_u32 vcc, 0, v48
  s_cbranch_vccnz T_p1re_109
  s_branch T_p1ok_110
T_kvw_103:
  s_mov_b32 s19, 0
  s_branch T_kvok_112
T_kv_111:
  s_sleep 4
  s_add_u32 s19, s19, 1
  s_cmp_gt_u32 s19, 32768
  s_cbranch_scc1 M_exit
T_kvok_112:
  s_add_u32 s39, s99, 128
  s_mov_b32 s38, 0
  s_mov_b32 s37, 0
  s_atomic_or s38, s[58:59], s99 glc
  s_atomic_or s37, s[58:59], s39 glc
  s_waitcnt lgkmcnt(0)
  s_add_u32 s37, s37, 30
  s_cmp_ge_u32 s38, 30
  s_cselect_b32 s38, s37, s38
  s_cmp_ge_u32 s38, 64
  s_cselect_b32 s38, 100, s38
  s_sub_u32 s38, s38, 1
  s_max_i32 s30, s30, s38
  s_cmp_ge_i32 s14, s30
  s_cbranch_scc1 T_kv_111
  s_branch T_kvb_104
T_slow_106:
  s_nop 7
  v_max3_f32 v100, v16, v17, v18
  v_max3_f32 v100, v100, v19, v20
  v_max3_f32 v100, v100, v21, v22
  v_max3_f32 v100, v100, v23, v112
  v_max3_f32 v100, v100, v113, v114
  v_max_f32 v100, v100, v115
  v_mov_b32 v101, v100
  s_nop 1
  v_permlane32_swap_b32 v100, v101
  s_nop 1
  v_max_f32 v100, v100, v101
  v_mov_b32 v101, v100
  s_nop 1
  v_permlane16_swap_b32 v100, v101
  s_nop 1
  v_max_f32 v100, v100, v101
  v_sub_f32 v16, v16, v100
  v_sub_f32 v17, v17, v100
  v_sub_f32 v18, v18, v100
  v_sub_f32 v19, v19, v100
  v_exp_f32 v16, v16
  v_exp_f32 v17, v17
  v_exp_f32 v18, v18
  v_exp_f32 v19, v19
  v_sub_f32 v20, v20, v100
  v_sub_f32 v21, v21, v100
  v_sub_f32 v22, v22, v100
  v_sub_f32 v23, v23, v100
  v_exp_f32 v20, v20
  v_exp_f32 v21, v21
  v_exp_f32 v22, v22
  v_exp_f32 v23, v23
  v_sub_f32 v112, v112, v100
  v_sub_f32 v113, v113, v100
  v_sub_f32 v114, v114, v100
  v_sub_f32 v115, v115, v100
  v_exp_f32 v112, v112
  v_exp_f32 v113, v113
  v_exp_f32 v114, v114
  v_exp_f32 v115, v115
  s_nop 0
  v_cvt_pk_bf16_f32 v44, v16, v17
  v_cvt_pk_bf16_f32 v45, v18, v19
  v_cvt_pk_bf16_f32 v46, v20, v21
  v_cvt_pk_bf16_f32 v47, v22, v23
  v_cvt_pk_bf16_f32 v84, v112, v113
  v_cvt_pk_bf16_f32 v85, v114, v115
  v_cndmask_b32 v48, v84, 0, s[16:17]
  v_cndmask_b32 v49, v85, 0, s[16:17]
  v_cndmask_b32 v50, 0, v84, s[16:17]
  v_cndmask_b32 v51, 0, v85, s[16:17]
  s_nop 1
  v_mfma_f32_16x16x16_bf16 v[88:91], v[12:13], v[48:49], 0
  v_mfma_f32_16x16x16_bf16 v[24:27], v[120:121], v[48:49], 0
  v_mfma_f32_16x16x16_bf16 v[116:119], v[120:121], v[50:51], 0
  v_mfma_f32_16x16x32_bf16 v[88:91], v[12:15], v[44:47], v[88:91]
  v_mfma_f32_16x16x32_bf16 v[24:27], v[28:31], v[44:47], v[24:27]
  v_mfma_f32_16x16x32_bf16 v[116:119], v[32:35], v[44:47], v[116:119]
  s_nop 7
  s_nop 1
  v_rcp_f32 v89, v88
  s_nop 0
  v_mul_f32 v24, v89, v24
  v_mul_f32 v25, v89, v25
  s_branch T_back_107
T_w_83:
  s_mov_b32 s19, 0
  v_mov_b64 v[16:17], 0
  v_mov_b64 v[18:19], 0
  v_mov_b64 v[20:21], 0
  v_mov_b64 v[22:23], 0
  v_mov_b64 v[24:25], 0
  v_mov_b64 v[26:27], 0
  buffer_load_dwordx4 v[124:127], v3, s[4:7], s24 offen offset:2048 sc1
  buffer_load_dwordx4 v[116:119], v3, s[4:7], s25 offen offset:2048 sc1
  buffer_load_dwordx4 v[124:127], v3, s[4:7], s24 offen offset:2048 sc1
  buffer_load_dwordx4 v[116:119], v3, s[4:7], s25 offen offset:2048 sc1
  s_branch T_loop_113
.p2align 6
T_retry_114:
  s_mov_b64 exec, vcc
  buffer_load_dwordx4 v[124:127], v3, s[4:7], s24 offen offset:2048 sc1
  buffer_load_dwordx4 v[116:119], v3, s[4:7], s25 offen offset:2048 sc1
  s_mov_b64 exec, -1
  s_add_u32 s19, s19, 1
  s_cmp_gt_u32 s19, 32768
  s_cbranch_scc1 M_exit
T_loop_113:
  s_waitcnt vmcnt(3) lgkmcnt(0)
  v_max3_u32 v123, v124, v125, v126
  v_max_u32 v123, v123, v127
  v_mov_b32_dpp v120, v124 row_ror:8 row_mask:0xf bank_mask:0xf
  v_mov_b32_dpp v121, v125 row_ror:8 row_mask:0xf bank_mask:0xf
  s_waitcnt vmcnt(2)
  v_max3_u32 v123, v123, v116, v117
  v_max3_u32 v123, v123, v118, v119
  v_cmp_eq_u32 vcc, -1, v123
  s_cbranch_vccnz T_retry_114
  v_smfmac_f32_16x16x64_bf16 v[16:19], v[124:127], v[68:75], v0
  s_add_u32 s14, s14, 1
  ds_write_b128 v2, v[124:127] offset:2048
  v_mov_b32_dpp v122, v126 row_ror:8 row_mask:0xf bank_mask:0xf
  v_smfmac_f32_16x16x64_bf16 v[20:23], v[124:127], v[76:83], v0
  s_and_b32 s57, s14, 1
  v_mov_b32_dpp v123, v127 row_ror:8 row_mask:0xf bank_mask:0xf
  v_smfmac_f32_16x16x64_bf16 v[24:27], v[124:127], v[84:91], v0
  s_and_b32 s36, s14, 3
  ds_write_b128 v2, v[116:119] offset:6144
  v_smfmac_f32_16x16x64_bf16 v[16:19], v[120:123], v[92:99], v0
  s_lshl_b32 s36, s36, 13
  v_mov_b32_dpp v84, v116 row_ror:8 row_mask:0xf bank_mask:0xf
  v_smfmac_f32_16x16x64_bf16 v[20:23], v[120:123], v[100:107], v0
  s_add_u32 s26, s36, s23
  ds_read_b128 v[68:71], v4 offset:12288
  v_mov_b32_dpp v85, v117 row_ror:8 row_mask:0xf bank_mask:0xf
  v_smfmac_f32_16x16x64_bf16 v[24:27], v[120:123], v[108:115], v0
  s_add_u32 s36, s36, 8192
  ds_read_b128 v[72:75], v4 offset:13312
  v_mov_b32_dpp v86, v118 row_ror:8 row_mask:0xf bank_mask:0xf
  v_smfmac_f32_16x16x64_bf16 v[16:19], v[116:119], v[224:231], v0
  s_and_b32 s36, s36, 0x7fff
  ds_read_b128 v[76:79], v4 offset:14336
  v_mov_b32_dpp v87, v119 row_ror:8 row_mask:0xf bank_mask:0xf
  v_smfmac_f32_16x16x64_bf16 v[20:23], v[116:119], v[240:247], v0
  s_waitcnt lgkmcnt(3)
  s_barrier
  ds_read_b128 v[100:103], v2 offset:3072
  v_smfmac_f32_16x16x64_bf16 v[24:27], v[116:119], a[0:7], v0
  s_mov_b32 m0, s31
  ds_read_b128 v[120:123], v1 offset:3072
  v_smfmac_f32_16x16x64_bf16 v[16:19], v[84:87], v[232:239], v0
  s_cmp_ge_i32 s14, s30
  s_cbranch_scc1 T_kvw_117
T_kvb_118:
  v_smfmac_f32_16x16x64_bf16 v[20:23], v[84:87], v[248:255], v0
  ds_read_b128 v[80:83], v4 offset:15360
  v_smfmac_f32_16x16x64_bf16 v[24:27], v[84:87], a[8:15], v0
  s_waitcnt lgkmcnt(2)
  v_smfmac_f32_16x16x64_bf16 v[16:19], v[100:103], v[128:135], v0
  ds_read_b128 v[92:95], v2 offset:0
  buffer_load_dwordx4 v9, s[4:7], s27 offen sc1 lds
  v_smfmac_f32_16x16x64_bf16 v[20:23], v[100:103], v[144:151], v0
  ds_read_b128 v[96:99], v1 offset:0
  s_mov_b32 m0, s32
  v_smfmac_f32_16x16x64_bf16 v[24:27], v[100:103], v[68:75], v0
  s_waitcnt vmcnt(1) lgkmcnt(3)
  ds_read_b128 v[116:119], v2 offset:1024
  v_smfmac_f32_16x16x64_bf16 v[16:19], v[120:123], v[136:143], v0
  ds_read_b128 v[124:127], v1 offset:1024
  v_smfmac_f32_16x16x64_bf16 v[20:23], v[120:123], v[152:159], v0
  s_waitcnt lgkmcnt(4)
  ds_read_b128 v[104:107], v2 offset:7168
  buffer_load_dwordx4 v9, s[4:7], s27 offen offset:128 sc1 lds
  v_smfmac_f32_16x16x64_bf16 v[24:27], v[120:123], v[76:83], v0
  s_waitcnt lgkmcnt(4)
  ds_read_b128 v[108:111], v1 offset:7168
  s_mov_b32 m0, s33
  v_smfmac_f32_16x16x64_bf16 v[16:19], v[92:95], v[160:167], v0
  s_waitcnt lgkmcnt(4)
  ds_read_b128 v[112:115], v2 offset:4096
  v_mov_b32 v122, s98
  v_smfmac_f32_16x16x64_bf16 v[16:19], v[96:99], v[168:175], v0
  s_waitcnt lgkmcnt(4)
  ds_read_b128 v[84:87], v1 offset:4096
  v_smfmac_f32_16x16x64_bf16 v[16:19], v[116:119], v[192:199], v0
  s_waitcnt lgkmcnt(4)
  ds_read_b128 v[88:91], v2 offset:5120
  buffer_load_dwordx4 v10, s[4:7], s28 offen sc1 lds
  v_smfmac_f32_16x16x64_bf16 v[16:19], v[124:127], v[200:207], v0
  s_waitcnt lgkmcnt(4)
  ds_read_b128 v[100:103], v1 offset:5120
  s_mov_b32 m0, s34
  v_smfmac_f32_16x16x64_bf16 v[16:19], v[104:107], a[16:23], v0
  s_waitcnt lgkmcnt(4)
  ds_read_b128 v[68:71], v4 offset:16384
  v_smfmac_f32_16x16x64_bf16 v[16:19], v[108:111], a[24:31], v0
  s_waitcnt lgkmcnt(4)
  ds_read_b128 v[72:75], v4 offset:17408
  v_smfmac_f32_16x16x64_bf16 v[16:19], v[112:115], a[64:71], v0
  s_waitcnt lgkmcnt(4)
  ds_read_b128 v[76:79], v4 offset:18432
  buffer_load_dwordx4 v10, s[4:7], s28 offen offset:256 sc1 lds
  v_smfmac_f32_16x16x64_bf16 v[16:19], v[84:87], a[72:79], v0
  s_waitcnt lgkmcnt(4)
  ds_read_b128 v[80:83], v4 offset:19456
  v_smfmac_f32_16x16x64_bf16 v[16:19], v[88:91], a[112:119], v0
  s_waitcnt lgkmcnt(4)
  v_smfmac_f32_16x16x64_bf16 v[16:19], v[100:103], a[120:127], v0
  s_add_u32 s24, s36, 145752064
  s_add_u32 s25, s36, 145756160
  v_smfmac_f32_16x16x64_bf16 v[20:23], v[92:95], v[176:183], v0
  buffer_store_dword v122, v8, s[4:7], s15 offen sc1
  s_add_u32 s35, s36, s23
  v_smfmac_f32_16x16x64_bf16 v[20:23], v[96:99], v[184:191], v0
  s_waitcnt lgkmcnt(2)
  s_add_u32 s98, s14, 1
  v_smfmac_f32_16x16x64_bf16 v[20:23], v[116:119], v[68:75], v0
  s_waitcnt lgkmcnt(0)
  ds_read_b128 v[68:71], v4 offset:20480
  v_mul_f32 v16, s18, v16
  v_smfmac_f32_16x16x64_bf16 v[20:23], v[124:127], v[76:83], v0
  ds_read_b128 v[72:75], v4 offset:21504
  v_mul_f32 v17, s18, v17
  v_smfmac_f32_16x16x64_bf16 v[20:23], v[104:107], a[32:39], v0
  ds_read_b128 v[76:79], v4 offset:22528
  v_mul_f32 v18, s18, v18
  v_smfmac_f32_16x16x64_bf16 v[20:23], v[108:111], a[40:47], v0
  ds_read_b128 v[80:83], v4 offset:23552
  v_mul_f32 v19, s18, v19
  v_smfmac_f32_16x16x64_bf16 v[20:23], v[112:115], a[80:87], v0
  v_cvt_pk_bf16_f32 v120, v16, v17
  v_smfmac_f32_16x16x64_bf16 v[20:23], v[84:87], a[88:95], v0
  v_cvt_pk_bf16_f32 v121, v18, v19
  v_smfmac_f32_16x16x64_bf16 v[20:23], v[88:91], a[128:135], v0
  ds_write_b64 v5, v[120:121] offset:24576
  v_smfmac_f32_16x16x64_bf16 v[20:23], v[100:103], a[136:143], v0
  s_waitcnt lgkmcnt(3)
  v_smfmac_f32_16x16x64_bf16 v[24:27], v[92:95], v[68:75], v0
  s_waitcnt lgkmcnt(1)
  v_mov_b64 v[92:93], 0
  v_smfmac_f32_16x16x64_bf16 v[24:27], v[96:99], v[76:83], v0
  s_nop 1
  v_cvt_pk_bf16_f32 v122, v20, v21
  v_cvt_pk_bf16_f32 v123, v22, v23
  v_smfmac_f32_16x16x64_bf16 v[24:27], v[116:119], v[208:215], v0
  ds_write_b64 v5, v[122:123] offset:26880
  v_mov_b64 v[94:95], 0
  v_smfmac_f32_16x16x64_bf16 v[24:27], v[124:127], v[216:223], v0
  s_waitcnt lgkmcnt(1)
  s_barrier
  ds_read_b64_tr_b16 v[68:69], v6 offset:24576
  v_smfmac_f32_16x16x64_bf16 v[24:27], v[104:107], a[48:55], v0
  s_add_u32 s27, s27, 8192
  ds_read_b64_tr_b16 v[70:71], v6 offset:24640
  ds_read_b64_tr_b16 v[72:73], v6 offset:24832
  v_smfmac_f32_16x16x64_bf16 v[24:27], v[108:111], a[56:63], v0
  s_add_u32 s28, s28, 8192
  ds_read_b64_tr_b16 v[74:75], v6 offset:24896
  ds_read_b64_tr_b16 v[76:77], v6 offset:25088
  v_smfmac_f32_16x16x64_bf16 v[24:27], v[112:115], a[96:103], v0
  s_nop 0
  ds_read_b64_tr_b16 v[78:79], v6 offset:25152
  ds_read_b64_tr_b16 v[80:81], v6 offset:25344
  v_smfmac_f32_16x16x64_bf16 v[24:27], v[84:87], a[104:111], v0
  ds_read_b64_tr_b16 v[82:83], v6 offset:25408
  v_mov_b64 v[96:97], 0
  v_smfmac_f32_16x16x64_bf16 v[24:27], v[88:91], a[144:151], v0
  s_waitcnt lgkmcnt(8)
  s_barrier
  ds_read_b64_tr_b16 v[116:117], v6 offset:26880
  v_smfmac_f32_16x16x64_bf16 v[24:27], v[100:103], a[152:159], v0
  s_waitcnt lgkmcnt(7)
  ds_read_b64_tr_b16 v[118:119], v6 offset:26944
  v_mfma_f32_16x16x32_bf16 v[16:19], v[36:39], v[68:71], 0
  s_waitcnt lgkmcnt(6)
  ds_read_b64_tr_b16 v[124:125], v6 offset:27136
  ds_read_b64_tr_b16 v[126:127], v6 offset:27200
  v_mfma_f32_16x16x32_bf16 v[16:19], v[40:43], v[72:75], v[16:19]
  s_waitcnt lgkmcnt(6)
  ds_read_b64_tr_b16 v[104:105], v6 offset:27392
  ds_read_b64_tr_b16 v[106:107], v6 offset:27456
  v_mfma_f32_16x16x32_bf16 v[16:19], v[44:47], v[76:79], v[16:19]
  s_waitcnt lgkmcnt(6)
  ds_read_b64_tr_b16 v[108:109], v6 offset:27648
  ds_read_b64_tr_b16 v[110:111], v6 offset:27712
  v_mfma_f32_16x16x32_bf16 v[16:19], v[48:51], v[80:83], v[16:19]
  s_waitcnt lgkmcnt(6)
  v_cvt_pk_bf16_f32 v120, v24, v25
  v_cvt_pk_bf16_f32 v121, v26, v27
  v_mfma_f32_16x16x32_bf16 v[112:115], v[116:119], v[68:71], 0
  s_waitcnt lgkmcnt(4)
  buffer_store_dwordx4 v[120:123], v2, s[4:7], s29 offen offset:2048 sc1
  v_mov_b64 v[98:99], 0
  v_mfma_f32_16x16x32_bf16 v[112:115], v[124:127], v[72:75], v[112:115]
  s_waitcnt lgkmcnt(2)
  v_mov_b64 v[36:37], 0
  v_exp_f32 v100, v16
  v_mfma_f32_16x16x32_bf16 v[112:115], v[104:107], v[76:79], v[112:115]
  s_waitcnt lgkmcnt(0)
  v_exp_f32 v101, v17
  v_mfma_f32_16x16x32_bf16 v[112:115], v[108:111], v[80:83], v[112:115]
  s_add_u32 s29, s29, 131072
  v_exp_f32 v102, v18
  v_mfma_f32_16x16x32_bf16 v[20:23], v[52:55], v[68:71], 0
  s_cmp_eq_u32 s14, 63
  v_exp_f32 v103, v19
  v_mfma_f32_16x16x32_bf16 v[20:23], v[56:59], v[72:75], v[20:23]
  s_cbranch_scc1 M_tdone
  v_cvt_pk_bf16_f32 v44, v100, v101
  v_cvt_pk_bf16_f32 v45, v102, v103
  v_mfma_f32_16x16x32_bf16 v[20:23], v[60:63], v[76:79], v[20:23]
  v_exp_f32 v100, v112
  v_mfma_f32_16x16x32_bf16 v[20:23], v[64:67], v[80:83], v[20:23]
  v_exp_f32 v101, v113
  v_exp_f32 v102, v114
  v_exp_f32 v103, v115
  v_cvt_pk_bf16_f32 v84, v100, v101
  v_cvt_pk_bf16_f32 v85, v102, v103
  v_cndmask_b32 v48, v84, 0, s[16:17]
  v_cndmask_b32 v49, v85, 0, s[16:17]
  v_cndmask_b32 v50, 0, v84, s[16:17]
  v_cndmask_b32 v51, 0, v85, s[16:17]
  v_exp_f32 v100, v20
  v_mfma_f32_16x16x16_bf16 v[88:91], v[12:13], v[48:49], 0
  v_exp_f32 v101, v21
  v_mfma_f32_16x16x16_bf16 v[24:27], v[120:121], v[48:49], 0
  v_exp_f32 v102, v22
  v_mfma_f32_16x16x16_bf16 v[116:119], v[120:121], v[50:51], 0
  v_exp_f32 v103, v23
  v_cvt_pk_bf16_f32 v46, v100, v101
  v_cvt_pk_bf16_f32 v47, v102, v103
  v_mov_b64 v[38:39], 0
  s_nop 0
  v_mfma_f32_16x16x32_bf16 v[88:91], v[12:15], v[44:47], v[88:91]
  v_mov_b64 v[40:41], 0
  v_mov_b64 v[42:43], 0
  v_mfma_f32_16x16x32_bf16 v[24:27], v[28:31], v[44:47], v[24:27]
  ds_read_b128 v[52:55], v4 offset:24576
  ds_read_b128 v[56:59], v4 offset:25600
  v_mfma_f32_16x16x32_bf16 v[116:119], v[32:35], v[44:47], v[116:119]
  s_nop 1
  v_rcp_f32 v89, v88
  v_subrev_u32 v100, s54, v88
  v_cmp_le_u32 vcc, s55, v100
  v_mul_f32 v24, v89, v24
  v_mul_f32 v25, v89, v25
  s_cbranch_vccnz T_slow_120
T_back_121:
  v_cvt_pk_bf16_f32 v124, v24, v25
  v_pk_mul_f32 v[26:27], v[26:27], v[88:89] op_sel:[0,1] op_sel_hi:[1,1]
  v_pk_mul_f32 v[116:117], v[116:117], v[88:89] op_sel:[0,1] op_sel_hi:[1,1]
  v_pk_mul_f32 v[118:119], v[118:119], v[88:89] op_sel:[0,1] op_sel_hi:[1,1]
  v_cvt_pk_bf16_f32 v125, v26, v27
  v_cvt_pk_bf16_f32 v126, v116, v117
  v_cvt_pk_bf16_f32 v127, v118, v119
  ds_write_b128 v11, v[124:127] offset:30208
  s_nop 0
  v_smfmac_f32_16x16x64_bf16 v[92:95], v[124:127], a[160:167], v0
  v_smfmac_f32_16x16x64_bf16 v[96:99], v[124:127], a[168:175], v0
  v_smfmac_f32_16x16x64_bf16 v[36:39], v[124:127], a[176:183], v0
  v_smfmac_f32_16x16x64_bf16 v[40:43], v[124:127], a[184:191], v0
  s_waitcnt lgkmcnt(0)
  s_barrier
  ds_read_b128 v[104:107], v11 offset:30720
  ds_read_b128 v[108:111], v11 offset:29184
  ds_read_b128 v[68:71], v11 offset:29696
  s_waitcnt lgkmcnt(2)
  v_smfmac_f32_16x16x64_bf16 v[92:95], v[104:107], a[192:199], v0
  s_waitcnt lgkmcnt(1)
  ds_read_b128 v[76:79], v4 offset:28672
  v_smfmac_f32_16x16x64_bf16 v[92:95], v[108:111], a[224:231], v0
  s_waitcnt lgkmcnt(1)
  ds_read_b128 v[80:83], v4 offset:29696
  v_smfmac_f32_16x16x64_bf16 v[92:95], v[68:71], a[240:247], v0
  ds_read_b128 v[60:63], v4 offset:26624
  v_smfmac_f32_16x16x64_bf16 v[96:99], v[104:107], a[200:207], v0
  ds_read_b128 v[64:67], v4 offset:27648
  v_smfmac_f32_16x16x64_bf16 v[96:99], v[108:111], a[232:239], v0
  ds_read_b128 v[28:31], v4 offset:30720
  s_nop 0
  v_cvt_pk_bf16_f32 v16, v92, v93
  v_cvt_pk_bf16_f32 v17, v94, v95
  v_bfi_b32 v16, 1, s57, v16
  v_smfmac_f32_16x16x64_bf16 v[96:99], v[68:71], a[248:255], v0
  buffer_store_dwordx2 v[16:17], v7, s[4:7], s20 offen offset:0
  v_smfmac_f32_16x16x64_bf16 v[36:39], v[104:107], a[208:215], v0
  ds_read_b128 v[32:35], v4 offset:31744
  v_smfmac_f32_16x16x64_bf16 v[36:39], v[108:111], v[52:59], v0
  s_waitcnt lgkmcnt(4)
  s_nop 0
  v_cvt_pk_bf16_f32 v18, v96, v97
  v_cvt_pk_bf16_f32 v19, v98, v99
  v_bfi_b32 v18, 1, s57, v18
  v_smfmac_f32_16x16x64_bf16 v[36:39], v[68:71], v[76:83], v0
  buffer_store_dwordx2 v[18:19], v7, s[4:7], s20 offen offset:64
  v_smfmac_f32_16x16x64_bf16 v[40:43], v[104:107], a[216:223], v0
  s_waitcnt lgkmcnt(2)
  v_smfmac_f32_16x16x64_bf16 v[40:43], v[108:111], v[60:67], v0
  s_waitcnt lgkmcnt(0)
  s_nop 0
  v_cvt_pk_bf16_f32 v20, v36, v37
  v_cvt_pk_bf16_f32 v21, v38, v39
  v_bfi_b32 v20, 1, s57, v20
  v_smfmac_f32_16x16x64_bf16 v[40:43], v[68:71], v[28:35], v0
  buffer_store_dwordx2 v[20:21], v7, s[4:7], s21 offen offset:0
  s_nop 6
  v_cvt_pk_bf16_f32 v22, v40, v41
  v_cvt_pk_bf16_f32 v23, v42, v43
  v_bfi_b32 v22, 1, s57, v22
  buffer_store_dwordx2 v[22:23], v7, s[4:7], s21 offen offset:64
  ds_read_b128 v[68:71], v4 offset:0
  ds_read_b128 v[72:75], v4 offset:1024
  ds_read_b128 v[76:79], v4 offset:4096
  ds_read_b128 v[80:83], v4 offset:5120
  ds_read_b128 v[84:87], v4 offset:8192
  ds_read_b128 v[88:91], v4 offset:9216
  ds_read_b128 v[92:95], v4 offset:2048
  ds_read_b128 v[96:99], v4 offset:3072
  ds_read_b128 v[100:103], v4 offset:6144
  ds_read_b128 v[104:107], v4 offset:7168
  ds_read_b128 v[108:111], v4 offset:10240
  ds_read_b128 v[112:115], v4 offset:11264
  v_mov_b64 v[16:17], 0
  v_mov_b64 v[18:19], 0
  v_mov_b64 v[20:21], 0
  v_mov_b64 v[22:23], 0
  v_mov_b64 v[24:25], 0
  v_mov_b64 v[26:27], 0
  ds_read_b64 v[44:45], v2 offset:32256
  s_waitcnt lgkmcnt(0)
  v_readfirstlane_b32 s38, v44
  v_readfirstlane_b32 s37, v45
  s_nop 0
  s_add_u32 s37, s37, 30
  s_cmp_ge_u32 s38, 30
  s_cselect_b32 s38, s37, s38
  s_cmp_ge_u32 s38, 64
  s_cselect_b32 s38, 100, s38
  s_sub_u32 s38, s38, 1
  s_max_i32 s30, s30, s38
  s_waitcnt vmcnt(4)
  s_barrier
  ds_read_b128 v[28:31], v2 offset:18432
  ds_read_b128 v[32:35], v2 offset:22528
  ds_read_b128 v[36:39], v2 offset:8192
  ds_read_b128 v[40:43], v2 offset:9216
  ds_read_b128 v[44:47], v2 offset:10240
  ds_read_b128 v[48:51], v2 offset:11264
  buffer_load_dwordx4 v[124:127], v3, s[4:7], s24 offen offset:2048 sc1
  buffer_load_dwordx4 v[116:119], v3, s[4:7], s25 offen offset:2048 sc1
  ds_read_b128 v[52:55], v2 offset:12288
  ds_read_b128 v[56:59], v2 offset:13312
  ds_read_b128 v[60:63], v2 offset:14336
  ds_read_b128 v[64:67], v2 offset:15360
  buffer_load_dwordx4 v[124:127], v3, s[4:7], s24 offen offset:2048 sc1
  buffer_load_dwordx4 v[116:119], v3, s[4:7], s25 offen offset:2048 sc1
  s_mov_b32 s19, 0
  s_branch T_loop_113
T_kvw_117:
  s_mov_b32 s19, 0
  s_branch T_kvok_126
T_kv_125:
  s_sleep 4
  s_add_u32 s19, s19, 1
  s_cmp_gt_u32 s19, 32768
  s_cbranch_scc1 M_exit
T_kvok_126:
  s_add_u32 s39, s99, 128
  s_mov_b32 s38, 0
  s_mov_b32 s37, 0
  s_atomic_or s38, s[58:59], s99 glc
  s_atomic_or s37, s[58:59], s39 glc
  s_waitcnt lgkmcnt(0)
  s_add_u32 s37, s37, 30
  s_cmp_ge_u32 s38, 30
  s_cselect_b32 s38, s37, s38
  s_cmp_ge_u32 s38, 64
  s_cselect_b32 s38, 100, s38
  s_sub_u32 s38, s38, 1
  s_max_i32 s30, s30, s38
  s_cmp_ge_i32 s14, s30
  s_cbranch_scc1 T_kv_125
  s_branch T_kvb_118
T_slow_120:
  s_nop 7
  v_max3_f32 v100, v16, v17, v18
  v_max3_f32 v100, v100, v19, v20
  v_max3_f32 v100, v100, v21, v22
  v_max3_f32 v100, v100, v23, v112
  v_max3_f32 v100, v100, v113, v114
  v_max_f32 v100, v100, v115
  v_mov_b32 v101, v100
  s_nop 1
  v_permlane32_swap_b32 v100, v101
  s_nop 1
  v_max_f32 v100, v100, v101
  v_mov_b32 v101, v100
  s_nop 1
  v_permlane16_swap_b32 v100, v101
  s_nop 1
  v_max_f32 v100, v100, v101
  v_sub_f32 v16, v16, v100
  v_sub_f32 v17, v17, v100
  v_sub_f32 v18, v18, v100
  v_sub_f32 v19, v19, v100
  v_exp_f32 v16, v16
  v_exp_f32 v17, v17
  v_exp_f32 v18, v18
  v_exp_f32 v19, v19
  v_sub_f32 v20, v20, v100
  v_sub_f32 v21, v21, v100
  v_sub_f32 v22, v22, v100
  v_sub_f32 v23, v23, v100
  v_exp_f32 v20, v20
  v_exp_f32 v21, v21
  v_exp_f32 v22, v22
  v_exp_f32 v23, v23
  v_sub_f32 v112, v112, v100
  v_sub_f32 v113, v113, v100
  v_sub_f32 v114, v114, v100
  v_sub_f32 v115, v115, v100
  v_exp_f32 v112, v112
  v_exp_f32 v113, v113
  v_exp_f32 v114, v114
  v_exp_f32 v115, v115
  s_nop 0
  v_cvt_pk_bf16_f32 v44, v16, v17
  v_cvt_pk_bf16_f32 v45, v18, v19
  v_cvt_pk_bf16_f32 v46, v20, v21
  v_cvt_pk_bf16_f32 v47, v22, v23
  v_cvt_pk_bf16_f32 v84, v112, v113
  v_cvt_pk_bf16_f32 v85, v114, v115
  v_cndmask_b32 v48, v84, 0, s[16:17]
  v_cndmask_b32 v49, v85, 0, s[16:17]
  v_cndmask_b32 v50, 0, v84, s[16:17]
  v_cndmask_b32 v51, 0, v85, s[16:17]
  s_nop 1
  v_mfma_f32_16x16x16_bf16 v[88:91], v[12:13], v[48:49], 0
  v_mfma_f32_16x16x16_bf16 v[24:27], v[120:121], v[48:49], 0
  v_mfma_f32_16x16x16_bf16 v[116:119], v[120:121], v[50:51], 0
  v_mfma_f32_16x16x32_bf16 v[88:91], v[12:15], v[44:47], v[88:91]
  v_mfma_f32_16x16x32_bf16 v[24:27], v[28:31], v[44:47], v[24:27]
  v_mfma_f32_16x16x32_bf16 v[116:119], v[32:35], v[44:47], v[116:119]
  s_nop 7
  s_nop 1
  v_rcp_f32 v89, v88
  s_nop 0
  v_mul_f32 v24, v89, v24
  v_mul_f32 v25, v89, v25
  s_branch T_back_121
T_w_84:
  s_mov_b32 s19, 0
  v_mov_b64 v[16:17], 0
  v_mov_b64 v[18:19], 0
  v_mov_b64 v[20:21], 0
  v_mov_b64 v[22:23], 0
  v_mov_b64 v[24:25], 0
  v_mov_b64 v[26:27], 0
  buffer_load_dwordx4 v[124:127], v3, s[4:7], s24 offen offset:3072 sc1
  buffer_load_dwordx4 v[116:119], v3, s[4:7], s25 offen offset:3072 sc1
  buffer_load_dwordx4 v[124:127], v3, s[4:7], s24 offen offset:3072 sc1
  buffer_load_dwordx4 v[116:119], v3, s[4:7], s25 offen offset:3072 sc1
  s_branch T_loop_127
.p2align 6
T_retry_128:
  s_mov_b64 exec, vcc
  buffer_load_dwordx4 v[124:127], v3, s[4:7], s24 offen offset:3072 sc1
  buffer_load_dwordx4 v[116:119], v3, s[4:7], s25 offen offset:3072 sc1
  s_mov_b64 exec, -1
  s_add_u32 s19, s19, 1
  s_cmp_gt_u32 s19, 32768
  s_cbranch_scc1 M_exit
T_loop_127:
  s_waitcnt vmcnt(3) lgkmcnt(0)
  v_max3_u32 v123, v124, v125, v126
  v_max_u32 v123, v123, v127
  v_mov_b32_dpp v120, v124 row_ror:8 row_mask:0xf bank_mask:0xf
  v_mov_b32_dpp v121, v125 row_ror:8 row_mask:0xf bank_mask:0xf
  s_waitcnt vmcnt(2)
  v_max3_u32 v123, v123, v116, v117
  v_max3_u32 v123, v123, v118, v119
  v_cmp_eq_u32 vcc, -1, v123
  s_cbranch_vccnz T_retry_128
  v_smfmac_f32_16x16x64_bf16 v[16:19], v[124:127], v[68:75], v0
  s_add_u32 s14, s14, 1
  ds_write_b128 v2, v[124:127] offset:3072
  v_mov_b32_dpp v122, v126 row_ror:8 row_mask:0xf bank_mask:0xf
  v_smfmac_f32_16x16x64_bf16 v[20:23], v[124:127], v[76:83], v0
  s_and_b32 s57, s14, 1
  v_mov_b32_dpp v123, v127 row_ror:8 row_mask:0xf bank_mask:0xf
  v_smfmac_f32_16x16x64_bf16 v[24:27], v[124:127], v[84:91], v0
  s_and_b32 s36, s14, 3
  ds_write_b128 v2, v[116:119] offset:7168
  v_smfmac_f32_16x16x64_bf16 v[16:19], v[120:123], v[92:99], v0
  s_lshl_b32 s36, s36, 13
  v_mov_b32_dpp v84, v116 row_ror:8 row_mask:0xf bank_mask:0xf
  v_smfmac_f32_16x16x64_bf16 v[20:23], v[120:123], v[100:107], v0
  s_add_u32 s26, s36, s23
  ds_read_b128 v[68:71], v4 offset:12288
  v_mov_b32_dpp v85, v117 row_ror:8 row_mask:0xf bank_mask:0xf
  v_smfmac_f32_16x16x64_bf16 v[24:27], v[120:123], v[108:115], v0
  s_add_u32 s36, s36, 8192
  ds_read_b128 v[72:75], v4 offset:13312
  v_mov_b32_dpp v86, v118 row_ror:8 row_mask:0xf bank_mask:0xf
  v_smfmac_f32_16x16x64_bf16 v[16:19], v[116:119], v[224:231], v0
  s_and_b32 s36, s36, 0x7fff
  ds_read_b128 v[76:79], v4 offset:14336
  v_mov_b32_dpp v87, v119 row_ror:8 row_mask:0xf bank_mask:0xf
  v_smfmac_f32_16x16x64_bf16 v[20:23], v[116:119], v[240:247], v0
  s_waitcnt lgkmcnt(3)
  s_barrier
  ds_read_b128 v[100:103], v2 offset:2048
  v_smfmac_f32_16x16x64_bf16 v[24:27], v[116:119], a[0:7], v0
  s_mov_b32 m0, s31
  ds_read_b128 v[120:123], v1 offset:2048
  v_smfmac_f32_16x16x64_bf16 v[16:19], v[84:87], v[232:239], v0
  s_cmp_ge_i32 s14, s30
  s_cbranch_scc1 T_kvw_131
T_kvb_132:
  v_smfmac_f32_16x16x64_bf16 v[20:23], v[84:87], v[248:255], v0
  ds_read_b128 v[80:83], v4 offset:15360
  v_smfmac_f32_16x16x64_bf16 v[24:27], v[84:87], a[8:15], v0
  s_waitcnt lgkmcnt(2)
  v_smfmac_f32_16x16x64_bf16 v[16:19], v[100:103], v[128:135], v0
  ds_read_b128 v[92:95], v2 offset:1024
  v_smfmac_f32_16x16x64_bf16 v[20:23], v[100:103], v[144:151], v0
  ds_read_b128 v[96:99], v1 offset:1024
  buffer_load_dwordx4 v9, s[4:7], s27 offen sc1 lds
  v_smfmac_f32_16x16x64_bf16 v[24:27], v[100:103], v[68:75], v0
  s_waitcnt vmcnt(1) lgkmcnt(3)
  ds_read_b128 v[116:119], v2 offset:0
  s_mov_b32 m0, s32
  v_smfmac_f32_16x16x64_bf16 v[16:19], v[120:123], v[136:143], v0
  ds_read_b128 v[124:127], v1 offset:0
  v_smfmac_f32_16x16x64_bf16 v[20:23], v[120:123], v[152:159], v0
  s_waitcnt lgkmcnt(4)
  ds_read_b128 v[104:107], v2 offset:6144
  v_smfmac_f32_16x16x64_bf16 v[24:27], v[120:123], v[76:83], v0
  s_waitcnt lgkmcnt(4)
  ds_read_b128 v[108:111], v1 offset:6144
  buffer_load_dwordx4 v9, s[4:7], s27 offen offset:128 sc1 lds
  v_smfmac_f32_16x16x64_bf16 v[16:19], v[92:95], v[160:167], v0
  s_waitcnt lgkmcnt(4)
  ds_read_b128 v[112:115], v2 offset:5120
  s_mov_b32 m0, s33
  v_smfmac_f32_16x16x64_bf16 v[16:19], v[96:99], v[168:175], v0
  s_waitcnt lgkmcnt(4)
  ds_read_b128 v[84:87], v1 offset:5120
  v_smfmac_f32_16x16x64_bf16 v[16:19], v[116:119], v[192:199], v0
  s_waitcnt lgkmcnt(4)
  ds_read_b128 v[88:91], v2 offset:4096
  v_smfmac_f32_16x16x64_bf16 v[16:19], v[124:127], v[200:207], v0
  s_waitcnt lgkmcnt(4)
  ds_read_b128 v[100:103], v1 offset:4096
  buffer_load_dwordx4 v10, s[4:7], s28 offen sc1 lds
  v_smfmac_f32_16x16x64_bf16 v[16:19], v[104:107], a[16:23], v0
  s_waitcnt lgkmcnt(4)
  ds_read_b128 v[68:71], v4 offset:16384
  s_mov_b32 m0, s34
  v_smfmac_f32_16x16x64_bf16 v[16:19], v[108:111], a[24:31], v0
  s_waitcnt lgkmcnt(4)
  ds_read_b128 v[72:75], v4 offset:17408
  v_smfmac_f32_16x16x64_bf16 v[16:19], v[112:115], a[64:71], v0
  s_waitcnt lgkmcnt(4)
  ds_read_b128 v[76:79], v4 offset:18432
  v_smfmac_f32_16x16x64_bf16 v[16:19], v[84:87], a[72:79], v0
  s_waitcnt lgkmcnt(4)
  ds_read_b128 v[80:83], v4 offset:19456
  buffer_load_dwordx4 v10, s[4:7], s28 offen offset:256 sc1 lds
  v_smfmac_f32_16x16x64_bf16 v[16:19], v[88:91], a[112:119], v0
  s_waitcnt lgkmcnt(4)
  s_mov_b32 m0, 32256
  v_smfmac_f32_16x16x64_bf16 v[16:19], v[100:103], a[120:127], v0
  s_add_u32 s24, s36, 145752064
  s_add_u32 s25, s36, 145756160
  v_smfmac_f32_16x16x64_bf16 v[20:23], v[92:95], v[176:183], v0
  s_add_u32 s35, s36, s23
  v_smfmac_f32_16x16x64_bf16 v[20:23], v[96:99], v[184:191], v0
  s_waitcnt lgkmcnt(2)
  buffer_load_dword v8, s[4:7], s99 offen sc1 lds
  v_smfmac_f32_16x16x64_bf16 v[20:23], v[116:119], v[68:75], v0
  s_waitcnt lgkmcnt(0)
  ds_read_b128 v[68:71], v4 offset:20480
  v_mul_f32 v16, s18, v16
  v_smfmac_f32_16x16x64_bf16 v[20:23], v[124:127], v[76:83], v0
  ds_read_b128 v[72:75], v4 offset:21504
  v_mul_f32 v17, s18, v17
  v_smfmac_f32_16x16x64_bf16 v[20:23], v[104:107], a[32:39], v0
  ds_read_b128 v[76:79], v4 offset:22528
  v_mul_f32 v18, s18, v18
  v_smfmac_f32_16x16x64_bf16 v[20:23], v[108:111], a[40:47], v0
  ds_read_b128 v[80:83], v4 offset:23552
  v_mul_f32 v19, s18, v19
  v_smfmac_f32_16x16x64_bf16 v[20:23], v[112:115], a[80:87], v0
  v_cvt_pk_bf16_f32 v120, v16, v17
  v_smfmac_f32_16x16x64_bf16 v[20:23], v[84:87], a[88:95], v0
  v_cvt_pk_bf16_f32 v121, v18, v19
  v_smfmac_f32_16x16x64_bf16 v[20:23], v[88:91], a[128:135], v0
  ds_write_b64 v5, v[120:121] offset:24576
  v_smfmac_f32_16x16x64_bf16 v[20:23], v[100:103], a[136:143], v0
  s_waitcnt lgkmcnt(3)
  v_smfmac_f32_16x16x64_bf16 v[24:27], v[92:95], v[68:75], v0
  s_waitcnt lgkmcnt(1)
  v_mov_b64 v[92:93], 0
  v_smfmac_f32_16x16x64_bf16 v[24:27], v[96:99], v[76:83], v0
  s_nop 1
  v_cvt_pk_bf16_f32 v122, v20, v21
  v_cvt_pk_bf16_f32 v123, v22, v23
  v_smfmac_f32_16x16x64_bf16 v[24:27], v[116:119], v[208:215], v0
  ds_write_b64 v5, v[122:123] offset:26880
  v_mov_b64 v[94:95], 0
  v_smfmac_f32_16x16x64_bf16 v[24:27], v[124:127], v[216:223], v0
  s_waitcnt lgkmcnt(1)
  s_barrier
  ds_read_b64_tr_b16 v[68:69], v6 offset:24576
  v_smfmac_f32_16x16x64_bf16 v[24:27], v[104:107], a[48:55], v0
  s_add_u32 s27, s27, 8192
  ds_read_b64_tr_b16 v[70:71], v6 offset:24640
  ds_read_b64_tr_b16 v[72:73], v6 offset:24832
  v_smfmac_f32_16x16x64_bf16 v[24:27], v[108:111], a[56:63], v0
  s_add_u32 s28, s28, 8192
  ds_read_b64_tr_b16 v[74:75], v6 offset:24896
  ds_read_b64_tr_b16 v[76:77], v6 offset:25088
  v_smfmac_f32_16x16x64_bf16 v[24:27], v[112:115], a[96:103], v0
  s_nop 0
  ds_read_b64_tr_b16 v[78:79], v6 offset:25152
  ds_read_b64_tr_b16 v[80:81], v6 offset:25344
  v_smfmac_f32_16x16x64_bf16 v[24:27], v[84:87], a[104:111], v0
  ds_read_b64_tr_b16 v[82:83], v6 offset:25408
  v_mov_b64 v[96:97], 0
  v_smfmac_f32_16x16x64_bf16 v[24:27], v[88:91], a[144:151], v0
  s_waitcnt lgkmcnt(8)
  s_barrier
  ds_read_b64_tr_b16 v[116:117], v6 offset:26880
  v_smfmac_f32_16x16x64_bf16 v[24:27], v[100:103], a[152:159], v0
  s_waitcnt lgkmcnt(7)
  ds_read_b64_tr_b16 v[118:119], v6 offset:26944
  v_mfma_f32_16x16x32_bf16 v[16:19], v[36:39], v[68:71], 0
  s_waitcnt lgkmcnt(6)
  ds_read_b64_tr_b16 v[124:125], v6 offset:27136
  ds_read_b64_tr_b16 v[126:127], v6 offset:27200
  v_mfma_f32_16x16x32_bf16 v[16:19], v[40:43], v[72:75], v[16:19]
  s_waitcnt lgkmcnt(6)
  ds_read_b64_tr_b16 v[104:105], v6 offset:27392
  ds_read_b64_tr_b16 v[106:107], v6 offset:27456
  v_mfma_f32_16x16x32_bf16 v[16:19], v[44:47], v[76:79], v[16:19]
  s_waitcnt lgkmcnt(6)
  ds_read_b64_tr_b16 v[108:109], v6 offset:27648
  ds_read_b64_tr_b16 v[110:111], v6 offset:27712
  v_mfma_f32_16x16x32_bf16 v[16:19], v[48:51], v[80:83], v[16:19]
  s_waitcnt lgkmcnt(6)
  v_cvt_pk_bf16_f32 v120, v24, v25
  v_cvt_pk_bf16_f32 v121, v26, v27
  v_mfma_f32_16x16x32_bf16 v[112:115], v[116:119], v[68:71], 0
  s_waitcnt lgkmcnt(4)
  buffer_store_dwordx4 v[120:123], v2, s[4:7], s29 offen offset:3072 sc1
  v_mov_b64 v[98:99], 0
  v_mfma_f32_16x16x32_bf16 v[112:115], v[124:127], v[72:75], v[112:115]
  s_waitcnt lgkmcnt(2)
  v_mov_b64 v[36:37], 0
  v_exp_f32 v100, v16
  v_mfma_f32_16x16x32_bf16 v[112:115], v[104:107], v[76:79], v[112:115]
  s_waitcnt lgkmcnt(0)
  v_exp_f32 v101, v17
  v_mfma_f32_16x16x32_bf16 v[112:115], v[108:111], v[80:83], v[112:115]
  s_add_u32 s29, s29, 131072
  v_exp_f32 v102, v18
  v_mfma_f32_16x16x32_bf16 v[20:23], v[52:55], v[68:71], 0
  s_cmp_eq_u32 s14, 63
  v_exp_f32 v103, v19
  v_mfma_f32_16x16x32_bf16 v[20:23], v[56:59], v[72:75], v[20:23]
  s_cbranch_scc1 M_tdone
  v_cvt_pk_bf16_f32 v44, v100, v101
  v_cvt_pk_bf16_f32 v45, v102, v103
  v_mfma_f32_16x16x32_bf16 v[20:23], v[60:63], v[76:79], v[20:23]
  v_exp_f32 v100, v112
  v_mfma_f32_16x16x32_bf16 v[20:23], v[64:67], v[80:83], v[20:23]
  v_exp_f32 v101, v113
  v_exp_f32 v102, v114
  v_exp_f32 v103, v115
  v_cvt_pk_bf16_f32 v84, v100, v101
  v_cvt_pk_bf16_f32 v85, v102, v103
  v_cndmask_b32 v48, v84, 0, s[16:17]
  v_cndmask_b32 v49, v85, 0, s[16:17]
  v_cndmask_b32 v50, 0, v84, s[16:17]
  v_cndmask_b32 v51, 0, v85, s[16:17]
  v_exp_f32 v100, v20
  v_mfma_f32_16x16x16_bf16 v[88:91], v[12:13], v[48:49], 0
  v_exp_f32 v101, v21
  v_mfma_f32_16x16x16_bf16 v[24:27], v[120:121], v[48:49], 0
  v_exp_f32 v102, v22
  v_mfma_f32_16x16x16_bf16 v[116:119], v[120:121], v[50:51], 0
  v_exp_f32 v103, v23
  v_cvt_pk_bf16_f32 v46, v100, v101
  v_cvt_pk_bf16_f32 v47, v102, v103
  v_mov_b64 v[38:39], 0
  s_nop 0
  v_mfma_f32_16x16x32_bf16 v[88:91], v[12:15], v[44:47], v[88:91]
  v_mov_b64 v[40:41], 0
  v_mov_b64 v[42:43], 0
  v_mfma_f32_16x16x32_bf16 v[24:27], v[28:31], v[44:47], v[24:27]
  ds_read_b128 v[52:55], v4 offset:24576
  ds_read_b128 v[56:59], v4 offset:25600
  v_mfma_f32_16x16x32_bf16 v[116:119], v[32:35], v[44:47], v[116:119]
  s_nop 1
  v_rcp_f32 v89, v88
  v_subrev_u32 v100, s54, v88
  v_cmp_le_u32 vcc, s55, v100
  v_mul_f32 v24, v89, v24
  v_mul_f32 v25, v89, v25
  s_cbranch_vccnz T_slow_134
T_back_135:
  v_cvt_pk_bf16_f32 v124, v24, v25
  v_pk_mul_f32 v[26:27], v[26:27], v[88:89] op_sel:[0,1] op_sel_hi:[1,1]
  v_pk_mul_f32 v[116:117], v[116:117], v[88:89] op_sel:[0,1] op_sel_hi:[1,1]
  v_pk_mul_f32 v[118:119], v[118:119], v[88:89] op_sel:[0,1] op_sel_hi:[1,1]
  v_cvt_pk_bf16_f32 v125, v26, v27
  v_cvt_pk_bf16_f32 v126, v116, v117
  v_cvt_pk_bf16_f32 v127, v118, v119
  ds_write_b128 v11, v[124:127] offset:30720
  s_nop 0
  v_smfmac_f32_16x16x64_bf16 v[92:95], v[124:127], a[160:167], v0
  v_smfmac_f32_16x16x64_bf16 v[96:99], v[124:127], a[168:175], v0
  v_smfmac_f32_16x16x64_bf16 v[36:39], v[124:127], a[176:183], v0
  v_smfmac_f32_16x16x64_bf16 v[40:43], v[124:127], a[184:191], v0
  s_waitcnt lgkmcnt(0)
  s_barrier
  ds_read_b128 v[104:107], v11 offset:30208
  ds_read_b128 v[108:111], v11 offset:29696
  ds_read_b128 v[68:71], v11 offset:29184
  s_waitcnt lgkmcnt(2)
  v_smfmac_f32_16x16x64_bf16 v[92:95], v[104:107], a[192:199], v0
  s_waitcnt lgkmcnt(1)
  ds_read_b128 v[76:79], v4 offset:28672
  v_smfmac_f32_16x16x64_bf16 v[92:95], v[108:111], a[224:231], v0
  s_waitcnt lgkmcnt(1)
  ds_read_b128 v[80:83], v4 offset:29696
  v_smfmac_f32_16x16x64_bf16 v[92:95], v[68:71], a[240:247], v0
  ds_read_b128 v[60:63], v4 offset:26624
  v_smfmac_f32_16x16x64_bf16 v[96:99], v[104:107], a[200:207], v0
  ds_read_b128 v[64:67], v4 offset:27648
  v_smfmac_f32_16x16x64_bf16 v[96:99], v[108:111], a[232:239], v0
  ds_read_b128 v[28:31], v4 offset:30720
  s_nop 0
  v_cvt_pk_bf16_f32 v16, v92, v93
  v_cvt_pk_bf16_f32 v17, v94, v95
  v_bfi_b32 v16, 1, s57, v16
  v_smfmac_f32_16x16x64_bf16 v[96:99], v[68:71], a[248:255], v0
  buffer_store_dwordx2 v[16:17], v7, s[4:7], s20 offen offset:0
  v_smfmac_f32_16x16x64_bf16 v[36:39], v[104:107], a[208:215], v0
  ds_read_b128 v[32:35], v4 offset:31744
  v_smfmac_f32_16x16x64_bf16 v[36:39], v[108:111], v[52:59], v0
  s_waitcnt lgkmcnt(4)
  s_nop 0
  v_cvt_pk_bf16_f32 v18, v96, v97
  v_cvt_pk_bf16_f32 v19, v98, v99
  v_bfi_b32 v18, 1, s57, v18
  v_smfmac_f32_16x16x64_bf16 v[36:39], v[68:71], v[76:83], v0
  buffer_store_dwordx2 v[18:19], v7, s[4:7], s20 offen offset:64
  v_smfmac_f32_16x16x64_bf16 v[40:43], v[104:107], a[216:223], v0
  s_waitcnt lgkmcnt(2)
  v_smfmac_f32_16x16x64_bf16 v[40:43], v[108:111], v[60:67], v0
  s_waitcnt lgkmcnt(0)
  s_nop 0
  v_cvt_pk_bf16_f32 v20, v36, v37
  v_cvt_pk_bf16_f32 v21, v38, v39
  v_bfi_b32 v20, 1, s57, v20
  v_smfmac_f32_16x16x64_bf16 v[40:43], v[68:71], v[28:35], v0
  buffer_store_dwordx2 v[20:21], v7, s[4:7], s21 offen offset:0
  s_nop 6
  v_cvt_pk_bf16_f32 v22, v40, v41
  v_cvt_pk_bf16_f32 v23, v42, v43
  v_bfi_b32 v22, 1, s57, v22
  buffer_store_dwordx2 v[22:23], v7, s[4:7], s21 offen offset:64
  ds_read_b128 v[68:71], v4 offset:0
  ds_read_b128 v[72:75], v4 offset:1024
  ds_read_b128 v[76:79], v4 offset:4096
  ds_read_b128 v[80:83], v4 offset:5120
  ds_read_b128 v[84:87], v4 offset:8192
  ds_read_b128 v[88:91], v4 offset:9216
  ds_read_b128 v[92:95], v4 offset:2048
  ds_read_b128 v[96:99], v4 offset:3072
  ds_read_b128 v[100:103], v4 offset:6144
  ds_read_b128 v[104:107], v4 offset:7168
  ds_read_b128 v[108:111], v4 offset:10240
  ds_read_b128 v[112:115], v4 offset:11264
  v_mov_b64 v[16:17], 0
  v_mov_b64 v[18:19], 0
  v_mov_b64 v[20:21], 0
  v_mov_b64 v[22:23], 0
  v_mov_b64 v[24:25], 0
  v_mov_b64 v[26:27], 0
  ds_read_b64 v[44:45], v2 offset:32256
  s_waitcnt lgkmcnt(0)
  v_readfirstlane_b32 s38, v44
  v_readfirstlane_b32 s37, v45
  s_nop 0
  s_add_u32 s37, s37, 30
  s_cmp_ge_u32 s38, 30
  s_cselect_b32 s38, s37, s38
  s_cmp_ge_u32 s38, 64
  s_cselect_b32 s38, 100, s38
  s_sub_u32 s38, s38, 1
  s_max_i32 s30, s30, s38
  s_waitcnt vmcnt(4)
  s_barrier
  ds_read_b128 v[28:31], v2 offset:19456
  ds_read_b128 v[32:35], v2 offset:23552
  ds_read_b128 v[36:39], v2 offset:8192
  ds_read_b128 v[40:43], v2 offset:9216
  ds_read_b128 v[44:47], v2 offset:10240
  ds_read_b128 v[48:51], v2 offset:11264
  buffer_load_dwordx4 v[124:127], v3, s[4:7], s24 offen offset:3072 sc1
  buffer_load_dwordx4 v[116:119], v3, s[4:7], s25 offen offset:3072 sc1
  ds_read_b128 v[52:55], v2 offset:12288
  ds_read_b128 v[56:59], v2 offset:13312
  ds_read_b128 v[60:63], v2 offset:14336
  ds_read_b128 v[64:67], v2 offset:15360
  buffer_load_dwordx4 v[124:127], v3, s[4:7], s24 offen offset:3072 sc1
  buffer_load_dwordx4 v[116:119], v3, s[4:7], s25 offen offset:3072 sc1
  s_mov_b32 s19, 0
  s_branch T_loop_127
T_kvw_131:
  s_mov_b32 s19, 0
  s_branch T_kvok_140
T_kv_139:
  s_sleep 4
  s_add_u32 s19, s19, 1
  s_cmp_gt_u32 s19, 32768
  s_cbranch_scc1 M_exit
T_kvok_140:
  s_add_u32 s39, s99, 128
  s_mov_b32 s38, 0
  s_mov_b32 s37, 0
  s_atomic_or s38, s[58:59], s99 glc
  s_atomic_or s37, s[58:59], s39 glc
  s_waitcnt lgkmcnt(0)
  s_add_u32 s37, s37, 30
  s_cmp_ge_u32 s38, 30
  s_cselect_b32 s38, s37, s38
  s_cmp_ge_u32 s38, 64
  s_cselect_b32 s38, 100, s38
  s_sub_u32 s38, s38, 1
  s_max_i32 s30, s30, s38
  s_cmp_ge_i32 s14, s30
  s_cbranch_scc1 T_kv_139
  s_branch T_kvb_132
T_slow_134:
  s_nop 7
  v_max3_f32 v100, v16, v17, v18
  v_max3_f32 v100, v100, v19, v20
  v_max3_f32 v100, v100, v21, v22
  v_max3_f32 v100, v100, v23, v112
  v_max3_f32 v100, v100, v113, v114
  v_max_f32 v100, v100, v115
  v_mov_b32 v101, v100
  s_nop 1
  v_permlane32_swap_b32 v100, v101
  s_nop 1
  v_max_f32 v100, v100, v101
  v_mov_b32 v101, v100
  s_nop 1
  v_permlane16_swap_b32 v100, v101
  s_nop 1
  v_max_f32 v100, v100, v101
  v_sub_f32 v16, v16, v100
  v_sub_f32 v17, v17, v100
  v_sub_f32 v18, v18, v100
  v_sub_f32 v19, v19, v100
  v_exp_f32 v16, v16
  v_exp_f32 v17, v17
  v_exp_f32 v18, v18
  v_exp_f32 v19, v19
  v_sub_f32 v20, v20, v100
  v_sub_f32 v21, v21, v100
  v_sub_f32 v22, v22, v100
  v_sub_f32 v23, v23, v100
  v_exp_f32 v20, v20
  v_exp_f32 v21, v21
  v_exp_f32 v22, v22
  v_exp_f32 v23, v23
  v_sub_f32 v112, v112, v100
  v_sub_f32 v113, v113, v100
  v_sub_f32 v114, v114, v100
  v_sub_f32 v115, v115, v100
  v_exp_f32 v112, v112
  v_exp_f32 v113, v113
  v_exp_f32 v114, v114
  v_exp_f32 v115, v115
  s_nop 0
  v_cvt_pk_bf16_f32 v44, v16, v17
  v_cvt_pk_bf16_f32 v45, v18, v19
  v_cvt_pk_bf16_f32 v46, v20, v21
  v_cvt_pk_bf16_f32 v47, v22, v23
  v_cvt_pk_bf16_f32 v84, v112, v113
  v_cvt_pk_bf16_f32 v85, v114, v115
  v_cndmask_b32 v48, v84, 0, s[16:17]
  v_cndmask_b32 v49, v85, 0, s[16:17]
  v_cndmask_b32 v50, 0, v84, s[16:17]
  v_cndmask_b32 v51, 0, v85, s[16:17]
  s_nop 1
  v_mfma_f32_16x16x16_bf16 v[88:91], v[12:13], v[48:49], 0
  v_mfma_f32_16x16x16_bf16 v[24:27], v[120:121], v[48:49], 0
  v_mfma_f32_16x16x16_bf16 v[116:119], v[120:121], v[50:51], 0
  v_mfma_f32_16x16x32_bf16 v[88:91], v[12:15], v[44:47], v[88:91]
  v_mfma_f32_16x16x32_bf16 v[24:27], v[28:31], v[44:47], v[24:27]
  v_mfma_f32_16x16x32_bf16 v[116:119], v[32:35], v[44:47], v[116:119]
  s_nop 7
  s_nop 1
  v_rcp_f32 v89, v88
  s_nop 0
  v_mul_f32 v24, v89, v24
  v_mul_f32 v25, v89, v25
  s_branch T_back_135
M_global:
  s_cmp_eq_u32 s13, 1
  s_cbranch_scc1 T_w_142
  s_cmp_eq_u32 s13, 2
  s_cbranch_scc1 T_w_143
  s_cmp_eq_u32 s13, 3
  s_cbranch_scc1 T_w_144
T_w_141:
  s_mov_b32 s19, 0
  v_mov_b64 v[16:17], 0
  v_mov_b64 v[18:19], 0
  v_mov_b64 v[20:21], 0
  v_mov_b64 v[22:23], 0
  v_mov_b64 v[24:25], 0
  v_mov_b64 v[26:27], 0
  buffer_load_dwordx4 v[124:127], v3, s[4:7], s24 offen offset:0 sc1
  buffer_load_dwordx4 v[116:119], v3, s[4:7], s25 offen offset:0 sc1
  buffer_load_dwordx4 v[124:127], v3, s[4:7], s24 offen offset:0 sc1
  buffer_load_dwordx4 v[116:119], v3, s[4:7], s25 offen offset:0 sc1
  s_branch T_loop_145
.p2align 6
T_retry_146:
  s_mov_b64 exec, vcc
  buffer_load_dwordx4 v[124:127], v3, s[4:7], s24 offen offset:0 sc1
  buffer_load_dwordx4 v[116:119], v3, s[4:7], s25 offen offset:0 sc1
  s_mov_b64 exec, -1
  s_add_u32 s19, s19, 1
  s_cmp_gt_u32 s19, 32768
  s_cbranch_scc1 M_exit
T_loop_145:
  s_waitcnt vmcnt(3) lgkmcnt(0)
  v_max3_u32 v123, v124, v125, v126
  v_max_u32 v123, v123, v127
  v_mov_b32_dpp v120, v124 row_ror:8 row_mask:0xf bank_mask:0xf
  v_mov_b32_dpp v121, v125 row_ror:8 row_mask:0xf bank_mask:0xf
  s_waitcnt vmcnt(2)
  v_max3_u32 v123, v123, v116, v117
  v_max3_u32 v123, v123, v118, v119
  v_cmp_eq_u32 vcc, -1, v123
  s_cbranch_vccnz T_retry_146
  v_smfmac_f32_16x16x64_bf16 v[16:19], v[124:127], v[68:75], v0
  s_add_u32 s14, s14, 1
  ds_write_b128 v2, v[124:127] offset:0
  v_mov_b32_dpp v122, v126 row_ror:8 row_mask:0xf bank_mask:0xf
  v_smfmac_f32_16x16x64_bf16 v[20:23], v[124:127], v[76:83], v0
  s_and_b32 s57, s14, 1
  v_mov_b32_dpp v123, v127 row_ror:8 row_mask:0xf bank_mask:0xf
  v_smfmac_f32_16x16x64_bf16 v[24:27], v[124:127], v[84:91], v0
  s_and_b32 s36, s14, 3
  ds_write_b128 v2, v[116:119] offset:4096
  v_smfmac_f32_16x16x64_bf16 v[16:19], v[120:123], v[92:99], v0
  s_lshl_b32 s36, s36, 13
  v_mov_b32_dpp v84, v116 row_ror:8 row_mask:0xf bank_mask:0xf
  v_smfmac_f32_16x16x64_bf16 v[20:23], v[120:123], v[100:107], v0
  s_add_u32 s26, s36, s23
  ds_read_b128 v[68:71], v4 offset:12288
  v_mov_b32_dpp v85, v117 row_ror:8 row_mask:0xf bank_mask:0xf
  v_smfmac_f32_16x16x64_bf16 v[24:27], v[120:123], v[108:115], v0
  s_add_u32 s36, s36, 8192
  ds_read_b128 v[72:75], v4 offset:13312
  v_mov_b32_dpp v86, v118 row_ror:8 row_mask:0xf bank_mask:0xf
  v_smfmac_f32_16x16x64_bf16 v[16:19], v[116:119], v[224:231], v0
  s_and_b32 s36, s36, 0x7fff
  ds_read_b128 v[76:79], v4 offset:14336
  v_mov_b32_dpp v87, v119 row_ror:8 row_mask:0xf bank_mask:0xf
  v_smfmac_f32_16x16x64_bf16 v[20:23], v[116:119], v[240:247], v0
  s_waitcnt lgkmcnt(3)
  s_barrier
  ds_read_b128 v[100:103], v2 offset:1024
  v_smfmac_f32_16x16x64_bf16 v[24:27], v[116:119], a[0:7], v0
  s_mov_b32 m0, s31
  ds_read_b128 v[120:123], v1 offset:1024
  v_smfmac_f32_16x16x64_bf16 v[16:19], v[84:87], v[232:239], v0
  s_cmp_ge_i32 s14, s30
  s_cbranch_scc1 T_kvw_149
T_kvb_150:
  v_smfmac_f32_16x16x64_bf16 v[20:23], v[84:87], v[248:255], v0
  ds_read_b128 v[80:83], v4 offset:15360
  buffer_load_dwordx4 v9, s[4:7], s27 offen sc1 lds
  v_smfmac_f32_16x16x64_bf16 v[24:27], v[84:87], a[8:15], v0
  s_waitcnt lgkmcnt(2)
  s_mov_b32 m0, s32
  v_smfmac_f32_16x16x64_bf16 v[16:19], v[100:103], v[128:135], v0
  ds_read_b128 v[92:95], v2 offset:2048
  v_smfmac_f32_16x16x64_bf16 v[20:23], v[100:103], v[144:151], v0
  ds_read_b128 v[96:99], v1 offset:2048
  v_smfmac_f32_16x16x64_bf16 v[24:27], v[100:103], v[68:75], v0
  s_waitcnt vmcnt(1) lgkmcnt(3)
  ds_read_b128 v[116:119], v2 offset:3072
  buffer_load_dwordx4 v9, s[4:7], s27 offen offset:128 sc1 lds
  v_smfmac_f32_16x16x64_bf16 v[16:19], v[120:123], v[136:143], v0
  ds_read_b128 v[124:127], v1 offset:3072
  s_mov_b32 m0, s33
  v_smfmac_f32_16x16x64_bf16 v[20:23], v[120:123], v[152:159], v0
  s_waitcnt lgkmcnt(4)
  ds_read_b128 v[104:107], v2 offset:5120
  v_smfmac_f32_16x16x64_bf16 v[24:27], v[120:123], v[76:83], v0
  s_waitcnt lgkmcnt(4)
  ds_read_b128 v[108:111], v1 offset:5120
  v_smfmac_f32_16x16x64_bf16 v[16:19], v[92:95], v[160:167], v0
  s_waitcnt lgkmcnt(4)
  ds_read_b128 v[112:115], v2 offset:6144
  buffer_load_dwordx4 v10, s[4:7], s28 offen sc1 lds
  v_smfmac_f32_16x16x64_bf16 v[16:19], v[96:99], v[168:175], v0
  s_waitcnt lgkmcnt(4)
  ds_read_b128 v[84:87], v1 offset:6144
  s_mov_b32 m0, s34
  v_smfmac_f32_16x16x64_bf16 v[16:19], v[116:119], v[192:199], v0
  s_waitcnt lgkmcnt(4)
  ds_read_b128 v[88:91], v2 offset:7168
  v_smfmac_f32_16x16x64_bf16 v[16:19], v[124:127], v[200:207], v0
  s_waitcnt lgkmcnt(4)
  ds_read_b128 v[100:103], v1 offset:7168
  v_smfmac_f32_16x16x64_bf16 v[16:19], v[104:107], a[16:23], v0
  s_waitcnt lgkmcnt(4)
  ds_read_b128 v[68:71], v4 offset:16384
  buffer_load_dwordx4 v10, s[4:7], s28 offen offset:256 sc1 lds
  v_smfmac_f32_16x16x64_bf16 v[16:19], v[108:111], a[24:31], v0
  s_waitcnt lgkmcnt(4)
  ds_read_b128 v[72:75], v4 offset:17408
  v_smfmac_f32_16x16x64_bf16 v[16:19], v[112:115], a[64:71], v0
  s_waitcnt lgkmcnt(4)
  ds_read_b128 v[76:79], v4 offset:18432
  v_smfmac_f32_16x16x64_bf16 v[16:19], v[84:87], a[72:79], v0
  s_waitcnt lgkmcnt(4)
  ds_read_b128 v[80:83], v4 offset:19456
  v_smfmac_f32_16x16x64_bf16 v[16:19], v[88:91], a[112:119], v0
  s_waitcnt lgkmcnt(4)
  v_smfmac_f32_16x16x64_bf16 v[16:19], v[100:103], a[120:127], v0
  s_add_u32 s24, s36, 145752064
  s_add_u32 s25, s36, 145756160
  v_smfmac_f32_16x16x64_bf16 v[20:23], v[92:95], v[176:183], v0
  s_add_u32 s35, s36, s23
  v_smfmac_f32_16x16x64_bf16 v[20:23], v[96:99], v[184:191], v0
  s_waitcnt lgkmcnt(2)
  v_smfmac_f32_16x16x64_bf16 v[20:23], v[116:119], v[68:75], v0
  s_waitcnt lgkmcnt(0)
  ds_read_b128 v[68:71], v4 offset:20480
  v_mul_f32 v16, s18, v16
  v_smfmac_f32_16x16x64_bf16 v[20:23], v[124:127], v[76:83], v0
  ds_read_b128 v[72:75], v4 offset:21504
  v_mul_f32 v17, s18, v17
  v_smfmac_f32_16x16x64_bf16 v[20:23], v[104:107], a[32:39], v0
  ds_read_b128 v[76:79], v4 offset:22528
  v_mul_f32 v18, s18, v18
  v_smfmac_f32_16x16x64_bf16 v[20:23], v[108:111], a[40:47], v0
  ds_read_b128 v[80:83], v4 offset:23552
  v_mul_f32 v19, s18, v19
  v_smfmac_f32_16x16x64_bf16 v[20:23], v[112:115], a[80:87], v0
  v_cvt_pk_bf16_f32 v120, v16, v17
  v_smfmac_f32_16x16x64_bf16 v[20:23], v[84:87], a[88:95], v0
  v_cvt_pk_bf16_f32 v121, v18, v19
  v_smfmac_f32_16x16x64_bf16 v[20:23], v[88:91], a[128:135], v0
  ds_write_b64 v5, v[120:121] offset:24576
  v_smfmac_f32_16x16x64_bf16 v[20:23], v[100:103], a[136:143], v0
  s_waitcnt lgkmcnt(3)
  v_smfmac_f32_16x16x64_bf16 v[24:27], v[92:95], v[68:75], v0
  s_waitcnt lgkmcnt(1)
  v_mov_b64 v[92:93], 0
  v_smfmac_f32_16x16x64_bf16 v[24:27], v[96:99], v[76:83], v0
  s_nop 1
  v_cvt_pk_bf16_f32 v122, v20, v21
  v_cvt_pk_bf16_f32 v123, v22, v23
  v_smfmac_f32_16x16x64_bf16 v[24:27], v[116:119], v[208:215], v0
  ds_write_b64 v5, v[122:123] offset:26880
  v_mov_b64 v[94:95], 0
  v_smfmac_f32_16x16x64_bf16 v[24:27], v[124:127], v[216:223], v0
  s_waitcnt lgkmcnt(1)
  s_barrier
  ds_read_b64_tr_b16 v[68:69], v6 offset:24576
  v_smfmac_f32_16x16x64_bf16 v[24:27], v[104:107], a[48:55], v0
  s_add_u32 s27, s27, 8192
  ds_read_b64_tr_b16 v[70:71], v6 offset:24640
  ds_read_b64_tr_b16 v[72:73], v6 offset:24832
  v_smfmac_f32_16x16x64_bf16 v[24:27], v[108:111], a[56:63], v0
  s_add_u32 s28, s28, 8192
  ds_read_b64_tr_b16 v[74:75], v6 offset:24896
  ds_read_b64_tr_b16 v[76:77], v6 offset:25088
  v_smfmac_f32_16x16x64_bf16 v[24:27], v[112:115], a[96:103], v0
  s_nop 0
  ds_read_b64_tr_b16 v[78:79], v6 offset:25152
  ds_read_b64_tr_b16 v[80:81], v6 offset:25344
  v_smfmac_f32_16x16x64_bf16 v[24:27], v[84:87], a[104:111], v0
  ds_read_b64_tr_b16 v[82:83], v6 offset:25408
  v_mov_b64 v[96:97], 0
  v_smfmac_f32_16x16x64_bf16 v[24:27], v[88:91], a[144:151], v0
  s_waitcnt lgkmcnt(8)
  s_barrier
  ds_read_b64_tr_b16 v[116:117], v6 offset:26880
  v_smfmac_f32_16x16x64_bf16 v[24:27], v[100:103], a[152:159], v0
  s_waitcnt lgkmcnt(7)
  ds_read_b64_tr_b16 v[118:119], v6 offset:26944
  v_mfma_f32_16x16x32_bf16 v[16:19], v[36:39], v[68:71], 0
  s_waitcnt lgkmcnt(6)
  ds_read_b64_tr_b16 v[124:125], v6 offset:27136
  ds_read_b64_tr_b16 v[126:127], v6 offset:27200
  v_mfma_f32_16x16x32_bf16 v[16:19], v[40:43], v[72:75], v[16:19]
  s_waitcnt lgkmcnt(6)
  ds_read_b64_tr_b16 v[104:105], v6 offset:27392
  ds_read_b64_tr_b16 v[106:107], v6 offset:27456
  v_mfma_f32_16x16x32_bf16 v[16:19], v[44:47], v[76:79], v[16:19]
  s_waitcnt lgkmcnt(6)
  ds_read_b64_tr_b16 v[108:109], v6 offset:27648
  ds_read_b64_tr_b16 v[110:111], v6 offset:27712
  v_mfma_f32_16x16x32_bf16 v[16:19], v[48:51], v[80:83], v[16:19]
  s_waitcnt lgkmcnt(6)
  v_cvt_pk_bf16_f32 v120, v24, v25
  v_cvt_pk_bf16_f32 v121, v26, v27
  v_mfma_f32_16x16x32_bf16 v[112:115], v[116:119], v[68:71], 0
  s_waitcnt lgkmcnt(4)
  buffer_store_dwordx4 v[120:123], v2, s[4:7], s29 offen offset:0 sc1
  v_mov_b64 v[98:99], 0
  v_mfma_f32_16x16x32_bf16 v[112:115], v[124:127], v[72:75], v[112:115]
  s_waitcnt lgkmcnt(2)
  v_mov_b64 v[36:37], 0
  v_exp_f32 v100, v16
  v_mfma_f32_16x16x32_bf16 v[112:115], v[104:107], v[76:79], v[112:115]
  s_waitcnt lgkmcnt(0)
  v_exp_f32 v101, v17
  v_mfma_f32_16x16x32_bf16 v[112:115], v[108:111], v[80:83], v[112:115]
  s_add_u32 s29, s29, 131072
  v_exp_f32 v102, v18
  v_mfma_f32_16x16x32_bf16 v[20:23], v[52:55], v[68:71], 0
  s_cmp_eq_u32 s14, 63
  v_exp_f32 v103, v19
  v_mfma_f32_16x16x32_bf16 v[20:23], v[56:59], v[72:75], v[20:23]
  s_cbranch_scc1 M_tdone
  v_cvt_pk_bf16_f32 v44, v100, v101
  v_cvt_pk_bf16_f32 v45, v102, v103
  v_mfma_f32_16x16x32_bf16 v[20:23], v[60:63], v[76:79], v[20:23]
  v_exp_f32 v100, v112
  v_mfma_f32_16x16x32_bf16 v[20:23], v[64:67], v[80:83], v[20:23]
  v_exp_f32 v101, v113
  v_exp_f32 v102, v114
  v_exp_f32 v103, v115
  v_cvt_pk_bf16_f32 v84, v100, v101
  v_cvt_pk_bf16_f32 v85, v102, v103
  v_cndmask_b32 v48, v84, 0, s[16:17]
  v_cndmask_b32 v49, v85, 0, s[16:17]
  v_cndmask_b32 v50, 0, v84, s[16:17]
  v_cndmask_b32 v51, 0, v85, s[16:17]
  v_exp_f32 v100, v20
  v_mfma_f32_16x16x16_bf16 v[88:91], v[12:13], v[48:49], 0
  v_exp_f32 v101, v21
  v_mfma_f32_16x16x16_bf16 v[24:27], v[120:121], v[48:49], 0
  v_exp_f32 v102, v22
  v_mfma_f32_16x16x16_bf16 v[116:119], v[120:121], v[50:51], 0
  v_exp_f32 v103, v23
  v_cvt_pk_bf16_f32 v46, v100, v101
  v_cvt_pk_bf16_f32 v47, v102, v103
  v_mov_b64 v[38:39], 0
  s_nop 0
  v_mfma_f32_16x16x32_bf16 v[88:91], v[12:15], v[44:47], v[88:91]
  v_mov_b64 v[40:41], 0
  v_mov_b64 v[42:43], 0
  v_mfma_f32_16x16x32_bf16 v[24:27], v[28:31], v[44:47], v[24:27]
  ds_read_b128 v[52:55], v4 offset:24576
  ds_read_b128 v[56:59], v4 offset:25600
  v_mfma_f32_16x16x32_bf16 v[116:119], v[32:35], v[44:47], v[116:119]
  s_nop 1
  v_rcp_f32 v89, v88
  v_subrev_u32 v100, s54, v88
  v_cmp_le_u32 vcc, s55, v100
  v_mul_f32 v24, v89, v24
  v_mul_f32 v25, v89, v25
  s_cbranch_vccnz T_slow_152
T_back_153:
  v_cvt_pk_bf16_f32 v124, v24, v25
  v_pk_mul_f32 v[26:27], v[26:27], v[88:89] op_sel:[0,1] op_sel_hi:[1,1]
  v_pk_mul_f32 v[116:117], v[116:117], v[88:89] op_sel:[0,1] op_sel_hi:[1,1]
  v_pk_mul_f32 v[118:119], v[118:119], v[88:89] op_sel:[0,1] op_sel_hi:[1,1]
  v_cvt_pk_bf16_f32 v125, v26, v27
  v_cvt_pk_bf16_f32 v126, v116, v117
  v_cvt_pk_bf16_f32 v127, v118, v119
  ds_write_b128 v11, v[124:127] offset:29184
  s_nop 0
  v_smfmac_f32_16x16x64_bf16 v[92:95], v[124:127], a[160:167], v0
  v_smfmac_f32_16x16x64_bf16 v[96:99], v[124:127], a[168:175], v0
  v_smfmac_f32_16x16x64_bf16 v[36:39], v[124:127], a[176:183], v0
  v_smfmac_f32_16x16x64_bf16 v[40:43], v[124:127], a[184:191], v0
  s_waitcnt lgkmcnt(0)
  s_barrier
  ds_read_b128 v[104:107], v11 offset:29696
  ds_read_b128 v[108:111], v11 offset:30208
  ds_read_b128 v[68:71], v11 offset:30720
  s_waitcnt lgkmcnt(2)
  v_smfmac_f32_16x16x64_bf16 v[92:95], v[104:107], a[192:199], v0
  s_waitcnt lgkmcnt(1)
  ds_read_b128 v[76:79], v4 offset:28672
  v_smfmac_f32_16x16x64_bf16 v[92:95], v[108:111], a[224:231], v0
  s_waitcnt lgkmcnt(1)
  ds_read_b128 v[80:83], v4 offset:29696
  v_smfmac_f32_16x16x64_bf16 v[92:95], v[68:71], a[240:247], v0
  ds_read_b128 v[60:63], v4 offset:26624
  v_smfmac_f32_16x16x64_bf16 v[96:99], v[104:107], a[200:207], v0
  ds_read_b128 v[64:67], v4 offset:27648
  v_smfmac_f32_16x16x64_bf16 v[96:99], v[108:111], a[232:239], v0
  ds_read_b128 v[28:31], v4 offset:30720
  s_nop 0
  v_cvt_pk_bf16_f32 v16, v92, v93
  v_cvt_pk_bf16_f32 v17, v94, v95
  v_bfi_b32 v16, 1, s57, v16
  v_smfmac_f32_16x16x64_bf16 v[96:99], v[68:71], a[248:255], v0
  buffer_store_dwordx2 v[16:17], v7, s[4:7], s20 offen offset:0 sc1
  v_smfmac_f32_16x16x64_bf16 v[36:39], v[104:107], a[208:215], v0
  ds_read_b128 v[32:35], v4 offset:31744
  v_smfmac_f32_16x16x64_bf16 v[36:39], v[108:111], v[52:59], v0
  s_waitcnt lgkmcnt(4)
  s_nop 0
  v_cvt_pk_bf16_f32 v18, v96, v97
  v_cvt_pk_bf16_f32 v19, v98, v99
  v_bfi_b32 v18, 1, s57, v18
  v_smfmac_f32_16x16x64_bf16 v[36:39], v[68:71], v[76:83], v0
  buffer_store_dwordx2 v[18:19], v7, s[4:7], s20 offen offset:64 sc1
  v_smfmac_f32_16x16x64_bf16 v[40:43], v[104:107], a[216:223], v0
  s_waitcnt lgkmcnt(2)
  ds_read_b128 v[116:119], v2 offset:31232
  v_smfmac_f32_16x16x64_bf16 v[40:43], v[108:111], v[60:67], v0
  s_waitcnt lgkmcnt(1)
  s_nop 0
  v_cvt_pk_bf16_f32 v20, v36, v37
  v_cvt_pk_bf16_f32 v21, v38, v39
  v_bfi_b32 v20, 1, s57, v20
  v_smfmac_f32_16x16x64_bf16 v[40:43], v[68:71], v[28:35], v0
  buffer_store_dwordx2 v[20:21], v7, s[4:7], s21 offen offset:0 sc1
  s_nop 6
  v_cvt_pk_bf16_f32 v22, v40, v41
  v_cvt_pk_bf16_f32 v23, v42, v43
  v_bfi_b32 v22, 1, s57, v22
  buffer_store_dwordx2 v[22:23], v7, s[4:7], s21 offen offset:64 sc1
  ds_read_b128 v[68:71], v4 offset:0
  ds_read_b128 v[72:75], v4 offset:1024
  ds_read_b128 v[76:79], v4 offset:4096
  ds_read_b128 v[80:83], v4 offset:5120
  ds_read_b128 v[84:87], v4 offset:8192
  ds_read_b128 v[88:91], v4 offset:9216
  v_mov_b64 v[16:17], 0
  v_mov_b64 v[18:19], 0
  v_mov_b64 v[20:21], 0
  v_mov_b64 v[22:23], 0
  v_mov_b64 v[24:25], 0
  v_mov_b64 v[26:27], 0
  s_mov_b32 s19, 0
  v_mov_b32 v49, -1
  s_waitcnt vmcnt(2)
  buffer_load_dwordx4 v[52:55], v2, s[4:7], s22 offen offset:0 sc1
  buffer_load_dwordx4 v[56:59], v2, s[4:7], s22 offen offset:1024 sc1
  buffer_load_dwordx4 v[60:63], v2, s[4:7], s22 offen offset:2048 sc1
  buffer_load_dwordx4 v[64:67], v2, s[4:7], s22 offen offset:3072 sc1
  ds_read_b128 v[92:95], v4 offset:2048
  ds_read_b128 v[96:99], v4 offset:3072
  ds_read_b128 v[100:103], v4 offset:6144
  ds_read_b128 v[104:107], v4 offset:7168
  ds_read_b128 v[108:111], v4 offset:10240
  ds_read_b128 v[112:115], v4 offset:11264
  ds_read_b64 v[44:45], v2 offset:32256
  s_waitcnt lgkmcnt(0)
  v_readfirstlane_b32 s38, v44
  v_readfirstlane_b32 s37, v45
  s_nop 0
  s_add_u32 s37, s37, 30
  s_cmp_ge_u32 s38, 30
  s_cselect_b32 s38, s37, s38
  s_cmp_ge_u32 s38, 64
  s_cselect_b32 s38, 100, s38
  s_sub_u32 s38, s38, 1
  s_max_i32 s30, s30, s38
  s_waitcnt lgkmcnt(12)
  s_waitcnt vmcnt(3)
  v_mfma_f32_16x16x32_bf16 v[120:123], v[116:119], v[52:55], 0
  v_xor_b32 v48, s57, v52
  v_bitop3_b32 v48, v48, v54, s57 bitop3:0xf6
  s_waitcnt vmcnt(2)
  v_mfma_f32_16x16x32_bf16 v[120:123], v[116:119], v[56:59], v[120:123]
  v_bitop3_b32 v48, v48, v56, s57 bitop3:0xf6
  v_bitop3_b32 v48, v48, v58, s57 bitop3:0xf6
  s_waitcnt vmcnt(1)
  v_mfma_f32_16x16x32_bf16 v[120:123], v[116:119], v[60:63], v[120:123]
  v_bitop3_b32 v48, v48, v60, s57 bitop3:0xf6
  v_bitop3_b32 v48, v48, v62, s57 bitop3:0xf6
  s_waitcnt vmcnt(0)
  v_mfma_f32_16x16x32_bf16 v[120:123], v[116:119], v[64:67], v[120:123]
  v_bitop3_b32 v48, v48, v64, s57 bitop3:0xf6
  v_bitop3_b32 v48, v48, v66, s57 bitop3:0xf6
  v_and_b32 v48, 1, v48
  v_cmp_ne_u32 vcc, 0, v48
  s_cbranch_vccnz T_p1re_155
T_p1ok_156:
  s_nop 2
  v_add_f32_dpp v120, v120, v120 row_ror:8 row_mask:0xf bank_mask:0xf
  v_add_f32_dpp v121, v121, v121 row_ror:8 row_mask:0xf bank_mask:0xf
  v_cvt_pk_bf16_f32 v48, v120, v121
  v_min_u32 v48, -2, v48
  buffer_store_dword v48, v8, s[4:7], s35 offen sc1
  buffer_store_dword v49, v8, s[4:7], s26 offen sc1
  s_barrier
  ds_read_b128 v[28:31], v2 offset:16384
  ds_read_b128 v[32:35], v2 offset:20480
  ds_read_b128 v[36:39], v2 offset:8192
  ds_read_b128 v[40:43], v2 offset:9216
  ds_read_b128 v[44:47], v2 offset:10240
  ds_read_b128 v[48:51], v2 offset:11264
  buffer_load_dwordx4 v[124:127], v3, s[4:7], s24 offen offset:0 sc1
  buffer_load_dwordx4 v[116:119], v3, s[4:7], s25 offen offset:0 sc1
  ds_read_b128 v[52:55], v2 offset:12288
  ds_read_b128 v[56:59], v2 offset:13312
  ds_read_b128 v[60:63], v2 offset:14336
  ds_read_b128 v[64:67], v2 offset:15360
  buffer_load_dwordx4 v[124:127], v3, s[4:7], s24 offen offset:0 sc1
  buffer_load_dwordx4 v[116:119], v3, s[4:7], s25 offen offset:0 sc1
  s_mov_b32 s19, 0
  s_branch T_loop_145
T_p1re_155:
  s_mov_b64 exec, vcc
  buffer_load_dwordx4 v[52:55], v2, s[4:7], s22 offen offset:0 sc1
  buffer_load_dwordx4 v[56:59], v2, s[4:7], s22 offen offset:1024 sc1
  buffer_load_dwordx4 v[60:63], v2, s[4:7], s22 offen offset:2048 sc1
  buffer_load_dwordx4 v[64:67], v2, s[4:7], s22 offen offset:3072 sc1
  s_mov_b64 exec, -1
  s_add_u32 s19, s19, 1
  s_cmp_gt_u32 s19, 32768
  s_cbranch_scc1 M_exit
  s_waitcnt vmcnt(3)
  v_mfma_f32_16x16x32_bf16 v[120:123], v[116:119], v[52:55], 0
  v_xor_b32 v48, s57, v52
  v_bitop3_b32 v48, v48, v54, s57 bitop3:0xf6
  s_waitcnt vmcnt(2)
  v_mfma_f32_16x16x32_bf16 v[120:123], v[116:119], v[56:59], v[120:123]
  v_bitop3_b32 v48, v48, v56, s57 bitop3:0xf6
  v_bitop3_b32 v48, v48, v58, s57 bitop3:0xf6
  s_waitcnt vmcnt(1)
  v_mfma_f32_16x16x32_bf16 v[120:123], v[116:119], v[60:63], v[120:123]
  v_bitop3_b32 v48, v48, v60, s57 bitop3:0xf6
  v_bitop3_b32 v48, v48, v62, s57 bitop3:0xf6
  s_waitcnt vmcnt(0)
  v_mfma_f32_16x16x32_bf16 v[120:123], v[116:119], v[64:67], v[120:123]
  v_bitop3_b32 v48, v48, v64, s57 bitop3:0xf6
  v_bitop3_b32 v48, v48, v66, s57 bitop3:0xf6
  v_and_b32 v48, 1, v48
  v_cmp_ne_u32 vcc, 0, v48
  s_cbranch_vccnz T_p1re_155
  s_branch T_p1ok_156
T_kvw_149:
  s_mov_b32 s19, 0
  s_branch T_kvok_158
T_kv_157:
  s_sleep 4
  s_add_u32 s19, s19, 1
  s_cmp_gt_u32 s19, 32768
  s_cbranch_scc1 M_exit
T_kvok_158:
  s_add_u32 s39, s99, 128
  s_mov_b32 s38, 0
  s_mov_b32 s37, 0
  s_atomic_or s38, s[58:59], s99 glc
  s_atomic_or s37, s[58:59], s39 glc
  s_waitcnt lgkmcnt(0)
  s_add_u32 s37, s37, 30
  s_cmp_ge_u32 s38, 30
  s_cselect_b32 s38, s37, s38
  s_cmp_ge_u32 s38, 64
  s_cselect_b32 s38, 100, s38
  s_sub_u32 s38, s38, 1
  s_max_i32 s30, s30, s38
  s_cmp_ge_i32 s14, s30
  s_cbranch_scc1 T_kv_157
  s_branch T_kvb_150
T_slow_152:
  s_nop 7
  v_max3_f32 v100, v16, v17, v18
  v_max3_f32 v100, v100, v19, v20
  v_max3_f32 v100, v100, v21, v22
  v_max3_f32 v100, v100, v23, v112
  v_max3_f32 v100, v100, v113, v114
  v_max_f32 v100, v100, v115
  v_mov_b32 v101, v100
  s_nop 1
  v_permlane32_swap_b32 v100, v101
  s_nop 1
  v_max_f32 v100, v100, v101
  v_mov_b32 v101, v100
  s_nop 1
  v_permlane16_swap_b32 v100, v101
  s_nop 1
  v_max_f32 v100, v100, v101
  v_sub_f32 v16, v16, v100
  v_sub_f32 v17, v17, v100
  v_sub_f32 v18, v18, v100
  v_sub_f32 v19, v19, v100
  v_exp_f32 v16, v16
  v_exp_f32 v17, v17
  v_exp_f32 v18, v18
  v_exp_f32 v19, v19
  v_sub_f32 v20, v20, v100
  v_sub_f32 v21, v21, v100
  v_sub_f32 v22, v22, v100
  v_sub_f32 v23, v23, v100
  v_exp_f32 v20, v20
  v_exp_f32 v21, v21
  v_exp_f32 v22, v22
  v_exp_f32 v23, v23
  v_sub_f32 v112, v112, v100
  v_sub_f32 v113, v113, v100
  v_sub_f32 v114, v114, v100
  v_sub_f32 v115, v115, v100
  v_exp_f32 v112, v112
  v_exp_f32 v113, v113
  v_exp_f32 v114, v114
  v_exp_f32 v115, v115
  s_nop 0
  v_cvt_pk_bf16_f32 v44, v16, v17
  v_cvt_pk_bf16_f32 v45, v18, v19
  v_cvt_pk_bf16_f32 v46, v20, v21
  v_cvt_pk_bf16_f32 v47, v22, v23
  v_cvt_pk_bf16_f32 v84, v112, v113
  v_cvt_pk_bf16_f32 v85, v114, v115
  v_cndmask_b32 v48, v84, 0, s[16:17]
  v_cndmask_b32 v49, v85, 0, s[16:17]
  v_cndmask_b32 v50, 0, v84, s[16:17]
  v_cndmask_b32 v51, 0, v85, s[16:17]
  s_nop 1
  v_mfma_f32_16x16x16_bf16 v[88:91], v[12:13], v[48:49], 0
  v_mfma_f32_16x16x16_bf16 v[24:27], v[120:121], v[48:49], 0
  v_mfma_f32_16x16x16_bf16 v[116:119], v[120:121], v[50:51], 0
  v_mfma_f32_16x16x32_bf16 v[88:91], v[12:15], v[44:47], v[88:91]
  v_mfma_f32_16x16x32_bf16 v[24:27], v[28:31], v[44:47], v[24:27]
  v_mfma_f32_16x16x32_bf16 v[116:119], v[32:35], v[44:47], v[116:119]
  s_nop 7
  s_nop 1
  v_rcp_f32 v89, v88
  s_nop 0
  v_mul_f32 v24, v89, v24
  v_mul_f32 v25, v89, v25
  s_branch T_back_153
T_w_142:
  s_mov_b32 s19, 0
  v_mov_b64 v[16:17], 0
  v_mov_b64 v[18:19], 0
  v_mov_b64 v[20:21], 0
  v_mov_b64 v[22:23], 0
  v_mov_b64 v[24:25], 0
  v_mov_b64 v[26:27], 0
  buffer_load_dwordx4 v[124:127], v3, s[4:7], s24 offen offset:1024 sc1
  buffer_load_dwordx4 v[116:119], v3, s[4:7], s25 offen offset:1024 sc1
  buffer_load_dwordx4 v[124:127], v3, s[4:7], s24 offen offset:1024 sc1
  buffer_load_dwordx4 v[116:119], v3, s[4:7], s25 offen offset:1024 sc1
  s_branch T_loop_159
.p2align 6
T_retry_160:
  s_mov_b64 exec, vcc
  buffer_load_dwordx4 v[124:127], v3, s[4:7], s24 offen offset:1024 sc1
  buffer_load_dwordx4 v[116:119], v3, s[4:7], s25 offen offset:1024 sc1
  s_mov_b64 exec, -1
  s_add_u32 s19, s19, 1
  s_cmp_gt_u32 s19, 32768
  s_cbranch_scc1 M_exit
T_loop_159:
  s_waitcnt vmcnt(3) lgkmcnt(0)
  v_max3_u32 v123, v124, v125, v126
  v_max_u32 v123, v123, v127
  v_mov_b32_dpp v120, v124 row_ror:8 row_mask:0xf bank_mask:0xf
  v_mov_b32_dpp v121, v125 row_ror:8 row_mask:0xf bank_mask:0xf
  s_waitcnt vmcnt(2)
  v_max3_u32 v123, v123, v116, v117
  v_max3_u32 v123, v123, v118, v119
  v_cmp_eq_u32 vcc, -1, v123
  s_cbranch_vccnz T_retry_160
  v_smfmac_f32_16x16x64_bf16 v[16:19], v[124:127], v[68:75], v0
  s_add_u32 s14, s14, 1
  ds_write_b128 v2, v[124:127] offset:1024
  v_mov_b32_dpp v122, v126 row_ror:8 row_mask:0xf bank_mask:0xf
  v_smfmac_f32_16x16x64_bf16 v[20:23], v[124:127], v[76:83], v0
  s_and_b32 s57, s14, 1
  v_mov_b32_dpp v123, v127 row_ror:8 row_mask:0xf bank_mask:0xf
  v_smfmac_f32_16x16x64_bf16 v[24:27], v[124:127], v[84:91], v0
  s_and_b32 s36, s14, 3
  ds_write_b128 v2, v[116:119] offset:5120
  v_smfmac_f32_16x16x64_bf16 v[16:19], v[120:123], v[92:99], v0
  s_lshl_b32 s36, s36, 13
  v_mov_b32_dpp v84, v116 row_ror:8 row_mask:0xf bank_mask:0xf
  v_smfmac_f32_16x16x64_bf16 v[20:23], v[120:123], v[100:107], v0
  s_add_u32 s26, s36, s23
  ds_read_b128 v[68:71], v4 offset:12288
  v_mov_b32_dpp v85, v117 row_ror:8 row_mask:0xf bank_mask:0xf
  v_smfmac_f32_16x16x64_bf16 v[24:27], v[120:123], v[108:115], v0
  s_add_u32 s36, s36, 8192
  ds_read_b128 v[72:75], v4 offset:13312
  v_mov_b32_dpp v86, v118 row_ror:8 row_mask:0xf bank_mask:0xf
  v_smfmac_f32_16x16x64_bf16 v[16:19], v[116:119], v[224:231], v0
  s_and_b32 s36, s36, 0x7fff
  ds_read_b128 v[76:79], v4 offset:14336
  v_mov_b32_dpp v87, v119 row_ror:8 row_mask:0xf bank_mask:0xf
  v_smfmac_f32_16x16x64_bf16 v[20:23], v[116:119], v[240:247], v0
  s_waitcnt lgkmcnt(3)
  s_barrier
  ds_read_b128 v[100:103], v2 offset:0
  v_smfmac_f32_16x16x64_bf16 v[24:27], v[116:119], a[0:7], v0
  s_mov_b32 m0, s31
  ds_read_b128 v[120:123], v1 offset:0
  v_smfmac_f32_16x16x64_bf16 v[16:19], v[84:87], v[232:239], v0
  s_cmp_ge_i32 s14, s30
  s_cbranch_scc1 T_kvw_163
T_kvb_164:
  v_smfmac_f32_16x16x64_bf16 v[20:23], v[84:87], v[248:255], v0
  ds_read_b128 v[80:83], v4 offset:15360
  v_smfmac_f32_16x16x64_bf16 v[24:27], v[84:87], a[8:15], v0
  s_waitcnt lgkmcnt(2)
  buffer_load_dwordx4 v9, s[4:7], s27 offen sc1 lds
  v_smfmac_f32_16x16x64_bf16 v[16:19], v[100:103], v[128:135], v0
  ds_read_b128 v[92:95], v2 offset:3072
  s_mov_b32 m0, s32
  v_smfmac_f32_16x16x64_bf16 v[20:23], v[100:103], v[144:151], v0
  ds_read_b128 v[96:99], v1 offset:3072
  v_smfmac_f32_16x16x64_bf16 v[24:27], v[100:103], v[68:75], v0
  s_waitcnt vmcnt(1) lgkmcnt(3)
  ds_read_b128 v[116:119], v2 offset:2048
  v_smfmac_f32_16x16x64_bf16 v[16:19], v[120:123], v[136:143], v0
  ds_read_b128 v[124:127], v1 offset:2048
  buffer_load_dwordx4 v9, s[4:7], s27 offen offset:128 sc1 lds
  v_smfmac_f32_16x16x64_bf16 v[20:23], v[120:123], v[152:159], v0
  s_waitcnt lgkmcnt(4)
  ds_read_b128 v[104:107], v2 offset:4096
  s_mov_b32 m0, s33
  v_smfmac_f32_16x16x64_bf16 v[24:27], v[120:123], v[76:83], v0
  s_waitcnt lgkmcnt(4)
  ds_read_b128 v[108:111], v1 offset:4096
  v_smfmac_f32_16x16x64_bf16 v[16:19], v[92:95], v[160:167], v0
  s_waitcnt lgkmcnt(4)
  ds_read_b128 v[112:115], v2 offset:7168
  v_smfmac_f32_16x16x64_bf16 v[16:19], v[96:99], v[168:175], v0
  s_waitcnt lgkmcnt(4)
  ds_read_b128 v[84:87], v1 offset:7168
  buffer_load_dwordx4 v10, s[4:7], s28 offen sc1 lds
  v_smfmac_f32_16x16x64_bf16 v[16:19], v[116:119], v[192:199], v0
  s_waitcnt lgkmcnt(4)
  ds_read_b128 v[88:91], v2 offset:6144
  s_mov_b32 m0, s34
  v_smfmac_f32_16x16x64_bf16 v[16:19], v[124:127], v[200:207], v0
  s_waitcnt lgkmcnt(4)
  ds_read_b128 v[100:103], v1 offset:6144
  v_smfmac_f32_16x16x64_bf16 v[16:19], v[104:107], a[16:23], v0
  s_waitcnt lgkmcnt(4)
  ds_read_b128 v[68:71], v4 offset:16384
  v_smfmac_f32_16x16x64_bf16 v[16:19], v[108:111], a[24:31], v0
  s_waitcnt lgkmcnt(4)
  ds_read_b128 v[72:75], v4 offset:17408
  buffer_load_dwordx4 v10, s[4:7], s28 offen offset:256 sc1 lds
  v_smfmac_f32_16x16x64_bf16 v[16:19], v[112:115], a[64:71], v0
  s_waitcnt lgkmcnt(4)
  ds_read_b128 v[76:79], v4 offset:18432
  v_smfmac_f32_16x16x64_bf16 v[16:19], v[84:87], a[72:79], v0
  s_waitcnt lgkmcnt(4)
  ds_read_b128 v[80:83], v4 offset:19456
  v_smfmac_f32_16x16x64_bf16 v[16:19], v[88:91], a[112:119], v0
  s_waitcnt lgkmcnt(4)
  v_smfmac_f32_16x16x64_bf16 v[16:19], v[100:103], a[120:127], v0
  s_add_u32 s24, s36, 145752064
  s_add_u32 s25, s36, 145756160
  v_smfmac_f32_16x16x64_bf16 v[20:23], v[92:95], v[176:183], v0
  s_add_u32 s35, s36, s23
  v_smfmac_f32_16x16x64_bf16 v[20:23], v[96:99], v[184:191], v0
  s_waitcnt lgkmcnt(2)
  v_smfmac_f32_16x16x64_bf16 v[20:23], v[116:119], v[68:75], v0
  s_waitcnt lgkmcnt(0)
  ds_read_b128 v[68:71], v4 offset:20480
  v_mul_f32 v16, s18, v16
  v_smfmac_f32_16x16x64_bf16 v[20:23], v[124:127], v[76:83], v0
  ds_read_b128 v[72:75], v4 offset:21504
  v_mul_f32 v17, s18, v17
  v_smfmac_f32_16x16x64_bf16 v[20:23], v[104:107], a[32:39], v0
  ds_read_b128 v[76:79], v4 offset:22528
  v_mul_f32 v18, s18, v18
  v_smfmac_f32_16x16x64_bf16 v[20:23], v[108:111], a[40:47], v0
  ds_read_b128 v[80:83], v4 offset:23552
  v_mul_f32 v19, s18, v19
  v_smfmac_f32_16x16x64_bf16 v[20:23], v[112:115], a[80:87], v0
  v_cvt_pk_bf16_f32 v120, v16, v17
  v_smfmac_f32_16x16x64_bf16 v[20:23], v[84:87], a[88:95], v0
  v_cvt_pk_bf16_f32 v121, v18, v19
  v_smfmac_f32_16x16x64_bf16 v[20:23], v[88:91], a[128:135], v0
  ds_write_b64 v5, v[120:121] offset:24576
  v_smfmac_f32_16x16x64_bf16 v[20:23], v[100:103], a[136:143], v0
  s_waitcnt lgkmcnt(3)
  v_smfmac_f32_16x16x64_bf16 v[24:27], v[92:95], v[68:75], v0
  s_waitcnt lgkmcnt(1)
  v_mov_b64 v[92:93], 0
  v_smfmac_f32_16x16x64_bf16 v[24:27], v[96:99], v[76:83], v0
  s_nop 1
  v_cvt_pk_bf16_f32 v122, v20, v21
  v_cvt_pk_bf16_f32 v123, v22, v23
  v_smfmac_f32_16x16x64_bf16 v[24:27], v[116:119], v[208:215], v0
  ds_write_b64 v5, v[122:123] offset:26880
  v_mov_b64 v[94:95], 0
  v_smfmac_f32_16x16x64_bf16 v[24:27], v[124:127], v[216:223], v0
  s_waitcnt lgkmcnt(1)
  s_barrier
  ds_read_b64_tr_b16 v[68:69], v6 offset:24576
  v_smfmac_f32_16x16x64_bf16 v[24:27], v[104:107], a[48:55], v0
  s_add_u32 s27, s27, 8192
  ds_read_b64_tr_b16 v[70:71], v6 offset:24640
  ds_read_b64_tr_b16 v[72:73], v6 offset:24832
  v_smfmac_f32_16x16x64_bf16 v[24:27], v[108:111], a[56:63], v0
  s_add_u32 s28, s28, 8192
  ds_read_b64_tr_b16 v[74:75], v6 offset:24896
  ds_read_b64_tr_b16 v[76:77], v6 offset:25088
  v_smfmac_f32_16x16x64_bf16 v[24:27], v[112:115], a[96:103], v0
  s_nop 0
  ds_read_b64_tr_b16 v[78:79], v6 offset:25152
  ds_read_b64_tr_b16 v[80:81], v6 offset:25344
  v_smfmac_f32_16x16x64_bf16 v[24:27], v[84:87], a[104:111], v0
  ds_read_b64_tr_b16 v[82:83], v6 offset:25408
  v_mov_b64 v[96:97], 0
  v_smfmac_f32_16x16x64_bf16 v[24:27], v[88:91], a[144:151], v0
  s_waitcnt lgkmcnt(8)
  s_barrier
  ds_read_b64_tr_b16 v[116:117], v6 offset:26880
  v_smfmac_f32_16x16x64_bf16 v[24:27], v[100:103], a[152:159], v0
  s_waitcnt lgkmcnt(7)
  ds_read_b64_tr_b16 v[118:119], v6 offset:26944
  v_mfma_f32_16x16x32_bf16 v[16:19], v[36:39], v[68:71], 0
  s_waitcnt lgkmcnt(6)
  ds_read_b64_tr_b16 v[124:125], v6 offset:27136
  ds_read_b64_tr_b16 v[126:127], v6 offset:27200
  v_mfma_f32_16x16x32_bf16 v[16:19], v[40:43], v[72:75], v[16:19]
  s_waitcnt lgkmcnt(6)
  ds_read_b64_tr_b16 v[104:105], v6 offset:27392
  ds_read_b64_tr_b16 v[106:107], v6 offset:27456
  v_mfma_f32_16x16x32_bf16 v[16:19], v[44:47], v[76:79], v[16:19]
  s_waitcnt lgkmcnt(6)
  ds_read_b64_tr_b16 v[108:109], v6 offset:27648
  ds_read_b64_tr_b16 v[110:111], v6 offset:27712
  v_mfma_f32_16x16x32_bf16 v[16:19], v[48:51], v[80:83], v[16:19]
  s_waitcnt lgkmcnt(6)
  v_cvt_pk_bf16_f32 v120, v24, v25
  v_cvt_pk_bf16_f32 v121, v26, v27
  v_mfma_f32_16x16x32_bf16 v[112:115], v[116:119], v[68:71], 0
  s_waitcnt lgkmcnt(4)
  buffer_store_dwordx4 v[120:123], v2, s[4:7], s29 offen offset:1024 sc1
  v_mov_b64 v[98:99], 0
  v_mfma_f32_16x16x32_bf16 v[112:115], v[124:127], v[72:75], v[112:115]
  s_waitcnt lgkmcnt(2)
  v_mov_b64 v[36:37], 0
  v_exp_f32 v100, v16
  v_mfma_f32_16x16x32_bf16 v[112:115], v[104:107], v[76:79], v[112:115]
  s_waitcnt lgkmcnt(0)
  v_exp_f32 v101, v17
  v_mfma_f32_16x16x32_bf16 v[112:115], v[108:111], v[80:83], v[112:115]
  s_add_u32 s29, s29, 131072
  v_exp_f32 v102, v18
  v_mfma_f32_16x16x32_bf16 v[20:23], v[52:55], v[68:71], 0
  s_cmp_eq_u32 s14, 63
  v_exp_f32 v103, v19
  v_mfma_f32_16x16x32_bf16 v[20:23], v[56:59], v[72:75], v[20:23]
  s_cbranch_scc1 M_tdone
  v_cvt_pk_bf16_f32 v44, v100, v101
  v_cvt_pk_bf16_f32 v45, v102, v103
  v_mfma_f32_16x16x32_bf16 v[20:23], v[60:63], v[76:79], v[20:23]
  v_exp_f32 v100, v112
  v_mfma_f32_16x16x32_bf16 v[20:23], v[64:67], v[80:83], v[20:23]
  v_exp_f32 v101, v113
  v_exp_f32 v102, v114
  v_exp_f32 v103, v115
  v_cvt_pk_bf16_f32 v84, v100, v101
  v_cvt_pk_bf16_f32 v85, v102, v103
  v_cndmask_b32 v48, v84, 0, s[16:17]
  v_cndmask_b32 v49, v85, 0, s[16:17]
  v_cndmask_b32 v50, 0, v84, s[16:17]
  v_cndmask_b32 v51, 0, v85, s[16:17]
  v_exp_f32 v100, v20
  v_mfma_f32_16x16x16_bf16 v[88:91], v[12:13], v[48:49], 0
  v_exp_f32 v101, v21
  v_mfma_f32_16x16x16_bf16 v[24:27], v[120:121], v[48:49], 0
  v_exp_f32 v102, v22
  v_mfma_f32_16x16x16_bf16 v[116:119], v[120:121], v[50:51], 0
  v_exp_f32 v103, v23
  v_cvt_pk_bf16_f32 v46, v100, v101
  v_cvt_pk_bf16_f32 v47, v102, v103
  v_mov_b64 v[38:39], 0
  s_nop 0
  v_mfma_f32_16x16x32_bf16 v[88:91], v[12:15], v[44:47], v[88:91]
  v_mov_b64 v[40:41], 0
  v_mov_b64 v[42:43], 0
  v_mfma_f32_16x16x32_bf16 v[24:27], v[28:31], v[44:47], v[24:27]
  ds_read_b128 v[52:55], v4 offset:24576
  ds_read_b128 v[56:59], v4 offset:25600
  v_mfma_f32_16x16x32_bf16 v[116:119], v[32:35], v[44:47], v[116:119]
  s_nop 1
  v_rcp_f32 v89, v88
  v_subrev_u32 v100, s54, v88
  v_cmp_le_u32 vcc, s55, v100
  v_mul_f32 v24, v89, v24
  v_mul_f32 v25, v89, v25
  s_cbranch_vccnz T_slow_166
T_back_167:
  v_cvt_pk_bf16_f32 v124, v24, v25
  v_pk_mul_f32 v[26:27], v[26:27], v[88:89] op_sel:[0,1] op_sel_hi:[1,1]
  v_pk_mul_f32 v[116:117], v[116:117], v[88:89] op_sel:[0,1] op_sel_hi:[1,1]
  v_pk_mul_f32 v[118:119], v[118:119], v[88:89] op_sel:[0,1] op_sel_hi:[1,1]
  v_cvt_pk_bf16_f32 v125, v26, v27
  v_cvt_pk_bf16_f32 v126, v116, v117
  v_cvt_pk_bf16_f32 v127, v118, v119
  ds_write_b128 v11, v[124:127] offset:29696
  s_nop 0
  v_smfmac_f32_16x16x64_bf16 v[92:95], v[124:127], a[160:167], v0
  v_smfmac_f32_16x16x64_bf16 v[96:99], v[124:127], a[168:175], v0
  v_smfmac_f32_16x16x64_bf16 v[36:39], v[124:127], a[176:183], v0
  v_smfmac_f32_16x16x64_bf16 v[40:43], v[124:127], a[184:191], v0
  s_waitcnt lgkmcnt(0)
  s_barrier
  ds_read_b128 v[104:107], v11 offset:29184
  ds_read_b128 v[108:111], v11 offset:30720
  ds_read_b128 v[68:71], v11 offset:30208
  s_waitcnt lgkmcnt(2)
  v_smfmac_f32_16x16x64_bf16 v[92:95], v[104:107], a[192:199], v0
  s_waitcnt lgkmcnt(1)
  ds_read_b128 v[76:79], v4 offset:28672
  v_smfmac_f32_16x16x64_bf16 v[92:95], v[108:111], a[224:231], v0
  s_waitcnt lgkmcnt(1)
  ds_read_b128 v[80:83], v4 offset:29696
  v_smfmac_f32_16x16x64_bf16 v[92:95], v[68:71], a[240:247], v0
  ds_read_b128 v[60:63], v4 offset:26624
  v_smfmac_f32_16x16x64_bf16 v[96:99], v[104:107], a[200:207], v0
  ds_read_b128 v[64:67], v4 offset:27648
  v_smfmac_f32_16x16x64_bf16 v[96:99], v[108:111], a[232:239], v0
  ds_read_b128 v[28:31], v4 offset:30720
  s_nop 0
  v_cvt_pk_bf16_f32 v16, v92, v93
  v_cvt_pk_bf16_f32 v17, v94, v95
  v_bfi_b32 v16, 1, s57, v16
  v_smfmac_f32_16x16x64_bf16 v[96:99], v[68:71], a[248:255], v0
  buffer_store_dwordx2 v[16:17], v7, s[4:7], s20 offen offset:0 sc1
  v_smfmac_f32_16x16x64_bf16 v[36:39], v[104:107], a[208:215], v0
  ds_read_b128 v[32:35], v4 offset:31744
  v_smfmac_f32_16x16x64_bf16 v[36:39], v[108:111], v[52:59], v0
  s_waitcnt lgkmcnt(4)
  s_nop 0
  v_cvt_pk_bf16_f32 v18, v96, v97
  v_cvt_pk_bf16_f32 v19, v98, v99
  v_bfi_b32 v18, 1, s57, v18
  v_smfmac_f32_16x16x64_bf16 v[36:39], v[68:71], v[76:83], v0
  buffer_store_dwordx2 v[18:19], v7, s[4:7], s20 offen offset:64 sc1
  v_smfmac_f32_16x16x64_bf16 v[40:43], v[104:107], a[216:223], v0
  s_waitcnt lgkmcnt(2)
  ds_read_b128 v[116:119], v2 offset:31232
  v_smfmac_f32_16x16x64_bf16 v[40:43], v[108:111], v[60:67], v0
  s_waitcnt lgkmcnt(1)
  s_nop 0
  v_cvt_pk_bf16_f32 v20, v36, v37
  v_cvt_pk_bf16_f32 v21, v38, v39
  v_bfi_b32 v20, 1, s57, v20
  v_smfmac_f32_16x16x64_bf16 v[40:43], v[68:71], v[28:35], v0
  buffer_store_dwordx2 v[20:21], v7, s[4:7], s21 offen offset:0 sc1
  s_nop 6
  v_cvt_pk_bf16_f32 v22, v40, v41
  v_cvt_pk_bf16_f32 v23, v42, v43
  v_bfi_b32 v22, 1, s57, v22
  buffer_store_dwordx2 v[22:23], v7, s[4:7], s21 offen offset:64 sc1
  ds_read_b128 v[68:71], v4 offset:0
  ds_read_b128 v[72:75], v4 offset:1024
  ds_read_b128 v[76:79], v4 offset:4096
  ds_read_b128 v[80:83], v4 offset:5120
  ds_read_b128 v[84:87], v4 offset:8192
  ds_read_b128 v[88:91], v4 offset:9216
  ds_read_b128 v[92:95], v4 offset:2048
  ds_read_b128 v[96:99], v4 offset:3072
  ds_read_b128 v[100:103], v4 offset:6144
  ds_read_b128 v[104:107], v4 offset:7168
  ds_read_b128 v[108:111], v4 offset:10240
  ds_read_b128 v[112:115], v4 offset:11264
  v_mov_b64 v[16:17], 0
  v_mov_b64 v[18:19], 0
  v_mov_b64 v[20:21], 0
  v_mov_b64 v[22:23], 0
  v_mov_b64 v[24:25], 0
  v_mov_b64 v[26:27], 0
  s_mov_b32 s19, 0
  v_mov_b32 v49, -1
  ds_read_b64 v[44:45], v2 offset:32256
  s_waitcnt lgkmcnt(0)
  v_readfirstlane_b32 s38, v44
  v_readfirstlane_b32 s37, v45
  s_nop 0
  s_add_u32 s37, s37, 30
  s_cmp_ge_u32 s38, 30
  s_cselect_b32 s38, s37, s38
  s_cmp_ge_u32 s38, 64
  s_cselect_b32 s38, 100, s38
  s_sub_u32 s38, s38, 1
  s_max_i32 s30, s30, s38
  s_waitcnt vmcnt(0)
  buffer_load_dwordx4 v[52:55], v2, s[4:7], s22 offen offset:0 sc1
  buffer_load_dwordx4 v[56:59], v2, s[4:7], s22 offen offset:1024 sc1
  buffer_load_dwordx4 v[60:63], v2, s[4:7], s22 offen offset:2048 sc1
  buffer_load_dwordx4 v[64:67], v2, s[4:7], s22 offen offset:3072 sc1
  s_waitcnt lgkmcnt(12)
  s_waitcnt vmcnt(3)
  v_mfma_f32_16x16x32_bf16 v[120:123], v[116:119], v[52:55], 0
  v_xor_b32 v48, s57, v52
  v_bitop3_b32 v48, v48, v54, s57 bitop3:0xf6
  s_waitcnt vmcnt(2)
  v_mfma_f32_16x16x32_bf16 v[120:123], v[116:119], v[56:59], v[120:123]
  v_bitop3_b32 v48, v48, v56, s57 bitop3:0xf6
  v_bitop3_b32 v48, v48, v58, s57 bitop3:0xf6
  s_waitcnt vmcnt(1)
  v_mfma_f32_16x16x32_bf16 v[120:123], v[116:119], v[60:63], v[120:123]
  v_bitop3_b32 v48, v48, v60, s57 bitop3:0xf6
  v_bitop3_b32 v48, v48, v62, s57 bitop3:0xf6
  s_waitcnt vmcnt(0)
  v_mfma_f32_16x16x32_bf16 v[120:123], v[116:119], v[64:67], v[120:123]
  v_bitop3_b32 v48, v48, v64, s57 bitop3:0xf6
  v_bitop3_b32 v48, v48, v66, s57 bitop3:0xf6
  v_and_b32 v48, 1, v48
  v_cmp_ne_u32 vcc, 0, v48
  s_cbranch_vccnz T_p1re_169
T_p1ok_170:
  s_nop 2
  v_add_f32_dpp v120, v120, v120 row_ror:8 row_mask:0xf bank_mask:0xf
  v_add_f32_dpp v121, v121, v121 row_ror:8 row_mask:0xf bank_mask:0xf
  v_cvt_pk_bf16_f32 v48, v120, v121
  v_min_u32 v48, -2, v48
  buffer_store_dword v48, v8, s[4:7], s35 offen sc1
  buffer_store_dword v49, v8, s[4:7], s26 offen sc1
  s_barrier
  ds_read_b128 v[28:31], v2 offset:17408
  ds_read_b128 v[32:35], v2 offset:21504
  ds_read_b128 v[36:39], v2 offset:8192
  ds_read_b128 v[40:43], v2 offset:9216
  ds_read_b128 v[44:47], v2 offset:10240
  ds_read_b128 v[48:51], v2 offset:11264
  buffer_load_dwordx4 v[124:127], v3, s[4:7], s24 offen offset:1024 sc1
  buffer_load_dwordx4 v[116:119], v3, s[4:7], s25 offen offset:1024 sc1
  ds_read_b128 v[52:55], v2 offset:12288
  ds_read_b128 v[56:59], v2 offset:13312
  ds_read_b128 v[60:63], v2 offset:14336
  ds_read_b128 v[64:67], v2 offset:15360
  buffer_load_dwordx4 v[124:127], v3, s[4:7], s24 offen offset:1024 sc1
  buffer_load_dwordx4 v[116:119], v3, s[4:7], s25 offen offset:1024 sc1
  s_mov_b32 s19, 0
  s_branch T_loop_159
T_p1re_169:
  s_mov_b64 exec, vcc
  buffer_load_dwordx4 v[52:55], v2, s[4:7], s22 offen offset:0 sc1
  buffer_load_dwordx4 v[56:59], v2, s[4:7], s22 offen offset:1024 sc1
  buffer_load_dwordx4 v[60:63], v2, s[4:7], s22 offen offset:2048 sc1
  buffer_load_dwordx4 v[64:67], v2, s[4:7], s22 offen offset:3072 sc1
  s_mov_b64 exec, -1
  s_add_u32 s19, s19, 1
  s_cmp_gt_u32 s19, 32768
  s_cbranch_scc1 M_exit
  s_waitcnt vmcnt(3)
  v_mfma_f32_16x16x32_bf16 v[120:123], v[116:119], v[52:55], 0
  v_xor_b32 v48, s57, v52
  v_bitop3_b32 v48, v48, v54, s57 bitop3:0xf6
  s_waitcnt vmcnt(2)
  v_mfma_f32_16x16x32_bf16 v[120:123], v[116:119], v[56:59], v[120:123]
  v_bitop3_b32 v48, v48, v56, s57 bitop3:0xf6
  v_bitop3_b32 v48, v48, v58, s57 bitop3:0xf6
  s_waitcnt vmcnt(1)
  v_mfma_f32_16x16x32_bf16 v[120:123], v[116:119], v[60:63], v[120:123]
  v_bitop3_b32 v48, v48, v60, s57 bitop3:0xf6
  v_bitop3_b32 v48, v48, v62, s57 bitop3:0xf6
  s_waitcnt vmcnt(0)
  v_mfma_f32_16x16x32_bf16 v[120:123], v[116:119], v[64:67], v[120:123]
  v_bitop3_b32 v48, v48, v64, s57 bitop3:0xf6
  v_bitop3_b32 v48, v48, v66, s57 bitop3:0xf6
  v_and_b32 v48, 1, v48
  v_cmp_ne_u32 vcc, 0, v48
  s_cbranch_vccnz T_p1re_169
  s_branch T_p1ok_170
T_kvw_163:
  s_mov_b32 s19, 0
  s_branch T_kvok_172
T_kv_171:
  s_sleep 4
  s_add_u32 s19, s19, 1
  s_cmp_gt_u32 s19, 32768
  s_cbranch_scc1 M_exit
T_kvok_172:
  s_add_u32 s39, s99, 128
  s_mov_b32 s38, 0
  s_mov_b32 s37, 0
  s_atomic_or s38, s[58:59], s99 glc
  s_atomic_or s37, s[58:59], s39 glc
  s_waitcnt lgkmcnt(0)
  s_add_u32 s37, s37, 30
  s_cmp_ge_u32 s38, 30
  s_cselect_b32 s38, s37, s38
  s_cmp_ge_u32 s38, 64
  s_cselect_b32 s38, 100, s38
  s_sub_u32 s38, s38, 1
  s_max_i32 s30, s30, s38
  s_cmp_ge_i32 s14, s30
  s_cbranch_scc1 T_kv_171
  s_branch T_kvb_164
T_slow_166:
  s_nop 7
  v_max3_f32 v100, v16, v17, v18
  v_max3_f32 v100, v100, v19, v20
  v_max3_f32 v100, v100, v21, v22
  v_max3_f32 v100, v100, v23, v112
  v_max3_f32 v100, v100, v113, v114
  v_max_f32 v100, v100, v115
  v_mov_b32 v101, v100
  s_nop 1
  v_permlane32_swap_b32 v100, v101
  s_nop 1
  v_max_f32 v100, v100, v101
  v_mov_b32 v101, v100
  s_nop 1
  v_permlane16_swap_b32 v100, v101
  s_nop 1
  v_max_f32 v100, v100, v101
  v_sub_f32 v16, v16, v100
  v_sub_f32 v17, v17, v100
  v_sub_f32 v18, v18, v100
  v_sub_f32 v19, v19, v100
  v_exp_f32 v16, v16
  v_exp_f32 v17, v17
  v_exp_f32 v18, v18
  v_exp_f32 v19, v19
  v_sub_f32 v20, v20, v100
  v_sub_f32 v21, v21, v100
  v_sub_f32 v22, v22, v100
  v_sub_f32 v23, v23, v100
  v_exp_f32 v20, v20
  v_exp_f32 v21, v21
  v_exp_f32 v22, v22
  v_exp_f32 v23, v23
  v_sub_f32 v112, v112, v100
  v_sub_f32 v113, v113, v100
  v_sub_f32 v114, v114, v100
  v_sub_f32 v115, v115, v100
  v_exp_f32 v112, v112
  v_exp_f32 v113, v113
  v_exp_f32 v114, v114
  v_exp_f32 v115, v115
  s_nop 0
  v_cvt_pk_bf16_f32 v44, v16, v17
  v_cvt_pk_bf16_f32 v45, v18, v19
  v_cvt_pk_bf16_f32 v46, v20, v21
  v_cvt_pk_bf16_f32 v47, v22, v23
  v_cvt_pk_bf16_f32 v84, v112, v113
  v_cvt_pk_bf16_f32 v85, v114, v115
  v_cndmask_b32 v48, v84, 0, s[16:17]
  v_cndmask_b32 v49, v85, 0, s[16:17]
  v_cndmask_b32 v50, 0, v84, s[16:17]
  v_cndmask_b32 v51, 0, v85, s[16:17]
  s_nop 1
  v_mfma_f32_16x16x16_bf16 v[88:91], v[12:13], v[48:49], 0
  v_mfma_f32_16x16x16_bf16 v[24:27], v[120:121], v[48:49], 0
  v_mfma_f32_16x16x16_bf16 v[116:119], v[120:121], v[50:51], 0
  v_mfma_f32_16x16x32_bf16 v[88:91], v[12:15], v[44:47], v[88:91]
  v_mfma_f32_16x16x32_bf16 v[24:27], v[28:31], v[44:47], v[24:27]
  v_mfma_f32_16x16x32_bf16 v[116:119], v[32:35], v[44:47], v[116:119]
  s_nop 7
  s_nop 1
  v_rcp_f32 v89, v88
  s_nop 0
  v_mul_f32 v24, v89, v24
  v_mul_f32 v25, v89, v25
  s_branch T_back_167
T_w_143:
  s_mov_b32 s19, 0
  v_mov_b64 v[16:17], 0
  v_mov_b64 v[18:19], 0
  v_mov_b64 v[20:21], 0
  v_mov_b64 v[22:23], 0
  v_mov_b64 v[24:25], 0
  v_mov_b64 v[26:27], 0
  buffer_load_dwordx4 v[124:127], v3, s[4:7], s24 offen offset:2048 sc1
  buffer_load_dwordx4 v[116:119], v3, s[4:7], s25 offen offset:2048 sc1
  buffer_load_dwordx4 v[124:127], v3, s[4:7], s24 offen offset:2048 sc1
  buffer_load_dwordx4 v[116:119], v3, s[4:7], s25 offen offset:2048 sc1
  s_branch T_loop_173
.p2align 6
T_retry_174:
  s_mov_b64 exec, vcc
  buffer_load_dwordx4 v[124:127], v3, s[4:7], s24 offen offset:2048 sc1
  buffer_load_dwordx4 v[116:119], v3, s[4:7], s25 offen offset:2048 sc1
  s_mov_b64 exec, -1
  s_add_u32 s19, s19, 1
  s_cmp_gt_u32 s19, 32768
  s_cbranch_scc1 M_exit
T_loop_173:
  s_waitcnt vmcnt(3) lgkmcnt(0)
  v_max3_u32 v123, v124, v125, v126
  v_max_u32 v123, v123, v127
  v_mov_b32_dpp v120, v124 row_ror:8 row_mask:0xf bank_mask:0xf
  v_mov_b32_dpp v121, v125 row_ror:8 row_mask:0xf bank_mask:0xf
  s_waitcnt vmcnt(2)
  v_max3_u32 v123, v123, v116, v117
  v_max3_u32 v123, v123, v118, v119
  v_cmp_eq_u32 vcc, -1, v123
  s_cbranch_vccnz T_retry_174
  v_smfmac_f32_16x16x64_bf16 v[16:19], v[124:127], v[68:75], v0
  s_add_u32 s14, s14, 1
  ds_write_b128 v2, v[124:127] offset:2048
  v_mov_b32_dpp v122, v126 row_ror:8 row_mask:0xf bank_mask:0xf
  v_smfmac_f32_16x16x64_bf16 v[20:23], v[124:127], v[76:83], v0
  s_and_b32 s57, s14, 1
  v_mov_b32_dpp v123, v127 row_ror:8 row_mask:0xf bank_mask:0xf
  v_smfmac_f32_16x16x64_bf16 v[24:27], v[124:127], v[84:91], v0
  s_and_b32 s36, s14, 3
  ds_write_b128 v2, v[116:119] offset:6144
  v_smfmac_f32_16x16x64_bf16 v[16:19], v[120:123], v[92:99], v0
  s_lshl_b32 s36, s36, 13
  v_mov_b32_dpp v84, v116 row_ror:8 row_mask:0xf bank_mask:0xf
  v_smfmac_f32_16x16x64_bf16 v[20:23], v[120:123], v[100:107], v0
  s_add_u32 s26, s36, s23
  ds_read_b128 v[68:71], v4 offset:12288
  v_mov_b32_dpp v85, v117 row_ror:8 row_mask:0xf bank_mask:0xf
  v_smfmac_f32_16x16x64_bf16 v[24:27], v[120:123], v[108:115], v0
  s_add_u32 s36, s36, 8192
  ds_read_b128 v[72:75], v4 offset:13312
  v_mov_b32_dpp v86, v118 row_ror:8 row_mask:0xf bank_mask:0xf
  v_smfmac_f32_16x16x64_bf16 v[16:19], v[116:119], v[224:231], v0
  s_and_b32 s36, s36, 0x7fff
  ds_read_b128 v[76:79], v4 offset:14336
  v_mov_b32_dpp v87, v119 row_ror:8 row_mask:0xf bank_mask:0xf
  v_smfmac_f32_16x16x64_bf16 v[20:23], v[116:119], v[240:247], v0
  s_waitcnt lgkmcnt(3)
  s_barrier
  ds_read_b128 v[100:103], v2 offset:3072
  v_smfmac_f32_16x16x64_bf16 v[24:27], v[116:119], a[0:7], v0
  s_mov_b32 m0, s31
  ds_read_b128 v[120:123], v1 offset:3072
  v_smfmac_f32_16x16x64_bf16 v[16:19], v[84:87], v[232:239], v0
  s_cmp_ge_i32 s14, s30
  s_cbranch_scc1 T_kvw_177
T_kvb_178:
  v_smfmac_f32_16x16x64_bf16 v[20:23], v[84:87], v[248:255], v0
  ds_read_b128 v[80:83], v4 offset:15360
  v_smfmac_f32_16x16x64_bf16 v[24:27], v[84:87], a[8:15], v0
  s_waitcnt lgkmcnt(2)
  v_smfmac_f32_16x16x64_bf16 v[16:19], v[100:103], v[128:135], v0
  ds_read_b128 v[92:95], v2 offset:0
  buffer_load_dwordx4 v9, s[4:7], s27 offen sc1 lds
  v_smfmac_f32_16x16x64_bf16 v[20:23], v[100:103], v[144:151], v0
  ds_read_b128 v[96:99], v1 offset:0
  s_mov_b32 m0, s32
  v_smfmac_f32_16x16x64_bf16 v[24:27], v[100:103], v[68:75], v0
  s_waitcnt vmcnt(1) lgkmcnt(3)
  ds_read_b128 v[116:119], v2 offset:1024
  v_smfmac_f32_16x16x64_bf16 v[16:19], v[120:123], v[136:143], v0
  ds_read_b128 v[124:127], v1 offset:1024
  v_smfmac_f32_16x16x64_bf16 v[20:23], v[120:123], v[152:159], v0
  s_waitcnt lgkmcnt(4)
  ds_read_b128 v[104:107], v2 offset:7168
  buffer_load_dwordx4 v9, s[4:7], s27 offen offset:128 sc1 lds
  v_smfmac_f32_16x16x64_bf16 v[24:27], v[120:123], v[76:83], v0
  s_waitcnt lgkmcnt(4)
  ds_read_b128 v[108:111], v1 offset:7168
  s_mov_b32 m0, s33
  v_smfmac_f32_16x16x64_bf16 v[16:19], v[92:95], v[160:167], v0
  s_waitcnt lgkmcnt(4)
  ds_read_b128 v[112:115], v2 offset:4096
  v_mov_b32 v122, s98
  v_smfmac_f32_16x16x64_bf16 v[16:19], v[96:99], v[168:175], v0
  s_waitcnt lgkmcnt(4)
  ds_read_b128 v[84:87], v1 offset:4096
  v_smfmac_f32_16x16x64_bf16 v[16:19], v[116:119], v[192:199], v0
  s_waitcnt lgkmcnt(4)
  ds_read_b128 v[88:91], v2 offset:5120
  buffer_load_dwordx4 v10, s[4:7], s28 offen sc1 lds
  v_smfmac_f32_16x16x64_bf16 v[16:19], v[124:127], v[200:207], v0
  s_waitcnt lgkmcnt(4)
  ds_read_b128 v[100:103], v1 offset:5120
  s_mov_b32 m0, s34
  v_smfmac_f32_16x16x64_bf16 v[16:19], v[104:107], a[16:23], v0
  s_waitcnt lgkmcnt(4)
  ds_read_b128 v[68:71], v4 offset:16384
  v_smfmac_f32_16x16x64_bf16 v[16:19], v[108:111], a[24:31], v0
  s_waitcnt lgkmcnt(4)
  ds_read_b128 v[72:75], v4 offset:17408
  v_smfmac_f32_16x16x64_bf16 v[16:19], v[112:115], a[64:71], v0
  s_waitcnt lgkmcnt(4)
  ds_read_b128 v[76:79], v4 offset:18432
  buffer_load_dwordx4 v10, s[4:7], s28 offen offset:256 sc1 lds
  v_smfmac_f32_16x16x64_bf16 v[16:19], v[84:87], a[72:79], v0
  s_waitcnt lgkmcnt(4)
  ds_read_b128 v[80:83], v4 offset:19456
  v_smfmac_f32_16x16x64_bf16 v[16:19], v[88:91], a[112:119], v0
  s_waitcnt lgkmcnt(4)
  v_smfmac_f32_16x16x64_bf16 v[16:19], v[100:103], a[120:127], v0
  s_add_u32 s24, s36, 145752064
  s_add_u32 s25, s36, 145756160
  v_smfmac_f32_16x16x64_bf16 v[20:23], v[92:95], v[176:183], v0
  buffer_store_dword v122, v8, s[4:7], s15 offen sc1
  s_add_u32 s35, s36, s23
  v_smfmac_f32_16x16x64_bf16 v[20:23], v[96:99], v[184:191], v0
  s_waitcnt lgkmcnt(2)
  s_add_u32 s98, s14, 1
  v_smfmac_f32_16x16x64_bf16 v[20:23], v[116:119], v[68:75], v0
  s_waitcnt lgkmcnt(0)
  ds_read_b128 v[68:71], v4 offset:20480
  v_mul_f32 v16, s18, v16
  v_smfmac_f32_16x16x64_bf16 v[20:23], v[124:127], v[76:83], v0
  ds_read_b128 v[72:75], v4 offset:21504
  v_mul_f32 v17, s18, v17
  v_smfmac_f32_16x16x64_bf16 v[20:23], v[104:107], a[32:39], v0
  ds_read_b128 v[76:79], v4 offset:22528
  v_mul_f32 v18, s18, v18
  v_smfmac_f32_16x16x64_bf16 v[20:23], v[108:111], a[40:47], v0
  ds_read_b128 v[80:83], v4 offset:23552
  v_mul_f32 v19, s18, v19
  v_smfmac_f32_16x16x64_bf16 v[20:23], v[112:115], a[80:87], v0
  v_cvt_pk_bf16_f32 v120, v16, v17
  v_smfmac_f32_16x16x64_bf16 v[20:23], v[84:87], a[88:95], v0
  v_cvt_pk_bf16_f32 v121, v18, v19
  v_smfmac_f32_16x16x64_bf16 v[20:23], v[88:91], a[128:135], v0
  ds_write_b64 v5, v[120:121] offset:24576
  v_smfmac_f32_16x16x64_bf16 v[20:23], v[100:103], a[136:143], v0
  s_waitcnt lgkmcnt(3)
  v_smfmac_f32_16x16x64_bf16 v[24:27], v[92:95], v[68:75], v0
  s_waitcnt lgkmcnt(1)
  v_mov_b64 v[92:93], 0
  v_smfmac_f32_16x16x64_bf16 v[24:27], v[96:99], v[76:83], v0
  s_nop 1
  v_cvt_pk_bf16_f32 v122, v20, v21
  v_cvt_pk_bf16_f32 v123, v22, v23
  v_smfmac_f32_16x16x64_bf16 v[24:27], v[116:119], v[208:215], v0
  ds_write_b64 v5, v[122:123] offset:26880
  v_mov_b64 v[94:95], 0
  v_smfmac_f32_16x16x64_bf16 v[24:27], v[124:127], v[216:223], v0
  s_waitcnt lgkmcnt(1)
  s_barrier
  ds_read_b64_tr_b16 v[68:69], v6 offset:24576
  v_smfmac_f32_16x16x64_bf16 v[24:27], v[104:107], a[48:55], v0
  s_add_u32 s27, s27, 8192
  ds_read_b64_tr_b16 v[70:71], v6 offset:24640
  ds_read_b64_tr_b16 v[72:73], v6 offset:24832
  v_smfmac_f32_16x16x64_bf16 v[24:27], v[108:111], a[56:63], v0
  s_add_u32 s28, s28, 8192
  ds_read_b64_tr_b16 v[74:75], v6 offset:24896
  ds_read_b64_tr_b16 v[76:77], v6 offset:25088
  v_smfmac_f32_16x16x64_bf16 v[24:27], v[112:115], a[96:103], v0
  s_nop 0
  ds_read_b64_tr_b16 v[78:79], v6 offset:25152
  ds_read_b64_tr_b16 v[80:81], v6 offset:25344
  v_smfmac_f32_16x16x64_bf16 v[24:27], v[84:87], a[104:111], v0
  ds_read_b64_tr_b16 v[82:83], v6 offset:25408
  v_mov_b64 v[96:97], 0
  v_smfmac_f32_16x16x64_bf16 v[24:27], v[88:91], a[144:151], v0
  s_waitcnt lgkmcnt(8)
  s_barrier
  ds_read_b64_tr_b16 v[116:117], v6 offset:26880
  v_smfmac_f32_16x16x64_bf16 v[24:27], v[100:103], a[152:159], v0
  s_waitcnt lgkmcnt(7)
  ds_read_b64_tr_b16 v[118:119], v6 offset:26944
  v_mfma_f32_16x16x32_bf16 v[16:19], v[36:39], v[68:71], 0
  s_waitcnt lgkmcnt(6)
  ds_read_b64_tr_b16 v[124:125], v6 offset:27136
  ds_read_b64_tr_b16 v[126:127], v6 offset:27200
  v_mfma_f32_16x16x32_bf16 v[16:19], v[40:43], v[72:75], v[16:19]
  s_waitcnt lgkmcnt(6)
  ds_read_b64_tr_b16 v[104:105], v6 offset:27392
  ds_read_b64_tr_b16 v[106:107], v6 offset:27456
  v_mfma_f32_16x16x32_bf16 v[16:19], v[44:47], v[76:79], v[16:19]
  s_waitcnt lgkmcnt(6)
  ds_read_b64_tr_b16 v[108:109], v6 offset:27648
  ds_read_b64_tr_b16 v[110:111], v6 offset:27712
  v_mfma_f32_16x16x32_bf16 v[16:19], v[48:51], v[80:83], v[16:19]
  s_waitcnt lgkmcnt(6)
  v_cvt_pk_bf16_f32 v120, v24, v25
  v_cvt_pk_bf16_f32 v121, v26, v27
  v_mfma_f32_16x16x32_bf16 v[112:115], v[116:119], v[68:71], 0
  s_waitcnt lgkmcnt(4)
  buffer_store_dwordx4 v[120:123], v2, s[4:7], s29 offen offset:2048 sc1
  v_mov_b64 v[98:99], 0
  v_mfma_f32_16x16x32_bf16 v[112:115], v[124:127], v[72:75], v[112:115]
  s_waitcnt lgkmcnt(2)
  v_mov_b64 v[36:37], 0
  v_exp_f32 v100, v16
  v_mfma_f32_16x16x32_bf16 v[112:115], v[104:107], v[76:79], v[112:115]
  s_waitcnt lgkmcnt(0)
  v_exp_f32 v101, v17
  v_mfma_f32_16x16x32_bf16 v[112:115], v[108:111], v[80:83], v[112:115]
  s_add_u32 s29, s29, 131072
  v_exp_f32 v102, v18
  v_mfma_f32_16x16x32_bf16 v[20:23], v[52:55], v[68:71], 0
  s_cmp_eq_u32 s14, 63
  v_exp_f32 v103, v19
  v_mfma_f32_16x16x32_bf16 v[20:23], v[56:59], v[72:75], v[20:23]
  s_cbranch_scc1 M_tdone
  v_cvt_pk_bf16_f32 v44, v100, v101
  v_cvt_pk_bf16_f32 v45, v102, v103
  v_mfma_f32_16x16x32_bf16 v[20:23], v[60:63], v[76:79], v[20:23]
  v_exp_f32 v100, v112
  v_mfma_f32_16x16x32_bf16 v[20:23], v[64:67], v[80:83], v[20:23]
  v_exp_f32 v101, v113
  v_exp_f32 v102, v114
  v_exp_f32 v103, v115
  v_cvt_pk_bf16_f32 v84, v100, v101
  v_cvt_pk_bf16_f32 v85, v102, v103
  v_cndmask_b32 v48, v84, 0, s[16:17]
  v_cndmask_b32 v49, v85, 0, s[16:17]
  v_cndmask_b32 v50, 0, v84, s[16:17]
  v_cndmask_b32 v51, 0, v85, s[16:17]
  v_exp_f32 v100, v20
  v_mfma_f32_16x16x16_bf16 v[88:91], v[12:13], v[48:49], 0
  v_exp_f32 v101, v21
  v_mfma_f32_16x16x16_bf16 v[24:27], v[120:121], v[48:49], 0
  v_exp_f32 v102, v22
  v_mfma_f32_16x16x16_bf16 v[116:119], v[120:121], v[50:51], 0
  v_exp_f32 v103, v23
  v_cvt_pk_bf16_f32 v46, v100, v101
  v_cvt_pk_bf16_f32 v47, v102, v103
  v_mov_b64 v[38:39], 0
  s_nop 0
  v_mfma_f32_16x16x32_bf16 v[88:91], v[12:15], v[44:47], v[88:91]
  v_mov_b64 v[40:41], 0
  v_mov_b64 v[42:43], 0
  v_mfma_f32_16x16x32_bf16 v[24:27], v[28:31], v[44:47], v[24:27]
  ds_read_b128 v[52:55], v4 offset:24576
  ds_read_b128 v[56:59], v4 offset:25600
  v_mfma_f32_16x16x32_bf16 v[116:119], v[32:35], v[44:47], v[116:119]
  s_nop 1
  v_rcp_f32 v89, v88
  v_subrev_u32 v100, s54, v88
  v_cmp_le_u32 vcc, s55, v100
  v_mul_f32 v24, v89, v24
  v_mul_f32 v25, v89, v25
  s_cbranch_vccnz T_slow_180
T_back_181:
  v_cvt_pk_bf16_f32 v124, v24, v25
  v_pk_mul_f32 v[26:27], v[26:27], v[88:89] op_sel:[0,1] op_sel_hi:[1,1]
  v_pk_mul_f32 v[116:117], v[116:117], v[88:89] op_sel:[0,1] op_sel_hi:[1,1]
  v_pk_mul_f32 v[118:119], v[118:119], v[88:89] op_sel:[0,1] op_sel_hi:[1,1]
  v_cvt_pk_bf16_f32 v125, v26, v27
  v_cvt_pk_bf16_f32 v126, v116, v117
  v_cvt_pk_bf16_f32 v127, v118, v119
  ds_write_b128 v11, v[124:127] offset:30208
  s_nop 0
  v_smfmac_f32_16x16x64_bf16 v[92:95], v[124:127], a[160:167], v0
  v_smfmac_f32_16x16x64_bf16 v[96:99], v[124:127], a[168:175], v0
  v_smfmac_f32_16x16x64_bf16 v[36:39], v[124:127], a[176:183], v0
  v_smfmac_f32_16x16x64_bf16 v[40:43], v[124:127], a[184:191], v0
  s_waitcnt lgkmcnt(0)
  s_barrier
  ds_read_b128 v[104:107], v11 offset:30720
  ds_read_b128 v[108:111], v11 offset:29184
  ds_read_b128 v[68:71], v11 offset:29696
  s_waitcnt lgkmcnt(2)
  v_smfmac_f32_16x16x64_bf16 v[92:95], v[104:107], a[192:199], v0
  s_waitcnt lgkmcnt(1)
  ds_read_b128 v[76:79], v4 offset:28672
  v_smfmac_f32_16x16x64_bf16 v[92:95], v[108:111], a[224:231], v0
  s_waitcnt lgkmcnt(1)
  ds_read_b128 v[80:83], v4 offset:29696
  v_smfmac_f32_16x16x64_bf16 v[92:95], v[68:71], a[240:247], v0
  ds_read_b128 v[60:63], v4 offset:26624
  v_smfmac_f32_16x16x64_bf16 v[96:99], v[104:107], a[200:207], v0
  ds_read_b128 v[64:67], v4 offset:27648
  v_smfmac_f32_16x16x64_bf16 v[96:99], v[108:111], a[232:239], v0
  ds_read_b128 v[28:31], v4 offset:30720
  s_nop 0
  v_cvt_pk_bf16_f32 v16, v92, v93
  v_cvt_pk_bf16_f32 v17, v94, v95
  v_bfi_b32 v16, 1, s57, v16
  v_smfmac_f32_16x16x64_bf16 v[96:99], v[68:71], a[248:255], v0
  buffer_store_dwordx2 v[16:17], v7, s[4:7], s20 offen offset:0 sc1
  v_smfmac_f32_16x16x64_bf16 v[36:39], v[104:107], a[208:215], v0
  ds_read_b128 v[32:35], v4 offset:31744
  v_smfmac_f32_16x16x64_bf16 v[36:39], v[108:111], v[52:59], v0
  s_waitcnt lgkmcnt(4)
  s_nop 0
  v_cvt_pk_bf16_f32 v18, v96, v97
  v_cvt_pk_bf16_f32 v19, v98, v99
  v_bfi_b32 v18, 1, s57, v18
  v_smfmac_f32_16x16x64_bf16 v[36:39], v[68:71], v[76:83], v0
  buffer_store_dwordx2 v[18:19], v7, s[4:7], s20 offen offset:64 sc1
  v_smfmac_f32_16x16x64_bf16 v[40:43], v[104:107], a[216:223], v0
  s_waitcnt lgkmcnt(2)
  v_smfmac_f32_16x16x64_bf16 v[40:43], v[108:111], v[60:67], v0
  s_waitcnt lgkmcnt(0)
  s_nop 0
  v_cvt_pk_bf16_f32 v20, v36, v37
  v_cvt_pk_bf16_f32 v21, v38, v39
  v_bfi_b32 v20, 1, s57, v20
  v_smfmac_f32_16x16x64_bf16 v[40:43], v[68:71], v[28:35], v0
  buffer_store_dwordx2 v[20:21], v7, s[4:7], s21 offen offset:0 sc1
  s_nop 6
  v_cvt_pk_bf16_f32 v22, v40, v41
  v_cvt_pk_bf16_f32 v23, v42, v43
  v_bfi_b32 v22, 1, s57, v22
  buffer_store_dwordx2 v[22:23], v7, s[4:7], s21 offen offset:64 sc1
  ds_read_b128 v[68:71], v4 offset:0
  ds_read_b128 v[72:75], v4 offset:1024
  ds_read_b128 v[76:79], v4 offset:4096
  ds_read_b128 v[80:83], v4 offset:5120
  ds_read_b128 v[84:87], v4 offset:8192
  ds_read_b128 v[88:91], v4 offset:9216
  ds_read_b128 v[92:95], v4 offset:2048
  ds_read_b128 v[96:99], v4 offset:3072
  ds_read_b128 v[100:103], v4 offset:6144
  ds_read_b128 v[104:107], v4 offset:7168
  ds_read_b128 v[108:111], v4 offset:10240
  ds_read_b128 v[112:115], v4 offset:11264
  v_mov_b64 v[16:17], 0
  v_mov_b64 v[18:19], 0
  v_mov_b64 v[20:21], 0
  v_mov_b64 v[22:23], 0
  v_mov_b64 v[24:25], 0
  v_mov_b64 v[26:27], 0
  ds_read_b64 v[44:45], v2 offset:32256
  s_waitcnt lgkmcnt(0)
  v_readfirstlane_b32 s38, v44
  v_readfirstlane_b32 s37, v45
  s_nop 0
  s_add_u32 s37, s37, 30
  s_cmp_ge_u32 s38, 30
  s_cselect_b32 s38, s37, s38
  s_cmp_ge_u32 s38, 64
  s_cselect_b32 s38, 100, s38
  s_sub_u32 s38, s38, 1
  s_max_i32 s30, s30, s38
  s_waitcnt vmcnt(4)
  s_barrier
  ds_read_b128 v[28:31], v2 offset:18432
  ds_read_b128 v[32:35], v2 offset:22528
  ds_read_b128 v[36:39], v2 offset:8192
  ds_read_b128 v[40:43], v2 offset:9216
  ds_read_b128 v[44:47], v2 offset:10240
  ds_read_b128 v[48:51], v2 offset:11264
  buffer_load_dwordx4 v[124:127], v3, s[4:7], s24 offen offset:2048 sc1
  buffer_load_dwordx4 v[116:119], v3, s[4:7], s25 offen offset:2048 sc1
  ds_read_b128 v[52:55], v2 offset:12288
  ds_read_b128 v[56:59], v2 offset:13312
  ds_read_b128 v[60:63], v2 offset:14336
  ds_read_b128 v[64:67], v2 offset:15360
  buffer_load_dwordx4 v[124:127], v3, s[4:7], s24 offen offset:2048 sc1
  buffer_load_dwordx4 v[116:119], v3, s[4:7], s25 offen offset:2048 sc1
  s_mov_b32 s19, 0
  s_branch T_loop_173
T_kvw_177:
  s_mov_b32 s19, 0
  s_branch T_kvok_186
T_kv_185:
  s_sleep 4
  s_add_u32 s19, s19, 1
  s_cmp_gt_u32 s19, 32768
  s_cbranch_scc1 M_exit
T_kvok_186:
  s_add_u32 s39, s99, 128
  s_mov_b32 s38, 0
  s_mov_b32 s37, 0
  s_atomic_or s38, s[58:59], s99 glc
  s_atomic_or s37, s[58:59], s39 glc
  s_waitcnt lgkmcnt(0)
  s_add_u32 s37, s37, 30
  s_cmp_ge_u32 s38, 30
  s_cselect_b32 s38, s37, s38
  s_cmp_ge_u32 s38, 64
  s_cselect_b32 s38, 100, s38
  s_sub_u32 s38, s38, 1
  s_max_i32 s30, s30, s38
  s_cmp_ge_i32 s14, s30
  s_cbranch_scc1 T_kv_185
  s_branch T_kvb_178
T_slow_180:
  s_nop 7
  v_max3_f32 v100, v16, v17, v18
  v_max3_f32 v100, v100, v19, v20
  v_max3_f32 v100, v100, v21, v22
  v_max3_f32 v100, v100, v23, v112
  v_max3_f32 v100, v100, v113, v114
  v_max_f32 v100, v100, v115
  v_mov_b32 v101, v100
  s_nop 1
  v_permlane32_swap_b32 v100, v101
  s_nop 1
  v_max_f32 v100, v100, v101
  v_mov_b32 v101, v100
  s_nop 1
  v_permlane16_swap_b32 v100, v101
  s_nop 1
  v_max_f32 v100, v100, v101
  v_sub_f32 v16, v16, v100
  v_sub_f32 v17, v17, v100
  v_sub_f32 v18, v18, v100
  v_sub_f32 v19, v19, v100
  v_exp_f32 v16, v16
  v_exp_f32 v17, v17
  v_exp_f32 v18, v18
  v_exp_f32 v19, v19
  v_sub_f32 v20, v20, v100
  v_sub_f32 v21, v21, v100
  v_sub_f32 v22, v22, v100
  v_sub_f32 v23, v23, v100
  v_exp_f32 v20, v20
  v_exp_f32 v21, v21
  v_exp_f32 v22, v22
  v_exp_f32 v23, v23
  v_sub_f32 v112, v112, v100
  v_sub_f32 v113, v113, v100
  v_sub_f32 v114, v114, v100
  v_sub_f32 v115, v115, v100
  v_exp_f32 v112, v112
  v_exp_f32 v113, v113
  v_exp_f32 v114, v114
  v_exp_f32 v115, v115
  s_nop 0
  v_cvt_pk_bf16_f32 v44, v16, v17
  v_cvt_pk_bf16_f32 v45, v18, v19
  v_cvt_pk_bf16_f32 v46, v20, v21
  v_cvt_pk_bf16_f32 v47, v22, v23
  v_cvt_pk_bf16_f32 v84, v112, v113
  v_cvt_pk_bf16_f32 v85, v114, v115
  v_cndmask_b32 v48, v84, 0, s[16:17]
  v_cndmask_b32 v49, v85, 0, s[16:17]
  v_cndmask_b32 v50, 0, v84, s[16:17]
  v_cndmask_b32 v51, 0, v85, s[16:17]
  s_nop 1
  v_mfma_f32_16x16x16_bf16 v[88:91], v[12:13], v[48:49], 0
  v_mfma_f32_16x16x16_bf16 v[24:27], v[120:121], v[48:49], 0
  v_mfma_f32_16x16x16_bf16 v[116:119], v[120:121], v[50:51], 0
  v_mfma_f32_16x16x32_bf16 v[88:91], v[12:15], v[44:47], v[88:91]
  v_mfma_f32_16x16x32_bf16 v[24:27], v[28:31], v[44:47], v[24:27]
  v_mfma_f32_16x16x32_bf16 v[116:119], v[32:35], v[44:47], v[116:119]
  s_nop 7
  s_nop 1
  v_rcp_f32 v89, v88
  s_nop 0
  v_mul_f32 v24, v89, v24
  v_mul_f32 v25, v89, v25
  s_branch T_back_181
T_w_144:
  s_mov_b32 s19, 0
  v_mov_b64 v[16:17], 0
  v_mov_b64 v[18:19], 0
  v_mov_b64 v[20:21], 0
  v_mov_b64 v[22:23], 0
  v_mov_b64 v[24:25], 0
  v_mov_b64 v[26:27], 0
  buffer_load_dwordx4 v[124:127], v3, s[4:7], s24 offen offset:3072 sc1
  buffer_load_dwordx4 v[116:119], v3, s[4:7], s25 offen offset:3072 sc1
  buffer_load_dwordx4 v[124:127], v3, s[4:7], s24 offen offset:3072 sc1
  buffer_load_dwordx4 v[116:119], v3, s[4:7], s25 offen offset:3072 sc1
  s_branch T_loop_187
.p2align 6
T_retry_188:
  s_mov_b64 exec, vcc
  buffer_load_dwordx4 v[124:127], v3, s[4:7], s24 offen offset:3072 sc1
  buffer_load_dwordx4 v[116:119], v3, s[4:7], s25 offen offset:3072 sc1
  s_mov_b64 exec, -1
  s_add_u32 s19, s19, 1
  s_cmp_gt_u32 s19, 32768
  s_cbranch_scc1 M_exit
T_loop_187:
  s_waitcnt vmcnt(3) lgkmcnt(0)
  v_max3_u32 v123, v124, v125, v126
  v_max_u32 v123, v123, v127
  v_mov_b32_dpp v120, v124 row_ror:8 row_mask:0xf bank_mask:0xf
  v_mov_b32_dpp v121, v125 row_ror:8 row_mask:0xf bank_mask:0xf
  s_waitcnt vmcnt(2)
  v_max3_u32 v123, v123, v116, v117
  v_max3_u32 v123, v123, v118, v119
  v_cmp_eq_u32 vcc, -1, v123
  s_cbranch_vccnz T_retry_188
  v_smfmac_f32_16x16x64_bf16 v[16:19], v[124:127], v[68:75], v0
  s_add_u32 s14, s14, 1
  ds_write_b128 v2, v[124:127] offset:3072
  v_mov_b32_dpp v122, v126 row_ror:8 row_mask:0xf bank_mask:0xf
  v_smfmac_f32_16x16x64_bf16 v[20:23], v[124:127], v[76:83], v0
  s_and_b32 s57, s14, 1
  v_mov_b32_dpp v123, v127 row_ror:8 row_mask:0xf bank_mask:0xf
  v_smfmac_f32_16x16x64_bf16 v[24:27], v[124:127], v[84:91], v0
  s_and_b32 s36, s14, 3
  ds_write_b128 v2, v[116:119] offset:7168
  v_smfmac_f32_16x16x64_bf16 v[16:19], v[120:123], v[92:99], v0
  s_lshl_b32 s36, s36, 13
  v_mov_b32_dpp v84, v116 row_ror:8 row_mask:0xf bank_mask:0xf
  v_smfmac_f32_16x16x64_bf16 v[20:23], v[120:123], v[100:107], v0
  s_add_u32 s26, s36, s23
  ds_read_b128 v[68:71], v4 offset:12288
  v_mov_b32_dpp v85, v117 row_ror:8 row_mask:0xf bank_mask:0xf
  v_smfmac_f32_16x16x64_bf16 v[24:27], v[120:123], v[108:115], v0
  s_add_u32 s36, s36, 8192
  ds_read_b128 v[72:75], v4 offset:13312
  v_mov_b32_dpp v86, v118 row_ror:8 row_mask:0xf bank_mask:0xf
  v_smfmac_f32_16x16x64_bf16 v[16:19], v[116:119], v[224:231], v0
  s_and_b32 s36, s36, 0x7fff
  ds_read_b128 v[76:79], v4 offset:14336
  v_mov_b32_dpp v87, v119 row_ror:8 row_mask:0xf bank_mask:0xf
  v_smfmac_f32_16x16x64_bf16 v[20:23], v[116:119], v[240:247], v0
  s_waitcnt lgkmcnt(3)
  s_barrier
  ds_read_b128 v[100:103], v2 offset:2048
  v_smfmac_f32_16x16x64_bf16 v[24:27], v[116:119], a[0:7], v0
  s_mov_b32 m0, s31
  ds_read_b128 v[120:123], v1 offset:2048
  v_smfmac_f32_16x16x64_bf16 v[16:19], v[84:87], v[232:239], v0
  s_cmp_ge_i32 s14, s30
  s_cbranch_scc1 T_kvw_191
T_kvb_192:
  v_smfmac_f32_16x16x64_bf16 v[20:23], v[84:87], v[248:255], v0
  ds_read_b128 v[80:83], v4 offset:15360
  v_smfmac_f32_16x16x64_bf16 v[24:27], v[84:87], a[8:15], v0
  s_waitcnt lgkmcnt(2)
  v_smfmac_f32_16x16x64_bf16 v[16:19], v[100:103], v[128:135], v0
  ds_read_b128 v[92:95], v2 offset:1024
  v_smfmac_f32_16x16x64_bf16 v[20:23], v[100:103], v[144:151], v0
  ds_read_b128 v[96:99], v1 offset:1024
  buffer_load_dwordx4 v9, s[4:7], s27 offen sc1 lds
  v_smfmac_f32_16x16x64_bf16 v[24:27], v[100:103], v[68:75], v0
  s_waitcnt vmcnt(1) lgkmcnt(3)
  ds_read_b128 v[116:119], v2 offset:0
  s_mov_b32 m0, s32
  v_smfmac_f32_16x16x64_bf16 v[16:19], v[120:123], v[136:143], v0
  ds_read_b128 v[124:127], v1 offset:0
  v_smfmac_f32_16x16x64_bf16 v[20:23], v[120:123], v[152:159], v0
  s_waitcnt lgkmcnt(4)
  ds_read_b128 v[104:107], v2 offset:6144
  v_smfmac_f32_16x16x64_bf16 v[24:27], v[120:123], v[76:83], v0
  s_waitcnt lgkmcnt(4)
  ds_read_b128 v[108:111], v1 offset:6144
  buffer_load_dwordx4 v9, s[4:7], s27 offen offset:128 sc1 lds
  v_smfmac_f32_16x16x64_bf16 v[16:19], v[92:95], v[160:167], v0
  s_waitcnt lgkmcnt(4)
  ds_read_b128 v[112:115], v2 offset:5120
  s_mov_b32 m0, s33
  v_smfmac_f32_16x16x64_bf16 v[16:19], v[96:99], v[168:175], v0
  s_waitcnt lgkmcnt(4)
  ds_read_b128 v[84:87], v1 offset:5120
  v_smfmac_f32_16x16x64_bf16 v[16:19], v[116:119], v[192:199], v0
  s_waitcnt lgkmcnt(4)
  ds_read_b128 v[88:91], v2 offset:4096
  v_smfmac_f32_16x16x64_bf16 v[16:19], v[124:127], v[200:207], v0
  s_waitcnt lgkmcnt(4)
  ds_read_b128 v[100:103], v1 offset:4096
  buffer_load_dwordx4 v10, s[4:7], s28 offen sc1 lds
  v_smfmac_f32_16x16x64_bf16 v[16:19], v[104:107], a[16:23], v0
  s_waitcnt lgkmcnt(4)
  ds_read_b128 v[68:71], v4 offset:16384
  s_mov_b32 m0, s34
  v_smfmac_f32_16x16x64_bf16 v[16:19], v[108:111], a[24:31], v0
  s_waitcnt lgkmcnt(4)
  ds_read_b128 v[72:75], v4 offset:17408
  v_smfmac_f32_16x16x64_bf16 v[16:19], v[112:115], a[64:71], v0
  s_waitcnt lgkmcnt(4)
  ds_read_b128 v[76:79], v4 offset:18432
  v_smfmac_f32_16x16x64_bf16 v[16:19], v[84:87], a[72:79], v0
  s_waitcnt lgkmcnt(4)
  ds_read_b128 v[80:83], v4 offset:19456
  buffer_load_dwordx4 v10, s[4:7], s28 offen offset:256 sc1 lds
  v_smfmac_f32_16x16x64_bf16 v[16:19], v[88:91], a[112:119], v0
  s_waitcnt lgkmcnt(4)
  s_mov_b32 m0, 32256
  v_smfmac_f32_16x16x64_bf16 v[16:19], v[100:103], a[120:127], v0
  s_add_u32 s24, s36, 145752064
  s_add_u32 s25, s36, 145756160
  v_smfmac_f32_16x16x64_bf16 v[20:23], v[92:95], v[176:183], v0
  s_add_u32 s35, s36, s23
  v_smfmac_f32_16x16x64_bf16 v[20:23], v[96:99], v[184:191], v0
  s_waitcnt lgkmcnt(2)
  buffer_load_dword v8, s[4:7], s99 offen sc1 lds
  v_smfmac_f32_16x16x64_bf16 v[20:23], v[116:119], v[68:75], v0
  s_waitcnt lgkmcnt(0)
  ds_read_b128 v[68:71], v4 offset:20480
  v_mul_f32 v16, s18, v16
  v_smfmac_f32_16x16x64_bf16 v[20:23], v[124:127], v[76:83], v0
  ds_read_b128 v[72:75], v4 offset:21504
  v_mul_f32 v17, s18, v17
  v_smfmac_f32_16x16x64_bf16 v[20:23], v[104:107], a[32:39], v0
  ds_read_b128 v[76:79], v4 offset:22528
  v_mul_f32 v18, s18, v18
  v_smfmac_f32_16x16x64_bf16 v[20:23], v[108:111], a[40:47], v0
  ds_read_b128 v[80:83], v4 offset:23552
  v_mul_f32 v19, s18, v19
  v_smfmac_f32_16x16x64_bf16 v[20:23], v[112:115], a[80:87], v0
  v_cvt_pk_bf16_f32 v120, v16, v17
  v_smfmac_f32_16x16x64_bf16 v[20:23], v[84:87], a[88:95], v0
  v_cvt_pk_bf16_f32 v121, v18, v19
  v_smfmac_f32_16x16x64_bf16 v[20:23], v[88:91], a[128:135], v0
  ds_write_b64 v5, v[120:121] offset:24576
  v_smfmac_f32_16x16x64_bf16 v[20:23], v[100:103], a[136:143], v0
  s_waitcnt lgkmcnt(3)
  v_smfmac_f32_16x16x64_bf16 v[24:27], v[92:95], v[68:75], v0
  s_waitcnt lgkmcnt(1)
  v_mov_b64 v[92:93], 0
  v_smfmac_f32_16x16x64_bf16 v[24:27], v[96:99], v[76:83], v0
  s_nop 1
  v_cvt_pk_bf16_f32 v122, v20, v21
  v_cvt_pk_bf16_f32 v123, v22, v23
  v_smfmac_f32_16x16x64_bf16 v[24:27], v[116:119], v[208:215], v0
  ds_write_b64 v5, v[122:123] offset:26880
  v_mov_b64 v[94:95], 0
  v_smfmac_f32_16x16x64_bf16 v[24:27], v[124:127], v[216:223], v0
  s_waitcnt lgkmcnt(1)
  s_barrier
  ds_read_b64_tr_b16 v[68:69], v6 offset:24576
  v_smfmac_f32_16x16x64_bf16 v[24:27], v[104:107], a[48:55], v0
  s_add_u32 s27, s27, 8192
  ds_read_b64_tr_b16 v[70:71], v6 offset:24640
  ds_read_b64_tr_b16 v[72:73], v6 offset:24832
  v_smfmac_f32_16x16x64_bf16 v[24:27], v[108:111], a[56:63], v0
  s_add_u32 s28, s28, 8192
  ds_read_b64_tr_b16 v[74:75], v6 offset:24896
  ds_read_b64_tr_b16 v[76:77], v6 offset:25088
  v_smfmac_f32_16x16x64_bf16 v[24:27], v[112:115], a[96:103], v0
  s_nop 0
  ds_read_b64_tr_b16 v[78:79], v6 offset:25152
  ds_read_b64_tr_b16 v[80:81], v6 offset:25344
  v_smfmac_f32_16x16x64_bf16 v[24:27], v[84:87], a[104:111], v0
  ds_read_b64_tr_b16 v[82:83], v6 offset:25408
  v_mov_b64 v[96:97], 0
  v_smfmac_f32_16x16x64_bf16 v[24:27], v[88:91], a[144:151], v0
  s_waitcnt lgkmcnt(8)
  s_barrier
  ds_read_b64_tr_b16 v[116:117], v6 offset:26880
  v_smfmac_f32_16x16x64_bf16 v[24:27], v[100:103], a[152:159], v0
  s_waitcnt lgkmcnt(7)
  ds_read_b64_tr_b16 v[118:119], v6 offset:26944
  v_mfma_f32_16x16x32_bf16 v[16:19], v[36:39], v[68:71], 0
  s_waitcnt lgkmcnt(6)
  ds_read_b64_tr_b16 v[124:125], v6 offset:27136
  ds_read_b64_tr_b16 v[126:127], v6 offset:27200
  v_mfma_f32_16x16x32_bf16 v[16:19], v[40:43], v[72:75], v[16:19]
  s_waitcnt lgkmcnt(6)
  ds_read_b64_tr_b16 v[104:105], v6 offset:27392
  ds_read_b64_tr_b16 v[106:107], v6 offset:27456
  v_mfma_f32_16x16x32_bf16 v[16:19], v[44:47], v[76:79], v[16:19]
  s_waitcnt lgkmcnt(6)
  ds_read_b64_tr_b16 v[108:109], v6 offset:27648
  ds_read_b64_tr_b16 v[110:111], v6 offset:27712
  v_mfma_f32_16x16x32_bf16 v[16:19], v[48:51], v[80:83], v[16:19]
  s_waitcnt lgkmcnt(6)
  v_cvt_pk_bf16_f32 v120, v24, v25
  v_cvt_pk_bf16_f32 v121, v26, v27
  v_mfma_f32_16x16x32_bf16 v[112:115], v[116:119], v[68:71], 0
  s_waitcnt lgkmcnt(4)
  buffer_store_dwordx4 v[120:123], v2, s[4:7], s29 offen offset:3072 sc1
  v_mov_b64 v[98:99], 0
  v_mfma_f32_16x16x32_bf16 v[112:115], v[124:127], v[72:75], v[112:115]
  s_waitcnt lgkmcnt(2)
  v_mov_b64 v[36:37], 0
  v_exp_f32 v100, v16
  v_mfma_f32_16x16x32_bf16 v[112:115], v[104:107], v[76:79], v[112:115]
  s_waitcnt lgkmcnt(0)
  v_exp_f32 v101, v17
  v_mfma_f32_16x16x32_bf16 v[112:115], v[108:111], v[80:83], v[112:115]
  s_add_u32 s29, s29, 131072
  v_exp_f32 v102, v18
  v_mfma_f32_16x16x32_bf16 v[20:23], v[52:55], v[68:71], 0
  s_cmp_eq_u32 s14, 63
  v_exp_f32 v103, v19
  v_mfma_f32_16x16x32_bf16 v[20:23], v[56:59], v[72:75], v[20:23]
  s_cbranch_scc1 M_tdone
  v_cvt_pk_bf16_f32 v44, v100, v101
  v_cvt_pk_bf16_f32 v45, v102, v103
  v_mfma_f32_16x16x32_bf16 v[20:23], v[60:63], v[76:79], v[20:23]
  v_exp_f32 v100, v112
  v_mfma_f32_16x16x32_bf16 v[20:23], v[64:67], v[80:83], v[20:23]
  v_exp_f32 v101, v113
  v_exp_f32 v102, v114
  v_exp_f32 v103, v115
  v_cvt_pk_bf16_f32 v84, v100, v101
  v_cvt_pk_bf16_f32 v85, v102, v103
  v_cndmask_b32 v48, v84, 0, s[16:17]
  v_cndmask_b32 v49, v85, 0, s[16:17]
  v_cndmask_b32 v50, 0, v84, s[16:17]
  v_cndmask_b32 v51, 0, v85, s[16:17]
  v_exp_f32 v100, v20
  v_mfma_f32_16x16x16_bf16 v[88:91], v[12:13], v[48:49], 0
  v_exp_f32 v101, v21
  v_mfma_f32_16x16x16_bf16 v[24:27], v[120:121], v[48:49], 0
  v_exp_f32 v102, v22
  v_mfma_f32_16x16x16_bf16 v[116:119], v[120:121], v[50:51], 0
  v_exp_f32 v103, v23
  v_cvt_pk_bf16_f32 v46, v100, v101
  v_cvt_pk_bf16_f32 v47, v102, v103
  v_mov_b64 v[38:39], 0
  s_nop 0
  v_mfma_f32_16x16x32_bf16 v[88:91], v[12:15], v[44:47], v[88:91]
  v_mov_b64 v[40:41], 0
  v_mov_b64 v[42:43], 0
  v_mfma_f32_16x16x32_bf16 v[24:27], v[28:31], v[44:47], v[24:27]
  ds_read_b128 v[52:55], v4 offset:24576
  ds_read_b128 v[56:59], v4 offset:25600
  v_mfma_f32_16x16x32_bf16 v[116:119], v[32:35], v[44:47], v[116:119]
  s_nop 1
  v_rcp_f32 v89, v88
  v_subrev_u32 v100, s54, v88
  v_cmp_le_u32 vcc, s55, v100
  v_mul_f32 v24, v89, v24
  v_mul_f32 v25, v89, v25
  s_cbranch_vccnz T_slow_194
T_back_195:
  v_cvt_pk_bf16_f32 v124, v24, v25
  v_pk_mul_f32 v[26:27], v[26:27], v[88:89] op_sel:[0,1] op_sel_hi:[1,1]
  v_pk_mul_f32 v[116:117], v[116:117], v[88:89] op_sel:[0,1] op_sel_hi:[1,1]
  v_pk_mul_f32 v[118:119], v[118:119], v[88:89] op_sel:[0,1] op_sel_hi:[1,1]
  v_cvt_pk_bf16_f32 v125, v26, v27
  v_cvt_pk_bf16_f32 v126, v116, v117
  v_cvt_pk_bf16_f32 v127, v118, v119
  ds_write_b128 v11, v[124:127] offset:30720
  s_nop 0
  v_smfmac_f32_16x16x64_bf16 v[92:95], v[124:127], a[160:167], v0
  v_smfmac_f32_16x16x64_bf16 v[96:99], v[124:127], a[168:175], v0
  v_smfmac_f32_16x16x64_bf16 v[36:39], v[124:127], a[176:183], v0
  v_smfmac_f32_16x16x64_bf16 v[40:43], v[124:127], a[184:191], v0
  s_waitcnt lgkmcnt(0)
  s_barrier
  ds_read_b128 v[104:107], v11 offset:30208
  ds_read_b128 v[108:111], v11 offset:29696
  ds_read_b128 v[68:71], v11 offset:29184
  s_waitcnt lgkmcnt(2)
  v_smfmac_f32_16x16x64_bf16 v[92:95], v[104:107], a[192:199], v0
  s_waitcnt lgkmcnt(1)
  ds_read_b128 v[76:79], v4 offset:28672
  v_smfmac_f32_16x16x64_bf16 v[92:95], v[108:111], a[224:231], v0
  s_waitcnt lgkmcnt(1)
  ds_read_b128 v[80:83], v4 offset:29696
  v_smfmac_f32_16x16x64_bf16 v[92:95], v[68:71], a[240:247], v0
  ds_read_b128 v[60:63], v4 offset:26624
  v_smfmac_f32_16x16x64_bf16 v[96:99], v[104:107], a[200:207], v0
  ds_read_b128 v[64:67], v4 offset:27648
  v_smfmac_f32_16x16x64_bf16 v[96:99], v[108:111], a[232:239], v0
  ds_read_b128 v[28:31], v4 offset:30720
  s_nop 0
  v_cvt_pk_bf16_f32 v16, v92, v93
  v_cvt_pk_bf16_f32 v17, v94, v95
  v_bfi_b32 v16, 1, s57, v16
  v_smfmac_f32_16x16x64_bf16 v[96:99], v[68:71], a[248:255], v0
  buffer_store_dwordx2 v[16:17], v7, s[4:7], s20 offen offset:0 sc1
  v_smfmac_f32_16x16x64_bf16 v[36:39], v[104:107], a[208:215], v0
  ds_read_b128 v[32:35], v4 offset:31744
  v_smfmac_f32_16x16x64_bf16 v[36:39], v[108:111], v[52:59], v0
  s_waitcnt lgkmcnt(4)
  s_nop 0
  v_cvt_pk_bf16_f32 v18, v96, v97
  v_cvt_pk_bf16_f32 v19, v98, v99
  v_bfi_b32 v18, 1, s57, v18
  v_smfmac_f32_16x16x64_bf16 v[36:39], v[68:71], v[76:83], v0
  buffer_store_dwordx2 v[18:19], v7, s[4:7], s20 offen offset:64 sc1
  v_smfmac_f32_16x16x64_bf16 v[40:43], v[104:107], a[216:223], v0
  s_waitcnt lgkmcnt(2)
  v_smfmac_f32_16x16x64_bf16 v[40:43], v[108:111], v[60:67], v0
  s_waitcnt lgkmcnt(0)
  s_nop 0
  v_cvt_pk_bf16_f32 v20, v36, v37
  v_cvt_pk_bf16_f32 v21, v38, v39
  v_bfi_b32 v20, 1, s57, v20
  v_smfmac_f32_16x16x64_bf16 v[40:43], v[68:71], v[28:35], v0
  buffer_store_dwordx2 v[20:21], v7, s[4:7], s21 offen offset:0 sc1
  s_nop 6
  v_cvt_pk_bf16_f32 v22, v40, v41
  v_cvt_pk_bf16_f32 v23, v42, v43
  v_bfi_b32 v22, 1, s57, v22
  buffer_store_dwordx2 v[22:23], v7, s[4:7], s21 offen offset:64 sc1
  ds_read_b128 v[68:71], v4 offset:0
  ds_read_b128 v[72:75], v4 offset:1024
  ds_read_b128 v[76:79], v4 offset:4096
  ds_read_b128 v[80:83], v4 offset:5120
  ds_read_b128 v[84:87], v4 offset:8192
  ds_read_b128 v[88:91], v4 offset:9216
  ds_read_b128 v[92:95], v4 offset:2048
  ds_read_b128 v[96:99], v4 offset:3072
  ds_read_b128 v[100:103], v4 offset:6144
  ds_read_b128 v[104:107], v4 offset:7168
  ds_read_b128 v[108:111], v4 offset:10240
  ds_read_b128 v[112:115], v4 offset:11264
  v_mov_b64 v[16:17], 0
  v_mov_b64 v[18:19], 0
  v_mov_b64 v[20:21], 0
  v_mov_b64 v[22:23], 0
  v_mov_b64 v[24:25], 0
  v_mov_b64 v[26:27], 0
  ds_read_b64 v[44:45], v2 offset:32256
  s_waitcnt lgkmcnt(0)
  v_readfirstlane_b32 s38, v44
  v_readfirstlane_b32 s37, v45
  s_nop 0
  s_add_u32 s37, s37, 30
  s_cmp_ge_u32 s38, 30
  s_cselect_b32 s38, s37, s38
  s_cmp_ge_u32 s38, 64
  s_cselect_b32 s38, 100, s38
  s_sub_u32 s38, s38, 1
  s_max_i32 s30, s30, s38
  s_waitcnt vmcnt(4)
  s_barrier
  ds_read_b128 v[28:31], v2 offset:19456
  ds_read_b128 v[32:35], v2 offset:23552
  ds_read_b128 v[36:39], v2 offset:8192
  ds_read_b128 v[40:43], v2 offset:9216
  ds_read_b128 v[44:47], v2 offset:10240
  ds_read_b128 v[48:51], v2 offset:11264
  buffer_load_dwordx4 v[124:127], v3, s[4:7], s24 offen offset:3072 sc1
  buffer_load_dwordx4 v[116:119], v3, s[4:7], s25 offen offset:3072 sc1
  ds_read_b128 v[52:55], v2 offset:12288
  ds_read_b128 v[56:59], v2 offset:13312
  ds_read_b128 v[60:63], v2 offset:14336
  ds_read_b128 v[64:67], v2 offset:15360
  buffer_load_dwordx4 v[124:127], v3, s[4:7], s24 offen offset:3072 sc1
  buffer_load_dwordx4 v[116:119], v3, s[4:7], s25 offen offset:3072 sc1
  s_mov_b32 s19, 0
  s_branch T_loop_187
T_kvw_191:
  s_mov_b32 s19, 0
  s_branch T_kvok_200
T_kv_199:
  s_sleep 4
  s_add_u32 s19, s19, 1
  s_cmp_gt_u32 s19, 32768
  s_cbranch_scc1 M_exit
T_kvok_200:
  s_add_u32 s39, s99, 128
  s_mov_b32 s38, 0
  s_mov_b32 s37, 0
  s_atomic_or s38, s[58:59], s99 glc
  s_atomic_or s37, s[58:59], s39 glc
  s_waitcnt lgkmcnt(0)
  s_add_u32 s37, s37, 30
  s_cmp_ge_u32 s38, 30
  s_cselect_b32 s38, s37, s38
  s_cmp_ge_u32 s38, 64
  s_cselect_b32 s38, 100, s38
  s_sub_u32 s38, s38, 1
  s_max_i32 s30, s30, s38
  s_cmp_ge_i32 s14, s30
  s_cbranch_scc1 T_kv_199
  s_branch T_kvb_192
T_slow_194:
  s_nop 7
  v_max3_f32 v100, v16, v17, v18
  v_max3_f32 v100, v100, v19, v20
  v_max3_f32 v100, v100, v21, v22
  v_max3_f32 v100, v100, v23, v112
  v_max3_f32 v100, v100, v113, v114
  v_max_f32 v100, v100, v115
  v_mov_b32 v101, v100
  s_nop 1
  v_permlane32_swap_b32 v100, v101
  s_nop 1
  v_max_f32 v100, v100, v101
  v_mov_b32 v101, v100
  s_nop 1
  v_permlane16_swap_b32 v100, v101
  s_nop 1
  v_max_f32 v100, v100, v101
  v_sub_f32 v16, v16, v100
  v_sub_f32 v17, v17, v100
  v_sub_f32 v18, v18, v100
  v_sub_f32 v19, v19, v100
  v_exp_f32 v16, v16
  v_exp_f32 v17, v17
  v_exp_f32 v18, v18
  v_exp_f32 v19, v19
  v_sub_f32 v20, v20, v100
  v_sub_f32 v21, v21, v100
  v_sub_f32 v22, v22, v100
  v_sub_f32 v23, v23, v100
  v_exp_f32 v20, v20
  v_exp_f32 v21, v21
  v_exp_f32 v22, v22
  v_exp_f32 v23, v23
  v_sub_f32 v112, v112, v100
  v_sub_f32 v113, v113, v100
  v_sub_f32 v114, v114, v100
  v_sub_f32 v115, v115, v100
  v_exp_f32 v112, v112
  v_exp_f32 v113, v113
  v_exp_f32 v114, v114
  v_exp_f32 v115, v115
  s_nop 0
  v_cvt_pk_bf16_f32 v44, v16, v17
  v_cvt_pk_bf16_f32 v45, v18, v19
  v_cvt_pk_bf16_f32 v46, v20, v21
  v_cvt_pk_bf16_f32 v47, v22, v23
  v_cvt_pk_bf16_f32 v84, v112, v113
  v_cvt_pk_bf16_f32 v85, v114, v115
  v_cndmask_b32 v48, v84, 0, s[16:17]
  v_cndmask_b32 v49, v85, 0, s[16:17]
  v_cndmask_b32 v50, 0, v84, s[16:17]
  v_cndmask_b32 v51, 0, v85, s[16:17]
  s_nop 1
  v_mfma_f32_16x16x16_bf16 v[88:91], v[12:13], v[48:49], 0
  v_mfma_f32_16x16x16_bf16 v[24:27], v[120:121], v[48:49], 0
  v_mfma_f32_16x16x16_bf16 v[116:119], v[120:121], v[50:51], 0
  v_mfma_f32_16x16x32_bf16 v[88:91], v[12:15], v[44:47], v[88:91]
  v_mfma_f32_16x16x32_bf16 v[24:27], v[28:31], v[44:47], v[24:27]
  v_mfma_f32_16x16x32_bf16 v[116:119], v[32:35], v[44:47], v[116:119]
  s_nop 7
  s_nop 1
  v_rcp_f32 v89, v88
  s_nop 0
  v_mul_f32 v24, v89, v24
  v_mul_f32 v25, v89, v25
  s_branch T_back_195
M_tdone:
  v_mov_b32 v16, 64
  v_or_b32 v17, s13, v2
  v_min_u32 v17, 1, v17
  v_lshlrev_b32 v17, 30, v17
  s_waitcnt vmcnt(0)
  s_barrier
  buffer_store_dword v16, v17, s[4:7], s15 offen sc1
M_done:
M_exit:
  s_endpgm
.p2align 6
.type M_table,@object
M_table:
.long 0x1, 0x3f, 0xffffffff, 0x17, 0x1, 0x7, 0x800, 0x0, 0x8, 0x0, 0x0, 0x0, 0x0, 0x0, 0x0, 0x0
.long 0x1, 0x28, 0xffffffff, 0x1b, 0x1, 0x6, 0x1000, 0x0, 0x8, 0x1, 0x0, 0x0, 0x0, 0x0, 0x0, 0x0
.long 0x2, 0x0, 0x1, 0x1e, 0x1, 0x5, 0x1800, 0x0, 0x8, 0x0, 0x0, 0x0, 0x0, 0x0, 0x0, 0x0
.long 0x2, 0x1e, 0x1, 0x22, 0x1, 0x4, 0x2000, 0x0, 0x8, 0x1, 0x0, 0x0, 0x0, 0x0, 0x0, 0x0
.long 0x0, 0x0, 0x1, 0x20, 0x2, 0x3, 0x20, 0x0, 0x8, 0x2, 0x0, 0x0, 0x0, 0x0, 0x0, 0x0
.long 0x0, 0x3f, 0xffffffff, 0x20, 0x2, 0x2, 0x18, 0x1, 0x10, 0x0, 0x0, 0x0, 0x0, 0x0, 0x0, 0x0
.long 0x1, 0xd, 0xffffffff, 0xe, 0x0, 0x0, 0x8, 0x0, 0x8, 0x2, 0x0, 0x0, 0x0, 0x0, 0x0, 0x0
.size M_table, 448
.section .rodata,"a"
.p2align 6
.amdhsa_kernel gated_mix__compressed_kv_cla__memory_aug_recurrent_mem_tr__prompt_kernel
.amdhsa_next_free_vgpr 512
.amdhsa_next_free_sgpr 102
.amdhsa_accum_offset 256
.amdhsa_group_segment_fixed_size 0
.amdhsa_kernarg_size 136
.amdhsa_user_sgpr_count 2
.amdhsa_user_sgpr_kernarg_segment_ptr 1
.amdhsa_system_sgpr_workgroup_id_x 1
.end_amdhsa_kernel
```

```asm
; @launch grid=(256,1,1) block=(256,1,1) lds=163840
.amdgcn_target "amdgcn-amd-amdhsa--gfx950"
.text
.globl gated_mix__compressed_kv_cla__memory_aug_recurrent_mem_tr__prompt_kernel
.p2align 8
.type gated_mix__compressed_kv_cla__memory_aug_recurrent_mem_tr__prompt_kernel,@function
gated_mix__compressed_kv_cla__memory_aug_recurrent_mem_tr__prompt_kernel:
  s_cmp_ge_u32 s2, 256
  s_cbranch_scc1 M_exit
  s_lshr_b32 s77, s2, 3
  s_and_b32 s76, s2, 7
  s_cbranch_scc0 M_team
  s_load_dwordx4 s[72:75], s[0:1], 120
  v_lshrrev_b32 v3, 6, v0
  v_and_b32 v1, 63, v0
  v_readfirstlane_b32 s16, v3
  v_lshlrev_b32 v2, 4, v1
  s_waitcnt lgkmcnt(0)
  s_mov_b64 s[4:5], s[74:75]
  s_mov_b64 s[74:75], s[72:73]
  s_mov_b64 s[72:73], s[4:5]
  s_and_b32 s5, s5, 0xffff
  s_mov_b32 s6, 268435456
  s_mov_b32 s7, 0x20000
  s_sub_u32 s76, s76, 2
  s_cmp_lt_u32 s76, 5
  s_cbranch_scc1 M_gen
  v_mov_b32 v4, 0
  s_cmp_lg_u32 s16, 0
  s_cbranch_scc1 M_claimed
  s_getreg_b32 s78, hwreg(HW_REG_XCC_ID, 0, 1)
  s_bfe_u32 s79, s2, 0x10001
  s_xor_b32 s78, s78, s79
  s_lshl_b32 s79, s77, 1
  s_add_u32 s79, s79, s78
  s_lshl_b64 s[36:37], 1, s79
  s_atomic_or_x2 s[36:37], s[74:75], 64 glc
  s_waitcnt lgkmcnt(0)
  s_lshr_b64 s[36:37], s[36:37], s79
  s_xor_b32 s78, s78, s36
  s_and_b32 s78, s78, 1
  v_mov_b32 v5, s78
  ds_write_b32 v4, v5
  s_waitcnt lgkmcnt(0)
M_claimed:
  s_barrier
  ds_read_b32 v5, v4
  s_waitcnt lgkmcnt(0)
  v_readfirstlane_b32 s78, v5
  s_barrier
  s_mov_b32 s76, 5
  s_mov_b32 s64, s77
  s_mov_b32 s65, 6
  s_cmp_lg_u32 s78, 0
  s_cbranch_scc1 M_role
M_gen:
  s_lshl_b32 s66, s76, 5
  s_add_u32 s66, s66, s77
  s_mul_i32 s64, s66, 10923
  s_lshr_b32 s64, s64, 16
  s_mul_i32 s65, s64, 6
  s_sub_u32 s65, s66, s65
M_role:
  s_mul_i32 s67, s64, 7
  s_add_u32 s66, s67, s65
  s_lshl_b32 s31, s66, 7
  s_add_u32 s31, s31, 148897792
  s_lshl_b32 s67, s67, 7
  s_add_u32 s67, s67, 148897792
  s_getpc_b64 s[76:77]
M_pc:
  s_add_u32 s76, s76, M_table-M_pc
  s_addc_u32 s77, s77, 0
  s_lshl_b32 s26, s65, 6
  s_load_dwordx16 s[48:63], s[76:77], s26
  s_waitcnt lgkmcnt(0)
  s_mov_b32 s23, s51
  s_cmp_lg_u32 s48, 1
  s_cbranch_scc1 M_nobpf
  s_load_dwordx8 s[36:43], s[0:1], 64
  s_mul_i32 s76, s64, 3
  s_add_u32 s76, s76, s57
  v_lshlrev_b32 v4, 7, v0
  s_mov_b32 s10, 4194304
  s_mov_b32 s11, 0x20000
  s_waitcnt lgkmcnt(0)
  s_mov_b32 s8, s42
  s_and_b32 s9, s43, 0xffff
  s_mul_i32 s77, s76, 43776
  s_add_u32 s77, s77, 0
  v_min_u32 v5, 32640, v4
  v_add_u32 v5, s77, v5
  s_add_u32 s77, s77, 32768
  buffer_load_dword v6, v5, s[8:11], 0 offen
  v_min_u32 v5, 10880, v4
  v_add_u32 v5, s77, v5
  s_add_u32 s77, s77, 32768
  buffer_load_dword v6, v5, s[8:11], 0 offen
  s_mov_b32 s8, s38
  s_and_b32 s9, s39, 0xffff
  s_mul_i32 s77, s76, 21888
  s_add_u32 s77, s77, 2097152
  v_min_u32 v5, 21760, v4
  v_add_u32 v5, s77, v5
  s_add_u32 s77, s77, 32768
  buffer_load_dword v6, v5, s[8:11], 0 offen
  s_mov_b32 s8, s40
  s_and_b32 s9, s41, 0xffff
  s_mul_i32 s77, s76, 21888
  s_add_u32 s77, s77, 2097152
  v_min_u32 v5, 21760, v4
  v_add_u32 v5, s77, v5
  s_add_u32 s77, s77, 32768
  buffer_load_dword v6, v5, s[8:11], 0 offen
  s_mov_b32 s8, s36
  s_and_b32 s9, s37, 0xffff
  s_mul_i32 s77, s76, 21888
  s_add_u32 s77, s77, 2097152
  v_min_u32 v5, 21760, v4
  v_add_u32 v5, s77, v5
  s_add_u32 s77, s77, 32768
  buffer_load_dword v6, v5, s[8:11], 0 offen
  s_waitcnt vmcnt(0)
M_nobpf:
  s_lshr_b32 s29, s16, 1
  s_cmp_eq_u32 s29, 0
  s_cselect_b32 s26, 2, 8
  s_cselect_b32 s27, 3, 4
  s_cselect_b32 s28, 9, 10
  s_cmp_eq_u32 s48, 1
  s_cselect_b32 s26, s27, s26
  s_cmp_eq_u32 s48, 2
  s_cselect_b32 s26, s28, s26
  s_lshl_b32 s26, s26, 3
  s_load_dwordx2 s[8:9], s[0:1], s26
  s_cmp_eq_u32 s48, 1
  s_cselect_b32 s26, 8, 0
  s_load_dwordx2 s[12:13], s[0:1], s26
  s_cmp_eq_u32 s29, 0
  s_cselect_b32 s21, 0, 3
  s_cselect_b32 s27, 1, 2
  s_cselect_b32 s28, 4, 5
  s_cmp_eq_u32 s48, 1
  s_cselect_b32 s21, s27, s21
  s_cmp_eq_u32 s48, 2
  s_cselect_b32 s21, s28, s21
  s_lshl_b32 s21, s21, 5
  s_add_u32 s21, s21, s64
  s_lshl_b32 s21, s21, 6
  s_add_u32 s21, s21, s49
  s_and_b32 s27, s16, 1
  s_lshl_b32 s21, s21, 1
  s_add_u32 s21, s21, s27
  s_lshl_b32 s21, s21, 12
  s_lshl_b32 s22, s50, 13
  s_lshl_b32 s19, s49, 15
  s_lshl_b32 s20, s50, 15
  s_lshl_b32 s17, s64, 1
  s_add_u32 s17, s17, s27
  s_lshl_b32 s17, s17, 7
  s_mov_b32 s18, 8192
  s_cmp_eq_u32 s48, 0
  s_cselect_b32 s24, 0x3e0293ee, 1.0
  s_waitcnt lgkmcnt(0)
  s_and_b32 s9, s9, 0xffff
  s_mov_b32 s10, 4194304
  s_mov_b32 s11, 0x20000
  s_and_b32 s13, s13, 0xffff
  s_mov_b32 s14, 2097152
  s_mov_b32 s15, 0x20000
  v_and_b32 v144, 31, v1
  v_lshrrev_b32 v145, 5, v1
  v_and_b32 v146, 15, v1
  v_or_b32 v147, 0, v145
  v_xor_b32 v147, v147, v146
  v_lshlrev_b32 v147, 4, v147
  v_lshl_add_u32 v8, v144, 8, v147
  v_or_b32 v147, 2, v145
  v_xor_b32 v147, v147, v146
  v_lshlrev_b32 v147, 4, v147
  v_lshl_add_u32 v9, v144, 8, v147
  v_or_b32 v147, 4, v145
  v_xor_b32 v147, v147, v146
  v_lshlrev_b32 v147, 4, v147
  v_lshl_add_u32 v10, v144, 8, v147
  v_or_b32 v147, 6, v145
  v_xor_b32 v147, v147, v146
  v_lshlrev_b32 v147, 4, v147
  v_lshl_add_u32 v11, v144, 8, v147
  v_or_b32 v147, 8, v145
  v_xor_b32 v147, v147, v146
  v_lshlrev_b32 v147, 4, v147
  v_lshl_add_u32 v12, v144, 8, v147
  v_or_b32 v147, 10, v145
  v_xor_b32 v147, v147, v146
  v_lshlrev_b32 v147, 4, v147
  v_lshl_add_u32 v13, v144, 8, v147
  v_or_b32 v147, 12, v145
  v_xor_b32 v147, v147, v146
  v_lshlrev_b32 v147, 4, v147
  v_lshl_add_u32 v14, v144, 8, v147
  v_or_b32 v147, 14, v145
  v_xor_b32 v147, v147, v146
  v_lshlrev_b32 v147, 4, v147
  v_lshl_add_u32 v15, v144, 8, v147
  v_lshrrev_b32 v144, 4, v1
  s_lshl_b32 s26, s16, 8
  v_add_u32 v145, 0, v144
  v_and_b32 v147, 15, v145
  v_xor_b32 v147, v147, v146
  v_lshlrev_b32 v147, 4, v147
  v_lshl_add_u32 v147, v145, 10, v147
  v_add_u32 v16, s26, v147
  v_add_u32 v145, 4, v144
  v_and_b32 v147, 15, v145
  v_xor_b32 v147, v147, v146
  v_lshlrev_b32 v147, 4, v147
  v_lshl_add_u32 v147, v145, 10, v147
  v_add_u32 v17, s26, v147
  v_add_u32 v145, 8, v144
  v_and_b32 v147, 15, v145
  v_xor_b32 v147, v147, v146
  v_lshlrev_b32 v147, 4, v147
  v_lshl_add_u32 v147, v145, 10, v147
  v_add_u32 v18, s26, v147
  v_add_u32 v145, 12, v144
  v_and_b32 v147, 15, v145
  v_xor_b32 v147, v147, v146
  v_lshlrev_b32 v147, 4, v147
  v_lshl_add_u32 v147, v145, 10, v147
  v_add_u32 v19, s26, v147
  v_add_u32 v145, 16, v144
  v_and_b32 v147, 15, v145
  v_xor_b32 v147, v147, v146
  v_lshlrev_b32 v147, 4, v147
  v_lshl_add_u32 v147, v145, 10, v147
  v_add_u32 v20, s26, v147
  v_add_u32 v145, 20, v144
  v_and_b32 v147, 15, v145
  v_xor_b32 v147, v147, v146
  v_lshlrev_b32 v147, 4, v147
  v_lshl_add_u32 v147, v145, 10, v147
  v_add_u32 v21, s26, v147
  v_add_u32 v145, 24, v144
  v_and_b32 v147, 15, v145
  v_xor_b32 v147, v147, v146
  v_lshlrev_b32 v147, 4, v147
  v_lshl_add_u32 v147, v145, 10, v147
  v_add_u32 v22, s26, v147
  v_add_u32 v145, 28, v144
  v_and_b32 v147, 15, v145
  v_xor_b32 v147, v147, v146
  v_lshlrev_b32 v147, 4, v147
  v_lshl_add_u32 v147, v145, 10, v147
  v_add_u32 v23, s26, v147
  v_lshrrev_b32 v144, 3, v1
  v_mul_lo_u32 v144, v144, s18
  v_and_b32 v145, 7, v1
  v_lshl_add_u32 v144, v145, 4, v144
  s_lshl_b32 s28, s16, 15
  s_add_u32 s28, s28, 32768
  s_lshl_b32 s29, s18, 3
  s_add_u32 m0, s28, 0
  s_nop 0
  buffer_load_dwordx4 v144, s[8:11], s17 offen lds
  s_add_u32 s17, s17, s29
  s_add_u32 m0, s28, 1024
  s_nop 0
  buffer_load_dwordx4 v144, s[8:11], s17 offen lds
  s_add_u32 s17, s17, s29
  s_add_u32 m0, s28, 2048
  s_nop 0
  buffer_load_dwordx4 v144, s[8:11], s17 offen lds
  s_add_u32 s17, s17, s29
  s_add_u32 m0, s28, 3072
  s_nop 0
  buffer_load_dwordx4 v144, s[8:11], s17 offen lds
  s_add_u32 s17, s17, s29
  s_add_u32 m0, s28, 4096
  s_nop 0
  buffer_load_dwordx4 v144, s[8:11], s17 offen lds
  s_add_u32 s17, s17, s29
  s_add_u32 m0, s28, 5120
  s_nop 0
  buffer_load_dwordx4 v144, s[8:11], s17 offen lds
  s_add_u32 s17, s17, s29
  s_add_u32 m0, s28, 6144
  s_nop 0
  buffer_load_dwordx4 v144, s[8:11], s17 offen lds
  s_add_u32 s17, s17, s29
  s_add_u32 m0, s28, 7168
  s_nop 0
  buffer_load_dwordx4 v144, s[8:11], s17 offen lds
  s_add_u32 s17, s17, s29
  s_add_u32 m0, s28, 8192
  s_nop 0
  buffer_load_dwordx4 v144, s[8:11], s17 offen lds
  s_add_u32 s17, s17, s29
  s_add_u32 m0, s28, 9216
  s_nop 0
  buffer_load_dwordx4 v144, s[8:11], s17 offen lds
  s_add_u32 s17, s17, s29
  s_add_u32 m0, s28, 10240
  s_nop 0
  buffer_load_dwordx4 v144, s[8:11], s17 offen lds
  s_add_u32 s17, s17, s29
  s_add_u32 m0, s28, 11264
  s_nop 0
  buffer_load_dwordx4 v144, s[8:11], s17 offen lds
  s_add_u32 s17, s17, s29
  s_add_u32 m0, s28, 12288
  s_nop 0
  buffer_load_dwordx4 v144, s[8:11], s17 offen lds
  s_add_u32 s17, s17, s29
  s_add_u32 m0, s28, 13312
  s_nop 0
  buffer_load_dwordx4 v144, s[8:11], s17 offen lds
  s_add_u32 s17, s17, s29
  s_add_u32 m0, s28, 14336
  s_nop 0
  buffer_load_dwordx4 v144, s[8:11], s17 offen lds
  s_add_u32 s17, s17, s29
  s_add_u32 m0, s28, 15360
  s_nop 0
  buffer_load_dwordx4 v144, s[8:11], s17 offen lds
  s_add_u32 s17, s17, s29
  s_add_u32 m0, s28, 16384
  s_nop 0
  buffer_load_dwordx4 v144, s[8:11], s17 offen lds
  s_add_u32 s17, s17, s29
  s_add_u32 m0, s28, 17408
  s_nop 0
  buffer_load_dwordx4 v144, s[8:11], s17 offen lds
  s_add_u32 s17, s17, s29
  s_add_u32 m0, s28, 18432
  s_nop 0
  buffer_load_dwordx4 v144, s[8:11], s17 offen lds
  s_add_u32 s17, s17, s29
  s_add_u32 m0, s28, 19456
  s_nop 0
  buffer_load_dwordx4 v144, s[8:11], s17 offen lds
  s_add_u32 s17, s17, s29
  s_add_u32 m0, s28, 20480
  s_nop 0
  buffer_load_dwordx4 v144, s[8:11], s17 offen lds
  s_add_u32 s17, s17, s29
  s_add_u32 m0, s28, 21504
  s_nop 0
  buffer_load_dwordx4 v144, s[8:11], s17 offen lds
  s_add_u32 s17, s17, s29
  s_add_u32 m0, s28, 22528
  s_nop 0
  buffer_load_dwordx4 v144, s[8:11], s17 offen lds
  s_add_u32 s17, s17, s29
  s_add_u32 m0, s28, 23552
  s_nop 0
  buffer_load_dwordx4 v144, s[8:11], s17 offen lds
  s_add_u32 s17, s17, s29
  s_add_u32 m0, s28, 24576
  s_nop 0
  buffer_load_dwordx4 v144, s[8:11], s17 offen lds
  s_add_u32 s17, s17, s29
  s_add_u32 m0, s28, 25600
  s_nop 0
  buffer_load_dwordx4 v144, s[8:11], s17 offen lds
  s_add_u32 s17, s17, s29
  s_add_u32 m0, s28, 26624
  s_nop 0
  buffer_load_dwordx4 v144, s[8:11], s17 offen lds
  s_add_u32 s17, s17, s29
  s_add_u32 m0, s28, 27648
  s_nop 0
  buffer_load_dwordx4 v144, s[8:11], s17 offen lds
  s_add_u32 s17, s17, s29
  s_add_u32 m0, s28, 28672
  s_nop 0
  buffer_load_dwordx4 v144, s[8:11], s17 offen lds
  s_add_u32 s17, s17, s29
  s_add_u32 m0, s28, 29696
  s_nop 0
  buffer_load_dwordx4 v144, s[8:11], s17 offen lds
  s_add_u32 s17, s17, s29
  s_add_u32 m0, s28, 30720
  s_nop 0
  buffer_load_dwordx4 v144, s[8:11], s17 offen lds
  s_add_u32 s17, s17, s29
  s_add_u32 m0, s28, 31744
  s_nop 0
  buffer_load_dwordx4 v144, s[8:11], s17 offen lds
  s_add_u32 s17, s17, s29
  s_lshl_b32 s25, s16, 13
  s_add_u32 m0, s25, 0
  s_nop 0
  buffer_load_dwordx4 v16, s[12:15], s19 offen lds
  s_add_u32 m0, s25, 1024
  s_nop 0
  buffer_load_dwordx4 v17, s[12:15], s19 offen lds
  s_add_u32 m0, s25, 2048
  s_nop 0
  buffer_load_dwordx4 v18, s[12:15], s19 offen lds
  s_add_u32 m0, s25, 3072
  s_nop 0
  buffer_load_dwordx4 v19, s[12:15], s19 offen lds
  s_add_u32 m0, s25, 4096
  s_nop 0
  buffer_load_dwordx4 v20, s[12:15], s19 offen lds
  s_add_u32 m0, s25, 5120
  s_nop 0
  buffer_load_dwordx4 v21, s[12:15], s19 offen lds
  s_add_u32 m0, s25, 6144
  s_nop 0
  buffer_load_dwordx4 v22, s[12:15], s19 offen lds
  s_add_u32 m0, s25, 7168
  s_nop 0
  buffer_load_dwordx4 v23, s[12:15], s19 offen lds
  s_cmp_gt_u32 s23, 1
  s_cselect_b32 s26, s20, 0
  s_add_u32 s19, s19, s26
  s_add_u32 s25, s25, 32768
  s_and_b32 s25, s25, 0x1ffff
  s_cmp_lg_u32 s16, 3
  s_cbranch_scc1 M_noinit
  s_mov_b32 s79, 0
  s_atomic_swap s79, s[72:73], s31 glc
  s_waitcnt lgkmcnt(0)
  s_mov_b32 s79, 1
  s_atomic_add s79, s[74:75], 128
M_noinit:
  s_cmp_lg_u32 s65, 3
  s_cbranch_scc1 M_noarm
  v_lshlrev_b32 v4, 4, v0
  v_mov_b64 v[60:61], -1
  v_mov_b64 v[62:63], -1
  s_mul_i32 s76, s64, 4096
  s_add_u32 s77, s76, 142868480
  buffer_store_dwordx4 v[60:63], v4, s[4:7], s77 offen sc1
  s_add_u32 s77, s76, 142999552
  buffer_store_dwordx4 v[60:63], v4, s[4:7], s77 offen sc1
  s_add_u32 s77, s76, 143130624
  buffer_store_dwordx4 v[60:63], v4, s[4:7], s77 offen sc1
  s_add_u32 s77, s76, 143261696
  buffer_store_dwordx4 v[60:63], v4, s[4:7], s77 offen sc1
  s_add_u32 s77, s76, 143392768
  buffer_store_dwordx4 v[60:63], v4, s[4:7], s77 offen sc1
  s_add_u32 s77, s76, 143523840
  buffer_store_dwordx4 v[60:63], v4, s[4:7], s77 offen sc1
M_noarm:
  s_mul_i32 s76, s64, 3
  s_add_u32 s76, s76, s57
  s_mul_i32 s76, s76, 24576
  v_lshlrev_b32 v4, 7, v0
  v_add_u32 v4, s76, v4
  buffer_load_dword v5, v4, s[12:15], 0 offen
  v_bfe_u32 v148, v1, 2, 2
  v_lshrrev_b32 v149, 5, v1
  v_lshl_add_u32 v148, v149, 3, v148
  v_lshlrev_b32 v148, 7, v148
  v_bfe_u32 v149, v1, 4, 1
  v_lshl_add_u32 v148, v149, 5, v148
  v_and_b32 v149, 3, v1
  v_lshl_add_u32 v148, v149, 3, v148
  v_add_u32 v146, s28, v148
  v_add_u32 v147, 512, v146
  s_waitcnt vmcnt(37)
  ds_read_b64_tr_b16 a[0:1], v146 offset:0
  ds_read_b64_tr_b16 a[2:3], v147 offset:0
  ds_read_b64_tr_b16 a[4:5], v146 offset:64
  ds_read_b64_tr_b16 a[6:7], v147 offset:64
  ds_read_b64_tr_b16 a[8:9], v146 offset:2048
  ds_read_b64_tr_b16 a[10:11], v147 offset:2048
  ds_read_b64_tr_b16 a[12:13], v146 offset:2112
  ds_read_b64_tr_b16 a[14:15], v147 offset:2112
  s_waitcnt lgkmcnt(0)
  s_add_u32 m0, s28, 0
  s_nop 0
  buffer_load_dwordx4 v144, s[8:11], s17 offen lds
  s_add_u32 s17, s17, s29
  s_add_u32 m0, s28, 1024
  s_nop 0
  buffer_load_dwordx4 v144, s[8:11], s17 offen lds
  s_add_u32 s17, s17, s29
  s_add_u32 m0, s28, 2048
  s_nop 0
  buffer_load_dwordx4 v144, s[8:11], s17 offen lds
  s_add_u32 s17, s17, s29
  s_add_u32 m0, s28, 3072
  s_nop 0
  buffer_load_dwordx4 v144, s[8:11], s17 offen lds
  s_add_u32 s17, s17, s29
  s_waitcnt vmcnt(37)
  ds_read_b64_tr_b16 a[16:17], v146 offset:4096
  ds_read_b64_tr_b16 a[18:19], v147 offset:4096
  ds_read_b64_tr_b16 a[20:21], v146 offset:4160
  ds_read_b64_tr_b16 a[22:23], v147 offset:4160
  ds_read_b64_tr_b16 a[24:25], v146 offset:6144
  ds_read_b64_tr_b16 a[26:27], v147 offset:6144
  ds_read_b64_tr_b16 a[28:29], v146 offset:6208
  ds_read_b64_tr_b16 a[30:31], v147 offset:6208
  s_waitcnt lgkmcnt(0)
  s_add_u32 m0, s28, 4096
  s_nop 0
  buffer_load_dwordx4 v144, s[8:11], s17 offen lds
  s_add_u32 s17, s17, s29
  s_add_u32 m0, s28, 5120
  s_nop 0
  buffer_load_dwordx4 v144, s[8:11], s17 offen lds
  s_add_u32 s17, s17, s29
  s_add_u32 m0, s28, 6144
  s_nop 0
  buffer_load_dwordx4 v144, s[8:11], s17 offen lds
  s_add_u32 s17, s17, s29
  s_add_u32 m0, s28, 7168
  s_nop 0
  buffer_load_dwordx4 v144, s[8:11], s17 offen lds
  s_add_u32 s17, s17, s29
  s_waitcnt vmcnt(37)
  ds_read_b64_tr_b16 a[32:33], v146 offset:8192
  ds_read_b64_tr_b16 a[34:35], v147 offset:8192
  ds_read_b64_tr_b16 a[36:37], v146 offset:8256
  ds_read_b64_tr_b16 a[38:39], v147 offset:8256
  ds_read_b64_tr_b16 a[40:41], v146 offset:10240
  ds_read_b64_tr_b16 a[42:43], v147 offset:10240
  ds_read_b64_tr_b16 a[44:45], v146 offset:10304
  ds_read_b64_tr_b16 a[46:47], v147 offset:10304
  s_waitcnt lgkmcnt(0)
  s_add_u32 m0, s28, 8192
  s_nop 0
  buffer_load_dwordx4 v144, s[8:11], s17 offen lds
  s_add_u32 s17, s17, s29
  s_add_u32 m0, s28, 9216
  s_nop 0
  buffer_load_dwordx4 v144, s[8:11], s17 offen lds
  s_add_u32 s17, s17, s29
  s_add_u32 m0, s28, 10240
  s_nop 0
  buffer_load_dwordx4 v144, s[8:11], s17 offen lds
  s_add_u32 s17, s17, s29
  s_add_u32 m0, s28, 11264
  s_nop 0
  buffer_load_dwordx4 v144, s[8:11], s17 offen lds
  s_add_u32 s17, s17, s29
  s_waitcnt vmcnt(37)
  ds_read_b64_tr_b16 a[48:49], v146 offset:12288
  ds_read_b64_tr_b16 a[50:51], v147 offset:12288
  ds_read_b64_tr_b16 a[52:53], v146 offset:12352
  ds_read_b64_tr_b16 a[54:55], v147 offset:12352
  ds_read_b64_tr_b16 a[56:57], v146 offset:14336
  ds_read_b64_tr_b16 a[58:59], v147 offset:14336
  ds_read_b64_tr_b16 a[60:61], v146 offset:14400
  ds_read_b64_tr_b16 a[62:63], v147 offset:14400
  s_waitcnt lgkmcnt(0)
  s_add_u32 m0, s28, 12288
  s_nop 0
  buffer_load_dwordx4 v144, s[8:11], s17 offen lds
  s_add_u32 s17, s17, s29
  s_add_u32 m0, s28, 13312
  s_nop 0
  buffer_load_dwordx4 v144, s[8:11], s17 offen lds
  s_add_u32 s17, s17, s29
  s_add_u32 m0, s28, 14336
  s_nop 0
  buffer_load_dwordx4 v144, s[8:11], s17 offen lds
  s_add_u32 s17, s17, s29
  s_add_u32 m0, s28, 15360
  s_nop 0
  buffer_load_dwordx4 v144, s[8:11], s17 offen lds
  s_add_u32 s17, s17, s29
  s_waitcnt vmcnt(37)
  ds_read_b64_tr_b16 a[64:65], v146 offset:16384
  ds_read_b64_tr_b16 a[66:67], v147 offset:16384
  ds_read_b64_tr_b16 a[68:69], v146 offset:16448
  ds_read_b64_tr_b16 a[70:71], v147 offset:16448
  ds_read_b64_tr_b16 a[72:73], v146 offset:18432
  ds_read_b64_tr_b16 a[74:75], v147 offset:18432
  ds_read_b64_tr_b16 a[76:77], v146 offset:18496
  ds_read_b64_tr_b16 a[78:79], v147 offset:18496
  s_waitcnt lgkmcnt(0)
  s_add_u32 m0, s28, 16384
  s_nop 0
  buffer_load_dwordx4 v144, s[8:11], s17 offen lds
  s_add_u32 s17, s17, s29
  s_add_u32 m0, s28, 17408
  s_nop 0
  buffer_load_dwordx4 v144, s[8:11], s17 offen lds
  s_add_u32 s17, s17, s29
  s_add_u32 m0, s28, 18432
  s_nop 0
  buffer_load_dwordx4 v144, s[8:11], s17 offen lds
  s_add_u32 s17, s17, s29
  s_add_u32 m0, s28, 19456
  s_nop 0
  buffer_load_dwordx4 v144, s[8:11], s17 offen lds
  s_add_u32 s17, s17, s29
  s_waitcnt vmcnt(37)
  ds_read_b64_tr_b16 a[80:81], v146 offset:20480
  ds_read_b64_tr_b16 a[82:83], v147 offset:20480
  ds_read_b64_tr_b16 a[84:85], v146 offset:20544
  ds_read_b64_tr_b16 a[86:87], v147 offset:20544
  ds_read_b64_tr_b16 a[88:89], v146 offset:22528
  ds_read_b64_tr_b16 a[90:91], v147 offset:22528
  ds_read_b64_tr_b16 a[92:93], v146 offset:22592
  ds_read_b64_tr_b16 a[94:95], v147 offset:22592
  s_waitcnt lgkmcnt(0)
  s_add_u32 m0, s28, 20480
  s_nop 0
  buffer_load_dwordx4 v144, s[8:11], s17 offen lds
  s_add_u32 s17, s17, s29
  s_add_u32 m0, s28, 21504
  s_nop 0
  buffer_load_dwordx4 v144, s[8:11], s17 offen lds
  s_add_u32 s17, s17, s29
  s_add_u32 m0, s28, 22528
  s_nop 0
  buffer_load_dwordx4 v144, s[8:11], s17 offen lds
  s_add_u32 s17, s17, s29
  s_add_u32 m0, s28, 23552
  s_nop 0
  buffer_load_dwordx4 v144, s[8:11], s17 offen lds
  s_add_u32 s17, s17, s29
  s_waitcnt vmcnt(37)
  ds_read_b64_tr_b16 a[96:97], v146 offset:24576
  ds_read_b64_tr_b16 a[98:99], v147 offset:24576
  ds_read_b64_tr_b16 a[100:101], v146 offset:24640
  ds_read_b64_tr_b16 a[102:103], v147 offset:24640
  ds_read_b64_tr_b16 a[104:105], v146 offset:26624
  ds_read_b64_tr_b16 a[106:107], v147 offset:26624
  ds_read_b64_tr_b16 a[108:109], v146 offset:26688
  ds_read_b64_tr_b16 a[110:111], v147 offset:26688
  s_waitcnt lgkmcnt(0)
  s_add_u32 m0, s28, 24576
  s_nop 0
  buffer_load_dwordx4 v144, s[8:11], s17 offen lds
  s_add_u32 s17, s17, s29
  s_add_u32 m0, s28, 25600
  s_nop 0
  buffer_load_dwordx4 v144, s[8:11], s17 offen lds
  s_add_u32 s17, s17, s29
  s_add_u32 m0, s28, 26624
  s_nop 0
  buffer_load_dwordx4 v144, s[8:11], s17 offen lds
  s_add_u32 s17, s17, s29
  s_add_u32 m0, s28, 27648
  s_nop 0
  buffer_load_dwordx4 v144, s[8:11], s17 offen lds
  s_add_u32 s17, s17, s29
  s_waitcnt vmcnt(37)
  ds_read_b64_tr_b16 a[112:113], v146 offset:28672
  ds_read_b64_tr_b16 a[114:115], v147 offset:28672
  ds_read_b64_tr_b16 a[116:117], v146 offset:28736
  ds_read_b64_tr_b16 a[118:119], v147 offset:28736
  ds_read_b64_tr_b16 a[120:121], v146 offset:30720
  ds_read_b64_tr_b16 a[122:123], v147 offset:30720
  ds_read_b64_tr_b16 a[124:125], v146 offset:30784
  ds_read_b64_tr_b16 a[126:127], v147 offset:30784
  s_waitcnt lgkmcnt(0)
  s_add_u32 m0, s28, 28672
  s_nop 0
  buffer_load_dwordx4 v144, s[8:11], s17 offen lds
  s_add_u32 s17, s17, s29
  s_add_u32 m0, s28, 29696
  s_nop 0
  buffer_load_dwordx4 v144, s[8:11], s17 offen lds
  s_add_u32 s17, s17, s29
  s_add_u32 m0, s28, 30720
  s_nop 0
  buffer_load_dwordx4 v144, s[8:11], s17 offen lds
  s_add_u32 s17, s17, s29
  s_add_u32 m0, s28, 31744
  s_nop 0
  buffer_load_dwordx4 v144, s[8:11], s17 offen lds
  s_add_u32 s17, s17, s29
  s_waitcnt vmcnt(28)
  ds_read_b64_tr_b16 a[128:129], v146 offset:0
  ds_read_b64_tr_b16 a[130:131], v147 offset:0
  ds_read_b64_tr_b16 a[132:133], v146 offset:64
  ds_read_b64_tr_b16 a[134:135], v147 offset:64
  ds_read_b64_tr_b16 a[136:137], v146 offset:2048
  ds_read_b64_tr_b16 a[138:139], v147 offset:2048
  ds_read_b64_tr_b16 a[140:141], v146 offset:2112
  ds_read_b64_tr_b16 a[142:143], v147 offset:2112
  s_waitcnt lgkmcnt(0)
  s_waitcnt vmcnt(24)
  ds_read_b64_tr_b16 a[144:145], v146 offset:4096
  ds_read_b64_tr_b16 a[146:147], v147 offset:4096
  ds_read_b64_tr_b16 a[148:149], v146 offset:4160
  ds_read_b64_tr_b16 a[150:151], v147 offset:4160
  ds_read_b64_tr_b16 a[152:153], v146 offset:6144
  ds_read_b64_tr_b16 a[154:155], v147 offset:6144
  ds_read_b64_tr_b16 a[156:157], v146 offset:6208
  ds_read_b64_tr_b16 a[158:159], v147 offset:6208
  s_waitcnt lgkmcnt(0)
  s_waitcnt vmcnt(20)
  ds_read_b64_tr_b16 a[160:161], v146 offset:8192
  ds_read_b64_tr_b16 a[162:163], v147 offset:8192
  ds_read_b64_tr_b16 a[164:165], v146 offset:8256
  ds_read_b64_tr_b16 a[166:167], v147 offset:8256
  ds_read_b64_tr_b16 a[168:169], v146 offset:10240
  ds_read_b64_tr_b16 a[170:171], v147 offset:10240
  ds_read_b64_tr_b16 a[172:173], v146 offset:10304
  ds_read_b64_tr_b16 a[174:175], v147 offset:10304
  s_waitcnt lgkmcnt(0)
  s_waitcnt vmcnt(16)
  ds_read_b64_tr_b16 a[176:177], v146 offset:12288
  ds_read_b64_tr_b16 a[178:179], v147 offset:12288
  ds_read_b64_tr_b16 a[180:181], v146 offset:12352
  ds_read_b64_tr_b16 a[182:183], v147 offset:12352
  ds_read_b64_tr_b16 a[184:185], v146 offset:14336
  ds_read_b64_tr_b16 a[186:187], v147 offset:14336
  ds_read_b64_tr_b16 a[188:189], v146 offset:14400
  ds_read_b64_tr_b16 a[190:191], v147 offset:14400
  s_waitcnt lgkmcnt(0)
  s_waitcnt vmcnt(12)
  ds_read_b64_tr_b16 a[192:193], v146 offset:16384
  ds_read_b64_tr_b16 a[194:195], v147 offset:16384
  ds_read_b64_tr_b16 a[196:197], v146 offset:16448
  ds_read_b64_tr_b16 a[198:199], v147 offset:16448
  ds_read_b64_tr_b16 a[200:201], v146 offset:18432
  ds_read_b64_tr_b16 a[202:203], v147 offset:18432
  ds_read_b64_tr_b16 a[204:205], v146 offset:18496
  ds_read_b64_tr_b16 a[206:207], v147 offset:18496
  s_waitcnt lgkmcnt(0)
  s_waitcnt vmcnt(8)
  ds_read_b64_tr_b16 a[208:209], v146 offset:20480
  ds_read_b64_tr_b16 a[210:211], v147 offset:20480
  ds_read_b64_tr_b16 a[212:213], v146 offset:20544
  ds_read_b64_tr_b16 a[214:215], v147 offset:20544
  ds_read_b64_tr_b16 a[216:217], v146 offset:22528
  ds_read_b64_tr_b16 a[218:219], v147 offset:22528
  ds_read_b64_tr_b16 a[220:221], v146 offset:22592
  ds_read_b64_tr_b16 a[222:223], v147 offset:22592
  s_waitcnt lgkmcnt(0)
  s_waitcnt vmcnt(4)
  ds_read_b64_tr_b16 a[224:225], v146 offset:24576
  ds_read_b64_tr_b16 a[226:227], v147 offset:24576
  ds_read_b64_tr_b16 a[228:229], v146 offset:24640
  ds_read_b64_tr_b16 a[230:231], v147 offset:24640
  ds_read_b64_tr_b16 a[232:233], v146 offset:26624
  ds_read_b64_tr_b16 a[234:235], v147 offset:26624
  ds_read_b64_tr_b16 a[236:237], v146 offset:26688
  ds_read_b64_tr_b16 a[238:239], v147 offset:26688
  s_waitcnt lgkmcnt(0)
  s_waitcnt vmcnt(0)
  ds_read_b64_tr_b16 a[240:241], v146 offset:28672
  ds_read_b64_tr_b16 a[242:243], v147 offset:28672
  ds_read_b64_tr_b16 a[244:245], v146 offset:28736
  ds_read_b64_tr_b16 a[246:247], v147 offset:28736
  ds_read_b64_tr_b16 a[248:249], v146 offset:30720
  ds_read_b64_tr_b16 a[250:251], v147 offset:30720
  ds_read_b64_tr_b16 a[252:253], v146 offset:30784
  ds_read_b64_tr_b16 a[254:255], v147 offset:30784
  s_waitcnt lgkmcnt(0)
  s_barrier
  s_add_u32 m0, s25, 0
  s_nop 0
  buffer_load_dwordx4 v16, s[12:15], s19 offen lds
  s_add_u32 m0, s25, 1024
  s_nop 0
  buffer_load_dwordx4 v17, s[12:15], s19 offen lds
  s_add_u32 m0, s25, 2048
  s_nop 0
  buffer_load_dwordx4 v18, s[12:15], s19 offen lds
  s_add_u32 m0, s25, 3072
  s_nop 0
  buffer_load_dwordx4 v19, s[12:15], s19 offen lds
  s_add_u32 m0, s25, 4096
  s_nop 0
  buffer_load_dwordx4 v20, s[12:15], s19 offen lds
  s_add_u32 m0, s25, 5120
  s_nop 0
  buffer_load_dwordx4 v21, s[12:15], s19 offen lds
  s_add_u32 m0, s25, 6144
  s_nop 0
  buffer_load_dwordx4 v22, s[12:15], s19 offen lds
  s_add_u32 m0, s25, 7168
  s_nop 0
  buffer_load_dwordx4 v23, s[12:15], s19 offen lds
  s_cmp_gt_u32 s23, 2
  s_cselect_b32 s26, s20, 0
  s_add_u32 s19, s19, s26
  s_add_u32 s25, s25, 32768
  s_and_b32 s25, s25, 0x1ffff
  s_waitcnt vmcnt(0)
  s_barrier
  s_cmp_eq_u32 s48, 0
  s_cselect_b32 s26, 0, s16
  s_cmp_ge_u32 s26, 2
  s_cbranch_scc1 P_v_1
  s_mov_b32 s27, s21
  v_mov_b32 v7, 0x40000000
  s_mov_b32 s29, -3
  v_min_u32 v145, 1, v0
  v_lshlrev_b32 v145, 30, v145
  ds_read_b128 v[24:27], v8 offset:0
  ds_read_b128 v[28:31], v9 offset:0
  ds_read_b128 v[32:35], v10 offset:0
  ds_read_b128 v[36:39], v11 offset:0
  ds_read_b128 v[40:43], v12 offset:0
  ds_read_b128 v[44:47], v13 offset:0
.p2align 6
G_top_3:
  s_waitcnt lgkmcnt(5)
  v_mfma_f32_32x32x16_bf16 v[64:79], a[0:3], v[24:27], 0
  s_add_u32 m0, s25, 0
  ds_read_b128 v[48:51], v14 offset:0
  v_mfma_f32_32x32x16_bf16 v[80:95], a[4:7], v[24:27], 0
  s_waitcnt lgkmcnt(5)
  buffer_load_dwordx4 v16, s[12:15], s19 offen lds
  v_mfma_f32_32x32x16_bf16 v[64:79], a[8:11], v[28:31], v[64:79]
  ds_read_b128 v[52:55], v15 offset:0
  v_mul_f32 v96, s24, v96
  v_mul_f32 v97, s24, v97
  v_mfma_f32_32x32x16_bf16 v[80:95], a[12:15], v[28:31], v[80:95]
  s_waitcnt lgkmcnt(5)
  v_cvt_pk_bf16_f32 v128, v96, v97
  v_mul_f32 v98, s24, v98
  v_mfma_f32_32x32x16_bf16 v[64:79], a[16:19], v[32:35], v[64:79]
  s_add_u32 m0, s25, 1024
  ds_read_b128 v[24:27], v8 offset:8192
  v_mul_f32 v99, s24, v99
  v_cvt_pk_bf16_f32 v129, v98, v99
  v_mfma_f32_32x32x16_bf16 v[80:95], a[20:23], v[32:35], v[80:95]
  s_waitcnt lgkmcnt(5)
  buffer_load_dwordx4 v17, s[12:15], s19 offen lds
  v_mul_f32 v100, s24, v100
  v_mul_f32 v101, s24, v101
  v_mfma_f32_32x32x16_bf16 v[64:79], a[24:27], v[36:39], v[64:79]
  ds_read_b128 v[28:31], v9 offset:8192
  v_cvt_pk_bf16_f32 v130, v100, v101
  v_mul_f32 v102, s24, v102
  v_mfma_f32_32x32x16_bf16 v[80:95], a[28:31], v[36:39], v[80:95]
  s_waitcnt lgkmcnt(5)
  v_mul_f32 v103, s24, v103
  v_cvt_pk_bf16_f32 v131, v102, v103
  v_mfma_f32_32x32x16_bf16 v[64:79], a[32:35], v[40:43], v[64:79]
  s_add_u32 m0, s25, 2048
  ds_read_b128 v[32:35], v10 offset:8192
  v_mul_f32 v104, s24, v104
  v_mul_f32 v105, s24, v105
  v_mfma_f32_32x32x16_bf16 v[80:95], a[36:39], v[40:43], v[80:95]
  s_waitcnt lgkmcnt(5)
  buffer_load_dwordx4 v18, s[12:15], s19 offen lds
  v_cvt_pk_bf16_f32 v132, v104, v105
  v_mul_f32 v106, s24, v106
  v_mfma_f32_32x32x16_bf16 v[64:79], a[40:43], v[44:47], v[64:79]
  ds_read_b128 v[36:39], v11 offset:8192
  v_mul_f32 v107, s24, v107
  v_cvt_pk_bf16_f32 v133, v106, v107
  v_mfma_f32_32x32x16_bf16 v[80:95], a[44:47], v[44:47], v[80:95]
  s_waitcnt lgkmcnt(5)
  v_mul_f32 v108, s24, v108
  v_mul_f32 v109, s24, v109
  v_mfma_f32_32x32x16_bf16 v[64:79], a[48:51], v[48:51], v[64:79]
  s_add_u32 m0, s25, 3072
  ds_read_b128 v[40:43], v12 offset:8192
  v_cvt_pk_bf16_f32 v134, v108, v109
  v_mul_f32 v110, s24, v110
  v_mfma_f32_32x32x16_bf16 v[80:95], a[52:55], v[48:51], v[80:95]
  s_waitcnt lgkmcnt(5)
  buffer_load_dwordx4 v19, s[12:15], s19 offen lds
  v_mul_f32 v111, s24, v111
  v_cvt_pk_bf16_f32 v135, v110, v111
  v_mfma_f32_32x32x16_bf16 v[64:79], a[56:59], v[52:55], v[64:79]
  ds_read_b128 v[44:47], v13 offset:8192
  v_mul_f32 v112, s24, v112
  v_mul_f32 v113, s24, v113
  v_mfma_f32_32x32x16_bf16 v[80:95], a[60:63], v[52:55], v[80:95]
  s_waitcnt lgkmcnt(5)
  v_cvt_pk_bf16_f32 v136, v112, v113
  v_mul_f32 v114, s24, v114
  v_mfma_f32_32x32x16_bf16 v[64:79], a[64:67], v[24:27], v[64:79]
  s_add_u32 m0, s25, 4096
  ds_read_b128 v[48:51], v14 offset:8192
  v_mul_f32 v115, s24, v115
  v_cvt_pk_bf16_f32 v137, v114, v115
  v_mfma_f32_32x32x16_bf16 v[80:95], a[68:71], v[24:27], v[80:95]
  s_waitcnt lgkmcnt(5)
  buffer_load_dwordx4 v20, s[12:15], s19 offen lds
  v_mul_f32 v116, s24, v116
  v_mul_f32 v117, s24, v117
  v_mfma_f32_32x32x16_bf16 v[64:79], a[72:75], v[28:31], v[64:79]
  ds_read_b128 v[52:55], v15 offset:8192
  v_cvt_pk_bf16_f32 v138, v116, v117
  v_mul_f32 v118, s24, v118
  v_mfma_f32_32x32x16_bf16 v[80:95], a[76:79], v[28:31], v[80:95]
  s_waitcnt lgkmcnt(5)
  v_mul_f32 v119, s24, v119
  v_cvt_pk_bf16_f32 v139, v118, v119
  v_mfma_f32_32x32x16_bf16 v[64:79], a[80:83], v[32:35], v[64:79]
  s_add_u32 m0, s25, 5120
  ds_read_b128 v[24:27], v8 offset:16384
  v_mul_f32 v120, s24, v120
  v_mul_f32 v121, s24, v121
  v_mfma_f32_32x32x16_bf16 v[80:95], a[84:87], v[32:35], v[80:95]
  s_waitcnt lgkmcnt(5)
  buffer_load_dwordx4 v21, s[12:15], s19 offen lds
  v_cvt_pk_bf16_f32 v140, v120, v121
  v_mul_f32 v122, s24, v122
  v_mfma_f32_32x32x16_bf16 v[64:79], a[88:91], v[36:39], v[64:79]
  ds_read_b128 v[28:31], v9 offset:16384
  v_mul_f32 v123, s24, v123
  v_cvt_pk_bf16_f32 v141, v122, v123
  v_mfma_f32_32x32x16_bf16 v[80:95], a[92:95], v[36:39], v[80:95]
  s_waitcnt lgkmcnt(5)
  v_mul_f32 v124, s24, v124
  v_mul_f32 v125, s24, v125
  v_mfma_f32_32x32x16_bf16 v[64:79], a[96:99], v[40:43], v[64:79]
  s_add_u32 m0, s25, 6144
  ds_read_b128 v[32:35], v10 offset:16384
  v_cvt_pk_bf16_f32 v142, v124, v125
  v_mul_f32 v126, s24, v126
  v_mfma_f32_32x32x16_bf16 v[80:95], a[100:103], v[40:43], v[80:95]
  s_waitcnt lgkmcnt(5)
  buffer_load_dwordx4 v22, s[12:15], s19 offen lds
  v_mul_f32 v127, s24, v127
  v_cvt_pk_bf16_f32 v143, v126, v127
  v_mfma_f32_32x32x16_bf16 v[64:79], a[104:107], v[44:47], v[64:79]
  ds_read_b128 v[36:39], v11 offset:16384
  v_mfma_f32_32x32x16_bf16 v[80:95], a[108:111], v[44:47], v[80:95]
  s_waitcnt lgkmcnt(5)
  v_mfma_f32_32x32x16_bf16 v[64:79], a[112:115], v[48:51], v[64:79]
  s_add_u32 m0, s25, 7168
  ds_read_b128 v[40:43], v12 offset:16384
  v_mfma_f32_32x32x16_bf16 v[80:95], a[116:119], v[48:51], v[80:95]
  s_waitcnt lgkmcnt(5)
  buffer_load_dwordx4 v23, s[12:15], s19 offen lds
  v_mfma_f32_32x32x16_bf16 v[64:79], a[120:123], v[52:55], v[64:79]
  s_cmp_gt_u32 s23, 3
  ds_read_b128 v[44:47], v13 offset:16384
  v_mfma_f32_32x32x16_bf16 v[80:95], a[124:127], v[52:55], v[80:95]
  s_waitcnt lgkmcnt(5)
  s_cselect_b32 s26, s20, 0
  v_mfma_f32_32x32x16_bf16 v[64:79], a[128:131], v[24:27], v[64:79]
  s_add_u32 s19, s19, s26
  ds_read_b128 v[48:51], v14 offset:16384
  v_mfma_f32_32x32x16_bf16 v[80:95], a[132:135], v[24:27], v[80:95]
  s_waitcnt lgkmcnt(5)
  s_add_u32 s25, s25, 32768
  v_mfma_f32_32x32x16_bf16 v[64:79], a[136:139], v[28:31], v[64:79]
  s_and_b32 s25, s25, 0x1ffff
  ds_read_b128 v[52:55], v15 offset:16384
  v_mfma_f32_32x32x16_bf16 v[80:95], a[140:143], v[28:31], v[80:95]
  s_waitcnt lgkmcnt(5)
  buffer_store_dwordx4 v[128:131], v7, s[4:7], s21 offen offset:0 sc1
  v_mfma_f32_32x32x16_bf16 v[64:79], a[144:147], v[32:35], v[64:79]
  ds_read_b128 v[24:27], v8 offset:24576
  v_mfma_f32_32x32x16_bf16 v[80:95], a[148:151], v[32:35], v[80:95]
  s_waitcnt lgkmcnt(5)
  v_mfma_f32_32x32x16_bf16 v[64:79], a[152:155], v[36:39], v[64:79]
  ds_read_b128 v[28:31], v9 offset:24576
  v_mfma_f32_32x32x16_bf16 v[80:95], a[156:159], v[36:39], v[80:95]
  s_waitcnt lgkmcnt(5)
  buffer_store_dwordx4 v[132:135], v7, s[4:7], s21 offen offset:1024 sc1
  v_mfma_f32_32x32x16_bf16 v[64:79], a[160:163], v[40:43], v[64:79]
  ds_read_b128 v[32:35], v10 offset:24576
  v_mfma_f32_32x32x16_bf16 v[80:95], a[164:167], v[40:43], v[80:95]
  s_waitcnt lgkmcnt(5)
  v_mfma_f32_32x32x16_bf16 v[64:79], a[168:171], v[44:47], v[64:79]
  ds_read_b128 v[36:39], v11 offset:24576
  v_mfma_f32_32x32x16_bf16 v[80:95], a[172:175], v[44:47], v[80:95]
  s_waitcnt lgkmcnt(5)
  buffer_store_dwordx4 v[136:139], v7, s[4:7], s21 offen offset:2048 sc1
  v_mfma_f32_32x32x16_bf16 v[64:79], a[176:179], v[48:51], v[64:79]
  ds_read_b128 v[40:43], v12 offset:24576
  v_mfma_f32_32x32x16_bf16 v[80:95], a[180:183], v[48:51], v[80:95]
  s_waitcnt lgkmcnt(5)
  v_mfma_f32_32x32x16_bf16 v[64:79], a[184:187], v[52:55], v[64:79]
  ds_read_b128 v[44:47], v13 offset:24576
  v_mfma_f32_32x32x16_bf16 v[80:95], a[188:191], v[52:55], v[80:95]
  s_waitcnt lgkmcnt(5)
  buffer_store_dwordx4 v[140:143], v7, s[4:7], s21 offen offset:3072 sc1
  v_mfma_f32_32x32x16_bf16 v[64:79], a[192:195], v[24:27], v[64:79]
  s_mov_b32 s21, s27
  ds_read_b128 v[48:51], v14 offset:24576
  v_mov_b32 v7, v2
  v_mfma_f32_32x32x16_bf16 v[80:95], a[196:199], v[24:27], v[80:95]
  s_waitcnt lgkmcnt(5)
  v_mfma_f32_32x32x16_bf16 v[64:79], a[200:203], v[28:31], v[64:79]
  s_add_u32 s27, s27, s22
  ds_read_b128 v[52:55], v15 offset:24576
  v_mfma_f32_32x32x16_bf16 v[80:95], a[204:207], v[28:31], v[80:95]
  s_waitcnt lgkmcnt(5)
  s_waitcnt vmcnt(17)
  s_barrier
  v_mfma_f32_32x32x16_bf16 v[64:79], a[208:211], v[32:35], v[64:79]
  ds_read_b128 v[24:27], v8 offset:32768
  v_mfma_f32_32x32x16_bf16 v[80:95], a[212:215], v[32:35], v[80:95]
  s_waitcnt lgkmcnt(5)
  v_mfma_f32_32x32x16_bf16 v[64:79], a[216:219], v[36:39], v[64:79]
  s_add_u32 s29, s29, 1
  ds_read_b128 v[28:31], v9 offset:32768
  v_mfma_f32_32x32x16_bf16 v[80:95], a[220:223], v[36:39], v[80:95]
  s_waitcnt lgkmcnt(5)
  s_max_i32 s30, s29, 0
  v_mov_b32 v144, s30
  v_mfma_f32_32x32x16_bf16 v[64:79], a[224:227], v[40:43], v[64:79]
  ds_read_b128 v[32:35], v10 offset:32768
  v_mfma_f32_32x32x16_bf16 v[80:95], a[228:231], v[40:43], v[80:95]
  s_waitcnt lgkmcnt(5)
  buffer_store_dword v144, v145, s[4:7], s31 offen sc1
  v_mfma_f32_32x32x16_bf16 v[64:79], a[232:235], v[44:47], v[64:79]
  ds_read_b128 v[36:39], v11 offset:32768
  v_mfma_f32_32x32x16_bf16 v[80:95], a[236:239], v[44:47], v[80:95]
  s_waitcnt lgkmcnt(5)
  v_mfma_f32_32x32x16_bf16 v[64:79], a[240:243], v[48:51], v[64:79]
  s_sub_u32 s23, s23, 1
  ds_read_b128 v[40:43], v12 offset:32768
  v_mfma_f32_32x32x16_bf16 v[80:95], a[244:247], v[48:51], v[80:95]
  s_waitcnt lgkmcnt(5)
  v_mfma_f32_32x32x16_bf16 v[64:79], a[248:251], v[52:55], v[64:79]
  s_cmp_eq_u32 s23, 0
  ds_read_b128 v[44:47], v13 offset:32768
  v_mfma_f32_32x32x16_bf16 v[80:95], a[252:255], v[52:55], v[80:95]
  s_cbranch_scc1 G_done0_4
  s_waitcnt lgkmcnt(5)
  v_mfma_f32_32x32x16_bf16 v[96:111], a[0:3], v[24:27], 0
  s_add_u32 m0, s25, 0
  ds_read_b128 v[48:51], v14 offset:32768
  v_mfma_f32_32x32x16_bf16 v[112:127], a[4:7], v[24:27], 0
  s_waitcnt lgkmcnt(5)
  buffer_load_dwordx4 v16, s[12:15], s19 offen lds
  v_mfma_f32_32x32x16_bf16 v[96:111], a[8:11], v[28:31], v[96:111]
  ds_read_b128 v[52:55], v15 offset:32768
  v_mul_f32 v64, s24, v64
  v_mul_f32 v65, s24, v65
  v_mfma_f32_32x32x16_bf16 v[112:127], a[12:15], v[28:31], v[112:127]
  s_waitcnt lgkmcnt(5)
  v_cvt_pk_bf16_f32 v128, v64, v65
  v_mul_f32 v66, s24, v66
  v_mfma_f32_32x32x16_bf16 v[96:111], a[16:19], v[32:35], v[96:111]
  s_add_u32 m0, s25, 1024
  ds_read_b128 v[24:27], v8 offset:40960
  v_mul_f32 v67, s24, v67
  v_cvt_pk_bf16_f32 v129, v66, v67
  v_mfma_f32_32x32x16_bf16 v[112:127], a[20:23], v[32:35], v[112:127]
  s_waitcnt lgkmcnt(5)
  buffer_load_dwordx4 v17, s[12:15], s19 offen lds
  v_mul_f32 v68, s24, v68
  v_mul_f32 v69, s24, v69
  v_mfma_f32_32x32x16_bf16 v[96:111], a[24:27], v[36:39], v[96:111]
  ds_read_b128 v[28:31], v9 offset:40960
  v_cvt_pk_bf16_f32 v130, v68, v69
  v_mul_f32 v70, s24, v70
  v_mfma_f32_32x32x16_bf16 v[112:127], a[28:31], v[36:39], v[112:127]
  s_waitcnt lgkmcnt(5)
  v_mul_f32 v71, s24, v71
  v_cvt_pk_bf16_f32 v131, v70, v71
  v_mfma_f32_32x32x16_bf16 v[96:111], a[32:35], v[40:43], v[96:111]
  s_add_u32 m0, s25, 2048
  ds_read_b128 v[32:35], v10 offset:40960
  v_mul_f32 v72, s24, v72
  v_mul_f32 v73, s24, v73
  v_mfma_f32_32x32x16_bf16 v[112:127], a[36:39], v[40:43], v[112:127]
  s_waitcnt lgkmcnt(5)
  buffer_load_dwordx4 v18, s[12:15], s19 offen lds
  v_cvt_pk_bf16_f32 v132, v72, v73
  v_mul_f32 v74, s24, v74
  v_mfma_f32_32x32x16_bf16 v[96:111], a[40:43], v[44:47], v[96:111]
  ds_read_b128 v[36:39], v11 offset:40960
  v_mul_f32 v75, s24, v75
  v_cvt_pk_bf16_f32 v133, v74, v75
  v_mfma_f32_32x32x16_bf16 v[112:127], a[44:47], v[44:47], v[112:127]
  s_waitcnt lgkmcnt(5)
  v_mul_f32 v76, s24, v76
  v_mul_f32 v77, s24, v77
  v_mfma_f32_32x32x16_bf16 v[96:111], a[48:51], v[48:51], v[96:111]
  s_add_u32 m0, s25, 3072
  ds_read_b128 v[40:43], v12 offset:40960
  v_cvt_pk_bf16_f32 v134, v76, v77
  v_mul_f32 v78, s24, v78
  v_mfma_f32_32x32x16_bf16 v[112:127], a[52:55], v[48:51], v[112:127]
  s_waitcnt lgkmcnt(5)
  buffer_load_dwordx4 v19, s[12:15], s19 offen lds
  v_mul_f32 v79, s24, v79
  v_cvt_pk_bf16_f32 v135, v78, v79
  v_mfma_f32_32x32x16_bf16 v[96:111], a[56:59], v[52:55], v[96:111]
  ds_read_b128 v[44:47], v13 offset:40960
  v_mul_f32 v80, s24, v80
  v_mul_f32 v81, s24, v81
  v_mfma_f32_32x32x16_bf16 v[112:127], a[60:63], v[52:55], v[112:127]
  s_waitcnt lgkmcnt(5)
  v_cvt_pk_bf16_f32 v136, v80, v81
  v_mul_f32 v82, s24, v82
  v_mfma_f32_32x32x16_bf16 v[96:111], a[64:67], v[24:27], v[96:111]
  s_add_u32 m0, s25, 4096
  ds_read_b128 v[48:51], v14 offset:40960
  v_mul_f32 v83, s24, v83
  v_cvt_pk_bf16_f32 v137, v82, v83
  v_mfma_f32_32x32x16_bf16 v[112:127], a[68:71], v[24:27], v[112:127]
  s_waitcnt lgkmcnt(5)
  buffer_load_dwordx4 v20, s[12:15], s19 offen lds
  v_mul_f32 v84, s24, v84
  v_mul_f32 v85, s24, v85
  v_mfma_f32_32x32x16_bf16 v[96:111], a[72:75], v[28:31], v[96:111]
  ds_read_b128 v[52:55], v15 offset:40960
  v_cvt_pk_bf16_f32 v138, v84, v85
  v_mul_f32 v86, s24, v86
  v_mfma_f32_32x32x16_bf16 v[112:127], a[76:79], v[28:31], v[112:127]
  s_waitcnt lgkmcnt(5)
  v_mul_f32 v87, s24, v87
  v_cvt_pk_bf16_f32 v139, v86, v87
  v_mfma_f32_32x32x16_bf16 v[96:111], a[80:83], v[32:35], v[96:111]
  s_add_u32 m0, s25, 5120
  ds_read_b128 v[24:27], v8 offset:49152
  v_mul_f32 v88, s24, v88
  v_mul_f32 v89, s24, v89
  v_mfma_f32_32x32x16_bf16 v[112:127], a[84:87], v[32:35], v[112:127]
  s_waitcnt lgkmcnt(5)
  buffer_load_dwordx4 v21, s[12:15], s19 offen lds
  v_cvt_pk_bf16_f32 v140, v88, v89
  v_mul_f32 v90, s24, v90
  v_mfma_f32_32x32x16_bf16 v[96:111], a[88:91], v[36:39], v[96:111]
  ds_read_b128 v[28:31], v9 offset:49152
  v_mul_f32 v91, s24, v91
  v_cvt_pk_bf16_f32 v141, v90, v91
  v_mfma_f32_32x32x16_bf16 v[112:127], a[92:95], v[36:39], v[112:127]
  s_waitcnt lgkmcnt(5)
  v_mul_f32 v92, s24, v92
  v_mul_f32 v93, s24, v93
  v_mfma_f32_32x32x16_bf16 v[96:111], a[96:99], v[40:43], v[96:111]
  s_add_u32 m0, s25, 6144
  ds_read_b128 v[32:35], v10 offset:49152
  v_cvt_pk_bf16_f32 v142, v92, v93
  v_mul_f32 v94, s24, v94
  v_mfma_f32_32x32x16_bf16 v[112:127], a[100:103], v[40:43], v[112:127]
  s_waitcnt lgkmcnt(5)
  buffer_load_dwordx4 v22, s[12:15], s19 offen lds
  v_mul_f32 v95, s24, v95
  v_cvt_pk_bf16_f32 v143, v94, v95
  v_mfma_f32_32x32x16_bf16 v[96:111], a[104:107], v[44:47], v[96:111]
  ds_read_b128 v[36:39], v11 offset:49152
  v_mfma_f32_32x32x16_bf16 v[112:127], a[108:111], v[44:47], v[112:127]
  s_waitcnt lgkmcnt(5)
  v_mfma_f32_32x32x16_bf16 v[96:111], a[112:115], v[48:51], v[96:111]
  s_add_u32 m0, s25, 7168
  ds_read_b128 v[40:43], v12 offset:49152
  v_mfma_f32_32x32x16_bf16 v[112:127], a[116:119], v[48:51], v[112:127]
  s_waitcnt lgkmcnt(5)
  buffer_load_dwordx4 v23, s[12:15], s19 offen lds
  v_mfma_f32_32x32x16_bf16 v[96:111], a[120:123], v[52:55], v[96:111]
  s_cmp_gt_u32 s23, 3
  ds_read_b128 v[44:47], v13 offset:49152
  v_mfma_f32_32x32x16_bf16 v[112:127], a[124:127], v[52:55], v[112:127]
  s_waitcnt lgkmcnt(5)
  s_cselect_b32 s26, s20, 0
  v_mfma_f32_32x32x16_bf16 v[96:111], a[128:131], v[24:27], v[96:111]
  s_add_u32 s19, s19, s26
  ds_read_b128 v[48:51], v14 offset:49152
  v_mfma_f32_32x32x16_bf16 v[112:127], a[132:135], v[24:27], v[112:127]
  s_waitcnt lgkmcnt(5)
  s_add_u32 s25, s25, 32768
  v_mfma_f32_32x32x16_bf16 v[96:111], a[136:139], v[28:31], v[96:111]
  s_and_b32 s25, s25, 0x1ffff
  ds_read_b128 v[52:55], v15 offset:49152
  v_mfma_f32_32x32x16_bf16 v[112:127], a[140:143], v[28:31], v[112:127]
  s_waitcnt lgkmcnt(5)
  buffer_store_dwordx4 v[128:131], v7, s[4:7], s21 offen offset:0 sc1
  v_mfma_f32_32x32x16_bf16 v[96:111], a[144:147], v[32:35], v[96:111]
  ds_read_b128 v[24:27], v8 offset:57344
  v_mfma_f32_32x32x16_bf16 v[112:127], a[148:151], v[32:35], v[112:127]
  s_waitcnt lgkmcnt(5)
  v_xor_b32 v8, 0x10000, v8
  v_mfma_f32_32x32x16_bf16 v[96:111], a[152:155], v[36:39], v[96:111]
  ds_read_b128 v[28:31], v9 offset:57344
  v_mfma_f32_32x32x16_bf16 v[112:127], a[156:159], v[36:39], v[112:127]
  s_waitcnt lgkmcnt(5)
  buffer_store_dwordx4 v[132:135], v7, s[4:7], s21 offen offset:1024 sc1
  v_xor_b32 v9, 0x10000, v9
  v_mfma_f32_32x32x16_bf16 v[96:111], a[160:163], v[40:43], v[96:111]
  ds_read_b128 v[32:35], v10 offset:57344
  v_mfma_f32_32x32x16_bf16 v[112:127], a[164:167], v[40:43], v[112:127]
  s_waitcnt lgkmcnt(5)
  v_xor_b32 v10, 0x10000, v10
  v_mfma_f32_32x32x16_bf16 v[96:111], a[168:171], v[44:47], v[96:111]
  ds_read_b128 v[36:39], v11 offset:57344
  v_mfma_f32_32x32x16_bf16 v[112:127], a[172:175], v[44:47], v[112:127]
  s_waitcnt lgkmcnt(5)
  buffer_store_dwordx4 v[136:139], v7, s[4:7], s21 offen offset:2048 sc1
  v_xor_b32 v11, 0x10000, v11
  v_mfma_f32_32x32x16_bf16 v[96:111], a[176:179], v[48:51], v[96:111]
  ds_read_b128 v[40:43], v12 offset:57344
  v_mfma_f32_32x32x16_bf16 v[112:127], a[180:183], v[48:51], v[112:127]
  s_waitcnt lgkmcnt(5)
  v_xor_b32 v12, 0x10000, v12
  v_mfma_f32_32x32x16_bf16 v[96:111], a[184:187], v[52:55], v[96:111]
  ds_read_b128 v[44:47], v13 offset:57344
  v_mfma_f32_32x32x16_bf16 v[112:127], a[188:191], v[52:55], v[112:127]
  s_waitcnt lgkmcnt(5)
  buffer_store_dwordx4 v[140:143], v7, s[4:7], s21 offen offset:3072 sc1
  v_xor_b32 v13, 0x10000, v13
  v_mfma_f32_32x32x16_bf16 v[96:111], a[192:195], v[24:27], v[96:111]
  s_mov_b32 s21, s27
  ds_read_b128 v[48:51], v14 offset:57344
  v_mov_b32 v7, v2
  v_mfma_f32_32x32x16_bf16 v[112:127], a[196:199], v[24:27], v[112:127]
  s_waitcnt lgkmcnt(5)
  v_xor_b32 v14, 0x10000, v14
  v_mfma_f32_32x32x16_bf16 v[96:111], a[200:203], v[28:31], v[96:111]
  s_add_u32 s27, s27, s22
  ds_read_b128 v[52:55], v15 offset:57344
  v_mfma_f32_32x32x16_bf16 v[112:127], a[204:207], v[28:31], v[112:127]
  s_waitcnt lgkmcnt(5)
  s_waitcnt vmcnt(17)
  s_barrier
  v_xor_b32 v15, 0x10000, v15
  v_mfma_f32_32x32x16_bf16 v[96:111], a[208:211], v[32:35], v[96:111]
  ds_read_b128 v[24:27], v8 offset:0
  v_mfma_f32_32x32x16_bf16 v[112:127], a[212:215], v[32:35], v[112:127]
  s_waitcnt lgkmcnt(5)
  v_mfma_f32_32x32x16_bf16 v[96:111], a[216:219], v[36:39], v[96:111]
  s_add_u32 s29, s29, 1
  ds_read_b128 v[28:31], v9 offset:0
  v_mfma_f32_32x32x16_bf16 v[112:127], a[220:223], v[36:39], v[112:127]
  s_waitcnt lgkmcnt(5)
  s_max_i32 s30, s29, 0
  v_mov_b32 v144, s30
  v_mfma_f32_32x32x16_bf16 v[96:111], a[224:227], v[40:43], v[96:111]
  ds_read_b128 v[32:35], v10 offset:0
  v_mfma_f32_32x32x16_bf16 v[112:127], a[228:231], v[40:43], v[112:127]
  s_waitcnt lgkmcnt(5)
  buffer_store_dword v144, v145, s[4:7], s31 offen sc1
  v_mfma_f32_32x32x16_bf16 v[96:111], a[232:235], v[44:47], v[96:111]
  ds_read_b128 v[36:39], v11 offset:0
  v_mfma_f32_32x32x16_bf16 v[112:127], a[236:239], v[44:47], v[112:127]
  s_waitcnt lgkmcnt(5)
  v_mfma_f32_32x32x16_bf16 v[96:111], a[240:243], v[48:51], v[96:111]
  s_sub_u32 s23, s23, 1
  ds_read_b128 v[40:43], v12 offset:0
  v_mfma_f32_32x32x16_bf16 v[112:127], a[244:247], v[48:51], v[112:127]
  s_waitcnt lgkmcnt(5)
  v_mfma_f32_32x32x16_bf16 v[96:111], a[248:251], v[52:55], v[96:111]
  s_cmp_eq_u32 s23, 0
  ds_read_b128 v[44:47], v13 offset:0
  v_mfma_f32_32x32x16_bf16 v[112:127], a[252:255], v[52:55], v[112:127]
  s_cbranch_scc1 G_done1_5
  s_branch G_top_3
G_done0_4:
  s_nop 7
  s_nop 3
  v_mul_f32 v64, s24, v64
  v_mul_f32 v65, s24, v65
  v_cvt_pk_bf16_f32 v128, v64, v65
  v_mul_f32 v66, s24, v66
  v_mul_f32 v67, s24, v67
  v_cvt_pk_bf16_f32 v129, v66, v67
  v_mul_f32 v68, s24, v68
  v_mul_f32 v69, s24, v69
  v_cvt_pk_bf16_f32 v130, v68, v69
  v_mul_f32 v70, s24, v70
  v_mul_f32 v71, s24, v71
  v_cvt_pk_bf16_f32 v131, v70, v71
  buffer_store_dwordx4 v[128:131], v7, s[4:7], s21 offen offset:0 sc1
  v_mul_f32 v72, s24, v72
  v_mul_f32 v73, s24, v73
  v_cvt_pk_bf16_f32 v132, v72, v73
  v_mul_f32 v74, s24, v74
  v_mul_f32 v75, s24, v75
  v_cvt_pk_bf16_f32 v133, v74, v75
  v_mul_f32 v76, s24, v76
  v_mul_f32 v77, s24, v77
  v_cvt_pk_bf16_f32 v134, v76, v77
  v_mul_f32 v78, s24, v78
  v_mul_f32 v79, s24, v79
  v_cvt_pk_bf16_f32 v135, v78, v79
  buffer_store_dwordx4 v[132:135], v7, s[4:7], s21 offen offset:1024 sc1
  v_mul_f32 v80, s24, v80
  v_mul_f32 v81, s24, v81
  v_cvt_pk_bf16_f32 v136, v80, v81
  v_mul_f32 v82, s24, v82
  v_mul_f32 v83, s24, v83
  v_cvt_pk_bf16_f32 v137, v82, v83
  v_mul_f32 v84, s24, v84
  v_mul_f32 v85, s24, v85
  v_cvt_pk_bf16_f32 v138, v84, v85
  v_mul_f32 v86, s24, v86
  v_mul_f32 v87, s24, v87
  v_cvt_pk_bf16_f32 v139, v86, v87
  buffer_store_dwordx4 v[136:139], v7, s[4:7], s21 offen offset:2048 sc1
  v_mul_f32 v88, s24, v88
  v_mul_f32 v89, s24, v89
  v_cvt_pk_bf16_f32 v140, v88, v89
  v_mul_f32 v90, s24, v90
  v_mul_f32 v91, s24, v91
  v_cvt_pk_bf16_f32 v141, v90, v91
  v_mul_f32 v92, s24, v92
  v_mul_f32 v93, s24, v93
  v_cvt_pk_bf16_f32 v142, v92, v93
  v_mul_f32 v94, s24, v94
  v_mul_f32 v95, s24, v95
  v_cvt_pk_bf16_f32 v143, v94, v95
  buffer_store_dwordx4 v[140:143], v7, s[4:7], s21 offen offset:3072 sc1
  s_branch G_fin_6
G_done1_5:
  s_nop 7
  s_nop 3
  v_mul_f32 v96, s24, v96
  v_mul_f32 v97, s24, v97
  v_cvt_pk_bf16_f32 v128, v96, v97
  v_mul_f32 v98, s24, v98
  v_mul_f32 v99, s24, v99
  v_cvt_pk_bf16_f32 v129, v98, v99
  v_mul_f32 v100, s24, v100
  v_mul_f32 v101, s24, v101
  v_cvt_pk_bf16_f32 v130, v100, v101
  v_mul_f32 v102, s24, v102
  v_mul_f32 v103, s24, v103
  v_cvt_pk_bf16_f32 v131, v102, v103
  buffer_store_dwordx4 v[128:131], v7, s[4:7], s21 offen offset:0 sc1
  v_mul_f32 v104, s24, v104
  v_mul_f32 v105, s24, v105
  v_cvt_pk_bf16_f32 v132, v104, v105
  v_mul_f32 v106, s24, v106
  v_mul_f32 v107, s24, v107
  v_cvt_pk_bf16_f32 v133, v106, v107
  v_mul_f32 v108, s24, v108
  v_mul_f32 v109, s24, v109
  v_cvt_pk_bf16_f32 v134, v108, v109
  v_mul_f32 v110, s24, v110
  v_mul_f32 v111, s24, v111
  v_cvt_pk_bf16_f32 v135, v110, v111
  buffer_store_dwordx4 v[132:135], v7, s[4:7], s21 offen offset:1024 sc1
  v_mul_f32 v112, s24, v112
  v_mul_f32 v113, s24, v113
  v_cvt_pk_bf16_f32 v136, v112, v113
  v_mul_f32 v114, s24, v114
  v_mul_f32 v115, s24, v115
  v_cvt_pk_bf16_f32 v137, v114, v115
  v_mul_f32 v116, s24, v116
  v_mul_f32 v117, s24, v117
  v_cvt_pk_bf16_f32 v138, v116, v117
  v_mul_f32 v118, s24, v118
  v_mul_f32 v119, s24, v119
  v_cvt_pk_bf16_f32 v139, v118, v119
  buffer_store_dwordx4 v[136:139], v7, s[4:7], s21 offen offset:2048 sc1
  v_mul_f32 v120, s24, v120
  v_mul_f32 v121, s24, v121
  v_cvt_pk_bf16_f32 v140, v120, v121
  v_mul_f32 v122, s24, v122
  v_mul_f32 v123, s24, v123
  v_cvt_pk_bf16_f32 v141, v122, v123
  v_mul_f32 v124, s24, v124
  v_mul_f32 v125, s24, v125
  v_cvt_pk_bf16_f32 v142, v124, v125
  v_mul_f32 v126, s24, v126
  v_mul_f32 v127, s24, v127
  v_cvt_pk_bf16_f32 v143, v126, v127
  buffer_store_dwordx4 v[140:143], v7, s[4:7], s21 offen offset:3072 sc1
G_fin_6:
  s_waitcnt vmcnt(0) lgkmcnt(0)
  s_barrier
  s_add_u32 s30, s29, 3
  v_mov_b32 v144, s30
  v_min_u32 v145, 1, v0
  v_lshlrev_b32 v145, 30, v145
  buffer_store_dword v144, v145, s[4:7], s31 offen sc1
  s_branch P_end_2
P_v_1:
  s_mov_b32 s27, s21
  v_mov_b32 v7, 0x40000000
  s_mov_b32 s29, -3
  v_min_u32 v145, 1, v0
  v_lshlrev_b32 v145, 30, v145
  ds_read_b128 v[24:27], v8 offset:0
  ds_read_b128 v[28:31], v9 offset:0
  ds_read_b128 v[32:35], v10 offset:0
  ds_read_b128 v[36:39], v11 offset:0
  ds_read_b128 v[40:43], v12 offset:0
  ds_read_b128 v[44:47], v13 offset:0
.p2align 6
G_top_7:
  s_waitcnt lgkmcnt(5)
  v_mfma_f32_32x32x16_bf16 v[64:79], v[24:27], a[0:3], 0
  s_add_u32 m0, s25, 0
  ds_read_b128 v[48:51], v14 offset:0
  v_mfma_f32_32x32x16_bf16 v[80:95], v[24:27], a[4:7], 0
  s_waitcnt lgkmcnt(5)
  buffer_load_dwordx4 v16, s[12:15], s19 offen lds
  v_mfma_f32_32x32x16_bf16 v[64:79], v[28:31], a[8:11], v[64:79]
  ds_read_b128 v[52:55], v15 offset:0
  v_mul_f32 v96, s24, v96
  v_mul_f32 v97, s24, v97
  v_mfma_f32_32x32x16_bf16 v[80:95], v[28:31], a[12:15], v[80:95]
  s_waitcnt lgkmcnt(5)
  v_cvt_pk_bf16_f32 v128, v96, v97
  v_mul_f32 v98, s24, v98
  v_mfma_f32_32x32x16_bf16 v[64:79], v[32:35], a[16:19], v[64:79]
  s_add_u32 m0, s25, 1024
  ds_read_b128 v[24:27], v8 offset:8192
  v_mul_f32 v99, s24, v99
  v_cvt_pk_bf16_f32 v129, v98, v99
  v_mfma_f32_32x32x16_bf16 v[80:95], v[32:35], a[20:23], v[80:95]
  s_waitcnt lgkmcnt(5)
  buffer_load_dwordx4 v17, s[12:15], s19 offen lds
  v_mul_f32 v100, s24, v100
  v_mul_f32 v101, s24, v101
  v_mfma_f32_32x32x16_bf16 v[64:79], v[36:39], a[24:27], v[64:79]
  ds_read_b128 v[28:31], v9 offset:8192
  v_cvt_pk_bf16_f32 v130, v100, v101
  v_mul_f32 v102, s24, v102
  v_mfma_f32_32x32x16_bf16 v[80:95], v[36:39], a[28:31], v[80:95]
  s_waitcnt lgkmcnt(5)
  v_mul_f32 v103, s24, v103
  v_cvt_pk_bf16_f32 v131, v102, v103
  v_mfma_f32_32x32x16_bf16 v[64:79], v[40:43], a[32:35], v[64:79]
  s_add_u32 m0, s25, 2048
  ds_read_b128 v[32:35], v10 offset:8192
  v_mul_f32 v104, s24, v104
  v_mul_f32 v105, s24, v105
  v_mfma_f32_32x32x16_bf16 v[80:95], v[40:43], a[36:39], v[80:95]
  s_waitcnt lgkmcnt(5)
  buffer_load_dwordx4 v18, s[12:15], s19 offen lds
  v_cvt_pk_bf16_f32 v132, v104, v105
  v_mul_f32 v106, s24, v106
  v_mfma_f32_32x32x16_bf16 v[64:79], v[44:47], a[40:43], v[64:79]
  ds_read_b128 v[36:39], v11 offset:8192
  v_mul_f32 v107, s24, v107
  v_cvt_pk_bf16_f32 v133, v106, v107
  v_mfma_f32_32x32x16_bf16 v[80:95], v[44:47], a[44:47], v[80:95]
  s_waitcnt lgkmcnt(5)
  v_mul_f32 v108, s24, v108
  v_mul_f32 v109, s24, v109
  v_mfma_f32_32x32x16_bf16 v[64:79], v[48:51], a[48:51], v[64:79]
  s_add_u32 m0, s25, 3072
  ds_read_b128 v[40:43], v12 offset:8192
  v_cvt_pk_bf16_f32 v134, v108, v109
  v_mul_f32 v110, s24, v110
  v_mfma_f32_32x32x16_bf16 v[80:95], v[48:51], a[52:55], v[80:95]
  s_waitcnt lgkmcnt(5)
  buffer_load_dwordx4 v19, s[12:15], s19 offen lds
  v_mul_f32 v111, s24, v111
  v_cvt_pk_bf16_f32 v135, v110, v111
  v_mfma_f32_32x32x16_bf16 v[64:79], v[52:55], a[56:59], v[64:79]
  ds_read_b128 v[44:47], v13 offset:8192
  v_mul_f32 v112, s24, v112
  v_mul_f32 v113, s24, v113
  v_mfma_f32_32x32x16_bf16 v[80:95], v[52:55], a[60:63], v[80:95]
  s_waitcnt lgkmcnt(5)
  v_cvt_pk_bf16_f32 v136, v112, v113
  v_mul_f32 v114, s24, v114
  v_mfma_f32_32x32x16_bf16 v[64:79], v[24:27], a[64:67], v[64:79]
  s_add_u32 m0, s25, 4096
  ds_read_b128 v[48:51], v14 offset:8192
  v_mul_f32 v115, s24, v115
  v_cvt_pk_bf16_f32 v137, v114, v115
  v_mfma_f32_32x32x16_bf16 v[80:95], v[24:27], a[68:71], v[80:95]
  s_waitcnt lgkmcnt(5)
  buffer_load_dwordx4 v20, s[12:15], s19 offen lds
  v_mul_f32 v116, s24, v116
  v_mul_f32 v117, s24, v117
  v_mfma_f32_32x32x16_bf16 v[64:79], v[28:31], a[72:75], v[64:79]
  ds_read_b128 v[52:55], v15 offset:8192
  v_cvt_pk_bf16_f32 v138, v116, v117
  v_mul_f32 v118, s24, v118
  v_mfma_f32_32x32x16_bf16 v[80:95], v[28:31], a[76:79], v[80:95]
  s_waitcnt lgkmcnt(5)
  v_mul_f32 v119, s24, v119
  v_cvt_pk_bf16_f32 v139, v118, v119
  v_mfma_f32_32x32x16_bf16 v[64:79], v[32:35], a[80:83], v[64:79]
  s_add_u32 m0, s25, 5120
  ds_read_b128 v[24:27], v8 offset:16384
  v_mul_f32 v120, s24, v120
  v_mul_f32 v121, s24, v121
  v_mfma_f32_32x32x16_bf16 v[80:95], v[32:35], a[84:87], v[80:95]
  s_waitcnt lgkmcnt(5)
  buffer_load_dwordx4 v21, s[12:15], s19 offen lds
  v_cvt_pk_bf16_f32 v140, v120, v121
  v_mul_f32 v122, s24, v122
  v_mfma_f32_32x32x16_bf16 v[64:79], v[36:39], a[88:91], v[64:79]
  ds_read_b128 v[28:31], v9 offset:16384
  v_mul_f32 v123, s24, v123
  v_cvt_pk_bf16_f32 v141, v122, v123
  v_mfma_f32_32x32x16_bf16 v[80:95], v[36:39], a[92:95], v[80:95]
  s_waitcnt lgkmcnt(5)
  v_mul_f32 v124, s24, v124
  v_mul_f32 v125, s24, v125
  v_mfma_f32_32x32x16_bf16 v[64:79], v[40:43], a[96:99], v[64:79]
  s_add_u32 m0, s25, 6144
  ds_read_b128 v[32:35], v10 offset:16384
  v_cvt_pk_bf16_f32 v142, v124, v125
  v_mul_f32 v126, s24, v126
  v_mfma_f32_32x32x16_bf16 v[80:95], v[40:43], a[100:103], v[80:95]
  s_waitcnt lgkmcnt(5)
  buffer_load_dwordx4 v22, s[12:15], s19 offen lds
  v_mul_f32 v127, s24, v127
  v_cvt_pk_bf16_f32 v143, v126, v127
  v_mfma_f32_32x32x16_bf16 v[64:79], v[44:47], a[104:107], v[64:79]
  ds_read_b128 v[36:39], v11 offset:16384
  v_mfma_f32_32x32x16_bf16 v[80:95], v[44:47], a[108:111], v[80:95]
  s_waitcnt lgkmcnt(5)
  v_mfma_f32_32x32x16_bf16 v[64:79], v[48:51], a[112:115], v[64:79]
  s_add_u32 m0, s25, 7168
  ds_read_b128 v[40:43], v12 offset:16384
  v_mfma_f32_32x32x16_bf16 v[80:95], v[48:51], a[116:119], v[80:95]
  s_waitcnt lgkmcnt(5)
  buffer_load_dwordx4 v23, s[12:15], s19 offen lds
  v_mfma_f32_32x32x16_bf16 v[64:79], v[52:55], a[120:123], v[64:79]
  s_cmp_gt_u32 s23, 3
  ds_read_b128 v[44:47], v13 offset:16384
  v_mfma_f32_32x32x16_bf16 v[80:95], v[52:55], a[124:127], v[80:95]
  s_waitcnt lgkmcnt(5)
  s_cselect_b32 s26, s20, 0
  v_mfma_f32_32x32x16_bf16 v[64:79], v[24:27], a[128:131], v[64:79]
  s_add_u32 s19, s19, s26
  ds_read_b128 v[48:51], v14 offset:16384
  v_mfma_f32_32x32x16_bf16 v[80:95], v[24:27], a[132:135], v[80:95]
  s_waitcnt lgkmcnt(5)
  s_add_u32 s25, s25, 32768
  v_mfma_f32_32x32x16_bf16 v[64:79], v[28:31], a[136:139], v[64:79]
  s_and_b32 s25, s25, 0x1ffff
  ds_read_b128 v[52:55], v15 offset:16384
  v_mfma_f32_32x32x16_bf16 v[80:95], v[28:31], a[140:143], v[80:95]
  s_waitcnt lgkmcnt(5)
  buffer_store_dwordx4 v[128:131], v7, s[4:7], s21 offen offset:0 sc1
  v_mfma_f32_32x32x16_bf16 v[64:79], v[32:35], a[144:147], v[64:79]
  ds_read_b128 v[24:27], v8 offset:24576
  v_mfma_f32_32x32x16_bf16 v[80:95], v[32:35], a[148:151], v[80:95]
  s_waitcnt lgkmcnt(5)
  v_mfma_f32_32x32x16_bf16 v[64:79], v[36:39], a[152:155], v[64:79]
  ds_read_b128 v[28:31], v9 offset:24576
  v_mfma_f32_32x32x16_bf16 v[80:95], v[36:39], a[156:159], v[80:95]
  s_waitcnt lgkmcnt(5)
  buffer_store_dwordx4 v[132:135], v7, s[4:7], s21 offen offset:1024 sc1
  v_mfma_f32_32x32x16_bf16 v[64:79], v[40:43], a[160:163], v[64:79]
  ds_read_b128 v[32:35], v10 offset:24576
  v_mfma_f32_32x32x16_bf16 v[80:95], v[40:43], a[164:167], v[80:95]
  s_waitcnt lgkmcnt(5)
  v_mfma_f32_32x32x16_bf16 v[64:79], v[44:47], a[168:171], v[64:79]
  ds_read_b128 v[36:39], v11 offset:24576
  v_mfma_f32_32x32x16_bf16 v[80:95], v[44:47], a[172:175], v[80:95]
  s_waitcnt lgkmcnt(5)
  buffer_store_dwordx4 v[136:139], v7, s[4:7], s21 offen offset:2048 sc1
  v_mfma_f32_32x32x16_bf16 v[64:79], v[48:51], a[176:179], v[64:79]
  ds_read_b128 v[40:43], v12 offset:24576
  v_mfma_f32_32x32x16_bf16 v[80:95], v[48:51], a[180:183], v[80:95]
  s_waitcnt lgkmcnt(5)
  v_mfma_f32_32x32x16_bf16 v[64:79], v[52:55], a[184:187], v[64:79]
  ds_read_b128 v[44:47], v13 offset:24576
  v_mfma_f32_32x32x16_bf16 v[80:95], v[52:55], a[188:191], v[80:95]
  s_waitcnt lgkmcnt(5)
  buffer_store_dwordx4 v[140:143], v7, s[4:7], s21 offen offset:3072 sc1
  v_mfma_f32_32x32x16_bf16 v[64:79], v[24:27], a[192:195], v[64:79]
  s_mov_b32 s21, s27
  ds_read_b128 v[48:51], v14 offset:24576
  v_mov_b32 v7, v2
  v_mfma_f32_32x32x16_bf16 v[80:95], v[24:27], a[196:199], v[80:95]
  s_waitcnt lgkmcnt(5)
  v_mfma_f32_32x32x16_bf16 v[64:79], v[28:31], a[200:203], v[64:79]
  s_add_u32 s27, s27, s22
  ds_read_b128 v[52:55], v15 offset:24576
  v_mfma_f32_32x32x16_bf16 v[80:95], v[28:31], a[204:207], v[80:95]
  s_waitcnt lgkmcnt(5)
  s_waitcnt vmcnt(17)
  s_barrier
  v_mfma_f32_32x32x16_bf16 v[64:79], v[32:35], a[208:211], v[64:79]
  ds_read_b128 v[24:27], v8 offset:32768
  v_mfma_f32_32x32x16_bf16 v[80:95], v[32:35], a[212:215], v[80:95]
  s_waitcnt lgkmcnt(5)
  v_mfma_f32_32x32x16_bf16 v[64:79], v[36:39], a[216:219], v[64:79]
  s_add_u32 s29, s29, 1
  ds_read_b128 v[28:31], v9 offset:32768
  v_mfma_f32_32x32x16_bf16 v[80:95], v[36:39], a[220:223], v[80:95]
  s_waitcnt lgkmcnt(5)
  s_max_i32 s30, s29, 0
  v_mov_b32 v144, s30
  v_mfma_f32_32x32x16_bf16 v[64:79], v[40:43], a[224:227], v[64:79]
  ds_read_b128 v[32:35], v10 offset:32768
  v_mfma_f32_32x32x16_bf16 v[80:95], v[40:43], a[228:231], v[80:95]
  s_waitcnt lgkmcnt(5)
  buffer_store_dword v144, v145, s[4:7], s31 offen sc1
  v_mfma_f32_32x32x16_bf16 v[64:79], v[44:47], a[232:235], v[64:79]
  ds_read_b128 v[36:39], v11 offset:32768
  v_mfma_f32_32x32x16_bf16 v[80:95], v[44:47], a[236:239], v[80:95]
  s_waitcnt lgkmcnt(5)
  v_mfma_f32_32x32x16_bf16 v[64:79], v[48:51], a[240:243], v[64:79]
  s_sub_u32 s23, s23, 1
  ds_read_b128 v[40:43], v12 offset:32768
  v_mfma_f32_32x32x16_bf16 v[80:95], v[48:51], a[244:247], v[80:95]
  s_waitcnt lgkmcnt(5)
  v_mfma_f32_32x32x16_bf16 v[64:79], v[52:55], a[248:251], v[64:79]
  s_cmp_eq_u32 s23, 0
  ds_read_b128 v[44:47], v13 offset:32768
  v_mfma_f32_32x32x16_bf16 v[80:95], v[52:55], a[252:255], v[80:95]
  s_cbranch_scc1 G_done0_8
  s_waitcnt lgkmcnt(5)
  v_mfma_f32_32x32x16_bf16 v[96:111], v[24:27], a[0:3], 0
  s_add_u32 m0, s25, 0
  ds_read_b128 v[48:51], v14 offset:32768
  v_mfma_f32_32x32x16_bf16 v[112:127], v[24:27], a[4:7], 0
  s_waitcnt lgkmcnt(5)
  buffer_load_dwordx4 v16, s[12:15], s19 offen lds
  v_mfma_f32_32x32x16_bf16 v[96:111], v[28:31], a[8:11], v[96:111]
  ds_read_b128 v[52:55], v15 offset:32768
  v_mul_f32 v64, s24, v64
  v_mul_f32 v65, s24, v65
  v_mfma_f32_32x32x16_bf16 v[112:127], v[28:31], a[12:15], v[112:127]
  s_waitcnt lgkmcnt(5)
  v_cvt_pk_bf16_f32 v128, v64, v65
  v_mul_f32 v66, s24, v66
  v_mfma_f32_32x32x16_bf16 v[96:111], v[32:35], a[16:19], v[96:111]
  s_add_u32 m0, s25, 1024
  ds_read_b128 v[24:27], v8 offset:40960
  v_mul_f32 v67, s24, v67
  v_cvt_pk_bf16_f32 v129, v66, v67
  v_mfma_f32_32x32x16_bf16 v[112:127], v[32:35], a[20:23], v[112:127]
  s_waitcnt lgkmcnt(5)
  buffer_load_dwordx4 v17, s[12:15], s19 offen lds
  v_mul_f32 v68, s24, v68
  v_mul_f32 v69, s24, v69
  v_mfma_f32_32x32x16_bf16 v[96:111], v[36:39], a[24:27], v[96:111]
  ds_read_b128 v[28:31], v9 offset:40960
  v_cvt_pk_bf16_f32 v130, v68, v69
  v_mul_f32 v70, s24, v70
  v_mfma_f32_32x32x16_bf16 v[112:127], v[36:39], a[28:31], v[112:127]
  s_waitcnt lgkmcnt(5)
  v_mul_f32 v71, s24, v71
  v_cvt_pk_bf16_f32 v131, v70, v71
  v_mfma_f32_32x32x16_bf16 v[96:111], v[40:43], a[32:35], v[96:111]
  s_add_u32 m0, s25, 2048
  ds_read_b128 v[32:35], v10 offset:40960
  v_mul_f32 v72, s24, v72
  v_mul_f32 v73, s24, v73
  v_mfma_f32_32x32x16_bf16 v[112:127], v[40:43], a[36:39], v[112:127]
  s_waitcnt lgkmcnt(5)
  buffer_load_dwordx4 v18, s[12:15], s19 offen lds
  v_cvt_pk_bf16_f32 v132, v72, v73
  v_mul_f32 v74, s24, v74
  v_mfma_f32_32x32x16_bf16 v[96:111], v[44:47], a[40:43], v[96:111]
  ds_read_b128 v[36:39], v11 offset:40960
  v_mul_f32 v75, s24, v75
  v_cvt_pk_bf16_f32 v133, v74, v75
  v_mfma_f32_32x32x16_bf16 v[112:127], v[44:47], a[44:47], v[112:127]
  s_waitcnt lgkmcnt(5)
  v_mul_f32 v76, s24, v76
  v_mul_f32 v77, s24, v77
  v_mfma_f32_32x32x16_bf16 v[96:111], v[48:51], a[48:51], v[96:111]
  s_add_u32 m0, s25, 3072
  ds_read_b128 v[40:43], v12 offset:40960
  v_cvt_pk_bf16_f32 v134, v76, v77
  v_mul_f32 v78, s24, v78
  v_mfma_f32_32x32x16_bf16 v[112:127], v[48:51], a[52:55], v[112:127]
  s_waitcnt lgkmcnt(5)
  buffer_load_dwordx4 v19, s[12:15], s19 offen lds
  v_mul_f32 v79, s24, v79
  v_cvt_pk_bf16_f32 v135, v78, v79
  v_mfma_f32_32x32x16_bf16 v[96:111], v[52:55], a[56:59], v[96:111]
  ds_read_b128 v[44:47], v13 offset:40960
  v_mul_f32 v80, s24, v80
  v_mul_f32 v81, s24, v81
  v_mfma_f32_32x32x16_bf16 v[112:127], v[52:55], a[60:63], v[112:127]
  s_waitcnt lgkmcnt(5)
  v_cvt_pk_bf16_f32 v136, v80, v81
  v_mul_f32 v82, s24, v82
  v_mfma_f32_32x32x16_bf16 v[96:111], v[24:27], a[64:67], v[96:111]
  s_add_u32 m0, s25, 4096
  ds_read_b128 v[48:51], v14 offset:40960
  v_mul_f32 v83, s24, v83
  v_cvt_pk_bf16_f32 v137, v82, v83
  v_mfma_f32_32x32x16_bf16 v[112:127], v[24:27], a[68:71], v[112:127]
  s_waitcnt lgkmcnt(5)
  buffer_load_dwordx4 v20, s[12:15], s19 offen lds
  v_mul_f32 v84, s24, v84
  v_mul_f32 v85, s24, v85
  v_mfma_f32_32x32x16_bf16 v[96:111], v[28:31], a[72:75], v[96:111]
  ds_read_b128 v[52:55], v15 offset:40960
  v_cvt_pk_bf16_f32 v138, v84, v85
  v_mul_f32 v86, s24, v86
  v_mfma_f32_32x32x16_bf16 v[112:127], v[28:31], a[76:79], v[112:127]
  s_waitcnt lgkmcnt(5)
  v_mul_f32 v87, s24, v87
  v_cvt_pk_bf16_f32 v139, v86, v87
  v_mfma_f32_32x32x16_bf16 v[96:111], v[32:35], a[80:83], v[96:111]
  s_add_u32 m0, s25, 5120
  ds_read_b128 v[24:27], v8 offset:49152
  v_mul_f32 v88, s24, v88
  v_mul_f32 v89, s24, v89
  v_mfma_f32_32x32x16_bf16 v[112:127], v[32:35], a[84:87], v[112:127]
  s_waitcnt lgkmcnt(5)
  buffer_load_dwordx4 v21, s[12:15], s19 offen lds
  v_cvt_pk_bf16_f32 v140, v88, v89
  v_mul_f32 v90, s24, v90
  v_mfma_f32_32x32x16_bf16 v[96:111], v[36:39], a[88:91], v[96:111]
  ds_read_b128 v[28:31], v9 offset:49152
  v_mul_f32 v91, s24, v91
  v_cvt_pk_bf16_f32 v141, v90, v91
  v_mfma_f32_32x32x16_bf16 v[112:127], v[36:39], a[92:95], v[112:127]
  s_waitcnt lgkmcnt(5)
  v_mul_f32 v92, s24, v92
  v_mul_f32 v93, s24, v93
  v_mfma_f32_32x32x16_bf16 v[96:111], v[40:43], a[96:99], v[96:111]
  s_add_u32 m0, s25, 6144
  ds_read_b128 v[32:35], v10 offset:49152
  v_cvt_pk_bf16_f32 v142, v92, v93
  v_mul_f32 v94, s24, v94
  v_mfma_f32_32x32x16_bf16 v[112:127], v[40:43], a[100:103], v[112:127]
  s_waitcnt lgkmcnt(5)
  buffer_load_dwordx4 v22, s[12:15], s19 offen lds
  v_mul_f32 v95, s24, v95
  v_cvt_pk_bf16_f32 v143, v94, v95
  v_mfma_f32_32x32x16_bf16 v[96:111], v[44:47], a[104:107], v[96:111]
  ds_read_b128 v[36:39], v11 offset:49152
  v_mfma_f32_32x32x16_bf16 v[112:127], v[44:47], a[108:111], v[112:127]
  s_waitcnt lgkmcnt(5)
  v_mfma_f32_32x32x16_bf16 v[96:111], v[48:51], a[112:115], v[96:111]
  s_add_u32 m0, s25, 7168
  ds_read_b128 v[40:43], v12 offset:49152
  v_mfma_f32_32x32x16_bf16 v[112:127], v[48:51], a[116:119], v[112:127]
  s_waitcnt lgkmcnt(5)
  buffer_load_dwordx4 v23, s[12:15], s19 offen lds
  v_mfma_f32_32x32x16_bf16 v[96:111], v[52:55], a[120:123], v[96:111]
  s_cmp_gt_u32 s23, 3
  ds_read_b128 v[44:47], v13 offset:49152
  v_mfma_f32_32x32x16_bf16 v[112:127], v[52:55], a[124:127], v[112:127]
  s_waitcnt lgkmcnt(5)
  s_cselect_b32 s26, s20, 0
  v_mfma_f32_32x32x16_bf16 v[96:111], v[24:27], a[128:131], v[96:111]
  s_add_u32 s19, s19, s26
  ds_read_b128 v[48:51], v14 offset:49152
  v_mfma_f32_32x32x16_bf16 v[112:127], v[24:27], a[132:135], v[112:127]
  s_waitcnt lgkmcnt(5)
  s_add_u32 s25, s25, 32768
  v_mfma_f32_32x32x16_bf16 v[96:111], v[28:31], a[136:139], v[96:111]
  s_and_b32 s25, s25, 0x1ffff
  ds_read_b128 v[52:55], v15 offset:49152
  v_mfma_f32_32x32x16_bf16 v[112:127], v[28:31], a[140:143], v[112:127]
  s_waitcnt lgkmcnt(5)
  buffer_store_dwordx4 v[128:131], v7, s[4:7], s21 offen offset:0 sc1
  v_mfma_f32_32x32x16_bf16 v[96:111], v[32:35], a[144:147], v[96:111]
  ds_read_b128 v[24:27], v8 offset:57344
  v_mfma_f32_32x32x16_bf16 v[112:127], v[32:35], a[148:151], v[112:127]
  s_waitcnt lgkmcnt(5)
  v_xor_b32 v8, 0x10000, v8
  v_mfma_f32_32x32x16_bf16 v[96:111], v[36:39], a[152:155], v[96:111]
  ds_read_b128 v[28:31], v9 offset:57344
  v_mfma_f32_32x32x16_bf16 v[112:127], v[36:39], a[156:159], v[112:127]
  s_waitcnt lgkmcnt(5)
  buffer_store_dwordx4 v[132:135], v7, s[4:7], s21 offen offset:1024 sc1
  v_xor_b32 v9, 0x10000, v9
  v_mfma_f32_32x32x16_bf16 v[96:111], v[40:43], a[160:163], v[96:111]
  ds_read_b128 v[32:35], v10 offset:57344
  v_mfma_f32_32x32x16_bf16 v[112:127], v[40:43], a[164:167], v[112:127]
  s_waitcnt lgkmcnt(5)
  v_xor_b32 v10, 0x10000, v10
  v_mfma_f32_32x32x16_bf16 v[96:111], v[44:47], a[168:171], v[96:111]
  ds_read_b128 v[36:39], v11 offset:57344
  v_mfma_f32_32x32x16_bf16 v[112:127], v[44:47], a[172:175], v[112:127]
  s_waitcnt lgkmcnt(5)
  buffer_store_dwordx4 v[136:139], v7, s[4:7], s21 offen offset:2048 sc1
  v_xor_b32 v11, 0x10000, v11
  v_mfma_f32_32x32x16_bf16 v[96:111], v[48:51], a[176:179], v[96:111]
  ds_read_b128 v[40:43], v12 offset:57344
  v_mfma_f32_32x32x16_bf16 v[112:127], v[48:51], a[180:183], v[112:127]
  s_waitcnt lgkmcnt(5)
  v_xor_b32 v12, 0x10000, v12
  v_mfma_f32_32x32x16_bf16 v[96:111], v[52:55], a[184:187], v[96:111]
  ds_read_b128 v[44:47], v13 offset:57344
  v_mfma_f32_32x32x16_bf16 v[112:127], v[52:55], a[188:191], v[112:127]
  s_waitcnt lgkmcnt(5)
  buffer_store_dwordx4 v[140:143], v7, s[4:7], s21 offen offset:3072 sc1
  v_xor_b32 v13, 0x10000, v13
  v_mfma_f32_32x32x16_bf16 v[96:111], v[24:27], a[192:195], v[96:111]
  s_mov_b32 s21, s27
  ds_read_b128 v[48:51], v14 offset:57344
  v_mov_b32 v7, v2
  v_mfma_f32_32x32x16_bf16 v[112:127], v[24:27], a[196:199], v[112:127]
  s_waitcnt lgkmcnt(5)
  v_xor_b32 v14, 0x10000, v14
  v_mfma_f32_32x32x16_bf16 v[96:111], v[28:31], a[200:203], v[96:111]
  s_add_u32 s27, s27, s22
  ds_read_b128 v[52:55], v15 offset:57344
  v_mfma_f32_32x32x16_bf16 v[112:127], v[28:31], a[204:207], v[112:127]
  s_waitcnt lgkmcnt(5)
  s_waitcnt vmcnt(17)
  s_barrier
  v_xor_b32 v15, 0x10000, v15
  v_mfma_f32_32x32x16_bf16 v[96:111], v[32:35], a[208:211], v[96:111]
  ds_read_b128 v[24:27], v8 offset:0
  v_mfma_f32_32x32x16_bf16 v[112:127], v[32:35], a[212:215], v[112:127]
  s_waitcnt lgkmcnt(5)
  v_mfma_f32_32x32x16_bf16 v[96:111], v[36:39], a[216:219], v[96:111]
  s_add_u32 s29, s29, 1
  ds_read_b128 v[28:31], v9 offset:0
  v_mfma_f32_32x32x16_bf16 v[112:127], v[36:39], a[220:223], v[112:127]
  s_waitcnt lgkmcnt(5)
  s_max_i32 s30, s29, 0
  v_mov_b32 v144, s30
  v_mfma_f32_32x32x16_bf16 v[96:111], v[40:43], a[224:227], v[96:111]
  ds_read_b128 v[32:35], v10 offset:0
  v_mfma_f32_32x32x16_bf16 v[112:127], v[40:43], a[228:231], v[112:127]
  s_waitcnt lgkmcnt(5)
  buffer_store_dword v144, v145, s[4:7], s31 offen sc1
  v_mfma_f32_32x32x16_bf16 v[96:111], v[44:47], a[232:235], v[96:111]
  ds_read_b128 v[36:39], v11 offset:0
  v_mfma_f32_32x32x16_bf16 v[112:127], v[44:47], a[236:239], v[112:127]
  s_waitcnt lgkmcnt(5)
  v_mfma_f32_32x32x16_bf16 v[96:111], v[48:51], a[240:243], v[96:111]
  s_sub_u32 s23, s23, 1
  ds_read_b128 v[40:43], v12 offset:0
  v_mfma_f32_32x32x16_bf16 v[112:127], v[48:51], a[244:247], v[112:127]
  s_waitcnt lgkmcnt(5)
  v_mfma_f32_32x32x16_bf16 v[96:111], v[52:55], a[248:251], v[96:111]
  s_cmp_eq_u32 s23, 0
  ds_read_b128 v[44:47], v13 offset:0
  v_mfma_f32_32x32x16_bf16 v[112:127], v[52:55], a[252:255], v[112:127]
  s_cbranch_scc1 G_done1_9
  s_branch G_top_7
G_done0_8:
  s_nop 7
  s_nop 3
  v_mul_f32 v64, s24, v64
  v_mul_f32 v65, s24, v65
  v_cvt_pk_bf16_f32 v128, v64, v65
  v_mul_f32 v66, s24, v66
  v_mul_f32 v67, s24, v67
  v_cvt_pk_bf16_f32 v129, v66, v67
  v_mul_f32 v68, s24, v68
  v_mul_f32 v69, s24, v69
  v_cvt_pk_bf16_f32 v130, v68, v69
  v_mul_f32 v70, s24, v70
  v_mul_f32 v71, s24, v71
  v_cvt_pk_bf16_f32 v131, v70, v71
  buffer_store_dwordx4 v[128:131], v7, s[4:7], s21 offen offset:0 sc1
  v_mul_f32 v72, s24, v72
  v_mul_f32 v73, s24, v73
  v_cvt_pk_bf16_f32 v132, v72, v73
  v_mul_f32 v74, s24, v74
  v_mul_f32 v75, s24, v75
  v_cvt_pk_bf16_f32 v133, v74, v75
  v_mul_f32 v76, s24, v76
  v_mul_f32 v77, s24, v77
  v_cvt_pk_bf16_f32 v134, v76, v77
  v_mul_f32 v78, s24, v78
  v_mul_f32 v79, s24, v79
  v_cvt_pk_bf16_f32 v135, v78, v79
  buffer_store_dwordx4 v[132:135], v7, s[4:7], s21 offen offset:1024 sc1
  v_mul_f32 v80, s24, v80
  v_mul_f32 v81, s24, v81
  v_cvt_pk_bf16_f32 v136, v80, v81
  v_mul_f32 v82, s24, v82
  v_mul_f32 v83, s24, v83
  v_cvt_pk_bf16_f32 v137, v82, v83
  v_mul_f32 v84, s24, v84
  v_mul_f32 v85, s24, v85
  v_cvt_pk_bf16_f32 v138, v84, v85
  v_mul_f32 v86, s24, v86
  v_mul_f32 v87, s24, v87
  v_cvt_pk_bf16_f32 v139, v86, v87
  buffer_store_dwordx4 v[136:139], v7, s[4:7], s21 offen offset:2048 sc1
  v_mul_f32 v88, s24, v88
  v_mul_f32 v89, s24, v89
  v_cvt_pk_bf16_f32 v140, v88, v89
  v_mul_f32 v90, s24, v90
  v_mul_f32 v91, s24, v91
  v_cvt_pk_bf16_f32 v141, v90, v91
  v_mul_f32 v92, s24, v92
  v_mul_f32 v93, s24, v93
  v_cvt_pk_bf16_f32 v142, v92, v93
  v_mul_f32 v94, s24, v94
  v_mul_f32 v95, s24, v95
  v_cvt_pk_bf16_f32 v143, v94, v95
  buffer_store_dwordx4 v[140:143], v7, s[4:7], s21 offen offset:3072 sc1
  s_branch G_fin_10
G_done1_9:
  s_nop 7
  s_nop 3
  v_mul_f32 v96, s24, v96
  v_mul_f32 v97, s24, v97
  v_cvt_pk_bf16_f32 v128, v96, v97
  v_mul_f32 v98, s24, v98
  v_mul_f32 v99, s24, v99
  v_cvt_pk_bf16_f32 v129, v98, v99
  v_mul_f32 v100, s24, v100
  v_mul_f32 v101, s24, v101
  v_cvt_pk_bf16_f32 v130, v100, v101
  v_mul_f32 v102, s24, v102
  v_mul_f32 v103, s24, v103
  v_cvt_pk_bf16_f32 v131, v102, v103
  buffer_store_dwordx4 v[128:131], v7, s[4:7], s21 offen offset:0 sc1
  v_mul_f32 v104, s24, v104
  v_mul_f32 v105, s24, v105
  v_cvt_pk_bf16_f32 v132, v104, v105
  v_mul_f32 v106, s24, v106
  v_mul_f32 v107, s24, v107
  v_cvt_pk_bf16_f32 v133, v106, v107
  v_mul_f32 v108, s24, v108
  v_mul_f32 v109, s24, v109
  v_cvt_pk_bf16_f32 v134, v108, v109
  v_mul_f32 v110, s24, v110
  v_mul_f32 v111, s24, v111
  v_cvt_pk_bf16_f32 v135, v110, v111
  buffer_store_dwordx4 v[132:135], v7, s[4:7], s21 offen offset:1024 sc1
  v_mul_f32 v112, s24, v112
  v_mul_f32 v113, s24, v113
  v_cvt_pk_bf16_f32 v136, v112, v113
  v_mul_f32 v114, s24, v114
  v_mul_f32 v115, s24, v115
  v_cvt_pk_bf16_f32 v137, v114, v115
  v_mul_f32 v116, s24, v116
  v_mul_f32 v117, s24, v117
  v_cvt_pk_bf16_f32 v138, v116, v117
  v_mul_f32 v118, s24, v118
  v_mul_f32 v119, s24, v119
  v_cvt_pk_bf16_f32 v139, v118, v119
  buffer_store_dwordx4 v[136:139], v7, s[4:7], s21 offen offset:2048 sc1
  v_mul_f32 v120, s24, v120
  v_mul_f32 v121, s24, v121
  v_cvt_pk_bf16_f32 v140, v120, v121
  v_mul_f32 v122, s24, v122
  v_mul_f32 v123, s24, v123
  v_cvt_pk_bf16_f32 v141, v122, v123
  v_mul_f32 v124, s24, v124
  v_mul_f32 v125, s24, v125
  v_cvt_pk_bf16_f32 v142, v124, v125
  v_mul_f32 v126, s24, v126
  v_mul_f32 v127, s24, v127
  v_cvt_pk_bf16_f32 v143, v126, v127
  buffer_store_dwordx4 v[140:143], v7, s[4:7], s21 offen offset:3072 sc1
G_fin_10:
  s_waitcnt vmcnt(0) lgkmcnt(0)
  s_barrier
  s_add_u32 s30, s29, 3
  v_mov_b32 v144, s30
  v_min_u32 v145, 1, v0
  v_lshlrev_b32 v145, 30, v145
  buffer_store_dword v144, v145, s[4:7], s31 offen sc1
P_end_2:
  s_mov_b32 s71, 0
  s_branch M_sg_12
M_sw_11:
  s_sleep 8
  s_add_u32 s71, s71, 1
  s_cmp_gt_u32 s71, 262144
  s_cbranch_scc1 M_exit
M_sg_12:
  s_mov_b32 s79, 0
  s_atomic_or s79, s[74:75], 128 glc
  s_waitcnt lgkmcnt(0)
  s_cmp_lt_u32 s79, 256
  s_cbranch_scc1 M_sw_11
  s_cmp_eq_u32 s65, 6
  s_cbranch_scc1 M_follow
  s_mov_b32 s68, 0
  s_mov_b32 s36, -1
  s_mov_b32 s69, s53
  s_mov_b32 s70, s54
  s_load_dwordx2 s[8:9], s[0:1], 40
  s_mul_i32 s76, s64, 6
  s_add_u32 s76, s76, s65
  s_mul_i32 s76, s76, 21888
  v_min_u32 v200, 170, v0
  v_lshl_add_u32 v200, v200, 7, s76
  s_waitcnt lgkmcnt(0)
  s_and_b32 s9, s9, 0xffff
  s_mov_b32 s10, 4194304
  s_mov_b32 s11, 0x20000
M_att:
  s_mov_b32 s24, 0xf149f2ca
  s_mov_b32 s29, 0
  v_mov_b32 v6, 0
  v_mov_b32 v7, 0
  s_lshl_b32 s26, s16, 11
  v_add_u32 v3, s26, v2
  v_and_b32 v5, 31, v1
  v_lshrrev_b32 v12, 5, v1
  v_lshlrev_b32 v12, 2, v12
  v_sub_u32 v5, v5, v12
  s_lshl_b32 s26, s64, 19
  s_add_u32 s19, s26, 16777216
  s_add_u32 s20, s26, 33554432
  s_lshl_b32 s27, s69, 2
  s_add_u32 s27, s27, s16
  s_lshl_b32 s27, s27, 14
  s_add_u32 s25, s26, s27
  s_bfe_u32 s78, s70, 0x80000
  s_add_u32 s76, s67, 512
  s_mov_b32 s71, 0
  s_branch M_sg_14
M_sw_13:
  s_sleep 8
  s_add_u32 s71, s71, 1
  s_cmp_gt_u32 s71, 262144
  s_cbranch_scc1 M_exit
M_sg_14:
  s_mov_b32 s79, 0
  s_atomic_or s79, s[72:73], s76 glc
  s_waitcnt lgkmcnt(0)
  s_cmp_lt_u32 s79, s78
  s_cbranch_scc1 M_sw_13
  s_bfe_u32 s78, s70, 0x80008
  s_add_u32 s76, s67, 640
  s_mov_b32 s71, 0
  s_branch M_sg_16
M_sw_15:
  s_sleep 8
  s_add_u32 s71, s71, 1
  s_cmp_gt_u32 s71, 262144
  s_cbranch_scc1 M_exit
M_sg_16:
  s_mov_b32 s79, 0
  s_atomic_or s79, s[72:73], s76 glc
  s_waitcnt lgkmcnt(0)
  s_cmp_lt_u32 s79, s78
  s_cbranch_scc1 M_sw_15
  s_lshl_b32 s27, s69, 16
  s_add_u32 s27, s27, 16384
  s_add_u32 s17, s19, s27
M_kv_17:
  s_cmp_ge_u32 s17, s36
  s_cbranch_scc1 M_kvok_18
  s_mov_b32 s76, 0
  s_mov_b32 s78, 23
  s_mov_b32 s77, 335872
  s_cmp_eq_u32 s68, 1
  s_cmov_b32 s76, 128
  s_cmov_b32 s78, 27
  s_cmov_b32 s77, 114688
  s_cmp_eq_u32 s68, 2
  s_cmov_b32 s76, 768
  s_cmov_b32 s78, 14
  s_cmov_b32 s77, 0
  s_add_u32 s76, s76, s67
  s_mov_b32 s71, 0
  s_branch M_sg_20
M_sw_19:
  s_sleep 8
  s_add_u32 s71, s71, 1
  s_cmp_gt_u32 s71, 262144
  s_cbranch_scc1 M_exit
M_sg_20:
  s_mov_b32 s79, 0
  s_atomic_or s79, s[72:73], s76 glc
  s_waitcnt lgkmcnt(0)
  s_cmp_lt_u32 s79, s78
  s_cbranch_scc1 M_sw_19
  s_add_u32 s36, s77, s19
  s_add_u32 s68, s68, 1
  s_branch M_kv_17
M_kvok_18:
  s_add_u32 s28, s25, 0
  buffer_load_dwordx4 a[128:131], v2, s[4:7], s28 offen offset:0 sc1
  buffer_load_dwordx4 a[132:135], v2, s[4:7], s28 offen offset:1024 sc1
  buffer_load_dwordx4 a[136:139], v2, s[4:7], s28 offen offset:2048 sc1
  buffer_load_dwordx4 a[140:143], v2, s[4:7], s28 offen offset:3072 sc1
  s_add_u32 s28, s25, 4096
  buffer_load_dwordx4 a[144:147], v2, s[4:7], s28 offen offset:0 sc1
  buffer_load_dwordx4 a[148:151], v2, s[4:7], s28 offen offset:1024 sc1
  buffer_load_dwordx4 a[152:155], v2, s[4:7], s28 offen offset:2048 sc1
  buffer_load_dwordx4 a[156:159], v2, s[4:7], s28 offen offset:3072 sc1
  s_add_u32 s28, s25, 8192
  buffer_load_dwordx4 a[160:163], v2, s[4:7], s28 offen offset:0 sc1
  buffer_load_dwordx4 a[164:167], v2, s[4:7], s28 offen offset:1024 sc1
  buffer_load_dwordx4 a[168:171], v2, s[4:7], s28 offen offset:2048 sc1
  buffer_load_dwordx4 a[172:175], v2, s[4:7], s28 offen offset:3072 sc1
  s_add_u32 s28, s25, 12288
  buffer_load_dwordx4 a[176:179], v2, s[4:7], s28 offen offset:0 sc1
  buffer_load_dwordx4 a[180:183], v2, s[4:7], s28 offen offset:1024 sc1
  buffer_load_dwordx4 a[184:187], v2, s[4:7], s28 offen offset:2048 sc1
  buffer_load_dwordx4 a[188:191], v2, s[4:7], s28 offen offset:3072 sc1
A_again_21:
  s_lshl_b32 s27, s69, 16
  s_add_u32 s27, s27, 57344
  s_add_u32 s17, s19, s27
  s_add_u32 s18, s20, s27
  s_lshl_b32 s21, s16, 11
  s_mov_b32 m0, s21
  s_nop 0
  buffer_load_dwordx4 v3, s[4:7], s18 offen offset:0 sc1 lds
  buffer_load_dwordx4 v3, s[4:7], s18 offen offset:1024 sc1 lds
  s_add_u32 m0, s21, 8192
  s_nop 0
  buffer_load_dwordx4 v3, s[4:7], s17 offen offset:0 sc1 lds
  buffer_load_dwordx4 v3, s[4:7], s17 offen offset:1024 sc1 lds
  s_add_u32 s18, s18, 8192
  s_sub_u32 s18, s18, 8192
  s_max_i32 s18, s18, s20
  s_sub_u32 s17, s17, 8192
  s_max_i32 s17, s17, s19
  s_add_u32 s21, s21, 16384
  s_and_b32 s21, s21, 131071
  s_mov_b32 m0, s21
  s_nop 0
  buffer_load_dwordx4 v3, s[4:7], s18 offen offset:0 sc1 lds
  buffer_load_dwordx4 v3, s[4:7], s18 offen offset:1024 sc1 lds
  s_add_u32 m0, s21, 8192
  s_nop 0
  buffer_load_dwordx4 v3, s[4:7], s17 offen offset:0 sc1 lds
  buffer_load_dwordx4 v3, s[4:7], s17 offen offset:1024 sc1 lds
  s_sub_u32 s18, s18, 8192
  s_max_i32 s18, s18, s20
  s_sub_u32 s17, s17, 8192
  s_max_i32 s17, s17, s19
  s_add_u32 s21, s21, 16384
  s_and_b32 s21, s21, 131071
  s_mov_b32 m0, s21
  s_nop 0
  buffer_load_dwordx4 v3, s[4:7], s18 offen offset:0 sc1 lds
  buffer_load_dwordx4 v3, s[4:7], s18 offen offset:1024 sc1 lds
  s_add_u32 m0, s21, 8192
  s_nop 0
  buffer_load_dwordx4 v3, s[4:7], s17 offen offset:0 sc1 lds
  buffer_load_dwordx4 v3, s[4:7], s17 offen offset:1024 sc1 lds
  s_sub_u32 s18, s18, 8192
  s_max_i32 s18, s18, s20
  s_sub_u32 s17, s17, 8192
  s_max_i32 s17, s17, s19
  s_add_u32 s21, s21, 16384
  s_and_b32 s21, s21, 131071
  s_mov_b32 m0, s21
  s_nop 0
  buffer_load_dwordx4 v3, s[4:7], s18 offen offset:0 sc1 lds
  buffer_load_dwordx4 v3, s[4:7], s18 offen offset:1024 sc1 lds
  s_add_u32 m0, s21, 8192
  s_nop 0
  buffer_load_dwordx4 v3, s[4:7], s17 offen offset:0 sc1 lds
  buffer_load_dwordx4 v3, s[4:7], s17 offen offset:1024 sc1 lds
  s_sub_u32 s18, s18, 8192
  s_max_i32 s18, s18, s20
  s_sub_u32 s17, s17, 8192
  s_max_i32 s17, s17, s19
  s_add_u32 s21, s21, 16384
  s_and_b32 s21, s21, 131071
  s_mov_b32 m0, s21
  s_nop 0
  buffer_load_dwordx4 v3, s[4:7], s18 offen offset:0 sc1 lds
  buffer_load_dwordx4 v3, s[4:7], s18 offen offset:1024 sc1 lds
  s_add_u32 m0, s21, 8192
  s_nop 0
  buffer_load_dwordx4 v3, s[4:7], s17 offen offset:0 sc1 lds
  buffer_load_dwordx4 v3, s[4:7], s17 offen offset:1024 sc1 lds
  s_sub_u32 s18, s18, 8192
  s_max_i32 s18, s18, s20
  s_sub_u32 s17, s17, 8192
  s_max_i32 s17, s17, s19
  s_add_u32 s21, s21, 16384
  s_and_b32 s21, s21, 131071
  s_mov_b32 m0, s21
  s_nop 0
  buffer_load_dwordx4 v3, s[4:7], s18 offen offset:0 sc1 lds
  buffer_load_dwordx4 v3, s[4:7], s18 offen offset:1024 sc1 lds
  s_add_u32 m0, s21, 8192
  s_nop 0
  buffer_load_dwordx4 v3, s[4:7], s17 offen offset:0 sc1 lds
  buffer_load_dwordx4 v3, s[4:7], s17 offen offset:1024 sc1 lds
  v_accvgpr_write_b32 a0, 0
  v_accvgpr_write_b32 a1, 0
  v_accvgpr_write_b32 a2, 0
  v_accvgpr_write_b32 a3, 0
  v_accvgpr_write_b32 a4, 0
  v_accvgpr_write_b32 a5, 0
  v_accvgpr_write_b32 a6, 0
  v_accvgpr_write_b32 a7, 0
  v_accvgpr_write_b32 a8, 0
  v_accvgpr_write_b32 a9, 0
  v_accvgpr_write_b32 a10, 0
  v_accvgpr_write_b32 a11, 0
  v_accvgpr_write_b32 a12, 0
  v_accvgpr_write_b32 a13, 0
  v_accvgpr_write_b32 a14, 0
  v_accvgpr_write_b32 a15, 0
  v_accvgpr_write_b32 a16, 0
  v_accvgpr_write_b32 a17, 0
  v_accvgpr_write_b32 a18, 0
  v_accvgpr_write_b32 a19, 0
  v_accvgpr_write_b32 a20, 0
  v_accvgpr_write_b32 a21, 0
  v_accvgpr_write_b32 a22, 0
  v_accvgpr_write_b32 a23, 0
  v_accvgpr_write_b32 a24, 0
  v_accvgpr_write_b32 a25, 0
  v_accvgpr_write_b32 a26, 0
  v_accvgpr_write_b32 a27, 0
  v_accvgpr_write_b32 a28, 0
  v_accvgpr_write_b32 a29, 0
  v_accvgpr_write_b32 a30, 0
  v_accvgpr_write_b32 a31, 0
  v_accvgpr_write_b32 a32, 0
  v_accvgpr_write_b32 a33, 0
  v_accvgpr_write_b32 a34, 0
  v_accvgpr_write_b32 a35, 0
  v_accvgpr_write_b32 a36, 0
  v_accvgpr_write_b32 a37, 0
  v_accvgpr_write_b32 a38, 0
  v_accvgpr_write_b32 a39, 0
  v_accvgpr_write_b32 a40, 0
  v_accvgpr_write_b32 a41, 0
  v_accvgpr_write_b32 a42, 0
  v_accvgpr_write_b32 a43, 0
  v_accvgpr_write_b32 a44, 0
  v_accvgpr_write_b32 a45, 0
  v_accvgpr_write_b32 a46, 0
  v_accvgpr_write_b32 a47, 0
  v_accvgpr_write_b32 a48, 0
  v_accvgpr_write_b32 a49, 0
  v_accvgpr_write_b32 a50, 0
  v_accvgpr_write_b32 a51, 0
  v_accvgpr_write_b32 a52, 0
  v_accvgpr_write_b32 a53, 0
  v_accvgpr_write_b32 a54, 0
  v_accvgpr_write_b32 a55, 0
  v_accvgpr_write_b32 a56, 0
  v_accvgpr_write_b32 a57, 0
  v_accvgpr_write_b32 a58, 0
  v_accvgpr_write_b32 a59, 0
  v_accvgpr_write_b32 a60, 0
  v_accvgpr_write_b32 a61, 0
  v_accvgpr_write_b32 a62, 0
  v_accvgpr_write_b32 a63, 0
  v_accvgpr_write_b32 a64, 0
  v_accvgpr_write_b32 a65, 0
  v_accvgpr_write_b32 a66, 0
  v_accvgpr_write_b32 a67, 0
  v_accvgpr_write_b32 a68, 0
  v_accvgpr_write_b32 a69, 0
  v_accvgpr_write_b32 a70, 0
  v_accvgpr_write_b32 a71, 0
  v_accvgpr_write_b32 a72, 0
  v_accvgpr_write_b32 a73, 0
  v_accvgpr_write_b32 a74, 0
  v_accvgpr_write_b32 a75, 0
  v_accvgpr_write_b32 a76, 0
  v_accvgpr_write_b32 a77, 0
  v_accvgpr_write_b32 a78, 0
  v_accvgpr_write_b32 a79, 0
  v_accvgpr_write_b32 a80, 0
  v_accvgpr_write_b32 a81, 0
  v_accvgpr_write_b32 a82, 0
  v_accvgpr_write_b32 a83, 0
  v_accvgpr_write_b32 a84, 0
  v_accvgpr_write_b32 a85, 0
  v_accvgpr_write_b32 a86, 0
  v_accvgpr_write_b32 a87, 0
  v_accvgpr_write_b32 a88, 0
  v_accvgpr_write_b32 a89, 0
  v_accvgpr_write_b32 a90, 0
  v_accvgpr_write_b32 a91, 0
  v_accvgpr_write_b32 a92, 0
  v_accvgpr_write_b32 a93, 0
  v_accvgpr_write_b32 a94, 0
  v_accvgpr_write_b32 a95, 0
  v_accvgpr_write_b32 a96, 0
  v_accvgpr_write_b32 a97, 0
  v_accvgpr_write_b32 a98, 0
  v_accvgpr_write_b32 a99, 0
  v_accvgpr_write_b32 a100, 0
  v_accvgpr_write_b32 a101, 0
  v_accvgpr_write_b32 a102, 0
  v_accvgpr_write_b32 a103, 0
  v_accvgpr_write_b32 a104, 0
  v_accvgpr_write_b32 a105, 0
  v_accvgpr_write_b32 a106, 0
  v_accvgpr_write_b32 a107, 0
  v_accvgpr_write_b32 a108, 0
  v_accvgpr_write_b32 a109, 0
  v_accvgpr_write_b32 a110, 0
  v_accvgpr_write_b32 a111, 0
  v_accvgpr_write_b32 a112, 0
  v_accvgpr_write_b32 a113, 0
  v_accvgpr_write_b32 a114, 0
  v_accvgpr_write_b32 a115, 0
  v_accvgpr_write_b32 a116, 0
  v_accvgpr_write_b32 a117, 0
  v_accvgpr_write_b32 a118, 0
  v_accvgpr_write_b32 a119, 0
  v_accvgpr_write_b32 a120, 0
  v_accvgpr_write_b32 a121, 0
  v_accvgpr_write_b32 a122, 0
  v_accvgpr_write_b32 a123, 0
  v_accvgpr_write_b32 a124, 0
  v_accvgpr_write_b32 a125, 0
  v_accvgpr_write_b32 a126, 0
  v_accvgpr_write_b32 a127, 0
  v_mov_b32 v8, 0
  v_mov_b32 v9, 0
  v_mov_b32 v10, 0
  v_mov_b32 v11, 0
  v_mov_b32 v52, 0
  v_mov_b32 v53, 0
  v_mov_b32 v54, s24
  v_mov_b32 v55, s24
  v_mov_b32 v56, s24
  v_mov_b32 v57, s24
  v_mov_b32 v58, s24
  v_mov_b32 v59, s24
  v_mov_b32 v60, s24
  v_mov_b32 v61, s24
  v_mov_b32 v62, s24
  v_mov_b32 v63, s24
  v_mov_b32 v104, 0
  v_mov_b32 v105, 0
  v_mov_b32 v4, v2
  v_mov_b32 v64, s24
  v_mov_b32 v65, s24
  v_mov_b32 v66, s24
  v_mov_b32 v67, s24
  v_mov_b32 v68, s24
  v_mov_b32 v69, s24
  v_mov_b32 v70, s24
  v_mov_b32 v71, s24
  v_mov_b32 v72, s24
  v_mov_b32 v73, s24
  v_mov_b32 v74, s24
  v_mov_b32 v75, s24
  v_mov_b32 v76, s24
  v_mov_b32 v77, s24
  v_mov_b32 v78, s24
  v_mov_b32 v79, s24
  v_mov_b32 v12, s24
  v_cmp_le_i32 s[40:41], 0, v5
  v_cmp_le_i32 s[42:43], 1, v5
  v_cmp_le_i32 s[44:45], 2, v5
  v_cmp_le_i32 s[46:47], 3, v5
  v_cndmask_b32 v80, v12, v7, s[40:41]
  v_cndmask_b32 v81, v12, v7, s[42:43]
  v_cndmask_b32 v82, v12, v7, s[44:45]
  v_cndmask_b32 v83, v12, v7, s[46:47]
  v_cmp_le_i32 s[40:41], 8, v5
  v_cmp_le_i32 s[42:43], 9, v5
  v_cmp_le_i32 s[44:45], 10, v5
  v_cmp_le_i32 s[46:47], 11, v5
  v_cndmask_b32 v84, v12, v7, s[40:41]
  v_cndmask_b32 v85, v12, v7, s[42:43]
  v_cndmask_b32 v86, v12, v7, s[44:45]
  v_cndmask_b32 v87, v12, v7, s[46:47]
  v_cmp_le_i32 s[40:41], 16, v5
  v_cmp_le_i32 s[42:43], 17, v5
  v_cmp_le_i32 s[44:45], 18, v5
  v_cmp_le_i32 s[46:47], 19, v5
  v_cndmask_b32 v88, v12, v7, s[40:41]
  v_cndmask_b32 v89, v12, v7, s[42:43]
  v_cndmask_b32 v90, v12, v7, s[44:45]
  v_cndmask_b32 v91, v12, v7, s[46:47]
  v_cmp_le_i32 s[40:41], 24, v5
  v_cmp_le_i32 s[42:43], 25, v5
  v_cmp_le_i32 s[44:45], 26, v5
  v_cmp_le_i32 s[46:47], 27, v5
  v_cndmask_b32 v92, v12, v7, s[40:41]
  v_cndmask_b32 v93, v12, v7, s[42:43]
  v_cndmask_b32 v94, v12, v7, s[44:45]
  v_cndmask_b32 v95, v12, v7, s[46:47]
  s_lshl_b32 s22, s69, 3
  s_add_u32 s22, s22, 8
  s_lshl_b32 s26, s16, 1
  s_sub_u32 s23, 6, s26
  s_waitcnt vmcnt(20)
  s_barrier
  buffer_load_dword v201, v200, s[8:11], 0 offen
  s_cmp_eq_u32 s23, 0
  s_cbranch_scc1 A_go_23
A_idle_22:
  s_waitcnt vmcnt(16)
  s_barrier
  s_sub_u32 s18, s18, 8192
  s_max_i32 s18, s18, s20
  s_sub_u32 s17, s17, 8192
  s_max_i32 s17, s17, s19
  s_add_u32 s21, s21, 16384
  s_and_b32 s21, s21, 131071
M_kv_24:
  s_cmp_ge_u32 s17, s36
  s_cbranch_scc1 M_kvok_25
  s_mov_b32 s76, 0
  s_mov_b32 s78, 23
  s_mov_b32 s77, 335872
  s_cmp_eq_u32 s68, 1
  s_cmov_b32 s76, 128
  s_cmov_b32 s78, 27
  s_cmov_b32 s77, 114688
  s_cmp_eq_u32 s68, 2
  s_cmov_b32 s76, 768
  s_cmov_b32 s78, 14
  s_cmov_b32 s77, 0
  s_add_u32 s76, s76, s67
  s_mov_b32 s71, 0
  s_branch M_sg_27
M_sw_26:
  s_sleep 8
  s_add_u32 s71, s71, 1
  s_cmp_gt_u32 s71, 262144
  s_cbranch_scc1 M_exit
M_sg_27:
  s_mov_b32 s79, 0
  s_atomic_or s79, s[72:73], s76 glc
  s_waitcnt lgkmcnt(0)
  s_cmp_lt_u32 s79, s78
  s_cbranch_scc1 M_sw_26
  s_add_u32 s36, s77, s19
  s_add_u32 s68, s68, 1
  s_branch M_kv_24
M_kvok_25:
  s_mov_b32 m0, s21
  s_nop 0
  buffer_load_dwordx4 v3, s[4:7], s18 offen offset:0 sc1 lds
  buffer_load_dwordx4 v3, s[4:7], s18 offen offset:1024 sc1 lds
  s_add_u32 m0, s21, 8192
  s_nop 0
  buffer_load_dwordx4 v3, s[4:7], s17 offen offset:0 sc1 lds
  buffer_load_dwordx4 v3, s[4:7], s17 offen offset:1024 sc1 lds
  v_add_u32 v4, 16384, v4
  v_and_b32 v4, 131071, v4
  s_sub_u32 s22, s22, 1
  s_sub_u32 s23, s23, 1
  s_cmp_lg_u32 s23, 0
  s_cbranch_scc1 A_idle_22
A_go_23:
  ds_read_b128 a[224:227], v4 offset:0
  ds_read_b128 a[228:231], v4 offset:2048
  ds_read_b128 a[232:235], v4 offset:4096
  ds_read_b128 a[236:239], v4 offset:6144
  ds_read_b128 a[240:243], v4 offset:1024
  ds_read_b128 a[244:247], v4 offset:3072
  ds_read_b128 a[248:251], v4 offset:5120
  ds_read_b128 a[252:255], v4 offset:7168
  ds_read_b128 a[192:195], v4 offset:8192
  ds_read_b128 a[196:199], v4 offset:9216
  ds_read_b128 a[200:203], v4 offset:10240
  ds_read_b128 a[204:207], v4 offset:11264
  ds_read_b128 a[208:211], v4 offset:12288
  ds_read_b128 a[212:215], v4 offset:13312
  ds_read_b128 a[216:219], v4 offset:14336
  ds_read_b128 a[220:223], v4 offset:15360
  v_add_u32 v4, 16384, v4
  v_and_b32 v4, 131071, v4
  s_waitcnt lgkmcnt(8)
.p2align 6
A_top_28:
  s_waitcnt lgkmcnt(7)
  v_mfma_f32_32x32x16_bf16 v[32:47], a[192:195], a[128:131], v[64:79]
  s_waitcnt lgkmcnt(6)
  v_exp_f32 v54, v54
  v_add_f32 v11, v11, v53
  v_cvt_pk_bf16_f32 v106, v52, v53
  v_mfma_f32_32x32x16_bf16 v[32:47], a[196:199], a[132:135], v[32:47]
  s_waitcnt lgkmcnt(4)
  v_exp_f32 v55, v55
  v_add_f32 v10, v10, v54
  v_mfma_f32_32x32x16_bf16 v[32:47], a[200:203], a[136:139], v[32:47]
  v_exp_f32 v56, v56
  v_add_f32 v11, v11, v55
  v_cvt_pk_bf16_f32 v107, v54, v55
  v_mfma_f32_32x32x16_bf16 v[32:47], a[204:207], a[140:143], v[32:47]
  s_waitcnt lgkmcnt(2)
  v_exp_f32 v57, v57
  v_add_f32 v10, v10, v56
  v_mfma_f32_32x32x16_bf16 v[32:47], a[208:211], a[144:147], v[32:47]
  v_exp_f32 v58, v58
  v_add_f32 v11, v11, v57
  v_cvt_pk_bf16_f32 v108, v56, v57
  v_mfma_f32_32x32x16_bf16 v[32:47], a[212:215], a[148:151], v[32:47]
  s_waitcnt lgkmcnt(0)
  v_exp_f32 v59, v59
  v_add_f32 v10, v10, v58
  v_mfma_f32_32x32x16_bf16 v[32:47], a[216:219], a[152:155], v[32:47]
  v_exp_f32 v60, v60
  v_add_f32 v11, v11, v59
  v_cvt_pk_bf16_f32 v109, v58, v59
  v_mfma_f32_32x32x16_bf16 v[32:47], a[220:223], a[156:159], v[32:47]
  s_waitcnt vmcnt(16)
  s_barrier
  v_exp_f32 v61, v61
  v_add_f32 v10, v10, v60
  v_mfma_f32_32x32x16_bf16 a[64:79], a[224:227], v[104:107], a[64:79]
  ds_read_b128 a[224:227], v4 offset:0
  v_exp_f32 v62, v62
  v_add_f32 v11, v11, v61
  v_cvt_pk_bf16_f32 v110, v60, v61
  v_mfma_f32_32x32x16_bf16 a[80:95], a[228:231], v[104:107], a[80:95]
  s_sub_u32 s18, s18, 8192
  ds_read_b128 a[228:231], v4 offset:2048
  v_exp_f32 v63, v63
  v_add_f32 v10, v10, v62
  v_mfma_f32_32x32x16_bf16 a[96:111], a[232:235], v[104:107], a[96:111]
  s_max_i32 s18, s18, s20
  ds_read_b128 a[232:235], v4 offset:4096
  v_exp_f32 v32, v32
  v_add_f32 v11, v11, v63
  v_cvt_pk_bf16_f32 v111, v62, v63
  v_mfma_f32_32x32x16_bf16 a[112:127], a[236:239], v[104:107], a[112:127]
  s_sub_u32 s17, s17, 8192
  ds_read_b128 a[236:239], v4 offset:6144
  v_exp_f32 v33, v33
  v_add_f32 v8, v8, v32
  v_mfma_f32_32x32x16_bf16 a[64:79], a[240:243], v[108:111], a[64:79]
  s_max_i32 s17, s17, s19
  ds_read_b128 a[240:243], v4 offset:1024
  v_exp_f32 v34, v34
  v_add_f32 v9, v9, v33
  v_cvt_pk_bf16_f32 v96, v32, v33
  v_mfma_f32_32x32x16_bf16 a[80:95], a[244:247], v[108:111], a[80:95]
  s_add_u32 s21, s21, 16384
  ds_read_b128 a[244:247], v4 offset:3072
  v_exp_f32 v35, v35
  v_add_f32 v8, v8, v34
  v_mfma_f32_32x32x16_bf16 a[96:111], a[248:251], v[108:111], a[96:111]
  s_and_b32 s21, s21, 131071
  ds_read_b128 a[248:251], v4 offset:5120
  v_exp_f32 v36, v36
  v_add_f32 v9, v9, v35
  v_cvt_pk_bf16_f32 v97, v34, v35
  v_mfma_f32_32x32x16_bf16 a[112:127], a[252:255], v[108:111], a[112:127]
  ds_read_b128 a[252:255], v4 offset:7168
  v_exp_f32 v37, v37
  v_add_f32 v8, v8, v36
  v_mfma_f32_32x32x16_bf16 v[48:63], a[192:195], a[160:163], v[80:95]
  s_add_u32 s23, s23, 1
  ds_read_b128 a[192:195], v4 offset:8192
  v_exp_f32 v38, v38
  v_add_f32 v9, v9, v37
  v_cvt_pk_bf16_f32 v98, v36, v37
  v_mfma_f32_32x32x16_bf16 v[48:63], a[196:199], a[164:167], v[48:63]
  s_sub_u32 s22, s22, 1
  ds_read_b128 a[196:199], v4 offset:9216
  v_exp_f32 v39, v39
  v_add_f32 v8, v8, v38
  v_mfma_f32_32x32x16_bf16 v[48:63], a[200:203], a[168:171], v[48:63]
  s_cmp_lt_u32 s23, 3
  ds_read_b128 a[200:203], v4 offset:10240
  v_exp_f32 v40, v40
  v_add_f32 v9, v9, v39
  v_cvt_pk_bf16_f32 v99, v38, v39
  v_mfma_f32_32x32x16_bf16 v[48:63], a[204:207], a[172:175], v[48:63]
  s_cbranch_scc1 A_upd_29
A_back_30:
  ds_read_b128 a[204:207], v4 offset:11264
  v_exp_f32 v41, v41
  v_add_f32 v8, v8, v40
  v_mfma_f32_32x32x16_bf16 v[48:63], a[208:211], a[176:179], v[48:63]
  s_cmp_lt_u32 s17, s36
  ds_read_b128 a[208:211], v4 offset:12288
  v_exp_f32 v42, v42
  v_add_f32 v9, v9, v41
  v_cvt_pk_bf16_f32 v100, v40, v41
  v_mfma_f32_32x32x16_bf16 v[48:63], a[212:215], a[180:183], v[48:63]
  s_cbranch_scc1 A_kvw_32
A_kvb_33:
  ds_read_b128 a[212:215], v4 offset:13312
  v_exp_f32 v43, v43
  v_add_f32 v8, v8, v42
  v_mfma_f32_32x32x16_bf16 v[48:63], a[216:219], a[184:187], v[48:63]
  s_mov_b32 m0, s21
  ds_read_b128 a[216:219], v4 offset:14336
  v_exp_f32 v44, v44
  v_add_f32 v9, v9, v43
  v_cvt_pk_bf16_f32 v101, v42, v43
  v_mfma_f32_32x32x16_bf16 v[48:63], a[220:223], a[188:191], v[48:63]
  s_waitcnt lgkmcnt(13)
  ds_read_b128 a[220:223], v4 offset:15360
  v_exp_f32 v45, v45
  v_add_f32 v8, v8, v44
  v_mfma_f32_32x32x16_bf16 a[0:15], a[224:227], v[96:99], a[0:15]
  buffer_load_dwordx4 v3, s[4:7], s18 offen offset:0 sc1 lds
  v_exp_f32 v46, v46
  v_add_f32 v9, v9, v45
  v_cvt_pk_bf16_f32 v102, v44, v45
  v_mfma_f32_32x32x16_bf16 a[16:31], a[228:231], v[96:99], a[16:31]
  s_waitcnt lgkmcnt(12)
  v_exp_f32 v47, v47
  v_add_f32 v8, v8, v46
  v_add_u32 v4, 16384, v4
  v_mfma_f32_32x32x16_bf16 a[32:47], a[232:235], v[96:99], a[32:47]
  buffer_load_dwordx4 v3, s[4:7], s18 offen offset:1024 sc1 lds
  v_exp_f32 v48, v48
  v_add_f32 v9, v9, v47
  v_cvt_pk_bf16_f32 v103, v46, v47
  v_mfma_f32_32x32x16_bf16 a[48:63], a[236:239], v[96:99], a[48:63]
  s_waitcnt lgkmcnt(10)
  s_add_u32 m0, s21, 8192
  v_exp_f32 v49, v49
  v_add_f32 v10, v10, v48
  v_and_b32 v4, 131071, v4
  v_mfma_f32_32x32x16_bf16 a[0:15], a[240:243], v[100:103], a[0:15]
  buffer_load_dwordx4 v3, s[4:7], s17 offen offset:0 sc1 lds
  v_exp_f32 v50, v50
  v_add_f32 v11, v11, v49
  v_cvt_pk_bf16_f32 v104, v48, v49
  v_mfma_f32_32x32x16_bf16 a[16:31], a[244:247], v[100:103], a[16:31]
  s_waitcnt lgkmcnt(8)
  s_cmp_lg_u32 s22, 0
  v_exp_f32 v51, v51
  v_add_f32 v10, v10, v50
  v_mfma_f32_32x32x16_bf16 a[32:47], a[248:251], v[100:103], a[32:47]
  buffer_load_dwordx4 v3, s[4:7], s17 offen offset:1024 sc1 lds
  v_exp_f32 v52, v52
  v_add_f32 v11, v11, v51
  v_cvt_pk_bf16_f32 v105, v50, v51
  v_mfma_f32_32x32x16_bf16 a[48:63], a[252:255], v[100:103], a[48:63]
  v_exp_f32 v53, v53
  v_add_f32 v10, v10, v52
  s_cbranch_scc1 A_top_28
  v_exp_f32 v54, v54
  v_add_f32 v11, v11, v53
  v_cvt_pk_bf16_f32 v106, v52, v53
  v_exp_f32 v55, v55
  v_add_f32 v10, v10, v54
  v_exp_f32 v56, v56
  v_add_f32 v11, v11, v55
  v_cvt_pk_bf16_f32 v107, v54, v55
  v_exp_f32 v57, v57
  v_add_f32 v10, v10, v56
  v_exp_f32 v58, v58
  v_add_f32 v11, v11, v57
  v_cvt_pk_bf16_f32 v108, v56, v57
  v_exp_f32 v59, v59
  v_add_f32 v10, v10, v58
  v_exp_f32 v60, v60
  v_add_f32 v11, v11, v59
  v_cvt_pk_bf16_f32 v109, v58, v59
  v_exp_f32 v61, v61
  v_add_f32 v10, v10, v60
  v_exp_f32 v62, v62
  v_add_f32 v11, v11, v61
  v_cvt_pk_bf16_f32 v110, v60, v61
  v_exp_f32 v63, v63
  v_add_f32 v10, v10, v62
  v_add_f32 v11, v11, v63
  v_cvt_pk_bf16_f32 v111, v62, v63
  s_nop 1
  v_mfma_f32_32x32x16_bf16 a[64:79], a[224:227], v[104:107], a[64:79]
  v_mfma_f32_32x32x16_bf16 a[80:95], a[228:231], v[104:107], a[80:95]
  v_mfma_f32_32x32x16_bf16 a[96:111], a[232:235], v[104:107], a[96:111]
  v_mfma_f32_32x32x16_bf16 a[112:127], a[236:239], v[104:107], a[112:127]
  v_mfma_f32_32x32x16_bf16 a[64:79], a[240:243], v[108:111], a[64:79]
  v_mfma_f32_32x32x16_bf16 a[80:95], a[244:247], v[108:111], a[80:95]
  v_mfma_f32_32x32x16_bf16 a[96:111], a[248:251], v[108:111], a[96:111]
  v_mfma_f32_32x32x16_bf16 a[112:127], a[252:255], v[108:111], a[112:127]
  v_add_f32 v8, v8, v9
  v_mov_b32 v9, v8
  s_nop 1
  v_permlane32_swap_b32 v8, v9
  s_nop 1
  v_add_f32 v8, v8, v9
  v_add_f32 v10, v10, v11
  v_mov_b32 v11, v10
  s_nop 1
  v_permlane32_swap_b32 v10, v11
  s_nop 1
  v_add_f32 v10, v10, v11
  v_subrev_u32 v12, 0x2f800000, v8
  v_subrev_u32 v13, 0x2f800000, v10
  v_max_u32 v12, v12, v13
  v_cmp_le_u32 vcc, 0x28000000, v12
  s_nop 1
  s_cmp_lg_u64 vcc, 0
  s_cselect_b32 s26, 1, 0
  v_mov_b32 v12, s26
  s_lshl_b32 s26, s16, 2
  s_add_u32 s26, s26, 131072
  v_mov_b32 v13, s26
  ds_write_b32 v13, v12
  v_mov_b32 v14, 131072
  s_waitcnt vmcnt(0) lgkmcnt(0)
  s_barrier
  ds_read_b128 v[16:19], v14
  v_rcp_f32 v8, v8
  v_rcp_f32 v10, v10
  s_waitcnt lgkmcnt(0)
  v_or3_b32 v12, v16, v17, v18
  v_or_b32 v12, v12, v19
  s_nop 0
  v_readfirstlane_b32 s26, v12
  s_nop 1
  s_cmp_gt_u32 s26, s29
  s_cbranch_scc1 A_slow_34
  s_add_u32 s28, s25, 100663296
  v_accvgpr_read_b32 v112, a0
  v_accvgpr_read_b32 v113, a1
  v_accvgpr_read_b32 v114, a2
  v_accvgpr_read_b32 v115, a3
  v_accvgpr_read_b32 v116, a4
  v_accvgpr_read_b32 v117, a5
  v_accvgpr_read_b32 v118, a6
  v_accvgpr_read_b32 v119, a7
  v_pk_mul_f32 v[112:113], v[112:113], v[8:9] op_sel_hi:[1,0]
  v_pk_mul_f32 v[114:115], v[114:115], v[8:9] op_sel_hi:[1,0]
  v_pk_mul_f32 v[116:117], v[116:117], v[8:9] op_sel_hi:[1,0]
  v_pk_mul_f32 v[118:119], v[118:119], v[8:9] op_sel_hi:[1,0]
  v_cvt_pk_bf16_f32 v120, v112, v113
  v_cvt_pk_bf16_f32 v121, v114, v115
  v_cvt_pk_bf16_f32 v122, v116, v117
  v_cvt_pk_bf16_f32 v123, v118, v119
  buffer_store_dwordx4 v[120:123], v2, s[4:7], s28 offen offset:0 sc1
  v_accvgpr_read_b32 v124, a8
  v_accvgpr_read_b32 v125, a9
  v_accvgpr_read_b32 v126, a10
  v_accvgpr_read_b32 v127, a11
  v_accvgpr_read_b32 v128, a12
  v_accvgpr_read_b32 v129, a13
  v_accvgpr_read_b32 v130, a14
  v_accvgpr_read_b32 v131, a15
  v_pk_mul_f32 v[124:125], v[124:125], v[8:9] op_sel_hi:[1,0]
  v_pk_mul_f32 v[126:127], v[126:127], v[8:9] op_sel_hi:[1,0]
  v_pk_mul_f32 v[128:129], v[128:129], v[8:9] op_sel_hi:[1,0]
  v_pk_mul_f32 v[130:131], v[130:131], v[8:9] op_sel_hi:[1,0]
  v_cvt_pk_bf16_f32 v132, v124, v125
  v_cvt_pk_bf16_f32 v133, v126, v127
  v_cvt_pk_bf16_f32 v134, v128, v129
  v_cvt_pk_bf16_f32 v135, v130, v131
  buffer_store_dwordx4 v[132:135], v2, s[4:7], s28 offen offset:1024 sc1
  v_accvgpr_read_b32 v136, a16
  v_accvgpr_read_b32 v137, a17
  v_accvgpr_read_b32 v138, a18
  v_accvgpr_read_b32 v139, a19
  v_accvgpr_read_b32 v140, a20
  v_accvgpr_read_b32 v141, a21
  v_accvgpr_read_b32 v142, a22
  v_accvgpr_read_b32 v143, a23
  v_pk_mul_f32 v[136:137], v[136:137], v[8:9] op_sel_hi:[1,0]
  v_pk_mul_f32 v[138:139], v[138:139], v[8:9] op_sel_hi:[1,0]
  v_pk_mul_f32 v[140:141], v[140:141], v[8:9] op_sel_hi:[1,0]
  v_pk_mul_f32 v[142:143], v[142:143], v[8:9] op_sel_hi:[1,0]
  v_cvt_pk_bf16_f32 v144, v136, v137
  v_cvt_pk_bf16_f32 v145, v138, v139
  v_cvt_pk_bf16_f32 v146, v140, v141
  v_cvt_pk_bf16_f32 v147, v142, v143
  buffer_store_dwordx4 v[144:147], v2, s[4:7], s28 offen offset:2048 sc1
  v_accvgpr_read_b32 v148, a24
  v_accvgpr_read_b32 v149, a25
  v_accvgpr_read_b32 v150, a26
  v_accvgpr_read_b32 v151, a27
  v_accvgpr_read_b32 v152, a28
  v_accvgpr_read_b32 v153, a29
  v_accvgpr_read_b32 v154, a30
  v_accvgpr_read_b32 v155, a31
  v_pk_mul_f32 v[148:149], v[148:149], v[8:9] op_sel_hi:[1,0]
  v_pk_mul_f32 v[150:151], v[150:151], v[8:9] op_sel_hi:[1,0]
  v_pk_mul_f32 v[152:153], v[152:153], v[8:9] op_sel_hi:[1,0]
  v_pk_mul_f32 v[154:155], v[154:155], v[8:9] op_sel_hi:[1,0]
  v_cvt_pk_bf16_f32 v156, v148, v149
  v_cvt_pk_bf16_f32 v157, v150, v151
  v_cvt_pk_bf16_f32 v158, v152, v153
  v_cvt_pk_bf16_f32 v159, v154, v155
  buffer_store_dwordx4 v[156:159], v2, s[4:7], s28 offen offset:3072 sc1
  s_add_u32 s28, s25, 100667392
  v_accvgpr_read_b32 v112, a32
  v_accvgpr_read_b32 v113, a33
  v_accvgpr_read_b32 v114, a34
  v_accvgpr_read_b32 v115, a35
  v_accvgpr_read_b32 v116, a36
  v_accvgpr_read_b32 v117, a37
  v_accvgpr_read_b32 v118, a38
  v_accvgpr_read_b32 v119, a39
  v_pk_mul_f32 v[112:113], v[112:113], v[8:9] op_sel_hi:[1,0]
  v_pk_mul_f32 v[114:115], v[114:115], v[8:9] op_sel_hi:[1,0]
  v_pk_mul_f32 v[116:117], v[116:117], v[8:9] op_sel_hi:[1,0]
  v_pk_mul_f32 v[118:119], v[118:119], v[8:9] op_sel_hi:[1,0]
  v_cvt_pk_bf16_f32 v120, v112, v113
  v_cvt_pk_bf16_f32 v121, v114, v115
  v_cvt_pk_bf16_f32 v122, v116, v117
  v_cvt_pk_bf16_f32 v123, v118, v119
  buffer_store_dwordx4 v[120:123], v2, s[4:7], s28 offen offset:0 sc1
  v_accvgpr_read_b32 v124, a40
  v_accvgpr_read_b32 v125, a41
  v_accvgpr_read_b32 v126, a42
  v_accvgpr_read_b32 v127, a43
  v_accvgpr_read_b32 v128, a44
  v_accvgpr_read_b32 v129, a45
  v_accvgpr_read_b32 v130, a46
  v_accvgpr_read_b32 v131, a47
  v_pk_mul_f32 v[124:125], v[124:125], v[8:9] op_sel_hi:[1,0]
  v_pk_mul_f32 v[126:127], v[126:127], v[8:9] op_sel_hi:[1,0]
  v_pk_mul_f32 v[128:129], v[128:129], v[8:9] op_sel_hi:[1,0]
  v_pk_mul_f32 v[130:131], v[130:131], v[8:9] op_sel_hi:[1,0]
  v_cvt_pk_bf16_f32 v132, v124, v125
  v_cvt_pk_bf16_f32 v133, v126, v127
  v_cvt_pk_bf16_f32 v134, v128, v129
  v_cvt_pk_bf16_f32 v135, v130, v131
  buffer_store_dwordx4 v[132:135], v2, s[4:7], s28 offen offset:1024 sc1
  v_accvgpr_read_b32 v136, a48
  v_accvgpr_read_b32 v137, a49
  v_accvgpr_read_b32 v138, a50
  v_accvgpr_read_b32 v139, a51
  v_accvgpr_read_b32 v140, a52
  v_accvgpr_read_b32 v141, a53
  v_accvgpr_read_b32 v142, a54
  v_accvgpr_read_b32 v143, a55
  v_pk_mul_f32 v[136:137], v[136:137], v[8:9] op_sel_hi:[1,0]
  v_pk_mul_f32 v[138:139], v[138:139], v[8:9] op_sel_hi:[1,0]
  v_pk_mul_f32 v[140:141], v[140:141], v[8:9] op_sel_hi:[1,0]
  v_pk_mul_f32 v[142:143], v[142:143], v[8:9] op_sel_hi:[1,0]
  v_cvt_pk_bf16_f32 v144, v136, v137
  v_cvt_pk_bf16_f32 v145, v138, v139
  v_cvt_pk_bf16_f32 v146, v140, v141
  v_cvt_pk_bf16_f32 v147, v142, v143
  buffer_store_dwordx4 v[144:147], v2, s[4:7], s28 offen offset:2048 sc1
  v_accvgpr_read_b32 v148, a56
  v_accvgpr_read_b32 v149, a57
  v_accvgpr_read_b32 v150, a58
  v_accvgpr_read_b32 v151, a59
  v_accvgpr_read_b32 v152, a60
  v_accvgpr_read_b32 v153, a61
  v_accvgpr_read_b32 v154, a62
  v_accvgpr_read_b32 v155, a63
  v_pk_mul_f32 v[148:149], v[148:149], v[8:9] op_sel_hi:[1,0]
  v_pk_mul_f32 v[150:151], v[150:151], v[8:9] op_sel_hi:[1,0]
  v_pk_mul_f32 v[152:153], v[152:153], v[8:9] op_sel_hi:[1,0]
  v_pk_mul_f32 v[154:155], v[154:155], v[8:9] op_sel_hi:[1,0]
  v_cvt_pk_bf16_f32 v156, v148, v149
  v_cvt_pk_bf16_f32 v157, v150, v151
  v_cvt_pk_bf16_f32 v158, v152, v153
  v_cvt_pk_bf16_f32 v159, v154, v155
  buffer_store_dwordx4 v[156:159], v2, s[4:7], s28 offen offset:3072 sc1
  s_add_u32 s28, s25, 100671488
  v_accvgpr_read_b32 v112, a64
  v_accvgpr_read_b32 v113, a65
  v_accvgpr_read_b32 v114, a66
  v_accvgpr_read_b32 v115, a67
  v_accvgpr_read_b32 v116, a68
  v_accvgpr_read_b32 v117, a69
  v_accvgpr_read_b32 v118, a70
  v_accvgpr_read_b32 v119, a71
  v_pk_mul_f32 v[112:113], v[112:113], v[10:11] op_sel_hi:[1,0]
  v_pk_mul_f32 v[114:115], v[114:115], v[10:11] op_sel_hi:[1,0]
  v_pk_mul_f32 v[116:117], v[116:117], v[10:11] op_sel_hi:[1,0]
  v_pk_mul_f32 v[118:119], v[118:119], v[10:11] op_sel_hi:[1,0]
  v_cvt_pk_bf16_f32 v120, v112, v113
  v_cvt_pk_bf16_f32 v121, v114, v115
  v_cvt_pk_bf16_f32 v122, v116, v117
  v_cvt_pk_bf16_f32 v123, v118, v119
  buffer_store_dwordx4 v[120:123], v2, s[4:7], s28 offen offset:0 sc1
  v_accvgpr_read_b32 v124, a72
  v_accvgpr_read_b32 v125, a73
  v_accvgpr_read_b32 v126, a74
  v_accvgpr_read_b32 v127, a75
  v_accvgpr_read_b32 v128, a76
  v_accvgpr_read_b32 v129, a77
  v_accvgpr_read_b32 v130, a78
  v_accvgpr_read_b32 v131, a79
  v_pk_mul_f32 v[124:125], v[124:125], v[10:11] op_sel_hi:[1,0]
  v_pk_mul_f32 v[126:127], v[126:127], v[10:11] op_sel_hi:[1,0]
  v_pk_mul_f32 v[128:129], v[128:129], v[10:11] op_sel_hi:[1,0]
  v_pk_mul_f32 v[130:131], v[130:131], v[10:11] op_sel_hi:[1,0]
  v_cvt_pk_bf16_f32 v132, v124, v125
  v_cvt_pk_bf16_f32 v133, v126, v127
  v_cvt_pk_bf16_f32 v134, v128, v129
  v_cvt_pk_bf16_f32 v135, v130, v131
  buffer_store_dwordx4 v[132:135], v2, s[4:7], s28 offen offset:1024 sc1
  v_accvgpr_read_b32 v136, a80
  v_accvgpr_read_b32 v137, a81
  v_accvgpr_read_b32 v138, a82
  v_accvgpr_read_b32 v139, a83
  v_accvgpr_read_b32 v140, a84
  v_accvgpr_read_b32 v141, a85
  v_accvgpr_read_b32 v142, a86
  v_accvgpr_read_b32 v143, a87
  v_pk_mul_f32 v[136:137], v[136:137], v[10:11] op_sel_hi:[1,0]
  v_pk_mul_f32 v[138:139], v[138:139], v[10:11] op_sel_hi:[1,0]
  v_pk_mul_f32 v[140:141], v[140:141], v[10:11] op_sel_hi:[1,0]
  v_pk_mul_f32 v[142:143], v[142:143], v[10:11] op_sel_hi:[1,0]
  v_cvt_pk_bf16_f32 v144, v136, v137
  v_cvt_pk_bf16_f32 v145, v138, v139
  v_cvt_pk_bf16_f32 v146, v140, v141
  v_cvt_pk_bf16_f32 v147, v142, v143
  buffer_store_dwordx4 v[144:147], v2, s[4:7], s28 offen offset:2048 sc1
  v_accvgpr_read_b32 v148, a88
  v_accvgpr_read_b32 v149, a89
  v_accvgpr_read_b32 v150, a90
  v_accvgpr_read_b32 v151, a91
  v_accvgpr_read_b32 v152, a92
  v_accvgpr_read_b32 v153, a93
  v_accvgpr_read_b32 v154, a94
  v_accvgpr_read_b32 v155, a95
  v_pk_mul_f32 v[148:149], v[148:149], v[10:11] op_sel_hi:[1,0]
  v_pk_mul_f32 v[150:151], v[150:151], v[10:11] op_sel_hi:[1,0]
  v_pk_mul_f32 v[152:153], v[152:153], v[10:11] op_sel_hi:[1,0]
  v_pk_mul_f32 v[154:155], v[154:155], v[10:11] op_sel_hi:[1,0]
  v_cvt_pk_bf16_f32 v156, v148, v149
  v_cvt_pk_bf16_f32 v157, v150, v151
  v_cvt_pk_bf16_f32 v158, v152, v153
  v_cvt_pk_bf16_f32 v159, v154, v155
  buffer_store_dwordx4 v[156:159], v2, s[4:7], s28 offen offset:3072 sc1
  s_add_u32 s28, s25, 100675584
  v_accvgpr_read_b32 v112, a96
  v_accvgpr_read_b32 v113, a97
  v_accvgpr_read_b32 v114, a98
  v_accvgpr_read_b32 v115, a99
  v_accvgpr_read_b32 v116, a100
  v_accvgpr_read_b32 v117, a101
  v_accvgpr_read_b32 v118, a102
  v_accvgpr_read_b32 v119, a103
  v_pk_mul_f32 v[112:113], v[112:113], v[10:11] op_sel_hi:[1,0]
  v_pk_mul_f32 v[114:115], v[114:115], v[10:11] op_sel_hi:[1,0]
  v_pk_mul_f32 v[116:117], v[116:117], v[10:11] op_sel_hi:[1,0]
  v_pk_mul_f32 v[118:119], v[118:119], v[10:11] op_sel_hi:[1,0]
  v_cvt_pk_bf16_f32 v120, v112, v113
  v_cvt_pk_bf16_f32 v121, v114, v115
  v_cvt_pk_bf16_f32 v122, v116, v117
  v_cvt_pk_bf16_f32 v123, v118, v119
  buffer_store_dwordx4 v[120:123], v2, s[4:7], s28 offen offset:0 sc1
  v_accvgpr_read_b32 v124, a104
  v_accvgpr_read_b32 v125, a105
  v_accvgpr_read_b32 v126, a106
  v_accvgpr_read_b32 v127, a107
  v_accvgpr_read_b32 v128, a108
  v_accvgpr_read_b32 v129, a109
  v_accvgpr_read_b32 v130, a110
  v_accvgpr_read_b32 v131, a111
  v_pk_mul_f32 v[124:125], v[124:125], v[10:11] op_sel_hi:[1,0]
  v_pk_mul_f32 v[126:127], v[126:127], v[10:11] op_sel_hi:[1,0]
  v_pk_mul_f32 v[128:129], v[128:129], v[10:11] op_sel_hi:[1,0]
  v_pk_mul_f32 v[130:131], v[130:131], v[10:11] op_sel_hi:[1,0]
  v_cvt_pk_bf16_f32 v132, v124, v125
  v_cvt_pk_bf16_f32 v133, v126, v127
  v_cvt_pk_bf16_f32 v134, v128, v129
  v_cvt_pk_bf16_f32 v135, v130, v131
  buffer_store_dwordx4 v[132:135], v2, s[4:7], s28 offen offset:1024 sc1
  v_accvgpr_read_b32 v136, a112
  v_accvgpr_read_b32 v137, a113
  v_accvgpr_read_b32 v138, a114
  v_accvgpr_read_b32 v139, a115
  v_accvgpr_read_b32 v140, a116
  v_accvgpr_read_b32 v141, a117
  v_accvgpr_read_b32 v142, a118
  v_accvgpr_read_b32 v143, a119
  v_pk_mul_f32 v[136:137], v[136:137], v[10:11] op_sel_hi:[1,0]
  v_pk_mul_f32 v[138:139], v[138:139], v[10:11] op_sel_hi:[1,0]
  v_pk_mul_f32 v[140:141], v[140:141], v[10:11] op_sel_hi:[1,0]
  v_pk_mul_f32 v[142:143], v[142:143], v[10:11] op_sel_hi:[1,0]
  v_cvt_pk_bf16_f32 v144, v136, v137
  v_cvt_pk_bf16_f32 v145, v138, v139
  v_cvt_pk_bf16_f32 v146, v140, v141
  v_cvt_pk_bf16_f32 v147, v142, v143
  buffer_store_dwordx4 v[144:147], v2, s[4:7], s28 offen offset:2048 sc1
  v_accvgpr_read_b32 v148, a120
  v_accvgpr_read_b32 v149, a121
  v_accvgpr_read_b32 v150, a122
  v_accvgpr_read_b32 v151, a123
  v_accvgpr_read_b32 v152, a124
  v_accvgpr_read_b32 v153, a125
  v_accvgpr_read_b32 v154, a126
  v_accvgpr_read_b32 v155, a127
  v_pk_mul_f32 v[148:149], v[148:149], v[10:11] op_sel_hi:[1,0]
  v_pk_mul_f32 v[150:151], v[150:151], v[10:11] op_sel_hi:[1,0]
  v_pk_mul_f32 v[152:153], v[152:153], v[10:11] op_sel_hi:[1,0]
  v_pk_mul_f32 v[154:155], v[154:155], v[10:11] op_sel_hi:[1,0]
  v_cvt_pk_bf16_f32 v156, v148, v149
  v_cvt_pk_bf16_f32 v157, v150, v151
  v_cvt_pk_bf16_f32 v158, v152, v153
  v_cvt_pk_bf16_f32 v159, v154, v155
  buffer_store_dwordx4 v[156:159], v2, s[4:7], s28 offen offset:3072 sc1
  s_branch A_out_31
A_kvw_32:
M_kv_35:
  s_cmp_ge_u32 s17, s36
  s_cbranch_scc1 M_kvok_36
  s_mov_b32 s76, 0
  s_mov_b32 s78, 23
  s_mov_b32 s77, 335872
  s_cmp_eq_u32 s68, 1
  s_cmov_b32 s76, 128
  s_cmov_b32 s78, 27
  s_cmov_b32 s77, 114688
  s_cmp_eq_u32 s68, 2
  s_cmov_b32 s76, 768
  s_cmov_b32 s78, 14
  s_cmov_b32 s77, 0
  s_add_u32 s76, s76, s67
  s_mov_b32 s71, 0
  s_branch M_sg_38
M_sw_37:
  s_sleep 8
  s_add_u32 s71, s71, 1
  s_cmp_gt_u32 s71, 262144
  s_cbranch_scc1 M_exit
M_sg_38:
  s_mov_b32 s79, 0
  s_atomic_or s79, s[72:73], s76 glc
  s_waitcnt lgkmcnt(0)
  s_cmp_lt_u32 s79, s78
  s_cbranch_scc1 M_sw_37
  s_add_u32 s36, s77, s19
  s_add_u32 s68, s68, 1
  s_branch M_kv_35
M_kvok_36:
  s_branch A_kvb_33
A_upd_29:
  s_cmp_eq_u32 s23, 2
  s_cbranch_scc1 A_upd2_39
  v_mov_b32 v12, s24
  v_cmp_le_i32 s[40:41], 0, v5
  v_cmp_le_i32 s[42:43], 1, v5
  v_cmp_le_i32 s[44:45], 2, v5
  v_cmp_le_i32 s[46:47], 3, v5
  v_cndmask_b32 v64, v12, v6, s[40:41]
  v_cndmask_b32 v65, v12, v6, s[42:43]
  v_cndmask_b32 v66, v12, v6, s[44:45]
  v_cndmask_b32 v67, v12, v6, s[46:47]
  v_cmp_le_i32 s[40:41], 8, v5
  v_cmp_le_i32 s[42:43], 9, v5
  v_cmp_le_i32 s[44:45], 10, v5
  v_cmp_le_i32 s[46:47], 11, v5
  v_cndmask_b32 v68, v12, v6, s[40:41]
  v_cndmask_b32 v69, v12, v6, s[42:43]
  v_cndmask_b32 v70, v12, v6, s[44:45]
  v_cndmask_b32 v71, v12, v6, s[46:47]
  v_cmp_le_i32 s[40:41], 16, v5
  v_cmp_le_i32 s[42:43], 17, v5
  v_cmp_le_i32 s[44:45], 18, v5
  v_cmp_le_i32 s[46:47], 19, v5
  v_cndmask_b32 v72, v12, v6, s[40:41]
  v_cndmask_b32 v73, v12, v6, s[42:43]
  v_cndmask_b32 v74, v12, v6, s[44:45]
  v_cndmask_b32 v75, v12, v6, s[46:47]
  v_cmp_le_i32 s[40:41], 24, v5
  v_cmp_le_i32 s[42:43], 25, v5
  v_cmp_le_i32 s[44:45], 26, v5
  v_cmp_le_i32 s[46:47], 27, v5
  v_cndmask_b32 v76, v12, v6, s[40:41]
  v_cndmask_b32 v77, v12, v6, s[42:43]
  v_cndmask_b32 v78, v12, v6, s[44:45]
  v_cndmask_b32 v79, v12, v6, s[46:47]
  v_mov_b32 v80, v7
  v_mov_b32 v81, v7
  v_mov_b32 v82, v7
  v_mov_b32 v83, v7
  v_mov_b32 v84, v7
  v_mov_b32 v85, v7
  v_mov_b32 v86, v7
  v_mov_b32 v87, v7
  v_mov_b32 v88, v7
  v_mov_b32 v89, v7
  v_mov_b32 v90, v7
  v_mov_b32 v91, v7
  v_mov_b32 v92, v7
  v_mov_b32 v93, v7
  v_mov_b32 v94, v7
  v_mov_b32 v95, v7
  s_branch A_back_30
A_upd2_39:
  v_mov_b32 v64, v6
  v_mov_b32 v65, v6
  v_mov_b32 v66, v6
  v_mov_b32 v67, v6
  v_mov_b32 v68, v6
  v_mov_b32 v69, v6
  v_mov_b32 v70, v6
  v_mov_b32 v71, v6
  v_mov_b32 v72, v6
  v_mov_b32 v73, v6
  v_mov_b32 v74, v6
  v_mov_b32 v75, v6
  v_mov_b32 v76, v6
  v_mov_b32 v77, v6
  v_mov_b32 v78, v6
  v_mov_b32 v79, v6
  s_branch A_back_30
A_slow_34:
  s_mov_b32 s29, 1
  v_mov_b32 v64, s24
  v_mov_b32 v65, s24
  v_mov_b32 v66, s24
  v_mov_b32 v67, s24
  v_mov_b32 v68, s24
  v_mov_b32 v69, s24
  v_mov_b32 v70, s24
  v_mov_b32 v71, s24
  v_mov_b32 v72, s24
  v_mov_b32 v73, s24
  v_mov_b32 v74, s24
  v_mov_b32 v75, s24
  v_mov_b32 v76, s24
  v_mov_b32 v77, s24
  v_mov_b32 v78, s24
  v_mov_b32 v79, s24
  v_mov_b32 v12, s24
  v_cmp_le_i32 s[40:41], 0, v5
  v_cmp_le_i32 s[42:43], 1, v5
  v_cmp_le_i32 s[44:45], 2, v5
  v_cmp_le_i32 s[46:47], 3, v5
  v_cndmask_b32 v80, v12, v7, s[40:41]
  v_cndmask_b32 v81, v12, v7, s[42:43]
  v_cndmask_b32 v82, v12, v7, s[44:45]
  v_cndmask_b32 v83, v12, v7, s[46:47]
  v_cmp_le_i32 s[40:41], 8, v5
  v_cmp_le_i32 s[42:43], 9, v5
  v_cmp_le_i32 s[44:45], 10, v5
  v_cmp_le_i32 s[46:47], 11, v5
  v_cndmask_b32 v84, v12, v7, s[40:41]
  v_cndmask_b32 v85, v12, v7, s[42:43]
  v_cndmask_b32 v86, v12, v7, s[44:45]
  v_cndmask_b32 v87, v12, v7, s[46:47]
  v_cmp_le_i32 s[40:41], 16, v5
  v_cmp_le_i32 s[42:43], 17, v5
  v_cmp_le_i32 s[44:45], 18, v5
  v_cmp_le_i32 s[46:47], 19, v5
  v_cndmask_b32 v88, v12, v7, s[40:41]
  v_cndmask_b32 v89, v12, v7, s[42:43]
  v_cndmask_b32 v90, v12, v7, s[44:45]
  v_cndmask_b32 v91, v12, v7, s[46:47]
  v_cmp_le_i32 s[40:41], 24, v5
  v_cmp_le_i32 s[42:43], 25, v5
  v_cmp_le_i32 s[44:45], 26, v5
  v_cmp_le_i32 s[46:47], 27, v5
  v_cndmask_b32 v92, v12, v7, s[40:41]
  v_cndmask_b32 v93, v12, v7, s[42:43]
  v_cndmask_b32 v94, v12, v7, s[44:45]
  v_cndmask_b32 v95, v12, v7, s[46:47]
  v_mov_b32 v8, s24
  v_mov_b32 v10, s24
  s_add_u32 s17, s25, 16785408
  s_mov_b32 s23, 0
A_ml_40:
  s_add_u32 s28, s17, 4096
  buffer_load_dwordx4 a[192:195], v2, s[4:7], s17 offen offset:0 sc1
  buffer_load_dwordx4 a[196:199], v2, s[4:7], s17 offen offset:1024 sc1
  buffer_load_dwordx4 a[200:203], v2, s[4:7], s17 offen offset:2048 sc1
  buffer_load_dwordx4 a[204:207], v2, s[4:7], s17 offen offset:3072 sc1
  buffer_load_dwordx4 a[208:211], v2, s[4:7], s28 offen offset:0 sc1
  buffer_load_dwordx4 a[212:215], v2, s[4:7], s28 offen offset:1024 sc1
  buffer_load_dwordx4 a[216:219], v2, s[4:7], s28 offen offset:2048 sc1
  buffer_load_dwordx4 a[220:223], v2, s[4:7], s28 offen offset:3072 sc1
  s_waitcnt vmcnt(0)
  v_mfma_f32_32x32x16_bf16 v[32:47], a[192:195], a[128:131], v[64:79]
  v_mfma_f32_32x32x16_bf16 v[32:47], a[196:199], a[132:135], v[32:47]
  v_mfma_f32_32x32x16_bf16 v[32:47], a[200:203], a[136:139], v[32:47]
  v_mfma_f32_32x32x16_bf16 v[32:47], a[204:207], a[140:143], v[32:47]
  v_mfma_f32_32x32x16_bf16 v[32:47], a[208:211], a[144:147], v[32:47]
  v_mfma_f32_32x32x16_bf16 v[32:47], a[212:215], a[148:151], v[32:47]
  v_mfma_f32_32x32x16_bf16 v[32:47], a[216:219], a[152:155], v[32:47]
  v_mfma_f32_32x32x16_bf16 v[32:47], a[220:223], a[156:159], v[32:47]
  v_mfma_f32_32x32x16_bf16 v[48:63], a[192:195], a[160:163], v[80:95]
  v_mfma_f32_32x32x16_bf16 v[48:63], a[196:199], a[164:167], v[48:63]
  v_mfma_f32_32x32x16_bf16 v[48:63], a[200:203], a[168:171], v[48:63]
  v_mfma_f32_32x32x16_bf16 v[48:63], a[204:207], a[172:175], v[48:63]
  v_mfma_f32_32x32x16_bf16 v[48:63], a[208:211], a[176:179], v[48:63]
  v_mfma_f32_32x32x16_bf16 v[48:63], a[212:215], a[180:183], v[48:63]
  v_mfma_f32_32x32x16_bf16 v[48:63], a[216:219], a[184:187], v[48:63]
  v_mfma_f32_32x32x16_bf16 v[48:63], a[220:223], a[188:191], v[48:63]
  s_nop 7
  s_nop 3
  v_max3_f32 v8, v8, v32, v33
  v_max3_f32 v8, v8, v34, v35
  v_max3_f32 v8, v8, v36, v37
  v_max3_f32 v8, v8, v38, v39
  v_max3_f32 v8, v8, v40, v41
  v_max3_f32 v8, v8, v42, v43
  v_max3_f32 v8, v8, v44, v45
  v_max3_f32 v8, v8, v46, v47
  v_max3_f32 v10, v10, v48, v49
  v_max3_f32 v10, v10, v50, v51
  v_max3_f32 v10, v10, v52, v53
  v_max3_f32 v10, v10, v54, v55
  v_max3_f32 v10, v10, v56, v57
  v_max3_f32 v10, v10, v58, v59
  v_max3_f32 v10, v10, v60, v61
  v_max3_f32 v10, v10, v62, v63
  s_add_u32 s23, s23, 1
  s_cmp_lg_u32 s23, 1
  s_cbranch_scc1 A_m2_41
  v_mov_b32 v12, s24
  v_cmp_le_i32 s[40:41], 0, v5
  v_cmp_le_i32 s[42:43], 1, v5
  v_cmp_le_i32 s[44:45], 2, v5
  v_cmp_le_i32 s[46:47], 3, v5
  v_cndmask_b32 v64, v12, v6, s[40:41]
  v_cndmask_b32 v65, v12, v6, s[42:43]
  v_cndmask_b32 v66, v12, v6, s[44:45]
  v_cndmask_b32 v67, v12, v6, s[46:47]
  v_cmp_le_i32 s[40:41], 8, v5
  v_cmp_le_i32 s[42:43], 9, v5
  v_cmp_le_i32 s[44:45], 10, v5
  v_cmp_le_i32 s[46:47], 11, v5
  v_cndmask_b32 v68, v12, v6, s[40:41]
  v_cndmask_b32 v69, v12, v6, s[42:43]
  v_cndmask_b32 v70, v12, v6, s[44:45]
  v_cndmask_b32 v71, v12, v6, s[46:47]
  v_cmp_le_i32 s[40:41], 16, v5
  v_cmp_le_i32 s[42:43], 17, v5
  v_cmp_le_i32 s[44:45], 18, v5
  v_cmp_le_i32 s[46:47], 19, v5
  v_cndmask_b32 v72, v12, v6, s[40:41]
  v_cndmask_b32 v73, v12, v6, s[42:43]
  v_cndmask_b32 v74, v12, v6, s[44:45]
  v_cndmask_b32 v75, v12, v6, s[46:47]
  v_cmp_le_i32 s[40:41], 24, v5
  v_cmp_le_i32 s[42:43], 25, v5
  v_cmp_le_i32 s[44:45], 26, v5
  v_cmp_le_i32 s[46:47], 27, v5
  v_cndmask_b32 v76, v12, v6, s[40:41]
  v_cndmask_b32 v77, v12, v6, s[42:43]
  v_cndmask_b32 v78, v12, v6, s[44:45]
  v_cndmask_b32 v79, v12, v6, s[46:47]
  v_mov_b32 v80, v7
  v_mov_b32 v81, v7
  v_mov_b32 v82, v7
  v_mov_b32 v83, v7
  v_mov_b32 v84, v7
  v_mov_b32 v85, v7
  v_mov_b32 v86, v7
  v_mov_b32 v87, v7
  v_mov_b32 v88, v7
  v_mov_b32 v89, v7
  v_mov_b32 v90, v7
  v_mov_b32 v91, v7
  v_mov_b32 v92, v7
  v_mov_b32 v93, v7
  v_mov_b32 v94, v7
  v_mov_b32 v95, v7
A_m2_41:
  s_cmp_lg_u32 s23, 2
  s_cbranch_scc1 A_m3_42
  v_mov_b32 v64, v6
  v_mov_b32 v65, v6
  v_mov_b32 v66, v6
  v_mov_b32 v67, v6
  v_mov_b32 v68, v6
  v_mov_b32 v69, v6
  v_mov_b32 v70, v6
  v_mov_b32 v71, v6
  v_mov_b32 v72, v6
  v_mov_b32 v73, v6
  v_mov_b32 v74, v6
  v_mov_b32 v75, v6
  v_mov_b32 v76, v6
  v_mov_b32 v77, v6
  v_mov_b32 v78, v6
  v_mov_b32 v79, v6
A_m3_42:
  s_sub_u32 s17, s17, 8192
  s_cmp_ge_i32 s17, s19
  s_cbranch_scc1 A_ml_40
  v_mov_b32 v9, v8
  s_nop 1
  v_permlane32_swap_b32 v8, v9
  s_nop 1
  v_max_f32 v8, v8, v9
  v_sub_f32 v6, 0, v8
  v_mov_b32 v11, v10
  s_nop 1
  v_permlane32_swap_b32 v10, v11
  s_nop 1
  v_max_f32 v10, v10, v11
  v_sub_f32 v7, 0, v10
  s_branch A_again_21
A_out_31:
  s_mov_b32 s69, s55
  s_mov_b32 s70, s56
  s_sub_u32 s52, s52, 1
  s_cmp_lg_u32 s52, 0
  s_cbranch_scc1 M_att
  s_waitcnt vmcnt(0)
  s_barrier
  s_mov_b32 s30, 512
  v_mov_b32 v144, s30
  v_min_u32 v145, 1, v0
  v_lshlrev_b32 v145, 30, v145
  buffer_store_dword v144, v145, s[4:7], s31 offen sc1
  s_lshr_b32 s48, s64, 2
  s_bfe_u32 s49, s64, 0x10001
  s_and_b32 s50, s64, 1
  s_mul_i32 s50, s50, 6
  s_add_u32 s50, s50, s65
  s_mov_b32 s51, 12
  s_cmp_lt_u32 s50, 4
  s_cselect_b32 s23, 6, 5
  s_load_dwordx2 s[8:9], s[0:1], 40
  s_lshl_b32 s17, s48, 19
  s_lshl_b32 s26, s49, 2
  s_add_u32 s26, s26, s16
  s_lshl_b32 s27, s26, 7
  s_add_u32 s17, s17, s27
  s_mov_b32 s18, 1024
  s_lshl_b32 s21, s48, 6
  s_add_u32 s21, s21, s50
  s_lshl_b32 s21, s21, 3
  s_add_u32 s21, s21, s26
  s_lshl_b32 s21, s21, 12
  s_add_u32 s21, s21, 150994944
  s_lshl_b32 s22, s51, 15
  s_mov_b32 s24, 1.0
  s_waitcnt lgkmcnt(0)
  s_and_b32 s9, s9, 0xffff
  s_mov_b32 s10, 4194304
  s_mov_b32 s11, 0x20000
  s_mov_b32 s12, s4
  s_mov_b32 s13, s5
  s_mov_b32 s14, 268435456
  s_mov_b32 s15, 0x20000
  s_lshl_b32 s19, s48, 8
  s_add_u32 s19, s19, s50
  s_lshl_b32 s19, s19, 13
  s_add_u32 s19, s19, 100663296
  s_lshl_b32 s20, s51, 13
  s_mul_i32 s26, s16, 524288
  v_add_u32 v8, 0, v2
  v_add_u32 v16, s26, v8
  v_add_u32 v9, 1024, v2
  v_add_u32 v17, s26, v9
  v_add_u32 v10, 2048, v2
  v_add_u32 v18, s26, v10
  v_add_u32 v11, 3072, v2
  v_add_u32 v19, s26, v11
  v_add_u32 v12, 4096, v2
  v_add_u32 v20, s26, v12
  v_add_u32 v13, 5120, v2
  v_add_u32 v21, s26, v13
  v_add_u32 v14, 6144, v2
  v_add_u32 v22, s26, v14
  v_add_u32 v15, 7168, v2
  v_add_u32 v23, s26, v15
  v_lshrrev_b32 v144, 3, v1
  v_mul_lo_u32 v144, v144, s18
  v_and_b32 v145, 7, v1
  v_lshl_add_u32 v144, v145, 4, v144
  s_lshl_b32 s28, s16, 15
  s_add_u32 s28, s28, 32768
  s_lshl_b32 s29, s18, 3
  s_add_u32 m0, s28, 0
  s_nop 0
  buffer_load_dwordx4 v144, s[8:11], s17 offen lds
  s_add_u32 s17, s17, s29
  s_add_u32 m0, s28, 1024
  s_nop 0
  buffer_load_dwordx4 v144, s[8:11], s17 offen lds
  s_add_u32 s17, s17, s29
  s_add_u32 m0, s28, 2048
  s_nop 0
  buffer_load_dwordx4 v144, s[8:11], s17 offen lds
  s_add_u32 s17, s17, s29
  s_add_u32 m0, s28, 3072
  s_nop 0
  buffer_load_dwordx4 v144, s[8:11], s17 offen lds
  s_add_u32 s17, s17, s29
  s_add_u32 m0, s28, 4096
  s_nop 0
  buffer_load_dwordx4 v144, s[8:11], s17 offen lds
  s_add_u32 s17, s17, s29
  s_add_u32 m0, s28, 5120
  s_nop 0
  buffer_load_dwordx4 v144, s[8:11], s17 offen lds
  s_add_u32 s17, s17, s29
  s_add_u32 m0, s28, 6144
  s_nop 0
  buffer_load_dwordx4 v144, s[8:11], s17 offen lds
  s_add_u32 s17, s17, s29
  s_add_u32 m0, s28, 7168
  s_nop 0
  buffer_load_dwordx4 v144, s[8:11], s17 offen lds
  s_add_u32 s17, s17, s29
  s_add_u32 m0, s28, 8192
  s_nop 0
  buffer_load_dwordx4 v144, s[8:11], s17 offen lds
  s_add_u32 s17, s17, s29
  s_add_u32 m0, s28, 9216
  s_nop 0
  buffer_load_dwordx4 v144, s[8:11], s17 offen lds
  s_add_u32 s17, s17, s29
  s_add_u32 m0, s28, 10240
  s_nop 0
  buffer_load_dwordx4 v144, s[8:11], s17 offen lds
  s_add_u32 s17, s17, s29
  s_add_u32 m0, s28, 11264
  s_nop 0
  buffer_load_dwordx4 v144, s[8:11], s17 offen lds
  s_add_u32 s17, s17, s29
  s_add_u32 m0, s28, 12288
  s_nop 0
  buffer_load_dwordx4 v144, s[8:11], s17 offen lds
  s_add_u32 s17, s17, s29
  s_add_u32 m0, s28, 13312
  s_nop 0
  buffer_load_dwordx4 v144, s[8:11], s17 offen lds
  s_add_u32 s17, s17, s29
  s_add_u32 m0, s28, 14336
  s_nop 0
  buffer_load_dwordx4 v144, s[8:11], s17 offen lds
  s_add_u32 s17, s17, s29
  s_add_u32 m0, s28, 15360
  s_nop 0
  buffer_load_dwordx4 v144, s[8:11], s17 offen lds
  s_add_u32 s17, s17, s29
  s_add_u32 m0, s28, 16384
  s_nop 0
  buffer_load_dwordx4 v144, s[8:11], s17 offen lds
  s_add_u32 s17, s17, s29
  s_add_u32 m0, s28, 17408
  s_nop 0
  buffer_load_dwordx4 v144, s[8:11], s17 offen lds
  s_add_u32 s17, s17, s29
  s_add_u32 m0, s28, 18432
  s_nop 0
  buffer_load_dwordx4 v144, s[8:11], s17 offen lds
  s_add_u32 s17, s17, s29
  s_add_u32 m0, s28, 19456
  s_nop 0
  buffer_load_dwordx4 v144, s[8:11], s17 offen lds
  s_add_u32 s17, s17, s29
  s_add_u32 m0, s28, 20480
  s_nop 0
  buffer_load_dwordx4 v144, s[8:11], s17 offen lds
  s_add_u32 s17, s17, s29
  s_add_u32 m0, s28, 21504
  s_nop 0
  buffer_load_dwordx4 v144, s[8:11], s17 offen lds
  s_add_u32 s17, s17, s29
  s_add_u32 m0, s28, 22528
  s_nop 0
  buffer_load_dwordx4 v144, s[8:11], s17 offen lds
  s_add_u32 s17, s17, s29
  s_add_u32 m0, s28, 23552
  s_nop 0
  buffer_load_dwordx4 v144, s[8:11], s17 offen lds
  s_add_u32 s17, s17, s29
  s_add_u32 m0, s28, 24576
  s_nop 0
  buffer_load_dwordx4 v144, s[8:11], s17 offen lds
  s_add_u32 s17, s17, s29
  s_add_u32 m0, s28, 25600
  s_nop 0
  buffer_load_dwordx4 v144, s[8:11], s17 offen lds
  s_add_u32 s17, s17, s29
  s_add_u32 m0, s28, 26624
  s_nop 0
  buffer_load_dwordx4 v144, s[8:11], s17 offen lds
  s_add_u32 s17, s17, s29
  s_add_u32 m0, s28, 27648
  s_nop 0
  buffer_load_dwordx4 v144, s[8:11], s17 offen lds
  s_add_u32 s17, s17, s29
  s_add_u32 m0, s28, 28672
  s_nop 0
  buffer_load_dwordx4 v144, s[8:11], s17 offen lds
  s_add_u32 s17, s17, s29
  s_add_u32 m0, s28, 29696
  s_nop 0
  buffer_load_dwordx4 v144, s[8:11], s17 offen lds
  s_add_u32 s17, s17, s29
  s_add_u32 m0, s28, 30720
  s_nop 0
  buffer_load_dwordx4 v144, s[8:11], s17 offen lds
  s_add_u32 s17, s17, s29
  s_add_u32 m0, s28, 31744
  s_nop 0
  buffer_load_dwordx4 v144, s[8:11], s17 offen lds
  s_add_u32 s17, s17, s29
  v_bfe_u32 v148, v1, 2, 2
  v_lshrrev_b32 v149, 5, v1
  v_lshl_add_u32 v148, v149, 2, v148
  v_lshlrev_b32 v148, 7, v148
  v_bfe_u32 v149, v1, 4, 1
  v_lshl_add_u32 v148, v149, 5, v148
  v_and_b32 v149, 1, v1
  v_lshl_add_u32 v148, v149, 4, v148
  v_bfe_u32 v149, v1, 1, 1
  v_lshl_add_u32 v148, v149, 3, v148
  v_add_u32 v146, s28, v148
  v_add_u32 v147, 1024, v146
  s_waitcnt vmcnt(28)
  ds_read_b64_tr_b16 a[0:1], v146 offset:0
  ds_read_b64_tr_b16 a[2:3], v147 offset:0
  ds_read_b64_tr_b16 a[4:5], v146 offset:64
  ds_read_b64_tr_b16 a[6:7], v147 offset:64
  ds_read_b64_tr_b16 a[8:9], v146 offset:2048
  ds_read_b64_tr_b16 a[10:11], v147 offset:2048
  ds_read_b64_tr_b16 a[12:13], v146 offset:2112
  ds_read_b64_tr_b16 a[14:15], v147 offset:2112
  s_waitcnt lgkmcnt(0)
  s_add_u32 m0, s28, 0
  s_nop 0
  buffer_load_dwordx4 v144, s[8:11], s17 offen lds
  s_add_u32 s17, s17, s29
  s_add_u32 m0, s28, 1024
  s_nop 0
  buffer_load_dwordx4 v144, s[8:11], s17 offen lds
  s_add_u32 s17, s17, s29
  s_add_u32 m0, s28, 2048
  s_nop 0
  buffer_load_dwordx4 v144, s[8:11], s17 offen lds
  s_add_u32 s17, s17, s29
  s_add_u32 m0, s28, 3072
  s_nop 0
  buffer_load_dwordx4 v144, s[8:11], s17 offen lds
  s_add_u32 s17, s17, s29
  s_waitcnt vmcnt(28)
  ds_read_b64_tr_b16 a[16:17], v146 offset:4096
  ds_read_b64_tr_b16 a[18:19], v147 offset:4096
  ds_read_b64_tr_b16 a[20:21], v146 offset:4160
  ds_read_b64_tr_b16 a[22:23], v147 offset:4160
  ds_read_b64_tr_b16 a[24:25], v146 offset:6144
  ds_read_b64_tr_b16 a[26:27], v147 offset:6144
  ds_read_b64_tr_b16 a[28:29], v146 offset:6208
  ds_read_b64_tr_b16 a[30:31], v147 offset:6208
  s_waitcnt lgkmcnt(0)
  s_add_u32 m0, s28, 4096
  s_nop 0
  buffer_load_dwordx4 v144, s[8:11], s17 offen lds
  s_add_u32 s17, s17, s29
  s_add_u32 m0, s28, 5120
  s_nop 0
  buffer_load_dwordx4 v144, s[8:11], s17 offen lds
  s_add_u32 s17, s17, s29
  s_add_u32 m0, s28, 6144
  s_nop 0
  buffer_load_dwordx4 v144, s[8:11], s17 offen lds
  s_add_u32 s17, s17, s29
  s_add_u32 m0, s28, 7168
  s_nop 0
  buffer_load_dwordx4 v144, s[8:11], s17 offen lds
  s_add_u32 s17, s17, s29
  s_waitcnt vmcnt(28)
  ds_read_b64_tr_b16 a[32:33], v146 offset:8192
  ds_read_b64_tr_b16 a[34:35], v147 offset:8192
  ds_read_b64_tr_b16 a[36:37], v146 offset:8256
  ds_read_b64_tr_b16 a[38:39], v147 offset:8256
  ds_read_b64_tr_b16 a[40:41], v146 offset:10240
  ds_read_b64_tr_b16 a[42:43], v147 offset:10240
  ds_read_b64_tr_b16 a[44:45], v146 offset:10304
  ds_read_b64_tr_b16 a[46:47], v147 offset:10304
  s_waitcnt lgkmcnt(0)
  s_add_u32 m0, s28, 8192
  s_nop 0
  buffer_load_dwordx4 v144, s[8:11], s17 offen lds
  s_add_u32 s17, s17, s29
  s_add_u32 m0, s28, 9216
  s_nop 0
  buffer_load_dwordx4 v144, s[8:11], s17 offen lds
  s_add_u32 s17, s17, s29
  s_add_u32 m0, s28, 10240
  s_nop 0
  buffer_load_dwordx4 v144, s[8:11], s17 offen lds
  s_add_u32 s17, s17, s29
  s_add_u32 m0, s28, 11264
  s_nop 0
  buffer_load_dwordx4 v144, s[8:11], s17 offen lds
  s_add_u32 s17, s17, s29
  s_waitcnt vmcnt(28)
  ds_read_b64_tr_b16 a[48:49], v146 offset:12288
  ds_read_b64_tr_b16 a[50:51], v147 offset:12288
  ds_read_b64_tr_b16 a[52:53], v146 offset:12352
  ds_read_b64_tr_b16 a[54:55], v147 offset:12352
  ds_read_b64_tr_b16 a[56:57], v146 offset:14336
  ds_read_b64_tr_b16 a[58:59], v147 offset:14336
  ds_read_b64_tr_b16 a[60:61], v146 offset:14400
  ds_read_b64_tr_b16 a[62:63], v147 offset:14400
  s_waitcnt lgkmcnt(0)
  s_add_u32 m0, s28, 12288
  s_nop 0
  buffer_load_dwordx4 v144, s[8:11], s17 offen lds
  s_add_u32 s17, s17, s29
  s_add_u32 m0, s28, 13312
  s_nop 0
  buffer_load_dwordx4 v144, s[8:11], s17 offen lds
  s_add_u32 s17, s17, s29
  s_add_u32 m0, s28, 14336
  s_nop 0
  buffer_load_dwordx4 v144, s[8:11], s17 offen lds
  s_add_u32 s17, s17, s29
  s_add_u32 m0, s28, 15360
  s_nop 0
  buffer_load_dwordx4 v144, s[8:11], s17 offen lds
  s_add_u32 s17, s17, s29
  s_waitcnt vmcnt(28)
  ds_read_b64_tr_b16 a[64:65], v146 offset:16384
  ds_read_b64_tr_b16 a[66:67], v147 offset:16384
  ds_read_b64_tr_b16 a[68:69], v146 offset:16448
  ds_read_b64_tr_b16 a[70:71], v147 offset:16448
  ds_read_b64_tr_b16 a[72:73], v146 offset:18432
  ds_read_b64_tr_b16 a[74:75], v147 offset:18432
  ds_read_b64_tr_b16 a[76:77], v146 offset:18496
  ds_read_b64_tr_b16 a[78:79], v147 offset:18496
  s_waitcnt lgkmcnt(0)
  s_add_u32 m0, s28, 16384
  s_nop 0
  buffer_load_dwordx4 v144, s[8:11], s17 offen lds
  s_add_u32 s17, s17, s29
  s_add_u32 m0, s28, 17408
  s_nop 0
  buffer_load_dwordx4 v144, s[8:11], s17 offen lds
  s_add_u32 s17, s17, s29
  s_add_u32 m0, s28, 18432
  s_nop 0
  buffer_load_dwordx4 v144, s[8:11], s17 offen lds
  s_add_u32 s17, s17, s29
  s_add_u32 m0, s28, 19456
  s_nop 0
  buffer_load_dwordx4 v144, s[8:11], s17 offen lds
  s_add_u32 s17, s17, s29
  s_waitcnt vmcnt(28)
  ds_read_b64_tr_b16 a[80:81], v146 offset:20480
  ds_read_b64_tr_b16 a[82:83], v147 offset:20480
  ds_read_b64_tr_b16 a[84:85], v146 offset:20544
  ds_read_b64_tr_b16 a[86:87], v147 offset:20544
  ds_read_b64_tr_b16 a[88:89], v146 offset:22528
  ds_read_b64_tr_b16 a[90:91], v147 offset:22528
  ds_read_b64_tr_b16 a[92:93], v146 offset:22592
  ds_read_b64_tr_b16 a[94:95], v147 offset:22592
  s_waitcnt lgkmcnt(0)
  s_add_u32 m0, s28, 20480
  s_nop 0
  buffer_load_dwordx4 v144, s[8:11], s17 offen lds
  s_add_u32 s17, s17, s29
  s_add_u32 m0, s28, 21504
  s_nop 0
  buffer_load_dwordx4 v144, s[8:11], s17 offen lds
  s_add_u32 s17, s17, s29
  s_add_u32 m0, s28, 22528
  s_nop 0
  buffer_load_dwordx4 v144, s[8:11], s17 offen lds
  s_add_u32 s17, s17, s29
  s_add_u32 m0, s28, 23552
  s_nop 0
  buffer_load_dwordx4 v144, s[8:11], s17 offen lds
  s_add_u32 s17, s17, s29
  s_waitcnt vmcnt(28)
  ds_read_b64_tr_b16 a[96:97], v146 offset:24576
  ds_read_b64_tr_b16 a[98:99], v147 offset:24576
  ds_read_b64_tr_b16 a[100:101], v146 offset:24640
  ds_read_b64_tr_b16 a[102:103], v147 offset:24640
  ds_read_b64_tr_b16 a[104:105], v146 offset:26624
  ds_read_b64_tr_b16 a[106:107], v147 offset:26624
  ds_read_b64_tr_b16 a[108:109], v146 offset:26688
  ds_read_b64_tr_b16 a[110:111], v147 offset:26688
  s_waitcnt lgkmcnt(0)
  s_add_u32 m0, s28, 24576
  s_nop 0
  buffer_load_dwordx4 v144, s[8:11], s17 offen lds
  s_add_u32 s17, s17, s29
  s_add_u32 m0, s28, 25600
  s_nop 0
  buffer_load_dwordx4 v144, s[8:11], s17 offen lds
  s_add_u32 s17, s17, s29
  s_add_u32 m0, s28, 26624
  s_nop 0
  buffer_load_dwordx4 v144, s[8:11], s17 offen lds
  s_add_u32 s17, s17, s29
  s_add_u32 m0, s28, 27648
  s_nop 0
  buffer_load_dwordx4 v144, s[8:11], s17 offen lds
  s_add_u32 s17, s17, s29
  s_waitcnt vmcnt(28)
  ds_read_b64_tr_b16 a[112:113], v146 offset:28672
  ds_read_b64_tr_b16 a[114:115], v147 offset:28672
  ds_read_b64_tr_b16 a[116:117], v146 offset:28736
  ds_read_b64_tr_b16 a[118:119], v147 offset:28736
  ds_read_b64_tr_b16 a[120:121], v146 offset:30720
  ds_read_b64_tr_b16 a[122:123], v147 offset:30720
  ds_read_b64_tr_b16 a[124:125], v146 offset:30784
  ds_read_b64_tr_b16 a[126:127], v147 offset:30784
  s_waitcnt lgkmcnt(0)
  s_add_u32 m0, s28, 28672
  s_nop 0
  buffer_load_dwordx4 v144, s[8:11], s17 offen lds
  s_add_u32 s17, s17, s29
  s_add_u32 m0, s28, 29696
  s_nop 0
  buffer_load_dwordx4 v144, s[8:11], s17 offen lds
  s_add_u32 s17, s17, s29
  s_add_u32 m0, s28, 30720
  s_nop 0
  buffer_load_dwordx4 v144, s[8:11], s17 offen lds
  s_add_u32 s17, s17, s29
  s_add_u32 m0, s28, 31744
  s_nop 0
  buffer_load_dwordx4 v144, s[8:11], s17 offen lds
  s_add_u32 s17, s17, s29
  s_waitcnt vmcnt(28)
  ds_read_b64_tr_b16 a[128:129], v146 offset:0
  ds_read_b64_tr_b16 a[130:131], v147 offset:0
  ds_read_b64_tr_b16 a[132:133], v146 offset:64
  ds_read_b64_tr_b16 a[134:135], v147 offset:64
  ds_read_b64_tr_b16 a[136:137], v146 offset:2048
  ds_read_b64_tr_b16 a[138:139], v147 offset:2048
  ds_read_b64_tr_b16 a[140:141], v146 offset:2112
  ds_read_b64_tr_b16 a[142:143], v147 offset:2112
  s_waitcnt lgkmcnt(0)
  s_waitcnt vmcnt(24)
  ds_read_b64_tr_b16 a[144:145], v146 offset:4096
  ds_read_b64_tr_b16 a[146:147], v147 offset:4096
  ds_read_b64_tr_b16 a[148:149], v146 offset:4160
  ds_read_b64_tr_b16 a[150:151], v147 offset:4160
  ds_read_b64_tr_b16 a[152:153], v146 offset:6144
  ds_read_b64_tr_b16 a[154:155], v147 offset:6144
  ds_read_b64_tr_b16 a[156:157], v146 offset:6208
  ds_read_b64_tr_b16 a[158:159], v147 offset:6208
  s_waitcnt lgkmcnt(0)
  s_waitcnt vmcnt(20)
  ds_read_b64_tr_b16 a[160:161], v146 offset:8192
  ds_read_b64_tr_b16 a[162:163], v147 offset:8192
  ds_read_b64_tr_b16 a[164:165], v146 offset:8256
  ds_read_b64_tr_b16 a[166:167], v147 offset:8256
  ds_read_b64_tr_b16 a[168:169], v146 offset:10240
  ds_read_b64_tr_b16 a[170:171], v147 offset:10240
  ds_read_b64_tr_b16 a[172:173], v146 offset:10304
  ds_read_b64_tr_b16 a[174:175], v147 offset:10304
  s_waitcnt lgkmcnt(0)
  s_waitcnt vmcnt(16)
  ds_read_b64_tr_b16 a[176:177], v146 offset:12288
  ds_read_b64_tr_b16 a[178:179], v147 offset:12288
  ds_read_b64_tr_b16 a[180:181], v146 offset:12352
  ds_read_b64_tr_b16 a[182:183], v147 offset:12352
  ds_read_b64_tr_b16 a[184:185], v146 offset:14336
  ds_read_b64_tr_b16 a[186:187], v147 offset:14336
  ds_read_b64_tr_b16 a[188:189], v146 offset:14400
  ds_read_b64_tr_b16 a[190:191], v147 offset:14400
  s_waitcnt lgkmcnt(0)
  s_waitcnt vmcnt(12)
  ds_read_b64_tr_b16 a[192:193], v146 offset:16384
  ds_read_b64_tr_b16 a[194:195], v147 offset:16384
  ds_read_b64_tr_b16 a[196:197], v146 offset:16448
  ds_read_b64_tr_b16 a[198:199], v147 offset:16448
  ds_read_b64_tr_b16 a[200:201], v146 offset:18432
  ds_read_b64_tr_b16 a[202:203], v147 offset:18432
  ds_read_b64_tr_b16 a[204:205], v146 offset:18496
  ds_read_b64_tr_b16 a[206:207], v147 offset:18496
  s_waitcnt lgkmcnt(0)
  s_waitcnt vmcnt(8)
  ds_read_b64_tr_b16 a[208:209], v146 offset:20480
  ds_read_b64_tr_b16 a[210:211], v147 offset:20480
  ds_read_b64_tr_b16 a[212:213], v146 offset:20544
  ds_read_b64_tr_b16 a[214:215], v147 offset:20544
  ds_read_b64_tr_b16 a[216:217], v146 offset:22528
  ds_read_b64_tr_b16 a[218:219], v147 offset:22528
  ds_read_b64_tr_b16 a[220:221], v146 offset:22592
  ds_read_b64_tr_b16 a[222:223], v147 offset:22592
  s_waitcnt lgkmcnt(0)
  s_waitcnt vmcnt(4)
  ds_read_b64_tr_b16 a[224:225], v146 offset:24576
  ds_read_b64_tr_b16 a[226:227], v147 offset:24576
  ds_read_b64_tr_b16 a[228:229], v146 offset:24640
  ds_read_b64_tr_b16 a[230:231], v147 offset:24640
  ds_read_b64_tr_b16 a[232:233], v146 offset:26624
  ds_read_b64_tr_b16 a[234:235], v147 offset:26624
  ds_read_b64_tr_b16 a[236:237], v146 offset:26688
  ds_read_b64_tr_b16 a[238:239], v147 offset:26688
  s_waitcnt lgkmcnt(0)
  s_waitcnt vmcnt(0)
  ds_read_b64_tr_b16 a[240:241], v146 offset:28672
  ds_read_b64_tr_b16 a[242:243], v147 offset:28672
  ds_read_b64_tr_b16 a[244:245], v146 offset:28736
  ds_read_b64_tr_b16 a[246:247], v147 offset:28736
  ds_read_b64_tr_b16 a[248:249], v146 offset:30720
  ds_read_b64_tr_b16 a[250:251], v147 offset:30720
  ds_read_b64_tr_b16 a[252:253], v146 offset:30784
  ds_read_b64_tr_b16 a[254:255], v147 offset:30784
  s_waitcnt lgkmcnt(0)
  v_min_u32 v4, 27, v1
  v_mul_u32_u24 v5, 37, v4
  v_lshrrev_b32 v5, 8, v5
  v_mul_u32_u24 v5, 7, v5
  v_sub_u32 v5, v4, v5
  v_mov_b32 v6, 0x200
  v_cmp_ne_u32 vcc, 6, v5
  s_mul_i32 s76, s48, 3584
  s_add_u32 s76, s76, 148897792
  v_cndmask_b32 v5, 0, v6, vcc
  v_lshl_add_u32 v4, v4, 7, s76
  s_mov_b32 s71, 0
  s_branch M_vg_44
M_vw_43:
  s_sleep 2
  s_add_u32 s71, s71, 1
  s_cmp_gt_u32 s71, 262144
  s_cbranch_scc1 M_exit
M_vg_44:
  buffer_load_dword v6, v4, s[4:7], 0 offen sc1
  s_waitcnt vmcnt(0)
  v_cmp_lt_u32 vcc, v6, v5
  s_cbranch_vccnz M_vw_43
  s_barrier
  s_lshl_b32 s25, s16, 13
  s_add_u32 m0, s25, 0
  s_nop 0
  buffer_load_dwordx4 v16, s[12:15], s19 offen sc1 lds
  s_add_u32 m0, s25, 1024
  s_nop 0
  buffer_load_dwordx4 v17, s[12:15], s19 offen sc1 lds
  s_add_u32 m0, s25, 2048
  s_nop 0
  buffer_load_dwordx4 v18, s[12:15], s19 offen sc1 lds
  s_add_u32 m0, s25, 3072
  s_nop 0
  buffer_load_dwordx4 v19, s[12:15], s19 offen sc1 lds
  s_add_u32 m0, s25, 4096
  s_nop 0
  buffer_load_dwordx4 v20, s[12:15], s19 offen sc1 lds
  s_add_u32 m0, s25, 5120
  s_nop 0
  buffer_load_dwordx4 v21, s[12:15], s19 offen sc1 lds
  s_add_u32 m0, s25, 6144
  s_nop 0
  buffer_load_dwordx4 v22, s[12:15], s19 offen sc1 lds
  s_add_u32 m0, s25, 7168
  s_nop 0
  buffer_load_dwordx4 v23, s[12:15], s19 offen sc1 lds
  s_cmp_gt_u32 s23, 1
  s_cselect_b32 s26, s20, 0
  s_add_u32 s19, s19, s26
  s_add_u32 s25, s25, 32768
  s_and_b32 s25, s25, 0x1ffff
  s_add_u32 m0, s25, 0
  s_nop 0
  buffer_load_dwordx4 v16, s[12:15], s19 offen sc1 lds
  s_add_u32 m0, s25, 1024
  s_nop 0
  buffer_load_dwordx4 v17, s[12:15], s19 offen sc1 lds
  s_add_u32 m0, s25, 2048
  s_nop 0
  buffer_load_dwordx4 v18, s[12:15], s19 offen sc1 lds
  s_add_u32 m0, s25, 3072
  s_nop 0
  buffer_load_dwordx4 v19, s[12:15], s19 offen sc1 lds
  s_add_u32 m0, s25, 4096
  s_nop 0
  buffer_load_dwordx4 v20, s[12:15], s19 offen sc1 lds
  s_add_u32 m0, s25, 5120
  s_nop 0
  buffer_load_dwordx4 v21, s[12:15], s19 offen sc1 lds
  s_add_u32 m0, s25, 6144
  s_nop 0
  buffer_load_dwordx4 v22, s[12:15], s19 offen sc1 lds
  s_add_u32 m0, s25, 7168
  s_nop 0
  buffer_load_dwordx4 v23, s[12:15], s19 offen sc1 lds
  s_cmp_gt_u32 s23, 2
  s_cselect_b32 s26, s20, 0
  s_add_u32 s19, s19, s26
  s_add_u32 s25, s25, 32768
  s_and_b32 s25, s25, 0x1ffff
  s_waitcnt vmcnt(0)
  s_barrier
  s_mov_b32 s27, s21
  v_mov_b32 v7, 0x40000000
  ds_read_b128 v[24:27], v8 offset:0
  ds_read_b128 v[28:31], v9 offset:0
  ds_read_b128 v[32:35], v10 offset:0
  ds_read_b128 v[36:39], v11 offset:0
  ds_read_b128 v[40:43], v12 offset:0
  ds_read_b128 v[44:47], v13 offset:0
.p2align 6
G_top_45:
  s_waitcnt lgkmcnt(5)
  v_mfma_f32_32x32x16_bf16 v[64:79], a[0:3], v[24:27], 0
  s_add_u32 m0, s25, 0
  ds_read_b128 v[48:51], v14 offset:0
  v_mfma_f32_32x32x16_bf16 v[80:95], a[4:7], v[24:27], 0
  s_waitcnt lgkmcnt(5)
  buffer_load_dwordx4 v16, s[12:15], s19 offen sc1 lds
  v_mfma_f32_32x32x16_bf16 v[64:79], a[8:11], v[28:31], v[64:79]
  ds_read_b128 v[52:55], v15 offset:0
  v_mul_f32 v96, s24, v96
  v_mul_f32 v97, s24, v97
  v_mfma_f32_32x32x16_bf16 v[80:95], a[12:15], v[28:31], v[80:95]
  s_waitcnt lgkmcnt(5)
  v_cvt_pk_bf16_f32 v128, v96, v97
  v_mul_f32 v98, s24, v98
  v_mfma_f32_32x32x16_bf16 v[64:79], a[16:19], v[32:35], v[64:79]
  s_add_u32 m0, s25, 1024
  ds_read_b128 v[24:27], v8 offset:8192
  v_mul_f32 v99, s24, v99
  v_cvt_pk_bf16_f32 v129, v98, v99
  v_mfma_f32_32x32x16_bf16 v[80:95], a[20:23], v[32:35], v[80:95]
  s_waitcnt lgkmcnt(5)
  buffer_load_dwordx4 v17, s[12:15], s19 offen sc1 lds
  v_mul_f32 v100, s24, v100
  v_mul_f32 v101, s24, v101
  v_mfma_f32_32x32x16_bf16 v[64:79], a[24:27], v[36:39], v[64:79]
  ds_read_b128 v[28:31], v9 offset:8192
  v_cvt_pk_bf16_f32 v130, v100, v101
  v_mul_f32 v102, s24, v102
  v_mfma_f32_32x32x16_bf16 v[80:95], a[28:31], v[36:39], v[80:95]
  s_waitcnt lgkmcnt(5)
  v_mul_f32 v103, s24, v103
  v_cvt_pk_bf16_f32 v131, v102, v103
  v_mfma_f32_32x32x16_bf16 v[64:79], a[32:35], v[40:43], v[64:79]
  s_add_u32 m0, s25, 2048
  ds_read_b128 v[32:35], v10 offset:8192
  v_mul_f32 v104, s24, v104
  v_mul_f32 v105, s24, v105
  v_mfma_f32_32x32x16_bf16 v[80:95], a[36:39], v[40:43], v[80:95]
  s_waitcnt lgkmcnt(5)
  buffer_load_dwordx4 v18, s[12:15], s19 offen sc1 lds
  v_cvt_pk_bf16_f32 v132, v104, v105
  v_mul_f32 v106, s24, v106
  v_mfma_f32_32x32x16_bf16 v[64:79], a[40:43], v[44:47], v[64:79]
  ds_read_b128 v[36:39], v11 offset:8192
  v_mul_f32 v107, s24, v107
  v_cvt_pk_bf16_f32 v133, v106, v107
  v_mfma_f32_32x32x16_bf16 v[80:95], a[44:47], v[44:47], v[80:95]
  s_waitcnt lgkmcnt(5)
  v_mul_f32 v108, s24, v108
  v_mul_f32 v109, s24, v109
  v_mfma_f32_32x32x16_bf16 v[64:79], a[48:51], v[48:51], v[64:79]
  s_add_u32 m0, s25, 3072
  ds_read_b128 v[40:43], v12 offset:8192
  v_cvt_pk_bf16_f32 v134, v108, v109
  v_mul_f32 v110, s24, v110
  v_mfma_f32_32x32x16_bf16 v[80:95], a[52:55], v[48:51], v[80:95]
  s_waitcnt lgkmcnt(5)
  buffer_load_dwordx4 v19, s[12:15], s19 offen sc1 lds
  v_mul_f32 v111, s24, v111
  v_cvt_pk_bf16_f32 v135, v110, v111
  v_mfma_f32_32x32x16_bf16 v[64:79], a[56:59], v[52:55], v[64:79]
  ds_read_b128 v[44:47], v13 offset:8192
  v_mul_f32 v112, s24, v112
  v_mul_f32 v113, s24, v113
  v_mfma_f32_32x32x16_bf16 v[80:95], a[60:63], v[52:55], v[80:95]
  s_waitcnt lgkmcnt(5)
  v_cvt_pk_bf16_f32 v136, v112, v113
  v_mul_f32 v114, s24, v114
  v_mfma_f32_32x32x16_bf16 v[64:79], a[64:67], v[24:27], v[64:79]
  s_add_u32 m0, s25, 4096
  ds_read_b128 v[48:51], v14 offset:8192
  v_mul_f32 v115, s24, v115
  v_cvt_pk_bf16_f32 v137, v114, v115
  v_mfma_f32_32x32x16_bf16 v[80:95], a[68:71], v[24:27], v[80:95]
  s_waitcnt lgkmcnt(5)
  buffer_load_dwordx4 v20, s[12:15], s19 offen sc1 lds
  v_mul_f32 v116, s24, v116
  v_mul_f32 v117, s24, v117
  v_mfma_f32_32x32x16_bf16 v[64:79], a[72:75], v[28:31], v[64:79]
  ds_read_b128 v[52:55], v15 offset:8192
  v_cvt_pk_bf16_f32 v138, v116, v117
  v_mul_f32 v118, s24, v118
  v_mfma_f32_32x32x16_bf16 v[80:95], a[76:79], v[28:31], v[80:95]
  s_waitcnt lgkmcnt(5)
  v_mul_f32 v119, s24, v119
  v_cvt_pk_bf16_f32 v139, v118, v119
  v_mfma_f32_32x32x16_bf16 v[64:79], a[80:83], v[32:35], v[64:79]
  s_add_u32 m0, s25, 5120
  ds_read_b128 v[24:27], v8 offset:16384
  v_mul_f32 v120, s24, v120
  v_mul_f32 v121, s24, v121
  v_mfma_f32_32x32x16_bf16 v[80:95], a[84:87], v[32:35], v[80:95]
  s_waitcnt lgkmcnt(5)
  buffer_load_dwordx4 v21, s[12:15], s19 offen sc1 lds
  v_cvt_pk_bf16_f32 v140, v120, v121
  v_mul_f32 v122, s24, v122
  v_mfma_f32_32x32x16_bf16 v[64:79], a[88:91], v[36:39], v[64:79]
  ds_read_b128 v[28:31], v9 offset:16384
  v_mul_f32 v123, s24, v123
  v_cvt_pk_bf16_f32 v141, v122, v123
  v_mfma_f32_32x32x16_bf16 v[80:95], a[92:95], v[36:39], v[80:95]
  s_waitcnt lgkmcnt(5)
  v_mul_f32 v124, s24, v124
  v_mul_f32 v125, s24, v125
  v_mfma_f32_32x32x16_bf16 v[64:79], a[96:99], v[40:43], v[64:79]
  s_add_u32 m0, s25, 6144
  ds_read_b128 v[32:35], v10 offset:16384
  v_cvt_pk_bf16_f32 v142, v124, v125
  v_mul_f32 v126, s24, v126
  v_mfma_f32_32x32x16_bf16 v[80:95], a[100:103], v[40:43], v[80:95]
  s_waitcnt lgkmcnt(5)
  buffer_load_dwordx4 v22, s[12:15], s19 offen sc1 lds
  v_mul_f32 v127, s24, v127
  v_cvt_pk_bf16_f32 v143, v126, v127
  v_mfma_f32_32x32x16_bf16 v[64:79], a[104:107], v[44:47], v[64:79]
  ds_read_b128 v[36:39], v11 offset:16384
  v_mfma_f32_32x32x16_bf16 v[80:95], a[108:111], v[44:47], v[80:95]
  s_waitcnt lgkmcnt(5)
  v_mfma_f32_32x32x16_bf16 v[64:79], a[112:115], v[48:51], v[64:79]
  s_add_u32 m0, s25, 7168
  ds_read_b128 v[40:43], v12 offset:16384
  v_mfma_f32_32x32x16_bf16 v[80:95], a[116:119], v[48:51], v[80:95]
  s_waitcnt lgkmcnt(5)
  buffer_load_dwordx4 v23, s[12:15], s19 offen sc1 lds
  v_mfma_f32_32x32x16_bf16 v[64:79], a[120:123], v[52:55], v[64:79]
  s_cmp_gt_u32 s23, 3
  ds_read_b128 v[44:47], v13 offset:16384
  v_mfma_f32_32x32x16_bf16 v[80:95], a[124:127], v[52:55], v[80:95]
  s_waitcnt lgkmcnt(5)
  s_cselect_b32 s26, s20, 0
  v_mfma_f32_32x32x16_bf16 v[64:79], a[128:131], v[24:27], v[64:79]
  s_add_u32 s19, s19, s26
  ds_read_b128 v[48:51], v14 offset:16384
  v_mfma_f32_32x32x16_bf16 v[80:95], a[132:135], v[24:27], v[80:95]
  s_waitcnt lgkmcnt(5)
  s_add_u32 s25, s25, 32768
  v_mfma_f32_32x32x16_bf16 v[64:79], a[136:139], v[28:31], v[64:79]
  s_and_b32 s25, s25, 0x1ffff
  ds_read_b128 v[52:55], v15 offset:16384
  v_mfma_f32_32x32x16_bf16 v[80:95], a[140:143], v[28:31], v[80:95]
  s_waitcnt lgkmcnt(5)
  buffer_store_dwordx4 v[128:131], v7, s[4:7], s21 offen offset:0 sc1
  v_mfma_f32_32x32x16_bf16 v[64:79], a[144:147], v[32:35], v[64:79]
  ds_read_b128 v[24:27], v8 offset:24576
  v_mfma_f32_32x32x16_bf16 v[80:95], a[148:151], v[32:35], v[80:95]
  s_waitcnt lgkmcnt(5)
  v_mfma_f32_32x32x16_bf16 v[64:79], a[152:155], v[36:39], v[64:79]
  ds_read_b128 v[28:31], v9 offset:24576
  v_mfma_f32_32x32x16_bf16 v[80:95], a[156:159], v[36:39], v[80:95]
  s_waitcnt lgkmcnt(5)
  buffer_store_dwordx4 v[132:135], v7, s[4:7], s21 offen offset:1024 sc1
  v_mfma_f32_32x32x16_bf16 v[64:79], a[160:163], v[40:43], v[64:79]
  ds_read_b128 v[32:35], v10 offset:24576
  v_mfma_f32_32x32x16_bf16 v[80:95], a[164:167], v[40:43], v[80:95]
  s_waitcnt lgkmcnt(5)
  v_mfma_f32_32x32x16_bf16 v[64:79], a[168:171], v[44:47], v[64:79]
  ds_read_b128 v[36:39], v11 offset:24576
  v_mfma_f32_32x32x16_bf16 v[80:95], a[172:175], v[44:47], v[80:95]
  s_waitcnt lgkmcnt(5)
  buffer_store_dwordx4 v[136:139], v7, s[4:7], s21 offen offset:2048 sc1
  v_mfma_f32_32x32x16_bf16 v[64:79], a[176:179], v[48:51], v[64:79]
  ds_read_b128 v[40:43], v12 offset:24576
  v_mfma_f32_32x32x16_bf16 v[80:95], a[180:183], v[48:51], v[80:95]
  s_waitcnt lgkmcnt(5)
  v_mfma_f32_32x32x16_bf16 v[64:79], a[184:187], v[52:55], v[64:79]
  ds_read_b128 v[44:47], v13 offset:24576
  v_mfma_f32_32x32x16_bf16 v[80:95], a[188:191], v[52:55], v[80:95]
  s_waitcnt lgkmcnt(5)
  buffer_store_dwordx4 v[140:143], v7, s[4:7], s21 offen offset:3072 sc1
  v_mfma_f32_32x32x16_bf16 v[64:79], a[192:195], v[24:27], v[64:79]
  s_mov_b32 s21, s27
  ds_read_b128 v[48:51], v14 offset:24576
  v_mov_b32 v7, v2
  v_mfma_f32_32x32x16_bf16 v[80:95], a[196:199], v[24:27], v[80:95]
  s_waitcnt lgkmcnt(5)
  v_mfma_f32_32x32x16_bf16 v[64:79], a[200:203], v[28:31], v[64:79]
  s_add_u32 s27, s27, s22
  ds_read_b128 v[52:55], v15 offset:24576
  v_mfma_f32_32x32x16_bf16 v[80:95], a[204:207], v[28:31], v[80:95]
  s_waitcnt lgkmcnt(5)
  s_waitcnt vmcnt(16)
  s_barrier
  v_mfma_f32_32x32x16_bf16 v[64:79], a[208:211], v[32:35], v[64:79]
  ds_read_b128 v[24:27], v8 offset:32768
  v_mfma_f32_32x32x16_bf16 v[80:95], a[212:215], v[32:35], v[80:95]
  s_waitcnt lgkmcnt(5)
  v_mfma_f32_32x32x16_bf16 v[64:79], a[216:219], v[36:39], v[64:79]
  ds_read_b128 v[28:31], v9 offset:32768
  v_mfma_f32_32x32x16_bf16 v[80:95], a[220:223], v[36:39], v[80:95]
  s_waitcnt lgkmcnt(5)
  v_mfma_f32_32x32x16_bf16 v[64:79], a[224:227], v[40:43], v[64:79]
  ds_read_b128 v[32:35], v10 offset:32768
  v_mfma_f32_32x32x16_bf16 v[80:95], a[228:231], v[40:43], v[80:95]
  s_waitcnt lgkmcnt(5)
  v_mfma_f32_32x32x16_bf16 v[64:79], a[232:235], v[44:47], v[64:79]
  ds_read_b128 v[36:39], v11 offset:32768
  v_mfma_f32_32x32x16_bf16 v[80:95], a[236:239], v[44:47], v[80:95]
  s_waitcnt lgkmcnt(5)
  v_mfma_f32_32x32x16_bf16 v[64:79], a[240:243], v[48:51], v[64:79]
  s_sub_u32 s23, s23, 1
  ds_read_b128 v[40:43], v12 offset:32768
  v_mfma_f32_32x32x16_bf16 v[80:95], a[244:247], v[48:51], v[80:95]
  s_waitcnt lgkmcnt(5)
  v_mfma_f32_32x32x16_bf16 v[64:79], a[248:251], v[52:55], v[64:79]
  s_cmp_eq_u32 s23, 0
  ds_read_b128 v[44:47], v13 offset:32768
  v_mfma_f32_32x32x16_bf16 v[80:95], a[252:255], v[52:55], v[80:95]
  s_cbranch_scc1 G_done0_46
  s_waitcnt lgkmcnt(5)
  v_mfma_f32_32x32x16_bf16 v[96:111], a[0:3], v[24:27], 0
  s_add_u32 m0, s25, 0
  ds_read_b128 v[48:51], v14 offset:32768
  v_mfma_f32_32x32x16_bf16 v[112:127], a[4:7], v[24:27], 0
  s_waitcnt lgkmcnt(5)
  buffer_load_dwordx4 v16, s[12:15], s19 offen sc1 lds
  v_mfma_f32_32x32x16_bf16 v[96:111], a[8:11], v[28:31], v[96:111]
  ds_read_b128 v[52:55], v15 offset:32768
  v_mul_f32 v64, s24, v64
  v_mul_f32 v65, s24, v65
  v_mfma_f32_32x32x16_bf16 v[112:127], a[12:15], v[28:31], v[112:127]
  s_waitcnt lgkmcnt(5)
  v_cvt_pk_bf16_f32 v128, v64, v65
  v_mul_f32 v66, s24, v66
  v_mfma_f32_32x32x16_bf16 v[96:111], a[16:19], v[32:35], v[96:111]
  s_add_u32 m0, s25, 1024
  ds_read_b128 v[24:27], v8 offset:40960
  v_mul_f32 v67, s24, v67
  v_cvt_pk_bf16_f32 v129, v66, v67
  v_mfma_f32_32x32x16_bf16 v[112:127], a[20:23], v[32:35], v[112:127]
  s_waitcnt lgkmcnt(5)
  buffer_load_dwordx4 v17, s[12:15], s19 offen sc1 lds
  v_mul_f32 v68, s24, v68
  v_mul_f32 v69, s24, v69
  v_mfma_f32_32x32x16_bf16 v[96:111], a[24:27], v[36:39], v[96:111]
  ds_read_b128 v[28:31], v9 offset:40960
  v_cvt_pk_bf16_f32 v130, v68, v69
  v_mul_f32 v70, s24, v70
  v_mfma_f32_32x32x16_bf16 v[112:127], a[28:31], v[36:39], v[112:127]
  s_waitcnt lgkmcnt(5)
  v_mul_f32 v71, s24, v71
  v_cvt_pk_bf16_f32 v131, v70, v71
  v_mfma_f32_32x32x16_bf16 v[96:111], a[32:35], v[40:43], v[96:111]
  s_add_u32 m0, s25, 2048
  ds_read_b128 v[32:35], v10 offset:40960
  v_mul_f32 v72, s24, v72
  v_mul_f32 v73, s24, v73
  v_mfma_f32_32x32x16_bf16 v[112:127], a[36:39], v[40:43], v[112:127]
  s_waitcnt lgkmcnt(5)
  buffer_load_dwordx4 v18, s[12:15], s19 offen sc1 lds
  v_cvt_pk_bf16_f32 v132, v72, v73
  v_mul_f32 v74, s24, v74
  v_mfma_f32_32x32x16_bf16 v[96:111], a[40:43], v[44:47], v[96:111]
  ds_read_b128 v[36:39], v11 offset:40960
  v_mul_f32 v75, s24, v75
  v_cvt_pk_bf16_f32 v133, v74, v75
  v_mfma_f32_32x32x16_bf16 v[112:127], a[44:47], v[44:47], v[112:127]
  s_waitcnt lgkmcnt(5)
  v_mul_f32 v76, s24, v76
  v_mul_f32 v77, s24, v77
  v_mfma_f32_32x32x16_bf16 v[96:111], a[48:51], v[48:51], v[96:111]
  s_add_u32 m0, s25, 3072
  ds_read_b128 v[40:43], v12 offset:40960
  v_cvt_pk_bf16_f32 v134, v76, v77
  v_mul_f32 v78, s24, v78
  v_mfma_f32_32x32x16_bf16 v[112:127], a[52:55], v[48:51], v[112:127]
  s_waitcnt lgkmcnt(5)
  buffer_load_dwordx4 v19, s[12:15], s19 offen sc1 lds
  v_mul_f32 v79, s24, v79
  v_cvt_pk_bf16_f32 v135, v78, v79
  v_mfma_f32_32x32x16_bf16 v[96:111], a[56:59], v[52:55], v[96:111]
  ds_read_b128 v[44:47], v13 offset:40960
  v_mul_f32 v80, s24, v80
  v_mul_f32 v81, s24, v81
  v_mfma_f32_32x32x16_bf16 v[112:127], a[60:63], v[52:55], v[112:127]
  s_waitcnt lgkmcnt(5)
  v_cvt_pk_bf16_f32 v136, v80, v81
  v_mul_f32 v82, s24, v82
  v_mfma_f32_32x32x16_bf16 v[96:111], a[64:67], v[24:27], v[96:111]
  s_add_u32 m0, s25, 4096
  ds_read_b128 v[48:51], v14 offset:40960
  v_mul_f32 v83, s24, v83
  v_cvt_pk_bf16_f32 v137, v82, v83
  v_mfma_f32_32x32x16_bf16 v[112:127], a[68:71], v[24:27], v[112:127]
  s_waitcnt lgkmcnt(5)
  buffer_load_dwordx4 v20, s[12:15], s19 offen sc1 lds
  v_mul_f32 v84, s24, v84
  v_mul_f32 v85, s24, v85
  v_mfma_f32_32x32x16_bf16 v[96:111], a[72:75], v[28:31], v[96:111]
  ds_read_b128 v[52:55], v15 offset:40960
  v_cvt_pk_bf16_f32 v138, v84, v85
  v_mul_f32 v86, s24, v86
  v_mfma_f32_32x32x16_bf16 v[112:127], a[76:79], v[28:31], v[112:127]
  s_waitcnt lgkmcnt(5)
  v_mul_f32 v87, s24, v87
  v_cvt_pk_bf16_f32 v139, v86, v87
  v_mfma_f32_32x32x16_bf16 v[96:111], a[80:83], v[32:35], v[96:111]
  s_add_u32 m0, s25, 5120
  ds_read_b128 v[24:27], v8 offset:49152
  v_mul_f32 v88, s24, v88
  v_mul_f32 v89, s24, v89
  v_mfma_f32_32x32x16_bf16 v[112:127], a[84:87], v[32:35], v[112:127]
  s_waitcnt lgkmcnt(5)
  buffer_load_dwordx4 v21, s[12:15], s19 offen sc1 lds
  v_cvt_pk_bf16_f32 v140, v88, v89
  v_mul_f32 v90, s24, v90
  v_mfma_f32_32x32x16_bf16 v[96:111], a[88:91], v[36:39], v[96:111]
  ds_read_b128 v[28:31], v9 offset:49152
  v_mul_f32 v91, s24, v91
  v_cvt_pk_bf16_f32 v141, v90, v91
  v_mfma_f32_32x32x16_bf16 v[112:127], a[92:95], v[36:39], v[112:127]
  s_waitcnt lgkmcnt(5)
  v_mul_f32 v92, s24, v92
  v_mul_f32 v93, s24, v93
  v_mfma_f32_32x32x16_bf16 v[96:111], a[96:99], v[40:43], v[96:111]
  s_add_u32 m0, s25, 6144
  ds_read_b128 v[32:35], v10 offset:49152
  v_cvt_pk_bf16_f32 v142, v92, v93
  v_mul_f32 v94, s24, v94
  v_mfma_f32_32x32x16_bf16 v[112:127], a[100:103], v[40:43], v[112:127]
  s_waitcnt lgkmcnt(5)
  buffer_load_dwordx4 v22, s[12:15], s19 offen sc1 lds
  v_mul_f32 v95, s24, v95
  v_cvt_pk_bf16_f32 v143, v94, v95
  v_mfma_f32_32x32x16_bf16 v[96:111], a[104:107], v[44:47], v[96:111]
  ds_read_b128 v[36:39], v11 offset:49152
  v_mfma_f32_32x32x16_bf16 v[112:127], a[108:111], v[44:47], v[112:127]
  s_waitcnt lgkmcnt(5)
  v_mfma_f32_32x32x16_bf16 v[96:111], a[112:115], v[48:51], v[96:111]
  s_add_u32 m0, s25, 7168
  ds_read_b128 v[40:43], v12 offset:49152
  v_mfma_f32_32x32x16_bf16 v[112:127], a[116:119], v[48:51], v[112:127]
  s_waitcnt lgkmcnt(5)
  buffer_load_dwordx4 v23, s[12:15], s19 offen sc1 lds
  v_mfma_f32_32x32x16_bf16 v[96:111], a[120:123], v[52:55], v[96:111]
  s_cmp_gt_u32 s23, 3
  ds_read_b128 v[44:47], v13 offset:49152
  v_mfma_f32_32x32x16_bf16 v[112:127], a[124:127], v[52:55], v[112:127]
  s_waitcnt lgkmcnt(5)
  s_cselect_b32 s26, s20, 0
  v_mfma_f32_32x32x16_bf16 v[96:111], a[128:131], v[24:27], v[96:111]
  s_add_u32 s19, s19, s26
  ds_read_b128 v[48:51], v14 offset:49152
  v_mfma_f32_32x32x16_bf16 v[112:127], a[132:135], v[24:27], v[112:127]
  s_waitcnt lgkmcnt(5)
  s_add_u32 s25, s25, 32768
  v_mfma_f32_32x32x16_bf16 v[96:111], a[136:139], v[28:31], v[96:111]
  s_and_b32 s25, s25, 0x1ffff
  ds_read_b128 v[52:55], v15 offset:49152
  v_mfma_f32_32x32x16_bf16 v[112:127], a[140:143], v[28:31], v[112:127]
  s_waitcnt lgkmcnt(5)
  buffer_store_dwordx4 v[128:131], v7, s[4:7], s21 offen offset:0 sc1
  v_mfma_f32_32x32x16_bf16 v[96:111], a[144:147], v[32:35], v[96:111]
  ds_read_b128 v[24:27], v8 offset:57344
  v_mfma_f32_32x32x16_bf16 v[112:127], a[148:151], v[32:35], v[112:127]
  s_waitcnt lgkmcnt(5)
  v_xor_b32 v8, 0x10000, v8
  v_mfma_f32_32x32x16_bf16 v[96:111], a[152:155], v[36:39], v[96:111]
  ds_read_b128 v[28:31], v9 offset:57344
  v_mfma_f32_32x32x16_bf16 v[112:127], a[156:159], v[36:39], v[112:127]
  s_waitcnt lgkmcnt(5)
  buffer_store_dwordx4 v[132:135], v7, s[4:7], s21 offen offset:1024 sc1
  v_xor_b32 v9, 0x10000, v9
  v_mfma_f32_32x32x16_bf16 v[96:111], a[160:163], v[40:43], v[96:111]
  ds_read_b128 v[32:35], v10 offset:57344
  v_mfma_f32_32x32x16_bf16 v[112:127], a[164:167], v[40:43], v[112:127]
  s_waitcnt lgkmcnt(5)
  v_xor_b32 v10, 0x10000, v10
  v_mfma_f32_32x32x16_bf16 v[96:111], a[168:171], v[44:47], v[96:111]
  ds_read_b128 v[36:39], v11 offset:57344
  v_mfma_f32_32x32x16_bf16 v[112:127], a[172:175], v[44:47], v[112:127]
  s_waitcnt lgkmcnt(5)
  buffer_store_dwordx4 v[136:139], v7, s[4:7], s21 offen offset:2048 sc1
  v_xor_b32 v11, 0x10000, v11
  v_mfma_f32_32x32x16_bf16 v[96:111], a[176:179], v[48:51], v[96:111]
  ds_read_b128 v[40:43], v12 offset:57344
  v_mfma_f32_32x32x16_bf16 v[112:127], a[180:183], v[48:51], v[112:127]
  s_waitcnt lgkmcnt(5)
  v_xor_b32 v12, 0x10000, v12
  v_mfma_f32_32x32x16_bf16 v[96:111], a[184:187], v[52:55], v[96:111]
  ds_read_b128 v[44:47], v13 offset:57344
  v_mfma_f32_32x32x16_bf16 v[112:127], a[188:191], v[52:55], v[112:127]
  s_waitcnt lgkmcnt(5)
  buffer_store_dwordx4 v[140:143], v7, s[4:7], s21 offen offset:3072 sc1
  v_xor_b32 v13, 0x10000, v13
  v_mfma_f32_32x32x16_bf16 v[96:111], a[192:195], v[24:27], v[96:111]
  s_mov_b32 s21, s27
  ds_read_b128 v[48:51], v14 offset:57344
  v_mov_b32 v7, v2
  v_mfma_f32_32x32x16_bf16 v[112:127], a[196:199], v[24:27], v[112:127]
  s_waitcnt lgkmcnt(5)
  v_xor_b32 v14, 0x10000, v14
  v_mfma_f32_32x32x16_bf16 v[96:111], a[200:203], v[28:31], v[96:111]
  s_add_u32 s27, s27, s22
  ds_read_b128 v[52:55], v15 offset:57344
  v_mfma_f32_32x32x16_bf16 v[112:127], a[204:207], v[28:31], v[112:127]
  s_waitcnt lgkmcnt(5)
  s_waitcnt vmcnt(16)
  s_barrier
  v_xor_b32 v15, 0x10000, v15
  v_mfma_f32_32x32x16_bf16 v[96:111], a[208:211], v[32:35], v[96:111]
  ds_read_b128 v[24:27], v8 offset:0
  v_mfma_f32_32x32x16_bf16 v[112:127], a[212:215], v[32:35], v[112:127]
  s_waitcnt lgkmcnt(5)
  v_mfma_f32_32x32x16_bf16 v[96:111], a[216:219], v[36:39], v[96:111]
  ds_read_b128 v[28:31], v9 offset:0
  v_mfma_f32_32x32x16_bf16 v[112:127], a[220:223], v[36:39], v[112:127]
  s_waitcnt lgkmcnt(5)
  v_mfma_f32_32x32x16_bf16 v[96:111], a[224:227], v[40:43], v[96:111]
  ds_read_b128 v[32:35], v10 offset:0
  v_mfma_f32_32x32x16_bf16 v[112:127], a[228:231], v[40:43], v[112:127]
  s_waitcnt lgkmcnt(5)
  v_mfma_f32_32x32x16_bf16 v[96:111], a[232:235], v[44:47], v[96:111]
  ds_read_b128 v[36:39], v11 offset:0
  v_mfma_f32_32x32x16_bf16 v[112:127], a[236:239], v[44:47], v[112:127]
  s_waitcnt lgkmcnt(5)
  v_mfma_f32_32x32x16_bf16 v[96:111], a[240:243], v[48:51], v[96:111]
  s_sub_u32 s23, s23, 1
  ds_read_b128 v[40:43], v12 offset:0
  v_mfma_f32_32x32x16_bf16 v[112:127], a[244:247], v[48:51], v[112:127]
  s_waitcnt lgkmcnt(5)
  v_mfma_f32_32x32x16_bf16 v[96:111], a[248:251], v[52:55], v[96:111]
  s_cmp_eq_u32 s23, 0
  ds_read_b128 v[44:47], v13 offset:0
  v_mfma_f32_32x32x16_bf16 v[112:127], a[252:255], v[52:55], v[112:127]
  s_cbranch_scc1 G_done1_47
  s_branch G_top_45
G_done0_46:
  s_nop 7
  s_nop 3
  v_mul_f32 v64, s24, v64
  v_mul_f32 v65, s24, v65
  v_cvt_pk_bf16_f32 v128, v64, v65
  v_mul_f32 v66, s24, v66
  v_mul_f32 v67, s24, v67
  v_cvt_pk_bf16_f32 v129, v66, v67
  v_mul_f32 v68, s24, v68
  v_mul_f32 v69, s24, v69
  v_cvt_pk_bf16_f32 v130, v68, v69
  v_mul_f32 v70, s24, v70
  v_mul_f32 v71, s24, v71
  v_cvt_pk_bf16_f32 v131, v70, v71
  buffer_store_dwordx4 v[128:131], v7, s[4:7], s21 offen offset:0 sc1
  v_mul_f32 v72, s24, v72
  v_mul_f32 v73, s24, v73
  v_cvt_pk_bf16_f32 v132, v72, v73
  v_mul_f32 v74, s24, v74
  v_mul_f32 v75, s24, v75
  v_cvt_pk_bf16_f32 v133, v74, v75
  v_mul_f32 v76, s24, v76
  v_mul_f32 v77, s24, v77
  v_cvt_pk_bf16_f32 v134, v76, v77
  v_mul_f32 v78, s24, v78
  v_mul_f32 v79, s24, v79
  v_cvt_pk_bf16_f32 v135, v78, v79
  buffer_store_dwordx4 v[132:135], v7, s[4:7], s21 offen offset:1024 sc1
  v_mul_f32 v80, s24, v80
  v_mul_f32 v81, s24, v81
  v_cvt_pk_bf16_f32 v136, v80, v81
  v_mul_f32 v82, s24, v82
  v_mul_f32 v83, s24, v83
  v_cvt_pk_bf16_f32 v137, v82, v83
  v_mul_f32 v84, s24, v84
  v_mul_f32 v85, s24, v85
  v_cvt_pk_bf16_f32 v138, v84, v85
  v_mul_f32 v86, s24, v86
  v_mul_f32 v87, s24, v87
  v_cvt_pk_bf16_f32 v139, v86, v87
  buffer_store_dwordx4 v[136:139], v7, s[4:7], s21 offen offset:2048 sc1
  v_mul_f32 v88, s24, v88
  v_mul_f32 v89, s24, v89
  v_cvt_pk_bf16_f32 v140, v88, v89
  v_mul_f32 v90, s24, v90
  v_mul_f32 v91, s24, v91
  v_cvt_pk_bf16_f32 v141, v90, v91
  v_mul_f32 v92, s24, v92
  v_mul_f32 v93, s24, v93
  v_cvt_pk_bf16_f32 v142, v92, v93
  v_mul_f32 v94, s24, v94
  v_mul_f32 v95, s24, v95
  v_cvt_pk_bf16_f32 v143, v94, v95
  buffer_store_dwordx4 v[140:143], v7, s[4:7], s21 offen offset:3072 sc1
  s_branch G_fin_48
G_done1_47:
  s_nop 7
  s_nop 3
  v_mul_f32 v96, s24, v96
  v_mul_f32 v97, s24, v97
  v_cvt_pk_bf16_f32 v128, v96, v97
  v_mul_f32 v98, s24, v98
  v_mul_f32 v99, s24, v99
  v_cvt_pk_bf16_f32 v129, v98, v99
  v_mul_f32 v100, s24, v100
  v_mul_f32 v101, s24, v101
  v_cvt_pk_bf16_f32 v130, v100, v101
  v_mul_f32 v102, s24, v102
  v_mul_f32 v103, s24, v103
  v_cvt_pk_bf16_f32 v131, v102, v103
  buffer_store_dwordx4 v[128:131], v7, s[4:7], s21 offen offset:0 sc1
  v_mul_f32 v104, s24, v104
  v_mul_f32 v105, s24, v105
  v_cvt_pk_bf16_f32 v132, v104, v105
  v_mul_f32 v106, s24, v106
  v_mul_f32 v107, s24, v107
  v_cvt_pk_bf16_f32 v133, v106, v107
  v_mul_f32 v108, s24, v108
  v_mul_f32 v109, s24, v109
  v_cvt_pk_bf16_f32 v134, v108, v109
  v_mul_f32 v110, s24, v110
  v_mul_f32 v111, s24, v111
  v_cvt_pk_bf16_f32 v135, v110, v111
  buffer_store_dwordx4 v[132:135], v7, s[4:7], s21 offen offset:1024 sc1
  v_mul_f32 v112, s24, v112
  v_mul_f32 v113, s24, v113
  v_cvt_pk_bf16_f32 v136, v112, v113
  v_mul_f32 v114, s24, v114
  v_mul_f32 v115, s24, v115
  v_cvt_pk_bf16_f32 v137, v114, v115
  v_mul_f32 v116, s24, v116
  v_mul_f32 v117, s24, v117
  v_cvt_pk_bf16_f32 v138, v116, v117
  v_mul_f32 v118, s24, v118
  v_mul_f32 v119, s24, v119
  v_cvt_pk_bf16_f32 v139, v118, v119
  buffer_store_dwordx4 v[136:139], v7, s[4:7], s21 offen offset:2048 sc1
  v_mul_f32 v120, s24, v120
  v_mul_f32 v121, s24, v121
  v_cvt_pk_bf16_f32 v140, v120, v121
  v_mul_f32 v122, s24, v122
  v_mul_f32 v123, s24, v123
  v_cvt_pk_bf16_f32 v141, v122, v123
  v_mul_f32 v124, s24, v124
  v_mul_f32 v125, s24, v125
  v_cvt_pk_bf16_f32 v142, v124, v125
  v_mul_f32 v126, s24, v126
  v_mul_f32 v127, s24, v127
  v_cvt_pk_bf16_f32 v143, v126, v127
  buffer_store_dwordx4 v[140:143], v7, s[4:7], s21 offen offset:3072 sc1
G_fin_48:
  s_waitcnt vmcnt(0) lgkmcnt(0)
  s_barrier
  s_waitcnt vmcnt(0)
  s_barrier
  s_mov_b32 s30, 768
  v_mov_b32 v144, s30
  v_min_u32 v145, 1, v0
  v_lshlrev_b32 v145, 30, v145
  buffer_store_dword v144, v145, s[4:7], s31 offen sc1
  s_mul_i32 s50, s64, 6
  s_add_u32 s50, s50, s65
  s_mul_i32 s76, s50, 21846
  s_lshr_b32 s76, s76, 16
  s_mul_i32 s77, s76, 3
  s_add_u32 s51, s50, 64
  s_cmp_eq_u32 s77, s50
  s_cselect_b32 s50, s76, s51
M_fin:
  s_lshr_b32 s48, s50, 2
  s_and_b32 s49, s50, 3
  s_load_dwordx2 s[8:9], s[0:1], 0
  s_load_dwordx2 s[12:13], s[0:1], 104
  s_load_dwordx2 s[32:33], s[0:1], 112
  v_and_b32 v4, 31, v1
  v_lshrrev_b32 v5, 5, v1
  v_lshlrev_b32 v5, 4, v5
  v_lshl_add_u32 v6, v4, 10, v5
  s_lshl_b32 s26, s16, 8
  s_lshl_b32 s27, s48, 15
  s_add_u32 s27, s27, s26
  s_waitcnt lgkmcnt(0)
  s_and_b32 s9, s9, 0xffff
  s_mov_b32 s10, 2097152
  s_mov_b32 s11, 0x20000
  s_and_b32 s13, s13, 0xffff
  s_mov_b32 s14, 1024
  s_mov_b32 s15, 0x20000
  s_and_b32 s33, s33, 0xffff
  s_mov_b32 s34, 2097152
  s_mov_b32 s35, 0x20000
  buffer_load_dwordx4 v[16:19], v6, s[8:11], s27 offen offset:0
  buffer_load_dwordx4 v[48:51], v5, s[12:15], s26 offen offset:0
  buffer_load_dwordx4 v[20:23], v6, s[8:11], s27 offen offset:32
  buffer_load_dwordx4 v[52:55], v5, s[12:15], s26 offen offset:32
  buffer_load_dwordx4 v[24:27], v6, s[8:11], s27 offen offset:64
  buffer_load_dwordx4 v[56:59], v5, s[12:15], s26 offen offset:64
  buffer_load_dwordx4 v[28:31], v6, s[8:11], s27 offen offset:96
  buffer_load_dwordx4 v[60:63], v5, s[12:15], s26 offen offset:96
  buffer_load_dwordx4 v[32:35], v6, s[8:11], s27 offen offset:128
  buffer_load_dwordx4 v[64:67], v5, s[12:15], s26 offen offset:128
  buffer_load_dwordx4 v[36:39], v6, s[8:11], s27 offen offset:160
  buffer_load_dwordx4 v[68:71], v5, s[12:15], s26 offen offset:160
  buffer_load_dwordx4 v[40:43], v6, s[8:11], s27 offen offset:192
  buffer_load_dwordx4 v[72:75], v5, s[12:15], s26 offen offset:192
  buffer_load_dwordx4 v[44:47], v6, s[8:11], s27 offen offset:224
  buffer_load_dwordx4 v[76:79], v5, s[12:15], s26 offen offset:224
  s_lshl_b32 s28, s48, 2
  s_add_u32 s28, s28, s49
  s_lshl_b32 s28, s28, 2
  s_add_u32 s28, s28, s16
  s_lshl_b32 s28, s28, 11
  s_waitcnt vmcnt(14)
  v_mfma_f32_32x32x16_bf16 v[80:95], v[48:51], v[16:19], 0
  s_waitcnt vmcnt(12)
  v_mfma_f32_32x32x16_bf16 v[80:95], v[52:55], v[20:23], v[80:95]
  s_waitcnt vmcnt(10)
  v_mfma_f32_32x32x16_bf16 v[80:95], v[56:59], v[24:27], v[80:95]
  s_waitcnt vmcnt(8)
  v_mfma_f32_32x32x16_bf16 v[80:95], v[60:63], v[28:31], v[80:95]
  s_waitcnt vmcnt(6)
  v_mfma_f32_32x32x16_bf16 v[80:95], v[64:67], v[32:35], v[80:95]
  s_waitcnt vmcnt(4)
  v_mfma_f32_32x32x16_bf16 v[80:95], v[68:71], v[36:39], v[80:95]
  s_waitcnt vmcnt(2)
  v_mfma_f32_32x32x16_bf16 v[80:95], v[72:75], v[40:43], v[80:95]
  s_waitcnt vmcnt(0)
  v_mfma_f32_32x32x16_bf16 v[80:95], v[76:79], v[44:47], v[80:95]
  s_mul_i32 s76, s48, 43
  s_lshr_b32 s76, s76, 9
  s_mul_i32 s76, s76, 12
  s_sub_u32 s76, s48, s76
  s_cmp_ge_u32 s76, 6
  s_addc_u32 s76, s76, 0
  s_and_b32 s77, s49, 2
  s_mul_i32 s77, s77, 7
  s_add_u32 s76, s76, s77
  v_mov_b32 v193, 0x300
  s_lshl_b32 s76, s76, 7
  s_add_u32 s76, s76, 148897792
  v_and_b32 v192, 7, v1
  v_mul_u32_u24 v192, 3584, v192
  v_add_u32 v192, s76, v192
  s_mov_b32 s71, 0
  s_branch M_vg_50
M_vw_49:
  s_sleep 2
  s_add_u32 s71, s71, 1
  s_cmp_gt_u32 s71, 262144
  s_cbranch_scc1 M_exit
M_vg_50:
  buffer_load_dword v194, v192, s[4:7], 0 offen sc1
  s_waitcnt vmcnt(0)
  v_cmp_lt_u32 vcc, v194, v193
  s_cbranch_vccnz M_vw_49
  s_add_u32 s29, s28, 150994944
  buffer_load_dwordx4 v[96:99], v2, s[4:7], s29 offen offset:0 sc1
  buffer_load_dwordx4 v[100:103], v2, s[4:7], s29 offen offset:1024 sc1
  s_add_u32 s29, s28, 153092096
  buffer_load_dwordx4 v[104:107], v2, s[4:7], s29 offen offset:0 sc1
  buffer_load_dwordx4 v[108:111], v2, s[4:7], s29 offen offset:1024 sc1
  s_add_u32 s29, s28, 155189248
  buffer_load_dwordx4 v[112:115], v2, s[4:7], s29 offen offset:0 sc1
  buffer_load_dwordx4 v[116:119], v2, s[4:7], s29 offen offset:1024 sc1
  s_add_u32 s29, s28, 157286400
  buffer_load_dwordx4 v[120:123], v2, s[4:7], s29 offen offset:0 sc1
  buffer_load_dwordx4 v[124:127], v2, s[4:7], s29 offen offset:1024 sc1
  s_add_u32 s29, s28, 159383552
  buffer_load_dwordx4 v[128:131], v2, s[4:7], s29 offen offset:0 sc1
  buffer_load_dwordx4 v[132:135], v2, s[4:7], s29 offen offset:1024 sc1
  s_add_u32 s29, s28, 161480704
  buffer_load_dwordx4 v[136:139], v2, s[4:7], s29 offen offset:0 sc1
  buffer_load_dwordx4 v[140:143], v2, s[4:7], s29 offen offset:1024 sc1
  s_add_u32 s29, s28, 163577856
  buffer_load_dwordx4 v[144:147], v2, s[4:7], s29 offen offset:0 sc1
  buffer_load_dwordx4 v[148:151], v2, s[4:7], s29 offen offset:1024 sc1
  s_add_u32 s29, s28, 165675008
  buffer_load_dwordx4 v[152:155], v2, s[4:7], s29 offen offset:0 sc1
  buffer_load_dwordx4 v[156:159], v2, s[4:7], s29 offen offset:1024 sc1
  v_lshlrev_b32 v7, 4, v4
  s_lshl_b32 s26, s16, 2
  v_add_u32 v4, s26, v7
  s_barrier
  ds_write_b32 v4, v80
  s_waitcnt lgkmcnt(0)
  s_barrier
  ds_read_b128 v[84:87], v7
  s_waitcnt lgkmcnt(0)
  v_add_f32 v80, v84, v85
  v_add_f32 v81, v86, v87
  v_add_f32 v80, v80, v81
  v_mul_f32 v80, 0xbfb8aa3b, v80
  v_exp_f32 v80, v80
  s_nop 0
  v_add_f32 v80, 1.0, v80
  v_rcp_f32 v80, v80
  s_nop 0
  v_sub_f32 v82, 1.0, v80
  s_waitcnt vmcnt(14)
  v_lshlrev_b32 v160, 16, v96
  v_and_b32 v161, 0xffff0000, v96
  v_lshlrev_b32 v162, 16, v97
  v_and_b32 v163, 0xffff0000, v97
  v_lshlrev_b32 v164, 16, v98
  v_and_b32 v165, 0xffff0000, v98
  v_lshlrev_b32 v166, 16, v99
  v_and_b32 v167, 0xffff0000, v99
  v_lshlrev_b32 v168, 16, v100
  v_and_b32 v169, 0xffff0000, v100
  v_lshlrev_b32 v170, 16, v101
  v_and_b32 v171, 0xffff0000, v101
  v_lshlrev_b32 v172, 16, v102
  v_and_b32 v173, 0xffff0000, v102
  v_lshlrev_b32 v174, 16, v103
  v_and_b32 v175, 0xffff0000, v103
  s_waitcnt vmcnt(12)
  v_lshlrev_b32 v8, 16, v104
  v_and_b32 v9, 0xffff0000, v104
  v_pk_add_f32 v[160:161], v[160:161], v[8:9]
  v_lshlrev_b32 v10, 16, v105
  v_and_b32 v11, 0xffff0000, v105
  v_pk_add_f32 v[162:163], v[162:163], v[10:11]
  v_lshlrev_b32 v12, 16, v106
  v_and_b32 v13, 0xffff0000, v106
  v_pk_add_f32 v[164:165], v[164:165], v[12:13]
  v_lshlrev_b32 v14, 16, v107
  v_and_b32 v15, 0xffff0000, v107
  v_pk_add_f32 v[166:167], v[166:167], v[14:15]
  v_lshlrev_b32 v8, 16, v108
  v_and_b32 v9, 0xffff0000, v108
  v_pk_add_f32 v[168:169], v[168:169], v[8:9]
  v_lshlrev_b32 v10, 16, v109
  v_and_b32 v11, 0xffff0000, v109
  v_pk_add_f32 v[170:171], v[170:171], v[10:11]
  v_lshlrev_b32 v12, 16, v110
  v_and_b32 v13, 0xffff0000, v110
  v_pk_add_f32 v[172:173], v[172:173], v[12:13]
  v_lshlrev_b32 v14, 16, v111
  v_and_b32 v15, 0xffff0000, v111
  v_pk_add_f32 v[174:175], v[174:175], v[14:15]
  s_waitcnt vmcnt(10)
  v_lshlrev_b32 v8, 16, v112
  v_and_b32 v9, 0xffff0000, v112
  v_pk_add_f32 v[160:161], v[160:161], v[8:9]
  v_lshlrev_b32 v10, 16, v113
  v_and_b32 v11, 0xffff0000, v113
  v_pk_add_f32 v[162:163], v[162:163], v[10:11]
  v_lshlrev_b32 v12, 16, v114
  v_and_b32 v13, 0xffff0000, v114
  v_pk_add_f32 v[164:165], v[164:165], v[12:13]
  v_lshlrev_b32 v14, 16, v115
  v_and_b32 v15, 0xffff0000, v115
  v_pk_add_f32 v[166:167], v[166:167], v[14:15]
  v_lshlrev_b32 v8, 16, v116
  v_and_b32 v9, 0xffff0000, v116
  v_pk_add_f32 v[168:169], v[168:169], v[8:9]
  v_lshlrev_b32 v10, 16, v117
  v_and_b32 v11, 0xffff0000, v117
  v_pk_add_f32 v[170:171], v[170:171], v[10:11]
  v_lshlrev_b32 v12, 16, v118
  v_and_b32 v13, 0xffff0000, v118
  v_pk_add_f32 v[172:173], v[172:173], v[12:13]
  v_lshlrev_b32 v14, 16, v119
  v_and_b32 v15, 0xffff0000, v119
  v_pk_add_f32 v[174:175], v[174:175], v[14:15]
  s_waitcnt vmcnt(8)
  v_lshlrev_b32 v8, 16, v120
  v_and_b32 v9, 0xffff0000, v120
  v_pk_add_f32 v[160:161], v[160:161], v[8:9]
  v_lshlrev_b32 v10, 16, v121
  v_and_b32 v11, 0xffff0000, v121
  v_pk_add_f32 v[162:163], v[162:163], v[10:11]
  v_lshlrev_b32 v12, 16, v122
  v_and_b32 v13, 0xffff0000, v122
  v_pk_add_f32 v[164:165], v[164:165], v[12:13]
  v_lshlrev_b32 v14, 16, v123
  v_and_b32 v15, 0xffff0000, v123
  v_pk_add_f32 v[166:167], v[166:167], v[14:15]
  v_lshlrev_b32 v8, 16, v124
  v_and_b32 v9, 0xffff0000, v124
  v_pk_add_f32 v[168:169], v[168:169], v[8:9]
  v_lshlrev_b32 v10, 16, v125
  v_and_b32 v11, 0xffff0000, v125
  v_pk_add_f32 v[170:171], v[170:171], v[10:11]
  v_lshlrev_b32 v12, 16, v126
  v_and_b32 v13, 0xffff0000, v126
  v_pk_add_f32 v[172:173], v[172:173], v[12:13]
  v_lshlrev_b32 v14, 16, v127
  v_and_b32 v15, 0xffff0000, v127
  v_pk_add_f32 v[174:175], v[174:175], v[14:15]
  s_waitcnt vmcnt(6)
  v_lshlrev_b32 v8, 16, v128
  v_and_b32 v9, 0xffff0000, v128
  v_pk_add_f32 v[160:161], v[160:161], v[8:9]
  v_lshlrev_b32 v10, 16, v129
  v_and_b32 v11, 0xffff0000, v129
  v_pk_add_f32 v[162:163], v[162:163], v[10:11]
  v_lshlrev_b32 v12, 16, v130
  v_and_b32 v13, 0xffff0000, v130
  v_pk_add_f32 v[164:165], v[164:165], v[12:13]
  v_lshlrev_b32 v14, 16, v131
  v_and_b32 v15, 0xffff0000, v131
  v_pk_add_f32 v[166:167], v[166:167], v[14:15]
  v_lshlrev_b32 v8, 16, v132
  v_and_b32 v9, 0xffff0000, v132
  v_pk_add_f32 v[168:169], v[168:169], v[8:9]
  v_lshlrev_b32 v10, 16, v133
  v_and_b32 v11, 0xffff0000, v133
  v_pk_add_f32 v[170:171], v[170:171], v[10:11]
  v_lshlrev_b32 v12, 16, v134
  v_and_b32 v13, 0xffff0000, v134
  v_pk_add_f32 v[172:173], v[172:173], v[12:13]
  v_lshlrev_b32 v14, 16, v135
  v_and_b32 v15, 0xffff0000, v135
  v_pk_add_f32 v[174:175], v[174:175], v[14:15]
  s_waitcnt vmcnt(4)
  v_lshlrev_b32 v8, 16, v136
  v_and_b32 v9, 0xffff0000, v136
  v_pk_add_f32 v[160:161], v[160:161], v[8:9]
  v_lshlrev_b32 v10, 16, v137
  v_and_b32 v11, 0xffff0000, v137
  v_pk_add_f32 v[162:163], v[162:163], v[10:11]
  v_lshlrev_b32 v12, 16, v138
  v_and_b32 v13, 0xffff0000, v138
  v_pk_add_f32 v[164:165], v[164:165], v[12:13]
  v_lshlrev_b32 v14, 16, v139
  v_and_b32 v15, 0xffff0000, v139
  v_pk_add_f32 v[166:167], v[166:167], v[14:15]
  v_lshlrev_b32 v8, 16, v140
  v_and_b32 v9, 0xffff0000, v140
  v_pk_add_f32 v[168:169], v[168:169], v[8:9]
  v_lshlrev_b32 v10, 16, v141
  v_and_b32 v11, 0xffff0000, v141
  v_pk_add_f32 v[170:171], v[170:171], v[10:11]
  v_lshlrev_b32 v12, 16, v142
  v_and_b32 v13, 0xffff0000, v142
  v_pk_add_f32 v[172:173], v[172:173], v[12:13]
  v_lshlrev_b32 v14, 16, v143
  v_and_b32 v15, 0xffff0000, v143
  v_pk_add_f32 v[174:175], v[174:175], v[14:15]
  s_waitcnt vmcnt(2)
  v_lshlrev_b32 v8, 16, v144
  v_and_b32 v9, 0xffff0000, v144
  v_pk_add_f32 v[160:161], v[160:161], v[8:9]
  v_lshlrev_b32 v10, 16, v145
  v_and_b32 v11, 0xffff0000, v145
  v_pk_add_f32 v[162:163], v[162:163], v[10:11]
  v_lshlrev_b32 v12, 16, v146
  v_and_b32 v13, 0xffff0000, v146
  v_pk_add_f32 v[164:165], v[164:165], v[12:13]
  v_lshlrev_b32 v14, 16, v147
  v_and_b32 v15, 0xffff0000, v147
  v_pk_add_f32 v[166:167], v[166:167], v[14:15]
  v_lshlrev_b32 v8, 16, v148
  v_and_b32 v9, 0xffff0000, v148
  v_pk_add_f32 v[168:169], v[168:169], v[8:9]
  v_lshlrev_b32 v10, 16, v149
  v_and_b32 v11, 0xffff0000, v149
  v_pk_add_f32 v[170:171], v[170:171], v[10:11]
  v_lshlrev_b32 v12, 16, v150
  v_and_b32 v13, 0xffff0000, v150
  v_pk_add_f32 v[172:173], v[172:173], v[12:13]
  v_lshlrev_b32 v14, 16, v151
  v_and_b32 v15, 0xffff0000, v151
  v_pk_add_f32 v[174:175], v[174:175], v[14:15]
  s_waitcnt vmcnt(0)
  v_lshlrev_b32 v8, 16, v152
  v_and_b32 v9, 0xffff0000, v152
  v_pk_add_f32 v[160:161], v[160:161], v[8:9]
  v_lshlrev_b32 v10, 16, v153
  v_and_b32 v11, 0xffff0000, v153
  v_pk_add_f32 v[162:163], v[162:163], v[10:11]
  v_lshlrev_b32 v12, 16, v154
  v_and_b32 v13, 0xffff0000, v154
  v_pk_add_f32 v[164:165], v[164:165], v[12:13]
  v_lshlrev_b32 v14, 16, v155
  v_and_b32 v15, 0xffff0000, v155
  v_pk_add_f32 v[166:167], v[166:167], v[14:15]
  v_lshlrev_b32 v8, 16, v156
  v_and_b32 v9, 0xffff0000, v156
  v_pk_add_f32 v[168:169], v[168:169], v[8:9]
  v_lshlrev_b32 v10, 16, v157
  v_and_b32 v11, 0xffff0000, v157
  v_pk_add_f32 v[170:171], v[170:171], v[10:11]
  v_lshlrev_b32 v12, 16, v158
  v_and_b32 v13, 0xffff0000, v158
  v_pk_add_f32 v[172:173], v[172:173], v[12:13]
  v_lshlrev_b32 v14, 16, v159
  v_and_b32 v15, 0xffff0000, v159
  v_pk_add_f32 v[174:175], v[174:175], v[14:15]
  s_and_b32 s76, s48, 1
  s_lshl_b32 s76, s76, 1
  s_lshr_b32 s77, s49, 1
  s_add_u32 s76, s76, s77
  s_mul_i32 s76, s76, 7
  s_add_u32 s76, s76, 6
  s_lshr_b32 s77, s48, 1
  s_add_u32 s77, s77, 0x201
  v_mov_b32 v193, s77
  s_lshl_b32 s76, s76, 7
  s_add_u32 s76, s76, 148897792
  v_and_b32 v192, 7, v1
  v_mul_u32_u24 v192, 3584, v192
  v_add_u32 v192, s76, v192
  s_mov_b32 s71, 0
  s_branch M_vg_52
M_vw_51:
  s_sleep 2
  s_add_u32 s71, s71, 1
  s_cmp_gt_u32 s71, 262144
  s_cbranch_scc1 M_exit
M_vg_52:
  buffer_load_dword v194, v192, s[4:7], 0 offen sc1
  s_waitcnt vmcnt(0)
  v_cmp_lt_u32 vcc, v194, v193
  s_cbranch_vccnz M_vw_51
  s_add_u32 s29, s28, 167772160
  buffer_load_dwordx4 v[96:99], v2, s[4:7], s29 offen offset:0 sc1
  buffer_load_dwordx4 v[100:103], v2, s[4:7], s29 offen offset:1024 sc1
  s_add_u32 s29, s28, 169869312
  buffer_load_dwordx4 v[104:107], v2, s[4:7], s29 offen offset:0 sc1
  buffer_load_dwordx4 v[108:111], v2, s[4:7], s29 offen offset:1024 sc1
  s_add_u32 s29, s28, 171966464
  buffer_load_dwordx4 v[112:115], v2, s[4:7], s29 offen offset:0 sc1
  buffer_load_dwordx4 v[116:119], v2, s[4:7], s29 offen offset:1024 sc1
  s_add_u32 s29, s28, 174063616
  buffer_load_dwordx4 v[120:123], v2, s[4:7], s29 offen offset:0 sc1
  buffer_load_dwordx4 v[124:127], v2, s[4:7], s29 offen offset:1024 sc1
  s_add_u32 s29, s28, 176160768
  buffer_load_dwordx4 v[128:131], v2, s[4:7], s29 offen offset:0 sc1
  buffer_load_dwordx4 v[132:135], v2, s[4:7], s29 offen offset:1024 sc1
  s_add_u32 s29, s28, 178257920
  buffer_load_dwordx4 v[136:139], v2, s[4:7], s29 offen offset:0 sc1
  buffer_load_dwordx4 v[140:143], v2, s[4:7], s29 offen offset:1024 sc1
  s_add_u32 s29, s28, 180355072
  buffer_load_dwordx4 v[144:147], v2, s[4:7], s29 offen offset:0 sc1
  buffer_load_dwordx4 v[148:151], v2, s[4:7], s29 offen offset:1024 sc1
  s_add_u32 s29, s28, 182452224
  buffer_load_dwordx4 v[152:155], v2, s[4:7], s29 offen offset:0 sc1
  buffer_load_dwordx4 v[156:159], v2, s[4:7], s29 offen offset:1024 sc1
  v_pk_mul_f32 v[160:161], v[160:161], v[80:81] op_sel_hi:[1,0]
  v_pk_mul_f32 v[162:163], v[162:163], v[80:81] op_sel_hi:[1,0]
  v_pk_mul_f32 v[164:165], v[164:165], v[80:81] op_sel_hi:[1,0]
  v_pk_mul_f32 v[166:167], v[166:167], v[80:81] op_sel_hi:[1,0]
  v_pk_mul_f32 v[168:169], v[168:169], v[80:81] op_sel_hi:[1,0]
  v_pk_mul_f32 v[170:171], v[170:171], v[80:81] op_sel_hi:[1,0]
  v_pk_mul_f32 v[172:173], v[172:173], v[80:81] op_sel_hi:[1,0]
  v_pk_mul_f32 v[174:175], v[174:175], v[80:81] op_sel_hi:[1,0]
  s_waitcnt vmcnt(14)
  v_lshlrev_b32 v176, 16, v96
  v_and_b32 v177, 0xffff0000, v96
  v_lshlrev_b32 v178, 16, v97
  v_and_b32 v179, 0xffff0000, v97
  v_lshlrev_b32 v180, 16, v98
  v_and_b32 v181, 0xffff0000, v98
  v_lshlrev_b32 v182, 16, v99
  v_and_b32 v183, 0xffff0000, v99
  v_lshlrev_b32 v184, 16, v100
  v_and_b32 v185, 0xffff0000, v100
  v_lshlrev_b32 v186, 16, v101
  v_and_b32 v187, 0xffff0000, v101
  v_lshlrev_b32 v188, 16, v102
  v_and_b32 v189, 0xffff0000, v102
  v_lshlrev_b32 v190, 16, v103
  v_and_b32 v191, 0xffff0000, v103
  s_waitcnt vmcnt(12)
  v_lshlrev_b32 v8, 16, v104
  v_and_b32 v9, 0xffff0000, v104
  v_pk_add_f32 v[176:177], v[176:177], v[8:9]
  v_lshlrev_b32 v10, 16, v105
  v_and_b32 v11, 0xffff0000, v105
  v_pk_add_f32 v[178:179], v[178:179], v[10:11]
  v_lshlrev_b32 v12, 16, v106
  v_and_b32 v13, 0xffff0000, v106
  v_pk_add_f32 v[180:181], v[180:181], v[12:13]
  v_lshlrev_b32 v14, 16, v107
  v_and_b32 v15, 0xffff0000, v107
  v_pk_add_f32 v[182:183], v[182:183], v[14:15]
  v_lshlrev_b32 v8, 16, v108
  v_and_b32 v9, 0xffff0000, v108
  v_pk_add_f32 v[184:185], v[184:185], v[8:9]
  v_lshlrev_b32 v10, 16, v109
  v_and_b32 v11, 0xffff0000, v109
  v_pk_add_f32 v[186:187], v[186:187], v[10:11]
  v_lshlrev_b32 v12, 16, v110
  v_and_b32 v13, 0xffff0000, v110
  v_pk_add_f32 v[188:189], v[188:189], v[12:13]
  v_lshlrev_b32 v14, 16, v111
  v_and_b32 v15, 0xffff0000, v111
  v_pk_add_f32 v[190:191], v[190:191], v[14:15]
  s_waitcnt vmcnt(10)
  v_lshlrev_b32 v8, 16, v112
  v_and_b32 v9, 0xffff0000, v112
  v_pk_add_f32 v[176:177], v[176:177], v[8:9]
  v_lshlrev_b32 v10, 16, v113
  v_and_b32 v11, 0xffff0000, v113
  v_pk_add_f32 v[178:179], v[178:179], v[10:11]
  v_lshlrev_b32 v12, 16, v114
  v_and_b32 v13, 0xffff0000, v114
  v_pk_add_f32 v[180:181], v[180:181], v[12:13]
  v_lshlrev_b32 v14, 16, v115
  v_and_b32 v15, 0xffff0000, v115
  v_pk_add_f32 v[182:183], v[182:183], v[14:15]
  v_lshlrev_b32 v8, 16, v116
  v_and_b32 v9, 0xffff0000, v116
  v_pk_add_f32 v[184:185], v[184:185], v[8:9]
  v_lshlrev_b32 v10, 16, v117
  v_and_b32 v11, 0xffff0000, v117
  v_pk_add_f32 v[186:187], v[186:187], v[10:11]
  v_lshlrev_b32 v12, 16, v118
  v_and_b32 v13, 0xffff0000, v118
  v_pk_add_f32 v[188:189], v[188:189], v[12:13]
  v_lshlrev_b32 v14, 16, v119
  v_and_b32 v15, 0xffff0000, v119
  v_pk_add_f32 v[190:191], v[190:191], v[14:15]
  s_waitcnt vmcnt(8)
  v_lshlrev_b32 v8, 16, v120
  v_and_b32 v9, 0xffff0000, v120
  v_pk_add_f32 v[176:177], v[176:177], v[8:9]
  v_lshlrev_b32 v10, 16, v121
  v_and_b32 v11, 0xffff0000, v121
  v_pk_add_f32 v[178:179], v[178:179], v[10:11]
  v_lshlrev_b32 v12, 16, v122
  v_and_b32 v13, 0xffff0000, v122
  v_pk_add_f32 v[180:181], v[180:181], v[12:13]
  v_lshlrev_b32 v14, 16, v123
  v_and_b32 v15, 0xffff0000, v123
  v_pk_add_f32 v[182:183], v[182:183], v[14:15]
  v_lshlrev_b32 v8, 16, v124
  v_and_b32 v9, 0xffff0000, v124
  v_pk_add_f32 v[184:185], v[184:185], v[8:9]
  v_lshlrev_b32 v10, 16, v125
  v_and_b32 v11, 0xffff0000, v125
  v_pk_add_f32 v[186:187], v[186:187], v[10:11]
  v_lshlrev_b32 v12, 16, v126
  v_and_b32 v13, 0xffff0000, v126
  v_pk_add_f32 v[188:189], v[188:189], v[12:13]
  v_lshlrev_b32 v14, 16, v127
  v_and_b32 v15, 0xffff0000, v127
  v_pk_add_f32 v[190:191], v[190:191], v[14:15]
  s_waitcnt vmcnt(6)
  v_lshlrev_b32 v8, 16, v128
  v_and_b32 v9, 0xffff0000, v128
  v_pk_add_f32 v[176:177], v[176:177], v[8:9]
  v_lshlrev_b32 v10, 16, v129
  v_and_b32 v11, 0xffff0000, v129
  v_pk_add_f32 v[178:179], v[178:179], v[10:11]
  v_lshlrev_b32 v12, 16, v130
  v_and_b32 v13, 0xffff0000, v130
  v_pk_add_f32 v[180:181], v[180:181], v[12:13]
  v_lshlrev_b32 v14, 16, v131
  v_and_b32 v15, 0xffff0000, v131
  v_pk_add_f32 v[182:183], v[182:183], v[14:15]
  v_lshlrev_b32 v8, 16, v132
  v_and_b32 v9, 0xffff0000, v132
  v_pk_add_f32 v[184:185], v[184:185], v[8:9]
  v_lshlrev_b32 v10, 16, v133
  v_and_b32 v11, 0xffff0000, v133
  v_pk_add_f32 v[186:187], v[186:187], v[10:11]
  v_lshlrev_b32 v12, 16, v134
  v_and_b32 v13, 0xffff0000, v134
  v_pk_add_f32 v[188:189], v[188:189], v[12:13]
  v_lshlrev_b32 v14, 16, v135
  v_and_b32 v15, 0xffff0000, v135
  v_pk_add_f32 v[190:191], v[190:191], v[14:15]
  s_waitcnt vmcnt(4)
  v_lshlrev_b32 v8, 16, v136
  v_and_b32 v9, 0xffff0000, v136
  v_pk_add_f32 v[176:177], v[176:177], v[8:9]
  v_lshlrev_b32 v10, 16, v137
  v_and_b32 v11, 0xffff0000, v137
  v_pk_add_f32 v[178:179], v[178:179], v[10:11]
  v_lshlrev_b32 v12, 16, v138
  v_and_b32 v13, 0xffff0000, v138
  v_pk_add_f32 v[180:181], v[180:181], v[12:13]
  v_lshlrev_b32 v14, 16, v139
  v_and_b32 v15, 0xffff0000, v139
  v_pk_add_f32 v[182:183], v[182:183], v[14:15]
  v_lshlrev_b32 v8, 16, v140
  v_and_b32 v9, 0xffff0000, v140
  v_pk_add_f32 v[184:185], v[184:185], v[8:9]
  v_lshlrev_b32 v10, 16, v141
  v_and_b32 v11, 0xffff0000, v141
  v_pk_add_f32 v[186:187], v[186:187], v[10:11]
  v_lshlrev_b32 v12, 16, v142
  v_and_b32 v13, 0xffff0000, v142
  v_pk_add_f32 v[188:189], v[188:189], v[12:13]
  v_lshlrev_b32 v14, 16, v143
  v_and_b32 v15, 0xffff0000, v143
  v_pk_add_f32 v[190:191], v[190:191], v[14:15]
  s_waitcnt vmcnt(2)
  v_lshlrev_b32 v8, 16, v144
  v_and_b32 v9, 0xffff0000, v144
  v_pk_add_f32 v[176:177], v[176:177], v[8:9]
  v_lshlrev_b32 v10, 16, v145
  v_and_b32 v11, 0xffff0000, v145
  v_pk_add_f32 v[178:179], v[178:179], v[10:11]
  v_lshlrev_b32 v12, 16, v146
  v_and_b32 v13, 0xffff0000, v146
  v_pk_add_f32 v[180:181], v[180:181], v[12:13]
  v_lshlrev_b32 v14, 16, v147
  v_and_b32 v15, 0xffff0000, v147
  v_pk_add_f32 v[182:183], v[182:183], v[14:15]
  v_lshlrev_b32 v8, 16, v148
  v_and_b32 v9, 0xffff0000, v148
  v_pk_add_f32 v[184:185], v[184:185], v[8:9]
  v_lshlrev_b32 v10, 16, v149
  v_and_b32 v11, 0xffff0000, v149
  v_pk_add_f32 v[186:187], v[186:187], v[10:11]
  v_lshlrev_b32 v12, 16, v150
  v_and_b32 v13, 0xffff0000, v150
  v_pk_add_f32 v[188:189], v[188:189], v[12:13]
  v_lshlrev_b32 v14, 16, v151
  v_and_b32 v15, 0xffff0000, v151
  v_pk_add_f32 v[190:191], v[190:191], v[14:15]
  s_waitcnt vmcnt(0)
  v_lshlrev_b32 v8, 16, v152
  v_and_b32 v9, 0xffff0000, v152
  v_pk_add_f32 v[176:177], v[176:177], v[8:9]
  v_lshlrev_b32 v10, 16, v153
  v_and_b32 v11, 0xffff0000, v153
  v_pk_add_f32 v[178:179], v[178:179], v[10:11]
  v_lshlrev_b32 v12, 16, v154
  v_and_b32 v13, 0xffff0000, v154
  v_pk_add_f32 v[180:181], v[180:181], v[12:13]
  v_lshlrev_b32 v14, 16, v155
  v_and_b32 v15, 0xffff0000, v155
  v_pk_add_f32 v[182:183], v[182:183], v[14:15]
  v_lshlrev_b32 v8, 16, v156
  v_and_b32 v9, 0xffff0000, v156
  v_pk_add_f32 v[184:185], v[184:185], v[8:9]
  v_lshlrev_b32 v10, 16, v157
  v_and_b32 v11, 0xffff0000, v157
  v_pk_add_f32 v[186:187], v[186:187], v[10:11]
  v_lshlrev_b32 v12, 16, v158
  v_and_b32 v13, 0xffff0000, v158
  v_pk_add_f32 v[188:189], v[188:189], v[12:13]
  v_lshlrev_b32 v14, 16, v159
  v_and_b32 v15, 0xffff0000, v159
  v_pk_add_f32 v[190:191], v[190:191], v[14:15]
  v_pk_fma_f32 v[160:161], v[176:177], v[82:83], v[160:161] op_sel_hi:[1,0,1]
  v_cvt_pk_bf16_f32 v16, v160, v161
  v_pk_fma_f32 v[162:163], v[178:179], v[82:83], v[162:163] op_sel_hi:[1,0,1]
  v_cvt_pk_bf16_f32 v17, v162, v163
  v_pk_fma_f32 v[164:165], v[180:181], v[82:83], v[164:165] op_sel_hi:[1,0,1]
  v_cvt_pk_bf16_f32 v18, v164, v165
  v_pk_fma_f32 v[166:167], v[182:183], v[82:83], v[166:167] op_sel_hi:[1,0,1]
  v_cvt_pk_bf16_f32 v19, v166, v167
  v_pk_fma_f32 v[168:169], v[184:185], v[82:83], v[168:169] op_sel_hi:[1,0,1]
  v_cvt_pk_bf16_f32 v20, v168, v169
  v_pk_fma_f32 v[170:171], v[186:187], v[82:83], v[170:171] op_sel_hi:[1,0,1]
  v_cvt_pk_bf16_f32 v21, v170, v171
  v_pk_fma_f32 v[172:173], v[188:189], v[82:83], v[172:173] op_sel_hi:[1,0,1]
  v_cvt_pk_bf16_f32 v22, v172, v173
  v_pk_fma_f32 v[174:175], v[190:191], v[82:83], v[174:175] op_sel_hi:[1,0,1]
  v_cvt_pk_bf16_f32 v23, v174, v175
  s_lshl_b32 s26, s49, 2
  s_add_u32 s26, s26, s16
  s_lshl_b32 s26, s26, 6
  s_lshl_b32 s27, s48, 15
  s_add_u32 s26, s26, s27
  buffer_store_dwordx4 v[16:19], v6, s[32:35], s26 offen offset:0
  buffer_store_dwordx4 v[20:23], v6, s[32:35], s26 offen offset:32
  s_cmp_lt_u32 s50, 64
  s_mov_b32 s50, s51
  s_cbranch_scc1 M_fin
  s_branch M_done
M_follow:
  s_lshr_b32 s48, s64, 2
  s_and_b32 s49, s64, 1
  s_bfe_u32 s50, s64, 0x10001
  s_mov_b32 s51, 2
  s_mov_b32 s23, 32
  s_load_dwordx2 s[8:9], s[0:1], 88
  s_lshl_b32 s17, s48, 19
  s_lshl_b32 s26, s49, 2
  s_add_u32 s26, s26, s16
  s_lshl_b32 s27, s26, 7
  s_add_u32 s17, s17, s27
  s_mov_b32 s18, 1024
  s_lshl_b32 s21, s48, 6
  s_add_u32 s21, s21, s50
  s_lshl_b32 s21, s21, 3
  s_add_u32 s21, s21, s26
  s_lshl_b32 s21, s21, 12
  s_add_u32 s21, s21, 167772160
  s_lshl_b32 s22, s51, 15
  s_mov_b32 s24, 1.0
  s_waitcnt lgkmcnt(0)
  s_and_b32 s9, s9, 0xffff
  s_mov_b32 s10, 4194304
  s_mov_b32 s11, 0x20000
  s_mul_i32 s26, s16, 0
  v_add_u32 v8, 0, v2
  v_add_u32 v16, s26, v8
  v_add_u32 v9, 1024, v2
  v_add_u32 v17, s26, v9
  v_add_u32 v10, 2048, v2
  v_add_u32 v18, s26, v10
  v_add_u32 v11, 3072, v2
  v_add_u32 v19, s26, v11
  v_add_u32 v12, 4096, v2
  v_add_u32 v20, s26, v12
  v_add_u32 v13, 5120, v2
  v_add_u32 v21, s26, v13
  v_add_u32 v14, 6144, v2
  v_add_u32 v22, s26, v14
  v_add_u32 v15, 7168, v2
  v_add_u32 v23, s26, v15
  v_lshrrev_b32 v144, 3, v1
  v_mul_lo_u32 v144, v144, s18
  v_and_b32 v145, 7, v1
  v_lshl_add_u32 v144, v145, 4, v144
  s_lshl_b32 s28, s16, 15
  s_add_u32 s28, s28, 32768
  s_lshl_b32 s29, s18, 3
  s_add_u32 m0, s28, 0
  s_nop 0
  buffer_load_dwordx4 v144, s[8:11], s17 offen lds
  s_add_u32 s17, s17, s29
  s_add_u32 m0, s28, 1024
  s_nop 0
  buffer_load_dwordx4 v144, s[8:11], s17 offen lds
  s_add_u32 s17, s17, s29
  s_add_u32 m0, s28, 2048
  s_nop 0
  buffer_load_dwordx4 v144, s[8:11], s17 offen lds
  s_add_u32 s17, s17, s29
  s_add_u32 m0, s28, 3072
  s_nop 0
  buffer_load_dwordx4 v144, s[8:11], s17 offen lds
  s_add_u32 s17, s17, s29
  s_add_u32 m0, s28, 4096
  s_nop 0
  buffer_load_dwordx4 v144, s[8:11], s17 offen lds
  s_add_u32 s17, s17, s29
  s_add_u32 m0, s28, 5120
  s_nop 0
  buffer_load_dwordx4 v144, s[8:11], s17 offen lds
  s_add_u32 s17, s17, s29
  s_add_u32 m0, s28, 6144
  s_nop 0
  buffer_load_dwordx4 v144, s[8:11], s17 offen lds
  s_add_u32 s17, s17, s29
  s_add_u32 m0, s28, 7168
  s_nop 0
  buffer_load_dwordx4 v144, s[8:11], s17 offen lds
  s_add_u32 s17, s17, s29
  s_add_u32 m0, s28, 8192
  s_nop 0
  buffer_load_dwordx4 v144, s[8:11], s17 offen lds
  s_add_u32 s17, s17, s29
  s_add_u32 m0, s28, 9216
  s_nop 0
  buffer_load_dwordx4 v144, s[8:11], s17 offen lds
  s_add_u32 s17, s17, s29
  s_add_u32 m0, s28, 10240
  s_nop 0
  buffer_load_dwordx4 v144, s[8:11], s17 offen lds
  s_add_u32 s17, s17, s29
  s_add_u32 m0, s28, 11264
  s_nop 0
  buffer_load_dwordx4 v144, s[8:11], s17 offen lds
  s_add_u32 s17, s17, s29
  s_add_u32 m0, s28, 12288
  s_nop 0
  buffer_load_dwordx4 v144, s[8:11], s17 offen lds
  s_add_u32 s17, s17, s29
  s_add_u32 m0, s28, 13312
  s_nop 0
  buffer_load_dwordx4 v144, s[8:11], s17 offen lds
  s_add_u32 s17, s17, s29
  s_add_u32 m0, s28, 14336
  s_nop 0
  buffer_load_dwordx4 v144, s[8:11], s17 offen lds
  s_add_u32 s17, s17, s29
  s_add_u32 m0, s28, 15360
  s_nop 0
  buffer_load_dwordx4 v144, s[8:11], s17 offen lds
  s_add_u32 s17, s17, s29
  s_add_u32 m0, s28, 16384
  s_nop 0
  buffer_load_dwordx4 v144, s[8:11], s17 offen lds
  s_add_u32 s17, s17, s29
  s_add_u32 m0, s28, 17408
  s_nop 0
  buffer_load_dwordx4 v144, s[8:11], s17 offen lds
  s_add_u32 s17, s17, s29
  s_add_u32 m0, s28, 18432
  s_nop 0
  buffer_load_dwordx4 v144, s[8:11], s17 offen lds
  s_add_u32 s17, s17, s29
  s_add_u32 m0, s28, 19456
  s_nop 0
  buffer_load_dwordx4 v144, s[8:11], s17 offen lds
  s_add_u32 s17, s17, s29
  s_add_u32 m0, s28, 20480
  s_nop 0
  buffer_load_dwordx4 v144, s[8:11], s17 offen lds
  s_add_u32 s17, s17, s29
  s_add_u32 m0, s28, 21504
  s_nop 0
  buffer_load_dwordx4 v144, s[8:11], s17 offen lds
  s_add_u32 s17, s17, s29
  s_add_u32 m0, s28, 22528
  s_nop 0
  buffer_load_dwordx4 v144, s[8:11], s17 offen lds
  s_add_u32 s17, s17, s29
  s_add_u32 m0, s28, 23552
  s_nop 0
  buffer_load_dwordx4 v144, s[8:11], s17 offen lds
  s_add_u32 s17, s17, s29
  s_add_u32 m0, s28, 24576
  s_nop 0
  buffer_load_dwordx4 v144, s[8:11], s17 offen lds
  s_add_u32 s17, s17, s29
  s_add_u32 m0, s28, 25600
  s_nop 0
  buffer_load_dwordx4 v144, s[8:11], s17 offen lds
  s_add_u32 s17, s17, s29
  s_add_u32 m0, s28, 26624
  s_nop 0
  buffer_load_dwordx4 v144, s[8:11], s17 offen lds
  s_add_u32 s17, s17, s29
  s_add_u32 m0, s28, 27648
  s_nop 0
  buffer_load_dwordx4 v144, s[8:11], s17 offen lds
  s_add_u32 s17, s17, s29
  s_add_u32 m0, s28, 28672
  s_nop 0
  buffer_load_dwordx4 v144, s[8:11], s17 offen lds
  s_add_u32 s17, s17, s29
  s_add_u32 m0, s28, 29696
  s_nop 0
  buffer_load_dwordx4 v144, s[8:11], s17 offen lds
  s_add_u32 s17, s17, s29
  s_add_u32 m0, s28, 30720
  s_nop 0
  buffer_load_dwordx4 v144, s[8:11], s17 offen lds
  s_add_u32 s17, s17, s29
  s_add_u32 m0, s28, 31744
  s_nop 0
  buffer_load_dwordx4 v144, s[8:11], s17 offen lds
  s_add_u32 s17, s17, s29
  v_bfe_u32 v148, v1, 2, 2
  v_lshrrev_b32 v149, 5, v1
  v_lshl_add_u32 v148, v149, 2, v148
  v_lshlrev_b32 v148, 7, v148
  v_bfe_u32 v149, v1, 4, 1
  v_lshl_add_u32 v148, v149, 5, v148
  v_and_b32 v149, 1, v1
  v_lshl_add_u32 v148, v149, 4, v148
  v_bfe_u32 v149, v1, 1, 1
  v_lshl_add_u32 v148, v149, 3, v148
  v_add_u32 v146, s28, v148
  v_add_u32 v147, 1024, v146
  s_waitcnt vmcnt(28)
  ds_read_b64_tr_b16 a[0:1], v146 offset:0
  ds_read_b64_tr_b16 a[2:3], v147 offset:0
  ds_read_b64_tr_b16 a[4:5], v146 offset:64
  ds_read_b64_tr_b16 a[6:7], v147 offset:64
  ds_read_b64_tr_b16 a[8:9], v146 offset:2048
  ds_read_b64_tr_b16 a[10:11], v147 offset:2048
  ds_read_b64_tr_b16 a[12:13], v146 offset:2112
  ds_read_b64_tr_b16 a[14:15], v147 offset:2112
  s_waitcnt lgkmcnt(0)
  s_add_u32 m0, s28, 0
  s_nop 0
  buffer_load_dwordx4 v144, s[8:11], s17 offen lds
  s_add_u32 s17, s17, s29
  s_add_u32 m0, s28, 1024
  s_nop 0
  buffer_load_dwordx4 v144, s[8:11], s17 offen lds
  s_add_u32 s17, s17, s29
  s_add_u32 m0, s28, 2048
  s_nop 0
  buffer_load_dwordx4 v144, s[8:11], s17 offen lds
  s_add_u32 s17, s17, s29
  s_add_u32 m0, s28, 3072
  s_nop 0
  buffer_load_dwordx4 v144, s[8:11], s17 offen lds
  s_add_u32 s17, s17, s29
  s_waitcnt vmcnt(28)
  ds_read_b64_tr_b16 a[16:17], v146 offset:4096
  ds_read_b64_tr_b16 a[18:19], v147 offset:4096
  ds_read_b64_tr_b16 a[20:21], v146 offset:4160
  ds_read_b64_tr_b16 a[22:23], v147 offset:4160
  ds_read_b64_tr_b16 a[24:25], v146 offset:6144
  ds_read_b64_tr_b16 a[26:27], v147 offset:6144
  ds_read_b64_tr_b16 a[28:29], v146 offset:6208
  ds_read_b64_tr_b16 a[30:31], v147 offset:6208
  s_waitcnt lgkmcnt(0)
  s_add_u32 m0, s28, 4096
  s_nop 0
  buffer_load_dwordx4 v144, s[8:11], s17 offen lds
  s_add_u32 s17, s17, s29
  s_add_u32 m0, s28, 5120
  s_nop 0
  buffer_load_dwordx4 v144, s[8:11], s17 offen lds
  s_add_u32 s17, s17, s29
  s_add_u32 m0, s28, 6144
  s_nop 0
  buffer_load_dwordx4 v144, s[8:11], s17 offen lds
  s_add_u32 s17, s17, s29
  s_add_u32 m0, s28, 7168
  s_nop 0
  buffer_load_dwordx4 v144, s[8:11], s17 offen lds
  s_add_u32 s17, s17, s29
  s_waitcnt vmcnt(28)
  ds_read_b64_tr_b16 a[32:33], v146 offset:8192
  ds_read_b64_tr_b16 a[34:35], v147 offset:8192
  ds_read_b64_tr_b16 a[36:37], v146 offset:8256
  ds_read_b64_tr_b16 a[38:39], v147 offset:8256
  ds_read_b64_tr_b16 a[40:41], v146 offset:10240
  ds_read_b64_tr_b16 a[42:43], v147 offset:10240
  ds_read_b64_tr_b16 a[44:45], v146 offset:10304
  ds_read_b64_tr_b16 a[46:47], v147 offset:10304
  s_waitcnt lgkmcnt(0)
  s_add_u32 m0, s28, 8192
  s_nop 0
  buffer_load_dwordx4 v144, s[8:11], s17 offen lds
  s_add_u32 s17, s17, s29
  s_add_u32 m0, s28, 9216
  s_nop 0
  buffer_load_dwordx4 v144, s[8:11], s17 offen lds
  s_add_u32 s17, s17, s29
  s_add_u32 m0, s28, 10240
  s_nop 0
  buffer_load_dwordx4 v144, s[8:11], s17 offen lds
  s_add_u32 s17, s17, s29
  s_add_u32 m0, s28, 11264
  s_nop 0
  buffer_load_dwordx4 v144, s[8:11], s17 offen lds
  s_add_u32 s17, s17, s29
  s_waitcnt vmcnt(28)
  ds_read_b64_tr_b16 a[48:49], v146 offset:12288
  ds_read_b64_tr_b16 a[50:51], v147 offset:12288
  ds_read_b64_tr_b16 a[52:53], v146 offset:12352
  ds_read_b64_tr_b16 a[54:55], v147 offset:12352
  ds_read_b64_tr_b16 a[56:57], v146 offset:14336
  ds_read_b64_tr_b16 a[58:59], v147 offset:14336
  ds_read_b64_tr_b16 a[60:61], v146 offset:14400
  ds_read_b64_tr_b16 a[62:63], v147 offset:14400
  s_waitcnt lgkmcnt(0)
  s_add_u32 m0, s28, 12288
  s_nop 0
  buffer_load_dwordx4 v144, s[8:11], s17 offen lds
  s_add_u32 s17, s17, s29
  s_add_u32 m0, s28, 13312
  s_nop 0
  buffer_load_dwordx4 v144, s[8:11], s17 offen lds
  s_add_u32 s17, s17, s29
  s_add_u32 m0, s28, 14336
  s_nop 0
  buffer_load_dwordx4 v144, s[8:11], s17 offen lds
  s_add_u32 s17, s17, s29
  s_add_u32 m0, s28, 15360
  s_nop 0
  buffer_load_dwordx4 v144, s[8:11], s17 offen lds
  s_add_u32 s17, s17, s29
  s_waitcnt vmcnt(28)
  ds_read_b64_tr_b16 a[64:65], v146 offset:16384
  ds_read_b64_tr_b16 a[66:67], v147 offset:16384
  ds_read_b64_tr_b16 a[68:69], v146 offset:16448
  ds_read_b64_tr_b16 a[70:71], v147 offset:16448
  ds_read_b64_tr_b16 a[72:73], v146 offset:18432
  ds_read_b64_tr_b16 a[74:75], v147 offset:18432
  ds_read_b64_tr_b16 a[76:77], v146 offset:18496
  ds_read_b64_tr_b16 a[78:79], v147 offset:18496
  s_waitcnt lgkmcnt(0)
  s_add_u32 m0, s28, 16384
  s_nop 0
  buffer_load_dwordx4 v144, s[8:11], s17 offen lds
  s_add_u32 s17, s17, s29
  s_add_u32 m0, s28, 17408
  s_nop 0
  buffer_load_dwordx4 v144, s[8:11], s17 offen lds
  s_add_u32 s17, s17, s29
  s_add_u32 m0, s28, 18432
  s_nop 0
  buffer_load_dwordx4 v144, s[8:11], s17 offen lds
  s_add_u32 s17, s17, s29
  s_add_u32 m0, s28, 19456
  s_nop 0
  buffer_load_dwordx4 v144, s[8:11], s17 offen lds
  s_add_u32 s17, s17, s29
  s_waitcnt vmcnt(28)
  ds_read_b64_tr_b16 a[80:81], v146 offset:20480
  ds_read_b64_tr_b16 a[82:83], v147 offset:20480
  ds_read_b64_tr_b16 a[84:85], v146 offset:20544
  ds_read_b64_tr_b16 a[86:87], v147 offset:20544
  ds_read_b64_tr_b16 a[88:89], v146 offset:22528
  ds_read_b64_tr_b16 a[90:91], v147 offset:22528
  ds_read_b64_tr_b16 a[92:93], v146 offset:22592
  ds_read_b64_tr_b16 a[94:95], v147 offset:22592
  s_waitcnt lgkmcnt(0)
  s_add_u32 m0, s28, 20480
  s_nop 0
  buffer_load_dwordx4 v144, s[8:11], s17 offen lds
  s_add_u32 s17, s17, s29
  s_add_u32 m0, s28, 21504
  s_nop 0
  buffer_load_dwordx4 v144, s[8:11], s17 offen lds
  s_add_u32 s17, s17, s29
  s_add_u32 m0, s28, 22528
  s_nop 0
  buffer_load_dwordx4 v144, s[8:11], s17 offen lds
  s_add_u32 s17, s17, s29
  s_add_u32 m0, s28, 23552
  s_nop 0
  buffer_load_dwordx4 v144, s[8:11], s17 offen lds
  s_add_u32 s17, s17, s29
  s_waitcnt vmcnt(28)
  ds_read_b64_tr_b16 a[96:97], v146 offset:24576
  ds_read_b64_tr_b16 a[98:99], v147 offset:24576
  ds_read_b64_tr_b16 a[100:101], v146 offset:24640
  ds_read_b64_tr_b16 a[102:103], v147 offset:24640
  ds_read_b64_tr_b16 a[104:105], v146 offset:26624
  ds_read_b64_tr_b16 a[106:107], v147 offset:26624
  ds_read_b64_tr_b16 a[108:109], v146 offset:26688
  ds_read_b64_tr_b16 a[110:111], v147 offset:26688
  s_waitcnt lgkmcnt(0)
  s_add_u32 m0, s28, 24576
  s_nop 0
  buffer_load_dwordx4 v144, s[8:11], s17 offen lds
  s_add_u32 s17, s17, s29
  s_add_u32 m0, s28, 25600
  s_nop 0
  buffer_load_dwordx4 v144, s[8:11], s17 offen lds
  s_add_u32 s17, s17, s29
  s_add_u32 m0, s28, 26624
  s_nop 0
  buffer_load_dwordx4 v144, s[8:11], s17 offen lds
  s_add_u32 s17, s17, s29
  s_add_u32 m0, s28, 27648
  s_nop 0
  buffer_load_dwordx4 v144, s[8:11], s17 offen lds
  s_add_u32 s17, s17, s29
  s_waitcnt vmcnt(28)
  ds_read_b64_tr_b16 a[112:113], v146 offset:28672
  ds_read_b64_tr_b16 a[114:115], v147 offset:28672
  ds_read_b64_tr_b16 a[116:117], v146 offset:28736
  ds_read_b64_tr_b16 a[118:119], v147 offset:28736
  ds_read_b64_tr_b16 a[120:121], v146 offset:30720
  ds_read_b64_tr_b16 a[122:123], v147 offset:30720
  ds_read_b64_tr_b16 a[124:125], v146 offset:30784
  ds_read_b64_tr_b16 a[126:127], v147 offset:30784
  s_waitcnt lgkmcnt(0)
  s_add_u32 m0, s28, 28672
  s_nop 0
  buffer_load_dwordx4 v144, s[8:11], s17 offen lds
  s_add_u32 s17, s17, s29
  s_add_u32 m0, s28, 29696
  s_nop 0
  buffer_load_dwordx4 v144, s[8:11], s17 offen lds
  s_add_u32 s17, s17, s29
  s_add_u32 m0, s28, 30720
  s_nop 0
  buffer_load_dwordx4 v144, s[8:11], s17 offen lds
  s_add_u32 s17, s17, s29
  s_add_u32 m0, s28, 31744
  s_nop 0
  buffer_load_dwordx4 v144, s[8:11], s17 offen lds
  s_add_u32 s17, s17, s29
  s_waitcnt vmcnt(28)
  ds_read_b64_tr_b16 a[128:129], v146 offset:0
  ds_read_b64_tr_b16 a[130:131], v147 offset:0
  ds_read_b64_tr_b16 a[132:133], v146 offset:64
  ds_read_b64_tr_b16 a[134:135], v147 offset:64
  ds_read_b64_tr_b16 a[136:137], v146 offset:2048
  ds_read_b64_tr_b16 a[138:139], v147 offset:2048
  ds_read_b64_tr_b16 a[140:141], v146 offset:2112
  ds_read_b64_tr_b16 a[142:143], v147 offset:2112
  s_waitcnt lgkmcnt(0)
  s_waitcnt vmcnt(24)
  ds_read_b64_tr_b16 a[144:145], v146 offset:4096
  ds_read_b64_tr_b16 a[146:147], v147 offset:4096
  ds_read_b64_tr_b16 a[148:149], v146 offset:4160
  ds_read_b64_tr_b16 a[150:151], v147 offset:4160
  ds_read_b64_tr_b16 a[152:153], v146 offset:6144
  ds_read_b64_tr_b16 a[154:155], v147 offset:6144
  ds_read_b64_tr_b16 a[156:157], v146 offset:6208
  ds_read_b64_tr_b16 a[158:159], v147 offset:6208
  s_waitcnt lgkmcnt(0)
  s_waitcnt vmcnt(20)
  ds_read_b64_tr_b16 a[160:161], v146 offset:8192
  ds_read_b64_tr_b16 a[162:163], v147 offset:8192
  ds_read_b64_tr_b16 a[164:165], v146 offset:8256
  ds_read_b64_tr_b16 a[166:167], v147 offset:8256
  ds_read_b64_tr_b16 a[168:169], v146 offset:10240
  ds_read_b64_tr_b16 a[170:171], v147 offset:10240
  ds_read_b64_tr_b16 a[172:173], v146 offset:10304
  ds_read_b64_tr_b16 a[174:175], v147 offset:10304
  s_waitcnt lgkmcnt(0)
  s_waitcnt vmcnt(16)
  ds_read_b64_tr_b16 a[176:177], v146 offset:12288
  ds_read_b64_tr_b16 a[178:179], v147 offset:12288
  ds_read_b64_tr_b16 a[180:181], v146 offset:12352
  ds_read_b64_tr_b16 a[182:183], v147 offset:12352
  ds_read_b64_tr_b16 a[184:185], v146 offset:14336
  ds_read_b64_tr_b16 a[186:187], v147 offset:14336
  ds_read_b64_tr_b16 a[188:189], v146 offset:14400
  ds_read_b64_tr_b16 a[190:191], v147 offset:14400
  s_waitcnt lgkmcnt(0)
  s_waitcnt vmcnt(12)
  ds_read_b64_tr_b16 a[192:193], v146 offset:16384
  ds_read_b64_tr_b16 a[194:195], v147 offset:16384
  ds_read_b64_tr_b16 a[196:197], v146 offset:16448
  ds_read_b64_tr_b16 a[198:199], v147 offset:16448
  ds_read_b64_tr_b16 a[200:201], v146 offset:18432
  ds_read_b64_tr_b16 a[202:203], v147 offset:18432
  ds_read_b64_tr_b16 a[204:205], v146 offset:18496
  ds_read_b64_tr_b16 a[206:207], v147 offset:18496
  s_waitcnt lgkmcnt(0)
  s_waitcnt vmcnt(8)
  ds_read_b64_tr_b16 a[208:209], v146 offset:20480
  ds_read_b64_tr_b16 a[210:211], v147 offset:20480
  ds_read_b64_tr_b16 a[212:213], v146 offset:20544
  ds_read_b64_tr_b16 a[214:215], v147 offset:20544
  ds_read_b64_tr_b16 a[216:217], v146 offset:22528
  ds_read_b64_tr_b16 a[218:219], v147 offset:22528
  ds_read_b64_tr_b16 a[220:221], v146 offset:22592
  ds_read_b64_tr_b16 a[222:223], v147 offset:22592
  s_waitcnt lgkmcnt(0)
  s_waitcnt vmcnt(4)
  ds_read_b64_tr_b16 a[224:225], v146 offset:24576
  ds_read_b64_tr_b16 a[226:227], v147 offset:24576
  ds_read_b64_tr_b16 a[228:229], v146 offset:24640
  ds_read_b64_tr_b16 a[230:231], v147 offset:24640
  ds_read_b64_tr_b16 a[232:233], v146 offset:26624
  ds_read_b64_tr_b16 a[234:235], v147 offset:26624
  ds_read_b64_tr_b16 a[236:237], v146 offset:26688
  ds_read_b64_tr_b16 a[238:239], v147 offset:26688
  s_waitcnt lgkmcnt(0)
  s_waitcnt vmcnt(0)
  ds_read_b64_tr_b16 a[240:241], v146 offset:28672
  ds_read_b64_tr_b16 a[242:243], v147 offset:28672
  ds_read_b64_tr_b16 a[244:245], v146 offset:28736
  ds_read_b64_tr_b16 a[246:247], v147 offset:28736
  ds_read_b64_tr_b16 a[248:249], v146 offset:30720
  ds_read_b64_tr_b16 a[250:251], v147 offset:30720
  ds_read_b64_tr_b16 a[252:253], v146 offset:30784
  ds_read_b64_tr_b16 a[254:255], v147 offset:30784
  s_waitcnt lgkmcnt(0)
  s_lshl_b32 s26, s48, 2
  s_add_u32 s26, s26, s16
  s_lshl_b32 s27, s26, 6
  s_add_u32 s27, s27, s50
  s_lshl_b32 s19, s27, 13
  s_lshl_b32 s27, s50, 5
  s_add_u32 s27, s27, s26
  s_mul_i32 s27, s27, 4096
  s_add_u32 s20, s27, 135266304
  s_lshl_b32 s25, s16, 12
  s_add_u32 s25, s25, 65536
  s_lshl_b32 s26, s16, 13
  v_add_u32 v3, s26, v2
  v_lshrrev_b32 v16, 5, v1
  v_and_b32 v17, 31, v1
  v_bfe_u32 v18, v1, 4, 1
  v_lshl_add_u32 v18, v18, 1, v16
  v_and_b32 v19, 15, v1
  v_lshl_add_u32 v18, v18, 4, v19
  v_lshl_add_u32 v5, v18, 4, s25
  v_bfe_u32 v18, v1, 2, 2
  v_lshl_add_u32 v18, v16, 2, v18
  v_and_b32 v19, 1, v1
  v_lshl_add_u32 v18, v19, 4, v18
  v_lshl_add_u32 v4, v18, 4, s25
  v_lshlrev_b32 v16, 2, v16
  v_sub_u32 v17, v17, v16
  v_mov_b32 v18, 0xf149f2ca
  v_cmp_le_i32 vcc, 0, v17
  s_nop 1
  v_cndmask_b32 v240, v18, 0, vcc
  v_cmp_le_i32 vcc, 1, v17
  s_nop 1
  v_cndmask_b32 v241, v18, 0, vcc
  v_cmp_le_i32 vcc, 2, v17
  s_nop 1
  v_cndmask_b32 v242, v18, 0, vcc
  v_cmp_le_i32 vcc, 3, v17
  s_nop 1
  v_cndmask_b32 v243, v18, 0, vcc
  v_cmp_le_i32 vcc, 8, v17
  s_nop 1
  v_cndmask_b32 v244, v18, 0, vcc
  v_cmp_le_i32 vcc, 9, v17
  s_nop 1
  v_cndmask_b32 v245, v18, 0, vcc
  v_cmp_le_i32 vcc, 10, v17
  s_nop 1
  v_cndmask_b32 v246, v18, 0, vcc
  v_cmp_le_i32 vcc, 11, v17
  s_nop 1
  v_cndmask_b32 v247, v18, 0, vcc
  v_cmp_le_i32 vcc, 16, v17
  s_nop 1
  v_cndmask_b32 v248, v18, 0, vcc
  v_cmp_le_i32 vcc, 17, v17
  s_nop 1
  v_cndmask_b32 v249, v18, 0, vcc
  v_cmp_le_i32 vcc, 18, v17
  s_nop 1
  v_cndmask_b32 v250, v18, 0, vcc
  v_cmp_le_i32 vcc, 19, v17
  s_nop 1
  v_cndmask_b32 v251, v18, 0, vcc
  v_cmp_le_i32 vcc, 24, v17
  s_nop 1
  v_cndmask_b32 v252, v18, 0, vcc
  v_cmp_le_i32 vcc, 25, v17
  s_nop 1
  v_cndmask_b32 v253, v18, 0, vcc
  v_cmp_le_i32 vcc, 26, v17
  s_nop 1
  v_cndmask_b32 v254, v18, 0, vcc
  v_cmp_le_i32 vcc, 27, v17
  s_nop 1
  v_cndmask_b32 v255, v18, 0, vcc
  v_mov_b32 v21, v2
  s_barrier
  s_lshl_b32 s77, s48, 2
  s_add_u32 s77, s77, s16
  s_mul_i32 s78, s77, 896
  s_add_u32 s76, s78, 148898304
  s_mov_b32 s71, 0
  s_branch M_sg_55
M_sw_54:
  s_sleep 8
  s_add_u32 s71, s71, 1
  s_cmp_gt_u32 s71, 262144
  s_cbranch_scc1 M_exit
M_sg_55:
  s_mov_b32 s79, 0
  s_atomic_or s79, s[72:73], s76 glc
  s_waitcnt lgkmcnt(0)
  s_cmp_lt_u32 s79, 16
  s_cbranch_scc1 M_sw_54
  s_add_u32 s76, s78, 148898048
  s_mov_b32 s71, 0
  s_branch M_sg_57
M_sw_56:
  s_sleep 8
  s_add_u32 s71, s71, 1
  s_cmp_gt_u32 s71, 262144
  s_cbranch_scc1 M_exit
M_sg_57:
  s_mov_b32 s79, 0
  s_atomic_or s79, s[72:73], s76 glc
  s_waitcnt lgkmcnt(0)
  s_cmp_lt_u32 s79, 16
  s_cbranch_scc1 M_sw_56
M_xok_53:
  s_lshl_b32 s77, s77, 7
  s_add_u32 s54, s77, 148926464
  s_add_u32 s52, s50, 1
  s_mov_b32 s53, 0
  s_mov_b32 s30, 0x200
  s_add_u32 s28, s19, 50331648
  buffer_load_dwordx4 v[144:147], v21, s[4:7], s28 offen offset:0 sc1
  buffer_load_dwordx4 v[148:151], v21, s[4:7], s28 offen offset:1024 sc1
  buffer_load_dwordx4 v[152:155], v21, s[4:7], s28 offen offset:2048 sc1
  buffer_load_dwordx4 v[156:159], v21, s[4:7], s28 offen offset:3072 sc1
  s_add_u32 s29, s19, 50335744
  buffer_load_dwordx4 v[160:163], v21, s[4:7], s29 offen offset:0 sc1
  buffer_load_dwordx4 v[164:167], v21, s[4:7], s29 offen offset:1024 sc1
  buffer_load_dwordx4 v[168:171], v21, s[4:7], s29 offen offset:2048 sc1
  buffer_load_dwordx4 v[172:175], v21, s[4:7], s29 offen offset:3072 sc1
  s_add_u32 s28, s19, 67108864
  buffer_load_dwordx4 v[176:179], v21, s[4:7], s28 offen offset:0 sc1
  buffer_load_dwordx4 v[180:183], v21, s[4:7], s28 offen offset:1024 sc1
  buffer_load_dwordx4 v[184:187], v21, s[4:7], s28 offen offset:2048 sc1
  buffer_load_dwordx4 v[188:191], v21, s[4:7], s28 offen offset:3072 sc1
  s_add_u32 s29, s19, 67112960
  buffer_load_dwordx4 v[192:195], v21, s[4:7], s29 offen offset:0 sc1
  buffer_load_dwordx4 v[196:199], v21, s[4:7], s29 offen offset:1024 sc1
  buffer_load_dwordx4 v[200:203], v21, s[4:7], s29 offen offset:2048 sc1
  buffer_load_dwordx4 v[204:207], v21, s[4:7], s29 offen offset:3072 sc1
  s_add_u32 s28, s19, 83886080
  buffer_load_dwordx4 v[208:211], v21, s[4:7], s28 offen offset:0 sc1
  buffer_load_dwordx4 v[212:215], v21, s[4:7], s28 offen offset:1024 sc1
  buffer_load_dwordx4 v[216:219], v21, s[4:7], s28 offen offset:2048 sc1
  buffer_load_dwordx4 v[220:223], v21, s[4:7], s28 offen offset:3072 sc1
  s_add_u32 s29, s19, 83890176
  buffer_load_dwordx4 v[224:227], v21, s[4:7], s29 offen offset:0 sc1
  buffer_load_dwordx4 v[228:231], v21, s[4:7], s29 offen offset:1024 sc1
  buffer_load_dwordx4 v[232:235], v21, s[4:7], s29 offen offset:2048 sc1
  buffer_load_dwordx4 v[236:239], v21, s[4:7], s29 offen offset:3072 sc1
  s_mov_b32 s24, 0
  v_mov_b32 v22, 0x40000000
  s_sub_u32 s21, s21, s22
F_top_58:
  s_waitcnt vmcnt(8)
  v_mfma_f32_32x32x16_bf16 v[24:39], v[176:179], v[144:147], v[240:255]
  s_nop 1
  v_cvt_pk_bf16_f32 v128, v64, v65
  v_cvt_pk_bf16_f32 v129, v66, v67
  v_cvt_pk_bf16_f32 v130, v68, v69
  v_cvt_pk_bf16_f32 v131, v70, v71
  v_mfma_f32_32x32x16_bf16 v[24:39], v[180:183], v[148:151], v[24:39]
  buffer_store_dwordx4 v[128:131], v22, s[4:7], s21 offen offset:0 sc1
  v_mfma_f32_32x32x16_bf16 v[24:39], v[184:187], v[152:155], v[24:39]
  v_cvt_pk_bf16_f32 v132, v72, v73
  v_cvt_pk_bf16_f32 v133, v74, v75
  v_cvt_pk_bf16_f32 v134, v76, v77
  v_cvt_pk_bf16_f32 v135, v78, v79
  v_mfma_f32_32x32x16_bf16 v[24:39], v[188:191], v[156:159], v[24:39]
  buffer_store_dwordx4 v[132:135], v22, s[4:7], s21 offen offset:1024 sc1
  v_mfma_f32_32x32x16_bf16 v[24:39], v[192:195], v[160:163], v[24:39]
  v_cvt_pk_bf16_f32 v136, v80, v81
  v_cvt_pk_bf16_f32 v137, v82, v83
  v_cvt_pk_bf16_f32 v138, v84, v85
  v_cvt_pk_bf16_f32 v139, v86, v87
  v_mfma_f32_32x32x16_bf16 v[24:39], v[196:199], v[164:167], v[24:39]
  buffer_store_dwordx4 v[136:139], v22, s[4:7], s21 offen offset:2048 sc1
  v_mfma_f32_32x32x16_bf16 v[24:39], v[200:203], v[168:171], v[24:39]
  v_cvt_pk_bf16_f32 v140, v88, v89
  v_cvt_pk_bf16_f32 v141, v90, v91
  v_cvt_pk_bf16_f32 v142, v92, v93
  v_cvt_pk_bf16_f32 v143, v94, v95
  v_mfma_f32_32x32x16_bf16 v[24:39], v[204:207], v[172:175], v[24:39]
  buffer_store_dwordx4 v[140:143], v22, s[4:7], s21 offen offset:3072 sc1
  s_add_u32 s21, s21, s22
  v_mov_b32 v22, v2
  s_cmp_lg_u32 s24, 0
  s_cbranch_scc1 F_have_59
  s_cmp_le_u32 s52, 58
  s_cbranch_scc1 M_dp_60
  s_mov_b32 s71, 0
  v_add_u32 v16, s25, v2
  s_branch M_dp_62
M_dp_61:
  s_sleep 1
  s_add_u32 s71, s71, 1
  s_cmp_gt_u32 s71, 262144
  s_cbranch_scc1 M_exit
M_dp_62:
  buffer_load_dword v23, off, s[4:7], s54 sc1
  buffer_load_dwordx4 v[96:99], v2, s[4:7], s20 offen offset:0 sc1
  buffer_load_dwordx4 v[100:103], v2, s[4:7], s20 offen offset:1024 sc1
  buffer_load_dwordx4 v[104:107], v2, s[4:7], s20 offen offset:2048 sc1
  buffer_load_dwordx4 v[108:111], v2, s[4:7], s20 offen offset:3072 sc1
  s_waitcnt vmcnt(3)
  v_max_u32 v17, v96, v97
  v_max3_u32 v17, v17, v98, v99
  s_waitcnt vmcnt(2)
  v_max3_u32 v17, v17, v100, v101
  v_max3_u32 v17, v17, v102, v103
  s_waitcnt vmcnt(1)
  v_max3_u32 v17, v17, v104, v105
  v_max3_u32 v17, v17, v106, v107
  s_waitcnt vmcnt(0)
  v_max3_u32 v17, v17, v108, v109
  v_max3_u32 v17, v17, v110, v111
  v_cmp_eq_u32 vcc, -1, v17
  s_cbranch_vccz M_dp_63
  v_cmp_gt_u32 vcc, s52, v23
  s_cbranch_vccnz M_dp_61
  s_branch M_dp_60
M_dp_63:
  ds_write_b128 v16, v[96:99] offset:0
  ds_write_b128 v16, v[100:103] offset:1024
  ds_write_b128 v16, v[104:107] offset:2048
  ds_write_b128 v16, v[108:111] offset:3072
  s_branch F_have_59
M_dp_60:
  v_mov_b32 v16, s54
  v_mov_b32 v17, s52
  s_mov_b32 s71, 0
  s_branch M_vg_65
M_vw_64:
  s_sleep 2
  s_add_u32 s71, s71, 1
  s_cmp_gt_u32 s71, 262144
  s_cbranch_scc1 M_exit
M_vg_65:
  buffer_load_dword v23, v16, s[4:7], 0 offen sc1
  s_waitcnt vmcnt(0)
  v_cmp_lt_u32 vcc, v23, v17
  s_cbranch_vccnz M_vw_64
  s_mov_b32 m0, s25
  s_nop 0
  buffer_load_dwordx4 v2, s[4:7], s20 offen offset:0 sc1 lds
  buffer_load_dwordx4 v2, s[4:7], s20 offen offset:1024 sc1 lds
  buffer_load_dwordx4 v2, s[4:7], s20 offen offset:2048 sc1 lds
  buffer_load_dwordx4 v2, s[4:7], s20 offen offset:3072 sc1 lds
  s_waitcnt vmcnt(0)
F_have_59:
  ds_read_b64_tr_b16 v[176:177], v4 offset:8
  ds_read_b64_tr_b16 v[178:179], v4 offset:136
  ds_read_b64_tr_b16 v[180:181], v4 offset:520
  ds_read_b64_tr_b16 v[182:183], v4 offset:648
  ds_read_b64_tr_b16 v[184:185], v4 offset:1032
  ds_read_b64_tr_b16 v[186:187], v4 offset:1160
  ds_read_b64_tr_b16 v[188:189], v4 offset:1544
  ds_read_b64_tr_b16 v[190:191], v4 offset:1672
  ds_read_b64_tr_b16 v[192:193], v4 offset:2056
  ds_read_b64_tr_b16 v[194:195], v4 offset:2184
  ds_read_b64_tr_b16 v[196:197], v4 offset:2568
  ds_read_b64_tr_b16 v[198:199], v4 offset:2696
  s_sub_u32 s23, s23, 1
  s_cmp_gt_u32 s23, 0
  s_cselect_b32 s26, s51, 0
  s_cselect_b32 s27, 0, 0x40000000
  v_or_b32 v21, s27, v21
  s_lshl_b32 s27, s26, 13
  s_add_u32 s19, s19, s27
  s_mul_i32 s27, s26, 131072
  s_add_u32 s20, s20, s27
  s_cmp_lg_u32 s23, 24
  s_cbranch_scc1 M_xok_66
  s_lshl_b32 s77, s48, 2
  s_add_u32 s77, s77, s16
  s_mul_i32 s78, s77, 896
  s_add_u32 s76, s78, 148898304
  s_mov_b32 s71, 0
  s_branch M_sg_68
M_sw_67:
  s_sleep 8
  s_add_u32 s71, s71, 1
  s_cmp_gt_u32 s71, 262144
  s_cbranch_scc1 M_exit
M_sg_68:
  s_mov_b32 s79, 0
  s_atomic_or s79, s[72:73], s76 glc
  s_waitcnt lgkmcnt(0)
  s_cmp_lt_u32 s79, 32
  s_cbranch_scc1 M_sw_67
  s_add_u32 s76, s78, 148898432
  s_mov_b32 s71, 0
  s_branch M_sg_70
M_sw_69:
  s_sleep 8
  s_add_u32 s71, s71, 1
  s_cmp_gt_u32 s71, 262144
  s_cbranch_scc1 M_exit
M_sg_70:
  s_mov_b32 s79, 0
  s_atomic_or s79, s[72:73], s76 glc
  s_waitcnt lgkmcnt(0)
  s_cmp_lt_u32 s79, 32
  s_cbranch_scc1 M_sw_69
  s_add_u32 s76, s78, 148898048
  s_mov_b32 s71, 0
  s_branch M_sg_72
M_sw_71:
  s_sleep 8
  s_add_u32 s71, s71, 1
  s_cmp_gt_u32 s71, 262144
  s_cbranch_scc1 M_exit
M_sg_72:
  s_mov_b32 s79, 0
  s_atomic_or s79, s[72:73], s76 glc
  s_waitcnt lgkmcnt(0)
  s_cmp_lt_u32 s79, 30
  s_cbranch_scc1 M_sw_71
  s_add_u32 s76, s78, 148898176
  s_mov_b32 s71, 0
  s_branch M_sg_74
M_sw_73:
  s_sleep 8
  s_add_u32 s71, s71, 1
  s_cmp_gt_u32 s71, 262144
  s_cbranch_scc1 M_exit
M_sg_74:
  s_mov_b32 s79, 0
  s_atomic_or s79, s[72:73], s76 glc
  s_waitcnt lgkmcnt(0)
  s_cmp_lt_u32 s79, 34
  s_cbranch_scc1 M_sw_73
M_xok_66:
  s_waitcnt lgkmcnt(10)
  v_mfma_f32_32x32x16_bf16 v[40:55], v[176:179], v[144:147], 0
  ds_read_b64_tr_b16 v[200:201], v4 offset:3080
  ds_read_b64_tr_b16 v[202:203], v4 offset:3208
  v_max_f32 v6, v24, v25
  s_waitcnt lgkmcnt(10)
  v_mfma_f32_32x32x16_bf16 v[40:55], v[180:183], v[148:151], v[40:55]
  ds_read_b64_tr_b16 v[204:205], v4 offset:3592
  ds_read_b64_tr_b16 v[206:207], v4 offset:3720
  v_max3_f32 v6, v6, v26, v27
  s_waitcnt lgkmcnt(10)
  v_mfma_f32_32x32x16_bf16 v[40:55], v[184:187], v[152:155], v[40:55]
  ds_read_b64 v[56:57], v5 offset:0
  ds_read_b64 v[58:59], v5 offset:1024
  v_max3_f32 v6, v6, v28, v29
  s_waitcnt lgkmcnt(10)
  v_mfma_f32_32x32x16_bf16 v[40:55], v[188:191], v[156:159], v[40:55]
  ds_read_b64 v[60:61], v5 offset:2048
  ds_read_b64 v[62:63], v5 offset:3072
  v_max3_f32 v6, v6, v30, v31
  s_waitcnt lgkmcnt(10)
  v_mfma_f32_32x32x16_bf16 v[40:55], v[192:195], v[160:163], v[40:55]
  v_max3_f32 v6, v6, v32, v33
  s_waitcnt lgkmcnt(8)
  v_mfma_f32_32x32x16_bf16 v[40:55], v[196:199], v[164:167], v[40:55]
  v_max3_f32 v6, v6, v34, v35
  s_waitcnt lgkmcnt(6)
  v_mfma_f32_32x32x16_bf16 v[40:55], v[200:203], v[168:171], v[40:55]
  v_max3_f32 v6, v6, v36, v37
  s_waitcnt lgkmcnt(4)
  v_mfma_f32_32x32x16_bf16 v[40:55], v[204:207], v[172:175], v[40:55]
  v_max3_f32 v6, v6, v38, v39
  s_add_u32 s28, s19, 50331648
  buffer_load_dwordx4 v[144:147], v21, s[4:7], s28 offen offset:0 sc1
  buffer_load_dwordx4 v[148:151], v21, s[4:7], s28 offen offset:1024 sc1
  s_nop 7
  v_max3_f32 v6, v6, v40, v41
  v_max3_f32 v6, v6, v42, v43
  v_mov_b32 v16, v6
  s_nop 1
  v_permlane32_swap_b32 v6, v16
  s_nop 1
  v_max_f32 v6, v6, v16
  v_pk_add_f32 v[24:25], v[24:25], v[6:7] op_sel_hi:[1,0] neg_lo:[0,1] neg_hi:[0,1]
  v_pk_add_f32 v[26:27], v[26:27], v[6:7] op_sel_hi:[1,0] neg_lo:[0,1] neg_hi:[0,1]
  v_pk_add_f32 v[28:29], v[28:29], v[6:7] op_sel_hi:[1,0] neg_lo:[0,1] neg_hi:[0,1]
  v_pk_add_f32 v[30:31], v[30:31], v[6:7] op_sel_hi:[1,0] neg_lo:[0,1] neg_hi:[0,1]
  v_pk_add_f32 v[32:33], v[32:33], v[6:7] op_sel_hi:[1,0] neg_lo:[0,1] neg_hi:[0,1]
  v_pk_add_f32 v[34:35], v[34:35], v[6:7] op_sel_hi:[1,0] neg_lo:[0,1] neg_hi:[0,1]
  v_pk_add_f32 v[36:37], v[36:37], v[6:7] op_sel_hi:[1,0] neg_lo:[0,1] neg_hi:[0,1]
  v_pk_add_f32 v[38:39], v[38:39], v[6:7] op_sel_hi:[1,0] neg_lo:[0,1] neg_hi:[0,1]
  v_pk_add_f32 v[40:41], v[40:41], v[6:7] op_sel_hi:[1,0] neg_lo:[0,1] neg_hi:[0,1]
  v_pk_add_f32 v[42:43], v[42:43], v[6:7] op_sel_hi:[1,0] neg_lo:[0,1] neg_hi:[0,1]
  v_exp_f32 v24, v24
  v_exp_f32 v25, v25
  v_exp_f32 v26, v26
  v_exp_f32 v27, v27
  v_exp_f32 v28, v28
  v_exp_f32 v29, v29
  v_exp_f32 v30, v30
  v_exp_f32 v31, v31
  v_exp_f32 v32, v32
  v_exp_f32 v33, v33
  buffer_load_dwordx4 v[152:155], v21, s[4:7], s28 offen offset:2048 sc1
  v_exp_f32 v34, v34
  v_exp_f32 v35, v35
  v_exp_f32 v36, v36
  v_exp_f32 v37, v37
  v_exp_f32 v38, v38
  v_exp_f32 v39, v39
  v_exp_f32 v40, v40
  v_exp_f32 v41, v41
  v_exp_f32 v42, v42
  v_exp_f32 v43, v43
  v_pk_add_f32 v[16:17], v[24:25], v[26:27]
  v_pk_add_f32 v[16:17], v[16:17], v[28:29]
  v_pk_add_f32 v[16:17], v[16:17], v[30:31]
  v_pk_add_f32 v[16:17], v[16:17], v[32:33]
  v_pk_add_f32 v[16:17], v[16:17], v[34:35]
  v_pk_add_f32 v[16:17], v[16:17], v[36:37]
  v_pk_add_f32 v[16:17], v[16:17], v[38:39]
  v_pk_add_f32 v[16:17], v[16:17], v[40:41]
  v_pk_add_f32 v[16:17], v[16:17], v[42:43]
  v_add_f32 v16, v16, v17
  v_mov_b32 v17, v16
  buffer_load_dwordx4 v[156:159], v21, s[4:7], s28 offen offset:3072 sc1
  s_nop 0
  v_permlane32_swap_b32 v16, v17
  s_nop 1
  v_add_f32 v16, v16, v17
  v_rcp_f32 v6, v16
  s_nop 0
  v_pk_mul_f32 v[24:25], v[24:25], v[6:7] op_sel_hi:[1,0]
  v_pk_mul_f32 v[26:27], v[26:27], v[6:7] op_sel_hi:[1,0]
  v_pk_mul_f32 v[28:29], v[28:29], v[6:7] op_sel_hi:[1,0]
  v_pk_mul_f32 v[30:31], v[30:31], v[6:7] op_sel_hi:[1,0]
  v_pk_mul_f32 v[32:33], v[32:33], v[6:7] op_sel_hi:[1,0]
  v_pk_mul_f32 v[34:35], v[34:35], v[6:7] op_sel_hi:[1,0]
  v_pk_mul_f32 v[36:37], v[36:37], v[6:7] op_sel_hi:[1,0]
  v_pk_mul_f32 v[38:39], v[38:39], v[6:7] op_sel_hi:[1,0]
  v_pk_mul_f32 v[40:41], v[40:41], v[6:7] op_sel_hi:[1,0]
  v_pk_mul_f32 v[42:43], v[42:43], v[6:7] op_sel_hi:[1,0]
  v_cvt_pk_bf16_f32 v128, v24, v25
  v_cvt_pk_bf16_f32 v129, v26, v27
  v_cvt_pk_bf16_f32 v130, v28, v29
  v_cvt_pk_bf16_f32 v131, v30, v31
  v_cvt_pk_bf16_f32 v132, v32, v33
  v_cvt_pk_bf16_f32 v133, v34, v35
  v_cvt_pk_bf16_f32 v134, v36, v37
  v_cvt_pk_bf16_f32 v135, v38, v39
  v_cvt_pk_bf16_f32 v136, v40, v41
  v_cvt_pk_bf16_f32 v137, v42, v43
  s_waitcnt vmcnt(8) lgkmcnt(0)
  v_mfma_f32_32x32x16_bf16 v[64:79], v[208:211], v[128:131], 0
  s_add_u32 s29, s19, 50335744
  buffer_load_dwordx4 v[160:163], v21, s[4:7], s29 offen offset:0 sc1
  v_mfma_f32_32x32x16_bf16 v[64:79], v[212:215], v[132:135], v[64:79]
  v_mfma_f32_32x32x8_bf16 v[64:79], v[56:57], v[136:137], v[64:79]
  v_mfma_f32_32x32x16_bf16 v[80:95], v[216:219], v[128:131], 0
  buffer_load_dwordx4 v[164:167], v21, s[4:7], s29 offen offset:1024 sc1
  v_mfma_f32_32x32x16_bf16 v[80:95], v[220:223], v[132:135], v[80:95]
  v_cvt_pk_bf16_f32 v24, v64, v65
  v_cvt_pk_bf16_f32 v25, v66, v67
  v_cvt_pk_bf16_f32 v26, v68, v69
  v_cvt_pk_bf16_f32 v27, v70, v71
  v_mfma_f32_32x32x8_bf16 v[80:95], v[58:59], v[136:137], v[80:95]
  ds_write_b128 v3, v[24:27] offset:0
  v_cvt_pk_bf16_f32 v28, v72, v73
  v_cvt_pk_bf16_f32 v29, v74, v75
  v_cvt_pk_bf16_f32 v30, v76, v77
  v_cvt_pk_bf16_f32 v31, v78, v79
  v_mfma_f32_32x32x16_bf16 v[96:111], v[224:227], v[128:131], 0
  ds_write_b128 v3, v[28:31] offset:1024
  buffer_load_dwordx4 v[168:171], v21, s[4:7], s29 offen offset:2048 sc1
  v_mfma_f32_32x32x16_bf16 v[96:111], v[228:231], v[132:135], v[96:111]
  v_cvt_pk_bf16_f32 v32, v80, v81
  v_cvt_pk_bf16_f32 v33, v82, v83
  v_cvt_pk_bf16_f32 v34, v84, v85
  v_cvt_pk_bf16_f32 v35, v86, v87
  v_mfma_f32_32x32x8_bf16 v[96:111], v[60:61], v[136:137], v[96:111]
  ds_write_b128 v3, v[32:35] offset:2048
  v_cvt_pk_bf16_f32 v36, v88, v89
  v_cvt_pk_bf16_f32 v37, v90, v91
  v_cvt_pk_bf16_f32 v38, v92, v93
  v_cvt_pk_bf16_f32 v39, v94, v95
  v_mfma_f32_32x32x16_bf16 v[112:127], v[232:235], v[128:131], 0
  ds_write_b128 v3, v[36:39] offset:3072
  buffer_load_dwordx4 v[172:175], v21, s[4:7], s29 offen offset:3072 sc1
  v_mfma_f32_32x32x16_bf16 v[112:127], v[236:239], v[132:135], v[112:127]
  v_cvt_pk_bf16_f32 v40, v96, v97
  v_cvt_pk_bf16_f32 v41, v98, v99
  v_cvt_pk_bf16_f32 v42, v100, v101
  v_cvt_pk_bf16_f32 v43, v102, v103
  v_mfma_f32_32x32x8_bf16 v[112:127], v[62:63], v[136:137], v[112:127]
  ds_write_b128 v3, v[40:43] offset:4096
  v_cvt_pk_bf16_f32 v44, v104, v105
  v_cvt_pk_bf16_f32 v45, v106, v107
  v_cvt_pk_bf16_f32 v46, v108, v109
  v_cvt_pk_bf16_f32 v47, v110, v111
  ds_write_b128 v3, v[44:47] offset:5120
  s_nop 5
  v_cvt_pk_bf16_f32 v48, v112, v113
  v_cvt_pk_bf16_f32 v49, v114, v115
  v_cvt_pk_bf16_f32 v50, v116, v117
  v_cvt_pk_bf16_f32 v51, v118, v119
  ds_write_b128 v3, v[48:51] offset:6144
  v_cvt_pk_bf16_f32 v52, v120, v121
  v_cvt_pk_bf16_f32 v53, v122, v123
  v_cvt_pk_bf16_f32 v54, v124, v125
  v_cvt_pk_bf16_f32 v55, v126, v127
  ds_write_b128 v3, v[52:55] offset:7168
  s_waitcnt vmcnt(8)
  s_waitcnt lgkmcnt(0)
  s_barrier
  ds_read_b128 v[24:27], v8 offset:0
  ds_read_b128 v[28:31], v9 offset:0
  ds_read_b128 v[32:35], v10 offset:0
  ds_read_b128 v[36:39], v11 offset:0
  ds_read_b128 v[40:43], v12 offset:0
  ds_read_b128 v[44:47], v13 offset:0
  buffer_load_dword v23, off, s[4:7], s54 sc1
  v_mov_b32 v16, s30
  v_min_u32 v17, 1, v0
  v_lshlrev_b32 v17, 30, v17
  buffer_store_dword v16, v17, s[4:7], s31 offen sc1
  s_add_u32 s30, s30, 1
  s_add_u32 s52, s52, 2
  s_waitcnt lgkmcnt(5)
  v_mfma_f32_32x32x16_bf16 v[64:79], a[0:3], v[24:27], 0
  s_add_u32 s28, s19, 67108864
  ds_read_b128 v[48:51], v14 offset:0
  v_mfma_f32_32x32x16_bf16 v[80:95], a[4:7], v[24:27], 0
  s_waitcnt lgkmcnt(5)
  v_mfma_f32_32x32x16_bf16 v[64:79], a[8:11], v[28:31], v[64:79]
  ds_read_b128 v[52:55], v15 offset:0
  v_mfma_f32_32x32x16_bf16 v[80:95], a[12:15], v[28:31], v[80:95]
  s_waitcnt lgkmcnt(5)
  buffer_load_dwordx4 v[176:179], v21, s[4:7], s28 offen offset:0 sc1
  v_mfma_f32_32x32x16_bf16 v[64:79], a[16:19], v[32:35], v[64:79]
  ds_read_b128 v[24:27], v8 offset:8192
  v_mfma_f32_32x32x16_bf16 v[80:95], a[20:23], v[32:35], v[80:95]
  s_waitcnt lgkmcnt(5)
  v_mfma_f32_32x32x16_bf16 v[64:79], a[24:27], v[36:39], v[64:79]
  ds_read_b128 v[28:31], v9 offset:8192
  v_mfma_f32_32x32x16_bf16 v[80:95], a[28:31], v[36:39], v[80:95]
  s_waitcnt lgkmcnt(5)
  buffer_load_dwordx4 v[180:183], v21, s[4:7], s28 offen offset:1024 sc1
  v_mfma_f32_32x32x16_bf16 v[64:79], a[32:35], v[40:43], v[64:79]
  ds_read_b128 v[32:35], v10 offset:8192
  v_mfma_f32_32x32x16_bf16 v[80:95], a[36:39], v[40:43], v[80:95]
  s_waitcnt lgkmcnt(5)
  v_mfma_f32_32x32x16_bf16 v[64:79], a[40:43], v[44:47], v[64:79]
  ds_read_b128 v[36:39], v11 offset:8192
  v_mfma_f32_32x32x16_bf16 v[80:95], a[44:47], v[44:47], v[80:95]
  s_waitcnt lgkmcnt(5)
  buffer_load_dwordx4 v[184:187], v21, s[4:7], s28 offen offset:2048 sc1
  v_mfma_f32_32x32x16_bf16 v[64:79], a[48:51], v[48:51], v[64:79]
  ds_read_b128 v[40:43], v12 offset:8192
  v_mfma_f32_32x32x16_bf16 v[80:95], a[52:55], v[48:51], v[80:95]
  s_waitcnt lgkmcnt(5)
  v_mfma_f32_32x32x16_bf16 v[64:79], a[56:59], v[52:55], v[64:79]
  ds_read_b128 v[44:47], v13 offset:8192
  v_mfma_f32_32x32x16_bf16 v[80:95], a[60:63], v[52:55], v[80:95]
  s_waitcnt lgkmcnt(5)
  buffer_load_dwordx4 v[188:191], v21, s[4:7], s28 offen offset:3072 sc1
  v_mfma_f32_32x32x16_bf16 v[64:79], a[64:67], v[24:27], v[64:79]
  s_add_u32 s29, s19, 67112960
  ds_read_b128 v[48:51], v14 offset:8192
  v_mfma_f32_32x32x16_bf16 v[80:95], a[68:71], v[24:27], v[80:95]
  s_waitcnt lgkmcnt(5)
  v_mfma_f32_32x32x16_bf16 v[64:79], a[72:75], v[28:31], v[64:79]
  ds_read_b128 v[52:55], v15 offset:8192
  v_mfma_f32_32x32x16_bf16 v[80:95], a[76:79], v[28:31], v[80:95]
  s_waitcnt lgkmcnt(5)
  buffer_load_dwordx4 v[192:195], v21, s[4:7], s29 offen offset:0 sc1
  v_mfma_f32_32x32x16_bf16 v[64:79], a[80:83], v[32:35], v[64:79]
  ds_read_b128 v[24:27], v8 offset:16384
  v_mfma_f32_32x32x16_bf16 v[80:95], a[84:87], v[32:35], v[80:95]
  s_waitcnt lgkmcnt(5)
  v_mfma_f32_32x32x16_bf16 v[64:79], a[88:91], v[36:39], v[64:79]
  ds_read_b128 v[28:31], v9 offset:16384
  v_mfma_f32_32x32x16_bf16 v[80:95], a[92:95], v[36:39], v[80:95]
  s_waitcnt lgkmcnt(5)
  buffer_load_dwordx4 v[196:199], v21, s[4:7], s29 offen offset:1024 sc1
  v_mfma_f32_32x32x16_bf16 v[64:79], a[96:99], v[40:43], v[64:79]
  ds_read_b128 v[32:35], v10 offset:16384
  v_mfma_f32_32x32x16_bf16 v[80:95], a[100:103], v[40:43], v[80:95]
  s_waitcnt lgkmcnt(5)
  s_waitcnt vmcnt(7)
  v_readfirstlane_b32 s53, v23
  s_nop 0
  s_cmp_ge_u32 s53, s52
  s_cselect_b32 s24, 1, 0
  s_cbranch_scc0 F_nopre_75
  s_mov_b32 m0, s25
  s_nop 0
  buffer_load_dwordx4 v2, s[4:7], s20 offen offset:0 sc1 lds
  buffer_load_dwordx4 v2, s[4:7], s20 offen offset:1024 sc1 lds
  buffer_load_dwordx4 v2, s[4:7], s20 offen offset:2048 sc1 lds
  buffer_load_dwordx4 v2, s[4:7], s20 offen offset:3072 sc1 lds
F_nopre_75:
  v_mfma_f32_32x32x16_bf16 v[64:79], a[104:107], v[44:47], v[64:79]
  ds_read_b128 v[36:39], v11 offset:16384
  v_mfma_f32_32x32x16_bf16 v[80:95], a[108:111], v[44:47], v[80:95]
  s_waitcnt lgkmcnt(5)
  buffer_load_dwordx4 v[200:203], v21, s[4:7], s29 offen offset:2048 sc1
  v_mfma_f32_32x32x16_bf16 v[64:79], a[112:115], v[48:51], v[64:79]
  ds_read_b128 v[40:43], v12 offset:16384
  v_mfma_f32_32x32x16_bf16 v[80:95], a[116:119], v[48:51], v[80:95]
  s_waitcnt lgkmcnt(5)
  v_mfma_f32_32x32x16_bf16 v[64:79], a[120:123], v[52:55], v[64:79]
  ds_read_b128 v[44:47], v13 offset:16384
  v_mfma_f32_32x32x16_bf16 v[80:95], a[124:127], v[52:55], v[80:95]
  s_waitcnt lgkmcnt(5)
  buffer_load_dwordx4 v[204:207], v21, s[4:7], s29 offen offset:3072 sc1
  v_mfma_f32_32x32x16_bf16 v[64:79], a[128:131], v[24:27], v[64:79]
  s_add_u32 s28, s19, 83886080
  ds_read_b128 v[48:51], v14 offset:16384
  v_mfma_f32_32x32x16_bf16 v[80:95], a[132:135], v[24:27], v[80:95]
  s_waitcnt lgkmcnt(5)
  v_mfma_f32_32x32x16_bf16 v[64:79], a[136:139], v[28:31], v[64:79]
  ds_read_b128 v[52:55], v15 offset:16384
  v_mfma_f32_32x32x16_bf16 v[80:95], a[140:143], v[28:31], v[80:95]
  s_waitcnt lgkmcnt(5)
  buffer_load_dwordx4 v[208:211], v21, s[4:7], s28 offen offset:0 sc1
  v_mfma_f32_32x32x16_bf16 v[64:79], a[144:147], v[32:35], v[64:79]
  ds_read_b128 v[24:27], v8 offset:24576
  v_mfma_f32_32x32x16_bf16 v[80:95], a[148:151], v[32:35], v[80:95]
  s_waitcnt lgkmcnt(5)
  v_mfma_f32_32x32x16_bf16 v[64:79], a[152:155], v[36:39], v[64:79]
  ds_read_b128 v[28:31], v9 offset:24576
  v_mfma_f32_32x32x16_bf16 v[80:95], a[156:159], v[36:39], v[80:95]
  s_waitcnt lgkmcnt(5)
  buffer_load_dwordx4 v[212:215], v21, s[4:7], s28 offen offset:1024 sc1
  v_mfma_f32_32x32x16_bf16 v[64:79], a[160:163], v[40:43], v[64:79]
  ds_read_b128 v[32:35], v10 offset:24576
  v_mfma_f32_32x32x16_bf16 v[80:95], a[164:167], v[40:43], v[80:95]
  s_waitcnt lgkmcnt(5)
  v_mfma_f32_32x32x16_bf16 v[64:79], a[168:171], v[44:47], v[64:79]
  ds_read_b128 v[36:39], v11 offset:24576
  v_mfma_f32_32x32x16_bf16 v[80:95], a[172:175], v[44:47], v[80:95]
  s_waitcnt lgkmcnt(5)
  buffer_load_dwordx4 v[216:219], v21, s[4:7], s28 offen offset:2048 sc1
  v_mfma_f32_32x32x16_bf16 v[64:79], a[176:179], v[48:51], v[64:79]
  ds_read_b128 v[40:43], v12 offset:24576
  v_mfma_f32_32x32x16_bf16 v[80:95], a[180:183], v[48:51], v[80:95]
  s_waitcnt lgkmcnt(5)
  v_mfma_f32_32x32x16_bf16 v[64:79], a[184:187], v[52:55], v[64:79]
  ds_read_b128 v[44:47], v13 offset:24576
  v_mfma_f32_32x32x16_bf16 v[80:95], a[188:191], v[52:55], v[80:95]
  s_waitcnt lgkmcnt(5)
  buffer_load_dwordx4 v[220:223], v21, s[4:7], s28 offen offset:3072 sc1
  v_mfma_f32_32x32x16_bf16 v[64:79], a[192:195], v[24:27], v[64:79]
  s_add_u32 s29, s19, 83890176
  ds_read_b128 v[48:51], v14 offset:24576
  v_mfma_f32_32x32x16_bf16 v[80:95], a[196:199], v[24:27], v[80:95]
  s_waitcnt lgkmcnt(5)
  v_mfma_f32_32x32x16_bf16 v[64:79], a[200:203], v[28:31], v[64:79]
  ds_read_b128 v[52:55], v15 offset:24576
  v_mfma_f32_32x32x16_bf16 v[80:95], a[204:207], v[28:31], v[80:95]
  s_waitcnt lgkmcnt(5)
  buffer_load_dwordx4 v[224:227], v21, s[4:7], s29 offen offset:0 sc1
  v_mfma_f32_32x32x16_bf16 v[64:79], a[208:211], v[32:35], v[64:79]
  v_mfma_f32_32x32x16_bf16 v[80:95], a[212:215], v[32:35], v[80:95]
  s_waitcnt lgkmcnt(4)
  v_mfma_f32_32x32x16_bf16 v[64:79], a[216:219], v[36:39], v[64:79]
  v_xor_b32 v8, 0x8000, v8
  v_mfma_f32_32x32x16_bf16 v[80:95], a[220:223], v[36:39], v[80:95]
  s_waitcnt lgkmcnt(3)
  buffer_load_dwordx4 v[228:231], v21, s[4:7], s29 offen offset:1024 sc1
  v_xor_b32 v9, 0x8000, v9
  v_mfma_f32_32x32x16_bf16 v[64:79], a[224:227], v[40:43], v[64:79]
  v_xor_b32 v10, 0x8000, v10
  v_mfma_f32_32x32x16_bf16 v[80:95], a[228:231], v[40:43], v[80:95]
  s_waitcnt lgkmcnt(2)
  v_xor_b32 v11, 0x8000, v11
  v_mfma_f32_32x32x16_bf16 v[64:79], a[232:235], v[44:47], v[64:79]
  v_xor_b32 v12, 0x8000, v12
  v_mfma_f32_32x32x16_bf16 v[80:95], a[236:239], v[44:47], v[80:95]
  s_waitcnt lgkmcnt(1)
  buffer_load_dwordx4 v[232:235], v21, s[4:7], s29 offen offset:2048 sc1
  v_xor_b32 v13, 0x8000, v13
  v_mfma_f32_32x32x16_bf16 v[64:79], a[240:243], v[48:51], v[64:79]
  v_xor_b32 v14, 0x8000, v14
  v_mfma_f32_32x32x16_bf16 v[80:95], a[244:247], v[48:51], v[80:95]
  s_waitcnt lgkmcnt(0)
  v_xor_b32 v15, 0x8000, v15
  v_mfma_f32_32x32x16_bf16 v[64:79], a[248:251], v[52:55], v[64:79]
  v_xor_b32 v3, 0x8000, v3
  v_mfma_f32_32x32x16_bf16 v[80:95], a[252:255], v[52:55], v[80:95]
  buffer_load_dwordx4 v[236:239], v21, s[4:7], s29 offen offset:3072 sc1
  s_cmp_gt_u32 s23, 0
  s_cbranch_scc1 F_top_58
  s_nop 2
  v_cvt_pk_bf16_f32 v128, v64, v65
  v_cvt_pk_bf16_f32 v129, v66, v67
  v_cvt_pk_bf16_f32 v130, v68, v69
  v_cvt_pk_bf16_f32 v131, v70, v71
  buffer_store_dwordx4 v[128:131], v22, s[4:7], s21 offen offset:0 sc1
  v_cvt_pk_bf16_f32 v132, v72, v73
  v_cvt_pk_bf16_f32 v133, v74, v75
  v_cvt_pk_bf16_f32 v134, v76, v77
  v_cvt_pk_bf16_f32 v135, v78, v79
  buffer_store_dwordx4 v[132:135], v22, s[4:7], s21 offen offset:1024 sc1
  v_cvt_pk_bf16_f32 v136, v80, v81
  v_cvt_pk_bf16_f32 v137, v82, v83
  v_cvt_pk_bf16_f32 v138, v84, v85
  v_cvt_pk_bf16_f32 v139, v86, v87
  buffer_store_dwordx4 v[136:139], v22, s[4:7], s21 offen offset:2048 sc1
  v_cvt_pk_bf16_f32 v140, v88, v89
  v_cvt_pk_bf16_f32 v141, v90, v91
  v_cvt_pk_bf16_f32 v142, v92, v93
  v_cvt_pk_bf16_f32 v143, v94, v95
  buffer_store_dwordx4 v[140:143], v22, s[4:7], s21 offen offset:3072 sc1
  s_waitcnt vmcnt(0) lgkmcnt(0)
  s_barrier
  v_mov_b32 v144, s30
  v_min_u32 v145, 1, v0
  v_lshlrev_b32 v145, 30, v145
  buffer_store_dword v144, v145, s[4:7], s31 offen sc1
  s_branch M_done
M_team:
  s_mov_b32 s12, s77
  s_load_dwordx4 s[60:63], s[0:1], 64
  s_load_dwordx4 s[64:67], s[0:1], 80
  s_load_dwordx4 s[68:71], s[0:1], 120
  s_load_dwordx2 s[72:73], s[0:1], 56
  v_lshrrev_b32 v1, 6, v0
  v_and_b32 v20, 63, v0
  v_readfirstlane_b32 s13, v1
  s_waitcnt lgkmcnt(0)
  s_mov_b32 s8, s60
  s_and_b32 s9, s61, 0xffff
  s_mov_b32 s10, 0x400000
  s_mov_b32 s11, 0x20000
  s_mov_b32 s40, s62
  s_and_b32 s41, s63, 0xffff
  s_mov_b32 s42, 0x400000
  s_mov_b32 s43, 0x20000
  s_mov_b32 s44, s64
  s_and_b32 s45, s65, 0xffff
  s_mov_b32 s46, 0x400000
  s_mov_b32 s47, 0x20000
  s_mov_b32 s48, s66
  s_and_b32 s49, s67, 0xffff
  s_mov_b32 s50, 0x400000
  s_mov_b32 s51, 0x20000
  s_mov_b32 s4, s70
  s_and_b32 s5, s71, 0xffff
  s_mov_b32 s6, 0x10000000
  s_mov_b32 s7, 0x20000
  s_mov_b32 s76, s72
  s_and_b32 s77, s73, 0xffff
  s_mov_b32 s78, 0x2000
  s_mov_b32 s79, 0x20000
  s_mov_b32 s72, s68
  s_and_b32 s73, s69, 0xffff
  s_mov_b32 s74, 0x100
  s_mov_b32 s75, 0x20000
  s_mov_b64 s[52:53], s[68:69]
  s_mov_b64 s[58:59], s[70:71]
  s_mul_i32 s99, s12, 896
  s_add_u32 s99, s99, 148898048
  s_lshl_b32 s15, s12, 7
  s_add_u32 s15, s15, 148926464
  v_lshrrev_b32 v21, 4, v20
  v_and_b32 v22, 15, v20
  v_and_b32 v23, 1, v21
  v_lshrrev_b32 v24, 1, v21
  v_lshlrev_b32 v2, 4, v20
  s_lshl_b32 s36, s13, 10
  v_add_u32 v59, s36, v2
  s_lshl_b32 s37, s13, 15
  s_add_u32 s37, s37, 32768
  v_add_u32 v4, s37, v2
  v_lshrrev_b32 v25, 2, v20
  v_lshlrev_b32 v25, 13, v25
  v_and_b32 v1, 3, v20
  v_lshl_add_u32 v25, v1, 4, v25
  s_lshl_b32 s36, s13, 6
  s_lshl_b32 s38, s12, 8
  s_add_u32 s36, s36, s38
  v_add_u32 v25, s36, v25
  v_lshrrev_b32 v26, 3, v20
  v_lshlrev_b32 v26, 10, v26
  v_and_b32 v1, 7, v20
  v_lshl_add_u32 v26, v1, 4, v26
  s_lshl_b32 s36, s13, 7
  s_lshl_b32 s38, s12, 17
  s_add_u32 s36, s36, s38
  v_add_u32 v26, s36, v26
  v_bfe_u32 v29, v20, 2, 1
  v_bfe_u32 v30, v20, 3, 1
  v_and_b32 v31, 3, v20
  v_lshl_add_u32 v27, v21, 2, v29
  v_lshlrev_b32 v27, 6, v27
  v_lshl_add_u32 v27, v30, 5, v27
  v_lshl_add_u32 v27, v31, 3, v27
  v_add_u32 v27, s37, v27
  v_xor_b32 v36, 1, v30
  v_lshl_add_u32 v36, v36, 11, v27
  v_lshl_add_u32 v27, v30, 11, v27
  v_lshl_add_u32 v28, v23, 2, v24
  v_lshl_add_u32 v28, v28, 2, v29
  v_lshlrev_b32 v28, 7, v28
  v_lshl_add_u32 v28, v30, 6, v28
  v_lshl_add_u32 v28, v31, 4, v28
  v_add_u32 v28, s37, v28
  s_mov_b32 s39, s37
  s_xor_b32 s36, s13, 0
  s_lshl_b32 s36, s36, 15
  s_add_u32 m0, s39, 0
  s_add_u32 s37, s36, 0
  buffer_load_dwordx4 v26, s[48:51], s37 offen lds
  s_add_u32 m0, s39, 1024
  s_add_u32 s37, s36, 8192
  buffer_load_dwordx4 v26, s[48:51], s37 offen lds
  s_add_u32 m0, s39, 2048
  s_add_u32 s37, s36, 16384
  buffer_load_dwordx4 v26, s[48:51], s37 offen lds
  s_add_u32 m0, s39, 3072
  s_add_u32 s37, s36, 24576
  buffer_load_dwordx4 v26, s[48:51], s37 offen lds
  s_xor_b32 s36, s13, 0
  s_lshl_b32 s36, s36, 15
  s_add_u32 m0, s39, 4096
  s_add_u32 s37, s36, 512
  buffer_load_dwordx4 v26, s[48:51], s37 offen lds
  s_add_u32 m0, s39, 5120
  s_add_u32 s37, s36, 8704
  buffer_load_dwordx4 v26, s[48:51], s37 offen lds
  s_add_u32 m0, s39, 6144
  s_add_u32 s37, s36, 16896
  buffer_load_dwordx4 v26, s[48:51], s37 offen lds
  s_add_u32 m0, s39, 7168
  s_add_u32 s37, s36, 25088
  buffer_load_dwordx4 v26, s[48:51], s37 offen lds
  v_mov_b32 v0, 0x4444
  v_mov_b32 v1, 0xeeee
  v_cmp_lt_u32 vcc, 7, v22
  s_nop 1
  v_cndmask_b32 v32, v0, v1, vcc
  v_mov_b32 v0, v32
  v_and_b32 v32, 7, v20
  v_lshlrev_b32 v32, 4, v32
  v_lshl_add_u32 v11, v21, 7, v32
  v_xor_b32 v1, 128, v2
  v_lshl_add_u32 v33, v24, 4, v22
  s_lshl_b32 s36, s13, 5
  v_add_u32 v33, s36, v33
  v_lshlrev_b32 v33, 3, v33
  v_mul_u32_u24 v34, 1152, v23
  v_add_u32 v5, v33, v34
  v_bfe_u32 v33, v20, 2, 2
  v_lshl_add_u32 v33, v23, 2, v33
  v_lshl_add_u32 v33, v24, 4, v33
  v_lshlrev_b32 v33, 3, v33
  v_and_b32 v34, 1, v20
  v_mul_u32_u24 v34, 1152, v34
  v_add_u32 v6, v33, v34
  s_lshl_b32 s36, s13, 3
  v_lshrrev_b32 v33, 3, v20
  v_add_u32 v33, s36, v33
  v_mul_u32_u24 v34, 0, v33
  v_add_u32 v34, s12, v34
  v_and_b32 v34, 31, v34
  v_lshrrev_b32 v37, 1, v32
  v_lshl_add_u32 v33, v33, 13, v37
  v_lshl_add_u32 v7, v34, 7, v33
  v_and_b32 v37, 1, v20
  v_bfe_u32 v38, v20, 1, 1
  v_lshl_add_u32 v37, v29, 1, v37
  s_lshr_b32 s36, s12, 3
  s_lshl_b32 s36, s36, 10
  s_and_b32 s37, s12, 1
  s_lshl_b32 s37, s37, 9
  s_add_u32 s36, s36, s37
  s_and_b32 s37, s12, 6
  s_lshl_b32 s37, s37, 5
  s_add_u32 s36, s36, s37
  v_lshlrev_b32 v33, 4, v21
  v_lshl_add_u32 v33, v37, 2, v33
  v_lshl_add_u32 v33, v38, 8, v33
  v_lshl_add_u32 v33, v30, 30, v33
  v_add_u32 v8, s36, v33
  v_mov_b32 v3, v2
  v_mov_b32 v39, v21
  s_lshr_b32 s36, s12, 2
  s_lshl_b32 s36, s36, 6
  s_and_b32 s37, s12, 1
  s_lshl_b32 s37, s37, 5
  s_add_u32 s36, s36, s37
  s_and_b32 s37, s12, 2
  s_lshl_b32 s37, s37, 11
  s_add_u32 s36, s36, s37
  v_lshlrev_b32 v35, 10, v39
  v_lshl_add_u32 v35, v37, 2, v35
  v_lshl_add_u32 v35, v38, 4, v35
  v_add_u32 v35, s36, v35
  buffer_load_ushort v44, v35, s[76:79], 0 offen offset:0
  buffer_load_ushort v45, v35, s[76:79], 0 offen offset:2
  buffer_load_ushort v46, v35, s[76:79], 0 offen offset:512
  buffer_load_ushort v47, v35, s[76:79], 0 offen offset:514
  v_lshlrev_b32 v33, 4, v29
  v_mov_b32 v34, 0x3f80
  v_lshlrev_b32 v33, v33, v34
  v_and_b32 v34, 1, v20
  v_lshl_add_u32 v34, v34, 1, v30
  v_cmp_eq_u32 vcc, 0, v34
  s_nop 1
  v_cndmask_b32 v48, 0, v33, vcc
  v_cmp_eq_u32 vcc, 1, v34
  s_nop 1
  v_cndmask_b32 v49, 0, v33, vcc
  v_cmp_eq_u32 vcc, 2, v34
  s_nop 1
  v_cndmask_b32 v50, 0, v33, vcc
  v_cmp_eq_u32 vcc, 3, v34
  s_nop 1
  v_cndmask_b32 v51, 0, v33, vcc
  ds_write_b128 v2, v[48:51] offset:31232
  v_lshlrev_b32 v33, 9, v21
  s_lshl_b32 s36, s13, 11
  v_add_u32 v33, s36, v33
  v_lshl_add_u32 v10, v22, 4, v33
  v_lshl_add_u32 v33, v30, 8, v33
  v_add_u32 v9, v33, v32
  v_mov_b32 v12, 0x3f803f80
  v_mov_b32 v13, 0x3f803f80
  v_mov_b32 v14, 0x3f803f80
  v_mov_b32 v15, 0x3f803f80
  s_mov_b32 s2, 0x3f803f80
  s_mov_b32 s3, 0x3f803f80
  s_mov_b32 s98, 0
  v_and_b32 v33, 1, v20
  v_mul_u32_u24 v33, 128, v33
  v_min_u32 v34, 1, v20
  v_lshlrev_b32 v34, 30, v34
  s_cmp_eq_u32 s13, 3
  s_cselect_b64 vcc, -1, 0
  v_cndmask_b32 v19, v34, v33, vcc
  v_mov_b64 v[60:61], 0
  v_mov_b32 v62, 32256
  ds_write_b64 v62, v[60:61]
  s_mov_b32 s16, 0
  s_mov_b32 s17, -1
  s_mov_b32 s18, 0x3e0293ee
  s_mov_b32 s54, 0x2f800000
  s_mov_b32 s55, 0x28000000
  s_lshl_b32 s36, s13, 10
  s_add_u32 s31, s36, 8192
  s_add_u32 s32, s36, 12160
  s_add_u32 s33, s36, 16384
  s_add_u32 s34, s36, 20224
  s_lshl_b32 s36, s12, 19
  s_add_u32 s27, s36, 67108864
  s_add_u32 s28, s36, 83886080
  s_mul_i32 s36, s12, 4096
  s_add_u32 s29, s36, 135266304
  s_lshl_b32 s36, s12, 13
  s_add_u32 s22, s36, 144703488
  s_add_u32 s23, s36, 144707584
  s_mov_b32 s20, 144703488
  s_mov_b32 s21, 144707584
  v_mov_b32 v40, -1
  v_mov_b32 v41, -1
  v_mov_b32 v42, -1
  v_mov_b32 v43, -1
  s_lshl_b32 s36, s13, 13
  s_add_u32 s36, s36, 145752064
  s_add_u32 s37, s36, 4096
  buffer_store_dwordx4 v[40:43], v59, s[4:7], s22 offen sc1
  buffer_store_dwordx4 v[40:43], v59, s[4:7], s23 offen sc1
  buffer_store_dword v40, v8, s[4:7], s36 offen sc1
  buffer_store_dword v40, v8, s[4:7], s37 offen sc1
  v_mov_b32 v52, 0
  v_min_u32 v53, 1, v59
  v_lshlrev_b32 v53, 30, v53
  buffer_store_dword v52, v53, s[4:7], s15 offen sc1
  s_xor_b32 s36, s13, 1
  s_lshl_b32 s36, s36, 15
  s_add_u32 m0, s39, 8192
  s_add_u32 s37, s36, 0
  buffer_load_dwordx4 v26, s[48:51], s37 offen lds
  s_add_u32 m0, s39, 9216
  s_add_u32 s37, s36, 8192
  buffer_load_dwordx4 v26, s[48:51], s37 offen lds
  s_add_u32 m0, s39, 10240
  s_add_u32 s37, s36, 16384
  buffer_load_dwordx4 v26, s[48:51], s37 offen lds
  s_add_u32 m0, s39, 11264
  s_add_u32 s37, s36, 24576
  buffer_load_dwordx4 v26, s[48:51], s37 offen lds
  s_xor_b32 s36, s13, 1
  s_lshl_b32 s36, s36, 15
  s_add_u32 m0, s39, 12288
  s_add_u32 s37, s36, 512
  buffer_load_dwordx4 v26, s[48:51], s37 offen lds
  s_add_u32 m0, s39, 13312
  s_add_u32 s37, s36, 8704
  buffer_load_dwordx4 v26, s[48:51], s37 offen lds
  s_add_u32 m0, s39, 14336
  s_add_u32 s37, s36, 16896
  buffer_load_dwordx4 v26, s[48:51], s37 offen lds
  s_add_u32 m0, s39, 15360
  s_add_u32 s37, s36, 25088
  buffer_load_dwordx4 v26, s[48:51], s37 offen lds
  s_waitcnt vmcnt(21)
  ds_read_b64_tr_b16 a[160:161], v28 offset:0
  ds_read_b64_tr_b16 a[162:163], v28 offset:256
  ds_read_b64_tr_b16 a[164:165], v28 offset:1024
  ds_read_b64_tr_b16 a[166:167], v28 offset:1280
  ds_read_b64_tr_b16 a[168:169], v28 offset:8
  ds_read_b64_tr_b16 a[170:171], v28 offset:264
  ds_read_b64_tr_b16 a[172:173], v28 offset:1032
  ds_read_b64_tr_b16 a[174:175], v28 offset:1288
  s_waitcnt lgkmcnt(0)
  s_xor_b32 s36, s13, 2
  s_lshl_b32 s36, s36, 15
  s_add_u32 m0, s39, 0
  s_add_u32 s37, s36, 0
  buffer_load_dwordx4 v26, s[48:51], s37 offen lds
  s_add_u32 m0, s39, 1024
  s_add_u32 s37, s36, 8192
  buffer_load_dwordx4 v26, s[48:51], s37 offen lds
  s_add_u32 m0, s39, 2048
  s_add_u32 s37, s36, 16384
  buffer_load_dwordx4 v26, s[48:51], s37 offen lds
  s_add_u32 m0, s39, 3072
  s_add_u32 s37, s36, 24576
  buffer_load_dwordx4 v26, s[48:51], s37 offen lds
  s_waitcnt vmcnt(21)
  ds_read_b64_tr_b16 a[176:177], v28 offset:4096
  ds_read_b64_tr_b16 a[178:179], v28 offset:4352
  ds_read_b64_tr_b16 a[180:181], v28 offset:5120
  ds_read_b64_tr_b16 a[182:183], v28 offset:5376
  ds_read_b64_tr_b16 a[184:185], v28 offset:4104
  ds_read_b64_tr_b16 a[186:187], v28 offset:4360
  ds_read_b64_tr_b16 a[188:189], v28 offset:5128
  ds_read_b64_tr_b16 a[190:191], v28 offset:5384
  s_waitcnt lgkmcnt(0)
  s_xor_b32 s36, s13, 3
  s_lshl_b32 s36, s36, 15
  s_add_u32 m0, s39, 4096
  s_add_u32 s37, s36, 0
  buffer_load_dwordx4 v26, s[48:51], s37 offen lds
  s_add_u32 m0, s39, 5120
  s_add_u32 s37, s36, 8192
  buffer_load_dwordx4 v26, s[48:51], s37 offen lds
  s_add_u32 m0, s39, 6144
  s_add_u32 s37, s36, 16384
  buffer_load_dwordx4 v26, s[48:51], s37 offen lds
  s_add_u32 m0, s39, 7168
  s_add_u32 s37, s36, 24576
  buffer_load_dwordx4 v26, s[48:51], s37 offen lds
  s_waitcnt vmcnt(12)
  ds_read_b64_tr_b16 a[192:193], v28 offset:8192
  ds_read_b64_tr_b16 a[194:195], v28 offset:8448
  ds_read_b64_tr_b16 a[196:197], v28 offset:9216
  ds_read_b64_tr_b16 a[198:199], v28 offset:9472
  ds_read_b64_tr_b16 a[200:201], v28 offset:8200
  ds_read_b64_tr_b16 a[202:203], v28 offset:8456
  ds_read_b64_tr_b16 a[204:205], v28 offset:9224
  ds_read_b64_tr_b16 a[206:207], v28 offset:9480
  s_waitcnt lgkmcnt(0)
  s_xor_b32 s36, s13, 2
  s_lshl_b32 s36, s36, 19
  s_add_u32 m0, s39, 8192
  s_add_u32 s37, s36, 0
  buffer_load_dwordx4 v25, s[8:11], s37 offen lds
  s_add_u32 m0, s39, 9216
  s_add_u32 s37, s36, 131072
  buffer_load_dwordx4 v25, s[8:11], s37 offen lds
  s_add_u32 m0, s39, 10240
  s_add_u32 s37, s36, 262144
  buffer_load_dwordx4 v25, s[8:11], s37 offen lds
  s_add_u32 m0, s39, 11264
  s_add_u32 s37, s36, 393216
  buffer_load_dwordx4 v25, s[8:11], s37 offen lds
  s_barrier
  s_cmp_lg_u32 s13, 0
  s_cbranch_scc1 T_arm_76
  s_getreg_b32 s36, hwreg(HW_REG_XCC_ID, 0, 3)
  s_lshl_b32 s36, s36, 3
  s_lshl_b64 s[60:61], 1, s36
  s_mov_b32 s62, 1
  s_atomic_add_x2 s[60:61], s[52:53], 0
  s_atomic_add s62, s[52:53], 128
  v_lshl_or_b32 v44, v45, 16, v44
  v_lshl_or_b32 v46, v47, 16, v46
  v_min_u32 v44, -2, v44
  v_min_u32 v46, -2, v46
  s_mov_b32 s36, 145752064
  s_mov_b32 s37, 145756160
  buffer_store_dword v44, v8, s[4:7], s36 offen sc1
  buffer_store_dword v46, v8, s[4:7], s37 offen sc1
T_arm_76:
  s_waitcnt vmcnt(12)
  ds_read_b64_tr_b16 a[208:209], v28 offset:12288
  ds_read_b64_tr_b16 a[210:211], v28 offset:12544
  ds_read_b64_tr_b16 a[212:213], v28 offset:13312
  ds_read_b64_tr_b16 a[214:215], v28 offset:13568
  ds_read_b64_tr_b16 a[216:217], v28 offset:12296
  ds_read_b64_tr_b16 a[218:219], v28 offset:12552
  ds_read_b64_tr_b16 a[220:221], v28 offset:13320
  ds_read_b64_tr_b16 a[222:223], v28 offset:13576
  s_waitcnt lgkmcnt(0)
  s_xor_b32 s36, s13, 3
  s_lshl_b32 s36, s36, 19
  s_add_u32 m0, s39, 12288
  s_add_u32 s37, s36, 0
  buffer_load_dwordx4 v25, s[8:11], s37 offen lds
  s_add_u32 m0, s39, 13312
  s_add_u32 s37, s36, 131072
  buffer_load_dwordx4 v25, s[8:11], s37 offen lds
  s_add_u32 m0, s39, 14336
  s_add_u32 s37, s36, 262144
  buffer_load_dwordx4 v25, s[8:11], s37 offen lds
  s_add_u32 m0, s39, 15360
  s_add_u32 s37, s36, 393216
  buffer_load_dwordx4 v25, s[8:11], s37 offen lds
  s_waitcnt vmcnt(12)
  ds_read_b64_tr_b16 a[224:225], v28 offset:0
  ds_read_b64_tr_b16 a[226:227], v28 offset:256
  ds_read_b64_tr_b16 a[228:229], v28 offset:1024
  ds_read_b64_tr_b16 a[230:231], v28 offset:1280
  ds_read_b64_tr_b16 a[232:233], v28 offset:8
  ds_read_b64_tr_b16 a[234:235], v28 offset:264
  ds_read_b64_tr_b16 a[236:237], v28 offset:1032
  ds_read_b64_tr_b16 a[238:239], v28 offset:1288
  s_waitcnt lgkmcnt(0)
  s_xor_b32 s36, s13, 4
  s_lshl_b32 s36, s36, 19
  s_add_u32 m0, s39, 0
  s_add_u32 s37, s36, 0
  buffer_load_dwordx4 v25, s[8:11], s37 offen lds
  s_add_u32 m0, s39, 1024
  s_add_u32 s37, s36, 131072
  buffer_load_dwordx4 v25, s[8:11], s37 offen lds
  s_add_u32 m0, s39, 2048
  s_add_u32 s37, s36, 262144
  buffer_load_dwordx4 v25, s[8:11], s37 offen lds
  s_add_u32 m0, s39, 3072
  s_add_u32 s37, s36, 393216
  buffer_load_dwordx4 v25, s[8:11], s37 offen lds
  s_waitcnt vmcnt(12)
  ds_read_b64_tr_b16 a[240:241], v28 offset:4096
  ds_read_b64_tr_b16 a[242:243], v28 offset:4352
  ds_read_b64_tr_b16 a[244:245], v28 offset:5120
  ds_read_b64_tr_b16 a[246:247], v28 offset:5376
  ds_read_b64_tr_b16 a[248:249], v28 offset:4104
  ds_read_b64_tr_b16 a[250:251], v28 offset:4360
  ds_read_b64_tr_b16 a[252:253], v28 offset:5128
  ds_read_b64_tr_b16 a[254:255], v28 offset:5384
  s_waitcnt lgkmcnt(0)
  s_xor_b32 s36, s13, 5
  s_lshl_b32 s36, s36, 19
  s_add_u32 m0, s39, 4096
  s_add_u32 s37, s36, 0
  buffer_load_dwordx4 v25, s[8:11], s37 offen lds
  s_add_u32 m0, s39, 5120
  s_add_u32 s37, s36, 131072
  buffer_load_dwordx4 v25, s[8:11], s37 offen lds
  s_add_u32 m0, s39, 6144
  s_add_u32 s37, s36, 262144
  buffer_load_dwordx4 v25, s[8:11], s37 offen lds
  s_add_u32 m0, s39, 7168
  s_add_u32 s37, s36, 393216
  buffer_load_dwordx4 v25, s[8:11], s37 offen lds
  s_waitcnt vmcnt(12)
  ds_read_b64_tr_b16 v[160:161], v27 offset:8192
  ds_read_b64_tr_b16 v[162:163], v27 offset:8320
  ds_read_b64_tr_b16 v[164:165], v27 offset:9216
  ds_read_b64_tr_b16 v[166:167], v27 offset:9344
  ds_read_b64_tr_b16 v[168:169], v36 offset:8192
  ds_read_b64_tr_b16 v[170:171], v36 offset:8320
  ds_read_b64_tr_b16 v[172:173], v36 offset:9216
  ds_read_b64_tr_b16 v[174:175], v36 offset:9344
  s_waitcnt lgkmcnt(0)
  s_xor_b32 s36, s13, 4
  s_lshl_b32 s36, s36, 19
  s_add_u32 m0, s39, 8192
  s_add_u32 s37, s36, 0
  buffer_load_dwordx4 v25, s[40:43], s37 offen lds
  s_add_u32 m0, s39, 9216
  s_add_u32 s37, s36, 131072
  buffer_load_dwordx4 v25, s[40:43], s37 offen lds
  s_add_u32 m0, s39, 10240
  s_add_u32 s37, s36, 262144
  buffer_load_dwordx4 v25, s[40:43], s37 offen lds
  s_add_u32 m0, s39, 11264
  s_add_u32 s37, s36, 393216
  buffer_load_dwordx4 v25, s[40:43], s37 offen lds
  s_waitcnt vmcnt(12)
  ds_read_b64_tr_b16 v[192:193], v27 offset:12288
  ds_read_b64_tr_b16 v[194:195], v27 offset:12416
  ds_read_b64_tr_b16 v[196:197], v27 offset:13312
  ds_read_b64_tr_b16 v[198:199], v27 offset:13440
  ds_read_b64_tr_b16 v[200:201], v36 offset:12288
  ds_read_b64_tr_b16 v[202:203], v36 offset:12416
  ds_read_b64_tr_b16 v[204:205], v36 offset:13312
  ds_read_b64_tr_b16 v[206:207], v36 offset:13440
  s_waitcnt lgkmcnt(0)
  s_xor_b32 s36, s13, 5
  s_lshl_b32 s36, s36, 19
  s_add_u32 m0, s39, 12288
  s_add_u32 s37, s36, 0
  buffer_load_dwordx4 v25, s[40:43], s37 offen lds
  s_add_u32 m0, s39, 13312
  s_add_u32 s37, s36, 131072
  buffer_load_dwordx4 v25, s[40:43], s37 offen lds
  s_add_u32 m0, s39, 14336
  s_add_u32 s37, s36, 262144
  buffer_load_dwordx4 v25, s[40:43], s37 offen lds
  s_add_u32 m0, s39, 15360
  s_add_u32 s37, s36, 393216
  buffer_load_dwordx4 v25, s[40:43], s37 offen lds
  s_waitcnt vmcnt(12)
  ds_read_b64_tr_b16 v[224:225], v27 offset:0
  ds_read_b64_tr_b16 v[226:227], v27 offset:128
  ds_read_b64_tr_b16 v[228:229], v27 offset:1024
  ds_read_b64_tr_b16 v[230:231], v27 offset:1152
  ds_read_b64_tr_b16 v[232:233], v36 offset:0
  ds_read_b64_tr_b16 v[234:235], v36 offset:128
  ds_read_b64_tr_b16 v[236:237], v36 offset:1024
  ds_read_b64_tr_b16 v[238:239], v36 offset:1152
  s_waitcnt lgkmcnt(0)
  s_xor_b32 s36, s13, 4
  s_lshl_b32 s36, s36, 19
  s_add_u32 m0, s39, 0
  s_add_u32 s37, s36, 0
  buffer_load_dwordx4 v25, s[44:47], s37 offen lds
  s_add_u32 m0, s39, 1024
  s_add_u32 s37, s36, 131072
  buffer_load_dwordx4 v25, s[44:47], s37 offen lds
  s_add_u32 m0, s39, 2048
  s_add_u32 s37, s36, 262144
  buffer_load_dwordx4 v25, s[44:47], s37 offen lds
  s_add_u32 m0, s39, 3072
  s_add_u32 s37, s36, 393216
  buffer_load_dwordx4 v25, s[44:47], s37 offen lds
  s_waitcnt vmcnt(12)
  ds_read_b64_tr_b16 a[16:17], v27 offset:4096
  ds_read_b64_tr_b16 a[18:19], v27 offset:4224
  ds_read_b64_tr_b16 a[20:21], v27 offset:5120
  ds_read_b64_tr_b16 a[22:23], v27 offset:5248
  ds_read_b64_tr_b16 a[24:25], v36 offset:4096
  ds_read_b64_tr_b16 a[26:27], v36 offset:4224
  ds_read_b64_tr_b16 a[28:29], v36 offset:5120
  ds_read_b64_tr_b16 a[30:31], v36 offset:5248
  s_waitcnt lgkmcnt(0)
  s_xor_b32 s36, s13, 5
  s_lshl_b32 s36, s36, 19
  s_add_u32 m0, s39, 4096
  s_add_u32 s37, s36, 0
  buffer_load_dwordx4 v25, s[44:47], s37 offen lds
  s_add_u32 m0, s39, 5120
  s_add_u32 s37, s36, 131072
  buffer_load_dwordx4 v25, s[44:47], s37 offen lds
  s_add_u32 m0, s39, 6144
  s_add_u32 s37, s36, 262144
  buffer_load_dwordx4 v25, s[44:47], s37 offen lds
  s_add_u32 m0, s39, 7168
  s_add_u32 s37, s36, 393216
  buffer_load_dwordx4 v25, s[44:47], s37 offen lds
  s_waitcnt vmcnt(12)
  ds_read_b64_tr_b16 v[240:241], v27 offset:8192
  ds_read_b64_tr_b16 v[242:243], v27 offset:8320
  ds_read_b64_tr_b16 v[244:245], v27 offset:9216
  ds_read_b64_tr_b16 v[246:247], v27 offset:9344
  ds_read_b64_tr_b16 v[248:249], v36 offset:8192
  ds_read_b64_tr_b16 v[250:251], v36 offset:8320
  ds_read_b64_tr_b16 v[252:253], v36 offset:9216
  ds_read_b64_tr_b16 v[254:255], v36 offset:9344
  s_waitcnt lgkmcnt(0)
  s_xor_b32 s36, s13, 6
  s_lshl_b32 s36, s36, 19
  s_add_u32 m0, s39, 8192
  s_add_u32 s37, s36, 0
  buffer_load_dwordx4 v25, s[8:11], s37 offen lds
  s_add_u32 m0, s39, 9216
  s_add_u32 s37, s36, 131072
  buffer_load_dwordx4 v25, s[8:11], s37 offen lds
  s_add_u32 m0, s39, 10240
  s_add_u32 s37, s36, 262144
  buffer_load_dwordx4 v25, s[8:11], s37 offen lds
  s_add_u32 m0, s39, 11264
  s_add_u32 s37, s36, 393216
  buffer_load_dwordx4 v25, s[8:11], s37 offen lds
  s_waitcnt vmcnt(12)
  ds_read_b64_tr_b16 a[32:33], v27 offset:12288
  ds_read_b64_tr_b16 a[34:35], v27 offset:12416
  ds_read_b64_tr_b16 a[36:37], v27 offset:13312
  ds_read_b64_tr_b16 a[38:39], v27 offset:13440
  ds_read_b64_tr_b16 a[40:41], v36 offset:12288
  ds_read_b64_tr_b16 a[42:43], v36 offset:12416
  ds_read_b64_tr_b16 a[44:45], v36 offset:13312
  ds_read_b64_tr_b16 a[46:47], v36 offset:13440
  s_waitcnt lgkmcnt(0)
  s_xor_b32 s36, s13, 7
  s_lshl_b32 s36, s36, 19
  s_add_u32 m0, s39, 12288
  s_add_u32 s37, s36, 0
  buffer_load_dwordx4 v25, s[8:11], s37 offen lds
  s_add_u32 m0, s39, 13312
  s_add_u32 s37, s36, 131072
  buffer_load_dwordx4 v25, s[8:11], s37 offen lds
  s_add_u32 m0, s39, 14336
  s_add_u32 s37, s36, 262144
  buffer_load_dwordx4 v25, s[8:11], s37 offen lds
  s_add_u32 m0, s39, 15360
  s_add_u32 s37, s36, 393216
  buffer_load_dwordx4 v25, s[8:11], s37 offen lds
  s_waitcnt vmcnt(12)
  ds_read_b64_tr_b16 a[0:1], v27 offset:0
  ds_read_b64_tr_b16 a[2:3], v27 offset:128
  ds_read_b64_tr_b16 a[4:5], v27 offset:1024
  ds_read_b64_tr_b16 a[6:7], v27 offset:1152
  ds_read_b64_tr_b16 a[8:9], v36 offset:0
  ds_read_b64_tr_b16 a[10:11], v36 offset:128
  ds_read_b64_tr_b16 a[12:13], v36 offset:1024
  ds_read_b64_tr_b16 a[14:15], v36 offset:1152
  s_waitcnt lgkmcnt(0)
  s_xor_b32 s36, s13, 6
  s_lshl_b32 s36, s36, 19
  s_add_u32 m0, s39, 0
  s_add_u32 s37, s36, 0
  buffer_load_dwordx4 v25, s[40:43], s37 offen lds
  s_add_u32 m0, s39, 1024
  s_add_u32 s37, s36, 131072
  buffer_load_dwordx4 v25, s[40:43], s37 offen lds
  s_add_u32 m0, s39, 2048
  s_add_u32 s37, s36, 262144
  buffer_load_dwordx4 v25, s[40:43], s37 offen lds
  s_add_u32 m0, s39, 3072
  s_add_u32 s37, s36, 393216
  buffer_load_dwordx4 v25, s[40:43], s37 offen lds
  s_waitcnt vmcnt(12)
  ds_read_b64_tr_b16 a[48:49], v27 offset:4096
  ds_read_b64_tr_b16 a[50:51], v27 offset:4224
  ds_read_b64_tr_b16 a[52:53], v27 offset:5120
  ds_read_b64_tr_b16 a[54:55], v27 offset:5248
  ds_read_b64_tr_b16 a[56:57], v36 offset:4096
  ds_read_b64_tr_b16 a[58:59], v36 offset:4224
  ds_read_b64_tr_b16 a[60:61], v36 offset:5120
  ds_read_b64_tr_b16 a[62:63], v36 offset:5248
  s_waitcnt lgkmcnt(0)
  s_xor_b32 s36, s13, 7
  s_lshl_b32 s36, s36, 19
  s_add_u32 m0, s39, 4096
  s_add_u32 s37, s36, 0
  buffer_load_dwordx4 v25, s[40:43], s37 offen lds
  s_add_u32 m0, s39, 5120
  s_add_u32 s37, s36, 131072
  buffer_load_dwordx4 v25, s[40:43], s37 offen lds
  s_add_u32 m0, s39, 6144
  s_add_u32 s37, s36, 262144
  buffer_load_dwordx4 v25, s[40:43], s37 offen lds
  s_add_u32 m0, s39, 7168
  s_add_u32 s37, s36, 393216
  buffer_load_dwordx4 v25, s[40:43], s37 offen lds
  s_waitcnt vmcnt(12)
  ds_read_b64_tr_b16 a[64:65], v27 offset:8192
  ds_read_b64_tr_b16 a[66:67], v27 offset:8320
  ds_read_b64_tr_b16 a[68:69], v27 offset:9216
  ds_read_b64_tr_b16 a[70:71], v27 offset:9344
  ds_read_b64_tr_b16 a[72:73], v36 offset:8192
  ds_read_b64_tr_b16 a[74:75], v36 offset:8320
  ds_read_b64_tr_b16 a[76:77], v36 offset:9216
  ds_read_b64_tr_b16 a[78:79], v36 offset:9344
  s_waitcnt lgkmcnt(0)
  s_xor_b32 s36, s13, 6
  s_lshl_b32 s36, s36, 19
  s_add_u32 m0, s39, 8192
  s_add_u32 s37, s36, 0
  buffer_load_dwordx4 v25, s[44:47], s37 offen lds
  s_add_u32 m0, s39, 9216
  s_add_u32 s37, s36, 131072
  buffer_load_dwordx4 v25, s[44:47], s37 offen lds
  s_add_u32 m0, s39, 10240
  s_add_u32 s37, s36, 262144
  buffer_load_dwordx4 v25, s[44:47], s37 offen lds
  s_add_u32 m0, s39, 11264
  s_add_u32 s37, s36, 393216
  buffer_load_dwordx4 v25, s[44:47], s37 offen lds
  s_waitcnt vmcnt(12)
  ds_read_b64_tr_b16 a[112:113], v27 offset:12288
  ds_read_b64_tr_b16 a[114:115], v27 offset:12416
  ds_read_b64_tr_b16 a[116:117], v27 offset:13312
  ds_read_b64_tr_b16 a[118:119], v27 offset:13440
  ds_read_b64_tr_b16 a[120:121], v36 offset:12288
  ds_read_b64_tr_b16 a[122:123], v36 offset:12416
  ds_read_b64_tr_b16 a[124:125], v36 offset:13312
  ds_read_b64_tr_b16 a[126:127], v36 offset:13440
  s_waitcnt lgkmcnt(0)
  s_xor_b32 s36, s13, 7
  s_lshl_b32 s36, s36, 19
  s_add_u32 m0, s39, 12288
  s_add_u32 s37, s36, 0
  buffer_load_dwordx4 v25, s[44:47], s37 offen lds
  s_add_u32 m0, s39, 13312
  s_add_u32 s37, s36, 131072
  buffer_load_dwordx4 v25, s[44:47], s37 offen lds
  s_add_u32 m0, s39, 14336
  s_add_u32 s37, s36, 262144
  buffer_load_dwordx4 v25, s[44:47], s37 offen lds
  s_add_u32 m0, s39, 15360
  s_add_u32 s37, s36, 393216
  buffer_load_dwordx4 v25, s[44:47], s37 offen lds
  s_waitcnt vmcnt(12)
  ds_read_b64_tr_b16 a[80:81], v27 offset:0
  ds_read_b64_tr_b16 a[82:83], v27 offset:128
  ds_read_b64_tr_b16 a[84:85], v27 offset:1024
  ds_read_b64_tr_b16 a[86:87], v27 offset:1152
  ds_read_b64_tr_b16 a[88:89], v36 offset:0
  ds_read_b64_tr_b16 a[90:91], v36 offset:128
  ds_read_b64_tr_b16 a[92:93], v36 offset:1024
  ds_read_b64_tr_b16 a[94:95], v36 offset:1152
  s_waitcnt lgkmcnt(0)
  s_xor_b32 s36, s13, 1
  s_lshl_b32 s36, s36, 19
  s_add_u32 m0, s39, 16384
  s_add_u32 s37, s36, 0
  buffer_load_dwordx4 v25, s[8:11], s37 offen lds
  s_add_u32 m0, s39, 17408
  s_add_u32 s37, s36, 131072
  buffer_load_dwordx4 v25, s[8:11], s37 offen lds
  s_add_u32 m0, s39, 18432
  s_add_u32 s37, s36, 262144
  buffer_load_dwordx4 v25, s[8:11], s37 offen lds
  s_add_u32 m0, s39, 19456
  s_add_u32 s37, s36, 393216
  buffer_load_dwordx4 v25, s[8:11], s37 offen lds
  s_waitcnt vmcnt(12)
  ds_read_b64_tr_b16 a[128:129], v27 offset:4096
  ds_read_b64_tr_b16 a[130:131], v27 offset:4224
  ds_read_b64_tr_b16 a[132:133], v27 offset:5120
  ds_read_b64_tr_b16 a[134:135], v27 offset:5248
  ds_read_b64_tr_b16 a[136:137], v36 offset:4096
  ds_read_b64_tr_b16 a[138:139], v36 offset:4224
  ds_read_b64_tr_b16 a[140:141], v36 offset:5120
  ds_read_b64_tr_b16 a[142:143], v36 offset:5248
  s_waitcnt lgkmcnt(0)
  s_xor_b32 s36, s13, 0
  s_lshl_b32 s36, s36, 19
  s_add_u32 m0, s39, 0
  s_add_u32 s37, s36, 0
  buffer_load_dwordx4 v25, s[8:11], s37 offen lds
  s_add_u32 m0, s39, 1024
  s_add_u32 s37, s36, 131072
  buffer_load_dwordx4 v25, s[8:11], s37 offen lds
  s_add_u32 m0, s39, 2048
  s_add_u32 s37, s36, 262144
  buffer_load_dwordx4 v25, s[8:11], s37 offen lds
  s_add_u32 m0, s39, 3072
  s_add_u32 s37, s36, 393216
  buffer_load_dwordx4 v25, s[8:11], s37 offen lds
  s_waitcnt vmcnt(12)
  ds_read_b64_tr_b16 a[96:97], v27 offset:8192
  ds_read_b64_tr_b16 a[98:99], v27 offset:8320
  ds_read_b64_tr_b16 a[100:101], v27 offset:9216
  ds_read_b64_tr_b16 a[102:103], v27 offset:9344
  ds_read_b64_tr_b16 a[104:105], v36 offset:8192
  ds_read_b64_tr_b16 a[106:107], v36 offset:8320
  ds_read_b64_tr_b16 a[108:109], v36 offset:9216
  ds_read_b64_tr_b16 a[110:111], v36 offset:9344
  s_waitcnt lgkmcnt(0)
  s_xor_b32 s36, s13, 1
  s_lshl_b32 s36, s36, 19
  s_add_u32 m0, s39, 8192
  s_add_u32 s37, s36, 0
  buffer_load_dwordx4 v25, s[40:43], s37 offen lds
  s_add_u32 m0, s39, 9216
  s_add_u32 s37, s36, 131072
  buffer_load_dwordx4 v25, s[40:43], s37 offen lds
  s_add_u32 m0, s39, 10240
  s_add_u32 s37, s36, 262144
  buffer_load_dwordx4 v25, s[40:43], s37 offen lds
  s_add_u32 m0, s39, 11264
  s_add_u32 s37, s36, 393216
  buffer_load_dwordx4 v25, s[40:43], s37 offen lds
  s_waitcnt vmcnt(12)
  ds_read_b64_tr_b16 a[144:145], v27 offset:12288
  ds_read_b64_tr_b16 a[146:147], v27 offset:12416
  ds_read_b64_tr_b16 a[148:149], v27 offset:13312
  ds_read_b64_tr_b16 a[150:151], v27 offset:13440
  ds_read_b64_tr_b16 a[152:153], v36 offset:12288
  ds_read_b64_tr_b16 a[154:155], v36 offset:12416
  ds_read_b64_tr_b16 a[156:157], v36 offset:13312
  ds_read_b64_tr_b16 a[158:159], v36 offset:13440
  s_waitcnt lgkmcnt(0)
  s_xor_b32 s36, s13, 0
  s_lshl_b32 s36, s36, 19
  s_add_u32 m0, s39, 4096
  s_add_u32 s37, s36, 0
  buffer_load_dwordx4 v25, s[40:43], s37 offen lds
  s_add_u32 m0, s39, 5120
  s_add_u32 s37, s36, 131072
  buffer_load_dwordx4 v25, s[40:43], s37 offen lds
  s_add_u32 m0, s39, 6144
  s_add_u32 s37, s36, 262144
  buffer_load_dwordx4 v25, s[40:43], s37 offen lds
  s_add_u32 m0, s39, 7168
  s_add_u32 s37, s36, 393216
  buffer_load_dwordx4 v25, s[40:43], s37 offen lds
  s_waitcnt vmcnt(12)
  ds_read_b64_tr_b16 v[128:129], v27 offset:16384
  ds_read_b64_tr_b16 v[130:131], v27 offset:16512
  ds_read_b64_tr_b16 v[132:133], v27 offset:17408
  ds_read_b64_tr_b16 v[134:135], v27 offset:17536
  ds_read_b64_tr_b16 v[136:137], v36 offset:16384
  ds_read_b64_tr_b16 v[138:139], v36 offset:16512
  ds_read_b64_tr_b16 v[140:141], v36 offset:17408
  ds_read_b64_tr_b16 v[142:143], v36 offset:17536
  s_waitcnt lgkmcnt(0)
  s_xor_b32 s36, s13, 2
  s_lshl_b32 s36, s36, 19
  s_add_u32 m0, s39, 12288
  s_add_u32 s37, s36, 0
  buffer_load_dwordx4 v25, s[40:43], s37 offen lds
  s_add_u32 m0, s39, 13312
  s_add_u32 s37, s36, 131072
  buffer_load_dwordx4 v25, s[40:43], s37 offen lds
  s_add_u32 m0, s39, 14336
  s_add_u32 s37, s36, 262144
  buffer_load_dwordx4 v25, s[40:43], s37 offen lds
  s_add_u32 m0, s39, 15360
  s_add_u32 s37, s36, 393216
  buffer_load_dwordx4 v25, s[40:43], s37 offen lds
  s_waitcnt vmcnt(12)
  ds_read_b64_tr_b16 v[64:65], v27 offset:0
  ds_read_b64_tr_b16 v[66:67], v27 offset:128
  ds_read_b64_tr_b16 v[68:69], v27 offset:1024
  ds_read_b64_tr_b16 v[70:71], v27 offset:1152
  ds_read_b64_tr_b16 v[72:73], v36 offset:0
  ds_read_b64_tr_b16 v[74:75], v36 offset:128
  ds_read_b64_tr_b16 v[76:77], v36 offset:1024
  ds_read_b64_tr_b16 v[78:79], v36 offset:1152
  s_waitcnt lgkmcnt(0)
  ds_write_b128 v4, v[64:67] offset:0
  ds_write_b128 v4, v[68:71] offset:1024
  ds_write_b128 v4, v[72:75] offset:2048
  ds_write_b128 v4, v[76:79] offset:3072
  s_waitcnt lgkmcnt(0)
  s_xor_b32 s36, s13, 3
  s_lshl_b32 s36, s36, 19
  s_add_u32 m0, s39, 16384
  s_add_u32 s37, s36, 0
  buffer_load_dwordx4 v25, s[40:43], s37 offen lds
  s_add_u32 m0, s39, 17408
  s_add_u32 s37, s36, 131072
  buffer_load_dwordx4 v25, s[40:43], s37 offen lds
  s_add_u32 m0, s39, 18432
  s_add_u32 s37, s36, 262144
  buffer_load_dwordx4 v25, s[40:43], s37 offen lds
  s_add_u32 m0, s39, 19456
  s_add_u32 s37, s36, 393216
  buffer_load_dwordx4 v25, s[40:43], s37 offen lds
  s_waitcnt vmcnt(12)
  ds_read_b64_tr_b16 v[144:145], v27 offset:8192
  ds_read_b64_tr_b16 v[146:147], v27 offset:8320
  ds_read_b64_tr_b16 v[148:149], v27 offset:9216
  ds_read_b64_tr_b16 v[150:151], v27 offset:9344
  ds_read_b64_tr_b16 v[152:153], v36 offset:8192
  ds_read_b64_tr_b16 v[154:155], v36 offset:8320
  ds_read_b64_tr_b16 v[156:157], v36 offset:9216
  ds_read_b64_tr_b16 v[158:159], v36 offset:9344
  s_waitcnt lgkmcnt(0)
  s_xor_b32 s36, s13, 3
  s_lshl_b32 s36, s36, 19
  s_add_u32 m0, s39, 24576
  s_add_u32 s37, s36, 0
  buffer_load_dwordx4 v25, s[44:47], s37 offen lds
  s_add_u32 m0, s39, 25600
  s_add_u32 s37, s36, 131072
  buffer_load_dwordx4 v25, s[44:47], s37 offen lds
  s_add_u32 m0, s39, 26624
  s_add_u32 s37, s36, 262144
  buffer_load_dwordx4 v25, s[44:47], s37 offen lds
  s_add_u32 m0, s39, 27648
  s_add_u32 s37, s36, 393216
  buffer_load_dwordx4 v25, s[44:47], s37 offen lds
  buffer_load_dwordx2 v[54:55], off, s[72:75], 0 sc1
  buffer_load_dword v56, off, s[72:75], 0 offset:128 sc1
  s_waitcnt vmcnt(14)
  ds_read_b64_tr_b16 v[64:65], v27 offset:4096
  ds_read_b64_tr_b16 v[66:67], v27 offset:4224
  ds_read_b64_tr_b16 v[68:69], v27 offset:5120
  ds_read_b64_tr_b16 v[70:71], v27 offset:5248
  ds_read_b64_tr_b16 v[72:73], v36 offset:4096
  ds_read_b64_tr_b16 v[74:75], v36 offset:4224
  ds_read_b64_tr_b16 v[76:77], v36 offset:5120
  ds_read_b64_tr_b16 v[78:79], v36 offset:5248
  s_waitcnt lgkmcnt(0)
  ds_write_b128 v4, v[64:67] offset:4096
  ds_write_b128 v4, v[68:71] offset:5120
  ds_write_b128 v4, v[72:75] offset:6144
  ds_write_b128 v4, v[76:79] offset:7168
  s_waitcnt lgkmcnt(0)
  s_xor_b32 s36, s13, 2
  s_lshl_b32 s36, s36, 19
  s_add_u32 m0, s39, 20480
  s_add_u32 s37, s36, 0
  buffer_load_dwordx4 v25, s[44:47], s37 offen lds
  s_add_u32 m0, s39, 21504
  s_add_u32 s37, s36, 131072
  buffer_load_dwordx4 v25, s[44:47], s37 offen lds
  s_add_u32 m0, s39, 22528
  s_add_u32 s37, s36, 262144
  buffer_load_dwordx4 v25, s[44:47], s37 offen lds
  s_add_u32 m0, s39, 23552
  s_add_u32 s37, s36, 393216
  buffer_load_dwordx4 v25, s[44:47], s37 offen lds
  s_waitcnt vmcnt(14)
  ds_read_b64_tr_b16 v[176:177], v27 offset:12288
  ds_read_b64_tr_b16 v[178:179], v27 offset:12416
  ds_read_b64_tr_b16 v[180:181], v27 offset:13312
  ds_read_b64_tr_b16 v[182:183], v27 offset:13440
  ds_read_b64_tr_b16 v[184:185], v36 offset:12288
  ds_read_b64_tr_b16 v[186:187], v36 offset:12416
  ds_read_b64_tr_b16 v[188:189], v36 offset:13312
  ds_read_b64_tr_b16 v[190:191], v36 offset:13440
  s_waitcnt lgkmcnt(0)
  s_xor_b32 s36, s13, 0
  s_lshl_b32 s36, s36, 19
  s_add_u32 m0, s39, 8192
  s_add_u32 s37, s36, 0
  buffer_load_dwordx4 v25, s[44:47], s37 offen lds
  s_add_u32 m0, s39, 9216
  s_add_u32 s37, s36, 131072
  buffer_load_dwordx4 v25, s[44:47], s37 offen lds
  s_add_u32 m0, s39, 10240
  s_add_u32 s37, s36, 262144
  buffer_load_dwordx4 v25, s[44:47], s37 offen lds
  s_add_u32 m0, s39, 11264
  s_add_u32 s37, s36, 393216
  buffer_load_dwordx4 v25, s[44:47], s37 offen lds
  s_waitcnt vmcnt(14)
  ds_read_b64_tr_b16 v[64:65], v27 offset:16384
  ds_read_b64_tr_b16 v[66:67], v27 offset:16512
  ds_read_b64_tr_b16 v[68:69], v27 offset:17408
  ds_read_b64_tr_b16 v[70:71], v27 offset:17536
  ds_read_b64_tr_b16 v[72:73], v36 offset:16384
  ds_read_b64_tr_b16 v[74:75], v36 offset:16512
  ds_read_b64_tr_b16 v[76:77], v36 offset:17408
  ds_read_b64_tr_b16 v[78:79], v36 offset:17536
  s_waitcnt lgkmcnt(0)
  ds_write_b128 v4, v[64:67] offset:16384
  ds_write_b128 v4, v[68:71] offset:17408
  ds_write_b128 v4, v[72:75] offset:18432
  ds_write_b128 v4, v[76:79] offset:19456
  s_waitcnt lgkmcnt(0)
  s_xor_b32 s36, s13, 1
  s_lshl_b32 s36, s36, 19
  s_add_u32 m0, s39, 12288
  s_add_u32 s37, s36, 0
  buffer_load_dwordx4 v25, s[44:47], s37 offen lds
  s_add_u32 m0, s39, 13312
  s_add_u32 s37, s36, 131072
  buffer_load_dwordx4 v25, s[44:47], s37 offen lds
  s_add_u32 m0, s39, 14336
  s_add_u32 s37, s36, 262144
  buffer_load_dwordx4 v25, s[44:47], s37 offen lds
  s_add_u32 m0, s39, 15360
  s_add_u32 s37, s36, 393216
  buffer_load_dwordx4 v25, s[44:47], s37 offen lds
  s_waitcnt vmcnt(14)
  ds_read_b64_tr_b16 v[208:209], v27 offset:24576
  ds_read_b64_tr_b16 v[210:211], v27 offset:24704
  ds_read_b64_tr_b16 v[212:213], v27 offset:25600
  ds_read_b64_tr_b16 v[214:215], v27 offset:25728
  ds_read_b64_tr_b16 v[216:217], v36 offset:24576
  ds_read_b64_tr_b16 v[218:219], v36 offset:24704
  ds_read_b64_tr_b16 v[220:221], v36 offset:25600
  ds_read_b64_tr_b16 v[222:223], v36 offset:25728
  s_waitcnt lgkmcnt(0)
  s_xor_b32 s36, s13, 2
  s_lshl_b32 s36, s36, 15
  s_add_u32 m0, s39, 24576
  s_add_u32 s37, s36, 512
  buffer_load_dwordx4 v26, s[48:51], s37 offen lds
  s_add_u32 m0, s39, 25600
  s_add_u32 s37, s36, 8704
  buffer_load_dwordx4 v26, s[48:51], s37 offen lds
  s_add_u32 m0, s39, 26624
  s_add_u32 s37, s36, 16896
  buffer_load_dwordx4 v26, s[48:51], s37 offen lds
  s_add_u32 m0, s39, 27648
  s_add_u32 s37, s36, 25088
  buffer_load_dwordx4 v26, s[48:51], s37 offen lds
  s_waitcnt vmcnt(12)
  ds_read_b64_tr_b16 v[64:65], v27 offset:20480
  ds_read_b64_tr_b16 v[66:67], v27 offset:20608
  ds_read_b64_tr_b16 v[68:69], v27 offset:21504
  ds_read_b64_tr_b16 v[70:71], v27 offset:21632
  ds_read_b64_tr_b16 v[72:73], v36 offset:20480
  ds_read_b64_tr_b16 v[74:75], v36 offset:20608
  ds_read_b64_tr_b16 v[76:77], v36 offset:21504
  ds_read_b64_tr_b16 v[78:79], v36 offset:21632
  s_waitcnt lgkmcnt(0)
  ds_write_b128 v4, v[64:67] offset:20480
  ds_write_b128 v4, v[68:71] offset:21504
  ds_write_b128 v4, v[72:75] offset:22528
  ds_write_b128 v4, v[76:79] offset:23552
  s_waitcnt lgkmcnt(0)
  s_xor_b32 s36, s13, 3
  s_lshl_b32 s36, s36, 15
  s_add_u32 m0, s39, 28672
  s_add_u32 s37, s36, 512
  buffer_load_dwordx4 v26, s[48:51], s37 offen lds
  s_add_u32 m0, s39, 29696
  s_add_u32 s37, s36, 8704
  buffer_load_dwordx4 v26, s[48:51], s37 offen lds
  s_add_u32 m0, s39, 30720
  s_add_u32 s37, s36, 16896
  buffer_load_dwordx4 v26, s[48:51], s37 offen lds
  s_add_u32 m0, s39, 31744
  s_add_u32 s37, s36, 25088
  buffer_load_dwordx4 v26, s[48:51], s37 offen lds
  s_mov_b32 s19, 0
  s_branch T_arrgo_78
T_arr_77:
  s_add_u32 s19, s19, 1
  s_cmp_gt_u32 s19, 32768
  s_cbranch_scc1 M_exit
  buffer_load_dwordx2 v[54:55], off, s[72:75], 0 sc1
  buffer_load_dword v56, off, s[72:75], 0 offset:128 sc1
  s_waitcnt vmcnt(0)
T_arrgo_78:
  v_sad_u8 v57, v54, 0, 0
  v_sad_u8 v57, v55, 0, v57
  v_or_b32 v58, v54, v55
  v_cmp_gt_u32 vcc, 32, v57
  s_cbranch_vccnz T_arr_77
  v_cmp_gt_u32 vcc, 0x100, v56
  s_cbranch_vccnz T_arr_77
  v_readfirstlane_b32 s36, v58
  s_nop 0
  s_and_b32 s36, s36, 0x20202020
  s_cselect_b32 s56, 0, 1
  s_mov_b32 s14, -1
  s_mov_b32 s30, -1
  s_mov_b32 s19, 0
  s_branch T_kvok_80
T_kv_79:
  s_sleep 4
  s_add_u32 s19, s19, 1
  s_cmp_gt_u32 s19, 32768
  s_cbranch_scc1 M_exit
T_kvok_80:
  s_add_u32 s39, s99, 128
  s_mov_b32 s38, 0
  s_mov_b32 s37, 0
  s_atomic_or s38, s[58:59], s99 glc
  s_atomic_or s37, s[58:59], s39 glc
  s_waitcnt lgkmcnt(0)
  s_add_u32 s37, s37, 30
  s_cmp_ge_u32 s38, 30
  s_cselect_b32 s38, s37, s38
  s_cmp_ge_u32 s38, 64
  s_cselect_b32 s38, 100, s38
  s_sub_u32 s38, s38, 1
  s_max_i32 s30, s30, s38
  s_cmp_ge_i32 s14, s30
  s_cbranch_scc1 T_kv_79
  s_mov_b32 m0, s31
  s_nop 0
  buffer_load_dwordx4 v9, s[4:7], s27 offen sc1 lds
  s_mov_b32 m0, s32
  s_nop 0
  buffer_load_dwordx4 v9, s[4:7], s27 offen offset:128 sc1 lds
  s_mov_b32 m0, s33
  s_nop 0
  buffer_load_dwordx4 v10, s[4:7], s28 offen sc1 lds
  s_mov_b32 m0, s34
  s_nop 0
  buffer_load_dwordx4 v10, s[4:7], s28 offen offset:256 sc1 lds
  s_add_u32 s27, s27, 8192
  s_add_u32 s28, s28, 8192
  s_lshl_b32 s36, s12, 10
  s_add_u32 s36, s36, 145752064
  buffer_load_dwordx4 v[40:43], v2, s[4:7], s36 offen sc1
  s_waitcnt vmcnt(17)
  ds_read_b64_tr_b16 v[64:65], v27 offset:8192
  ds_read_b64_tr_b16 v[66:67], v27 offset:8320
  ds_read_b64_tr_b16 v[68:69], v27 offset:9216
  ds_read_b64_tr_b16 v[70:71], v27 offset:9344
  ds_read_b64_tr_b16 v[72:73], v36 offset:8192
  ds_read_b64_tr_b16 v[74:75], v36 offset:8320
  ds_read_b64_tr_b16 v[76:77], v36 offset:9216
  ds_read_b64_tr_b16 v[78:79], v36 offset:9344
  s_waitcnt lgkmcnt(0)
  ds_write_b128 v4, v[64:67] offset:8192
  ds_write_b128 v4, v[68:71] offset:9216
  ds_write_b128 v4, v[72:75] offset:10240
  ds_write_b128 v4, v[76:79] offset:11264
  s_waitcnt lgkmcnt(0)
  s_waitcnt vmcnt(13)
  ds_read_b64_tr_b16 v[64:65], v27 offset:12288
  ds_read_b64_tr_b16 v[66:67], v27 offset:12416
  ds_read_b64_tr_b16 v[68:69], v27 offset:13312
  ds_read_b64_tr_b16 v[70:71], v27 offset:13440
  ds_read_b64_tr_b16 v[72:73], v36 offset:12288
  ds_read_b64_tr_b16 v[74:75], v36 offset:12416
  ds_read_b64_tr_b16 v[76:77], v36 offset:13312
  ds_read_b64_tr_b16 v[78:79], v36 offset:13440
  s_waitcnt lgkmcnt(0)
  ds_write_b128 v4, v[64:67] offset:12288
  ds_write_b128 v4, v[68:71] offset:13312
  ds_write_b128 v4, v[72:75] offset:14336
  ds_write_b128 v4, v[76:79] offset:15360
  s_waitcnt lgkmcnt(0)
  s_waitcnt vmcnt(9)
  ds_read_b64_tr_b16 v[64:65], v28 offset:24576
  ds_read_b64_tr_b16 v[66:67], v28 offset:24832
  ds_read_b64_tr_b16 v[68:69], v28 offset:25600
  ds_read_b64_tr_b16 v[70:71], v28 offset:25856
  ds_read_b64_tr_b16 v[72:73], v28 offset:24584
  ds_read_b64_tr_b16 v[74:75], v28 offset:24840
  ds_read_b64_tr_b16 v[76:77], v28 offset:25608
  ds_read_b64_tr_b16 v[78:79], v28 offset:25864
  s_waitcnt lgkmcnt(0)
  ds_write_b128 v4, v[64:67] offset:24576
  ds_write_b128 v4, v[68:71] offset:25600
  ds_write_b128 v4, v[72:75] offset:26624
  ds_write_b128 v4, v[76:79] offset:27648
  s_waitcnt lgkmcnt(0)
  s_waitcnt vmcnt(5)
  ds_read_b64_tr_b16 v[64:65], v28 offset:28672
  ds_read_b64_tr_b16 v[66:67], v28 offset:28928
  ds_read_b64_tr_b16 v[68:69], v28 offset:29696
  ds_read_b64_tr_b16 v[70:71], v28 offset:29952
  ds_read_b64_tr_b16 v[72:73], v28 offset:28680
  ds_read_b64_tr_b16 v[74:75], v28 offset:28936
  ds_read_b64_tr_b16 v[76:77], v28 offset:29704
  ds_read_b64_tr_b16 v[78:79], v28 offset:29960
  s_waitcnt lgkmcnt(0)
  ds_write_b128 v4, v[64:67] offset:28672
  ds_write_b128 v4, v[68:71] offset:29696
  ds_write_b128 v4, v[72:75] offset:30720
  ds_write_b128 v4, v[76:79] offset:31744
  s_waitcnt lgkmcnt(0)
  s_waitcnt vmcnt(0) lgkmcnt(0)
  s_barrier
  s_cmp_ge_u32 s13, 2
  s_cselect_b64 vcc, -1, 0
  v_cndmask_b32 v8, v8, v19, vcc
  ds_read_b128 v[68:71], v4 offset:0
  ds_read_b128 v[72:75], v4 offset:1024
  ds_read_b128 v[76:79], v4 offset:4096
  ds_read_b128 v[80:83], v4 offset:5120
  ds_read_b128 v[84:87], v4 offset:8192
  ds_read_b128 v[88:91], v4 offset:9216
  ds_read_b128 v[92:95], v4 offset:2048
  ds_read_b128 v[96:99], v4 offset:3072
  ds_read_b128 v[100:103], v4 offset:6144
  ds_read_b128 v[104:107], v4 offset:7168
  ds_read_b128 v[108:111], v4 offset:10240
  ds_read_b128 v[112:115], v4 offset:11264
  ds_read_b128 v[28:31], v59 offset:16384
  ds_read_b128 v[32:35], v59 offset:20480
  ds_read_b128 v[36:39], v2 offset:8192
  ds_read_b128 v[40:43], v2 offset:9216
  ds_read_b128 v[44:47], v2 offset:10240
  ds_read_b128 v[48:51], v2 offset:11264
  ds_read_b128 v[52:55], v2 offset:12288
  ds_read_b128 v[56:59], v2 offset:13312
  ds_read_b128 v[60:63], v2 offset:14336
  ds_read_b128 v[64:67], v2 offset:15360
  s_and_b32 s36, s13, 1
  s_lshl_b32 s36, s36, 12
  s_add_u32 s22, s22, s36
  s_add_u32 s23, s36, 145752064
  s_mov_b32 s14, -1
  s_and_b32 s57, s14, 1
  s_and_b32 s36, s14, 3
  s_lshl_b32 s36, s36, 13
  s_add_u32 s26, s36, s23
  s_add_u32 s36, s36, 8192
  s_and_b32 s36, s36, 0x7fff
  s_add_u32 s24, s36, 145752064
  s_add_u32 s25, s36, 145756160
  s_add_u32 s35, s36, s23
  s_waitcnt lgkmcnt(0)
  s_cmp_lg_u32 s56, 0
  s_cbranch_scc1 M_global
  s_cmp_eq_u32 s13, 1
  s_cbranch_scc1 T_w_82
  s_cmp_eq_u32 s13, 2
  s_cbranch_scc1 T_w_83
  s_cmp_eq_u32 s13, 3
  s_cbranch_scc1 T_w_84
T_w_81:
  s_mov_b32 s19, 0
  v_mov_b64 v[16:17], 0
  v_mov_b64 v[18:19], 0
  v_mov_b64 v[20:21], 0
  v_mov_b64 v[22:23], 0
  v_mov_b64 v[24:25], 0
  v_mov_b64 v[26:27], 0
  buffer_load_dwordx4 v[124:127], v3, s[4:7], s24 offen offset:0 sc1
  buffer_load_dwordx4 v[116:119], v3, s[4:7], s25 offen offset:0 sc1
  buffer_load_dwordx4 v[124:127], v3, s[4:7], s24 offen offset:0 sc1
  buffer_load_dwordx4 v[116:119], v3, s[4:7], s25 offen offset:0 sc1
  s_branch T_loop_85
.p2align 6
T_retry_86:
  s_mov_b64 exec, vcc
  buffer_load_dwordx4 v[124:127], v3, s[4:7], s24 offen offset:0 sc1
  buffer_load_dwordx4 v[116:119], v3, s[4:7], s25 offen offset:0 sc1
  s_mov_b64 exec, -1
  s_add_u32 s19, s19, 1
  s_cmp_gt_u32 s19, 32768
  s_cbranch_scc1 M_exit
T_loop_85:
  s_waitcnt vmcnt(3) lgkmcnt(0)
  v_max3_u32 v123, v124, v125, v126
  v_max_u32 v123, v123, v127
  v_mov_b32_dpp v120, v124 row_ror:8 row_mask:0xf bank_mask:0xf
  v_mov_b32_dpp v121, v125 row_ror:8 row_mask:0xf bank_mask:0xf
  s_waitcnt vmcnt(2)
  v_max3_u32 v123, v123, v116, v117
  v_max3_u32 v123, v123, v118, v119
  v_cmp_eq_u32 vcc, -1, v123
  s_cbranch_vccnz T_retry_86
  v_smfmac_f32_16x16x64_bf16 v[16:19], v[124:127], v[68:75], v0
  s_add_u32 s14, s14, 1
  ds_write_b128 v2, v[124:127] offset:0
  v_mov_b32_dpp v122, v126 row_ror:8 row_mask:0xf bank_mask:0xf
  v_smfmac_f32_16x16x64_bf16 v[20:23], v[124:127], v[76:83], v0
  s_and_b32 s57, s14, 1
  v_mov_b32_dpp v123, v127 row_ror:8 row_mask:0xf bank_mask:0xf
  v_smfmac_f32_16x16x64_bf16 v[24:27], v[124:127], v[84:91], v0
  s_and_b32 s36, s14, 3
  ds_write_b128 v2, v[116:119] offset:4096
  v_smfmac_f32_16x16x64_bf16 v[16:19], v[120:123], v[92:99], v0
  s_lshl_b32 s36, s36, 13
  v_mov_b32_dpp v84, v116 row_ror:8 row_mask:0xf bank_mask:0xf
  v_smfmac_f32_16x16x64_bf16 v[20:23], v[120:123], v[100:107], v0
  s_add_u32 s26, s36, s23
  ds_read_b128 v[68:71], v4 offset:12288
  v_mov_b32_dpp v85, v117 row_ror:8 row_mask:0xf bank_mask:0xf
  v_smfmac_f32_16x16x64_bf16 v[24:27], v[120:123], v[108:115], v0
  s_add_u32 s36, s36, 8192
  ds_read_b128 v[72:75], v4 offset:13312
  v_mov_b32_dpp v86, v118 row_ror:8 row_mask:0xf bank_mask:0xf
  v_smfmac_f32_16x16x64_bf16 v[16:19], v[116:119], v[224:231], v0
  s_and_b32 s36, s36, 0x7fff
  ds_read_b128 v[76:79], v4 offset:14336
  v_mov_b32_dpp v87, v119 row_ror:8 row_mask:0xf bank_mask:0xf
  v_smfmac_f32_16x16x64_bf16 v[20:23], v[116:119], v[240:247], v0
  s_waitcnt lgkmcnt(3)
  s_barrier
  ds_read_b128 v[100:103], v2 offset:1024
  v_smfmac_f32_16x16x64_bf16 v[24:27], v[116:119], a[0:7], v0
  s_mov_b32 m0, s31
  ds_read_b128 v[120:123], v1 offset:1024
  v_smfmac_f32_16x16x64_bf16 v[16:19], v[84:87], v[232:239], v0
  s_cmp_ge_i32 s14, s30
  s_cbranch_scc1 T_kvw_89
T_kvb_90:
  v_smfmac_f32_16x16x64_bf16 v[20:23], v[84:87], v[248:255], v0
  ds_read_b128 v[80:83], v4 offset:15360
  buffer_load_dwordx4 v9, s[4:7], s27 offen sc1 lds
  v_smfmac_f32_16x16x64_bf16 v[24:27], v[84:87], a[8:15], v0
  s_waitcnt lgkmcnt(2)
  s_mov_b32 m0, s32
  v_smfmac_f32_16x16x64_bf16 v[16:19], v[100:103], v[128:135], v0
  ds_read_b128 v[92:95], v2 offset:2048
  v_smfmac_f32_16x16x64_bf16 v[20:23], v[100:103], v[144:151], v0
  ds_read_b128 v[96:99], v1 offset:2048
  v_smfmac_f32_16x16x64_bf16 v[24:27], v[100:103], v[68:75], v0
  s_waitcnt vmcnt(1) lgkmcnt(3)
  ds_read_b128 v[116:119], v2 offset:3072
  buffer_load_dwordx4 v9, s[4:7], s27 offen offset:128 sc1 lds
  v_smfmac_f32_16x16x64_bf16 v[16:19], v[120:123], v[136:143], v0
  ds_read_b128 v[124:127], v1 offset:3072
  s_mov_b32 m0, s33
  v_smfmac_f32_16x16x64_bf16 v[20:23], v[120:123], v[152:159], v0
  s_waitcnt lgkmcnt(4)
  ds_read_b128 v[104:107], v2 offset:5120
  v_smfmac_f32_16x16x64_bf16 v[24:27], v[120:123], v[76:83], v0
  s_waitcnt lgkmcnt(4)
  ds_read_b128 v[108:111], v1 offset:5120
  v_smfmac_f32_16x16x64_bf16 v[16:19], v[92:95], v[160:167], v0
  s_waitcnt lgkmcnt(4)
  ds_read_b128 v[112:115], v2 offset:6144
  buffer_load_dwordx4 v10, s[4:7], s28 offen sc1 lds
  v_smfmac_f32_16x16x64_bf16 v[16:19], v[96:99], v[168:175], v0
  s_waitcnt lgkmcnt(4)
  ds_read_b128 v[84:87], v1 offset:6144
  s_mov_b32 m0, s34
  v_smfmac_f32_16x16x64_bf16 v[16:19], v[116:119], v[192:199], v0
  s_waitcnt lgkmcnt(4)
  ds_read_b128 v[88:91], v2 offset:7168
  v_smfmac_f32_16x16x64_bf16 v[16:19], v[124:127], v[200:207], v0
  s_waitcnt lgkmcnt(4)
  ds_read_b128 v[100:103], v1 offset:7168
  v_smfmac_f32_16x16x64_bf16 v[16:19], v[104:107], a[16:23], v0
  s_waitcnt lgkmcnt(4)
  ds_read_b128 v[68:71], v4 offset:16384
  buffer_load_dwordx4 v10, s[4:7], s28 offen offset:256 sc1 lds
  v_smfmac_f32_16x16x64_bf16 v[16:19], v[108:111], a[24:31], v0
  s_waitcnt lgkmcnt(4)
  ds_read_b128 v[72:75], v4 offset:17408
  v_smfmac_f32_16x16x64_bf16 v[16:19], v[112:115], a[64:71], v0
  s_waitcnt lgkmcnt(4)
  ds_read_b128 v[76:79], v4 offset:18432
  v_smfmac_f32_16x16x64_bf16 v[16:19], v[84:87], a[72:79], v0
  s_waitcnt lgkmcnt(4)
  ds_read_b128 v[80:83], v4 offset:19456
  v_smfmac_f32_16x16x64_bf16 v[16:19], v[88:91], a[112:119], v0
  s_waitcnt lgkmcnt(4)
  v_smfmac_f32_16x16x64_bf16 v[16:19], v[100:103], a[120:127], v0
  s_add_u32 s24, s36, 145752064
  s_add_u32 s25, s36, 145756160
  v_smfmac_f32_16x16x64_bf16 v[20:23], v[92:95], v[176:183], v0
  s_add_u32 s35, s36, s23
  v_smfmac_f32_16x16x64_bf16 v[20:23], v[96:99], v[184:191], v0
  s_waitcnt lgkmcnt(2)
  v_smfmac_f32_16x16x64_bf16 v[20:23], v[116:119], v[68:75], v0
  s_waitcnt lgkmcnt(0)
  ds_read_b128 v[68:71], v4 offset:20480
  v_mul_f32 v16, s18, v16
  v_smfmac_f32_16x16x64_bf16 v[20:23], v[124:127], v[76:83], v0
  ds_read_b128 v[72:75], v4 offset:21504
  v_mul_f32 v17, s18, v17
  v_smfmac_f32_16x16x64_bf16 v[20:23], v[104:107], a[32:39], v0
  ds_read_b128 v[76:79], v4 offset:22528
  v_mul_f32 v18, s18, v18
  v_smfmac_f32_16x16x64_bf16 v[20:23], v[108:111], a[40:47], v0
  ds_read_b128 v[80:83], v4 offset:23552
  v_mul_f32 v19, s18, v19
  v_smfmac_f32_16x16x64_bf16 v[20:23], v[112:115], a[80:87], v0
  v_cvt_pk_bf16_f32 v120, v16, v17
  v_smfmac_f32_16x16x64_bf16 v[20:23], v[84:87], a[88:95], v0
  v_cvt_pk_bf16_f32 v121, v18, v19
  v_smfmac_f32_16x16x64_bf16 v[20:23], v[88:91], a[128:135], v0
  ds_write_b64 v5, v[120:121] offset:24576
  v_smfmac_f32_16x16x64_bf16 v[20:23], v[100:103], a[136:143], v0
  s_waitcnt lgkmcnt(3)
  v_smfmac_f32_16x16x64_bf16 v[24:27], v[92:95], v[68:75], v0
  s_waitcnt lgkmcnt(1)
  v_mov_b64 v[92:93], 0
  v_smfmac_f32_16x16x64_bf16 v[24:27], v[96:99], v[76:83], v0
  s_nop 1
  v_cvt_pk_bf16_f32 v122, v20, v21
  v_cvt_pk_bf16_f32 v123, v22, v23
  v_smfmac_f32_16x16x64_bf16 v[24:27], v[116:119], v[208:215], v0
  ds_write_b64 v5, v[122:123] offset:26880
  v_mov_b64 v[94:95], 0
  v_smfmac_f32_16x16x64_bf16 v[24:27], v[124:127], v[216:223], v0
  s_waitcnt lgkmcnt(1)
  s_barrier
  ds_read_b64_tr_b16 v[68:69], v6 offset:24576
  v_smfmac_f32_16x16x64_bf16 v[24:27], v[104:107], a[48:55], v0
  s_add_u32 s27, s27, 8192
  ds_read_b64_tr_b16 v[70:71], v6 offset:24640
  ds_read_b64_tr_b16 v[72:73], v6 offset:24832
  v_smfmac_f32_16x16x64_bf16 v[24:27], v[108:111], a[56:63], v0
  s_add_u32 s28, s28, 8192
  ds_read_b64_tr_b16 v[74:75], v6 offset:24896
  ds_read_b64_tr_b16 v[76:77], v6 offset:25088
  v_smfmac_f32_16x16x64_bf16 v[24:27], v[112:115], a[96:103], v0
  s_nop 0
  ds_read_b64_tr_b16 v[78:79], v6 offset:25152
  ds_read_b64_tr_b16 v[80:81], v6 offset:25344
  v_smfmac_f32_16x16x64_bf16 v[24:27], v[84:87], a[104:111], v0
  ds_read_b64_tr_b16 v[82:83], v6 offset:25408
  v_mov_b64 v[96:97], 0
  v_smfmac_f32_16x16x64_bf16 v[24:27], v[88:91], a[144:151], v0
  s_waitcnt lgkmcnt(8)
  s_barrier
  ds_read_b64_tr_b16 v[116:117], v6 offset:26880
  v_smfmac_f32_16x16x64_bf16 v[24:27], v[100:103], a[152:159], v0
  s_waitcnt lgkmcnt(7)
  ds_read_b64_tr_b16 v[118:119], v6 offset:26944
  v_mfma_f32_16x16x32_bf16 v[16:19], v[36:39], v[68:71], 0
  s_waitcnt lgkmcnt(6)
  ds_read_b64_tr_b16 v[124:125], v6 offset:27136
  ds_read_b64_tr_b16 v[126:127], v6 offset:27200
  v_mfma_f32_16x16x32_bf16 v[16:19], v[40:43], v[72:75], v[16:19]
  s_waitcnt lgkmcnt(6)
  ds_read_b64_tr_b16 v[104:105], v6 offset:27392
  ds_read_b64_tr_b16 v[106:107], v6 offset:27456
  v_mfma_f32_16x16x32_bf16 v[16:19], v[44:47], v[76:79], v[16:19]
  s_waitcnt lgkmcnt(6)
  ds_read_b64_tr_b16 v[108:109], v6 offset:27648
  ds_read_b64_tr_b16 v[110:111], v6 offset:27712
  v_mfma_f32_16x16x32_bf16 v[16:19], v[48:51], v[80:83], v[16:19]
  s_waitcnt lgkmcnt(6)
  v_cvt_pk_bf16_f32 v120, v24, v25
  v_cvt_pk_bf16_f32 v121, v26, v27
  v_mfma_f32_16x16x32_bf16 v[112:115], v[116:119], v[68:71], 0
  s_waitcnt lgkmcnt(4)
  buffer_store_dwordx4 v[120:123], v2, s[4:7], s29 offen offset:0 sc1
  v_mov_b64 v[98:99], 0
  v_mfma_f32_16x16x32_bf16 v[112:115], v[124:127], v[72:75], v[112:115]
  s_waitcnt lgkmcnt(2)
  v_mov_b64 v[36:37], 0
  v_exp_f32 v100, v16
  v_mfma_f32_16x16x32_bf16 v[112:115], v[104:107], v[76:79], v[112:115]
  s_waitcnt lgkmcnt(0)
  v_exp_f32 v101, v17
  v_mfma_f32_16x16x32_bf16 v[112:115], v[108:111], v[80:83], v[112:115]
  s_add_u32 s29, s29, 131072
  v_exp_f32 v102, v18
  v_mfma_f32_16x16x32_bf16 v[20:23], v[52:55], v[68:71], 0
  s_cmp_eq_u32 s14, 63
  v_exp_f32 v103, v19
  v_mfma_f32_16x16x32_bf16 v[20:23], v[56:59], v[72:75], v[20:23]
  s_cbranch_scc1 M_tdone
  v_cvt_pk_bf16_f32 v44, v100, v101
  v_cvt_pk_bf16_f32 v45, v102, v103
  v_mfma_f32_16x16x32_bf16 v[20:23], v[60:63], v[76:79], v[20:23]
  v_exp_f32 v100, v112
  v_mfma_f32_16x16x32_bf16 v[20:23], v[64:67], v[80:83], v[20:23]
  v_exp_f32 v101, v113
  v_exp_f32 v102, v114
  v_exp_f32 v103, v115
  v_cvt_pk_bf16_f32 v84, v100, v101
  v_cvt_pk_bf16_f32 v85, v102, v103
  v_cndmask_b32 v48, v84, 0, s[16:17]
  v_cndmask_b32 v49, v85, 0, s[16:17]
  v_cndmask_b32 v50, 0, v84, s[16:17]
  v_cndmask_b32 v51, 0, v85, s[16:17]
  v_exp_f32 v100, v20
  v_mfma_f32_16x16x16_bf16 v[88:91], v[12:13], v[48:49], 0
  v_exp_f32 v101, v21
  v_mfma_f32_16x16x16_bf16 v[24:27], v[120:121], v[48:49], 0
  v_exp_f32 v102, v22
  v_mfma_f32_16x16x16_bf16 v[116:119], v[120:121], v[50:51], 0
  v_exp_f32 v103, v23
  v_cvt_pk_bf16_f32 v46, v100, v101
  v_cvt_pk_bf16_f32 v47, v102, v103
  v_mov_b64 v[38:39], 0
  s_nop 0
  v_mfma_f32_16x16x32_bf16 v[88:91], v[12:15], v[44:47], v[88:91]
  v_mov_b64 v[40:41], 0
  v_mov_b64 v[42:43], 0
  v_mfma_f32_16x16x32_bf16 v[24:27], v[28:31], v[44:47], v[24:27]
  ds_read_b128 v[52:55], v4 offset:24576
  ds_read_b128 v[56:59], v4 offset:25600
  v_mfma_f32_16x16x32_bf16 v[116:119], v[32:35], v[44:47], v[116:119]
  s_nop 1
  v_rcp_f32 v89, v88
  v_subrev_u32 v100, s54, v88
  v_cmp_le_u32 vcc, s55, v100
  v_mul_f32 v24, v89, v24
  v_mul_f32 v25, v89, v25
  s_cbranch_vccnz T_slow_92
T_back_93:
  v_cvt_pk_bf16_f32 v124, v24, v25
  v_pk_mul_f32 v[26:27], v[26:27], v[88:89] op_sel:[0,1] op_sel_hi:[1,1]
  v_pk_mul_f32 v[116:117], v[116:117], v[88:89] op_sel:[0,1] op_sel_hi:[1,1]
  v_pk_mul_f32 v[118:119], v[118:119], v[88:89] op_sel:[0,1] op_sel_hi:[1,1]
  v_cvt_pk_bf16_f32 v125, v26, v27
  v_cvt_pk_bf16_f32 v126, v116, v117
  v_cvt_pk_bf16_f32 v127, v118, v119
  ds_write_b128 v11, v[124:127] offset:29184
  s_nop 0
  v_smfmac_f32_16x16x64_bf16 v[92:95], v[124:127], a[160:167], v0
  v_smfmac_f32_16x16x64_bf16 v[96:99], v[124:127], a[168:175], v0
  v_smfmac_f32_16x16x64_bf16 v[36:39], v[124:127], a[176:183], v0
  v_smfmac_f32_16x16x64_bf16 v[40:43], v[124:127], a[184:191], v0
  s_waitcnt lgkmcnt(0)
  s_barrier
  ds_read_b128 v[104:107], v11 offset:29696
  ds_read_b128 v[108:111], v11 offset:30208
  ds_read_b128 v[68:71], v11 offset:30720
  s_waitcnt lgkmcnt(2)
  v_smfmac_f32_16x16x64_bf16 v[92:95], v[104:107], a[192:199], v0
  s_waitcnt lgkmcnt(1)
  ds_read_b128 v[76:79], v4 offset:28672
  v_smfmac_f32_16x16x64_bf16 v[92:95], v[108:111], a[224:231], v0
  s_waitcnt lgkmcnt(1)
  ds_read_b128 v[80:83], v4 offset:29696
  v_smfmac_f32_16x16x64_bf16 v[92:95], v[68:71], a[240:247], v0
  ds_read_b128 v[60:63], v4 offset:26624
  v_smfmac_f32_16x16x64_bf16 v[96:99], v[104:107], a[200:207], v0
  ds_read_b128 v[64:67], v4 offset:27648
  v_smfmac_f32_16x16x64_bf16 v[96:99], v[108:111], a[232:239], v0
  ds_read_b128 v[28:31], v4 offset:30720
  s_nop 0
  v_cvt_pk_bf16_f32 v16, v92, v93
  v_cvt_pk_bf16_f32 v17, v94, v95
  v_bfi_b32 v16, 1, s57, v16
  v_smfmac_f32_16x16x64_bf16 v[96:99], v[68:71], a[248:255], v0
  buffer_store_dwordx2 v[16:17], v7, s[4:7], s20 offen offset:0
  v_smfmac_f32_16x16x64_bf16 v[36:39], v[104:107], a[208:215], v0
  ds_read_b128 v[32:35], v4 offset:31744
  v_smfmac_f32_16x16x64_bf16 v[36:39], v[108:111], v[52:59], v0
  s_waitcnt lgkmcnt(4)
  s_nop 0
  v_cvt_pk_bf16_f32 v18, v96, v97
  v_cvt_pk_bf16_f32 v19, v98, v99
  v_bfi_b32 v18, 1, s57, v18
  v_smfmac_f32_16x16x64_bf16 v[36:39], v[68:71], v[76:83], v0
  buffer_store_dwordx2 v[18:19], v7, s[4:7], s20 offen offset:64
  v_smfmac_f32_16x16x64_bf16 v[40:43], v[104:107], a[216:223], v0
  s_waitcnt lgkmcnt(2)
  ds_read_b128 v[116:119], v2 offset:31232
  v_smfmac_f32_16x16x64_bf16 v[40:43], v[108:111], v[60:67], v0
  s_waitcnt lgkmcnt(1)
  s_nop 0
  v_cvt_pk_bf16_f32 v20, v36, v37
  v_cvt_pk_bf16_f32 v21, v38, v39
  v_bfi_b32 v20, 1, s57, v20
  v_smfmac_f32_16x16x64_bf16 v[40:43], v[68:71], v[28:35], v0
  buffer_store_dwordx2 v[20:21], v7, s[4:7], s21 offen offset:0
  s_nop 6
  v_cvt_pk_bf16_f32 v22, v40, v41
  v_cvt_pk_bf16_f32 v23, v42, v43
  v_bfi_b32 v22, 1, s57, v22
  buffer_store_dwordx2 v[22:23], v7, s[4:7], s21 offen offset:64
  ds_read_b128 v[68:71], v4 offset:0
  ds_read_b128 v[72:75], v4 offset:1024
  ds_read_b128 v[76:79], v4 offset:4096
  ds_read_b128 v[80:83], v4 offset:5120
  ds_read_b128 v[84:87], v4 offset:8192
  ds_read_b128 v[88:91], v4 offset:9216
  v_mov_b64 v[16:17], 0
  v_mov_b64 v[18:19], 0
  v_mov_b64 v[20:21], 0
  v_mov_b64 v[22:23], 0
  v_mov_b64 v[24:25], 0
  v_mov_b64 v[26:27], 0
  s_mov_b32 s19, 0
  v_mov_b32 v49, -1
  s_waitcnt vmcnt(2)
  buffer_load_dwordx4 v[52:55], v2, s[4:7], s22 offen offset:0 sc1
  buffer_load_dwordx4 v[56:59], v2, s[4:7], s22 offen offset:1024 sc1
  buffer_load_dwordx4 v[60:63], v2, s[4:7], s22 offen offset:2048 sc1
  buffer_load_dwordx4 v[64:67], v2, s[4:7], s22 offen offset:3072 sc1
  ds_read_b128 v[92:95], v4 offset:2048
  ds_read_b128 v[96:99], v4 offset:3072
  ds_read_b128 v[100:103], v4 offset:6144
  ds_read_b128 v[104:107], v4 offset:7168
  ds_read_b128 v[108:111], v4 offset:10240
  ds_read_b128 v[112:115], v4 offset:11264
  ds_read_b64 v[44:45], v2 offset:32256
  s_waitcnt lgkmcnt(0)
  v_readfirstlane_b32 s38, v44
  v_readfirstlane_b32 s37, v45
  s_nop 0
  s_add_u32 s37, s37, 30
  s_cmp_ge_u32 s38, 30
  s_cselect_b32 s38, s37, s38
  s_cmp_ge_u32 s38, 64
  s_cselect_b32 s38, 100, s38
  s_sub_u32 s38, s38, 1
  s_max_i32 s30, s30, s38
  s_waitcnt lgkmcnt(12)
  s_waitcnt vmcnt(3)
  v_mfma_f32_16x16x32_bf16 v[120:123], v[116:119], v[52:55], 0
  v_xor_b32 v48, s57, v52
  v_bitop3_b32 v48, v48, v54, s57 bitop3:0xf6
  s_waitcnt vmcnt(2)
  v_mfma_f32_16x16x32_bf16 v[120:123], v[116:119], v[56:59], v[120:123]
  v_bitop3_b32 v48, v48, v56, s57 bitop3:0xf6
  v_bitop3_b32 v48, v48, v58, s57 bitop3:0xf6
  s_waitcnt vmcnt(1)
  v_mfma_f32_16x16x32_bf16 v[120:123], v[116:119], v[60:63], v[120:123]
  v_bitop3_b32 v48, v48, v60, s57 bitop3:0xf6
  v_bitop3_b32 v48, v48, v62, s57 bitop3:0xf6
  s_waitcnt vmcnt(0)
  v_mfma_f32_16x16x32_bf16 v[120:123], v[116:119], v[64:67], v[120:123]
  v_bitop3_b32 v48, v48, v64, s57 bitop3:0xf6
  v_bitop3_b32 v48, v48, v66, s57 bitop3:0xf6
  v_and_b32 v48, 1, v48
  v_cmp_ne_u32 vcc, 0, v48
  s_cbranch_vccnz T_p1re_95
T_p1ok_96:
  s_nop 2
  v_add_f32_dpp v120, v120, v120 row_ror:8 row_mask:0xf bank_mask:0xf
  v_add_f32_dpp v121, v121, v121 row_ror:8 row_mask:0xf bank_mask:0xf
  v_cvt_pk_bf16_f32 v48, v120, v121
  v_min_u32 v48, -2, v48
  buffer_store_dword v48, v8, s[4:7], s35 offen
  buffer_store_dword v49, v8, s[4:7], s26 offen
  s_barrier
  ds_read_b128 v[28:31], v2 offset:16384
  ds_read_b128 v[32:35], v2 offset:20480
  ds_read_b128 v[36:39], v2 offset:8192
  ds_read_b128 v[40:43], v2 offset:9216
  ds_read_b128 v[44:47], v2 offset:10240
  ds_read_b128 v[48:51], v2 offset:11264
  buffer_load_dwordx4 v[124:127], v3, s[4:7], s24 offen offset:0 sc1
  buffer_load_dwordx4 v[116:119], v3, s[4:7], s25 offen offset:0 sc1
  ds_read_b128 v[52:55], v2 offset:12288
  ds_read_b128 v[56:59], v2 offset:13312
  ds_read_b128 v[60:63], v2 offset:14336
  ds_read_b128 v[64:67], v2 offset:15360
  buffer_load_dwordx4 v[124:127], v3, s[4:7], s24 offen offset:0 sc1
  buffer_load_dwordx4 v[116:119], v3, s[4:7], s25 offen offset:0 sc1
  s_mov_b32 s19, 0
  s_branch T_loop_85
T_p1re_95:
  s_mov_b64 exec, vcc
  buffer_load_dwordx4 v[52:55], v2, s[4:7], s22 offen offset:0 sc1
  buffer_load_dwordx4 v[56:59], v2, s[4:7], s22 offen offset:1024 sc1
  buffer_load_dwordx4 v[60:63], v2, s[4:7], s22 offen offset:2048 sc1
  buffer_load_dwordx4 v[64:67], v2, s[4:7], s22 offen offset:3072 sc1
  s_mov_b64 exec, -1
  s_add_u32 s19, s19, 1
  s_cmp_gt_u32 s19, 32768
  s_cbranch_scc1 M_exit
  s_waitcnt vmcnt(3)
  v_mfma_f32_16x16x32_bf16 v[120:123], v[116:119], v[52:55], 0
  v_xor_b32 v48, s57, v52
  v_bitop3_b32 v48, v48, v54, s57 bitop3:0xf6
  s_waitcnt vmcnt(2)
  v_mfma_f32_16x16x32_bf16 v[120:123], v[116:119], v[56:59], v[120:123]
  v_bitop3_b32 v48, v48, v56, s57 bitop3:0xf6
  v_bitop3_b32 v48, v48, v58, s57 bitop3:0xf6
  s_waitcnt vmcnt(1)
  v_mfma_f32_16x16x32_bf16 v[120:123], v[116:119], v[60:63], v[120:123]
  v_bitop3_b32 v48, v48, v60, s57 bitop3:0xf6
  v_bitop3_b32 v48, v48, v62, s57 bitop3:0xf6
  s_waitcnt vmcnt(0)
  v_mfma_f32_16x16x32_bf16 v[120:123], v[116:119], v[64:67], v[120:123]
  v_bitop3_b32 v48, v48, v64, s57 bitop3:0xf6
  v_bitop3_b32 v48, v48, v66, s57 bitop3:0xf6
  v_and_b32 v48, 1, v48
  v_cmp_ne_u32 vcc, 0, v48
  s_cbranch_vccnz T_p1re_95
  s_branch T_p1ok_96
T_kvw_89:
  s_mov_b32 s19, 0
  s_branch T_kvok_98
T_kv_97:
  s_sleep 4
  s_add_u32 s19, s19, 1
  s_cmp_gt_u32 s19, 32768
  s_cbranch_scc1 M_exit
T_kvok_98:
  s_add_u32 s39, s99, 128
  s_mov_b32 s38, 0
  s_mov_b32 s37, 0
  s_atomic_or s38, s[58:59], s99 glc
  s_atomic_or s37, s[58:59], s39 glc
  s_waitcnt lgkmcnt(0)
  s_add_u32 s37, s37, 30
  s_cmp_ge_u32 s38, 30
  s_cselect_b32 s38, s37, s38
  s_cmp_ge_u32 s38, 64
  s_cselect_b32 s38, 100, s38
  s_sub_u32 s38, s38, 1
  s_max_i32 s30, s30, s38
  s_cmp_ge_i32 s14, s30
  s_cbranch_scc1 T_kv_97
  s_branch T_kvb_90
T_slow_92:
  s_nop 7
  v_max3_f32 v100, v16, v17, v18
  v_max3_f32 v100, v100, v19, v20
  v_max3_f32 v100, v100, v21, v22
  v_max3_f32 v100, v100, v23, v112
  v_max3_f32 v100, v100, v113, v114
  v_max_f32 v100, v100, v115
  v_mov_b32 v101, v100
  s_nop 1
  v_permlane32_swap_b32 v100, v101
  s_nop 1
  v_max_f32 v100, v100, v101
  v_mov_b32 v101, v100
  s_nop 1
  v_permlane16_swap_b32 v100, v101
  s_nop 1
  v_max_f32 v100, v100, v101
  v_sub_f32 v16, v16, v100
  v_sub_f32 v17, v17, v100
  v_sub_f32 v18, v18, v100
  v_sub_f32 v19, v19, v100
  v_exp_f32 v16, v16
  v_exp_f32 v17, v17
  v_exp_f32 v18, v18
  v_exp_f32 v19, v19
  v_sub_f32 v20, v20, v100
  v_sub_f32 v21, v21, v100
  v_sub_f32 v22, v22, v100
  v_sub_f32 v23, v23, v100
  v_exp_f32 v20, v20
  v_exp_f32 v21, v21
  v_exp_f32 v22, v22
  v_exp_f32 v23, v23
  v_sub_f32 v112, v112, v100
  v_sub_f32 v113, v113, v100
  v_sub_f32 v114, v114, v100
  v_sub_f32 v115, v115, v100
  v_exp_f32 v112, v112
  v_exp_f32 v113, v113
  v_exp_f32 v114, v114
  v_exp_f32 v115, v115
  s_nop 0
  v_cvt_pk_bf16_f32 v44, v16, v17
  v_cvt_pk_bf16_f32 v45, v18, v19
  v_cvt_pk_bf16_f32 v46, v20, v21
  v_cvt_pk_bf16_f32 v47, v22, v23
  v_cvt_pk_bf16_f32 v84, v112, v113
  v_cvt_pk_bf16_f32 v85, v114, v115
  v_cndmask_b32 v48, v84, 0, s[16:17]
  v_cndmask_b32 v49, v85, 0, s[16:17]
  v_cndmask_b32 v50, 0, v84, s[16:17]
  v_cndmask_b32 v51, 0, v85, s[16:17]
  s_nop 1
  v_mfma_f32_16x16x16_bf16 v[88:91], v[12:13], v[48:49], 0
  v_mfma_f32_16x16x16_bf16 v[24:27], v[120:121], v[48:49], 0
  v_mfma_f32_16x16x16_bf16 v[116:119], v[120:121], v[50:51], 0
  v_mfma_f32_16x16x32_bf16 v[88:91], v[12:15], v[44:47], v[88:91]
  v_mfma_f32_16x16x32_bf16 v[24:27], v[28:31], v[44:47], v[24:27]
  v_mfma_f32_16x16x32_bf16 v[116:119], v[32:35], v[44:47], v[116:119]
  s_nop 7
  s_nop 1
  v_rcp_f32 v89, v88
  s_nop 0
  v_mul_f32 v24, v89, v24
  v_mul_f32 v25, v89, v25
  s_branch T_back_93
T_w_82:
  s_mov_b32 s19, 0
  v_mov_b64 v[16:17], 0
  v_mov_b64 v[18:19], 0
  v_mov_b64 v[20:21], 0
  v_mov_b64 v[22:23], 0
  v_mov_b64 v[24:25], 0
  v_mov_b64 v[26:27], 0
  buffer_load_dwordx4 v[124:127], v3, s[4:7], s24 offen offset:1024 sc1
  buffer_load_dwordx4 v[116:119], v3, s[4:7], s25 offen offset:1024 sc1
  buffer_load_dwordx4 v[124:127], v3, s[4:7], s24 offen offset:1024 sc1
  buffer_load_dwordx4 v[116:119], v3, s[4:7], s25 offen offset:1024 sc1
  s_branch T_loop_99
.p2align 6
T_retry_100:
  s_mov_b64 exec, vcc
  buffer_load_dwordx4 v[124:127], v3, s[4:7], s24 offen offset:1024 sc1
  buffer_load_dwordx4 v[116:119], v3, s[4:7], s25 offen offset:1024 sc1
  s_mov_b64 exec, -1
  s_add_u32 s19, s19, 1
  s_cmp_gt_u32 s19, 32768
  s_cbranch_scc1 M_exit
T_loop_99:
  s_waitcnt vmcnt(3) lgkmcnt(0)
  v_max3_u32 v123, v124, v125, v126
  v_max_u32 v123, v123, v127
  v_mov_b32_dpp v120, v124 row_ror:8 row_mask:0xf bank_mask:0xf
  v_mov_b32_dpp v121, v125 row_ror:8 row_mask:0xf bank_mask:0xf
  s_waitcnt vmcnt(2)
  v_max3_u32 v123, v123, v116, v117
  v_max3_u32 v123, v123, v118, v119
  v_cmp_eq_u32 vcc, -1, v123
  s_cbranch_vccnz T_retry_100
  v_smfmac_f32_16x16x64_bf16 v[16:19], v[124:127], v[68:75], v0
  s_add_u32 s14, s14, 1
  ds_write_b128 v2, v[124:127] offset:1024
  v_mov_b32_dpp v122, v126 row_ror:8 row_mask:0xf bank_mask:0xf
  v_smfmac_f32_16x16x64_bf16 v[20:23], v[124:127], v[76:83], v0
  s_and_b32 s57, s14, 1
  v_mov_b32_dpp v123, v127 row_ror:8 row_mask:0xf bank_mask:0xf
  v_smfmac_f32_16x16x64_bf16 v[24:27], v[124:127], v[84:91], v0
  s_and_b32 s36, s14, 3
  ds_write_b128 v2, v[116:119] offset:5120
  v_smfmac_f32_16x16x64_bf16 v[16:19], v[120:123], v[92:99], v0
  s_lshl_b32 s36, s36, 13
  v_mov_b32_dpp v84, v116 row_ror:8 row_mask:0xf bank_mask:0xf
  v_smfmac_f32_16x16x64_bf16 v[20:23], v[120:123], v[100:107], v0
  s_add_u32 s26, s36, s23
  ds_read_b128 v[68:71], v4 offset:12288
  v_mov_b32_dpp v85, v117 row_ror:8 row_mask:0xf bank_mask:0xf
  v_smfmac_f32_16x16x64_bf16 v[24:27], v[120:123], v[108:115], v0
  s_add_u32 s36, s36, 8192
  ds_read_b128 v[72:75], v4 offset:13312
  v_mov_b32_dpp v86, v118 row_ror:8 row_mask:0xf bank_mask:0xf
  v_smfmac_f32_16x16x64_bf16 v[16:19], v[116:119], v[224:231], v0
  s_and_b32 s36, s36, 0x7fff
  ds_read_b128 v[76:79], v4 offset:14336
  v_mov_b32_dpp v87, v119 row_ror:8 row_mask:0xf bank_mask:0xf
  v_smfmac_f32_16x16x64_bf16 v[20:23], v[116:119], v[240:247], v0
  s_waitcnt lgkmcnt(3)
  s_barrier
  ds_read_b128 v[100:103], v2 offset:0
  v_smfmac_f32_16x16x64_bf16 v[24:27], v[116:119], a[0:7], v0
  s_mov_b32 m0, s31
  ds_read_b128 v[120:123], v1 offset:0
  v_smfmac_f32_16x16x64_bf16 v[16:19], v[84:87], v[232:239], v0
  s_cmp_ge_i32 s14, s30
  s_cbranch_scc1 T_kvw_103
T_kvb_104:
  v_smfmac_f32_16x16x64_bf16 v[20:23], v[84:87], v[248:255], v0
  ds_read_b128 v[80:83], v4 offset:15360
  v_smfmac_f32_16x16x64_bf16 v[24:27], v[84:87], a[8:15], v0
  s_waitcnt lgkmcnt(2)
  buffer_load_dwordx4 v9, s[4:7], s27 offen sc1 lds
  v_smfmac_f32_16x16x64_bf16 v[16:19], v[100:103], v[128:135], v0
  ds_read_b128 v[92:95], v2 offset:3072
  s_mov_b32 m0, s32
  v_smfmac_f32_16x16x64_bf16 v[20:23], v[100:103], v[144:151], v0
  ds_read_b128 v[96:99], v1 offset:3072
  v_smfmac_f32_16x16x64_bf16 v[24:27], v[100:103], v[68:75], v0
  s_waitcnt vmcnt(1) lgkmcnt(3)
  ds_read_b128 v[116:119], v2 offset:2048
  v_smfmac_f32_16x16x64_bf16 v[16:19], v[120:123], v[136:143], v0
  ds_read_b128 v[124:127], v1 offset:2048
  buffer_load_dwordx4 v9, s[4:7], s27 offen offset:128 sc1 lds
  v_smfmac_f32_16x16x64_bf16 v[20:23], v[120:123], v[152:159], v0
  s_waitcnt lgkmcnt(4)
  ds_read_b128 v[104:107], v2 offset:4096
  s_mov_b32 m0, s33
  v_smfmac_f32_16x16x64_bf16 v[24:27], v[120:123], v[76:83], v0
  s_waitcnt lgkmcnt(4)
  ds_read_b128 v[108:111], v1 offset:4096
  v_smfmac_f32_16x16x64_bf16 v[16:19], v[92:95], v[160:167], v0
  s_waitcnt lgkmcnt(4)
  ds_read_b128 v[112:115], v2 offset:7168
  v_smfmac_f32_16x16x64_bf16 v[16:19], v[96:99], v[168:175], v0
  s_waitcnt lgkmcnt(4)
  ds_read_b128 v[84:87], v1 offset:7168
  buffer_load_dwordx4 v10, s[4:7], s28 offen sc1 lds
  v_smfmac_f32_16x16x64_bf16 v[16:19], v[116:119], v[192:199], v0
  s_waitcnt lgkmcnt(4)
  ds_read_b128 v[88:91], v2 offset:6144
  s_mov_b32 m0, s34
  v_smfmac_f32_16x16x64_bf16 v[16:19], v[124:127], v[200:207], v0
  s_waitcnt lgkmcnt(4)
  ds_read_b128 v[100:103], v1 offset:6144
  v_smfmac_f32_16x16x64_bf16 v[16:19], v[104:107], a[16:23], v0
  s_waitcnt lgkmcnt(4)
  ds_read_b128 v[68:71], v4 offset:16384
  v_smfmac_f32_16x16x64_bf16 v[16:19], v[108:111], a[24:31], v0
  s_waitcnt lgkmcnt(4)
  ds_read_b128 v[72:75], v4 offset:17408
  buffer_load_dwordx4 v10, s[4:7], s28 offen offset:256 sc1 lds
  v_smfmac_f32_16x16x64_bf16 v[16:19], v[112:115], a[64:71], v0
  s_waitcnt lgkmcnt(4)
  ds_read_b128 v[76:79], v4 offset:18432
  v_smfmac_f32_16x16x64_bf16 v[16:19], v[84:87], a[72:79], v0
  s_waitcnt lgkmcnt(4)
  ds_read_b128 v[80:83], v4 offset:19456
  v_smfmac_f32_16x16x64_bf16 v[16:19], v[88:91], a[112:119], v0
  s_waitcnt lgkmcnt(4)
  v_smfmac_f32_16x16x64_bf16 v[16:19], v[100:103], a[120:127], v0
  s_add_u32 s24, s36, 145752064
  s_add_u32 s25, s36, 145756160
  v_smfmac_f32_16x16x64_bf16 v[20:23], v[92:95], v[176:183], v0
  s_add_u32 s35, s36, s23
  v_smfmac_f32_16x16x64_bf16 v[20:23], v[96:99], v[184:191], v0
  s_waitcnt lgkmcnt(2)
  v_smfmac_f32_16x16x64_bf16 v[20:23], v[116:119], v[68:75], v0
  s_waitcnt lgkmcnt(0)
  ds_read_b128 v[68:71], v4 offset:20480
  v_mul_f32 v16, s18, v16
  v_smfmac_f32_16x16x64_bf16 v[20:23], v[124:127], v[76:83], v0
  ds_read_b128 v[72:75], v4 offset:21504
  v_mul_f32 v17, s18, v17
  v_smfmac_f32_16x16x64_bf16 v[20:23], v[104:107], a[32:39], v0
  ds_read_b128 v[76:79], v4 offset:22528
  v_mul_f32 v18, s18, v18
  v_smfmac_f32_16x16x64_bf16 v[20:23], v[108:111], a[40:47], v0
  ds_read_b128 v[80:83], v4 offset:23552
  v_mul_f32 v19, s18, v19
  v_smfmac_f32_16x16x64_bf16 v[20:23], v[112:115], a[80:87], v0
  v_cvt_pk_bf16_f32 v120, v16, v17
  v_smfmac_f32_16x16x64_bf16 v[20:23], v[84:87], a[88:95], v0
  v_cvt_pk_bf16_f32 v121, v18, v19
  v_smfmac_f32_16x16x64_bf16 v[20:23], v[88:91], a[128:135], v0
  ds_write_b64 v5, v[120:121] offset:24576
  v_smfmac_f32_16x16x64_bf16 v[20:23], v[100:103], a[136:143], v0
  s_waitcnt lgkmcnt(3)
  v_smfmac_f32_16x16x64_bf16 v[24:27], v[92:95], v[68:75], v0
  s_waitcnt lgkmcnt(1)
  v_mov_b64 v[92:93], 0
  v_smfmac_f32_16x16x64_bf16 v[24:27], v[96:99], v[76:83], v0
  s_nop 1
  v_cvt_pk_bf16_f32 v122, v20, v21
  v_cvt_pk_bf16_f32 v123, v22, v23
  v_smfmac_f32_16x16x64_bf16 v[24:27], v[116:119], v[208:215], v0
  ds_write_b64 v5, v[122:123] offset:26880
  v_mov_b64 v[94:95], 0
  v_smfmac_f32_16x16x64_bf16 v[24:27], v[124:127], v[216:223], v0
  s_waitcnt lgkmcnt(1)
  s_barrier
  ds_read_b64_tr_b16 v[68:69], v6 offset:24576
  v_smfmac_f32_16x16x64_bf16 v[24:27], v[104:107], a[48:55], v0
  s_add_u32 s27, s27, 8192
  ds_read_b64_tr_b16 v[70:71], v6 offset:24640
  ds_read_b64_tr_b16 v[72:73], v6 offset:24832
  v_smfmac_f32_16x16x64_bf16 v[24:27], v[108:111], a[56:63], v0
  s_add_u32 s28, s28, 8192
  ds_read_b64_tr_b16 v[74:75], v6 offset:24896
  ds_read_b64_tr_b16 v[76:77], v6 offset:25088
  v_smfmac_f32_16x16x64_bf16 v[24:27], v[112:115], a[96:103], v0
  s_nop 0
  ds_read_b64_tr_b16 v[78:79], v6 offset:25152
  ds_read_b64_tr_b16 v[80:81], v6 offset:25344
  v_smfmac_f32_16x16x64_bf16 v[24:27], v[84:87], a[104:111], v0
  ds_read_b64_tr_b16 v[82:83], v6 offset:25408
  v_mov_b64 v[96:97], 0
  v_smfmac_f32_16x16x64_bf16 v[24:27], v[88:91], a[144:151], v0
  s_waitcnt lgkmcnt(8)
  s_barrier
  ds_read_b64_tr_b16 v[116:117], v6 offset:26880
  v_smfmac_f32_16x16x64_bf16 v[24:27], v[100:103], a[152:159], v0
  s_waitcnt lgkmcnt(7)
  ds_read_b64_tr_b16 v[118:119], v6 offset:26944
  v_mfma_f32_16x16x32_bf16 v[16:19], v[36:39], v[68:71], 0
  s_waitcnt lgkmcnt(6)
  ds_read_b64_tr_b16 v[124:125], v6 offset:27136
  ds_read_b64_tr_b16 v[126:127], v6 offset:27200
  v_mfma_f32_16x16x32_bf16 v[16:19], v[40:43], v[72:75], v[16:19]
  s_waitcnt lgkmcnt(6)
  ds_read_b64_tr_b16 v[104:105], v6 offset:27392
  ds_read_b64_tr_b16 v[106:107], v6 offset:27456
  v_mfma_f32_16x16x32_bf16 v[16:19], v[44:47], v[76:79], v[16:19]
  s_waitcnt lgkmcnt(6)
  ds_read_b64_tr_b16 v[108:109], v6 offset:27648
  ds_read_b64_tr_b16 v[110:111], v6 offset:27712
  v_mfma_f32_16x16x32_bf16 v[16:19], v[48:51], v[80:83], v[16:19]
  s_waitcnt lgkmcnt(6)
  v_cvt_pk_bf16_f32 v120, v24, v25
  v_cvt_pk_bf16_f32 v121, v26, v27
  v_mfma_f32_16x16x32_bf16 v[112:115], v[116:119], v[68:71], 0
  s_waitcnt lgkmcnt(4)
  buffer_store_dwordx4 v[120:123], v2, s[4:7], s29 offen offset:1024 sc1
  v_mov_b64 v[98:99], 0
  v_mfma_f32_16x16x32_bf16 v[112:115], v[124:127], v[72:75], v[112:115]
  s_waitcnt lgkmcnt(2)
  v_mov_b64 v[36:37], 0
  v_exp_f32 v100, v16
  v_mfma_f32_16x16x32_bf16 v[112:115], v[104:107], v[76:79], v[112:115]
  s_waitcnt lgkmcnt(0)
  v_exp_f32 v101, v17
  v_mfma_f32_16x16x32_bf16 v[112:115], v[108:111], v[80:83], v[112:115]
  s_add_u32 s29, s29, 131072
  v_exp_f32 v102, v18
  v_mfma_f32_16x16x32_bf16 v[20:23], v[52:55], v[68:71], 0
  s_cmp_eq_u32 s14, 63
  v_exp_f32 v103, v19
  v_mfma_f32_16x16x32_bf16 v[20:23], v[56:59], v[72:75], v[20:23]
  s_cbranch_scc1 M_tdone
  v_cvt_pk_bf16_f32 v44, v100, v101
  v_cvt_pk_bf16_f32 v45, v102, v103
  v_mfma_f32_16x16x32_bf16 v[20:23], v[60:63], v[76:79], v[20:23]
  v_exp_f32 v100, v112
  v_mfma_f32_16x16x32_bf16 v[20:23], v[64:67], v[80:83], v[20:23]
  v_exp_f32 v101, v113
  v_exp_f32 v102, v114
  v_exp_f32 v103, v115
  v_cvt_pk_bf16_f32 v84, v100, v101
  v_cvt_pk_bf16_f32 v85, v102, v103
  v_cndmask_b32 v48, v84, 0, s[16:17]
  v_cndmask_b32 v49, v85, 0, s[16:17]
  v_cndmask_b32 v50, 0, v84, s[16:17]
  v_cndmask_b32 v51, 0, v85, s[16:17]
  v_exp_f32 v100, v20
  v_mfma_f32_16x16x16_bf16 v[88:91], v[12:13], v[48:49], 0
  v_exp_f32 v101, v21
  v_mfma_f32_16x16x16_bf16 v[24:27], v[120:121], v[48:49], 0
  v_exp_f32 v102, v22
  v_mfma_f32_16x16x16_bf16 v[116:119], v[120:121], v[50:51], 0
  v_exp_f32 v103, v23
  v_cvt_pk_bf16_f32 v46, v100, v101
  v_cvt_pk_bf16_f32 v47, v102, v103
  v_mov_b64 v[38:39], 0
  s_nop 0
  v_mfma_f32_16x16x32_bf16 v[88:91], v[12:15], v[44:47], v[88:91]
  v_mov_b64 v[40:41], 0
  v_mov_b64 v[42:43], 0
  v_mfma_f32_16x16x32_bf16 v[24:27], v[28:31], v[44:47], v[24:27]
  ds_read_b128 v[52:55], v4 offset:24576
  ds_read_b128 v[56:59], v4 offset:25600
  v_mfma_f32_16x16x32_bf16 v[116:119], v[32:35], v[44:47], v[116:119]
  s_nop 1
  v_rcp_f32 v89, v88
  v_subrev_u32 v100, s54, v88
  v_cmp_le_u32 vcc, s55, v100
  v_mul_f32 v24, v89, v24
  v_mul_f32 v25, v89, v25
  s_cbranch_vccnz T_slow_106
T_back_107:
  v_cvt_pk_bf16_f32 v124, v24, v25
  v_pk_mul_f32 v[26:27], v[26:27], v[88:89] op_sel:[0,1] op_sel_hi:[1,1]
  v_pk_mul_f32 v[116:117], v[116:117], v[88:89] op_sel:[0,1] op_sel_hi:[1,1]
  v_pk_mul_f32 v[118:119], v[118:119], v[88:89] op_sel:[0,1] op_sel_hi:[1,1]
  v_cvt_pk_bf16_f32 v125, v26, v27
  v_cvt_pk_bf16_f32 v126, v116, v117
  v_cvt_pk_bf16_f32 v127, v118, v119
  ds_write_b128 v11, v[124:127] offset:29696
  s_nop 0
  v_smfmac_f32_16x16x64_bf16 v[92:95], v[124:127], a[160:167], v0
  v_smfmac_f32_16x16x64_bf16 v[96:99], v[124:127], a[168:175], v0
  v_smfmac_f32_16x16x64_bf16 v[36:39], v[124:127], a[176:183], v0
  v_smfmac_f32_16x16x64_bf16 v[40:43], v[124:127], a[184:191], v0
  s_waitcnt lgkmcnt(0)
  s_barrier
  ds_read_b128 v[104:107], v11 offset:29184
  ds_read_b128 v[108:111], v11 offset:30720
  ds_read_b128 v[68:71], v11 offset:30208
  s_waitcnt lgkmcnt(2)
  v_smfmac_f32_16x16x64_bf16 v[92:95], v[104:107], a[192:199], v0
  s_waitcnt lgkmcnt(1)
  ds_read_b128 v[76:79], v4 offset:28672
  v_smfmac_f32_16x16x64_bf16 v[92:95], v[108:111], a[224:231], v0
  s_waitcnt lgkmcnt(1)
  ds_read_b128 v[80:83], v4 offset:29696
  v_smfmac_f32_16x16x64_bf16 v[92:95], v[68:71], a[240:247], v0
  ds_read_b128 v[60:63], v4 offset:26624
  v_smfmac_f32_16x16x64_bf16 v[96:99], v[104:107], a[200:207], v0
  ds_read_b128 v[64:67], v4 offset:27648
  v_smfmac_f32_16x16x64_bf16 v[96:99], v[108:111], a[232:239], v0
  ds_read_b128 v[28:31], v4 offset:30720
  s_nop 0
  v_cvt_pk_bf16_f32 v16, v92, v93
  v_cvt_pk_bf16_f32 v17, v94, v95
  v_bfi_b32 v16, 1, s57, v16
  v_smfmac_f32_16x16x64_bf16 v[96:99], v[68:71], a[248:255], v0
  buffer_store_dwordx2 v[16:17], v7, s[4:7], s20 offen offset:0
  v_smfmac_f32_16x16x64_bf16 v[36:39], v[104:107], a[208:215], v0
  ds_read_b128 v[32:35], v4 offset:31744
  v_smfmac_f32_16x16x64_bf16 v[36:39], v[108:111], v[52:59], v0
  s_waitcnt lgkmcnt(4)
  s_nop 0
  v_cvt_pk_bf16_f32 v18, v96, v97
  v_cvt_pk_bf16_f32 v19, v98, v99
  v_bfi_b32 v18, 1, s57, v18
  v_smfmac_f32_16x16x64_bf16 v[36:39], v[68:71], v[76:83], v0
  buffer_store_dwordx2 v[18:19], v7, s[4:7], s20 offen offset:64
  v_smfmac_f32_16x16x64_bf16 v[40:43], v[104:107], a[216:223], v0
  s_waitcnt lgkmcnt(2)
  ds_read_b128 v[116:119], v2 offset:31232
  v_smfmac_f32_16x16x64_bf16 v[40:43], v[108:111], v[60:67], v0
  s_waitcnt lgkmcnt(1)
  s_nop 0
  v_cvt_pk_bf16_f32 v20, v36, v37
  v_cvt_pk_bf16_f32 v21, v38, v39
  v_bfi_b32 v20, 1, s57, v20
  v_smfmac_f32_16x16x64_bf16 v[40:43], v[68:71], v[28:35], v0
  buffer_store_dwordx2 v[20:21], v7, s[4:7], s21 offen offset:0
  s_nop 6
  v_cvt_pk_bf16_f32 v22, v40, v41
  v_cvt_pk_bf16_f32 v23, v42, v43
  v_bfi_b32 v22, 1, s57, v22
  buffer_store_dwordx2 v[22:23], v7, s[4:7], s21 offen offset:64
  ds_read_b128 v[68:71], v4 offset:0
  ds_read_b128 v[72:75], v4 offset:1024
  ds_read_b128 v[76:79], v4 offset:4096
  ds_read_b128 v[80:83], v4 offset:5120
  ds_read_b128 v[84:87], v4 offset:8192
  ds_read_b128 v[88:91], v4 offset:9216
  ds_read_b128 v[92:95], v4 offset:2048
  ds_read_b128 v[96:99], v4 offset:3072
  ds_read_b128 v[100:103], v4 offset:6144
  ds_read_b128 v[104:107], v4 offset:7168
  ds_read_b128 v[108:111], v4 offset:10240
  ds_read_b128 v[112:115], v4 offset:11264
  v_mov_b64 v[16:17], 0
  v_mov_b64 v[18:19], 0
  v_mov_b64 v[20:21], 0
  v_mov_b64 v[22:23], 0
  v_mov_b64 v[24:25], 0
  v_mov_b64 v[26:27], 0
  s_mov_b32 s19, 0
  v_mov_b32 v49, -1
  ds_read_b64 v[44:45], v2 offset:32256
  s_waitcnt lgkmcnt(0)
  v_readfirstlane_b32 s38, v44
  v_readfirstlane_b32 s37, v45
  s_nop 0
  s_add_u32 s37, s37, 30
  s_cmp_ge_u32 s38, 30
  s_cselect_b32 s38, s37, s38
  s_cmp_ge_u32 s38, 64
  s_cselect_b32 s38, 100, s38
  s_sub_u32 s38, s38, 1
  s_max_i32 s30, s30, s38
  s_waitcnt vmcnt(0)
  buffer_load_dwordx4 v[52:55], v2, s[4:7], s22 offen offset:0 sc1
  buffer_load_dwordx4 v[56:59], v2, s[4:7], s22 offen offset:1024 sc1
  buffer_load_dwordx4 v[60:63], v2, s[4:7], s22 offen offset:2048 sc1
  buffer_load_dwordx4 v[64:67], v2, s[4:7], s22 offen offset:3072 sc1
  s_waitcnt lgkmcnt(12)
  s_waitcnt vmcnt(3)
  v_mfma_f32_16x16x32_bf16 v[120:123], v[116:119], v[52:55], 0
  v_xor_b32 v48, s57, v52
  v_bitop3_b32 v48, v48, v54, s57 bitop3:0xf6
  s_waitcnt vmcnt(2)
  v_mfma_f32_16x16x32_bf16 v[120:123], v[116:119], v[56:59], v[120:123]
  v_bitop3_b32 v48, v48, v56, s57 bitop3:0xf6
  v_bitop3_b32 v48, v48, v58, s57 bitop3:0xf6
  s_waitcnt vmcnt(1)
  v_mfma_f32_16x16x32_bf16 v[120:123], v[116:119], v[60:63], v[120:123]
  v_bitop3_b32 v48, v48, v60, s57 bitop3:0xf6
  v_bitop3_b32 v48, v48, v62, s57 bitop3:0xf6
  s_waitcnt vmcnt(0)
  v_mfma_f32_16x16x32_bf16 v[120:123], v[116:119], v[64:67], v[120:123]
  v_bitop3_b32 v48, v48, v64, s57 bitop3:0xf6
  v_bitop3_b32 v48, v48, v66, s57 bitop3:0xf6
  v_and_b32 v48, 1, v48
  v_cmp_ne_u32 vcc, 0, v48
  s_cbranch_vccnz T_p1re_109
T_p1ok_110:
  s_nop 2
  v_add_f32_dpp v120, v120, v120 row_ror:8 row_mask:0xf bank_mask:0xf
  v_add_f32_dpp v121, v121, v121 row_ror:8 row_mask:0xf bank_mask:0xf
  v_cvt_pk_bf16_f32 v48, v120, v121
  v_min_u32 v48, -2, v48
  buffer_store_dword v48, v8, s[4:7], s35 offen
  buffer_store_dword v49, v8, s[4:7], s26 offen
  s_barrier
  ds_read_b128 v[28:31], v2 offset:17408
  ds_read_b128 v[32:35], v2 offset:21504
  ds_read_b128 v[36:39], v2 offset:8192
  ds_read_b128 v[40:43], v2 offset:9216
  ds_read_b128 v[44:47], v2 offset:10240
  ds_read_b128 v[48:51], v2 offset:11264
  buffer_load_dwordx4 v[124:127], v3, s[4:7], s24 offen offset:1024 sc1
  buffer_load_dwordx4 v[116:119], v3, s[4:7], s25 offen offset:1024 sc1
  ds_read_b128 v[52:55], v2 offset:12288
  ds_read_b128 v[56:59], v2 offset:13312
  ds_read_b128 v[60:63], v2 offset:14336
  ds_read_b128 v[64:67], v2 offset:15360
  buffer_load_dwordx4 v[124:127], v3, s[4:7], s24 offen offset:1024 sc1
  buffer_load_dwordx4 v[116:119], v3, s[4:7], s25 offen offset:1024 sc1
  s_mov_b32 s19, 0
  s_branch T_loop_99
T_p1re_109:
  s_mov_b64 exec, vcc
  buffer_load_dwordx4 v[52:55], v2, s[4:7], s22 offen offset:0 sc1
  buffer_load_dwordx4 v[56:59], v2, s[4:7], s22 offen offset:1024 sc1
  buffer_load_dwordx4 v[60:63], v2, s[4:7], s22 offen offset:2048 sc1
  buffer_load_dwordx4 v[64:67], v2, s[4:7], s22 offen offset:3072 sc1
  s_mov_b64 exec, -1
  s_add_u32 s19, s19, 1
  s_cmp_gt_u32 s19, 32768
  s_cbranch_scc1 M_exit
  s_waitcnt vmcnt(3)
  v_mfma_f32_16x16x32_bf16 v[120:123], v[116:119], v[52:55], 0
  v_xor_b32 v48, s57, v52
  v_bitop3_b32 v48, v48, v54, s57 bitop3:0xf6
  s_waitcnt vmcnt(2)
  v_mfma_f32_16x16x32_bf16 v[120:123], v[116:119], v[56:59], v[120:123]
  v_bitop3_b32 v48, v48, v56, s57 bitop3:0xf6
  v_bitop3_b32 v48, v48, v58, s57 bitop3:0xf6
  s_waitcnt vmcnt(1)
  v_mfma_f32_16x16x32_bf16 v[120:123], v[116:119], v[60:63], v[120:123]
  v_bitop3_b32 v48, v48, v60, s57 bitop3:0xf6
  v_bitop3_b32 v48, v48, v62, s57 bitop3:0xf6
  s_waitcnt vmcnt(0)
  v_mfma_f32_16x16x32_bf16 v[120:123], v[116:119], v[64:67], v[120:123]
  v_bitop3_b32 v48, v48, v64, s57 bitop3:0xf6
  v_bitop3_b32 v48, v48, v66, s57 bitop3:0xf6
  v_and_b32 v48, 1, v48
  v_cmp_ne_u32 vcc, 0, v48
  s_cbranch_vccnz T_p1re_109
  s_branch T_p1ok_110
T_kvw_103:
  s_mov_b32 s19, 0
  s_branch T_kvok_112
T_kv_111:
  s_sleep 4
  s_add_u32 s19, s19, 1
  s_cmp_gt_u32 s19, 32768
  s_cbranch_scc1 M_exit
T_kvok_112:
  s_add_u32 s39, s99, 128
  s_mov_b32 s38, 0
  s_mov_b32 s37, 0
  s_atomic_or s38, s[58:59], s99 glc
  s_atomic_or s37, s[58:59], s39 glc
  s_waitcnt lgkmcnt(0)
  s_add_u32 s37, s37, 30
  s_cmp_ge_u32 s38, 30
  s_cselect_b32 s38, s37, s38
  s_cmp_ge_u32 s38, 64
  s_cselect_b32 s38, 100, s38
  s_sub_u32 s38, s38, 1
  s_max_i32 s30, s30, s38
  s_cmp_ge_i32 s14, s30
  s_cbranch_scc1 T_kv_111
  s_branch T_kvb_104
T_slow_106:
  s_nop 7
  v_max3_f32 v100, v16, v17, v18
  v_max3_f32 v100, v100, v19, v20
  v_max3_f32 v100, v100, v21, v22
  v_max3_f32 v100, v100, v23, v112
  v_max3_f32 v100, v100, v113, v114
  v_max_f32 v100, v100, v115
  v_mov_b32 v101, v100
  s_nop 1
  v_permlane32_swap_b32 v100, v101
  s_nop 1
  v_max_f32 v100, v100, v101
  v_mov_b32 v101, v100
  s_nop 1
  v_permlane16_swap_b32 v100, v101
  s_nop 1
  v_max_f32 v100, v100, v101
  v_sub_f32 v16, v16, v100
  v_sub_f32 v17, v17, v100
  v_sub_f32 v18, v18, v100
  v_sub_f32 v19, v19, v100
  v_exp_f32 v16, v16
  v_exp_f32 v17, v17
  v_exp_f32 v18, v18
  v_exp_f32 v19, v19
  v_sub_f32 v20, v20, v100
  v_sub_f32 v21, v21, v100
  v_sub_f32 v22, v22, v100
  v_sub_f32 v23, v23, v100
  v_exp_f32 v20, v20
  v_exp_f32 v21, v21
  v_exp_f32 v22, v22
  v_exp_f32 v23, v23
  v_sub_f32 v112, v112, v100
  v_sub_f32 v113, v113, v100
  v_sub_f32 v114, v114, v100
  v_sub_f32 v115, v115, v100
  v_exp_f32 v112, v112
  v_exp_f32 v113, v113
  v_exp_f32 v114, v114
  v_exp_f32 v115, v115
  s_nop 0
  v_cvt_pk_bf16_f32 v44, v16, v17
  v_cvt_pk_bf16_f32 v45, v18, v19
  v_cvt_pk_bf16_f32 v46, v20, v21
  v_cvt_pk_bf16_f32 v47, v22, v23
  v_cvt_pk_bf16_f32 v84, v112, v113
  v_cvt_pk_bf16_f32 v85, v114, v115
  v_cndmask_b32 v48, v84, 0, s[16:17]
  v_cndmask_b32 v49, v85, 0, s[16:17]
  v_cndmask_b32 v50, 0, v84, s[16:17]
  v_cndmask_b32 v51, 0, v85, s[16:17]
  s_nop 1
  v_mfma_f32_16x16x16_bf16 v[88:91], v[12:13], v[48:49], 0
  v_mfma_f32_16x16x16_bf16 v[24:27], v[120:121], v[48:49], 0
  v_mfma_f32_16x16x16_bf16 v[116:119], v[120:121], v[50:51], 0
  v_mfma_f32_16x16x32_bf16 v[88:91], v[12:15], v[44:47], v[88:91]
  v_mfma_f32_16x16x32_bf16 v[24:27], v[28:31], v[44:47], v[24:27]
  v_mfma_f32_16x16x32_bf16 v[116:119], v[32:35], v[44:47], v[116:119]
  s_nop 7
  s_nop 1
  v_rcp_f32 v89, v88
  s_nop 0
  v_mul_f32 v24, v89, v24
  v_mul_f32 v25, v89, v25
  s_branch T_back_107
T_w_83:
  s_mov_b32 s19, 0
  v_mov_b64 v[16:17], 0
  v_mov_b64 v[18:19], 0
  v_mov_b64 v[20:21], 0
  v_mov_b64 v[22:23], 0
  v_mov_b64 v[24:25], 0
  v_mov_b64 v[26:27], 0
  buffer_load_dwordx4 v[124:127], v3, s[4:7], s24 offen offset:2048 sc1
  buffer_load_dwordx4 v[116:119], v3, s[4:7], s25 offen offset:2048 sc1
  buffer_load_dwordx4 v[124:127], v3, s[4:7], s24 offen offset:2048 sc1
  buffer_load_dwordx4 v[116:119], v3, s[4:7], s25 offen offset:2048 sc1
  s_branch T_loop_113
.p2align 6
T_retry_114:
  s_mov_b64 exec, vcc
  buffer_load_dwordx4 v[124:127], v3, s[4:7], s24 offen offset:2048 sc1
  buffer_load_dwordx4 v[116:119], v3, s[4:7], s25 offen offset:2048 sc1
  s_mov_b64 exec, -1
  s_add_u32 s19, s19, 1
  s_cmp_gt_u32 s19, 32768
  s_cbranch_scc1 M_exit
T_loop_113:
  s_waitcnt vmcnt(3) lgkmcnt(0)
  v_max3_u32 v123, v124, v125, v126
  v_max_u32 v123, v123, v127
  v_mov_b32_dpp v120, v124 row_ror:8 row_mask:0xf bank_mask:0xf
  v_mov_b32_dpp v121, v125 row_ror:8 row_mask:0xf bank_mask:0xf
  s_waitcnt vmcnt(2)
  v_max3_u32 v123, v123, v116, v117
  v_max3_u32 v123, v123, v118, v119
  v_cmp_eq_u32 vcc, -1, v123
  s_cbranch_vccnz T_retry_114
  v_smfmac_f32_16x16x64_bf16 v[16:19], v[124:127], v[68:75], v0
  s_add_u32 s14, s14, 1
  ds_write_b128 v2, v[124:127] offset:2048
  v_mov_b32_dpp v122, v126 row_ror:8 row_mask:0xf bank_mask:0xf
  v_smfmac_f32_16x16x64_bf16 v[20:23], v[124:127], v[76:83], v0
  s_and_b32 s57, s14, 1
  v_mov_b32_dpp v123, v127 row_ror:8 row_mask:0xf bank_mask:0xf
  v_smfmac_f32_16x16x64_bf16 v[24:27], v[124:127], v[84:91], v0
  s_and_b32 s36, s14, 3
  ds_write_b128 v2, v[116:119] offset:6144
  v_smfmac_f32_16x16x64_bf16 v[16:19], v[120:123], v[92:99], v0
  s_lshl_b32 s36, s36, 13
  v_mov_b32_dpp v84, v116 row_ror:8 row_mask:0xf bank_mask:0xf
  v_smfmac_f32_16x16x64_bf16 v[20:23], v[120:123], v[100:107], v0
  s_add_u32 s26, s36, s23
  ds_read_b128 v[68:71], v4 offset:12288
  v_mov_b32_dpp v85, v117 row_ror:8 row_mask:0xf bank_mask:0xf
  v_smfmac_f32_16x16x64_bf16 v[24:27], v[120:123], v[108:115], v0
  s_add_u32 s36, s36, 8192
  ds_read_b128 v[72:75], v4 offset:13312
  v_mov_b32_dpp v86, v118 row_ror:8 row_mask:0xf bank_mask:0xf
  v_smfmac_f32_16x16x64_bf16 v[16:19], v[116:119], v[224:231], v0
  s_and_b32 s36, s36, 0x7fff
  ds_read_b128 v[76:79], v4 offset:14336
  v_mov_b32_dpp v87, v119 row_ror:8 row_mask:0xf bank_mask:0xf
  v_smfmac_f32_16x16x64_bf16 v[20:23], v[116:119], v[240:247], v0
  s_waitcnt lgkmcnt(3)
  s_barrier
  ds_read_b128 v[100:103], v2 offset:3072
  v_smfmac_f32_16x16x64_bf16 v[24:27], v[116:119], a[0:7], v0
  s_mov_b32 m0, s31
  ds_read_b128 v[120:123], v1 offset:3072
  v_smfmac_f32_16x16x64_bf16 v[16:19], v[84:87], v[232:239], v0
  s_cmp_ge_i32 s14, s30
  s_cbranch_scc1 T_kvw_117
T_kvb_118:
  v_smfmac_f32_16x16x64_bf16 v[20:23], v[84:87], v[248:255], v0
  ds_read_b128 v[80:83], v4 offset:15360
  v_smfmac_f32_16x16x64_bf16 v[24:27], v[84:87], a[8:15], v0
  s_waitcnt lgkmcnt(2)
  v_smfmac_f32_16x16x64_bf16 v[16:19], v[100:103], v[128:135], v0
  ds_read_b128 v[92:95], v2 offset:0
  buffer_load_dwordx4 v9, s[4:7], s27 offen sc1 lds
  v_smfmac_f32_16x16x64_bf16 v[20:23], v[100:103], v[144:151], v0
  ds_read_b128 v[96:99], v1 offset:0
  s_mov_b32 m0, s32
  v_smfmac_f32_16x16x64_bf16 v[24:27], v[100:103], v[68:75], v0
  s_waitcnt vmcnt(1) lgkmcnt(3)
  ds_read_b128 v[116:119], v2 offset:1024
  v_smfmac_f32_16x16x64_bf16 v[16:19], v[120:123], v[136:143], v0
  ds_read_b128 v[124:127], v1 offset:1024
  v_smfmac_f32_16x16x64_bf16 v[20:23], v[120:123], v[152:159], v0
  s_waitcnt lgkmcnt(4)
  ds_read_b128 v[104:107], v2 offset:7168
  buffer_load_dwordx4 v9, s[4:7], s27 offen offset:128 sc1 lds
  v_smfmac_f32_16x16x64_bf16 v[24:27], v[120:123], v[76:83], v0
  s_waitcnt lgkmcnt(4)
  ds_read_b128 v[108:111], v1 offset:7168
  s_mov_b32 m0, s33
  v_smfmac_f32_16x16x64_bf16 v[16:19], v[92:95], v[160:167], v0
  s_waitcnt lgkmcnt(4)
  ds_read_b128 v[112:115], v2 offset:4096
  v_mov_b32 v122, s98
  v_smfmac_f32_16x16x64_bf16 v[16:19], v[96:99], v[168:175], v0
  s_waitcnt lgkmcnt(4)
  ds_read_b128 v[84:87], v1 offset:4096
  v_smfmac_f32_16x16x64_bf16 v[16:19], v[116:119], v[192:199], v0
  s_waitcnt lgkmcnt(4)
  ds_read_b128 v[88:91], v2 offset:5120
  buffer_load_dwordx4 v10, s[4:7], s28 offen sc1 lds
  v_smfmac_f32_16x16x64_bf16 v[16:19], v[124:127], v[200:207], v0
  s_waitcnt lgkmcnt(4)
  ds_read_b128 v[100:103], v1 offset:5120
  s_mov_b32 m0, s34
  v_smfmac_f32_16x16x64_bf16 v[16:19], v[104:107], a[16:23], v0
  s_waitcnt lgkmcnt(4)
  ds_read_b128 v[68:71], v4 offset:16384
  v_smfmac_f32_16x16x64_bf16 v[16:19], v[108:111], a[24:31], v0
  s_waitcnt lgkmcnt(4)
  ds_read_b128 v[72:75], v4 offset:17408
  v_smfmac_f32_16x16x64_bf16 v[16:19], v[112:115], a[64:71], v0
  s_waitcnt lgkmcnt(4)
  ds_read_b128 v[76:79], v4 offset:18432
  buffer_load_dwordx4 v10, s[4:7], s28 offen offset:256 sc1 lds
  v_smfmac_f32_16x16x64_bf16 v[16:19], v[84:87], a[72:79], v0
  s_waitcnt lgkmcnt(4)
  ds_read_b128 v[80:83], v4 offset:19456
  v_smfmac_f32_16x16x64_bf16 v[16:19], v[88:91], a[112:119], v0
  s_waitcnt lgkmcnt(4)
  v_smfmac_f32_16x16x64_bf16 v[16:19], v[100:103], a[120:127], v0
  s_add_u32 s24, s36, 145752064
  s_add_u32 s25, s36, 145756160
  v_smfmac_f32_16x16x64_bf16 v[20:23], v[92:95], v[176:183], v0
  buffer_store_dword v122, v8, s[4:7], s15 offen sc1
  s_add_u32 s35, s36, s23
  v_smfmac_f32_16x16x64_bf16 v[20:23], v[96:99], v[184:191], v0
  s_waitcnt lgkmcnt(2)
  s_add_u32 s98, s14, 1
  v_smfmac_f32_16x16x64_bf16 v[20:23], v[116:119], v[68:75], v0
  s_waitcnt lgkmcnt(0)
  ds_read_b128 v[68:71], v4 offset:20480
  v_mul_f32 v16, s18, v16
  v_smfmac_f32_16x16x64_bf16 v[20:23], v[124:127], v[76:83], v0
  ds_read_b128 v[72:75], v4 offset:21504
  v_mul_f32 v17, s18, v17
  v_smfmac_f32_16x16x64_bf16 v[20:23], v[104:107], a[32:39], v0
  ds_read_b128 v[76:79], v4 offset:22528
  v_mul_f32 v18, s18, v18
  v_smfmac_f32_16x16x64_bf16 v[20:23], v[108:111], a[40:47], v0
  ds_read_b128 v[80:83], v4 offset:23552
  v_mul_f32 v19, s18, v19
  v_smfmac_f32_16x16x64_bf16 v[20:23], v[112:115], a[80:87], v0
  v_cvt_pk_bf16_f32 v120, v16, v17
  v_smfmac_f32_16x16x64_bf16 v[20:23], v[84:87], a[88:95], v0
  v_cvt_pk_bf16_f32 v121, v18, v19
  v_smfmac_f32_16x16x64_bf16 v[20:23], v[88:91], a[128:135], v0
  ds_write_b64 v5, v[120:121] offset:24576
  v_smfmac_f32_16x16x64_bf16 v[20:23], v[100:103], a[136:143], v0
  s_waitcnt lgkmcnt(3)
  v_smfmac_f32_16x16x64_bf16 v[24:27], v[92:95], v[68:75], v0
  s_waitcnt lgkmcnt(1)
  v_mov_b64 v[92:93], 0
  v_smfmac_f32_16x16x64_bf16 v[24:27], v[96:99], v[76:83], v0
  s_nop 1
  v_cvt_pk_bf16_f32 v122, v20, v21
  v_cvt_pk_bf16_f32 v123, v22, v23
  v_smfmac_f32_16x16x64_bf16 v[24:27], v[116:119], v[208:215], v0
  ds_write_b64 v5, v[122:123] offset:26880
  v_mov_b64 v[94:95], 0
  v_smfmac_f32_16x16x64_bf16 v[24:27], v[124:127], v[216:223], v0
  s_waitcnt lgkmcnt(1)
  s_barrier
  ds_read_b64_tr_b16 v[68:69], v6 offset:24576
  v_smfmac_f32_16x16x64_bf16 v[24:27], v[104:107], a[48:55], v0
  s_add_u32 s27, s27, 8192
  ds_read_b64_tr_b16 v[70:71], v6 offset:24640
  ds_read_b64_tr_b16 v[72:73], v6 offset:24832
  v_smfmac_f32_16x16x64_bf16 v[24:27], v[108:111], a[56:63], v0
  s_add_u32 s28, s28, 8192
  ds_read_b64_tr_b16 v[74:75], v6 offset:24896
  ds_read_b64_tr_b16 v[76:77], v6 offset:25088
  v_smfmac_f32_16x16x64_bf16 v[24:27], v[112:115], a[96:103], v0
  s_nop 0
  ds_read_b64_tr_b16 v[78:79], v6 offset:25152
  ds_read_b64_tr_b16 v[80:81], v6 offset:25344
  v_smfmac_f32_16x16x64_bf16 v[24:27], v[84:87], a[104:111], v0
  ds_read_b64_tr_b16 v[82:83], v6 offset:25408
  v_mov_b64 v[96:97], 0
  v_smfmac_f32_16x16x64_bf16 v[24:27], v[88:91], a[144:151], v0
  s_waitcnt lgkmcnt(8)
  s_barrier
  ds_read_b64_tr_b16 v[116:117], v6 offset:26880
  v_smfmac_f32_16x16x64_bf16 v[24:27], v[100:103], a[152:159], v0
  s_waitcnt lgkmcnt(7)
  ds_read_b64_tr_b16 v[118:119], v6 offset:26944
  v_mfma_f32_16x16x32_bf16 v[16:19], v[36:39], v[68:71], 0
  s_waitcnt lgkmcnt(6)
  ds_read_b64_tr_b16 v[124:125], v6 offset:27136
  ds_read_b64_tr_b16 v[126:127], v6 offset:27200
  v_mfma_f32_16x16x32_bf16 v[16:19], v[40:43], v[72:75], v[16:19]
  s_waitcnt lgkmcnt(6)
  ds_read_b64_tr_b16 v[104:105], v6 offset:27392
  ds_read_b64_tr_b16 v[106:107], v6 offset:27456
  v_mfma_f32_16x16x32_bf16 v[16:19], v[44:47], v[76:79], v[16:19]
  s_waitcnt lgkmcnt(6)
  ds_read_b64_tr_b16 v[108:109], v6 offset:27648
  ds_read_b64_tr_b16 v[110:111], v6 offset:27712
  v_mfma_f32_16x16x32_bf16 v[16:19], v[48:51], v[80:83], v[16:19]
  s_waitcnt lgkmcnt(6)
  v_cvt_pk_bf16_f32 v120, v24, v25
  v_cvt_pk_bf16_f32 v121, v26, v27
  v_mfma_f32_16x16x32_bf16 v[112:115], v[116:119], v[68:71], 0
  s_waitcnt lgkmcnt(4)
  buffer_store_dwordx4 v[120:123], v2, s[4:7], s29 offen offset:2048 sc1
  v_mov_b64 v[98:99], 0
  v_mfma_f32_16x16x32_bf16 v[112:115], v[124:127], v[72:75], v[112:115]
  s_waitcnt lgkmcnt(2)
  v_mov_b64 v[36:37], 0
  v_exp_f32 v100, v16
  v_mfma_f32_16x16x32_bf16 v[112:115], v[104:107], v[76:79], v[112:115]
  s_waitcnt lgkmcnt(0)
  v_exp_f32 v101, v17
  v_mfma_f32_16x16x32_bf16 v[112:115], v[108:111], v[80:83], v[112:115]
  s_add_u32 s29, s29, 131072
  v_exp_f32 v102, v18
  v_mfma_f32_16x16x32_bf16 v[20:23], v[52:55], v[68:71], 0
  s_cmp_eq_u32 s14, 63
  v_exp_f32 v103, v19
  v_mfma_f32_16x16x32_bf16 v[20:23], v[56:59], v[72:75], v[20:23]
  s_cbranch_scc1 M_tdone
  v_cvt_pk_bf16_f32 v44, v100, v101
  v_cvt_pk_bf16_f32 v45, v102, v103
  v_mfma_f32_16x16x32_bf16 v[20:23], v[60:63], v[76:79], v[20:23]
  v_exp_f32 v100, v112
  v_mfma_f32_16x16x32_bf16 v[20:23], v[64:67], v[80:83], v[20:23]
  v_exp_f32 v101, v113
  v_exp_f32 v102, v114
  v_exp_f32 v103, v115
  v_cvt_pk_bf16_f32 v84, v100, v101
  v_cvt_pk_bf16_f32 v85, v102, v103
  v_cndmask_b32 v48, v84, 0, s[16:17]
  v_cndmask_b32 v49, v85, 0, s[16:17]
  v_cndmask_b32 v50, 0, v84, s[16:17]
  v_cndmask_b32 v51, 0, v85, s[16:17]
  v_exp_f32 v100, v20
  v_mfma_f32_16x16x16_bf16 v[88:91], v[12:13], v[48:49], 0
  v_exp_f32 v101, v21
  v_mfma_f32_16x16x16_bf16 v[24:27], v[120:121], v[48:49], 0
  v_exp_f32 v102, v22
  v_mfma_f32_16x16x16_bf16 v[116:119], v[120:121], v[50:51], 0
  v_exp_f32 v103, v23
  v_cvt_pk_bf16_f32 v46, v100, v101
  v_cvt_pk_bf16_f32 v47, v102, v103
  v_mov_b64 v[38:39], 0
  s_nop 0
  v_mfma_f32_16x16x32_bf16 v[88:91], v[12:15], v[44:47], v[88:91]
  v_mov_b64 v[40:41], 0
  v_mov_b64 v[42:43], 0
  v_mfma_f32_16x16x32_bf16 v[24:27], v[28:31], v[44:47], v[24:27]
  ds_read_b128 v[52:55], v4 offset:24576
  ds_read_b128 v[56:59], v4 offset:25600
  v_mfma_f32_16x16x32_bf16 v[116:119], v[32:35], v[44:47], v[116:119]
  s_nop 1
  v_rcp_f32 v89, v88
  v_subrev_u32 v100, s54, v88
  v_cmp_le_u32 vcc, s55, v100
  v_mul_f32 v24, v89, v24
  v_mul_f32 v25, v89, v25
  s_cbranch_vccnz T_slow_120
T_back_121:
  v_cvt_pk_bf16_f32 v124, v24, v25
  v_pk_mul_f32 v[26:27], v[26:27], v[88:89] op_sel:[0,1] op_sel_hi:[1,1]
  v_pk_mul_f32 v[116:117], v[116:117], v[88:89] op_sel:[0,1] op_sel_hi:[1,1]
  v_pk_mul_f32 v[118:119], v[118:119], v[88:89] op_sel:[0,1] op_sel_hi:[1,1]
  v_cvt_pk_bf16_f32 v125, v26, v27
  v_cvt_pk_bf16_f32 v126, v116, v117
  v_cvt_pk_bf16_f32 v127, v118, v119
  ds_write_b128 v11, v[124:127] offset:30208
  s_nop 0
  v_smfmac_f32_16x16x64_bf16 v[92:95], v[124:127], a[160:167], v0
  v_smfmac_f32_16x16x64_bf16 v[96:99], v[124:127], a[168:175], v0
  v_smfmac_f32_16x16x64_bf16 v[36:39], v[124:127], a[176:183], v0
  v_smfmac_f32_16x16x64_bf16 v[40:43], v[124:127], a[184:191], v0
  s_waitcnt lgkmcnt(0)
  s_barrier
  ds_read_b128 v[104:107], v11 offset:30720
  ds_read_b128 v[108:111], v11 offset:29184
  ds_read_b128 v[68:71], v11 offset:29696
  s_waitcnt lgkmcnt(2)
  v_smfmac_f32_16x16x64_bf16 v[92:95], v[104:107], a[192:199], v0
  s_waitcnt lgkmcnt(1)
  ds_read_b128 v[76:79], v4 offset:28672
  v_smfmac_f32_16x16x64_bf16 v[92:95], v[108:111], a[224:231], v0
  s_waitcnt lgkmcnt(1)
  ds_read_b128 v[80:83], v4 offset:29696
  v_smfmac_f32_16x16x64_bf16 v[92:95], v[68:71], a[240:247], v0
  ds_read_b128 v[60:63], v4 offset:26624
  v_smfmac_f32_16x16x64_bf16 v[96:99], v[104:107], a[200:207], v0
  ds_read_b128 v[64:67], v4 offset:27648
  v_smfmac_f32_16x16x64_bf16 v[96:99], v[108:111], a[232:239], v0
  ds_read_b128 v[28:31], v4 offset:30720
  s_nop 0
  v_cvt_pk_bf16_f32 v16, v92, v93
  v_cvt_pk_bf16_f32 v17, v94, v95
  v_bfi_b32 v16, 1, s57, v16
  v_smfmac_f32_16x16x64_bf16 v[96:99], v[68:71], a[248:255], v0
  buffer_store_dwordx2 v[16:17], v7, s[4:7], s20 offen offset:0
  v_smfmac_f32_16x16x64_bf16 v[36:39], v[104:107], a[208:215], v0
  ds_read_b128 v[32:35], v4 offset:31744
  v_smfmac_f32_16x16x64_bf16 v[36:39], v[108:111], v[52:59], v0
  s_waitcnt lgkmcnt(4)
  s_nop 0
  v_cvt_pk_bf16_f32 v18, v96, v97
  v_cvt_pk_bf16_f32 v19, v98, v99
  v_bfi_b32 v18, 1, s57, v18
  v_smfmac_f32_16x16x64_bf16 v[36:39], v[68:71], v[76:83], v0
  buffer_store_dwordx2 v[18:19], v7, s[4:7], s20 offen offset:64
  v_smfmac_f32_16x16x64_bf16 v[40:43], v[104:107], a[216:223], v0
  s_waitcnt lgkmcnt(2)
  v_smfmac_f32_16x16x64_bf16 v[40:43], v[108:111], v[60:67], v0
  s_waitcnt lgkmcnt(0)
  s_nop 0
  v_cvt_pk_bf16_f32 v20, v36, v37
  v_cvt_pk_bf16_f32 v21, v38, v39
  v_bfi_b32 v20, 1, s57, v20
  v_smfmac_f32_16x16x64_bf16 v[40:43], v[68:71], v[28:35], v0
  buffer_store_dwordx2 v[20:21], v7, s[4:7], s21 offen offset:0
  s_nop 6
  v_cvt_pk_bf16_f32 v22, v40, v41
  v_cvt_pk_bf16_f32 v23, v42, v43
  v_bfi_b32 v22, 1, s57, v22
  buffer_store_dwordx2 v[22:23], v7, s[4:7], s21 offen offset:64
  ds_read_b128 v[68:71], v4 offset:0
  ds_read_b128 v[72:75], v4 offset:1024
  ds_read_b128 v[76:79], v4 offset:4096
  ds_read_b128 v[80:83], v4 offset:5120
  ds_read_b128 v[84:87], v4 offset:8192
  ds_read_b128 v[88:91], v4 offset:9216
  ds_read_b128 v[92:95], v4 offset:2048
  ds_read_b128 v[96:99], v4 offset:3072
  ds_read_b128 v[100:103], v4 offset:6144
  ds_read_b128 v[104:107], v4 offset:7168
  ds_read_b128 v[108:111], v4 offset:10240
  ds_read_b128 v[112:115], v4 offset:11264
  v_mov_b64 v[16:17], 0
  v_mov_b64 v[18:19], 0
  v_mov_b64 v[20:21], 0
  v_mov_b64 v[22:23], 0
  v_mov_b64 v[24:25], 0
  v_mov_b64 v[26:27], 0
  ds_read_b64 v[44:45], v2 offset:32256
  s_waitcnt lgkmcnt(0)
  v_readfirstlane_b32 s38, v44
  v_readfirstlane_b32 s37, v45
  s_nop 0
  s_add_u32 s37, s37, 30
  s_cmp_ge_u32 s38, 30
  s_cselect_b32 s38, s37, s38
  s_cmp_ge_u32 s38, 64
  s_cselect_b32 s38, 100, s38
  s_sub_u32 s38, s38, 1
  s_max_i32 s30, s30, s38
  s_waitcnt vmcnt(4)
  s_barrier
  ds_read_b128 v[28:31], v2 offset:18432
  ds_read_b128 v[32:35], v2 offset:22528
  ds_read_b128 v[36:39], v2 offset:8192
  ds_read_b128 v[40:43], v2 offset:9216
  ds_read_b128 v[44:47], v2 offset:10240
  ds_read_b128 v[48:51], v2 offset:11264
  buffer_load_dwordx4 v[124:127], v3, s[4:7], s24 offen offset:2048 sc1
  buffer_load_dwordx4 v[116:119], v3, s[4:7], s25 offen offset:2048 sc1
  ds_read_b128 v[52:55], v2 offset:12288
  ds_read_b128 v[56:59], v2 offset:13312
  ds_read_b128 v[60:63], v2 offset:14336
  ds_read_b128 v[64:67], v2 offset:15360
  buffer_load_dwordx4 v[124:127], v3, s[4:7], s24 offen offset:2048 sc1
  buffer_load_dwordx4 v[116:119], v3, s[4:7], s25 offen offset:2048 sc1
  s_mov_b32 s19, 0
  s_branch T_loop_113
T_kvw_117:
  s_mov_b32 s19, 0
  s_branch T_kvok_126
T_kv_125:
  s_sleep 4
  s_add_u32 s19, s19, 1
  s_cmp_gt_u32 s19, 32768
  s_cbranch_scc1 M_exit
T_kvok_126:
  s_add_u32 s39, s99, 128
  s_mov_b32 s38, 0
  s_mov_b32 s37, 0
  s_atomic_or s38, s[58:59], s99 glc
  s_atomic_or s37, s[58:59], s39 glc
  s_waitcnt lgkmcnt(0)
  s_add_u32 s37, s37, 30
  s_cmp_ge_u32 s38, 30
  s_cselect_b32 s38, s37, s38
  s_cmp_ge_u32 s38, 64
  s_cselect_b32 s38, 100, s38
  s_sub_u32 s38, s38, 1
  s_max_i32 s30, s30, s38
  s_cmp_ge_i32 s14, s30
  s_cbranch_scc1 T_kv_125
  s_branch T_kvb_118
T_slow_120:
  s_nop 7
  v_max3_f32 v100, v16, v17, v18
  v_max3_f32 v100, v100, v19, v20
  v_max3_f32 v100, v100, v21, v22
  v_max3_f32 v100, v100, v23, v112
  v_max3_f32 v100, v100, v113, v114
  v_max_f32 v100, v100, v115
  v_mov_b32 v101, v100
  s_nop 1
  v_permlane32_swap_b32 v100, v101
  s_nop 1
  v_max_f32 v100, v100, v101
  v_mov_b32 v101, v100
  s_nop 1
  v_permlane16_swap_b32 v100, v101
  s_nop 1
  v_max_f32 v100, v100, v101
  v_sub_f32 v16, v16, v100
  v_sub_f32 v17, v17, v100
  v_sub_f32 v18, v18, v100
  v_sub_f32 v19, v19, v100
  v_exp_f32 v16, v16
  v_exp_f32 v17, v17
  v_exp_f32 v18, v18
  v_exp_f32 v19, v19
  v_sub_f32 v20, v20, v100
  v_sub_f32 v21, v21, v100
  v_sub_f32 v22, v22, v100
  v_sub_f32 v23, v23, v100
  v_exp_f32 v20, v20
  v_exp_f32 v21, v21
  v_exp_f32 v22, v22
  v_exp_f32 v23, v23
  v_sub_f32 v112, v112, v100
  v_sub_f32 v113, v113, v100
  v_sub_f32 v114, v114, v100
  v_sub_f32 v115, v115, v100
  v_exp_f32 v112, v112
  v_exp_f32 v113, v113
  v_exp_f32 v114, v114
  v_exp_f32 v115, v115
  s_nop 0
  v_cvt_pk_bf16_f32 v44, v16, v17
  v_cvt_pk_bf16_f32 v45, v18, v19
  v_cvt_pk_bf16_f32 v46, v20, v21
  v_cvt_pk_bf16_f32 v47, v22, v23
  v_cvt_pk_bf16_f32 v84, v112, v113
  v_cvt_pk_bf16_f32 v85, v114, v115
  v_cndmask_b32 v48, v84, 0, s[16:17]
  v_cndmask_b32 v49, v85, 0, s[16:17]
  v_cndmask_b32 v50, 0, v84, s[16:17]
  v_cndmask_b32 v51, 0, v85, s[16:17]
  s_nop 1
  v_mfma_f32_16x16x16_bf16 v[88:91], v[12:13], v[48:49], 0
  v_mfma_f32_16x16x16_bf16 v[24:27], v[120:121], v[48:49], 0
  v_mfma_f32_16x16x16_bf16 v[116:119], v[120:121], v[50:51], 0
  v_mfma_f32_16x16x32_bf16 v[88:91], v[12:15], v[44:47], v[88:91]
  v_mfma_f32_16x16x32_bf16 v[24:27], v[28:31], v[44:47], v[24:27]
  v_mfma_f32_16x16x32_bf16 v[116:119], v[32:35], v[44:47], v[116:119]
  s_nop 7
  s_nop 1
  v_rcp_f32 v89, v88
  s_nop 0
  v_mul_f32 v24, v89, v24
  v_mul_f32 v25, v89, v25
  s_branch T_back_121
T_w_84:
  s_mov_b32 s19, 0
  v_mov_b64 v[16:17], 0
  v_mov_b64 v[18:19], 0
  v_mov_b64 v[20:21], 0
  v_mov_b64 v[22:23], 0
  v_mov_b64 v[24:25], 0
  v_mov_b64 v[26:27], 0
  buffer_load_dwordx4 v[124:127], v3, s[4:7], s24 offen offset:3072 sc1
  buffer_load_dwordx4 v[116:119], v3, s[4:7], s25 offen offset:3072 sc1
  buffer_load_dwordx4 v[124:127], v3, s[4:7], s24 offen offset:3072 sc1
  buffer_load_dwordx4 v[116:119], v3, s[4:7], s25 offen offset:3072 sc1
  s_branch T_loop_127
.p2align 6
T_retry_128:
  s_mov_b64 exec, vcc
  buffer_load_dwordx4 v[124:127], v3, s[4:7], s24 offen offset:3072 sc1
  buffer_load_dwordx4 v[116:119], v3, s[4:7], s25 offen offset:3072 sc1
  s_mov_b64 exec, -1
  s_add_u32 s19, s19, 1
  s_cmp_gt_u32 s19, 32768
  s_cbranch_scc1 M_exit
T_loop_127:
  s_waitcnt vmcnt(3) lgkmcnt(0)
  v_max3_u32 v123, v124, v125, v126
  v_max_u32 v123, v123, v127
  v_mov_b32_dpp v120, v124 row_ror:8 row_mask:0xf bank_mask:0xf
  v_mov_b32_dpp v121, v125 row_ror:8 row_mask:0xf bank_mask:0xf
  s_waitcnt vmcnt(2)
  v_max3_u32 v123, v123, v116, v117
  v_max3_u32 v123, v123, v118, v119
  v_cmp_eq_u32 vcc, -1, v123
  s_cbranch_vccnz T_retry_128
  v_smfmac_f32_16x16x64_bf16 v[16:19], v[124:127], v[68:75], v0
  s_add_u32 s14, s14, 1
  ds_write_b128 v2, v[124:127] offset:3072
  v_mov_b32_dpp v122, v126 row_ror:8 row_mask:0xf bank_mask:0xf
  v_smfmac_f32_16x16x64_bf16 v[20:23], v[124:127], v[76:83], v0
  s_and_b32 s57, s14, 1
  v_mov_b32_dpp v123, v127 row_ror:8 row_mask:0xf bank_mask:0xf
  v_smfmac_f32_16x16x64_bf16 v[24:27], v[124:127], v[84:91], v0
  s_and_b32 s36, s14, 3
  ds_write_b128 v2, v[116:119] offset:7168
  v_smfmac_f32_16x16x64_bf16 v[16:19], v[120:123], v[92:99], v0
  s_lshl_b32 s36, s36, 13
  v_mov_b32_dpp v84, v116 row_ror:8 row_mask:0xf bank_mask:0xf
  v_smfmac_f32_16x16x64_bf16 v[20:23], v[120:123], v[100:107], v0
  s_add_u32 s26, s36, s23
  ds_read_b128 v[68:71], v4 offset:12288
  v_mov_b32_dpp v85, v117 row_ror:8 row_mask:0xf bank_mask:0xf
  v_smfmac_f32_16x16x64_bf16 v[24:27], v[120:123], v[108:115], v0
  s_add_u32 s36, s36, 8192
  ds_read_b128 v[72:75], v4 offset:13312
  v_mov_b32_dpp v86, v118 row_ror:8 row_mask:0xf bank_mask:0xf
  v_smfmac_f32_16x16x64_bf16 v[16:19], v[116:119], v[224:231], v0
  s_and_b32 s36, s36, 0x7fff
  ds_read_b128 v[76:79], v4 offset:14336
  v_mov_b32_dpp v87, v119 row_ror:8 row_mask:0xf bank_mask:0xf
  v_smfmac_f32_16x16x64_bf16 v[20:23], v[116:119], v[240:247], v0
  s_waitcnt lgkmcnt(3)
  s_barrier
  ds_read_b128 v[100:103], v2 offset:2048
  v_smfmac_f32_16x16x64_bf16 v[24:27], v[116:119], a[0:7], v0
  s_mov_b32 m0, s31
  ds_read_b128 v[120:123], v1 offset:2048
  v_smfmac_f32_16x16x64_bf16 v[16:19], v[84:87], v[232:239], v0
  s_cmp_ge_i32 s14, s30
  s_cbranch_scc1 T_kvw_131
T_kvb_132:
  v_smfmac_f32_16x16x64_bf16 v[20:23], v[84:87], v[248:255], v0
  ds_read_b128 v[80:83], v4 offset:15360
  v_smfmac_f32_16x16x64_bf16 v[24:27], v[84:87], a[8:15], v0
  s_waitcnt lgkmcnt(2)
  v_smfmac_f32_16x16x64_bf16 v[16:19], v[100:103], v[128:135], v0
  ds_read_b128 v[92:95], v2 offset:1024
  v_smfmac_f32_16x16x64_bf16 v[20:23], v[100:103], v[144:151], v0
  ds_read_b128 v[96:99], v1 offset:1024
  buffer_load_dwordx4 v9, s[4:7], s27 offen sc1 lds
  v_smfmac_f32_16x16x64_bf16 v[24:27], v[100:103], v[68:75], v0
  s_waitcnt vmcnt(1) lgkmcnt(3)
  ds_read_b128 v[116:119], v2 offset:0
  s_mov_b32 m0, s32
  v_smfmac_f32_16x16x64_bf16 v[16:19], v[120:123], v[136:143], v0
  ds_read_b128 v[124:127], v1 offset:0
  v_smfmac_f32_16x16x64_bf16 v[20:23], v[120:123], v[152:159], v0
  s_waitcnt lgkmcnt(4)
  ds_read_b128 v[104:107], v2 offset:6144
  v_smfmac_f32_16x16x64_bf16 v[24:27], v[120:123], v[76:83], v0
  s_waitcnt lgkmcnt(4)
  ds_read_b128 v[108:111], v1 offset:6144
  buffer_load_dwordx4 v9, s[4:7], s27 offen offset:128 sc1 lds
  v_smfmac_f32_16x16x64_bf16 v[16:19], v[92:95], v[160:167], v0
  s_waitcnt lgkmcnt(4)
  ds_read_b128 v[112:115], v2 offset:5120
  s_mov_b32 m0, s33
  v_smfmac_f32_16x16x64_bf16 v[16:19], v[96:99], v[168:175], v0
  s_waitcnt lgkmcnt(4)
  ds_read_b128 v[84:87], v1 offset:5120
  v_smfmac_f32_16x16x64_bf16 v[16:19], v[116:119], v[192:199], v0
  s_waitcnt lgkmcnt(4)
  ds_read_b128 v[88:91], v2 offset:4096
  v_smfmac_f32_16x16x64_bf16 v[16:19], v[124:127], v[200:207], v0
  s_waitcnt lgkmcnt(4)
  ds_read_b128 v[100:103], v1 offset:4096
  buffer_load_dwordx4 v10, s[4:7], s28 offen sc1 lds
  v_smfmac_f32_16x16x64_bf16 v[16:19], v[104:107], a[16:23], v0
  s_waitcnt lgkmcnt(4)
  ds_read_b128 v[68:71], v4 offset:16384
  s_mov_b32 m0, s34
  v_smfmac_f32_16x16x64_bf16 v[16:19], v[108:111], a[24:31], v0
  s_waitcnt lgkmcnt(4)
  ds_read_b128 v[72:75], v4 offset:17408
  v_smfmac_f32_16x16x64_bf16 v[16:19], v[112:115], a[64:71], v0
  s_waitcnt lgkmcnt(4)
  ds_read_b128 v[76:79], v4 offset:18432
  v_smfmac_f32_16x16x64_bf16 v[16:19], v[84:87], a[72:79], v0
  s_waitcnt lgkmcnt(4)
  ds_read_b128 v[80:83], v4 offset:19456
  buffer_load_dwordx4 v10, s[4:7], s28 offen offset:256 sc1 lds
  v_smfmac_f32_16x16x64_bf16 v[16:19], v[88:91], a[112:119], v0
  s_waitcnt lgkmcnt(4)
  s_mov_b32 m0, 32256
  v_smfmac_f32_16x16x64_bf16 v[16:19], v[100:103], a[120:127], v0
  s_add_u32 s24, s36, 145752064
  s_add_u32 s25, s36, 145756160
  v_smfmac_f32_16x16x64_bf16 v[20:23], v[92:95], v[176:183], v0
  s_add_u32 s35, s36, s23
  v_smfmac_f32_16x16x64_bf16 v[20:23], v[96:99], v[184:191], v0
  s_waitcnt lgkmcnt(2)
  buffer_load_dword v8, s[4:7], s99 offen sc1 lds
  v_smfmac_f32_16x16x64_bf16 v[20:23], v[116:119], v[68:75], v0
  s_waitcnt lgkmcnt(0)
  ds_read_b128 v[68:71], v4 offset:20480
  v_mul_f32 v16, s18, v16
  v_smfmac_f32_16x16x64_bf16 v[20:23], v[124:127], v[76:83], v0
  ds_read_b128 v[72:75], v4 offset:21504
  v_mul_f32 v17, s18, v17
  v_smfmac_f32_16x16x64_bf16 v[20:23], v[104:107], a[32:39], v0
  ds_read_b128 v[76:79], v4 offset:22528
  v_mul_f32 v18, s18, v18
  v_smfmac_f32_16x16x64_bf16 v[20:23], v[108:111], a[40:47], v0
  ds_read_b128 v[80:83], v4 offset:23552
  v_mul_f32 v19, s18, v19
  v_smfmac_f32_16x16x64_bf16 v[20:23], v[112:115], a[80:87], v0
  v_cvt_pk_bf16_f32 v120, v16, v17
  v_smfmac_f32_16x16x64_bf16 v[20:23], v[84:87], a[88:95], v0
  v_cvt_pk_bf16_f32 v121, v18, v19
  v_smfmac_f32_16x16x64_bf16 v[20:23], v[88:91], a[128:135], v0
  ds_write_b64 v5, v[120:121] offset:24576
  v_smfmac_f32_16x16x64_bf16 v[20:23], v[100:103], a[136:143], v0
  s_waitcnt lgkmcnt(3)
  v_smfmac_f32_16x16x64_bf16 v[24:27], v[92:95], v[68:75], v0
  s_waitcnt lgkmcnt(1)
  v_mov_b64 v[92:93], 0
  v_smfmac_f32_16x16x64_bf16 v[24:27], v[96:99], v[76:83], v0
  s_nop 1
  v_cvt_pk_bf16_f32 v122, v20, v21
  v_cvt_pk_bf16_f32 v123, v22, v23
  v_smfmac_f32_16x16x64_bf16 v[24:27], v[116:119], v[208:215], v0
  ds_write_b64 v5, v[122:123] offset:26880
  v_mov_b64 v[94:95], 0
  v_smfmac_f32_16x16x64_bf16 v[24:27], v[124:127], v[216:223], v0
  s_waitcnt lgkmcnt(1)
  s_barrier
  ds_read_b64_tr_b16 v[68:69], v6 offset:24576
  v_smfmac_f32_16x16x64_bf16 v[24:27], v[104:107], a[48:55], v0
  s_add_u32 s27, s27, 8192
  ds_read_b64_tr_b16 v[70:71], v6 offset:24640
  ds_read_b64_tr_b16 v[72:73], v6 offset:24832
  v_smfmac_f32_16x16x64_bf16 v[24:27], v[108:111], a[56:63], v0
  s_add_u32 s28, s28, 8192
  ds_read_b64_tr_b16 v[74:75], v6 offset:24896
  ds_read_b64_tr_b16 v[76:77], v6 offset:25088
  v_smfmac_f32_16x16x64_bf16 v[24:27], v[112:115], a[96:103], v0
  s_nop 0
  ds_read_b64_tr_b16 v[78:79], v6 offset:25152
  ds_read_b64_tr_b16 v[80:81], v6 offset:25344
  v_smfmac_f32_16x16x64_bf16 v[24:27], v[84:87], a[104:111], v0
  ds_read_b64_tr_b16 v[82:83], v6 offset:25408
  v_mov_b64 v[96:97], 0
  v_smfmac_f32_16x16x64_bf16 v[24:27], v[88:91], a[144:151], v0
  s_waitcnt lgkmcnt(8)
  s_barrier
  ds_read_b64_tr_b16 v[116:117], v6 offset:26880
  v_smfmac_f32_16x16x64_bf16 v[24:27], v[100:103], a[152:159], v0
  s_waitcnt lgkmcnt(7)
  ds_read_b64_tr_b16 v[118:119], v6 offset:26944
  v_mfma_f32_16x16x32_bf16 v[16:19], v[36:39], v[68:71], 0
  s_waitcnt lgkmcnt(6)
  ds_read_b64_tr_b16 v[124:125], v6 offset:27136
  ds_read_b64_tr_b16 v[126:127], v6 offset:27200
  v_mfma_f32_16x16x32_bf16 v[16:19], v[40:43], v[72:75], v[16:19]
  s_waitcnt lgkmcnt(6)
  ds_read_b64_tr_b16 v[104:105], v6 offset:27392
  ds_read_b64_tr_b16 v[106:107], v6 offset:27456
  v_mfma_f32_16x16x32_bf16 v[16:19], v[44:47], v[76:79], v[16:19]
  s_waitcnt lgkmcnt(6)
  ds_read_b64_tr_b16 v[108:109], v6 offset:27648
  ds_read_b64_tr_b16 v[110:111], v6 offset:27712
  v_mfma_f32_16x16x32_bf16 v[16:19], v[48:51], v[80:83], v[16:19]
  s_waitcnt lgkmcnt(6)
  v_cvt_pk_bf16_f32 v120, v24, v25
  v_cvt_pk_bf16_f32 v121, v26, v27
  v_mfma_f32_16x16x32_bf16 v[112:115], v[116:119], v[68:71], 0
  s_waitcnt lgkmcnt(4)
  buffer_store_dwordx4 v[120:123], v2, s[4:7], s29 offen offset:3072 sc1
  v_mov_b64 v[98:99], 0
  v_mfma_f32_16x16x32_bf16 v[112:115], v[124:127], v[72:75], v[112:115]
  s_waitcnt lgkmcnt(2)
  v_mov_b64 v[36:37], 0
  v_exp_f32 v100, v16
  v_mfma_f32_16x16x32_bf16 v[112:115], v[104:107], v[76:79], v[112:115]
  s_waitcnt lgkmcnt(0)
  v_exp_f32 v101, v17
  v_mfma_f32_16x16x32_bf16 v[112:115], v[108:111], v[80:83], v[112:115]
  s_add_u32 s29, s29, 131072
  v_exp_f32 v102, v18
  v_mfma_f32_16x16x32_bf16 v[20:23], v[52:55], v[68:71], 0
  s_cmp_eq_u32 s14, 63
  v_exp_f32 v103, v19
  v_mfma_f32_16x16x32_bf16 v[20:23], v[56:59], v[72:75], v[20:23]
  s_cbranch_scc1 M_tdone
  v_cvt_pk_bf16_f32 v44, v100, v101
  v_cvt_pk_bf16_f32 v45, v102, v103
  v_mfma_f32_16x16x32_bf16 v[20:23], v[60:63], v[76:79], v[20:23]
  v_exp_f32 v100, v112
  v_mfma_f32_16x16x32_bf16 v[20:23], v[64:67], v[80:83], v[20:23]
  v_exp_f32 v101, v113
  v_exp_f32 v102, v114
  v_exp_f32 v103, v115
  v_cvt_pk_bf16_f32 v84, v100, v101
  v_cvt_pk_bf16_f32 v85, v102, v103
  v_cndmask_b32 v48, v84, 0, s[16:17]
  v_cndmask_b32 v49, v85, 0, s[16:17]
  v_cndmask_b32 v50, 0, v84, s[16:17]
  v_cndmask_b32 v51, 0, v85, s[16:17]
  v_exp_f32 v100, v20
  v_mfma_f32_16x16x16_bf16 v[88:91], v[12:13], v[48:49], 0
  v_exp_f32 v101, v21
  v_mfma_f32_16x16x16_bf16 v[24:27], v[120:121], v[48:49], 0
  v_exp_f32 v102, v22
  v_mfma_f32_16x16x16_bf16 v[116:119], v[120:121], v[50:51], 0
  v_exp_f32 v103, v23
  v_cvt_pk_bf16_f32 v46, v100, v101
  v_cvt_pk_bf16_f32 v47, v102, v103
  v_mov_b64 v[38:39], 0
  s_nop 0
  v_mfma_f32_16x16x32_bf16 v[88:91], v[12:15], v[44:47], v[88:91]
  v_mov_b64 v[40:41], 0
  v_mov_b64 v[42:43], 0
  v_mfma_f32_16x16x32_bf16 v[24:27], v[28:31], v[44:47], v[24:27]
  ds_read_b128 v[52:55], v4 offset:24576
  ds_read_b128 v[56:59], v4 offset:25600
  v_mfma_f32_16x16x32_bf16 v[116:119], v[32:35], v[44:47], v[116:119]
  s_nop 1
  v_rcp_f32 v89, v88
  v_subrev_u32 v100, s54, v88
  v_cmp_le_u32 vcc, s55, v100
  v_mul_f32 v24, v89, v24
  v_mul_f32 v25, v89, v25
  s_cbranch_vccnz T_slow_134
T_back_135:
  v_cvt_pk_bf16_f32 v124, v24, v25
  v_pk_mul_f32 v[26:27], v[26:27], v[88:89] op_sel:[0,1] op_sel_hi:[1,1]
  v_pk_mul_f32 v[116:117], v[116:117], v[88:89] op_sel:[0,1] op_sel_hi:[1,1]
  v_pk_mul_f32 v[118:119], v[118:119], v[88:89] op_sel:[0,1] op_sel_hi:[1,1]
  v_cvt_pk_bf16_f32 v125, v26, v27
  v_cvt_pk_bf16_f32 v126, v116, v117
  v_cvt_pk_bf16_f32 v127, v118, v119
  ds_write_b128 v11, v[124:127] offset:30720
  s_nop 0
  v_smfmac_f32_16x16x64_bf16 v[92:95], v[124:127], a[160:167], v0
  v_smfmac_f32_16x16x64_bf16 v[96:99], v[124:127], a[168:175], v0
  v_smfmac_f32_16x16x64_bf16 v[36:39], v[124:127], a[176:183], v0
  v_smfmac_f32_16x16x64_bf16 v[40:43], v[124:127], a[184:191], v0
  s_waitcnt lgkmcnt(0)
  s_barrier
  ds_read_b128 v[104:107], v11 offset:30208
  ds_read_b128 v[108:111], v11 offset:29696
  ds_read_b128 v[68:71], v11 offset:29184
  s_waitcnt lgkmcnt(2)
  v_smfmac_f32_16x16x64_bf16 v[92:95], v[104:107], a[192:199], v0
  s_waitcnt lgkmcnt(1)
  ds_read_b128 v[76:79], v4 offset:28672
  v_smfmac_f32_16x16x64_bf16 v[92:95], v[108:111], a[224:231], v0
  s_waitcnt lgkmcnt(1)
  ds_read_b128 v[80:83], v4 offset:29696
  v_smfmac_f32_16x16x64_bf16 v[92:95], v[68:71], a[240:247], v0
  ds_read_b128 v[60:63], v4 offset:26624
  v_smfmac_f32_16x16x64_bf16 v[96:99], v[104:107], a[200:207], v0
  ds_read_b128 v[64:67], v4 offset:27648
  v_smfmac_f32_16x16x64_bf16 v[96:99], v[108:111], a[232:239], v0
  ds_read_b128 v[28:31], v4 offset:30720
  s_nop 0
  v_cvt_pk_bf16_f32 v16, v92, v93
  v_cvt_pk_bf16_f32 v17, v94, v95
  v_bfi_b32 v16, 1, s57, v16
  v_smfmac_f32_16x16x64_bf16 v[96:99], v[68:71], a[248:255], v0
  buffer_store_dwordx2 v[16:17], v7, s[4:7], s20 offen offset:0
  v_smfmac_f32_16x16x64_bf16 v[36:39], v[104:107], a[208:215], v0
  ds_read_b128 v[32:35], v4 offset:31744
  v_smfmac_f32_16x16x64_bf16 v[36:39], v[108:111], v[52:59], v0
  s_waitcnt lgkmcnt(4)
  s_nop 0
  v_cvt_pk_bf16_f32 v18, v96, v97
  v_cvt_pk_bf16_f32 v19, v98, v99
  v_bfi_b32 v18, 1, s57, v18
  v_smfmac_f32_16x16x64_bf16 v[36:39], v[68:71], v[76:83], v0
  buffer_store_dwordx2 v[18:19], v7, s[4:7], s20 offen offset:64
  v_smfmac_f32_16x16x64_bf16 v[40:43], v[104:107], a[216:223], v0
  s_waitcnt lgkmcnt(2)
  v_smfmac_f32_16x16x64_bf16 v[40:43], v[108:111], v[60:67], v0
  s_waitcnt lgkmcnt(0)
  s_nop 0
  v_cvt_pk_bf16_f32 v20, v36, v37
  v_cvt_pk_bf16_f32 v21, v38, v39
  v_bfi_b32 v20, 1, s57, v20
  v_smfmac_f32_16x16x64_bf16 v[40:43], v[68:71], v[28:35], v0
  buffer_store_dwordx2 v[20:21], v7, s[4:7], s21 offen offset:0
  s_nop 6
  v_cvt_pk_bf16_f32 v22, v40, v41
  v_cvt_pk_bf16_f32 v23, v42, v43
  v_bfi_b32 v22, 1, s57, v22
  buffer_store_dwordx2 v[22:23], v7, s[4:7], s21 offen offset:64
  ds_read_b128 v[68:71], v4 offset:0
  ds_read_b128 v[72:75], v4 offset:1024
  ds_read_b128 v[76:79], v4 offset:4096
  ds_read_b128 v[80:83], v4 offset:5120
  ds_read_b128 v[84:87], v4 offset:8192
  ds_read_b128 v[88:91], v4 offset:9216
  ds_read_b128 v[92:95], v4 offset:2048
  ds_read_b128 v[96:99], v4 offset:3072
  ds_read_b128 v[100:103], v4 offset:6144
  ds_read_b128 v[104:107], v4 offset:7168
  ds_read_b128 v[108:111], v4 offset:10240
  ds_read_b128 v[112:115], v4 offset:11264
  v_mov_b64 v[16:17], 0
  v_mov_b64 v[18:19], 0
  v_mov_b64 v[20:21], 0
  v_mov_b64 v[22:23], 0
  v_mov_b64 v[24:25], 0
  v_mov_b64 v[26:27], 0
  ds_read_b64 v[44:45], v2 offset:32256
  s_waitcnt lgkmcnt(0)
  v_readfirstlane_b32 s38, v44
  v_readfirstlane_b32 s37, v45
  s_nop 0
  s_add_u32 s37, s37, 30
  s_cmp_ge_u32 s38, 30
  s_cselect_b32 s38, s37, s38
  s_cmp_ge_u32 s38, 64
  s_cselect_b32 s38, 100, s38
  s_sub_u32 s38, s38, 1
  s_max_i32 s30, s30, s38
  s_waitcnt vmcnt(4)
  s_barrier
  ds_read_b128 v[28:31], v2 offset:19456
  ds_read_b128 v[32:35], v2 offset:23552
  ds_read_b128 v[36:39], v2 offset:8192
  ds_read_b128 v[40:43], v2 offset:9216
  ds_read_b128 v[44:47], v2 offset:10240
  ds_read_b128 v[48:51], v2 offset:11264
  buffer_load_dwordx4 v[124:127], v3, s[4:7], s24 offen offset:3072 sc1
  buffer_load_dwordx4 v[116:119], v3, s[4:7], s25 offen offset:3072 sc1
  ds_read_b128 v[52:55], v2 offset:12288
  ds_read_b128 v[56:59], v2 offset:13312
  ds_read_b128 v[60:63], v2 offset:14336
  ds_read_b128 v[64:67], v2 offset:15360
  buffer_load_dwordx4 v[124:127], v3, s[4:7], s24 offen offset:3072 sc1
  buffer_load_dwordx4 v[116:119], v3, s[4:7], s25 offen offset:3072 sc1
  s_mov_b32 s19, 0
  s_branch T_loop_127
T_kvw_131:
  s_mov_b32 s19, 0
  s_branch T_kvok_140
T_kv_139:
  s_sleep 4
  s_add_u32 s19, s19, 1
  s_cmp_gt_u32 s19, 32768
  s_cbranch_scc1 M_exit
T_kvok_140:
  s_add_u32 s39, s99, 128
  s_mov_b32 s38, 0
  s_mov_b32 s37, 0
  s_atomic_or s38, s[58:59], s99 glc
  s_atomic_or s37, s[58:59], s39 glc
  s_waitcnt lgkmcnt(0)
  s_add_u32 s37, s37, 30
  s_cmp_ge_u32 s38, 30
  s_cselect_b32 s38, s37, s38
  s_cmp_ge_u32 s38, 64
  s_cselect_b32 s38, 100, s38
  s_sub_u32 s38, s38, 1
  s_max_i32 s30, s30, s38
  s_cmp_ge_i32 s14, s30
  s_cbranch_scc1 T_kv_139
  s_branch T_kvb_132
T_slow_134:
  s_nop 7
  v_max3_f32 v100, v16, v17, v18
  v_max3_f32 v100, v100, v19, v20
  v_max3_f32 v100, v100, v21, v22
  v_max3_f32 v100, v100, v23, v112
  v_max3_f32 v100, v100, v113, v114
  v_max_f32 v100, v100, v115
  v_mov_b32 v101, v100
  s_nop 1
  v_permlane32_swap_b32 v100, v101
  s_nop 1
  v_max_f32 v100, v100, v101
  v_mov_b32 v101, v100
  s_nop 1
  v_permlane16_swap_b32 v100, v101
  s_nop 1
  v_max_f32 v100, v100, v101
  v_sub_f32 v16, v16, v100
  v_sub_f32 v17, v17, v100
  v_sub_f32 v18, v18, v100
  v_sub_f32 v19, v19, v100
  v_exp_f32 v16, v16
  v_exp_f32 v17, v17
  v_exp_f32 v18, v18
  v_exp_f32 v19, v19
  v_sub_f32 v20, v20, v100
  v_sub_f32 v21, v21, v100
  v_sub_f32 v22, v22, v100
  v_sub_f32 v23, v23, v100
  v_exp_f32 v20, v20
  v_exp_f32 v21, v21
  v_exp_f32 v22, v22
  v_exp_f32 v23, v23
  v_sub_f32 v112, v112, v100
  v_sub_f32 v113, v113, v100
  v_sub_f32 v114, v114, v100
  v_sub_f32 v115, v115, v100
  v_exp_f32 v112, v112
  v_exp_f32 v113, v113
  v_exp_f32 v114, v114
  v_exp_f32 v115, v115
  s_nop 0
  v_cvt_pk_bf16_f32 v44, v16, v17
  v_cvt_pk_bf16_f32 v45, v18, v19
  v_cvt_pk_bf16_f32 v46, v20, v21
  v_cvt_pk_bf16_f32 v47, v22, v23
  v_cvt_pk_bf16_f32 v84, v112, v113
  v_cvt_pk_bf16_f32 v85, v114, v115
  v_cndmask_b32 v48, v84, 0, s[16:17]
  v_cndmask_b32 v49, v85, 0, s[16:17]
  v_cndmask_b32 v50, 0, v84, s[16:17]
  v_cndmask_b32 v51, 0, v85, s[16:17]
  s_nop 1
  v_mfma_f32_16x16x16_bf16 v[88:91], v[12:13], v[48:49], 0
  v_mfma_f32_16x16x16_bf16 v[24:27], v[120:121], v[48:49], 0
  v_mfma_f32_16x16x16_bf16 v[116:119], v[120:121], v[50:51], 0
  v_mfma_f32_16x16x32_bf16 v[88:91], v[12:15], v[44:47], v[88:91]
  v_mfma_f32_16x16x32_bf16 v[24:27], v[28:31], v[44:47], v[24:27]
  v_mfma_f32_16x16x32_bf16 v[116:119], v[32:35], v[44:47], v[116:119]
  s_nop 7
  s_nop 1
  v_rcp_f32 v89, v88
  s_nop 0
  v_mul_f32 v24, v89, v24
  v_mul_f32 v25, v89, v25
  s_branch T_back_135
M_global:
  s_cmp_eq_u32 s13, 1
  s_cbranch_scc1 T_w_142
  s_cmp_eq_u32 s13, 2
  s_cbranch_scc1 T_w_143
  s_cmp_eq_u32 s13, 3
  s_cbranch_scc1 T_w_144
T_w_141:
  s_mov_b32 s19, 0
  v_mov_b64 v[16:17], 0
  v_mov_b64 v[18:19], 0
  v_mov_b64 v[20:21], 0
  v_mov_b64 v[22:23], 0
  v_mov_b64 v[24:25], 0
  v_mov_b64 v[26:27], 0
  buffer_load_dwordx4 v[124:127], v3, s[4:7], s24 offen offset:0 sc1
  buffer_load_dwordx4 v[116:119], v3, s[4:7], s25 offen offset:0 sc1
  buffer_load_dwordx4 v[124:127], v3, s[4:7], s24 offen offset:0 sc1
  buffer_load_dwordx4 v[116:119], v3, s[4:7], s25 offen offset:0 sc1
  s_branch T_loop_145
.p2align 6
T_retry_146:
  s_mov_b64 exec, vcc
  buffer_load_dwordx4 v[124:127], v3, s[4:7], s24 offen offset:0 sc1
  buffer_load_dwordx4 v[116:119], v3, s[4:7], s25 offen offset:0 sc1
  s_mov_b64 exec, -1
  s_add_u32 s19, s19, 1
  s_cmp_gt_u32 s19, 32768
  s_cbranch_scc1 M_exit
T_loop_145:
  s_waitcnt vmcnt(3) lgkmcnt(0)
  v_max3_u32 v123, v124, v125, v126
  v_max_u32 v123, v123, v127
  v_mov_b32_dpp v120, v124 row_ror:8 row_mask:0xf bank_mask:0xf
  v_mov_b32_dpp v121, v125 row_ror:8 row_mask:0xf bank_mask:0xf
  s_waitcnt vmcnt(2)
  v_max3_u32 v123, v123, v116, v117
  v_max3_u32 v123, v123, v118, v119
  v_cmp_eq_u32 vcc, -1, v123
  s_cbranch_vccnz T_retry_146
  v_smfmac_f32_16x16x64_bf16 v[16:19], v[124:127], v[68:75], v0
  s_add_u32 s14, s14, 1
  ds_write_b128 v2, v[124:127] offset:0
  v_mov_b32_dpp v122, v126 row_ror:8 row_mask:0xf bank_mask:0xf
  v_smfmac_f32_16x16x64_bf16 v[20:23], v[124:127], v[76:83], v0
  s_and_b32 s57, s14, 1
  v_mov_b32_dpp v123, v127 row_ror:8 row_mask:0xf bank_mask:0xf
  v_smfmac_f32_16x16x64_bf16 v[24:27], v[124:127], v[84:91], v0
  s_and_b32 s36, s14, 3
  ds_write_b128 v2, v[116:119] offset:4096
  v_smfmac_f32_16x16x64_bf16 v[16:19], v[120:123], v[92:99], v0
  s_lshl_b32 s36, s36, 13
  v_mov_b32_dpp v84, v116 row_ror:8 row_mask:0xf bank_mask:0xf
  v_smfmac_f32_16x16x64_bf16 v[20:23], v[120:123], v[100:107], v0
  s_add_u32 s26, s36, s23
  ds_read_b128 v[68:71], v4 offset:12288
  v_mov_b32_dpp v85, v117 row_ror:8 row_mask:0xf bank_mask:0xf
  v_smfmac_f32_16x16x64_bf16 v[24:27], v[120:123], v[108:115], v0
  s_add_u32 s36, s36, 8192
  ds_read_b128 v[72:75], v4 offset:13312
  v_mov_b32_dpp v86, v118 row_ror:8 row_mask:0xf bank_mask:0xf
  v_smfmac_f32_16x16x64_bf16 v[16:19], v[116:119], v[224:231], v0
  s_and_b32 s36, s36, 0x7fff
  ds_read_b128 v[76:79], v4 offset:14336
  v_mov_b32_dpp v87, v119 row_ror:8 row_mask:0xf bank_mask:0xf
  v_smfmac_f32_16x16x64_bf16 v[20:23], v[116:119], v[240:247], v0
  s_waitcnt lgkmcnt(3)
  s_barrier
  ds_read_b128 v[100:103], v2 offset:1024
  v_smfmac_f32_16x16x64_bf16 v[24:27], v[116:119], a[0:7], v0
  s_mov_b32 m0, s31
  ds_read_b128 v[120:123], v1 offset:1024
  v_smfmac_f32_16x16x64_bf16 v[16:19], v[84:87], v[232:239], v0
  s_cmp_ge_i32 s14, s30
  s_cbranch_scc1 T_kvw_149
T_kvb_150:
  v_smfmac_f32_16x16x64_bf16 v[20:23], v[84:87], v[248:255], v0
  ds_read_b128 v[80:83], v4 offset:15360
  buffer_load_dwordx4 v9, s[4:7], s27 offen sc1 lds
  v_smfmac_f32_16x16x64_bf16 v[24:27], v[84:87], a[8:15], v0
  s_waitcnt lgkmcnt(2)
  s_mov_b32 m0, s32
  v_smfmac_f32_16x16x64_bf16 v[16:19], v[100:103], v[128:135], v0
  ds_read_b128 v[92:95], v2 offset:2048
  v_smfmac_f32_16x16x64_bf16 v[20:23], v[100:103], v[144:151], v0
  ds_read_b128 v[96:99], v1 offset:2048
  v_smfmac_f32_16x16x64_bf16 v[24:27], v[100:103], v[68:75], v0
  s_waitcnt vmcnt(1) lgkmcnt(3)
  ds_read_b128 v[116:119], v2 offset:3072
  buffer_load_dwordx4 v9, s[4:7], s27 offen offset:128 sc1 lds
  v_smfmac_f32_16x16x64_bf16 v[16:19], v[120:123], v[136:143], v0
  ds_read_b128 v[124:127], v1 offset:3072
  s_mov_b32 m0, s33
  v_smfmac_f32_16x16x64_bf16 v[20:23], v[120:123], v[152:159], v0
  s_waitcnt lgkmcnt(4)
  ds_read_b128 v[104:107], v2 offset:5120
  v_smfmac_f32_16x16x64_bf16 v[24:27], v[120:123], v[76:83], v0
  s_waitcnt lgkmcnt(4)
  ds_read_b128 v[108:111], v1 offset:5120
  v_smfmac_f32_16x16x64_bf16 v[16:19], v[92:95], v[160:167], v0
  s_waitcnt lgkmcnt(4)
  ds_read_b128 v[112:115], v2 offset:6144
  buffer_load_dwordx4 v10, s[4:7], s28 offen sc1 lds
  v_smfmac_f32_16x16x64_bf16 v[16:19], v[96:99], v[168:175], v0
  s_waitcnt lgkmcnt(4)
  ds_read_b128 v[84:87], v1 offset:6144
  s_mov_b32 m0, s34
  v_smfmac_f32_16x16x64_bf16 v[16:19], v[116:119], v[192:199], v0
  s_waitcnt lgkmcnt(4)
  ds_read_b128 v[88:91], v2 offset:7168
  v_smfmac_f32_16x16x64_bf16 v[16:19], v[124:127], v[200:207], v0
  s_waitcnt lgkmcnt(4)
  ds_read_b128 v[100:103], v1 offset:7168
  v_smfmac_f32_16x16x64_bf16 v[16:19], v[104:107], a[16:23], v0
  s_waitcnt lgkmcnt(4)
  ds_read_b128 v[68:71], v4 offset:16384
  buffer_load_dwordx4 v10, s[4:7], s28 offen offset:256 sc1 lds
  v_smfmac_f32_16x16x64_bf16 v[16:19], v[108:111], a[24:31], v0
  s_waitcnt lgkmcnt(4)
  ds_read_b128 v[72:75], v4 offset:17408
  v_smfmac_f32_16x16x64_bf16 v[16:19], v[112:115], a[64:71], v0
  s_waitcnt lgkmcnt(4)
  ds_read_b128 v[76:79], v4 offset:18432
  v_smfmac_f32_16x16x64_bf16 v[16:19], v[84:87], a[72:79], v0
  s_waitcnt lgkmcnt(4)
  ds_read_b128 v[80:83], v4 offset:19456
  v_smfmac_f32_16x16x64_bf16 v[16:19], v[88:91], a[112:119], v0
  s_waitcnt lgkmcnt(4)
  v_smfmac_f32_16x16x64_bf16 v[16:19], v[100:103], a[120:127], v0
  s_add_u32 s24, s36, 145752064
  s_add_u32 s25, s36, 145756160
  v_smfmac_f32_16x16x64_bf16 v[20:23], v[92:95], v[176:183], v0
  s_add_u32 s35, s36, s23
  v_smfmac_f32_16x16x64_bf16 v[20:23], v[96:99], v[184:191], v0
  s_waitcnt lgkmcnt(2)
  v_smfmac_f32_16x16x64_bf16 v[20:23], v[116:119], v[68:75], v0
  s_waitcnt lgkmcnt(0)
  ds_read_b128 v[68:71], v4 offset:20480
  v_mul_f32 v16, s18, v16
  v_smfmac_f32_16x16x64_bf16 v[20:23], v[124:127], v[76:83], v0
  ds_read_b128 v[72:75], v4 offset:21504
  v_mul_f32 v17, s18, v17
  v_smfmac_f32_16x16x64_bf16 v[20:23], v[104:107], a[32:39], v0
  ds_read_b128 v[76:79], v4 offset:22528
  v_mul_f32 v18, s18, v18
  v_smfmac_f32_16x16x64_bf16 v[20:23], v[108:111], a[40:47], v0
  ds_read_b128 v[80:83], v4 offset:23552
  v_mul_f32 v19, s18, v19
  v_smfmac_f32_16x16x64_bf16 v[20:23], v[112:115], a[80:87], v0
  v_cvt_pk_bf16_f32 v120, v16, v17
  v_smfmac_f32_16x16x64_bf16 v[20:23], v[84:87], a[88:95], v0
  v_cvt_pk_bf16_f32 v121, v18, v19
  v_smfmac_f32_16x16x64_bf16 v[20:23], v[88:91], a[128:135], v0
  ds_write_b64 v5, v[120:121] offset:24576
  v_smfmac_f32_16x16x64_bf16 v[20:23], v[100:103], a[136:143], v0
  s_waitcnt lgkmcnt(3)
  v_smfmac_f32_16x16x64_bf16 v[24:27], v[92:95], v[68:75], v0
  s_waitcnt lgkmcnt(1)
  v_mov_b64 v[92:93], 0
  v_smfmac_f32_16x16x64_bf16 v[24:27], v[96:99], v[76:83], v0
  s_nop 1
  v_cvt_pk_bf16_f32 v122, v20, v21
  v_cvt_pk_bf16_f32 v123, v22, v23
  v_smfmac_f32_16x16x64_bf16 v[24:27], v[116:119], v[208:215], v0
  ds_write_b64 v5, v[122:123] offset:26880
  v_mov_b64 v[94:95], 0
  v_smfmac_f32_16x16x64_bf16 v[24:27], v[124:127], v[216:223], v0
  s_waitcnt lgkmcnt(1)
  s_barrier
  ds_read_b64_tr_b16 v[68:69], v6 offset:24576
  v_smfmac_f32_16x16x64_bf16 v[24:27], v[104:107], a[48:55], v0
  s_add_u32 s27, s27, 8192
  ds_read_b64_tr_b16 v[70:71], v6 offset:24640
  ds_read_b64_tr_b16 v[72:73], v6 offset:24832
  v_smfmac_f32_16x16x64_bf16 v[24:27], v[108:111], a[56:63], v0
  s_add_u32 s28, s28, 8192
  ds_read_b64_tr_b16 v[74:75], v6 offset:24896
  ds_read_b64_tr_b16 v[76:77], v6 offset:25088
  v_smfmac_f32_16x16x64_bf16 v[24:27], v[112:115], a[96:103], v0
  s_nop 0
  ds_read_b64_tr_b16 v[78:79], v6 offset:25152
  ds_read_b64_tr_b16 v[80:81], v6 offset:25344
  v_smfmac_f32_16x16x64_bf16 v[24:27], v[84:87], a[104:111], v0
  ds_read_b64_tr_b16 v[82:83], v6 offset:25408
  v_mov_b64 v[96:97], 0
  v_smfmac_f32_16x16x64_bf16 v[24:27], v[88:91], a[144:151], v0
  s_waitcnt lgkmcnt(8)
  s_barrier
  ds_read_b64_tr_b16 v[116:117], v6 offset:26880
  v_smfmac_f32_16x16x64_bf16 v[24:27], v[100:103], a[152:159], v0
  s_waitcnt lgkmcnt(7)
  ds_read_b64_tr_b16 v[118:119], v6 offset:26944
  v_mfma_f32_16x16x32_bf16 v[16:19], v[36:39], v[68:71], 0
  s_waitcnt lgkmcnt(6)
  ds_read_b64_tr_b16 v[124:125], v6 offset:27136
  ds_read_b64_tr_b16 v[126:127], v6 offset:27200
  v_mfma_f32_16x16x32_bf16 v[16:19], v[40:43], v[72:75], v[16:19]
  s_waitcnt lgkmcnt(6)
  ds_read_b64_tr_b16 v[104:105], v6 offset:27392
  ds_read_b64_tr_b16 v[106:107], v6 offset:27456
  v_mfma_f32_16x16x32_bf16 v[16:19], v[44:47], v[76:79], v[16:19]
  s_waitcnt lgkmcnt(6)
  ds_read_b64_tr_b16 v[108:109], v6 offset:27648
  ds_read_b64_tr_b16 v[110:111], v6 offset:27712
  v_mfma_f32_16x16x32_bf16 v[16:19], v[48:51], v[80:83], v[16:19]
  s_waitcnt lgkmcnt(6)
  v_cvt_pk_bf16_f32 v120, v24, v25
  v_cvt_pk_bf16_f32 v121, v26, v27
  v_mfma_f32_16x16x32_bf16 v[112:115], v[116:119], v[68:71], 0
  s_waitcnt lgkmcnt(4)
  buffer_store_dwordx4 v[120:123], v2, s[4:7], s29 offen offset:0 sc1
  v_mov_b64 v[98:99], 0
  v_mfma_f32_16x16x32_bf16 v[112:115], v[124:127], v[72:75], v[112:115]
  s_waitcnt lgkmcnt(2)
  v_mov_b64 v[36:37], 0
  v_exp_f32 v100, v16
  v_mfma_f32_16x16x32_bf16 v[112:115], v[104:107], v[76:79], v[112:115]
  s_waitcnt lgkmcnt(0)
  v_exp_f32 v101, v17
  v_mfma_f32_16x16x32_bf16 v[112:115], v[108:111], v[80:83], v[112:115]
  s_add_u32 s29, s29, 131072
  v_exp_f32 v102, v18
  v_mfma_f32_16x16x32_bf16 v[20:23], v[52:55], v[68:71], 0
  s_cmp_eq_u32 s14, 63
  v_exp_f32 v103, v19
  v_mfma_f32_16x16x32_bf16 v[20:23], v[56:59], v[72:75], v[20:23]
  s_cbranch_scc1 M_tdone
  v_cvt_pk_bf16_f32 v44, v100, v101
  v_cvt_pk_bf16_f32 v45, v102, v103
  v_mfma_f32_16x16x32_bf16 v[20:23], v[60:63], v[76:79], v[20:23]
  v_exp_f32 v100, v112
  v_mfma_f32_16x16x32_bf16 v[20:23], v[64:67], v[80:83], v[20:23]
  v_exp_f32 v101, v113
  v_exp_f32 v102, v114
  v_exp_f32 v103, v115
  v_cvt_pk_bf16_f32 v84, v100, v101
  v_cvt_pk_bf16_f32 v85, v102, v103
  v_cndmask_b32 v48, v84, 0, s[16:17]
  v_cndmask_b32 v49, v85, 0, s[16:17]
  v_cndmask_b32 v50, 0, v84, s[16:17]
  v_cndmask_b32 v51, 0, v85, s[16:17]
  v_exp_f32 v100, v20
  v_mfma_f32_16x16x16_bf16 v[88:91], v[12:13], v[48:49], 0
  v_exp_f32 v101, v21
  v_mfma_f32_16x16x16_bf16 v[24:27], v[120:121], v[48:49], 0
  v_exp_f32 v102, v22
  v_mfma_f32_16x16x16_bf16 v[116:119], v[120:121], v[50:51], 0
  v_exp_f32 v103, v23
  v_cvt_pk_bf16_f32 v46, v100, v101
  v_cvt_pk_bf16_f32 v47, v102, v103
  v_mov_b64 v[38:39], 0
  s_nop 0
  v_mfma_f32_16x16x32_bf16 v[88:91], v[12:15], v[44:47], v[88:91]
  v_mov_b64 v[40:41], 0
  v_mov_b64 v[42:43], 0
  v_mfma_f32_16x16x32_bf16 v[24:27], v[28:31], v[44:47], v[24:27]
  ds_read_b128 v[52:55], v4 offset:24576
  ds_read_b128 v[56:59], v4 offset:25600
  v_mfma_f32_16x16x32_bf16 v[116:119], v[32:35], v[44:47], v[116:119]
  s_nop 1
  v_rcp_f32 v89, v88
  v_subrev_u32 v100, s54, v88
  v_cmp_le_u32 vcc, s55, v100
  v_mul_f32 v24, v89, v24
  v_mul_f32 v25, v89, v25
  s_cbranch_vccnz T_slow_152
T_back_153:
  v_cvt_pk_bf16_f32 v124, v24, v25
  v_pk_mul_f32 v[26:27], v[26:27], v[88:89] op_sel:[0,1] op_sel_hi:[1,1]
  v_pk_mul_f32 v[116:117], v[116:117], v[88:89] op_sel:[0,1] op_sel_hi:[1,1]
  v_pk_mul_f32 v[118:119], v[118:119], v[88:89] op_sel:[0,1] op_sel_hi:[1,1]
  v_cvt_pk_bf16_f32 v125, v26, v27
  v_cvt_pk_bf16_f32 v126, v116, v117
  v_cvt_pk_bf16_f32 v127, v118, v119
  ds_write_b128 v11, v[124:127] offset:29184
  s_nop 0
  v_smfmac_f32_16x16x64_bf16 v[92:95], v[124:127], a[160:167], v0
  v_smfmac_f32_16x16x64_bf16 v[96:99], v[124:127], a[168:175], v0
  v_smfmac_f32_16x16x64_bf16 v[36:39], v[124:127], a[176:183], v0
  v_smfmac_f32_16x16x64_bf16 v[40:43], v[124:127], a[184:191], v0
  s_waitcnt lgkmcnt(0)
  s_barrier
  ds_read_b128 v[104:107], v11 offset:29696
  ds_read_b128 v[108:111], v11 offset:30208
  ds_read_b128 v[68:71], v11 offset:30720
  s_waitcnt lgkmcnt(2)
  v_smfmac_f32_16x16x64_bf16 v[92:95], v[104:107], a[192:199], v0
  s_waitcnt lgkmcnt(1)
  ds_read_b128 v[76:79], v4 offset:28672
  v_smfmac_f32_16x16x64_bf16 v[92:95], v[108:111], a[224:231], v0
  s_waitcnt lgkmcnt(1)
  ds_read_b128 v[80:83], v4 offset:29696
  v_smfmac_f32_16x16x64_bf16 v[92:95], v[68:71], a[240:247], v0
  ds_read_b128 v[60:63], v4 offset:26624
  v_smfmac_f32_16x16x64_bf16 v[96:99], v[104:107], a[200:207], v0
  ds_read_b128 v[64:67], v4 offset:27648
  v_smfmac_f32_16x16x64_bf16 v[96:99], v[108:111], a[232:239], v0
  ds_read_b128 v[28:31], v4 offset:30720
  s_nop 0
  v_cvt_pk_bf16_f32 v16, v92, v93
  v_cvt_pk_bf16_f32 v17, v94, v95
  v_bfi_b32 v16, 1, s57, v16
  v_smfmac_f32_16x16x64_bf16 v[96:99], v[68:71], a[248:255], v0
  buffer_store_dwordx2 v[16:17], v7, s[4:7], s20 offen offset:0 sc1
  v_smfmac_f32_16x16x64_bf16 v[36:39], v[104:107], a[208:215], v0
  ds_read_b128 v[32:35], v4 offset:31744
  v_smfmac_f32_16x16x64_bf16 v[36:39], v[108:111], v[52:59], v0
  s_waitcnt lgkmcnt(4)
  s_nop 0
  v_cvt_pk_bf16_f32 v18, v96, v97
  v_cvt_pk_bf16_f32 v19, v98, v99
  v_bfi_b32 v18, 1, s57, v18
  v_smfmac_f32_16x16x64_bf16 v[36:39], v[68:71], v[76:83], v0
  buffer_store_dwordx2 v[18:19], v7, s[4:7], s20 offen offset:64 sc1
  v_smfmac_f32_16x16x64_bf16 v[40:43], v[104:107], a[216:223], v0
  s_waitcnt lgkmcnt(2)
  ds_read_b128 v[116:119], v2 offset:31232
  v_smfmac_f32_16x16x64_bf16 v[40:43], v[108:111], v[60:67], v0
  s_waitcnt lgkmcnt(1)
  s_nop 0
  v_cvt_pk_bf16_f32 v20, v36, v37
  v_cvt_pk_bf16_f32 v21, v38, v39
  v_bfi_b32 v20, 1, s57, v20
  v_smfmac_f32_16x16x64_bf16 v[40:43], v[68:71], v[28:35], v0
  buffer_store_dwordx2 v[20:21], v7, s[4:7], s21 offen offset:0 sc1
  s_nop 6
  v_cvt_pk_bf16_f32 v22, v40, v41
  v_cvt_pk_bf16_f32 v23, v42, v43
  v_bfi_b32 v22, 1, s57, v22
  buffer_store_dwordx2 v[22:23], v7, s[4:7], s21 offen offset:64 sc1
  ds_read_b128 v[68:71], v4 offset:0
  ds_read_b128 v[72:75], v4 offset:1024
  ds_read_b128 v[76:79], v4 offset:4096
  ds_read_b128 v[80:83], v4 offset:5120
  ds_read_b128 v[84:87], v4 offset:8192
  ds_read_b128 v[88:91], v4 offset:9216
  v_mov_b64 v[16:17], 0
  v_mov_b64 v[18:19], 0
  v_mov_b64 v[20:21], 0
  v_mov_b64 v[22:23], 0
  v_mov_b64 v[24:25], 0
  v_mov_b64 v[26:27], 0
  s_mov_b32 s19, 0
  v_mov_b32 v49, -1
  s_waitcnt vmcnt(2)
  buffer_load_dwordx4 v[52:55], v2, s[4:7], s22 offen offset:0 sc1
  buffer_load_dwordx4 v[56:59], v2, s[4:7], s22 offen offset:1024 sc1
  buffer_load_dwordx4 v[60:63], v2, s[4:7], s22 offen offset:2048 sc1
  buffer_load_dwordx4 v[64:67], v2, s[4:7], s22 offen offset:3072 sc1
  ds_read_b128 v[92:95], v4 offset:2048
  ds_read_b128 v[96:99], v4 offset:3072
  ds_read_b128 v[100:103], v4 offset:6144
  ds_read_b128 v[104:107], v4 offset:7168
  ds_read_b128 v[108:111], v4 offset:10240
  ds_read_b128 v[112:115], v4 offset:11264
  ds_read_b64 v[44:45], v2 offset:32256
  s_waitcnt lgkmcnt(0)
  v_readfirstlane_b32 s38, v44
  v_readfirstlane_b32 s37, v45
  s_nop 0
  s_add_u32 s37, s37, 30
  s_cmp_ge_u32 s38, 30
  s_cselect_b32 s38, s37, s38
  s_cmp_ge_u32 s38, 64
  s_cselect_b32 s38, 100, s38
  s_sub_u32 s38, s38, 1
  s_max_i32 s30, s30, s38
  s_waitcnt lgkmcnt(12)
  s_waitcnt vmcnt(3)
  v_mfma_f32_16x16x32_bf16 v[120:123], v[116:119], v[52:55], 0
  v_xor_b32 v48, s57, v52
  v_bitop3_b32 v48, v48, v54, s57 bitop3:0xf6
  s_waitcnt vmcnt(2)
  v_mfma_f32_16x16x32_bf16 v[120:123], v[116:119], v[56:59], v[120:123]
  v_bitop3_b32 v48, v48, v56, s57 bitop3:0xf6
  v_bitop3_b32 v48, v48, v58, s57 bitop3:0xf6
  s_waitcnt vmcnt(1)
  v_mfma_f32_16x16x32_bf16 v[120:123], v[116:119], v[60:63], v[120:123]
  v_bitop3_b32 v48, v48, v60, s57 bitop3:0xf6
  v_bitop3_b32 v48, v48, v62, s57 bitop3:0xf6
  s_waitcnt vmcnt(0)
  v_mfma_f32_16x16x32_bf16 v[120:123], v[116:119], v[64:67], v[120:123]
  v_bitop3_b32 v48, v48, v64, s57 bitop3:0xf6
  v_bitop3_b32 v48, v48, v66, s57 bitop3:0xf6
  v_and_b32 v48, 1, v48
  v_cmp_ne_u32 vcc, 0, v48
  s_cbranch_vccnz T_p1re_155
T_p1ok_156:
  s_nop 2
  v_add_f32_dpp v120, v120, v120 row_ror:8 row_mask:0xf bank_mask:0xf
  v_add_f32_dpp v121, v121, v121 row_ror:8 row_mask:0xf bank_mask:0xf
  v_cvt_pk_bf16_f32 v48, v120, v121
  v_min_u32 v48, -2, v48
  buffer_store_dword v48, v8, s[4:7], s35 offen sc1
  buffer_store_dword v49, v8, s[4:7], s26 offen sc1
  s_barrier
  ds_read_b128 v[28:31], v2 offset:16384
  ds_read_b128 v[32:35], v2 offset:20480
  ds_read_b128 v[36:39], v2 offset:8192
  ds_read_b128 v[40:43], v2 offset:9216
  ds_read_b128 v[44:47], v2 offset:10240
  ds_read_b128 v[48:51], v2 offset:11264
  buffer_load_dwordx4 v[124:127], v3, s[4:7], s24 offen offset:0 sc1
  buffer_load_dwordx4 v[116:119], v3, s[4:7], s25 offen offset:0 sc1
  ds_read_b128 v[52:55], v2 offset:12288
  ds_read_b128 v[56:59], v2 offset:13312
  ds_read_b128 v[60:63], v2 offset:14336
  ds_read_b128 v[64:67], v2 offset:15360
  buffer_load_dwordx4 v[124:127], v3, s[4:7], s24 offen offset:0 sc1
  buffer_load_dwordx4 v[116:119], v3, s[4:7], s25 offen offset:0 sc1
  s_mov_b32 s19, 0
  s_branch T_loop_145
T_p1re_155:
  s_mov_b64 exec, vcc
  buffer_load_dwordx4 v[52:55], v2, s[4:7], s22 offen offset:0 sc1
  buffer_load_dwordx4 v[56:59], v2, s[4:7], s22 offen offset:1024 sc1
  buffer_load_dwordx4 v[60:63], v2, s[4:7], s22 offen offset:2048 sc1
  buffer_load_dwordx4 v[64:67], v2, s[4:7], s22 offen offset:3072 sc1
  s_mov_b64 exec, -1
  s_add_u32 s19, s19, 1
  s_cmp_gt_u32 s19, 32768
  s_cbranch_scc1 M_exit
  s_waitcnt vmcnt(3)
  v_mfma_f32_16x16x32_bf16 v[120:123], v[116:119], v[52:55], 0
  v_xor_b32 v48, s57, v52
  v_bitop3_b32 v48, v48, v54, s57 bitop3:0xf6
  s_waitcnt vmcnt(2)
  v_mfma_f32_16x16x32_bf16 v[120:123], v[116:119], v[56:59], v[120:123]
  v_bitop3_b32 v48, v48, v56, s57 bitop3:0xf6
  v_bitop3_b32 v48, v48, v58, s57 bitop3:0xf6
  s_waitcnt vmcnt(1)
  v_mfma_f32_16x16x32_bf16 v[120:123], v[116:119], v[60:63], v[120:123]
  v_bitop3_b32 v48, v48, v60, s57 bitop3:0xf6
  v_bitop3_b32 v48, v48, v62, s57 bitop3:0xf6
  s_waitcnt vmcnt(0)
  v_mfma_f32_16x16x32_bf16 v[120:123], v[116:119], v[64:67], v[120:123]
  v_bitop3_b32 v48, v48, v64, s57 bitop3:0xf6
  v_bitop3_b32 v48, v48, v66, s57 bitop3:0xf6
  v_and_b32 v48, 1, v48
  v_cmp_ne_u32 vcc, 0, v48
  s_cbranch_vccnz T_p1re_155
  s_branch T_p1ok_156
T_kvw_149:
  s_mov_b32 s19, 0
  s_branch T_kvok_158
T_kv_157:
  s_sleep 4
  s_add_u32 s19, s19, 1
  s_cmp_gt_u32 s19, 32768
  s_cbranch_scc1 M_exit
T_kvok_158:
  s_add_u32 s39, s99, 128
  s_mov_b32 s38, 0
  s_mov_b32 s37, 0
  s_atomic_or s38, s[58:59], s99 glc
  s_atomic_or s37, s[58:59], s39 glc
  s_waitcnt lgkmcnt(0)
  s_add_u32 s37, s37, 30
  s_cmp_ge_u32 s38, 30
  s_cselect_b32 s38, s37, s38
  s_cmp_ge_u32 s38, 64
  s_cselect_b32 s38, 100, s38
  s_sub_u32 s38, s38, 1
  s_max_i32 s30, s30, s38
  s_cmp_ge_i32 s14, s30
  s_cbranch_scc1 T_kv_157
  s_branch T_kvb_150
T_slow_152:
  s_nop 7
  v_max3_f32 v100, v16, v17, v18
  v_max3_f32 v100, v100, v19, v20
  v_max3_f32 v100, v100, v21, v22
  v_max3_f32 v100, v100, v23, v112
  v_max3_f32 v100, v100, v113, v114
  v_max_f32 v100, v100, v115
  v_mov_b32 v101, v100
  s_nop 1
  v_permlane32_swap_b32 v100, v101
  s_nop 1
  v_max_f32 v100, v100, v101
  v_mov_b32 v101, v100
  s_nop 1
  v_permlane16_swap_b32 v100, v101
  s_nop 1
  v_max_f32 v100, v100, v101
  v_sub_f32 v16, v16, v100
  v_sub_f32 v17, v17, v100
  v_sub_f32 v18, v18, v100
  v_sub_f32 v19, v19, v100
  v_exp_f32 v16, v16
  v_exp_f32 v17, v17
  v_exp_f32 v18, v18
  v_exp_f32 v19, v19
  v_sub_f32 v20, v20, v100
  v_sub_f32 v21, v21, v100
  v_sub_f32 v22, v22, v100
  v_sub_f32 v23, v23, v100
  v_exp_f32 v20, v20
  v_exp_f32 v21, v21
  v_exp_f32 v22, v22
  v_exp_f32 v23, v23
  v_sub_f32 v112, v112, v100
  v_sub_f32 v113, v113, v100
  v_sub_f32 v114, v114, v100
  v_sub_f32 v115, v115, v100
  v_exp_f32 v112, v112
  v_exp_f32 v113, v113
  v_exp_f32 v114, v114
  v_exp_f32 v115, v115
  s_nop 0
  v_cvt_pk_bf16_f32 v44, v16, v17
  v_cvt_pk_bf16_f32 v45, v18, v19
  v_cvt_pk_bf16_f32 v46, v20, v21
  v_cvt_pk_bf16_f32 v47, v22, v23
  v_cvt_pk_bf16_f32 v84, v112, v113
  v_cvt_pk_bf16_f32 v85, v114, v115
  v_cndmask_b32 v48, v84, 0, s[16:17]
  v_cndmask_b32 v49, v85, 0, s[16:17]
  v_cndmask_b32 v50, 0, v84, s[16:17]
  v_cndmask_b32 v51, 0, v85, s[16:17]
  s_nop 1
  v_mfma_f32_16x16x16_bf16 v[88:91], v[12:13], v[48:49], 0
  v_mfma_f32_16x16x16_bf16 v[24:27], v[120:121], v[48:49], 0
  v_mfma_f32_16x16x16_bf16 v[116:119], v[120:121], v[50:51], 0
  v_mfma_f32_16x16x32_bf16 v[88:91], v[12:15], v[44:47], v[88:91]
  v_mfma_f32_16x16x32_bf16 v[24:27], v[28:31], v[44:47], v[24:27]
  v_mfma_f32_16x16x32_bf16 v[116:119], v[32:35], v[44:47], v[116:119]
  s_nop 7
  s_nop 1
  v_rcp_f32 v89, v88
  s_nop 0
  v_mul_f32 v24, v89, v24
  v_mul_f32 v25, v89, v25
  s_branch T_back_153
T_w_142:
  s_mov_b32 s19, 0
  v_mov_b64 v[16:17], 0
  v_mov_b64 v[18:19], 0
  v_mov_b64 v[20:21], 0
  v_mov_b64 v[22:23], 0
  v_mov_b64 v[24:25], 0
  v_mov_b64 v[26:27], 0
  buffer_load_dwordx4 v[124:127], v3, s[4:7], s24 offen offset:1024 sc1
  buffer_load_dwordx4 v[116:119], v3, s[4:7], s25 offen offset:1024 sc1
  buffer_load_dwordx4 v[124:127], v3, s[4:7], s24 offen offset:1024 sc1
  buffer_load_dwordx4 v[116:119], v3, s[4:7], s25 offen offset:1024 sc1
  s_branch T_loop_159
.p2align 6
T_retry_160:
  s_mov_b64 exec, vcc
  buffer_load_dwordx4 v[124:127], v3, s[4:7], s24 offen offset:1024 sc1
  buffer_load_dwordx4 v[116:119], v3, s[4:7], s25 offen offset:1024 sc1
  s_mov_b64 exec, -1
  s_add_u32 s19, s19, 1
  s_cmp_gt_u32 s19, 32768
  s_cbranch_scc1 M_exit
T_loop_159:
  s_waitcnt vmcnt(3) lgkmcnt(0)
  v_max3_u32 v123, v124, v125, v126
  v_max_u32 v123, v123, v127
  v_mov_b32_dpp v120, v124 row_ror:8 row_mask:0xf bank_mask:0xf
  v_mov_b32_dpp v121, v125 row_ror:8 row_mask:0xf bank_mask:0xf
  s_waitcnt vmcnt(2)
  v_max3_u32 v123, v123, v116, v117
  v_max3_u32 v123, v123, v118, v119
  v_cmp_eq_u32 vcc, -1, v123
  s_cbranch_vccnz T_retry_160
  v_smfmac_f32_16x16x64_bf16 v[16:19], v[124:127], v[68:75], v0
  s_add_u32 s14, s14, 1
  ds_write_b128 v2, v[124:127] offset:1024
  v_mov_b32_dpp v122, v126 row_ror:8 row_mask:0xf bank_mask:0xf
  v_smfmac_f32_16x16x64_bf16 v[20:23], v[124:127], v[76:83], v0
  s_and_b32 s57, s14, 1
  v_mov_b32_dpp v123, v127 row_ror:8 row_mask:0xf bank_mask:0xf
  v_smfmac_f32_16x16x64_bf16 v[24:27], v[124:127], v[84:91], v0
  s_and_b32 s36, s14, 3
  ds_write_b128 v2, v[116:119] offset:5120
  v_smfmac_f32_16x16x64_bf16 v[16:19], v[120:123], v[92:99], v0
  s_lshl_b32 s36, s36, 13
  v_mov_b32_dpp v84, v116 row_ror:8 row_mask:0xf bank_mask:0xf
  v_smfmac_f32_16x16x64_bf16 v[20:23], v[120:123], v[100:107], v0
  s_add_u32 s26, s36, s23
  ds_read_b128 v[68:71], v4 offset:12288
  v_mov_b32_dpp v85, v117 row_ror:8 row_mask:0xf bank_mask:0xf
  v_smfmac_f32_16x16x64_bf16 v[24:27], v[120:123], v[108:115], v0
  s_add_u32 s36, s36, 8192
  ds_read_b128 v[72:75], v4 offset:13312
  v_mov_b32_dpp v86, v118 row_ror:8 row_mask:0xf bank_mask:0xf
  v_smfmac_f32_16x16x64_bf16 v[16:19], v[116:119], v[224:231], v0
  s_and_b32 s36, s36, 0x7fff
  ds_read_b128 v[76:79], v4 offset:14336
  v_mov_b32_dpp v87, v119 row_ror:8 row_mask:0xf bank_mask:0xf
  v_smfmac_f32_16x16x64_bf16 v[20:23], v[116:119], v[240:247], v0
  s_waitcnt lgkmcnt(3)
  s_barrier
  ds_read_b128 v[100:103], v2 offset:0
  v_smfmac_f32_16x16x64_bf16 v[24:27], v[116:119], a[0:7], v0
  s_mov_b32 m0, s31
  ds_read_b128 v[120:123], v1 offset:0
  v_smfmac_f32_16x16x64_bf16 v[16:19], v[84:87], v[232:239], v0
  s_cmp_ge_i32 s14, s30
  s_cbranch_scc1 T_kvw_163
T_kvb_164:
  v_smfmac_f32_16x16x64_bf16 v[20:23], v[84:87], v[248:255], v0
  ds_read_b128 v[80:83], v4 offset:15360
  v_smfmac_f32_16x16x64_bf16 v[24:27], v[84:87], a[8:15], v0
  s_waitcnt lgkmcnt(2)
  buffer_load_dwordx4 v9, s[4:7], s27 offen sc1 lds
  v_smfmac_f32_16x16x64_bf16 v[16:19], v[100:103], v[128:135], v0
  ds_read_b128 v[92:95], v2 offset:3072
  s_mov_b32 m0, s32
  v_smfmac_f32_16x16x64_bf16 v[20:23], v[100:103], v[144:151], v0
  ds_read_b128 v[96:99], v1 offset:3072
  v_smfmac_f32_16x16x64_bf16 v[24:27], v[100:103], v[68:75], v0
  s_waitcnt vmcnt(1) lgkmcnt(3)
  ds_read_b128 v[116:119], v2 offset:2048
  v_smfmac_f32_16x16x64_bf16 v[16:19], v[120:123], v[136:143], v0
  ds_read_b128 v[124:127], v1 offset:2048
  buffer_load_dwordx4 v9, s[4:7], s27 offen offset:128 sc1 lds
  v_smfmac_f32_16x16x64_bf16 v[20:23], v[120:123], v[152:159], v0
  s_waitcnt lgkmcnt(4)
  ds_read_b128 v[104:107], v2 offset:4096
  s_mov_b32 m0, s33
  v_smfmac_f32_16x16x64_bf16 v[24:27], v[120:123], v[76:83], v0
  s_waitcnt lgkmcnt(4)
  ds_read_b128 v[108:111], v1 offset:4096
  v_smfmac_f32_16x16x64_bf16 v[16:19], v[92:95], v[160:167], v0
  s_waitcnt lgkmcnt(4)
  ds_read_b128 v[112:115], v2 offset:7168
  v_smfmac_f32_16x16x64_bf16 v[16:19], v[96:99], v[168:175], v0
  s_waitcnt lgkmcnt(4)
  ds_read_b128 v[84:87], v1 offset:7168
  buffer_load_dwordx4 v10, s[4:7], s28 offen sc1 lds
  v_smfmac_f32_16x16x64_bf16 v[16:19], v[116:119], v[192:199], v0
  s_waitcnt lgkmcnt(4)
  ds_read_b128 v[88:91], v2 offset:6144
  s_mov_b32 m0, s34
  v_smfmac_f32_16x16x64_bf16 v[16:19], v[124:127], v[200:207], v0
  s_waitcnt lgkmcnt(4)
  ds_read_b128 v[100:103], v1 offset:6144
  v_smfmac_f32_16x16x64_bf16 v[16:19], v[104:107], a[16:23], v0
  s_waitcnt lgkmcnt(4)
  ds_read_b128 v[68:71], v4 offset:16384
  v_smfmac_f32_16x16x64_bf16 v[16:19], v[108:111], a[24:31], v0
  s_waitcnt lgkmcnt(4)
  ds_read_b128 v[72:75], v4 offset:17408
  buffer_load_dwordx4 v10, s[4:7], s28 offen offset:256 sc1 lds
  v_smfmac_f32_16x16x64_bf16 v[16:19], v[112:115], a[64:71], v0
  s_waitcnt lgkmcnt(4)
  ds_read_b128 v[76:79], v4 offset:18432
  v_smfmac_f32_16x16x64_bf16 v[16:19], v[84:87], a[72:79], v0
  s_waitcnt lgkmcnt(4)
  ds_read_b128 v[80:83], v4 offset:19456
  v_smfmac_f32_16x16x64_bf16 v[16:19], v[88:91], a[112:119], v0
  s_waitcnt lgkmcnt(4)
  v_smfmac_f32_16x16x64_bf16 v[16:19], v[100:103], a[120:127], v0
  s_add_u32 s24, s36, 145752064
  s_add_u32 s25, s36, 145756160
  v_smfmac_f32_16x16x64_bf16 v[20:23], v[92:95], v[176:183], v0
  s_add_u32 s35, s36, s23
  v_smfmac_f32_16x16x64_bf16 v[20:23], v[96:99], v[184:191], v0
  s_waitcnt lgkmcnt(2)
  v_smfmac_f32_16x16x64_bf16 v[20:23], v[116:119], v[68:75], v0
  s_waitcnt lgkmcnt(0)
  ds_read_b128 v[68:71], v4 offset:20480
  v_mul_f32 v16, s18, v16
  v_smfmac_f32_16x16x64_bf16 v[20:23], v[124:127], v[76:83], v0
  ds_read_b128 v[72:75], v4 offset:21504
  v_mul_f32 v17, s18, v17
  v_smfmac_f32_16x16x64_bf16 v[20:23], v[104:107], a[32:39], v0
  ds_read_b128 v[76:79], v4 offset:22528
  v_mul_f32 v18, s18, v18
  v_smfmac_f32_16x16x64_bf16 v[20:23], v[108:111], a[40:47], v0
  ds_read_b128 v[80:83], v4 offset:23552
  v_mul_f32 v19, s18, v19
  v_smfmac_f32_16x16x64_bf16 v[20:23], v[112:115], a[80:87], v0
  v_cvt_pk_bf16_f32 v120, v16, v17
  v_smfmac_f32_16x16x64_bf16 v[20:23], v[84:87], a[88:95], v0
  v_cvt_pk_bf16_f32 v121, v18, v19
  v_smfmac_f32_16x16x64_bf16 v[20:23], v[88:91], a[128:135], v0
  ds_write_b64 v5, v[120:121] offset:24576
  v_smfmac_f32_16x16x64_bf16 v[20:23], v[100:103], a[136:143], v0
  s_waitcnt lgkmcnt(3)
  v_smfmac_f32_16x16x64_bf16 v[24:27], v[92:95], v[68:75], v0
  s_waitcnt lgkmcnt(1)
  v_mov_b64 v[92:93], 0
  v_smfmac_f32_16x16x64_bf16 v[24:27], v[96:99], v[76:83], v0
  s_nop 1
  v_cvt_pk_bf16_f32 v122, v20, v21
  v_cvt_pk_bf16_f32 v123, v22, v23
  v_smfmac_f32_16x16x64_bf16 v[24:27], v[116:119], v[208:215], v0
  ds_write_b64 v5, v[122:123] offset:26880
  v_mov_b64 v[94:95], 0
  v_smfmac_f32_16x16x64_bf16 v[24:27], v[124:127], v[216:223], v0
  s_waitcnt lgkmcnt(1)
  s_barrier
  ds_read_b64_tr_b16 v[68:69], v6 offset:24576
  v_smfmac_f32_16x16x64_bf16 v[24:27], v[104:107], a[48:55], v0
  s_add_u32 s27, s27, 8192
  ds_read_b64_tr_b16 v[70:71], v6 offset:24640
  ds_read_b64_tr_b16 v[72:73], v6 offset:24832
  v_smfmac_f32_16x16x64_bf16 v[24:27], v[108:111], a[56:63], v0
  s_add_u32 s28, s28, 8192
  ds_read_b64_tr_b16 v[74:75], v6 offset:24896
  ds_read_b64_tr_b16 v[76:77], v6 offset:25088
  v_smfmac_f32_16x16x64_bf16 v[24:27], v[112:115], a[96:103], v0
  s_nop 0
  ds_read_b64_tr_b16 v[78:79], v6 offset:25152
  ds_read_b64_tr_b16 v[80:81], v6 offset:25344
  v_smfmac_f32_16x16x64_bf16 v[24:27], v[84:87], a[104:111], v0
  ds_read_b64_tr_b16 v[82:83], v6 offset:25408
  v_mov_b64 v[96:97], 0
  v_smfmac_f32_16x16x64_bf16 v[24:27], v[88:91], a[144:151], v0
  s_waitcnt lgkmcnt(8)
  s_barrier
  ds_read_b64_tr_b16 v[116:117], v6 offset:26880
  v_smfmac_f32_16x16x64_bf16 v[24:27], v[100:103], a[152:159], v0
  s_waitcnt lgkmcnt(7)
  ds_read_b64_tr_b16 v[118:119], v6 offset:26944
  v_mfma_f32_16x16x32_bf16 v[16:19], v[36:39], v[68:71], 0
  s_waitcnt lgkmcnt(6)
  ds_read_b64_tr_b16 v[124:125], v6 offset:27136
  ds_read_b64_tr_b16 v[126:127], v6 offset:27200
  v_mfma_f32_16x16x32_bf16 v[16:19], v[40:43], v[72:75], v[16:19]
  s_waitcnt lgkmcnt(6)
  ds_read_b64_tr_b16 v[104:105], v6 offset:27392
  ds_read_b64_tr_b16 v[106:107], v6 offset:27456
  v_mfma_f32_16x16x32_bf16 v[16:19], v[44:47], v[76:79], v[16:19]
  s_waitcnt lgkmcnt(6)
  ds_read_b64_tr_b16 v[108:109], v6 offset:27648
  ds_read_b64_tr_b16 v[110:111], v6 offset:27712
  v_mfma_f32_16x16x32_bf16 v[16:19], v[48:51], v[80:83], v[16:19]
  s_waitcnt lgkmcnt(6)
  v_cvt_pk_bf16_f32 v120, v24, v25
  v_cvt_pk_bf16_f32 v121, v26, v27
  v_mfma_f32_16x16x32_bf16 v[112:115], v[116:119], v[68:71], 0
  s_waitcnt lgkmcnt(4)
  buffer_store_dwordx4 v[120:123], v2, s[4:7], s29 offen offset:1024 sc1
  v_mov_b64 v[98:99], 0
  v_mfma_f32_16x16x32_bf16 v[112:115], v[124:127], v[72:75], v[112:115]
  s_waitcnt lgkmcnt(2)
  v_mov_b64 v[36:37], 0
  v_exp_f32 v100, v16
  v_mfma_f32_16x16x32_bf16 v[112:115], v[104:107], v[76:79], v[112:115]
  s_waitcnt lgkmcnt(0)
  v_exp_f32 v101, v17
  v_mfma_f32_16x16x32_bf16 v[112:115], v[108:111], v[80:83], v[112:115]
  s_add_u32 s29, s29, 131072
  v_exp_f32 v102, v18
  v_mfma_f32_16x16x32_bf16 v[20:23], v[52:55], v[68:71], 0
  s_cmp_eq_u32 s14, 63
  v_exp_f32 v103, v19
  v_mfma_f32_16x16x32_bf16 v[20:23], v[56:59], v[72:75], v[20:23]
  s_cbranch_scc1 M_tdone
  v_cvt_pk_bf16_f32 v44, v100, v101
  v_cvt_pk_bf16_f32 v45, v102, v103
  v_mfma_f32_16x16x32_bf16 v[20:23], v[60:63], v[76:79], v[20:23]
  v_exp_f32 v100, v112
  v_mfma_f32_16x16x32_bf16 v[20:23], v[64:67], v[80:83], v[20:23]
  v_exp_f32 v101, v113
  v_exp_f32 v102, v114
  v_exp_f32 v103, v115
  v_cvt_pk_bf16_f32 v84, v100, v101
  v_cvt_pk_bf16_f32 v85, v102, v103
  v_cndmask_b32 v48, v84, 0, s[16:17]
  v_cndmask_b32 v49, v85, 0, s[16:17]
  v_cndmask_b32 v50, 0, v84, s[16:17]
  v_cndmask_b32 v51, 0, v85, s[16:17]
  v_exp_f32 v100, v20
  v_mfma_f32_16x16x16_bf16 v[88:91], v[12:13], v[48:49], 0
  v_exp_f32 v101, v21
  v_mfma_f32_16x16x16_bf16 v[24:27], v[120:121], v[48:49], 0
  v_exp_f32 v102, v22
  v_mfma_f32_16x16x16_bf16 v[116:119], v[120:121], v[50:51], 0
  v_exp_f32 v103, v23
  v_cvt_pk_bf16_f32 v46, v100, v101
  v_cvt_pk_bf16_f32 v47, v102, v103
  v_mov_b64 v[38:39], 0
  s_nop 0
  v_mfma_f32_16x16x32_bf16 v[88:91], v[12:15], v[44:47], v[88:91]
  v_mov_b64 v[40:41], 0
  v_mov_b64 v[42:43], 0
  v_mfma_f32_16x16x32_bf16 v[24:27], v[28:31], v[44:47], v[24:27]
  ds_read_b128 v[52:55], v4 offset:24576
  ds_read_b128 v[56:59], v4 offset:25600
  v_mfma_f32_16x16x32_bf16 v[116:119], v[32:35], v[44:47], v[116:119]
  s_nop 1
  v_rcp_f32 v89, v88
  v_subrev_u32 v100, s54, v88
  v_cmp_le_u32 vcc, s55, v100
  v_mul_f32 v24, v89, v24
  v_mul_f32 v25, v89, v25
  s_cbranch_vccnz T_slow_166
T_back_167:
  v_cvt_pk_bf16_f32 v124, v24, v25
  v_pk_mul_f32 v[26:27], v[26:27], v[88:89] op_sel:[0,1] op_sel_hi:[1,1]
  v_pk_mul_f32 v[116:117], v[116:117], v[88:89] op_sel:[0,1] op_sel_hi:[1,1]
  v_pk_mul_f32 v[118:119], v[118:119], v[88:89] op_sel:[0,1] op_sel_hi:[1,1]
  v_cvt_pk_bf16_f32 v125, v26, v27
  v_cvt_pk_bf16_f32 v126, v116, v117
  v_cvt_pk_bf16_f32 v127, v118, v119
  ds_write_b128 v11, v[124:127] offset:29696
  s_nop 0
  v_smfmac_f32_16x16x64_bf16 v[92:95], v[124:127], a[160:167], v0
  v_smfmac_f32_16x16x64_bf16 v[96:99], v[124:127], a[168:175], v0
  v_smfmac_f32_16x16x64_bf16 v[36:39], v[124:127], a[176:183], v0
  v_smfmac_f32_16x16x64_bf16 v[40:43], v[124:127], a[184:191], v0
  s_waitcnt lgkmcnt(0)
  s_barrier
  ds_read_b128 v[104:107], v11 offset:29184
  ds_read_b128 v[108:111], v11 offset:30720
  ds_read_b128 v[68:71], v11 offset:30208
  s_waitcnt lgkmcnt(2)
  v_smfmac_f32_16x16x64_bf16 v[92:95], v[104:107], a[192:199], v0
  s_waitcnt lgkmcnt(1)
  ds_read_b128 v[76:79], v4 offset:28672
  v_smfmac_f32_16x16x64_bf16 v[92:95], v[108:111], a[224:231], v0
  s_waitcnt lgkmcnt(1)
  ds_read_b128 v[80:83], v4 offset:29696
  v_smfmac_f32_16x16x64_bf16 v[92:95], v[68:71], a[240:247], v0
  ds_read_b128 v[60:63], v4 offset:26624
  v_smfmac_f32_16x16x64_bf16 v[96:99], v[104:107], a[200:207], v0
  ds_read_b128 v[64:67], v4 offset:27648
  v_smfmac_f32_16x16x64_bf16 v[96:99], v[108:111], a[232:239], v0
  ds_read_b128 v[28:31], v4 offset:30720
  s_nop 0
  v_cvt_pk_bf16_f32 v16, v92, v93
  v_cvt_pk_bf16_f32 v17, v94, v95
  v_bfi_b32 v16, 1, s57, v16
  v_smfmac_f32_16x16x64_bf16 v[96:99], v[68:71], a[248:255], v0
  buffer_store_dwordx2 v[16:17], v7, s[4:7], s20 offen offset:0 sc1
  v_smfmac_f32_16x16x64_bf16 v[36:39], v[104:107], a[208:215], v0
  ds_read_b128 v[32:35], v4 offset:31744
  v_smfmac_f32_16x16x64_bf16 v[36:39], v[108:111], v[52:59], v0
  s_waitcnt lgkmcnt(4)
  s_nop 0
  v_cvt_pk_bf16_f32 v18, v96, v97
  v_cvt_pk_bf16_f32 v19, v98, v99
  v_bfi_b32 v18, 1, s57, v18
  v_smfmac_f32_16x16x64_bf16 v[36:39], v[68:71], v[76:83], v0
  buffer_store_dwordx2 v[18:19], v7, s[4:7], s20 offen offset:64 sc1
  v_smfmac_f32_16x16x64_bf16 v[40:43], v[104:107], a[216:223], v0
  s_waitcnt lgkmcnt(2)
  ds_read_b128 v[116:119], v2 offset:31232
  v_smfmac_f32_16x16x64_bf16 v[40:43], v[108:111], v[60:67], v0
  s_waitcnt lgkmcnt(1)
  s_nop 0
  v_cvt_pk_bf16_f32 v20, v36, v37
  v_cvt_pk_bf16_f32 v21, v38, v39
  v_bfi_b32 v20, 1, s57, v20
  v_smfmac_f32_16x16x64_bf16 v[40:43], v[68:71], v[28:35], v0
  buffer_store_dwordx2 v[20:21], v7, s[4:7], s21 offen offset:0 sc1
  s_nop 6
  v_cvt_pk_bf16_f32 v22, v40, v41
  v_cvt_pk_bf16_f32 v23, v42, v43
  v_bfi_b32 v22, 1, s57, v22
  buffer_store_dwordx2 v[22:23], v7, s[4:7], s21 offen offset:64 sc1
  ds_read_b128 v[68:71], v4 offset:0
  ds_read_b128 v[72:75], v4 offset:1024
  ds_read_b128 v[76:79], v4 offset:4096
  ds_read_b128 v[80:83], v4 offset:5120
  ds_read_b128 v[84:87], v4 offset:8192
  ds_read_b128 v[88:91], v4 offset:9216
  ds_read_b128 v[92:95], v4 offset:2048
  ds_read_b128 v[96:99], v4 offset:3072
  ds_read_b128 v[100:103], v4 offset:6144
  ds_read_b128 v[104:107], v4 offset:7168
  ds_read_b128 v[108:111], v4 offset:10240
  ds_read_b128 v[112:115], v4 offset:11264
  v_mov_b64 v[16:17], 0
  v_mov_b64 v[18:19], 0
  v_mov_b64 v[20:21], 0
  v_mov_b64 v[22:23], 0
  v_mov_b64 v[24:25], 0
  v_mov_b64 v[26:27], 0
  s_mov_b32 s19, 0
  v_mov_b32 v49, -1
  ds_read_b64 v[44:45], v2 offset:32256
  s_waitcnt lgkmcnt(0)
  v_readfirstlane_b32 s38, v44
  v_readfirstlane_b32 s37, v45
  s_nop 0
  s_add_u32 s37, s37, 30
  s_cmp_ge_u32 s38, 30
  s_cselect_b32 s38, s37, s38
  s_cmp_ge_u32 s38, 64
  s_cselect_b32 s38, 100, s38
  s_sub_u32 s38, s38, 1
  s_max_i32 s30, s30, s38
  s_waitcnt vmcnt(0)
  buffer_load_dwordx4 v[52:55], v2, s[4:7], s22 offen offset:0 sc1
  buffer_load_dwordx4 v[56:59], v2, s[4:7], s22 offen offset:1024 sc1
  buffer_load_dwordx4 v[60:63], v2, s[4:7], s22 offen offset:2048 sc1
  buffer_load_dwordx4 v[64:67], v2, s[4:7], s22 offen offset:3072 sc1
  s_waitcnt lgkmcnt(12)
  s_waitcnt vmcnt(3)
  v_mfma_f32_16x16x32_bf16 v[120:123], v[116:119], v[52:55], 0
  v_xor_b32 v48, s57, v52
  v_bitop3_b32 v48, v48, v54, s57 bitop3:0xf6
  s_waitcnt vmcnt(2)
  v_mfma_f32_16x16x32_bf16 v[120:123], v[116:119], v[56:59], v[120:123]
  v_bitop3_b32 v48, v48, v56, s57 bitop3:0xf6
  v_bitop3_b32 v48, v48, v58, s57 bitop3:0xf6
  s_waitcnt vmcnt(1)
  v_mfma_f32_16x16x32_bf16 v[120:123], v[116:119], v[60:63], v[120:123]
  v_bitop3_b32 v48, v48, v60, s57 bitop3:0xf6
  v_bitop3_b32 v48, v48, v62, s57 bitop3:0xf6
  s_waitcnt vmcnt(0)
  v_mfma_f32_16x16x32_bf16 v[120:123], v[116:119], v[64:67], v[120:123]
  v_bitop3_b32 v48, v48, v64, s57 bitop3:0xf6
  v_bitop3_b32 v48, v48, v66, s57 bitop3:0xf6
  v_and_b32 v48, 1, v48
  v_cmp_ne_u32 vcc, 0, v48
  s_cbranch_vccnz T_p1re_169
T_p1ok_170:
  s_nop 2
  v_add_f32_dpp v120, v120, v120 row_ror:8 row_mask:0xf bank_mask:0xf
  v_add_f32_dpp v121, v121, v121 row_ror:8 row_mask:0xf bank_mask:0xf
  v_cvt_pk_bf16_f32 v48, v120, v121
  v_min_u32 v48, -2, v48
  buffer_store_dword v48, v8, s[4:7], s35 offen sc1
  buffer_store_dword v49, v8, s[4:7], s26 offen sc1
  s_barrier
  ds_read_b128 v[28:31], v2 offset:17408
  ds_read_b128 v[32:35], v2 offset:21504
  ds_read_b128 v[36:39], v2 offset:8192
  ds_read_b128 v[40:43], v2 offset:9216
  ds_read_b128 v[44:47], v2 offset:10240
  ds_read_b128 v[48:51], v2 offset:11264
  buffer_load_dwordx4 v[124:127], v3, s[4:7], s24 offen offset:1024 sc1
  buffer_load_dwordx4 v[116:119], v3, s[4:7], s25 offen offset:1024 sc1
  ds_read_b128 v[52:55], v2 offset:12288
  ds_read_b128 v[56:59], v2 offset:13312
  ds_read_b128 v[60:63], v2 offset:14336
  ds_read_b128 v[64:67], v2 offset:15360
  buffer_load_dwordx4 v[124:127], v3, s[4:7], s24 offen offset:1024 sc1
  buffer_load_dwordx4 v[116:119], v3, s[4:7], s25 offen offset:1024 sc1
  s_mov_b32 s19, 0
  s_branch T_loop_159
T_p1re_169:
  s_mov_b64 exec, vcc
  buffer_load_dwordx4 v[52:55], v2, s[4:7], s22 offen offset:0 sc1
  buffer_load_dwordx4 v[56:59], v2, s[4:7], s22 offen offset:1024 sc1
  buffer_load_dwordx4 v[60:63], v2, s[4:7], s22 offen offset:2048 sc1
  buffer_load_dwordx4 v[64:67], v2, s[4:7], s22 offen offset:3072 sc1
  s_mov_b64 exec, -1
  s_add_u32 s19, s19, 1
  s_cmp_gt_u32 s19, 32768
  s_cbranch_scc1 M_exit
  s_waitcnt vmcnt(3)
  v_mfma_f32_16x16x32_bf16 v[120:123], v[116:119], v[52:55], 0
  v_xor_b32 v48, s57, v52
  v_bitop3_b32 v48, v48, v54, s57 bitop3:0xf6
  s_waitcnt vmcnt(2)
  v_mfma_f32_16x16x32_bf16 v[120:123], v[116:119], v[56:59], v[120:123]
  v_bitop3_b32 v48, v48, v56, s57 bitop3:0xf6
  v_bitop3_b32 v48, v48, v58, s57 bitop3:0xf6
  s_waitcnt vmcnt(1)
  v_mfma_f32_16x16x32_bf16 v[120:123], v[116:119], v[60:63], v[120:123]
  v_bitop3_b32 v48, v48, v60, s57 bitop3:0xf6
  v_bitop3_b32 v48, v48, v62, s57 bitop3:0xf6
  s_waitcnt vmcnt(0)
  v_mfma_f32_16x16x32_bf16 v[120:123], v[116:119], v[64:67], v[120:123]
  v_bitop3_b32 v48, v48, v64, s57 bitop3:0xf6
  v_bitop3_b32 v48, v48, v66, s57 bitop3:0xf6
  v_and_b32 v48, 1, v48
  v_cmp_ne_u32 vcc, 0, v48
  s_cbranch_vccnz T_p1re_169
  s_branch T_p1ok_170
T_kvw_163:
  s_mov_b32 s19, 0
  s_branch T_kvok_172
T_kv_171:
  s_sleep 4
  s_add_u32 s19, s19, 1
  s_cmp_gt_u32 s19, 32768
  s_cbranch_scc1 M_exit
T_kvok_172:
  s_add_u32 s39, s99, 128
  s_mov_b32 s38, 0
  s_mov_b32 s37, 0
  s_atomic_or s38, s[58:59], s99 glc
  s_atomic_or s37, s[58:59], s39 glc
  s_waitcnt lgkmcnt(0)
  s_add_u32 s37, s37, 30
  s_cmp_ge_u32 s38, 30
  s_cselect_b32 s38, s37, s38
  s_cmp_ge_u32 s38, 64
  s_cselect_b32 s38, 100, s38
  s_sub_u32 s38, s38, 1
  s_max_i32 s30, s30, s38
  s_cmp_ge_i32 s14, s30
  s_cbranch_scc1 T_kv_171
  s_branch T_kvb_164
T_slow_166:
  s_nop 7
  v_max3_f32 v100, v16, v17, v18
  v_max3_f32 v100, v100, v19, v20
  v_max3_f32 v100, v100, v21, v22
  v_max3_f32 v100, v100, v23, v112
  v_max3_f32 v100, v100, v113, v114
  v_max_f32 v100, v100, v115
  v_mov_b32 v101, v100
  s_nop 1
  v_permlane32_swap_b32 v100, v101
  s_nop 1
  v_max_f32 v100, v100, v101
  v_mov_b32 v101, v100
  s_nop 1
  v_permlane16_swap_b32 v100, v101
  s_nop 1
  v_max_f32 v100, v100, v101
  v_sub_f32 v16, v16, v100
  v_sub_f32 v17, v17, v100
  v_sub_f32 v18, v18, v100
  v_sub_f32 v19, v19, v100
  v_exp_f32 v16, v16
  v_exp_f32 v17, v17
  v_exp_f32 v18, v18
  v_exp_f32 v19, v19
  v_sub_f32 v20, v20, v100
  v_sub_f32 v21, v21, v100
  v_sub_f32 v22, v22, v100
  v_sub_f32 v23, v23, v100
  v_exp_f32 v20, v20
  v_exp_f32 v21, v21
  v_exp_f32 v22, v22
  v_exp_f32 v23, v23
  v_sub_f32 v112, v112, v100
  v_sub_f32 v113, v113, v100
  v_sub_f32 v114, v114, v100
  v_sub_f32 v115, v115, v100
  v_exp_f32 v112, v112
  v_exp_f32 v113, v113
  v_exp_f32 v114, v114
  v_exp_f32 v115, v115
  s_nop 0
  v_cvt_pk_bf16_f32 v44, v16, v17
  v_cvt_pk_bf16_f32 v45, v18, v19
  v_cvt_pk_bf16_f32 v46, v20, v21
  v_cvt_pk_bf16_f32 v47, v22, v23
  v_cvt_pk_bf16_f32 v84, v112, v113
  v_cvt_pk_bf16_f32 v85, v114, v115
  v_cndmask_b32 v48, v84, 0, s[16:17]
  v_cndmask_b32 v49, v85, 0, s[16:17]
  v_cndmask_b32 v50, 0, v84, s[16:17]
  v_cndmask_b32 v51, 0, v85, s[16:17]
  s_nop 1
  v_mfma_f32_16x16x16_bf16 v[88:91], v[12:13], v[48:49], 0
  v_mfma_f32_16x16x16_bf16 v[24:27], v[120:121], v[48:49], 0
  v_mfma_f32_16x16x16_bf16 v[116:119], v[120:121], v[50:51], 0
  v_mfma_f32_16x16x32_bf16 v[88:91], v[12:15], v[44:47], v[88:91]
  v_mfma_f32_16x16x32_bf16 v[24:27], v[28:31], v[44:47], v[24:27]
  v_mfma_f32_16x16x32_bf16 v[116:119], v[32:35], v[44:47], v[116:119]
  s_nop 7
  s_nop 1
  v_rcp_f32 v89, v88
  s_nop 0
  v_mul_f32 v24, v89, v24
  v_mul_f32 v25, v89, v25
  s_branch T_back_167
T_w_143:
  s_mov_b32 s19, 0
  v_mov_b64 v[16:17], 0
  v_mov_b64 v[18:19], 0
  v_mov_b64 v[20:21], 0
  v_mov_b64 v[22:23], 0
  v_mov_b64 v[24:25], 0
  v_mov_b64 v[26:27], 0
  buffer_load_dwordx4 v[124:127], v3, s[4:7], s24 offen offset:2048 sc1
  buffer_load_dwordx4 v[116:119], v3, s[4:7], s25 offen offset:2048 sc1
  buffer_load_dwordx4 v[124:127], v3, s[4:7], s24 offen offset:2048 sc1
  buffer_load_dwordx4 v[116:119], v3, s[4:7], s25 offen offset:2048 sc1
  s_branch T_loop_173
.p2align 6
T_retry_174:
  s_mov_b64 exec, vcc
  buffer_load_dwordx4 v[124:127], v3, s[4:7], s24 offen offset:2048 sc1
  buffer_load_dwordx4 v[116:119], v3, s[4:7], s25 offen offset:2048 sc1
  s_mov_b64 exec, -1
  s_add_u32 s19, s19, 1
  s_cmp_gt_u32 s19, 32768
  s_cbranch_scc1 M_exit
T_loop_173:
  s_waitcnt vmcnt(3) lgkmcnt(0)
  v_max3_u32 v123, v124, v125, v126
  v_max_u32 v123, v123, v127
  v_mov_b32_dpp v120, v124 row_ror:8 row_mask:0xf bank_mask:0xf
  v_mov_b32_dpp v121, v125 row_ror:8 row_mask:0xf bank_mask:0xf
  s_waitcnt vmcnt(2)
  v_max3_u32 v123, v123, v116, v117
  v_max3_u32 v123, v123, v118, v119
  v_cmp_eq_u32 vcc, -1, v123
  s_cbranch_vccnz T_retry_174
  v_smfmac_f32_16x16x64_bf16 v[16:19], v[124:127], v[68:75], v0
  s_add_u32 s14, s14, 1
  ds_write_b128 v2, v[124:127] offset:2048
  v_mov_b32_dpp v122, v126 row_ror:8 row_mask:0xf bank_mask:0xf
  v_smfmac_f32_16x16x64_bf16 v[20:23], v[124:127], v[76:83], v0
  s_and_b32 s57, s14, 1
  v_mov_b32_dpp v123, v127 row_ror:8 row_mask:0xf bank_mask:0xf
  v_smfmac_f32_16x16x64_bf16 v[24:27], v[124:127], v[84:91], v0
  s_and_b32 s36, s14, 3
  ds_write_b128 v2, v[116:119] offset:6144
  v_smfmac_f32_16x16x64_bf16 v[16:19], v[120:123], v[92:99], v0
  s_lshl_b32 s36, s36, 13
  v_mov_b32_dpp v84, v116 row_ror:8 row_mask:0xf bank_mask:0xf
  v_smfmac_f32_16x16x64_bf16 v[20:23], v[120:123], v[100:107], v0
  s_add_u32 s26, s36, s23
  ds_read_b128 v[68:71], v4 offset:12288
  v_mov_b32_dpp v85, v117 row_ror:8 row_mask:0xf bank_mask:0xf
  v_smfmac_f32_16x16x64_bf16 v[24:27], v[120:123], v[108:115], v0
  s_add_u32 s36, s36, 8192
  ds_read_b128 v[72:75], v4 offset:13312
  v_mov_b32_dpp v86, v118 row_ror:8 row_mask:0xf bank_mask:0xf
  v_smfmac_f32_16x16x64_bf16 v[16:19], v[116:119], v[224:231], v0
  s_and_b32 s36, s36, 0x7fff
  ds_read_b128 v[76:79], v4 offset:14336
  v_mov_b32_dpp v87, v119 row_ror:8 row_mask:0xf bank_mask:0xf
  v_smfmac_f32_16x16x64_bf16 v[20:23], v[116:119], v[240:247], v0
  s_waitcnt lgkmcnt(3)
  s_barrier
  ds_read_b128 v[100:103], v2 offset:3072
  v_smfmac_f32_16x16x64_bf16 v[24:27], v[116:119], a[0:7], v0
  s_mov_b32 m0, s31
  ds_read_b128 v[120:123], v1 offset:3072
  v_smfmac_f32_16x16x64_bf16 v[16:19], v[84:87], v[232:239], v0
  s_cmp_ge_i32 s14, s30
  s_cbranch_scc1 T_kvw_177
T_kvb_178:
  v_smfmac_f32_16x16x64_bf16 v[20:23], v[84:87], v[248:255], v0
  ds_read_b128 v[80:83], v4 offset:15360
  v_smfmac_f32_16x16x64_bf16 v[24:27], v[84:87], a[8:15], v0
  s_waitcnt lgkmcnt(2)
  v_smfmac_f32_16x16x64_bf16 v[16:19], v[100:103], v[128:135], v0
  ds_read_b128 v[92:95], v2 offset:0
  buffer_load_dwordx4 v9, s[4:7], s27 offen sc1 lds
  v_smfmac_f32_16x16x64_bf16 v[20:23], v[100:103], v[144:151], v0
  ds_read_b128 v[96:99], v1 offset:0
  s_mov_b32 m0, s32
  v_smfmac_f32_16x16x64_bf16 v[24:27], v[100:103], v[68:75], v0
  s_waitcnt vmcnt(1) lgkmcnt(3)
  ds_read_b128 v[116:119], v2 offset:1024
  v_smfmac_f32_16x16x64_bf16 v[16:19], v[120:123], v[136:143], v0
  ds_read_b128 v[124:127], v1 offset:1024
  v_smfmac_f32_16x16x64_bf16 v[20:23], v[120:123], v[152:159], v0
  s_waitcnt lgkmcnt(4)
  ds_read_b128 v[104:107], v2 offset:7168
  buffer_load_dwordx4 v9, s[4:7], s27 offen offset:128 sc1 lds
  v_smfmac_f32_16x16x64_bf16 v[24:27], v[120:123], v[76:83], v0
  s_waitcnt lgkmcnt(4)
  ds_read_b128 v[108:111], v1 offset:7168
  s_mov_b32 m0, s33
  v_smfmac_f32_16x16x64_bf16 v[16:19], v[92:95], v[160:167], v0
  s_waitcnt lgkmcnt(4)
  ds_read_b128 v[112:115], v2 offset:4096
  v_mov_b32 v122, s98
  v_smfmac_f32_16x16x64_bf16 v[16:19], v[96:99], v[168:175], v0
  s_waitcnt lgkmcnt(4)
  ds_read_b128 v[84:87], v1 offset:4096
  v_smfmac_f32_16x16x64_bf16 v[16:19], v[116:119], v[192:199], v0
  s_waitcnt lgkmcnt(4)
  ds_read_b128 v[88:91], v2 offset:5120
  buffer_load_dwordx4 v10, s[4:7], s28 offen sc1 lds
  v_smfmac_f32_16x16x64_bf16 v[16:19], v[124:127], v[200:207], v0
  s_waitcnt lgkmcnt(4)
  ds_read_b128 v[100:103], v1 offset:5120
  s_mov_b32 m0, s34
  v_smfmac_f32_16x16x64_bf16 v[16:19], v[104:107], a[16:23], v0
  s_waitcnt lgkmcnt(4)
  ds_read_b128 v[68:71], v4 offset:16384
  v_smfmac_f32_16x16x64_bf16 v[16:19], v[108:111], a[24:31], v0
  s_waitcnt lgkmcnt(4)
  ds_read_b128 v[72:75], v4 offset:17408
  v_smfmac_f32_16x16x64_bf16 v[16:19], v[112:115], a[64:71], v0
  s_waitcnt lgkmcnt(4)
  ds_read_b128 v[76:79], v4 offset:18432
  buffer_load_dwordx4 v10, s[4:7], s28 offen offset:256 sc1 lds
  v_smfmac_f32_16x16x64_bf16 v[16:19], v[84:87], a[72:79], v0
  s_waitcnt lgkmcnt(4)
  ds_read_b128 v[80:83], v4 offset:19456
  v_smfmac_f32_16x16x64_bf16 v[16:19], v[88:91], a[112:119], v0
  s_waitcnt lgkmcnt(4)
  v_smfmac_f32_16x16x64_bf16 v[16:19], v[100:103], a[120:127], v0
  s_add_u32 s24, s36, 145752064
  s_add_u32 s25, s36, 145756160
  v_smfmac_f32_16x16x64_bf16 v[20:23], v[92:95], v[176:183], v0
  buffer_store_dword v122, v8, s[4:7], s15 offen sc1
  s_add_u32 s35, s36, s23
  v_smfmac_f32_16x16x64_bf16 v[20:23], v[96:99], v[184:191], v0
  s_waitcnt lgkmcnt(2)
  s_add_u32 s98, s14, 1
  v_smfmac_f32_16x16x64_bf16 v[20:23], v[116:119], v[68:75], v0
  s_waitcnt lgkmcnt(0)
  ds_read_b128 v[68:71], v4 offset:20480
  v_mul_f32 v16, s18, v16
  v_smfmac_f32_16x16x64_bf16 v[20:23], v[124:127], v[76:83], v0
  ds_read_b128 v[72:75], v4 offset:21504
  v_mul_f32 v17, s18, v17
  v_smfmac_f32_16x16x64_bf16 v[20:23], v[104:107], a[32:39], v0
  ds_read_b128 v[76:79], v4 offset:22528
  v_mul_f32 v18, s18, v18
  v_smfmac_f32_16x16x64_bf16 v[20:23], v[108:111], a[40:47], v0
  ds_read_b128 v[80:83], v4 offset:23552
  v_mul_f32 v19, s18, v19
  v_smfmac_f32_16x16x64_bf16 v[20:23], v[112:115], a[80:87], v0
  v_cvt_pk_bf16_f32 v120, v16, v17
  v_smfmac_f32_16x16x64_bf16 v[20:23], v[84:87], a[88:95], v0
  v_cvt_pk_bf16_f32 v121, v18, v19
  v_smfmac_f32_16x16x64_bf16 v[20:23], v[88:91], a[128:135], v0
  ds_write_b64 v5, v[120:121] offset:24576
  v_smfmac_f32_16x16x64_bf16 v[20:23], v[100:103], a[136:143], v0
  s_waitcnt lgkmcnt(3)
  v_smfmac_f32_16x16x64_bf16 v[24:27], v[92:95], v[68:75], v0
  s_waitcnt lgkmcnt(1)
  v_mov_b64 v[92:93], 0
  v_smfmac_f32_16x16x64_bf16 v[24:27], v[96:99], v[76:83], v0
  s_nop 1
  v_cvt_pk_bf16_f32 v122, v20, v21
  v_cvt_pk_bf16_f32 v123, v22, v23
  v_smfmac_f32_16x16x64_bf16 v[24:27], v[116:119], v[208:215], v0
  ds_write_b64 v5, v[122:123] offset:26880
  v_mov_b64 v[94:95], 0
  v_smfmac_f32_16x16x64_bf16 v[24:27], v[124:127], v[216:223], v0
  s_waitcnt lgkmcnt(1)
  s_barrier
  ds_read_b64_tr_b16 v[68:69], v6 offset:24576
  v_smfmac_f32_16x16x64_bf16 v[24:27], v[104:107], a[48:55], v0
  s_add_u32 s27, s27, 8192
  ds_read_b64_tr_b16 v[70:71], v6 offset:24640
  ds_read_b64_tr_b16 v[72:73], v6 offset:24832
  v_smfmac_f32_16x16x64_bf16 v[24:27], v[108:111], a[56:63], v0
  s_add_u32 s28, s28, 8192
  ds_read_b64_tr_b16 v[74:75], v6 offset:24896
  ds_read_b64_tr_b16 v[76:77], v6 offset:25088
  v_smfmac_f32_16x16x64_bf16 v[24:27], v[112:115], a[96:103], v0
  s_nop 0
  ds_read_b64_tr_b16 v[78:79], v6 offset:25152
  ds_read_b64_tr_b16 v[80:81], v6 offset:25344
  v_smfmac_f32_16x16x64_bf16 v[24:27], v[84:87], a[104:111], v0
  ds_read_b64_tr_b16 v[82:83], v6 offset:25408
  v_mov_b64 v[96:97], 0
  v_smfmac_f32_16x16x64_bf16 v[24:27], v[88:91], a[144:151], v0
  s_waitcnt lgkmcnt(8)
  s_barrier
  ds_read_b64_tr_b16 v[116:117], v6 offset:26880
  v_smfmac_f32_16x16x64_bf16 v[24:27], v[100:103], a[152:159], v0
  s_waitcnt lgkmcnt(7)
  ds_read_b64_tr_b16 v[118:119], v6 offset:26944
  v_mfma_f32_16x16x32_bf16 v[16:19], v[36:39], v[68:71], 0
  s_waitcnt lgkmcnt(6)
  ds_read_b64_tr_b16 v[124:125], v6 offset:27136
  ds_read_b64_tr_b16 v[126:127], v6 offset:27200
  v_mfma_f32_16x16x32_bf16 v[16:19], v[40:43], v[72:75], v[16:19]
  s_waitcnt lgkmcnt(6)
  ds_read_b64_tr_b16 v[104:105], v6 offset:27392
  ds_read_b64_tr_b16 v[106:107], v6 offset:27456
  v_mfma_f32_16x16x32_bf16 v[16:19], v[44:47], v[76:79], v[16:19]
  s_waitcnt lgkmcnt(6)
  ds_read_b64_tr_b16 v[108:109], v6 offset:27648
  ds_read_b64_tr_b16 v[110:111], v6 offset:27712
  v_mfma_f32_16x16x32_bf16 v[16:19], v[48:51], v[80:83], v[16:19]
  s_waitcnt lgkmcnt(6)
  v_cvt_pk_bf16_f32 v120, v24, v25
  v_cvt_pk_bf16_f32 v121, v26, v27
  v_mfma_f32_16x16x32_bf16 v[112:115], v[116:119], v[68:71], 0
  s_waitcnt lgkmcnt(4)
  buffer_store_dwordx4 v[120:123], v2, s[4:7], s29 offen offset:2048 sc1
  v_mov_b64 v[98:99], 0
  v_mfma_f32_16x16x32_bf16 v[112:115], v[124:127], v[72:75], v[112:115]
  s_waitcnt lgkmcnt(2)
  v_mov_b64 v[36:37], 0
  v_exp_f32 v100, v16
  v_mfma_f32_16x16x32_bf16 v[112:115], v[104:107], v[76:79], v[112:115]
  s_waitcnt lgkmcnt(0)
  v_exp_f32 v101, v17
  v_mfma_f32_16x16x32_bf16 v[112:115], v[108:111], v[80:83], v[112:115]
  s_add_u32 s29, s29, 131072
  v_exp_f32 v102, v18
  v_mfma_f32_16x16x32_bf16 v[20:23], v[52:55], v[68:71], 0
  s_cmp_eq_u32 s14, 63
  v_exp_f32 v103, v19
  v_mfma_f32_16x16x32_bf16 v[20:23], v[56:59], v[72:75], v[20:23]
  s_cbranch_scc1 M_tdone
  v_cvt_pk_bf16_f32 v44, v100, v101
  v_cvt_pk_bf16_f32 v45, v102, v103
  v_mfma_f32_16x16x32_bf16 v[20:23], v[60:63], v[76:79], v[20:23]
  v_exp_f32 v100, v112
  v_mfma_f32_16x16x32_bf16 v[20:23], v[64:67], v[80:83], v[20:23]
  v_exp_f32 v101, v113
  v_exp_f32 v102, v114
  v_exp_f32 v103, v115
  v_cvt_pk_bf16_f32 v84, v100, v101
  v_cvt_pk_bf16_f32 v85, v102, v103
  v_cndmask_b32 v48, v84, 0, s[16:17]
  v_cndmask_b32 v49, v85, 0, s[16:17]
  v_cndmask_b32 v50, 0, v84, s[16:17]
  v_cndmask_b32 v51, 0, v85, s[16:17]
  v_exp_f32 v100, v20
  v_mfma_f32_16x16x16_bf16 v[88:91], v[12:13], v[48:49], 0
  v_exp_f32 v101, v21
  v_mfma_f32_16x16x16_bf16 v[24:27], v[120:121], v[48:49], 0
  v_exp_f32 v102, v22
  v_mfma_f32_16x16x16_bf16 v[116:119], v[120:121], v[50:51], 0
  v_exp_f32 v103, v23
  v_cvt_pk_bf16_f32 v46, v100, v101
  v_cvt_pk_bf16_f32 v47, v102, v103
  v_mov_b64 v[38:39], 0
  s_nop 0
  v_mfma_f32_16x16x32_bf16 v[88:91], v[12:15], v[44:47], v[88:91]
  v_mov_b64 v[40:41], 0
  v_mov_b64 v[42:43], 0
  v_mfma_f32_16x16x32_bf16 v[24:27], v[28:31], v[44:47], v[24:27]
  ds_read_b128 v[52:55], v4 offset:24576
  ds_read_b128 v[56:59], v4 offset:25600
  v_mfma_f32_16x16x32_bf16 v[116:119], v[32:35], v[44:47], v[116:119]
  s_nop 1
  v_rcp_f32 v89, v88
  v_subrev_u32 v100, s54, v88
  v_cmp_le_u32 vcc, s55, v100
  v_mul_f32 v24, v89, v24
  v_mul_f32 v25, v89, v25
  s_cbranch_vccnz T_slow_180
T_back_181:
  v_cvt_pk_bf16_f32 v124, v24, v25
  v_pk_mul_f32 v[26:27], v[26:27], v[88:89] op_sel:[0,1] op_sel_hi:[1,1]
  v_pk_mul_f32 v[116:117], v[116:117], v[88:89] op_sel:[0,1] op_sel_hi:[1,1]
  v_pk_mul_f32 v[118:119], v[118:119], v[88:89] op_sel:[0,1] op_sel_hi:[1,1]
  v_cvt_pk_bf16_f32 v125, v26, v27
  v_cvt_pk_bf16_f32 v126, v116, v117
  v_cvt_pk_bf16_f32 v127, v118, v119
  ds_write_b128 v11, v[124:127] offset:30208
  s_nop 0
  v_smfmac_f32_16x16x64_bf16 v[92:95], v[124:127], a[160:167], v0
  v_smfmac_f32_16x16x64_bf16 v[96:99], v[124:127], a[168:175], v0
  v_smfmac_f32_16x16x64_bf16 v[36:39], v[124:127], a[176:183], v0
  v_smfmac_f32_16x16x64_bf16 v[40:43], v[124:127], a[184:191], v0
  s_waitcnt lgkmcnt(0)
  s_barrier
  ds_read_b128 v[104:107], v11 offset:30720
  ds_read_b128 v[108:111], v11 offset:29184
  ds_read_b128 v[68:71], v11 offset:29696
  s_waitcnt lgkmcnt(2)
  v_smfmac_f32_16x16x64_bf16 v[92:95], v[104:107], a[192:199], v0
  s_waitcnt lgkmcnt(1)
  ds_read_b128 v[76:79], v4 offset:28672
  v_smfmac_f32_16x16x64_bf16 v[92:95], v[108:111], a[224:231], v0
  s_waitcnt lgkmcnt(1)
  ds_read_b128 v[80:83], v4 offset:29696
  v_smfmac_f32_16x16x64_bf16 v[92:95], v[68:71], a[240:247], v0
  ds_read_b128 v[60:63], v4 offset:26624
  v_smfmac_f32_16x16x64_bf16 v[96:99], v[104:107], a[200:207], v0
  ds_read_b128 v[64:67], v4 offset:27648
  v_smfmac_f32_16x16x64_bf16 v[96:99], v[108:111], a[232:239], v0
  ds_read_b128 v[28:31], v4 offset:30720
  s_nop 0
  v_cvt_pk_bf16_f32 v16, v92, v93
  v_cvt_pk_bf16_f32 v17, v94, v95
  v_bfi_b32 v16, 1, s57, v16
  v_smfmac_f32_16x16x64_bf16 v[96:99], v[68:71], a[248:255], v0
  buffer_store_dwordx2 v[16:17], v7, s[4:7], s20 offen offset:0 sc1
  v_smfmac_f32_16x16x64_bf16 v[36:39], v[104:107], a[208:215], v0
  ds_read_b128 v[32:35], v4 offset:31744
  v_smfmac_f32_16x16x64_bf16 v[36:39], v[108:111], v[52:59], v0
  s_waitcnt lgkmcnt(4)
  s_nop 0
  v_cvt_pk_bf16_f32 v18, v96, v97
  v_cvt_pk_bf16_f32 v19, v98, v99
  v_bfi_b32 v18, 1, s57, v18
  v_smfmac_f32_16x16x64_bf16 v[36:39], v[68:71], v[76:83], v0
  buffer_store_dwordx2 v[18:19], v7, s[4:7], s20 offen offset:64 sc1
  v_smfmac_f32_16x16x64_bf16 v[40:43], v[104:107], a[216:223], v0
  s_waitcnt lgkmcnt(2)
  v_smfmac_f32_16x16x64_bf16 v[40:43], v[108:111], v[60:67], v0
  s_waitcnt lgkmcnt(0)
  s_nop 0
  v_cvt_pk_bf16_f32 v20, v36, v37
  v_cvt_pk_bf16_f32 v21, v38, v39
  v_bfi_b32 v20, 1, s57, v20
  v_smfmac_f32_16x16x64_bf16 v[40:43], v[68:71], v[28:35], v0
  buffer_store_dwordx2 v[20:21], v7, s[4:7], s21 offen offset:0 sc1
  s_nop 6
  v_cvt_pk_bf16_f32 v22, v40, v41
  v_cvt_pk_bf16_f32 v23, v42, v43
  v_bfi_b32 v22, 1, s57, v22
  buffer_store_dwordx2 v[22:23], v7, s[4:7], s21 offen offset:64 sc1
  ds_read_b128 v[68:71], v4 offset:0
  ds_read_b128 v[72:75], v4 offset:1024
  ds_read_b128 v[76:79], v4 offset:4096
  ds_read_b128 v[80:83], v4 offset:5120
  ds_read_b128 v[84:87], v4 offset:8192
  ds_read_b128 v[88:91], v4 offset:9216
  ds_read_b128 v[92:95], v4 offset:2048
  ds_read_b128 v[96:99], v4 offset:3072
  ds_read_b128 v[100:103], v4 offset:6144
  ds_read_b128 v[104:107], v4 offset:7168
  ds_read_b128 v[108:111], v4 offset:10240
  ds_read_b128 v[112:115], v4 offset:11264
  v_mov_b64 v[16:17], 0
  v_mov_b64 v[18:19], 0
  v_mov_b64 v[20:21], 0
  v_mov_b64 v[22:23], 0
  v_mov_b64 v[24:25], 0
  v_mov_b64 v[26:27], 0
  ds_read_b64 v[44:45], v2 offset:32256
  s_waitcnt lgkmcnt(0)
  v_readfirstlane_b32 s38, v44
  v_readfirstlane_b32 s37, v45
  s_nop 0
  s_add_u32 s37, s37, 30
  s_cmp_ge_u32 s38, 30
  s_cselect_b32 s38, s37, s38
  s_cmp_ge_u32 s38, 64
  s_cselect_b32 s38, 100, s38
  s_sub_u32 s38, s38, 1
  s_max_i32 s30, s30, s38
  s_waitcnt vmcnt(4)
  s_barrier
  ds_read_b128 v[28:31], v2 offset:18432
  ds_read_b128 v[32:35], v2 offset:22528
  ds_read_b128 v[36:39], v2 offset:8192
  ds_read_b128 v[40:43], v2 offset:9216
  ds_read_b128 v[44:47], v2 offset:10240
  ds_read_b128 v[48:51], v2 offset:11264
  buffer_load_dwordx4 v[124:127], v3, s[4:7], s24 offen offset:2048 sc1
  buffer_load_dwordx4 v[116:119], v3, s[4:7], s25 offen offset:2048 sc1
  ds_read_b128 v[52:55], v2 offset:12288
  ds_read_b128 v[56:59], v2 offset:13312
  ds_read_b128 v[60:63], v2 offset:14336
  ds_read_b128 v[64:67], v2 offset:15360
  buffer_load_dwordx4 v[124:127], v3, s[4:7], s24 offen offset:2048 sc1
  buffer_load_dwordx4 v[116:119], v3, s[4:7], s25 offen offset:2048 sc1
  s_mov_b32 s19, 0
  s_branch T_loop_173
T_kvw_177:
  s_mov_b32 s19, 0
  s_branch T_kvok_186
T_kv_185:
  s_sleep 4
  s_add_u32 s19, s19, 1
  s_cmp_gt_u32 s19, 32768
  s_cbranch_scc1 M_exit
T_kvok_186:
  s_add_u32 s39, s99, 128
  s_mov_b32 s38, 0
  s_mov_b32 s37, 0
  s_atomic_or s38, s[58:59], s99 glc
  s_atomic_or s37, s[58:59], s39 glc
  s_waitcnt lgkmcnt(0)
  s_add_u32 s37, s37, 30
  s_cmp_ge_u32 s38, 30
  s_cselect_b32 s38, s37, s38
  s_cmp_ge_u32 s38, 64
  s_cselect_b32 s38, 100, s38
  s_sub_u32 s38, s38, 1
  s_max_i32 s30, s30, s38
  s_cmp_ge_i32 s14, s30
  s_cbranch_scc1 T_kv_185
  s_branch T_kvb_178
T_slow_180:
  s_nop 7
  v_max3_f32 v100, v16, v17, v18
  v_max3_f32 v100, v100, v19, v20
  v_max3_f32 v100, v100, v21, v22
  v_max3_f32 v100, v100, v23, v112
  v_max3_f32 v100, v100, v113, v114
  v_max_f32 v100, v100, v115
  v_mov_b32 v101, v100
  s_nop 1
  v_permlane32_swap_b32 v100, v101
  s_nop 1
  v_max_f32 v100, v100, v101
  v_mov_b32 v101, v100
  s_nop 1
  v_permlane16_swap_b32 v100, v101
  s_nop 1
  v_max_f32 v100, v100, v101
  v_sub_f32 v16, v16, v100
  v_sub_f32 v17, v17, v100
  v_sub_f32 v18, v18, v100
  v_sub_f32 v19, v19, v100
  v_exp_f32 v16, v16
  v_exp_f32 v17, v17
  v_exp_f32 v18, v18
  v_exp_f32 v19, v19
  v_sub_f32 v20, v20, v100
  v_sub_f32 v21, v21, v100
  v_sub_f32 v22, v22, v100
  v_sub_f32 v23, v23, v100
  v_exp_f32 v20, v20
  v_exp_f32 v21, v21
  v_exp_f32 v22, v22
  v_exp_f32 v23, v23
  v_sub_f32 v112, v112, v100
  v_sub_f32 v113, v113, v100
  v_sub_f32 v114, v114, v100
  v_sub_f32 v115, v115, v100
  v_exp_f32 v112, v112
  v_exp_f32 v113, v113
  v_exp_f32 v114, v114
  v_exp_f32 v115, v115
  s_nop 0
  v_cvt_pk_bf16_f32 v44, v16, v17
  v_cvt_pk_bf16_f32 v45, v18, v19
  v_cvt_pk_bf16_f32 v46, v20, v21
  v_cvt_pk_bf16_f32 v47, v22, v23
  v_cvt_pk_bf16_f32 v84, v112, v113
  v_cvt_pk_bf16_f32 v85, v114, v115
  v_cndmask_b32 v48, v84, 0, s[16:17]
  v_cndmask_b32 v49, v85, 0, s[16:17]
  v_cndmask_b32 v50, 0, v84, s[16:17]
  v_cndmask_b32 v51, 0, v85, s[16:17]
  s_nop 1
  v_mfma_f32_16x16x16_bf16 v[88:91], v[12:13], v[48:49], 0
  v_mfma_f32_16x16x16_bf16 v[24:27], v[120:121], v[48:49], 0
  v_mfma_f32_16x16x16_bf16 v[116:119], v[120:121], v[50:51], 0
  v_mfma_f32_16x16x32_bf16 v[88:91], v[12:15], v[44:47], v[88:91]
  v_mfma_f32_16x16x32_bf16 v[24:27], v[28:31], v[44:47], v[24:27]
  v_mfma_f32_16x16x32_bf16 v[116:119], v[32:35], v[44:47], v[116:119]
  s_nop 7
  s_nop 1
  v_rcp_f32 v89, v88
  s_nop 0
  v_mul_f32 v24, v89, v24
  v_mul_f32 v25, v89, v25
  s_branch T_back_181
T_w_144:
  s_mov_b32 s19, 0
  v_mov_b64 v[16:17], 0
  v_mov_b64 v[18:19], 0
  v_mov_b64 v[20:21], 0
  v_mov_b64 v[22:23], 0
  v_mov_b64 v[24:25], 0
  v_mov_b64 v[26:27], 0
  buffer_load_dwordx4 v[124:127], v3, s[4:7], s24 offen offset:3072 sc1
  buffer_load_dwordx4 v[116:119], v3, s[4:7], s25 offen offset:3072 sc1
  buffer_load_dwordx4 v[124:127], v3, s[4:7], s24 offen offset:3072 sc1
  buffer_load_dwordx4 v[116:119], v3, s[4:7], s25 offen offset:3072 sc1
  s_branch T_loop_187
.p2align 6
T_retry_188:
  s_mov_b64 exec, vcc
  buffer_load_dwordx4 v[124:127], v3, s[4:7], s24 offen offset:3072 sc1
  buffer_load_dwordx4 v[116:119], v3, s[4:7], s25 offen offset:3072 sc1
  s_mov_b64 exec, -1
  s_add_u32 s19, s19, 1
  s_cmp_gt_u32 s19, 32768
  s_cbranch_scc1 M_exit
T_loop_187:
  s_waitcnt vmcnt(3) lgkmcnt(0)
  v_max3_u32 v123, v124, v125, v126
  v_max_u32 v123, v123, v127
  v_mov_b32_dpp v120, v124 row_ror:8 row_mask:0xf bank_mask:0xf
  v_mov_b32_dpp v121, v125 row_ror:8 row_mask:0xf bank_mask:0xf
  s_waitcnt vmcnt(2)
  v_max3_u32 v123, v123, v116, v117
  v_max3_u32 v123, v123, v118, v119
  v_cmp_eq_u32 vcc, -1, v123
  s_cbranch_vccnz T_retry_188
  v_smfmac_f32_16x16x64_bf16 v[16:19], v[124:127], v[68:75], v0
  s_add_u32 s14, s14, 1
  ds_write_b128 v2, v[124:127] offset:3072
  v_mov_b32_dpp v122, v126 row_ror:8 row_mask:0xf bank_mask:0xf
  v_smfmac_f32_16x16x64_bf16 v[20:23], v[124:127], v[76:83], v0
  s_and_b32 s57, s14, 1
  v_mov_b32_dpp v123, v127 row_ror:8 row_mask:0xf bank_mask:0xf
  v_smfmac_f32_16x16x64_bf16 v[24:27], v[124:127], v[84:91], v0
  s_and_b32 s36, s14, 3
  ds_write_b128 v2, v[116:119] offset:7168
  v_smfmac_f32_16x16x64_bf16 v[16:19], v[120:123], v[92:99], v0
  s_lshl_b32 s36, s36, 13
  v_mov_b32_dpp v84, v116 row_ror:8 row_mask:0xf bank_mask:0xf
  v_smfmac_f32_16x16x64_bf16 v[20:23], v[120:123], v[100:107], v0
  s_add_u32 s26, s36, s23
  ds_read_b128 v[68:71], v4 offset:12288
  v_mov_b32_dpp v85, v117 row_ror:8 row_mask:0xf bank_mask:0xf
  v_smfmac_f32_16x16x64_bf16 v[24:27], v[120:123], v[108:115], v0
  s_add_u32 s36, s36, 8192
  ds_read_b128 v[72:75], v4 offset:13312
  v_mov_b32_dpp v86, v118 row_ror:8 row_mask:0xf bank_mask:0xf
  v_smfmac_f32_16x16x64_bf16 v[16:19], v[116:119], v[224:231], v0
  s_and_b32 s36, s36, 0x7fff
  ds_read_b128 v[76:79], v4 offset:14336
  v_mov_b32_dpp v87, v119 row_ror:8 row_mask:0xf bank_mask:0xf
  v_smfmac_f32_16x16x64_bf16 v[20:23], v[116:119], v[240:247], v0
  s_waitcnt lgkmcnt(3)
  s_barrier
  ds_read_b128 v[100:103], v2 offset:2048
  v_smfmac_f32_16x16x64_bf16 v[24:27], v[116:119], a[0:7], v0
  s_mov_b32 m0, s31
  ds_read_b128 v[120:123], v1 offset:2048
  v_smfmac_f32_16x16x64_bf16 v[16:19], v[84:87], v[232:239], v0
  s_cmp_ge_i32 s14, s30
  s_cbranch_scc1 T_kvw_191
T_kvb_192:
  v_smfmac_f32_16x16x64_bf16 v[20:23], v[84:87], v[248:255], v0
  ds_read_b128 v[80:83], v4 offset:15360
  v_smfmac_f32_16x16x64_bf16 v[24:27], v[84:87], a[8:15], v0
  s_waitcnt lgkmcnt(2)
  v_smfmac_f32_16x16x64_bf16 v[16:19], v[100:103], v[128:135], v0
  ds_read_b128 v[92:95], v2 offset:1024
  v_smfmac_f32_16x16x64_bf16 v[20:23], v[100:103], v[144:151], v0
  ds_read_b128 v[96:99], v1 offset:1024
  buffer_load_dwordx4 v9, s[4:7], s27 offen sc1 lds
  v_smfmac_f32_16x16x64_bf16 v[24:27], v[100:103], v[68:75], v0
  s_waitcnt vmcnt(1) lgkmcnt(3)
  ds_read_b128 v[116:119], v2 offset:0
  s_mov_b32 m0, s32
  v_smfmac_f32_16x16x64_bf16 v[16:19], v[120:123], v[136:143], v0
  ds_read_b128 v[124:127], v1 offset:0
  v_smfmac_f32_16x16x64_bf16 v[20:23], v[120:123], v[152:159], v0
  s_waitcnt lgkmcnt(4)
  ds_read_b128 v[104:107], v2 offset:6144
  v_smfmac_f32_16x16x64_bf16 v[24:27], v[120:123], v[76:83], v0
  s_waitcnt lgkmcnt(4)
  ds_read_b128 v[108:111], v1 offset:6144
  buffer_load_dwordx4 v9, s[4:7], s27 offen offset:128 sc1 lds
  v_smfmac_f32_16x16x64_bf16 v[16:19], v[92:95], v[160:167], v0
  s_waitcnt lgkmcnt(4)
  ds_read_b128 v[112:115], v2 offset:5120
  s_mov_b32 m0, s33
  v_smfmac_f32_16x16x64_bf16 v[16:19], v[96:99], v[168:175], v0
  s_waitcnt lgkmcnt(4)
  ds_read_b128 v[84:87], v1 offset:5120
  v_smfmac_f32_16x16x64_bf16 v[16:19], v[116:119], v[192:199], v0
  s_waitcnt lgkmcnt(4)
  ds_read_b128 v[88:91], v2 offset:4096
  v_smfmac_f32_16x16x64_bf16 v[16:19], v[124:127], v[200:207], v0
  s_waitcnt lgkmcnt(4)
  ds_read_b128 v[100:103], v1 offset:4096
  buffer_load_dwordx4 v10, s[4:7], s28 offen sc1 lds
  v_smfmac_f32_16x16x64_bf16 v[16:19], v[104:107], a[16:23], v0
  s_waitcnt lgkmcnt(4)
  ds_read_b128 v[68:71], v4 offset:16384
  s_mov_b32 m0, s34
  v_smfmac_f32_16x16x64_bf16 v[16:19], v[108:111], a[24:31], v0
  s_waitcnt lgkmcnt(4)
  ds_read_b128 v[72:75], v4 offset:17408
  v_smfmac_f32_16x16x64_bf16 v[16:19], v[112:115], a[64:71], v0
  s_waitcnt lgkmcnt(4)
  ds_read_b128 v[76:79], v4 offset:18432
  v_smfmac_f32_16x16x64_bf16 v[16:19], v[84:87], a[72:79], v0
  s_waitcnt lgkmcnt(4)
  ds_read_b128 v[80:83], v4 offset:19456
  buffer_load_dwordx4 v10, s[4:7], s28 offen offset:256 sc1 lds
  v_smfmac_f32_16x16x64_bf16 v[16:19], v[88:91], a[112:119], v0
  s_waitcnt lgkmcnt(4)
  s_mov_b32 m0, 32256
  v_smfmac_f32_16x16x64_bf16 v[16:19], v[100:103], a[120:127], v0
  s_add_u32 s24, s36, 145752064
  s_add_u32 s25, s36, 145756160
  v_smfmac_f32_16x16x64_bf16 v[20:23], v[92:95], v[176:183], v0
  s_add_u32 s35, s36, s23
  v_smfmac_f32_16x16x64_bf16 v[20:23], v[96:99], v[184:191], v0
  s_waitcnt lgkmcnt(2)
  buffer_load_dword v8, s[4:7], s99 offen sc1 lds
  v_smfmac_f32_16x16x64_bf16 v[20:23], v[116:119], v[68:75], v0
  s_waitcnt lgkmcnt(0)
  ds_read_b128 v[68:71], v4 offset:20480
  v_mul_f32 v16, s18, v16
  v_smfmac_f32_16x16x64_bf16 v[20:23], v[124:127], v[76:83], v0
  ds_read_b128 v[72:75], v4 offset:21504
  v_mul_f32 v17, s18, v17
  v_smfmac_f32_16x16x64_bf16 v[20:23], v[104:107], a[32:39], v0
  ds_read_b128 v[76:79], v4 offset:22528
  v_mul_f32 v18, s18, v18
  v_smfmac_f32_16x16x64_bf16 v[20:23], v[108:111], a[40:47], v0
  ds_read_b128 v[80:83], v4 offset:23552
  v_mul_f32 v19, s18, v19
  v_smfmac_f32_16x16x64_bf16 v[20:23], v[112:115], a[80:87], v0
  v_cvt_pk_bf16_f32 v120, v16, v17
  v_smfmac_f32_16x16x64_bf16 v[20:23], v[84:87], a[88:95], v0
  v_cvt_pk_bf16_f32 v121, v18, v19
  v_smfmac_f32_16x16x64_bf16 v[20:23], v[88:91], a[128:135], v0
  ds_write_b64 v5, v[120:121] offset:24576
  v_smfmac_f32_16x16x64_bf16 v[20:23], v[100:103], a[136:143], v0
  s_waitcnt lgkmcnt(3)
  v_smfmac_f32_16x16x64_bf16 v[24:27], v[92:95], v[68:75], v0
  s_waitcnt lgkmcnt(1)
  v_mov_b64 v[92:93], 0
  v_smfmac_f32_16x16x64_bf16 v[24:27], v[96:99], v[76:83], v0
  s_nop 1
  v_cvt_pk_bf16_f32 v122, v20, v21
  v_cvt_pk_bf16_f32 v123, v22, v23
  v_smfmac_f32_16x16x64_bf16 v[24:27], v[116:119], v[208:215], v0
  ds_write_b64 v5, v[122:123] offset:26880
  v_mov_b64 v[94:95], 0
  v_smfmac_f32_16x16x64_bf16 v[24:27], v[124:127], v[216:223], v0
  s_waitcnt lgkmcnt(1)
  s_barrier
  ds_read_b64_tr_b16 v[68:69], v6 offset:24576
  v_smfmac_f32_16x16x64_bf16 v[24:27], v[104:107], a[48:55], v0
  s_add_u32 s27, s27, 8192
  ds_read_b64_tr_b16 v[70:71], v6 offset:24640
  ds_read_b64_tr_b16 v[72:73], v6 offset:24832
  v_smfmac_f32_16x16x64_bf16 v[24:27], v[108:111], a[56:63], v0
  s_add_u32 s28, s28, 8192
  ds_read_b64_tr_b16 v[74:75], v6 offset:24896
  ds_read_b64_tr_b16 v[76:77], v6 offset:25088
  v_smfmac_f32_16x16x64_bf16 v[24:27], v[112:115], a[96:103], v0
  s_nop 0
  ds_read_b64_tr_b16 v[78:79], v6 offset:25152
  ds_read_b64_tr_b16 v[80:81], v6 offset:25344
  v_smfmac_f32_16x16x64_bf16 v[24:27], v[84:87], a[104:111], v0
  ds_read_b64_tr_b16 v[82:83], v6 offset:25408
  v_mov_b64 v[96:97], 0
  v_smfmac_f32_16x16x64_bf16 v[24:27], v[88:91], a[144:151], v0
  s_waitcnt lgkmcnt(8)
  s_barrier
  ds_read_b64_tr_b16 v[116:117], v6 offset:26880
  v_smfmac_f32_16x16x64_bf16 v[24:27], v[100:103], a[152:159], v0
  s_waitcnt lgkmcnt(7)
  ds_read_b64_tr_b16 v[118:119], v6 offset:26944
  v_mfma_f32_16x16x32_bf16 v[16:19], v[36:39], v[68:71], 0
  s_waitcnt lgkmcnt(6)
  ds_read_b64_tr_b16 v[124:125], v6 offset:27136
  ds_read_b64_tr_b16 v[126:127], v6 offset:27200
  v_mfma_f32_16x16x32_bf16 v[16:19], v[40:43], v[72:75], v[16:19]
  s_waitcnt lgkmcnt(6)
  ds_read_b64_tr_b16 v[104:105], v6 offset:27392
  ds_read_b64_tr_b16 v[106:107], v6 offset:27456
  v_mfma_f32_16x16x32_bf16 v[16:19], v[44:47], v[76:79], v[16:19]
  s_waitcnt lgkmcnt(6)
  ds_read_b64_tr_b16 v[108:109], v6 offset:27648
  ds_read_b64_tr_b16 v[110:111], v6 offset:27712
  v_mfma_f32_16x16x32_bf16 v[16:19], v[48:51], v[80:83], v[16:19]
  s_waitcnt lgkmcnt(6)
  v_cvt_pk_bf16_f32 v120, v24, v25
  v_cvt_pk_bf16_f32 v121, v26, v27
  v_mfma_f32_16x16x32_bf16 v[112:115], v[116:119], v[68:71], 0
  s_waitcnt lgkmcnt(4)
  buffer_store_dwordx4 v[120:123], v2, s[4:7], s29 offen offset:3072 sc1
  v_mov_b64 v[98:99], 0
  v_mfma_f32_16x16x32_bf16 v[112:115], v[124:127], v[72:75], v[112:115]
  s_waitcnt lgkmcnt(2)
  v_mov_b64 v[36:37], 0
  v_exp_f32 v100, v16
  v_mfma_f32_16x16x32_bf16 v[112:115], v[104:107], v[76:79], v[112:115]
  s_waitcnt lgkmcnt(0)
  v_exp_f32 v101, v17
  v_mfma_f32_16x16x32_bf16 v[112:115], v[108:111], v[80:83], v[112:115]
  s_add_u32 s29, s29, 131072
  v_exp_f32 v102, v18
  v_mfma_f32_16x16x32_bf16 v[20:23], v[52:55], v[68:71], 0
  s_cmp_eq_u32 s14, 63
  v_exp_f32 v103, v19
  v_mfma_f32_16x16x32_bf16 v[20:23], v[56:59], v[72:75], v[20:23]
  s_cbranch_scc1 M_tdone
  v_cvt_pk_bf16_f32 v44, v100, v101
  v_cvt_pk_bf16_f32 v45, v102, v103
  v_mfma_f32_16x16x32_bf16 v[20:23], v[60:63], v[76:79], v[20:23]
  v_exp_f32 v100, v112
  v_mfma_f32_16x16x32_bf16 v[20:23], v[64:67], v[80:83], v[20:23]
  v_exp_f32 v101, v113
  v_exp_f32 v102, v114
  v_exp_f32 v103, v115
  v_cvt_pk_bf16_f32 v84, v100, v101
  v_cvt_pk_bf16_f32 v85, v102, v103
  v_cndmask_b32 v48, v84, 0, s[16:17]
  v_cndmask_b32 v49, v85, 0, s[16:17]
  v_cndmask_b32 v50, 0, v84, s[16:17]
  v_cndmask_b32 v51, 0, v85, s[16:17]
  v_exp_f32 v100, v20
  v_mfma_f32_16x16x16_bf16 v[88:91], v[12:13], v[48:49], 0
  v_exp_f32 v101, v21
  v_mfma_f32_16x16x16_bf16 v[24:27], v[120:121], v[48:49], 0
  v_exp_f32 v102, v22
  v_mfma_f32_16x16x16_bf16 v[116:119], v[120:121], v[50:51], 0
  v_exp_f32 v103, v23
  v_cvt_pk_bf16_f32 v46, v100, v101
  v_cvt_pk_bf16_f32 v47, v102, v103
  v_mov_b64 v[38:39], 0
  s_nop 0
  v_mfma_f32_16x16x32_bf16 v[88:91], v[12:15], v[44:47], v[88:91]
  v_mov_b64 v[40:41], 0
  v_mov_b64 v[42:43], 0
  v_mfma_f32_16x16x32_bf16 v[24:27], v[28:31], v[44:47], v[24:27]
  ds_read_b128 v[52:55], v4 offset:24576
  ds_read_b128 v[56:59], v4 offset:25600
  v_mfma_f32_16x16x32_bf16 v[116:119], v[32:35], v[44:47], v[116:119]
  s_nop 1
  v_rcp_f32 v89, v88
  v_subrev_u32 v100, s54, v88
  v_cmp_le_u32 vcc, s55, v100
  v_mul_f32 v24, v89, v24
  v_mul_f32 v25, v89, v25
  s_cbranch_vccnz T_slow_194
T_back_195:
  v_cvt_pk_bf16_f32 v124, v24, v25
  v_pk_mul_f32 v[26:27], v[26:27], v[88:89] op_sel:[0,1] op_sel_hi:[1,1]
  v_pk_mul_f32 v[116:117], v[116:117], v[88:89] op_sel:[0,1] op_sel_hi:[1,1]
  v_pk_mul_f32 v[118:119], v[118:119], v[88:89] op_sel:[0,1] op_sel_hi:[1,1]
  v_cvt_pk_bf16_f32 v125, v26, v27
  v_cvt_pk_bf16_f32 v126, v116, v117
  v_cvt_pk_bf16_f32 v127, v118, v119
  ds_write_b128 v11, v[124:127] offset:30720
  s_nop 0
  v_smfmac_f32_16x16x64_bf16 v[92:95], v[124:127], a[160:167], v0
  v_smfmac_f32_16x16x64_bf16 v[96:99], v[124:127], a[168:175], v0
  v_smfmac_f32_16x16x64_bf16 v[36:39], v[124:127], a[176:183], v0
  v_smfmac_f32_16x16x64_bf16 v[40:43], v[124:127], a[184:191], v0
  s_waitcnt lgkmcnt(0)
  s_barrier
  ds_read_b128 v[104:107], v11 offset:30208
  ds_read_b128 v[108:111], v11 offset:29696
  ds_read_b128 v[68:71], v11 offset:29184
  s_waitcnt lgkmcnt(2)
  v_smfmac_f32_16x16x64_bf16 v[92:95], v[104:107], a[192:199], v0
  s_waitcnt lgkmcnt(1)
  ds_read_b128 v[76:79], v4 offset:28672
  v_smfmac_f32_16x16x64_bf16 v[92:95], v[108:111], a[224:231], v0
  s_waitcnt lgkmcnt(1)
  ds_read_b128 v[80:83], v4 offset:29696
  v_smfmac_f32_16x16x64_bf16 v[92:95], v[68:71], a[240:247], v0
  ds_read_b128 v[60:63], v4 offset:26624
  v_smfmac_f32_16x16x64_bf16 v[96:99], v[104:107], a[200:207], v0
  ds_read_b128 v[64:67], v4 offset:27648
  v_smfmac_f32_16x16x64_bf16 v[96:99], v[108:111], a[232:239], v0
  ds_read_b128 v[28:31], v4 offset:30720
  s_nop 0
  v_cvt_pk_bf16_f32 v16, v92, v93
  v_cvt_pk_bf16_f32 v17, v94, v95
  v_bfi_b32 v16, 1, s57, v16
  v_smfmac_f32_16x16x64_bf16 v[96:99], v[68:71], a[248:255], v0
  buffer_store_dwordx2 v[16:17], v7, s[4:7], s20 offen offset:0 sc1
  v_smfmac_f32_16x16x64_bf16 v[36:39], v[104:107], a[208:215], v0
  ds_read_b128 v[32:35], v4 offset:31744
  v_smfmac_f32_16x16x64_bf16 v[36:39], v[108:111], v[52:59], v0
  s_waitcnt lgkmcnt(4)
  s_nop 0
  v_cvt_pk_bf16_f32 v18, v96, v97
  v_cvt_pk_bf16_f32 v19, v98, v99
  v_bfi_b32 v18, 1, s57, v18
  v_smfmac_f32_16x16x64_bf16 v[36:39], v[68:71], v[76:83], v0
  buffer_store_dwordx2 v[18:19], v7, s[4:7], s20 offen offset:64 sc1
  v_smfmac_f32_16x16x64_bf16 v[40:43], v[104:107], a[216:223], v0
  s_waitcnt lgkmcnt(2)
  v_smfmac_f32_16x16x64_bf16 v[40:43], v[108:111], v[60:67], v0
  s_waitcnt lgkmcnt(0)
  s_nop 0
  v_cvt_pk_bf16_f32 v20, v36, v37
  v_cvt_pk_bf16_f32 v21, v38, v39
  v_bfi_b32 v20, 1, s57, v20
  v_smfmac_f32_16x16x64_bf16 v[40:43], v[68:71], v[28:35], v0
  buffer_store_dwordx2 v[20:21], v7, s[4:7], s21 offen offset:0 sc1
  s_nop 6
  v_cvt_pk_bf16_f32 v22, v40, v41
  v_cvt_pk_bf16_f32 v23, v42, v43
  v_bfi_b32 v22, 1, s57, v22
  buffer_store_dwordx2 v[22:23], v7, s[4:7], s21 offen offset:64 sc1
  ds_read_b128 v[68:71], v4 offset:0
  ds_read_b128 v[72:75], v4 offset:1024
  ds_read_b128 v[76:79], v4 offset:4096
  ds_read_b128 v[80:83], v4 offset:5120
  ds_read_b128 v[84:87], v4 offset:8192
  ds_read_b128 v[88:91], v4 offset:9216
  ds_read_b128 v[92:95], v4 offset:2048
  ds_read_b128 v[96:99], v4 offset:3072
  ds_read_b128 v[100:103], v4 offset:6144
  ds_read_b128 v[104:107], v4 offset:7168
  ds_read_b128 v[108:111], v4 offset:10240
  ds_read_b128 v[112:115], v4 offset:11264
  v_mov_b64 v[16:17], 0
  v_mov_b64 v[18:19], 0
  v_mov_b64 v[20:21], 0
  v_mov_b64 v[22:23], 0
  v_mov_b64 v[24:25], 0
  v_mov_b64 v[26:27], 0
  ds_read_b64 v[44:45], v2 offset:32256
  s_waitcnt lgkmcnt(0)
  v_readfirstlane_b32 s38, v44
  v_readfirstlane_b32 s37, v45
  s_nop 0
  s_add_u32 s37, s37, 30
  s_cmp_ge_u32 s38, 30
  s_cselect_b32 s38, s37, s38
  s_cmp_ge_u32 s38, 64
  s_cselect_b32 s38, 100, s38
  s_sub_u32 s38, s38, 1
  s_max_i32 s30, s30, s38
  s_waitcnt vmcnt(4)
  s_barrier
  ds_read_b128 v[28:31], v2 offset:19456
  ds_read_b128 v[32:35], v2 offset:23552
  ds_read_b128 v[36:39], v2 offset:8192
  ds_read_b128 v[40:43], v2 offset:9216
  ds_read_b128 v[44:47], v2 offset:10240
  ds_read_b128 v[48:51], v2 offset:11264
  buffer_load_dwordx4 v[124:127], v3, s[4:7], s24 offen offset:3072 sc1
  buffer_load_dwordx4 v[116:119], v3, s[4:7], s25 offen offset:3072 sc1
  ds_read_b128 v[52:55], v2 offset:12288
  ds_read_b128 v[56:59], v2 offset:13312
  ds_read_b128 v[60:63], v2 offset:14336
  ds_read_b128 v[64:67], v2 offset:15360
  buffer_load_dwordx4 v[124:127], v3, s[4:7], s24 offen offset:3072 sc1
  buffer_load_dwordx4 v[116:119], v3, s[4:7], s25 offen offset:3072 sc1
  s_mov_b32 s19, 0
  s_branch T_loop_187
T_kvw_191:
  s_mov_b32 s19, 0
  s_branch T_kvok_200
T_kv_199:
  s_sleep 4
  s_add_u32 s19, s19, 1
  s_cmp_gt_u32 s19, 32768
  s_cbranch_scc1 M_exit
T_kvok_200:
  s_add_u32 s39, s99, 128
  s_mov_b32 s38, 0
  s_mov_b32 s37, 0
  s_atomic_or s38, s[58:59], s99 glc
  s_atomic_or s37, s[58:59], s39 glc
  s_waitcnt lgkmcnt(0)
  s_add_u32 s37, s37, 30
  s_cmp_ge_u32 s38, 30
  s_cselect_b32 s38, s37, s38
  s_cmp_ge_u32 s38, 64
  s_cselect_b32 s38, 100, s38
  s_sub_u32 s38, s38, 1
  s_max_i32 s30, s30, s38
  s_cmp_ge_i32 s14, s30
  s_cbranch_scc1 T_kv_199
  s_branch T_kvb_192
T_slow_194:
  s_nop 7
  v_max3_f32 v100, v16, v17, v18
  v_max3_f32 v100, v100, v19, v20
  v_max3_f32 v100, v100, v21, v22
  v_max3_f32 v100, v100, v23, v112
  v_max3_f32 v100, v100, v113, v114
  v_max_f32 v100, v100, v115
  v_mov_b32 v101, v100
  s_nop 1
  v_permlane32_swap_b32 v100, v101
  s_nop 1
  v_max_f32 v100, v100, v101
  v_mov_b32 v101, v100
  s_nop 1
  v_permlane16_swap_b32 v100, v101
  s_nop 1
  v_max_f32 v100, v100, v101
  v_sub_f32 v16, v16, v100
  v_sub_f32 v17, v17, v100
  v_sub_f32 v18, v18, v100
  v_sub_f32 v19, v19, v100
  v_exp_f32 v16, v16
  v_exp_f32 v17, v17
  v_exp_f32 v18, v18
  v_exp_f32 v19, v19
  v_sub_f32 v20, v20, v100
  v_sub_f32 v21, v21, v100
  v_sub_f32 v22, v22, v100
  v_sub_f32 v23, v23, v100
  v_exp_f32 v20, v20
  v_exp_f32 v21, v21
  v_exp_f32 v22, v22
  v_exp_f32 v23, v23
  v_sub_f32 v112, v112, v100
  v_sub_f32 v113, v113, v100
  v_sub_f32 v114, v114, v100
  v_sub_f32 v115, v115, v100
  v_exp_f32 v112, v112
  v_exp_f32 v113, v113
  v_exp_f32 v114, v114
  v_exp_f32 v115, v115
  s_nop 0
  v_cvt_pk_bf16_f32 v44, v16, v17
  v_cvt_pk_bf16_f32 v45, v18, v19
  v_cvt_pk_bf16_f32 v46, v20, v21
  v_cvt_pk_bf16_f32 v47, v22, v23
  v_cvt_pk_bf16_f32 v84, v112, v113
  v_cvt_pk_bf16_f32 v85, v114, v115
  v_cndmask_b32 v48, v84, 0, s[16:17]
  v_cndmask_b32 v49, v85, 0, s[16:17]
  v_cndmask_b32 v50, 0, v84, s[16:17]
  v_cndmask_b32 v51, 0, v85, s[16:17]
  s_nop 1
  v_mfma_f32_16x16x16_bf16 v[88:91], v[12:13], v[48:49], 0
  v_mfma_f32_16x16x16_bf16 v[24:27], v[120:121], v[48:49], 0
  v_mfma_f32_16x16x16_bf16 v[116:119], v[120:121], v[50:51], 0
  v_mfma_f32_16x16x32_bf16 v[88:91], v[12:15], v[44:47], v[88:91]
  v_mfma_f32_16x16x32_bf16 v[24:27], v[28:31], v[44:47], v[24:27]
  v_mfma_f32_16x16x32_bf16 v[116:119], v[32:35], v[44:47], v[116:119]
  s_nop 7
  s_nop 1
  v_rcp_f32 v89, v88
  s_nop 0
  v_mul_f32 v24, v89, v24
  v_mul_f32 v25, v89, v25
  s_branch T_back_195
M_tdone:
  v_mov_b32 v16, 64
  v_or_b32 v17, s13, v2
  v_min_u32 v17, 1, v17
  v_lshlrev_b32 v17, 30, v17
  s_waitcnt vmcnt(0)
  s_barrier
  buffer_store_dword v16, v17, s[4:7], s15 offen sc1
M_done:
M_exit:
  s_endpgm
.p2align 6
.type M_table,@object
M_table:
.long 0x1, 0x3f, 0xffffffff, 0x17, 0x1, 0x7, 0x800, 0x0, 0x8, 0x0, 0x0, 0x0, 0x0, 0x0, 0x0, 0x0
.long 0x1, 0x28, 0xffffffff, 0x1b, 0x1, 0x6, 0x1000, 0x0, 0x8, 0x1, 0x0, 0x0, 0x0, 0x0, 0x0, 0x0
.long 0x2, 0x0, 0x1, 0x1e, 0x1, 0x5, 0x1800, 0x0, 0x8, 0x0, 0x0, 0x0, 0x0, 0x0, 0x0, 0x0
.long 0x2, 0x1e, 0x1, 0x22, 0x1, 0x4, 0x2000, 0x0, 0x8, 0x1, 0x0, 0x0, 0x0, 0x0, 0x0, 0x0
.long 0x0, 0x0, 0x1, 0x20, 0x2, 0x3, 0x20, 0x0, 0x8, 0x2, 0x0, 0x0, 0x0, 0x0, 0x0, 0x0
.long 0x0, 0x3f, 0xffffffff, 0x20, 0x2, 0x2, 0x18, 0x1, 0x10, 0x0, 0x0, 0x0, 0x0, 0x0, 0x0, 0x0
.long 0x1, 0xd, 0xffffffff, 0xe, 0x0, 0x0, 0x8, 0x0, 0x8, 0x2, 0x0, 0x0, 0x0, 0x0, 0x0, 0x0
.size M_table, 448
.section .rodata,"a"
.p2align 6
.amdhsa_kernel gated_mix__compressed_kv_cla__memory_aug_recurrent_mem_tr__prompt_kernel
.amdhsa_next_free_vgpr 512
.amdhsa_next_free_sgpr 102
.amdhsa_accum_offset 256
.amdhsa_group_segment_fixed_size 0
.amdhsa_kernarg_size 136
.amdhsa_user_sgpr_count 2
.amdhsa_user_sgpr_kernarg_segment_ptr 1
.amdhsa_system_sgpr_workgroup_id_x 1
.end_amdhsa_kernel
```

```asm
; @launch grid=(256,1,1) block=(256,1,1) lds=163840
.amdgcn_target "amdgcn-amd-amdhsa--gfx950"
.text
.globl gated_mix__compressed_kv_cla__memory_aug_recurrent_mem_tr__prompt_kernel
.p2align 8
.type gated_mix__compressed_kv_cla__memory_aug_recurrent_mem_tr__prompt_kernel,@function
gated_mix__compressed_kv_cla__memory_aug_recurrent_mem_tr__prompt_kernel:
  s_cmp_ge_u32 s2, 256
  s_cbranch_scc1 M_exit
  s_lshr_b32 s77, s2, 3
  s_and_b32 s76, s2, 7
  s_cbranch_scc0 M_team
  s_load_dwordx4 s[72:75], s[0:1], 120
  v_lshrrev_b32 v3, 6, v0
  v_and_b32 v1, 63, v0
  v_readfirstlane_b32 s16, v3
  v_lshlrev_b32 v2, 4, v1
  s_waitcnt lgkmcnt(0)
  s_mov_b64 s[4:5], s[74:75]
  s_mov_b64 s[74:75], s[72:73]
  s_mov_b64 s[72:73], s[4:5]
  s_and_b32 s5, s5, 0xffff
  s_mov_b32 s6, 268435456
  s_mov_b32 s7, 0x20000
  s_sub_u32 s66, s76, 1
  s_lshl_b32 s66, s66, 5
  s_add_u32 s66, s66, s77
  s_mul_i32 s64, s66, 9363
  s_lshr_b32 s64, s64, 16
  s_mul_i32 s67, s64, 7
  s_sub_u32 s65, s66, s67
  s_lshl_b32 s31, s66, 7
  s_add_u32 s31, s31, 148897792
  s_lshl_b32 s67, s67, 7
  s_add_u32 s67, s67, 148897792
  s_getpc_b64 s[76:77]
M_pc:
  s_add_u32 s76, s76, M_table-M_pc
  s_addc_u32 s77, s77, 0
  s_lshl_b32 s26, s65, 6
  s_load_dwordx16 s[48:63], s[76:77], s26
  s_waitcnt lgkmcnt(0)
  s_mov_b32 s23, s51
  s_cmp_lg_u32 s48, 1
  s_cbranch_scc1 M_nobpf
  s_load_dwordx8 s[36:43], s[0:1], 64
  s_mul_i32 s76, s64, 3
  s_add_u32 s76, s76, s57
  v_lshlrev_b32 v4, 7, v0
  s_mov_b32 s10, 4194304
  s_mov_b32 s11, 0x20000
  s_waitcnt lgkmcnt(0)
  s_mov_b32 s8, s42
  s_and_b32 s9, s43, 0xffff
  s_mul_i32 s77, s76, 43776
  s_add_u32 s77, s77, 0
  v_min_u32 v5, 32640, v4
  v_add_u32 v5, s77, v5
  s_add_u32 s77, s77, 32768
  buffer_load_dword v6, v5, s[8:11], 0 offen
  v_min_u32 v5, 10880, v4
  v_add_u32 v5, s77, v5
  s_add_u32 s77, s77, 32768
  buffer_load_dword v6, v5, s[8:11], 0 offen
  s_mov_b32 s8, s38
  s_and_b32 s9, s39, 0xffff
  s_mul_i32 s77, s76, 21888
  s_add_u32 s77, s77, 2097152
  v_min_u32 v5, 21760, v4
  v_add_u32 v5, s77, v5
  s_add_u32 s77, s77, 32768
  buffer_load_dword v6, v5, s[8:11], 0 offen
  s_mov_b32 s8, s40
  s_and_b32 s9, s41, 0xffff
  s_mul_i32 s77, s76, 21888
  s_add_u32 s77, s77, 2097152
  v_min_u32 v5, 21760, v4
  v_add_u32 v5, s77, v5
  s_add_u32 s77, s77, 32768
  buffer_load_dword v6, v5, s[8:11], 0 offen
  s_mov_b32 s8, s36
  s_and_b32 s9, s37, 0xffff
  s_mul_i32 s77, s76, 21888
  s_add_u32 s77, s77, 2097152
  v_min_u32 v5, 21760, v4
  v_add_u32 v5, s77, v5
  s_add_u32 s77, s77, 32768
  buffer_load_dword v6, v5, s[8:11], 0 offen
  s_waitcnt vmcnt(0)
M_nobpf:
  s_lshr_b32 s29, s16, 1
  s_cmp_eq_u32 s29, 0
  s_cselect_b32 s26, 2, 8
  s_cselect_b32 s27, 3, 4
  s_cselect_b32 s28, 9, 10
  s_cmp_eq_u32 s48, 1
  s_cselect_b32 s26, s27, s26
  s_cmp_eq_u32 s48, 2
  s_cselect_b32 s26, s28, s26
  s_lshl_b32 s26, s26, 3
  s_load_dwordx2 s[8:9], s[0:1], s26
  s_cmp_eq_u32 s48, 1
  s_cselect_b32 s26, 8, 0
  s_load_dwordx2 s[12:13], s[0:1], s26
  s_cmp_eq_u32 s29, 0
  s_cselect_b32 s21, 0, 3
  s_cselect_b32 s27, 1, 2
  s_cselect_b32 s28, 4, 5
  s_cmp_eq_u32 s48, 1
  s_cselect_b32 s21, s27, s21
  s_cmp_eq_u32 s48, 2
  s_cselect_b32 s21, s28, s21
  s_lshl_b32 s21, s21, 5
  s_add_u32 s21, s21, s64
  s_lshl_b32 s21, s21, 6
  s_add_u32 s21, s21, s49
  s_and_b32 s27, s16, 1
  s_lshl_b32 s21, s21, 1
  s_add_u32 s21, s21, s27
  s_lshl_b32 s21, s21, 12
  s_lshl_b32 s22, s50, 13
  s_lshl_b32 s19, s49, 15
  s_lshl_b32 s20, s50, 15
  s_lshl_b32 s17, s64, 1
  s_add_u32 s17, s17, s27
  s_lshl_b32 s17, s17, 7
  s_mov_b32 s18, 8192
  s_cmp_eq_u32 s48, 0
  s_cselect_b32 s24, 0x3e0293ee, 1.0
  s_waitcnt lgkmcnt(0)
  s_and_b32 s9, s9, 0xffff
  s_mov_b32 s10, 4194304
  s_mov_b32 s11, 0x20000
  s_and_b32 s13, s13, 0xffff
  s_mov_b32 s14, 2097152
  s_mov_b32 s15, 0x20000
  s_cmp_eq_u32 s48, 0
  s_cselect_b32 s32, 0, s16
  s_lshr_b32 s32, s32, 1
  v_lshrrev_b32 v144, 4, v1
  v_and_b32 v56, 0xff, v2
  v_lshl_add_u32 v56, v144, 9, v56
  v_and_b32 v146, 15, v1
  v_and_b32 v144, 8, v1
  v_add_u32 v144, v144, v146
  s_cmp_lg_u32 s32, 0
  s_cselect_b64 vcc, -1, 0
  s_cselect_b32 s26, 8, 16
  v_cndmask_b32 v144, v146, v144, vcc
  v_lshrrev_b32 v145, 4, v1
  v_add_u32 v148, s26, v144
  v_xor_b32 v147, 0, v145
  v_xor_b32 v147, v147, v146
  v_lshlrev_b32 v147, 4, v147
  v_lshl_add_u32 v8, v144, 8, v147
  v_xor_b32 v147, 8, v145
  v_xor_b32 v147, v147, v146
  v_lshlrev_b32 v147, 4, v147
  v_lshl_add_u32 v9, v148, 8, v147
  v_xor_b32 v147, 4, v145
  v_xor_b32 v147, v147, v146
  v_lshlrev_b32 v147, 4, v147
  v_lshl_add_u32 v10, v144, 8, v147
  v_xor_b32 v147, 12, v145
  v_xor_b32 v147, v147, v146
  v_lshlrev_b32 v147, 4, v147
  v_lshl_add_u32 v11, v148, 8, v147
  v_xor_b32 v147, 8, v145
  v_xor_b32 v147, v147, v146
  v_lshlrev_b32 v147, 4, v147
  v_lshl_add_u32 v12, v144, 8, v147
  v_xor_b32 v147, 0, v145
  v_xor_b32 v147, v147, v146
  v_lshlrev_b32 v147, 4, v147
  v_lshl_add_u32 v13, v148, 8, v147
  v_xor_b32 v147, 12, v145
  v_xor_b32 v147, v147, v146
  v_lshlrev_b32 v147, 4, v147
  v_lshl_add_u32 v14, v144, 8, v147
  v_xor_b32 v147, 4, v145
  v_xor_b32 v147, v147, v146
  v_lshlrev_b32 v147, 4, v147
  v_lshl_add_u32 v15, v148, 8, v147
  v_lshrrev_b32 v144, 4, v1
  s_lshl_b32 s26, s16, 8
  v_add_u32 v145, 0, v144
  v_or_b32 v147, 0, v144
  v_xor_b32 v147, v147, v146
  v_lshlrev_b32 v147, 4, v147
  v_lshl_add_u32 v147, v145, 10, v147
  v_add_u32 v16, s26, v147
  v_add_u32 v145, 4, v144
  v_or_b32 v147, 4, v144
  v_xor_b32 v147, v147, v146
  v_lshlrev_b32 v147, 4, v147
  v_lshl_add_u32 v147, v145, 10, v147
  v_add_u32 v17, s26, v147
  v_add_u32 v145, 8, v144
  v_or_b32 v147, 8, v144
  v_xor_b32 v147, v147, v146
  v_lshlrev_b32 v147, 4, v147
  v_lshl_add_u32 v147, v145, 10, v147
  v_add_u32 v18, s26, v147
  v_add_u32 v145, 12, v144
  v_or_b32 v147, 12, v144
  v_xor_b32 v147, v147, v146
  v_lshlrev_b32 v147, 4, v147
  v_lshl_add_u32 v147, v145, 10, v147
  v_add_u32 v19, s26, v147
  v_add_u32 v145, 16, v144
  v_or_b32 v147, 8, v144
  v_xor_b32 v147, v147, v146
  v_lshlrev_b32 v147, 4, v147
  v_lshl_add_u32 v147, v145, 10, v147
  v_add_u32 v20, s26, v147
  v_add_u32 v145, 20, v144
  v_or_b32 v147, 12, v144
  v_xor_b32 v147, v147, v146
  v_lshlrev_b32 v147, 4, v147
  v_lshl_add_u32 v147, v145, 10, v147
  v_add_u32 v21, s26, v147
  v_add_u32 v145, 24, v144
  v_or_b32 v147, 0, v144
  v_xor_b32 v147, v147, v146
  v_lshlrev_b32 v147, 4, v147
  v_lshl_add_u32 v147, v145, 10, v147
  v_add_u32 v22, s26, v147
  v_add_u32 v145, 28, v144
  v_or_b32 v147, 4, v144
  v_xor_b32 v147, v147, v146
  v_lshlrev_b32 v147, 4, v147
  v_lshl_add_u32 v147, v145, 10, v147
  v_add_u32 v23, s26, v147
  v_lshrrev_b32 v144, 3, v1
  v_mul_lo_u32 v144, v144, s18
  v_and_b32 v145, 7, v1
  v_lshl_add_u32 v144, v145, 4, v144
  s_lshl_b32 s28, s16, 15
  s_add_u32 s28, s28, 32768
  s_lshl_b32 s29, s18, 3
  s_add_u32 m0, s28, 0
  s_nop 0
  buffer_load_dwordx4 v144, s[8:11], s17 offen lds
  s_add_u32 s17, s17, s29
  s_add_u32 m0, s28, 1024
  s_nop 0
  buffer_load_dwordx4 v144, s[8:11], s17 offen lds
  s_add_u32 s17, s17, s29
  s_add_u32 m0, s28, 2048
  s_nop 0
  buffer_load_dwordx4 v144, s[8:11], s17 offen lds
  s_add_u32 s17, s17, s29
  s_add_u32 m0, s28, 3072
  s_nop 0
  buffer_load_dwordx4 v144, s[8:11], s17 offen lds
  s_add_u32 s17, s17, s29
  s_add_u32 m0, s28, 4096
  s_nop 0
  buffer_load_dwordx4 v144, s[8:11], s17 offen lds
  s_add_u32 s17, s17, s29
  s_add_u32 m0, s28, 5120
  s_nop 0
  buffer_load_dwordx4 v144, s[8:11], s17 offen lds
  s_add_u32 s17, s17, s29
  s_add_u32 m0, s28, 6144
  s_nop 0
  buffer_load_dwordx4 v144, s[8:11], s17 offen lds
  s_add_u32 s17, s17, s29
  s_add_u32 m0, s28, 7168
  s_nop 0
  buffer_load_dwordx4 v144, s[8:11], s17 offen lds
  s_add_u32 s17, s17, s29
  s_add_u32 m0, s28, 8192
  s_nop 0
  buffer_load_dwordx4 v144, s[8:11], s17 offen lds
  s_add_u32 s17, s17, s29
  s_add_u32 m0, s28, 9216
  s_nop 0
  buffer_load_dwordx4 v144, s[8:11], s17 offen lds
  s_add_u32 s17, s17, s29
  s_add_u32 m0, s28, 10240
  s_nop 0
  buffer_load_dwordx4 v144, s[8:11], s17 offen lds
  s_add_u32 s17, s17, s29
  s_add_u32 m0, s28, 11264
  s_nop 0
  buffer_load_dwordx4 v144, s[8:11], s17 offen lds
  s_add_u32 s17, s17, s29
  s_add_u32 m0, s28, 12288
  s_nop 0
  buffer_load_dwordx4 v144, s[8:11], s17 offen lds
  s_add_u32 s17, s17, s29
  s_add_u32 m0, s28, 13312
  s_nop 0
  buffer_load_dwordx4 v144, s[8:11], s17 offen lds
  s_add_u32 s17, s17, s29
  s_add_u32 m0, s28, 14336
  s_nop 0
  buffer_load_dwordx4 v144, s[8:11], s17 offen lds
  s_add_u32 s17, s17, s29
  s_add_u32 m0, s28, 15360
  s_nop 0
  buffer_load_dwordx4 v144, s[8:11], s17 offen lds
  s_add_u32 s17, s17, s29
  s_add_u32 m0, s28, 16384
  s_nop 0
  buffer_load_dwordx4 v144, s[8:11], s17 offen lds
  s_add_u32 s17, s17, s29
  s_add_u32 m0, s28, 17408
  s_nop 0
  buffer_load_dwordx4 v144, s[8:11], s17 offen lds
  s_add_u32 s17, s17, s29
  s_add_u32 m0, s28, 18432
  s_nop 0
  buffer_load_dwordx4 v144, s[8:11], s17 offen lds
  s_add_u32 s17, s17, s29
  s_add_u32 m0, s28, 19456
  s_nop 0
  buffer_load_dwordx4 v144, s[8:11], s17 offen lds
  s_add_u32 s17, s17, s29
  s_add_u32 m0, s28, 20480
  s_nop 0
  buffer_load_dwordx4 v144, s[8:11], s17 offen lds
  s_add_u32 s17, s17, s29
  s_add_u32 m0, s28, 21504
  s_nop 0
  buffer_load_dwordx4 v144, s[8:11], s17 offen lds
  s_add_u32 s17, s17, s29
  s_add_u32 m0, s28, 22528
  s_nop 0
  buffer_load_dwordx4 v144, s[8:11], s17 offen lds
  s_add_u32 s17, s17, s29
  s_add_u32 m0, s28, 23552
  s_nop 0
  buffer_load_dwordx4 v144, s[8:11], s17 offen lds
  s_add_u32 s17, s17, s29
  s_add_u32 m0, s28, 24576
  s_nop 0
  buffer_load_dwordx4 v144, s[8:11], s17 offen lds
  s_add_u32 s17, s17, s29
  s_add_u32 m0, s28, 25600
  s_nop 0
  buffer_load_dwordx4 v144, s[8:11], s17 offen lds
  s_add_u32 s17, s17, s29
  s_add_u32 m0, s28, 26624
  s_nop 0
  buffer_load_dwordx4 v144, s[8:11], s17 offen lds
  s_add_u32 s17, s17, s29
  s_add_u32 m0, s28, 27648
  s_nop 0
  buffer_load_dwordx4 v144, s[8:11], s17 offen lds
  s_add_u32 s17, s17, s29
  s_add_u32 m0, s28, 28672
  s_nop 0
  buffer_load_dwordx4 v144, s[8:11], s17 offen lds
  s_add_u32 s17, s17, s29
  s_add_u32 m0, s28, 29696
  s_nop 0
  buffer_load_dwordx4 v144, s[8:11], s17 offen lds
  s_add_u32 s17, s17, s29
  s_add_u32 m0, s28, 30720
  s_nop 0
  buffer_load_dwordx4 v144, s[8:11], s17 offen lds
  s_add_u32 s17, s17, s29
  s_add_u32 m0, s28, 31744
  s_nop 0
  buffer_load_dwordx4 v144, s[8:11], s17 offen lds
  s_add_u32 s17, s17, s29
  s_lshl_b32 s25, s16, 13
  s_add_u32 m0, s25, 0
  s_nop 0
  buffer_load_dwordx4 v16, s[12:15], s19 offen lds
  s_add_u32 m0, s25, 1024
  s_nop 0
  buffer_load_dwordx4 v17, s[12:15], s19 offen lds
  s_add_u32 m0, s25, 2048
  s_nop 0
  buffer_load_dwordx4 v18, s[12:15], s19 offen lds
  s_add_u32 m0, s25, 3072
  s_nop 0
  buffer_load_dwordx4 v19, s[12:15], s19 offen lds
  s_add_u32 m0, s25, 4096
  s_nop 0
  buffer_load_dwordx4 v20, s[12:15], s19 offen lds
  s_add_u32 m0, s25, 5120
  s_nop 0
  buffer_load_dwordx4 v21, s[12:15], s19 offen lds
  s_add_u32 m0, s25, 6144
  s_nop 0
  buffer_load_dwordx4 v22, s[12:15], s19 offen lds
  s_add_u32 m0, s25, 7168
  s_nop 0
  buffer_load_dwordx4 v23, s[12:15], s19 offen lds
  s_cmp_gt_u32 s23, 1
  s_cselect_b32 s26, s20, 0
  s_add_u32 s19, s19, s26
  s_add_u32 s25, s25, 32768
  s_and_b32 s25, s25, 0x1ffff
  s_cmp_lg_u32 s16, 3
  s_cbranch_scc1 M_noinit
  s_mov_b32 s79, 0
  s_atomic_swap s79, s[72:73], s31 glc
  s_waitcnt lgkmcnt(0)
  s_mov_b32 s79, 1
  s_atomic_add s79, s[74:75], 128
M_noinit:
  s_cmp_lg_u32 s65, 3
  s_cbranch_scc1 M_noarm
  v_lshlrev_b32 v4, 4, v0
  v_mov_b64 v[60:61], -1
  v_mov_b64 v[62:63], -1
  s_mul_i32 s76, s64, 4096
  s_add_u32 s77, s76, 142868480
  buffer_store_dwordx4 v[60:63], v4, s[4:7], s77 offen sc1
  s_add_u32 s77, s76, 142999552
  buffer_store_dwordx4 v[60:63], v4, s[4:7], s77 offen sc1
  s_add_u32 s77, s76, 143130624
  buffer_store_dwordx4 v[60:63], v4, s[4:7], s77 offen sc1
  s_add_u32 s77, s76, 143261696
  buffer_store_dwordx4 v[60:63], v4, s[4:7], s77 offen sc1
  s_add_u32 s77, s76, 143392768
  buffer_store_dwordx4 v[60:63], v4, s[4:7], s77 offen sc1
  s_add_u32 s77, s76, 143523840
  buffer_store_dwordx4 v[60:63], v4, s[4:7], s77 offen sc1
M_noarm:
  s_mul_i32 s76, s64, 3
  s_add_u32 s76, s76, s57
  s_mul_i32 s76, s76, 24576
  v_lshlrev_b32 v4, 7, v0
  v_add_u32 v4, s76, v4
  buffer_load_dword v5, v4, s[12:15], 0 offen
  v_bfe_u32 v148, v1, 2, 2
  v_lshrrev_b32 v149, 5, v1
  v_lshl_add_u32 v148, v149, 4, v148
  v_bfe_u32 v149, v1, 4, 1
  v_lshl_add_u32 v148, v149, 3, v148
  v_and_b32 v149, 3, v1
  v_and_b32 v150, 2, v149
  v_add_u32 v150, v150, v149
  s_cmp_lg_u32 s32, 0
  s_cselect_b64 vcc, -1, 0
  s_cselect_b32 s26, 32, 16
  v_cndmask_b32 v149, v150, v149, vcc
  v_lshlrev_b32 v149, 3, v149
  v_lshl_add_u32 v148, v148, 7, v149
  v_add_u32 v152, s28, v148
  v_add_u32 v153, 512, v152
  v_add_u32 v154, s26, v152
  v_add_u32 v155, s26, v153
  s_waitcnt vmcnt(37)
  ds_read_b64_tr_b16 a[0:1], v152 offset:0
  ds_read_b64_tr_b16 a[2:3], v153 offset:0
  ds_read_b64_tr_b16 a[4:5], v154 offset:0
  ds_read_b64_tr_b16 a[6:7], v155 offset:0
  ds_read_b64_tr_b16 a[8:9], v152 offset:64
  ds_read_b64_tr_b16 a[10:11], v153 offset:64
  ds_read_b64_tr_b16 a[12:13], v154 offset:64
  ds_read_b64_tr_b16 a[14:15], v155 offset:64
  s_waitcnt lgkmcnt(0)
  s_add_u32 m0, s28, 0
  s_nop 0
  buffer_load_dwordx4 v144, s[8:11], s17 offen lds
  s_add_u32 s17, s17, s29
  s_add_u32 m0, s28, 1024
  s_nop 0
  buffer_load_dwordx4 v144, s[8:11], s17 offen lds
  s_add_u32 s17, s17, s29
  s_add_u32 m0, s28, 2048
  s_nop 0
  buffer_load_dwordx4 v144, s[8:11], s17 offen lds
  s_add_u32 s17, s17, s29
  s_add_u32 m0, s28, 3072
  s_nop 0
  buffer_load_dwordx4 v144, s[8:11], s17 offen lds
  s_add_u32 s17, s17, s29
  s_waitcnt vmcnt(37)
  ds_read_b64_tr_b16 a[16:17], v152 offset:4096
  ds_read_b64_tr_b16 a[18:19], v153 offset:4096
  ds_read_b64_tr_b16 a[20:21], v154 offset:4096
  ds_read_b64_tr_b16 a[22:23], v155 offset:4096
  ds_read_b64_tr_b16 a[24:25], v152 offset:4160
  ds_read_b64_tr_b16 a[26:27], v153 offset:4160
  ds_read_b64_tr_b16 a[28:29], v154 offset:4160
  ds_read_b64_tr_b16 a[30:31], v155 offset:4160
  s_waitcnt lgkmcnt(0)
  s_add_u32 m0, s28, 4096
  s_nop 0
  buffer_load_dwordx4 v144, s[8:11], s17 offen lds
  s_add_u32 s17, s17, s29
  s_add_u32 m0, s28, 5120
  s_nop 0
  buffer_load_dwordx4 v144, s[8:11], s17 offen lds
  s_add_u32 s17, s17, s29
  s_add_u32 m0, s28, 6144
  s_nop 0
  buffer_load_dwordx4 v144, s[8:11], s17 offen lds
  s_add_u32 s17, s17, s29
  s_add_u32 m0, s28, 7168
  s_nop 0
  buffer_load_dwordx4 v144, s[8:11], s17 offen lds
  s_add_u32 s17, s17, s29
  s_waitcnt vmcnt(37)
  ds_read_b64_tr_b16 a[32:33], v152 offset:8192
  ds_read_b64_tr_b16 a[34:35], v153 offset:8192
  ds_read_b64_tr_b16 a[36:37], v154 offset:8192
  ds_read_b64_tr_b16 a[38:39], v155 offset:8192
  ds_read_b64_tr_b16 a[40:41], v152 offset:8256
  ds_read_b64_tr_b16 a[42:43], v153 offset:8256
  ds_read_b64_tr_b16 a[44:45], v154 offset:8256
  ds_read_b64_tr_b16 a[46:47], v155 offset:8256
  s_waitcnt lgkmcnt(0)
  s_add_u32 m0, s28, 8192
  s_nop 0
  buffer_load_dwordx4 v144, s[8:11], s17 offen lds
  s_add_u32 s17, s17, s29
  s_add_u32 m0, s28, 9216
  s_nop 0
  buffer_load_dwordx4 v144, s[8:11], s17 offen lds
  s_add_u32 s17, s17, s29
  s_add_u32 m0, s28, 10240
  s_nop 0
  buffer_load_dwordx4 v144, s[8:11], s17 offen lds
  s_add_u32 s17, s17, s29
  s_add_u32 m0, s28, 11264
  s_nop 0
  buffer_load_dwordx4 v144, s[8:11], s17 offen lds
  s_add_u32 s17, s17, s29
  s_waitcnt vmcnt(37)
  ds_read_b64_tr_b16 a[48:49], v152 offset:12288
  ds_read_b64_tr_b16 a[50:51], v153 offset:12288
  ds_read_b64_tr_b16 a[52:53], v154 offset:12288
  ds_read_b64_tr_b16 a[54:55], v155 offset:12288
  ds_read_b64_tr_b16 a[56:57], v152 offset:12352
  ds_read_b64_tr_b16 a[58:59], v153 offset:12352
  ds_read_b64_tr_b16 a[60:61], v154 offset:12352
  ds_read_b64_tr_b16 a[62:63], v155 offset:12352
  s_waitcnt lgkmcnt(0)
  s_add_u32 m0, s28, 12288
  s_nop 0
  buffer_load_dwordx4 v144, s[8:11], s17 offen lds
  s_add_u32 s17, s17, s29
  s_add_u32 m0, s28, 13312
  s_nop 0
  buffer_load_dwordx4 v144, s[8:11], s17 offen lds
  s_add_u32 s17, s17, s29
  s_add_u32 m0, s28, 14336
  s_nop 0
  buffer_load_dwordx4 v144, s[8:11], s17 offen lds
  s_add_u32 s17, s17, s29
  s_add_u32 m0, s28, 15360
  s_nop 0
  buffer_load_dwordx4 v144, s[8:11], s17 offen lds
  s_add_u32 s17, s17, s29
  s_waitcnt vmcnt(37)
  ds_read_b64_tr_b16 a[64:65], v152 offset:16384
  ds_read_b64_tr_b16 a[66:67], v153 offset:16384
  ds_read_b64_tr_b16 a[68:69], v154 offset:16384
  ds_read_b64_tr_b16 a[70:71], v155 offset:16384
  ds_read_b64_tr_b16 a[72:73], v152 offset:16448
  ds_read_b64_tr_b16 a[74:75], v153 offset:16448
  ds_read_b64_tr_b16 a[76:77], v154 offset:16448
  ds_read_b64_tr_b16 a[78:79], v155 offset:16448
  s_waitcnt lgkmcnt(0)
  s_add_u32 m0, s28, 16384
  s_nop 0
  buffer_load_dwordx4 v144, s[8:11], s17 offen lds
  s_add_u32 s17, s17, s29
  s_add_u32 m0, s28, 17408
  s_nop 0
  buffer_load_dwordx4 v144, s[8:11], s17 offen lds
  s_add_u32 s17, s17, s29
  s_add_u32 m0, s28, 18432
  s_nop 0
  buffer_load_dwordx4 v144, s[8:11], s17 offen lds
  s_add_u32 s17, s17, s29
  s_add_u32 m0, s28, 19456
  s_nop 0
  buffer_load_dwordx4 v144, s[8:11], s17 offen lds
  s_add_u32 s17, s17, s29
  s_waitcnt vmcnt(37)
  ds_read_b64_tr_b16 a[80:81], v152 offset:20480
  ds_read_b64_tr_b16 a[82:83], v153 offset:20480
  ds_read_b64_tr_b16 a[84:85], v154 offset:20480
  ds_read_b64_tr_b16 a[86:87], v155 offset:20480
  ds_read_b64_tr_b16 a[88:89], v152 offset:20544
  ds_read_b64_tr_b16 a[90:91], v153 offset:20544
  ds_read_b64_tr_b16 a[92:93], v154 offset:20544
  ds_read_b64_tr_b16 a[94:95], v155 offset:20544
  s_waitcnt lgkmcnt(0)
  s_add_u32 m0, s28, 20480
  s_nop 0
  buffer_load_dwordx4 v144, s[8:11], s17 offen lds
  s_add_u32 s17, s17, s29
  s_add_u32 m0, s28, 21504
  s_nop 0
  buffer_load_dwordx4 v144, s[8:11], s17 offen lds
  s_add_u32 s17, s17, s29
  s_add_u32 m0, s28, 22528
  s_nop 0
  buffer_load_dwordx4 v144, s[8:11], s17 offen lds
  s_add_u32 s17, s17, s29
  s_add_u32 m0, s28, 23552
  s_nop 0
  buffer_load_dwordx4 v144, s[8:11], s17 offen lds
  s_add_u32 s17, s17, s29
  s_waitcnt vmcnt(37)
  ds_read_b64_tr_b16 a[96:97], v152 offset:24576
  ds_read_b64_tr_b16 a[98:99], v153 offset:24576
  ds_read_b64_tr_b16 a[100:101], v154 offset:24576
  ds_read_b64_tr_b16 a[102:103], v155 offset:24576
  ds_read_b64_tr_b16 a[104:105], v152 offset:24640
  ds_read_b64_tr_b16 a[106:107], v153 offset:24640
  ds_read_b64_tr_b16 a[108:109], v154 offset:24640
  ds_read_b64_tr_b16 a[110:111], v155 offset:24640
  s_waitcnt lgkmcnt(0)
  s_add_u32 m0, s28, 24576
  s_nop 0
  buffer_load_dwordx4 v144, s[8:11], s17 offen lds
  s_add_u32 s17, s17, s29
  s_add_u32 m0, s28, 25600
  s_nop 0
  buffer_load_dwordx4 v144, s[8:11], s17 offen lds
  s_add_u32 s17, s17, s29
  s_add_u32 m0, s28, 26624
  s_nop 0
  buffer_load_dwordx4 v144, s[8:11], s17 offen lds
  s_add_u32 s17, s17, s29
  s_add_u32 m0, s28, 27648
  s_nop 0
  buffer_load_dwordx4 v144, s[8:11], s17 offen lds
  s_add_u32 s17, s17, s29
  s_waitcnt vmcnt(37)
  ds_read_b64_tr_b16 a[112:113], v152 offset:28672
  ds_read_b64_tr_b16 a[114:115], v153 offset:28672
  ds_read_b64_tr_b16 a[116:117], v154 offset:28672
  ds_read_b64_tr_b16 a[118:119], v155 offset:28672
  ds_read_b64_tr_b16 a[120:121], v152 offset:28736
  ds_read_b64_tr_b16 a[122:123], v153 offset:28736
  ds_read_b64_tr_b16 a[124:125], v154 offset:28736
  ds_read_b64_tr_b16 a[126:127], v155 offset:28736
  s_waitcnt lgkmcnt(0)
  s_add_u32 m0, s28, 28672
  s_nop 0
  buffer_load_dwordx4 v144, s[8:11], s17 offen lds
  s_add_u32 s17, s17, s29
  s_add_u32 m0, s28, 29696
  s_nop 0
  buffer_load_dwordx4 v144, s[8:11], s17 offen lds
  s_add_u32 s17, s17, s29
  s_add_u32 m0, s28, 30720
  s_nop 0
  buffer_load_dwordx4 v144, s[8:11], s17 offen lds
  s_add_u32 s17, s17, s29
  s_add_u32 m0, s28, 31744
  s_nop 0
  buffer_load_dwordx4 v144, s[8:11], s17 offen lds
  s_add_u32 s17, s17, s29
  s_waitcnt vmcnt(28)
  ds_read_b64_tr_b16 a[128:129], v152 offset:0
  ds_read_b64_tr_b16 a[130:131], v153 offset:0
  ds_read_b64_tr_b16 a[132:133], v154 offset:0
  ds_read_b64_tr_b16 a[134:135], v155 offset:0
  ds_read_b64_tr_b16 a[136:137], v152 offset:64
  ds_read_b64_tr_b16 a[138:139], v153 offset:64
  ds_read_b64_tr_b16 a[140:141], v154 offset:64
  ds_read_b64_tr_b16 a[142:143], v155 offset:64
  s_waitcnt lgkmcnt(0)
  s_waitcnt vmcnt(24)
  ds_read_b64_tr_b16 a[144:145], v152 offset:4096
  ds_read_b64_tr_b16 a[146:147], v153 offset:4096
  ds_read_b64_tr_b16 a[148:149], v154 offset:4096
  ds_read_b64_tr_b16 a[150:151], v155 offset:4096
  ds_read_b64_tr_b16 a[152:153], v152 offset:4160
  ds_read_b64_tr_b16 a[154:155], v153 offset:4160
  ds_read_b64_tr_b16 a[156:157], v154 offset:4160
  ds_read_b64_tr_b16 a[158:159], v155 offset:4160
  s_waitcnt lgkmcnt(0)
  s_waitcnt vmcnt(20)
  ds_read_b64_tr_b16 a[160:161], v152 offset:8192
  ds_read_b64_tr_b16 a[162:163], v153 offset:8192
  ds_read_b64_tr_b16 a[164:165], v154 offset:8192
  ds_read_b64_tr_b16 a[166:167], v155 offset:8192
  ds_read_b64_tr_b16 a[168:169], v152 offset:8256
  ds_read_b64_tr_b16 a[170:171], v153 offset:8256
  ds_read_b64_tr_b16 a[172:173], v154 offset:8256
  ds_read_b64_tr_b16 a[174:175], v155 offset:8256
  s_waitcnt lgkmcnt(0)
  s_waitcnt vmcnt(16)
  ds_read_b64_tr_b16 a[176:177], v152 offset:12288
  ds_read_b64_tr_b16 a[178:179], v153 offset:12288
  ds_read_b64_tr_b16 a[180:181], v154 offset:12288
  ds_read_b64_tr_b16 a[182:183], v155 offset:12288
  ds_read_b64_tr_b16 a[184:185], v152 offset:12352
  ds_read_b64_tr_b16 a[186:187], v153 offset:12352
  ds_read_b64_tr_b16 a[188:189], v154 offset:12352
  ds_read_b64_tr_b16 a[190:191], v155 offset:12352
  s_waitcnt lgkmcnt(0)
  s_waitcnt vmcnt(12)
  ds_read_b64_tr_b16 a[192:193], v152 offset:16384
  ds_read_b64_tr_b16 a[194:195], v153 offset:16384
  ds_read_b64_tr_b16 a[196:197], v154 offset:16384
  ds_read_b64_tr_b16 a[198:199], v155 offset:16384
  ds_read_b64_tr_b16 a[200:201], v152 offset:16448
  ds_read_b64_tr_b16 a[202:203], v153 offset:16448
  ds_read_b64_tr_b16 a[204:205], v154 offset:16448
  ds_read_b64_tr_b16 a[206:207], v155 offset:16448
  s_waitcnt lgkmcnt(0)
  s_waitcnt vmcnt(8)
  ds_read_b64_tr_b16 a[208:209], v152 offset:20480
  ds_read_b64_tr_b16 a[210:211], v153 offset:20480
  ds_read_b64_tr_b16 a[212:213], v154 offset:20480
  ds_read_b64_tr_b16 a[214:215], v155 offset:20480
  ds_read_b64_tr_b16 a[216:217], v152 offset:20544
  ds_read_b64_tr_b16 a[218:219], v153 offset:20544
  ds_read_b64_tr_b16 a[220:221], v154 offset:20544
  ds_read_b64_tr_b16 a[222:223], v155 offset:20544
  s_waitcnt lgkmcnt(0)
  s_waitcnt vmcnt(4)
  ds_read_b64_tr_b16 a[224:225], v152 offset:24576
  ds_read_b64_tr_b16 a[226:227], v153 offset:24576
  ds_read_b64_tr_b16 a[228:229], v154 offset:24576
  ds_read_b64_tr_b16 a[230:231], v155 offset:24576
  ds_read_b64_tr_b16 a[232:233], v152 offset:24640
  ds_read_b64_tr_b16 a[234:235], v153 offset:24640
  ds_read_b64_tr_b16 a[236:237], v154 offset:24640
  ds_read_b64_tr_b16 a[238:239], v155 offset:24640
  s_waitcnt lgkmcnt(0)
  s_waitcnt vmcnt(0)
  ds_read_b64_tr_b16 a[240:241], v152 offset:28672
  ds_read_b64_tr_b16 a[242:243], v153 offset:28672
  ds_read_b64_tr_b16 a[244:245], v154 offset:28672
  ds_read_b64_tr_b16 a[246:247], v155 offset:28672
  ds_read_b64_tr_b16 a[248:249], v152 offset:28736
  ds_read_b64_tr_b16 a[250:251], v153 offset:28736
  ds_read_b64_tr_b16 a[252:253], v154 offset:28736
  ds_read_b64_tr_b16 a[254:255], v155 offset:28736
  s_waitcnt lgkmcnt(0)
  s_barrier
  s_add_u32 m0, s25, 0
  s_nop 0
  buffer_load_dwordx4 v16, s[12:15], s19 offen lds
  s_add_u32 m0, s25, 1024
  s_nop 0
  buffer_load_dwordx4 v17, s[12:15], s19 offen lds
  s_add_u32 m0, s25, 2048
  s_nop 0
  buffer_load_dwordx4 v18, s[12:15], s19 offen lds
  s_add_u32 m0, s25, 3072
  s_nop 0
  buffer_load_dwordx4 v19, s[12:15], s19 offen lds
  s_add_u32 m0, s25, 4096
  s_nop 0
  buffer_load_dwordx4 v20, s[12:15], s19 offen lds
  s_add_u32 m0, s25, 5120
  s_nop 0
  buffer_load_dwordx4 v21, s[12:15], s19 offen lds
  s_add_u32 m0, s25, 6144
  s_nop 0
  buffer_load_dwordx4 v22, s[12:15], s19 offen lds
  s_add_u32 m0, s25, 7168
  s_nop 0
  buffer_load_dwordx4 v23, s[12:15], s19 offen lds
  s_cmp_gt_u32 s23, 2
  s_cselect_b32 s26, s20, 0
  s_add_u32 s19, s19, s26
  s_add_u32 s25, s25, 32768
  s_and_b32 s25, s25, 0x1ffff
  s_waitcnt vmcnt(0)
  s_barrier
  s_cmp_lg_u32 s32, 0
  s_cbranch_scc1 P_v_1
  s_mov_b32 s27, s21
  v_mov_b32 v7, 0x40000000
  s_mov_b32 s29, -3
  v_min_u32 v145, 1, v0
  v_lshlrev_b32 v145, 30, v145
  ds_read_b128 v[24:27], v8 offset:0
  ds_read_b128 v[28:31], v9 offset:0
  ds_read_b128 v[32:35], v10 offset:0
  ds_read_b128 v[36:39], v11 offset:0
  ds_read_b128 v[40:43], v12 offset:0
  ds_read_b128 v[44:47], v13 offset:0
.p2align 6
G_top_3:
  s_waitcnt lgkmcnt(5)
  v_mfma_f32_16x16x32_bf16 v[64:67], a[0:3], v[24:27], 0
  s_add_u32 m0, s25, 0
  ds_read_b128 v[48:51], v14 offset:0
  v_mfma_f32_16x16x32_bf16 v[68:71], a[4:7], v[24:27], 0
  v_mfma_f32_16x16x32_bf16 v[80:83], a[8:11], v[24:27], 0
  buffer_load_dwordx4 v16, s[12:15], s19 offen lds
  v_mfma_f32_16x16x32_bf16 v[84:87], a[12:15], v[24:27], 0
  s_waitcnt lgkmcnt(5)
  v_mfma_f32_16x16x32_bf16 v[72:75], a[0:3], v[28:31], 0
  ds_read_b128 v[52:55], v15 offset:0
  v_mfma_f32_16x16x32_bf16 v[76:79], a[4:7], v[28:31], 0
  v_mul_f32 v96, s24, v96
  v_mul_f32 v97, s24, v97
  v_mfma_f32_16x16x32_bf16 v[88:91], a[8:11], v[28:31], 0
  v_mfma_f32_16x16x32_bf16 v[92:95], a[12:15], v[28:31], 0
  s_waitcnt lgkmcnt(5)
  v_cvt_pk_bf16_f32 v128, v96, v97
  v_mul_f32 v98, s24, v98
  v_mfma_f32_16x16x32_bf16 v[64:67], a[16:19], v[32:35], v[64:67]
  s_add_u32 m0, s25, 1024
  ds_read_b128 v[24:27], v8 offset:8192
  v_mfma_f32_16x16x32_bf16 v[68:71], a[20:23], v[32:35], v[68:71]
  v_mul_f32 v99, s24, v99
  v_cvt_pk_bf16_f32 v129, v98, v99
  v_mfma_f32_16x16x32_bf16 v[80:83], a[24:27], v[32:35], v[80:83]
  buffer_load_dwordx4 v17, s[12:15], s19 offen lds
  v_mfma_f32_16x16x32_bf16 v[84:87], a[28:31], v[32:35], v[84:87]
  s_waitcnt lgkmcnt(5)
  v_mul_f32 v100, s24, v100
  v_mul_f32 v101, s24, v101
  v_mfma_f32_16x16x32_bf16 v[72:75], a[16:19], v[36:39], v[72:75]
  ds_read_b128 v[28:31], v9 offset:8192
  v_mfma_f32_16x16x32_bf16 v[76:79], a[20:23], v[36:39], v[76:79]
  v_cvt_pk_bf16_f32 v130, v100, v101
  v_mul_f32 v102, s24, v102
  v_mfma_f32_16x16x32_bf16 v[88:91], a[24:27], v[36:39], v[88:91]
  v_mfma_f32_16x16x32_bf16 v[92:95], a[28:31], v[36:39], v[92:95]
  s_waitcnt lgkmcnt(5)
  v_mul_f32 v103, s24, v103
  v_cvt_pk_bf16_f32 v131, v102, v103
  v_mfma_f32_16x16x32_bf16 v[64:67], a[32:35], v[40:43], v[64:67]
  s_add_u32 m0, s25, 2048
  ds_read_b128 v[32:35], v10 offset:8192
  v_mfma_f32_16x16x32_bf16 v[68:71], a[36:39], v[40:43], v[68:71]
  v_mul_f32 v104, s24, v104
  v_mul_f32 v105, s24, v105
  v_mfma_f32_16x16x32_bf16 v[80:83], a[40:43], v[40:43], v[80:83]
  buffer_load_dwordx4 v18, s[12:15], s19 offen lds
  v_mfma_f32_16x16x32_bf16 v[84:87], a[44:47], v[40:43], v[84:87]
  s_waitcnt lgkmcnt(5)
  v_cvt_pk_bf16_f32 v132, v104, v105
  v_mul_f32 v106, s24, v106
  v_mfma_f32_16x16x32_bf16 v[72:75], a[32:35], v[44:47], v[72:75]
  ds_read_b128 v[36:39], v11 offset:8192
  v_mfma_f32_16x16x32_bf16 v[76:79], a[36:39], v[44:47], v[76:79]
  v_mul_f32 v107, s24, v107
  v_cvt_pk_bf16_f32 v133, v106, v107
  v_mfma_f32_16x16x32_bf16 v[88:91], a[40:43], v[44:47], v[88:91]
  v_mfma_f32_16x16x32_bf16 v[92:95], a[44:47], v[44:47], v[92:95]
  s_waitcnt lgkmcnt(5)
  v_mul_f32 v108, s24, v108
  v_mul_f32 v109, s24, v109
  v_mfma_f32_16x16x32_bf16 v[64:67], a[48:51], v[48:51], v[64:67]
  s_add_u32 m0, s25, 3072
  ds_read_b128 v[40:43], v12 offset:8192
  v_mfma_f32_16x16x32_bf16 v[68:71], a[52:55], v[48:51], v[68:71]
  v_cvt_pk_bf16_f32 v134, v108, v109
  v_mul_f32 v110, s24, v110
  v_mfma_f32_16x16x32_bf16 v[80:83], a[56:59], v[48:51], v[80:83]
  buffer_load_dwordx4 v19, s[12:15], s19 offen lds
  v_mfma_f32_16x16x32_bf16 v[84:87], a[60:63], v[48:51], v[84:87]
  s_waitcnt lgkmcnt(5)
  v_mul_f32 v111, s24, v111
  v_cvt_pk_bf16_f32 v135, v110, v111
  v_mfma_f32_16x16x32_bf16 v[72:75], a[48:51], v[52:55], v[72:75]
  ds_read_b128 v[44:47], v13 offset:8192
  v_mfma_f32_16x16x32_bf16 v[76:79], a[52:55], v[52:55], v[76:79]
  v_mul_f32 v112, s24, v112
  v_mul_f32 v113, s24, v113
  v_mfma_f32_16x16x32_bf16 v[88:91], a[56:59], v[52:55], v[88:91]
  v_mfma_f32_16x16x32_bf16 v[92:95], a[60:63], v[52:55], v[92:95]
  s_waitcnt lgkmcnt(5)
  v_cvt_pk_bf16_f32 v136, v112, v113
  v_mul_f32 v114, s24, v114
  v_mfma_f32_16x16x32_bf16 v[64:67], a[64:67], v[24:27], v[64:67]
  s_add_u32 m0, s25, 4096
  ds_read_b128 v[48:51], v14 offset:8192
  v_mfma_f32_16x16x32_bf16 v[68:71], a[68:71], v[24:27], v[68:71]
  v_mul_f32 v115, s24, v115
  v_cvt_pk_bf16_f32 v137, v114, v115
  v_mfma_f32_16x16x32_bf16 v[80:83], a[72:75], v[24:27], v[80:83]
  buffer_load_dwordx4 v20, s[12:15], s19 offen lds
  v_mfma_f32_16x16x32_bf16 v[84:87], a[76:79], v[24:27], v[84:87]
  s_waitcnt lgkmcnt(5)
  v_mul_f32 v116, s24, v116
  v_mul_f32 v117, s24, v117
  v_mfma_f32_16x16x32_bf16 v[72:75], a[64:67], v[28:31], v[72:75]
  ds_read_b128 v[52:55], v15 offset:8192
  v_mfma_f32_16x16x32_bf16 v[76:79], a[68:71], v[28:31], v[76:79]
  v_cvt_pk_bf16_f32 v138, v116, v117
  v_mul_f32 v118, s24, v118
  v_mfma_f32_16x16x32_bf16 v[88:91], a[72:75], v[28:31], v[88:91]
  v_mfma_f32_16x16x32_bf16 v[92:95], a[76:79], v[28:31], v[92:95]
  s_waitcnt lgkmcnt(5)
  v_mul_f32 v119, s24, v119
  v_cvt_pk_bf16_f32 v139, v118, v119
  v_mfma_f32_16x16x32_bf16 v[64:67], a[80:83], v[32:35], v[64:67]
  s_add_u32 m0, s25, 5120
  ds_read_b128 v[24:27], v8 offset:16384
  v_mfma_f32_16x16x32_bf16 v[68:71], a[84:87], v[32:35], v[68:71]
  v_mul_f32 v120, s24, v120
  v_mul_f32 v121, s24, v121
  v_mfma_f32_16x16x32_bf16 v[80:83], a[88:91], v[32:35], v[80:83]
  buffer_load_dwordx4 v21, s[12:15], s19 offen lds
  v_mfma_f32_16x16x32_bf16 v[84:87], a[92:95], v[32:35], v[84:87]
  s_waitcnt lgkmcnt(5)
  v_cvt_pk_bf16_f32 v140, v120, v121
  v_mul_f32 v122, s24, v122
  v_mfma_f32_16x16x32_bf16 v[72:75], a[80:83], v[36:39], v[72:75]
  ds_read_b128 v[28:31], v9 offset:16384
  v_mfma_f32_16x16x32_bf16 v[76:79], a[84:87], v[36:39], v[76:79]
  v_mul_f32 v123, s24, v123
  v_cvt_pk_bf16_f32 v141, v122, v123
  v_mfma_f32_16x16x32_bf16 v[88:91], a[88:91], v[36:39], v[88:91]
  v_mfma_f32_16x16x32_bf16 v[92:95], a[92:95], v[36:39], v[92:95]
  s_waitcnt lgkmcnt(5)
  v_mul_f32 v124, s24, v124
  v_mul_f32 v125, s24, v125
  v_mfma_f32_16x16x32_bf16 v[64:67], a[96:99], v[40:43], v[64:67]
  s_add_u32 m0, s25, 6144
  ds_read_b128 v[32:35], v10 offset:16384
  v_mfma_f32_16x16x32_bf16 v[68:71], a[100:103], v[40:43], v[68:71]
  v_cvt_pk_bf16_f32 v142, v124, v125
  v_mul_f32 v126, s24, v126
  v_mfma_f32_16x16x32_bf16 v[80:83], a[104:107], v[40:43], v[80:83]
  buffer_load_dwordx4 v22, s[12:15], s19 offen lds
  v_mfma_f32_16x16x32_bf16 v[84:87], a[108:111], v[40:43], v[84:87]
  s_waitcnt lgkmcnt(5)
  v_mul_f32 v127, s24, v127
  v_cvt_pk_bf16_f32 v143, v126, v127
  v_mfma_f32_16x16x32_bf16 v[72:75], a[96:99], v[44:47], v[72:75]
  ds_read_b128 v[36:39], v11 offset:16384
  v_mfma_f32_16x16x32_bf16 v[76:79], a[100:103], v[44:47], v[76:79]
  v_mfma_f32_16x16x32_bf16 v[88:91], a[104:107], v[44:47], v[88:91]
  v_mfma_f32_16x16x32_bf16 v[92:95], a[108:111], v[44:47], v[92:95]
  s_waitcnt lgkmcnt(5)
  v_mfma_f32_16x16x32_bf16 v[64:67], a[112:115], v[48:51], v[64:67]
  s_add_u32 m0, s25, 7168
  ds_read_b128 v[40:43], v12 offset:16384
  v_mfma_f32_16x16x32_bf16 v[68:71], a[116:119], v[48:51], v[68:71]
  v_mfma_f32_16x16x32_bf16 v[80:83], a[120:123], v[48:51], v[80:83]
  buffer_load_dwordx4 v23, s[12:15], s19 offen lds
  v_mfma_f32_16x16x32_bf16 v[84:87], a[124:127], v[48:51], v[84:87]
  s_waitcnt lgkmcnt(5)
  v_mfma_f32_16x16x32_bf16 v[72:75], a[112:115], v[52:55], v[72:75]
  s_cmp_gt_u32 s23, 3
  ds_read_b128 v[44:47], v13 offset:16384
  v_mfma_f32_16x16x32_bf16 v[76:79], a[116:119], v[52:55], v[76:79]
  v_mfma_f32_16x16x32_bf16 v[88:91], a[120:123], v[52:55], v[88:91]
  s_cselect_b32 s26, s20, 0
  v_mfma_f32_16x16x32_bf16 v[92:95], a[124:127], v[52:55], v[92:95]
  s_waitcnt lgkmcnt(5)
  v_mfma_f32_16x16x32_bf16 v[64:67], a[128:131], v[24:27], v[64:67]
  s_add_u32 s19, s19, s26
  ds_read_b128 v[48:51], v14 offset:16384
  v_mfma_f32_16x16x32_bf16 v[68:71], a[132:135], v[24:27], v[68:71]
  v_mfma_f32_16x16x32_bf16 v[80:83], a[136:139], v[24:27], v[80:83]
  s_add_u32 s25, s25, 32768
  v_mfma_f32_16x16x32_bf16 v[84:87], a[140:143], v[24:27], v[84:87]
  s_waitcnt lgkmcnt(5)
  v_mfma_f32_16x16x32_bf16 v[72:75], a[128:131], v[28:31], v[72:75]
  s_and_b32 s25, s25, 0x1ffff
  ds_read_b128 v[52:55], v15 offset:16384
  v_mfma_f32_16x16x32_bf16 v[76:79], a[132:135], v[28:31], v[76:79]
  v_mfma_f32_16x16x32_bf16 v[88:91], a[136:139], v[28:31], v[88:91]
  buffer_store_dwordx4 v[128:131], v7, s[4:7], s21 offen offset:0 sc1
  v_mfma_f32_16x16x32_bf16 v[92:95], a[140:143], v[28:31], v[92:95]
  s_waitcnt lgkmcnt(5)
  v_mfma_f32_16x16x32_bf16 v[64:67], a[144:147], v[32:35], v[64:67]
  ds_read_b128 v[24:27], v8 offset:24576
  v_mfma_f32_16x16x32_bf16 v[68:71], a[148:151], v[32:35], v[68:71]
  v_mfma_f32_16x16x32_bf16 v[80:83], a[152:155], v[32:35], v[80:83]
  v_mfma_f32_16x16x32_bf16 v[84:87], a[156:159], v[32:35], v[84:87]
  s_waitcnt lgkmcnt(5)
  v_mfma_f32_16x16x32_bf16 v[72:75], a[144:147], v[36:39], v[72:75]
  ds_read_b128 v[28:31], v9 offset:24576
  v_mfma_f32_16x16x32_bf16 v[76:79], a[148:151], v[36:39], v[76:79]
  v_mfma_f32_16x16x32_bf16 v[88:91], a[152:155], v[36:39], v[88:91]
  buffer_store_dwordx4 v[132:135], v7, s[4:7], s21 offen offset:256 sc1
  v_mfma_f32_16x16x32_bf16 v[92:95], a[156:159], v[36:39], v[92:95]
  s_waitcnt lgkmcnt(5)
  v_mfma_f32_16x16x32_bf16 v[64:67], a[160:163], v[40:43], v[64:67]
  ds_read_b128 v[32:35], v10 offset:24576
  v_mfma_f32_16x16x32_bf16 v[68:71], a[164:167], v[40:43], v[68:71]
  v_mfma_f32_16x16x32_bf16 v[80:83], a[168:171], v[40:43], v[80:83]
  v_mfma_f32_16x16x32_bf16 v[84:87], a[172:175], v[40:43], v[84:87]
  s_waitcnt lgkmcnt(5)
  v_mfma_f32_16x16x32_bf16 v[72:75], a[160:163], v[44:47], v[72:75]
  ds_read_b128 v[36:39], v11 offset:24576
  v_mfma_f32_16x16x32_bf16 v[76:79], a[164:167], v[44:47], v[76:79]
  v_mfma_f32_16x16x32_bf16 v[88:91], a[168:171], v[44:47], v[88:91]
  buffer_store_dwordx4 v[136:139], v7, s[4:7], s21 offen offset:2048 sc1
  v_mfma_f32_16x16x32_bf16 v[92:95], a[172:175], v[44:47], v[92:95]
  s_waitcnt lgkmcnt(5)
  v_mfma_f32_16x16x32_bf16 v[64:67], a[176:179], v[48:51], v[64:67]
  ds_read_b128 v[40:43], v12 offset:24576
  v_mfma_f32_16x16x32_bf16 v[68:71], a[180:183], v[48:51], v[68:71]
  v_mfma_f32_16x16x32_bf16 v[80:83], a[184:187], v[48:51], v[80:83]
  v_mfma_f32_16x16x32_bf16 v[84:87], a[188:191], v[48:51], v[84:87]
  s_waitcnt lgkmcnt(5)
  v_mfma_f32_16x16x32_bf16 v[72:75], a[176:179], v[52:55], v[72:75]
  ds_read_b128 v[44:47], v13 offset:24576
  v_mfma_f32_16x16x32_bf16 v[76:79], a[180:183], v[52:55], v[76:79]
  v_mfma_f32_16x16x32_bf16 v[88:91], a[184:187], v[52:55], v[88:91]
  buffer_store_dwordx4 v[140:143], v7, s[4:7], s21 offen offset:2304 sc1
  v_mfma_f32_16x16x32_bf16 v[92:95], a[188:191], v[52:55], v[92:95]
  s_waitcnt lgkmcnt(5)
  v_mfma_f32_16x16x32_bf16 v[64:67], a[192:195], v[24:27], v[64:67]
  s_mov_b32 s21, s27
  ds_read_b128 v[48:51], v14 offset:24576
  v_mfma_f32_16x16x32_bf16 v[68:71], a[196:199], v[24:27], v[68:71]
  v_mov_b32 v7, v56
  v_mfma_f32_16x16x32_bf16 v[80:83], a[200:203], v[24:27], v[80:83]
  v_mfma_f32_16x16x32_bf16 v[84:87], a[204:207], v[24:27], v[84:87]
  s_waitcnt lgkmcnt(5)
  v_mfma_f32_16x16x32_bf16 v[72:75], a[192:195], v[28:31], v[72:75]
  s_add_u32 s27, s27, s22
  ds_read_b128 v[52:55], v15 offset:24576
  v_mfma_f32_16x16x32_bf16 v[76:79], a[196:199], v[28:31], v[76:79]
  v_mfma_f32_16x16x32_bf16 v[88:91], a[200:203], v[28:31], v[88:91]
  s_waitcnt vmcnt(17)
  s_barrier
  v_mfma_f32_16x16x32_bf16 v[92:95], a[204:207], v[28:31], v[92:95]
  s_waitcnt lgkmcnt(5)
  v_mfma_f32_16x16x32_bf16 v[64:67], a[208:211], v[32:35], v[64:67]
  ds_read_b128 v[24:27], v8 offset:32768
  v_mfma_f32_16x16x32_bf16 v[68:71], a[212:215], v[32:35], v[68:71]
  v_mfma_f32_16x16x32_bf16 v[80:83], a[216:219], v[32:35], v[80:83]
  v_mfma_f32_16x16x32_bf16 v[84:87], a[220:223], v[32:35], v[84:87]
  s_waitcnt lgkmcnt(5)
  v_mfma_f32_16x16x32_bf16 v[72:75], a[208:211], v[36:39], v[72:75]
  s_add_u32 s29, s29, 1
  ds_read_b128 v[28:31], v9 offset:32768
  v_mfma_f32_16x16x32_bf16 v[76:79], a[212:215], v[36:39], v[76:79]
  v_mfma_f32_16x16x32_bf16 v[88:91], a[216:219], v[36:39], v[88:91]
  s_max_i32 s30, s29, 0
  v_mfma_f32_16x16x32_bf16 v[92:95], a[220:223], v[36:39], v[92:95]
  s_waitcnt lgkmcnt(5)
  v_mov_b32 v144, s30
  v_mfma_f32_16x16x32_bf16 v[64:67], a[224:227], v[40:43], v[64:67]
  ds_read_b128 v[32:35], v10 offset:32768
  v_mfma_f32_16x16x32_bf16 v[68:71], a[228:231], v[40:43], v[68:71]
  v_mfma_f32_16x16x32_bf16 v[80:83], a[232:235], v[40:43], v[80:83]
  buffer_store_dword v144, v145, s[4:7], s31 offen sc1
  v_mfma_f32_16x16x32_bf16 v[84:87], a[236:239], v[40:43], v[84:87]
  s_waitcnt lgkmcnt(5)
  v_mfma_f32_16x16x32_bf16 v[72:75], a[224:227], v[44:47], v[72:75]
  ds_read_b128 v[36:39], v11 offset:32768
  v_mfma_f32_16x16x32_bf16 v[76:79], a[228:231], v[44:47], v[76:79]
  v_mfma_f32_16x16x32_bf16 v[88:91], a[232:235], v[44:47], v[88:91]
  v_mfma_f32_16x16x32_bf16 v[92:95], a[236:239], v[44:47], v[92:95]
  s_waitcnt lgkmcnt(5)
  v_mfma_f32_16x16x32_bf16 v[64:67], a[240:243], v[48:51], v[64:67]
  s_sub_u32 s23, s23, 1
  ds_read_b128 v[40:43], v12 offset:32768
  v_mfma_f32_16x16x32_bf16 v[68:71], a[244:247], v[48:51], v[68:71]
  v_mfma_f32_16x16x32_bf16 v[80:83], a[248:251], v[48:51], v[80:83]
  v_mfma_f32_16x16x32_bf16 v[84:87], a[252:255], v[48:51], v[84:87]
  s_waitcnt lgkmcnt(5)
  v_mfma_f32_16x16x32_bf16 v[72:75], a[240:243], v[52:55], v[72:75]
  s_cmp_eq_u32 s23, 0
  ds_read_b128 v[44:47], v13 offset:32768
  v_mfma_f32_16x16x32_bf16 v[76:79], a[244:247], v[52:55], v[76:79]
  v_mfma_f32_16x16x32_bf16 v[88:91], a[248:251], v[52:55], v[88:91]
  v_mfma_f32_16x16x32_bf16 v[92:95], a[252:255], v[52:55], v[92:95]
  s_cbranch_scc1 G_done0_4
  s_waitcnt lgkmcnt(5)
  v_mfma_f32_16x16x32_bf16 v[96:99], a[0:3], v[24:27], 0
  s_add_u32 m0, s25, 0
  ds_read_b128 v[48:51], v14 offset:32768
  v_mfma_f32_16x16x32_bf16 v[100:103], a[4:7], v[24:27], 0
  v_mfma_f32_16x16x32_bf16 v[112:115], a[8:11], v[24:27], 0
  buffer_load_dwordx4 v16, s[12:15], s19 offen lds
  v_mfma_f32_16x16x32_bf16 v[116:119], a[12:15], v[24:27], 0
  s_waitcnt lgkmcnt(5)
  v_mfma_f32_16x16x32_bf16 v[104:107], a[0:3], v[28:31], 0
  ds_read_b128 v[52:55], v15 offset:32768
  v_mfma_f32_16x16x32_bf16 v[108:111], a[4:7], v[28:31], 0
  v_mul_f32 v64, s24, v64
  v_mul_f32 v65, s24, v65
  v_mfma_f32_16x16x32_bf16 v[120:123], a[8:11], v[28:31], 0
  v_mfma_f32_16x16x32_bf16 v[124:127], a[12:15], v[28:31], 0
  s_waitcnt lgkmcnt(5)
  v_cvt_pk_bf16_f32 v128, v64, v65
  v_mul_f32 v66, s24, v66
  v_mfma_f32_16x16x32_bf16 v[96:99], a[16:19], v[32:35], v[96:99]
  s_add_u32 m0, s25, 1024
  ds_read_b128 v[24:27], v8 offset:40960
  v_mfma_f32_16x16x32_bf16 v[100:103], a[20:23], v[32:35], v[100:103]
  v_mul_f32 v67, s24, v67
  v_cvt_pk_bf16_f32 v129, v66, v67
  v_mfma_f32_16x16x32_bf16 v[112:115], a[24:27], v[32:35], v[112:115]
  buffer_load_dwordx4 v17, s[12:15], s19 offen lds
  v_mfma_f32_16x16x32_bf16 v[116:119], a[28:31], v[32:35], v[116:119]
  s_waitcnt lgkmcnt(5)
  v_mul_f32 v68, s24, v68
  v_mul_f32 v69, s24, v69
  v_mfma_f32_16x16x32_bf16 v[104:107], a[16:19], v[36:39], v[104:107]
  ds_read_b128 v[28:31], v9 offset:40960
  v_mfma_f32_16x16x32_bf16 v[108:111], a[20:23], v[36:39], v[108:111]
  v_cvt_pk_bf16_f32 v130, v68, v69
  v_mul_f32 v70, s24, v70
  v_mfma_f32_16x16x32_bf16 v[120:123], a[24:27], v[36:39], v[120:123]
  v_mfma_f32_16x16x32_bf16 v[124:127], a[28:31], v[36:39], v[124:127]
  s_waitcnt lgkmcnt(5)
  v_mul_f32 v71, s24, v71
  v_cvt_pk_bf16_f32 v131, v70, v71
  v_mfma_f32_16x16x32_bf16 v[96:99], a[32:35], v[40:43], v[96:99]
  s_add_u32 m0, s25, 2048
  ds_read_b128 v[32:35], v10 offset:40960
  v_mfma_f32_16x16x32_bf16 v[100:103], a[36:39], v[40:43], v[100:103]
  v_mul_f32 v72, s24, v72
  v_mul_f32 v73, s24, v73
  v_mfma_f32_16x16x32_bf16 v[112:115], a[40:43], v[40:43], v[112:115]
  buffer_load_dwordx4 v18, s[12:15], s19 offen lds
  v_mfma_f32_16x16x32_bf16 v[116:119], a[44:47], v[40:43], v[116:119]
  s_waitcnt lgkmcnt(5)
  v_cvt_pk_bf16_f32 v132, v72, v73
  v_mul_f32 v74, s24, v74
  v_mfma_f32_16x16x32_bf16 v[104:107], a[32:35], v[44:47], v[104:107]
  ds_read_b128 v[36:39], v11 offset:40960
  v_mfma_f32_16x16x32_bf16 v[108:111], a[36:39], v[44:47], v[108:111]
  v_mul_f32 v75, s24, v75
  v_cvt_pk_bf16_f32 v133, v74, v75
  v_mfma_f32_16x16x32_bf16 v[120:123], a[40:43], v[44:47], v[120:123]
  v_mfma_f32_16x16x32_bf16 v[124:127], a[44:47], v[44:47], v[124:127]
  s_waitcnt lgkmcnt(5)
  v_mul_f32 v76, s24, v76
  v_mul_f32 v77, s24, v77
  v_mfma_f32_16x16x32_bf16 v[96:99], a[48:51], v[48:51], v[96:99]
  s_add_u32 m0, s25, 3072
  ds_read_b128 v[40:43], v12 offset:40960
  v_mfma_f32_16x16x32_bf16 v[100:103], a[52:55], v[48:51], v[100:103]
  v_cvt_pk_bf16_f32 v134, v76, v77
  v_mul_f32 v78, s24, v78
  v_mfma_f32_16x16x32_bf16 v[112:115], a[56:59], v[48:51], v[112:115]
  buffer_load_dwordx4 v19, s[12:15], s19 offen lds
  v_mfma_f32_16x16x32_bf16 v[116:119], a[60:63], v[48:51], v[116:119]
  s_waitcnt lgkmcnt(5)
  v_mul_f32 v79, s24, v79
  v_cvt_pk_bf16_f32 v135, v78, v79
  v_mfma_f32_16x16x32_bf16 v[104:107], a[48:51], v[52:55], v[104:107]
  ds_read_b128 v[44:47], v13 offset:40960
  v_mfma_f32_16x16x32_bf16 v[108:111], a[52:55], v[52:55], v[108:111]
  v_mul_f32 v80, s24, v80
  v_mul_f32 v81, s24, v81
  v_mfma_f32_16x16x32_bf16 v[120:123], a[56:59], v[52:55], v[120:123]
  v_mfma_f32_16x16x32_bf16 v[124:127], a[60:63], v[52:55], v[124:127]
  s_waitcnt lgkmcnt(5)
  v_cvt_pk_bf16_f32 v136, v80, v81
  v_mul_f32 v82, s24, v82
  v_mfma_f32_16x16x32_bf16 v[96:99], a[64:67], v[24:27], v[96:99]
  s_add_u32 m0, s25, 4096
  ds_read_b128 v[48:51], v14 offset:40960
  v_mfma_f32_16x16x32_bf16 v[100:103], a[68:71], v[24:27], v[100:103]
  v_mul_f32 v83, s24, v83
  v_cvt_pk_bf16_f32 v137, v82, v83
  v_mfma_f32_16x16x32_bf16 v[112:115], a[72:75], v[24:27], v[112:115]
  buffer_load_dwordx4 v20, s[12:15], s19 offen lds
  v_mfma_f32_16x16x32_bf16 v[116:119], a[76:79], v[24:27], v[116:119]
  s_waitcnt lgkmcnt(5)
  v_mul_f32 v84, s24, v84
  v_mul_f32 v85, s24, v85
  v_mfma_f32_16x16x32_bf16 v[104:107], a[64:67], v[28:31], v[104:107]
  ds_read_b128 v[52:55], v15 offset:40960
  v_mfma_f32_16x16x32_bf16 v[108:111], a[68:71], v[28:31], v[108:111]
  v_cvt_pk_bf16_f32 v138, v84, v85
  v_mul_f32 v86, s24, v86
  v_mfma_f32_16x16x32_bf16 v[120:123], a[72:75], v[28:31], v[120:123]
  v_mfma_f32_16x16x32_bf16 v[124:127], a[76:79], v[28:31], v[124:127]
  s_waitcnt lgkmcnt(5)
  v_mul_f32 v87, s24, v87
  v_cvt_pk_bf16_f32 v139, v86, v87
  v_mfma_f32_16x16x32_bf16 v[96:99], a[80:83], v[32:35], v[96:99]
  s_add_u32 m0, s25, 5120
  ds_read_b128 v[24:27], v8 offset:49152
  v_mfma_f32_16x16x32_bf16 v[100:103], a[84:87], v[32:35], v[100:103]
  v_mul_f32 v88, s24, v88
  v_mul_f32 v89, s24, v89
  v_mfma_f32_16x16x32_bf16 v[112:115], a[88:91], v[32:35], v[112:115]
  buffer_load_dwordx4 v21, s[12:15], s19 offen lds
  v_mfma_f32_16x16x32_bf16 v[116:119], a[92:95], v[32:35], v[116:119]
  s_waitcnt lgkmcnt(5)
  v_cvt_pk_bf16_f32 v140, v88, v89
  v_mul_f32 v90, s24, v90
  v_mfma_f32_16x16x32_bf16 v[104:107], a[80:83], v[36:39], v[104:107]
  ds_read_b128 v[28:31], v9 offset:49152
  v_mfma_f32_16x16x32_bf16 v[108:111], a[84:87], v[36:39], v[108:111]
  v_mul_f32 v91, s24, v91
  v_cvt_pk_bf16_f32 v141, v90, v91
  v_mfma_f32_16x16x32_bf16 v[120:123], a[88:91], v[36:39], v[120:123]
  v_mfma_f32_16x16x32_bf16 v[124:127], a[92:95], v[36:39], v[124:127]
  s_waitcnt lgkmcnt(5)
  v_mul_f32 v92, s24, v92
  v_mul_f32 v93, s24, v93
  v_mfma_f32_16x16x32_bf16 v[96:99], a[96:99], v[40:43], v[96:99]
  s_add_u32 m0, s25, 6144
  ds_read_b128 v[32:35], v10 offset:49152
  v_mfma_f32_16x16x32_bf16 v[100:103], a[100:103], v[40:43], v[100:103]
  v_cvt_pk_bf16_f32 v142, v92, v93
  v_mul_f32 v94, s24, v94
  v_mfma_f32_16x16x32_bf16 v[112:115], a[104:107], v[40:43], v[112:115]
  buffer_load_dwordx4 v22, s[12:15], s19 offen lds
  v_mfma_f32_16x16x32_bf16 v[116:119], a[108:111], v[40:43], v[116:119]
  s_waitcnt lgkmcnt(5)
  v_mul_f32 v95, s24, v95
  v_cvt_pk_bf16_f32 v143, v94, v95
  v_mfma_f32_16x16x32_bf16 v[104:107], a[96:99], v[44:47], v[104:107]
  ds_read_b128 v[36:39], v11 offset:49152
  v_mfma_f32_16x16x32_bf16 v[108:111], a[100:103], v[44:47], v[108:111]
  v_mfma_f32_16x16x32_bf16 v[120:123], a[104:107], v[44:47], v[120:123]
  v_mfma_f32_16x16x32_bf16 v[124:127], a[108:111], v[44:47], v[124:127]
  s_waitcnt lgkmcnt(5)
  v_mfma_f32_16x16x32_bf16 v[96:99], a[112:115], v[48:51], v[96:99]
  s_add_u32 m0, s25, 7168
  ds_read_b128 v[40:43], v12 offset:49152
  v_mfma_f32_16x16x32_bf16 v[100:103], a[116:119], v[48:51], v[100:103]
  v_mfma_f32_16x16x32_bf16 v[112:115], a[120:123], v[48:51], v[112:115]
  buffer_load_dwordx4 v23, s[12:15], s19 offen lds
  v_mfma_f32_16x16x32_bf16 v[116:119], a[124:127], v[48:51], v[116:119]
  s_waitcnt lgkmcnt(5)
  v_mfma_f32_16x16x32_bf16 v[104:107], a[112:115], v[52:55], v[104:107]
  s_cmp_gt_u32 s23, 3
  ds_read_b128 v[44:47], v13 offset:49152
  v_mfma_f32_16x16x32_bf16 v[108:111], a[116:119], v[52:55], v[108:111]
  v_mfma_f32_16x16x32_bf16 v[120:123], a[120:123], v[52:55], v[120:123]
  s_cselect_b32 s26, s20, 0
  v_mfma_f32_16x16x32_bf16 v[124:127], a[124:127], v[52:55], v[124:127]
  s_waitcnt lgkmcnt(5)
  v_mfma_f32_16x16x32_bf16 v[96:99], a[128:131], v[24:27], v[96:99]
  s_add_u32 s19, s19, s26
  ds_read_b128 v[48:51], v14 offset:49152
  v_mfma_f32_16x16x32_bf16 v[100:103], a[132:135], v[24:27], v[100:103]
  v_mfma_f32_16x16x32_bf16 v[112:115], a[136:139], v[24:27], v[112:115]
  s_add_u32 s25, s25, 32768
  v_mfma_f32_16x16x32_bf16 v[116:119], a[140:143], v[24:27], v[116:119]
  s_waitcnt lgkmcnt(5)
  v_mfma_f32_16x16x32_bf16 v[104:107], a[128:131], v[28:31], v[104:107]
  s_and_b32 s25, s25, 0x1ffff
  ds_read_b128 v[52:55], v15 offset:49152
  v_mfma_f32_16x16x32_bf16 v[108:111], a[132:135], v[28:31], v[108:111]
  v_mfma_f32_16x16x32_bf16 v[120:123], a[136:139], v[28:31], v[120:123]
  buffer_store_dwordx4 v[128:131], v7, s[4:7], s21 offen offset:0 sc1
  v_mfma_f32_16x16x32_bf16 v[124:127], a[140:143], v[28:31], v[124:127]
  s_waitcnt lgkmcnt(5)
  v_mfma_f32_16x16x32_bf16 v[96:99], a[144:147], v[32:35], v[96:99]
  ds_read_b128 v[24:27], v8 offset:57344
  v_mfma_f32_16x16x32_bf16 v[100:103], a[148:151], v[32:35], v[100:103]
  v_mfma_f32_16x16x32_bf16 v[112:115], a[152:155], v[32:35], v[112:115]
  v_mfma_f32_16x16x32_bf16 v[116:119], a[156:159], v[32:35], v[116:119]
  s_waitcnt lgkmcnt(5)
  v_xor_b32 v8, 0x10000, v8
  v_mfma_f32_16x16x32_bf16 v[104:107], a[144:147], v[36:39], v[104:107]
  ds_read_b128 v[28:31], v9 offset:57344
  v_mfma_f32_16x16x32_bf16 v[108:111], a[148:151], v[36:39], v[108:111]
  v_mfma_f32_16x16x32_bf16 v[120:123], a[152:155], v[36:39], v[120:123]
  buffer_store_dwordx4 v[132:135], v7, s[4:7], s21 offen offset:256 sc1
  v_mfma_f32_16x16x32_bf16 v[124:127], a[156:159], v[36:39], v[124:127]
  s_waitcnt lgkmcnt(5)
  v_xor_b32 v9, 0x10000, v9
  v_mfma_f32_16x16x32_bf16 v[96:99], a[160:163], v[40:43], v[96:99]
  ds_read_b128 v[32:35], v10 offset:57344
  v_mfma_f32_16x16x32_bf16 v[100:103], a[164:167], v[40:43], v[100:103]
  v_mfma_f32_16x16x32_bf16 v[112:115], a[168:171], v[40:43], v[112:115]
  v_mfma_f32_16x16x32_bf16 v[116:119], a[172:175], v[40:43], v[116:119]
  s_waitcnt lgkmcnt(5)
  v_xor_b32 v10, 0x10000, v10
  v_mfma_f32_16x16x32_bf16 v[104:107], a[160:163], v[44:47], v[104:107]
  ds_read_b128 v[36:39], v11 offset:57344
  v_mfma_f32_16x16x32_bf16 v[108:111], a[164:167], v[44:47], v[108:111]
  v_mfma_f32_16x16x32_bf16 v[120:123], a[168:171], v[44:47], v[120:123]
  buffer_store_dwordx4 v[136:139], v7, s[4:7], s21 offen offset:2048 sc1
  v_mfma_f32_16x16x32_bf16 v[124:127], a[172:175], v[44:47], v[124:127]
  s_waitcnt lgkmcnt(5)
  v_xor_b32 v11, 0x10000, v11
  v_mfma_f32_16x16x32_bf16 v[96:99], a[176:179], v[48:51], v[96:99]
  ds_read_b128 v[40:43], v12 offset:57344
  v_mfma_f32_16x16x32_bf16 v[100:103], a[180:183], v[48:51], v[100:103]
  v_mfma_f32_16x16x32_bf16 v[112:115], a[184:187], v[48:51], v[112:115]
  v_mfma_f32_16x16x32_bf16 v[116:119], a[188:191], v[48:51], v[116:119]
  s_waitcnt lgkmcnt(5)
  v_xor_b32 v12, 0x10000, v12
  v_mfma_f32_16x16x32_bf16 v[104:107], a[176:179], v[52:55], v[104:107]
  ds_read_b128 v[44:47], v13 offset:57344
  v_mfma_f32_16x16x32_bf16 v[108:111], a[180:183], v[52:55], v[108:111]
  v_mfma_f32_16x16x32_bf16 v[120:123], a[184:187], v[52:55], v[120:123]
  buffer_store_dwordx4 v[140:143], v7, s[4:7], s21 offen offset:2304 sc1
  v_mfma_f32_16x16x32_bf16 v[124:127], a[188:191], v[52:55], v[124:127]
  s_waitcnt lgkmcnt(5)
  v_xor_b32 v13, 0x10000, v13
  v_mfma_f32_16x16x32_bf16 v[96:99], a[192:195], v[24:27], v[96:99]
  s_mov_b32 s21, s27
  ds_read_b128 v[48:51], v14 offset:57344
  v_mfma_f32_16x16x32_bf16 v[100:103], a[196:199], v[24:27], v[100:103]
  v_mov_b32 v7, v56
  v_mfma_f32_16x16x32_bf16 v[112:115], a[200:203], v[24:27], v[112:115]
  v_mfma_f32_16x16x32_bf16 v[116:119], a[204:207], v[24:27], v[116:119]
  s_waitcnt lgkmcnt(5)
  v_xor_b32 v14, 0x10000, v14
  v_mfma_f32_16x16x32_bf16 v[104:107], a[192:195], v[28:31], v[104:107]
  s_add_u32 s27, s27, s22
  ds_read_b128 v[52:55], v15 offset:57344
  v_mfma_f32_16x16x32_bf16 v[108:111], a[196:199], v[28:31], v[108:111]
  v_mfma_f32_16x16x32_bf16 v[120:123], a[200:203], v[28:31], v[120:123]
  s_waitcnt vmcnt(17)
  s_barrier
  v_mfma_f32_16x16x32_bf16 v[124:127], a[204:207], v[28:31], v[124:127]
  s_waitcnt lgkmcnt(5)
  v_xor_b32 v15, 0x10000, v15
  v_mfma_f32_16x16x32_bf16 v[96:99], a[208:211], v[32:35], v[96:99]
  ds_read_b128 v[24:27], v8 offset:0
  v_mfma_f32_16x16x32_bf16 v[100:103], a[212:215], v[32:35], v[100:103]
  v_mfma_f32_16x16x32_bf16 v[112:115], a[216:219], v[32:35], v[112:115]
  v_mfma_f32_16x16x32_bf16 v[116:119], a[220:223], v[32:35], v[116:119]
  s_waitcnt lgkmcnt(5)
  v_mfma_f32_16x16x32_bf16 v[104:107], a[208:211], v[36:39], v[104:107]
  s_add_u32 s29, s29, 1
  ds_read_b128 v[28:31], v9 offset:0
  v_mfma_f32_16x16x32_bf16 v[108:111], a[212:215], v[36:39], v[108:111]
  v_mfma_f32_16x16x32_bf16 v[120:123], a[216:219], v[36:39], v[120:123]
  s_max_i32 s30, s29, 0
  v_mfma_f32_16x16x32_bf16 v[124:127], a[220:223], v[36:39], v[124:127]
  s_waitcnt lgkmcnt(5)
  v_mov_b32 v144, s30
  v_mfma_f32_16x16x32_bf16 v[96:99], a[224:227], v[40:43], v[96:99]
  ds_read_b128 v[32:35], v10 offset:0
  v_mfma_f32_16x16x32_bf16 v[100:103], a[228:231], v[40:43], v[100:103]
  v_mfma_f32_16x16x32_bf16 v[112:115], a[232:235], v[40:43], v[112:115]
  buffer_store_dword v144, v145, s[4:7], s31 offen sc1
  v_mfma_f32_16x16x32_bf16 v[116:119], a[236:239], v[40:43], v[116:119]
  s_waitcnt lgkmcnt(5)
  v_mfma_f32_16x16x32_bf16 v[104:107], a[224:227], v[44:47], v[104:107]
  ds_read_b128 v[36:39], v11 offset:0
  v_mfma_f32_16x16x32_bf16 v[108:111], a[228:231], v[44:47], v[108:111]
  v_mfma_f32_16x16x32_bf16 v[120:123], a[232:235], v[44:47], v[120:123]
  v_mfma_f32_16x16x32_bf16 v[124:127], a[236:239], v[44:47], v[124:127]
  s_waitcnt lgkmcnt(5)
  v_mfma_f32_16x16x32_bf16 v[96:99], a[240:243], v[48:51], v[96:99]
  s_sub_u32 s23, s23, 1
  ds_read_b128 v[40:43], v12 offset:0
  v_mfma_f32_16x16x32_bf16 v[100:103], a[244:247], v[48:51], v[100:103]
  v_mfma_f32_16x16x32_bf16 v[112:115], a[248:251], v[48:51], v[112:115]
  v_mfma_f32_16x16x32_bf16 v[116:119], a[252:255], v[48:51], v[116:119]
  s_waitcnt lgkmcnt(5)
  v_mfma_f32_16x16x32_bf16 v[104:107], a[240:243], v[52:55], v[104:107]
  s_cmp_eq_u32 s23, 0
  ds_read_b128 v[44:47], v13 offset:0
  v_mfma_f32_16x16x32_bf16 v[108:111], a[244:247], v[52:55], v[108:111]
  v_mfma_f32_16x16x32_bf16 v[120:123], a[248:251], v[52:55], v[120:123]
  v_mfma_f32_16x16x32_bf16 v[124:127], a[252:255], v[52:55], v[124:127]
  s_cbranch_scc1 G_done1_5
  s_branch G_top_3
G_done0_4:
  s_nop 7
  s_nop 3
  v_mul_f32 v64, s24, v64
  v_mul_f32 v65, s24, v65
  v_cvt_pk_bf16_f32 v128, v64, v65
  v_mul_f32 v66, s24, v66
  v_mul_f32 v67, s24, v67
  v_cvt_pk_bf16_f32 v129, v66, v67
  v_mul_f32 v68, s24, v68
  v_mul_f32 v69, s24, v69
  v_cvt_pk_bf16_f32 v130, v68, v69
  v_mul_f32 v70, s24, v70
  v_mul_f32 v71, s24, v71
  v_cvt_pk_bf16_f32 v131, v70, v71
  buffer_store_dwordx4 v[128:131], v7, s[4:7], s21 offen offset:0 sc1
  v_mul_f32 v72, s24, v72
  v_mul_f32 v73, s24, v73
  v_cvt_pk_bf16_f32 v132, v72, v73
  v_mul_f32 v74, s24, v74
  v_mul_f32 v75, s24, v75
  v_cvt_pk_bf16_f32 v133, v74, v75
  v_mul_f32 v76, s24, v76
  v_mul_f32 v77, s24, v77
  v_cvt_pk_bf16_f32 v134, v76, v77
  v_mul_f32 v78, s24, v78
  v_mul_f32 v79, s24, v79
  v_cvt_pk_bf16_f32 v135, v78, v79
  buffer_store_dwordx4 v[132:135], v7, s[4:7], s21 offen offset:256 sc1
  v_mul_f32 v80, s24, v80
  v_mul_f32 v81, s24, v81
  v_cvt_pk_bf16_f32 v136, v80, v81
  v_mul_f32 v82, s24, v82
  v_mul_f32 v83, s24, v83
  v_cvt_pk_bf16_f32 v137, v82, v83
  v_mul_f32 v84, s24, v84
  v_mul_f32 v85, s24, v85
  v_cvt_pk_bf16_f32 v138, v84, v85
  v_mul_f32 v86, s24, v86
  v_mul_f32 v87, s24, v87
  v_cvt_pk_bf16_f32 v139, v86, v87
  buffer_store_dwordx4 v[136:139], v7, s[4:7], s21 offen offset:2048 sc1
  v_mul_f32 v88, s24, v88
  v_mul_f32 v89, s24, v89
  v_cvt_pk_bf16_f32 v140, v88, v89
  v_mul_f32 v90, s24, v90
  v_mul_f32 v91, s24, v91
  v_cvt_pk_bf16_f32 v141, v90, v91
  v_mul_f32 v92, s24, v92
  v_mul_f32 v93, s24, v93
  v_cvt_pk_bf16_f32 v142, v92, v93
  v_mul_f32 v94, s24, v94
  v_mul_f32 v95, s24, v95
  v_cvt_pk_bf16_f32 v143, v94, v95
  buffer_store_dwordx4 v[140:143], v7, s[4:7], s21 offen offset:2304 sc1
  s_branch G_fin_6
G_done1_5:
  s_nop 7
  s_nop 3
  v_mul_f32 v96, s24, v96
  v_mul_f32 v97, s24, v97
  v_cvt_pk_bf16_f32 v128, v96, v97
  v_mul_f32 v98, s24, v98
  v_mul_f32 v99, s24, v99
  v_cvt_pk_bf16_f32 v129, v98, v99
  v_mul_f32 v100, s24, v100
  v_mul_f32 v101, s24, v101
  v_cvt_pk_bf16_f32 v130, v100, v101
  v_mul_f32 v102, s24, v102
  v_mul_f32 v103, s24, v103
  v_cvt_pk_bf16_f32 v131, v102, v103
  buffer_store_dwordx4 v[128:131], v7, s[4:7], s21 offen offset:0 sc1
  v_mul_f32 v104, s24, v104
  v_mul_f32 v105, s24, v105
  v_cvt_pk_bf16_f32 v132, v104, v105
  v_mul_f32 v106, s24, v106
  v_mul_f32 v107, s24, v107
  v_cvt_pk_bf16_f32 v133, v106, v107
  v_mul_f32 v108, s24, v108
  v_mul_f32 v109, s24, v109
  v_cvt_pk_bf16_f32 v134, v108, v109
  v_mul_f32 v110, s24, v110
  v_mul_f32 v111, s24, v111
  v_cvt_pk_bf16_f32 v135, v110, v111
  buffer_store_dwordx4 v[132:135], v7, s[4:7], s21 offen offset:256 sc1
  v_mul_f32 v112, s24, v112
  v_mul_f32 v113, s24, v113
  v_cvt_pk_bf16_f32 v136, v112, v113
  v_mul_f32 v114, s24, v114
  v_mul_f32 v115, s24, v115
  v_cvt_pk_bf16_f32 v137, v114, v115
  v_mul_f32 v116, s24, v116
  v_mul_f32 v117, s24, v117
  v_cvt_pk_bf16_f32 v138, v116, v117
  v_mul_f32 v118, s24, v118
  v_mul_f32 v119, s24, v119
  v_cvt_pk_bf16_f32 v139, v118, v119
  buffer_store_dwordx4 v[136:139], v7, s[4:7], s21 offen offset:2048 sc1
  v_mul_f32 v120, s24, v120
  v_mul_f32 v121, s24, v121
  v_cvt_pk_bf16_f32 v140, v120, v121
  v_mul_f32 v122, s24, v122
  v_mul_f32 v123, s24, v123
  v_cvt_pk_bf16_f32 v141, v122, v123
  v_mul_f32 v124, s24, v124
  v_mul_f32 v125, s24, v125
  v_cvt_pk_bf16_f32 v142, v124, v125
  v_mul_f32 v126, s24, v126
  v_mul_f32 v127, s24, v127
  v_cvt_pk_bf16_f32 v143, v126, v127
  buffer_store_dwordx4 v[140:143], v7, s[4:7], s21 offen offset:2304 sc1
G_fin_6:
  s_waitcnt vmcnt(0) lgkmcnt(0)
  s_barrier
  s_add_u32 s30, s29, 3
  v_mov_b32 v144, s30
  v_min_u32 v145, 1, v0
  v_lshlrev_b32 v145, 30, v145
  buffer_store_dword v144, v145, s[4:7], s31 offen sc1
  s_branch P_end_2
P_v_1:
  s_mov_b32 s27, s21
  v_mov_b32 v7, 0x40000000
  s_mov_b32 s29, -3
  v_min_u32 v145, 1, v0
  v_lshlrev_b32 v145, 30, v145
  ds_read_b128 v[24:27], v8 offset:0
  ds_read_b128 v[28:31], v9 offset:0
  ds_read_b128 v[32:35], v10 offset:0
  ds_read_b128 v[36:39], v11 offset:0
  ds_read_b128 v[40:43], v12 offset:0
  ds_read_b128 v[44:47], v13 offset:0
.p2align 6
G_top_7:
  s_waitcnt lgkmcnt(5)
  v_mfma_f32_16x16x32_bf16 v[64:67], v[24:27], a[0:3], 0
  s_add_u32 m0, s25, 0
  ds_read_b128 v[48:51], v14 offset:0
  v_mfma_f32_16x16x32_bf16 v[72:75], v[24:27], a[4:7], 0
  v_mfma_f32_16x16x32_bf16 v[80:83], v[24:27], a[8:11], 0
  buffer_load_dwordx4 v16, s[12:15], s19 offen lds
  v_mfma_f32_16x16x32_bf16 v[88:91], v[24:27], a[12:15], 0
  s_waitcnt lgkmcnt(5)
  v_mfma_f32_16x16x32_bf16 v[68:71], v[28:31], a[0:3], 0
  ds_read_b128 v[52:55], v15 offset:0
  v_mfma_f32_16x16x32_bf16 v[76:79], v[28:31], a[4:7], 0
  v_mul_f32 v96, s24, v96
  v_mul_f32 v97, s24, v97
  v_mfma_f32_16x16x32_bf16 v[84:87], v[28:31], a[8:11], 0
  v_mfma_f32_16x16x32_bf16 v[92:95], v[28:31], a[12:15], 0
  s_waitcnt lgkmcnt(5)
  v_cvt_pk_bf16_f32 v128, v96, v97
  v_mul_f32 v98, s24, v98
  v_mfma_f32_16x16x32_bf16 v[64:67], v[32:35], a[16:19], v[64:67]
  s_add_u32 m0, s25, 1024
  ds_read_b128 v[24:27], v8 offset:8192
  v_mfma_f32_16x16x32_bf16 v[72:75], v[32:35], a[20:23], v[72:75]
  v_mul_f32 v99, s24, v99
  v_cvt_pk_bf16_f32 v129, v98, v99
  v_mfma_f32_16x16x32_bf16 v[80:83], v[32:35], a[24:27], v[80:83]
  buffer_load_dwordx4 v17, s[12:15], s19 offen lds
  v_mfma_f32_16x16x32_bf16 v[88:91], v[32:35], a[28:31], v[88:91]
  s_waitcnt lgkmcnt(5)
  v_mul_f32 v100, s24, v100
  v_mul_f32 v101, s24, v101
  v_mfma_f32_16x16x32_bf16 v[68:71], v[36:39], a[16:19], v[68:71]
  ds_read_b128 v[28:31], v9 offset:8192
  v_mfma_f32_16x16x32_bf16 v[76:79], v[36:39], a[20:23], v[76:79]
  v_cvt_pk_bf16_f32 v130, v100, v101
  v_mul_f32 v102, s24, v102
  v_mfma_f32_16x16x32_bf16 v[84:87], v[36:39], a[24:27], v[84:87]
  v_mfma_f32_16x16x32_bf16 v[92:95], v[36:39], a[28:31], v[92:95]
  s_waitcnt lgkmcnt(5)
  v_mul_f32 v103, s24, v103
  v_cvt_pk_bf16_f32 v131, v102, v103
  v_mfma_f32_16x16x32_bf16 v[64:67], v[40:43], a[32:35], v[64:67]
  s_add_u32 m0, s25, 2048
  ds_read_b128 v[32:35], v10 offset:8192
  v_mfma_f32_16x16x32_bf16 v[72:75], v[40:43], a[36:39], v[72:75]
  v_mul_f32 v104, s24, v104
  v_mul_f32 v105, s24, v105
  v_mfma_f32_16x16x32_bf16 v[80:83], v[40:43], a[40:43], v[80:83]
  buffer_load_dwordx4 v18, s[12:15], s19 offen lds
  v_mfma_f32_16x16x32_bf16 v[88:91], v[40:43], a[44:47], v[88:91]
  s_waitcnt lgkmcnt(5)
  v_cvt_pk_bf16_f32 v132, v104, v105
  v_mul_f32 v106, s24, v106
  v_mfma_f32_16x16x32_bf16 v[68:71], v[44:47], a[32:35], v[68:71]
  ds_read_b128 v[36:39], v11 offset:8192
  v_mfma_f32_16x16x32_bf16 v[76:79], v[44:47], a[36:39], v[76:79]
  v_mul_f32 v107, s24, v107
  v_cvt_pk_bf16_f32 v133, v106, v107
  v_mfma_f32_16x16x32_bf16 v[84:87], v[44:47], a[40:43], v[84:87]
  v_mfma_f32_16x16x32_bf16 v[92:95], v[44:47], a[44:47], v[92:95]
  s_waitcnt lgkmcnt(5)
  v_mul_f32 v108, s24, v108
  v_mul_f32 v109, s24, v109
  v_mfma_f32_16x16x32_bf16 v[64:67], v[48:51], a[48:51], v[64:67]
  s_add_u32 m0, s25, 3072
  ds_read_b128 v[40:43], v12 offset:8192
  v_mfma_f32_16x16x32_bf16 v[72:75], v[48:51], a[52:55], v[72:75]
  v_cvt_pk_bf16_f32 v134, v108, v109
  v_mul_f32 v110, s24, v110
  v_mfma_f32_16x16x32_bf16 v[80:83], v[48:51], a[56:59], v[80:83]
  buffer_load_dwordx4 v19, s[12:15], s19 offen lds
  v_mfma_f32_16x16x32_bf16 v[88:91], v[48:51], a[60:63], v[88:91]
  s_waitcnt lgkmcnt(5)
  v_mul_f32 v111, s24, v111
  v_cvt_pk_bf16_f32 v135, v110, v111
  v_mfma_f32_16x16x32_bf16 v[68:71], v[52:55], a[48:51], v[68:71]
  ds_read_b128 v[44:47], v13 offset:8192
  v_mfma_f32_16x16x32_bf16 v[76:79], v[52:55], a[52:55], v[76:79]
  v_mul_f32 v112, s24, v112
  v_mul_f32 v113, s24, v113
  v_mfma_f32_16x16x32_bf16 v[84:87], v[52:55], a[56:59], v[84:87]
  v_mfma_f32_16x16x32_bf16 v[92:95], v[52:55], a[60:63], v[92:95]
  s_waitcnt lgkmcnt(5)
  v_cvt_pk_bf16_f32 v136, v112, v113
  v_mul_f32 v114, s24, v114
  v_mfma_f32_16x16x32_bf16 v[64:67], v[24:27], a[64:67], v[64:67]
  s_add_u32 m0, s25, 4096
  ds_read_b128 v[48:51], v14 offset:8192
  v_mfma_f32_16x16x32_bf16 v[72:75], v[24:27], a[68:71], v[72:75]
  v_mul_f32 v115, s24, v115
  v_cvt_pk_bf16_f32 v137, v114, v115
  v_mfma_f32_16x16x32_bf16 v[80:83], v[24:27], a[72:75], v[80:83]
  buffer_load_dwordx4 v20, s[12:15], s19 offen lds
  v_mfma_f32_16x16x32_bf16 v[88:91], v[24:27], a[76:79], v[88:91]
  s_waitcnt lgkmcnt(5)
  v_mul_f32 v116, s24, v116
  v_mul_f32 v117, s24, v117
  v_mfma_f32_16x16x32_bf16 v[68:71], v[28:31], a[64:67], v[68:71]
  ds_read_b128 v[52:55], v15 offset:8192
  v_mfma_f32_16x16x32_bf16 v[76:79], v[28:31], a[68:71], v[76:79]
  v_cvt_pk_bf16_f32 v138, v116, v117
  v_mul_f32 v118, s24, v118
  v_mfma_f32_16x16x32_bf16 v[84:87], v[28:31], a[72:75], v[84:87]
  v_mfma_f32_16x16x32_bf16 v[92:95], v[28:31], a[76:79], v[92:95]
  s_waitcnt lgkmcnt(5)
  v_mul_f32 v119, s24, v119
  v_cvt_pk_bf16_f32 v139, v118, v119
  v_mfma_f32_16x16x32_bf16 v[64:67], v[32:35], a[80:83], v[64:67]
  s_add_u32 m0, s25, 5120
  ds_read_b128 v[24:27], v8 offset:16384
  v_mfma_f32_16x16x32_bf16 v[72:75], v[32:35], a[84:87], v[72:75]
  v_mul_f32 v120, s24, v120
  v_mul_f32 v121, s24, v121
  v_mfma_f32_16x16x32_bf16 v[80:83], v[32:35], a[88:91], v[80:83]
  buffer_load_dwordx4 v21, s[12:15], s19 offen lds
  v_mfma_f32_16x16x32_bf16 v[88:91], v[32:35], a[92:95], v[88:91]
  s_waitcnt lgkmcnt(5)
  v_cvt_pk_bf16_f32 v140, v120, v121
  v_mul_f32 v122, s24, v122
  v_mfma_f32_16x16x32_bf16 v[68:71], v[36:39], a[80:83], v[68:71]
  ds_read_b128 v[28:31], v9 offset:16384
  v_mfma_f32_16x16x32_bf16 v[76:79], v[36:39], a[84:87], v[76:79]
  v_mul_f32 v123, s24, v123
  v_cvt_pk_bf16_f32 v141, v122, v123
  v_mfma_f32_16x16x32_bf16 v[84:87], v[36:39], a[88:91], v[84:87]
  v_mfma_f32_16x16x32_bf16 v[92:95], v[36:39], a[92:95], v[92:95]
  s_waitcnt lgkmcnt(5)
  v_mul_f32 v124, s24, v124
  v_mul_f32 v125, s24, v125
  v_mfma_f32_16x16x32_bf16 v[64:67], v[40:43], a[96:99], v[64:67]
  s_add_u32 m0, s25, 6144
  ds_read_b128 v[32:35], v10 offset:16384
  v_mfma_f32_16x16x32_bf16 v[72:75], v[40:43], a[100:103], v[72:75]
  v_cvt_pk_bf16_f32 v142, v124, v125
  v_mul_f32 v126, s24, v126
  v_mfma_f32_16x16x32_bf16 v[80:83], v[40:43], a[104:107], v[80:83]
  buffer_load_dwordx4 v22, s[12:15], s19 offen lds
  v_mfma_f32_16x16x32_bf16 v[88:91], v[40:43], a[108:111], v[88:91]
  s_waitcnt lgkmcnt(5)
  v_mul_f32 v127, s24, v127
  v_cvt_pk_bf16_f32 v143, v126, v127
  v_mfma_f32_16x16x32_bf16 v[68:71], v[44:47], a[96:99], v[68:71]
  ds_read_b128 v[36:39], v11 offset:16384
  v_mfma_f32_16x16x32_bf16 v[76:79], v[44:47], a[100:103], v[76:79]
  v_mfma_f32_16x16x32_bf16 v[84:87], v[44:47], a[104:107], v[84:87]
  v_mfma_f32_16x16x32_bf16 v[92:95], v[44:47], a[108:111], v[92:95]
  s_waitcnt lgkmcnt(5)
  v_mfma_f32_16x16x32_bf16 v[64:67], v[48:51], a[112:115], v[64:67]
  s_add_u32 m0, s25, 7168
  ds_read_b128 v[40:43], v12 offset:16384
  v_mfma_f32_16x16x32_bf16 v[72:75], v[48:51], a[116:119], v[72:75]
  v_mfma_f32_16x16x32_bf16 v[80:83], v[48:51], a[120:123], v[80:83]
  buffer_load_dwordx4 v23, s[12:15], s19 offen lds
  v_mfma_f32_16x16x32_bf16 v[88:91], v[48:51], a[124:127], v[88:91]
  s_waitcnt lgkmcnt(5)
  v_mfma_f32_16x16x32_bf16 v[68:71], v[52:55], a[112:115], v[68:71]
  s_cmp_gt_u32 s23, 3
  ds_read_b128 v[44:47], v13 offset:16384
  v_mfma_f32_16x16x32_bf16 v[76:79], v[52:55], a[116:119], v[76:79]
  v_mfma_f32_16x16x32_bf16 v[84:87], v[52:55], a[120:123], v[84:87]
  s_cselect_b32 s26, s20, 0
  v_mfma_f32_16x16x32_bf16 v[92:95], v[52:55], a[124:127], v[92:95]
  s_waitcnt lgkmcnt(5)
  v_mfma_f32_16x16x32_bf16 v[64:67], v[24:27], a[128:131], v[64:67]
  s_add_u32 s19, s19, s26
  ds_read_b128 v[48:51], v14 offset:16384
  v_mfma_f32_16x16x32_bf16 v[72:75], v[24:27], a[132:135], v[72:75]
  v_mfma_f32_16x16x32_bf16 v[80:83], v[24:27], a[136:139], v[80:83]
  s_add_u32 s25, s25, 32768
  v_mfma_f32_16x16x32_bf16 v[88:91], v[24:27], a[140:143], v[88:91]
  s_waitcnt lgkmcnt(5)
  v_mfma_f32_16x16x32_bf16 v[68:71], v[28:31], a[128:131], v[68:71]
  s_and_b32 s25, s25, 0x1ffff
  ds_read_b128 v[52:55], v15 offset:16384
  v_mfma_f32_16x16x32_bf16 v[76:79], v[28:31], a[132:135], v[76:79]
  v_mfma_f32_16x16x32_bf16 v[84:87], v[28:31], a[136:139], v[84:87]
  buffer_store_dwordx4 v[128:131], v7, s[4:7], s21 offen offset:0 sc1
  v_mfma_f32_16x16x32_bf16 v[92:95], v[28:31], a[140:143], v[92:95]
  s_waitcnt lgkmcnt(5)
  v_mfma_f32_16x16x32_bf16 v[64:67], v[32:35], a[144:147], v[64:67]
  ds_read_b128 v[24:27], v8 offset:24576
  v_mfma_f32_16x16x32_bf16 v[72:75], v[32:35], a[148:151], v[72:75]
  v_mfma_f32_16x16x32_bf16 v[80:83], v[32:35], a[152:155], v[80:83]
  v_mfma_f32_16x16x32_bf16 v[88:91], v[32:35], a[156:159], v[88:91]
  s_waitcnt lgkmcnt(5)
  v_mfma_f32_16x16x32_bf16 v[68:71], v[36:39], a[144:147], v[68:71]
  ds_read_b128 v[28:31], v9 offset:24576
  v_mfma_f32_16x16x32_bf16 v[76:79], v[36:39], a[148:151], v[76:79]
  v_mfma_f32_16x16x32_bf16 v[84:87], v[36:39], a[152:155], v[84:87]
  buffer_store_dwordx4 v[132:135], v7, s[4:7], s21 offen offset:256 sc1
  v_mfma_f32_16x16x32_bf16 v[92:95], v[36:39], a[156:159], v[92:95]
  s_waitcnt lgkmcnt(5)
  v_mfma_f32_16x16x32_bf16 v[64:67], v[40:43], a[160:163], v[64:67]
  ds_read_b128 v[32:35], v10 offset:24576
  v_mfma_f32_16x16x32_bf16 v[72:75], v[40:43], a[164:167], v[72:75]
  v_mfma_f32_16x16x32_bf16 v[80:83], v[40:43], a[168:171], v[80:83]
  v_mfma_f32_16x16x32_bf16 v[88:91], v[40:43], a[172:175], v[88:91]
  s_waitcnt lgkmcnt(5)
  v_mfma_f32_16x16x32_bf16 v[68:71], v[44:47], a[160:163], v[68:71]
  ds_read_b128 v[36:39], v11 offset:24576
  v_mfma_f32_16x16x32_bf16 v[76:79], v[44:47], a[164:167], v[76:79]
  v_mfma_f32_16x16x32_bf16 v[84:87], v[44:47], a[168:171], v[84:87]
  buffer_store_dwordx4 v[136:139], v7, s[4:7], s21 offen offset:2048 sc1
  v_mfma_f32_16x16x32_bf16 v[92:95], v[44:47], a[172:175], v[92:95]
  s_waitcnt lgkmcnt(5)
  v_mfma_f32_16x16x32_bf16 v[64:67], v[48:51], a[176:179], v[64:67]
  ds_read_b128 v[40:43], v12 offset:24576
  v_mfma_f32_16x16x32_bf16 v[72:75], v[48:51], a[180:183], v[72:75]
  v_mfma_f32_16x16x32_bf16 v[80:83], v[48:51], a[184:187], v[80:83]
  v_mfma_f32_16x16x32_bf16 v[88:91], v[48:51], a[188:191], v[88:91]
  s_waitcnt lgkmcnt(5)
  v_mfma_f32_16x16x32_bf16 v[68:71], v[52:55], a[176:179], v[68:71]
  ds_read_b128 v[44:47], v13 offset:24576
  v_mfma_f32_16x16x32_bf16 v[76:79], v[52:55], a[180:183], v[76:79]
  v_mfma_f32_16x16x32_bf16 v[84:87], v[52:55], a[184:187], v[84:87]
  buffer_store_dwordx4 v[140:143], v7, s[4:7], s21 offen offset:2304 sc1
  v_mfma_f32_16x16x32_bf16 v[92:95], v[52:55], a[188:191], v[92:95]
  s_waitcnt lgkmcnt(5)
  v_mfma_f32_16x16x32_bf16 v[64:67], v[24:27], a[192:195], v[64:67]
  s_mov_b32 s21, s27
  ds_read_b128 v[48:51], v14 offset:24576
  v_mfma_f32_16x16x32_bf16 v[72:75], v[24:27], a[196:199], v[72:75]
  v_mov_b32 v7, v56
  v_mfma_f32_16x16x32_bf16 v[80:83], v[24:27], a[200:203], v[80:83]
  v_mfma_f32_16x16x32_bf16 v[88:91], v[24:27], a[204:207], v[88:91]
  s_waitcnt lgkmcnt(5)
  v_mfma_f32_16x16x32_bf16 v[68:71], v[28:31], a[192:195], v[68:71]
  s_add_u32 s27, s27, s22
  ds_read_b128 v[52:55], v15 offset:24576
  v_mfma_f32_16x16x32_bf16 v[76:79], v[28:31], a[196:199], v[76:79]
  v_mfma_f32_16x16x32_bf16 v[84:87], v[28:31], a[200:203], v[84:87]
  s_waitcnt vmcnt(17)
  s_barrier
  v_mfma_f32_16x16x32_bf16 v[92:95], v[28:31], a[204:207], v[92:95]
  s_waitcnt lgkmcnt(5)
  v_mfma_f32_16x16x32_bf16 v[64:67], v[32:35], a[208:211], v[64:67]
  ds_read_b128 v[24:27], v8 offset:32768
  v_mfma_f32_16x16x32_bf16 v[72:75], v[32:35], a[212:215], v[72:75]
  v_mfma_f32_16x16x32_bf16 v[80:83], v[32:35], a[216:219], v[80:83]
  v_mfma_f32_16x16x32_bf16 v[88:91], v[32:35], a[220:223], v[88:91]
  s_waitcnt lgkmcnt(5)
  v_mfma_f32_16x16x32_bf16 v[68:71], v[36:39], a[208:211], v[68:71]
  s_add_u32 s29, s29, 1
  ds_read_b128 v[28:31], v9 offset:32768
  v_mfma_f32_16x16x32_bf16 v[76:79], v[36:39], a[212:215], v[76:79]
  v_mfma_f32_16x16x32_bf16 v[84:87], v[36:39], a[216:219], v[84:87]
  s_max_i32 s30, s29, 0
  v_mfma_f32_16x16x32_bf16 v[92:95], v[36:39], a[220:223], v[92:95]
  s_waitcnt lgkmcnt(5)
  v_mov_b32 v144, s30
  v_mfma_f32_16x16x32_bf16 v[64:67], v[40:43], a[224:227], v[64:67]
  ds_read_b128 v[32:35], v10 offset:32768
  v_mfma_f32_16x16x32_bf16 v[72:75], v[40:43], a[228:231], v[72:75]
  v_mfma_f32_16x16x32_bf16 v[80:83], v[40:43], a[232:235], v[80:83]
  buffer_store_dword v144, v145, s[4:7], s31 offen sc1
  v_mfma_f32_16x16x32_bf16 v[88:91], v[40:43], a[236:239], v[88:91]
  s_waitcnt lgkmcnt(5)
  v_mfma_f32_16x16x32_bf16 v[68:71], v[44:47], a[224:227], v[68:71]
  ds_read_b128 v[36:39], v11 offset:32768
  v_mfma_f32_16x16x32_bf16 v[76:79], v[44:47], a[228:231], v[76:79]
  v_mfma_f32_16x16x32_bf16 v[84:87], v[44:47], a[232:235], v[84:87]
  v_mfma_f32_16x16x32_bf16 v[92:95], v[44:47], a[236:239], v[92:95]
  s_waitcnt lgkmcnt(5)
  v_mfma_f32_16x16x32_bf16 v[64:67], v[48:51], a[240:243], v[64:67]
  s_sub_u32 s23, s23, 1
  ds_read_b128 v[40:43], v12 offset:32768
  v_mfma_f32_16x16x32_bf16 v[72:75], v[48:51], a[244:247], v[72:75]
  v_mfma_f32_16x16x32_bf16 v[80:83], v[48:51], a[248:251], v[80:83]
  v_mfma_f32_16x16x32_bf16 v[88:91], v[48:51], a[252:255], v[88:91]
  s_waitcnt lgkmcnt(5)
  v_mfma_f32_16x16x32_bf16 v[68:71], v[52:55], a[240:243], v[68:71]
  s_cmp_eq_u32 s23, 0
  ds_read_b128 v[44:47], v13 offset:32768
  v_mfma_f32_16x16x32_bf16 v[76:79], v[52:55], a[244:247], v[76:79]
  v_mfma_f32_16x16x32_bf16 v[84:87], v[52:55], a[248:251], v[84:87]
  v_mfma_f32_16x16x32_bf16 v[92:95], v[52:55], a[252:255], v[92:95]
  s_cbranch_scc1 G_done0_8
  s_waitcnt lgkmcnt(5)
  v_mfma_f32_16x16x32_bf16 v[96:99], v[24:27], a[0:3], 0
  s_add_u32 m0, s25, 0
  ds_read_b128 v[48:51], v14 offset:32768
  v_mfma_f32_16x16x32_bf16 v[104:107], v[24:27], a[4:7], 0
  v_mfma_f32_16x16x32_bf16 v[112:115], v[24:27], a[8:11], 0
  buffer_load_dwordx4 v16, s[12:15], s19 offen lds
  v_mfma_f32_16x16x32_bf16 v[120:123], v[24:27], a[12:15], 0
  s_waitcnt lgkmcnt(5)
  v_mfma_f32_16x16x32_bf16 v[100:103], v[28:31], a[0:3], 0
  ds_read_b128 v[52:55], v15 offset:32768
  v_mfma_f32_16x16x32_bf16 v[108:111], v[28:31], a[4:7], 0
  v_mul_f32 v64, s24, v64
  v_mul_f32 v65, s24, v65
  v_mfma_f32_16x16x32_bf16 v[116:119], v[28:31], a[8:11], 0
  v_mfma_f32_16x16x32_bf16 v[124:127], v[28:31], a[12:15], 0
  s_waitcnt lgkmcnt(5)
  v_cvt_pk_bf16_f32 v128, v64, v65
  v_mul_f32 v66, s24, v66
  v_mfma_f32_16x16x32_bf16 v[96:99], v[32:35], a[16:19], v[96:99]
  s_add_u32 m0, s25, 1024
  ds_read_b128 v[24:27], v8 offset:40960
  v_mfma_f32_16x16x32_bf16 v[104:107], v[32:35], a[20:23], v[104:107]
  v_mul_f32 v67, s24, v67
  v_cvt_pk_bf16_f32 v129, v66, v67
  v_mfma_f32_16x16x32_bf16 v[112:115], v[32:35], a[24:27], v[112:115]
  buffer_load_dwordx4 v17, s[12:15], s19 offen lds
  v_mfma_f32_16x16x32_bf16 v[120:123], v[32:35], a[28:31], v[120:123]
  s_waitcnt lgkmcnt(5)
  v_mul_f32 v68, s24, v68
  v_mul_f32 v69, s24, v69
  v_mfma_f32_16x16x32_bf16 v[100:103], v[36:39], a[16:19], v[100:103]
  ds_read_b128 v[28:31], v9 offset:40960
  v_mfma_f32_16x16x32_bf16 v[108:111], v[36:39], a[20:23], v[108:111]
  v_cvt_pk_bf16_f32 v130, v68, v69
  v_mul_f32 v70, s24, v70
  v_mfma_f32_16x16x32_bf16 v[116:119], v[36:39], a[24:27], v[116:119]
  v_mfma_f32_16x16x32_bf16 v[124:127], v[36:39], a[28:31], v[124:127]
  s_waitcnt lgkmcnt(5)
  v_mul_f32 v71, s24, v71
  v_cvt_pk_bf16_f32 v131, v70, v71
  v_mfma_f32_16x16x32_bf16 v[96:99], v[40:43], a[32:35], v[96:99]
  s_add_u32 m0, s25, 2048
  ds_read_b128 v[32:35], v10 offset:40960
  v_mfma_f32_16x16x32_bf16 v[104:107], v[40:43], a[36:39], v[104:107]
  v_mul_f32 v72, s24, v72
  v_mul_f32 v73, s24, v73
  v_mfma_f32_16x16x32_bf16 v[112:115], v[40:43], a[40:43], v[112:115]
  buffer_load_dwordx4 v18, s[12:15], s19 offen lds
  v_mfma_f32_16x16x32_bf16 v[120:123], v[40:43], a[44:47], v[120:123]
  s_waitcnt lgkmcnt(5)
  v_cvt_pk_bf16_f32 v132, v72, v73
  v_mul_f32 v74, s24, v74
  v_mfma_f32_16x16x32_bf16 v[100:103], v[44:47], a[32:35], v[100:103]
  ds_read_b128 v[36:39], v11 offset:40960
  v_mfma_f32_16x16x32_bf16 v[108:111], v[44:47], a[36:39], v[108:111]
  v_mul_f32 v75, s24, v75
  v_cvt_pk_bf16_f32 v133, v74, v75
  v_mfma_f32_16x16x32_bf16 v[116:119], v[44:47], a[40:43], v[116:119]
  v_mfma_f32_16x16x32_bf16 v[124:127], v[44:47], a[44:47], v[124:127]
  s_waitcnt lgkmcnt(5)
  v_mul_f32 v76, s24, v76
  v_mul_f32 v77, s24, v77
  v_mfma_f32_16x16x32_bf16 v[96:99], v[48:51], a[48:51], v[96:99]
  s_add_u32 m0, s25, 3072
  ds_read_b128 v[40:43], v12 offset:40960
  v_mfma_f32_16x16x32_bf16 v[104:107], v[48:51], a[52:55], v[104:107]
  v_cvt_pk_bf16_f32 v134, v76, v77
  v_mul_f32 v78, s24, v78
  v_mfma_f32_16x16x32_bf16 v[112:115], v[48:51], a[56:59], v[112:115]
  buffer_load_dwordx4 v19, s[12:15], s19 offen lds
  v_mfma_f32_16x16x32_bf16 v[120:123], v[48:51], a[60:63], v[120:123]
  s_waitcnt lgkmcnt(5)
  v_mul_f32 v79, s24, v79
  v_cvt_pk_bf16_f32 v135, v78, v79
  v_mfma_f32_16x16x32_bf16 v[100:103], v[52:55], a[48:51], v[100:103]
  ds_read_b128 v[44:47], v13 offset:40960
  v_mfma_f32_16x16x32_bf16 v[108:111], v[52:55], a[52:55], v[108:111]
  v_mul_f32 v80, s24, v80
  v_mul_f32 v81, s24, v81
  v_mfma_f32_16x16x32_bf16 v[116:119], v[52:55], a[56:59], v[116:119]
  v_mfma_f32_16x16x32_bf16 v[124:127], v[52:55], a[60:63], v[124:127]
  s_waitcnt lgkmcnt(5)
  v_cvt_pk_bf16_f32 v136, v80, v81
  v_mul_f32 v82, s24, v82
  v_mfma_f32_16x16x32_bf16 v[96:99], v[24:27], a[64:67], v[96:99]
  s_add_u32 m0, s25, 4096
  ds_read_b128 v[48:51], v14 offset:40960
  v_mfma_f32_16x16x32_bf16 v[104:107], v[24:27], a[68:71], v[104:107]
  v_mul_f32 v83, s24, v83
  v_cvt_pk_bf16_f32 v137, v82, v83
  v_mfma_f32_16x16x32_bf16 v[112:115], v[24:27], a[72:75], v[112:115]
  buffer_load_dwordx4 v20, s[12:15], s19 offen lds
  v_mfma_f32_16x16x32_bf16 v[120:123], v[24:27], a[76:79], v[120:123]
  s_waitcnt lgkmcnt(5)
  v_mul_f32 v84, s24, v84
  v_mul_f32 v85, s24, v85
  v_mfma_f32_16x16x32_bf16 v[100:103], v[28:31], a[64:67], v[100:103]
  ds_read_b128 v[52:55], v15 offset:40960
  v_mfma_f32_16x16x32_bf16 v[108:111], v[28:31], a[68:71], v[108:111]
  v_cvt_pk_bf16_f32 v138, v84, v85
  v_mul_f32 v86, s24, v86
  v_mfma_f32_16x16x32_bf16 v[116:119], v[28:31], a[72:75], v[116:119]
  v_mfma_f32_16x16x32_bf16 v[124:127], v[28:31], a[76:79], v[124:127]
  s_waitcnt lgkmcnt(5)
  v_mul_f32 v87, s24, v87
  v_cvt_pk_bf16_f32 v139, v86, v87
  v_mfma_f32_16x16x32_bf16 v[96:99], v[32:35], a[80:83], v[96:99]
  s_add_u32 m0, s25, 5120
  ds_read_b128 v[24:27], v8 offset:49152
  v_mfma_f32_16x16x32_bf16 v[104:107], v[32:35], a[84:87], v[104:107]
  v_mul_f32 v88, s24, v88
  v_mul_f32 v89, s24, v89
  v_mfma_f32_16x16x32_bf16 v[112:115], v[32:35], a[88:91], v[112:115]
  buffer_load_dwordx4 v21, s[12:15], s19 offen lds
  v_mfma_f32_16x16x32_bf16 v[120:123], v[32:35], a[92:95], v[120:123]
  s_waitcnt lgkmcnt(5)
  v_cvt_pk_bf16_f32 v140, v88, v89
  v_mul_f32 v90, s24, v90
  v_mfma_f32_16x16x32_bf16 v[100:103], v[36:39], a[80:83], v[100:103]
  ds_read_b128 v[28:31], v9 offset:49152
  v_mfma_f32_16x16x32_bf16 v[108:111], v[36:39], a[84:87], v[108:111]
  v_mul_f32 v91, s24, v91
  v_cvt_pk_bf16_f32 v141, v90, v91
  v_mfma_f32_16x16x32_bf16 v[116:119], v[36:39], a[88:91], v[116:119]
  v_mfma_f32_16x16x32_bf16 v[124:127], v[36:39], a[92:95], v[124:127]
  s_waitcnt lgkmcnt(5)
  v_mul_f32 v92, s24, v92
  v_mul_f32 v93, s24, v93
  v_mfma_f32_16x16x32_bf16 v[96:99], v[40:43], a[96:99], v[96:99]
  s_add_u32 m0, s25, 6144
  ds_read_b128 v[32:35], v10 offset:49152
  v_mfma_f32_16x16x32_bf16 v[104:107], v[40:43], a[100:103], v[104:107]
  v_cvt_pk_bf16_f32 v142, v92, v93
  v_mul_f32 v94, s24, v94
  v_mfma_f32_16x16x32_bf16 v[112:115], v[40:43], a[104:107], v[112:115]
  buffer_load_dwordx4 v22, s[12:15], s19 offen lds
  v_mfma_f32_16x16x32_bf16 v[120:123], v[40:43], a[108:111], v[120:123]
  s_waitcnt lgkmcnt(5)
  v_mul_f32 v95, s24, v95
  v_cvt_pk_bf16_f32 v143, v94, v95
  v_mfma_f32_16x16x32_bf16 v[100:103], v[44:47], a[96:99], v[100:103]
  ds_read_b128 v[36:39], v11 offset:49152
  v_mfma_f32_16x16x32_bf16 v[108:111], v[44:47], a[100:103], v[108:111]
  v_mfma_f32_16x16x32_bf16 v[116:119], v[44:47], a[104:107], v[116:119]
  v_mfma_f32_16x16x32_bf16 v[124:127], v[44:47], a[108:111], v[124:127]
  s_waitcnt lgkmcnt(5)
  v_mfma_f32_16x16x32_bf16 v[96:99], v[48:51], a[112:115], v[96:99]
  s_add_u32 m0, s25, 7168
  ds_read_b128 v[40:43], v12 offset:49152
  v_mfma_f32_16x16x32_bf16 v[104:107], v[48:51], a[116:119], v[104:107]
  v_mfma_f32_16x16x32_bf16 v[112:115], v[48:51], a[120:123], v[112:115]
  buffer_load_dwordx4 v23, s[12:15], s19 offen lds
  v_mfma_f32_16x16x32_bf16 v[120:123], v[48:51], a[124:127], v[120:123]
  s_waitcnt lgkmcnt(5)
  v_mfma_f32_16x16x32_bf16 v[100:103], v[52:55], a[112:115], v[100:103]
  s_cmp_gt_u32 s23, 3
  ds_read_b128 v[44:47], v13 offset:49152
  v_mfma_f32_16x16x32_bf16 v[108:111], v[52:55], a[116:119], v[108:111]
  v_mfma_f32_16x16x32_bf16 v[116:119], v[52:55], a[120:123], v[116:119]
  s_cselect_b32 s26, s20, 0
  v_mfma_f32_16x16x32_bf16 v[124:127], v[52:55], a[124:127], v[124:127]
  s_waitcnt lgkmcnt(5)
  v_mfma_f32_16x16x32_bf16 v[96:99], v[24:27], a[128:131], v[96:99]
  s_add_u32 s19, s19, s26
  ds_read_b128 v[48:51], v14 offset:49152
  v_mfma_f32_16x16x32_bf16 v[104:107], v[24:27], a[132:135], v[104:107]
  v_mfma_f32_16x16x32_bf16 v[112:115], v[24:27], a[136:139], v[112:115]
  s_add_u32 s25, s25, 32768
  v_mfma_f32_16x16x32_bf16 v[120:123], v[24:27], a[140:143], v[120:123]
  s_waitcnt lgkmcnt(5)
  v_mfma_f32_16x16x32_bf16 v[100:103], v[28:31], a[128:131], v[100:103]
  s_and_b32 s25, s25, 0x1ffff
  ds_read_b128 v[52:55], v15 offset:49152
  v_mfma_f32_16x16x32_bf16 v[108:111], v[28:31], a[132:135], v[108:111]
  v_mfma_f32_16x16x32_bf16 v[116:119], v[28:31], a[136:139], v[116:119]
  buffer_store_dwordx4 v[128:131], v7, s[4:7], s21 offen offset:0 sc1
  v_mfma_f32_16x16x32_bf16 v[124:127], v[28:31], a[140:143], v[124:127]
  s_waitcnt lgkmcnt(5)
  v_mfma_f32_16x16x32_bf16 v[96:99], v[32:35], a[144:147], v[96:99]
  ds_read_b128 v[24:27], v8 offset:57344
  v_mfma_f32_16x16x32_bf16 v[104:107], v[32:35], a[148:151], v[104:107]
  v_mfma_f32_16x16x32_bf16 v[112:115], v[32:35], a[152:155], v[112:115]
  v_mfma_f32_16x16x32_bf16 v[120:123], v[32:35], a[156:159], v[120:123]
  s_waitcnt lgkmcnt(5)
  v_xor_b32 v8, 0x10000, v8
  v_mfma_f32_16x16x32_bf16 v[100:103], v[36:39], a[144:147], v[100:103]
  ds_read_b128 v[28:31], v9 offset:57344
  v_mfma_f32_16x16x32_bf16 v[108:111], v[36:39], a[148:151], v[108:111]
  v_mfma_f32_16x16x32_bf16 v[116:119], v[36:39], a[152:155], v[116:119]
  buffer_store_dwordx4 v[132:135], v7, s[4:7], s21 offen offset:256 sc1
  v_mfma_f32_16x16x32_bf16 v[124:127], v[36:39], a[156:159], v[124:127]
  s_waitcnt lgkmcnt(5)
  v_xor_b32 v9, 0x10000, v9
  v_mfma_f32_16x16x32_bf16 v[96:99], v[40:43], a[160:163], v[96:99]
  ds_read_b128 v[32:35], v10 offset:57344
  v_mfma_f32_16x16x32_bf16 v[104:107], v[40:43], a[164:167], v[104:107]
  v_mfma_f32_16x16x32_bf16 v[112:115], v[40:43], a[168:171], v[112:115]
  v_mfma_f32_16x16x32_bf16 v[120:123], v[40:43], a[172:175], v[120:123]
  s_waitcnt lgkmcnt(5)
  v_xor_b32 v10, 0x10000, v10
  v_mfma_f32_16x16x32_bf16 v[100:103], v[44:47], a[160:163], v[100:103]
  ds_read_b128 v[36:39], v11 offset:57344
  v_mfma_f32_16x16x32_bf16 v[108:111], v[44:47], a[164:167], v[108:111]
  v_mfma_f32_16x16x32_bf16 v[116:119], v[44:47], a[168:171], v[116:119]
  buffer_store_dwordx4 v[136:139], v7, s[4:7], s21 offen offset:2048 sc1
  v_mfma_f32_16x16x32_bf16 v[124:127], v[44:47], a[172:175], v[124:127]
  s_waitcnt lgkmcnt(5)
  v_xor_b32 v11, 0x10000, v11
  v_mfma_f32_16x16x32_bf16 v[96:99], v[48:51], a[176:179], v[96:99]
  ds_read_b128 v[40:43], v12 offset:57344
  v_mfma_f32_16x16x32_bf16 v[104:107], v[48:51], a[180:183], v[104:107]
  v_mfma_f32_16x16x32_bf16 v[112:115], v[48:51], a[184:187], v[112:115]
  v_mfma_f32_16x16x32_bf16 v[120:123], v[48:51], a[188:191], v[120:123]
  s_waitcnt lgkmcnt(5)
  v_xor_b32 v12, 0x10000, v12
  v_mfma_f32_16x16x32_bf16 v[100:103], v[52:55], a[176:179], v[100:103]
  ds_read_b128 v[44:47], v13 offset:57344
  v_mfma_f32_16x16x32_bf16 v[108:111], v[52:55], a[180:183], v[108:111]
  v_mfma_f32_16x16x32_bf16 v[116:119], v[52:55], a[184:187], v[116:119]
  buffer_store_dwordx4 v[140:143], v7, s[4:7], s21 offen offset:2304 sc1
  v_mfma_f32_16x16x32_bf16 v[124:127], v[52:55], a[188:191], v[124:127]
  s_waitcnt lgkmcnt(5)
  v_xor_b32 v13, 0x10000, v13
  v_mfma_f32_16x16x32_bf16 v[96:99], v[24:27], a[192:195], v[96:99]
  s_mov_b32 s21, s27
  ds_read_b128 v[48:51], v14 offset:57344
  v_mfma_f32_16x16x32_bf16 v[104:107], v[24:27], a[196:199], v[104:107]
  v_mov_b32 v7, v56
  v_mfma_f32_16x16x32_bf16 v[112:115], v[24:27], a[200:203], v[112:115]
  v_mfma_f32_16x16x32_bf16 v[120:123], v[24:27], a[204:207], v[120:123]
  s_waitcnt lgkmcnt(5)
  v_xor_b32 v14, 0x10000, v14
  v_mfma_f32_16x16x32_bf16 v[100:103], v[28:31], a[192:195], v[100:103]
  s_add_u32 s27, s27, s22
  ds_read_b128 v[52:55], v15 offset:57344
  v_mfma_f32_16x16x32_bf16 v[108:111], v[28:31], a[196:199], v[108:111]
  v_mfma_f32_16x16x32_bf16 v[116:119], v[28:31], a[200:203], v[116:119]
  s_waitcnt vmcnt(17)
  s_barrier
  v_mfma_f32_16x16x32_bf16 v[124:127], v[28:31], a[204:207], v[124:127]
  s_waitcnt lgkmcnt(5)
  v_xor_b32 v15, 0x10000, v15
  v_mfma_f32_16x16x32_bf16 v[96:99], v[32:35], a[208:211], v[96:99]
  ds_read_b128 v[24:27], v8 offset:0
  v_mfma_f32_16x16x32_bf16 v[104:107], v[32:35], a[212:215], v[104:107]
  v_mfma_f32_16x16x32_bf16 v[112:115], v[32:35], a[216:219], v[112:115]
  v_mfma_f32_16x16x32_bf16 v[120:123], v[32:35], a[220:223], v[120:123]
  s_waitcnt lgkmcnt(5)
  v_mfma_f32_16x16x32_bf16 v[100:103], v[36:39], a[208:211], v[100:103]
  s_add_u32 s29, s29, 1
  ds_read_b128 v[28:31], v9 offset:0
  v_mfma_f32_16x16x32_bf16 v[108:111], v[36:39], a[212:215], v[108:111]
  v_mfma_f32_16x16x32_bf16 v[116:119], v[36:39], a[216:219], v[116:119]
  s_max_i32 s30, s29, 0
  v_mfma_f32_16x16x32_bf16 v[124:127], v[36:39], a[220:223], v[124:127]
  s_waitcnt lgkmcnt(5)
  v_mov_b32 v144, s30
  v_mfma_f32_16x16x32_bf16 v[96:99], v[40:43], a[224:227], v[96:99]
  ds_read_b128 v[32:35], v10 offset:0
  v_mfma_f32_16x16x32_bf16 v[104:107], v[40:43], a[228:231], v[104:107]
  v_mfma_f32_16x16x32_bf16 v[112:115], v[40:43], a[232:235], v[112:115]
  buffer_store_dword v144, v145, s[4:7], s31 offen sc1
  v_mfma_f32_16x16x32_bf16 v[120:123], v[40:43], a[236:239], v[120:123]
  s_waitcnt lgkmcnt(5)
  v_mfma_f32_16x16x32_bf16 v[100:103], v[44:47], a[224:227], v[100:103]
  ds_read_b128 v[36:39], v11 offset:0
  v_mfma_f32_16x16x32_bf16 v[108:111], v[44:47], a[228:231], v[108:111]
  v_mfma_f32_16x16x32_bf16 v[116:119], v[44:47], a[232:235], v[116:119]
  v_mfma_f32_16x16x32_bf16 v[124:127], v[44:47], a[236:239], v[124:127]
  s_waitcnt lgkmcnt(5)
  v_mfma_f32_16x16x32_bf16 v[96:99], v[48:51], a[240:243], v[96:99]
  s_sub_u32 s23, s23, 1
  ds_read_b128 v[40:43], v12 offset:0
  v_mfma_f32_16x16x32_bf16 v[104:107], v[48:51], a[244:247], v[104:107]
  v_mfma_f32_16x16x32_bf16 v[112:115], v[48:51], a[248:251], v[112:115]
  v_mfma_f32_16x16x32_bf16 v[120:123], v[48:51], a[252:255], v[120:123]
  s_waitcnt lgkmcnt(5)
  v_mfma_f32_16x16x32_bf16 v[100:103], v[52:55], a[240:243], v[100:103]
  s_cmp_eq_u32 s23, 0
  ds_read_b128 v[44:47], v13 offset:0
  v_mfma_f32_16x16x32_bf16 v[108:111], v[52:55], a[244:247], v[108:111]
  v_mfma_f32_16x16x32_bf16 v[116:119], v[52:55], a[248:251], v[116:119]
  v_mfma_f32_16x16x32_bf16 v[124:127], v[52:55], a[252:255], v[124:127]
  s_cbranch_scc1 G_done1_9
  s_branch G_top_7
G_done0_8:
  s_nop 7
  s_nop 3
  v_mul_f32 v64, s24, v64
  v_mul_f32 v65, s24, v65
  v_cvt_pk_bf16_f32 v128, v64, v65
  v_mul_f32 v66, s24, v66
  v_mul_f32 v67, s24, v67
  v_cvt_pk_bf16_f32 v129, v66, v67
  v_mul_f32 v68, s24, v68
  v_mul_f32 v69, s24, v69
  v_cvt_pk_bf16_f32 v130, v68, v69
  v_mul_f32 v70, s24, v70
  v_mul_f32 v71, s24, v71
  v_cvt_pk_bf16_f32 v131, v70, v71
  buffer_store_dwordx4 v[128:131], v7, s[4:7], s21 offen offset:0 sc1
  v_mul_f32 v72, s24, v72
  v_mul_f32 v73, s24, v73
  v_cvt_pk_bf16_f32 v132, v72, v73
  v_mul_f32 v74, s24, v74
  v_mul_f32 v75, s24, v75
  v_cvt_pk_bf16_f32 v133, v74, v75
  v_mul_f32 v76, s24, v76
  v_mul_f32 v77, s24, v77
  v_cvt_pk_bf16_f32 v134, v76, v77
  v_mul_f32 v78, s24, v78
  v_mul_f32 v79, s24, v79
  v_cvt_pk_bf16_f32 v135, v78, v79
  buffer_store_dwordx4 v[132:135], v7, s[4:7], s21 offen offset:256 sc1
  v_mul_f32 v80, s24, v80
  v_mul_f32 v81, s24, v81
  v_cvt_pk_bf16_f32 v136, v80, v81
  v_mul_f32 v82, s24, v82
  v_mul_f32 v83, s24, v83
  v_cvt_pk_bf16_f32 v137, v82, v83
  v_mul_f32 v84, s24, v84
  v_mul_f32 v85, s24, v85
  v_cvt_pk_bf16_f32 v138, v84, v85
  v_mul_f32 v86, s24, v86
  v_mul_f32 v87, s24, v87
  v_cvt_pk_bf16_f32 v139, v86, v87
  buffer_store_dwordx4 v[136:139], v7, s[4:7], s21 offen offset:2048 sc1
  v_mul_f32 v88, s24, v88
  v_mul_f32 v89, s24, v89
  v_cvt_pk_bf16_f32 v140, v88, v89
  v_mul_f32 v90, s24, v90
  v_mul_f32 v91, s24, v91
  v_cvt_pk_bf16_f32 v141, v90, v91
  v_mul_f32 v92, s24, v92
  v_mul_f32 v93, s24, v93
  v_cvt_pk_bf16_f32 v142, v92, v93
  v_mul_f32 v94, s24, v94
  v_mul_f32 v95, s24, v95
  v_cvt_pk_bf16_f32 v143, v94, v95
  buffer_store_dwordx4 v[140:143], v7, s[4:7], s21 offen offset:2304 sc1
  s_branch G_fin_10
G_done1_9:
  s_nop 7
  s_nop 3
  v_mul_f32 v96, s24, v96
  v_mul_f32 v97, s24, v97
  v_cvt_pk_bf16_f32 v128, v96, v97
  v_mul_f32 v98, s24, v98
  v_mul_f32 v99, s24, v99
  v_cvt_pk_bf16_f32 v129, v98, v99
  v_mul_f32 v100, s24, v100
  v_mul_f32 v101, s24, v101
  v_cvt_pk_bf16_f32 v130, v100, v101
  v_mul_f32 v102, s24, v102
  v_mul_f32 v103, s24, v103
  v_cvt_pk_bf16_f32 v131, v102, v103
  buffer_store_dwordx4 v[128:131], v7, s[4:7], s21 offen offset:0 sc1
  v_mul_f32 v104, s24, v104
  v_mul_f32 v105, s24, v105
  v_cvt_pk_bf16_f32 v132, v104, v105
  v_mul_f32 v106, s24, v106
  v_mul_f32 v107, s24, v107
  v_cvt_pk_bf16_f32 v133, v106, v107
  v_mul_f32 v108, s24, v108
  v_mul_f32 v109, s24, v109
  v_cvt_pk_bf16_f32 v134, v108, v109
  v_mul_f32 v110, s24, v110
  v_mul_f32 v111, s24, v111
  v_cvt_pk_bf16_f32 v135, v110, v111
  buffer_store_dwordx4 v[132:135], v7, s[4:7], s21 offen offset:256 sc1
  v_mul_f32 v112, s24, v112
  v_mul_f32 v113, s24, v113
  v_cvt_pk_bf16_f32 v136, v112, v113
  v_mul_f32 v114, s24, v114
  v_mul_f32 v115, s24, v115
  v_cvt_pk_bf16_f32 v137, v114, v115
  v_mul_f32 v116, s24, v116
  v_mul_f32 v117, s24, v117
  v_cvt_pk_bf16_f32 v138, v116, v117
  v_mul_f32 v118, s24, v118
  v_mul_f32 v119, s24, v119
  v_cvt_pk_bf16_f32 v139, v118, v119
  buffer_store_dwordx4 v[136:139], v7, s[4:7], s21 offen offset:2048 sc1
  v_mul_f32 v120, s24, v120
  v_mul_f32 v121, s24, v121
  v_cvt_pk_bf16_f32 v140, v120, v121
  v_mul_f32 v122, s24, v122
  v_mul_f32 v123, s24, v123
  v_cvt_pk_bf16_f32 v141, v122, v123
  v_mul_f32 v124, s24, v124
  v_mul_f32 v125, s24, v125
  v_cvt_pk_bf16_f32 v142, v124, v125
  v_mul_f32 v126, s24, v126
  v_mul_f32 v127, s24, v127
  v_cvt_pk_bf16_f32 v143, v126, v127
  buffer_store_dwordx4 v[140:143], v7, s[4:7], s21 offen offset:2304 sc1
G_fin_10:
  s_waitcnt vmcnt(0) lgkmcnt(0)
  s_barrier
  s_add_u32 s30, s29, 3
  v_mov_b32 v144, s30
  v_min_u32 v145, 1, v0
  v_lshlrev_b32 v145, 30, v145
  buffer_store_dword v144, v145, s[4:7], s31 offen sc1
P_end_2:
  s_mov_b32 s71, 0
  s_branch M_sg_12
M_sw_11:
  s_sleep 8
  s_add_u32 s71, s71, 1
  s_cmp_gt_u32 s71, 262144
  s_cbranch_scc1 M_exit
M_sg_12:
  s_mov_b32 s79, 0
  s_atomic_or s79, s[74:75], 128 glc
  s_waitcnt lgkmcnt(0)
  s_cmp_lt_u32 s79, 256
  s_cbranch_scc1 M_sw_11
  s_cmp_eq_u32 s65, 6
  s_cbranch_scc1 M_follow
  s_mov_b32 s68, 0
  s_mov_b32 s36, -1
  s_mov_b32 s69, s53
  s_mov_b32 s70, s54
  s_load_dwordx2 s[8:9], s[0:1], 40
  s_mul_i32 s76, s64, 6
  s_add_u32 s76, s76, s65
  s_mul_i32 s76, s76, 21888
  v_min_u32 v200, 170, v0
  v_lshl_add_u32 v200, v200, 7, s76
  s_waitcnt lgkmcnt(0)
  s_and_b32 s9, s9, 0xffff
  s_mov_b32 s10, 4194304
  s_mov_b32 s11, 0x20000
M_att:
  s_mov_b32 s24, 0xf149f2ca
  s_mov_b32 s29, 0
  v_mov_b32 v6, 0
  v_mov_b32 v7, 0
  s_lshl_b32 s26, s16, 11
  v_add_u32 v3, s26, v2
  v_and_b32 v5, 31, v1
  v_lshrrev_b32 v12, 5, v1
  v_lshlrev_b32 v12, 2, v12
  v_sub_u32 v5, v5, v12
  s_lshl_b32 s26, s64, 19
  s_add_u32 s19, s26, 16777216
  s_add_u32 s20, s26, 33554432
  s_lshl_b32 s27, s69, 2
  s_add_u32 s27, s27, s16
  s_lshl_b32 s27, s27, 14
  s_add_u32 s25, s26, s27
  s_bfe_u32 s78, s70, 0x80000
  s_add_u32 s76, s67, 512
  s_mov_b32 s71, 0
  s_branch M_sg_14
M_sw_13:
  s_sleep 8
  s_add_u32 s71, s71, 1
  s_cmp_gt_u32 s71, 262144
  s_cbranch_scc1 M_exit
M_sg_14:
  s_mov_b32 s79, 0
  s_atomic_or s79, s[72:73], s76 glc
  s_waitcnt lgkmcnt(0)
  s_cmp_lt_u32 s79, s78
  s_cbranch_scc1 M_sw_13
  s_bfe_u32 s78, s70, 0x80008
  s_add_u32 s76, s67, 640
  s_mov_b32 s71, 0
  s_branch M_sg_16
M_sw_15:
  s_sleep 8
  s_add_u32 s71, s71, 1
  s_cmp_gt_u32 s71, 262144
  s_cbranch_scc1 M_exit
M_sg_16:
  s_mov_b32 s79, 0
  s_atomic_or s79, s[72:73], s76 glc
  s_waitcnt lgkmcnt(0)
  s_cmp_lt_u32 s79, s78
  s_cbranch_scc1 M_sw_15
  s_lshl_b32 s27, s69, 16
  s_add_u32 s27, s27, 16384
  s_add_u32 s17, s19, s27
M_kv_17:
  s_cmp_ge_u32 s17, s36
  s_cbranch_scc1 M_kvok_18
  s_mov_b32 s76, 0
  s_mov_b32 s78, 23
  s_mov_b32 s77, 335872
  s_cmp_eq_u32 s68, 1
  s_cmov_b32 s76, 128
  s_cmov_b32 s78, 27
  s_cmov_b32 s77, 114688
  s_cmp_eq_u32 s68, 2
  s_cmov_b32 s76, 768
  s_cmov_b32 s78, 14
  s_cmov_b32 s77, 0
  s_add_u32 s76, s76, s67
  s_mov_b32 s71, 0
  s_branch M_sg_20
M_sw_19:
  s_sleep 8
  s_add_u32 s71, s71, 1
  s_cmp_gt_u32 s71, 262144
  s_cbranch_scc1 M_exit
M_sg_20:
  s_mov_b32 s79, 0
  s_atomic_or s79, s[72:73], s76 glc
  s_waitcnt lgkmcnt(0)
  s_cmp_lt_u32 s79, s78
  s_cbranch_scc1 M_sw_19
  s_add_u32 s36, s77, s19
  s_add_u32 s68, s68, 1
  s_branch M_kv_17
M_kvok_18:
  s_add_u32 s28, s25, 0
  buffer_load_dwordx4 a[128:131], v2, s[4:7], s28 offen offset:0 sc1
  buffer_load_dwordx4 a[132:135], v2, s[4:7], s28 offen offset:1024 sc1
  buffer_load_dwordx4 a[136:139], v2, s[4:7], s28 offen offset:2048 sc1
  buffer_load_dwordx4 a[140:143], v2, s[4:7], s28 offen offset:3072 sc1
  s_add_u32 s28, s25, 4096
  buffer_load_dwordx4 a[144:147], v2, s[4:7], s28 offen offset:0 sc1
  buffer_load_dwordx4 a[148:151], v2, s[4:7], s28 offen offset:1024 sc1
  buffer_load_dwordx4 a[152:155], v2, s[4:7], s28 offen offset:2048 sc1
  buffer_load_dwordx4 a[156:159], v2, s[4:7], s28 offen offset:3072 sc1
  s_add_u32 s28, s25, 8192
  buffer_load_dwordx4 a[160:163], v2, s[4:7], s28 offen offset:0 sc1
  buffer_load_dwordx4 a[164:167], v2, s[4:7], s28 offen offset:1024 sc1
  buffer_load_dwordx4 a[168:171], v2, s[4:7], s28 offen offset:2048 sc1
  buffer_load_dwordx4 a[172:175], v2, s[4:7], s28 offen offset:3072 sc1
  s_add_u32 s28, s25, 12288
  buffer_load_dwordx4 a[176:179], v2, s[4:7], s28 offen offset:0 sc1
  buffer_load_dwordx4 a[180:183], v2, s[4:7], s28 offen offset:1024 sc1
  buffer_load_dwordx4 a[184:187], v2, s[4:7], s28 offen offset:2048 sc1
  buffer_load_dwordx4 a[188:191], v2, s[4:7], s28 offen offset:3072 sc1
A_again_21:
  s_lshl_b32 s27, s69, 16
  s_add_u32 s27, s27, 57344
  s_add_u32 s17, s19, s27
  s_add_u32 s18, s20, s27
  s_lshl_b32 s21, s16, 11
  s_mov_b32 m0, s21
  s_nop 0
  buffer_load_dwordx4 v3, s[4:7], s18 offen offset:0 sc1 lds
  buffer_load_dwordx4 v3, s[4:7], s18 offen offset:1024 sc1 lds
  s_add_u32 m0, s21, 8192
  s_nop 0
  buffer_load_dwordx4 v3, s[4:7], s17 offen offset:0 sc1 lds
  buffer_load_dwordx4 v3, s[4:7], s17 offen offset:1024 sc1 lds
  s_add_u32 s18, s18, 8192
  s_sub_u32 s18, s18, 8192
  s_max_i32 s18, s18, s20
  s_sub_u32 s17, s17, 8192
  s_max_i32 s17, s17, s19
  s_add_u32 s21, s21, 16384
  s_and_b32 s21, s21, 131071
  s_mov_b32 m0, s21
  s_nop 0
  buffer_load_dwordx4 v3, s[4:7], s18 offen offset:0 sc1 lds
  buffer_load_dwordx4 v3, s[4:7], s18 offen offset:1024 sc1 lds
  s_add_u32 m0, s21, 8192
  s_nop 0
  buffer_load_dwordx4 v3, s[4:7], s17 offen offset:0 sc1 lds
  buffer_load_dwordx4 v3, s[4:7], s17 offen offset:1024 sc1 lds
  s_sub_u32 s18, s18, 8192
  s_max_i32 s18, s18, s20
  s_sub_u32 s17, s17, 8192
  s_max_i32 s17, s17, s19
  s_add_u32 s21, s21, 16384
  s_and_b32 s21, s21, 131071
  s_mov_b32 m0, s21
  s_nop 0
  buffer_load_dwordx4 v3, s[4:7], s18 offen offset:0 sc1 lds
  buffer_load_dwordx4 v3, s[4:7], s18 offen offset:1024 sc1 lds
  s_add_u32 m0, s21, 8192
  s_nop 0
  buffer_load_dwordx4 v3, s[4:7], s17 offen offset:0 sc1 lds
  buffer_load_dwordx4 v3, s[4:7], s17 offen offset:1024 sc1 lds
  s_sub_u32 s18, s18, 8192
  s_max_i32 s18, s18, s20
  s_sub_u32 s17, s17, 8192
  s_max_i32 s17, s17, s19
  s_add_u32 s21, s21, 16384
  s_and_b32 s21, s21, 131071
  s_mov_b32 m0, s21
  s_nop 0
  buffer_load_dwordx4 v3, s[4:7], s18 offen offset:0 sc1 lds
  buffer_load_dwordx4 v3, s[4:7], s18 offen offset:1024 sc1 lds
  s_add_u32 m0, s21, 8192
  s_nop 0
  buffer_load_dwordx4 v3, s[4:7], s17 offen offset:0 sc1 lds
  buffer_load_dwordx4 v3, s[4:7], s17 offen offset:1024 sc1 lds
  s_sub_u32 s18, s18, 8192
  s_max_i32 s18, s18, s20
  s_sub_u32 s17, s17, 8192
  s_max_i32 s17, s17, s19
  s_add_u32 s21, s21, 16384
  s_and_b32 s21, s21, 131071
  s_mov_b32 m0, s21
  s_nop 0
  buffer_load_dwordx4 v3, s[4:7], s18 offen offset:0 sc1 lds
  buffer_load_dwordx4 v3, s[4:7], s18 offen offset:1024 sc1 lds
  s_add_u32 m0, s21, 8192
  s_nop 0
  buffer_load_dwordx4 v3, s[4:7], s17 offen offset:0 sc1 lds
  buffer_load_dwordx4 v3, s[4:7], s17 offen offset:1024 sc1 lds
  s_sub_u32 s18, s18, 8192
  s_max_i32 s18, s18, s20
  s_sub_u32 s17, s17, 8192
  s_max_i32 s17, s17, s19
  s_add_u32 s21, s21, 16384
  s_and_b32 s21, s21, 131071
  s_mov_b32 m0, s21
  s_nop 0
  buffer_load_dwordx4 v3, s[4:7], s18 offen offset:0 sc1 lds
  buffer_load_dwordx4 v3, s[4:7], s18 offen offset:1024 sc1 lds
  s_add_u32 m0, s21, 8192
  s_nop 0
  buffer_load_dwordx4 v3, s[4:7], s17 offen offset:0 sc1 lds
  buffer_load_dwordx4 v3, s[4:7], s17 offen offset:1024 sc1 lds
  v_accvgpr_write_b32 a0, 0
  v_accvgpr_write_b32 a1, 0
  v_accvgpr_write_b32 a2, 0
  v_accvgpr_write_b32 a3, 0
  v_accvgpr_write_b32 a4, 0
  v_accvgpr_write_b32 a5, 0
  v_accvgpr_write_b32 a6, 0
  v_accvgpr_write_b32 a7, 0
  v_accvgpr_write_b32 a8, 0
  v_accvgpr_write_b32 a9, 0
  v_accvgpr_write_b32 a10, 0
  v_accvgpr_write_b32 a11, 0
  v_accvgpr_write_b32 a12, 0
  v_accvgpr_write_b32 a13, 0
  v_accvgpr_write_b32 a14, 0
  v_accvgpr_write_b32 a15, 0
  v_accvgpr_write_b32 a16, 0
  v_accvgpr_write_b32 a17, 0
  v_accvgpr_write_b32 a18, 0
  v_accvgpr_write_b32 a19, 0
  v_accvgpr_write_b32 a20, 0
  v_accvgpr_write_b32 a21, 0
  v_accvgpr_write_b32 a22, 0
  v_accvgpr_write_b32 a23, 0
  v_accvgpr_write_b32 a24, 0
  v_accvgpr_write_b32 a25, 0
  v_accvgpr_write_b32 a26, 0
  v_accvgpr_write_b32 a27, 0
  v_accvgpr_write_b32 a28, 0
  v_accvgpr_write_b32 a29, 0
  v_accvgpr_write_b32 a30, 0
  v_accvgpr_write_b32 a31, 0
  v_accvgpr_write_b32 a32, 0
  v_accvgpr_write_b32 a33, 0
  v_accvgpr_write_b32 a34, 0
  v_accvgpr_write_b32 a35, 0
  v_accvgpr_write_b32 a36, 0
  v_accvgpr_write_b32 a37, 0
  v_accvgpr_write_b32 a38, 0
  v_accvgpr_write_b32 a39, 0
  v_accvgpr_write_b32 a40, 0
  v_accvgpr_write_b32 a41, 0
  v_accvgpr_write_b32 a42, 0
  v_accvgpr_write_b32 a43, 0
  v_accvgpr_write_b32 a44, 0
  v_accvgpr_write_b32 a45, 0
  v_accvgpr_write_b32 a46, 0
  v_accvgpr_write_b32 a47, 0
  v_accvgpr_write_b32 a48, 0
  v_accvgpr_write_b32 a49, 0
  v_accvgpr_write_b32 a50, 0
  v_accvgpr_write_b32 a51, 0
  v_accvgpr_write_b32 a52, 0
  v_accvgpr_write_b32 a53, 0
  v_accvgpr_write_b32 a54, 0
  v_accvgpr_write_b32 a55, 0
  v_accvgpr_write_b32 a56, 0
  v_accvgpr_write_b32 a57, 0
  v_accvgpr_write_b32 a58, 0
  v_accvgpr_write_b32 a59, 0
  v_accvgpr_write_b32 a60, 0
  v_accvgpr_write_b32 a61, 0
  v_accvgpr_write_b32 a62, 0
  v_accvgpr_write_b32 a63, 0
  v_accvgpr_write_b32 a64, 0
  v_accvgpr_write_b32 a65, 0
  v_accvgpr_write_b32 a66, 0
  v_accvgpr_write_b32 a67, 0
  v_accvgpr_write_b32 a68, 0
  v_accvgpr_write_b32 a69, 0
  v_accvgpr_write_b32 a70, 0
  v_accvgpr_write_b32 a71, 0
  v_accvgpr_write_b32 a72, 0
  v_accvgpr_write_b32 a73, 0
  v_accvgpr_write_b32 a74, 0
  v_accvgpr_write_b32 a75, 0
  v_accvgpr_write_b32 a76, 0
  v_accvgpr_write_b32 a77, 0
  v_accvgpr_write_b32 a78, 0
  v_accvgpr_write_b32 a79, 0
  v_accvgpr_write_b32 a80, 0
  v_accvgpr_write_b32 a81, 0
  v_accvgpr_write_b32 a82, 0
  v_accvgpr_write_b32 a83, 0
  v_accvgpr_write_b32 a84, 0
  v_accvgpr_write_b32 a85, 0
  v_accvgpr_write_b32 a86, 0
  v_accvgpr_write_b32 a87, 0
  v_accvgpr_write_b32 a88, 0
  v_accvgpr_write_b32 a89, 0
  v_accvgpr_write_b32 a90, 0
  v_accvgpr_write_b32 a91, 0
  v_accvgpr_write_b32 a92, 0
  v_accvgpr_write_b32 a93, 0
  v_accvgpr_write_b32 a94, 0
  v_accvgpr_write_b32 a95, 0
  v_accvgpr_write_b32 a96, 0
  v_accvgpr_write_b32 a97, 0
  v_accvgpr_write_b32 a98, 0
  v_accvgpr_write_b32 a99, 0
  v_accvgpr_write_b32 a100, 0
  v_accvgpr_write_b32 a101, 0
  v_accvgpr_write_b32 a102, 0
  v_accvgpr_write_b32 a103, 0
  v_accvgpr_write_b32 a104, 0
  v_accvgpr_write_b32 a105, 0
  v_accvgpr_write_b32 a106, 0
  v_accvgpr_write_b32 a107, 0
  v_accvgpr_write_b32 a108, 0
  v_accvgpr_write_b32 a109, 0
  v_accvgpr_write_b32 a110, 0
  v_accvgpr_write_b32 a111, 0
  v_accvgpr_write_b32 a112, 0
  v_accvgpr_write_b32 a113, 0
  v_accvgpr_write_b32 a114, 0
  v_accvgpr_write_b32 a115, 0
  v_accvgpr_write_b32 a116, 0
  v_accvgpr_write_b32 a117, 0
  v_accvgpr_write_b32 a118, 0
  v_accvgpr_write_b32 a119, 0
  v_accvgpr_write_b32 a120, 0
  v_accvgpr_write_b32 a121, 0
  v_accvgpr_write_b32 a122, 0
  v_accvgpr_write_b32 a123, 0
  v_accvgpr_write_b32 a124, 0
  v_accvgpr_write_b32 a125, 0
  v_accvgpr_write_b32 a126, 0
  v_accvgpr_write_b32 a127, 0
  v_mov_b32 v8, 0
  v_mov_b32 v9, 0
  v_mov_b32 v10, 0
  v_mov_b32 v11, 0
  v_mov_b32 v52, 0
  v_mov_b32 v53, 0
  v_mov_b32 v54, s24
  v_mov_b32 v55, s24
  v_mov_b32 v56, s24
  v_mov_b32 v57, s24
  v_mov_b32 v58, s24
  v_mov_b32 v59, s24
  v_mov_b32 v60, s24
  v_mov_b32 v61, s24
  v_mov_b32 v62, s24
  v_mov_b32 v63, s24
  v_mov_b32 v104, 0
  v_mov_b32 v105, 0
  v_mov_b32 v4, v2
  v_mov_b32 v64, s24
  v_mov_b32 v65, s24
  v_mov_b32 v66, s24
  v_mov_b32 v67, s24
  v_mov_b32 v68, s24
  v_mov_b32 v69, s24
  v_mov_b32 v70, s24
  v_mov_b32 v71, s24
  v_mov_b32 v72, s24
  v_mov_b32 v73, s24
  v_mov_b32 v74, s24
  v_mov_b32 v75, s24
  v_mov_b32 v76, s24
  v_mov_b32 v77, s24
  v_mov_b32 v78, s24
  v_mov_b32 v79, s24
  v_mov_b32 v12, s24
  v_cmp_le_i32 s[40:41], 0, v5
  v_cmp_le_i32 s[42:43], 1, v5
  v_cmp_le_i32 s[44:45], 2, v5
  v_cmp_le_i32 s[46:47], 3, v5
  v_cndmask_b32 v80, v12, v7, s[40:41]
  v_cndmask_b32 v81, v12, v7, s[42:43]
  v_cndmask_b32 v82, v12, v7, s[44:45]
  v_cndmask_b32 v83, v12, v7, s[46:47]
  v_cmp_le_i32 s[40:41], 8, v5
  v_cmp_le_i32 s[42:43], 9, v5
  v_cmp_le_i32 s[44:45], 10, v5
  v_cmp_le_i32 s[46:47], 11, v5
  v_cndmask_b32 v84, v12, v7, s[40:41]
  v_cndmask_b32 v85, v12, v7, s[42:43]
  v_cndmask_b32 v86, v12, v7, s[44:45]
  v_cndmask_b32 v87, v12, v7, s[46:47]
  v_cmp_le_i32 s[40:41], 16, v5
  v_cmp_le_i32 s[42:43], 17, v5
  v_cmp_le_i32 s[44:45], 18, v5
  v_cmp_le_i32 s[46:47], 19, v5
  v_cndmask_b32 v88, v12, v7, s[40:41]
  v_cndmask_b32 v89, v12, v7, s[42:43]
  v_cndmask_b32 v90, v12, v7, s[44:45]
  v_cndmask_b32 v91, v12, v7, s[46:47]
  v_cmp_le_i32 s[40:41], 24, v5
  v_cmp_le_i32 s[42:43], 25, v5
  v_cmp_le_i32 s[44:45], 26, v5
  v_cmp_le_i32 s[46:47], 27, v5
  v_cndmask_b32 v92, v12, v7, s[40:41]
  v_cndmask_b32 v93, v12, v7, s[42:43]
  v_cndmask_b32 v94, v12, v7, s[44:45]
  v_cndmask_b32 v95, v12, v7, s[46:47]
  s_lshl_b32 s22, s69, 3
  s_add_u32 s22, s22, 8
  s_lshl_b32 s26, s16, 1
  s_sub_u32 s23, 6, s26
  s_waitcnt vmcnt(20)
  s_barrier
  buffer_load_dword v201, v200, s[8:11], 0 offen
  s_cmp_eq_u32 s23, 0
  s_cbranch_scc1 A_go_23
A_idle_22:
  s_waitcnt vmcnt(16)
  s_barrier
  s_sub_u32 s18, s18, 8192
  s_max_i32 s18, s18, s20
  s_sub_u32 s17, s17, 8192
  s_max_i32 s17, s17, s19
  s_add_u32 s21, s21, 16384
  s_and_b32 s21, s21, 131071
M_kv_24:
  s_cmp_ge_u32 s17, s36
  s_cbranch_scc1 M_kvok_25
  s_mov_b32 s76, 0
  s_mov_b32 s78, 23
  s_mov_b32 s77, 335872
  s_cmp_eq_u32 s68, 1
  s_cmov_b32 s76, 128
  s_cmov_b32 s78, 27
  s_cmov_b32 s77, 114688
  s_cmp_eq_u32 s68, 2
  s_cmov_b32 s76, 768
  s_cmov_b32 s78, 14
  s_cmov_b32 s77, 0
  s_add_u32 s76, s76, s67
  s_mov_b32 s71, 0
  s_branch M_sg_27
M_sw_26:
  s_sleep 8
  s_add_u32 s71, s71, 1
  s_cmp_gt_u32 s71, 262144
  s_cbranch_scc1 M_exit
M_sg_27:
  s_mov_b32 s79, 0
  s_atomic_or s79, s[72:73], s76 glc
  s_waitcnt lgkmcnt(0)
  s_cmp_lt_u32 s79, s78
  s_cbranch_scc1 M_sw_26
  s_add_u32 s36, s77, s19
  s_add_u32 s68, s68, 1
  s_branch M_kv_24
M_kvok_25:
  s_mov_b32 m0, s21
  s_nop 0
  buffer_load_dwordx4 v3, s[4:7], s18 offen offset:0 sc1 lds
  buffer_load_dwordx4 v3, s[4:7], s18 offen offset:1024 sc1 lds
  s_add_u32 m0, s21, 8192
  s_nop 0
  buffer_load_dwordx4 v3, s[4:7], s17 offen offset:0 sc1 lds
  buffer_load_dwordx4 v3, s[4:7], s17 offen offset:1024 sc1 lds
  v_add_u32 v4, 16384, v4
  v_and_b32 v4, 131071, v4
  s_sub_u32 s22, s22, 1
  s_sub_u32 s23, s23, 1
  s_cmp_lg_u32 s23, 0
  s_cbranch_scc1 A_idle_22
A_go_23:
  ds_read_b128 a[224:227], v4 offset:0
  ds_read_b128 a[228:231], v4 offset:2048
  ds_read_b128 a[232:235], v4 offset:4096
  ds_read_b128 a[236:239], v4 offset:6144
  ds_read_b128 a[240:243], v4 offset:1024
  ds_read_b128 a[244:247], v4 offset:3072
  ds_read_b128 a[248:251], v4 offset:5120
  ds_read_b128 a[252:255], v4 offset:7168
  ds_read_b128 a[192:195], v4 offset:8192
  ds_read_b128 a[196:199], v4 offset:9216
  ds_read_b128 a[200:203], v4 offset:10240
  ds_read_b128 a[204:207], v4 offset:11264
  ds_read_b128 a[208:211], v4 offset:12288
  ds_read_b128 a[212:215], v4 offset:13312
  ds_read_b128 a[216:219], v4 offset:14336
  ds_read_b128 a[220:223], v4 offset:15360
  v_add_u32 v4, 16384, v4
  v_and_b32 v4, 131071, v4
  s_waitcnt lgkmcnt(8)
.p2align 6
A_top_28:
  s_waitcnt lgkmcnt(7)
  v_mfma_f32_32x32x16_bf16 v[32:47], a[192:195], a[128:131], v[64:79]
  s_waitcnt lgkmcnt(6)
  v_exp_f32 v54, v54
  v_add_f32 v11, v11, v53
  v_cvt_pk_bf16_f32 v106, v52, v53
  v_mfma_f32_32x32x16_bf16 v[32:47], a[196:199], a[132:135], v[32:47]
  s_waitcnt lgkmcnt(4)
  v_exp_f32 v55, v55
  v_add_f32 v10, v10, v54
  v_mfma_f32_32x32x16_bf16 v[32:47], a[200:203], a[136:139], v[32:47]
  v_exp_f32 v56, v56
  v_add_f32 v11, v11, v55
  v_cvt_pk_bf16_f32 v107, v54, v55
  v_mfma_f32_32x32x16_bf16 v[32:47], a[204:207], a[140:143], v[32:47]
  s_waitcnt lgkmcnt(2)
  v_exp_f32 v57, v57
  v_add_f32 v10, v10, v56
  v_mfma_f32_32x32x16_bf16 v[32:47], a[208:211], a[144:147], v[32:47]
  v_exp_f32 v58, v58
  v_add_f32 v11, v11, v57
  v_cvt_pk_bf16_f32 v108, v56, v57
  v_mfma_f32_32x32x16_bf16 v[32:47], a[212:215], a[148:151], v[32:47]
  s_waitcnt lgkmcnt(0)
  v_exp_f32 v59, v59
  v_add_f32 v10, v10, v58
  v_mfma_f32_32x32x16_bf16 v[32:47], a[216:219], a[152:155], v[32:47]
  v_exp_f32 v60, v60
  v_add_f32 v11, v11, v59
  v_cvt_pk_bf16_f32 v109, v58, v59
  v_mfma_f32_32x32x16_bf16 v[32:47], a[220:223], a[156:159], v[32:47]
  s_waitcnt vmcnt(16)
  s_barrier
  v_exp_f32 v61, v61
  v_add_f32 v10, v10, v60
  v_mfma_f32_32x32x16_bf16 a[64:79], a[224:227], v[104:107], a[64:79]
  ds_read_b128 a[224:227], v4 offset:0
  v_exp_f32 v62, v62
  v_add_f32 v11, v11, v61
  v_cvt_pk_bf16_f32 v110, v60, v61
  v_mfma_f32_32x32x16_bf16 a[80:95], a[228:231], v[104:107], a[80:95]
  s_sub_u32 s18, s18, 8192
  ds_read_b128 a[228:231], v4 offset:2048
  v_exp_f32 v63, v63
  v_add_f32 v10, v10, v62
  v_mfma_f32_32x32x16_bf16 a[96:111], a[232:235], v[104:107], a[96:111]
  s_max_i32 s18, s18, s20
  ds_read_b128 a[232:235], v4 offset:4096
  v_exp_f32 v32, v32
  v_add_f32 v11, v11, v63
  v_cvt_pk_bf16_f32 v111, v62, v63
  v_mfma_f32_32x32x16_bf16 a[112:127], a[236:239], v[104:107], a[112:127]
  s_sub_u32 s17, s17, 8192
  ds_read_b128 a[236:239], v4 offset:6144
  v_exp_f32 v33, v33
  v_add_f32 v8, v8, v32
  v_mfma_f32_32x32x16_bf16 a[64:79], a[240:243], v[108:111], a[64:79]
  s_max_i32 s17, s17, s19
  ds_read_b128 a[240:243], v4 offset:1024
  v_exp_f32 v34, v34
  v_add_f32 v9, v9, v33
  v_cvt_pk_bf16_f32 v96, v32, v33
  v_mfma_f32_32x32x16_bf16 a[80:95], a[244:247], v[108:111], a[80:95]
  s_add_u32 s21, s21, 16384
  ds_read_b128 a[244:247], v4 offset:3072
  v_exp_f32 v35, v35
  v_add_f32 v8, v8, v34
  v_mfma_f32_32x32x16_bf16 a[96:111], a[248:251], v[108:111], a[96:111]
  s_and_b32 s21, s21, 131071
  ds_read_b128 a[248:251], v4 offset:5120
  v_exp_f32 v36, v36
  v_add_f32 v9, v9, v35
  v_cvt_pk_bf16_f32 v97, v34, v35
  v_mfma_f32_32x32x16_bf16 a[112:127], a[252:255], v[108:111], a[112:127]
  ds_read_b128 a[252:255], v4 offset:7168
  v_exp_f32 v37, v37
  v_add_f32 v8, v8, v36
  v_mfma_f32_32x32x16_bf16 v[48:63], a[192:195], a[160:163], v[80:95]
  s_add_u32 s23, s23, 1
  ds_read_b128 a[192:195], v4 offset:8192
  v_exp_f32 v38, v38
  v_add_f32 v9, v9, v37
  v_cvt_pk_bf16_f32 v98, v36, v37
  v_mfma_f32_32x32x16_bf16 v[48:63], a[196:199], a[164:167], v[48:63]
  s_sub_u32 s22, s22, 1
  ds_read_b128 a[196:199], v4 offset:9216
  v_exp_f32 v39, v39
  v_add_f32 v8, v8, v38
  v_mfma_f32_32x32x16_bf16 v[48:63], a[200:203], a[168:171], v[48:63]
  s_cmp_lt_u32 s23, 3
  ds_read_b128 a[200:203], v4 offset:10240
  v_exp_f32 v40, v40
  v_add_f32 v9, v9, v39
  v_cvt_pk_bf16_f32 v99, v38, v39
  v_mfma_f32_32x32x16_bf16 v[48:63], a[204:207], a[172:175], v[48:63]
  s_cbranch_scc1 A_upd_29
A_back_30:
  ds_read_b128 a[204:207], v4 offset:11264
  v_exp_f32 v41, v41
  v_add_f32 v8, v8, v40
  v_mfma_f32_32x32x16_bf16 v[48:63], a[208:211], a[176:179], v[48:63]
  s_cmp_lt_u32 s17, s36
  ds_read_b128 a[208:211], v4 offset:12288
  v_exp_f32 v42, v42
  v_add_f32 v9, v9, v41
  v_cvt_pk_bf16_f32 v100, v40, v41
  v_mfma_f32_32x32x16_bf16 v[48:63], a[212:215], a[180:183], v[48:63]
  s_cbranch_scc1 A_kvw_32
A_kvb_33:
  ds_read_b128 a[212:215], v4 offset:13312
  v_exp_f32 v43, v43
  v_add_f32 v8, v8, v42
  v_mfma_f32_32x32x16_bf16 v[48:63], a[216:219], a[184:187], v[48:63]
  s_mov_b32 m0, s21
  ds_read_b128 a[216:219], v4 offset:14336
  v_exp_f32 v44, v44
  v_add_f32 v9, v9, v43
  v_cvt_pk_bf16_f32 v101, v42, v43
  v_mfma_f32_32x32x16_bf16 v[48:63], a[220:223], a[188:191], v[48:63]
  s_waitcnt lgkmcnt(13)
  ds_read_b128 a[220:223], v4 offset:15360
  v_exp_f32 v45, v45
  v_add_f32 v8, v8, v44
  v_mfma_f32_32x32x16_bf16 a[0:15], a[224:227], v[96:99], a[0:15]
  buffer_load_dwordx4 v3, s[4:7], s18 offen offset:0 sc1 lds
  v_exp_f32 v46, v46
  v_add_f32 v9, v9, v45
  v_cvt_pk_bf16_f32 v102, v44, v45
  v_mfma_f32_32x32x16_bf16 a[16:31], a[228:231], v[96:99], a[16:31]
  s_waitcnt lgkmcnt(12)
  v_exp_f32 v47, v47
  v_add_f32 v8, v8, v46
  v_add_u32 v4, 16384, v4
  v_mfma_f32_32x32x16_bf16 a[32:47], a[232:235], v[96:99], a[32:47]
  buffer_load_dwordx4 v3, s[4:7], s18 offen offset:1024 sc1 lds
  v_exp_f32 v48, v48
  v_add_f32 v9, v9, v47
  v_cvt_pk_bf16_f32 v103, v46, v47
  v_mfma_f32_32x32x16_bf16 a[48:63], a[236:239], v[96:99], a[48:63]
  s_waitcnt lgkmcnt(10)
  s_add_u32 m0, s21, 8192
  v_exp_f32 v49, v49
  v_add_f32 v10, v10, v48
  v_and_b32 v4, 131071, v4
  v_mfma_f32_32x32x16_bf16 a[0:15], a[240:243], v[100:103], a[0:15]
  buffer_load_dwordx4 v3, s[4:7], s17 offen offset:0 sc1 lds
  v_exp_f32 v50, v50
  v_add_f32 v11, v11, v49
  v_cvt_pk_bf16_f32 v104, v48, v49
  v_mfma_f32_32x32x16_bf16 a[16:31], a[244:247], v[100:103], a[16:31]
  s_waitcnt lgkmcnt(8)
  s_cmp_lg_u32 s22, 0
  v_exp_f32 v51, v51
  v_add_f32 v10, v10, v50
  v_mfma_f32_32x32x16_bf16 a[32:47], a[248:251], v[100:103], a[32:47]
  buffer_load_dwordx4 v3, s[4:7], s17 offen offset:1024 sc1 lds
  v_exp_f32 v52, v52
  v_add_f32 v11, v11, v51
  v_cvt_pk_bf16_f32 v105, v50, v51
  v_mfma_f32_32x32x16_bf16 a[48:63], a[252:255], v[100:103], a[48:63]
  v_exp_f32 v53, v53
  v_add_f32 v10, v10, v52
  s_cbranch_scc1 A_top_28
  v_exp_f32 v54, v54
  v_add_f32 v11, v11, v53
  v_cvt_pk_bf16_f32 v106, v52, v53
  v_exp_f32 v55, v55
  v_add_f32 v10, v10, v54
  v_exp_f32 v56, v56
  v_add_f32 v11, v11, v55
  v_cvt_pk_bf16_f32 v107, v54, v55
  v_exp_f32 v57, v57
  v_add_f32 v10, v10, v56
  v_exp_f32 v58, v58
  v_add_f32 v11, v11, v57
  v_cvt_pk_bf16_f32 v108, v56, v57
  v_exp_f32 v59, v59
  v_add_f32 v10, v10, v58
  v_exp_f32 v60, v60
  v_add_f32 v11, v11, v59
  v_cvt_pk_bf16_f32 v109, v58, v59
  v_exp_f32 v61, v61
  v_add_f32 v10, v10, v60
  v_exp_f32 v62, v62
  v_add_f32 v11, v11, v61
  v_cvt_pk_bf16_f32 v110, v60, v61
  v_exp_f32 v63, v63
  v_add_f32 v10, v10, v62
  v_add_f32 v11, v11, v63
  v_cvt_pk_bf16_f32 v111, v62, v63
  s_nop 1
  v_mfma_f32_32x32x16_bf16 a[64:79], a[224:227], v[104:107], a[64:79]
  v_mfma_f32_32x32x16_bf16 a[80:95], a[228:231], v[104:107], a[80:95]
  v_mfma_f32_32x32x16_bf16 a[96:111], a[232:235], v[104:107], a[96:111]
  v_mfma_f32_32x32x16_bf16 a[112:127], a[236:239], v[104:107], a[112:127]
  v_mfma_f32_32x32x16_bf16 a[64:79], a[240:243], v[108:111], a[64:79]
  v_mfma_f32_32x32x16_bf16 a[80:95], a[244:247], v[108:111], a[80:95]
  v_mfma_f32_32x32x16_bf16 a[96:111], a[248:251], v[108:111], a[96:111]
  v_mfma_f32_32x32x16_bf16 a[112:127], a[252:255], v[108:111], a[112:127]
  v_add_f32 v8, v8, v9
  v_mov_b32 v9, v8
  s_nop 1
  v_permlane32_swap_b32 v8, v9
  s_nop 1
  v_add_f32 v8, v8, v9
  v_add_f32 v10, v10, v11
  v_mov_b32 v11, v10
  s_nop 1
  v_permlane32_swap_b32 v10, v11
  s_nop 1
  v_add_f32 v10, v10, v11
  v_subrev_u32 v12, 0x2f800000, v8
  v_subrev_u32 v13, 0x2f800000, v10
  v_max_u32 v12, v12, v13
  v_cmp_le_u32 vcc, 0x28000000, v12
  s_nop 1
  s_cmp_lg_u64 vcc, 0
  s_cselect_b32 s26, 1, 0
  v_mov_b32 v12, s26
  s_lshl_b32 s26, s16, 2
  s_add_u32 s26, s26, 131072
  v_mov_b32 v13, s26
  ds_write_b32 v13, v12
  v_mov_b32 v14, 131072
  s_waitcnt vmcnt(0) lgkmcnt(0)
  s_barrier
  ds_read_b128 v[16:19], v14
  v_rcp_f32 v8, v8
  v_rcp_f32 v10, v10
  s_waitcnt lgkmcnt(0)
  v_or3_b32 v12, v16, v17, v18
  v_or_b32 v12, v12, v19
  s_nop 0
  v_readfirstlane_b32 s26, v12
  s_nop 1
  s_cmp_gt_u32 s26, s29
  s_cbranch_scc1 A_slow_34
  s_add_u32 s28, s25, 100663296
  v_accvgpr_read_b32 v112, a0
  v_accvgpr_read_b32 v113, a1
  v_accvgpr_read_b32 v114, a2
  v_accvgpr_read_b32 v115, a3
  v_accvgpr_read_b32 v116, a4
  v_accvgpr_read_b32 v117, a5
  v_accvgpr_read_b32 v118, a6
  v_accvgpr_read_b32 v119, a7
  v_pk_mul_f32 v[112:113], v[112:113], v[8:9] op_sel_hi:[1,0]
  v_pk_mul_f32 v[114:115], v[114:115], v[8:9] op_sel_hi:[1,0]
  v_pk_mul_f32 v[116:117], v[116:117], v[8:9] op_sel_hi:[1,0]
  v_pk_mul_f32 v[118:119], v[118:119], v[8:9] op_sel_hi:[1,0]
  v_cvt_pk_bf16_f32 v120, v112, v113
  v_cvt_pk_bf16_f32 v121, v114, v115
  v_cvt_pk_bf16_f32 v122, v116, v117
  v_cvt_pk_bf16_f32 v123, v118, v119
  buffer_store_dwordx4 v[120:123], v2, s[4:7], s28 offen offset:0 sc1
  v_accvgpr_read_b32 v124, a8
  v_accvgpr_read_b32 v125, a9
  v_accvgpr_read_b32 v126, a10
  v_accvgpr_read_b32 v127, a11
  v_accvgpr_read_b32 v128, a12
  v_accvgpr_read_b32 v129, a13
  v_accvgpr_read_b32 v130, a14
  v_accvgpr_read_b32 v131, a15
  v_pk_mul_f32 v[124:125], v[124:125], v[8:9] op_sel_hi:[1,0]
  v_pk_mul_f32 v[126:127], v[126:127], v[8:9] op_sel_hi:[1,0]
  v_pk_mul_f32 v[128:129], v[128:129], v[8:9] op_sel_hi:[1,0]
  v_pk_mul_f32 v[130:131], v[130:131], v[8:9] op_sel_hi:[1,0]
  v_cvt_pk_bf16_f32 v132, v124, v125
  v_cvt_pk_bf16_f32 v133, v126, v127
  v_cvt_pk_bf16_f32 v134, v128, v129
  v_cvt_pk_bf16_f32 v135, v130, v131
  buffer_store_dwordx4 v[132:135], v2, s[4:7], s28 offen offset:1024 sc1
  v_accvgpr_read_b32 v136, a16
  v_accvgpr_read_b32 v137, a17
  v_accvgpr_read_b32 v138, a18
  v_accvgpr_read_b32 v139, a19
  v_accvgpr_read_b32 v140, a20
  v_accvgpr_read_b32 v141, a21
  v_accvgpr_read_b32 v142, a22
  v_accvgpr_read_b32 v143, a23
  v_pk_mul_f32 v[136:137], v[136:137], v[8:9] op_sel_hi:[1,0]
  v_pk_mul_f32 v[138:139], v[138:139], v[8:9] op_sel_hi:[1,0]
  v_pk_mul_f32 v[140:141], v[140:141], v[8:9] op_sel_hi:[1,0]
  v_pk_mul_f32 v[142:143], v[142:143], v[8:9] op_sel_hi:[1,0]
  v_cvt_pk_bf16_f32 v144, v136, v137
  v_cvt_pk_bf16_f32 v145, v138, v139
  v_cvt_pk_bf16_f32 v146, v140, v141
  v_cvt_pk_bf16_f32 v147, v142, v143
  buffer_store_dwordx4 v[144:147], v2, s[4:7], s28 offen offset:2048 sc1
  v_accvgpr_read_b32 v148, a24
  v_accvgpr_read_b32 v149, a25
  v_accvgpr_read_b32 v150, a26
  v_accvgpr_read_b32 v151, a27
  v_accvgpr_read_b32 v152, a28
  v_accvgpr_read_b32 v153, a29
  v_accvgpr_read_b32 v154, a30
  v_accvgpr_read_b32 v155, a31
  v_pk_mul_f32 v[148:149], v[148:149], v[8:9] op_sel_hi:[1,0]
  v_pk_mul_f32 v[150:151], v[150:151], v[8:9] op_sel_hi:[1,0]
  v_pk_mul_f32 v[152:153], v[152:153], v[8:9] op_sel_hi:[1,0]
  v_pk_mul_f32 v[154:155], v[154:155], v[8:9] op_sel_hi:[1,0]
  v_cvt_pk_bf16_f32 v156, v148, v149
  v_cvt_pk_bf16_f32 v157, v150, v151
  v_cvt_pk_bf16_f32 v158, v152, v153
  v_cvt_pk_bf16_f32 v159, v154, v155
  buffer_store_dwordx4 v[156:159], v2, s[4:7], s28 offen offset:3072 sc1
  s_add_u32 s28, s25, 100667392
  v_accvgpr_read_b32 v112, a32
  v_accvgpr_read_b32 v113, a33
  v_accvgpr_read_b32 v114, a34
  v_accvgpr_read_b32 v115, a35
  v_accvgpr_read_b32 v116, a36
  v_accvgpr_read_b32 v117, a37
  v_accvgpr_read_b32 v118, a38
  v_accvgpr_read_b32 v119, a39
  v_pk_mul_f32 v[112:113], v[112:113], v[8:9] op_sel_hi:[1,0]
  v_pk_mul_f32 v[114:115], v[114:115], v[8:9] op_sel_hi:[1,0]
  v_pk_mul_f32 v[116:117], v[116:117], v[8:9] op_sel_hi:[1,0]
  v_pk_mul_f32 v[118:119], v[118:119], v[8:9] op_sel_hi:[1,0]
  v_cvt_pk_bf16_f32 v120, v112, v113
  v_cvt_pk_bf16_f32 v121, v114, v115
  v_cvt_pk_bf16_f32 v122, v116, v117
  v_cvt_pk_bf16_f32 v123, v118, v119
  buffer_store_dwordx4 v[120:123], v2, s[4:7], s28 offen offset:0 sc1
  v_accvgpr_read_b32 v124, a40
  v_accvgpr_read_b32 v125, a41
  v_accvgpr_read_b32 v126, a42
  v_accvgpr_read_b32 v127, a43
  v_accvgpr_read_b32 v128, a44
  v_accvgpr_read_b32 v129, a45
  v_accvgpr_read_b32 v130, a46
  v_accvgpr_read_b32 v131, a47
  v_pk_mul_f32 v[124:125], v[124:125], v[8:9] op_sel_hi:[1,0]
  v_pk_mul_f32 v[126:127], v[126:127], v[8:9] op_sel_hi:[1,0]
  v_pk_mul_f32 v[128:129], v[128:129], v[8:9] op_sel_hi:[1,0]
  v_pk_mul_f32 v[130:131], v[130:131], v[8:9] op_sel_hi:[1,0]
  v_cvt_pk_bf16_f32 v132, v124, v125
  v_cvt_pk_bf16_f32 v133, v126, v127
  v_cvt_pk_bf16_f32 v134, v128, v129
  v_cvt_pk_bf16_f32 v135, v130, v131
  buffer_store_dwordx4 v[132:135], v2, s[4:7], s28 offen offset:1024 sc1
  v_accvgpr_read_b32 v136, a48
  v_accvgpr_read_b32 v137, a49
  v_accvgpr_read_b32 v138, a50
  v_accvgpr_read_b32 v139, a51
  v_accvgpr_read_b32 v140, a52
  v_accvgpr_read_b32 v141, a53
  v_accvgpr_read_b32 v142, a54
  v_accvgpr_read_b32 v143, a55
  v_pk_mul_f32 v[136:137], v[136:137], v[8:9] op_sel_hi:[1,0]
  v_pk_mul_f32 v[138:139], v[138:139], v[8:9] op_sel_hi:[1,0]
  v_pk_mul_f32 v[140:141], v[140:141], v[8:9] op_sel_hi:[1,0]
  v_pk_mul_f32 v[142:143], v[142:143], v[8:9] op_sel_hi:[1,0]
  v_cvt_pk_bf16_f32 v144, v136, v137
  v_cvt_pk_bf16_f32 v145, v138, v139
  v_cvt_pk_bf16_f32 v146, v140, v141
  v_cvt_pk_bf16_f32 v147, v142, v143
  buffer_store_dwordx4 v[144:147], v2, s[4:7], s28 offen offset:2048 sc1
  v_accvgpr_read_b32 v148, a56
  v_accvgpr_read_b32 v149, a57
  v_accvgpr_read_b32 v150, a58
  v_accvgpr_read_b32 v151, a59
  v_accvgpr_read_b32 v152, a60
  v_accvgpr_read_b32 v153, a61
  v_accvgpr_read_b32 v154, a62
  v_accvgpr_read_b32 v155, a63
  v_pk_mul_f32 v[148:149], v[148:149], v[8:9] op_sel_hi:[1,0]
  v_pk_mul_f32 v[150:151], v[150:151], v[8:9] op_sel_hi:[1,0]
  v_pk_mul_f32 v[152:153], v[152:153], v[8:9] op_sel_hi:[1,0]
  v_pk_mul_f32 v[154:155], v[154:155], v[8:9] op_sel_hi:[1,0]
  v_cvt_pk_bf16_f32 v156, v148, v149
  v_cvt_pk_bf16_f32 v157, v150, v151
  v_cvt_pk_bf16_f32 v158, v152, v153
  v_cvt_pk_bf16_f32 v159, v154, v155
  buffer_store_dwordx4 v[156:159], v2, s[4:7], s28 offen offset:3072 sc1
  s_add_u32 s28, s25, 100671488
  v_accvgpr_read_b32 v112, a64
  v_accvgpr_read_b32 v113, a65
  v_accvgpr_read_b32 v114, a66
  v_accvgpr_read_b32 v115, a67
  v_accvgpr_read_b32 v116, a68
  v_accvgpr_read_b32 v117, a69
  v_accvgpr_read_b32 v118, a70
  v_accvgpr_read_b32 v119, a71
  v_pk_mul_f32 v[112:113], v[112:113], v[10:11] op_sel_hi:[1,0]
  v_pk_mul_f32 v[114:115], v[114:115], v[10:11] op_sel_hi:[1,0]
  v_pk_mul_f32 v[116:117], v[116:117], v[10:11] op_sel_hi:[1,0]
  v_pk_mul_f32 v[118:119], v[118:119], v[10:11] op_sel_hi:[1,0]
  v_cvt_pk_bf16_f32 v120, v112, v113
  v_cvt_pk_bf16_f32 v121, v114, v115
  v_cvt_pk_bf16_f32 v122, v116, v117
  v_cvt_pk_bf16_f32 v123, v118, v119
  buffer_store_dwordx4 v[120:123], v2, s[4:7], s28 offen offset:0 sc1
  v_accvgpr_read_b32 v124, a72
  v_accvgpr_read_b32 v125, a73
  v_accvgpr_read_b32 v126, a74
  v_accvgpr_read_b32 v127, a75
  v_accvgpr_read_b32 v128, a76
  v_accvgpr_read_b32 v129, a77
  v_accvgpr_read_b32 v130, a78
  v_accvgpr_read_b32 v131, a79
  v_pk_mul_f32 v[124:125], v[124:125], v[10:11] op_sel_hi:[1,0]
  v_pk_mul_f32 v[126:127], v[126:127], v[10:11] op_sel_hi:[1,0]
  v_pk_mul_f32 v[128:129], v[128:129], v[10:11] op_sel_hi:[1,0]
  v_pk_mul_f32 v[130:131], v[130:131], v[10:11] op_sel_hi:[1,0]
  v_cvt_pk_bf16_f32 v132, v124, v125
  v_cvt_pk_bf16_f32 v133, v126, v127
  v_cvt_pk_bf16_f32 v134, v128, v129
  v_cvt_pk_bf16_f32 v135, v130, v131
  buffer_store_dwordx4 v[132:135], v2, s[4:7], s28 offen offset:1024 sc1
  v_accvgpr_read_b32 v136, a80
  v_accvgpr_read_b32 v137, a81
  v_accvgpr_read_b32 v138, a82
  v_accvgpr_read_b32 v139, a83
  v_accvgpr_read_b32 v140, a84
  v_accvgpr_read_b32 v141, a85
  v_accvgpr_read_b32 v142, a86
  v_accvgpr_read_b32 v143, a87
  v_pk_mul_f32 v[136:137], v[136:137], v[10:11] op_sel_hi:[1,0]
  v_pk_mul_f32 v[138:139], v[138:139], v[10:11] op_sel_hi:[1,0]
  v_pk_mul_f32 v[140:141], v[140:141], v[10:11] op_sel_hi:[1,0]
  v_pk_mul_f32 v[142:143], v[142:143], v[10:11] op_sel_hi:[1,0]
  v_cvt_pk_bf16_f32 v144, v136, v137
  v_cvt_pk_bf16_f32 v145, v138, v139
  v_cvt_pk_bf16_f32 v146, v140, v141
  v_cvt_pk_bf16_f32 v147, v142, v143
  buffer_store_dwordx4 v[144:147], v2, s[4:7], s28 offen offset:2048 sc1
  v_accvgpr_read_b32 v148, a88
  v_accvgpr_read_b32 v149, a89
  v_accvgpr_read_b32 v150, a90
  v_accvgpr_read_b32 v151, a91
  v_accvgpr_read_b32 v152, a92
  v_accvgpr_read_b32 v153, a93
  v_accvgpr_read_b32 v154, a94
  v_accvgpr_read_b32 v155, a95
  v_pk_mul_f32 v[148:149], v[148:149], v[10:11] op_sel_hi:[1,0]
  v_pk_mul_f32 v[150:151], v[150:151], v[10:11] op_sel_hi:[1,0]
  v_pk_mul_f32 v[152:153], v[152:153], v[10:11] op_sel_hi:[1,0]
  v_pk_mul_f32 v[154:155], v[154:155], v[10:11] op_sel_hi:[1,0]
  v_cvt_pk_bf16_f32 v156, v148, v149
  v_cvt_pk_bf16_f32 v157, v150, v151
  v_cvt_pk_bf16_f32 v158, v152, v153
  v_cvt_pk_bf16_f32 v159, v154, v155
  buffer_store_dwordx4 v[156:159], v2, s[4:7], s28 offen offset:3072 sc1
  s_add_u32 s28, s25, 100675584
  v_accvgpr_read_b32 v112, a96
  v_accvgpr_read_b32 v113, a97
  v_accvgpr_read_b32 v114, a98
  v_accvgpr_read_b32 v115, a99
  v_accvgpr_read_b32 v116, a100
  v_accvgpr_read_b32 v117, a101
  v_accvgpr_read_b32 v118, a102
  v_accvgpr_read_b32 v119, a103
  v_pk_mul_f32 v[112:113], v[112:113], v[10:11] op_sel_hi:[1,0]
  v_pk_mul_f32 v[114:115], v[114:115], v[10:11] op_sel_hi:[1,0]
  v_pk_mul_f32 v[116:117], v[116:117], v[10:11] op_sel_hi:[1,0]
  v_pk_mul_f32 v[118:119], v[118:119], v[10:11] op_sel_hi:[1,0]
  v_cvt_pk_bf16_f32 v120, v112, v113
  v_cvt_pk_bf16_f32 v121, v114, v115
  v_cvt_pk_bf16_f32 v122, v116, v117
  v_cvt_pk_bf16_f32 v123, v118, v119
  buffer_store_dwordx4 v[120:123], v2, s[4:7], s28 offen offset:0 sc1
  v_accvgpr_read_b32 v124, a104
  v_accvgpr_read_b32 v125, a105
  v_accvgpr_read_b32 v126, a106
  v_accvgpr_read_b32 v127, a107
  v_accvgpr_read_b32 v128, a108
  v_accvgpr_read_b32 v129, a109
  v_accvgpr_read_b32 v130, a110
  v_accvgpr_read_b32 v131, a111
  v_pk_mul_f32 v[124:125], v[124:125], v[10:11] op_sel_hi:[1,0]
  v_pk_mul_f32 v[126:127], v[126:127], v[10:11] op_sel_hi:[1,0]
  v_pk_mul_f32 v[128:129], v[128:129], v[10:11] op_sel_hi:[1,0]
  v_pk_mul_f32 v[130:131], v[130:131], v[10:11] op_sel_hi:[1,0]
  v_cvt_pk_bf16_f32 v132, v124, v125
  v_cvt_pk_bf16_f32 v133, v126, v127
  v_cvt_pk_bf16_f32 v134, v128, v129
  v_cvt_pk_bf16_f32 v135, v130, v131
  buffer_store_dwordx4 v[132:135], v2, s[4:7], s28 offen offset:1024 sc1
  v_accvgpr_read_b32 v136, a112
  v_accvgpr_read_b32 v137, a113
  v_accvgpr_read_b32 v138, a114
  v_accvgpr_read_b32 v139, a115
  v_accvgpr_read_b32 v140, a116
  v_accvgpr_read_b32 v141, a117
  v_accvgpr_read_b32 v142, a118
  v_accvgpr_read_b32 v143, a119
  v_pk_mul_f32 v[136:137], v[136:137], v[10:11] op_sel_hi:[1,0]
  v_pk_mul_f32 v[138:139], v[138:139], v[10:11] op_sel_hi:[1,0]
  v_pk_mul_f32 v[140:141], v[140:141], v[10:11] op_sel_hi:[1,0]
  v_pk_mul_f32 v[142:143], v[142:143], v[10:11] op_sel_hi:[1,0]
  v_cvt_pk_bf16_f32 v144, v136, v137
  v_cvt_pk_bf16_f32 v145, v138, v139
  v_cvt_pk_bf16_f32 v146, v140, v141
  v_cvt_pk_bf16_f32 v147, v142, v143
  buffer_store_dwordx4 v[144:147], v2, s[4:7], s28 offen offset:2048 sc1
  v_accvgpr_read_b32 v148, a120
  v_accvgpr_read_b32 v149, a121
  v_accvgpr_read_b32 v150, a122
  v_accvgpr_read_b32 v151, a123
  v_accvgpr_read_b32 v152, a124
  v_accvgpr_read_b32 v153, a125
  v_accvgpr_read_b32 v154, a126
  v_accvgpr_read_b32 v155, a127
  v_pk_mul_f32 v[148:149], v[148:149], v[10:11] op_sel_hi:[1,0]
  v_pk_mul_f32 v[150:151], v[150:151], v[10:11] op_sel_hi:[1,0]
  v_pk_mul_f32 v[152:153], v[152:153], v[10:11] op_sel_hi:[1,0]
  v_pk_mul_f32 v[154:155], v[154:155], v[10:11] op_sel_hi:[1,0]
  v_cvt_pk_bf16_f32 v156, v148, v149
  v_cvt_pk_bf16_f32 v157, v150, v151
  v_cvt_pk_bf16_f32 v158, v152, v153
  v_cvt_pk_bf16_f32 v159, v154, v155
  buffer_store_dwordx4 v[156:159], v2, s[4:7], s28 offen offset:3072 sc1
  s_branch A_out_31
A_kvw_32:
M_kv_35:
  s_cmp_ge_u32 s17, s36
  s_cbranch_scc1 M_kvok_36
  s_mov_b32 s76, 0
  s_mov_b32 s78, 23
  s_mov_b32 s77, 335872
  s_cmp_eq_u32 s68, 1
  s_cmov_b32 s76, 128
  s_cmov_b32 s78, 27
  s_cmov_b32 s77, 114688
  s_cmp_eq_u32 s68, 2
  s_cmov_b32 s76, 768
  s_cmov_b32 s78, 14
  s_cmov_b32 s77, 0
  s_add_u32 s76, s76, s67
  s_mov_b32 s71, 0
  s_branch M_sg_38
M_sw_37:
  s_sleep 8
  s_add_u32 s71, s71, 1
  s_cmp_gt_u32 s71, 262144
  s_cbranch_scc1 M_exit
M_sg_38:
  s_mov_b32 s79, 0
  s_atomic_or s79, s[72:73], s76 glc
  s_waitcnt lgkmcnt(0)
  s_cmp_lt_u32 s79, s78
  s_cbranch_scc1 M_sw_37
  s_add_u32 s36, s77, s19
  s_add_u32 s68, s68, 1
  s_branch M_kv_35
M_kvok_36:
  s_branch A_kvb_33
A_upd_29:
  s_cmp_eq_u32 s23, 2
  s_cbranch_scc1 A_upd2_39
  v_mov_b32 v12, s24
  v_cmp_le_i32 s[40:41], 0, v5
  v_cmp_le_i32 s[42:43], 1, v5
  v_cmp_le_i32 s[44:45], 2, v5
  v_cmp_le_i32 s[46:47], 3, v5
  v_cndmask_b32 v64, v12, v6, s[40:41]
  v_cndmask_b32 v65, v12, v6, s[42:43]
  v_cndmask_b32 v66, v12, v6, s[44:45]
  v_cndmask_b32 v67, v12, v6, s[46:47]
  v_cmp_le_i32 s[40:41], 8, v5
  v_cmp_le_i32 s[42:43], 9, v5
  v_cmp_le_i32 s[44:45], 10, v5
  v_cmp_le_i32 s[46:47], 11, v5
  v_cndmask_b32 v68, v12, v6, s[40:41]
  v_cndmask_b32 v69, v12, v6, s[42:43]
  v_cndmask_b32 v70, v12, v6, s[44:45]
  v_cndmask_b32 v71, v12, v6, s[46:47]
  v_cmp_le_i32 s[40:41], 16, v5
  v_cmp_le_i32 s[42:43], 17, v5
  v_cmp_le_i32 s[44:45], 18, v5
  v_cmp_le_i32 s[46:47], 19, v5
  v_cndmask_b32 v72, v12, v6, s[40:41]
  v_cndmask_b32 v73, v12, v6, s[42:43]
  v_cndmask_b32 v74, v12, v6, s[44:45]
  v_cndmask_b32 v75, v12, v6, s[46:47]
  v_cmp_le_i32 s[40:41], 24, v5
  v_cmp_le_i32 s[42:43], 25, v5
  v_cmp_le_i32 s[44:45], 26, v5
  v_cmp_le_i32 s[46:47], 27, v5
  v_cndmask_b32 v76, v12, v6, s[40:41]
  v_cndmask_b32 v77, v12, v6, s[42:43]
  v_cndmask_b32 v78, v12, v6, s[44:45]
  v_cndmask_b32 v79, v12, v6, s[46:47]
  v_mov_b32 v80, v7
  v_mov_b32 v81, v7
  v_mov_b32 v82, v7
  v_mov_b32 v83, v7
  v_mov_b32 v84, v7
  v_mov_b32 v85, v7
  v_mov_b32 v86, v7
  v_mov_b32 v87, v7
  v_mov_b32 v88, v7
  v_mov_b32 v89, v7
  v_mov_b32 v90, v7
  v_mov_b32 v91, v7
  v_mov_b32 v92, v7
  v_mov_b32 v93, v7
  v_mov_b32 v94, v7
  v_mov_b32 v95, v7
  s_branch A_back_30
A_upd2_39:
  v_mov_b32 v64, v6
  v_mov_b32 v65, v6
  v_mov_b32 v66, v6
  v_mov_b32 v67, v6
  v_mov_b32 v68, v6
  v_mov_b32 v69, v6
  v_mov_b32 v70, v6
  v_mov_b32 v71, v6
  v_mov_b32 v72, v6
  v_mov_b32 v73, v6
  v_mov_b32 v74, v6
  v_mov_b32 v75, v6
  v_mov_b32 v76, v6
  v_mov_b32 v77, v6
  v_mov_b32 v78, v6
  v_mov_b32 v79, v6
  s_branch A_back_30
A_slow_34:
  s_mov_b32 s29, 1
  v_mov_b32 v64, s24
  v_mov_b32 v65, s24
  v_mov_b32 v66, s24
  v_mov_b32 v67, s24
  v_mov_b32 v68, s24
  v_mov_b32 v69, s24
  v_mov_b32 v70, s24
  v_mov_b32 v71, s24
  v_mov_b32 v72, s24
  v_mov_b32 v73, s24
  v_mov_b32 v74, s24
  v_mov_b32 v75, s24
  v_mov_b32 v76, s24
  v_mov_b32 v77, s24
  v_mov_b32 v78, s24
  v_mov_b32 v79, s24
  v_mov_b32 v12, s24
  v_cmp_le_i32 s[40:41], 0, v5
  v_cmp_le_i32 s[42:43], 1, v5
  v_cmp_le_i32 s[44:45], 2, v5
  v_cmp_le_i32 s[46:47], 3, v5
  v_cndmask_b32 v80, v12, v7, s[40:41]
  v_cndmask_b32 v81, v12, v7, s[42:43]
  v_cndmask_b32 v82, v12, v7, s[44:45]
  v_cndmask_b32 v83, v12, v7, s[46:47]
  v_cmp_le_i32 s[40:41], 8, v5
  v_cmp_le_i32 s[42:43], 9, v5
  v_cmp_le_i32 s[44:45], 10, v5
  v_cmp_le_i32 s[46:47], 11, v5
  v_cndmask_b32 v84, v12, v7, s[40:41]
  v_cndmask_b32 v85, v12, v7, s[42:43]
  v_cndmask_b32 v86, v12, v7, s[44:45]
  v_cndmask_b32 v87, v12, v7, s[46:47]
  v_cmp_le_i32 s[40:41], 16, v5
  v_cmp_le_i32 s[42:43], 17, v5
  v_cmp_le_i32 s[44:45], 18, v5
  v_cmp_le_i32 s[46:47], 19, v5
  v_cndmask_b32 v88, v12, v7, s[40:41]
  v_cndmask_b32 v89, v12, v7, s[42:43]
  v_cndmask_b32 v90, v12, v7, s[44:45]
  v_cndmask_b32 v91, v12, v7, s[46:47]
  v_cmp_le_i32 s[40:41], 24, v5
  v_cmp_le_i32 s[42:43], 25, v5
  v_cmp_le_i32 s[44:45], 26, v5
  v_cmp_le_i32 s[46:47], 27, v5
  v_cndmask_b32 v92, v12, v7, s[40:41]
  v_cndmask_b32 v93, v12, v7, s[42:43]
  v_cndmask_b32 v94, v12, v7, s[44:45]
  v_cndmask_b32 v95, v12, v7, s[46:47]
  v_mov_b32 v8, s24
  v_mov_b32 v10, s24
  s_add_u32 s17, s25, 16785408
  s_mov_b32 s23, 0
A_ml_40:
  s_add_u32 s28, s17, 4096
  buffer_load_dwordx4 a[192:195], v2, s[4:7], s17 offen offset:0 sc1
  buffer_load_dwordx4 a[196:199], v2, s[4:7], s17 offen offset:1024 sc1
  buffer_load_dwordx4 a[200:203], v2, s[4:7], s17 offen offset:2048 sc1
  buffer_load_dwordx4 a[204:207], v2, s[4:7], s17 offen offset:3072 sc1
  buffer_load_dwordx4 a[208:211], v2, s[4:7], s28 offen offset:0 sc1
  buffer_load_dwordx4 a[212:215], v2, s[4:7], s28 offen offset:1024 sc1
  buffer_load_dwordx4 a[216:219], v2, s[4:7], s28 offen offset:2048 sc1
  buffer_load_dwordx4 a[220:223], v2, s[4:7], s28 offen offset:3072 sc1
  s_waitcnt vmcnt(0)
  v_mfma_f32_32x32x16_bf16 v[32:47], a[192:195], a[128:131], v[64:79]
  v_mfma_f32_32x32x16_bf16 v[32:47], a[196:199], a[132:135], v[32:47]
  v_mfma_f32_32x32x16_bf16 v[32:47], a[200:203], a[136:139], v[32:47]
  v_mfma_f32_32x32x16_bf16 v[32:47], a[204:207], a[140:143], v[32:47]
  v_mfma_f32_32x32x16_bf16 v[32:47], a[208:211], a[144:147], v[32:47]
  v_mfma_f32_32x32x16_bf16 v[32:47], a[212:215], a[148:151], v[32:47]
  v_mfma_f32_32x32x16_bf16 v[32:47], a[216:219], a[152:155], v[32:47]
  v_mfma_f32_32x32x16_bf16 v[32:47], a[220:223], a[156:159], v[32:47]
  v_mfma_f32_32x32x16_bf16 v[48:63], a[192:195], a[160:163], v[80:95]
  v_mfma_f32_32x32x16_bf16 v[48:63], a[196:199], a[164:167], v[48:63]
  v_mfma_f32_32x32x16_bf16 v[48:63], a[200:203], a[168:171], v[48:63]
  v_mfma_f32_32x32x16_bf16 v[48:63], a[204:207], a[172:175], v[48:63]
  v_mfma_f32_32x32x16_bf16 v[48:63], a[208:211], a[176:179], v[48:63]
  v_mfma_f32_32x32x16_bf16 v[48:63], a[212:215], a[180:183], v[48:63]
  v_mfma_f32_32x32x16_bf16 v[48:63], a[216:219], a[184:187], v[48:63]
  v_mfma_f32_32x32x16_bf16 v[48:63], a[220:223], a[188:191], v[48:63]
  s_nop 7
  s_nop 3
  v_max3_f32 v8, v8, v32, v33
  v_max3_f32 v8, v8, v34, v35
  v_max3_f32 v8, v8, v36, v37
  v_max3_f32 v8, v8, v38, v39
  v_max3_f32 v8, v8, v40, v41
  v_max3_f32 v8, v8, v42, v43
  v_max3_f32 v8, v8, v44, v45
  v_max3_f32 v8, v8, v46, v47
  v_max3_f32 v10, v10, v48, v49
  v_max3_f32 v10, v10, v50, v51
  v_max3_f32 v10, v10, v52, v53
  v_max3_f32 v10, v10, v54, v55
  v_max3_f32 v10, v10, v56, v57
  v_max3_f32 v10, v10, v58, v59
  v_max3_f32 v10, v10, v60, v61
  v_max3_f32 v10, v10, v62, v63
  s_add_u32 s23, s23, 1
  s_cmp_lg_u32 s23, 1
  s_cbranch_scc1 A_m2_41
  v_mov_b32 v12, s24
  v_cmp_le_i32 s[40:41], 0, v5
  v_cmp_le_i32 s[42:43], 1, v5
  v_cmp_le_i32 s[44:45], 2, v5
  v_cmp_le_i32 s[46:47], 3, v5
  v_cndmask_b32 v64, v12, v6, s[40:41]
  v_cndmask_b32 v65, v12, v6, s[42:43]
  v_cndmask_b32 v66, v12, v6, s[44:45]
  v_cndmask_b32 v67, v12, v6, s[46:47]
  v_cmp_le_i32 s[40:41], 8, v5
  v_cmp_le_i32 s[42:43], 9, v5
  v_cmp_le_i32 s[44:45], 10, v5
  v_cmp_le_i32 s[46:47], 11, v5
  v_cndmask_b32 v68, v12, v6, s[40:41]
  v_cndmask_b32 v69, v12, v6, s[42:43]
  v_cndmask_b32 v70, v12, v6, s[44:45]
  v_cndmask_b32 v71, v12, v6, s[46:47]
  v_cmp_le_i32 s[40:41], 16, v5
  v_cmp_le_i32 s[42:43], 17, v5
  v_cmp_le_i32 s[44:45], 18, v5
  v_cmp_le_i32 s[46:47], 19, v5
  v_cndmask_b32 v72, v12, v6, s[40:41]
  v_cndmask_b32 v73, v12, v6, s[42:43]
  v_cndmask_b32 v74, v12, v6, s[44:45]
  v_cndmask_b32 v75, v12, v6, s[46:47]
  v_cmp_le_i32 s[40:41], 24, v5
  v_cmp_le_i32 s[42:43], 25, v5
  v_cmp_le_i32 s[44:45], 26, v5
  v_cmp_le_i32 s[46:47], 27, v5
  v_cndmask_b32 v76, v12, v6, s[40:41]
  v_cndmask_b32 v77, v12, v6, s[42:43]
  v_cndmask_b32 v78, v12, v6, s[44:45]
  v_cndmask_b32 v79, v12, v6, s[46:47]
  v_mov_b32 v80, v7
  v_mov_b32 v81, v7
  v_mov_b32 v82, v7
  v_mov_b32 v83, v7
  v_mov_b32 v84, v7
  v_mov_b32 v85, v7
  v_mov_b32 v86, v7
  v_mov_b32 v87, v7
  v_mov_b32 v88, v7
  v_mov_b32 v89, v7
  v_mov_b32 v90, v7
  v_mov_b32 v91, v7
  v_mov_b32 v92, v7
  v_mov_b32 v93, v7
  v_mov_b32 v94, v7
  v_mov_b32 v95, v7
A_m2_41:
  s_cmp_lg_u32 s23, 2
  s_cbranch_scc1 A_m3_42
  v_mov_b32 v64, v6
  v_mov_b32 v65, v6
  v_mov_b32 v66, v6
  v_mov_b32 v67, v6
  v_mov_b32 v68, v6
  v_mov_b32 v69, v6
  v_mov_b32 v70, v6
  v_mov_b32 v71, v6
  v_mov_b32 v72, v6
  v_mov_b32 v73, v6
  v_mov_b32 v74, v6
  v_mov_b32 v75, v6
  v_mov_b32 v76, v6
  v_mov_b32 v77, v6
  v_mov_b32 v78, v6
  v_mov_b32 v79, v6
A_m3_42:
  s_sub_u32 s17, s17, 8192
  s_cmp_ge_i32 s17, s19
  s_cbranch_scc1 A_ml_40
  v_mov_b32 v9, v8
  s_nop 1
  v_permlane32_swap_b32 v8, v9
  s_nop 1
  v_max_f32 v8, v8, v9
  v_sub_f32 v6, 0, v8
  v_mov_b32 v11, v10
  s_nop 1
  v_permlane32_swap_b32 v10, v11
  s_nop 1
  v_max_f32 v10, v10, v11
  v_sub_f32 v7, 0, v10
  s_branch A_again_21
A_out_31:
  s_mov_b32 s69, s55
  s_mov_b32 s70, s56
  s_sub_u32 s52, s52, 1
  s_cmp_lg_u32 s52, 0
  s_cbranch_scc1 M_att
  s_waitcnt vmcnt(0)
  s_barrier
  s_mov_b32 s30, 512
  v_mov_b32 v144, s30
  v_min_u32 v145, 1, v0
  v_lshlrev_b32 v145, 30, v145
  buffer_store_dword v144, v145, s[4:7], s31 offen sc1
  s_lshr_b32 s48, s64, 2
  s_bfe_u32 s49, s64, 0x10001
  s_and_b32 s50, s64, 1
  s_mul_i32 s50, s50, 6
  s_add_u32 s50, s50, s65
  s_mov_b32 s51, 12
  s_cmp_lt_u32 s50, 4
  s_cselect_b32 s23, 6, 5
  s_load_dwordx2 s[8:9], s[0:1], 40
  s_lshl_b32 s17, s48, 19
  s_lshl_b32 s26, s49, 2
  s_add_u32 s26, s26, s16
  s_lshl_b32 s27, s26, 7
  s_add_u32 s17, s17, s27
  s_mov_b32 s18, 1024
  s_lshl_b32 s21, s48, 6
  s_add_u32 s21, s21, s50
  s_lshl_b32 s21, s21, 3
  s_add_u32 s21, s21, s26
  s_lshl_b32 s21, s21, 12
  s_add_u32 s21, s21, 150994944
  s_lshl_b32 s22, s51, 15
  s_mov_b32 s24, 1.0
  s_waitcnt lgkmcnt(0)
  s_and_b32 s9, s9, 0xffff
  s_mov_b32 s10, 4194304
  s_mov_b32 s11, 0x20000
  s_mov_b32 s12, s4
  s_mov_b32 s13, s5
  s_mov_b32 s14, 268435456
  s_mov_b32 s15, 0x20000
  s_lshl_b32 s19, s48, 8
  s_add_u32 s19, s19, s50
  s_lshl_b32 s19, s19, 13
  s_add_u32 s19, s19, 100663296
  s_lshl_b32 s20, s51, 13
  v_lshrrev_b32 v144, 4, v1
  v_and_b32 v56, 0xff, v2
  v_lshl_add_u32 v56, v144, 9, v56
  s_mul_i32 s26, s16, 524288
  v_add_u32 v8, 0, v56
  v_add_u32 v16, 0, v2
  v_add_u32 v16, s26, v16
  v_add_u32 v9, 256, v56
  v_add_u32 v17, 1024, v2
  v_add_u32 v17, s26, v17
  v_add_u32 v10, 2048, v56
  v_add_u32 v18, 2048, v2
  v_add_u32 v18, s26, v18
  v_add_u32 v11, 2304, v56
  v_add_u32 v19, 3072, v2
  v_add_u32 v19, s26, v19
  v_add_u32 v12, 4096, v56
  v_add_u32 v20, 4096, v2
  v_add_u32 v20, s26, v20
  v_add_u32 v13, 4352, v56
  v_add_u32 v21, 5120, v2
  v_add_u32 v21, s26, v21
  v_add_u32 v14, 6144, v56
  v_add_u32 v22, 6144, v2
  v_add_u32 v22, s26, v22
  v_add_u32 v15, 6400, v56
  v_add_u32 v23, 7168, v2
  v_add_u32 v23, s26, v23
  v_lshrrev_b32 v144, 3, v1
  v_mul_lo_u32 v144, v144, s18
  v_and_b32 v145, 7, v1
  v_lshl_add_u32 v144, v145, 4, v144
  s_lshl_b32 s28, s16, 15
  s_add_u32 s28, s28, 32768
  s_lshl_b32 s29, s18, 3
  s_add_u32 m0, s28, 0
  s_nop 0
  buffer_load_dwordx4 v144, s[8:11], s17 offen lds
  s_add_u32 s17, s17, s29
  s_add_u32 m0, s28, 1024
  s_nop 0
  buffer_load_dwordx4 v144, s[8:11], s17 offen lds
  s_add_u32 s17, s17, s29
  s_add_u32 m0, s28, 2048
  s_nop 0
  buffer_load_dwordx4 v144, s[8:11], s17 offen lds
  s_add_u32 s17, s17, s29
  s_add_u32 m0, s28, 3072
  s_nop 0
  buffer_load_dwordx4 v144, s[8:11], s17 offen lds
  s_add_u32 s17, s17, s29
  s_add_u32 m0, s28, 4096
  s_nop 0
  buffer_load_dwordx4 v144, s[8:11], s17 offen lds
  s_add_u32 s17, s17, s29
  s_add_u32 m0, s28, 5120
  s_nop 0
  buffer_load_dwordx4 v144, s[8:11], s17 offen lds
  s_add_u32 s17, s17, s29
  s_add_u32 m0, s28, 6144
  s_nop 0
  buffer_load_dwordx4 v144, s[8:11], s17 offen lds
  s_add_u32 s17, s17, s29
  s_add_u32 m0, s28, 7168
  s_nop 0
  buffer_load_dwordx4 v144, s[8:11], s17 offen lds
  s_add_u32 s17, s17, s29
  s_add_u32 m0, s28, 8192
  s_nop 0
  buffer_load_dwordx4 v144, s[8:11], s17 offen lds
  s_add_u32 s17, s17, s29
  s_add_u32 m0, s28, 9216
  s_nop 0
  buffer_load_dwordx4 v144, s[8:11], s17 offen lds
  s_add_u32 s17, s17, s29
  s_add_u32 m0, s28, 10240
  s_nop 0
  buffer_load_dwordx4 v144, s[8:11], s17 offen lds
  s_add_u32 s17, s17, s29
  s_add_u32 m0, s28, 11264
  s_nop 0
  buffer_load_dwordx4 v144, s[8:11], s17 offen lds
  s_add_u32 s17, s17, s29
  s_add_u32 m0, s28, 12288
  s_nop 0
  buffer_load_dwordx4 v144, s[8:11], s17 offen lds
  s_add_u32 s17, s17, s29
  s_add_u32 m0, s28, 13312
  s_nop 0
  buffer_load_dwordx4 v144, s[8:11], s17 offen lds
  s_add_u32 s17, s17, s29
  s_add_u32 m0, s28, 14336
  s_nop 0
  buffer_load_dwordx4 v144, s[8:11], s17 offen lds
  s_add_u32 s17, s17, s29
  s_add_u32 m0, s28, 15360
  s_nop 0
  buffer_load_dwordx4 v144, s[8:11], s17 offen lds
  s_add_u32 s17, s17, s29
  s_add_u32 m0, s28, 16384
  s_nop 0
  buffer_load_dwordx4 v144, s[8:11], s17 offen lds
  s_add_u32 s17, s17, s29
  s_add_u32 m0, s28, 17408
  s_nop 0
  buffer_load_dwordx4 v144, s[8:11], s17 offen lds
  s_add_u32 s17, s17, s29
  s_add_u32 m0, s28, 18432
  s_nop 0
  buffer_load_dwordx4 v144, s[8:11], s17 offen lds
  s_add_u32 s17, s17, s29
  s_add_u32 m0, s28, 19456
  s_nop 0
  buffer_load_dwordx4 v144, s[8:11], s17 offen lds
  s_add_u32 s17, s17, s29
  s_add_u32 m0, s28, 20480
  s_nop 0
  buffer_load_dwordx4 v144, s[8:11], s17 offen lds
  s_add_u32 s17, s17, s29
  s_add_u32 m0, s28, 21504
  s_nop 0
  buffer_load_dwordx4 v144, s[8:11], s17 offen lds
  s_add_u32 s17, s17, s29
  s_add_u32 m0, s28, 22528
  s_nop 0
  buffer_load_dwordx4 v144, s[8:11], s17 offen lds
  s_add_u32 s17, s17, s29
  s_add_u32 m0, s28, 23552
  s_nop 0
  buffer_load_dwordx4 v144, s[8:11], s17 offen lds
  s_add_u32 s17, s17, s29
  s_add_u32 m0, s28, 24576
  s_nop 0
  buffer_load_dwordx4 v144, s[8:11], s17 offen lds
  s_add_u32 s17, s17, s29
  s_add_u32 m0, s28, 25600
  s_nop 0
  buffer_load_dwordx4 v144, s[8:11], s17 offen lds
  s_add_u32 s17, s17, s29
  s_add_u32 m0, s28, 26624
  s_nop 0
  buffer_load_dwordx4 v144, s[8:11], s17 offen lds
  s_add_u32 s17, s17, s29
  s_add_u32 m0, s28, 27648
  s_nop 0
  buffer_load_dwordx4 v144, s[8:11], s17 offen lds
  s_add_u32 s17, s17, s29
  s_add_u32 m0, s28, 28672
  s_nop 0
  buffer_load_dwordx4 v144, s[8:11], s17 offen lds
  s_add_u32 s17, s17, s29
  s_add_u32 m0, s28, 29696
  s_nop 0
  buffer_load_dwordx4 v144, s[8:11], s17 offen lds
  s_add_u32 s17, s17, s29
  s_add_u32 m0, s28, 30720
  s_nop 0
  buffer_load_dwordx4 v144, s[8:11], s17 offen lds
  s_add_u32 s17, s17, s29
  s_add_u32 m0, s28, 31744
  s_nop 0
  buffer_load_dwordx4 v144, s[8:11], s17 offen lds
  s_add_u32 s17, s17, s29
  v_bfe_u32 v148, v1, 2, 2
  v_lshrrev_b32 v149, 5, v1
  v_lshl_add_u32 v148, v149, 4, v148
  v_bfe_u32 v149, v1, 4, 1
  v_lshl_add_u32 v148, v149, 2, v148
  v_and_b32 v149, 3, v1
  v_lshlrev_b32 v149, 4, v149
  s_mov_b32 s26, 8
  v_lshl_add_u32 v148, v148, 7, v149
  v_add_u32 v152, s28, v148
  v_add_u32 v153, 1024, v152
  v_add_u32 v154, s26, v152
  v_add_u32 v155, s26, v153
  s_waitcnt vmcnt(28)
  ds_read_b64_tr_b16 a[0:1], v152 offset:0
  ds_read_b64_tr_b16 a[2:3], v153 offset:0
  ds_read_b64_tr_b16 a[4:5], v154 offset:0
  ds_read_b64_tr_b16 a[6:7], v155 offset:0
  ds_read_b64_tr_b16 a[8:9], v152 offset:64
  ds_read_b64_tr_b16 a[10:11], v153 offset:64
  ds_read_b64_tr_b16 a[12:13], v154 offset:64
  ds_read_b64_tr_b16 a[14:15], v155 offset:64
  s_waitcnt lgkmcnt(0)
  s_add_u32 m0, s28, 0
  s_nop 0
  buffer_load_dwordx4 v144, s[8:11], s17 offen lds
  s_add_u32 s17, s17, s29
  s_add_u32 m0, s28, 1024
  s_nop 0
  buffer_load_dwordx4 v144, s[8:11], s17 offen lds
  s_add_u32 s17, s17, s29
  s_add_u32 m0, s28, 2048
  s_nop 0
  buffer_load_dwordx4 v144, s[8:11], s17 offen lds
  s_add_u32 s17, s17, s29
  s_add_u32 m0, s28, 3072
  s_nop 0
  buffer_load_dwordx4 v144, s[8:11], s17 offen lds
  s_add_u32 s17, s17, s29
  s_waitcnt vmcnt(28)
  ds_read_b64_tr_b16 a[16:17], v152 offset:4096
  ds_read_b64_tr_b16 a[18:19], v153 offset:4096
  ds_read_b64_tr_b16 a[20:21], v154 offset:4096
  ds_read_b64_tr_b16 a[22:23], v155 offset:4096
  ds_read_b64_tr_b16 a[24:25], v152 offset:4160
  ds_read_b64_tr_b16 a[26:27], v153 offset:4160
  ds_read_b64_tr_b16 a[28:29], v154 offset:4160
  ds_read_b64_tr_b16 a[30:31], v155 offset:4160
  s_waitcnt lgkmcnt(0)
  s_add_u32 m0, s28, 4096
  s_nop 0
  buffer_load_dwordx4 v144, s[8:11], s17 offen lds
  s_add_u32 s17, s17, s29
  s_add_u32 m0, s28, 5120
  s_nop 0
  buffer_load_dwordx4 v144, s[8:11], s17 offen lds
  s_add_u32 s17, s17, s29
  s_add_u32 m0, s28, 6144
  s_nop 0
  buffer_load_dwordx4 v144, s[8:11], s17 offen lds
  s_add_u32 s17, s17, s29
  s_add_u32 m0, s28, 7168
  s_nop 0
  buffer_load_dwordx4 v144, s[8:11], s17 offen lds
  s_add_u32 s17, s17, s29
  s_waitcnt vmcnt(28)
  ds_read_b64_tr_b16 a[32:33], v152 offset:8192
  ds_read_b64_tr_b16 a[34:35], v153 offset:8192
  ds_read_b64_tr_b16 a[36:37], v154 offset:8192
  ds_read_b64_tr_b16 a[38:39], v155 offset:8192
  ds_read_b64_tr_b16 a[40:41], v152 offset:8256
  ds_read_b64_tr_b16 a[42:43], v153 offset:8256
  ds_read_b64_tr_b16 a[44:45], v154 offset:8256
  ds_read_b64_tr_b16 a[46:47], v155 offset:8256
  s_waitcnt lgkmcnt(0)
  s_add_u32 m0, s28, 8192
  s_nop 0
  buffer_load_dwordx4 v144, s[8:11], s17 offen lds
  s_add_u32 s17, s17, s29
  s_add_u32 m0, s28, 9216
  s_nop 0
  buffer_load_dwordx4 v144, s[8:11], s17 offen lds
  s_add_u32 s17, s17, s29
  s_add_u32 m0, s28, 10240
  s_nop 0
  buffer_load_dwordx4 v144, s[8:11], s17 offen lds
  s_add_u32 s17, s17, s29
  s_add_u32 m0, s28, 11264
  s_nop 0
  buffer_load_dwordx4 v144, s[8:11], s17 offen lds
  s_add_u32 s17, s17, s29
  s_waitcnt vmcnt(28)
  ds_read_b64_tr_b16 a[48:49], v152 offset:12288
  ds_read_b64_tr_b16 a[50:51], v153 offset:12288
  ds_read_b64_tr_b16 a[52:53], v154 offset:12288
  ds_read_b64_tr_b16 a[54:55], v155 offset:12288
  ds_read_b64_tr_b16 a[56:57], v152 offset:12352
  ds_read_b64_tr_b16 a[58:59], v153 offset:12352
  ds_read_b64_tr_b16 a[60:61], v154 offset:12352
  ds_read_b64_tr_b16 a[62:63], v155 offset:12352
  s_waitcnt lgkmcnt(0)
  s_add_u32 m0, s28, 12288
  s_nop 0
  buffer_load_dwordx4 v144, s[8:11], s17 offen lds
  s_add_u32 s17, s17, s29
  s_add_u32 m0, s28, 13312
  s_nop 0
  buffer_load_dwordx4 v144, s[8:11], s17 offen lds
  s_add_u32 s17, s17, s29
  s_add_u32 m0, s28, 14336
  s_nop 0
  buffer_load_dwordx4 v144, s[8:11], s17 offen lds
  s_add_u32 s17, s17, s29
  s_add_u32 m0, s28, 15360
  s_nop 0
  buffer_load_dwordx4 v144, s[8:11], s17 offen lds
  s_add_u32 s17, s17, s29
  s_waitcnt vmcnt(28)
  ds_read_b64_tr_b16 a[64:65], v152 offset:16384
  ds_read_b64_tr_b16 a[66:67], v153 offset:16384
  ds_read_b64_tr_b16 a[68:69], v154 offset:16384
  ds_read_b64_tr_b16 a[70:71], v155 offset:16384
  ds_read_b64_tr_b16 a[72:73], v152 offset:16448
  ds_read_b64_tr_b16 a[74:75], v153 offset:16448
  ds_read_b64_tr_b16 a[76:77], v154 offset:16448
  ds_read_b64_tr_b16 a[78:79], v155 offset:16448
  s_waitcnt lgkmcnt(0)
  s_add_u32 m0, s28, 16384
  s_nop 0
  buffer_load_dwordx4 v144, s[8:11], s17 offen lds
  s_add_u32 s17, s17, s29
  s_add_u32 m0, s28, 17408
  s_nop 0
  buffer_load_dwordx4 v144, s[8:11], s17 offen lds
  s_add_u32 s17, s17, s29
  s_add_u32 m0, s28, 18432
  s_nop 0
  buffer_load_dwordx4 v144, s[8:11], s17 offen lds
  s_add_u32 s17, s17, s29
  s_add_u32 m0, s28, 19456
  s_nop 0
  buffer_load_dwordx4 v144, s[8:11], s17 offen lds
  s_add_u32 s17, s17, s29
  s_waitcnt vmcnt(28)
  ds_read_b64_tr_b16 a[80:81], v152 offset:20480
  ds_read_b64_tr_b16 a[82:83], v153 offset:20480
  ds_read_b64_tr_b16 a[84:85], v154 offset:20480
  ds_read_b64_tr_b16 a[86:87], v155 offset:20480
  ds_read_b64_tr_b16 a[88:89], v152 offset:20544
  ds_read_b64_tr_b16 a[90:91], v153 offset:20544
  ds_read_b64_tr_b16 a[92:93], v154 offset:20544
  ds_read_b64_tr_b16 a[94:95], v155 offset:20544
  s_waitcnt lgkmcnt(0)
  s_add_u32 m0, s28, 20480
  s_nop 0
  buffer_load_dwordx4 v144, s[8:11], s17 offen lds
  s_add_u32 s17, s17, s29
  s_add_u32 m0, s28, 21504
  s_nop 0
  buffer_load_dwordx4 v144, s[8:11], s17 offen lds
  s_add_u32 s17, s17, s29
  s_add_u32 m0, s28, 22528
  s_nop 0
  buffer_load_dwordx4 v144, s[8:11], s17 offen lds
  s_add_u32 s17, s17, s29
  s_add_u32 m0, s28, 23552
  s_nop 0
  buffer_load_dwordx4 v144, s[8:11], s17 offen lds
  s_add_u32 s17, s17, s29
  s_waitcnt vmcnt(28)
  ds_read_b64_tr_b16 a[96:97], v152 offset:24576
  ds_read_b64_tr_b16 a[98:99], v153 offset:24576
  ds_read_b64_tr_b16 a[100:101], v154 offset:24576
  ds_read_b64_tr_b16 a[102:103], v155 offset:24576
  ds_read_b64_tr_b16 a[104:105], v152 offset:24640
  ds_read_b64_tr_b16 a[106:107], v153 offset:24640
  ds_read_b64_tr_b16 a[108:109], v154 offset:24640
  ds_read_b64_tr_b16 a[110:111], v155 offset:24640
  s_waitcnt lgkmcnt(0)
  s_add_u32 m0, s28, 24576
  s_nop 0
  buffer_load_dwordx4 v144, s[8:11], s17 offen lds
  s_add_u32 s17, s17, s29
  s_add_u32 m0, s28, 25600
  s_nop 0
  buffer_load_dwordx4 v144, s[8:11], s17 offen lds
  s_add_u32 s17, s17, s29
  s_add_u32 m0, s28, 26624
  s_nop 0
  buffer_load_dwordx4 v144, s[8:11], s17 offen lds
  s_add_u32 s17, s17, s29
  s_add_u32 m0, s28, 27648
  s_nop 0
  buffer_load_dwordx4 v144, s[8:11], s17 offen lds
  s_add_u32 s17, s17, s29
  s_waitcnt vmcnt(28)
  ds_read_b64_tr_b16 a[112:113], v152 offset:28672
  ds_read_b64_tr_b16 a[114:115], v153 offset:28672
  ds_read_b64_tr_b16 a[116:117], v154 offset:28672
  ds_read_b64_tr_b16 a[118:119], v155 offset:28672
  ds_read_b64_tr_b16 a[120:121], v152 offset:28736
  ds_read_b64_tr_b16 a[122:123], v153 offset:28736
  ds_read_b64_tr_b16 a[124:125], v154 offset:28736
  ds_read_b64_tr_b16 a[126:127], v155 offset:28736
  s_waitcnt lgkmcnt(0)
  s_add_u32 m0, s28, 28672
  s_nop 0
  buffer_load_dwordx4 v144, s[8:11], s17 offen lds
  s_add_u32 s17, s17, s29
  s_add_u32 m0, s28, 29696
  s_nop 0
  buffer_load_dwordx4 v144, s[8:11], s17 offen lds
  s_add_u32 s17, s17, s29
  s_add_u32 m0, s28, 30720
  s_nop 0
  buffer_load_dwordx4 v144, s[8:11], s17 offen lds
  s_add_u32 s17, s17, s29
  s_add_u32 m0, s28, 31744
  s_nop 0
  buffer_load_dwordx4 v144, s[8:11], s17 offen lds
  s_add_u32 s17, s17, s29
  s_waitcnt vmcnt(28)
  ds_read_b64_tr_b16 a[128:129], v152 offset:0
  ds_read_b64_tr_b16 a[130:131], v153 offset:0
  ds_read_b64_tr_b16 a[132:133], v154 offset:0
  ds_read_b64_tr_b16 a[134:135], v155 offset:0
  ds_read_b64_tr_b16 a[136:137], v152 offset:64
  ds_read_b64_tr_b16 a[138:139], v153 offset:64
  ds_read_b64_tr_b16 a[140:141], v154 offset:64
  ds_read_b64_tr_b16 a[142:143], v155 offset:64
  s_waitcnt lgkmcnt(0)
  s_waitcnt vmcnt(24)
  ds_read_b64_tr_b16 a[144:145], v152 offset:4096
  ds_read_b64_tr_b16 a[146:147], v153 offset:4096
  ds_read_b64_tr_b16 a[148:149], v154 offset:4096
  ds_read_b64_tr_b16 a[150:151], v155 offset:4096
  ds_read_b64_tr_b16 a[152:153], v152 offset:4160
  ds_read_b64_tr_b16 a[154:155], v153 offset:4160
  ds_read_b64_tr_b16 a[156:157], v154 offset:4160
  ds_read_b64_tr_b16 a[158:159], v155 offset:4160
  s_waitcnt lgkmcnt(0)
  s_waitcnt vmcnt(20)
  ds_read_b64_tr_b16 a[160:161], v152 offset:8192
  ds_read_b64_tr_b16 a[162:163], v153 offset:8192
  ds_read_b64_tr_b16 a[164:165], v154 offset:8192
  ds_read_b64_tr_b16 a[166:167], v155 offset:8192
  ds_read_b64_tr_b16 a[168:169], v152 offset:8256
  ds_read_b64_tr_b16 a[170:171], v153 offset:8256
  ds_read_b64_tr_b16 a[172:173], v154 offset:8256
  ds_read_b64_tr_b16 a[174:175], v155 offset:8256
  s_waitcnt lgkmcnt(0)
  s_waitcnt vmcnt(16)
  ds_read_b64_tr_b16 a[176:177], v152 offset:12288
  ds_read_b64_tr_b16 a[178:179], v153 offset:12288
  ds_read_b64_tr_b16 a[180:181], v154 offset:12288
  ds_read_b64_tr_b16 a[182:183], v155 offset:12288
  ds_read_b64_tr_b16 a[184:185], v152 offset:12352
  ds_read_b64_tr_b16 a[186:187], v153 offset:12352
  ds_read_b64_tr_b16 a[188:189], v154 offset:12352
  ds_read_b64_tr_b16 a[190:191], v155 offset:12352
  s_waitcnt lgkmcnt(0)
  s_waitcnt vmcnt(12)
  ds_read_b64_tr_b16 a[192:193], v152 offset:16384
  ds_read_b64_tr_b16 a[194:195], v153 offset:16384
  ds_read_b64_tr_b16 a[196:197], v154 offset:16384
  ds_read_b64_tr_b16 a[198:199], v155 offset:16384
  ds_read_b64_tr_b16 a[200:201], v152 offset:16448
  ds_read_b64_tr_b16 a[202:203], v153 offset:16448
  ds_read_b64_tr_b16 a[204:205], v154 offset:16448
  ds_read_b64_tr_b16 a[206:207], v155 offset:16448
  s_waitcnt lgkmcnt(0)
  s_waitcnt vmcnt(8)
  ds_read_b64_tr_b16 a[208:209], v152 offset:20480
  ds_read_b64_tr_b16 a[210:211], v153 offset:20480
  ds_read_b64_tr_b16 a[212:213], v154 offset:20480
  ds_read_b64_tr_b16 a[214:215], v155 offset:20480
  ds_read_b64_tr_b16 a[216:217], v152 offset:20544
  ds_read_b64_tr_b16 a[218:219], v153 offset:20544
  ds_read_b64_tr_b16 a[220:221], v154 offset:20544
  ds_read_b64_tr_b16 a[222:223], v155 offset:20544
  s_waitcnt lgkmcnt(0)
  s_waitcnt vmcnt(4)
  ds_read_b64_tr_b16 a[224:225], v152 offset:24576
  ds_read_b64_tr_b16 a[226:227], v153 offset:24576
  ds_read_b64_tr_b16 a[228:229], v154 offset:24576
  ds_read_b64_tr_b16 a[230:231], v155 offset:24576
  ds_read_b64_tr_b16 a[232:233], v152 offset:24640
  ds_read_b64_tr_b16 a[234:235], v153 offset:24640
  ds_read_b64_tr_b16 a[236:237], v154 offset:24640
  ds_read_b64_tr_b16 a[238:239], v155 offset:24640
  s_waitcnt lgkmcnt(0)
  s_waitcnt vmcnt(0)
  ds_read_b64_tr_b16 a[240:241], v152 offset:28672
  ds_read_b64_tr_b16 a[242:243], v153 offset:28672
  ds_read_b64_tr_b16 a[244:245], v154 offset:28672
  ds_read_b64_tr_b16 a[246:247], v155 offset:28672
  ds_read_b64_tr_b16 a[248:249], v152 offset:28736
  ds_read_b64_tr_b16 a[250:251], v153 offset:28736
  ds_read_b64_tr_b16 a[252:253], v154 offset:28736
  ds_read_b64_tr_b16 a[254:255], v155 offset:28736
  s_waitcnt lgkmcnt(0)
  v_min_u32 v4, 27, v1
  v_mul_u32_u24 v5, 37, v4
  v_lshrrev_b32 v5, 8, v5
  v_mul_u32_u24 v5, 7, v5
  v_sub_u32 v5, v4, v5
  v_mov_b32 v6, 0x200
  v_cmp_ne_u32 vcc, 6, v5
  s_mul_i32 s76, s48, 3584
  s_add_u32 s76, s76, 148897792
  v_cndmask_b32 v5, 0, v6, vcc
  v_lshl_add_u32 v4, v4, 7, s76
  s_mov_b32 s71, 0
  s_branch M_vg_44
M_vw_43:
  s_sleep 2
  s_add_u32 s71, s71, 1
  s_cmp_gt_u32 s71, 262144
  s_cbranch_scc1 M_exit
M_vg_44:
  buffer_load_dword v6, v4, s[4:7], 0 offen sc1
  s_waitcnt vmcnt(0)
  v_cmp_lt_u32 vcc, v6, v5
  s_cbranch_vccnz M_vw_43
  s_barrier
  s_lshl_b32 s25, s16, 13
  s_add_u32 m0, s25, 0
  s_nop 0
  buffer_load_dwordx4 v16, s[12:15], s19 offen sc1 lds
  s_add_u32 m0, s25, 1024
  s_nop 0
  buffer_load_dwordx4 v17, s[12:15], s19 offen sc1 lds
  s_add_u32 m0, s25, 2048
  s_nop 0
  buffer_load_dwordx4 v18, s[12:15], s19 offen sc1 lds
  s_add_u32 m0, s25, 3072
  s_nop 0
  buffer_load_dwordx4 v19, s[12:15], s19 offen sc1 lds
  s_add_u32 m0, s25, 4096
  s_nop 0
  buffer_load_dwordx4 v20, s[12:15], s19 offen sc1 lds
  s_add_u32 m0, s25, 5120
  s_nop 0
  buffer_load_dwordx4 v21, s[12:15], s19 offen sc1 lds
  s_add_u32 m0, s25, 6144
  s_nop 0
  buffer_load_dwordx4 v22, s[12:15], s19 offen sc1 lds
  s_add_u32 m0, s25, 7168
  s_nop 0
  buffer_load_dwordx4 v23, s[12:15], s19 offen sc1 lds
  s_cmp_gt_u32 s23, 1
  s_cselect_b32 s26, s20, 0
  s_add_u32 s19, s19, s26
  s_add_u32 s25, s25, 32768
  s_and_b32 s25, s25, 0x1ffff
  s_add_u32 m0, s25, 0
  s_nop 0
  buffer_load_dwordx4 v16, s[12:15], s19 offen sc1 lds
  s_add_u32 m0, s25, 1024
  s_nop 0
  buffer_load_dwordx4 v17, s[12:15], s19 offen sc1 lds
  s_add_u32 m0, s25, 2048
  s_nop 0
  buffer_load_dwordx4 v18, s[12:15], s19 offen sc1 lds
  s_add_u32 m0, s25, 3072
  s_nop 0
  buffer_load_dwordx4 v19, s[12:15], s19 offen sc1 lds
  s_add_u32 m0, s25, 4096
  s_nop 0
  buffer_load_dwordx4 v20, s[12:15], s19 offen sc1 lds
  s_add_u32 m0, s25, 5120
  s_nop 0
  buffer_load_dwordx4 v21, s[12:15], s19 offen sc1 lds
  s_add_u32 m0, s25, 6144
  s_nop 0
  buffer_load_dwordx4 v22, s[12:15], s19 offen sc1 lds
  s_add_u32 m0, s25, 7168
  s_nop 0
  buffer_load_dwordx4 v23, s[12:15], s19 offen sc1 lds
  s_cmp_gt_u32 s23, 2
  s_cselect_b32 s26, s20, 0
  s_add_u32 s19, s19, s26
  s_add_u32 s25, s25, 32768
  s_and_b32 s25, s25, 0x1ffff
  s_waitcnt vmcnt(0)
  s_barrier
  s_mov_b32 s27, s21
  v_mov_b32 v7, 0x40000000
  ds_read_b128 v[24:27], v8 offset:0
  ds_read_b128 v[28:31], v9 offset:0
  ds_read_b128 v[32:35], v10 offset:0
  ds_read_b128 v[36:39], v11 offset:0
  ds_read_b128 v[40:43], v12 offset:0
  ds_read_b128 v[44:47], v13 offset:0
.p2align 6
G_top_45:
  s_waitcnt lgkmcnt(5)
  v_mfma_f32_16x16x32_bf16 v[64:67], a[0:3], v[24:27], 0
  s_add_u32 m0, s25, 0
  ds_read_b128 v[48:51], v14 offset:0
  v_mfma_f32_16x16x32_bf16 v[68:71], a[4:7], v[24:27], 0
  v_mfma_f32_16x16x32_bf16 v[80:83], a[8:11], v[24:27], 0
  buffer_load_dwordx4 v16, s[12:15], s19 offen sc1 lds
  v_mfma_f32_16x16x32_bf16 v[84:87], a[12:15], v[24:27], 0
  s_waitcnt lgkmcnt(5)
  v_mfma_f32_16x16x32_bf16 v[72:75], a[0:3], v[28:31], 0
  ds_read_b128 v[52:55], v15 offset:0
  v_mfma_f32_16x16x32_bf16 v[76:79], a[4:7], v[28:31], 0
  v_mul_f32 v96, s24, v96
  v_mul_f32 v97, s24, v97
  v_mfma_f32_16x16x32_bf16 v[88:91], a[8:11], v[28:31], 0
  v_mfma_f32_16x16x32_bf16 v[92:95], a[12:15], v[28:31], 0
  s_waitcnt lgkmcnt(5)
  v_cvt_pk_bf16_f32 v128, v96, v97
  v_mul_f32 v98, s24, v98
  v_mfma_f32_16x16x32_bf16 v[64:67], a[16:19], v[32:35], v[64:67]
  s_add_u32 m0, s25, 1024
  ds_read_b128 v[24:27], v8 offset:8192
  v_mfma_f32_16x16x32_bf16 v[68:71], a[20:23], v[32:35], v[68:71]
  v_mul_f32 v99, s24, v99
  v_cvt_pk_bf16_f32 v129, v98, v99
  v_mfma_f32_16x16x32_bf16 v[80:83], a[24:27], v[32:35], v[80:83]
  buffer_load_dwordx4 v17, s[12:15], s19 offen sc1 lds
  v_mfma_f32_16x16x32_bf16 v[84:87], a[28:31], v[32:35], v[84:87]
  s_waitcnt lgkmcnt(5)
  v_mul_f32 v100, s24, v100
  v_mul_f32 v101, s24, v101
  v_mfma_f32_16x16x32_bf16 v[72:75], a[16:19], v[36:39], v[72:75]
  ds_read_b128 v[28:31], v9 offset:8192
  v_mfma_f32_16x16x32_bf16 v[76:79], a[20:23], v[36:39], v[76:79]
  v_cvt_pk_bf16_f32 v130, v100, v101
  v_mul_f32 v102, s24, v102
  v_mfma_f32_16x16x32_bf16 v[88:91], a[24:27], v[36:39], v[88:91]
  v_mfma_f32_16x16x32_bf16 v[92:95], a[28:31], v[36:39], v[92:95]
  s_waitcnt lgkmcnt(5)
  v_mul_f32 v103, s24, v103
  v_cvt_pk_bf16_f32 v131, v102, v103
  v_mfma_f32_16x16x32_bf16 v[64:67], a[32:35], v[40:43], v[64:67]
  s_add_u32 m0, s25, 2048
  ds_read_b128 v[32:35], v10 offset:8192
  v_mfma_f32_16x16x32_bf16 v[68:71], a[36:39], v[40:43], v[68:71]
  v_mul_f32 v104, s24, v104
  v_mul_f32 v105, s24, v105
  v_mfma_f32_16x16x32_bf16 v[80:83], a[40:43], v[40:43], v[80:83]
  buffer_load_dwordx4 v18, s[12:15], s19 offen sc1 lds
  v_mfma_f32_16x16x32_bf16 v[84:87], a[44:47], v[40:43], v[84:87]
  s_waitcnt lgkmcnt(5)
  v_cvt_pk_bf16_f32 v132, v104, v105
  v_mul_f32 v106, s24, v106
  v_mfma_f32_16x16x32_bf16 v[72:75], a[32:35], v[44:47], v[72:75]
  ds_read_b128 v[36:39], v11 offset:8192
  v_mfma_f32_16x16x32_bf16 v[76:79], a[36:39], v[44:47], v[76:79]
  v_mul_f32 v107, s24, v107
  v_cvt_pk_bf16_f32 v133, v106, v107
  v_mfma_f32_16x16x32_bf16 v[88:91], a[40:43], v[44:47], v[88:91]
  v_mfma_f32_16x16x32_bf16 v[92:95], a[44:47], v[44:47], v[92:95]
  s_waitcnt lgkmcnt(5)
  v_mul_f32 v108, s24, v108
  v_mul_f32 v109, s24, v109
  v_mfma_f32_16x16x32_bf16 v[64:67], a[48:51], v[48:51], v[64:67]
  s_add_u32 m0, s25, 3072
  ds_read_b128 v[40:43], v12 offset:8192
  v_mfma_f32_16x16x32_bf16 v[68:71], a[52:55], v[48:51], v[68:71]
  v_cvt_pk_bf16_f32 v134, v108, v109
  v_mul_f32 v110, s24, v110
  v_mfma_f32_16x16x32_bf16 v[80:83], a[56:59], v[48:51], v[80:83]
  buffer_load_dwordx4 v19, s[12:15], s19 offen sc1 lds
  v_mfma_f32_16x16x32_bf16 v[84:87], a[60:63], v[48:51], v[84:87]
  s_waitcnt lgkmcnt(5)
  v_mul_f32 v111, s24, v111
  v_cvt_pk_bf16_f32 v135, v110, v111
  v_mfma_f32_16x16x32_bf16 v[72:75], a[48:51], v[52:55], v[72:75]
  ds_read_b128 v[44:47], v13 offset:8192
  v_mfma_f32_16x16x32_bf16 v[76:79], a[52:55], v[52:55], v[76:79]
  v_mul_f32 v112, s24, v112
  v_mul_f32 v113, s24, v113
  v_mfma_f32_16x16x32_bf16 v[88:91], a[56:59], v[52:55], v[88:91]
  v_mfma_f32_16x16x32_bf16 v[92:95], a[60:63], v[52:55], v[92:95]
  s_waitcnt lgkmcnt(5)
  v_cvt_pk_bf16_f32 v136, v112, v113
  v_mul_f32 v114, s24, v114
  v_mfma_f32_16x16x32_bf16 v[64:67], a[64:67], v[24:27], v[64:67]
  s_add_u32 m0, s25, 4096
  ds_read_b128 v[48:51], v14 offset:8192
  v_mfma_f32_16x16x32_bf16 v[68:71], a[68:71], v[24:27], v[68:71]
  v_mul_f32 v115, s24, v115
  v_cvt_pk_bf16_f32 v137, v114, v115
  v_mfma_f32_16x16x32_bf16 v[80:83], a[72:75], v[24:27], v[80:83]
  buffer_load_dwordx4 v20, s[12:15], s19 offen sc1 lds
  v_mfma_f32_16x16x32_bf16 v[84:87], a[76:79], v[24:27], v[84:87]
  s_waitcnt lgkmcnt(5)
  v_mul_f32 v116, s24, v116
  v_mul_f32 v117, s24, v117
  v_mfma_f32_16x16x32_bf16 v[72:75], a[64:67], v[28:31], v[72:75]
  ds_read_b128 v[52:55], v15 offset:8192
  v_mfma_f32_16x16x32_bf16 v[76:79], a[68:71], v[28:31], v[76:79]
  v_cvt_pk_bf16_f32 v138, v116, v117
  v_mul_f32 v118, s24, v118
  v_mfma_f32_16x16x32_bf16 v[88:91], a[72:75], v[28:31], v[88:91]
  v_mfma_f32_16x16x32_bf16 v[92:95], a[76:79], v[28:31], v[92:95]
  s_waitcnt lgkmcnt(5)
  v_mul_f32 v119, s24, v119
  v_cvt_pk_bf16_f32 v139, v118, v119
  v_mfma_f32_16x16x32_bf16 v[64:67], a[80:83], v[32:35], v[64:67]
  s_add_u32 m0, s25, 5120
  ds_read_b128 v[24:27], v8 offset:16384
  v_mfma_f32_16x16x32_bf16 v[68:71], a[84:87], v[32:35], v[68:71]
  v_mul_f32 v120, s24, v120
  v_mul_f32 v121, s24, v121
  v_mfma_f32_16x16x32_bf16 v[80:83], a[88:91], v[32:35], v[80:83]
  buffer_load_dwordx4 v21, s[12:15], s19 offen sc1 lds
  v_mfma_f32_16x16x32_bf16 v[84:87], a[92:95], v[32:35], v[84:87]
  s_waitcnt lgkmcnt(5)
  v_cvt_pk_bf16_f32 v140, v120, v121
  v_mul_f32 v122, s24, v122
  v_mfma_f32_16x16x32_bf16 v[72:75], a[80:83], v[36:39], v[72:75]
  ds_read_b128 v[28:31], v9 offset:16384
  v_mfma_f32_16x16x32_bf16 v[76:79], a[84:87], v[36:39], v[76:79]
  v_mul_f32 v123, s24, v123
  v_cvt_pk_bf16_f32 v141, v122, v123
  v_mfma_f32_16x16x32_bf16 v[88:91], a[88:91], v[36:39], v[88:91]
  v_mfma_f32_16x16x32_bf16 v[92:95], a[92:95], v[36:39], v[92:95]
  s_waitcnt lgkmcnt(5)
  v_mul_f32 v124, s24, v124
  v_mul_f32 v125, s24, v125
  v_mfma_f32_16x16x32_bf16 v[64:67], a[96:99], v[40:43], v[64:67]
  s_add_u32 m0, s25, 6144
  ds_read_b128 v[32:35], v10 offset:16384
  v_mfma_f32_16x16x32_bf16 v[68:71], a[100:103], v[40:43], v[68:71]
  v_cvt_pk_bf16_f32 v142, v124, v125
  v_mul_f32 v126, s24, v126
  v_mfma_f32_16x16x32_bf16 v[80:83], a[104:107], v[40:43], v[80:83]
  buffer_load_dwordx4 v22, s[12:15], s19 offen sc1 lds
  v_mfma_f32_16x16x32_bf16 v[84:87], a[108:111], v[40:43], v[84:87]
  s_waitcnt lgkmcnt(5)
  v_mul_f32 v127, s24, v127
  v_cvt_pk_bf16_f32 v143, v126, v127
  v_mfma_f32_16x16x32_bf16 v[72:75], a[96:99], v[44:47], v[72:75]
  ds_read_b128 v[36:39], v11 offset:16384
  v_mfma_f32_16x16x32_bf16 v[76:79], a[100:103], v[44:47], v[76:79]
  v_mfma_f32_16x16x32_bf16 v[88:91], a[104:107], v[44:47], v[88:91]
  v_mfma_f32_16x16x32_bf16 v[92:95], a[108:111], v[44:47], v[92:95]
  s_waitcnt lgkmcnt(5)
  v_mfma_f32_16x16x32_bf16 v[64:67], a[112:115], v[48:51], v[64:67]
  s_add_u32 m0, s25, 7168
  ds_read_b128 v[40:43], v12 offset:16384
  v_mfma_f32_16x16x32_bf16 v[68:71], a[116:119], v[48:51], v[68:71]
  v_mfma_f32_16x16x32_bf16 v[80:83], a[120:123], v[48:51], v[80:83]
  buffer_load_dwordx4 v23, s[12:15], s19 offen sc1 lds
  v_mfma_f32_16x16x32_bf16 v[84:87], a[124:127], v[48:51], v[84:87]
  s_waitcnt lgkmcnt(5)
  v_mfma_f32_16x16x32_bf16 v[72:75], a[112:115], v[52:55], v[72:75]
  s_cmp_gt_u32 s23, 3
  ds_read_b128 v[44:47], v13 offset:16384
  v_mfma_f32_16x16x32_bf16 v[76:79], a[116:119], v[52:55], v[76:79]
  v_mfma_f32_16x16x32_bf16 v[88:91], a[120:123], v[52:55], v[88:91]
  s_cselect_b32 s26, s20, 0
  v_mfma_f32_16x16x32_bf16 v[92:95], a[124:127], v[52:55], v[92:95]
  s_waitcnt lgkmcnt(5)
  v_mfma_f32_16x16x32_bf16 v[64:67], a[128:131], v[24:27], v[64:67]
  s_add_u32 s19, s19, s26
  ds_read_b128 v[48:51], v14 offset:16384
  v_mfma_f32_16x16x32_bf16 v[68:71], a[132:135], v[24:27], v[68:71]
  v_mfma_f32_16x16x32_bf16 v[80:83], a[136:139], v[24:27], v[80:83]
  s_add_u32 s25, s25, 32768
  v_mfma_f32_16x16x32_bf16 v[84:87], a[140:143], v[24:27], v[84:87]
  s_waitcnt lgkmcnt(5)
  v_mfma_f32_16x16x32_bf16 v[72:75], a[128:131], v[28:31], v[72:75]
  s_and_b32 s25, s25, 0x1ffff
  ds_read_b128 v[52:55], v15 offset:16384
  v_mfma_f32_16x16x32_bf16 v[76:79], a[132:135], v[28:31], v[76:79]
  v_mfma_f32_16x16x32_bf16 v[88:91], a[136:139], v[28:31], v[88:91]
  buffer_store_dwordx4 v[128:131], v7, s[4:7], s21 offen offset:0 sc1
  v_mfma_f32_16x16x32_bf16 v[92:95], a[140:143], v[28:31], v[92:95]
  s_waitcnt lgkmcnt(5)
  v_mfma_f32_16x16x32_bf16 v[64:67], a[144:147], v[32:35], v[64:67]
  ds_read_b128 v[24:27], v8 offset:24576
  v_mfma_f32_16x16x32_bf16 v[68:71], a[148:151], v[32:35], v[68:71]
  v_mfma_f32_16x16x32_bf16 v[80:83], a[152:155], v[32:35], v[80:83]
  v_mfma_f32_16x16x32_bf16 v[84:87], a[156:159], v[32:35], v[84:87]
  s_waitcnt lgkmcnt(5)
  v_mfma_f32_16x16x32_bf16 v[72:75], a[144:147], v[36:39], v[72:75]
  ds_read_b128 v[28:31], v9 offset:24576
  v_mfma_f32_16x16x32_bf16 v[76:79], a[148:151], v[36:39], v[76:79]
  v_mfma_f32_16x16x32_bf16 v[88:91], a[152:155], v[36:39], v[88:91]
  buffer_store_dwordx4 v[132:135], v7, s[4:7], s21 offen offset:256 sc1
  v_mfma_f32_16x16x32_bf16 v[92:95], a[156:159], v[36:39], v[92:95]
  s_waitcnt lgkmcnt(5)
  v_mfma_f32_16x16x32_bf16 v[64:67], a[160:163], v[40:43], v[64:67]
  ds_read_b128 v[32:35], v10 offset:24576
  v_mfma_f32_16x16x32_bf16 v[68:71], a[164:167], v[40:43], v[68:71]
  v_mfma_f32_16x16x32_bf16 v[80:83], a[168:171], v[40:43], v[80:83]
  v_mfma_f32_16x16x32_bf16 v[84:87], a[172:175], v[40:43], v[84:87]
  s_waitcnt lgkmcnt(5)
  v_mfma_f32_16x16x32_bf16 v[72:75], a[160:163], v[44:47], v[72:75]
  ds_read_b128 v[36:39], v11 offset:24576
  v_mfma_f32_16x16x32_bf16 v[76:79], a[164:167], v[44:47], v[76:79]
  v_mfma_f32_16x16x32_bf16 v[88:91], a[168:171], v[44:47], v[88:91]
  buffer_store_dwordx4 v[136:139], v7, s[4:7], s21 offen offset:2048 sc1
  v_mfma_f32_16x16x32_bf16 v[92:95], a[172:175], v[44:47], v[92:95]
  s_waitcnt lgkmcnt(5)
  v_mfma_f32_16x16x32_bf16 v[64:67], a[176:179], v[48:51], v[64:67]
  ds_read_b128 v[40:43], v12 offset:24576
  v_mfma_f32_16x16x32_bf16 v[68:71], a[180:183], v[48:51], v[68:71]
  v_mfma_f32_16x16x32_bf16 v[80:83], a[184:187], v[48:51], v[80:83]
  v_mfma_f32_16x16x32_bf16 v[84:87], a[188:191], v[48:51], v[84:87]
  s_waitcnt lgkmcnt(5)
  v_mfma_f32_16x16x32_bf16 v[72:75], a[176:179], v[52:55], v[72:75]
  ds_read_b128 v[44:47], v13 offset:24576
  v_mfma_f32_16x16x32_bf16 v[76:79], a[180:183], v[52:55], v[76:79]
  v_mfma_f32_16x16x32_bf16 v[88:91], a[184:187], v[52:55], v[88:91]
  buffer_store_dwordx4 v[140:143], v7, s[4:7], s21 offen offset:2304 sc1
  v_mfma_f32_16x16x32_bf16 v[92:95], a[188:191], v[52:55], v[92:95]
  s_waitcnt lgkmcnt(5)
  v_mfma_f32_16x16x32_bf16 v[64:67], a[192:195], v[24:27], v[64:67]
  s_mov_b32 s21, s27
  ds_read_b128 v[48:51], v14 offset:24576
  v_mfma_f32_16x16x32_bf16 v[68:71], a[196:199], v[24:27], v[68:71]
  v_mov_b32 v7, v56
  v_mfma_f32_16x16x32_bf16 v[80:83], a[200:203], v[24:27], v[80:83]
  v_mfma_f32_16x16x32_bf16 v[84:87], a[204:207], v[24:27], v[84:87]
  s_waitcnt lgkmcnt(5)
  v_mfma_f32_16x16x32_bf16 v[72:75], a[192:195], v[28:31], v[72:75]
  s_add_u32 s27, s27, s22
  ds_read_b128 v[52:55], v15 offset:24576
  v_mfma_f32_16x16x32_bf16 v[76:79], a[196:199], v[28:31], v[76:79]
  v_mfma_f32_16x16x32_bf16 v[88:91], a[200:203], v[28:31], v[88:91]
  s_waitcnt vmcnt(16)
  s_barrier
  v_mfma_f32_16x16x32_bf16 v[92:95], a[204:207], v[28:31], v[92:95]
  s_waitcnt lgkmcnt(5)
  v_mfma_f32_16x16x32_bf16 v[64:67], a[208:211], v[32:35], v[64:67]
  ds_read_b128 v[24:27], v8 offset:32768
  v_mfma_f32_16x16x32_bf16 v[68:71], a[212:215], v[32:35], v[68:71]
  v_mfma_f32_16x16x32_bf16 v[80:83], a[216:219], v[32:35], v[80:83]
  v_mfma_f32_16x16x32_bf16 v[84:87], a[220:223], v[32:35], v[84:87]
  s_waitcnt lgkmcnt(5)
  v_mfma_f32_16x16x32_bf16 v[72:75], a[208:211], v[36:39], v[72:75]
  ds_read_b128 v[28:31], v9 offset:32768
  v_mfma_f32_16x16x32_bf16 v[76:79], a[212:215], v[36:39], v[76:79]
  v_mfma_f32_16x16x32_bf16 v[88:91], a[216:219], v[36:39], v[88:91]
  v_mfma_f32_16x16x32_bf16 v[92:95], a[220:223], v[36:39], v[92:95]
  s_waitcnt lgkmcnt(5)
  v_mfma_f32_16x16x32_bf16 v[64:67], a[224:227], v[40:43], v[64:67]
  ds_read_b128 v[32:35], v10 offset:32768
  v_mfma_f32_16x16x32_bf16 v[68:71], a[228:231], v[40:43], v[68:71]
  v_mfma_f32_16x16x32_bf16 v[80:83], a[232:235], v[40:43], v[80:83]
  v_mfma_f32_16x16x32_bf16 v[84:87], a[236:239], v[40:43], v[84:87]
  s_waitcnt lgkmcnt(5)
  v_mfma_f32_16x16x32_bf16 v[72:75], a[224:227], v[44:47], v[72:75]
  ds_read_b128 v[36:39], v11 offset:32768
  v_mfma_f32_16x16x32_bf16 v[76:79], a[228:231], v[44:47], v[76:79]
  v_mfma_f32_16x16x32_bf16 v[88:91], a[232:235], v[44:47], v[88:91]
  v_mfma_f32_16x16x32_bf16 v[92:95], a[236:239], v[44:47], v[92:95]
  s_waitcnt lgkmcnt(5)
  v_mfma_f32_16x16x32_bf16 v[64:67], a[240:243], v[48:51], v[64:67]
  s_sub_u32 s23, s23, 1
  ds_read_b128 v[40:43], v12 offset:32768
  v_mfma_f32_16x16x32_bf16 v[68:71], a[244:247], v[48:51], v[68:71]
  v_mfma_f32_16x16x32_bf16 v[80:83], a[248:251], v[48:51], v[80:83]
  v_mfma_f32_16x16x32_bf16 v[84:87], a[252:255], v[48:51], v[84:87]
  s_waitcnt lgkmcnt(5)
  v_mfma_f32_16x16x32_bf16 v[72:75], a[240:243], v[52:55], v[72:75]
  s_cmp_eq_u32 s23, 0
  ds_read_b128 v[44:47], v13 offset:32768
  v_mfma_f32_16x16x32_bf16 v[76:79], a[244:247], v[52:55], v[76:79]
  v_mfma_f32_16x16x32_bf16 v[88:91], a[248:251], v[52:55], v[88:91]
  v_mfma_f32_16x16x32_bf16 v[92:95], a[252:255], v[52:55], v[92:95]
  s_cbranch_scc1 G_done0_46
  s_waitcnt lgkmcnt(5)
  v_mfma_f32_16x16x32_bf16 v[96:99], a[0:3], v[24:27], 0
  s_add_u32 m0, s25, 0
  ds_read_b128 v[48:51], v14 offset:32768
  v_mfma_f32_16x16x32_bf16 v[100:103], a[4:7], v[24:27], 0
  v_mfma_f32_16x16x32_bf16 v[112:115], a[8:11], v[24:27], 0
  buffer_load_dwordx4 v16, s[12:15], s19 offen sc1 lds
  v_mfma_f32_16x16x32_bf16 v[116:119], a[12:15], v[24:27], 0
  s_waitcnt lgkmcnt(5)
  v_mfma_f32_16x16x32_bf16 v[104:107], a[0:3], v[28:31], 0
  ds_read_b128 v[52:55], v15 offset:32768
  v_mfma_f32_16x16x32_bf16 v[108:111], a[4:7], v[28:31], 0
  v_mul_f32 v64, s24, v64
  v_mul_f32 v65, s24, v65
  v_mfma_f32_16x16x32_bf16 v[120:123], a[8:11], v[28:31], 0
  v_mfma_f32_16x16x32_bf16 v[124:127], a[12:15], v[28:31], 0
  s_waitcnt lgkmcnt(5)
  v_cvt_pk_bf16_f32 v128, v64, v65
  v_mul_f32 v66, s24, v66
  v_mfma_f32_16x16x32_bf16 v[96:99], a[16:19], v[32:35], v[96:99]
  s_add_u32 m0, s25, 1024
  ds_read_b128 v[24:27], v8 offset:40960
  v_mfma_f32_16x16x32_bf16 v[100:103], a[20:23], v[32:35], v[100:103]
  v_mul_f32 v67, s24, v67
  v_cvt_pk_bf16_f32 v129, v66, v67
  v_mfma_f32_16x16x32_bf16 v[112:115], a[24:27], v[32:35], v[112:115]
  buffer_load_dwordx4 v17, s[12:15], s19 offen sc1 lds
  v_mfma_f32_16x16x32_bf16 v[116:119], a[28:31], v[32:35], v[116:119]
  s_waitcnt lgkmcnt(5)
  v_mul_f32 v68, s24, v68
  v_mul_f32 v69, s24, v69
  v_mfma_f32_16x16x32_bf16 v[104:107], a[16:19], v[36:39], v[104:107]
  ds_read_b128 v[28:31], v9 offset:40960
  v_mfma_f32_16x16x32_bf16 v[108:111], a[20:23], v[36:39], v[108:111]
  v_cvt_pk_bf16_f32 v130, v68, v69
  v_mul_f32 v70, s24, v70
  v_mfma_f32_16x16x32_bf16 v[120:123], a[24:27], v[36:39], v[120:123]
  v_mfma_f32_16x16x32_bf16 v[124:127], a[28:31], v[36:39], v[124:127]
  s_waitcnt lgkmcnt(5)
  v_mul_f32 v71, s24, v71
  v_cvt_pk_bf16_f32 v131, v70, v71
  v_mfma_f32_16x16x32_bf16 v[96:99], a[32:35], v[40:43], v[96:99]
  s_add_u32 m0, s25, 2048
  ds_read_b128 v[32:35], v10 offset:40960
  v_mfma_f32_16x16x32_bf16 v[100:103], a[36:39], v[40:43], v[100:103]
  v_mul_f32 v72, s24, v72
  v_mul_f32 v73, s24, v73
  v_mfma_f32_16x16x32_bf16 v[112:115], a[40:43], v[40:43], v[112:115]
  buffer_load_dwordx4 v18, s[12:15], s19 offen sc1 lds
  v_mfma_f32_16x16x32_bf16 v[116:119], a[44:47], v[40:43], v[116:119]
  s_waitcnt lgkmcnt(5)
  v_cvt_pk_bf16_f32 v132, v72, v73
  v_mul_f32 v74, s24, v74
  v_mfma_f32_16x16x32_bf16 v[104:107], a[32:35], v[44:47], v[104:107]
  ds_read_b128 v[36:39], v11 offset:40960
  v_mfma_f32_16x16x32_bf16 v[108:111], a[36:39], v[44:47], v[108:111]
  v_mul_f32 v75, s24, v75
  v_cvt_pk_bf16_f32 v133, v74, v75
  v_mfma_f32_16x16x32_bf16 v[120:123], a[40:43], v[44:47], v[120:123]
  v_mfma_f32_16x16x32_bf16 v[124:127], a[44:47], v[44:47], v[124:127]
  s_waitcnt lgkmcnt(5)
  v_mul_f32 v76, s24, v76
  v_mul_f32 v77, s24, v77
  v_mfma_f32_16x16x32_bf16 v[96:99], a[48:51], v[48:51], v[96:99]
  s_add_u32 m0, s25, 3072
  ds_read_b128 v[40:43], v12 offset:40960
  v_mfma_f32_16x16x32_bf16 v[100:103], a[52:55], v[48:51], v[100:103]
  v_cvt_pk_bf16_f32 v134, v76, v77
  v_mul_f32 v78, s24, v78
  v_mfma_f32_16x16x32_bf16 v[112:115], a[56:59], v[48:51], v[112:115]
  buffer_load_dwordx4 v19, s[12:15], s19 offen sc1 lds
  v_mfma_f32_16x16x32_bf16 v[116:119], a[60:63], v[48:51], v[116:119]
  s_waitcnt lgkmcnt(5)
  v_mul_f32 v79, s24, v79
  v_cvt_pk_bf16_f32 v135, v78, v79
  v_mfma_f32_16x16x32_bf16 v[104:107], a[48:51], v[52:55], v[104:107]
  ds_read_b128 v[44:47], v13 offset:40960
  v_mfma_f32_16x16x32_bf16 v[108:111], a[52:55], v[52:55], v[108:111]
  v_mul_f32 v80, s24, v80
  v_mul_f32 v81, s24, v81
  v_mfma_f32_16x16x32_bf16 v[120:123], a[56:59], v[52:55], v[120:123]
  v_mfma_f32_16x16x32_bf16 v[124:127], a[60:63], v[52:55], v[124:127]
  s_waitcnt lgkmcnt(5)
  v_cvt_pk_bf16_f32 v136, v80, v81
  v_mul_f32 v82, s24, v82
  v_mfma_f32_16x16x32_bf16 v[96:99], a[64:67], v[24:27], v[96:99]
  s_add_u32 m0, s25, 4096
  ds_read_b128 v[48:51], v14 offset:40960
  v_mfma_f32_16x16x32_bf16 v[100:103], a[68:71], v[24:27], v[100:103]
  v_mul_f32 v83, s24, v83
  v_cvt_pk_bf16_f32 v137, v82, v83
  v_mfma_f32_16x16x32_bf16 v[112:115], a[72:75], v[24:27], v[112:115]
  buffer_load_dwordx4 v20, s[12:15], s19 offen sc1 lds
  v_mfma_f32_16x16x32_bf16 v[116:119], a[76:79], v[24:27], v[116:119]
  s_waitcnt lgkmcnt(5)
  v_mul_f32 v84, s24, v84
  v_mul_f32 v85, s24, v85
  v_mfma_f32_16x16x32_bf16 v[104:107], a[64:67], v[28:31], v[104:107]
  ds_read_b128 v[52:55], v15 offset:40960
  v_mfma_f32_16x16x32_bf16 v[108:111], a[68:71], v[28:31], v[108:111]
  v_cvt_pk_bf16_f32 v138, v84, v85
  v_mul_f32 v86, s24, v86
  v_mfma_f32_16x16x32_bf16 v[120:123], a[72:75], v[28:31], v[120:123]
  v_mfma_f32_16x16x32_bf16 v[124:127], a[76:79], v[28:31], v[124:127]
  s_waitcnt lgkmcnt(5)
  v_mul_f32 v87, s24, v87
  v_cvt_pk_bf16_f32 v139, v86, v87
  v_mfma_f32_16x16x32_bf16 v[96:99], a[80:83], v[32:35], v[96:99]
  s_add_u32 m0, s25, 5120
  ds_read_b128 v[24:27], v8 offset:49152
  v_mfma_f32_16x16x32_bf16 v[100:103], a[84:87], v[32:35], v[100:103]
  v_mul_f32 v88, s24, v88
  v_mul_f32 v89, s24, v89
  v_mfma_f32_16x16x32_bf16 v[112:115], a[88:91], v[32:35], v[112:115]
  buffer_load_dwordx4 v21, s[12:15], s19 offen sc1 lds
  v_mfma_f32_16x16x32_bf16 v[116:119], a[92:95], v[32:35], v[116:119]
  s_waitcnt lgkmcnt(5)
  v_cvt_pk_bf16_f32 v140, v88, v89
  v_mul_f32 v90, s24, v90
  v_mfma_f32_16x16x32_bf16 v[104:107], a[80:83], v[36:39], v[104:107]
  ds_read_b128 v[28:31], v9 offset:49152
  v_mfma_f32_16x16x32_bf16 v[108:111], a[84:87], v[36:39], v[108:111]
  v_mul_f32 v91, s24, v91
  v_cvt_pk_bf16_f32 v141, v90, v91
  v_mfma_f32_16x16x32_bf16 v[120:123], a[88:91], v[36:39], v[120:123]
  v_mfma_f32_16x16x32_bf16 v[124:127], a[92:95], v[36:39], v[124:127]
  s_waitcnt lgkmcnt(5)
  v_mul_f32 v92, s24, v92
  v_mul_f32 v93, s24, v93
  v_mfma_f32_16x16x32_bf16 v[96:99], a[96:99], v[40:43], v[96:99]
  s_add_u32 m0, s25, 6144
  ds_read_b128 v[32:35], v10 offset:49152
  v_mfma_f32_16x16x32_bf16 v[100:103], a[100:103], v[40:43], v[100:103]
  v_cvt_pk_bf16_f32 v142, v92, v93
  v_mul_f32 v94, s24, v94
  v_mfma_f32_16x16x32_bf16 v[112:115], a[104:107], v[40:43], v[112:115]
  buffer_load_dwordx4 v22, s[12:15], s19 offen sc1 lds
  v_mfma_f32_16x16x32_bf16 v[116:119], a[108:111], v[40:43], v[116:119]
  s_waitcnt lgkmcnt(5)
  v_mul_f32 v95, s24, v95
  v_cvt_pk_bf16_f32 v143, v94, v95
  v_mfma_f32_16x16x32_bf16 v[104:107], a[96:99], v[44:47], v[104:107]
  ds_read_b128 v[36:39], v11 offset:49152
  v_mfma_f32_16x16x32_bf16 v[108:111], a[100:103], v[44:47], v[108:111]
  v_mfma_f32_16x16x32_bf16 v[120:123], a[104:107], v[44:47], v[120:123]
  v_mfma_f32_16x16x32_bf16 v[124:127], a[108:111], v[44:47], v[124:127]
  s_waitcnt lgkmcnt(5)
  v_mfma_f32_16x16x32_bf16 v[96:99], a[112:115], v[48:51], v[96:99]
  s_add_u32 m0, s25, 7168
  ds_read_b128 v[40:43], v12 offset:49152
  v_mfma_f32_16x16x32_bf16 v[100:103], a[116:119], v[48:51], v[100:103]
  v_mfma_f32_16x16x32_bf16 v[112:115], a[120:123], v[48:51], v[112:115]
  buffer_load_dwordx4 v23, s[12:15], s19 offen sc1 lds
  v_mfma_f32_16x16x32_bf16 v[116:119], a[124:127], v[48:51], v[116:119]
  s_waitcnt lgkmcnt(5)
  v_mfma_f32_16x16x32_bf16 v[104:107], a[112:115], v[52:55], v[104:107]
  s_cmp_gt_u32 s23, 3
  ds_read_b128 v[44:47], v13 offset:49152
  v_mfma_f32_16x16x32_bf16 v[108:111], a[116:119], v[52:55], v[108:111]
  v_mfma_f32_16x16x32_bf16 v[120:123], a[120:123], v[52:55], v[120:123]
  s_cselect_b32 s26, s20, 0
  v_mfma_f32_16x16x32_bf16 v[124:127], a[124:127], v[52:55], v[124:127]
  s_waitcnt lgkmcnt(5)
  v_mfma_f32_16x16x32_bf16 v[96:99], a[128:131], v[24:27], v[96:99]
  s_add_u32 s19, s19, s26
  ds_read_b128 v[48:51], v14 offset:49152
  v_mfma_f32_16x16x32_bf16 v[100:103], a[132:135], v[24:27], v[100:103]
  v_mfma_f32_16x16x32_bf16 v[112:115], a[136:139], v[24:27], v[112:115]
  s_add_u32 s25, s25, 32768
  v_mfma_f32_16x16x32_bf16 v[116:119], a[140:143], v[24:27], v[116:119]
  s_waitcnt lgkmcnt(5)
  v_mfma_f32_16x16x32_bf16 v[104:107], a[128:131], v[28:31], v[104:107]
  s_and_b32 s25, s25, 0x1ffff
  ds_read_b128 v[52:55], v15 offset:49152
  v_mfma_f32_16x16x32_bf16 v[108:111], a[132:135], v[28:31], v[108:111]
  v_mfma_f32_16x16x32_bf16 v[120:123], a[136:139], v[28:31], v[120:123]
  buffer_store_dwordx4 v[128:131], v7, s[4:7], s21 offen offset:0 sc1
  v_mfma_f32_16x16x32_bf16 v[124:127], a[140:143], v[28:31], v[124:127]
  s_waitcnt lgkmcnt(5)
  v_mfma_f32_16x16x32_bf16 v[96:99], a[144:147], v[32:35], v[96:99]
  ds_read_b128 v[24:27], v8 offset:57344
  v_mfma_f32_16x16x32_bf16 v[100:103], a[148:151], v[32:35], v[100:103]
  v_mfma_f32_16x16x32_bf16 v[112:115], a[152:155], v[32:35], v[112:115]
  v_mfma_f32_16x16x32_bf16 v[116:119], a[156:159], v[32:35], v[116:119]
  s_waitcnt lgkmcnt(5)
  v_xor_b32 v8, 0x10000, v8
  v_mfma_f32_16x16x32_bf16 v[104:107], a[144:147], v[36:39], v[104:107]
  ds_read_b128 v[28:31], v9 offset:57344
  v_mfma_f32_16x16x32_bf16 v[108:111], a[148:151], v[36:39], v[108:111]
  v_mfma_f32_16x16x32_bf16 v[120:123], a[152:155], v[36:39], v[120:123]
  buffer_store_dwordx4 v[132:135], v7, s[4:7], s21 offen offset:256 sc1
  v_mfma_f32_16x16x32_bf16 v[124:127], a[156:159], v[36:39], v[124:127]
  s_waitcnt lgkmcnt(5)
  v_xor_b32 v9, 0x10000, v9
  v_mfma_f32_16x16x32_bf16 v[96:99], a[160:163], v[40:43], v[96:99]
  ds_read_b128 v[32:35], v10 offset:57344
  v_mfma_f32_16x16x32_bf16 v[100:103], a[164:167], v[40:43], v[100:103]
  v_mfma_f32_16x16x32_bf16 v[112:115], a[168:171], v[40:43], v[112:115]
  v_mfma_f32_16x16x32_bf16 v[116:119], a[172:175], v[40:43], v[116:119]
  s_waitcnt lgkmcnt(5)
  v_xor_b32 v10, 0x10000, v10
  v_mfma_f32_16x16x32_bf16 v[104:107], a[160:163], v[44:47], v[104:107]
  ds_read_b128 v[36:39], v11 offset:57344
  v_mfma_f32_16x16x32_bf16 v[108:111], a[164:167], v[44:47], v[108:111]
  v_mfma_f32_16x16x32_bf16 v[120:123], a[168:171], v[44:47], v[120:123]
  buffer_store_dwordx4 v[136:139], v7, s[4:7], s21 offen offset:2048 sc1
  v_mfma_f32_16x16x32_bf16 v[124:127], a[172:175], v[44:47], v[124:127]
  s_waitcnt lgkmcnt(5)
  v_xor_b32 v11, 0x10000, v11
  v_mfma_f32_16x16x32_bf16 v[96:99], a[176:179], v[48:51], v[96:99]
  ds_read_b128 v[40:43], v12 offset:57344
  v_mfma_f32_16x16x32_bf16 v[100:103], a[180:183], v[48:51], v[100:103]
  v_mfma_f32_16x16x32_bf16 v[112:115], a[184:187], v[48:51], v[112:115]
  v_mfma_f32_16x16x32_bf16 v[116:119], a[188:191], v[48:51], v[116:119]
  s_waitcnt lgkmcnt(5)
  v_xor_b32 v12, 0x10000, v12
  v_mfma_f32_16x16x32_bf16 v[104:107], a[176:179], v[52:55], v[104:107]
  ds_read_b128 v[44:47], v13 offset:57344
  v_mfma_f32_16x16x32_bf16 v[108:111], a[180:183], v[52:55], v[108:111]
  v_mfma_f32_16x16x32_bf16 v[120:123], a[184:187], v[52:55], v[120:123]
  buffer_store_dwordx4 v[140:143], v7, s[4:7], s21 offen offset:2304 sc1
  v_mfma_f32_16x16x32_bf16 v[124:127], a[188:191], v[52:55], v[124:127]
  s_waitcnt lgkmcnt(5)
  v_xor_b32 v13, 0x10000, v13
  v_mfma_f32_16x16x32_bf16 v[96:99], a[192:195], v[24:27], v[96:99]
  s_mov_b32 s21, s27
  ds_read_b128 v[48:51], v14 offset:57344
  v_mfma_f32_16x16x32_bf16 v[100:103], a[196:199], v[24:27], v[100:103]
  v_mov_b32 v7, v56
  v_mfma_f32_16x16x32_bf16 v[112:115], a[200:203], v[24:27], v[112:115]
  v_mfma_f32_16x16x32_bf16 v[116:119], a[204:207], v[24:27], v[116:119]
  s_waitcnt lgkmcnt(5)
  v_xor_b32 v14, 0x10000, v14
  v_mfma_f32_16x16x32_bf16 v[104:107], a[192:195], v[28:31], v[104:107]
  s_add_u32 s27, s27, s22
  ds_read_b128 v[52:55], v15 offset:57344
  v_mfma_f32_16x16x32_bf16 v[108:111], a[196:199], v[28:31], v[108:111]
  v_mfma_f32_16x16x32_bf16 v[120:123], a[200:203], v[28:31], v[120:123]
  s_waitcnt vmcnt(16)
  s_barrier
  v_mfma_f32_16x16x32_bf16 v[124:127], a[204:207], v[28:31], v[124:127]
  s_waitcnt lgkmcnt(5)
  v_xor_b32 v15, 0x10000, v15
  v_mfma_f32_16x16x32_bf16 v[96:99], a[208:211], v[32:35], v[96:99]
  ds_read_b128 v[24:27], v8 offset:0
  v_mfma_f32_16x16x32_bf16 v[100:103], a[212:215], v[32:35], v[100:103]
  v_mfma_f32_16x16x32_bf16 v[112:115], a[216:219], v[32:35], v[112:115]
  v_mfma_f32_16x16x32_bf16 v[116:119], a[220:223], v[32:35], v[116:119]
  s_waitcnt lgkmcnt(5)
  v_mfma_f32_16x16x32_bf16 v[104:107], a[208:211], v[36:39], v[104:107]
  ds_read_b128 v[28:31], v9 offset:0
  v_mfma_f32_16x16x32_bf16 v[108:111], a[212:215], v[36:39], v[108:111]
  v_mfma_f32_16x16x32_bf16 v[120:123], a[216:219], v[36:39], v[120:123]
  v_mfma_f32_16x16x32_bf16 v[124:127], a[220:223], v[36:39], v[124:127]
  s_waitcnt lgkmcnt(5)
  v_mfma_f32_16x16x32_bf16 v[96:99], a[224:227], v[40:43], v[96:99]
  ds_read_b128 v[32:35], v10 offset:0
  v_mfma_f32_16x16x32_bf16 v[100:103], a[228:231], v[40:43], v[100:103]
  v_mfma_f32_16x16x32_bf16 v[112:115], a[232:235], v[40:43], v[112:115]
  v_mfma_f32_16x16x32_bf16 v[116:119], a[236:239], v[40:43], v[116:119]
  s_waitcnt lgkmcnt(5)
  v_mfma_f32_16x16x32_bf16 v[104:107], a[224:227], v[44:47], v[104:107]
  ds_read_b128 v[36:39], v11 offset:0
  v_mfma_f32_16x16x32_bf16 v[108:111], a[228:231], v[44:47], v[108:111]
  v_mfma_f32_16x16x32_bf16 v[120:123], a[232:235], v[44:47], v[120:123]
  v_mfma_f32_16x16x32_bf16 v[124:127], a[236:239], v[44:47], v[124:127]
  s_waitcnt lgkmcnt(5)
  v_mfma_f32_16x16x32_bf16 v[96:99], a[240:243], v[48:51], v[96:99]
  s_sub_u32 s23, s23, 1
  ds_read_b128 v[40:43], v12 offset:0
  v_mfma_f32_16x16x32_bf16 v[100:103], a[244:247], v[48:51], v[100:103]
  v_mfma_f32_16x16x32_bf16 v[112:115], a[248:251], v[48:51], v[112:115]
  v_mfma_f32_16x16x32_bf16 v[116:119], a[252:255], v[48:51], v[116:119]
  s_waitcnt lgkmcnt(5)
  v_mfma_f32_16x16x32_bf16 v[104:107], a[240:243], v[52:55], v[104:107]
  s_cmp_eq_u32 s23, 0
  ds_read_b128 v[44:47], v13 offset:0
  v_mfma_f32_16x16x32_bf16 v[108:111], a[244:247], v[52:55], v[108:111]
  v_mfma_f32_16x16x32_bf16 v[120:123], a[248:251], v[52:55], v[120:123]
  v_mfma_f32_16x16x32_bf16 v[124:127], a[252:255], v[52:55], v[124:127]
  s_cbranch_scc1 G_done1_47
  s_branch G_top_45
G_done0_46:
  s_nop 7
  s_nop 3
  v_mul_f32 v64, s24, v64
  v_mul_f32 v65, s24, v65
  v_cvt_pk_bf16_f32 v128, v64, v65
  v_mul_f32 v66, s24, v66
  v_mul_f32 v67, s24, v67
  v_cvt_pk_bf16_f32 v129, v66, v67
  v_mul_f32 v68, s24, v68
  v_mul_f32 v69, s24, v69
  v_cvt_pk_bf16_f32 v130, v68, v69
  v_mul_f32 v70, s24, v70
  v_mul_f32 v71, s24, v71
  v_cvt_pk_bf16_f32 v131, v70, v71
  buffer_store_dwordx4 v[128:131], v7, s[4:7], s21 offen offset:0 sc1
  v_mul_f32 v72, s24, v72
  v_mul_f32 v73, s24, v73
  v_cvt_pk_bf16_f32 v132, v72, v73
  v_mul_f32 v74, s24, v74
  v_mul_f32 v75, s24, v75
  v_cvt_pk_bf16_f32 v133, v74, v75
  v_mul_f32 v76, s24, v76
  v_mul_f32 v77, s24, v77
  v_cvt_pk_bf16_f32 v134, v76, v77
  v_mul_f32 v78, s24, v78
  v_mul_f32 v79, s24, v79
  v_cvt_pk_bf16_f32 v135, v78, v79
  buffer_store_dwordx4 v[132:135], v7, s[4:7], s21 offen offset:256 sc1
  v_mul_f32 v80, s24, v80
  v_mul_f32 v81, s24, v81
  v_cvt_pk_bf16_f32 v136, v80, v81
  v_mul_f32 v82, s24, v82
  v_mul_f32 v83, s24, v83
  v_cvt_pk_bf16_f32 v137, v82, v83
  v_mul_f32 v84, s24, v84
  v_mul_f32 v85, s24, v85
  v_cvt_pk_bf16_f32 v138, v84, v85
  v_mul_f32 v86, s24, v86
  v_mul_f32 v87, s24, v87
  v_cvt_pk_bf16_f32 v139, v86, v87
  buffer_store_dwordx4 v[136:139], v7, s[4:7], s21 offen offset:2048 sc1
  v_mul_f32 v88, s24, v88
  v_mul_f32 v89, s24, v89
  v_cvt_pk_bf16_f32 v140, v88, v89
  v_mul_f32 v90, s24, v90
  v_mul_f32 v91, s24, v91
  v_cvt_pk_bf16_f32 v141, v90, v91
  v_mul_f32 v92, s24, v92
  v_mul_f32 v93, s24, v93
  v_cvt_pk_bf16_f32 v142, v92, v93
  v_mul_f32 v94, s24, v94
  v_mul_f32 v95, s24, v95
  v_cvt_pk_bf16_f32 v143, v94, v95
  buffer_store_dwordx4 v[140:143], v7, s[4:7], s21 offen offset:2304 sc1
  s_branch G_fin_48
G_done1_47:
  s_nop 7
  s_nop 3
  v_mul_f32 v96, s24, v96
  v_mul_f32 v97, s24, v97
  v_cvt_pk_bf16_f32 v128, v96, v97
  v_mul_f32 v98, s24, v98
  v_mul_f32 v99, s24, v99
  v_cvt_pk_bf16_f32 v129, v98, v99
  v_mul_f32 v100, s24, v100
  v_mul_f32 v101, s24, v101
  v_cvt_pk_bf16_f32 v130, v100, v101
  v_mul_f32 v102, s24, v102
  v_mul_f32 v103, s24, v103
  v_cvt_pk_bf16_f32 v131, v102, v103
  buffer_store_dwordx4 v[128:131], v7, s[4:7], s21 offen offset:0 sc1
  v_mul_f32 v104, s24, v104
  v_mul_f32 v105, s24, v105
  v_cvt_pk_bf16_f32 v132, v104, v105
  v_mul_f32 v106, s24, v106
  v_mul_f32 v107, s24, v107
  v_cvt_pk_bf16_f32 v133, v106, v107
  v_mul_f32 v108, s24, v108
  v_mul_f32 v109, s24, v109
  v_cvt_pk_bf16_f32 v134, v108, v109
  v_mul_f32 v110, s24, v110
  v_mul_f32 v111, s24, v111
  v_cvt_pk_bf16_f32 v135, v110, v111
  buffer_store_dwordx4 v[132:135], v7, s[4:7], s21 offen offset:256 sc1
  v_mul_f32 v112, s24, v112
  v_mul_f32 v113, s24, v113
  v_cvt_pk_bf16_f32 v136, v112, v113
  v_mul_f32 v114, s24, v114
  v_mul_f32 v115, s24, v115
  v_cvt_pk_bf16_f32 v137, v114, v115
  v_mul_f32 v116, s24, v116
  v_mul_f32 v117, s24, v117
  v_cvt_pk_bf16_f32 v138, v116, v117
  v_mul_f32 v118, s24, v118
  v_mul_f32 v119, s24, v119
  v_cvt_pk_bf16_f32 v139, v118, v119
  buffer_store_dwordx4 v[136:139], v7, s[4:7], s21 offen offset:2048 sc1
  v_mul_f32 v120, s24, v120
  v_mul_f32 v121, s24, v121
  v_cvt_pk_bf16_f32 v140, v120, v121
  v_mul_f32 v122, s24, v122
  v_mul_f32 v123, s24, v123
  v_cvt_pk_bf16_f32 v141, v122, v123
  v_mul_f32 v124, s24, v124
  v_mul_f32 v125, s24, v125
  v_cvt_pk_bf16_f32 v142, v124, v125
  v_mul_f32 v126, s24, v126
  v_mul_f32 v127, s24, v127
  v_cvt_pk_bf16_f32 v143, v126, v127
  buffer_store_dwordx4 v[140:143], v7, s[4:7], s21 offen offset:2304 sc1
G_fin_48:
  s_waitcnt vmcnt(0) lgkmcnt(0)
  s_barrier
  s_waitcnt vmcnt(0)
  s_barrier
  s_mov_b32 s30, 768
  v_mov_b32 v144, s30
  v_min_u32 v145, 1, v0
  v_lshlrev_b32 v145, 30, v145
  buffer_store_dword v144, v145, s[4:7], s31 offen sc1
  s_mul_i32 s50, s64, 6
  s_add_u32 s50, s50, s65
  s_mul_i32 s76, s50, 21846
  s_lshr_b32 s76, s76, 16
  s_mul_i32 s77, s76, 3
  s_add_u32 s51, s50, 64
  s_cmp_eq_u32 s77, s50
  s_cselect_b32 s50, s76, s51
M_fin:
  s_lshr_b32 s48, s50, 2
  s_and_b32 s49, s50, 3
  s_load_dwordx2 s[8:9], s[0:1], 0
  s_load_dwordx2 s[12:13], s[0:1], 104
  s_load_dwordx2 s[32:33], s[0:1], 112
  v_and_b32 v4, 31, v1
  v_lshrrev_b32 v5, 5, v1
  v_lshlrev_b32 v5, 4, v5
  v_lshl_add_u32 v6, v4, 10, v5
  s_lshl_b32 s26, s16, 8
  s_lshl_b32 s27, s48, 15
  s_add_u32 s27, s27, s26
  s_waitcnt lgkmcnt(0)
  s_and_b32 s9, s9, 0xffff
  s_mov_b32 s10, 2097152
  s_mov_b32 s11, 0x20000
  s_and_b32 s13, s13, 0xffff
  s_mov_b32 s14, 1024
  s_mov_b32 s15, 0x20000
  s_and_b32 s33, s33, 0xffff
  s_mov_b32 s34, 2097152
  s_mov_b32 s35, 0x20000
  buffer_load_dwordx4 v[16:19], v6, s[8:11], s27 offen offset:0
  buffer_load_dwordx4 v[48:51], v5, s[12:15], s26 offen offset:0
  buffer_load_dwordx4 v[20:23], v6, s[8:11], s27 offen offset:32
  buffer_load_dwordx4 v[52:55], v5, s[12:15], s26 offen offset:32
  buffer_load_dwordx4 v[24:27], v6, s[8:11], s27 offen offset:64
  buffer_load_dwordx4 v[56:59], v5, s[12:15], s26 offen offset:64
  buffer_load_dwordx4 v[28:31], v6, s[8:11], s27 offen offset:96
  buffer_load_dwordx4 v[60:63], v5, s[12:15], s26 offen offset:96
  buffer_load_dwordx4 v[32:35], v6, s[8:11], s27 offen offset:128
  buffer_load_dwordx4 v[64:67], v5, s[12:15], s26 offen offset:128
  buffer_load_dwordx4 v[36:39], v6, s[8:11], s27 offen offset:160
  buffer_load_dwordx4 v[68:71], v5, s[12:15], s26 offen offset:160
  buffer_load_dwordx4 v[40:43], v6, s[8:11], s27 offen offset:192
  buffer_load_dwordx4 v[72:75], v5, s[12:15], s26 offen offset:192
  buffer_load_dwordx4 v[44:47], v6, s[8:11], s27 offen offset:224
  buffer_load_dwordx4 v[76:79], v5, s[12:15], s26 offen offset:224
  s_lshl_b32 s28, s48, 2
  s_add_u32 s28, s28, s49
  s_lshl_b32 s28, s28, 2
  s_add_u32 s28, s28, s16
  s_lshl_b32 s28, s28, 11
  s_waitcnt vmcnt(14)
  v_mfma_f32_32x32x16_bf16 v[80:95], v[48:51], v[16:19], 0
  s_waitcnt vmcnt(12)
  v_mfma_f32_32x32x16_bf16 v[80:95], v[52:55], v[20:23], v[80:95]
  s_waitcnt vmcnt(10)
  v_mfma_f32_32x32x16_bf16 v[80:95], v[56:59], v[24:27], v[80:95]
  s_waitcnt vmcnt(8)
  v_mfma_f32_32x32x16_bf16 v[80:95], v[60:63], v[28:31], v[80:95]
  s_waitcnt vmcnt(6)
  v_mfma_f32_32x32x16_bf16 v[80:95], v[64:67], v[32:35], v[80:95]
  s_waitcnt vmcnt(4)
  v_mfma_f32_32x32x16_bf16 v[80:95], v[68:71], v[36:39], v[80:95]
  s_waitcnt vmcnt(2)
  v_mfma_f32_32x32x16_bf16 v[80:95], v[72:75], v[40:43], v[80:95]
  s_waitcnt vmcnt(0)
  v_mfma_f32_32x32x16_bf16 v[80:95], v[76:79], v[44:47], v[80:95]
  s_mul_i32 s76, s48, 43
  s_lshr_b32 s76, s76, 9
  s_mul_i32 s76, s76, 12
  s_sub_u32 s76, s48, s76
  s_cmp_ge_u32 s76, 6
  s_addc_u32 s76, s76, 0
  s_and_b32 s77, s49, 2
  s_mul_i32 s77, s77, 7
  s_add_u32 s76, s76, s77
  v_mov_b32 v193, 0x300
  s_lshl_b32 s76, s76, 7
  s_add_u32 s76, s76, 148897792
  v_and_b32 v192, 7, v1
  v_mul_u32_u24 v192, 3584, v192
  v_add_u32 v192, s76, v192
  s_mov_b32 s71, 0
  s_branch M_vg_50
M_vw_49:
  s_sleep 2
  s_add_u32 s71, s71, 1
  s_cmp_gt_u32 s71, 262144
  s_cbranch_scc1 M_exit
M_vg_50:
  buffer_load_dword v194, v192, s[4:7], 0 offen sc1
  s_waitcnt vmcnt(0)
  v_cmp_lt_u32 vcc, v194, v193
  s_cbranch_vccnz M_vw_49
  s_add_u32 s29, s28, 150994944
  buffer_load_dwordx4 v[96:99], v2, s[4:7], s29 offen offset:0 sc1
  buffer_load_dwordx4 v[100:103], v2, s[4:7], s29 offen offset:1024 sc1
  s_add_u32 s29, s28, 153092096
  buffer_load_dwordx4 v[104:107], v2, s[4:7], s29 offen offset:0 sc1
  buffer_load_dwordx4 v[108:111], v2, s[4:7], s29 offen offset:1024 sc1
  s_add_u32 s29, s28, 155189248
  buffer_load_dwordx4 v[112:115], v2, s[4:7], s29 offen offset:0 sc1
  buffer_load_dwordx4 v[116:119], v2, s[4:7], s29 offen offset:1024 sc1
  s_add_u32 s29, s28, 157286400
  buffer_load_dwordx4 v[120:123], v2, s[4:7], s29 offen offset:0 sc1
  buffer_load_dwordx4 v[124:127], v2, s[4:7], s29 offen offset:1024 sc1
  s_add_u32 s29, s28, 159383552
  buffer_load_dwordx4 v[128:131], v2, s[4:7], s29 offen offset:0 sc1
  buffer_load_dwordx4 v[132:135], v2, s[4:7], s29 offen offset:1024 sc1
  s_add_u32 s29, s28, 161480704
  buffer_load_dwordx4 v[136:139], v2, s[4:7], s29 offen offset:0 sc1
  buffer_load_dwordx4 v[140:143], v2, s[4:7], s29 offen offset:1024 sc1
  s_add_u32 s29, s28, 163577856
  buffer_load_dwordx4 v[144:147], v2, s[4:7], s29 offen offset:0 sc1
  buffer_load_dwordx4 v[148:151], v2, s[4:7], s29 offen offset:1024 sc1
  s_add_u32 s29, s28, 165675008
  buffer_load_dwordx4 v[152:155], v2, s[4:7], s29 offen offset:0 sc1
  buffer_load_dwordx4 v[156:159], v2, s[4:7], s29 offen offset:1024 sc1
  v_lshlrev_b32 v7, 4, v4
  s_lshl_b32 s26, s16, 2
  v_add_u32 v4, s26, v7
  s_barrier
  ds_write_b32 v4, v80
  s_waitcnt lgkmcnt(0)
  s_barrier
  ds_read_b128 v[84:87], v7
  s_waitcnt lgkmcnt(0)
  v_add_f32 v80, v84, v85
  v_add_f32 v81, v86, v87
  v_add_f32 v80, v80, v81
  v_mul_f32 v80, 0xbfb8aa3b, v80
  v_exp_f32 v80, v80
  s_nop 0
  v_add_f32 v80, 1.0, v80
  v_rcp_f32 v80, v80
  s_nop 0
  v_sub_f32 v82, 1.0, v80
  s_waitcnt vmcnt(14)
  v_lshlrev_b32 v160, 16, v96
  v_and_b32 v161, 0xffff0000, v96
  v_lshlrev_b32 v162, 16, v97
  v_and_b32 v163, 0xffff0000, v97
  v_lshlrev_b32 v164, 16, v98
  v_and_b32 v165, 0xffff0000, v98
  v_lshlrev_b32 v166, 16, v99
  v_and_b32 v167, 0xffff0000, v99
  v_lshlrev_b32 v168, 16, v100
  v_and_b32 v169, 0xffff0000, v100
  v_lshlrev_b32 v170, 16, v101
  v_and_b32 v171, 0xffff0000, v101
  v_lshlrev_b32 v172, 16, v102
  v_and_b32 v173, 0xffff0000, v102
  v_lshlrev_b32 v174, 16, v103
  v_and_b32 v175, 0xffff0000, v103
  s_waitcnt vmcnt(12)
  v_lshlrev_b32 v8, 16, v104
  v_and_b32 v9, 0xffff0000, v104
  v_pk_add_f32 v[160:161], v[160:161], v[8:9]
  v_lshlrev_b32 v10, 16, v105
  v_and_b32 v11, 0xffff0000, v105
  v_pk_add_f32 v[162:163], v[162:163], v[10:11]
  v_lshlrev_b32 v12, 16, v106
  v_and_b32 v13, 0xffff0000, v106
  v_pk_add_f32 v[164:165], v[164:165], v[12:13]
  v_lshlrev_b32 v14, 16, v107
  v_and_b32 v15, 0xffff0000, v107
  v_pk_add_f32 v[166:167], v[166:167], v[14:15]
  v_lshlrev_b32 v8, 16, v108
  v_and_b32 v9, 0xffff0000, v108
  v_pk_add_f32 v[168:169], v[168:169], v[8:9]
  v_lshlrev_b32 v10, 16, v109
  v_and_b32 v11, 0xffff0000, v109
  v_pk_add_f32 v[170:171], v[170:171], v[10:11]
  v_lshlrev_b32 v12, 16, v110
  v_and_b32 v13, 0xffff0000, v110
  v_pk_add_f32 v[172:173], v[172:173], v[12:13]
  v_lshlrev_b32 v14, 16, v111
  v_and_b32 v15, 0xffff0000, v111
  v_pk_add_f32 v[174:175], v[174:175], v[14:15]
  s_waitcnt vmcnt(10)
  v_lshlrev_b32 v8, 16, v112
  v_and_b32 v9, 0xffff0000, v112
  v_pk_add_f32 v[160:161], v[160:161], v[8:9]
  v_lshlrev_b32 v10, 16, v113
  v_and_b32 v11, 0xffff0000, v113
  v_pk_add_f32 v[162:163], v[162:163], v[10:11]
  v_lshlrev_b32 v12, 16, v114
  v_and_b32 v13, 0xffff0000, v114
  v_pk_add_f32 v[164:165], v[164:165], v[12:13]
  v_lshlrev_b32 v14, 16, v115
  v_and_b32 v15, 0xffff0000, v115
  v_pk_add_f32 v[166:167], v[166:167], v[14:15]
  v_lshlrev_b32 v8, 16, v116
  v_and_b32 v9, 0xffff0000, v116
  v_pk_add_f32 v[168:169], v[168:169], v[8:9]
  v_lshlrev_b32 v10, 16, v117
  v_and_b32 v11, 0xffff0000, v117
  v_pk_add_f32 v[170:171], v[170:171], v[10:11]
  v_lshlrev_b32 v12, 16, v118
  v_and_b32 v13, 0xffff0000, v118
  v_pk_add_f32 v[172:173], v[172:173], v[12:13]
  v_lshlrev_b32 v14, 16, v119
  v_and_b32 v15, 0xffff0000, v119
  v_pk_add_f32 v[174:175], v[174:175], v[14:15]
  s_waitcnt vmcnt(8)
  v_lshlrev_b32 v8, 16, v120
  v_and_b32 v9, 0xffff0000, v120
  v_pk_add_f32 v[160:161], v[160:161], v[8:9]
  v_lshlrev_b32 v10, 16, v121
  v_and_b32 v11, 0xffff0000, v121
  v_pk_add_f32 v[162:163], v[162:163], v[10:11]
  v_lshlrev_b32 v12, 16, v122
  v_and_b32 v13, 0xffff0000, v122
  v_pk_add_f32 v[164:165], v[164:165], v[12:13]
  v_lshlrev_b32 v14, 16, v123
  v_and_b32 v15, 0xffff0000, v123
  v_pk_add_f32 v[166:167], v[166:167], v[14:15]
  v_lshlrev_b32 v8, 16, v124
  v_and_b32 v9, 0xffff0000, v124
  v_pk_add_f32 v[168:169], v[168:169], v[8:9]
  v_lshlrev_b32 v10, 16, v125
  v_and_b32 v11, 0xffff0000, v125
  v_pk_add_f32 v[170:171], v[170:171], v[10:11]
  v_lshlrev_b32 v12, 16, v126
  v_and_b32 v13, 0xffff0000, v126
  v_pk_add_f32 v[172:173], v[172:173], v[12:13]
  v_lshlrev_b32 v14, 16, v127
  v_and_b32 v15, 0xffff0000, v127
  v_pk_add_f32 v[174:175], v[174:175], v[14:15]
  s_waitcnt vmcnt(6)
  v_lshlrev_b32 v8, 16, v128
  v_and_b32 v9, 0xffff0000, v128
  v_pk_add_f32 v[160:161], v[160:161], v[8:9]
  v_lshlrev_b32 v10, 16, v129
  v_and_b32 v11, 0xffff0000, v129
  v_pk_add_f32 v[162:163], v[162:163], v[10:11]
  v_lshlrev_b32 v12, 16, v130
  v_and_b32 v13, 0xffff0000, v130
  v_pk_add_f32 v[164:165], v[164:165], v[12:13]
  v_lshlrev_b32 v14, 16, v131
  v_and_b32 v15, 0xffff0000, v131
  v_pk_add_f32 v[166:167], v[166:167], v[14:15]
  v_lshlrev_b32 v8, 16, v132
  v_and_b32 v9, 0xffff0000, v132
  v_pk_add_f32 v[168:169], v[168:169], v[8:9]
  v_lshlrev_b32 v10, 16, v133
  v_and_b32 v11, 0xffff0000, v133
  v_pk_add_f32 v[170:171], v[170:171], v[10:11]
  v_lshlrev_b32 v12, 16, v134
  v_and_b32 v13, 0xffff0000, v134
  v_pk_add_f32 v[172:173], v[172:173], v[12:13]
  v_lshlrev_b32 v14, 16, v135
  v_and_b32 v15, 0xffff0000, v135
  v_pk_add_f32 v[174:175], v[174:175], v[14:15]
  s_waitcnt vmcnt(4)
  v_lshlrev_b32 v8, 16, v136
  v_and_b32 v9, 0xffff0000, v136
  v_pk_add_f32 v[160:161], v[160:161], v[8:9]
  v_lshlrev_b32 v10, 16, v137
  v_and_b32 v11, 0xffff0000, v137
  v_pk_add_f32 v[162:163], v[162:163], v[10:11]
  v_lshlrev_b32 v12, 16, v138
  v_and_b32 v13, 0xffff0000, v138
  v_pk_add_f32 v[164:165], v[164:165], v[12:13]
  v_lshlrev_b32 v14, 16, v139
  v_and_b32 v15, 0xffff0000, v139
  v_pk_add_f32 v[166:167], v[166:167], v[14:15]
  v_lshlrev_b32 v8, 16, v140
  v_and_b32 v9, 0xffff0000, v140
  v_pk_add_f32 v[168:169], v[168:169], v[8:9]
  v_lshlrev_b32 v10, 16, v141
  v_and_b32 v11, 0xffff0000, v141
  v_pk_add_f32 v[170:171], v[170:171], v[10:11]
  v_lshlrev_b32 v12, 16, v142
  v_and_b32 v13, 0xffff0000, v142
  v_pk_add_f32 v[172:173], v[172:173], v[12:13]
  v_lshlrev_b32 v14, 16, v143
  v_and_b32 v15, 0xffff0000, v143
  v_pk_add_f32 v[174:175], v[174:175], v[14:15]
  s_waitcnt vmcnt(2)
  v_lshlrev_b32 v8, 16, v144
  v_and_b32 v9, 0xffff0000, v144
  v_pk_add_f32 v[160:161], v[160:161], v[8:9]
  v_lshlrev_b32 v10, 16, v145
  v_and_b32 v11, 0xffff0000, v145
  v_pk_add_f32 v[162:163], v[162:163], v[10:11]
  v_lshlrev_b32 v12, 16, v146
  v_and_b32 v13, 0xffff0000, v146
  v_pk_add_f32 v[164:165], v[164:165], v[12:13]
  v_lshlrev_b32 v14, 16, v147
  v_and_b32 v15, 0xffff0000, v147
  v_pk_add_f32 v[166:167], v[166:167], v[14:15]
  v_lshlrev_b32 v8, 16, v148
  v_and_b32 v9, 0xffff0000, v148
  v_pk_add_f32 v[168:169], v[168:169], v[8:9]
  v_lshlrev_b32 v10, 16, v149
  v_and_b32 v11, 0xffff0000, v149
  v_pk_add_f32 v[170:171], v[170:171], v[10:11]
  v_lshlrev_b32 v12, 16, v150
  v_and_b32 v13, 0xffff0000, v150
  v_pk_add_f32 v[172:173], v[172:173], v[12:13]
  v_lshlrev_b32 v14, 16, v151
  v_and_b32 v15, 0xffff0000, v151
  v_pk_add_f32 v[174:175], v[174:175], v[14:15]
  s_waitcnt vmcnt(0)
  v_lshlrev_b32 v8, 16, v152
  v_and_b32 v9, 0xffff0000, v152
  v_pk_add_f32 v[160:161], v[160:161], v[8:9]
  v_lshlrev_b32 v10, 16, v153
  v_and_b32 v11, 0xffff0000, v153
  v_pk_add_f32 v[162:163], v[162:163], v[10:11]
  v_lshlrev_b32 v12, 16, v154
  v_and_b32 v13, 0xffff0000, v154
  v_pk_add_f32 v[164:165], v[164:165], v[12:13]
  v_lshlrev_b32 v14, 16, v155
  v_and_b32 v15, 0xffff0000, v155
  v_pk_add_f32 v[166:167], v[166:167], v[14:15]
  v_lshlrev_b32 v8, 16, v156
  v_and_b32 v9, 0xffff0000, v156
  v_pk_add_f32 v[168:169], v[168:169], v[8:9]
  v_lshlrev_b32 v10, 16, v157
  v_and_b32 v11, 0xffff0000, v157
  v_pk_add_f32 v[170:171], v[170:171], v[10:11]
  v_lshlrev_b32 v12, 16, v158
  v_and_b32 v13, 0xffff0000, v158
  v_pk_add_f32 v[172:173], v[172:173], v[12:13]
  v_lshlrev_b32 v14, 16, v159
  v_and_b32 v15, 0xffff0000, v159
  v_pk_add_f32 v[174:175], v[174:175], v[14:15]
  s_and_b32 s76, s48, 1
  s_lshl_b32 s76, s76, 1
  s_lshr_b32 s77, s49, 1
  s_add_u32 s76, s76, s77
  s_mul_i32 s76, s76, 7
  s_add_u32 s76, s76, 6
  s_lshr_b32 s77, s48, 1
  s_add_u32 s77, s77, 0x201
  v_mov_b32 v193, s77
  s_lshl_b32 s76, s76, 7
  s_add_u32 s76, s76, 148897792
  v_and_b32 v192, 7, v1
  v_mul_u32_u24 v192, 3584, v192
  v_add_u32 v192, s76, v192
  s_mov_b32 s71, 0
  s_branch M_vg_52
M_vw_51:
  s_sleep 2
  s_add_u32 s71, s71, 1
  s_cmp_gt_u32 s71, 262144
  s_cbranch_scc1 M_exit
M_vg_52:
  buffer_load_dword v194, v192, s[4:7], 0 offen sc1
  s_waitcnt vmcnt(0)
  v_cmp_lt_u32 vcc, v194, v193
  s_cbranch_vccnz M_vw_51
  s_add_u32 s29, s28, 167772160
  buffer_load_dwordx4 v[96:99], v2, s[4:7], s29 offen offset:0 sc1
  buffer_load_dwordx4 v[100:103], v2, s[4:7], s29 offen offset:1024 sc1
  s_add_u32 s29, s28, 169869312
  buffer_load_dwordx4 v[104:107], v2, s[4:7], s29 offen offset:0 sc1
  buffer_load_dwordx4 v[108:111], v2, s[4:7], s29 offen offset:1024 sc1
  s_add_u32 s29, s28, 171966464
  buffer_load_dwordx4 v[112:115], v2, s[4:7], s29 offen offset:0 sc1
  buffer_load_dwordx4 v[116:119], v2, s[4:7], s29 offen offset:1024 sc1
  s_add_u32 s29, s28, 174063616
  buffer_load_dwordx4 v[120:123], v2, s[4:7], s29 offen offset:0 sc1
  buffer_load_dwordx4 v[124:127], v2, s[4:7], s29 offen offset:1024 sc1
  s_add_u32 s29, s28, 176160768
  buffer_load_dwordx4 v[128:131], v2, s[4:7], s29 offen offset:0 sc1
  buffer_load_dwordx4 v[132:135], v2, s[4:7], s29 offen offset:1024 sc1
  s_add_u32 s29, s28, 178257920
  buffer_load_dwordx4 v[136:139], v2, s[4:7], s29 offen offset:0 sc1
  buffer_load_dwordx4 v[140:143], v2, s[4:7], s29 offen offset:1024 sc1
  s_add_u32 s29, s28, 180355072
  buffer_load_dwordx4 v[144:147], v2, s[4:7], s29 offen offset:0 sc1
  buffer_load_dwordx4 v[148:151], v2, s[4:7], s29 offen offset:1024 sc1
  s_add_u32 s29, s28, 182452224
  buffer_load_dwordx4 v[152:155], v2, s[4:7], s29 offen offset:0 sc1
  buffer_load_dwordx4 v[156:159], v2, s[4:7], s29 offen offset:1024 sc1
  v_pk_mul_f32 v[160:161], v[160:161], v[80:81] op_sel_hi:[1,0]
  v_pk_mul_f32 v[162:163], v[162:163], v[80:81] op_sel_hi:[1,0]
  v_pk_mul_f32 v[164:165], v[164:165], v[80:81] op_sel_hi:[1,0]
  v_pk_mul_f32 v[166:167], v[166:167], v[80:81] op_sel_hi:[1,0]
  v_pk_mul_f32 v[168:169], v[168:169], v[80:81] op_sel_hi:[1,0]
  v_pk_mul_f32 v[170:171], v[170:171], v[80:81] op_sel_hi:[1,0]
  v_pk_mul_f32 v[172:173], v[172:173], v[80:81] op_sel_hi:[1,0]
  v_pk_mul_f32 v[174:175], v[174:175], v[80:81] op_sel_hi:[1,0]
  s_waitcnt vmcnt(14)
  v_lshlrev_b32 v176, 16, v96
  v_and_b32 v177, 0xffff0000, v96
  v_lshlrev_b32 v178, 16, v97
  v_and_b32 v179, 0xffff0000, v97
  v_lshlrev_b32 v180, 16, v98
  v_and_b32 v181, 0xffff0000, v98
  v_lshlrev_b32 v182, 16, v99
  v_and_b32 v183, 0xffff0000, v99
  v_lshlrev_b32 v184, 16, v100
  v_and_b32 v185, 0xffff0000, v100
  v_lshlrev_b32 v186, 16, v101
  v_and_b32 v187, 0xffff0000, v101
  v_lshlrev_b32 v188, 16, v102
  v_and_b32 v189, 0xffff0000, v102
  v_lshlrev_b32 v190, 16, v103
  v_and_b32 v191, 0xffff0000, v103
  s_waitcnt vmcnt(12)
  v_lshlrev_b32 v8, 16, v104
  v_and_b32 v9, 0xffff0000, v104
  v_pk_add_f32 v[176:177], v[176:177], v[8:9]
  v_lshlrev_b32 v10, 16, v105
  v_and_b32 v11, 0xffff0000, v105
  v_pk_add_f32 v[178:179], v[178:179], v[10:11]
  v_lshlrev_b32 v12, 16, v106
  v_and_b32 v13, 0xffff0000, v106
  v_pk_add_f32 v[180:181], v[180:181], v[12:13]
  v_lshlrev_b32 v14, 16, v107
  v_and_b32 v15, 0xffff0000, v107
  v_pk_add_f32 v[182:183], v[182:183], v[14:15]
  v_lshlrev_b32 v8, 16, v108
  v_and_b32 v9, 0xffff0000, v108
  v_pk_add_f32 v[184:185], v[184:185], v[8:9]
  v_lshlrev_b32 v10, 16, v109
  v_and_b32 v11, 0xffff0000, v109
  v_pk_add_f32 v[186:187], v[186:187], v[10:11]
  v_lshlrev_b32 v12, 16, v110
  v_and_b32 v13, 0xffff0000, v110
  v_pk_add_f32 v[188:189], v[188:189], v[12:13]
  v_lshlrev_b32 v14, 16, v111
  v_and_b32 v15, 0xffff0000, v111
  v_pk_add_f32 v[190:191], v[190:191], v[14:15]
  s_waitcnt vmcnt(10)
  v_lshlrev_b32 v8, 16, v112
  v_and_b32 v9, 0xffff0000, v112
  v_pk_add_f32 v[176:177], v[176:177], v[8:9]
  v_lshlrev_b32 v10, 16, v113
  v_and_b32 v11, 0xffff0000, v113
  v_pk_add_f32 v[178:179], v[178:179], v[10:11]
  v_lshlrev_b32 v12, 16, v114
  v_and_b32 v13, 0xffff0000, v114
  v_pk_add_f32 v[180:181], v[180:181], v[12:13]
  v_lshlrev_b32 v14, 16, v115
  v_and_b32 v15, 0xffff0000, v115
  v_pk_add_f32 v[182:183], v[182:183], v[14:15]
  v_lshlrev_b32 v8, 16, v116
  v_and_b32 v9, 0xffff0000, v116
  v_pk_add_f32 v[184:185], v[184:185], v[8:9]
  v_lshlrev_b32 v10, 16, v117
  v_and_b32 v11, 0xffff0000, v117
  v_pk_add_f32 v[186:187], v[186:187], v[10:11]
  v_lshlrev_b32 v12, 16, v118
  v_and_b32 v13, 0xffff0000, v118
  v_pk_add_f32 v[188:189], v[188:189], v[12:13]
  v_lshlrev_b32 v14, 16, v119
  v_and_b32 v15, 0xffff0000, v119
  v_pk_add_f32 v[190:191], v[190:191], v[14:15]
  s_waitcnt vmcnt(8)
  v_lshlrev_b32 v8, 16, v120
  v_and_b32 v9, 0xffff0000, v120
  v_pk_add_f32 v[176:177], v[176:177], v[8:9]
  v_lshlrev_b32 v10, 16, v121
  v_and_b32 v11, 0xffff0000, v121
  v_pk_add_f32 v[178:179], v[178:179], v[10:11]
  v_lshlrev_b32 v12, 16, v122
  v_and_b32 v13, 0xffff0000, v122
  v_pk_add_f32 v[180:181], v[180:181], v[12:13]
  v_lshlrev_b32 v14, 16, v123
  v_and_b32 v15, 0xffff0000, v123
  v_pk_add_f32 v[182:183], v[182:183], v[14:15]
  v_lshlrev_b32 v8, 16, v124
  v_and_b32 v9, 0xffff0000, v124
  v_pk_add_f32 v[184:185], v[184:185], v[8:9]
  v_lshlrev_b32 v10, 16, v125
  v_and_b32 v11, 0xffff0000, v125
  v_pk_add_f32 v[186:187], v[186:187], v[10:11]
  v_lshlrev_b32 v12, 16, v126
  v_and_b32 v13, 0xffff0000, v126
  v_pk_add_f32 v[188:189], v[188:189], v[12:13]
  v_lshlrev_b32 v14, 16, v127
  v_and_b32 v15, 0xffff0000, v127
  v_pk_add_f32 v[190:191], v[190:191], v[14:15]
  s_waitcnt vmcnt(6)
  v_lshlrev_b32 v8, 16, v128
  v_and_b32 v9, 0xffff0000, v128
  v_pk_add_f32 v[176:177], v[176:177], v[8:9]
  v_lshlrev_b32 v10, 16, v129
  v_and_b32 v11, 0xffff0000, v129
  v_pk_add_f32 v[178:179], v[178:179], v[10:11]
  v_lshlrev_b32 v12, 16, v130
  v_and_b32 v13, 0xffff0000, v130
  v_pk_add_f32 v[180:181], v[180:181], v[12:13]
  v_lshlrev_b32 v14, 16, v131
  v_and_b32 v15, 0xffff0000, v131
  v_pk_add_f32 v[182:183], v[182:183], v[14:15]
  v_lshlrev_b32 v8, 16, v132
  v_and_b32 v9, 0xffff0000, v132
  v_pk_add_f32 v[184:185], v[184:185], v[8:9]
  v_lshlrev_b32 v10, 16, v133
  v_and_b32 v11, 0xffff0000, v133
  v_pk_add_f32 v[186:187], v[186:187], v[10:11]
  v_lshlrev_b32 v12, 16, v134
  v_and_b32 v13, 0xffff0000, v134
  v_pk_add_f32 v[188:189], v[188:189], v[12:13]
  v_lshlrev_b32 v14, 16, v135
  v_and_b32 v15, 0xffff0000, v135
  v_pk_add_f32 v[190:191], v[190:191], v[14:15]
  s_waitcnt vmcnt(4)
  v_lshlrev_b32 v8, 16, v136
  v_and_b32 v9, 0xffff0000, v136
  v_pk_add_f32 v[176:177], v[176:177], v[8:9]
  v_lshlrev_b32 v10, 16, v137
  v_and_b32 v11, 0xffff0000, v137
  v_pk_add_f32 v[178:179], v[178:179], v[10:11]
  v_lshlrev_b32 v12, 16, v138
  v_and_b32 v13, 0xffff0000, v138
  v_pk_add_f32 v[180:181], v[180:181], v[12:13]
  v_lshlrev_b32 v14, 16, v139
  v_and_b32 v15, 0xffff0000, v139
  v_pk_add_f32 v[182:183], v[182:183], v[14:15]
  v_lshlrev_b32 v8, 16, v140
  v_and_b32 v9, 0xffff0000, v140
  v_pk_add_f32 v[184:185], v[184:185], v[8:9]
  v_lshlrev_b32 v10, 16, v141
  v_and_b32 v11, 0xffff0000, v141
  v_pk_add_f32 v[186:187], v[186:187], v[10:11]
  v_lshlrev_b32 v12, 16, v142
  v_and_b32 v13, 0xffff0000, v142
  v_pk_add_f32 v[188:189], v[188:189], v[12:13]
  v_lshlrev_b32 v14, 16, v143
  v_and_b32 v15, 0xffff0000, v143
  v_pk_add_f32 v[190:191], v[190:191], v[14:15]
  s_waitcnt vmcnt(2)
  v_lshlrev_b32 v8, 16, v144
  v_and_b32 v9, 0xffff0000, v144
  v_pk_add_f32 v[176:177], v[176:177], v[8:9]
  v_lshlrev_b32 v10, 16, v145
  v_and_b32 v11, 0xffff0000, v145
  v_pk_add_f32 v[178:179], v[178:179], v[10:11]
  v_lshlrev_b32 v12, 16, v146
  v_and_b32 v13, 0xffff0000, v146
  v_pk_add_f32 v[180:181], v[180:181], v[12:13]
  v_lshlrev_b32 v14, 16, v147
  v_and_b32 v15, 0xffff0000, v147
  v_pk_add_f32 v[182:183], v[182:183], v[14:15]
  v_lshlrev_b32 v8, 16, v148
  v_and_b32 v9, 0xffff0000, v148
  v_pk_add_f32 v[184:185], v[184:185], v[8:9]
  v_lshlrev_b32 v10, 16, v149
  v_and_b32 v11, 0xffff0000, v149
  v_pk_add_f32 v[186:187], v[186:187], v[10:11]
  v_lshlrev_b32 v12, 16, v150
  v_and_b32 v13, 0xffff0000, v150
  v_pk_add_f32 v[188:189], v[188:189], v[12:13]
  v_lshlrev_b32 v14, 16, v151
  v_and_b32 v15, 0xffff0000, v151
  v_pk_add_f32 v[190:191], v[190:191], v[14:15]
  s_waitcnt vmcnt(0)
  v_lshlrev_b32 v8, 16, v152
  v_and_b32 v9, 0xffff0000, v152
  v_pk_add_f32 v[176:177], v[176:177], v[8:9]
  v_lshlrev_b32 v10, 16, v153
  v_and_b32 v11, 0xffff0000, v153
  v_pk_add_f32 v[178:179], v[178:179], v[10:11]
  v_lshlrev_b32 v12, 16, v154
  v_and_b32 v13, 0xffff0000, v154
  v_pk_add_f32 v[180:181], v[180:181], v[12:13]
  v_lshlrev_b32 v14, 16, v155
  v_and_b32 v15, 0xffff0000, v155
  v_pk_add_f32 v[182:183], v[182:183], v[14:15]
  v_lshlrev_b32 v8, 16, v156
  v_and_b32 v9, 0xffff0000, v156
  v_pk_add_f32 v[184:185], v[184:185], v[8:9]
  v_lshlrev_b32 v10, 16, v157
  v_and_b32 v11, 0xffff0000, v157
  v_pk_add_f32 v[186:187], v[186:187], v[10:11]
  v_lshlrev_b32 v12, 16, v158
  v_and_b32 v13, 0xffff0000, v158
  v_pk_add_f32 v[188:189], v[188:189], v[12:13]
  v_lshlrev_b32 v14, 16, v159
  v_and_b32 v15, 0xffff0000, v159
  v_pk_add_f32 v[190:191], v[190:191], v[14:15]
  v_pk_fma_f32 v[160:161], v[176:177], v[82:83], v[160:161] op_sel_hi:[1,0,1]
  v_cvt_pk_bf16_f32 v16, v160, v161
  v_pk_fma_f32 v[162:163], v[178:179], v[82:83], v[162:163] op_sel_hi:[1,0,1]
  v_cvt_pk_bf16_f32 v17, v162, v163
  v_pk_fma_f32 v[164:165], v[180:181], v[82:83], v[164:165] op_sel_hi:[1,0,1]
  v_cvt_pk_bf16_f32 v18, v164, v165
  v_pk_fma_f32 v[166:167], v[182:183], v[82:83], v[166:167] op_sel_hi:[1,0,1]
  v_cvt_pk_bf16_f32 v19, v166, v167
  v_pk_fma_f32 v[168:169], v[184:185], v[82:83], v[168:169] op_sel_hi:[1,0,1]
  v_cvt_pk_bf16_f32 v20, v168, v169
  v_pk_fma_f32 v[170:171], v[186:187], v[82:83], v[170:171] op_sel_hi:[1,0,1]
  v_cvt_pk_bf16_f32 v21, v170, v171
  v_pk_fma_f32 v[172:173], v[188:189], v[82:83], v[172:173] op_sel_hi:[1,0,1]
  v_cvt_pk_bf16_f32 v22, v172, v173
  v_pk_fma_f32 v[174:175], v[190:191], v[82:83], v[174:175] op_sel_hi:[1,0,1]
  v_cvt_pk_bf16_f32 v23, v174, v175
  s_lshl_b32 s26, s49, 2
  s_add_u32 s26, s26, s16
  s_lshl_b32 s26, s26, 6
  s_lshl_b32 s27, s48, 15
  s_add_u32 s26, s26, s27
  buffer_store_dwordx4 v[16:19], v6, s[32:35], s26 offen offset:0
  buffer_store_dwordx4 v[20:23], v6, s[32:35], s26 offen offset:32
  s_cmp_lt_u32 s50, 64
  s_mov_b32 s50, s51
  s_cbranch_scc1 M_fin
  s_branch M_done
M_follow:
  s_lshr_b32 s48, s64, 2
  s_and_b32 s49, s64, 1
  s_bfe_u32 s50, s64, 0x10001
  s_mov_b32 s51, 2
  s_mov_b32 s23, 32
  s_load_dwordx2 s[8:9], s[0:1], 88
  s_lshl_b32 s17, s48, 19
  s_lshl_b32 s26, s49, 2
  s_add_u32 s26, s26, s16
  s_lshl_b32 s27, s26, 7
  s_add_u32 s17, s17, s27
  s_mov_b32 s18, 1024
  s_lshl_b32 s21, s48, 6
  s_add_u32 s21, s21, s50
  s_lshl_b32 s21, s21, 3
  s_add_u32 s21, s21, s26
  s_lshl_b32 s21, s21, 12
  s_add_u32 s21, s21, 167772160
  s_lshl_b32 s22, s51, 15
  s_mov_b32 s24, 1.0
  s_waitcnt lgkmcnt(0)
  s_and_b32 s9, s9, 0xffff
  s_mov_b32 s10, 4194304
  s_mov_b32 s11, 0x20000
  v_lshrrev_b32 v144, 4, v1
  v_and_b32 v56, 0xff, v2
  v_lshl_add_u32 v56, v144, 9, v56
  s_mul_i32 s26, s16, 0
  v_add_u32 v8, 0, v56
  v_add_u32 v16, 0, v2
  v_add_u32 v16, s26, v16
  v_add_u32 v9, 256, v56
  v_add_u32 v17, 1024, v2
  v_add_u32 v17, s26, v17
  v_add_u32 v10, 2048, v56
  v_add_u32 v18, 2048, v2
  v_add_u32 v18, s26, v18
  v_add_u32 v11, 2304, v56
  v_add_u32 v19, 3072, v2
  v_add_u32 v19, s26, v19
  v_add_u32 v12, 4096, v56
  v_add_u32 v20, 4096, v2
  v_add_u32 v20, s26, v20
  v_add_u32 v13, 4352, v56
  v_add_u32 v21, 5120, v2
  v_add_u32 v21, s26, v21
  v_add_u32 v14, 6144, v56
  v_add_u32 v22, 6144, v2
  v_add_u32 v22, s26, v22
  v_add_u32 v15, 6400, v56
  v_add_u32 v23, 7168, v2
  v_add_u32 v23, s26, v23
  v_mov_b32 v20, v56
  v_lshrrev_b32 v144, 3, v1
  v_mul_lo_u32 v144, v144, s18
  v_and_b32 v145, 7, v1
  v_lshl_add_u32 v144, v145, 4, v144
  s_lshl_b32 s28, s16, 15
  s_add_u32 s28, s28, 32768
  s_lshl_b32 s29, s18, 3
  s_add_u32 m0, s28, 0
  s_nop 0
  buffer_load_dwordx4 v144, s[8:11], s17 offen lds
  s_add_u32 s17, s17, s29
  s_add_u32 m0, s28, 1024
  s_nop 0
  buffer_load_dwordx4 v144, s[8:11], s17 offen lds
  s_add_u32 s17, s17, s29
  s_add_u32 m0, s28, 2048
  s_nop 0
  buffer_load_dwordx4 v144, s[8:11], s17 offen lds
  s_add_u32 s17, s17, s29
  s_add_u32 m0, s28, 3072
  s_nop 0
  buffer_load_dwordx4 v144, s[8:11], s17 offen lds
  s_add_u32 s17, s17, s29
  s_add_u32 m0, s28, 4096
  s_nop 0
  buffer_load_dwordx4 v144, s[8:11], s17 offen lds
  s_add_u32 s17, s17, s29
  s_add_u32 m0, s28, 5120
  s_nop 0
  buffer_load_dwordx4 v144, s[8:11], s17 offen lds
  s_add_u32 s17, s17, s29
  s_add_u32 m0, s28, 6144
  s_nop 0
  buffer_load_dwordx4 v144, s[8:11], s17 offen lds
  s_add_u32 s17, s17, s29
  s_add_u32 m0, s28, 7168
  s_nop 0
  buffer_load_dwordx4 v144, s[8:11], s17 offen lds
  s_add_u32 s17, s17, s29
  s_add_u32 m0, s28, 8192
  s_nop 0
  buffer_load_dwordx4 v144, s[8:11], s17 offen lds
  s_add_u32 s17, s17, s29
  s_add_u32 m0, s28, 9216
  s_nop 0
  buffer_load_dwordx4 v144, s[8:11], s17 offen lds
  s_add_u32 s17, s17, s29
  s_add_u32 m0, s28, 10240
  s_nop 0
  buffer_load_dwordx4 v144, s[8:11], s17 offen lds
  s_add_u32 s17, s17, s29
  s_add_u32 m0, s28, 11264
  s_nop 0
  buffer_load_dwordx4 v144, s[8:11], s17 offen lds
  s_add_u32 s17, s17, s29
  s_add_u32 m0, s28, 12288
  s_nop 0
  buffer_load_dwordx4 v144, s[8:11], s17 offen lds
  s_add_u32 s17, s17, s29
  s_add_u32 m0, s28, 13312
  s_nop 0
  buffer_load_dwordx4 v144, s[8:11], s17 offen lds
  s_add_u32 s17, s17, s29
  s_add_u32 m0, s28, 14336
  s_nop 0
  buffer_load_dwordx4 v144, s[8:11], s17 offen lds
  s_add_u32 s17, s17, s29
  s_add_u32 m0, s28, 15360
  s_nop 0
  buffer_load_dwordx4 v144, s[8:11], s17 offen lds
  s_add_u32 s17, s17, s29
  s_add_u32 m0, s28, 16384
  s_nop 0
  buffer_load_dwordx4 v144, s[8:11], s17 offen lds
  s_add_u32 s17, s17, s29
  s_add_u32 m0, s28, 17408
  s_nop 0
  buffer_load_dwordx4 v144, s[8:11], s17 offen lds
  s_add_u32 s17, s17, s29
  s_add_u32 m0, s28, 18432
  s_nop 0
  buffer_load_dwordx4 v144, s[8:11], s17 offen lds
  s_add_u32 s17, s17, s29
  s_add_u32 m0, s28, 19456
  s_nop 0
  buffer_load_dwordx4 v144, s[8:11], s17 offen lds
  s_add_u32 s17, s17, s29
  s_add_u32 m0, s28, 20480
  s_nop 0
  buffer_load_dwordx4 v144, s[8:11], s17 offen lds
  s_add_u32 s17, s17, s29
  s_add_u32 m0, s28, 21504
  s_nop 0
  buffer_load_dwordx4 v144, s[8:11], s17 offen lds
  s_add_u32 s17, s17, s29
  s_add_u32 m0, s28, 22528
  s_nop 0
  buffer_load_dwordx4 v144, s[8:11], s17 offen lds
  s_add_u32 s17, s17, s29
  s_add_u32 m0, s28, 23552
  s_nop 0
  buffer_load_dwordx4 v144, s[8:11], s17 offen lds
  s_add_u32 s17, s17, s29
  s_add_u32 m0, s28, 24576
  s_nop 0
  buffer_load_dwordx4 v144, s[8:11], s17 offen lds
  s_add_u32 s17, s17, s29
  s_add_u32 m0, s28, 25600
  s_nop 0
  buffer_load_dwordx4 v144, s[8:11], s17 offen lds
  s_add_u32 s17, s17, s29
  s_add_u32 m0, s28, 26624
  s_nop 0
  buffer_load_dwordx4 v144, s[8:11], s17 offen lds
  s_add_u32 s17, s17, s29
  s_add_u32 m0, s28, 27648
  s_nop 0
  buffer_load_dwordx4 v144, s[8:11], s17 offen lds
  s_add_u32 s17, s17, s29
  s_add_u32 m0, s28, 28672
  s_nop 0
  buffer_load_dwordx4 v144, s[8:11], s17 offen lds
  s_add_u32 s17, s17, s29
  s_add_u32 m0, s28, 29696
  s_nop 0
  buffer_load_dwordx4 v144, s[8:11], s17 offen lds
  s_add_u32 s17, s17, s29
  s_add_u32 m0, s28, 30720
  s_nop 0
  buffer_load_dwordx4 v144, s[8:11], s17 offen lds
  s_add_u32 s17, s17, s29
  s_add_u32 m0, s28, 31744
  s_nop 0
  buffer_load_dwordx4 v144, s[8:11], s17 offen lds
  s_add_u32 s17, s17, s29
  v_bfe_u32 v148, v1, 2, 2
  v_lshrrev_b32 v149, 5, v1
  v_lshl_add_u32 v148, v149, 4, v148
  v_bfe_u32 v149, v1, 4, 1
  v_lshl_add_u32 v148, v149, 2, v148
  v_and_b32 v149, 3, v1
  v_lshlrev_b32 v149, 4, v149
  s_mov_b32 s26, 8
  v_lshl_add_u32 v148, v148, 7, v149
  v_add_u32 v152, s28, v148
  v_add_u32 v153, 1024, v152
  v_add_u32 v154, s26, v152
  v_add_u32 v155, s26, v153
  s_waitcnt vmcnt(28)
  ds_read_b64_tr_b16 a[0:1], v152 offset:0
  ds_read_b64_tr_b16 a[2:3], v153 offset:0
  ds_read_b64_tr_b16 a[4:5], v154 offset:0
  ds_read_b64_tr_b16 a[6:7], v155 offset:0
  ds_read_b64_tr_b16 a[8:9], v152 offset:64
  ds_read_b64_tr_b16 a[10:11], v153 offset:64
  ds_read_b64_tr_b16 a[12:13], v154 offset:64
  ds_read_b64_tr_b16 a[14:15], v155 offset:64
  s_waitcnt lgkmcnt(0)
  s_add_u32 m0, s28, 0
  s_nop 0
  buffer_load_dwordx4 v144, s[8:11], s17 offen lds
  s_add_u32 s17, s17, s29
  s_add_u32 m0, s28, 1024
  s_nop 0
  buffer_load_dwordx4 v144, s[8:11], s17 offen lds
  s_add_u32 s17, s17, s29
  s_add_u32 m0, s28, 2048
  s_nop 0
  buffer_load_dwordx4 v144, s[8:11], s17 offen lds
  s_add_u32 s17, s17, s29
  s_add_u32 m0, s28, 3072
  s_nop 0
  buffer_load_dwordx4 v144, s[8:11], s17 offen lds
  s_add_u32 s17, s17, s29
  s_waitcnt vmcnt(28)
  ds_read_b64_tr_b16 a[16:17], v152 offset:4096
  ds_read_b64_tr_b16 a[18:19], v153 offset:4096
  ds_read_b64_tr_b16 a[20:21], v154 offset:4096
  ds_read_b64_tr_b16 a[22:23], v155 offset:4096
  ds_read_b64_tr_b16 a[24:25], v152 offset:4160
  ds_read_b64_tr_b16 a[26:27], v153 offset:4160
  ds_read_b64_tr_b16 a[28:29], v154 offset:4160
  ds_read_b64_tr_b16 a[30:31], v155 offset:4160
  s_waitcnt lgkmcnt(0)
  s_add_u32 m0, s28, 4096
  s_nop 0
  buffer_load_dwordx4 v144, s[8:11], s17 offen lds
  s_add_u32 s17, s17, s29
  s_add_u32 m0, s28, 5120
  s_nop 0
  buffer_load_dwordx4 v144, s[8:11], s17 offen lds
  s_add_u32 s17, s17, s29
  s_add_u32 m0, s28, 6144
  s_nop 0
  buffer_load_dwordx4 v144, s[8:11], s17 offen lds
  s_add_u32 s17, s17, s29
  s_add_u32 m0, s28, 7168
  s_nop 0
  buffer_load_dwordx4 v144, s[8:11], s17 offen lds
  s_add_u32 s17, s17, s29
  s_waitcnt vmcnt(28)
  ds_read_b64_tr_b16 a[32:33], v152 offset:8192
  ds_read_b64_tr_b16 a[34:35], v153 offset:8192
  ds_read_b64_tr_b16 a[36:37], v154 offset:8192
  ds_read_b64_tr_b16 a[38:39], v155 offset:8192
  ds_read_b64_tr_b16 a[40:41], v152 offset:8256
  ds_read_b64_tr_b16 a[42:43], v153 offset:8256
  ds_read_b64_tr_b16 a[44:45], v154 offset:8256
  ds_read_b64_tr_b16 a[46:47], v155 offset:8256
  s_waitcnt lgkmcnt(0)
  s_add_u32 m0, s28, 8192
  s_nop 0
  buffer_load_dwordx4 v144, s[8:11], s17 offen lds
  s_add_u32 s17, s17, s29
  s_add_u32 m0, s28, 9216
  s_nop 0
  buffer_load_dwordx4 v144, s[8:11], s17 offen lds
  s_add_u32 s17, s17, s29
  s_add_u32 m0, s28, 10240
  s_nop 0
  buffer_load_dwordx4 v144, s[8:11], s17 offen lds
  s_add_u32 s17, s17, s29
  s_add_u32 m0, s28, 11264
  s_nop 0
  buffer_load_dwordx4 v144, s[8:11], s17 offen lds
  s_add_u32 s17, s17, s29
  s_waitcnt vmcnt(28)
  ds_read_b64_tr_b16 a[48:49], v152 offset:12288
  ds_read_b64_tr_b16 a[50:51], v153 offset:12288
  ds_read_b64_tr_b16 a[52:53], v154 offset:12288
  ds_read_b64_tr_b16 a[54:55], v155 offset:12288
  ds_read_b64_tr_b16 a[56:57], v152 offset:12352
  ds_read_b64_tr_b16 a[58:59], v153 offset:12352
  ds_read_b64_tr_b16 a[60:61], v154 offset:12352
  ds_read_b64_tr_b16 a[62:63], v155 offset:12352
  s_waitcnt lgkmcnt(0)
  s_add_u32 m0, s28, 12288
  s_nop 0
  buffer_load_dwordx4 v144, s[8:11], s17 offen lds
  s_add_u32 s17, s17, s29
  s_add_u32 m0, s28, 13312
  s_nop 0
  buffer_load_dwordx4 v144, s[8:11], s17 offen lds
  s_add_u32 s17, s17, s29
  s_add_u32 m0, s28, 14336
  s_nop 0
  buffer_load_dwordx4 v144, s[8:11], s17 offen lds
  s_add_u32 s17, s17, s29
  s_add_u32 m0, s28, 15360
  s_nop 0
  buffer_load_dwordx4 v144, s[8:11], s17 offen lds
  s_add_u32 s17, s17, s29
  s_waitcnt vmcnt(28)
  ds_read_b64_tr_b16 a[64:65], v152 offset:16384
  ds_read_b64_tr_b16 a[66:67], v153 offset:16384
  ds_read_b64_tr_b16 a[68:69], v154 offset:16384
  ds_read_b64_tr_b16 a[70:71], v155 offset:16384
  ds_read_b64_tr_b16 a[72:73], v152 offset:16448
  ds_read_b64_tr_b16 a[74:75], v153 offset:16448
  ds_read_b64_tr_b16 a[76:77], v154 offset:16448
  ds_read_b64_tr_b16 a[78:79], v155 offset:16448
  s_waitcnt lgkmcnt(0)
  s_add_u32 m0, s28, 16384
  s_nop 0
  buffer_load_dwordx4 v144, s[8:11], s17 offen lds
  s_add_u32 s17, s17, s29
  s_add_u32 m0, s28, 17408
  s_nop 0
  buffer_load_dwordx4 v144, s[8:11], s17 offen lds
  s_add_u32 s17, s17, s29
  s_add_u32 m0, s28, 18432
  s_nop 0
  buffer_load_dwordx4 v144, s[8:11], s17 offen lds
  s_add_u32 s17, s17, s29
  s_add_u32 m0, s28, 19456
  s_nop 0
  buffer_load_dwordx4 v144, s[8:11], s17 offen lds
  s_add_u32 s17, s17, s29
  s_waitcnt vmcnt(28)
  ds_read_b64_tr_b16 a[80:81], v152 offset:20480
  ds_read_b64_tr_b16 a[82:83], v153 offset:20480
  ds_read_b64_tr_b16 a[84:85], v154 offset:20480
  ds_read_b64_tr_b16 a[86:87], v155 offset:20480
  ds_read_b64_tr_b16 a[88:89], v152 offset:20544
  ds_read_b64_tr_b16 a[90:91], v153 offset:20544
  ds_read_b64_tr_b16 a[92:93], v154 offset:20544
  ds_read_b64_tr_b16 a[94:95], v155 offset:20544
  s_waitcnt lgkmcnt(0)
  s_add_u32 m0, s28, 20480
  s_nop 0
  buffer_load_dwordx4 v144, s[8:11], s17 offen lds
  s_add_u32 s17, s17, s29
  s_add_u32 m0, s28, 21504
  s_nop 0
  buffer_load_dwordx4 v144, s[8:11], s17 offen lds
  s_add_u32 s17, s17, s29
  s_add_u32 m0, s28, 22528
  s_nop 0
  buffer_load_dwordx4 v144, s[8:11], s17 offen lds
  s_add_u32 s17, s17, s29
  s_add_u32 m0, s28, 23552
  s_nop 0
  buffer_load_dwordx4 v144, s[8:11], s17 offen lds
  s_add_u32 s17, s17, s29
  s_waitcnt vmcnt(28)
  ds_read_b64_tr_b16 a[96:97], v152 offset:24576
  ds_read_b64_tr_b16 a[98:99], v153 offset:24576
  ds_read_b64_tr_b16 a[100:101], v154 offset:24576
  ds_read_b64_tr_b16 a[102:103], v155 offset:24576
  ds_read_b64_tr_b16 a[104:105], v152 offset:24640
  ds_read_b64_tr_b16 a[106:107], v153 offset:24640
  ds_read_b64_tr_b16 a[108:109], v154 offset:24640
  ds_read_b64_tr_b16 a[110:111], v155 offset:24640
  s_waitcnt lgkmcnt(0)
  s_add_u32 m0, s28, 24576
  s_nop 0
  buffer_load_dwordx4 v144, s[8:11], s17 offen lds
  s_add_u32 s17, s17, s29
  s_add_u32 m0, s28, 25600
  s_nop 0
  buffer_load_dwordx4 v144, s[8:11], s17 offen lds
  s_add_u32 s17, s17, s29
  s_add_u32 m0, s28, 26624
  s_nop 0
  buffer_load_dwordx4 v144, s[8:11], s17 offen lds
  s_add_u32 s17, s17, s29
  s_add_u32 m0, s28, 27648
  s_nop 0
  buffer_load_dwordx4 v144, s[8:11], s17 offen lds
  s_add_u32 s17, s17, s29
  s_waitcnt vmcnt(28)
  ds_read_b64_tr_b16 a[112:113], v152 offset:28672
  ds_read_b64_tr_b16 a[114:115], v153 offset:28672
  ds_read_b64_tr_b16 a[116:117], v154 offset:28672
  ds_read_b64_tr_b16 a[118:119], v155 offset:28672
  ds_read_b64_tr_b16 a[120:121], v152 offset:28736
  ds_read_b64_tr_b16 a[122:123], v153 offset:28736
  ds_read_b64_tr_b16 a[124:125], v154 offset:28736
  ds_read_b64_tr_b16 a[126:127], v155 offset:28736
  s_waitcnt lgkmcnt(0)
  s_add_u32 m0, s28, 28672
  s_nop 0
  buffer_load_dwordx4 v144, s[8:11], s17 offen lds
  s_add_u32 s17, s17, s29
  s_add_u32 m0, s28, 29696
  s_nop 0
  buffer_load_dwordx4 v144, s[8:11], s17 offen lds
  s_add_u32 s17, s17, s29
  s_add_u32 m0, s28, 30720
  s_nop 0
  buffer_load_dwordx4 v144, s[8:11], s17 offen lds
  s_add_u32 s17, s17, s29
  s_add_u32 m0, s28, 31744
  s_nop 0
  buffer_load_dwordx4 v144, s[8:11], s17 offen lds
  s_add_u32 s17, s17, s29
  s_waitcnt vmcnt(28)
  ds_read_b64_tr_b16 a[128:129], v152 offset:0
  ds_read_b64_tr_b16 a[130:131], v153 offset:0
  ds_read_b64_tr_b16 a[132:133], v154 offset:0
  ds_read_b64_tr_b16 a[134:135], v155 offset:0
  ds_read_b64_tr_b16 a[136:137], v152 offset:64
  ds_read_b64_tr_b16 a[138:139], v153 offset:64
  ds_read_b64_tr_b16 a[140:141], v154 offset:64
  ds_read_b64_tr_b16 a[142:143], v155 offset:64
  s_waitcnt lgkmcnt(0)
  s_waitcnt vmcnt(24)
  ds_read_b64_tr_b16 a[144:145], v152 offset:4096
  ds_read_b64_tr_b16 a[146:147], v153 offset:4096
  ds_read_b64_tr_b16 a[148:149], v154 offset:4096
  ds_read_b64_tr_b16 a[150:151], v155 offset:4096
  ds_read_b64_tr_b16 a[152:153], v152 offset:4160
  ds_read_b64_tr_b16 a[154:155], v153 offset:4160
  ds_read_b64_tr_b16 a[156:157], v154 offset:4160
  ds_read_b64_tr_b16 a[158:159], v155 offset:4160
  s_waitcnt lgkmcnt(0)
  s_waitcnt vmcnt(20)
  ds_read_b64_tr_b16 a[160:161], v152 offset:8192
  ds_read_b64_tr_b16 a[162:163], v153 offset:8192
  ds_read_b64_tr_b16 a[164:165], v154 offset:8192
  ds_read_b64_tr_b16 a[166:167], v155 offset:8192
  ds_read_b64_tr_b16 a[168:169], v152 offset:8256
  ds_read_b64_tr_b16 a[170:171], v153 offset:8256
  ds_read_b64_tr_b16 a[172:173], v154 offset:8256
  ds_read_b64_tr_b16 a[174:175], v155 offset:8256
  s_waitcnt lgkmcnt(0)
  s_waitcnt vmcnt(16)
  ds_read_b64_tr_b16 a[176:177], v152 offset:12288
  ds_read_b64_tr_b16 a[178:179], v153 offset:12288
  ds_read_b64_tr_b16 a[180:181], v154 offset:12288
  ds_read_b64_tr_b16 a[182:183], v155 offset:12288
  ds_read_b64_tr_b16 a[184:185], v152 offset:12352
  ds_read_b64_tr_b16 a[186:187], v153 offset:12352
  ds_read_b64_tr_b16 a[188:189], v154 offset:12352
  ds_read_b64_tr_b16 a[190:191], v155 offset:12352
  s_waitcnt lgkmcnt(0)
  s_waitcnt vmcnt(12)
  ds_read_b64_tr_b16 a[192:193], v152 offset:16384
  ds_read_b64_tr_b16 a[194:195], v153 offset:16384
  ds_read_b64_tr_b16 a[196:197], v154 offset:16384
  ds_read_b64_tr_b16 a[198:199], v155 offset:16384
  ds_read_b64_tr_b16 a[200:201], v152 offset:16448
  ds_read_b64_tr_b16 a[202:203], v153 offset:16448
  ds_read_b64_tr_b16 a[204:205], v154 offset:16448
  ds_read_b64_tr_b16 a[206:207], v155 offset:16448
  s_waitcnt lgkmcnt(0)
  s_waitcnt vmcnt(8)
  ds_read_b64_tr_b16 a[208:209], v152 offset:20480
  ds_read_b64_tr_b16 a[210:211], v153 offset:20480
  ds_read_b64_tr_b16 a[212:213], v154 offset:20480
  ds_read_b64_tr_b16 a[214:215], v155 offset:20480
  ds_read_b64_tr_b16 a[216:217], v152 offset:20544
  ds_read_b64_tr_b16 a[218:219], v153 offset:20544
  ds_read_b64_tr_b16 a[220:221], v154 offset:20544
  ds_read_b64_tr_b16 a[222:223], v155 offset:20544
  s_waitcnt lgkmcnt(0)
  s_waitcnt vmcnt(4)
  ds_read_b64_tr_b16 a[224:225], v152 offset:24576
  ds_read_b64_tr_b16 a[226:227], v153 offset:24576
  ds_read_b64_tr_b16 a[228:229], v154 offset:24576
  ds_read_b64_tr_b16 a[230:231], v155 offset:24576
  ds_read_b64_tr_b16 a[232:233], v152 offset:24640
  ds_read_b64_tr_b16 a[234:235], v153 offset:24640
  ds_read_b64_tr_b16 a[236:237], v154 offset:24640
  ds_read_b64_tr_b16 a[238:239], v155 offset:24640
  s_waitcnt lgkmcnt(0)
  s_waitcnt vmcnt(0)
  ds_read_b64_tr_b16 a[240:241], v152 offset:28672
  ds_read_b64_tr_b16 a[242:243], v153 offset:28672
  ds_read_b64_tr_b16 a[244:245], v154 offset:28672
  ds_read_b64_tr_b16 a[246:247], v155 offset:28672
  ds_read_b64_tr_b16 a[248:249], v152 offset:28736
  ds_read_b64_tr_b16 a[250:251], v153 offset:28736
  ds_read_b64_tr_b16 a[252:253], v154 offset:28736
  ds_read_b64_tr_b16 a[254:255], v155 offset:28736
  s_waitcnt lgkmcnt(0)
  s_lshl_b32 s26, s48, 2
  s_add_u32 s26, s26, s16
  s_lshl_b32 s27, s26, 6
  s_add_u32 s27, s27, s50
  s_lshl_b32 s19, s27, 13
  s_lshl_b32 s27, s50, 5
  s_add_u32 s27, s27, s26
  s_mul_i32 s27, s27, 4096
  s_add_u32 s20, s27, 135266304
  s_lshl_b32 s25, s16, 12
  s_add_u32 s25, s25, 65536
  s_lshl_b32 s26, s16, 13
  v_add_u32 v3, s26, v2
  v_lshrrev_b32 v16, 5, v1
  v_and_b32 v17, 31, v1
  v_bfe_u32 v18, v1, 4, 1
  v_lshl_add_u32 v18, v18, 1, v16
  v_and_b32 v19, 15, v1
  v_lshl_add_u32 v18, v18, 4, v19
  v_lshl_add_u32 v5, v18, 4, s25
  v_bfe_u32 v18, v1, 2, 2
  v_lshl_add_u32 v18, v16, 2, v18
  v_and_b32 v19, 1, v1
  v_lshl_add_u32 v18, v19, 4, v18
  v_lshl_add_u32 v4, v18, 4, s25
  v_lshlrev_b32 v16, 2, v16
  v_sub_u32 v17, v17, v16
  v_mov_b32 v18, 0xf149f2ca
  v_cmp_le_i32 vcc, 0, v17
  s_nop 1
  v_cndmask_b32 v240, v18, 0, vcc
  v_cmp_le_i32 vcc, 1, v17
  s_nop 1
  v_cndmask_b32 v241, v18, 0, vcc
  v_cmp_le_i32 vcc, 2, v17
  s_nop 1
  v_cndmask_b32 v242, v18, 0, vcc
  v_cmp_le_i32 vcc, 3, v17
  s_nop 1
  v_cndmask_b32 v243, v18, 0, vcc
  v_cmp_le_i32 vcc, 8, v17
  s_nop 1
  v_cndmask_b32 v244, v18, 0, vcc
  v_cmp_le_i32 vcc, 9, v17
  s_nop 1
  v_cndmask_b32 v245, v18, 0, vcc
  v_cmp_le_i32 vcc, 10, v17
  s_nop 1
  v_cndmask_b32 v246, v18, 0, vcc
  v_cmp_le_i32 vcc, 11, v17
  s_nop 1
  v_cndmask_b32 v247, v18, 0, vcc
  v_cmp_le_i32 vcc, 16, v17
  s_nop 1
  v_cndmask_b32 v248, v18, 0, vcc
  v_cmp_le_i32 vcc, 17, v17
  s_nop 1
  v_cndmask_b32 v249, v18, 0, vcc
  v_cmp_le_i32 vcc, 18, v17
  s_nop 1
  v_cndmask_b32 v250, v18, 0, vcc
  v_cmp_le_i32 vcc, 19, v17
  s_nop 1
  v_cndmask_b32 v251, v18, 0, vcc
  v_cmp_le_i32 vcc, 24, v17
  s_nop 1
  v_cndmask_b32 v252, v18, 0, vcc
  v_cmp_le_i32 vcc, 25, v17
  s_nop 1
  v_cndmask_b32 v253, v18, 0, vcc
  v_cmp_le_i32 vcc, 26, v17
  s_nop 1
  v_cndmask_b32 v254, v18, 0, vcc
  v_cmp_le_i32 vcc, 27, v17
  s_nop 1
  v_cndmask_b32 v255, v18, 0, vcc
  v_mov_b32 v21, v2
  s_barrier
  s_lshl_b32 s77, s48, 2
  s_add_u32 s77, s77, s16
  s_mul_i32 s78, s77, 896
  s_add_u32 s76, s78, 148898304
  s_mov_b32 s71, 0
  s_branch M_sg_55
M_sw_54:
  s_sleep 8
  s_add_u32 s71, s71, 1
  s_cmp_gt_u32 s71, 262144
  s_cbranch_scc1 M_exit
M_sg_55:
  s_mov_b32 s79, 0
  s_atomic_or s79, s[72:73], s76 glc
  s_waitcnt lgkmcnt(0)
  s_cmp_lt_u32 s79, 16
  s_cbranch_scc1 M_sw_54
  s_add_u32 s76, s78, 148898048
  s_mov_b32 s71, 0
  s_branch M_sg_57
M_sw_56:
  s_sleep 8
  s_add_u32 s71, s71, 1
  s_cmp_gt_u32 s71, 262144
  s_cbranch_scc1 M_exit
M_sg_57:
  s_mov_b32 s79, 0
  s_atomic_or s79, s[72:73], s76 glc
  s_waitcnt lgkmcnt(0)
  s_cmp_lt_u32 s79, 16
  s_cbranch_scc1 M_sw_56
M_xok_53:
  s_lshl_b32 s77, s77, 7
  s_add_u32 s54, s77, 148926464
  s_add_u32 s52, s50, 1
  s_mov_b32 s53, 0
  s_mov_b32 s30, 0x200
  s_add_u32 s28, s19, 50331648
  buffer_load_dwordx4 v[144:147], v21, s[4:7], s28 offen offset:0 sc1
  buffer_load_dwordx4 v[148:151], v21, s[4:7], s28 offen offset:1024 sc1
  buffer_load_dwordx4 v[152:155], v21, s[4:7], s28 offen offset:2048 sc1
  buffer_load_dwordx4 v[156:159], v21, s[4:7], s28 offen offset:3072 sc1
  s_add_u32 s29, s19, 50335744
  buffer_load_dwordx4 v[160:163], v21, s[4:7], s29 offen offset:0 sc1
  buffer_load_dwordx4 v[164:167], v21, s[4:7], s29 offen offset:1024 sc1
  buffer_load_dwordx4 v[168:171], v21, s[4:7], s29 offen offset:2048 sc1
  buffer_load_dwordx4 v[172:175], v21, s[4:7], s29 offen offset:3072 sc1
  s_add_u32 s28, s19, 67108864
  buffer_load_dwordx4 v[176:179], v21, s[4:7], s28 offen offset:0 sc1
  buffer_load_dwordx4 v[180:183], v21, s[4:7], s28 offen offset:1024 sc1
  buffer_load_dwordx4 v[184:187], v21, s[4:7], s28 offen offset:2048 sc1
  buffer_load_dwordx4 v[188:191], v21, s[4:7], s28 offen offset:3072 sc1
  s_add_u32 s29, s19, 67112960
  buffer_load_dwordx4 v[192:195], v21, s[4:7], s29 offen offset:0 sc1
  buffer_load_dwordx4 v[196:199], v21, s[4:7], s29 offen offset:1024 sc1
  buffer_load_dwordx4 v[200:203], v21, s[4:7], s29 offen offset:2048 sc1
  buffer_load_dwordx4 v[204:207], v21, s[4:7], s29 offen offset:3072 sc1
  s_add_u32 s28, s19, 83886080
  buffer_load_dwordx4 v[208:211], v21, s[4:7], s28 offen offset:0 sc1
  buffer_load_dwordx4 v[212:215], v21, s[4:7], s28 offen offset:1024 sc1
  buffer_load_dwordx4 v[216:219], v21, s[4:7], s28 offen offset:2048 sc1
  buffer_load_dwordx4 v[220:223], v21, s[4:7], s28 offen offset:3072 sc1
  s_add_u32 s29, s19, 83890176
  buffer_load_dwordx4 v[224:227], v21, s[4:7], s29 offen offset:0 sc1
  buffer_load_dwordx4 v[228:231], v21, s[4:7], s29 offen offset:1024 sc1
  buffer_load_dwordx4 v[232:235], v21, s[4:7], s29 offen offset:2048 sc1
  buffer_load_dwordx4 v[236:239], v21, s[4:7], s29 offen offset:3072 sc1
  s_mov_b32 s24, 0
  v_mov_b32 v22, 0x40000000
  s_sub_u32 s21, s21, s22
F_top_58:
  s_waitcnt vmcnt(8)
  v_mfma_f32_32x32x16_bf16 v[24:39], v[176:179], v[144:147], v[240:255]
  s_nop 1
  v_cvt_pk_bf16_f32 v128, v64, v65
  v_cvt_pk_bf16_f32 v129, v66, v67
  v_cvt_pk_bf16_f32 v130, v68, v69
  v_cvt_pk_bf16_f32 v131, v70, v71
  v_mfma_f32_32x32x16_bf16 v[24:39], v[180:183], v[148:151], v[24:39]
  buffer_store_dwordx4 v[128:131], v22, s[4:7], s21 offen offset:0 sc1
  v_mfma_f32_32x32x16_bf16 v[24:39], v[184:187], v[152:155], v[24:39]
  v_cvt_pk_bf16_f32 v132, v72, v73
  v_cvt_pk_bf16_f32 v133, v74, v75
  v_cvt_pk_bf16_f32 v134, v76, v77
  v_cvt_pk_bf16_f32 v135, v78, v79
  v_mfma_f32_32x32x16_bf16 v[24:39], v[188:191], v[156:159], v[24:39]
  buffer_store_dwordx4 v[132:135], v22, s[4:7], s21 offen offset:256 sc1
  v_mfma_f32_32x32x16_bf16 v[24:39], v[192:195], v[160:163], v[24:39]
  v_cvt_pk_bf16_f32 v136, v80, v81
  v_cvt_pk_bf16_f32 v137, v82, v83
  v_cvt_pk_bf16_f32 v138, v84, v85
  v_cvt_pk_bf16_f32 v139, v86, v87
  v_mfma_f32_32x32x16_bf16 v[24:39], v[196:199], v[164:167], v[24:39]
  buffer_store_dwordx4 v[136:139], v22, s[4:7], s21 offen offset:2048 sc1
  v_mfma_f32_32x32x16_bf16 v[24:39], v[200:203], v[168:171], v[24:39]
  v_cvt_pk_bf16_f32 v140, v88, v89
  v_cvt_pk_bf16_f32 v141, v90, v91
  v_cvt_pk_bf16_f32 v142, v92, v93
  v_cvt_pk_bf16_f32 v143, v94, v95
  v_mfma_f32_32x32x16_bf16 v[24:39], v[204:207], v[172:175], v[24:39]
  buffer_store_dwordx4 v[140:143], v22, s[4:7], s21 offen offset:2304 sc1
  s_add_u32 s21, s21, s22
  v_mov_b32 v22, v20
  s_cmp_lg_u32 s24, 0
  s_cbranch_scc1 F_have_59
  s_cmp_le_u32 s52, 58
  s_cbranch_scc1 M_dp_60
  s_mov_b32 s71, 0
  v_add_u32 v16, s25, v2
  s_branch M_dp_62
M_dp_61:
  s_sleep 1
  s_add_u32 s71, s71, 1
  s_cmp_gt_u32 s71, 262144
  s_cbranch_scc1 M_exit
M_dp_62:
  buffer_load_dword v23, off, s[4:7], s54 sc1
  buffer_load_dwordx4 v[96:99], v2, s[4:7], s20 offen offset:0 sc1
  buffer_load_dwordx4 v[100:103], v2, s[4:7], s20 offen offset:1024 sc1
  buffer_load_dwordx4 v[104:107], v2, s[4:7], s20 offen offset:2048 sc1
  buffer_load_dwordx4 v[108:111], v2, s[4:7], s20 offen offset:3072 sc1
  s_waitcnt vmcnt(3)
  v_max_u32 v17, v96, v97
  v_max3_u32 v17, v17, v98, v99
  s_waitcnt vmcnt(2)
  v_max3_u32 v17, v17, v100, v101
  v_max3_u32 v17, v17, v102, v103
  s_waitcnt vmcnt(1)
  v_max3_u32 v17, v17, v104, v105
  v_max3_u32 v17, v17, v106, v107
  s_waitcnt vmcnt(0)
  v_max3_u32 v17, v17, v108, v109
  v_max3_u32 v17, v17, v110, v111
  v_cmp_eq_u32 vcc, -1, v17
  s_cbranch_vccz M_dp_63
  v_cmp_gt_u32 vcc, s52, v23
  s_cbranch_vccnz M_dp_61
  s_branch M_dp_60
M_dp_63:
  ds_write_b128 v16, v[96:99] offset:0
  ds_write_b128 v16, v[100:103] offset:1024
  ds_write_b128 v16, v[104:107] offset:2048
  ds_write_b128 v16, v[108:111] offset:3072
  s_branch F_have_59
M_dp_60:
  v_mov_b32 v16, s54
  v_mov_b32 v17, s52
  s_mov_b32 s71, 0
  s_branch M_vg_65
M_vw_64:
  s_sleep 2
  s_add_u32 s71, s71, 1
  s_cmp_gt_u32 s71, 262144
  s_cbranch_scc1 M_exit
M_vg_65:
  buffer_load_dword v23, v16, s[4:7], 0 offen sc1
  s_waitcnt vmcnt(0)
  v_cmp_lt_u32 vcc, v23, v17
  s_cbranch_vccnz M_vw_64
  s_mov_b32 m0, s25
  s_nop 0
  buffer_load_dwordx4 v2, s[4:7], s20 offen offset:0 sc1 lds
  buffer_load_dwordx4 v2, s[4:7], s20 offen offset:1024 sc1 lds
  buffer_load_dwordx4 v2, s[4:7], s20 offen offset:2048 sc1 lds
  buffer_load_dwordx4 v2, s[4:7], s20 offen offset:3072 sc1 lds
  s_waitcnt vmcnt(0)
F_have_59:
  ds_read_b64_tr_b16 v[176:177], v4 offset:8
  ds_read_b64_tr_b16 v[178:179], v4 offset:136
  ds_read_b64_tr_b16 v[180:181], v4 offset:520
  ds_read_b64_tr_b16 v[182:183], v4 offset:648
  ds_read_b64_tr_b16 v[184:185], v4 offset:1032
  ds_read_b64_tr_b16 v[186:187], v4 offset:1160
  ds_read_b64_tr_b16 v[188:189], v4 offset:1544
  ds_read_b64_tr_b16 v[190:191], v4 offset:1672
  ds_read_b64_tr_b16 v[192:193], v4 offset:2056
  ds_read_b64_tr_b16 v[194:195], v4 offset:2184
  ds_read_b64_tr_b16 v[196:197], v4 offset:2568
  ds_read_b64_tr_b16 v[198:199], v4 offset:2696
  s_sub_u32 s23, s23, 1
  s_cmp_gt_u32 s23, 0
  s_cselect_b32 s26, s51, 0
  s_cselect_b32 s27, 0, 0x40000000
  v_or_b32 v21, s27, v21
  s_lshl_b32 s27, s26, 13
  s_add_u32 s19, s19, s27
  s_mul_i32 s27, s26, 131072
  s_add_u32 s20, s20, s27
  s_cmp_lg_u32 s23, 24
  s_cbranch_scc1 M_xok_66
  s_lshl_b32 s77, s48, 2
  s_add_u32 s77, s77, s16
  s_mul_i32 s78, s77, 896
  s_add_u32 s76, s78, 148898304
  s_mov_b32 s71, 0
  s_branch M_sg_68
M_sw_67:
  s_sleep 8
  s_add_u32 s71, s71, 1
  s_cmp_gt_u32 s71, 262144
  s_cbranch_scc1 M_exit
M_sg_68:
  s_mov_b32 s79, 0
  s_atomic_or s79, s[72:73], s76 glc
  s_waitcnt lgkmcnt(0)
  s_cmp_lt_u32 s79, 32
  s_cbranch_scc1 M_sw_67
  s_add_u32 s76, s78, 148898432
  s_mov_b32 s71, 0
  s_branch M_sg_70
M_sw_69:
  s_sleep 8
  s_add_u32 s71, s71, 1
  s_cmp_gt_u32 s71, 262144
  s_cbranch_scc1 M_exit
M_sg_70:
  s_mov_b32 s79, 0
  s_atomic_or s79, s[72:73], s76 glc
  s_waitcnt lgkmcnt(0)
  s_cmp_lt_u32 s79, 32
  s_cbranch_scc1 M_sw_69
  s_add_u32 s76, s78, 148898048
  s_mov_b32 s71, 0
  s_branch M_sg_72
M_sw_71:
  s_sleep 8
  s_add_u32 s71, s71, 1
  s_cmp_gt_u32 s71, 262144
  s_cbranch_scc1 M_exit
M_sg_72:
  s_mov_b32 s79, 0
  s_atomic_or s79, s[72:73], s76 glc
  s_waitcnt lgkmcnt(0)
  s_cmp_lt_u32 s79, 30
  s_cbranch_scc1 M_sw_71
  s_add_u32 s76, s78, 148898176
  s_mov_b32 s71, 0
  s_branch M_sg_74
M_sw_73:
  s_sleep 8
  s_add_u32 s71, s71, 1
  s_cmp_gt_u32 s71, 262144
  s_cbranch_scc1 M_exit
M_sg_74:
  s_mov_b32 s79, 0
  s_atomic_or s79, s[72:73], s76 glc
  s_waitcnt lgkmcnt(0)
  s_cmp_lt_u32 s79, 34
  s_cbranch_scc1 M_sw_73
M_xok_66:
  s_waitcnt lgkmcnt(10)
  v_mfma_f32_32x32x16_bf16 v[40:55], v[176:179], v[144:147], 0
  ds_read_b64_tr_b16 v[200:201], v4 offset:3080
  ds_read_b64_tr_b16 v[202:203], v4 offset:3208
  v_max_f32 v6, v24, v25
  s_waitcnt lgkmcnt(10)
  v_mfma_f32_32x32x16_bf16 v[40:55], v[180:183], v[148:151], v[40:55]
  ds_read_b64_tr_b16 v[204:205], v4 offset:3592
  ds_read_b64_tr_b16 v[206:207], v4 offset:3720
  v_max3_f32 v6, v6, v26, v27
  s_waitcnt lgkmcnt(10)
  v_mfma_f32_32x32x16_bf16 v[40:55], v[184:187], v[152:155], v[40:55]
  ds_read_b64 v[56:57], v5 offset:0
  ds_read_b64 v[58:59], v5 offset:1024
  v_max3_f32 v6, v6, v28, v29
  s_waitcnt lgkmcnt(10)
  v_mfma_f32_32x32x16_bf16 v[40:55], v[188:191], v[156:159], v[40:55]
  ds_read_b64 v[60:61], v5 offset:2048
  ds_read_b64 v[62:63], v5 offset:3072
  v_max3_f32 v6, v6, v30, v31
  s_waitcnt lgkmcnt(10)
  v_mfma_f32_32x32x16_bf16 v[40:55], v[192:195], v[160:163], v[40:55]
  v_max3_f32 v6, v6, v32, v33
  s_waitcnt lgkmcnt(8)
  v_mfma_f32_32x32x16_bf16 v[40:55], v[196:199], v[164:167], v[40:55]
  v_max3_f32 v6, v6, v34, v35
  s_waitcnt lgkmcnt(6)
  v_mfma_f32_32x32x16_bf16 v[40:55], v[200:203], v[168:171], v[40:55]
  v_max3_f32 v6, v6, v36, v37
  s_waitcnt lgkmcnt(4)
  v_mfma_f32_32x32x16_bf16 v[40:55], v[204:207], v[172:175], v[40:55]
  v_max3_f32 v6, v6, v38, v39
  s_add_u32 s28, s19, 50331648
  buffer_load_dwordx4 v[144:147], v21, s[4:7], s28 offen offset:0 sc1
  buffer_load_dwordx4 v[148:151], v21, s[4:7], s28 offen offset:1024 sc1
  s_nop 7
  v_max3_f32 v6, v6, v40, v41
  v_max3_f32 v6, v6, v42, v43
  v_mov_b32 v16, v6
  s_nop 1
  v_permlane32_swap_b32 v6, v16
  s_nop 1
  v_max_f32 v6, v6, v16
  v_pk_add_f32 v[24:25], v[24:25], v[6:7] op_sel_hi:[1,0] neg_lo:[0,1] neg_hi:[0,1]
  v_pk_add_f32 v[26:27], v[26:27], v[6:7] op_sel_hi:[1,0] neg_lo:[0,1] neg_hi:[0,1]
  v_pk_add_f32 v[28:29], v[28:29], v[6:7] op_sel_hi:[1,0] neg_lo:[0,1] neg_hi:[0,1]
  v_pk_add_f32 v[30:31], v[30:31], v[6:7] op_sel_hi:[1,0] neg_lo:[0,1] neg_hi:[0,1]
  v_pk_add_f32 v[32:33], v[32:33], v[6:7] op_sel_hi:[1,0] neg_lo:[0,1] neg_hi:[0,1]
  v_pk_add_f32 v[34:35], v[34:35], v[6:7] op_sel_hi:[1,0] neg_lo:[0,1] neg_hi:[0,1]
  v_pk_add_f32 v[36:37], v[36:37], v[6:7] op_sel_hi:[1,0] neg_lo:[0,1] neg_hi:[0,1]
  v_pk_add_f32 v[38:39], v[38:39], v[6:7] op_sel_hi:[1,0] neg_lo:[0,1] neg_hi:[0,1]
  v_pk_add_f32 v[40:41], v[40:41], v[6:7] op_sel_hi:[1,0] neg_lo:[0,1] neg_hi:[0,1]
  v_pk_add_f32 v[42:43], v[42:43], v[6:7] op_sel_hi:[1,0] neg_lo:[0,1] neg_hi:[0,1]
  v_exp_f32 v24, v24
  v_exp_f32 v25, v25
  v_exp_f32 v26, v26
  v_exp_f32 v27, v27
  v_exp_f32 v28, v28
  v_exp_f32 v29, v29
  v_exp_f32 v30, v30
  v_exp_f32 v31, v31
  v_exp_f32 v32, v32
  v_exp_f32 v33, v33
  buffer_load_dwordx4 v[152:155], v21, s[4:7], s28 offen offset:2048 sc1
  v_exp_f32 v34, v34
  v_exp_f32 v35, v35
  v_exp_f32 v36, v36
  v_exp_f32 v37, v37
  v_exp_f32 v38, v38
  v_exp_f32 v39, v39
  v_exp_f32 v40, v40
  v_exp_f32 v41, v41
  v_exp_f32 v42, v42
  v_exp_f32 v43, v43
  v_pk_add_f32 v[16:17], v[24:25], v[26:27]
  v_pk_add_f32 v[16:17], v[16:17], v[28:29]
  v_pk_add_f32 v[16:17], v[16:17], v[30:31]
  v_pk_add_f32 v[16:17], v[16:17], v[32:33]
  v_pk_add_f32 v[16:17], v[16:17], v[34:35]
  v_pk_add_f32 v[16:17], v[16:17], v[36:37]
  v_pk_add_f32 v[16:17], v[16:17], v[38:39]
  v_pk_add_f32 v[16:17], v[16:17], v[40:41]
  v_pk_add_f32 v[16:17], v[16:17], v[42:43]
  v_add_f32 v16, v16, v17
  v_mov_b32 v17, v16
  buffer_load_dwordx4 v[156:159], v21, s[4:7], s28 offen offset:3072 sc1
  s_nop 0
  v_permlane32_swap_b32 v16, v17
  s_nop 1
  v_add_f32 v16, v16, v17
  v_rcp_f32 v6, v16
  s_nop 0
  v_pk_mul_f32 v[24:25], v[24:25], v[6:7] op_sel_hi:[1,0]
  v_pk_mul_f32 v[26:27], v[26:27], v[6:7] op_sel_hi:[1,0]
  v_pk_mul_f32 v[28:29], v[28:29], v[6:7] op_sel_hi:[1,0]
  v_pk_mul_f32 v[30:31], v[30:31], v[6:7] op_sel_hi:[1,0]
  v_pk_mul_f32 v[32:33], v[32:33], v[6:7] op_sel_hi:[1,0]
  v_pk_mul_f32 v[34:35], v[34:35], v[6:7] op_sel_hi:[1,0]
  v_pk_mul_f32 v[36:37], v[36:37], v[6:7] op_sel_hi:[1,0]
  v_pk_mul_f32 v[38:39], v[38:39], v[6:7] op_sel_hi:[1,0]
  v_pk_mul_f32 v[40:41], v[40:41], v[6:7] op_sel_hi:[1,0]
  v_pk_mul_f32 v[42:43], v[42:43], v[6:7] op_sel_hi:[1,0]
  v_cvt_pk_bf16_f32 v128, v24, v25
  v_cvt_pk_bf16_f32 v129, v26, v27
  v_cvt_pk_bf16_f32 v130, v28, v29
  v_cvt_pk_bf16_f32 v131, v30, v31
  v_cvt_pk_bf16_f32 v132, v32, v33
  v_cvt_pk_bf16_f32 v133, v34, v35
  v_cvt_pk_bf16_f32 v134, v36, v37
  v_cvt_pk_bf16_f32 v135, v38, v39
  v_cvt_pk_bf16_f32 v136, v40, v41
  v_cvt_pk_bf16_f32 v137, v42, v43
  s_waitcnt vmcnt(8) lgkmcnt(0)
  v_mfma_f32_32x32x16_bf16 v[64:79], v[208:211], v[128:131], 0
  s_add_u32 s29, s19, 50335744
  buffer_load_dwordx4 v[160:163], v21, s[4:7], s29 offen offset:0 sc1
  v_mfma_f32_32x32x16_bf16 v[64:79], v[212:215], v[132:135], v[64:79]
  v_mfma_f32_32x32x8_bf16 v[64:79], v[56:57], v[136:137], v[64:79]
  v_mfma_f32_32x32x16_bf16 v[80:95], v[216:219], v[128:131], 0
  buffer_load_dwordx4 v[164:167], v21, s[4:7], s29 offen offset:1024 sc1
  v_mfma_f32_32x32x16_bf16 v[80:95], v[220:223], v[132:135], v[80:95]
  v_cvt_pk_bf16_f32 v24, v64, v65
  v_cvt_pk_bf16_f32 v25, v66, v67
  v_cvt_pk_bf16_f32 v26, v68, v69
  v_cvt_pk_bf16_f32 v27, v70, v71
  v_mfma_f32_32x32x8_bf16 v[80:95], v[58:59], v[136:137], v[80:95]
  ds_write_b128 v3, v[24:27] offset:0
  v_cvt_pk_bf16_f32 v28, v72, v73
  v_cvt_pk_bf16_f32 v29, v74, v75
  v_cvt_pk_bf16_f32 v30, v76, v77
  v_cvt_pk_bf16_f32 v31, v78, v79
  v_mfma_f32_32x32x16_bf16 v[96:111], v[224:227], v[128:131], 0
  ds_write_b128 v3, v[28:31] offset:1024
  buffer_load_dwordx4 v[168:171], v21, s[4:7], s29 offen offset:2048 sc1
  v_mfma_f32_32x32x16_bf16 v[96:111], v[228:231], v[132:135], v[96:111]
  v_cvt_pk_bf16_f32 v32, v80, v81
  v_cvt_pk_bf16_f32 v33, v82, v83
  v_cvt_pk_bf16_f32 v34, v84, v85
  v_cvt_pk_bf16_f32 v35, v86, v87
  v_mfma_f32_32x32x8_bf16 v[96:111], v[60:61], v[136:137], v[96:111]
  ds_write_b128 v3, v[32:35] offset:2048
  v_cvt_pk_bf16_f32 v36, v88, v89
  v_cvt_pk_bf16_f32 v37, v90, v91
  v_cvt_pk_bf16_f32 v38, v92, v93
  v_cvt_pk_bf16_f32 v39, v94, v95
  v_mfma_f32_32x32x16_bf16 v[112:127], v[232:235], v[128:131], 0
  ds_write_b128 v3, v[36:39] offset:3072
  buffer_load_dwordx4 v[172:175], v21, s[4:7], s29 offen offset:3072 sc1
  v_mfma_f32_32x32x16_bf16 v[112:127], v[236:239], v[132:135], v[112:127]
  v_cvt_pk_bf16_f32 v40, v96, v97
  v_cvt_pk_bf16_f32 v41, v98, v99
  v_cvt_pk_bf16_f32 v42, v100, v101
  v_cvt_pk_bf16_f32 v43, v102, v103
  v_mfma_f32_32x32x8_bf16 v[112:127], v[62:63], v[136:137], v[112:127]
  ds_write_b128 v3, v[40:43] offset:4096
  v_cvt_pk_bf16_f32 v44, v104, v105
  v_cvt_pk_bf16_f32 v45, v106, v107
  v_cvt_pk_bf16_f32 v46, v108, v109
  v_cvt_pk_bf16_f32 v47, v110, v111
  ds_write_b128 v3, v[44:47] offset:5120
  s_nop 5
  v_cvt_pk_bf16_f32 v48, v112, v113
  v_cvt_pk_bf16_f32 v49, v114, v115
  v_cvt_pk_bf16_f32 v50, v116, v117
  v_cvt_pk_bf16_f32 v51, v118, v119
  ds_write_b128 v3, v[48:51] offset:6144
  v_cvt_pk_bf16_f32 v52, v120, v121
  v_cvt_pk_bf16_f32 v53, v122, v123
  v_cvt_pk_bf16_f32 v54, v124, v125
  v_cvt_pk_bf16_f32 v55, v126, v127
  ds_write_b128 v3, v[52:55] offset:7168
  s_waitcnt vmcnt(8)
  s_waitcnt lgkmcnt(0)
  s_barrier
  ds_read_b128 v[24:27], v8 offset:0
  ds_read_b128 v[28:31], v9 offset:0
  ds_read_b128 v[32:35], v10 offset:0
  ds_read_b128 v[36:39], v11 offset:0
  ds_read_b128 v[40:43], v12 offset:0
  ds_read_b128 v[44:47], v13 offset:0
  buffer_load_dword v23, off, s[4:7], s54 sc1
  v_mov_b32 v16, s30
  v_min_u32 v17, 1, v0
  v_lshlrev_b32 v17, 30, v17
  buffer_store_dword v16, v17, s[4:7], s31 offen sc1
  s_add_u32 s30, s30, 1
  s_add_u32 s52, s52, 2
  s_waitcnt lgkmcnt(5)
  v_mfma_f32_16x16x32_bf16 v[64:67], a[0:3], v[24:27], 0
  s_add_u32 s28, s19, 67108864
  ds_read_b128 v[48:51], v14 offset:0
  v_mfma_f32_16x16x32_bf16 v[68:71], a[4:7], v[24:27], 0
  v_mfma_f32_16x16x32_bf16 v[80:83], a[8:11], v[24:27], 0
  v_mfma_f32_16x16x32_bf16 v[84:87], a[12:15], v[24:27], 0
  s_waitcnt lgkmcnt(5)
  v_mfma_f32_16x16x32_bf16 v[72:75], a[0:3], v[28:31], 0
  ds_read_b128 v[52:55], v15 offset:0
  v_mfma_f32_16x16x32_bf16 v[76:79], a[4:7], v[28:31], 0
  v_mfma_f32_16x16x32_bf16 v[88:91], a[8:11], v[28:31], 0
  buffer_load_dwordx4 v[176:179], v21, s[4:7], s28 offen offset:0 sc1
  v_mfma_f32_16x16x32_bf16 v[92:95], a[12:15], v[28:31], 0
  s_waitcnt lgkmcnt(5)
  v_mfma_f32_16x16x32_bf16 v[64:67], a[16:19], v[32:35], v[64:67]
  ds_read_b128 v[24:27], v8 offset:8192
  v_mfma_f32_16x16x32_bf16 v[68:71], a[20:23], v[32:35], v[68:71]
  v_mfma_f32_16x16x32_bf16 v[80:83], a[24:27], v[32:35], v[80:83]
  v_mfma_f32_16x16x32_bf16 v[84:87], a[28:31], v[32:35], v[84:87]
  s_waitcnt lgkmcnt(5)
  v_mfma_f32_16x16x32_bf16 v[72:75], a[16:19], v[36:39], v[72:75]
  ds_read_b128 v[28:31], v9 offset:8192
  v_mfma_f32_16x16x32_bf16 v[76:79], a[20:23], v[36:39], v[76:79]
  v_mfma_f32_16x16x32_bf16 v[88:91], a[24:27], v[36:39], v[88:91]
  buffer_load_dwordx4 v[180:183], v21, s[4:7], s28 offen offset:1024 sc1
  v_mfma_f32_16x16x32_bf16 v[92:95], a[28:31], v[36:39], v[92:95]
  s_waitcnt lgkmcnt(5)
  v_mfma_f32_16x16x32_bf16 v[64:67], a[32:35], v[40:43], v[64:67]
  ds_read_b128 v[32:35], v10 offset:8192
  v_mfma_f32_16x16x32_bf16 v[68:71], a[36:39], v[40:43], v[68:71]
  v_mfma_f32_16x16x32_bf16 v[80:83], a[40:43], v[40:43], v[80:83]
  v_mfma_f32_16x16x32_bf16 v[84:87], a[44:47], v[40:43], v[84:87]
  s_waitcnt lgkmcnt(5)
  v_mfma_f32_16x16x32_bf16 v[72:75], a[32:35], v[44:47], v[72:75]
  ds_read_b128 v[36:39], v11 offset:8192
  v_mfma_f32_16x16x32_bf16 v[76:79], a[36:39], v[44:47], v[76:79]
  v_mfma_f32_16x16x32_bf16 v[88:91], a[40:43], v[44:47], v[88:91]
  buffer_load_dwordx4 v[184:187], v21, s[4:7], s28 offen offset:2048 sc1
  v_mfma_f32_16x16x32_bf16 v[92:95], a[44:47], v[44:47], v[92:95]
  s_waitcnt lgkmcnt(5)
  v_mfma_f32_16x16x32_bf16 v[64:67], a[48:51], v[48:51], v[64:67]
  ds_read_b128 v[40:43], v12 offset:8192
  v_mfma_f32_16x16x32_bf16 v[68:71], a[52:55], v[48:51], v[68:71]
  v_mfma_f32_16x16x32_bf16 v[80:83], a[56:59], v[48:51], v[80:83]
  v_mfma_f32_16x16x32_bf16 v[84:87], a[60:63], v[48:51], v[84:87]
  s_waitcnt lgkmcnt(5)
  v_mfma_f32_16x16x32_bf16 v[72:75], a[48:51], v[52:55], v[72:75]
  ds_read_b128 v[44:47], v13 offset:8192
  v_mfma_f32_16x16x32_bf16 v[76:79], a[52:55], v[52:55], v[76:79]
  v_mfma_f32_16x16x32_bf16 v[88:91], a[56:59], v[52:55], v[88:91]
  buffer_load_dwordx4 v[188:191], v21, s[4:7], s28 offen offset:3072 sc1
  v_mfma_f32_16x16x32_bf16 v[92:95], a[60:63], v[52:55], v[92:95]
  s_waitcnt lgkmcnt(5)
  v_mfma_f32_16x16x32_bf16 v[64:67], a[64:67], v[24:27], v[64:67]
  s_add_u32 s29, s19, 67112960
  ds_read_b128 v[48:51], v14 offset:8192
  v_mfma_f32_16x16x32_bf16 v[68:71], a[68:71], v[24:27], v[68:71]
  v_mfma_f32_16x16x32_bf16 v[80:83], a[72:75], v[24:27], v[80:83]
  v_mfma_f32_16x16x32_bf16 v[84:87], a[76:79], v[24:27], v[84:87]
  s_waitcnt lgkmcnt(5)
  v_mfma_f32_16x16x32_bf16 v[72:75], a[64:67], v[28:31], v[72:75]
  ds_read_b128 v[52:55], v15 offset:8192
  v_mfma_f32_16x16x32_bf16 v[76:79], a[68:71], v[28:31], v[76:79]
  v_mfma_f32_16x16x32_bf16 v[88:91], a[72:75], v[28:31], v[88:91]
  buffer_load_dwordx4 v[192:195], v21, s[4:7], s29 offen offset:0 sc1
  v_mfma_f32_16x16x32_bf16 v[92:95], a[76:79], v[28:31], v[92:95]
  s_waitcnt lgkmcnt(5)
  v_mfma_f32_16x16x32_bf16 v[64:67], a[80:83], v[32:35], v[64:67]
  ds_read_b128 v[24:27], v8 offset:16384
  v_mfma_f32_16x16x32_bf16 v[68:71], a[84:87], v[32:35], v[68:71]
  v_mfma_f32_16x16x32_bf16 v[80:83], a[88:91], v[32:35], v[80:83]
  v_mfma_f32_16x16x32_bf16 v[84:87], a[92:95], v[32:35], v[84:87]
  s_waitcnt lgkmcnt(5)
  v_mfma_f32_16x16x32_bf16 v[72:75], a[80:83], v[36:39], v[72:75]
  ds_read_b128 v[28:31], v9 offset:16384
  v_mfma_f32_16x16x32_bf16 v[76:79], a[84:87], v[36:39], v[76:79]
  v_mfma_f32_16x16x32_bf16 v[88:91], a[88:91], v[36:39], v[88:91]
  buffer_load_dwordx4 v[196:199], v21, s[4:7], s29 offen offset:1024 sc1
  v_mfma_f32_16x16x32_bf16 v[92:95], a[92:95], v[36:39], v[92:95]
  s_waitcnt lgkmcnt(5)
  v_mfma_f32_16x16x32_bf16 v[64:67], a[96:99], v[40:43], v[64:67]
  ds_read_b128 v[32:35], v10 offset:16384
  v_mfma_f32_16x16x32_bf16 v[68:71], a[100:103], v[40:43], v[68:71]
  v_mfma_f32_16x16x32_bf16 v[80:83], a[104:107], v[40:43], v[80:83]
  v_mfma_f32_16x16x32_bf16 v[84:87], a[108:111], v[40:43], v[84:87]
  s_waitcnt lgkmcnt(5)
  s_waitcnt vmcnt(7)
  v_readfirstlane_b32 s53, v23
  s_nop 0
  s_cmp_ge_u32 s53, s52
  s_cselect_b32 s24, 1, 0
  s_cbranch_scc0 F_nopre_75
  s_mov_b32 m0, s25
  s_nop 0
  buffer_load_dwordx4 v2, s[4:7], s20 offen offset:0 sc1 lds
  buffer_load_dwordx4 v2, s[4:7], s20 offen offset:1024 sc1 lds
  buffer_load_dwordx4 v2, s[4:7], s20 offen offset:2048 sc1 lds
  buffer_load_dwordx4 v2, s[4:7], s20 offen offset:3072 sc1 lds
F_nopre_75:
  v_mfma_f32_16x16x32_bf16 v[72:75], a[96:99], v[44:47], v[72:75]
  ds_read_b128 v[36:39], v11 offset:16384
  v_mfma_f32_16x16x32_bf16 v[76:79], a[100:103], v[44:47], v[76:79]
  v_mfma_f32_16x16x32_bf16 v[88:91], a[104:107], v[44:47], v[88:91]
  buffer_load_dwordx4 v[200:203], v21, s[4:7], s29 offen offset:2048 sc1
  v_mfma_f32_16x16x32_bf16 v[92:95], a[108:111], v[44:47], v[92:95]
  s_waitcnt lgkmcnt(5)
  v_mfma_f32_16x16x32_bf16 v[64:67], a[112:115], v[48:51], v[64:67]
  ds_read_b128 v[40:43], v12 offset:16384
  v_mfma_f32_16x16x32_bf16 v[68:71], a[116:119], v[48:51], v[68:71]
  v_mfma_f32_16x16x32_bf16 v[80:83], a[120:123], v[48:51], v[80:83]
  v_mfma_f32_16x16x32_bf16 v[84:87], a[124:127], v[48:51], v[84:87]
  s_waitcnt lgkmcnt(5)
  v_mfma_f32_16x16x32_bf16 v[72:75], a[112:115], v[52:55], v[72:75]
  ds_read_b128 v[44:47], v13 offset:16384
  v_mfma_f32_16x16x32_bf16 v[76:79], a[116:119], v[52:55], v[76:79]
  v_mfma_f32_16x16x32_bf16 v[88:91], a[120:123], v[52:55], v[88:91]
  buffer_load_dwordx4 v[204:207], v21, s[4:7], s29 offen offset:3072 sc1
  v_mfma_f32_16x16x32_bf16 v[92:95], a[124:127], v[52:55], v[92:95]
  s_waitcnt lgkmcnt(5)
  v_mfma_f32_16x16x32_bf16 v[64:67], a[128:131], v[24:27], v[64:67]
  s_add_u32 s28, s19, 83886080
  ds_read_b128 v[48:51], v14 offset:16384
  v_mfma_f32_16x16x32_bf16 v[68:71], a[132:135], v[24:27], v[68:71]
  v_mfma_f32_16x16x32_bf16 v[80:83], a[136:139], v[24:27], v[80:83]
  v_mfma_f32_16x16x32_bf16 v[84:87], a[140:143], v[24:27], v[84:87]
  s_waitcnt lgkmcnt(5)
  v_mfma_f32_16x16x32_bf16 v[72:75], a[128:131], v[28:31], v[72:75]
  ds_read_b128 v[52:55], v15 offset:16384
  v_mfma_f32_16x16x32_bf16 v[76:79], a[132:135], v[28:31], v[76:79]
  v_mfma_f32_16x16x32_bf16 v[88:91], a[136:139], v[28:31], v[88:91]
  buffer_load_dwordx4 v[208:211], v21, s[4:7], s28 offen offset:0 sc1
  v_mfma_f32_16x16x32_bf16 v[92:95], a[140:143], v[28:31], v[92:95]
  s_waitcnt lgkmcnt(5)
  v_mfma_f32_16x16x32_bf16 v[64:67], a[144:147], v[32:35], v[64:67]
  ds_read_b128 v[24:27], v8 offset:24576
  v_mfma_f32_16x16x32_bf16 v[68:71], a[148:151], v[32:35], v[68:71]
  v_mfma_f32_16x16x32_bf16 v[80:83], a[152:155], v[32:35], v[80:83]
  v_mfma_f32_16x16x32_bf16 v[84:87], a[156:159], v[32:35], v[84:87]
  s_waitcnt lgkmcnt(5)
  v_mfma_f32_16x16x32_bf16 v[72:75], a[144:147], v[36:39], v[72:75]
  ds_read_b128 v[28:31], v9 offset:24576
  v_mfma_f32_16x16x32_bf16 v[76:79], a[148:151], v[36:39], v[76:79]
  v_mfma_f32_16x16x32_bf16 v[88:91], a[152:155], v[36:39], v[88:91]
  buffer_load_dwordx4 v[212:215], v21, s[4:7], s28 offen offset:1024 sc1
  v_mfma_f32_16x16x32_bf16 v[92:95], a[156:159], v[36:39], v[92:95]
  s_waitcnt lgkmcnt(5)
  v_mfma_f32_16x16x32_bf16 v[64:67], a[160:163], v[40:43], v[64:67]
  ds_read_b128 v[32:35], v10 offset:24576
  v_mfma_f32_16x16x32_bf16 v[68:71], a[164:167], v[40:43], v[68:71]
  v_mfma_f32_16x16x32_bf16 v[80:83], a[168:171], v[40:43], v[80:83]
  v_mfma_f32_16x16x32_bf16 v[84:87], a[172:175], v[40:43], v[84:87]
  s_waitcnt lgkmcnt(5)
  v_mfma_f32_16x16x32_bf16 v[72:75], a[160:163], v[44:47], v[72:75]
  ds_read_b128 v[36:39], v11 offset:24576
  v_mfma_f32_16x16x32_bf16 v[76:79], a[164:167], v[44:47], v[76:79]
  v_mfma_f32_16x16x32_bf16 v[88:91], a[168:171], v[44:47], v[88:91]
  buffer_load_dwordx4 v[216:219], v21, s[4:7], s28 offen offset:2048 sc1
  v_mfma_f32_16x16x32_bf16 v[92:95], a[172:175], v[44:47], v[92:95]
  s_waitcnt lgkmcnt(5)
  v_mfma_f32_16x16x32_bf16 v[64:67], a[176:179], v[48:51], v[64:67]
  ds_read_b128 v[40:43], v12 offset:24576
  v_mfma_f32_16x16x32_bf16 v[68:71], a[180:183], v[48:51], v[68:71]
  v_mfma_f32_16x16x32_bf16 v[80:83], a[184:187], v[48:51], v[80:83]
  v_mfma_f32_16x16x32_bf16 v[84:87], a[188:191], v[48:51], v[84:87]
  s_waitcnt lgkmcnt(5)
  v_mfma_f32_16x16x32_bf16 v[72:75], a[176:179], v[52:55], v[72:75]
  ds_read_b128 v[44:47], v13 offset:24576
  v_mfma_f32_16x16x32_bf16 v[76:79], a[180:183], v[52:55], v[76:79]
  v_mfma_f32_16x16x32_bf16 v[88:91], a[184:187], v[52:55], v[88:91]
  buffer_load_dwordx4 v[220:223], v21, s[4:7], s28 offen offset:3072 sc1
  v_mfma_f32_16x16x32_bf16 v[92:95], a[188:191], v[52:55], v[92:95]
  s_waitcnt lgkmcnt(5)
  v_mfma_f32_16x16x32_bf16 v[64:67], a[192:195], v[24:27], v[64:67]
  s_add_u32 s29, s19, 83890176
  ds_read_b128 v[48:51], v14 offset:24576
  v_mfma_f32_16x16x32_bf16 v[68:71], a[196:199], v[24:27], v[68:71]
  v_mfma_f32_16x16x32_bf16 v[80:83], a[200:203], v[24:27], v[80:83]
  v_mfma_f32_16x16x32_bf16 v[84:87], a[204:207], v[24:27], v[84:87]
  s_waitcnt lgkmcnt(5)
  v_mfma_f32_16x16x32_bf16 v[72:75], a[192:195], v[28:31], v[72:75]
  ds_read_b128 v[52:55], v15 offset:24576
  v_mfma_f32_16x16x32_bf16 v[76:79], a[196:199], v[28:31], v[76:79]
  v_mfma_f32_16x16x32_bf16 v[88:91], a[200:203], v[28:31], v[88:91]
  buffer_load_dwordx4 v[224:227], v21, s[4:7], s29 offen offset:0 sc1
  v_mfma_f32_16x16x32_bf16 v[92:95], a[204:207], v[28:31], v[92:95]
  s_waitcnt lgkmcnt(5)
  v_mfma_f32_16x16x32_bf16 v[64:67], a[208:211], v[32:35], v[64:67]
  v_mfma_f32_16x16x32_bf16 v[68:71], a[212:215], v[32:35], v[68:71]
  v_mfma_f32_16x16x32_bf16 v[80:83], a[216:219], v[32:35], v[80:83]
  v_mfma_f32_16x16x32_bf16 v[84:87], a[220:223], v[32:35], v[84:87]
  s_waitcnt lgkmcnt(4)
  v_mfma_f32_16x16x32_bf16 v[72:75], a[208:211], v[36:39], v[72:75]
  v_mfma_f32_16x16x32_bf16 v[76:79], a[212:215], v[36:39], v[76:79]
  v_xor_b32 v8, 0x8000, v8
  v_mfma_f32_16x16x32_bf16 v[88:91], a[216:219], v[36:39], v[88:91]
  buffer_load_dwordx4 v[228:231], v21, s[4:7], s29 offen offset:1024 sc1
  v_mfma_f32_16x16x32_bf16 v[92:95], a[220:223], v[36:39], v[92:95]
  s_waitcnt lgkmcnt(3)
  v_xor_b32 v9, 0x8000, v9
  v_mfma_f32_16x16x32_bf16 v[64:67], a[224:227], v[40:43], v[64:67]
  v_mfma_f32_16x16x32_bf16 v[68:71], a[228:231], v[40:43], v[68:71]
  v_xor_b32 v10, 0x8000, v10
  v_mfma_f32_16x16x32_bf16 v[80:83], a[232:235], v[40:43], v[80:83]
  v_mfma_f32_16x16x32_bf16 v[84:87], a[236:239], v[40:43], v[84:87]
  s_waitcnt lgkmcnt(2)
  v_xor_b32 v11, 0x8000, v11
  v_mfma_f32_16x16x32_bf16 v[72:75], a[224:227], v[44:47], v[72:75]
  v_mfma_f32_16x16x32_bf16 v[76:79], a[228:231], v[44:47], v[76:79]
  v_xor_b32 v12, 0x8000, v12
  v_mfma_f32_16x16x32_bf16 v[88:91], a[232:235], v[44:47], v[88:91]
  buffer_load_dwordx4 v[232:235], v21, s[4:7], s29 offen offset:2048 sc1
  v_mfma_f32_16x16x32_bf16 v[92:95], a[236:239], v[44:47], v[92:95]
  s_waitcnt lgkmcnt(1)
  v_xor_b32 v13, 0x8000, v13
  v_mfma_f32_16x16x32_bf16 v[64:67], a[240:243], v[48:51], v[64:67]
  v_mfma_f32_16x16x32_bf16 v[68:71], a[244:247], v[48:51], v[68:71]
  v_xor_b32 v14, 0x8000, v14
  v_mfma_f32_16x16x32_bf16 v[80:83], a[248:251], v[48:51], v[80:83]
  v_mfma_f32_16x16x32_bf16 v[84:87], a[252:255], v[48:51], v[84:87]
  s_waitcnt lgkmcnt(0)
  v_xor_b32 v15, 0x8000, v15
  v_mfma_f32_16x16x32_bf16 v[72:75], a[240:243], v[52:55], v[72:75]
  v_mfma_f32_16x16x32_bf16 v[76:79], a[244:247], v[52:55], v[76:79]
  v_xor_b32 v3, 0x8000, v3
  v_mfma_f32_16x16x32_bf16 v[88:91], a[248:251], v[52:55], v[88:91]
  buffer_load_dwordx4 v[236:239], v21, s[4:7], s29 offen offset:3072 sc1
  v_mfma_f32_16x16x32_bf16 v[92:95], a[252:255], v[52:55], v[92:95]
  s_cmp_gt_u32 s23, 0
  s_cbranch_scc1 F_top_58
  s_nop 2
  v_cvt_pk_bf16_f32 v128, v64, v65
  v_cvt_pk_bf16_f32 v129, v66, v67
  v_cvt_pk_bf16_f32 v130, v68, v69
  v_cvt_pk_bf16_f32 v131, v70, v71
  buffer_store_dwordx4 v[128:131], v22, s[4:7], s21 offen offset:0 sc1
  v_cvt_pk_bf16_f32 v132, v72, v73
  v_cvt_pk_bf16_f32 v133, v74, v75
  v_cvt_pk_bf16_f32 v134, v76, v77
  v_cvt_pk_bf16_f32 v135, v78, v79
  buffer_store_dwordx4 v[132:135], v22, s[4:7], s21 offen offset:256 sc1
  v_cvt_pk_bf16_f32 v136, v80, v81
  v_cvt_pk_bf16_f32 v137, v82, v83
  v_cvt_pk_bf16_f32 v138, v84, v85
  v_cvt_pk_bf16_f32 v139, v86, v87
  buffer_store_dwordx4 v[136:139], v22, s[4:7], s21 offen offset:2048 sc1
  v_cvt_pk_bf16_f32 v140, v88, v89
  v_cvt_pk_bf16_f32 v141, v90, v91
  v_cvt_pk_bf16_f32 v142, v92, v93
  v_cvt_pk_bf16_f32 v143, v94, v95
  buffer_store_dwordx4 v[140:143], v22, s[4:7], s21 offen offset:2304 sc1
  s_waitcnt vmcnt(0) lgkmcnt(0)
  s_barrier
  v_mov_b32 v144, s30
  v_min_u32 v145, 1, v0
  v_lshlrev_b32 v145, 30, v145
  buffer_store_dword v144, v145, s[4:7], s31 offen sc1
  s_branch M_done
M_team:
  s_mov_b32 s12, s77
  s_load_dwordx4 s[60:63], s[0:1], 64
  s_load_dwordx4 s[64:67], s[0:1], 80
  s_load_dwordx4 s[68:71], s[0:1], 120
  s_load_dwordx2 s[72:73], s[0:1], 56
  v_lshrrev_b32 v1, 6, v0
  v_and_b32 v20, 63, v0
  v_readfirstlane_b32 s13, v1
  s_waitcnt lgkmcnt(0)
  s_mov_b32 s8, s60
  s_and_b32 s9, s61, 0xffff
  s_mov_b32 s10, 0x400000
  s_mov_b32 s11, 0x20000
  s_mov_b32 s40, s62
  s_and_b32 s41, s63, 0xffff
  s_mov_b32 s42, 0x400000
  s_mov_b32 s43, 0x20000
  s_mov_b32 s44, s64
  s_and_b32 s45, s65, 0xffff
  s_mov_b32 s46, 0x400000
  s_mov_b32 s47, 0x20000
  s_mov_b32 s48, s66
  s_and_b32 s49, s67, 0xffff
  s_mov_b32 s50, 0x400000
  s_mov_b32 s51, 0x20000
  s_mov_b32 s4, s70
  s_and_b32 s5, s71, 0xffff
  s_mov_b32 s6, 0x10000000
  s_mov_b32 s7, 0x20000
  s_mov_b32 s76, s72
  s_and_b32 s77, s73, 0xffff
  s_mov_b32 s78, 0x2000
  s_mov_b32 s79, 0x20000
  s_mov_b32 s72, s68
  s_and_b32 s73, s69, 0xffff
  s_mov_b32 s74, 0x100
  s_mov_b32 s75, 0x20000
  s_mov_b64 s[52:53], s[68:69]
  s_mov_b64 s[58:59], s[70:71]
  s_mul_i32 s99, s12, 896
  s_add_u32 s99, s99, 148898048
  s_lshl_b32 s15, s12, 7
  s_add_u32 s15, s15, 148926464
  v_lshrrev_b32 v21, 4, v20
  v_and_b32 v22, 15, v20
  v_and_b32 v23, 1, v21
  v_lshrrev_b32 v24, 1, v21
  v_lshlrev_b32 v2, 4, v20
  s_lshl_b32 s36, s13, 10
  v_add_u32 v59, s36, v2
  s_lshl_b32 s37, s13, 15
  s_add_u32 s37, s37, 32768
  v_add_u32 v4, s37, v2
  v_lshrrev_b32 v25, 2, v20
  v_lshlrev_b32 v25, 13, v25
  v_and_b32 v1, 3, v20
  v_lshl_add_u32 v25, v1, 4, v25
  s_lshl_b32 s36, s13, 6
  s_lshl_b32 s38, s12, 8
  s_add_u32 s36, s36, s38
  v_add_u32 v25, s36, v25
  v_lshrrev_b32 v26, 3, v20
  v_lshlrev_b32 v26, 10, v26
  v_and_b32 v1, 7, v20
  v_lshl_add_u32 v26, v1, 4, v26
  s_lshl_b32 s36, s13, 7
  s_lshl_b32 s38, s12, 17
  s_add_u32 s36, s36, s38
  v_add_u32 v26, s36, v26
  v_bfe_u32 v29, v20, 2, 1
  v_bfe_u32 v30, v20, 3, 1
  v_and_b32 v31, 3, v20
  v_lshl_add_u32 v27, v21, 2, v29
  v_lshlrev_b32 v27, 6, v27
  v_lshl_add_u32 v27, v30, 5, v27
  v_lshl_add_u32 v27, v31, 3, v27
  v_add_u32 v27, s37, v27
  v_xor_b32 v36, 1, v30
  v_lshl_add_u32 v36, v36, 11, v27
  v_lshl_add_u32 v27, v30, 11, v27
  v_lshl_add_u32 v28, v23, 2, v24
  v_lshl_add_u32 v28, v28, 2, v29
  v_lshlrev_b32 v28, 7, v28
  v_lshl_add_u32 v28, v30, 6, v28
  v_lshl_add_u32 v28, v31, 4, v28
  v_add_u32 v28, s37, v28
  s_mov_b32 s39, s37
  s_xor_b32 s36, s13, 0
  s_lshl_b32 s36, s36, 15
  s_add_u32 m0, s39, 0
  s_add_u32 s37, s36, 0
  buffer_load_dwordx4 v26, s[48:51], s37 offen lds
  s_add_u32 m0, s39, 1024
  s_add_u32 s37, s36, 8192
  buffer_load_dwordx4 v26, s[48:51], s37 offen lds
  s_add_u32 m0, s39, 2048
  s_add_u32 s37, s36, 16384
  buffer_load_dwordx4 v26, s[48:51], s37 offen lds
  s_add_u32 m0, s39, 3072
  s_add_u32 s37, s36, 24576
  buffer_load_dwordx4 v26, s[48:51], s37 offen lds
  s_xor_b32 s36, s13, 0
  s_lshl_b32 s36, s36, 15
  s_add_u32 m0, s39, 4096
  s_add_u32 s37, s36, 512
  buffer_load_dwordx4 v26, s[48:51], s37 offen lds
  s_add_u32 m0, s39, 5120
  s_add_u32 s37, s36, 8704
  buffer_load_dwordx4 v26, s[48:51], s37 offen lds
  s_add_u32 m0, s39, 6144
  s_add_u32 s37, s36, 16896
  buffer_load_dwordx4 v26, s[48:51], s37 offen lds
  s_add_u32 m0, s39, 7168
  s_add_u32 s37, s36, 25088
  buffer_load_dwordx4 v26, s[48:51], s37 offen lds
  v_mov_b32 v0, 0x4444
  v_mov_b32 v1, 0xeeee
  v_cmp_lt_u32 vcc, 7, v22
  s_nop 1
  v_cndmask_b32 v32, v0, v1, vcc
  v_mov_b32 v0, v32
  v_and_b32 v32, 7, v20
  v_lshlrev_b32 v32, 4, v32
  v_lshl_add_u32 v11, v21, 7, v32
  v_xor_b32 v1, 128, v2
  v_lshl_add_u32 v33, v24, 4, v22
  s_lshl_b32 s36, s13, 5
  v_add_u32 v33, s36, v33
  v_lshlrev_b32 v33, 3, v33
  v_mul_u32_u24 v34, 1152, v23
  v_add_u32 v5, v33, v34
  v_bfe_u32 v33, v20, 2, 2
  v_lshl_add_u32 v33, v23, 2, v33
  v_lshl_add_u32 v33, v24, 4, v33
  v_lshlrev_b32 v33, 3, v33
  v_and_b32 v34, 1, v20
  v_mul_u32_u24 v34, 1152, v34
  v_add_u32 v6, v33, v34
  s_lshl_b32 s36, s13, 3
  v_lshrrev_b32 v33, 3, v20
  v_add_u32 v33, s36, v33
  v_mul_u32_u24 v34, 0, v33
  v_add_u32 v34, s12, v34
  v_and_b32 v34, 31, v34
  v_lshrrev_b32 v37, 1, v32
  v_lshl_add_u32 v33, v33, 13, v37
  v_lshl_add_u32 v7, v34, 7, v33
  v_and_b32 v37, 1, v20
  v_bfe_u32 v38, v20, 1, 1
  v_lshl_add_u32 v37, v29, 1, v37
  s_lshr_b32 s36, s12, 3
  s_lshl_b32 s36, s36, 10
  s_and_b32 s37, s12, 1
  s_lshl_b32 s37, s37, 9
  s_add_u32 s36, s36, s37
  s_and_b32 s37, s12, 6
  s_lshl_b32 s37, s37, 5
  s_add_u32 s36, s36, s37
  v_lshlrev_b32 v33, 4, v21
  v_lshl_add_u32 v33, v37, 2, v33
  v_lshl_add_u32 v33, v38, 8, v33
  v_lshl_add_u32 v33, v30, 30, v33
  v_add_u32 v8, s36, v33
  v_mov_b32 v3, v2
  v_mov_b32 v39, v21
  s_lshr_b32 s36, s12, 2
  s_lshl_b32 s36, s36, 6
  s_and_b32 s37, s12, 1
  s_lshl_b32 s37, s37, 5
  s_add_u32 s36, s36, s37
  s_and_b32 s37, s12, 2
  s_lshl_b32 s37, s37, 11
  s_add_u32 s36, s36, s37
  v_lshlrev_b32 v35, 10, v39
  v_lshl_add_u32 v35, v37, 2, v35
  v_lshl_add_u32 v35, v38, 4, v35
  v_add_u32 v35, s36, v35
  buffer_load_ushort v44, v35, s[76:79], 0 offen offset:0
  buffer_load_ushort v45, v35, s[76:79], 0 offen offset:2
  buffer_load_ushort v46, v35, s[76:79], 0 offen offset:512
  buffer_load_ushort v47, v35, s[76:79], 0 offen offset:514
  v_lshlrev_b32 v33, 4, v29
  v_mov_b32 v34, 0x3f80
  v_lshlrev_b32 v33, v33, v34
  v_and_b32 v34, 1, v20
  v_lshl_add_u32 v34, v34, 1, v30
  v_cmp_eq_u32 vcc, 0, v34
  s_nop 1
  v_cndmask_b32 v48, 0, v33, vcc
  v_cmp_eq_u32 vcc, 1, v34
  s_nop 1
  v_cndmask_b32 v49, 0, v33, vcc
  v_cmp_eq_u32 vcc, 2, v34
  s_nop 1
  v_cndmask_b32 v50, 0, v33, vcc
  v_cmp_eq_u32 vcc, 3, v34
  s_nop 1
  v_cndmask_b32 v51, 0, v33, vcc
  ds_write_b128 v2, v[48:51] offset:31232
  v_lshlrev_b32 v33, 9, v21
  s_lshl_b32 s36, s13, 11
  v_add_u32 v33, s36, v33
  v_lshl_add_u32 v10, v22, 4, v33
  v_lshl_add_u32 v33, v30, 8, v33
  v_add_u32 v9, v33, v32
  v_mov_b32 v12, 0x3f803f80
  v_mov_b32 v13, 0x3f803f80
  v_mov_b32 v14, 0x3f803f80
  v_mov_b32 v15, 0x3f803f80
  s_mov_b32 s2, 0x3f803f80
  s_mov_b32 s3, 0x3f803f80
  s_mov_b32 s98, 0
  v_and_b32 v33, 1, v20
  v_mul_u32_u24 v33, 128, v33
  v_min_u32 v34, 1, v20
  v_lshlrev_b32 v34, 30, v34
  s_cmp_eq_u32 s13, 3
  s_cselect_b64 vcc, -1, 0
  v_cndmask_b32 v19, v34, v33, vcc
  v_mov_b64 v[60:61], 0
  v_mov_b32 v62, 32256
  ds_write_b64 v62, v[60:61]
  s_mov_b32 s16, 0
  s_mov_b32 s17, -1
  s_mov_b32 s18, 0x3e0293ee
  s_mov_b32 s54, 0x2f800000
  s_mov_b32 s55, 0x28000000
  s_lshl_b32 s36, s13, 10
  s_add_u32 s31, s36, 8192
  s_add_u32 s32, s36, 12160
  s_add_u32 s33, s36, 16384
  s_add_u32 s34, s36, 20224
  s_lshl_b32 s36, s12, 19
  s_add_u32 s27, s36, 67108864
  s_add_u32 s28, s36, 83886080
  s_mul_i32 s36, s12, 4096
  s_add_u32 s29, s36, 135266304
  s_lshl_b32 s36, s12, 13
  s_add_u32 s22, s36, 144703488
  s_add_u32 s23, s36, 144707584
  s_mov_b32 s20, 144703488
  s_mov_b32 s21, 144707584
  v_mov_b32 v40, -1
  v_mov_b32 v41, -1
  v_mov_b32 v42, -1
  v_mov_b32 v43, -1
  s_lshl_b32 s36, s13, 13
  s_add_u32 s36, s36, 145752064
  s_add_u32 s37, s36, 4096
  buffer_store_dwordx4 v[40:43], v59, s[4:7], s22 offen sc1
  buffer_store_dwordx4 v[40:43], v59, s[4:7], s23 offen sc1
  buffer_store_dword v40, v8, s[4:7], s36 offen sc1
  buffer_store_dword v40, v8, s[4:7], s37 offen sc1
  v_mov_b32 v52, 0
  v_min_u32 v53, 1, v59
  v_lshlrev_b32 v53, 30, v53
  buffer_store_dword v52, v53, s[4:7], s15 offen sc1
  s_xor_b32 s36, s13, 1
  s_lshl_b32 s36, s36, 15
  s_add_u32 m0, s39, 8192
  s_add_u32 s37, s36, 0
  buffer_load_dwordx4 v26, s[48:51], s37 offen lds
  s_add_u32 m0, s39, 9216
  s_add_u32 s37, s36, 8192
  buffer_load_dwordx4 v26, s[48:51], s37 offen lds
  s_add_u32 m0, s39, 10240
  s_add_u32 s37, s36, 16384
  buffer_load_dwordx4 v26, s[48:51], s37 offen lds
  s_add_u32 m0, s39, 11264
  s_add_u32 s37, s36, 24576
  buffer_load_dwordx4 v26, s[48:51], s37 offen lds
  s_xor_b32 s36, s13, 1
  s_lshl_b32 s36, s36, 15
  s_add_u32 m0, s39, 12288
  s_add_u32 s37, s36, 512
  buffer_load_dwordx4 v26, s[48:51], s37 offen lds
  s_add_u32 m0, s39, 13312
  s_add_u32 s37, s36, 8704
  buffer_load_dwordx4 v26, s[48:51], s37 offen lds
  s_add_u32 m0, s39, 14336
  s_add_u32 s37, s36, 16896
  buffer_load_dwordx4 v26, s[48:51], s37 offen lds
  s_add_u32 m0, s39, 15360
  s_add_u32 s37, s36, 25088
  buffer_load_dwordx4 v26, s[48:51], s37 offen lds
  s_waitcnt vmcnt(21)
  ds_read_b64_tr_b16 a[160:161], v28 offset:0
  ds_read_b64_tr_b16 a[162:163], v28 offset:256
  ds_read_b64_tr_b16 a[164:165], v28 offset:1024
  ds_read_b64_tr_b16 a[166:167], v28 offset:1280
  ds_read_b64_tr_b16 a[168:169], v28 offset:8
  ds_read_b64_tr_b16 a[170:171], v28 offset:264
  ds_read_b64_tr_b16 a[172:173], v28 offset:1032
  ds_read_b64_tr_b16 a[174:175], v28 offset:1288
  s_waitcnt lgkmcnt(0)
  s_xor_b32 s36, s13, 2
  s_lshl_b32 s36, s36, 15
  s_add_u32 m0, s39, 0
  s_add_u32 s37, s36, 0
  buffer_load_dwordx4 v26, s[48:51], s37 offen lds
  s_add_u32 m0, s39, 1024
  s_add_u32 s37, s36, 8192
  buffer_load_dwordx4 v26, s[48:51], s37 offen lds
  s_add_u32 m0, s39, 2048
  s_add_u32 s37, s36, 16384
  buffer_load_dwordx4 v26, s[48:51], s37 offen lds
  s_add_u32 m0, s39, 3072
  s_add_u32 s37, s36, 24576
  buffer_load_dwordx4 v26, s[48:51], s37 offen lds
  s_waitcnt vmcnt(21)
  ds_read_b64_tr_b16 a[176:177], v28 offset:4096
  ds_read_b64_tr_b16 a[178:179], v28 offset:4352
  ds_read_b64_tr_b16 a[180:181], v28 offset:5120
  ds_read_b64_tr_b16 a[182:183], v28 offset:5376
  ds_read_b64_tr_b16 a[184:185], v28 offset:4104
  ds_read_b64_tr_b16 a[186:187], v28 offset:4360
  ds_read_b64_tr_b16 a[188:189], v28 offset:5128
  ds_read_b64_tr_b16 a[190:191], v28 offset:5384
  s_waitcnt lgkmcnt(0)
  s_xor_b32 s36, s13, 3
  s_lshl_b32 s36, s36, 15
  s_add_u32 m0, s39, 4096
  s_add_u32 s37, s36, 0
  buffer_load_dwordx4 v26, s[48:51], s37 offen lds
  s_add_u32 m0, s39, 5120
  s_add_u32 s37, s36, 8192
  buffer_load_dwordx4 v26, s[48:51], s37 offen lds
  s_add_u32 m0, s39, 6144
  s_add_u32 s37, s36, 16384
  buffer_load_dwordx4 v26, s[48:51], s37 offen lds
  s_add_u32 m0, s39, 7168
  s_add_u32 s37, s36, 24576
  buffer_load_dwordx4 v26, s[48:51], s37 offen lds
  s_waitcnt vmcnt(12)
  ds_read_b64_tr_b16 a[192:193], v28 offset:8192
  ds_read_b64_tr_b16 a[194:195], v28 offset:8448
  ds_read_b64_tr_b16 a[196:197], v28 offset:9216
  ds_read_b64_tr_b16 a[198:199], v28 offset:9472
  ds_read_b64_tr_b16 a[200:201], v28 offset:8200
  ds_read_b64_tr_b16 a[202:203], v28 offset:8456
  ds_read_b64_tr_b16 a[204:205], v28 offset:9224
  ds_read_b64_tr_b16 a[206:207], v28 offset:9480
  s_waitcnt lgkmcnt(0)
  s_xor_b32 s36, s13, 2
  s_lshl_b32 s36, s36, 19
  s_add_u32 m0, s39, 8192
  s_add_u32 s37, s36, 0
  buffer_load_dwordx4 v25, s[8:11], s37 offen lds
  s_add_u32 m0, s39, 9216
  s_add_u32 s37, s36, 131072
  buffer_load_dwordx4 v25, s[8:11], s37 offen lds
  s_add_u32 m0, s39, 10240
  s_add_u32 s37, s36, 262144
  buffer_load_dwordx4 v25, s[8:11], s37 offen lds
  s_add_u32 m0, s39, 11264
  s_add_u32 s37, s36, 393216
  buffer_load_dwordx4 v25, s[8:11], s37 offen lds
  s_barrier
  s_cmp_lg_u32 s13, 0
  s_cbranch_scc1 T_arm_76
  s_getreg_b32 s36, hwreg(HW_REG_XCC_ID, 0, 3)
  s_lshl_b32 s36, s36, 3
  s_lshl_b64 s[60:61], 1, s36
  s_mov_b32 s62, 1
  s_atomic_add_x2 s[60:61], s[52:53], 0
  s_atomic_add s62, s[52:53], 128
  v_lshl_or_b32 v44, v45, 16, v44
  v_lshl_or_b32 v46, v47, 16, v46
  v_min_u32 v44, -2, v44
  v_min_u32 v46, -2, v46
  s_mov_b32 s36, 145752064
  s_mov_b32 s37, 145756160
  buffer_store_dword v44, v8, s[4:7], s36 offen sc1
  buffer_store_dword v46, v8, s[4:7], s37 offen sc1
T_arm_76:
  s_waitcnt vmcnt(12)
  ds_read_b64_tr_b16 a[208:209], v28 offset:12288
  ds_read_b64_tr_b16 a[210:211], v28 offset:12544
  ds_read_b64_tr_b16 a[212:213], v28 offset:13312
  ds_read_b64_tr_b16 a[214:215], v28 offset:13568
  ds_read_b64_tr_b16 a[216:217], v28 offset:12296
  ds_read_b64_tr_b16 a[218:219], v28 offset:12552
  ds_read_b64_tr_b16 a[220:221], v28 offset:13320
  ds_read_b64_tr_b16 a[222:223], v28 offset:13576
  s_waitcnt lgkmcnt(0)
  s_xor_b32 s36, s13, 3
  s_lshl_b32 s36, s36, 19
  s_add_u32 m0, s39, 12288
  s_add_u32 s37, s36, 0
  buffer_load_dwordx4 v25, s[8:11], s37 offen lds
  s_add_u32 m0, s39, 13312
  s_add_u32 s37, s36, 131072
  buffer_load_dwordx4 v25, s[8:11], s37 offen lds
  s_add_u32 m0, s39, 14336
  s_add_u32 s37, s36, 262144
  buffer_load_dwordx4 v25, s[8:11], s37 offen lds
  s_add_u32 m0, s39, 15360
  s_add_u32 s37, s36, 393216
  buffer_load_dwordx4 v25, s[8:11], s37 offen lds
  s_waitcnt vmcnt(12)
  ds_read_b64_tr_b16 a[224:225], v28 offset:0
  ds_read_b64_tr_b16 a[226:227], v28 offset:256
  ds_read_b64_tr_b16 a[228:229], v28 offset:1024
  ds_read_b64_tr_b16 a[230:231], v28 offset:1280
  ds_read_b64_tr_b16 a[232:233], v28 offset:8
  ds_read_b64_tr_b16 a[234:235], v28 offset:264
  ds_read_b64_tr_b16 a[236:237], v28 offset:1032
  ds_read_b64_tr_b16 a[238:239], v28 offset:1288
  s_waitcnt lgkmcnt(0)
  s_xor_b32 s36, s13, 4
  s_lshl_b32 s36, s36, 19
  s_add_u32 m0, s39, 0
  s_add_u32 s37, s36, 0
  buffer_load_dwordx4 v25, s[8:11], s37 offen lds
  s_add_u32 m0, s39, 1024
  s_add_u32 s37, s36, 131072
  buffer_load_dwordx4 v25, s[8:11], s37 offen lds
  s_add_u32 m0, s39, 2048
  s_add_u32 s37, s36, 262144
  buffer_load_dwordx4 v25, s[8:11], s37 offen lds
  s_add_u32 m0, s39, 3072
  s_add_u32 s37, s36, 393216
  buffer_load_dwordx4 v25, s[8:11], s37 offen lds
  s_waitcnt vmcnt(12)
  ds_read_b64_tr_b16 a[240:241], v28 offset:4096
  ds_read_b64_tr_b16 a[242:243], v28 offset:4352
  ds_read_b64_tr_b16 a[244:245], v28 offset:5120
  ds_read_b64_tr_b16 a[246:247], v28 offset:5376
  ds_read_b64_tr_b16 a[248:249], v28 offset:4104
  ds_read_b64_tr_b16 a[250:251], v28 offset:4360
  ds_read_b64_tr_b16 a[252:253], v28 offset:5128
  ds_read_b64_tr_b16 a[254:255], v28 offset:5384
  s_waitcnt lgkmcnt(0)
  s_xor_b32 s36, s13, 5
  s_lshl_b32 s36, s36, 19
  s_add_u32 m0, s39, 4096
  s_add_u32 s37, s36, 0
  buffer_load_dwordx4 v25, s[8:11], s37 offen lds
  s_add_u32 m0, s39, 5120
  s_add_u32 s37, s36, 131072
  buffer_load_dwordx4 v25, s[8:11], s37 offen lds
  s_add_u32 m0, s39, 6144
  s_add_u32 s37, s36, 262144
  buffer_load_dwordx4 v25, s[8:11], s37 offen lds
  s_add_u32 m0, s39, 7168
  s_add_u32 s37, s36, 393216
  buffer_load_dwordx4 v25, s[8:11], s37 offen lds
  s_waitcnt vmcnt(12)
  ds_read_b64_tr_b16 v[160:161], v27 offset:8192
  ds_read_b64_tr_b16 v[162:163], v27 offset:8320
  ds_read_b64_tr_b16 v[164:165], v27 offset:9216
  ds_read_b64_tr_b16 v[166:167], v27 offset:9344
  ds_read_b64_tr_b16 v[168:169], v36 offset:8192
  ds_read_b64_tr_b16 v[170:171], v36 offset:8320
  ds_read_b64_tr_b16 v[172:173], v36 offset:9216
  ds_read_b64_tr_b16 v[174:175], v36 offset:9344
  s_waitcnt lgkmcnt(0)
  s_xor_b32 s36, s13, 4
  s_lshl_b32 s36, s36, 19
  s_add_u32 m0, s39, 8192
  s_add_u32 s37, s36, 0
  buffer_load_dwordx4 v25, s[40:43], s37 offen lds
  s_add_u32 m0, s39, 9216
  s_add_u32 s37, s36, 131072
  buffer_load_dwordx4 v25, s[40:43], s37 offen lds
  s_add_u32 m0, s39, 10240
  s_add_u32 s37, s36, 262144
  buffer_load_dwordx4 v25, s[40:43], s37 offen lds
  s_add_u32 m0, s39, 11264
  s_add_u32 s37, s36, 393216
  buffer_load_dwordx4 v25, s[40:43], s37 offen lds
  s_waitcnt vmcnt(12)
  ds_read_b64_tr_b16 v[192:193], v27 offset:12288
  ds_read_b64_tr_b16 v[194:195], v27 offset:12416
  ds_read_b64_tr_b16 v[196:197], v27 offset:13312
  ds_read_b64_tr_b16 v[198:199], v27 offset:13440
  ds_read_b64_tr_b16 v[200:201], v36 offset:12288
  ds_read_b64_tr_b16 v[202:203], v36 offset:12416
  ds_read_b64_tr_b16 v[204:205], v36 offset:13312
  ds_read_b64_tr_b16 v[206:207], v36 offset:13440
  s_waitcnt lgkmcnt(0)
  s_xor_b32 s36, s13, 5
  s_lshl_b32 s36, s36, 19
  s_add_u32 m0, s39, 12288
  s_add_u32 s37, s36, 0
  buffer_load_dwordx4 v25, s[40:43], s37 offen lds
  s_add_u32 m0, s39, 13312
  s_add_u32 s37, s36, 131072
  buffer_load_dwordx4 v25, s[40:43], s37 offen lds
  s_add_u32 m0, s39, 14336
  s_add_u32 s37, s36, 262144
  buffer_load_dwordx4 v25, s[40:43], s37 offen lds
  s_add_u32 m0, s39, 15360
  s_add_u32 s37, s36, 393216
  buffer_load_dwordx4 v25, s[40:43], s37 offen lds
  s_waitcnt vmcnt(12)
  ds_read_b64_tr_b16 v[224:225], v27 offset:0
  ds_read_b64_tr_b16 v[226:227], v27 offset:128
  ds_read_b64_tr_b16 v[228:229], v27 offset:1024
  ds_read_b64_tr_b16 v[230:231], v27 offset:1152
  ds_read_b64_tr_b16 v[232:233], v36 offset:0
  ds_read_b64_tr_b16 v[234:235], v36 offset:128
  ds_read_b64_tr_b16 v[236:237], v36 offset:1024
  ds_read_b64_tr_b16 v[238:239], v36 offset:1152
  s_waitcnt lgkmcnt(0)
  s_xor_b32 s36, s13, 4
  s_lshl_b32 s36, s36, 19
  s_add_u32 m0, s39, 0
  s_add_u32 s37, s36, 0
  buffer_load_dwordx4 v25, s[44:47], s37 offen lds
  s_add_u32 m0, s39, 1024
  s_add_u32 s37, s36, 131072
  buffer_load_dwordx4 v25, s[44:47], s37 offen lds
  s_add_u32 m0, s39, 2048
  s_add_u32 s37, s36, 262144
  buffer_load_dwordx4 v25, s[44:47], s37 offen lds
  s_add_u32 m0, s39, 3072
  s_add_u32 s37, s36, 393216
  buffer_load_dwordx4 v25, s[44:47], s37 offen lds
  s_waitcnt vmcnt(12)
  ds_read_b64_tr_b16 a[16:17], v27 offset:4096
  ds_read_b64_tr_b16 a[18:19], v27 offset:4224
  ds_read_b64_tr_b16 a[20:21], v27 offset:5120
  ds_read_b64_tr_b16 a[22:23], v27 offset:5248
  ds_read_b64_tr_b16 a[24:25], v36 offset:4096
  ds_read_b64_tr_b16 a[26:27], v36 offset:4224
  ds_read_b64_tr_b16 a[28:29], v36 offset:5120
  ds_read_b64_tr_b16 a[30:31], v36 offset:5248
  s_waitcnt lgkmcnt(0)
  s_xor_b32 s36, s13, 5
  s_lshl_b32 s36, s36, 19
  s_add_u32 m0, s39, 4096
  s_add_u32 s37, s36, 0
  buffer_load_dwordx4 v25, s[44:47], s37 offen lds
  s_add_u32 m0, s39, 5120
  s_add_u32 s37, s36, 131072
  buffer_load_dwordx4 v25, s[44:47], s37 offen lds
  s_add_u32 m0, s39, 6144
  s_add_u32 s37, s36, 262144
  buffer_load_dwordx4 v25, s[44:47], s37 offen lds
  s_add_u32 m0, s39, 7168
  s_add_u32 s37, s36, 393216
  buffer_load_dwordx4 v25, s[44:47], s37 offen lds
  s_waitcnt vmcnt(12)
  ds_read_b64_tr_b16 v[240:241], v27 offset:8192
  ds_read_b64_tr_b16 v[242:243], v27 offset:8320
  ds_read_b64_tr_b16 v[244:245], v27 offset:9216
  ds_read_b64_tr_b16 v[246:247], v27 offset:9344
  ds_read_b64_tr_b16 v[248:249], v36 offset:8192
  ds_read_b64_tr_b16 v[250:251], v36 offset:8320
  ds_read_b64_tr_b16 v[252:253], v36 offset:9216
  ds_read_b64_tr_b16 v[254:255], v36 offset:9344
  s_waitcnt lgkmcnt(0)
  s_xor_b32 s36, s13, 6
  s_lshl_b32 s36, s36, 19
  s_add_u32 m0, s39, 8192
  s_add_u32 s37, s36, 0
  buffer_load_dwordx4 v25, s[8:11], s37 offen lds
  s_add_u32 m0, s39, 9216
  s_add_u32 s37, s36, 131072
  buffer_load_dwordx4 v25, s[8:11], s37 offen lds
  s_add_u32 m0, s39, 10240
  s_add_u32 s37, s36, 262144
  buffer_load_dwordx4 v25, s[8:11], s37 offen lds
  s_add_u32 m0, s39, 11264
  s_add_u32 s37, s36, 393216
  buffer_load_dwordx4 v25, s[8:11], s37 offen lds
  s_waitcnt vmcnt(12)
  ds_read_b64_tr_b16 a[32:33], v27 offset:12288
  ds_read_b64_tr_b16 a[34:35], v27 offset:12416
  ds_read_b64_tr_b16 a[36:37], v27 offset:13312
  ds_read_b64_tr_b16 a[38:39], v27 offset:13440
  ds_read_b64_tr_b16 a[40:41], v36 offset:12288
  ds_read_b64_tr_b16 a[42:43], v36 offset:12416
  ds_read_b64_tr_b16 a[44:45], v36 offset:13312
  ds_read_b64_tr_b16 a[46:47], v36 offset:13440
  s_waitcnt lgkmcnt(0)
  s_xor_b32 s36, s13, 7
  s_lshl_b32 s36, s36, 19
  s_add_u32 m0, s39, 12288
  s_add_u32 s37, s36, 0
  buffer_load_dwordx4 v25, s[8:11], s37 offen lds
  s_add_u32 m0, s39, 13312
  s_add_u32 s37, s36, 131072
  buffer_load_dwordx4 v25, s[8:11], s37 offen lds
  s_add_u32 m0, s39, 14336
  s_add_u32 s37, s36, 262144
  buffer_load_dwordx4 v25, s[8:11], s37 offen lds
  s_add_u32 m0, s39, 15360
  s_add_u32 s37, s36, 393216
  buffer_load_dwordx4 v25, s[8:11], s37 offen lds
  s_waitcnt vmcnt(12)
  ds_read_b64_tr_b16 a[0:1], v27 offset:0
  ds_read_b64_tr_b16 a[2:3], v27 offset:128
  ds_read_b64_tr_b16 a[4:5], v27 offset:1024
  ds_read_b64_tr_b16 a[6:7], v27 offset:1152
  ds_read_b64_tr_b16 a[8:9], v36 offset:0
  ds_read_b64_tr_b16 a[10:11], v36 offset:128
  ds_read_b64_tr_b16 a[12:13], v36 offset:1024
  ds_read_b64_tr_b16 a[14:15], v36 offset:1152
  s_waitcnt lgkmcnt(0)
  s_xor_b32 s36, s13, 6
  s_lshl_b32 s36, s36, 19
  s_add_u32 m0, s39, 0
  s_add_u32 s37, s36, 0
  buffer_load_dwordx4 v25, s[40:43], s37 offen lds
  s_add_u32 m0, s39, 1024
  s_add_u32 s37, s36, 131072
  buffer_load_dwordx4 v25, s[40:43], s37 offen lds
  s_add_u32 m0, s39, 2048
  s_add_u32 s37, s36, 262144
  buffer_load_dwordx4 v25, s[40:43], s37 offen lds
  s_add_u32 m0, s39, 3072
  s_add_u32 s37, s36, 393216
  buffer_load_dwordx4 v25, s[40:43], s37 offen lds
  s_waitcnt vmcnt(12)
  ds_read_b64_tr_b16 a[48:49], v27 offset:4096
  ds_read_b64_tr_b16 a[50:51], v27 offset:4224
  ds_read_b64_tr_b16 a[52:53], v27 offset:5120
  ds_read_b64_tr_b16 a[54:55], v27 offset:5248
  ds_read_b64_tr_b16 a[56:57], v36 offset:4096
  ds_read_b64_tr_b16 a[58:59], v36 offset:4224
  ds_read_b64_tr_b16 a[60:61], v36 offset:5120
  ds_read_b64_tr_b16 a[62:63], v36 offset:5248
  s_waitcnt lgkmcnt(0)
  s_xor_b32 s36, s13, 7
  s_lshl_b32 s36, s36, 19
  s_add_u32 m0, s39, 4096
  s_add_u32 s37, s36, 0
  buffer_load_dwordx4 v25, s[40:43], s37 offen lds
  s_add_u32 m0, s39, 5120
  s_add_u32 s37, s36, 131072
  buffer_load_dwordx4 v25, s[40:43], s37 offen lds
  s_add_u32 m0, s39, 6144
  s_add_u32 s37, s36, 262144
  buffer_load_dwordx4 v25, s[40:43], s37 offen lds
  s_add_u32 m0, s39, 7168
  s_add_u32 s37, s36, 393216
  buffer_load_dwordx4 v25, s[40:43], s37 offen lds
  s_waitcnt vmcnt(12)
  ds_read_b64_tr_b16 a[64:65], v27 offset:8192
  ds_read_b64_tr_b16 a[66:67], v27 offset:8320
  ds_read_b64_tr_b16 a[68:69], v27 offset:9216
  ds_read_b64_tr_b16 a[70:71], v27 offset:9344
  ds_read_b64_tr_b16 a[72:73], v36 offset:8192
  ds_read_b64_tr_b16 a[74:75], v36 offset:8320
  ds_read_b64_tr_b16 a[76:77], v36 offset:9216
  ds_read_b64_tr_b16 a[78:79], v36 offset:9344
  s_waitcnt lgkmcnt(0)
  s_xor_b32 s36, s13, 6
  s_lshl_b32 s36, s36, 19
  s_add_u32 m0, s39, 8192
  s_add_u32 s37, s36, 0
  buffer_load_dwordx4 v25, s[44:47], s37 offen lds
  s_add_u32 m0, s39, 9216
  s_add_u32 s37, s36, 131072
  buffer_load_dwordx4 v25, s[44:47], s37 offen lds
  s_add_u32 m0, s39, 10240
  s_add_u32 s37, s36, 262144
  buffer_load_dwordx4 v25, s[44:47], s37 offen lds
  s_add_u32 m0, s39, 11264
  s_add_u32 s37, s36, 393216
  buffer_load_dwordx4 v25, s[44:47], s37 offen lds
  s_waitcnt vmcnt(12)
  ds_read_b64_tr_b16 a[112:113], v27 offset:12288
  ds_read_b64_tr_b16 a[114:115], v27 offset:12416
  ds_read_b64_tr_b16 a[116:117], v27 offset:13312
  ds_read_b64_tr_b16 a[118:119], v27 offset:13440
  ds_read_b64_tr_b16 a[120:121], v36 offset:12288
  ds_read_b64_tr_b16 a[122:123], v36 offset:12416
  ds_read_b64_tr_b16 a[124:125], v36 offset:13312
  ds_read_b64_tr_b16 a[126:127], v36 offset:13440
  s_waitcnt lgkmcnt(0)
  s_xor_b32 s36, s13, 7
  s_lshl_b32 s36, s36, 19
  s_add_u32 m0, s39, 12288
  s_add_u32 s37, s36, 0
  buffer_load_dwordx4 v25, s[44:47], s37 offen lds
  s_add_u32 m0, s39, 13312
  s_add_u32 s37, s36, 131072
  buffer_load_dwordx4 v25, s[44:47], s37 offen lds
  s_add_u32 m0, s39, 14336
  s_add_u32 s37, s36, 262144
  buffer_load_dwordx4 v25, s[44:47], s37 offen lds
  s_add_u32 m0, s39, 15360
  s_add_u32 s37, s36, 393216
  buffer_load_dwordx4 v25, s[44:47], s37 offen lds
  s_waitcnt vmcnt(12)
  ds_read_b64_tr_b16 a[80:81], v27 offset:0
  ds_read_b64_tr_b16 a[82:83], v27 offset:128
  ds_read_b64_tr_b16 a[84:85], v27 offset:1024
  ds_read_b64_tr_b16 a[86:87], v27 offset:1152
  ds_read_b64_tr_b16 a[88:89], v36 offset:0
  ds_read_b64_tr_b16 a[90:91], v36 offset:128
  ds_read_b64_tr_b16 a[92:93], v36 offset:1024
  ds_read_b64_tr_b16 a[94:95], v36 offset:1152
  s_waitcnt lgkmcnt(0)
  s_xor_b32 s36, s13, 1
  s_lshl_b32 s36, s36, 19
  s_add_u32 m0, s39, 16384
  s_add_u32 s37, s36, 0
  buffer_load_dwordx4 v25, s[8:11], s37 offen lds
  s_add_u32 m0, s39, 17408
  s_add_u32 s37, s36, 131072
  buffer_load_dwordx4 v25, s[8:11], s37 offen lds
  s_add_u32 m0, s39, 18432
  s_add_u32 s37, s36, 262144
  buffer_load_dwordx4 v25, s[8:11], s37 offen lds
  s_add_u32 m0, s39, 19456
  s_add_u32 s37, s36, 393216
  buffer_load_dwordx4 v25, s[8:11], s37 offen lds
  s_waitcnt vmcnt(12)
  ds_read_b64_tr_b16 a[128:129], v27 offset:4096
  ds_read_b64_tr_b16 a[130:131], v27 offset:4224
  ds_read_b64_tr_b16 a[132:133], v27 offset:5120
  ds_read_b64_tr_b16 a[134:135], v27 offset:5248
  ds_read_b64_tr_b16 a[136:137], v36 offset:4096
  ds_read_b64_tr_b16 a[138:139], v36 offset:4224
  ds_read_b64_tr_b16 a[140:141], v36 offset:5120
  ds_read_b64_tr_b16 a[142:143], v36 offset:5248
  s_waitcnt lgkmcnt(0)
  s_xor_b32 s36, s13, 0
  s_lshl_b32 s36, s36, 19
  s_add_u32 m0, s39, 0
  s_add_u32 s37, s36, 0
  buffer_load_dwordx4 v25, s[8:11], s37 offen lds
  s_add_u32 m0, s39, 1024
  s_add_u32 s37, s36, 131072
  buffer_load_dwordx4 v25, s[8:11], s37 offen lds
  s_add_u32 m0, s39, 2048
  s_add_u32 s37, s36, 262144
  buffer_load_dwordx4 v25, s[8:11], s37 offen lds
  s_add_u32 m0, s39, 3072
  s_add_u32 s37, s36, 393216
  buffer_load_dwordx4 v25, s[8:11], s37 offen lds
  s_waitcnt vmcnt(12)
  ds_read_b64_tr_b16 a[96:97], v27 offset:8192
  ds_read_b64_tr_b16 a[98:99], v27 offset:8320
  ds_read_b64_tr_b16 a[100:101], v27 offset:9216
  ds_read_b64_tr_b16 a[102:103], v27 offset:9344
  ds_read_b64_tr_b16 a[104:105], v36 offset:8192
  ds_read_b64_tr_b16 a[106:107], v36 offset:8320
  ds_read_b64_tr_b16 a[108:109], v36 offset:9216
  ds_read_b64_tr_b16 a[110:111], v36 offset:9344
  s_waitcnt lgkmcnt(0)
  s_xor_b32 s36, s13, 1
  s_lshl_b32 s36, s36, 19
  s_add_u32 m0, s39, 8192
  s_add_u32 s37, s36, 0
  buffer_load_dwordx4 v25, s[40:43], s37 offen lds
  s_add_u32 m0, s39, 9216
  s_add_u32 s37, s36, 131072
  buffer_load_dwordx4 v25, s[40:43], s37 offen lds
  s_add_u32 m0, s39, 10240
  s_add_u32 s37, s36, 262144
  buffer_load_dwordx4 v25, s[40:43], s37 offen lds
  s_add_u32 m0, s39, 11264
  s_add_u32 s37, s36, 393216
  buffer_load_dwordx4 v25, s[40:43], s37 offen lds
  s_waitcnt vmcnt(12)
  ds_read_b64_tr_b16 a[144:145], v27 offset:12288
  ds_read_b64_tr_b16 a[146:147], v27 offset:12416
  ds_read_b64_tr_b16 a[148:149], v27 offset:13312
  ds_read_b64_tr_b16 a[150:151], v27 offset:13440
  ds_read_b64_tr_b16 a[152:153], v36 offset:12288
  ds_read_b64_tr_b16 a[154:155], v36 offset:12416
  ds_read_b64_tr_b16 a[156:157], v36 offset:13312
  ds_read_b64_tr_b16 a[158:159], v36 offset:13440
  s_waitcnt lgkmcnt(0)
  s_xor_b32 s36, s13, 0
  s_lshl_b32 s36, s36, 19
  s_add_u32 m0, s39, 4096
  s_add_u32 s37, s36, 0
  buffer_load_dwordx4 v25, s[40:43], s37 offen lds
  s_add_u32 m0, s39, 5120
  s_add_u32 s37, s36, 131072
  buffer_load_dwordx4 v25, s[40:43], s37 offen lds
  s_add_u32 m0, s39, 6144
  s_add_u32 s37, s36, 262144
  buffer_load_dwordx4 v25, s[40:43], s37 offen lds
  s_add_u32 m0, s39, 7168
  s_add_u32 s37, s36, 393216
  buffer_load_dwordx4 v25, s[40:43], s37 offen lds
  s_waitcnt vmcnt(12)
  ds_read_b64_tr_b16 v[128:129], v27 offset:16384
  ds_read_b64_tr_b16 v[130:131], v27 offset:16512
  ds_read_b64_tr_b16 v[132:133], v27 offset:17408
  ds_read_b64_tr_b16 v[134:135], v27 offset:17536
  ds_read_b64_tr_b16 v[136:137], v36 offset:16384
  ds_read_b64_tr_b16 v[138:139], v36 offset:16512
  ds_read_b64_tr_b16 v[140:141], v36 offset:17408
  ds_read_b64_tr_b16 v[142:143], v36 offset:17536
  s_waitcnt lgkmcnt(0)
  s_xor_b32 s36, s13, 2
  s_lshl_b32 s36, s36, 19
  s_add_u32 m0, s39, 12288
  s_add_u32 s37, s36, 0
  buffer_load_dwordx4 v25, s[40:43], s37 offen lds
  s_add_u32 m0, s39, 13312
  s_add_u32 s37, s36, 131072
  buffer_load_dwordx4 v25, s[40:43], s37 offen lds
  s_add_u32 m0, s39, 14336
  s_add_u32 s37, s36, 262144
  buffer_load_dwordx4 v25, s[40:43], s37 offen lds
  s_add_u32 m0, s39, 15360
  s_add_u32 s37, s36, 393216
  buffer_load_dwordx4 v25, s[40:43], s37 offen lds
  s_waitcnt vmcnt(12)
  ds_read_b64_tr_b16 v[64:65], v27 offset:0
  ds_read_b64_tr_b16 v[66:67], v27 offset:128
  ds_read_b64_tr_b16 v[68:69], v27 offset:1024
  ds_read_b64_tr_b16 v[70:71], v27 offset:1152
  ds_read_b64_tr_b16 v[72:73], v36 offset:0
  ds_read_b64_tr_b16 v[74:75], v36 offset:128
  ds_read_b64_tr_b16 v[76:77], v36 offset:1024
  ds_read_b64_tr_b16 v[78:79], v36 offset:1152
  s_waitcnt lgkmcnt(0)
  ds_write_b128 v4, v[64:67] offset:0
  ds_write_b128 v4, v[68:71] offset:1024
  ds_write_b128 v4, v[72:75] offset:2048
  ds_write_b128 v4, v[76:79] offset:3072
  s_waitcnt lgkmcnt(0)
  s_xor_b32 s36, s13, 3
  s_lshl_b32 s36, s36, 19
  s_add_u32 m0, s39, 16384
  s_add_u32 s37, s36, 0
  buffer_load_dwordx4 v25, s[40:43], s37 offen lds
  s_add_u32 m0, s39, 17408
  s_add_u32 s37, s36, 131072
  buffer_load_dwordx4 v25, s[40:43], s37 offen lds
  s_add_u32 m0, s39, 18432
  s_add_u32 s37, s36, 262144
  buffer_load_dwordx4 v25, s[40:43], s37 offen lds
  s_add_u32 m0, s39, 19456
  s_add_u32 s37, s36, 393216
  buffer_load_dwordx4 v25, s[40:43], s37 offen lds
  s_waitcnt vmcnt(12)
  ds_read_b64_tr_b16 v[144:145], v27 offset:8192
  ds_read_b64_tr_b16 v[146:147], v27 offset:8320
  ds_read_b64_tr_b16 v[148:149], v27 offset:9216
  ds_read_b64_tr_b16 v[150:151], v27 offset:9344
  ds_read_b64_tr_b16 v[152:153], v36 offset:8192
  ds_read_b64_tr_b16 v[154:155], v36 offset:8320
  ds_read_b64_tr_b16 v[156:157], v36 offset:9216
  ds_read_b64_tr_b16 v[158:159], v36 offset:9344
  s_waitcnt lgkmcnt(0)
  s_xor_b32 s36, s13, 3
  s_lshl_b32 s36, s36, 19
  s_add_u32 m0, s39, 24576
  s_add_u32 s37, s36, 0
  buffer_load_dwordx4 v25, s[44:47], s37 offen lds
  s_add_u32 m0, s39, 25600
  s_add_u32 s37, s36, 131072
  buffer_load_dwordx4 v25, s[44:47], s37 offen lds
  s_add_u32 m0, s39, 26624
  s_add_u32 s37, s36, 262144
  buffer_load_dwordx4 v25, s[44:47], s37 offen lds
  s_add_u32 m0, s39, 27648
  s_add_u32 s37, s36, 393216
  buffer_load_dwordx4 v25, s[44:47], s37 offen lds
  buffer_load_dwordx2 v[54:55], off, s[72:75], 0 sc1
  buffer_load_dword v56, off, s[72:75], 0 offset:128 sc1
  s_waitcnt vmcnt(14)
  ds_read_b64_tr_b16 v[64:65], v27 offset:4096
  ds_read_b64_tr_b16 v[66:67], v27 offset:4224
  ds_read_b64_tr_b16 v[68:69], v27 offset:5120
  ds_read_b64_tr_b16 v[70:71], v27 offset:5248
  ds_read_b64_tr_b16 v[72:73], v36 offset:4096
  ds_read_b64_tr_b16 v[74:75], v36 offset:4224
  ds_read_b64_tr_b16 v[76:77], v36 offset:5120
  ds_read_b64_tr_b16 v[78:79], v36 offset:5248
  s_waitcnt lgkmcnt(0)
  ds_write_b128 v4, v[64:67] offset:4096
  ds_write_b128 v4, v[68:71] offset:5120
  ds_write_b128 v4, v[72:75] offset:6144
  ds_write_b128 v4, v[76:79] offset:7168
  s_waitcnt lgkmcnt(0)
  s_xor_b32 s36, s13, 2
  s_lshl_b32 s36, s36, 19
  s_add_u32 m0, s39, 20480
  s_add_u32 s37, s36, 0
  buffer_load_dwordx4 v25, s[44:47], s37 offen lds
  s_add_u32 m0, s39, 21504
  s_add_u32 s37, s36, 131072
  buffer_load_dwordx4 v25, s[44:47], s37 offen lds
  s_add_u32 m0, s39, 22528
  s_add_u32 s37, s36, 262144
  buffer_load_dwordx4 v25, s[44:47], s37 offen lds
  s_add_u32 m0, s39, 23552
  s_add_u32 s37, s36, 393216
  buffer_load_dwordx4 v25, s[44:47], s37 offen lds
  s_waitcnt vmcnt(14)
  ds_read_b64_tr_b16 v[176:177], v27 offset:12288
  ds_read_b64_tr_b16 v[178:179], v27 offset:12416
  ds_read_b64_tr_b16 v[180:181], v27 offset:13312
  ds_read_b64_tr_b16 v[182:183], v27 offset:13440
  ds_read_b64_tr_b16 v[184:185], v36 offset:12288
  ds_read_b64_tr_b16 v[186:187], v36 offset:12416
  ds_read_b64_tr_b16 v[188:189], v36 offset:13312
  ds_read_b64_tr_b16 v[190:191], v36 offset:13440
  s_waitcnt lgkmcnt(0)
  s_xor_b32 s36, s13, 0
  s_lshl_b32 s36, s36, 19
  s_add_u32 m0, s39, 8192
  s_add_u32 s37, s36, 0
  buffer_load_dwordx4 v25, s[44:47], s37 offen lds
  s_add_u32 m0, s39, 9216
  s_add_u32 s37, s36, 131072
  buffer_load_dwordx4 v25, s[44:47], s37 offen lds
  s_add_u32 m0, s39, 10240
  s_add_u32 s37, s36, 262144
  buffer_load_dwordx4 v25, s[44:47], s37 offen lds
  s_add_u32 m0, s39, 11264
  s_add_u32 s37, s36, 393216
  buffer_load_dwordx4 v25, s[44:47], s37 offen lds
  s_waitcnt vmcnt(14)
  ds_read_b64_tr_b16 v[64:65], v27 offset:16384
  ds_read_b64_tr_b16 v[66:67], v27 offset:16512
  ds_read_b64_tr_b16 v[68:69], v27 offset:17408
  ds_read_b64_tr_b16 v[70:71], v27 offset:17536
  ds_read_b64_tr_b16 v[72:73], v36 offset:16384
  ds_read_b64_tr_b16 v[74:75], v36 offset:16512
  ds_read_b64_tr_b16 v[76:77], v36 offset:17408
  ds_read_b64_tr_b16 v[78:79], v36 offset:17536
  s_waitcnt lgkmcnt(0)
  ds_write_b128 v4, v[64:67] offset:16384
  ds_write_b128 v4, v[68:71] offset:17408
  ds_write_b128 v4, v[72:75] offset:18432
  ds_write_b128 v4, v[76:79] offset:19456
  s_waitcnt lgkmcnt(0)
  s_xor_b32 s36, s13, 1
  s_lshl_b32 s36, s36, 19
  s_add_u32 m0, s39, 12288
  s_add_u32 s37, s36, 0
  buffer_load_dwordx4 v25, s[44:47], s37 offen lds
  s_add_u32 m0, s39, 13312
  s_add_u32 s37, s36, 131072
  buffer_load_dwordx4 v25, s[44:47], s37 offen lds
  s_add_u32 m0, s39, 14336
  s_add_u32 s37, s36, 262144
  buffer_load_dwordx4 v25, s[44:47], s37 offen lds
  s_add_u32 m0, s39, 15360
  s_add_u32 s37, s36, 393216
  buffer_load_dwordx4 v25, s[44:47], s37 offen lds
  s_waitcnt vmcnt(14)
  ds_read_b64_tr_b16 v[208:209], v27 offset:24576
  ds_read_b64_tr_b16 v[210:211], v27 offset:24704
  ds_read_b64_tr_b16 v[212:213], v27 offset:25600
  ds_read_b64_tr_b16 v[214:215], v27 offset:25728
  ds_read_b64_tr_b16 v[216:217], v36 offset:24576
  ds_read_b64_tr_b16 v[218:219], v36 offset:24704
  ds_read_b64_tr_b16 v[220:221], v36 offset:25600
  ds_read_b64_tr_b16 v[222:223], v36 offset:25728
  s_waitcnt lgkmcnt(0)
  s_xor_b32 s36, s13, 2
  s_lshl_b32 s36, s36, 15
  s_add_u32 m0, s39, 24576
  s_add_u32 s37, s36, 512
  buffer_load_dwordx4 v26, s[48:51], s37 offen lds
  s_add_u32 m0, s39, 25600
  s_add_u32 s37, s36, 8704
  buffer_load_dwordx4 v26, s[48:51], s37 offen lds
  s_add_u32 m0, s39, 26624
  s_add_u32 s37, s36, 16896
  buffer_load_dwordx4 v26, s[48:51], s37 offen lds
  s_add_u32 m0, s39, 27648
  s_add_u32 s37, s36, 25088
  buffer_load_dwordx4 v26, s[48:51], s37 offen lds
  s_waitcnt vmcnt(12)
  ds_read_b64_tr_b16 v[64:65], v27 offset:20480
  ds_read_b64_tr_b16 v[66:67], v27 offset:20608
  ds_read_b64_tr_b16 v[68:69], v27 offset:21504
  ds_read_b64_tr_b16 v[70:71], v27 offset:21632
  ds_read_b64_tr_b16 v[72:73], v36 offset:20480
  ds_read_b64_tr_b16 v[74:75], v36 offset:20608
  ds_read_b64_tr_b16 v[76:77], v36 offset:21504
  ds_read_b64_tr_b16 v[78:79], v36 offset:21632
  s_waitcnt lgkmcnt(0)
  ds_write_b128 v4, v[64:67] offset:20480
  ds_write_b128 v4, v[68:71] offset:21504
  ds_write_b128 v4, v[72:75] offset:22528
  ds_write_b128 v4, v[76:79] offset:23552
  s_waitcnt lgkmcnt(0)
  s_xor_b32 s36, s13, 3
  s_lshl_b32 s36, s36, 15
  s_add_u32 m0, s39, 28672
  s_add_u32 s37, s36, 512
  buffer_load_dwordx4 v26, s[48:51], s37 offen lds
  s_add_u32 m0, s39, 29696
  s_add_u32 s37, s36, 8704
  buffer_load_dwordx4 v26, s[48:51], s37 offen lds
  s_add_u32 m0, s39, 30720
  s_add_u32 s37, s36, 16896
  buffer_load_dwordx4 v26, s[48:51], s37 offen lds
  s_add_u32 m0, s39, 31744
  s_add_u32 s37, s36, 25088
  buffer_load_dwordx4 v26, s[48:51], s37 offen lds
  s_mov_b32 s19, 0
  s_branch T_arrgo_78
T_arr_77:
  s_add_u32 s19, s19, 1
  s_cmp_gt_u32 s19, 32768
  s_cbranch_scc1 M_exit
  buffer_load_dwordx2 v[54:55], off, s[72:75], 0 sc1
  buffer_load_dword v56, off, s[72:75], 0 offset:128 sc1
  s_waitcnt vmcnt(0)
T_arrgo_78:
  v_sad_u8 v57, v54, 0, 0
  v_sad_u8 v57, v55, 0, v57
  v_or_b32 v58, v54, v55
  v_cmp_gt_u32 vcc, 32, v57
  s_cbranch_vccnz T_arr_77
  v_cmp_gt_u32 vcc, 0x100, v56
  s_cbranch_vccnz T_arr_77
  v_readfirstlane_b32 s36, v58
  s_nop 0
  s_and_b32 s36, s36, 0x20202020
  s_cselect_b32 s56, 0, 1
  s_mov_b32 s14, -1
  s_mov_b32 s30, -1
  s_mov_b32 s19, 0
  s_branch T_kvok_80
T_kv_79:
  s_sleep 4
  s_add_u32 s19, s19, 1
  s_cmp_gt_u32 s19, 32768
  s_cbranch_scc1 M_exit
T_kvok_80:
  s_add_u32 s39, s99, 128
  s_mov_b32 s38, 0
  s_mov_b32 s37, 0
  s_atomic_or s38, s[58:59], s99 glc
  s_atomic_or s37, s[58:59], s39 glc
  s_waitcnt lgkmcnt(0)
  s_add_u32 s37, s37, 30
  s_cmp_ge_u32 s38, 30
  s_cselect_b32 s38, s37, s38
  s_cmp_ge_u32 s38, 64
  s_cselect_b32 s38, 100, s38
  s_sub_u32 s38, s38, 1
  s_max_i32 s30, s30, s38
  s_cmp_ge_i32 s14, s30
  s_cbranch_scc1 T_kv_79
  s_mov_b32 m0, s31
  s_nop 0
  buffer_load_dwordx4 v9, s[4:7], s27 offen sc1 lds
  s_mov_b32 m0, s32
  s_nop 0
  buffer_load_dwordx4 v9, s[4:7], s27 offen offset:128 sc1 lds
  s_mov_b32 m0, s33
  s_nop 0
  buffer_load_dwordx4 v10, s[4:7], s28 offen sc1 lds
  s_mov_b32 m0, s34
  s_nop 0
  buffer_load_dwordx4 v10, s[4:7], s28 offen offset:256 sc1 lds
  s_add_u32 s27, s27, 8192
  s_add_u32 s28, s28, 8192
  s_lshl_b32 s36, s12, 10
  s_add_u32 s36, s36, 145752064
  buffer_load_dwordx4 v[40:43], v2, s[4:7], s36 offen sc1
  s_waitcnt vmcnt(17)
  ds_read_b64_tr_b16 v[64:65], v27 offset:8192
  ds_read_b64_tr_b16 v[66:67], v27 offset:8320
  ds_read_b64_tr_b16 v[68:69], v27 offset:9216
  ds_read_b64_tr_b16 v[70:71], v27 offset:9344
  ds_read_b64_tr_b16 v[72:73], v36 offset:8192
  ds_read_b64_tr_b16 v[74:75], v36 offset:8320
  ds_read_b64_tr_b16 v[76:77], v36 offset:9216
  ds_read_b64_tr_b16 v[78:79], v36 offset:9344
  s_waitcnt lgkmcnt(0)
  ds_write_b128 v4, v[64:67] offset:8192
  ds_write_b128 v4, v[68:71] offset:9216
  ds_write_b128 v4, v[72:75] offset:10240
  ds_write_b128 v4, v[76:79] offset:11264
  s_waitcnt lgkmcnt(0)
  s_waitcnt vmcnt(13)
  ds_read_b64_tr_b16 v[64:65], v27 offset:12288
  ds_read_b64_tr_b16 v[66:67], v27 offset:12416
  ds_read_b64_tr_b16 v[68:69], v27 offset:13312
  ds_read_b64_tr_b16 v[70:71], v27 offset:13440
  ds_read_b64_tr_b16 v[72:73], v36 offset:12288
  ds_read_b64_tr_b16 v[74:75], v36 offset:12416
  ds_read_b64_tr_b16 v[76:77], v36 offset:13312
  ds_read_b64_tr_b16 v[78:79], v36 offset:13440
  s_waitcnt lgkmcnt(0)
  ds_write_b128 v4, v[64:67] offset:12288
  ds_write_b128 v4, v[68:71] offset:13312
  ds_write_b128 v4, v[72:75] offset:14336
  ds_write_b128 v4, v[76:79] offset:15360
  s_waitcnt lgkmcnt(0)
  s_waitcnt vmcnt(9)
  ds_read_b64_tr_b16 v[64:65], v28 offset:24576
  ds_read_b64_tr_b16 v[66:67], v28 offset:24832
  ds_read_b64_tr_b16 v[68:69], v28 offset:25600
  ds_read_b64_tr_b16 v[70:71], v28 offset:25856
  ds_read_b64_tr_b16 v[72:73], v28 offset:24584
  ds_read_b64_tr_b16 v[74:75], v28 offset:24840
  ds_read_b64_tr_b16 v[76:77], v28 offset:25608
  ds_read_b64_tr_b16 v[78:79], v28 offset:25864
  s_waitcnt lgkmcnt(0)
  ds_write_b128 v4, v[64:67] offset:24576
  ds_write_b128 v4, v[68:71] offset:25600
  ds_write_b128 v4, v[72:75] offset:26624
  ds_write_b128 v4, v[76:79] offset:27648
  s_waitcnt lgkmcnt(0)
  s_waitcnt vmcnt(5)
  ds_read_b64_tr_b16 v[64:65], v28 offset:28672
  ds_read_b64_tr_b16 v[66:67], v28 offset:28928
  ds_read_b64_tr_b16 v[68:69], v28 offset:29696
  ds_read_b64_tr_b16 v[70:71], v28 offset:29952
  ds_read_b64_tr_b16 v[72:73], v28 offset:28680
  ds_read_b64_tr_b16 v[74:75], v28 offset:28936
  ds_read_b64_tr_b16 v[76:77], v28 offset:29704
  ds_read_b64_tr_b16 v[78:79], v28 offset:29960
  s_waitcnt lgkmcnt(0)
  ds_write_b128 v4, v[64:67] offset:28672
  ds_write_b128 v4, v[68:71] offset:29696
  ds_write_b128 v4, v[72:75] offset:30720
  ds_write_b128 v4, v[76:79] offset:31744
  s_waitcnt lgkmcnt(0)
  s_waitcnt vmcnt(0) lgkmcnt(0)
  s_barrier
  s_cmp_ge_u32 s13, 2
  s_cselect_b64 vcc, -1, 0
  v_cndmask_b32 v8, v8, v19, vcc
  ds_read_b128 v[68:71], v4 offset:0
  ds_read_b128 v[72:75], v4 offset:1024
  ds_read_b128 v[76:79], v4 offset:4096
  ds_read_b128 v[80:83], v4 offset:5120
  ds_read_b128 v[84:87], v4 offset:8192
  ds_read_b128 v[88:91], v4 offset:9216
  ds_read_b128 v[92:95], v4 offset:2048
  ds_read_b128 v[96:99], v4 offset:3072
  ds_read_b128 v[100:103], v4 offset:6144
  ds_read_b128 v[104:107], v4 offset:7168
  ds_read_b128 v[108:111], v4 offset:10240
  ds_read_b128 v[112:115], v4 offset:11264
  ds_read_b128 v[28:31], v59 offset:16384
  ds_read_b128 v[32:35], v59 offset:20480
  ds_read_b128 v[36:39], v2 offset:8192
  ds_read_b128 v[40:43], v2 offset:9216
  ds_read_b128 v[44:47], v2 offset:10240
  ds_read_b128 v[48:51], v2 offset:11264
  ds_read_b128 v[52:55], v2 offset:12288
  ds_read_b128 v[56:59], v2 offset:13312
  ds_read_b128 v[60:63], v2 offset:14336
  ds_read_b128 v[64:67], v2 offset:15360
  s_and_b32 s36, s13, 1
  s_lshl_b32 s36, s36, 12
  s_add_u32 s22, s22, s36
  s_add_u32 s23, s36, 145752064
  s_mov_b32 s14, -1
  s_and_b32 s57, s14, 1
  s_and_b32 s36, s14, 3
  s_lshl_b32 s36, s36, 13
  s_add_u32 s26, s36, s23
  s_add_u32 s36, s36, 8192
  s_and_b32 s36, s36, 0x7fff
  s_add_u32 s24, s36, 145752064
  s_add_u32 s25, s36, 145756160
  s_add_u32 s35, s36, s23
  s_waitcnt lgkmcnt(0)
  s_cmp_lg_u32 s56, 0
  s_cbranch_scc1 M_global
  s_cmp_eq_u32 s13, 1
  s_cbranch_scc1 T_w_82
  s_cmp_eq_u32 s13, 2
  s_cbranch_scc1 T_w_83
  s_cmp_eq_u32 s13, 3
  s_cbranch_scc1 T_w_84
T_w_81:
  s_mov_b32 s19, 0
  v_mov_b64 v[16:17], 0
  v_mov_b64 v[18:19], 0
  v_mov_b64 v[20:21], 0
  v_mov_b64 v[22:23], 0
  v_mov_b64 v[24:25], 0
  v_mov_b64 v[26:27], 0
  buffer_load_dwordx4 v[124:127], v3, s[4:7], s24 offen offset:0 sc1
  buffer_load_dwordx4 v[116:119], v3, s[4:7], s25 offen offset:0 sc1
  buffer_load_dwordx4 v[124:127], v3, s[4:7], s24 offen offset:0 sc1
  buffer_load_dwordx4 v[116:119], v3, s[4:7], s25 offen offset:0 sc1
  s_branch T_loop_85
.p2align 6
T_retry_86:
  s_mov_b64 exec, vcc
  buffer_load_dwordx4 v[124:127], v3, s[4:7], s24 offen offset:0 sc1
  buffer_load_dwordx4 v[116:119], v3, s[4:7], s25 offen offset:0 sc1
  s_mov_b64 exec, -1
  s_add_u32 s19, s19, 1
  s_cmp_gt_u32 s19, 32768
  s_cbranch_scc1 M_exit
T_loop_85:
  s_waitcnt vmcnt(3) lgkmcnt(0)
  v_max3_u32 v123, v124, v125, v126
  v_max_u32 v123, v123, v127
  v_mov_b32_dpp v120, v124 row_ror:8 row_mask:0xf bank_mask:0xf
  v_mov_b32_dpp v121, v125 row_ror:8 row_mask:0xf bank_mask:0xf
  s_waitcnt vmcnt(2)
  v_max3_u32 v123, v123, v116, v117
  v_max3_u32 v123, v123, v118, v119
  v_cmp_eq_u32 vcc, -1, v123
  s_cbranch_vccnz T_retry_86
  v_smfmac_f32_16x16x64_bf16 v[16:19], v[124:127], v[68:75], v0
  s_add_u32 s14, s14, 1
  ds_write_b128 v2, v[124:127] offset:0
  v_mov_b32_dpp v122, v126 row_ror:8 row_mask:0xf bank_mask:0xf
  v_smfmac_f32_16x16x64_bf16 v[20:23], v[124:127], v[76:83], v0
  s_and_b32 s57, s14, 1
  v_mov_b32_dpp v123, v127 row_ror:8 row_mask:0xf bank_mask:0xf
  v_smfmac_f32_16x16x64_bf16 v[24:27], v[124:127], v[84:91], v0
  s_and_b32 s36, s14, 3
  ds_write_b128 v2, v[116:119] offset:4096
  v_smfmac_f32_16x16x64_bf16 v[16:19], v[120:123], v[92:99], v0
  s_lshl_b32 s36, s36, 13
  v_mov_b32_dpp v84, v116 row_ror:8 row_mask:0xf bank_mask:0xf
  v_smfmac_f32_16x16x64_bf16 v[20:23], v[120:123], v[100:107], v0
  s_add_u32 s26, s36, s23
  ds_read_b128 v[68:71], v4 offset:12288
  v_mov_b32_dpp v85, v117 row_ror:8 row_mask:0xf bank_mask:0xf
  v_smfmac_f32_16x16x64_bf16 v[24:27], v[120:123], v[108:115], v0
  s_add_u32 s36, s36, 8192
  ds_read_b128 v[72:75], v4 offset:13312
  v_mov_b32_dpp v86, v118 row_ror:8 row_mask:0xf bank_mask:0xf
  v_smfmac_f32_16x16x64_bf16 v[16:19], v[116:119], v[224:231], v0
  s_and_b32 s36, s36, 0x7fff
  ds_read_b128 v[76:79], v4 offset:14336
  v_mov_b32_dpp v87, v119 row_ror:8 row_mask:0xf bank_mask:0xf
  v_smfmac_f32_16x16x64_bf16 v[20:23], v[116:119], v[240:247], v0
  s_waitcnt lgkmcnt(3)
  s_barrier
  ds_read_b128 v[100:103], v2 offset:1024
  v_smfmac_f32_16x16x64_bf16 v[24:27], v[116:119], a[0:7], v0
  s_mov_b32 m0, s31
  ds_read_b128 v[120:123], v1 offset:1024
  v_smfmac_f32_16x16x64_bf16 v[16:19], v[84:87], v[232:239], v0
  s_cmp_ge_i32 s14, s30
  s_cbranch_scc1 T_kvw_89
T_kvb_90:
  v_smfmac_f32_16x16x64_bf16 v[20:23], v[84:87], v[248:255], v0
  ds_read_b128 v[80:83], v4 offset:15360
  buffer_load_dwordx4 v9, s[4:7], s27 offen sc1 lds
  v_smfmac_f32_16x16x64_bf16 v[24:27], v[84:87], a[8:15], v0
  s_waitcnt lgkmcnt(2)
  s_mov_b32 m0, s32
  v_smfmac_f32_16x16x64_bf16 v[16:19], v[100:103], v[128:135], v0
  ds_read_b128 v[92:95], v2 offset:2048
  v_smfmac_f32_16x16x64_bf16 v[20:23], v[100:103], v[144:151], v0
  ds_read_b128 v[96:99], v1 offset:2048
  v_smfmac_f32_16x16x64_bf16 v[24:27], v[100:103], v[68:75], v0
  s_waitcnt vmcnt(1) lgkmcnt(3)
  ds_read_b128 v[116:119], v2 offset:3072
  buffer_load_dwordx4 v9, s[4:7], s27 offen offset:128 sc1 lds
  v_smfmac_f32_16x16x64_bf16 v[16:19], v[120:123], v[136:143], v0
  ds_read_b128 v[124:127], v1 offset:3072
  s_mov_b32 m0, s33
  v_smfmac_f32_16x16x64_bf16 v[20:23], v[120:123], v[152:159], v0
  s_waitcnt lgkmcnt(4)
  ds_read_b128 v[104:107], v2 offset:5120
  v_smfmac_f32_16x16x64_bf16 v[24:27], v[120:123], v[76:83], v0
  s_waitcnt lgkmcnt(4)
  ds_read_b128 v[108:111], v1 offset:5120
  v_smfmac_f32_16x16x64_bf16 v[16:19], v[92:95], v[160:167], v0
  s_waitcnt lgkmcnt(4)
  ds_read_b128 v[112:115], v2 offset:6144
  buffer_load_dwordx4 v10, s[4:7], s28 offen sc1 lds
  v_smfmac_f32_16x16x64_bf16 v[16:19], v[96:99], v[168:175], v0
  s_waitcnt lgkmcnt(4)
  ds_read_b128 v[84:87], v1 offset:6144
  s_mov_b32 m0, s34
  v_smfmac_f32_16x16x64_bf16 v[16:19], v[116:119], v[192:199], v0
  s_waitcnt lgkmcnt(4)
  ds_read_b128 v[88:91], v2 offset:7168
  v_smfmac_f32_16x16x64_bf16 v[16:19], v[124:127], v[200:207], v0
  s_waitcnt lgkmcnt(4)
  ds_read_b128 v[100:103], v1 offset:7168
  v_smfmac_f32_16x16x64_bf16 v[16:19], v[104:107], a[16:23], v0
  s_waitcnt lgkmcnt(4)
  ds_read_b128 v[68:71], v4 offset:16384
  buffer_load_dwordx4 v10, s[4:7], s28 offen offset:256 sc1 lds
  v_smfmac_f32_16x16x64_bf16 v[16:19], v[108:111], a[24:31], v0
  s_waitcnt lgkmcnt(4)
  ds_read_b128 v[72:75], v4 offset:17408
  v_smfmac_f32_16x16x64_bf16 v[16:19], v[112:115], a[64:71], v0
  s_waitcnt lgkmcnt(4)
  ds_read_b128 v[76:79], v4 offset:18432
  v_smfmac_f32_16x16x64_bf16 v[16:19], v[84:87], a[72:79], v0
  s_waitcnt lgkmcnt(4)
  ds_read_b128 v[80:83], v4 offset:19456
  v_smfmac_f32_16x16x64_bf16 v[16:19], v[88:91], a[112:119], v0
  s_waitcnt lgkmcnt(4)
  v_smfmac_f32_16x16x64_bf16 v[16:19], v[100:103], a[120:127], v0
  s_add_u32 s24, s36, 145752064
  s_add_u32 s25, s36, 145756160
  v_smfmac_f32_16x16x64_bf16 v[20:23], v[92:95], v[176:183], v0
  s_add_u32 s35, s36, s23
  v_smfmac_f32_16x16x64_bf16 v[20:23], v[96:99], v[184:191], v0
  s_waitcnt lgkmcnt(2)
  v_smfmac_f32_16x16x64_bf16 v[20:23], v[116:119], v[68:75], v0
  s_waitcnt lgkmcnt(0)
  ds_read_b128 v[68:71], v4 offset:20480
  v_mul_f32 v16, s18, v16
  v_smfmac_f32_16x16x64_bf16 v[20:23], v[124:127], v[76:83], v0
  ds_read_b128 v[72:75], v4 offset:21504
  v_mul_f32 v17, s18, v17
  v_smfmac_f32_16x16x64_bf16 v[20:23], v[104:107], a[32:39], v0
  ds_read_b128 v[76:79], v4 offset:22528
  v_mul_f32 v18, s18, v18
  v_smfmac_f32_16x16x64_bf16 v[20:23], v[108:111], a[40:47], v0
  ds_read_b128 v[80:83], v4 offset:23552
  v_mul_f32 v19, s18, v19
  v_smfmac_f32_16x16x64_bf16 v[20:23], v[112:115], a[80:87], v0
  v_cvt_pk_bf16_f32 v120, v16, v17
  v_smfmac_f32_16x16x64_bf16 v[20:23], v[84:87], a[88:95], v0
  v_cvt_pk_bf16_f32 v121, v18, v19
  v_smfmac_f32_16x16x64_bf16 v[20:23], v[88:91], a[128:135], v0
  ds_write_b64 v5, v[120:121] offset:24576
  v_smfmac_f32_16x16x64_bf16 v[20:23], v[100:103], a[136:143], v0
  s_waitcnt lgkmcnt(3)
  v_smfmac_f32_16x16x64_bf16 v[24:27], v[92:95], v[68:75], v0
  s_waitcnt lgkmcnt(1)
  v_mov_b64 v[92:93], 0
  v_smfmac_f32_16x16x64_bf16 v[24:27], v[96:99], v[76:83], v0
  s_nop 1
  v_cvt_pk_bf16_f32 v122, v20, v21
  v_cvt_pk_bf16_f32 v123, v22, v23
  v_smfmac_f32_16x16x64_bf16 v[24:27], v[116:119], v[208:215], v0
  ds_write_b64 v5, v[122:123] offset:26880
  v_mov_b64 v[94:95], 0
  v_smfmac_f32_16x16x64_bf16 v[24:27], v[124:127], v[216:223], v0
  s_waitcnt lgkmcnt(1)
  s_barrier
  ds_read_b64_tr_b16 v[68:69], v6 offset:24576
  v_smfmac_f32_16x16x64_bf16 v[24:27], v[104:107], a[48:55], v0
  s_add_u32 s27, s27, 8192
  ds_read_b64_tr_b16 v[70:71], v6 offset:24640
  ds_read_b64_tr_b16 v[72:73], v6 offset:24832
  v_smfmac_f32_16x16x64_bf16 v[24:27], v[108:111], a[56:63], v0
  s_add_u32 s28, s28, 8192
  ds_read_b64_tr_b16 v[74:75], v6 offset:24896
  ds_read_b64_tr_b16 v[76:77], v6 offset:25088
  v_smfmac_f32_16x16x64_bf16 v[24:27], v[112:115], a[96:103], v0
  s_nop 0
  ds_read_b64_tr_b16 v[78:79], v6 offset:25152
  ds_read_b64_tr_b16 v[80:81], v6 offset:25344
  v_smfmac_f32_16x16x64_bf16 v[24:27], v[84:87], a[104:111], v0
  ds_read_b64_tr_b16 v[82:83], v6 offset:25408
  v_mov_b64 v[96:97], 0
  v_smfmac_f32_16x16x64_bf16 v[24:27], v[88:91], a[144:151], v0
  s_waitcnt lgkmcnt(8)
  s_barrier
  ds_read_b64_tr_b16 v[116:117], v6 offset:26880
  v_smfmac_f32_16x16x64_bf16 v[24:27], v[100:103], a[152:159], v0
  s_waitcnt lgkmcnt(7)
  ds_read_b64_tr_b16 v[118:119], v6 offset:26944
  v_mfma_f32_16x16x32_bf16 v[16:19], v[36:39], v[68:71], 0
  s_waitcnt lgkmcnt(6)
  ds_read_b64_tr_b16 v[124:125], v6 offset:27136
  ds_read_b64_tr_b16 v[126:127], v6 offset:27200
  v_mfma_f32_16x16x32_bf16 v[16:19], v[40:43], v[72:75], v[16:19]
  s_waitcnt lgkmcnt(6)
  ds_read_b64_tr_b16 v[104:105], v6 offset:27392
  ds_read_b64_tr_b16 v[106:107], v6 offset:27456
  v_mfma_f32_16x16x32_bf16 v[16:19], v[44:47], v[76:79], v[16:19]
  s_waitcnt lgkmcnt(6)
  ds_read_b64_tr_b16 v[108:109], v6 offset:27648
  ds_read_b64_tr_b16 v[110:111], v6 offset:27712
  v_mfma_f32_16x16x32_bf16 v[16:19], v[48:51], v[80:83], v[16:19]
  s_waitcnt lgkmcnt(6)
  v_cvt_pk_bf16_f32 v120, v24, v25
  v_cvt_pk_bf16_f32 v121, v26, v27
  v_mfma_f32_16x16x32_bf16 v[112:115], v[116:119], v[68:71], 0
  s_waitcnt lgkmcnt(4)
  buffer_store_dwordx4 v[120:123], v2, s[4:7], s29 offen offset:0 sc1
  v_mov_b64 v[98:99], 0
  v_mfma_f32_16x16x32_bf16 v[112:115], v[124:127], v[72:75], v[112:115]
  s_waitcnt lgkmcnt(2)
  v_mov_b64 v[36:37], 0
  v_exp_f32 v100, v16
  v_mfma_f32_16x16x32_bf16 v[112:115], v[104:107], v[76:79], v[112:115]
  s_waitcnt lgkmcnt(0)
  v_exp_f32 v101, v17
  v_mfma_f32_16x16x32_bf16 v[112:115], v[108:111], v[80:83], v[112:115]
  s_add_u32 s29, s29, 131072
  v_exp_f32 v102, v18
  v_mfma_f32_16x16x32_bf16 v[20:23], v[52:55], v[68:71], 0
  s_cmp_eq_u32 s14, 63
  v_exp_f32 v103, v19
  v_mfma_f32_16x16x32_bf16 v[20:23], v[56:59], v[72:75], v[20:23]
  s_cbranch_scc1 M_tdone
  v_cvt_pk_bf16_f32 v44, v100, v101
  v_cvt_pk_bf16_f32 v45, v102, v103
  v_mfma_f32_16x16x32_bf16 v[20:23], v[60:63], v[76:79], v[20:23]
  v_exp_f32 v100, v112
  v_mfma_f32_16x16x32_bf16 v[20:23], v[64:67], v[80:83], v[20:23]
  v_exp_f32 v101, v113
  v_exp_f32 v102, v114
  v_exp_f32 v103, v115
  v_cvt_pk_bf16_f32 v84, v100, v101
  v_cvt_pk_bf16_f32 v85, v102, v103
  v_cndmask_b32 v48, v84, 0, s[16:17]
  v_cndmask_b32 v49, v85, 0, s[16:17]
  v_cndmask_b32 v50, 0, v84, s[16:17]
  v_cndmask_b32 v51, 0, v85, s[16:17]
  v_exp_f32 v100, v20
  v_mfma_f32_16x16x16_bf16 v[88:91], v[12:13], v[48:49], 0
  v_exp_f32 v101, v21
  v_mfma_f32_16x16x16_bf16 v[24:27], v[120:121], v[48:49], 0
  v_exp_f32 v102, v22
  v_mfma_f32_16x16x16_bf16 v[116:119], v[120:121], v[50:51], 0
  v_exp_f32 v103, v23
  v_cvt_pk_bf16_f32 v46, v100, v101
  v_cvt_pk_bf16_f32 v47, v102, v103
  v_mov_b64 v[38:39], 0
  s_nop 0
  v_mfma_f32_16x16x32_bf16 v[88:91], v[12:15], v[44:47], v[88:91]
  v_mov_b64 v[40:41], 0
  v_mov_b64 v[42:43], 0
  v_mfma_f32_16x16x32_bf16 v[24:27], v[28:31], v[44:47], v[24:27]
  ds_read_b128 v[52:55], v4 offset:24576
  ds_read_b128 v[56:59], v4 offset:25600
  v_mfma_f32_16x16x32_bf16 v[116:119], v[32:35], v[44:47], v[116:119]
  s_nop 1
  v_rcp_f32 v89, v88
  v_subrev_u32 v100, s54, v88
  v_cmp_le_u32 vcc, s55, v100
  v_mul_f32 v24, v89, v24
  v_mul_f32 v25, v89, v25
  s_cbranch_vccnz T_slow_92
T_back_93:
  v_cvt_pk_bf16_f32 v124, v24, v25
  v_pk_mul_f32 v[26:27], v[26:27], v[88:89] op_sel:[0,1] op_sel_hi:[1,1]
  v_pk_mul_f32 v[116:117], v[116:117], v[88:89] op_sel:[0,1] op_sel_hi:[1,1]
  v_pk_mul_f32 v[118:119], v[118:119], v[88:89] op_sel:[0,1] op_sel_hi:[1,1]
  v_cvt_pk_bf16_f32 v125, v26, v27
  v_cvt_pk_bf16_f32 v126, v116, v117
  v_cvt_pk_bf16_f32 v127, v118, v119
  ds_write_b128 v11, v[124:127] offset:29184
  s_nop 0
  v_smfmac_f32_16x16x64_bf16 v[92:95], v[124:127], a[160:167], v0
  v_smfmac_f32_16x16x64_bf16 v[96:99], v[124:127], a[168:175], v0
  v_smfmac_f32_16x16x64_bf16 v[36:39], v[124:127], a[176:183], v0
  v_smfmac_f32_16x16x64_bf16 v[40:43], v[124:127], a[184:191], v0
  s_waitcnt lgkmcnt(0)
  s_barrier
  ds_read_b128 v[104:107], v11 offset:29696
  ds_read_b128 v[108:111], v11 offset:30208
  ds_read_b128 v[68:71], v11 offset:30720
  s_waitcnt lgkmcnt(2)
  v_smfmac_f32_16x16x64_bf16 v[92:95], v[104:107], a[192:199], v0
  s_waitcnt lgkmcnt(1)
  ds_read_b128 v[76:79], v4 offset:28672
  v_smfmac_f32_16x16x64_bf16 v[92:95], v[108:111], a[224:231], v0
  s_waitcnt lgkmcnt(1)
  ds_read_b128 v[80:83], v4 offset:29696
  v_smfmac_f32_16x16x64_bf16 v[92:95], v[68:71], a[240:247], v0
  ds_read_b128 v[60:63], v4 offset:26624
  v_smfmac_f32_16x16x64_bf16 v[96:99], v[104:107], a[200:207], v0
  ds_read_b128 v[64:67], v4 offset:27648
  v_smfmac_f32_16x16x64_bf16 v[96:99], v[108:111], a[232:239], v0
  ds_read_b128 v[28:31], v4 offset:30720
  s_nop 0
  v_cvt_pk_bf16_f32 v16, v92, v93
  v_cvt_pk_bf16_f32 v17, v94, v95
  v_bfi_b32 v16, 1, s57, v16
  v_smfmac_f32_16x16x64_bf16 v[96:99], v[68:71], a[248:255], v0
  buffer_store_dwordx2 v[16:17], v7, s[4:7], s20 offen offset:0
  v_smfmac_f32_16x16x64_bf16 v[36:39], v[104:107], a[208:215], v0
  ds_read_b128 v[32:35], v4 offset:31744
  v_smfmac_f32_16x16x64_bf16 v[36:39], v[108:111], v[52:59], v0
  s_waitcnt lgkmcnt(4)
  s_nop 0
  v_cvt_pk_bf16_f32 v18, v96, v97
  v_cvt_pk_bf16_f32 v19, v98, v99
  v_bfi_b32 v18, 1, s57, v18
  v_smfmac_f32_16x16x64_bf16 v[36:39], v[68:71], v[76:83], v0
  buffer_store_dwordx2 v[18:19], v7, s[4:7], s20 offen offset:64
  v_smfmac_f32_16x16x64_bf16 v[40:43], v[104:107], a[216:223], v0
  s_waitcnt lgkmcnt(2)
  ds_read_b128 v[116:119], v2 offset:31232
  v_smfmac_f32_16x16x64_bf16 v[40:43], v[108:111], v[60:67], v0
  s_waitcnt lgkmcnt(1)
  s_nop 0
  v_cvt_pk_bf16_f32 v20, v36, v37
  v_cvt_pk_bf16_f32 v21, v38, v39
  v_bfi_b32 v20, 1, s57, v20
  v_smfmac_f32_16x16x64_bf16 v[40:43], v[68:71], v[28:35], v0
  buffer_store_dwordx2 v[20:21], v7, s[4:7], s21 offen offset:0
  s_nop 6
  v_cvt_pk_bf16_f32 v22, v40, v41
  v_cvt_pk_bf16_f32 v23, v42, v43
  v_bfi_b32 v22, 1, s57, v22
  buffer_store_dwordx2 v[22:23], v7, s[4:7], s21 offen offset:64
  ds_read_b128 v[68:71], v4 offset:0
  ds_read_b128 v[72:75], v4 offset:1024
  ds_read_b128 v[76:79], v4 offset:4096
  ds_read_b128 v[80:83], v4 offset:5120
  ds_read_b128 v[84:87], v4 offset:8192
  ds_read_b128 v[88:91], v4 offset:9216
  v_mov_b64 v[16:17], 0
  v_mov_b64 v[18:19], 0
  v_mov_b64 v[20:21], 0
  v_mov_b64 v[22:23], 0
  v_mov_b64 v[24:25], 0
  v_mov_b64 v[26:27], 0
  s_mov_b32 s19, 0
  v_mov_b32 v49, -1
  s_waitcnt vmcnt(2)
  buffer_load_dwordx4 v[52:55], v2, s[4:7], s22 offen offset:0 sc1
  buffer_load_dwordx4 v[56:59], v2, s[4:7], s22 offen offset:1024 sc1
  buffer_load_dwordx4 v[60:63], v2, s[4:7], s22 offen offset:2048 sc1
  buffer_load_dwordx4 v[64:67], v2, s[4:7], s22 offen offset:3072 sc1
  ds_read_b128 v[92:95], v4 offset:2048
  ds_read_b128 v[96:99], v4 offset:3072
  ds_read_b128 v[100:103], v4 offset:6144
  ds_read_b128 v[104:107], v4 offset:7168
  ds_read_b128 v[108:111], v4 offset:10240
  ds_read_b128 v[112:115], v4 offset:11264
  ds_read_b64 v[44:45], v2 offset:32256
  s_waitcnt lgkmcnt(0)
  v_readfirstlane_b32 s38, v44
  v_readfirstlane_b32 s37, v45
  s_nop 0
  s_add_u32 s37, s37, 30
  s_cmp_ge_u32 s38, 30
  s_cselect_b32 s38, s37, s38
  s_cmp_ge_u32 s38, 64
  s_cselect_b32 s38, 100, s38
  s_sub_u32 s38, s38, 1
  s_max_i32 s30, s30, s38
  s_waitcnt lgkmcnt(12)
  s_waitcnt vmcnt(3)
  v_mfma_f32_16x16x32_bf16 v[120:123], v[116:119], v[52:55], 0
  v_xor_b32 v48, s57, v52
  v_bitop3_b32 v48, v48, v54, s57 bitop3:0xf6
  s_waitcnt vmcnt(2)
  v_mfma_f32_16x16x32_bf16 v[120:123], v[116:119], v[56:59], v[120:123]
  v_bitop3_b32 v48, v48, v56, s57 bitop3:0xf6
  v_bitop3_b32 v48, v48, v58, s57 bitop3:0xf6
  s_waitcnt vmcnt(1)
  v_mfma_f32_16x16x32_bf16 v[120:123], v[116:119], v[60:63], v[120:123]
  v_bitop3_b32 v48, v48, v60, s57 bitop3:0xf6
  v_bitop3_b32 v48, v48, v62, s57 bitop3:0xf6
  s_waitcnt vmcnt(0)
  v_mfma_f32_16x16x32_bf16 v[120:123], v[116:119], v[64:67], v[120:123]
  v_bitop3_b32 v48, v48, v64, s57 bitop3:0xf6
  v_bitop3_b32 v48, v48, v66, s57 bitop3:0xf6
  v_and_b32 v48, 1, v48
  v_cmp_ne_u32 vcc, 0, v48
  s_cbranch_vccnz T_p1re_95
T_p1ok_96:
  s_nop 2
  v_add_f32_dpp v120, v120, v120 row_ror:8 row_mask:0xf bank_mask:0xf
  v_add_f32_dpp v121, v121, v121 row_ror:8 row_mask:0xf bank_mask:0xf
  v_cvt_pk_bf16_f32 v48, v120, v121
  v_min_u32 v48, -2, v48
  buffer_store_dword v48, v8, s[4:7], s35 offen
  buffer_store_dword v49, v8, s[4:7], s26 offen
  s_barrier
  ds_read_b128 v[28:31], v2 offset:16384
  ds_read_b128 v[32:35], v2 offset:20480
  ds_read_b128 v[36:39], v2 offset:8192
  ds_read_b128 v[40:43], v2 offset:9216
  ds_read_b128 v[44:47], v2 offset:10240
  ds_read_b128 v[48:51], v2 offset:11264
  buffer_load_dwordx4 v[124:127], v3, s[4:7], s24 offen offset:0 sc1
  buffer_load_dwordx4 v[116:119], v3, s[4:7], s25 offen offset:0 sc1
  ds_read_b128 v[52:55], v2 offset:12288
  ds_read_b128 v[56:59], v2 offset:13312
  ds_read_b128 v[60:63], v2 offset:14336
  ds_read_b128 v[64:67], v2 offset:15360
  buffer_load_dwordx4 v[124:127], v3, s[4:7], s24 offen offset:0 sc1
  buffer_load_dwordx4 v[116:119], v3, s[4:7], s25 offen offset:0 sc1
  s_mov_b32 s19, 0
  s_branch T_loop_85
T_p1re_95:
  s_mov_b64 exec, vcc
  buffer_load_dwordx4 v[52:55], v2, s[4:7], s22 offen offset:0 sc1
  buffer_load_dwordx4 v[56:59], v2, s[4:7], s22 offen offset:1024 sc1
  buffer_load_dwordx4 v[60:63], v2, s[4:7], s22 offen offset:2048 sc1
  buffer_load_dwordx4 v[64:67], v2, s[4:7], s22 offen offset:3072 sc1
  s_mov_b64 exec, -1
  s_add_u32 s19, s19, 1
  s_cmp_gt_u32 s19, 32768
  s_cbranch_scc1 M_exit
  s_waitcnt vmcnt(3)
  v_mfma_f32_16x16x32_bf16 v[120:123], v[116:119], v[52:55], 0
  v_xor_b32 v48, s57, v52
  v_bitop3_b32 v48, v48, v54, s57 bitop3:0xf6
  s_waitcnt vmcnt(2)
  v_mfma_f32_16x16x32_bf16 v[120:123], v[116:119], v[56:59], v[120:123]
  v_bitop3_b32 v48, v48, v56, s57 bitop3:0xf6
  v_bitop3_b32 v48, v48, v58, s57 bitop3:0xf6
  s_waitcnt vmcnt(1)
  v_mfma_f32_16x16x32_bf16 v[120:123], v[116:119], v[60:63], v[120:123]
  v_bitop3_b32 v48, v48, v60, s57 bitop3:0xf6
  v_bitop3_b32 v48, v48, v62, s57 bitop3:0xf6
  s_waitcnt vmcnt(0)
  v_mfma_f32_16x16x32_bf16 v[120:123], v[116:119], v[64:67], v[120:123]
  v_bitop3_b32 v48, v48, v64, s57 bitop3:0xf6
  v_bitop3_b32 v48, v48, v66, s57 bitop3:0xf6
  v_and_b32 v48, 1, v48
  v_cmp_ne_u32 vcc, 0, v48
  s_cbranch_vccnz T_p1re_95
  s_branch T_p1ok_96
T_kvw_89:
  s_mov_b32 s19, 0
  s_branch T_kvok_98
T_kv_97:
  s_sleep 4
  s_add_u32 s19, s19, 1
  s_cmp_gt_u32 s19, 32768
  s_cbranch_scc1 M_exit
T_kvok_98:
  s_add_u32 s39, s99, 128
  s_mov_b32 s38, 0
  s_mov_b32 s37, 0
  s_atomic_or s38, s[58:59], s99 glc
  s_atomic_or s37, s[58:59], s39 glc
  s_waitcnt lgkmcnt(0)
  s_add_u32 s37, s37, 30
  s_cmp_ge_u32 s38, 30
  s_cselect_b32 s38, s37, s38
  s_cmp_ge_u32 s38, 64
  s_cselect_b32 s38, 100, s38
  s_sub_u32 s38, s38, 1
  s_max_i32 s30, s30, s38
  s_cmp_ge_i32 s14, s30
  s_cbranch_scc1 T_kv_97
  s_branch T_kvb_90
T_slow_92:
  s_nop 7
  v_max3_f32 v100, v16, v17, v18
  v_max3_f32 v100, v100, v19, v20
  v_max3_f32 v100, v100, v21, v22
  v_max3_f32 v100, v100, v23, v112
  v_max3_f32 v100, v100, v113, v114
  v_max_f32 v100, v100, v115
  v_mov_b32 v101, v100
  s_nop 1
  v_permlane32_swap_b32 v100, v101
  s_nop 1
  v_max_f32 v100, v100, v101
  v_mov_b32 v101, v100
  s_nop 1
  v_permlane16_swap_b32 v100, v101
  s_nop 1
  v_max_f32 v100, v100, v101
  v_sub_f32 v16, v16, v100
  v_sub_f32 v17, v17, v100
  v_sub_f32 v18, v18, v100
  v_sub_f32 v19, v19, v100
  v_exp_f32 v16, v16
  v_exp_f32 v17, v17
  v_exp_f32 v18, v18
  v_exp_f32 v19, v19
  v_sub_f32 v20, v20, v100
  v_sub_f32 v21, v21, v100
  v_sub_f32 v22, v22, v100
  v_sub_f32 v23, v23, v100
  v_exp_f32 v20, v20
  v_exp_f32 v21, v21
  v_exp_f32 v22, v22
  v_exp_f32 v23, v23
  v_sub_f32 v112, v112, v100
  v_sub_f32 v113, v113, v100
  v_sub_f32 v114, v114, v100
  v_sub_f32 v115, v115, v100
  v_exp_f32 v112, v112
  v_exp_f32 v113, v113
  v_exp_f32 v114, v114
  v_exp_f32 v115, v115
  s_nop 0
  v_cvt_pk_bf16_f32 v44, v16, v17
  v_cvt_pk_bf16_f32 v45, v18, v19
  v_cvt_pk_bf16_f32 v46, v20, v21
  v_cvt_pk_bf16_f32 v47, v22, v23
  v_cvt_pk_bf16_f32 v84, v112, v113
  v_cvt_pk_bf16_f32 v85, v114, v115
  v_cndmask_b32 v48, v84, 0, s[16:17]
  v_cndmask_b32 v49, v85, 0, s[16:17]
  v_cndmask_b32 v50, 0, v84, s[16:17]
  v_cndmask_b32 v51, 0, v85, s[16:17]
  s_nop 1
  v_mfma_f32_16x16x16_bf16 v[88:91], v[12:13], v[48:49], 0
  v_mfma_f32_16x16x16_bf16 v[24:27], v[120:121], v[48:49], 0
  v_mfma_f32_16x16x16_bf16 v[116:119], v[120:121], v[50:51], 0
  v_mfma_f32_16x16x32_bf16 v[88:91], v[12:15], v[44:47], v[88:91]
  v_mfma_f32_16x16x32_bf16 v[24:27], v[28:31], v[44:47], v[24:27]
  v_mfma_f32_16x16x32_bf16 v[116:119], v[32:35], v[44:47], v[116:119]
  s_nop 7
  s_nop 1
  v_rcp_f32 v89, v88
  s_nop 0
  v_mul_f32 v24, v89, v24
  v_mul_f32 v25, v89, v25
  s_branch T_back_93
T_w_82:
  s_mov_b32 s19, 0
  v_mov_b64 v[16:17], 0
  v_mov_b64 v[18:19], 0
  v_mov_b64 v[20:21], 0
  v_mov_b64 v[22:23], 0
  v_mov_b64 v[24:25], 0
  v_mov_b64 v[26:27], 0
  buffer_load_dwordx4 v[124:127], v3, s[4:7], s24 offen offset:1024 sc1
  buffer_load_dwordx4 v[116:119], v3, s[4:7], s25 offen offset:1024 sc1
  buffer_load_dwordx4 v[124:127], v3, s[4:7], s24 offen offset:1024 sc1
  buffer_load_dwordx4 v[116:119], v3, s[4:7], s25 offen offset:1024 sc1
  s_branch T_loop_99
.p2align 6
T_retry_100:
  s_mov_b64 exec, vcc
  buffer_load_dwordx4 v[124:127], v3, s[4:7], s24 offen offset:1024 sc1
  buffer_load_dwordx4 v[116:119], v3, s[4:7], s25 offen offset:1024 sc1
  s_mov_b64 exec, -1
  s_add_u32 s19, s19, 1
  s_cmp_gt_u32 s19, 32768
  s_cbranch_scc1 M_exit
T_loop_99:
  s_waitcnt vmcnt(3) lgkmcnt(0)
  v_max3_u32 v123, v124, v125, v126
  v_max_u32 v123, v123, v127
  v_mov_b32_dpp v120, v124 row_ror:8 row_mask:0xf bank_mask:0xf
  v_mov_b32_dpp v121, v125 row_ror:8 row_mask:0xf bank_mask:0xf
  s_waitcnt vmcnt(2)
  v_max3_u32 v123, v123, v116, v117
  v_max3_u32 v123, v123, v118, v119
  v_cmp_eq_u32 vcc, -1, v123
  s_cbranch_vccnz T_retry_100
  v_smfmac_f32_16x16x64_bf16 v[16:19], v[124:127], v[68:75], v0
  s_add_u32 s14, s14, 1
  ds_write_b128 v2, v[124:127] offset:1024
  v_mov_b32_dpp v122, v126 row_ror:8 row_mask:0xf bank_mask:0xf
  v_smfmac_f32_16x16x64_bf16 v[20:23], v[124:127], v[76:83], v0
  s_and_b32 s57, s14, 1
  v_mov_b32_dpp v123, v127 row_ror:8 row_mask:0xf bank_mask:0xf
  v_smfmac_f32_16x16x64_bf16 v[24:27], v[124:127], v[84:91], v0
  s_and_b32 s36, s14, 3
  ds_write_b128 v2, v[116:119] offset:5120
  v_smfmac_f32_16x16x64_bf16 v[16:19], v[120:123], v[92:99], v0
  s_lshl_b32 s36, s36, 13
  v_mov_b32_dpp v84, v116 row_ror:8 row_mask:0xf bank_mask:0xf
  v_smfmac_f32_16x16x64_bf16 v[20:23], v[120:123], v[100:107], v0
  s_add_u32 s26, s36, s23
  ds_read_b128 v[68:71], v4 offset:12288
  v_mov_b32_dpp v85, v117 row_ror:8 row_mask:0xf bank_mask:0xf
  v_smfmac_f32_16x16x64_bf16 v[24:27], v[120:123], v[108:115], v0
  s_add_u32 s36, s36, 8192
  ds_read_b128 v[72:75], v4 offset:13312
  v_mov_b32_dpp v86, v118 row_ror:8 row_mask:0xf bank_mask:0xf
  v_smfmac_f32_16x16x64_bf16 v[16:19], v[116:119], v[224:231], v0
  s_and_b32 s36, s36, 0x7fff
  ds_read_b128 v[76:79], v4 offset:14336
  v_mov_b32_dpp v87, v119 row_ror:8 row_mask:0xf bank_mask:0xf
  v_smfmac_f32_16x16x64_bf16 v[20:23], v[116:119], v[240:247], v0
  s_waitcnt lgkmcnt(3)
  s_barrier
  ds_read_b128 v[100:103], v2 offset:0
  v_smfmac_f32_16x16x64_bf16 v[24:27], v[116:119], a[0:7], v0
  s_mov_b32 m0, s31
  ds_read_b128 v[120:123], v1 offset:0
  v_smfmac_f32_16x16x64_bf16 v[16:19], v[84:87], v[232:239], v0
  s_cmp_ge_i32 s14, s30
  s_cbranch_scc1 T_kvw_103
T_kvb_104:
  v_smfmac_f32_16x16x64_bf16 v[20:23], v[84:87], v[248:255], v0
  ds_read_b128 v[80:83], v4 offset:15360
  v_smfmac_f32_16x16x64_bf16 v[24:27], v[84:87], a[8:15], v0
  s_waitcnt lgkmcnt(2)
  buffer_load_dwordx4 v9, s[4:7], s27 offen sc1 lds
  v_smfmac_f32_16x16x64_bf16 v[16:19], v[100:103], v[128:135], v0
  ds_read_b128 v[92:95], v2 offset:3072
  s_mov_b32 m0, s32
  v_smfmac_f32_16x16x64_bf16 v[20:23], v[100:103], v[144:151], v0
  ds_read_b128 v[96:99], v1 offset:3072
  v_smfmac_f32_16x16x64_bf16 v[24:27], v[100:103], v[68:75], v0
  s_waitcnt vmcnt(1) lgkmcnt(3)
  ds_read_b128 v[116:119], v2 offset:2048
  v_smfmac_f32_16x16x64_bf16 v[16:19], v[120:123], v[136:143], v0
  ds_read_b128 v[124:127], v1 offset:2048
  buffer_load_dwordx4 v9, s[4:7], s27 offen offset:128 sc1 lds
  v_smfmac_f32_16x16x64_bf16 v[20:23], v[120:123], v[152:159], v0
  s_waitcnt lgkmcnt(4)
  ds_read_b128 v[104:107], v2 offset:4096
  s_mov_b32 m0, s33
  v_smfmac_f32_16x16x64_bf16 v[24:27], v[120:123], v[76:83], v0
  s_waitcnt lgkmcnt(4)
  ds_read_b128 v[108:111], v1 offset:4096
  v_smfmac_f32_16x16x64_bf16 v[16:19], v[92:95], v[160:167], v0
  s_waitcnt lgkmcnt(4)
  ds_read_b128 v[112:115], v2 offset:7168
  v_smfmac_f32_16x16x64_bf16 v[16:19], v[96:99], v[168:175], v0
  s_waitcnt lgkmcnt(4)
  ds_read_b128 v[84:87], v1 offset:7168
  buffer_load_dwordx4 v10, s[4:7], s28 offen sc1 lds
  v_smfmac_f32_16x16x64_bf16 v[16:19], v[116:119], v[192:199], v0
  s_waitcnt lgkmcnt(4)
  ds_read_b128 v[88:91], v2 offset:6144
  s_mov_b32 m0, s34
  v_smfmac_f32_16x16x64_bf16 v[16:19], v[124:127], v[200:207], v0
  s_waitcnt lgkmcnt(4)
  ds_read_b128 v[100:103], v1 offset:6144
  v_smfmac_f32_16x16x64_bf16 v[16:19], v[104:107], a[16:23], v0
  s_waitcnt lgkmcnt(4)
  ds_read_b128 v[68:71], v4 offset:16384
  v_smfmac_f32_16x16x64_bf16 v[16:19], v[108:111], a[24:31], v0
  s_waitcnt lgkmcnt(4)
  ds_read_b128 v[72:75], v4 offset:17408
  buffer_load_dwordx4 v10, s[4:7], s28 offen offset:256 sc1 lds
  v_smfmac_f32_16x16x64_bf16 v[16:19], v[112:115], a[64:71], v0
  s_waitcnt lgkmcnt(4)
  ds_read_b128 v[76:79], v4 offset:18432
  v_smfmac_f32_16x16x64_bf16 v[16:19], v[84:87], a[72:79], v0
  s_waitcnt lgkmcnt(4)
  ds_read_b128 v[80:83], v4 offset:19456
  v_smfmac_f32_16x16x64_bf16 v[16:19], v[88:91], a[112:119], v0
  s_waitcnt lgkmcnt(4)
  v_smfmac_f32_16x16x64_bf16 v[16:19], v[100:103], a[120:127], v0
  s_add_u32 s24, s36, 145752064
  s_add_u32 s25, s36, 145756160
  v_smfmac_f32_16x16x64_bf16 v[20:23], v[92:95], v[176:183], v0
  s_add_u32 s35, s36, s23
  v_smfmac_f32_16x16x64_bf16 v[20:23], v[96:99], v[184:191], v0
  s_waitcnt lgkmcnt(2)
  v_smfmac_f32_16x16x64_bf16 v[20:23], v[116:119], v[68:75], v0
  s_waitcnt lgkmcnt(0)
  ds_read_b128 v[68:71], v4 offset:20480
  v_mul_f32 v16, s18, v16
  v_smfmac_f32_16x16x64_bf16 v[20:23], v[124:127], v[76:83], v0
  ds_read_b128 v[72:75], v4 offset:21504
  v_mul_f32 v17, s18, v17
  v_smfmac_f32_16x16x64_bf16 v[20:23], v[104:107], a[32:39], v0
  ds_read_b128 v[76:79], v4 offset:22528
  v_mul_f32 v18, s18, v18
  v_smfmac_f32_16x16x64_bf16 v[20:23], v[108:111], a[40:47], v0
  ds_read_b128 v[80:83], v4 offset:23552
  v_mul_f32 v19, s18, v19
  v_smfmac_f32_16x16x64_bf16 v[20:23], v[112:115], a[80:87], v0
  v_cvt_pk_bf16_f32 v120, v16, v17
  v_smfmac_f32_16x16x64_bf16 v[20:23], v[84:87], a[88:95], v0
  v_cvt_pk_bf16_f32 v121, v18, v19
  v_smfmac_f32_16x16x64_bf16 v[20:23], v[88:91], a[128:135], v0
  ds_write_b64 v5, v[120:121] offset:24576
  v_smfmac_f32_16x16x64_bf16 v[20:23], v[100:103], a[136:143], v0
  s_waitcnt lgkmcnt(3)
  v_smfmac_f32_16x16x64_bf16 v[24:27], v[92:95], v[68:75], v0
  s_waitcnt lgkmcnt(1)
  v_mov_b64 v[92:93], 0
  v_smfmac_f32_16x16x64_bf16 v[24:27], v[96:99], v[76:83], v0
  s_nop 1
  v_cvt_pk_bf16_f32 v122, v20, v21
  v_cvt_pk_bf16_f32 v123, v22, v23
  v_smfmac_f32_16x16x64_bf16 v[24:27], v[116:119], v[208:215], v0
  ds_write_b64 v5, v[122:123] offset:26880
  v_mov_b64 v[94:95], 0
  v_smfmac_f32_16x16x64_bf16 v[24:27], v[124:127], v[216:223], v0
  s_waitcnt lgkmcnt(1)
  s_barrier
  ds_read_b64_tr_b16 v[68:69], v6 offset:24576
  v_smfmac_f32_16x16x64_bf16 v[24:27], v[104:107], a[48:55], v0
  s_add_u32 s27, s27, 8192
  ds_read_b64_tr_b16 v[70:71], v6 offset:24640
  ds_read_b64_tr_b16 v[72:73], v6 offset:24832
  v_smfmac_f32_16x16x64_bf16 v[24:27], v[108:111], a[56:63], v0
  s_add_u32 s28, s28, 8192
  ds_read_b64_tr_b16 v[74:75], v6 offset:24896
  ds_read_b64_tr_b16 v[76:77], v6 offset:25088
  v_smfmac_f32_16x16x64_bf16 v[24:27], v[112:115], a[96:103], v0
  s_nop 0
  ds_read_b64_tr_b16 v[78:79], v6 offset:25152
  ds_read_b64_tr_b16 v[80:81], v6 offset:25344
  v_smfmac_f32_16x16x64_bf16 v[24:27], v[84:87], a[104:111], v0
  ds_read_b64_tr_b16 v[82:83], v6 offset:25408
  v_mov_b64 v[96:97], 0
  v_smfmac_f32_16x16x64_bf16 v[24:27], v[88:91], a[144:151], v0
  s_waitcnt lgkmcnt(8)
  s_barrier
  ds_read_b64_tr_b16 v[116:117], v6 offset:26880
  v_smfmac_f32_16x16x64_bf16 v[24:27], v[100:103], a[152:159], v0
  s_waitcnt lgkmcnt(7)
  ds_read_b64_tr_b16 v[118:119], v6 offset:26944
  v_mfma_f32_16x16x32_bf16 v[16:19], v[36:39], v[68:71], 0
  s_waitcnt lgkmcnt(6)
  ds_read_b64_tr_b16 v[124:125], v6 offset:27136
  ds_read_b64_tr_b16 v[126:127], v6 offset:27200
  v_mfma_f32_16x16x32_bf16 v[16:19], v[40:43], v[72:75], v[16:19]
  s_waitcnt lgkmcnt(6)
  ds_read_b64_tr_b16 v[104:105], v6 offset:27392
  ds_read_b64_tr_b16 v[106:107], v6 offset:27456
  v_mfma_f32_16x16x32_bf16 v[16:19], v[44:47], v[76:79], v[16:19]
  s_waitcnt lgkmcnt(6)
  ds_read_b64_tr_b16 v[108:109], v6 offset:27648
  ds_read_b64_tr_b16 v[110:111], v6 offset:27712
  v_mfma_f32_16x16x32_bf16 v[16:19], v[48:51], v[80:83], v[16:19]
  s_waitcnt lgkmcnt(6)
  v_cvt_pk_bf16_f32 v120, v24, v25
  v_cvt_pk_bf16_f32 v121, v26, v27
  v_mfma_f32_16x16x32_bf16 v[112:115], v[116:119], v[68:71], 0
  s_waitcnt lgkmcnt(4)
  buffer_store_dwordx4 v[120:123], v2, s[4:7], s29 offen offset:1024 sc1
  v_mov_b64 v[98:99], 0
  v_mfma_f32_16x16x32_bf16 v[112:115], v[124:127], v[72:75], v[112:115]
  s_waitcnt lgkmcnt(2)
  v_mov_b64 v[36:37], 0
  v_exp_f32 v100, v16
  v_mfma_f32_16x16x32_bf16 v[112:115], v[104:107], v[76:79], v[112:115]
  s_waitcnt lgkmcnt(0)
  v_exp_f32 v101, v17
  v_mfma_f32_16x16x32_bf16 v[112:115], v[108:111], v[80:83], v[112:115]
  s_add_u32 s29, s29, 131072
  v_exp_f32 v102, v18
  v_mfma_f32_16x16x32_bf16 v[20:23], v[52:55], v[68:71], 0
  s_cmp_eq_u32 s14, 63
  v_exp_f32 v103, v19
  v_mfma_f32_16x16x32_bf16 v[20:23], v[56:59], v[72:75], v[20:23]
  s_cbranch_scc1 M_tdone
  v_cvt_pk_bf16_f32 v44, v100, v101
  v_cvt_pk_bf16_f32 v45, v102, v103
  v_mfma_f32_16x16x32_bf16 v[20:23], v[60:63], v[76:79], v[20:23]
  v_exp_f32 v100, v112
  v_mfma_f32_16x16x32_bf16 v[20:23], v[64:67], v[80:83], v[20:23]
  v_exp_f32 v101, v113
  v_exp_f32 v102, v114
  v_exp_f32 v103, v115
  v_cvt_pk_bf16_f32 v84, v100, v101
  v_cvt_pk_bf16_f32 v85, v102, v103
  v_cndmask_b32 v48, v84, 0, s[16:17]
  v_cndmask_b32 v49, v85, 0, s[16:17]
  v_cndmask_b32 v50, 0, v84, s[16:17]
  v_cndmask_b32 v51, 0, v85, s[16:17]
  v_exp_f32 v100, v20
  v_mfma_f32_16x16x16_bf16 v[88:91], v[12:13], v[48:49], 0
  v_exp_f32 v101, v21
  v_mfma_f32_16x16x16_bf16 v[24:27], v[120:121], v[48:49], 0
  v_exp_f32 v102, v22
  v_mfma_f32_16x16x16_bf16 v[116:119], v[120:121], v[50:51], 0
  v_exp_f32 v103, v23
  v_cvt_pk_bf16_f32 v46, v100, v101
  v_cvt_pk_bf16_f32 v47, v102, v103
  v_mov_b64 v[38:39], 0
  s_nop 0
  v_mfma_f32_16x16x32_bf16 v[88:91], v[12:15], v[44:47], v[88:91]
  v_mov_b64 v[40:41], 0
  v_mov_b64 v[42:43], 0
  v_mfma_f32_16x16x32_bf16 v[24:27], v[28:31], v[44:47], v[24:27]
  ds_read_b128 v[52:55], v4 offset:24576
  ds_read_b128 v[56:59], v4 offset:25600
  v_mfma_f32_16x16x32_bf16 v[116:119], v[32:35], v[44:47], v[116:119]
  s_nop 1
  v_rcp_f32 v89, v88
  v_subrev_u32 v100, s54, v88
  v_cmp_le_u32 vcc, s55, v100
  v_mul_f32 v24, v89, v24
  v_mul_f32 v25, v89, v25
  s_cbranch_vccnz T_slow_106
T_back_107:
  v_cvt_pk_bf16_f32 v124, v24, v25
  v_pk_mul_f32 v[26:27], v[26:27], v[88:89] op_sel:[0,1] op_sel_hi:[1,1]
  v_pk_mul_f32 v[116:117], v[116:117], v[88:89] op_sel:[0,1] op_sel_hi:[1,1]
  v_pk_mul_f32 v[118:119], v[118:119], v[88:89] op_sel:[0,1] op_sel_hi:[1,1]
  v_cvt_pk_bf16_f32 v125, v26, v27
  v_cvt_pk_bf16_f32 v126, v116, v117
  v_cvt_pk_bf16_f32 v127, v118, v119
  ds_write_b128 v11, v[124:127] offset:29696
  s_nop 0
  v_smfmac_f32_16x16x64_bf16 v[92:95], v[124:127], a[160:167], v0
  v_smfmac_f32_16x16x64_bf16 v[96:99], v[124:127], a[168:175], v0
  v_smfmac_f32_16x16x64_bf16 v[36:39], v[124:127], a[176:183], v0
  v_smfmac_f32_16x16x64_bf16 v[40:43], v[124:127], a[184:191], v0
  s_waitcnt lgkmcnt(0)
  s_barrier
  ds_read_b128 v[104:107], v11 offset:29184
  ds_read_b128 v[108:111], v11 offset:30720
  ds_read_b128 v[68:71], v11 offset:30208
  s_waitcnt lgkmcnt(2)
  v_smfmac_f32_16x16x64_bf16 v[92:95], v[104:107], a[192:199], v0
  s_waitcnt lgkmcnt(1)
  ds_read_b128 v[76:79], v4 offset:28672
  v_smfmac_f32_16x16x64_bf16 v[92:95], v[108:111], a[224:231], v0
  s_waitcnt lgkmcnt(1)
  ds_read_b128 v[80:83], v4 offset:29696
  v_smfmac_f32_16x16x64_bf16 v[92:95], v[68:71], a[240:247], v0
  ds_read_b128 v[60:63], v4 offset:26624
  v_smfmac_f32_16x16x64_bf16 v[96:99], v[104:107], a[200:207], v0
  ds_read_b128 v[64:67], v4 offset:27648
  v_smfmac_f32_16x16x64_bf16 v[96:99], v[108:111], a[232:239], v0
  ds_read_b128 v[28:31], v4 offset:30720
  s_nop 0
  v_cvt_pk_bf16_f32 v16, v92, v93
  v_cvt_pk_bf16_f32 v17, v94, v95
  v_bfi_b32 v16, 1, s57, v16
  v_smfmac_f32_16x16x64_bf16 v[96:99], v[68:71], a[248:255], v0
  buffer_store_dwordx2 v[16:17], v7, s[4:7], s20 offen offset:0
  v_smfmac_f32_16x16x64_bf16 v[36:39], v[104:107], a[208:215], v0
  ds_read_b128 v[32:35], v4 offset:31744
  v_smfmac_f32_16x16x64_bf16 v[36:39], v[108:111], v[52:59], v0
  s_waitcnt lgkmcnt(4)
  s_nop 0
  v_cvt_pk_bf16_f32 v18, v96, v97
  v_cvt_pk_bf16_f32 v19, v98, v99
  v_bfi_b32 v18, 1, s57, v18
  v_smfmac_f32_16x16x64_bf16 v[36:39], v[68:71], v[76:83], v0
  buffer_store_dwordx2 v[18:19], v7, s[4:7], s20 offen offset:64
  v_smfmac_f32_16x16x64_bf16 v[40:43], v[104:107], a[216:223], v0
  s_waitcnt lgkmcnt(2)
  ds_read_b128 v[116:119], v2 offset:31232
  v_smfmac_f32_16x16x64_bf16 v[40:43], v[108:111], v[60:67], v0
  s_waitcnt lgkmcnt(1)
  s_nop 0
  v_cvt_pk_bf16_f32 v20, v36, v37
  v_cvt_pk_bf16_f32 v21, v38, v39
  v_bfi_b32 v20, 1, s57, v20
  v_smfmac_f32_16x16x64_bf16 v[40:43], v[68:71], v[28:35], v0
  buffer_store_dwordx2 v[20:21], v7, s[4:7], s21 offen offset:0
  s_nop 6
  v_cvt_pk_bf16_f32 v22, v40, v41
  v_cvt_pk_bf16_f32 v23, v42, v43
  v_bfi_b32 v22, 1, s57, v22
  buffer_store_dwordx2 v[22:23], v7, s[4:7], s21 offen offset:64
  ds_read_b128 v[68:71], v4 offset:0
  ds_read_b128 v[72:75], v4 offset:1024
  ds_read_b128 v[76:79], v4 offset:4096
  ds_read_b128 v[80:83], v4 offset:5120
  ds_read_b128 v[84:87], v4 offset:8192
  ds_read_b128 v[88:91], v4 offset:9216
  ds_read_b128 v[92:95], v4 offset:2048
  ds_read_b128 v[96:99], v4 offset:3072
  ds_read_b128 v[100:103], v4 offset:6144
  ds_read_b128 v[104:107], v4 offset:7168
  ds_read_b128 v[108:111], v4 offset:10240
  ds_read_b128 v[112:115], v4 offset:11264
  v_mov_b64 v[16:17], 0
  v_mov_b64 v[18:19], 0
  v_mov_b64 v[20:21], 0
  v_mov_b64 v[22:23], 0
  v_mov_b64 v[24:25], 0
  v_mov_b64 v[26:27], 0
  s_mov_b32 s19, 0
  v_mov_b32 v49, -1
  ds_read_b64 v[44:45], v2 offset:32256
  s_waitcnt lgkmcnt(0)
  v_readfirstlane_b32 s38, v44
  v_readfirstlane_b32 s37, v45
  s_nop 0
  s_add_u32 s37, s37, 30
  s_cmp_ge_u32 s38, 30
  s_cselect_b32 s38, s37, s38
  s_cmp_ge_u32 s38, 64
  s_cselect_b32 s38, 100, s38
  s_sub_u32 s38, s38, 1
  s_max_i32 s30, s30, s38
  s_waitcnt vmcnt(0)
  buffer_load_dwordx4 v[52:55], v2, s[4:7], s22 offen offset:0 sc1
  buffer_load_dwordx4 v[56:59], v2, s[4:7], s22 offen offset:1024 sc1
  buffer_load_dwordx4 v[60:63], v2, s[4:7], s22 offen offset:2048 sc1
  buffer_load_dwordx4 v[64:67], v2, s[4:7], s22 offen offset:3072 sc1
  s_waitcnt lgkmcnt(12)
  s_waitcnt vmcnt(3)
  v_mfma_f32_16x16x32_bf16 v[120:123], v[116:119], v[52:55], 0
  v_xor_b32 v48, s57, v52
  v_bitop3_b32 v48, v48, v54, s57 bitop3:0xf6
  s_waitcnt vmcnt(2)
  v_mfma_f32_16x16x32_bf16 v[120:123], v[116:119], v[56:59], v[120:123]
  v_bitop3_b32 v48, v48, v56, s57 bitop3:0xf6
  v_bitop3_b32 v48, v48, v58, s57 bitop3:0xf6
  s_waitcnt vmcnt(1)
  v_mfma_f32_16x16x32_bf16 v[120:123], v[116:119], v[60:63], v[120:123]
  v_bitop3_b32 v48, v48, v60, s57 bitop3:0xf6
  v_bitop3_b32 v48, v48, v62, s57 bitop3:0xf6
  s_waitcnt vmcnt(0)
  v_mfma_f32_16x16x32_bf16 v[120:123], v[116:119], v[64:67], v[120:123]
  v_bitop3_b32 v48, v48, v64, s57 bitop3:0xf6
  v_bitop3_b32 v48, v48, v66, s57 bitop3:0xf6
  v_and_b32 v48, 1, v48
  v_cmp_ne_u32 vcc, 0, v48
  s_cbranch_vccnz T_p1re_109
T_p1ok_110:
  s_nop 2
  v_add_f32_dpp v120, v120, v120 row_ror:8 row_mask:0xf bank_mask:0xf
  v_add_f32_dpp v121, v121, v121 row_ror:8 row_mask:0xf bank_mask:0xf
  v_cvt_pk_bf16_f32 v48, v120, v121
  v_min_u32 v48, -2, v48
  buffer_store_dword v48, v8, s[4:7], s35 offen
  buffer_store_dword v49, v8, s[4:7], s26 offen
  s_barrier
  ds_read_b128 v[28:31], v2 offset:17408
  ds_read_b128 v[32:35], v2 offset:21504
  ds_read_b128 v[36:39], v2 offset:8192
  ds_read_b128 v[40:43], v2 offset:9216
  ds_read_b128 v[44:47], v2 offset:10240
  ds_read_b128 v[48:51], v2 offset:11264
  buffer_load_dwordx4 v[124:127], v3, s[4:7], s24 offen offset:1024 sc1
  buffer_load_dwordx4 v[116:119], v3, s[4:7], s25 offen offset:1024 sc1
  ds_read_b128 v[52:55], v2 offset:12288
  ds_read_b128 v[56:59], v2 offset:13312
  ds_read_b128 v[60:63], v2 offset:14336
  ds_read_b128 v[64:67], v2 offset:15360
  buffer_load_dwordx4 v[124:127], v3, s[4:7], s24 offen offset:1024 sc1
  buffer_load_dwordx4 v[116:119], v3, s[4:7], s25 offen offset:1024 sc1
  s_mov_b32 s19, 0
  s_branch T_loop_99
T_p1re_109:
  s_mov_b64 exec, vcc
  buffer_load_dwordx4 v[52:55], v2, s[4:7], s22 offen offset:0 sc1
  buffer_load_dwordx4 v[56:59], v2, s[4:7], s22 offen offset:1024 sc1
  buffer_load_dwordx4 v[60:63], v2, s[4:7], s22 offen offset:2048 sc1
  buffer_load_dwordx4 v[64:67], v2, s[4:7], s22 offen offset:3072 sc1
  s_mov_b64 exec, -1
  s_add_u32 s19, s19, 1
  s_cmp_gt_u32 s19, 32768
  s_cbranch_scc1 M_exit
  s_waitcnt vmcnt(3)
  v_mfma_f32_16x16x32_bf16 v[120:123], v[116:119], v[52:55], 0
  v_xor_b32 v48, s57, v52
  v_bitop3_b32 v48, v48, v54, s57 bitop3:0xf6
  s_waitcnt vmcnt(2)
  v_mfma_f32_16x16x32_bf16 v[120:123], v[116:119], v[56:59], v[120:123]
  v_bitop3_b32 v48, v48, v56, s57 bitop3:0xf6
  v_bitop3_b32 v48, v48, v58, s57 bitop3:0xf6
  s_waitcnt vmcnt(1)
  v_mfma_f32_16x16x32_bf16 v[120:123], v[116:119], v[60:63], v[120:123]
  v_bitop3_b32 v48, v48, v60, s57 bitop3:0xf6
  v_bitop3_b32 v48, v48, v62, s57 bitop3:0xf6
  s_waitcnt vmcnt(0)
  v_mfma_f32_16x16x32_bf16 v[120:123], v[116:119], v[64:67], v[120:123]
  v_bitop3_b32 v48, v48, v64, s57 bitop3:0xf6
  v_bitop3_b32 v48, v48, v66, s57 bitop3:0xf6
  v_and_b32 v48, 1, v48
  v_cmp_ne_u32 vcc, 0, v48
  s_cbranch_vccnz T_p1re_109
  s_branch T_p1ok_110
T_kvw_103:
  s_mov_b32 s19, 0
  s_branch T_kvok_112
T_kv_111:
  s_sleep 4
  s_add_u32 s19, s19, 1
  s_cmp_gt_u32 s19, 32768
  s_cbranch_scc1 M_exit
T_kvok_112:
  s_add_u32 s39, s99, 128
  s_mov_b32 s38, 0
  s_mov_b32 s37, 0
  s_atomic_or s38, s[58:59], s99 glc
  s_atomic_or s37, s[58:59], s39 glc
  s_waitcnt lgkmcnt(0)
  s_add_u32 s37, s37, 30
  s_cmp_ge_u32 s38, 30
  s_cselect_b32 s38, s37, s38
  s_cmp_ge_u32 s38, 64
  s_cselect_b32 s38, 100, s38
  s_sub_u32 s38, s38, 1
  s_max_i32 s30, s30, s38
  s_cmp_ge_i32 s14, s30
  s_cbranch_scc1 T_kv_111
  s_branch T_kvb_104
T_slow_106:
  s_nop 7
  v_max3_f32 v100, v16, v17, v18
  v_max3_f32 v100, v100, v19, v20
  v_max3_f32 v100, v100, v21, v22
  v_max3_f32 v100, v100, v23, v112
  v_max3_f32 v100, v100, v113, v114
  v_max_f32 v100, v100, v115
  v_mov_b32 v101, v100
  s_nop 1
  v_permlane32_swap_b32 v100, v101
  s_nop 1
  v_max_f32 v100, v100, v101
  v_mov_b32 v101, v100
  s_nop 1
  v_permlane16_swap_b32 v100, v101
  s_nop 1
  v_max_f32 v100, v100, v101
  v_sub_f32 v16, v16, v100
  v_sub_f32 v17, v17, v100
  v_sub_f32 v18, v18, v100
  v_sub_f32 v19, v19, v100
  v_exp_f32 v16, v16
  v_exp_f32 v17, v17
  v_exp_f32 v18, v18
  v_exp_f32 v19, v19
  v_sub_f32 v20, v20, v100
  v_sub_f32 v21, v21, v100
  v_sub_f32 v22, v22, v100
  v_sub_f32 v23, v23, v100
  v_exp_f32 v20, v20
  v_exp_f32 v21, v21
  v_exp_f32 v22, v22
  v_exp_f32 v23, v23
  v_sub_f32 v112, v112, v100
  v_sub_f32 v113, v113, v100
  v_sub_f32 v114, v114, v100
  v_sub_f32 v115, v115, v100
  v_exp_f32 v112, v112
  v_exp_f32 v113, v113
  v_exp_f32 v114, v114
  v_exp_f32 v115, v115
  s_nop 0
  v_cvt_pk_bf16_f32 v44, v16, v17
  v_cvt_pk_bf16_f32 v45, v18, v19
  v_cvt_pk_bf16_f32 v46, v20, v21
  v_cvt_pk_bf16_f32 v47, v22, v23
  v_cvt_pk_bf16_f32 v84, v112, v113
  v_cvt_pk_bf16_f32 v85, v114, v115
  v_cndmask_b32 v48, v84, 0, s[16:17]
  v_cndmask_b32 v49, v85, 0, s[16:17]
  v_cndmask_b32 v50, 0, v84, s[16:17]
  v_cndmask_b32 v51, 0, v85, s[16:17]
  s_nop 1
  v_mfma_f32_16x16x16_bf16 v[88:91], v[12:13], v[48:49], 0
  v_mfma_f32_16x16x16_bf16 v[24:27], v[120:121], v[48:49], 0
  v_mfma_f32_16x16x16_bf16 v[116:119], v[120:121], v[50:51], 0
  v_mfma_f32_16x16x32_bf16 v[88:91], v[12:15], v[44:47], v[88:91]
  v_mfma_f32_16x16x32_bf16 v[24:27], v[28:31], v[44:47], v[24:27]
  v_mfma_f32_16x16x32_bf16 v[116:119], v[32:35], v[44:47], v[116:119]
  s_nop 7
  s_nop 1
  v_rcp_f32 v89, v88
  s_nop 0
  v_mul_f32 v24, v89, v24
  v_mul_f32 v25, v89, v25
  s_branch T_back_107
T_w_83:
  s_mov_b32 s19, 0
  v_mov_b64 v[16:17], 0
  v_mov_b64 v[18:19], 0
  v_mov_b64 v[20:21], 0
  v_mov_b64 v[22:23], 0
  v_mov_b64 v[24:25], 0
  v_mov_b64 v[26:27], 0
  buffer_load_dwordx4 v[124:127], v3, s[4:7], s24 offen offset:2048 sc1
  buffer_load_dwordx4 v[116:119], v3, s[4:7], s25 offen offset:2048 sc1
  buffer_load_dwordx4 v[124:127], v3, s[4:7], s24 offen offset:2048 sc1
  buffer_load_dwordx4 v[116:119], v3, s[4:7], s25 offen offset:2048 sc1
  s_branch T_loop_113
.p2align 6
T_retry_114:
  s_mov_b64 exec, vcc
  buffer_load_dwordx4 v[124:127], v3, s[4:7], s24 offen offset:2048 sc1
  buffer_load_dwordx4 v[116:119], v3, s[4:7], s25 offen offset:2048 sc1
  s_mov_b64 exec, -1
  s_add_u32 s19, s19, 1
  s_cmp_gt_u32 s19, 32768
  s_cbranch_scc1 M_exit
T_loop_113:
  s_waitcnt vmcnt(3) lgkmcnt(0)
  v_max3_u32 v123, v124, v125, v126
  v_max_u32 v123, v123, v127
  v_mov_b32_dpp v120, v124 row_ror:8 row_mask:0xf bank_mask:0xf
  v_mov_b32_dpp v121, v125 row_ror:8 row_mask:0xf bank_mask:0xf
  s_waitcnt vmcnt(2)
  v_max3_u32 v123, v123, v116, v117
  v_max3_u32 v123, v123, v118, v119
  v_cmp_eq_u32 vcc, -1, v123
  s_cbranch_vccnz T_retry_114
  v_smfmac_f32_16x16x64_bf16 v[16:19], v[124:127], v[68:75], v0
  s_add_u32 s14, s14, 1
  ds_write_b128 v2, v[124:127] offset:2048
  v_mov_b32_dpp v122, v126 row_ror:8 row_mask:0xf bank_mask:0xf
  v_smfmac_f32_16x16x64_bf16 v[20:23], v[124:127], v[76:83], v0
  s_and_b32 s57, s14, 1
  v_mov_b32_dpp v123, v127 row_ror:8 row_mask:0xf bank_mask:0xf
  v_smfmac_f32_16x16x64_bf16 v[24:27], v[124:127], v[84:91], v0
  s_and_b32 s36, s14, 3
  ds_write_b128 v2, v[116:119] offset:6144
  v_smfmac_f32_16x16x64_bf16 v[16:19], v[120:123], v[92:99], v0
  s_lshl_b32 s36, s36, 13
  v_mov_b32_dpp v84, v116 row_ror:8 row_mask:0xf bank_mask:0xf
  v_smfmac_f32_16x16x64_bf16 v[20:23], v[120:123], v[100:107], v0
  s_add_u32 s26, s36, s23
  ds_read_b128 v[68:71], v4 offset:12288
  v_mov_b32_dpp v85, v117 row_ror:8 row_mask:0xf bank_mask:0xf
  v_smfmac_f32_16x16x64_bf16 v[24:27], v[120:123], v[108:115], v0
  s_add_u32 s36, s36, 8192
  ds_read_b128 v[72:75], v4 offset:13312
  v_mov_b32_dpp v86, v118 row_ror:8 row_mask:0xf bank_mask:0xf
  v_smfmac_f32_16x16x64_bf16 v[16:19], v[116:119], v[224:231], v0
  s_and_b32 s36, s36, 0x7fff
  ds_read_b128 v[76:79], v4 offset:14336
  v_mov_b32_dpp v87, v119 row_ror:8 row_mask:0xf bank_mask:0xf
  v_smfmac_f32_16x16x64_bf16 v[20:23], v[116:119], v[240:247], v0
  s_waitcnt lgkmcnt(3)
  s_barrier
  ds_read_b128 v[100:103], v2 offset:3072
  v_smfmac_f32_16x16x64_bf16 v[24:27], v[116:119], a[0:7], v0
  s_mov_b32 m0, s31
  ds_read_b128 v[120:123], v1 offset:3072
  v_smfmac_f32_16x16x64_bf16 v[16:19], v[84:87], v[232:239], v0
  s_cmp_ge_i32 s14, s30
  s_cbranch_scc1 T_kvw_117
T_kvb_118:
  v_smfmac_f32_16x16x64_bf16 v[20:23], v[84:87], v[248:255], v0
  ds_read_b128 v[80:83], v4 offset:15360
  v_smfmac_f32_16x16x64_bf16 v[24:27], v[84:87], a[8:15], v0
  s_waitcnt lgkmcnt(2)
  v_smfmac_f32_16x16x64_bf16 v[16:19], v[100:103], v[128:135], v0
  ds_read_b128 v[92:95], v2 offset:0
  buffer_load_dwordx4 v9, s[4:7], s27 offen sc1 lds
  v_smfmac_f32_16x16x64_bf16 v[20:23], v[100:103], v[144:151], v0
  ds_read_b128 v[96:99], v1 offset:0
  s_mov_b32 m0, s32
  v_smfmac_f32_16x16x64_bf16 v[24:27], v[100:103], v[68:75], v0
  s_waitcnt vmcnt(1) lgkmcnt(3)
  ds_read_b128 v[116:119], v2 offset:1024
  v_smfmac_f32_16x16x64_bf16 v[16:19], v[120:123], v[136:143], v0
  ds_read_b128 v[124:127], v1 offset:1024
  v_smfmac_f32_16x16x64_bf16 v[20:23], v[120:123], v[152:159], v0
  s_waitcnt lgkmcnt(4)
  ds_read_b128 v[104:107], v2 offset:7168
  buffer_load_dwordx4 v9, s[4:7], s27 offen offset:128 sc1 lds
  v_smfmac_f32_16x16x64_bf16 v[24:27], v[120:123], v[76:83], v0
  s_waitcnt lgkmcnt(4)
  ds_read_b128 v[108:111], v1 offset:7168
  s_mov_b32 m0, s33
  v_smfmac_f32_16x16x64_bf16 v[16:19], v[92:95], v[160:167], v0
  s_waitcnt lgkmcnt(4)
  ds_read_b128 v[112:115], v2 offset:4096
  v_mov_b32 v122, s98
  v_smfmac_f32_16x16x64_bf16 v[16:19], v[96:99], v[168:175], v0
  s_waitcnt lgkmcnt(4)
  ds_read_b128 v[84:87], v1 offset:4096
  v_smfmac_f32_16x16x64_bf16 v[16:19], v[116:119], v[192:199], v0
  s_waitcnt lgkmcnt(4)
  ds_read_b128 v[88:91], v2 offset:5120
  buffer_load_dwordx4 v10, s[4:7], s28 offen sc1 lds
  v_smfmac_f32_16x16x64_bf16 v[16:19], v[124:127], v[200:207], v0
  s_waitcnt lgkmcnt(4)
  ds_read_b128 v[100:103], v1 offset:5120
  s_mov_b32 m0, s34
  v_smfmac_f32_16x16x64_bf16 v[16:19], v[104:107], a[16:23], v0
  s_waitcnt lgkmcnt(4)
  ds_read_b128 v[68:71], v4 offset:16384
  v_smfmac_f32_16x16x64_bf16 v[16:19], v[108:111], a[24:31], v0
  s_waitcnt lgkmcnt(4)
  ds_read_b128 v[72:75], v4 offset:17408
  v_smfmac_f32_16x16x64_bf16 v[16:19], v[112:115], a[64:71], v0
  s_waitcnt lgkmcnt(4)
  ds_read_b128 v[76:79], v4 offset:18432
  buffer_load_dwordx4 v10, s[4:7], s28 offen offset:256 sc1 lds
  v_smfmac_f32_16x16x64_bf16 v[16:19], v[84:87], a[72:79], v0
  s_waitcnt lgkmcnt(4)
  ds_read_b128 v[80:83], v4 offset:19456
  v_smfmac_f32_16x16x64_bf16 v[16:19], v[88:91], a[112:119], v0
  s_waitcnt lgkmcnt(4)
  v_smfmac_f32_16x16x64_bf16 v[16:19], v[100:103], a[120:127], v0
  s_add_u32 s24, s36, 145752064
  s_add_u32 s25, s36, 145756160
  v_smfmac_f32_16x16x64_bf16 v[20:23], v[92:95], v[176:183], v0
  buffer_store_dword v122, v8, s[4:7], s15 offen sc1
  s_add_u32 s35, s36, s23
  v_smfmac_f32_16x16x64_bf16 v[20:23], v[96:99], v[184:191], v0
  s_waitcnt lgkmcnt(2)
  s_add_u32 s98, s14, 1
  v_smfmac_f32_16x16x64_bf16 v[20:23], v[116:119], v[68:75], v0
  s_waitcnt lgkmcnt(0)
  ds_read_b128 v[68:71], v4 offset:20480
  v_mul_f32 v16, s18, v16
  v_smfmac_f32_16x16x64_bf16 v[20:23], v[124:127], v[76:83], v0
  ds_read_b128 v[72:75], v4 offset:21504
  v_mul_f32 v17, s18, v17
  v_smfmac_f32_16x16x64_bf16 v[20:23], v[104:107], a[32:39], v0
  ds_read_b128 v[76:79], v4 offset:22528
  v_mul_f32 v18, s18, v18
  v_smfmac_f32_16x16x64_bf16 v[20:23], v[108:111], a[40:47], v0
  ds_read_b128 v[80:83], v4 offset:23552
  v_mul_f32 v19, s18, v19
  v_smfmac_f32_16x16x64_bf16 v[20:23], v[112:115], a[80:87], v0
  v_cvt_pk_bf16_f32 v120, v16, v17
  v_smfmac_f32_16x16x64_bf16 v[20:23], v[84:87], a[88:95], v0
  v_cvt_pk_bf16_f32 v121, v18, v19
  v_smfmac_f32_16x16x64_bf16 v[20:23], v[88:91], a[128:135], v0
  ds_write_b64 v5, v[120:121] offset:24576
  v_smfmac_f32_16x16x64_bf16 v[20:23], v[100:103], a[136:143], v0
  s_waitcnt lgkmcnt(3)
  v_smfmac_f32_16x16x64_bf16 v[24:27], v[92:95], v[68:75], v0
  s_waitcnt lgkmcnt(1)
  v_mov_b64 v[92:93], 0
  v_smfmac_f32_16x16x64_bf16 v[24:27], v[96:99], v[76:83], v0
  s_nop 1
  v_cvt_pk_bf16_f32 v122, v20, v21
  v_cvt_pk_bf16_f32 v123, v22, v23
  v_smfmac_f32_16x16x64_bf16 v[24:27], v[116:119], v[208:215], v0
  ds_write_b64 v5, v[122:123] offset:26880
  v_mov_b64 v[94:95], 0
  v_smfmac_f32_16x16x64_bf16 v[24:27], v[124:127], v[216:223], v0
  s_waitcnt lgkmcnt(1)
  s_barrier
  ds_read_b64_tr_b16 v[68:69], v6 offset:24576
  v_smfmac_f32_16x16x64_bf16 v[24:27], v[104:107], a[48:55], v0
  s_add_u32 s27, s27, 8192
  ds_read_b64_tr_b16 v[70:71], v6 offset:24640
  ds_read_b64_tr_b16 v[72:73], v6 offset:24832
  v_smfmac_f32_16x16x64_bf16 v[24:27], v[108:111], a[56:63], v0
  s_add_u32 s28, s28, 8192
  ds_read_b64_tr_b16 v[74:75], v6 offset:24896
  ds_read_b64_tr_b16 v[76:77], v6 offset:25088
  v_smfmac_f32_16x16x64_bf16 v[24:27], v[112:115], a[96:103], v0
  s_nop 0
  ds_read_b64_tr_b16 v[78:79], v6 offset:25152
  ds_read_b64_tr_b16 v[80:81], v6 offset:25344
  v_smfmac_f32_16x16x64_bf16 v[24:27], v[84:87], a[104:111], v0
  ds_read_b64_tr_b16 v[82:83], v6 offset:25408
  v_mov_b64 v[96:97], 0
  v_smfmac_f32_16x16x64_bf16 v[24:27], v[88:91], a[144:151], v0
  s_waitcnt lgkmcnt(8)
  s_barrier
  ds_read_b64_tr_b16 v[116:117], v6 offset:26880
  v_smfmac_f32_16x16x64_bf16 v[24:27], v[100:103], a[152:159], v0
  s_waitcnt lgkmcnt(7)
  ds_read_b64_tr_b16 v[118:119], v6 offset:26944
  v_mfma_f32_16x16x32_bf16 v[16:19], v[36:39], v[68:71], 0
  s_waitcnt lgkmcnt(6)
  ds_read_b64_tr_b16 v[124:125], v6 offset:27136
  ds_read_b64_tr_b16 v[126:127], v6 offset:27200
  v_mfma_f32_16x16x32_bf16 v[16:19], v[40:43], v[72:75], v[16:19]
  s_waitcnt lgkmcnt(6)
  ds_read_b64_tr_b16 v[104:105], v6 offset:27392
  ds_read_b64_tr_b16 v[106:107], v6 offset:27456
  v_mfma_f32_16x16x32_bf16 v[16:19], v[44:47], v[76:79], v[16:19]
  s_waitcnt lgkmcnt(6)
  ds_read_b64_tr_b16 v[108:109], v6 offset:27648
  ds_read_b64_tr_b16 v[110:111], v6 offset:27712
  v_mfma_f32_16x16x32_bf16 v[16:19], v[48:51], v[80:83], v[16:19]
  s_waitcnt lgkmcnt(6)
  v_cvt_pk_bf16_f32 v120, v24, v25
  v_cvt_pk_bf16_f32 v121, v26, v27
  v_mfma_f32_16x16x32_bf16 v[112:115], v[116:119], v[68:71], 0
  s_waitcnt lgkmcnt(4)
  buffer_store_dwordx4 v[120:123], v2, s[4:7], s29 offen offset:2048 sc1
  v_mov_b64 v[98:99], 0
  v_mfma_f32_16x16x32_bf16 v[112:115], v[124:127], v[72:75], v[112:115]
  s_waitcnt lgkmcnt(2)
  v_mov_b64 v[36:37], 0
  v_exp_f32 v100, v16
  v_mfma_f32_16x16x32_bf16 v[112:115], v[104:107], v[76:79], v[112:115]
  s_waitcnt lgkmcnt(0)
  v_exp_f32 v101, v17
  v_mfma_f32_16x16x32_bf16 v[112:115], v[108:111], v[80:83], v[112:115]
  s_add_u32 s29, s29, 131072
  v_exp_f32 v102, v18
  v_mfma_f32_16x16x32_bf16 v[20:23], v[52:55], v[68:71], 0
  s_cmp_eq_u32 s14, 63
  v_exp_f32 v103, v19
  v_mfma_f32_16x16x32_bf16 v[20:23], v[56:59], v[72:75], v[20:23]
  s_cbranch_scc1 M_tdone
  v_cvt_pk_bf16_f32 v44, v100, v101
  v_cvt_pk_bf16_f32 v45, v102, v103
  v_mfma_f32_16x16x32_bf16 v[20:23], v[60:63], v[76:79], v[20:23]
  v_exp_f32 v100, v112
  v_mfma_f32_16x16x32_bf16 v[20:23], v[64:67], v[80:83], v[20:23]
  v_exp_f32 v101, v113
  v_exp_f32 v102, v114
  v_exp_f32 v103, v115
  v_cvt_pk_bf16_f32 v84, v100, v101
  v_cvt_pk_bf16_f32 v85, v102, v103
  v_cndmask_b32 v48, v84, 0, s[16:17]
  v_cndmask_b32 v49, v85, 0, s[16:17]
  v_cndmask_b32 v50, 0, v84, s[16:17]
  v_cndmask_b32 v51, 0, v85, s[16:17]
  v_exp_f32 v100, v20
  v_mfma_f32_16x16x16_bf16 v[88:91], v[12:13], v[48:49], 0
  v_exp_f32 v101, v21
  v_mfma_f32_16x16x16_bf16 v[24:27], v[120:121], v[48:49], 0
  v_exp_f32 v102, v22
  v_mfma_f32_16x16x16_bf16 v[116:119], v[120:121], v[50:51], 0
  v_exp_f32 v103, v23
  v_cvt_pk_bf16_f32 v46, v100, v101
  v_cvt_pk_bf16_f32 v47, v102, v103
  v_mov_b64 v[38:39], 0
  s_nop 0
  v_mfma_f32_16x16x32_bf16 v[88:91], v[12:15], v[44:47], v[88:91]
  v_mov_b64 v[40:41], 0
  v_mov_b64 v[42:43], 0
  v_mfma_f32_16x16x32_bf16 v[24:27], v[28:31], v[44:47], v[24:27]
  ds_read_b128 v[52:55], v4 offset:24576
  ds_read_b128 v[56:59], v4 offset:25600
  v_mfma_f32_16x16x32_bf16 v[116:119], v[32:35], v[44:47], v[116:119]
  s_nop 1
  v_rcp_f32 v89, v88
  v_subrev_u32 v100, s54, v88
  v_cmp_le_u32 vcc, s55, v100
  v_mul_f32 v24, v89, v24
  v_mul_f32 v25, v89, v25
  s_cbranch_vccnz T_slow_120
T_back_121:
  v_cvt_pk_bf16_f32 v124, v24, v25
  v_pk_mul_f32 v[26:27], v[26:27], v[88:89] op_sel:[0,1] op_sel_hi:[1,1]
  v_pk_mul_f32 v[116:117], v[116:117], v[88:89] op_sel:[0,1] op_sel_hi:[1,1]
  v_pk_mul_f32 v[118:119], v[118:119], v[88:89] op_sel:[0,1] op_sel_hi:[1,1]
  v_cvt_pk_bf16_f32 v125, v26, v27
  v_cvt_pk_bf16_f32 v126, v116, v117
  v_cvt_pk_bf16_f32 v127, v118, v119
  ds_write_b128 v11, v[124:127] offset:30208
  s_nop 0
  v_smfmac_f32_16x16x64_bf16 v[92:95], v[124:127], a[160:167], v0
  v_smfmac_f32_16x16x64_bf16 v[96:99], v[124:127], a[168:175], v0
  v_smfmac_f32_16x16x64_bf16 v[36:39], v[124:127], a[176:183], v0
  v_smfmac_f32_16x16x64_bf16 v[40:43], v[124:127], a[184:191], v0
  s_waitcnt lgkmcnt(0)
  s_barrier
  ds_read_b128 v[104:107], v11 offset:30720
  ds_read_b128 v[108:111], v11 offset:29184
  ds_read_b128 v[68:71], v11 offset:29696
  s_waitcnt lgkmcnt(2)
  v_smfmac_f32_16x16x64_bf16 v[92:95], v[104:107], a[192:199], v0
  s_waitcnt lgkmcnt(1)
  ds_read_b128 v[76:79], v4 offset:28672
  v_smfmac_f32_16x16x64_bf16 v[92:95], v[108:111], a[224:231], v0
  s_waitcnt lgkmcnt(1)
  ds_read_b128 v[80:83], v4 offset:29696
  v_smfmac_f32_16x16x64_bf16 v[92:95], v[68:71], a[240:247], v0
  ds_read_b128 v[60:63], v4 offset:26624
  v_smfmac_f32_16x16x64_bf16 v[96:99], v[104:107], a[200:207], v0
  ds_read_b128 v[64:67], v4 offset:27648
  v_smfmac_f32_16x16x64_bf16 v[96:99], v[108:111], a[232:239], v0
  ds_read_b128 v[28:31], v4 offset:30720
  s_nop 0
  v_cvt_pk_bf16_f32 v16, v92, v93
  v_cvt_pk_bf16_f32 v17, v94, v95
  v_bfi_b32 v16, 1, s57, v16
  v_smfmac_f32_16x16x64_bf16 v[96:99], v[68:71], a[248:255], v0
  buffer_store_dwordx2 v[16:17], v7, s[4:7], s20 offen offset:0
  v_smfmac_f32_16x16x64_bf16 v[36:39], v[104:107], a[208:215], v0
  ds_read_b128 v[32:35], v4 offset:31744
  v_smfmac_f32_16x16x64_bf16 v[36:39], v[108:111], v[52:59], v0
  s_waitcnt lgkmcnt(4)
  s_nop 0
  v_cvt_pk_bf16_f32 v18, v96, v97
  v_cvt_pk_bf16_f32 v19, v98, v99
  v_bfi_b32 v18, 1, s57, v18
  v_smfmac_f32_16x16x64_bf16 v[36:39], v[68:71], v[76:83], v0
  buffer_store_dwordx2 v[18:19], v7, s[4:7], s20 offen offset:64
  v_smfmac_f32_16x16x64_bf16 v[40:43], v[104:107], a[216:223], v0
  s_waitcnt lgkmcnt(2)
  v_smfmac_f32_16x16x64_bf16 v[40:43], v[108:111], v[60:67], v0
  s_waitcnt lgkmcnt(0)
  s_nop 0
  v_cvt_pk_bf16_f32 v20, v36, v37
  v_cvt_pk_bf16_f32 v21, v38, v39
  v_bfi_b32 v20, 1, s57, v20
  v_smfmac_f32_16x16x64_bf16 v[40:43], v[68:71], v[28:35], v0
  buffer_store_dwordx2 v[20:21], v7, s[4:7], s21 offen offset:0
  s_nop 6
  v_cvt_pk_bf16_f32 v22, v40, v41
  v_cvt_pk_bf16_f32 v23, v42, v43
  v_bfi_b32 v22, 1, s57, v22
  buffer_store_dwordx2 v[22:23], v7, s[4:7], s21 offen offset:64
  ds_read_b128 v[68:71], v4 offset:0
  ds_read_b128 v[72:75], v4 offset:1024
  ds_read_b128 v[76:79], v4 offset:4096
  ds_read_b128 v[80:83], v4 offset:5120
  ds_read_b128 v[84:87], v4 offset:8192
  ds_read_b128 v[88:91], v4 offset:9216
  ds_read_b128 v[92:95], v4 offset:2048
  ds_read_b128 v[96:99], v4 offset:3072
  ds_read_b128 v[100:103], v4 offset:6144
  ds_read_b128 v[104:107], v4 offset:7168
  ds_read_b128 v[108:111], v4 offset:10240
  ds_read_b128 v[112:115], v4 offset:11264
  v_mov_b64 v[16:17], 0
  v_mov_b64 v[18:19], 0
  v_mov_b64 v[20:21], 0
  v_mov_b64 v[22:23], 0
  v_mov_b64 v[24:25], 0
  v_mov_b64 v[26:27], 0
  ds_read_b64 v[44:45], v2 offset:32256
  s_waitcnt lgkmcnt(0)
  v_readfirstlane_b32 s38, v44
  v_readfirstlane_b32 s37, v45
  s_nop 0
  s_add_u32 s37, s37, 30
  s_cmp_ge_u32 s38, 30
  s_cselect_b32 s38, s37, s38
  s_cmp_ge_u32 s38, 64
  s_cselect_b32 s38, 100, s38
  s_sub_u32 s38, s38, 1
  s_max_i32 s30, s30, s38
  s_waitcnt vmcnt(4)
  s_barrier
  ds_read_b128 v[28:31], v2 offset:18432
  ds_read_b128 v[32:35], v2 offset:22528
  ds_read_b128 v[36:39], v2 offset:8192
  ds_read_b128 v[40:43], v2 offset:9216
  ds_read_b128 v[44:47], v2 offset:10240
  ds_read_b128 v[48:51], v2 offset:11264
  buffer_load_dwordx4 v[124:127], v3, s[4:7], s24 offen offset:2048 sc1
  buffer_load_dwordx4 v[116:119], v3, s[4:7], s25 offen offset:2048 sc1
  ds_read_b128 v[52:55], v2 offset:12288
  ds_read_b128 v[56:59], v2 offset:13312
  ds_read_b128 v[60:63], v2 offset:14336
  ds_read_b128 v[64:67], v2 offset:15360
  buffer_load_dwordx4 v[124:127], v3, s[4:7], s24 offen offset:2048 sc1
  buffer_load_dwordx4 v[116:119], v3, s[4:7], s25 offen offset:2048 sc1
  s_mov_b32 s19, 0
  s_branch T_loop_113
T_kvw_117:
  s_mov_b32 s19, 0
  s_branch T_kvok_126
T_kv_125:
  s_sleep 4
  s_add_u32 s19, s19, 1
  s_cmp_gt_u32 s19, 32768
  s_cbranch_scc1 M_exit
T_kvok_126:
  s_add_u32 s39, s99, 128
  s_mov_b32 s38, 0
  s_mov_b32 s37, 0
  s_atomic_or s38, s[58:59], s99 glc
  s_atomic_or s37, s[58:59], s39 glc
  s_waitcnt lgkmcnt(0)
  s_add_u32 s37, s37, 30
  s_cmp_ge_u32 s38, 30
  s_cselect_b32 s38, s37, s38
  s_cmp_ge_u32 s38, 64
  s_cselect_b32 s38, 100, s38
  s_sub_u32 s38, s38, 1
  s_max_i32 s30, s30, s38
  s_cmp_ge_i32 s14, s30
  s_cbranch_scc1 T_kv_125
  s_branch T_kvb_118
T_slow_120:
  s_nop 7
  v_max3_f32 v100, v16, v17, v18
  v_max3_f32 v100, v100, v19, v20
  v_max3_f32 v100, v100, v21, v22
  v_max3_f32 v100, v100, v23, v112
  v_max3_f32 v100, v100, v113, v114
  v_max_f32 v100, v100, v115
  v_mov_b32 v101, v100
  s_nop 1
  v_permlane32_swap_b32 v100, v101
  s_nop 1
  v_max_f32 v100, v100, v101
  v_mov_b32 v101, v100
  s_nop 1
  v_permlane16_swap_b32 v100, v101
  s_nop 1
  v_max_f32 v100, v100, v101
  v_sub_f32 v16, v16, v100
  v_sub_f32 v17, v17, v100
  v_sub_f32 v18, v18, v100
  v_sub_f32 v19, v19, v100
  v_exp_f32 v16, v16
  v_exp_f32 v17, v17
  v_exp_f32 v18, v18
  v_exp_f32 v19, v19
  v_sub_f32 v20, v20, v100
  v_sub_f32 v21, v21, v100
  v_sub_f32 v22, v22, v100
  v_sub_f32 v23, v23, v100
  v_exp_f32 v20, v20
  v_exp_f32 v21, v21
  v_exp_f32 v22, v22
  v_exp_f32 v23, v23
  v_sub_f32 v112, v112, v100
  v_sub_f32 v113, v113, v100
  v_sub_f32 v114, v114, v100
  v_sub_f32 v115, v115, v100
  v_exp_f32 v112, v112
  v_exp_f32 v113, v113
  v_exp_f32 v114, v114
  v_exp_f32 v115, v115
  s_nop 0
  v_cvt_pk_bf16_f32 v44, v16, v17
  v_cvt_pk_bf16_f32 v45, v18, v19
  v_cvt_pk_bf16_f32 v46, v20, v21
  v_cvt_pk_bf16_f32 v47, v22, v23
  v_cvt_pk_bf16_f32 v84, v112, v113
  v_cvt_pk_bf16_f32 v85, v114, v115
  v_cndmask_b32 v48, v84, 0, s[16:17]
  v_cndmask_b32 v49, v85, 0, s[16:17]
  v_cndmask_b32 v50, 0, v84, s[16:17]
  v_cndmask_b32 v51, 0, v85, s[16:17]
  s_nop 1
  v_mfma_f32_16x16x16_bf16 v[88:91], v[12:13], v[48:49], 0
  v_mfma_f32_16x16x16_bf16 v[24:27], v[120:121], v[48:49], 0
  v_mfma_f32_16x16x16_bf16 v[116:119], v[120:121], v[50:51], 0
  v_mfma_f32_16x16x32_bf16 v[88:91], v[12:15], v[44:47], v[88:91]
  v_mfma_f32_16x16x32_bf16 v[24:27], v[28:31], v[44:47], v[24:27]
  v_mfma_f32_16x16x32_bf16 v[116:119], v[32:35], v[44:47], v[116:119]
  s_nop 7
  s_nop 1
  v_rcp_f32 v89, v88
  s_nop 0
  v_mul_f32 v24, v89, v24
  v_mul_f32 v25, v89, v25
  s_branch T_back_121
T_w_84:
  s_mov_b32 s19, 0
  v_mov_b64 v[16:17], 0
  v_mov_b64 v[18:19], 0
  v_mov_b64 v[20:21], 0
  v_mov_b64 v[22:23], 0
  v_mov_b64 v[24:25], 0
  v_mov_b64 v[26:27], 0
  buffer_load_dwordx4 v[124:127], v3, s[4:7], s24 offen offset:3072 sc1
  buffer_load_dwordx4 v[116:119], v3, s[4:7], s25 offen offset:3072 sc1
  buffer_load_dwordx4 v[124:127], v3, s[4:7], s24 offen offset:3072 sc1
  buffer_load_dwordx4 v[116:119], v3, s[4:7], s25 offen offset:3072 sc1
  s_branch T_loop_127
.p2align 6
T_retry_128:
  s_mov_b64 exec, vcc
  buffer_load_dwordx4 v[124:127], v3, s[4:7], s24 offen offset:3072 sc1
  buffer_load_dwordx4 v[116:119], v3, s[4:7], s25 offen offset:3072 sc1
  s_mov_b64 exec, -1
  s_add_u32 s19, s19, 1
  s_cmp_gt_u32 s19, 32768
  s_cbranch_scc1 M_exit
T_loop_127:
  s_waitcnt vmcnt(3) lgkmcnt(0)
  v_max3_u32 v123, v124, v125, v126
  v_max_u32 v123, v123, v127
  v_mov_b32_dpp v120, v124 row_ror:8 row_mask:0xf bank_mask:0xf
  v_mov_b32_dpp v121, v125 row_ror:8 row_mask:0xf bank_mask:0xf
  s_waitcnt vmcnt(2)
  v_max3_u32 v123, v123, v116, v117
  v_max3_u32 v123, v123, v118, v119
  v_cmp_eq_u32 vcc, -1, v123
  s_cbranch_vccnz T_retry_128
  v_smfmac_f32_16x16x64_bf16 v[16:19], v[124:127], v[68:75], v0
  s_add_u32 s14, s14, 1
  ds_write_b128 v2, v[124:127] offset:3072
  v_mov_b32_dpp v122, v126 row_ror:8 row_mask:0xf bank_mask:0xf
  v_smfmac_f32_16x16x64_bf16 v[20:23], v[124:127], v[76:83], v0
  s_and_b32 s57, s14, 1
  v_mov_b32_dpp v123, v127 row_ror:8 row_mask:0xf bank_mask:0xf
  v_smfmac_f32_16x16x64_bf16 v[24:27], v[124:127], v[84:91], v0
  s_and_b32 s36, s14, 3
  ds_write_b128 v2, v[116:119] offset:7168
  v_smfmac_f32_16x16x64_bf16 v[16:19], v[120:123], v[92:99], v0
  s_lshl_b32 s36, s36, 13
  v_mov_b32_dpp v84, v116 row_ror:8 row_mask:0xf bank_mask:0xf
  v_smfmac_f32_16x16x64_bf16 v[20:23], v[120:123], v[100:107], v0
  s_add_u32 s26, s36, s23
  ds_read_b128 v[68:71], v4 offset:12288
  v_mov_b32_dpp v85, v117 row_ror:8 row_mask:0xf bank_mask:0xf
  v_smfmac_f32_16x16x64_bf16 v[24:27], v[120:123], v[108:115], v0
  s_add_u32 s36, s36, 8192
  ds_read_b128 v[72:75], v4 offset:13312
  v_mov_b32_dpp v86, v118 row_ror:8 row_mask:0xf bank_mask:0xf
  v_smfmac_f32_16x16x64_bf16 v[16:19], v[116:119], v[224:231], v0
  s_and_b32 s36, s36, 0x7fff
  ds_read_b128 v[76:79], v4 offset:14336
  v_mov_b32_dpp v87, v119 row_ror:8 row_mask:0xf bank_mask:0xf
  v_smfmac_f32_16x16x64_bf16 v[20:23], v[116:119], v[240:247], v0
  s_waitcnt lgkmcnt(3)
  s_barrier
  ds_read_b128 v[100:103], v2 offset:2048
  v_smfmac_f32_16x16x64_bf16 v[24:27], v[116:119], a[0:7], v0
  s_mov_b32 m0, s31
  ds_read_b128 v[120:123], v1 offset:2048
  v_smfmac_f32_16x16x64_bf16 v[16:19], v[84:87], v[232:239], v0
  s_cmp_ge_i32 s14, s30
  s_cbranch_scc1 T_kvw_131
T_kvb_132:
  v_smfmac_f32_16x16x64_bf16 v[20:23], v[84:87], v[248:255], v0
  ds_read_b128 v[80:83], v4 offset:15360
  v_smfmac_f32_16x16x64_bf16 v[24:27], v[84:87], a[8:15], v0
  s_waitcnt lgkmcnt(2)
  v_smfmac_f32_16x16x64_bf16 v[16:19], v[100:103], v[128:135], v0
  ds_read_b128 v[92:95], v2 offset:1024
  v_smfmac_f32_16x16x64_bf16 v[20:23], v[100:103], v[144:151], v0
  ds_read_b128 v[96:99], v1 offset:1024
  buffer_load_dwordx4 v9, s[4:7], s27 offen sc1 lds
  v_smfmac_f32_16x16x64_bf16 v[24:27], v[100:103], v[68:75], v0
  s_waitcnt vmcnt(1) lgkmcnt(3)
  ds_read_b128 v[116:119], v2 offset:0
  s_mov_b32 m0, s32
  v_smfmac_f32_16x16x64_bf16 v[16:19], v[120:123], v[136:143], v0
  ds_read_b128 v[124:127], v1 offset:0
  v_smfmac_f32_16x16x64_bf16 v[20:23], v[120:123], v[152:159], v0
  s_waitcnt lgkmcnt(4)
  ds_read_b128 v[104:107], v2 offset:6144
  v_smfmac_f32_16x16x64_bf16 v[24:27], v[120:123], v[76:83], v0
  s_waitcnt lgkmcnt(4)
  ds_read_b128 v[108:111], v1 offset:6144
  buffer_load_dwordx4 v9, s[4:7], s27 offen offset:128 sc1 lds
  v_smfmac_f32_16x16x64_bf16 v[16:19], v[92:95], v[160:167], v0
  s_waitcnt lgkmcnt(4)
  ds_read_b128 v[112:115], v2 offset:5120
  s_mov_b32 m0, s33
  v_smfmac_f32_16x16x64_bf16 v[16:19], v[96:99], v[168:175], v0
  s_waitcnt lgkmcnt(4)
  ds_read_b128 v[84:87], v1 offset:5120
  v_smfmac_f32_16x16x64_bf16 v[16:19], v[116:119], v[192:199], v0
  s_waitcnt lgkmcnt(4)
  ds_read_b128 v[88:91], v2 offset:4096
  v_smfmac_f32_16x16x64_bf16 v[16:19], v[124:127], v[200:207], v0
  s_waitcnt lgkmcnt(4)
  ds_read_b128 v[100:103], v1 offset:4096
  buffer_load_dwordx4 v10, s[4:7], s28 offen sc1 lds
  v_smfmac_f32_16x16x64_bf16 v[16:19], v[104:107], a[16:23], v0
  s_waitcnt lgkmcnt(4)
  ds_read_b128 v[68:71], v4 offset:16384
  s_mov_b32 m0, s34
  v_smfmac_f32_16x16x64_bf16 v[16:19], v[108:111], a[24:31], v0
  s_waitcnt lgkmcnt(4)
  ds_read_b128 v[72:75], v4 offset:17408
  v_smfmac_f32_16x16x64_bf16 v[16:19], v[112:115], a[64:71], v0
  s_waitcnt lgkmcnt(4)
  ds_read_b128 v[76:79], v4 offset:18432
  v_smfmac_f32_16x16x64_bf16 v[16:19], v[84:87], a[72:79], v0
  s_waitcnt lgkmcnt(4)
  ds_read_b128 v[80:83], v4 offset:19456
  buffer_load_dwordx4 v10, s[4:7], s28 offen offset:256 sc1 lds
  v_smfmac_f32_16x16x64_bf16 v[16:19], v[88:91], a[112:119], v0
  s_waitcnt lgkmcnt(4)
  s_mov_b32 m0, 32256
  v_smfmac_f32_16x16x64_bf16 v[16:19], v[100:103], a[120:127], v0
  s_add_u32 s24, s36, 145752064
  s_add_u32 s25, s36, 145756160
  v_smfmac_f32_16x16x64_bf16 v[20:23], v[92:95], v[176:183], v0
  s_add_u32 s35, s36, s23
  v_smfmac_f32_16x16x64_bf16 v[20:23], v[96:99], v[184:191], v0
  s_waitcnt lgkmcnt(2)
  buffer_load_dword v8, s[4:7], s99 offen sc1 lds
  v_smfmac_f32_16x16x64_bf16 v[20:23], v[116:119], v[68:75], v0
  s_waitcnt lgkmcnt(0)
  ds_read_b128 v[68:71], v4 offset:20480
  v_mul_f32 v16, s18, v16
  v_smfmac_f32_16x16x64_bf16 v[20:23], v[124:127], v[76:83], v0
  ds_read_b128 v[72:75], v4 offset:21504
  v_mul_f32 v17, s18, v17
  v_smfmac_f32_16x16x64_bf16 v[20:23], v[104:107], a[32:39], v0
  ds_read_b128 v[76:79], v4 offset:22528
  v_mul_f32 v18, s18, v18
  v_smfmac_f32_16x16x64_bf16 v[20:23], v[108:111], a[40:47], v0
  ds_read_b128 v[80:83], v4 offset:23552
  v_mul_f32 v19, s18, v19
  v_smfmac_f32_16x16x64_bf16 v[20:23], v[112:115], a[80:87], v0
  v_cvt_pk_bf16_f32 v120, v16, v17
  v_smfmac_f32_16x16x64_bf16 v[20:23], v[84:87], a[88:95], v0
  v_cvt_pk_bf16_f32 v121, v18, v19
  v_smfmac_f32_16x16x64_bf16 v[20:23], v[88:91], a[128:135], v0
  ds_write_b64 v5, v[120:121] offset:24576
  v_smfmac_f32_16x16x64_bf16 v[20:23], v[100:103], a[136:143], v0
  s_waitcnt lgkmcnt(3)
  v_smfmac_f32_16x16x64_bf16 v[24:27], v[92:95], v[68:75], v0
  s_waitcnt lgkmcnt(1)
  v_mov_b64 v[92:93], 0
  v_smfmac_f32_16x16x64_bf16 v[24:27], v[96:99], v[76:83], v0
  s_nop 1
  v_cvt_pk_bf16_f32 v122, v20, v21
  v_cvt_pk_bf16_f32 v123, v22, v23
  v_smfmac_f32_16x16x64_bf16 v[24:27], v[116:119], v[208:215], v0
  ds_write_b64 v5, v[122:123] offset:26880
  v_mov_b64 v[94:95], 0
  v_smfmac_f32_16x16x64_bf16 v[24:27], v[124:127], v[216:223], v0
  s_waitcnt lgkmcnt(1)
  s_barrier
  ds_read_b64_tr_b16 v[68:69], v6 offset:24576
  v_smfmac_f32_16x16x64_bf16 v[24:27], v[104:107], a[48:55], v0
  s_add_u32 s27, s27, 8192
  ds_read_b64_tr_b16 v[70:71], v6 offset:24640
  ds_read_b64_tr_b16 v[72:73], v6 offset:24832
  v_smfmac_f32_16x16x64_bf16 v[24:27], v[108:111], a[56:63], v0
  s_add_u32 s28, s28, 8192
  ds_read_b64_tr_b16 v[74:75], v6 offset:24896
  ds_read_b64_tr_b16 v[76:77], v6 offset:25088
  v_smfmac_f32_16x16x64_bf16 v[24:27], v[112:115], a[96:103], v0
  s_nop 0
  ds_read_b64_tr_b16 v[78:79], v6 offset:25152
  ds_read_b64_tr_b16 v[80:81], v6 offset:25344
  v_smfmac_f32_16x16x64_bf16 v[24:27], v[84:87], a[104:111], v0
  ds_read_b64_tr_b16 v[82:83], v6 offset:25408
  v_mov_b64 v[96:97], 0
  v_smfmac_f32_16x16x64_bf16 v[24:27], v[88:91], a[144:151], v0
  s_waitcnt lgkmcnt(8)
  s_barrier
  ds_read_b64_tr_b16 v[116:117], v6 offset:26880
  v_smfmac_f32_16x16x64_bf16 v[24:27], v[100:103], a[152:159], v0
  s_waitcnt lgkmcnt(7)
  ds_read_b64_tr_b16 v[118:119], v6 offset:26944
  v_mfma_f32_16x16x32_bf16 v[16:19], v[36:39], v[68:71], 0
  s_waitcnt lgkmcnt(6)
  ds_read_b64_tr_b16 v[124:125], v6 offset:27136
  ds_read_b64_tr_b16 v[126:127], v6 offset:27200
  v_mfma_f32_16x16x32_bf16 v[16:19], v[40:43], v[72:75], v[16:19]
  s_waitcnt lgkmcnt(6)
  ds_read_b64_tr_b16 v[104:105], v6 offset:27392
  ds_read_b64_tr_b16 v[106:107], v6 offset:27456
  v_mfma_f32_16x16x32_bf16 v[16:19], v[44:47], v[76:79], v[16:19]
  s_waitcnt lgkmcnt(6)
  ds_read_b64_tr_b16 v[108:109], v6 offset:27648
  ds_read_b64_tr_b16 v[110:111], v6 offset:27712
  v_mfma_f32_16x16x32_bf16 v[16:19], v[48:51], v[80:83], v[16:19]
  s_waitcnt lgkmcnt(6)
  v_cvt_pk_bf16_f32 v120, v24, v25
  v_cvt_pk_bf16_f32 v121, v26, v27
  v_mfma_f32_16x16x32_bf16 v[112:115], v[116:119], v[68:71], 0
  s_waitcnt lgkmcnt(4)
  buffer_store_dwordx4 v[120:123], v2, s[4:7], s29 offen offset:3072 sc1
  v_mov_b64 v[98:99], 0
  v_mfma_f32_16x16x32_bf16 v[112:115], v[124:127], v[72:75], v[112:115]
  s_waitcnt lgkmcnt(2)
  v_mov_b64 v[36:37], 0
  v_exp_f32 v100, v16
  v_mfma_f32_16x16x32_bf16 v[112:115], v[104:107], v[76:79], v[112:115]
  s_waitcnt lgkmcnt(0)
  v_exp_f32 v101, v17
  v_mfma_f32_16x16x32_bf16 v[112:115], v[108:111], v[80:83], v[112:115]
  s_add_u32 s29, s29, 131072
  v_exp_f32 v102, v18
  v_mfma_f32_16x16x32_bf16 v[20:23], v[52:55], v[68:71], 0
  s_cmp_eq_u32 s14, 63
  v_exp_f32 v103, v19
  v_mfma_f32_16x16x32_bf16 v[20:23], v[56:59], v[72:75], v[20:23]
  s_cbranch_scc1 M_tdone
  v_cvt_pk_bf16_f32 v44, v100, v101
  v_cvt_pk_bf16_f32 v45, v102, v103
  v_mfma_f32_16x16x32_bf16 v[20:23], v[60:63], v[76:79], v[20:23]
  v_exp_f32 v100, v112
  v_mfma_f32_16x16x32_bf16 v[20:23], v[64:67], v[80:83], v[20:23]
  v_exp_f32 v101, v113
  v_exp_f32 v102, v114
  v_exp_f32 v103, v115
  v_cvt_pk_bf16_f32 v84, v100, v101
  v_cvt_pk_bf16_f32 v85, v102, v103
  v_cndmask_b32 v48, v84, 0, s[16:17]
  v_cndmask_b32 v49, v85, 0, s[16:17]
  v_cndmask_b32 v50, 0, v84, s[16:17]
  v_cndmask_b32 v51, 0, v85, s[16:17]
  v_exp_f32 v100, v20
  v_mfma_f32_16x16x16_bf16 v[88:91], v[12:13], v[48:49], 0
  v_exp_f32 v101, v21
  v_mfma_f32_16x16x16_bf16 v[24:27], v[120:121], v[48:49], 0
  v_exp_f32 v102, v22
  v_mfma_f32_16x16x16_bf16 v[116:119], v[120:121], v[50:51], 0
  v_exp_f32 v103, v23
  v_cvt_pk_bf16_f32 v46, v100, v101
  v_cvt_pk_bf16_f32 v47, v102, v103
  v_mov_b64 v[38:39], 0
  s_nop 0
  v_mfma_f32_16x16x32_bf16 v[88:91], v[12:15], v[44:47], v[88:91]
  v_mov_b64 v[40:41], 0
  v_mov_b64 v[42:43], 0
  v_mfma_f32_16x16x32_bf16 v[24:27], v[28:31], v[44:47], v[24:27]
  ds_read_b128 v[52:55], v4 offset:24576
  ds_read_b128 v[56:59], v4 offset:25600
  v_mfma_f32_16x16x32_bf16 v[116:119], v[32:35], v[44:47], v[116:119]
  s_nop 1
  v_rcp_f32 v89, v88
  v_subrev_u32 v100, s54, v88
  v_cmp_le_u32 vcc, s55, v100
  v_mul_f32 v24, v89, v24
  v_mul_f32 v25, v89, v25
  s_cbranch_vccnz T_slow_134
T_back_135:
  v_cvt_pk_bf16_f32 v124, v24, v25
  v_pk_mul_f32 v[26:27], v[26:27], v[88:89] op_sel:[0,1] op_sel_hi:[1,1]
  v_pk_mul_f32 v[116:117], v[116:117], v[88:89] op_sel:[0,1] op_sel_hi:[1,1]
  v_pk_mul_f32 v[118:119], v[118:119], v[88:89] op_sel:[0,1] op_sel_hi:[1,1]
  v_cvt_pk_bf16_f32 v125, v26, v27
  v_cvt_pk_bf16_f32 v126, v116, v117
  v_cvt_pk_bf16_f32 v127, v118, v119
  ds_write_b128 v11, v[124:127] offset:30720
  s_nop 0
  v_smfmac_f32_16x16x64_bf16 v[92:95], v[124:127], a[160:167], v0
  v_smfmac_f32_16x16x64_bf16 v[96:99], v[124:127], a[168:175], v0
  v_smfmac_f32_16x16x64_bf16 v[36:39], v[124:127], a[176:183], v0
  v_smfmac_f32_16x16x64_bf16 v[40:43], v[124:127], a[184:191], v0
  s_waitcnt lgkmcnt(0)
  s_barrier
  ds_read_b128 v[104:107], v11 offset:30208
  ds_read_b128 v[108:111], v11 offset:29696
  ds_read_b128 v[68:71], v11 offset:29184
  s_waitcnt lgkmcnt(2)
  v_smfmac_f32_16x16x64_bf16 v[92:95], v[104:107], a[192:199], v0
  s_waitcnt lgkmcnt(1)
  ds_read_b128 v[76:79], v4 offset:28672
  v_smfmac_f32_16x16x64_bf16 v[92:95], v[108:111], a[224:231], v0
  s_waitcnt lgkmcnt(1)
  ds_read_b128 v[80:83], v4 offset:29696
  v_smfmac_f32_16x16x64_bf16 v[92:95], v[68:71], a[240:247], v0
  ds_read_b128 v[60:63], v4 offset:26624
  v_smfmac_f32_16x16x64_bf16 v[96:99], v[104:107], a[200:207], v0
  ds_read_b128 v[64:67], v4 offset:27648
  v_smfmac_f32_16x16x64_bf16 v[96:99], v[108:111], a[232:239], v0
  ds_read_b128 v[28:31], v4 offset:30720
  s_nop 0
  v_cvt_pk_bf16_f32 v16, v92, v93
  v_cvt_pk_bf16_f32 v17, v94, v95
  v_bfi_b32 v16, 1, s57, v16
  v_smfmac_f32_16x16x64_bf16 v[96:99], v[68:71], a[248:255], v0
  buffer_store_dwordx2 v[16:17], v7, s[4:7], s20 offen offset:0
  v_smfmac_f32_16x16x64_bf16 v[36:39], v[104:107], a[208:215], v0
  ds_read_b128 v[32:35], v4 offset:31744
  v_smfmac_f32_16x16x64_bf16 v[36:39], v[108:111], v[52:59], v0
  s_waitcnt lgkmcnt(4)
  s_nop 0
  v_cvt_pk_bf16_f32 v18, v96, v97
  v_cvt_pk_bf16_f32 v19, v98, v99
  v_bfi_b32 v18, 1, s57, v18
  v_smfmac_f32_16x16x64_bf16 v[36:39], v[68:71], v[76:83], v0
  buffer_store_dwordx2 v[18:19], v7, s[4:7], s20 offen offset:64
  v_smfmac_f32_16x16x64_bf16 v[40:43], v[104:107], a[216:223], v0
  s_waitcnt lgkmcnt(2)
  v_smfmac_f32_16x16x64_bf16 v[40:43], v[108:111], v[60:67], v0
  s_waitcnt lgkmcnt(0)
  s_nop 0
  v_cvt_pk_bf16_f32 v20, v36, v37
  v_cvt_pk_bf16_f32 v21, v38, v39
  v_bfi_b32 v20, 1, s57, v20
  v_smfmac_f32_16x16x64_bf16 v[40:43], v[68:71], v[28:35], v0
  buffer_store_dwordx2 v[20:21], v7, s[4:7], s21 offen offset:0
  s_nop 6
  v_cvt_pk_bf16_f32 v22, v40, v41
  v_cvt_pk_bf16_f32 v23, v42, v43
  v_bfi_b32 v22, 1, s57, v22
  buffer_store_dwordx2 v[22:23], v7, s[4:7], s21 offen offset:64
  ds_read_b128 v[68:71], v4 offset:0
  ds_read_b128 v[72:75], v4 offset:1024
  ds_read_b128 v[76:79], v4 offset:4096
  ds_read_b128 v[80:83], v4 offset:5120
  ds_read_b128 v[84:87], v4 offset:8192
  ds_read_b128 v[88:91], v4 offset:9216
  ds_read_b128 v[92:95], v4 offset:2048
  ds_read_b128 v[96:99], v4 offset:3072
  ds_read_b128 v[100:103], v4 offset:6144
  ds_read_b128 v[104:107], v4 offset:7168
  ds_read_b128 v[108:111], v4 offset:10240
  ds_read_b128 v[112:115], v4 offset:11264
  v_mov_b64 v[16:17], 0
  v_mov_b64 v[18:19], 0
  v_mov_b64 v[20:21], 0
  v_mov_b64 v[22:23], 0
  v_mov_b64 v[24:25], 0
  v_mov_b64 v[26:27], 0
  ds_read_b64 v[44:45], v2 offset:32256
  s_waitcnt lgkmcnt(0)
  v_readfirstlane_b32 s38, v44
  v_readfirstlane_b32 s37, v45
  s_nop 0
  s_add_u32 s37, s37, 30
  s_cmp_ge_u32 s38, 30
  s_cselect_b32 s38, s37, s38
  s_cmp_ge_u32 s38, 64
  s_cselect_b32 s38, 100, s38
  s_sub_u32 s38, s38, 1
  s_max_i32 s30, s30, s38
  s_waitcnt vmcnt(4)
  s_barrier
  ds_read_b128 v[28:31], v2 offset:19456
  ds_read_b128 v[32:35], v2 offset:23552
  ds_read_b128 v[36:39], v2 offset:8192
  ds_read_b128 v[40:43], v2 offset:9216
  ds_read_b128 v[44:47], v2 offset:10240
  ds_read_b128 v[48:51], v2 offset:11264
  buffer_load_dwordx4 v[124:127], v3, s[4:7], s24 offen offset:3072 sc1
  buffer_load_dwordx4 v[116:119], v3, s[4:7], s25 offen offset:3072 sc1
  ds_read_b128 v[52:55], v2 offset:12288
  ds_read_b128 v[56:59], v2 offset:13312
  ds_read_b128 v[60:63], v2 offset:14336
  ds_read_b128 v[64:67], v2 offset:15360
  buffer_load_dwordx4 v[124:127], v3, s[4:7], s24 offen offset:3072 sc1
  buffer_load_dwordx4 v[116:119], v3, s[4:7], s25 offen offset:3072 sc1
  s_mov_b32 s19, 0
  s_branch T_loop_127
T_kvw_131:
  s_mov_b32 s19, 0
  s_branch T_kvok_140
T_kv_139:
  s_sleep 4
  s_add_u32 s19, s19, 1
  s_cmp_gt_u32 s19, 32768
  s_cbranch_scc1 M_exit
T_kvok_140:
  s_add_u32 s39, s99, 128
  s_mov_b32 s38, 0
  s_mov_b32 s37, 0
  s_atomic_or s38, s[58:59], s99 glc
  s_atomic_or s37, s[58:59], s39 glc
  s_waitcnt lgkmcnt(0)
  s_add_u32 s37, s37, 30
  s_cmp_ge_u32 s38, 30
  s_cselect_b32 s38, s37, s38
  s_cmp_ge_u32 s38, 64
  s_cselect_b32 s38, 100, s38
  s_sub_u32 s38, s38, 1
  s_max_i32 s30, s30, s38
  s_cmp_ge_i32 s14, s30
  s_cbranch_scc1 T_kv_139
  s_branch T_kvb_132
T_slow_134:
  s_nop 7
  v_max3_f32 v100, v16, v17, v18
  v_max3_f32 v100, v100, v19, v20
  v_max3_f32 v100, v100, v21, v22
  v_max3_f32 v100, v100, v23, v112
  v_max3_f32 v100, v100, v113, v114
  v_max_f32 v100, v100, v115
  v_mov_b32 v101, v100
  s_nop 1
  v_permlane32_swap_b32 v100, v101
  s_nop 1
  v_max_f32 v100, v100, v101
  v_mov_b32 v101, v100
  s_nop 1
  v_permlane16_swap_b32 v100, v101
  s_nop 1
  v_max_f32 v100, v100, v101
  v_sub_f32 v16, v16, v100
  v_sub_f32 v17, v17, v100
  v_sub_f32 v18, v18, v100
  v_sub_f32 v19, v19, v100
  v_exp_f32 v16, v16
  v_exp_f32 v17, v17
  v_exp_f32 v18, v18
  v_exp_f32 v19, v19
  v_sub_f32 v20, v20, v100
  v_sub_f32 v21, v21, v100
  v_sub_f32 v22, v22, v100
  v_sub_f32 v23, v23, v100
  v_exp_f32 v20, v20
  v_exp_f32 v21, v21
  v_exp_f32 v22, v22
  v_exp_f32 v23, v23
  v_sub_f32 v112, v112, v100
  v_sub_f32 v113, v113, v100
  v_sub_f32 v114, v114, v100
  v_sub_f32 v115, v115, v100
  v_exp_f32 v112, v112
  v_exp_f32 v113, v113
  v_exp_f32 v114, v114
  v_exp_f32 v115, v115
  s_nop 0
  v_cvt_pk_bf16_f32 v44, v16, v17
  v_cvt_pk_bf16_f32 v45, v18, v19
  v_cvt_pk_bf16_f32 v46, v20, v21
  v_cvt_pk_bf16_f32 v47, v22, v23
  v_cvt_pk_bf16_f32 v84, v112, v113
  v_cvt_pk_bf16_f32 v85, v114, v115
  v_cndmask_b32 v48, v84, 0, s[16:17]
  v_cndmask_b32 v49, v85, 0, s[16:17]
  v_cndmask_b32 v50, 0, v84, s[16:17]
  v_cndmask_b32 v51, 0, v85, s[16:17]
  s_nop 1
  v_mfma_f32_16x16x16_bf16 v[88:91], v[12:13], v[48:49], 0
  v_mfma_f32_16x16x16_bf16 v[24:27], v[120:121], v[48:49], 0
  v_mfma_f32_16x16x16_bf16 v[116:119], v[120:121], v[50:51], 0
  v_mfma_f32_16x16x32_bf16 v[88:91], v[12:15], v[44:47], v[88:91]
  v_mfma_f32_16x16x32_bf16 v[24:27], v[28:31], v[44:47], v[24:27]
  v_mfma_f32_16x16x32_bf16 v[116:119], v[32:35], v[44:47], v[116:119]
  s_nop 7
  s_nop 1
  v_rcp_f32 v89, v88
  s_nop 0
  v_mul_f32 v24, v89, v24
  v_mul_f32 v25, v89, v25
  s_branch T_back_135
M_global:
  s_cmp_eq_u32 s13, 1
  s_cbranch_scc1 T_w_142
  s_cmp_eq_u32 s13, 2
  s_cbranch_scc1 T_w_143
  s_cmp_eq_u32 s13, 3
  s_cbranch_scc1 T_w_144
T_w_141:
  s_mov_b32 s19, 0
  v_mov_b64 v[16:17], 0
  v_mov_b64 v[18:19], 0
  v_mov_b64 v[20:21], 0
  v_mov_b64 v[22:23], 0
  v_mov_b64 v[24:25], 0
  v_mov_b64 v[26:27], 0
  buffer_load_dwordx4 v[124:127], v3, s[4:7], s24 offen offset:0 sc1
  buffer_load_dwordx4 v[116:119], v3, s[4:7], s25 offen offset:0 sc1
  buffer_load_dwordx4 v[124:127], v3, s[4:7], s24 offen offset:0 sc1
  buffer_load_dwordx4 v[116:119], v3, s[4:7], s25 offen offset:0 sc1
  s_branch T_loop_145
.p2align 6
T_retry_146:
  s_mov_b64 exec, vcc
  buffer_load_dwordx4 v[124:127], v3, s[4:7], s24 offen offset:0 sc1
  buffer_load_dwordx4 v[116:119], v3, s[4:7], s25 offen offset:0 sc1
  s_mov_b64 exec, -1
  s_add_u32 s19, s19, 1
  s_cmp_gt_u32 s19, 32768
  s_cbranch_scc1 M_exit
T_loop_145:
  s_waitcnt vmcnt(3) lgkmcnt(0)
  v_max3_u32 v123, v124, v125, v126
  v_max_u32 v123, v123, v127
  v_mov_b32_dpp v120, v124 row_ror:8 row_mask:0xf bank_mask:0xf
  v_mov_b32_dpp v121, v125 row_ror:8 row_mask:0xf bank_mask:0xf
  s_waitcnt vmcnt(2)
  v_max3_u32 v123, v123, v116, v117
  v_max3_u32 v123, v123, v118, v119
  v_cmp_eq_u32 vcc, -1, v123
  s_cbranch_vccnz T_retry_146
  v_smfmac_f32_16x16x64_bf16 v[16:19], v[124:127], v[68:75], v0
  s_add_u32 s14, s14, 1
  ds_write_b128 v2, v[124:127] offset:0
  v_mov_b32_dpp v122, v126 row_ror:8 row_mask:0xf bank_mask:0xf
  v_smfmac_f32_16x16x64_bf16 v[20:23], v[124:127], v[76:83], v0
  s_and_b32 s57, s14, 1
  v_mov_b32_dpp v123, v127 row_ror:8 row_mask:0xf bank_mask:0xf
  v_smfmac_f32_16x16x64_bf16 v[24:27], v[124:127], v[84:91], v0
  s_and_b32 s36, s14, 3
  ds_write_b128 v2, v[116:119] offset:4096
  v_smfmac_f32_16x16x64_bf16 v[16:19], v[120:123], v[92:99], v0
  s_lshl_b32 s36, s36, 13
  v_mov_b32_dpp v84, v116 row_ror:8 row_mask:0xf bank_mask:0xf
  v_smfmac_f32_16x16x64_bf16 v[20:23], v[120:123], v[100:107], v0
  s_add_u32 s26, s36, s23
  ds_read_b128 v[68:71], v4 offset:12288
  v_mov_b32_dpp v85, v117 row_ror:8 row_mask:0xf bank_mask:0xf
  v_smfmac_f32_16x16x64_bf16 v[24:27], v[120:123], v[108:115], v0
  s_add_u32 s36, s36, 8192
  ds_read_b128 v[72:75], v4 offset:13312
  v_mov_b32_dpp v86, v118 row_ror:8 row_mask:0xf bank_mask:0xf
  v_smfmac_f32_16x16x64_bf16 v[16:19], v[116:119], v[224:231], v0
  s_and_b32 s36, s36, 0x7fff
  ds_read_b128 v[76:79], v4 offset:14336
  v_mov_b32_dpp v87, v119 row_ror:8 row_mask:0xf bank_mask:0xf
  v_smfmac_f32_16x16x64_bf16 v[20:23], v[116:119], v[240:247], v0
  s_waitcnt lgkmcnt(3)
  s_barrier
  ds_read_b128 v[100:103], v2 offset:1024
  v_smfmac_f32_16x16x64_bf16 v[24:27], v[116:119], a[0:7], v0
  s_mov_b32 m0, s31
  ds_read_b128 v[120:123], v1 offset:1024
  v_smfmac_f32_16x16x64_bf16 v[16:19], v[84:87], v[232:239], v0
  s_cmp_ge_i32 s14, s30
  s_cbranch_scc1 T_kvw_149
T_kvb_150:
  v_smfmac_f32_16x16x64_bf16 v[20:23], v[84:87], v[248:255], v0
  ds_read_b128 v[80:83], v4 offset:15360
  buffer_load_dwordx4 v9, s[4:7], s27 offen sc1 lds
  v_smfmac_f32_16x16x64_bf16 v[24:27], v[84:87], a[8:15], v0
  s_waitcnt lgkmcnt(2)
  s_mov_b32 m0, s32
  v_smfmac_f32_16x16x64_bf16 v[16:19], v[100:103], v[128:135], v0
  ds_read_b128 v[92:95], v2 offset:2048
  v_smfmac_f32_16x16x64_bf16 v[20:23], v[100:103], v[144:151], v0
  ds_read_b128 v[96:99], v1 offset:2048
  v_smfmac_f32_16x16x64_bf16 v[24:27], v[100:103], v[68:75], v0
  s_waitcnt vmcnt(1) lgkmcnt(3)
  ds_read_b128 v[116:119], v2 offset:3072
  buffer_load_dwordx4 v9, s[4:7], s27 offen offset:128 sc1 lds
  v_smfmac_f32_16x16x64_bf16 v[16:19], v[120:123], v[136:143], v0
  ds_read_b128 v[124:127], v1 offset:3072
  s_mov_b32 m0, s33
  v_smfmac_f32_16x16x64_bf16 v[20:23], v[120:123], v[152:159], v0
  s_waitcnt lgkmcnt(4)
  ds_read_b128 v[104:107], v2 offset:5120
  v_smfmac_f32_16x16x64_bf16 v[24:27], v[120:123], v[76:83], v0
  s_waitcnt lgkmcnt(4)
  ds_read_b128 v[108:111], v1 offset:5120
  v_smfmac_f32_16x16x64_bf16 v[16:19], v[92:95], v[160:167], v0
  s_waitcnt lgkmcnt(4)
  ds_read_b128 v[112:115], v2 offset:6144
  buffer_load_dwordx4 v10, s[4:7], s28 offen sc1 lds
  v_smfmac_f32_16x16x64_bf16 v[16:19], v[96:99], v[168:175], v0
  s_waitcnt lgkmcnt(4)
  ds_read_b128 v[84:87], v1 offset:6144
  s_mov_b32 m0, s34
  v_smfmac_f32_16x16x64_bf16 v[16:19], v[116:119], v[192:199], v0
  s_waitcnt lgkmcnt(4)
  ds_read_b128 v[88:91], v2 offset:7168
  v_smfmac_f32_16x16x64_bf16 v[16:19], v[124:127], v[200:207], v0
  s_waitcnt lgkmcnt(4)
  ds_read_b128 v[100:103], v1 offset:7168
  v_smfmac_f32_16x16x64_bf16 v[16:19], v[104:107], a[16:23], v0
  s_waitcnt lgkmcnt(4)
  ds_read_b128 v[68:71], v4 offset:16384
  buffer_load_dwordx4 v10, s[4:7], s28 offen offset:256 sc1 lds
  v_smfmac_f32_16x16x64_bf16 v[16:19], v[108:111], a[24:31], v0
  s_waitcnt lgkmcnt(4)
  ds_read_b128 v[72:75], v4 offset:17408
  v_smfmac_f32_16x16x64_bf16 v[16:19], v[112:115], a[64:71], v0
  s_waitcnt lgkmcnt(4)
  ds_read_b128 v[76:79], v4 offset:18432
  v_smfmac_f32_16x16x64_bf16 v[16:19], v[84:87], a[72:79], v0
  s_waitcnt lgkmcnt(4)
  ds_read_b128 v[80:83], v4 offset:19456
  v_smfmac_f32_16x16x64_bf16 v[16:19], v[88:91], a[112:119], v0
  s_waitcnt lgkmcnt(4)
  v_smfmac_f32_16x16x64_bf16 v[16:19], v[100:103], a[120:127], v0
  s_add_u32 s24, s36, 145752064
  s_add_u32 s25, s36, 145756160
  v_smfmac_f32_16x16x64_bf16 v[20:23], v[92:95], v[176:183], v0
  s_add_u32 s35, s36, s23
  v_smfmac_f32_16x16x64_bf16 v[20:23], v[96:99], v[184:191], v0
  s_waitcnt lgkmcnt(2)
  v_smfmac_f32_16x16x64_bf16 v[20:23], v[116:119], v[68:75], v0
  s_waitcnt lgkmcnt(0)
  ds_read_b128 v[68:71], v4 offset:20480
  v_mul_f32 v16, s18, v16
  v_smfmac_f32_16x16x64_bf16 v[20:23], v[124:127], v[76:83], v0
  ds_read_b128 v[72:75], v4 offset:21504
  v_mul_f32 v17, s18, v17
  v_smfmac_f32_16x16x64_bf16 v[20:23], v[104:107], a[32:39], v0
  ds_read_b128 v[76:79], v4 offset:22528
  v_mul_f32 v18, s18, v18
  v_smfmac_f32_16x16x64_bf16 v[20:23], v[108:111], a[40:47], v0
  ds_read_b128 v[80:83], v4 offset:23552
  v_mul_f32 v19, s18, v19
  v_smfmac_f32_16x16x64_bf16 v[20:23], v[112:115], a[80:87], v0
  v_cvt_pk_bf16_f32 v120, v16, v17
  v_smfmac_f32_16x16x64_bf16 v[20:23], v[84:87], a[88:95], v0
  v_cvt_pk_bf16_f32 v121, v18, v19
  v_smfmac_f32_16x16x64_bf16 v[20:23], v[88:91], a[128:135], v0
  ds_write_b64 v5, v[120:121] offset:24576
  v_smfmac_f32_16x16x64_bf16 v[20:23], v[100:103], a[136:143], v0
  s_waitcnt lgkmcnt(3)
  v_smfmac_f32_16x16x64_bf16 v[24:27], v[92:95], v[68:75], v0
  s_waitcnt lgkmcnt(1)
  v_mov_b64 v[92:93], 0
  v_smfmac_f32_16x16x64_bf16 v[24:27], v[96:99], v[76:83], v0
  s_nop 1
  v_cvt_pk_bf16_f32 v122, v20, v21
  v_cvt_pk_bf16_f32 v123, v22, v23
  v_smfmac_f32_16x16x64_bf16 v[24:27], v[116:119], v[208:215], v0
  ds_write_b64 v5, v[122:123] offset:26880
  v_mov_b64 v[94:95], 0
  v_smfmac_f32_16x16x64_bf16 v[24:27], v[124:127], v[216:223], v0
  s_waitcnt lgkmcnt(1)
  s_barrier
  ds_read_b64_tr_b16 v[68:69], v6 offset:24576
  v_smfmac_f32_16x16x64_bf16 v[24:27], v[104:107], a[48:55], v0
  s_add_u32 s27, s27, 8192
  ds_read_b64_tr_b16 v[70:71], v6 offset:24640
  ds_read_b64_tr_b16 v[72:73], v6 offset:24832
  v_smfmac_f32_16x16x64_bf16 v[24:27], v[108:111], a[56:63], v0
  s_add_u32 s28, s28, 8192
  ds_read_b64_tr_b16 v[74:75], v6 offset:24896
  ds_read_b64_tr_b16 v[76:77], v6 offset:25088
  v_smfmac_f32_16x16x64_bf16 v[24:27], v[112:115], a[96:103], v0
  s_nop 0
  ds_read_b64_tr_b16 v[78:79], v6 offset:25152
  ds_read_b64_tr_b16 v[80:81], v6 offset:25344
  v_smfmac_f32_16x16x64_bf16 v[24:27], v[84:87], a[104:111], v0
  ds_read_b64_tr_b16 v[82:83], v6 offset:25408
  v_mov_b64 v[96:97], 0
  v_smfmac_f32_16x16x64_bf16 v[24:27], v[88:91], a[144:151], v0
  s_waitcnt lgkmcnt(8)
  s_barrier
  ds_read_b64_tr_b16 v[116:117], v6 offset:26880
  v_smfmac_f32_16x16x64_bf16 v[24:27], v[100:103], a[152:159], v0
  s_waitcnt lgkmcnt(7)
  ds_read_b64_tr_b16 v[118:119], v6 offset:26944
  v_mfma_f32_16x16x32_bf16 v[16:19], v[36:39], v[68:71], 0
  s_waitcnt lgkmcnt(6)
  ds_read_b64_tr_b16 v[124:125], v6 offset:27136
  ds_read_b64_tr_b16 v[126:127], v6 offset:27200
  v_mfma_f32_16x16x32_bf16 v[16:19], v[40:43], v[72:75], v[16:19]
  s_waitcnt lgkmcnt(6)
  ds_read_b64_tr_b16 v[104:105], v6 offset:27392
  ds_read_b64_tr_b16 v[106:107], v6 offset:27456
  v_mfma_f32_16x16x32_bf16 v[16:19], v[44:47], v[76:79], v[16:19]
  s_waitcnt lgkmcnt(6)
  ds_read_b64_tr_b16 v[108:109], v6 offset:27648
  ds_read_b64_tr_b16 v[110:111], v6 offset:27712
  v_mfma_f32_16x16x32_bf16 v[16:19], v[48:51], v[80:83], v[16:19]
  s_waitcnt lgkmcnt(6)
  v_cvt_pk_bf16_f32 v120, v24, v25
  v_cvt_pk_bf16_f32 v121, v26, v27
  v_mfma_f32_16x16x32_bf16 v[112:115], v[116:119], v[68:71], 0
  s_waitcnt lgkmcnt(4)
  buffer_store_dwordx4 v[120:123], v2, s[4:7], s29 offen offset:0 sc1
  v_mov_b64 v[98:99], 0
  v_mfma_f32_16x16x32_bf16 v[112:115], v[124:127], v[72:75], v[112:115]
  s_waitcnt lgkmcnt(2)
  v_mov_b64 v[36:37], 0
  v_exp_f32 v100, v16
  v_mfma_f32_16x16x32_bf16 v[112:115], v[104:107], v[76:79], v[112:115]
  s_waitcnt lgkmcnt(0)
  v_exp_f32 v101, v17
  v_mfma_f32_16x16x32_bf16 v[112:115], v[108:111], v[80:83], v[112:115]
  s_add_u32 s29, s29, 131072
  v_exp_f32 v102, v18
  v_mfma_f32_16x16x32_bf16 v[20:23], v[52:55], v[68:71], 0
  s_cmp_eq_u32 s14, 63
  v_exp_f32 v103, v19
  v_mfma_f32_16x16x32_bf16 v[20:23], v[56:59], v[72:75], v[20:23]
  s_cbranch_scc1 M_tdone
  v_cvt_pk_bf16_f32 v44, v100, v101
  v_cvt_pk_bf16_f32 v45, v102, v103
  v_mfma_f32_16x16x32_bf16 v[20:23], v[60:63], v[76:79], v[20:23]
  v_exp_f32 v100, v112
  v_mfma_f32_16x16x32_bf16 v[20:23], v[64:67], v[80:83], v[20:23]
  v_exp_f32 v101, v113
  v_exp_f32 v102, v114
  v_exp_f32 v103, v115
  v_cvt_pk_bf16_f32 v84, v100, v101
  v_cvt_pk_bf16_f32 v85, v102, v103
  v_cndmask_b32 v48, v84, 0, s[16:17]
  v_cndmask_b32 v49, v85, 0, s[16:17]
  v_cndmask_b32 v50, 0, v84, s[16:17]
  v_cndmask_b32 v51, 0, v85, s[16:17]
  v_exp_f32 v100, v20
  v_mfma_f32_16x16x16_bf16 v[88:91], v[12:13], v[48:49], 0
  v_exp_f32 v101, v21
  v_mfma_f32_16x16x16_bf16 v[24:27], v[120:121], v[48:49], 0
  v_exp_f32 v102, v22
  v_mfma_f32_16x16x16_bf16 v[116:119], v[120:121], v[50:51], 0
  v_exp_f32 v103, v23
  v_cvt_pk_bf16_f32 v46, v100, v101
  v_cvt_pk_bf16_f32 v47, v102, v103
  v_mov_b64 v[38:39], 0
  s_nop 0
  v_mfma_f32_16x16x32_bf16 v[88:91], v[12:15], v[44:47], v[88:91]
  v_mov_b64 v[40:41], 0
  v_mov_b64 v[42:43], 0
  v_mfma_f32_16x16x32_bf16 v[24:27], v[28:31], v[44:47], v[24:27]
  ds_read_b128 v[52:55], v4 offset:24576
  ds_read_b128 v[56:59], v4 offset:25600
  v_mfma_f32_16x16x32_bf16 v[116:119], v[32:35], v[44:47], v[116:119]
  s_nop 1
  v_rcp_f32 v89, v88
  v_subrev_u32 v100, s54, v88
  v_cmp_le_u32 vcc, s55, v100
  v_mul_f32 v24, v89, v24
  v_mul_f32 v25, v89, v25
  s_cbranch_vccnz T_slow_152
T_back_153:
  v_cvt_pk_bf16_f32 v124, v24, v25
  v_pk_mul_f32 v[26:27], v[26:27], v[88:89] op_sel:[0,1] op_sel_hi:[1,1]
  v_pk_mul_f32 v[116:117], v[116:117], v[88:89] op_sel:[0,1] op_sel_hi:[1,1]
  v_pk_mul_f32 v[118:119], v[118:119], v[88:89] op_sel:[0,1] op_sel_hi:[1,1]
  v_cvt_pk_bf16_f32 v125, v26, v27
  v_cvt_pk_bf16_f32 v126, v116, v117
  v_cvt_pk_bf16_f32 v127, v118, v119
  ds_write_b128 v11, v[124:127] offset:29184
  s_nop 0
  v_smfmac_f32_16x16x64_bf16 v[92:95], v[124:127], a[160:167], v0
  v_smfmac_f32_16x16x64_bf16 v[96:99], v[124:127], a[168:175], v0
  v_smfmac_f32_16x16x64_bf16 v[36:39], v[124:127], a[176:183], v0
  v_smfmac_f32_16x16x64_bf16 v[40:43], v[124:127], a[184:191], v0
  s_waitcnt lgkmcnt(0)
  s_barrier
  ds_read_b128 v[104:107], v11 offset:29696
  ds_read_b128 v[108:111], v11 offset:30208
  ds_read_b128 v[68:71], v11 offset:30720
  s_waitcnt lgkmcnt(2)
  v_smfmac_f32_16x16x64_bf16 v[92:95], v[104:107], a[192:199], v0
  s_waitcnt lgkmcnt(1)
  ds_read_b128 v[76:79], v4 offset:28672
  v_smfmac_f32_16x16x64_bf16 v[92:95], v[108:111], a[224:231], v0
  s_waitcnt lgkmcnt(1)
  ds_read_b128 v[80:83], v4 offset:29696
  v_smfmac_f32_16x16x64_bf16 v[92:95], v[68:71], a[240:247], v0
  ds_read_b128 v[60:63], v4 offset:26624
  v_smfmac_f32_16x16x64_bf16 v[96:99], v[104:107], a[200:207], v0
  ds_read_b128 v[64:67], v4 offset:27648
  v_smfmac_f32_16x16x64_bf16 v[96:99], v[108:111], a[232:239], v0
  ds_read_b128 v[28:31], v4 offset:30720
  s_nop 0
  v_cvt_pk_bf16_f32 v16, v92, v93
  v_cvt_pk_bf16_f32 v17, v94, v95
  v_bfi_b32 v16, 1, s57, v16
  v_smfmac_f32_16x16x64_bf16 v[96:99], v[68:71], a[248:255], v0
  buffer_store_dwordx2 v[16:17], v7, s[4:7], s20 offen offset:0 sc1
  v_smfmac_f32_16x16x64_bf16 v[36:39], v[104:107], a[208:215], v0
  ds_read_b128 v[32:35], v4 offset:31744
  v_smfmac_f32_16x16x64_bf16 v[36:39], v[108:111], v[52:59], v0
  s_waitcnt lgkmcnt(4)
  s_nop 0
  v_cvt_pk_bf16_f32 v18, v96, v97
  v_cvt_pk_bf16_f32 v19, v98, v99
  v_bfi_b32 v18, 1, s57, v18
  v_smfmac_f32_16x16x64_bf16 v[36:39], v[68:71], v[76:83], v0
  buffer_store_dwordx2 v[18:19], v7, s[4:7], s20 offen offset:64 sc1
  v_smfmac_f32_16x16x64_bf16 v[40:43], v[104:107], a[216:223], v0
  s_waitcnt lgkmcnt(2)
  ds_read_b128 v[116:119], v2 offset:31232
  v_smfmac_f32_16x16x64_bf16 v[40:43], v[108:111], v[60:67], v0
  s_waitcnt lgkmcnt(1)
  s_nop 0
  v_cvt_pk_bf16_f32 v20, v36, v37
  v_cvt_pk_bf16_f32 v21, v38, v39
  v_bfi_b32 v20, 1, s57, v20
  v_smfmac_f32_16x16x64_bf16 v[40:43], v[68:71], v[28:35], v0
  buffer_store_dwordx2 v[20:21], v7, s[4:7], s21 offen offset:0 sc1
  s_nop 6
  v_cvt_pk_bf16_f32 v22, v40, v41
  v_cvt_pk_bf16_f32 v23, v42, v43
  v_bfi_b32 v22, 1, s57, v22
  buffer_store_dwordx2 v[22:23], v7, s[4:7], s21 offen offset:64 sc1
  ds_read_b128 v[68:71], v4 offset:0
  ds_read_b128 v[72:75], v4 offset:1024
  ds_read_b128 v[76:79], v4 offset:4096
  ds_read_b128 v[80:83], v4 offset:5120
  ds_read_b128 v[84:87], v4 offset:8192
  ds_read_b128 v[88:91], v4 offset:9216
  v_mov_b64 v[16:17], 0
  v_mov_b64 v[18:19], 0
  v_mov_b64 v[20:21], 0
  v_mov_b64 v[22:23], 0
  v_mov_b64 v[24:25], 0
  v_mov_b64 v[26:27], 0
  s_mov_b32 s19, 0
  v_mov_b32 v49, -1
  s_waitcnt vmcnt(2)
  buffer_load_dwordx4 v[52:55], v2, s[4:7], s22 offen offset:0 sc1
  buffer_load_dwordx4 v[56:59], v2, s[4:7], s22 offen offset:1024 sc1
  buffer_load_dwordx4 v[60:63], v2, s[4:7], s22 offen offset:2048 sc1
  buffer_load_dwordx4 v[64:67], v2, s[4:7], s22 offen offset:3072 sc1
  ds_read_b128 v[92:95], v4 offset:2048
  ds_read_b128 v[96:99], v4 offset:3072
  ds_read_b128 v[100:103], v4 offset:6144
  ds_read_b128 v[104:107], v4 offset:7168
  ds_read_b128 v[108:111], v4 offset:10240
  ds_read_b128 v[112:115], v4 offset:11264
  ds_read_b64 v[44:45], v2 offset:32256
  s_waitcnt lgkmcnt(0)
  v_readfirstlane_b32 s38, v44
  v_readfirstlane_b32 s37, v45
  s_nop 0
  s_add_u32 s37, s37, 30
  s_cmp_ge_u32 s38, 30
  s_cselect_b32 s38, s37, s38
  s_cmp_ge_u32 s38, 64
  s_cselect_b32 s38, 100, s38
  s_sub_u32 s38, s38, 1
  s_max_i32 s30, s30, s38
  s_waitcnt lgkmcnt(12)
  s_waitcnt vmcnt(3)
  v_mfma_f32_16x16x32_bf16 v[120:123], v[116:119], v[52:55], 0
  v_xor_b32 v48, s57, v52
  v_bitop3_b32 v48, v48, v54, s57 bitop3:0xf6
  s_waitcnt vmcnt(2)
  v_mfma_f32_16x16x32_bf16 v[120:123], v[116:119], v[56:59], v[120:123]
  v_bitop3_b32 v48, v48, v56, s57 bitop3:0xf6
  v_bitop3_b32 v48, v48, v58, s57 bitop3:0xf6
  s_waitcnt vmcnt(1)
  v_mfma_f32_16x16x32_bf16 v[120:123], v[116:119], v[60:63], v[120:123]
  v_bitop3_b32 v48, v48, v60, s57 bitop3:0xf6
  v_bitop3_b32 v48, v48, v62, s57 bitop3:0xf6
  s_waitcnt vmcnt(0)
  v_mfma_f32_16x16x32_bf16 v[120:123], v[116:119], v[64:67], v[120:123]
  v_bitop3_b32 v48, v48, v64, s57 bitop3:0xf6
  v_bitop3_b32 v48, v48, v66, s57 bitop3:0xf6
  v_and_b32 v48, 1, v48
  v_cmp_ne_u32 vcc, 0, v48
  s_cbranch_vccnz T_p1re_155
T_p1ok_156:
  s_nop 2
  v_add_f32_dpp v120, v120, v120 row_ror:8 row_mask:0xf bank_mask:0xf
  v_add_f32_dpp v121, v121, v121 row_ror:8 row_mask:0xf bank_mask:0xf
  v_cvt_pk_bf16_f32 v48, v120, v121
  v_min_u32 v48, -2, v48
  buffer_store_dword v48, v8, s[4:7], s35 offen sc1
  buffer_store_dword v49, v8, s[4:7], s26 offen sc1
  s_barrier
  ds_read_b128 v[28:31], v2 offset:16384
  ds_read_b128 v[32:35], v2 offset:20480
  ds_read_b128 v[36:39], v2 offset:8192
  ds_read_b128 v[40:43], v2 offset:9216
  ds_read_b128 v[44:47], v2 offset:10240
  ds_read_b128 v[48:51], v2 offset:11264
  buffer_load_dwordx4 v[124:127], v3, s[4:7], s24 offen offset:0 sc1
  buffer_load_dwordx4 v[116:119], v3, s[4:7], s25 offen offset:0 sc1
  ds_read_b128 v[52:55], v2 offset:12288
  ds_read_b128 v[56:59], v2 offset:13312
  ds_read_b128 v[60:63], v2 offset:14336
  ds_read_b128 v[64:67], v2 offset:15360
  buffer_load_dwordx4 v[124:127], v3, s[4:7], s24 offen offset:0 sc1
  buffer_load_dwordx4 v[116:119], v3, s[4:7], s25 offen offset:0 sc1
  s_mov_b32 s19, 0
  s_branch T_loop_145
T_p1re_155:
  s_mov_b64 exec, vcc
  buffer_load_dwordx4 v[52:55], v2, s[4:7], s22 offen offset:0 sc1
  buffer_load_dwordx4 v[56:59], v2, s[4:7], s22 offen offset:1024 sc1
  buffer_load_dwordx4 v[60:63], v2, s[4:7], s22 offen offset:2048 sc1
  buffer_load_dwordx4 v[64:67], v2, s[4:7], s22 offen offset:3072 sc1
  s_mov_b64 exec, -1
  s_add_u32 s19, s19, 1
  s_cmp_gt_u32 s19, 32768
  s_cbranch_scc1 M_exit
  s_waitcnt vmcnt(3)
  v_mfma_f32_16x16x32_bf16 v[120:123], v[116:119], v[52:55], 0
  v_xor_b32 v48, s57, v52
  v_bitop3_b32 v48, v48, v54, s57 bitop3:0xf6
  s_waitcnt vmcnt(2)
  v_mfma_f32_16x16x32_bf16 v[120:123], v[116:119], v[56:59], v[120:123]
  v_bitop3_b32 v48, v48, v56, s57 bitop3:0xf6
  v_bitop3_b32 v48, v48, v58, s57 bitop3:0xf6
  s_waitcnt vmcnt(1)
  v_mfma_f32_16x16x32_bf16 v[120:123], v[116:119], v[60:63], v[120:123]
  v_bitop3_b32 v48, v48, v60, s57 bitop3:0xf6
  v_bitop3_b32 v48, v48, v62, s57 bitop3:0xf6
  s_waitcnt vmcnt(0)
  v_mfma_f32_16x16x32_bf16 v[120:123], v[116:119], v[64:67], v[120:123]
  v_bitop3_b32 v48, v48, v64, s57 bitop3:0xf6
  v_bitop3_b32 v48, v48, v66, s57 bitop3:0xf6
  v_and_b32 v48, 1, v48
  v_cmp_ne_u32 vcc, 0, v48
  s_cbranch_vccnz T_p1re_155
  s_branch T_p1ok_156
T_kvw_149:
  s_mov_b32 s19, 0
  s_branch T_kvok_158
T_kv_157:
  s_sleep 4
  s_add_u32 s19, s19, 1
  s_cmp_gt_u32 s19, 32768
  s_cbranch_scc1 M_exit
T_kvok_158:
  s_add_u32 s39, s99, 128
  s_mov_b32 s38, 0
  s_mov_b32 s37, 0
  s_atomic_or s38, s[58:59], s99 glc
  s_atomic_or s37, s[58:59], s39 glc
  s_waitcnt lgkmcnt(0)
  s_add_u32 s37, s37, 30
  s_cmp_ge_u32 s38, 30
  s_cselect_b32 s38, s37, s38
  s_cmp_ge_u32 s38, 64
  s_cselect_b32 s38, 100, s38
  s_sub_u32 s38, s38, 1
  s_max_i32 s30, s30, s38
  s_cmp_ge_i32 s14, s30
  s_cbranch_scc1 T_kv_157
  s_branch T_kvb_150
T_slow_152:
  s_nop 7
  v_max3_f32 v100, v16, v17, v18
  v_max3_f32 v100, v100, v19, v20
  v_max3_f32 v100, v100, v21, v22
  v_max3_f32 v100, v100, v23, v112
  v_max3_f32 v100, v100, v113, v114
  v_max_f32 v100, v100, v115
  v_mov_b32 v101, v100
  s_nop 1
  v_permlane32_swap_b32 v100, v101
  s_nop 1
  v_max_f32 v100, v100, v101
  v_mov_b32 v101, v100
  s_nop 1
  v_permlane16_swap_b32 v100, v101
  s_nop 1
  v_max_f32 v100, v100, v101
  v_sub_f32 v16, v16, v100
  v_sub_f32 v17, v17, v100
  v_sub_f32 v18, v18, v100
  v_sub_f32 v19, v19, v100
  v_exp_f32 v16, v16
  v_exp_f32 v17, v17
  v_exp_f32 v18, v18
  v_exp_f32 v19, v19
  v_sub_f32 v20, v20, v100
  v_sub_f32 v21, v21, v100
  v_sub_f32 v22, v22, v100
  v_sub_f32 v23, v23, v100
  v_exp_f32 v20, v20
  v_exp_f32 v21, v21
  v_exp_f32 v22, v22
  v_exp_f32 v23, v23
  v_sub_f32 v112, v112, v100
  v_sub_f32 v113, v113, v100
  v_sub_f32 v114, v114, v100
  v_sub_f32 v115, v115, v100
  v_exp_f32 v112, v112
  v_exp_f32 v113, v113
  v_exp_f32 v114, v114
  v_exp_f32 v115, v115
  s_nop 0
  v_cvt_pk_bf16_f32 v44, v16, v17
  v_cvt_pk_bf16_f32 v45, v18, v19
  v_cvt_pk_bf16_f32 v46, v20, v21
  v_cvt_pk_bf16_f32 v47, v22, v23
  v_cvt_pk_bf16_f32 v84, v112, v113
  v_cvt_pk_bf16_f32 v85, v114, v115
  v_cndmask_b32 v48, v84, 0, s[16:17]
  v_cndmask_b32 v49, v85, 0, s[16:17]
  v_cndmask_b32 v50, 0, v84, s[16:17]
  v_cndmask_b32 v51, 0, v85, s[16:17]
  s_nop 1
  v_mfma_f32_16x16x16_bf16 v[88:91], v[12:13], v[48:49], 0
  v_mfma_f32_16x16x16_bf16 v[24:27], v[120:121], v[48:49], 0
  v_mfma_f32_16x16x16_bf16 v[116:119], v[120:121], v[50:51], 0
  v_mfma_f32_16x16x32_bf16 v[88:91], v[12:15], v[44:47], v[88:91]
  v_mfma_f32_16x16x32_bf16 v[24:27], v[28:31], v[44:47], v[24:27]
  v_mfma_f32_16x16x32_bf16 v[116:119], v[32:35], v[44:47], v[116:119]
  s_nop 7
  s_nop 1
  v_rcp_f32 v89, v88
  s_nop 0
  v_mul_f32 v24, v89, v24
  v_mul_f32 v25, v89, v25
  s_branch T_back_153
T_w_142:
  s_mov_b32 s19, 0
  v_mov_b64 v[16:17], 0
  v_mov_b64 v[18:19], 0
  v_mov_b64 v[20:21], 0
  v_mov_b64 v[22:23], 0
  v_mov_b64 v[24:25], 0
  v_mov_b64 v[26:27], 0
  buffer_load_dwordx4 v[124:127], v3, s[4:7], s24 offen offset:1024 sc1
  buffer_load_dwordx4 v[116:119], v3, s[4:7], s25 offen offset:1024 sc1
  buffer_load_dwordx4 v[124:127], v3, s[4:7], s24 offen offset:1024 sc1
  buffer_load_dwordx4 v[116:119], v3, s[4:7], s25 offen offset:1024 sc1
  s_branch T_loop_159
.p2align 6
T_retry_160:
  s_mov_b64 exec, vcc
  buffer_load_dwordx4 v[124:127], v3, s[4:7], s24 offen offset:1024 sc1
  buffer_load_dwordx4 v[116:119], v3, s[4:7], s25 offen offset:1024 sc1
  s_mov_b64 exec, -1
  s_add_u32 s19, s19, 1
  s_cmp_gt_u32 s19, 32768
  s_cbranch_scc1 M_exit
T_loop_159:
  s_waitcnt vmcnt(3) lgkmcnt(0)
  v_max3_u32 v123, v124, v125, v126
  v_max_u32 v123, v123, v127
  v_mov_b32_dpp v120, v124 row_ror:8 row_mask:0xf bank_mask:0xf
  v_mov_b32_dpp v121, v125 row_ror:8 row_mask:0xf bank_mask:0xf
  s_waitcnt vmcnt(2)
  v_max3_u32 v123, v123, v116, v117
  v_max3_u32 v123, v123, v118, v119
  v_cmp_eq_u32 vcc, -1, v123
  s_cbranch_vccnz T_retry_160
  v_smfmac_f32_16x16x64_bf16 v[16:19], v[124:127], v[68:75], v0
  s_add_u32 s14, s14, 1
  ds_write_b128 v2, v[124:127] offset:1024
  v_mov_b32_dpp v122, v126 row_ror:8 row_mask:0xf bank_mask:0xf
  v_smfmac_f32_16x16x64_bf16 v[20:23], v[124:127], v[76:83], v0
  s_and_b32 s57, s14, 1
  v_mov_b32_dpp v123, v127 row_ror:8 row_mask:0xf bank_mask:0xf
  v_smfmac_f32_16x16x64_bf16 v[24:27], v[124:127], v[84:91], v0
  s_and_b32 s36, s14, 3
  ds_write_b128 v2, v[116:119] offset:5120
  v_smfmac_f32_16x16x64_bf16 v[16:19], v[120:123], v[92:99], v0
  s_lshl_b32 s36, s36, 13
  v_mov_b32_dpp v84, v116 row_ror:8 row_mask:0xf bank_mask:0xf
  v_smfmac_f32_16x16x64_bf16 v[20:23], v[120:123], v[100:107], v0
  s_add_u32 s26, s36, s23
  ds_read_b128 v[68:71], v4 offset:12288
  v_mov_b32_dpp v85, v117 row_ror:8 row_mask:0xf bank_mask:0xf
  v_smfmac_f32_16x16x64_bf16 v[24:27], v[120:123], v[108:115], v0
  s_add_u32 s36, s36, 8192
  ds_read_b128 v[72:75], v4 offset:13312
  v_mov_b32_dpp v86, v118 row_ror:8 row_mask:0xf bank_mask:0xf
  v_smfmac_f32_16x16x64_bf16 v[16:19], v[116:119], v[224:231], v0
  s_and_b32 s36, s36, 0x7fff
  ds_read_b128 v[76:79], v4 offset:14336
  v_mov_b32_dpp v87, v119 row_ror:8 row_mask:0xf bank_mask:0xf
  v_smfmac_f32_16x16x64_bf16 v[20:23], v[116:119], v[240:247], v0
  s_waitcnt lgkmcnt(3)
  s_barrier
  ds_read_b128 v[100:103], v2 offset:0
  v_smfmac_f32_16x16x64_bf16 v[24:27], v[116:119], a[0:7], v0
  s_mov_b32 m0, s31
  ds_read_b128 v[120:123], v1 offset:0
  v_smfmac_f32_16x16x64_bf16 v[16:19], v[84:87], v[232:239], v0
  s_cmp_ge_i32 s14, s30
  s_cbranch_scc1 T_kvw_163
T_kvb_164:
  v_smfmac_f32_16x16x64_bf16 v[20:23], v[84:87], v[248:255], v0
  ds_read_b128 v[80:83], v4 offset:15360
  v_smfmac_f32_16x16x64_bf16 v[24:27], v[84:87], a[8:15], v0
  s_waitcnt lgkmcnt(2)
  buffer_load_dwordx4 v9, s[4:7], s27 offen sc1 lds
  v_smfmac_f32_16x16x64_bf16 v[16:19], v[100:103], v[128:135], v0
  ds_read_b128 v[92:95], v2 offset:3072
  s_mov_b32 m0, s32
  v_smfmac_f32_16x16x64_bf16 v[20:23], v[100:103], v[144:151], v0
  ds_read_b128 v[96:99], v1 offset:3072
  v_smfmac_f32_16x16x64_bf16 v[24:27], v[100:103], v[68:75], v0
  s_waitcnt vmcnt(1) lgkmcnt(3)
  ds_read_b128 v[116:119], v2 offset:2048
  v_smfmac_f32_16x16x64_bf16 v[16:19], v[120:123], v[136:143], v0
  ds_read_b128 v[124:127], v1 offset:2048
  buffer_load_dwordx4 v9, s[4:7], s27 offen offset:128 sc1 lds
  v_smfmac_f32_16x16x64_bf16 v[20:23], v[120:123], v[152:159], v0
  s_waitcnt lgkmcnt(4)
  ds_read_b128 v[104:107], v2 offset:4096
  s_mov_b32 m0, s33
  v_smfmac_f32_16x16x64_bf16 v[24:27], v[120:123], v[76:83], v0
  s_waitcnt lgkmcnt(4)
  ds_read_b128 v[108:111], v1 offset:4096
  v_smfmac_f32_16x16x64_bf16 v[16:19], v[92:95], v[160:167], v0
  s_waitcnt lgkmcnt(4)
  ds_read_b128 v[112:115], v2 offset:7168
  v_smfmac_f32_16x16x64_bf16 v[16:19], v[96:99], v[168:175], v0
  s_waitcnt lgkmcnt(4)
  ds_read_b128 v[84:87], v1 offset:7168
  buffer_load_dwordx4 v10, s[4:7], s28 offen sc1 lds
  v_smfmac_f32_16x16x64_bf16 v[16:19], v[116:119], v[192:199], v0
  s_waitcnt lgkmcnt(4)
  ds_read_b128 v[88:91], v2 offset:6144
  s_mov_b32 m0, s34
  v_smfmac_f32_16x16x64_bf16 v[16:19], v[124:127], v[200:207], v0
  s_waitcnt lgkmcnt(4)
  ds_read_b128 v[100:103], v1 offset:6144
  v_smfmac_f32_16x16x64_bf16 v[16:19], v[104:107], a[16:23], v0
  s_waitcnt lgkmcnt(4)
  ds_read_b128 v[68:71], v4 offset:16384
  v_smfmac_f32_16x16x64_bf16 v[16:19], v[108:111], a[24:31], v0
  s_waitcnt lgkmcnt(4)
  ds_read_b128 v[72:75], v4 offset:17408
  buffer_load_dwordx4 v10, s[4:7], s28 offen offset:256 sc1 lds
  v_smfmac_f32_16x16x64_bf16 v[16:19], v[112:115], a[64:71], v0
  s_waitcnt lgkmcnt(4)
  ds_read_b128 v[76:79], v4 offset:18432
  v_smfmac_f32_16x16x64_bf16 v[16:19], v[84:87], a[72:79], v0
  s_waitcnt lgkmcnt(4)
  ds_read_b128 v[80:83], v4 offset:19456
  v_smfmac_f32_16x16x64_bf16 v[16:19], v[88:91], a[112:119], v0
  s_waitcnt lgkmcnt(4)
  v_smfmac_f32_16x16x64_bf16 v[16:19], v[100:103], a[120:127], v0
  s_add_u32 s24, s36, 145752064
  s_add_u32 s25, s36, 145756160
  v_smfmac_f32_16x16x64_bf16 v[20:23], v[92:95], v[176:183], v0
  s_add_u32 s35, s36, s23
  v_smfmac_f32_16x16x64_bf16 v[20:23], v[96:99], v[184:191], v0
  s_waitcnt lgkmcnt(2)
  v_smfmac_f32_16x16x64_bf16 v[20:23], v[116:119], v[68:75], v0
  s_waitcnt lgkmcnt(0)
  ds_read_b128 v[68:71], v4 offset:20480
  v_mul_f32 v16, s18, v16
  v_smfmac_f32_16x16x64_bf16 v[20:23], v[124:127], v[76:83], v0
  ds_read_b128 v[72:75], v4 offset:21504
  v_mul_f32 v17, s18, v17
  v_smfmac_f32_16x16x64_bf16 v[20:23], v[104:107], a[32:39], v0
  ds_read_b128 v[76:79], v4 offset:22528
  v_mul_f32 v18, s18, v18
  v_smfmac_f32_16x16x64_bf16 v[20:23], v[108:111], a[40:47], v0
  ds_read_b128 v[80:83], v4 offset:23552
  v_mul_f32 v19, s18, v19
  v_smfmac_f32_16x16x64_bf16 v[20:23], v[112:115], a[80:87], v0
  v_cvt_pk_bf16_f32 v120, v16, v17
  v_smfmac_f32_16x16x64_bf16 v[20:23], v[84:87], a[88:95], v0
  v_cvt_pk_bf16_f32 v121, v18, v19
  v_smfmac_f32_16x16x64_bf16 v[20:23], v[88:91], a[128:135], v0
  ds_write_b64 v5, v[120:121] offset:24576
  v_smfmac_f32_16x16x64_bf16 v[20:23], v[100:103], a[136:143], v0
  s_waitcnt lgkmcnt(3)
  v_smfmac_f32_16x16x64_bf16 v[24:27], v[92:95], v[68:75], v0
  s_waitcnt lgkmcnt(1)
  v_mov_b64 v[92:93], 0
  v_smfmac_f32_16x16x64_bf16 v[24:27], v[96:99], v[76:83], v0
  s_nop 1
  v_cvt_pk_bf16_f32 v122, v20, v21
  v_cvt_pk_bf16_f32 v123, v22, v23
  v_smfmac_f32_16x16x64_bf16 v[24:27], v[116:119], v[208:215], v0
  ds_write_b64 v5, v[122:123] offset:26880
  v_mov_b64 v[94:95], 0
  v_smfmac_f32_16x16x64_bf16 v[24:27], v[124:127], v[216:223], v0
  s_waitcnt lgkmcnt(1)
  s_barrier
  ds_read_b64_tr_b16 v[68:69], v6 offset:24576
  v_smfmac_f32_16x16x64_bf16 v[24:27], v[104:107], a[48:55], v0
  s_add_u32 s27, s27, 8192
  ds_read_b64_tr_b16 v[70:71], v6 offset:24640
  ds_read_b64_tr_b16 v[72:73], v6 offset:24832
  v_smfmac_f32_16x16x64_bf16 v[24:27], v[108:111], a[56:63], v0
  s_add_u32 s28, s28, 8192
  ds_read_b64_tr_b16 v[74:75], v6 offset:24896
  ds_read_b64_tr_b16 v[76:77], v6 offset:25088
  v_smfmac_f32_16x16x64_bf16 v[24:27], v[112:115], a[96:103], v0
  s_nop 0
  ds_read_b64_tr_b16 v[78:79], v6 offset:25152
  ds_read_b64_tr_b16 v[80:81], v6 offset:25344
  v_smfmac_f32_16x16x64_bf16 v[24:27], v[84:87], a[104:111], v0
  ds_read_b64_tr_b16 v[82:83], v6 offset:25408
  v_mov_b64 v[96:97], 0
  v_smfmac_f32_16x16x64_bf16 v[24:27], v[88:91], a[144:151], v0
  s_waitcnt lgkmcnt(8)
  s_barrier
  ds_read_b64_tr_b16 v[116:117], v6 offset:26880
  v_smfmac_f32_16x16x64_bf16 v[24:27], v[100:103], a[152:159], v0
  s_waitcnt lgkmcnt(7)
  ds_read_b64_tr_b16 v[118:119], v6 offset:26944
  v_mfma_f32_16x16x32_bf16 v[16:19], v[36:39], v[68:71], 0
  s_waitcnt lgkmcnt(6)
  ds_read_b64_tr_b16 v[124:125], v6 offset:27136
  ds_read_b64_tr_b16 v[126:127], v6 offset:27200
  v_mfma_f32_16x16x32_bf16 v[16:19], v[40:43], v[72:75], v[16:19]
  s_waitcnt lgkmcnt(6)
  ds_read_b64_tr_b16 v[104:105], v6 offset:27392
  ds_read_b64_tr_b16 v[106:107], v6 offset:27456
  v_mfma_f32_16x16x32_bf16 v[16:19], v[44:47], v[76:79], v[16:19]
  s_waitcnt lgkmcnt(6)
  ds_read_b64_tr_b16 v[108:109], v6 offset:27648
  ds_read_b64_tr_b16 v[110:111], v6 offset:27712
  v_mfma_f32_16x16x32_bf16 v[16:19], v[48:51], v[80:83], v[16:19]
  s_waitcnt lgkmcnt(6)
  v_cvt_pk_bf16_f32 v120, v24, v25
  v_cvt_pk_bf16_f32 v121, v26, v27
  v_mfma_f32_16x16x32_bf16 v[112:115], v[116:119], v[68:71], 0
  s_waitcnt lgkmcnt(4)
  buffer_store_dwordx4 v[120:123], v2, s[4:7], s29 offen offset:1024 sc1
  v_mov_b64 v[98:99], 0
  v_mfma_f32_16x16x32_bf16 v[112:115], v[124:127], v[72:75], v[112:115]
  s_waitcnt lgkmcnt(2)
  v_mov_b64 v[36:37], 0
  v_exp_f32 v100, v16
  v_mfma_f32_16x16x32_bf16 v[112:115], v[104:107], v[76:79], v[112:115]
  s_waitcnt lgkmcnt(0)
  v_exp_f32 v101, v17
  v_mfma_f32_16x16x32_bf16 v[112:115], v[108:111], v[80:83], v[112:115]
  s_add_u32 s29, s29, 131072
  v_exp_f32 v102, v18
  v_mfma_f32_16x16x32_bf16 v[20:23], v[52:55], v[68:71], 0
  s_cmp_eq_u32 s14, 63
  v_exp_f32 v103, v19
  v_mfma_f32_16x16x32_bf16 v[20:23], v[56:59], v[72:75], v[20:23]
  s_cbranch_scc1 M_tdone
  v_cvt_pk_bf16_f32 v44, v100, v101
  v_cvt_pk_bf16_f32 v45, v102, v103
  v_mfma_f32_16x16x32_bf16 v[20:23], v[60:63], v[76:79], v[20:23]
  v_exp_f32 v100, v112
  v_mfma_f32_16x16x32_bf16 v[20:23], v[64:67], v[80:83], v[20:23]
  v_exp_f32 v101, v113
  v_exp_f32 v102, v114
  v_exp_f32 v103, v115
  v_cvt_pk_bf16_f32 v84, v100, v101
  v_cvt_pk_bf16_f32 v85, v102, v103
  v_cndmask_b32 v48, v84, 0, s[16:17]
  v_cndmask_b32 v49, v85, 0, s[16:17]
  v_cndmask_b32 v50, 0, v84, s[16:17]
  v_cndmask_b32 v51, 0, v85, s[16:17]
  v_exp_f32 v100, v20
  v_mfma_f32_16x16x16_bf16 v[88:91], v[12:13], v[48:49], 0
  v_exp_f32 v101, v21
  v_mfma_f32_16x16x16_bf16 v[24:27], v[120:121], v[48:49], 0
  v_exp_f32 v102, v22
  v_mfma_f32_16x16x16_bf16 v[116:119], v[120:121], v[50:51], 0
  v_exp_f32 v103, v23
  v_cvt_pk_bf16_f32 v46, v100, v101
  v_cvt_pk_bf16_f32 v47, v102, v103
  v_mov_b64 v[38:39], 0
  s_nop 0
  v_mfma_f32_16x16x32_bf16 v[88:91], v[12:15], v[44:47], v[88:91]
  v_mov_b64 v[40:41], 0
  v_mov_b64 v[42:43], 0
  v_mfma_f32_16x16x32_bf16 v[24:27], v[28:31], v[44:47], v[24:27]
  ds_read_b128 v[52:55], v4 offset:24576
  ds_read_b128 v[56:59], v4 offset:25600
  v_mfma_f32_16x16x32_bf16 v[116:119], v[32:35], v[44:47], v[116:119]
  s_nop 1
  v_rcp_f32 v89, v88
  v_subrev_u32 v100, s54, v88
  v_cmp_le_u32 vcc, s55, v100
  v_mul_f32 v24, v89, v24
  v_mul_f32 v25, v89, v25
  s_cbranch_vccnz T_slow_166
T_back_167:
  v_cvt_pk_bf16_f32 v124, v24, v25
  v_pk_mul_f32 v[26:27], v[26:27], v[88:89] op_sel:[0,1] op_sel_hi:[1,1]
  v_pk_mul_f32 v[116:117], v[116:117], v[88:89] op_sel:[0,1] op_sel_hi:[1,1]
  v_pk_mul_f32 v[118:119], v[118:119], v[88:89] op_sel:[0,1] op_sel_hi:[1,1]
  v_cvt_pk_bf16_f32 v125, v26, v27
  v_cvt_pk_bf16_f32 v126, v116, v117
  v_cvt_pk_bf16_f32 v127, v118, v119
  ds_write_b128 v11, v[124:127] offset:29696
  s_nop 0
  v_smfmac_f32_16x16x64_bf16 v[92:95], v[124:127], a[160:167], v0
  v_smfmac_f32_16x16x64_bf16 v[96:99], v[124:127], a[168:175], v0
  v_smfmac_f32_16x16x64_bf16 v[36:39], v[124:127], a[176:183], v0
  v_smfmac_f32_16x16x64_bf16 v[40:43], v[124:127], a[184:191], v0
  s_waitcnt lgkmcnt(0)
  s_barrier
  ds_read_b128 v[104:107], v11 offset:29184
  ds_read_b128 v[108:111], v11 offset:30720
  ds_read_b128 v[68:71], v11 offset:30208
  s_waitcnt lgkmcnt(2)
  v_smfmac_f32_16x16x64_bf16 v[92:95], v[104:107], a[192:199], v0
  s_waitcnt lgkmcnt(1)
  ds_read_b128 v[76:79], v4 offset:28672
  v_smfmac_f32_16x16x64_bf16 v[92:95], v[108:111], a[224:231], v0
  s_waitcnt lgkmcnt(1)
  ds_read_b128 v[80:83], v4 offset:29696
  v_smfmac_f32_16x16x64_bf16 v[92:95], v[68:71], a[240:247], v0
  ds_read_b128 v[60:63], v4 offset:26624
  v_smfmac_f32_16x16x64_bf16 v[96:99], v[104:107], a[200:207], v0
  ds_read_b128 v[64:67], v4 offset:27648
  v_smfmac_f32_16x16x64_bf16 v[96:99], v[108:111], a[232:239], v0
  ds_read_b128 v[28:31], v4 offset:30720
  s_nop 0
  v_cvt_pk_bf16_f32 v16, v92, v93
  v_cvt_pk_bf16_f32 v17, v94, v95
  v_bfi_b32 v16, 1, s57, v16
  v_smfmac_f32_16x16x64_bf16 v[96:99], v[68:71], a[248:255], v0
  buffer_store_dwordx2 v[16:17], v7, s[4:7], s20 offen offset:0 sc1
  v_smfmac_f32_16x16x64_bf16 v[36:39], v[104:107], a[208:215], v0
  ds_read_b128 v[32:35], v4 offset:31744
  v_smfmac_f32_16x16x64_bf16 v[36:39], v[108:111], v[52:59], v0
  s_waitcnt lgkmcnt(4)
  s_nop 0
  v_cvt_pk_bf16_f32 v18, v96, v97
  v_cvt_pk_bf16_f32 v19, v98, v99
  v_bfi_b32 v18, 1, s57, v18
  v_smfmac_f32_16x16x64_bf16 v[36:39], v[68:71], v[76:83], v0
  buffer_store_dwordx2 v[18:19], v7, s[4:7], s20 offen offset:64 sc1
  v_smfmac_f32_16x16x64_bf16 v[40:43], v[104:107], a[216:223], v0
  s_waitcnt lgkmcnt(2)
  ds_read_b128 v[116:119], v2 offset:31232
  v_smfmac_f32_16x16x64_bf16 v[40:43], v[108:111], v[60:67], v0
  s_waitcnt lgkmcnt(1)
  s_nop 0
  v_cvt_pk_bf16_f32 v20, v36, v37
  v_cvt_pk_bf16_f32 v21, v38, v39
  v_bfi_b32 v20, 1, s57, v20
  v_smfmac_f32_16x16x64_bf16 v[40:43], v[68:71], v[28:35], v0
  buffer_store_dwordx2 v[20:21], v7, s[4:7], s21 offen offset:0 sc1
  s_nop 6
  v_cvt_pk_bf16_f32 v22, v40, v41
  v_cvt_pk_bf16_f32 v23, v42, v43
  v_bfi_b32 v22, 1, s57, v22
  buffer_store_dwordx2 v[22:23], v7, s[4:7], s21 offen offset:64 sc1
  ds_read_b128 v[68:71], v4 offset:0
  ds_read_b128 v[72:75], v4 offset:1024
  ds_read_b128 v[76:79], v4 offset:4096
  ds_read_b128 v[80:83], v4 offset:5120
  ds_read_b128 v[84:87], v4 offset:8192
  ds_read_b128 v[88:91], v4 offset:9216
  ds_read_b128 v[92:95], v4 offset:2048
  ds_read_b128 v[96:99], v4 offset:3072
  ds_read_b128 v[100:103], v4 offset:6144
  ds_read_b128 v[104:107], v4 offset:7168
  ds_read_b128 v[108:111], v4 offset:10240
  ds_read_b128 v[112:115], v4 offset:11264
  v_mov_b64 v[16:17], 0
  v_mov_b64 v[18:19], 0
  v_mov_b64 v[20:21], 0
  v_mov_b64 v[22:23], 0
  v_mov_b64 v[24:25], 0
  v_mov_b64 v[26:27], 0
  s_mov_b32 s19, 0
  v_mov_b32 v49, -1
  ds_read_b64 v[44:45], v2 offset:32256
  s_waitcnt lgkmcnt(0)
  v_readfirstlane_b32 s38, v44
  v_readfirstlane_b32 s37, v45
  s_nop 0
  s_add_u32 s37, s37, 30
  s_cmp_ge_u32 s38, 30
  s_cselect_b32 s38, s37, s38
  s_cmp_ge_u32 s38, 64
  s_cselect_b32 s38, 100, s38
  s_sub_u32 s38, s38, 1
  s_max_i32 s30, s30, s38
  s_waitcnt vmcnt(0)
  buffer_load_dwordx4 v[52:55], v2, s[4:7], s22 offen offset:0 sc1
  buffer_load_dwordx4 v[56:59], v2, s[4:7], s22 offen offset:1024 sc1
  buffer_load_dwordx4 v[60:63], v2, s[4:7], s22 offen offset:2048 sc1
  buffer_load_dwordx4 v[64:67], v2, s[4:7], s22 offen offset:3072 sc1
  s_waitcnt lgkmcnt(12)
  s_waitcnt vmcnt(3)
  v_mfma_f32_16x16x32_bf16 v[120:123], v[116:119], v[52:55], 0
  v_xor_b32 v48, s57, v52
  v_bitop3_b32 v48, v48, v54, s57 bitop3:0xf6
  s_waitcnt vmcnt(2)
  v_mfma_f32_16x16x32_bf16 v[120:123], v[116:119], v[56:59], v[120:123]
  v_bitop3_b32 v48, v48, v56, s57 bitop3:0xf6
  v_bitop3_b32 v48, v48, v58, s57 bitop3:0xf6
  s_waitcnt vmcnt(1)
  v_mfma_f32_16x16x32_bf16 v[120:123], v[116:119], v[60:63], v[120:123]
  v_bitop3_b32 v48, v48, v60, s57 bitop3:0xf6
  v_bitop3_b32 v48, v48, v62, s57 bitop3:0xf6
  s_waitcnt vmcnt(0)
  v_mfma_f32_16x16x32_bf16 v[120:123], v[116:119], v[64:67], v[120:123]
  v_bitop3_b32 v48, v48, v64, s57 bitop3:0xf6
  v_bitop3_b32 v48, v48, v66, s57 bitop3:0xf6
  v_and_b32 v48, 1, v48
  v_cmp_ne_u32 vcc, 0, v48
  s_cbranch_vccnz T_p1re_169
T_p1ok_170:
  s_nop 2
  v_add_f32_dpp v120, v120, v120 row_ror:8 row_mask:0xf bank_mask:0xf
  v_add_f32_dpp v121, v121, v121 row_ror:8 row_mask:0xf bank_mask:0xf
  v_cvt_pk_bf16_f32 v48, v120, v121
  v_min_u32 v48, -2, v48
  buffer_store_dword v48, v8, s[4:7], s35 offen sc1
  buffer_store_dword v49, v8, s[4:7], s26 offen sc1
  s_barrier
  ds_read_b128 v[28:31], v2 offset:17408
  ds_read_b128 v[32:35], v2 offset:21504
  ds_read_b128 v[36:39], v2 offset:8192
  ds_read_b128 v[40:43], v2 offset:9216
  ds_read_b128 v[44:47], v2 offset:10240
  ds_read_b128 v[48:51], v2 offset:11264
  buffer_load_dwordx4 v[124:127], v3, s[4:7], s24 offen offset:1024 sc1
  buffer_load_dwordx4 v[116:119], v3, s[4:7], s25 offen offset:1024 sc1
  ds_read_b128 v[52:55], v2 offset:12288
  ds_read_b128 v[56:59], v2 offset:13312
  ds_read_b128 v[60:63], v2 offset:14336
  ds_read_b128 v[64:67], v2 offset:15360
  buffer_load_dwordx4 v[124:127], v3, s[4:7], s24 offen offset:1024 sc1
  buffer_load_dwordx4 v[116:119], v3, s[4:7], s25 offen offset:1024 sc1
  s_mov_b32 s19, 0
  s_branch T_loop_159
T_p1re_169:
  s_mov_b64 exec, vcc
  buffer_load_dwordx4 v[52:55], v2, s[4:7], s22 offen offset:0 sc1
  buffer_load_dwordx4 v[56:59], v2, s[4:7], s22 offen offset:1024 sc1
  buffer_load_dwordx4 v[60:63], v2, s[4:7], s22 offen offset:2048 sc1
  buffer_load_dwordx4 v[64:67], v2, s[4:7], s22 offen offset:3072 sc1
  s_mov_b64 exec, -1
  s_add_u32 s19, s19, 1
  s_cmp_gt_u32 s19, 32768
  s_cbranch_scc1 M_exit
  s_waitcnt vmcnt(3)
  v_mfma_f32_16x16x32_bf16 v[120:123], v[116:119], v[52:55], 0
  v_xor_b32 v48, s57, v52
  v_bitop3_b32 v48, v48, v54, s57 bitop3:0xf6
  s_waitcnt vmcnt(2)
  v_mfma_f32_16x16x32_bf16 v[120:123], v[116:119], v[56:59], v[120:123]
  v_bitop3_b32 v48, v48, v56, s57 bitop3:0xf6
  v_bitop3_b32 v48, v48, v58, s57 bitop3:0xf6
  s_waitcnt vmcnt(1)
  v_mfma_f32_16x16x32_bf16 v[120:123], v[116:119], v[60:63], v[120:123]
  v_bitop3_b32 v48, v48, v60, s57 bitop3:0xf6
  v_bitop3_b32 v48, v48, v62, s57 bitop3:0xf6
  s_waitcnt vmcnt(0)
  v_mfma_f32_16x16x32_bf16 v[120:123], v[116:119], v[64:67], v[120:123]
  v_bitop3_b32 v48, v48, v64, s57 bitop3:0xf6
  v_bitop3_b32 v48, v48, v66, s57 bitop3:0xf6
  v_and_b32 v48, 1, v48
  v_cmp_ne_u32 vcc, 0, v48
  s_cbranch_vccnz T_p1re_169
  s_branch T_p1ok_170
T_kvw_163:
  s_mov_b32 s19, 0
  s_branch T_kvok_172
T_kv_171:
  s_sleep 4
  s_add_u32 s19, s19, 1
  s_cmp_gt_u32 s19, 32768
  s_cbranch_scc1 M_exit
T_kvok_172:
  s_add_u32 s39, s99, 128
  s_mov_b32 s38, 0
  s_mov_b32 s37, 0
  s_atomic_or s38, s[58:59], s99 glc
  s_atomic_or s37, s[58:59], s39 glc
  s_waitcnt lgkmcnt(0)
  s_add_u32 s37, s37, 30
  s_cmp_ge_u32 s38, 30
  s_cselect_b32 s38, s37, s38
  s_cmp_ge_u32 s38, 64
  s_cselect_b32 s38, 100, s38
  s_sub_u32 s38, s38, 1
  s_max_i32 s30, s30, s38
  s_cmp_ge_i32 s14, s30
  s_cbranch_scc1 T_kv_171
  s_branch T_kvb_164
T_slow_166:
  s_nop 7
  v_max3_f32 v100, v16, v17, v18
  v_max3_f32 v100, v100, v19, v20
  v_max3_f32 v100, v100, v21, v22
  v_max3_f32 v100, v100, v23, v112
  v_max3_f32 v100, v100, v113, v114
  v_max_f32 v100, v100, v115
  v_mov_b32 v101, v100
  s_nop 1
  v_permlane32_swap_b32 v100, v101
  s_nop 1
  v_max_f32 v100, v100, v101
  v_mov_b32 v101, v100
  s_nop 1
  v_permlane16_swap_b32 v100, v101
  s_nop 1
  v_max_f32 v100, v100, v101
  v_sub_f32 v16, v16, v100
  v_sub_f32 v17, v17, v100
  v_sub_f32 v18, v18, v100
  v_sub_f32 v19, v19, v100
  v_exp_f32 v16, v16
  v_exp_f32 v17, v17
  v_exp_f32 v18, v18
  v_exp_f32 v19, v19
  v_sub_f32 v20, v20, v100
  v_sub_f32 v21, v21, v100
  v_sub_f32 v22, v22, v100
  v_sub_f32 v23, v23, v100
  v_exp_f32 v20, v20
  v_exp_f32 v21, v21
  v_exp_f32 v22, v22
  v_exp_f32 v23, v23
  v_sub_f32 v112, v112, v100
  v_sub_f32 v113, v113, v100
  v_sub_f32 v114, v114, v100
  v_sub_f32 v115, v115, v100
  v_exp_f32 v112, v112
  v_exp_f32 v113, v113
  v_exp_f32 v114, v114
  v_exp_f32 v115, v115
  s_nop 0
  v_cvt_pk_bf16_f32 v44, v16, v17
  v_cvt_pk_bf16_f32 v45, v18, v19
  v_cvt_pk_bf16_f32 v46, v20, v21
  v_cvt_pk_bf16_f32 v47, v22, v23
  v_cvt_pk_bf16_f32 v84, v112, v113
  v_cvt_pk_bf16_f32 v85, v114, v115
  v_cndmask_b32 v48, v84, 0, s[16:17]
  v_cndmask_b32 v49, v85, 0, s[16:17]
  v_cndmask_b32 v50, 0, v84, s[16:17]
  v_cndmask_b32 v51, 0, v85, s[16:17]
  s_nop 1
  v_mfma_f32_16x16x16_bf16 v[88:91], v[12:13], v[48:49], 0
  v_mfma_f32_16x16x16_bf16 v[24:27], v[120:121], v[48:49], 0
  v_mfma_f32_16x16x16_bf16 v[116:119], v[120:121], v[50:51], 0
  v_mfma_f32_16x16x32_bf16 v[88:91], v[12:15], v[44:47], v[88:91]
  v_mfma_f32_16x16x32_bf16 v[24:27], v[28:31], v[44:47], v[24:27]
  v_mfma_f32_16x16x32_bf16 v[116:119], v[32:35], v[44:47], v[116:119]
  s_nop 7
  s_nop 1
  v_rcp_f32 v89, v88
  s_nop 0
  v_mul_f32 v24, v89, v24
  v_mul_f32 v25, v89, v25
  s_branch T_back_167
T_w_143:
  s_mov_b32 s19, 0
  v_mov_b64 v[16:17], 0
  v_mov_b64 v[18:19], 0
  v_mov_b64 v[20:21], 0
  v_mov_b64 v[22:23], 0
  v_mov_b64 v[24:25], 0
  v_mov_b64 v[26:27], 0
  buffer_load_dwordx4 v[124:127], v3, s[4:7], s24 offen offset:2048 sc1
  buffer_load_dwordx4 v[116:119], v3, s[4:7], s25 offen offset:2048 sc1
  buffer_load_dwordx4 v[124:127], v3, s[4:7], s24 offen offset:2048 sc1
  buffer_load_dwordx4 v[116:119], v3, s[4:7], s25 offen offset:2048 sc1
  s_branch T_loop_173
.p2align 6
T_retry_174:
  s_mov_b64 exec, vcc
  buffer_load_dwordx4 v[124:127], v3, s[4:7], s24 offen offset:2048 sc1
  buffer_load_dwordx4 v[116:119], v3, s[4:7], s25 offen offset:2048 sc1
  s_mov_b64 exec, -1
  s_add_u32 s19, s19, 1
  s_cmp_gt_u32 s19, 32768
  s_cbranch_scc1 M_exit
T_loop_173:
  s_waitcnt vmcnt(3) lgkmcnt(0)
  v_max3_u32 v123, v124, v125, v126
  v_max_u32 v123, v123, v127
  v_mov_b32_dpp v120, v124 row_ror:8 row_mask:0xf bank_mask:0xf
  v_mov_b32_dpp v121, v125 row_ror:8 row_mask:0xf bank_mask:0xf
  s_waitcnt vmcnt(2)
  v_max3_u32 v123, v123, v116, v117
  v_max3_u32 v123, v123, v118, v119
  v_cmp_eq_u32 vcc, -1, v123
  s_cbranch_vccnz T_retry_174
  v_smfmac_f32_16x16x64_bf16 v[16:19], v[124:127], v[68:75], v0
  s_add_u32 s14, s14, 1
  ds_write_b128 v2, v[124:127] offset:2048
  v_mov_b32_dpp v122, v126 row_ror:8 row_mask:0xf bank_mask:0xf
  v_smfmac_f32_16x16x64_bf16 v[20:23], v[124:127], v[76:83], v0
  s_and_b32 s57, s14, 1
  v_mov_b32_dpp v123, v127 row_ror:8 row_mask:0xf bank_mask:0xf
  v_smfmac_f32_16x16x64_bf16 v[24:27], v[124:127], v[84:91], v0
  s_and_b32 s36, s14, 3
  ds_write_b128 v2, v[116:119] offset:6144
  v_smfmac_f32_16x16x64_bf16 v[16:19], v[120:123], v[92:99], v0
  s_lshl_b32 s36, s36, 13
  v_mov_b32_dpp v84, v116 row_ror:8 row_mask:0xf bank_mask:0xf
  v_smfmac_f32_16x16x64_bf16 v[20:23], v[120:123], v[100:107], v0
  s_add_u32 s26, s36, s23
  ds_read_b128 v[68:71], v4 offset:12288
  v_mov_b32_dpp v85, v117 row_ror:8 row_mask:0xf bank_mask:0xf
  v_smfmac_f32_16x16x64_bf16 v[24:27], v[120:123], v[108:115], v0
  s_add_u32 s36, s36, 8192
  ds_read_b128 v[72:75], v4 offset:13312
  v_mov_b32_dpp v86, v118 row_ror:8 row_mask:0xf bank_mask:0xf
  v_smfmac_f32_16x16x64_bf16 v[16:19], v[116:119], v[224:231], v0
  s_and_b32 s36, s36, 0x7fff
  ds_read_b128 v[76:79], v4 offset:14336
  v_mov_b32_dpp v87, v119 row_ror:8 row_mask:0xf bank_mask:0xf
  v_smfmac_f32_16x16x64_bf16 v[20:23], v[116:119], v[240:247], v0
  s_waitcnt lgkmcnt(3)
  s_barrier
  ds_read_b128 v[100:103], v2 offset:3072
  v_smfmac_f32_16x16x64_bf16 v[24:27], v[116:119], a[0:7], v0
  s_mov_b32 m0, s31
  ds_read_b128 v[120:123], v1 offset:3072
  v_smfmac_f32_16x16x64_bf16 v[16:19], v[84:87], v[232:239], v0
  s_cmp_ge_i32 s14, s30
  s_cbranch_scc1 T_kvw_177
T_kvb_178:
  v_smfmac_f32_16x16x64_bf16 v[20:23], v[84:87], v[248:255], v0
  ds_read_b128 v[80:83], v4 offset:15360
  v_smfmac_f32_16x16x64_bf16 v[24:27], v[84:87], a[8:15], v0
  s_waitcnt lgkmcnt(2)
  v_smfmac_f32_16x16x64_bf16 v[16:19], v[100:103], v[128:135], v0
  ds_read_b128 v[92:95], v2 offset:0
  buffer_load_dwordx4 v9, s[4:7], s27 offen sc1 lds
  v_smfmac_f32_16x16x64_bf16 v[20:23], v[100:103], v[144:151], v0
  ds_read_b128 v[96:99], v1 offset:0
  s_mov_b32 m0, s32
  v_smfmac_f32_16x16x64_bf16 v[24:27], v[100:103], v[68:75], v0
  s_waitcnt vmcnt(1) lgkmcnt(3)
  ds_read_b128 v[116:119], v2 offset:1024
  v_smfmac_f32_16x16x64_bf16 v[16:19], v[120:123], v[136:143], v0
  ds_read_b128 v[124:127], v1 offset:1024
  v_smfmac_f32_16x16x64_bf16 v[20:23], v[120:123], v[152:159], v0
  s_waitcnt lgkmcnt(4)
  ds_read_b128 v[104:107], v2 offset:7168
  buffer_load_dwordx4 v9, s[4:7], s27 offen offset:128 sc1 lds
  v_smfmac_f32_16x16x64_bf16 v[24:27], v[120:123], v[76:83], v0
  s_waitcnt lgkmcnt(4)
  ds_read_b128 v[108:111], v1 offset:7168
  s_mov_b32 m0, s33
  v_smfmac_f32_16x16x64_bf16 v[16:19], v[92:95], v[160:167], v0
  s_waitcnt lgkmcnt(4)
  ds_read_b128 v[112:115], v2 offset:4096
  v_mov_b32 v122, s98
  v_smfmac_f32_16x16x64_bf16 v[16:19], v[96:99], v[168:175], v0
  s_waitcnt lgkmcnt(4)
  ds_read_b128 v[84:87], v1 offset:4096
  v_smfmac_f32_16x16x64_bf16 v[16:19], v[116:119], v[192:199], v0
  s_waitcnt lgkmcnt(4)
  ds_read_b128 v[88:91], v2 offset:5120
  buffer_load_dwordx4 v10, s[4:7], s28 offen sc1 lds
  v_smfmac_f32_16x16x64_bf16 v[16:19], v[124:127], v[200:207], v0
  s_waitcnt lgkmcnt(4)
  ds_read_b128 v[100:103], v1 offset:5120
  s_mov_b32 m0, s34
  v_smfmac_f32_16x16x64_bf16 v[16:19], v[104:107], a[16:23], v0
  s_waitcnt lgkmcnt(4)
  ds_read_b128 v[68:71], v4 offset:16384
  v_smfmac_f32_16x16x64_bf16 v[16:19], v[108:111], a[24:31], v0
  s_waitcnt lgkmcnt(4)
  ds_read_b128 v[72:75], v4 offset:17408
  v_smfmac_f32_16x16x64_bf16 v[16:19], v[112:115], a[64:71], v0
  s_waitcnt lgkmcnt(4)
  ds_read_b128 v[76:79], v4 offset:18432
  buffer_load_dwordx4 v10, s[4:7], s28 offen offset:256 sc1 lds
  v_smfmac_f32_16x16x64_bf16 v[16:19], v[84:87], a[72:79], v0
  s_waitcnt lgkmcnt(4)
  ds_read_b128 v[80:83], v4 offset:19456
  v_smfmac_f32_16x16x64_bf16 v[16:19], v[88:91], a[112:119], v0
  s_waitcnt lgkmcnt(4)
  v_smfmac_f32_16x16x64_bf16 v[16:19], v[100:103], a[120:127], v0
  s_add_u32 s24, s36, 145752064
  s_add_u32 s25, s36, 145756160
  v_smfmac_f32_16x16x64_bf16 v[20:23], v[92:95], v[176:183], v0
  buffer_store_dword v122, v8, s[4:7], s15 offen sc1
  s_add_u32 s35, s36, s23
  v_smfmac_f32_16x16x64_bf16 v[20:23], v[96:99], v[184:191], v0
  s_waitcnt lgkmcnt(2)
  s_add_u32 s98, s14, 1
  v_smfmac_f32_16x16x64_bf16 v[20:23], v[116:119], v[68:75], v0
  s_waitcnt lgkmcnt(0)
  ds_read_b128 v[68:71], v4 offset:20480
  v_mul_f32 v16, s18, v16
  v_smfmac_f32_16x16x64_bf16 v[20:23], v[124:127], v[76:83], v0
  ds_read_b128 v[72:75], v4 offset:21504
  v_mul_f32 v17, s18, v17
  v_smfmac_f32_16x16x64_bf16 v[20:23], v[104:107], a[32:39], v0
  ds_read_b128 v[76:79], v4 offset:22528
  v_mul_f32 v18, s18, v18
  v_smfmac_f32_16x16x64_bf16 v[20:23], v[108:111], a[40:47], v0
  ds_read_b128 v[80:83], v4 offset:23552
  v_mul_f32 v19, s18, v19
  v_smfmac_f32_16x16x64_bf16 v[20:23], v[112:115], a[80:87], v0
  v_cvt_pk_bf16_f32 v120, v16, v17
  v_smfmac_f32_16x16x64_bf16 v[20:23], v[84:87], a[88:95], v0
  v_cvt_pk_bf16_f32 v121, v18, v19
  v_smfmac_f32_16x16x64_bf16 v[20:23], v[88:91], a[128:135], v0
  ds_write_b64 v5, v[120:121] offset:24576
  v_smfmac_f32_16x16x64_bf16 v[20:23], v[100:103], a[136:143], v0
  s_waitcnt lgkmcnt(3)
  v_smfmac_f32_16x16x64_bf16 v[24:27], v[92:95], v[68:75], v0
  s_waitcnt lgkmcnt(1)
  v_mov_b64 v[92:93], 0
  v_smfmac_f32_16x16x64_bf16 v[24:27], v[96:99], v[76:83], v0
  s_nop 1
  v_cvt_pk_bf16_f32 v122, v20, v21
  v_cvt_pk_bf16_f32 v123, v22, v23
  v_smfmac_f32_16x16x64_bf16 v[24:27], v[116:119], v[208:215], v0
  ds_write_b64 v5, v[122:123] offset:26880
  v_mov_b64 v[94:95], 0
  v_smfmac_f32_16x16x64_bf16 v[24:27], v[124:127], v[216:223], v0
  s_waitcnt lgkmcnt(1)
  s_barrier
  ds_read_b64_tr_b16 v[68:69], v6 offset:24576
  v_smfmac_f32_16x16x64_bf16 v[24:27], v[104:107], a[48:55], v0
  s_add_u32 s27, s27, 8192
  ds_read_b64_tr_b16 v[70:71], v6 offset:24640
  ds_read_b64_tr_b16 v[72:73], v6 offset:24832
  v_smfmac_f32_16x16x64_bf16 v[24:27], v[108:111], a[56:63], v0
  s_add_u32 s28, s28, 8192
  ds_read_b64_tr_b16 v[74:75], v6 offset:24896
  ds_read_b64_tr_b16 v[76:77], v6 offset:25088
  v_smfmac_f32_16x16x64_bf16 v[24:27], v[112:115], a[96:103], v0
  s_nop 0
  ds_read_b64_tr_b16 v[78:79], v6 offset:25152
  ds_read_b64_tr_b16 v[80:81], v6 offset:25344
  v_smfmac_f32_16x16x64_bf16 v[24:27], v[84:87], a[104:111], v0
  ds_read_b64_tr_b16 v[82:83], v6 offset:25408
  v_mov_b64 v[96:97], 0
  v_smfmac_f32_16x16x64_bf16 v[24:27], v[88:91], a[144:151], v0
  s_waitcnt lgkmcnt(8)
  s_barrier
  ds_read_b64_tr_b16 v[116:117], v6 offset:26880
  v_smfmac_f32_16x16x64_bf16 v[24:27], v[100:103], a[152:159], v0
  s_waitcnt lgkmcnt(7)
  ds_read_b64_tr_b16 v[118:119], v6 offset:26944
  v_mfma_f32_16x16x32_bf16 v[16:19], v[36:39], v[68:71], 0
  s_waitcnt lgkmcnt(6)
  ds_read_b64_tr_b16 v[124:125], v6 offset:27136
  ds_read_b64_tr_b16 v[126:127], v6 offset:27200
  v_mfma_f32_16x16x32_bf16 v[16:19], v[40:43], v[72:75], v[16:19]
  s_waitcnt lgkmcnt(6)
  ds_read_b64_tr_b16 v[104:105], v6 offset:27392
  ds_read_b64_tr_b16 v[106:107], v6 offset:27456
  v_mfma_f32_16x16x32_bf16 v[16:19], v[44:47], v[76:79], v[16:19]
  s_waitcnt lgkmcnt(6)
  ds_read_b64_tr_b16 v[108:109], v6 offset:27648
  ds_read_b64_tr_b16 v[110:111], v6 offset:27712
  v_mfma_f32_16x16x32_bf16 v[16:19], v[48:51], v[80:83], v[16:19]
  s_waitcnt lgkmcnt(6)
  v_cvt_pk_bf16_f32 v120, v24, v25
  v_cvt_pk_bf16_f32 v121, v26, v27
  v_mfma_f32_16x16x32_bf16 v[112:115], v[116:119], v[68:71], 0
  s_waitcnt lgkmcnt(4)
  buffer_store_dwordx4 v[120:123], v2, s[4:7], s29 offen offset:2048 sc1
  v_mov_b64 v[98:99], 0
  v_mfma_f32_16x16x32_bf16 v[112:115], v[124:127], v[72:75], v[112:115]
  s_waitcnt lgkmcnt(2)
  v_mov_b64 v[36:37], 0
  v_exp_f32 v100, v16
  v_mfma_f32_16x16x32_bf16 v[112:115], v[104:107], v[76:79], v[112:115]
  s_waitcnt lgkmcnt(0)
  v_exp_f32 v101, v17
  v_mfma_f32_16x16x32_bf16 v[112:115], v[108:111], v[80:83], v[112:115]
  s_add_u32 s29, s29, 131072
  v_exp_f32 v102, v18
  v_mfma_f32_16x16x32_bf16 v[20:23], v[52:55], v[68:71], 0
  s_cmp_eq_u32 s14, 63
  v_exp_f32 v103, v19
  v_mfma_f32_16x16x32_bf16 v[20:23], v[56:59], v[72:75], v[20:23]
  s_cbranch_scc1 M_tdone
  v_cvt_pk_bf16_f32 v44, v100, v101
  v_cvt_pk_bf16_f32 v45, v102, v103
  v_mfma_f32_16x16x32_bf16 v[20:23], v[60:63], v[76:79], v[20:23]
  v_exp_f32 v100, v112
  v_mfma_f32_16x16x32_bf16 v[20:23], v[64:67], v[80:83], v[20:23]
  v_exp_f32 v101, v113
  v_exp_f32 v102, v114
  v_exp_f32 v103, v115
  v_cvt_pk_bf16_f32 v84, v100, v101
  v_cvt_pk_bf16_f32 v85, v102, v103
  v_cndmask_b32 v48, v84, 0, s[16:17]
  v_cndmask_b32 v49, v85, 0, s[16:17]
  v_cndmask_b32 v50, 0, v84, s[16:17]
  v_cndmask_b32 v51, 0, v85, s[16:17]
  v_exp_f32 v100, v20
  v_mfma_f32_16x16x16_bf16 v[88:91], v[12:13], v[48:49], 0
  v_exp_f32 v101, v21
  v_mfma_f32_16x16x16_bf16 v[24:27], v[120:121], v[48:49], 0
  v_exp_f32 v102, v22
  v_mfma_f32_16x16x16_bf16 v[116:119], v[120:121], v[50:51], 0
  v_exp_f32 v103, v23
  v_cvt_pk_bf16_f32 v46, v100, v101
  v_cvt_pk_bf16_f32 v47, v102, v103
  v_mov_b64 v[38:39], 0
  s_nop 0
  v_mfma_f32_16x16x32_bf16 v[88:91], v[12:15], v[44:47], v[88:91]
  v_mov_b64 v[40:41], 0
  v_mov_b64 v[42:43], 0
  v_mfma_f32_16x16x32_bf16 v[24:27], v[28:31], v[44:47], v[24:27]
  ds_read_b128 v[52:55], v4 offset:24576
  ds_read_b128 v[56:59], v4 offset:25600
  v_mfma_f32_16x16x32_bf16 v[116:119], v[32:35], v[44:47], v[116:119]
  s_nop 1
  v_rcp_f32 v89, v88
  v_subrev_u32 v100, s54, v88
  v_cmp_le_u32 vcc, s55, v100
  v_mul_f32 v24, v89, v24
  v_mul_f32 v25, v89, v25
  s_cbranch_vccnz T_slow_180
T_back_181:
  v_cvt_pk_bf16_f32 v124, v24, v25
  v_pk_mul_f32 v[26:27], v[26:27], v[88:89] op_sel:[0,1] op_sel_hi:[1,1]
  v_pk_mul_f32 v[116:117], v[116:117], v[88:89] op_sel:[0,1] op_sel_hi:[1,1]
  v_pk_mul_f32 v[118:119], v[118:119], v[88:89] op_sel:[0,1] op_sel_hi:[1,1]
  v_cvt_pk_bf16_f32 v125, v26, v27
  v_cvt_pk_bf16_f32 v126, v116, v117
  v_cvt_pk_bf16_f32 v127, v118, v119
  ds_write_b128 v11, v[124:127] offset:30208
  s_nop 0
  v_smfmac_f32_16x16x64_bf16 v[92:95], v[124:127], a[160:167], v0
  v_smfmac_f32_16x16x64_bf16 v[96:99], v[124:127], a[168:175], v0
  v_smfmac_f32_16x16x64_bf16 v[36:39], v[124:127], a[176:183], v0
  v_smfmac_f32_16x16x64_bf16 v[40:43], v[124:127], a[184:191], v0
  s_waitcnt lgkmcnt(0)
  s_barrier
  ds_read_b128 v[104:107], v11 offset:30720
  ds_read_b128 v[108:111], v11 offset:29184
  ds_read_b128 v[68:71], v11 offset:29696
  s_waitcnt lgkmcnt(2)
  v_smfmac_f32_16x16x64_bf16 v[92:95], v[104:107], a[192:199], v0
  s_waitcnt lgkmcnt(1)
  ds_read_b128 v[76:79], v4 offset:28672
  v_smfmac_f32_16x16x64_bf16 v[92:95], v[108:111], a[224:231], v0
  s_waitcnt lgkmcnt(1)
  ds_read_b128 v[80:83], v4 offset:29696
  v_smfmac_f32_16x16x64_bf16 v[92:95], v[68:71], a[240:247], v0
  ds_read_b128 v[60:63], v4 offset:26624
  v_smfmac_f32_16x16x64_bf16 v[96:99], v[104:107], a[200:207], v0
  ds_read_b128 v[64:67], v4 offset:27648
  v_smfmac_f32_16x16x64_bf16 v[96:99], v[108:111], a[232:239], v0
  ds_read_b128 v[28:31], v4 offset:30720
  s_nop 0
  v_cvt_pk_bf16_f32 v16, v92, v93
  v_cvt_pk_bf16_f32 v17, v94, v95
  v_bfi_b32 v16, 1, s57, v16
  v_smfmac_f32_16x16x64_bf16 v[96:99], v[68:71], a[248:255], v0
  buffer_store_dwordx2 v[16:17], v7, s[4:7], s20 offen offset:0 sc1
  v_smfmac_f32_16x16x64_bf16 v[36:39], v[104:107], a[208:215], v0
  ds_read_b128 v[32:35], v4 offset:31744
  v_smfmac_f32_16x16x64_bf16 v[36:39], v[108:111], v[52:59], v0
  s_waitcnt lgkmcnt(4)
  s_nop 0
  v_cvt_pk_bf16_f32 v18, v96, v97
  v_cvt_pk_bf16_f32 v19, v98, v99
  v_bfi_b32 v18, 1, s57, v18
  v_smfmac_f32_16x16x64_bf16 v[36:39], v[68:71], v[76:83], v0
  buffer_store_dwordx2 v[18:19], v7, s[4:7], s20 offen offset:64 sc1
  v_smfmac_f32_16x16x64_bf16 v[40:43], v[104:107], a[216:223], v0
  s_waitcnt lgkmcnt(2)
  v_smfmac_f32_16x16x64_bf16 v[40:43], v[108:111], v[60:67], v0
  s_waitcnt lgkmcnt(0)
  s_nop 0
  v_cvt_pk_bf16_f32 v20, v36, v37
  v_cvt_pk_bf16_f32 v21, v38, v39
  v_bfi_b32 v20, 1, s57, v20
  v_smfmac_f32_16x16x64_bf16 v[40:43], v[68:71], v[28:35], v0
  buffer_store_dwordx2 v[20:21], v7, s[4:7], s21 offen offset:0 sc1
  s_nop 6
  v_cvt_pk_bf16_f32 v22, v40, v41
  v_cvt_pk_bf16_f32 v23, v42, v43
  v_bfi_b32 v22, 1, s57, v22
  buffer_store_dwordx2 v[22:23], v7, s[4:7], s21 offen offset:64 sc1
  ds_read_b128 v[68:71], v4 offset:0
  ds_read_b128 v[72:75], v4 offset:1024
  ds_read_b128 v[76:79], v4 offset:4096
  ds_read_b128 v[80:83], v4 offset:5120
  ds_read_b128 v[84:87], v4 offset:8192
  ds_read_b128 v[88:91], v4 offset:9216
  ds_read_b128 v[92:95], v4 offset:2048
  ds_read_b128 v[96:99], v4 offset:3072
  ds_read_b128 v[100:103], v4 offset:6144
  ds_read_b128 v[104:107], v4 offset:7168
  ds_read_b128 v[108:111], v4 offset:10240
  ds_read_b128 v[112:115], v4 offset:11264
  v_mov_b64 v[16:17], 0
  v_mov_b64 v[18:19], 0
  v_mov_b64 v[20:21], 0
  v_mov_b64 v[22:23], 0
  v_mov_b64 v[24:25], 0
  v_mov_b64 v[26:27], 0
  ds_read_b64 v[44:45], v2 offset:32256
  s_waitcnt lgkmcnt(0)
  v_readfirstlane_b32 s38, v44
  v_readfirstlane_b32 s37, v45
  s_nop 0
  s_add_u32 s37, s37, 30
  s_cmp_ge_u32 s38, 30
  s_cselect_b32 s38, s37, s38
  s_cmp_ge_u32 s38, 64
  s_cselect_b32 s38, 100, s38
  s_sub_u32 s38, s38, 1
  s_max_i32 s30, s30, s38
  s_waitcnt vmcnt(4)
  s_barrier
  ds_read_b128 v[28:31], v2 offset:18432
  ds_read_b128 v[32:35], v2 offset:22528
  ds_read_b128 v[36:39], v2 offset:8192
  ds_read_b128 v[40:43], v2 offset:9216
  ds_read_b128 v[44:47], v2 offset:10240
  ds_read_b128 v[48:51], v2 offset:11264
  buffer_load_dwordx4 v[124:127], v3, s[4:7], s24 offen offset:2048 sc1
  buffer_load_dwordx4 v[116:119], v3, s[4:7], s25 offen offset:2048 sc1
  ds_read_b128 v[52:55], v2 offset:12288
  ds_read_b128 v[56:59], v2 offset:13312
  ds_read_b128 v[60:63], v2 offset:14336
  ds_read_b128 v[64:67], v2 offset:15360
  buffer_load_dwordx4 v[124:127], v3, s[4:7], s24 offen offset:2048 sc1
  buffer_load_dwordx4 v[116:119], v3, s[4:7], s25 offen offset:2048 sc1
  s_mov_b32 s19, 0
  s_branch T_loop_173
T_kvw_177:
  s_mov_b32 s19, 0
  s_branch T_kvok_186
T_kv_185:
  s_sleep 4
  s_add_u32 s19, s19, 1
  s_cmp_gt_u32 s19, 32768
  s_cbranch_scc1 M_exit
T_kvok_186:
  s_add_u32 s39, s99, 128
  s_mov_b32 s38, 0
  s_mov_b32 s37, 0
  s_atomic_or s38, s[58:59], s99 glc
  s_atomic_or s37, s[58:59], s39 glc
  s_waitcnt lgkmcnt(0)
  s_add_u32 s37, s37, 30
  s_cmp_ge_u32 s38, 30
  s_cselect_b32 s38, s37, s38
  s_cmp_ge_u32 s38, 64
  s_cselect_b32 s38, 100, s38
  s_sub_u32 s38, s38, 1
  s_max_i32 s30, s30, s38
  s_cmp_ge_i32 s14, s30
  s_cbranch_scc1 T_kv_185
  s_branch T_kvb_178
T_slow_180:
  s_nop 7
  v_max3_f32 v100, v16, v17, v18
  v_max3_f32 v100, v100, v19, v20
  v_max3_f32 v100, v100, v21, v22
  v_max3_f32 v100, v100, v23, v112
  v_max3_f32 v100, v100, v113, v114
  v_max_f32 v100, v100, v115
  v_mov_b32 v101, v100
  s_nop 1
  v_permlane32_swap_b32 v100, v101
  s_nop 1
  v_max_f32 v100, v100, v101
  v_mov_b32 v101, v100
  s_nop 1
  v_permlane16_swap_b32 v100, v101
  s_nop 1
  v_max_f32 v100, v100, v101
  v_sub_f32 v16, v16, v100
  v_sub_f32 v17, v17, v100
  v_sub_f32 v18, v18, v100
  v_sub_f32 v19, v19, v100
  v_exp_f32 v16, v16
  v_exp_f32 v17, v17
  v_exp_f32 v18, v18
  v_exp_f32 v19, v19
  v_sub_f32 v20, v20, v100
  v_sub_f32 v21, v21, v100
  v_sub_f32 v22, v22, v100
  v_sub_f32 v23, v23, v100
  v_exp_f32 v20, v20
  v_exp_f32 v21, v21
  v_exp_f32 v22, v22
  v_exp_f32 v23, v23
  v_sub_f32 v112, v112, v100
  v_sub_f32 v113, v113, v100
  v_sub_f32 v114, v114, v100
  v_sub_f32 v115, v115, v100
  v_exp_f32 v112, v112
  v_exp_f32 v113, v113
  v_exp_f32 v114, v114
  v_exp_f32 v115, v115
  s_nop 0
  v_cvt_pk_bf16_f32 v44, v16, v17
  v_cvt_pk_bf16_f32 v45, v18, v19
  v_cvt_pk_bf16_f32 v46, v20, v21
  v_cvt_pk_bf16_f32 v47, v22, v23
  v_cvt_pk_bf16_f32 v84, v112, v113
  v_cvt_pk_bf16_f32 v85, v114, v115
  v_cndmask_b32 v48, v84, 0, s[16:17]
  v_cndmask_b32 v49, v85, 0, s[16:17]
  v_cndmask_b32 v50, 0, v84, s[16:17]
  v_cndmask_b32 v51, 0, v85, s[16:17]
  s_nop 1
  v_mfma_f32_16x16x16_bf16 v[88:91], v[12:13], v[48:49], 0
  v_mfma_f32_16x16x16_bf16 v[24:27], v[120:121], v[48:49], 0
  v_mfma_f32_16x16x16_bf16 v[116:119], v[120:121], v[50:51], 0
  v_mfma_f32_16x16x32_bf16 v[88:91], v[12:15], v[44:47], v[88:91]
  v_mfma_f32_16x16x32_bf16 v[24:27], v[28:31], v[44:47], v[24:27]
  v_mfma_f32_16x16x32_bf16 v[116:119], v[32:35], v[44:47], v[116:119]
  s_nop 7
  s_nop 1
  v_rcp_f32 v89, v88
  s_nop 0
  v_mul_f32 v24, v89, v24
  v_mul_f32 v25, v89, v25
  s_branch T_back_181
T_w_144:
  s_mov_b32 s19, 0
  v_mov_b64 v[16:17], 0
  v_mov_b64 v[18:19], 0
  v_mov_b64 v[20:21], 0
  v_mov_b64 v[22:23], 0
  v_mov_b64 v[24:25], 0
  v_mov_b64 v[26:27], 0
  buffer_load_dwordx4 v[124:127], v3, s[4:7], s24 offen offset:3072 sc1
  buffer_load_dwordx4 v[116:119], v3, s[4:7], s25 offen offset:3072 sc1
  buffer_load_dwordx4 v[124:127], v3, s[4:7], s24 offen offset:3072 sc1
  buffer_load_dwordx4 v[116:119], v3, s[4:7], s25 offen offset:3072 sc1
  s_branch T_loop_187
.p2align 6
T_retry_188:
  s_mov_b64 exec, vcc
  buffer_load_dwordx4 v[124:127], v3, s[4:7], s24 offen offset:3072 sc1
  buffer_load_dwordx4 v[116:119], v3, s[4:7], s25 offen offset:3072 sc1
  s_mov_b64 exec, -1
  s_add_u32 s19, s19, 1
  s_cmp_gt_u32 s19, 32768
  s_cbranch_scc1 M_exit
T_loop_187:
  s_waitcnt vmcnt(3) lgkmcnt(0)
  v_max3_u32 v123, v124, v125, v126
  v_max_u32 v123, v123, v127
  v_mov_b32_dpp v120, v124 row_ror:8 row_mask:0xf bank_mask:0xf
  v_mov_b32_dpp v121, v125 row_ror:8 row_mask:0xf bank_mask:0xf
  s_waitcnt vmcnt(2)
  v_max3_u32 v123, v123, v116, v117
  v_max3_u32 v123, v123, v118, v119
  v_cmp_eq_u32 vcc, -1, v123
  s_cbranch_vccnz T_retry_188
  v_smfmac_f32_16x16x64_bf16 v[16:19], v[124:127], v[68:75], v0
  s_add_u32 s14, s14, 1
  ds_write_b128 v2, v[124:127] offset:3072
  v_mov_b32_dpp v122, v126 row_ror:8 row_mask:0xf bank_mask:0xf
  v_smfmac_f32_16x16x64_bf16 v[20:23], v[124:127], v[76:83], v0
  s_and_b32 s57, s14, 1
  v_mov_b32_dpp v123, v127 row_ror:8 row_mask:0xf bank_mask:0xf
  v_smfmac_f32_16x16x64_bf16 v[24:27], v[124:127], v[84:91], v0
  s_and_b32 s36, s14, 3
  ds_write_b128 v2, v[116:119] offset:7168
  v_smfmac_f32_16x16x64_bf16 v[16:19], v[120:123], v[92:99], v0
  s_lshl_b32 s36, s36, 13
  v_mov_b32_dpp v84, v116 row_ror:8 row_mask:0xf bank_mask:0xf
  v_smfmac_f32_16x16x64_bf16 v[20:23], v[120:123], v[100:107], v0
  s_add_u32 s26, s36, s23
  ds_read_b128 v[68:71], v4 offset:12288
  v_mov_b32_dpp v85, v117 row_ror:8 row_mask:0xf bank_mask:0xf
  v_smfmac_f32_16x16x64_bf16 v[24:27], v[120:123], v[108:115], v0
  s_add_u32 s36, s36, 8192
  ds_read_b128 v[72:75], v4 offset:13312
  v_mov_b32_dpp v86, v118 row_ror:8 row_mask:0xf bank_mask:0xf
  v_smfmac_f32_16x16x64_bf16 v[16:19], v[116:119], v[224:231], v0
  s_and_b32 s36, s36, 0x7fff
  ds_read_b128 v[76:79], v4 offset:14336
  v_mov_b32_dpp v87, v119 row_ror:8 row_mask:0xf bank_mask:0xf
  v_smfmac_f32_16x16x64_bf16 v[20:23], v[116:119], v[240:247], v0
  s_waitcnt lgkmcnt(3)
  s_barrier
  ds_read_b128 v[100:103], v2 offset:2048
  v_smfmac_f32_16x16x64_bf16 v[24:27], v[116:119], a[0:7], v0
  s_mov_b32 m0, s31
  ds_read_b128 v[120:123], v1 offset:2048
  v_smfmac_f32_16x16x64_bf16 v[16:19], v[84:87], v[232:239], v0
  s_cmp_ge_i32 s14, s30
  s_cbranch_scc1 T_kvw_191
T_kvb_192:
  v_smfmac_f32_16x16x64_bf16 v[20:23], v[84:87], v[248:255], v0
  ds_read_b128 v[80:83], v4 offset:15360
  v_smfmac_f32_16x16x64_bf16 v[24:27], v[84:87], a[8:15], v0
  s_waitcnt lgkmcnt(2)
  v_smfmac_f32_16x16x64_bf16 v[16:19], v[100:103], v[128:135], v0
  ds_read_b128 v[92:95], v2 offset:1024
  v_smfmac_f32_16x16x64_bf16 v[20:23], v[100:103], v[144:151], v0
  ds_read_b128 v[96:99], v1 offset:1024
  buffer_load_dwordx4 v9, s[4:7], s27 offen sc1 lds
  v_smfmac_f32_16x16x64_bf16 v[24:27], v[100:103], v[68:75], v0
  s_waitcnt vmcnt(1) lgkmcnt(3)
  ds_read_b128 v[116:119], v2 offset:0
  s_mov_b32 m0, s32
  v_smfmac_f32_16x16x64_bf16 v[16:19], v[120:123], v[136:143], v0
  ds_read_b128 v[124:127], v1 offset:0
  v_smfmac_f32_16x16x64_bf16 v[20:23], v[120:123], v[152:159], v0
  s_waitcnt lgkmcnt(4)
  ds_read_b128 v[104:107], v2 offset:6144
  v_smfmac_f32_16x16x64_bf16 v[24:27], v[120:123], v[76:83], v0
  s_waitcnt lgkmcnt(4)
  ds_read_b128 v[108:111], v1 offset:6144
  buffer_load_dwordx4 v9, s[4:7], s27 offen offset:128 sc1 lds
  v_smfmac_f32_16x16x64_bf16 v[16:19], v[92:95], v[160:167], v0
  s_waitcnt lgkmcnt(4)
  ds_read_b128 v[112:115], v2 offset:5120
  s_mov_b32 m0, s33
  v_smfmac_f32_16x16x64_bf16 v[16:19], v[96:99], v[168:175], v0
  s_waitcnt lgkmcnt(4)
  ds_read_b128 v[84:87], v1 offset:5120
  v_smfmac_f32_16x16x64_bf16 v[16:19], v[116:119], v[192:199], v0
  s_waitcnt lgkmcnt(4)
  ds_read_b128 v[88:91], v2 offset:4096
  v_smfmac_f32_16x16x64_bf16 v[16:19], v[124:127], v[200:207], v0
  s_waitcnt lgkmcnt(4)
  ds_read_b128 v[100:103], v1 offset:4096
  buffer_load_dwordx4 v10, s[4:7], s28 offen sc1 lds
  v_smfmac_f32_16x16x64_bf16 v[16:19], v[104:107], a[16:23], v0
  s_waitcnt lgkmcnt(4)
  ds_read_b128 v[68:71], v4 offset:16384
  s_mov_b32 m0, s34
  v_smfmac_f32_16x16x64_bf16 v[16:19], v[108:111], a[24:31], v0
  s_waitcnt lgkmcnt(4)
  ds_read_b128 v[72:75], v4 offset:17408
  v_smfmac_f32_16x16x64_bf16 v[16:19], v[112:115], a[64:71], v0
  s_waitcnt lgkmcnt(4)
  ds_read_b128 v[76:79], v4 offset:18432
  v_smfmac_f32_16x16x64_bf16 v[16:19], v[84:87], a[72:79], v0
  s_waitcnt lgkmcnt(4)
  ds_read_b128 v[80:83], v4 offset:19456
  buffer_load_dwordx4 v10, s[4:7], s28 offen offset:256 sc1 lds
  v_smfmac_f32_16x16x64_bf16 v[16:19], v[88:91], a[112:119], v0
  s_waitcnt lgkmcnt(4)
  s_mov_b32 m0, 32256
  v_smfmac_f32_16x16x64_bf16 v[16:19], v[100:103], a[120:127], v0
  s_add_u32 s24, s36, 145752064
  s_add_u32 s25, s36, 145756160
  v_smfmac_f32_16x16x64_bf16 v[20:23], v[92:95], v[176:183], v0
  s_add_u32 s35, s36, s23
  v_smfmac_f32_16x16x64_bf16 v[20:23], v[96:99], v[184:191], v0
  s_waitcnt lgkmcnt(2)
  buffer_load_dword v8, s[4:7], s99 offen sc1 lds
  v_smfmac_f32_16x16x64_bf16 v[20:23], v[116:119], v[68:75], v0
  s_waitcnt lgkmcnt(0)
  ds_read_b128 v[68:71], v4 offset:20480
  v_mul_f32 v16, s18, v16
  v_smfmac_f32_16x16x64_bf16 v[20:23], v[124:127], v[76:83], v0
  ds_read_b128 v[72:75], v4 offset:21504
  v_mul_f32 v17, s18, v17
  v_smfmac_f32_16x16x64_bf16 v[20:23], v[104:107], a[32:39], v0
  ds_read_b128 v[76:79], v4 offset:22528
  v_mul_f32 v18, s18, v18
  v_smfmac_f32_16x16x64_bf16 v[20:23], v[108:111], a[40:47], v0
  ds_read_b128 v[80:83], v4 offset:23552
  v_mul_f32 v19, s18, v19
  v_smfmac_f32_16x16x64_bf16 v[20:23], v[112:115], a[80:87], v0
  v_cvt_pk_bf16_f32 v120, v16, v17
  v_smfmac_f32_16x16x64_bf16 v[20:23], v[84:87], a[88:95], v0
  v_cvt_pk_bf16_f32 v121, v18, v19
  v_smfmac_f32_16x16x64_bf16 v[20:23], v[88:91], a[128:135], v0
  ds_write_b64 v5, v[120:121] offset:24576
  v_smfmac_f32_16x16x64_bf16 v[20:23], v[100:103], a[136:143], v0
  s_waitcnt lgkmcnt(3)
  v_smfmac_f32_16x16x64_bf16 v[24:27], v[92:95], v[68:75], v0
  s_waitcnt lgkmcnt(1)
  v_mov_b64 v[92:93], 0
  v_smfmac_f32_16x16x64_bf16 v[24:27], v[96:99], v[76:83], v0
  s_nop 1
  v_cvt_pk_bf16_f32 v122, v20, v21
  v_cvt_pk_bf16_f32 v123, v22, v23
  v_smfmac_f32_16x16x64_bf16 v[24:27], v[116:119], v[208:215], v0
  ds_write_b64 v5, v[122:123] offset:26880
  v_mov_b64 v[94:95], 0
  v_smfmac_f32_16x16x64_bf16 v[24:27], v[124:127], v[216:223], v0
  s_waitcnt lgkmcnt(1)
  s_barrier
  ds_read_b64_tr_b16 v[68:69], v6 offset:24576
  v_smfmac_f32_16x16x64_bf16 v[24:27], v[104:107], a[48:55], v0
  s_add_u32 s27, s27, 8192
  ds_read_b64_tr_b16 v[70:71], v6 offset:24640
  ds_read_b64_tr_b16 v[72:73], v6 offset:24832
  v_smfmac_f32_16x16x64_bf16 v[24:27], v[108:111], a[56:63], v0
  s_add_u32 s28, s28, 8192
  ds_read_b64_tr_b16 v[74:75], v6 offset:24896
  ds_read_b64_tr_b16 v[76:77], v6 offset:25088
  v_smfmac_f32_16x16x64_bf16 v[24:27], v[112:115], a[96:103], v0
  s_nop 0
  ds_read_b64_tr_b16 v[78:79], v6 offset:25152
  ds_read_b64_tr_b16 v[80:81], v6 offset:25344
  v_smfmac_f32_16x16x64_bf16 v[24:27], v[84:87], a[104:111], v0
  ds_read_b64_tr_b16 v[82:83], v6 offset:25408
  v_mov_b64 v[96:97], 0
  v_smfmac_f32_16x16x64_bf16 v[24:27], v[88:91], a[144:151], v0
  s_waitcnt lgkmcnt(8)
  s_barrier
  ds_read_b64_tr_b16 v[116:117], v6 offset:26880
  v_smfmac_f32_16x16x64_bf16 v[24:27], v[100:103], a[152:159], v0
  s_waitcnt lgkmcnt(7)
  ds_read_b64_tr_b16 v[118:119], v6 offset:26944
  v_mfma_f32_16x16x32_bf16 v[16:19], v[36:39], v[68:71], 0
  s_waitcnt lgkmcnt(6)
  ds_read_b64_tr_b16 v[124:125], v6 offset:27136
  ds_read_b64_tr_b16 v[126:127], v6 offset:27200
  v_mfma_f32_16x16x32_bf16 v[16:19], v[40:43], v[72:75], v[16:19]
  s_waitcnt lgkmcnt(6)
  ds_read_b64_tr_b16 v[104:105], v6 offset:27392
  ds_read_b64_tr_b16 v[106:107], v6 offset:27456
  v_mfma_f32_16x16x32_bf16 v[16:19], v[44:47], v[76:79], v[16:19]
  s_waitcnt lgkmcnt(6)
  ds_read_b64_tr_b16 v[108:109], v6 offset:27648
  ds_read_b64_tr_b16 v[110:111], v6 offset:27712
  v_mfma_f32_16x16x32_bf16 v[16:19], v[48:51], v[80:83], v[16:19]
  s_waitcnt lgkmcnt(6)
  v_cvt_pk_bf16_f32 v120, v24, v25
  v_cvt_pk_bf16_f32 v121, v26, v27
  v_mfma_f32_16x16x32_bf16 v[112:115], v[116:119], v[68:71], 0
  s_waitcnt lgkmcnt(4)
  buffer_store_dwordx4 v[120:123], v2, s[4:7], s29 offen offset:3072 sc1
  v_mov_b64 v[98:99], 0
  v_mfma_f32_16x16x32_bf16 v[112:115], v[124:127], v[72:75], v[112:115]
  s_waitcnt lgkmcnt(2)
  v_mov_b64 v[36:37], 0
  v_exp_f32 v100, v16
  v_mfma_f32_16x16x32_bf16 v[112:115], v[104:107], v[76:79], v[112:115]
  s_waitcnt lgkmcnt(0)
  v_exp_f32 v101, v17
  v_mfma_f32_16x16x32_bf16 v[112:115], v[108:111], v[80:83], v[112:115]
  s_add_u32 s29, s29, 131072
  v_exp_f32 v102, v18
  v_mfma_f32_16x16x32_bf16 v[20:23], v[52:55], v[68:71], 0
  s_cmp_eq_u32 s14, 63
  v_exp_f32 v103, v19
  v_mfma_f32_16x16x32_bf16 v[20:23], v[56:59], v[72:75], v[20:23]
  s_cbranch_scc1 M_tdone
  v_cvt_pk_bf16_f32 v44, v100, v101
  v_cvt_pk_bf16_f32 v45, v102, v103
  v_mfma_f32_16x16x32_bf16 v[20:23], v[60:63], v[76:79], v[20:23]
  v_exp_f32 v100, v112
  v_mfma_f32_16x16x32_bf16 v[20:23], v[64:67], v[80:83], v[20:23]
  v_exp_f32 v101, v113
  v_exp_f32 v102, v114
  v_exp_f32 v103, v115
  v_cvt_pk_bf16_f32 v84, v100, v101
  v_cvt_pk_bf16_f32 v85, v102, v103
  v_cndmask_b32 v48, v84, 0, s[16:17]
  v_cndmask_b32 v49, v85, 0, s[16:17]
  v_cndmask_b32 v50, 0, v84, s[16:17]
  v_cndmask_b32 v51, 0, v85, s[16:17]
  v_exp_f32 v100, v20
  v_mfma_f32_16x16x16_bf16 v[88:91], v[12:13], v[48:49], 0
  v_exp_f32 v101, v21
  v_mfma_f32_16x16x16_bf16 v[24:27], v[120:121], v[48:49], 0
  v_exp_f32 v102, v22
  v_mfma_f32_16x16x16_bf16 v[116:119], v[120:121], v[50:51], 0
  v_exp_f32 v103, v23
  v_cvt_pk_bf16_f32 v46, v100, v101
  v_cvt_pk_bf16_f32 v47, v102, v103
  v_mov_b64 v[38:39], 0
  s_nop 0
  v_mfma_f32_16x16x32_bf16 v[88:91], v[12:15], v[44:47], v[88:91]
  v_mov_b64 v[40:41], 0
  v_mov_b64 v[42:43], 0
  v_mfma_f32_16x16x32_bf16 v[24:27], v[28:31], v[44:47], v[24:27]
  ds_read_b128 v[52:55], v4 offset:24576
  ds_read_b128 v[56:59], v4 offset:25600
  v_mfma_f32_16x16x32_bf16 v[116:119], v[32:35], v[44:47], v[116:119]
  s_nop 1
  v_rcp_f32 v89, v88
  v_subrev_u32 v100, s54, v88
  v_cmp_le_u32 vcc, s55, v100
  v_mul_f32 v24, v89, v24
  v_mul_f32 v25, v89, v25
  s_cbranch_vccnz T_slow_194
T_back_195:
  v_cvt_pk_bf16_f32 v124, v24, v25
  v_pk_mul_f32 v[26:27], v[26:27], v[88:89] op_sel:[0,1] op_sel_hi:[1,1]
  v_pk_mul_f32 v[116:117], v[116:117], v[88:89] op_sel:[0,1] op_sel_hi:[1,1]
  v_pk_mul_f32 v[118:119], v[118:119], v[88:89] op_sel:[0,1] op_sel_hi:[1,1]
  v_cvt_pk_bf16_f32 v125, v26, v27
  v_cvt_pk_bf16_f32 v126, v116, v117
  v_cvt_pk_bf16_f32 v127, v118, v119
  ds_write_b128 v11, v[124:127] offset:30720
  s_nop 0
  v_smfmac_f32_16x16x64_bf16 v[92:95], v[124:127], a[160:167], v0
  v_smfmac_f32_16x16x64_bf16 v[96:99], v[124:127], a[168:175], v0
  v_smfmac_f32_16x16x64_bf16 v[36:39], v[124:127], a[176:183], v0
  v_smfmac_f32_16x16x64_bf16 v[40:43], v[124:127], a[184:191], v0
  s_waitcnt lgkmcnt(0)
  s_barrier
  ds_read_b128 v[104:107], v11 offset:30208
  ds_read_b128 v[108:111], v11 offset:29696
  ds_read_b128 v[68:71], v11 offset:29184
  s_waitcnt lgkmcnt(2)
  v_smfmac_f32_16x16x64_bf16 v[92:95], v[104:107], a[192:199], v0
  s_waitcnt lgkmcnt(1)
  ds_read_b128 v[76:79], v4 offset:28672
  v_smfmac_f32_16x16x64_bf16 v[92:95], v[108:111], a[224:231], v0
  s_waitcnt lgkmcnt(1)
  ds_read_b128 v[80:83], v4 offset:29696
  v_smfmac_f32_16x16x64_bf16 v[92:95], v[68:71], a[240:247], v0
  ds_read_b128 v[60:63], v4 offset:26624
  v_smfmac_f32_16x16x64_bf16 v[96:99], v[104:107], a[200:207], v0
  ds_read_b128 v[64:67], v4 offset:27648
  v_smfmac_f32_16x16x64_bf16 v[96:99], v[108:111], a[232:239], v0
  ds_read_b128 v[28:31], v4 offset:30720
  s_nop 0
  v_cvt_pk_bf16_f32 v16, v92, v93
  v_cvt_pk_bf16_f32 v17, v94, v95
  v_bfi_b32 v16, 1, s57, v16
  v_smfmac_f32_16x16x64_bf16 v[96:99], v[68:71], a[248:255], v0
  buffer_store_dwordx2 v[16:17], v7, s[4:7], s20 offen offset:0 sc1
  v_smfmac_f32_16x16x64_bf16 v[36:39], v[104:107], a[208:215], v0
  ds_read_b128 v[32:35], v4 offset:31744
  v_smfmac_f32_16x16x64_bf16 v[36:39], v[108:111], v[52:59], v0
  s_waitcnt lgkmcnt(4)
  s_nop 0
  v_cvt_pk_bf16_f32 v18, v96, v97
  v_cvt_pk_bf16_f32 v19, v98, v99
  v_bfi_b32 v18, 1, s57, v18
  v_smfmac_f32_16x16x64_bf16 v[36:39], v[68:71], v[76:83], v0
  buffer_store_dwordx2 v[18:19], v7, s[4:7], s20 offen offset:64 sc1
  v_smfmac_f32_16x16x64_bf16 v[40:43], v[104:107], a[216:223], v0
  s_waitcnt lgkmcnt(2)
  v_smfmac_f32_16x16x64_bf16 v[40:43], v[108:111], v[60:67], v0
  s_waitcnt lgkmcnt(0)
  s_nop 0
  v_cvt_pk_bf16_f32 v20, v36, v37
  v_cvt_pk_bf16_f32 v21, v38, v39
  v_bfi_b32 v20, 1, s57, v20
  v_smfmac_f32_16x16x64_bf16 v[40:43], v[68:71], v[28:35], v0
  buffer_store_dwordx2 v[20:21], v7, s[4:7], s21 offen offset:0 sc1
  s_nop 6
  v_cvt_pk_bf16_f32 v22, v40, v41
  v_cvt_pk_bf16_f32 v23, v42, v43
  v_bfi_b32 v22, 1, s57, v22
  buffer_store_dwordx2 v[22:23], v7, s[4:7], s21 offen offset:64 sc1
  ds_read_b128 v[68:71], v4 offset:0
  ds_read_b128 v[72:75], v4 offset:1024
  ds_read_b128 v[76:79], v4 offset:4096
  ds_read_b128 v[80:83], v4 offset:5120
  ds_read_b128 v[84:87], v4 offset:8192
  ds_read_b128 v[88:91], v4 offset:9216
  ds_read_b128 v[92:95], v4 offset:2048
  ds_read_b128 v[96:99], v4 offset:3072
  ds_read_b128 v[100:103], v4 offset:6144
  ds_read_b128 v[104:107], v4 offset:7168
  ds_read_b128 v[108:111], v4 offset:10240
  ds_read_b128 v[112:115], v4 offset:11264
  v_mov_b64 v[16:17], 0
  v_mov_b64 v[18:19], 0
  v_mov_b64 v[20:21], 0
  v_mov_b64 v[22:23], 0
  v_mov_b64 v[24:25], 0
  v_mov_b64 v[26:27], 0
  ds_read_b64 v[44:45], v2 offset:32256
  s_waitcnt lgkmcnt(0)
  v_readfirstlane_b32 s38, v44
  v_readfirstlane_b32 s37, v45
  s_nop 0
  s_add_u32 s37, s37, 30
  s_cmp_ge_u32 s38, 30
  s_cselect_b32 s38, s37, s38
  s_cmp_ge_u32 s38, 64
  s_cselect_b32 s38, 100, s38
  s_sub_u32 s38, s38, 1
  s_max_i32 s30, s30, s38
  s_waitcnt vmcnt(4)
  s_barrier
  ds_read_b128 v[28:31], v2 offset:19456
  ds_read_b128 v[32:35], v2 offset:23552
  ds_read_b128 v[36:39], v2 offset:8192
  ds_read_b128 v[40:43], v2 offset:9216
  ds_read_b128 v[44:47], v2 offset:10240
  ds_read_b128 v[48:51], v2 offset:11264
  buffer_load_dwordx4 v[124:127], v3, s[4:7], s24 offen offset:3072 sc1
  buffer_load_dwordx4 v[116:119], v3, s[4:7], s25 offen offset:3072 sc1
  ds_read_b128 v[52:55], v2 offset:12288
  ds_read_b128 v[56:59], v2 offset:13312
  ds_read_b128 v[60:63], v2 offset:14336
  ds_read_b128 v[64:67], v2 offset:15360
  buffer_load_dwordx4 v[124:127], v3, s[4:7], s24 offen offset:3072 sc1
  buffer_load_dwordx4 v[116:119], v3, s[4:7], s25 offen offset:3072 sc1
  s_mov_b32 s19, 0
  s_branch T_loop_187
T_kvw_191:
  s_mov_b32 s19, 0
  s_branch T_kvok_200
T_kv_199:
  s_sleep 4
  s_add_u32 s19, s19, 1
  s_cmp_gt_u32 s19, 32768
  s_cbranch_scc1 M_exit
T_kvok_200:
  s_add_u32 s39, s99, 128
  s_mov_b32 s38, 0
  s_mov_b32 s37, 0
  s_atomic_or s38, s[58:59], s99 glc
  s_atomic_or s37, s[58:59], s39 glc
  s_waitcnt lgkmcnt(0)
  s_add_u32 s37, s37, 30
  s_cmp_ge_u32 s38, 30
  s_cselect_b32 s38, s37, s38
  s_cmp_ge_u32 s38, 64
  s_cselect_b32 s38, 100, s38
  s_sub_u32 s38, s38, 1
  s_max_i32 s30, s30, s38
  s_cmp_ge_i32 s14, s30
  s_cbranch_scc1 T_kv_199
  s_branch T_kvb_192
T_slow_194:
  s_nop 7
  v_max3_f32 v100, v16, v17, v18
  v_max3_f32 v100, v100, v19, v20
  v_max3_f32 v100, v100, v21, v22
  v_max3_f32 v100, v100, v23, v112
  v_max3_f32 v100, v100, v113, v114
  v_max_f32 v100, v100, v115
  v_mov_b32 v101, v100
  s_nop 1
  v_permlane32_swap_b32 v100, v101
  s_nop 1
  v_max_f32 v100, v100, v101
  v_mov_b32 v101, v100
  s_nop 1
  v_permlane16_swap_b32 v100, v101
  s_nop 1
  v_max_f32 v100, v100, v101
  v_sub_f32 v16, v16, v100
  v_sub_f32 v17, v17, v100
  v_sub_f32 v18, v18, v100
  v_sub_f32 v19, v19, v100
  v_exp_f32 v16, v16
  v_exp_f32 v17, v17
  v_exp_f32 v18, v18
  v_exp_f32 v19, v19
  v_sub_f32 v20, v20, v100
  v_sub_f32 v21, v21, v100
  v_sub_f32 v22, v22, v100
  v_sub_f32 v23, v23, v100
  v_exp_f32 v20, v20
  v_exp_f32 v21, v21
  v_exp_f32 v22, v22
  v_exp_f32 v23, v23
  v_sub_f32 v112, v112, v100
  v_sub_f32 v113, v113, v100
  v_sub_f32 v114, v114, v100
  v_sub_f32 v115, v115, v100
  v_exp_f32 v112, v112
  v_exp_f32 v113, v113
  v_exp_f32 v114, v114
  v_exp_f32 v115, v115
  s_nop 0
  v_cvt_pk_bf16_f32 v44, v16, v17
  v_cvt_pk_bf16_f32 v45, v18, v19
  v_cvt_pk_bf16_f32 v46, v20, v21
  v_cvt_pk_bf16_f32 v47, v22, v23
  v_cvt_pk_bf16_f32 v84, v112, v113
  v_cvt_pk_bf16_f32 v85, v114, v115
  v_cndmask_b32 v48, v84, 0, s[16:17]
  v_cndmask_b32 v49, v85, 0, s[16:17]
  v_cndmask_b32 v50, 0, v84, s[16:17]
  v_cndmask_b32 v51, 0, v85, s[16:17]
  s_nop 1
  v_mfma_f32_16x16x16_bf16 v[88:91], v[12:13], v[48:49], 0
  v_mfma_f32_16x16x16_bf16 v[24:27], v[120:121], v[48:49], 0
  v_mfma_f32_16x16x16_bf16 v[116:119], v[120:121], v[50:51], 0
  v_mfma_f32_16x16x32_bf16 v[88:91], v[12:15], v[44:47], v[88:91]
  v_mfma_f32_16x16x32_bf16 v[24:27], v[28:31], v[44:47], v[24:27]
  v_mfma_f32_16x16x32_bf16 v[116:119], v[32:35], v[44:47], v[116:119]
  s_nop 7
  s_nop 1
  v_rcp_f32 v89, v88
  s_nop 0
  v_mul_f32 v24, v89, v24
  v_mul_f32 v25, v89, v25
  s_branch T_back_195
M_tdone:
  v_mov_b32 v16, 64
  v_or_b32 v17, s13, v2
  v_min_u32 v17, 1, v17
  v_lshlrev_b32 v17, 30, v17
  s_waitcnt vmcnt(0)
  s_barrier
  buffer_store_dword v16, v17, s[4:7], s15 offen sc1
M_done:
M_exit:
  s_endpgm
.p2align 6
.type M_table,@object
M_table:
.long 0x1, 0x3f, 0xffffffff, 0x17, 0x1, 0x7, 0x800, 0x0, 0x8, 0x0, 0x0, 0x0, 0x0, 0x0, 0x0, 0x0
.long 0x1, 0x28, 0xffffffff, 0x1b, 0x1, 0x6, 0x1000, 0x0, 0x8, 0x1, 0x0, 0x0, 0x0, 0x0, 0x0, 0x0
.long 0x2, 0x0, 0x1, 0x1e, 0x1, 0x5, 0x1800, 0x0, 0x8, 0x0, 0x0, 0x0, 0x0, 0x0, 0x0, 0x0
.long 0x2, 0x1e, 0x1, 0x22, 0x1, 0x4, 0x2000, 0x0, 0x8, 0x1, 0x0, 0x0, 0x0, 0x0, 0x0, 0x0
.long 0x0, 0x0, 0x1, 0x20, 0x2, 0x3, 0x20, 0x0, 0x8, 0x2, 0x0, 0x0, 0x0, 0x0, 0x0, 0x0
.long 0x0, 0x3f, 0xffffffff, 0x20, 0x2, 0x2, 0x18, 0x1, 0x10, 0x0, 0x0, 0x0, 0x0, 0x0, 0x0, 0x0
.long 0x1, 0xd, 0xffffffff, 0xe, 0x0, 0x0, 0x8, 0x0, 0x8, 0x2, 0x0, 0x0, 0x0, 0x0, 0x0, 0x0
.size M_table, 448
.section .rodata,"a"
.p2align 6
.amdhsa_kernel gated_mix__compressed_kv_cla__memory_aug_recurrent_mem_tr__prompt_kernel
.amdhsa_next_free_vgpr 512
.amdhsa_next_free_sgpr 102
.amdhsa_accum_offset 256
.amdhsa_group_segment_fixed_size 0
.amdhsa_kernarg_size 136
.amdhsa_user_sgpr_count 2
.amdhsa_user_sgpr_kernarg_segment_ptr 1
.amdhsa_system_sgpr_workgroup_id_x 1
.end_amdhsa_kernel
```

```asm
; @launch grid=(256,1,1) block=(256,1,1) lds=163840
.amdgcn_target "amdgcn-amd-amdhsa--gfx950"
.text
.globl gated_mix__compressed_kv_cla__memory_aug_recurrent_mem_tr__prompt_kernel
.p2align 8
.type gated_mix__compressed_kv_cla__memory_aug_recurrent_mem_tr__prompt_kernel,@function
gated_mix__compressed_kv_cla__memory_aug_recurrent_mem_tr__prompt_kernel:
  s_cmp_ge_u32 s2, 256
  s_cbranch_scc1 M_exit
  s_lshr_b32 s77, s2, 3
  s_and_b32 s76, s2, 7
  s_cbranch_scc0 M_team
  s_load_dwordx4 s[72:75], s[0:1], 120
  v_lshrrev_b32 v3, 6, v0
  v_and_b32 v1, 63, v0
  v_readfirstlane_b32 s16, v3
  v_lshlrev_b32 v2, 4, v1
  s_waitcnt lgkmcnt(0)
  s_mov_b64 s[4:5], s[74:75]
  s_mov_b64 s[74:75], s[72:73]
  s_mov_b64 s[72:73], s[4:5]
  s_and_b32 s5, s5, 0xffff
  s_mov_b32 s6, 268435456
  s_mov_b32 s7, 0x20000
  s_sub_u32 s66, s76, 1
  s_lshl_b32 s66, s66, 5
  s_add_u32 s66, s66, s77
  s_mul_i32 s64, s66, 9363
  s_lshr_b32 s64, s64, 16
  s_mul_i32 s67, s64, 7
  s_sub_u32 s65, s66, s67
  s_lshl_b32 s31, s66, 7
  s_add_u32 s31, s31, 148897792
  s_lshl_b32 s67, s67, 7
  s_add_u32 s67, s67, 148897792
  s_getpc_b64 s[76:77]
M_pc:
  s_add_u32 s76, s76, M_table-M_pc
  s_addc_u32 s77, s77, 0
  s_lshl_b32 s26, s65, 6
  s_load_dwordx16 s[48:63], s[76:77], s26
  s_waitcnt lgkmcnt(0)
  s_mov_b32 s23, s51
  s_cmp_lg_u32 s48, 1
  s_cbranch_scc1 M_nobpf
  s_load_dwordx8 s[36:43], s[0:1], 64
  s_mul_i32 s76, s64, 3
  s_add_u32 s76, s76, s57
  v_lshlrev_b32 v4, 7, v0
  s_mov_b32 s10, 4194304
  s_mov_b32 s11, 0x20000
  s_waitcnt lgkmcnt(0)
  s_mov_b32 s8, s42
  s_and_b32 s9, s43, 0xffff
  s_mul_i32 s77, s76, 43776
  s_add_u32 s77, s77, 0
  v_min_u32 v5, 32640, v4
  v_add_u32 v5, s77, v5
  s_add_u32 s77, s77, 32768
  buffer_load_dword v6, v5, s[8:11], 0 offen
  v_min_u32 v5, 10880, v4
  v_add_u32 v5, s77, v5
  s_add_u32 s77, s77, 32768
  buffer_load_dword v6, v5, s[8:11], 0 offen
  s_mov_b32 s8, s38
  s_and_b32 s9, s39, 0xffff
  s_mul_i32 s77, s76, 21888
  s_add_u32 s77, s77, 2097152
  v_min_u32 v5, 21760, v4
  v_add_u32 v5, s77, v5
  s_add_u32 s77, s77, 32768
  buffer_load_dword v6, v5, s[8:11], 0 offen
  s_mov_b32 s8, s40
  s_and_b32 s9, s41, 0xffff
  s_mul_i32 s77, s76, 21888
  s_add_u32 s77, s77, 2097152
  v_min_u32 v5, 21760, v4
  v_add_u32 v5, s77, v5
  s_add_u32 s77, s77, 32768
  buffer_load_dword v6, v5, s[8:11], 0 offen
  s_mov_b32 s8, s36
  s_and_b32 s9, s37, 0xffff
  s_mul_i32 s77, s76, 21888
  s_add_u32 s77, s77, 2097152
  v_min_u32 v5, 21760, v4
  v_add_u32 v5, s77, v5
  s_add_u32 s77, s77, 32768
  buffer_load_dword v6, v5, s[8:11], 0 offen
  s_waitcnt vmcnt(0)
M_nobpf:
  s_lshr_b32 s29, s16, 1
  s_cmp_eq_u32 s29, 0
  s_cselect_b32 s26, 2, 8
  s_cselect_b32 s27, 3, 4
  s_cselect_b32 s28, 9, 10
  s_cmp_eq_u32 s48, 1
  s_cselect_b32 s26, s27, s26
  s_cmp_eq_u32 s48, 2
  s_cselect_b32 s26, s28, s26
  s_lshl_b32 s26, s26, 3
  s_load_dwordx2 s[8:9], s[0:1], s26
  s_cmp_eq_u32 s48, 1
  s_cselect_b32 s26, 8, 0
  s_load_dwordx2 s[12:13], s[0:1], s26
  s_cmp_eq_u32 s29, 0
  s_cselect_b32 s21, 0, 3
  s_cselect_b32 s27, 1, 2
  s_cselect_b32 s28, 4, 5
  s_cmp_eq_u32 s48, 1
  s_cselect_b32 s21, s27, s21
  s_cmp_eq_u32 s48, 2
  s_cselect_b32 s21, s28, s21
  s_lshl_b32 s21, s21, 5
  s_add_u32 s21, s21, s64
  s_lshl_b32 s21, s21, 6
  s_add_u32 s21, s21, s49
  s_and_b32 s27, s16, 1
  s_lshl_b32 s21, s21, 1
  s_add_u32 s21, s21, s27
  s_lshl_b32 s21, s21, 12
  s_lshl_b32 s22, s50, 13
  s_lshl_b32 s19, s49, 15
  s_lshl_b32 s20, s50, 15
  s_lshl_b32 s17, s64, 1
  s_add_u32 s17, s17, s27
  s_lshl_b32 s17, s17, 7
  s_mov_b32 s18, 8192
  s_mov_b32 s24, 0x3e0293ee
  s_waitcnt lgkmcnt(0)
  s_and_b32 s9, s9, 0xffff
  s_mov_b32 s10, 4194304
  s_mov_b32 s11, 0x20000
  s_and_b32 s13, s13, 0xffff
  s_mov_b32 s14, 2097152
  s_mov_b32 s15, 0x20000
  s_cmp_eq_u32 s48, 0
  s_cselect_b32 s32, 0, s16
  s_lshr_b32 s32, s32, 1
  v_lshrrev_b32 v144, 4, v1
  v_and_b32 v56, 0xff, v2
  v_lshl_add_u32 v56, v144, 9, v56
  v_and_b32 v146, 15, v1
  v_and_b32 v144, 8, v1
  v_add_u32 v144, v144, v146
  s_cmp_lg_u32 s32, 0
  s_cselect_b64 vcc, -1, 0
  s_cselect_b32 s26, 8, 16
  v_cndmask_b32 v144, v146, v144, vcc
  v_lshrrev_b32 v145, 4, v1
  v_add_u32 v148, s26, v144
  v_xor_b32 v147, 0, v145
  v_xor_b32 v147, v147, v146
  v_lshlrev_b32 v147, 4, v147
  v_lshl_add_u32 v8, v144, 8, v147
  v_xor_b32 v147, 8, v145
  v_xor_b32 v147, v147, v146
  v_lshlrev_b32 v147, 4, v147
  v_lshl_add_u32 v9, v148, 8, v147
  v_xor_b32 v147, 4, v145
  v_xor_b32 v147, v147, v146
  v_lshlrev_b32 v147, 4, v147
  v_lshl_add_u32 v10, v144, 8, v147
  v_xor_b32 v147, 12, v145
  v_xor_b32 v147, v147, v146
  v_lshlrev_b32 v147, 4, v147
  v_lshl_add_u32 v11, v148, 8, v147
  v_xor_b32 v147, 8, v145
  v_xor_b32 v147, v147, v146
  v_lshlrev_b32 v147, 4, v147
  v_lshl_add_u32 v12, v144, 8, v147
  v_xor_b32 v147, 0, v145
  v_xor_b32 v147, v147, v146
  v_lshlrev_b32 v147, 4, v147
  v_lshl_add_u32 v13, v148, 8, v147
  v_xor_b32 v147, 12, v145
  v_xor_b32 v147, v147, v146
  v_lshlrev_b32 v147, 4, v147
  v_lshl_add_u32 v14, v144, 8, v147
  v_xor_b32 v147, 4, v145
  v_xor_b32 v147, v147, v146
  v_lshlrev_b32 v147, 4, v147
  v_lshl_add_u32 v15, v148, 8, v147
  v_lshrrev_b32 v144, 4, v1
  s_lshl_b32 s26, s16, 8
  v_add_u32 v145, 0, v144
  v_or_b32 v147, 0, v144
  v_xor_b32 v147, v147, v146
  v_lshlrev_b32 v147, 4, v147
  v_lshl_add_u32 v147, v145, 10, v147
  v_add_u32 v16, s26, v147
  v_add_u32 v145, 4, v144
  v_or_b32 v147, 4, v144
  v_xor_b32 v147, v147, v146
  v_lshlrev_b32 v147, 4, v147
  v_lshl_add_u32 v147, v145, 10, v147
  v_add_u32 v17, s26, v147
  v_add_u32 v145, 8, v144
  v_or_b32 v147, 8, v144
  v_xor_b32 v147, v147, v146
  v_lshlrev_b32 v147, 4, v147
  v_lshl_add_u32 v147, v145, 10, v147
  v_add_u32 v18, s26, v147
  v_add_u32 v145, 12, v144
  v_or_b32 v147, 12, v144
  v_xor_b32 v147, v147, v146
  v_lshlrev_b32 v147, 4, v147
  v_lshl_add_u32 v147, v145, 10, v147
  v_add_u32 v19, s26, v147
  v_add_u32 v145, 16, v144
  v_or_b32 v147, 8, v144
  v_xor_b32 v147, v147, v146
  v_lshlrev_b32 v147, 4, v147
  v_lshl_add_u32 v147, v145, 10, v147
  v_add_u32 v20, s26, v147
  v_add_u32 v145, 20, v144
  v_or_b32 v147, 12, v144
  v_xor_b32 v147, v147, v146
  v_lshlrev_b32 v147, 4, v147
  v_lshl_add_u32 v147, v145, 10, v147
  v_add_u32 v21, s26, v147
  v_add_u32 v145, 24, v144
  v_or_b32 v147, 0, v144
  v_xor_b32 v147, v147, v146
  v_lshlrev_b32 v147, 4, v147
  v_lshl_add_u32 v147, v145, 10, v147
  v_add_u32 v22, s26, v147
  v_add_u32 v145, 28, v144
  v_or_b32 v147, 4, v144
  v_xor_b32 v147, v147, v146
  v_lshlrev_b32 v147, 4, v147
  v_lshl_add_u32 v147, v145, 10, v147
  v_add_u32 v23, s26, v147
  v_lshrrev_b32 v144, 3, v1
  v_mul_lo_u32 v144, v144, s18
  v_and_b32 v145, 7, v1
  v_lshl_add_u32 v144, v145, 4, v144
  s_lshl_b32 s28, s16, 15
  s_add_u32 s28, s28, 32768
  s_lshl_b32 s29, s18, 3
  s_add_u32 m0, s28, 0
  s_nop 0
  buffer_load_dwordx4 v144, s[8:11], s17 offen lds
  s_add_u32 s17, s17, s29
  s_add_u32 m0, s28, 1024
  s_nop 0
  buffer_load_dwordx4 v144, s[8:11], s17 offen lds
  s_add_u32 s17, s17, s29
  s_add_u32 m0, s28, 2048
  s_nop 0
  buffer_load_dwordx4 v144, s[8:11], s17 offen lds
  s_add_u32 s17, s17, s29
  s_add_u32 m0, s28, 3072
  s_nop 0
  buffer_load_dwordx4 v144, s[8:11], s17 offen lds
  s_add_u32 s17, s17, s29
  s_add_u32 m0, s28, 4096
  s_nop 0
  buffer_load_dwordx4 v144, s[8:11], s17 offen lds
  s_add_u32 s17, s17, s29
  s_add_u32 m0, s28, 5120
  s_nop 0
  buffer_load_dwordx4 v144, s[8:11], s17 offen lds
  s_add_u32 s17, s17, s29
  s_add_u32 m0, s28, 6144
  s_nop 0
  buffer_load_dwordx4 v144, s[8:11], s17 offen lds
  s_add_u32 s17, s17, s29
  s_add_u32 m0, s28, 7168
  s_nop 0
  buffer_load_dwordx4 v144, s[8:11], s17 offen lds
  s_add_u32 s17, s17, s29
  s_add_u32 m0, s28, 8192
  s_nop 0
  buffer_load_dwordx4 v144, s[8:11], s17 offen lds
  s_add_u32 s17, s17, s29
  s_add_u32 m0, s28, 9216
  s_nop 0
  buffer_load_dwordx4 v144, s[8:11], s17 offen lds
  s_add_u32 s17, s17, s29
  s_add_u32 m0, s28, 10240
  s_nop 0
  buffer_load_dwordx4 v144, s[8:11], s17 offen lds
  s_add_u32 s17, s17, s29
  s_add_u32 m0, s28, 11264
  s_nop 0
  buffer_load_dwordx4 v144, s[8:11], s17 offen lds
  s_add_u32 s17, s17, s29
  s_add_u32 m0, s28, 12288
  s_nop 0
  buffer_load_dwordx4 v144, s[8:11], s17 offen lds
  s_add_u32 s17, s17, s29
  s_add_u32 m0, s28, 13312
  s_nop 0
  buffer_load_dwordx4 v144, s[8:11], s17 offen lds
  s_add_u32 s17, s17, s29
  s_add_u32 m0, s28, 14336
  s_nop 0
  buffer_load_dwordx4 v144, s[8:11], s17 offen lds
  s_add_u32 s17, s17, s29
  s_add_u32 m0, s28, 15360
  s_nop 0
  buffer_load_dwordx4 v144, s[8:11], s17 offen lds
  s_add_u32 s17, s17, s29
  s_add_u32 m0, s28, 16384
  s_nop 0
  buffer_load_dwordx4 v144, s[8:11], s17 offen lds
  s_add_u32 s17, s17, s29
  s_add_u32 m0, s28, 17408
  s_nop 0
  buffer_load_dwordx4 v144, s[8:11], s17 offen lds
  s_add_u32 s17, s17, s29
  s_add_u32 m0, s28, 18432
  s_nop 0
  buffer_load_dwordx4 v144, s[8:11], s17 offen lds
  s_add_u32 s17, s17, s29
  s_add_u32 m0, s28, 19456
  s_nop 0
  buffer_load_dwordx4 v144, s[8:11], s17 offen lds
  s_add_u32 s17, s17, s29
  s_add_u32 m0, s28, 20480
  s_nop 0
  buffer_load_dwordx4 v144, s[8:11], s17 offen lds
  s_add_u32 s17, s17, s29
  s_add_u32 m0, s28, 21504
  s_nop 0
  buffer_load_dwordx4 v144, s[8:11], s17 offen lds
  s_add_u32 s17, s17, s29
  s_add_u32 m0, s28, 22528
  s_nop 0
  buffer_load_dwordx4 v144, s[8:11], s17 offen lds
  s_add_u32 s17, s17, s29
  s_add_u32 m0, s28, 23552
  s_nop 0
  buffer_load_dwordx4 v144, s[8:11], s17 offen lds
  s_add_u32 s17, s17, s29
  s_add_u32 m0, s28, 24576
  s_nop 0
  buffer_load_dwordx4 v144, s[8:11], s17 offen lds
  s_add_u32 s17, s17, s29
  s_add_u32 m0, s28, 25600
  s_nop 0
  buffer_load_dwordx4 v144, s[8:11], s17 offen lds
  s_add_u32 s17, s17, s29
  s_add_u32 m0, s28, 26624
  s_nop 0
  buffer_load_dwordx4 v144, s[8:11], s17 offen lds
  s_add_u32 s17, s17, s29
  s_add_u32 m0, s28, 27648
  s_nop 0
  buffer_load_dwordx4 v144, s[8:11], s17 offen lds
  s_add_u32 s17, s17, s29
  s_add_u32 m0, s28, 28672
  s_nop 0
  buffer_load_dwordx4 v144, s[8:11], s17 offen lds
  s_add_u32 s17, s17, s29
  s_add_u32 m0, s28, 29696
  s_nop 0
  buffer_load_dwordx4 v144, s[8:11], s17 offen lds
  s_add_u32 s17, s17, s29
  s_add_u32 m0, s28, 30720
  s_nop 0
  buffer_load_dwordx4 v144, s[8:11], s17 offen lds
  s_add_u32 s17, s17, s29
  s_add_u32 m0, s28, 31744
  s_nop 0
  buffer_load_dwordx4 v144, s[8:11], s17 offen lds
  s_add_u32 s17, s17, s29
  s_lshl_b32 s25, s16, 13
  s_add_u32 m0, s25, 0
  s_nop 0
  buffer_load_dwordx4 v16, s[12:15], s19 offen lds
  s_add_u32 m0, s25, 1024
  s_nop 0
  buffer_load_dwordx4 v17, s[12:15], s19 offen lds
  s_add_u32 m0, s25, 2048
  s_nop 0
  buffer_load_dwordx4 v18, s[12:15], s19 offen lds
  s_add_u32 m0, s25, 3072
  s_nop 0
  buffer_load_dwordx4 v19, s[12:15], s19 offen lds
  s_add_u32 m0, s25, 4096
  s_nop 0
  buffer_load_dwordx4 v20, s[12:15], s19 offen lds
  s_add_u32 m0, s25, 5120
  s_nop 0
  buffer_load_dwordx4 v21, s[12:15], s19 offen lds
  s_add_u32 m0, s25, 6144
  s_nop 0
  buffer_load_dwordx4 v22, s[12:15], s19 offen lds
  s_add_u32 m0, s25, 7168
  s_nop 0
  buffer_load_dwordx4 v23, s[12:15], s19 offen lds
  s_cmp_gt_u32 s23, 1
  s_cselect_b32 s26, s20, 0
  s_add_u32 s19, s19, s26
  s_add_u32 s25, s25, 32768
  s_and_b32 s25, s25, 0x1ffff
  s_cmp_lg_u32 s16, 3
  s_cbranch_scc1 M_noinit
  s_mov_b32 s79, 0
  s_atomic_swap s79, s[72:73], s31 glc
  s_waitcnt lgkmcnt(0)
  s_mov_b32 s79, 1
  s_atomic_add s79, s[74:75], 128
M_noinit:
  s_cmp_lg_u32 s65, 3
  s_cbranch_scc1 M_noarm
  v_lshlrev_b32 v4, 4, v0
  v_mov_b64 v[60:61], -1
  v_mov_b64 v[62:63], -1
  s_mul_i32 s76, s64, 4096
  s_add_u32 s77, s76, 142868480
  buffer_store_dwordx4 v[60:63], v4, s[4:7], s77 offen sc1
  s_add_u32 s77, s76, 142999552
  buffer_store_dwordx4 v[60:63], v4, s[4:7], s77 offen sc1
  s_add_u32 s77, s76, 143130624
  buffer_store_dwordx4 v[60:63], v4, s[4:7], s77 offen sc1
  s_add_u32 s77, s76, 143261696
  buffer_store_dwordx4 v[60:63], v4, s[4:7], s77 offen sc1
  s_add_u32 s77, s76, 143392768
  buffer_store_dwordx4 v[60:63], v4, s[4:7], s77 offen sc1
  s_add_u32 s77, s76, 143523840
  buffer_store_dwordx4 v[60:63], v4, s[4:7], s77 offen sc1
M_noarm:
  s_mul_i32 s76, s64, 3
  s_add_u32 s76, s76, s57
  s_mul_i32 s76, s76, 24576
  v_lshlrev_b32 v4, 7, v0
  v_add_u32 v4, s76, v4
  buffer_load_dword v5, v4, s[12:15], 0 offen
  v_bfe_u32 v148, v1, 2, 2
  v_lshrrev_b32 v149, 5, v1
  v_lshl_add_u32 v148, v149, 4, v148
  v_bfe_u32 v149, v1, 4, 1
  v_lshl_add_u32 v148, v149, 3, v148
  v_and_b32 v149, 3, v1
  v_and_b32 v150, 2, v149
  v_add_u32 v150, v150, v149
  s_cmp_lg_u32 s32, 0
  s_cselect_b64 vcc, -1, 0
  s_cselect_b32 s26, 32, 16
  v_cndmask_b32 v149, v150, v149, vcc
  v_lshlrev_b32 v149, 3, v149
  v_lshl_add_u32 v148, v148, 7, v149
  v_add_u32 v152, s28, v148
  v_add_u32 v153, 512, v152
  v_add_u32 v154, s26, v152
  v_add_u32 v155, s26, v153
  s_waitcnt vmcnt(37)
  ds_read_b64_tr_b16 a[0:1], v152 offset:0
  ds_read_b64_tr_b16 a[2:3], v153 offset:0
  ds_read_b64_tr_b16 a[4:5], v154 offset:0
  ds_read_b64_tr_b16 a[6:7], v155 offset:0
  ds_read_b64_tr_b16 a[8:9], v152 offset:64
  ds_read_b64_tr_b16 a[10:11], v153 offset:64
  ds_read_b64_tr_b16 a[12:13], v154 offset:64
  ds_read_b64_tr_b16 a[14:15], v155 offset:64
  s_waitcnt lgkmcnt(0)
  s_add_u32 m0, s28, 0
  s_nop 0
  buffer_load_dwordx4 v144, s[8:11], s17 offen lds
  s_add_u32 s17, s17, s29
  s_add_u32 m0, s28, 1024
  s_nop 0
  buffer_load_dwordx4 v144, s[8:11], s17 offen lds
  s_add_u32 s17, s17, s29
  s_add_u32 m0, s28, 2048
  s_nop 0
  buffer_load_dwordx4 v144, s[8:11], s17 offen lds
  s_add_u32 s17, s17, s29
  s_add_u32 m0, s28, 3072
  s_nop 0
  buffer_load_dwordx4 v144, s[8:11], s17 offen lds
  s_add_u32 s17, s17, s29
  s_waitcnt vmcnt(37)
  ds_read_b64_tr_b16 a[16:17], v152 offset:4096
  ds_read_b64_tr_b16 a[18:19], v153 offset:4096
  ds_read_b64_tr_b16 a[20:21], v154 offset:4096
  ds_read_b64_tr_b16 a[22:23], v155 offset:4096
  ds_read_b64_tr_b16 a[24:25], v152 offset:4160
  ds_read_b64_tr_b16 a[26:27], v153 offset:4160
  ds_read_b64_tr_b16 a[28:29], v154 offset:4160
  ds_read_b64_tr_b16 a[30:31], v155 offset:4160
  s_waitcnt lgkmcnt(0)
  s_add_u32 m0, s28, 4096
  s_nop 0
  buffer_load_dwordx4 v144, s[8:11], s17 offen lds
  s_add_u32 s17, s17, s29
  s_add_u32 m0, s28, 5120
  s_nop 0
  buffer_load_dwordx4 v144, s[8:11], s17 offen lds
  s_add_u32 s17, s17, s29
  s_add_u32 m0, s28, 6144
  s_nop 0
  buffer_load_dwordx4 v144, s[8:11], s17 offen lds
  s_add_u32 s17, s17, s29
  s_add_u32 m0, s28, 7168
  s_nop 0
  buffer_load_dwordx4 v144, s[8:11], s17 offen lds
  s_add_u32 s17, s17, s29
  s_waitcnt vmcnt(37)
  ds_read_b64_tr_b16 a[32:33], v152 offset:8192
  ds_read_b64_tr_b16 a[34:35], v153 offset:8192
  ds_read_b64_tr_b16 a[36:37], v154 offset:8192
  ds_read_b64_tr_b16 a[38:39], v155 offset:8192
  ds_read_b64_tr_b16 a[40:41], v152 offset:8256
  ds_read_b64_tr_b16 a[42:43], v153 offset:8256
  ds_read_b64_tr_b16 a[44:45], v154 offset:8256
  ds_read_b64_tr_b16 a[46:47], v155 offset:8256
  s_waitcnt lgkmcnt(0)
  s_add_u32 m0, s28, 8192
  s_nop 0
  buffer_load_dwordx4 v144, s[8:11], s17 offen lds
  s_add_u32 s17, s17, s29
  s_add_u32 m0, s28, 9216
  s_nop 0
  buffer_load_dwordx4 v144, s[8:11], s17 offen lds
  s_add_u32 s17, s17, s29
  s_add_u32 m0, s28, 10240
  s_nop 0
  buffer_load_dwordx4 v144, s[8:11], s17 offen lds
  s_add_u32 s17, s17, s29
  s_add_u32 m0, s28, 11264
  s_nop 0
  buffer_load_dwordx4 v144, s[8:11], s17 offen lds
  s_add_u32 s17, s17, s29
  s_waitcnt vmcnt(37)
  ds_read_b64_tr_b16 a[48:49], v152 offset:12288
  ds_read_b64_tr_b16 a[50:51], v153 offset:12288
  ds_read_b64_tr_b16 a[52:53], v154 offset:12288
  ds_read_b64_tr_b16 a[54:55], v155 offset:12288
  ds_read_b64_tr_b16 a[56:57], v152 offset:12352
  ds_read_b64_tr_b16 a[58:59], v153 offset:12352
  ds_read_b64_tr_b16 a[60:61], v154 offset:12352
  ds_read_b64_tr_b16 a[62:63], v155 offset:12352
  s_waitcnt lgkmcnt(0)
  s_add_u32 m0, s28, 12288
  s_nop 0
  buffer_load_dwordx4 v144, s[8:11], s17 offen lds
  s_add_u32 s17, s17, s29
  s_add_u32 m0, s28, 13312
  s_nop 0
  buffer_load_dwordx4 v144, s[8:11], s17 offen lds
  s_add_u32 s17, s17, s29
  s_add_u32 m0, s28, 14336
  s_nop 0
  buffer_load_dwordx4 v144, s[8:11], s17 offen lds
  s_add_u32 s17, s17, s29
  s_add_u32 m0, s28, 15360
  s_nop 0
  buffer_load_dwordx4 v144, s[8:11], s17 offen lds
  s_add_u32 s17, s17, s29
  s_waitcnt vmcnt(37)
  ds_read_b64_tr_b16 a[64:65], v152 offset:16384
  ds_read_b64_tr_b16 a[66:67], v153 offset:16384
  ds_read_b64_tr_b16 a[68:69], v154 offset:16384
  ds_read_b64_tr_b16 a[70:71], v155 offset:16384
  ds_read_b64_tr_b16 a[72:73], v152 offset:16448
  ds_read_b64_tr_b16 a[74:75], v153 offset:16448
  ds_read_b64_tr_b16 a[76:77], v154 offset:16448
  ds_read_b64_tr_b16 a[78:79], v155 offset:16448
  s_waitcnt lgkmcnt(0)
  s_add_u32 m0, s28, 16384
  s_nop 0
  buffer_load_dwordx4 v144, s[8:11], s17 offen lds
  s_add_u32 s17, s17, s29
  s_add_u32 m0, s28, 17408
  s_nop 0
  buffer_load_dwordx4 v144, s[8:11], s17 offen lds
  s_add_u32 s17, s17, s29
  s_add_u32 m0, s28, 18432
  s_nop 0
  buffer_load_dwordx4 v144, s[8:11], s17 offen lds
  s_add_u32 s17, s17, s29
  s_add_u32 m0, s28, 19456
  s_nop 0
  buffer_load_dwordx4 v144, s[8:11], s17 offen lds
  s_add_u32 s17, s17, s29
  s_waitcnt vmcnt(37)
  ds_read_b64_tr_b16 a[80:81], v152 offset:20480
  ds_read_b64_tr_b16 a[82:83], v153 offset:20480
  ds_read_b64_tr_b16 a[84:85], v154 offset:20480
  ds_read_b64_tr_b16 a[86:87], v155 offset:20480
  ds_read_b64_tr_b16 a[88:89], v152 offset:20544
  ds_read_b64_tr_b16 a[90:91], v153 offset:20544
  ds_read_b64_tr_b16 a[92:93], v154 offset:20544
  ds_read_b64_tr_b16 a[94:95], v155 offset:20544
  s_waitcnt lgkmcnt(0)
  s_add_u32 m0, s28, 20480
  s_nop 0
  buffer_load_dwordx4 v144, s[8:11], s17 offen lds
  s_add_u32 s17, s17, s29
  s_add_u32 m0, s28, 21504
  s_nop 0
  buffer_load_dwordx4 v144, s[8:11], s17 offen lds
  s_add_u32 s17, s17, s29
  s_add_u32 m0, s28, 22528
  s_nop 0
  buffer_load_dwordx4 v144, s[8:11], s17 offen lds
  s_add_u32 s17, s17, s29
  s_add_u32 m0, s28, 23552
  s_nop 0
  buffer_load_dwordx4 v144, s[8:11], s17 offen lds
  s_add_u32 s17, s17, s29
  s_waitcnt vmcnt(37)
  ds_read_b64_tr_b16 a[96:97], v152 offset:24576
  ds_read_b64_tr_b16 a[98:99], v153 offset:24576
  ds_read_b64_tr_b16 a[100:101], v154 offset:24576
  ds_read_b64_tr_b16 a[102:103], v155 offset:24576
  ds_read_b64_tr_b16 a[104:105], v152 offset:24640
  ds_read_b64_tr_b16 a[106:107], v153 offset:24640
  ds_read_b64_tr_b16 a[108:109], v154 offset:24640
  ds_read_b64_tr_b16 a[110:111], v155 offset:24640
  s_waitcnt lgkmcnt(0)
  s_add_u32 m0, s28, 24576
  s_nop 0
  buffer_load_dwordx4 v144, s[8:11], s17 offen lds
  s_add_u32 s17, s17, s29
  s_add_u32 m0, s28, 25600
  s_nop 0
  buffer_load_dwordx4 v144, s[8:11], s17 offen lds
  s_add_u32 s17, s17, s29
  s_add_u32 m0, s28, 26624
  s_nop 0
  buffer_load_dwordx4 v144, s[8:11], s17 offen lds
  s_add_u32 s17, s17, s29
  s_add_u32 m0, s28, 27648
  s_nop 0
  buffer_load_dwordx4 v144, s[8:11], s17 offen lds
  s_add_u32 s17, s17, s29
  s_waitcnt vmcnt(37)
  ds_read_b64_tr_b16 a[112:113], v152 offset:28672
  ds_read_b64_tr_b16 a[114:115], v153 offset:28672
  ds_read_b64_tr_b16 a[116:117], v154 offset:28672
  ds_read_b64_tr_b16 a[118:119], v155 offset:28672
  ds_read_b64_tr_b16 a[120:121], v152 offset:28736
  ds_read_b64_tr_b16 a[122:123], v153 offset:28736
  ds_read_b64_tr_b16 a[124:125], v154 offset:28736
  ds_read_b64_tr_b16 a[126:127], v155 offset:28736
  s_waitcnt lgkmcnt(0)
  s_add_u32 m0, s28, 28672
  s_nop 0
  buffer_load_dwordx4 v144, s[8:11], s17 offen lds
  s_add_u32 s17, s17, s29
  s_add_u32 m0, s28, 29696
  s_nop 0
  buffer_load_dwordx4 v144, s[8:11], s17 offen lds
  s_add_u32 s17, s17, s29
  s_add_u32 m0, s28, 30720
  s_nop 0
  buffer_load_dwordx4 v144, s[8:11], s17 offen lds
  s_add_u32 s17, s17, s29
  s_add_u32 m0, s28, 31744
  s_nop 0
  buffer_load_dwordx4 v144, s[8:11], s17 offen lds
  s_add_u32 s17, s17, s29
  s_waitcnt vmcnt(28)
  ds_read_b64_tr_b16 a[128:129], v152 offset:0
  ds_read_b64_tr_b16 a[130:131], v153 offset:0
  ds_read_b64_tr_b16 a[132:133], v154 offset:0
  ds_read_b64_tr_b16 a[134:135], v155 offset:0
  ds_read_b64_tr_b16 a[136:137], v152 offset:64
  ds_read_b64_tr_b16 a[138:139], v153 offset:64
  ds_read_b64_tr_b16 a[140:141], v154 offset:64
  ds_read_b64_tr_b16 a[142:143], v155 offset:64
  s_waitcnt lgkmcnt(0)
  s_waitcnt vmcnt(24)
  ds_read_b64_tr_b16 a[144:145], v152 offset:4096
  ds_read_b64_tr_b16 a[146:147], v153 offset:4096
  ds_read_b64_tr_b16 a[148:149], v154 offset:4096
  ds_read_b64_tr_b16 a[150:151], v155 offset:4096
  ds_read_b64_tr_b16 a[152:153], v152 offset:4160
  ds_read_b64_tr_b16 a[154:155], v153 offset:4160
  ds_read_b64_tr_b16 a[156:157], v154 offset:4160
  ds_read_b64_tr_b16 a[158:159], v155 offset:4160
  s_waitcnt lgkmcnt(0)
  s_waitcnt vmcnt(20)
  ds_read_b64_tr_b16 a[160:161], v152 offset:8192
  ds_read_b64_tr_b16 a[162:163], v153 offset:8192
  ds_read_b64_tr_b16 a[164:165], v154 offset:8192
  ds_read_b64_tr_b16 a[166:167], v155 offset:8192
  ds_read_b64_tr_b16 a[168:169], v152 offset:8256
  ds_read_b64_tr_b16 a[170:171], v153 offset:8256
  ds_read_b64_tr_b16 a[172:173], v154 offset:8256
  ds_read_b64_tr_b16 a[174:175], v155 offset:8256
  s_waitcnt lgkmcnt(0)
  s_waitcnt vmcnt(16)
  ds_read_b64_tr_b16 a[176:177], v152 offset:12288
  ds_read_b64_tr_b16 a[178:179], v153 offset:12288
  ds_read_b64_tr_b16 a[180:181], v154 offset:12288
  ds_read_b64_tr_b16 a[182:183], v155 offset:12288
  ds_read_b64_tr_b16 a[184:185], v152 offset:12352
  ds_read_b64_tr_b16 a[186:187], v153 offset:12352
  ds_read_b64_tr_b16 a[188:189], v154 offset:12352
  ds_read_b64_tr_b16 a[190:191], v155 offset:12352
  s_waitcnt lgkmcnt(0)
  s_waitcnt vmcnt(12)
  ds_read_b64_tr_b16 a[192:193], v152 offset:16384
  ds_read_b64_tr_b16 a[194:195], v153 offset:16384
  ds_read_b64_tr_b16 a[196:197], v154 offset:16384
  ds_read_b64_tr_b16 a[198:199], v155 offset:16384
  ds_read_b64_tr_b16 a[200:201], v152 offset:16448
  ds_read_b64_tr_b16 a[202:203], v153 offset:16448
  ds_read_b64_tr_b16 a[204:205], v154 offset:16448
  ds_read_b64_tr_b16 a[206:207], v155 offset:16448
  s_waitcnt lgkmcnt(0)
  s_waitcnt vmcnt(8)
  ds_read_b64_tr_b16 a[208:209], v152 offset:20480
  ds_read_b64_tr_b16 a[210:211], v153 offset:20480
  ds_read_b64_tr_b16 a[212:213], v154 offset:20480
  ds_read_b64_tr_b16 a[214:215], v155 offset:20480
  ds_read_b64_tr_b16 a[216:217], v152 offset:20544
  ds_read_b64_tr_b16 a[218:219], v153 offset:20544
  ds_read_b64_tr_b16 a[220:221], v154 offset:20544
  ds_read_b64_tr_b16 a[222:223], v155 offset:20544
  s_waitcnt lgkmcnt(0)
  s_waitcnt vmcnt(4)
  ds_read_b64_tr_b16 a[224:225], v152 offset:24576
  ds_read_b64_tr_b16 a[226:227], v153 offset:24576
  ds_read_b64_tr_b16 a[228:229], v154 offset:24576
  ds_read_b64_tr_b16 a[230:231], v155 offset:24576
  ds_read_b64_tr_b16 a[232:233], v152 offset:24640
  ds_read_b64_tr_b16 a[234:235], v153 offset:24640
  ds_read_b64_tr_b16 a[236:237], v154 offset:24640
  ds_read_b64_tr_b16 a[238:239], v155 offset:24640
  s_waitcnt lgkmcnt(0)
  s_waitcnt vmcnt(0)
  ds_read_b64_tr_b16 a[240:241], v152 offset:28672
  ds_read_b64_tr_b16 a[242:243], v153 offset:28672
  ds_read_b64_tr_b16 a[244:245], v154 offset:28672
  ds_read_b64_tr_b16 a[246:247], v155 offset:28672
  ds_read_b64_tr_b16 a[248:249], v152 offset:28736
  ds_read_b64_tr_b16 a[250:251], v153 offset:28736
  ds_read_b64_tr_b16 a[252:253], v154 offset:28736
  ds_read_b64_tr_b16 a[254:255], v155 offset:28736
  s_waitcnt lgkmcnt(0)
  s_barrier
  s_add_u32 m0, s25, 0
  s_nop 0
  buffer_load_dwordx4 v16, s[12:15], s19 offen lds
  s_add_u32 m0, s25, 1024
  s_nop 0
  buffer_load_dwordx4 v17, s[12:15], s19 offen lds
  s_add_u32 m0, s25, 2048
  s_nop 0
  buffer_load_dwordx4 v18, s[12:15], s19 offen lds
  s_add_u32 m0, s25, 3072
  s_nop 0
  buffer_load_dwordx4 v19, s[12:15], s19 offen lds
  s_add_u32 m0, s25, 4096
  s_nop 0
  buffer_load_dwordx4 v20, s[12:15], s19 offen lds
  s_add_u32 m0, s25, 5120
  s_nop 0
  buffer_load_dwordx4 v21, s[12:15], s19 offen lds
  s_add_u32 m0, s25, 6144
  s_nop 0
  buffer_load_dwordx4 v22, s[12:15], s19 offen lds
  s_add_u32 m0, s25, 7168
  s_nop 0
  buffer_load_dwordx4 v23, s[12:15], s19 offen lds
  s_cmp_gt_u32 s23, 2
  s_cselect_b32 s26, s20, 0
  s_add_u32 s19, s19, s26
  s_add_u32 s25, s25, 32768
  s_and_b32 s25, s25, 0x1ffff
  s_waitcnt vmcnt(0)
  s_barrier
  s_cmp_lg_u32 s32, 0
  s_cbranch_scc1 P_v_1
  s_cmp_eq_u32 s48, 0
  s_cbranch_scc1 P_q_3
  s_mov_b32 s27, s21
  v_mov_b32 v7, 0x40000000
  s_mov_b32 s29, -2
  v_min_u32 v145, 1, v0
  v_lshlrev_b32 v145, 30, v145
  ds_read_b128 v[24:27], v8 offset:0
  ds_read_b128 v[28:31], v9 offset:0
  ds_read_b128 v[32:35], v10 offset:0
  ds_read_b128 v[36:39], v11 offset:0
  ds_read_b128 v[40:43], v12 offset:0
  ds_read_b128 v[44:47], v13 offset:0
.p2align 6
G_top_4:
  s_waitcnt lgkmcnt(5)
  v_mfma_f32_16x16x32_bf16 v[64:67], a[0:3], v[24:27], 0
  s_add_u32 m0, s25, 0
  ds_read_b128 v[48:51], v14 offset:0
  v_mfma_f32_16x16x32_bf16 v[68:71], a[4:7], v[24:27], 0
  v_mfma_f32_16x16x32_bf16 v[80:83], a[8:11], v[24:27], 0
  buffer_load_dwordx4 v16, s[12:15], s19 offen lds
  v_mfma_f32_16x16x32_bf16 v[84:87], a[12:15], v[24:27], 0
  s_waitcnt lgkmcnt(5)
  v_mfma_f32_16x16x32_bf16 v[72:75], a[0:3], v[28:31], 0
  ds_read_b128 v[52:55], v15 offset:0
  v_mfma_f32_16x16x32_bf16 v[76:79], a[4:7], v[28:31], 0
  v_cvt_pk_bf16_f32 v128, v96, v97
  v_cvt_pk_bf16_f32 v129, v98, v99
  v_mfma_f32_16x16x32_bf16 v[88:91], a[8:11], v[28:31], 0
  v_mfma_f32_16x16x32_bf16 v[92:95], a[12:15], v[28:31], 0
  s_waitcnt lgkmcnt(5)
  v_cvt_pk_bf16_f32 v130, v100, v101
  v_cvt_pk_bf16_f32 v131, v102, v103
  v_mfma_f32_16x16x32_bf16 v[64:67], a[16:19], v[32:35], v[64:67]
  s_add_u32 m0, s25, 1024
  ds_read_b128 v[24:27], v8 offset:8192
  v_mfma_f32_16x16x32_bf16 v[68:71], a[20:23], v[32:35], v[68:71]
  v_mfma_f32_16x16x32_bf16 v[80:83], a[24:27], v[32:35], v[80:83]
  buffer_load_dwordx4 v17, s[12:15], s19 offen lds
  v_mfma_f32_16x16x32_bf16 v[84:87], a[28:31], v[32:35], v[84:87]
  s_waitcnt lgkmcnt(5)
  v_mfma_f32_16x16x32_bf16 v[72:75], a[16:19], v[36:39], v[72:75]
  ds_read_b128 v[28:31], v9 offset:8192
  v_mfma_f32_16x16x32_bf16 v[76:79], a[20:23], v[36:39], v[76:79]
  v_mfma_f32_16x16x32_bf16 v[88:91], a[24:27], v[36:39], v[88:91]
  v_mfma_f32_16x16x32_bf16 v[92:95], a[28:31], v[36:39], v[92:95]
  s_waitcnt lgkmcnt(5)
  v_mfma_f32_16x16x32_bf16 v[64:67], a[32:35], v[40:43], v[64:67]
  s_add_u32 m0, s25, 2048
  ds_read_b128 v[32:35], v10 offset:8192
  v_mfma_f32_16x16x32_bf16 v[68:71], a[36:39], v[40:43], v[68:71]
  v_cvt_pk_bf16_f32 v132, v104, v105
  v_cvt_pk_bf16_f32 v133, v106, v107
  v_mfma_f32_16x16x32_bf16 v[80:83], a[40:43], v[40:43], v[80:83]
  buffer_load_dwordx4 v18, s[12:15], s19 offen lds
  v_mfma_f32_16x16x32_bf16 v[84:87], a[44:47], v[40:43], v[84:87]
  s_waitcnt lgkmcnt(5)
  v_cvt_pk_bf16_f32 v134, v108, v109
  v_cvt_pk_bf16_f32 v135, v110, v111
  v_mfma_f32_16x16x32_bf16 v[72:75], a[32:35], v[44:47], v[72:75]
  ds_read_b128 v[36:39], v11 offset:8192
  v_mfma_f32_16x16x32_bf16 v[76:79], a[36:39], v[44:47], v[76:79]
  v_mfma_f32_16x16x32_bf16 v[88:91], a[40:43], v[44:47], v[88:91]
  v_mfma_f32_16x16x32_bf16 v[92:95], a[44:47], v[44:47], v[92:95]
  s_waitcnt lgkmcnt(5)
  v_mfma_f32_16x16x32_bf16 v[64:67], a[48:51], v[48:51], v[64:67]
  s_add_u32 m0, s25, 3072
  ds_read_b128 v[40:43], v12 offset:8192
  v_mfma_f32_16x16x32_bf16 v[68:71], a[52:55], v[48:51], v[68:71]
  v_mfma_f32_16x16x32_bf16 v[80:83], a[56:59], v[48:51], v[80:83]
  buffer_load_dwordx4 v19, s[12:15], s19 offen lds
  v_mfma_f32_16x16x32_bf16 v[84:87], a[60:63], v[48:51], v[84:87]
  s_waitcnt lgkmcnt(5)
  v_mfma_f32_16x16x32_bf16 v[72:75], a[48:51], v[52:55], v[72:75]
  ds_read_b128 v[44:47], v13 offset:8192
  v_mfma_f32_16x16x32_bf16 v[76:79], a[52:55], v[52:55], v[76:79]
  v_cvt_pk_bf16_f32 v136, v112, v113
  v_cvt_pk_bf16_f32 v137, v114, v115
  v_mfma_f32_16x16x32_bf16 v[88:91], a[56:59], v[52:55], v[88:91]
  v_mfma_f32_16x16x32_bf16 v[92:95], a[60:63], v[52:55], v[92:95]
  s_waitcnt lgkmcnt(5)
  v_cvt_pk_bf16_f32 v138, v116, v117
  v_cvt_pk_bf16_f32 v139, v118, v119
  v_mfma_f32_16x16x32_bf16 v[64:67], a[64:67], v[24:27], v[64:67]
  s_add_u32 m0, s25, 4096
  ds_read_b128 v[48:51], v14 offset:8192
  v_mfma_f32_16x16x32_bf16 v[68:71], a[68:71], v[24:27], v[68:71]
  v_mfma_f32_16x16x32_bf16 v[80:83], a[72:75], v[24:27], v[80:83]
  buffer_load_dwordx4 v20, s[12:15], s19 offen lds
  v_mfma_f32_16x16x32_bf16 v[84:87], a[76:79], v[24:27], v[84:87]
  s_waitcnt lgkmcnt(5)
  v_mfma_f32_16x16x32_bf16 v[72:75], a[64:67], v[28:31], v[72:75]
  ds_read_b128 v[52:55], v15 offset:8192
  v_mfma_f32_16x16x32_bf16 v[76:79], a[68:71], v[28:31], v[76:79]
  v_mfma_f32_16x16x32_bf16 v[88:91], a[72:75], v[28:31], v[88:91]
  v_mfma_f32_16x16x32_bf16 v[92:95], a[76:79], v[28:31], v[92:95]
  s_waitcnt lgkmcnt(5)
  v_mfma_f32_16x16x32_bf16 v[64:67], a[80:83], v[32:35], v[64:67]
  s_add_u32 m0, s25, 5120
  ds_read_b128 v[24:27], v8 offset:16384
  v_mfma_f32_16x16x32_bf16 v[68:71], a[84:87], v[32:35], v[68:71]
  v_cvt_pk_bf16_f32 v140, v120, v121
  v_cvt_pk_bf16_f32 v141, v122, v123
  v_mfma_f32_16x16x32_bf16 v[80:83], a[88:91], v[32:35], v[80:83]
  buffer_load_dwordx4 v21, s[12:15], s19 offen lds
  v_mfma_f32_16x16x32_bf16 v[84:87], a[92:95], v[32:35], v[84:87]
  s_waitcnt lgkmcnt(5)
  v_cvt_pk_bf16_f32 v142, v124, v125
  v_cvt_pk_bf16_f32 v143, v126, v127
  v_mfma_f32_16x16x32_bf16 v[72:75], a[80:83], v[36:39], v[72:75]
  ds_read_b128 v[28:31], v9 offset:16384
  v_mfma_f32_16x16x32_bf16 v[76:79], a[84:87], v[36:39], v[76:79]
  v_mfma_f32_16x16x32_bf16 v[88:91], a[88:91], v[36:39], v[88:91]
  v_mfma_f32_16x16x32_bf16 v[92:95], a[92:95], v[36:39], v[92:95]
  s_waitcnt lgkmcnt(5)
  v_mfma_f32_16x16x32_bf16 v[64:67], a[96:99], v[40:43], v[64:67]
  s_add_u32 m0, s25, 6144
  ds_read_b128 v[32:35], v10 offset:16384
  v_mfma_f32_16x16x32_bf16 v[68:71], a[100:103], v[40:43], v[68:71]
  v_mfma_f32_16x16x32_bf16 v[80:83], a[104:107], v[40:43], v[80:83]
  buffer_load_dwordx4 v22, s[12:15], s19 offen lds
  v_mfma_f32_16x16x32_bf16 v[84:87], a[108:111], v[40:43], v[84:87]
  s_waitcnt lgkmcnt(5)
  v_mfma_f32_16x16x32_bf16 v[72:75], a[96:99], v[44:47], v[72:75]
  ds_read_b128 v[36:39], v11 offset:16384
  v_mfma_f32_16x16x32_bf16 v[76:79], a[100:103], v[44:47], v[76:79]
  v_mfma_f32_16x16x32_bf16 v[88:91], a[104:107], v[44:47], v[88:91]
  v_mfma_f32_16x16x32_bf16 v[92:95], a[108:111], v[44:47], v[92:95]
  s_waitcnt lgkmcnt(5)
  v_mfma_f32_16x16x32_bf16 v[64:67], a[112:115], v[48:51], v[64:67]
  s_add_u32 m0, s25, 7168
  ds_read_b128 v[40:43], v12 offset:16384
  v_mfma_f32_16x16x32_bf16 v[68:71], a[116:119], v[48:51], v[68:71]
  v_mfma_f32_16x16x32_bf16 v[80:83], a[120:123], v[48:51], v[80:83]
  buffer_load_dwordx4 v23, s[12:15], s19 offen lds
  v_mfma_f32_16x16x32_bf16 v[84:87], a[124:127], v[48:51], v[84:87]
  s_waitcnt lgkmcnt(5)
  v_mfma_f32_16x16x32_bf16 v[72:75], a[112:115], v[52:55], v[72:75]
  s_cmp_gt_u32 s23, 3
  ds_read_b128 v[44:47], v13 offset:16384
  v_mfma_f32_16x16x32_bf16 v[76:79], a[116:119], v[52:55], v[76:79]
  v_mfma_f32_16x16x32_bf16 v[88:91], a[120:123], v[52:55], v[88:91]
  s_cselect_b32 s26, s20, 0
  v_mfma_f32_16x16x32_bf16 v[92:95], a[124:127], v[52:55], v[92:95]
  s_waitcnt lgkmcnt(5)
  v_mfma_f32_16x16x32_bf16 v[64:67], a[128:131], v[24:27], v[64:67]
  s_add_u32 s19, s19, s26
  ds_read_b128 v[48:51], v14 offset:16384
  v_mfma_f32_16x16x32_bf16 v[68:71], a[132:135], v[24:27], v[68:71]
  v_mfma_f32_16x16x32_bf16 v[80:83], a[136:139], v[24:27], v[80:83]
  s_add_u32 s25, s25, 32768
  v_mfma_f32_16x16x32_bf16 v[84:87], a[140:143], v[24:27], v[84:87]
  s_waitcnt lgkmcnt(5)
  v_mfma_f32_16x16x32_bf16 v[72:75], a[128:131], v[28:31], v[72:75]
  s_and_b32 s25, s25, 0x1ffff
  ds_read_b128 v[52:55], v15 offset:16384
  v_mfma_f32_16x16x32_bf16 v[76:79], a[132:135], v[28:31], v[76:79]
  v_mfma_f32_16x16x32_bf16 v[88:91], a[136:139], v[28:31], v[88:91]
  buffer_store_dwordx4 v[128:131], v7, s[4:7], s21 offen offset:0 sc1
  v_mfma_f32_16x16x32_bf16 v[92:95], a[140:143], v[28:31], v[92:95]
  s_waitcnt lgkmcnt(5)
  v_mfma_f32_16x16x32_bf16 v[64:67], a[144:147], v[32:35], v[64:67]
  ds_read_b128 v[24:27], v8 offset:24576
  v_mfma_f32_16x16x32_bf16 v[68:71], a[148:151], v[32:35], v[68:71]
  v_mfma_f32_16x16x32_bf16 v[80:83], a[152:155], v[32:35], v[80:83]
  v_mfma_f32_16x16x32_bf16 v[84:87], a[156:159], v[32:35], v[84:87]
  s_waitcnt lgkmcnt(5)
  v_mfma_f32_16x16x32_bf16 v[72:75], a[144:147], v[36:39], v[72:75]
  ds_read_b128 v[28:31], v9 offset:24576
  v_mfma_f32_16x16x32_bf16 v[76:79], a[148:151], v[36:39], v[76:79]
  v_mfma_f32_16x16x32_bf16 v[88:91], a[152:155], v[36:39], v[88:91]
  buffer_store_dwordx4 v[132:135], v7, s[4:7], s21 offen offset:256 sc1
  v_mfma_f32_16x16x32_bf16 v[92:95], a[156:159], v[36:39], v[92:95]
  s_waitcnt lgkmcnt(5)
  v_mfma_f32_16x16x32_bf16 v[64:67], a[160:163], v[40:43], v[64:67]
  ds_read_b128 v[32:35], v10 offset:24576
  v_mfma_f32_16x16x32_bf16 v[68:71], a[164:167], v[40:43], v[68:71]
  v_mfma_f32_16x16x32_bf16 v[80:83], a[168:171], v[40:43], v[80:83]
  v_mfma_f32_16x16x32_bf16 v[84:87], a[172:175], v[40:43], v[84:87]
  s_waitcnt lgkmcnt(5)
  v_mfma_f32_16x16x32_bf16 v[72:75], a[160:163], v[44:47], v[72:75]
  ds_read_b128 v[36:39], v11 offset:24576
  v_mfma_f32_16x16x32_bf16 v[76:79], a[164:167], v[44:47], v[76:79]
  v_mfma_f32_16x16x32_bf16 v[88:91], a[168:171], v[44:47], v[88:91]
  buffer_store_dwordx4 v[136:139], v7, s[4:7], s21 offen offset:2048 sc1
  v_mfma_f32_16x16x32_bf16 v[92:95], a[172:175], v[44:47], v[92:95]
  s_waitcnt lgkmcnt(5)
  v_mfma_f32_16x16x32_bf16 v[64:67], a[176:179], v[48:51], v[64:67]
  ds_read_b128 v[40:43], v12 offset:24576
  v_mfma_f32_16x16x32_bf16 v[68:71], a[180:183], v[48:51], v[68:71]
  v_mfma_f32_16x16x32_bf16 v[80:83], a[184:187], v[48:51], v[80:83]
  v_mfma_f32_16x16x32_bf16 v[84:87], a[188:191], v[48:51], v[84:87]
  s_waitcnt lgkmcnt(5)
  v_mfma_f32_16x16x32_bf16 v[72:75], a[176:179], v[52:55], v[72:75]
  ds_read_b128 v[44:47], v13 offset:24576
  v_mfma_f32_16x16x32_bf16 v[76:79], a[180:183], v[52:55], v[76:79]
  v_mfma_f32_16x16x32_bf16 v[88:91], a[184:187], v[52:55], v[88:91]
  buffer_store_dwordx4 v[140:143], v7, s[4:7], s21 offen offset:2304 sc1
  v_mfma_f32_16x16x32_bf16 v[92:95], a[188:191], v[52:55], v[92:95]
  s_waitcnt lgkmcnt(5)
  v_mfma_f32_16x16x32_bf16 v[64:67], a[192:195], v[24:27], v[64:67]
  s_mov_b32 s21, s27
  ds_read_b128 v[48:51], v14 offset:24576
  v_mfma_f32_16x16x32_bf16 v[68:71], a[196:199], v[24:27], v[68:71]
  v_mov_b32 v7, v56
  v_mfma_f32_16x16x32_bf16 v[80:83], a[200:203], v[24:27], v[80:83]
  v_mfma_f32_16x16x32_bf16 v[84:87], a[204:207], v[24:27], v[84:87]
  s_waitcnt lgkmcnt(5)
  v_mfma_f32_16x16x32_bf16 v[72:75], a[192:195], v[28:31], v[72:75]
  s_add_u32 s27, s27, s22
  ds_read_b128 v[52:55], v15 offset:24576
  v_mfma_f32_16x16x32_bf16 v[76:79], a[196:199], v[28:31], v[76:79]
  v_mfma_f32_16x16x32_bf16 v[88:91], a[200:203], v[28:31], v[88:91]
  s_waitcnt vmcnt(13)
  s_barrier
  v_mfma_f32_16x16x32_bf16 v[92:95], a[204:207], v[28:31], v[92:95]
  s_waitcnt lgkmcnt(5)
  v_mfma_f32_16x16x32_bf16 v[64:67], a[208:211], v[32:35], v[64:67]
  ds_read_b128 v[24:27], v8 offset:32768
  v_mfma_f32_16x16x32_bf16 v[68:71], a[212:215], v[32:35], v[68:71]
  v_mfma_f32_16x16x32_bf16 v[80:83], a[216:219], v[32:35], v[80:83]
  v_mfma_f32_16x16x32_bf16 v[84:87], a[220:223], v[32:35], v[84:87]
  s_waitcnt lgkmcnt(5)
  v_mfma_f32_16x16x32_bf16 v[72:75], a[208:211], v[36:39], v[72:75]
  s_add_u32 s29, s29, 1
  ds_read_b128 v[28:31], v9 offset:32768
  v_mfma_f32_16x16x32_bf16 v[76:79], a[212:215], v[36:39], v[76:79]
  v_mfma_f32_16x16x32_bf16 v[88:91], a[216:219], v[36:39], v[88:91]
  s_max_i32 s30, s29, 0
  v_mfma_f32_16x16x32_bf16 v[92:95], a[220:223], v[36:39], v[92:95]
  s_waitcnt lgkmcnt(5)
  v_mov_b32 v144, s30
  v_mfma_f32_16x16x32_bf16 v[64:67], a[224:227], v[40:43], v[64:67]
  ds_read_b128 v[32:35], v10 offset:32768
  v_mfma_f32_16x16x32_bf16 v[68:71], a[228:231], v[40:43], v[68:71]
  v_mfma_f32_16x16x32_bf16 v[80:83], a[232:235], v[40:43], v[80:83]
  buffer_store_dword v144, v145, s[4:7], s31 offen sc1
  v_mfma_f32_16x16x32_bf16 v[84:87], a[236:239], v[40:43], v[84:87]
  s_waitcnt lgkmcnt(5)
  v_mfma_f32_16x16x32_bf16 v[72:75], a[224:227], v[44:47], v[72:75]
  ds_read_b128 v[36:39], v11 offset:32768
  v_mfma_f32_16x16x32_bf16 v[76:79], a[228:231], v[44:47], v[76:79]
  v_mfma_f32_16x16x32_bf16 v[88:91], a[232:235], v[44:47], v[88:91]
  v_mfma_f32_16x16x32_bf16 v[92:95], a[236:239], v[44:47], v[92:95]
  s_waitcnt lgkmcnt(5)
  v_mfma_f32_16x16x32_bf16 v[64:67], a[240:243], v[48:51], v[64:67]
  s_sub_u32 s23, s23, 1
  ds_read_b128 v[40:43], v12 offset:32768
  v_mfma_f32_16x16x32_bf16 v[68:71], a[244:247], v[48:51], v[68:71]
  v_mfma_f32_16x16x32_bf16 v[80:83], a[248:251], v[48:51], v[80:83]
  v_mfma_f32_16x16x32_bf16 v[84:87], a[252:255], v[48:51], v[84:87]
  s_waitcnt lgkmcnt(5)
  v_mfma_f32_16x16x32_bf16 v[72:75], a[240:243], v[52:55], v[72:75]
  s_cmp_eq_u32 s23, 0
  ds_read_b128 v[44:47], v13 offset:32768
  v_mfma_f32_16x16x32_bf16 v[76:79], a[244:247], v[52:55], v[76:79]
  v_mfma_f32_16x16x32_bf16 v[88:91], a[248:251], v[52:55], v[88:91]
  v_mfma_f32_16x16x32_bf16 v[92:95], a[252:255], v[52:55], v[92:95]
  s_cbranch_scc1 G_done0_5
  s_waitcnt lgkmcnt(5)
  v_mfma_f32_16x16x32_bf16 v[96:99], a[0:3], v[24:27], 0
  s_add_u32 m0, s25, 0
  ds_read_b128 v[48:51], v14 offset:32768
  v_mfma_f32_16x16x32_bf16 v[100:103], a[4:7], v[24:27], 0
  v_mfma_f32_16x16x32_bf16 v[112:115], a[8:11], v[24:27], 0
  buffer_load_dwordx4 v16, s[12:15], s19 offen lds
  v_mfma_f32_16x16x32_bf16 v[116:119], a[12:15], v[24:27], 0
  s_waitcnt lgkmcnt(5)
  v_mfma_f32_16x16x32_bf16 v[104:107], a[0:3], v[28:31], 0
  ds_read_b128 v[52:55], v15 offset:32768
  v_mfma_f32_16x16x32_bf16 v[108:111], a[4:7], v[28:31], 0
  v_cvt_pk_bf16_f32 v128, v64, v65
  v_cvt_pk_bf16_f32 v129, v66, v67
  v_mfma_f32_16x16x32_bf16 v[120:123], a[8:11], v[28:31], 0
  v_mfma_f32_16x16x32_bf16 v[124:127], a[12:15], v[28:31], 0
  s_waitcnt lgkmcnt(5)
  v_cvt_pk_bf16_f32 v130, v68, v69
  v_cvt_pk_bf16_f32 v131, v70, v71
  v_mfma_f32_16x16x32_bf16 v[96:99], a[16:19], v[32:35], v[96:99]
  s_add_u32 m0, s25, 1024
  ds_read_b128 v[24:27], v8 offset:40960
  v_mfma_f32_16x16x32_bf16 v[100:103], a[20:23], v[32:35], v[100:103]
  v_mfma_f32_16x16x32_bf16 v[112:115], a[24:27], v[32:35], v[112:115]
  buffer_load_dwordx4 v17, s[12:15], s19 offen lds
  v_mfma_f32_16x16x32_bf16 v[116:119], a[28:31], v[32:35], v[116:119]
  s_waitcnt lgkmcnt(5)
  v_mfma_f32_16x16x32_bf16 v[104:107], a[16:19], v[36:39], v[104:107]
  ds_read_b128 v[28:31], v9 offset:40960
  v_mfma_f32_16x16x32_bf16 v[108:111], a[20:23], v[36:39], v[108:111]
  v_mfma_f32_16x16x32_bf16 v[120:123], a[24:27], v[36:39], v[120:123]
  v_mfma_f32_16x16x32_bf16 v[124:127], a[28:31], v[36:39], v[124:127]
  s_waitcnt lgkmcnt(5)
  v_mfma_f32_16x16x32_bf16 v[96:99], a[32:35], v[40:43], v[96:99]
  s_add_u32 m0, s25, 2048
  ds_read_b128 v[32:35], v10 offset:40960
  v_mfma_f32_16x16x32_bf16 v[100:103], a[36:39], v[40:43], v[100:103]
  v_cvt_pk_bf16_f32 v132, v72, v73
  v_cvt_pk_bf16_f32 v133, v74, v75
  v_mfma_f32_16x16x32_bf16 v[112:115], a[40:43], v[40:43], v[112:115]
  buffer_load_dwordx4 v18, s[12:15], s19 offen lds
  v_mfma_f32_16x16x32_bf16 v[116:119], a[44:47], v[40:43], v[116:119]
  s_waitcnt lgkmcnt(5)
  v_cvt_pk_bf16_f32 v134, v76, v77
  v_cvt_pk_bf16_f32 v135, v78, v79
  v_mfma_f32_16x16x32_bf16 v[104:107], a[32:35], v[44:47], v[104:107]
  ds_read_b128 v[36:39], v11 offset:40960
  v_mfma_f32_16x16x32_bf16 v[108:111], a[36:39], v[44:47], v[108:111]
  v_mfma_f32_16x16x32_bf16 v[120:123], a[40:43], v[44:47], v[120:123]
  v_mfma_f32_16x16x32_bf16 v[124:127], a[44:47], v[44:47], v[124:127]
  s_waitcnt lgkmcnt(5)
  v_mfma_f32_16x16x32_bf16 v[96:99], a[48:51], v[48:51], v[96:99]
  s_add_u32 m0, s25, 3072
  ds_read_b128 v[40:43], v12 offset:40960
  v_mfma_f32_16x16x32_bf16 v[100:103], a[52:55], v[48:51], v[100:103]
  v_mfma_f32_16x16x32_bf16 v[112:115], a[56:59], v[48:51], v[112:115]
  buffer_load_dwordx4 v19, s[12:15], s19 offen lds
  v_mfma_f32_16x16x32_bf16 v[116:119], a[60:63], v[48:51], v[116:119]
  s_waitcnt lgkmcnt(5)
  v_mfma_f32_16x16x32_bf16 v[104:107], a[48:51], v[52:55], v[104:107]
  ds_read_b128 v[44:47], v13 offset:40960
  v_mfma_f32_16x16x32_bf16 v[108:111], a[52:55], v[52:55], v[108:111]
  v_cvt_pk_bf16_f32 v136, v80, v81
  v_cvt_pk_bf16_f32 v137, v82, v83
  v_mfma_f32_16x16x32_bf16 v[120:123], a[56:59], v[52:55], v[120:123]
  v_mfma_f32_16x16x32_bf16 v[124:127], a[60:63], v[52:55], v[124:127]
  s_waitcnt lgkmcnt(5)
  v_cvt_pk_bf16_f32 v138, v84, v85
  v_cvt_pk_bf16_f32 v139, v86, v87
  v_mfma_f32_16x16x32_bf16 v[96:99], a[64:67], v[24:27], v[96:99]
  s_add_u32 m0, s25, 4096
  ds_read_b128 v[48:51], v14 offset:40960
  v_mfma_f32_16x16x32_bf16 v[100:103], a[68:71], v[24:27], v[100:103]
  v_mfma_f32_16x16x32_bf16 v[112:115], a[72:75], v[24:27], v[112:115]
  buffer_load_dwordx4 v20, s[12:15], s19 offen lds
  v_mfma_f32_16x16x32_bf16 v[116:119], a[76:79], v[24:27], v[116:119]
  s_waitcnt lgkmcnt(5)
  v_mfma_f32_16x16x32_bf16 v[104:107], a[64:67], v[28:31], v[104:107]
  ds_read_b128 v[52:55], v15 offset:40960
  v_mfma_f32_16x16x32_bf16 v[108:111], a[68:71], v[28:31], v[108:111]
  v_mfma_f32_16x16x32_bf16 v[120:123], a[72:75], v[28:31], v[120:123]
  v_mfma_f32_16x16x32_bf16 v[124:127], a[76:79], v[28:31], v[124:127]
  s_waitcnt lgkmcnt(5)
  v_mfma_f32_16x16x32_bf16 v[96:99], a[80:83], v[32:35], v[96:99]
  s_add_u32 m0, s25, 5120
  ds_read_b128 v[24:27], v8 offset:49152
  v_mfma_f32_16x16x32_bf16 v[100:103], a[84:87], v[32:35], v[100:103]
  v_cvt_pk_bf16_f32 v140, v88, v89
  v_cvt_pk_bf16_f32 v141, v90, v91
  v_mfma_f32_16x16x32_bf16 v[112:115], a[88:91], v[32:35], v[112:115]
  buffer_load_dwordx4 v21, s[12:15], s19 offen lds
  v_mfma_f32_16x16x32_bf16 v[116:119], a[92:95], v[32:35], v[116:119]
  s_waitcnt lgkmcnt(5)
  v_cvt_pk_bf16_f32 v142, v92, v93
  v_cvt_pk_bf16_f32 v143, v94, v95
  v_mfma_f32_16x16x32_bf16 v[104:107], a[80:83], v[36:39], v[104:107]
  ds_read_b128 v[28:31], v9 offset:49152
  v_mfma_f32_16x16x32_bf16 v[108:111], a[84:87], v[36:39], v[108:111]
  v_mfma_f32_16x16x32_bf16 v[120:123], a[88:91], v[36:39], v[120:123]
  v_mfma_f32_16x16x32_bf16 v[124:127], a[92:95], v[36:39], v[124:127]
  s_waitcnt lgkmcnt(5)
  v_mfma_f32_16x16x32_bf16 v[96:99], a[96:99], v[40:43], v[96:99]
  s_add_u32 m0, s25, 6144
  ds_read_b128 v[32:35], v10 offset:49152
  v_mfma_f32_16x16x32_bf16 v[100:103], a[100:103], v[40:43], v[100:103]
  v_mfma_f32_16x16x32_bf16 v[112:115], a[104:107], v[40:43], v[112:115]
  buffer_load_dwordx4 v22, s[12:15], s19 offen lds
  v_mfma_f32_16x16x32_bf16 v[116:119], a[108:111], v[40:43], v[116:119]
  s_waitcnt lgkmcnt(5)
  v_mfma_f32_16x16x32_bf16 v[104:107], a[96:99], v[44:47], v[104:107]
  ds_read_b128 v[36:39], v11 offset:49152
  v_mfma_f32_16x16x32_bf16 v[108:111], a[100:103], v[44:47], v[108:111]
  v_mfma_f32_16x16x32_bf16 v[120:123], a[104:107], v[44:47], v[120:123]
  v_mfma_f32_16x16x32_bf16 v[124:127], a[108:111], v[44:47], v[124:127]
  s_waitcnt lgkmcnt(5)
  v_mfma_f32_16x16x32_bf16 v[96:99], a[112:115], v[48:51], v[96:99]
  s_add_u32 m0, s25, 7168
  ds_read_b128 v[40:43], v12 offset:49152
  v_mfma_f32_16x16x32_bf16 v[100:103], a[116:119], v[48:51], v[100:103]
  v_mfma_f32_16x16x32_bf16 v[112:115], a[120:123], v[48:51], v[112:115]
  buffer_load_dwordx4 v23, s[12:15], s19 offen lds
  v_mfma_f32_16x16x32_bf16 v[116:119], a[124:127], v[48:51], v[116:119]
  s_waitcnt lgkmcnt(5)
  v_mfma_f32_16x16x32_bf16 v[104:107], a[112:115], v[52:55], v[104:107]
  s_cmp_gt_u32 s23, 3
  ds_read_b128 v[44:47], v13 offset:49152
  v_mfma_f32_16x16x32_bf16 v[108:111], a[116:119], v[52:55], v[108:111]
  v_mfma_f32_16x16x32_bf16 v[120:123], a[120:123], v[52:55], v[120:123]
  s_cselect_b32 s26, s20, 0
  v_mfma_f32_16x16x32_bf16 v[124:127], a[124:127], v[52:55], v[124:127]
  s_waitcnt lgkmcnt(5)
  v_mfma_f32_16x16x32_bf16 v[96:99], a[128:131], v[24:27], v[96:99]
  s_add_u32 s19, s19, s26
  ds_read_b128 v[48:51], v14 offset:49152
  v_mfma_f32_16x16x32_bf16 v[100:103], a[132:135], v[24:27], v[100:103]
  v_mfma_f32_16x16x32_bf16 v[112:115], a[136:139], v[24:27], v[112:115]
  s_add_u32 s25, s25, 32768
  v_mfma_f32_16x16x32_bf16 v[116:119], a[140:143], v[24:27], v[116:119]
  s_waitcnt lgkmcnt(5)
  v_mfma_f32_16x16x32_bf16 v[104:107], a[128:131], v[28:31], v[104:107]
  s_and_b32 s25, s25, 0x1ffff
  ds_read_b128 v[52:55], v15 offset:49152
  v_mfma_f32_16x16x32_bf16 v[108:111], a[132:135], v[28:31], v[108:111]
  v_mfma_f32_16x16x32_bf16 v[120:123], a[136:139], v[28:31], v[120:123]
  buffer_store_dwordx4 v[128:131], v7, s[4:7], s21 offen offset:0 sc1
  v_mfma_f32_16x16x32_bf16 v[124:127], a[140:143], v[28:31], v[124:127]
  s_waitcnt lgkmcnt(5)
  v_mfma_f32_16x16x32_bf16 v[96:99], a[144:147], v[32:35], v[96:99]
  ds_read_b128 v[24:27], v8 offset:57344
  v_mfma_f32_16x16x32_bf16 v[100:103], a[148:151], v[32:35], v[100:103]
  v_mfma_f32_16x16x32_bf16 v[112:115], a[152:155], v[32:35], v[112:115]
  v_mfma_f32_16x16x32_bf16 v[116:119], a[156:159], v[32:35], v[116:119]
  s_waitcnt lgkmcnt(5)
  v_xor_b32 v8, 0x10000, v8
  v_mfma_f32_16x16x32_bf16 v[104:107], a[144:147], v[36:39], v[104:107]
  ds_read_b128 v[28:31], v9 offset:57344
  v_mfma_f32_16x16x32_bf16 v[108:111], a[148:151], v[36:39], v[108:111]
  v_mfma_f32_16x16x32_bf16 v[120:123], a[152:155], v[36:39], v[120:123]
  buffer_store_dwordx4 v[132:135], v7, s[4:7], s21 offen offset:256 sc1
  v_mfma_f32_16x16x32_bf16 v[124:127], a[156:159], v[36:39], v[124:127]
  s_waitcnt lgkmcnt(5)
  v_xor_b32 v9, 0x10000, v9
  v_mfma_f32_16x16x32_bf16 v[96:99], a[160:163], v[40:43], v[96:99]
  ds_read_b128 v[32:35], v10 offset:57344
  v_mfma_f32_16x16x32_bf16 v[100:103], a[164:167], v[40:43], v[100:103]
  v_mfma_f32_16x16x32_bf16 v[112:115], a[168:171], v[40:43], v[112:115]
  v_mfma_f32_16x16x32_bf16 v[116:119], a[172:175], v[40:43], v[116:119]
  s_waitcnt lgkmcnt(5)
  v_xor_b32 v10, 0x10000, v10
  v_mfma_f32_16x16x32_bf16 v[104:107], a[160:163], v[44:47], v[104:107]
  ds_read_b128 v[36:39], v11 offset:57344
  v_mfma_f32_16x16x32_bf16 v[108:111], a[164:167], v[44:47], v[108:111]
  v_mfma_f32_16x16x32_bf16 v[120:123], a[168:171], v[44:47], v[120:123]
  buffer_store_dwordx4 v[136:139], v7, s[4:7], s21 offen offset:2048 sc1
  v_mfma_f32_16x16x32_bf16 v[124:127], a[172:175], v[44:47], v[124:127]
  s_waitcnt lgkmcnt(5)
  v_xor_b32 v11, 0x10000, v11
  v_mfma_f32_16x16x32_bf16 v[96:99], a[176:179], v[48:51], v[96:99]
  ds_read_b128 v[40:43], v12 offset:57344
  v_mfma_f32_16x16x32_bf16 v[100:103], a[180:183], v[48:51], v[100:103]
  v_mfma_f32_16x16x32_bf16 v[112:115], a[184:187], v[48:51], v[112:115]
  v_mfma_f32_16x16x32_bf16 v[116:119], a[188:191], v[48:51], v[116:119]
  s_waitcnt lgkmcnt(5)
  v_xor_b32 v12, 0x10000, v12
  v_mfma_f32_16x16x32_bf16 v[104:107], a[176:179], v[52:55], v[104:107]
  ds_read_b128 v[44:47], v13 offset:57344
  v_mfma_f32_16x16x32_bf16 v[108:111], a[180:183], v[52:55], v[108:111]
  v_mfma_f32_16x16x32_bf16 v[120:123], a[184:187], v[52:55], v[120:123]
  buffer_store_dwordx4 v[140:143], v7, s[4:7], s21 offen offset:2304 sc1
  v_mfma_f32_16x16x32_bf16 v[124:127], a[188:191], v[52:55], v[124:127]
  s_waitcnt lgkmcnt(5)
  v_xor_b32 v13, 0x10000, v13
  v_mfma_f32_16x16x32_bf16 v[96:99], a[192:195], v[24:27], v[96:99]
  s_mov_b32 s21, s27
  ds_read_b128 v[48:51], v14 offset:57344
  v_mfma_f32_16x16x32_bf16 v[100:103], a[196:199], v[24:27], v[100:103]
  v_mov_b32 v7, v56
  v_mfma_f32_16x16x32_bf16 v[112:115], a[200:203], v[24:27], v[112:115]
  v_mfma_f32_16x16x32_bf16 v[116:119], a[204:207], v[24:27], v[116:119]
  s_waitcnt lgkmcnt(5)
  v_xor_b32 v14, 0x10000, v14
  v_mfma_f32_16x16x32_bf16 v[104:107], a[192:195], v[28:31], v[104:107]
  s_add_u32 s27, s27, s22
  ds_read_b128 v[52:55], v15 offset:57344
  v_mfma_f32_16x16x32_bf16 v[108:111], a[196:199], v[28:31], v[108:111]
  v_mfma_f32_16x16x32_bf16 v[120:123], a[200:203], v[28:31], v[120:123]
  s_waitcnt vmcnt(13)
  s_barrier
  v_mfma_f32_16x16x32_bf16 v[124:127], a[204:207], v[28:31], v[124:127]
  s_waitcnt lgkmcnt(5)
  v_xor_b32 v15, 0x10000, v15
  v_mfma_f32_16x16x32_bf16 v[96:99], a[208:211], v[32:35], v[96:99]
  ds_read_b128 v[24:27], v8 offset:0
  v_mfma_f32_16x16x32_bf16 v[100:103], a[212:215], v[32:35], v[100:103]
  v_mfma_f32_16x16x32_bf16 v[112:115], a[216:219], v[32:35], v[112:115]
  v_mfma_f32_16x16x32_bf16 v[116:119], a[220:223], v[32:35], v[116:119]
  s_waitcnt lgkmcnt(5)
  v_mfma_f32_16x16x32_bf16 v[104:107], a[208:211], v[36:39], v[104:107]
  s_add_u32 s29, s29, 1
  ds_read_b128 v[28:31], v9 offset:0
  v_mfma_f32_16x16x32_bf16 v[108:111], a[212:215], v[36:39], v[108:111]
  v_mfma_f32_16x16x32_bf16 v[120:123], a[216:219], v[36:39], v[120:123]
  s_max_i32 s30, s29, 0
  v_mfma_f32_16x16x32_bf16 v[124:127], a[220:223], v[36:39], v[124:127]
  s_waitcnt lgkmcnt(5)
  v_mov_b32 v144, s30
  v_mfma_f32_16x16x32_bf16 v[96:99], a[224:227], v[40:43], v[96:99]
  ds_read_b128 v[32:35], v10 offset:0
  v_mfma_f32_16x16x32_bf16 v[100:103], a[228:231], v[40:43], v[100:103]
  v_mfma_f32_16x16x32_bf16 v[112:115], a[232:235], v[40:43], v[112:115]
  buffer_store_dword v144, v145, s[4:7], s31 offen sc1
  v_mfma_f32_16x16x32_bf16 v[116:119], a[236:239], v[40:43], v[116:119]
  s_waitcnt lgkmcnt(5)
  v_mfma_f32_16x16x32_bf16 v[104:107], a[224:227], v[44:47], v[104:107]
  ds_read_b128 v[36:39], v11 offset:0
  v_mfma_f32_16x16x32_bf16 v[108:111], a[228:231], v[44:47], v[108:111]
  v_mfma_f32_16x16x32_bf16 v[120:123], a[232:235], v[44:47], v[120:123]
  v_mfma_f32_16x16x32_bf16 v[124:127], a[236:239], v[44:47], v[124:127]
  s_waitcnt lgkmcnt(5)
  v_mfma_f32_16x16x32_bf16 v[96:99], a[240:243], v[48:51], v[96:99]
  s_sub_u32 s23, s23, 1
  ds_read_b128 v[40:43], v12 offset:0
  v_mfma_f32_16x16x32_bf16 v[100:103], a[244:247], v[48:51], v[100:103]
  v_mfma_f32_16x16x32_bf16 v[112:115], a[248:251], v[48:51], v[112:115]
  v_mfma_f32_16x16x32_bf16 v[116:119], a[252:255], v[48:51], v[116:119]
  s_waitcnt lgkmcnt(5)
  v_mfma_f32_16x16x32_bf16 v[104:107], a[240:243], v[52:55], v[104:107]
  s_cmp_eq_u32 s23, 0
  ds_read_b128 v[44:47], v13 offset:0
  v_mfma_f32_16x16x32_bf16 v[108:111], a[244:247], v[52:55], v[108:111]
  v_mfma_f32_16x16x32_bf16 v[120:123], a[248:251], v[52:55], v[120:123]
  v_mfma_f32_16x16x32_bf16 v[124:127], a[252:255], v[52:55], v[124:127]
  s_cbranch_scc1 G_done1_6
  s_branch G_top_4
G_done0_5:
  s_nop 7
  s_nop 3
  v_cvt_pk_bf16_f32 v128, v64, v65
  v_cvt_pk_bf16_f32 v129, v66, v67
  v_cvt_pk_bf16_f32 v130, v68, v69
  v_cvt_pk_bf16_f32 v131, v70, v71
  buffer_store_dwordx4 v[128:131], v7, s[4:7], s21 offen offset:0 sc1
  v_cvt_pk_bf16_f32 v132, v72, v73
  v_cvt_pk_bf16_f32 v133, v74, v75
  v_cvt_pk_bf16_f32 v134, v76, v77
  v_cvt_pk_bf16_f32 v135, v78, v79
  buffer_store_dwordx4 v[132:135], v7, s[4:7], s21 offen offset:256 sc1
  v_cvt_pk_bf16_f32 v136, v80, v81
  v_cvt_pk_bf16_f32 v137, v82, v83
  v_cvt_pk_bf16_f32 v138, v84, v85
  v_cvt_pk_bf16_f32 v139, v86, v87
  buffer_store_dwordx4 v[136:139], v7, s[4:7], s21 offen offset:2048 sc1
  v_cvt_pk_bf16_f32 v140, v88, v89
  v_cvt_pk_bf16_f32 v141, v90, v91
  v_cvt_pk_bf16_f32 v142, v92, v93
  v_cvt_pk_bf16_f32 v143, v94, v95
  buffer_store_dwordx4 v[140:143], v7, s[4:7], s21 offen offset:2304 sc1
  s_branch G_fin_7
G_done1_6:
  s_nop 7
  s_nop 3
  v_cvt_pk_bf16_f32 v128, v96, v97
  v_cvt_pk_bf16_f32 v129, v98, v99
  v_cvt_pk_bf16_f32 v130, v100, v101
  v_cvt_pk_bf16_f32 v131, v102, v103
  buffer_store_dwordx4 v[128:131], v7, s[4:7], s21 offen offset:0 sc1
  v_cvt_pk_bf16_f32 v132, v104, v105
  v_cvt_pk_bf16_f32 v133, v106, v107
  v_cvt_pk_bf16_f32 v134, v108, v109
  v_cvt_pk_bf16_f32 v135, v110, v111
  buffer_store_dwordx4 v[132:135], v7, s[4:7], s21 offen offset:256 sc1
  v_cvt_pk_bf16_f32 v136, v112, v113
  v_cvt_pk_bf16_f32 v137, v114, v115
  v_cvt_pk_bf16_f32 v138, v116, v117
  v_cvt_pk_bf16_f32 v139, v118, v119
  buffer_store_dwordx4 v[136:139], v7, s[4:7], s21 offen offset:2048 sc1
  v_cvt_pk_bf16_f32 v140, v120, v121
  v_cvt_pk_bf16_f32 v141, v122, v123
  v_cvt_pk_bf16_f32 v142, v124, v125
  v_cvt_pk_bf16_f32 v143, v126, v127
  buffer_store_dwordx4 v[140:143], v7, s[4:7], s21 offen offset:2304 sc1
G_fin_7:
  s_waitcnt vmcnt(0) lgkmcnt(0)
  s_barrier
  s_add_u32 s30, s29, 2
  v_mov_b32 v144, s30
  v_min_u32 v145, 1, v0
  v_lshlrev_b32 v145, 30, v145
  buffer_store_dword v144, v145, s[4:7], s31 offen sc1
  s_branch P_end_2
P_q_3:
  s_mov_b32 s27, s21
  v_mov_b32 v7, 0x40000000
  s_mov_b32 s29, -2
  v_min_u32 v145, 1, v0
  v_lshlrev_b32 v145, 30, v145
  ds_read_b128 v[24:27], v8 offset:0
  ds_read_b128 v[28:31], v9 offset:0
  ds_read_b128 v[32:35], v10 offset:0
  ds_read_b128 v[36:39], v11 offset:0
  ds_read_b128 v[40:43], v12 offset:0
  ds_read_b128 v[44:47], v13 offset:0
.p2align 6
G_top_8:
  s_waitcnt lgkmcnt(5)
  v_mfma_f32_16x16x32_bf16 v[64:67], a[0:3], v[24:27], 0
  s_add_u32 m0, s25, 0
  ds_read_b128 v[48:51], v14 offset:0
  v_mfma_f32_16x16x32_bf16 v[68:71], a[4:7], v[24:27], 0
  v_mfma_f32_16x16x32_bf16 v[80:83], a[8:11], v[24:27], 0
  buffer_load_dwordx4 v16, s[12:15], s19 offen lds
  v_mfma_f32_16x16x32_bf16 v[84:87], a[12:15], v[24:27], 0
  s_waitcnt lgkmcnt(5)
  v_mfma_f32_16x16x32_bf16 v[72:75], a[0:3], v[28:31], 0
  ds_read_b128 v[52:55], v15 offset:0
  v_mfma_f32_16x16x32_bf16 v[76:79], a[4:7], v[28:31], 0
  v_mul_f32 v96, s24, v96
  v_mul_f32 v97, s24, v97
  v_mfma_f32_16x16x32_bf16 v[88:91], a[8:11], v[28:31], 0
  v_mfma_f32_16x16x32_bf16 v[92:95], a[12:15], v[28:31], 0
  s_waitcnt lgkmcnt(5)
  v_cvt_pk_bf16_f32 v128, v96, v97
  v_mul_f32 v98, s24, v98
  v_mfma_f32_16x16x32_bf16 v[64:67], a[16:19], v[32:35], v[64:67]
  s_add_u32 m0, s25, 1024
  ds_read_b128 v[24:27], v8 offset:8192
  v_mfma_f32_16x16x32_bf16 v[68:71], a[20:23], v[32:35], v[68:71]
  v_mul_f32 v99, s24, v99
  v_cvt_pk_bf16_f32 v129, v98, v99
  v_mfma_f32_16x16x32_bf16 v[80:83], a[24:27], v[32:35], v[80:83]
  buffer_load_dwordx4 v17, s[12:15], s19 offen lds
  v_mfma_f32_16x16x32_bf16 v[84:87], a[28:31], v[32:35], v[84:87]
  s_waitcnt lgkmcnt(5)
  v_mul_f32 v100, s24, v100
  v_mul_f32 v101, s24, v101
  v_mfma_f32_16x16x32_bf16 v[72:75], a[16:19], v[36:39], v[72:75]
  ds_read_b128 v[28:31], v9 offset:8192
  v_mfma_f32_16x16x32_bf16 v[76:79], a[20:23], v[36:39], v[76:79]
  v_cvt_pk_bf16_f32 v130, v100, v101
  v_mul_f32 v102, s24, v102
  v_mfma_f32_16x16x32_bf16 v[88:91], a[24:27], v[36:39], v[88:91]
  v_mfma_f32_16x16x32_bf16 v[92:95], a[28:31], v[36:39], v[92:95]
  s_waitcnt lgkmcnt(5)
  v_mul_f32 v103, s24, v103
  v_cvt_pk_bf16_f32 v131, v102, v103
  v_mfma_f32_16x16x32_bf16 v[64:67], a[32:35], v[40:43], v[64:67]
  s_add_u32 m0, s25, 2048
  ds_read_b128 v[32:35], v10 offset:8192
  v_mfma_f32_16x16x32_bf16 v[68:71], a[36:39], v[40:43], v[68:71]
  v_mul_f32 v104, s24, v104
  v_mul_f32 v105, s24, v105
  v_mfma_f32_16x16x32_bf16 v[80:83], a[40:43], v[40:43], v[80:83]
  buffer_load_dwordx4 v18, s[12:15], s19 offen lds
  v_mfma_f32_16x16x32_bf16 v[84:87], a[44:47], v[40:43], v[84:87]
  s_waitcnt lgkmcnt(5)
  v_cvt_pk_bf16_f32 v132, v104, v105
  v_mul_f32 v106, s24, v106
  v_mfma_f32_16x16x32_bf16 v[72:75], a[32:35], v[44:47], v[72:75]
  ds_read_b128 v[36:39], v11 offset:8192
  v_mfma_f32_16x16x32_bf16 v[76:79], a[36:39], v[44:47], v[76:79]
  v_mul_f32 v107, s24, v107
  v_cvt_pk_bf16_f32 v133, v106, v107
  v_mfma_f32_16x16x32_bf16 v[88:91], a[40:43], v[44:47], v[88:91]
  v_mfma_f32_16x16x32_bf16 v[92:95], a[44:47], v[44:47], v[92:95]
  s_waitcnt lgkmcnt(5)
  v_mul_f32 v108, s24, v108
  v_mul_f32 v109, s24, v109
  v_mfma_f32_16x16x32_bf16 v[64:67], a[48:51], v[48:51], v[64:67]
  s_add_u32 m0, s25, 3072
  ds_read_b128 v[40:43], v12 offset:8192
  v_mfma_f32_16x16x32_bf16 v[68:71], a[52:55], v[48:51], v[68:71]
  v_cvt_pk_bf16_f32 v134, v108, v109
  v_mul_f32 v110, s24, v110
  v_mfma_f32_16x16x32_bf16 v[80:83], a[56:59], v[48:51], v[80:83]
  buffer_load_dwordx4 v19, s[12:15], s19 offen lds
  v_mfma_f32_16x16x32_bf16 v[84:87], a[60:63], v[48:51], v[84:87]
  s_waitcnt lgkmcnt(5)
  v_mul_f32 v111, s24, v111
  v_cvt_pk_bf16_f32 v135, v110, v111
  v_mfma_f32_16x16x32_bf16 v[72:75], a[48:51], v[52:55], v[72:75]
  ds_read_b128 v[44:47], v13 offset:8192
  v_mfma_f32_16x16x32_bf16 v[76:79], a[52:55], v[52:55], v[76:79]
  v_mul_f32 v112, s24, v112
  v_mul_f32 v113, s24, v113
  v_mfma_f32_16x16x32_bf16 v[88:91], a[56:59], v[52:55], v[88:91]
  v_mfma_f32_16x16x32_bf16 v[92:95], a[60:63], v[52:55], v[92:95]
  s_waitcnt lgkmcnt(5)
  v_cvt_pk_bf16_f32 v136, v112, v113
  v_mul_f32 v114, s24, v114
  v_mfma_f32_16x16x32_bf16 v[64:67], a[64:67], v[24:27], v[64:67]
  s_add_u32 m0, s25, 4096
  ds_read_b128 v[48:51], v14 offset:8192
  v_mfma_f32_16x16x32_bf16 v[68:71], a[68:71], v[24:27], v[68:71]
  v_mul_f32 v115, s24, v115
  v_cvt_pk_bf16_f32 v137, v114, v115
  v_mfma_f32_16x16x32_bf16 v[80:83], a[72:75], v[24:27], v[80:83]
  buffer_load_dwordx4 v20, s[12:15], s19 offen lds
  v_mfma_f32_16x16x32_bf16 v[84:87], a[76:79], v[24:27], v[84:87]
  s_waitcnt lgkmcnt(5)
  v_mul_f32 v116, s24, v116
  v_mul_f32 v117, s24, v117
  v_mfma_f32_16x16x32_bf16 v[72:75], a[64:67], v[28:31], v[72:75]
  ds_read_b128 v[52:55], v15 offset:8192
  v_mfma_f32_16x16x32_bf16 v[76:79], a[68:71], v[28:31], v[76:79]
  v_cvt_pk_bf16_f32 v138, v116, v117
  v_mul_f32 v118, s24, v118
  v_mfma_f32_16x16x32_bf16 v[88:91], a[72:75], v[28:31], v[88:91]
  v_mfma_f32_16x16x32_bf16 v[92:95], a[76:79], v[28:31], v[92:95]
  s_waitcnt lgkmcnt(5)
  v_mul_f32 v119, s24, v119
  v_cvt_pk_bf16_f32 v139, v118, v119
  v_mfma_f32_16x16x32_bf16 v[64:67], a[80:83], v[32:35], v[64:67]
  s_add_u32 m0, s25, 5120
  ds_read_b128 v[24:27], v8 offset:16384
  v_mfma_f32_16x16x32_bf16 v[68:71], a[84:87], v[32:35], v[68:71]
  v_mul_f32 v120, s24, v120
  v_mul_f32 v121, s24, v121
  v_mfma_f32_16x16x32_bf16 v[80:83], a[88:91], v[32:35], v[80:83]
  buffer_load_dwordx4 v21, s[12:15], s19 offen lds
  v_mfma_f32_16x16x32_bf16 v[84:87], a[92:95], v[32:35], v[84:87]
  s_waitcnt lgkmcnt(5)
  v_cvt_pk_bf16_f32 v140, v120, v121
  v_mul_f32 v122, s24, v122
  v_mfma_f32_16x16x32_bf16 v[72:75], a[80:83], v[36:39], v[72:75]
  ds_read_b128 v[28:31], v9 offset:16384
  v_mfma_f32_16x16x32_bf16 v[76:79], a[84:87], v[36:39], v[76:79]
  v_mul_f32 v123, s24, v123
  v_cvt_pk_bf16_f32 v141, v122, v123
  v_mfma_f32_16x16x32_bf16 v[88:91], a[88:91], v[36:39], v[88:91]
  v_mfma_f32_16x16x32_bf16 v[92:95], a[92:95], v[36:39], v[92:95]
  s_waitcnt lgkmcnt(5)
  v_mul_f32 v124, s24, v124
  v_mul_f32 v125, s24, v125
  v_mfma_f32_16x16x32_bf16 v[64:67], a[96:99], v[40:43], v[64:67]
  s_add_u32 m0, s25, 6144
  ds_read_b128 v[32:35], v10 offset:16384
  v_mfma_f32_16x16x32_bf16 v[68:71], a[100:103], v[40:43], v[68:71]
  v_cvt_pk_bf16_f32 v142, v124, v125
  v_mul_f32 v126, s24, v126
  v_mfma_f32_16x16x32_bf16 v[80:83], a[104:107], v[40:43], v[80:83]
  buffer_load_dwordx4 v22, s[12:15], s19 offen lds
  v_mfma_f32_16x16x32_bf16 v[84:87], a[108:111], v[40:43], v[84:87]
  s_waitcnt lgkmcnt(5)
  v_mul_f32 v127, s24, v127
  v_cvt_pk_bf16_f32 v143, v126, v127
  v_mfma_f32_16x16x32_bf16 v[72:75], a[96:99], v[44:47], v[72:75]
  ds_read_b128 v[36:39], v11 offset:16384
  v_mfma_f32_16x16x32_bf16 v[76:79], a[100:103], v[44:47], v[76:79]
  v_mfma_f32_16x16x32_bf16 v[88:91], a[104:107], v[44:47], v[88:91]
  v_mfma_f32_16x16x32_bf16 v[92:95], a[108:111], v[44:47], v[92:95]
  s_waitcnt lgkmcnt(5)
  v_mfma_f32_16x16x32_bf16 v[64:67], a[112:115], v[48:51], v[64:67]
  s_add_u32 m0, s25, 7168
  ds_read_b128 v[40:43], v12 offset:16384
  v_mfma_f32_16x16x32_bf16 v[68:71], a[116:119], v[48:51], v[68:71]
  v_mfma_f32_16x16x32_bf16 v[80:83], a[120:123], v[48:51], v[80:83]
  buffer_load_dwordx4 v23, s[12:15], s19 offen lds
  v_mfma_f32_16x16x32_bf16 v[84:87], a[124:127], v[48:51], v[84:87]
  s_waitcnt lgkmcnt(5)
  v_mfma_f32_16x16x32_bf16 v[72:75], a[112:115], v[52:55], v[72:75]
  s_cmp_gt_u32 s23, 3
  ds_read_b128 v[44:47], v13 offset:16384
  v_mfma_f32_16x16x32_bf16 v[76:79], a[116:119], v[52:55], v[76:79]
  v_mfma_f32_16x16x32_bf16 v[88:91], a[120:123], v[52:55], v[88:91]
  s_cselect_b32 s26, s20, 0
  v_mfma_f32_16x16x32_bf16 v[92:95], a[124:127], v[52:55], v[92:95]
  s_waitcnt lgkmcnt(5)
  v_mfma_f32_16x16x32_bf16 v[64:67], a[128:131], v[24:27], v[64:67]
  s_add_u32 s19, s19, s26
  ds_read_b128 v[48:51], v14 offset:16384
  v_mfma_f32_16x16x32_bf16 v[68:71], a[132:135], v[24:27], v[68:71]
  v_mfma_f32_16x16x32_bf16 v[80:83], a[136:139], v[24:27], v[80:83]
  s_add_u32 s25, s25, 32768
  v_mfma_f32_16x16x32_bf16 v[84:87], a[140:143], v[24:27], v[84:87]
  s_waitcnt lgkmcnt(5)
  v_mfma_f32_16x16x32_bf16 v[72:75], a[128:131], v[28:31], v[72:75]
  s_and_b32 s25, s25, 0x1ffff
  ds_read_b128 v[52:55], v15 offset:16384
  v_mfma_f32_16x16x32_bf16 v[76:79], a[132:135], v[28:31], v[76:79]
  v_mfma_f32_16x16x32_bf16 v[88:91], a[136:139], v[28:31], v[88:91]
  buffer_store_dwordx4 v[128:131], v7, s[4:7], s21 offen offset:0 sc1
  v_mfma_f32_16x16x32_bf16 v[92:95], a[140:143], v[28:31], v[92:95]
  s_waitcnt lgkmcnt(5)
  v_mfma_f32_16x16x32_bf16 v[64:67], a[144:147], v[32:35], v[64:67]
  ds_read_b128 v[24:27], v8 offset:24576
  v_mfma_f32_16x16x32_bf16 v[68:71], a[148:151], v[32:35], v[68:71]
  v_mfma_f32_16x16x32_bf16 v[80:83], a[152:155], v[32:35], v[80:83]
  v_mfma_f32_16x16x32_bf16 v[84:87], a[156:159], v[32:35], v[84:87]
  s_waitcnt lgkmcnt(5)
  v_mfma_f32_16x16x32_bf16 v[72:75], a[144:147], v[36:39], v[72:75]
  ds_read_b128 v[28:31], v9 offset:24576
  v_mfma_f32_16x16x32_bf16 v[76:79], a[148:151], v[36:39], v[76:79]
  v_mfma_f32_16x16x32_bf16 v[88:91], a[152:155], v[36:39], v[88:91]
  buffer_store_dwordx4 v[132:135], v7, s[4:7], s21 offen offset:256 sc1
  v_mfma_f32_16x16x32_bf16 v[92:95], a[156:159], v[36:39], v[92:95]
  s_waitcnt lgkmcnt(5)
  v_mfma_f32_16x16x32_bf16 v[64:67], a[160:163], v[40:43], v[64:67]
  ds_read_b128 v[32:35], v10 offset:24576
  v_mfma_f32_16x16x32_bf16 v[68:71], a[164:167], v[40:43], v[68:71]
  v_mfma_f32_16x16x32_bf16 v[80:83], a[168:171], v[40:43], v[80:83]
  v_mfma_f32_16x16x32_bf16 v[84:87], a[172:175], v[40:43], v[84:87]
  s_waitcnt lgkmcnt(5)
  v_mfma_f32_16x16x32_bf16 v[72:75], a[160:163], v[44:47], v[72:75]
  ds_read_b128 v[36:39], v11 offset:24576
  v_mfma_f32_16x16x32_bf16 v[76:79], a[164:167], v[44:47], v[76:79]
  v_mfma_f32_16x16x32_bf16 v[88:91], a[168:171], v[44:47], v[88:91]
  buffer_store_dwordx4 v[136:139], v7, s[4:7], s21 offen offset:2048 sc1
  v_mfma_f32_16x16x32_bf16 v[92:95], a[172:175], v[44:47], v[92:95]
  s_waitcnt lgkmcnt(5)
  v_mfma_f32_16x16x32_bf16 v[64:67], a[176:179], v[48:51], v[64:67]
  ds_read_b128 v[40:43], v12 offset:24576
  v_mfma_f32_16x16x32_bf16 v[68:71], a[180:183], v[48:51], v[68:71]
  v_mfma_f32_16x16x32_bf16 v[80:83], a[184:187], v[48:51], v[80:83]
  v_mfma_f32_16x16x32_bf16 v[84:87], a[188:191], v[48:51], v[84:87]
  s_waitcnt lgkmcnt(5)
  v_mfma_f32_16x16x32_bf16 v[72:75], a[176:179], v[52:55], v[72:75]
  ds_read_b128 v[44:47], v13 offset:24576
  v_mfma_f32_16x16x32_bf16 v[76:79], a[180:183], v[52:55], v[76:79]
  v_mfma_f32_16x16x32_bf16 v[88:91], a[184:187], v[52:55], v[88:91]
  buffer_store_dwordx4 v[140:143], v7, s[4:7], s21 offen offset:2304 sc1
  v_mfma_f32_16x16x32_bf16 v[92:95], a[188:191], v[52:55], v[92:95]
  s_waitcnt lgkmcnt(5)
  v_mfma_f32_16x16x32_bf16 v[64:67], a[192:195], v[24:27], v[64:67]
  s_mov_b32 s21, s27
  ds_read_b128 v[48:51], v14 offset:24576
  v_mfma_f32_16x16x32_bf16 v[68:71], a[196:199], v[24:27], v[68:71]
  v_mov_b32 v7, v56
  v_mfma_f32_16x16x32_bf16 v[80:83], a[200:203], v[24:27], v[80:83]
  v_mfma_f32_16x16x32_bf16 v[84:87], a[204:207], v[24:27], v[84:87]
  s_waitcnt lgkmcnt(5)
  v_mfma_f32_16x16x32_bf16 v[72:75], a[192:195], v[28:31], v[72:75]
  s_add_u32 s27, s27, s22
  ds_read_b128 v[52:55], v15 offset:24576
  v_mfma_f32_16x16x32_bf16 v[76:79], a[196:199], v[28:31], v[76:79]
  v_mfma_f32_16x16x32_bf16 v[88:91], a[200:203], v[28:31], v[88:91]
  s_waitcnt vmcnt(13)
  s_barrier
  v_mfma_f32_16x16x32_bf16 v[92:95], a[204:207], v[28:31], v[92:95]
  s_waitcnt lgkmcnt(5)
  v_mfma_f32_16x16x32_bf16 v[64:67], a[208:211], v[32:35], v[64:67]
  ds_read_b128 v[24:27], v8 offset:32768
  v_mfma_f32_16x16x32_bf16 v[68:71], a[212:215], v[32:35], v[68:71]
  v_mfma_f32_16x16x32_bf16 v[80:83], a[216:219], v[32:35], v[80:83]
  v_mfma_f32_16x16x32_bf16 v[84:87], a[220:223], v[32:35], v[84:87]
  s_waitcnt lgkmcnt(5)
  v_mfma_f32_16x16x32_bf16 v[72:75], a[208:211], v[36:39], v[72:75]
  s_add_u32 s29, s29, 1
  ds_read_b128 v[28:31], v9 offset:32768
  v_mfma_f32_16x16x32_bf16 v[76:79], a[212:215], v[36:39], v[76:79]
  v_mfma_f32_16x16x32_bf16 v[88:91], a[216:219], v[36:39], v[88:91]
  s_max_i32 s30, s29, 0
  v_mfma_f32_16x16x32_bf16 v[92:95], a[220:223], v[36:39], v[92:95]
  s_waitcnt lgkmcnt(5)
  v_mov_b32 v144, s30
  v_mfma_f32_16x16x32_bf16 v[64:67], a[224:227], v[40:43], v[64:67]
  ds_read_b128 v[32:35], v10 offset:32768
  v_mfma_f32_16x16x32_bf16 v[68:71], a[228:231], v[40:43], v[68:71]
  v_mfma_f32_16x16x32_bf16 v[80:83], a[232:235], v[40:43], v[80:83]
  buffer_store_dword v144, v145, s[4:7], s31 offen sc1
  v_mfma_f32_16x16x32_bf16 v[84:87], a[236:239], v[40:43], v[84:87]
  s_waitcnt lgkmcnt(5)
  v_mfma_f32_16x16x32_bf16 v[72:75], a[224:227], v[44:47], v[72:75]
  ds_read_b128 v[36:39], v11 offset:32768
  v_mfma_f32_16x16x32_bf16 v[76:79], a[228:231], v[44:47], v[76:79]
  v_mfma_f32_16x16x32_bf16 v[88:91], a[232:235], v[44:47], v[88:91]
  v_mfma_f32_16x16x32_bf16 v[92:95], a[236:239], v[44:47], v[92:95]
  s_waitcnt lgkmcnt(5)
  v_mfma_f32_16x16x32_bf16 v[64:67], a[240:243], v[48:51], v[64:67]
  s_sub_u32 s23, s23, 1
  ds_read_b128 v[40:43], v12 offset:32768
  v_mfma_f32_16x16x32_bf16 v[68:71], a[244:247], v[48:51], v[68:71]
  v_mfma_f32_16x16x32_bf16 v[80:83], a[248:251], v[48:51], v[80:83]
  v_mfma_f32_16x16x32_bf16 v[84:87], a[252:255], v[48:51], v[84:87]
  s_waitcnt lgkmcnt(5)
  v_mfma_f32_16x16x32_bf16 v[72:75], a[240:243], v[52:55], v[72:75]
  s_cmp_eq_u32 s23, 0
  ds_read_b128 v[44:47], v13 offset:32768
  v_mfma_f32_16x16x32_bf16 v[76:79], a[244:247], v[52:55], v[76:79]
  v_mfma_f32_16x16x32_bf16 v[88:91], a[248:251], v[52:55], v[88:91]
  v_mfma_f32_16x16x32_bf16 v[92:95], a[252:255], v[52:55], v[92:95]
  s_cbranch_scc1 G_done0_9
  s_waitcnt lgkmcnt(5)
  v_mfma_f32_16x16x32_bf16 v[96:99], a[0:3], v[24:27], 0
  s_add_u32 m0, s25, 0
  ds_read_b128 v[48:51], v14 offset:32768
  v_mfma_f32_16x16x32_bf16 v[100:103], a[4:7], v[24:27], 0
  v_mfma_f32_16x16x32_bf16 v[112:115], a[8:11], v[24:27], 0
  buffer_load_dwordx4 v16, s[12:15], s19 offen lds
  v_mfma_f32_16x16x32_bf16 v[116:119], a[12:15], v[24:27], 0
  s_waitcnt lgkmcnt(5)
  v_mfma_f32_16x16x32_bf16 v[104:107], a[0:3], v[28:31], 0
  ds_read_b128 v[52:55], v15 offset:32768
  v_mfma_f32_16x16x32_bf16 v[108:111], a[4:7], v[28:31], 0
  v_mul_f32 v64, s24, v64
  v_mul_f32 v65, s24, v65
  v_mfma_f32_16x16x32_bf16 v[120:123], a[8:11], v[28:31], 0
  v_mfma_f32_16x16x32_bf16 v[124:127], a[12:15], v[28:31], 0
  s_waitcnt lgkmcnt(5)
  v_cvt_pk_bf16_f32 v128, v64, v65
  v_mul_f32 v66, s24, v66
  v_mfma_f32_16x16x32_bf16 v[96:99], a[16:19], v[32:35], v[96:99]
  s_add_u32 m0, s25, 1024
  ds_read_b128 v[24:27], v8 offset:40960
  v_mfma_f32_16x16x32_bf16 v[100:103], a[20:23], v[32:35], v[100:103]
  v_mul_f32 v67, s24, v67
  v_cvt_pk_bf16_f32 v129, v66, v67
  v_mfma_f32_16x16x32_bf16 v[112:115], a[24:27], v[32:35], v[112:115]
  buffer_load_dwordx4 v17, s[12:15], s19 offen lds
  v_mfma_f32_16x16x32_bf16 v[116:119], a[28:31], v[32:35], v[116:119]
  s_waitcnt lgkmcnt(5)
  v_mul_f32 v68, s24, v68
  v_mul_f32 v69, s24, v69
  v_mfma_f32_16x16x32_bf16 v[104:107], a[16:19], v[36:39], v[104:107]
  ds_read_b128 v[28:31], v9 offset:40960
  v_mfma_f32_16x16x32_bf16 v[108:111], a[20:23], v[36:39], v[108:111]
  v_cvt_pk_bf16_f32 v130, v68, v69
  v_mul_f32 v70, s24, v70
  v_mfma_f32_16x16x32_bf16 v[120:123], a[24:27], v[36:39], v[120:123]
  v_mfma_f32_16x16x32_bf16 v[124:127], a[28:31], v[36:39], v[124:127]
  s_waitcnt lgkmcnt(5)
  v_mul_f32 v71, s24, v71
  v_cvt_pk_bf16_f32 v131, v70, v71
  v_mfma_f32_16x16x32_bf16 v[96:99], a[32:35], v[40:43], v[96:99]
  s_add_u32 m0, s25, 2048
  ds_read_b128 v[32:35], v10 offset:40960
  v_mfma_f32_16x16x32_bf16 v[100:103], a[36:39], v[40:43], v[100:103]
  v_mul_f32 v72, s24, v72
  v_mul_f32 v73, s24, v73
  v_mfma_f32_16x16x32_bf16 v[112:115], a[40:43], v[40:43], v[112:115]
  buffer_load_dwordx4 v18, s[12:15], s19 offen lds
  v_mfma_f32_16x16x32_bf16 v[116:119], a[44:47], v[40:43], v[116:119]
  s_waitcnt lgkmcnt(5)
  v_cvt_pk_bf16_f32 v132, v72, v73
  v_mul_f32 v74, s24, v74
  v_mfma_f32_16x16x32_bf16 v[104:107], a[32:35], v[44:47], v[104:107]
  ds_read_b128 v[36:39], v11 offset:40960
  v_mfma_f32_16x16x32_bf16 v[108:111], a[36:39], v[44:47], v[108:111]
  v_mul_f32 v75, s24, v75
  v_cvt_pk_bf16_f32 v133, v74, v75
  v_mfma_f32_16x16x32_bf16 v[120:123], a[40:43], v[44:47], v[120:123]
  v_mfma_f32_16x16x32_bf16 v[124:127], a[44:47], v[44:47], v[124:127]
  s_waitcnt lgkmcnt(5)
  v_mul_f32 v76, s24, v76
  v_mul_f32 v77, s24, v77
  v_mfma_f32_16x16x32_bf16 v[96:99], a[48:51], v[48:51], v[96:99]
  s_add_u32 m0, s25, 3072
  ds_read_b128 v[40:43], v12 offset:40960
  v_mfma_f32_16x16x32_bf16 v[100:103], a[52:55], v[48:51], v[100:103]
  v_cvt_pk_bf16_f32 v134, v76, v77
  v_mul_f32 v78, s24, v78
  v_mfma_f32_16x16x32_bf16 v[112:115], a[56:59], v[48:51], v[112:115]
  buffer_load_dwordx4 v19, s[12:15], s19 offen lds
  v_mfma_f32_16x16x32_bf16 v[116:119], a[60:63], v[48:51], v[116:119]
  s_waitcnt lgkmcnt(5)
  v_mul_f32 v79, s24, v79
  v_cvt_pk_bf16_f32 v135, v78, v79
  v_mfma_f32_16x16x32_bf16 v[104:107], a[48:51], v[52:55], v[104:107]
  ds_read_b128 v[44:47], v13 offset:40960
  v_mfma_f32_16x16x32_bf16 v[108:111], a[52:55], v[52:55], v[108:111]
  v_mul_f32 v80, s24, v80
  v_mul_f32 v81, s24, v81
  v_mfma_f32_16x16x32_bf16 v[120:123], a[56:59], v[52:55], v[120:123]
  v_mfma_f32_16x16x32_bf16 v[124:127], a[60:63], v[52:55], v[124:127]
  s_waitcnt lgkmcnt(5)
  v_cvt_pk_bf16_f32 v136, v80, v81
  v_mul_f32 v82, s24, v82
  v_mfma_f32_16x16x32_bf16 v[96:99], a[64:67], v[24:27], v[96:99]
  s_add_u32 m0, s25, 4096
  ds_read_b128 v[48:51], v14 offset:40960
  v_mfma_f32_16x16x32_bf16 v[100:103], a[68:71], v[24:27], v[100:103]
  v_mul_f32 v83, s24, v83
  v_cvt_pk_bf16_f32 v137, v82, v83
  v_mfma_f32_16x16x32_bf16 v[112:115], a[72:75], v[24:27], v[112:115]
  buffer_load_dwordx4 v20, s[12:15], s19 offen lds
  v_mfma_f32_16x16x32_bf16 v[116:119], a[76:79], v[24:27], v[116:119]
  s_waitcnt lgkmcnt(5)
  v_mul_f32 v84, s24, v84
  v_mul_f32 v85, s24, v85
  v_mfma_f32_16x16x32_bf16 v[104:107], a[64:67], v[28:31], v[104:107]
  ds_read_b128 v[52:55], v15 offset:40960
  v_mfma_f32_16x16x32_bf16 v[108:111], a[68:71], v[28:31], v[108:111]
  v_cvt_pk_bf16_f32 v138, v84, v85
  v_mul_f32 v86, s24, v86
  v_mfma_f32_16x16x32_bf16 v[120:123], a[72:75], v[28:31], v[120:123]
  v_mfma_f32_16x16x32_bf16 v[124:127], a[76:79], v[28:31], v[124:127]
  s_waitcnt lgkmcnt(5)
  v_mul_f32 v87, s24, v87
  v_cvt_pk_bf16_f32 v139, v86, v87
  v_mfma_f32_16x16x32_bf16 v[96:99], a[80:83], v[32:35], v[96:99]
  s_add_u32 m0, s25, 5120
  ds_read_b128 v[24:27], v8 offset:49152
  v_mfma_f32_16x16x32_bf16 v[100:103], a[84:87], v[32:35], v[100:103]
  v_mul_f32 v88, s24, v88
  v_mul_f32 v89, s24, v89
  v_mfma_f32_16x16x32_bf16 v[112:115], a[88:91], v[32:35], v[112:115]
  buffer_load_dwordx4 v21, s[12:15], s19 offen lds
  v_mfma_f32_16x16x32_bf16 v[116:119], a[92:95], v[32:35], v[116:119]
  s_waitcnt lgkmcnt(5)
  v_cvt_pk_bf16_f32 v140, v88, v89
  v_mul_f32 v90, s24, v90
  v_mfma_f32_16x16x32_bf16 v[104:107], a[80:83], v[36:39], v[104:107]
  ds_read_b128 v[28:31], v9 offset:49152
  v_mfma_f32_16x16x32_bf16 v[108:111], a[84:87], v[36:39], v[108:111]
  v_mul_f32 v91, s24, v91
  v_cvt_pk_bf16_f32 v141, v90, v91
  v_mfma_f32_16x16x32_bf16 v[120:123], a[88:91], v[36:39], v[120:123]
  v_mfma_f32_16x16x32_bf16 v[124:127], a[92:95], v[36:39], v[124:127]
  s_waitcnt lgkmcnt(5)
  v_mul_f32 v92, s24, v92
  v_mul_f32 v93, s24, v93
  v_mfma_f32_16x16x32_bf16 v[96:99], a[96:99], v[40:43], v[96:99]
  s_add_u32 m0, s25, 6144
  ds_read_b128 v[32:35], v10 offset:49152
  v_mfma_f32_16x16x32_bf16 v[100:103], a[100:103], v[40:43], v[100:103]
  v_cvt_pk_bf16_f32 v142, v92, v93
  v_mul_f32 v94, s24, v94
  v_mfma_f32_16x16x32_bf16 v[112:115], a[104:107], v[40:43], v[112:115]
  buffer_load_dwordx4 v22, s[12:15], s19 offen lds
  v_mfma_f32_16x16x32_bf16 v[116:119], a[108:111], v[40:43], v[116:119]
  s_waitcnt lgkmcnt(5)
  v_mul_f32 v95, s24, v95
  v_cvt_pk_bf16_f32 v143, v94, v95
  v_mfma_f32_16x16x32_bf16 v[104:107], a[96:99], v[44:47], v[104:107]
  ds_read_b128 v[36:39], v11 offset:49152
  v_mfma_f32_16x16x32_bf16 v[108:111], a[100:103], v[44:47], v[108:111]
  v_mfma_f32_16x16x32_bf16 v[120:123], a[104:107], v[44:47], v[120:123]
  v_mfma_f32_16x16x32_bf16 v[124:127], a[108:111], v[44:47], v[124:127]
  s_waitcnt lgkmcnt(5)
  v_mfma_f32_16x16x32_bf16 v[96:99], a[112:115], v[48:51], v[96:99]
  s_add_u32 m0, s25, 7168
  ds_read_b128 v[40:43], v12 offset:49152
  v_mfma_f32_16x16x32_bf16 v[100:103], a[116:119], v[48:51], v[100:103]
  v_mfma_f32_16x16x32_bf16 v[112:115], a[120:123], v[48:51], v[112:115]
  buffer_load_dwordx4 v23, s[12:15], s19 offen lds
  v_mfma_f32_16x16x32_bf16 v[116:119], a[124:127], v[48:51], v[116:119]
  s_waitcnt lgkmcnt(5)
  v_mfma_f32_16x16x32_bf16 v[104:107], a[112:115], v[52:55], v[104:107]
  s_cmp_gt_u32 s23, 3
  ds_read_b128 v[44:47], v13 offset:49152
  v_mfma_f32_16x16x32_bf16 v[108:111], a[116:119], v[52:55], v[108:111]
  v_mfma_f32_16x16x32_bf16 v[120:123], a[120:123], v[52:55], v[120:123]
  s_cselect_b32 s26, s20, 0
  v_mfma_f32_16x16x32_bf16 v[124:127], a[124:127], v[52:55], v[124:127]
  s_waitcnt lgkmcnt(5)
  v_mfma_f32_16x16x32_bf16 v[96:99], a[128:131], v[24:27], v[96:99]
  s_add_u32 s19, s19, s26
  ds_read_b128 v[48:51], v14 offset:49152
  v_mfma_f32_16x16x32_bf16 v[100:103], a[132:135], v[24:27], v[100:103]
  v_mfma_f32_16x16x32_bf16 v[112:115], a[136:139], v[24:27], v[112:115]
  s_add_u32 s25, s25, 32768
  v_mfma_f32_16x16x32_bf16 v[116:119], a[140:143], v[24:27], v[116:119]
  s_waitcnt lgkmcnt(5)
  v_mfma_f32_16x16x32_bf16 v[104:107], a[128:131], v[28:31], v[104:107]
  s_and_b32 s25, s25, 0x1ffff
  ds_read_b128 v[52:55], v15 offset:49152
  v_mfma_f32_16x16x32_bf16 v[108:111], a[132:135], v[28:31], v[108:111]
  v_mfma_f32_16x16x32_bf16 v[120:123], a[136:139], v[28:31], v[120:123]
  buffer_store_dwordx4 v[128:131], v7, s[4:7], s21 offen offset:0 sc1
  v_mfma_f32_16x16x32_bf16 v[124:127], a[140:143], v[28:31], v[124:127]
  s_waitcnt lgkmcnt(5)
  v_mfma_f32_16x16x32_bf16 v[96:99], a[144:147], v[32:35], v[96:99]
  ds_read_b128 v[24:27], v8 offset:57344
  v_mfma_f32_16x16x32_bf16 v[100:103], a[148:151], v[32:35], v[100:103]
  v_mfma_f32_16x16x32_bf16 v[112:115], a[152:155], v[32:35], v[112:115]
  v_mfma_f32_16x16x32_bf16 v[116:119], a[156:159], v[32:35], v[116:119]
  s_waitcnt lgkmcnt(5)
  v_xor_b32 v8, 0x10000, v8
  v_mfma_f32_16x16x32_bf16 v[104:107], a[144:147], v[36:39], v[104:107]
  ds_read_b128 v[28:31], v9 offset:57344
  v_mfma_f32_16x16x32_bf16 v[108:111], a[148:151], v[36:39], v[108:111]
  v_mfma_f32_16x16x32_bf16 v[120:123], a[152:155], v[36:39], v[120:123]
  buffer_store_dwordx4 v[132:135], v7, s[4:7], s21 offen offset:256 sc1
  v_mfma_f32_16x16x32_bf16 v[124:127], a[156:159], v[36:39], v[124:127]
  s_waitcnt lgkmcnt(5)
  v_xor_b32 v9, 0x10000, v9
  v_mfma_f32_16x16x32_bf16 v[96:99], a[160:163], v[40:43], v[96:99]
  ds_read_b128 v[32:35], v10 offset:57344
  v_mfma_f32_16x16x32_bf16 v[100:103], a[164:167], v[40:43], v[100:103]
  v_mfma_f32_16x16x32_bf16 v[112:115], a[168:171], v[40:43], v[112:115]
  v_mfma_f32_16x16x32_bf16 v[116:119], a[172:175], v[40:43], v[116:119]
  s_waitcnt lgkmcnt(5)
  v_xor_b32 v10, 0x10000, v10
  v_mfma_f32_16x16x32_bf16 v[104:107], a[160:163], v[44:47], v[104:107]
  ds_read_b128 v[36:39], v11 offset:57344
  v_mfma_f32_16x16x32_bf16 v[108:111], a[164:167], v[44:47], v[108:111]
  v_mfma_f32_16x16x32_bf16 v[120:123], a[168:171], v[44:47], v[120:123]
  buffer_store_dwordx4 v[136:139], v7, s[4:7], s21 offen offset:2048 sc1
  v_mfma_f32_16x16x32_bf16 v[124:127], a[172:175], v[44:47], v[124:127]
  s_waitcnt lgkmcnt(5)
  v_xor_b32 v11, 0x10000, v11
  v_mfma_f32_16x16x32_bf16 v[96:99], a[176:179], v[48:51], v[96:99]
  ds_read_b128 v[40:43], v12 offset:57344
  v_mfma_f32_16x16x32_bf16 v[100:103], a[180:183], v[48:51], v[100:103]
  v_mfma_f32_16x16x32_bf16 v[112:115], a[184:187], v[48:51], v[112:115]
  v_mfma_f32_16x16x32_bf16 v[116:119], a[188:191], v[48:51], v[116:119]
  s_waitcnt lgkmcnt(5)
  v_xor_b32 v12, 0x10000, v12
  v_mfma_f32_16x16x32_bf16 v[104:107], a[176:179], v[52:55], v[104:107]
  ds_read_b128 v[44:47], v13 offset:57344
  v_mfma_f32_16x16x32_bf16 v[108:111], a[180:183], v[52:55], v[108:111]
  v_mfma_f32_16x16x32_bf16 v[120:123], a[184:187], v[52:55], v[120:123]
  buffer_store_dwordx4 v[140:143], v7, s[4:7], s21 offen offset:2304 sc1
  v_mfma_f32_16x16x32_bf16 v[124:127], a[188:191], v[52:55], v[124:127]
  s_waitcnt lgkmcnt(5)
  v_xor_b32 v13, 0x10000, v13
  v_mfma_f32_16x16x32_bf16 v[96:99], a[192:195], v[24:27], v[96:99]
  s_mov_b32 s21, s27
  ds_read_b128 v[48:51], v14 offset:57344
  v_mfma_f32_16x16x32_bf16 v[100:103], a[196:199], v[24:27], v[100:103]
  v_mov_b32 v7, v56
  v_mfma_f32_16x16x32_bf16 v[112:115], a[200:203], v[24:27], v[112:115]
  v_mfma_f32_16x16x32_bf16 v[116:119], a[204:207], v[24:27], v[116:119]
  s_waitcnt lgkmcnt(5)
  v_xor_b32 v14, 0x10000, v14
  v_mfma_f32_16x16x32_bf16 v[104:107], a[192:195], v[28:31], v[104:107]
  s_add_u32 s27, s27, s22
  ds_read_b128 v[52:55], v15 offset:57344
  v_mfma_f32_16x16x32_bf16 v[108:111], a[196:199], v[28:31], v[108:111]
  v_mfma_f32_16x16x32_bf16 v[120:123], a[200:203], v[28:31], v[120:123]
  s_waitcnt vmcnt(13)
  s_barrier
  v_mfma_f32_16x16x32_bf16 v[124:127], a[204:207], v[28:31], v[124:127]
  s_waitcnt lgkmcnt(5)
  v_xor_b32 v15, 0x10000, v15
  v_mfma_f32_16x16x32_bf16 v[96:99], a[208:211], v[32:35], v[96:99]
  ds_read_b128 v[24:27], v8 offset:0
  v_mfma_f32_16x16x32_bf16 v[100:103], a[212:215], v[32:35], v[100:103]
  v_mfma_f32_16x16x32_bf16 v[112:115], a[216:219], v[32:35], v[112:115]
  v_mfma_f32_16x16x32_bf16 v[116:119], a[220:223], v[32:35], v[116:119]
  s_waitcnt lgkmcnt(5)
  v_mfma_f32_16x16x32_bf16 v[104:107], a[208:211], v[36:39], v[104:107]
  s_add_u32 s29, s29, 1
  ds_read_b128 v[28:31], v9 offset:0
  v_mfma_f32_16x16x32_bf16 v[108:111], a[212:215], v[36:39], v[108:111]
  v_mfma_f32_16x16x32_bf16 v[120:123], a[216:219], v[36:39], v[120:123]
  s_max_i32 s30, s29, 0
  v_mfma_f32_16x16x32_bf16 v[124:127], a[220:223], v[36:39], v[124:127]
  s_waitcnt lgkmcnt(5)
  v_mov_b32 v144, s30
  v_mfma_f32_16x16x32_bf16 v[96:99], a[224:227], v[40:43], v[96:99]
  ds_read_b128 v[32:35], v10 offset:0
  v_mfma_f32_16x16x32_bf16 v[100:103], a[228:231], v[40:43], v[100:103]
  v_mfma_f32_16x16x32_bf16 v[112:115], a[232:235], v[40:43], v[112:115]
  buffer_store_dword v144, v145, s[4:7], s31 offen sc1
  v_mfma_f32_16x16x32_bf16 v[116:119], a[236:239], v[40:43], v[116:119]
  s_waitcnt lgkmcnt(5)
  v_mfma_f32_16x16x32_bf16 v[104:107], a[224:227], v[44:47], v[104:107]
  ds_read_b128 v[36:39], v11 offset:0
  v_mfma_f32_16x16x32_bf16 v[108:111], a[228:231], v[44:47], v[108:111]
  v_mfma_f32_16x16x32_bf16 v[120:123], a[232:235], v[44:47], v[120:123]
  v_mfma_f32_16x16x32_bf16 v[124:127], a[236:239], v[44:47], v[124:127]
  s_waitcnt lgkmcnt(5)
  v_mfma_f32_16x16x32_bf16 v[96:99], a[240:243], v[48:51], v[96:99]
  s_sub_u32 s23, s23, 1
  ds_read_b128 v[40:43], v12 offset:0
  v_mfma_f32_16x16x32_bf16 v[100:103], a[244:247], v[48:51], v[100:103]
  v_mfma_f32_16x16x32_bf16 v[112:115], a[248:251], v[48:51], v[112:115]
  v_mfma_f32_16x16x32_bf16 v[116:119], a[252:255], v[48:51], v[116:119]
  s_waitcnt lgkmcnt(5)
  v_mfma_f32_16x16x32_bf16 v[104:107], a[240:243], v[52:55], v[104:107]
  s_cmp_eq_u32 s23, 0
  ds_read_b128 v[44:47], v13 offset:0
  v_mfma_f32_16x16x32_bf16 v[108:111], a[244:247], v[52:55], v[108:111]
  v_mfma_f32_16x16x32_bf16 v[120:123], a[248:251], v[52:55], v[120:123]
  v_mfma_f32_16x16x32_bf16 v[124:127], a[252:255], v[52:55], v[124:127]
  s_cbranch_scc1 G_done1_10
  s_branch G_top_8
G_done0_9:
  s_nop 7
  s_nop 3
  v_mul_f32 v64, s24, v64
  v_mul_f32 v65, s24, v65
  v_cvt_pk_bf16_f32 v128, v64, v65
  v_mul_f32 v66, s24, v66
  v_mul_f32 v67, s24, v67
  v_cvt_pk_bf16_f32 v129, v66, v67
  v_mul_f32 v68, s24, v68
  v_mul_f32 v69, s24, v69
  v_cvt_pk_bf16_f32 v130, v68, v69
  v_mul_f32 v70, s24, v70
  v_mul_f32 v71, s24, v71
  v_cvt_pk_bf16_f32 v131, v70, v71
  buffer_store_dwordx4 v[128:131], v7, s[4:7], s21 offen offset:0 sc1
  v_mul_f32 v72, s24, v72
  v_mul_f32 v73, s24, v73
  v_cvt_pk_bf16_f32 v132, v72, v73
  v_mul_f32 v74, s24, v74
  v_mul_f32 v75, s24, v75
  v_cvt_pk_bf16_f32 v133, v74, v75
  v_mul_f32 v76, s24, v76
  v_mul_f32 v77, s24, v77
  v_cvt_pk_bf16_f32 v134, v76, v77
  v_mul_f32 v78, s24, v78
  v_mul_f32 v79, s24, v79
  v_cvt_pk_bf16_f32 v135, v78, v79
  buffer_store_dwordx4 v[132:135], v7, s[4:7], s21 offen offset:256 sc1
  v_mul_f32 v80, s24, v80
  v_mul_f32 v81, s24, v81
  v_cvt_pk_bf16_f32 v136, v80, v81
  v_mul_f32 v82, s24, v82
  v_mul_f32 v83, s24, v83
  v_cvt_pk_bf16_f32 v137, v82, v83
  v_mul_f32 v84, s24, v84
  v_mul_f32 v85, s24, v85
  v_cvt_pk_bf16_f32 v138, v84, v85
  v_mul_f32 v86, s24, v86
  v_mul_f32 v87, s24, v87
  v_cvt_pk_bf16_f32 v139, v86, v87
  buffer_store_dwordx4 v[136:139], v7, s[4:7], s21 offen offset:2048 sc1
  v_mul_f32 v88, s24, v88
  v_mul_f32 v89, s24, v89
  v_cvt_pk_bf16_f32 v140, v88, v89
  v_mul_f32 v90, s24, v90
  v_mul_f32 v91, s24, v91
  v_cvt_pk_bf16_f32 v141, v90, v91
  v_mul_f32 v92, s24, v92
  v_mul_f32 v93, s24, v93
  v_cvt_pk_bf16_f32 v142, v92, v93
  v_mul_f32 v94, s24, v94
  v_mul_f32 v95, s24, v95
  v_cvt_pk_bf16_f32 v143, v94, v95
  buffer_store_dwordx4 v[140:143], v7, s[4:7], s21 offen offset:2304 sc1
  s_branch G_fin_11
G_done1_10:
  s_nop 7
  s_nop 3
  v_mul_f32 v96, s24, v96
  v_mul_f32 v97, s24, v97
  v_cvt_pk_bf16_f32 v128, v96, v97
  v_mul_f32 v98, s24, v98
  v_mul_f32 v99, s24, v99
  v_cvt_pk_bf16_f32 v129, v98, v99
  v_mul_f32 v100, s24, v100
  v_mul_f32 v101, s24, v101
  v_cvt_pk_bf16_f32 v130, v100, v101
  v_mul_f32 v102, s24, v102
  v_mul_f32 v103, s24, v103
  v_cvt_pk_bf16_f32 v131, v102, v103
  buffer_store_dwordx4 v[128:131], v7, s[4:7], s21 offen offset:0 sc1
  v_mul_f32 v104, s24, v104
  v_mul_f32 v105, s24, v105
  v_cvt_pk_bf16_f32 v132, v104, v105
  v_mul_f32 v106, s24, v106
  v_mul_f32 v107, s24, v107
  v_cvt_pk_bf16_f32 v133, v106, v107
  v_mul_f32 v108, s24, v108
  v_mul_f32 v109, s24, v109
  v_cvt_pk_bf16_f32 v134, v108, v109
  v_mul_f32 v110, s24, v110
  v_mul_f32 v111, s24, v111
  v_cvt_pk_bf16_f32 v135, v110, v111
  buffer_store_dwordx4 v[132:135], v7, s[4:7], s21 offen offset:256 sc1
  v_mul_f32 v112, s24, v112
  v_mul_f32 v113, s24, v113
  v_cvt_pk_bf16_f32 v136, v112, v113
  v_mul_f32 v114, s24, v114
  v_mul_f32 v115, s24, v115
  v_cvt_pk_bf16_f32 v137, v114, v115
  v_mul_f32 v116, s24, v116
  v_mul_f32 v117, s24, v117
  v_cvt_pk_bf16_f32 v138, v116, v117
  v_mul_f32 v118, s24, v118
  v_mul_f32 v119, s24, v119
  v_cvt_pk_bf16_f32 v139, v118, v119
  buffer_store_dwordx4 v[136:139], v7, s[4:7], s21 offen offset:2048 sc1
  v_mul_f32 v120, s24, v120
  v_mul_f32 v121, s24, v121
  v_cvt_pk_bf16_f32 v140, v120, v121
  v_mul_f32 v122, s24, v122
  v_mul_f32 v123, s24, v123
  v_cvt_pk_bf16_f32 v141, v122, v123
  v_mul_f32 v124, s24, v124
  v_mul_f32 v125, s24, v125
  v_cvt_pk_bf16_f32 v142, v124, v125
  v_mul_f32 v126, s24, v126
  v_mul_f32 v127, s24, v127
  v_cvt_pk_bf16_f32 v143, v126, v127
  buffer_store_dwordx4 v[140:143], v7, s[4:7], s21 offen offset:2304 sc1
G_fin_11:
  s_waitcnt vmcnt(0) lgkmcnt(0)
  s_barrier
  s_add_u32 s30, s29, 2
  v_mov_b32 v144, s30
  v_min_u32 v145, 1, v0
  v_lshlrev_b32 v145, 30, v145
  buffer_store_dword v144, v145, s[4:7], s31 offen sc1
  s_branch P_end_2
P_v_1:
  s_mov_b32 s27, s21
  v_mov_b32 v7, 0x40000000
  s_mov_b32 s29, -2
  v_min_u32 v145, 1, v0
  v_lshlrev_b32 v145, 30, v145
  ds_read_b128 v[24:27], v8 offset:0
  ds_read_b128 v[28:31], v9 offset:0
  ds_read_b128 v[32:35], v10 offset:0
  ds_read_b128 v[36:39], v11 offset:0
  ds_read_b128 v[40:43], v12 offset:0
  ds_read_b128 v[44:47], v13 offset:0
.p2align 6
G_top_12:
  s_waitcnt lgkmcnt(5)
  v_mfma_f32_16x16x32_bf16 v[64:67], v[24:27], a[0:3], 0
  s_add_u32 m0, s25, 0
  ds_read_b128 v[48:51], v14 offset:0
  v_mfma_f32_16x16x32_bf16 v[72:75], v[24:27], a[4:7], 0
  v_mfma_f32_16x16x32_bf16 v[80:83], v[24:27], a[8:11], 0
  buffer_load_dwordx4 v16, s[12:15], s19 offen lds
  v_mfma_f32_16x16x32_bf16 v[88:91], v[24:27], a[12:15], 0
  s_waitcnt lgkmcnt(5)
  v_mfma_f32_16x16x32_bf16 v[68:71], v[28:31], a[0:3], 0
  ds_read_b128 v[52:55], v15 offset:0
  v_mfma_f32_16x16x32_bf16 v[76:79], v[28:31], a[4:7], 0
  v_cvt_pk_bf16_f32 v128, v96, v97
  v_cvt_pk_bf16_f32 v129, v98, v99
  v_mfma_f32_16x16x32_bf16 v[84:87], v[28:31], a[8:11], 0
  v_mfma_f32_16x16x32_bf16 v[92:95], v[28:31], a[12:15], 0
  s_waitcnt lgkmcnt(5)
  v_cvt_pk_bf16_f32 v130, v100, v101
  v_cvt_pk_bf16_f32 v131, v102, v103
  v_mfma_f32_16x16x32_bf16 v[64:67], v[32:35], a[16:19], v[64:67]
  s_add_u32 m0, s25, 1024
  ds_read_b128 v[24:27], v8 offset:8192
  v_mfma_f32_16x16x32_bf16 v[72:75], v[32:35], a[20:23], v[72:75]
  v_mfma_f32_16x16x32_bf16 v[80:83], v[32:35], a[24:27], v[80:83]
  buffer_load_dwordx4 v17, s[12:15], s19 offen lds
  v_mfma_f32_16x16x32_bf16 v[88:91], v[32:35], a[28:31], v[88:91]
  s_waitcnt lgkmcnt(5)
  v_mfma_f32_16x16x32_bf16 v[68:71], v[36:39], a[16:19], v[68:71]
  ds_read_b128 v[28:31], v9 offset:8192
  v_mfma_f32_16x16x32_bf16 v[76:79], v[36:39], a[20:23], v[76:79]
  v_mfma_f32_16x16x32_bf16 v[84:87], v[36:39], a[24:27], v[84:87]
  v_mfma_f32_16x16x32_bf16 v[92:95], v[36:39], a[28:31], v[92:95]
  s_waitcnt lgkmcnt(5)
  v_mfma_f32_16x16x32_bf16 v[64:67], v[40:43], a[32:35], v[64:67]
  s_add_u32 m0, s25, 2048
  ds_read_b128 v[32:35], v10 offset:8192
  v_mfma_f32_16x16x32_bf16 v[72:75], v[40:43], a[36:39], v[72:75]
  v_cvt_pk_bf16_f32 v132, v104, v105
  v_cvt_pk_bf16_f32 v133, v106, v107
  v_mfma_f32_16x16x32_bf16 v[80:83], v[40:43], a[40:43], v[80:83]
  buffer_load_dwordx4 v18, s[12:15], s19 offen lds
  v_mfma_f32_16x16x32_bf16 v[88:91], v[40:43], a[44:47], v[88:91]
  s_waitcnt lgkmcnt(5)
  v_cvt_pk_bf16_f32 v134, v108, v109
  v_cvt_pk_bf16_f32 v135, v110, v111
  v_mfma_f32_16x16x32_bf16 v[68:71], v[44:47], a[32:35], v[68:71]
  ds_read_b128 v[36:39], v11 offset:8192
  v_mfma_f32_16x16x32_bf16 v[76:79], v[44:47], a[36:39], v[76:79]
  v_mfma_f32_16x16x32_bf16 v[84:87], v[44:47], a[40:43], v[84:87]
  v_mfma_f32_16x16x32_bf16 v[92:95], v[44:47], a[44:47], v[92:95]
  s_waitcnt lgkmcnt(5)
  v_mfma_f32_16x16x32_bf16 v[64:67], v[48:51], a[48:51], v[64:67]
  s_add_u32 m0, s25, 3072
  ds_read_b128 v[40:43], v12 offset:8192
  v_mfma_f32_16x16x32_bf16 v[72:75], v[48:51], a[52:55], v[72:75]
  v_mfma_f32_16x16x32_bf16 v[80:83], v[48:51], a[56:59], v[80:83]
  buffer_load_dwordx4 v19, s[12:15], s19 offen lds
  v_mfma_f32_16x16x32_bf16 v[88:91], v[48:51], a[60:63], v[88:91]
  s_waitcnt lgkmcnt(5)
  v_mfma_f32_16x16x32_bf16 v[68:71], v[52:55], a[48:51], v[68:71]
  ds_read_b128 v[44:47], v13 offset:8192
  v_mfma_f32_16x16x32_bf16 v[76:79], v[52:55], a[52:55], v[76:79]
  v_cvt_pk_bf16_f32 v136, v112, v113
  v_cvt_pk_bf16_f32 v137, v114, v115
  v_mfma_f32_16x16x32_bf16 v[84:87], v[52:55], a[56:59], v[84:87]
  v_mfma_f32_16x16x32_bf16 v[92:95], v[52:55], a[60:63], v[92:95]
  s_waitcnt lgkmcnt(5)
  v_cvt_pk_bf16_f32 v138, v116, v117
  v_cvt_pk_bf16_f32 v139, v118, v119
  v_mfma_f32_16x16x32_bf16 v[64:67], v[24:27], a[64:67], v[64:67]
  s_add_u32 m0, s25, 4096
  ds_read_b128 v[48:51], v14 offset:8192
  v_mfma_f32_16x16x32_bf16 v[72:75], v[24:27], a[68:71], v[72:75]
  v_mfma_f32_16x16x32_bf16 v[80:83], v[24:27], a[72:75], v[80:83]
  buffer_load_dwordx4 v20, s[12:15], s19 offen lds
  v_mfma_f32_16x16x32_bf16 v[88:91], v[24:27], a[76:79], v[88:91]
  s_waitcnt lgkmcnt(5)
  v_mfma_f32_16x16x32_bf16 v[68:71], v[28:31], a[64:67], v[68:71]
  ds_read_b128 v[52:55], v15 offset:8192
  v_mfma_f32_16x16x32_bf16 v[76:79], v[28:31], a[68:71], v[76:79]
  v_mfma_f32_16x16x32_bf16 v[84:87], v[28:31], a[72:75], v[84:87]
  v_mfma_f32_16x16x32_bf16 v[92:95], v[28:31], a[76:79], v[92:95]
  s_waitcnt lgkmcnt(5)
  v_mfma_f32_16x16x32_bf16 v[64:67], v[32:35], a[80:83], v[64:67]
  s_add_u32 m0, s25, 5120
  ds_read_b128 v[24:27], v8 offset:16384
  v_mfma_f32_16x16x32_bf16 v[72:75], v[32:35], a[84:87], v[72:75]
  v_cvt_pk_bf16_f32 v140, v120, v121
  v_cvt_pk_bf16_f32 v141, v122, v123
  v_mfma_f32_16x16x32_bf16 v[80:83], v[32:35], a[88:91], v[80:83]
  buffer_load_dwordx4 v21, s[12:15], s19 offen lds
  v_mfma_f32_16x16x32_bf16 v[88:91], v[32:35], a[92:95], v[88:91]
  s_waitcnt lgkmcnt(5)
  v_cvt_pk_bf16_f32 v142, v124, v125
  v_cvt_pk_bf16_f32 v143, v126, v127
  v_mfma_f32_16x16x32_bf16 v[68:71], v[36:39], a[80:83], v[68:71]
  ds_read_b128 v[28:31], v9 offset:16384
  v_mfma_f32_16x16x32_bf16 v[76:79], v[36:39], a[84:87], v[76:79]
  v_mfma_f32_16x16x32_bf16 v[84:87], v[36:39], a[88:91], v[84:87]
  v_mfma_f32_16x16x32_bf16 v[92:95], v[36:39], a[92:95], v[92:95]
  s_waitcnt lgkmcnt(5)
  v_mfma_f32_16x16x32_bf16 v[64:67], v[40:43], a[96:99], v[64:67]
  s_add_u32 m0, s25, 6144
  ds_read_b128 v[32:35], v10 offset:16384
  v_mfma_f32_16x16x32_bf16 v[72:75], v[40:43], a[100:103], v[72:75]
  v_mfma_f32_16x16x32_bf16 v[80:83], v[40:43], a[104:107], v[80:83]
  buffer_load_dwordx4 v22, s[12:15], s19 offen lds
  v_mfma_f32_16x16x32_bf16 v[88:91], v[40:43], a[108:111], v[88:91]
  s_waitcnt lgkmcnt(5)
  v_mfma_f32_16x16x32_bf16 v[68:71], v[44:47], a[96:99], v[68:71]
  ds_read_b128 v[36:39], v11 offset:16384
  v_mfma_f32_16x16x32_bf16 v[76:79], v[44:47], a[100:103], v[76:79]
  v_mfma_f32_16x16x32_bf16 v[84:87], v[44:47], a[104:107], v[84:87]
  v_mfma_f32_16x16x32_bf16 v[92:95], v[44:47], a[108:111], v[92:95]
  s_waitcnt lgkmcnt(5)
  v_mfma_f32_16x16x32_bf16 v[64:67], v[48:51], a[112:115], v[64:67]
  s_add_u32 m0, s25, 7168
  ds_read_b128 v[40:43], v12 offset:16384
  v_mfma_f32_16x16x32_bf16 v[72:75], v[48:51], a[116:119], v[72:75]
  v_mfma_f32_16x16x32_bf16 v[80:83], v[48:51], a[120:123], v[80:83]
  buffer_load_dwordx4 v23, s[12:15], s19 offen lds
  v_mfma_f32_16x16x32_bf16 v[88:91], v[48:51], a[124:127], v[88:91]
  s_waitcnt lgkmcnt(5)
  v_mfma_f32_16x16x32_bf16 v[68:71], v[52:55], a[112:115], v[68:71]
  s_cmp_gt_u32 s23, 3
  ds_read_b128 v[44:47], v13 offset:16384
  v_mfma_f32_16x16x32_bf16 v[76:79], v[52:55], a[116:119], v[76:79]
  v_mfma_f32_16x16x32_bf16 v[84:87], v[52:55], a[120:123], v[84:87]
  s_cselect_b32 s26, s20, 0
  v_mfma_f32_16x16x32_bf16 v[92:95], v[52:55], a[124:127], v[92:95]
  s_waitcnt lgkmcnt(5)
  v_mfma_f32_16x16x32_bf16 v[64:67], v[24:27], a[128:131], v[64:67]
  s_add_u32 s19, s19, s26
  ds_read_b128 v[48:51], v14 offset:16384
  v_mfma_f32_16x16x32_bf16 v[72:75], v[24:27], a[132:135], v[72:75]
  v_mfma_f32_16x16x32_bf16 v[80:83], v[24:27], a[136:139], v[80:83]
  s_add_u32 s25, s25, 32768
  v_mfma_f32_16x16x32_bf16 v[88:91], v[24:27], a[140:143], v[88:91]
  s_waitcnt lgkmcnt(5)
  v_mfma_f32_16x16x32_bf16 v[68:71], v[28:31], a[128:131], v[68:71]
  s_and_b32 s25, s25, 0x1ffff
  ds_read_b128 v[52:55], v15 offset:16384
  v_mfma_f32_16x16x32_bf16 v[76:79], v[28:31], a[132:135], v[76:79]
  v_mfma_f32_16x16x32_bf16 v[84:87], v[28:31], a[136:139], v[84:87]
  buffer_store_dwordx4 v[128:131], v7, s[4:7], s21 offen offset:0 sc1
  v_mfma_f32_16x16x32_bf16 v[92:95], v[28:31], a[140:143], v[92:95]
  s_waitcnt lgkmcnt(5)
  v_mfma_f32_16x16x32_bf16 v[64:67], v[32:35], a[144:147], v[64:67]
  ds_read_b128 v[24:27], v8 offset:24576
  v_mfma_f32_16x16x32_bf16 v[72:75], v[32:35], a[148:151], v[72:75]
  v_mfma_f32_16x16x32_bf16 v[80:83], v[32:35], a[152:155], v[80:83]
  v_mfma_f32_16x16x32_bf16 v[88:91], v[32:35], a[156:159], v[88:91]
  s_waitcnt lgkmcnt(5)
  v_mfma_f32_16x16x32_bf16 v[68:71], v[36:39], a[144:147], v[68:71]
  ds_read_b128 v[28:31], v9 offset:24576
  v_mfma_f32_16x16x32_bf16 v[76:79], v[36:39], a[148:151], v[76:79]
  v_mfma_f32_16x16x32_bf16 v[84:87], v[36:39], a[152:155], v[84:87]
  buffer_store_dwordx4 v[132:135], v7, s[4:7], s21 offen offset:256 sc1
  v_mfma_f32_16x16x32_bf16 v[92:95], v[36:39], a[156:159], v[92:95]
  s_waitcnt lgkmcnt(5)
  v_mfma_f32_16x16x32_bf16 v[64:67], v[40:43], a[160:163], v[64:67]
  ds_read_b128 v[32:35], v10 offset:24576
  v_mfma_f32_16x16x32_bf16 v[72:75], v[40:43], a[164:167], v[72:75]
  v_mfma_f32_16x16x32_bf16 v[80:83], v[40:43], a[168:171], v[80:83]
  v_mfma_f32_16x16x32_bf16 v[88:91], v[40:43], a[172:175], v[88:91]
  s_waitcnt lgkmcnt(5)
  v_mfma_f32_16x16x32_bf16 v[68:71], v[44:47], a[160:163], v[68:71]
  ds_read_b128 v[36:39], v11 offset:24576
  v_mfma_f32_16x16x32_bf16 v[76:79], v[44:47], a[164:167], v[76:79]
  v_mfma_f32_16x16x32_bf16 v[84:87], v[44:47], a[168:171], v[84:87]
  buffer_store_dwordx4 v[136:139], v7, s[4:7], s21 offen offset:2048 sc1
  v_mfma_f32_16x16x32_bf16 v[92:95], v[44:47], a[172:175], v[92:95]
  s_waitcnt lgkmcnt(5)
  v_mfma_f32_16x16x32_bf16 v[64:67], v[48:51], a[176:179], v[64:67]
  ds_read_b128 v[40:43], v12 offset:24576
  v_mfma_f32_16x16x32_bf16 v[72:75], v[48:51], a[180:183], v[72:75]
  v_mfma_f32_16x16x32_bf16 v[80:83], v[48:51], a[184:187], v[80:83]
  v_mfma_f32_16x16x32_bf16 v[88:91], v[48:51], a[188:191], v[88:91]
  s_waitcnt lgkmcnt(5)
  v_mfma_f32_16x16x32_bf16 v[68:71], v[52:55], a[176:179], v[68:71]
  ds_read_b128 v[44:47], v13 offset:24576
  v_mfma_f32_16x16x32_bf16 v[76:79], v[52:55], a[180:183], v[76:79]
  v_mfma_f32_16x16x32_bf16 v[84:87], v[52:55], a[184:187], v[84:87]
  buffer_store_dwordx4 v[140:143], v7, s[4:7], s21 offen offset:2304 sc1
  v_mfma_f32_16x16x32_bf16 v[92:95], v[52:55], a[188:191], v[92:95]
  s_waitcnt lgkmcnt(5)
  v_mfma_f32_16x16x32_bf16 v[64:67], v[24:27], a[192:195], v[64:67]
  s_mov_b32 s21, s27
  ds_read_b128 v[48:51], v14 offset:24576
  v_mfma_f32_16x16x32_bf16 v[72:75], v[24:27], a[196:199], v[72:75]
  v_mov_b32 v7, v56
  v_mfma_f32_16x16x32_bf16 v[80:83], v[24:27], a[200:203], v[80:83]
  v_mfma_f32_16x16x32_bf16 v[88:91], v[24:27], a[204:207], v[88:91]
  s_waitcnt lgkmcnt(5)
  v_mfma_f32_16x16x32_bf16 v[68:71], v[28:31], a[192:195], v[68:71]
  s_add_u32 s27, s27, s22
  ds_read_b128 v[52:55], v15 offset:24576
  v_mfma_f32_16x16x32_bf16 v[76:79], v[28:31], a[196:199], v[76:79]
  v_mfma_f32_16x16x32_bf16 v[84:87], v[28:31], a[200:203], v[84:87]
  s_waitcnt vmcnt(13)
  s_barrier
  v_mfma_f32_16x16x32_bf16 v[92:95], v[28:31], a[204:207], v[92:95]
  s_waitcnt lgkmcnt(5)
  v_mfma_f32_16x16x32_bf16 v[64:67], v[32:35], a[208:211], v[64:67]
  ds_read_b128 v[24:27], v8 offset:32768
  v_mfma_f32_16x16x32_bf16 v[72:75], v[32:35], a[212:215], v[72:75]
  v_mfma_f32_16x16x32_bf16 v[80:83], v[32:35], a[216:219], v[80:83]
  v_mfma_f32_16x16x32_bf16 v[88:91], v[32:35], a[220:223], v[88:91]
  s_waitcnt lgkmcnt(5)
  v_mfma_f32_16x16x32_bf16 v[68:71], v[36:39], a[208:211], v[68:71]
  s_add_u32 s29, s29, 1
  ds_read_b128 v[28:31], v9 offset:32768
  v_mfma_f32_16x16x32_bf16 v[76:79], v[36:39], a[212:215], v[76:79]
  v_mfma_f32_16x16x32_bf16 v[84:87], v[36:39], a[216:219], v[84:87]
  s_max_i32 s30, s29, 0
  v_mfma_f32_16x16x32_bf16 v[92:95], v[36:39], a[220:223], v[92:95]
  s_waitcnt lgkmcnt(5)
  v_mov_b32 v144, s30
  v_mfma_f32_16x16x32_bf16 v[64:67], v[40:43], a[224:227], v[64:67]
  ds_read_b128 v[32:35], v10 offset:32768
  v_mfma_f32_16x16x32_bf16 v[72:75], v[40:43], a[228:231], v[72:75]
  v_mfma_f32_16x16x32_bf16 v[80:83], v[40:43], a[232:235], v[80:83]
  buffer_store_dword v144, v145, s[4:7], s31 offen sc1
  v_mfma_f32_16x16x32_bf16 v[88:91], v[40:43], a[236:239], v[88:91]
  s_waitcnt lgkmcnt(5)
  v_mfma_f32_16x16x32_bf16 v[68:71], v[44:47], a[224:227], v[68:71]
  ds_read_b128 v[36:39], v11 offset:32768
  v_mfma_f32_16x16x32_bf16 v[76:79], v[44:47], a[228:231], v[76:79]
  v_mfma_f32_16x16x32_bf16 v[84:87], v[44:47], a[232:235], v[84:87]
  v_mfma_f32_16x16x32_bf16 v[92:95], v[44:47], a[236:239], v[92:95]
  s_waitcnt lgkmcnt(5)
  v_mfma_f32_16x16x32_bf16 v[64:67], v[48:51], a[240:243], v[64:67]
  s_sub_u32 s23, s23, 1
  ds_read_b128 v[40:43], v12 offset:32768
  v_mfma_f32_16x16x32_bf16 v[72:75], v[48:51], a[244:247], v[72:75]
  v_mfma_f32_16x16x32_bf16 v[80:83], v[48:51], a[248:251], v[80:83]
  v_mfma_f32_16x16x32_bf16 v[88:91], v[48:51], a[252:255], v[88:91]
  s_waitcnt lgkmcnt(5)
  v_mfma_f32_16x16x32_bf16 v[68:71], v[52:55], a[240:243], v[68:71]
  s_cmp_eq_u32 s23, 0
  ds_read_b128 v[44:47], v13 offset:32768
  v_mfma_f32_16x16x32_bf16 v[76:79], v[52:55], a[244:247], v[76:79]
  v_mfma_f32_16x16x32_bf16 v[84:87], v[52:55], a[248:251], v[84:87]
  v_mfma_f32_16x16x32_bf16 v[92:95], v[52:55], a[252:255], v[92:95]
  s_cbranch_scc1 G_done0_13
  s_waitcnt lgkmcnt(5)
  v_mfma_f32_16x16x32_bf16 v[96:99], v[24:27], a[0:3], 0
  s_add_u32 m0, s25, 0
  ds_read_b128 v[48:51], v14 offset:32768
  v_mfma_f32_16x16x32_bf16 v[104:107], v[24:27], a[4:7], 0
  v_mfma_f32_16x16x32_bf16 v[112:115], v[24:27], a[8:11], 0
  buffer_load_dwordx4 v16, s[12:15], s19 offen lds
  v_mfma_f32_16x16x32_bf16 v[120:123], v[24:27], a[12:15], 0
  s_waitcnt lgkmcnt(5)
  v_mfma_f32_16x16x32_bf16 v[100:103], v[28:31], a[0:3], 0
  ds_read_b128 v[52:55], v15 offset:32768
  v_mfma_f32_16x16x32_bf16 v[108:111], v[28:31], a[4:7], 0
  v_cvt_pk_bf16_f32 v128, v64, v65
  v_cvt_pk_bf16_f32 v129, v66, v67
  v_mfma_f32_16x16x32_bf16 v[116:119], v[28:31], a[8:11], 0
  v_mfma_f32_16x16x32_bf16 v[124:127], v[28:31], a[12:15], 0
  s_waitcnt lgkmcnt(5)
  v_cvt_pk_bf16_f32 v130, v68, v69
  v_cvt_pk_bf16_f32 v131, v70, v71
  v_mfma_f32_16x16x32_bf16 v[96:99], v[32:35], a[16:19], v[96:99]
  s_add_u32 m0, s25, 1024
  ds_read_b128 v[24:27], v8 offset:40960
  v_mfma_f32_16x16x32_bf16 v[104:107], v[32:35], a[20:23], v[104:107]
  v_mfma_f32_16x16x32_bf16 v[112:115], v[32:35], a[24:27], v[112:115]
  buffer_load_dwordx4 v17, s[12:15], s19 offen lds
  v_mfma_f32_16x16x32_bf16 v[120:123], v[32:35], a[28:31], v[120:123]
  s_waitcnt lgkmcnt(5)
  v_mfma_f32_16x16x32_bf16 v[100:103], v[36:39], a[16:19], v[100:103]
  ds_read_b128 v[28:31], v9 offset:40960
  v_mfma_f32_16x16x32_bf16 v[108:111], v[36:39], a[20:23], v[108:111]
  v_mfma_f32_16x16x32_bf16 v[116:119], v[36:39], a[24:27], v[116:119]
  v_mfma_f32_16x16x32_bf16 v[124:127], v[36:39], a[28:31], v[124:127]
  s_waitcnt lgkmcnt(5)
  v_mfma_f32_16x16x32_bf16 v[96:99], v[40:43], a[32:35], v[96:99]
  s_add_u32 m0, s25, 2048
  ds_read_b128 v[32:35], v10 offset:40960
  v_mfma_f32_16x16x32_bf16 v[104:107], v[40:43], a[36:39], v[104:107]
  v_cvt_pk_bf16_f32 v132, v72, v73
  v_cvt_pk_bf16_f32 v133, v74, v75
  v_mfma_f32_16x16x32_bf16 v[112:115], v[40:43], a[40:43], v[112:115]
  buffer_load_dwordx4 v18, s[12:15], s19 offen lds
  v_mfma_f32_16x16x32_bf16 v[120:123], v[40:43], a[44:47], v[120:123]
  s_waitcnt lgkmcnt(5)
  v_cvt_pk_bf16_f32 v134, v76, v77
  v_cvt_pk_bf16_f32 v135, v78, v79
  v_mfma_f32_16x16x32_bf16 v[100:103], v[44:47], a[32:35], v[100:103]
  ds_read_b128 v[36:39], v11 offset:40960
  v_mfma_f32_16x16x32_bf16 v[108:111], v[44:47], a[36:39], v[108:111]
  v_mfma_f32_16x16x32_bf16 v[116:119], v[44:47], a[40:43], v[116:119]
  v_mfma_f32_16x16x32_bf16 v[124:127], v[44:47], a[44:47], v[124:127]
  s_waitcnt lgkmcnt(5)
  v_mfma_f32_16x16x32_bf16 v[96:99], v[48:51], a[48:51], v[96:99]
  s_add_u32 m0, s25, 3072
  ds_read_b128 v[40:43], v12 offset:40960
  v_mfma_f32_16x16x32_bf16 v[104:107], v[48:51], a[52:55], v[104:107]
  v_mfma_f32_16x16x32_bf16 v[112:115], v[48:51], a[56:59], v[112:115]
  buffer_load_dwordx4 v19, s[12:15], s19 offen lds
  v_mfma_f32_16x16x32_bf16 v[120:123], v[48:51], a[60:63], v[120:123]
  s_waitcnt lgkmcnt(5)
  v_mfma_f32_16x16x32_bf16 v[100:103], v[52:55], a[48:51], v[100:103]
  ds_read_b128 v[44:47], v13 offset:40960
  v_mfma_f32_16x16x32_bf16 v[108:111], v[52:55], a[52:55], v[108:111]
  v_cvt_pk_bf16_f32 v136, v80, v81
  v_cvt_pk_bf16_f32 v137, v82, v83
  v_mfma_f32_16x16x32_bf16 v[116:119], v[52:55], a[56:59], v[116:119]
  v_mfma_f32_16x16x32_bf16 v[124:127], v[52:55], a[60:63], v[124:127]
  s_waitcnt lgkmcnt(5)
  v_cvt_pk_bf16_f32 v138, v84, v85
  v_cvt_pk_bf16_f32 v139, v86, v87
  v_mfma_f32_16x16x32_bf16 v[96:99], v[24:27], a[64:67], v[96:99]
  s_add_u32 m0, s25, 4096
  ds_read_b128 v[48:51], v14 offset:40960
  v_mfma_f32_16x16x32_bf16 v[104:107], v[24:27], a[68:71], v[104:107]
  v_mfma_f32_16x16x32_bf16 v[112:115], v[24:27], a[72:75], v[112:115]
  buffer_load_dwordx4 v20, s[12:15], s19 offen lds
  v_mfma_f32_16x16x32_bf16 v[120:123], v[24:27], a[76:79], v[120:123]
  s_waitcnt lgkmcnt(5)
  v_mfma_f32_16x16x32_bf16 v[100:103], v[28:31], a[64:67], v[100:103]
  ds_read_b128 v[52:55], v15 offset:40960
  v_mfma_f32_16x16x32_bf16 v[108:111], v[28:31], a[68:71], v[108:111]
  v_mfma_f32_16x16x32_bf16 v[116:119], v[28:31], a[72:75], v[116:119]
  v_mfma_f32_16x16x32_bf16 v[124:127], v[28:31], a[76:79], v[124:127]
  s_waitcnt lgkmcnt(5)
  v_mfma_f32_16x16x32_bf16 v[96:99], v[32:35], a[80:83], v[96:99]
  s_add_u32 m0, s25, 5120
  ds_read_b128 v[24:27], v8 offset:49152
  v_mfma_f32_16x16x32_bf16 v[104:107], v[32:35], a[84:87], v[104:107]
  v_cvt_pk_bf16_f32 v140, v88, v89
  v_cvt_pk_bf16_f32 v141, v90, v91
  v_mfma_f32_16x16x32_bf16 v[112:115], v[32:35], a[88:91], v[112:115]
  buffer_load_dwordx4 v21, s[12:15], s19 offen lds
  v_mfma_f32_16x16x32_bf16 v[120:123], v[32:35], a[92:95], v[120:123]
  s_waitcnt lgkmcnt(5)
  v_cvt_pk_bf16_f32 v142, v92, v93
  v_cvt_pk_bf16_f32 v143, v94, v95
  v_mfma_f32_16x16x32_bf16 v[100:103], v[36:39], a[80:83], v[100:103]
  ds_read_b128 v[28:31], v9 offset:49152
  v_mfma_f32_16x16x32_bf16 v[108:111], v[36:39], a[84:87], v[108:111]
  v_mfma_f32_16x16x32_bf16 v[116:119], v[36:39], a[88:91], v[116:119]
  v_mfma_f32_16x16x32_bf16 v[124:127], v[36:39], a[92:95], v[124:127]
  s_waitcnt lgkmcnt(5)
  v_mfma_f32_16x16x32_bf16 v[96:99], v[40:43], a[96:99], v[96:99]
  s_add_u32 m0, s25, 6144
  ds_read_b128 v[32:35], v10 offset:49152
  v_mfma_f32_16x16x32_bf16 v[104:107], v[40:43], a[100:103], v[104:107]
  v_mfma_f32_16x16x32_bf16 v[112:115], v[40:43], a[104:107], v[112:115]
  buffer_load_dwordx4 v22, s[12:15], s19 offen lds
  v_mfma_f32_16x16x32_bf16 v[120:123], v[40:43], a[108:111], v[120:123]
  s_waitcnt lgkmcnt(5)
  v_mfma_f32_16x16x32_bf16 v[100:103], v[44:47], a[96:99], v[100:103]
  ds_read_b128 v[36:39], v11 offset:49152
  v_mfma_f32_16x16x32_bf16 v[108:111], v[44:47], a[100:103], v[108:111]
  v_mfma_f32_16x16x32_bf16 v[116:119], v[44:47], a[104:107], v[116:119]
  v_mfma_f32_16x16x32_bf16 v[124:127], v[44:47], a[108:111], v[124:127]
  s_waitcnt lgkmcnt(5)
  v_mfma_f32_16x16x32_bf16 v[96:99], v[48:51], a[112:115], v[96:99]
  s_add_u32 m0, s25, 7168
  ds_read_b128 v[40:43], v12 offset:49152
  v_mfma_f32_16x16x32_bf16 v[104:107], v[48:51], a[116:119], v[104:107]
  v_mfma_f32_16x16x32_bf16 v[112:115], v[48:51], a[120:123], v[112:115]
  buffer_load_dwordx4 v23, s[12:15], s19 offen lds
  v_mfma_f32_16x16x32_bf16 v[120:123], v[48:51], a[124:127], v[120:123]
  s_waitcnt lgkmcnt(5)
  v_mfma_f32_16x16x32_bf16 v[100:103], v[52:55], a[112:115], v[100:103]
  s_cmp_gt_u32 s23, 3
  ds_read_b128 v[44:47], v13 offset:49152
  v_mfma_f32_16x16x32_bf16 v[108:111], v[52:55], a[116:119], v[108:111]
  v_mfma_f32_16x16x32_bf16 v[116:119], v[52:55], a[120:123], v[116:119]
  s_cselect_b32 s26, s20, 0
  v_mfma_f32_16x16x32_bf16 v[124:127], v[52:55], a[124:127], v[124:127]
  s_waitcnt lgkmcnt(5)
  v_mfma_f32_16x16x32_bf16 v[96:99], v[24:27], a[128:131], v[96:99]
  s_add_u32 s19, s19, s26
  ds_read_b128 v[48:51], v14 offset:49152
  v_mfma_f32_16x16x32_bf16 v[104:107], v[24:27], a[132:135], v[104:107]
  v_mfma_f32_16x16x32_bf16 v[112:115], v[24:27], a[136:139], v[112:115]
  s_add_u32 s25, s25, 32768
  v_mfma_f32_16x16x32_bf16 v[120:123], v[24:27], a[140:143], v[120:123]
  s_waitcnt lgkmcnt(5)
  v_mfma_f32_16x16x32_bf16 v[100:103], v[28:31], a[128:131], v[100:103]
  s_and_b32 s25, s25, 0x1ffff
  ds_read_b128 v[52:55], v15 offset:49152
  v_mfma_f32_16x16x32_bf16 v[108:111], v[28:31], a[132:135], v[108:111]
  v_mfma_f32_16x16x32_bf16 v[116:119], v[28:31], a[136:139], v[116:119]
  buffer_store_dwordx4 v[128:131], v7, s[4:7], s21 offen offset:0 sc1
  v_mfma_f32_16x16x32_bf16 v[124:127], v[28:31], a[140:143], v[124:127]
  s_waitcnt lgkmcnt(5)
  v_mfma_f32_16x16x32_bf16 v[96:99], v[32:35], a[144:147], v[96:99]
  ds_read_b128 v[24:27], v8 offset:57344
  v_mfma_f32_16x16x32_bf16 v[104:107], v[32:35], a[148:151], v[104:107]
  v_mfma_f32_16x16x32_bf16 v[112:115], v[32:35], a[152:155], v[112:115]
  v_mfma_f32_16x16x32_bf16 v[120:123], v[32:35], a[156:159], v[120:123]
  s_waitcnt lgkmcnt(5)
  v_xor_b32 v8, 0x10000, v8
  v_mfma_f32_16x16x32_bf16 v[100:103], v[36:39], a[144:147], v[100:103]
  ds_read_b128 v[28:31], v9 offset:57344
  v_mfma_f32_16x16x32_bf16 v[108:111], v[36:39], a[148:151], v[108:111]
  v_mfma_f32_16x16x32_bf16 v[116:119], v[36:39], a[152:155], v[116:119]
  buffer_store_dwordx4 v[132:135], v7, s[4:7], s21 offen offset:256 sc1
  v_mfma_f32_16x16x32_bf16 v[124:127], v[36:39], a[156:159], v[124:127]
  s_waitcnt lgkmcnt(5)
  v_xor_b32 v9, 0x10000, v9
  v_mfma_f32_16x16x32_bf16 v[96:99], v[40:43], a[160:163], v[96:99]
  ds_read_b128 v[32:35], v10 offset:57344
  v_mfma_f32_16x16x32_bf16 v[104:107], v[40:43], a[164:167], v[104:107]
  v_mfma_f32_16x16x32_bf16 v[112:115], v[40:43], a[168:171], v[112:115]
  v_mfma_f32_16x16x32_bf16 v[120:123], v[40:43], a[172:175], v[120:123]
  s_waitcnt lgkmcnt(5)
  v_xor_b32 v10, 0x10000, v10
  v_mfma_f32_16x16x32_bf16 v[100:103], v[44:47], a[160:163], v[100:103]
  ds_read_b128 v[36:39], v11 offset:57344
  v_mfma_f32_16x16x32_bf16 v[108:111], v[44:47], a[164:167], v[108:111]
  v_mfma_f32_16x16x32_bf16 v[116:119], v[44:47], a[168:171], v[116:119]
  buffer_store_dwordx4 v[136:139], v7, s[4:7], s21 offen offset:2048 sc1
  v_mfma_f32_16x16x32_bf16 v[124:127], v[44:47], a[172:175], v[124:127]
  s_waitcnt lgkmcnt(5)
  v_xor_b32 v11, 0x10000, v11
  v_mfma_f32_16x16x32_bf16 v[96:99], v[48:51], a[176:179], v[96:99]
  ds_read_b128 v[40:43], v12 offset:57344
  v_mfma_f32_16x16x32_bf16 v[104:107], v[48:51], a[180:183], v[104:107]
  v_mfma_f32_16x16x32_bf16 v[112:115], v[48:51], a[184:187], v[112:115]
  v_mfma_f32_16x16x32_bf16 v[120:123], v[48:51], a[188:191], v[120:123]
  s_waitcnt lgkmcnt(5)
  v_xor_b32 v12, 0x10000, v12
  v_mfma_f32_16x16x32_bf16 v[100:103], v[52:55], a[176:179], v[100:103]
  ds_read_b128 v[44:47], v13 offset:57344
  v_mfma_f32_16x16x32_bf16 v[108:111], v[52:55], a[180:183], v[108:111]
  v_mfma_f32_16x16x32_bf16 v[116:119], v[52:55], a[184:187], v[116:119]
  buffer_store_dwordx4 v[140:143], v7, s[4:7], s21 offen offset:2304 sc1
  v_mfma_f32_16x16x32_bf16 v[124:127], v[52:55], a[188:191], v[124:127]
  s_waitcnt lgkmcnt(5)
  v_xor_b32 v13, 0x10000, v13
  v_mfma_f32_16x16x32_bf16 v[96:99], v[24:27], a[192:195], v[96:99]
  s_mov_b32 s21, s27
  ds_read_b128 v[48:51], v14 offset:57344
  v_mfma_f32_16x16x32_bf16 v[104:107], v[24:27], a[196:199], v[104:107]
  v_mov_b32 v7, v56
  v_mfma_f32_16x16x32_bf16 v[112:115], v[24:27], a[200:203], v[112:115]
  v_mfma_f32_16x16x32_bf16 v[120:123], v[24:27], a[204:207], v[120:123]
  s_waitcnt lgkmcnt(5)
  v_xor_b32 v14, 0x10000, v14
  v_mfma_f32_16x16x32_bf16 v[100:103], v[28:31], a[192:195], v[100:103]
  s_add_u32 s27, s27, s22
  ds_read_b128 v[52:55], v15 offset:57344
  v_mfma_f32_16x16x32_bf16 v[108:111], v[28:31], a[196:199], v[108:111]
  v_mfma_f32_16x16x32_bf16 v[116:119], v[28:31], a[200:203], v[116:119]
  s_waitcnt vmcnt(13)
  s_barrier
  v_mfma_f32_16x16x32_bf16 v[124:127], v[28:31], a[204:207], v[124:127]
  s_waitcnt lgkmcnt(5)
  v_xor_b32 v15, 0x10000, v15
  v_mfma_f32_16x16x32_bf16 v[96:99], v[32:35], a[208:211], v[96:99]
  ds_read_b128 v[24:27], v8 offset:0
  v_mfma_f32_16x16x32_bf16 v[104:107], v[32:35], a[212:215], v[104:107]
  v_mfma_f32_16x16x32_bf16 v[112:115], v[32:35], a[216:219], v[112:115]
  v_mfma_f32_16x16x32_bf16 v[120:123], v[32:35], a[220:223], v[120:123]
  s_waitcnt lgkmcnt(5)
  v_mfma_f32_16x16x32_bf16 v[100:103], v[36:39], a[208:211], v[100:103]
  s_add_u32 s29, s29, 1
  ds_read_b128 v[28:31], v9 offset:0
  v_mfma_f32_16x16x32_bf16 v[108:111], v[36:39], a[212:215], v[108:111]
  v_mfma_f32_16x16x32_bf16 v[116:119], v[36:39], a[216:219], v[116:119]
  s_max_i32 s30, s29, 0
  v_mfma_f32_16x16x32_bf16 v[124:127], v[36:39], a[220:223], v[124:127]
  s_waitcnt lgkmcnt(5)
  v_mov_b32 v144, s30
  v_mfma_f32_16x16x32_bf16 v[96:99], v[40:43], a[224:227], v[96:99]
  ds_read_b128 v[32:35], v10 offset:0
  v_mfma_f32_16x16x32_bf16 v[104:107], v[40:43], a[228:231], v[104:107]
  v_mfma_f32_16x16x32_bf16 v[112:115], v[40:43], a[232:235], v[112:115]
  buffer_store_dword v144, v145, s[4:7], s31 offen sc1
  v_mfma_f32_16x16x32_bf16 v[120:123], v[40:43], a[236:239], v[120:123]
  s_waitcnt lgkmcnt(5)
  v_mfma_f32_16x16x32_bf16 v[100:103], v[44:47], a[224:227], v[100:103]
  ds_read_b128 v[36:39], v11 offset:0
  v_mfma_f32_16x16x32_bf16 v[108:111], v[44:47], a[228:231], v[108:111]
  v_mfma_f32_16x16x32_bf16 v[116:119], v[44:47], a[232:235], v[116:119]
  v_mfma_f32_16x16x32_bf16 v[124:127], v[44:47], a[236:239], v[124:127]
  s_waitcnt lgkmcnt(5)
  v_mfma_f32_16x16x32_bf16 v[96:99], v[48:51], a[240:243], v[96:99]
  s_sub_u32 s23, s23, 1
  ds_read_b128 v[40:43], v12 offset:0
  v_mfma_f32_16x16x32_bf16 v[104:107], v[48:51], a[244:247], v[104:107]
  v_mfma_f32_16x16x32_bf16 v[112:115], v[48:51], a[248:251], v[112:115]
  v_mfma_f32_16x16x32_bf16 v[120:123], v[48:51], a[252:255], v[120:123]
  s_waitcnt lgkmcnt(5)
  v_mfma_f32_16x16x32_bf16 v[100:103], v[52:55], a[240:243], v[100:103]
  s_cmp_eq_u32 s23, 0
  ds_read_b128 v[44:47], v13 offset:0
  v_mfma_f32_16x16x32_bf16 v[108:111], v[52:55], a[244:247], v[108:111]
  v_mfma_f32_16x16x32_bf16 v[116:119], v[52:55], a[248:251], v[116:119]
  v_mfma_f32_16x16x32_bf16 v[124:127], v[52:55], a[252:255], v[124:127]
  s_cbranch_scc1 G_done1_14
  s_branch G_top_12
G_done0_13:
  s_nop 7
  s_nop 3
  v_cvt_pk_bf16_f32 v128, v64, v65
  v_cvt_pk_bf16_f32 v129, v66, v67
  v_cvt_pk_bf16_f32 v130, v68, v69
  v_cvt_pk_bf16_f32 v131, v70, v71
  buffer_store_dwordx4 v[128:131], v7, s[4:7], s21 offen offset:0 sc1
  v_cvt_pk_bf16_f32 v132, v72, v73
  v_cvt_pk_bf16_f32 v133, v74, v75
  v_cvt_pk_bf16_f32 v134, v76, v77
  v_cvt_pk_bf16_f32 v135, v78, v79
  buffer_store_dwordx4 v[132:135], v7, s[4:7], s21 offen offset:256 sc1
  v_cvt_pk_bf16_f32 v136, v80, v81
  v_cvt_pk_bf16_f32 v137, v82, v83
  v_cvt_pk_bf16_f32 v138, v84, v85
  v_cvt_pk_bf16_f32 v139, v86, v87
  buffer_store_dwordx4 v[136:139], v7, s[4:7], s21 offen offset:2048 sc1
  v_cvt_pk_bf16_f32 v140, v88, v89
  v_cvt_pk_bf16_f32 v141, v90, v91
  v_cvt_pk_bf16_f32 v142, v92, v93
  v_cvt_pk_bf16_f32 v143, v94, v95
  buffer_store_dwordx4 v[140:143], v7, s[4:7], s21 offen offset:2304 sc1
  s_branch G_fin_15
G_done1_14:
  s_nop 7
  s_nop 3
  v_cvt_pk_bf16_f32 v128, v96, v97
  v_cvt_pk_bf16_f32 v129, v98, v99
  v_cvt_pk_bf16_f32 v130, v100, v101
  v_cvt_pk_bf16_f32 v131, v102, v103
  buffer_store_dwordx4 v[128:131], v7, s[4:7], s21 offen offset:0 sc1
  v_cvt_pk_bf16_f32 v132, v104, v105
  v_cvt_pk_bf16_f32 v133, v106, v107
  v_cvt_pk_bf16_f32 v134, v108, v109
  v_cvt_pk_bf16_f32 v135, v110, v111
  buffer_store_dwordx4 v[132:135], v7, s[4:7], s21 offen offset:256 sc1
  v_cvt_pk_bf16_f32 v136, v112, v113
  v_cvt_pk_bf16_f32 v137, v114, v115
  v_cvt_pk_bf16_f32 v138, v116, v117
  v_cvt_pk_bf16_f32 v139, v118, v119
  buffer_store_dwordx4 v[136:139], v7, s[4:7], s21 offen offset:2048 sc1
  v_cvt_pk_bf16_f32 v140, v120, v121
  v_cvt_pk_bf16_f32 v141, v122, v123
  v_cvt_pk_bf16_f32 v142, v124, v125
  v_cvt_pk_bf16_f32 v143, v126, v127
  buffer_store_dwordx4 v[140:143], v7, s[4:7], s21 offen offset:2304 sc1
G_fin_15:
  s_waitcnt vmcnt(0) lgkmcnt(0)
  s_barrier
  s_add_u32 s30, s29, 2
  v_mov_b32 v144, s30
  v_min_u32 v145, 1, v0
  v_lshlrev_b32 v145, 30, v145
  buffer_store_dword v144, v145, s[4:7], s31 offen sc1
P_end_2:
  s_mov_b32 s71, 0
  s_branch M_sg_17
M_sw_16:
  s_sleep 8
  s_add_u32 s71, s71, 1
  s_cmp_gt_u32 s71, 262144
  s_cbranch_scc1 M_exit
M_sg_17:
  s_mov_b32 s79, 0
  s_atomic_or s79, s[74:75], 128 glc
  s_waitcnt lgkmcnt(0)
  s_cmp_lt_u32 s79, 256
  s_cbranch_scc1 M_sw_16
  s_cmp_eq_u32 s65, 6
  s_cbranch_scc1 M_follow
  s_mov_b32 s68, 0
  s_mov_b32 s36, -1
  s_mov_b32 s69, s53
  s_mov_b32 s70, s54
  s_load_dwordx2 s[8:9], s[0:1], 40
  s_mul_i32 s76, s64, 6
  s_add_u32 s76, s76, s65
  s_mul_i32 s76, s76, 21888
  v_min_u32 v200, 170, v0
  v_lshl_add_u32 v200, v200, 7, s76
  s_waitcnt lgkmcnt(0)
  s_and_b32 s9, s9, 0xffff
  s_mov_b32 s10, 4194304
  s_mov_b32 s11, 0x20000
M_att:
  s_mov_b32 s24, 0xf149f2ca
  s_mov_b32 s29, 0
  v_mov_b32 v6, 0
  v_mov_b32 v7, 0
  s_lshl_b32 s26, s16, 11
  v_add_u32 v3, s26, v2
  v_and_b32 v5, 31, v1
  v_lshrrev_b32 v12, 5, v1
  v_lshlrev_b32 v12, 2, v12
  v_sub_u32 v5, v5, v12
  s_lshl_b32 s26, s64, 19
  s_add_u32 s19, s26, 16777216
  s_add_u32 s20, s26, 33554432
  s_lshl_b32 s27, s69, 2
  s_add_u32 s27, s27, s16
  s_lshl_b32 s27, s27, 14
  s_add_u32 s25, s26, s27
  s_bfe_u32 s78, s70, 0x80000
  s_add_u32 s76, s67, 512
  s_mov_b32 s71, 0
  s_branch M_sg_19
M_sw_18:
  s_sleep 8
  s_add_u32 s71, s71, 1
  s_cmp_gt_u32 s71, 262144
  s_cbranch_scc1 M_exit
M_sg_19:
  s_mov_b32 s79, 0
  s_atomic_or s79, s[72:73], s76 glc
  s_waitcnt lgkmcnt(0)
  s_cmp_lt_u32 s79, s78
  s_cbranch_scc1 M_sw_18
  s_bfe_u32 s78, s70, 0x80008
  s_add_u32 s76, s67, 640
  s_mov_b32 s71, 0
  s_branch M_sg_21
M_sw_20:
  s_sleep 8
  s_add_u32 s71, s71, 1
  s_cmp_gt_u32 s71, 262144
  s_cbranch_scc1 M_exit
M_sg_21:
  s_mov_b32 s79, 0
  s_atomic_or s79, s[72:73], s76 glc
  s_waitcnt lgkmcnt(0)
  s_cmp_lt_u32 s79, s78
  s_cbranch_scc1 M_sw_20
  s_lshl_b32 s27, s69, 16
  s_add_u32 s27, s27, 16384
  s_add_u32 s17, s19, s27
M_kv_22:
  s_cmp_ge_u32 s17, s36
  s_cbranch_scc1 M_kvok_23
  s_mov_b32 s76, 0
  s_mov_b32 s78, 23
  s_mov_b32 s77, 335872
  s_cmp_eq_u32 s68, 1
  s_cmov_b32 s76, 128
  s_cmov_b32 s78, 27
  s_cmov_b32 s77, 114688
  s_cmp_eq_u32 s68, 2
  s_cmov_b32 s76, 768
  s_cmov_b32 s78, 14
  s_cmov_b32 s77, 0
  s_add_u32 s76, s76, s67
  s_mov_b32 s71, 0
  s_branch M_sg_25
M_sw_24:
  s_sleep 8
  s_add_u32 s71, s71, 1
  s_cmp_gt_u32 s71, 262144
  s_cbranch_scc1 M_exit
M_sg_25:
  s_mov_b32 s79, 0
  s_atomic_or s79, s[72:73], s76 glc
  s_waitcnt lgkmcnt(0)
  s_cmp_lt_u32 s79, s78
  s_cbranch_scc1 M_sw_24
  s_add_u32 s36, s77, s19
  s_add_u32 s68, s68, 1
  s_branch M_kv_22
M_kvok_23:
  s_add_u32 s28, s25, 0
  buffer_load_dwordx4 a[128:131], v2, s[4:7], s28 offen offset:0 sc1
  buffer_load_dwordx4 a[132:135], v2, s[4:7], s28 offen offset:1024 sc1
  buffer_load_dwordx4 a[136:139], v2, s[4:7], s28 offen offset:2048 sc1
  buffer_load_dwordx4 a[140:143], v2, s[4:7], s28 offen offset:3072 sc1
  s_add_u32 s28, s25, 4096
  buffer_load_dwordx4 a[144:147], v2, s[4:7], s28 offen offset:0 sc1
  buffer_load_dwordx4 a[148:151], v2, s[4:7], s28 offen offset:1024 sc1
  buffer_load_dwordx4 a[152:155], v2, s[4:7], s28 offen offset:2048 sc1
  buffer_load_dwordx4 a[156:159], v2, s[4:7], s28 offen offset:3072 sc1
  s_add_u32 s28, s25, 8192
  buffer_load_dwordx4 a[160:163], v2, s[4:7], s28 offen offset:0 sc1
  buffer_load_dwordx4 a[164:167], v2, s[4:7], s28 offen offset:1024 sc1
  buffer_load_dwordx4 a[168:171], v2, s[4:7], s28 offen offset:2048 sc1
  buffer_load_dwordx4 a[172:175], v2, s[4:7], s28 offen offset:3072 sc1
  s_add_u32 s28, s25, 12288
  buffer_load_dwordx4 a[176:179], v2, s[4:7], s28 offen offset:0 sc1
  buffer_load_dwordx4 a[180:183], v2, s[4:7], s28 offen offset:1024 sc1
  buffer_load_dwordx4 a[184:187], v2, s[4:7], s28 offen offset:2048 sc1
  buffer_load_dwordx4 a[188:191], v2, s[4:7], s28 offen offset:3072 sc1
A_again_26:
  s_lshl_b32 s27, s69, 16
  s_add_u32 s27, s27, 57344
  s_add_u32 s17, s19, s27
  s_add_u32 s18, s20, s27
  s_lshl_b32 s21, s16, 11
  s_mov_b32 m0, s21
  s_nop 0
  buffer_load_dwordx4 v3, s[4:7], s18 offen offset:0 sc1 lds
  buffer_load_dwordx4 v3, s[4:7], s18 offen offset:1024 sc1 lds
  s_add_u32 m0, s21, 8192
  s_nop 0
  buffer_load_dwordx4 v3, s[4:7], s17 offen offset:0 sc1 lds
  buffer_load_dwordx4 v3, s[4:7], s17 offen offset:1024 sc1 lds
  s_add_u32 s18, s18, 8192
  s_sub_u32 s18, s18, 8192
  s_max_i32 s18, s18, s20
  s_sub_u32 s17, s17, 8192
  s_max_i32 s17, s17, s19
  s_add_u32 s21, s21, 16384
  s_and_b32 s21, s21, 131071
  s_mov_b32 m0, s21
  s_nop 0
  buffer_load_dwordx4 v3, s[4:7], s18 offen offset:0 sc1 lds
  buffer_load_dwordx4 v3, s[4:7], s18 offen offset:1024 sc1 lds
  s_add_u32 m0, s21, 8192
  s_nop 0
  buffer_load_dwordx4 v3, s[4:7], s17 offen offset:0 sc1 lds
  buffer_load_dwordx4 v3, s[4:7], s17 offen offset:1024 sc1 lds
  s_sub_u32 s18, s18, 8192
  s_max_i32 s18, s18, s20
  s_sub_u32 s17, s17, 8192
  s_max_i32 s17, s17, s19
  s_add_u32 s21, s21, 16384
  s_and_b32 s21, s21, 131071
  s_mov_b32 m0, s21
  s_nop 0
  buffer_load_dwordx4 v3, s[4:7], s18 offen offset:0 sc1 lds
  buffer_load_dwordx4 v3, s[4:7], s18 offen offset:1024 sc1 lds
  s_add_u32 m0, s21, 8192
  s_nop 0
  buffer_load_dwordx4 v3, s[4:7], s17 offen offset:0 sc1 lds
  buffer_load_dwordx4 v3, s[4:7], s17 offen offset:1024 sc1 lds
  s_sub_u32 s18, s18, 8192
  s_max_i32 s18, s18, s20
  s_sub_u32 s17, s17, 8192
  s_max_i32 s17, s17, s19
  s_add_u32 s21, s21, 16384
  s_and_b32 s21, s21, 131071
  s_mov_b32 m0, s21
  s_nop 0
  buffer_load_dwordx4 v3, s[4:7], s18 offen offset:0 sc1 lds
  buffer_load_dwordx4 v3, s[4:7], s18 offen offset:1024 sc1 lds
  s_add_u32 m0, s21, 8192
  s_nop 0
  buffer_load_dwordx4 v3, s[4:7], s17 offen offset:0 sc1 lds
  buffer_load_dwordx4 v3, s[4:7], s17 offen offset:1024 sc1 lds
  s_sub_u32 s18, s18, 8192
  s_max_i32 s18, s18, s20
  s_sub_u32 s17, s17, 8192
  s_max_i32 s17, s17, s19
  s_add_u32 s21, s21, 16384
  s_and_b32 s21, s21, 131071
  s_mov_b32 m0, s21
  s_nop 0
  buffer_load_dwordx4 v3, s[4:7], s18 offen offset:0 sc1 lds
  buffer_load_dwordx4 v3, s[4:7], s18 offen offset:1024 sc1 lds
  s_add_u32 m0, s21, 8192
  s_nop 0
  buffer_load_dwordx4 v3, s[4:7], s17 offen offset:0 sc1 lds
  buffer_load_dwordx4 v3, s[4:7], s17 offen offset:1024 sc1 lds
  s_sub_u32 s18, s18, 8192
  s_max_i32 s18, s18, s20
  s_sub_u32 s17, s17, 8192
  s_max_i32 s17, s17, s19
  s_add_u32 s21, s21, 16384
  s_and_b32 s21, s21, 131071
  s_mov_b32 m0, s21
  s_nop 0
  buffer_load_dwordx4 v3, s[4:7], s18 offen offset:0 sc1 lds
  buffer_load_dwordx4 v3, s[4:7], s18 offen offset:1024 sc1 lds
  s_add_u32 m0, s21, 8192
  s_nop 0
  buffer_load_dwordx4 v3, s[4:7], s17 offen offset:0 sc1 lds
  buffer_load_dwordx4 v3, s[4:7], s17 offen offset:1024 sc1 lds
  v_accvgpr_write_b32 a0, 0
  v_accvgpr_write_b32 a1, 0
  v_accvgpr_write_b32 a2, 0
  v_accvgpr_write_b32 a3, 0
  v_accvgpr_write_b32 a4, 0
  v_accvgpr_write_b32 a5, 0
  v_accvgpr_write_b32 a6, 0
  v_accvgpr_write_b32 a7, 0
  v_accvgpr_write_b32 a8, 0
  v_accvgpr_write_b32 a9, 0
  v_accvgpr_write_b32 a10, 0
  v_accvgpr_write_b32 a11, 0
  v_accvgpr_write_b32 a12, 0
  v_accvgpr_write_b32 a13, 0
  v_accvgpr_write_b32 a14, 0
  v_accvgpr_write_b32 a15, 0
  v_accvgpr_write_b32 a16, 0
  v_accvgpr_write_b32 a17, 0
  v_accvgpr_write_b32 a18, 0
  v_accvgpr_write_b32 a19, 0
  v_accvgpr_write_b32 a20, 0
  v_accvgpr_write_b32 a21, 0
  v_accvgpr_write_b32 a22, 0
  v_accvgpr_write_b32 a23, 0
  v_accvgpr_write_b32 a24, 0
  v_accvgpr_write_b32 a25, 0
  v_accvgpr_write_b32 a26, 0
  v_accvgpr_write_b32 a27, 0
  v_accvgpr_write_b32 a28, 0
  v_accvgpr_write_b32 a29, 0
  v_accvgpr_write_b32 a30, 0
  v_accvgpr_write_b32 a31, 0
  v_accvgpr_write_b32 a32, 0
  v_accvgpr_write_b32 a33, 0
  v_accvgpr_write_b32 a34, 0
  v_accvgpr_write_b32 a35, 0
  v_accvgpr_write_b32 a36, 0
  v_accvgpr_write_b32 a37, 0
  v_accvgpr_write_b32 a38, 0
  v_accvgpr_write_b32 a39, 0
  v_accvgpr_write_b32 a40, 0
  v_accvgpr_write_b32 a41, 0
  v_accvgpr_write_b32 a42, 0
  v_accvgpr_write_b32 a43, 0
  v_accvgpr_write_b32 a44, 0
  v_accvgpr_write_b32 a45, 0
  v_accvgpr_write_b32 a46, 0
  v_accvgpr_write_b32 a47, 0
  v_accvgpr_write_b32 a48, 0
  v_accvgpr_write_b32 a49, 0
  v_accvgpr_write_b32 a50, 0
  v_accvgpr_write_b32 a51, 0
  v_accvgpr_write_b32 a52, 0
  v_accvgpr_write_b32 a53, 0
  v_accvgpr_write_b32 a54, 0
  v_accvgpr_write_b32 a55, 0
  v_accvgpr_write_b32 a56, 0
  v_accvgpr_write_b32 a57, 0
  v_accvgpr_write_b32 a58, 0
  v_accvgpr_write_b32 a59, 0
  v_accvgpr_write_b32 a60, 0
  v_accvgpr_write_b32 a61, 0
  v_accvgpr_write_b32 a62, 0
  v_accvgpr_write_b32 a63, 0
  v_accvgpr_write_b32 a64, 0
  v_accvgpr_write_b32 a65, 0
  v_accvgpr_write_b32 a66, 0
  v_accvgpr_write_b32 a67, 0
  v_accvgpr_write_b32 a68, 0
  v_accvgpr_write_b32 a69, 0
  v_accvgpr_write_b32 a70, 0
  v_accvgpr_write_b32 a71, 0
  v_accvgpr_write_b32 a72, 0
  v_accvgpr_write_b32 a73, 0
  v_accvgpr_write_b32 a74, 0
  v_accvgpr_write_b32 a75, 0
  v_accvgpr_write_b32 a76, 0
  v_accvgpr_write_b32 a77, 0
  v_accvgpr_write_b32 a78, 0
  v_accvgpr_write_b32 a79, 0
  v_accvgpr_write_b32 a80, 0
  v_accvgpr_write_b32 a81, 0
  v_accvgpr_write_b32 a82, 0
  v_accvgpr_write_b32 a83, 0
  v_accvgpr_write_b32 a84, 0
  v_accvgpr_write_b32 a85, 0
  v_accvgpr_write_b32 a86, 0
  v_accvgpr_write_b32 a87, 0
  v_accvgpr_write_b32 a88, 0
  v_accvgpr_write_b32 a89, 0
  v_accvgpr_write_b32 a90, 0
  v_accvgpr_write_b32 a91, 0
  v_accvgpr_write_b32 a92, 0
  v_accvgpr_write_b32 a93, 0
  v_accvgpr_write_b32 a94, 0
  v_accvgpr_write_b32 a95, 0
  v_accvgpr_write_b32 a96, 0
  v_accvgpr_write_b32 a97, 0
  v_accvgpr_write_b32 a98, 0
  v_accvgpr_write_b32 a99, 0
  v_accvgpr_write_b32 a100, 0
  v_accvgpr_write_b32 a101, 0
  v_accvgpr_write_b32 a102, 0
  v_accvgpr_write_b32 a103, 0
  v_accvgpr_write_b32 a104, 0
  v_accvgpr_write_b32 a105, 0
  v_accvgpr_write_b32 a106, 0
  v_accvgpr_write_b32 a107, 0
  v_accvgpr_write_b32 a108, 0
  v_accvgpr_write_b32 a109, 0
  v_accvgpr_write_b32 a110, 0
  v_accvgpr_write_b32 a111, 0
  v_accvgpr_write_b32 a112, 0
  v_accvgpr_write_b32 a113, 0
  v_accvgpr_write_b32 a114, 0
  v_accvgpr_write_b32 a115, 0
  v_accvgpr_write_b32 a116, 0
  v_accvgpr_write_b32 a117, 0
  v_accvgpr_write_b32 a118, 0
  v_accvgpr_write_b32 a119, 0
  v_accvgpr_write_b32 a120, 0
  v_accvgpr_write_b32 a121, 0
  v_accvgpr_write_b32 a122, 0
  v_accvgpr_write_b32 a123, 0
  v_accvgpr_write_b32 a124, 0
  v_accvgpr_write_b32 a125, 0
  v_accvgpr_write_b32 a126, 0
  v_accvgpr_write_b32 a127, 0
  v_mov_b32 v8, 0
  v_mov_b32 v9, 0
  v_mov_b32 v10, 0
  v_mov_b32 v11, 0
  v_mov_b32 v52, 0
  v_mov_b32 v53, 0
  v_mov_b32 v54, s24
  v_mov_b32 v55, s24
  v_mov_b32 v56, s24
  v_mov_b32 v57, s24
  v_mov_b32 v58, s24
  v_mov_b32 v59, s24
  v_mov_b32 v60, s24
  v_mov_b32 v61, s24
  v_mov_b32 v62, s24
  v_mov_b32 v63, s24
  v_mov_b32 v104, 0
  v_mov_b32 v105, 0
  v_mov_b32 v4, v2
  v_mov_b32 v64, s24
  v_mov_b32 v65, s24
  v_mov_b32 v66, s24
  v_mov_b32 v67, s24
  v_mov_b32 v68, s24
  v_mov_b32 v69, s24
  v_mov_b32 v70, s24
  v_mov_b32 v71, s24
  v_mov_b32 v72, s24
  v_mov_b32 v73, s24
  v_mov_b32 v74, s24
  v_mov_b32 v75, s24
  v_mov_b32 v76, s24
  v_mov_b32 v77, s24
  v_mov_b32 v78, s24
  v_mov_b32 v79, s24
  v_mov_b32 v12, s24
  v_cmp_le_i32 s[40:41], 0, v5
  v_cmp_le_i32 s[42:43], 1, v5
  v_cmp_le_i32 s[44:45], 2, v5
  v_cmp_le_i32 s[46:47], 3, v5
  v_cndmask_b32 v80, v12, v7, s[40:41]
  v_cndmask_b32 v81, v12, v7, s[42:43]
  v_cndmask_b32 v82, v12, v7, s[44:45]
  v_cndmask_b32 v83, v12, v7, s[46:47]
  v_cmp_le_i32 s[40:41], 8, v5
  v_cmp_le_i32 s[42:43], 9, v5
  v_cmp_le_i32 s[44:45], 10, v5
  v_cmp_le_i32 s[46:47], 11, v5
  v_cndmask_b32 v84, v12, v7, s[40:41]
  v_cndmask_b32 v85, v12, v7, s[42:43]
  v_cndmask_b32 v86, v12, v7, s[44:45]
  v_cndmask_b32 v87, v12, v7, s[46:47]
  v_cmp_le_i32 s[40:41], 16, v5
  v_cmp_le_i32 s[42:43], 17, v5
  v_cmp_le_i32 s[44:45], 18, v5
  v_cmp_le_i32 s[46:47], 19, v5
  v_cndmask_b32 v88, v12, v7, s[40:41]
  v_cndmask_b32 v89, v12, v7, s[42:43]
  v_cndmask_b32 v90, v12, v7, s[44:45]
  v_cndmask_b32 v91, v12, v7, s[46:47]
  v_cmp_le_i32 s[40:41], 24, v5
  v_cmp_le_i32 s[42:43], 25, v5
  v_cmp_le_i32 s[44:45], 26, v5
  v_cmp_le_i32 s[46:47], 27, v5
  v_cndmask_b32 v92, v12, v7, s[40:41]
  v_cndmask_b32 v93, v12, v7, s[42:43]
  v_cndmask_b32 v94, v12, v7, s[44:45]
  v_cndmask_b32 v95, v12, v7, s[46:47]
  s_lshl_b32 s22, s69, 3
  s_add_u32 s22, s22, 8
  s_lshl_b32 s26, s16, 1
  s_sub_u32 s23, 6, s26
  s_waitcnt vmcnt(20)
  s_barrier
  s_cmp_eq_u32 s23, 0
  s_cbranch_scc1 A_go_28
A_idle_27:
  s_waitcnt vmcnt(16)
  s_barrier
  s_sub_u32 s18, s18, 8192
  s_max_i32 s18, s18, s20
  s_sub_u32 s17, s17, 8192
  s_max_i32 s17, s17, s19
  s_add_u32 s21, s21, 16384
  s_and_b32 s21, s21, 131071
M_kv_29:
  s_cmp_ge_u32 s17, s36
  s_cbranch_scc1 M_kvok_30
  s_mov_b32 s76, 0
  s_mov_b32 s78, 23
  s_mov_b32 s77, 335872
  s_cmp_eq_u32 s68, 1
  s_cmov_b32 s76, 128
  s_cmov_b32 s78, 27
  s_cmov_b32 s77, 114688
  s_cmp_eq_u32 s68, 2
  s_cmov_b32 s76, 768
  s_cmov_b32 s78, 14
  s_cmov_b32 s77, 0
  s_add_u32 s76, s76, s67
  s_mov_b32 s71, 0
  s_branch M_sg_32
M_sw_31:
  s_sleep 8
  s_add_u32 s71, s71, 1
  s_cmp_gt_u32 s71, 262144
  s_cbranch_scc1 M_exit
M_sg_32:
  s_mov_b32 s79, 0
  s_atomic_or s79, s[72:73], s76 glc
  s_waitcnt lgkmcnt(0)
  s_cmp_lt_u32 s79, s78
  s_cbranch_scc1 M_sw_31
  s_add_u32 s36, s77, s19
  s_add_u32 s68, s68, 1
  s_branch M_kv_29
M_kvok_30:
  s_mov_b32 m0, s21
  s_nop 0
  buffer_load_dwordx4 v3, s[4:7], s18 offen offset:0 sc1 lds
  buffer_load_dwordx4 v3, s[4:7], s18 offen offset:1024 sc1 lds
  s_add_u32 m0, s21, 8192
  s_nop 0
  buffer_load_dwordx4 v3, s[4:7], s17 offen offset:0 sc1 lds
  buffer_load_dwordx4 v3, s[4:7], s17 offen offset:1024 sc1 lds
  v_add_u32 v4, 16384, v4
  v_and_b32 v4, 131071, v4
  s_sub_u32 s22, s22, 1
  s_sub_u32 s23, s23, 1
  s_cmp_lg_u32 s23, 0
  s_cbranch_scc1 A_idle_27
A_go_28:
  ds_read_b128 a[224:227], v4 offset:0
  ds_read_b128 a[228:231], v4 offset:2048
  ds_read_b128 a[232:235], v4 offset:4096
  ds_read_b128 a[236:239], v4 offset:6144
  ds_read_b128 a[240:243], v4 offset:1024
  ds_read_b128 a[244:247], v4 offset:3072
  ds_read_b128 a[248:251], v4 offset:5120
  ds_read_b128 a[252:255], v4 offset:7168
  ds_read_b128 a[192:195], v4 offset:8192
  ds_read_b128 a[196:199], v4 offset:9216
  ds_read_b128 a[200:203], v4 offset:10240
  ds_read_b128 a[204:207], v4 offset:11264
  ds_read_b128 a[208:211], v4 offset:12288
  ds_read_b128 a[212:215], v4 offset:13312
  ds_read_b128 a[216:219], v4 offset:14336
  ds_read_b128 a[220:223], v4 offset:15360
  v_add_u32 v4, 16384, v4
  v_and_b32 v4, 131071, v4
  s_waitcnt lgkmcnt(8)
.p2align 6
A_top_33:
  s_waitcnt lgkmcnt(7)
  v_mfma_f32_32x32x16_bf16 v[32:47], a[192:195], a[128:131], v[64:79]
  s_waitcnt lgkmcnt(6)
  v_exp_f32 v54, v54
  v_add_f32 v11, v11, v53
  v_cvt_pk_bf16_f32 v106, v52, v53
  v_mfma_f32_32x32x16_bf16 v[32:47], a[196:199], a[132:135], v[32:47]
  s_waitcnt lgkmcnt(4)
  v_exp_f32 v55, v55
  v_add_f32 v10, v10, v54
  v_mfma_f32_32x32x16_bf16 v[32:47], a[200:203], a[136:139], v[32:47]
  v_exp_f32 v56, v56
  v_add_f32 v11, v11, v55
  v_cvt_pk_bf16_f32 v107, v54, v55
  v_mfma_f32_32x32x16_bf16 v[32:47], a[204:207], a[140:143], v[32:47]
  s_waitcnt lgkmcnt(2)
  v_exp_f32 v57, v57
  v_add_f32 v10, v10, v56
  v_mfma_f32_32x32x16_bf16 v[32:47], a[208:211], a[144:147], v[32:47]
  v_exp_f32 v58, v58
  v_add_f32 v11, v11, v57
  v_cvt_pk_bf16_f32 v108, v56, v57
  v_mfma_f32_32x32x16_bf16 v[32:47], a[212:215], a[148:151], v[32:47]
  s_waitcnt lgkmcnt(0)
  v_exp_f32 v59, v59
  v_add_f32 v10, v10, v58
  v_mfma_f32_32x32x16_bf16 v[32:47], a[216:219], a[152:155], v[32:47]
  v_exp_f32 v60, v60
  v_add_f32 v11, v11, v59
  v_cvt_pk_bf16_f32 v109, v58, v59
  v_mfma_f32_32x32x16_bf16 v[32:47], a[220:223], a[156:159], v[32:47]
  s_waitcnt vmcnt(16)
  s_barrier
  v_exp_f32 v61, v61
  v_add_f32 v10, v10, v60
  v_mfma_f32_32x32x16_bf16 a[64:79], a[224:227], v[104:107], a[64:79]
  ds_read_b128 a[224:227], v4 offset:0
  v_exp_f32 v62, v62
  v_add_f32 v11, v11, v61
  v_cvt_pk_bf16_f32 v110, v60, v61
  v_mfma_f32_32x32x16_bf16 a[80:95], a[228:231], v[104:107], a[80:95]
  s_sub_u32 s18, s18, 8192
  ds_read_b128 a[228:231], v4 offset:2048
  v_exp_f32 v63, v63
  v_add_f32 v10, v10, v62
  v_mfma_f32_32x32x16_bf16 a[96:111], a[232:235], v[104:107], a[96:111]
  s_max_i32 s18, s18, s20
  ds_read_b128 a[232:235], v4 offset:4096
  v_exp_f32 v32, v32
  v_add_f32 v11, v11, v63
  v_cvt_pk_bf16_f32 v111, v62, v63
  v_mfma_f32_32x32x16_bf16 a[112:127], a[236:239], v[104:107], a[112:127]
  s_sub_u32 s17, s17, 8192
  ds_read_b128 a[236:239], v4 offset:6144
  v_exp_f32 v33, v33
  v_add_f32 v8, v8, v32
  v_mfma_f32_32x32x16_bf16 a[64:79], a[240:243], v[108:111], a[64:79]
  s_max_i32 s17, s17, s19
  ds_read_b128 a[240:243], v4 offset:1024
  v_exp_f32 v34, v34
  v_add_f32 v9, v9, v33
  v_cvt_pk_bf16_f32 v96, v32, v33
  v_mfma_f32_32x32x16_bf16 a[80:95], a[244:247], v[108:111], a[80:95]
  s_add_u32 s21, s21, 16384
  ds_read_b128 a[244:247], v4 offset:3072
  v_exp_f32 v35, v35
  v_add_f32 v8, v8, v34
  v_mfma_f32_32x32x16_bf16 a[96:111], a[248:251], v[108:111], a[96:111]
  s_and_b32 s21, s21, 131071
  ds_read_b128 a[248:251], v4 offset:5120
  v_exp_f32 v36, v36
  v_add_f32 v9, v9, v35
  v_cvt_pk_bf16_f32 v97, v34, v35
  v_mfma_f32_32x32x16_bf16 a[112:127], a[252:255], v[108:111], a[112:127]
  ds_read_b128 a[252:255], v4 offset:7168
  v_exp_f32 v37, v37
  v_add_f32 v8, v8, v36
  v_mfma_f32_32x32x16_bf16 v[48:63], a[192:195], a[160:163], v[80:95]
  s_add_u32 s23, s23, 1
  ds_read_b128 a[192:195], v4 offset:8192
  v_exp_f32 v38, v38
  v_add_f32 v9, v9, v37
  v_cvt_pk_bf16_f32 v98, v36, v37
  v_mfma_f32_32x32x16_bf16 v[48:63], a[196:199], a[164:167], v[48:63]
  s_sub_u32 s22, s22, 1
  ds_read_b128 a[196:199], v4 offset:9216
  v_exp_f32 v39, v39
  v_add_f32 v8, v8, v38
  v_mfma_f32_32x32x16_bf16 v[48:63], a[200:203], a[168:171], v[48:63]
  s_cmp_lt_u32 s23, 3
  ds_read_b128 a[200:203], v4 offset:10240
  v_exp_f32 v40, v40
  v_add_f32 v9, v9, v39
  v_cvt_pk_bf16_f32 v99, v38, v39
  v_mfma_f32_32x32x16_bf16 v[48:63], a[204:207], a[172:175], v[48:63]
  s_cbranch_scc1 A_upd_34
A_back_35:
  ds_read_b128 a[204:207], v4 offset:11264
  v_exp_f32 v41, v41
  v_add_f32 v8, v8, v40
  v_mfma_f32_32x32x16_bf16 v[48:63], a[208:211], a[176:179], v[48:63]
  s_cmp_lt_u32 s17, s36
  ds_read_b128 a[208:211], v4 offset:12288
  v_exp_f32 v42, v42
  v_add_f32 v9, v9, v41
  v_cvt_pk_bf16_f32 v100, v40, v41
  v_mfma_f32_32x32x16_bf16 v[48:63], a[212:215], a[180:183], v[48:63]
  s_cbranch_scc1 A_kvw_37
A_kvb_38:
  ds_read_b128 a[212:215], v4 offset:13312
  v_exp_f32 v43, v43
  v_add_f32 v8, v8, v42
  v_mfma_f32_32x32x16_bf16 v[48:63], a[216:219], a[184:187], v[48:63]
  s_mov_b32 m0, s21
  ds_read_b128 a[216:219], v4 offset:14336
  v_exp_f32 v44, v44
  v_add_f32 v9, v9, v43
  v_cvt_pk_bf16_f32 v101, v42, v43
  v_mfma_f32_32x32x16_bf16 v[48:63], a[220:223], a[188:191], v[48:63]
  s_waitcnt lgkmcnt(13)
  ds_read_b128 a[220:223], v4 offset:15360
  v_exp_f32 v45, v45
  v_add_f32 v8, v8, v44
  v_mfma_f32_32x32x16_bf16 a[0:15], a[224:227], v[96:99], a[0:15]
  buffer_load_dwordx4 v3, s[4:7], s18 offen offset:0 sc1 lds
  v_exp_f32 v46, v46
  v_add_f32 v9, v9, v45
  v_cvt_pk_bf16_f32 v102, v44, v45
  v_mfma_f32_32x32x16_bf16 a[16:31], a[228:231], v[96:99], a[16:31]
  s_waitcnt lgkmcnt(12)
  v_exp_f32 v47, v47
  v_add_f32 v8, v8, v46
  v_add_u32 v4, 16384, v4
  v_mfma_f32_32x32x16_bf16 a[32:47], a[232:235], v[96:99], a[32:47]
  buffer_load_dwordx4 v3, s[4:7], s18 offen offset:1024 sc1 lds
  v_exp_f32 v48, v48
  v_add_f32 v9, v9, v47
  v_cvt_pk_bf16_f32 v103, v46, v47
  v_mfma_f32_32x32x16_bf16 a[48:63], a[236:239], v[96:99], a[48:63]
  s_waitcnt lgkmcnt(10)
  s_add_u32 m0, s21, 8192
  v_exp_f32 v49, v49
  v_add_f32 v10, v10, v48
  v_and_b32 v4, 131071, v4
  v_mfma_f32_32x32x16_bf16 a[0:15], a[240:243], v[100:103], a[0:15]
  buffer_load_dwordx4 v3, s[4:7], s17 offen offset:0 sc1 lds
  v_exp_f32 v50, v50
  v_add_f32 v11, v11, v49
  v_cvt_pk_bf16_f32 v104, v48, v49
  v_mfma_f32_32x32x16_bf16 a[16:31], a[244:247], v[100:103], a[16:31]
  s_waitcnt lgkmcnt(8)
  s_cmp_lg_u32 s22, 0
  v_exp_f32 v51, v51
  v_add_f32 v10, v10, v50
  v_mfma_f32_32x32x16_bf16 a[32:47], a[248:251], v[100:103], a[32:47]
  buffer_load_dwordx4 v3, s[4:7], s17 offen offset:1024 sc1 lds
  v_exp_f32 v52, v52
  v_add_f32 v11, v11, v51
  v_cvt_pk_bf16_f32 v105, v50, v51
  v_mfma_f32_32x32x16_bf16 a[48:63], a[252:255], v[100:103], a[48:63]
  v_exp_f32 v53, v53
  v_add_f32 v10, v10, v52
  s_cbranch_scc1 A_top_33
  v_exp_f32 v54, v54
  v_add_f32 v11, v11, v53
  v_cvt_pk_bf16_f32 v106, v52, v53
  v_exp_f32 v55, v55
  v_add_f32 v10, v10, v54
  v_exp_f32 v56, v56
  v_add_f32 v11, v11, v55
  v_cvt_pk_bf16_f32 v107, v54, v55
  v_exp_f32 v57, v57
  v_add_f32 v10, v10, v56
  v_exp_f32 v58, v58
  v_add_f32 v11, v11, v57
  v_cvt_pk_bf16_f32 v108, v56, v57
  v_exp_f32 v59, v59
  v_add_f32 v10, v10, v58
  v_exp_f32 v60, v60
  v_add_f32 v11, v11, v59
  v_cvt_pk_bf16_f32 v109, v58, v59
  v_exp_f32 v61, v61
  v_add_f32 v10, v10, v60
  v_exp_f32 v62, v62
  v_add_f32 v11, v11, v61
  v_cvt_pk_bf16_f32 v110, v60, v61
  v_exp_f32 v63, v63
  v_add_f32 v10, v10, v62
  v_add_f32 v11, v11, v63
  v_cvt_pk_bf16_f32 v111, v62, v63
  s_nop 1
  v_mfma_f32_32x32x16_bf16 a[64:79], a[224:227], v[104:107], a[64:79]
  v_mfma_f32_32x32x16_bf16 a[80:95], a[228:231], v[104:107], a[80:95]
  v_mfma_f32_32x32x16_bf16 a[96:111], a[232:235], v[104:107], a[96:111]
  v_mfma_f32_32x32x16_bf16 a[112:127], a[236:239], v[104:107], a[112:127]
  v_mfma_f32_32x32x16_bf16 a[64:79], a[240:243], v[108:111], a[64:79]
  v_mfma_f32_32x32x16_bf16 a[80:95], a[244:247], v[108:111], a[80:95]
  v_mfma_f32_32x32x16_bf16 a[96:111], a[248:251], v[108:111], a[96:111]
  v_mfma_f32_32x32x16_bf16 a[112:127], a[252:255], v[108:111], a[112:127]
  v_add_f32 v8, v8, v9
  v_mov_b32 v9, v8
  s_nop 1
  v_permlane32_swap_b32 v8, v9
  s_nop 1
  v_add_f32 v8, v8, v9
  v_add_f32 v10, v10, v11
  v_mov_b32 v11, v10
  s_nop 1
  v_permlane32_swap_b32 v10, v11
  s_nop 1
  v_add_f32 v10, v10, v11
  v_subrev_u32 v12, 0x2f800000, v8
  v_subrev_u32 v13, 0x2f800000, v10
  v_max_u32 v12, v12, v13
  v_cmp_le_u32 vcc, 0x28000000, v12
  s_nop 1
  s_cmp_lg_u64 vcc, 0
  s_cselect_b32 s26, 1, 0
  v_mov_b32 v12, s26
  s_lshl_b32 s26, s16, 2
  s_add_u32 s26, s26, 131072
  v_mov_b32 v13, s26
  ds_write_b32 v13, v12
  v_mov_b32 v14, 131072
  s_waitcnt vmcnt(0) lgkmcnt(0)
  s_barrier
  ds_read_b128 v[16:19], v14
  v_rcp_f32 v8, v8
  v_rcp_f32 v10, v10
  s_waitcnt lgkmcnt(0)
  v_or3_b32 v12, v16, v17, v18
  v_or_b32 v12, v12, v19
  s_nop 0
  v_readfirstlane_b32 s26, v12
  s_nop 1
  s_cmp_gt_u32 s26, s29
  s_cbranch_scc1 A_slow_39
  s_add_u32 s28, s25, 100663296
  v_accvgpr_read_b32 v112, a0
  v_accvgpr_read_b32 v113, a1
  v_accvgpr_read_b32 v114, a2
  v_accvgpr_read_b32 v115, a3
  v_accvgpr_read_b32 v116, a4
  v_accvgpr_read_b32 v117, a5
  v_accvgpr_read_b32 v118, a6
  v_accvgpr_read_b32 v119, a7
  v_pk_mul_f32 v[112:113], v[112:113], v[8:9] op_sel_hi:[1,0]
  v_pk_mul_f32 v[114:115], v[114:115], v[8:9] op_sel_hi:[1,0]
  v_pk_mul_f32 v[116:117], v[116:117], v[8:9] op_sel_hi:[1,0]
  v_pk_mul_f32 v[118:119], v[118:119], v[8:9] op_sel_hi:[1,0]
  v_cvt_pk_bf16_f32 v120, v112, v113
  v_cvt_pk_bf16_f32 v121, v114, v115
  v_cvt_pk_bf16_f32 v122, v116, v117
  v_cvt_pk_bf16_f32 v123, v118, v119
  buffer_store_dwordx4 v[120:123], v2, s[4:7], s28 offen offset:0 sc1
  v_accvgpr_read_b32 v124, a8
  v_accvgpr_read_b32 v125, a9
  v_accvgpr_read_b32 v126, a10
  v_accvgpr_read_b32 v127, a11
  v_accvgpr_read_b32 v128, a12
  v_accvgpr_read_b32 v129, a13
  v_accvgpr_read_b32 v130, a14
  v_accvgpr_read_b32 v131, a15
  v_pk_mul_f32 v[124:125], v[124:125], v[8:9] op_sel_hi:[1,0]
  v_pk_mul_f32 v[126:127], v[126:127], v[8:9] op_sel_hi:[1,0]
  v_pk_mul_f32 v[128:129], v[128:129], v[8:9] op_sel_hi:[1,0]
  v_pk_mul_f32 v[130:131], v[130:131], v[8:9] op_sel_hi:[1,0]
  v_cvt_pk_bf16_f32 v132, v124, v125
  v_cvt_pk_bf16_f32 v133, v126, v127
  v_cvt_pk_bf16_f32 v134, v128, v129
  v_cvt_pk_bf16_f32 v135, v130, v131
  buffer_store_dwordx4 v[132:135], v2, s[4:7], s28 offen offset:1024 sc1
  v_accvgpr_read_b32 v136, a16
  v_accvgpr_read_b32 v137, a17
  v_accvgpr_read_b32 v138, a18
  v_accvgpr_read_b32 v139, a19
  v_accvgpr_read_b32 v140, a20
  v_accvgpr_read_b32 v141, a21
  v_accvgpr_read_b32 v142, a22
  v_accvgpr_read_b32 v143, a23
  v_pk_mul_f32 v[136:137], v[136:137], v[8:9] op_sel_hi:[1,0]
  v_pk_mul_f32 v[138:139], v[138:139], v[8:9] op_sel_hi:[1,0]
  v_pk_mul_f32 v[140:141], v[140:141], v[8:9] op_sel_hi:[1,0]
  v_pk_mul_f32 v[142:143], v[142:143], v[8:9] op_sel_hi:[1,0]
  v_cvt_pk_bf16_f32 v144, v136, v137
  v_cvt_pk_bf16_f32 v145, v138, v139
  v_cvt_pk_bf16_f32 v146, v140, v141
  v_cvt_pk_bf16_f32 v147, v142, v143
  buffer_store_dwordx4 v[144:147], v2, s[4:7], s28 offen offset:2048 sc1
  v_accvgpr_read_b32 v148, a24
  v_accvgpr_read_b32 v149, a25
  v_accvgpr_read_b32 v150, a26
  v_accvgpr_read_b32 v151, a27
  v_accvgpr_read_b32 v152, a28
  v_accvgpr_read_b32 v153, a29
  v_accvgpr_read_b32 v154, a30
  v_accvgpr_read_b32 v155, a31
  v_pk_mul_f32 v[148:149], v[148:149], v[8:9] op_sel_hi:[1,0]
  v_pk_mul_f32 v[150:151], v[150:151], v[8:9] op_sel_hi:[1,0]
  v_pk_mul_f32 v[152:153], v[152:153], v[8:9] op_sel_hi:[1,0]
  v_pk_mul_f32 v[154:155], v[154:155], v[8:9] op_sel_hi:[1,0]
  v_cvt_pk_bf16_f32 v156, v148, v149
  v_cvt_pk_bf16_f32 v157, v150, v151
  v_cvt_pk_bf16_f32 v158, v152, v153
  v_cvt_pk_bf16_f32 v159, v154, v155
  buffer_store_dwordx4 v[156:159], v2, s[4:7], s28 offen offset:3072 sc1
  s_add_u32 s28, s25, 100667392
  v_accvgpr_read_b32 v112, a32
  v_accvgpr_read_b32 v113, a33
  v_accvgpr_read_b32 v114, a34
  v_accvgpr_read_b32 v115, a35
  v_accvgpr_read_b32 v116, a36
  v_accvgpr_read_b32 v117, a37
  v_accvgpr_read_b32 v118, a38
  v_accvgpr_read_b32 v119, a39
  v_pk_mul_f32 v[112:113], v[112:113], v[8:9] op_sel_hi:[1,0]
  v_pk_mul_f32 v[114:115], v[114:115], v[8:9] op_sel_hi:[1,0]
  v_pk_mul_f32 v[116:117], v[116:117], v[8:9] op_sel_hi:[1,0]
  v_pk_mul_f32 v[118:119], v[118:119], v[8:9] op_sel_hi:[1,0]
  v_cvt_pk_bf16_f32 v120, v112, v113
  v_cvt_pk_bf16_f32 v121, v114, v115
  v_cvt_pk_bf16_f32 v122, v116, v117
  v_cvt_pk_bf16_f32 v123, v118, v119
  buffer_store_dwordx4 v[120:123], v2, s[4:7], s28 offen offset:0 sc1
  v_accvgpr_read_b32 v124, a40
  v_accvgpr_read_b32 v125, a41
  v_accvgpr_read_b32 v126, a42
  v_accvgpr_read_b32 v127, a43
  v_accvgpr_read_b32 v128, a44
  v_accvgpr_read_b32 v129, a45
  v_accvgpr_read_b32 v130, a46
  v_accvgpr_read_b32 v131, a47
  v_pk_mul_f32 v[124:125], v[124:125], v[8:9] op_sel_hi:[1,0]
  v_pk_mul_f32 v[126:127], v[126:127], v[8:9] op_sel_hi:[1,0]
  v_pk_mul_f32 v[128:129], v[128:129], v[8:9] op_sel_hi:[1,0]
  v_pk_mul_f32 v[130:131], v[130:131], v[8:9] op_sel_hi:[1,0]
  v_cvt_pk_bf16_f32 v132, v124, v125
  v_cvt_pk_bf16_f32 v133, v126, v127
  v_cvt_pk_bf16_f32 v134, v128, v129
  v_cvt_pk_bf16_f32 v135, v130, v131
  buffer_store_dwordx4 v[132:135], v2, s[4:7], s28 offen offset:1024 sc1
  v_accvgpr_read_b32 v136, a48
  v_accvgpr_read_b32 v137, a49
  v_accvgpr_read_b32 v138, a50
  v_accvgpr_read_b32 v139, a51
  v_accvgpr_read_b32 v140, a52
  v_accvgpr_read_b32 v141, a53
  v_accvgpr_read_b32 v142, a54
  v_accvgpr_read_b32 v143, a55
  v_pk_mul_f32 v[136:137], v[136:137], v[8:9] op_sel_hi:[1,0]
  v_pk_mul_f32 v[138:139], v[138:139], v[8:9] op_sel_hi:[1,0]
  v_pk_mul_f32 v[140:141], v[140:141], v[8:9] op_sel_hi:[1,0]
  v_pk_mul_f32 v[142:143], v[142:143], v[8:9] op_sel_hi:[1,0]
  v_cvt_pk_bf16_f32 v144, v136, v137
  v_cvt_pk_bf16_f32 v145, v138, v139
  v_cvt_pk_bf16_f32 v146, v140, v141
  v_cvt_pk_bf16_f32 v147, v142, v143
  buffer_store_dwordx4 v[144:147], v2, s[4:7], s28 offen offset:2048 sc1
  v_accvgpr_read_b32 v148, a56
  v_accvgpr_read_b32 v149, a57
  v_accvgpr_read_b32 v150, a58
  v_accvgpr_read_b32 v151, a59
  v_accvgpr_read_b32 v152, a60
  v_accvgpr_read_b32 v153, a61
  v_accvgpr_read_b32 v154, a62
  v_accvgpr_read_b32 v155, a63
  v_pk_mul_f32 v[148:149], v[148:149], v[8:9] op_sel_hi:[1,0]
  v_pk_mul_f32 v[150:151], v[150:151], v[8:9] op_sel_hi:[1,0]
  v_pk_mul_f32 v[152:153], v[152:153], v[8:9] op_sel_hi:[1,0]
  v_pk_mul_f32 v[154:155], v[154:155], v[8:9] op_sel_hi:[1,0]
  v_cvt_pk_bf16_f32 v156, v148, v149
  v_cvt_pk_bf16_f32 v157, v150, v151
  v_cvt_pk_bf16_f32 v158, v152, v153
  v_cvt_pk_bf16_f32 v159, v154, v155
  buffer_store_dwordx4 v[156:159], v2, s[4:7], s28 offen offset:3072 sc1
  s_add_u32 s28, s25, 100671488
  v_accvgpr_read_b32 v112, a64
  v_accvgpr_read_b32 v113, a65
  v_accvgpr_read_b32 v114, a66
  v_accvgpr_read_b32 v115, a67
  v_accvgpr_read_b32 v116, a68
  v_accvgpr_read_b32 v117, a69
  v_accvgpr_read_b32 v118, a70
  v_accvgpr_read_b32 v119, a71
  v_pk_mul_f32 v[112:113], v[112:113], v[10:11] op_sel_hi:[1,0]
  v_pk_mul_f32 v[114:115], v[114:115], v[10:11] op_sel_hi:[1,0]
  v_pk_mul_f32 v[116:117], v[116:117], v[10:11] op_sel_hi:[1,0]
  v_pk_mul_f32 v[118:119], v[118:119], v[10:11] op_sel_hi:[1,0]
  v_cvt_pk_bf16_f32 v120, v112, v113
  v_cvt_pk_bf16_f32 v121, v114, v115
  v_cvt_pk_bf16_f32 v122, v116, v117
  v_cvt_pk_bf16_f32 v123, v118, v119
  buffer_store_dwordx4 v[120:123], v2, s[4:7], s28 offen offset:0 sc1
  v_accvgpr_read_b32 v124, a72
  v_accvgpr_read_b32 v125, a73
  v_accvgpr_read_b32 v126, a74
  v_accvgpr_read_b32 v127, a75
  v_accvgpr_read_b32 v128, a76
  v_accvgpr_read_b32 v129, a77
  v_accvgpr_read_b32 v130, a78
  v_accvgpr_read_b32 v131, a79
  v_pk_mul_f32 v[124:125], v[124:125], v[10:11] op_sel_hi:[1,0]
  v_pk_mul_f32 v[126:127], v[126:127], v[10:11] op_sel_hi:[1,0]
  v_pk_mul_f32 v[128:129], v[128:129], v[10:11] op_sel_hi:[1,0]
  v_pk_mul_f32 v[130:131], v[130:131], v[10:11] op_sel_hi:[1,0]
  v_cvt_pk_bf16_f32 v132, v124, v125
  v_cvt_pk_bf16_f32 v133, v126, v127
  v_cvt_pk_bf16_f32 v134, v128, v129
  v_cvt_pk_bf16_f32 v135, v130, v131
  buffer_store_dwordx4 v[132:135], v2, s[4:7], s28 offen offset:1024 sc1
  v_accvgpr_read_b32 v136, a80
  v_accvgpr_read_b32 v137, a81
  v_accvgpr_read_b32 v138, a82
  v_accvgpr_read_b32 v139, a83
  v_accvgpr_read_b32 v140, a84
  v_accvgpr_read_b32 v141, a85
  v_accvgpr_read_b32 v142, a86
  v_accvgpr_read_b32 v143, a87
  v_pk_mul_f32 v[136:137], v[136:137], v[10:11] op_sel_hi:[1,0]
  v_pk_mul_f32 v[138:139], v[138:139], v[10:11] op_sel_hi:[1,0]
  v_pk_mul_f32 v[140:141], v[140:141], v[10:11] op_sel_hi:[1,0]
  v_pk_mul_f32 v[142:143], v[142:143], v[10:11] op_sel_hi:[1,0]
  v_cvt_pk_bf16_f32 v144, v136, v137
  v_cvt_pk_bf16_f32 v145, v138, v139
  v_cvt_pk_bf16_f32 v146, v140, v141
  v_cvt_pk_bf16_f32 v147, v142, v143
  buffer_store_dwordx4 v[144:147], v2, s[4:7], s28 offen offset:2048 sc1
  v_accvgpr_read_b32 v148, a88
  v_accvgpr_read_b32 v149, a89
  v_accvgpr_read_b32 v150, a90
  v_accvgpr_read_b32 v151, a91
  v_accvgpr_read_b32 v152, a92
  v_accvgpr_read_b32 v153, a93
  v_accvgpr_read_b32 v154, a94
  v_accvgpr_read_b32 v155, a95
  v_pk_mul_f32 v[148:149], v[148:149], v[10:11] op_sel_hi:[1,0]
  v_pk_mul_f32 v[150:151], v[150:151], v[10:11] op_sel_hi:[1,0]
  v_pk_mul_f32 v[152:153], v[152:153], v[10:11] op_sel_hi:[1,0]
  v_pk_mul_f32 v[154:155], v[154:155], v[10:11] op_sel_hi:[1,0]
  v_cvt_pk_bf16_f32 v156, v148, v149
  v_cvt_pk_bf16_f32 v157, v150, v151
  v_cvt_pk_bf16_f32 v158, v152, v153
  v_cvt_pk_bf16_f32 v159, v154, v155
  buffer_store_dwordx4 v[156:159], v2, s[4:7], s28 offen offset:3072 sc1
  s_add_u32 s28, s25, 100675584
  v_accvgpr_read_b32 v112, a96
  v_accvgpr_read_b32 v113, a97
  v_accvgpr_read_b32 v114, a98
  v_accvgpr_read_b32 v115, a99
  v_accvgpr_read_b32 v116, a100
  v_accvgpr_read_b32 v117, a101
  v_accvgpr_read_b32 v118, a102
  v_accvgpr_read_b32 v119, a103
  v_pk_mul_f32 v[112:113], v[112:113], v[10:11] op_sel_hi:[1,0]
  v_pk_mul_f32 v[114:115], v[114:115], v[10:11] op_sel_hi:[1,0]
  v_pk_mul_f32 v[116:117], v[116:117], v[10:11] op_sel_hi:[1,0]
  v_pk_mul_f32 v[118:119], v[118:119], v[10:11] op_sel_hi:[1,0]
  v_cvt_pk_bf16_f32 v120, v112, v113
  v_cvt_pk_bf16_f32 v121, v114, v115
  v_cvt_pk_bf16_f32 v122, v116, v117
  v_cvt_pk_bf16_f32 v123, v118, v119
  buffer_store_dwordx4 v[120:123], v2, s[4:7], s28 offen offset:0 sc1
  v_accvgpr_read_b32 v124, a104
  v_accvgpr_read_b32 v125, a105
  v_accvgpr_read_b32 v126, a106
  v_accvgpr_read_b32 v127, a107
  v_accvgpr_read_b32 v128, a108
  v_accvgpr_read_b32 v129, a109
  v_accvgpr_read_b32 v130, a110
  v_accvgpr_read_b32 v131, a111
  v_pk_mul_f32 v[124:125], v[124:125], v[10:11] op_sel_hi:[1,0]
  v_pk_mul_f32 v[126:127], v[126:127], v[10:11] op_sel_hi:[1,0]
  v_pk_mul_f32 v[128:129], v[128:129], v[10:11] op_sel_hi:[1,0]
  v_pk_mul_f32 v[130:131], v[130:131], v[10:11] op_sel_hi:[1,0]
  v_cvt_pk_bf16_f32 v132, v124, v125
  v_cvt_pk_bf16_f32 v133, v126, v127
  v_cvt_pk_bf16_f32 v134, v128, v129
  v_cvt_pk_bf16_f32 v135, v130, v131
  buffer_store_dwordx4 v[132:135], v2, s[4:7], s28 offen offset:1024 sc1
  v_accvgpr_read_b32 v136, a112
  v_accvgpr_read_b32 v137, a113
  v_accvgpr_read_b32 v138, a114
  v_accvgpr_read_b32 v139, a115
  v_accvgpr_read_b32 v140, a116
  v_accvgpr_read_b32 v141, a117
  v_accvgpr_read_b32 v142, a118
  v_accvgpr_read_b32 v143, a119
  v_pk_mul_f32 v[136:137], v[136:137], v[10:11] op_sel_hi:[1,0]
  v_pk_mul_f32 v[138:139], v[138:139], v[10:11] op_sel_hi:[1,0]
  v_pk_mul_f32 v[140:141], v[140:141], v[10:11] op_sel_hi:[1,0]
  v_pk_mul_f32 v[142:143], v[142:143], v[10:11] op_sel_hi:[1,0]
  v_cvt_pk_bf16_f32 v144, v136, v137
  v_cvt_pk_bf16_f32 v145, v138, v139
  v_cvt_pk_bf16_f32 v146, v140, v141
  v_cvt_pk_bf16_f32 v147, v142, v143
  buffer_store_dwordx4 v[144:147], v2, s[4:7], s28 offen offset:2048 sc1
  v_accvgpr_read_b32 v148, a120
  v_accvgpr_read_b32 v149, a121
  v_accvgpr_read_b32 v150, a122
  v_accvgpr_read_b32 v151, a123
  v_accvgpr_read_b32 v152, a124
  v_accvgpr_read_b32 v153, a125
  v_accvgpr_read_b32 v154, a126
  v_accvgpr_read_b32 v155, a127
  v_pk_mul_f32 v[148:149], v[148:149], v[10:11] op_sel_hi:[1,0]
  v_pk_mul_f32 v[150:151], v[150:151], v[10:11] op_sel_hi:[1,0]
  v_pk_mul_f32 v[152:153], v[152:153], v[10:11] op_sel_hi:[1,0]
  v_pk_mul_f32 v[154:155], v[154:155], v[10:11] op_sel_hi:[1,0]
  v_cvt_pk_bf16_f32 v156, v148, v149
  v_cvt_pk_bf16_f32 v157, v150, v151
  v_cvt_pk_bf16_f32 v158, v152, v153
  v_cvt_pk_bf16_f32 v159, v154, v155
  buffer_store_dwordx4 v[156:159], v2, s[4:7], s28 offen offset:3072 sc1
  s_branch A_out_36
A_kvw_37:
M_kv_40:
  s_cmp_ge_u32 s17, s36
  s_cbranch_scc1 M_kvok_41
  s_mov_b32 s76, 0
  s_mov_b32 s78, 23
  s_mov_b32 s77, 335872
  s_cmp_eq_u32 s68, 1
  s_cmov_b32 s76, 128
  s_cmov_b32 s78, 27
  s_cmov_b32 s77, 114688
  s_cmp_eq_u32 s68, 2
  s_cmov_b32 s76, 768
  s_cmov_b32 s78, 14
  s_cmov_b32 s77, 0
  s_add_u32 s76, s76, s67
  s_mov_b32 s71, 0
  s_branch M_sg_43
M_sw_42:
  s_sleep 8
  s_add_u32 s71, s71, 1
  s_cmp_gt_u32 s71, 262144
  s_cbranch_scc1 M_exit
M_sg_43:
  s_mov_b32 s79, 0
  s_atomic_or s79, s[72:73], s76 glc
  s_waitcnt lgkmcnt(0)
  s_cmp_lt_u32 s79, s78
  s_cbranch_scc1 M_sw_42
  s_add_u32 s36, s77, s19
  s_add_u32 s68, s68, 1
  s_branch M_kv_40
M_kvok_41:
  s_branch A_kvb_38
A_upd_34:
  s_cmp_eq_u32 s23, 2
  s_cbranch_scc1 A_upd2_44
  v_mov_b32 v12, s24
  v_cmp_le_i32 s[40:41], 0, v5
  v_cmp_le_i32 s[42:43], 1, v5
  v_cmp_le_i32 s[44:45], 2, v5
  v_cmp_le_i32 s[46:47], 3, v5
  v_cndmask_b32 v64, v12, v6, s[40:41]
  v_cndmask_b32 v65, v12, v6, s[42:43]
  v_cndmask_b32 v66, v12, v6, s[44:45]
  v_cndmask_b32 v67, v12, v6, s[46:47]
  v_cmp_le_i32 s[40:41], 8, v5
  v_cmp_le_i32 s[42:43], 9, v5
  v_cmp_le_i32 s[44:45], 10, v5
  v_cmp_le_i32 s[46:47], 11, v5
  v_cndmask_b32 v68, v12, v6, s[40:41]
  v_cndmask_b32 v69, v12, v6, s[42:43]
  v_cndmask_b32 v70, v12, v6, s[44:45]
  v_cndmask_b32 v71, v12, v6, s[46:47]
  v_cmp_le_i32 s[40:41], 16, v5
  v_cmp_le_i32 s[42:43], 17, v5
  v_cmp_le_i32 s[44:45], 18, v5
  v_cmp_le_i32 s[46:47], 19, v5
  v_cndmask_b32 v72, v12, v6, s[40:41]
  v_cndmask_b32 v73, v12, v6, s[42:43]
  v_cndmask_b32 v74, v12, v6, s[44:45]
  v_cndmask_b32 v75, v12, v6, s[46:47]
  v_cmp_le_i32 s[40:41], 24, v5
  v_cmp_le_i32 s[42:43], 25, v5
  v_cmp_le_i32 s[44:45], 26, v5
  v_cmp_le_i32 s[46:47], 27, v5
  v_cndmask_b32 v76, v12, v6, s[40:41]
  v_cndmask_b32 v77, v12, v6, s[42:43]
  v_cndmask_b32 v78, v12, v6, s[44:45]
  v_cndmask_b32 v79, v12, v6, s[46:47]
  v_mov_b32 v80, v7
  v_mov_b32 v81, v7
  v_mov_b32 v82, v7
  v_mov_b32 v83, v7
  v_mov_b32 v84, v7
  v_mov_b32 v85, v7
  v_mov_b32 v86, v7
  v_mov_b32 v87, v7
  v_mov_b32 v88, v7
  v_mov_b32 v89, v7
  v_mov_b32 v90, v7
  v_mov_b32 v91, v7
  v_mov_b32 v92, v7
  v_mov_b32 v93, v7
  v_mov_b32 v94, v7
  v_mov_b32 v95, v7
  s_branch A_back_35
A_upd2_44:
  v_mov_b32 v64, v6
  v_mov_b32 v65, v6
  v_mov_b32 v66, v6
  v_mov_b32 v67, v6
  v_mov_b32 v68, v6
  v_mov_b32 v69, v6
  v_mov_b32 v70, v6
  v_mov_b32 v71, v6
  v_mov_b32 v72, v6
  v_mov_b32 v73, v6
  v_mov_b32 v74, v6
  v_mov_b32 v75, v6
  v_mov_b32 v76, v6
  v_mov_b32 v77, v6
  v_mov_b32 v78, v6
  v_mov_b32 v79, v6
  s_branch A_back_35
A_slow_39:
  s_mov_b32 s29, 1
  v_mov_b32 v64, s24
  v_mov_b32 v65, s24
  v_mov_b32 v66, s24
  v_mov_b32 v67, s24
  v_mov_b32 v68, s24
  v_mov_b32 v69, s24
  v_mov_b32 v70, s24
  v_mov_b32 v71, s24
  v_mov_b32 v72, s24
  v_mov_b32 v73, s24
  v_mov_b32 v74, s24
  v_mov_b32 v75, s24
  v_mov_b32 v76, s24
  v_mov_b32 v77, s24
  v_mov_b32 v78, s24
  v_mov_b32 v79, s24
  v_mov_b32 v12, s24
  v_cmp_le_i32 s[40:41], 0, v5
  v_cmp_le_i32 s[42:43], 1, v5
  v_cmp_le_i32 s[44:45], 2, v5
  v_cmp_le_i32 s[46:47], 3, v5
  v_cndmask_b32 v80, v12, v7, s[40:41]
  v_cndmask_b32 v81, v12, v7, s[42:43]
  v_cndmask_b32 v82, v12, v7, s[44:45]
  v_cndmask_b32 v83, v12, v7, s[46:47]
  v_cmp_le_i32 s[40:41], 8, v5
  v_cmp_le_i32 s[42:43], 9, v5
  v_cmp_le_i32 s[44:45], 10, v5
  v_cmp_le_i32 s[46:47], 11, v5
  v_cndmask_b32 v84, v12, v7, s[40:41]
  v_cndmask_b32 v85, v12, v7, s[42:43]
  v_cndmask_b32 v86, v12, v7, s[44:45]
  v_cndmask_b32 v87, v12, v7, s[46:47]
  v_cmp_le_i32 s[40:41], 16, v5
  v_cmp_le_i32 s[42:43], 17, v5
  v_cmp_le_i32 s[44:45], 18, v5
  v_cmp_le_i32 s[46:47], 19, v5
  v_cndmask_b32 v88, v12, v7, s[40:41]
  v_cndmask_b32 v89, v12, v7, s[42:43]
  v_cndmask_b32 v90, v12, v7, s[44:45]
  v_cndmask_b32 v91, v12, v7, s[46:47]
  v_cmp_le_i32 s[40:41], 24, v5
  v_cmp_le_i32 s[42:43], 25, v5
  v_cmp_le_i32 s[44:45], 26, v5
  v_cmp_le_i32 s[46:47], 27, v5
  v_cndmask_b32 v92, v12, v7, s[40:41]
  v_cndmask_b32 v93, v12, v7, s[42:43]
  v_cndmask_b32 v94, v12, v7, s[44:45]
  v_cndmask_b32 v95, v12, v7, s[46:47]
  v_mov_b32 v8, s24
  v_mov_b32 v10, s24
  s_add_u32 s17, s25, 16785408
  s_mov_b32 s23, 0
A_ml_45:
  s_add_u32 s28, s17, 4096
  buffer_load_dwordx4 a[192:195], v2, s[4:7], s17 offen offset:0 sc1
  buffer_load_dwordx4 a[196:199], v2, s[4:7], s17 offen offset:1024 sc1
  buffer_load_dwordx4 a[200:203], v2, s[4:7], s17 offen offset:2048 sc1
  buffer_load_dwordx4 a[204:207], v2, s[4:7], s17 offen offset:3072 sc1
  buffer_load_dwordx4 a[208:211], v2, s[4:7], s28 offen offset:0 sc1
  buffer_load_dwordx4 a[212:215], v2, s[4:7], s28 offen offset:1024 sc1
  buffer_load_dwordx4 a[216:219], v2, s[4:7], s28 offen offset:2048 sc1
  buffer_load_dwordx4 a[220:223], v2, s[4:7], s28 offen offset:3072 sc1
  s_waitcnt vmcnt(0)
  v_mfma_f32_32x32x16_bf16 v[32:47], a[192:195], a[128:131], v[64:79]
  v_mfma_f32_32x32x16_bf16 v[32:47], a[196:199], a[132:135], v[32:47]
  v_mfma_f32_32x32x16_bf16 v[32:47], a[200:203], a[136:139], v[32:47]
  v_mfma_f32_32x32x16_bf16 v[32:47], a[204:207], a[140:143], v[32:47]
  v_mfma_f32_32x32x16_bf16 v[32:47], a[208:211], a[144:147], v[32:47]
  v_mfma_f32_32x32x16_bf16 v[32:47], a[212:215], a[148:151], v[32:47]
  v_mfma_f32_32x32x16_bf16 v[32:47], a[216:219], a[152:155], v[32:47]
  v_mfma_f32_32x32x16_bf16 v[32:47], a[220:223], a[156:159], v[32:47]
  v_mfma_f32_32x32x16_bf16 v[48:63], a[192:195], a[160:163], v[80:95]
  v_mfma_f32_32x32x16_bf16 v[48:63], a[196:199], a[164:167], v[48:63]
  v_mfma_f32_32x32x16_bf16 v[48:63], a[200:203], a[168:171], v[48:63]
  v_mfma_f32_32x32x16_bf16 v[48:63], a[204:207], a[172:175], v[48:63]
  v_mfma_f32_32x32x16_bf16 v[48:63], a[208:211], a[176:179], v[48:63]
  v_mfma_f32_32x32x16_bf16 v[48:63], a[212:215], a[180:183], v[48:63]
  v_mfma_f32_32x32x16_bf16 v[48:63], a[216:219], a[184:187], v[48:63]
  v_mfma_f32_32x32x16_bf16 v[48:63], a[220:223], a[188:191], v[48:63]
  s_nop 7
  s_nop 3
  v_max3_f32 v8, v8, v32, v33
  v_max3_f32 v8, v8, v34, v35
  v_max3_f32 v8, v8, v36, v37
  v_max3_f32 v8, v8, v38, v39
  v_max3_f32 v8, v8, v40, v41
  v_max3_f32 v8, v8, v42, v43
  v_max3_f32 v8, v8, v44, v45
  v_max3_f32 v8, v8, v46, v47
  v_max3_f32 v10, v10, v48, v49
  v_max3_f32 v10, v10, v50, v51
  v_max3_f32 v10, v10, v52, v53
  v_max3_f32 v10, v10, v54, v55
  v_max3_f32 v10, v10, v56, v57
  v_max3_f32 v10, v10, v58, v59
  v_max3_f32 v10, v10, v60, v61
  v_max3_f32 v10, v10, v62, v63
  s_add_u32 s23, s23, 1
  s_cmp_lg_u32 s23, 1
  s_cbranch_scc1 A_m2_46
  v_mov_b32 v12, s24
  v_cmp_le_i32 s[40:41], 0, v5
  v_cmp_le_i32 s[42:43], 1, v5
  v_cmp_le_i32 s[44:45], 2, v5
  v_cmp_le_i32 s[46:47], 3, v5
  v_cndmask_b32 v64, v12, v6, s[40:41]
  v_cndmask_b32 v65, v12, v6, s[42:43]
  v_cndmask_b32 v66, v12, v6, s[44:45]
  v_cndmask_b32 v67, v12, v6, s[46:47]
  v_cmp_le_i32 s[40:41], 8, v5
  v_cmp_le_i32 s[42:43], 9, v5
  v_cmp_le_i32 s[44:45], 10, v5
  v_cmp_le_i32 s[46:47], 11, v5
  v_cndmask_b32 v68, v12, v6, s[40:41]
  v_cndmask_b32 v69, v12, v6, s[42:43]
  v_cndmask_b32 v70, v12, v6, s[44:45]
  v_cndmask_b32 v71, v12, v6, s[46:47]
  v_cmp_le_i32 s[40:41], 16, v5
  v_cmp_le_i32 s[42:43], 17, v5
  v_cmp_le_i32 s[44:45], 18, v5
  v_cmp_le_i32 s[46:47], 19, v5
  v_cndmask_b32 v72, v12, v6, s[40:41]
  v_cndmask_b32 v73, v12, v6, s[42:43]
  v_cndmask_b32 v74, v12, v6, s[44:45]
  v_cndmask_b32 v75, v12, v6, s[46:47]
  v_cmp_le_i32 s[40:41], 24, v5
  v_cmp_le_i32 s[42:43], 25, v5
  v_cmp_le_i32 s[44:45], 26, v5
  v_cmp_le_i32 s[46:47], 27, v5
  v_cndmask_b32 v76, v12, v6, s[40:41]
  v_cndmask_b32 v77, v12, v6, s[42:43]
  v_cndmask_b32 v78, v12, v6, s[44:45]
  v_cndmask_b32 v79, v12, v6, s[46:47]
  v_mov_b32 v80, v7
  v_mov_b32 v81, v7
  v_mov_b32 v82, v7
  v_mov_b32 v83, v7
  v_mov_b32 v84, v7
  v_mov_b32 v85, v7
  v_mov_b32 v86, v7
  v_mov_b32 v87, v7
  v_mov_b32 v88, v7
  v_mov_b32 v89, v7
  v_mov_b32 v90, v7
  v_mov_b32 v91, v7
  v_mov_b32 v92, v7
  v_mov_b32 v93, v7
  v_mov_b32 v94, v7
  v_mov_b32 v95, v7
A_m2_46:
  s_cmp_lg_u32 s23, 2
  s_cbranch_scc1 A_m3_47
  v_mov_b32 v64, v6
  v_mov_b32 v65, v6
  v_mov_b32 v66, v6
  v_mov_b32 v67, v6
  v_mov_b32 v68, v6
  v_mov_b32 v69, v6
  v_mov_b32 v70, v6
  v_mov_b32 v71, v6
  v_mov_b32 v72, v6
  v_mov_b32 v73, v6
  v_mov_b32 v74, v6
  v_mov_b32 v75, v6
  v_mov_b32 v76, v6
  v_mov_b32 v77, v6
  v_mov_b32 v78, v6
  v_mov_b32 v79, v6
A_m3_47:
  s_sub_u32 s17, s17, 8192
  s_cmp_ge_i32 s17, s19
  s_cbranch_scc1 A_ml_45
  v_mov_b32 v9, v8
  s_nop 1
  v_permlane32_swap_b32 v8, v9
  s_nop 1
  v_max_f32 v8, v8, v9
  v_sub_f32 v6, 0, v8
  v_mov_b32 v11, v10
  s_nop 1
  v_permlane32_swap_b32 v10, v11
  s_nop 1
  v_max_f32 v10, v10, v11
  v_sub_f32 v7, 0, v10
  s_branch A_again_26
A_out_36:
  s_mov_b32 s69, s55
  s_mov_b32 s70, s56
  s_sub_u32 s52, s52, 1
  s_cmp_lg_u32 s52, 0
  s_cbranch_scc1 M_att
  s_waitcnt vmcnt(0)
  s_barrier
  s_mov_b32 s30, 512
  v_mov_b32 v144, s30
  v_min_u32 v145, 1, v0
  v_lshlrev_b32 v145, 30, v145
  buffer_store_dword v144, v145, s[4:7], s31 offen sc1
  s_lshr_b32 s48, s64, 2
  s_bfe_u32 s49, s64, 0x10001
  s_and_b32 s50, s64, 1
  s_mul_i32 s50, s50, 6
  s_add_u32 s50, s50, s65
  s_mov_b32 s51, 12
  s_cmp_lt_u32 s50, 4
  s_cselect_b32 s23, 6, 5
  s_load_dwordx2 s[8:9], s[0:1], 40
  s_lshl_b32 s17, s48, 19
  s_lshl_b32 s26, s49, 2
  s_add_u32 s26, s26, s16
  s_lshl_b32 s27, s26, 7
  s_add_u32 s17, s17, s27
  s_mov_b32 s18, 1024
  s_lshl_b32 s21, s48, 6
  s_add_u32 s21, s21, s50
  s_lshl_b32 s21, s21, 3
  s_add_u32 s21, s21, s26
  s_lshl_b32 s21, s21, 12
  s_add_u32 s21, s21, 150994944
  s_lshl_b32 s22, s51, 15
  s_mov_b32 s24, 1.0
  s_waitcnt lgkmcnt(0)
  s_and_b32 s9, s9, 0xffff
  s_mov_b32 s10, 4194304
  s_mov_b32 s11, 0x20000
  s_mov_b32 s12, s4
  s_mov_b32 s13, s5
  s_mov_b32 s14, 268435456
  s_mov_b32 s15, 0x20000
  s_lshl_b32 s19, s48, 8
  s_add_u32 s19, s19, s50
  s_lshl_b32 s19, s19, 13
  s_add_u32 s19, s19, 100663296
  s_lshl_b32 s20, s51, 13
  v_lshrrev_b32 v144, 4, v1
  v_and_b32 v56, 0xff, v2
  v_lshl_add_u32 v56, v144, 9, v56
  s_mul_i32 s26, s16, 524288
  v_add_u32 v8, 0, v56
  v_add_u32 v16, 0, v2
  v_add_u32 v16, s26, v16
  v_add_u32 v9, 256, v56
  v_add_u32 v17, 1024, v2
  v_add_u32 v17, s26, v17
  v_add_u32 v10, 2048, v56
  v_add_u32 v18, 2048, v2
  v_add_u32 v18, s26, v18
  v_add_u32 v11, 2304, v56
  v_add_u32 v19, 3072, v2
  v_add_u32 v19, s26, v19
  v_add_u32 v12, 4096, v56
  v_add_u32 v20, 4096, v2
  v_add_u32 v20, s26, v20
  v_add_u32 v13, 4352, v56
  v_add_u32 v21, 5120, v2
  v_add_u32 v21, s26, v21
  v_add_u32 v14, 6144, v56
  v_add_u32 v22, 6144, v2
  v_add_u32 v22, s26, v22
  v_add_u32 v15, 6400, v56
  v_add_u32 v23, 7168, v2
  v_add_u32 v23, s26, v23
  v_lshrrev_b32 v144, 3, v1
  v_mul_lo_u32 v144, v144, s18
  v_and_b32 v145, 7, v1
  v_lshl_add_u32 v144, v145, 4, v144
  s_lshl_b32 s28, s16, 15
  s_add_u32 s28, s28, 32768
  s_lshl_b32 s29, s18, 3
  s_add_u32 m0, s28, 0
  s_nop 0
  buffer_load_dwordx4 v144, s[8:11], s17 offen lds
  s_add_u32 s17, s17, s29
  s_add_u32 m0, s28, 1024
  s_nop 0
  buffer_load_dwordx4 v144, s[8:11], s17 offen lds
  s_add_u32 s17, s17, s29
  s_add_u32 m0, s28, 2048
  s_nop 0
  buffer_load_dwordx4 v144, s[8:11], s17 offen lds
  s_add_u32 s17, s17, s29
  s_add_u32 m0, s28, 3072
  s_nop 0
  buffer_load_dwordx4 v144, s[8:11], s17 offen lds
  s_add_u32 s17, s17, s29
  s_add_u32 m0, s28, 4096
  s_nop 0
  buffer_load_dwordx4 v144, s[8:11], s17 offen lds
  s_add_u32 s17, s17, s29
  s_add_u32 m0, s28, 5120
  s_nop 0
  buffer_load_dwordx4 v144, s[8:11], s17 offen lds
  s_add_u32 s17, s17, s29
  s_add_u32 m0, s28, 6144
  s_nop 0
  buffer_load_dwordx4 v144, s[8:11], s17 offen lds
  s_add_u32 s17, s17, s29
  s_add_u32 m0, s28, 7168
  s_nop 0
  buffer_load_dwordx4 v144, s[8:11], s17 offen lds
  s_add_u32 s17, s17, s29
  s_add_u32 m0, s28, 8192
  s_nop 0
  buffer_load_dwordx4 v144, s[8:11], s17 offen lds
  s_add_u32 s17, s17, s29
  s_add_u32 m0, s28, 9216
  s_nop 0
  buffer_load_dwordx4 v144, s[8:11], s17 offen lds
  s_add_u32 s17, s17, s29
  s_add_u32 m0, s28, 10240
  s_nop 0
  buffer_load_dwordx4 v144, s[8:11], s17 offen lds
  s_add_u32 s17, s17, s29
  s_add_u32 m0, s28, 11264
  s_nop 0
  buffer_load_dwordx4 v144, s[8:11], s17 offen lds
  s_add_u32 s17, s17, s29
  s_add_u32 m0, s28, 12288
  s_nop 0
  buffer_load_dwordx4 v144, s[8:11], s17 offen lds
  s_add_u32 s17, s17, s29
  s_add_u32 m0, s28, 13312
  s_nop 0
  buffer_load_dwordx4 v144, s[8:11], s17 offen lds
  s_add_u32 s17, s17, s29
  s_add_u32 m0, s28, 14336
  s_nop 0
  buffer_load_dwordx4 v144, s[8:11], s17 offen lds
  s_add_u32 s17, s17, s29
  s_add_u32 m0, s28, 15360
  s_nop 0
  buffer_load_dwordx4 v144, s[8:11], s17 offen lds
  s_add_u32 s17, s17, s29
  s_add_u32 m0, s28, 16384
  s_nop 0
  buffer_load_dwordx4 v144, s[8:11], s17 offen lds
  s_add_u32 s17, s17, s29
  s_add_u32 m0, s28, 17408
  s_nop 0
  buffer_load_dwordx4 v144, s[8:11], s17 offen lds
  s_add_u32 s17, s17, s29
  s_add_u32 m0, s28, 18432
  s_nop 0
  buffer_load_dwordx4 v144, s[8:11], s17 offen lds
  s_add_u32 s17, s17, s29
  s_add_u32 m0, s28, 19456
  s_nop 0
  buffer_load_dwordx4 v144, s[8:11], s17 offen lds
  s_add_u32 s17, s17, s29
  s_add_u32 m0, s28, 20480
  s_nop 0
  buffer_load_dwordx4 v144, s[8:11], s17 offen lds
  s_add_u32 s17, s17, s29
  s_add_u32 m0, s28, 21504
  s_nop 0
  buffer_load_dwordx4 v144, s[8:11], s17 offen lds
  s_add_u32 s17, s17, s29
  s_add_u32 m0, s28, 22528
  s_nop 0
  buffer_load_dwordx4 v144, s[8:11], s17 offen lds
  s_add_u32 s17, s17, s29
  s_add_u32 m0, s28, 23552
  s_nop 0
  buffer_load_dwordx4 v144, s[8:11], s17 offen lds
  s_add_u32 s17, s17, s29
  s_add_u32 m0, s28, 24576
  s_nop 0
  buffer_load_dwordx4 v144, s[8:11], s17 offen lds
  s_add_u32 s17, s17, s29
  s_add_u32 m0, s28, 25600
  s_nop 0
  buffer_load_dwordx4 v144, s[8:11], s17 offen lds
  s_add_u32 s17, s17, s29
  s_add_u32 m0, s28, 26624
  s_nop 0
  buffer_load_dwordx4 v144, s[8:11], s17 offen lds
  s_add_u32 s17, s17, s29
  s_add_u32 m0, s28, 27648
  s_nop 0
  buffer_load_dwordx4 v144, s[8:11], s17 offen lds
  s_add_u32 s17, s17, s29
  s_add_u32 m0, s28, 28672
  s_nop 0
  buffer_load_dwordx4 v144, s[8:11], s17 offen lds
  s_add_u32 s17, s17, s29
  s_add_u32 m0, s28, 29696
  s_nop 0
  buffer_load_dwordx4 v144, s[8:11], s17 offen lds
  s_add_u32 s17, s17, s29
  s_add_u32 m0, s28, 30720
  s_nop 0
  buffer_load_dwordx4 v144, s[8:11], s17 offen lds
  s_add_u32 s17, s17, s29
  s_add_u32 m0, s28, 31744
  s_nop 0
  buffer_load_dwordx4 v144, s[8:11], s17 offen lds
  s_add_u32 s17, s17, s29
  v_bfe_u32 v148, v1, 2, 2
  v_lshrrev_b32 v149, 5, v1
  v_lshl_add_u32 v148, v149, 4, v148
  v_bfe_u32 v149, v1, 4, 1
  v_lshl_add_u32 v148, v149, 2, v148
  v_and_b32 v149, 3, v1
  v_lshlrev_b32 v149, 4, v149
  s_mov_b32 s26, 8
  v_lshl_add_u32 v148, v148, 7, v149
  v_add_u32 v152, s28, v148
  v_add_u32 v153, 1024, v152
  v_add_u32 v154, s26, v152
  v_add_u32 v155, s26, v153
  s_waitcnt vmcnt(28)
  ds_read_b64_tr_b16 a[0:1], v152 offset:0
  ds_read_b64_tr_b16 a[2:3], v153 offset:0
  ds_read_b64_tr_b16 a[4:5], v154 offset:0
  ds_read_b64_tr_b16 a[6:7], v155 offset:0
  ds_read_b64_tr_b16 a[8:9], v152 offset:64
  ds_read_b64_tr_b16 a[10:11], v153 offset:64
  ds_read_b64_tr_b16 a[12:13], v154 offset:64
  ds_read_b64_tr_b16 a[14:15], v155 offset:64
  s_waitcnt lgkmcnt(0)
  s_add_u32 m0, s28, 0
  s_nop 0
  buffer_load_dwordx4 v144, s[8:11], s17 offen lds
  s_add_u32 s17, s17, s29
  s_add_u32 m0, s28, 1024
  s_nop 0
  buffer_load_dwordx4 v144, s[8:11], s17 offen lds
  s_add_u32 s17, s17, s29
  s_add_u32 m0, s28, 2048
  s_nop 0
  buffer_load_dwordx4 v144, s[8:11], s17 offen lds
  s_add_u32 s17, s17, s29
  s_add_u32 m0, s28, 3072
  s_nop 0
  buffer_load_dwordx4 v144, s[8:11], s17 offen lds
  s_add_u32 s17, s17, s29
  s_waitcnt vmcnt(28)
  ds_read_b64_tr_b16 a[16:17], v152 offset:4096
  ds_read_b64_tr_b16 a[18:19], v153 offset:4096
  ds_read_b64_tr_b16 a[20:21], v154 offset:4096
  ds_read_b64_tr_b16 a[22:23], v155 offset:4096
  ds_read_b64_tr_b16 a[24:25], v152 offset:4160
  ds_read_b64_tr_b16 a[26:27], v153 offset:4160
  ds_read_b64_tr_b16 a[28:29], v154 offset:4160
  ds_read_b64_tr_b16 a[30:31], v155 offset:4160
  s_waitcnt lgkmcnt(0)
  s_add_u32 m0, s28, 4096
  s_nop 0
  buffer_load_dwordx4 v144, s[8:11], s17 offen lds
  s_add_u32 s17, s17, s29
  s_add_u32 m0, s28, 5120
  s_nop 0
  buffer_load_dwordx4 v144, s[8:11], s17 offen lds
  s_add_u32 s17, s17, s29
  s_add_u32 m0, s28, 6144
  s_nop 0
  buffer_load_dwordx4 v144, s[8:11], s17 offen lds
  s_add_u32 s17, s17, s29
  s_add_u32 m0, s28, 7168
  s_nop 0
  buffer_load_dwordx4 v144, s[8:11], s17 offen lds
  s_add_u32 s17, s17, s29
  s_waitcnt vmcnt(28)
  ds_read_b64_tr_b16 a[32:33], v152 offset:8192
  ds_read_b64_tr_b16 a[34:35], v153 offset:8192
  ds_read_b64_tr_b16 a[36:37], v154 offset:8192
  ds_read_b64_tr_b16 a[38:39], v155 offset:8192
  ds_read_b64_tr_b16 a[40:41], v152 offset:8256
  ds_read_b64_tr_b16 a[42:43], v153 offset:8256
  ds_read_b64_tr_b16 a[44:45], v154 offset:8256
  ds_read_b64_tr_b16 a[46:47], v155 offset:8256
  s_waitcnt lgkmcnt(0)
  s_add_u32 m0, s28, 8192
  s_nop 0
  buffer_load_dwordx4 v144, s[8:11], s17 offen lds
  s_add_u32 s17, s17, s29
  s_add_u32 m0, s28, 9216
  s_nop 0
  buffer_load_dwordx4 v144, s[8:11], s17 offen lds
  s_add_u32 s17, s17, s29
  s_add_u32 m0, s28, 10240
  s_nop 0
  buffer_load_dwordx4 v144, s[8:11], s17 offen lds
  s_add_u32 s17, s17, s29
  s_add_u32 m0, s28, 11264
  s_nop 0
  buffer_load_dwordx4 v144, s[8:11], s17 offen lds
  s_add_u32 s17, s17, s29
  s_waitcnt vmcnt(28)
  ds_read_b64_tr_b16 a[48:49], v152 offset:12288
  ds_read_b64_tr_b16 a[50:51], v153 offset:12288
  ds_read_b64_tr_b16 a[52:53], v154 offset:12288
  ds_read_b64_tr_b16 a[54:55], v155 offset:12288
  ds_read_b64_tr_b16 a[56:57], v152 offset:12352
  ds_read_b64_tr_b16 a[58:59], v153 offset:12352
  ds_read_b64_tr_b16 a[60:61], v154 offset:12352
  ds_read_b64_tr_b16 a[62:63], v155 offset:12352
  s_waitcnt lgkmcnt(0)
  s_add_u32 m0, s28, 12288
  s_nop 0
  buffer_load_dwordx4 v144, s[8:11], s17 offen lds
  s_add_u32 s17, s17, s29
  s_add_u32 m0, s28, 13312
  s_nop 0
  buffer_load_dwordx4 v144, s[8:11], s17 offen lds
  s_add_u32 s17, s17, s29
  s_add_u32 m0, s28, 14336
  s_nop 0
  buffer_load_dwordx4 v144, s[8:11], s17 offen lds
  s_add_u32 s17, s17, s29
  s_add_u32 m0, s28, 15360
  s_nop 0
  buffer_load_dwordx4 v144, s[8:11], s17 offen lds
  s_add_u32 s17, s17, s29
  s_waitcnt vmcnt(28)
  ds_read_b64_tr_b16 a[64:65], v152 offset:16384
  ds_read_b64_tr_b16 a[66:67], v153 offset:16384
  ds_read_b64_tr_b16 a[68:69], v154 offset:16384
  ds_read_b64_tr_b16 a[70:71], v155 offset:16384
  ds_read_b64_tr_b16 a[72:73], v152 offset:16448
  ds_read_b64_tr_b16 a[74:75], v153 offset:16448
  ds_read_b64_tr_b16 a[76:77], v154 offset:16448
  ds_read_b64_tr_b16 a[78:79], v155 offset:16448
  s_waitcnt lgkmcnt(0)
  s_add_u32 m0, s28, 16384
  s_nop 0
  buffer_load_dwordx4 v144, s[8:11], s17 offen lds
  s_add_u32 s17, s17, s29
  s_add_u32 m0, s28, 17408
  s_nop 0
  buffer_load_dwordx4 v144, s[8:11], s17 offen lds
  s_add_u32 s17, s17, s29
  s_add_u32 m0, s28, 18432
  s_nop 0
  buffer_load_dwordx4 v144, s[8:11], s17 offen lds
  s_add_u32 s17, s17, s29
  s_add_u32 m0, s28, 19456
  s_nop 0
  buffer_load_dwordx4 v144, s[8:11], s17 offen lds
  s_add_u32 s17, s17, s29
  s_waitcnt vmcnt(28)
  ds_read_b64_tr_b16 a[80:81], v152 offset:20480
  ds_read_b64_tr_b16 a[82:83], v153 offset:20480
  ds_read_b64_tr_b16 a[84:85], v154 offset:20480
  ds_read_b64_tr_b16 a[86:87], v155 offset:20480
  ds_read_b64_tr_b16 a[88:89], v152 offset:20544
  ds_read_b64_tr_b16 a[90:91], v153 offset:20544
  ds_read_b64_tr_b16 a[92:93], v154 offset:20544
  ds_read_b64_tr_b16 a[94:95], v155 offset:20544
  s_waitcnt lgkmcnt(0)
  s_add_u32 m0, s28, 20480
  s_nop 0
  buffer_load_dwordx4 v144, s[8:11], s17 offen lds
  s_add_u32 s17, s17, s29
  s_add_u32 m0, s28, 21504
  s_nop 0
  buffer_load_dwordx4 v144, s[8:11], s17 offen lds
  s_add_u32 s17, s17, s29
  s_add_u32 m0, s28, 22528
  s_nop 0
  buffer_load_dwordx4 v144, s[8:11], s17 offen lds
  s_add_u32 s17, s17, s29
  s_add_u32 m0, s28, 23552
  s_nop 0
  buffer_load_dwordx4 v144, s[8:11], s17 offen lds
  s_add_u32 s17, s17, s29
  s_waitcnt vmcnt(28)
  ds_read_b64_tr_b16 a[96:97], v152 offset:24576
  ds_read_b64_tr_b16 a[98:99], v153 offset:24576
  ds_read_b64_tr_b16 a[100:101], v154 offset:24576
  ds_read_b64_tr_b16 a[102:103], v155 offset:24576
  ds_read_b64_tr_b16 a[104:105], v152 offset:24640
  ds_read_b64_tr_b16 a[106:107], v153 offset:24640
  ds_read_b64_tr_b16 a[108:109], v154 offset:24640
  ds_read_b64_tr_b16 a[110:111], v155 offset:24640
  s_waitcnt lgkmcnt(0)
  s_add_u32 m0, s28, 24576
  s_nop 0
  buffer_load_dwordx4 v144, s[8:11], s17 offen lds
  s_add_u32 s17, s17, s29
  s_add_u32 m0, s28, 25600
  s_nop 0
  buffer_load_dwordx4 v144, s[8:11], s17 offen lds
  s_add_u32 s17, s17, s29
  s_add_u32 m0, s28, 26624
  s_nop 0
  buffer_load_dwordx4 v144, s[8:11], s17 offen lds
  s_add_u32 s17, s17, s29
  s_add_u32 m0, s28, 27648
  s_nop 0
  buffer_load_dwordx4 v144, s[8:11], s17 offen lds
  s_add_u32 s17, s17, s29
  s_waitcnt vmcnt(28)
  ds_read_b64_tr_b16 a[112:113], v152 offset:28672
  ds_read_b64_tr_b16 a[114:115], v153 offset:28672
  ds_read_b64_tr_b16 a[116:117], v154 offset:28672
  ds_read_b64_tr_b16 a[118:119], v155 offset:28672
  ds_read_b64_tr_b16 a[120:121], v152 offset:28736
  ds_read_b64_tr_b16 a[122:123], v153 offset:28736
  ds_read_b64_tr_b16 a[124:125], v154 offset:28736
  ds_read_b64_tr_b16 a[126:127], v155 offset:28736
  s_waitcnt lgkmcnt(0)
  s_add_u32 m0, s28, 28672
  s_nop 0
  buffer_load_dwordx4 v144, s[8:11], s17 offen lds
  s_add_u32 s17, s17, s29
  s_add_u32 m0, s28, 29696
  s_nop 0
  buffer_load_dwordx4 v144, s[8:11], s17 offen lds
  s_add_u32 s17, s17, s29
  s_add_u32 m0, s28, 30720
  s_nop 0
  buffer_load_dwordx4 v144, s[8:11], s17 offen lds
  s_add_u32 s17, s17, s29
  s_add_u32 m0, s28, 31744
  s_nop 0
  buffer_load_dwordx4 v144, s[8:11], s17 offen lds
  s_add_u32 s17, s17, s29
  s_waitcnt vmcnt(28)
  ds_read_b64_tr_b16 a[128:129], v152 offset:0
  ds_read_b64_tr_b16 a[130:131], v153 offset:0
  ds_read_b64_tr_b16 a[132:133], v154 offset:0
  ds_read_b64_tr_b16 a[134:135], v155 offset:0
  ds_read_b64_tr_b16 a[136:137], v152 offset:64
  ds_read_b64_tr_b16 a[138:139], v153 offset:64
  ds_read_b64_tr_b16 a[140:141], v154 offset:64
  ds_read_b64_tr_b16 a[142:143], v155 offset:64
  s_waitcnt lgkmcnt(0)
  s_waitcnt vmcnt(24)
  ds_read_b64_tr_b16 a[144:145], v152 offset:4096
  ds_read_b64_tr_b16 a[146:147], v153 offset:4096
  ds_read_b64_tr_b16 a[148:149], v154 offset:4096
  ds_read_b64_tr_b16 a[150:151], v155 offset:4096
  ds_read_b64_tr_b16 a[152:153], v152 offset:4160
  ds_read_b64_tr_b16 a[154:155], v153 offset:4160
  ds_read_b64_tr_b16 a[156:157], v154 offset:4160
  ds_read_b64_tr_b16 a[158:159], v155 offset:4160
  s_waitcnt lgkmcnt(0)
  s_waitcnt vmcnt(20)
  ds_read_b64_tr_b16 a[160:161], v152 offset:8192
  ds_read_b64_tr_b16 a[162:163], v153 offset:8192
  ds_read_b64_tr_b16 a[164:165], v154 offset:8192
  ds_read_b64_tr_b16 a[166:167], v155 offset:8192
  ds_read_b64_tr_b16 a[168:169], v152 offset:8256
  ds_read_b64_tr_b16 a[170:171], v153 offset:8256
  ds_read_b64_tr_b16 a[172:173], v154 offset:8256
  ds_read_b64_tr_b16 a[174:175], v155 offset:8256
  s_waitcnt lgkmcnt(0)
  s_waitcnt vmcnt(16)
  ds_read_b64_tr_b16 a[176:177], v152 offset:12288
  ds_read_b64_tr_b16 a[178:179], v153 offset:12288
  ds_read_b64_tr_b16 a[180:181], v154 offset:12288
  ds_read_b64_tr_b16 a[182:183], v155 offset:12288
  ds_read_b64_tr_b16 a[184:185], v152 offset:12352
  ds_read_b64_tr_b16 a[186:187], v153 offset:12352
  ds_read_b64_tr_b16 a[188:189], v154 offset:12352
  ds_read_b64_tr_b16 a[190:191], v155 offset:12352
  s_waitcnt lgkmcnt(0)
  s_waitcnt vmcnt(12)
  ds_read_b64_tr_b16 a[192:193], v152 offset:16384
  ds_read_b64_tr_b16 a[194:195], v153 offset:16384
  ds_read_b64_tr_b16 a[196:197], v154 offset:16384
  ds_read_b64_tr_b16 a[198:199], v155 offset:16384
  ds_read_b64_tr_b16 a[200:201], v152 offset:16448
  ds_read_b64_tr_b16 a[202:203], v153 offset:16448
  ds_read_b64_tr_b16 a[204:205], v154 offset:16448
  ds_read_b64_tr_b16 a[206:207], v155 offset:16448
  s_waitcnt lgkmcnt(0)
  s_waitcnt vmcnt(8)
  ds_read_b64_tr_b16 a[208:209], v152 offset:20480
  ds_read_b64_tr_b16 a[210:211], v153 offset:20480
  ds_read_b64_tr_b16 a[212:213], v154 offset:20480
  ds_read_b64_tr_b16 a[214:215], v155 offset:20480
  ds_read_b64_tr_b16 a[216:217], v152 offset:20544
  ds_read_b64_tr_b16 a[218:219], v153 offset:20544
  ds_read_b64_tr_b16 a[220:221], v154 offset:20544
  ds_read_b64_tr_b16 a[222:223], v155 offset:20544
  s_waitcnt lgkmcnt(0)
  s_waitcnt vmcnt(4)
  ds_read_b64_tr_b16 a[224:225], v152 offset:24576
  ds_read_b64_tr_b16 a[226:227], v153 offset:24576
  ds_read_b64_tr_b16 a[228:229], v154 offset:24576
  ds_read_b64_tr_b16 a[230:231], v155 offset:24576
  ds_read_b64_tr_b16 a[232:233], v152 offset:24640
  ds_read_b64_tr_b16 a[234:235], v153 offset:24640
  ds_read_b64_tr_b16 a[236:237], v154 offset:24640
  ds_read_b64_tr_b16 a[238:239], v155 offset:24640
  s_waitcnt lgkmcnt(0)
  s_waitcnt vmcnt(0)
  ds_read_b64_tr_b16 a[240:241], v152 offset:28672
  ds_read_b64_tr_b16 a[242:243], v153 offset:28672
  ds_read_b64_tr_b16 a[244:245], v154 offset:28672
  ds_read_b64_tr_b16 a[246:247], v155 offset:28672
  ds_read_b64_tr_b16 a[248:249], v152 offset:28736
  ds_read_b64_tr_b16 a[250:251], v153 offset:28736
  ds_read_b64_tr_b16 a[252:253], v154 offset:28736
  ds_read_b64_tr_b16 a[254:255], v155 offset:28736
  s_waitcnt lgkmcnt(0)
  v_min_u32 v4, 27, v1
  v_mul_u32_u24 v5, 37, v4
  v_lshrrev_b32 v5, 8, v5
  v_mul_u32_u24 v5, 7, v5
  v_sub_u32 v5, v4, v5
  v_mov_b32 v6, 0x200
  v_cmp_ne_u32 vcc, 6, v5
  s_mul_i32 s76, s48, 3584
  s_add_u32 s76, s76, 148897792
  v_cndmask_b32 v5, 0, v6, vcc
  v_lshl_add_u32 v4, v4, 7, s76
  s_mov_b32 s71, 0
  s_branch M_vg_49
M_vw_48:
  s_sleep 2
  s_add_u32 s71, s71, 1
  s_cmp_gt_u32 s71, 262144
  s_cbranch_scc1 M_exit
M_vg_49:
  buffer_load_dword v6, v4, s[4:7], 0 offen sc1
  s_waitcnt vmcnt(0)
  v_cmp_lt_u32 vcc, v6, v5
  s_cbranch_vccnz M_vw_48
  s_barrier
  s_lshl_b32 s25, s16, 13
  s_add_u32 m0, s25, 0
  s_nop 0
  buffer_load_dwordx4 v16, s[12:15], s19 offen sc1 lds
  s_add_u32 m0, s25, 1024
  s_nop 0
  buffer_load_dwordx4 v17, s[12:15], s19 offen sc1 lds
  s_add_u32 m0, s25, 2048
  s_nop 0
  buffer_load_dwordx4 v18, s[12:15], s19 offen sc1 lds
  s_add_u32 m0, s25, 3072
  s_nop 0
  buffer_load_dwordx4 v19, s[12:15], s19 offen sc1 lds
  s_add_u32 m0, s25, 4096
  s_nop 0
  buffer_load_dwordx4 v20, s[12:15], s19 offen sc1 lds
  s_add_u32 m0, s25, 5120
  s_nop 0
  buffer_load_dwordx4 v21, s[12:15], s19 offen sc1 lds
  s_add_u32 m0, s25, 6144
  s_nop 0
  buffer_load_dwordx4 v22, s[12:15], s19 offen sc1 lds
  s_add_u32 m0, s25, 7168
  s_nop 0
  buffer_load_dwordx4 v23, s[12:15], s19 offen sc1 lds
  s_cmp_gt_u32 s23, 1
  s_cselect_b32 s26, s20, 0
  s_add_u32 s19, s19, s26
  s_add_u32 s25, s25, 32768
  s_and_b32 s25, s25, 0x1ffff
  s_add_u32 m0, s25, 0
  s_nop 0
  buffer_load_dwordx4 v16, s[12:15], s19 offen sc1 lds
  s_add_u32 m0, s25, 1024
  s_nop 0
  buffer_load_dwordx4 v17, s[12:15], s19 offen sc1 lds
  s_add_u32 m0, s25, 2048
  s_nop 0
  buffer_load_dwordx4 v18, s[12:15], s19 offen sc1 lds
  s_add_u32 m0, s25, 3072
  s_nop 0
  buffer_load_dwordx4 v19, s[12:15], s19 offen sc1 lds
  s_add_u32 m0, s25, 4096
  s_nop 0
  buffer_load_dwordx4 v20, s[12:15], s19 offen sc1 lds
  s_add_u32 m0, s25, 5120
  s_nop 0
  buffer_load_dwordx4 v21, s[12:15], s19 offen sc1 lds
  s_add_u32 m0, s25, 6144
  s_nop 0
  buffer_load_dwordx4 v22, s[12:15], s19 offen sc1 lds
  s_add_u32 m0, s25, 7168
  s_nop 0
  buffer_load_dwordx4 v23, s[12:15], s19 offen sc1 lds
  s_cmp_gt_u32 s23, 2
  s_cselect_b32 s26, s20, 0
  s_add_u32 s19, s19, s26
  s_add_u32 s25, s25, 32768
  s_and_b32 s25, s25, 0x1ffff
  s_waitcnt vmcnt(0)
  s_barrier
  s_mov_b32 s27, s21
  v_mov_b32 v7, 0x40000000
  ds_read_b128 v[24:27], v8 offset:0
  ds_read_b128 v[28:31], v9 offset:0
  ds_read_b128 v[32:35], v10 offset:0
  ds_read_b128 v[36:39], v11 offset:0
  ds_read_b128 v[40:43], v12 offset:0
  ds_read_b128 v[44:47], v13 offset:0
.p2align 6
G_top_50:
  s_waitcnt lgkmcnt(5)
  v_mfma_f32_16x16x32_bf16 v[64:67], a[0:3], v[24:27], 0
  s_add_u32 m0, s25, 0
  ds_read_b128 v[48:51], v14 offset:0
  v_mfma_f32_16x16x32_bf16 v[68:71], a[4:7], v[24:27], 0
  v_mfma_f32_16x16x32_bf16 v[80:83], a[8:11], v[24:27], 0
  buffer_load_dwordx4 v16, s[12:15], s19 offen sc1 lds
  v_mfma_f32_16x16x32_bf16 v[84:87], a[12:15], v[24:27], 0
  s_waitcnt lgkmcnt(5)
  v_mfma_f32_16x16x32_bf16 v[72:75], a[0:3], v[28:31], 0
  ds_read_b128 v[52:55], v15 offset:0
  v_mfma_f32_16x16x32_bf16 v[76:79], a[4:7], v[28:31], 0
  v_cvt_pk_bf16_f32 v128, v96, v97
  v_cvt_pk_bf16_f32 v129, v98, v99
  v_mfma_f32_16x16x32_bf16 v[88:91], a[8:11], v[28:31], 0
  v_mfma_f32_16x16x32_bf16 v[92:95], a[12:15], v[28:31], 0
  s_waitcnt lgkmcnt(5)
  v_cvt_pk_bf16_f32 v130, v100, v101
  v_cvt_pk_bf16_f32 v131, v102, v103
  v_mfma_f32_16x16x32_bf16 v[64:67], a[16:19], v[32:35], v[64:67]
  s_add_u32 m0, s25, 1024
  ds_read_b128 v[24:27], v8 offset:8192
  v_mfma_f32_16x16x32_bf16 v[68:71], a[20:23], v[32:35], v[68:71]
  v_mfma_f32_16x16x32_bf16 v[80:83], a[24:27], v[32:35], v[80:83]
  buffer_load_dwordx4 v17, s[12:15], s19 offen sc1 lds
  v_mfma_f32_16x16x32_bf16 v[84:87], a[28:31], v[32:35], v[84:87]
  s_waitcnt lgkmcnt(5)
  v_mfma_f32_16x16x32_bf16 v[72:75], a[16:19], v[36:39], v[72:75]
  ds_read_b128 v[28:31], v9 offset:8192
  v_mfma_f32_16x16x32_bf16 v[76:79], a[20:23], v[36:39], v[76:79]
  v_mfma_f32_16x16x32_bf16 v[88:91], a[24:27], v[36:39], v[88:91]
  v_mfma_f32_16x16x32_bf16 v[92:95], a[28:31], v[36:39], v[92:95]
  s_waitcnt lgkmcnt(5)
  v_mfma_f32_16x16x32_bf16 v[64:67], a[32:35], v[40:43], v[64:67]
  s_add_u32 m0, s25, 2048
  ds_read_b128 v[32:35], v10 offset:8192
  v_mfma_f32_16x16x32_bf16 v[68:71], a[36:39], v[40:43], v[68:71]
  v_cvt_pk_bf16_f32 v132, v104, v105
  v_cvt_pk_bf16_f32 v133, v106, v107
  v_mfma_f32_16x16x32_bf16 v[80:83], a[40:43], v[40:43], v[80:83]
  buffer_load_dwordx4 v18, s[12:15], s19 offen sc1 lds
  v_mfma_f32_16x16x32_bf16 v[84:87], a[44:47], v[40:43], v[84:87]
  s_waitcnt lgkmcnt(5)
  v_cvt_pk_bf16_f32 v134, v108, v109
  v_cvt_pk_bf16_f32 v135, v110, v111
  v_mfma_f32_16x16x32_bf16 v[72:75], a[32:35], v[44:47], v[72:75]
  ds_read_b128 v[36:39], v11 offset:8192
  v_mfma_f32_16x16x32_bf16 v[76:79], a[36:39], v[44:47], v[76:79]
  v_mfma_f32_16x16x32_bf16 v[88:91], a[40:43], v[44:47], v[88:91]
  v_mfma_f32_16x16x32_bf16 v[92:95], a[44:47], v[44:47], v[92:95]
  s_waitcnt lgkmcnt(5)
  v_mfma_f32_16x16x32_bf16 v[64:67], a[48:51], v[48:51], v[64:67]
  s_add_u32 m0, s25, 3072
  ds_read_b128 v[40:43], v12 offset:8192
  v_mfma_f32_16x16x32_bf16 v[68:71], a[52:55], v[48:51], v[68:71]
  v_mfma_f32_16x16x32_bf16 v[80:83], a[56:59], v[48:51], v[80:83]
  buffer_load_dwordx4 v19, s[12:15], s19 offen sc1 lds
  v_mfma_f32_16x16x32_bf16 v[84:87], a[60:63], v[48:51], v[84:87]
  s_waitcnt lgkmcnt(5)
  v_mfma_f32_16x16x32_bf16 v[72:75], a[48:51], v[52:55], v[72:75]
  ds_read_b128 v[44:47], v13 offset:8192
  v_mfma_f32_16x16x32_bf16 v[76:79], a[52:55], v[52:55], v[76:79]
  v_cvt_pk_bf16_f32 v136, v112, v113
  v_cvt_pk_bf16_f32 v137, v114, v115
  v_mfma_f32_16x16x32_bf16 v[88:91], a[56:59], v[52:55], v[88:91]
  v_mfma_f32_16x16x32_bf16 v[92:95], a[60:63], v[52:55], v[92:95]
  s_waitcnt lgkmcnt(5)
  v_cvt_pk_bf16_f32 v138, v116, v117
  v_cvt_pk_bf16_f32 v139, v118, v119
  v_mfma_f32_16x16x32_bf16 v[64:67], a[64:67], v[24:27], v[64:67]
  s_add_u32 m0, s25, 4096
  ds_read_b128 v[48:51], v14 offset:8192
  v_mfma_f32_16x16x32_bf16 v[68:71], a[68:71], v[24:27], v[68:71]
  v_mfma_f32_16x16x32_bf16 v[80:83], a[72:75], v[24:27], v[80:83]
  buffer_load_dwordx4 v20, s[12:15], s19 offen sc1 lds
  v_mfma_f32_16x16x32_bf16 v[84:87], a[76:79], v[24:27], v[84:87]
  s_waitcnt lgkmcnt(5)
  v_mfma_f32_16x16x32_bf16 v[72:75], a[64:67], v[28:31], v[72:75]
  ds_read_b128 v[52:55], v15 offset:8192
  v_mfma_f32_16x16x32_bf16 v[76:79], a[68:71], v[28:31], v[76:79]
  v_mfma_f32_16x16x32_bf16 v[88:91], a[72:75], v[28:31], v[88:91]
  v_mfma_f32_16x16x32_bf16 v[92:95], a[76:79], v[28:31], v[92:95]
  s_waitcnt lgkmcnt(5)
  v_mfma_f32_16x16x32_bf16 v[64:67], a[80:83], v[32:35], v[64:67]
  s_add_u32 m0, s25, 5120
  ds_read_b128 v[24:27], v8 offset:16384
  v_mfma_f32_16x16x32_bf16 v[68:71], a[84:87], v[32:35], v[68:71]
  v_cvt_pk_bf16_f32 v140, v120, v121
  v_cvt_pk_bf16_f32 v141, v122, v123
  v_mfma_f32_16x16x32_bf16 v[80:83], a[88:91], v[32:35], v[80:83]
  buffer_load_dwordx4 v21, s[12:15], s19 offen sc1 lds
  v_mfma_f32_16x16x32_bf16 v[84:87], a[92:95], v[32:35], v[84:87]
  s_waitcnt lgkmcnt(5)
  v_cvt_pk_bf16_f32 v142, v124, v125
  v_cvt_pk_bf16_f32 v143, v126, v127
  v_mfma_f32_16x16x32_bf16 v[72:75], a[80:83], v[36:39], v[72:75]
  ds_read_b128 v[28:31], v9 offset:16384
  v_mfma_f32_16x16x32_bf16 v[76:79], a[84:87], v[36:39], v[76:79]
  v_mfma_f32_16x16x32_bf16 v[88:91], a[88:91], v[36:39], v[88:91]
  v_mfma_f32_16x16x32_bf16 v[92:95], a[92:95], v[36:39], v[92:95]
  s_waitcnt lgkmcnt(5)
  v_mfma_f32_16x16x32_bf16 v[64:67], a[96:99], v[40:43], v[64:67]
  s_add_u32 m0, s25, 6144
  ds_read_b128 v[32:35], v10 offset:16384
  v_mfma_f32_16x16x32_bf16 v[68:71], a[100:103], v[40:43], v[68:71]
  v_mfma_f32_16x16x32_bf16 v[80:83], a[104:107], v[40:43], v[80:83]
  buffer_load_dwordx4 v22, s[12:15], s19 offen sc1 lds
  v_mfma_f32_16x16x32_bf16 v[84:87], a[108:111], v[40:43], v[84:87]
  s_waitcnt lgkmcnt(5)
  v_mfma_f32_16x16x32_bf16 v[72:75], a[96:99], v[44:47], v[72:75]
  ds_read_b128 v[36:39], v11 offset:16384
  v_mfma_f32_16x16x32_bf16 v[76:79], a[100:103], v[44:47], v[76:79]
  v_mfma_f32_16x16x32_bf16 v[88:91], a[104:107], v[44:47], v[88:91]
  v_mfma_f32_16x16x32_bf16 v[92:95], a[108:111], v[44:47], v[92:95]
  s_waitcnt lgkmcnt(5)
  v_mfma_f32_16x16x32_bf16 v[64:67], a[112:115], v[48:51], v[64:67]
  s_add_u32 m0, s25, 7168
  ds_read_b128 v[40:43], v12 offset:16384
  v_mfma_f32_16x16x32_bf16 v[68:71], a[116:119], v[48:51], v[68:71]
  v_mfma_f32_16x16x32_bf16 v[80:83], a[120:123], v[48:51], v[80:83]
  buffer_load_dwordx4 v23, s[12:15], s19 offen sc1 lds
  v_mfma_f32_16x16x32_bf16 v[84:87], a[124:127], v[48:51], v[84:87]
  s_waitcnt lgkmcnt(5)
  v_mfma_f32_16x16x32_bf16 v[72:75], a[112:115], v[52:55], v[72:75]
  s_cmp_gt_u32 s23, 3
  ds_read_b128 v[44:47], v13 offset:16384
  v_mfma_f32_16x16x32_bf16 v[76:79], a[116:119], v[52:55], v[76:79]
  v_mfma_f32_16x16x32_bf16 v[88:91], a[120:123], v[52:55], v[88:91]
  s_cselect_b32 s26, s20, 0
  v_mfma_f32_16x16x32_bf16 v[92:95], a[124:127], v[52:55], v[92:95]
  s_waitcnt lgkmcnt(5)
  v_mfma_f32_16x16x32_bf16 v[64:67], a[128:131], v[24:27], v[64:67]
  s_add_u32 s19, s19, s26
  ds_read_b128 v[48:51], v14 offset:16384
  v_mfma_f32_16x16x32_bf16 v[68:71], a[132:135], v[24:27], v[68:71]
  v_mfma_f32_16x16x32_bf16 v[80:83], a[136:139], v[24:27], v[80:83]
  s_add_u32 s25, s25, 32768
  v_mfma_f32_16x16x32_bf16 v[84:87], a[140:143], v[24:27], v[84:87]
  s_waitcnt lgkmcnt(5)
  v_mfma_f32_16x16x32_bf16 v[72:75], a[128:131], v[28:31], v[72:75]
  s_and_b32 s25, s25, 0x1ffff
  ds_read_b128 v[52:55], v15 offset:16384
  v_mfma_f32_16x16x32_bf16 v[76:79], a[132:135], v[28:31], v[76:79]
  v_mfma_f32_16x16x32_bf16 v[88:91], a[136:139], v[28:31], v[88:91]
  buffer_store_dwordx4 v[128:131], v7, s[4:7], s21 offen offset:0 sc1
  v_mfma_f32_16x16x32_bf16 v[92:95], a[140:143], v[28:31], v[92:95]
  s_waitcnt lgkmcnt(5)
  v_mfma_f32_16x16x32_bf16 v[64:67], a[144:147], v[32:35], v[64:67]
  ds_read_b128 v[24:27], v8 offset:24576
  v_mfma_f32_16x16x32_bf16 v[68:71], a[148:151], v[32:35], v[68:71]
  v_mfma_f32_16x16x32_bf16 v[80:83], a[152:155], v[32:35], v[80:83]
  v_mfma_f32_16x16x32_bf16 v[84:87], a[156:159], v[32:35], v[84:87]
  s_waitcnt lgkmcnt(5)
  v_mfma_f32_16x16x32_bf16 v[72:75], a[144:147], v[36:39], v[72:75]
  ds_read_b128 v[28:31], v9 offset:24576
  v_mfma_f32_16x16x32_bf16 v[76:79], a[148:151], v[36:39], v[76:79]
  v_mfma_f32_16x16x32_bf16 v[88:91], a[152:155], v[36:39], v[88:91]
  buffer_store_dwordx4 v[132:135], v7, s[4:7], s21 offen offset:256 sc1
  v_mfma_f32_16x16x32_bf16 v[92:95], a[156:159], v[36:39], v[92:95]
  s_waitcnt lgkmcnt(5)
  v_mfma_f32_16x16x32_bf16 v[64:67], a[160:163], v[40:43], v[64:67]
  ds_read_b128 v[32:35], v10 offset:24576
  v_mfma_f32_16x16x32_bf16 v[68:71], a[164:167], v[40:43], v[68:71]
  v_mfma_f32_16x16x32_bf16 v[80:83], a[168:171], v[40:43], v[80:83]
  v_mfma_f32_16x16x32_bf16 v[84:87], a[172:175], v[40:43], v[84:87]
  s_waitcnt lgkmcnt(5)
  v_mfma_f32_16x16x32_bf16 v[72:75], a[160:163], v[44:47], v[72:75]
  ds_read_b128 v[36:39], v11 offset:24576
  v_mfma_f32_16x16x32_bf16 v[76:79], a[164:167], v[44:47], v[76:79]
  v_mfma_f32_16x16x32_bf16 v[88:91], a[168:171], v[44:47], v[88:91]
  buffer_store_dwordx4 v[136:139], v7, s[4:7], s21 offen offset:2048 sc1
  v_mfma_f32_16x16x32_bf16 v[92:95], a[172:175], v[44:47], v[92:95]
  s_waitcnt lgkmcnt(5)
  v_mfma_f32_16x16x32_bf16 v[64:67], a[176:179], v[48:51], v[64:67]
  ds_read_b128 v[40:43], v12 offset:24576
  v_mfma_f32_16x16x32_bf16 v[68:71], a[180:183], v[48:51], v[68:71]
  v_mfma_f32_16x16x32_bf16 v[80:83], a[184:187], v[48:51], v[80:83]
  v_mfma_f32_16x16x32_bf16 v[84:87], a[188:191], v[48:51], v[84:87]
  s_waitcnt lgkmcnt(5)
  v_mfma_f32_16x16x32_bf16 v[72:75], a[176:179], v[52:55], v[72:75]
  ds_read_b128 v[44:47], v13 offset:24576
  v_mfma_f32_16x16x32_bf16 v[76:79], a[180:183], v[52:55], v[76:79]
  v_mfma_f32_16x16x32_bf16 v[88:91], a[184:187], v[52:55], v[88:91]
  buffer_store_dwordx4 v[140:143], v7, s[4:7], s21 offen offset:2304 sc1
  v_mfma_f32_16x16x32_bf16 v[92:95], a[188:191], v[52:55], v[92:95]
  s_waitcnt lgkmcnt(5)
  v_mfma_f32_16x16x32_bf16 v[64:67], a[192:195], v[24:27], v[64:67]
  s_mov_b32 s21, s27
  ds_read_b128 v[48:51], v14 offset:24576
  v_mfma_f32_16x16x32_bf16 v[68:71], a[196:199], v[24:27], v[68:71]
  v_mov_b32 v7, v56
  v_mfma_f32_16x16x32_bf16 v[80:83], a[200:203], v[24:27], v[80:83]
  v_mfma_f32_16x16x32_bf16 v[84:87], a[204:207], v[24:27], v[84:87]
  s_waitcnt lgkmcnt(5)
  v_mfma_f32_16x16x32_bf16 v[72:75], a[192:195], v[28:31], v[72:75]
  s_add_u32 s27, s27, s22
  ds_read_b128 v[52:55], v15 offset:24576
  v_mfma_f32_16x16x32_bf16 v[76:79], a[196:199], v[28:31], v[76:79]
  v_mfma_f32_16x16x32_bf16 v[88:91], a[200:203], v[28:31], v[88:91]
  s_waitcnt vmcnt(16)
  s_barrier
  v_mfma_f32_16x16x32_bf16 v[92:95], a[204:207], v[28:31], v[92:95]
  s_waitcnt lgkmcnt(5)
  v_mfma_f32_16x16x32_bf16 v[64:67], a[208:211], v[32:35], v[64:67]
  ds_read_b128 v[24:27], v8 offset:32768
  v_mfma_f32_16x16x32_bf16 v[68:71], a[212:215], v[32:35], v[68:71]
  v_mfma_f32_16x16x32_bf16 v[80:83], a[216:219], v[32:35], v[80:83]
  v_mfma_f32_16x16x32_bf16 v[84:87], a[220:223], v[32:35], v[84:87]
  s_waitcnt lgkmcnt(5)
  v_mfma_f32_16x16x32_bf16 v[72:75], a[208:211], v[36:39], v[72:75]
  ds_read_b128 v[28:31], v9 offset:32768
  v_mfma_f32_16x16x32_bf16 v[76:79], a[212:215], v[36:39], v[76:79]
  v_mfma_f32_16x16x32_bf16 v[88:91], a[216:219], v[36:39], v[88:91]
  v_mfma_f32_16x16x32_bf16 v[92:95], a[220:223], v[36:39], v[92:95]
  s_waitcnt lgkmcnt(5)
  v_mfma_f32_16x16x32_bf16 v[64:67], a[224:227], v[40:43], v[64:67]
  ds_read_b128 v[32:35], v10 offset:32768
  v_mfma_f32_16x16x32_bf16 v[68:71], a[228:231], v[40:43], v[68:71]
  v_mfma_f32_16x16x32_bf16 v[80:83], a[232:235], v[40:43], v[80:83]
  v_mfma_f32_16x16x32_bf16 v[84:87], a[236:239], v[40:43], v[84:87]
  s_waitcnt lgkmcnt(5)
  v_mfma_f32_16x16x32_bf16 v[72:75], a[224:227], v[44:47], v[72:75]
  ds_read_b128 v[36:39], v11 offset:32768
  v_mfma_f32_16x16x32_bf16 v[76:79], a[228:231], v[44:47], v[76:79]
  v_mfma_f32_16x16x32_bf16 v[88:91], a[232:235], v[44:47], v[88:91]
  v_mfma_f32_16x16x32_bf16 v[92:95], a[236:239], v[44:47], v[92:95]
  s_waitcnt lgkmcnt(5)
  v_mfma_f32_16x16x32_bf16 v[64:67], a[240:243], v[48:51], v[64:67]
  s_sub_u32 s23, s23, 1
  ds_read_b128 v[40:43], v12 offset:32768
  v_mfma_f32_16x16x32_bf16 v[68:71], a[244:247], v[48:51], v[68:71]
  v_mfma_f32_16x16x32_bf16 v[80:83], a[248:251], v[48:51], v[80:83]
  v_mfma_f32_16x16x32_bf16 v[84:87], a[252:255], v[48:51], v[84:87]
  s_waitcnt lgkmcnt(5)
  v_mfma_f32_16x16x32_bf16 v[72:75], a[240:243], v[52:55], v[72:75]
  s_cmp_eq_u32 s23, 0
  ds_read_b128 v[44:47], v13 offset:32768
  v_mfma_f32_16x16x32_bf16 v[76:79], a[244:247], v[52:55], v[76:79]
  v_mfma_f32_16x16x32_bf16 v[88:91], a[248:251], v[52:55], v[88:91]
  v_mfma_f32_16x16x32_bf16 v[92:95], a[252:255], v[52:55], v[92:95]
  s_cbranch_scc1 G_done0_51
  s_waitcnt lgkmcnt(5)
  v_mfma_f32_16x16x32_bf16 v[96:99], a[0:3], v[24:27], 0
  s_add_u32 m0, s25, 0
  ds_read_b128 v[48:51], v14 offset:32768
  v_mfma_f32_16x16x32_bf16 v[100:103], a[4:7], v[24:27], 0
  v_mfma_f32_16x16x32_bf16 v[112:115], a[8:11], v[24:27], 0
  buffer_load_dwordx4 v16, s[12:15], s19 offen sc1 lds
  v_mfma_f32_16x16x32_bf16 v[116:119], a[12:15], v[24:27], 0
  s_waitcnt lgkmcnt(5)
  v_mfma_f32_16x16x32_bf16 v[104:107], a[0:3], v[28:31], 0
  ds_read_b128 v[52:55], v15 offset:32768
  v_mfma_f32_16x16x32_bf16 v[108:111], a[4:7], v[28:31], 0
  v_cvt_pk_bf16_f32 v128, v64, v65
  v_cvt_pk_bf16_f32 v129, v66, v67
  v_mfma_f32_16x16x32_bf16 v[120:123], a[8:11], v[28:31], 0
  v_mfma_f32_16x16x32_bf16 v[124:127], a[12:15], v[28:31], 0
  s_waitcnt lgkmcnt(5)
  v_cvt_pk_bf16_f32 v130, v68, v69
  v_cvt_pk_bf16_f32 v131, v70, v71
  v_mfma_f32_16x16x32_bf16 v[96:99], a[16:19], v[32:35], v[96:99]
  s_add_u32 m0, s25, 1024
  ds_read_b128 v[24:27], v8 offset:40960
  v_mfma_f32_16x16x32_bf16 v[100:103], a[20:23], v[32:35], v[100:103]
  v_mfma_f32_16x16x32_bf16 v[112:115], a[24:27], v[32:35], v[112:115]
  buffer_load_dwordx4 v17, s[12:15], s19 offen sc1 lds
  v_mfma_f32_16x16x32_bf16 v[116:119], a[28:31], v[32:35], v[116:119]
  s_waitcnt lgkmcnt(5)
  v_mfma_f32_16x16x32_bf16 v[104:107], a[16:19], v[36:39], v[104:107]
  ds_read_b128 v[28:31], v9 offset:40960
  v_mfma_f32_16x16x32_bf16 v[108:111], a[20:23], v[36:39], v[108:111]
  v_mfma_f32_16x16x32_bf16 v[120:123], a[24:27], v[36:39], v[120:123]
  v_mfma_f32_16x16x32_bf16 v[124:127], a[28:31], v[36:39], v[124:127]
  s_waitcnt lgkmcnt(5)
  v_mfma_f32_16x16x32_bf16 v[96:99], a[32:35], v[40:43], v[96:99]
  s_add_u32 m0, s25, 2048
  ds_read_b128 v[32:35], v10 offset:40960
  v_mfma_f32_16x16x32_bf16 v[100:103], a[36:39], v[40:43], v[100:103]
  v_cvt_pk_bf16_f32 v132, v72, v73
  v_cvt_pk_bf16_f32 v133, v74, v75
  v_mfma_f32_16x16x32_bf16 v[112:115], a[40:43], v[40:43], v[112:115]
  buffer_load_dwordx4 v18, s[12:15], s19 offen sc1 lds
  v_mfma_f32_16x16x32_bf16 v[116:119], a[44:47], v[40:43], v[116:119]
  s_waitcnt lgkmcnt(5)
  v_cvt_pk_bf16_f32 v134, v76, v77
  v_cvt_pk_bf16_f32 v135, v78, v79
  v_mfma_f32_16x16x32_bf16 v[104:107], a[32:35], v[44:47], v[104:107]
  ds_read_b128 v[36:39], v11 offset:40960
  v_mfma_f32_16x16x32_bf16 v[108:111], a[36:39], v[44:47], v[108:111]
  v_mfma_f32_16x16x32_bf16 v[120:123], a[40:43], v[44:47], v[120:123]
  v_mfma_f32_16x16x32_bf16 v[124:127], a[44:47], v[44:47], v[124:127]
  s_waitcnt lgkmcnt(5)
  v_mfma_f32_16x16x32_bf16 v[96:99], a[48:51], v[48:51], v[96:99]
  s_add_u32 m0, s25, 3072
  ds_read_b128 v[40:43], v12 offset:40960
  v_mfma_f32_16x16x32_bf16 v[100:103], a[52:55], v[48:51], v[100:103]
  v_mfma_f32_16x16x32_bf16 v[112:115], a[56:59], v[48:51], v[112:115]
  buffer_load_dwordx4 v19, s[12:15], s19 offen sc1 lds
  v_mfma_f32_16x16x32_bf16 v[116:119], a[60:63], v[48:51], v[116:119]
  s_waitcnt lgkmcnt(5)
  v_mfma_f32_16x16x32_bf16 v[104:107], a[48:51], v[52:55], v[104:107]
  ds_read_b128 v[44:47], v13 offset:40960
  v_mfma_f32_16x16x32_bf16 v[108:111], a[52:55], v[52:55], v[108:111]
  v_cvt_pk_bf16_f32 v136, v80, v81
  v_cvt_pk_bf16_f32 v137, v82, v83
  v_mfma_f32_16x16x32_bf16 v[120:123], a[56:59], v[52:55], v[120:123]
  v_mfma_f32_16x16x32_bf16 v[124:127], a[60:63], v[52:55], v[124:127]
  s_waitcnt lgkmcnt(5)
  v_cvt_pk_bf16_f32 v138, v84, v85
  v_cvt_pk_bf16_f32 v139, v86, v87
  v_mfma_f32_16x16x32_bf16 v[96:99], a[64:67], v[24:27], v[96:99]
  s_add_u32 m0, s25, 4096
  ds_read_b128 v[48:51], v14 offset:40960
  v_mfma_f32_16x16x32_bf16 v[100:103], a[68:71], v[24:27], v[100:103]
  v_mfma_f32_16x16x32_bf16 v[112:115], a[72:75], v[24:27], v[112:115]
  buffer_load_dwordx4 v20, s[12:15], s19 offen sc1 lds
  v_mfma_f32_16x16x32_bf16 v[116:119], a[76:79], v[24:27], v[116:119]
  s_waitcnt lgkmcnt(5)
  v_mfma_f32_16x16x32_bf16 v[104:107], a[64:67], v[28:31], v[104:107]
  ds_read_b128 v[52:55], v15 offset:40960
  v_mfma_f32_16x16x32_bf16 v[108:111], a[68:71], v[28:31], v[108:111]
  v_mfma_f32_16x16x32_bf16 v[120:123], a[72:75], v[28:31], v[120:123]
  v_mfma_f32_16x16x32_bf16 v[124:127], a[76:79], v[28:31], v[124:127]
  s_waitcnt lgkmcnt(5)
  v_mfma_f32_16x16x32_bf16 v[96:99], a[80:83], v[32:35], v[96:99]
  s_add_u32 m0, s25, 5120
  ds_read_b128 v[24:27], v8 offset:49152
  v_mfma_f32_16x16x32_bf16 v[100:103], a[84:87], v[32:35], v[100:103]
  v_cvt_pk_bf16_f32 v140, v88, v89
  v_cvt_pk_bf16_f32 v141, v90, v91
  v_mfma_f32_16x16x32_bf16 v[112:115], a[88:91], v[32:35], v[112:115]
  buffer_load_dwordx4 v21, s[12:15], s19 offen sc1 lds
  v_mfma_f32_16x16x32_bf16 v[116:119], a[92:95], v[32:35], v[116:119]
  s_waitcnt lgkmcnt(5)
  v_cvt_pk_bf16_f32 v142, v92, v93
  v_cvt_pk_bf16_f32 v143, v94, v95
  v_mfma_f32_16x16x32_bf16 v[104:107], a[80:83], v[36:39], v[104:107]
  ds_read_b128 v[28:31], v9 offset:49152
  v_mfma_f32_16x16x32_bf16 v[108:111], a[84:87], v[36:39], v[108:111]
  v_mfma_f32_16x16x32_bf16 v[120:123], a[88:91], v[36:39], v[120:123]
  v_mfma_f32_16x16x32_bf16 v[124:127], a[92:95], v[36:39], v[124:127]
  s_waitcnt lgkmcnt(5)
  v_mfma_f32_16x16x32_bf16 v[96:99], a[96:99], v[40:43], v[96:99]
  s_add_u32 m0, s25, 6144
  ds_read_b128 v[32:35], v10 offset:49152
  v_mfma_f32_16x16x32_bf16 v[100:103], a[100:103], v[40:43], v[100:103]
  v_mfma_f32_16x16x32_bf16 v[112:115], a[104:107], v[40:43], v[112:115]
  buffer_load_dwordx4 v22, s[12:15], s19 offen sc1 lds
  v_mfma_f32_16x16x32_bf16 v[116:119], a[108:111], v[40:43], v[116:119]
  s_waitcnt lgkmcnt(5)
  v_mfma_f32_16x16x32_bf16 v[104:107], a[96:99], v[44:47], v[104:107]
  ds_read_b128 v[36:39], v11 offset:49152
  v_mfma_f32_16x16x32_bf16 v[108:111], a[100:103], v[44:47], v[108:111]
  v_mfma_f32_16x16x32_bf16 v[120:123], a[104:107], v[44:47], v[120:123]
  v_mfma_f32_16x16x32_bf16 v[124:127], a[108:111], v[44:47], v[124:127]
  s_waitcnt lgkmcnt(5)
  v_mfma_f32_16x16x32_bf16 v[96:99], a[112:115], v[48:51], v[96:99]
  s_add_u32 m0, s25, 7168
  ds_read_b128 v[40:43], v12 offset:49152
  v_mfma_f32_16x16x32_bf16 v[100:103], a[116:119], v[48:51], v[100:103]
  v_mfma_f32_16x16x32_bf16 v[112:115], a[120:123], v[48:51], v[112:115]
  buffer_load_dwordx4 v23, s[12:15], s19 offen sc1 lds
  v_mfma_f32_16x16x32_bf16 v[116:119], a[124:127], v[48:51], v[116:119]
  s_waitcnt lgkmcnt(5)
  v_mfma_f32_16x16x32_bf16 v[104:107], a[112:115], v[52:55], v[104:107]
  s_cmp_gt_u32 s23, 3
  ds_read_b128 v[44:47], v13 offset:49152
  v_mfma_f32_16x16x32_bf16 v[108:111], a[116:119], v[52:55], v[108:111]
  v_mfma_f32_16x16x32_bf16 v[120:123], a[120:123], v[52:55], v[120:123]
  s_cselect_b32 s26, s20, 0
  v_mfma_f32_16x16x32_bf16 v[124:127], a[124:127], v[52:55], v[124:127]
  s_waitcnt lgkmcnt(5)
  v_mfma_f32_16x16x32_bf16 v[96:99], a[128:131], v[24:27], v[96:99]
  s_add_u32 s19, s19, s26
  ds_read_b128 v[48:51], v14 offset:49152
  v_mfma_f32_16x16x32_bf16 v[100:103], a[132:135], v[24:27], v[100:103]
  v_mfma_f32_16x16x32_bf16 v[112:115], a[136:139], v[24:27], v[112:115]
  s_add_u32 s25, s25, 32768
  v_mfma_f32_16x16x32_bf16 v[116:119], a[140:143], v[24:27], v[116:119]
  s_waitcnt lgkmcnt(5)
  v_mfma_f32_16x16x32_bf16 v[104:107], a[128:131], v[28:31], v[104:107]
  s_and_b32 s25, s25, 0x1ffff
  ds_read_b128 v[52:55], v15 offset:49152
  v_mfma_f32_16x16x32_bf16 v[108:111], a[132:135], v[28:31], v[108:111]
  v_mfma_f32_16x16x32_bf16 v[120:123], a[136:139], v[28:31], v[120:123]
  buffer_store_dwordx4 v[128:131], v7, s[4:7], s21 offen offset:0 sc1
  v_mfma_f32_16x16x32_bf16 v[124:127], a[140:143], v[28:31], v[124:127]
  s_waitcnt lgkmcnt(5)
  v_mfma_f32_16x16x32_bf16 v[96:99], a[144:147], v[32:35], v[96:99]
  ds_read_b128 v[24:27], v8 offset:57344
  v_mfma_f32_16x16x32_bf16 v[100:103], a[148:151], v[32:35], v[100:103]
  v_mfma_f32_16x16x32_bf16 v[112:115], a[152:155], v[32:35], v[112:115]
  v_mfma_f32_16x16x32_bf16 v[116:119], a[156:159], v[32:35], v[116:119]
  s_waitcnt lgkmcnt(5)
  v_xor_b32 v8, 0x10000, v8
  v_mfma_f32_16x16x32_bf16 v[104:107], a[144:147], v[36:39], v[104:107]
  ds_read_b128 v[28:31], v9 offset:57344
  v_mfma_f32_16x16x32_bf16 v[108:111], a[148:151], v[36:39], v[108:111]
  v_mfma_f32_16x16x32_bf16 v[120:123], a[152:155], v[36:39], v[120:123]
  buffer_store_dwordx4 v[132:135], v7, s[4:7], s21 offen offset:256 sc1
  v_mfma_f32_16x16x32_bf16 v[124:127], a[156:159], v[36:39], v[124:127]
  s_waitcnt lgkmcnt(5)
  v_xor_b32 v9, 0x10000, v9
  v_mfma_f32_16x16x32_bf16 v[96:99], a[160:163], v[40:43], v[96:99]
  ds_read_b128 v[32:35], v10 offset:57344
  v_mfma_f32_16x16x32_bf16 v[100:103], a[164:167], v[40:43], v[100:103]
  v_mfma_f32_16x16x32_bf16 v[112:115], a[168:171], v[40:43], v[112:115]
  v_mfma_f32_16x16x32_bf16 v[116:119], a[172:175], v[40:43], v[116:119]
  s_waitcnt lgkmcnt(5)
  v_xor_b32 v10, 0x10000, v10
  v_mfma_f32_16x16x32_bf16 v[104:107], a[160:163], v[44:47], v[104:107]
  ds_read_b128 v[36:39], v11 offset:57344
  v_mfma_f32_16x16x32_bf16 v[108:111], a[164:167], v[44:47], v[108:111]
  v_mfma_f32_16x16x32_bf16 v[120:123], a[168:171], v[44:47], v[120:123]
  buffer_store_dwordx4 v[136:139], v7, s[4:7], s21 offen offset:2048 sc1
  v_mfma_f32_16x16x32_bf16 v[124:127], a[172:175], v[44:47], v[124:127]
  s_waitcnt lgkmcnt(5)
  v_xor_b32 v11, 0x10000, v11
  v_mfma_f32_16x16x32_bf16 v[96:99], a[176:179], v[48:51], v[96:99]
  ds_read_b128 v[40:43], v12 offset:57344
  v_mfma_f32_16x16x32_bf16 v[100:103], a[180:183], v[48:51], v[100:103]
  v_mfma_f32_16x16x32_bf16 v[112:115], a[184:187], v[48:51], v[112:115]
  v_mfma_f32_16x16x32_bf16 v[116:119], a[188:191], v[48:51], v[116:119]
  s_waitcnt lgkmcnt(5)
  v_xor_b32 v12, 0x10000, v12
  v_mfma_f32_16x16x32_bf16 v[104:107], a[176:179], v[52:55], v[104:107]
  ds_read_b128 v[44:47], v13 offset:57344
  v_mfma_f32_16x16x32_bf16 v[108:111], a[180:183], v[52:55], v[108:111]
  v_mfma_f32_16x16x32_bf16 v[120:123], a[184:187], v[52:55], v[120:123]
  buffer_store_dwordx4 v[140:143], v7, s[4:7], s21 offen offset:2304 sc1
  v_mfma_f32_16x16x32_bf16 v[124:127], a[188:191], v[52:55], v[124:127]
  s_waitcnt lgkmcnt(5)
  v_xor_b32 v13, 0x10000, v13
  v_mfma_f32_16x16x32_bf16 v[96:99], a[192:195], v[24:27], v[96:99]
  s_mov_b32 s21, s27
  ds_read_b128 v[48:51], v14 offset:57344
  v_mfma_f32_16x16x32_bf16 v[100:103], a[196:199], v[24:27], v[100:103]
  v_mov_b32 v7, v56
  v_mfma_f32_16x16x32_bf16 v[112:115], a[200:203], v[24:27], v[112:115]
  v_mfma_f32_16x16x32_bf16 v[116:119], a[204:207], v[24:27], v[116:119]
  s_waitcnt lgkmcnt(5)
  v_xor_b32 v14, 0x10000, v14
  v_mfma_f32_16x16x32_bf16 v[104:107], a[192:195], v[28:31], v[104:107]
  s_add_u32 s27, s27, s22
  ds_read_b128 v[52:55], v15 offset:57344
  v_mfma_f32_16x16x32_bf16 v[108:111], a[196:199], v[28:31], v[108:111]
  v_mfma_f32_16x16x32_bf16 v[120:123], a[200:203], v[28:31], v[120:123]
  s_waitcnt vmcnt(16)
  s_barrier
  v_mfma_f32_16x16x32_bf16 v[124:127], a[204:207], v[28:31], v[124:127]
  s_waitcnt lgkmcnt(5)
  v_xor_b32 v15, 0x10000, v15
  v_mfma_f32_16x16x32_bf16 v[96:99], a[208:211], v[32:35], v[96:99]
  ds_read_b128 v[24:27], v8 offset:0
  v_mfma_f32_16x16x32_bf16 v[100:103], a[212:215], v[32:35], v[100:103]
  v_mfma_f32_16x16x32_bf16 v[112:115], a[216:219], v[32:35], v[112:115]
  v_mfma_f32_16x16x32_bf16 v[116:119], a[220:223], v[32:35], v[116:119]
  s_waitcnt lgkmcnt(5)
  v_mfma_f32_16x16x32_bf16 v[104:107], a[208:211], v[36:39], v[104:107]
  ds_read_b128 v[28:31], v9 offset:0
  v_mfma_f32_16x16x32_bf16 v[108:111], a[212:215], v[36:39], v[108:111]
  v_mfma_f32_16x16x32_bf16 v[120:123], a[216:219], v[36:39], v[120:123]
  v_mfma_f32_16x16x32_bf16 v[124:127], a[220:223], v[36:39], v[124:127]
  s_waitcnt lgkmcnt(5)
  v_mfma_f32_16x16x32_bf16 v[96:99], a[224:227], v[40:43], v[96:99]
  ds_read_b128 v[32:35], v10 offset:0
  v_mfma_f32_16x16x32_bf16 v[100:103], a[228:231], v[40:43], v[100:103]
  v_mfma_f32_16x16x32_bf16 v[112:115], a[232:235], v[40:43], v[112:115]
  v_mfma_f32_16x16x32_bf16 v[116:119], a[236:239], v[40:43], v[116:119]
  s_waitcnt lgkmcnt(5)
  v_mfma_f32_16x16x32_bf16 v[104:107], a[224:227], v[44:47], v[104:107]
  ds_read_b128 v[36:39], v11 offset:0
  v_mfma_f32_16x16x32_bf16 v[108:111], a[228:231], v[44:47], v[108:111]
  v_mfma_f32_16x16x32_bf16 v[120:123], a[232:235], v[44:47], v[120:123]
  v_mfma_f32_16x16x32_bf16 v[124:127], a[236:239], v[44:47], v[124:127]
  s_waitcnt lgkmcnt(5)
  v_mfma_f32_16x16x32_bf16 v[96:99], a[240:243], v[48:51], v[96:99]
  s_sub_u32 s23, s23, 1
  ds_read_b128 v[40:43], v12 offset:0
  v_mfma_f32_16x16x32_bf16 v[100:103], a[244:247], v[48:51], v[100:103]
  v_mfma_f32_16x16x32_bf16 v[112:115], a[248:251], v[48:51], v[112:115]
  v_mfma_f32_16x16x32_bf16 v[116:119], a[252:255], v[48:51], v[116:119]
  s_waitcnt lgkmcnt(5)
  v_mfma_f32_16x16x32_bf16 v[104:107], a[240:243], v[52:55], v[104:107]
  s_cmp_eq_u32 s23, 0
  ds_read_b128 v[44:47], v13 offset:0
  v_mfma_f32_16x16x32_bf16 v[108:111], a[244:247], v[52:55], v[108:111]
  v_mfma_f32_16x16x32_bf16 v[120:123], a[248:251], v[52:55], v[120:123]
  v_mfma_f32_16x16x32_bf16 v[124:127], a[252:255], v[52:55], v[124:127]
  s_cbranch_scc1 G_done1_52
  s_branch G_top_50
G_done0_51:
  s_nop 7
  s_nop 3
  v_cvt_pk_bf16_f32 v128, v64, v65
  v_cvt_pk_bf16_f32 v129, v66, v67
  v_cvt_pk_bf16_f32 v130, v68, v69
  v_cvt_pk_bf16_f32 v131, v70, v71
  buffer_store_dwordx4 v[128:131], v7, s[4:7], s21 offen offset:0 sc1
  v_cvt_pk_bf16_f32 v132, v72, v73
  v_cvt_pk_bf16_f32 v133, v74, v75
  v_cvt_pk_bf16_f32 v134, v76, v77
  v_cvt_pk_bf16_f32 v135, v78, v79
  buffer_store_dwordx4 v[132:135], v7, s[4:7], s21 offen offset:256 sc1
  v_cvt_pk_bf16_f32 v136, v80, v81
  v_cvt_pk_bf16_f32 v137, v82, v83
  v_cvt_pk_bf16_f32 v138, v84, v85
  v_cvt_pk_bf16_f32 v139, v86, v87
  buffer_store_dwordx4 v[136:139], v7, s[4:7], s21 offen offset:2048 sc1
  v_cvt_pk_bf16_f32 v140, v88, v89
  v_cvt_pk_bf16_f32 v141, v90, v91
  v_cvt_pk_bf16_f32 v142, v92, v93
  v_cvt_pk_bf16_f32 v143, v94, v95
  buffer_store_dwordx4 v[140:143], v7, s[4:7], s21 offen offset:2304 sc1
  s_branch G_fin_53
G_done1_52:
  s_nop 7
  s_nop 3
  v_cvt_pk_bf16_f32 v128, v96, v97
  v_cvt_pk_bf16_f32 v129, v98, v99
  v_cvt_pk_bf16_f32 v130, v100, v101
  v_cvt_pk_bf16_f32 v131, v102, v103
  buffer_store_dwordx4 v[128:131], v7, s[4:7], s21 offen offset:0 sc1
  v_cvt_pk_bf16_f32 v132, v104, v105
  v_cvt_pk_bf16_f32 v133, v106, v107
  v_cvt_pk_bf16_f32 v134, v108, v109
  v_cvt_pk_bf16_f32 v135, v110, v111
  buffer_store_dwordx4 v[132:135], v7, s[4:7], s21 offen offset:256 sc1
  v_cvt_pk_bf16_f32 v136, v112, v113
  v_cvt_pk_bf16_f32 v137, v114, v115
  v_cvt_pk_bf16_f32 v138, v116, v117
  v_cvt_pk_bf16_f32 v139, v118, v119
  buffer_store_dwordx4 v[136:139], v7, s[4:7], s21 offen offset:2048 sc1
  v_cvt_pk_bf16_f32 v140, v120, v121
  v_cvt_pk_bf16_f32 v141, v122, v123
  v_cvt_pk_bf16_f32 v142, v124, v125
  v_cvt_pk_bf16_f32 v143, v126, v127
  buffer_store_dwordx4 v[140:143], v7, s[4:7], s21 offen offset:2304 sc1
G_fin_53:
  s_waitcnt vmcnt(0) lgkmcnt(0)
  s_barrier
  s_waitcnt vmcnt(0)
  s_barrier
  s_mov_b32 s30, 768
  v_mov_b32 v144, s30
  v_min_u32 v145, 1, v0
  v_lshlrev_b32 v145, 30, v145
  buffer_store_dword v144, v145, s[4:7], s31 offen sc1
  s_mul_i32 s50, s64, 6
  s_add_u32 s50, s50, s65
  s_mul_i32 s76, s50, 21846
  s_lshr_b32 s76, s76, 16
  s_mul_i32 s77, s76, 3
  s_add_u32 s51, s50, 64
  s_cmp_eq_u32 s77, s50
  s_cselect_b32 s50, s76, s51
M_fin:
  s_lshr_b32 s48, s50, 2
  s_and_b32 s49, s50, 3
  s_load_dwordx2 s[8:9], s[0:1], 0
  s_load_dwordx2 s[12:13], s[0:1], 104
  s_load_dwordx2 s[32:33], s[0:1], 112
  v_and_b32 v4, 31, v1
  v_lshrrev_b32 v5, 5, v1
  v_lshlrev_b32 v5, 4, v5
  v_lshl_add_u32 v6, v4, 10, v5
  s_lshl_b32 s26, s16, 8
  s_lshl_b32 s27, s48, 15
  s_add_u32 s27, s27, s26
  s_waitcnt lgkmcnt(0)
  s_and_b32 s9, s9, 0xffff
  s_mov_b32 s10, 2097152
  s_mov_b32 s11, 0x20000
  s_and_b32 s13, s13, 0xffff
  s_mov_b32 s14, 1024
  s_mov_b32 s15, 0x20000
  s_and_b32 s33, s33, 0xffff
  s_mov_b32 s34, 2097152
  s_mov_b32 s35, 0x20000
  buffer_load_dwordx4 v[16:19], v6, s[8:11], s27 offen offset:0
  buffer_load_dwordx4 v[48:51], v5, s[12:15], s26 offen offset:0
  buffer_load_dwordx4 v[20:23], v6, s[8:11], s27 offen offset:32
  buffer_load_dwordx4 v[52:55], v5, s[12:15], s26 offen offset:32
  buffer_load_dwordx4 v[24:27], v6, s[8:11], s27 offen offset:64
  buffer_load_dwordx4 v[56:59], v5, s[12:15], s26 offen offset:64
  buffer_load_dwordx4 v[28:31], v6, s[8:11], s27 offen offset:96
  buffer_load_dwordx4 v[60:63], v5, s[12:15], s26 offen offset:96
  buffer_load_dwordx4 v[32:35], v6, s[8:11], s27 offen offset:128
  buffer_load_dwordx4 v[64:67], v5, s[12:15], s26 offen offset:128
  buffer_load_dwordx4 v[36:39], v6, s[8:11], s27 offen offset:160
  buffer_load_dwordx4 v[68:71], v5, s[12:15], s26 offen offset:160
  buffer_load_dwordx4 v[40:43], v6, s[8:11], s27 offen offset:192
  buffer_load_dwordx4 v[72:75], v5, s[12:15], s26 offen offset:192
  buffer_load_dwordx4 v[44:47], v6, s[8:11], s27 offen offset:224
  buffer_load_dwordx4 v[76:79], v5, s[12:15], s26 offen offset:224
  s_lshl_b32 s28, s48, 2
  s_add_u32 s28, s28, s49
  s_lshl_b32 s28, s28, 2
  s_add_u32 s28, s28, s16
  s_lshl_b32 s28, s28, 11
  s_waitcnt vmcnt(14)
  v_mfma_f32_32x32x16_bf16 v[80:95], v[48:51], v[16:19], 0
  s_waitcnt vmcnt(12)
  v_mfma_f32_32x32x16_bf16 v[80:95], v[52:55], v[20:23], v[80:95]
  s_waitcnt vmcnt(10)
  v_mfma_f32_32x32x16_bf16 v[80:95], v[56:59], v[24:27], v[80:95]
  s_waitcnt vmcnt(8)
  v_mfma_f32_32x32x16_bf16 v[80:95], v[60:63], v[28:31], v[80:95]
  s_waitcnt vmcnt(6)
  v_mfma_f32_32x32x16_bf16 v[80:95], v[64:67], v[32:35], v[80:95]
  s_waitcnt vmcnt(4)
  v_mfma_f32_32x32x16_bf16 v[80:95], v[68:71], v[36:39], v[80:95]
  s_waitcnt vmcnt(2)
  v_mfma_f32_32x32x16_bf16 v[80:95], v[72:75], v[40:43], v[80:95]
  s_waitcnt vmcnt(0)
  v_mfma_f32_32x32x16_bf16 v[80:95], v[76:79], v[44:47], v[80:95]
  s_mul_i32 s76, s48, 43
  s_lshr_b32 s76, s76, 9
  s_mul_i32 s76, s76, 12
  s_sub_u32 s76, s48, s76
  s_cmp_ge_u32 s76, 6
  s_addc_u32 s76, s76, 0
  s_and_b32 s77, s49, 2
  s_mul_i32 s77, s77, 7
  s_add_u32 s76, s76, s77
  v_mov_b32 v193, 0x300
  s_lshl_b32 s76, s76, 7
  s_add_u32 s76, s76, 148897792
  v_and_b32 v192, 7, v1
  v_mul_u32_u24 v192, 3584, v192
  v_add_u32 v192, s76, v192
  s_mov_b32 s71, 0
  s_branch M_vg_55
M_vw_54:
  s_sleep 2
  s_add_u32 s71, s71, 1
  s_cmp_gt_u32 s71, 262144
  s_cbranch_scc1 M_exit
M_vg_55:
  buffer_load_dword v194, v192, s[4:7], 0 offen sc1
  s_waitcnt vmcnt(0)
  v_cmp_lt_u32 vcc, v194, v193
  s_cbranch_vccnz M_vw_54
  s_add_u32 s29, s28, 150994944
  buffer_load_dwordx4 v[96:99], v2, s[4:7], s29 offen offset:0 sc1
  buffer_load_dwordx4 v[100:103], v2, s[4:7], s29 offen offset:1024 sc1
  s_add_u32 s29, s28, 153092096
  buffer_load_dwordx4 v[104:107], v2, s[4:7], s29 offen offset:0 sc1
  buffer_load_dwordx4 v[108:111], v2, s[4:7], s29 offen offset:1024 sc1
  s_add_u32 s29, s28, 155189248
  buffer_load_dwordx4 v[112:115], v2, s[4:7], s29 offen offset:0 sc1
  buffer_load_dwordx4 v[116:119], v2, s[4:7], s29 offen offset:1024 sc1
  s_add_u32 s29, s28, 157286400
  buffer_load_dwordx4 v[120:123], v2, s[4:7], s29 offen offset:0 sc1
  buffer_load_dwordx4 v[124:127], v2, s[4:7], s29 offen offset:1024 sc1
  s_add_u32 s29, s28, 159383552
  buffer_load_dwordx4 v[128:131], v2, s[4:7], s29 offen offset:0 sc1
  buffer_load_dwordx4 v[132:135], v2, s[4:7], s29 offen offset:1024 sc1
  s_add_u32 s29, s28, 161480704
  buffer_load_dwordx4 v[136:139], v2, s[4:7], s29 offen offset:0 sc1
  buffer_load_dwordx4 v[140:143], v2, s[4:7], s29 offen offset:1024 sc1
  s_add_u32 s29, s28, 163577856
  buffer_load_dwordx4 v[144:147], v2, s[4:7], s29 offen offset:0 sc1
  buffer_load_dwordx4 v[148:151], v2, s[4:7], s29 offen offset:1024 sc1
  s_add_u32 s29, s28, 165675008
  buffer_load_dwordx4 v[152:155], v2, s[4:7], s29 offen offset:0 sc1
  buffer_load_dwordx4 v[156:159], v2, s[4:7], s29 offen offset:1024 sc1
  v_lshlrev_b32 v7, 4, v4
  s_lshl_b32 s26, s16, 2
  v_add_u32 v4, s26, v7
  s_barrier
  ds_write_b32 v4, v80
  s_waitcnt lgkmcnt(0)
  s_barrier
  ds_read_b128 v[84:87], v7
  s_waitcnt lgkmcnt(0)
  v_add_f32 v80, v84, v85
  v_add_f32 v81, v86, v87
  v_add_f32 v80, v80, v81
  v_mul_f32 v80, 0xbfb8aa3b, v80
  v_exp_f32 v80, v80
  s_nop 0
  v_add_f32 v80, 1.0, v80
  v_rcp_f32 v80, v80
  s_nop 0
  v_sub_f32 v82, 1.0, v80
  s_waitcnt vmcnt(14)
  v_lshlrev_b32 v160, 16, v96
  v_and_b32 v161, 0xffff0000, v96
  v_lshlrev_b32 v162, 16, v97
  v_and_b32 v163, 0xffff0000, v97
  v_lshlrev_b32 v164, 16, v98
  v_and_b32 v165, 0xffff0000, v98
  v_lshlrev_b32 v166, 16, v99
  v_and_b32 v167, 0xffff0000, v99
  v_lshlrev_b32 v168, 16, v100
  v_and_b32 v169, 0xffff0000, v100
  v_lshlrev_b32 v170, 16, v101
  v_and_b32 v171, 0xffff0000, v101
  v_lshlrev_b32 v172, 16, v102
  v_and_b32 v173, 0xffff0000, v102
  v_lshlrev_b32 v174, 16, v103
  v_and_b32 v175, 0xffff0000, v103
  s_waitcnt vmcnt(12)
  v_lshlrev_b32 v8, 16, v104
  v_and_b32 v9, 0xffff0000, v104
  v_pk_add_f32 v[160:161], v[160:161], v[8:9]
  v_lshlrev_b32 v10, 16, v105
  v_and_b32 v11, 0xffff0000, v105
  v_pk_add_f32 v[162:163], v[162:163], v[10:11]
  v_lshlrev_b32 v12, 16, v106
  v_and_b32 v13, 0xffff0000, v106
  v_pk_add_f32 v[164:165], v[164:165], v[12:13]
  v_lshlrev_b32 v14, 16, v107
  v_and_b32 v15, 0xffff0000, v107
  v_pk_add_f32 v[166:167], v[166:167], v[14:15]
  v_lshlrev_b32 v8, 16, v108
  v_and_b32 v9, 0xffff0000, v108
  v_pk_add_f32 v[168:169], v[168:169], v[8:9]
  v_lshlrev_b32 v10, 16, v109
  v_and_b32 v11, 0xffff0000, v109
  v_pk_add_f32 v[170:171], v[170:171], v[10:11]
  v_lshlrev_b32 v12, 16, v110
  v_and_b32 v13, 0xffff0000, v110
  v_pk_add_f32 v[172:173], v[172:173], v[12:13]
  v_lshlrev_b32 v14, 16, v111
  v_and_b32 v15, 0xffff0000, v111
  v_pk_add_f32 v[174:175], v[174:175], v[14:15]
  s_waitcnt vmcnt(10)
  v_lshlrev_b32 v8, 16, v112
  v_and_b32 v9, 0xffff0000, v112
  v_pk_add_f32 v[160:161], v[160:161], v[8:9]
  v_lshlrev_b32 v10, 16, v113
  v_and_b32 v11, 0xffff0000, v113
  v_pk_add_f32 v[162:163], v[162:163], v[10:11]
  v_lshlrev_b32 v12, 16, v114
  v_and_b32 v13, 0xffff0000, v114
  v_pk_add_f32 v[164:165], v[164:165], v[12:13]
  v_lshlrev_b32 v14, 16, v115
  v_and_b32 v15, 0xffff0000, v115
  v_pk_add_f32 v[166:167], v[166:167], v[14:15]
  v_lshlrev_b32 v8, 16, v116
  v_and_b32 v9, 0xffff0000, v116
  v_pk_add_f32 v[168:169], v[168:169], v[8:9]
  v_lshlrev_b32 v10, 16, v117
  v_and_b32 v11, 0xffff0000, v117
  v_pk_add_f32 v[170:171], v[170:171], v[10:11]
  v_lshlrev_b32 v12, 16, v118
  v_and_b32 v13, 0xffff0000, v118
  v_pk_add_f32 v[172:173], v[172:173], v[12:13]
  v_lshlrev_b32 v14, 16, v119
  v_and_b32 v15, 0xffff0000, v119
  v_pk_add_f32 v[174:175], v[174:175], v[14:15]
  s_waitcnt vmcnt(8)
  v_lshlrev_b32 v8, 16, v120
  v_and_b32 v9, 0xffff0000, v120
  v_pk_add_f32 v[160:161], v[160:161], v[8:9]
  v_lshlrev_b32 v10, 16, v121
  v_and_b32 v11, 0xffff0000, v121
  v_pk_add_f32 v[162:163], v[162:163], v[10:11]
  v_lshlrev_b32 v12, 16, v122
  v_and_b32 v13, 0xffff0000, v122
  v_pk_add_f32 v[164:165], v[164:165], v[12:13]
  v_lshlrev_b32 v14, 16, v123
  v_and_b32 v15, 0xffff0000, v123
  v_pk_add_f32 v[166:167], v[166:167], v[14:15]
  v_lshlrev_b32 v8, 16, v124
  v_and_b32 v9, 0xffff0000, v124
  v_pk_add_f32 v[168:169], v[168:169], v[8:9]
  v_lshlrev_b32 v10, 16, v125
  v_and_b32 v11, 0xffff0000, v125
  v_pk_add_f32 v[170:171], v[170:171], v[10:11]
  v_lshlrev_b32 v12, 16, v126
  v_and_b32 v13, 0xffff0000, v126
  v_pk_add_f32 v[172:173], v[172:173], v[12:13]
  v_lshlrev_b32 v14, 16, v127
  v_and_b32 v15, 0xffff0000, v127
  v_pk_add_f32 v[174:175], v[174:175], v[14:15]
  s_waitcnt vmcnt(6)
  v_lshlrev_b32 v8, 16, v128
  v_and_b32 v9, 0xffff0000, v128
  v_pk_add_f32 v[160:161], v[160:161], v[8:9]
  v_lshlrev_b32 v10, 16, v129
  v_and_b32 v11, 0xffff0000, v129
  v_pk_add_f32 v[162:163], v[162:163], v[10:11]
  v_lshlrev_b32 v12, 16, v130
  v_and_b32 v13, 0xffff0000, v130
  v_pk_add_f32 v[164:165], v[164:165], v[12:13]
  v_lshlrev_b32 v14, 16, v131
  v_and_b32 v15, 0xffff0000, v131
  v_pk_add_f32 v[166:167], v[166:167], v[14:15]
  v_lshlrev_b32 v8, 16, v132
  v_and_b32 v9, 0xffff0000, v132
  v_pk_add_f32 v[168:169], v[168:169], v[8:9]
  v_lshlrev_b32 v10, 16, v133
  v_and_b32 v11, 0xffff0000, v133
  v_pk_add_f32 v[170:171], v[170:171], v[10:11]
  v_lshlrev_b32 v12, 16, v134
  v_and_b32 v13, 0xffff0000, v134
  v_pk_add_f32 v[172:173], v[172:173], v[12:13]
  v_lshlrev_b32 v14, 16, v135
  v_and_b32 v15, 0xffff0000, v135
  v_pk_add_f32 v[174:175], v[174:175], v[14:15]
  s_waitcnt vmcnt(4)
  v_lshlrev_b32 v8, 16, v136
  v_and_b32 v9, 0xffff0000, v136
  v_pk_add_f32 v[160:161], v[160:161], v[8:9]
  v_lshlrev_b32 v10, 16, v137
  v_and_b32 v11, 0xffff0000, v137
  v_pk_add_f32 v[162:163], v[162:163], v[10:11]
  v_lshlrev_b32 v12, 16, v138
  v_and_b32 v13, 0xffff0000, v138
  v_pk_add_f32 v[164:165], v[164:165], v[12:13]
  v_lshlrev_b32 v14, 16, v139
  v_and_b32 v15, 0xffff0000, v139
  v_pk_add_f32 v[166:167], v[166:167], v[14:15]
  v_lshlrev_b32 v8, 16, v140
  v_and_b32 v9, 0xffff0000, v140
  v_pk_add_f32 v[168:169], v[168:169], v[8:9]
  v_lshlrev_b32 v10, 16, v141
  v_and_b32 v11, 0xffff0000, v141
  v_pk_add_f32 v[170:171], v[170:171], v[10:11]
  v_lshlrev_b32 v12, 16, v142
  v_and_b32 v13, 0xffff0000, v142
  v_pk_add_f32 v[172:173], v[172:173], v[12:13]
  v_lshlrev_b32 v14, 16, v143
  v_and_b32 v15, 0xffff0000, v143
  v_pk_add_f32 v[174:175], v[174:175], v[14:15]
  s_waitcnt vmcnt(2)
  v_lshlrev_b32 v8, 16, v144
  v_and_b32 v9, 0xffff0000, v144
  v_pk_add_f32 v[160:161], v[160:161], v[8:9]
  v_lshlrev_b32 v10, 16, v145
  v_and_b32 v11, 0xffff0000, v145
  v_pk_add_f32 v[162:163], v[162:163], v[10:11]
  v_lshlrev_b32 v12, 16, v146
  v_and_b32 v13, 0xffff0000, v146
  v_pk_add_f32 v[164:165], v[164:165], v[12:13]
  v_lshlrev_b32 v14, 16, v147
  v_and_b32 v15, 0xffff0000, v147
  v_pk_add_f32 v[166:167], v[166:167], v[14:15]
  v_lshlrev_b32 v8, 16, v148
  v_and_b32 v9, 0xffff0000, v148
  v_pk_add_f32 v[168:169], v[168:169], v[8:9]
  v_lshlrev_b32 v10, 16, v149
  v_and_b32 v11, 0xffff0000, v149
  v_pk_add_f32 v[170:171], v[170:171], v[10:11]
  v_lshlrev_b32 v12, 16, v150
  v_and_b32 v13, 0xffff0000, v150
  v_pk_add_f32 v[172:173], v[172:173], v[12:13]
  v_lshlrev_b32 v14, 16, v151
  v_and_b32 v15, 0xffff0000, v151
  v_pk_add_f32 v[174:175], v[174:175], v[14:15]
  s_waitcnt vmcnt(0)
  v_lshlrev_b32 v8, 16, v152
  v_and_b32 v9, 0xffff0000, v152
  v_pk_add_f32 v[160:161], v[160:161], v[8:9]
  v_lshlrev_b32 v10, 16, v153
  v_and_b32 v11, 0xffff0000, v153
  v_pk_add_f32 v[162:163], v[162:163], v[10:11]
  v_lshlrev_b32 v12, 16, v154
  v_and_b32 v13, 0xffff0000, v154
  v_pk_add_f32 v[164:165], v[164:165], v[12:13]
  v_lshlrev_b32 v14, 16, v155
  v_and_b32 v15, 0xffff0000, v155
  v_pk_add_f32 v[166:167], v[166:167], v[14:15]
  v_lshlrev_b32 v8, 16, v156
  v_and_b32 v9, 0xffff0000, v156
  v_pk_add_f32 v[168:169], v[168:169], v[8:9]
  v_lshlrev_b32 v10, 16, v157
  v_and_b32 v11, 0xffff0000, v157
  v_pk_add_f32 v[170:171], v[170:171], v[10:11]
  v_lshlrev_b32 v12, 16, v158
  v_and_b32 v13, 0xffff0000, v158
  v_pk_add_f32 v[172:173], v[172:173], v[12:13]
  v_lshlrev_b32 v14, 16, v159
  v_and_b32 v15, 0xffff0000, v159
  v_pk_add_f32 v[174:175], v[174:175], v[14:15]
  s_and_b32 s76, s48, 1
  s_lshl_b32 s76, s76, 1
  s_lshr_b32 s77, s49, 1
  s_add_u32 s76, s76, s77
  s_mul_i32 s76, s76, 7
  s_add_u32 s76, s76, 6
  s_lshr_b32 s77, s48, 1
  s_add_u32 s77, s77, 0x201
  v_mov_b32 v193, s77
  s_lshl_b32 s76, s76, 7
  s_add_u32 s76, s76, 148897792
  v_and_b32 v192, 7, v1
  v_mul_u32_u24 v192, 3584, v192
  v_add_u32 v192, s76, v192
  s_mov_b32 s71, 0
  s_branch M_vg_57
M_vw_56:
  s_sleep 2
  s_add_u32 s71, s71, 1
  s_cmp_gt_u32 s71, 262144
  s_cbranch_scc1 M_exit
M_vg_57:
  buffer_load_dword v194, v192, s[4:7], 0 offen sc1
  s_waitcnt vmcnt(0)
  v_cmp_lt_u32 vcc, v194, v193
  s_cbranch_vccnz M_vw_56
  s_add_u32 s29, s28, 167772160
  buffer_load_dwordx4 v[96:99], v2, s[4:7], s29 offen offset:0 sc1
  buffer_load_dwordx4 v[100:103], v2, s[4:7], s29 offen offset:1024 sc1
  s_add_u32 s29, s28, 169869312
  buffer_load_dwordx4 v[104:107], v2, s[4:7], s29 offen offset:0 sc1
  buffer_load_dwordx4 v[108:111], v2, s[4:7], s29 offen offset:1024 sc1
  s_add_u32 s29, s28, 171966464
  buffer_load_dwordx4 v[112:115], v2, s[4:7], s29 offen offset:0 sc1
  buffer_load_dwordx4 v[116:119], v2, s[4:7], s29 offen offset:1024 sc1
  s_add_u32 s29, s28, 174063616
  buffer_load_dwordx4 v[120:123], v2, s[4:7], s29 offen offset:0 sc1
  buffer_load_dwordx4 v[124:127], v2, s[4:7], s29 offen offset:1024 sc1
  s_add_u32 s29, s28, 176160768
  buffer_load_dwordx4 v[128:131], v2, s[4:7], s29 offen offset:0 sc1
  buffer_load_dwordx4 v[132:135], v2, s[4:7], s29 offen offset:1024 sc1
  s_add_u32 s29, s28, 178257920
  buffer_load_dwordx4 v[136:139], v2, s[4:7], s29 offen offset:0 sc1
  buffer_load_dwordx4 v[140:143], v2, s[4:7], s29 offen offset:1024 sc1
  s_add_u32 s29, s28, 180355072
  buffer_load_dwordx4 v[144:147], v2, s[4:7], s29 offen offset:0 sc1
  buffer_load_dwordx4 v[148:151], v2, s[4:7], s29 offen offset:1024 sc1
  s_add_u32 s29, s28, 182452224
  buffer_load_dwordx4 v[152:155], v2, s[4:7], s29 offen offset:0 sc1
  buffer_load_dwordx4 v[156:159], v2, s[4:7], s29 offen offset:1024 sc1
  v_pk_mul_f32 v[160:161], v[160:161], v[80:81] op_sel_hi:[1,0]
  v_pk_mul_f32 v[162:163], v[162:163], v[80:81] op_sel_hi:[1,0]
  v_pk_mul_f32 v[164:165], v[164:165], v[80:81] op_sel_hi:[1,0]
  v_pk_mul_f32 v[166:167], v[166:167], v[80:81] op_sel_hi:[1,0]
  v_pk_mul_f32 v[168:169], v[168:169], v[80:81] op_sel_hi:[1,0]
  v_pk_mul_f32 v[170:171], v[170:171], v[80:81] op_sel_hi:[1,0]
  v_pk_mul_f32 v[172:173], v[172:173], v[80:81] op_sel_hi:[1,0]
  v_pk_mul_f32 v[174:175], v[174:175], v[80:81] op_sel_hi:[1,0]
  s_waitcnt vmcnt(14)
  v_lshlrev_b32 v176, 16, v96
  v_and_b32 v177, 0xffff0000, v96
  v_lshlrev_b32 v178, 16, v97
  v_and_b32 v179, 0xffff0000, v97
  v_lshlrev_b32 v180, 16, v98
  v_and_b32 v181, 0xffff0000, v98
  v_lshlrev_b32 v182, 16, v99
  v_and_b32 v183, 0xffff0000, v99
  v_lshlrev_b32 v184, 16, v100
  v_and_b32 v185, 0xffff0000, v100
  v_lshlrev_b32 v186, 16, v101
  v_and_b32 v187, 0xffff0000, v101
  v_lshlrev_b32 v188, 16, v102
  v_and_b32 v189, 0xffff0000, v102
  v_lshlrev_b32 v190, 16, v103
  v_and_b32 v191, 0xffff0000, v103
  s_waitcnt vmcnt(12)
  v_lshlrev_b32 v8, 16, v104
  v_and_b32 v9, 0xffff0000, v104
  v_pk_add_f32 v[176:177], v[176:177], v[8:9]
  v_lshlrev_b32 v10, 16, v105
  v_and_b32 v11, 0xffff0000, v105
  v_pk_add_f32 v[178:179], v[178:179], v[10:11]
  v_lshlrev_b32 v12, 16, v106
  v_and_b32 v13, 0xffff0000, v106
  v_pk_add_f32 v[180:181], v[180:181], v[12:13]
  v_lshlrev_b32 v14, 16, v107
  v_and_b32 v15, 0xffff0000, v107
  v_pk_add_f32 v[182:183], v[182:183], v[14:15]
  v_lshlrev_b32 v8, 16, v108
  v_and_b32 v9, 0xffff0000, v108
  v_pk_add_f32 v[184:185], v[184:185], v[8:9]
  v_lshlrev_b32 v10, 16, v109
  v_and_b32 v11, 0xffff0000, v109
  v_pk_add_f32 v[186:187], v[186:187], v[10:11]
  v_lshlrev_b32 v12, 16, v110
  v_and_b32 v13, 0xffff0000, v110
  v_pk_add_f32 v[188:189], v[188:189], v[12:13]
  v_lshlrev_b32 v14, 16, v111
  v_and_b32 v15, 0xffff0000, v111
  v_pk_add_f32 v[190:191], v[190:191], v[14:15]
  s_waitcnt vmcnt(10)
  v_lshlrev_b32 v8, 16, v112
  v_and_b32 v9, 0xffff0000, v112
  v_pk_add_f32 v[176:177], v[176:177], v[8:9]
  v_lshlrev_b32 v10, 16, v113
  v_and_b32 v11, 0xffff0000, v113
  v_pk_add_f32 v[178:179], v[178:179], v[10:11]
  v_lshlrev_b32 v12, 16, v114
  v_and_b32 v13, 0xffff0000, v114
  v_pk_add_f32 v[180:181], v[180:181], v[12:13]
  v_lshlrev_b32 v14, 16, v115
  v_and_b32 v15, 0xffff0000, v115
  v_pk_add_f32 v[182:183], v[182:183], v[14:15]
  v_lshlrev_b32 v8, 16, v116
  v_and_b32 v9, 0xffff0000, v116
  v_pk_add_f32 v[184:185], v[184:185], v[8:9]
  v_lshlrev_b32 v10, 16, v117
  v_and_b32 v11, 0xffff0000, v117
  v_pk_add_f32 v[186:187], v[186:187], v[10:11]
  v_lshlrev_b32 v12, 16, v118
  v_and_b32 v13, 0xffff0000, v118
  v_pk_add_f32 v[188:189], v[188:189], v[12:13]
  v_lshlrev_b32 v14, 16, v119
  v_and_b32 v15, 0xffff0000, v119
  v_pk_add_f32 v[190:191], v[190:191], v[14:15]
  s_waitcnt vmcnt(8)
  v_lshlrev_b32 v8, 16, v120
  v_and_b32 v9, 0xffff0000, v120
  v_pk_add_f32 v[176:177], v[176:177], v[8:9]
  v_lshlrev_b32 v10, 16, v121
  v_and_b32 v11, 0xffff0000, v121
  v_pk_add_f32 v[178:179], v[178:179], v[10:11]
  v_lshlrev_b32 v12, 16, v122
  v_and_b32 v13, 0xffff0000, v122
  v_pk_add_f32 v[180:181], v[180:181], v[12:13]
  v_lshlrev_b32 v14, 16, v123
  v_and_b32 v15, 0xffff0000, v123
  v_pk_add_f32 v[182:183], v[182:183], v[14:15]
  v_lshlrev_b32 v8, 16, v124
  v_and_b32 v9, 0xffff0000, v124
  v_pk_add_f32 v[184:185], v[184:185], v[8:9]
  v_lshlrev_b32 v10, 16, v125
  v_and_b32 v11, 0xffff0000, v125
  v_pk_add_f32 v[186:187], v[186:187], v[10:11]
  v_lshlrev_b32 v12, 16, v126
  v_and_b32 v13, 0xffff0000, v126
  v_pk_add_f32 v[188:189], v[188:189], v[12:13]
  v_lshlrev_b32 v14, 16, v127
  v_and_b32 v15, 0xffff0000, v127
  v_pk_add_f32 v[190:191], v[190:191], v[14:15]
  s_waitcnt vmcnt(6)
  v_lshlrev_b32 v8, 16, v128
  v_and_b32 v9, 0xffff0000, v128
  v_pk_add_f32 v[176:177], v[176:177], v[8:9]
  v_lshlrev_b32 v10, 16, v129
  v_and_b32 v11, 0xffff0000, v129
  v_pk_add_f32 v[178:179], v[178:179], v[10:11]
  v_lshlrev_b32 v12, 16, v130
  v_and_b32 v13, 0xffff0000, v130
  v_pk_add_f32 v[180:181], v[180:181], v[12:13]
  v_lshlrev_b32 v14, 16, v131
  v_and_b32 v15, 0xffff0000, v131
  v_pk_add_f32 v[182:183], v[182:183], v[14:15]
  v_lshlrev_b32 v8, 16, v132
  v_and_b32 v9, 0xffff0000, v132
  v_pk_add_f32 v[184:185], v[184:185], v[8:9]
  v_lshlrev_b32 v10, 16, v133
  v_and_b32 v11, 0xffff0000, v133
  v_pk_add_f32 v[186:187], v[186:187], v[10:11]
  v_lshlrev_b32 v12, 16, v134
  v_and_b32 v13, 0xffff0000, v134
  v_pk_add_f32 v[188:189], v[188:189], v[12:13]
  v_lshlrev_b32 v14, 16, v135
  v_and_b32 v15, 0xffff0000, v135
  v_pk_add_f32 v[190:191], v[190:191], v[14:15]
  s_waitcnt vmcnt(4)
  v_lshlrev_b32 v8, 16, v136
  v_and_b32 v9, 0xffff0000, v136
  v_pk_add_f32 v[176:177], v[176:177], v[8:9]
  v_lshlrev_b32 v10, 16, v137
  v_and_b32 v11, 0xffff0000, v137
  v_pk_add_f32 v[178:179], v[178:179], v[10:11]
  v_lshlrev_b32 v12, 16, v138
  v_and_b32 v13, 0xffff0000, v138
  v_pk_add_f32 v[180:181], v[180:181], v[12:13]
  v_lshlrev_b32 v14, 16, v139
  v_and_b32 v15, 0xffff0000, v139
  v_pk_add_f32 v[182:183], v[182:183], v[14:15]
  v_lshlrev_b32 v8, 16, v140
  v_and_b32 v9, 0xffff0000, v140
  v_pk_add_f32 v[184:185], v[184:185], v[8:9]
  v_lshlrev_b32 v10, 16, v141
  v_and_b32 v11, 0xffff0000, v141
  v_pk_add_f32 v[186:187], v[186:187], v[10:11]
  v_lshlrev_b32 v12, 16, v142
  v_and_b32 v13, 0xffff0000, v142
  v_pk_add_f32 v[188:189], v[188:189], v[12:13]
  v_lshlrev_b32 v14, 16, v143
  v_and_b32 v15, 0xffff0000, v143
  v_pk_add_f32 v[190:191], v[190:191], v[14:15]
  s_waitcnt vmcnt(2)
  v_lshlrev_b32 v8, 16, v144
  v_and_b32 v9, 0xffff0000, v144
  v_pk_add_f32 v[176:177], v[176:177], v[8:9]
  v_lshlrev_b32 v10, 16, v145
  v_and_b32 v11, 0xffff0000, v145
  v_pk_add_f32 v[178:179], v[178:179], v[10:11]
  v_lshlrev_b32 v12, 16, v146
  v_and_b32 v13, 0xffff0000, v146
  v_pk_add_f32 v[180:181], v[180:181], v[12:13]
  v_lshlrev_b32 v14, 16, v147
  v_and_b32 v15, 0xffff0000, v147
  v_pk_add_f32 v[182:183], v[182:183], v[14:15]
  v_lshlrev_b32 v8, 16, v148
  v_and_b32 v9, 0xffff0000, v148
  v_pk_add_f32 v[184:185], v[184:185], v[8:9]
  v_lshlrev_b32 v10, 16, v149
  v_and_b32 v11, 0xffff0000, v149
  v_pk_add_f32 v[186:187], v[186:187], v[10:11]
  v_lshlrev_b32 v12, 16, v150
  v_and_b32 v13, 0xffff0000, v150
  v_pk_add_f32 v[188:189], v[188:189], v[12:13]
  v_lshlrev_b32 v14, 16, v151
  v_and_b32 v15, 0xffff0000, v151
  v_pk_add_f32 v[190:191], v[190:191], v[14:15]
  s_waitcnt vmcnt(0)
  v_lshlrev_b32 v8, 16, v152
  v_and_b32 v9, 0xffff0000, v152
  v_pk_add_f32 v[176:177], v[176:177], v[8:9]
  v_lshlrev_b32 v10, 16, v153
  v_and_b32 v11, 0xffff0000, v153
  v_pk_add_f32 v[178:179], v[178:179], v[10:11]
  v_lshlrev_b32 v12, 16, v154
  v_and_b32 v13, 0xffff0000, v154
  v_pk_add_f32 v[180:181], v[180:181], v[12:13]
  v_lshlrev_b32 v14, 16, v155
  v_and_b32 v15, 0xffff0000, v155
  v_pk_add_f32 v[182:183], v[182:183], v[14:15]
  v_lshlrev_b32 v8, 16, v156
  v_and_b32 v9, 0xffff0000, v156
  v_pk_add_f32 v[184:185], v[184:185], v[8:9]
  v_lshlrev_b32 v10, 16, v157
  v_and_b32 v11, 0xffff0000, v157
  v_pk_add_f32 v[186:187], v[186:187], v[10:11]
  v_lshlrev_b32 v12, 16, v158
  v_and_b32 v13, 0xffff0000, v158
  v_pk_add_f32 v[188:189], v[188:189], v[12:13]
  v_lshlrev_b32 v14, 16, v159
  v_and_b32 v15, 0xffff0000, v159
  v_pk_add_f32 v[190:191], v[190:191], v[14:15]
  v_pk_fma_f32 v[160:161], v[176:177], v[82:83], v[160:161] op_sel_hi:[1,0,1]
  v_cvt_pk_bf16_f32 v16, v160, v161
  v_pk_fma_f32 v[162:163], v[178:179], v[82:83], v[162:163] op_sel_hi:[1,0,1]
  v_cvt_pk_bf16_f32 v17, v162, v163
  v_pk_fma_f32 v[164:165], v[180:181], v[82:83], v[164:165] op_sel_hi:[1,0,1]
  v_cvt_pk_bf16_f32 v18, v164, v165
  v_pk_fma_f32 v[166:167], v[182:183], v[82:83], v[166:167] op_sel_hi:[1,0,1]
  v_cvt_pk_bf16_f32 v19, v166, v167
  v_pk_fma_f32 v[168:169], v[184:185], v[82:83], v[168:169] op_sel_hi:[1,0,1]
  v_cvt_pk_bf16_f32 v20, v168, v169
  v_pk_fma_f32 v[170:171], v[186:187], v[82:83], v[170:171] op_sel_hi:[1,0,1]
  v_cvt_pk_bf16_f32 v21, v170, v171
  v_pk_fma_f32 v[172:173], v[188:189], v[82:83], v[172:173] op_sel_hi:[1,0,1]
  v_cvt_pk_bf16_f32 v22, v172, v173
  v_pk_fma_f32 v[174:175], v[190:191], v[82:83], v[174:175] op_sel_hi:[1,0,1]
  v_cvt_pk_bf16_f32 v23, v174, v175
  s_lshl_b32 s26, s49, 2
  s_add_u32 s26, s26, s16
  s_lshl_b32 s26, s26, 6
  s_lshl_b32 s27, s48, 15
  s_add_u32 s26, s26, s27
  buffer_store_dwordx4 v[16:19], v6, s[32:35], s26 offen offset:0
  buffer_store_dwordx4 v[20:23], v6, s[32:35], s26 offen offset:32
  s_cmp_lt_u32 s50, 64
  s_mov_b32 s50, s51
  s_cbranch_scc1 M_fin
  s_branch M_done
M_follow:
  s_lshr_b32 s48, s64, 2
  s_and_b32 s49, s64, 1
  s_bfe_u32 s50, s64, 0x10001
  s_mov_b32 s51, 2
  s_mov_b32 s23, 32
  s_load_dwordx2 s[8:9], s[0:1], 88
  s_lshl_b32 s17, s48, 19
  s_lshl_b32 s26, s49, 2
  s_add_u32 s26, s26, s16
  s_lshl_b32 s27, s26, 7
  s_add_u32 s17, s17, s27
  s_mov_b32 s18, 1024
  s_lshl_b32 s21, s48, 6
  s_add_u32 s21, s21, s50
  s_lshl_b32 s21, s21, 3
  s_add_u32 s21, s21, s26
  s_lshl_b32 s21, s21, 12
  s_add_u32 s21, s21, 167772160
  s_lshl_b32 s22, s51, 15
  s_mov_b32 s24, 1.0
  s_waitcnt lgkmcnt(0)
  s_and_b32 s9, s9, 0xffff
  s_mov_b32 s10, 4194304
  s_mov_b32 s11, 0x20000
  v_lshrrev_b32 v144, 4, v1
  v_and_b32 v56, 0xff, v2
  v_lshl_add_u32 v56, v144, 9, v56
  s_mul_i32 s26, s16, 0
  v_add_u32 v8, 0, v56
  v_add_u32 v16, 0, v2
  v_add_u32 v16, s26, v16
  v_add_u32 v9, 256, v56
  v_add_u32 v17, 1024, v2
  v_add_u32 v17, s26, v17
  v_add_u32 v10, 2048, v56
  v_add_u32 v18, 2048, v2
  v_add_u32 v18, s26, v18
  v_add_u32 v11, 2304, v56
  v_add_u32 v19, 3072, v2
  v_add_u32 v19, s26, v19
  v_add_u32 v12, 4096, v56
  v_add_u32 v20, 4096, v2
  v_add_u32 v20, s26, v20
  v_add_u32 v13, 4352, v56
  v_add_u32 v21, 5120, v2
  v_add_u32 v21, s26, v21
  v_add_u32 v14, 6144, v56
  v_add_u32 v22, 6144, v2
  v_add_u32 v22, s26, v22
  v_add_u32 v15, 6400, v56
  v_add_u32 v23, 7168, v2
  v_add_u32 v23, s26, v23
  v_mov_b32 v20, v56
  v_lshrrev_b32 v144, 3, v1
  v_mul_lo_u32 v144, v144, s18
  v_and_b32 v145, 7, v1
  v_lshl_add_u32 v144, v145, 4, v144
  s_lshl_b32 s28, s16, 15
  s_add_u32 s28, s28, 32768
  s_lshl_b32 s29, s18, 3
  s_add_u32 m0, s28, 0
  s_nop 0
  buffer_load_dwordx4 v144, s[8:11], s17 offen lds
  s_add_u32 s17, s17, s29
  s_add_u32 m0, s28, 1024
  s_nop 0
  buffer_load_dwordx4 v144, s[8:11], s17 offen lds
  s_add_u32 s17, s17, s29
  s_add_u32 m0, s28, 2048
  s_nop 0
  buffer_load_dwordx4 v144, s[8:11], s17 offen lds
  s_add_u32 s17, s17, s29
  s_add_u32 m0, s28, 3072
  s_nop 0
  buffer_load_dwordx4 v144, s[8:11], s17 offen lds
  s_add_u32 s17, s17, s29
  s_add_u32 m0, s28, 4096
  s_nop 0
  buffer_load_dwordx4 v144, s[8:11], s17 offen lds
  s_add_u32 s17, s17, s29
  s_add_u32 m0, s28, 5120
  s_nop 0
  buffer_load_dwordx4 v144, s[8:11], s17 offen lds
  s_add_u32 s17, s17, s29
  s_add_u32 m0, s28, 6144
  s_nop 0
  buffer_load_dwordx4 v144, s[8:11], s17 offen lds
  s_add_u32 s17, s17, s29
  s_add_u32 m0, s28, 7168
  s_nop 0
  buffer_load_dwordx4 v144, s[8:11], s17 offen lds
  s_add_u32 s17, s17, s29
  s_add_u32 m0, s28, 8192
  s_nop 0
  buffer_load_dwordx4 v144, s[8:11], s17 offen lds
  s_add_u32 s17, s17, s29
  s_add_u32 m0, s28, 9216
  s_nop 0
  buffer_load_dwordx4 v144, s[8:11], s17 offen lds
  s_add_u32 s17, s17, s29
  s_add_u32 m0, s28, 10240
  s_nop 0
  buffer_load_dwordx4 v144, s[8:11], s17 offen lds
  s_add_u32 s17, s17, s29
  s_add_u32 m0, s28, 11264
  s_nop 0
  buffer_load_dwordx4 v144, s[8:11], s17 offen lds
  s_add_u32 s17, s17, s29
  s_add_u32 m0, s28, 12288
  s_nop 0
  buffer_load_dwordx4 v144, s[8:11], s17 offen lds
  s_add_u32 s17, s17, s29
  s_add_u32 m0, s28, 13312
  s_nop 0
  buffer_load_dwordx4 v144, s[8:11], s17 offen lds
  s_add_u32 s17, s17, s29
  s_add_u32 m0, s28, 14336
  s_nop 0
  buffer_load_dwordx4 v144, s[8:11], s17 offen lds
  s_add_u32 s17, s17, s29
  s_add_u32 m0, s28, 15360
  s_nop 0
  buffer_load_dwordx4 v144, s[8:11], s17 offen lds
  s_add_u32 s17, s17, s29
  s_add_u32 m0, s28, 16384
  s_nop 0
  buffer_load_dwordx4 v144, s[8:11], s17 offen lds
  s_add_u32 s17, s17, s29
  s_add_u32 m0, s28, 17408
  s_nop 0
  buffer_load_dwordx4 v144, s[8:11], s17 offen lds
  s_add_u32 s17, s17, s29
  s_add_u32 m0, s28, 18432
  s_nop 0
  buffer_load_dwordx4 v144, s[8:11], s17 offen lds
  s_add_u32 s17, s17, s29
  s_add_u32 m0, s28, 19456
  s_nop 0
  buffer_load_dwordx4 v144, s[8:11], s17 offen lds
  s_add_u32 s17, s17, s29
  s_add_u32 m0, s28, 20480
  s_nop 0
  buffer_load_dwordx4 v144, s[8:11], s17 offen lds
  s_add_u32 s17, s17, s29
  s_add_u32 m0, s28, 21504
  s_nop 0
  buffer_load_dwordx4 v144, s[8:11], s17 offen lds
  s_add_u32 s17, s17, s29
  s_add_u32 m0, s28, 22528
  s_nop 0
  buffer_load_dwordx4 v144, s[8:11], s17 offen lds
  s_add_u32 s17, s17, s29
  s_add_u32 m0, s28, 23552
  s_nop 0
  buffer_load_dwordx4 v144, s[8:11], s17 offen lds
  s_add_u32 s17, s17, s29
  s_add_u32 m0, s28, 24576
  s_nop 0
  buffer_load_dwordx4 v144, s[8:11], s17 offen lds
  s_add_u32 s17, s17, s29
  s_add_u32 m0, s28, 25600
  s_nop 0
  buffer_load_dwordx4 v144, s[8:11], s17 offen lds
  s_add_u32 s17, s17, s29
  s_add_u32 m0, s28, 26624
  s_nop 0
  buffer_load_dwordx4 v144, s[8:11], s17 offen lds
  s_add_u32 s17, s17, s29
  s_add_u32 m0, s28, 27648
  s_nop 0
  buffer_load_dwordx4 v144, s[8:11], s17 offen lds
  s_add_u32 s17, s17, s29
  s_add_u32 m0, s28, 28672
  s_nop 0
  buffer_load_dwordx4 v144, s[8:11], s17 offen lds
  s_add_u32 s17, s17, s29
  s_add_u32 m0, s28, 29696
  s_nop 0
  buffer_load_dwordx4 v144, s[8:11], s17 offen lds
  s_add_u32 s17, s17, s29
  s_add_u32 m0, s28, 30720
  s_nop 0
  buffer_load_dwordx4 v144, s[8:11], s17 offen lds
  s_add_u32 s17, s17, s29
  s_add_u32 m0, s28, 31744
  s_nop 0
  buffer_load_dwordx4 v144, s[8:11], s17 offen lds
  s_add_u32 s17, s17, s29
  v_bfe_u32 v148, v1, 2, 2
  v_lshrrev_b32 v149, 5, v1
  v_lshl_add_u32 v148, v149, 4, v148
  v_bfe_u32 v149, v1, 4, 1
  v_lshl_add_u32 v148, v149, 2, v148
  v_and_b32 v149, 3, v1
  v_lshlrev_b32 v149, 4, v149
  s_mov_b32 s26, 8
  v_lshl_add_u32 v148, v148, 7, v149
  v_add_u32 v152, s28, v148
  v_add_u32 v153, 1024, v152
  v_add_u32 v154, s26, v152
  v_add_u32 v155, s26, v153
  s_waitcnt vmcnt(28)
  ds_read_b64_tr_b16 a[0:1], v152 offset:0
  ds_read_b64_tr_b16 a[2:3], v153 offset:0
  ds_read_b64_tr_b16 a[4:5], v154 offset:0
  ds_read_b64_tr_b16 a[6:7], v155 offset:0
  ds_read_b64_tr_b16 a[8:9], v152 offset:64
  ds_read_b64_tr_b16 a[10:11], v153 offset:64
  ds_read_b64_tr_b16 a[12:13], v154 offset:64
  ds_read_b64_tr_b16 a[14:15], v155 offset:64
  s_waitcnt lgkmcnt(0)
  s_add_u32 m0, s28, 0
  s_nop 0
  buffer_load_dwordx4 v144, s[8:11], s17 offen lds
  s_add_u32 s17, s17, s29
  s_add_u32 m0, s28, 1024
  s_nop 0
  buffer_load_dwordx4 v144, s[8:11], s17 offen lds
  s_add_u32 s17, s17, s29
  s_add_u32 m0, s28, 2048
  s_nop 0
  buffer_load_dwordx4 v144, s[8:11], s17 offen lds
  s_add_u32 s17, s17, s29
  s_add_u32 m0, s28, 3072
  s_nop 0
  buffer_load_dwordx4 v144, s[8:11], s17 offen lds
  s_add_u32 s17, s17, s29
  s_waitcnt vmcnt(28)
  ds_read_b64_tr_b16 a[16:17], v152 offset:4096
  ds_read_b64_tr_b16 a[18:19], v153 offset:4096
  ds_read_b64_tr_b16 a[20:21], v154 offset:4096
  ds_read_b64_tr_b16 a[22:23], v155 offset:4096
  ds_read_b64_tr_b16 a[24:25], v152 offset:4160
  ds_read_b64_tr_b16 a[26:27], v153 offset:4160
  ds_read_b64_tr_b16 a[28:29], v154 offset:4160
  ds_read_b64_tr_b16 a[30:31], v155 offset:4160
  s_waitcnt lgkmcnt(0)
  s_add_u32 m0, s28, 4096
  s_nop 0
  buffer_load_dwordx4 v144, s[8:11], s17 offen lds
  s_add_u32 s17, s17, s29
  s_add_u32 m0, s28, 5120
  s_nop 0
  buffer_load_dwordx4 v144, s[8:11], s17 offen lds
  s_add_u32 s17, s17, s29
  s_add_u32 m0, s28, 6144
  s_nop 0
  buffer_load_dwordx4 v144, s[8:11], s17 offen lds
  s_add_u32 s17, s17, s29
  s_add_u32 m0, s28, 7168
  s_nop 0
  buffer_load_dwordx4 v144, s[8:11], s17 offen lds
  s_add_u32 s17, s17, s29
  s_waitcnt vmcnt(28)
  ds_read_b64_tr_b16 a[32:33], v152 offset:8192
  ds_read_b64_tr_b16 a[34:35], v153 offset:8192
  ds_read_b64_tr_b16 a[36:37], v154 offset:8192
  ds_read_b64_tr_b16 a[38:39], v155 offset:8192
  ds_read_b64_tr_b16 a[40:41], v152 offset:8256
  ds_read_b64_tr_b16 a[42:43], v153 offset:8256
  ds_read_b64_tr_b16 a[44:45], v154 offset:8256
  ds_read_b64_tr_b16 a[46:47], v155 offset:8256
  s_waitcnt lgkmcnt(0)
  s_add_u32 m0, s28, 8192
  s_nop 0
  buffer_load_dwordx4 v144, s[8:11], s17 offen lds
  s_add_u32 s17, s17, s29
  s_add_u32 m0, s28, 9216
  s_nop 0
  buffer_load_dwordx4 v144, s[8:11], s17 offen lds
  s_add_u32 s17, s17, s29
  s_add_u32 m0, s28, 10240
  s_nop 0
  buffer_load_dwordx4 v144, s[8:11], s17 offen lds
  s_add_u32 s17, s17, s29
  s_add_u32 m0, s28, 11264
  s_nop 0
  buffer_load_dwordx4 v144, s[8:11], s17 offen lds
  s_add_u32 s17, s17, s29
  s_waitcnt vmcnt(28)
  ds_read_b64_tr_b16 a[48:49], v152 offset:12288
  ds_read_b64_tr_b16 a[50:51], v153 offset:12288
  ds_read_b64_tr_b16 a[52:53], v154 offset:12288
  ds_read_b64_tr_b16 a[54:55], v155 offset:12288
  ds_read_b64_tr_b16 a[56:57], v152 offset:12352
  ds_read_b64_tr_b16 a[58:59], v153 offset:12352
  ds_read_b64_tr_b16 a[60:61], v154 offset:12352
  ds_read_b64_tr_b16 a[62:63], v155 offset:12352
  s_waitcnt lgkmcnt(0)
  s_add_u32 m0, s28, 12288
  s_nop 0
  buffer_load_dwordx4 v144, s[8:11], s17 offen lds
  s_add_u32 s17, s17, s29
  s_add_u32 m0, s28, 13312
  s_nop 0
  buffer_load_dwordx4 v144, s[8:11], s17 offen lds
  s_add_u32 s17, s17, s29
  s_add_u32 m0, s28, 14336
  s_nop 0
  buffer_load_dwordx4 v144, s[8:11], s17 offen lds
  s_add_u32 s17, s17, s29
  s_add_u32 m0, s28, 15360
  s_nop 0
  buffer_load_dwordx4 v144, s[8:11], s17 offen lds
  s_add_u32 s17, s17, s29
  s_waitcnt vmcnt(28)
  ds_read_b64_tr_b16 a[64:65], v152 offset:16384
  ds_read_b64_tr_b16 a[66:67], v153 offset:16384
  ds_read_b64_tr_b16 a[68:69], v154 offset:16384
  ds_read_b64_tr_b16 a[70:71], v155 offset:16384
  ds_read_b64_tr_b16 a[72:73], v152 offset:16448
  ds_read_b64_tr_b16 a[74:75], v153 offset:16448
  ds_read_b64_tr_b16 a[76:77], v154 offset:16448
  ds_read_b64_tr_b16 a[78:79], v155 offset:16448
  s_waitcnt lgkmcnt(0)
  s_add_u32 m0, s28, 16384
  s_nop 0
  buffer_load_dwordx4 v144, s[8:11], s17 offen lds
  s_add_u32 s17, s17, s29
  s_add_u32 m0, s28, 17408
  s_nop 0
  buffer_load_dwordx4 v144, s[8:11], s17 offen lds
  s_add_u32 s17, s17, s29
  s_add_u32 m0, s28, 18432
  s_nop 0
  buffer_load_dwordx4 v144, s[8:11], s17 offen lds
  s_add_u32 s17, s17, s29
  s_add_u32 m0, s28, 19456
  s_nop 0
  buffer_load_dwordx4 v144, s[8:11], s17 offen lds
  s_add_u32 s17, s17, s29
  s_waitcnt vmcnt(28)
  ds_read_b64_tr_b16 a[80:81], v152 offset:20480
  ds_read_b64_tr_b16 a[82:83], v153 offset:20480
  ds_read_b64_tr_b16 a[84:85], v154 offset:20480
  ds_read_b64_tr_b16 a[86:87], v155 offset:20480
  ds_read_b64_tr_b16 a[88:89], v152 offset:20544
  ds_read_b64_tr_b16 a[90:91], v153 offset:20544
  ds_read_b64_tr_b16 a[92:93], v154 offset:20544
  ds_read_b64_tr_b16 a[94:95], v155 offset:20544
  s_waitcnt lgkmcnt(0)
  s_add_u32 m0, s28, 20480
  s_nop 0
  buffer_load_dwordx4 v144, s[8:11], s17 offen lds
  s_add_u32 s17, s17, s29
  s_add_u32 m0, s28, 21504
  s_nop 0
  buffer_load_dwordx4 v144, s[8:11], s17 offen lds
  s_add_u32 s17, s17, s29
  s_add_u32 m0, s28, 22528
  s_nop 0
  buffer_load_dwordx4 v144, s[8:11], s17 offen lds
  s_add_u32 s17, s17, s29
  s_add_u32 m0, s28, 23552
  s_nop 0
  buffer_load_dwordx4 v144, s[8:11], s17 offen lds
  s_add_u32 s17, s17, s29
  s_waitcnt vmcnt(28)
  ds_read_b64_tr_b16 a[96:97], v152 offset:24576
  ds_read_b64_tr_b16 a[98:99], v153 offset:24576
  ds_read_b64_tr_b16 a[100:101], v154 offset:24576
  ds_read_b64_tr_b16 a[102:103], v155 offset:24576
  ds_read_b64_tr_b16 a[104:105], v152 offset:24640
  ds_read_b64_tr_b16 a[106:107], v153 offset:24640
  ds_read_b64_tr_b16 a[108:109], v154 offset:24640
  ds_read_b64_tr_b16 a[110:111], v155 offset:24640
  s_waitcnt lgkmcnt(0)
  s_add_u32 m0, s28, 24576
  s_nop 0
  buffer_load_dwordx4 v144, s[8:11], s17 offen lds
  s_add_u32 s17, s17, s29
  s_add_u32 m0, s28, 25600
  s_nop 0
  buffer_load_dwordx4 v144, s[8:11], s17 offen lds
  s_add_u32 s17, s17, s29
  s_add_u32 m0, s28, 26624
  s_nop 0
  buffer_load_dwordx4 v144, s[8:11], s17 offen lds
  s_add_u32 s17, s17, s29
  s_add_u32 m0, s28, 27648
  s_nop 0
  buffer_load_dwordx4 v144, s[8:11], s17 offen lds
  s_add_u32 s17, s17, s29
  s_waitcnt vmcnt(28)
  ds_read_b64_tr_b16 a[112:113], v152 offset:28672
  ds_read_b64_tr_b16 a[114:115], v153 offset:28672
  ds_read_b64_tr_b16 a[116:117], v154 offset:28672
  ds_read_b64_tr_b16 a[118:119], v155 offset:28672
  ds_read_b64_tr_b16 a[120:121], v152 offset:28736
  ds_read_b64_tr_b16 a[122:123], v153 offset:28736
  ds_read_b64_tr_b16 a[124:125], v154 offset:28736
  ds_read_b64_tr_b16 a[126:127], v155 offset:28736
  s_waitcnt lgkmcnt(0)
  s_add_u32 m0, s28, 28672
  s_nop 0
  buffer_load_dwordx4 v144, s[8:11], s17 offen lds
  s_add_u32 s17, s17, s29
  s_add_u32 m0, s28, 29696
  s_nop 0
  buffer_load_dwordx4 v144, s[8:11], s17 offen lds
  s_add_u32 s17, s17, s29
  s_add_u32 m0, s28, 30720
  s_nop 0
  buffer_load_dwordx4 v144, s[8:11], s17 offen lds
  s_add_u32 s17, s17, s29
  s_add_u32 m0, s28, 31744
  s_nop 0
  buffer_load_dwordx4 v144, s[8:11], s17 offen lds
  s_add_u32 s17, s17, s29
  s_waitcnt vmcnt(28)
  ds_read_b64_tr_b16 a[128:129], v152 offset:0
  ds_read_b64_tr_b16 a[130:131], v153 offset:0
  ds_read_b64_tr_b16 a[132:133], v154 offset:0
  ds_read_b64_tr_b16 a[134:135], v155 offset:0
  ds_read_b64_tr_b16 a[136:137], v152 offset:64
  ds_read_b64_tr_b16 a[138:139], v153 offset:64
  ds_read_b64_tr_b16 a[140:141], v154 offset:64
  ds_read_b64_tr_b16 a[142:143], v155 offset:64
  s_waitcnt lgkmcnt(0)
  s_waitcnt vmcnt(24)
  ds_read_b64_tr_b16 a[144:145], v152 offset:4096
  ds_read_b64_tr_b16 a[146:147], v153 offset:4096
  ds_read_b64_tr_b16 a[148:149], v154 offset:4096
  ds_read_b64_tr_b16 a[150:151], v155 offset:4096
  ds_read_b64_tr_b16 a[152:153], v152 offset:4160
  ds_read_b64_tr_b16 a[154:155], v153 offset:4160
  ds_read_b64_tr_b16 a[156:157], v154 offset:4160
  ds_read_b64_tr_b16 a[158:159], v155 offset:4160
  s_waitcnt lgkmcnt(0)
  s_waitcnt vmcnt(20)
  ds_read_b64_tr_b16 a[160:161], v152 offset:8192
  ds_read_b64_tr_b16 a[162:163], v153 offset:8192
  ds_read_b64_tr_b16 a[164:165], v154 offset:8192
  ds_read_b64_tr_b16 a[166:167], v155 offset:8192
  ds_read_b64_tr_b16 a[168:169], v152 offset:8256
  ds_read_b64_tr_b16 a[170:171], v153 offset:8256
  ds_read_b64_tr_b16 a[172:173], v154 offset:8256
  ds_read_b64_tr_b16 a[174:175], v155 offset:8256
  s_waitcnt lgkmcnt(0)
  s_waitcnt vmcnt(16)
  ds_read_b64_tr_b16 a[176:177], v152 offset:12288
  ds_read_b64_tr_b16 a[178:179], v153 offset:12288
  ds_read_b64_tr_b16 a[180:181], v154 offset:12288
  ds_read_b64_tr_b16 a[182:183], v155 offset:12288
  ds_read_b64_tr_b16 a[184:185], v152 offset:12352
  ds_read_b64_tr_b16 a[186:187], v153 offset:12352
  ds_read_b64_tr_b16 a[188:189], v154 offset:12352
  ds_read_b64_tr_b16 a[190:191], v155 offset:12352
  s_waitcnt lgkmcnt(0)
  s_waitcnt vmcnt(12)
  ds_read_b64_tr_b16 a[192:193], v152 offset:16384
  ds_read_b64_tr_b16 a[194:195], v153 offset:16384
  ds_read_b64_tr_b16 a[196:197], v154 offset:16384
  ds_read_b64_tr_b16 a[198:199], v155 offset:16384
  ds_read_b64_tr_b16 a[200:201], v152 offset:16448
  ds_read_b64_tr_b16 a[202:203], v153 offset:16448
  ds_read_b64_tr_b16 a[204:205], v154 offset:16448
  ds_read_b64_tr_b16 a[206:207], v155 offset:16448
  s_waitcnt lgkmcnt(0)
  s_waitcnt vmcnt(8)
  ds_read_b64_tr_b16 a[208:209], v152 offset:20480
  ds_read_b64_tr_b16 a[210:211], v153 offset:20480
  ds_read_b64_tr_b16 a[212:213], v154 offset:20480
  ds_read_b64_tr_b16 a[214:215], v155 offset:20480
  ds_read_b64_tr_b16 a[216:217], v152 offset:20544
  ds_read_b64_tr_b16 a[218:219], v153 offset:20544
  ds_read_b64_tr_b16 a[220:221], v154 offset:20544
  ds_read_b64_tr_b16 a[222:223], v155 offset:20544
  s_waitcnt lgkmcnt(0)
  s_waitcnt vmcnt(4)
  ds_read_b64_tr_b16 a[224:225], v152 offset:24576
  ds_read_b64_tr_b16 a[226:227], v153 offset:24576
  ds_read_b64_tr_b16 a[228:229], v154 offset:24576
  ds_read_b64_tr_b16 a[230:231], v155 offset:24576
  ds_read_b64_tr_b16 a[232:233], v152 offset:24640
  ds_read_b64_tr_b16 a[234:235], v153 offset:24640
  ds_read_b64_tr_b16 a[236:237], v154 offset:24640
  ds_read_b64_tr_b16 a[238:239], v155 offset:24640
  s_waitcnt lgkmcnt(0)
  s_waitcnt vmcnt(0)
  ds_read_b64_tr_b16 a[240:241], v152 offset:28672
  ds_read_b64_tr_b16 a[242:243], v153 offset:28672
  ds_read_b64_tr_b16 a[244:245], v154 offset:28672
  ds_read_b64_tr_b16 a[246:247], v155 offset:28672
  ds_read_b64_tr_b16 a[248:249], v152 offset:28736
  ds_read_b64_tr_b16 a[250:251], v153 offset:28736
  ds_read_b64_tr_b16 a[252:253], v154 offset:28736
  ds_read_b64_tr_b16 a[254:255], v155 offset:28736
  s_waitcnt lgkmcnt(0)
  s_lshl_b32 s26, s48, 2
  s_add_u32 s26, s26, s16
  s_lshl_b32 s27, s26, 6
  s_add_u32 s27, s27, s50
  s_lshl_b32 s19, s27, 13
  s_lshl_b32 s27, s50, 5
  s_add_u32 s27, s27, s26
  s_mul_i32 s27, s27, 4096
  s_add_u32 s20, s27, 135266304
  s_lshl_b32 s25, s16, 12
  s_add_u32 s25, s25, 65536
  s_lshl_b32 s26, s16, 13
  v_add_u32 v3, s26, v2
  v_lshrrev_b32 v16, 5, v1
  v_and_b32 v17, 31, v1
  v_bfe_u32 v18, v1, 4, 1
  v_lshl_add_u32 v18, v18, 1, v16
  v_and_b32 v19, 15, v1
  v_lshl_add_u32 v18, v18, 4, v19
  v_lshl_add_u32 v5, v18, 4, s25
  v_bfe_u32 v18, v1, 2, 2
  v_lshl_add_u32 v18, v16, 2, v18
  v_and_b32 v19, 1, v1
  v_lshl_add_u32 v18, v19, 4, v18
  v_lshl_add_u32 v4, v18, 4, s25
  v_lshlrev_b32 v16, 2, v16
  v_sub_u32 v17, v17, v16
  v_mov_b32 v18, 0xf149f2ca
  v_cmp_le_i32 vcc, 0, v17
  s_nop 1
  v_cndmask_b32 v240, v18, 0, vcc
  v_cmp_le_i32 vcc, 1, v17
  s_nop 1
  v_cndmask_b32 v241, v18, 0, vcc
  v_cmp_le_i32 vcc, 2, v17
  s_nop 1
  v_cndmask_b32 v242, v18, 0, vcc
  v_cmp_le_i32 vcc, 3, v17
  s_nop 1
  v_cndmask_b32 v243, v18, 0, vcc
  v_cmp_le_i32 vcc, 8, v17
  s_nop 1
  v_cndmask_b32 v244, v18, 0, vcc
  v_cmp_le_i32 vcc, 9, v17
  s_nop 1
  v_cndmask_b32 v245, v18, 0, vcc
  v_cmp_le_i32 vcc, 10, v17
  s_nop 1
  v_cndmask_b32 v246, v18, 0, vcc
  v_cmp_le_i32 vcc, 11, v17
  s_nop 1
  v_cndmask_b32 v247, v18, 0, vcc
  v_cmp_le_i32 vcc, 16, v17
  s_nop 1
  v_cndmask_b32 v248, v18, 0, vcc
  v_cmp_le_i32 vcc, 17, v17
  s_nop 1
  v_cndmask_b32 v249, v18, 0, vcc
  v_cmp_le_i32 vcc, 18, v17
  s_nop 1
  v_cndmask_b32 v250, v18, 0, vcc
  v_cmp_le_i32 vcc, 19, v17
  s_nop 1
  v_cndmask_b32 v251, v18, 0, vcc
  v_cmp_le_i32 vcc, 24, v17
  s_nop 1
  v_cndmask_b32 v252, v18, 0, vcc
  v_cmp_le_i32 vcc, 25, v17
  s_nop 1
  v_cndmask_b32 v253, v18, 0, vcc
  v_cmp_le_i32 vcc, 26, v17
  s_nop 1
  v_cndmask_b32 v254, v18, 0, vcc
  v_cmp_le_i32 vcc, 27, v17
  s_nop 1
  v_cndmask_b32 v255, v18, 0, vcc
  v_mov_b32 v21, v2
  s_barrier
  s_lshl_b32 s77, s48, 2
  s_add_u32 s77, s77, s16
  s_mul_i32 s78, s77, 896
  s_add_u32 s76, s78, 148898304
  s_mov_b32 s71, 0
  s_branch M_sg_60
M_sw_59:
  s_sleep 8
  s_add_u32 s71, s71, 1
  s_cmp_gt_u32 s71, 262144
  s_cbranch_scc1 M_exit
M_sg_60:
  s_mov_b32 s79, 0
  s_atomic_or s79, s[72:73], s76 glc
  s_waitcnt lgkmcnt(0)
  s_cmp_lt_u32 s79, 16
  s_cbranch_scc1 M_sw_59
  s_add_u32 s76, s78, 148898048
  s_mov_b32 s71, 0
  s_branch M_sg_62
M_sw_61:
  s_sleep 8
  s_add_u32 s71, s71, 1
  s_cmp_gt_u32 s71, 262144
  s_cbranch_scc1 M_exit
M_sg_62:
  s_mov_b32 s79, 0
  s_atomic_or s79, s[72:73], s76 glc
  s_waitcnt lgkmcnt(0)
  s_cmp_lt_u32 s79, 16
  s_cbranch_scc1 M_sw_61
M_xok_58:
  s_lshl_b32 s77, s77, 7
  s_add_u32 s54, s77, 148926464
  s_add_u32 s52, s50, 1
  s_mov_b32 s53, 0
  s_mov_b32 s30, 0x200
  s_add_u32 s28, s19, 50331648
  buffer_load_dwordx4 v[144:147], v21, s[4:7], s28 offen offset:0 sc1
  buffer_load_dwordx4 v[148:151], v21, s[4:7], s28 offen offset:1024 sc1
  buffer_load_dwordx4 v[152:155], v21, s[4:7], s28 offen offset:2048 sc1
  buffer_load_dwordx4 v[156:159], v21, s[4:7], s28 offen offset:3072 sc1
  s_add_u32 s29, s19, 50335744
  buffer_load_dwordx4 v[160:163], v21, s[4:7], s29 offen offset:0 sc1
  buffer_load_dwordx4 v[164:167], v21, s[4:7], s29 offen offset:1024 sc1
  buffer_load_dwordx4 v[168:171], v21, s[4:7], s29 offen offset:2048 sc1
  buffer_load_dwordx4 v[172:175], v21, s[4:7], s29 offen offset:3072 sc1
  s_add_u32 s28, s19, 67108864
  buffer_load_dwordx4 v[176:179], v21, s[4:7], s28 offen offset:0 sc1
  buffer_load_dwordx4 v[180:183], v21, s[4:7], s28 offen offset:1024 sc1
  buffer_load_dwordx4 v[184:187], v21, s[4:7], s28 offen offset:2048 sc1
  buffer_load_dwordx4 v[188:191], v21, s[4:7], s28 offen offset:3072 sc1
  s_add_u32 s29, s19, 67112960
  buffer_load_dwordx4 v[192:195], v21, s[4:7], s29 offen offset:0 sc1
  buffer_load_dwordx4 v[196:199], v21, s[4:7], s29 offen offset:1024 sc1
  buffer_load_dwordx4 v[200:203], v21, s[4:7], s29 offen offset:2048 sc1
  buffer_load_dwordx4 v[204:207], v21, s[4:7], s29 offen offset:3072 sc1
  s_add_u32 s28, s19, 83886080
  buffer_load_dwordx4 v[208:211], v21, s[4:7], s28 offen offset:0 sc1
  buffer_load_dwordx4 v[212:215], v21, s[4:7], s28 offen offset:1024 sc1
  buffer_load_dwordx4 v[216:219], v21, s[4:7], s28 offen offset:2048 sc1
  buffer_load_dwordx4 v[220:223], v21, s[4:7], s28 offen offset:3072 sc1
  s_add_u32 s29, s19, 83890176
  buffer_load_dwordx4 v[224:227], v21, s[4:7], s29 offen offset:0 sc1
  buffer_load_dwordx4 v[228:231], v21, s[4:7], s29 offen offset:1024 sc1
  buffer_load_dwordx4 v[232:235], v21, s[4:7], s29 offen offset:2048 sc1
  buffer_load_dwordx4 v[236:239], v21, s[4:7], s29 offen offset:3072 sc1
  s_mov_b32 s24, 0
  v_mov_b32 v22, 0x40000000
  s_sub_u32 s21, s21, s22
F_top_63:
  s_waitcnt vmcnt(8)
  v_mfma_f32_32x32x16_bf16 v[24:39], v[176:179], v[144:147], v[240:255]
  s_nop 1
  v_cvt_pk_bf16_f32 v128, v64, v65
  v_cvt_pk_bf16_f32 v129, v66, v67
  v_cvt_pk_bf16_f32 v130, v68, v69
  v_cvt_pk_bf16_f32 v131, v70, v71
  v_mfma_f32_32x32x16_bf16 v[24:39], v[180:183], v[148:151], v[24:39]
  buffer_store_dwordx4 v[128:131], v22, s[4:7], s21 offen offset:0 sc1
  v_mfma_f32_32x32x16_bf16 v[24:39], v[184:187], v[152:155], v[24:39]
  v_cvt_pk_bf16_f32 v132, v72, v73
  v_cvt_pk_bf16_f32 v133, v74, v75
  v_cvt_pk_bf16_f32 v134, v76, v77
  v_cvt_pk_bf16_f32 v135, v78, v79
  v_mfma_f32_32x32x16_bf16 v[24:39], v[188:191], v[156:159], v[24:39]
  buffer_store_dwordx4 v[132:135], v22, s[4:7], s21 offen offset:256 sc1
  v_mfma_f32_32x32x16_bf16 v[24:39], v[192:195], v[160:163], v[24:39]
  v_cvt_pk_bf16_f32 v136, v80, v81
  v_cvt_pk_bf16_f32 v137, v82, v83
  v_cvt_pk_bf16_f32 v138, v84, v85
  v_cvt_pk_bf16_f32 v139, v86, v87
  v_mfma_f32_32x32x16_bf16 v[24:39], v[196:199], v[164:167], v[24:39]
  buffer_store_dwordx4 v[136:139], v22, s[4:7], s21 offen offset:2048 sc1
  v_mfma_f32_32x32x16_bf16 v[24:39], v[200:203], v[168:171], v[24:39]
  v_cvt_pk_bf16_f32 v140, v88, v89
  v_cvt_pk_bf16_f32 v141, v90, v91
  v_cvt_pk_bf16_f32 v142, v92, v93
  v_cvt_pk_bf16_f32 v143, v94, v95
  v_mfma_f32_32x32x16_bf16 v[24:39], v[204:207], v[172:175], v[24:39]
  buffer_store_dwordx4 v[140:143], v22, s[4:7], s21 offen offset:2304 sc1
  s_add_u32 s21, s21, s22
  v_mov_b32 v22, v20
  s_cmp_lg_u32 s24, 0
  s_cbranch_scc1 F_have_64
  s_cmp_le_u32 s52, 58
  s_cbranch_scc1 M_dp_65
  s_mov_b32 s71, 0
  v_add_u32 v16, s25, v2
  s_branch M_dp_67
M_dp_66:
  s_sleep 1
  s_add_u32 s71, s71, 1
  s_cmp_gt_u32 s71, 262144
  s_cbranch_scc1 M_exit
M_dp_67:
  buffer_load_dword v23, off, s[4:7], s54 sc1
  buffer_load_dwordx4 v[96:99], v2, s[4:7], s20 offen offset:0 sc1
  buffer_load_dwordx4 v[100:103], v2, s[4:7], s20 offen offset:1024 sc1
  buffer_load_dwordx4 v[104:107], v2, s[4:7], s20 offen offset:2048 sc1
  buffer_load_dwordx4 v[108:111], v2, s[4:7], s20 offen offset:3072 sc1
  s_waitcnt vmcnt(3)
  v_max_u32 v17, v96, v97
  v_max3_u32 v17, v17, v98, v99
  s_waitcnt vmcnt(2)
  v_max3_u32 v17, v17, v100, v101
  v_max3_u32 v17, v17, v102, v103
  s_waitcnt vmcnt(1)
  v_max3_u32 v17, v17, v104, v105
  v_max3_u32 v17, v17, v106, v107
  s_waitcnt vmcnt(0)
  v_max3_u32 v17, v17, v108, v109
  v_max3_u32 v17, v17, v110, v111
  v_cmp_eq_u32 vcc, -1, v17
  s_cbranch_vccz M_dp_68
  v_cmp_gt_u32 vcc, s52, v23
  s_cbranch_vccnz M_dp_66
  s_branch M_dp_65
M_dp_68:
  ds_write_b128 v16, v[96:99] offset:0
  ds_write_b128 v16, v[100:103] offset:1024
  ds_write_b128 v16, v[104:107] offset:2048
  ds_write_b128 v16, v[108:111] offset:3072
  s_branch F_have_64
M_dp_65:
  v_mov_b32 v16, s54
  v_mov_b32 v17, s52
  s_mov_b32 s71, 0
  s_branch M_vg_70
M_vw_69:
  s_sleep 2
  s_add_u32 s71, s71, 1
  s_cmp_gt_u32 s71, 262144
  s_cbranch_scc1 M_exit
M_vg_70:
  buffer_load_dword v23, v16, s[4:7], 0 offen sc1
  s_waitcnt vmcnt(0)
  v_cmp_lt_u32 vcc, v23, v17
  s_cbranch_vccnz M_vw_69
  s_mov_b32 m0, s25
  s_nop 0
  buffer_load_dwordx4 v2, s[4:7], s20 offen offset:0 sc1 lds
  buffer_load_dwordx4 v2, s[4:7], s20 offen offset:1024 sc1 lds
  buffer_load_dwordx4 v2, s[4:7], s20 offen offset:2048 sc1 lds
  buffer_load_dwordx4 v2, s[4:7], s20 offen offset:3072 sc1 lds
  s_waitcnt vmcnt(0)
F_have_64:
  ds_read_b64_tr_b16 v[176:177], v4 offset:8
  ds_read_b64_tr_b16 v[178:179], v4 offset:136
  ds_read_b64_tr_b16 v[180:181], v4 offset:520
  ds_read_b64_tr_b16 v[182:183], v4 offset:648
  ds_read_b64_tr_b16 v[184:185], v4 offset:1032
  ds_read_b64_tr_b16 v[186:187], v4 offset:1160
  ds_read_b64_tr_b16 v[188:189], v4 offset:1544
  ds_read_b64_tr_b16 v[190:191], v4 offset:1672
  ds_read_b64_tr_b16 v[192:193], v4 offset:2056
  ds_read_b64_tr_b16 v[194:195], v4 offset:2184
  ds_read_b64_tr_b16 v[196:197], v4 offset:2568
  ds_read_b64_tr_b16 v[198:199], v4 offset:2696
  s_sub_u32 s23, s23, 1
  s_cmp_gt_u32 s23, 0
  s_cselect_b32 s26, s51, 0
  s_cselect_b32 s27, 0, 0x40000000
  v_or_b32 v21, s27, v21
  s_lshl_b32 s27, s26, 13
  s_add_u32 s19, s19, s27
  s_mul_i32 s27, s26, 131072
  s_add_u32 s20, s20, s27
  s_cmp_lg_u32 s23, 24
  s_cbranch_scc1 M_xok_71
  s_lshl_b32 s77, s48, 2
  s_add_u32 s77, s77, s16
  s_mul_i32 s78, s77, 896
  s_add_u32 s76, s78, 148898304
  s_mov_b32 s71, 0
  s_branch M_sg_73
M_sw_72:
  s_sleep 8
  s_add_u32 s71, s71, 1
  s_cmp_gt_u32 s71, 262144
  s_cbranch_scc1 M_exit
M_sg_73:
  s_mov_b32 s79, 0
  s_atomic_or s79, s[72:73], s76 glc
  s_waitcnt lgkmcnt(0)
  s_cmp_lt_u32 s79, 32
  s_cbranch_scc1 M_sw_72
  s_add_u32 s76, s78, 148898432
  s_mov_b32 s71, 0
  s_branch M_sg_75
M_sw_74:
  s_sleep 8
  s_add_u32 s71, s71, 1
  s_cmp_gt_u32 s71, 262144
  s_cbranch_scc1 M_exit
M_sg_75:
  s_mov_b32 s79, 0
  s_atomic_or s79, s[72:73], s76 glc
  s_waitcnt lgkmcnt(0)
  s_cmp_lt_u32 s79, 32
  s_cbranch_scc1 M_sw_74
  s_add_u32 s76, s78, 148898048
  s_mov_b32 s71, 0
  s_branch M_sg_77
M_sw_76:
  s_sleep 8
  s_add_u32 s71, s71, 1
  s_cmp_gt_u32 s71, 262144
  s_cbranch_scc1 M_exit
M_sg_77:
  s_mov_b32 s79, 0
  s_atomic_or s79, s[72:73], s76 glc
  s_waitcnt lgkmcnt(0)
  s_cmp_lt_u32 s79, 30
  s_cbranch_scc1 M_sw_76
  s_add_u32 s76, s78, 148898176
  s_mov_b32 s71, 0
  s_branch M_sg_79
M_sw_78:
  s_sleep 8
  s_add_u32 s71, s71, 1
  s_cmp_gt_u32 s71, 262144
  s_cbranch_scc1 M_exit
M_sg_79:
  s_mov_b32 s79, 0
  s_atomic_or s79, s[72:73], s76 glc
  s_waitcnt lgkmcnt(0)
  s_cmp_lt_u32 s79, 34
  s_cbranch_scc1 M_sw_78
M_xok_71:
  s_waitcnt lgkmcnt(10)
  v_mfma_f32_32x32x16_bf16 v[40:55], v[176:179], v[144:147], 0
  ds_read_b64_tr_b16 v[200:201], v4 offset:3080
  ds_read_b64_tr_b16 v[202:203], v4 offset:3208
  v_max_f32 v6, v24, v25
  s_waitcnt lgkmcnt(10)
  v_mfma_f32_32x32x16_bf16 v[40:55], v[180:183], v[148:151], v[40:55]
  ds_read_b64_tr_b16 v[204:205], v4 offset:3592
  ds_read_b64_tr_b16 v[206:207], v4 offset:3720
  v_max3_f32 v6, v6, v26, v27
  s_waitcnt lgkmcnt(10)
  v_mfma_f32_32x32x16_bf16 v[40:55], v[184:187], v[152:155], v[40:55]
  ds_read_b64 v[56:57], v5 offset:0
  ds_read_b64 v[58:59], v5 offset:1024
  v_max3_f32 v6, v6, v28, v29
  s_waitcnt lgkmcnt(10)
  v_mfma_f32_32x32x16_bf16 v[40:55], v[188:191], v[156:159], v[40:55]
  ds_read_b64 v[60:61], v5 offset:2048
  ds_read_b64 v[62:63], v5 offset:3072
  v_max3_f32 v6, v6, v30, v31
  s_waitcnt lgkmcnt(10)
  v_mfma_f32_32x32x16_bf16 v[40:55], v[192:195], v[160:163], v[40:55]
  v_max3_f32 v6, v6, v32, v33
  s_waitcnt lgkmcnt(8)
  v_mfma_f32_32x32x16_bf16 v[40:55], v[196:199], v[164:167], v[40:55]
  v_max3_f32 v6, v6, v34, v35
  s_waitcnt lgkmcnt(6)
  v_mfma_f32_32x32x16_bf16 v[40:55], v[200:203], v[168:171], v[40:55]
  v_max3_f32 v6, v6, v36, v37
  s_waitcnt lgkmcnt(4)
  v_mfma_f32_32x32x16_bf16 v[40:55], v[204:207], v[172:175], v[40:55]
  v_max3_f32 v6, v6, v38, v39
  s_add_u32 s28, s19, 50331648
  buffer_load_dwordx4 v[144:147], v21, s[4:7], s28 offen offset:0 sc1
  buffer_load_dwordx4 v[148:151], v21, s[4:7], s28 offen offset:1024 sc1
  s_nop 7
  v_max3_f32 v6, v6, v40, v41
  v_max3_f32 v6, v6, v42, v43
  v_mov_b32 v16, v6
  s_nop 1
  v_permlane32_swap_b32 v6, v16
  s_nop 1
  v_max_f32 v6, v6, v16
  v_pk_add_f32 v[24:25], v[24:25], v[6:7] op_sel_hi:[1,0] neg_lo:[0,1] neg_hi:[0,1]
  v_pk_add_f32 v[26:27], v[26:27], v[6:7] op_sel_hi:[1,0] neg_lo:[0,1] neg_hi:[0,1]
  v_pk_add_f32 v[28:29], v[28:29], v[6:7] op_sel_hi:[1,0] neg_lo:[0,1] neg_hi:[0,1]
  v_pk_add_f32 v[30:31], v[30:31], v[6:7] op_sel_hi:[1,0] neg_lo:[0,1] neg_hi:[0,1]
  v_pk_add_f32 v[32:33], v[32:33], v[6:7] op_sel_hi:[1,0] neg_lo:[0,1] neg_hi:[0,1]
  v_pk_add_f32 v[34:35], v[34:35], v[6:7] op_sel_hi:[1,0] neg_lo:[0,1] neg_hi:[0,1]
  v_pk_add_f32 v[36:37], v[36:37], v[6:7] op_sel_hi:[1,0] neg_lo:[0,1] neg_hi:[0,1]
  v_pk_add_f32 v[38:39], v[38:39], v[6:7] op_sel_hi:[1,0] neg_lo:[0,1] neg_hi:[0,1]
  v_pk_add_f32 v[40:41], v[40:41], v[6:7] op_sel_hi:[1,0] neg_lo:[0,1] neg_hi:[0,1]
  v_pk_add_f32 v[42:43], v[42:43], v[6:7] op_sel_hi:[1,0] neg_lo:[0,1] neg_hi:[0,1]
  v_exp_f32 v24, v24
  v_exp_f32 v25, v25
  v_exp_f32 v26, v26
  v_exp_f32 v27, v27
  v_exp_f32 v28, v28
  v_exp_f32 v29, v29
  v_exp_f32 v30, v30
  v_exp_f32 v31, v31
  v_exp_f32 v32, v32
  v_exp_f32 v33, v33
  buffer_load_dwordx4 v[152:155], v21, s[4:7], s28 offen offset:2048 sc1
  v_exp_f32 v34, v34
  v_exp_f32 v35, v35
  v_exp_f32 v36, v36
  v_exp_f32 v37, v37
  v_exp_f32 v38, v38
  v_exp_f32 v39, v39
  v_exp_f32 v40, v40
  v_exp_f32 v41, v41
  v_exp_f32 v42, v42
  v_exp_f32 v43, v43
  v_pk_add_f32 v[16:17], v[24:25], v[26:27]
  v_pk_add_f32 v[16:17], v[16:17], v[28:29]
  v_pk_add_f32 v[16:17], v[16:17], v[30:31]
  v_pk_add_f32 v[16:17], v[16:17], v[32:33]
  v_pk_add_f32 v[16:17], v[16:17], v[34:35]
  v_pk_add_f32 v[16:17], v[16:17], v[36:37]
  v_pk_add_f32 v[16:17], v[16:17], v[38:39]
  v_pk_add_f32 v[16:17], v[16:17], v[40:41]
  v_pk_add_f32 v[16:17], v[16:17], v[42:43]
  v_add_f32 v16, v16, v17
  v_mov_b32 v17, v16
  buffer_load_dwordx4 v[156:159], v21, s[4:7], s28 offen offset:3072 sc1
  s_nop 0
  v_permlane32_swap_b32 v16, v17
  s_nop 1
  v_add_f32 v16, v16, v17
  v_rcp_f32 v6, v16
  s_nop 0
  v_pk_mul_f32 v[24:25], v[24:25], v[6:7] op_sel_hi:[1,0]
  v_pk_mul_f32 v[26:27], v[26:27], v[6:7] op_sel_hi:[1,0]
  v_pk_mul_f32 v[28:29], v[28:29], v[6:7] op_sel_hi:[1,0]
  v_pk_mul_f32 v[30:31], v[30:31], v[6:7] op_sel_hi:[1,0]
  v_pk_mul_f32 v[32:33], v[32:33], v[6:7] op_sel_hi:[1,0]
  v_pk_mul_f32 v[34:35], v[34:35], v[6:7] op_sel_hi:[1,0]
  v_pk_mul_f32 v[36:37], v[36:37], v[6:7] op_sel_hi:[1,0]
  v_pk_mul_f32 v[38:39], v[38:39], v[6:7] op_sel_hi:[1,0]
  v_pk_mul_f32 v[40:41], v[40:41], v[6:7] op_sel_hi:[1,0]
  v_pk_mul_f32 v[42:43], v[42:43], v[6:7] op_sel_hi:[1,0]
  v_cvt_pk_bf16_f32 v128, v24, v25
  v_cvt_pk_bf16_f32 v129, v26, v27
  v_cvt_pk_bf16_f32 v130, v28, v29
  v_cvt_pk_bf16_f32 v131, v30, v31
  v_cvt_pk_bf16_f32 v132, v32, v33
  v_cvt_pk_bf16_f32 v133, v34, v35
  v_cvt_pk_bf16_f32 v134, v36, v37
  v_cvt_pk_bf16_f32 v135, v38, v39
  v_cvt_pk_bf16_f32 v136, v40, v41
  v_cvt_pk_bf16_f32 v137, v42, v43
  s_waitcnt vmcnt(8) lgkmcnt(0)
  v_mfma_f32_32x32x16_bf16 v[64:79], v[208:211], v[128:131], 0
  s_add_u32 s29, s19, 50335744
  buffer_load_dwordx4 v[160:163], v21, s[4:7], s29 offen offset:0 sc1
  v_mfma_f32_32x32x16_bf16 v[64:79], v[212:215], v[132:135], v[64:79]
  v_mfma_f32_32x32x8_bf16 v[64:79], v[56:57], v[136:137], v[64:79]
  v_mfma_f32_32x32x16_bf16 v[80:95], v[216:219], v[128:131], 0
  buffer_load_dwordx4 v[164:167], v21, s[4:7], s29 offen offset:1024 sc1
  v_mfma_f32_32x32x16_bf16 v[80:95], v[220:223], v[132:135], v[80:95]
  v_cvt_pk_bf16_f32 v24, v64, v65
  v_cvt_pk_bf16_f32 v25, v66, v67
  v_cvt_pk_bf16_f32 v26, v68, v69
  v_cvt_pk_bf16_f32 v27, v70, v71
  v_mfma_f32_32x32x8_bf16 v[80:95], v[58:59], v[136:137], v[80:95]
  ds_write_b128 v3, v[24:27] offset:0
  v_cvt_pk_bf16_f32 v28, v72, v73
  v_cvt_pk_bf16_f32 v29, v74, v75
  v_cvt_pk_bf16_f32 v30, v76, v77
  v_cvt_pk_bf16_f32 v31, v78, v79
  v_mfma_f32_32x32x16_bf16 v[96:111], v[224:227], v[128:131], 0
  ds_write_b128 v3, v[28:31] offset:1024
  buffer_load_dwordx4 v[168:171], v21, s[4:7], s29 offen offset:2048 sc1
  v_mfma_f32_32x32x16_bf16 v[96:111], v[228:231], v[132:135], v[96:111]
  v_cvt_pk_bf16_f32 v32, v80, v81
  v_cvt_pk_bf16_f32 v33, v82, v83
  v_cvt_pk_bf16_f32 v34, v84, v85
  v_cvt_pk_bf16_f32 v35, v86, v87
  v_mfma_f32_32x32x8_bf16 v[96:111], v[60:61], v[136:137], v[96:111]
  ds_write_b128 v3, v[32:35] offset:2048
  v_cvt_pk_bf16_f32 v36, v88, v89
  v_cvt_pk_bf16_f32 v37, v90, v91
  v_cvt_pk_bf16_f32 v38, v92, v93
  v_cvt_pk_bf16_f32 v39, v94, v95
  v_mfma_f32_32x32x16_bf16 v[112:127], v[232:235], v[128:131], 0
  ds_write_b128 v3, v[36:39] offset:3072
  buffer_load_dwordx4 v[172:175], v21, s[4:7], s29 offen offset:3072 sc1
  v_mfma_f32_32x32x16_bf16 v[112:127], v[236:239], v[132:135], v[112:127]
  v_cvt_pk_bf16_f32 v40, v96, v97
  v_cvt_pk_bf16_f32 v41, v98, v99
  v_cvt_pk_bf16_f32 v42, v100, v101
  v_cvt_pk_bf16_f32 v43, v102, v103
  v_mfma_f32_32x32x8_bf16 v[112:127], v[62:63], v[136:137], v[112:127]
  ds_write_b128 v3, v[40:43] offset:4096
  v_cvt_pk_bf16_f32 v44, v104, v105
  v_cvt_pk_bf16_f32 v45, v106, v107
  v_cvt_pk_bf16_f32 v46, v108, v109
  v_cvt_pk_bf16_f32 v47, v110, v111
  ds_write_b128 v3, v[44:47] offset:5120
  s_nop 5
  v_cvt_pk_bf16_f32 v48, v112, v113
  v_cvt_pk_bf16_f32 v49, v114, v115
  v_cvt_pk_bf16_f32 v50, v116, v117
  v_cvt_pk_bf16_f32 v51, v118, v119
  ds_write_b128 v3, v[48:51] offset:6144
  v_cvt_pk_bf16_f32 v52, v120, v121
  v_cvt_pk_bf16_f32 v53, v122, v123
  v_cvt_pk_bf16_f32 v54, v124, v125
  v_cvt_pk_bf16_f32 v55, v126, v127
  ds_write_b128 v3, v[52:55] offset:7168
  s_waitcnt vmcnt(8)
  s_waitcnt lgkmcnt(0)
  s_barrier
  ds_read_b128 v[24:27], v8 offset:0
  ds_read_b128 v[28:31], v9 offset:0
  ds_read_b128 v[32:35], v10 offset:0
  ds_read_b128 v[36:39], v11 offset:0
  ds_read_b128 v[40:43], v12 offset:0
  ds_read_b128 v[44:47], v13 offset:0
  buffer_load_dword v23, off, s[4:7], s54 sc1
  v_mov_b32 v16, s30
  v_min_u32 v17, 1, v0
  v_lshlrev_b32 v17, 30, v17
  buffer_store_dword v16, v17, s[4:7], s31 offen sc1
  s_add_u32 s30, s30, 1
  s_add_u32 s52, s52, 2
  s_waitcnt lgkmcnt(5)
  v_mfma_f32_16x16x32_bf16 v[64:67], a[0:3], v[24:27], 0
  s_add_u32 s28, s19, 67108864
  ds_read_b128 v[48:51], v14 offset:0
  v_mfma_f32_16x16x32_bf16 v[68:71], a[4:7], v[24:27], 0
  v_mfma_f32_16x16x32_bf16 v[80:83], a[8:11], v[24:27], 0
  v_mfma_f32_16x16x32_bf16 v[84:87], a[12:15], v[24:27], 0
  s_waitcnt lgkmcnt(5)
  v_mfma_f32_16x16x32_bf16 v[72:75], a[0:3], v[28:31], 0
  ds_read_b128 v[52:55], v15 offset:0
  v_mfma_f32_16x16x32_bf16 v[76:79], a[4:7], v[28:31], 0
  v_mfma_f32_16x16x32_bf16 v[88:91], a[8:11], v[28:31], 0
  buffer_load_dwordx4 v[176:179], v21, s[4:7], s28 offen offset:0 sc1
  v_mfma_f32_16x16x32_bf16 v[92:95], a[12:15], v[28:31], 0
  s_waitcnt lgkmcnt(5)
  v_mfma_f32_16x16x32_bf16 v[64:67], a[16:19], v[32:35], v[64:67]
  ds_read_b128 v[24:27], v8 offset:8192
  v_mfma_f32_16x16x32_bf16 v[68:71], a[20:23], v[32:35], v[68:71]
  v_mfma_f32_16x16x32_bf16 v[80:83], a[24:27], v[32:35], v[80:83]
  v_mfma_f32_16x16x32_bf16 v[84:87], a[28:31], v[32:35], v[84:87]
  s_waitcnt lgkmcnt(5)
  v_mfma_f32_16x16x32_bf16 v[72:75], a[16:19], v[36:39], v[72:75]
  ds_read_b128 v[28:31], v9 offset:8192
  v_mfma_f32_16x16x32_bf16 v[76:79], a[20:23], v[36:39], v[76:79]
  v_mfma_f32_16x16x32_bf16 v[88:91], a[24:27], v[36:39], v[88:91]
  buffer_load_dwordx4 v[180:183], v21, s[4:7], s28 offen offset:1024 sc1
  v_mfma_f32_16x16x32_bf16 v[92:95], a[28:31], v[36:39], v[92:95]
  s_waitcnt lgkmcnt(5)
  v_mfma_f32_16x16x32_bf16 v[64:67], a[32:35], v[40:43], v[64:67]
  ds_read_b128 v[32:35], v10 offset:8192
  v_mfma_f32_16x16x32_bf16 v[68:71], a[36:39], v[40:43], v[68:71]
  v_mfma_f32_16x16x32_bf16 v[80:83], a[40:43], v[40:43], v[80:83]
  v_mfma_f32_16x16x32_bf16 v[84:87], a[44:47], v[40:43], v[84:87]
  s_waitcnt lgkmcnt(5)
  v_mfma_f32_16x16x32_bf16 v[72:75], a[32:35], v[44:47], v[72:75]
  ds_read_b128 v[36:39], v11 offset:8192
  v_mfma_f32_16x16x32_bf16 v[76:79], a[36:39], v[44:47], v[76:79]
  v_mfma_f32_16x16x32_bf16 v[88:91], a[40:43], v[44:47], v[88:91]
  buffer_load_dwordx4 v[184:187], v21, s[4:7], s28 offen offset:2048 sc1
  v_mfma_f32_16x16x32_bf16 v[92:95], a[44:47], v[44:47], v[92:95]
  s_waitcnt lgkmcnt(5)
  v_mfma_f32_16x16x32_bf16 v[64:67], a[48:51], v[48:51], v[64:67]
  ds_read_b128 v[40:43], v12 offset:8192
  v_mfma_f32_16x16x32_bf16 v[68:71], a[52:55], v[48:51], v[68:71]
  v_mfma_f32_16x16x32_bf16 v[80:83], a[56:59], v[48:51], v[80:83]
  v_mfma_f32_16x16x32_bf16 v[84:87], a[60:63], v[48:51], v[84:87]
  s_waitcnt lgkmcnt(5)
  v_mfma_f32_16x16x32_bf16 v[72:75], a[48:51], v[52:55], v[72:75]
  ds_read_b128 v[44:47], v13 offset:8192
  v_mfma_f32_16x16x32_bf16 v[76:79], a[52:55], v[52:55], v[76:79]
  v_mfma_f32_16x16x32_bf16 v[88:91], a[56:59], v[52:55], v[88:91]
  buffer_load_dwordx4 v[188:191], v21, s[4:7], s28 offen offset:3072 sc1
  v_mfma_f32_16x16x32_bf16 v[92:95], a[60:63], v[52:55], v[92:95]
  s_waitcnt lgkmcnt(5)
  v_mfma_f32_16x16x32_bf16 v[64:67], a[64:67], v[24:27], v[64:67]
  s_add_u32 s29, s19, 67112960
  ds_read_b128 v[48:51], v14 offset:8192
  v_mfma_f32_16x16x32_bf16 v[68:71], a[68:71], v[24:27], v[68:71]
  v_mfma_f32_16x16x32_bf16 v[80:83], a[72:75], v[24:27], v[80:83]
  v_mfma_f32_16x16x32_bf16 v[84:87], a[76:79], v[24:27], v[84:87]
  s_waitcnt lgkmcnt(5)
  v_mfma_f32_16x16x32_bf16 v[72:75], a[64:67], v[28:31], v[72:75]
  ds_read_b128 v[52:55], v15 offset:8192
  v_mfma_f32_16x16x32_bf16 v[76:79], a[68:71], v[28:31], v[76:79]
  v_mfma_f32_16x16x32_bf16 v[88:91], a[72:75], v[28:31], v[88:91]
  buffer_load_dwordx4 v[192:195], v21, s[4:7], s29 offen offset:0 sc1
  v_mfma_f32_16x16x32_bf16 v[92:95], a[76:79], v[28:31], v[92:95]
  s_waitcnt lgkmcnt(5)
  v_mfma_f32_16x16x32_bf16 v[64:67], a[80:83], v[32:35], v[64:67]
  ds_read_b128 v[24:27], v8 offset:16384
  v_mfma_f32_16x16x32_bf16 v[68:71], a[84:87], v[32:35], v[68:71]
  v_mfma_f32_16x16x32_bf16 v[80:83], a[88:91], v[32:35], v[80:83]
  v_mfma_f32_16x16x32_bf16 v[84:87], a[92:95], v[32:35], v[84:87]
  s_waitcnt lgkmcnt(5)
  v_mfma_f32_16x16x32_bf16 v[72:75], a[80:83], v[36:39], v[72:75]
  ds_read_b128 v[28:31], v9 offset:16384
  v_mfma_f32_16x16x32_bf16 v[76:79], a[84:87], v[36:39], v[76:79]
  v_mfma_f32_16x16x32_bf16 v[88:91], a[88:91], v[36:39], v[88:91]
  buffer_load_dwordx4 v[196:199], v21, s[4:7], s29 offen offset:1024 sc1
  v_mfma_f32_16x16x32_bf16 v[92:95], a[92:95], v[36:39], v[92:95]
  s_waitcnt lgkmcnt(5)
  v_mfma_f32_16x16x32_bf16 v[64:67], a[96:99], v[40:43], v[64:67]
  ds_read_b128 v[32:35], v10 offset:16384
  v_mfma_f32_16x16x32_bf16 v[68:71], a[100:103], v[40:43], v[68:71]
  v_mfma_f32_16x16x32_bf16 v[80:83], a[104:107], v[40:43], v[80:83]
  v_mfma_f32_16x16x32_bf16 v[84:87], a[108:111], v[40:43], v[84:87]
  s_waitcnt lgkmcnt(5)
  s_waitcnt vmcnt(7)
  v_readfirstlane_b32 s53, v23
  s_nop 0
  s_cmp_ge_u32 s53, s52
  s_cselect_b32 s24, 1, 0
  s_cbranch_scc0 F_nopre_80
  s_mov_b32 m0, s25
  s_nop 0
  buffer_load_dwordx4 v2, s[4:7], s20 offen offset:0 sc1 lds
  buffer_load_dwordx4 v2, s[4:7], s20 offen offset:1024 sc1 lds
  buffer_load_dwordx4 v2, s[4:7], s20 offen offset:2048 sc1 lds
  buffer_load_dwordx4 v2, s[4:7], s20 offen offset:3072 sc1 lds
F_nopre_80:
  v_mfma_f32_16x16x32_bf16 v[72:75], a[96:99], v[44:47], v[72:75]
  ds_read_b128 v[36:39], v11 offset:16384
  v_mfma_f32_16x16x32_bf16 v[76:79], a[100:103], v[44:47], v[76:79]
  v_mfma_f32_16x16x32_bf16 v[88:91], a[104:107], v[44:47], v[88:91]
  buffer_load_dwordx4 v[200:203], v21, s[4:7], s29 offen offset:2048 sc1
  v_mfma_f32_16x16x32_bf16 v[92:95], a[108:111], v[44:47], v[92:95]
  s_waitcnt lgkmcnt(5)
  v_mfma_f32_16x16x32_bf16 v[64:67], a[112:115], v[48:51], v[64:67]
  ds_read_b128 v[40:43], v12 offset:16384
  v_mfma_f32_16x16x32_bf16 v[68:71], a[116:119], v[48:51], v[68:71]
  v_mfma_f32_16x16x32_bf16 v[80:83], a[120:123], v[48:51], v[80:83]
  v_mfma_f32_16x16x32_bf16 v[84:87], a[124:127], v[48:51], v[84:87]
  s_waitcnt lgkmcnt(5)
  v_mfma_f32_16x16x32_bf16 v[72:75], a[112:115], v[52:55], v[72:75]
  ds_read_b128 v[44:47], v13 offset:16384
  v_mfma_f32_16x16x32_bf16 v[76:79], a[116:119], v[52:55], v[76:79]
  v_mfma_f32_16x16x32_bf16 v[88:91], a[120:123], v[52:55], v[88:91]
  buffer_load_dwordx4 v[204:207], v21, s[4:7], s29 offen offset:3072 sc1
  v_mfma_f32_16x16x32_bf16 v[92:95], a[124:127], v[52:55], v[92:95]
  s_waitcnt lgkmcnt(5)
  v_mfma_f32_16x16x32_bf16 v[64:67], a[128:131], v[24:27], v[64:67]
  s_add_u32 s28, s19, 83886080
  ds_read_b128 v[48:51], v14 offset:16384
  v_mfma_f32_16x16x32_bf16 v[68:71], a[132:135], v[24:27], v[68:71]
  v_mfma_f32_16x16x32_bf16 v[80:83], a[136:139], v[24:27], v[80:83]
  v_mfma_f32_16x16x32_bf16 v[84:87], a[140:143], v[24:27], v[84:87]
  s_waitcnt lgkmcnt(5)
  v_mfma_f32_16x16x32_bf16 v[72:75], a[128:131], v[28:31], v[72:75]
  ds_read_b128 v[52:55], v15 offset:16384
  v_mfma_f32_16x16x32_bf16 v[76:79], a[132:135], v[28:31], v[76:79]
  v_mfma_f32_16x16x32_bf16 v[88:91], a[136:139], v[28:31], v[88:91]
  buffer_load_dwordx4 v[208:211], v21, s[4:7], s28 offen offset:0 sc1
  v_mfma_f32_16x16x32_bf16 v[92:95], a[140:143], v[28:31], v[92:95]
  s_waitcnt lgkmcnt(5)
  v_mfma_f32_16x16x32_bf16 v[64:67], a[144:147], v[32:35], v[64:67]
  ds_read_b128 v[24:27], v8 offset:24576
  v_mfma_f32_16x16x32_bf16 v[68:71], a[148:151], v[32:35], v[68:71]
  v_mfma_f32_16x16x32_bf16 v[80:83], a[152:155], v[32:35], v[80:83]
  v_mfma_f32_16x16x32_bf16 v[84:87], a[156:159], v[32:35], v[84:87]
  s_waitcnt lgkmcnt(5)
  v_mfma_f32_16x16x32_bf16 v[72:75], a[144:147], v[36:39], v[72:75]
  ds_read_b128 v[28:31], v9 offset:24576
  v_mfma_f32_16x16x32_bf16 v[76:79], a[148:151], v[36:39], v[76:79]
  v_mfma_f32_16x16x32_bf16 v[88:91], a[152:155], v[36:39], v[88:91]
  buffer_load_dwordx4 v[212:215], v21, s[4:7], s28 offen offset:1024 sc1
  v_mfma_f32_16x16x32_bf16 v[92:95], a[156:159], v[36:39], v[92:95]
  s_waitcnt lgkmcnt(5)
  v_mfma_f32_16x16x32_bf16 v[64:67], a[160:163], v[40:43], v[64:67]
  ds_read_b128 v[32:35], v10 offset:24576
  v_mfma_f32_16x16x32_bf16 v[68:71], a[164:167], v[40:43], v[68:71]
  v_mfma_f32_16x16x32_bf16 v[80:83], a[168:171], v[40:43], v[80:83]
  v_mfma_f32_16x16x32_bf16 v[84:87], a[172:175], v[40:43], v[84:87]
  s_waitcnt lgkmcnt(5)
  v_mfma_f32_16x16x32_bf16 v[72:75], a[160:163], v[44:47], v[72:75]
  ds_read_b128 v[36:39], v11 offset:24576
  v_mfma_f32_16x16x32_bf16 v[76:79], a[164:167], v[44:47], v[76:79]
  v_mfma_f32_16x16x32_bf16 v[88:91], a[168:171], v[44:47], v[88:91]
  buffer_load_dwordx4 v[216:219], v21, s[4:7], s28 offen offset:2048 sc1
  v_mfma_f32_16x16x32_bf16 v[92:95], a[172:175], v[44:47], v[92:95]
  s_waitcnt lgkmcnt(5)
  v_mfma_f32_16x16x32_bf16 v[64:67], a[176:179], v[48:51], v[64:67]
  ds_read_b128 v[40:43], v12 offset:24576
  v_mfma_f32_16x16x32_bf16 v[68:71], a[180:183], v[48:51], v[68:71]
  v_mfma_f32_16x16x32_bf16 v[80:83], a[184:187], v[48:51], v[80:83]
  v_mfma_f32_16x16x32_bf16 v[84:87], a[188:191], v[48:51], v[84:87]
  s_waitcnt lgkmcnt(5)
  v_mfma_f32_16x16x32_bf16 v[72:75], a[176:179], v[52:55], v[72:75]
  ds_read_b128 v[44:47], v13 offset:24576
  v_mfma_f32_16x16x32_bf16 v[76:79], a[180:183], v[52:55], v[76:79]
  v_mfma_f32_16x16x32_bf16 v[88:91], a[184:187], v[52:55], v[88:91]
  buffer_load_dwordx4 v[220:223], v21, s[4:7], s28 offen offset:3072 sc1
  v_mfma_f32_16x16x32_bf16 v[92:95], a[188:191], v[52:55], v[92:95]
  s_waitcnt lgkmcnt(5)
  v_mfma_f32_16x16x32_bf16 v[64:67], a[192:195], v[24:27], v[64:67]
  s_add_u32 s29, s19, 83890176
  ds_read_b128 v[48:51], v14 offset:24576
  v_mfma_f32_16x16x32_bf16 v[68:71], a[196:199], v[24:27], v[68:71]
  v_mfma_f32_16x16x32_bf16 v[80:83], a[200:203], v[24:27], v[80:83]
  v_mfma_f32_16x16x32_bf16 v[84:87], a[204:207], v[24:27], v[84:87]
  s_waitcnt lgkmcnt(5)
  v_mfma_f32_16x16x32_bf16 v[72:75], a[192:195], v[28:31], v[72:75]
  ds_read_b128 v[52:55], v15 offset:24576
  v_mfma_f32_16x16x32_bf16 v[76:79], a[196:199], v[28:31], v[76:79]
  v_mfma_f32_16x16x32_bf16 v[88:91], a[200:203], v[28:31], v[88:91]
  buffer_load_dwordx4 v[224:227], v21, s[4:7], s29 offen offset:0 sc1
  v_mfma_f32_16x16x32_bf16 v[92:95], a[204:207], v[28:31], v[92:95]
  s_waitcnt lgkmcnt(5)
  v_mfma_f32_16x16x32_bf16 v[64:67], a[208:211], v[32:35], v[64:67]
  v_mfma_f32_16x16x32_bf16 v[68:71], a[212:215], v[32:35], v[68:71]
  v_mfma_f32_16x16x32_bf16 v[80:83], a[216:219], v[32:35], v[80:83]
  v_mfma_f32_16x16x32_bf16 v[84:87], a[220:223], v[32:35], v[84:87]
  s_waitcnt lgkmcnt(4)
  v_mfma_f32_16x16x32_bf16 v[72:75], a[208:211], v[36:39], v[72:75]
  v_mfma_f32_16x16x32_bf16 v[76:79], a[212:215], v[36:39], v[76:79]
  v_xor_b32 v8, 0x8000, v8
  v_mfma_f32_16x16x32_bf16 v[88:91], a[216:219], v[36:39], v[88:91]
  buffer_load_dwordx4 v[228:231], v21, s[4:7], s29 offen offset:1024 sc1
  v_mfma_f32_16x16x32_bf16 v[92:95], a[220:223], v[36:39], v[92:95]
  s_waitcnt lgkmcnt(3)
  v_xor_b32 v9, 0x8000, v9
  v_mfma_f32_16x16x32_bf16 v[64:67], a[224:227], v[40:43], v[64:67]
  v_mfma_f32_16x16x32_bf16 v[68:71], a[228:231], v[40:43], v[68:71]
  v_xor_b32 v10, 0x8000, v10
  v_mfma_f32_16x16x32_bf16 v[80:83], a[232:235], v[40:43], v[80:83]
  v_mfma_f32_16x16x32_bf16 v[84:87], a[236:239], v[40:43], v[84:87]
  s_waitcnt lgkmcnt(2)
  v_xor_b32 v11, 0x8000, v11
  v_mfma_f32_16x16x32_bf16 v[72:75], a[224:227], v[44:47], v[72:75]
  v_mfma_f32_16x16x32_bf16 v[76:79], a[228:231], v[44:47], v[76:79]
  v_xor_b32 v12, 0x8000, v12
  v_mfma_f32_16x16x32_bf16 v[88:91], a[232:235], v[44:47], v[88:91]
  buffer_load_dwordx4 v[232:235], v21, s[4:7], s29 offen offset:2048 sc1
  v_mfma_f32_16x16x32_bf16 v[92:95], a[236:239], v[44:47], v[92:95]
  s_waitcnt lgkmcnt(1)
  v_xor_b32 v13, 0x8000, v13
  v_mfma_f32_16x16x32_bf16 v[64:67], a[240:243], v[48:51], v[64:67]
  v_mfma_f32_16x16x32_bf16 v[68:71], a[244:247], v[48:51], v[68:71]
  v_xor_b32 v14, 0x8000, v14
  v_mfma_f32_16x16x32_bf16 v[80:83], a[248:251], v[48:51], v[80:83]
  v_mfma_f32_16x16x32_bf16 v[84:87], a[252:255], v[48:51], v[84:87]
  s_waitcnt lgkmcnt(0)
  v_xor_b32 v15, 0x8000, v15
  v_mfma_f32_16x16x32_bf16 v[72:75], a[240:243], v[52:55], v[72:75]
  v_mfma_f32_16x16x32_bf16 v[76:79], a[244:247], v[52:55], v[76:79]
  v_xor_b32 v3, 0x8000, v3
  v_mfma_f32_16x16x32_bf16 v[88:91], a[248:251], v[52:55], v[88:91]
  buffer_load_dwordx4 v[236:239], v21, s[4:7], s29 offen offset:3072 sc1
  v_mfma_f32_16x16x32_bf16 v[92:95], a[252:255], v[52:55], v[92:95]
  s_cmp_gt_u32 s23, 0
  s_cbranch_scc1 F_top_63
  s_nop 2
  v_cvt_pk_bf16_f32 v128, v64, v65
  v_cvt_pk_bf16_f32 v129, v66, v67
  v_cvt_pk_bf16_f32 v130, v68, v69
  v_cvt_pk_bf16_f32 v131, v70, v71
  buffer_store_dwordx4 v[128:131], v22, s[4:7], s21 offen offset:0 sc1
  v_cvt_pk_bf16_f32 v132, v72, v73
  v_cvt_pk_bf16_f32 v133, v74, v75
  v_cvt_pk_bf16_f32 v134, v76, v77
  v_cvt_pk_bf16_f32 v135, v78, v79
  buffer_store_dwordx4 v[132:135], v22, s[4:7], s21 offen offset:256 sc1
  v_cvt_pk_bf16_f32 v136, v80, v81
  v_cvt_pk_bf16_f32 v137, v82, v83
  v_cvt_pk_bf16_f32 v138, v84, v85
  v_cvt_pk_bf16_f32 v139, v86, v87
  buffer_store_dwordx4 v[136:139], v22, s[4:7], s21 offen offset:2048 sc1
  v_cvt_pk_bf16_f32 v140, v88, v89
  v_cvt_pk_bf16_f32 v141, v90, v91
  v_cvt_pk_bf16_f32 v142, v92, v93
  v_cvt_pk_bf16_f32 v143, v94, v95
  buffer_store_dwordx4 v[140:143], v22, s[4:7], s21 offen offset:2304 sc1
  s_waitcnt vmcnt(0) lgkmcnt(0)
  s_barrier
  v_mov_b32 v144, s30
  v_min_u32 v145, 1, v0
  v_lshlrev_b32 v145, 30, v145
  buffer_store_dword v144, v145, s[4:7], s31 offen sc1
  s_branch M_done
M_team:
  s_mov_b32 s12, s77
  s_load_dwordx4 s[60:63], s[0:1], 64
  s_load_dwordx4 s[64:67], s[0:1], 80
  s_load_dwordx4 s[68:71], s[0:1], 120
  s_load_dwordx2 s[72:73], s[0:1], 56
  v_lshrrev_b32 v1, 6, v0
  v_and_b32 v20, 63, v0
  v_readfirstlane_b32 s13, v1
  s_waitcnt lgkmcnt(0)
  s_mov_b32 s8, s60
  s_and_b32 s9, s61, 0xffff
  s_mov_b32 s10, 0x400000
  s_mov_b32 s11, 0x20000
  s_mov_b32 s40, s62
  s_and_b32 s41, s63, 0xffff
  s_mov_b32 s42, 0x400000
  s_mov_b32 s43, 0x20000
  s_mov_b32 s44, s64
  s_and_b32 s45, s65, 0xffff
  s_mov_b32 s46, 0x400000
  s_mov_b32 s47, 0x20000
  s_mov_b32 s48, s66
  s_and_b32 s49, s67, 0xffff
  s_mov_b32 s50, 0x400000
  s_mov_b32 s51, 0x20000
  s_mov_b32 s4, s70
  s_and_b32 s5, s71, 0xffff
  s_mov_b32 s6, 0x10000000
  s_mov_b32 s7, 0x20000
  s_mov_b32 s76, s72
  s_and_b32 s77, s73, 0xffff
  s_mov_b32 s78, 0x2000
  s_mov_b32 s79, 0x20000
  s_mov_b32 s72, s68
  s_and_b32 s73, s69, 0xffff
  s_mov_b32 s74, 0x100
  s_mov_b32 s75, 0x20000
  s_mov_b64 s[52:53], s[68:69]
  s_mov_b64 s[58:59], s[70:71]
  s_mul_i32 s99, s12, 896
  s_add_u32 s99, s99, 148898048
  s_lshl_b32 s15, s12, 7
  s_add_u32 s15, s15, 148926464
  v_lshrrev_b32 v21, 4, v20
  v_and_b32 v22, 15, v20
  v_and_b32 v23, 1, v21
  v_lshrrev_b32 v24, 1, v21
  v_lshlrev_b32 v2, 4, v20
  s_lshl_b32 s36, s13, 10
  v_add_u32 v59, s36, v2
  s_lshl_b32 s37, s13, 15
  s_add_u32 s37, s37, 32768
  v_add_u32 v4, s37, v2
  v_lshrrev_b32 v25, 2, v20
  v_lshlrev_b32 v25, 13, v25
  v_and_b32 v1, 3, v20
  v_lshl_add_u32 v25, v1, 4, v25
  s_lshl_b32 s36, s13, 6
  s_lshl_b32 s38, s12, 8
  s_add_u32 s36, s36, s38
  v_add_u32 v25, s36, v25
  v_lshrrev_b32 v26, 3, v20
  v_lshlrev_b32 v26, 10, v26
  v_and_b32 v1, 7, v20
  v_lshl_add_u32 v26, v1, 4, v26
  s_lshl_b32 s36, s13, 7
  s_lshl_b32 s38, s12, 17
  s_add_u32 s36, s36, s38
  v_add_u32 v26, s36, v26
  v_bfe_u32 v29, v20, 2, 1
  v_bfe_u32 v30, v20, 3, 1
  v_and_b32 v31, 3, v20
  v_lshl_add_u32 v27, v21, 2, v29
  v_lshlrev_b32 v27, 6, v27
  v_lshl_add_u32 v27, v30, 5, v27
  v_lshl_add_u32 v27, v31, 3, v27
  v_add_u32 v27, s37, v27
  v_xor_b32 v36, 1, v30
  v_lshl_add_u32 v36, v36, 11, v27
  v_lshl_add_u32 v27, v30, 11, v27
  v_lshl_add_u32 v28, v23, 2, v24
  v_lshl_add_u32 v28, v28, 2, v29
  v_lshlrev_b32 v28, 7, v28
  v_lshl_add_u32 v28, v30, 6, v28
  v_lshl_add_u32 v28, v31, 4, v28
  v_add_u32 v28, s37, v28
  s_mov_b32 s39, s37
  s_xor_b32 s36, s13, 0
  s_lshl_b32 s36, s36, 15
  s_add_u32 m0, s39, 0
  s_add_u32 s37, s36, 0
  buffer_load_dwordx4 v26, s[48:51], s37 offen lds
  s_add_u32 m0, s39, 1024
  s_add_u32 s37, s36, 8192
  buffer_load_dwordx4 v26, s[48:51], s37 offen lds
  s_add_u32 m0, s39, 2048
  s_add_u32 s37, s36, 16384
  buffer_load_dwordx4 v26, s[48:51], s37 offen lds
  s_add_u32 m0, s39, 3072
  s_add_u32 s37, s36, 24576
  buffer_load_dwordx4 v26, s[48:51], s37 offen lds
  s_xor_b32 s36, s13, 0
  s_lshl_b32 s36, s36, 15
  s_add_u32 m0, s39, 4096
  s_add_u32 s37, s36, 512
  buffer_load_dwordx4 v26, s[48:51], s37 offen lds
  s_add_u32 m0, s39, 5120
  s_add_u32 s37, s36, 8704
  buffer_load_dwordx4 v26, s[48:51], s37 offen lds
  s_add_u32 m0, s39, 6144
  s_add_u32 s37, s36, 16896
  buffer_load_dwordx4 v26, s[48:51], s37 offen lds
  s_add_u32 m0, s39, 7168
  s_add_u32 s37, s36, 25088
  buffer_load_dwordx4 v26, s[48:51], s37 offen lds
  v_mov_b32 v0, 0x4444
  v_mov_b32 v1, 0xeeee
  v_cmp_lt_u32 vcc, 7, v22
  s_nop 1
  v_cndmask_b32 v32, v0, v1, vcc
  v_mov_b32 v0, v32
  v_and_b32 v32, 7, v20
  v_lshlrev_b32 v32, 4, v32
  v_lshl_add_u32 v11, v21, 7, v32
  v_xor_b32 v1, 128, v2
  v_lshl_add_u32 v33, v24, 4, v22
  s_lshl_b32 s36, s13, 5
  v_add_u32 v33, s36, v33
  v_lshlrev_b32 v33, 3, v33
  v_mul_u32_u24 v34, 1152, v23
  v_add_u32 v5, v33, v34
  v_bfe_u32 v33, v20, 2, 2
  v_lshl_add_u32 v33, v23, 2, v33
  v_lshl_add_u32 v33, v24, 4, v33
  v_lshlrev_b32 v33, 3, v33
  v_and_b32 v34, 1, v20
  v_mul_u32_u24 v34, 1152, v34
  v_add_u32 v6, v33, v34
  s_lshl_b32 s36, s13, 3
  v_lshrrev_b32 v33, 3, v20
  v_add_u32 v33, s36, v33
  v_mul_u32_u24 v34, 0, v33
  v_add_u32 v34, s12, v34
  v_and_b32 v34, 31, v34
  v_lshrrev_b32 v37, 1, v32
  v_lshl_add_u32 v33, v33, 13, v37
  v_lshl_add_u32 v7, v34, 7, v33
  v_and_b32 v37, 1, v20
  v_bfe_u32 v38, v20, 1, 1
  v_lshl_add_u32 v37, v29, 1, v37
  s_lshr_b32 s36, s12, 3
  s_lshl_b32 s36, s36, 10
  s_and_b32 s37, s12, 1
  s_lshl_b32 s37, s37, 9
  s_add_u32 s36, s36, s37
  s_and_b32 s37, s12, 6
  s_lshl_b32 s37, s37, 5
  s_add_u32 s36, s36, s37
  v_lshlrev_b32 v33, 4, v21
  v_lshl_add_u32 v33, v37, 2, v33
  v_lshl_add_u32 v33, v38, 8, v33
  v_lshl_add_u32 v33, v30, 30, v33
  v_add_u32 v8, s36, v33
  v_mov_b32 v3, v2
  v_mov_b32 v39, v21
  s_lshr_b32 s36, s12, 2
  s_lshl_b32 s36, s36, 6
  s_and_b32 s37, s12, 1
  s_lshl_b32 s37, s37, 5
  s_add_u32 s36, s36, s37
  s_and_b32 s37, s12, 2
  s_lshl_b32 s37, s37, 11
  s_add_u32 s36, s36, s37
  v_lshlrev_b32 v35, 10, v39
  v_lshl_add_u32 v35, v37, 2, v35
  v_lshl_add_u32 v35, v38, 4, v35
  v_add_u32 v35, s36, v35
  buffer_load_ushort v44, v35, s[76:79], 0 offen offset:0
  buffer_load_ushort v45, v35, s[76:79], 0 offen offset:2
  buffer_load_ushort v46, v35, s[76:79], 0 offen offset:512
  buffer_load_ushort v47, v35, s[76:79], 0 offen offset:514
  v_lshlrev_b32 v33, 4, v29
  v_mov_b32 v34, 0x3f80
  v_lshlrev_b32 v33, v33, v34
  v_and_b32 v34, 1, v20
  v_lshl_add_u32 v34, v34, 1, v30
  v_cmp_eq_u32 vcc, 0, v34
  s_nop 1
  v_cndmask_b32 v48, 0, v33, vcc
  v_cmp_eq_u32 vcc, 1, v34
  s_nop 1
  v_cndmask_b32 v49, 0, v33, vcc
  v_cmp_eq_u32 vcc, 2, v34
  s_nop 1
  v_cndmask_b32 v50, 0, v33, vcc
  v_cmp_eq_u32 vcc, 3, v34
  s_nop 1
  v_cndmask_b32 v51, 0, v33, vcc
  ds_write_b128 v2, v[48:51] offset:31232
  v_lshlrev_b32 v33, 9, v21
  s_lshl_b32 s36, s13, 11
  v_add_u32 v33, s36, v33
  v_lshl_add_u32 v10, v22, 4, v33
  v_lshl_add_u32 v33, v30, 8, v33
  v_add_u32 v9, v33, v32
  v_mov_b32 v12, 0x3f803f80
  v_mov_b32 v13, 0x3f803f80
  v_mov_b32 v14, 0x3f803f80
  v_mov_b32 v15, 0x3f803f80
  s_mov_b32 s2, 0x3f803f80
  s_mov_b32 s3, 0x3f803f80
  s_mov_b32 s98, 0
  v_and_b32 v33, 1, v20
  v_mul_u32_u24 v33, 128, v33
  v_min_u32 v34, 1, v20
  v_lshlrev_b32 v34, 30, v34
  s_cmp_eq_u32 s13, 3
  s_cselect_b64 vcc, -1, 0
  v_cndmask_b32 v19, v34, v33, vcc
  v_mov_b64 v[60:61], 0
  v_mov_b32 v62, 32256
  ds_write_b64 v62, v[60:61]
  s_mov_b32 s16, 0
  s_mov_b32 s17, -1
  s_mov_b32 s18, 0x3e0293ee
  s_mov_b32 s54, 0x2f800000
  s_mov_b32 s55, 0x28000000
  s_lshl_b32 s36, s13, 10
  s_add_u32 s31, s36, 8192
  s_add_u32 s32, s36, 12160
  s_add_u32 s33, s36, 16384
  s_add_u32 s34, s36, 20224
  s_lshl_b32 s36, s12, 19
  s_add_u32 s27, s36, 67108864
  s_add_u32 s28, s36, 83886080
  s_mul_i32 s36, s12, 4096
  s_add_u32 s29, s36, 135266304
  s_lshl_b32 s36, s12, 13
  s_add_u32 s22, s36, 144703488
  s_add_u32 s23, s36, 144707584
  s_mov_b32 s20, 144703488
  s_mov_b32 s21, 144707584
  v_mov_b32 v40, -1
  v_mov_b32 v41, -1
  v_mov_b32 v42, -1
  v_mov_b32 v43, -1
  s_lshl_b32 s36, s13, 13
  s_add_u32 s36, s36, 145752064
  s_add_u32 s37, s36, 4096
  buffer_store_dwordx4 v[40:43], v59, s[4:7], s22 offen sc1
  buffer_store_dwordx4 v[40:43], v59, s[4:7], s23 offen sc1
  buffer_store_dword v40, v8, s[4:7], s36 offen sc1
  buffer_store_dword v40, v8, s[4:7], s37 offen sc1
  v_mov_b32 v52, 0
  v_min_u32 v53, 1, v59
  v_lshlrev_b32 v53, 30, v53
  buffer_store_dword v52, v53, s[4:7], s15 offen sc1
  s_xor_b32 s36, s13, 1
  s_lshl_b32 s36, s36, 15
  s_add_u32 m0, s39, 8192
  s_add_u32 s37, s36, 0
  buffer_load_dwordx4 v26, s[48:51], s37 offen lds
  s_add_u32 m0, s39, 9216
  s_add_u32 s37, s36, 8192
  buffer_load_dwordx4 v26, s[48:51], s37 offen lds
  s_add_u32 m0, s39, 10240
  s_add_u32 s37, s36, 16384
  buffer_load_dwordx4 v26, s[48:51], s37 offen lds
  s_add_u32 m0, s39, 11264
  s_add_u32 s37, s36, 24576
  buffer_load_dwordx4 v26, s[48:51], s37 offen lds
  s_xor_b32 s36, s13, 1
  s_lshl_b32 s36, s36, 15
  s_add_u32 m0, s39, 12288
  s_add_u32 s37, s36, 512
  buffer_load_dwordx4 v26, s[48:51], s37 offen lds
  s_add_u32 m0, s39, 13312
  s_add_u32 s37, s36, 8704
  buffer_load_dwordx4 v26, s[48:51], s37 offen lds
  s_add_u32 m0, s39, 14336
  s_add_u32 s37, s36, 16896
  buffer_load_dwordx4 v26, s[48:51], s37 offen lds
  s_add_u32 m0, s39, 15360
  s_add_u32 s37, s36, 25088
  buffer_load_dwordx4 v26, s[48:51], s37 offen lds
  s_waitcnt vmcnt(21)
  ds_read_b64_tr_b16 a[160:161], v28 offset:0
  ds_read_b64_tr_b16 a[162:163], v28 offset:256
  ds_read_b64_tr_b16 a[164:165], v28 offset:1024
  ds_read_b64_tr_b16 a[166:167], v28 offset:1280
  ds_read_b64_tr_b16 a[168:169], v28 offset:8
  ds_read_b64_tr_b16 a[170:171], v28 offset:264
  ds_read_b64_tr_b16 a[172:173], v28 offset:1032
  ds_read_b64_tr_b16 a[174:175], v28 offset:1288
  s_waitcnt lgkmcnt(0)
  s_xor_b32 s36, s13, 2
  s_lshl_b32 s36, s36, 15
  s_add_u32 m0, s39, 0
  s_add_u32 s37, s36, 0
  buffer_load_dwordx4 v26, s[48:51], s37 offen lds
  s_add_u32 m0, s39, 1024
  s_add_u32 s37, s36, 8192
  buffer_load_dwordx4 v26, s[48:51], s37 offen lds
  s_add_u32 m0, s39, 2048
  s_add_u32 s37, s36, 16384
  buffer_load_dwordx4 v26, s[48:51], s37 offen lds
  s_add_u32 m0, s39, 3072
  s_add_u32 s37, s36, 24576
  buffer_load_dwordx4 v26, s[48:51], s37 offen lds
  s_waitcnt vmcnt(21)
  ds_read_b64_tr_b16 a[176:177], v28 offset:4096
  ds_read_b64_tr_b16 a[178:179], v28 offset:4352
  ds_read_b64_tr_b16 a[180:181], v28 offset:5120
  ds_read_b64_tr_b16 a[182:183], v28 offset:5376
  ds_read_b64_tr_b16 a[184:185], v28 offset:4104
  ds_read_b64_tr_b16 a[186:187], v28 offset:4360
  ds_read_b64_tr_b16 a[188:189], v28 offset:5128
  ds_read_b64_tr_b16 a[190:191], v28 offset:5384
  s_waitcnt lgkmcnt(0)
  s_xor_b32 s36, s13, 3
  s_lshl_b32 s36, s36, 15
  s_add_u32 m0, s39, 4096
  s_add_u32 s37, s36, 0
  buffer_load_dwordx4 v26, s[48:51], s37 offen lds
  s_add_u32 m0, s39, 5120
  s_add_u32 s37, s36, 8192
  buffer_load_dwordx4 v26, s[48:51], s37 offen lds
  s_add_u32 m0, s39, 6144
  s_add_u32 s37, s36, 16384
  buffer_load_dwordx4 v26, s[48:51], s37 offen lds
  s_add_u32 m0, s39, 7168
  s_add_u32 s37, s36, 24576
  buffer_load_dwordx4 v26, s[48:51], s37 offen lds
  s_waitcnt vmcnt(12)
  ds_read_b64_tr_b16 a[192:193], v28 offset:8192
  ds_read_b64_tr_b16 a[194:195], v28 offset:8448
  ds_read_b64_tr_b16 a[196:197], v28 offset:9216
  ds_read_b64_tr_b16 a[198:199], v28 offset:9472
  ds_read_b64_tr_b16 a[200:201], v28 offset:8200
  ds_read_b64_tr_b16 a[202:203], v28 offset:8456
  ds_read_b64_tr_b16 a[204:205], v28 offset:9224
  ds_read_b64_tr_b16 a[206:207], v28 offset:9480
  s_waitcnt lgkmcnt(0)
  s_xor_b32 s36, s13, 2
  s_lshl_b32 s36, s36, 19
  s_add_u32 m0, s39, 8192
  s_add_u32 s37, s36, 0
  buffer_load_dwordx4 v25, s[8:11], s37 offen lds
  s_add_u32 m0, s39, 9216
  s_add_u32 s37, s36, 131072
  buffer_load_dwordx4 v25, s[8:11], s37 offen lds
  s_add_u32 m0, s39, 10240
  s_add_u32 s37, s36, 262144
  buffer_load_dwordx4 v25, s[8:11], s37 offen lds
  s_add_u32 m0, s39, 11264
  s_add_u32 s37, s36, 393216
  buffer_load_dwordx4 v25, s[8:11], s37 offen lds
  s_barrier
  s_cmp_lg_u32 s13, 0
  s_cbranch_scc1 T_arm_81
  s_getreg_b32 s36, hwreg(HW_REG_XCC_ID, 0, 3)
  s_lshl_b32 s36, s36, 3
  s_lshl_b64 s[60:61], 1, s36
  s_mov_b32 s62, 1
  s_atomic_add_x2 s[60:61], s[52:53], 0
  s_atomic_add s62, s[52:53], 128
  v_lshl_or_b32 v44, v45, 16, v44
  v_lshl_or_b32 v46, v47, 16, v46
  v_min_u32 v44, -2, v44
  v_min_u32 v46, -2, v46
  s_mov_b32 s36, 145752064
  s_mov_b32 s37, 145756160
  buffer_store_dword v44, v8, s[4:7], s36 offen sc1
  buffer_store_dword v46, v8, s[4:7], s37 offen sc1
T_arm_81:
  s_waitcnt vmcnt(12)
  ds_read_b64_tr_b16 a[208:209], v28 offset:12288
  ds_read_b64_tr_b16 a[210:211], v28 offset:12544
  ds_read_b64_tr_b16 a[212:213], v28 offset:13312
  ds_read_b64_tr_b16 a[214:215], v28 offset:13568
  ds_read_b64_tr_b16 a[216:217], v28 offset:12296
  ds_read_b64_tr_b16 a[218:219], v28 offset:12552
  ds_read_b64_tr_b16 a[220:221], v28 offset:13320
  ds_read_b64_tr_b16 a[222:223], v28 offset:13576
  s_waitcnt lgkmcnt(0)
  s_xor_b32 s36, s13, 3
  s_lshl_b32 s36, s36, 19
  s_add_u32 m0, s39, 12288
  s_add_u32 s37, s36, 0
  buffer_load_dwordx4 v25, s[8:11], s37 offen lds
  s_add_u32 m0, s39, 13312
  s_add_u32 s37, s36, 131072
  buffer_load_dwordx4 v25, s[8:11], s37 offen lds
  s_add_u32 m0, s39, 14336
  s_add_u32 s37, s36, 262144
  buffer_load_dwordx4 v25, s[8:11], s37 offen lds
  s_add_u32 m0, s39, 15360
  s_add_u32 s37, s36, 393216
  buffer_load_dwordx4 v25, s[8:11], s37 offen lds
  s_waitcnt vmcnt(12)
  ds_read_b64_tr_b16 a[224:225], v28 offset:0
  ds_read_b64_tr_b16 a[226:227], v28 offset:256
  ds_read_b64_tr_b16 a[228:229], v28 offset:1024
  ds_read_b64_tr_b16 a[230:231], v28 offset:1280
  ds_read_b64_tr_b16 a[232:233], v28 offset:8
  ds_read_b64_tr_b16 a[234:235], v28 offset:264
  ds_read_b64_tr_b16 a[236:237], v28 offset:1032
  ds_read_b64_tr_b16 a[238:239], v28 offset:1288
  s_waitcnt lgkmcnt(0)
  s_xor_b32 s36, s13, 4
  s_lshl_b32 s36, s36, 19
  s_add_u32 m0, s39, 0
  s_add_u32 s37, s36, 0
  buffer_load_dwordx4 v25, s[8:11], s37 offen lds
  s_add_u32 m0, s39, 1024
  s_add_u32 s37, s36, 131072
  buffer_load_dwordx4 v25, s[8:11], s37 offen lds
  s_add_u32 m0, s39, 2048
  s_add_u32 s37, s36, 262144
  buffer_load_dwordx4 v25, s[8:11], s37 offen lds
  s_add_u32 m0, s39, 3072
  s_add_u32 s37, s36, 393216
  buffer_load_dwordx4 v25, s[8:11], s37 offen lds
  s_waitcnt vmcnt(12)
  ds_read_b64_tr_b16 a[240:241], v28 offset:4096
  ds_read_b64_tr_b16 a[242:243], v28 offset:4352
  ds_read_b64_tr_b16 a[244:245], v28 offset:5120
  ds_read_b64_tr_b16 a[246:247], v28 offset:5376
  ds_read_b64_tr_b16 a[248:249], v28 offset:4104
  ds_read_b64_tr_b16 a[250:251], v28 offset:4360
  ds_read_b64_tr_b16 a[252:253], v28 offset:5128
  ds_read_b64_tr_b16 a[254:255], v28 offset:5384
  s_waitcnt lgkmcnt(0)
  s_xor_b32 s36, s13, 5
  s_lshl_b32 s36, s36, 19
  s_add_u32 m0, s39, 4096
  s_add_u32 s37, s36, 0
  buffer_load_dwordx4 v25, s[8:11], s37 offen lds
  s_add_u32 m0, s39, 5120
  s_add_u32 s37, s36, 131072
  buffer_load_dwordx4 v25, s[8:11], s37 offen lds
  s_add_u32 m0, s39, 6144
  s_add_u32 s37, s36, 262144
  buffer_load_dwordx4 v25, s[8:11], s37 offen lds
  s_add_u32 m0, s39, 7168
  s_add_u32 s37, s36, 393216
  buffer_load_dwordx4 v25, s[8:11], s37 offen lds
  s_waitcnt vmcnt(12)
  ds_read_b64_tr_b16 v[160:161], v27 offset:8192
  ds_read_b64_tr_b16 v[162:163], v27 offset:8320
  ds_read_b64_tr_b16 v[164:165], v27 offset:9216
  ds_read_b64_tr_b16 v[166:167], v27 offset:9344
  ds_read_b64_tr_b16 v[168:169], v36 offset:8192
  ds_read_b64_tr_b16 v[170:171], v36 offset:8320
  ds_read_b64_tr_b16 v[172:173], v36 offset:9216
  ds_read_b64_tr_b16 v[174:175], v36 offset:9344
  s_waitcnt lgkmcnt(0)
  s_xor_b32 s36, s13, 4
  s_lshl_b32 s36, s36, 19
  s_add_u32 m0, s39, 8192
  s_add_u32 s37, s36, 0
  buffer_load_dwordx4 v25, s[40:43], s37 offen lds
  s_add_u32 m0, s39, 9216
  s_add_u32 s37, s36, 131072
  buffer_load_dwordx4 v25, s[40:43], s37 offen lds
  s_add_u32 m0, s39, 10240
  s_add_u32 s37, s36, 262144
  buffer_load_dwordx4 v25, s[40:43], s37 offen lds
  s_add_u32 m0, s39, 11264
  s_add_u32 s37, s36, 393216
  buffer_load_dwordx4 v25, s[40:43], s37 offen lds
  s_waitcnt vmcnt(12)
  ds_read_b64_tr_b16 v[192:193], v27 offset:12288
  ds_read_b64_tr_b16 v[194:195], v27 offset:12416
  ds_read_b64_tr_b16 v[196:197], v27 offset:13312
  ds_read_b64_tr_b16 v[198:199], v27 offset:13440
  ds_read_b64_tr_b16 v[200:201], v36 offset:12288
  ds_read_b64_tr_b16 v[202:203], v36 offset:12416
  ds_read_b64_tr_b16 v[204:205], v36 offset:13312
  ds_read_b64_tr_b16 v[206:207], v36 offset:13440
  s_waitcnt lgkmcnt(0)
  s_xor_b32 s36, s13, 5
  s_lshl_b32 s36, s36, 19
  s_add_u32 m0, s39, 12288
  s_add_u32 s37, s36, 0
  buffer_load_dwordx4 v25, s[40:43], s37 offen lds
  s_add_u32 m0, s39, 13312
  s_add_u32 s37, s36, 131072
  buffer_load_dwordx4 v25, s[40:43], s37 offen lds
  s_add_u32 m0, s39, 14336
  s_add_u32 s37, s36, 262144
  buffer_load_dwordx4 v25, s[40:43], s37 offen lds
  s_add_u32 m0, s39, 15360
  s_add_u32 s37, s36, 393216
  buffer_load_dwordx4 v25, s[40:43], s37 offen lds
  s_waitcnt vmcnt(12)
  ds_read_b64_tr_b16 v[224:225], v27 offset:0
  ds_read_b64_tr_b16 v[226:227], v27 offset:128
  ds_read_b64_tr_b16 v[228:229], v27 offset:1024
  ds_read_b64_tr_b16 v[230:231], v27 offset:1152
  ds_read_b64_tr_b16 v[232:233], v36 offset:0
  ds_read_b64_tr_b16 v[234:235], v36 offset:128
  ds_read_b64_tr_b16 v[236:237], v36 offset:1024
  ds_read_b64_tr_b16 v[238:239], v36 offset:1152
  s_waitcnt lgkmcnt(0)
  s_xor_b32 s36, s13, 4
  s_lshl_b32 s36, s36, 19
  s_add_u32 m0, s39, 0
  s_add_u32 s37, s36, 0
  buffer_load_dwordx4 v25, s[44:47], s37 offen lds
  s_add_u32 m0, s39, 1024
  s_add_u32 s37, s36, 131072
  buffer_load_dwordx4 v25, s[44:47], s37 offen lds
  s_add_u32 m0, s39, 2048
  s_add_u32 s37, s36, 262144
  buffer_load_dwordx4 v25, s[44:47], s37 offen lds
  s_add_u32 m0, s39, 3072
  s_add_u32 s37, s36, 393216
  buffer_load_dwordx4 v25, s[44:47], s37 offen lds
  s_waitcnt vmcnt(12)
  ds_read_b64_tr_b16 a[16:17], v27 offset:4096
  ds_read_b64_tr_b16 a[18:19], v27 offset:4224
  ds_read_b64_tr_b16 a[20:21], v27 offset:5120
  ds_read_b64_tr_b16 a[22:23], v27 offset:5248
  ds_read_b64_tr_b16 a[24:25], v36 offset:4096
  ds_read_b64_tr_b16 a[26:27], v36 offset:4224
  ds_read_b64_tr_b16 a[28:29], v36 offset:5120
  ds_read_b64_tr_b16 a[30:31], v36 offset:5248
  s_waitcnt lgkmcnt(0)
  s_xor_b32 s36, s13, 5
  s_lshl_b32 s36, s36, 19
  s_add_u32 m0, s39, 4096
  s_add_u32 s37, s36, 0
  buffer_load_dwordx4 v25, s[44:47], s37 offen lds
  s_add_u32 m0, s39, 5120
  s_add_u32 s37, s36, 131072
  buffer_load_dwordx4 v25, s[44:47], s37 offen lds
  s_add_u32 m0, s39, 6144
  s_add_u32 s37, s36, 262144
  buffer_load_dwordx4 v25, s[44:47], s37 offen lds
  s_add_u32 m0, s39, 7168
  s_add_u32 s37, s36, 393216
  buffer_load_dwordx4 v25, s[44:47], s37 offen lds
  s_waitcnt vmcnt(12)
  ds_read_b64_tr_b16 v[240:241], v27 offset:8192
  ds_read_b64_tr_b16 v[242:243], v27 offset:8320
  ds_read_b64_tr_b16 v[244:245], v27 offset:9216
  ds_read_b64_tr_b16 v[246:247], v27 offset:9344
  ds_read_b64_tr_b16 v[248:249], v36 offset:8192
  ds_read_b64_tr_b16 v[250:251], v36 offset:8320
  ds_read_b64_tr_b16 v[252:253], v36 offset:9216
  ds_read_b64_tr_b16 v[254:255], v36 offset:9344
  s_waitcnt lgkmcnt(0)
  s_xor_b32 s36, s13, 6
  s_lshl_b32 s36, s36, 19
  s_add_u32 m0, s39, 8192
  s_add_u32 s37, s36, 0
  buffer_load_dwordx4 v25, s[8:11], s37 offen lds
  s_add_u32 m0, s39, 9216
  s_add_u32 s37, s36, 131072
  buffer_load_dwordx4 v25, s[8:11], s37 offen lds
  s_add_u32 m0, s39, 10240
  s_add_u32 s37, s36, 262144
  buffer_load_dwordx4 v25, s[8:11], s37 offen lds
  s_add_u32 m0, s39, 11264
  s_add_u32 s37, s36, 393216
  buffer_load_dwordx4 v25, s[8:11], s37 offen lds
  s_waitcnt vmcnt(12)
  ds_read_b64_tr_b16 a[32:33], v27 offset:12288
  ds_read_b64_tr_b16 a[34:35], v27 offset:12416
  ds_read_b64_tr_b16 a[36:37], v27 offset:13312
  ds_read_b64_tr_b16 a[38:39], v27 offset:13440
  ds_read_b64_tr_b16 a[40:41], v36 offset:12288
  ds_read_b64_tr_b16 a[42:43], v36 offset:12416
  ds_read_b64_tr_b16 a[44:45], v36 offset:13312
  ds_read_b64_tr_b16 a[46:47], v36 offset:13440
  s_waitcnt lgkmcnt(0)
  s_xor_b32 s36, s13, 7
  s_lshl_b32 s36, s36, 19
  s_add_u32 m0, s39, 12288
  s_add_u32 s37, s36, 0
  buffer_load_dwordx4 v25, s[8:11], s37 offen lds
  s_add_u32 m0, s39, 13312
  s_add_u32 s37, s36, 131072
  buffer_load_dwordx4 v25, s[8:11], s37 offen lds
  s_add_u32 m0, s39, 14336
  s_add_u32 s37, s36, 262144
  buffer_load_dwordx4 v25, s[8:11], s37 offen lds
  s_add_u32 m0, s39, 15360
  s_add_u32 s37, s36, 393216
  buffer_load_dwordx4 v25, s[8:11], s37 offen lds
  s_waitcnt vmcnt(12)
  ds_read_b64_tr_b16 a[0:1], v27 offset:0
  ds_read_b64_tr_b16 a[2:3], v27 offset:128
  ds_read_b64_tr_b16 a[4:5], v27 offset:1024
  ds_read_b64_tr_b16 a[6:7], v27 offset:1152
  ds_read_b64_tr_b16 a[8:9], v36 offset:0
  ds_read_b64_tr_b16 a[10:11], v36 offset:128
  ds_read_b64_tr_b16 a[12:13], v36 offset:1024
  ds_read_b64_tr_b16 a[14:15], v36 offset:1152
  s_waitcnt lgkmcnt(0)
  s_xor_b32 s36, s13, 6
  s_lshl_b32 s36, s36, 19
  s_add_u32 m0, s39, 0
  s_add_u32 s37, s36, 0
  buffer_load_dwordx4 v25, s[40:43], s37 offen lds
  s_add_u32 m0, s39, 1024
  s_add_u32 s37, s36, 131072
  buffer_load_dwordx4 v25, s[40:43], s37 offen lds
  s_add_u32 m0, s39, 2048
  s_add_u32 s37, s36, 262144
  buffer_load_dwordx4 v25, s[40:43], s37 offen lds
  s_add_u32 m0, s39, 3072
  s_add_u32 s37, s36, 393216
  buffer_load_dwordx4 v25, s[40:43], s37 offen lds
  s_waitcnt vmcnt(12)
  ds_read_b64_tr_b16 a[48:49], v27 offset:4096
  ds_read_b64_tr_b16 a[50:51], v27 offset:4224
  ds_read_b64_tr_b16 a[52:53], v27 offset:5120
  ds_read_b64_tr_b16 a[54:55], v27 offset:5248
  ds_read_b64_tr_b16 a[56:57], v36 offset:4096
  ds_read_b64_tr_b16 a[58:59], v36 offset:4224
  ds_read_b64_tr_b16 a[60:61], v36 offset:5120
  ds_read_b64_tr_b16 a[62:63], v36 offset:5248
  s_waitcnt lgkmcnt(0)
  s_xor_b32 s36, s13, 7
  s_lshl_b32 s36, s36, 19
  s_add_u32 m0, s39, 4096
  s_add_u32 s37, s36, 0
  buffer_load_dwordx4 v25, s[40:43], s37 offen lds
  s_add_u32 m0, s39, 5120
  s_add_u32 s37, s36, 131072
  buffer_load_dwordx4 v25, s[40:43], s37 offen lds
  s_add_u32 m0, s39, 6144
  s_add_u32 s37, s36, 262144
  buffer_load_dwordx4 v25, s[40:43], s37 offen lds
  s_add_u32 m0, s39, 7168
  s_add_u32 s37, s36, 393216
  buffer_load_dwordx4 v25, s[40:43], s37 offen lds
  s_waitcnt vmcnt(12)
  ds_read_b64_tr_b16 a[64:65], v27 offset:8192
  ds_read_b64_tr_b16 a[66:67], v27 offset:8320
  ds_read_b64_tr_b16 a[68:69], v27 offset:9216
  ds_read_b64_tr_b16 a[70:71], v27 offset:9344
  ds_read_b64_tr_b16 a[72:73], v36 offset:8192
  ds_read_b64_tr_b16 a[74:75], v36 offset:8320
  ds_read_b64_tr_b16 a[76:77], v36 offset:9216
  ds_read_b64_tr_b16 a[78:79], v36 offset:9344
  s_waitcnt lgkmcnt(0)
  s_xor_b32 s36, s13, 6
  s_lshl_b32 s36, s36, 19
  s_add_u32 m0, s39, 8192
  s_add_u32 s37, s36, 0
  buffer_load_dwordx4 v25, s[44:47], s37 offen lds
  s_add_u32 m0, s39, 9216
  s_add_u32 s37, s36, 131072
  buffer_load_dwordx4 v25, s[44:47], s37 offen lds
  s_add_u32 m0, s39, 10240
  s_add_u32 s37, s36, 262144
  buffer_load_dwordx4 v25, s[44:47], s37 offen lds
  s_add_u32 m0, s39, 11264
  s_add_u32 s37, s36, 393216
  buffer_load_dwordx4 v25, s[44:47], s37 offen lds
  s_waitcnt vmcnt(12)
  ds_read_b64_tr_b16 a[112:113], v27 offset:12288
  ds_read_b64_tr_b16 a[114:115], v27 offset:12416
  ds_read_b64_tr_b16 a[116:117], v27 offset:13312
  ds_read_b64_tr_b16 a[118:119], v27 offset:13440
  ds_read_b64_tr_b16 a[120:121], v36 offset:12288
  ds_read_b64_tr_b16 a[122:123], v36 offset:12416
  ds_read_b64_tr_b16 a[124:125], v36 offset:13312
  ds_read_b64_tr_b16 a[126:127], v36 offset:13440
  s_waitcnt lgkmcnt(0)
  s_xor_b32 s36, s13, 7
  s_lshl_b32 s36, s36, 19
  s_add_u32 m0, s39, 12288
  s_add_u32 s37, s36, 0
  buffer_load_dwordx4 v25, s[44:47], s37 offen lds
  s_add_u32 m0, s39, 13312
  s_add_u32 s37, s36, 131072
  buffer_load_dwordx4 v25, s[44:47], s37 offen lds
  s_add_u32 m0, s39, 14336
  s_add_u32 s37, s36, 262144
  buffer_load_dwordx4 v25, s[44:47], s37 offen lds
  s_add_u32 m0, s39, 15360
  s_add_u32 s37, s36, 393216
  buffer_load_dwordx4 v25, s[44:47], s37 offen lds
  s_waitcnt vmcnt(12)
  ds_read_b64_tr_b16 a[80:81], v27 offset:0
  ds_read_b64_tr_b16 a[82:83], v27 offset:128
  ds_read_b64_tr_b16 a[84:85], v27 offset:1024
  ds_read_b64_tr_b16 a[86:87], v27 offset:1152
  ds_read_b64_tr_b16 a[88:89], v36 offset:0
  ds_read_b64_tr_b16 a[90:91], v36 offset:128
  ds_read_b64_tr_b16 a[92:93], v36 offset:1024
  ds_read_b64_tr_b16 a[94:95], v36 offset:1152
  s_waitcnt lgkmcnt(0)
  s_xor_b32 s36, s13, 1
  s_lshl_b32 s36, s36, 19
  s_add_u32 m0, s39, 16384
  s_add_u32 s37, s36, 0
  buffer_load_dwordx4 v25, s[8:11], s37 offen lds
  s_add_u32 m0, s39, 17408
  s_add_u32 s37, s36, 131072
  buffer_load_dwordx4 v25, s[8:11], s37 offen lds
  s_add_u32 m0, s39, 18432
  s_add_u32 s37, s36, 262144
  buffer_load_dwordx4 v25, s[8:11], s37 offen lds
  s_add_u32 m0, s39, 19456
  s_add_u32 s37, s36, 393216
  buffer_load_dwordx4 v25, s[8:11], s37 offen lds
  s_waitcnt vmcnt(12)
  ds_read_b64_tr_b16 a[128:129], v27 offset:4096
  ds_read_b64_tr_b16 a[130:131], v27 offset:4224
  ds_read_b64_tr_b16 a[132:133], v27 offset:5120
  ds_read_b64_tr_b16 a[134:135], v27 offset:5248
  ds_read_b64_tr_b16 a[136:137], v36 offset:4096
  ds_read_b64_tr_b16 a[138:139], v36 offset:4224
  ds_read_b64_tr_b16 a[140:141], v36 offset:5120
  ds_read_b64_tr_b16 a[142:143], v36 offset:5248
  s_waitcnt lgkmcnt(0)
  s_xor_b32 s36, s13, 0
  s_lshl_b32 s36, s36, 19
  s_add_u32 m0, s39, 0
  s_add_u32 s37, s36, 0
  buffer_load_dwordx4 v25, s[8:11], s37 offen lds
  s_add_u32 m0, s39, 1024
  s_add_u32 s37, s36, 131072
  buffer_load_dwordx4 v25, s[8:11], s37 offen lds
  s_add_u32 m0, s39, 2048
  s_add_u32 s37, s36, 262144
  buffer_load_dwordx4 v25, s[8:11], s37 offen lds
  s_add_u32 m0, s39, 3072
  s_add_u32 s37, s36, 393216
  buffer_load_dwordx4 v25, s[8:11], s37 offen lds
  s_waitcnt vmcnt(12)
  ds_read_b64_tr_b16 a[96:97], v27 offset:8192
  ds_read_b64_tr_b16 a[98:99], v27 offset:8320
  ds_read_b64_tr_b16 a[100:101], v27 offset:9216
  ds_read_b64_tr_b16 a[102:103], v27 offset:9344
  ds_read_b64_tr_b16 a[104:105], v36 offset:8192
  ds_read_b64_tr_b16 a[106:107], v36 offset:8320
  ds_read_b64_tr_b16 a[108:109], v36 offset:9216
  ds_read_b64_tr_b16 a[110:111], v36 offset:9344
  s_waitcnt lgkmcnt(0)
  s_xor_b32 s36, s13, 1
  s_lshl_b32 s36, s36, 19
  s_add_u32 m0, s39, 8192
  s_add_u32 s37, s36, 0
  buffer_load_dwordx4 v25, s[40:43], s37 offen lds
  s_add_u32 m0, s39, 9216
  s_add_u32 s37, s36, 131072
  buffer_load_dwordx4 v25, s[40:43], s37 offen lds
  s_add_u32 m0, s39, 10240
  s_add_u32 s37, s36, 262144
  buffer_load_dwordx4 v25, s[40:43], s37 offen lds
  s_add_u32 m0, s39, 11264
  s_add_u32 s37, s36, 393216
  buffer_load_dwordx4 v25, s[40:43], s37 offen lds
  s_waitcnt vmcnt(12)
  ds_read_b64_tr_b16 a[144:145], v27 offset:12288
  ds_read_b64_tr_b16 a[146:147], v27 offset:12416
  ds_read_b64_tr_b16 a[148:149], v27 offset:13312
  ds_read_b64_tr_b16 a[150:151], v27 offset:13440
  ds_read_b64_tr_b16 a[152:153], v36 offset:12288
  ds_read_b64_tr_b16 a[154:155], v36 offset:12416
  ds_read_b64_tr_b16 a[156:157], v36 offset:13312
  ds_read_b64_tr_b16 a[158:159], v36 offset:13440
  s_waitcnt lgkmcnt(0)
  s_xor_b32 s36, s13, 0
  s_lshl_b32 s36, s36, 19
  s_add_u32 m0, s39, 4096
  s_add_u32 s37, s36, 0
  buffer_load_dwordx4 v25, s[40:43], s37 offen lds
  s_add_u32 m0, s39, 5120
  s_add_u32 s37, s36, 131072
  buffer_load_dwordx4 v25, s[40:43], s37 offen lds
  s_add_u32 m0, s39, 6144
  s_add_u32 s37, s36, 262144
  buffer_load_dwordx4 v25, s[40:43], s37 offen lds
  s_add_u32 m0, s39, 7168
  s_add_u32 s37, s36, 393216
  buffer_load_dwordx4 v25, s[40:43], s37 offen lds
  s_waitcnt vmcnt(12)
  ds_read_b64_tr_b16 v[128:129], v27 offset:16384
  ds_read_b64_tr_b16 v[130:131], v27 offset:16512
  ds_read_b64_tr_b16 v[132:133], v27 offset:17408
  ds_read_b64_tr_b16 v[134:135], v27 offset:17536
  ds_read_b64_tr_b16 v[136:137], v36 offset:16384
  ds_read_b64_tr_b16 v[138:139], v36 offset:16512
  ds_read_b64_tr_b16 v[140:141], v36 offset:17408
  ds_read_b64_tr_b16 v[142:143], v36 offset:17536
  s_waitcnt lgkmcnt(0)
  s_xor_b32 s36, s13, 2
  s_lshl_b32 s36, s36, 19
  s_add_u32 m0, s39, 12288
  s_add_u32 s37, s36, 0
  buffer_load_dwordx4 v25, s[40:43], s37 offen lds
  s_add_u32 m0, s39, 13312
  s_add_u32 s37, s36, 131072
  buffer_load_dwordx4 v25, s[40:43], s37 offen lds
  s_add_u32 m0, s39, 14336
  s_add_u32 s37, s36, 262144
  buffer_load_dwordx4 v25, s[40:43], s37 offen lds
  s_add_u32 m0, s39, 15360
  s_add_u32 s37, s36, 393216
  buffer_load_dwordx4 v25, s[40:43], s37 offen lds
  s_waitcnt vmcnt(12)
  ds_read_b64_tr_b16 v[64:65], v27 offset:0
  ds_read_b64_tr_b16 v[66:67], v27 offset:128
  ds_read_b64_tr_b16 v[68:69], v27 offset:1024
  ds_read_b64_tr_b16 v[70:71], v27 offset:1152
  ds_read_b64_tr_b16 v[72:73], v36 offset:0
  ds_read_b64_tr_b16 v[74:75], v36 offset:128
  ds_read_b64_tr_b16 v[76:77], v36 offset:1024
  ds_read_b64_tr_b16 v[78:79], v36 offset:1152
  s_waitcnt lgkmcnt(0)
  ds_write_b128 v4, v[64:67] offset:0
  ds_write_b128 v4, v[68:71] offset:1024
  ds_write_b128 v4, v[72:75] offset:2048
  ds_write_b128 v4, v[76:79] offset:3072
  s_waitcnt lgkmcnt(0)
  s_xor_b32 s36, s13, 3
  s_lshl_b32 s36, s36, 19
  s_add_u32 m0, s39, 16384
  s_add_u32 s37, s36, 0
  buffer_load_dwordx4 v25, s[40:43], s37 offen lds
  s_add_u32 m0, s39, 17408
  s_add_u32 s37, s36, 131072
  buffer_load_dwordx4 v25, s[40:43], s37 offen lds
  s_add_u32 m0, s39, 18432
  s_add_u32 s37, s36, 262144
  buffer_load_dwordx4 v25, s[40:43], s37 offen lds
  s_add_u32 m0, s39, 19456
  s_add_u32 s37, s36, 393216
  buffer_load_dwordx4 v25, s[40:43], s37 offen lds
  s_waitcnt vmcnt(12)
  ds_read_b64_tr_b16 v[144:145], v27 offset:8192
  ds_read_b64_tr_b16 v[146:147], v27 offset:8320
  ds_read_b64_tr_b16 v[148:149], v27 offset:9216
  ds_read_b64_tr_b16 v[150:151], v27 offset:9344
  ds_read_b64_tr_b16 v[152:153], v36 offset:8192
  ds_read_b64_tr_b16 v[154:155], v36 offset:8320
  ds_read_b64_tr_b16 v[156:157], v36 offset:9216
  ds_read_b64_tr_b16 v[158:159], v36 offset:9344
  s_waitcnt lgkmcnt(0)
  s_xor_b32 s36, s13, 3
  s_lshl_b32 s36, s36, 19
  s_add_u32 m0, s39, 24576
  s_add_u32 s37, s36, 0
  buffer_load_dwordx4 v25, s[44:47], s37 offen lds
  s_add_u32 m0, s39, 25600
  s_add_u32 s37, s36, 131072
  buffer_load_dwordx4 v25, s[44:47], s37 offen lds
  s_add_u32 m0, s39, 26624
  s_add_u32 s37, s36, 262144
  buffer_load_dwordx4 v25, s[44:47], s37 offen lds
  s_add_u32 m0, s39, 27648
  s_add_u32 s37, s36, 393216
  buffer_load_dwordx4 v25, s[44:47], s37 offen lds
  buffer_load_dwordx2 v[54:55], off, s[72:75], 0 sc1
  buffer_load_dword v56, off, s[72:75], 0 offset:128 sc1
  s_waitcnt vmcnt(14)
  ds_read_b64_tr_b16 v[64:65], v27 offset:4096
  ds_read_b64_tr_b16 v[66:67], v27 offset:4224
  ds_read_b64_tr_b16 v[68:69], v27 offset:5120
  ds_read_b64_tr_b16 v[70:71], v27 offset:5248
  ds_read_b64_tr_b16 v[72:73], v36 offset:4096
  ds_read_b64_tr_b16 v[74:75], v36 offset:4224
  ds_read_b64_tr_b16 v[76:77], v36 offset:5120
  ds_read_b64_tr_b16 v[78:79], v36 offset:5248
  s_waitcnt lgkmcnt(0)
  ds_write_b128 v4, v[64:67] offset:4096
  ds_write_b128 v4, v[68:71] offset:5120
  ds_write_b128 v4, v[72:75] offset:6144
  ds_write_b128 v4, v[76:79] offset:7168
  s_waitcnt lgkmcnt(0)
  s_xor_b32 s36, s13, 2
  s_lshl_b32 s36, s36, 19
  s_add_u32 m0, s39, 20480
  s_add_u32 s37, s36, 0
  buffer_load_dwordx4 v25, s[44:47], s37 offen lds
  s_add_u32 m0, s39, 21504
  s_add_u32 s37, s36, 131072
  buffer_load_dwordx4 v25, s[44:47], s37 offen lds
  s_add_u32 m0, s39, 22528
  s_add_u32 s37, s36, 262144
  buffer_load_dwordx4 v25, s[44:47], s37 offen lds
  s_add_u32 m0, s39, 23552
  s_add_u32 s37, s36, 393216
  buffer_load_dwordx4 v25, s[44:47], s37 offen lds
  s_waitcnt vmcnt(14)
  ds_read_b64_tr_b16 v[176:177], v27 offset:12288
  ds_read_b64_tr_b16 v[178:179], v27 offset:12416
  ds_read_b64_tr_b16 v[180:181], v27 offset:13312
  ds_read_b64_tr_b16 v[182:183], v27 offset:13440
  ds_read_b64_tr_b16 v[184:185], v36 offset:12288
  ds_read_b64_tr_b16 v[186:187], v36 offset:12416
  ds_read_b64_tr_b16 v[188:189], v36 offset:13312
  ds_read_b64_tr_b16 v[190:191], v36 offset:13440
  s_waitcnt lgkmcnt(0)
  s_xor_b32 s36, s13, 0
  s_lshl_b32 s36, s36, 19
  s_add_u32 m0, s39, 8192
  s_add_u32 s37, s36, 0
  buffer_load_dwordx4 v25, s[44:47], s37 offen lds
  s_add_u32 m0, s39, 9216
  s_add_u32 s37, s36, 131072
  buffer_load_dwordx4 v25, s[44:47], s37 offen lds
  s_add_u32 m0, s39, 10240
  s_add_u32 s37, s36, 262144
  buffer_load_dwordx4 v25, s[44:47], s37 offen lds
  s_add_u32 m0, s39, 11264
  s_add_u32 s37, s36, 393216
  buffer_load_dwordx4 v25, s[44:47], s37 offen lds
  s_waitcnt vmcnt(14)
  ds_read_b64_tr_b16 v[64:65], v27 offset:16384
  ds_read_b64_tr_b16 v[66:67], v27 offset:16512
  ds_read_b64_tr_b16 v[68:69], v27 offset:17408
  ds_read_b64_tr_b16 v[70:71], v27 offset:17536
  ds_read_b64_tr_b16 v[72:73], v36 offset:16384
  ds_read_b64_tr_b16 v[74:75], v36 offset:16512
  ds_read_b64_tr_b16 v[76:77], v36 offset:17408
  ds_read_b64_tr_b16 v[78:79], v36 offset:17536
  s_waitcnt lgkmcnt(0)
  ds_write_b128 v4, v[64:67] offset:16384
  ds_write_b128 v4, v[68:71] offset:17408
  ds_write_b128 v4, v[72:75] offset:18432
  ds_write_b128 v4, v[76:79] offset:19456
  s_waitcnt lgkmcnt(0)
  s_xor_b32 s36, s13, 1
  s_lshl_b32 s36, s36, 19
  s_add_u32 m0, s39, 12288
  s_add_u32 s37, s36, 0
  buffer_load_dwordx4 v25, s[44:47], s37 offen lds
  s_add_u32 m0, s39, 13312
  s_add_u32 s37, s36, 131072
  buffer_load_dwordx4 v25, s[44:47], s37 offen lds
  s_add_u32 m0, s39, 14336
  s_add_u32 s37, s36, 262144
  buffer_load_dwordx4 v25, s[44:47], s37 offen lds
  s_add_u32 m0, s39, 15360
  s_add_u32 s37, s36, 393216
  buffer_load_dwordx4 v25, s[44:47], s37 offen lds
  s_waitcnt vmcnt(14)
  ds_read_b64_tr_b16 v[208:209], v27 offset:24576
  ds_read_b64_tr_b16 v[210:211], v27 offset:24704
  ds_read_b64_tr_b16 v[212:213], v27 offset:25600
  ds_read_b64_tr_b16 v[214:215], v27 offset:25728
  ds_read_b64_tr_b16 v[216:217], v36 offset:24576
  ds_read_b64_tr_b16 v[218:219], v36 offset:24704
  ds_read_b64_tr_b16 v[220:221], v36 offset:25600
  ds_read_b64_tr_b16 v[222:223], v36 offset:25728
  s_waitcnt lgkmcnt(0)
  s_xor_b32 s36, s13, 2
  s_lshl_b32 s36, s36, 15
  s_add_u32 m0, s39, 24576
  s_add_u32 s37, s36, 512
  buffer_load_dwordx4 v26, s[48:51], s37 offen lds
  s_add_u32 m0, s39, 25600
  s_add_u32 s37, s36, 8704
  buffer_load_dwordx4 v26, s[48:51], s37 offen lds
  s_add_u32 m0, s39, 26624
  s_add_u32 s37, s36, 16896
  buffer_load_dwordx4 v26, s[48:51], s37 offen lds
  s_add_u32 m0, s39, 27648
  s_add_u32 s37, s36, 25088
  buffer_load_dwordx4 v26, s[48:51], s37 offen lds
  s_waitcnt vmcnt(12)
  ds_read_b64_tr_b16 v[64:65], v27 offset:20480
  ds_read_b64_tr_b16 v[66:67], v27 offset:20608
  ds_read_b64_tr_b16 v[68:69], v27 offset:21504
  ds_read_b64_tr_b16 v[70:71], v27 offset:21632
  ds_read_b64_tr_b16 v[72:73], v36 offset:20480
  ds_read_b64_tr_b16 v[74:75], v36 offset:20608
  ds_read_b64_tr_b16 v[76:77], v36 offset:21504
  ds_read_b64_tr_b16 v[78:79], v36 offset:21632
  s_waitcnt lgkmcnt(0)
  ds_write_b128 v4, v[64:67] offset:20480
  ds_write_b128 v4, v[68:71] offset:21504
  ds_write_b128 v4, v[72:75] offset:22528
  ds_write_b128 v4, v[76:79] offset:23552
  s_waitcnt lgkmcnt(0)
  s_xor_b32 s36, s13, 3
  s_lshl_b32 s36, s36, 15
  s_add_u32 m0, s39, 28672
  s_add_u32 s37, s36, 512
  buffer_load_dwordx4 v26, s[48:51], s37 offen lds
  s_add_u32 m0, s39, 29696
  s_add_u32 s37, s36, 8704
  buffer_load_dwordx4 v26, s[48:51], s37 offen lds
  s_add_u32 m0, s39, 30720
  s_add_u32 s37, s36, 16896
  buffer_load_dwordx4 v26, s[48:51], s37 offen lds
  s_add_u32 m0, s39, 31744
  s_add_u32 s37, s36, 25088
  buffer_load_dwordx4 v26, s[48:51], s37 offen lds
  s_mov_b32 s19, 0
  s_branch T_arrgo_83
T_arr_82:
  s_add_u32 s19, s19, 1
  s_cmp_gt_u32 s19, 32768
  s_cbranch_scc1 M_exit
  buffer_load_dwordx2 v[54:55], off, s[72:75], 0 sc1
  buffer_load_dword v56, off, s[72:75], 0 offset:128 sc1
  s_waitcnt vmcnt(0)
T_arrgo_83:
  v_sad_u8 v57, v54, 0, 0
  v_sad_u8 v57, v55, 0, v57
  v_or_b32 v58, v54, v55
  v_cmp_gt_u32 vcc, 32, v57
  s_cbranch_vccnz T_arr_82
  v_cmp_gt_u32 vcc, 0x100, v56
  s_cbranch_vccnz T_arr_82
  v_readfirstlane_b32 s36, v58
  s_nop 0
  s_and_b32 s36, s36, 0x20202020
  s_cselect_b32 s56, 0, 1
  s_mov_b32 s14, -1
  s_mov_b32 s30, -1
  s_mov_b32 s19, 0
  s_branch T_kvok_85
T_kv_84:
  s_sleep 4
  s_add_u32 s19, s19, 1
  s_cmp_gt_u32 s19, 32768
  s_cbranch_scc1 M_exit
T_kvok_85:
  s_add_u32 s39, s99, 128
  s_mov_b32 s38, 0
  s_mov_b32 s37, 0
  s_atomic_or s38, s[58:59], s99 glc
  s_atomic_or s37, s[58:59], s39 glc
  s_waitcnt lgkmcnt(0)
  s_add_u32 s37, s37, 30
  s_cmp_ge_u32 s38, 30
  s_cselect_b32 s38, s37, s38
  s_cmp_ge_u32 s38, 64
  s_cselect_b32 s38, 100, s38
  s_sub_u32 s38, s38, 1
  s_max_i32 s30, s30, s38
  s_cmp_ge_i32 s14, s30
  s_cbranch_scc1 T_kv_84
  s_mov_b32 m0, s31
  s_nop 0
  buffer_load_dwordx4 v9, s[4:7], s27 offen sc1 lds
  s_mov_b32 m0, s32
  s_nop 0
  buffer_load_dwordx4 v9, s[4:7], s27 offen offset:128 sc1 lds
  s_mov_b32 m0, s33
  s_nop 0
  buffer_load_dwordx4 v10, s[4:7], s28 offen sc1 lds
  s_mov_b32 m0, s34
  s_nop 0
  buffer_load_dwordx4 v10, s[4:7], s28 offen offset:256 sc1 lds
  s_add_u32 s27, s27, 8192
  s_add_u32 s28, s28, 8192
  s_lshl_b32 s36, s12, 10
  s_add_u32 s36, s36, 145752064
  buffer_load_dwordx4 v[40:43], v2, s[4:7], s36 offen sc1
  s_waitcnt vmcnt(17)
  ds_read_b64_tr_b16 v[64:65], v27 offset:8192
  ds_read_b64_tr_b16 v[66:67], v27 offset:8320
  ds_read_b64_tr_b16 v[68:69], v27 offset:9216
  ds_read_b64_tr_b16 v[70:71], v27 offset:9344
  ds_read_b64_tr_b16 v[72:73], v36 offset:8192
  ds_read_b64_tr_b16 v[74:75], v36 offset:8320
  ds_read_b64_tr_b16 v[76:77], v36 offset:9216
  ds_read_b64_tr_b16 v[78:79], v36 offset:9344
  s_waitcnt lgkmcnt(0)
  ds_write_b128 v4, v[64:67] offset:8192
  ds_write_b128 v4, v[68:71] offset:9216
  ds_write_b128 v4, v[72:75] offset:10240
  ds_write_b128 v4, v[76:79] offset:11264
  s_waitcnt lgkmcnt(0)
  s_waitcnt vmcnt(13)
  ds_read_b64_tr_b16 v[64:65], v27 offset:12288
  ds_read_b64_tr_b16 v[66:67], v27 offset:12416
  ds_read_b64_tr_b16 v[68:69], v27 offset:13312
  ds_read_b64_tr_b16 v[70:71], v27 offset:13440
  ds_read_b64_tr_b16 v[72:73], v36 offset:12288
  ds_read_b64_tr_b16 v[74:75], v36 offset:12416
  ds_read_b64_tr_b16 v[76:77], v36 offset:13312
  ds_read_b64_tr_b16 v[78:79], v36 offset:13440
  s_waitcnt lgkmcnt(0)
  ds_write_b128 v4, v[64:67] offset:12288
  ds_write_b128 v4, v[68:71] offset:13312
  ds_write_b128 v4, v[72:75] offset:14336
  ds_write_b128 v4, v[76:79] offset:15360
  s_waitcnt lgkmcnt(0)
  s_waitcnt vmcnt(9)
  ds_read_b64_tr_b16 v[64:65], v28 offset:24576
  ds_read_b64_tr_b16 v[66:67], v28 offset:24832
  ds_read_b64_tr_b16 v[68:69], v28 offset:25600
  ds_read_b64_tr_b16 v[70:71], v28 offset:25856
  ds_read_b64_tr_b16 v[72:73], v28 offset:24584
  ds_read_b64_tr_b16 v[74:75], v28 offset:24840
  ds_read_b64_tr_b16 v[76:77], v28 offset:25608
  ds_read_b64_tr_b16 v[78:79], v28 offset:25864
  s_waitcnt lgkmcnt(0)
  ds_write_b128 v4, v[64:67] offset:24576
  ds_write_b128 v4, v[68:71] offset:25600
  ds_write_b128 v4, v[72:75] offset:26624
  ds_write_b128 v4, v[76:79] offset:27648
  s_waitcnt lgkmcnt(0)
  s_waitcnt vmcnt(5)
  ds_read_b64_tr_b16 v[64:65], v28 offset:28672
  ds_read_b64_tr_b16 v[66:67], v28 offset:28928
  ds_read_b64_tr_b16 v[68:69], v28 offset:29696
  ds_read_b64_tr_b16 v[70:71], v28 offset:29952
  ds_read_b64_tr_b16 v[72:73], v28 offset:28680
  ds_read_b64_tr_b16 v[74:75], v28 offset:28936
  ds_read_b64_tr_b16 v[76:77], v28 offset:29704
  ds_read_b64_tr_b16 v[78:79], v28 offset:29960
  s_waitcnt lgkmcnt(0)
  ds_write_b128 v4, v[64:67] offset:28672
  ds_write_b128 v4, v[68:71] offset:29696
  ds_write_b128 v4, v[72:75] offset:30720
  ds_write_b128 v4, v[76:79] offset:31744
  s_waitcnt lgkmcnt(0)
  s_mov_b32 s14, 1
  s_cmp_lt_i32 s14, s30
  s_cbranch_scc1 T_kv2_86
  s_mov_b32 s19, 0
  s_branch T_kvok_88
T_kv_87:
  s_sleep 4
  s_add_u32 s19, s19, 1
  s_cmp_gt_u32 s19, 32768
  s_cbranch_scc1 M_exit
T_kvok_88:
  s_add_u32 s39, s99, 128
  s_mov_b32 s38, 0
  s_mov_b32 s37, 0
  s_atomic_or s38, s[58:59], s99 glc
  s_atomic_or s37, s[58:59], s39 glc
  s_waitcnt lgkmcnt(0)
  s_add_u32 s37, s37, 30
  s_cmp_ge_u32 s38, 30
  s_cselect_b32 s38, s37, s38
  s_cmp_ge_u32 s38, 64
  s_cselect_b32 s38, 100, s38
  s_sub_u32 s38, s38, 1
  s_max_i32 s30, s30, s38
  s_cmp_ge_i32 s14, s30
  s_cbranch_scc1 T_kv_87
T_kv2_86:
  s_waitcnt vmcnt(0) lgkmcnt(0)
  s_barrier
  s_cmp_ge_u32 s13, 2
  s_cselect_b64 vcc, -1, 0
  v_cndmask_b32 v8, v8, v19, vcc
  ds_read_b128 v[68:71], v4 offset:0
  ds_read_b128 v[72:75], v4 offset:1024
  ds_read_b128 v[76:79], v4 offset:4096
  ds_read_b128 v[80:83], v4 offset:5120
  ds_read_b128 v[84:87], v4 offset:8192
  ds_read_b128 v[88:91], v4 offset:9216
  ds_read_b128 v[92:95], v4 offset:2048
  ds_read_b128 v[96:99], v4 offset:3072
  ds_read_b128 v[100:103], v4 offset:6144
  ds_read_b128 v[104:107], v4 offset:7168
  ds_read_b128 v[108:111], v4 offset:10240
  ds_read_b128 v[112:115], v4 offset:11264
  ds_read_b128 v[28:31], v59 offset:16384
  ds_read_b128 v[32:35], v59 offset:20480
  ds_read_b128 v[36:39], v2 offset:8192
  ds_read_b128 v[40:43], v2 offset:9216
  ds_read_b128 v[44:47], v2 offset:10240
  ds_read_b128 v[48:51], v2 offset:11264
  ds_read_b128 v[52:55], v2 offset:12288
  ds_read_b128 v[56:59], v2 offset:13312
  ds_read_b128 v[60:63], v2 offset:14336
  ds_read_b128 v[64:67], v2 offset:15360
  s_and_b32 s36, s13, 1
  s_lshl_b32 s36, s36, 12
  s_add_u32 s22, s22, s36
  s_add_u32 s23, s36, 145752064
  s_mov_b32 s14, -1
  s_and_b32 s57, s14, 1
  s_and_b32 s36, s14, 3
  s_lshl_b32 s36, s36, 13
  s_add_u32 s26, s36, s23
  s_add_u32 s36, s36, 8192
  s_and_b32 s36, s36, 0x7fff
  s_add_u32 s24, s36, 145752064
  s_add_u32 s25, s36, 145756160
  s_add_u32 s35, s36, s23
  s_waitcnt lgkmcnt(0)
  s_cmp_lg_u32 s56, 0
  s_cbranch_scc1 M_global
  s_cmp_eq_u32 s13, 1
  s_cbranch_scc1 T_w_90
  s_cmp_eq_u32 s13, 2
  s_cbranch_scc1 T_w_91
  s_cmp_eq_u32 s13, 3
  s_cbranch_scc1 T_w_92
T_w_89:
  s_mov_b32 s19, 0
  v_mov_b64 v[16:17], 0
  v_mov_b64 v[18:19], 0
  v_mov_b64 v[20:21], 0
  v_mov_b64 v[22:23], 0
  v_mov_b64 v[24:25], 0
  v_mov_b64 v[26:27], 0
  buffer_load_dwordx4 v[124:127], v3, s[4:7], s24 offen offset:0 sc1
  buffer_load_dwordx4 v[116:119], v3, s[4:7], s25 offen offset:0 sc1
  buffer_load_dwordx4 v[124:127], v3, s[4:7], s24 offen offset:0 sc1
  buffer_load_dwordx4 v[116:119], v3, s[4:7], s25 offen offset:0 sc1
  s_branch T_loop_93
.p2align 6
T_retry_94:
  s_mov_b64 exec, vcc
  buffer_load_dwordx4 v[124:127], v3, s[4:7], s24 offen offset:0 sc1
  buffer_load_dwordx4 v[116:119], v3, s[4:7], s25 offen offset:0 sc1
  s_mov_b64 exec, -1
  s_add_u32 s19, s19, 1
  s_cmp_gt_u32 s19, 32768
  s_cbranch_scc1 M_exit
T_loop_93:
  s_waitcnt vmcnt(3) lgkmcnt(0)
  v_max3_u32 v123, v124, v125, v126
  v_max_u32 v123, v123, v127
  v_mov_b32_dpp v120, v124 row_ror:8 row_mask:0xf bank_mask:0xf
  v_mov_b32_dpp v121, v125 row_ror:8 row_mask:0xf bank_mask:0xf
  s_waitcnt vmcnt(2)
  v_max3_u32 v123, v123, v116, v117
  v_max3_u32 v123, v123, v118, v119
  v_cmp_eq_u32 vcc, -1, v123
  s_cbranch_vccnz T_retry_94
  v_smfmac_f32_16x16x64_bf16 v[16:19], v[124:127], v[68:75], v0
  s_add_u32 s14, s14, 1
  ds_write_b128 v2, v[124:127] offset:0
  v_mov_b32_dpp v122, v126 row_ror:8 row_mask:0xf bank_mask:0xf
  v_smfmac_f32_16x16x64_bf16 v[20:23], v[124:127], v[76:83], v0
  s_and_b32 s57, s14, 1
  v_mov_b32_dpp v123, v127 row_ror:8 row_mask:0xf bank_mask:0xf
  v_smfmac_f32_16x16x64_bf16 v[24:27], v[124:127], v[84:91], v0
  s_and_b32 s36, s14, 3
  ds_write_b128 v2, v[116:119] offset:4096
  v_smfmac_f32_16x16x64_bf16 v[16:19], v[120:123], v[92:99], v0
  s_lshl_b32 s36, s36, 13
  v_mov_b32_dpp v84, v116 row_ror:8 row_mask:0xf bank_mask:0xf
  v_smfmac_f32_16x16x64_bf16 v[20:23], v[120:123], v[100:107], v0
  s_add_u32 s26, s36, s23
  ds_read_b128 v[68:71], v4 offset:12288
  v_mov_b32_dpp v85, v117 row_ror:8 row_mask:0xf bank_mask:0xf
  v_smfmac_f32_16x16x64_bf16 v[24:27], v[120:123], v[108:115], v0
  s_add_u32 s36, s36, 8192
  ds_read_b128 v[72:75], v4 offset:13312
  v_mov_b32_dpp v86, v118 row_ror:8 row_mask:0xf bank_mask:0xf
  v_smfmac_f32_16x16x64_bf16 v[16:19], v[116:119], v[224:231], v0
  s_and_b32 s36, s36, 0x7fff
  ds_read_b128 v[76:79], v4 offset:14336
  v_mov_b32_dpp v87, v119 row_ror:8 row_mask:0xf bank_mask:0xf
  v_smfmac_f32_16x16x64_bf16 v[20:23], v[116:119], v[240:247], v0
  s_waitcnt lgkmcnt(3)
  s_barrier
  ds_read_b128 v[100:103], v2 offset:1024
  v_smfmac_f32_16x16x64_bf16 v[24:27], v[116:119], a[0:7], v0
  s_mov_b32 m0, s31
  ds_read_b128 v[120:123], v1 offset:1024
  v_smfmac_f32_16x16x64_bf16 v[16:19], v[84:87], v[232:239], v0
  s_cmp_ge_i32 s14, s30
  s_cbranch_scc1 T_kvw_97
T_kvb_98:
  v_smfmac_f32_16x16x64_bf16 v[20:23], v[84:87], v[248:255], v0
  ds_read_b128 v[80:83], v4 offset:15360
  buffer_load_dwordx4 v9, s[4:7], s27 offen sc1 lds
  v_smfmac_f32_16x16x64_bf16 v[24:27], v[84:87], a[8:15], v0
  s_waitcnt lgkmcnt(2)
  s_mov_b32 m0, s32
  v_smfmac_f32_16x16x64_bf16 v[16:19], v[100:103], v[128:135], v0
  ds_read_b128 v[92:95], v2 offset:2048
  v_smfmac_f32_16x16x64_bf16 v[20:23], v[100:103], v[144:151], v0
  ds_read_b128 v[96:99], v1 offset:2048
  v_smfmac_f32_16x16x64_bf16 v[24:27], v[100:103], v[68:75], v0
  s_waitcnt vmcnt(1) lgkmcnt(3)
  ds_read_b128 v[116:119], v2 offset:3072
  buffer_load_dwordx4 v9, s[4:7], s27 offen offset:128 sc1 lds
  v_smfmac_f32_16x16x64_bf16 v[16:19], v[120:123], v[136:143], v0
  ds_read_b128 v[124:127], v1 offset:3072
  s_mov_b32 m0, s33
  v_smfmac_f32_16x16x64_bf16 v[20:23], v[120:123], v[152:159], v0
  s_waitcnt lgkmcnt(4)
  ds_read_b128 v[104:107], v2 offset:5120
  v_smfmac_f32_16x16x64_bf16 v[24:27], v[120:123], v[76:83], v0
  s_waitcnt lgkmcnt(4)
  ds_read_b128 v[108:111], v1 offset:5120
  v_smfmac_f32_16x16x64_bf16 v[16:19], v[92:95], v[160:167], v0
  s_waitcnt lgkmcnt(4)
  ds_read_b128 v[112:115], v2 offset:6144
  buffer_load_dwordx4 v10, s[4:7], s28 offen sc1 lds
  v_smfmac_f32_16x16x64_bf16 v[16:19], v[96:99], v[168:175], v0
  s_waitcnt lgkmcnt(4)
  ds_read_b128 v[84:87], v1 offset:6144
  s_mov_b32 m0, s34
  v_smfmac_f32_16x16x64_bf16 v[16:19], v[116:119], v[192:199], v0
  s_waitcnt lgkmcnt(4)
  ds_read_b128 v[88:91], v2 offset:7168
  v_smfmac_f32_16x16x64_bf16 v[16:19], v[124:127], v[200:207], v0
  s_waitcnt lgkmcnt(4)
  ds_read_b128 v[100:103], v1 offset:7168
  v_smfmac_f32_16x16x64_bf16 v[16:19], v[104:107], a[16:23], v0
  s_waitcnt lgkmcnt(4)
  ds_read_b128 v[68:71], v4 offset:16384
  buffer_load_dwordx4 v10, s[4:7], s28 offen offset:256 sc1 lds
  v_smfmac_f32_16x16x64_bf16 v[16:19], v[108:111], a[24:31], v0
  s_waitcnt lgkmcnt(4)
  ds_read_b128 v[72:75], v4 offset:17408
  v_smfmac_f32_16x16x64_bf16 v[16:19], v[112:115], a[64:71], v0
  s_waitcnt lgkmcnt(4)
  ds_read_b128 v[76:79], v4 offset:18432
  v_smfmac_f32_16x16x64_bf16 v[16:19], v[84:87], a[72:79], v0
  s_waitcnt lgkmcnt(4)
  ds_read_b128 v[80:83], v4 offset:19456
  v_smfmac_f32_16x16x64_bf16 v[16:19], v[88:91], a[112:119], v0
  s_waitcnt lgkmcnt(4)
  v_smfmac_f32_16x16x64_bf16 v[16:19], v[100:103], a[120:127], v0
  s_add_u32 s24, s36, 145752064
  s_add_u32 s25, s36, 145756160
  v_smfmac_f32_16x16x64_bf16 v[20:23], v[92:95], v[176:183], v0
  s_add_u32 s35, s36, s23
  v_smfmac_f32_16x16x64_bf16 v[20:23], v[96:99], v[184:191], v0
  s_waitcnt lgkmcnt(2)
  v_smfmac_f32_16x16x64_bf16 v[20:23], v[116:119], v[68:75], v0
  s_waitcnt lgkmcnt(0)
  ds_read_b128 v[68:71], v4 offset:20480
  v_mul_f32 v16, s18, v16
  v_smfmac_f32_16x16x64_bf16 v[20:23], v[124:127], v[76:83], v0
  ds_read_b128 v[72:75], v4 offset:21504
  v_mul_f32 v17, s18, v17
  v_smfmac_f32_16x16x64_bf16 v[20:23], v[104:107], a[32:39], v0
  ds_read_b128 v[76:79], v4 offset:22528
  v_mul_f32 v18, s18, v18
  v_smfmac_f32_16x16x64_bf16 v[20:23], v[108:111], a[40:47], v0
  ds_read_b128 v[80:83], v4 offset:23552
  v_mul_f32 v19, s18, v19
  v_smfmac_f32_16x16x64_bf16 v[20:23], v[112:115], a[80:87], v0
  v_cvt_pk_bf16_f32 v120, v16, v17
  v_smfmac_f32_16x16x64_bf16 v[20:23], v[84:87], a[88:95], v0
  v_cvt_pk_bf16_f32 v121, v18, v19
  v_smfmac_f32_16x16x64_bf16 v[20:23], v[88:91], a[128:135], v0
  ds_write_b64 v5, v[120:121] offset:24576
  v_smfmac_f32_16x16x64_bf16 v[20:23], v[100:103], a[136:143], v0
  s_waitcnt lgkmcnt(3)
  v_smfmac_f32_16x16x64_bf16 v[24:27], v[92:95], v[68:75], v0
  s_waitcnt lgkmcnt(1)
  v_mov_b64 v[92:93], 0
  v_smfmac_f32_16x16x64_bf16 v[24:27], v[96:99], v[76:83], v0
  s_nop 1
  v_cvt_pk_bf16_f32 v122, v20, v21
  v_cvt_pk_bf16_f32 v123, v22, v23
  v_smfmac_f32_16x16x64_bf16 v[24:27], v[116:119], v[208:215], v0
  ds_write_b64 v5, v[122:123] offset:26880
  v_mov_b64 v[94:95], 0
  v_smfmac_f32_16x16x64_bf16 v[24:27], v[124:127], v[216:223], v0
  s_waitcnt lgkmcnt(1)
  s_barrier
  ds_read_b64_tr_b16 v[68:69], v6 offset:24576
  v_smfmac_f32_16x16x64_bf16 v[24:27], v[104:107], a[48:55], v0
  s_add_u32 s27, s27, 8192
  ds_read_b64_tr_b16 v[70:71], v6 offset:24640
  ds_read_b64_tr_b16 v[72:73], v6 offset:24832
  v_smfmac_f32_16x16x64_bf16 v[24:27], v[108:111], a[56:63], v0
  s_add_u32 s28, s28, 8192
  ds_read_b64_tr_b16 v[74:75], v6 offset:24896
  ds_read_b64_tr_b16 v[76:77], v6 offset:25088
  v_smfmac_f32_16x16x64_bf16 v[24:27], v[112:115], a[96:103], v0
  s_nop 0
  ds_read_b64_tr_b16 v[78:79], v6 offset:25152
  ds_read_b64_tr_b16 v[80:81], v6 offset:25344
  v_smfmac_f32_16x16x64_bf16 v[24:27], v[84:87], a[104:111], v0
  ds_read_b64_tr_b16 v[82:83], v6 offset:25408
  v_mov_b64 v[96:97], 0
  v_smfmac_f32_16x16x64_bf16 v[24:27], v[88:91], a[144:151], v0
  s_waitcnt lgkmcnt(8)
  s_barrier
  ds_read_b64_tr_b16 v[116:117], v6 offset:26880
  v_smfmac_f32_16x16x64_bf16 v[24:27], v[100:103], a[152:159], v0
  s_waitcnt lgkmcnt(7)
  ds_read_b64_tr_b16 v[118:119], v6 offset:26944
  v_mfma_f32_16x16x32_bf16 v[16:19], v[36:39], v[68:71], 0
  s_waitcnt lgkmcnt(6)
  ds_read_b64_tr_b16 v[124:125], v6 offset:27136
  ds_read_b64_tr_b16 v[126:127], v6 offset:27200
  v_mfma_f32_16x16x32_bf16 v[16:19], v[40:43], v[72:75], v[16:19]
  s_waitcnt lgkmcnt(6)
  ds_read_b64_tr_b16 v[104:105], v6 offset:27392
  ds_read_b64_tr_b16 v[106:107], v6 offset:27456
  v_mfma_f32_16x16x32_bf16 v[16:19], v[44:47], v[76:79], v[16:19]
  s_waitcnt lgkmcnt(6)
  ds_read_b64_tr_b16 v[108:109], v6 offset:27648
  ds_read_b64_tr_b16 v[110:111], v6 offset:27712
  v_mfma_f32_16x16x32_bf16 v[16:19], v[48:51], v[80:83], v[16:19]
  s_waitcnt lgkmcnt(6)
  v_cvt_pk_bf16_f32 v120, v24, v25
  v_cvt_pk_bf16_f32 v121, v26, v27
  v_mfma_f32_16x16x32_bf16 v[112:115], v[116:119], v[68:71], 0
  s_waitcnt lgkmcnt(4)
  buffer_store_dwordx4 v[120:123], v2, s[4:7], s29 offen offset:0 sc1
  v_mov_b64 v[98:99], 0
  v_mfma_f32_16x16x32_bf16 v[112:115], v[124:127], v[72:75], v[112:115]
  s_waitcnt lgkmcnt(2)
  v_mov_b64 v[36:37], 0
  v_exp_f32 v100, v16
  v_mfma_f32_16x16x32_bf16 v[112:115], v[104:107], v[76:79], v[112:115]
  s_waitcnt lgkmcnt(0)
  v_exp_f32 v101, v17
  v_mfma_f32_16x16x32_bf16 v[112:115], v[108:111], v[80:83], v[112:115]
  s_add_u32 s29, s29, 131072
  v_exp_f32 v102, v18
  v_mfma_f32_16x16x32_bf16 v[20:23], v[52:55], v[68:71], 0
  s_cmp_eq_u32 s14, 63
  v_exp_f32 v103, v19
  v_mfma_f32_16x16x32_bf16 v[20:23], v[56:59], v[72:75], v[20:23]
  s_cbranch_scc1 M_tdone
  v_cvt_pk_bf16_f32 v44, v100, v101
  v_cvt_pk_bf16_f32 v45, v102, v103
  v_mfma_f32_16x16x32_bf16 v[20:23], v[60:63], v[76:79], v[20:23]
  v_exp_f32 v100, v112
  v_mfma_f32_16x16x32_bf16 v[20:23], v[64:67], v[80:83], v[20:23]
  v_exp_f32 v101, v113
  v_exp_f32 v102, v114
  v_exp_f32 v103, v115
  v_cvt_pk_bf16_f32 v84, v100, v101
  v_cvt_pk_bf16_f32 v85, v102, v103
  v_cndmask_b32 v48, v84, 0, s[16:17]
  v_cndmask_b32 v49, v85, 0, s[16:17]
  v_cndmask_b32 v50, 0, v84, s[16:17]
  v_cndmask_b32 v51, 0, v85, s[16:17]
  v_exp_f32 v100, v20
  v_mfma_f32_16x16x16_bf16 v[88:91], v[12:13], v[48:49], 0
  v_exp_f32 v101, v21
  v_mfma_f32_16x16x16_bf16 v[24:27], v[120:121], v[48:49], 0
  v_exp_f32 v102, v22
  v_mfma_f32_16x16x16_bf16 v[116:119], v[120:121], v[50:51], 0
  v_exp_f32 v103, v23
  v_cvt_pk_bf16_f32 v46, v100, v101
  v_cvt_pk_bf16_f32 v47, v102, v103
  v_mov_b64 v[38:39], 0
  s_nop 0
  v_mfma_f32_16x16x32_bf16 v[88:91], v[12:15], v[44:47], v[88:91]
  v_mov_b64 v[40:41], 0
  v_mov_b64 v[42:43], 0
  v_mfma_f32_16x16x32_bf16 v[24:27], v[28:31], v[44:47], v[24:27]
  ds_read_b128 v[52:55], v4 offset:24576
  ds_read_b128 v[56:59], v4 offset:25600
  v_mfma_f32_16x16x32_bf16 v[116:119], v[32:35], v[44:47], v[116:119]
  s_nop 1
  v_rcp_f32 v89, v88
  v_subrev_u32 v100, s54, v88
  v_cmp_le_u32 vcc, s55, v100
  v_mul_f32 v24, v89, v24
  v_mul_f32 v25, v89, v25
  s_cbranch_vccnz T_slow_100
T_back_101:
  v_cvt_pk_bf16_f32 v124, v24, v25
  v_pk_mul_f32 v[26:27], v[26:27], v[88:89] op_sel:[0,1] op_sel_hi:[1,1]
  v_pk_mul_f32 v[116:117], v[116:117], v[88:89] op_sel:[0,1] op_sel_hi:[1,1]
  v_pk_mul_f32 v[118:119], v[118:119], v[88:89] op_sel:[0,1] op_sel_hi:[1,1]
  v_cvt_pk_bf16_f32 v125, v26, v27
  v_cvt_pk_bf16_f32 v126, v116, v117
  v_cvt_pk_bf16_f32 v127, v118, v119
  ds_write_b128 v11, v[124:127] offset:29184
  s_nop 0
  v_smfmac_f32_16x16x64_bf16 v[92:95], v[124:127], a[160:167], v0
  v_smfmac_f32_16x16x64_bf16 v[96:99], v[124:127], a[168:175], v0
  v_smfmac_f32_16x16x64_bf16 v[36:39], v[124:127], a[176:183], v0
  v_smfmac_f32_16x16x64_bf16 v[40:43], v[124:127], a[184:191], v0
  s_waitcnt lgkmcnt(0)
  s_barrier
  ds_read_b128 v[104:107], v11 offset:29696
  ds_read_b128 v[108:111], v11 offset:30208
  ds_read_b128 v[68:71], v11 offset:30720
  s_waitcnt lgkmcnt(2)
  v_smfmac_f32_16x16x64_bf16 v[92:95], v[104:107], a[192:199], v0
  s_waitcnt lgkmcnt(1)
  ds_read_b128 v[76:79], v4 offset:28672
  v_smfmac_f32_16x16x64_bf16 v[92:95], v[108:111], a[224:231], v0
  s_waitcnt lgkmcnt(1)
  ds_read_b128 v[80:83], v4 offset:29696
  v_smfmac_f32_16x16x64_bf16 v[92:95], v[68:71], a[240:247], v0
  ds_read_b128 v[60:63], v4 offset:26624
  v_smfmac_f32_16x16x64_bf16 v[96:99], v[104:107], a[200:207], v0
  ds_read_b128 v[64:67], v4 offset:27648
  v_smfmac_f32_16x16x64_bf16 v[96:99], v[108:111], a[232:239], v0
  ds_read_b128 v[28:31], v4 offset:30720
  s_nop 0
  v_cvt_pk_bf16_f32 v16, v92, v93
  v_cvt_pk_bf16_f32 v17, v94, v95
  v_bfi_b32 v16, 1, s57, v16
  v_smfmac_f32_16x16x64_bf16 v[96:99], v[68:71], a[248:255], v0
  buffer_store_dwordx2 v[16:17], v7, s[4:7], s20 offen offset:0
  v_smfmac_f32_16x16x64_bf16 v[36:39], v[104:107], a[208:215], v0
  ds_read_b128 v[32:35], v4 offset:31744
  v_smfmac_f32_16x16x64_bf16 v[36:39], v[108:111], v[52:59], v0
  s_waitcnt lgkmcnt(4)
  s_nop 0
  v_cvt_pk_bf16_f32 v18, v96, v97
  v_cvt_pk_bf16_f32 v19, v98, v99
  v_bfi_b32 v18, 1, s57, v18
  v_smfmac_f32_16x16x64_bf16 v[36:39], v[68:71], v[76:83], v0
  buffer_store_dwordx2 v[18:19], v7, s[4:7], s20 offen offset:64
  v_smfmac_f32_16x16x64_bf16 v[40:43], v[104:107], a[216:223], v0
  s_waitcnt lgkmcnt(2)
  ds_read_b128 v[116:119], v2 offset:31232
  v_smfmac_f32_16x16x64_bf16 v[40:43], v[108:111], v[60:67], v0
  s_waitcnt lgkmcnt(1)
  s_nop 0
  v_cvt_pk_bf16_f32 v20, v36, v37
  v_cvt_pk_bf16_f32 v21, v38, v39
  v_bfi_b32 v20, 1, s57, v20
  v_smfmac_f32_16x16x64_bf16 v[40:43], v[68:71], v[28:35], v0
  buffer_store_dwordx2 v[20:21], v7, s[4:7], s21 offen offset:0
  s_nop 6
  v_cvt_pk_bf16_f32 v22, v40, v41
  v_cvt_pk_bf16_f32 v23, v42, v43
  v_bfi_b32 v22, 1, s57, v22
  buffer_store_dwordx2 v[22:23], v7, s[4:7], s21 offen offset:64
  ds_read_b128 v[68:71], v4 offset:0
  ds_read_b128 v[72:75], v4 offset:1024
  ds_read_b128 v[76:79], v4 offset:4096
  ds_read_b128 v[80:83], v4 offset:5120
  ds_read_b128 v[84:87], v4 offset:8192
  ds_read_b128 v[88:91], v4 offset:9216
  v_mov_b64 v[16:17], 0
  v_mov_b64 v[18:19], 0
  v_mov_b64 v[20:21], 0
  v_mov_b64 v[22:23], 0
  v_mov_b64 v[24:25], 0
  v_mov_b64 v[26:27], 0
  s_mov_b32 s19, 0
  v_mov_b32 v49, -1
  s_waitcnt vmcnt(2)
  buffer_load_dwordx4 v[52:55], v2, s[4:7], s22 offen offset:0 sc1
  buffer_load_dwordx4 v[56:59], v2, s[4:7], s22 offen offset:1024 sc1
  buffer_load_dwordx4 v[60:63], v2, s[4:7], s22 offen offset:2048 sc1
  buffer_load_dwordx4 v[64:67], v2, s[4:7], s22 offen offset:3072 sc1
  ds_read_b128 v[92:95], v4 offset:2048
  ds_read_b128 v[96:99], v4 offset:3072
  ds_read_b128 v[100:103], v4 offset:6144
  ds_read_b128 v[104:107], v4 offset:7168
  ds_read_b128 v[108:111], v4 offset:10240
  ds_read_b128 v[112:115], v4 offset:11264
  ds_read_b64 v[44:45], v2 offset:32256
  s_waitcnt lgkmcnt(0)
  v_readfirstlane_b32 s38, v44
  v_readfirstlane_b32 s37, v45
  s_nop 0
  s_add_u32 s37, s37, 30
  s_cmp_ge_u32 s38, 30
  s_cselect_b32 s38, s37, s38
  s_cmp_ge_u32 s38, 64
  s_cselect_b32 s38, 100, s38
  s_sub_u32 s38, s38, 1
  s_max_i32 s30, s30, s38
  s_waitcnt lgkmcnt(12)
  s_waitcnt vmcnt(3)
  v_mfma_f32_16x16x32_bf16 v[120:123], v[116:119], v[52:55], 0
  v_xor_b32 v48, s57, v52
  v_bitop3_b32 v48, v48, v54, s57 bitop3:0xf6
  s_waitcnt vmcnt(2)
  v_mfma_f32_16x16x32_bf16 v[120:123], v[116:119], v[56:59], v[120:123]
  v_bitop3_b32 v48, v48, v56, s57 bitop3:0xf6
  v_bitop3_b32 v48, v48, v58, s57 bitop3:0xf6
  s_waitcnt vmcnt(1)
  v_mfma_f32_16x16x32_bf16 v[120:123], v[116:119], v[60:63], v[120:123]
  v_bitop3_b32 v48, v48, v60, s57 bitop3:0xf6
  v_bitop3_b32 v48, v48, v62, s57 bitop3:0xf6
  s_waitcnt vmcnt(0)
  v_mfma_f32_16x16x32_bf16 v[120:123], v[116:119], v[64:67], v[120:123]
  v_bitop3_b32 v48, v48, v64, s57 bitop3:0xf6
  v_bitop3_b32 v48, v48, v66, s57 bitop3:0xf6
  v_and_b32 v48, 1, v48
  v_cmp_ne_u32 vcc, 0, v48
  s_cbranch_vccnz T_p1re_103
T_p1ok_104:
  s_nop 2
  v_add_f32_dpp v120, v120, v120 row_ror:8 row_mask:0xf bank_mask:0xf
  v_add_f32_dpp v121, v121, v121 row_ror:8 row_mask:0xf bank_mask:0xf
  v_cvt_pk_bf16_f32 v48, v120, v121
  v_min_u32 v48, -2, v48
  buffer_store_dword v48, v8, s[4:7], s35 offen
  buffer_store_dword v49, v8, s[4:7], s26 offen
  s_barrier
  ds_read_b128 v[28:31], v2 offset:16384
  ds_read_b128 v[32:35], v2 offset:20480
  ds_read_b128 v[36:39], v2 offset:8192
  ds_read_b128 v[40:43], v2 offset:9216
  ds_read_b128 v[44:47], v2 offset:10240
  ds_read_b128 v[48:51], v2 offset:11264
  buffer_load_dwordx4 v[124:127], v3, s[4:7], s24 offen offset:0 sc1
  buffer_load_dwordx4 v[116:119], v3, s[4:7], s25 offen offset:0 sc1
  ds_read_b128 v[52:55], v2 offset:12288
  ds_read_b128 v[56:59], v2 offset:13312
  ds_read_b128 v[60:63], v2 offset:14336
  ds_read_b128 v[64:67], v2 offset:15360
  buffer_load_dwordx4 v[124:127], v3, s[4:7], s24 offen offset:0 sc1
  buffer_load_dwordx4 v[116:119], v3, s[4:7], s25 offen offset:0 sc1
  s_mov_b32 s19, 0
  s_branch T_loop_93
T_p1re_103:
  s_mov_b64 exec, vcc
  buffer_load_dwordx4 v[52:55], v2, s[4:7], s22 offen offset:0 sc1
  buffer_load_dwordx4 v[56:59], v2, s[4:7], s22 offen offset:1024 sc1
  buffer_load_dwordx4 v[60:63], v2, s[4:7], s22 offen offset:2048 sc1
  buffer_load_dwordx4 v[64:67], v2, s[4:7], s22 offen offset:3072 sc1
  s_mov_b64 exec, -1
  s_add_u32 s19, s19, 1
  s_cmp_gt_u32 s19, 32768
  s_cbranch_scc1 M_exit
  s_waitcnt vmcnt(3)
  v_mfma_f32_16x16x32_bf16 v[120:123], v[116:119], v[52:55], 0
  v_xor_b32 v48, s57, v52
  v_bitop3_b32 v48, v48, v54, s57 bitop3:0xf6
  s_waitcnt vmcnt(2)
  v_mfma_f32_16x16x32_bf16 v[120:123], v[116:119], v[56:59], v[120:123]
  v_bitop3_b32 v48, v48, v56, s57 bitop3:0xf6
  v_bitop3_b32 v48, v48, v58, s57 bitop3:0xf6
  s_waitcnt vmcnt(1)
  v_mfma_f32_16x16x32_bf16 v[120:123], v[116:119], v[60:63], v[120:123]
  v_bitop3_b32 v48, v48, v60, s57 bitop3:0xf6
  v_bitop3_b32 v48, v48, v62, s57 bitop3:0xf6
  s_waitcnt vmcnt(0)
  v_mfma_f32_16x16x32_bf16 v[120:123], v[116:119], v[64:67], v[120:123]
  v_bitop3_b32 v48, v48, v64, s57 bitop3:0xf6
  v_bitop3_b32 v48, v48, v66, s57 bitop3:0xf6
  v_and_b32 v48, 1, v48
  v_cmp_ne_u32 vcc, 0, v48
  s_cbranch_vccnz T_p1re_103
  s_branch T_p1ok_104
T_kvw_97:
  s_mov_b32 s19, 0
  s_branch T_kvok_106
T_kv_105:
  s_sleep 4
  s_add_u32 s19, s19, 1
  s_cmp_gt_u32 s19, 32768
  s_cbranch_scc1 M_exit
T_kvok_106:
  s_add_u32 s39, s99, 128
  s_mov_b32 s38, 0
  s_mov_b32 s37, 0
  s_atomic_or s38, s[58:59], s99 glc
  s_atomic_or s37, s[58:59], s39 glc
  s_waitcnt lgkmcnt(0)
  s_add_u32 s37, s37, 30
  s_cmp_ge_u32 s38, 30
  s_cselect_b32 s38, s37, s38
  s_cmp_ge_u32 s38, 64
  s_cselect_b32 s38, 100, s38
  s_sub_u32 s38, s38, 1
  s_max_i32 s30, s30, s38
  s_cmp_ge_i32 s14, s30
  s_cbranch_scc1 T_kv_105
  s_branch T_kvb_98
T_slow_100:
  s_nop 7
  v_max3_f32 v100, v16, v17, v18
  v_max3_f32 v100, v100, v19, v20
  v_max3_f32 v100, v100, v21, v22
  v_max3_f32 v100, v100, v23, v112
  v_max3_f32 v100, v100, v113, v114
  v_max_f32 v100, v100, v115
  v_mov_b32 v101, v100
  s_nop 1
  v_permlane32_swap_b32 v100, v101
  s_nop 1
  v_max_f32 v100, v100, v101
  v_mov_b32 v101, v100
  s_nop 1
  v_permlane16_swap_b32 v100, v101
  s_nop 1
  v_max_f32 v100, v100, v101
  v_sub_f32 v16, v16, v100
  v_sub_f32 v17, v17, v100
  v_sub_f32 v18, v18, v100
  v_sub_f32 v19, v19, v100
  v_exp_f32 v16, v16
  v_exp_f32 v17, v17
  v_exp_f32 v18, v18
  v_exp_f32 v19, v19
  v_sub_f32 v20, v20, v100
  v_sub_f32 v21, v21, v100
  v_sub_f32 v22, v22, v100
  v_sub_f32 v23, v23, v100
  v_exp_f32 v20, v20
  v_exp_f32 v21, v21
  v_exp_f32 v22, v22
  v_exp_f32 v23, v23
  v_sub_f32 v112, v112, v100
  v_sub_f32 v113, v113, v100
  v_sub_f32 v114, v114, v100
  v_sub_f32 v115, v115, v100
  v_exp_f32 v112, v112
  v_exp_f32 v113, v113
  v_exp_f32 v114, v114
  v_exp_f32 v115, v115
  s_nop 0
  v_cvt_pk_bf16_f32 v44, v16, v17
  v_cvt_pk_bf16_f32 v45, v18, v19
  v_cvt_pk_bf16_f32 v46, v20, v21
  v_cvt_pk_bf16_f32 v47, v22, v23
  v_cvt_pk_bf16_f32 v84, v112, v113
  v_cvt_pk_bf16_f32 v85, v114, v115
  v_cndmask_b32 v48, v84, 0, s[16:17]
  v_cndmask_b32 v49, v85, 0, s[16:17]
  v_cndmask_b32 v50, 0, v84, s[16:17]
  v_cndmask_b32 v51, 0, v85, s[16:17]
  s_nop 1
  v_mfma_f32_16x16x16_bf16 v[88:91], v[12:13], v[48:49], 0
  v_mfma_f32_16x16x16_bf16 v[24:27], v[120:121], v[48:49], 0
  v_mfma_f32_16x16x16_bf16 v[116:119], v[120:121], v[50:51], 0
  v_mfma_f32_16x16x32_bf16 v[88:91], v[12:15], v[44:47], v[88:91]
  v_mfma_f32_16x16x32_bf16 v[24:27], v[28:31], v[44:47], v[24:27]
  v_mfma_f32_16x16x32_bf16 v[116:119], v[32:35], v[44:47], v[116:119]
  s_nop 7
  s_nop 1
  v_rcp_f32 v89, v88
  s_nop 0
  v_mul_f32 v24, v89, v24
  v_mul_f32 v25, v89, v25
  s_branch T_back_101
T_w_90:
  s_mov_b32 s19, 0
  v_mov_b64 v[16:17], 0
  v_mov_b64 v[18:19], 0
  v_mov_b64 v[20:21], 0
  v_mov_b64 v[22:23], 0
  v_mov_b64 v[24:25], 0
  v_mov_b64 v[26:27], 0
  buffer_load_dwordx4 v[124:127], v3, s[4:7], s24 offen offset:1024 sc1
  buffer_load_dwordx4 v[116:119], v3, s[4:7], s25 offen offset:1024 sc1
  buffer_load_dwordx4 v[124:127], v3, s[4:7], s24 offen offset:1024 sc1
  buffer_load_dwordx4 v[116:119], v3, s[4:7], s25 offen offset:1024 sc1
  s_branch T_loop_107
.p2align 6
T_retry_108:
  s_mov_b64 exec, vcc
  buffer_load_dwordx4 v[124:127], v3, s[4:7], s24 offen offset:1024 sc1
  buffer_load_dwordx4 v[116:119], v3, s[4:7], s25 offen offset:1024 sc1
  s_mov_b64 exec, -1
  s_add_u32 s19, s19, 1
  s_cmp_gt_u32 s19, 32768
  s_cbranch_scc1 M_exit
T_loop_107:
  s_waitcnt vmcnt(3) lgkmcnt(0)
  v_max3_u32 v123, v124, v125, v126
  v_max_u32 v123, v123, v127
  v_mov_b32_dpp v120, v124 row_ror:8 row_mask:0xf bank_mask:0xf
  v_mov_b32_dpp v121, v125 row_ror:8 row_mask:0xf bank_mask:0xf
  s_waitcnt vmcnt(2)
  v_max3_u32 v123, v123, v116, v117
  v_max3_u32 v123, v123, v118, v119
  v_cmp_eq_u32 vcc, -1, v123
  s_cbranch_vccnz T_retry_108
  v_smfmac_f32_16x16x64_bf16 v[16:19], v[124:127], v[68:75], v0
  s_add_u32 s14, s14, 1
  ds_write_b128 v2, v[124:127] offset:1024
  v_mov_b32_dpp v122, v126 row_ror:8 row_mask:0xf bank_mask:0xf
  v_smfmac_f32_16x16x64_bf16 v[20:23], v[124:127], v[76:83], v0
  s_and_b32 s57, s14, 1
  v_mov_b32_dpp v123, v127 row_ror:8 row_mask:0xf bank_mask:0xf
  v_smfmac_f32_16x16x64_bf16 v[24:27], v[124:127], v[84:91], v0
  s_and_b32 s36, s14, 3
  ds_write_b128 v2, v[116:119] offset:5120
  v_smfmac_f32_16x16x64_bf16 v[16:19], v[120:123], v[92:99], v0
  s_lshl_b32 s36, s36, 13
  v_mov_b32_dpp v84, v116 row_ror:8 row_mask:0xf bank_mask:0xf
  v_smfmac_f32_16x16x64_bf16 v[20:23], v[120:123], v[100:107], v0
  s_add_u32 s26, s36, s23
  ds_read_b128 v[68:71], v4 offset:12288
  v_mov_b32_dpp v85, v117 row_ror:8 row_mask:0xf bank_mask:0xf
  v_smfmac_f32_16x16x64_bf16 v[24:27], v[120:123], v[108:115], v0
  s_add_u32 s36, s36, 8192
  ds_read_b128 v[72:75], v4 offset:13312
  v_mov_b32_dpp v86, v118 row_ror:8 row_mask:0xf bank_mask:0xf
  v_smfmac_f32_16x16x64_bf16 v[16:19], v[116:119], v[224:231], v0
  s_and_b32 s36, s36, 0x7fff
  ds_read_b128 v[76:79], v4 offset:14336
  v_mov_b32_dpp v87, v119 row_ror:8 row_mask:0xf bank_mask:0xf
  v_smfmac_f32_16x16x64_bf16 v[20:23], v[116:119], v[240:247], v0
  s_waitcnt lgkmcnt(3)
  s_barrier
  ds_read_b128 v[100:103], v2 offset:0
  v_smfmac_f32_16x16x64_bf16 v[24:27], v[116:119], a[0:7], v0
  s_mov_b32 m0, s31
  ds_read_b128 v[120:123], v1 offset:0
  v_smfmac_f32_16x16x64_bf16 v[16:19], v[84:87], v[232:239], v0
  s_cmp_ge_i32 s14, s30
  s_cbranch_scc1 T_kvw_111
T_kvb_112:
  v_smfmac_f32_16x16x64_bf16 v[20:23], v[84:87], v[248:255], v0
  ds_read_b128 v[80:83], v4 offset:15360
  v_smfmac_f32_16x16x64_bf16 v[24:27], v[84:87], a[8:15], v0
  s_waitcnt lgkmcnt(2)
  buffer_load_dwordx4 v9, s[4:7], s27 offen sc1 lds
  v_smfmac_f32_16x16x64_bf16 v[16:19], v[100:103], v[128:135], v0
  ds_read_b128 v[92:95], v2 offset:3072
  s_mov_b32 m0, s32
  v_smfmac_f32_16x16x64_bf16 v[20:23], v[100:103], v[144:151], v0
  ds_read_b128 v[96:99], v1 offset:3072
  v_smfmac_f32_16x16x64_bf16 v[24:27], v[100:103], v[68:75], v0
  s_waitcnt vmcnt(1) lgkmcnt(3)
  ds_read_b128 v[116:119], v2 offset:2048
  v_smfmac_f32_16x16x64_bf16 v[16:19], v[120:123], v[136:143], v0
  ds_read_b128 v[124:127], v1 offset:2048
  buffer_load_dwordx4 v9, s[4:7], s27 offen offset:128 sc1 lds
  v_smfmac_f32_16x16x64_bf16 v[20:23], v[120:123], v[152:159], v0
  s_waitcnt lgkmcnt(4)
  ds_read_b128 v[104:107], v2 offset:4096
  s_mov_b32 m0, s33
  v_smfmac_f32_16x16x64_bf16 v[24:27], v[120:123], v[76:83], v0
  s_waitcnt lgkmcnt(4)
  ds_read_b128 v[108:111], v1 offset:4096
  v_smfmac_f32_16x16x64_bf16 v[16:19], v[92:95], v[160:167], v0
  s_waitcnt lgkmcnt(4)
  ds_read_b128 v[112:115], v2 offset:7168
  v_smfmac_f32_16x16x64_bf16 v[16:19], v[96:99], v[168:175], v0
  s_waitcnt lgkmcnt(4)
  ds_read_b128 v[84:87], v1 offset:7168
  buffer_load_dwordx4 v10, s[4:7], s28 offen sc1 lds
  v_smfmac_f32_16x16x64_bf16 v[16:19], v[116:119], v[192:199], v0
  s_waitcnt lgkmcnt(4)
  ds_read_b128 v[88:91], v2 offset:6144
  s_mov_b32 m0, s34
  v_smfmac_f32_16x16x64_bf16 v[16:19], v[124:127], v[200:207], v0
  s_waitcnt lgkmcnt(4)
  ds_read_b128 v[100:103], v1 offset:6144
  v_smfmac_f32_16x16x64_bf16 v[16:19], v[104:107], a[16:23], v0
  s_waitcnt lgkmcnt(4)
  ds_read_b128 v[68:71], v4 offset:16384
  v_smfmac_f32_16x16x64_bf16 v[16:19], v[108:111], a[24:31], v0
  s_waitcnt lgkmcnt(4)
  ds_read_b128 v[72:75], v4 offset:17408
  buffer_load_dwordx4 v10, s[4:7], s28 offen offset:256 sc1 lds
  v_smfmac_f32_16x16x64_bf16 v[16:19], v[112:115], a[64:71], v0
  s_waitcnt lgkmcnt(4)
  ds_read_b128 v[76:79], v4 offset:18432
  v_smfmac_f32_16x16x64_bf16 v[16:19], v[84:87], a[72:79], v0
  s_waitcnt lgkmcnt(4)
  ds_read_b128 v[80:83], v4 offset:19456
  v_smfmac_f32_16x16x64_bf16 v[16:19], v[88:91], a[112:119], v0
  s_waitcnt lgkmcnt(4)
  v_smfmac_f32_16x16x64_bf16 v[16:19], v[100:103], a[120:127], v0
  s_add_u32 s24, s36, 145752064
  s_add_u32 s25, s36, 145756160
  v_smfmac_f32_16x16x64_bf16 v[20:23], v[92:95], v[176:183], v0
  s_add_u32 s35, s36, s23
  v_smfmac_f32_16x16x64_bf16 v[20:23], v[96:99], v[184:191], v0
  s_waitcnt lgkmcnt(2)
  v_smfmac_f32_16x16x64_bf16 v[20:23], v[116:119], v[68:75], v0
  s_waitcnt lgkmcnt(0)
  ds_read_b128 v[68:71], v4 offset:20480
  v_mul_f32 v16, s18, v16
  v_smfmac_f32_16x16x64_bf16 v[20:23], v[124:127], v[76:83], v0
  ds_read_b128 v[72:75], v4 offset:21504
  v_mul_f32 v17, s18, v17
  v_smfmac_f32_16x16x64_bf16 v[20:23], v[104:107], a[32:39], v0
  ds_read_b128 v[76:79], v4 offset:22528
  v_mul_f32 v18, s18, v18
  v_smfmac_f32_16x16x64_bf16 v[20:23], v[108:111], a[40:47], v0
  ds_read_b128 v[80:83], v4 offset:23552
  v_mul_f32 v19, s18, v19
  v_smfmac_f32_16x16x64_bf16 v[20:23], v[112:115], a[80:87], v0
  v_cvt_pk_bf16_f32 v120, v16, v17
  v_smfmac_f32_16x16x64_bf16 v[20:23], v[84:87], a[88:95], v0
  v_cvt_pk_bf16_f32 v121, v18, v19
  v_smfmac_f32_16x16x64_bf16 v[20:23], v[88:91], a[128:135], v0
  ds_write_b64 v5, v[120:121] offset:24576
  v_smfmac_f32_16x16x64_bf16 v[20:23], v[100:103], a[136:143], v0
  s_waitcnt lgkmcnt(3)
  v_smfmac_f32_16x16x64_bf16 v[24:27], v[92:95], v[68:75], v0
  s_waitcnt lgkmcnt(1)
  v_mov_b64 v[92:93], 0
  v_smfmac_f32_16x16x64_bf16 v[24:27], v[96:99], v[76:83], v0
  s_nop 1
  v_cvt_pk_bf16_f32 v122, v20, v21
  v_cvt_pk_bf16_f32 v123, v22, v23
  v_smfmac_f32_16x16x64_bf16 v[24:27], v[116:119], v[208:215], v0
  ds_write_b64 v5, v[122:123] offset:26880
  v_mov_b64 v[94:95], 0
  v_smfmac_f32_16x16x64_bf16 v[24:27], v[124:127], v[216:223], v0
  s_waitcnt lgkmcnt(1)
  s_barrier
  ds_read_b64_tr_b16 v[68:69], v6 offset:24576
  v_smfmac_f32_16x16x64_bf16 v[24:27], v[104:107], a[48:55], v0
  s_add_u32 s27, s27, 8192
  ds_read_b64_tr_b16 v[70:71], v6 offset:24640
  ds_read_b64_tr_b16 v[72:73], v6 offset:24832
  v_smfmac_f32_16x16x64_bf16 v[24:27], v[108:111], a[56:63], v0
  s_add_u32 s28, s28, 8192
  ds_read_b64_tr_b16 v[74:75], v6 offset:24896
  ds_read_b64_tr_b16 v[76:77], v6 offset:25088
  v_smfmac_f32_16x16x64_bf16 v[24:27], v[112:115], a[96:103], v0
  s_nop 0
  ds_read_b64_tr_b16 v[78:79], v6 offset:25152
  ds_read_b64_tr_b16 v[80:81], v6 offset:25344
  v_smfmac_f32_16x16x64_bf16 v[24:27], v[84:87], a[104:111], v0
  ds_read_b64_tr_b16 v[82:83], v6 offset:25408
  v_mov_b64 v[96:97], 0
  v_smfmac_f32_16x16x64_bf16 v[24:27], v[88:91], a[144:151], v0
  s_waitcnt lgkmcnt(8)
  s_barrier
  ds_read_b64_tr_b16 v[116:117], v6 offset:26880
  v_smfmac_f32_16x16x64_bf16 v[24:27], v[100:103], a[152:159], v0
  s_waitcnt lgkmcnt(7)
  ds_read_b64_tr_b16 v[118:119], v6 offset:26944
  v_mfma_f32_16x16x32_bf16 v[16:19], v[36:39], v[68:71], 0
  s_waitcnt lgkmcnt(6)
  ds_read_b64_tr_b16 v[124:125], v6 offset:27136
  ds_read_b64_tr_b16 v[126:127], v6 offset:27200
  v_mfma_f32_16x16x32_bf16 v[16:19], v[40:43], v[72:75], v[16:19]
  s_waitcnt lgkmcnt(6)
  ds_read_b64_tr_b16 v[104:105], v6 offset:27392
  ds_read_b64_tr_b16 v[106:107], v6 offset:27456
  v_mfma_f32_16x16x32_bf16 v[16:19], v[44:47], v[76:79], v[16:19]
  s_waitcnt lgkmcnt(6)
  ds_read_b64_tr_b16 v[108:109], v6 offset:27648
  ds_read_b64_tr_b16 v[110:111], v6 offset:27712
  v_mfma_f32_16x16x32_bf16 v[16:19], v[48:51], v[80:83], v[16:19]
  s_waitcnt lgkmcnt(6)
  v_cvt_pk_bf16_f32 v120, v24, v25
  v_cvt_pk_bf16_f32 v121, v26, v27
  v_mfma_f32_16x16x32_bf16 v[112:115], v[116:119], v[68:71], 0
  s_waitcnt lgkmcnt(4)
  buffer_store_dwordx4 v[120:123], v2, s[4:7], s29 offen offset:1024 sc1
  v_mov_b64 v[98:99], 0
  v_mfma_f32_16x16x32_bf16 v[112:115], v[124:127], v[72:75], v[112:115]
  s_waitcnt lgkmcnt(2)
  v_mov_b64 v[36:37], 0
  v_exp_f32 v100, v16
  v_mfma_f32_16x16x32_bf16 v[112:115], v[104:107], v[76:79], v[112:115]
  s_waitcnt lgkmcnt(0)
  v_exp_f32 v101, v17
  v_mfma_f32_16x16x32_bf16 v[112:115], v[108:111], v[80:83], v[112:115]
  s_add_u32 s29, s29, 131072
  v_exp_f32 v102, v18
  v_mfma_f32_16x16x32_bf16 v[20:23], v[52:55], v[68:71], 0
  s_cmp_eq_u32 s14, 63
  v_exp_f32 v103, v19
  v_mfma_f32_16x16x32_bf16 v[20:23], v[56:59], v[72:75], v[20:23]
  s_cbranch_scc1 M_tdone
  v_cvt_pk_bf16_f32 v44, v100, v101
  v_cvt_pk_bf16_f32 v45, v102, v103
  v_mfma_f32_16x16x32_bf16 v[20:23], v[60:63], v[76:79], v[20:23]
  v_exp_f32 v100, v112
  v_mfma_f32_16x16x32_bf16 v[20:23], v[64:67], v[80:83], v[20:23]
  v_exp_f32 v101, v113
  v_exp_f32 v102, v114
  v_exp_f32 v103, v115
  v_cvt_pk_bf16_f32 v84, v100, v101
  v_cvt_pk_bf16_f32 v85, v102, v103
  v_cndmask_b32 v48, v84, 0, s[16:17]
  v_cndmask_b32 v49, v85, 0, s[16:17]
  v_cndmask_b32 v50, 0, v84, s[16:17]
  v_cndmask_b32 v51, 0, v85, s[16:17]
  v_exp_f32 v100, v20
  v_mfma_f32_16x16x16_bf16 v[88:91], v[12:13], v[48:49], 0
  v_exp_f32 v101, v21
  v_mfma_f32_16x16x16_bf16 v[24:27], v[120:121], v[48:49], 0
  v_exp_f32 v102, v22
  v_mfma_f32_16x16x16_bf16 v[116:119], v[120:121], v[50:51], 0
  v_exp_f32 v103, v23
  v_cvt_pk_bf16_f32 v46, v100, v101
  v_cvt_pk_bf16_f32 v47, v102, v103
  v_mov_b64 v[38:39], 0
  s_nop 0
  v_mfma_f32_16x16x32_bf16 v[88:91], v[12:15], v[44:47], v[88:91]
  v_mov_b64 v[40:41], 0
  v_mov_b64 v[42:43], 0
  v_mfma_f32_16x16x32_bf16 v[24:27], v[28:31], v[44:47], v[24:27]
  ds_read_b128 v[52:55], v4 offset:24576
  ds_read_b128 v[56:59], v4 offset:25600
  v_mfma_f32_16x16x32_bf16 v[116:119], v[32:35], v[44:47], v[116:119]
  s_nop 1
  v_rcp_f32 v89, v88
  v_subrev_u32 v100, s54, v88
  v_cmp_le_u32 vcc, s55, v100
  v_mul_f32 v24, v89, v24
  v_mul_f32 v25, v89, v25
  s_cbranch_vccnz T_slow_114
T_back_115:
  v_cvt_pk_bf16_f32 v124, v24, v25
  v_pk_mul_f32 v[26:27], v[26:27], v[88:89] op_sel:[0,1] op_sel_hi:[1,1]
  v_pk_mul_f32 v[116:117], v[116:117], v[88:89] op_sel:[0,1] op_sel_hi:[1,1]
  v_pk_mul_f32 v[118:119], v[118:119], v[88:89] op_sel:[0,1] op_sel_hi:[1,1]
  v_cvt_pk_bf16_f32 v125, v26, v27
  v_cvt_pk_bf16_f32 v126, v116, v117
  v_cvt_pk_bf16_f32 v127, v118, v119
  ds_write_b128 v11, v[124:127] offset:29696
  s_nop 0
  v_smfmac_f32_16x16x64_bf16 v[92:95], v[124:127], a[160:167], v0
  v_smfmac_f32_16x16x64_bf16 v[96:99], v[124:127], a[168:175], v0
  v_smfmac_f32_16x16x64_bf16 v[36:39], v[124:127], a[176:183], v0
  v_smfmac_f32_16x16x64_bf16 v[40:43], v[124:127], a[184:191], v0
  s_waitcnt lgkmcnt(0)
  s_barrier
  ds_read_b128 v[104:107], v11 offset:29184
  ds_read_b128 v[108:111], v11 offset:30720
  ds_read_b128 v[68:71], v11 offset:30208
  s_waitcnt lgkmcnt(2)
  v_smfmac_f32_16x16x64_bf16 v[92:95], v[104:107], a[192:199], v0
  s_waitcnt lgkmcnt(1)
  ds_read_b128 v[76:79], v4 offset:28672
  v_smfmac_f32_16x16x64_bf16 v[92:95], v[108:111], a[224:231], v0
  s_waitcnt lgkmcnt(1)
  ds_read_b128 v[80:83], v4 offset:29696
  v_smfmac_f32_16x16x64_bf16 v[92:95], v[68:71], a[240:247], v0
  ds_read_b128 v[60:63], v4 offset:26624
  v_smfmac_f32_16x16x64_bf16 v[96:99], v[104:107], a[200:207], v0
  ds_read_b128 v[64:67], v4 offset:27648
  v_smfmac_f32_16x16x64_bf16 v[96:99], v[108:111], a[232:239], v0
  ds_read_b128 v[28:31], v4 offset:30720
  s_nop 0
  v_cvt_pk_bf16_f32 v16, v92, v93
  v_cvt_pk_bf16_f32 v17, v94, v95
  v_bfi_b32 v16, 1, s57, v16
  v_smfmac_f32_16x16x64_bf16 v[96:99], v[68:71], a[248:255], v0
  buffer_store_dwordx2 v[16:17], v7, s[4:7], s20 offen offset:0
  v_smfmac_f32_16x16x64_bf16 v[36:39], v[104:107], a[208:215], v0
  ds_read_b128 v[32:35], v4 offset:31744
  v_smfmac_f32_16x16x64_bf16 v[36:39], v[108:111], v[52:59], v0
  s_waitcnt lgkmcnt(4)
  s_nop 0
  v_cvt_pk_bf16_f32 v18, v96, v97
  v_cvt_pk_bf16_f32 v19, v98, v99
  v_bfi_b32 v18, 1, s57, v18
  v_smfmac_f32_16x16x64_bf16 v[36:39], v[68:71], v[76:83], v0
  buffer_store_dwordx2 v[18:19], v7, s[4:7], s20 offen offset:64
  v_smfmac_f32_16x16x64_bf16 v[40:43], v[104:107], a[216:223], v0
  s_waitcnt lgkmcnt(2)
  ds_read_b128 v[116:119], v2 offset:31232
  v_smfmac_f32_16x16x64_bf16 v[40:43], v[108:111], v[60:67], v0
  s_waitcnt lgkmcnt(1)
  s_nop 0
  v_cvt_pk_bf16_f32 v20, v36, v37
  v_cvt_pk_bf16_f32 v21, v38, v39
  v_bfi_b32 v20, 1, s57, v20
  v_smfmac_f32_16x16x64_bf16 v[40:43], v[68:71], v[28:35], v0
  buffer_store_dwordx2 v[20:21], v7, s[4:7], s21 offen offset:0
  s_nop 6
  v_cvt_pk_bf16_f32 v22, v40, v41
  v_cvt_pk_bf16_f32 v23, v42, v43
  v_bfi_b32 v22, 1, s57, v22
  buffer_store_dwordx2 v[22:23], v7, s[4:7], s21 offen offset:64
  ds_read_b128 v[68:71], v4 offset:0
  ds_read_b128 v[72:75], v4 offset:1024
  ds_read_b128 v[76:79], v4 offset:4096
  ds_read_b128 v[80:83], v4 offset:5120
  ds_read_b128 v[84:87], v4 offset:8192
  ds_read_b128 v[88:91], v4 offset:9216
  ds_read_b128 v[92:95], v4 offset:2048
  ds_read_b128 v[96:99], v4 offset:3072
  ds_read_b128 v[100:103], v4 offset:6144
  ds_read_b128 v[104:107], v4 offset:7168
  ds_read_b128 v[108:111], v4 offset:10240
  ds_read_b128 v[112:115], v4 offset:11264
  v_mov_b64 v[16:17], 0
  v_mov_b64 v[18:19], 0
  v_mov_b64 v[20:21], 0
  v_mov_b64 v[22:23], 0
  v_mov_b64 v[24:25], 0
  v_mov_b64 v[26:27], 0
  s_mov_b32 s19, 0
  v_mov_b32 v49, -1
  ds_read_b64 v[44:45], v2 offset:32256
  s_waitcnt lgkmcnt(0)
  v_readfirstlane_b32 s38, v44
  v_readfirstlane_b32 s37, v45
  s_nop 0
  s_add_u32 s37, s37, 30
  s_cmp_ge_u32 s38, 30
  s_cselect_b32 s38, s37, s38
  s_cmp_ge_u32 s38, 64
  s_cselect_b32 s38, 100, s38
  s_sub_u32 s38, s38, 1
  s_max_i32 s30, s30, s38
  s_waitcnt vmcnt(0)
  buffer_load_dwordx4 v[52:55], v2, s[4:7], s22 offen offset:0 sc1
  buffer_load_dwordx4 v[56:59], v2, s[4:7], s22 offen offset:1024 sc1
  buffer_load_dwordx4 v[60:63], v2, s[4:7], s22 offen offset:2048 sc1
  buffer_load_dwordx4 v[64:67], v2, s[4:7], s22 offen offset:3072 sc1
  s_waitcnt lgkmcnt(12)
  s_waitcnt vmcnt(3)
  v_mfma_f32_16x16x32_bf16 v[120:123], v[116:119], v[52:55], 0
  v_xor_b32 v48, s57, v52
  v_bitop3_b32 v48, v48, v54, s57 bitop3:0xf6
  s_waitcnt vmcnt(2)
  v_mfma_f32_16x16x32_bf16 v[120:123], v[116:119], v[56:59], v[120:123]
  v_bitop3_b32 v48, v48, v56, s57 bitop3:0xf6
  v_bitop3_b32 v48, v48, v58, s57 bitop3:0xf6
  s_waitcnt vmcnt(1)
  v_mfma_f32_16x16x32_bf16 v[120:123], v[116:119], v[60:63], v[120:123]
  v_bitop3_b32 v48, v48, v60, s57 bitop3:0xf6
  v_bitop3_b32 v48, v48, v62, s57 bitop3:0xf6
  s_waitcnt vmcnt(0)
  v_mfma_f32_16x16x32_bf16 v[120:123], v[116:119], v[64:67], v[120:123]
  v_bitop3_b32 v48, v48, v64, s57 bitop3:0xf6
  v_bitop3_b32 v48, v48, v66, s57 bitop3:0xf6
  v_and_b32 v48, 1, v48
  v_cmp_ne_u32 vcc, 0, v48
  s_cbranch_vccnz T_p1re_117
T_p1ok_118:
  s_nop 2
  v_add_f32_dpp v120, v120, v120 row_ror:8 row_mask:0xf bank_mask:0xf
  v_add_f32_dpp v121, v121, v121 row_ror:8 row_mask:0xf bank_mask:0xf
  v_cvt_pk_bf16_f32 v48, v120, v121
  v_min_u32 v48, -2, v48
  buffer_store_dword v48, v8, s[4:7], s35 offen
  buffer_store_dword v49, v8, s[4:7], s26 offen
  s_barrier
  ds_read_b128 v[28:31], v2 offset:17408
  ds_read_b128 v[32:35], v2 offset:21504
  ds_read_b128 v[36:39], v2 offset:8192
  ds_read_b128 v[40:43], v2 offset:9216
  ds_read_b128 v[44:47], v2 offset:10240
  ds_read_b128 v[48:51], v2 offset:11264
  buffer_load_dwordx4 v[124:127], v3, s[4:7], s24 offen offset:1024 sc1
  buffer_load_dwordx4 v[116:119], v3, s[4:7], s25 offen offset:1024 sc1
  ds_read_b128 v[52:55], v2 offset:12288
  ds_read_b128 v[56:59], v2 offset:13312
  ds_read_b128 v[60:63], v2 offset:14336
  ds_read_b128 v[64:67], v2 offset:15360
  buffer_load_dwordx4 v[124:127], v3, s[4:7], s24 offen offset:1024 sc1
  buffer_load_dwordx4 v[116:119], v3, s[4:7], s25 offen offset:1024 sc1
  s_mov_b32 s19, 0
  s_branch T_loop_107
T_p1re_117:
  s_mov_b64 exec, vcc
  buffer_load_dwordx4 v[52:55], v2, s[4:7], s22 offen offset:0 sc1
  buffer_load_dwordx4 v[56:59], v2, s[4:7], s22 offen offset:1024 sc1
  buffer_load_dwordx4 v[60:63], v2, s[4:7], s22 offen offset:2048 sc1
  buffer_load_dwordx4 v[64:67], v2, s[4:7], s22 offen offset:3072 sc1
  s_mov_b64 exec, -1
  s_add_u32 s19, s19, 1
  s_cmp_gt_u32 s19, 32768
  s_cbranch_scc1 M_exit
  s_waitcnt vmcnt(3)
  v_mfma_f32_16x16x32_bf16 v[120:123], v[116:119], v[52:55], 0
  v_xor_b32 v48, s57, v52
  v_bitop3_b32 v48, v48, v54, s57 bitop3:0xf6
  s_waitcnt vmcnt(2)
  v_mfma_f32_16x16x32_bf16 v[120:123], v[116:119], v[56:59], v[120:123]
  v_bitop3_b32 v48, v48, v56, s57 bitop3:0xf6
  v_bitop3_b32 v48, v48, v58, s57 bitop3:0xf6
  s_waitcnt vmcnt(1)
  v_mfma_f32_16x16x32_bf16 v[120:123], v[116:119], v[60:63], v[120:123]
  v_bitop3_b32 v48, v48, v60, s57 bitop3:0xf6
  v_bitop3_b32 v48, v48, v62, s57 bitop3:0xf6
  s_waitcnt vmcnt(0)
  v_mfma_f32_16x16x32_bf16 v[120:123], v[116:119], v[64:67], v[120:123]
  v_bitop3_b32 v48, v48, v64, s57 bitop3:0xf6
  v_bitop3_b32 v48, v48, v66, s57 bitop3:0xf6
  v_and_b32 v48, 1, v48
  v_cmp_ne_u32 vcc, 0, v48
  s_cbranch_vccnz T_p1re_117
  s_branch T_p1ok_118
T_kvw_111:
  s_mov_b32 s19, 0
  s_branch T_kvok_120
T_kv_119:
  s_sleep 4
  s_add_u32 s19, s19, 1
  s_cmp_gt_u32 s19, 32768
  s_cbranch_scc1 M_exit
T_kvok_120:
  s_add_u32 s39, s99, 128
  s_mov_b32 s38, 0
  s_mov_b32 s37, 0
  s_atomic_or s38, s[58:59], s99 glc
  s_atomic_or s37, s[58:59], s39 glc
  s_waitcnt lgkmcnt(0)
  s_add_u32 s37, s37, 30
  s_cmp_ge_u32 s38, 30
  s_cselect_b32 s38, s37, s38
  s_cmp_ge_u32 s38, 64
  s_cselect_b32 s38, 100, s38
  s_sub_u32 s38, s38, 1
  s_max_i32 s30, s30, s38
  s_cmp_ge_i32 s14, s30
  s_cbranch_scc1 T_kv_119
  s_branch T_kvb_112
T_slow_114:
  s_nop 7
  v_max3_f32 v100, v16, v17, v18
  v_max3_f32 v100, v100, v19, v20
  v_max3_f32 v100, v100, v21, v22
  v_max3_f32 v100, v100, v23, v112
  v_max3_f32 v100, v100, v113, v114
  v_max_f32 v100, v100, v115
  v_mov_b32 v101, v100
  s_nop 1
  v_permlane32_swap_b32 v100, v101
  s_nop 1
  v_max_f32 v100, v100, v101
  v_mov_b32 v101, v100
  s_nop 1
  v_permlane16_swap_b32 v100, v101
  s_nop 1
  v_max_f32 v100, v100, v101
  v_sub_f32 v16, v16, v100
  v_sub_f32 v17, v17, v100
  v_sub_f32 v18, v18, v100
  v_sub_f32 v19, v19, v100
  v_exp_f32 v16, v16
  v_exp_f32 v17, v17
  v_exp_f32 v18, v18
  v_exp_f32 v19, v19
  v_sub_f32 v20, v20, v100
  v_sub_f32 v21, v21, v100
  v_sub_f32 v22, v22, v100
  v_sub_f32 v23, v23, v100
  v_exp_f32 v20, v20
  v_exp_f32 v21, v21
  v_exp_f32 v22, v22
  v_exp_f32 v23, v23
  v_sub_f32 v112, v112, v100
  v_sub_f32 v113, v113, v100
  v_sub_f32 v114, v114, v100
  v_sub_f32 v115, v115, v100
  v_exp_f32 v112, v112
  v_exp_f32 v113, v113
  v_exp_f32 v114, v114
  v_exp_f32 v115, v115
  s_nop 0
  v_cvt_pk_bf16_f32 v44, v16, v17
  v_cvt_pk_bf16_f32 v45, v18, v19
  v_cvt_pk_bf16_f32 v46, v20, v21
  v_cvt_pk_bf16_f32 v47, v22, v23
  v_cvt_pk_bf16_f32 v84, v112, v113
  v_cvt_pk_bf16_f32 v85, v114, v115
  v_cndmask_b32 v48, v84, 0, s[16:17]
  v_cndmask_b32 v49, v85, 0, s[16:17]
  v_cndmask_b32 v50, 0, v84, s[16:17]
  v_cndmask_b32 v51, 0, v85, s[16:17]
  s_nop 1
  v_mfma_f32_16x16x16_bf16 v[88:91], v[12:13], v[48:49], 0
  v_mfma_f32_16x16x16_bf16 v[24:27], v[120:121], v[48:49], 0
  v_mfma_f32_16x16x16_bf16 v[116:119], v[120:121], v[50:51], 0
  v_mfma_f32_16x16x32_bf16 v[88:91], v[12:15], v[44:47], v[88:91]
  v_mfma_f32_16x16x32_bf16 v[24:27], v[28:31], v[44:47], v[24:27]
  v_mfma_f32_16x16x32_bf16 v[116:119], v[32:35], v[44:47], v[116:119]
  s_nop 7
  s_nop 1
  v_rcp_f32 v89, v88
  s_nop 0
  v_mul_f32 v24, v89, v24
  v_mul_f32 v25, v89, v25
  s_branch T_back_115
T_w_91:
  s_mov_b32 s19, 0
  v_mov_b64 v[16:17], 0
  v_mov_b64 v[18:19], 0
  v_mov_b64 v[20:21], 0
  v_mov_b64 v[22:23], 0
  v_mov_b64 v[24:25], 0
  v_mov_b64 v[26:27], 0
  buffer_load_dwordx4 v[124:127], v3, s[4:7], s24 offen offset:2048 sc1
  buffer_load_dwordx4 v[116:119], v3, s[4:7], s25 offen offset:2048 sc1
  buffer_load_dwordx4 v[124:127], v3, s[4:7], s24 offen offset:2048 sc1
  buffer_load_dwordx4 v[116:119], v3, s[4:7], s25 offen offset:2048 sc1
  s_branch T_loop_121
.p2align 6
T_retry_122:
  s_mov_b64 exec, vcc
  buffer_load_dwordx4 v[124:127], v3, s[4:7], s24 offen offset:2048 sc1
  buffer_load_dwordx4 v[116:119], v3, s[4:7], s25 offen offset:2048 sc1
  s_mov_b64 exec, -1
  s_add_u32 s19, s19, 1
  s_cmp_gt_u32 s19, 32768
  s_cbranch_scc1 M_exit
T_loop_121:
  s_waitcnt vmcnt(3) lgkmcnt(0)
  v_max3_u32 v123, v124, v125, v126
  v_max_u32 v123, v123, v127
  v_mov_b32_dpp v120, v124 row_ror:8 row_mask:0xf bank_mask:0xf
  v_mov_b32_dpp v121, v125 row_ror:8 row_mask:0xf bank_mask:0xf
  s_waitcnt vmcnt(2)
  v_max3_u32 v123, v123, v116, v117
  v_max3_u32 v123, v123, v118, v119
  v_cmp_eq_u32 vcc, -1, v123
  s_cbranch_vccnz T_retry_122
  v_smfmac_f32_16x16x64_bf16 v[16:19], v[124:127], v[68:75], v0
  s_add_u32 s14, s14, 1
  ds_write_b128 v2, v[124:127] offset:2048
  v_mov_b32_dpp v122, v126 row_ror:8 row_mask:0xf bank_mask:0xf
  v_smfmac_f32_16x16x64_bf16 v[20:23], v[124:127], v[76:83], v0
  s_and_b32 s57, s14, 1
  v_mov_b32_dpp v123, v127 row_ror:8 row_mask:0xf bank_mask:0xf
  v_smfmac_f32_16x16x64_bf16 v[24:27], v[124:127], v[84:91], v0
  s_and_b32 s36, s14, 3
  ds_write_b128 v2, v[116:119] offset:6144
  v_smfmac_f32_16x16x64_bf16 v[16:19], v[120:123], v[92:99], v0
  s_lshl_b32 s36, s36, 13
  v_mov_b32_dpp v84, v116 row_ror:8 row_mask:0xf bank_mask:0xf
  v_smfmac_f32_16x16x64_bf16 v[20:23], v[120:123], v[100:107], v0
  s_add_u32 s26, s36, s23
  ds_read_b128 v[68:71], v4 offset:12288
  v_mov_b32_dpp v85, v117 row_ror:8 row_mask:0xf bank_mask:0xf
  v_smfmac_f32_16x16x64_bf16 v[24:27], v[120:123], v[108:115], v0
  s_add_u32 s36, s36, 8192
  ds_read_b128 v[72:75], v4 offset:13312
  v_mov_b32_dpp v86, v118 row_ror:8 row_mask:0xf bank_mask:0xf
  v_smfmac_f32_16x16x64_bf16 v[16:19], v[116:119], v[224:231], v0
  s_and_b32 s36, s36, 0x7fff
  ds_read_b128 v[76:79], v4 offset:14336
  v_mov_b32_dpp v87, v119 row_ror:8 row_mask:0xf bank_mask:0xf
  v_smfmac_f32_16x16x64_bf16 v[20:23], v[116:119], v[240:247], v0
  s_waitcnt lgkmcnt(3)
  s_barrier
  ds_read_b128 v[100:103], v2 offset:3072
  v_smfmac_f32_16x16x64_bf16 v[24:27], v[116:119], a[0:7], v0
  s_mov_b32 m0, s31
  ds_read_b128 v[120:123], v1 offset:3072
  v_smfmac_f32_16x16x64_bf16 v[16:19], v[84:87], v[232:239], v0
  s_cmp_ge_i32 s14, s30
  s_cbranch_scc1 T_kvw_125
T_kvb_126:
  v_smfmac_f32_16x16x64_bf16 v[20:23], v[84:87], v[248:255], v0
  ds_read_b128 v[80:83], v4 offset:15360
  v_smfmac_f32_16x16x64_bf16 v[24:27], v[84:87], a[8:15], v0
  s_waitcnt lgkmcnt(2)
  v_smfmac_f32_16x16x64_bf16 v[16:19], v[100:103], v[128:135], v0
  ds_read_b128 v[92:95], v2 offset:0
  buffer_load_dwordx4 v9, s[4:7], s27 offen sc1 lds
  v_smfmac_f32_16x16x64_bf16 v[20:23], v[100:103], v[144:151], v0
  ds_read_b128 v[96:99], v1 offset:0
  s_mov_b32 m0, s32
  v_smfmac_f32_16x16x64_bf16 v[24:27], v[100:103], v[68:75], v0
  s_waitcnt vmcnt(1) lgkmcnt(3)
  ds_read_b128 v[116:119], v2 offset:1024
  v_smfmac_f32_16x16x64_bf16 v[16:19], v[120:123], v[136:143], v0
  ds_read_b128 v[124:127], v1 offset:1024
  v_smfmac_f32_16x16x64_bf16 v[20:23], v[120:123], v[152:159], v0
  s_waitcnt lgkmcnt(4)
  ds_read_b128 v[104:107], v2 offset:7168
  buffer_load_dwordx4 v9, s[4:7], s27 offen offset:128 sc1 lds
  v_smfmac_f32_16x16x64_bf16 v[24:27], v[120:123], v[76:83], v0
  s_waitcnt lgkmcnt(4)
  ds_read_b128 v[108:111], v1 offset:7168
  s_mov_b32 m0, s33
  v_smfmac_f32_16x16x64_bf16 v[16:19], v[92:95], v[160:167], v0
  s_waitcnt lgkmcnt(4)
  ds_read_b128 v[112:115], v2 offset:4096
  v_mov_b32 v122, s98
  v_smfmac_f32_16x16x64_bf16 v[16:19], v[96:99], v[168:175], v0
  s_waitcnt lgkmcnt(4)
  ds_read_b128 v[84:87], v1 offset:4096
  v_smfmac_f32_16x16x64_bf16 v[16:19], v[116:119], v[192:199], v0
  s_waitcnt lgkmcnt(4)
  ds_read_b128 v[88:91], v2 offset:5120
  buffer_load_dwordx4 v10, s[4:7], s28 offen sc1 lds
  v_smfmac_f32_16x16x64_bf16 v[16:19], v[124:127], v[200:207], v0
  s_waitcnt lgkmcnt(4)
  ds_read_b128 v[100:103], v1 offset:5120
  s_mov_b32 m0, s34
  v_smfmac_f32_16x16x64_bf16 v[16:19], v[104:107], a[16:23], v0
  s_waitcnt lgkmcnt(4)
  ds_read_b128 v[68:71], v4 offset:16384
  v_smfmac_f32_16x16x64_bf16 v[16:19], v[108:111], a[24:31], v0
  s_waitcnt lgkmcnt(4)
  ds_read_b128 v[72:75], v4 offset:17408
  v_smfmac_f32_16x16x64_bf16 v[16:19], v[112:115], a[64:71], v0
  s_waitcnt lgkmcnt(4)
  ds_read_b128 v[76:79], v4 offset:18432
  buffer_load_dwordx4 v10, s[4:7], s28 offen offset:256 sc1 lds
  v_smfmac_f32_16x16x64_bf16 v[16:19], v[84:87], a[72:79], v0
  s_waitcnt lgkmcnt(4)
  ds_read_b128 v[80:83], v4 offset:19456
  v_smfmac_f32_16x16x64_bf16 v[16:19], v[88:91], a[112:119], v0
  s_waitcnt lgkmcnt(4)
  v_smfmac_f32_16x16x64_bf16 v[16:19], v[100:103], a[120:127], v0
  s_add_u32 s24, s36, 145752064
  s_add_u32 s25, s36, 145756160
  v_smfmac_f32_16x16x64_bf16 v[20:23], v[92:95], v[176:183], v0
  buffer_store_dword v122, v8, s[4:7], s15 offen sc1
  s_add_u32 s35, s36, s23
  v_smfmac_f32_16x16x64_bf16 v[20:23], v[96:99], v[184:191], v0
  s_waitcnt lgkmcnt(2)
  s_add_u32 s98, s14, 1
  v_smfmac_f32_16x16x64_bf16 v[20:23], v[116:119], v[68:75], v0
  s_waitcnt lgkmcnt(0)
  ds_read_b128 v[68:71], v4 offset:20480
  v_mul_f32 v16, s18, v16
  v_smfmac_f32_16x16x64_bf16 v[20:23], v[124:127], v[76:83], v0
  ds_read_b128 v[72:75], v4 offset:21504
  v_mul_f32 v17, s18, v17
  v_smfmac_f32_16x16x64_bf16 v[20:23], v[104:107], a[32:39], v0
  ds_read_b128 v[76:79], v4 offset:22528
  v_mul_f32 v18, s18, v18
  v_smfmac_f32_16x16x64_bf16 v[20:23], v[108:111], a[40:47], v0
  ds_read_b128 v[80:83], v4 offset:23552
  v_mul_f32 v19, s18, v19
  v_smfmac_f32_16x16x64_bf16 v[20:23], v[112:115], a[80:87], v0
  v_cvt_pk_bf16_f32 v120, v16, v17
  v_smfmac_f32_16x16x64_bf16 v[20:23], v[84:87], a[88:95], v0
  v_cvt_pk_bf16_f32 v121, v18, v19
  v_smfmac_f32_16x16x64_bf16 v[20:23], v[88:91], a[128:135], v0
  ds_write_b64 v5, v[120:121] offset:24576
  v_smfmac_f32_16x16x64_bf16 v[20:23], v[100:103], a[136:143], v0
  s_waitcnt lgkmcnt(3)
  v_smfmac_f32_16x16x64_bf16 v[24:27], v[92:95], v[68:75], v0
  s_waitcnt lgkmcnt(1)
  v_mov_b64 v[92:93], 0
  v_smfmac_f32_16x16x64_bf16 v[24:27], v[96:99], v[76:83], v0
  s_nop 1
  v_cvt_pk_bf16_f32 v122, v20, v21
  v_cvt_pk_bf16_f32 v123, v22, v23
  v_smfmac_f32_16x16x64_bf16 v[24:27], v[116:119], v[208:215], v0
  ds_write_b64 v5, v[122:123] offset:26880
  v_mov_b64 v[94:95], 0
  v_smfmac_f32_16x16x64_bf16 v[24:27], v[124:127], v[216:223], v0
  s_waitcnt lgkmcnt(1)
  s_barrier
  ds_read_b64_tr_b16 v[68:69], v6 offset:24576
  v_smfmac_f32_16x16x64_bf16 v[24:27], v[104:107], a[48:55], v0
  s_add_u32 s27, s27, 8192
  ds_read_b64_tr_b16 v[70:71], v6 offset:24640
  ds_read_b64_tr_b16 v[72:73], v6 offset:24832
  v_smfmac_f32_16x16x64_bf16 v[24:27], v[108:111], a[56:63], v0
  s_add_u32 s28, s28, 8192
  ds_read_b64_tr_b16 v[74:75], v6 offset:24896
  ds_read_b64_tr_b16 v[76:77], v6 offset:25088
  v_smfmac_f32_16x16x64_bf16 v[24:27], v[112:115], a[96:103], v0
  s_nop 0
  ds_read_b64_tr_b16 v[78:79], v6 offset:25152
  ds_read_b64_tr_b16 v[80:81], v6 offset:25344
  v_smfmac_f32_16x16x64_bf16 v[24:27], v[84:87], a[104:111], v0
  ds_read_b64_tr_b16 v[82:83], v6 offset:25408
  v_mov_b64 v[96:97], 0
  v_smfmac_f32_16x16x64_bf16 v[24:27], v[88:91], a[144:151], v0
  s_waitcnt lgkmcnt(8)
  s_barrier
  ds_read_b64_tr_b16 v[116:117], v6 offset:26880
  v_smfmac_f32_16x16x64_bf16 v[24:27], v[100:103], a[152:159], v0
  s_waitcnt lgkmcnt(7)
  ds_read_b64_tr_b16 v[118:119], v6 offset:26944
  v_mfma_f32_16x16x32_bf16 v[16:19], v[36:39], v[68:71], 0
  s_waitcnt lgkmcnt(6)
  ds_read_b64_tr_b16 v[124:125], v6 offset:27136
  ds_read_b64_tr_b16 v[126:127], v6 offset:27200
  v_mfma_f32_16x16x32_bf16 v[16:19], v[40:43], v[72:75], v[16:19]
  s_waitcnt lgkmcnt(6)
  ds_read_b64_tr_b16 v[104:105], v6 offset:27392
  ds_read_b64_tr_b16 v[106:107], v6 offset:27456
  v_mfma_f32_16x16x32_bf16 v[16:19], v[44:47], v[76:79], v[16:19]
  s_waitcnt lgkmcnt(6)
  ds_read_b64_tr_b16 v[108:109], v6 offset:27648
  ds_read_b64_tr_b16 v[110:111], v6 offset:27712
  v_mfma_f32_16x16x32_bf16 v[16:19], v[48:51], v[80:83], v[16:19]
  s_waitcnt lgkmcnt(6)
  v_cvt_pk_bf16_f32 v120, v24, v25
  v_cvt_pk_bf16_f32 v121, v26, v27
  v_mfma_f32_16x16x32_bf16 v[112:115], v[116:119], v[68:71], 0
  s_waitcnt lgkmcnt(4)
  buffer_store_dwordx4 v[120:123], v2, s[4:7], s29 offen offset:2048 sc1
  v_mov_b64 v[98:99], 0
  v_mfma_f32_16x16x32_bf16 v[112:115], v[124:127], v[72:75], v[112:115]
  s_waitcnt lgkmcnt(2)
  v_mov_b64 v[36:37], 0
  v_exp_f32 v100, v16
  v_mfma_f32_16x16x32_bf16 v[112:115], v[104:107], v[76:79], v[112:115]
  s_waitcnt lgkmcnt(0)
  v_exp_f32 v101, v17
  v_mfma_f32_16x16x32_bf16 v[112:115], v[108:111], v[80:83], v[112:115]
  s_add_u32 s29, s29, 131072
  v_exp_f32 v102, v18
  v_mfma_f32_16x16x32_bf16 v[20:23], v[52:55], v[68:71], 0
  s_cmp_eq_u32 s14, 63
  v_exp_f32 v103, v19
  v_mfma_f32_16x16x32_bf16 v[20:23], v[56:59], v[72:75], v[20:23]
  s_cbranch_scc1 M_tdone
  v_cvt_pk_bf16_f32 v44, v100, v101
  v_cvt_pk_bf16_f32 v45, v102, v103
  v_mfma_f32_16x16x32_bf16 v[20:23], v[60:63], v[76:79], v[20:23]
  v_exp_f32 v100, v112
  v_mfma_f32_16x16x32_bf16 v[20:23], v[64:67], v[80:83], v[20:23]
  v_exp_f32 v101, v113
  v_exp_f32 v102, v114
  v_exp_f32 v103, v115
  v_cvt_pk_bf16_f32 v84, v100, v101
  v_cvt_pk_bf16_f32 v85, v102, v103
  v_cndmask_b32 v48, v84, 0, s[16:17]
  v_cndmask_b32 v49, v85, 0, s[16:17]
  v_cndmask_b32 v50, 0, v84, s[16:17]
  v_cndmask_b32 v51, 0, v85, s[16:17]
  v_exp_f32 v100, v20
  v_mfma_f32_16x16x16_bf16 v[88:91], v[12:13], v[48:49], 0
  v_exp_f32 v101, v21
  v_mfma_f32_16x16x16_bf16 v[24:27], v[120:121], v[48:49], 0
  v_exp_f32 v102, v22
  v_mfma_f32_16x16x16_bf16 v[116:119], v[120:121], v[50:51], 0
  v_exp_f32 v103, v23
  v_cvt_pk_bf16_f32 v46, v100, v101
  v_cvt_pk_bf16_f32 v47, v102, v103
  v_mov_b64 v[38:39], 0
  s_nop 0
  v_mfma_f32_16x16x32_bf16 v[88:91], v[12:15], v[44:47], v[88:91]
  v_mov_b64 v[40:41], 0
  v_mov_b64 v[42:43], 0
  v_mfma_f32_16x16x32_bf16 v[24:27], v[28:31], v[44:47], v[24:27]
  ds_read_b128 v[52:55], v4 offset:24576
  ds_read_b128 v[56:59], v4 offset:25600
  v_mfma_f32_16x16x32_bf16 v[116:119], v[32:35], v[44:47], v[116:119]
  s_nop 1
  v_rcp_f32 v89, v88
  v_subrev_u32 v100, s54, v88
  v_cmp_le_u32 vcc, s55, v100
  v_mul_f32 v24, v89, v24
  v_mul_f32 v25, v89, v25
  s_cbranch_vccnz T_slow_128
T_back_129:
  v_cvt_pk_bf16_f32 v124, v24, v25
  v_pk_mul_f32 v[26:27], v[26:27], v[88:89] op_sel:[0,1] op_sel_hi:[1,1]
  v_pk_mul_f32 v[116:117], v[116:117], v[88:89] op_sel:[0,1] op_sel_hi:[1,1]
  v_pk_mul_f32 v[118:119], v[118:119], v[88:89] op_sel:[0,1] op_sel_hi:[1,1]
  v_cvt_pk_bf16_f32 v125, v26, v27
  v_cvt_pk_bf16_f32 v126, v116, v117
  v_cvt_pk_bf16_f32 v127, v118, v119
  ds_write_b128 v11, v[124:127] offset:30208
  s_nop 0
  v_smfmac_f32_16x16x64_bf16 v[92:95], v[124:127], a[160:167], v0
  v_smfmac_f32_16x16x64_bf16 v[96:99], v[124:127], a[168:175], v0
  v_smfmac_f32_16x16x64_bf16 v[36:39], v[124:127], a[176:183], v0
  v_smfmac_f32_16x16x64_bf16 v[40:43], v[124:127], a[184:191], v0
  s_waitcnt lgkmcnt(0)
  s_barrier
  ds_read_b128 v[104:107], v11 offset:30720
  ds_read_b128 v[108:111], v11 offset:29184
  ds_read_b128 v[68:71], v11 offset:29696
  s_waitcnt lgkmcnt(2)
  v_smfmac_f32_16x16x64_bf16 v[92:95], v[104:107], a[192:199], v0
  s_waitcnt lgkmcnt(1)
  ds_read_b128 v[76:79], v4 offset:28672
  v_smfmac_f32_16x16x64_bf16 v[92:95], v[108:111], a[224:231], v0
  s_waitcnt lgkmcnt(1)
  ds_read_b128 v[80:83], v4 offset:29696
  v_smfmac_f32_16x16x64_bf16 v[92:95], v[68:71], a[240:247], v0
  ds_read_b128 v[60:63], v4 offset:26624
  v_smfmac_f32_16x16x64_bf16 v[96:99], v[104:107], a[200:207], v0
  ds_read_b128 v[64:67], v4 offset:27648
  v_smfmac_f32_16x16x64_bf16 v[96:99], v[108:111], a[232:239], v0
  ds_read_b128 v[28:31], v4 offset:30720
  s_nop 0
  v_cvt_pk_bf16_f32 v16, v92, v93
  v_cvt_pk_bf16_f32 v17, v94, v95
  v_bfi_b32 v16, 1, s57, v16
  v_smfmac_f32_16x16x64_bf16 v[96:99], v[68:71], a[248:255], v0
  buffer_store_dwordx2 v[16:17], v7, s[4:7], s20 offen offset:0
  v_smfmac_f32_16x16x64_bf16 v[36:39], v[104:107], a[208:215], v0
  ds_read_b128 v[32:35], v4 offset:31744
  v_smfmac_f32_16x16x64_bf16 v[36:39], v[108:111], v[52:59], v0
  s_waitcnt lgkmcnt(4)
  s_nop 0
  v_cvt_pk_bf16_f32 v18, v96, v97
  v_cvt_pk_bf16_f32 v19, v98, v99
  v_bfi_b32 v18, 1, s57, v18
  v_smfmac_f32_16x16x64_bf16 v[36:39], v[68:71], v[76:83], v0
  buffer_store_dwordx2 v[18:19], v7, s[4:7], s20 offen offset:64
  v_smfmac_f32_16x16x64_bf16 v[40:43], v[104:107], a[216:223], v0
  s_waitcnt lgkmcnt(2)
  v_smfmac_f32_16x16x64_bf16 v[40:43], v[108:111], v[60:67], v0
  s_waitcnt lgkmcnt(0)
  s_nop 0
  v_cvt_pk_bf16_f32 v20, v36, v37
  v_cvt_pk_bf16_f32 v21, v38, v39
  v_bfi_b32 v20, 1, s57, v20
  v_smfmac_f32_16x16x64_bf16 v[40:43], v[68:71], v[28:35], v0
  buffer_store_dwordx2 v[20:21], v7, s[4:7], s21 offen offset:0
  s_nop 6
  v_cvt_pk_bf16_f32 v22, v40, v41
  v_cvt_pk_bf16_f32 v23, v42, v43
  v_bfi_b32 v22, 1, s57, v22
  buffer_store_dwordx2 v[22:23], v7, s[4:7], s21 offen offset:64
  ds_read_b128 v[68:71], v4 offset:0
  ds_read_b128 v[72:75], v4 offset:1024
  ds_read_b128 v[76:79], v4 offset:4096
  ds_read_b128 v[80:83], v4 offset:5120
  ds_read_b128 v[84:87], v4 offset:8192
  ds_read_b128 v[88:91], v4 offset:9216
  ds_read_b128 v[92:95], v4 offset:2048
  ds_read_b128 v[96:99], v4 offset:3072
  ds_read_b128 v[100:103], v4 offset:6144
  ds_read_b128 v[104:107], v4 offset:7168
  ds_read_b128 v[108:111], v4 offset:10240
  ds_read_b128 v[112:115], v4 offset:11264
  v_mov_b64 v[16:17], 0
  v_mov_b64 v[18:19], 0
  v_mov_b64 v[20:21], 0
  v_mov_b64 v[22:23], 0
  v_mov_b64 v[24:25], 0
  v_mov_b64 v[26:27], 0
  ds_read_b64 v[44:45], v2 offset:32256
  s_waitcnt lgkmcnt(0)
  v_readfirstlane_b32 s38, v44
  v_readfirstlane_b32 s37, v45
  s_nop 0
  s_add_u32 s37, s37, 30
  s_cmp_ge_u32 s38, 30
  s_cselect_b32 s38, s37, s38
  s_cmp_ge_u32 s38, 64
  s_cselect_b32 s38, 100, s38
  s_sub_u32 s38, s38, 1
  s_max_i32 s30, s30, s38
  s_waitcnt vmcnt(4)
  s_barrier
  ds_read_b128 v[28:31], v2 offset:18432
  ds_read_b128 v[32:35], v2 offset:22528
  ds_read_b128 v[36:39], v2 offset:8192
  ds_read_b128 v[40:43], v2 offset:9216
  ds_read_b128 v[44:47], v2 offset:10240
  ds_read_b128 v[48:51], v2 offset:11264
  buffer_load_dwordx4 v[124:127], v3, s[4:7], s24 offen offset:2048 sc1
  buffer_load_dwordx4 v[116:119], v3, s[4:7], s25 offen offset:2048 sc1
  ds_read_b128 v[52:55], v2 offset:12288
  ds_read_b128 v[56:59], v2 offset:13312
  ds_read_b128 v[60:63], v2 offset:14336
  ds_read_b128 v[64:67], v2 offset:15360
  buffer_load_dwordx4 v[124:127], v3, s[4:7], s24 offen offset:2048 sc1
  buffer_load_dwordx4 v[116:119], v3, s[4:7], s25 offen offset:2048 sc1
  s_mov_b32 s19, 0
  s_branch T_loop_121
T_kvw_125:
  s_mov_b32 s19, 0
  s_branch T_kvok_134
T_kv_133:
  s_sleep 4
  s_add_u32 s19, s19, 1
  s_cmp_gt_u32 s19, 32768
  s_cbranch_scc1 M_exit
T_kvok_134:
  s_add_u32 s39, s99, 128
  s_mov_b32 s38, 0
  s_mov_b32 s37, 0
  s_atomic_or s38, s[58:59], s99 glc
  s_atomic_or s37, s[58:59], s39 glc
  s_waitcnt lgkmcnt(0)
  s_add_u32 s37, s37, 30
  s_cmp_ge_u32 s38, 30
  s_cselect_b32 s38, s37, s38
  s_cmp_ge_u32 s38, 64
  s_cselect_b32 s38, 100, s38
  s_sub_u32 s38, s38, 1
  s_max_i32 s30, s30, s38
  s_cmp_ge_i32 s14, s30
  s_cbranch_scc1 T_kv_133
  s_branch T_kvb_126
T_slow_128:
  s_nop 7
  v_max3_f32 v100, v16, v17, v18
  v_max3_f32 v100, v100, v19, v20
  v_max3_f32 v100, v100, v21, v22
  v_max3_f32 v100, v100, v23, v112
  v_max3_f32 v100, v100, v113, v114
  v_max_f32 v100, v100, v115
  v_mov_b32 v101, v100
  s_nop 1
  v_permlane32_swap_b32 v100, v101
  s_nop 1
  v_max_f32 v100, v100, v101
  v_mov_b32 v101, v100
  s_nop 1
  v_permlane16_swap_b32 v100, v101
  s_nop 1
  v_max_f32 v100, v100, v101
  v_sub_f32 v16, v16, v100
  v_sub_f32 v17, v17, v100
  v_sub_f32 v18, v18, v100
  v_sub_f32 v19, v19, v100
  v_exp_f32 v16, v16
  v_exp_f32 v17, v17
  v_exp_f32 v18, v18
  v_exp_f32 v19, v19
  v_sub_f32 v20, v20, v100
  v_sub_f32 v21, v21, v100
  v_sub_f32 v22, v22, v100
  v_sub_f32 v23, v23, v100
  v_exp_f32 v20, v20
  v_exp_f32 v21, v21
  v_exp_f32 v22, v22
  v_exp_f32 v23, v23
  v_sub_f32 v112, v112, v100
  v_sub_f32 v113, v113, v100
  v_sub_f32 v114, v114, v100
  v_sub_f32 v115, v115, v100
  v_exp_f32 v112, v112
  v_exp_f32 v113, v113
  v_exp_f32 v114, v114
  v_exp_f32 v115, v115
  s_nop 0
  v_cvt_pk_bf16_f32 v44, v16, v17
  v_cvt_pk_bf16_f32 v45, v18, v19
  v_cvt_pk_bf16_f32 v46, v20, v21
  v_cvt_pk_bf16_f32 v47, v22, v23
  v_cvt_pk_bf16_f32 v84, v112, v113
  v_cvt_pk_bf16_f32 v85, v114, v115
  v_cndmask_b32 v48, v84, 0, s[16:17]
  v_cndmask_b32 v49, v85, 0, s[16:17]
  v_cndmask_b32 v50, 0, v84, s[16:17]
  v_cndmask_b32 v51, 0, v85, s[16:17]
  s_nop 1
  v_mfma_f32_16x16x16_bf16 v[88:91], v[12:13], v[48:49], 0
  v_mfma_f32_16x16x16_bf16 v[24:27], v[120:121], v[48:49], 0
  v_mfma_f32_16x16x16_bf16 v[116:119], v[120:121], v[50:51], 0
  v_mfma_f32_16x16x32_bf16 v[88:91], v[12:15], v[44:47], v[88:91]
  v_mfma_f32_16x16x32_bf16 v[24:27], v[28:31], v[44:47], v[24:27]
  v_mfma_f32_16x16x32_bf16 v[116:119], v[32:35], v[44:47], v[116:119]
  s_nop 7
  s_nop 1
  v_rcp_f32 v89, v88
  s_nop 0
  v_mul_f32 v24, v89, v24
  v_mul_f32 v25, v89, v25
  s_branch T_back_129
T_w_92:
  s_mov_b32 s19, 0
  v_mov_b64 v[16:17], 0
  v_mov_b64 v[18:19], 0
  v_mov_b64 v[20:21], 0
  v_mov_b64 v[22:23], 0
  v_mov_b64 v[24:25], 0
  v_mov_b64 v[26:27], 0
  buffer_load_dwordx4 v[124:127], v3, s[4:7], s24 offen offset:3072 sc1
  buffer_load_dwordx4 v[116:119], v3, s[4:7], s25 offen offset:3072 sc1
  buffer_load_dwordx4 v[124:127], v3, s[4:7], s24 offen offset:3072 sc1
  buffer_load_dwordx4 v[116:119], v3, s[4:7], s25 offen offset:3072 sc1
  s_branch T_loop_135
.p2align 6
T_retry_136:
  s_mov_b64 exec, vcc
  buffer_load_dwordx4 v[124:127], v3, s[4:7], s24 offen offset:3072 sc1
  buffer_load_dwordx4 v[116:119], v3, s[4:7], s25 offen offset:3072 sc1
  s_mov_b64 exec, -1
  s_add_u32 s19, s19, 1
  s_cmp_gt_u32 s19, 32768
  s_cbranch_scc1 M_exit
T_loop_135:
  s_waitcnt vmcnt(3) lgkmcnt(0)
  v_max3_u32 v123, v124, v125, v126
  v_max_u32 v123, v123, v127
  v_mov_b32_dpp v120, v124 row_ror:8 row_mask:0xf bank_mask:0xf
  v_mov_b32_dpp v121, v125 row_ror:8 row_mask:0xf bank_mask:0xf
  s_waitcnt vmcnt(2)
  v_max3_u32 v123, v123, v116, v117
  v_max3_u32 v123, v123, v118, v119
  v_cmp_eq_u32 vcc, -1, v123
  s_cbranch_vccnz T_retry_136
  v_smfmac_f32_16x16x64_bf16 v[16:19], v[124:127], v[68:75], v0
  s_add_u32 s14, s14, 1
  ds_write_b128 v2, v[124:127] offset:3072
  v_mov_b32_dpp v122, v126 row_ror:8 row_mask:0xf bank_mask:0xf
  v_smfmac_f32_16x16x64_bf16 v[20:23], v[124:127], v[76:83], v0
  s_and_b32 s57, s14, 1
  v_mov_b32_dpp v123, v127 row_ror:8 row_mask:0xf bank_mask:0xf
  v_smfmac_f32_16x16x64_bf16 v[24:27], v[124:127], v[84:91], v0
  s_and_b32 s36, s14, 3
  ds_write_b128 v2, v[116:119] offset:7168
  v_smfmac_f32_16x16x64_bf16 v[16:19], v[120:123], v[92:99], v0
  s_lshl_b32 s36, s36, 13
  v_mov_b32_dpp v84, v116 row_ror:8 row_mask:0xf bank_mask:0xf
  v_smfmac_f32_16x16x64_bf16 v[20:23], v[120:123], v[100:107], v0
  s_add_u32 s26, s36, s23
  ds_read_b128 v[68:71], v4 offset:12288
  v_mov_b32_dpp v85, v117 row_ror:8 row_mask:0xf bank_mask:0xf
  v_smfmac_f32_16x16x64_bf16 v[24:27], v[120:123], v[108:115], v0
  s_add_u32 s36, s36, 8192
  ds_read_b128 v[72:75], v4 offset:13312
  v_mov_b32_dpp v86, v118 row_ror:8 row_mask:0xf bank_mask:0xf
  v_smfmac_f32_16x16x64_bf16 v[16:19], v[116:119], v[224:231], v0
  s_and_b32 s36, s36, 0x7fff
  ds_read_b128 v[76:79], v4 offset:14336
  v_mov_b32_dpp v87, v119 row_ror:8 row_mask:0xf bank_mask:0xf
  v_smfmac_f32_16x16x64_bf16 v[20:23], v[116:119], v[240:247], v0
  s_waitcnt lgkmcnt(3)
  s_barrier
  ds_read_b128 v[100:103], v2 offset:2048
  v_smfmac_f32_16x16x64_bf16 v[24:27], v[116:119], a[0:7], v0
  s_mov_b32 m0, s31
  ds_read_b128 v[120:123], v1 offset:2048
  v_smfmac_f32_16x16x64_bf16 v[16:19], v[84:87], v[232:239], v0
  s_cmp_ge_i32 s14, s30
  s_cbranch_scc1 T_kvw_139
T_kvb_140:
  v_smfmac_f32_16x16x64_bf16 v[20:23], v[84:87], v[248:255], v0
  ds_read_b128 v[80:83], v4 offset:15360
  v_smfmac_f32_16x16x64_bf16 v[24:27], v[84:87], a[8:15], v0
  s_waitcnt lgkmcnt(2)
  v_smfmac_f32_16x16x64_bf16 v[16:19], v[100:103], v[128:135], v0
  ds_read_b128 v[92:95], v2 offset:1024
  v_smfmac_f32_16x16x64_bf16 v[20:23], v[100:103], v[144:151], v0
  ds_read_b128 v[96:99], v1 offset:1024
  buffer_load_dwordx4 v9, s[4:7], s27 offen sc1 lds
  v_smfmac_f32_16x16x64_bf16 v[24:27], v[100:103], v[68:75], v0
  s_waitcnt vmcnt(1) lgkmcnt(3)
  ds_read_b128 v[116:119], v2 offset:0
  s_mov_b32 m0, s32
  v_smfmac_f32_16x16x64_bf16 v[16:19], v[120:123], v[136:143], v0
  ds_read_b128 v[124:127], v1 offset:0
  v_smfmac_f32_16x16x64_bf16 v[20:23], v[120:123], v[152:159], v0
  s_waitcnt lgkmcnt(4)
  ds_read_b128 v[104:107], v2 offset:6144
  v_smfmac_f32_16x16x64_bf16 v[24:27], v[120:123], v[76:83], v0
  s_waitcnt lgkmcnt(4)
  ds_read_b128 v[108:111], v1 offset:6144
  buffer_load_dwordx4 v9, s[4:7], s27 offen offset:128 sc1 lds
  v_smfmac_f32_16x16x64_bf16 v[16:19], v[92:95], v[160:167], v0
  s_waitcnt lgkmcnt(4)
  ds_read_b128 v[112:115], v2 offset:5120
  s_mov_b32 m0, s33
  v_smfmac_f32_16x16x64_bf16 v[16:19], v[96:99], v[168:175], v0
  s_waitcnt lgkmcnt(4)
  ds_read_b128 v[84:87], v1 offset:5120
  v_smfmac_f32_16x16x64_bf16 v[16:19], v[116:119], v[192:199], v0
  s_waitcnt lgkmcnt(4)
  ds_read_b128 v[88:91], v2 offset:4096
  v_smfmac_f32_16x16x64_bf16 v[16:19], v[124:127], v[200:207], v0
  s_waitcnt lgkmcnt(4)
  ds_read_b128 v[100:103], v1 offset:4096
  buffer_load_dwordx4 v10, s[4:7], s28 offen sc1 lds
  v_smfmac_f32_16x16x64_bf16 v[16:19], v[104:107], a[16:23], v0
  s_waitcnt lgkmcnt(4)
  ds_read_b128 v[68:71], v4 offset:16384
  s_mov_b32 m0, s34
  v_smfmac_f32_16x16x64_bf16 v[16:19], v[108:111], a[24:31], v0
  s_waitcnt lgkmcnt(4)
  ds_read_b128 v[72:75], v4 offset:17408
  v_smfmac_f32_16x16x64_bf16 v[16:19], v[112:115], a[64:71], v0
  s_waitcnt lgkmcnt(4)
  ds_read_b128 v[76:79], v4 offset:18432
  v_smfmac_f32_16x16x64_bf16 v[16:19], v[84:87], a[72:79], v0
  s_waitcnt lgkmcnt(4)
  ds_read_b128 v[80:83], v4 offset:19456
  buffer_load_dwordx4 v10, s[4:7], s28 offen offset:256 sc1 lds
  v_smfmac_f32_16x16x64_bf16 v[16:19], v[88:91], a[112:119], v0
  s_waitcnt lgkmcnt(4)
  s_mov_b32 m0, 32256
  v_smfmac_f32_16x16x64_bf16 v[16:19], v[100:103], a[120:127], v0
  s_add_u32 s24, s36, 145752064
  s_add_u32 s25, s36, 145756160
  v_smfmac_f32_16x16x64_bf16 v[20:23], v[92:95], v[176:183], v0
  s_add_u32 s35, s36, s23
  v_smfmac_f32_16x16x64_bf16 v[20:23], v[96:99], v[184:191], v0
  s_waitcnt lgkmcnt(2)
  buffer_load_dword v8, s[4:7], s99 offen sc1 lds
  v_smfmac_f32_16x16x64_bf16 v[20:23], v[116:119], v[68:75], v0
  s_waitcnt lgkmcnt(0)
  ds_read_b128 v[68:71], v4 offset:20480
  v_mul_f32 v16, s18, v16
  v_smfmac_f32_16x16x64_bf16 v[20:23], v[124:127], v[76:83], v0
  ds_read_b128 v[72:75], v4 offset:21504
  v_mul_f32 v17, s18, v17
  v_smfmac_f32_16x16x64_bf16 v[20:23], v[104:107], a[32:39], v0
  ds_read_b128 v[76:79], v4 offset:22528
  v_mul_f32 v18, s18, v18
  v_smfmac_f32_16x16x64_bf16 v[20:23], v[108:111], a[40:47], v0
  ds_read_b128 v[80:83], v4 offset:23552
  v_mul_f32 v19, s18, v19
  v_smfmac_f32_16x16x64_bf16 v[20:23], v[112:115], a[80:87], v0
  v_cvt_pk_bf16_f32 v120, v16, v17
  v_smfmac_f32_16x16x64_bf16 v[20:23], v[84:87], a[88:95], v0
  v_cvt_pk_bf16_f32 v121, v18, v19
  v_smfmac_f32_16x16x64_bf16 v[20:23], v[88:91], a[128:135], v0
  ds_write_b64 v5, v[120:121] offset:24576
  v_smfmac_f32_16x16x64_bf16 v[20:23], v[100:103], a[136:143], v0
  s_waitcnt lgkmcnt(3)
  v_smfmac_f32_16x16x64_bf16 v[24:27], v[92:95], v[68:75], v0
  s_waitcnt lgkmcnt(1)
  v_mov_b64 v[92:93], 0
  v_smfmac_f32_16x16x64_bf16 v[24:27], v[96:99], v[76:83], v0
  s_nop 1
  v_cvt_pk_bf16_f32 v122, v20, v21
  v_cvt_pk_bf16_f32 v123, v22, v23
  v_smfmac_f32_16x16x64_bf16 v[24:27], v[116:119], v[208:215], v0
  ds_write_b64 v5, v[122:123] offset:26880
  v_mov_b64 v[94:95], 0
  v_smfmac_f32_16x16x64_bf16 v[24:27], v[124:127], v[216:223], v0
  s_waitcnt lgkmcnt(1)
  s_barrier
  ds_read_b64_tr_b16 v[68:69], v6 offset:24576
  v_smfmac_f32_16x16x64_bf16 v[24:27], v[104:107], a[48:55], v0
  s_add_u32 s27, s27, 8192
  ds_read_b64_tr_b16 v[70:71], v6 offset:24640
  ds_read_b64_tr_b16 v[72:73], v6 offset:24832
  v_smfmac_f32_16x16x64_bf16 v[24:27], v[108:111], a[56:63], v0
  s_add_u32 s28, s28, 8192
  ds_read_b64_tr_b16 v[74:75], v6 offset:24896
  ds_read_b64_tr_b16 v[76:77], v6 offset:25088
  v_smfmac_f32_16x16x64_bf16 v[24:27], v[112:115], a[96:103], v0
  s_nop 0
  ds_read_b64_tr_b16 v[78:79], v6 offset:25152
  ds_read_b64_tr_b16 v[80:81], v6 offset:25344
  v_smfmac_f32_16x16x64_bf16 v[24:27], v[84:87], a[104:111], v0
  ds_read_b64_tr_b16 v[82:83], v6 offset:25408
  v_mov_b64 v[96:97], 0
  v_smfmac_f32_16x16x64_bf16 v[24:27], v[88:91], a[144:151], v0
  s_waitcnt lgkmcnt(8)
  s_barrier
  ds_read_b64_tr_b16 v[116:117], v6 offset:26880
  v_smfmac_f32_16x16x64_bf16 v[24:27], v[100:103], a[152:159], v0
  s_waitcnt lgkmcnt(7)
  ds_read_b64_tr_b16 v[118:119], v6 offset:26944
  v_mfma_f32_16x16x32_bf16 v[16:19], v[36:39], v[68:71], 0
  s_waitcnt lgkmcnt(6)
  ds_read_b64_tr_b16 v[124:125], v6 offset:27136
  ds_read_b64_tr_b16 v[126:127], v6 offset:27200
  v_mfma_f32_16x16x32_bf16 v[16:19], v[40:43], v[72:75], v[16:19]
  s_waitcnt lgkmcnt(6)
  ds_read_b64_tr_b16 v[104:105], v6 offset:27392
  ds_read_b64_tr_b16 v[106:107], v6 offset:27456
  v_mfma_f32_16x16x32_bf16 v[16:19], v[44:47], v[76:79], v[16:19]
  s_waitcnt lgkmcnt(6)
  ds_read_b64_tr_b16 v[108:109], v6 offset:27648
  ds_read_b64_tr_b16 v[110:111], v6 offset:27712
  v_mfma_f32_16x16x32_bf16 v[16:19], v[48:51], v[80:83], v[16:19]
  s_waitcnt lgkmcnt(6)
  v_cvt_pk_bf16_f32 v120, v24, v25
  v_cvt_pk_bf16_f32 v121, v26, v27
  v_mfma_f32_16x16x32_bf16 v[112:115], v[116:119], v[68:71], 0
  s_waitcnt lgkmcnt(4)
  buffer_store_dwordx4 v[120:123], v2, s[4:7], s29 offen offset:3072 sc1
  v_mov_b64 v[98:99], 0
  v_mfma_f32_16x16x32_bf16 v[112:115], v[124:127], v[72:75], v[112:115]
  s_waitcnt lgkmcnt(2)
  v_mov_b64 v[36:37], 0
  v_exp_f32 v100, v16
  v_mfma_f32_16x16x32_bf16 v[112:115], v[104:107], v[76:79], v[112:115]
  s_waitcnt lgkmcnt(0)
  v_exp_f32 v101, v17
  v_mfma_f32_16x16x32_bf16 v[112:115], v[108:111], v[80:83], v[112:115]
  s_add_u32 s29, s29, 131072
  v_exp_f32 v102, v18
  v_mfma_f32_16x16x32_bf16 v[20:23], v[52:55], v[68:71], 0
  s_cmp_eq_u32 s14, 63
  v_exp_f32 v103, v19
  v_mfma_f32_16x16x32_bf16 v[20:23], v[56:59], v[72:75], v[20:23]
  s_cbranch_scc1 M_tdone
  v_cvt_pk_bf16_f32 v44, v100, v101
  v_cvt_pk_bf16_f32 v45, v102, v103
  v_mfma_f32_16x16x32_bf16 v[20:23], v[60:63], v[76:79], v[20:23]
  v_exp_f32 v100, v112
  v_mfma_f32_16x16x32_bf16 v[20:23], v[64:67], v[80:83], v[20:23]
  v_exp_f32 v101, v113
  v_exp_f32 v102, v114
  v_exp_f32 v103, v115
  v_cvt_pk_bf16_f32 v84, v100, v101
  v_cvt_pk_bf16_f32 v85, v102, v103
  v_cndmask_b32 v48, v84, 0, s[16:17]
  v_cndmask_b32 v49, v85, 0, s[16:17]
  v_cndmask_b32 v50, 0, v84, s[16:17]
  v_cndmask_b32 v51, 0, v85, s[16:17]
  v_exp_f32 v100, v20
  v_mfma_f32_16x16x16_bf16 v[88:91], v[12:13], v[48:49], 0
  v_exp_f32 v101, v21
  v_mfma_f32_16x16x16_bf16 v[24:27], v[120:121], v[48:49], 0
  v_exp_f32 v102, v22
  v_mfma_f32_16x16x16_bf16 v[116:119], v[120:121], v[50:51], 0
  v_exp_f32 v103, v23
  v_cvt_pk_bf16_f32 v46, v100, v101
  v_cvt_pk_bf16_f32 v47, v102, v103
  v_mov_b64 v[38:39], 0
  s_nop 0
  v_mfma_f32_16x16x32_bf16 v[88:91], v[12:15], v[44:47], v[88:91]
  v_mov_b64 v[40:41], 0
  v_mov_b64 v[42:43], 0
  v_mfma_f32_16x16x32_bf16 v[24:27], v[28:31], v[44:47], v[24:27]
  ds_read_b128 v[52:55], v4 offset:24576
  ds_read_b128 v[56:59], v4 offset:25600
  v_mfma_f32_16x16x32_bf16 v[116:119], v[32:35], v[44:47], v[116:119]
  s_nop 1
  v_rcp_f32 v89, v88
  v_subrev_u32 v100, s54, v88
  v_cmp_le_u32 vcc, s55, v100
  v_mul_f32 v24, v89, v24
  v_mul_f32 v25, v89, v25
  s_cbranch_vccnz T_slow_142
T_back_143:
  v_cvt_pk_bf16_f32 v124, v24, v25
  v_pk_mul_f32 v[26:27], v[26:27], v[88:89] op_sel:[0,1] op_sel_hi:[1,1]
  v_pk_mul_f32 v[116:117], v[116:117], v[88:89] op_sel:[0,1] op_sel_hi:[1,1]
  v_pk_mul_f32 v[118:119], v[118:119], v[88:89] op_sel:[0,1] op_sel_hi:[1,1]
  v_cvt_pk_bf16_f32 v125, v26, v27
  v_cvt_pk_bf16_f32 v126, v116, v117
  v_cvt_pk_bf16_f32 v127, v118, v119
  ds_write_b128 v11, v[124:127] offset:30720
  s_nop 0
  v_smfmac_f32_16x16x64_bf16 v[92:95], v[124:127], a[160:167], v0
  v_smfmac_f32_16x16x64_bf16 v[96:99], v[124:127], a[168:175], v0
  v_smfmac_f32_16x16x64_bf16 v[36:39], v[124:127], a[176:183], v0
  v_smfmac_f32_16x16x64_bf16 v[40:43], v[124:127], a[184:191], v0
  s_waitcnt lgkmcnt(0)
  s_barrier
  ds_read_b128 v[104:107], v11 offset:30208
  ds_read_b128 v[108:111], v11 offset:29696
  ds_read_b128 v[68:71], v11 offset:29184
  s_waitcnt lgkmcnt(2)
  v_smfmac_f32_16x16x64_bf16 v[92:95], v[104:107], a[192:199], v0
  s_waitcnt lgkmcnt(1)
  ds_read_b128 v[76:79], v4 offset:28672
  v_smfmac_f32_16x16x64_bf16 v[92:95], v[108:111], a[224:231], v0
  s_waitcnt lgkmcnt(1)
  ds_read_b128 v[80:83], v4 offset:29696
  v_smfmac_f32_16x16x64_bf16 v[92:95], v[68:71], a[240:247], v0
  ds_read_b128 v[60:63], v4 offset:26624
  v_smfmac_f32_16x16x64_bf16 v[96:99], v[104:107], a[200:207], v0
  ds_read_b128 v[64:67], v4 offset:27648
  v_smfmac_f32_16x16x64_bf16 v[96:99], v[108:111], a[232:239], v0
  ds_read_b128 v[28:31], v4 offset:30720
  s_nop 0
  v_cvt_pk_bf16_f32 v16, v92, v93
  v_cvt_pk_bf16_f32 v17, v94, v95
  v_bfi_b32 v16, 1, s57, v16
  v_smfmac_f32_16x16x64_bf16 v[96:99], v[68:71], a[248:255], v0
  buffer_store_dwordx2 v[16:17], v7, s[4:7], s20 offen offset:0
  v_smfmac_f32_16x16x64_bf16 v[36:39], v[104:107], a[208:215], v0
  ds_read_b128 v[32:35], v4 offset:31744
  v_smfmac_f32_16x16x64_bf16 v[36:39], v[108:111], v[52:59], v0
  s_waitcnt lgkmcnt(4)
  s_nop 0
  v_cvt_pk_bf16_f32 v18, v96, v97
  v_cvt_pk_bf16_f32 v19, v98, v99
  v_bfi_b32 v18, 1, s57, v18
  v_smfmac_f32_16x16x64_bf16 v[36:39], v[68:71], v[76:83], v0
  buffer_store_dwordx2 v[18:19], v7, s[4:7], s20 offen offset:64
  v_smfmac_f32_16x16x64_bf16 v[40:43], v[104:107], a[216:223], v0
  s_waitcnt lgkmcnt(2)
  v_smfmac_f32_16x16x64_bf16 v[40:43], v[108:111], v[60:67], v0
  s_waitcnt lgkmcnt(0)
  s_nop 0
  v_cvt_pk_bf16_f32 v20, v36, v37
  v_cvt_pk_bf16_f32 v21, v38, v39
  v_bfi_b32 v20, 1, s57, v20
  v_smfmac_f32_16x16x64_bf16 v[40:43], v[68:71], v[28:35], v0
  buffer_store_dwordx2 v[20:21], v7, s[4:7], s21 offen offset:0
  s_nop 6
  v_cvt_pk_bf16_f32 v22, v40, v41
  v_cvt_pk_bf16_f32 v23, v42, v43
  v_bfi_b32 v22, 1, s57, v22
  buffer_store_dwordx2 v[22:23], v7, s[4:7], s21 offen offset:64
  ds_read_b128 v[68:71], v4 offset:0
  ds_read_b128 v[72:75], v4 offset:1024
  ds_read_b128 v[76:79], v4 offset:4096
  ds_read_b128 v[80:83], v4 offset:5120
  ds_read_b128 v[84:87], v4 offset:8192
  ds_read_b128 v[88:91], v4 offset:9216
  ds_read_b128 v[92:95], v4 offset:2048
  ds_read_b128 v[96:99], v4 offset:3072
  ds_read_b128 v[100:103], v4 offset:6144
  ds_read_b128 v[104:107], v4 offset:7168
  ds_read_b128 v[108:111], v4 offset:10240
  ds_read_b128 v[112:115], v4 offset:11264
  v_mov_b64 v[16:17], 0
  v_mov_b64 v[18:19], 0
  v_mov_b64 v[20:21], 0
  v_mov_b64 v[22:23], 0
  v_mov_b64 v[24:25], 0
  v_mov_b64 v[26:27], 0
  ds_read_b64 v[44:45], v2 offset:32256
  s_waitcnt lgkmcnt(0)
  v_readfirstlane_b32 s38, v44
  v_readfirstlane_b32 s37, v45
  s_nop 0
  s_add_u32 s37, s37, 30
  s_cmp_ge_u32 s38, 30
  s_cselect_b32 s38, s37, s38
  s_cmp_ge_u32 s38, 64
  s_cselect_b32 s38, 100, s38
  s_sub_u32 s38, s38, 1
  s_max_i32 s30, s30, s38
  s_waitcnt vmcnt(4)
  s_barrier
  ds_read_b128 v[28:31], v2 offset:19456
  ds_read_b128 v[32:35], v2 offset:23552
  ds_read_b128 v[36:39], v2 offset:8192
  ds_read_b128 v[40:43], v2 offset:9216
  ds_read_b128 v[44:47], v2 offset:10240
  ds_read_b128 v[48:51], v2 offset:11264
  buffer_load_dwordx4 v[124:127], v3, s[4:7], s24 offen offset:3072 sc1
  buffer_load_dwordx4 v[116:119], v3, s[4:7], s25 offen offset:3072 sc1
  ds_read_b128 v[52:55], v2 offset:12288
  ds_read_b128 v[56:59], v2 offset:13312
  ds_read_b128 v[60:63], v2 offset:14336
  ds_read_b128 v[64:67], v2 offset:15360
  buffer_load_dwordx4 v[124:127], v3, s[4:7], s24 offen offset:3072 sc1
  buffer_load_dwordx4 v[116:119], v3, s[4:7], s25 offen offset:3072 sc1
  s_mov_b32 s19, 0
  s_branch T_loop_135
T_kvw_139:
  s_mov_b32 s19, 0
  s_branch T_kvok_148
T_kv_147:
  s_sleep 4
  s_add_u32 s19, s19, 1
  s_cmp_gt_u32 s19, 32768
  s_cbranch_scc1 M_exit
T_kvok_148:
  s_add_u32 s39, s99, 128
  s_mov_b32 s38, 0
  s_mov_b32 s37, 0
  s_atomic_or s38, s[58:59], s99 glc
  s_atomic_or s37, s[58:59], s39 glc
  s_waitcnt lgkmcnt(0)
  s_add_u32 s37, s37, 30
  s_cmp_ge_u32 s38, 30
  s_cselect_b32 s38, s37, s38
  s_cmp_ge_u32 s38, 64
  s_cselect_b32 s38, 100, s38
  s_sub_u32 s38, s38, 1
  s_max_i32 s30, s30, s38
  s_cmp_ge_i32 s14, s30
  s_cbranch_scc1 T_kv_147
  s_branch T_kvb_140
T_slow_142:
  s_nop 7
  v_max3_f32 v100, v16, v17, v18
  v_max3_f32 v100, v100, v19, v20
  v_max3_f32 v100, v100, v21, v22
  v_max3_f32 v100, v100, v23, v112
  v_max3_f32 v100, v100, v113, v114
  v_max_f32 v100, v100, v115
  v_mov_b32 v101, v100
  s_nop 1
  v_permlane32_swap_b32 v100, v101
  s_nop 1
  v_max_f32 v100, v100, v101
  v_mov_b32 v101, v100
  s_nop 1
  v_permlane16_swap_b32 v100, v101
  s_nop 1
  v_max_f32 v100, v100, v101
  v_sub_f32 v16, v16, v100
  v_sub_f32 v17, v17, v100
  v_sub_f32 v18, v18, v100
  v_sub_f32 v19, v19, v100
  v_exp_f32 v16, v16
  v_exp_f32 v17, v17
  v_exp_f32 v18, v18
  v_exp_f32 v19, v19
  v_sub_f32 v20, v20, v100
  v_sub_f32 v21, v21, v100
  v_sub_f32 v22, v22, v100
  v_sub_f32 v23, v23, v100
  v_exp_f32 v20, v20
  v_exp_f32 v21, v21
  v_exp_f32 v22, v22
  v_exp_f32 v23, v23
  v_sub_f32 v112, v112, v100
  v_sub_f32 v113, v113, v100
  v_sub_f32 v114, v114, v100
  v_sub_f32 v115, v115, v100
  v_exp_f32 v112, v112
  v_exp_f32 v113, v113
  v_exp_f32 v114, v114
  v_exp_f32 v115, v115
  s_nop 0
  v_cvt_pk_bf16_f32 v44, v16, v17
  v_cvt_pk_bf16_f32 v45, v18, v19
  v_cvt_pk_bf16_f32 v46, v20, v21
  v_cvt_pk_bf16_f32 v47, v22, v23
  v_cvt_pk_bf16_f32 v84, v112, v113
  v_cvt_pk_bf16_f32 v85, v114, v115
  v_cndmask_b32 v48, v84, 0, s[16:17]
  v_cndmask_b32 v49, v85, 0, s[16:17]
  v_cndmask_b32 v50, 0, v84, s[16:17]
  v_cndmask_b32 v51, 0, v85, s[16:17]
  s_nop 1
  v_mfma_f32_16x16x16_bf16 v[88:91], v[12:13], v[48:49], 0
  v_mfma_f32_16x16x16_bf16 v[24:27], v[120:121], v[48:49], 0
  v_mfma_f32_16x16x16_bf16 v[116:119], v[120:121], v[50:51], 0
  v_mfma_f32_16x16x32_bf16 v[88:91], v[12:15], v[44:47], v[88:91]
  v_mfma_f32_16x16x32_bf16 v[24:27], v[28:31], v[44:47], v[24:27]
  v_mfma_f32_16x16x32_bf16 v[116:119], v[32:35], v[44:47], v[116:119]
  s_nop 7
  s_nop 1
  v_rcp_f32 v89, v88
  s_nop 0
  v_mul_f32 v24, v89, v24
  v_mul_f32 v25, v89, v25
  s_branch T_back_143
M_global:
  s_cmp_eq_u32 s13, 1
  s_cbranch_scc1 T_w_150
  s_cmp_eq_u32 s13, 2
  s_cbranch_scc1 T_w_151
  s_cmp_eq_u32 s13, 3
  s_cbranch_scc1 T_w_152
T_w_149:
  s_mov_b32 s19, 0
  v_mov_b64 v[16:17], 0
  v_mov_b64 v[18:19], 0
  v_mov_b64 v[20:21], 0
  v_mov_b64 v[22:23], 0
  v_mov_b64 v[24:25], 0
  v_mov_b64 v[26:27], 0
  buffer_load_dwordx4 v[124:127], v3, s[4:7], s24 offen offset:0 sc1
  buffer_load_dwordx4 v[116:119], v3, s[4:7], s25 offen offset:0 sc1
  buffer_load_dwordx4 v[124:127], v3, s[4:7], s24 offen offset:0 sc1
  buffer_load_dwordx4 v[116:119], v3, s[4:7], s25 offen offset:0 sc1
  s_branch T_loop_153
.p2align 6
T_retry_154:
  s_mov_b64 exec, vcc
  buffer_load_dwordx4 v[124:127], v3, s[4:7], s24 offen offset:0 sc1
  buffer_load_dwordx4 v[116:119], v3, s[4:7], s25 offen offset:0 sc1
  s_mov_b64 exec, -1
  s_add_u32 s19, s19, 1
  s_cmp_gt_u32 s19, 32768
  s_cbranch_scc1 M_exit
T_loop_153:
  s_waitcnt vmcnt(3) lgkmcnt(0)
  v_max3_u32 v123, v124, v125, v126
  v_max_u32 v123, v123, v127
  v_mov_b32_dpp v120, v124 row_ror:8 row_mask:0xf bank_mask:0xf
  v_mov_b32_dpp v121, v125 row_ror:8 row_mask:0xf bank_mask:0xf
  s_waitcnt vmcnt(2)
  v_max3_u32 v123, v123, v116, v117
  v_max3_u32 v123, v123, v118, v119
  v_cmp_eq_u32 vcc, -1, v123
  s_cbranch_vccnz T_retry_154
  v_smfmac_f32_16x16x64_bf16 v[16:19], v[124:127], v[68:75], v0
  s_add_u32 s14, s14, 1
  ds_write_b128 v2, v[124:127] offset:0
  v_mov_b32_dpp v122, v126 row_ror:8 row_mask:0xf bank_mask:0xf
  v_smfmac_f32_16x16x64_bf16 v[20:23], v[124:127], v[76:83], v0
  s_and_b32 s57, s14, 1
  v_mov_b32_dpp v123, v127 row_ror:8 row_mask:0xf bank_mask:0xf
  v_smfmac_f32_16x16x64_bf16 v[24:27], v[124:127], v[84:91], v0
  s_and_b32 s36, s14, 3
  ds_write_b128 v2, v[116:119] offset:4096
  v_smfmac_f32_16x16x64_bf16 v[16:19], v[120:123], v[92:99], v0
  s_lshl_b32 s36, s36, 13
  v_mov_b32_dpp v84, v116 row_ror:8 row_mask:0xf bank_mask:0xf
  v_smfmac_f32_16x16x64_bf16 v[20:23], v[120:123], v[100:107], v0
  s_add_u32 s26, s36, s23
  ds_read_b128 v[68:71], v4 offset:12288
  v_mov_b32_dpp v85, v117 row_ror:8 row_mask:0xf bank_mask:0xf
  v_smfmac_f32_16x16x64_bf16 v[24:27], v[120:123], v[108:115], v0
  s_add_u32 s36, s36, 8192
  ds_read_b128 v[72:75], v4 offset:13312
  v_mov_b32_dpp v86, v118 row_ror:8 row_mask:0xf bank_mask:0xf
  v_smfmac_f32_16x16x64_bf16 v[16:19], v[116:119], v[224:231], v0
  s_and_b32 s36, s36, 0x7fff
  ds_read_b128 v[76:79], v4 offset:14336
  v_mov_b32_dpp v87, v119 row_ror:8 row_mask:0xf bank_mask:0xf
  v_smfmac_f32_16x16x64_bf16 v[20:23], v[116:119], v[240:247], v0
  s_waitcnt lgkmcnt(3)
  s_barrier
  ds_read_b128 v[100:103], v2 offset:1024
  v_smfmac_f32_16x16x64_bf16 v[24:27], v[116:119], a[0:7], v0
  s_mov_b32 m0, s31
  ds_read_b128 v[120:123], v1 offset:1024
  v_smfmac_f32_16x16x64_bf16 v[16:19], v[84:87], v[232:239], v0
  s_cmp_ge_i32 s14, s30
  s_cbranch_scc1 T_kvw_157
T_kvb_158:
  v_smfmac_f32_16x16x64_bf16 v[20:23], v[84:87], v[248:255], v0
  ds_read_b128 v[80:83], v4 offset:15360
  buffer_load_dwordx4 v9, s[4:7], s27 offen sc1 lds
  v_smfmac_f32_16x16x64_bf16 v[24:27], v[84:87], a[8:15], v0
  s_waitcnt lgkmcnt(2)
  s_mov_b32 m0, s32
  v_smfmac_f32_16x16x64_bf16 v[16:19], v[100:103], v[128:135], v0
  ds_read_b128 v[92:95], v2 offset:2048
  v_smfmac_f32_16x16x64_bf16 v[20:23], v[100:103], v[144:151], v0
  ds_read_b128 v[96:99], v1 offset:2048
  v_smfmac_f32_16x16x64_bf16 v[24:27], v[100:103], v[68:75], v0
  s_waitcnt vmcnt(1) lgkmcnt(3)
  ds_read_b128 v[116:119], v2 offset:3072
  buffer_load_dwordx4 v9, s[4:7], s27 offen offset:128 sc1 lds
  v_smfmac_f32_16x16x64_bf16 v[16:19], v[120:123], v[136:143], v0
  ds_read_b128 v[124:127], v1 offset:3072
  s_mov_b32 m0, s33
  v_smfmac_f32_16x16x64_bf16 v[20:23], v[120:123], v[152:159], v0
  s_waitcnt lgkmcnt(4)
  ds_read_b128 v[104:107], v2 offset:5120
  v_smfmac_f32_16x16x64_bf16 v[24:27], v[120:123], v[76:83], v0
  s_waitcnt lgkmcnt(4)
  ds_read_b128 v[108:111], v1 offset:5120
  v_smfmac_f32_16x16x64_bf16 v[16:19], v[92:95], v[160:167], v0
  s_waitcnt lgkmcnt(4)
  ds_read_b128 v[112:115], v2 offset:6144
  buffer_load_dwordx4 v10, s[4:7], s28 offen sc1 lds
  v_smfmac_f32_16x16x64_bf16 v[16:19], v[96:99], v[168:175], v0
  s_waitcnt lgkmcnt(4)
  ds_read_b128 v[84:87], v1 offset:6144
  s_mov_b32 m0, s34
  v_smfmac_f32_16x16x64_bf16 v[16:19], v[116:119], v[192:199], v0
  s_waitcnt lgkmcnt(4)
  ds_read_b128 v[88:91], v2 offset:7168
  v_smfmac_f32_16x16x64_bf16 v[16:19], v[124:127], v[200:207], v0
  s_waitcnt lgkmcnt(4)
  ds_read_b128 v[100:103], v1 offset:7168
  v_smfmac_f32_16x16x64_bf16 v[16:19], v[104:107], a[16:23], v0
  s_waitcnt lgkmcnt(4)
  ds_read_b128 v[68:71], v4 offset:16384
  buffer_load_dwordx4 v10, s[4:7], s28 offen offset:256 sc1 lds
  v_smfmac_f32_16x16x64_bf16 v[16:19], v[108:111], a[24:31], v0
  s_waitcnt lgkmcnt(4)
  ds_read_b128 v[72:75], v4 offset:17408
  v_smfmac_f32_16x16x64_bf16 v[16:19], v[112:115], a[64:71], v0
  s_waitcnt lgkmcnt(4)
  ds_read_b128 v[76:79], v4 offset:18432
  v_smfmac_f32_16x16x64_bf16 v[16:19], v[84:87], a[72:79], v0
  s_waitcnt lgkmcnt(4)
  ds_read_b128 v[80:83], v4 offset:19456
  v_smfmac_f32_16x16x64_bf16 v[16:19], v[88:91], a[112:119], v0
  s_waitcnt lgkmcnt(4)
  v_smfmac_f32_16x16x64_bf16 v[16:19], v[100:103], a[120:127], v0
  s_add_u32 s24, s36, 145752064
  s_add_u32 s25, s36, 145756160
  v_smfmac_f32_16x16x64_bf16 v[20:23], v[92:95], v[176:183], v0
  s_add_u32 s35, s36, s23
  v_smfmac_f32_16x16x64_bf16 v[20:23], v[96:99], v[184:191], v0
  s_waitcnt lgkmcnt(2)
  v_smfmac_f32_16x16x64_bf16 v[20:23], v[116:119], v[68:75], v0
  s_waitcnt lgkmcnt(0)
  ds_read_b128 v[68:71], v4 offset:20480
  v_mul_f32 v16, s18, v16
  v_smfmac_f32_16x16x64_bf16 v[20:23], v[124:127], v[76:83], v0
  ds_read_b128 v[72:75], v4 offset:21504
  v_mul_f32 v17, s18, v17
  v_smfmac_f32_16x16x64_bf16 v[20:23], v[104:107], a[32:39], v0
  ds_read_b128 v[76:79], v4 offset:22528
  v_mul_f32 v18, s18, v18
  v_smfmac_f32_16x16x64_bf16 v[20:23], v[108:111], a[40:47], v0
  ds_read_b128 v[80:83], v4 offset:23552
  v_mul_f32 v19, s18, v19
  v_smfmac_f32_16x16x64_bf16 v[20:23], v[112:115], a[80:87], v0
  v_cvt_pk_bf16_f32 v120, v16, v17
  v_smfmac_f32_16x16x64_bf16 v[20:23], v[84:87], a[88:95], v0
  v_cvt_pk_bf16_f32 v121, v18, v19
  v_smfmac_f32_16x16x64_bf16 v[20:23], v[88:91], a[128:135], v0
  ds_write_b64 v5, v[120:121] offset:24576
  v_smfmac_f32_16x16x64_bf16 v[20:23], v[100:103], a[136:143], v0
  s_waitcnt lgkmcnt(3)
  v_smfmac_f32_16x16x64_bf16 v[24:27], v[92:95], v[68:75], v0
  s_waitcnt lgkmcnt(1)
  v_mov_b64 v[92:93], 0
  v_smfmac_f32_16x16x64_bf16 v[24:27], v[96:99], v[76:83], v0
  s_nop 1
  v_cvt_pk_bf16_f32 v122, v20, v21
  v_cvt_pk_bf16_f32 v123, v22, v23
  v_smfmac_f32_16x16x64_bf16 v[24:27], v[116:119], v[208:215], v0
  ds_write_b64 v5, v[122:123] offset:26880
  v_mov_b64 v[94:95], 0
  v_smfmac_f32_16x16x64_bf16 v[24:27], v[124:127], v[216:223], v0
  s_waitcnt lgkmcnt(1)
  s_barrier
  ds_read_b64_tr_b16 v[68:69], v6 offset:24576
  v_smfmac_f32_16x16x64_bf16 v[24:27], v[104:107], a[48:55], v0
  s_add_u32 s27, s27, 8192
  ds_read_b64_tr_b16 v[70:71], v6 offset:24640
  ds_read_b64_tr_b16 v[72:73], v6 offset:24832
  v_smfmac_f32_16x16x64_bf16 v[24:27], v[108:111], a[56:63], v0
  s_add_u32 s28, s28, 8192
  ds_read_b64_tr_b16 v[74:75], v6 offset:24896
  ds_read_b64_tr_b16 v[76:77], v6 offset:25088
  v_smfmac_f32_16x16x64_bf16 v[24:27], v[112:115], a[96:103], v0
  s_nop 0
  ds_read_b64_tr_b16 v[78:79], v6 offset:25152
  ds_read_b64_tr_b16 v[80:81], v6 offset:25344
  v_smfmac_f32_16x16x64_bf16 v[24:27], v[84:87], a[104:111], v0
  ds_read_b64_tr_b16 v[82:83], v6 offset:25408
  v_mov_b64 v[96:97], 0
  v_smfmac_f32_16x16x64_bf16 v[24:27], v[88:91], a[144:151], v0
  s_waitcnt lgkmcnt(8)
  s_barrier
  ds_read_b64_tr_b16 v[116:117], v6 offset:26880
  v_smfmac_f32_16x16x64_bf16 v[24:27], v[100:103], a[152:159], v0
  s_waitcnt lgkmcnt(7)
  ds_read_b64_tr_b16 v[118:119], v6 offset:26944
  v_mfma_f32_16x16x32_bf16 v[16:19], v[36:39], v[68:71], 0
  s_waitcnt lgkmcnt(6)
  ds_read_b64_tr_b16 v[124:125], v6 offset:27136
  ds_read_b64_tr_b16 v[126:127], v6 offset:27200
  v_mfma_f32_16x16x32_bf16 v[16:19], v[40:43], v[72:75], v[16:19]
  s_waitcnt lgkmcnt(6)
  ds_read_b64_tr_b16 v[104:105], v6 offset:27392
  ds_read_b64_tr_b16 v[106:107], v6 offset:27456
  v_mfma_f32_16x16x32_bf16 v[16:19], v[44:47], v[76:79], v[16:19]
  s_waitcnt lgkmcnt(6)
  ds_read_b64_tr_b16 v[108:109], v6 offset:27648
  ds_read_b64_tr_b16 v[110:111], v6 offset:27712
  v_mfma_f32_16x16x32_bf16 v[16:19], v[48:51], v[80:83], v[16:19]
  s_waitcnt lgkmcnt(6)
  v_cvt_pk_bf16_f32 v120, v24, v25
  v_cvt_pk_bf16_f32 v121, v26, v27
  v_mfma_f32_16x16x32_bf16 v[112:115], v[116:119], v[68:71], 0
  s_waitcnt lgkmcnt(4)
  buffer_store_dwordx4 v[120:123], v2, s[4:7], s29 offen offset:0 sc1
  v_mov_b64 v[98:99], 0
  v_mfma_f32_16x16x32_bf16 v[112:115], v[124:127], v[72:75], v[112:115]
  s_waitcnt lgkmcnt(2)
  v_mov_b64 v[36:37], 0
  v_exp_f32 v100, v16
  v_mfma_f32_16x16x32_bf16 v[112:115], v[104:107], v[76:79], v[112:115]
  s_waitcnt lgkmcnt(0)
  v_exp_f32 v101, v17
  v_mfma_f32_16x16x32_bf16 v[112:115], v[108:111], v[80:83], v[112:115]
  s_add_u32 s29, s29, 131072
  v_exp_f32 v102, v18
  v_mfma_f32_16x16x32_bf16 v[20:23], v[52:55], v[68:71], 0
  s_cmp_eq_u32 s14, 63
  v_exp_f32 v103, v19
  v_mfma_f32_16x16x32_bf16 v[20:23], v[56:59], v[72:75], v[20:23]
  s_cbranch_scc1 M_tdone
  v_cvt_pk_bf16_f32 v44, v100, v101
  v_cvt_pk_bf16_f32 v45, v102, v103
  v_mfma_f32_16x16x32_bf16 v[20:23], v[60:63], v[76:79], v[20:23]
  v_exp_f32 v100, v112
  v_mfma_f32_16x16x32_bf16 v[20:23], v[64:67], v[80:83], v[20:23]
  v_exp_f32 v101, v113
  v_exp_f32 v102, v114
  v_exp_f32 v103, v115
  v_cvt_pk_bf16_f32 v84, v100, v101
  v_cvt_pk_bf16_f32 v85, v102, v103
  v_cndmask_b32 v48, v84, 0, s[16:17]
  v_cndmask_b32 v49, v85, 0, s[16:17]
  v_cndmask_b32 v50, 0, v84, s[16:17]
  v_cndmask_b32 v51, 0, v85, s[16:17]
  v_exp_f32 v100, v20
  v_mfma_f32_16x16x16_bf16 v[88:91], v[12:13], v[48:49], 0
  v_exp_f32 v101, v21
  v_mfma_f32_16x16x16_bf16 v[24:27], v[120:121], v[48:49], 0
  v_exp_f32 v102, v22
  v_mfma_f32_16x16x16_bf16 v[116:119], v[120:121], v[50:51], 0
  v_exp_f32 v103, v23
  v_cvt_pk_bf16_f32 v46, v100, v101
  v_cvt_pk_bf16_f32 v47, v102, v103
  v_mov_b64 v[38:39], 0
  s_nop 0
  v_mfma_f32_16x16x32_bf16 v[88:91], v[12:15], v[44:47], v[88:91]
  v_mov_b64 v[40:41], 0
  v_mov_b64 v[42:43], 0
  v_mfma_f32_16x16x32_bf16 v[24:27], v[28:31], v[44:47], v[24:27]
  ds_read_b128 v[52:55], v4 offset:24576
  ds_read_b128 v[56:59], v4 offset:25600
  v_mfma_f32_16x16x32_bf16 v[116:119], v[32:35], v[44:47], v[116:119]
  s_nop 1
  v_rcp_f32 v89, v88
  v_subrev_u32 v100, s54, v88
  v_cmp_le_u32 vcc, s55, v100
  v_mul_f32 v24, v89, v24
  v_mul_f32 v25, v89, v25
  s_cbranch_vccnz T_slow_160
T_back_161:
  v_cvt_pk_bf16_f32 v124, v24, v25
  v_pk_mul_f32 v[26:27], v[26:27], v[88:89] op_sel:[0,1] op_sel_hi:[1,1]
  v_pk_mul_f32 v[116:117], v[116:117], v[88:89] op_sel:[0,1] op_sel_hi:[1,1]
  v_pk_mul_f32 v[118:119], v[118:119], v[88:89] op_sel:[0,1] op_sel_hi:[1,1]
  v_cvt_pk_bf16_f32 v125, v26, v27
  v_cvt_pk_bf16_f32 v126, v116, v117
  v_cvt_pk_bf16_f32 v127, v118, v119
  ds_write_b128 v11, v[124:127] offset:29184
  s_nop 0
  v_smfmac_f32_16x16x64_bf16 v[92:95], v[124:127], a[160:167], v0
  v_smfmac_f32_16x16x64_bf16 v[96:99], v[124:127], a[168:175], v0
  v_smfmac_f32_16x16x64_bf16 v[36:39], v[124:127], a[176:183], v0
  v_smfmac_f32_16x16x64_bf16 v[40:43], v[124:127], a[184:191], v0
  s_waitcnt lgkmcnt(0)
  s_barrier
  ds_read_b128 v[104:107], v11 offset:29696
  ds_read_b128 v[108:111], v11 offset:30208
  ds_read_b128 v[68:71], v11 offset:30720
  s_waitcnt lgkmcnt(2)
  v_smfmac_f32_16x16x64_bf16 v[92:95], v[104:107], a[192:199], v0
  s_waitcnt lgkmcnt(1)
  ds_read_b128 v[76:79], v4 offset:28672
  v_smfmac_f32_16x16x64_bf16 v[92:95], v[108:111], a[224:231], v0
  s_waitcnt lgkmcnt(1)
  ds_read_b128 v[80:83], v4 offset:29696
  v_smfmac_f32_16x16x64_bf16 v[92:95], v[68:71], a[240:247], v0
  ds_read_b128 v[60:63], v4 offset:26624
  v_smfmac_f32_16x16x64_bf16 v[96:99], v[104:107], a[200:207], v0
  ds_read_b128 v[64:67], v4 offset:27648
  v_smfmac_f32_16x16x64_bf16 v[96:99], v[108:111], a[232:239], v0
  ds_read_b128 v[28:31], v4 offset:30720
  s_nop 0
  v_cvt_pk_bf16_f32 v16, v92, v93
  v_cvt_pk_bf16_f32 v17, v94, v95
  v_bfi_b32 v16, 1, s57, v16
  v_smfmac_f32_16x16x64_bf16 v[96:99], v[68:71], a[248:255], v0
  buffer_store_dwordx2 v[16:17], v7, s[4:7], s20 offen offset:0 sc1
  v_smfmac_f32_16x16x64_bf16 v[36:39], v[104:107], a[208:215], v0
  ds_read_b128 v[32:35], v4 offset:31744
  v_smfmac_f32_16x16x64_bf16 v[36:39], v[108:111], v[52:59], v0
  s_waitcnt lgkmcnt(4)
  s_nop 0
  v_cvt_pk_bf16_f32 v18, v96, v97
  v_cvt_pk_bf16_f32 v19, v98, v99
  v_bfi_b32 v18, 1, s57, v18
  v_smfmac_f32_16x16x64_bf16 v[36:39], v[68:71], v[76:83], v0
  buffer_store_dwordx2 v[18:19], v7, s[4:7], s20 offen offset:64 sc1
  v_smfmac_f32_16x16x64_bf16 v[40:43], v[104:107], a[216:223], v0
  s_waitcnt lgkmcnt(2)
  ds_read_b128 v[116:119], v2 offset:31232
  v_smfmac_f32_16x16x64_bf16 v[40:43], v[108:111], v[60:67], v0
  s_waitcnt lgkmcnt(1)
  s_nop 0
  v_cvt_pk_bf16_f32 v20, v36, v37
  v_cvt_pk_bf16_f32 v21, v38, v39
  v_bfi_b32 v20, 1, s57, v20
  v_smfmac_f32_16x16x64_bf16 v[40:43], v[68:71], v[28:35], v0
  buffer_store_dwordx2 v[20:21], v7, s[4:7], s21 offen offset:0 sc1
  s_nop 6
  v_cvt_pk_bf16_f32 v22, v40, v41
  v_cvt_pk_bf16_f32 v23, v42, v43
  v_bfi_b32 v22, 1, s57, v22
  buffer_store_dwordx2 v[22:23], v7, s[4:7], s21 offen offset:64 sc1
  ds_read_b128 v[68:71], v4 offset:0
  ds_read_b128 v[72:75], v4 offset:1024
  ds_read_b128 v[76:79], v4 offset:4096
  ds_read_b128 v[80:83], v4 offset:5120
  ds_read_b128 v[84:87], v4 offset:8192
  ds_read_b128 v[88:91], v4 offset:9216
  v_mov_b64 v[16:17], 0
  v_mov_b64 v[18:19], 0
  v_mov_b64 v[20:21], 0
  v_mov_b64 v[22:23], 0
  v_mov_b64 v[24:25], 0
  v_mov_b64 v[26:27], 0
  s_mov_b32 s19, 0
  v_mov_b32 v49, -1
  s_waitcnt vmcnt(2)
  buffer_load_dwordx4 v[52:55], v2, s[4:7], s22 offen offset:0 sc1
  buffer_load_dwordx4 v[56:59], v2, s[4:7], s22 offen offset:1024 sc1
  buffer_load_dwordx4 v[60:63], v2, s[4:7], s22 offen offset:2048 sc1
  buffer_load_dwordx4 v[64:67], v2, s[4:7], s22 offen offset:3072 sc1
  ds_read_b128 v[92:95], v4 offset:2048
  ds_read_b128 v[96:99], v4 offset:3072
  ds_read_b128 v[100:103], v4 offset:6144
  ds_read_b128 v[104:107], v4 offset:7168
  ds_read_b128 v[108:111], v4 offset:10240
  ds_read_b128 v[112:115], v4 offset:11264
  ds_read_b64 v[44:45], v2 offset:32256
  s_waitcnt lgkmcnt(0)
  v_readfirstlane_b32 s38, v44
  v_readfirstlane_b32 s37, v45
  s_nop 0
  s_add_u32 s37, s37, 30
  s_cmp_ge_u32 s38, 30
  s_cselect_b32 s38, s37, s38
  s_cmp_ge_u32 s38, 64
  s_cselect_b32 s38, 100, s38
  s_sub_u32 s38, s38, 1
  s_max_i32 s30, s30, s38
  s_waitcnt lgkmcnt(12)
  s_waitcnt vmcnt(3)
  v_mfma_f32_16x16x32_bf16 v[120:123], v[116:119], v[52:55], 0
  v_xor_b32 v48, s57, v52
  v_bitop3_b32 v48, v48, v54, s57 bitop3:0xf6
  s_waitcnt vmcnt(2)
  v_mfma_f32_16x16x32_bf16 v[120:123], v[116:119], v[56:59], v[120:123]
  v_bitop3_b32 v48, v48, v56, s57 bitop3:0xf6
  v_bitop3_b32 v48, v48, v58, s57 bitop3:0xf6
  s_waitcnt vmcnt(1)
  v_mfma_f32_16x16x32_bf16 v[120:123], v[116:119], v[60:63], v[120:123]
  v_bitop3_b32 v48, v48, v60, s57 bitop3:0xf6
  v_bitop3_b32 v48, v48, v62, s57 bitop3:0xf6
  s_waitcnt vmcnt(0)
  v_mfma_f32_16x16x32_bf16 v[120:123], v[116:119], v[64:67], v[120:123]
  v_bitop3_b32 v48, v48, v64, s57 bitop3:0xf6
  v_bitop3_b32 v48, v48, v66, s57 bitop3:0xf6
  v_and_b32 v48, 1, v48
  v_cmp_ne_u32 vcc, 0, v48
  s_cbranch_vccnz T_p1re_163
T_p1ok_164:
  s_nop 2
  v_add_f32_dpp v120, v120, v120 row_ror:8 row_mask:0xf bank_mask:0xf
  v_add_f32_dpp v121, v121, v121 row_ror:8 row_mask:0xf bank_mask:0xf
  v_cvt_pk_bf16_f32 v48, v120, v121
  v_min_u32 v48, -2, v48
  buffer_store_dword v48, v8, s[4:7], s35 offen sc1
  buffer_store_dword v49, v8, s[4:7], s26 offen sc1
  s_barrier
  ds_read_b128 v[28:31], v2 offset:16384
  ds_read_b128 v[32:35], v2 offset:20480
  ds_read_b128 v[36:39], v2 offset:8192
  ds_read_b128 v[40:43], v2 offset:9216
  ds_read_b128 v[44:47], v2 offset:10240
  ds_read_b128 v[48:51], v2 offset:11264
  buffer_load_dwordx4 v[124:127], v3, s[4:7], s24 offen offset:0 sc1
  buffer_load_dwordx4 v[116:119], v3, s[4:7], s25 offen offset:0 sc1
  ds_read_b128 v[52:55], v2 offset:12288
  ds_read_b128 v[56:59], v2 offset:13312
  ds_read_b128 v[60:63], v2 offset:14336
  ds_read_b128 v[64:67], v2 offset:15360
  buffer_load_dwordx4 v[124:127], v3, s[4:7], s24 offen offset:0 sc1
  buffer_load_dwordx4 v[116:119], v3, s[4:7], s25 offen offset:0 sc1
  s_mov_b32 s19, 0
  s_branch T_loop_153
T_p1re_163:
  s_mov_b64 exec, vcc
  buffer_load_dwordx4 v[52:55], v2, s[4:7], s22 offen offset:0 sc1
  buffer_load_dwordx4 v[56:59], v2, s[4:7], s22 offen offset:1024 sc1
  buffer_load_dwordx4 v[60:63], v2, s[4:7], s22 offen offset:2048 sc1
  buffer_load_dwordx4 v[64:67], v2, s[4:7], s22 offen offset:3072 sc1
  s_mov_b64 exec, -1
  s_add_u32 s19, s19, 1
  s_cmp_gt_u32 s19, 32768
  s_cbranch_scc1 M_exit
  s_waitcnt vmcnt(3)
  v_mfma_f32_16x16x32_bf16 v[120:123], v[116:119], v[52:55], 0
  v_xor_b32 v48, s57, v52
  v_bitop3_b32 v48, v48, v54, s57 bitop3:0xf6
  s_waitcnt vmcnt(2)
  v_mfma_f32_16x16x32_bf16 v[120:123], v[116:119], v[56:59], v[120:123]
  v_bitop3_b32 v48, v48, v56, s57 bitop3:0xf6
  v_bitop3_b32 v48, v48, v58, s57 bitop3:0xf6
  s_waitcnt vmcnt(1)
  v_mfma_f32_16x16x32_bf16 v[120:123], v[116:119], v[60:63], v[120:123]
  v_bitop3_b32 v48, v48, v60, s57 bitop3:0xf6
  v_bitop3_b32 v48, v48, v62, s57 bitop3:0xf6
  s_waitcnt vmcnt(0)
  v_mfma_f32_16x16x32_bf16 v[120:123], v[116:119], v[64:67], v[120:123]
  v_bitop3_b32 v48, v48, v64, s57 bitop3:0xf6
  v_bitop3_b32 v48, v48, v66, s57 bitop3:0xf6
  v_and_b32 v48, 1, v48
  v_cmp_ne_u32 vcc, 0, v48
  s_cbranch_vccnz T_p1re_163
  s_branch T_p1ok_164
T_kvw_157:
  s_mov_b32 s19, 0
  s_branch T_kvok_166
T_kv_165:
  s_sleep 4
  s_add_u32 s19, s19, 1
  s_cmp_gt_u32 s19, 32768
  s_cbranch_scc1 M_exit
T_kvok_166:
  s_add_u32 s39, s99, 128
  s_mov_b32 s38, 0
  s_mov_b32 s37, 0
  s_atomic_or s38, s[58:59], s99 glc
  s_atomic_or s37, s[58:59], s39 glc
  s_waitcnt lgkmcnt(0)
  s_add_u32 s37, s37, 30
  s_cmp_ge_u32 s38, 30
  s_cselect_b32 s38, s37, s38
  s_cmp_ge_u32 s38, 64
  s_cselect_b32 s38, 100, s38
  s_sub_u32 s38, s38, 1
  s_max_i32 s30, s30, s38
  s_cmp_ge_i32 s14, s30
  s_cbranch_scc1 T_kv_165
  s_branch T_kvb_158
T_slow_160:
  s_nop 7
  v_max3_f32 v100, v16, v17, v18
  v_max3_f32 v100, v100, v19, v20
  v_max3_f32 v100, v100, v21, v22
  v_max3_f32 v100, v100, v23, v112
  v_max3_f32 v100, v100, v113, v114
  v_max_f32 v100, v100, v115
  v_mov_b32 v101, v100
  s_nop 1
  v_permlane32_swap_b32 v100, v101
  s_nop 1
  v_max_f32 v100, v100, v101
  v_mov_b32 v101, v100
  s_nop 1
  v_permlane16_swap_b32 v100, v101
  s_nop 1
  v_max_f32 v100, v100, v101
  v_sub_f32 v16, v16, v100
  v_sub_f32 v17, v17, v100
  v_sub_f32 v18, v18, v100
  v_sub_f32 v19, v19, v100
  v_exp_f32 v16, v16
  v_exp_f32 v17, v17
  v_exp_f32 v18, v18
  v_exp_f32 v19, v19
  v_sub_f32 v20, v20, v100
  v_sub_f32 v21, v21, v100
  v_sub_f32 v22, v22, v100
  v_sub_f32 v23, v23, v100
  v_exp_f32 v20, v20
  v_exp_f32 v21, v21
  v_exp_f32 v22, v22
  v_exp_f32 v23, v23
  v_sub_f32 v112, v112, v100
  v_sub_f32 v113, v113, v100
  v_sub_f32 v114, v114, v100
  v_sub_f32 v115, v115, v100
  v_exp_f32 v112, v112
  v_exp_f32 v113, v113
  v_exp_f32 v114, v114
  v_exp_f32 v115, v115
  s_nop 0
  v_cvt_pk_bf16_f32 v44, v16, v17
  v_cvt_pk_bf16_f32 v45, v18, v19
  v_cvt_pk_bf16_f32 v46, v20, v21
  v_cvt_pk_bf16_f32 v47, v22, v23
  v_cvt_pk_bf16_f32 v84, v112, v113
  v_cvt_pk_bf16_f32 v85, v114, v115
  v_cndmask_b32 v48, v84, 0, s[16:17]
  v_cndmask_b32 v49, v85, 0, s[16:17]
  v_cndmask_b32 v50, 0, v84, s[16:17]
  v_cndmask_b32 v51, 0, v85, s[16:17]
  s_nop 1
  v_mfma_f32_16x16x16_bf16 v[88:91], v[12:13], v[48:49], 0
  v_mfma_f32_16x16x16_bf16 v[24:27], v[120:121], v[48:49], 0
  v_mfma_f32_16x16x16_bf16 v[116:119], v[120:121], v[50:51], 0
  v_mfma_f32_16x16x32_bf16 v[88:91], v[12:15], v[44:47], v[88:91]
  v_mfma_f32_16x16x32_bf16 v[24:27], v[28:31], v[44:47], v[24:27]
  v_mfma_f32_16x16x32_bf16 v[116:119], v[32:35], v[44:47], v[116:119]
  s_nop 7
  s_nop 1
  v_rcp_f32 v89, v88
  s_nop 0
  v_mul_f32 v24, v89, v24
  v_mul_f32 v25, v89, v25
  s_branch T_back_161
T_w_150:
  s_mov_b32 s19, 0
  v_mov_b64 v[16:17], 0
  v_mov_b64 v[18:19], 0
  v_mov_b64 v[20:21], 0
  v_mov_b64 v[22:23], 0
  v_mov_b64 v[24:25], 0
  v_mov_b64 v[26:27], 0
  buffer_load_dwordx4 v[124:127], v3, s[4:7], s24 offen offset:1024 sc1
  buffer_load_dwordx4 v[116:119], v3, s[4:7], s25 offen offset:1024 sc1
  buffer_load_dwordx4 v[124:127], v3, s[4:7], s24 offen offset:1024 sc1
  buffer_load_dwordx4 v[116:119], v3, s[4:7], s25 offen offset:1024 sc1
  s_branch T_loop_167
.p2align 6
T_retry_168:
  s_mov_b64 exec, vcc
  buffer_load_dwordx4 v[124:127], v3, s[4:7], s24 offen offset:1024 sc1
  buffer_load_dwordx4 v[116:119], v3, s[4:7], s25 offen offset:1024 sc1
  s_mov_b64 exec, -1
  s_add_u32 s19, s19, 1
  s_cmp_gt_u32 s19, 32768
  s_cbranch_scc1 M_exit
T_loop_167:
  s_waitcnt vmcnt(3) lgkmcnt(0)
  v_max3_u32 v123, v124, v125, v126
  v_max_u32 v123, v123, v127
  v_mov_b32_dpp v120, v124 row_ror:8 row_mask:0xf bank_mask:0xf
  v_mov_b32_dpp v121, v125 row_ror:8 row_mask:0xf bank_mask:0xf
  s_waitcnt vmcnt(2)
  v_max3_u32 v123, v123, v116, v117
  v_max3_u32 v123, v123, v118, v119
  v_cmp_eq_u32 vcc, -1, v123
  s_cbranch_vccnz T_retry_168
  v_smfmac_f32_16x16x64_bf16 v[16:19], v[124:127], v[68:75], v0
  s_add_u32 s14, s14, 1
  ds_write_b128 v2, v[124:127] offset:1024
  v_mov_b32_dpp v122, v126 row_ror:8 row_mask:0xf bank_mask:0xf
  v_smfmac_f32_16x16x64_bf16 v[20:23], v[124:127], v[76:83], v0
  s_and_b32 s57, s14, 1
  v_mov_b32_dpp v123, v127 row_ror:8 row_mask:0xf bank_mask:0xf
  v_smfmac_f32_16x16x64_bf16 v[24:27], v[124:127], v[84:91], v0
  s_and_b32 s36, s14, 3
  ds_write_b128 v2, v[116:119] offset:5120
  v_smfmac_f32_16x16x64_bf16 v[16:19], v[120:123], v[92:99], v0
  s_lshl_b32 s36, s36, 13
  v_mov_b32_dpp v84, v116 row_ror:8 row_mask:0xf bank_mask:0xf
  v_smfmac_f32_16x16x64_bf16 v[20:23], v[120:123], v[100:107], v0
  s_add_u32 s26, s36, s23
  ds_read_b128 v[68:71], v4 offset:12288
  v_mov_b32_dpp v85, v117 row_ror:8 row_mask:0xf bank_mask:0xf
  v_smfmac_f32_16x16x64_bf16 v[24:27], v[120:123], v[108:115], v0
  s_add_u32 s36, s36, 8192
  ds_read_b128 v[72:75], v4 offset:13312
  v_mov_b32_dpp v86, v118 row_ror:8 row_mask:0xf bank_mask:0xf
  v_smfmac_f32_16x16x64_bf16 v[16:19], v[116:119], v[224:231], v0
  s_and_b32 s36, s36, 0x7fff
  ds_read_b128 v[76:79], v4 offset:14336
  v_mov_b32_dpp v87, v119 row_ror:8 row_mask:0xf bank_mask:0xf
  v_smfmac_f32_16x16x64_bf16 v[20:23], v[116:119], v[240:247], v0
  s_waitcnt lgkmcnt(3)
  s_barrier
  ds_read_b128 v[100:103], v2 offset:0
  v_smfmac_f32_16x16x64_bf16 v[24:27], v[116:119], a[0:7], v0
  s_mov_b32 m0, s31
  ds_read_b128 v[120:123], v1 offset:0
  v_smfmac_f32_16x16x64_bf16 v[16:19], v[84:87], v[232:239], v0
  s_cmp_ge_i32 s14, s30
  s_cbranch_scc1 T_kvw_171
T_kvb_172:
  v_smfmac_f32_16x16x64_bf16 v[20:23], v[84:87], v[248:255], v0
  ds_read_b128 v[80:83], v4 offset:15360
  v_smfmac_f32_16x16x64_bf16 v[24:27], v[84:87], a[8:15], v0
  s_waitcnt lgkmcnt(2)
  buffer_load_dwordx4 v9, s[4:7], s27 offen sc1 lds
  v_smfmac_f32_16x16x64_bf16 v[16:19], v[100:103], v[128:135], v0
  ds_read_b128 v[92:95], v2 offset:3072
  s_mov_b32 m0, s32
  v_smfmac_f32_16x16x64_bf16 v[20:23], v[100:103], v[144:151], v0
  ds_read_b128 v[96:99], v1 offset:3072
  v_smfmac_f32_16x16x64_bf16 v[24:27], v[100:103], v[68:75], v0
  s_waitcnt vmcnt(1) lgkmcnt(3)
  ds_read_b128 v[116:119], v2 offset:2048
  v_smfmac_f32_16x16x64_bf16 v[16:19], v[120:123], v[136:143], v0
  ds_read_b128 v[124:127], v1 offset:2048
  buffer_load_dwordx4 v9, s[4:7], s27 offen offset:128 sc1 lds
  v_smfmac_f32_16x16x64_bf16 v[20:23], v[120:123], v[152:159], v0
  s_waitcnt lgkmcnt(4)
  ds_read_b128 v[104:107], v2 offset:4096
  s_mov_b32 m0, s33
  v_smfmac_f32_16x16x64_bf16 v[24:27], v[120:123], v[76:83], v0
  s_waitcnt lgkmcnt(4)
  ds_read_b128 v[108:111], v1 offset:4096
  v_smfmac_f32_16x16x64_bf16 v[16:19], v[92:95], v[160:167], v0
  s_waitcnt lgkmcnt(4)
  ds_read_b128 v[112:115], v2 offset:7168
  v_smfmac_f32_16x16x64_bf16 v[16:19], v[96:99], v[168:175], v0
  s_waitcnt lgkmcnt(4)
  ds_read_b128 v[84:87], v1 offset:7168
  buffer_load_dwordx4 v10, s[4:7], s28 offen sc1 lds
  v_smfmac_f32_16x16x64_bf16 v[16:19], v[116:119], v[192:199], v0
  s_waitcnt lgkmcnt(4)
  ds_read_b128 v[88:91], v2 offset:6144
  s_mov_b32 m0, s34
  v_smfmac_f32_16x16x64_bf16 v[16:19], v[124:127], v[200:207], v0
  s_waitcnt lgkmcnt(4)
  ds_read_b128 v[100:103], v1 offset:6144
  v_smfmac_f32_16x16x64_bf16 v[16:19], v[104:107], a[16:23], v0
  s_waitcnt lgkmcnt(4)
  ds_read_b128 v[68:71], v4 offset:16384
  v_smfmac_f32_16x16x64_bf16 v[16:19], v[108:111], a[24:31], v0
  s_waitcnt lgkmcnt(4)
  ds_read_b128 v[72:75], v4 offset:17408
  buffer_load_dwordx4 v10, s[4:7], s28 offen offset:256 sc1 lds
  v_smfmac_f32_16x16x64_bf16 v[16:19], v[112:115], a[64:71], v0
  s_waitcnt lgkmcnt(4)
  ds_read_b128 v[76:79], v4 offset:18432
  v_smfmac_f32_16x16x64_bf16 v[16:19], v[84:87], a[72:79], v0
  s_waitcnt lgkmcnt(4)
  ds_read_b128 v[80:83], v4 offset:19456
  v_smfmac_f32_16x16x64_bf16 v[16:19], v[88:91], a[112:119], v0
  s_waitcnt lgkmcnt(4)
  v_smfmac_f32_16x16x64_bf16 v[16:19], v[100:103], a[120:127], v0
  s_add_u32 s24, s36, 145752064
  s_add_u32 s25, s36, 145756160
  v_smfmac_f32_16x16x64_bf16 v[20:23], v[92:95], v[176:183], v0
  s_add_u32 s35, s36, s23
  v_smfmac_f32_16x16x64_bf16 v[20:23], v[96:99], v[184:191], v0
  s_waitcnt lgkmcnt(2)
  v_smfmac_f32_16x16x64_bf16 v[20:23], v[116:119], v[68:75], v0
  s_waitcnt lgkmcnt(0)
  ds_read_b128 v[68:71], v4 offset:20480
  v_mul_f32 v16, s18, v16
  v_smfmac_f32_16x16x64_bf16 v[20:23], v[124:127], v[76:83], v0
  ds_read_b128 v[72:75], v4 offset:21504
  v_mul_f32 v17, s18, v17
  v_smfmac_f32_16x16x64_bf16 v[20:23], v[104:107], a[32:39], v0
  ds_read_b128 v[76:79], v4 offset:22528
  v_mul_f32 v18, s18, v18
  v_smfmac_f32_16x16x64_bf16 v[20:23], v[108:111], a[40:47], v0
  ds_read_b128 v[80:83], v4 offset:23552
  v_mul_f32 v19, s18, v19
  v_smfmac_f32_16x16x64_bf16 v[20:23], v[112:115], a[80:87], v0
  v_cvt_pk_bf16_f32 v120, v16, v17
  v_smfmac_f32_16x16x64_bf16 v[20:23], v[84:87], a[88:95], v0
  v_cvt_pk_bf16_f32 v121, v18, v19
  v_smfmac_f32_16x16x64_bf16 v[20:23], v[88:91], a[128:135], v0
  ds_write_b64 v5, v[120:121] offset:24576
  v_smfmac_f32_16x16x64_bf16 v[20:23], v[100:103], a[136:143], v0
  s_waitcnt lgkmcnt(3)
  v_smfmac_f32_16x16x64_bf16 v[24:27], v[92:95], v[68:75], v0
  s_waitcnt lgkmcnt(1)
  v_mov_b64 v[92:93], 0
  v_smfmac_f32_16x16x64_bf16 v[24:27], v[96:99], v[76:83], v0
  s_nop 1
  v_cvt_pk_bf16_f32 v122, v20, v21
  v_cvt_pk_bf16_f32 v123, v22, v23
  v_smfmac_f32_16x16x64_bf16 v[24:27], v[116:119], v[208:215], v0
  ds_write_b64 v5, v[122:123] offset:26880
  v_mov_b64 v[94:95], 0
  v_smfmac_f32_16x16x64_bf16 v[24:27], v[124:127], v[216:223], v0
  s_waitcnt lgkmcnt(1)
  s_barrier
  ds_read_b64_tr_b16 v[68:69], v6 offset:24576
  v_smfmac_f32_16x16x64_bf16 v[24:27], v[104:107], a[48:55], v0
  s_add_u32 s27, s27, 8192
  ds_read_b64_tr_b16 v[70:71], v6 offset:24640
  ds_read_b64_tr_b16 v[72:73], v6 offset:24832
  v_smfmac_f32_16x16x64_bf16 v[24:27], v[108:111], a[56:63], v0
  s_add_u32 s28, s28, 8192
  ds_read_b64_tr_b16 v[74:75], v6 offset:24896
  ds_read_b64_tr_b16 v[76:77], v6 offset:25088
  v_smfmac_f32_16x16x64_bf16 v[24:27], v[112:115], a[96:103], v0
  s_nop 0
  ds_read_b64_tr_b16 v[78:79], v6 offset:25152
  ds_read_b64_tr_b16 v[80:81], v6 offset:25344
  v_smfmac_f32_16x16x64_bf16 v[24:27], v[84:87], a[104:111], v0
  ds_read_b64_tr_b16 v[82:83], v6 offset:25408
  v_mov_b64 v[96:97], 0
  v_smfmac_f32_16x16x64_bf16 v[24:27], v[88:91], a[144:151], v0
  s_waitcnt lgkmcnt(8)
  s_barrier
  ds_read_b64_tr_b16 v[116:117], v6 offset:26880
  v_smfmac_f32_16x16x64_bf16 v[24:27], v[100:103], a[152:159], v0
  s_waitcnt lgkmcnt(7)
  ds_read_b64_tr_b16 v[118:119], v6 offset:26944
  v_mfma_f32_16x16x32_bf16 v[16:19], v[36:39], v[68:71], 0
  s_waitcnt lgkmcnt(6)
  ds_read_b64_tr_b16 v[124:125], v6 offset:27136
  ds_read_b64_tr_b16 v[126:127], v6 offset:27200
  v_mfma_f32_16x16x32_bf16 v[16:19], v[40:43], v[72:75], v[16:19]
  s_waitcnt lgkmcnt(6)
  ds_read_b64_tr_b16 v[104:105], v6 offset:27392
  ds_read_b64_tr_b16 v[106:107], v6 offset:27456
  v_mfma_f32_16x16x32_bf16 v[16:19], v[44:47], v[76:79], v[16:19]
  s_waitcnt lgkmcnt(6)
  ds_read_b64_tr_b16 v[108:109], v6 offset:27648
  ds_read_b64_tr_b16 v[110:111], v6 offset:27712
  v_mfma_f32_16x16x32_bf16 v[16:19], v[48:51], v[80:83], v[16:19]
  s_waitcnt lgkmcnt(6)
  v_cvt_pk_bf16_f32 v120, v24, v25
  v_cvt_pk_bf16_f32 v121, v26, v27
  v_mfma_f32_16x16x32_bf16 v[112:115], v[116:119], v[68:71], 0
  s_waitcnt lgkmcnt(4)
  buffer_store_dwordx4 v[120:123], v2, s[4:7], s29 offen offset:1024 sc1
  v_mov_b64 v[98:99], 0
  v_mfma_f32_16x16x32_bf16 v[112:115], v[124:127], v[72:75], v[112:115]
  s_waitcnt lgkmcnt(2)
  v_mov_b64 v[36:37], 0
  v_exp_f32 v100, v16
  v_mfma_f32_16x16x32_bf16 v[112:115], v[104:107], v[76:79], v[112:115]
  s_waitcnt lgkmcnt(0)
  v_exp_f32 v101, v17
  v_mfma_f32_16x16x32_bf16 v[112:115], v[108:111], v[80:83], v[112:115]
  s_add_u32 s29, s29, 131072
  v_exp_f32 v102, v18
  v_mfma_f32_16x16x32_bf16 v[20:23], v[52:55], v[68:71], 0
  s_cmp_eq_u32 s14, 63
  v_exp_f32 v103, v19
  v_mfma_f32_16x16x32_bf16 v[20:23], v[56:59], v[72:75], v[20:23]
  s_cbranch_scc1 M_tdone
  v_cvt_pk_bf16_f32 v44, v100, v101
  v_cvt_pk_bf16_f32 v45, v102, v103
  v_mfma_f32_16x16x32_bf16 v[20:23], v[60:63], v[76:79], v[20:23]
  v_exp_f32 v100, v112
  v_mfma_f32_16x16x32_bf16 v[20:23], v[64:67], v[80:83], v[20:23]
  v_exp_f32 v101, v113
  v_exp_f32 v102, v114
  v_exp_f32 v103, v115
  v_cvt_pk_bf16_f32 v84, v100, v101
  v_cvt_pk_bf16_f32 v85, v102, v103
  v_cndmask_b32 v48, v84, 0, s[16:17]
  v_cndmask_b32 v49, v85, 0, s[16:17]
  v_cndmask_b32 v50, 0, v84, s[16:17]
  v_cndmask_b32 v51, 0, v85, s[16:17]
  v_exp_f32 v100, v20
  v_mfma_f32_16x16x16_bf16 v[88:91], v[12:13], v[48:49], 0
  v_exp_f32 v101, v21
  v_mfma_f32_16x16x16_bf16 v[24:27], v[120:121], v[48:49], 0
  v_exp_f32 v102, v22
  v_mfma_f32_16x16x16_bf16 v[116:119], v[120:121], v[50:51], 0
  v_exp_f32 v103, v23
  v_cvt_pk_bf16_f32 v46, v100, v101
  v_cvt_pk_bf16_f32 v47, v102, v103
  v_mov_b64 v[38:39], 0
  s_nop 0
  v_mfma_f32_16x16x32_bf16 v[88:91], v[12:15], v[44:47], v[88:91]
  v_mov_b64 v[40:41], 0
  v_mov_b64 v[42:43], 0
  v_mfma_f32_16x16x32_bf16 v[24:27], v[28:31], v[44:47], v[24:27]
  ds_read_b128 v[52:55], v4 offset:24576
  ds_read_b128 v[56:59], v4 offset:25600
  v_mfma_f32_16x16x32_bf16 v[116:119], v[32:35], v[44:47], v[116:119]
  s_nop 1
  v_rcp_f32 v89, v88
  v_subrev_u32 v100, s54, v88
  v_cmp_le_u32 vcc, s55, v100
  v_mul_f32 v24, v89, v24
  v_mul_f32 v25, v89, v25
  s_cbranch_vccnz T_slow_174
T_back_175:
  v_cvt_pk_bf16_f32 v124, v24, v25
  v_pk_mul_f32 v[26:27], v[26:27], v[88:89] op_sel:[0,1] op_sel_hi:[1,1]
  v_pk_mul_f32 v[116:117], v[116:117], v[88:89] op_sel:[0,1] op_sel_hi:[1,1]
  v_pk_mul_f32 v[118:119], v[118:119], v[88:89] op_sel:[0,1] op_sel_hi:[1,1]
  v_cvt_pk_bf16_f32 v125, v26, v27
  v_cvt_pk_bf16_f32 v126, v116, v117
  v_cvt_pk_bf16_f32 v127, v118, v119
  ds_write_b128 v11, v[124:127] offset:29696
  s_nop 0
  v_smfmac_f32_16x16x64_bf16 v[92:95], v[124:127], a[160:167], v0
  v_smfmac_f32_16x16x64_bf16 v[96:99], v[124:127], a[168:175], v0
  v_smfmac_f32_16x16x64_bf16 v[36:39], v[124:127], a[176:183], v0
  v_smfmac_f32_16x16x64_bf16 v[40:43], v[124:127], a[184:191], v0
  s_waitcnt lgkmcnt(0)
  s_barrier
  ds_read_b128 v[104:107], v11 offset:29184
  ds_read_b128 v[108:111], v11 offset:30720
  ds_read_b128 v[68:71], v11 offset:30208
  s_waitcnt lgkmcnt(2)
  v_smfmac_f32_16x16x64_bf16 v[92:95], v[104:107], a[192:199], v0
  s_waitcnt lgkmcnt(1)
  ds_read_b128 v[76:79], v4 offset:28672
  v_smfmac_f32_16x16x64_bf16 v[92:95], v[108:111], a[224:231], v0
  s_waitcnt lgkmcnt(1)
  ds_read_b128 v[80:83], v4 offset:29696
  v_smfmac_f32_16x16x64_bf16 v[92:95], v[68:71], a[240:247], v0
  ds_read_b128 v[60:63], v4 offset:26624
  v_smfmac_f32_16x16x64_bf16 v[96:99], v[104:107], a[200:207], v0
  ds_read_b128 v[64:67], v4 offset:27648
  v_smfmac_f32_16x16x64_bf16 v[96:99], v[108:111], a[232:239], v0
  ds_read_b128 v[28:31], v4 offset:30720
  s_nop 0
  v_cvt_pk_bf16_f32 v16, v92, v93
  v_cvt_pk_bf16_f32 v17, v94, v95
  v_bfi_b32 v16, 1, s57, v16
  v_smfmac_f32_16x16x64_bf16 v[96:99], v[68:71], a[248:255], v0
  buffer_store_dwordx2 v[16:17], v7, s[4:7], s20 offen offset:0 sc1
  v_smfmac_f32_16x16x64_bf16 v[36:39], v[104:107], a[208:215], v0
  ds_read_b128 v[32:35], v4 offset:31744
  v_smfmac_f32_16x16x64_bf16 v[36:39], v[108:111], v[52:59], v0
  s_waitcnt lgkmcnt(4)
  s_nop 0
  v_cvt_pk_bf16_f32 v18, v96, v97
  v_cvt_pk_bf16_f32 v19, v98, v99
  v_bfi_b32 v18, 1, s57, v18
  v_smfmac_f32_16x16x64_bf16 v[36:39], v[68:71], v[76:83], v0
  buffer_store_dwordx2 v[18:19], v7, s[4:7], s20 offen offset:64 sc1
  v_smfmac_f32_16x16x64_bf16 v[40:43], v[104:107], a[216:223], v0
  s_waitcnt lgkmcnt(2)
  ds_read_b128 v[116:119], v2 offset:31232
  v_smfmac_f32_16x16x64_bf16 v[40:43], v[108:111], v[60:67], v0
  s_waitcnt lgkmcnt(1)
  s_nop 0
  v_cvt_pk_bf16_f32 v20, v36, v37
  v_cvt_pk_bf16_f32 v21, v38, v39
  v_bfi_b32 v20, 1, s57, v20
  v_smfmac_f32_16x16x64_bf16 v[40:43], v[68:71], v[28:35], v0
  buffer_store_dwordx2 v[20:21], v7, s[4:7], s21 offen offset:0 sc1
  s_nop 6
  v_cvt_pk_bf16_f32 v22, v40, v41
  v_cvt_pk_bf16_f32 v23, v42, v43
  v_bfi_b32 v22, 1, s57, v22
  buffer_store_dwordx2 v[22:23], v7, s[4:7], s21 offen offset:64 sc1
  ds_read_b128 v[68:71], v4 offset:0
  ds_read_b128 v[72:75], v4 offset:1024
  ds_read_b128 v[76:79], v4 offset:4096
  ds_read_b128 v[80:83], v4 offset:5120
  ds_read_b128 v[84:87], v4 offset:8192
  ds_read_b128 v[88:91], v4 offset:9216
  ds_read_b128 v[92:95], v4 offset:2048
  ds_read_b128 v[96:99], v4 offset:3072
  ds_read_b128 v[100:103], v4 offset:6144
  ds_read_b128 v[104:107], v4 offset:7168
  ds_read_b128 v[108:111], v4 offset:10240
  ds_read_b128 v[112:115], v4 offset:11264
  v_mov_b64 v[16:17], 0
  v_mov_b64 v[18:19], 0
  v_mov_b64 v[20:21], 0
  v_mov_b64 v[22:23], 0
  v_mov_b64 v[24:25], 0
  v_mov_b64 v[26:27], 0
  s_mov_b32 s19, 0
  v_mov_b32 v49, -1
  ds_read_b64 v[44:45], v2 offset:32256
  s_waitcnt lgkmcnt(0)
  v_readfirstlane_b32 s38, v44
  v_readfirstlane_b32 s37, v45
  s_nop 0
  s_add_u32 s37, s37, 30
  s_cmp_ge_u32 s38, 30
  s_cselect_b32 s38, s37, s38
  s_cmp_ge_u32 s38, 64
  s_cselect_b32 s38, 100, s38
  s_sub_u32 s38, s38, 1
  s_max_i32 s30, s30, s38
  s_waitcnt vmcnt(0)
  buffer_load_dwordx4 v[52:55], v2, s[4:7], s22 offen offset:0 sc1
  buffer_load_dwordx4 v[56:59], v2, s[4:7], s22 offen offset:1024 sc1
  buffer_load_dwordx4 v[60:63], v2, s[4:7], s22 offen offset:2048 sc1
  buffer_load_dwordx4 v[64:67], v2, s[4:7], s22 offen offset:3072 sc1
  s_waitcnt lgkmcnt(12)
  s_waitcnt vmcnt(3)
  v_mfma_f32_16x16x32_bf16 v[120:123], v[116:119], v[52:55], 0
  v_xor_b32 v48, s57, v52
  v_bitop3_b32 v48, v48, v54, s57 bitop3:0xf6
  s_waitcnt vmcnt(2)
  v_mfma_f32_16x16x32_bf16 v[120:123], v[116:119], v[56:59], v[120:123]
  v_bitop3_b32 v48, v48, v56, s57 bitop3:0xf6
  v_bitop3_b32 v48, v48, v58, s57 bitop3:0xf6
  s_waitcnt vmcnt(1)
  v_mfma_f32_16x16x32_bf16 v[120:123], v[116:119], v[60:63], v[120:123]
  v_bitop3_b32 v48, v48, v60, s57 bitop3:0xf6
  v_bitop3_b32 v48, v48, v62, s57 bitop3:0xf6
  s_waitcnt vmcnt(0)
  v_mfma_f32_16x16x32_bf16 v[120:123], v[116:119], v[64:67], v[120:123]
  v_bitop3_b32 v48, v48, v64, s57 bitop3:0xf6
  v_bitop3_b32 v48, v48, v66, s57 bitop3:0xf6
  v_and_b32 v48, 1, v48
  v_cmp_ne_u32 vcc, 0, v48
  s_cbranch_vccnz T_p1re_177
T_p1ok_178:
  s_nop 2
  v_add_f32_dpp v120, v120, v120 row_ror:8 row_mask:0xf bank_mask:0xf
  v_add_f32_dpp v121, v121, v121 row_ror:8 row_mask:0xf bank_mask:0xf
  v_cvt_pk_bf16_f32 v48, v120, v121
  v_min_u32 v48, -2, v48
  buffer_store_dword v48, v8, s[4:7], s35 offen sc1
  buffer_store_dword v49, v8, s[4:7], s26 offen sc1
  s_barrier
  ds_read_b128 v[28:31], v2 offset:17408
  ds_read_b128 v[32:35], v2 offset:21504
  ds_read_b128 v[36:39], v2 offset:8192
  ds_read_b128 v[40:43], v2 offset:9216
  ds_read_b128 v[44:47], v2 offset:10240
  ds_read_b128 v[48:51], v2 offset:11264
  buffer_load_dwordx4 v[124:127], v3, s[4:7], s24 offen offset:1024 sc1
  buffer_load_dwordx4 v[116:119], v3, s[4:7], s25 offen offset:1024 sc1
  ds_read_b128 v[52:55], v2 offset:12288
  ds_read_b128 v[56:59], v2 offset:13312
  ds_read_b128 v[60:63], v2 offset:14336
  ds_read_b128 v[64:67], v2 offset:15360
  buffer_load_dwordx4 v[124:127], v3, s[4:7], s24 offen offset:1024 sc1
  buffer_load_dwordx4 v[116:119], v3, s[4:7], s25 offen offset:1024 sc1
  s_mov_b32 s19, 0
  s_branch T_loop_167
T_p1re_177:
  s_mov_b64 exec, vcc
  buffer_load_dwordx4 v[52:55], v2, s[4:7], s22 offen offset:0 sc1
  buffer_load_dwordx4 v[56:59], v2, s[4:7], s22 offen offset:1024 sc1
  buffer_load_dwordx4 v[60:63], v2, s[4:7], s22 offen offset:2048 sc1
  buffer_load_dwordx4 v[64:67], v2, s[4:7], s22 offen offset:3072 sc1
  s_mov_b64 exec, -1
  s_add_u32 s19, s19, 1
  s_cmp_gt_u32 s19, 32768
  s_cbranch_scc1 M_exit
  s_waitcnt vmcnt(3)
  v_mfma_f32_16x16x32_bf16 v[120:123], v[116:119], v[52:55], 0
  v_xor_b32 v48, s57, v52
  v_bitop3_b32 v48, v48, v54, s57 bitop3:0xf6
  s_waitcnt vmcnt(2)
  v_mfma_f32_16x16x32_bf16 v[120:123], v[116:119], v[56:59], v[120:123]
  v_bitop3_b32 v48, v48, v56, s57 bitop3:0xf6
  v_bitop3_b32 v48, v48, v58, s57 bitop3:0xf6
  s_waitcnt vmcnt(1)
  v_mfma_f32_16x16x32_bf16 v[120:123], v[116:119], v[60:63], v[120:123]
  v_bitop3_b32 v48, v48, v60, s57 bitop3:0xf6
  v_bitop3_b32 v48, v48, v62, s57 bitop3:0xf6
  s_waitcnt vmcnt(0)
  v_mfma_f32_16x16x32_bf16 v[120:123], v[116:119], v[64:67], v[120:123]
  v_bitop3_b32 v48, v48, v64, s57 bitop3:0xf6
  v_bitop3_b32 v48, v48, v66, s57 bitop3:0xf6
  v_and_b32 v48, 1, v48
  v_cmp_ne_u32 vcc, 0, v48
  s_cbranch_vccnz T_p1re_177
  s_branch T_p1ok_178
T_kvw_171:
  s_mov_b32 s19, 0
  s_branch T_kvok_180
T_kv_179:
  s_sleep 4
  s_add_u32 s19, s19, 1
  s_cmp_gt_u32 s19, 32768
  s_cbranch_scc1 M_exit
T_kvok_180:
  s_add_u32 s39, s99, 128
  s_mov_b32 s38, 0
  s_mov_b32 s37, 0
  s_atomic_or s38, s[58:59], s99 glc
  s_atomic_or s37, s[58:59], s39 glc
  s_waitcnt lgkmcnt(0)
  s_add_u32 s37, s37, 30
  s_cmp_ge_u32 s38, 30
  s_cselect_b32 s38, s37, s38
  s_cmp_ge_u32 s38, 64
  s_cselect_b32 s38, 100, s38
  s_sub_u32 s38, s38, 1
  s_max_i32 s30, s30, s38
  s_cmp_ge_i32 s14, s30
  s_cbranch_scc1 T_kv_179
  s_branch T_kvb_172
T_slow_174:
  s_nop 7
  v_max3_f32 v100, v16, v17, v18
  v_max3_f32 v100, v100, v19, v20
  v_max3_f32 v100, v100, v21, v22
  v_max3_f32 v100, v100, v23, v112
  v_max3_f32 v100, v100, v113, v114
  v_max_f32 v100, v100, v115
  v_mov_b32 v101, v100
  s_nop 1
  v_permlane32_swap_b32 v100, v101
  s_nop 1
  v_max_f32 v100, v100, v101
  v_mov_b32 v101, v100
  s_nop 1
  v_permlane16_swap_b32 v100, v101
  s_nop 1
  v_max_f32 v100, v100, v101
  v_sub_f32 v16, v16, v100
  v_sub_f32 v17, v17, v100
  v_sub_f32 v18, v18, v100
  v_sub_f32 v19, v19, v100
  v_exp_f32 v16, v16
  v_exp_f32 v17, v17
  v_exp_f32 v18, v18
  v_exp_f32 v19, v19
  v_sub_f32 v20, v20, v100
  v_sub_f32 v21, v21, v100
  v_sub_f32 v22, v22, v100
  v_sub_f32 v23, v23, v100
  v_exp_f32 v20, v20
  v_exp_f32 v21, v21
  v_exp_f32 v22, v22
  v_exp_f32 v23, v23
  v_sub_f32 v112, v112, v100
  v_sub_f32 v113, v113, v100
  v_sub_f32 v114, v114, v100
  v_sub_f32 v115, v115, v100
  v_exp_f32 v112, v112
  v_exp_f32 v113, v113
  v_exp_f32 v114, v114
  v_exp_f32 v115, v115
  s_nop 0
  v_cvt_pk_bf16_f32 v44, v16, v17
  v_cvt_pk_bf16_f32 v45, v18, v19
  v_cvt_pk_bf16_f32 v46, v20, v21
  v_cvt_pk_bf16_f32 v47, v22, v23
  v_cvt_pk_bf16_f32 v84, v112, v113
  v_cvt_pk_bf16_f32 v85, v114, v115
  v_cndmask_b32 v48, v84, 0, s[16:17]
  v_cndmask_b32 v49, v85, 0, s[16:17]
  v_cndmask_b32 v50, 0, v84, s[16:17]
  v_cndmask_b32 v51, 0, v85, s[16:17]
  s_nop 1
  v_mfma_f32_16x16x16_bf16 v[88:91], v[12:13], v[48:49], 0
  v_mfma_f32_16x16x16_bf16 v[24:27], v[120:121], v[48:49], 0
  v_mfma_f32_16x16x16_bf16 v[116:119], v[120:121], v[50:51], 0
  v_mfma_f32_16x16x32_bf16 v[88:91], v[12:15], v[44:47], v[88:91]
  v_mfma_f32_16x16x32_bf16 v[24:27], v[28:31], v[44:47], v[24:27]
  v_mfma_f32_16x16x32_bf16 v[116:119], v[32:35], v[44:47], v[116:119]
  s_nop 7
  s_nop 1
  v_rcp_f32 v89, v88
  s_nop 0
  v_mul_f32 v24, v89, v24
  v_mul_f32 v25, v89, v25
  s_branch T_back_175
T_w_151:
  s_mov_b32 s19, 0
  v_mov_b64 v[16:17], 0
  v_mov_b64 v[18:19], 0
  v_mov_b64 v[20:21], 0
  v_mov_b64 v[22:23], 0
  v_mov_b64 v[24:25], 0
  v_mov_b64 v[26:27], 0
  buffer_load_dwordx4 v[124:127], v3, s[4:7], s24 offen offset:2048 sc1
  buffer_load_dwordx4 v[116:119], v3, s[4:7], s25 offen offset:2048 sc1
  buffer_load_dwordx4 v[124:127], v3, s[4:7], s24 offen offset:2048 sc1
  buffer_load_dwordx4 v[116:119], v3, s[4:7], s25 offen offset:2048 sc1
  s_branch T_loop_181
.p2align 6
T_retry_182:
  s_mov_b64 exec, vcc
  buffer_load_dwordx4 v[124:127], v3, s[4:7], s24 offen offset:2048 sc1
  buffer_load_dwordx4 v[116:119], v3, s[4:7], s25 offen offset:2048 sc1
  s_mov_b64 exec, -1
  s_add_u32 s19, s19, 1
  s_cmp_gt_u32 s19, 32768
  s_cbranch_scc1 M_exit
T_loop_181:
  s_waitcnt vmcnt(3) lgkmcnt(0)
  v_max3_u32 v123, v124, v125, v126
  v_max_u32 v123, v123, v127
  v_mov_b32_dpp v120, v124 row_ror:8 row_mask:0xf bank_mask:0xf
  v_mov_b32_dpp v121, v125 row_ror:8 row_mask:0xf bank_mask:0xf
  s_waitcnt vmcnt(2)
  v_max3_u32 v123, v123, v116, v117
  v_max3_u32 v123, v123, v118, v119
  v_cmp_eq_u32 vcc, -1, v123
  s_cbranch_vccnz T_retry_182
  v_smfmac_f32_16x16x64_bf16 v[16:19], v[124:127], v[68:75], v0
  s_add_u32 s14, s14, 1
  ds_write_b128 v2, v[124:127] offset:2048
  v_mov_b32_dpp v122, v126 row_ror:8 row_mask:0xf bank_mask:0xf
  v_smfmac_f32_16x16x64_bf16 v[20:23], v[124:127], v[76:83], v0
  s_and_b32 s57, s14, 1
  v_mov_b32_dpp v123, v127 row_ror:8 row_mask:0xf bank_mask:0xf
  v_smfmac_f32_16x16x64_bf16 v[24:27], v[124:127], v[84:91], v0
  s_and_b32 s36, s14, 3
  ds_write_b128 v2, v[116:119] offset:6144
  v_smfmac_f32_16x16x64_bf16 v[16:19], v[120:123], v[92:99], v0
  s_lshl_b32 s36, s36, 13
  v_mov_b32_dpp v84, v116 row_ror:8 row_mask:0xf bank_mask:0xf
  v_smfmac_f32_16x16x64_bf16 v[20:23], v[120:123], v[100:107], v0
  s_add_u32 s26, s36, s23
  ds_read_b128 v[68:71], v4 offset:12288
  v_mov_b32_dpp v85, v117 row_ror:8 row_mask:0xf bank_mask:0xf
  v_smfmac_f32_16x16x64_bf16 v[24:27], v[120:123], v[108:115], v0
  s_add_u32 s36, s36, 8192
  ds_read_b128 v[72:75], v4 offset:13312
  v_mov_b32_dpp v86, v118 row_ror:8 row_mask:0xf bank_mask:0xf
  v_smfmac_f32_16x16x64_bf16 v[16:19], v[116:119], v[224:231], v0
  s_and_b32 s36, s36, 0x7fff
  ds_read_b128 v[76:79], v4 offset:14336
  v_mov_b32_dpp v87, v119 row_ror:8 row_mask:0xf bank_mask:0xf
  v_smfmac_f32_16x16x64_bf16 v[20:23], v[116:119], v[240:247], v0
  s_waitcnt lgkmcnt(3)
  s_barrier
  ds_read_b128 v[100:103], v2 offset:3072
  v_smfmac_f32_16x16x64_bf16 v[24:27], v[116:119], a[0:7], v0
  s_mov_b32 m0, s31
  ds_read_b128 v[120:123], v1 offset:3072
  v_smfmac_f32_16x16x64_bf16 v[16:19], v[84:87], v[232:239], v0
  s_cmp_ge_i32 s14, s30
  s_cbranch_scc1 T_kvw_185
T_kvb_186:
  v_smfmac_f32_16x16x64_bf16 v[20:23], v[84:87], v[248:255], v0
  ds_read_b128 v[80:83], v4 offset:15360
  v_smfmac_f32_16x16x64_bf16 v[24:27], v[84:87], a[8:15], v0
  s_waitcnt lgkmcnt(2)
  v_smfmac_f32_16x16x64_bf16 v[16:19], v[100:103], v[128:135], v0
  ds_read_b128 v[92:95], v2 offset:0
  buffer_load_dwordx4 v9, s[4:7], s27 offen sc1 lds
  v_smfmac_f32_16x16x64_bf16 v[20:23], v[100:103], v[144:151], v0
  ds_read_b128 v[96:99], v1 offset:0
  s_mov_b32 m0, s32
  v_smfmac_f32_16x16x64_bf16 v[24:27], v[100:103], v[68:75], v0
  s_waitcnt vmcnt(1) lgkmcnt(3)
  ds_read_b128 v[116:119], v2 offset:1024
  v_smfmac_f32_16x16x64_bf16 v[16:19], v[120:123], v[136:143], v0
  ds_read_b128 v[124:127], v1 offset:1024
  v_smfmac_f32_16x16x64_bf16 v[20:23], v[120:123], v[152:159], v0
  s_waitcnt lgkmcnt(4)
  ds_read_b128 v[104:107], v2 offset:7168
  buffer_load_dwordx4 v9, s[4:7], s27 offen offset:128 sc1 lds
  v_smfmac_f32_16x16x64_bf16 v[24:27], v[120:123], v[76:83], v0
  s_waitcnt lgkmcnt(4)
  ds_read_b128 v[108:111], v1 offset:7168
  s_mov_b32 m0, s33
  v_smfmac_f32_16x16x64_bf16 v[16:19], v[92:95], v[160:167], v0
  s_waitcnt lgkmcnt(4)
  ds_read_b128 v[112:115], v2 offset:4096
  v_mov_b32 v122, s98
  v_smfmac_f32_16x16x64_bf16 v[16:19], v[96:99], v[168:175], v0
  s_waitcnt lgkmcnt(4)
  ds_read_b128 v[84:87], v1 offset:4096
  v_smfmac_f32_16x16x64_bf16 v[16:19], v[116:119], v[192:199], v0
  s_waitcnt lgkmcnt(4)
  ds_read_b128 v[88:91], v2 offset:5120
  buffer_load_dwordx4 v10, s[4:7], s28 offen sc1 lds
  v_smfmac_f32_16x16x64_bf16 v[16:19], v[124:127], v[200:207], v0
  s_waitcnt lgkmcnt(4)
  ds_read_b128 v[100:103], v1 offset:5120
  s_mov_b32 m0, s34
  v_smfmac_f32_16x16x64_bf16 v[16:19], v[104:107], a[16:23], v0
  s_waitcnt lgkmcnt(4)
  ds_read_b128 v[68:71], v4 offset:16384
  v_smfmac_f32_16x16x64_bf16 v[16:19], v[108:111], a[24:31], v0
  s_waitcnt lgkmcnt(4)
  ds_read_b128 v[72:75], v4 offset:17408
  v_smfmac_f32_16x16x64_bf16 v[16:19], v[112:115], a[64:71], v0
  s_waitcnt lgkmcnt(4)
  ds_read_b128 v[76:79], v4 offset:18432
  buffer_load_dwordx4 v10, s[4:7], s28 offen offset:256 sc1 lds
  v_smfmac_f32_16x16x64_bf16 v[16:19], v[84:87], a[72:79], v0
  s_waitcnt lgkmcnt(4)
  ds_read_b128 v[80:83], v4 offset:19456
  v_smfmac_f32_16x16x64_bf16 v[16:19], v[88:91], a[112:119], v0
  s_waitcnt lgkmcnt(4)
  v_smfmac_f32_16x16x64_bf16 v[16:19], v[100:103], a[120:127], v0
  s_add_u32 s24, s36, 145752064
  s_add_u32 s25, s36, 145756160
  v_smfmac_f32_16x16x64_bf16 v[20:23], v[92:95], v[176:183], v0
  buffer_store_dword v122, v8, s[4:7], s15 offen sc1
  s_add_u32 s35, s36, s23
  v_smfmac_f32_16x16x64_bf16 v[20:23], v[96:99], v[184:191], v0
  s_waitcnt lgkmcnt(2)
  s_add_u32 s98, s14, 1
  v_smfmac_f32_16x16x64_bf16 v[20:23], v[116:119], v[68:75], v0
  s_waitcnt lgkmcnt(0)
  ds_read_b128 v[68:71], v4 offset:20480
  v_mul_f32 v16, s18, v16
  v_smfmac_f32_16x16x64_bf16 v[20:23], v[124:127], v[76:83], v0
  ds_read_b128 v[72:75], v4 offset:21504
  v_mul_f32 v17, s18, v17
  v_smfmac_f32_16x16x64_bf16 v[20:23], v[104:107], a[32:39], v0
  ds_read_b128 v[76:79], v4 offset:22528
  v_mul_f32 v18, s18, v18
  v_smfmac_f32_16x16x64_bf16 v[20:23], v[108:111], a[40:47], v0
  ds_read_b128 v[80:83], v4 offset:23552
  v_mul_f32 v19, s18, v19
  v_smfmac_f32_16x16x64_bf16 v[20:23], v[112:115], a[80:87], v0
  v_cvt_pk_bf16_f32 v120, v16, v17
  v_smfmac_f32_16x16x64_bf16 v[20:23], v[84:87], a[88:95], v0
  v_cvt_pk_bf16_f32 v121, v18, v19
  v_smfmac_f32_16x16x64_bf16 v[20:23], v[88:91], a[128:135], v0
  ds_write_b64 v5, v[120:121] offset:24576
  v_smfmac_f32_16x16x64_bf16 v[20:23], v[100:103], a[136:143], v0
  s_waitcnt lgkmcnt(3)
  v_smfmac_f32_16x16x64_bf16 v[24:27], v[92:95], v[68:75], v0
  s_waitcnt lgkmcnt(1)
  v_mov_b64 v[92:93], 0
  v_smfmac_f32_16x16x64_bf16 v[24:27], v[96:99], v[76:83], v0
  s_nop 1
  v_cvt_pk_bf16_f32 v122, v20, v21
  v_cvt_pk_bf16_f32 v123, v22, v23
  v_smfmac_f32_16x16x64_bf16 v[24:27], v[116:119], v[208:215], v0
  ds_write_b64 v5, v[122:123] offset:26880
  v_mov_b64 v[94:95], 0
  v_smfmac_f32_16x16x64_bf16 v[24:27], v[124:127], v[216:223], v0
  s_waitcnt lgkmcnt(1)
  s_barrier
  ds_read_b64_tr_b16 v[68:69], v6 offset:24576
  v_smfmac_f32_16x16x64_bf16 v[24:27], v[104:107], a[48:55], v0
  s_add_u32 s27, s27, 8192
  ds_read_b64_tr_b16 v[70:71], v6 offset:24640
  ds_read_b64_tr_b16 v[72:73], v6 offset:24832
  v_smfmac_f32_16x16x64_bf16 v[24:27], v[108:111], a[56:63], v0
  s_add_u32 s28, s28, 8192
  ds_read_b64_tr_b16 v[74:75], v6 offset:24896
  ds_read_b64_tr_b16 v[76:77], v6 offset:25088
  v_smfmac_f32_16x16x64_bf16 v[24:27], v[112:115], a[96:103], v0
  s_nop 0
  ds_read_b64_tr_b16 v[78:79], v6 offset:25152
  ds_read_b64_tr_b16 v[80:81], v6 offset:25344
  v_smfmac_f32_16x16x64_bf16 v[24:27], v[84:87], a[104:111], v0
  ds_read_b64_tr_b16 v[82:83], v6 offset:25408
  v_mov_b64 v[96:97], 0
  v_smfmac_f32_16x16x64_bf16 v[24:27], v[88:91], a[144:151], v0
  s_waitcnt lgkmcnt(8)
  s_barrier
  ds_read_b64_tr_b16 v[116:117], v6 offset:26880
  v_smfmac_f32_16x16x64_bf16 v[24:27], v[100:103], a[152:159], v0
  s_waitcnt lgkmcnt(7)
  ds_read_b64_tr_b16 v[118:119], v6 offset:26944
  v_mfma_f32_16x16x32_bf16 v[16:19], v[36:39], v[68:71], 0
  s_waitcnt lgkmcnt(6)
  ds_read_b64_tr_b16 v[124:125], v6 offset:27136
  ds_read_b64_tr_b16 v[126:127], v6 offset:27200
  v_mfma_f32_16x16x32_bf16 v[16:19], v[40:43], v[72:75], v[16:19]
  s_waitcnt lgkmcnt(6)
  ds_read_b64_tr_b16 v[104:105], v6 offset:27392
  ds_read_b64_tr_b16 v[106:107], v6 offset:27456
  v_mfma_f32_16x16x32_bf16 v[16:19], v[44:47], v[76:79], v[16:19]
  s_waitcnt lgkmcnt(6)
  ds_read_b64_tr_b16 v[108:109], v6 offset:27648
  ds_read_b64_tr_b16 v[110:111], v6 offset:27712
  v_mfma_f32_16x16x32_bf16 v[16:19], v[48:51], v[80:83], v[16:19]
  s_waitcnt lgkmcnt(6)
  v_cvt_pk_bf16_f32 v120, v24, v25
  v_cvt_pk_bf16_f32 v121, v26, v27
  v_mfma_f32_16x16x32_bf16 v[112:115], v[116:119], v[68:71], 0
  s_waitcnt lgkmcnt(4)
  buffer_store_dwordx4 v[120:123], v2, s[4:7], s29 offen offset:2048 sc1
  v_mov_b64 v[98:99], 0
  v_mfma_f32_16x16x32_bf16 v[112:115], v[124:127], v[72:75], v[112:115]
  s_waitcnt lgkmcnt(2)
  v_mov_b64 v[36:37], 0
  v_exp_f32 v100, v16
  v_mfma_f32_16x16x32_bf16 v[112:115], v[104:107], v[76:79], v[112:115]
  s_waitcnt lgkmcnt(0)
  v_exp_f32 v101, v17
  v_mfma_f32_16x16x32_bf16 v[112:115], v[108:111], v[80:83], v[112:115]
  s_add_u32 s29, s29, 131072
  v_exp_f32 v102, v18
  v_mfma_f32_16x16x32_bf16 v[20:23], v[52:55], v[68:71], 0
  s_cmp_eq_u32 s14, 63
  v_exp_f32 v103, v19
  v_mfma_f32_16x16x32_bf16 v[20:23], v[56:59], v[72:75], v[20:23]
  s_cbranch_scc1 M_tdone
  v_cvt_pk_bf16_f32 v44, v100, v101
  v_cvt_pk_bf16_f32 v45, v102, v103
  v_mfma_f32_16x16x32_bf16 v[20:23], v[60:63], v[76:79], v[20:23]
  v_exp_f32 v100, v112
  v_mfma_f32_16x16x32_bf16 v[20:23], v[64:67], v[80:83], v[20:23]
  v_exp_f32 v101, v113
  v_exp_f32 v102, v114
  v_exp_f32 v103, v115
  v_cvt_pk_bf16_f32 v84, v100, v101
  v_cvt_pk_bf16_f32 v85, v102, v103
  v_cndmask_b32 v48, v84, 0, s[16:17]
  v_cndmask_b32 v49, v85, 0, s[16:17]
  v_cndmask_b32 v50, 0, v84, s[16:17]
  v_cndmask_b32 v51, 0, v85, s[16:17]
  v_exp_f32 v100, v20
  v_mfma_f32_16x16x16_bf16 v[88:91], v[12:13], v[48:49], 0
  v_exp_f32 v101, v21
  v_mfma_f32_16x16x16_bf16 v[24:27], v[120:121], v[48:49], 0
  v_exp_f32 v102, v22
  v_mfma_f32_16x16x16_bf16 v[116:119], v[120:121], v[50:51], 0
  v_exp_f32 v103, v23
  v_cvt_pk_bf16_f32 v46, v100, v101
  v_cvt_pk_bf16_f32 v47, v102, v103
  v_mov_b64 v[38:39], 0
  s_nop 0
  v_mfma_f32_16x16x32_bf16 v[88:91], v[12:15], v[44:47], v[88:91]
  v_mov_b64 v[40:41], 0
  v_mov_b64 v[42:43], 0
  v_mfma_f32_16x16x32_bf16 v[24:27], v[28:31], v[44:47], v[24:27]
  ds_read_b128 v[52:55], v4 offset:24576
  ds_read_b128 v[56:59], v4 offset:25600
  v_mfma_f32_16x16x32_bf16 v[116:119], v[32:35], v[44:47], v[116:119]
  s_nop 1
  v_rcp_f32 v89, v88
  v_subrev_u32 v100, s54, v88
  v_cmp_le_u32 vcc, s55, v100
  v_mul_f32 v24, v89, v24
  v_mul_f32 v25, v89, v25
  s_cbranch_vccnz T_slow_188
T_back_189:
  v_cvt_pk_bf16_f32 v124, v24, v25
  v_pk_mul_f32 v[26:27], v[26:27], v[88:89] op_sel:[0,1] op_sel_hi:[1,1]
  v_pk_mul_f32 v[116:117], v[116:117], v[88:89] op_sel:[0,1] op_sel_hi:[1,1]
  v_pk_mul_f32 v[118:119], v[118:119], v[88:89] op_sel:[0,1] op_sel_hi:[1,1]
  v_cvt_pk_bf16_f32 v125, v26, v27
  v_cvt_pk_bf16_f32 v126, v116, v117
  v_cvt_pk_bf16_f32 v127, v118, v119
  ds_write_b128 v11, v[124:127] offset:30208
  s_nop 0
  v_smfmac_f32_16x16x64_bf16 v[92:95], v[124:127], a[160:167], v0
  v_smfmac_f32_16x16x64_bf16 v[96:99], v[124:127], a[168:175], v0
  v_smfmac_f32_16x16x64_bf16 v[36:39], v[124:127], a[176:183], v0
  v_smfmac_f32_16x16x64_bf16 v[40:43], v[124:127], a[184:191], v0
  s_waitcnt lgkmcnt(0)
  s_barrier
  ds_read_b128 v[104:107], v11 offset:30720
  ds_read_b128 v[108:111], v11 offset:29184
  ds_read_b128 v[68:71], v11 offset:29696
  s_waitcnt lgkmcnt(2)
  v_smfmac_f32_16x16x64_bf16 v[92:95], v[104:107], a[192:199], v0
  s_waitcnt lgkmcnt(1)
  ds_read_b128 v[76:79], v4 offset:28672
  v_smfmac_f32_16x16x64_bf16 v[92:95], v[108:111], a[224:231], v0
  s_waitcnt lgkmcnt(1)
  ds_read_b128 v[80:83], v4 offset:29696
  v_smfmac_f32_16x16x64_bf16 v[92:95], v[68:71], a[240:247], v0
  ds_read_b128 v[60:63], v4 offset:26624
  v_smfmac_f32_16x16x64_bf16 v[96:99], v[104:107], a[200:207], v0
  ds_read_b128 v[64:67], v4 offset:27648
  v_smfmac_f32_16x16x64_bf16 v[96:99], v[108:111], a[232:239], v0
  ds_read_b128 v[28:31], v4 offset:30720
  s_nop 0
  v_cvt_pk_bf16_f32 v16, v92, v93
  v_cvt_pk_bf16_f32 v17, v94, v95
  v_bfi_b32 v16, 1, s57, v16
  v_smfmac_f32_16x16x64_bf16 v[96:99], v[68:71], a[248:255], v0
  buffer_store_dwordx2 v[16:17], v7, s[4:7], s20 offen offset:0 sc1
  v_smfmac_f32_16x16x64_bf16 v[36:39], v[104:107], a[208:215], v0
  ds_read_b128 v[32:35], v4 offset:31744
  v_smfmac_f32_16x16x64_bf16 v[36:39], v[108:111], v[52:59], v0
  s_waitcnt lgkmcnt(4)
  s_nop 0
  v_cvt_pk_bf16_f32 v18, v96, v97
  v_cvt_pk_bf16_f32 v19, v98, v99
  v_bfi_b32 v18, 1, s57, v18
  v_smfmac_f32_16x16x64_bf16 v[36:39], v[68:71], v[76:83], v0
  buffer_store_dwordx2 v[18:19], v7, s[4:7], s20 offen offset:64 sc1
  v_smfmac_f32_16x16x64_bf16 v[40:43], v[104:107], a[216:223], v0
  s_waitcnt lgkmcnt(2)
  v_smfmac_f32_16x16x64_bf16 v[40:43], v[108:111], v[60:67], v0
  s_waitcnt lgkmcnt(0)
  s_nop 0
  v_cvt_pk_bf16_f32 v20, v36, v37
  v_cvt_pk_bf16_f32 v21, v38, v39
  v_bfi_b32 v20, 1, s57, v20
  v_smfmac_f32_16x16x64_bf16 v[40:43], v[68:71], v[28:35], v0
  buffer_store_dwordx2 v[20:21], v7, s[4:7], s21 offen offset:0 sc1
  s_nop 6
  v_cvt_pk_bf16_f32 v22, v40, v41
  v_cvt_pk_bf16_f32 v23, v42, v43
  v_bfi_b32 v22, 1, s57, v22
  buffer_store_dwordx2 v[22:23], v7, s[4:7], s21 offen offset:64 sc1
  ds_read_b128 v[68:71], v4 offset:0
  ds_read_b128 v[72:75], v4 offset:1024
  ds_read_b128 v[76:79], v4 offset:4096
  ds_read_b128 v[80:83], v4 offset:5120
  ds_read_b128 v[84:87], v4 offset:8192
  ds_read_b128 v[88:91], v4 offset:9216
  ds_read_b128 v[92:95], v4 offset:2048
  ds_read_b128 v[96:99], v4 offset:3072
  ds_read_b128 v[100:103], v4 offset:6144
  ds_read_b128 v[104:107], v4 offset:7168
  ds_read_b128 v[108:111], v4 offset:10240
  ds_read_b128 v[112:115], v4 offset:11264
  v_mov_b64 v[16:17], 0
  v_mov_b64 v[18:19], 0
  v_mov_b64 v[20:21], 0
  v_mov_b64 v[22:23], 0
  v_mov_b64 v[24:25], 0
  v_mov_b64 v[26:27], 0
  ds_read_b64 v[44:45], v2 offset:32256
  s_waitcnt lgkmcnt(0)
  v_readfirstlane_b32 s38, v44
  v_readfirstlane_b32 s37, v45
  s_nop 0
  s_add_u32 s37, s37, 30
  s_cmp_ge_u32 s38, 30
  s_cselect_b32 s38, s37, s38
  s_cmp_ge_u32 s38, 64
  s_cselect_b32 s38, 100, s38
  s_sub_u32 s38, s38, 1
  s_max_i32 s30, s30, s38
  s_waitcnt vmcnt(4)
  s_barrier
  ds_read_b128 v[28:31], v2 offset:18432
  ds_read_b128 v[32:35], v2 offset:22528
  ds_read_b128 v[36:39], v2 offset:8192
  ds_read_b128 v[40:43], v2 offset:9216
  ds_read_b128 v[44:47], v2 offset:10240
  ds_read_b128 v[48:51], v2 offset:11264
  buffer_load_dwordx4 v[124:127], v3, s[4:7], s24 offen offset:2048 sc1
  buffer_load_dwordx4 v[116:119], v3, s[4:7], s25 offen offset:2048 sc1
  ds_read_b128 v[52:55], v2 offset:12288
  ds_read_b128 v[56:59], v2 offset:13312
  ds_read_b128 v[60:63], v2 offset:14336
  ds_read_b128 v[64:67], v2 offset:15360
  buffer_load_dwordx4 v[124:127], v3, s[4:7], s24 offen offset:2048 sc1
  buffer_load_dwordx4 v[116:119], v3, s[4:7], s25 offen offset:2048 sc1
  s_mov_b32 s19, 0
  s_branch T_loop_181
T_kvw_185:
  s_mov_b32 s19, 0
  s_branch T_kvok_194
T_kv_193:
  s_sleep 4
  s_add_u32 s19, s19, 1
  s_cmp_gt_u32 s19, 32768
  s_cbranch_scc1 M_exit
T_kvok_194:
  s_add_u32 s39, s99, 128
  s_mov_b32 s38, 0
  s_mov_b32 s37, 0
  s_atomic_or s38, s[58:59], s99 glc
  s_atomic_or s37, s[58:59], s39 glc
  s_waitcnt lgkmcnt(0)
  s_add_u32 s37, s37, 30
  s_cmp_ge_u32 s38, 30
  s_cselect_b32 s38, s37, s38
  s_cmp_ge_u32 s38, 64
  s_cselect_b32 s38, 100, s38
  s_sub_u32 s38, s38, 1
  s_max_i32 s30, s30, s38
  s_cmp_ge_i32 s14, s30
  s_cbranch_scc1 T_kv_193
  s_branch T_kvb_186
T_slow_188:
  s_nop 7
  v_max3_f32 v100, v16, v17, v18
  v_max3_f32 v100, v100, v19, v20
  v_max3_f32 v100, v100, v21, v22
  v_max3_f32 v100, v100, v23, v112
  v_max3_f32 v100, v100, v113, v114
  v_max_f32 v100, v100, v115
  v_mov_b32 v101, v100
  s_nop 1
  v_permlane32_swap_b32 v100, v101
  s_nop 1
  v_max_f32 v100, v100, v101
  v_mov_b32 v101, v100
  s_nop 1
  v_permlane16_swap_b32 v100, v101
  s_nop 1
  v_max_f32 v100, v100, v101
  v_sub_f32 v16, v16, v100
  v_sub_f32 v17, v17, v100
  v_sub_f32 v18, v18, v100
  v_sub_f32 v19, v19, v100
  v_exp_f32 v16, v16
  v_exp_f32 v17, v17
  v_exp_f32 v18, v18
  v_exp_f32 v19, v19
  v_sub_f32 v20, v20, v100
  v_sub_f32 v21, v21, v100
  v_sub_f32 v22, v22, v100
  v_sub_f32 v23, v23, v100
  v_exp_f32 v20, v20
  v_exp_f32 v21, v21
  v_exp_f32 v22, v22
  v_exp_f32 v23, v23
  v_sub_f32 v112, v112, v100
  v_sub_f32 v113, v113, v100
  v_sub_f32 v114, v114, v100
  v_sub_f32 v115, v115, v100
  v_exp_f32 v112, v112
  v_exp_f32 v113, v113
  v_exp_f32 v114, v114
  v_exp_f32 v115, v115
  s_nop 0
  v_cvt_pk_bf16_f32 v44, v16, v17
  v_cvt_pk_bf16_f32 v45, v18, v19
  v_cvt_pk_bf16_f32 v46, v20, v21
  v_cvt_pk_bf16_f32 v47, v22, v23
  v_cvt_pk_bf16_f32 v84, v112, v113
  v_cvt_pk_bf16_f32 v85, v114, v115
  v_cndmask_b32 v48, v84, 0, s[16:17]
  v_cndmask_b32 v49, v85, 0, s[16:17]
  v_cndmask_b32 v50, 0, v84, s[16:17]
  v_cndmask_b32 v51, 0, v85, s[16:17]
  s_nop 1
  v_mfma_f32_16x16x16_bf16 v[88:91], v[12:13], v[48:49], 0
  v_mfma_f32_16x16x16_bf16 v[24:27], v[120:121], v[48:49], 0
  v_mfma_f32_16x16x16_bf16 v[116:119], v[120:121], v[50:51], 0
  v_mfma_f32_16x16x32_bf16 v[88:91], v[12:15], v[44:47], v[88:91]
  v_mfma_f32_16x16x32_bf16 v[24:27], v[28:31], v[44:47], v[24:27]
  v_mfma_f32_16x16x32_bf16 v[116:119], v[32:35], v[44:47], v[116:119]
  s_nop 7
  s_nop 1
  v_rcp_f32 v89, v88
  s_nop 0
  v_mul_f32 v24, v89, v24
  v_mul_f32 v25, v89, v25
  s_branch T_back_189
T_w_152:
  s_mov_b32 s19, 0
  v_mov_b64 v[16:17], 0
  v_mov_b64 v[18:19], 0
  v_mov_b64 v[20:21], 0
  v_mov_b64 v[22:23], 0
  v_mov_b64 v[24:25], 0
  v_mov_b64 v[26:27], 0
  buffer_load_dwordx4 v[124:127], v3, s[4:7], s24 offen offset:3072 sc1
  buffer_load_dwordx4 v[116:119], v3, s[4:7], s25 offen offset:3072 sc1
  buffer_load_dwordx4 v[124:127], v3, s[4:7], s24 offen offset:3072 sc1
  buffer_load_dwordx4 v[116:119], v3, s[4:7], s25 offen offset:3072 sc1
  s_branch T_loop_195
.p2align 6
T_retry_196:
  s_mov_b64 exec, vcc
  buffer_load_dwordx4 v[124:127], v3, s[4:7], s24 offen offset:3072 sc1
  buffer_load_dwordx4 v[116:119], v3, s[4:7], s25 offen offset:3072 sc1
  s_mov_b64 exec, -1
  s_add_u32 s19, s19, 1
  s_cmp_gt_u32 s19, 32768
  s_cbranch_scc1 M_exit
T_loop_195:
  s_waitcnt vmcnt(3) lgkmcnt(0)
  v_max3_u32 v123, v124, v125, v126
  v_max_u32 v123, v123, v127
  v_mov_b32_dpp v120, v124 row_ror:8 row_mask:0xf bank_mask:0xf
  v_mov_b32_dpp v121, v125 row_ror:8 row_mask:0xf bank_mask:0xf
  s_waitcnt vmcnt(2)
  v_max3_u32 v123, v123, v116, v117
  v_max3_u32 v123, v123, v118, v119
  v_cmp_eq_u32 vcc, -1, v123
  s_cbranch_vccnz T_retry_196
  v_smfmac_f32_16x16x64_bf16 v[16:19], v[124:127], v[68:75], v0
  s_add_u32 s14, s14, 1
  ds_write_b128 v2, v[124:127] offset:3072
  v_mov_b32_dpp v122, v126 row_ror:8 row_mask:0xf bank_mask:0xf
  v_smfmac_f32_16x16x64_bf16 v[20:23], v[124:127], v[76:83], v0
  s_and_b32 s57, s14, 1
  v_mov_b32_dpp v123, v127 row_ror:8 row_mask:0xf bank_mask:0xf
  v_smfmac_f32_16x16x64_bf16 v[24:27], v[124:127], v[84:91], v0
  s_and_b32 s36, s14, 3
  ds_write_b128 v2, v[116:119] offset:7168
  v_smfmac_f32_16x16x64_bf16 v[16:19], v[120:123], v[92:99], v0
  s_lshl_b32 s36, s36, 13
  v_mov_b32_dpp v84, v116 row_ror:8 row_mask:0xf bank_mask:0xf
  v_smfmac_f32_16x16x64_bf16 v[20:23], v[120:123], v[100:107], v0
  s_add_u32 s26, s36, s23
  ds_read_b128 v[68:71], v4 offset:12288
  v_mov_b32_dpp v85, v117 row_ror:8 row_mask:0xf bank_mask:0xf
  v_smfmac_f32_16x16x64_bf16 v[24:27], v[120:123], v[108:115], v0
  s_add_u32 s36, s36, 8192
  ds_read_b128 v[72:75], v4 offset:13312
  v_mov_b32_dpp v86, v118 row_ror:8 row_mask:0xf bank_mask:0xf
  v_smfmac_f32_16x16x64_bf16 v[16:19], v[116:119], v[224:231], v0
  s_and_b32 s36, s36, 0x7fff
  ds_read_b128 v[76:79], v4 offset:14336
  v_mov_b32_dpp v87, v119 row_ror:8 row_mask:0xf bank_mask:0xf
  v_smfmac_f32_16x16x64_bf16 v[20:23], v[116:119], v[240:247], v0
  s_waitcnt lgkmcnt(3)
  s_barrier
  ds_read_b128 v[100:103], v2 offset:2048
  v_smfmac_f32_16x16x64_bf16 v[24:27], v[116:119], a[0:7], v0
  s_mov_b32 m0, s31
  ds_read_b128 v[120:123], v1 offset:2048
  v_smfmac_f32_16x16x64_bf16 v[16:19], v[84:87], v[232:239], v0
  s_cmp_ge_i32 s14, s30
  s_cbranch_scc1 T_kvw_199
T_kvb_200:
  v_smfmac_f32_16x16x64_bf16 v[20:23], v[84:87], v[248:255], v0
  ds_read_b128 v[80:83], v4 offset:15360
  v_smfmac_f32_16x16x64_bf16 v[24:27], v[84:87], a[8:15], v0
  s_waitcnt lgkmcnt(2)
  v_smfmac_f32_16x16x64_bf16 v[16:19], v[100:103], v[128:135], v0
  ds_read_b128 v[92:95], v2 offset:1024
  v_smfmac_f32_16x16x64_bf16 v[20:23], v[100:103], v[144:151], v0
  ds_read_b128 v[96:99], v1 offset:1024
  buffer_load_dwordx4 v9, s[4:7], s27 offen sc1 lds
  v_smfmac_f32_16x16x64_bf16 v[24:27], v[100:103], v[68:75], v0
  s_waitcnt vmcnt(1) lgkmcnt(3)
  ds_read_b128 v[116:119], v2 offset:0
  s_mov_b32 m0, s32
  v_smfmac_f32_16x16x64_bf16 v[16:19], v[120:123], v[136:143], v0
  ds_read_b128 v[124:127], v1 offset:0
  v_smfmac_f32_16x16x64_bf16 v[20:23], v[120:123], v[152:159], v0
  s_waitcnt lgkmcnt(4)
  ds_read_b128 v[104:107], v2 offset:6144
  v_smfmac_f32_16x16x64_bf16 v[24:27], v[120:123], v[76:83], v0
  s_waitcnt lgkmcnt(4)
  ds_read_b128 v[108:111], v1 offset:6144
  buffer_load_dwordx4 v9, s[4:7], s27 offen offset:128 sc1 lds
  v_smfmac_f32_16x16x64_bf16 v[16:19], v[92:95], v[160:167], v0
  s_waitcnt lgkmcnt(4)
  ds_read_b128 v[112:115], v2 offset:5120
  s_mov_b32 m0, s33
  v_smfmac_f32_16x16x64_bf16 v[16:19], v[96:99], v[168:175], v0
  s_waitcnt lgkmcnt(4)
  ds_read_b128 v[84:87], v1 offset:5120
  v_smfmac_f32_16x16x64_bf16 v[16:19], v[116:119], v[192:199], v0
  s_waitcnt lgkmcnt(4)
  ds_read_b128 v[88:91], v2 offset:4096
  v_smfmac_f32_16x16x64_bf16 v[16:19], v[124:127], v[200:207], v0
  s_waitcnt lgkmcnt(4)
  ds_read_b128 v[100:103], v1 offset:4096
  buffer_load_dwordx4 v10, s[4:7], s28 offen sc1 lds
  v_smfmac_f32_16x16x64_bf16 v[16:19], v[104:107], a[16:23], v0
  s_waitcnt lgkmcnt(4)
  ds_read_b128 v[68:71], v4 offset:16384
  s_mov_b32 m0, s34
  v_smfmac_f32_16x16x64_bf16 v[16:19], v[108:111], a[24:31], v0
  s_waitcnt lgkmcnt(4)
  ds_read_b128 v[72:75], v4 offset:17408
  v_smfmac_f32_16x16x64_bf16 v[16:19], v[112:115], a[64:71], v0
  s_waitcnt lgkmcnt(4)
  ds_read_b128 v[76:79], v4 offset:18432
  v_smfmac_f32_16x16x64_bf16 v[16:19], v[84:87], a[72:79], v0
  s_waitcnt lgkmcnt(4)
  ds_read_b128 v[80:83], v4 offset:19456
  buffer_load_dwordx4 v10, s[4:7], s28 offen offset:256 sc1 lds
  v_smfmac_f32_16x16x64_bf16 v[16:19], v[88:91], a[112:119], v0
  s_waitcnt lgkmcnt(4)
  s_mov_b32 m0, 32256
  v_smfmac_f32_16x16x64_bf16 v[16:19], v[100:103], a[120:127], v0
  s_add_u32 s24, s36, 145752064
  s_add_u32 s25, s36, 145756160
  v_smfmac_f32_16x16x64_bf16 v[20:23], v[92:95], v[176:183], v0
  s_add_u32 s35, s36, s23
  v_smfmac_f32_16x16x64_bf16 v[20:23], v[96:99], v[184:191], v0
  s_waitcnt lgkmcnt(2)
  buffer_load_dword v8, s[4:7], s99 offen sc1 lds
  v_smfmac_f32_16x16x64_bf16 v[20:23], v[116:119], v[68:75], v0
  s_waitcnt lgkmcnt(0)
  ds_read_b128 v[68:71], v4 offset:20480
  v_mul_f32 v16, s18, v16
  v_smfmac_f32_16x16x64_bf16 v[20:23], v[124:127], v[76:83], v0
  ds_read_b128 v[72:75], v4 offset:21504
  v_mul_f32 v17, s18, v17
  v_smfmac_f32_16x16x64_bf16 v[20:23], v[104:107], a[32:39], v0
  ds_read_b128 v[76:79], v4 offset:22528
  v_mul_f32 v18, s18, v18
  v_smfmac_f32_16x16x64_bf16 v[20:23], v[108:111], a[40:47], v0
  ds_read_b128 v[80:83], v4 offset:23552
  v_mul_f32 v19, s18, v19
  v_smfmac_f32_16x16x64_bf16 v[20:23], v[112:115], a[80:87], v0
  v_cvt_pk_bf16_f32 v120, v16, v17
  v_smfmac_f32_16x16x64_bf16 v[20:23], v[84:87], a[88:95], v0
  v_cvt_pk_bf16_f32 v121, v18, v19
  v_smfmac_f32_16x16x64_bf16 v[20:23], v[88:91], a[128:135], v0
  ds_write_b64 v5, v[120:121] offset:24576
  v_smfmac_f32_16x16x64_bf16 v[20:23], v[100:103], a[136:143], v0
  s_waitcnt lgkmcnt(3)
  v_smfmac_f32_16x16x64_bf16 v[24:27], v[92:95], v[68:75], v0
  s_waitcnt lgkmcnt(1)
  v_mov_b64 v[92:93], 0
  v_smfmac_f32_16x16x64_bf16 v[24:27], v[96:99], v[76:83], v0
  s_nop 1
  v_cvt_pk_bf16_f32 v122, v20, v21
  v_cvt_pk_bf16_f32 v123, v22, v23
  v_smfmac_f32_16x16x64_bf16 v[24:27], v[116:119], v[208:215], v0
  ds_write_b64 v5, v[122:123] offset:26880
  v_mov_b64 v[94:95], 0
  v_smfmac_f32_16x16x64_bf16 v[24:27], v[124:127], v[216:223], v0
  s_waitcnt lgkmcnt(1)
  s_barrier
  ds_read_b64_tr_b16 v[68:69], v6 offset:24576
  v_smfmac_f32_16x16x64_bf16 v[24:27], v[104:107], a[48:55], v0
  s_add_u32 s27, s27, 8192
  ds_read_b64_tr_b16 v[70:71], v6 offset:24640
  ds_read_b64_tr_b16 v[72:73], v6 offset:24832
  v_smfmac_f32_16x16x64_bf16 v[24:27], v[108:111], a[56:63], v0
  s_add_u32 s28, s28, 8192
  ds_read_b64_tr_b16 v[74:75], v6 offset:24896
  ds_read_b64_tr_b16 v[76:77], v6 offset:25088
  v_smfmac_f32_16x16x64_bf16 v[24:27], v[112:115], a[96:103], v0
  s_nop 0
  ds_read_b64_tr_b16 v[78:79], v6 offset:25152
  ds_read_b64_tr_b16 v[80:81], v6 offset:25344
  v_smfmac_f32_16x16x64_bf16 v[24:27], v[84:87], a[104:111], v0
  ds_read_b64_tr_b16 v[82:83], v6 offset:25408
  v_mov_b64 v[96:97], 0
  v_smfmac_f32_16x16x64_bf16 v[24:27], v[88:91], a[144:151], v0
  s_waitcnt lgkmcnt(8)
  s_barrier
  ds_read_b64_tr_b16 v[116:117], v6 offset:26880
  v_smfmac_f32_16x16x64_bf16 v[24:27], v[100:103], a[152:159], v0
  s_waitcnt lgkmcnt(7)
  ds_read_b64_tr_b16 v[118:119], v6 offset:26944
  v_mfma_f32_16x16x32_bf16 v[16:19], v[36:39], v[68:71], 0
  s_waitcnt lgkmcnt(6)
  ds_read_b64_tr_b16 v[124:125], v6 offset:27136
  ds_read_b64_tr_b16 v[126:127], v6 offset:27200
  v_mfma_f32_16x16x32_bf16 v[16:19], v[40:43], v[72:75], v[16:19]
  s_waitcnt lgkmcnt(6)
  ds_read_b64_tr_b16 v[104:105], v6 offset:27392
  ds_read_b64_tr_b16 v[106:107], v6 offset:27456
  v_mfma_f32_16x16x32_bf16 v[16:19], v[44:47], v[76:79], v[16:19]
  s_waitcnt lgkmcnt(6)
  ds_read_b64_tr_b16 v[108:109], v6 offset:27648
  ds_read_b64_tr_b16 v[110:111], v6 offset:27712
  v_mfma_f32_16x16x32_bf16 v[16:19], v[48:51], v[80:83], v[16:19]
  s_waitcnt lgkmcnt(6)
  v_cvt_pk_bf16_f32 v120, v24, v25
  v_cvt_pk_bf16_f32 v121, v26, v27
  v_mfma_f32_16x16x32_bf16 v[112:115], v[116:119], v[68:71], 0
  s_waitcnt lgkmcnt(4)
  buffer_store_dwordx4 v[120:123], v2, s[4:7], s29 offen offset:3072 sc1
  v_mov_b64 v[98:99], 0
  v_mfma_f32_16x16x32_bf16 v[112:115], v[124:127], v[72:75], v[112:115]
  s_waitcnt lgkmcnt(2)
  v_mov_b64 v[36:37], 0
  v_exp_f32 v100, v16
  v_mfma_f32_16x16x32_bf16 v[112:115], v[104:107], v[76:79], v[112:115]
  s_waitcnt lgkmcnt(0)
  v_exp_f32 v101, v17
  v_mfma_f32_16x16x32_bf16 v[112:115], v[108:111], v[80:83], v[112:115]
  s_add_u32 s29, s29, 131072
  v_exp_f32 v102, v18
  v_mfma_f32_16x16x32_bf16 v[20:23], v[52:55], v[68:71], 0
  s_cmp_eq_u32 s14, 63
  v_exp_f32 v103, v19
  v_mfma_f32_16x16x32_bf16 v[20:23], v[56:59], v[72:75], v[20:23]
  s_cbranch_scc1 M_tdone
  v_cvt_pk_bf16_f32 v44, v100, v101
  v_cvt_pk_bf16_f32 v45, v102, v103
  v_mfma_f32_16x16x32_bf16 v[20:23], v[60:63], v[76:79], v[20:23]
  v_exp_f32 v100, v112
  v_mfma_f32_16x16x32_bf16 v[20:23], v[64:67], v[80:83], v[20:23]
  v_exp_f32 v101, v113
  v_exp_f32 v102, v114
  v_exp_f32 v103, v115
  v_cvt_pk_bf16_f32 v84, v100, v101
  v_cvt_pk_bf16_f32 v85, v102, v103
  v_cndmask_b32 v48, v84, 0, s[16:17]
  v_cndmask_b32 v49, v85, 0, s[16:17]
  v_cndmask_b32 v50, 0, v84, s[16:17]
  v_cndmask_b32 v51, 0, v85, s[16:17]
  v_exp_f32 v100, v20
  v_mfma_f32_16x16x16_bf16 v[88:91], v[12:13], v[48:49], 0
  v_exp_f32 v101, v21
  v_mfma_f32_16x16x16_bf16 v[24:27], v[120:121], v[48:49], 0
  v_exp_f32 v102, v22
  v_mfma_f32_16x16x16_bf16 v[116:119], v[120:121], v[50:51], 0
  v_exp_f32 v103, v23
  v_cvt_pk_bf16_f32 v46, v100, v101
  v_cvt_pk_bf16_f32 v47, v102, v103
  v_mov_b64 v[38:39], 0
  s_nop 0
  v_mfma_f32_16x16x32_bf16 v[88:91], v[12:15], v[44:47], v[88:91]
  v_mov_b64 v[40:41], 0
  v_mov_b64 v[42:43], 0
  v_mfma_f32_16x16x32_bf16 v[24:27], v[28:31], v[44:47], v[24:27]
  ds_read_b128 v[52:55], v4 offset:24576
  ds_read_b128 v[56:59], v4 offset:25600
  v_mfma_f32_16x16x32_bf16 v[116:119], v[32:35], v[44:47], v[116:119]
  s_nop 1
  v_rcp_f32 v89, v88
  v_subrev_u32 v100, s54, v88
  v_cmp_le_u32 vcc, s55, v100
  v_mul_f32 v24, v89, v24
  v_mul_f32 v25, v89, v25
  s_cbranch_vccnz T_slow_202
T_back_203:
  v_cvt_pk_bf16_f32 v124, v24, v25
  v_pk_mul_f32 v[26:27], v[26:27], v[88:89] op_sel:[0,1] op_sel_hi:[1,1]
  v_pk_mul_f32 v[116:117], v[116:117], v[88:89] op_sel:[0,1] op_sel_hi:[1,1]
  v_pk_mul_f32 v[118:119], v[118:119], v[88:89] op_sel:[0,1] op_sel_hi:[1,1]
  v_cvt_pk_bf16_f32 v125, v26, v27
  v_cvt_pk_bf16_f32 v126, v116, v117
  v_cvt_pk_bf16_f32 v127, v118, v119
  ds_write_b128 v11, v[124:127] offset:30720
  s_nop 0
  v_smfmac_f32_16x16x64_bf16 v[92:95], v[124:127], a[160:167], v0
  v_smfmac_f32_16x16x64_bf16 v[96:99], v[124:127], a[168:175], v0
  v_smfmac_f32_16x16x64_bf16 v[36:39], v[124:127], a[176:183], v0
  v_smfmac_f32_16x16x64_bf16 v[40:43], v[124:127], a[184:191], v0
  s_waitcnt lgkmcnt(0)
  s_barrier
  ds_read_b128 v[104:107], v11 offset:30208
  ds_read_b128 v[108:111], v11 offset:29696
  ds_read_b128 v[68:71], v11 offset:29184
  s_waitcnt lgkmcnt(2)
  v_smfmac_f32_16x16x64_bf16 v[92:95], v[104:107], a[192:199], v0
  s_waitcnt lgkmcnt(1)
  ds_read_b128 v[76:79], v4 offset:28672
  v_smfmac_f32_16x16x64_bf16 v[92:95], v[108:111], a[224:231], v0
  s_waitcnt lgkmcnt(1)
  ds_read_b128 v[80:83], v4 offset:29696
  v_smfmac_f32_16x16x64_bf16 v[92:95], v[68:71], a[240:247], v0
  ds_read_b128 v[60:63], v4 offset:26624
  v_smfmac_f32_16x16x64_bf16 v[96:99], v[104:107], a[200:207], v0
  ds_read_b128 v[64:67], v4 offset:27648
  v_smfmac_f32_16x16x64_bf16 v[96:99], v[108:111], a[232:239], v0
  ds_read_b128 v[28:31], v4 offset:30720
  s_nop 0
  v_cvt_pk_bf16_f32 v16, v92, v93
  v_cvt_pk_bf16_f32 v17, v94, v95
  v_bfi_b32 v16, 1, s57, v16
  v_smfmac_f32_16x16x64_bf16 v[96:99], v[68:71], a[248:255], v0
  buffer_store_dwordx2 v[16:17], v7, s[4:7], s20 offen offset:0 sc1
  v_smfmac_f32_16x16x64_bf16 v[36:39], v[104:107], a[208:215], v0
  ds_read_b128 v[32:35], v4 offset:31744
  v_smfmac_f32_16x16x64_bf16 v[36:39], v[108:111], v[52:59], v0
  s_waitcnt lgkmcnt(4)
  s_nop 0
  v_cvt_pk_bf16_f32 v18, v96, v97
  v_cvt_pk_bf16_f32 v19, v98, v99
  v_bfi_b32 v18, 1, s57, v18
  v_smfmac_f32_16x16x64_bf16 v[36:39], v[68:71], v[76:83], v0
  buffer_store_dwordx2 v[18:19], v7, s[4:7], s20 offen offset:64 sc1
  v_smfmac_f32_16x16x64_bf16 v[40:43], v[104:107], a[216:223], v0
  s_waitcnt lgkmcnt(2)
  v_smfmac_f32_16x16x64_bf16 v[40:43], v[108:111], v[60:67], v0
  s_waitcnt lgkmcnt(0)
  s_nop 0
  v_cvt_pk_bf16_f32 v20, v36, v37
  v_cvt_pk_bf16_f32 v21, v38, v39
  v_bfi_b32 v20, 1, s57, v20
  v_smfmac_f32_16x16x64_bf16 v[40:43], v[68:71], v[28:35], v0
  buffer_store_dwordx2 v[20:21], v7, s[4:7], s21 offen offset:0 sc1
  s_nop 6
  v_cvt_pk_bf16_f32 v22, v40, v41
  v_cvt_pk_bf16_f32 v23, v42, v43
  v_bfi_b32 v22, 1, s57, v22
  buffer_store_dwordx2 v[22:23], v7, s[4:7], s21 offen offset:64 sc1
  ds_read_b128 v[68:71], v4 offset:0
  ds_read_b128 v[72:75], v4 offset:1024
  ds_read_b128 v[76:79], v4 offset:4096
  ds_read_b128 v[80:83], v4 offset:5120
  ds_read_b128 v[84:87], v4 offset:8192
  ds_read_b128 v[88:91], v4 offset:9216
  ds_read_b128 v[92:95], v4 offset:2048
  ds_read_b128 v[96:99], v4 offset:3072
  ds_read_b128 v[100:103], v4 offset:6144
  ds_read_b128 v[104:107], v4 offset:7168
  ds_read_b128 v[108:111], v4 offset:10240
  ds_read_b128 v[112:115], v4 offset:11264
  v_mov_b64 v[16:17], 0
  v_mov_b64 v[18:19], 0
  v_mov_b64 v[20:21], 0
  v_mov_b64 v[22:23], 0
  v_mov_b64 v[24:25], 0
  v_mov_b64 v[26:27], 0
  ds_read_b64 v[44:45], v2 offset:32256
  s_waitcnt lgkmcnt(0)
  v_readfirstlane_b32 s38, v44
  v_readfirstlane_b32 s37, v45
  s_nop 0
  s_add_u32 s37, s37, 30
  s_cmp_ge_u32 s38, 30
  s_cselect_b32 s38, s37, s38
  s_cmp_ge_u32 s38, 64
  s_cselect_b32 s38, 100, s38
  s_sub_u32 s38, s38, 1
  s_max_i32 s30, s30, s38
  s_waitcnt vmcnt(4)
  s_barrier
  ds_read_b128 v[28:31], v2 offset:19456
  ds_read_b128 v[32:35], v2 offset:23552
  ds_read_b128 v[36:39], v2 offset:8192
  ds_read_b128 v[40:43], v2 offset:9216
  ds_read_b128 v[44:47], v2 offset:10240
  ds_read_b128 v[48:51], v2 offset:11264
  buffer_load_dwordx4 v[124:127], v3, s[4:7], s24 offen offset:3072 sc1
  buffer_load_dwordx4 v[116:119], v3, s[4:7], s25 offen offset:3072 sc1
  ds_read_b128 v[52:55], v2 offset:12288
  ds_read_b128 v[56:59], v2 offset:13312
  ds_read_b128 v[60:63], v2 offset:14336
  ds_read_b128 v[64:67], v2 offset:15360
  buffer_load_dwordx4 v[124:127], v3, s[4:7], s24 offen offset:3072 sc1
  buffer_load_dwordx4 v[116:119], v3, s[4:7], s25 offen offset:3072 sc1
  s_mov_b32 s19, 0
  s_branch T_loop_195
T_kvw_199:
  s_mov_b32 s19, 0
  s_branch T_kvok_208
T_kv_207:
  s_sleep 4
  s_add_u32 s19, s19, 1
  s_cmp_gt_u32 s19, 32768
  s_cbranch_scc1 M_exit
T_kvok_208:
  s_add_u32 s39, s99, 128
  s_mov_b32 s38, 0
  s_mov_b32 s37, 0
  s_atomic_or s38, s[58:59], s99 glc
  s_atomic_or s37, s[58:59], s39 glc
  s_waitcnt lgkmcnt(0)
  s_add_u32 s37, s37, 30
  s_cmp_ge_u32 s38, 30
  s_cselect_b32 s38, s37, s38
  s_cmp_ge_u32 s38, 64
  s_cselect_b32 s38, 100, s38
  s_sub_u32 s38, s38, 1
  s_max_i32 s30, s30, s38
  s_cmp_ge_i32 s14, s30
  s_cbranch_scc1 T_kv_207
  s_branch T_kvb_200
T_slow_202:
  s_nop 7
  v_max3_f32 v100, v16, v17, v18
  v_max3_f32 v100, v100, v19, v20
  v_max3_f32 v100, v100, v21, v22
  v_max3_f32 v100, v100, v23, v112
  v_max3_f32 v100, v100, v113, v114
  v_max_f32 v100, v100, v115
  v_mov_b32 v101, v100
  s_nop 1
  v_permlane32_swap_b32 v100, v101
  s_nop 1
  v_max_f32 v100, v100, v101
  v_mov_b32 v101, v100
  s_nop 1
  v_permlane16_swap_b32 v100, v101
  s_nop 1
  v_max_f32 v100, v100, v101
  v_sub_f32 v16, v16, v100
  v_sub_f32 v17, v17, v100
  v_sub_f32 v18, v18, v100
  v_sub_f32 v19, v19, v100
  v_exp_f32 v16, v16
  v_exp_f32 v17, v17
  v_exp_f32 v18, v18
  v_exp_f32 v19, v19
  v_sub_f32 v20, v20, v100
  v_sub_f32 v21, v21, v100
  v_sub_f32 v22, v22, v100
  v_sub_f32 v23, v23, v100
  v_exp_f32 v20, v20
  v_exp_f32 v21, v21
  v_exp_f32 v22, v22
  v_exp_f32 v23, v23
  v_sub_f32 v112, v112, v100
  v_sub_f32 v113, v113, v100
  v_sub_f32 v114, v114, v100
  v_sub_f32 v115, v115, v100
  v_exp_f32 v112, v112
  v_exp_f32 v113, v113
  v_exp_f32 v114, v114
  v_exp_f32 v115, v115
  s_nop 0
  v_cvt_pk_bf16_f32 v44, v16, v17
  v_cvt_pk_bf16_f32 v45, v18, v19
  v_cvt_pk_bf16_f32 v46, v20, v21
  v_cvt_pk_bf16_f32 v47, v22, v23
  v_cvt_pk_bf16_f32 v84, v112, v113
  v_cvt_pk_bf16_f32 v85, v114, v115
  v_cndmask_b32 v48, v84, 0, s[16:17]
  v_cndmask_b32 v49, v85, 0, s[16:17]
  v_cndmask_b32 v50, 0, v84, s[16:17]
  v_cndmask_b32 v51, 0, v85, s[16:17]
  s_nop 1
  v_mfma_f32_16x16x16_bf16 v[88:91], v[12:13], v[48:49], 0
  v_mfma_f32_16x16x16_bf16 v[24:27], v[120:121], v[48:49], 0
  v_mfma_f32_16x16x16_bf16 v[116:119], v[120:121], v[50:51], 0
  v_mfma_f32_16x16x32_bf16 v[88:91], v[12:15], v[44:47], v[88:91]
  v_mfma_f32_16x16x32_bf16 v[24:27], v[28:31], v[44:47], v[24:27]
  v_mfma_f32_16x16x32_bf16 v[116:119], v[32:35], v[44:47], v[116:119]
  s_nop 7
  s_nop 1
  v_rcp_f32 v89, v88
  s_nop 0
  v_mul_f32 v24, v89, v24
  v_mul_f32 v25, v89, v25
  s_branch T_back_203
M_tdone:
  v_mov_b32 v16, 64
  v_or_b32 v17, s13, v2
  v_min_u32 v17, 1, v17
  v_lshlrev_b32 v17, 30, v17
  s_waitcnt vmcnt(0)
  s_barrier
  buffer_store_dword v16, v17, s[4:7], s15 offen sc1
M_done:
M_exit:
  s_endpgm
.p2align 6
.type M_table,@object
M_table:
.long 0x1, 0x3f, 0xffffffff, 0x17, 0x1, 0x7, 0x800, 0x0, 0x8, 0x0, 0x0, 0x0, 0x0, 0x0, 0x0, 0x0
.long 0x1, 0x28, 0xffffffff, 0x1b, 0x1, 0x6, 0x1000, 0x0, 0x8, 0x1, 0x0, 0x0, 0x0, 0x0, 0x0, 0x0
.long 0x2, 0x0, 0x1, 0x1e, 0x1, 0x5, 0x1800, 0x0, 0x8, 0x0, 0x0, 0x0, 0x0, 0x0, 0x0, 0x0
.long 0x2, 0x1e, 0x1, 0x22, 0x1, 0x4, 0x2000, 0x0, 0x8, 0x1, 0x0, 0x0, 0x0, 0x0, 0x0, 0x0
.long 0x0, 0x0, 0x1, 0x20, 0x2, 0x3, 0x20, 0x0, 0x8, 0x2, 0x0, 0x0, 0x0, 0x0, 0x0, 0x0
.long 0x0, 0x3f, 0xffffffff, 0x20, 0x2, 0x2, 0x18, 0x1, 0x10, 0x0, 0x0, 0x0, 0x0, 0x0, 0x0, 0x0
.long 0x1, 0xd, 0xffffffff, 0xe, 0x0, 0x0, 0x8, 0x0, 0x8, 0x2, 0x0, 0x0, 0x0, 0x0, 0x0, 0x0
.size M_table, 448
.section .rodata,"a"
.p2align 6
.amdhsa_kernel gated_mix__compressed_kv_cla__memory_aug_recurrent_mem_tr__prompt_kernel
.amdhsa_next_free_vgpr 512
.amdhsa_next_free_sgpr 102
.amdhsa_accum_offset 256
.amdhsa_group_segment_fixed_size 0
.amdhsa_kernarg_size 136
.amdhsa_user_sgpr_count 2
.amdhsa_user_sgpr_kernarg_segment_ptr 1
.amdhsa_system_sgpr_workgroup_id_x 1
.end_amdhsa_kernel
```

```asm
; @launch grid=(256,1,1) block=(256,1,1) lds=163840
.amdgcn_target "amdgcn-amd-amdhsa--gfx950"
.text
.globl gated_mix__compressed_kv_cla__memory_aug_recurrent_mem_tr__prompt_kernel
.p2align 8
.type gated_mix__compressed_kv_cla__memory_aug_recurrent_mem_tr__prompt_kernel,@function
gated_mix__compressed_kv_cla__memory_aug_recurrent_mem_tr__prompt_kernel:
  s_cmp_ge_u32 s2, 256
  s_cbranch_scc1 M_exit
  s_lshr_b32 s77, s2, 3
  s_and_b32 s76, s2, 7
  s_cbranch_scc0 M_team
  s_load_dwordx4 s[72:75], s[0:1], 120
  v_lshrrev_b32 v3, 6, v0
  v_and_b32 v1, 63, v0
  v_readfirstlane_b32 s16, v3
  v_lshlrev_b32 v2, 4, v1
  s_waitcnt lgkmcnt(0)
  s_mov_b64 s[4:5], s[74:75]
  s_mov_b64 s[74:75], s[72:73]
  s_mov_b64 s[72:73], s[4:5]
  s_and_b32 s5, s5, 0xffff
  s_mov_b32 s6, 268435456
  s_mov_b32 s7, 0x20000
  s_sub_u32 s66, s76, 1
  s_lshl_b32 s66, s66, 5
  s_add_u32 s66, s66, s77
  s_mul_i32 s64, s66, 9363
  s_lshr_b32 s64, s64, 16
  s_mul_i32 s67, s64, 7
  s_sub_u32 s65, s66, s67
  s_lshl_b32 s31, s66, 7
  s_add_u32 s31, s31, 148897792
  s_lshl_b32 s67, s67, 7
  s_add_u32 s67, s67, 148897792
  s_getpc_b64 s[76:77]
M_pc:
  s_add_u32 s76, s76, M_table-M_pc
  s_addc_u32 s77, s77, 0
  s_lshl_b32 s26, s65, 6
  s_load_dwordx16 s[48:63], s[76:77], s26
  s_waitcnt lgkmcnt(0)
  s_mov_b32 s23, s51
  s_cmp_lg_u32 s48, 1
  s_cbranch_scc1 M_nobpf
  s_load_dwordx8 s[36:43], s[0:1], 64
  s_mul_i32 s76, s64, 3
  s_add_u32 s76, s76, s57
  v_lshlrev_b32 v4, 7, v0
  s_mov_b32 s10, 4194304
  s_mov_b32 s11, 0x20000
  s_waitcnt lgkmcnt(0)
  s_mov_b32 s8, s42
  s_and_b32 s9, s43, 0xffff
  s_mul_i32 s77, s76, 43776
  s_add_u32 s77, s77, 0
  v_min_u32 v5, 32640, v4
  v_add_u32 v5, s77, v5
  s_add_u32 s77, s77, 32768
  buffer_load_dword v6, v5, s[8:11], 0 offen
  v_min_u32 v5, 10880, v4
  v_add_u32 v5, s77, v5
  s_add_u32 s77, s77, 32768
  buffer_load_dword v6, v5, s[8:11], 0 offen
  s_mov_b32 s8, s38
  s_and_b32 s9, s39, 0xffff
  s_mul_i32 s77, s76, 21888
  s_add_u32 s77, s77, 2097152
  v_min_u32 v5, 21760, v4
  v_add_u32 v5, s77, v5
  s_add_u32 s77, s77, 32768
  buffer_load_dword v6, v5, s[8:11], 0 offen
  s_mov_b32 s8, s40
  s_and_b32 s9, s41, 0xffff
  s_mul_i32 s77, s76, 21888
  s_add_u32 s77, s77, 2097152
  v_min_u32 v5, 21760, v4
  v_add_u32 v5, s77, v5
  s_add_u32 s77, s77, 32768
  buffer_load_dword v6, v5, s[8:11], 0 offen
  s_mov_b32 s8, s36
  s_and_b32 s9, s37, 0xffff
  s_mul_i32 s77, s76, 21888
  s_add_u32 s77, s77, 2097152
  v_min_u32 v5, 21760, v4
  v_add_u32 v5, s77, v5
  s_add_u32 s77, s77, 32768
  buffer_load_dword v6, v5, s[8:11], 0 offen
  s_waitcnt vmcnt(0)
M_nobpf:
  s_lshr_b32 s29, s16, 1
  s_cmp_eq_u32 s29, 0
  s_cselect_b32 s26, 2, 8
  s_cselect_b32 s27, 3, 4
  s_cselect_b32 s28, 9, 10
  s_cmp_eq_u32 s48, 1
  s_cselect_b32 s26, s27, s26
  s_cmp_eq_u32 s48, 2
  s_cselect_b32 s26, s28, s26
  s_lshl_b32 s26, s26, 3
  s_load_dwordx2 s[8:9], s[0:1], s26
  s_cmp_eq_u32 s48, 1
  s_cselect_b32 s26, 8, 0
  s_load_dwordx2 s[12:13], s[0:1], s26
  s_cmp_eq_u32 s29, 0
  s_cselect_b32 s21, 0, 3
  s_cselect_b32 s27, 1, 2
  s_cselect_b32 s28, 4, 5
  s_cmp_eq_u32 s48, 1
  s_cselect_b32 s21, s27, s21
  s_cmp_eq_u32 s48, 2
  s_cselect_b32 s21, s28, s21
  s_lshl_b32 s21, s21, 5
  s_add_u32 s21, s21, s64
  s_lshl_b32 s21, s21, 6
  s_add_u32 s21, s21, s49
  s_and_b32 s27, s16, 1
  s_lshl_b32 s21, s21, 1
  s_add_u32 s21, s21, s27
  s_lshl_b32 s21, s21, 12
  s_lshl_b32 s22, s50, 13
  s_lshl_b32 s19, s49, 15
  s_lshl_b32 s20, s50, 15
  s_lshl_b32 s17, s64, 1
  s_add_u32 s17, s17, s27
  s_lshl_b32 s17, s17, 7
  s_mov_b32 s18, 8192
  s_mov_b32 s24, 0x3e0293ee
  s_waitcnt lgkmcnt(0)
  s_and_b32 s9, s9, 0xffff
  s_mov_b32 s10, 4194304
  s_mov_b32 s11, 0x20000
  s_and_b32 s13, s13, 0xffff
  s_mov_b32 s14, 2097152
  s_mov_b32 s15, 0x20000
  s_cmp_eq_u32 s48, 0
  s_cselect_b32 s32, 0, s16
  s_lshr_b32 s32, s32, 1
  v_lshrrev_b32 v144, 4, v1
  v_and_b32 v56, 0xff, v2
  v_lshl_add_u32 v56, v144, 9, v56
  v_and_b32 v146, 15, v1
  v_and_b32 v144, 8, v1
  v_add_u32 v144, v144, v146
  s_cmp_lg_u32 s32, 0
  s_cselect_b64 vcc, -1, 0
  s_cselect_b32 s26, 8, 16
  v_cndmask_b32 v144, v146, v144, vcc
  v_lshrrev_b32 v145, 4, v1
  v_add_u32 v148, s26, v144
  v_xor_b32 v147, 0, v145
  v_xor_b32 v147, v147, v146
  v_lshlrev_b32 v147, 4, v147
  v_lshl_add_u32 v8, v144, 8, v147
  v_xor_b32 v147, 8, v145
  v_xor_b32 v147, v147, v146
  v_lshlrev_b32 v147, 4, v147
  v_lshl_add_u32 v9, v148, 8, v147
  v_xor_b32 v147, 4, v145
  v_xor_b32 v147, v147, v146
  v_lshlrev_b32 v147, 4, v147
  v_lshl_add_u32 v10, v144, 8, v147
  v_xor_b32 v147, 12, v145
  v_xor_b32 v147, v147, v146
  v_lshlrev_b32 v147, 4, v147
  v_lshl_add_u32 v11, v148, 8, v147
  v_xor_b32 v147, 8, v145
  v_xor_b32 v147, v147, v146
  v_lshlrev_b32 v147, 4, v147
  v_lshl_add_u32 v12, v144, 8, v147
  v_xor_b32 v147, 0, v145
  v_xor_b32 v147, v147, v146
  v_lshlrev_b32 v147, 4, v147
  v_lshl_add_u32 v13, v148, 8, v147
  v_xor_b32 v147, 12, v145
  v_xor_b32 v147, v147, v146
  v_lshlrev_b32 v147, 4, v147
  v_lshl_add_u32 v14, v144, 8, v147
  v_xor_b32 v147, 4, v145
  v_xor_b32 v147, v147, v146
  v_lshlrev_b32 v147, 4, v147
  v_lshl_add_u32 v15, v148, 8, v147
  v_lshrrev_b32 v144, 4, v1
  s_lshl_b32 s26, s16, 8
  v_add_u32 v145, 0, v144
  v_or_b32 v147, 0, v144
  v_xor_b32 v147, v147, v146
  v_lshlrev_b32 v147, 4, v147
  v_lshl_add_u32 v147, v145, 10, v147
  v_add_u32 v16, s26, v147
  v_add_u32 v145, 4, v144
  v_or_b32 v147, 4, v144
  v_xor_b32 v147, v147, v146
  v_lshlrev_b32 v147, 4, v147
  v_lshl_add_u32 v147, v145, 10, v147
  v_add_u32 v17, s26, v147
  v_add_u32 v145, 8, v144
  v_or_b32 v147, 8, v144
  v_xor_b32 v147, v147, v146
  v_lshlrev_b32 v147, 4, v147
  v_lshl_add_u32 v147, v145, 10, v147
  v_add_u32 v18, s26, v147
  v_add_u32 v145, 12, v144
  v_or_b32 v147, 12, v144
  v_xor_b32 v147, v147, v146
  v_lshlrev_b32 v147, 4, v147
  v_lshl_add_u32 v147, v145, 10, v147
  v_add_u32 v19, s26, v147
  v_add_u32 v145, 16, v144
  v_or_b32 v147, 8, v144
  v_xor_b32 v147, v147, v146
  v_lshlrev_b32 v147, 4, v147
  v_lshl_add_u32 v147, v145, 10, v147
  v_add_u32 v20, s26, v147
  v_add_u32 v145, 20, v144
  v_or_b32 v147, 12, v144
  v_xor_b32 v147, v147, v146
  v_lshlrev_b32 v147, 4, v147
  v_lshl_add_u32 v147, v145, 10, v147
  v_add_u32 v21, s26, v147
  v_add_u32 v145, 24, v144
  v_or_b32 v147, 0, v144
  v_xor_b32 v147, v147, v146
  v_lshlrev_b32 v147, 4, v147
  v_lshl_add_u32 v147, v145, 10, v147
  v_add_u32 v22, s26, v147
  v_add_u32 v145, 28, v144
  v_or_b32 v147, 4, v144
  v_xor_b32 v147, v147, v146
  v_lshlrev_b32 v147, 4, v147
  v_lshl_add_u32 v147, v145, 10, v147
  v_add_u32 v23, s26, v147
  v_lshrrev_b32 v144, 3, v1
  v_mul_lo_u32 v144, v144, s18
  v_and_b32 v145, 7, v1
  v_lshl_add_u32 v144, v145, 4, v144
  s_lshl_b32 s28, s16, 15
  s_add_u32 s28, s28, 32768
  s_lshl_b32 s29, s18, 3
  s_add_u32 m0, s28, 0
  s_nop 0
  buffer_load_dwordx4 v144, s[8:11], s17 offen lds
  s_add_u32 s17, s17, s29
  s_add_u32 m0, s28, 1024
  s_nop 0
  buffer_load_dwordx4 v144, s[8:11], s17 offen lds
  s_add_u32 s17, s17, s29
  s_add_u32 m0, s28, 2048
  s_nop 0
  buffer_load_dwordx4 v144, s[8:11], s17 offen lds
  s_add_u32 s17, s17, s29
  s_add_u32 m0, s28, 3072
  s_nop 0
  buffer_load_dwordx4 v144, s[8:11], s17 offen lds
  s_add_u32 s17, s17, s29
  s_add_u32 m0, s28, 4096
  s_nop 0
  buffer_load_dwordx4 v144, s[8:11], s17 offen lds
  s_add_u32 s17, s17, s29
  s_add_u32 m0, s28, 5120
  s_nop 0
  buffer_load_dwordx4 v144, s[8:11], s17 offen lds
  s_add_u32 s17, s17, s29
  s_add_u32 m0, s28, 6144
  s_nop 0
  buffer_load_dwordx4 v144, s[8:11], s17 offen lds
  s_add_u32 s17, s17, s29
  s_add_u32 m0, s28, 7168
  s_nop 0
  buffer_load_dwordx4 v144, s[8:11], s17 offen lds
  s_add_u32 s17, s17, s29
  s_add_u32 m0, s28, 8192
  s_nop 0
  buffer_load_dwordx4 v144, s[8:11], s17 offen lds
  s_add_u32 s17, s17, s29
  s_add_u32 m0, s28, 9216
  s_nop 0
  buffer_load_dwordx4 v144, s[8:11], s17 offen lds
  s_add_u32 s17, s17, s29
  s_add_u32 m0, s28, 10240
  s_nop 0
  buffer_load_dwordx4 v144, s[8:11], s17 offen lds
  s_add_u32 s17, s17, s29
  s_add_u32 m0, s28, 11264
  s_nop 0
  buffer_load_dwordx4 v144, s[8:11], s17 offen lds
  s_add_u32 s17, s17, s29
  s_add_u32 m0, s28, 12288
  s_nop 0
  buffer_load_dwordx4 v144, s[8:11], s17 offen lds
  s_add_u32 s17, s17, s29
  s_add_u32 m0, s28, 13312
  s_nop 0
  buffer_load_dwordx4 v144, s[8:11], s17 offen lds
  s_add_u32 s17, s17, s29
  s_add_u32 m0, s28, 14336
  s_nop 0
  buffer_load_dwordx4 v144, s[8:11], s17 offen lds
  s_add_u32 s17, s17, s29
  s_add_u32 m0, s28, 15360
  s_nop 0
  buffer_load_dwordx4 v144, s[8:11], s17 offen lds
  s_add_u32 s17, s17, s29
  s_add_u32 m0, s28, 16384
  s_nop 0
  buffer_load_dwordx4 v144, s[8:11], s17 offen lds
  s_add_u32 s17, s17, s29
  s_add_u32 m0, s28, 17408
  s_nop 0
  buffer_load_dwordx4 v144, s[8:11], s17 offen lds
  s_add_u32 s17, s17, s29
  s_add_u32 m0, s28, 18432
  s_nop 0
  buffer_load_dwordx4 v144, s[8:11], s17 offen lds
  s_add_u32 s17, s17, s29
  s_add_u32 m0, s28, 19456
  s_nop 0
  buffer_load_dwordx4 v144, s[8:11], s17 offen lds
  s_add_u32 s17, s17, s29
  s_add_u32 m0, s28, 20480
  s_nop 0
  buffer_load_dwordx4 v144, s[8:11], s17 offen lds
  s_add_u32 s17, s17, s29
  s_add_u32 m0, s28, 21504
  s_nop 0
  buffer_load_dwordx4 v144, s[8:11], s17 offen lds
  s_add_u32 s17, s17, s29
  s_add_u32 m0, s28, 22528
  s_nop 0
  buffer_load_dwordx4 v144, s[8:11], s17 offen lds
  s_add_u32 s17, s17, s29
  s_add_u32 m0, s28, 23552
  s_nop 0
  buffer_load_dwordx4 v144, s[8:11], s17 offen lds
  s_add_u32 s17, s17, s29
  s_add_u32 m0, s28, 24576
  s_nop 0
  buffer_load_dwordx4 v144, s[8:11], s17 offen lds
  s_add_u32 s17, s17, s29
  s_add_u32 m0, s28, 25600
  s_nop 0
  buffer_load_dwordx4 v144, s[8:11], s17 offen lds
  s_add_u32 s17, s17, s29
  s_add_u32 m0, s28, 26624
  s_nop 0
  buffer_load_dwordx4 v144, s[8:11], s17 offen lds
  s_add_u32 s17, s17, s29
  s_add_u32 m0, s28, 27648
  s_nop 0
  buffer_load_dwordx4 v144, s[8:11], s17 offen lds
  s_add_u32 s17, s17, s29
  s_add_u32 m0, s28, 28672
  s_nop 0
  buffer_load_dwordx4 v144, s[8:11], s17 offen lds
  s_add_u32 s17, s17, s29
  s_add_u32 m0, s28, 29696
  s_nop 0
  buffer_load_dwordx4 v144, s[8:11], s17 offen lds
  s_add_u32 s17, s17, s29
  s_add_u32 m0, s28, 30720
  s_nop 0
  buffer_load_dwordx4 v144, s[8:11], s17 offen lds
  s_add_u32 s17, s17, s29
  s_add_u32 m0, s28, 31744
  s_nop 0
  buffer_load_dwordx4 v144, s[8:11], s17 offen lds
  s_add_u32 s17, s17, s29
  s_lshl_b32 s25, s16, 13
  s_add_u32 m0, s25, 0
  s_nop 0
  buffer_load_dwordx4 v16, s[12:15], s19 offen lds
  s_add_u32 m0, s25, 1024
  s_nop 0
  buffer_load_dwordx4 v17, s[12:15], s19 offen lds
  s_add_u32 m0, s25, 2048
  s_nop 0
  buffer_load_dwordx4 v18, s[12:15], s19 offen lds
  s_add_u32 m0, s25, 3072
  s_nop 0
  buffer_load_dwordx4 v19, s[12:15], s19 offen lds
  s_add_u32 m0, s25, 4096
  s_nop 0
  buffer_load_dwordx4 v20, s[12:15], s19 offen lds
  s_add_u32 m0, s25, 5120
  s_nop 0
  buffer_load_dwordx4 v21, s[12:15], s19 offen lds
  s_add_u32 m0, s25, 6144
  s_nop 0
  buffer_load_dwordx4 v22, s[12:15], s19 offen lds
  s_add_u32 m0, s25, 7168
  s_nop 0
  buffer_load_dwordx4 v23, s[12:15], s19 offen lds
  s_cmp_gt_u32 s23, 1
  s_cselect_b32 s26, s20, 0
  s_add_u32 s19, s19, s26
  s_add_u32 s25, s25, 32768
  s_and_b32 s25, s25, 0x1ffff
  s_cmp_lg_u32 s16, 3
  s_cbranch_scc1 M_noinit
  s_mov_b32 s79, 0
  s_atomic_swap s79, s[72:73], s31 glc
  s_waitcnt lgkmcnt(0)
  s_mov_b32 s79, 1
  s_atomic_add s79, s[74:75], 128
M_noinit:
  s_cmp_lg_u32 s65, 3
  s_cbranch_scc1 M_noarm
  v_lshlrev_b32 v4, 4, v0
  v_mov_b64 v[60:61], -1
  v_mov_b64 v[62:63], -1
  s_mul_i32 s76, s64, 4096
  s_add_u32 s77, s76, 142868480
  buffer_store_dwordx4 v[60:63], v4, s[4:7], s77 offen sc1
  s_add_u32 s77, s76, 142999552
  buffer_store_dwordx4 v[60:63], v4, s[4:7], s77 offen sc1
  s_add_u32 s77, s76, 143130624
  buffer_store_dwordx4 v[60:63], v4, s[4:7], s77 offen sc1
  s_add_u32 s77, s76, 143261696
  buffer_store_dwordx4 v[60:63], v4, s[4:7], s77 offen sc1
  s_add_u32 s77, s76, 143392768
  buffer_store_dwordx4 v[60:63], v4, s[4:7], s77 offen sc1
  s_add_u32 s77, s76, 143523840
  buffer_store_dwordx4 v[60:63], v4, s[4:7], s77 offen sc1
M_noarm:
  s_mul_i32 s76, s64, 3
  s_add_u32 s76, s76, s57
  s_mul_i32 s76, s76, 24576
  v_lshlrev_b32 v4, 7, v0
  v_add_u32 v4, s76, v4
  buffer_load_dword v5, v4, s[12:15], 0 offen
  v_bfe_u32 v148, v1, 2, 2
  v_lshrrev_b32 v149, 5, v1
  v_lshl_add_u32 v148, v149, 4, v148
  v_bfe_u32 v149, v1, 4, 1
  v_lshl_add_u32 v148, v149, 3, v148
  v_and_b32 v149, 3, v1
  v_and_b32 v150, 2, v149
  v_add_u32 v150, v150, v149
  s_cmp_lg_u32 s32, 0
  s_cselect_b64 vcc, -1, 0
  s_cselect_b32 s26, 32, 16
  v_cndmask_b32 v149, v150, v149, vcc
  v_lshlrev_b32 v149, 3, v149
  v_lshl_add_u32 v148, v148, 7, v149
  v_add_u32 v152, s28, v148
  v_add_u32 v153, 512, v152
  v_add_u32 v154, s26, v152
  v_add_u32 v155, s26, v153
  s_waitcnt vmcnt(37)
  ds_read_b64_tr_b16 a[0:1], v152 offset:0
  ds_read_b64_tr_b16 a[2:3], v153 offset:0
  ds_read_b64_tr_b16 a[4:5], v154 offset:0
  ds_read_b64_tr_b16 a[6:7], v155 offset:0
  ds_read_b64_tr_b16 a[8:9], v152 offset:64
  ds_read_b64_tr_b16 a[10:11], v153 offset:64
  ds_read_b64_tr_b16 a[12:13], v154 offset:64
  ds_read_b64_tr_b16 a[14:15], v155 offset:64
  s_waitcnt lgkmcnt(0)
  s_add_u32 m0, s28, 0
  s_nop 0
  buffer_load_dwordx4 v144, s[8:11], s17 offen lds
  s_add_u32 s17, s17, s29
  s_add_u32 m0, s28, 1024
  s_nop 0
  buffer_load_dwordx4 v144, s[8:11], s17 offen lds
  s_add_u32 s17, s17, s29
  s_add_u32 m0, s28, 2048
  s_nop 0
  buffer_load_dwordx4 v144, s[8:11], s17 offen lds
  s_add_u32 s17, s17, s29
  s_add_u32 m0, s28, 3072
  s_nop 0
  buffer_load_dwordx4 v144, s[8:11], s17 offen lds
  s_add_u32 s17, s17, s29
  s_waitcnt vmcnt(37)
  ds_read_b64_tr_b16 a[16:17], v152 offset:4096
  ds_read_b64_tr_b16 a[18:19], v153 offset:4096
  ds_read_b64_tr_b16 a[20:21], v154 offset:4096
  ds_read_b64_tr_b16 a[22:23], v155 offset:4096
  ds_read_b64_tr_b16 a[24:25], v152 offset:4160
  ds_read_b64_tr_b16 a[26:27], v153 offset:4160
  ds_read_b64_tr_b16 a[28:29], v154 offset:4160
  ds_read_b64_tr_b16 a[30:31], v155 offset:4160
  s_waitcnt lgkmcnt(0)
  s_add_u32 m0, s28, 4096
  s_nop 0
  buffer_load_dwordx4 v144, s[8:11], s17 offen lds
  s_add_u32 s17, s17, s29
  s_add_u32 m0, s28, 5120
  s_nop 0
  buffer_load_dwordx4 v144, s[8:11], s17 offen lds
  s_add_u32 s17, s17, s29
  s_add_u32 m0, s28, 6144
  s_nop 0
  buffer_load_dwordx4 v144, s[8:11], s17 offen lds
  s_add_u32 s17, s17, s29
  s_add_u32 m0, s28, 7168
  s_nop 0
  buffer_load_dwordx4 v144, s[8:11], s17 offen lds
  s_add_u32 s17, s17, s29
  s_waitcnt vmcnt(37)
  ds_read_b64_tr_b16 a[32:33], v152 offset:8192
  ds_read_b64_tr_b16 a[34:35], v153 offset:8192
  ds_read_b64_tr_b16 a[36:37], v154 offset:8192
  ds_read_b64_tr_b16 a[38:39], v155 offset:8192
  ds_read_b64_tr_b16 a[40:41], v152 offset:8256
  ds_read_b64_tr_b16 a[42:43], v153 offset:8256
  ds_read_b64_tr_b16 a[44:45], v154 offset:8256
  ds_read_b64_tr_b16 a[46:47], v155 offset:8256
  s_waitcnt lgkmcnt(0)
  s_add_u32 m0, s28, 8192
  s_nop 0
  buffer_load_dwordx4 v144, s[8:11], s17 offen lds
  s_add_u32 s17, s17, s29
  s_add_u32 m0, s28, 9216
  s_nop 0
  buffer_load_dwordx4 v144, s[8:11], s17 offen lds
  s_add_u32 s17, s17, s29
  s_add_u32 m0, s28, 10240
  s_nop 0
  buffer_load_dwordx4 v144, s[8:11], s17 offen lds
  s_add_u32 s17, s17, s29
  s_add_u32 m0, s28, 11264
  s_nop 0
  buffer_load_dwordx4 v144, s[8:11], s17 offen lds
  s_add_u32 s17, s17, s29
  s_waitcnt vmcnt(37)
  ds_read_b64_tr_b16 a[48:49], v152 offset:12288
  ds_read_b64_tr_b16 a[50:51], v153 offset:12288
  ds_read_b64_tr_b16 a[52:53], v154 offset:12288
  ds_read_b64_tr_b16 a[54:55], v155 offset:12288
  ds_read_b64_tr_b16 a[56:57], v152 offset:12352
  ds_read_b64_tr_b16 a[58:59], v153 offset:12352
  ds_read_b64_tr_b16 a[60:61], v154 offset:12352
  ds_read_b64_tr_b16 a[62:63], v155 offset:12352
  s_waitcnt lgkmcnt(0)
  s_add_u32 m0, s28, 12288
  s_nop 0
  buffer_load_dwordx4 v144, s[8:11], s17 offen lds
  s_add_u32 s17, s17, s29
  s_add_u32 m0, s28, 13312
  s_nop 0
  buffer_load_dwordx4 v144, s[8:11], s17 offen lds
  s_add_u32 s17, s17, s29
  s_add_u32 m0, s28, 14336
  s_nop 0
  buffer_load_dwordx4 v144, s[8:11], s17 offen lds
  s_add_u32 s17, s17, s29
  s_add_u32 m0, s28, 15360
  s_nop 0
  buffer_load_dwordx4 v144, s[8:11], s17 offen lds
  s_add_u32 s17, s17, s29
  s_waitcnt vmcnt(37)
  ds_read_b64_tr_b16 a[64:65], v152 offset:16384
  ds_read_b64_tr_b16 a[66:67], v153 offset:16384
  ds_read_b64_tr_b16 a[68:69], v154 offset:16384
  ds_read_b64_tr_b16 a[70:71], v155 offset:16384
  ds_read_b64_tr_b16 a[72:73], v152 offset:16448
  ds_read_b64_tr_b16 a[74:75], v153 offset:16448
  ds_read_b64_tr_b16 a[76:77], v154 offset:16448
  ds_read_b64_tr_b16 a[78:79], v155 offset:16448
  s_waitcnt lgkmcnt(0)
  s_add_u32 m0, s28, 16384
  s_nop 0
  buffer_load_dwordx4 v144, s[8:11], s17 offen lds
  s_add_u32 s17, s17, s29
  s_add_u32 m0, s28, 17408
  s_nop 0
  buffer_load_dwordx4 v144, s[8:11], s17 offen lds
  s_add_u32 s17, s17, s29
  s_add_u32 m0, s28, 18432
  s_nop 0
  buffer_load_dwordx4 v144, s[8:11], s17 offen lds
  s_add_u32 s17, s17, s29
  s_add_u32 m0, s28, 19456
  s_nop 0
  buffer_load_dwordx4 v144, s[8:11], s17 offen lds
  s_add_u32 s17, s17, s29
  s_waitcnt vmcnt(37)
  ds_read_b64_tr_b16 a[80:81], v152 offset:20480
  ds_read_b64_tr_b16 a[82:83], v153 offset:20480
  ds_read_b64_tr_b16 a[84:85], v154 offset:20480
  ds_read_b64_tr_b16 a[86:87], v155 offset:20480
  ds_read_b64_tr_b16 a[88:89], v152 offset:20544
  ds_read_b64_tr_b16 a[90:91], v153 offset:20544
  ds_read_b64_tr_b16 a[92:93], v154 offset:20544
  ds_read_b64_tr_b16 a[94:95], v155 offset:20544
  s_waitcnt lgkmcnt(0)
  s_add_u32 m0, s28, 20480
  s_nop 0
  buffer_load_dwordx4 v144, s[8:11], s17 offen lds
  s_add_u32 s17, s17, s29
  s_add_u32 m0, s28, 21504
  s_nop 0
  buffer_load_dwordx4 v144, s[8:11], s17 offen lds
  s_add_u32 s17, s17, s29
  s_add_u32 m0, s28, 22528
  s_nop 0
  buffer_load_dwordx4 v144, s[8:11], s17 offen lds
  s_add_u32 s17, s17, s29
  s_add_u32 m0, s28, 23552
  s_nop 0
  buffer_load_dwordx4 v144, s[8:11], s17 offen lds
  s_add_u32 s17, s17, s29
  s_waitcnt vmcnt(37)
  ds_read_b64_tr_b16 a[96:97], v152 offset:24576
  ds_read_b64_tr_b16 a[98:99], v153 offset:24576
  ds_read_b64_tr_b16 a[100:101], v154 offset:24576
  ds_read_b64_tr_b16 a[102:103], v155 offset:24576
  ds_read_b64_tr_b16 a[104:105], v152 offset:24640
  ds_read_b64_tr_b16 a[106:107], v153 offset:24640
  ds_read_b64_tr_b16 a[108:109], v154 offset:24640
  ds_read_b64_tr_b16 a[110:111], v155 offset:24640
  s_waitcnt lgkmcnt(0)
  s_add_u32 m0, s28, 24576
  s_nop 0
  buffer_load_dwordx4 v144, s[8:11], s17 offen lds
  s_add_u32 s17, s17, s29
  s_add_u32 m0, s28, 25600
  s_nop 0
  buffer_load_dwordx4 v144, s[8:11], s17 offen lds
  s_add_u32 s17, s17, s29
  s_add_u32 m0, s28, 26624
  s_nop 0
  buffer_load_dwordx4 v144, s[8:11], s17 offen lds
  s_add_u32 s17, s17, s29
  s_add_u32 m0, s28, 27648
  s_nop 0
  buffer_load_dwordx4 v144, s[8:11], s17 offen lds
  s_add_u32 s17, s17, s29
  s_waitcnt vmcnt(37)
  ds_read_b64_tr_b16 a[112:113], v152 offset:28672
  ds_read_b64_tr_b16 a[114:115], v153 offset:28672
  ds_read_b64_tr_b16 a[116:117], v154 offset:28672
  ds_read_b64_tr_b16 a[118:119], v155 offset:28672
  ds_read_b64_tr_b16 a[120:121], v152 offset:28736
  ds_read_b64_tr_b16 a[122:123], v153 offset:28736
  ds_read_b64_tr_b16 a[124:125], v154 offset:28736
  ds_read_b64_tr_b16 a[126:127], v155 offset:28736
  s_waitcnt lgkmcnt(0)
  s_add_u32 m0, s28, 28672
  s_nop 0
  buffer_load_dwordx4 v144, s[8:11], s17 offen lds
  s_add_u32 s17, s17, s29
  s_add_u32 m0, s28, 29696
  s_nop 0
  buffer_load_dwordx4 v144, s[8:11], s17 offen lds
  s_add_u32 s17, s17, s29
  s_add_u32 m0, s28, 30720
  s_nop 0
  buffer_load_dwordx4 v144, s[8:11], s17 offen lds
  s_add_u32 s17, s17, s29
  s_add_u32 m0, s28, 31744
  s_nop 0
  buffer_load_dwordx4 v144, s[8:11], s17 offen lds
  s_add_u32 s17, s17, s29
  s_waitcnt vmcnt(28)
  ds_read_b64_tr_b16 a[128:129], v152 offset:0
  ds_read_b64_tr_b16 a[130:131], v153 offset:0
  ds_read_b64_tr_b16 a[132:133], v154 offset:0
  ds_read_b64_tr_b16 a[134:135], v155 offset:0
  ds_read_b64_tr_b16 a[136:137], v152 offset:64
  ds_read_b64_tr_b16 a[138:139], v153 offset:64
  ds_read_b64_tr_b16 a[140:141], v154 offset:64
  ds_read_b64_tr_b16 a[142:143], v155 offset:64
  s_waitcnt lgkmcnt(0)
  s_waitcnt vmcnt(24)
  ds_read_b64_tr_b16 a[144:145], v152 offset:4096
  ds_read_b64_tr_b16 a[146:147], v153 offset:4096
  ds_read_b64_tr_b16 a[148:149], v154 offset:4096
  ds_read_b64_tr_b16 a[150:151], v155 offset:4096
  ds_read_b64_tr_b16 a[152:153], v152 offset:4160
  ds_read_b64_tr_b16 a[154:155], v153 offset:4160
  ds_read_b64_tr_b16 a[156:157], v154 offset:4160
  ds_read_b64_tr_b16 a[158:159], v155 offset:4160
  s_waitcnt lgkmcnt(0)
  s_waitcnt vmcnt(20)
  ds_read_b64_tr_b16 a[160:161], v152 offset:8192
  ds_read_b64_tr_b16 a[162:163], v153 offset:8192
  ds_read_b64_tr_b16 a[164:165], v154 offset:8192
  ds_read_b64_tr_b16 a[166:167], v155 offset:8192
  ds_read_b64_tr_b16 a[168:169], v152 offset:8256
  ds_read_b64_tr_b16 a[170:171], v153 offset:8256
  ds_read_b64_tr_b16 a[172:173], v154 offset:8256
  ds_read_b64_tr_b16 a[174:175], v155 offset:8256
  s_waitcnt lgkmcnt(0)
  s_waitcnt vmcnt(16)
  ds_read_b64_tr_b16 a[176:177], v152 offset:12288
  ds_read_b64_tr_b16 a[178:179], v153 offset:12288
  ds_read_b64_tr_b16 a[180:181], v154 offset:12288
  ds_read_b64_tr_b16 a[182:183], v155 offset:12288
  ds_read_b64_tr_b16 a[184:185], v152 offset:12352
  ds_read_b64_tr_b16 a[186:187], v153 offset:12352
  ds_read_b64_tr_b16 a[188:189], v154 offset:12352
  ds_read_b64_tr_b16 a[190:191], v155 offset:12352
  s_waitcnt lgkmcnt(0)
  s_waitcnt vmcnt(12)
  ds_read_b64_tr_b16 a[192:193], v152 offset:16384
  ds_read_b64_tr_b16 a[194:195], v153 offset:16384
  ds_read_b64_tr_b16 a[196:197], v154 offset:16384
  ds_read_b64_tr_b16 a[198:199], v155 offset:16384
  ds_read_b64_tr_b16 a[200:201], v152 offset:16448
  ds_read_b64_tr_b16 a[202:203], v153 offset:16448
  ds_read_b64_tr_b16 a[204:205], v154 offset:16448
  ds_read_b64_tr_b16 a[206:207], v155 offset:16448
  s_waitcnt lgkmcnt(0)
  s_waitcnt vmcnt(8)
  ds_read_b64_tr_b16 a[208:209], v152 offset:20480
  ds_read_b64_tr_b16 a[210:211], v153 offset:20480
  ds_read_b64_tr_b16 a[212:213], v154 offset:20480
  ds_read_b64_tr_b16 a[214:215], v155 offset:20480
  ds_read_b64_tr_b16 a[216:217], v152 offset:20544
  ds_read_b64_tr_b16 a[218:219], v153 offset:20544
  ds_read_b64_tr_b16 a[220:221], v154 offset:20544
  ds_read_b64_tr_b16 a[222:223], v155 offset:20544
  s_waitcnt lgkmcnt(0)
  s_waitcnt vmcnt(4)
  ds_read_b64_tr_b16 a[224:225], v152 offset:24576
  ds_read_b64_tr_b16 a[226:227], v153 offset:24576
  ds_read_b64_tr_b16 a[228:229], v154 offset:24576
  ds_read_b64_tr_b16 a[230:231], v155 offset:24576
  ds_read_b64_tr_b16 a[232:233], v152 offset:24640
  ds_read_b64_tr_b16 a[234:235], v153 offset:24640
  ds_read_b64_tr_b16 a[236:237], v154 offset:24640
  ds_read_b64_tr_b16 a[238:239], v155 offset:24640
  s_waitcnt lgkmcnt(0)
  s_waitcnt vmcnt(0)
  ds_read_b64_tr_b16 a[240:241], v152 offset:28672
  ds_read_b64_tr_b16 a[242:243], v153 offset:28672
  ds_read_b64_tr_b16 a[244:245], v154 offset:28672
  ds_read_b64_tr_b16 a[246:247], v155 offset:28672
  ds_read_b64_tr_b16 a[248:249], v152 offset:28736
  ds_read_b64_tr_b16 a[250:251], v153 offset:28736
  ds_read_b64_tr_b16 a[252:253], v154 offset:28736
  ds_read_b64_tr_b16 a[254:255], v155 offset:28736
  s_waitcnt lgkmcnt(0)
  s_barrier
  s_add_u32 m0, s25, 0
  s_nop 0
  buffer_load_dwordx4 v16, s[12:15], s19 offen lds
  s_add_u32 m0, s25, 1024
  s_nop 0
  buffer_load_dwordx4 v17, s[12:15], s19 offen lds
  s_add_u32 m0, s25, 2048
  s_nop 0
  buffer_load_dwordx4 v18, s[12:15], s19 offen lds
  s_add_u32 m0, s25, 3072
  s_nop 0
  buffer_load_dwordx4 v19, s[12:15], s19 offen lds
  s_add_u32 m0, s25, 4096
  s_nop 0
  buffer_load_dwordx4 v20, s[12:15], s19 offen lds
  s_add_u32 m0, s25, 5120
  s_nop 0
  buffer_load_dwordx4 v21, s[12:15], s19 offen lds
  s_add_u32 m0, s25, 6144
  s_nop 0
  buffer_load_dwordx4 v22, s[12:15], s19 offen lds
  s_add_u32 m0, s25, 7168
  s_nop 0
  buffer_load_dwordx4 v23, s[12:15], s19 offen lds
  s_cmp_gt_u32 s23, 2
  s_cselect_b32 s26, s20, 0
  s_add_u32 s19, s19, s26
  s_add_u32 s25, s25, 32768
  s_and_b32 s25, s25, 0x1ffff
  s_waitcnt vmcnt(0)
  s_barrier
  s_load_dwordx2 s[8:9], s[0:1], 40
  s_mul_i32 s76, s66, 18816
  v_min_u32 v200, 146, v0
  v_lshl_add_u32 v200, v200, 7, s76
  s_waitcnt lgkmcnt(0)
  s_and_b32 s9, s9, 0xffff
  buffer_load_dword v201, v200, s[8:11], 0 offen
  s_cmp_lg_u32 s32, 0
  s_cbranch_scc1 P_v_1
  s_cmp_eq_u32 s48, 0
  s_cbranch_scc1 P_q_3
  s_mov_b32 s27, s21
  v_mov_b32 v7, 0x40000000
  s_mov_b32 s29, -2
  v_min_u32 v145, 1, v0
  v_lshlrev_b32 v145, 30, v145
  ds_read_b128 v[24:27], v8 offset:0
  ds_read_b128 v[28:31], v9 offset:0
  ds_read_b128 v[32:35], v10 offset:0
  ds_read_b128 v[36:39], v11 offset:0
  ds_read_b128 v[40:43], v12 offset:0
  ds_read_b128 v[44:47], v13 offset:0
.p2align 6
G_top_4:
  s_waitcnt lgkmcnt(5)
  v_mfma_f32_16x16x32_bf16 v[64:67], a[0:3], v[24:27], 0
  s_add_u32 m0, s25, 0
  ds_read_b128 v[48:51], v14 offset:0
  v_mfma_f32_16x16x32_bf16 v[68:71], a[4:7], v[24:27], 0
  v_mfma_f32_16x16x32_bf16 v[80:83], a[8:11], v[24:27], 0
  buffer_load_dwordx4 v16, s[12:15], s19 offen lds
  v_mfma_f32_16x16x32_bf16 v[84:87], a[12:15], v[24:27], 0
  s_waitcnt lgkmcnt(5)
  v_mfma_f32_16x16x32_bf16 v[72:75], a[0:3], v[28:31], 0
  ds_read_b128 v[52:55], v15 offset:0
  v_mfma_f32_16x16x32_bf16 v[76:79], a[4:7], v[28:31], 0
  v_cvt_pk_bf16_f32 v128, v96, v97
  v_cvt_pk_bf16_f32 v129, v98, v99
  v_mfma_f32_16x16x32_bf16 v[88:91], a[8:11], v[28:31], 0
  v_mfma_f32_16x16x32_bf16 v[92:95], a[12:15], v[28:31], 0
  s_waitcnt lgkmcnt(5)
  v_cvt_pk_bf16_f32 v130, v100, v101
  v_cvt_pk_bf16_f32 v131, v102, v103
  v_mfma_f32_16x16x32_bf16 v[64:67], a[16:19], v[32:35], v[64:67]
  s_add_u32 m0, s25, 1024
  ds_read_b128 v[24:27], v8 offset:8192
  v_mfma_f32_16x16x32_bf16 v[68:71], a[20:23], v[32:35], v[68:71]
  v_mfma_f32_16x16x32_bf16 v[80:83], a[24:27], v[32:35], v[80:83]
  buffer_load_dwordx4 v17, s[12:15], s19 offen lds
  v_mfma_f32_16x16x32_bf16 v[84:87], a[28:31], v[32:35], v[84:87]
  s_waitcnt lgkmcnt(5)
  v_mfma_f32_16x16x32_bf16 v[72:75], a[16:19], v[36:39], v[72:75]
  ds_read_b128 v[28:31], v9 offset:8192
  v_mfma_f32_16x16x32_bf16 v[76:79], a[20:23], v[36:39], v[76:79]
  v_mfma_f32_16x16x32_bf16 v[88:91], a[24:27], v[36:39], v[88:91]
  v_mfma_f32_16x16x32_bf16 v[92:95], a[28:31], v[36:39], v[92:95]
  s_waitcnt lgkmcnt(5)
  v_mfma_f32_16x16x32_bf16 v[64:67], a[32:35], v[40:43], v[64:67]
  s_add_u32 m0, s25, 2048
  ds_read_b128 v[32:35], v10 offset:8192
  v_mfma_f32_16x16x32_bf16 v[68:71], a[36:39], v[40:43], v[68:71]
  v_cvt_pk_bf16_f32 v132, v104, v105
  v_cvt_pk_bf16_f32 v133, v106, v107
  v_mfma_f32_16x16x32_bf16 v[80:83], a[40:43], v[40:43], v[80:83]
  buffer_load_dwordx4 v18, s[12:15], s19 offen lds
  v_mfma_f32_16x16x32_bf16 v[84:87], a[44:47], v[40:43], v[84:87]
  s_waitcnt lgkmcnt(5)
  v_cvt_pk_bf16_f32 v134, v108, v109
  v_cvt_pk_bf16_f32 v135, v110, v111
  v_mfma_f32_16x16x32_bf16 v[72:75], a[32:35], v[44:47], v[72:75]
  ds_read_b128 v[36:39], v11 offset:8192
  v_mfma_f32_16x16x32_bf16 v[76:79], a[36:39], v[44:47], v[76:79]
  v_mfma_f32_16x16x32_bf16 v[88:91], a[40:43], v[44:47], v[88:91]
  v_mfma_f32_16x16x32_bf16 v[92:95], a[44:47], v[44:47], v[92:95]
  s_waitcnt lgkmcnt(5)
  v_mfma_f32_16x16x32_bf16 v[64:67], a[48:51], v[48:51], v[64:67]
  s_add_u32 m0, s25, 3072
  ds_read_b128 v[40:43], v12 offset:8192
  v_mfma_f32_16x16x32_bf16 v[68:71], a[52:55], v[48:51], v[68:71]
  v_mfma_f32_16x16x32_bf16 v[80:83], a[56:59], v[48:51], v[80:83]
  buffer_load_dwordx4 v19, s[12:15], s19 offen lds
  v_mfma_f32_16x16x32_bf16 v[84:87], a[60:63], v[48:51], v[84:87]
  s_waitcnt lgkmcnt(5)
  v_mfma_f32_16x16x32_bf16 v[72:75], a[48:51], v[52:55], v[72:75]
  ds_read_b128 v[44:47], v13 offset:8192
  v_mfma_f32_16x16x32_bf16 v[76:79], a[52:55], v[52:55], v[76:79]
  v_cvt_pk_bf16_f32 v136, v112, v113
  v_cvt_pk_bf16_f32 v137, v114, v115
  v_mfma_f32_16x16x32_bf16 v[88:91], a[56:59], v[52:55], v[88:91]
  v_mfma_f32_16x16x32_bf16 v[92:95], a[60:63], v[52:55], v[92:95]
  s_waitcnt lgkmcnt(5)
  v_cvt_pk_bf16_f32 v138, v116, v117
  v_cvt_pk_bf16_f32 v139, v118, v119
  v_mfma_f32_16x16x32_bf16 v[64:67], a[64:67], v[24:27], v[64:67]
  s_add_u32 m0, s25, 4096
  ds_read_b128 v[48:51], v14 offset:8192
  v_mfma_f32_16x16x32_bf16 v[68:71], a[68:71], v[24:27], v[68:71]
  v_mfma_f32_16x16x32_bf16 v[80:83], a[72:75], v[24:27], v[80:83]
  buffer_load_dwordx4 v20, s[12:15], s19 offen lds
  v_mfma_f32_16x16x32_bf16 v[84:87], a[76:79], v[24:27], v[84:87]
  s_waitcnt lgkmcnt(5)
  v_mfma_f32_16x16x32_bf16 v[72:75], a[64:67], v[28:31], v[72:75]
  ds_read_b128 v[52:55], v15 offset:8192
  v_mfma_f32_16x16x32_bf16 v[76:79], a[68:71], v[28:31], v[76:79]
  v_mfma_f32_16x16x32_bf16 v[88:91], a[72:75], v[28:31], v[88:91]
  v_mfma_f32_16x16x32_bf16 v[92:95], a[76:79], v[28:31], v[92:95]
  s_waitcnt lgkmcnt(5)
  v_mfma_f32_16x16x32_bf16 v[64:67], a[80:83], v[32:35], v[64:67]
  s_add_u32 m0, s25, 5120
  ds_read_b128 v[24:27], v8 offset:16384
  v_mfma_f32_16x16x32_bf16 v[68:71], a[84:87], v[32:35], v[68:71]
  v_cvt_pk_bf16_f32 v140, v120, v121
  v_cvt_pk_bf16_f32 v141, v122, v123
  v_mfma_f32_16x16x32_bf16 v[80:83], a[88:91], v[32:35], v[80:83]
  buffer_load_dwordx4 v21, s[12:15], s19 offen lds
  v_mfma_f32_16x16x32_bf16 v[84:87], a[92:95], v[32:35], v[84:87]
  s_waitcnt lgkmcnt(5)
  v_cvt_pk_bf16_f32 v142, v124, v125
  v_cvt_pk_bf16_f32 v143, v126, v127
  v_mfma_f32_16x16x32_bf16 v[72:75], a[80:83], v[36:39], v[72:75]
  ds_read_b128 v[28:31], v9 offset:16384
  v_mfma_f32_16x16x32_bf16 v[76:79], a[84:87], v[36:39], v[76:79]
  v_mfma_f32_16x16x32_bf16 v[88:91], a[88:91], v[36:39], v[88:91]
  v_mfma_f32_16x16x32_bf16 v[92:95], a[92:95], v[36:39], v[92:95]
  s_waitcnt lgkmcnt(5)
  v_mfma_f32_16x16x32_bf16 v[64:67], a[96:99], v[40:43], v[64:67]
  s_add_u32 m0, s25, 6144
  ds_read_b128 v[32:35], v10 offset:16384
  v_mfma_f32_16x16x32_bf16 v[68:71], a[100:103], v[40:43], v[68:71]
  v_mfma_f32_16x16x32_bf16 v[80:83], a[104:107], v[40:43], v[80:83]
  buffer_load_dwordx4 v22, s[12:15], s19 offen lds
  v_mfma_f32_16x16x32_bf16 v[84:87], a[108:111], v[40:43], v[84:87]
  s_waitcnt lgkmcnt(5)
  v_mfma_f32_16x16x32_bf16 v[72:75], a[96:99], v[44:47], v[72:75]
  ds_read_b128 v[36:39], v11 offset:16384
  v_mfma_f32_16x16x32_bf16 v[76:79], a[100:103], v[44:47], v[76:79]
  v_mfma_f32_16x16x32_bf16 v[88:91], a[104:107], v[44:47], v[88:91]
  v_mfma_f32_16x16x32_bf16 v[92:95], a[108:111], v[44:47], v[92:95]
  s_waitcnt lgkmcnt(5)
  v_mfma_f32_16x16x32_bf16 v[64:67], a[112:115], v[48:51], v[64:67]
  s_add_u32 m0, s25, 7168
  ds_read_b128 v[40:43], v12 offset:16384
  v_mfma_f32_16x16x32_bf16 v[68:71], a[116:119], v[48:51], v[68:71]
  v_mfma_f32_16x16x32_bf16 v[80:83], a[120:123], v[48:51], v[80:83]
  buffer_load_dwordx4 v23, s[12:15], s19 offen lds
  v_mfma_f32_16x16x32_bf16 v[84:87], a[124:127], v[48:51], v[84:87]
  s_waitcnt lgkmcnt(5)
  v_mfma_f32_16x16x32_bf16 v[72:75], a[112:115], v[52:55], v[72:75]
  s_cmp_gt_u32 s23, 3
  ds_read_b128 v[44:47], v13 offset:16384
  v_mfma_f32_16x16x32_bf16 v[76:79], a[116:119], v[52:55], v[76:79]
  v_mfma_f32_16x16x32_bf16 v[88:91], a[120:123], v[52:55], v[88:91]
  s_cselect_b32 s26, s20, 0
  v_mfma_f32_16x16x32_bf16 v[92:95], a[124:127], v[52:55], v[92:95]
  s_waitcnt lgkmcnt(5)
  v_mfma_f32_16x16x32_bf16 v[64:67], a[128:131], v[24:27], v[64:67]
  s_add_u32 s19, s19, s26
  ds_read_b128 v[48:51], v14 offset:16384
  v_mfma_f32_16x16x32_bf16 v[68:71], a[132:135], v[24:27], v[68:71]
  v_mfma_f32_16x16x32_bf16 v[80:83], a[136:139], v[24:27], v[80:83]
  s_add_u32 s25, s25, 32768
  v_mfma_f32_16x16x32_bf16 v[84:87], a[140:143], v[24:27], v[84:87]
  s_waitcnt lgkmcnt(5)
  v_mfma_f32_16x16x32_bf16 v[72:75], a[128:131], v[28:31], v[72:75]
  s_and_b32 s25, s25, 0x1ffff
  ds_read_b128 v[52:55], v15 offset:16384
  v_mfma_f32_16x16x32_bf16 v[76:79], a[132:135], v[28:31], v[76:79]
  v_mfma_f32_16x16x32_bf16 v[88:91], a[136:139], v[28:31], v[88:91]
  buffer_store_dwordx4 v[128:131], v7, s[4:7], s21 offen offset:0 sc1
  v_mfma_f32_16x16x32_bf16 v[92:95], a[140:143], v[28:31], v[92:95]
  s_waitcnt lgkmcnt(5)
  v_mfma_f32_16x16x32_bf16 v[64:67], a[144:147], v[32:35], v[64:67]
  ds_read_b128 v[24:27], v8 offset:24576
  v_mfma_f32_16x16x32_bf16 v[68:71], a[148:151], v[32:35], v[68:71]
  v_mfma_f32_16x16x32_bf16 v[80:83], a[152:155], v[32:35], v[80:83]
  v_mfma_f32_16x16x32_bf16 v[84:87], a[156:159], v[32:35], v[84:87]
  s_waitcnt lgkmcnt(5)
  v_mfma_f32_16x16x32_bf16 v[72:75], a[144:147], v[36:39], v[72:75]
  ds_read_b128 v[28:31], v9 offset:24576
  v_mfma_f32_16x16x32_bf16 v[76:79], a[148:151], v[36:39], v[76:79]
  v_mfma_f32_16x16x32_bf16 v[88:91], a[152:155], v[36:39], v[88:91]
  buffer_store_dwordx4 v[132:135], v7, s[4:7], s21 offen offset:256 sc1
  v_mfma_f32_16x16x32_bf16 v[92:95], a[156:159], v[36:39], v[92:95]
  s_waitcnt lgkmcnt(5)
  v_mfma_f32_16x16x32_bf16 v[64:67], a[160:163], v[40:43], v[64:67]
  ds_read_b128 v[32:35], v10 offset:24576
  v_mfma_f32_16x16x32_bf16 v[68:71], a[164:167], v[40:43], v[68:71]
  v_mfma_f32_16x16x32_bf16 v[80:83], a[168:171], v[40:43], v[80:83]
  v_mfma_f32_16x16x32_bf16 v[84:87], a[172:175], v[40:43], v[84:87]
  s_waitcnt lgkmcnt(5)
  v_mfma_f32_16x16x32_bf16 v[72:75], a[160:163], v[44:47], v[72:75]
  ds_read_b128 v[36:39], v11 offset:24576
  v_mfma_f32_16x16x32_bf16 v[76:79], a[164:167], v[44:47], v[76:79]
  v_mfma_f32_16x16x32_bf16 v[88:91], a[168:171], v[44:47], v[88:91]
  buffer_store_dwordx4 v[136:139], v7, s[4:7], s21 offen offset:2048 sc1
  v_mfma_f32_16x16x32_bf16 v[92:95], a[172:175], v[44:47], v[92:95]
  s_waitcnt lgkmcnt(5)
  v_mfma_f32_16x16x32_bf16 v[64:67], a[176:179], v[48:51], v[64:67]
  ds_read_b128 v[40:43], v12 offset:24576
  v_mfma_f32_16x16x32_bf16 v[68:71], a[180:183], v[48:51], v[68:71]
  v_mfma_f32_16x16x32_bf16 v[80:83], a[184:187], v[48:51], v[80:83]
  v_mfma_f32_16x16x32_bf16 v[84:87], a[188:191], v[48:51], v[84:87]
  s_waitcnt lgkmcnt(5)
  v_mfma_f32_16x16x32_bf16 v[72:75], a[176:179], v[52:55], v[72:75]
  ds_read_b128 v[44:47], v13 offset:24576
  v_mfma_f32_16x16x32_bf16 v[76:79], a[180:183], v[52:55], v[76:79]
  v_mfma_f32_16x16x32_bf16 v[88:91], a[184:187], v[52:55], v[88:91]
  buffer_store_dwordx4 v[140:143], v7, s[4:7], s21 offen offset:2304 sc1
  v_mfma_f32_16x16x32_bf16 v[92:95], a[188:191], v[52:55], v[92:95]
  s_waitcnt lgkmcnt(5)
  v_mfma_f32_16x16x32_bf16 v[64:67], a[192:195], v[24:27], v[64:67]
  s_mov_b32 s21, s27
  ds_read_b128 v[48:51], v14 offset:24576
  v_mfma_f32_16x16x32_bf16 v[68:71], a[196:199], v[24:27], v[68:71]
  v_mov_b32 v7, v56
  v_mfma_f32_16x16x32_bf16 v[80:83], a[200:203], v[24:27], v[80:83]
  v_mfma_f32_16x16x32_bf16 v[84:87], a[204:207], v[24:27], v[84:87]
  s_waitcnt lgkmcnt(5)
  v_mfma_f32_16x16x32_bf16 v[72:75], a[192:195], v[28:31], v[72:75]
  s_add_u32 s27, s27, s22
  ds_read_b128 v[52:55], v15 offset:24576
  v_mfma_f32_16x16x32_bf16 v[76:79], a[196:199], v[28:31], v[76:79]
  v_mfma_f32_16x16x32_bf16 v[88:91], a[200:203], v[28:31], v[88:91]
  s_waitcnt vmcnt(13)
  s_barrier
  v_mfma_f32_16x16x32_bf16 v[92:95], a[204:207], v[28:31], v[92:95]
  s_waitcnt lgkmcnt(5)
  v_mfma_f32_16x16x32_bf16 v[64:67], a[208:211], v[32:35], v[64:67]
  ds_read_b128 v[24:27], v8 offset:32768
  v_mfma_f32_16x16x32_bf16 v[68:71], a[212:215], v[32:35], v[68:71]
  v_mfma_f32_16x16x32_bf16 v[80:83], a[216:219], v[32:35], v[80:83]
  v_mfma_f32_16x16x32_bf16 v[84:87], a[220:223], v[32:35], v[84:87]
  s_waitcnt lgkmcnt(5)
  v_mfma_f32_16x16x32_bf16 v[72:75], a[208:211], v[36:39], v[72:75]
  s_add_u32 s29, s29, 1
  ds_read_b128 v[28:31], v9 offset:32768
  v_mfma_f32_16x16x32_bf16 v[76:79], a[212:215], v[36:39], v[76:79]
  v_mfma_f32_16x16x32_bf16 v[88:91], a[216:219], v[36:39], v[88:91]
  s_max_i32 s30, s29, 0
  v_mfma_f32_16x16x32_bf16 v[92:95], a[220:223], v[36:39], v[92:95]
  s_waitcnt lgkmcnt(5)
  v_mov_b32 v144, s30
  v_mfma_f32_16x16x32_bf16 v[64:67], a[224:227], v[40:43], v[64:67]
  ds_read_b128 v[32:35], v10 offset:32768
  v_mfma_f32_16x16x32_bf16 v[68:71], a[228:231], v[40:43], v[68:71]
  v_mfma_f32_16x16x32_bf16 v[80:83], a[232:235], v[40:43], v[80:83]
  buffer_store_dword v144, v145, s[4:7], s31 offen sc1
  v_mfma_f32_16x16x32_bf16 v[84:87], a[236:239], v[40:43], v[84:87]
  s_waitcnt lgkmcnt(5)
  v_mfma_f32_16x16x32_bf16 v[72:75], a[224:227], v[44:47], v[72:75]
  ds_read_b128 v[36:39], v11 offset:32768
  v_mfma_f32_16x16x32_bf16 v[76:79], a[228:231], v[44:47], v[76:79]
  v_mfma_f32_16x16x32_bf16 v[88:91], a[232:235], v[44:47], v[88:91]
  v_mfma_f32_16x16x32_bf16 v[92:95], a[236:239], v[44:47], v[92:95]
  s_waitcnt lgkmcnt(5)
  v_mfma_f32_16x16x32_bf16 v[64:67], a[240:243], v[48:51], v[64:67]
  s_sub_u32 s23, s23, 1
  ds_read_b128 v[40:43], v12 offset:32768
  v_mfma_f32_16x16x32_bf16 v[68:71], a[244:247], v[48:51], v[68:71]
  v_mfma_f32_16x16x32_bf16 v[80:83], a[248:251], v[48:51], v[80:83]
  v_mfma_f32_16x16x32_bf16 v[84:87], a[252:255], v[48:51], v[84:87]
  s_waitcnt lgkmcnt(5)
  v_mfma_f32_16x16x32_bf16 v[72:75], a[240:243], v[52:55], v[72:75]
  s_cmp_eq_u32 s23, 0
  ds_read_b128 v[44:47], v13 offset:32768
  v_mfma_f32_16x16x32_bf16 v[76:79], a[244:247], v[52:55], v[76:79]
  v_mfma_f32_16x16x32_bf16 v[88:91], a[248:251], v[52:55], v[88:91]
  v_mfma_f32_16x16x32_bf16 v[92:95], a[252:255], v[52:55], v[92:95]
  s_cbranch_scc1 G_done0_5
  s_waitcnt lgkmcnt(5)
  v_mfma_f32_16x16x32_bf16 v[96:99], a[0:3], v[24:27], 0
  s_add_u32 m0, s25, 0
  ds_read_b128 v[48:51], v14 offset:32768
  v_mfma_f32_16x16x32_bf16 v[100:103], a[4:7], v[24:27], 0
  v_mfma_f32_16x16x32_bf16 v[112:115], a[8:11], v[24:27], 0
  buffer_load_dwordx4 v16, s[12:15], s19 offen lds
  v_mfma_f32_16x16x32_bf16 v[116:119], a[12:15], v[24:27], 0
  s_waitcnt lgkmcnt(5)
  v_mfma_f32_16x16x32_bf16 v[104:107], a[0:3], v[28:31], 0
  ds_read_b128 v[52:55], v15 offset:32768
  v_mfma_f32_16x16x32_bf16 v[108:111], a[4:7], v[28:31], 0
  v_cvt_pk_bf16_f32 v128, v64, v65
  v_cvt_pk_bf16_f32 v129, v66, v67
  v_mfma_f32_16x16x32_bf16 v[120:123], a[8:11], v[28:31], 0
  v_mfma_f32_16x16x32_bf16 v[124:127], a[12:15], v[28:31], 0
  s_waitcnt lgkmcnt(5)
  v_cvt_pk_bf16_f32 v130, v68, v69
  v_cvt_pk_bf16_f32 v131, v70, v71
  v_mfma_f32_16x16x32_bf16 v[96:99], a[16:19], v[32:35], v[96:99]
  s_add_u32 m0, s25, 1024
  ds_read_b128 v[24:27], v8 offset:40960
  v_mfma_f32_16x16x32_bf16 v[100:103], a[20:23], v[32:35], v[100:103]
  v_mfma_f32_16x16x32_bf16 v[112:115], a[24:27], v[32:35], v[112:115]
  buffer_load_dwordx4 v17, s[12:15], s19 offen lds
  v_mfma_f32_16x16x32_bf16 v[116:119], a[28:31], v[32:35], v[116:119]
  s_waitcnt lgkmcnt(5)
  v_mfma_f32_16x16x32_bf16 v[104:107], a[16:19], v[36:39], v[104:107]
  ds_read_b128 v[28:31], v9 offset:40960
  v_mfma_f32_16x16x32_bf16 v[108:111], a[20:23], v[36:39], v[108:111]
  v_mfma_f32_16x16x32_bf16 v[120:123], a[24:27], v[36:39], v[120:123]
  v_mfma_f32_16x16x32_bf16 v[124:127], a[28:31], v[36:39], v[124:127]
  s_waitcnt lgkmcnt(5)
  v_mfma_f32_16x16x32_bf16 v[96:99], a[32:35], v[40:43], v[96:99]
  s_add_u32 m0, s25, 2048
  ds_read_b128 v[32:35], v10 offset:40960
  v_mfma_f32_16x16x32_bf16 v[100:103], a[36:39], v[40:43], v[100:103]
  v_cvt_pk_bf16_f32 v132, v72, v73
  v_cvt_pk_bf16_f32 v133, v74, v75
  v_mfma_f32_16x16x32_bf16 v[112:115], a[40:43], v[40:43], v[112:115]
  buffer_load_dwordx4 v18, s[12:15], s19 offen lds
  v_mfma_f32_16x16x32_bf16 v[116:119], a[44:47], v[40:43], v[116:119]
  s_waitcnt lgkmcnt(5)
  v_cvt_pk_bf16_f32 v134, v76, v77
  v_cvt_pk_bf16_f32 v135, v78, v79
  v_mfma_f32_16x16x32_bf16 v[104:107], a[32:35], v[44:47], v[104:107]
  ds_read_b128 v[36:39], v11 offset:40960
  v_mfma_f32_16x16x32_bf16 v[108:111], a[36:39], v[44:47], v[108:111]
  v_mfma_f32_16x16x32_bf16 v[120:123], a[40:43], v[44:47], v[120:123]
  v_mfma_f32_16x16x32_bf16 v[124:127], a[44:47], v[44:47], v[124:127]
  s_waitcnt lgkmcnt(5)
  v_mfma_f32_16x16x32_bf16 v[96:99], a[48:51], v[48:51], v[96:99]
  s_add_u32 m0, s25, 3072
  ds_read_b128 v[40:43], v12 offset:40960
  v_mfma_f32_16x16x32_bf16 v[100:103], a[52:55], v[48:51], v[100:103]
  v_mfma_f32_16x16x32_bf16 v[112:115], a[56:59], v[48:51], v[112:115]
  buffer_load_dwordx4 v19, s[12:15], s19 offen lds
  v_mfma_f32_16x16x32_bf16 v[116:119], a[60:63], v[48:51], v[116:119]
  s_waitcnt lgkmcnt(5)
  v_mfma_f32_16x16x32_bf16 v[104:107], a[48:51], v[52:55], v[104:107]
  ds_read_b128 v[44:47], v13 offset:40960
  v_mfma_f32_16x16x32_bf16 v[108:111], a[52:55], v[52:55], v[108:111]
  v_cvt_pk_bf16_f32 v136, v80, v81
  v_cvt_pk_bf16_f32 v137, v82, v83
  v_mfma_f32_16x16x32_bf16 v[120:123], a[56:59], v[52:55], v[120:123]
  v_mfma_f32_16x16x32_bf16 v[124:127], a[60:63], v[52:55], v[124:127]
  s_waitcnt lgkmcnt(5)
  v_cvt_pk_bf16_f32 v138, v84, v85
  v_cvt_pk_bf16_f32 v139, v86, v87
  v_mfma_f32_16x16x32_bf16 v[96:99], a[64:67], v[24:27], v[96:99]
  s_add_u32 m0, s25, 4096
  ds_read_b128 v[48:51], v14 offset:40960
  v_mfma_f32_16x16x32_bf16 v[100:103], a[68:71], v[24:27], v[100:103]
  v_mfma_f32_16x16x32_bf16 v[112:115], a[72:75], v[24:27], v[112:115]
  buffer_load_dwordx4 v20, s[12:15], s19 offen lds
  v_mfma_f32_16x16x32_bf16 v[116:119], a[76:79], v[24:27], v[116:119]
  s_waitcnt lgkmcnt(5)
  v_mfma_f32_16x16x32_bf16 v[104:107], a[64:67], v[28:31], v[104:107]
  ds_read_b128 v[52:55], v15 offset:40960
  v_mfma_f32_16x16x32_bf16 v[108:111], a[68:71], v[28:31], v[108:111]
  v_mfma_f32_16x16x32_bf16 v[120:123], a[72:75], v[28:31], v[120:123]
  v_mfma_f32_16x16x32_bf16 v[124:127], a[76:79], v[28:31], v[124:127]
  s_waitcnt lgkmcnt(5)
  v_mfma_f32_16x16x32_bf16 v[96:99], a[80:83], v[32:35], v[96:99]
  s_add_u32 m0, s25, 5120
  ds_read_b128 v[24:27], v8 offset:49152
  v_mfma_f32_16x16x32_bf16 v[100:103], a[84:87], v[32:35], v[100:103]
  v_cvt_pk_bf16_f32 v140, v88, v89
  v_cvt_pk_bf16_f32 v141, v90, v91
  v_mfma_f32_16x16x32_bf16 v[112:115], a[88:91], v[32:35], v[112:115]
  buffer_load_dwordx4 v21, s[12:15], s19 offen lds
  v_mfma_f32_16x16x32_bf16 v[116:119], a[92:95], v[32:35], v[116:119]
  s_waitcnt lgkmcnt(5)
  v_cvt_pk_bf16_f32 v142, v92, v93
  v_cvt_pk_bf16_f32 v143, v94, v95
  v_mfma_f32_16x16x32_bf16 v[104:107], a[80:83], v[36:39], v[104:107]
  ds_read_b128 v[28:31], v9 offset:49152
  v_mfma_f32_16x16x32_bf16 v[108:111], a[84:87], v[36:39], v[108:111]
  v_mfma_f32_16x16x32_bf16 v[120:123], a[88:91], v[36:39], v[120:123]
  v_mfma_f32_16x16x32_bf16 v[124:127], a[92:95], v[36:39], v[124:127]
  s_waitcnt lgkmcnt(5)
  v_mfma_f32_16x16x32_bf16 v[96:99], a[96:99], v[40:43], v[96:99]
  s_add_u32 m0, s25, 6144
  ds_read_b128 v[32:35], v10 offset:49152
  v_mfma_f32_16x16x32_bf16 v[100:103], a[100:103], v[40:43], v[100:103]
  v_mfma_f32_16x16x32_bf16 v[112:115], a[104:107], v[40:43], v[112:115]
  buffer_load_dwordx4 v22, s[12:15], s19 offen lds
  v_mfma_f32_16x16x32_bf16 v[116:119], a[108:111], v[40:43], v[116:119]
  s_waitcnt lgkmcnt(5)
  v_mfma_f32_16x16x32_bf16 v[104:107], a[96:99], v[44:47], v[104:107]
  ds_read_b128 v[36:39], v11 offset:49152
  v_mfma_f32_16x16x32_bf16 v[108:111], a[100:103], v[44:47], v[108:111]
  v_mfma_f32_16x16x32_bf16 v[120:123], a[104:107], v[44:47], v[120:123]
  v_mfma_f32_16x16x32_bf16 v[124:127], a[108:111], v[44:47], v[124:127]
  s_waitcnt lgkmcnt(5)
  v_mfma_f32_16x16x32_bf16 v[96:99], a[112:115], v[48:51], v[96:99]
  s_add_u32 m0, s25, 7168
  ds_read_b128 v[40:43], v12 offset:49152
  v_mfma_f32_16x16x32_bf16 v[100:103], a[116:119], v[48:51], v[100:103]
  v_mfma_f32_16x16x32_bf16 v[112:115], a[120:123], v[48:51], v[112:115]
  buffer_load_dwordx4 v23, s[12:15], s19 offen lds
  v_mfma_f32_16x16x32_bf16 v[116:119], a[124:127], v[48:51], v[116:119]
  s_waitcnt lgkmcnt(5)
  v_mfma_f32_16x16x32_bf16 v[104:107], a[112:115], v[52:55], v[104:107]
  s_cmp_gt_u32 s23, 3
  ds_read_b128 v[44:47], v13 offset:49152
  v_mfma_f32_16x16x32_bf16 v[108:111], a[116:119], v[52:55], v[108:111]
  v_mfma_f32_16x16x32_bf16 v[120:123], a[120:123], v[52:55], v[120:123]
  s_cselect_b32 s26, s20, 0
  v_mfma_f32_16x16x32_bf16 v[124:127], a[124:127], v[52:55], v[124:127]
  s_waitcnt lgkmcnt(5)
  v_mfma_f32_16x16x32_bf16 v[96:99], a[128:131], v[24:27], v[96:99]
  s_add_u32 s19, s19, s26
  ds_read_b128 v[48:51], v14 offset:49152
  v_mfma_f32_16x16x32_bf16 v[100:103], a[132:135], v[24:27], v[100:103]
  v_mfma_f32_16x16x32_bf16 v[112:115], a[136:139], v[24:27], v[112:115]
  s_add_u32 s25, s25, 32768
  v_mfma_f32_16x16x32_bf16 v[116:119], a[140:143], v[24:27], v[116:119]
  s_waitcnt lgkmcnt(5)
  v_mfma_f32_16x16x32_bf16 v[104:107], a[128:131], v[28:31], v[104:107]
  s_and_b32 s25, s25, 0x1ffff
  ds_read_b128 v[52:55], v15 offset:49152
  v_mfma_f32_16x16x32_bf16 v[108:111], a[132:135], v[28:31], v[108:111]
  v_mfma_f32_16x16x32_bf16 v[120:123], a[136:139], v[28:31], v[120:123]
  buffer_store_dwordx4 v[128:131], v7, s[4:7], s21 offen offset:0 sc1
  v_mfma_f32_16x16x32_bf16 v[124:127], a[140:143], v[28:31], v[124:127]
  s_waitcnt lgkmcnt(5)
  v_mfma_f32_16x16x32_bf16 v[96:99], a[144:147], v[32:35], v[96:99]
  ds_read_b128 v[24:27], v8 offset:57344
  v_mfma_f32_16x16x32_bf16 v[100:103], a[148:151], v[32:35], v[100:103]
  v_mfma_f32_16x16x32_bf16 v[112:115], a[152:155], v[32:35], v[112:115]
  v_mfma_f32_16x16x32_bf16 v[116:119], a[156:159], v[32:35], v[116:119]
  s_waitcnt lgkmcnt(5)
  v_xor_b32 v8, 0x10000, v8
  v_mfma_f32_16x16x32_bf16 v[104:107], a[144:147], v[36:39], v[104:107]
  ds_read_b128 v[28:31], v9 offset:57344
  v_mfma_f32_16x16x32_bf16 v[108:111], a[148:151], v[36:39], v[108:111]
  v_mfma_f32_16x16x32_bf16 v[120:123], a[152:155], v[36:39], v[120:123]
  buffer_store_dwordx4 v[132:135], v7, s[4:7], s21 offen offset:256 sc1
  v_mfma_f32_16x16x32_bf16 v[124:127], a[156:159], v[36:39], v[124:127]
  s_waitcnt lgkmcnt(5)
  v_xor_b32 v9, 0x10000, v9
  v_mfma_f32_16x16x32_bf16 v[96:99], a[160:163], v[40:43], v[96:99]
  ds_read_b128 v[32:35], v10 offset:57344
  v_mfma_f32_16x16x32_bf16 v[100:103], a[164:167], v[40:43], v[100:103]
  v_mfma_f32_16x16x32_bf16 v[112:115], a[168:171], v[40:43], v[112:115]
  v_mfma_f32_16x16x32_bf16 v[116:119], a[172:175], v[40:43], v[116:119]
  s_waitcnt lgkmcnt(5)
  v_xor_b32 v10, 0x10000, v10
  v_mfma_f32_16x16x32_bf16 v[104:107], a[160:163], v[44:47], v[104:107]
  ds_read_b128 v[36:39], v11 offset:57344
  v_mfma_f32_16x16x32_bf16 v[108:111], a[164:167], v[44:47], v[108:111]
  v_mfma_f32_16x16x32_bf16 v[120:123], a[168:171], v[44:47], v[120:123]
  buffer_store_dwordx4 v[136:139], v7, s[4:7], s21 offen offset:2048 sc1
  v_mfma_f32_16x16x32_bf16 v[124:127], a[172:175], v[44:47], v[124:127]
  s_waitcnt lgkmcnt(5)
  v_xor_b32 v11, 0x10000, v11
  v_mfma_f32_16x16x32_bf16 v[96:99], a[176:179], v[48:51], v[96:99]
  ds_read_b128 v[40:43], v12 offset:57344
  v_mfma_f32_16x16x32_bf16 v[100:103], a[180:183], v[48:51], v[100:103]
  v_mfma_f32_16x16x32_bf16 v[112:115], a[184:187], v[48:51], v[112:115]
  v_mfma_f32_16x16x32_bf16 v[116:119], a[188:191], v[48:51], v[116:119]
  s_waitcnt lgkmcnt(5)
  v_xor_b32 v12, 0x10000, v12
  v_mfma_f32_16x16x32_bf16 v[104:107], a[176:179], v[52:55], v[104:107]
  ds_read_b128 v[44:47], v13 offset:57344
  v_mfma_f32_16x16x32_bf16 v[108:111], a[180:183], v[52:55], v[108:111]
  v_mfma_f32_16x16x32_bf16 v[120:123], a[184:187], v[52:55], v[120:123]
  buffer_store_dwordx4 v[140:143], v7, s[4:7], s21 offen offset:2304 sc1
  v_mfma_f32_16x16x32_bf16 v[124:127], a[188:191], v[52:55], v[124:127]
  s_waitcnt lgkmcnt(5)
  v_xor_b32 v13, 0x10000, v13
  v_mfma_f32_16x16x32_bf16 v[96:99], a[192:195], v[24:27], v[96:99]
  s_mov_b32 s21, s27
  ds_read_b128 v[48:51], v14 offset:57344
  v_mfma_f32_16x16x32_bf16 v[100:103], a[196:199], v[24:27], v[100:103]
  v_mov_b32 v7, v56
  v_mfma_f32_16x16x32_bf16 v[112:115], a[200:203], v[24:27], v[112:115]
  v_mfma_f32_16x16x32_bf16 v[116:119], a[204:207], v[24:27], v[116:119]
  s_waitcnt lgkmcnt(5)
  v_xor_b32 v14, 0x10000, v14
  v_mfma_f32_16x16x32_bf16 v[104:107], a[192:195], v[28:31], v[104:107]
  s_add_u32 s27, s27, s22
  ds_read_b128 v[52:55], v15 offset:57344
  v_mfma_f32_16x16x32_bf16 v[108:111], a[196:199], v[28:31], v[108:111]
  v_mfma_f32_16x16x32_bf16 v[120:123], a[200:203], v[28:31], v[120:123]
  s_waitcnt vmcnt(13)
  s_barrier
  v_mfma_f32_16x16x32_bf16 v[124:127], a[204:207], v[28:31], v[124:127]
  s_waitcnt lgkmcnt(5)
  v_xor_b32 v15, 0x10000, v15
  v_mfma_f32_16x16x32_bf16 v[96:99], a[208:211], v[32:35], v[96:99]
  ds_read_b128 v[24:27], v8 offset:0
  v_mfma_f32_16x16x32_bf16 v[100:103], a[212:215], v[32:35], v[100:103]
  v_mfma_f32_16x16x32_bf16 v[112:115], a[216:219], v[32:35], v[112:115]
  v_mfma_f32_16x16x32_bf16 v[116:119], a[220:223], v[32:35], v[116:119]
  s_waitcnt lgkmcnt(5)
  v_mfma_f32_16x16x32_bf16 v[104:107], a[208:211], v[36:39], v[104:107]
  s_add_u32 s29, s29, 1
  ds_read_b128 v[28:31], v9 offset:0
  v_mfma_f32_16x16x32_bf16 v[108:111], a[212:215], v[36:39], v[108:111]
  v_mfma_f32_16x16x32_bf16 v[120:123], a[216:219], v[36:39], v[120:123]
  s_max_i32 s30, s29, 0
  v_mfma_f32_16x16x32_bf16 v[124:127], a[220:223], v[36:39], v[124:127]
  s_waitcnt lgkmcnt(5)
  v_mov_b32 v144, s30
  v_mfma_f32_16x16x32_bf16 v[96:99], a[224:227], v[40:43], v[96:99]
  ds_read_b128 v[32:35], v10 offset:0
  v_mfma_f32_16x16x32_bf16 v[100:103], a[228:231], v[40:43], v[100:103]
  v_mfma_f32_16x16x32_bf16 v[112:115], a[232:235], v[40:43], v[112:115]
  buffer_store_dword v144, v145, s[4:7], s31 offen sc1
  v_mfma_f32_16x16x32_bf16 v[116:119], a[236:239], v[40:43], v[116:119]
  s_waitcnt lgkmcnt(5)
  v_mfma_f32_16x16x32_bf16 v[104:107], a[224:227], v[44:47], v[104:107]
  ds_read_b128 v[36:39], v11 offset:0
  v_mfma_f32_16x16x32_bf16 v[108:111], a[228:231], v[44:47], v[108:111]
  v_mfma_f32_16x16x32_bf16 v[120:123], a[232:235], v[44:47], v[120:123]
  v_mfma_f32_16x16x32_bf16 v[124:127], a[236:239], v[44:47], v[124:127]
  s_waitcnt lgkmcnt(5)
  v_mfma_f32_16x16x32_bf16 v[96:99], a[240:243], v[48:51], v[96:99]
  s_sub_u32 s23, s23, 1
  ds_read_b128 v[40:43], v12 offset:0
  v_mfma_f32_16x16x32_bf16 v[100:103], a[244:247], v[48:51], v[100:103]
  v_mfma_f32_16x16x32_bf16 v[112:115], a[248:251], v[48:51], v[112:115]
  v_mfma_f32_16x16x32_bf16 v[116:119], a[252:255], v[48:51], v[116:119]
  s_waitcnt lgkmcnt(5)
  v_mfma_f32_16x16x32_bf16 v[104:107], a[240:243], v[52:55], v[104:107]
  s_cmp_eq_u32 s23, 0
  ds_read_b128 v[44:47], v13 offset:0
  v_mfma_f32_16x16x32_bf16 v[108:111], a[244:247], v[52:55], v[108:111]
  v_mfma_f32_16x16x32_bf16 v[120:123], a[248:251], v[52:55], v[120:123]
  v_mfma_f32_16x16x32_bf16 v[124:127], a[252:255], v[52:55], v[124:127]
  s_cbranch_scc1 G_done1_6
  s_branch G_top_4
G_done0_5:
  s_nop 7
  s_nop 3
  v_cvt_pk_bf16_f32 v128, v64, v65
  v_cvt_pk_bf16_f32 v129, v66, v67
  v_cvt_pk_bf16_f32 v130, v68, v69
  v_cvt_pk_bf16_f32 v131, v70, v71
  buffer_store_dwordx4 v[128:131], v7, s[4:7], s21 offen offset:0 sc1
  v_cvt_pk_bf16_f32 v132, v72, v73
  v_cvt_pk_bf16_f32 v133, v74, v75
  v_cvt_pk_bf16_f32 v134, v76, v77
  v_cvt_pk_bf16_f32 v135, v78, v79
  buffer_store_dwordx4 v[132:135], v7, s[4:7], s21 offen offset:256 sc1
  v_cvt_pk_bf16_f32 v136, v80, v81
  v_cvt_pk_bf16_f32 v137, v82, v83
  v_cvt_pk_bf16_f32 v138, v84, v85
  v_cvt_pk_bf16_f32 v139, v86, v87
  buffer_store_dwordx4 v[136:139], v7, s[4:7], s21 offen offset:2048 sc1
  v_cvt_pk_bf16_f32 v140, v88, v89
  v_cvt_pk_bf16_f32 v141, v90, v91
  v_cvt_pk_bf16_f32 v142, v92, v93
  v_cvt_pk_bf16_f32 v143, v94, v95
  buffer_store_dwordx4 v[140:143], v7, s[4:7], s21 offen offset:2304 sc1
  s_branch G_fin_7
G_done1_6:
  s_nop 7
  s_nop 3
  v_cvt_pk_bf16_f32 v128, v96, v97
  v_cvt_pk_bf16_f32 v129, v98, v99
  v_cvt_pk_bf16_f32 v130, v100, v101
  v_cvt_pk_bf16_f32 v131, v102, v103
  buffer_store_dwordx4 v[128:131], v7, s[4:7], s21 offen offset:0 sc1
  v_cvt_pk_bf16_f32 v132, v104, v105
  v_cvt_pk_bf16_f32 v133, v106, v107
  v_cvt_pk_bf16_f32 v134, v108, v109
  v_cvt_pk_bf16_f32 v135, v110, v111
  buffer_store_dwordx4 v[132:135], v7, s[4:7], s21 offen offset:256 sc1
  v_cvt_pk_bf16_f32 v136, v112, v113
  v_cvt_pk_bf16_f32 v137, v114, v115
  v_cvt_pk_bf16_f32 v138, v116, v117
  v_cvt_pk_bf16_f32 v139, v118, v119
  buffer_store_dwordx4 v[136:139], v7, s[4:7], s21 offen offset:2048 sc1
  v_cvt_pk_bf16_f32 v140, v120, v121
  v_cvt_pk_bf16_f32 v141, v122, v123
  v_cvt_pk_bf16_f32 v142, v124, v125
  v_cvt_pk_bf16_f32 v143, v126, v127
  buffer_store_dwordx4 v[140:143], v7, s[4:7], s21 offen offset:2304 sc1
G_fin_7:
  s_waitcnt vmcnt(0) lgkmcnt(0)
  s_barrier
  s_add_u32 s30, s29, 2
  v_mov_b32 v144, s30
  v_min_u32 v145, 1, v0
  v_lshlrev_b32 v145, 30, v145
  buffer_store_dword v144, v145, s[4:7], s31 offen sc1
  s_branch P_end_2
P_q_3:
  s_mov_b32 s27, s21
  v_mov_b32 v7, 0x40000000
  s_mov_b32 s29, -2
  v_min_u32 v145, 1, v0
  v_lshlrev_b32 v145, 30, v145
  ds_read_b128 v[24:27], v8 offset:0
  ds_read_b128 v[28:31], v9 offset:0
  ds_read_b128 v[32:35], v10 offset:0
  ds_read_b128 v[36:39], v11 offset:0
  ds_read_b128 v[40:43], v12 offset:0
  ds_read_b128 v[44:47], v13 offset:0
.p2align 6
G_top_8:
  s_waitcnt lgkmcnt(5)
  v_mfma_f32_16x16x32_bf16 v[64:67], a[0:3], v[24:27], 0
  s_add_u32 m0, s25, 0
  ds_read_b128 v[48:51], v14 offset:0
  v_mfma_f32_16x16x32_bf16 v[68:71], a[4:7], v[24:27], 0
  v_mfma_f32_16x16x32_bf16 v[80:83], a[8:11], v[24:27], 0
  buffer_load_dwordx4 v16, s[12:15], s19 offen lds
  v_mfma_f32_16x16x32_bf16 v[84:87], a[12:15], v[24:27], 0
  s_waitcnt lgkmcnt(5)
  v_mfma_f32_16x16x32_bf16 v[72:75], a[0:3], v[28:31], 0
  ds_read_b128 v[52:55], v15 offset:0
  v_mfma_f32_16x16x32_bf16 v[76:79], a[4:7], v[28:31], 0
  v_mul_f32 v96, s24, v96
  v_mul_f32 v97, s24, v97
  v_mfma_f32_16x16x32_bf16 v[88:91], a[8:11], v[28:31], 0
  v_mfma_f32_16x16x32_bf16 v[92:95], a[12:15], v[28:31], 0
  s_waitcnt lgkmcnt(5)
  v_cvt_pk_bf16_f32 v128, v96, v97
  v_mul_f32 v98, s24, v98
  v_mfma_f32_16x16x32_bf16 v[64:67], a[16:19], v[32:35], v[64:67]
  s_add_u32 m0, s25, 1024
  ds_read_b128 v[24:27], v8 offset:8192
  v_mfma_f32_16x16x32_bf16 v[68:71], a[20:23], v[32:35], v[68:71]
  v_mul_f32 v99, s24, v99
  v_cvt_pk_bf16_f32 v129, v98, v99
  v_mfma_f32_16x16x32_bf16 v[80:83], a[24:27], v[32:35], v[80:83]
  buffer_load_dwordx4 v17, s[12:15], s19 offen lds
  v_mfma_f32_16x16x32_bf16 v[84:87], a[28:31], v[32:35], v[84:87]
  s_waitcnt lgkmcnt(5)
  v_mul_f32 v100, s24, v100
  v_mul_f32 v101, s24, v101
  v_mfma_f32_16x16x32_bf16 v[72:75], a[16:19], v[36:39], v[72:75]
  ds_read_b128 v[28:31], v9 offset:8192
  v_mfma_f32_16x16x32_bf16 v[76:79], a[20:23], v[36:39], v[76:79]
  v_cvt_pk_bf16_f32 v130, v100, v101
  v_mul_f32 v102, s24, v102
  v_mfma_f32_16x16x32_bf16 v[88:91], a[24:27], v[36:39], v[88:91]
  v_mfma_f32_16x16x32_bf16 v[92:95], a[28:31], v[36:39], v[92:95]
  s_waitcnt lgkmcnt(5)
  v_mul_f32 v103, s24, v103
  v_cvt_pk_bf16_f32 v131, v102, v103
  v_mfma_f32_16x16x32_bf16 v[64:67], a[32:35], v[40:43], v[64:67]
  s_add_u32 m0, s25, 2048
  ds_read_b128 v[32:35], v10 offset:8192
  v_mfma_f32_16x16x32_bf16 v[68:71], a[36:39], v[40:43], v[68:71]
  v_mul_f32 v104, s24, v104
  v_mul_f32 v105, s24, v105
  v_mfma_f32_16x16x32_bf16 v[80:83], a[40:43], v[40:43], v[80:83]
  buffer_load_dwordx4 v18, s[12:15], s19 offen lds
  v_mfma_f32_16x16x32_bf16 v[84:87], a[44:47], v[40:43], v[84:87]
  s_waitcnt lgkmcnt(5)
  v_cvt_pk_bf16_f32 v132, v104, v105
  v_mul_f32 v106, s24, v106
  v_mfma_f32_16x16x32_bf16 v[72:75], a[32:35], v[44:47], v[72:75]
  ds_read_b128 v[36:39], v11 offset:8192
  v_mfma_f32_16x16x32_bf16 v[76:79], a[36:39], v[44:47], v[76:79]
  v_mul_f32 v107, s24, v107
  v_cvt_pk_bf16_f32 v133, v106, v107
  v_mfma_f32_16x16x32_bf16 v[88:91], a[40:43], v[44:47], v[88:91]
  v_mfma_f32_16x16x32_bf16 v[92:95], a[44:47], v[44:47], v[92:95]
  s_waitcnt lgkmcnt(5)
  v_mul_f32 v108, s24, v108
  v_mul_f32 v109, s24, v109
  v_mfma_f32_16x16x32_bf16 v[64:67], a[48:51], v[48:51], v[64:67]
  s_add_u32 m0, s25, 3072
  ds_read_b128 v[40:43], v12 offset:8192
  v_mfma_f32_16x16x32_bf16 v[68:71], a[52:55], v[48:51], v[68:71]
  v_cvt_pk_bf16_f32 v134, v108, v109
  v_mul_f32 v110, s24, v110
  v_mfma_f32_16x16x32_bf16 v[80:83], a[56:59], v[48:51], v[80:83]
  buffer_load_dwordx4 v19, s[12:15], s19 offen lds
  v_mfma_f32_16x16x32_bf16 v[84:87], a[60:63], v[48:51], v[84:87]
  s_waitcnt lgkmcnt(5)
  v_mul_f32 v111, s24, v111
  v_cvt_pk_bf16_f32 v135, v110, v111
  v_mfma_f32_16x16x32_bf16 v[72:75], a[48:51], v[52:55], v[72:75]
  ds_read_b128 v[44:47], v13 offset:8192
  v_mfma_f32_16x16x32_bf16 v[76:79], a[52:55], v[52:55], v[76:79]
  v_mul_f32 v112, s24, v112
  v_mul_f32 v113, s24, v113
  v_mfma_f32_16x16x32_bf16 v[88:91], a[56:59], v[52:55], v[88:91]
  v_mfma_f32_16x16x32_bf16 v[92:95], a[60:63], v[52:55], v[92:95]
  s_waitcnt lgkmcnt(5)
  v_cvt_pk_bf16_f32 v136, v112, v113
  v_mul_f32 v114, s24, v114
  v_mfma_f32_16x16x32_bf16 v[64:67], a[64:67], v[24:27], v[64:67]
  s_add_u32 m0, s25, 4096
  ds_read_b128 v[48:51], v14 offset:8192
  v_mfma_f32_16x16x32_bf16 v[68:71], a[68:71], v[24:27], v[68:71]
  v_mul_f32 v115, s24, v115
  v_cvt_pk_bf16_f32 v137, v114, v115
  v_mfma_f32_16x16x32_bf16 v[80:83], a[72:75], v[24:27], v[80:83]
  buffer_load_dwordx4 v20, s[12:15], s19 offen lds
  v_mfma_f32_16x16x32_bf16 v[84:87], a[76:79], v[24:27], v[84:87]
  s_waitcnt lgkmcnt(5)
  v_mul_f32 v116, s24, v116
  v_mul_f32 v117, s24, v117
  v_mfma_f32_16x16x32_bf16 v[72:75], a[64:67], v[28:31], v[72:75]
  ds_read_b128 v[52:55], v15 offset:8192
  v_mfma_f32_16x16x32_bf16 v[76:79], a[68:71], v[28:31], v[76:79]
  v_cvt_pk_bf16_f32 v138, v116, v117
  v_mul_f32 v118, s24, v118
  v_mfma_f32_16x16x32_bf16 v[88:91], a[72:75], v[28:31], v[88:91]
  v_mfma_f32_16x16x32_bf16 v[92:95], a[76:79], v[28:31], v[92:95]
  s_waitcnt lgkmcnt(5)
  v_mul_f32 v119, s24, v119
  v_cvt_pk_bf16_f32 v139, v118, v119
  v_mfma_f32_16x16x32_bf16 v[64:67], a[80:83], v[32:35], v[64:67]
  s_add_u32 m0, s25, 5120
  ds_read_b128 v[24:27], v8 offset:16384
  v_mfma_f32_16x16x32_bf16 v[68:71], a[84:87], v[32:35], v[68:71]
  v_mul_f32 v120, s24, v120
  v_mul_f32 v121, s24, v121
  v_mfma_f32_16x16x32_bf16 v[80:83], a[88:91], v[32:35], v[80:83]
  buffer_load_dwordx4 v21, s[12:15], s19 offen lds
  v_mfma_f32_16x16x32_bf16 v[84:87], a[92:95], v[32:35], v[84:87]
  s_waitcnt lgkmcnt(5)
  v_cvt_pk_bf16_f32 v140, v120, v121
  v_mul_f32 v122, s24, v122
  v_mfma_f32_16x16x32_bf16 v[72:75], a[80:83], v[36:39], v[72:75]
  ds_read_b128 v[28:31], v9 offset:16384
  v_mfma_f32_16x16x32_bf16 v[76:79], a[84:87], v[36:39], v[76:79]
  v_mul_f32 v123, s24, v123
  v_cvt_pk_bf16_f32 v141, v122, v123
  v_mfma_f32_16x16x32_bf16 v[88:91], a[88:91], v[36:39], v[88:91]
  v_mfma_f32_16x16x32_bf16 v[92:95], a[92:95], v[36:39], v[92:95]
  s_waitcnt lgkmcnt(5)
  v_mul_f32 v124, s24, v124
  v_mul_f32 v125, s24, v125
  v_mfma_f32_16x16x32_bf16 v[64:67], a[96:99], v[40:43], v[64:67]
  s_add_u32 m0, s25, 6144
  ds_read_b128 v[32:35], v10 offset:16384
  v_mfma_f32_16x16x32_bf16 v[68:71], a[100:103], v[40:43], v[68:71]
  v_cvt_pk_bf16_f32 v142, v124, v125
  v_mul_f32 v126, s24, v126
  v_mfma_f32_16x16x32_bf16 v[80:83], a[104:107], v[40:43], v[80:83]
  buffer_load_dwordx4 v22, s[12:15], s19 offen lds
  v_mfma_f32_16x16x32_bf16 v[84:87], a[108:111], v[40:43], v[84:87]
  s_waitcnt lgkmcnt(5)
  v_mul_f32 v127, s24, v127
  v_cvt_pk_bf16_f32 v143, v126, v127
  v_mfma_f32_16x16x32_bf16 v[72:75], a[96:99], v[44:47], v[72:75]
  ds_read_b128 v[36:39], v11 offset:16384
  v_mfma_f32_16x16x32_bf16 v[76:79], a[100:103], v[44:47], v[76:79]
  v_mfma_f32_16x16x32_bf16 v[88:91], a[104:107], v[44:47], v[88:91]
  v_mfma_f32_16x16x32_bf16 v[92:95], a[108:111], v[44:47], v[92:95]
  s_waitcnt lgkmcnt(5)
  v_mfma_f32_16x16x32_bf16 v[64:67], a[112:115], v[48:51], v[64:67]
  s_add_u32 m0, s25, 7168
  ds_read_b128 v[40:43], v12 offset:16384
  v_mfma_f32_16x16x32_bf16 v[68:71], a[116:119], v[48:51], v[68:71]
  v_mfma_f32_16x16x32_bf16 v[80:83], a[120:123], v[48:51], v[80:83]
  buffer_load_dwordx4 v23, s[12:15], s19 offen lds
  v_mfma_f32_16x16x32_bf16 v[84:87], a[124:127], v[48:51], v[84:87]
  s_waitcnt lgkmcnt(5)
  v_mfma_f32_16x16x32_bf16 v[72:75], a[112:115], v[52:55], v[72:75]
  s_cmp_gt_u32 s23, 3
  ds_read_b128 v[44:47], v13 offset:16384
  v_mfma_f32_16x16x32_bf16 v[76:79], a[116:119], v[52:55], v[76:79]
  v_mfma_f32_16x16x32_bf16 v[88:91], a[120:123], v[52:55], v[88:91]
  s_cselect_b32 s26, s20, 0
  v_mfma_f32_16x16x32_bf16 v[92:95], a[124:127], v[52:55], v[92:95]
  s_waitcnt lgkmcnt(5)
  v_mfma_f32_16x16x32_bf16 v[64:67], a[128:131], v[24:27], v[64:67]
  s_add_u32 s19, s19, s26
  ds_read_b128 v[48:51], v14 offset:16384
  v_mfma_f32_16x16x32_bf16 v[68:71], a[132:135], v[24:27], v[68:71]
  v_mfma_f32_16x16x32_bf16 v[80:83], a[136:139], v[24:27], v[80:83]
  s_add_u32 s25, s25, 32768
  v_mfma_f32_16x16x32_bf16 v[84:87], a[140:143], v[24:27], v[84:87]
  s_waitcnt lgkmcnt(5)
  v_mfma_f32_16x16x32_bf16 v[72:75], a[128:131], v[28:31], v[72:75]
  s_and_b32 s25, s25, 0x1ffff
  ds_read_b128 v[52:55], v15 offset:16384
  v_mfma_f32_16x16x32_bf16 v[76:79], a[132:135], v[28:31], v[76:79]
  v_mfma_f32_16x16x32_bf16 v[88:91], a[136:139], v[28:31], v[88:91]
  buffer_store_dwordx4 v[128:131], v7, s[4:7], s21 offen offset:0 sc1
  v_mfma_f32_16x16x32_bf16 v[92:95], a[140:143], v[28:31], v[92:95]
  s_waitcnt lgkmcnt(5)
  v_mfma_f32_16x16x32_bf16 v[64:67], a[144:147], v[32:35], v[64:67]
  ds_read_b128 v[24:27], v8 offset:24576
  v_mfma_f32_16x16x32_bf16 v[68:71], a[148:151], v[32:35], v[68:71]
  v_mfma_f32_16x16x32_bf16 v[80:83], a[152:155], v[32:35], v[80:83]
  v_mfma_f32_16x16x32_bf16 v[84:87], a[156:159], v[32:35], v[84:87]
  s_waitcnt lgkmcnt(5)
  v_mfma_f32_16x16x32_bf16 v[72:75], a[144:147], v[36:39], v[72:75]
  ds_read_b128 v[28:31], v9 offset:24576
  v_mfma_f32_16x16x32_bf16 v[76:79], a[148:151], v[36:39], v[76:79]
  v_mfma_f32_16x16x32_bf16 v[88:91], a[152:155], v[36:39], v[88:91]
  buffer_store_dwordx4 v[132:135], v7, s[4:7], s21 offen offset:256 sc1
  v_mfma_f32_16x16x32_bf16 v[92:95], a[156:159], v[36:39], v[92:95]
  s_waitcnt lgkmcnt(5)
  v_mfma_f32_16x16x32_bf16 v[64:67], a[160:163], v[40:43], v[64:67]
  ds_read_b128 v[32:35], v10 offset:24576
  v_mfma_f32_16x16x32_bf16 v[68:71], a[164:167], v[40:43], v[68:71]
  v_mfma_f32_16x16x32_bf16 v[80:83], a[168:171], v[40:43], v[80:83]
  v_mfma_f32_16x16x32_bf16 v[84:87], a[172:175], v[40:43], v[84:87]
  s_waitcnt lgkmcnt(5)
  v_mfma_f32_16x16x32_bf16 v[72:75], a[160:163], v[44:47], v[72:75]
  ds_read_b128 v[36:39], v11 offset:24576
  v_mfma_f32_16x16x32_bf16 v[76:79], a[164:167], v[44:47], v[76:79]
  v_mfma_f32_16x16x32_bf16 v[88:91], a[168:171], v[44:47], v[88:91]
  buffer_store_dwordx4 v[136:139], v7, s[4:7], s21 offen offset:2048 sc1
  v_mfma_f32_16x16x32_bf16 v[92:95], a[172:175], v[44:47], v[92:95]
  s_waitcnt lgkmcnt(5)
  v_mfma_f32_16x16x32_bf16 v[64:67], a[176:179], v[48:51], v[64:67]
  ds_read_b128 v[40:43], v12 offset:24576
  v_mfma_f32_16x16x32_bf16 v[68:71], a[180:183], v[48:51], v[68:71]
  v_mfma_f32_16x16x32_bf16 v[80:83], a[184:187], v[48:51], v[80:83]
  v_mfma_f32_16x16x32_bf16 v[84:87], a[188:191], v[48:51], v[84:87]
  s_waitcnt lgkmcnt(5)
  v_mfma_f32_16x16x32_bf16 v[72:75], a[176:179], v[52:55], v[72:75]
  ds_read_b128 v[44:47], v13 offset:24576
  v_mfma_f32_16x16x32_bf16 v[76:79], a[180:183], v[52:55], v[76:79]
  v_mfma_f32_16x16x32_bf16 v[88:91], a[184:187], v[52:55], v[88:91]
  buffer_store_dwordx4 v[140:143], v7, s[4:7], s21 offen offset:2304 sc1
  v_mfma_f32_16x16x32_bf16 v[92:95], a[188:191], v[52:55], v[92:95]
  s_waitcnt lgkmcnt(5)
  v_mfma_f32_16x16x32_bf16 v[64:67], a[192:195], v[24:27], v[64:67]
  s_mov_b32 s21, s27
  ds_read_b128 v[48:51], v14 offset:24576
  v_mfma_f32_16x16x32_bf16 v[68:71], a[196:199], v[24:27], v[68:71]
  v_mov_b32 v7, v56
  v_mfma_f32_16x16x32_bf16 v[80:83], a[200:203], v[24:27], v[80:83]
  v_mfma_f32_16x16x32_bf16 v[84:87], a[204:207], v[24:27], v[84:87]
  s_waitcnt lgkmcnt(5)
  v_mfma_f32_16x16x32_bf16 v[72:75], a[192:195], v[28:31], v[72:75]
  s_add_u32 s27, s27, s22
  ds_read_b128 v[52:55], v15 offset:24576
  v_mfma_f32_16x16x32_bf16 v[76:79], a[196:199], v[28:31], v[76:79]
  v_mfma_f32_16x16x32_bf16 v[88:91], a[200:203], v[28:31], v[88:91]
  s_waitcnt vmcnt(13)
  s_barrier
  v_mfma_f32_16x16x32_bf16 v[92:95], a[204:207], v[28:31], v[92:95]
  s_waitcnt lgkmcnt(5)
  v_mfma_f32_16x16x32_bf16 v[64:67], a[208:211], v[32:35], v[64:67]
  ds_read_b128 v[24:27], v8 offset:32768
  v_mfma_f32_16x16x32_bf16 v[68:71], a[212:215], v[32:35], v[68:71]
  v_mfma_f32_16x16x32_bf16 v[80:83], a[216:219], v[32:35], v[80:83]
  v_mfma_f32_16x16x32_bf16 v[84:87], a[220:223], v[32:35], v[84:87]
  s_waitcnt lgkmcnt(5)
  v_mfma_f32_16x16x32_bf16 v[72:75], a[208:211], v[36:39], v[72:75]
  s_add_u32 s29, s29, 1
  ds_read_b128 v[28:31], v9 offset:32768
  v_mfma_f32_16x16x32_bf16 v[76:79], a[212:215], v[36:39], v[76:79]
  v_mfma_f32_16x16x32_bf16 v[88:91], a[216:219], v[36:39], v[88:91]
  s_max_i32 s30, s29, 0
  v_mfma_f32_16x16x32_bf16 v[92:95], a[220:223], v[36:39], v[92:95]
  s_waitcnt lgkmcnt(5)
  v_mov_b32 v144, s30
  v_mfma_f32_16x16x32_bf16 v[64:67], a[224:227], v[40:43], v[64:67]
  ds_read_b128 v[32:35], v10 offset:32768
  v_mfma_f32_16x16x32_bf16 v[68:71], a[228:231], v[40:43], v[68:71]
  v_mfma_f32_16x16x32_bf16 v[80:83], a[232:235], v[40:43], v[80:83]
  buffer_store_dword v144, v145, s[4:7], s31 offen sc1
  v_mfma_f32_16x16x32_bf16 v[84:87], a[236:239], v[40:43], v[84:87]
  s_waitcnt lgkmcnt(5)
  v_mfma_f32_16x16x32_bf16 v[72:75], a[224:227], v[44:47], v[72:75]
  ds_read_b128 v[36:39], v11 offset:32768
  v_mfma_f32_16x16x32_bf16 v[76:79], a[228:231], v[44:47], v[76:79]
  v_mfma_f32_16x16x32_bf16 v[88:91], a[232:235], v[44:47], v[88:91]
  v_mfma_f32_16x16x32_bf16 v[92:95], a[236:239], v[44:47], v[92:95]
  s_waitcnt lgkmcnt(5)
  v_mfma_f32_16x16x32_bf16 v[64:67], a[240:243], v[48:51], v[64:67]
  s_sub_u32 s23, s23, 1
  ds_read_b128 v[40:43], v12 offset:32768
  v_mfma_f32_16x16x32_bf16 v[68:71], a[244:247], v[48:51], v[68:71]
  v_mfma_f32_16x16x32_bf16 v[80:83], a[248:251], v[48:51], v[80:83]
  v_mfma_f32_16x16x32_bf16 v[84:87], a[252:255], v[48:51], v[84:87]
  s_waitcnt lgkmcnt(5)
  v_mfma_f32_16x16x32_bf16 v[72:75], a[240:243], v[52:55], v[72:75]
  s_cmp_eq_u32 s23, 0
  ds_read_b128 v[44:47], v13 offset:32768
  v_mfma_f32_16x16x32_bf16 v[76:79], a[244:247], v[52:55], v[76:79]
  v_mfma_f32_16x16x32_bf16 v[88:91], a[248:251], v[52:55], v[88:91]
  v_mfma_f32_16x16x32_bf16 v[92:95], a[252:255], v[52:55], v[92:95]
  s_cbranch_scc1 G_done0_9
  s_waitcnt lgkmcnt(5)
  v_mfma_f32_16x16x32_bf16 v[96:99], a[0:3], v[24:27], 0
  s_add_u32 m0, s25, 0
  ds_read_b128 v[48:51], v14 offset:32768
  v_mfma_f32_16x16x32_bf16 v[100:103], a[4:7], v[24:27], 0
  v_mfma_f32_16x16x32_bf16 v[112:115], a[8:11], v[24:27], 0
  buffer_load_dwordx4 v16, s[12:15], s19 offen lds
  v_mfma_f32_16x16x32_bf16 v[116:119], a[12:15], v[24:27], 0
  s_waitcnt lgkmcnt(5)
  v_mfma_f32_16x16x32_bf16 v[104:107], a[0:3], v[28:31], 0
  ds_read_b128 v[52:55], v15 offset:32768
  v_mfma_f32_16x16x32_bf16 v[108:111], a[4:7], v[28:31], 0
  v_mul_f32 v64, s24, v64
  v_mul_f32 v65, s24, v65
  v_mfma_f32_16x16x32_bf16 v[120:123], a[8:11], v[28:31], 0
  v_mfma_f32_16x16x32_bf16 v[124:127], a[12:15], v[28:31], 0
  s_waitcnt lgkmcnt(5)
  v_cvt_pk_bf16_f32 v128, v64, v65
  v_mul_f32 v66, s24, v66
  v_mfma_f32_16x16x32_bf16 v[96:99], a[16:19], v[32:35], v[96:99]
  s_add_u32 m0, s25, 1024
  ds_read_b128 v[24:27], v8 offset:40960
  v_mfma_f32_16x16x32_bf16 v[100:103], a[20:23], v[32:35], v[100:103]
  v_mul_f32 v67, s24, v67
  v_cvt_pk_bf16_f32 v129, v66, v67
  v_mfma_f32_16x16x32_bf16 v[112:115], a[24:27], v[32:35], v[112:115]
  buffer_load_dwordx4 v17, s[12:15], s19 offen lds
  v_mfma_f32_16x16x32_bf16 v[116:119], a[28:31], v[32:35], v[116:119]
  s_waitcnt lgkmcnt(5)
  v_mul_f32 v68, s24, v68
  v_mul_f32 v69, s24, v69
  v_mfma_f32_16x16x32_bf16 v[104:107], a[16:19], v[36:39], v[104:107]
  ds_read_b128 v[28:31], v9 offset:40960
  v_mfma_f32_16x16x32_bf16 v[108:111], a[20:23], v[36:39], v[108:111]
  v_cvt_pk_bf16_f32 v130, v68, v69
  v_mul_f32 v70, s24, v70
  v_mfma_f32_16x16x32_bf16 v[120:123], a[24:27], v[36:39], v[120:123]
  v_mfma_f32_16x16x32_bf16 v[124:127], a[28:31], v[36:39], v[124:127]
  s_waitcnt lgkmcnt(5)
  v_mul_f32 v71, s24, v71
  v_cvt_pk_bf16_f32 v131, v70, v71
  v_mfma_f32_16x16x32_bf16 v[96:99], a[32:35], v[40:43], v[96:99]
  s_add_u32 m0, s25, 2048
  ds_read_b128 v[32:35], v10 offset:40960
  v_mfma_f32_16x16x32_bf16 v[100:103], a[36:39], v[40:43], v[100:103]
  v_mul_f32 v72, s24, v72
  v_mul_f32 v73, s24, v73
  v_mfma_f32_16x16x32_bf16 v[112:115], a[40:43], v[40:43], v[112:115]
  buffer_load_dwordx4 v18, s[12:15], s19 offen lds
  v_mfma_f32_16x16x32_bf16 v[116:119], a[44:47], v[40:43], v[116:119]
  s_waitcnt lgkmcnt(5)
  v_cvt_pk_bf16_f32 v132, v72, v73
  v_mul_f32 v74, s24, v74
  v_mfma_f32_16x16x32_bf16 v[104:107], a[32:35], v[44:47], v[104:107]
  ds_read_b128 v[36:39], v11 offset:40960
  v_mfma_f32_16x16x32_bf16 v[108:111], a[36:39], v[44:47], v[108:111]
  v_mul_f32 v75, s24, v75
  v_cvt_pk_bf16_f32 v133, v74, v75
  v_mfma_f32_16x16x32_bf16 v[120:123], a[40:43], v[44:47], v[120:123]
  v_mfma_f32_16x16x32_bf16 v[124:127], a[44:47], v[44:47], v[124:127]
  s_waitcnt lgkmcnt(5)
  v_mul_f32 v76, s24, v76
  v_mul_f32 v77, s24, v77
  v_mfma_f32_16x16x32_bf16 v[96:99], a[48:51], v[48:51], v[96:99]
  s_add_u32 m0, s25, 3072
  ds_read_b128 v[40:43], v12 offset:40960
  v_mfma_f32_16x16x32_bf16 v[100:103], a[52:55], v[48:51], v[100:103]
  v_cvt_pk_bf16_f32 v134, v76, v77
  v_mul_f32 v78, s24, v78
  v_mfma_f32_16x16x32_bf16 v[112:115], a[56:59], v[48:51], v[112:115]
  buffer_load_dwordx4 v19, s[12:15], s19 offen lds
  v_mfma_f32_16x16x32_bf16 v[116:119], a[60:63], v[48:51], v[116:119]
  s_waitcnt lgkmcnt(5)
  v_mul_f32 v79, s24, v79
  v_cvt_pk_bf16_f32 v135, v78, v79
  v_mfma_f32_16x16x32_bf16 v[104:107], a[48:51], v[52:55], v[104:107]
  ds_read_b128 v[44:47], v13 offset:40960
  v_mfma_f32_16x16x32_bf16 v[108:111], a[52:55], v[52:55], v[108:111]
  v_mul_f32 v80, s24, v80
  v_mul_f32 v81, s24, v81
  v_mfma_f32_16x16x32_bf16 v[120:123], a[56:59], v[52:55], v[120:123]
  v_mfma_f32_16x16x32_bf16 v[124:127], a[60:63], v[52:55], v[124:127]
  s_waitcnt lgkmcnt(5)
  v_cvt_pk_bf16_f32 v136, v80, v81
  v_mul_f32 v82, s24, v82
  v_mfma_f32_16x16x32_bf16 v[96:99], a[64:67], v[24:27], v[96:99]
  s_add_u32 m0, s25, 4096
  ds_read_b128 v[48:51], v14 offset:40960
  v_mfma_f32_16x16x32_bf16 v[100:103], a[68:71], v[24:27], v[100:103]
  v_mul_f32 v83, s24, v83
  v_cvt_pk_bf16_f32 v137, v82, v83
  v_mfma_f32_16x16x32_bf16 v[112:115], a[72:75], v[24:27], v[112:115]
  buffer_load_dwordx4 v20, s[12:15], s19 offen lds
  v_mfma_f32_16x16x32_bf16 v[116:119], a[76:79], v[24:27], v[116:119]
  s_waitcnt lgkmcnt(5)
  v_mul_f32 v84, s24, v84
  v_mul_f32 v85, s24, v85
  v_mfma_f32_16x16x32_bf16 v[104:107], a[64:67], v[28:31], v[104:107]
  ds_read_b128 v[52:55], v15 offset:40960
  v_mfma_f32_16x16x32_bf16 v[108:111], a[68:71], v[28:31], v[108:111]
  v_cvt_pk_bf16_f32 v138, v84, v85
  v_mul_f32 v86, s24, v86
  v_mfma_f32_16x16x32_bf16 v[120:123], a[72:75], v[28:31], v[120:123]
  v_mfma_f32_16x16x32_bf16 v[124:127], a[76:79], v[28:31], v[124:127]
  s_waitcnt lgkmcnt(5)
  v_mul_f32 v87, s24, v87
  v_cvt_pk_bf16_f32 v139, v86, v87
  v_mfma_f32_16x16x32_bf16 v[96:99], a[80:83], v[32:35], v[96:99]
  s_add_u32 m0, s25, 5120
  ds_read_b128 v[24:27], v8 offset:49152
  v_mfma_f32_16x16x32_bf16 v[100:103], a[84:87], v[32:35], v[100:103]
  v_mul_f32 v88, s24, v88
  v_mul_f32 v89, s24, v89
  v_mfma_f32_16x16x32_bf16 v[112:115], a[88:91], v[32:35], v[112:115]
  buffer_load_dwordx4 v21, s[12:15], s19 offen lds
  v_mfma_f32_16x16x32_bf16 v[116:119], a[92:95], v[32:35], v[116:119]
  s_waitcnt lgkmcnt(5)
  v_cvt_pk_bf16_f32 v140, v88, v89
  v_mul_f32 v90, s24, v90
  v_mfma_f32_16x16x32_bf16 v[104:107], a[80:83], v[36:39], v[104:107]
  ds_read_b128 v[28:31], v9 offset:49152
  v_mfma_f32_16x16x32_bf16 v[108:111], a[84:87], v[36:39], v[108:111]
  v_mul_f32 v91, s24, v91
  v_cvt_pk_bf16_f32 v141, v90, v91
  v_mfma_f32_16x16x32_bf16 v[120:123], a[88:91], v[36:39], v[120:123]
  v_mfma_f32_16x16x32_bf16 v[124:127], a[92:95], v[36:39], v[124:127]
  s_waitcnt lgkmcnt(5)
  v_mul_f32 v92, s24, v92
  v_mul_f32 v93, s24, v93
  v_mfma_f32_16x16x32_bf16 v[96:99], a[96:99], v[40:43], v[96:99]
  s_add_u32 m0, s25, 6144
  ds_read_b128 v[32:35], v10 offset:49152
  v_mfma_f32_16x16x32_bf16 v[100:103], a[100:103], v[40:43], v[100:103]
  v_cvt_pk_bf16_f32 v142, v92, v93
  v_mul_f32 v94, s24, v94
  v_mfma_f32_16x16x32_bf16 v[112:115], a[104:107], v[40:43], v[112:115]
  buffer_load_dwordx4 v22, s[12:15], s19 offen lds
  v_mfma_f32_16x16x32_bf16 v[116:119], a[108:111], v[40:43], v[116:119]
  s_waitcnt lgkmcnt(5)
  v_mul_f32 v95, s24, v95
  v_cvt_pk_bf16_f32 v143, v94, v95
  v_mfma_f32_16x16x32_bf16 v[104:107], a[96:99], v[44:47], v[104:107]
  ds_read_b128 v[36:39], v11 offset:49152
  v_mfma_f32_16x16x32_bf16 v[108:111], a[100:103], v[44:47], v[108:111]
  v_mfma_f32_16x16x32_bf16 v[120:123], a[104:107], v[44:47], v[120:123]
  v_mfma_f32_16x16x32_bf16 v[124:127], a[108:111], v[44:47], v[124:127]
  s_waitcnt lgkmcnt(5)
  v_mfma_f32_16x16x32_bf16 v[96:99], a[112:115], v[48:51], v[96:99]
  s_add_u32 m0, s25, 7168
  ds_read_b128 v[40:43], v12 offset:49152
  v_mfma_f32_16x16x32_bf16 v[100:103], a[116:119], v[48:51], v[100:103]
  v_mfma_f32_16x16x32_bf16 v[112:115], a[120:123], v[48:51], v[112:115]
  buffer_load_dwordx4 v23, s[12:15], s19 offen lds
  v_mfma_f32_16x16x32_bf16 v[116:119], a[124:127], v[48:51], v[116:119]
  s_waitcnt lgkmcnt(5)
  v_mfma_f32_16x16x32_bf16 v[104:107], a[112:115], v[52:55], v[104:107]
  s_cmp_gt_u32 s23, 3
  ds_read_b128 v[44:47], v13 offset:49152
  v_mfma_f32_16x16x32_bf16 v[108:111], a[116:119], v[52:55], v[108:111]
  v_mfma_f32_16x16x32_bf16 v[120:123], a[120:123], v[52:55], v[120:123]
  s_cselect_b32 s26, s20, 0
  v_mfma_f32_16x16x32_bf16 v[124:127], a[124:127], v[52:55], v[124:127]
  s_waitcnt lgkmcnt(5)
  v_mfma_f32_16x16x32_bf16 v[96:99], a[128:131], v[24:27], v[96:99]
  s_add_u32 s19, s19, s26
  ds_read_b128 v[48:51], v14 offset:49152
  v_mfma_f32_16x16x32_bf16 v[100:103], a[132:135], v[24:27], v[100:103]
  v_mfma_f32_16x16x32_bf16 v[112:115], a[136:139], v[24:27], v[112:115]
  s_add_u32 s25, s25, 32768
  v_mfma_f32_16x16x32_bf16 v[116:119], a[140:143], v[24:27], v[116:119]
  s_waitcnt lgkmcnt(5)
  v_mfma_f32_16x16x32_bf16 v[104:107], a[128:131], v[28:31], v[104:107]
  s_and_b32 s25, s25, 0x1ffff
  ds_read_b128 v[52:55], v15 offset:49152
  v_mfma_f32_16x16x32_bf16 v[108:111], a[132:135], v[28:31], v[108:111]
  v_mfma_f32_16x16x32_bf16 v[120:123], a[136:139], v[28:31], v[120:123]
  buffer_store_dwordx4 v[128:131], v7, s[4:7], s21 offen offset:0 sc1
  v_mfma_f32_16x16x32_bf16 v[124:127], a[140:143], v[28:31], v[124:127]
  s_waitcnt lgkmcnt(5)
  v_mfma_f32_16x16x32_bf16 v[96:99], a[144:147], v[32:35], v[96:99]
  ds_read_b128 v[24:27], v8 offset:57344
  v_mfma_f32_16x16x32_bf16 v[100:103], a[148:151], v[32:35], v[100:103]
  v_mfma_f32_16x16x32_bf16 v[112:115], a[152:155], v[32:35], v[112:115]
  v_mfma_f32_16x16x32_bf16 v[116:119], a[156:159], v[32:35], v[116:119]
  s_waitcnt lgkmcnt(5)
  v_xor_b32 v8, 0x10000, v8
  v_mfma_f32_16x16x32_bf16 v[104:107], a[144:147], v[36:39], v[104:107]
  ds_read_b128 v[28:31], v9 offset:57344
  v_mfma_f32_16x16x32_bf16 v[108:111], a[148:151], v[36:39], v[108:111]
  v_mfma_f32_16x16x32_bf16 v[120:123], a[152:155], v[36:39], v[120:123]
  buffer_store_dwordx4 v[132:135], v7, s[4:7], s21 offen offset:256 sc1
  v_mfma_f32_16x16x32_bf16 v[124:127], a[156:159], v[36:39], v[124:127]
  s_waitcnt lgkmcnt(5)
  v_xor_b32 v9, 0x10000, v9
  v_mfma_f32_16x16x32_bf16 v[96:99], a[160:163], v[40:43], v[96:99]
  ds_read_b128 v[32:35], v10 offset:57344
  v_mfma_f32_16x16x32_bf16 v[100:103], a[164:167], v[40:43], v[100:103]
  v_mfma_f32_16x16x32_bf16 v[112:115], a[168:171], v[40:43], v[112:115]
  v_mfma_f32_16x16x32_bf16 v[116:119], a[172:175], v[40:43], v[116:119]
  s_waitcnt lgkmcnt(5)
  v_xor_b32 v10, 0x10000, v10
  v_mfma_f32_16x16x32_bf16 v[104:107], a[160:163], v[44:47], v[104:107]
  ds_read_b128 v[36:39], v11 offset:57344
  v_mfma_f32_16x16x32_bf16 v[108:111], a[164:167], v[44:47], v[108:111]
  v_mfma_f32_16x16x32_bf16 v[120:123], a[168:171], v[44:47], v[120:123]
  buffer_store_dwordx4 v[136:139], v7, s[4:7], s21 offen offset:2048 sc1
  v_mfma_f32_16x16x32_bf16 v[124:127], a[172:175], v[44:47], v[124:127]
  s_waitcnt lgkmcnt(5)
  v_xor_b32 v11, 0x10000, v11
  v_mfma_f32_16x16x32_bf16 v[96:99], a[176:179], v[48:51], v[96:99]
  ds_read_b128 v[40:43], v12 offset:57344
  v_mfma_f32_16x16x32_bf16 v[100:103], a[180:183], v[48:51], v[100:103]
  v_mfma_f32_16x16x32_bf16 v[112:115], a[184:187], v[48:51], v[112:115]
  v_mfma_f32_16x16x32_bf16 v[116:119], a[188:191], v[48:51], v[116:119]
  s_waitcnt lgkmcnt(5)
  v_xor_b32 v12, 0x10000, v12
  v_mfma_f32_16x16x32_bf16 v[104:107], a[176:179], v[52:55], v[104:107]
  ds_read_b128 v[44:47], v13 offset:57344
  v_mfma_f32_16x16x32_bf16 v[108:111], a[180:183], v[52:55], v[108:111]
  v_mfma_f32_16x16x32_bf16 v[120:123], a[184:187], v[52:55], v[120:123]
  buffer_store_dwordx4 v[140:143], v7, s[4:7], s21 offen offset:2304 sc1
  v_mfma_f32_16x16x32_bf16 v[124:127], a[188:191], v[52:55], v[124:127]
  s_waitcnt lgkmcnt(5)
  v_xor_b32 v13, 0x10000, v13
  v_mfma_f32_16x16x32_bf16 v[96:99], a[192:195], v[24:27], v[96:99]
  s_mov_b32 s21, s27
  ds_read_b128 v[48:51], v14 offset:57344
  v_mfma_f32_16x16x32_bf16 v[100:103], a[196:199], v[24:27], v[100:103]
  v_mov_b32 v7, v56
  v_mfma_f32_16x16x32_bf16 v[112:115], a[200:203], v[24:27], v[112:115]
  v_mfma_f32_16x16x32_bf16 v[116:119], a[204:207], v[24:27], v[116:119]
  s_waitcnt lgkmcnt(5)
  v_xor_b32 v14, 0x10000, v14
  v_mfma_f32_16x16x32_bf16 v[104:107], a[192:195], v[28:31], v[104:107]
  s_add_u32 s27, s27, s22
  ds_read_b128 v[52:55], v15 offset:57344
  v_mfma_f32_16x16x32_bf16 v[108:111], a[196:199], v[28:31], v[108:111]
  v_mfma_f32_16x16x32_bf16 v[120:123], a[200:203], v[28:31], v[120:123]
  s_waitcnt vmcnt(13)
  s_barrier
  v_mfma_f32_16x16x32_bf16 v[124:127], a[204:207], v[28:31], v[124:127]
  s_waitcnt lgkmcnt(5)
  v_xor_b32 v15, 0x10000, v15
  v_mfma_f32_16x16x32_bf16 v[96:99], a[208:211], v[32:35], v[96:99]
  ds_read_b128 v[24:27], v8 offset:0
  v_mfma_f32_16x16x32_bf16 v[100:103], a[212:215], v[32:35], v[100:103]
  v_mfma_f32_16x16x32_bf16 v[112:115], a[216:219], v[32:35], v[112:115]
  v_mfma_f32_16x16x32_bf16 v[116:119], a[220:223], v[32:35], v[116:119]
  s_waitcnt lgkmcnt(5)
  v_mfma_f32_16x16x32_bf16 v[104:107], a[208:211], v[36:39], v[104:107]
  s_add_u32 s29, s29, 1
  ds_read_b128 v[28:31], v9 offset:0
  v_mfma_f32_16x16x32_bf16 v[108:111], a[212:215], v[36:39], v[108:111]
  v_mfma_f32_16x16x32_bf16 v[120:123], a[216:219], v[36:39], v[120:123]
  s_max_i32 s30, s29, 0
  v_mfma_f32_16x16x32_bf16 v[124:127], a[220:223], v[36:39], v[124:127]
  s_waitcnt lgkmcnt(5)
  v_mov_b32 v144, s30
  v_mfma_f32_16x16x32_bf16 v[96:99], a[224:227], v[40:43], v[96:99]
  ds_read_b128 v[32:35], v10 offset:0
  v_mfma_f32_16x16x32_bf16 v[100:103], a[228:231], v[40:43], v[100:103]
  v_mfma_f32_16x16x32_bf16 v[112:115], a[232:235], v[40:43], v[112:115]
  buffer_store_dword v144, v145, s[4:7], s31 offen sc1
  v_mfma_f32_16x16x32_bf16 v[116:119], a[236:239], v[40:43], v[116:119]
  s_waitcnt lgkmcnt(5)
  v_mfma_f32_16x16x32_bf16 v[104:107], a[224:227], v[44:47], v[104:107]
  ds_read_b128 v[36:39], v11 offset:0
  v_mfma_f32_16x16x32_bf16 v[108:111], a[228:231], v[44:47], v[108:111]
  v_mfma_f32_16x16x32_bf16 v[120:123], a[232:235], v[44:47], v[120:123]
  v_mfma_f32_16x16x32_bf16 v[124:127], a[236:239], v[44:47], v[124:127]
  s_waitcnt lgkmcnt(5)
  v_mfma_f32_16x16x32_bf16 v[96:99], a[240:243], v[48:51], v[96:99]
  s_sub_u32 s23, s23, 1
  ds_read_b128 v[40:43], v12 offset:0
  v_mfma_f32_16x16x32_bf16 v[100:103], a[244:247], v[48:51], v[100:103]
  v_mfma_f32_16x16x32_bf16 v[112:115], a[248:251], v[48:51], v[112:115]
  v_mfma_f32_16x16x32_bf16 v[116:119], a[252:255], v[48:51], v[116:119]
  s_waitcnt lgkmcnt(5)
  v_mfma_f32_16x16x32_bf16 v[104:107], a[240:243], v[52:55], v[104:107]
  s_cmp_eq_u32 s23, 0
  ds_read_b128 v[44:47], v13 offset:0
  v_mfma_f32_16x16x32_bf16 v[108:111], a[244:247], v[52:55], v[108:111]
  v_mfma_f32_16x16x32_bf16 v[120:123], a[248:251], v[52:55], v[120:123]
  v_mfma_f32_16x16x32_bf16 v[124:127], a[252:255], v[52:55], v[124:127]
  s_cbranch_scc1 G_done1_10
  s_branch G_top_8
G_done0_9:
  s_nop 7
  s_nop 3
  v_mul_f32 v64, s24, v64
  v_mul_f32 v65, s24, v65
  v_cvt_pk_bf16_f32 v128, v64, v65
  v_mul_f32 v66, s24, v66
  v_mul_f32 v67, s24, v67
  v_cvt_pk_bf16_f32 v129, v66, v67
  v_mul_f32 v68, s24, v68
  v_mul_f32 v69, s24, v69
  v_cvt_pk_bf16_f32 v130, v68, v69
  v_mul_f32 v70, s24, v70
  v_mul_f32 v71, s24, v71
  v_cvt_pk_bf16_f32 v131, v70, v71
  buffer_store_dwordx4 v[128:131], v7, s[4:7], s21 offen offset:0 sc1
  v_mul_f32 v72, s24, v72
  v_mul_f32 v73, s24, v73
  v_cvt_pk_bf16_f32 v132, v72, v73
  v_mul_f32 v74, s24, v74
  v_mul_f32 v75, s24, v75
  v_cvt_pk_bf16_f32 v133, v74, v75
  v_mul_f32 v76, s24, v76
  v_mul_f32 v77, s24, v77
  v_cvt_pk_bf16_f32 v134, v76, v77
  v_mul_f32 v78, s24, v78
  v_mul_f32 v79, s24, v79
  v_cvt_pk_bf16_f32 v135, v78, v79
  buffer_store_dwordx4 v[132:135], v7, s[4:7], s21 offen offset:256 sc1
  v_mul_f32 v80, s24, v80
  v_mul_f32 v81, s24, v81
  v_cvt_pk_bf16_f32 v136, v80, v81
  v_mul_f32 v82, s24, v82
  v_mul_f32 v83, s24, v83
  v_cvt_pk_bf16_f32 v137, v82, v83
  v_mul_f32 v84, s24, v84
  v_mul_f32 v85, s24, v85
  v_cvt_pk_bf16_f32 v138, v84, v85
  v_mul_f32 v86, s24, v86
  v_mul_f32 v87, s24, v87
  v_cvt_pk_bf16_f32 v139, v86, v87
  buffer_store_dwordx4 v[136:139], v7, s[4:7], s21 offen offset:2048 sc1
  v_mul_f32 v88, s24, v88
  v_mul_f32 v89, s24, v89
  v_cvt_pk_bf16_f32 v140, v88, v89
  v_mul_f32 v90, s24, v90
  v_mul_f32 v91, s24, v91
  v_cvt_pk_bf16_f32 v141, v90, v91
  v_mul_f32 v92, s24, v92
  v_mul_f32 v93, s24, v93
  v_cvt_pk_bf16_f32 v142, v92, v93
  v_mul_f32 v94, s24, v94
  v_mul_f32 v95, s24, v95
  v_cvt_pk_bf16_f32 v143, v94, v95
  buffer_store_dwordx4 v[140:143], v7, s[4:7], s21 offen offset:2304 sc1
  s_branch G_fin_11
G_done1_10:
  s_nop 7
  s_nop 3
  v_mul_f32 v96, s24, v96
  v_mul_f32 v97, s24, v97
  v_cvt_pk_bf16_f32 v128, v96, v97
  v_mul_f32 v98, s24, v98
  v_mul_f32 v99, s24, v99
  v_cvt_pk_bf16_f32 v129, v98, v99
  v_mul_f32 v100, s24, v100
  v_mul_f32 v101, s24, v101
  v_cvt_pk_bf16_f32 v130, v100, v101
  v_mul_f32 v102, s24, v102
  v_mul_f32 v103, s24, v103
  v_cvt_pk_bf16_f32 v131, v102, v103
  buffer_store_dwordx4 v[128:131], v7, s[4:7], s21 offen offset:0 sc1
  v_mul_f32 v104, s24, v104
  v_mul_f32 v105, s24, v105
  v_cvt_pk_bf16_f32 v132, v104, v105
  v_mul_f32 v106, s24, v106
  v_mul_f32 v107, s24, v107
  v_cvt_pk_bf16_f32 v133, v106, v107
  v_mul_f32 v108, s24, v108
  v_mul_f32 v109, s24, v109
  v_cvt_pk_bf16_f32 v134, v108, v109
  v_mul_f32 v110, s24, v110
  v_mul_f32 v111, s24, v111
  v_cvt_pk_bf16_f32 v135, v110, v111
  buffer_store_dwordx4 v[132:135], v7, s[4:7], s21 offen offset:256 sc1
  v_mul_f32 v112, s24, v112
  v_mul_f32 v113, s24, v113
  v_cvt_pk_bf16_f32 v136, v112, v113
  v_mul_f32 v114, s24, v114
  v_mul_f32 v115, s24, v115
  v_cvt_pk_bf16_f32 v137, v114, v115
  v_mul_f32 v116, s24, v116
  v_mul_f32 v117, s24, v117
  v_cvt_pk_bf16_f32 v138, v116, v117
  v_mul_f32 v118, s24, v118
  v_mul_f32 v119, s24, v119
  v_cvt_pk_bf16_f32 v139, v118, v119
  buffer_store_dwordx4 v[136:139], v7, s[4:7], s21 offen offset:2048 sc1
  v_mul_f32 v120, s24, v120
  v_mul_f32 v121, s24, v121
  v_cvt_pk_bf16_f32 v140, v120, v121
  v_mul_f32 v122, s24, v122
  v_mul_f32 v123, s24, v123
  v_cvt_pk_bf16_f32 v141, v122, v123
  v_mul_f32 v124, s24, v124
  v_mul_f32 v125, s24, v125
  v_cvt_pk_bf16_f32 v142, v124, v125
  v_mul_f32 v126, s24, v126
  v_mul_f32 v127, s24, v127
  v_cvt_pk_bf16_f32 v143, v126, v127
  buffer_store_dwordx4 v[140:143], v7, s[4:7], s21 offen offset:2304 sc1
G_fin_11:
  s_waitcnt vmcnt(0) lgkmcnt(0)
  s_barrier
  s_add_u32 s30, s29, 2
  v_mov_b32 v144, s30
  v_min_u32 v145, 1, v0
  v_lshlrev_b32 v145, 30, v145
  buffer_store_dword v144, v145, s[4:7], s31 offen sc1
  s_branch P_end_2
P_v_1:
  s_mov_b32 s27, s21
  v_mov_b32 v7, 0x40000000
  s_mov_b32 s29, -2
  v_min_u32 v145, 1, v0
  v_lshlrev_b32 v145, 30, v145
  ds_read_b128 v[24:27], v8 offset:0
  ds_read_b128 v[28:31], v9 offset:0
  ds_read_b128 v[32:35], v10 offset:0
  ds_read_b128 v[36:39], v11 offset:0
  ds_read_b128 v[40:43], v12 offset:0
  ds_read_b128 v[44:47], v13 offset:0
.p2align 6
G_top_12:
  s_waitcnt lgkmcnt(5)
  v_mfma_f32_16x16x32_bf16 v[64:67], v[24:27], a[0:3], 0
  s_add_u32 m0, s25, 0
  ds_read_b128 v[48:51], v14 offset:0
  v_mfma_f32_16x16x32_bf16 v[72:75], v[24:27], a[4:7], 0
  v_mfma_f32_16x16x32_bf16 v[80:83], v[24:27], a[8:11], 0
  buffer_load_dwordx4 v16, s[12:15], s19 offen lds
  v_mfma_f32_16x16x32_bf16 v[88:91], v[24:27], a[12:15], 0
  s_waitcnt lgkmcnt(5)
  v_mfma_f32_16x16x32_bf16 v[68:71], v[28:31], a[0:3], 0
  ds_read_b128 v[52:55], v15 offset:0
  v_mfma_f32_16x16x32_bf16 v[76:79], v[28:31], a[4:7], 0
  v_cvt_pk_bf16_f32 v128, v96, v97
  v_cvt_pk_bf16_f32 v129, v98, v99
  v_mfma_f32_16x16x32_bf16 v[84:87], v[28:31], a[8:11], 0
  v_mfma_f32_16x16x32_bf16 v[92:95], v[28:31], a[12:15], 0
  s_waitcnt lgkmcnt(5)
  v_cvt_pk_bf16_f32 v130, v100, v101
  v_cvt_pk_bf16_f32 v131, v102, v103
  v_mfma_f32_16x16x32_bf16 v[64:67], v[32:35], a[16:19], v[64:67]
  s_add_u32 m0, s25, 1024
  ds_read_b128 v[24:27], v8 offset:8192
  v_mfma_f32_16x16x32_bf16 v[72:75], v[32:35], a[20:23], v[72:75]
  v_mfma_f32_16x16x32_bf16 v[80:83], v[32:35], a[24:27], v[80:83]
  buffer_load_dwordx4 v17, s[12:15], s19 offen lds
  v_mfma_f32_16x16x32_bf16 v[88:91], v[32:35], a[28:31], v[88:91]
  s_waitcnt lgkmcnt(5)
  v_mfma_f32_16x16x32_bf16 v[68:71], v[36:39], a[16:19], v[68:71]
  ds_read_b128 v[28:31], v9 offset:8192
  v_mfma_f32_16x16x32_bf16 v[76:79], v[36:39], a[20:23], v[76:79]
  v_mfma_f32_16x16x32_bf16 v[84:87], v[36:39], a[24:27], v[84:87]
  v_mfma_f32_16x16x32_bf16 v[92:95], v[36:39], a[28:31], v[92:95]
  s_waitcnt lgkmcnt(5)
  v_mfma_f32_16x16x32_bf16 v[64:67], v[40:43], a[32:35], v[64:67]
  s_add_u32 m0, s25, 2048
  ds_read_b128 v[32:35], v10 offset:8192
  v_mfma_f32_16x16x32_bf16 v[72:75], v[40:43], a[36:39], v[72:75]
  v_cvt_pk_bf16_f32 v132, v104, v105
  v_cvt_pk_bf16_f32 v133, v106, v107
  v_mfma_f32_16x16x32_bf16 v[80:83], v[40:43], a[40:43], v[80:83]
  buffer_load_dwordx4 v18, s[12:15], s19 offen lds
  v_mfma_f32_16x16x32_bf16 v[88:91], v[40:43], a[44:47], v[88:91]
  s_waitcnt lgkmcnt(5)
  v_cvt_pk_bf16_f32 v134, v108, v109
  v_cvt_pk_bf16_f32 v135, v110, v111
  v_mfma_f32_16x16x32_bf16 v[68:71], v[44:47], a[32:35], v[68:71]
  ds_read_b128 v[36:39], v11 offset:8192
  v_mfma_f32_16x16x32_bf16 v[76:79], v[44:47], a[36:39], v[76:79]
  v_mfma_f32_16x16x32_bf16 v[84:87], v[44:47], a[40:43], v[84:87]
  v_mfma_f32_16x16x32_bf16 v[92:95], v[44:47], a[44:47], v[92:95]
  s_waitcnt lgkmcnt(5)
  v_mfma_f32_16x16x32_bf16 v[64:67], v[48:51], a[48:51], v[64:67]
  s_add_u32 m0, s25, 3072
  ds_read_b128 v[40:43], v12 offset:8192
  v_mfma_f32_16x16x32_bf16 v[72:75], v[48:51], a[52:55], v[72:75]
  v_mfma_f32_16x16x32_bf16 v[80:83], v[48:51], a[56:59], v[80:83]
  buffer_load_dwordx4 v19, s[12:15], s19 offen lds
  v_mfma_f32_16x16x32_bf16 v[88:91], v[48:51], a[60:63], v[88:91]
  s_waitcnt lgkmcnt(5)
  v_mfma_f32_16x16x32_bf16 v[68:71], v[52:55], a[48:51], v[68:71]
  ds_read_b128 v[44:47], v13 offset:8192
  v_mfma_f32_16x16x32_bf16 v[76:79], v[52:55], a[52:55], v[76:79]
  v_cvt_pk_bf16_f32 v136, v112, v113
  v_cvt_pk_bf16_f32 v137, v114, v115
  v_mfma_f32_16x16x32_bf16 v[84:87], v[52:55], a[56:59], v[84:87]
  v_mfma_f32_16x16x32_bf16 v[92:95], v[52:55], a[60:63], v[92:95]
  s_waitcnt lgkmcnt(5)
  v_cvt_pk_bf16_f32 v138, v116, v117
  v_cvt_pk_bf16_f32 v139, v118, v119
  v_mfma_f32_16x16x32_bf16 v[64:67], v[24:27], a[64:67], v[64:67]
  s_add_u32 m0, s25, 4096
  ds_read_b128 v[48:51], v14 offset:8192
  v_mfma_f32_16x16x32_bf16 v[72:75], v[24:27], a[68:71], v[72:75]
  v_mfma_f32_16x16x32_bf16 v[80:83], v[24:27], a[72:75], v[80:83]
  buffer_load_dwordx4 v20, s[12:15], s19 offen lds
  v_mfma_f32_16x16x32_bf16 v[88:91], v[24:27], a[76:79], v[88:91]
  s_waitcnt lgkmcnt(5)
  v_mfma_f32_16x16x32_bf16 v[68:71], v[28:31], a[64:67], v[68:71]
  ds_read_b128 v[52:55], v15 offset:8192
  v_mfma_f32_16x16x32_bf16 v[76:79], v[28:31], a[68:71], v[76:79]
  v_mfma_f32_16x16x32_bf16 v[84:87], v[28:31], a[72:75], v[84:87]
  v_mfma_f32_16x16x32_bf16 v[92:95], v[28:31], a[76:79], v[92:95]
  s_waitcnt lgkmcnt(5)
  v_mfma_f32_16x16x32_bf16 v[64:67], v[32:35], a[80:83], v[64:67]
  s_add_u32 m0, s25, 5120
  ds_read_b128 v[24:27], v8 offset:16384
  v_mfma_f32_16x16x32_bf16 v[72:75], v[32:35], a[84:87], v[72:75]
  v_cvt_pk_bf16_f32 v140, v120, v121
  v_cvt_pk_bf16_f32 v141, v122, v123
  v_mfma_f32_16x16x32_bf16 v[80:83], v[32:35], a[88:91], v[80:83]
  buffer_load_dwordx4 v21, s[12:15], s19 offen lds
  v_mfma_f32_16x16x32_bf16 v[88:91], v[32:35], a[92:95], v[88:91]
  s_waitcnt lgkmcnt(5)
  v_cvt_pk_bf16_f32 v142, v124, v125
  v_cvt_pk_bf16_f32 v143, v126, v127
  v_mfma_f32_16x16x32_bf16 v[68:71], v[36:39], a[80:83], v[68:71]
  ds_read_b128 v[28:31], v9 offset:16384
  v_mfma_f32_16x16x32_bf16 v[76:79], v[36:39], a[84:87], v[76:79]
  v_mfma_f32_16x16x32_bf16 v[84:87], v[36:39], a[88:91], v[84:87]
  v_mfma_f32_16x16x32_bf16 v[92:95], v[36:39], a[92:95], v[92:95]
  s_waitcnt lgkmcnt(5)
  v_mfma_f32_16x16x32_bf16 v[64:67], v[40:43], a[96:99], v[64:67]
  s_add_u32 m0, s25, 6144
  ds_read_b128 v[32:35], v10 offset:16384
  v_mfma_f32_16x16x32_bf16 v[72:75], v[40:43], a[100:103], v[72:75]
  v_mfma_f32_16x16x32_bf16 v[80:83], v[40:43], a[104:107], v[80:83]
  buffer_load_dwordx4 v22, s[12:15], s19 offen lds
  v_mfma_f32_16x16x32_bf16 v[88:91], v[40:43], a[108:111], v[88:91]
  s_waitcnt lgkmcnt(5)
  v_mfma_f32_16x16x32_bf16 v[68:71], v[44:47], a[96:99], v[68:71]
  ds_read_b128 v[36:39], v11 offset:16384
  v_mfma_f32_16x16x32_bf16 v[76:79], v[44:47], a[100:103], v[76:79]
  v_mfma_f32_16x16x32_bf16 v[84:87], v[44:47], a[104:107], v[84:87]
  v_mfma_f32_16x16x32_bf16 v[92:95], v[44:47], a[108:111], v[92:95]
  s_waitcnt lgkmcnt(5)
  v_mfma_f32_16x16x32_bf16 v[64:67], v[48:51], a[112:115], v[64:67]
  s_add_u32 m0, s25, 7168
  ds_read_b128 v[40:43], v12 offset:16384
  v_mfma_f32_16x16x32_bf16 v[72:75], v[48:51], a[116:119], v[72:75]
  v_mfma_f32_16x16x32_bf16 v[80:83], v[48:51], a[120:123], v[80:83]
  buffer_load_dwordx4 v23, s[12:15], s19 offen lds
  v_mfma_f32_16x16x32_bf16 v[88:91], v[48:51], a[124:127], v[88:91]
  s_waitcnt lgkmcnt(5)
  v_mfma_f32_16x16x32_bf16 v[68:71], v[52:55], a[112:115], v[68:71]
  s_cmp_gt_u32 s23, 3
  ds_read_b128 v[44:47], v13 offset:16384
  v_mfma_f32_16x16x32_bf16 v[76:79], v[52:55], a[116:119], v[76:79]
  v_mfma_f32_16x16x32_bf16 v[84:87], v[52:55], a[120:123], v[84:87]
  s_cselect_b32 s26, s20, 0
  v_mfma_f32_16x16x32_bf16 v[92:95], v[52:55], a[124:127], v[92:95]
  s_waitcnt lgkmcnt(5)
  v_mfma_f32_16x16x32_bf16 v[64:67], v[24:27], a[128:131], v[64:67]
  s_add_u32 s19, s19, s26
  ds_read_b128 v[48:51], v14 offset:16384
  v_mfma_f32_16x16x32_bf16 v[72:75], v[24:27], a[132:135], v[72:75]
  v_mfma_f32_16x16x32_bf16 v[80:83], v[24:27], a[136:139], v[80:83]
  s_add_u32 s25, s25, 32768
  v_mfma_f32_16x16x32_bf16 v[88:91], v[24:27], a[140:143], v[88:91]
  s_waitcnt lgkmcnt(5)
  v_mfma_f32_16x16x32_bf16 v[68:71], v[28:31], a[128:131], v[68:71]
  s_and_b32 s25, s25, 0x1ffff
  ds_read_b128 v[52:55], v15 offset:16384
  v_mfma_f32_16x16x32_bf16 v[76:79], v[28:31], a[132:135], v[76:79]
  v_mfma_f32_16x16x32_bf16 v[84:87], v[28:31], a[136:139], v[84:87]
  buffer_store_dwordx4 v[128:131], v7, s[4:7], s21 offen offset:0 sc1
  v_mfma_f32_16x16x32_bf16 v[92:95], v[28:31], a[140:143], v[92:95]
  s_waitcnt lgkmcnt(5)
  v_mfma_f32_16x16x32_bf16 v[64:67], v[32:35], a[144:147], v[64:67]
  ds_read_b128 v[24:27], v8 offset:24576
  v_mfma_f32_16x16x32_bf16 v[72:75], v[32:35], a[148:151], v[72:75]
  v_mfma_f32_16x16x32_bf16 v[80:83], v[32:35], a[152:155], v[80:83]
  v_mfma_f32_16x16x32_bf16 v[88:91], v[32:35], a[156:159], v[88:91]
  s_waitcnt lgkmcnt(5)
  v_mfma_f32_16x16x32_bf16 v[68:71], v[36:39], a[144:147], v[68:71]
  ds_read_b128 v[28:31], v9 offset:24576
  v_mfma_f32_16x16x32_bf16 v[76:79], v[36:39], a[148:151], v[76:79]
  v_mfma_f32_16x16x32_bf16 v[84:87], v[36:39], a[152:155], v[84:87]
  buffer_store_dwordx4 v[132:135], v7, s[4:7], s21 offen offset:256 sc1
  v_mfma_f32_16x16x32_bf16 v[92:95], v[36:39], a[156:159], v[92:95]
  s_waitcnt lgkmcnt(5)
  v_mfma_f32_16x16x32_bf16 v[64:67], v[40:43], a[160:163], v[64:67]
  ds_read_b128 v[32:35], v10 offset:24576
  v_mfma_f32_16x16x32_bf16 v[72:75], v[40:43], a[164:167], v[72:75]
  v_mfma_f32_16x16x32_bf16 v[80:83], v[40:43], a[168:171], v[80:83]
  v_mfma_f32_16x16x32_bf16 v[88:91], v[40:43], a[172:175], v[88:91]
  s_waitcnt lgkmcnt(5)
  v_mfma_f32_16x16x32_bf16 v[68:71], v[44:47], a[160:163], v[68:71]
  ds_read_b128 v[36:39], v11 offset:24576
  v_mfma_f32_16x16x32_bf16 v[76:79], v[44:47], a[164:167], v[76:79]
  v_mfma_f32_16x16x32_bf16 v[84:87], v[44:47], a[168:171], v[84:87]
  buffer_store_dwordx4 v[136:139], v7, s[4:7], s21 offen offset:2048 sc1
  v_mfma_f32_16x16x32_bf16 v[92:95], v[44:47], a[172:175], v[92:95]
  s_waitcnt lgkmcnt(5)
  v_mfma_f32_16x16x32_bf16 v[64:67], v[48:51], a[176:179], v[64:67]
  ds_read_b128 v[40:43], v12 offset:24576
  v_mfma_f32_16x16x32_bf16 v[72:75], v[48:51], a[180:183], v[72:75]
  v_mfma_f32_16x16x32_bf16 v[80:83], v[48:51], a[184:187], v[80:83]
  v_mfma_f32_16x16x32_bf16 v[88:91], v[48:51], a[188:191], v[88:91]
  s_waitcnt lgkmcnt(5)
  v_mfma_f32_16x16x32_bf16 v[68:71], v[52:55], a[176:179], v[68:71]
  ds_read_b128 v[44:47], v13 offset:24576
  v_mfma_f32_16x16x32_bf16 v[76:79], v[52:55], a[180:183], v[76:79]
  v_mfma_f32_16x16x32_bf16 v[84:87], v[52:55], a[184:187], v[84:87]
  buffer_store_dwordx4 v[140:143], v7, s[4:7], s21 offen offset:2304 sc1
  v_mfma_f32_16x16x32_bf16 v[92:95], v[52:55], a[188:191], v[92:95]
  s_waitcnt lgkmcnt(5)
  v_mfma_f32_16x16x32_bf16 v[64:67], v[24:27], a[192:195], v[64:67]
  s_mov_b32 s21, s27
  ds_read_b128 v[48:51], v14 offset:24576
  v_mfma_f32_16x16x32_bf16 v[72:75], v[24:27], a[196:199], v[72:75]
  v_mov_b32 v7, v56
  v_mfma_f32_16x16x32_bf16 v[80:83], v[24:27], a[200:203], v[80:83]
  v_mfma_f32_16x16x32_bf16 v[88:91], v[24:27], a[204:207], v[88:91]
  s_waitcnt lgkmcnt(5)
  v_mfma_f32_16x16x32_bf16 v[68:71], v[28:31], a[192:195], v[68:71]
  s_add_u32 s27, s27, s22
  ds_read_b128 v[52:55], v15 offset:24576
  v_mfma_f32_16x16x32_bf16 v[76:79], v[28:31], a[196:199], v[76:79]
  v_mfma_f32_16x16x32_bf16 v[84:87], v[28:31], a[200:203], v[84:87]
  s_waitcnt vmcnt(13)
  s_barrier
  v_mfma_f32_16x16x32_bf16 v[92:95], v[28:31], a[204:207], v[92:95]
  s_waitcnt lgkmcnt(5)
  v_mfma_f32_16x16x32_bf16 v[64:67], v[32:35], a[208:211], v[64:67]
  ds_read_b128 v[24:27], v8 offset:32768
  v_mfma_f32_16x16x32_bf16 v[72:75], v[32:35], a[212:215], v[72:75]
  v_mfma_f32_16x16x32_bf16 v[80:83], v[32:35], a[216:219], v[80:83]
  v_mfma_f32_16x16x32_bf16 v[88:91], v[32:35], a[220:223], v[88:91]
  s_waitcnt lgkmcnt(5)
  v_mfma_f32_16x16x32_bf16 v[68:71], v[36:39], a[208:211], v[68:71]
  s_add_u32 s29, s29, 1
  ds_read_b128 v[28:31], v9 offset:32768
  v_mfma_f32_16x16x32_bf16 v[76:79], v[36:39], a[212:215], v[76:79]
  v_mfma_f32_16x16x32_bf16 v[84:87], v[36:39], a[216:219], v[84:87]
  s_max_i32 s30, s29, 0
  v_mfma_f32_16x16x32_bf16 v[92:95], v[36:39], a[220:223], v[92:95]
  s_waitcnt lgkmcnt(5)
  v_mov_b32 v144, s30
  v_mfma_f32_16x16x32_bf16 v[64:67], v[40:43], a[224:227], v[64:67]
  ds_read_b128 v[32:35], v10 offset:32768
  v_mfma_f32_16x16x32_bf16 v[72:75], v[40:43], a[228:231], v[72:75]
  v_mfma_f32_16x16x32_bf16 v[80:83], v[40:43], a[232:235], v[80:83]
  buffer_store_dword v144, v145, s[4:7], s31 offen sc1
  v_mfma_f32_16x16x32_bf16 v[88:91], v[40:43], a[236:239], v[88:91]
  s_waitcnt lgkmcnt(5)
  v_mfma_f32_16x16x32_bf16 v[68:71], v[44:47], a[224:227], v[68:71]
  ds_read_b128 v[36:39], v11 offset:32768
  v_mfma_f32_16x16x32_bf16 v[76:79], v[44:47], a[228:231], v[76:79]
  v_mfma_f32_16x16x32_bf16 v[84:87], v[44:47], a[232:235], v[84:87]
  v_mfma_f32_16x16x32_bf16 v[92:95], v[44:47], a[236:239], v[92:95]
  s_waitcnt lgkmcnt(5)
  v_mfma_f32_16x16x32_bf16 v[64:67], v[48:51], a[240:243], v[64:67]
  s_sub_u32 s23, s23, 1
  ds_read_b128 v[40:43], v12 offset:32768
  v_mfma_f32_16x16x32_bf16 v[72:75], v[48:51], a[244:247], v[72:75]
  v_mfma_f32_16x16x32_bf16 v[80:83], v[48:51], a[248:251], v[80:83]
  v_mfma_f32_16x16x32_bf16 v[88:91], v[48:51], a[252:255], v[88:91]
  s_waitcnt lgkmcnt(5)
  v_mfma_f32_16x16x32_bf16 v[68:71], v[52:55], a[240:243], v[68:71]
  s_cmp_eq_u32 s23, 0
  ds_read_b128 v[44:47], v13 offset:32768
  v_mfma_f32_16x16x32_bf16 v[76:79], v[52:55], a[244:247], v[76:79]
  v_mfma_f32_16x16x32_bf16 v[84:87], v[52:55], a[248:251], v[84:87]
  v_mfma_f32_16x16x32_bf16 v[92:95], v[52:55], a[252:255], v[92:95]
  s_cbranch_scc1 G_done0_13
  s_waitcnt lgkmcnt(5)
  v_mfma_f32_16x16x32_bf16 v[96:99], v[24:27], a[0:3], 0
  s_add_u32 m0, s25, 0
  ds_read_b128 v[48:51], v14 offset:32768
  v_mfma_f32_16x16x32_bf16 v[104:107], v[24:27], a[4:7], 0
  v_mfma_f32_16x16x32_bf16 v[112:115], v[24:27], a[8:11], 0
  buffer_load_dwordx4 v16, s[12:15], s19 offen lds
  v_mfma_f32_16x16x32_bf16 v[120:123], v[24:27], a[12:15], 0
  s_waitcnt lgkmcnt(5)
  v_mfma_f32_16x16x32_bf16 v[100:103], v[28:31], a[0:3], 0
  ds_read_b128 v[52:55], v15 offset:32768
  v_mfma_f32_16x16x32_bf16 v[108:111], v[28:31], a[4:7], 0
  v_cvt_pk_bf16_f32 v128, v64, v65
  v_cvt_pk_bf16_f32 v129, v66, v67
  v_mfma_f32_16x16x32_bf16 v[116:119], v[28:31], a[8:11], 0
  v_mfma_f32_16x16x32_bf16 v[124:127], v[28:31], a[12:15], 0
  s_waitcnt lgkmcnt(5)
  v_cvt_pk_bf16_f32 v130, v68, v69
  v_cvt_pk_bf16_f32 v131, v70, v71
  v_mfma_f32_16x16x32_bf16 v[96:99], v[32:35], a[16:19], v[96:99]
  s_add_u32 m0, s25, 1024
  ds_read_b128 v[24:27], v8 offset:40960
  v_mfma_f32_16x16x32_bf16 v[104:107], v[32:35], a[20:23], v[104:107]
  v_mfma_f32_16x16x32_bf16 v[112:115], v[32:35], a[24:27], v[112:115]
  buffer_load_dwordx4 v17, s[12:15], s19 offen lds
  v_mfma_f32_16x16x32_bf16 v[120:123], v[32:35], a[28:31], v[120:123]
  s_waitcnt lgkmcnt(5)
  v_mfma_f32_16x16x32_bf16 v[100:103], v[36:39], a[16:19], v[100:103]
  ds_read_b128 v[28:31], v9 offset:40960
  v_mfma_f32_16x16x32_bf16 v[108:111], v[36:39], a[20:23], v[108:111]
  v_mfma_f32_16x16x32_bf16 v[116:119], v[36:39], a[24:27], v[116:119]
  v_mfma_f32_16x16x32_bf16 v[124:127], v[36:39], a[28:31], v[124:127]
  s_waitcnt lgkmcnt(5)
  v_mfma_f32_16x16x32_bf16 v[96:99], v[40:43], a[32:35], v[96:99]
  s_add_u32 m0, s25, 2048
  ds_read_b128 v[32:35], v10 offset:40960
  v_mfma_f32_16x16x32_bf16 v[104:107], v[40:43], a[36:39], v[104:107]
  v_cvt_pk_bf16_f32 v132, v72, v73
  v_cvt_pk_bf16_f32 v133, v74, v75
  v_mfma_f32_16x16x32_bf16 v[112:115], v[40:43], a[40:43], v[112:115]
  buffer_load_dwordx4 v18, s[12:15], s19 offen lds
  v_mfma_f32_16x16x32_bf16 v[120:123], v[40:43], a[44:47], v[120:123]
  s_waitcnt lgkmcnt(5)
  v_cvt_pk_bf16_f32 v134, v76, v77
  v_cvt_pk_bf16_f32 v135, v78, v79
  v_mfma_f32_16x16x32_bf16 v[100:103], v[44:47], a[32:35], v[100:103]
  ds_read_b128 v[36:39], v11 offset:40960
  v_mfma_f32_16x16x32_bf16 v[108:111], v[44:47], a[36:39], v[108:111]
  v_mfma_f32_16x16x32_bf16 v[116:119], v[44:47], a[40:43], v[116:119]
  v_mfma_f32_16x16x32_bf16 v[124:127], v[44:47], a[44:47], v[124:127]
  s_waitcnt lgkmcnt(5)
  v_mfma_f32_16x16x32_bf16 v[96:99], v[48:51], a[48:51], v[96:99]
  s_add_u32 m0, s25, 3072
  ds_read_b128 v[40:43], v12 offset:40960
  v_mfma_f32_16x16x32_bf16 v[104:107], v[48:51], a[52:55], v[104:107]
  v_mfma_f32_16x16x32_bf16 v[112:115], v[48:51], a[56:59], v[112:115]
  buffer_load_dwordx4 v19, s[12:15], s19 offen lds
  v_mfma_f32_16x16x32_bf16 v[120:123], v[48:51], a[60:63], v[120:123]
  s_waitcnt lgkmcnt(5)
  v_mfma_f32_16x16x32_bf16 v[100:103], v[52:55], a[48:51], v[100:103]
  ds_read_b128 v[44:47], v13 offset:40960
  v_mfma_f32_16x16x32_bf16 v[108:111], v[52:55], a[52:55], v[108:111]
  v_cvt_pk_bf16_f32 v136, v80, v81
  v_cvt_pk_bf16_f32 v137, v82, v83
  v_mfma_f32_16x16x32_bf16 v[116:119], v[52:55], a[56:59], v[116:119]
  v_mfma_f32_16x16x32_bf16 v[124:127], v[52:55], a[60:63], v[124:127]
  s_waitcnt lgkmcnt(5)
  v_cvt_pk_bf16_f32 v138, v84, v85
  v_cvt_pk_bf16_f32 v139, v86, v87
  v_mfma_f32_16x16x32_bf16 v[96:99], v[24:27], a[64:67], v[96:99]
  s_add_u32 m0, s25, 4096
  ds_read_b128 v[48:51], v14 offset:40960
  v_mfma_f32_16x16x32_bf16 v[104:107], v[24:27], a[68:71], v[104:107]
  v_mfma_f32_16x16x32_bf16 v[112:115], v[24:27], a[72:75], v[112:115]
  buffer_load_dwordx4 v20, s[12:15], s19 offen lds
  v_mfma_f32_16x16x32_bf16 v[120:123], v[24:27], a[76:79], v[120:123]
  s_waitcnt lgkmcnt(5)
  v_mfma_f32_16x16x32_bf16 v[100:103], v[28:31], a[64:67], v[100:103]
  ds_read_b128 v[52:55], v15 offset:40960
  v_mfma_f32_16x16x32_bf16 v[108:111], v[28:31], a[68:71], v[108:111]
  v_mfma_f32_16x16x32_bf16 v[116:119], v[28:31], a[72:75], v[116:119]
  v_mfma_f32_16x16x32_bf16 v[124:127], v[28:31], a[76:79], v[124:127]
  s_waitcnt lgkmcnt(5)
  v_mfma_f32_16x16x32_bf16 v[96:99], v[32:35], a[80:83], v[96:99]
  s_add_u32 m0, s25, 5120
  ds_read_b128 v[24:27], v8 offset:49152
  v_mfma_f32_16x16x32_bf16 v[104:107], v[32:35], a[84:87], v[104:107]
  v_cvt_pk_bf16_f32 v140, v88, v89
  v_cvt_pk_bf16_f32 v141, v90, v91
  v_mfma_f32_16x16x32_bf16 v[112:115], v[32:35], a[88:91], v[112:115]
  buffer_load_dwordx4 v21, s[12:15], s19 offen lds
  v_mfma_f32_16x16x32_bf16 v[120:123], v[32:35], a[92:95], v[120:123]
  s_waitcnt lgkmcnt(5)
  v_cvt_pk_bf16_f32 v142, v92, v93
  v_cvt_pk_bf16_f32 v143, v94, v95
  v_mfma_f32_16x16x32_bf16 v[100:103], v[36:39], a[80:83], v[100:103]
  ds_read_b128 v[28:31], v9 offset:49152
  v_mfma_f32_16x16x32_bf16 v[108:111], v[36:39], a[84:87], v[108:111]
  v_mfma_f32_16x16x32_bf16 v[116:119], v[36:39], a[88:91], v[116:119]
  v_mfma_f32_16x16x32_bf16 v[124:127], v[36:39], a[92:95], v[124:127]
  s_waitcnt lgkmcnt(5)
  v_mfma_f32_16x16x32_bf16 v[96:99], v[40:43], a[96:99], v[96:99]
  s_add_u32 m0, s25, 6144
  ds_read_b128 v[32:35], v10 offset:49152
  v_mfma_f32_16x16x32_bf16 v[104:107], v[40:43], a[100:103], v[104:107]
  v_mfma_f32_16x16x32_bf16 v[112:115], v[40:43], a[104:107], v[112:115]
  buffer_load_dwordx4 v22, s[12:15], s19 offen lds
  v_mfma_f32_16x16x32_bf16 v[120:123], v[40:43], a[108:111], v[120:123]
  s_waitcnt lgkmcnt(5)
  v_mfma_f32_16x16x32_bf16 v[100:103], v[44:47], a[96:99], v[100:103]
  ds_read_b128 v[36:39], v11 offset:49152
  v_mfma_f32_16x16x32_bf16 v[108:111], v[44:47], a[100:103], v[108:111]
  v_mfma_f32_16x16x32_bf16 v[116:119], v[44:47], a[104:107], v[116:119]
  v_mfma_f32_16x16x32_bf16 v[124:127], v[44:47], a[108:111], v[124:127]
  s_waitcnt lgkmcnt(5)
  v_mfma_f32_16x16x32_bf16 v[96:99], v[48:51], a[112:115], v[96:99]
  s_add_u32 m0, s25, 7168
  ds_read_b128 v[40:43], v12 offset:49152
  v_mfma_f32_16x16x32_bf16 v[104:107], v[48:51], a[116:119], v[104:107]
  v_mfma_f32_16x16x32_bf16 v[112:115], v[48:51], a[120:123], v[112:115]
  buffer_load_dwordx4 v23, s[12:15], s19 offen lds
  v_mfma_f32_16x16x32_bf16 v[120:123], v[48:51], a[124:127], v[120:123]
  s_waitcnt lgkmcnt(5)
  v_mfma_f32_16x16x32_bf16 v[100:103], v[52:55], a[112:115], v[100:103]
  s_cmp_gt_u32 s23, 3
  ds_read_b128 v[44:47], v13 offset:49152
  v_mfma_f32_16x16x32_bf16 v[108:111], v[52:55], a[116:119], v[108:111]
  v_mfma_f32_16x16x32_bf16 v[116:119], v[52:55], a[120:123], v[116:119]
  s_cselect_b32 s26, s20, 0
  v_mfma_f32_16x16x32_bf16 v[124:127], v[52:55], a[124:127], v[124:127]
  s_waitcnt lgkmcnt(5)
  v_mfma_f32_16x16x32_bf16 v[96:99], v[24:27], a[128:131], v[96:99]
  s_add_u32 s19, s19, s26
  ds_read_b128 v[48:51], v14 offset:49152
  v_mfma_f32_16x16x32_bf16 v[104:107], v[24:27], a[132:135], v[104:107]
  v_mfma_f32_16x16x32_bf16 v[112:115], v[24:27], a[136:139], v[112:115]
  s_add_u32 s25, s25, 32768
  v_mfma_f32_16x16x32_bf16 v[120:123], v[24:27], a[140:143], v[120:123]
  s_waitcnt lgkmcnt(5)
  v_mfma_f32_16x16x32_bf16 v[100:103], v[28:31], a[128:131], v[100:103]
  s_and_b32 s25, s25, 0x1ffff
  ds_read_b128 v[52:55], v15 offset:49152
  v_mfma_f32_16x16x32_bf16 v[108:111], v[28:31], a[132:135], v[108:111]
  v_mfma_f32_16x16x32_bf16 v[116:119], v[28:31], a[136:139], v[116:119]
  buffer_store_dwordx4 v[128:131], v7, s[4:7], s21 offen offset:0 sc1
  v_mfma_f32_16x16x32_bf16 v[124:127], v[28:31], a[140:143], v[124:127]
  s_waitcnt lgkmcnt(5)
  v_mfma_f32_16x16x32_bf16 v[96:99], v[32:35], a[144:147], v[96:99]
  ds_read_b128 v[24:27], v8 offset:57344
  v_mfma_f32_16x16x32_bf16 v[104:107], v[32:35], a[148:151], v[104:107]
  v_mfma_f32_16x16x32_bf16 v[112:115], v[32:35], a[152:155], v[112:115]
  v_mfma_f32_16x16x32_bf16 v[120:123], v[32:35], a[156:159], v[120:123]
  s_waitcnt lgkmcnt(5)
  v_xor_b32 v8, 0x10000, v8
  v_mfma_f32_16x16x32_bf16 v[100:103], v[36:39], a[144:147], v[100:103]
  ds_read_b128 v[28:31], v9 offset:57344
  v_mfma_f32_16x16x32_bf16 v[108:111], v[36:39], a[148:151], v[108:111]
  v_mfma_f32_16x16x32_bf16 v[116:119], v[36:39], a[152:155], v[116:119]
  buffer_store_dwordx4 v[132:135], v7, s[4:7], s21 offen offset:256 sc1
  v_mfma_f32_16x16x32_bf16 v[124:127], v[36:39], a[156:159], v[124:127]
  s_waitcnt lgkmcnt(5)
  v_xor_b32 v9, 0x10000, v9
  v_mfma_f32_16x16x32_bf16 v[96:99], v[40:43], a[160:163], v[96:99]
  ds_read_b128 v[32:35], v10 offset:57344
  v_mfma_f32_16x16x32_bf16 v[104:107], v[40:43], a[164:167], v[104:107]
  v_mfma_f32_16x16x32_bf16 v[112:115], v[40:43], a[168:171], v[112:115]
  v_mfma_f32_16x16x32_bf16 v[120:123], v[40:43], a[172:175], v[120:123]
  s_waitcnt lgkmcnt(5)
  v_xor_b32 v10, 0x10000, v10
  v_mfma_f32_16x16x32_bf16 v[100:103], v[44:47], a[160:163], v[100:103]
  ds_read_b128 v[36:39], v11 offset:57344
  v_mfma_f32_16x16x32_bf16 v[108:111], v[44:47], a[164:167], v[108:111]
  v_mfma_f32_16x16x32_bf16 v[116:119], v[44:47], a[168:171], v[116:119]
  buffer_store_dwordx4 v[136:139], v7, s[4:7], s21 offen offset:2048 sc1
  v_mfma_f32_16x16x32_bf16 v[124:127], v[44:47], a[172:175], v[124:127]
  s_waitcnt lgkmcnt(5)
  v_xor_b32 v11, 0x10000, v11
  v_mfma_f32_16x16x32_bf16 v[96:99], v[48:51], a[176:179], v[96:99]
  ds_read_b128 v[40:43], v12 offset:57344
  v_mfma_f32_16x16x32_bf16 v[104:107], v[48:51], a[180:183], v[104:107]
  v_mfma_f32_16x16x32_bf16 v[112:115], v[48:51], a[184:187], v[112:115]
  v_mfma_f32_16x16x32_bf16 v[120:123], v[48:51], a[188:191], v[120:123]
  s_waitcnt lgkmcnt(5)
  v_xor_b32 v12, 0x10000, v12
  v_mfma_f32_16x16x32_bf16 v[100:103], v[52:55], a[176:179], v[100:103]
  ds_read_b128 v[44:47], v13 offset:57344
  v_mfma_f32_16x16x32_bf16 v[108:111], v[52:55], a[180:183], v[108:111]
  v_mfma_f32_16x16x32_bf16 v[116:119], v[52:55], a[184:187], v[116:119]
  buffer_store_dwordx4 v[140:143], v7, s[4:7], s21 offen offset:2304 sc1
  v_mfma_f32_16x16x32_bf16 v[124:127], v[52:55], a[188:191], v[124:127]
  s_waitcnt lgkmcnt(5)
  v_xor_b32 v13, 0x10000, v13
  v_mfma_f32_16x16x32_bf16 v[96:99], v[24:27], a[192:195], v[96:99]
  s_mov_b32 s21, s27
  ds_read_b128 v[48:51], v14 offset:57344
  v_mfma_f32_16x16x32_bf16 v[104:107], v[24:27], a[196:199], v[104:107]
  v_mov_b32 v7, v56
  v_mfma_f32_16x16x32_bf16 v[112:115], v[24:27], a[200:203], v[112:115]
  v_mfma_f32_16x16x32_bf16 v[120:123], v[24:27], a[204:207], v[120:123]
  s_waitcnt lgkmcnt(5)
  v_xor_b32 v14, 0x10000, v14
  v_mfma_f32_16x16x32_bf16 v[100:103], v[28:31], a[192:195], v[100:103]
  s_add_u32 s27, s27, s22
  ds_read_b128 v[52:55], v15 offset:57344
  v_mfma_f32_16x16x32_bf16 v[108:111], v[28:31], a[196:199], v[108:111]
  v_mfma_f32_16x16x32_bf16 v[116:119], v[28:31], a[200:203], v[116:119]
  s_waitcnt vmcnt(13)
  s_barrier
  v_mfma_f32_16x16x32_bf16 v[124:127], v[28:31], a[204:207], v[124:127]
  s_waitcnt lgkmcnt(5)
  v_xor_b32 v15, 0x10000, v15
  v_mfma_f32_16x16x32_bf16 v[96:99], v[32:35], a[208:211], v[96:99]
  ds_read_b128 v[24:27], v8 offset:0
  v_mfma_f32_16x16x32_bf16 v[104:107], v[32:35], a[212:215], v[104:107]
  v_mfma_f32_16x16x32_bf16 v[112:115], v[32:35], a[216:219], v[112:115]
  v_mfma_f32_16x16x32_bf16 v[120:123], v[32:35], a[220:223], v[120:123]
  s_waitcnt lgkmcnt(5)
  v_mfma_f32_16x16x32_bf16 v[100:103], v[36:39], a[208:211], v[100:103]
  s_add_u32 s29, s29, 1
  ds_read_b128 v[28:31], v9 offset:0
  v_mfma_f32_16x16x32_bf16 v[108:111], v[36:39], a[212:215], v[108:111]
  v_mfma_f32_16x16x32_bf16 v[116:119], v[36:39], a[216:219], v[116:119]
  s_max_i32 s30, s29, 0
  v_mfma_f32_16x16x32_bf16 v[124:127], v[36:39], a[220:223], v[124:127]
  s_waitcnt lgkmcnt(5)
  v_mov_b32 v144, s30
  v_mfma_f32_16x16x32_bf16 v[96:99], v[40:43], a[224:227], v[96:99]
  ds_read_b128 v[32:35], v10 offset:0
  v_mfma_f32_16x16x32_bf16 v[104:107], v[40:43], a[228:231], v[104:107]
  v_mfma_f32_16x16x32_bf16 v[112:115], v[40:43], a[232:235], v[112:115]
  buffer_store_dword v144, v145, s[4:7], s31 offen sc1
  v_mfma_f32_16x16x32_bf16 v[120:123], v[40:43], a[236:239], v[120:123]
  s_waitcnt lgkmcnt(5)
  v_mfma_f32_16x16x32_bf16 v[100:103], v[44:47], a[224:227], v[100:103]
  ds_read_b128 v[36:39], v11 offset:0
  v_mfma_f32_16x16x32_bf16 v[108:111], v[44:47], a[228:231], v[108:111]
  v_mfma_f32_16x16x32_bf16 v[116:119], v[44:47], a[232:235], v[116:119]
  v_mfma_f32_16x16x32_bf16 v[124:127], v[44:47], a[236:239], v[124:127]
  s_waitcnt lgkmcnt(5)
  v_mfma_f32_16x16x32_bf16 v[96:99], v[48:51], a[240:243], v[96:99]
  s_sub_u32 s23, s23, 1
  ds_read_b128 v[40:43], v12 offset:0
  v_mfma_f32_16x16x32_bf16 v[104:107], v[48:51], a[244:247], v[104:107]
  v_mfma_f32_16x16x32_bf16 v[112:115], v[48:51], a[248:251], v[112:115]
  v_mfma_f32_16x16x32_bf16 v[120:123], v[48:51], a[252:255], v[120:123]
  s_waitcnt lgkmcnt(5)
  v_mfma_f32_16x16x32_bf16 v[100:103], v[52:55], a[240:243], v[100:103]
  s_cmp_eq_u32 s23, 0
  ds_read_b128 v[44:47], v13 offset:0
  v_mfma_f32_16x16x32_bf16 v[108:111], v[52:55], a[244:247], v[108:111]
  v_mfma_f32_16x16x32_bf16 v[116:119], v[52:55], a[248:251], v[116:119]
  v_mfma_f32_16x16x32_bf16 v[124:127], v[52:55], a[252:255], v[124:127]
  s_cbranch_scc1 G_done1_14
  s_branch G_top_12
G_done0_13:
  s_nop 7
  s_nop 3
  v_cvt_pk_bf16_f32 v128, v64, v65
  v_cvt_pk_bf16_f32 v129, v66, v67
  v_cvt_pk_bf16_f32 v130, v68, v69
  v_cvt_pk_bf16_f32 v131, v70, v71
  buffer_store_dwordx4 v[128:131], v7, s[4:7], s21 offen offset:0 sc1
  v_cvt_pk_bf16_f32 v132, v72, v73
  v_cvt_pk_bf16_f32 v133, v74, v75
  v_cvt_pk_bf16_f32 v134, v76, v77
  v_cvt_pk_bf16_f32 v135, v78, v79
  buffer_store_dwordx4 v[132:135], v7, s[4:7], s21 offen offset:256 sc1
  v_cvt_pk_bf16_f32 v136, v80, v81
  v_cvt_pk_bf16_f32 v137, v82, v83
  v_cvt_pk_bf16_f32 v138, v84, v85
  v_cvt_pk_bf16_f32 v139, v86, v87
  buffer_store_dwordx4 v[136:139], v7, s[4:7], s21 offen offset:2048 sc1
  v_cvt_pk_bf16_f32 v140, v88, v89
  v_cvt_pk_bf16_f32 v141, v90, v91
  v_cvt_pk_bf16_f32 v142, v92, v93
  v_cvt_pk_bf16_f32 v143, v94, v95
  buffer_store_dwordx4 v[140:143], v7, s[4:7], s21 offen offset:2304 sc1
  s_branch G_fin_15
G_done1_14:
  s_nop 7
  s_nop 3
  v_cvt_pk_bf16_f32 v128, v96, v97
  v_cvt_pk_bf16_f32 v129, v98, v99
  v_cvt_pk_bf16_f32 v130, v100, v101
  v_cvt_pk_bf16_f32 v131, v102, v103
  buffer_store_dwordx4 v[128:131], v7, s[4:7], s21 offen offset:0 sc1
  v_cvt_pk_bf16_f32 v132, v104, v105
  v_cvt_pk_bf16_f32 v133, v106, v107
  v_cvt_pk_bf16_f32 v134, v108, v109
  v_cvt_pk_bf16_f32 v135, v110, v111
  buffer_store_dwordx4 v[132:135], v7, s[4:7], s21 offen offset:256 sc1
  v_cvt_pk_bf16_f32 v136, v112, v113
  v_cvt_pk_bf16_f32 v137, v114, v115
  v_cvt_pk_bf16_f32 v138, v116, v117
  v_cvt_pk_bf16_f32 v139, v118, v119
  buffer_store_dwordx4 v[136:139], v7, s[4:7], s21 offen offset:2048 sc1
  v_cvt_pk_bf16_f32 v140, v120, v121
  v_cvt_pk_bf16_f32 v141, v122, v123
  v_cvt_pk_bf16_f32 v142, v124, v125
  v_cvt_pk_bf16_f32 v143, v126, v127
  buffer_store_dwordx4 v[140:143], v7, s[4:7], s21 offen offset:2304 sc1
G_fin_15:
  s_waitcnt vmcnt(0) lgkmcnt(0)
  s_barrier
  s_add_u32 s30, s29, 2
  v_mov_b32 v144, s30
  v_min_u32 v145, 1, v0
  v_lshlrev_b32 v145, 30, v145
  buffer_store_dword v144, v145, s[4:7], s31 offen sc1
P_end_2:
  s_mov_b32 s71, 0
  s_branch M_sg_17
M_sw_16:
  s_sleep 8
  s_add_u32 s71, s71, 1
  s_cmp_gt_u32 s71, 262144
  s_cbranch_scc1 M_exit
M_sg_17:
  s_mov_b32 s79, 0
  s_atomic_or s79, s[74:75], 128 glc
  s_waitcnt lgkmcnt(0)
  s_cmp_lt_u32 s79, 256
  s_cbranch_scc1 M_sw_16
  s_cmp_eq_u32 s65, 6
  s_cbranch_scc1 M_follow
  s_mov_b32 s68, 0
  s_mov_b32 s36, -1
  s_mov_b32 s69, s53
  s_mov_b32 s70, s54
  s_load_dwordx2 s[8:9], s[0:1], 40
  s_mul_i32 s76, s64, 6
  s_add_u32 s76, s76, s65
  s_mul_i32 s76, s76, 21888
  v_min_u32 v200, 170, v0
  v_mul_u32_u24 v200, 128, v200
  v_add_u32 v200, s76, v200
  s_waitcnt lgkmcnt(0)
  s_and_b32 s9, s9, 0xffff
  s_mov_b32 s10, 4194304
  s_mov_b32 s11, 0x20000
M_att:
  s_mov_b32 s24, 0xf149f2ca
  s_mov_b32 s29, 0
  v_mov_b32 v6, 0
  v_mov_b32 v7, 0
  s_lshl_b32 s26, s16, 11
  v_add_u32 v3, s26, v2
  v_and_b32 v5, 31, v1
  v_lshrrev_b32 v12, 5, v1
  v_lshlrev_b32 v12, 2, v12
  v_sub_u32 v5, v5, v12
  s_lshl_b32 s26, s64, 19
  s_add_u32 s19, s26, 16777216
  s_add_u32 s20, s26, 33554432
  s_lshl_b32 s27, s69, 2
  s_add_u32 s27, s27, s16
  s_lshl_b32 s27, s27, 14
  s_add_u32 s25, s26, s27
  s_bfe_u32 s78, s70, 0x80000
  s_add_u32 s76, s67, 512
  s_mov_b32 s71, 0
  s_branch M_sg_19
M_sw_18:
  s_sleep 8
  s_add_u32 s71, s71, 1
  s_cmp_gt_u32 s71, 262144
  s_cbranch_scc1 M_exit
M_sg_19:
  s_mov_b32 s79, 0
  s_atomic_or s79, s[72:73], s76 glc
  s_waitcnt lgkmcnt(0)
  s_cmp_lt_u32 s79, s78
  s_cbranch_scc1 M_sw_18
  s_bfe_u32 s78, s70, 0x80008
  s_add_u32 s76, s67, 640
  s_mov_b32 s71, 0
  s_branch M_sg_21
M_sw_20:
  s_sleep 8
  s_add_u32 s71, s71, 1
  s_cmp_gt_u32 s71, 262144
  s_cbranch_scc1 M_exit
M_sg_21:
  s_mov_b32 s79, 0
  s_atomic_or s79, s[72:73], s76 glc
  s_waitcnt lgkmcnt(0)
  s_cmp_lt_u32 s79, s78
  s_cbranch_scc1 M_sw_20
  s_lshl_b32 s27, s69, 16
  s_add_u32 s27, s27, 16384
  s_add_u32 s17, s19, s27
M_kv_22:
  s_cmp_ge_u32 s17, s36
  s_cbranch_scc1 M_kvok_23
  s_mov_b32 s76, 0
  s_mov_b32 s78, 23
  s_mov_b32 s77, 335872
  s_cmp_eq_u32 s68, 1
  s_cmov_b32 s76, 128
  s_cmov_b32 s78, 27
  s_cmov_b32 s77, 114688
  s_cmp_eq_u32 s68, 2
  s_cmov_b32 s76, 768
  s_cmov_b32 s78, 14
  s_cmov_b32 s77, 0
  s_add_u32 s76, s76, s67
  s_mov_b32 s71, 0
  s_branch M_sg_25
M_sw_24:
  s_sleep 8
  s_add_u32 s71, s71, 1
  s_cmp_gt_u32 s71, 262144
  s_cbranch_scc1 M_exit
M_sg_25:
  s_mov_b32 s79, 0
  s_atomic_or s79, s[72:73], s76 glc
  s_waitcnt lgkmcnt(0)
  s_cmp_lt_u32 s79, s78
  s_cbranch_scc1 M_sw_24
  s_add_u32 s36, s77, s19
  s_add_u32 s68, s68, 1
  s_branch M_kv_22
M_kvok_23:
  s_add_u32 s28, s25, 0
  buffer_load_dwordx4 a[128:131], v2, s[4:7], s28 offen offset:0 sc1
  buffer_load_dwordx4 a[132:135], v2, s[4:7], s28 offen offset:1024 sc1
  buffer_load_dwordx4 a[136:139], v2, s[4:7], s28 offen offset:2048 sc1
  buffer_load_dwordx4 a[140:143], v2, s[4:7], s28 offen offset:3072 sc1
  s_add_u32 s28, s25, 4096
  buffer_load_dwordx4 a[144:147], v2, s[4:7], s28 offen offset:0 sc1
  buffer_load_dwordx4 a[148:151], v2, s[4:7], s28 offen offset:1024 sc1
  buffer_load_dwordx4 a[152:155], v2, s[4:7], s28 offen offset:2048 sc1
  buffer_load_dwordx4 a[156:159], v2, s[4:7], s28 offen offset:3072 sc1
  s_add_u32 s28, s25, 8192
  buffer_load_dwordx4 a[160:163], v2, s[4:7], s28 offen offset:0 sc1
  buffer_load_dwordx4 a[164:167], v2, s[4:7], s28 offen offset:1024 sc1
  buffer_load_dwordx4 a[168:171], v2, s[4:7], s28 offen offset:2048 sc1
  buffer_load_dwordx4 a[172:175], v2, s[4:7], s28 offen offset:3072 sc1
  s_add_u32 s28, s25, 12288
  buffer_load_dwordx4 a[176:179], v2, s[4:7], s28 offen offset:0 sc1
  buffer_load_dwordx4 a[180:183], v2, s[4:7], s28 offen offset:1024 sc1
  buffer_load_dwordx4 a[184:187], v2, s[4:7], s28 offen offset:2048 sc1
  buffer_load_dwordx4 a[188:191], v2, s[4:7], s28 offen offset:3072 sc1
A_again_26:
  s_lshl_b32 s27, s69, 16
  s_add_u32 s27, s27, 57344
  s_add_u32 s17, s19, s27
  s_add_u32 s18, s20, s27
  s_lshl_b32 s21, s16, 11
  s_mov_b32 m0, s21
  s_nop 0
  buffer_load_dwordx4 v3, s[4:7], s18 offen offset:0 sc1 lds
  buffer_load_dwordx4 v3, s[4:7], s18 offen offset:1024 sc1 lds
  s_add_u32 m0, s21, 8192
  s_nop 0
  buffer_load_dwordx4 v3, s[4:7], s17 offen offset:0 sc1 lds
  buffer_load_dwordx4 v3, s[4:7], s17 offen offset:1024 sc1 lds
  s_add_u32 s18, s18, 8192
  s_sub_u32 s18, s18, 8192
  s_max_i32 s18, s18, s20
  s_sub_u32 s17, s17, 8192
  s_max_i32 s17, s17, s19
  s_add_u32 s21, s21, 16384
  s_and_b32 s21, s21, 131071
  s_mov_b32 m0, s21
  s_nop 0
  buffer_load_dwordx4 v3, s[4:7], s18 offen offset:0 sc1 lds
  buffer_load_dwordx4 v3, s[4:7], s18 offen offset:1024 sc1 lds
  s_add_u32 m0, s21, 8192
  s_nop 0
  buffer_load_dwordx4 v3, s[4:7], s17 offen offset:0 sc1 lds
  buffer_load_dwordx4 v3, s[4:7], s17 offen offset:1024 sc1 lds
  s_sub_u32 s18, s18, 8192
  s_max_i32 s18, s18, s20
  s_sub_u32 s17, s17, 8192
  s_max_i32 s17, s17, s19
  s_add_u32 s21, s21, 16384
  s_and_b32 s21, s21, 131071
  s_mov_b32 m0, s21
  s_nop 0
  buffer_load_dwordx4 v3, s[4:7], s18 offen offset:0 sc1 lds
  buffer_load_dwordx4 v3, s[4:7], s18 offen offset:1024 sc1 lds
  s_add_u32 m0, s21, 8192
  s_nop 0
  buffer_load_dwordx4 v3, s[4:7], s17 offen offset:0 sc1 lds
  buffer_load_dwordx4 v3, s[4:7], s17 offen offset:1024 sc1 lds
  s_sub_u32 s18, s18, 8192
  s_max_i32 s18, s18, s20
  s_sub_u32 s17, s17, 8192
  s_max_i32 s17, s17, s19
  s_add_u32 s21, s21, 16384
  s_and_b32 s21, s21, 131071
  s_mov_b32 m0, s21
  s_nop 0
  buffer_load_dwordx4 v3, s[4:7], s18 offen offset:0 sc1 lds
  buffer_load_dwordx4 v3, s[4:7], s18 offen offset:1024 sc1 lds
  s_add_u32 m0, s21, 8192
  s_nop 0
  buffer_load_dwordx4 v3, s[4:7], s17 offen offset:0 sc1 lds
  buffer_load_dwordx4 v3, s[4:7], s17 offen offset:1024 sc1 lds
  s_sub_u32 s18, s18, 8192
  s_max_i32 s18, s18, s20
  s_sub_u32 s17, s17, 8192
  s_max_i32 s17, s17, s19
  s_add_u32 s21, s21, 16384
  s_and_b32 s21, s21, 131071
  s_mov_b32 m0, s21
  s_nop 0
  buffer_load_dwordx4 v3, s[4:7], s18 offen offset:0 sc1 lds
  buffer_load_dwordx4 v3, s[4:7], s18 offen offset:1024 sc1 lds
  s_add_u32 m0, s21, 8192
  s_nop 0
  buffer_load_dwordx4 v3, s[4:7], s17 offen offset:0 sc1 lds
  buffer_load_dwordx4 v3, s[4:7], s17 offen offset:1024 sc1 lds
  s_sub_u32 s18, s18, 8192
  s_max_i32 s18, s18, s20
  s_sub_u32 s17, s17, 8192
  s_max_i32 s17, s17, s19
  s_add_u32 s21, s21, 16384
  s_and_b32 s21, s21, 131071
  s_mov_b32 m0, s21
  s_nop 0
  buffer_load_dwordx4 v3, s[4:7], s18 offen offset:0 sc1 lds
  buffer_load_dwordx4 v3, s[4:7], s18 offen offset:1024 sc1 lds
  s_add_u32 m0, s21, 8192
  s_nop 0
  buffer_load_dwordx4 v3, s[4:7], s17 offen offset:0 sc1 lds
  buffer_load_dwordx4 v3, s[4:7], s17 offen offset:1024 sc1 lds
  v_accvgpr_write_b32 a0, 0
  v_accvgpr_write_b32 a1, 0
  v_accvgpr_write_b32 a2, 0
  v_accvgpr_write_b32 a3, 0
  v_accvgpr_write_b32 a4, 0
  v_accvgpr_write_b32 a5, 0
  v_accvgpr_write_b32 a6, 0
  v_accvgpr_write_b32 a7, 0
  v_accvgpr_write_b32 a8, 0
  v_accvgpr_write_b32 a9, 0
  v_accvgpr_write_b32 a10, 0
  v_accvgpr_write_b32 a11, 0
  v_accvgpr_write_b32 a12, 0
  v_accvgpr_write_b32 a13, 0
  v_accvgpr_write_b32 a14, 0
  v_accvgpr_write_b32 a15, 0
  v_accvgpr_write_b32 a16, 0
  v_accvgpr_write_b32 a17, 0
  v_accvgpr_write_b32 a18, 0
  v_accvgpr_write_b32 a19, 0
  v_accvgpr_write_b32 a20, 0
  v_accvgpr_write_b32 a21, 0
  v_accvgpr_write_b32 a22, 0
  v_accvgpr_write_b32 a23, 0
  v_accvgpr_write_b32 a24, 0
  v_accvgpr_write_b32 a25, 0
  v_accvgpr_write_b32 a26, 0
  v_accvgpr_write_b32 a27, 0
  v_accvgpr_write_b32 a28, 0
  v_accvgpr_write_b32 a29, 0
  v_accvgpr_write_b32 a30, 0
  v_accvgpr_write_b32 a31, 0
  v_accvgpr_write_b32 a32, 0
  v_accvgpr_write_b32 a33, 0
  v_accvgpr_write_b32 a34, 0
  v_accvgpr_write_b32 a35, 0
  v_accvgpr_write_b32 a36, 0
  v_accvgpr_write_b32 a37, 0
  v_accvgpr_write_b32 a38, 0
  v_accvgpr_write_b32 a39, 0
  v_accvgpr_write_b32 a40, 0
  v_accvgpr_write_b32 a41, 0
  v_accvgpr_write_b32 a42, 0
  v_accvgpr_write_b32 a43, 0
  v_accvgpr_write_b32 a44, 0
  v_accvgpr_write_b32 a45, 0
  v_accvgpr_write_b32 a46, 0
  v_accvgpr_write_b32 a47, 0
  v_accvgpr_write_b32 a48, 0
  v_accvgpr_write_b32 a49, 0
  v_accvgpr_write_b32 a50, 0
  v_accvgpr_write_b32 a51, 0
  v_accvgpr_write_b32 a52, 0
  v_accvgpr_write_b32 a53, 0
  v_accvgpr_write_b32 a54, 0
  v_accvgpr_write_b32 a55, 0
  v_accvgpr_write_b32 a56, 0
  v_accvgpr_write_b32 a57, 0
  v_accvgpr_write_b32 a58, 0
  v_accvgpr_write_b32 a59, 0
  v_accvgpr_write_b32 a60, 0
  v_accvgpr_write_b32 a61, 0
  v_accvgpr_write_b32 a62, 0
  v_accvgpr_write_b32 a63, 0
  v_accvgpr_write_b32 a64, 0
  v_accvgpr_write_b32 a65, 0
  v_accvgpr_write_b32 a66, 0
  v_accvgpr_write_b32 a67, 0
  v_accvgpr_write_b32 a68, 0
  v_accvgpr_write_b32 a69, 0
  v_accvgpr_write_b32 a70, 0
  v_accvgpr_write_b32 a71, 0
  v_accvgpr_write_b32 a72, 0
  v_accvgpr_write_b32 a73, 0
  v_accvgpr_write_b32 a74, 0
  v_accvgpr_write_b32 a75, 0
  v_accvgpr_write_b32 a76, 0
  v_accvgpr_write_b32 a77, 0
  v_accvgpr_write_b32 a78, 0
  v_accvgpr_write_b32 a79, 0
  v_accvgpr_write_b32 a80, 0
  v_accvgpr_write_b32 a81, 0
  v_accvgpr_write_b32 a82, 0
  v_accvgpr_write_b32 a83, 0
  v_accvgpr_write_b32 a84, 0
  v_accvgpr_write_b32 a85, 0
  v_accvgpr_write_b32 a86, 0
  v_accvgpr_write_b32 a87, 0
  v_accvgpr_write_b32 a88, 0
  v_accvgpr_write_b32 a89, 0
  v_accvgpr_write_b32 a90, 0
  v_accvgpr_write_b32 a91, 0
  v_accvgpr_write_b32 a92, 0
  v_accvgpr_write_b32 a93, 0
  v_accvgpr_write_b32 a94, 0
  v_accvgpr_write_b32 a95, 0
  v_accvgpr_write_b32 a96, 0
  v_accvgpr_write_b32 a97, 0
  v_accvgpr_write_b32 a98, 0
  v_accvgpr_write_b32 a99, 0
  v_accvgpr_write_b32 a100, 0
  v_accvgpr_write_b32 a101, 0
  v_accvgpr_write_b32 a102, 0
  v_accvgpr_write_b32 a103, 0
  v_accvgpr_write_b32 a104, 0
  v_accvgpr_write_b32 a105, 0
  v_accvgpr_write_b32 a106, 0
  v_accvgpr_write_b32 a107, 0
  v_accvgpr_write_b32 a108, 0
  v_accvgpr_write_b32 a109, 0
  v_accvgpr_write_b32 a110, 0
  v_accvgpr_write_b32 a111, 0
  v_accvgpr_write_b32 a112, 0
  v_accvgpr_write_b32 a113, 0
  v_accvgpr_write_b32 a114, 0
  v_accvgpr_write_b32 a115, 0
  v_accvgpr_write_b32 a116, 0
  v_accvgpr_write_b32 a117, 0
  v_accvgpr_write_b32 a118, 0
  v_accvgpr_write_b32 a119, 0
  v_accvgpr_write_b32 a120, 0
  v_accvgpr_write_b32 a121, 0
  v_accvgpr_write_b32 a122, 0
  v_accvgpr_write_b32 a123, 0
  v_accvgpr_write_b32 a124, 0
  v_accvgpr_write_b32 a125, 0
  v_accvgpr_write_b32 a126, 0
  v_accvgpr_write_b32 a127, 0
  v_mov_b32 v8, 0
  v_mov_b32 v9, 0
  v_mov_b32 v10, 0
  v_mov_b32 v11, 0
  v_mov_b32 v52, 0
  v_mov_b32 v53, 0
  v_mov_b32 v54, s24
  v_mov_b32 v55, s24
  v_mov_b32 v56, s24
  v_mov_b32 v57, s24
  v_mov_b32 v58, s24
  v_mov_b32 v59, s24
  v_mov_b32 v60, s24
  v_mov_b32 v61, s24
  v_mov_b32 v62, s24
  v_mov_b32 v63, s24
  v_mov_b32 v104, 0
  v_mov_b32 v105, 0
  v_mov_b32 v4, v2
  v_mov_b32 v64, s24
  v_mov_b32 v65, s24
  v_mov_b32 v66, s24
  v_mov_b32 v67, s24
  v_mov_b32 v68, s24
  v_mov_b32 v69, s24
  v_mov_b32 v70, s24
  v_mov_b32 v71, s24
  v_mov_b32 v72, s24
  v_mov_b32 v73, s24
  v_mov_b32 v74, s24
  v_mov_b32 v75, s24
  v_mov_b32 v76, s24
  v_mov_b32 v77, s24
  v_mov_b32 v78, s24
  v_mov_b32 v79, s24
  v_mov_b32 v12, s24
  v_cmp_le_i32 s[40:41], 0, v5
  v_cmp_le_i32 s[42:43], 1, v5
  v_cmp_le_i32 s[44:45], 2, v5
  v_cmp_le_i32 s[46:47], 3, v5
  v_cndmask_b32 v80, v12, v7, s[40:41]
  v_cndmask_b32 v81, v12, v7, s[42:43]
  v_cndmask_b32 v82, v12, v7, s[44:45]
  v_cndmask_b32 v83, v12, v7, s[46:47]
  v_cmp_le_i32 s[40:41], 8, v5
  v_cmp_le_i32 s[42:43], 9, v5
  v_cmp_le_i32 s[44:45], 10, v5
  v_cmp_le_i32 s[46:47], 11, v5
  v_cndmask_b32 v84, v12, v7, s[40:41]
  v_cndmask_b32 v85, v12, v7, s[42:43]
  v_cndmask_b32 v86, v12, v7, s[44:45]
  v_cndmask_b32 v87, v12, v7, s[46:47]
  v_cmp_le_i32 s[40:41], 16, v5
  v_cmp_le_i32 s[42:43], 17, v5
  v_cmp_le_i32 s[44:45], 18, v5
  v_cmp_le_i32 s[46:47], 19, v5
  v_cndmask_b32 v88, v12, v7, s[40:41]
  v_cndmask_b32 v89, v12, v7, s[42:43]
  v_cndmask_b32 v90, v12, v7, s[44:45]
  v_cndmask_b32 v91, v12, v7, s[46:47]
  v_cmp_le_i32 s[40:41], 24, v5
  v_cmp_le_i32 s[42:43], 25, v5
  v_cmp_le_i32 s[44:45], 26, v5
  v_cmp_le_i32 s[46:47], 27, v5
  v_cndmask_b32 v92, v12, v7, s[40:41]
  v_cndmask_b32 v93, v12, v7, s[42:43]
  v_cndmask_b32 v94, v12, v7, s[44:45]
  v_cndmask_b32 v95, v12, v7, s[46:47]
  s_lshl_b32 s22, s69, 3
  s_add_u32 s22, s22, 8
  s_lshl_b32 s26, s16, 1
  s_sub_u32 s23, 6, s26
  s_waitcnt vmcnt(20)
  s_barrier
  s_cmp_eq_u32 s23, 0
  s_cbranch_scc1 A_go_28
A_idle_27:
  s_waitcnt vmcnt(16)
  s_barrier
  s_sub_u32 s18, s18, 8192
  s_max_i32 s18, s18, s20
  s_sub_u32 s17, s17, 8192
  s_max_i32 s17, s17, s19
  s_add_u32 s21, s21, 16384
  s_and_b32 s21, s21, 131071
M_kv_29:
  s_cmp_ge_u32 s17, s36
  s_cbranch_scc1 M_kvok_30
  s_mov_b32 s76, 0
  s_mov_b32 s78, 23
  s_mov_b32 s77, 335872
  s_cmp_eq_u32 s68, 1
  s_cmov_b32 s76, 128
  s_cmov_b32 s78, 27
  s_cmov_b32 s77, 114688
  s_cmp_eq_u32 s68, 2
  s_cmov_b32 s76, 768
  s_cmov_b32 s78, 14
  s_cmov_b32 s77, 0
  s_add_u32 s76, s76, s67
  s_mov_b32 s71, 0
  s_branch M_sg_32
M_sw_31:
  s_sleep 8
  s_add_u32 s71, s71, 1
  s_cmp_gt_u32 s71, 262144
  s_cbranch_scc1 M_exit
M_sg_32:
  s_mov_b32 s79, 0
  s_atomic_or s79, s[72:73], s76 glc
  s_waitcnt lgkmcnt(0)
  s_cmp_lt_u32 s79, s78
  s_cbranch_scc1 M_sw_31
  s_add_u32 s36, s77, s19
  s_add_u32 s68, s68, 1
  s_branch M_kv_29
M_kvok_30:
  s_mov_b32 m0, s21
  s_nop 0
  buffer_load_dwordx4 v3, s[4:7], s18 offen offset:0 sc1 lds
  buffer_load_dwordx4 v3, s[4:7], s18 offen offset:1024 sc1 lds
  s_add_u32 m0, s21, 8192
  s_nop 0
  buffer_load_dwordx4 v3, s[4:7], s17 offen offset:0 sc1 lds
  buffer_load_dwordx4 v3, s[4:7], s17 offen offset:1024 sc1 lds
  v_add_u32 v4, 16384, v4
  v_and_b32 v4, 131071, v4
  s_sub_u32 s22, s22, 1
  s_sub_u32 s23, s23, 1
  s_cmp_lg_u32 s23, 0
  s_cbranch_scc1 A_idle_27
A_go_28:
  ds_read_b128 a[224:227], v4 offset:0
  ds_read_b128 a[228:231], v4 offset:2048
  ds_read_b128 a[232:235], v4 offset:4096
  ds_read_b128 a[236:239], v4 offset:6144
  ds_read_b128 a[240:243], v4 offset:1024
  ds_read_b128 a[244:247], v4 offset:3072
  ds_read_b128 a[248:251], v4 offset:5120
  ds_read_b128 a[252:255], v4 offset:7168
  ds_read_b128 a[192:195], v4 offset:8192
  ds_read_b128 a[196:199], v4 offset:9216
  ds_read_b128 a[200:203], v4 offset:10240
  ds_read_b128 a[204:207], v4 offset:11264
  ds_read_b128 a[208:211], v4 offset:12288
  ds_read_b128 a[212:215], v4 offset:13312
  ds_read_b128 a[216:219], v4 offset:14336
  ds_read_b128 a[220:223], v4 offset:15360
  v_add_u32 v4, 16384, v4
  v_and_b32 v4, 131071, v4
  s_waitcnt lgkmcnt(8)
.p2align 6
A_top_33:
  s_waitcnt lgkmcnt(7)
  v_mfma_f32_32x32x16_bf16 v[32:47], a[192:195], a[128:131], v[64:79]
  s_waitcnt lgkmcnt(6)
  v_exp_f32 v54, v54
  v_add_f32 v11, v11, v53
  v_cvt_pk_bf16_f32 v106, v52, v53
  v_mfma_f32_32x32x16_bf16 v[32:47], a[196:199], a[132:135], v[32:47]
  s_waitcnt lgkmcnt(4)
  v_exp_f32 v55, v55
  v_add_f32 v10, v10, v54
  v_mfma_f32_32x32x16_bf16 v[32:47], a[200:203], a[136:139], v[32:47]
  v_exp_f32 v56, v56
  v_add_f32 v11, v11, v55
  v_cvt_pk_bf16_f32 v107, v54, v55
  v_mfma_f32_32x32x16_bf16 v[32:47], a[204:207], a[140:143], v[32:47]
  s_waitcnt lgkmcnt(2)
  v_exp_f32 v57, v57
  v_add_f32 v10, v10, v56
  v_mfma_f32_32x32x16_bf16 v[32:47], a[208:211], a[144:147], v[32:47]
  v_exp_f32 v58, v58
  v_add_f32 v11, v11, v57
  v_cvt_pk_bf16_f32 v108, v56, v57
  v_mfma_f32_32x32x16_bf16 v[32:47], a[212:215], a[148:151], v[32:47]
  s_waitcnt lgkmcnt(0)
  v_exp_f32 v59, v59
  v_add_f32 v10, v10, v58
  v_mfma_f32_32x32x16_bf16 v[32:47], a[216:219], a[152:155], v[32:47]
  v_exp_f32 v60, v60
  v_add_f32 v11, v11, v59
  v_cvt_pk_bf16_f32 v109, v58, v59
  v_mfma_f32_32x32x16_bf16 v[32:47], a[220:223], a[156:159], v[32:47]
  s_waitcnt vmcnt(16)
  s_barrier
  v_exp_f32 v61, v61
  v_add_f32 v10, v10, v60
  v_mfma_f32_32x32x16_bf16 a[64:79], a[224:227], v[104:107], a[64:79]
  ds_read_b128 a[224:227], v4 offset:0
  v_exp_f32 v62, v62
  v_add_f32 v11, v11, v61
  v_cvt_pk_bf16_f32 v110, v60, v61
  v_mfma_f32_32x32x16_bf16 a[80:95], a[228:231], v[104:107], a[80:95]
  s_sub_u32 s18, s18, 8192
  ds_read_b128 a[228:231], v4 offset:2048
  v_exp_f32 v63, v63
  v_add_f32 v10, v10, v62
  v_mfma_f32_32x32x16_bf16 a[96:111], a[232:235], v[104:107], a[96:111]
  s_max_i32 s18, s18, s20
  ds_read_b128 a[232:235], v4 offset:4096
  v_exp_f32 v32, v32
  v_add_f32 v11, v11, v63
  v_cvt_pk_bf16_f32 v111, v62, v63
  v_mfma_f32_32x32x16_bf16 a[112:127], a[236:239], v[104:107], a[112:127]
  s_sub_u32 s17, s17, 8192
  ds_read_b128 a[236:239], v4 offset:6144
  v_exp_f32 v33, v33
  v_add_f32 v8, v8, v32
  v_mfma_f32_32x32x16_bf16 a[64:79], a[240:243], v[108:111], a[64:79]
  s_max_i32 s17, s17, s19
  ds_read_b128 a[240:243], v4 offset:1024
  v_exp_f32 v34, v34
  v_add_f32 v9, v9, v33
  v_cvt_pk_bf16_f32 v96, v32, v33
  v_mfma_f32_32x32x16_bf16 a[80:95], a[244:247], v[108:111], a[80:95]
  s_add_u32 s21, s21, 16384
  ds_read_b128 a[244:247], v4 offset:3072
  v_exp_f32 v35, v35
  v_add_f32 v8, v8, v34
  v_mfma_f32_32x32x16_bf16 a[96:111], a[248:251], v[108:111], a[96:111]
  s_and_b32 s21, s21, 131071
  ds_read_b128 a[248:251], v4 offset:5120
  v_exp_f32 v36, v36
  v_add_f32 v9, v9, v35
  v_cvt_pk_bf16_f32 v97, v34, v35
  v_mfma_f32_32x32x16_bf16 a[112:127], a[252:255], v[108:111], a[112:127]
  ds_read_b128 a[252:255], v4 offset:7168
  v_exp_f32 v37, v37
  v_add_f32 v8, v8, v36
  v_mfma_f32_32x32x16_bf16 v[48:63], a[192:195], a[160:163], v[80:95]
  s_add_u32 s23, s23, 1
  ds_read_b128 a[192:195], v4 offset:8192
  v_exp_f32 v38, v38
  v_add_f32 v9, v9, v37
  v_cvt_pk_bf16_f32 v98, v36, v37
  v_mfma_f32_32x32x16_bf16 v[48:63], a[196:199], a[164:167], v[48:63]
  s_sub_u32 s22, s22, 1
  ds_read_b128 a[196:199], v4 offset:9216
  v_exp_f32 v39, v39
  v_add_f32 v8, v8, v38
  v_mfma_f32_32x32x16_bf16 v[48:63], a[200:203], a[168:171], v[48:63]
  s_cmp_lt_u32 s23, 3
  ds_read_b128 a[200:203], v4 offset:10240
  v_exp_f32 v40, v40
  v_add_f32 v9, v9, v39
  v_cvt_pk_bf16_f32 v99, v38, v39
  v_mfma_f32_32x32x16_bf16 v[48:63], a[204:207], a[172:175], v[48:63]
  s_cbranch_scc1 A_upd_34
A_back_35:
  ds_read_b128 a[204:207], v4 offset:11264
  v_exp_f32 v41, v41
  v_add_f32 v8, v8, v40
  v_mfma_f32_32x32x16_bf16 v[48:63], a[208:211], a[176:179], v[48:63]
  s_cmp_lt_u32 s17, s36
  ds_read_b128 a[208:211], v4 offset:12288
  v_exp_f32 v42, v42
  v_add_f32 v9, v9, v41
  v_cvt_pk_bf16_f32 v100, v40, v41
  v_mfma_f32_32x32x16_bf16 v[48:63], a[212:215], a[180:183], v[48:63]
  s_cbranch_scc1 A_kvw_37
A_kvb_38:
  ds_read_b128 a[212:215], v4 offset:13312
  v_exp_f32 v43, v43
  v_add_f32 v8, v8, v42
  v_mfma_f32_32x32x16_bf16 v[48:63], a[216:219], a[184:187], v[48:63]
  s_mov_b32 m0, s21
  ds_read_b128 a[216:219], v4 offset:14336
  v_exp_f32 v44, v44
  v_add_f32 v9, v9, v43
  v_cvt_pk_bf16_f32 v101, v42, v43
  v_mfma_f32_32x32x16_bf16 v[48:63], a[220:223], a[188:191], v[48:63]
  s_waitcnt lgkmcnt(13)
  ds_read_b128 a[220:223], v4 offset:15360
  v_exp_f32 v45, v45
  v_add_f32 v8, v8, v44
  v_mfma_f32_32x32x16_bf16 a[0:15], a[224:227], v[96:99], a[0:15]
  buffer_load_dwordx4 v3, s[4:7], s18 offen offset:0 sc1 lds
  v_exp_f32 v46, v46
  v_add_f32 v9, v9, v45
  v_cvt_pk_bf16_f32 v102, v44, v45
  v_mfma_f32_32x32x16_bf16 a[16:31], a[228:231], v[96:99], a[16:31]
  s_waitcnt lgkmcnt(12)
  v_exp_f32 v47, v47
  v_add_f32 v8, v8, v46
  v_add_u32 v4, 16384, v4
  v_mfma_f32_32x32x16_bf16 a[32:47], a[232:235], v[96:99], a[32:47]
  buffer_load_dwordx4 v3, s[4:7], s18 offen offset:1024 sc1 lds
  v_exp_f32 v48, v48
  v_add_f32 v9, v9, v47
  v_cvt_pk_bf16_f32 v103, v46, v47
  v_mfma_f32_32x32x16_bf16 a[48:63], a[236:239], v[96:99], a[48:63]
  s_waitcnt lgkmcnt(10)
  s_add_u32 m0, s21, 8192
  v_exp_f32 v49, v49
  v_add_f32 v10, v10, v48
  v_and_b32 v4, 131071, v4
  v_mfma_f32_32x32x16_bf16 a[0:15], a[240:243], v[100:103], a[0:15]
  buffer_load_dwordx4 v3, s[4:7], s17 offen offset:0 sc1 lds
  v_exp_f32 v50, v50
  v_add_f32 v11, v11, v49
  v_cvt_pk_bf16_f32 v104, v48, v49
  v_mfma_f32_32x32x16_bf16 a[16:31], a[244:247], v[100:103], a[16:31]
  s_waitcnt lgkmcnt(8)
  s_cmp_lg_u32 s22, 0
  v_exp_f32 v51, v51
  v_add_f32 v10, v10, v50
  v_mfma_f32_32x32x16_bf16 a[32:47], a[248:251], v[100:103], a[32:47]
  buffer_load_dwordx4 v3, s[4:7], s17 offen offset:1024 sc1 lds
  v_exp_f32 v52, v52
  v_add_f32 v11, v11, v51
  v_cvt_pk_bf16_f32 v105, v50, v51
  v_mfma_f32_32x32x16_bf16 a[48:63], a[252:255], v[100:103], a[48:63]
  v_exp_f32 v53, v53
  v_add_f32 v10, v10, v52
  s_cbranch_scc1 A_top_33
  v_exp_f32 v54, v54
  v_add_f32 v11, v11, v53
  v_cvt_pk_bf16_f32 v106, v52, v53
  v_exp_f32 v55, v55
  v_add_f32 v10, v10, v54
  v_exp_f32 v56, v56
  v_add_f32 v11, v11, v55
  v_cvt_pk_bf16_f32 v107, v54, v55
  v_exp_f32 v57, v57
  v_add_f32 v10, v10, v56
  v_exp_f32 v58, v58
  v_add_f32 v11, v11, v57
  v_cvt_pk_bf16_f32 v108, v56, v57
  v_exp_f32 v59, v59
  v_add_f32 v10, v10, v58
  v_exp_f32 v60, v60
  v_add_f32 v11, v11, v59
  v_cvt_pk_bf16_f32 v109, v58, v59
  v_exp_f32 v61, v61
  v_add_f32 v10, v10, v60
  v_exp_f32 v62, v62
  v_add_f32 v11, v11, v61
  v_cvt_pk_bf16_f32 v110, v60, v61
  v_exp_f32 v63, v63
  v_add_f32 v10, v10, v62
  v_add_f32 v11, v11, v63
  v_cvt_pk_bf16_f32 v111, v62, v63
  s_nop 1
  v_mfma_f32_32x32x16_bf16 a[64:79], a[224:227], v[104:107], a[64:79]
  v_mfma_f32_32x32x16_bf16 a[80:95], a[228:231], v[104:107], a[80:95]
  v_mfma_f32_32x32x16_bf16 a[96:111], a[232:235], v[104:107], a[96:111]
  v_mfma_f32_32x32x16_bf16 a[112:127], a[236:239], v[104:107], a[112:127]
  v_mfma_f32_32x32x16_bf16 a[64:79], a[240:243], v[108:111], a[64:79]
  v_mfma_f32_32x32x16_bf16 a[80:95], a[244:247], v[108:111], a[80:95]
  v_mfma_f32_32x32x16_bf16 a[96:111], a[248:251], v[108:111], a[96:111]
  v_mfma_f32_32x32x16_bf16 a[112:127], a[252:255], v[108:111], a[112:127]
  v_add_f32 v8, v8, v9
  v_mov_b32 v9, v8
  s_nop 1
  v_permlane32_swap_b32 v8, v9
  s_nop 1
  v_add_f32 v8, v8, v9
  v_add_f32 v10, v10, v11
  v_mov_b32 v11, v10
  s_nop 1
  v_permlane32_swap_b32 v10, v11
  s_nop 1
  v_add_f32 v10, v10, v11
  v_subrev_u32 v12, 0x2f800000, v8
  v_subrev_u32 v13, 0x2f800000, v10
  v_max_u32 v12, v12, v13
  v_cmp_le_u32 vcc, 0x28000000, v12
  s_nop 1
  s_cmp_lg_u64 vcc, 0
  s_cselect_b32 s26, 1, 0
  v_mov_b32 v12, s26
  s_lshl_b32 s26, s16, 2
  s_add_u32 s26, s26, 131072
  v_mov_b32 v13, s26
  ds_write_b32 v13, v12
  v_mov_b32 v14, 131072
  s_waitcnt vmcnt(0) lgkmcnt(0)
  s_barrier
  ds_read_b128 v[16:19], v14
  v_rcp_f32 v8, v8
  v_rcp_f32 v10, v10
  s_waitcnt lgkmcnt(0)
  v_or3_b32 v12, v16, v17, v18
  v_or_b32 v12, v12, v19
  s_nop 0
  v_readfirstlane_b32 s26, v12
  s_nop 1
  s_cmp_gt_u32 s26, s29
  s_cbranch_scc1 A_slow_39
  s_add_u32 s28, s25, 100663296
  v_accvgpr_read_b32 v112, a0
  v_accvgpr_read_b32 v113, a1
  v_accvgpr_read_b32 v114, a2
  v_accvgpr_read_b32 v115, a3
  v_accvgpr_read_b32 v116, a4
  v_accvgpr_read_b32 v117, a5
  v_accvgpr_read_b32 v118, a6
  v_accvgpr_read_b32 v119, a7
  v_pk_mul_f32 v[112:113], v[112:113], v[8:9] op_sel_hi:[1,0]
  v_pk_mul_f32 v[114:115], v[114:115], v[8:9] op_sel_hi:[1,0]
  v_pk_mul_f32 v[116:117], v[116:117], v[8:9] op_sel_hi:[1,0]
  v_pk_mul_f32 v[118:119], v[118:119], v[8:9] op_sel_hi:[1,0]
  v_cvt_pk_bf16_f32 v120, v112, v113
  v_cvt_pk_bf16_f32 v121, v114, v115
  v_cvt_pk_bf16_f32 v122, v116, v117
  v_cvt_pk_bf16_f32 v123, v118, v119
  buffer_store_dwordx4 v[120:123], v2, s[4:7], s28 offen offset:0 sc1
  v_accvgpr_read_b32 v124, a8
  v_accvgpr_read_b32 v125, a9
  v_accvgpr_read_b32 v126, a10
  v_accvgpr_read_b32 v127, a11
  v_accvgpr_read_b32 v128, a12
  v_accvgpr_read_b32 v129, a13
  v_accvgpr_read_b32 v130, a14
  v_accvgpr_read_b32 v131, a15
  v_pk_mul_f32 v[124:125], v[124:125], v[8:9] op_sel_hi:[1,0]
  v_pk_mul_f32 v[126:127], v[126:127], v[8:9] op_sel_hi:[1,0]
  v_pk_mul_f32 v[128:129], v[128:129], v[8:9] op_sel_hi:[1,0]
  v_pk_mul_f32 v[130:131], v[130:131], v[8:9] op_sel_hi:[1,0]
  v_cvt_pk_bf16_f32 v132, v124, v125
  v_cvt_pk_bf16_f32 v133, v126, v127
  v_cvt_pk_bf16_f32 v134, v128, v129
  v_cvt_pk_bf16_f32 v135, v130, v131
  buffer_store_dwordx4 v[132:135], v2, s[4:7], s28 offen offset:1024 sc1
  v_accvgpr_read_b32 v136, a16
  v_accvgpr_read_b32 v137, a17
  v_accvgpr_read_b32 v138, a18
  v_accvgpr_read_b32 v139, a19
  v_accvgpr_read_b32 v140, a20
  v_accvgpr_read_b32 v141, a21
  v_accvgpr_read_b32 v142, a22
  v_accvgpr_read_b32 v143, a23
  v_pk_mul_f32 v[136:137], v[136:137], v[8:9] op_sel_hi:[1,0]
  v_pk_mul_f32 v[138:139], v[138:139], v[8:9] op_sel_hi:[1,0]
  v_pk_mul_f32 v[140:141], v[140:141], v[8:9] op_sel_hi:[1,0]
  v_pk_mul_f32 v[142:143], v[142:143], v[8:9] op_sel_hi:[1,0]
  v_cvt_pk_bf16_f32 v144, v136, v137
  v_cvt_pk_bf16_f32 v145, v138, v139
  v_cvt_pk_bf16_f32 v146, v140, v141
  v_cvt_pk_bf16_f32 v147, v142, v143
  buffer_store_dwordx4 v[144:147], v2, s[4:7], s28 offen offset:2048 sc1
  v_accvgpr_read_b32 v148, a24
  v_accvgpr_read_b32 v149, a25
  v_accvgpr_read_b32 v150, a26
  v_accvgpr_read_b32 v151, a27
  v_accvgpr_read_b32 v152, a28
  v_accvgpr_read_b32 v153, a29
  v_accvgpr_read_b32 v154, a30
  v_accvgpr_read_b32 v155, a31
  v_pk_mul_f32 v[148:149], v[148:149], v[8:9] op_sel_hi:[1,0]
  v_pk_mul_f32 v[150:151], v[150:151], v[8:9] op_sel_hi:[1,0]
  v_pk_mul_f32 v[152:153], v[152:153], v[8:9] op_sel_hi:[1,0]
  v_pk_mul_f32 v[154:155], v[154:155], v[8:9] op_sel_hi:[1,0]
  v_cvt_pk_bf16_f32 v156, v148, v149
  v_cvt_pk_bf16_f32 v157, v150, v151
  v_cvt_pk_bf16_f32 v158, v152, v153
  v_cvt_pk_bf16_f32 v159, v154, v155
  buffer_store_dwordx4 v[156:159], v2, s[4:7], s28 offen offset:3072 sc1
  s_add_u32 s28, s25, 100667392
  v_accvgpr_read_b32 v112, a32
  v_accvgpr_read_b32 v113, a33
  v_accvgpr_read_b32 v114, a34
  v_accvgpr_read_b32 v115, a35
  v_accvgpr_read_b32 v116, a36
  v_accvgpr_read_b32 v117, a37
  v_accvgpr_read_b32 v118, a38
  v_accvgpr_read_b32 v119, a39
  v_pk_mul_f32 v[112:113], v[112:113], v[8:9] op_sel_hi:[1,0]
  v_pk_mul_f32 v[114:115], v[114:115], v[8:9] op_sel_hi:[1,0]
  v_pk_mul_f32 v[116:117], v[116:117], v[8:9] op_sel_hi:[1,0]
  v_pk_mul_f32 v[118:119], v[118:119], v[8:9] op_sel_hi:[1,0]
  v_cvt_pk_bf16_f32 v120, v112, v113
  v_cvt_pk_bf16_f32 v121, v114, v115
  v_cvt_pk_bf16_f32 v122, v116, v117
  v_cvt_pk_bf16_f32 v123, v118, v119
  buffer_store_dwordx4 v[120:123], v2, s[4:7], s28 offen offset:0 sc1
  v_accvgpr_read_b32 v124, a40
  v_accvgpr_read_b32 v125, a41
  v_accvgpr_read_b32 v126, a42
  v_accvgpr_read_b32 v127, a43
  v_accvgpr_read_b32 v128, a44
  v_accvgpr_read_b32 v129, a45
  v_accvgpr_read_b32 v130, a46
  v_accvgpr_read_b32 v131, a47
  v_pk_mul_f32 v[124:125], v[124:125], v[8:9] op_sel_hi:[1,0]
  v_pk_mul_f32 v[126:127], v[126:127], v[8:9] op_sel_hi:[1,0]
  v_pk_mul_f32 v[128:129], v[128:129], v[8:9] op_sel_hi:[1,0]
  v_pk_mul_f32 v[130:131], v[130:131], v[8:9] op_sel_hi:[1,0]
  v_cvt_pk_bf16_f32 v132, v124, v125
  v_cvt_pk_bf16_f32 v133, v126, v127
  v_cvt_pk_bf16_f32 v134, v128, v129
  v_cvt_pk_bf16_f32 v135, v130, v131
  buffer_store_dwordx4 v[132:135], v2, s[4:7], s28 offen offset:1024 sc1
  v_accvgpr_read_b32 v136, a48
  v_accvgpr_read_b32 v137, a49
  v_accvgpr_read_b32 v138, a50
  v_accvgpr_read_b32 v139, a51
  v_accvgpr_read_b32 v140, a52
  v_accvgpr_read_b32 v141, a53
  v_accvgpr_read_b32 v142, a54
  v_accvgpr_read_b32 v143, a55
  v_pk_mul_f32 v[136:137], v[136:137], v[8:9] op_sel_hi:[1,0]
  v_pk_mul_f32 v[138:139], v[138:139], v[8:9] op_sel_hi:[1,0]
  v_pk_mul_f32 v[140:141], v[140:141], v[8:9] op_sel_hi:[1,0]
  v_pk_mul_f32 v[142:143], v[142:143], v[8:9] op_sel_hi:[1,0]
  v_cvt_pk_bf16_f32 v144, v136, v137
  v_cvt_pk_bf16_f32 v145, v138, v139
  v_cvt_pk_bf16_f32 v146, v140, v141
  v_cvt_pk_bf16_f32 v147, v142, v143
  buffer_store_dwordx4 v[144:147], v2, s[4:7], s28 offen offset:2048 sc1
  v_accvgpr_read_b32 v148, a56
  v_accvgpr_read_b32 v149, a57
  v_accvgpr_read_b32 v150, a58
  v_accvgpr_read_b32 v151, a59
  v_accvgpr_read_b32 v152, a60
  v_accvgpr_read_b32 v153, a61
  v_accvgpr_read_b32 v154, a62
  v_accvgpr_read_b32 v155, a63
  v_pk_mul_f32 v[148:149], v[148:149], v[8:9] op_sel_hi:[1,0]
  v_pk_mul_f32 v[150:151], v[150:151], v[8:9] op_sel_hi:[1,0]
  v_pk_mul_f32 v[152:153], v[152:153], v[8:9] op_sel_hi:[1,0]
  v_pk_mul_f32 v[154:155], v[154:155], v[8:9] op_sel_hi:[1,0]
  v_cvt_pk_bf16_f32 v156, v148, v149
  v_cvt_pk_bf16_f32 v157, v150, v151
  v_cvt_pk_bf16_f32 v158, v152, v153
  v_cvt_pk_bf16_f32 v159, v154, v155
  buffer_store_dwordx4 v[156:159], v2, s[4:7], s28 offen offset:3072 sc1
  s_add_u32 s28, s25, 100671488
  v_accvgpr_read_b32 v112, a64
  v_accvgpr_read_b32 v113, a65
  v_accvgpr_read_b32 v114, a66
  v_accvgpr_read_b32 v115, a67
  v_accvgpr_read_b32 v116, a68
  v_accvgpr_read_b32 v117, a69
  v_accvgpr_read_b32 v118, a70
  v_accvgpr_read_b32 v119, a71
  v_pk_mul_f32 v[112:113], v[112:113], v[10:11] op_sel_hi:[1,0]
  v_pk_mul_f32 v[114:115], v[114:115], v[10:11] op_sel_hi:[1,0]
  v_pk_mul_f32 v[116:117], v[116:117], v[10:11] op_sel_hi:[1,0]
  v_pk_mul_f32 v[118:119], v[118:119], v[10:11] op_sel_hi:[1,0]
  v_cvt_pk_bf16_f32 v120, v112, v113
  v_cvt_pk_bf16_f32 v121, v114, v115
  v_cvt_pk_bf16_f32 v122, v116, v117
  v_cvt_pk_bf16_f32 v123, v118, v119
  buffer_store_dwordx4 v[120:123], v2, s[4:7], s28 offen offset:0 sc1
  v_accvgpr_read_b32 v124, a72
  v_accvgpr_read_b32 v125, a73
  v_accvgpr_read_b32 v126, a74
  v_accvgpr_read_b32 v127, a75
  v_accvgpr_read_b32 v128, a76
  v_accvgpr_read_b32 v129, a77
  v_accvgpr_read_b32 v130, a78
  v_accvgpr_read_b32 v131, a79
  v_pk_mul_f32 v[124:125], v[124:125], v[10:11] op_sel_hi:[1,0]
  v_pk_mul_f32 v[126:127], v[126:127], v[10:11] op_sel_hi:[1,0]
  v_pk_mul_f32 v[128:129], v[128:129], v[10:11] op_sel_hi:[1,0]
  v_pk_mul_f32 v[130:131], v[130:131], v[10:11] op_sel_hi:[1,0]
  v_cvt_pk_bf16_f32 v132, v124, v125
  v_cvt_pk_bf16_f32 v133, v126, v127
  v_cvt_pk_bf16_f32 v134, v128, v129
  v_cvt_pk_bf16_f32 v135, v130, v131
  buffer_store_dwordx4 v[132:135], v2, s[4:7], s28 offen offset:1024 sc1
  v_accvgpr_read_b32 v136, a80
  v_accvgpr_read_b32 v137, a81
  v_accvgpr_read_b32 v138, a82
  v_accvgpr_read_b32 v139, a83
  v_accvgpr_read_b32 v140, a84
  v_accvgpr_read_b32 v141, a85
  v_accvgpr_read_b32 v142, a86
  v_accvgpr_read_b32 v143, a87
  v_pk_mul_f32 v[136:137], v[136:137], v[10:11] op_sel_hi:[1,0]
  v_pk_mul_f32 v[138:139], v[138:139], v[10:11] op_sel_hi:[1,0]
  v_pk_mul_f32 v[140:141], v[140:141], v[10:11] op_sel_hi:[1,0]
  v_pk_mul_f32 v[142:143], v[142:143], v[10:11] op_sel_hi:[1,0]
  v_cvt_pk_bf16_f32 v144, v136, v137
  v_cvt_pk_bf16_f32 v145, v138, v139
  v_cvt_pk_bf16_f32 v146, v140, v141
  v_cvt_pk_bf16_f32 v147, v142, v143
  buffer_store_dwordx4 v[144:147], v2, s[4:7], s28 offen offset:2048 sc1
  v_accvgpr_read_b32 v148, a88
  v_accvgpr_read_b32 v149, a89
  v_accvgpr_read_b32 v150, a90
  v_accvgpr_read_b32 v151, a91
  v_accvgpr_read_b32 v152, a92
  v_accvgpr_read_b32 v153, a93
  v_accvgpr_read_b32 v154, a94
  v_accvgpr_read_b32 v155, a95
  v_pk_mul_f32 v[148:149], v[148:149], v[10:11] op_sel_hi:[1,0]
  v_pk_mul_f32 v[150:151], v[150:151], v[10:11] op_sel_hi:[1,0]
  v_pk_mul_f32 v[152:153], v[152:153], v[10:11] op_sel_hi:[1,0]
  v_pk_mul_f32 v[154:155], v[154:155], v[10:11] op_sel_hi:[1,0]
  v_cvt_pk_bf16_f32 v156, v148, v149
  v_cvt_pk_bf16_f32 v157, v150, v151
  v_cvt_pk_bf16_f32 v158, v152, v153
  v_cvt_pk_bf16_f32 v159, v154, v155
  buffer_store_dwordx4 v[156:159], v2, s[4:7], s28 offen offset:3072 sc1
  s_add_u32 s28, s25, 100675584
  v_accvgpr_read_b32 v112, a96
  v_accvgpr_read_b32 v113, a97
  v_accvgpr_read_b32 v114, a98
  v_accvgpr_read_b32 v115, a99
  v_accvgpr_read_b32 v116, a100
  v_accvgpr_read_b32 v117, a101
  v_accvgpr_read_b32 v118, a102
  v_accvgpr_read_b32 v119, a103
  v_pk_mul_f32 v[112:113], v[112:113], v[10:11] op_sel_hi:[1,0]
  v_pk_mul_f32 v[114:115], v[114:115], v[10:11] op_sel_hi:[1,0]
  v_pk_mul_f32 v[116:117], v[116:117], v[10:11] op_sel_hi:[1,0]
  v_pk_mul_f32 v[118:119], v[118:119], v[10:11] op_sel_hi:[1,0]
  v_cvt_pk_bf16_f32 v120, v112, v113
  v_cvt_pk_bf16_f32 v121, v114, v115
  v_cvt_pk_bf16_f32 v122, v116, v117
  v_cvt_pk_bf16_f32 v123, v118, v119
  buffer_store_dwordx4 v[120:123], v2, s[4:7], s28 offen offset:0 sc1
  v_accvgpr_read_b32 v124, a104
  v_accvgpr_read_b32 v125, a105
  v_accvgpr_read_b32 v126, a106
  v_accvgpr_read_b32 v127, a107
  v_accvgpr_read_b32 v128, a108
  v_accvgpr_read_b32 v129, a109
  v_accvgpr_read_b32 v130, a110
  v_accvgpr_read_b32 v131, a111
  v_pk_mul_f32 v[124:125], v[124:125], v[10:11] op_sel_hi:[1,0]
  v_pk_mul_f32 v[126:127], v[126:127], v[10:11] op_sel_hi:[1,0]
  v_pk_mul_f32 v[128:129], v[128:129], v[10:11] op_sel_hi:[1,0]
  v_pk_mul_f32 v[130:131], v[130:131], v[10:11] op_sel_hi:[1,0]
  v_cvt_pk_bf16_f32 v132, v124, v125
  v_cvt_pk_bf16_f32 v133, v126, v127
  v_cvt_pk_bf16_f32 v134, v128, v129
  v_cvt_pk_bf16_f32 v135, v130, v131
  buffer_store_dwordx4 v[132:135], v2, s[4:7], s28 offen offset:1024 sc1
  v_accvgpr_read_b32 v136, a112
  v_accvgpr_read_b32 v137, a113
  v_accvgpr_read_b32 v138, a114
  v_accvgpr_read_b32 v139, a115
  v_accvgpr_read_b32 v140, a116
  v_accvgpr_read_b32 v141, a117
  v_accvgpr_read_b32 v142, a118
  v_accvgpr_read_b32 v143, a119
  v_pk_mul_f32 v[136:137], v[136:137], v[10:11] op_sel_hi:[1,0]
  v_pk_mul_f32 v[138:139], v[138:139], v[10:11] op_sel_hi:[1,0]
  v_pk_mul_f32 v[140:141], v[140:141], v[10:11] op_sel_hi:[1,0]
  v_pk_mul_f32 v[142:143], v[142:143], v[10:11] op_sel_hi:[1,0]
  v_cvt_pk_bf16_f32 v144, v136, v137
  v_cvt_pk_bf16_f32 v145, v138, v139
  v_cvt_pk_bf16_f32 v146, v140, v141
  v_cvt_pk_bf16_f32 v147, v142, v143
  buffer_store_dwordx4 v[144:147], v2, s[4:7], s28 offen offset:2048 sc1
  v_accvgpr_read_b32 v148, a120
  v_accvgpr_read_b32 v149, a121
  v_accvgpr_read_b32 v150, a122
  v_accvgpr_read_b32 v151, a123
  v_accvgpr_read_b32 v152, a124
  v_accvgpr_read_b32 v153, a125
  v_accvgpr_read_b32 v154, a126
  v_accvgpr_read_b32 v155, a127
  v_pk_mul_f32 v[148:149], v[148:149], v[10:11] op_sel_hi:[1,0]
  v_pk_mul_f32 v[150:151], v[150:151], v[10:11] op_sel_hi:[1,0]
  v_pk_mul_f32 v[152:153], v[152:153], v[10:11] op_sel_hi:[1,0]
  v_pk_mul_f32 v[154:155], v[154:155], v[10:11] op_sel_hi:[1,0]
  v_cvt_pk_bf16_f32 v156, v148, v149
  v_cvt_pk_bf16_f32 v157, v150, v151
  v_cvt_pk_bf16_f32 v158, v152, v153
  v_cvt_pk_bf16_f32 v159, v154, v155
  buffer_store_dwordx4 v[156:159], v2, s[4:7], s28 offen offset:3072 sc1
  s_branch A_out_36
A_kvw_37:
M_kv_40:
  s_cmp_ge_u32 s17, s36
  s_cbranch_scc1 M_kvok_41
  s_mov_b32 s76, 0
  s_mov_b32 s78, 23
  s_mov_b32 s77, 335872
  s_cmp_eq_u32 s68, 1
  s_cmov_b32 s76, 128
  s_cmov_b32 s78, 27
  s_cmov_b32 s77, 114688
  s_cmp_eq_u32 s68, 2
  s_cmov_b32 s76, 768
  s_cmov_b32 s78, 14
  s_cmov_b32 s77, 0
  s_add_u32 s76, s76, s67
  s_mov_b32 s71, 0
  s_branch M_sg_43
M_sw_42:
  s_sleep 8
  s_add_u32 s71, s71, 1
  s_cmp_gt_u32 s71, 262144
  s_cbranch_scc1 M_exit
M_sg_43:
  s_mov_b32 s79, 0
  s_atomic_or s79, s[72:73], s76 glc
  s_waitcnt lgkmcnt(0)
  s_cmp_lt_u32 s79, s78
  s_cbranch_scc1 M_sw_42
  s_add_u32 s36, s77, s19
  s_add_u32 s68, s68, 1
  s_branch M_kv_40
M_kvok_41:
  s_branch A_kvb_38
A_upd_34:
  s_cmp_eq_u32 s23, 2
  s_cbranch_scc1 A_upd2_44
  v_mov_b32 v12, s24
  v_cmp_le_i32 s[40:41], 0, v5
  v_cmp_le_i32 s[42:43], 1, v5
  v_cmp_le_i32 s[44:45], 2, v5
  v_cmp_le_i32 s[46:47], 3, v5
  v_cndmask_b32 v64, v12, v6, s[40:41]
  v_cndmask_b32 v65, v12, v6, s[42:43]
  v_cndmask_b32 v66, v12, v6, s[44:45]
  v_cndmask_b32 v67, v12, v6, s[46:47]
  v_cmp_le_i32 s[40:41], 8, v5
  v_cmp_le_i32 s[42:43], 9, v5
  v_cmp_le_i32 s[44:45], 10, v5
  v_cmp_le_i32 s[46:47], 11, v5
  v_cndmask_b32 v68, v12, v6, s[40:41]
  v_cndmask_b32 v69, v12, v6, s[42:43]
  v_cndmask_b32 v70, v12, v6, s[44:45]
  v_cndmask_b32 v71, v12, v6, s[46:47]
  v_cmp_le_i32 s[40:41], 16, v5
  v_cmp_le_i32 s[42:43], 17, v5
  v_cmp_le_i32 s[44:45], 18, v5
  v_cmp_le_i32 s[46:47], 19, v5
  v_cndmask_b32 v72, v12, v6, s[40:41]
  v_cndmask_b32 v73, v12, v6, s[42:43]
  v_cndmask_b32 v74, v12, v6, s[44:45]
  v_cndmask_b32 v75, v12, v6, s[46:47]
  v_cmp_le_i32 s[40:41], 24, v5
  v_cmp_le_i32 s[42:43], 25, v5
  v_cmp_le_i32 s[44:45], 26, v5
  v_cmp_le_i32 s[46:47], 27, v5
  v_cndmask_b32 v76, v12, v6, s[40:41]
  v_cndmask_b32 v77, v12, v6, s[42:43]
  v_cndmask_b32 v78, v12, v6, s[44:45]
  v_cndmask_b32 v79, v12, v6, s[46:47]
  v_mov_b32 v80, v7
  v_mov_b32 v81, v7
  v_mov_b32 v82, v7
  v_mov_b32 v83, v7
  v_mov_b32 v84, v7
  v_mov_b32 v85, v7
  v_mov_b32 v86, v7
  v_mov_b32 v87, v7
  v_mov_b32 v88, v7
  v_mov_b32 v89, v7
  v_mov_b32 v90, v7
  v_mov_b32 v91, v7
  v_mov_b32 v92, v7
  v_mov_b32 v93, v7
  v_mov_b32 v94, v7
  v_mov_b32 v95, v7
  s_branch A_back_35
A_upd2_44:
  v_mov_b32 v64, v6
  v_mov_b32 v65, v6
  v_mov_b32 v66, v6
  v_mov_b32 v67, v6
  v_mov_b32 v68, v6
  v_mov_b32 v69, v6
  v_mov_b32 v70, v6
  v_mov_b32 v71, v6
  v_mov_b32 v72, v6
  v_mov_b32 v73, v6
  v_mov_b32 v74, v6
  v_mov_b32 v75, v6
  v_mov_b32 v76, v6
  v_mov_b32 v77, v6
  v_mov_b32 v78, v6
  v_mov_b32 v79, v6
  s_branch A_back_35
A_slow_39:
  s_mov_b32 s29, 1
  v_mov_b32 v64, s24
  v_mov_b32 v65, s24
  v_mov_b32 v66, s24
  v_mov_b32 v67, s24
  v_mov_b32 v68, s24
  v_mov_b32 v69, s24
  v_mov_b32 v70, s24
  v_mov_b32 v71, s24
  v_mov_b32 v72, s24
  v_mov_b32 v73, s24
  v_mov_b32 v74, s24
  v_mov_b32 v75, s24
  v_mov_b32 v76, s24
  v_mov_b32 v77, s24
  v_mov_b32 v78, s24
  v_mov_b32 v79, s24
  v_mov_b32 v12, s24
  v_cmp_le_i32 s[40:41], 0, v5
  v_cmp_le_i32 s[42:43], 1, v5
  v_cmp_le_i32 s[44:45], 2, v5
  v_cmp_le_i32 s[46:47], 3, v5
  v_cndmask_b32 v80, v12, v7, s[40:41]
  v_cndmask_b32 v81, v12, v7, s[42:43]
  v_cndmask_b32 v82, v12, v7, s[44:45]
  v_cndmask_b32 v83, v12, v7, s[46:47]
  v_cmp_le_i32 s[40:41], 8, v5
  v_cmp_le_i32 s[42:43], 9, v5
  v_cmp_le_i32 s[44:45], 10, v5
  v_cmp_le_i32 s[46:47], 11, v5
  v_cndmask_b32 v84, v12, v7, s[40:41]
  v_cndmask_b32 v85, v12, v7, s[42:43]
  v_cndmask_b32 v86, v12, v7, s[44:45]
  v_cndmask_b32 v87, v12, v7, s[46:47]
  v_cmp_le_i32 s[40:41], 16, v5
  v_cmp_le_i32 s[42:43], 17, v5
  v_cmp_le_i32 s[44:45], 18, v5
  v_cmp_le_i32 s[46:47], 19, v5
  v_cndmask_b32 v88, v12, v7, s[40:41]
  v_cndmask_b32 v89, v12, v7, s[42:43]
  v_cndmask_b32 v90, v12, v7, s[44:45]
  v_cndmask_b32 v91, v12, v7, s[46:47]
  v_cmp_le_i32 s[40:41], 24, v5
  v_cmp_le_i32 s[42:43], 25, v5
  v_cmp_le_i32 s[44:45], 26, v5
  v_cmp_le_i32 s[46:47], 27, v5
  v_cndmask_b32 v92, v12, v7, s[40:41]
  v_cndmask_b32 v93, v12, v7, s[42:43]
  v_cndmask_b32 v94, v12, v7, s[44:45]
  v_cndmask_b32 v95, v12, v7, s[46:47]
  v_mov_b32 v8, s24
  v_mov_b32 v10, s24
  s_add_u32 s17, s25, 16785408
  s_mov_b32 s23, 0
A_ml_45:
  s_add_u32 s28, s17, 4096
  buffer_load_dwordx4 a[192:195], v2, s[4:7], s17 offen offset:0 sc1
  buffer_load_dwordx4 a[196:199], v2, s[4:7], s17 offen offset:1024 sc1
  buffer_load_dwordx4 a[200:203], v2, s[4:7], s17 offen offset:2048 sc1
  buffer_load_dwordx4 a[204:207], v2, s[4:7], s17 offen offset:3072 sc1
  buffer_load_dwordx4 a[208:211], v2, s[4:7], s28 offen offset:0 sc1
  buffer_load_dwordx4 a[212:215], v2, s[4:7], s28 offen offset:1024 sc1
  buffer_load_dwordx4 a[216:219], v2, s[4:7], s28 offen offset:2048 sc1
  buffer_load_dwordx4 a[220:223], v2, s[4:7], s28 offen offset:3072 sc1
  s_waitcnt vmcnt(0)
  v_mfma_f32_32x32x16_bf16 v[32:47], a[192:195], a[128:131], v[64:79]
  v_mfma_f32_32x32x16_bf16 v[32:47], a[196:199], a[132:135], v[32:47]
  v_mfma_f32_32x32x16_bf16 v[32:47], a[200:203], a[136:139], v[32:47]
  v_mfma_f32_32x32x16_bf16 v[32:47], a[204:207], a[140:143], v[32:47]
  v_mfma_f32_32x32x16_bf16 v[32:47], a[208:211], a[144:147], v[32:47]
  v_mfma_f32_32x32x16_bf16 v[32:47], a[212:215], a[148:151], v[32:47]
  v_mfma_f32_32x32x16_bf16 v[32:47], a[216:219], a[152:155], v[32:47]
  v_mfma_f32_32x32x16_bf16 v[32:47], a[220:223], a[156:159], v[32:47]
  v_mfma_f32_32x32x16_bf16 v[48:63], a[192:195], a[160:163], v[80:95]
  v_mfma_f32_32x32x16_bf16 v[48:63], a[196:199], a[164:167], v[48:63]
  v_mfma_f32_32x32x16_bf16 v[48:63], a[200:203], a[168:171], v[48:63]
  v_mfma_f32_32x32x16_bf16 v[48:63], a[204:207], a[172:175], v[48:63]
  v_mfma_f32_32x32x16_bf16 v[48:63], a[208:211], a[176:179], v[48:63]
  v_mfma_f32_32x32x16_bf16 v[48:63], a[212:215], a[180:183], v[48:63]
  v_mfma_f32_32x32x16_bf16 v[48:63], a[216:219], a[184:187], v[48:63]
  v_mfma_f32_32x32x16_bf16 v[48:63], a[220:223], a[188:191], v[48:63]
  s_nop 7
  s_nop 3
  v_max3_f32 v8, v8, v32, v33
  v_max3_f32 v8, v8, v34, v35
  v_max3_f32 v8, v8, v36, v37
  v_max3_f32 v8, v8, v38, v39
  v_max3_f32 v8, v8, v40, v41
  v_max3_f32 v8, v8, v42, v43
  v_max3_f32 v8, v8, v44, v45
  v_max3_f32 v8, v8, v46, v47
  v_max3_f32 v10, v10, v48, v49
  v_max3_f32 v10, v10, v50, v51
  v_max3_f32 v10, v10, v52, v53
  v_max3_f32 v10, v10, v54, v55
  v_max3_f32 v10, v10, v56, v57
  v_max3_f32 v10, v10, v58, v59
  v_max3_f32 v10, v10, v60, v61
  v_max3_f32 v10, v10, v62, v63
  s_add_u32 s23, s23, 1
  s_cmp_lg_u32 s23, 1
  s_cbranch_scc1 A_m2_46
  v_mov_b32 v12, s24
  v_cmp_le_i32 s[40:41], 0, v5
  v_cmp_le_i32 s[42:43], 1, v5
  v_cmp_le_i32 s[44:45], 2, v5
  v_cmp_le_i32 s[46:47], 3, v5
  v_cndmask_b32 v64, v12, v6, s[40:41]
  v_cndmask_b32 v65, v12, v6, s[42:43]
  v_cndmask_b32 v66, v12, v6, s[44:45]
  v_cndmask_b32 v67, v12, v6, s[46:47]
  v_cmp_le_i32 s[40:41], 8, v5
  v_cmp_le_i32 s[42:43], 9, v5
  v_cmp_le_i32 s[44:45], 10, v5
  v_cmp_le_i32 s[46:47], 11, v5
  v_cndmask_b32 v68, v12, v6, s[40:41]
  v_cndmask_b32 v69, v12, v6, s[42:43]
  v_cndmask_b32 v70, v12, v6, s[44:45]
  v_cndmask_b32 v71, v12, v6, s[46:47]
  v_cmp_le_i32 s[40:41], 16, v5
  v_cmp_le_i32 s[42:43], 17, v5
  v_cmp_le_i32 s[44:45], 18, v5
  v_cmp_le_i32 s[46:47], 19, v5
  v_cndmask_b32 v72, v12, v6, s[40:41]
  v_cndmask_b32 v73, v12, v6, s[42:43]
  v_cndmask_b32 v74, v12, v6, s[44:45]
  v_cndmask_b32 v75, v12, v6, s[46:47]
  v_cmp_le_i32 s[40:41], 24, v5
  v_cmp_le_i32 s[42:43], 25, v5
  v_cmp_le_i32 s[44:45], 26, v5
  v_cmp_le_i32 s[46:47], 27, v5
  v_cndmask_b32 v76, v12, v6, s[40:41]
  v_cndmask_b32 v77, v12, v6, s[42:43]
  v_cndmask_b32 v78, v12, v6, s[44:45]
  v_cndmask_b32 v79, v12, v6, s[46:47]
  v_mov_b32 v80, v7
  v_mov_b32 v81, v7
  v_mov_b32 v82, v7
  v_mov_b32 v83, v7
  v_mov_b32 v84, v7
  v_mov_b32 v85, v7
  v_mov_b32 v86, v7
  v_mov_b32 v87, v7
  v_mov_b32 v88, v7
  v_mov_b32 v89, v7
  v_mov_b32 v90, v7
  v_mov_b32 v91, v7
  v_mov_b32 v92, v7
  v_mov_b32 v93, v7
  v_mov_b32 v94, v7
  v_mov_b32 v95, v7
A_m2_46:
  s_cmp_lg_u32 s23, 2
  s_cbranch_scc1 A_m3_47
  v_mov_b32 v64, v6
  v_mov_b32 v65, v6
  v_mov_b32 v66, v6
  v_mov_b32 v67, v6
  v_mov_b32 v68, v6
  v_mov_b32 v69, v6
  v_mov_b32 v70, v6
  v_mov_b32 v71, v6
  v_mov_b32 v72, v6
  v_mov_b32 v73, v6
  v_mov_b32 v74, v6
  v_mov_b32 v75, v6
  v_mov_b32 v76, v6
  v_mov_b32 v77, v6
  v_mov_b32 v78, v6
  v_mov_b32 v79, v6
A_m3_47:
  s_sub_u32 s17, s17, 8192
  s_cmp_ge_i32 s17, s19
  s_cbranch_scc1 A_ml_45
  v_mov_b32 v9, v8
  s_nop 1
  v_permlane32_swap_b32 v8, v9
  s_nop 1
  v_max_f32 v8, v8, v9
  v_sub_f32 v6, 0, v8
  v_mov_b32 v11, v10
  s_nop 1
  v_permlane32_swap_b32 v10, v11
  s_nop 1
  v_max_f32 v10, v10, v11
  v_sub_f32 v7, 0, v10
  s_branch A_again_26
A_out_36:
  s_mov_b32 s69, s55
  s_mov_b32 s70, s56
  s_sub_u32 s52, s52, 1
  s_cmp_lg_u32 s52, 0
  s_cbranch_scc1 M_att
  s_waitcnt vmcnt(0)
  s_barrier
  s_mov_b32 s30, 512
  v_mov_b32 v144, s30
  v_min_u32 v145, 1, v0
  v_lshlrev_b32 v145, 30, v145
  buffer_store_dword v144, v145, s[4:7], s31 offen sc1
  s_lshr_b32 s48, s64, 2
  s_bfe_u32 s49, s64, 0x10001
  s_and_b32 s50, s64, 1
  s_mul_i32 s50, s50, 6
  s_add_u32 s50, s50, s65
  s_mov_b32 s51, 12
  s_cmp_lt_u32 s50, 4
  s_cselect_b32 s23, 6, 5
  s_load_dwordx2 s[8:9], s[0:1], 40
  s_lshl_b32 s17, s48, 19
  s_lshl_b32 s26, s49, 2
  s_add_u32 s26, s26, s16
  s_lshl_b32 s27, s26, 7
  s_add_u32 s17, s17, s27
  s_mov_b32 s18, 1024
  s_lshl_b32 s21, s48, 6
  s_add_u32 s21, s21, s50
  s_lshl_b32 s21, s21, 3
  s_add_u32 s21, s21, s26
  s_lshl_b32 s21, s21, 12
  s_add_u32 s21, s21, 150994944
  s_lshl_b32 s22, s51, 15
  s_mov_b32 s24, 1.0
  s_waitcnt lgkmcnt(0)
  s_and_b32 s9, s9, 0xffff
  s_mov_b32 s10, 4194304
  s_mov_b32 s11, 0x20000
  s_mov_b32 s12, s4
  s_mov_b32 s13, s5
  s_mov_b32 s14, 268435456
  s_mov_b32 s15, 0x20000
  s_lshl_b32 s19, s48, 8
  s_add_u32 s19, s19, s50
  s_lshl_b32 s19, s19, 13
  s_add_u32 s19, s19, 100663296
  s_lshl_b32 s20, s51, 13
  v_lshrrev_b32 v144, 4, v1
  v_and_b32 v56, 0xff, v2
  v_lshl_add_u32 v56, v144, 9, v56
  s_mul_i32 s26, s16, 524288
  v_add_u32 v8, 0, v56
  v_add_u32 v16, 0, v2
  v_add_u32 v16, s26, v16
  v_add_u32 v9, 256, v56
  v_add_u32 v17, 1024, v2
  v_add_u32 v17, s26, v17
  v_add_u32 v10, 2048, v56
  v_add_u32 v18, 2048, v2
  v_add_u32 v18, s26, v18
  v_add_u32 v11, 2304, v56
  v_add_u32 v19, 3072, v2
  v_add_u32 v19, s26, v19
  v_add_u32 v12, 4096, v56
  v_add_u32 v20, 4096, v2
  v_add_u32 v20, s26, v20
  v_add_u32 v13, 4352, v56
  v_add_u32 v21, 5120, v2
  v_add_u32 v21, s26, v21
  v_add_u32 v14, 6144, v56
  v_add_u32 v22, 6144, v2
  v_add_u32 v22, s26, v22
  v_add_u32 v15, 6400, v56
  v_add_u32 v23, 7168, v2
  v_add_u32 v23, s26, v23
  v_lshrrev_b32 v144, 3, v1
  v_mul_lo_u32 v144, v144, s18
  v_and_b32 v145, 7, v1
  v_lshl_add_u32 v144, v145, 4, v144
  s_lshl_b32 s28, s16, 15
  s_add_u32 s28, s28, 32768
  s_lshl_b32 s29, s18, 3
  s_add_u32 m0, s28, 0
  s_nop 0
  buffer_load_dwordx4 v144, s[8:11], s17 offen lds
  s_add_u32 s17, s17, s29
  s_add_u32 m0, s28, 1024
  s_nop 0
  buffer_load_dwordx4 v144, s[8:11], s17 offen lds
  s_add_u32 s17, s17, s29
  s_add_u32 m0, s28, 2048
  s_nop 0
  buffer_load_dwordx4 v144, s[8:11], s17 offen lds
  s_add_u32 s17, s17, s29
  s_add_u32 m0, s28, 3072
  s_nop 0
  buffer_load_dwordx4 v144, s[8:11], s17 offen lds
  s_add_u32 s17, s17, s29
  s_add_u32 m0, s28, 4096
  s_nop 0
  buffer_load_dwordx4 v144, s[8:11], s17 offen lds
  s_add_u32 s17, s17, s29
  s_add_u32 m0, s28, 5120
  s_nop 0
  buffer_load_dwordx4 v144, s[8:11], s17 offen lds
  s_add_u32 s17, s17, s29
  s_add_u32 m0, s28, 6144
  s_nop 0
  buffer_load_dwordx4 v144, s[8:11], s17 offen lds
  s_add_u32 s17, s17, s29
  s_add_u32 m0, s28, 7168
  s_nop 0
  buffer_load_dwordx4 v144, s[8:11], s17 offen lds
  s_add_u32 s17, s17, s29
  s_add_u32 m0, s28, 8192
  s_nop 0
  buffer_load_dwordx4 v144, s[8:11], s17 offen lds
  s_add_u32 s17, s17, s29
  s_add_u32 m0, s28, 9216
  s_nop 0
  buffer_load_dwordx4 v144, s[8:11], s17 offen lds
  s_add_u32 s17, s17, s29
  s_add_u32 m0, s28, 10240
  s_nop 0
  buffer_load_dwordx4 v144, s[8:11], s17 offen lds
  s_add_u32 s17, s17, s29
  s_add_u32 m0, s28, 11264
  s_nop 0
  buffer_load_dwordx4 v144, s[8:11], s17 offen lds
  s_add_u32 s17, s17, s29
  s_add_u32 m0, s28, 12288
  s_nop 0
  buffer_load_dwordx4 v144, s[8:11], s17 offen lds
  s_add_u32 s17, s17, s29
  s_add_u32 m0, s28, 13312
  s_nop 0
  buffer_load_dwordx4 v144, s[8:11], s17 offen lds
  s_add_u32 s17, s17, s29
  s_add_u32 m0, s28, 14336
  s_nop 0
  buffer_load_dwordx4 v144, s[8:11], s17 offen lds
  s_add_u32 s17, s17, s29
  s_add_u32 m0, s28, 15360
  s_nop 0
  buffer_load_dwordx4 v144, s[8:11], s17 offen lds
  s_add_u32 s17, s17, s29
  s_add_u32 m0, s28, 16384
  s_nop 0
  buffer_load_dwordx4 v144, s[8:11], s17 offen lds
  s_add_u32 s17, s17, s29
  s_add_u32 m0, s28, 17408
  s_nop 0
  buffer_load_dwordx4 v144, s[8:11], s17 offen lds
  s_add_u32 s17, s17, s29
  s_add_u32 m0, s28, 18432
  s_nop 0
  buffer_load_dwordx4 v144, s[8:11], s17 offen lds
  s_add_u32 s17, s17, s29
  s_add_u32 m0, s28, 19456
  s_nop 0
  buffer_load_dwordx4 v144, s[8:11], s17 offen lds
  s_add_u32 s17, s17, s29
  s_add_u32 m0, s28, 20480
  s_nop 0
  buffer_load_dwordx4 v144, s[8:11], s17 offen lds
  s_add_u32 s17, s17, s29
  s_add_u32 m0, s28, 21504
  s_nop 0
  buffer_load_dwordx4 v144, s[8:11], s17 offen lds
  s_add_u32 s17, s17, s29
  s_add_u32 m0, s28, 22528
  s_nop 0
  buffer_load_dwordx4 v144, s[8:11], s17 offen lds
  s_add_u32 s17, s17, s29
  s_add_u32 m0, s28, 23552
  s_nop 0
  buffer_load_dwordx4 v144, s[8:11], s17 offen lds
  s_add_u32 s17, s17, s29
  s_add_u32 m0, s28, 24576
  s_nop 0
  buffer_load_dwordx4 v144, s[8:11], s17 offen lds
  s_add_u32 s17, s17, s29
  s_add_u32 m0, s28, 25600
  s_nop 0
  buffer_load_dwordx4 v144, s[8:11], s17 offen lds
  s_add_u32 s17, s17, s29
  s_add_u32 m0, s28, 26624
  s_nop 0
  buffer_load_dwordx4 v144, s[8:11], s17 offen lds
  s_add_u32 s17, s17, s29
  s_add_u32 m0, s28, 27648
  s_nop 0
  buffer_load_dwordx4 v144, s[8:11], s17 offen lds
  s_add_u32 s17, s17, s29
  s_add_u32 m0, s28, 28672
  s_nop 0
  buffer_load_dwordx4 v144, s[8:11], s17 offen lds
  s_add_u32 s17, s17, s29
  s_add_u32 m0, s28, 29696
  s_nop 0
  buffer_load_dwordx4 v144, s[8:11], s17 offen lds
  s_add_u32 s17, s17, s29
  s_add_u32 m0, s28, 30720
  s_nop 0
  buffer_load_dwordx4 v144, s[8:11], s17 offen lds
  s_add_u32 s17, s17, s29
  s_add_u32 m0, s28, 31744
  s_nop 0
  buffer_load_dwordx4 v144, s[8:11], s17 offen lds
  s_add_u32 s17, s17, s29
  v_bfe_u32 v148, v1, 2, 2
  v_lshrrev_b32 v149, 5, v1
  v_lshl_add_u32 v148, v149, 4, v148
  v_bfe_u32 v149, v1, 4, 1
  v_lshl_add_u32 v148, v149, 2, v148
  v_and_b32 v149, 3, v1
  v_lshlrev_b32 v149, 4, v149
  s_mov_b32 s26, 8
  v_lshl_add_u32 v148, v148, 7, v149
  v_add_u32 v152, s28, v148
  v_add_u32 v153, 1024, v152
  v_add_u32 v154, s26, v152
  v_add_u32 v155, s26, v153
  s_waitcnt vmcnt(28)
  ds_read_b64_tr_b16 a[0:1], v152 offset:0
  ds_read_b64_tr_b16 a[2:3], v153 offset:0
  ds_read_b64_tr_b16 a[4:5], v154 offset:0
  ds_read_b64_tr_b16 a[6:7], v155 offset:0
  ds_read_b64_tr_b16 a[8:9], v152 offset:64
  ds_read_b64_tr_b16 a[10:11], v153 offset:64
  ds_read_b64_tr_b16 a[12:13], v154 offset:64
  ds_read_b64_tr_b16 a[14:15], v155 offset:64
  s_waitcnt lgkmcnt(0)
  s_add_u32 m0, s28, 0
  s_nop 0
  buffer_load_dwordx4 v144, s[8:11], s17 offen lds
  s_add_u32 s17, s17, s29
  s_add_u32 m0, s28, 1024
  s_nop 0
  buffer_load_dwordx4 v144, s[8:11], s17 offen lds
  s_add_u32 s17, s17, s29
  s_add_u32 m0, s28, 2048
  s_nop 0
  buffer_load_dwordx4 v144, s[8:11], s17 offen lds
  s_add_u32 s17, s17, s29
  s_add_u32 m0, s28, 3072
  s_nop 0
  buffer_load_dwordx4 v144, s[8:11], s17 offen lds
  s_add_u32 s17, s17, s29
  s_waitcnt vmcnt(28)
  ds_read_b64_tr_b16 a[16:17], v152 offset:4096
  ds_read_b64_tr_b16 a[18:19], v153 offset:4096
  ds_read_b64_tr_b16 a[20:21], v154 offset:4096
  ds_read_b64_tr_b16 a[22:23], v155 offset:4096
  ds_read_b64_tr_b16 a[24:25], v152 offset:4160
  ds_read_b64_tr_b16 a[26:27], v153 offset:4160
  ds_read_b64_tr_b16 a[28:29], v154 offset:4160
  ds_read_b64_tr_b16 a[30:31], v155 offset:4160
  s_waitcnt lgkmcnt(0)
  s_add_u32 m0, s28, 4096
  s_nop 0
  buffer_load_dwordx4 v144, s[8:11], s17 offen lds
  s_add_u32 s17, s17, s29
  s_add_u32 m0, s28, 5120
  s_nop 0
  buffer_load_dwordx4 v144, s[8:11], s17 offen lds
  s_add_u32 s17, s17, s29
  s_add_u32 m0, s28, 6144
  s_nop 0
  buffer_load_dwordx4 v144, s[8:11], s17 offen lds
  s_add_u32 s17, s17, s29
  s_add_u32 m0, s28, 7168
  s_nop 0
  buffer_load_dwordx4 v144, s[8:11], s17 offen lds
  s_add_u32 s17, s17, s29
  s_waitcnt vmcnt(28)
  ds_read_b64_tr_b16 a[32:33], v152 offset:8192
  ds_read_b64_tr_b16 a[34:35], v153 offset:8192
  ds_read_b64_tr_b16 a[36:37], v154 offset:8192
  ds_read_b64_tr_b16 a[38:39], v155 offset:8192
  ds_read_b64_tr_b16 a[40:41], v152 offset:8256
  ds_read_b64_tr_b16 a[42:43], v153 offset:8256
  ds_read_b64_tr_b16 a[44:45], v154 offset:8256
  ds_read_b64_tr_b16 a[46:47], v155 offset:8256
  s_waitcnt lgkmcnt(0)
  s_add_u32 m0, s28, 8192
  s_nop 0
  buffer_load_dwordx4 v144, s[8:11], s17 offen lds
  s_add_u32 s17, s17, s29
  s_add_u32 m0, s28, 9216
  s_nop 0
  buffer_load_dwordx4 v144, s[8:11], s17 offen lds
  s_add_u32 s17, s17, s29
  s_add_u32 m0, s28, 10240
  s_nop 0
  buffer_load_dwordx4 v144, s[8:11], s17 offen lds
  s_add_u32 s17, s17, s29
  s_add_u32 m0, s28, 11264
  s_nop 0
  buffer_load_dwordx4 v144, s[8:11], s17 offen lds
  s_add_u32 s17, s17, s29
  s_waitcnt vmcnt(28)
  ds_read_b64_tr_b16 a[48:49], v152 offset:12288
  ds_read_b64_tr_b16 a[50:51], v153 offset:12288
  ds_read_b64_tr_b16 a[52:53], v154 offset:12288
  ds_read_b64_tr_b16 a[54:55], v155 offset:12288
  ds_read_b64_tr_b16 a[56:57], v152 offset:12352
  ds_read_b64_tr_b16 a[58:59], v153 offset:12352
  ds_read_b64_tr_b16 a[60:61], v154 offset:12352
  ds_read_b64_tr_b16 a[62:63], v155 offset:12352
  s_waitcnt lgkmcnt(0)
  s_add_u32 m0, s28, 12288
  s_nop 0
  buffer_load_dwordx4 v144, s[8:11], s17 offen lds
  s_add_u32 s17, s17, s29
  s_add_u32 m0, s28, 13312
  s_nop 0
  buffer_load_dwordx4 v144, s[8:11], s17 offen lds
  s_add_u32 s17, s17, s29
  s_add_u32 m0, s28, 14336
  s_nop 0
  buffer_load_dwordx4 v144, s[8:11], s17 offen lds
  s_add_u32 s17, s17, s29
  s_add_u32 m0, s28, 15360
  s_nop 0
  buffer_load_dwordx4 v144, s[8:11], s17 offen lds
  s_add_u32 s17, s17, s29
  s_waitcnt vmcnt(28)
  ds_read_b64_tr_b16 a[64:65], v152 offset:16384
  ds_read_b64_tr_b16 a[66:67], v153 offset:16384
  ds_read_b64_tr_b16 a[68:69], v154 offset:16384
  ds_read_b64_tr_b16 a[70:71], v155 offset:16384
  ds_read_b64_tr_b16 a[72:73], v152 offset:16448
  ds_read_b64_tr_b16 a[74:75], v153 offset:16448
  ds_read_b64_tr_b16 a[76:77], v154 offset:16448
  ds_read_b64_tr_b16 a[78:79], v155 offset:16448
  s_waitcnt lgkmcnt(0)
  s_add_u32 m0, s28, 16384
  s_nop 0
  buffer_load_dwordx4 v144, s[8:11], s17 offen lds
  s_add_u32 s17, s17, s29
  s_add_u32 m0, s28, 17408
  s_nop 0
  buffer_load_dwordx4 v144, s[8:11], s17 offen lds
  s_add_u32 s17, s17, s29
  s_add_u32 m0, s28, 18432
  s_nop 0
  buffer_load_dwordx4 v144, s[8:11], s17 offen lds
  s_add_u32 s17, s17, s29
  s_add_u32 m0, s28, 19456
  s_nop 0
  buffer_load_dwordx4 v144, s[8:11], s17 offen lds
  s_add_u32 s17, s17, s29
  s_waitcnt vmcnt(28)
  ds_read_b64_tr_b16 a[80:81], v152 offset:20480
  ds_read_b64_tr_b16 a[82:83], v153 offset:20480
  ds_read_b64_tr_b16 a[84:85], v154 offset:20480
  ds_read_b64_tr_b16 a[86:87], v155 offset:20480
  ds_read_b64_tr_b16 a[88:89], v152 offset:20544
  ds_read_b64_tr_b16 a[90:91], v153 offset:20544
  ds_read_b64_tr_b16 a[92:93], v154 offset:20544
  ds_read_b64_tr_b16 a[94:95], v155 offset:20544
  s_waitcnt lgkmcnt(0)
  s_add_u32 m0, s28, 20480
  s_nop 0
  buffer_load_dwordx4 v144, s[8:11], s17 offen lds
  s_add_u32 s17, s17, s29
  s_add_u32 m0, s28, 21504
  s_nop 0
  buffer_load_dwordx4 v144, s[8:11], s17 offen lds
  s_add_u32 s17, s17, s29
  s_add_u32 m0, s28, 22528
  s_nop 0
  buffer_load_dwordx4 v144, s[8:11], s17 offen lds
  s_add_u32 s17, s17, s29
  s_add_u32 m0, s28, 23552
  s_nop 0
  buffer_load_dwordx4 v144, s[8:11], s17 offen lds
  s_add_u32 s17, s17, s29
  s_waitcnt vmcnt(28)
  ds_read_b64_tr_b16 a[96:97], v152 offset:24576
  ds_read_b64_tr_b16 a[98:99], v153 offset:24576
  ds_read_b64_tr_b16 a[100:101], v154 offset:24576
  ds_read_b64_tr_b16 a[102:103], v155 offset:24576
  ds_read_b64_tr_b16 a[104:105], v152 offset:24640
  ds_read_b64_tr_b16 a[106:107], v153 offset:24640
  ds_read_b64_tr_b16 a[108:109], v154 offset:24640
  ds_read_b64_tr_b16 a[110:111], v155 offset:24640
  s_waitcnt lgkmcnt(0)
  s_add_u32 m0, s28, 24576
  s_nop 0
  buffer_load_dwordx4 v144, s[8:11], s17 offen lds
  s_add_u32 s17, s17, s29
  s_add_u32 m0, s28, 25600
  s_nop 0
  buffer_load_dwordx4 v144, s[8:11], s17 offen lds
  s_add_u32 s17, s17, s29
  s_add_u32 m0, s28, 26624
  s_nop 0
  buffer_load_dwordx4 v144, s[8:11], s17 offen lds
  s_add_u32 s17, s17, s29
  s_add_u32 m0, s28, 27648
  s_nop 0
  buffer_load_dwordx4 v144, s[8:11], s17 offen lds
  s_add_u32 s17, s17, s29
  s_waitcnt vmcnt(28)
  ds_read_b64_tr_b16 a[112:113], v152 offset:28672
  ds_read_b64_tr_b16 a[114:115], v153 offset:28672
  ds_read_b64_tr_b16 a[116:117], v154 offset:28672
  ds_read_b64_tr_b16 a[118:119], v155 offset:28672
  ds_read_b64_tr_b16 a[120:121], v152 offset:28736
  ds_read_b64_tr_b16 a[122:123], v153 offset:28736
  ds_read_b64_tr_b16 a[124:125], v154 offset:28736
  ds_read_b64_tr_b16 a[126:127], v155 offset:28736
  s_waitcnt lgkmcnt(0)
  s_add_u32 m0, s28, 28672
  s_nop 0
  buffer_load_dwordx4 v144, s[8:11], s17 offen lds
  s_add_u32 s17, s17, s29
  s_add_u32 m0, s28, 29696
  s_nop 0
  buffer_load_dwordx4 v144, s[8:11], s17 offen lds
  s_add_u32 s17, s17, s29
  s_add_u32 m0, s28, 30720
  s_nop 0
  buffer_load_dwordx4 v144, s[8:11], s17 offen lds
  s_add_u32 s17, s17, s29
  s_add_u32 m0, s28, 31744
  s_nop 0
  buffer_load_dwordx4 v144, s[8:11], s17 offen lds
  s_add_u32 s17, s17, s29
  s_waitcnt vmcnt(28)
  ds_read_b64_tr_b16 a[128:129], v152 offset:0
  ds_read_b64_tr_b16 a[130:131], v153 offset:0
  ds_read_b64_tr_b16 a[132:133], v154 offset:0
  ds_read_b64_tr_b16 a[134:135], v155 offset:0
  ds_read_b64_tr_b16 a[136:137], v152 offset:64
  ds_read_b64_tr_b16 a[138:139], v153 offset:64
  ds_read_b64_tr_b16 a[140:141], v154 offset:64
  ds_read_b64_tr_b16 a[142:143], v155 offset:64
  s_waitcnt lgkmcnt(0)
  s_waitcnt vmcnt(24)
  ds_read_b64_tr_b16 a[144:145], v152 offset:4096
  ds_read_b64_tr_b16 a[146:147], v153 offset:4096
  ds_read_b64_tr_b16 a[148:149], v154 offset:4096
  ds_read_b64_tr_b16 a[150:151], v155 offset:4096
  ds_read_b64_tr_b16 a[152:153], v152 offset:4160
  ds_read_b64_tr_b16 a[154:155], v153 offset:4160
  ds_read_b64_tr_b16 a[156:157], v154 offset:4160
  ds_read_b64_tr_b16 a[158:159], v155 offset:4160
  s_waitcnt lgkmcnt(0)
  s_waitcnt vmcnt(20)
  ds_read_b64_tr_b16 a[160:161], v152 offset:8192
  ds_read_b64_tr_b16 a[162:163], v153 offset:8192
  ds_read_b64_tr_b16 a[164:165], v154 offset:8192
  ds_read_b64_tr_b16 a[166:167], v155 offset:8192
  ds_read_b64_tr_b16 a[168:169], v152 offset:8256
  ds_read_b64_tr_b16 a[170:171], v153 offset:8256
  ds_read_b64_tr_b16 a[172:173], v154 offset:8256
  ds_read_b64_tr_b16 a[174:175], v155 offset:8256
  s_waitcnt lgkmcnt(0)
  s_waitcnt vmcnt(16)
  ds_read_b64_tr_b16 a[176:177], v152 offset:12288
  ds_read_b64_tr_b16 a[178:179], v153 offset:12288
  ds_read_b64_tr_b16 a[180:181], v154 offset:12288
  ds_read_b64_tr_b16 a[182:183], v155 offset:12288
  ds_read_b64_tr_b16 a[184:185], v152 offset:12352
  ds_read_b64_tr_b16 a[186:187], v153 offset:12352
  ds_read_b64_tr_b16 a[188:189], v154 offset:12352
  ds_read_b64_tr_b16 a[190:191], v155 offset:12352
  s_waitcnt lgkmcnt(0)
  s_waitcnt vmcnt(12)
  ds_read_b64_tr_b16 a[192:193], v152 offset:16384
  ds_read_b64_tr_b16 a[194:195], v153 offset:16384
  ds_read_b64_tr_b16 a[196:197], v154 offset:16384
  ds_read_b64_tr_b16 a[198:199], v155 offset:16384
  ds_read_b64_tr_b16 a[200:201], v152 offset:16448
  ds_read_b64_tr_b16 a[202:203], v153 offset:16448
  ds_read_b64_tr_b16 a[204:205], v154 offset:16448
  ds_read_b64_tr_b16 a[206:207], v155 offset:16448
  s_waitcnt lgkmcnt(0)
  s_waitcnt vmcnt(8)
  ds_read_b64_tr_b16 a[208:209], v152 offset:20480
  ds_read_b64_tr_b16 a[210:211], v153 offset:20480
  ds_read_b64_tr_b16 a[212:213], v154 offset:20480
  ds_read_b64_tr_b16 a[214:215], v155 offset:20480
  ds_read_b64_tr_b16 a[216:217], v152 offset:20544
  ds_read_b64_tr_b16 a[218:219], v153 offset:20544
  ds_read_b64_tr_b16 a[220:221], v154 offset:20544
  ds_read_b64_tr_b16 a[222:223], v155 offset:20544
  s_waitcnt lgkmcnt(0)
  s_waitcnt vmcnt(4)
  ds_read_b64_tr_b16 a[224:225], v152 offset:24576
  ds_read_b64_tr_b16 a[226:227], v153 offset:24576
  ds_read_b64_tr_b16 a[228:229], v154 offset:24576
  ds_read_b64_tr_b16 a[230:231], v155 offset:24576
  ds_read_b64_tr_b16 a[232:233], v152 offset:24640
  ds_read_b64_tr_b16 a[234:235], v153 offset:24640
  ds_read_b64_tr_b16 a[236:237], v154 offset:24640
  ds_read_b64_tr_b16 a[238:239], v155 offset:24640
  s_waitcnt lgkmcnt(0)
  s_waitcnt vmcnt(0)
  ds_read_b64_tr_b16 a[240:241], v152 offset:28672
  ds_read_b64_tr_b16 a[242:243], v153 offset:28672
  ds_read_b64_tr_b16 a[244:245], v154 offset:28672
  ds_read_b64_tr_b16 a[246:247], v155 offset:28672
  ds_read_b64_tr_b16 a[248:249], v152 offset:28736
  ds_read_b64_tr_b16 a[250:251], v153 offset:28736
  ds_read_b64_tr_b16 a[252:253], v154 offset:28736
  ds_read_b64_tr_b16 a[254:255], v155 offset:28736
  s_waitcnt lgkmcnt(0)
  v_min_u32 v4, 27, v1
  v_mul_u32_u24 v5, 37, v4
  v_lshrrev_b32 v5, 8, v5
  v_mul_u32_u24 v5, 7, v5
  v_sub_u32 v5, v4, v5
  v_mov_b32 v6, 0x200
  v_cmp_ne_u32 vcc, 6, v5
  s_mul_i32 s76, s48, 3584
  s_add_u32 s76, s76, 148897792
  v_cndmask_b32 v5, 0, v6, vcc
  v_lshl_add_u32 v4, v4, 7, s76
  s_mov_b32 s71, 0
  s_branch M_vg_49
M_vw_48:
  s_sleep 2
  s_add_u32 s71, s71, 1
  s_cmp_gt_u32 s71, 262144
  s_cbranch_scc1 M_exit
M_vg_49:
  buffer_load_dword v6, v4, s[4:7], 0 offen sc1
  s_waitcnt vmcnt(0)
  v_cmp_lt_u32 vcc, v6, v5
  s_cbranch_vccnz M_vw_48
  s_barrier
  s_lshl_b32 s25, s16, 13
  s_add_u32 m0, s25, 0
  s_nop 0
  buffer_load_dwordx4 v16, s[12:15], s19 offen sc1 lds
  s_add_u32 m0, s25, 1024
  s_nop 0
  buffer_load_dwordx4 v17, s[12:15], s19 offen sc1 lds
  s_add_u32 m0, s25, 2048
  s_nop 0
  buffer_load_dwordx4 v18, s[12:15], s19 offen sc1 lds
  s_add_u32 m0, s25, 3072
  s_nop 0
  buffer_load_dwordx4 v19, s[12:15], s19 offen sc1 lds
  s_add_u32 m0, s25, 4096
  s_nop 0
  buffer_load_dwordx4 v20, s[12:15], s19 offen sc1 lds
  s_add_u32 m0, s25, 5120
  s_nop 0
  buffer_load_dwordx4 v21, s[12:15], s19 offen sc1 lds
  s_add_u32 m0, s25, 6144
  s_nop 0
  buffer_load_dwordx4 v22, s[12:15], s19 offen sc1 lds
  s_add_u32 m0, s25, 7168
  s_nop 0
  buffer_load_dwordx4 v23, s[12:15], s19 offen sc1 lds
  s_cmp_gt_u32 s23, 1
  s_cselect_b32 s26, s20, 0
  s_add_u32 s19, s19, s26
  s_add_u32 s25, s25, 32768
  s_and_b32 s25, s25, 0x1ffff
  s_add_u32 m0, s25, 0
  s_nop 0
  buffer_load_dwordx4 v16, s[12:15], s19 offen sc1 lds
  s_add_u32 m0, s25, 1024
  s_nop 0
  buffer_load_dwordx4 v17, s[12:15], s19 offen sc1 lds
  s_add_u32 m0, s25, 2048
  s_nop 0
  buffer_load_dwordx4 v18, s[12:15], s19 offen sc1 lds
  s_add_u32 m0, s25, 3072
  s_nop 0
  buffer_load_dwordx4 v19, s[12:15], s19 offen sc1 lds
  s_add_u32 m0, s25, 4096
  s_nop 0
  buffer_load_dwordx4 v20, s[12:15], s19 offen sc1 lds
  s_add_u32 m0, s25, 5120
  s_nop 0
  buffer_load_dwordx4 v21, s[12:15], s19 offen sc1 lds
  s_add_u32 m0, s25, 6144
  s_nop 0
  buffer_load_dwordx4 v22, s[12:15], s19 offen sc1 lds
  s_add_u32 m0, s25, 7168
  s_nop 0
  buffer_load_dwordx4 v23, s[12:15], s19 offen sc1 lds
  s_cmp_gt_u32 s23, 2
  s_cselect_b32 s26, s20, 0
  s_add_u32 s19, s19, s26
  s_add_u32 s25, s25, 32768
  s_and_b32 s25, s25, 0x1ffff
  s_waitcnt vmcnt(0)
  s_barrier
  s_mov_b32 s27, s21
  v_mov_b32 v7, 0x40000000
  ds_read_b128 v[24:27], v8 offset:0
  ds_read_b128 v[28:31], v9 offset:0
  ds_read_b128 v[32:35], v10 offset:0
  ds_read_b128 v[36:39], v11 offset:0
  ds_read_b128 v[40:43], v12 offset:0
  ds_read_b128 v[44:47], v13 offset:0
.p2align 6
G_top_50:
  s_waitcnt lgkmcnt(5)
  v_mfma_f32_16x16x32_bf16 v[64:67], a[0:3], v[24:27], 0
  s_add_u32 m0, s25, 0
  ds_read_b128 v[48:51], v14 offset:0
  v_mfma_f32_16x16x32_bf16 v[68:71], a[4:7], v[24:27], 0
  v_mfma_f32_16x16x32_bf16 v[80:83], a[8:11], v[24:27], 0
  buffer_load_dwordx4 v16, s[12:15], s19 offen sc1 lds
  v_mfma_f32_16x16x32_bf16 v[84:87], a[12:15], v[24:27], 0
  s_waitcnt lgkmcnt(5)
  v_mfma_f32_16x16x32_bf16 v[72:75], a[0:3], v[28:31], 0
  ds_read_b128 v[52:55], v15 offset:0
  v_mfma_f32_16x16x32_bf16 v[76:79], a[4:7], v[28:31], 0
  v_cvt_pk_bf16_f32 v128, v96, v97
  v_cvt_pk_bf16_f32 v129, v98, v99
  v_mfma_f32_16x16x32_bf16 v[88:91], a[8:11], v[28:31], 0
  v_mfma_f32_16x16x32_bf16 v[92:95], a[12:15], v[28:31], 0
  s_waitcnt lgkmcnt(5)
  v_cvt_pk_bf16_f32 v130, v100, v101
  v_cvt_pk_bf16_f32 v131, v102, v103
  v_mfma_f32_16x16x32_bf16 v[64:67], a[16:19], v[32:35], v[64:67]
  s_add_u32 m0, s25, 1024
  ds_read_b128 v[24:27], v8 offset:8192
  v_mfma_f32_16x16x32_bf16 v[68:71], a[20:23], v[32:35], v[68:71]
  v_mfma_f32_16x16x32_bf16 v[80:83], a[24:27], v[32:35], v[80:83]
  buffer_load_dwordx4 v17, s[12:15], s19 offen sc1 lds
  v_mfma_f32_16x16x32_bf16 v[84:87], a[28:31], v[32:35], v[84:87]
  s_waitcnt lgkmcnt(5)
  v_mfma_f32_16x16x32_bf16 v[72:75], a[16:19], v[36:39], v[72:75]
  ds_read_b128 v[28:31], v9 offset:8192
  v_mfma_f32_16x16x32_bf16 v[76:79], a[20:23], v[36:39], v[76:79]
  v_mfma_f32_16x16x32_bf16 v[88:91], a[24:27], v[36:39], v[88:91]
  v_mfma_f32_16x16x32_bf16 v[92:95], a[28:31], v[36:39], v[92:95]
  s_waitcnt lgkmcnt(5)
  v_mfma_f32_16x16x32_bf16 v[64:67], a[32:35], v[40:43], v[64:67]
  s_add_u32 m0, s25, 2048
  ds_read_b128 v[32:35], v10 offset:8192
  v_mfma_f32_16x16x32_bf16 v[68:71], a[36:39], v[40:43], v[68:71]
  v_cvt_pk_bf16_f32 v132, v104, v105
  v_cvt_pk_bf16_f32 v133, v106, v107
  v_mfma_f32_16x16x32_bf16 v[80:83], a[40:43], v[40:43], v[80:83]
  buffer_load_dwordx4 v18, s[12:15], s19 offen sc1 lds
  v_mfma_f32_16x16x32_bf16 v[84:87], a[44:47], v[40:43], v[84:87]
  s_waitcnt lgkmcnt(5)
  v_cvt_pk_bf16_f32 v134, v108, v109
  v_cvt_pk_bf16_f32 v135, v110, v111
  v_mfma_f32_16x16x32_bf16 v[72:75], a[32:35], v[44:47], v[72:75]
  ds_read_b128 v[36:39], v11 offset:8192
  v_mfma_f32_16x16x32_bf16 v[76:79], a[36:39], v[44:47], v[76:79]
  v_mfma_f32_16x16x32_bf16 v[88:91], a[40:43], v[44:47], v[88:91]
  v_mfma_f32_16x16x32_bf16 v[92:95], a[44:47], v[44:47], v[92:95]
  s_waitcnt lgkmcnt(5)
  v_mfma_f32_16x16x32_bf16 v[64:67], a[48:51], v[48:51], v[64:67]
  s_add_u32 m0, s25, 3072
  ds_read_b128 v[40:43], v12 offset:8192
  v_mfma_f32_16x16x32_bf16 v[68:71], a[52:55], v[48:51], v[68:71]
  v_mfma_f32_16x16x32_bf16 v[80:83], a[56:59], v[48:51], v[80:83]
  buffer_load_dwordx4 v19, s[12:15], s19 offen sc1 lds
  v_mfma_f32_16x16x32_bf16 v[84:87], a[60:63], v[48:51], v[84:87]
  s_waitcnt lgkmcnt(5)
  v_mfma_f32_16x16x32_bf16 v[72:75], a[48:51], v[52:55], v[72:75]
  ds_read_b128 v[44:47], v13 offset:8192
  v_mfma_f32_16x16x32_bf16 v[76:79], a[52:55], v[52:55], v[76:79]
  v_cvt_pk_bf16_f32 v136, v112, v113
  v_cvt_pk_bf16_f32 v137, v114, v115
  v_mfma_f32_16x16x32_bf16 v[88:91], a[56:59], v[52:55], v[88:91]
  v_mfma_f32_16x16x32_bf16 v[92:95], a[60:63], v[52:55], v[92:95]
  s_waitcnt lgkmcnt(5)
  v_cvt_pk_bf16_f32 v138, v116, v117
  v_cvt_pk_bf16_f32 v139, v118, v119
  v_mfma_f32_16x16x32_bf16 v[64:67], a[64:67], v[24:27], v[64:67]
  s_add_u32 m0, s25, 4096
  ds_read_b128 v[48:51], v14 offset:8192
  v_mfma_f32_16x16x32_bf16 v[68:71], a[68:71], v[24:27], v[68:71]
  v_mfma_f32_16x16x32_bf16 v[80:83], a[72:75], v[24:27], v[80:83]
  buffer_load_dwordx4 v20, s[12:15], s19 offen sc1 lds
  v_mfma_f32_16x16x32_bf16 v[84:87], a[76:79], v[24:27], v[84:87]
  s_waitcnt lgkmcnt(5)
  v_mfma_f32_16x16x32_bf16 v[72:75], a[64:67], v[28:31], v[72:75]
  ds_read_b128 v[52:55], v15 offset:8192
  v_mfma_f32_16x16x32_bf16 v[76:79], a[68:71], v[28:31], v[76:79]
  v_mfma_f32_16x16x32_bf16 v[88:91], a[72:75], v[28:31], v[88:91]
  v_mfma_f32_16x16x32_bf16 v[92:95], a[76:79], v[28:31], v[92:95]
  s_waitcnt lgkmcnt(5)
  v_mfma_f32_16x16x32_bf16 v[64:67], a[80:83], v[32:35], v[64:67]
  s_add_u32 m0, s25, 5120
  ds_read_b128 v[24:27], v8 offset:16384
  v_mfma_f32_16x16x32_bf16 v[68:71], a[84:87], v[32:35], v[68:71]
  v_cvt_pk_bf16_f32 v140, v120, v121
  v_cvt_pk_bf16_f32 v141, v122, v123
  v_mfma_f32_16x16x32_bf16 v[80:83], a[88:91], v[32:35], v[80:83]
  buffer_load_dwordx4 v21, s[12:15], s19 offen sc1 lds
  v_mfma_f32_16x16x32_bf16 v[84:87], a[92:95], v[32:35], v[84:87]
  s_waitcnt lgkmcnt(5)
  v_cvt_pk_bf16_f32 v142, v124, v125
  v_cvt_pk_bf16_f32 v143, v126, v127
  v_mfma_f32_16x16x32_bf16 v[72:75], a[80:83], v[36:39], v[72:75]
  ds_read_b128 v[28:31], v9 offset:16384
  v_mfma_f32_16x16x32_bf16 v[76:79], a[84:87], v[36:39], v[76:79]
  v_mfma_f32_16x16x32_bf16 v[88:91], a[88:91], v[36:39], v[88:91]
  v_mfma_f32_16x16x32_bf16 v[92:95], a[92:95], v[36:39], v[92:95]
  s_waitcnt lgkmcnt(5)
  v_mfma_f32_16x16x32_bf16 v[64:67], a[96:99], v[40:43], v[64:67]
  s_add_u32 m0, s25, 6144
  ds_read_b128 v[32:35], v10 offset:16384
  v_mfma_f32_16x16x32_bf16 v[68:71], a[100:103], v[40:43], v[68:71]
  v_mfma_f32_16x16x32_bf16 v[80:83], a[104:107], v[40:43], v[80:83]
  buffer_load_dwordx4 v22, s[12:15], s19 offen sc1 lds
  v_mfma_f32_16x16x32_bf16 v[84:87], a[108:111], v[40:43], v[84:87]
  s_waitcnt lgkmcnt(5)
  v_mfma_f32_16x16x32_bf16 v[72:75], a[96:99], v[44:47], v[72:75]
  ds_read_b128 v[36:39], v11 offset:16384
  v_mfma_f32_16x16x32_bf16 v[76:79], a[100:103], v[44:47], v[76:79]
  v_mfma_f32_16x16x32_bf16 v[88:91], a[104:107], v[44:47], v[88:91]
  v_mfma_f32_16x16x32_bf16 v[92:95], a[108:111], v[44:47], v[92:95]
  s_waitcnt lgkmcnt(5)
  v_mfma_f32_16x16x32_bf16 v[64:67], a[112:115], v[48:51], v[64:67]
  s_add_u32 m0, s25, 7168
  ds_read_b128 v[40:43], v12 offset:16384
  v_mfma_f32_16x16x32_bf16 v[68:71], a[116:119], v[48:51], v[68:71]
  v_mfma_f32_16x16x32_bf16 v[80:83], a[120:123], v[48:51], v[80:83]
  buffer_load_dwordx4 v23, s[12:15], s19 offen sc1 lds
  v_mfma_f32_16x16x32_bf16 v[84:87], a[124:127], v[48:51], v[84:87]
  s_waitcnt lgkmcnt(5)
  v_mfma_f32_16x16x32_bf16 v[72:75], a[112:115], v[52:55], v[72:75]
  s_cmp_gt_u32 s23, 3
  ds_read_b128 v[44:47], v13 offset:16384
  v_mfma_f32_16x16x32_bf16 v[76:79], a[116:119], v[52:55], v[76:79]
  v_mfma_f32_16x16x32_bf16 v[88:91], a[120:123], v[52:55], v[88:91]
  s_cselect_b32 s26, s20, 0
  v_mfma_f32_16x16x32_bf16 v[92:95], a[124:127], v[52:55], v[92:95]
  s_waitcnt lgkmcnt(5)
  v_mfma_f32_16x16x32_bf16 v[64:67], a[128:131], v[24:27], v[64:67]
  s_add_u32 s19, s19, s26
  ds_read_b128 v[48:51], v14 offset:16384
  v_mfma_f32_16x16x32_bf16 v[68:71], a[132:135], v[24:27], v[68:71]
  v_mfma_f32_16x16x32_bf16 v[80:83], a[136:139], v[24:27], v[80:83]
  s_add_u32 s25, s25, 32768
  v_mfma_f32_16x16x32_bf16 v[84:87], a[140:143], v[24:27], v[84:87]
  s_waitcnt lgkmcnt(5)
  v_mfma_f32_16x16x32_bf16 v[72:75], a[128:131], v[28:31], v[72:75]
  s_and_b32 s25, s25, 0x1ffff
  ds_read_b128 v[52:55], v15 offset:16384
  v_mfma_f32_16x16x32_bf16 v[76:79], a[132:135], v[28:31], v[76:79]
  v_mfma_f32_16x16x32_bf16 v[88:91], a[136:139], v[28:31], v[88:91]
  buffer_store_dwordx4 v[128:131], v7, s[4:7], s21 offen offset:0 sc1
  v_mfma_f32_16x16x32_bf16 v[92:95], a[140:143], v[28:31], v[92:95]
  s_waitcnt lgkmcnt(5)
  v_mfma_f32_16x16x32_bf16 v[64:67], a[144:147], v[32:35], v[64:67]
  ds_read_b128 v[24:27], v8 offset:24576
  v_mfma_f32_16x16x32_bf16 v[68:71], a[148:151], v[32:35], v[68:71]
  v_mfma_f32_16x16x32_bf16 v[80:83], a[152:155], v[32:35], v[80:83]
  v_mfma_f32_16x16x32_bf16 v[84:87], a[156:159], v[32:35], v[84:87]
  s_waitcnt lgkmcnt(5)
  v_mfma_f32_16x16x32_bf16 v[72:75], a[144:147], v[36:39], v[72:75]
  ds_read_b128 v[28:31], v9 offset:24576
  v_mfma_f32_16x16x32_bf16 v[76:79], a[148:151], v[36:39], v[76:79]
  v_mfma_f32_16x16x32_bf16 v[88:91], a[152:155], v[36:39], v[88:91]
  buffer_store_dwordx4 v[132:135], v7, s[4:7], s21 offen offset:256 sc1
  v_mfma_f32_16x16x32_bf16 v[92:95], a[156:159], v[36:39], v[92:95]
  s_waitcnt lgkmcnt(5)
  v_mfma_f32_16x16x32_bf16 v[64:67], a[160:163], v[40:43], v[64:67]
  ds_read_b128 v[32:35], v10 offset:24576
  v_mfma_f32_16x16x32_bf16 v[68:71], a[164:167], v[40:43], v[68:71]
  v_mfma_f32_16x16x32_bf16 v[80:83], a[168:171], v[40:43], v[80:83]
  v_mfma_f32_16x16x32_bf16 v[84:87], a[172:175], v[40:43], v[84:87]
  s_waitcnt lgkmcnt(5)
  v_mfma_f32_16x16x32_bf16 v[72:75], a[160:163], v[44:47], v[72:75]
  ds_read_b128 v[36:39], v11 offset:24576
  v_mfma_f32_16x16x32_bf16 v[76:79], a[164:167], v[44:47], v[76:79]
  v_mfma_f32_16x16x32_bf16 v[88:91], a[168:171], v[44:47], v[88:91]
  buffer_store_dwordx4 v[136:139], v7, s[4:7], s21 offen offset:2048 sc1
  v_mfma_f32_16x16x32_bf16 v[92:95], a[172:175], v[44:47], v[92:95]
  s_waitcnt lgkmcnt(5)
  v_mfma_f32_16x16x32_bf16 v[64:67], a[176:179], v[48:51], v[64:67]
  ds_read_b128 v[40:43], v12 offset:24576
  v_mfma_f32_16x16x32_bf16 v[68:71], a[180:183], v[48:51], v[68:71]
  v_mfma_f32_16x16x32_bf16 v[80:83], a[184:187], v[48:51], v[80:83]
  v_mfma_f32_16x16x32_bf16 v[84:87], a[188:191], v[48:51], v[84:87]
  s_waitcnt lgkmcnt(5)
  v_mfma_f32_16x16x32_bf16 v[72:75], a[176:179], v[52:55], v[72:75]
  ds_read_b128 v[44:47], v13 offset:24576
  v_mfma_f32_16x16x32_bf16 v[76:79], a[180:183], v[52:55], v[76:79]
  v_mfma_f32_16x16x32_bf16 v[88:91], a[184:187], v[52:55], v[88:91]
  buffer_store_dwordx4 v[140:143], v7, s[4:7], s21 offen offset:2304 sc1
  v_mfma_f32_16x16x32_bf16 v[92:95], a[188:191], v[52:55], v[92:95]
  s_waitcnt lgkmcnt(5)
  v_mfma_f32_16x16x32_bf16 v[64:67], a[192:195], v[24:27], v[64:67]
  s_mov_b32 s21, s27
  ds_read_b128 v[48:51], v14 offset:24576
  v_mfma_f32_16x16x32_bf16 v[68:71], a[196:199], v[24:27], v[68:71]
  v_mov_b32 v7, v56
  v_mfma_f32_16x16x32_bf16 v[80:83], a[200:203], v[24:27], v[80:83]
  v_mfma_f32_16x16x32_bf16 v[84:87], a[204:207], v[24:27], v[84:87]
  s_waitcnt lgkmcnt(5)
  v_mfma_f32_16x16x32_bf16 v[72:75], a[192:195], v[28:31], v[72:75]
  s_add_u32 s27, s27, s22
  ds_read_b128 v[52:55], v15 offset:24576
  v_mfma_f32_16x16x32_bf16 v[76:79], a[196:199], v[28:31], v[76:79]
  v_mfma_f32_16x16x32_bf16 v[88:91], a[200:203], v[28:31], v[88:91]
  s_waitcnt vmcnt(16)
  s_barrier
  v_mfma_f32_16x16x32_bf16 v[92:95], a[204:207], v[28:31], v[92:95]
  s_waitcnt lgkmcnt(5)
  v_mfma_f32_16x16x32_bf16 v[64:67], a[208:211], v[32:35], v[64:67]
  ds_read_b128 v[24:27], v8 offset:32768
  v_mfma_f32_16x16x32_bf16 v[68:71], a[212:215], v[32:35], v[68:71]
  v_mfma_f32_16x16x32_bf16 v[80:83], a[216:219], v[32:35], v[80:83]
  v_mfma_f32_16x16x32_bf16 v[84:87], a[220:223], v[32:35], v[84:87]
  s_waitcnt lgkmcnt(5)
  v_mfma_f32_16x16x32_bf16 v[72:75], a[208:211], v[36:39], v[72:75]
  ds_read_b128 v[28:31], v9 offset:32768
  v_mfma_f32_16x16x32_bf16 v[76:79], a[212:215], v[36:39], v[76:79]
  v_mfma_f32_16x16x32_bf16 v[88:91], a[216:219], v[36:39], v[88:91]
  v_mfma_f32_16x16x32_bf16 v[92:95], a[220:223], v[36:39], v[92:95]
  s_waitcnt lgkmcnt(5)
  v_mfma_f32_16x16x32_bf16 v[64:67], a[224:227], v[40:43], v[64:67]
  ds_read_b128 v[32:35], v10 offset:32768
  v_mfma_f32_16x16x32_bf16 v[68:71], a[228:231], v[40:43], v[68:71]
  v_mfma_f32_16x16x32_bf16 v[80:83], a[232:235], v[40:43], v[80:83]
  v_mfma_f32_16x16x32_bf16 v[84:87], a[236:239], v[40:43], v[84:87]
  s_waitcnt lgkmcnt(5)
  v_mfma_f32_16x16x32_bf16 v[72:75], a[224:227], v[44:47], v[72:75]
  ds_read_b128 v[36:39], v11 offset:32768
  v_mfma_f32_16x16x32_bf16 v[76:79], a[228:231], v[44:47], v[76:79]
  v_mfma_f32_16x16x32_bf16 v[88:91], a[232:235], v[44:47], v[88:91]
  v_mfma_f32_16x16x32_bf16 v[92:95], a[236:239], v[44:47], v[92:95]
  s_waitcnt lgkmcnt(5)
  v_mfma_f32_16x16x32_bf16 v[64:67], a[240:243], v[48:51], v[64:67]
  s_sub_u32 s23, s23, 1
  ds_read_b128 v[40:43], v12 offset:32768
  v_mfma_f32_16x16x32_bf16 v[68:71], a[244:247], v[48:51], v[68:71]
  v_mfma_f32_16x16x32_bf16 v[80:83], a[248:251], v[48:51], v[80:83]
  v_mfma_f32_16x16x32_bf16 v[84:87], a[252:255], v[48:51], v[84:87]
  s_waitcnt lgkmcnt(5)
  v_mfma_f32_16x16x32_bf16 v[72:75], a[240:243], v[52:55], v[72:75]
  s_cmp_eq_u32 s23, 0
  ds_read_b128 v[44:47], v13 offset:32768
  v_mfma_f32_16x16x32_bf16 v[76:79], a[244:247], v[52:55], v[76:79]
  v_mfma_f32_16x16x32_bf16 v[88:91], a[248:251], v[52:55], v[88:91]
  v_mfma_f32_16x16x32_bf16 v[92:95], a[252:255], v[52:55], v[92:95]
  s_cbranch_scc1 G_done0_51
  s_waitcnt lgkmcnt(5)
  v_mfma_f32_16x16x32_bf16 v[96:99], a[0:3], v[24:27], 0
  s_add_u32 m0, s25, 0
  ds_read_b128 v[48:51], v14 offset:32768
  v_mfma_f32_16x16x32_bf16 v[100:103], a[4:7], v[24:27], 0
  v_mfma_f32_16x16x32_bf16 v[112:115], a[8:11], v[24:27], 0
  buffer_load_dwordx4 v16, s[12:15], s19 offen sc1 lds
  v_mfma_f32_16x16x32_bf16 v[116:119], a[12:15], v[24:27], 0
  s_waitcnt lgkmcnt(5)
  v_mfma_f32_16x16x32_bf16 v[104:107], a[0:3], v[28:31], 0
  ds_read_b128 v[52:55], v15 offset:32768
  v_mfma_f32_16x16x32_bf16 v[108:111], a[4:7], v[28:31], 0
  v_cvt_pk_bf16_f32 v128, v64, v65
  v_cvt_pk_bf16_f32 v129, v66, v67
  v_mfma_f32_16x16x32_bf16 v[120:123], a[8:11], v[28:31], 0
  v_mfma_f32_16x16x32_bf16 v[124:127], a[12:15], v[28:31], 0
  s_waitcnt lgkmcnt(5)
  v_cvt_pk_bf16_f32 v130, v68, v69
  v_cvt_pk_bf16_f32 v131, v70, v71
  v_mfma_f32_16x16x32_bf16 v[96:99], a[16:19], v[32:35], v[96:99]
  s_add_u32 m0, s25, 1024
  ds_read_b128 v[24:27], v8 offset:40960
  v_mfma_f32_16x16x32_bf16 v[100:103], a[20:23], v[32:35], v[100:103]
  v_mfma_f32_16x16x32_bf16 v[112:115], a[24:27], v[32:35], v[112:115]
  buffer_load_dwordx4 v17, s[12:15], s19 offen sc1 lds
  v_mfma_f32_16x16x32_bf16 v[116:119], a[28:31], v[32:35], v[116:119]
  s_waitcnt lgkmcnt(5)
  v_mfma_f32_16x16x32_bf16 v[104:107], a[16:19], v[36:39], v[104:107]
  ds_read_b128 v[28:31], v9 offset:40960
  v_mfma_f32_16x16x32_bf16 v[108:111], a[20:23], v[36:39], v[108:111]
  v_mfma_f32_16x16x32_bf16 v[120:123], a[24:27], v[36:39], v[120:123]
  v_mfma_f32_16x16x32_bf16 v[124:127], a[28:31], v[36:39], v[124:127]
  s_waitcnt lgkmcnt(5)
  v_mfma_f32_16x16x32_bf16 v[96:99], a[32:35], v[40:43], v[96:99]
  s_add_u32 m0, s25, 2048
  ds_read_b128 v[32:35], v10 offset:40960
  v_mfma_f32_16x16x32_bf16 v[100:103], a[36:39], v[40:43], v[100:103]
  v_cvt_pk_bf16_f32 v132, v72, v73
  v_cvt_pk_bf16_f32 v133, v74, v75
  v_mfma_f32_16x16x32_bf16 v[112:115], a[40:43], v[40:43], v[112:115]
  buffer_load_dwordx4 v18, s[12:15], s19 offen sc1 lds
  v_mfma_f32_16x16x32_bf16 v[116:119], a[44:47], v[40:43], v[116:119]
  s_waitcnt lgkmcnt(5)
  v_cvt_pk_bf16_f32 v134, v76, v77
  v_cvt_pk_bf16_f32 v135, v78, v79
  v_mfma_f32_16x16x32_bf16 v[104:107], a[32:35], v[44:47], v[104:107]
  ds_read_b128 v[36:39], v11 offset:40960
  v_mfma_f32_16x16x32_bf16 v[108:111], a[36:39], v[44:47], v[108:111]
  v_mfma_f32_16x16x32_bf16 v[120:123], a[40:43], v[44:47], v[120:123]
  v_mfma_f32_16x16x32_bf16 v[124:127], a[44:47], v[44:47], v[124:127]
  s_waitcnt lgkmcnt(5)
  v_mfma_f32_16x16x32_bf16 v[96:99], a[48:51], v[48:51], v[96:99]
  s_add_u32 m0, s25, 3072
  ds_read_b128 v[40:43], v12 offset:40960
  v_mfma_f32_16x16x32_bf16 v[100:103], a[52:55], v[48:51], v[100:103]
  v_mfma_f32_16x16x32_bf16 v[112:115], a[56:59], v[48:51], v[112:115]
  buffer_load_dwordx4 v19, s[12:15], s19 offen sc1 lds
  v_mfma_f32_16x16x32_bf16 v[116:119], a[60:63], v[48:51], v[116:119]
  s_waitcnt lgkmcnt(5)
  v_mfma_f32_16x16x32_bf16 v[104:107], a[48:51], v[52:55], v[104:107]
  ds_read_b128 v[44:47], v13 offset:40960
  v_mfma_f32_16x16x32_bf16 v[108:111], a[52:55], v[52:55], v[108:111]
  v_cvt_pk_bf16_f32 v136, v80, v81
  v_cvt_pk_bf16_f32 v137, v82, v83
  v_mfma_f32_16x16x32_bf16 v[120:123], a[56:59], v[52:55], v[120:123]
  v_mfma_f32_16x16x32_bf16 v[124:127], a[60:63], v[52:55], v[124:127]
  s_waitcnt lgkmcnt(5)
  v_cvt_pk_bf16_f32 v138, v84, v85
  v_cvt_pk_bf16_f32 v139, v86, v87
  v_mfma_f32_16x16x32_bf16 v[96:99], a[64:67], v[24:27], v[96:99]
  s_add_u32 m0, s25, 4096
  ds_read_b128 v[48:51], v14 offset:40960
  v_mfma_f32_16x16x32_bf16 v[100:103], a[68:71], v[24:27], v[100:103]
  v_mfma_f32_16x16x32_bf16 v[112:115], a[72:75], v[24:27], v[112:115]
  buffer_load_dwordx4 v20, s[12:15], s19 offen sc1 lds
  v_mfma_f32_16x16x32_bf16 v[116:119], a[76:79], v[24:27], v[116:119]
  s_waitcnt lgkmcnt(5)
  v_mfma_f32_16x16x32_bf16 v[104:107], a[64:67], v[28:31], v[104:107]
  ds_read_b128 v[52:55], v15 offset:40960
  v_mfma_f32_16x16x32_bf16 v[108:111], a[68:71], v[28:31], v[108:111]
  v_mfma_f32_16x16x32_bf16 v[120:123], a[72:75], v[28:31], v[120:123]
  v_mfma_f32_16x16x32_bf16 v[124:127], a[76:79], v[28:31], v[124:127]
  s_waitcnt lgkmcnt(5)
  v_mfma_f32_16x16x32_bf16 v[96:99], a[80:83], v[32:35], v[96:99]
  s_add_u32 m0, s25, 5120
  ds_read_b128 v[24:27], v8 offset:49152
  v_mfma_f32_16x16x32_bf16 v[100:103], a[84:87], v[32:35], v[100:103]
  v_cvt_pk_bf16_f32 v140, v88, v89
  v_cvt_pk_bf16_f32 v141, v90, v91
  v_mfma_f32_16x16x32_bf16 v[112:115], a[88:91], v[32:35], v[112:115]
  buffer_load_dwordx4 v21, s[12:15], s19 offen sc1 lds
  v_mfma_f32_16x16x32_bf16 v[116:119], a[92:95], v[32:35], v[116:119]
  s_waitcnt lgkmcnt(5)
  v_cvt_pk_bf16_f32 v142, v92, v93
  v_cvt_pk_bf16_f32 v143, v94, v95
  v_mfma_f32_16x16x32_bf16 v[104:107], a[80:83], v[36:39], v[104:107]
  ds_read_b128 v[28:31], v9 offset:49152
  v_mfma_f32_16x16x32_bf16 v[108:111], a[84:87], v[36:39], v[108:111]
  v_mfma_f32_16x16x32_bf16 v[120:123], a[88:91], v[36:39], v[120:123]
  v_mfma_f32_16x16x32_bf16 v[124:127], a[92:95], v[36:39], v[124:127]
  s_waitcnt lgkmcnt(5)
  v_mfma_f32_16x16x32_bf16 v[96:99], a[96:99], v[40:43], v[96:99]
  s_add_u32 m0, s25, 6144
  ds_read_b128 v[32:35], v10 offset:49152
  v_mfma_f32_16x16x32_bf16 v[100:103], a[100:103], v[40:43], v[100:103]
  v_mfma_f32_16x16x32_bf16 v[112:115], a[104:107], v[40:43], v[112:115]
  buffer_load_dwordx4 v22, s[12:15], s19 offen sc1 lds
  v_mfma_f32_16x16x32_bf16 v[116:119], a[108:111], v[40:43], v[116:119]
  s_waitcnt lgkmcnt(5)
  v_mfma_f32_16x16x32_bf16 v[104:107], a[96:99], v[44:47], v[104:107]
  ds_read_b128 v[36:39], v11 offset:49152
  v_mfma_f32_16x16x32_bf16 v[108:111], a[100:103], v[44:47], v[108:111]
  v_mfma_f32_16x16x32_bf16 v[120:123], a[104:107], v[44:47], v[120:123]
  v_mfma_f32_16x16x32_bf16 v[124:127], a[108:111], v[44:47], v[124:127]
  s_waitcnt lgkmcnt(5)
  v_mfma_f32_16x16x32_bf16 v[96:99], a[112:115], v[48:51], v[96:99]
  s_add_u32 m0, s25, 7168
  ds_read_b128 v[40:43], v12 offset:49152
  v_mfma_f32_16x16x32_bf16 v[100:103], a[116:119], v[48:51], v[100:103]
  v_mfma_f32_16x16x32_bf16 v[112:115], a[120:123], v[48:51], v[112:115]
  buffer_load_dwordx4 v23, s[12:15], s19 offen sc1 lds
  v_mfma_f32_16x16x32_bf16 v[116:119], a[124:127], v[48:51], v[116:119]
  s_waitcnt lgkmcnt(5)
  v_mfma_f32_16x16x32_bf16 v[104:107], a[112:115], v[52:55], v[104:107]
  s_cmp_gt_u32 s23, 3
  ds_read_b128 v[44:47], v13 offset:49152
  v_mfma_f32_16x16x32_bf16 v[108:111], a[116:119], v[52:55], v[108:111]
  v_mfma_f32_16x16x32_bf16 v[120:123], a[120:123], v[52:55], v[120:123]
  s_cselect_b32 s26, s20, 0
  v_mfma_f32_16x16x32_bf16 v[124:127], a[124:127], v[52:55], v[124:127]
  s_waitcnt lgkmcnt(5)
  v_mfma_f32_16x16x32_bf16 v[96:99], a[128:131], v[24:27], v[96:99]
  s_add_u32 s19, s19, s26
  ds_read_b128 v[48:51], v14 offset:49152
  v_mfma_f32_16x16x32_bf16 v[100:103], a[132:135], v[24:27], v[100:103]
  v_mfma_f32_16x16x32_bf16 v[112:115], a[136:139], v[24:27], v[112:115]
  s_add_u32 s25, s25, 32768
  v_mfma_f32_16x16x32_bf16 v[116:119], a[140:143], v[24:27], v[116:119]
  s_waitcnt lgkmcnt(5)
  v_mfma_f32_16x16x32_bf16 v[104:107], a[128:131], v[28:31], v[104:107]
  s_and_b32 s25, s25, 0x1ffff
  ds_read_b128 v[52:55], v15 offset:49152
  v_mfma_f32_16x16x32_bf16 v[108:111], a[132:135], v[28:31], v[108:111]
  v_mfma_f32_16x16x32_bf16 v[120:123], a[136:139], v[28:31], v[120:123]
  buffer_store_dwordx4 v[128:131], v7, s[4:7], s21 offen offset:0 sc1
  v_mfma_f32_16x16x32_bf16 v[124:127], a[140:143], v[28:31], v[124:127]
  s_waitcnt lgkmcnt(5)
  v_mfma_f32_16x16x32_bf16 v[96:99], a[144:147], v[32:35], v[96:99]
  ds_read_b128 v[24:27], v8 offset:57344
  v_mfma_f32_16x16x32_bf16 v[100:103], a[148:151], v[32:35], v[100:103]
  v_mfma_f32_16x16x32_bf16 v[112:115], a[152:155], v[32:35], v[112:115]
  v_mfma_f32_16x16x32_bf16 v[116:119], a[156:159], v[32:35], v[116:119]
  s_waitcnt lgkmcnt(5)
  v_xor_b32 v8, 0x10000, v8
  v_mfma_f32_16x16x32_bf16 v[104:107], a[144:147], v[36:39], v[104:107]
  ds_read_b128 v[28:31], v9 offset:57344
  v_mfma_f32_16x16x32_bf16 v[108:111], a[148:151], v[36:39], v[108:111]
  v_mfma_f32_16x16x32_bf16 v[120:123], a[152:155], v[36:39], v[120:123]
  buffer_store_dwordx4 v[132:135], v7, s[4:7], s21 offen offset:256 sc1
  v_mfma_f32_16x16x32_bf16 v[124:127], a[156:159], v[36:39], v[124:127]
  s_waitcnt lgkmcnt(5)
  v_xor_b32 v9, 0x10000, v9
  v_mfma_f32_16x16x32_bf16 v[96:99], a[160:163], v[40:43], v[96:99]
  ds_read_b128 v[32:35], v10 offset:57344
  v_mfma_f32_16x16x32_bf16 v[100:103], a[164:167], v[40:43], v[100:103]
  v_mfma_f32_16x16x32_bf16 v[112:115], a[168:171], v[40:43], v[112:115]
  v_mfma_f32_16x16x32_bf16 v[116:119], a[172:175], v[40:43], v[116:119]
  s_waitcnt lgkmcnt(5)
  v_xor_b32 v10, 0x10000, v10
  v_mfma_f32_16x16x32_bf16 v[104:107], a[160:163], v[44:47], v[104:107]
  ds_read_b128 v[36:39], v11 offset:57344
  v_mfma_f32_16x16x32_bf16 v[108:111], a[164:167], v[44:47], v[108:111]
  v_mfma_f32_16x16x32_bf16 v[120:123], a[168:171], v[44:47], v[120:123]
  buffer_store_dwordx4 v[136:139], v7, s[4:7], s21 offen offset:2048 sc1
  v_mfma_f32_16x16x32_bf16 v[124:127], a[172:175], v[44:47], v[124:127]
  s_waitcnt lgkmcnt(5)
  v_xor_b32 v11, 0x10000, v11
  v_mfma_f32_16x16x32_bf16 v[96:99], a[176:179], v[48:51], v[96:99]
  ds_read_b128 v[40:43], v12 offset:57344
  v_mfma_f32_16x16x32_bf16 v[100:103], a[180:183], v[48:51], v[100:103]
  v_mfma_f32_16x16x32_bf16 v[112:115], a[184:187], v[48:51], v[112:115]
  v_mfma_f32_16x16x32_bf16 v[116:119], a[188:191], v[48:51], v[116:119]
  s_waitcnt lgkmcnt(5)
  v_xor_b32 v12, 0x10000, v12
  v_mfma_f32_16x16x32_bf16 v[104:107], a[176:179], v[52:55], v[104:107]
  ds_read_b128 v[44:47], v13 offset:57344
  v_mfma_f32_16x16x32_bf16 v[108:111], a[180:183], v[52:55], v[108:111]
  v_mfma_f32_16x16x32_bf16 v[120:123], a[184:187], v[52:55], v[120:123]
  buffer_store_dwordx4 v[140:143], v7, s[4:7], s21 offen offset:2304 sc1
  v_mfma_f32_16x16x32_bf16 v[124:127], a[188:191], v[52:55], v[124:127]
  s_waitcnt lgkmcnt(5)
  v_xor_b32 v13, 0x10000, v13
  v_mfma_f32_16x16x32_bf16 v[96:99], a[192:195], v[24:27], v[96:99]
  s_mov_b32 s21, s27
  ds_read_b128 v[48:51], v14 offset:57344
  v_mfma_f32_16x16x32_bf16 v[100:103], a[196:199], v[24:27], v[100:103]
  v_mov_b32 v7, v56
  v_mfma_f32_16x16x32_bf16 v[112:115], a[200:203], v[24:27], v[112:115]
  v_mfma_f32_16x16x32_bf16 v[116:119], a[204:207], v[24:27], v[116:119]
  s_waitcnt lgkmcnt(5)
  v_xor_b32 v14, 0x10000, v14
  v_mfma_f32_16x16x32_bf16 v[104:107], a[192:195], v[28:31], v[104:107]
  s_add_u32 s27, s27, s22
  ds_read_b128 v[52:55], v15 offset:57344
  v_mfma_f32_16x16x32_bf16 v[108:111], a[196:199], v[28:31], v[108:111]
  v_mfma_f32_16x16x32_bf16 v[120:123], a[200:203], v[28:31], v[120:123]
  s_waitcnt vmcnt(16)
  s_barrier
  v_mfma_f32_16x16x32_bf16 v[124:127], a[204:207], v[28:31], v[124:127]
  s_waitcnt lgkmcnt(5)
  v_xor_b32 v15, 0x10000, v15
  v_mfma_f32_16x16x32_bf16 v[96:99], a[208:211], v[32:35], v[96:99]
  ds_read_b128 v[24:27], v8 offset:0
  v_mfma_f32_16x16x32_bf16 v[100:103], a[212:215], v[32:35], v[100:103]
  v_mfma_f32_16x16x32_bf16 v[112:115], a[216:219], v[32:35], v[112:115]
  v_mfma_f32_16x16x32_bf16 v[116:119], a[220:223], v[32:35], v[116:119]
  s_waitcnt lgkmcnt(5)
  v_mfma_f32_16x16x32_bf16 v[104:107], a[208:211], v[36:39], v[104:107]
  ds_read_b128 v[28:31], v9 offset:0
  v_mfma_f32_16x16x32_bf16 v[108:111], a[212:215], v[36:39], v[108:111]
  v_mfma_f32_16x16x32_bf16 v[120:123], a[216:219], v[36:39], v[120:123]
  v_mfma_f32_16x16x32_bf16 v[124:127], a[220:223], v[36:39], v[124:127]
  s_waitcnt lgkmcnt(5)
  v_mfma_f32_16x16x32_bf16 v[96:99], a[224:227], v[40:43], v[96:99]
  ds_read_b128 v[32:35], v10 offset:0
  v_mfma_f32_16x16x32_bf16 v[100:103], a[228:231], v[40:43], v[100:103]
  v_mfma_f32_16x16x32_bf16 v[112:115], a[232:235], v[40:43], v[112:115]
  v_mfma_f32_16x16x32_bf16 v[116:119], a[236:239], v[40:43], v[116:119]
  s_waitcnt lgkmcnt(5)
  v_mfma_f32_16x16x32_bf16 v[104:107], a[224:227], v[44:47], v[104:107]
  ds_read_b128 v[36:39], v11 offset:0
  v_mfma_f32_16x16x32_bf16 v[108:111], a[228:231], v[44:47], v[108:111]
  v_mfma_f32_16x16x32_bf16 v[120:123], a[232:235], v[44:47], v[120:123]
  v_mfma_f32_16x16x32_bf16 v[124:127], a[236:239], v[44:47], v[124:127]
  s_waitcnt lgkmcnt(5)
  v_mfma_f32_16x16x32_bf16 v[96:99], a[240:243], v[48:51], v[96:99]
  s_sub_u32 s23, s23, 1
  ds_read_b128 v[40:43], v12 offset:0
  v_mfma_f32_16x16x32_bf16 v[100:103], a[244:247], v[48:51], v[100:103]
  v_mfma_f32_16x16x32_bf16 v[112:115], a[248:251], v[48:51], v[112:115]
  v_mfma_f32_16x16x32_bf16 v[116:119], a[252:255], v[48:51], v[116:119]
  s_waitcnt lgkmcnt(5)
  v_mfma_f32_16x16x32_bf16 v[104:107], a[240:243], v[52:55], v[104:107]
  s_cmp_eq_u32 s23, 0
  ds_read_b128 v[44:47], v13 offset:0
  v_mfma_f32_16x16x32_bf16 v[108:111], a[244:247], v[52:55], v[108:111]
  v_mfma_f32_16x16x32_bf16 v[120:123], a[248:251], v[52:55], v[120:123]
  v_mfma_f32_16x16x32_bf16 v[124:127], a[252:255], v[52:55], v[124:127]
  s_cbranch_scc1 G_done1_52
  s_branch G_top_50
G_done0_51:
  s_nop 7
  s_nop 3
  v_cvt_pk_bf16_f32 v128, v64, v65
  v_cvt_pk_bf16_f32 v129, v66, v67
  v_cvt_pk_bf16_f32 v130, v68, v69
  v_cvt_pk_bf16_f32 v131, v70, v71
  buffer_store_dwordx4 v[128:131], v7, s[4:7], s21 offen offset:0 sc1
  v_cvt_pk_bf16_f32 v132, v72, v73
  v_cvt_pk_bf16_f32 v133, v74, v75
  v_cvt_pk_bf16_f32 v134, v76, v77
  v_cvt_pk_bf16_f32 v135, v78, v79
  buffer_store_dwordx4 v[132:135], v7, s[4:7], s21 offen offset:256 sc1
  v_cvt_pk_bf16_f32 v136, v80, v81
  v_cvt_pk_bf16_f32 v137, v82, v83
  v_cvt_pk_bf16_f32 v138, v84, v85
  v_cvt_pk_bf16_f32 v139, v86, v87
  buffer_store_dwordx4 v[136:139], v7, s[4:7], s21 offen offset:2048 sc1
  v_cvt_pk_bf16_f32 v140, v88, v89
  v_cvt_pk_bf16_f32 v141, v90, v91
  v_cvt_pk_bf16_f32 v142, v92, v93
  v_cvt_pk_bf16_f32 v143, v94, v95
  buffer_store_dwordx4 v[140:143], v7, s[4:7], s21 offen offset:2304 sc1
  s_branch G_fin_53
G_done1_52:
  s_nop 7
  s_nop 3
  v_cvt_pk_bf16_f32 v128, v96, v97
  v_cvt_pk_bf16_f32 v129, v98, v99
  v_cvt_pk_bf16_f32 v130, v100, v101
  v_cvt_pk_bf16_f32 v131, v102, v103
  buffer_store_dwordx4 v[128:131], v7, s[4:7], s21 offen offset:0 sc1
  v_cvt_pk_bf16_f32 v132, v104, v105
  v_cvt_pk_bf16_f32 v133, v106, v107
  v_cvt_pk_bf16_f32 v134, v108, v109
  v_cvt_pk_bf16_f32 v135, v110, v111
  buffer_store_dwordx4 v[132:135], v7, s[4:7], s21 offen offset:256 sc1
  v_cvt_pk_bf16_f32 v136, v112, v113
  v_cvt_pk_bf16_f32 v137, v114, v115
  v_cvt_pk_bf16_f32 v138, v116, v117
  v_cvt_pk_bf16_f32 v139, v118, v119
  buffer_store_dwordx4 v[136:139], v7, s[4:7], s21 offen offset:2048 sc1
  v_cvt_pk_bf16_f32 v140, v120, v121
  v_cvt_pk_bf16_f32 v141, v122, v123
  v_cvt_pk_bf16_f32 v142, v124, v125
  v_cvt_pk_bf16_f32 v143, v126, v127
  buffer_store_dwordx4 v[140:143], v7, s[4:7], s21 offen offset:2304 sc1
G_fin_53:
  s_waitcnt vmcnt(0) lgkmcnt(0)
  s_barrier
  s_waitcnt vmcnt(0)
  s_barrier
  s_mov_b32 s30, 768
  v_mov_b32 v144, s30
  v_min_u32 v145, 1, v0
  v_lshlrev_b32 v145, 30, v145
  buffer_store_dword v144, v145, s[4:7], s31 offen sc1
  s_mul_i32 s50, s64, 6
  s_add_u32 s50, s50, s65
  s_mul_i32 s76, s50, 21846
  s_lshr_b32 s76, s76, 16
  s_mul_i32 s77, s76, 3
  s_add_u32 s51, s50, 64
  s_cmp_eq_u32 s77, s50
  s_cselect_b32 s50, s76, s51
M_fin:
  s_lshr_b32 s48, s50, 2
  s_and_b32 s49, s50, 3
  s_load_dwordx2 s[8:9], s[0:1], 0
  s_load_dwordx2 s[12:13], s[0:1], 104
  s_load_dwordx2 s[32:33], s[0:1], 112
  v_and_b32 v4, 31, v1
  v_lshrrev_b32 v5, 5, v1
  v_lshlrev_b32 v5, 4, v5
  v_lshl_add_u32 v6, v4, 10, v5
  s_lshl_b32 s26, s16, 8
  s_lshl_b32 s27, s48, 15
  s_add_u32 s27, s27, s26
  s_waitcnt lgkmcnt(0)
  s_and_b32 s9, s9, 0xffff
  s_mov_b32 s10, 2097152
  s_mov_b32 s11, 0x20000
  s_and_b32 s13, s13, 0xffff
  s_mov_b32 s14, 1024
  s_mov_b32 s15, 0x20000
  s_and_b32 s33, s33, 0xffff
  s_mov_b32 s34, 2097152
  s_mov_b32 s35, 0x20000
  buffer_load_dwordx4 v[16:19], v6, s[8:11], s27 offen offset:0
  buffer_load_dwordx4 v[48:51], v5, s[12:15], s26 offen offset:0
  buffer_load_dwordx4 v[20:23], v6, s[8:11], s27 offen offset:32
  buffer_load_dwordx4 v[52:55], v5, s[12:15], s26 offen offset:32
  buffer_load_dwordx4 v[24:27], v6, s[8:11], s27 offen offset:64
  buffer_load_dwordx4 v[56:59], v5, s[12:15], s26 offen offset:64
  buffer_load_dwordx4 v[28:31], v6, s[8:11], s27 offen offset:96
  buffer_load_dwordx4 v[60:63], v5, s[12:15], s26 offen offset:96
  buffer_load_dwordx4 v[32:35], v6, s[8:11], s27 offen offset:128
  buffer_load_dwordx4 v[64:67], v5, s[12:15], s26 offen offset:128
  buffer_load_dwordx4 v[36:39], v6, s[8:11], s27 offen offset:160
  buffer_load_dwordx4 v[68:71], v5, s[12:15], s26 offen offset:160
  buffer_load_dwordx4 v[40:43], v6, s[8:11], s27 offen offset:192
  buffer_load_dwordx4 v[72:75], v5, s[12:15], s26 offen offset:192
  buffer_load_dwordx4 v[44:47], v6, s[8:11], s27 offen offset:224
  buffer_load_dwordx4 v[76:79], v5, s[12:15], s26 offen offset:224
  s_lshl_b32 s28, s48, 2
  s_add_u32 s28, s28, s49
  s_lshl_b32 s28, s28, 2
  s_add_u32 s28, s28, s16
  s_lshl_b32 s28, s28, 11
  s_waitcnt vmcnt(14)
  v_mfma_f32_32x32x16_bf16 v[80:95], v[48:51], v[16:19], 0
  s_waitcnt vmcnt(12)
  v_mfma_f32_32x32x16_bf16 v[80:95], v[52:55], v[20:23], v[80:95]
  s_waitcnt vmcnt(10)
  v_mfma_f32_32x32x16_bf16 v[80:95], v[56:59], v[24:27], v[80:95]
  s_waitcnt vmcnt(8)
  v_mfma_f32_32x32x16_bf16 v[80:95], v[60:63], v[28:31], v[80:95]
  s_waitcnt vmcnt(6)
  v_mfma_f32_32x32x16_bf16 v[80:95], v[64:67], v[32:35], v[80:95]
  s_waitcnt vmcnt(4)
  v_mfma_f32_32x32x16_bf16 v[80:95], v[68:71], v[36:39], v[80:95]
  s_waitcnt vmcnt(2)
  v_mfma_f32_32x32x16_bf16 v[80:95], v[72:75], v[40:43], v[80:95]
  s_waitcnt vmcnt(0)
  v_mfma_f32_32x32x16_bf16 v[80:95], v[76:79], v[44:47], v[80:95]
  s_mul_i32 s76, s48, 43
  s_lshr_b32 s76, s76, 9
  s_mul_i32 s76, s76, 12
  s_sub_u32 s76, s48, s76
  s_cmp_ge_u32 s76, 6
  s_addc_u32 s76, s76, 0
  s_and_b32 s77, s49, 2
  s_mul_i32 s77, s77, 7
  s_add_u32 s76, s76, s77
  v_mov_b32 v193, 0x300
  s_lshl_b32 s76, s76, 7
  s_add_u32 s76, s76, 148897792
  v_and_b32 v192, 7, v1
  v_mul_u32_u24 v192, 3584, v192
  v_add_u32 v192, s76, v192
  s_mov_b32 s71, 0
  s_branch M_vg_55
M_vw_54:
  s_sleep 2
  s_add_u32 s71, s71, 1
  s_cmp_gt_u32 s71, 262144
  s_cbranch_scc1 M_exit
M_vg_55:
  buffer_load_dword v194, v192, s[4:7], 0 offen sc1
  s_waitcnt vmcnt(0)
  v_cmp_lt_u32 vcc, v194, v193
  s_cbranch_vccnz M_vw_54
  s_add_u32 s29, s28, 150994944
  buffer_load_dwordx4 v[96:99], v2, s[4:7], s29 offen offset:0 sc1
  buffer_load_dwordx4 v[100:103], v2, s[4:7], s29 offen offset:1024 sc1
  s_add_u32 s29, s28, 153092096
  buffer_load_dwordx4 v[104:107], v2, s[4:7], s29 offen offset:0 sc1
  buffer_load_dwordx4 v[108:111], v2, s[4:7], s29 offen offset:1024 sc1
  s_add_u32 s29, s28, 155189248
  buffer_load_dwordx4 v[112:115], v2, s[4:7], s29 offen offset:0 sc1
  buffer_load_dwordx4 v[116:119], v2, s[4:7], s29 offen offset:1024 sc1
  s_add_u32 s29, s28, 157286400
  buffer_load_dwordx4 v[120:123], v2, s[4:7], s29 offen offset:0 sc1
  buffer_load_dwordx4 v[124:127], v2, s[4:7], s29 offen offset:1024 sc1
  s_add_u32 s29, s28, 159383552
  buffer_load_dwordx4 v[128:131], v2, s[4:7], s29 offen offset:0 sc1
  buffer_load_dwordx4 v[132:135], v2, s[4:7], s29 offen offset:1024 sc1
  s_add_u32 s29, s28, 161480704
  buffer_load_dwordx4 v[136:139], v2, s[4:7], s29 offen offset:0 sc1
  buffer_load_dwordx4 v[140:143], v2, s[4:7], s29 offen offset:1024 sc1
  s_add_u32 s29, s28, 163577856
  buffer_load_dwordx4 v[144:147], v2, s[4:7], s29 offen offset:0 sc1
  buffer_load_dwordx4 v[148:151], v2, s[4:7], s29 offen offset:1024 sc1
  s_add_u32 s29, s28, 165675008
  buffer_load_dwordx4 v[152:155], v2, s[4:7], s29 offen offset:0 sc1
  buffer_load_dwordx4 v[156:159], v2, s[4:7], s29 offen offset:1024 sc1
  v_lshlrev_b32 v7, 4, v4
  s_lshl_b32 s26, s16, 2
  v_add_u32 v4, s26, v7
  s_barrier
  ds_write_b32 v4, v80
  s_waitcnt lgkmcnt(0)
  s_barrier
  ds_read_b128 v[84:87], v7
  s_waitcnt lgkmcnt(0)
  v_add_f32 v80, v84, v85
  v_add_f32 v81, v86, v87
  v_add_f32 v80, v80, v81
  v_mul_f32 v80, 0xbfb8aa3b, v80
  v_exp_f32 v80, v80
  s_nop 0
  v_add_f32 v80, 1.0, v80
  v_rcp_f32 v80, v80
  s_nop 0
  v_sub_f32 v82, 1.0, v80
  s_waitcnt vmcnt(14)
  v_lshlrev_b32 v160, 16, v96
  v_and_b32 v161, 0xffff0000, v96
  v_lshlrev_b32 v162, 16, v97
  v_and_b32 v163, 0xffff0000, v97
  v_lshlrev_b32 v164, 16, v98
  v_and_b32 v165, 0xffff0000, v98
  v_lshlrev_b32 v166, 16, v99
  v_and_b32 v167, 0xffff0000, v99
  v_lshlrev_b32 v168, 16, v100
  v_and_b32 v169, 0xffff0000, v100
  v_lshlrev_b32 v170, 16, v101
  v_and_b32 v171, 0xffff0000, v101
  v_lshlrev_b32 v172, 16, v102
  v_and_b32 v173, 0xffff0000, v102
  v_lshlrev_b32 v174, 16, v103
  v_and_b32 v175, 0xffff0000, v103
  s_waitcnt vmcnt(12)
  v_lshlrev_b32 v8, 16, v104
  v_and_b32 v9, 0xffff0000, v104
  v_pk_add_f32 v[160:161], v[160:161], v[8:9]
  v_lshlrev_b32 v10, 16, v105
  v_and_b32 v11, 0xffff0000, v105
  v_pk_add_f32 v[162:163], v[162:163], v[10:11]
  v_lshlrev_b32 v12, 16, v106
  v_and_b32 v13, 0xffff0000, v106
  v_pk_add_f32 v[164:165], v[164:165], v[12:13]
  v_lshlrev_b32 v14, 16, v107
  v_and_b32 v15, 0xffff0000, v107
  v_pk_add_f32 v[166:167], v[166:167], v[14:15]
  v_lshlrev_b32 v8, 16, v108
  v_and_b32 v9, 0xffff0000, v108
  v_pk_add_f32 v[168:169], v[168:169], v[8:9]
  v_lshlrev_b32 v10, 16, v109
  v_and_b32 v11, 0xffff0000, v109
  v_pk_add_f32 v[170:171], v[170:171], v[10:11]
  v_lshlrev_b32 v12, 16, v110
  v_and_b32 v13, 0xffff0000, v110
  v_pk_add_f32 v[172:173], v[172:173], v[12:13]
  v_lshlrev_b32 v14, 16, v111
  v_and_b32 v15, 0xffff0000, v111
  v_pk_add_f32 v[174:175], v[174:175], v[14:15]
  s_waitcnt vmcnt(10)
  v_lshlrev_b32 v8, 16, v112
  v_and_b32 v9, 0xffff0000, v112
  v_pk_add_f32 v[160:161], v[160:161], v[8:9]
  v_lshlrev_b32 v10, 16, v113
  v_and_b32 v11, 0xffff0000, v113
  v_pk_add_f32 v[162:163], v[162:163], v[10:11]
  v_lshlrev_b32 v12, 16, v114
  v_and_b32 v13, 0xffff0000, v114
  v_pk_add_f32 v[164:165], v[164:165], v[12:13]
  v_lshlrev_b32 v14, 16, v115
  v_and_b32 v15, 0xffff0000, v115
  v_pk_add_f32 v[166:167], v[166:167], v[14:15]
  v_lshlrev_b32 v8, 16, v116
  v_and_b32 v9, 0xffff0000, v116
  v_pk_add_f32 v[168:169], v[168:169], v[8:9]
  v_lshlrev_b32 v10, 16, v117
  v_and_b32 v11, 0xffff0000, v117
  v_pk_add_f32 v[170:171], v[170:171], v[10:11]
  v_lshlrev_b32 v12, 16, v118
  v_and_b32 v13, 0xffff0000, v118
  v_pk_add_f32 v[172:173], v[172:173], v[12:13]
  v_lshlrev_b32 v14, 16, v119
  v_and_b32 v15, 0xffff0000, v119
  v_pk_add_f32 v[174:175], v[174:175], v[14:15]
  s_waitcnt vmcnt(8)
  v_lshlrev_b32 v8, 16, v120
  v_and_b32 v9, 0xffff0000, v120
  v_pk_add_f32 v[160:161], v[160:161], v[8:9]
  v_lshlrev_b32 v10, 16, v121
  v_and_b32 v11, 0xffff0000, v121
  v_pk_add_f32 v[162:163], v[162:163], v[10:11]
  v_lshlrev_b32 v12, 16, v122
  v_and_b32 v13, 0xffff0000, v122
  v_pk_add_f32 v[164:165], v[164:165], v[12:13]
  v_lshlrev_b32 v14, 16, v123
  v_and_b32 v15, 0xffff0000, v123
  v_pk_add_f32 v[166:167], v[166:167], v[14:15]
  v_lshlrev_b32 v8, 16, v124
  v_and_b32 v9, 0xffff0000, v124
  v_pk_add_f32 v[168:169], v[168:169], v[8:9]
  v_lshlrev_b32 v10, 16, v125
  v_and_b32 v11, 0xffff0000, v125
  v_pk_add_f32 v[170:171], v[170:171], v[10:11]
  v_lshlrev_b32 v12, 16, v126
  v_and_b32 v13, 0xffff0000, v126
  v_pk_add_f32 v[172:173], v[172:173], v[12:13]
  v_lshlrev_b32 v14, 16, v127
  v_and_b32 v15, 0xffff0000, v127
  v_pk_add_f32 v[174:175], v[174:175], v[14:15]
  s_waitcnt vmcnt(6)
  v_lshlrev_b32 v8, 16, v128
  v_and_b32 v9, 0xffff0000, v128
  v_pk_add_f32 v[160:161], v[160:161], v[8:9]
  v_lshlrev_b32 v10, 16, v129
  v_and_b32 v11, 0xffff0000, v129
  v_pk_add_f32 v[162:163], v[162:163], v[10:11]
  v_lshlrev_b32 v12, 16, v130
  v_and_b32 v13, 0xffff0000, v130
  v_pk_add_f32 v[164:165], v[164:165], v[12:13]
  v_lshlrev_b32 v14, 16, v131
  v_and_b32 v15, 0xffff0000, v131
  v_pk_add_f32 v[166:167], v[166:167], v[14:15]
  v_lshlrev_b32 v8, 16, v132
  v_and_b32 v9, 0xffff0000, v132
  v_pk_add_f32 v[168:169], v[168:169], v[8:9]
  v_lshlrev_b32 v10, 16, v133
  v_and_b32 v11, 0xffff0000, v133
  v_pk_add_f32 v[170:171], v[170:171], v[10:11]
  v_lshlrev_b32 v12, 16, v134
  v_and_b32 v13, 0xffff0000, v134
  v_pk_add_f32 v[172:173], v[172:173], v[12:13]
  v_lshlrev_b32 v14, 16, v135
  v_and_b32 v15, 0xffff0000, v135
  v_pk_add_f32 v[174:175], v[174:175], v[14:15]
  s_waitcnt vmcnt(4)
  v_lshlrev_b32 v8, 16, v136
  v_and_b32 v9, 0xffff0000, v136
  v_pk_add_f32 v[160:161], v[160:161], v[8:9]
  v_lshlrev_b32 v10, 16, v137
  v_and_b32 v11, 0xffff0000, v137
  v_pk_add_f32 v[162:163], v[162:163], v[10:11]
  v_lshlrev_b32 v12, 16, v138
  v_and_b32 v13, 0xffff0000, v138
  v_pk_add_f32 v[164:165], v[164:165], v[12:13]
  v_lshlrev_b32 v14, 16, v139
  v_and_b32 v15, 0xffff0000, v139
  v_pk_add_f32 v[166:167], v[166:167], v[14:15]
  v_lshlrev_b32 v8, 16, v140
  v_and_b32 v9, 0xffff0000, v140
  v_pk_add_f32 v[168:169], v[168:169], v[8:9]
  v_lshlrev_b32 v10, 16, v141
  v_and_b32 v11, 0xffff0000, v141
  v_pk_add_f32 v[170:171], v[170:171], v[10:11]
  v_lshlrev_b32 v12, 16, v142
  v_and_b32 v13, 0xffff0000, v142
  v_pk_add_f32 v[172:173], v[172:173], v[12:13]
  v_lshlrev_b32 v14, 16, v143
  v_and_b32 v15, 0xffff0000, v143
  v_pk_add_f32 v[174:175], v[174:175], v[14:15]
  s_waitcnt vmcnt(2)
  v_lshlrev_b32 v8, 16, v144
  v_and_b32 v9, 0xffff0000, v144
  v_pk_add_f32 v[160:161], v[160:161], v[8:9]
  v_lshlrev_b32 v10, 16, v145
  v_and_b32 v11, 0xffff0000, v145
  v_pk_add_f32 v[162:163], v[162:163], v[10:11]
  v_lshlrev_b32 v12, 16, v146
  v_and_b32 v13, 0xffff0000, v146
  v_pk_add_f32 v[164:165], v[164:165], v[12:13]
  v_lshlrev_b32 v14, 16, v147
  v_and_b32 v15, 0xffff0000, v147
  v_pk_add_f32 v[166:167], v[166:167], v[14:15]
  v_lshlrev_b32 v8, 16, v148
  v_and_b32 v9, 0xffff0000, v148
  v_pk_add_f32 v[168:169], v[168:169], v[8:9]
  v_lshlrev_b32 v10, 16, v149
  v_and_b32 v11, 0xffff0000, v149
  v_pk_add_f32 v[170:171], v[170:171], v[10:11]
  v_lshlrev_b32 v12, 16, v150
  v_and_b32 v13, 0xffff0000, v150
  v_pk_add_f32 v[172:173], v[172:173], v[12:13]
  v_lshlrev_b32 v14, 16, v151
  v_and_b32 v15, 0xffff0000, v151
  v_pk_add_f32 v[174:175], v[174:175], v[14:15]
  s_waitcnt vmcnt(0)
  v_lshlrev_b32 v8, 16, v152
  v_and_b32 v9, 0xffff0000, v152
  v_pk_add_f32 v[160:161], v[160:161], v[8:9]
  v_lshlrev_b32 v10, 16, v153
  v_and_b32 v11, 0xffff0000, v153
  v_pk_add_f32 v[162:163], v[162:163], v[10:11]
  v_lshlrev_b32 v12, 16, v154
  v_and_b32 v13, 0xffff0000, v154
  v_pk_add_f32 v[164:165], v[164:165], v[12:13]
  v_lshlrev_b32 v14, 16, v155
  v_and_b32 v15, 0xffff0000, v155
  v_pk_add_f32 v[166:167], v[166:167], v[14:15]
  v_lshlrev_b32 v8, 16, v156
  v_and_b32 v9, 0xffff0000, v156
  v_pk_add_f32 v[168:169], v[168:169], v[8:9]
  v_lshlrev_b32 v10, 16, v157
  v_and_b32 v11, 0xffff0000, v157
  v_pk_add_f32 v[170:171], v[170:171], v[10:11]
  v_lshlrev_b32 v12, 16, v158
  v_and_b32 v13, 0xffff0000, v158
  v_pk_add_f32 v[172:173], v[172:173], v[12:13]
  v_lshlrev_b32 v14, 16, v159
  v_and_b32 v15, 0xffff0000, v159
  v_pk_add_f32 v[174:175], v[174:175], v[14:15]
  s_and_b32 s76, s48, 1
  s_lshl_b32 s76, s76, 1
  s_lshr_b32 s77, s49, 1
  s_add_u32 s76, s76, s77
  s_mul_i32 s76, s76, 7
  s_add_u32 s76, s76, 6
  s_lshr_b32 s77, s48, 1
  s_add_u32 s77, s77, 0x201
  v_mov_b32 v193, s77
  s_lshl_b32 s76, s76, 7
  s_add_u32 s76, s76, 148897792
  v_and_b32 v192, 7, v1
  v_mul_u32_u24 v192, 3584, v192
  v_add_u32 v192, s76, v192
  s_mov_b32 s71, 0
  s_branch M_vg_57
M_vw_56:
  s_sleep 2
  s_add_u32 s71, s71, 1
  s_cmp_gt_u32 s71, 262144
  s_cbranch_scc1 M_exit
M_vg_57:
  buffer_load_dword v194, v192, s[4:7], 0 offen sc1
  s_waitcnt vmcnt(0)
  v_cmp_lt_u32 vcc, v194, v193
  s_cbranch_vccnz M_vw_56
  s_add_u32 s29, s28, 167772160
  buffer_load_dwordx4 v[96:99], v2, s[4:7], s29 offen offset:0 sc1
  buffer_load_dwordx4 v[100:103], v2, s[4:7], s29 offen offset:1024 sc1
  s_add_u32 s29, s28, 169869312
  buffer_load_dwordx4 v[104:107], v2, s[4:7], s29 offen offset:0 sc1
  buffer_load_dwordx4 v[108:111], v2, s[4:7], s29 offen offset:1024 sc1
  s_add_u32 s29, s28, 171966464
  buffer_load_dwordx4 v[112:115], v2, s[4:7], s29 offen offset:0 sc1
  buffer_load_dwordx4 v[116:119], v2, s[4:7], s29 offen offset:1024 sc1
  s_add_u32 s29, s28, 174063616
  buffer_load_dwordx4 v[120:123], v2, s[4:7], s29 offen offset:0 sc1
  buffer_load_dwordx4 v[124:127], v2, s[4:7], s29 offen offset:1024 sc1
  s_add_u32 s29, s28, 176160768
  buffer_load_dwordx4 v[128:131], v2, s[4:7], s29 offen offset:0 sc1
  buffer_load_dwordx4 v[132:135], v2, s[4:7], s29 offen offset:1024 sc1
  s_add_u32 s29, s28, 178257920
  buffer_load_dwordx4 v[136:139], v2, s[4:7], s29 offen offset:0 sc1
  buffer_load_dwordx4 v[140:143], v2, s[4:7], s29 offen offset:1024 sc1
  s_add_u32 s29, s28, 180355072
  buffer_load_dwordx4 v[144:147], v2, s[4:7], s29 offen offset:0 sc1
  buffer_load_dwordx4 v[148:151], v2, s[4:7], s29 offen offset:1024 sc1
  s_add_u32 s29, s28, 182452224
  buffer_load_dwordx4 v[152:155], v2, s[4:7], s29 offen offset:0 sc1
  buffer_load_dwordx4 v[156:159], v2, s[4:7], s29 offen offset:1024 sc1
  v_pk_mul_f32 v[160:161], v[160:161], v[80:81] op_sel_hi:[1,0]
  v_pk_mul_f32 v[162:163], v[162:163], v[80:81] op_sel_hi:[1,0]
  v_pk_mul_f32 v[164:165], v[164:165], v[80:81] op_sel_hi:[1,0]
  v_pk_mul_f32 v[166:167], v[166:167], v[80:81] op_sel_hi:[1,0]
  v_pk_mul_f32 v[168:169], v[168:169], v[80:81] op_sel_hi:[1,0]
  v_pk_mul_f32 v[170:171], v[170:171], v[80:81] op_sel_hi:[1,0]
  v_pk_mul_f32 v[172:173], v[172:173], v[80:81] op_sel_hi:[1,0]
  v_pk_mul_f32 v[174:175], v[174:175], v[80:81] op_sel_hi:[1,0]
  s_waitcnt vmcnt(14)
  v_lshlrev_b32 v176, 16, v96
  v_and_b32 v177, 0xffff0000, v96
  v_lshlrev_b32 v178, 16, v97
  v_and_b32 v179, 0xffff0000, v97
  v_lshlrev_b32 v180, 16, v98
  v_and_b32 v181, 0xffff0000, v98
  v_lshlrev_b32 v182, 16, v99
  v_and_b32 v183, 0xffff0000, v99
  v_lshlrev_b32 v184, 16, v100
  v_and_b32 v185, 0xffff0000, v100
  v_lshlrev_b32 v186, 16, v101
  v_and_b32 v187, 0xffff0000, v101
  v_lshlrev_b32 v188, 16, v102
  v_and_b32 v189, 0xffff0000, v102
  v_lshlrev_b32 v190, 16, v103
  v_and_b32 v191, 0xffff0000, v103
  s_waitcnt vmcnt(12)
  v_lshlrev_b32 v8, 16, v104
  v_and_b32 v9, 0xffff0000, v104
  v_pk_add_f32 v[176:177], v[176:177], v[8:9]
  v_lshlrev_b32 v10, 16, v105
  v_and_b32 v11, 0xffff0000, v105
  v_pk_add_f32 v[178:179], v[178:179], v[10:11]
  v_lshlrev_b32 v12, 16, v106
  v_and_b32 v13, 0xffff0000, v106
  v_pk_add_f32 v[180:181], v[180:181], v[12:13]
  v_lshlrev_b32 v14, 16, v107
  v_and_b32 v15, 0xffff0000, v107
  v_pk_add_f32 v[182:183], v[182:183], v[14:15]
  v_lshlrev_b32 v8, 16, v108
  v_and_b32 v9, 0xffff0000, v108
  v_pk_add_f32 v[184:185], v[184:185], v[8:9]
  v_lshlrev_b32 v10, 16, v109
  v_and_b32 v11, 0xffff0000, v109
  v_pk_add_f32 v[186:187], v[186:187], v[10:11]
  v_lshlrev_b32 v12, 16, v110
  v_and_b32 v13, 0xffff0000, v110
  v_pk_add_f32 v[188:189], v[188:189], v[12:13]
  v_lshlrev_b32 v14, 16, v111
  v_and_b32 v15, 0xffff0000, v111
  v_pk_add_f32 v[190:191], v[190:191], v[14:15]
  s_waitcnt vmcnt(10)
  v_lshlrev_b32 v8, 16, v112
  v_and_b32 v9, 0xffff0000, v112
  v_pk_add_f32 v[176:177], v[176:177], v[8:9]
  v_lshlrev_b32 v10, 16, v113
  v_and_b32 v11, 0xffff0000, v113
  v_pk_add_f32 v[178:179], v[178:179], v[10:11]
  v_lshlrev_b32 v12, 16, v114
  v_and_b32 v13, 0xffff0000, v114
  v_pk_add_f32 v[180:181], v[180:181], v[12:13]
  v_lshlrev_b32 v14, 16, v115
  v_and_b32 v15, 0xffff0000, v115
  v_pk_add_f32 v[182:183], v[182:183], v[14:15]
  v_lshlrev_b32 v8, 16, v116
  v_and_b32 v9, 0xffff0000, v116
  v_pk_add_f32 v[184:185], v[184:185], v[8:9]
  v_lshlrev_b32 v10, 16, v117
  v_and_b32 v11, 0xffff0000, v117
  v_pk_add_f32 v[186:187], v[186:187], v[10:11]
  v_lshlrev_b32 v12, 16, v118
  v_and_b32 v13, 0xffff0000, v118
  v_pk_add_f32 v[188:189], v[188:189], v[12:13]
  v_lshlrev_b32 v14, 16, v119
  v_and_b32 v15, 0xffff0000, v119
  v_pk_add_f32 v[190:191], v[190:191], v[14:15]
  s_waitcnt vmcnt(8)
  v_lshlrev_b32 v8, 16, v120
  v_and_b32 v9, 0xffff0000, v120
  v_pk_add_f32 v[176:177], v[176:177], v[8:9]
  v_lshlrev_b32 v10, 16, v121
  v_and_b32 v11, 0xffff0000, v121
  v_pk_add_f32 v[178:179], v[178:179], v[10:11]
  v_lshlrev_b32 v12, 16, v122
  v_and_b32 v13, 0xffff0000, v122
  v_pk_add_f32 v[180:181], v[180:181], v[12:13]
  v_lshlrev_b32 v14, 16, v123
  v_and_b32 v15, 0xffff0000, v123
  v_pk_add_f32 v[182:183], v[182:183], v[14:15]
  v_lshlrev_b32 v8, 16, v124
  v_and_b32 v9, 0xffff0000, v124
  v_pk_add_f32 v[184:185], v[184:185], v[8:9]
  v_lshlrev_b32 v10, 16, v125
  v_and_b32 v11, 0xffff0000, v125
  v_pk_add_f32 v[186:187], v[186:187], v[10:11]
  v_lshlrev_b32 v12, 16, v126
  v_and_b32 v13, 0xffff0000, v126
  v_pk_add_f32 v[188:189], v[188:189], v[12:13]
  v_lshlrev_b32 v14, 16, v127
  v_and_b32 v15, 0xffff0000, v127
  v_pk_add_f32 v[190:191], v[190:191], v[14:15]
  s_waitcnt vmcnt(6)
  v_lshlrev_b32 v8, 16, v128
  v_and_b32 v9, 0xffff0000, v128
  v_pk_add_f32 v[176:177], v[176:177], v[8:9]
  v_lshlrev_b32 v10, 16, v129
  v_and_b32 v11, 0xffff0000, v129
  v_pk_add_f32 v[178:179], v[178:179], v[10:11]
  v_lshlrev_b32 v12, 16, v130
  v_and_b32 v13, 0xffff0000, v130
  v_pk_add_f32 v[180:181], v[180:181], v[12:13]
  v_lshlrev_b32 v14, 16, v131
  v_and_b32 v15, 0xffff0000, v131
  v_pk_add_f32 v[182:183], v[182:183], v[14:15]
  v_lshlrev_b32 v8, 16, v132
  v_and_b32 v9, 0xffff0000, v132
  v_pk_add_f32 v[184:185], v[184:185], v[8:9]
  v_lshlrev_b32 v10, 16, v133
  v_and_b32 v11, 0xffff0000, v133
  v_pk_add_f32 v[186:187], v[186:187], v[10:11]
  v_lshlrev_b32 v12, 16, v134
  v_and_b32 v13, 0xffff0000, v134
  v_pk_add_f32 v[188:189], v[188:189], v[12:13]
  v_lshlrev_b32 v14, 16, v135
  v_and_b32 v15, 0xffff0000, v135
  v_pk_add_f32 v[190:191], v[190:191], v[14:15]
  s_waitcnt vmcnt(4)
  v_lshlrev_b32 v8, 16, v136
  v_and_b32 v9, 0xffff0000, v136
  v_pk_add_f32 v[176:177], v[176:177], v[8:9]
  v_lshlrev_b32 v10, 16, v137
  v_and_b32 v11, 0xffff0000, v137
  v_pk_add_f32 v[178:179], v[178:179], v[10:11]
  v_lshlrev_b32 v12, 16, v138
  v_and_b32 v13, 0xffff0000, v138
  v_pk_add_f32 v[180:181], v[180:181], v[12:13]
  v_lshlrev_b32 v14, 16, v139
  v_and_b32 v15, 0xffff0000, v139
  v_pk_add_f32 v[182:183], v[182:183], v[14:15]
  v_lshlrev_b32 v8, 16, v140
  v_and_b32 v9, 0xffff0000, v140
  v_pk_add_f32 v[184:185], v[184:185], v[8:9]
  v_lshlrev_b32 v10, 16, v141
  v_and_b32 v11, 0xffff0000, v141
  v_pk_add_f32 v[186:187], v[186:187], v[10:11]
  v_lshlrev_b32 v12, 16, v142
  v_and_b32 v13, 0xffff0000, v142
  v_pk_add_f32 v[188:189], v[188:189], v[12:13]
  v_lshlrev_b32 v14, 16, v143
  v_and_b32 v15, 0xffff0000, v143
  v_pk_add_f32 v[190:191], v[190:191], v[14:15]
  s_waitcnt vmcnt(2)
  v_lshlrev_b32 v8, 16, v144
  v_and_b32 v9, 0xffff0000, v144
  v_pk_add_f32 v[176:177], v[176:177], v[8:9]
  v_lshlrev_b32 v10, 16, v145
  v_and_b32 v11, 0xffff0000, v145
  v_pk_add_f32 v[178:179], v[178:179], v[10:11]
  v_lshlrev_b32 v12, 16, v146
  v_and_b32 v13, 0xffff0000, v146
  v_pk_add_f32 v[180:181], v[180:181], v[12:13]
  v_lshlrev_b32 v14, 16, v147
  v_and_b32 v15, 0xffff0000, v147
  v_pk_add_f32 v[182:183], v[182:183], v[14:15]
  v_lshlrev_b32 v8, 16, v148
  v_and_b32 v9, 0xffff0000, v148
  v_pk_add_f32 v[184:185], v[184:185], v[8:9]
  v_lshlrev_b32 v10, 16, v149
  v_and_b32 v11, 0xffff0000, v149
  v_pk_add_f32 v[186:187], v[186:187], v[10:11]
  v_lshlrev_b32 v12, 16, v150
  v_and_b32 v13, 0xffff0000, v150
  v_pk_add_f32 v[188:189], v[188:189], v[12:13]
  v_lshlrev_b32 v14, 16, v151
  v_and_b32 v15, 0xffff0000, v151
  v_pk_add_f32 v[190:191], v[190:191], v[14:15]
  s_waitcnt vmcnt(0)
  v_lshlrev_b32 v8, 16, v152
  v_and_b32 v9, 0xffff0000, v152
  v_pk_add_f32 v[176:177], v[176:177], v[8:9]
  v_lshlrev_b32 v10, 16, v153
  v_and_b32 v11, 0xffff0000, v153
  v_pk_add_f32 v[178:179], v[178:179], v[10:11]
  v_lshlrev_b32 v12, 16, v154
  v_and_b32 v13, 0xffff0000, v154
  v_pk_add_f32 v[180:181], v[180:181], v[12:13]
  v_lshlrev_b32 v14, 16, v155
  v_and_b32 v15, 0xffff0000, v155
  v_pk_add_f32 v[182:183], v[182:183], v[14:15]
  v_lshlrev_b32 v8, 16, v156
  v_and_b32 v9, 0xffff0000, v156
  v_pk_add_f32 v[184:185], v[184:185], v[8:9]
  v_lshlrev_b32 v10, 16, v157
  v_and_b32 v11, 0xffff0000, v157
  v_pk_add_f32 v[186:187], v[186:187], v[10:11]
  v_lshlrev_b32 v12, 16, v158
  v_and_b32 v13, 0xffff0000, v158
  v_pk_add_f32 v[188:189], v[188:189], v[12:13]
  v_lshlrev_b32 v14, 16, v159
  v_and_b32 v15, 0xffff0000, v159
  v_pk_add_f32 v[190:191], v[190:191], v[14:15]
  v_pk_fma_f32 v[160:161], v[176:177], v[82:83], v[160:161] op_sel_hi:[1,0,1]
  v_cvt_pk_bf16_f32 v16, v160, v161
  v_pk_fma_f32 v[162:163], v[178:179], v[82:83], v[162:163] op_sel_hi:[1,0,1]
  v_cvt_pk_bf16_f32 v17, v162, v163
  v_pk_fma_f32 v[164:165], v[180:181], v[82:83], v[164:165] op_sel_hi:[1,0,1]
  v_cvt_pk_bf16_f32 v18, v164, v165
  v_pk_fma_f32 v[166:167], v[182:183], v[82:83], v[166:167] op_sel_hi:[1,0,1]
  v_cvt_pk_bf16_f32 v19, v166, v167
  v_pk_fma_f32 v[168:169], v[184:185], v[82:83], v[168:169] op_sel_hi:[1,0,1]
  v_cvt_pk_bf16_f32 v20, v168, v169
  v_pk_fma_f32 v[170:171], v[186:187], v[82:83], v[170:171] op_sel_hi:[1,0,1]
  v_cvt_pk_bf16_f32 v21, v170, v171
  v_pk_fma_f32 v[172:173], v[188:189], v[82:83], v[172:173] op_sel_hi:[1,0,1]
  v_cvt_pk_bf16_f32 v22, v172, v173
  v_pk_fma_f32 v[174:175], v[190:191], v[82:83], v[174:175] op_sel_hi:[1,0,1]
  v_cvt_pk_bf16_f32 v23, v174, v175
  s_lshl_b32 s26, s49, 2
  s_add_u32 s26, s26, s16
  s_lshl_b32 s26, s26, 6
  s_lshl_b32 s27, s48, 15
  s_add_u32 s26, s26, s27
  buffer_store_dwordx4 v[16:19], v6, s[32:35], s26 offen offset:0
  buffer_store_dwordx4 v[20:23], v6, s[32:35], s26 offen offset:32
  s_cmp_lt_u32 s50, 64
  s_mov_b32 s50, s51
  s_cbranch_scc1 M_fin
  s_branch M_done
M_follow:
  s_lshr_b32 s48, s64, 2
  s_and_b32 s49, s64, 1
  s_bfe_u32 s50, s64, 0x10001
  s_mov_b32 s51, 2
  s_mov_b32 s23, 32
  s_load_dwordx2 s[8:9], s[0:1], 88
  s_lshl_b32 s17, s48, 19
  s_lshl_b32 s26, s49, 2
  s_add_u32 s26, s26, s16
  s_lshl_b32 s27, s26, 7
  s_add_u32 s17, s17, s27
  s_mov_b32 s18, 1024
  s_lshl_b32 s21, s48, 6
  s_add_u32 s21, s21, s50
  s_lshl_b32 s21, s21, 3
  s_add_u32 s21, s21, s26
  s_lshl_b32 s21, s21, 12
  s_add_u32 s21, s21, 167772160
  s_lshl_b32 s22, s51, 15
  s_mov_b32 s24, 1.0
  s_waitcnt lgkmcnt(0)
  s_and_b32 s9, s9, 0xffff
  s_mov_b32 s10, 4194304
  s_mov_b32 s11, 0x20000
  v_lshrrev_b32 v144, 4, v1
  v_and_b32 v56, 0xff, v2
  v_lshl_add_u32 v56, v144, 9, v56
  s_mul_i32 s26, s16, 0
  v_add_u32 v8, 0, v56
  v_add_u32 v16, 0, v2
  v_add_u32 v16, s26, v16
  v_add_u32 v9, 256, v56
  v_add_u32 v17, 1024, v2
  v_add_u32 v17, s26, v17
  v_add_u32 v10, 2048, v56
  v_add_u32 v18, 2048, v2
  v_add_u32 v18, s26, v18
  v_add_u32 v11, 2304, v56
  v_add_u32 v19, 3072, v2
  v_add_u32 v19, s26, v19
  v_add_u32 v12, 4096, v56
  v_add_u32 v20, 4096, v2
  v_add_u32 v20, s26, v20
  v_add_u32 v13, 4352, v56
  v_add_u32 v21, 5120, v2
  v_add_u32 v21, s26, v21
  v_add_u32 v14, 6144, v56
  v_add_u32 v22, 6144, v2
  v_add_u32 v22, s26, v22
  v_add_u32 v15, 6400, v56
  v_add_u32 v23, 7168, v2
  v_add_u32 v23, s26, v23
  v_mov_b32 v20, v56
  v_lshrrev_b32 v144, 3, v1
  v_mul_lo_u32 v144, v144, s18
  v_and_b32 v145, 7, v1
  v_lshl_add_u32 v144, v145, 4, v144
  s_lshl_b32 s28, s16, 15
  s_add_u32 s28, s28, 32768
  s_lshl_b32 s29, s18, 3
  s_add_u32 m0, s28, 0
  s_nop 0
  buffer_load_dwordx4 v144, s[8:11], s17 offen lds
  s_add_u32 s17, s17, s29
  s_add_u32 m0, s28, 1024
  s_nop 0
  buffer_load_dwordx4 v144, s[8:11], s17 offen lds
  s_add_u32 s17, s17, s29
  s_add_u32 m0, s28, 2048
  s_nop 0
  buffer_load_dwordx4 v144, s[8:11], s17 offen lds
  s_add_u32 s17, s17, s29
  s_add_u32 m0, s28, 3072
  s_nop 0
  buffer_load_dwordx4 v144, s[8:11], s17 offen lds
  s_add_u32 s17, s17, s29
  s_add_u32 m0, s28, 4096
  s_nop 0
  buffer_load_dwordx4 v144, s[8:11], s17 offen lds
  s_add_u32 s17, s17, s29
  s_add_u32 m0, s28, 5120
  s_nop 0
  buffer_load_dwordx4 v144, s[8:11], s17 offen lds
  s_add_u32 s17, s17, s29
  s_add_u32 m0, s28, 6144
  s_nop 0
  buffer_load_dwordx4 v144, s[8:11], s17 offen lds
  s_add_u32 s17, s17, s29
  s_add_u32 m0, s28, 7168
  s_nop 0
  buffer_load_dwordx4 v144, s[8:11], s17 offen lds
  s_add_u32 s17, s17, s29
  s_add_u32 m0, s28, 8192
  s_nop 0
  buffer_load_dwordx4 v144, s[8:11], s17 offen lds
  s_add_u32 s17, s17, s29
  s_add_u32 m0, s28, 9216
  s_nop 0
  buffer_load_dwordx4 v144, s[8:11], s17 offen lds
  s_add_u32 s17, s17, s29
  s_add_u32 m0, s28, 10240
  s_nop 0
  buffer_load_dwordx4 v144, s[8:11], s17 offen lds
  s_add_u32 s17, s17, s29
  s_add_u32 m0, s28, 11264
  s_nop 0
  buffer_load_dwordx4 v144, s[8:11], s17 offen lds
  s_add_u32 s17, s17, s29
  s_add_u32 m0, s28, 12288
  s_nop 0
  buffer_load_dwordx4 v144, s[8:11], s17 offen lds
  s_add_u32 s17, s17, s29
  s_add_u32 m0, s28, 13312
  s_nop 0
  buffer_load_dwordx4 v144, s[8:11], s17 offen lds
  s_add_u32 s17, s17, s29
  s_add_u32 m0, s28, 14336
  s_nop 0
  buffer_load_dwordx4 v144, s[8:11], s17 offen lds
  s_add_u32 s17, s17, s29
  s_add_u32 m0, s28, 15360
  s_nop 0
  buffer_load_dwordx4 v144, s[8:11], s17 offen lds
  s_add_u32 s17, s17, s29
  s_add_u32 m0, s28, 16384
  s_nop 0
  buffer_load_dwordx4 v144, s[8:11], s17 offen lds
  s_add_u32 s17, s17, s29
  s_add_u32 m0, s28, 17408
  s_nop 0
  buffer_load_dwordx4 v144, s[8:11], s17 offen lds
  s_add_u32 s17, s17, s29
  s_add_u32 m0, s28, 18432
  s_nop 0
  buffer_load_dwordx4 v144, s[8:11], s17 offen lds
  s_add_u32 s17, s17, s29
  s_add_u32 m0, s28, 19456
  s_nop 0
  buffer_load_dwordx4 v144, s[8:11], s17 offen lds
  s_add_u32 s17, s17, s29
  s_add_u32 m0, s28, 20480
  s_nop 0
  buffer_load_dwordx4 v144, s[8:11], s17 offen lds
  s_add_u32 s17, s17, s29
  s_add_u32 m0, s28, 21504
  s_nop 0
  buffer_load_dwordx4 v144, s[8:11], s17 offen lds
  s_add_u32 s17, s17, s29
  s_add_u32 m0, s28, 22528
  s_nop 0
  buffer_load_dwordx4 v144, s[8:11], s17 offen lds
  s_add_u32 s17, s17, s29
  s_add_u32 m0, s28, 23552
  s_nop 0
  buffer_load_dwordx4 v144, s[8:11], s17 offen lds
  s_add_u32 s17, s17, s29
  s_add_u32 m0, s28, 24576
  s_nop 0
  buffer_load_dwordx4 v144, s[8:11], s17 offen lds
  s_add_u32 s17, s17, s29
  s_add_u32 m0, s28, 25600
  s_nop 0
  buffer_load_dwordx4 v144, s[8:11], s17 offen lds
  s_add_u32 s17, s17, s29
  s_add_u32 m0, s28, 26624
  s_nop 0
  buffer_load_dwordx4 v144, s[8:11], s17 offen lds
  s_add_u32 s17, s17, s29
  s_add_u32 m0, s28, 27648
  s_nop 0
  buffer_load_dwordx4 v144, s[8:11], s17 offen lds
  s_add_u32 s17, s17, s29
  s_add_u32 m0, s28, 28672
  s_nop 0
  buffer_load_dwordx4 v144, s[8:11], s17 offen lds
  s_add_u32 s17, s17, s29
  s_add_u32 m0, s28, 29696
  s_nop 0
  buffer_load_dwordx4 v144, s[8:11], s17 offen lds
  s_add_u32 s17, s17, s29
  s_add_u32 m0, s28, 30720
  s_nop 0
  buffer_load_dwordx4 v144, s[8:11], s17 offen lds
  s_add_u32 s17, s17, s29
  s_add_u32 m0, s28, 31744
  s_nop 0
  buffer_load_dwordx4 v144, s[8:11], s17 offen lds
  s_add_u32 s17, s17, s29
  v_bfe_u32 v148, v1, 2, 2
  v_lshrrev_b32 v149, 5, v1
  v_lshl_add_u32 v148, v149, 4, v148
  v_bfe_u32 v149, v1, 4, 1
  v_lshl_add_u32 v148, v149, 2, v148
  v_and_b32 v149, 3, v1
  v_lshlrev_b32 v149, 4, v149
  s_mov_b32 s26, 8
  v_lshl_add_u32 v148, v148, 7, v149
  v_add_u32 v152, s28, v148
  v_add_u32 v153, 1024, v152
  v_add_u32 v154, s26, v152
  v_add_u32 v155, s26, v153
  s_waitcnt vmcnt(28)
  ds_read_b64_tr_b16 a[0:1], v152 offset:0
  ds_read_b64_tr_b16 a[2:3], v153 offset:0
  ds_read_b64_tr_b16 a[4:5], v154 offset:0
  ds_read_b64_tr_b16 a[6:7], v155 offset:0
  ds_read_b64_tr_b16 a[8:9], v152 offset:64
  ds_read_b64_tr_b16 a[10:11], v153 offset:64
  ds_read_b64_tr_b16 a[12:13], v154 offset:64
  ds_read_b64_tr_b16 a[14:15], v155 offset:64
  s_waitcnt lgkmcnt(0)
  s_add_u32 m0, s28, 0
  s_nop 0
  buffer_load_dwordx4 v144, s[8:11], s17 offen lds
  s_add_u32 s17, s17, s29
  s_add_u32 m0, s28, 1024
  s_nop 0
  buffer_load_dwordx4 v144, s[8:11], s17 offen lds
  s_add_u32 s17, s17, s29
  s_add_u32 m0, s28, 2048
  s_nop 0
  buffer_load_dwordx4 v144, s[8:11], s17 offen lds
  s_add_u32 s17, s17, s29
  s_add_u32 m0, s28, 3072
  s_nop 0
  buffer_load_dwordx4 v144, s[8:11], s17 offen lds
  s_add_u32 s17, s17, s29
  s_waitcnt vmcnt(28)
  ds_read_b64_tr_b16 a[16:17], v152 offset:4096
  ds_read_b64_tr_b16 a[18:19], v153 offset:4096
  ds_read_b64_tr_b16 a[20:21], v154 offset:4096
  ds_read_b64_tr_b16 a[22:23], v155 offset:4096
  ds_read_b64_tr_b16 a[24:25], v152 offset:4160
  ds_read_b64_tr_b16 a[26:27], v153 offset:4160
  ds_read_b64_tr_b16 a[28:29], v154 offset:4160
  ds_read_b64_tr_b16 a[30:31], v155 offset:4160
  s_waitcnt lgkmcnt(0)
  s_add_u32 m0, s28, 4096
  s_nop 0
  buffer_load_dwordx4 v144, s[8:11], s17 offen lds
  s_add_u32 s17, s17, s29
  s_add_u32 m0, s28, 5120
  s_nop 0
  buffer_load_dwordx4 v144, s[8:11], s17 offen lds
  s_add_u32 s17, s17, s29
  s_add_u32 m0, s28, 6144
  s_nop 0
  buffer_load_dwordx4 v144, s[8:11], s17 offen lds
  s_add_u32 s17, s17, s29
  s_add_u32 m0, s28, 7168
  s_nop 0
  buffer_load_dwordx4 v144, s[8:11], s17 offen lds
  s_add_u32 s17, s17, s29
  s_waitcnt vmcnt(28)
  ds_read_b64_tr_b16 a[32:33], v152 offset:8192
  ds_read_b64_tr_b16 a[34:35], v153 offset:8192
  ds_read_b64_tr_b16 a[36:37], v154 offset:8192
  ds_read_b64_tr_b16 a[38:39], v155 offset:8192
  ds_read_b64_tr_b16 a[40:41], v152 offset:8256
  ds_read_b64_tr_b16 a[42:43], v153 offset:8256
  ds_read_b64_tr_b16 a[44:45], v154 offset:8256
  ds_read_b64_tr_b16 a[46:47], v155 offset:8256
  s_waitcnt lgkmcnt(0)
  s_add_u32 m0, s28, 8192
  s_nop 0
  buffer_load_dwordx4 v144, s[8:11], s17 offen lds
  s_add_u32 s17, s17, s29
  s_add_u32 m0, s28, 9216
  s_nop 0
  buffer_load_dwordx4 v144, s[8:11], s17 offen lds
  s_add_u32 s17, s17, s29
  s_add_u32 m0, s28, 10240
  s_nop 0
  buffer_load_dwordx4 v144, s[8:11], s17 offen lds
  s_add_u32 s17, s17, s29
  s_add_u32 m0, s28, 11264
  s_nop 0
  buffer_load_dwordx4 v144, s[8:11], s17 offen lds
  s_add_u32 s17, s17, s29
  s_waitcnt vmcnt(28)
  ds_read_b64_tr_b16 a[48:49], v152 offset:12288
  ds_read_b64_tr_b16 a[50:51], v153 offset:12288
  ds_read_b64_tr_b16 a[52:53], v154 offset:12288
  ds_read_b64_tr_b16 a[54:55], v155 offset:12288
  ds_read_b64_tr_b16 a[56:57], v152 offset:12352
  ds_read_b64_tr_b16 a[58:59], v153 offset:12352
  ds_read_b64_tr_b16 a[60:61], v154 offset:12352
  ds_read_b64_tr_b16 a[62:63], v155 offset:12352
  s_waitcnt lgkmcnt(0)
  s_add_u32 m0, s28, 12288
  s_nop 0
  buffer_load_dwordx4 v144, s[8:11], s17 offen lds
  s_add_u32 s17, s17, s29
  s_add_u32 m0, s28, 13312
  s_nop 0
  buffer_load_dwordx4 v144, s[8:11], s17 offen lds
  s_add_u32 s17, s17, s29
  s_add_u32 m0, s28, 14336
  s_nop 0
  buffer_load_dwordx4 v144, s[8:11], s17 offen lds
  s_add_u32 s17, s17, s29
  s_add_u32 m0, s28, 15360
  s_nop 0
  buffer_load_dwordx4 v144, s[8:11], s17 offen lds
  s_add_u32 s17, s17, s29
  s_waitcnt vmcnt(28)
  ds_read_b64_tr_b16 a[64:65], v152 offset:16384
  ds_read_b64_tr_b16 a[66:67], v153 offset:16384
  ds_read_b64_tr_b16 a[68:69], v154 offset:16384
  ds_read_b64_tr_b16 a[70:71], v155 offset:16384
  ds_read_b64_tr_b16 a[72:73], v152 offset:16448
  ds_read_b64_tr_b16 a[74:75], v153 offset:16448
  ds_read_b64_tr_b16 a[76:77], v154 offset:16448
  ds_read_b64_tr_b16 a[78:79], v155 offset:16448
  s_waitcnt lgkmcnt(0)
  s_add_u32 m0, s28, 16384
  s_nop 0
  buffer_load_dwordx4 v144, s[8:11], s17 offen lds
  s_add_u32 s17, s17, s29
  s_add_u32 m0, s28, 17408
  s_nop 0
  buffer_load_dwordx4 v144, s[8:11], s17 offen lds
  s_add_u32 s17, s17, s29
  s_add_u32 m0, s28, 18432
  s_nop 0
  buffer_load_dwordx4 v144, s[8:11], s17 offen lds
  s_add_u32 s17, s17, s29
  s_add_u32 m0, s28, 19456
  s_nop 0
  buffer_load_dwordx4 v144, s[8:11], s17 offen lds
  s_add_u32 s17, s17, s29
  s_waitcnt vmcnt(28)
  ds_read_b64_tr_b16 a[80:81], v152 offset:20480
  ds_read_b64_tr_b16 a[82:83], v153 offset:20480
  ds_read_b64_tr_b16 a[84:85], v154 offset:20480
  ds_read_b64_tr_b16 a[86:87], v155 offset:20480
  ds_read_b64_tr_b16 a[88:89], v152 offset:20544
  ds_read_b64_tr_b16 a[90:91], v153 offset:20544
  ds_read_b64_tr_b16 a[92:93], v154 offset:20544
  ds_read_b64_tr_b16 a[94:95], v155 offset:20544
  s_waitcnt lgkmcnt(0)
  s_add_u32 m0, s28, 20480
  s_nop 0
  buffer_load_dwordx4 v144, s[8:11], s17 offen lds
  s_add_u32 s17, s17, s29
  s_add_u32 m0, s28, 21504
  s_nop 0
  buffer_load_dwordx4 v144, s[8:11], s17 offen lds
  s_add_u32 s17, s17, s29
  s_add_u32 m0, s28, 22528
  s_nop 0
  buffer_load_dwordx4 v144, s[8:11], s17 offen lds
  s_add_u32 s17, s17, s29
  s_add_u32 m0, s28, 23552
  s_nop 0
  buffer_load_dwordx4 v144, s[8:11], s17 offen lds
  s_add_u32 s17, s17, s29
  s_waitcnt vmcnt(28)
  ds_read_b64_tr_b16 a[96:97], v152 offset:24576
  ds_read_b64_tr_b16 a[98:99], v153 offset:24576
  ds_read_b64_tr_b16 a[100:101], v154 offset:24576
  ds_read_b64_tr_b16 a[102:103], v155 offset:24576
  ds_read_b64_tr_b16 a[104:105], v152 offset:24640
  ds_read_b64_tr_b16 a[106:107], v153 offset:24640
  ds_read_b64_tr_b16 a[108:109], v154 offset:24640
  ds_read_b64_tr_b16 a[110:111], v155 offset:24640
  s_waitcnt lgkmcnt(0)
  s_add_u32 m0, s28, 24576
  s_nop 0
  buffer_load_dwordx4 v144, s[8:11], s17 offen lds
  s_add_u32 s17, s17, s29
  s_add_u32 m0, s28, 25600
  s_nop 0
  buffer_load_dwordx4 v144, s[8:11], s17 offen lds
  s_add_u32 s17, s17, s29
  s_add_u32 m0, s28, 26624
  s_nop 0
  buffer_load_dwordx4 v144, s[8:11], s17 offen lds
  s_add_u32 s17, s17, s29
  s_add_u32 m0, s28, 27648
  s_nop 0
  buffer_load_dwordx4 v144, s[8:11], s17 offen lds
  s_add_u32 s17, s17, s29
  s_waitcnt vmcnt(28)
  ds_read_b64_tr_b16 a[112:113], v152 offset:28672
  ds_read_b64_tr_b16 a[114:115], v153 offset:28672
  ds_read_b64_tr_b16 a[116:117], v154 offset:28672
  ds_read_b64_tr_b16 a[118:119], v155 offset:28672
  ds_read_b64_tr_b16 a[120:121], v152 offset:28736
  ds_read_b64_tr_b16 a[122:123], v153 offset:28736
  ds_read_b64_tr_b16 a[124:125], v154 offset:28736
  ds_read_b64_tr_b16 a[126:127], v155 offset:28736
  s_waitcnt lgkmcnt(0)
  s_add_u32 m0, s28, 28672
  s_nop 0
  buffer_load_dwordx4 v144, s[8:11], s17 offen lds
  s_add_u32 s17, s17, s29
  s_add_u32 m0, s28, 29696
  s_nop 0
  buffer_load_dwordx4 v144, s[8:11], s17 offen lds
  s_add_u32 s17, s17, s29
  s_add_u32 m0, s28, 30720
  s_nop 0
  buffer_load_dwordx4 v144, s[8:11], s17 offen lds
  s_add_u32 s17, s17, s29
  s_add_u32 m0, s28, 31744
  s_nop 0
  buffer_load_dwordx4 v144, s[8:11], s17 offen lds
  s_add_u32 s17, s17, s29
  s_waitcnt vmcnt(28)
  ds_read_b64_tr_b16 a[128:129], v152 offset:0
  ds_read_b64_tr_b16 a[130:131], v153 offset:0
  ds_read_b64_tr_b16 a[132:133], v154 offset:0
  ds_read_b64_tr_b16 a[134:135], v155 offset:0
  ds_read_b64_tr_b16 a[136:137], v152 offset:64
  ds_read_b64_tr_b16 a[138:139], v153 offset:64
  ds_read_b64_tr_b16 a[140:141], v154 offset:64
  ds_read_b64_tr_b16 a[142:143], v155 offset:64
  s_waitcnt lgkmcnt(0)
  s_waitcnt vmcnt(24)
  ds_read_b64_tr_b16 a[144:145], v152 offset:4096
  ds_read_b64_tr_b16 a[146:147], v153 offset:4096
  ds_read_b64_tr_b16 a[148:149], v154 offset:4096
  ds_read_b64_tr_b16 a[150:151], v155 offset:4096
  ds_read_b64_tr_b16 a[152:153], v152 offset:4160
  ds_read_b64_tr_b16 a[154:155], v153 offset:4160
  ds_read_b64_tr_b16 a[156:157], v154 offset:4160
  ds_read_b64_tr_b16 a[158:159], v155 offset:4160
  s_waitcnt lgkmcnt(0)
  s_waitcnt vmcnt(20)
  ds_read_b64_tr_b16 a[160:161], v152 offset:8192
  ds_read_b64_tr_b16 a[162:163], v153 offset:8192
  ds_read_b64_tr_b16 a[164:165], v154 offset:8192
  ds_read_b64_tr_b16 a[166:167], v155 offset:8192
  ds_read_b64_tr_b16 a[168:169], v152 offset:8256
  ds_read_b64_tr_b16 a[170:171], v153 offset:8256
  ds_read_b64_tr_b16 a[172:173], v154 offset:8256
  ds_read_b64_tr_b16 a[174:175], v155 offset:8256
  s_waitcnt lgkmcnt(0)
  s_waitcnt vmcnt(16)
  ds_read_b64_tr_b16 a[176:177], v152 offset:12288
  ds_read_b64_tr_b16 a[178:179], v153 offset:12288
  ds_read_b64_tr_b16 a[180:181], v154 offset:12288
  ds_read_b64_tr_b16 a[182:183], v155 offset:12288
  ds_read_b64_tr_b16 a[184:185], v152 offset:12352
  ds_read_b64_tr_b16 a[186:187], v153 offset:12352
  ds_read_b64_tr_b16 a[188:189], v154 offset:12352
  ds_read_b64_tr_b16 a[190:191], v155 offset:12352
  s_waitcnt lgkmcnt(0)
  s_waitcnt vmcnt(12)
  ds_read_b64_tr_b16 a[192:193], v152 offset:16384
  ds_read_b64_tr_b16 a[194:195], v153 offset:16384
  ds_read_b64_tr_b16 a[196:197], v154 offset:16384
  ds_read_b64_tr_b16 a[198:199], v155 offset:16384
  ds_read_b64_tr_b16 a[200:201], v152 offset:16448
  ds_read_b64_tr_b16 a[202:203], v153 offset:16448
  ds_read_b64_tr_b16 a[204:205], v154 offset:16448
  ds_read_b64_tr_b16 a[206:207], v155 offset:16448
  s_waitcnt lgkmcnt(0)
  s_waitcnt vmcnt(8)
  ds_read_b64_tr_b16 a[208:209], v152 offset:20480
  ds_read_b64_tr_b16 a[210:211], v153 offset:20480
  ds_read_b64_tr_b16 a[212:213], v154 offset:20480
  ds_read_b64_tr_b16 a[214:215], v155 offset:20480
  ds_read_b64_tr_b16 a[216:217], v152 offset:20544
  ds_read_b64_tr_b16 a[218:219], v153 offset:20544
  ds_read_b64_tr_b16 a[220:221], v154 offset:20544
  ds_read_b64_tr_b16 a[222:223], v155 offset:20544
  s_waitcnt lgkmcnt(0)
  s_waitcnt vmcnt(4)
  ds_read_b64_tr_b16 a[224:225], v152 offset:24576
  ds_read_b64_tr_b16 a[226:227], v153 offset:24576
  ds_read_b64_tr_b16 a[228:229], v154 offset:24576
  ds_read_b64_tr_b16 a[230:231], v155 offset:24576
  ds_read_b64_tr_b16 a[232:233], v152 offset:24640
  ds_read_b64_tr_b16 a[234:235], v153 offset:24640
  ds_read_b64_tr_b16 a[236:237], v154 offset:24640
  ds_read_b64_tr_b16 a[238:239], v155 offset:24640
  s_waitcnt lgkmcnt(0)
  s_waitcnt vmcnt(0)
  ds_read_b64_tr_b16 a[240:241], v152 offset:28672
  ds_read_b64_tr_b16 a[242:243], v153 offset:28672
  ds_read_b64_tr_b16 a[244:245], v154 offset:28672
  ds_read_b64_tr_b16 a[246:247], v155 offset:28672
  ds_read_b64_tr_b16 a[248:249], v152 offset:28736
  ds_read_b64_tr_b16 a[250:251], v153 offset:28736
  ds_read_b64_tr_b16 a[252:253], v154 offset:28736
  ds_read_b64_tr_b16 a[254:255], v155 offset:28736
  s_waitcnt lgkmcnt(0)
  s_lshl_b32 s26, s48, 2
  s_add_u32 s26, s26, s16
  s_lshl_b32 s27, s26, 6
  s_add_u32 s27, s27, s50
  s_lshl_b32 s19, s27, 13
  s_lshl_b32 s27, s50, 5
  s_add_u32 s27, s27, s26
  s_mul_i32 s27, s27, 4096
  s_add_u32 s20, s27, 135266304
  s_lshl_b32 s25, s16, 12
  s_add_u32 s25, s25, 65536
  s_lshl_b32 s26, s16, 13
  v_add_u32 v3, s26, v2
  v_lshrrev_b32 v16, 5, v1
  v_and_b32 v17, 31, v1
  v_bfe_u32 v18, v1, 4, 1
  v_lshl_add_u32 v18, v18, 1, v16
  v_and_b32 v19, 15, v1
  v_lshl_add_u32 v18, v18, 4, v19
  v_lshl_add_u32 v5, v18, 4, s25
  v_bfe_u32 v18, v1, 2, 2
  v_lshl_add_u32 v18, v16, 2, v18
  v_and_b32 v19, 1, v1
  v_lshl_add_u32 v18, v19, 4, v18
  v_lshl_add_u32 v4, v18, 4, s25
  v_lshlrev_b32 v16, 2, v16
  v_sub_u32 v17, v17, v16
  v_mov_b32 v18, 0xf149f2ca
  v_cmp_le_i32 vcc, 0, v17
  s_nop 1
  v_cndmask_b32 v240, v18, 0, vcc
  v_cmp_le_i32 vcc, 1, v17
  s_nop 1
  v_cndmask_b32 v241, v18, 0, vcc
  v_cmp_le_i32 vcc, 2, v17
  s_nop 1
  v_cndmask_b32 v242, v18, 0, vcc
  v_cmp_le_i32 vcc, 3, v17
  s_nop 1
  v_cndmask_b32 v243, v18, 0, vcc
  v_cmp_le_i32 vcc, 8, v17
  s_nop 1
  v_cndmask_b32 v244, v18, 0, vcc
  v_cmp_le_i32 vcc, 9, v17
  s_nop 1
  v_cndmask_b32 v245, v18, 0, vcc
  v_cmp_le_i32 vcc, 10, v17
  s_nop 1
  v_cndmask_b32 v246, v18, 0, vcc
  v_cmp_le_i32 vcc, 11, v17
  s_nop 1
  v_cndmask_b32 v247, v18, 0, vcc
  v_cmp_le_i32 vcc, 16, v17
  s_nop 1
  v_cndmask_b32 v248, v18, 0, vcc
  v_cmp_le_i32 vcc, 17, v17
  s_nop 1
  v_cndmask_b32 v249, v18, 0, vcc
  v_cmp_le_i32 vcc, 18, v17
  s_nop 1
  v_cndmask_b32 v250, v18, 0, vcc
  v_cmp_le_i32 vcc, 19, v17
  s_nop 1
  v_cndmask_b32 v251, v18, 0, vcc
  v_cmp_le_i32 vcc, 24, v17
  s_nop 1
  v_cndmask_b32 v252, v18, 0, vcc
  v_cmp_le_i32 vcc, 25, v17
  s_nop 1
  v_cndmask_b32 v253, v18, 0, vcc
  v_cmp_le_i32 vcc, 26, v17
  s_nop 1
  v_cndmask_b32 v254, v18, 0, vcc
  v_cmp_le_i32 vcc, 27, v17
  s_nop 1
  v_cndmask_b32 v255, v18, 0, vcc
  v_mov_b32 v21, v2
  s_barrier
  s_lshl_b32 s77, s48, 2
  s_add_u32 s77, s77, s16
  s_mul_i32 s78, s77, 896
  s_add_u32 s76, s78, 148898304
  s_mov_b32 s71, 0
  s_branch M_sg_60
M_sw_59:
  s_sleep 8
  s_add_u32 s71, s71, 1
  s_cmp_gt_u32 s71, 262144
  s_cbranch_scc1 M_exit
M_sg_60:
  s_mov_b32 s79, 0
  s_atomic_or s79, s[72:73], s76 glc
  s_waitcnt lgkmcnt(0)
  s_cmp_lt_u32 s79, 16
  s_cbranch_scc1 M_sw_59
  s_add_u32 s76, s78, 148898048
  s_mov_b32 s71, 0
  s_branch M_sg_62
M_sw_61:
  s_sleep 8
  s_add_u32 s71, s71, 1
  s_cmp_gt_u32 s71, 262144
  s_cbranch_scc1 M_exit
M_sg_62:
  s_mov_b32 s79, 0
  s_atomic_or s79, s[72:73], s76 glc
  s_waitcnt lgkmcnt(0)
  s_cmp_lt_u32 s79, 16
  s_cbranch_scc1 M_sw_61
M_xok_58:
  s_lshl_b32 s77, s77, 7
  s_add_u32 s54, s77, 148926464
  s_add_u32 s52, s50, 1
  s_mov_b32 s53, 0
  s_mov_b32 s30, 0x200
  s_add_u32 s28, s19, 50331648
  buffer_load_dwordx4 v[144:147], v21, s[4:7], s28 offen offset:0 sc1
  buffer_load_dwordx4 v[148:151], v21, s[4:7], s28 offen offset:1024 sc1
  buffer_load_dwordx4 v[152:155], v21, s[4:7], s28 offen offset:2048 sc1
  buffer_load_dwordx4 v[156:159], v21, s[4:7], s28 offen offset:3072 sc1
  s_add_u32 s29, s19, 50335744
  buffer_load_dwordx4 v[160:163], v21, s[4:7], s29 offen offset:0 sc1
  buffer_load_dwordx4 v[164:167], v21, s[4:7], s29 offen offset:1024 sc1
  buffer_load_dwordx4 v[168:171], v21, s[4:7], s29 offen offset:2048 sc1
  buffer_load_dwordx4 v[172:175], v21, s[4:7], s29 offen offset:3072 sc1
  s_add_u32 s28, s19, 67108864
  buffer_load_dwordx4 v[176:179], v21, s[4:7], s28 offen offset:0 sc1
  buffer_load_dwordx4 v[180:183], v21, s[4:7], s28 offen offset:1024 sc1
  buffer_load_dwordx4 v[184:187], v21, s[4:7], s28 offen offset:2048 sc1
  buffer_load_dwordx4 v[188:191], v21, s[4:7], s28 offen offset:3072 sc1
  s_add_u32 s29, s19, 67112960
  buffer_load_dwordx4 v[192:195], v21, s[4:7], s29 offen offset:0 sc1
  buffer_load_dwordx4 v[196:199], v21, s[4:7], s29 offen offset:1024 sc1
  buffer_load_dwordx4 v[200:203], v21, s[4:7], s29 offen offset:2048 sc1
  buffer_load_dwordx4 v[204:207], v21, s[4:7], s29 offen offset:3072 sc1
  s_add_u32 s28, s19, 83886080
  buffer_load_dwordx4 v[208:211], v21, s[4:7], s28 offen offset:0 sc1
  buffer_load_dwordx4 v[212:215], v21, s[4:7], s28 offen offset:1024 sc1
  buffer_load_dwordx4 v[216:219], v21, s[4:7], s28 offen offset:2048 sc1
  buffer_load_dwordx4 v[220:223], v21, s[4:7], s28 offen offset:3072 sc1
  s_add_u32 s29, s19, 83890176
  buffer_load_dwordx4 v[224:227], v21, s[4:7], s29 offen offset:0 sc1
  buffer_load_dwordx4 v[228:231], v21, s[4:7], s29 offen offset:1024 sc1
  buffer_load_dwordx4 v[232:235], v21, s[4:7], s29 offen offset:2048 sc1
  buffer_load_dwordx4 v[236:239], v21, s[4:7], s29 offen offset:3072 sc1
  s_mov_b32 s24, 0
  v_mov_b32 v22, 0x40000000
  s_sub_u32 s21, s21, s22
F_top_63:
  s_waitcnt vmcnt(8)
  v_mfma_f32_32x32x16_bf16 v[24:39], v[176:179], v[144:147], v[240:255]
  s_nop 1
  v_cvt_pk_bf16_f32 v128, v64, v65
  v_cvt_pk_bf16_f32 v129, v66, v67
  v_cvt_pk_bf16_f32 v130, v68, v69
  v_cvt_pk_bf16_f32 v131, v70, v71
  v_mfma_f32_32x32x16_bf16 v[24:39], v[180:183], v[148:151], v[24:39]
  buffer_store_dwordx4 v[128:131], v22, s[4:7], s21 offen offset:0 sc1
  v_mfma_f32_32x32x16_bf16 v[24:39], v[184:187], v[152:155], v[24:39]
  v_cvt_pk_bf16_f32 v132, v72, v73
  v_cvt_pk_bf16_f32 v133, v74, v75
  v_cvt_pk_bf16_f32 v134, v76, v77
  v_cvt_pk_bf16_f32 v135, v78, v79
  v_mfma_f32_32x32x16_bf16 v[24:39], v[188:191], v[156:159], v[24:39]
  buffer_store_dwordx4 v[132:135], v22, s[4:7], s21 offen offset:256 sc1
  v_mfma_f32_32x32x16_bf16 v[24:39], v[192:195], v[160:163], v[24:39]
  v_cvt_pk_bf16_f32 v136, v80, v81
  v_cvt_pk_bf16_f32 v137, v82, v83
  v_cvt_pk_bf16_f32 v138, v84, v85
  v_cvt_pk_bf16_f32 v139, v86, v87
  v_mfma_f32_32x32x16_bf16 v[24:39], v[196:199], v[164:167], v[24:39]
  buffer_store_dwordx4 v[136:139], v22, s[4:7], s21 offen offset:2048 sc1
  v_mfma_f32_32x32x16_bf16 v[24:39], v[200:203], v[168:171], v[24:39]
  v_cvt_pk_bf16_f32 v140, v88, v89
  v_cvt_pk_bf16_f32 v141, v90, v91
  v_cvt_pk_bf16_f32 v142, v92, v93
  v_cvt_pk_bf16_f32 v143, v94, v95
  v_mfma_f32_32x32x16_bf16 v[24:39], v[204:207], v[172:175], v[24:39]
  buffer_store_dwordx4 v[140:143], v22, s[4:7], s21 offen offset:2304 sc1
  s_add_u32 s21, s21, s22
  v_mov_b32 v22, v20
  s_cmp_lg_u32 s24, 0
  s_cbranch_scc1 F_have_64
  s_cmp_le_u32 s52, 58
  s_cbranch_scc1 M_dp_65
  s_mov_b32 s71, 0
  v_add_u32 v16, s25, v2
  s_branch M_dp_67
M_dp_66:
  s_sleep 1
  s_add_u32 s71, s71, 1
  s_cmp_gt_u32 s71, 262144
  s_cbranch_scc1 M_exit
M_dp_67:
  buffer_load_dword v23, off, s[4:7], s54 sc1
  buffer_load_dwordx4 v[96:99], v2, s[4:7], s20 offen offset:0 sc1
  buffer_load_dwordx4 v[100:103], v2, s[4:7], s20 offen offset:1024 sc1
  buffer_load_dwordx4 v[104:107], v2, s[4:7], s20 offen offset:2048 sc1
  buffer_load_dwordx4 v[108:111], v2, s[4:7], s20 offen offset:3072 sc1
  s_waitcnt vmcnt(3)
  v_max_u32 v17, v96, v97
  v_max3_u32 v17, v17, v98, v99
  s_waitcnt vmcnt(2)
  v_max3_u32 v17, v17, v100, v101
  v_max3_u32 v17, v17, v102, v103
  s_waitcnt vmcnt(1)
  v_max3_u32 v17, v17, v104, v105
  v_max3_u32 v17, v17, v106, v107
  s_waitcnt vmcnt(0)
  v_max3_u32 v17, v17, v108, v109
  v_max3_u32 v17, v17, v110, v111
  v_cmp_eq_u32 vcc, -1, v17
  s_cbranch_vccz M_dp_68
  v_cmp_gt_u32 vcc, s52, v23
  s_cbranch_vccnz M_dp_66
  s_branch M_dp_65
M_dp_68:
  ds_write_b128 v16, v[96:99] offset:0
  ds_write_b128 v16, v[100:103] offset:1024
  ds_write_b128 v16, v[104:107] offset:2048
  ds_write_b128 v16, v[108:111] offset:3072
  s_branch F_have_64
M_dp_65:
  v_mov_b32 v16, s54
  v_mov_b32 v17, s52
  s_mov_b32 s71, 0
  s_branch M_vg_70
M_vw_69:
  s_sleep 2
  s_add_u32 s71, s71, 1
  s_cmp_gt_u32 s71, 262144
  s_cbranch_scc1 M_exit
M_vg_70:
  buffer_load_dword v23, v16, s[4:7], 0 offen sc1
  s_waitcnt vmcnt(0)
  v_cmp_lt_u32 vcc, v23, v17
  s_cbranch_vccnz M_vw_69
  s_mov_b32 m0, s25
  s_nop 0
  buffer_load_dwordx4 v2, s[4:7], s20 offen offset:0 sc1 lds
  buffer_load_dwordx4 v2, s[4:7], s20 offen offset:1024 sc1 lds
  buffer_load_dwordx4 v2, s[4:7], s20 offen offset:2048 sc1 lds
  buffer_load_dwordx4 v2, s[4:7], s20 offen offset:3072 sc1 lds
  s_waitcnt vmcnt(0)
F_have_64:
  ds_read_b64_tr_b16 v[176:177], v4 offset:8
  ds_read_b64_tr_b16 v[178:179], v4 offset:136
  ds_read_b64_tr_b16 v[180:181], v4 offset:520
  ds_read_b64_tr_b16 v[182:183], v4 offset:648
  ds_read_b64_tr_b16 v[184:185], v4 offset:1032
  ds_read_b64_tr_b16 v[186:187], v4 offset:1160
  ds_read_b64_tr_b16 v[188:189], v4 offset:1544
  ds_read_b64_tr_b16 v[190:191], v4 offset:1672
  ds_read_b64_tr_b16 v[192:193], v4 offset:2056
  ds_read_b64_tr_b16 v[194:195], v4 offset:2184
  ds_read_b64_tr_b16 v[196:197], v4 offset:2568
  ds_read_b64_tr_b16 v[198:199], v4 offset:2696
  s_sub_u32 s23, s23, 1
  s_cmp_gt_u32 s23, 0
  s_cselect_b32 s26, s51, 0
  s_cselect_b32 s27, 0, 0x40000000
  v_or_b32 v21, s27, v21
  s_lshl_b32 s27, s26, 13
  s_add_u32 s19, s19, s27
  s_mul_i32 s27, s26, 131072
  s_add_u32 s20, s20, s27
  s_cmp_lg_u32 s23, 24
  s_cbranch_scc1 M_xok_71
  s_lshl_b32 s77, s48, 2
  s_add_u32 s77, s77, s16
  s_mul_i32 s78, s77, 896
  s_add_u32 s76, s78, 148898304
  s_mov_b32 s71, 0
  s_branch M_sg_73
M_sw_72:
  s_sleep 8
  s_add_u32 s71, s71, 1
  s_cmp_gt_u32 s71, 262144
  s_cbranch_scc1 M_exit
M_sg_73:
  s_mov_b32 s79, 0
  s_atomic_or s79, s[72:73], s76 glc
  s_waitcnt lgkmcnt(0)
  s_cmp_lt_u32 s79, 32
  s_cbranch_scc1 M_sw_72
  s_add_u32 s76, s78, 148898432
  s_mov_b32 s71, 0
  s_branch M_sg_75
M_sw_74:
  s_sleep 8
  s_add_u32 s71, s71, 1
  s_cmp_gt_u32 s71, 262144
  s_cbranch_scc1 M_exit
M_sg_75:
  s_mov_b32 s79, 0
  s_atomic_or s79, s[72:73], s76 glc
  s_waitcnt lgkmcnt(0)
  s_cmp_lt_u32 s79, 32
  s_cbranch_scc1 M_sw_74
  s_add_u32 s76, s78, 148898048
  s_mov_b32 s71, 0
  s_branch M_sg_77
M_sw_76:
  s_sleep 8
  s_add_u32 s71, s71, 1
  s_cmp_gt_u32 s71, 262144
  s_cbranch_scc1 M_exit
M_sg_77:
  s_mov_b32 s79, 0
  s_atomic_or s79, s[72:73], s76 glc
  s_waitcnt lgkmcnt(0)
  s_cmp_lt_u32 s79, 30
  s_cbranch_scc1 M_sw_76
  s_add_u32 s76, s78, 148898176
  s_mov_b32 s71, 0
  s_branch M_sg_79
M_sw_78:
  s_sleep 8
  s_add_u32 s71, s71, 1
  s_cmp_gt_u32 s71, 262144
  s_cbranch_scc1 M_exit
M_sg_79:
  s_mov_b32 s79, 0
  s_atomic_or s79, s[72:73], s76 glc
  s_waitcnt lgkmcnt(0)
  s_cmp_lt_u32 s79, 34
  s_cbranch_scc1 M_sw_78
M_xok_71:
  s_waitcnt lgkmcnt(10)
  v_mfma_f32_32x32x16_bf16 v[40:55], v[176:179], v[144:147], 0
  ds_read_b64_tr_b16 v[200:201], v4 offset:3080
  ds_read_b64_tr_b16 v[202:203], v4 offset:3208
  v_max_f32 v6, v24, v25
  s_waitcnt lgkmcnt(10)
  v_mfma_f32_32x32x16_bf16 v[40:55], v[180:183], v[148:151], v[40:55]
  ds_read_b64_tr_b16 v[204:205], v4 offset:3592
  ds_read_b64_tr_b16 v[206:207], v4 offset:3720
  v_max3_f32 v6, v6, v26, v27
  s_waitcnt lgkmcnt(10)
  v_mfma_f32_32x32x16_bf16 v[40:55], v[184:187], v[152:155], v[40:55]
  ds_read_b64 v[56:57], v5 offset:0
  ds_read_b64 v[58:59], v5 offset:1024
  v_max3_f32 v6, v6, v28, v29
  s_waitcnt lgkmcnt(10)
  v_mfma_f32_32x32x16_bf16 v[40:55], v[188:191], v[156:159], v[40:55]
  ds_read_b64 v[60:61], v5 offset:2048
  ds_read_b64 v[62:63], v5 offset:3072
  v_max3_f32 v6, v6, v30, v31
  s_waitcnt lgkmcnt(10)
  v_mfma_f32_32x32x16_bf16 v[40:55], v[192:195], v[160:163], v[40:55]
  v_max3_f32 v6, v6, v32, v33
  s_waitcnt lgkmcnt(8)
  v_mfma_f32_32x32x16_bf16 v[40:55], v[196:199], v[164:167], v[40:55]
  v_max3_f32 v6, v6, v34, v35
  s_waitcnt lgkmcnt(6)
  v_mfma_f32_32x32x16_bf16 v[40:55], v[200:203], v[168:171], v[40:55]
  v_max3_f32 v6, v6, v36, v37
  s_waitcnt lgkmcnt(4)
  v_mfma_f32_32x32x16_bf16 v[40:55], v[204:207], v[172:175], v[40:55]
  v_max3_f32 v6, v6, v38, v39
  s_add_u32 s28, s19, 50331648
  buffer_load_dwordx4 v[144:147], v21, s[4:7], s28 offen offset:0 sc1
  buffer_load_dwordx4 v[148:151], v21, s[4:7], s28 offen offset:1024 sc1
  s_nop 7
  v_max3_f32 v6, v6, v40, v41
  v_max3_f32 v6, v6, v42, v43
  v_mov_b32 v16, v6
  s_nop 1
  v_permlane32_swap_b32 v6, v16
  s_nop 1
  v_max_f32 v6, v6, v16
  v_pk_add_f32 v[24:25], v[24:25], v[6:7] op_sel_hi:[1,0] neg_lo:[0,1] neg_hi:[0,1]
  v_pk_add_f32 v[26:27], v[26:27], v[6:7] op_sel_hi:[1,0] neg_lo:[0,1] neg_hi:[0,1]
  v_pk_add_f32 v[28:29], v[28:29], v[6:7] op_sel_hi:[1,0] neg_lo:[0,1] neg_hi:[0,1]
  v_pk_add_f32 v[30:31], v[30:31], v[6:7] op_sel_hi:[1,0] neg_lo:[0,1] neg_hi:[0,1]
  v_pk_add_f32 v[32:33], v[32:33], v[6:7] op_sel_hi:[1,0] neg_lo:[0,1] neg_hi:[0,1]
  v_pk_add_f32 v[34:35], v[34:35], v[6:7] op_sel_hi:[1,0] neg_lo:[0,1] neg_hi:[0,1]
  v_pk_add_f32 v[36:37], v[36:37], v[6:7] op_sel_hi:[1,0] neg_lo:[0,1] neg_hi:[0,1]
  v_pk_add_f32 v[38:39], v[38:39], v[6:7] op_sel_hi:[1,0] neg_lo:[0,1] neg_hi:[0,1]
  v_pk_add_f32 v[40:41], v[40:41], v[6:7] op_sel_hi:[1,0] neg_lo:[0,1] neg_hi:[0,1]
  v_pk_add_f32 v[42:43], v[42:43], v[6:7] op_sel_hi:[1,0] neg_lo:[0,1] neg_hi:[0,1]
  v_exp_f32 v24, v24
  v_exp_f32 v25, v25
  v_exp_f32 v26, v26
  v_exp_f32 v27, v27
  v_exp_f32 v28, v28
  v_exp_f32 v29, v29
  v_exp_f32 v30, v30
  v_exp_f32 v31, v31
  v_exp_f32 v32, v32
  v_exp_f32 v33, v33
  buffer_load_dwordx4 v[152:155], v21, s[4:7], s28 offen offset:2048 sc1
  v_exp_f32 v34, v34
  v_exp_f32 v35, v35
  v_exp_f32 v36, v36
  v_exp_f32 v37, v37
  v_exp_f32 v38, v38
  v_exp_f32 v39, v39
  v_exp_f32 v40, v40
  v_exp_f32 v41, v41
  v_exp_f32 v42, v42
  v_exp_f32 v43, v43
  v_pk_add_f32 v[16:17], v[24:25], v[26:27]
  v_pk_add_f32 v[16:17], v[16:17], v[28:29]
  v_pk_add_f32 v[16:17], v[16:17], v[30:31]
  v_pk_add_f32 v[16:17], v[16:17], v[32:33]
  v_pk_add_f32 v[16:17], v[16:17], v[34:35]
  v_pk_add_f32 v[16:17], v[16:17], v[36:37]
  v_pk_add_f32 v[16:17], v[16:17], v[38:39]
  v_pk_add_f32 v[16:17], v[16:17], v[40:41]
  v_pk_add_f32 v[16:17], v[16:17], v[42:43]
  v_add_f32 v16, v16, v17
  v_mov_b32 v17, v16
  buffer_load_dwordx4 v[156:159], v21, s[4:7], s28 offen offset:3072 sc1
  s_nop 0
  v_permlane32_swap_b32 v16, v17
  s_nop 1
  v_add_f32 v16, v16, v17
  v_rcp_f32 v6, v16
  s_nop 0
  v_pk_mul_f32 v[24:25], v[24:25], v[6:7] op_sel_hi:[1,0]
  v_pk_mul_f32 v[26:27], v[26:27], v[6:7] op_sel_hi:[1,0]
  v_pk_mul_f32 v[28:29], v[28:29], v[6:7] op_sel_hi:[1,0]
  v_pk_mul_f32 v[30:31], v[30:31], v[6:7] op_sel_hi:[1,0]
  v_pk_mul_f32 v[32:33], v[32:33], v[6:7] op_sel_hi:[1,0]
  v_pk_mul_f32 v[34:35], v[34:35], v[6:7] op_sel_hi:[1,0]
  v_pk_mul_f32 v[36:37], v[36:37], v[6:7] op_sel_hi:[1,0]
  v_pk_mul_f32 v[38:39], v[38:39], v[6:7] op_sel_hi:[1,0]
  v_pk_mul_f32 v[40:41], v[40:41], v[6:7] op_sel_hi:[1,0]
  v_pk_mul_f32 v[42:43], v[42:43], v[6:7] op_sel_hi:[1,0]
  v_cvt_pk_bf16_f32 v128, v24, v25
  v_cvt_pk_bf16_f32 v129, v26, v27
  v_cvt_pk_bf16_f32 v130, v28, v29
  v_cvt_pk_bf16_f32 v131, v30, v31
  v_cvt_pk_bf16_f32 v132, v32, v33
  v_cvt_pk_bf16_f32 v133, v34, v35
  v_cvt_pk_bf16_f32 v134, v36, v37
  v_cvt_pk_bf16_f32 v135, v38, v39
  v_cvt_pk_bf16_f32 v136, v40, v41
  v_cvt_pk_bf16_f32 v137, v42, v43
  s_waitcnt vmcnt(8) lgkmcnt(0)
  v_mfma_f32_32x32x16_bf16 v[64:79], v[208:211], v[128:131], 0
  s_add_u32 s29, s19, 50335744
  buffer_load_dwordx4 v[160:163], v21, s[4:7], s29 offen offset:0 sc1
  v_mfma_f32_32x32x16_bf16 v[64:79], v[212:215], v[132:135], v[64:79]
  v_mfma_f32_32x32x8_bf16 v[64:79], v[56:57], v[136:137], v[64:79]
  v_mfma_f32_32x32x16_bf16 v[80:95], v[216:219], v[128:131], 0
  buffer_load_dwordx4 v[164:167], v21, s[4:7], s29 offen offset:1024 sc1
  v_mfma_f32_32x32x16_bf16 v[80:95], v[220:223], v[132:135], v[80:95]
  v_cvt_pk_bf16_f32 v24, v64, v65
  v_cvt_pk_bf16_f32 v25, v66, v67
  v_cvt_pk_bf16_f32 v26, v68, v69
  v_cvt_pk_bf16_f32 v27, v70, v71
  v_mfma_f32_32x32x8_bf16 v[80:95], v[58:59], v[136:137], v[80:95]
  ds_write_b128 v3, v[24:27] offset:0
  v_cvt_pk_bf16_f32 v28, v72, v73
  v_cvt_pk_bf16_f32 v29, v74, v75
  v_cvt_pk_bf16_f32 v30, v76, v77
  v_cvt_pk_bf16_f32 v31, v78, v79
  v_mfma_f32_32x32x16_bf16 v[96:111], v[224:227], v[128:131], 0
  ds_write_b128 v3, v[28:31] offset:1024
  buffer_load_dwordx4 v[168:171], v21, s[4:7], s29 offen offset:2048 sc1
  v_mfma_f32_32x32x16_bf16 v[96:111], v[228:231], v[132:135], v[96:111]
  v_cvt_pk_bf16_f32 v32, v80, v81
  v_cvt_pk_bf16_f32 v33, v82, v83
  v_cvt_pk_bf16_f32 v34, v84, v85
  v_cvt_pk_bf16_f32 v35, v86, v87
  v_mfma_f32_32x32x8_bf16 v[96:111], v[60:61], v[136:137], v[96:111]
  ds_write_b128 v3, v[32:35] offset:2048
  v_cvt_pk_bf16_f32 v36, v88, v89
  v_cvt_pk_bf16_f32 v37, v90, v91
  v_cvt_pk_bf16_f32 v38, v92, v93
  v_cvt_pk_bf16_f32 v39, v94, v95
  v_mfma_f32_32x32x16_bf16 v[112:127], v[232:235], v[128:131], 0
  ds_write_b128 v3, v[36:39] offset:3072
  buffer_load_dwordx4 v[172:175], v21, s[4:7], s29 offen offset:3072 sc1
  v_mfma_f32_32x32x16_bf16 v[112:127], v[236:239], v[132:135], v[112:127]
  v_cvt_pk_bf16_f32 v40, v96, v97
  v_cvt_pk_bf16_f32 v41, v98, v99
  v_cvt_pk_bf16_f32 v42, v100, v101
  v_cvt_pk_bf16_f32 v43, v102, v103
  v_mfma_f32_32x32x8_bf16 v[112:127], v[62:63], v[136:137], v[112:127]
  ds_write_b128 v3, v[40:43] offset:4096
  v_cvt_pk_bf16_f32 v44, v104, v105
  v_cvt_pk_bf16_f32 v45, v106, v107
  v_cvt_pk_bf16_f32 v46, v108, v109
  v_cvt_pk_bf16_f32 v47, v110, v111
  ds_write_b128 v3, v[44:47] offset:5120
  s_nop 5
  v_cvt_pk_bf16_f32 v48, v112, v113
  v_cvt_pk_bf16_f32 v49, v114, v115
  v_cvt_pk_bf16_f32 v50, v116, v117
  v_cvt_pk_bf16_f32 v51, v118, v119
  ds_write_b128 v3, v[48:51] offset:6144
  v_cvt_pk_bf16_f32 v52, v120, v121
  v_cvt_pk_bf16_f32 v53, v122, v123
  v_cvt_pk_bf16_f32 v54, v124, v125
  v_cvt_pk_bf16_f32 v55, v126, v127
  ds_write_b128 v3, v[52:55] offset:7168
  s_waitcnt vmcnt(8)
  s_waitcnt lgkmcnt(0)
  s_barrier
  ds_read_b128 v[24:27], v8 offset:0
  ds_read_b128 v[28:31], v9 offset:0
  ds_read_b128 v[32:35], v10 offset:0
  ds_read_b128 v[36:39], v11 offset:0
  ds_read_b128 v[40:43], v12 offset:0
  ds_read_b128 v[44:47], v13 offset:0
  buffer_load_dword v23, off, s[4:7], s54 sc1
  v_mov_b32 v16, s30
  v_min_u32 v17, 1, v0
  v_lshlrev_b32 v17, 30, v17
  buffer_store_dword v16, v17, s[4:7], s31 offen sc1
  s_add_u32 s30, s30, 1
  s_add_u32 s52, s52, 2
  s_waitcnt lgkmcnt(5)
  v_mfma_f32_16x16x32_bf16 v[64:67], a[0:3], v[24:27], 0
  s_add_u32 s28, s19, 67108864
  ds_read_b128 v[48:51], v14 offset:0
  v_mfma_f32_16x16x32_bf16 v[68:71], a[4:7], v[24:27], 0
  v_mfma_f32_16x16x32_bf16 v[80:83], a[8:11], v[24:27], 0
  v_mfma_f32_16x16x32_bf16 v[84:87], a[12:15], v[24:27], 0
  s_waitcnt lgkmcnt(5)
  v_mfma_f32_16x16x32_bf16 v[72:75], a[0:3], v[28:31], 0
  ds_read_b128 v[52:55], v15 offset:0
  v_mfma_f32_16x16x32_bf16 v[76:79], a[4:7], v[28:31], 0
  v_mfma_f32_16x16x32_bf16 v[88:91], a[8:11], v[28:31], 0
  buffer_load_dwordx4 v[176:179], v21, s[4:7], s28 offen offset:0 sc1
  v_mfma_f32_16x16x32_bf16 v[92:95], a[12:15], v[28:31], 0
  s_waitcnt lgkmcnt(5)
  v_mfma_f32_16x16x32_bf16 v[64:67], a[16:19], v[32:35], v[64:67]
  ds_read_b128 v[24:27], v8 offset:8192
  v_mfma_f32_16x16x32_bf16 v[68:71], a[20:23], v[32:35], v[68:71]
  v_mfma_f32_16x16x32_bf16 v[80:83], a[24:27], v[32:35], v[80:83]
  v_mfma_f32_16x16x32_bf16 v[84:87], a[28:31], v[32:35], v[84:87]
  s_waitcnt lgkmcnt(5)
  v_mfma_f32_16x16x32_bf16 v[72:75], a[16:19], v[36:39], v[72:75]
  ds_read_b128 v[28:31], v9 offset:8192
  v_mfma_f32_16x16x32_bf16 v[76:79], a[20:23], v[36:39], v[76:79]
  v_mfma_f32_16x16x32_bf16 v[88:91], a[24:27], v[36:39], v[88:91]
  buffer_load_dwordx4 v[180:183], v21, s[4:7], s28 offen offset:1024 sc1
  v_mfma_f32_16x16x32_bf16 v[92:95], a[28:31], v[36:39], v[92:95]
  s_waitcnt lgkmcnt(5)
  v_mfma_f32_16x16x32_bf16 v[64:67], a[32:35], v[40:43], v[64:67]
  ds_read_b128 v[32:35], v10 offset:8192
  v_mfma_f32_16x16x32_bf16 v[68:71], a[36:39], v[40:43], v[68:71]
  v_mfma_f32_16x16x32_bf16 v[80:83], a[40:43], v[40:43], v[80:83]
  v_mfma_f32_16x16x32_bf16 v[84:87], a[44:47], v[40:43], v[84:87]
  s_waitcnt lgkmcnt(5)
  v_mfma_f32_16x16x32_bf16 v[72:75], a[32:35], v[44:47], v[72:75]
  ds_read_b128 v[36:39], v11 offset:8192
  v_mfma_f32_16x16x32_bf16 v[76:79], a[36:39], v[44:47], v[76:79]
  v_mfma_f32_16x16x32_bf16 v[88:91], a[40:43], v[44:47], v[88:91]
  buffer_load_dwordx4 v[184:187], v21, s[4:7], s28 offen offset:2048 sc1
  v_mfma_f32_16x16x32_bf16 v[92:95], a[44:47], v[44:47], v[92:95]
  s_waitcnt lgkmcnt(5)
  v_mfma_f32_16x16x32_bf16 v[64:67], a[48:51], v[48:51], v[64:67]
  ds_read_b128 v[40:43], v12 offset:8192
  v_mfma_f32_16x16x32_bf16 v[68:71], a[52:55], v[48:51], v[68:71]
  v_mfma_f32_16x16x32_bf16 v[80:83], a[56:59], v[48:51], v[80:83]
  v_mfma_f32_16x16x32_bf16 v[84:87], a[60:63], v[48:51], v[84:87]
  s_waitcnt lgkmcnt(5)
  v_mfma_f32_16x16x32_bf16 v[72:75], a[48:51], v[52:55], v[72:75]
  ds_read_b128 v[44:47], v13 offset:8192
  v_mfma_f32_16x16x32_bf16 v[76:79], a[52:55], v[52:55], v[76:79]
  v_mfma_f32_16x16x32_bf16 v[88:91], a[56:59], v[52:55], v[88:91]
  buffer_load_dwordx4 v[188:191], v21, s[4:7], s28 offen offset:3072 sc1
  v_mfma_f32_16x16x32_bf16 v[92:95], a[60:63], v[52:55], v[92:95]
  s_waitcnt lgkmcnt(5)
  v_mfma_f32_16x16x32_bf16 v[64:67], a[64:67], v[24:27], v[64:67]
  s_add_u32 s29, s19, 67112960
  ds_read_b128 v[48:51], v14 offset:8192
  v_mfma_f32_16x16x32_bf16 v[68:71], a[68:71], v[24:27], v[68:71]
  v_mfma_f32_16x16x32_bf16 v[80:83], a[72:75], v[24:27], v[80:83]
  v_mfma_f32_16x16x32_bf16 v[84:87], a[76:79], v[24:27], v[84:87]
  s_waitcnt lgkmcnt(5)
  v_mfma_f32_16x16x32_bf16 v[72:75], a[64:67], v[28:31], v[72:75]
  ds_read_b128 v[52:55], v15 offset:8192
  v_mfma_f32_16x16x32_bf16 v[76:79], a[68:71], v[28:31], v[76:79]
  v_mfma_f32_16x16x32_bf16 v[88:91], a[72:75], v[28:31], v[88:91]
  buffer_load_dwordx4 v[192:195], v21, s[4:7], s29 offen offset:0 sc1
  v_mfma_f32_16x16x32_bf16 v[92:95], a[76:79], v[28:31], v[92:95]
  s_waitcnt lgkmcnt(5)
  v_mfma_f32_16x16x32_bf16 v[64:67], a[80:83], v[32:35], v[64:67]
  ds_read_b128 v[24:27], v8 offset:16384
  v_mfma_f32_16x16x32_bf16 v[68:71], a[84:87], v[32:35], v[68:71]
  v_mfma_f32_16x16x32_bf16 v[80:83], a[88:91], v[32:35], v[80:83]
  v_mfma_f32_16x16x32_bf16 v[84:87], a[92:95], v[32:35], v[84:87]
  s_waitcnt lgkmcnt(5)
  v_mfma_f32_16x16x32_bf16 v[72:75], a[80:83], v[36:39], v[72:75]
  ds_read_b128 v[28:31], v9 offset:16384
  v_mfma_f32_16x16x32_bf16 v[76:79], a[84:87], v[36:39], v[76:79]
  v_mfma_f32_16x16x32_bf16 v[88:91], a[88:91], v[36:39], v[88:91]
  buffer_load_dwordx4 v[196:199], v21, s[4:7], s29 offen offset:1024 sc1
  v_mfma_f32_16x16x32_bf16 v[92:95], a[92:95], v[36:39], v[92:95]
  s_waitcnt lgkmcnt(5)
  v_mfma_f32_16x16x32_bf16 v[64:67], a[96:99], v[40:43], v[64:67]
  ds_read_b128 v[32:35], v10 offset:16384
  v_mfma_f32_16x16x32_bf16 v[68:71], a[100:103], v[40:43], v[68:71]
  v_mfma_f32_16x16x32_bf16 v[80:83], a[104:107], v[40:43], v[80:83]
  v_mfma_f32_16x16x32_bf16 v[84:87], a[108:111], v[40:43], v[84:87]
  s_waitcnt lgkmcnt(5)
  s_waitcnt vmcnt(7)
  v_readfirstlane_b32 s53, v23
  s_nop 0
  s_cmp_ge_u32 s53, s52
  s_cselect_b32 s24, 1, 0
  s_cbranch_scc0 F_nopre_80
  s_mov_b32 m0, s25
  s_nop 0
  buffer_load_dwordx4 v2, s[4:7], s20 offen offset:0 sc1 lds
  buffer_load_dwordx4 v2, s[4:7], s20 offen offset:1024 sc1 lds
  buffer_load_dwordx4 v2, s[4:7], s20 offen offset:2048 sc1 lds
  buffer_load_dwordx4 v2, s[4:7], s20 offen offset:3072 sc1 lds
F_nopre_80:
  v_mfma_f32_16x16x32_bf16 v[72:75], a[96:99], v[44:47], v[72:75]
  ds_read_b128 v[36:39], v11 offset:16384
  v_mfma_f32_16x16x32_bf16 v[76:79], a[100:103], v[44:47], v[76:79]
  v_mfma_f32_16x16x32_bf16 v[88:91], a[104:107], v[44:47], v[88:91]
  buffer_load_dwordx4 v[200:203], v21, s[4:7], s29 offen offset:2048 sc1
  v_mfma_f32_16x16x32_bf16 v[92:95], a[108:111], v[44:47], v[92:95]
  s_waitcnt lgkmcnt(5)
  v_mfma_f32_16x16x32_bf16 v[64:67], a[112:115], v[48:51], v[64:67]
  ds_read_b128 v[40:43], v12 offset:16384
  v_mfma_f32_16x16x32_bf16 v[68:71], a[116:119], v[48:51], v[68:71]
  v_mfma_f32_16x16x32_bf16 v[80:83], a[120:123], v[48:51], v[80:83]
  v_mfma_f32_16x16x32_bf16 v[84:87], a[124:127], v[48:51], v[84:87]
  s_waitcnt lgkmcnt(5)
  v_mfma_f32_16x16x32_bf16 v[72:75], a[112:115], v[52:55], v[72:75]
  ds_read_b128 v[44:47], v13 offset:16384
  v_mfma_f32_16x16x32_bf16 v[76:79], a[116:119], v[52:55], v[76:79]
  v_mfma_f32_16x16x32_bf16 v[88:91], a[120:123], v[52:55], v[88:91]
  buffer_load_dwordx4 v[204:207], v21, s[4:7], s29 offen offset:3072 sc1
  v_mfma_f32_16x16x32_bf16 v[92:95], a[124:127], v[52:55], v[92:95]
  s_waitcnt lgkmcnt(5)
  v_mfma_f32_16x16x32_bf16 v[64:67], a[128:131], v[24:27], v[64:67]
  s_add_u32 s28, s19, 83886080
  ds_read_b128 v[48:51], v14 offset:16384
  v_mfma_f32_16x16x32_bf16 v[68:71], a[132:135], v[24:27], v[68:71]
  v_mfma_f32_16x16x32_bf16 v[80:83], a[136:139], v[24:27], v[80:83]
  v_mfma_f32_16x16x32_bf16 v[84:87], a[140:143], v[24:27], v[84:87]
  s_waitcnt lgkmcnt(5)
  v_mfma_f32_16x16x32_bf16 v[72:75], a[128:131], v[28:31], v[72:75]
  ds_read_b128 v[52:55], v15 offset:16384
  v_mfma_f32_16x16x32_bf16 v[76:79], a[132:135], v[28:31], v[76:79]
  v_mfma_f32_16x16x32_bf16 v[88:91], a[136:139], v[28:31], v[88:91]
  buffer_load_dwordx4 v[208:211], v21, s[4:7], s28 offen offset:0 sc1
  v_mfma_f32_16x16x32_bf16 v[92:95], a[140:143], v[28:31], v[92:95]
  s_waitcnt lgkmcnt(5)
  v_mfma_f32_16x16x32_bf16 v[64:67], a[144:147], v[32:35], v[64:67]
  ds_read_b128 v[24:27], v8 offset:24576
  v_mfma_f32_16x16x32_bf16 v[68:71], a[148:151], v[32:35], v[68:71]
  v_mfma_f32_16x16x32_bf16 v[80:83], a[152:155], v[32:35], v[80:83]
  v_mfma_f32_16x16x32_bf16 v[84:87], a[156:159], v[32:35], v[84:87]
  s_waitcnt lgkmcnt(5)
  v_mfma_f32_16x16x32_bf16 v[72:75], a[144:147], v[36:39], v[72:75]
  ds_read_b128 v[28:31], v9 offset:24576
  v_mfma_f32_16x16x32_bf16 v[76:79], a[148:151], v[36:39], v[76:79]
  v_mfma_f32_16x16x32_bf16 v[88:91], a[152:155], v[36:39], v[88:91]
  buffer_load_dwordx4 v[212:215], v21, s[4:7], s28 offen offset:1024 sc1
  v_mfma_f32_16x16x32_bf16 v[92:95], a[156:159], v[36:39], v[92:95]
  s_waitcnt lgkmcnt(5)
  v_mfma_f32_16x16x32_bf16 v[64:67], a[160:163], v[40:43], v[64:67]
  ds_read_b128 v[32:35], v10 offset:24576
  v_mfma_f32_16x16x32_bf16 v[68:71], a[164:167], v[40:43], v[68:71]
  v_mfma_f32_16x16x32_bf16 v[80:83], a[168:171], v[40:43], v[80:83]
  v_mfma_f32_16x16x32_bf16 v[84:87], a[172:175], v[40:43], v[84:87]
  s_waitcnt lgkmcnt(5)
  v_mfma_f32_16x16x32_bf16 v[72:75], a[160:163], v[44:47], v[72:75]
  ds_read_b128 v[36:39], v11 offset:24576
  v_mfma_f32_16x16x32_bf16 v[76:79], a[164:167], v[44:47], v[76:79]
  v_mfma_f32_16x16x32_bf16 v[88:91], a[168:171], v[44:47], v[88:91]
  buffer_load_dwordx4 v[216:219], v21, s[4:7], s28 offen offset:2048 sc1
  v_mfma_f32_16x16x32_bf16 v[92:95], a[172:175], v[44:47], v[92:95]
  s_waitcnt lgkmcnt(5)
  v_mfma_f32_16x16x32_bf16 v[64:67], a[176:179], v[48:51], v[64:67]
  ds_read_b128 v[40:43], v12 offset:24576
  v_mfma_f32_16x16x32_bf16 v[68:71], a[180:183], v[48:51], v[68:71]
  v_mfma_f32_16x16x32_bf16 v[80:83], a[184:187], v[48:51], v[80:83]
  v_mfma_f32_16x16x32_bf16 v[84:87], a[188:191], v[48:51], v[84:87]
  s_waitcnt lgkmcnt(5)
  v_mfma_f32_16x16x32_bf16 v[72:75], a[176:179], v[52:55], v[72:75]
  ds_read_b128 v[44:47], v13 offset:24576
  v_mfma_f32_16x16x32_bf16 v[76:79], a[180:183], v[52:55], v[76:79]
  v_mfma_f32_16x16x32_bf16 v[88:91], a[184:187], v[52:55], v[88:91]
  buffer_load_dwordx4 v[220:223], v21, s[4:7], s28 offen offset:3072 sc1
  v_mfma_f32_16x16x32_bf16 v[92:95], a[188:191], v[52:55], v[92:95]
  s_waitcnt lgkmcnt(5)
  v_mfma_f32_16x16x32_bf16 v[64:67], a[192:195], v[24:27], v[64:67]
  s_add_u32 s29, s19, 83890176
  ds_read_b128 v[48:51], v14 offset:24576
  v_mfma_f32_16x16x32_bf16 v[68:71], a[196:199], v[24:27], v[68:71]
  v_mfma_f32_16x16x32_bf16 v[80:83], a[200:203], v[24:27], v[80:83]
  v_mfma_f32_16x16x32_bf16 v[84:87], a[204:207], v[24:27], v[84:87]
  s_waitcnt lgkmcnt(5)
  v_mfma_f32_16x16x32_bf16 v[72:75], a[192:195], v[28:31], v[72:75]
  ds_read_b128 v[52:55], v15 offset:24576
  v_mfma_f32_16x16x32_bf16 v[76:79], a[196:199], v[28:31], v[76:79]
  v_mfma_f32_16x16x32_bf16 v[88:91], a[200:203], v[28:31], v[88:91]
  buffer_load_dwordx4 v[224:227], v21, s[4:7], s29 offen offset:0 sc1
  v_mfma_f32_16x16x32_bf16 v[92:95], a[204:207], v[28:31], v[92:95]
  s_waitcnt lgkmcnt(5)
  v_mfma_f32_16x16x32_bf16 v[64:67], a[208:211], v[32:35], v[64:67]
  v_mfma_f32_16x16x32_bf16 v[68:71], a[212:215], v[32:35], v[68:71]
  v_mfma_f32_16x16x32_bf16 v[80:83], a[216:219], v[32:35], v[80:83]
  v_mfma_f32_16x16x32_bf16 v[84:87], a[220:223], v[32:35], v[84:87]
  s_waitcnt lgkmcnt(4)
  v_mfma_f32_16x16x32_bf16 v[72:75], a[208:211], v[36:39], v[72:75]
  v_mfma_f32_16x16x32_bf16 v[76:79], a[212:215], v[36:39], v[76:79]
  v_xor_b32 v8, 0x8000, v8
  v_mfma_f32_16x16x32_bf16 v[88:91], a[216:219], v[36:39], v[88:91]
  buffer_load_dwordx4 v[228:231], v21, s[4:7], s29 offen offset:1024 sc1
  v_mfma_f32_16x16x32_bf16 v[92:95], a[220:223], v[36:39], v[92:95]
  s_waitcnt lgkmcnt(3)
  v_xor_b32 v9, 0x8000, v9
  v_mfma_f32_16x16x32_bf16 v[64:67], a[224:227], v[40:43], v[64:67]
  v_mfma_f32_16x16x32_bf16 v[68:71], a[228:231], v[40:43], v[68:71]
  v_xor_b32 v10, 0x8000, v10
  v_mfma_f32_16x16x32_bf16 v[80:83], a[232:235], v[40:43], v[80:83]
  v_mfma_f32_16x16x32_bf16 v[84:87], a[236:239], v[40:43], v[84:87]
  s_waitcnt lgkmcnt(2)
  v_xor_b32 v11, 0x8000, v11
  v_mfma_f32_16x16x32_bf16 v[72:75], a[224:227], v[44:47], v[72:75]
  v_mfma_f32_16x16x32_bf16 v[76:79], a[228:231], v[44:47], v[76:79]
  v_xor_b32 v12, 0x8000, v12
  v_mfma_f32_16x16x32_bf16 v[88:91], a[232:235], v[44:47], v[88:91]
  buffer_load_dwordx4 v[232:235], v21, s[4:7], s29 offen offset:2048 sc1
  v_mfma_f32_16x16x32_bf16 v[92:95], a[236:239], v[44:47], v[92:95]
  s_waitcnt lgkmcnt(1)
  v_xor_b32 v13, 0x8000, v13
  v_mfma_f32_16x16x32_bf16 v[64:67], a[240:243], v[48:51], v[64:67]
  v_mfma_f32_16x16x32_bf16 v[68:71], a[244:247], v[48:51], v[68:71]
  v_xor_b32 v14, 0x8000, v14
  v_mfma_f32_16x16x32_bf16 v[80:83], a[248:251], v[48:51], v[80:83]
  v_mfma_f32_16x16x32_bf16 v[84:87], a[252:255], v[48:51], v[84:87]
  s_waitcnt lgkmcnt(0)
  v_xor_b32 v15, 0x8000, v15
  v_mfma_f32_16x16x32_bf16 v[72:75], a[240:243], v[52:55], v[72:75]
  v_mfma_f32_16x16x32_bf16 v[76:79], a[244:247], v[52:55], v[76:79]
  v_xor_b32 v3, 0x8000, v3
  v_mfma_f32_16x16x32_bf16 v[88:91], a[248:251], v[52:55], v[88:91]
  buffer_load_dwordx4 v[236:239], v21, s[4:7], s29 offen offset:3072 sc1
  v_mfma_f32_16x16x32_bf16 v[92:95], a[252:255], v[52:55], v[92:95]
  s_cmp_gt_u32 s23, 0
  s_cbranch_scc1 F_top_63
  s_nop 2
  v_cvt_pk_bf16_f32 v128, v64, v65
  v_cvt_pk_bf16_f32 v129, v66, v67
  v_cvt_pk_bf16_f32 v130, v68, v69
  v_cvt_pk_bf16_f32 v131, v70, v71
  buffer_store_dwordx4 v[128:131], v22, s[4:7], s21 offen offset:0 sc1
  v_cvt_pk_bf16_f32 v132, v72, v73
  v_cvt_pk_bf16_f32 v133, v74, v75
  v_cvt_pk_bf16_f32 v134, v76, v77
  v_cvt_pk_bf16_f32 v135, v78, v79
  buffer_store_dwordx4 v[132:135], v22, s[4:7], s21 offen offset:256 sc1
  v_cvt_pk_bf16_f32 v136, v80, v81
  v_cvt_pk_bf16_f32 v137, v82, v83
  v_cvt_pk_bf16_f32 v138, v84, v85
  v_cvt_pk_bf16_f32 v139, v86, v87
  buffer_store_dwordx4 v[136:139], v22, s[4:7], s21 offen offset:2048 sc1
  v_cvt_pk_bf16_f32 v140, v88, v89
  v_cvt_pk_bf16_f32 v141, v90, v91
  v_cvt_pk_bf16_f32 v142, v92, v93
  v_cvt_pk_bf16_f32 v143, v94, v95
  buffer_store_dwordx4 v[140:143], v22, s[4:7], s21 offen offset:2304 sc1
  s_waitcnt vmcnt(0) lgkmcnt(0)
  s_barrier
  v_mov_b32 v144, s30
  v_min_u32 v145, 1, v0
  v_lshlrev_b32 v145, 30, v145
  buffer_store_dword v144, v145, s[4:7], s31 offen sc1
  s_branch M_done
M_team:
  s_mov_b32 s12, s77
  s_load_dwordx4 s[60:63], s[0:1], 64
  s_load_dwordx4 s[64:67], s[0:1], 80
  s_load_dwordx4 s[68:71], s[0:1], 120
  s_load_dwordx2 s[72:73], s[0:1], 56
  v_lshrrev_b32 v1, 6, v0
  v_and_b32 v20, 63, v0
  v_readfirstlane_b32 s13, v1
  s_waitcnt lgkmcnt(0)
  s_mov_b32 s8, s60
  s_and_b32 s9, s61, 0xffff
  s_mov_b32 s10, 0x400000
  s_mov_b32 s11, 0x20000
  s_mov_b32 s40, s62
  s_and_b32 s41, s63, 0xffff
  s_mov_b32 s42, 0x400000
  s_mov_b32 s43, 0x20000
  s_mov_b32 s44, s64
  s_and_b32 s45, s65, 0xffff
  s_mov_b32 s46, 0x400000
  s_mov_b32 s47, 0x20000
  s_mov_b32 s48, s66
  s_and_b32 s49, s67, 0xffff
  s_mov_b32 s50, 0x400000
  s_mov_b32 s51, 0x20000
  s_mov_b32 s4, s70
  s_and_b32 s5, s71, 0xffff
  s_mov_b32 s6, 0x10000000
  s_mov_b32 s7, 0x20000
  s_mov_b32 s76, s72
  s_and_b32 s77, s73, 0xffff
  s_mov_b32 s78, 0x2000
  s_mov_b32 s79, 0x20000
  s_mov_b32 s72, s68
  s_and_b32 s73, s69, 0xffff
  s_mov_b32 s74, 0x100
  s_mov_b32 s75, 0x20000
  s_mov_b64 s[52:53], s[68:69]
  s_mov_b64 s[58:59], s[70:71]
  s_mul_i32 s99, s12, 896
  s_add_u32 s99, s99, 148898048
  s_lshl_b32 s15, s12, 7
  s_add_u32 s15, s15, 148926464
  v_lshrrev_b32 v21, 4, v20
  v_and_b32 v22, 15, v20
  v_and_b32 v23, 1, v21
  v_lshrrev_b32 v24, 1, v21
  v_lshlrev_b32 v2, 4, v20
  s_lshl_b32 s36, s13, 10
  v_add_u32 v59, s36, v2
  s_lshl_b32 s37, s13, 15
  s_add_u32 s37, s37, 32768
  v_add_u32 v4, s37, v2
  v_lshrrev_b32 v25, 2, v20
  v_lshlrev_b32 v25, 13, v25
  v_and_b32 v1, 3, v20
  v_lshl_add_u32 v25, v1, 4, v25
  s_lshl_b32 s36, s13, 6
  s_lshl_b32 s38, s12, 8
  s_add_u32 s36, s36, s38
  v_add_u32 v25, s36, v25
  v_lshrrev_b32 v26, 3, v20
  v_lshlrev_b32 v26, 10, v26
  v_and_b32 v1, 7, v20
  v_lshl_add_u32 v26, v1, 4, v26
  s_lshl_b32 s36, s13, 7
  s_lshl_b32 s38, s12, 17
  s_add_u32 s36, s36, s38
  v_add_u32 v26, s36, v26
  v_bfe_u32 v29, v20, 2, 1
  v_bfe_u32 v30, v20, 3, 1
  v_and_b32 v31, 3, v20
  v_lshl_add_u32 v27, v21, 2, v29
  v_lshlrev_b32 v27, 6, v27
  v_lshl_add_u32 v27, v30, 5, v27
  v_lshl_add_u32 v27, v31, 3, v27
  v_add_u32 v27, s37, v27
  v_xor_b32 v36, 1, v30
  v_lshl_add_u32 v36, v36, 11, v27
  v_lshl_add_u32 v27, v30, 11, v27
  v_lshl_add_u32 v28, v23, 2, v24
  v_lshl_add_u32 v28, v28, 2, v29
  v_lshlrev_b32 v28, 7, v28
  v_lshl_add_u32 v28, v30, 6, v28
  v_lshl_add_u32 v28, v31, 4, v28
  v_add_u32 v28, s37, v28
  s_mov_b32 s39, s37
  s_xor_b32 s36, s13, 0
  s_lshl_b32 s36, s36, 15
  s_add_u32 m0, s39, 0
  s_add_u32 s37, s36, 0
  buffer_load_dwordx4 v26, s[48:51], s37 offen lds
  s_add_u32 m0, s39, 1024
  s_add_u32 s37, s36, 8192
  buffer_load_dwordx4 v26, s[48:51], s37 offen lds
  s_add_u32 m0, s39, 2048
  s_add_u32 s37, s36, 16384
  buffer_load_dwordx4 v26, s[48:51], s37 offen lds
  s_add_u32 m0, s39, 3072
  s_add_u32 s37, s36, 24576
  buffer_load_dwordx4 v26, s[48:51], s37 offen lds
  s_xor_b32 s36, s13, 0
  s_lshl_b32 s36, s36, 15
  s_add_u32 m0, s39, 4096
  s_add_u32 s37, s36, 512
  buffer_load_dwordx4 v26, s[48:51], s37 offen lds
  s_add_u32 m0, s39, 5120
  s_add_u32 s37, s36, 8704
  buffer_load_dwordx4 v26, s[48:51], s37 offen lds
  s_add_u32 m0, s39, 6144
  s_add_u32 s37, s36, 16896
  buffer_load_dwordx4 v26, s[48:51], s37 offen lds
  s_add_u32 m0, s39, 7168
  s_add_u32 s37, s36, 25088
  buffer_load_dwordx4 v26, s[48:51], s37 offen lds
  v_mov_b32 v0, 0x4444
  v_mov_b32 v1, 0xeeee
  v_cmp_lt_u32 vcc, 7, v22
  s_nop 1
  v_cndmask_b32 v32, v0, v1, vcc
  v_mov_b32 v0, v32
  v_and_b32 v32, 7, v20
  v_lshlrev_b32 v32, 4, v32
  v_lshl_add_u32 v11, v21, 7, v32
  v_xor_b32 v1, 128, v2
  v_lshl_add_u32 v33, v24, 4, v22
  s_lshl_b32 s36, s13, 5
  v_add_u32 v33, s36, v33
  v_lshlrev_b32 v33, 3, v33
  v_mul_u32_u24 v34, 1152, v23
  v_add_u32 v5, v33, v34
  v_bfe_u32 v33, v20, 2, 2
  v_lshl_add_u32 v33, v23, 2, v33
  v_lshl_add_u32 v33, v24, 4, v33
  v_lshlrev_b32 v33, 3, v33
  v_and_b32 v34, 1, v20
  v_mul_u32_u24 v34, 1152, v34
  v_add_u32 v6, v33, v34
  s_lshl_b32 s36, s13, 3
  v_lshrrev_b32 v33, 3, v20
  v_add_u32 v33, s36, v33
  v_mul_u32_u24 v34, 0, v33
  v_add_u32 v34, s12, v34
  v_and_b32 v34, 31, v34
  v_lshrrev_b32 v37, 1, v32
  v_lshl_add_u32 v33, v33, 13, v37
  v_lshl_add_u32 v7, v34, 7, v33
  v_and_b32 v37, 1, v20
  v_bfe_u32 v38, v20, 1, 1
  v_lshl_add_u32 v37, v29, 1, v37
  s_lshr_b32 s36, s12, 3
  s_lshl_b32 s36, s36, 10
  s_and_b32 s37, s12, 1
  s_lshl_b32 s37, s37, 9
  s_add_u32 s36, s36, s37
  s_and_b32 s37, s12, 6
  s_lshl_b32 s37, s37, 5
  s_add_u32 s36, s36, s37
  v_lshlrev_b32 v33, 4, v21
  v_lshl_add_u32 v33, v37, 2, v33
  v_lshl_add_u32 v33, v38, 8, v33
  v_lshl_add_u32 v33, v30, 30, v33
  v_add_u32 v8, s36, v33
  v_mov_b32 v3, v2
  v_mov_b32 v39, v21
  s_lshr_b32 s36, s12, 2
  s_lshl_b32 s36, s36, 6
  s_and_b32 s37, s12, 1
  s_lshl_b32 s37, s37, 5
  s_add_u32 s36, s36, s37
  s_and_b32 s37, s12, 2
  s_lshl_b32 s37, s37, 11
  s_add_u32 s36, s36, s37
  v_lshlrev_b32 v35, 10, v39
  v_lshl_add_u32 v35, v37, 2, v35
  v_lshl_add_u32 v35, v38, 4, v35
  v_add_u32 v35, s36, v35
  buffer_load_ushort v44, v35, s[76:79], 0 offen offset:0
  buffer_load_ushort v45, v35, s[76:79], 0 offen offset:2
  buffer_load_ushort v46, v35, s[76:79], 0 offen offset:512
  buffer_load_ushort v47, v35, s[76:79], 0 offen offset:514
  v_lshlrev_b32 v33, 4, v29
  v_mov_b32 v34, 0x3f80
  v_lshlrev_b32 v33, v33, v34
  v_and_b32 v34, 1, v20
  v_lshl_add_u32 v34, v34, 1, v30
  v_cmp_eq_u32 vcc, 0, v34
  s_nop 1
  v_cndmask_b32 v48, 0, v33, vcc
  v_cmp_eq_u32 vcc, 1, v34
  s_nop 1
  v_cndmask_b32 v49, 0, v33, vcc
  v_cmp_eq_u32 vcc, 2, v34
  s_nop 1
  v_cndmask_b32 v50, 0, v33, vcc
  v_cmp_eq_u32 vcc, 3, v34
  s_nop 1
  v_cndmask_b32 v51, 0, v33, vcc
  ds_write_b128 v2, v[48:51] offset:31232
  v_lshlrev_b32 v33, 9, v21
  s_lshl_b32 s36, s13, 11
  v_add_u32 v33, s36, v33
  v_lshl_add_u32 v10, v22, 4, v33
  v_lshl_add_u32 v33, v30, 8, v33
  v_add_u32 v9, v33, v32
  v_mov_b32 v12, 0x3f803f80
  v_mov_b32 v13, 0x3f803f80
  v_mov_b32 v14, 0x3f803f80
  v_mov_b32 v15, 0x3f803f80
  s_mov_b32 s2, 0x3f803f80
  s_mov_b32 s3, 0x3f803f80
  s_mov_b32 s98, 0
  v_and_b32 v33, 1, v20
  v_mul_u32_u24 v33, 128, v33
  v_min_u32 v34, 1, v20
  v_lshlrev_b32 v34, 30, v34
  s_cmp_eq_u32 s13, 3
  s_cselect_b64 vcc, -1, 0
  v_cndmask_b32 v19, v34, v33, vcc
  v_mov_b64 v[60:61], 0
  v_mov_b32 v62, 32256
  ds_write_b64 v62, v[60:61]
  s_mov_b32 s16, 0
  s_mov_b32 s17, -1
  s_mov_b32 s18, 0x3e0293ee
  s_mov_b32 s54, 0x2f800000
  s_mov_b32 s55, 0x28000000
  s_lshl_b32 s36, s13, 10
  s_add_u32 s31, s36, 8192
  s_add_u32 s32, s36, 12160
  s_add_u32 s33, s36, 16384
  s_add_u32 s34, s36, 20224
  s_lshl_b32 s36, s12, 19
  s_add_u32 s27, s36, 67108864
  s_add_u32 s28, s36, 83886080
  s_mul_i32 s36, s12, 4096
  s_add_u32 s29, s36, 135266304
  s_lshl_b32 s36, s12, 13
  s_add_u32 s22, s36, 144703488
  s_add_u32 s23, s36, 144707584
  s_mov_b32 s20, 144703488
  s_mov_b32 s21, 144707584
  v_mov_b32 v40, -1
  v_mov_b32 v41, -1
  v_mov_b32 v42, -1
  v_mov_b32 v43, -1
  s_lshl_b32 s36, s13, 13
  s_add_u32 s36, s36, 145752064
  s_add_u32 s37, s36, 4096
  buffer_store_dwordx4 v[40:43], v59, s[4:7], s22 offen sc1
  buffer_store_dwordx4 v[40:43], v59, s[4:7], s23 offen sc1
  buffer_store_dword v40, v8, s[4:7], s36 offen sc1
  buffer_store_dword v40, v8, s[4:7], s37 offen sc1
  v_mov_b32 v52, 0
  v_min_u32 v53, 1, v59
  v_lshlrev_b32 v53, 30, v53
  buffer_store_dword v52, v53, s[4:7], s15 offen sc1
  s_xor_b32 s36, s13, 1
  s_lshl_b32 s36, s36, 15
  s_add_u32 m0, s39, 8192
  s_add_u32 s37, s36, 0
  buffer_load_dwordx4 v26, s[48:51], s37 offen lds
  s_add_u32 m0, s39, 9216
  s_add_u32 s37, s36, 8192
  buffer_load_dwordx4 v26, s[48:51], s37 offen lds
  s_add_u32 m0, s39, 10240
  s_add_u32 s37, s36, 16384
  buffer_load_dwordx4 v26, s[48:51], s37 offen lds
  s_add_u32 m0, s39, 11264
  s_add_u32 s37, s36, 24576
  buffer_load_dwordx4 v26, s[48:51], s37 offen lds
  s_xor_b32 s36, s13, 1
  s_lshl_b32 s36, s36, 15
  s_add_u32 m0, s39, 12288
  s_add_u32 s37, s36, 512
  buffer_load_dwordx4 v26, s[48:51], s37 offen lds
  s_add_u32 m0, s39, 13312
  s_add_u32 s37, s36, 8704
  buffer_load_dwordx4 v26, s[48:51], s37 offen lds
  s_add_u32 m0, s39, 14336
  s_add_u32 s37, s36, 16896
  buffer_load_dwordx4 v26, s[48:51], s37 offen lds
  s_add_u32 m0, s39, 15360
  s_add_u32 s37, s36, 25088
  buffer_load_dwordx4 v26, s[48:51], s37 offen lds
  s_waitcnt vmcnt(21)
  ds_read_b64_tr_b16 a[160:161], v28 offset:0
  ds_read_b64_tr_b16 a[162:163], v28 offset:256
  ds_read_b64_tr_b16 a[164:165], v28 offset:1024
  ds_read_b64_tr_b16 a[166:167], v28 offset:1280
  ds_read_b64_tr_b16 a[168:169], v28 offset:8
  ds_read_b64_tr_b16 a[170:171], v28 offset:264
  ds_read_b64_tr_b16 a[172:173], v28 offset:1032
  ds_read_b64_tr_b16 a[174:175], v28 offset:1288
  s_waitcnt lgkmcnt(0)
  s_xor_b32 s36, s13, 2
  s_lshl_b32 s36, s36, 15
  s_add_u32 m0, s39, 0
  s_add_u32 s37, s36, 0
  buffer_load_dwordx4 v26, s[48:51], s37 offen lds
  s_add_u32 m0, s39, 1024
  s_add_u32 s37, s36, 8192
  buffer_load_dwordx4 v26, s[48:51], s37 offen lds
  s_add_u32 m0, s39, 2048
  s_add_u32 s37, s36, 16384
  buffer_load_dwordx4 v26, s[48:51], s37 offen lds
  s_add_u32 m0, s39, 3072
  s_add_u32 s37, s36, 24576
  buffer_load_dwordx4 v26, s[48:51], s37 offen lds
  s_waitcnt vmcnt(21)
  ds_read_b64_tr_b16 a[176:177], v28 offset:4096
  ds_read_b64_tr_b16 a[178:179], v28 offset:4352
  ds_read_b64_tr_b16 a[180:181], v28 offset:5120
  ds_read_b64_tr_b16 a[182:183], v28 offset:5376
  ds_read_b64_tr_b16 a[184:185], v28 offset:4104
  ds_read_b64_tr_b16 a[186:187], v28 offset:4360
  ds_read_b64_tr_b16 a[188:189], v28 offset:5128
  ds_read_b64_tr_b16 a[190:191], v28 offset:5384
  s_waitcnt lgkmcnt(0)
  s_xor_b32 s36, s13, 3
  s_lshl_b32 s36, s36, 15
  s_add_u32 m0, s39, 4096
  s_add_u32 s37, s36, 0
  buffer_load_dwordx4 v26, s[48:51], s37 offen lds
  s_add_u32 m0, s39, 5120
  s_add_u32 s37, s36, 8192
  buffer_load_dwordx4 v26, s[48:51], s37 offen lds
  s_add_u32 m0, s39, 6144
  s_add_u32 s37, s36, 16384
  buffer_load_dwordx4 v26, s[48:51], s37 offen lds
  s_add_u32 m0, s39, 7168
  s_add_u32 s37, s36, 24576
  buffer_load_dwordx4 v26, s[48:51], s37 offen lds
  s_waitcnt vmcnt(12)
  ds_read_b64_tr_b16 a[192:193], v28 offset:8192
  ds_read_b64_tr_b16 a[194:195], v28 offset:8448
  ds_read_b64_tr_b16 a[196:197], v28 offset:9216
  ds_read_b64_tr_b16 a[198:199], v28 offset:9472
  ds_read_b64_tr_b16 a[200:201], v28 offset:8200
  ds_read_b64_tr_b16 a[202:203], v28 offset:8456
  ds_read_b64_tr_b16 a[204:205], v28 offset:9224
  ds_read_b64_tr_b16 a[206:207], v28 offset:9480
  s_waitcnt lgkmcnt(0)
  s_xor_b32 s36, s13, 2
  s_lshl_b32 s36, s36, 19
  s_add_u32 m0, s39, 8192
  s_add_u32 s37, s36, 0
  buffer_load_dwordx4 v25, s[8:11], s37 offen lds
  s_add_u32 m0, s39, 9216
  s_add_u32 s37, s36, 131072
  buffer_load_dwordx4 v25, s[8:11], s37 offen lds
  s_add_u32 m0, s39, 10240
  s_add_u32 s37, s36, 262144
  buffer_load_dwordx4 v25, s[8:11], s37 offen lds
  s_add_u32 m0, s39, 11264
  s_add_u32 s37, s36, 393216
  buffer_load_dwordx4 v25, s[8:11], s37 offen lds
  s_barrier
  s_cmp_lg_u32 s13, 0
  s_cbranch_scc1 T_arm_81
  s_getreg_b32 s36, hwreg(HW_REG_XCC_ID, 0, 3)
  s_lshl_b32 s36, s36, 3
  s_lshl_b64 s[60:61], 1, s36
  s_mov_b32 s62, 1
  s_atomic_add_x2 s[60:61], s[52:53], 0
  s_atomic_add s62, s[52:53], 128
  v_lshl_or_b32 v44, v45, 16, v44
  v_lshl_or_b32 v46, v47, 16, v46
  v_min_u32 v44, -2, v44
  v_min_u32 v46, -2, v46
  s_mov_b32 s36, 145752064
  s_mov_b32 s37, 145756160
  buffer_store_dword v44, v8, s[4:7], s36 offen sc1
  buffer_store_dword v46, v8, s[4:7], s37 offen sc1
T_arm_81:
  s_waitcnt vmcnt(12)
  ds_read_b64_tr_b16 a[208:209], v28 offset:12288
  ds_read_b64_tr_b16 a[210:211], v28 offset:12544
  ds_read_b64_tr_b16 a[212:213], v28 offset:13312
  ds_read_b64_tr_b16 a[214:215], v28 offset:13568
  ds_read_b64_tr_b16 a[216:217], v28 offset:12296
  ds_read_b64_tr_b16 a[218:219], v28 offset:12552
  ds_read_b64_tr_b16 a[220:221], v28 offset:13320
  ds_read_b64_tr_b16 a[222:223], v28 offset:13576
  s_waitcnt lgkmcnt(0)
  s_xor_b32 s36, s13, 3
  s_lshl_b32 s36, s36, 19
  s_add_u32 m0, s39, 12288
  s_add_u32 s37, s36, 0
  buffer_load_dwordx4 v25, s[8:11], s37 offen lds
  s_add_u32 m0, s39, 13312
  s_add_u32 s37, s36, 131072
  buffer_load_dwordx4 v25, s[8:11], s37 offen lds
  s_add_u32 m0, s39, 14336
  s_add_u32 s37, s36, 262144
  buffer_load_dwordx4 v25, s[8:11], s37 offen lds
  s_add_u32 m0, s39, 15360
  s_add_u32 s37, s36, 393216
  buffer_load_dwordx4 v25, s[8:11], s37 offen lds
  s_waitcnt vmcnt(12)
  ds_read_b64_tr_b16 a[224:225], v28 offset:0
  ds_read_b64_tr_b16 a[226:227], v28 offset:256
  ds_read_b64_tr_b16 a[228:229], v28 offset:1024
  ds_read_b64_tr_b16 a[230:231], v28 offset:1280
  ds_read_b64_tr_b16 a[232:233], v28 offset:8
  ds_read_b64_tr_b16 a[234:235], v28 offset:264
  ds_read_b64_tr_b16 a[236:237], v28 offset:1032
  ds_read_b64_tr_b16 a[238:239], v28 offset:1288
  s_waitcnt lgkmcnt(0)
  s_xor_b32 s36, s13, 4
  s_lshl_b32 s36, s36, 19
  s_add_u32 m0, s39, 0
  s_add_u32 s37, s36, 0
  buffer_load_dwordx4 v25, s[8:11], s37 offen lds
  s_add_u32 m0, s39, 1024
  s_add_u32 s37, s36, 131072
  buffer_load_dwordx4 v25, s[8:11], s37 offen lds
  s_add_u32 m0, s39, 2048
  s_add_u32 s37, s36, 262144
  buffer_load_dwordx4 v25, s[8:11], s37 offen lds
  s_add_u32 m0, s39, 3072
  s_add_u32 s37, s36, 393216
  buffer_load_dwordx4 v25, s[8:11], s37 offen lds
  s_waitcnt vmcnt(12)
  ds_read_b64_tr_b16 a[240:241], v28 offset:4096
  ds_read_b64_tr_b16 a[242:243], v28 offset:4352
  ds_read_b64_tr_b16 a[244:245], v28 offset:5120
  ds_read_b64_tr_b16 a[246:247], v28 offset:5376
  ds_read_b64_tr_b16 a[248:249], v28 offset:4104
  ds_read_b64_tr_b16 a[250:251], v28 offset:4360
  ds_read_b64_tr_b16 a[252:253], v28 offset:5128
  ds_read_b64_tr_b16 a[254:255], v28 offset:5384
  s_waitcnt lgkmcnt(0)
  s_xor_b32 s36, s13, 5
  s_lshl_b32 s36, s36, 19
  s_add_u32 m0, s39, 4096
  s_add_u32 s37, s36, 0
  buffer_load_dwordx4 v25, s[8:11], s37 offen lds
  s_add_u32 m0, s39, 5120
  s_add_u32 s37, s36, 131072
  buffer_load_dwordx4 v25, s[8:11], s37 offen lds
  s_add_u32 m0, s39, 6144
  s_add_u32 s37, s36, 262144
  buffer_load_dwordx4 v25, s[8:11], s37 offen lds
  s_add_u32 m0, s39, 7168
  s_add_u32 s37, s36, 393216
  buffer_load_dwordx4 v25, s[8:11], s37 offen lds
  s_waitcnt vmcnt(12)
  ds_read_b64_tr_b16 v[160:161], v27 offset:8192
  ds_read_b64_tr_b16 v[162:163], v27 offset:8320
  ds_read_b64_tr_b16 v[164:165], v27 offset:9216
  ds_read_b64_tr_b16 v[166:167], v27 offset:9344
  ds_read_b64_tr_b16 v[168:169], v36 offset:8192
  ds_read_b64_tr_b16 v[170:171], v36 offset:8320
  ds_read_b64_tr_b16 v[172:173], v36 offset:9216
  ds_read_b64_tr_b16 v[174:175], v36 offset:9344
  s_waitcnt lgkmcnt(0)
  s_xor_b32 s36, s13, 4
  s_lshl_b32 s36, s36, 19
  s_add_u32 m0, s39, 8192
  s_add_u32 s37, s36, 0
  buffer_load_dwordx4 v25, s[40:43], s37 offen lds
  s_add_u32 m0, s39, 9216
  s_add_u32 s37, s36, 131072
  buffer_load_dwordx4 v25, s[40:43], s37 offen lds
  s_add_u32 m0, s39, 10240
  s_add_u32 s37, s36, 262144
  buffer_load_dwordx4 v25, s[40:43], s37 offen lds
  s_add_u32 m0, s39, 11264
  s_add_u32 s37, s36, 393216
  buffer_load_dwordx4 v25, s[40:43], s37 offen lds
  s_waitcnt vmcnt(12)
  ds_read_b64_tr_b16 v[192:193], v27 offset:12288
  ds_read_b64_tr_b16 v[194:195], v27 offset:12416
  ds_read_b64_tr_b16 v[196:197], v27 offset:13312
  ds_read_b64_tr_b16 v[198:199], v27 offset:13440
  ds_read_b64_tr_b16 v[200:201], v36 offset:12288
  ds_read_b64_tr_b16 v[202:203], v36 offset:12416
  ds_read_b64_tr_b16 v[204:205], v36 offset:13312
  ds_read_b64_tr_b16 v[206:207], v36 offset:13440
  s_waitcnt lgkmcnt(0)
  s_xor_b32 s36, s13, 5
  s_lshl_b32 s36, s36, 19
  s_add_u32 m0, s39, 12288
  s_add_u32 s37, s36, 0
  buffer_load_dwordx4 v25, s[40:43], s37 offen lds
  s_add_u32 m0, s39, 13312
  s_add_u32 s37, s36, 131072
  buffer_load_dwordx4 v25, s[40:43], s37 offen lds
  s_add_u32 m0, s39, 14336
  s_add_u32 s37, s36, 262144
  buffer_load_dwordx4 v25, s[40:43], s37 offen lds
  s_add_u32 m0, s39, 15360
  s_add_u32 s37, s36, 393216
  buffer_load_dwordx4 v25, s[40:43], s37 offen lds
  s_waitcnt vmcnt(12)
  ds_read_b64_tr_b16 v[224:225], v27 offset:0
  ds_read_b64_tr_b16 v[226:227], v27 offset:128
  ds_read_b64_tr_b16 v[228:229], v27 offset:1024
  ds_read_b64_tr_b16 v[230:231], v27 offset:1152
  ds_read_b64_tr_b16 v[232:233], v36 offset:0
  ds_read_b64_tr_b16 v[234:235], v36 offset:128
  ds_read_b64_tr_b16 v[236:237], v36 offset:1024
  ds_read_b64_tr_b16 v[238:239], v36 offset:1152
  s_waitcnt lgkmcnt(0)
  s_xor_b32 s36, s13, 4
  s_lshl_b32 s36, s36, 19
  s_add_u32 m0, s39, 0
  s_add_u32 s37, s36, 0
  buffer_load_dwordx4 v25, s[44:47], s37 offen lds
  s_add_u32 m0, s39, 1024
  s_add_u32 s37, s36, 131072
  buffer_load_dwordx4 v25, s[44:47], s37 offen lds
  s_add_u32 m0, s39, 2048
  s_add_u32 s37, s36, 262144
  buffer_load_dwordx4 v25, s[44:47], s37 offen lds
  s_add_u32 m0, s39, 3072
  s_add_u32 s37, s36, 393216
  buffer_load_dwordx4 v25, s[44:47], s37 offen lds
  s_waitcnt vmcnt(12)
  ds_read_b64_tr_b16 a[16:17], v27 offset:4096
  ds_read_b64_tr_b16 a[18:19], v27 offset:4224
  ds_read_b64_tr_b16 a[20:21], v27 offset:5120
  ds_read_b64_tr_b16 a[22:23], v27 offset:5248
  ds_read_b64_tr_b16 a[24:25], v36 offset:4096
  ds_read_b64_tr_b16 a[26:27], v36 offset:4224
  ds_read_b64_tr_b16 a[28:29], v36 offset:5120
  ds_read_b64_tr_b16 a[30:31], v36 offset:5248
  s_waitcnt lgkmcnt(0)
  s_xor_b32 s36, s13, 5
  s_lshl_b32 s36, s36, 19
  s_add_u32 m0, s39, 4096
  s_add_u32 s37, s36, 0
  buffer_load_dwordx4 v25, s[44:47], s37 offen lds
  s_add_u32 m0, s39, 5120
  s_add_u32 s37, s36, 131072
  buffer_load_dwordx4 v25, s[44:47], s37 offen lds
  s_add_u32 m0, s39, 6144
  s_add_u32 s37, s36, 262144
  buffer_load_dwordx4 v25, s[44:47], s37 offen lds
  s_add_u32 m0, s39, 7168
  s_add_u32 s37, s36, 393216
  buffer_load_dwordx4 v25, s[44:47], s37 offen lds
  s_waitcnt vmcnt(12)
  ds_read_b64_tr_b16 v[240:241], v27 offset:8192
  ds_read_b64_tr_b16 v[242:243], v27 offset:8320
  ds_read_b64_tr_b16 v[244:245], v27 offset:9216
  ds_read_b64_tr_b16 v[246:247], v27 offset:9344
  ds_read_b64_tr_b16 v[248:249], v36 offset:8192
  ds_read_b64_tr_b16 v[250:251], v36 offset:8320
  ds_read_b64_tr_b16 v[252:253], v36 offset:9216
  ds_read_b64_tr_b16 v[254:255], v36 offset:9344
  s_waitcnt lgkmcnt(0)
  s_xor_b32 s36, s13, 6
  s_lshl_b32 s36, s36, 19
  s_add_u32 m0, s39, 8192
  s_add_u32 s37, s36, 0
  buffer_load_dwordx4 v25, s[8:11], s37 offen lds
  s_add_u32 m0, s39, 9216
  s_add_u32 s37, s36, 131072
  buffer_load_dwordx4 v25, s[8:11], s37 offen lds
  s_add_u32 m0, s39, 10240
  s_add_u32 s37, s36, 262144
  buffer_load_dwordx4 v25, s[8:11], s37 offen lds
  s_add_u32 m0, s39, 11264
  s_add_u32 s37, s36, 393216
  buffer_load_dwordx4 v25, s[8:11], s37 offen lds
  s_waitcnt vmcnt(12)
  ds_read_b64_tr_b16 a[32:33], v27 offset:12288
  ds_read_b64_tr_b16 a[34:35], v27 offset:12416
  ds_read_b64_tr_b16 a[36:37], v27 offset:13312
  ds_read_b64_tr_b16 a[38:39], v27 offset:13440
  ds_read_b64_tr_b16 a[40:41], v36 offset:12288
  ds_read_b64_tr_b16 a[42:43], v36 offset:12416
  ds_read_b64_tr_b16 a[44:45], v36 offset:13312
  ds_read_b64_tr_b16 a[46:47], v36 offset:13440
  s_waitcnt lgkmcnt(0)
  s_xor_b32 s36, s13, 7
  s_lshl_b32 s36, s36, 19
  s_add_u32 m0, s39, 12288
  s_add_u32 s37, s36, 0
  buffer_load_dwordx4 v25, s[8:11], s37 offen lds
  s_add_u32 m0, s39, 13312
  s_add_u32 s37, s36, 131072
  buffer_load_dwordx4 v25, s[8:11], s37 offen lds
  s_add_u32 m0, s39, 14336
  s_add_u32 s37, s36, 262144
  buffer_load_dwordx4 v25, s[8:11], s37 offen lds
  s_add_u32 m0, s39, 15360
  s_add_u32 s37, s36, 393216
  buffer_load_dwordx4 v25, s[8:11], s37 offen lds
  s_waitcnt vmcnt(12)
  ds_read_b64_tr_b16 a[0:1], v27 offset:0
  ds_read_b64_tr_b16 a[2:3], v27 offset:128
  ds_read_b64_tr_b16 a[4:5], v27 offset:1024
  ds_read_b64_tr_b16 a[6:7], v27 offset:1152
  ds_read_b64_tr_b16 a[8:9], v36 offset:0
  ds_read_b64_tr_b16 a[10:11], v36 offset:128
  ds_read_b64_tr_b16 a[12:13], v36 offset:1024
  ds_read_b64_tr_b16 a[14:15], v36 offset:1152
  s_waitcnt lgkmcnt(0)
  s_xor_b32 s36, s13, 6
  s_lshl_b32 s36, s36, 19
  s_add_u32 m0, s39, 0
  s_add_u32 s37, s36, 0
  buffer_load_dwordx4 v25, s[40:43], s37 offen lds
  s_add_u32 m0, s39, 1024
  s_add_u32 s37, s36, 131072
  buffer_load_dwordx4 v25, s[40:43], s37 offen lds
  s_add_u32 m0, s39, 2048
  s_add_u32 s37, s36, 262144
  buffer_load_dwordx4 v25, s[40:43], s37 offen lds
  s_add_u32 m0, s39, 3072
  s_add_u32 s37, s36, 393216
  buffer_load_dwordx4 v25, s[40:43], s37 offen lds
  s_waitcnt vmcnt(12)
  ds_read_b64_tr_b16 a[48:49], v27 offset:4096
  ds_read_b64_tr_b16 a[50:51], v27 offset:4224
  ds_read_b64_tr_b16 a[52:53], v27 offset:5120
  ds_read_b64_tr_b16 a[54:55], v27 offset:5248
  ds_read_b64_tr_b16 a[56:57], v36 offset:4096
  ds_read_b64_tr_b16 a[58:59], v36 offset:4224
  ds_read_b64_tr_b16 a[60:61], v36 offset:5120
  ds_read_b64_tr_b16 a[62:63], v36 offset:5248
  s_waitcnt lgkmcnt(0)
  s_xor_b32 s36, s13, 7
  s_lshl_b32 s36, s36, 19
  s_add_u32 m0, s39, 4096
  s_add_u32 s37, s36, 0
  buffer_load_dwordx4 v25, s[40:43], s37 offen lds
  s_add_u32 m0, s39, 5120
  s_add_u32 s37, s36, 131072
  buffer_load_dwordx4 v25, s[40:43], s37 offen lds
  s_add_u32 m0, s39, 6144
  s_add_u32 s37, s36, 262144
  buffer_load_dwordx4 v25, s[40:43], s37 offen lds
  s_add_u32 m0, s39, 7168
  s_add_u32 s37, s36, 393216
  buffer_load_dwordx4 v25, s[40:43], s37 offen lds
  s_waitcnt vmcnt(12)
  ds_read_b64_tr_b16 a[64:65], v27 offset:8192
  ds_read_b64_tr_b16 a[66:67], v27 offset:8320
  ds_read_b64_tr_b16 a[68:69], v27 offset:9216
  ds_read_b64_tr_b16 a[70:71], v27 offset:9344
  ds_read_b64_tr_b16 a[72:73], v36 offset:8192
  ds_read_b64_tr_b16 a[74:75], v36 offset:8320
  ds_read_b64_tr_b16 a[76:77], v36 offset:9216
  ds_read_b64_tr_b16 a[78:79], v36 offset:9344
  s_waitcnt lgkmcnt(0)
  s_xor_b32 s36, s13, 6
  s_lshl_b32 s36, s36, 19
  s_add_u32 m0, s39, 8192
  s_add_u32 s37, s36, 0
  buffer_load_dwordx4 v25, s[44:47], s37 offen lds
  s_add_u32 m0, s39, 9216
  s_add_u32 s37, s36, 131072
  buffer_load_dwordx4 v25, s[44:47], s37 offen lds
  s_add_u32 m0, s39, 10240
  s_add_u32 s37, s36, 262144
  buffer_load_dwordx4 v25, s[44:47], s37 offen lds
  s_add_u32 m0, s39, 11264
  s_add_u32 s37, s36, 393216
  buffer_load_dwordx4 v25, s[44:47], s37 offen lds
  s_waitcnt vmcnt(12)
  ds_read_b64_tr_b16 a[112:113], v27 offset:12288
  ds_read_b64_tr_b16 a[114:115], v27 offset:12416
  ds_read_b64_tr_b16 a[116:117], v27 offset:13312
  ds_read_b64_tr_b16 a[118:119], v27 offset:13440
  ds_read_b64_tr_b16 a[120:121], v36 offset:12288
  ds_read_b64_tr_b16 a[122:123], v36 offset:12416
  ds_read_b64_tr_b16 a[124:125], v36 offset:13312
  ds_read_b64_tr_b16 a[126:127], v36 offset:13440
  s_waitcnt lgkmcnt(0)
  s_xor_b32 s36, s13, 7
  s_lshl_b32 s36, s36, 19
  s_add_u32 m0, s39, 12288
  s_add_u32 s37, s36, 0
  buffer_load_dwordx4 v25, s[44:47], s37 offen lds
  s_add_u32 m0, s39, 13312
  s_add_u32 s37, s36, 131072
  buffer_load_dwordx4 v25, s[44:47], s37 offen lds
  s_add_u32 m0, s39, 14336
  s_add_u32 s37, s36, 262144
  buffer_load_dwordx4 v25, s[44:47], s37 offen lds
  s_add_u32 m0, s39, 15360
  s_add_u32 s37, s36, 393216
  buffer_load_dwordx4 v25, s[44:47], s37 offen lds
  s_waitcnt vmcnt(12)
  ds_read_b64_tr_b16 a[80:81], v27 offset:0
  ds_read_b64_tr_b16 a[82:83], v27 offset:128
  ds_read_b64_tr_b16 a[84:85], v27 offset:1024
  ds_read_b64_tr_b16 a[86:87], v27 offset:1152
  ds_read_b64_tr_b16 a[88:89], v36 offset:0
  ds_read_b64_tr_b16 a[90:91], v36 offset:128
  ds_read_b64_tr_b16 a[92:93], v36 offset:1024
  ds_read_b64_tr_b16 a[94:95], v36 offset:1152
  s_waitcnt lgkmcnt(0)
  s_xor_b32 s36, s13, 1
  s_lshl_b32 s36, s36, 19
  s_add_u32 m0, s39, 16384
  s_add_u32 s37, s36, 0
  buffer_load_dwordx4 v25, s[8:11], s37 offen lds
  s_add_u32 m0, s39, 17408
  s_add_u32 s37, s36, 131072
  buffer_load_dwordx4 v25, s[8:11], s37 offen lds
  s_add_u32 m0, s39, 18432
  s_add_u32 s37, s36, 262144
  buffer_load_dwordx4 v25, s[8:11], s37 offen lds
  s_add_u32 m0, s39, 19456
  s_add_u32 s37, s36, 393216
  buffer_load_dwordx4 v25, s[8:11], s37 offen lds
  s_waitcnt vmcnt(12)
  ds_read_b64_tr_b16 a[128:129], v27 offset:4096
  ds_read_b64_tr_b16 a[130:131], v27 offset:4224
  ds_read_b64_tr_b16 a[132:133], v27 offset:5120
  ds_read_b64_tr_b16 a[134:135], v27 offset:5248
  ds_read_b64_tr_b16 a[136:137], v36 offset:4096
  ds_read_b64_tr_b16 a[138:139], v36 offset:4224
  ds_read_b64_tr_b16 a[140:141], v36 offset:5120
  ds_read_b64_tr_b16 a[142:143], v36 offset:5248
  s_waitcnt lgkmcnt(0)
  s_xor_b32 s36, s13, 0
  s_lshl_b32 s36, s36, 19
  s_add_u32 m0, s39, 0
  s_add_u32 s37, s36, 0
  buffer_load_dwordx4 v25, s[8:11], s37 offen lds
  s_add_u32 m0, s39, 1024
  s_add_u32 s37, s36, 131072
  buffer_load_dwordx4 v25, s[8:11], s37 offen lds
  s_add_u32 m0, s39, 2048
  s_add_u32 s37, s36, 262144
  buffer_load_dwordx4 v25, s[8:11], s37 offen lds
  s_add_u32 m0, s39, 3072
  s_add_u32 s37, s36, 393216
  buffer_load_dwordx4 v25, s[8:11], s37 offen lds
  s_waitcnt vmcnt(12)
  ds_read_b64_tr_b16 a[96:97], v27 offset:8192
  ds_read_b64_tr_b16 a[98:99], v27 offset:8320
  ds_read_b64_tr_b16 a[100:101], v27 offset:9216
  ds_read_b64_tr_b16 a[102:103], v27 offset:9344
  ds_read_b64_tr_b16 a[104:105], v36 offset:8192
  ds_read_b64_tr_b16 a[106:107], v36 offset:8320
  ds_read_b64_tr_b16 a[108:109], v36 offset:9216
  ds_read_b64_tr_b16 a[110:111], v36 offset:9344
  s_waitcnt lgkmcnt(0)
  s_xor_b32 s36, s13, 1
  s_lshl_b32 s36, s36, 19
  s_add_u32 m0, s39, 8192
  s_add_u32 s37, s36, 0
  buffer_load_dwordx4 v25, s[40:43], s37 offen lds
  s_add_u32 m0, s39, 9216
  s_add_u32 s37, s36, 131072
  buffer_load_dwordx4 v25, s[40:43], s37 offen lds
  s_add_u32 m0, s39, 10240
  s_add_u32 s37, s36, 262144
  buffer_load_dwordx4 v25, s[40:43], s37 offen lds
  s_add_u32 m0, s39, 11264
  s_add_u32 s37, s36, 393216
  buffer_load_dwordx4 v25, s[40:43], s37 offen lds
  s_waitcnt vmcnt(12)
  ds_read_b64_tr_b16 a[144:145], v27 offset:12288
  ds_read_b64_tr_b16 a[146:147], v27 offset:12416
  ds_read_b64_tr_b16 a[148:149], v27 offset:13312
  ds_read_b64_tr_b16 a[150:151], v27 offset:13440
  ds_read_b64_tr_b16 a[152:153], v36 offset:12288
  ds_read_b64_tr_b16 a[154:155], v36 offset:12416
  ds_read_b64_tr_b16 a[156:157], v36 offset:13312
  ds_read_b64_tr_b16 a[158:159], v36 offset:13440
  s_waitcnt lgkmcnt(0)
  s_xor_b32 s36, s13, 0
  s_lshl_b32 s36, s36, 19
  s_add_u32 m0, s39, 4096
  s_add_u32 s37, s36, 0
  buffer_load_dwordx4 v25, s[40:43], s37 offen lds
  s_add_u32 m0, s39, 5120
  s_add_u32 s37, s36, 131072
  buffer_load_dwordx4 v25, s[40:43], s37 offen lds
  s_add_u32 m0, s39, 6144
  s_add_u32 s37, s36, 262144
  buffer_load_dwordx4 v25, s[40:43], s37 offen lds
  s_add_u32 m0, s39, 7168
  s_add_u32 s37, s36, 393216
  buffer_load_dwordx4 v25, s[40:43], s37 offen lds
  s_waitcnt vmcnt(12)
  ds_read_b64_tr_b16 v[128:129], v27 offset:16384
  ds_read_b64_tr_b16 v[130:131], v27 offset:16512
  ds_read_b64_tr_b16 v[132:133], v27 offset:17408
  ds_read_b64_tr_b16 v[134:135], v27 offset:17536
  ds_read_b64_tr_b16 v[136:137], v36 offset:16384
  ds_read_b64_tr_b16 v[138:139], v36 offset:16512
  ds_read_b64_tr_b16 v[140:141], v36 offset:17408
  ds_read_b64_tr_b16 v[142:143], v36 offset:17536
  s_waitcnt lgkmcnt(0)
  s_xor_b32 s36, s13, 2
  s_lshl_b32 s36, s36, 19
  s_add_u32 m0, s39, 12288
  s_add_u32 s37, s36, 0
  buffer_load_dwordx4 v25, s[40:43], s37 offen lds
  s_add_u32 m0, s39, 13312
  s_add_u32 s37, s36, 131072
  buffer_load_dwordx4 v25, s[40:43], s37 offen lds
  s_add_u32 m0, s39, 14336
  s_add_u32 s37, s36, 262144
  buffer_load_dwordx4 v25, s[40:43], s37 offen lds
  s_add_u32 m0, s39, 15360
  s_add_u32 s37, s36, 393216
  buffer_load_dwordx4 v25, s[40:43], s37 offen lds
  s_waitcnt vmcnt(12)
  ds_read_b64_tr_b16 v[64:65], v27 offset:0
  ds_read_b64_tr_b16 v[66:67], v27 offset:128
  ds_read_b64_tr_b16 v[68:69], v27 offset:1024
  ds_read_b64_tr_b16 v[70:71], v27 offset:1152
  ds_read_b64_tr_b16 v[72:73], v36 offset:0
  ds_read_b64_tr_b16 v[74:75], v36 offset:128
  ds_read_b64_tr_b16 v[76:77], v36 offset:1024
  ds_read_b64_tr_b16 v[78:79], v36 offset:1152
  s_waitcnt lgkmcnt(0)
  ds_write_b128 v4, v[64:67] offset:0
  ds_write_b128 v4, v[68:71] offset:1024
  ds_write_b128 v4, v[72:75] offset:2048
  ds_write_b128 v4, v[76:79] offset:3072
  s_waitcnt lgkmcnt(0)
  s_xor_b32 s36, s13, 3
  s_lshl_b32 s36, s36, 19
  s_add_u32 m0, s39, 16384
  s_add_u32 s37, s36, 0
  buffer_load_dwordx4 v25, s[40:43], s37 offen lds
  s_add_u32 m0, s39, 17408
  s_add_u32 s37, s36, 131072
  buffer_load_dwordx4 v25, s[40:43], s37 offen lds
  s_add_u32 m0, s39, 18432
  s_add_u32 s37, s36, 262144
  buffer_load_dwordx4 v25, s[40:43], s37 offen lds
  s_add_u32 m0, s39, 19456
  s_add_u32 s37, s36, 393216
  buffer_load_dwordx4 v25, s[40:43], s37 offen lds
  s_waitcnt vmcnt(12)
  ds_read_b64_tr_b16 v[144:145], v27 offset:8192
  ds_read_b64_tr_b16 v[146:147], v27 offset:8320
  ds_read_b64_tr_b16 v[148:149], v27 offset:9216
  ds_read_b64_tr_b16 v[150:151], v27 offset:9344
  ds_read_b64_tr_b16 v[152:153], v36 offset:8192
  ds_read_b64_tr_b16 v[154:155], v36 offset:8320
  ds_read_b64_tr_b16 v[156:157], v36 offset:9216
  ds_read_b64_tr_b16 v[158:159], v36 offset:9344
  s_waitcnt lgkmcnt(0)
  s_xor_b32 s36, s13, 3
  s_lshl_b32 s36, s36, 19
  s_add_u32 m0, s39, 24576
  s_add_u32 s37, s36, 0
  buffer_load_dwordx4 v25, s[44:47], s37 offen lds
  s_add_u32 m0, s39, 25600
  s_add_u32 s37, s36, 131072
  buffer_load_dwordx4 v25, s[44:47], s37 offen lds
  s_add_u32 m0, s39, 26624
  s_add_u32 s37, s36, 262144
  buffer_load_dwordx4 v25, s[44:47], s37 offen lds
  s_add_u32 m0, s39, 27648
  s_add_u32 s37, s36, 393216
  buffer_load_dwordx4 v25, s[44:47], s37 offen lds
  buffer_load_dwordx2 v[54:55], off, s[72:75], 0 sc1
  buffer_load_dword v56, off, s[72:75], 0 offset:128 sc1
  s_waitcnt vmcnt(14)
  ds_read_b64_tr_b16 v[64:65], v27 offset:4096
  ds_read_b64_tr_b16 v[66:67], v27 offset:4224
  ds_read_b64_tr_b16 v[68:69], v27 offset:5120
  ds_read_b64_tr_b16 v[70:71], v27 offset:5248
  ds_read_b64_tr_b16 v[72:73], v36 offset:4096
  ds_read_b64_tr_b16 v[74:75], v36 offset:4224
  ds_read_b64_tr_b16 v[76:77], v36 offset:5120
  ds_read_b64_tr_b16 v[78:79], v36 offset:5248
  s_waitcnt lgkmcnt(0)
  ds_write_b128 v4, v[64:67] offset:4096
  ds_write_b128 v4, v[68:71] offset:5120
  ds_write_b128 v4, v[72:75] offset:6144
  ds_write_b128 v4, v[76:79] offset:7168
  s_waitcnt lgkmcnt(0)
  s_xor_b32 s36, s13, 2
  s_lshl_b32 s36, s36, 19
  s_add_u32 m0, s39, 20480
  s_add_u32 s37, s36, 0
  buffer_load_dwordx4 v25, s[44:47], s37 offen lds
  s_add_u32 m0, s39, 21504
  s_add_u32 s37, s36, 131072
  buffer_load_dwordx4 v25, s[44:47], s37 offen lds
  s_add_u32 m0, s39, 22528
  s_add_u32 s37, s36, 262144
  buffer_load_dwordx4 v25, s[44:47], s37 offen lds
  s_add_u32 m0, s39, 23552
  s_add_u32 s37, s36, 393216
  buffer_load_dwordx4 v25, s[44:47], s37 offen lds
  s_waitcnt vmcnt(14)
  ds_read_b64_tr_b16 v[176:177], v27 offset:12288
  ds_read_b64_tr_b16 v[178:179], v27 offset:12416
  ds_read_b64_tr_b16 v[180:181], v27 offset:13312
  ds_read_b64_tr_b16 v[182:183], v27 offset:13440
  ds_read_b64_tr_b16 v[184:185], v36 offset:12288
  ds_read_b64_tr_b16 v[186:187], v36 offset:12416
  ds_read_b64_tr_b16 v[188:189], v36 offset:13312
  ds_read_b64_tr_b16 v[190:191], v36 offset:13440
  s_waitcnt lgkmcnt(0)
  s_xor_b32 s36, s13, 0
  s_lshl_b32 s36, s36, 19
  s_add_u32 m0, s39, 8192
  s_add_u32 s37, s36, 0
  buffer_load_dwordx4 v25, s[44:47], s37 offen lds
  s_add_u32 m0, s39, 9216
  s_add_u32 s37, s36, 131072
  buffer_load_dwordx4 v25, s[44:47], s37 offen lds
  s_add_u32 m0, s39, 10240
  s_add_u32 s37, s36, 262144
  buffer_load_dwordx4 v25, s[44:47], s37 offen lds
  s_add_u32 m0, s39, 11264
  s_add_u32 s37, s36, 393216
  buffer_load_dwordx4 v25, s[44:47], s37 offen lds
  s_waitcnt vmcnt(14)
  ds_read_b64_tr_b16 v[64:65], v27 offset:16384
  ds_read_b64_tr_b16 v[66:67], v27 offset:16512
  ds_read_b64_tr_b16 v[68:69], v27 offset:17408
  ds_read_b64_tr_b16 v[70:71], v27 offset:17536
  ds_read_b64_tr_b16 v[72:73], v36 offset:16384
  ds_read_b64_tr_b16 v[74:75], v36 offset:16512
  ds_read_b64_tr_b16 v[76:77], v36 offset:17408
  ds_read_b64_tr_b16 v[78:79], v36 offset:17536
  s_waitcnt lgkmcnt(0)
  ds_write_b128 v4, v[64:67] offset:16384
  ds_write_b128 v4, v[68:71] offset:17408
  ds_write_b128 v4, v[72:75] offset:18432
  ds_write_b128 v4, v[76:79] offset:19456
  s_waitcnt lgkmcnt(0)
  s_xor_b32 s36, s13, 1
  s_lshl_b32 s36, s36, 19
  s_add_u32 m0, s39, 12288
  s_add_u32 s37, s36, 0
  buffer_load_dwordx4 v25, s[44:47], s37 offen lds
  s_add_u32 m0, s39, 13312
  s_add_u32 s37, s36, 131072
  buffer_load_dwordx4 v25, s[44:47], s37 offen lds
  s_add_u32 m0, s39, 14336
  s_add_u32 s37, s36, 262144
  buffer_load_dwordx4 v25, s[44:47], s37 offen lds
  s_add_u32 m0, s39, 15360
  s_add_u32 s37, s36, 393216
  buffer_load_dwordx4 v25, s[44:47], s37 offen lds
  s_waitcnt vmcnt(14)
  ds_read_b64_tr_b16 v[208:209], v27 offset:24576
  ds_read_b64_tr_b16 v[210:211], v27 offset:24704
  ds_read_b64_tr_b16 v[212:213], v27 offset:25600
  ds_read_b64_tr_b16 v[214:215], v27 offset:25728
  ds_read_b64_tr_b16 v[216:217], v36 offset:24576
  ds_read_b64_tr_b16 v[218:219], v36 offset:24704
  ds_read_b64_tr_b16 v[220:221], v36 offset:25600
  ds_read_b64_tr_b16 v[222:223], v36 offset:25728
  s_waitcnt lgkmcnt(0)
  s_xor_b32 s36, s13, 2
  s_lshl_b32 s36, s36, 15
  s_add_u32 m0, s39, 24576
  s_add_u32 s37, s36, 512
  buffer_load_dwordx4 v26, s[48:51], s37 offen lds
  s_add_u32 m0, s39, 25600
  s_add_u32 s37, s36, 8704
  buffer_load_dwordx4 v26, s[48:51], s37 offen lds
  s_add_u32 m0, s39, 26624
  s_add_u32 s37, s36, 16896
  buffer_load_dwordx4 v26, s[48:51], s37 offen lds
  s_add_u32 m0, s39, 27648
  s_add_u32 s37, s36, 25088
  buffer_load_dwordx4 v26, s[48:51], s37 offen lds
  s_waitcnt vmcnt(12)
  ds_read_b64_tr_b16 v[64:65], v27 offset:20480
  ds_read_b64_tr_b16 v[66:67], v27 offset:20608
  ds_read_b64_tr_b16 v[68:69], v27 offset:21504
  ds_read_b64_tr_b16 v[70:71], v27 offset:21632
  ds_read_b64_tr_b16 v[72:73], v36 offset:20480
  ds_read_b64_tr_b16 v[74:75], v36 offset:20608
  ds_read_b64_tr_b16 v[76:77], v36 offset:21504
  ds_read_b64_tr_b16 v[78:79], v36 offset:21632
  s_waitcnt lgkmcnt(0)
  ds_write_b128 v4, v[64:67] offset:20480
  ds_write_b128 v4, v[68:71] offset:21504
  ds_write_b128 v4, v[72:75] offset:22528
  ds_write_b128 v4, v[76:79] offset:23552
  s_waitcnt lgkmcnt(0)
  s_xor_b32 s36, s13, 3
  s_lshl_b32 s36, s36, 15
  s_add_u32 m0, s39, 28672
  s_add_u32 s37, s36, 512
  buffer_load_dwordx4 v26, s[48:51], s37 offen lds
  s_add_u32 m0, s39, 29696
  s_add_u32 s37, s36, 8704
  buffer_load_dwordx4 v26, s[48:51], s37 offen lds
  s_add_u32 m0, s39, 30720
  s_add_u32 s37, s36, 16896
  buffer_load_dwordx4 v26, s[48:51], s37 offen lds
  s_add_u32 m0, s39, 31744
  s_add_u32 s37, s36, 25088
  buffer_load_dwordx4 v26, s[48:51], s37 offen lds
  s_mov_b32 s19, 0
  s_branch T_arrgo_83
T_arr_82:
  s_add_u32 s19, s19, 1
  s_cmp_gt_u32 s19, 32768
  s_cbranch_scc1 M_exit
  buffer_load_dwordx2 v[54:55], off, s[72:75], 0 sc1
  buffer_load_dword v56, off, s[72:75], 0 offset:128 sc1
  s_waitcnt vmcnt(0)
T_arrgo_83:
  v_sad_u8 v57, v54, 0, 0
  v_sad_u8 v57, v55, 0, v57
  v_or_b32 v58, v54, v55
  v_cmp_gt_u32 vcc, 32, v57
  s_cbranch_vccnz T_arr_82
  v_cmp_gt_u32 vcc, 0x100, v56
  s_cbranch_vccnz T_arr_82
  v_readfirstlane_b32 s36, v58
  s_nop 0
  s_and_b32 s36, s36, 0x20202020
  s_cselect_b32 s56, 0, 1
  s_mov_b32 s14, -1
  s_mov_b32 s30, -1
  s_mov_b32 s19, 0
  s_branch T_kvok_85
T_kv_84:
  s_sleep 4
  s_add_u32 s19, s19, 1
  s_cmp_gt_u32 s19, 32768
  s_cbranch_scc1 M_exit
T_kvok_85:
  s_add_u32 s39, s99, 128
  s_mov_b32 s38, 0
  s_mov_b32 s37, 0
  s_atomic_or s38, s[58:59], s99 glc
  s_atomic_or s37, s[58:59], s39 glc
  s_waitcnt lgkmcnt(0)
  s_add_u32 s37, s37, 30
  s_cmp_ge_u32 s38, 30
  s_cselect_b32 s38, s37, s38
  s_cmp_ge_u32 s38, 64
  s_cselect_b32 s38, 100, s38
  s_sub_u32 s38, s38, 1
  s_max_i32 s30, s30, s38
  s_cmp_ge_i32 s14, s30
  s_cbranch_scc1 T_kv_84
  s_mov_b32 m0, s31
  s_nop 0
  buffer_load_dwordx4 v9, s[4:7], s27 offen sc1 lds
  s_mov_b32 m0, s32
  s_nop 0
  buffer_load_dwordx4 v9, s[4:7], s27 offen offset:128 sc1 lds
  s_mov_b32 m0, s33
  s_nop 0
  buffer_load_dwordx4 v10, s[4:7], s28 offen sc1 lds
  s_mov_b32 m0, s34
  s_nop 0
  buffer_load_dwordx4 v10, s[4:7], s28 offen offset:256 sc1 lds
  s_add_u32 s27, s27, 8192
  s_add_u32 s28, s28, 8192
  s_lshl_b32 s36, s12, 10
  s_add_u32 s36, s36, 145752064
  buffer_load_dwordx4 v[40:43], v2, s[4:7], s36 offen sc1
  s_waitcnt vmcnt(17)
  ds_read_b64_tr_b16 v[64:65], v27 offset:8192
  ds_read_b64_tr_b16 v[66:67], v27 offset:8320
  ds_read_b64_tr_b16 v[68:69], v27 offset:9216
  ds_read_b64_tr_b16 v[70:71], v27 offset:9344
  ds_read_b64_tr_b16 v[72:73], v36 offset:8192
  ds_read_b64_tr_b16 v[74:75], v36 offset:8320
  ds_read_b64_tr_b16 v[76:77], v36 offset:9216
  ds_read_b64_tr_b16 v[78:79], v36 offset:9344
  s_waitcnt lgkmcnt(0)
  ds_write_b128 v4, v[64:67] offset:8192
  ds_write_b128 v4, v[68:71] offset:9216
  ds_write_b128 v4, v[72:75] offset:10240
  ds_write_b128 v4, v[76:79] offset:11264
  s_waitcnt lgkmcnt(0)
  s_waitcnt vmcnt(13)
  ds_read_b64_tr_b16 v[64:65], v27 offset:12288
  ds_read_b64_tr_b16 v[66:67], v27 offset:12416
  ds_read_b64_tr_b16 v[68:69], v27 offset:13312
  ds_read_b64_tr_b16 v[70:71], v27 offset:13440
  ds_read_b64_tr_b16 v[72:73], v36 offset:12288
  ds_read_b64_tr_b16 v[74:75], v36 offset:12416
  ds_read_b64_tr_b16 v[76:77], v36 offset:13312
  ds_read_b64_tr_b16 v[78:79], v36 offset:13440
  s_waitcnt lgkmcnt(0)
  ds_write_b128 v4, v[64:67] offset:12288
  ds_write_b128 v4, v[68:71] offset:13312
  ds_write_b128 v4, v[72:75] offset:14336
  ds_write_b128 v4, v[76:79] offset:15360
  s_waitcnt lgkmcnt(0)
  s_waitcnt vmcnt(9)
  ds_read_b64_tr_b16 v[64:65], v28 offset:24576
  ds_read_b64_tr_b16 v[66:67], v28 offset:24832
  ds_read_b64_tr_b16 v[68:69], v28 offset:25600
  ds_read_b64_tr_b16 v[70:71], v28 offset:25856
  ds_read_b64_tr_b16 v[72:73], v28 offset:24584
  ds_read_b64_tr_b16 v[74:75], v28 offset:24840
  ds_read_b64_tr_b16 v[76:77], v28 offset:25608
  ds_read_b64_tr_b16 v[78:79], v28 offset:25864
  s_waitcnt lgkmcnt(0)
  ds_write_b128 v4, v[64:67] offset:24576
  ds_write_b128 v4, v[68:71] offset:25600
  ds_write_b128 v4, v[72:75] offset:26624
  ds_write_b128 v4, v[76:79] offset:27648
  s_waitcnt lgkmcnt(0)
  s_waitcnt vmcnt(5)
  ds_read_b64_tr_b16 v[64:65], v28 offset:28672
  ds_read_b64_tr_b16 v[66:67], v28 offset:28928
  ds_read_b64_tr_b16 v[68:69], v28 offset:29696
  ds_read_b64_tr_b16 v[70:71], v28 offset:29952
  ds_read_b64_tr_b16 v[72:73], v28 offset:28680
  ds_read_b64_tr_b16 v[74:75], v28 offset:28936
  ds_read_b64_tr_b16 v[76:77], v28 offset:29704
  ds_read_b64_tr_b16 v[78:79], v28 offset:29960
  s_waitcnt lgkmcnt(0)
  ds_write_b128 v4, v[64:67] offset:28672
  ds_write_b128 v4, v[68:71] offset:29696
  ds_write_b128 v4, v[72:75] offset:30720
  ds_write_b128 v4, v[76:79] offset:31744
  s_waitcnt lgkmcnt(0)
  s_mov_b32 s14, 1
  s_cmp_lt_i32 s14, s30
  s_cbranch_scc1 T_kv2_86
  s_mov_b32 s19, 0
  s_branch T_kvok_88
T_kv_87:
  s_sleep 4
  s_add_u32 s19, s19, 1
  s_cmp_gt_u32 s19, 32768
  s_cbranch_scc1 M_exit
T_kvok_88:
  s_add_u32 s39, s99, 128
  s_mov_b32 s38, 0
  s_mov_b32 s37, 0
  s_atomic_or s38, s[58:59], s99 glc
  s_atomic_or s37, s[58:59], s39 glc
  s_waitcnt lgkmcnt(0)
  s_add_u32 s37, s37, 30
  s_cmp_ge_u32 s38, 30
  s_cselect_b32 s38, s37, s38
  s_cmp_ge_u32 s38, 64
  s_cselect_b32 s38, 100, s38
  s_sub_u32 s38, s38, 1
  s_max_i32 s30, s30, s38
  s_cmp_ge_i32 s14, s30
  s_cbranch_scc1 T_kv_87
T_kv2_86:
  s_waitcnt vmcnt(0) lgkmcnt(0)
  s_barrier
  s_cmp_ge_u32 s13, 2
  s_cselect_b64 vcc, -1, 0
  v_cndmask_b32 v8, v8, v19, vcc
  ds_read_b128 v[68:71], v4 offset:0
  ds_read_b128 v[72:75], v4 offset:1024
  ds_read_b128 v[76:79], v4 offset:4096
  ds_read_b128 v[80:83], v4 offset:5120
  ds_read_b128 v[84:87], v4 offset:8192
  ds_read_b128 v[88:91], v4 offset:9216
  ds_read_b128 v[92:95], v4 offset:2048
  ds_read_b128 v[96:99], v4 offset:3072
  ds_read_b128 v[100:103], v4 offset:6144
  ds_read_b128 v[104:107], v4 offset:7168
  ds_read_b128 v[108:111], v4 offset:10240
  ds_read_b128 v[112:115], v4 offset:11264
  ds_read_b128 v[28:31], v59 offset:16384
  ds_read_b128 v[32:35], v59 offset:20480
  ds_read_b128 v[36:39], v2 offset:8192
  ds_read_b128 v[40:43], v2 offset:9216
  ds_read_b128 v[44:47], v2 offset:10240
  ds_read_b128 v[48:51], v2 offset:11264
  ds_read_b128 v[52:55], v2 offset:12288
  ds_read_b128 v[56:59], v2 offset:13312
  ds_read_b128 v[60:63], v2 offset:14336
  ds_read_b128 v[64:67], v2 offset:15360
  s_and_b32 s36, s13, 1
  s_lshl_b32 s36, s36, 12
  s_add_u32 s22, s22, s36
  s_add_u32 s23, s36, 145752064
  s_mov_b32 s14, -1
  s_and_b32 s57, s14, 1
  s_and_b32 s36, s14, 3
  s_lshl_b32 s36, s36, 13
  s_add_u32 s26, s36, s23
  s_add_u32 s36, s36, 8192
  s_and_b32 s36, s36, 0x7fff
  s_add_u32 s24, s36, 145752064
  s_add_u32 s25, s36, 145756160
  s_add_u32 s35, s36, s23
  s_waitcnt lgkmcnt(0)
  s_cmp_lg_u32 s56, 0
  s_cbranch_scc1 M_global
  s_cmp_eq_u32 s13, 1
  s_cbranch_scc1 T_w_90
  s_cmp_eq_u32 s13, 2
  s_cbranch_scc1 T_w_91
  s_cmp_eq_u32 s13, 3
  s_cbranch_scc1 T_w_92
T_w_89:
  s_mov_b32 s19, 0
  v_mov_b64 v[16:17], 0
  v_mov_b64 v[18:19], 0
  v_mov_b64 v[20:21], 0
  v_mov_b64 v[22:23], 0
  v_mov_b64 v[24:25], 0
  v_mov_b64 v[26:27], 0
  buffer_load_dwordx4 v[124:127], v3, s[4:7], s24 offen offset:0 sc1
  buffer_load_dwordx4 v[116:119], v3, s[4:7], s25 offen offset:0 sc1
  buffer_load_dwordx4 v[124:127], v3, s[4:7], s24 offen offset:0 sc1
  buffer_load_dwordx4 v[116:119], v3, s[4:7], s25 offen offset:0 sc1
  s_branch T_loop_93
.p2align 6
T_retry_94:
  s_mov_b64 exec, vcc
  buffer_load_dwordx4 v[124:127], v3, s[4:7], s24 offen offset:0 sc1
  buffer_load_dwordx4 v[116:119], v3, s[4:7], s25 offen offset:0 sc1
  s_mov_b64 exec, -1
  s_add_u32 s19, s19, 1
  s_cmp_gt_u32 s19, 32768
  s_cbranch_scc1 M_exit
T_loop_93:
  s_waitcnt vmcnt(3) lgkmcnt(0)
  v_max3_u32 v123, v124, v125, v126
  v_max_u32 v123, v123, v127
  v_mov_b32_dpp v120, v124 row_ror:8 row_mask:0xf bank_mask:0xf
  v_mov_b32_dpp v121, v125 row_ror:8 row_mask:0xf bank_mask:0xf
  s_waitcnt vmcnt(2)
  v_max3_u32 v123, v123, v116, v117
  v_max3_u32 v123, v123, v118, v119
  v_cmp_eq_u32 vcc, -1, v123
  s_cbranch_vccnz T_retry_94
  v_smfmac_f32_16x16x64_bf16 v[16:19], v[124:127], v[68:75], v0
  s_add_u32 s14, s14, 1
  ds_write_b128 v2, v[124:127] offset:0
  v_mov_b32_dpp v122, v126 row_ror:8 row_mask:0xf bank_mask:0xf
  v_smfmac_f32_16x16x64_bf16 v[20:23], v[124:127], v[76:83], v0
  s_and_b32 s57, s14, 1
  v_mov_b32_dpp v123, v127 row_ror:8 row_mask:0xf bank_mask:0xf
  v_smfmac_f32_16x16x64_bf16 v[24:27], v[124:127], v[84:91], v0
  s_and_b32 s36, s14, 3
  ds_write_b128 v2, v[116:119] offset:4096
  v_smfmac_f32_16x16x64_bf16 v[16:19], v[120:123], v[92:99], v0
  s_lshl_b32 s36, s36, 13
  v_mov_b32_dpp v84, v116 row_ror:8 row_mask:0xf bank_mask:0xf
  v_smfmac_f32_16x16x64_bf16 v[20:23], v[120:123], v[100:107], v0
  s_add_u32 s26, s36, s23
  ds_read_b128 v[68:71], v4 offset:12288
  v_mov_b32_dpp v85, v117 row_ror:8 row_mask:0xf bank_mask:0xf
  v_smfmac_f32_16x16x64_bf16 v[24:27], v[120:123], v[108:115], v0
  s_add_u32 s36, s36, 8192
  ds_read_b128 v[72:75], v4 offset:13312
  v_mov_b32_dpp v86, v118 row_ror:8 row_mask:0xf bank_mask:0xf
  v_smfmac_f32_16x16x64_bf16 v[16:19], v[116:119], v[224:231], v0
  s_and_b32 s36, s36, 0x7fff
  ds_read_b128 v[76:79], v4 offset:14336
  v_mov_b32_dpp v87, v119 row_ror:8 row_mask:0xf bank_mask:0xf
  v_smfmac_f32_16x16x64_bf16 v[20:23], v[116:119], v[240:247], v0
  s_waitcnt lgkmcnt(3)
  s_barrier
  ds_read_b128 v[100:103], v2 offset:1024
  v_smfmac_f32_16x16x64_bf16 v[24:27], v[116:119], a[0:7], v0
  s_mov_b32 m0, s31
  ds_read_b128 v[120:123], v1 offset:1024
  v_smfmac_f32_16x16x64_bf16 v[16:19], v[84:87], v[232:239], v0
  s_cmp_ge_i32 s14, s30
  s_cbranch_scc1 T_kvw_97
T_kvb_98:
  v_smfmac_f32_16x16x64_bf16 v[20:23], v[84:87], v[248:255], v0
  ds_read_b128 v[80:83], v4 offset:15360
  buffer_load_dwordx4 v9, s[4:7], s27 offen sc1 lds
  v_smfmac_f32_16x16x64_bf16 v[24:27], v[84:87], a[8:15], v0
  s_waitcnt lgkmcnt(2)
  s_mov_b32 m0, s32
  v_smfmac_f32_16x16x64_bf16 v[16:19], v[100:103], v[128:135], v0
  ds_read_b128 v[92:95], v2 offset:2048
  v_smfmac_f32_16x16x64_bf16 v[20:23], v[100:103], v[144:151], v0
  ds_read_b128 v[96:99], v1 offset:2048
  v_smfmac_f32_16x16x64_bf16 v[24:27], v[100:103], v[68:75], v0
  s_waitcnt vmcnt(1) lgkmcnt(3)
  ds_read_b128 v[116:119], v2 offset:3072
  buffer_load_dwordx4 v9, s[4:7], s27 offen offset:128 sc1 lds
  v_smfmac_f32_16x16x64_bf16 v[16:19], v[120:123], v[136:143], v0
  ds_read_b128 v[124:127], v1 offset:3072
  s_mov_b32 m0, s33
  v_smfmac_f32_16x16x64_bf16 v[20:23], v[120:123], v[152:159], v0
  s_waitcnt lgkmcnt(4)
  ds_read_b128 v[104:107], v2 offset:5120
  v_smfmac_f32_16x16x64_bf16 v[24:27], v[120:123], v[76:83], v0
  s_waitcnt lgkmcnt(4)
  ds_read_b128 v[108:111], v1 offset:5120
  v_smfmac_f32_16x16x64_bf16 v[16:19], v[92:95], v[160:167], v0
  s_waitcnt lgkmcnt(4)
  ds_read_b128 v[112:115], v2 offset:6144
  buffer_load_dwordx4 v10, s[4:7], s28 offen sc1 lds
  v_smfmac_f32_16x16x64_bf16 v[16:19], v[96:99], v[168:175], v0
  s_waitcnt lgkmcnt(4)
  ds_read_b128 v[84:87], v1 offset:6144
  s_mov_b32 m0, s34
  v_smfmac_f32_16x16x64_bf16 v[16:19], v[116:119], v[192:199], v0
  s_waitcnt lgkmcnt(4)
  ds_read_b128 v[88:91], v2 offset:7168
  v_smfmac_f32_16x16x64_bf16 v[16:19], v[124:127], v[200:207], v0
  s_waitcnt lgkmcnt(4)
  ds_read_b128 v[100:103], v1 offset:7168
  v_smfmac_f32_16x16x64_bf16 v[16:19], v[104:107], a[16:23], v0
  s_waitcnt lgkmcnt(4)
  ds_read_b128 v[68:71], v4 offset:16384
  buffer_load_dwordx4 v10, s[4:7], s28 offen offset:256 sc1 lds
  v_smfmac_f32_16x16x64_bf16 v[16:19], v[108:111], a[24:31], v0
  s_waitcnt lgkmcnt(4)
  ds_read_b128 v[72:75], v4 offset:17408
  v_smfmac_f32_16x16x64_bf16 v[16:19], v[112:115], a[64:71], v0
  s_waitcnt lgkmcnt(4)
  ds_read_b128 v[76:79], v4 offset:18432
  v_smfmac_f32_16x16x64_bf16 v[16:19], v[84:87], a[72:79], v0
  s_waitcnt lgkmcnt(4)
  ds_read_b128 v[80:83], v4 offset:19456
  v_smfmac_f32_16x16x64_bf16 v[16:19], v[88:91], a[112:119], v0
  s_waitcnt lgkmcnt(4)
  v_smfmac_f32_16x16x64_bf16 v[16:19], v[100:103], a[120:127], v0
  s_add_u32 s24, s36, 145752064
  s_add_u32 s25, s36, 145756160
  v_smfmac_f32_16x16x64_bf16 v[20:23], v[92:95], v[176:183], v0
  s_add_u32 s35, s36, s23
  v_smfmac_f32_16x16x64_bf16 v[20:23], v[96:99], v[184:191], v0
  s_waitcnt lgkmcnt(2)
  v_smfmac_f32_16x16x64_bf16 v[20:23], v[116:119], v[68:75], v0
  s_waitcnt lgkmcnt(0)
  ds_read_b128 v[68:71], v4 offset:20480
  v_mul_f32 v16, s18, v16
  v_smfmac_f32_16x16x64_bf16 v[20:23], v[124:127], v[76:83], v0
  ds_read_b128 v[72:75], v4 offset:21504
  v_mul_f32 v17, s18, v17
  v_smfmac_f32_16x16x64_bf16 v[20:23], v[104:107], a[32:39], v0
  ds_read_b128 v[76:79], v4 offset:22528
  v_mul_f32 v18, s18, v18
  v_smfmac_f32_16x16x64_bf16 v[20:23], v[108:111], a[40:47], v0
  ds_read_b128 v[80:83], v4 offset:23552
  v_mul_f32 v19, s18, v19
  v_smfmac_f32_16x16x64_bf16 v[20:23], v[112:115], a[80:87], v0
  v_cvt_pk_bf16_f32 v120, v16, v17
  v_smfmac_f32_16x16x64_bf16 v[20:23], v[84:87], a[88:95], v0
  v_cvt_pk_bf16_f32 v121, v18, v19
  v_smfmac_f32_16x16x64_bf16 v[20:23], v[88:91], a[128:135], v0
  ds_write_b64 v5, v[120:121] offset:24576
  v_smfmac_f32_16x16x64_bf16 v[20:23], v[100:103], a[136:143], v0
  s_waitcnt lgkmcnt(3)
  v_smfmac_f32_16x16x64_bf16 v[24:27], v[92:95], v[68:75], v0
  s_waitcnt lgkmcnt(1)
  v_mov_b64 v[92:93], 0
  v_smfmac_f32_16x16x64_bf16 v[24:27], v[96:99], v[76:83], v0
  s_nop 1
  v_cvt_pk_bf16_f32 v122, v20, v21
  v_cvt_pk_bf16_f32 v123, v22, v23
  v_smfmac_f32_16x16x64_bf16 v[24:27], v[116:119], v[208:215], v0
  ds_write_b64 v5, v[122:123] offset:26880
  v_mov_b64 v[94:95], 0
  v_smfmac_f32_16x16x64_bf16 v[24:27], v[124:127], v[216:223], v0
  s_waitcnt lgkmcnt(1)
  s_barrier
  ds_read_b64_tr_b16 v[68:69], v6 offset:24576
  v_smfmac_f32_16x16x64_bf16 v[24:27], v[104:107], a[48:55], v0
  s_add_u32 s27, s27, 8192
  ds_read_b64_tr_b16 v[70:71], v6 offset:24640
  ds_read_b64_tr_b16 v[72:73], v6 offset:24832
  v_smfmac_f32_16x16x64_bf16 v[24:27], v[108:111], a[56:63], v0
  s_add_u32 s28, s28, 8192
  ds_read_b64_tr_b16 v[74:75], v6 offset:24896
  ds_read_b64_tr_b16 v[76:77], v6 offset:25088
  v_smfmac_f32_16x16x64_bf16 v[24:27], v[112:115], a[96:103], v0
  s_nop 0
  ds_read_b64_tr_b16 v[78:79], v6 offset:25152
  ds_read_b64_tr_b16 v[80:81], v6 offset:25344
  v_smfmac_f32_16x16x64_bf16 v[24:27], v[84:87], a[104:111], v0
  ds_read_b64_tr_b16 v[82:83], v6 offset:25408
  v_mov_b64 v[96:97], 0
  v_smfmac_f32_16x16x64_bf16 v[24:27], v[88:91], a[144:151], v0
  s_waitcnt lgkmcnt(8)
  s_barrier
  ds_read_b64_tr_b16 v[116:117], v6 offset:26880
  v_smfmac_f32_16x16x64_bf16 v[24:27], v[100:103], a[152:159], v0
  s_waitcnt lgkmcnt(7)
  ds_read_b64_tr_b16 v[118:119], v6 offset:26944
  v_mfma_f32_16x16x32_bf16 v[16:19], v[36:39], v[68:71], 0
  s_waitcnt lgkmcnt(6)
  ds_read_b64_tr_b16 v[124:125], v6 offset:27136
  ds_read_b64_tr_b16 v[126:127], v6 offset:27200
  v_mfma_f32_16x16x32_bf16 v[16:19], v[40:43], v[72:75], v[16:19]
  s_waitcnt lgkmcnt(6)
  ds_read_b64_tr_b16 v[104:105], v6 offset:27392
  ds_read_b64_tr_b16 v[106:107], v6 offset:27456
  v_mfma_f32_16x16x32_bf16 v[16:19], v[44:47], v[76:79], v[16:19]
  s_waitcnt lgkmcnt(6)
  ds_read_b64_tr_b16 v[108:109], v6 offset:27648
  ds_read_b64_tr_b16 v[110:111], v6 offset:27712
  v_mfma_f32_16x16x32_bf16 v[16:19], v[48:51], v[80:83], v[16:19]
  s_waitcnt lgkmcnt(6)
  v_cvt_pk_bf16_f32 v120, v24, v25
  v_cvt_pk_bf16_f32 v121, v26, v27
  v_mfma_f32_16x16x32_bf16 v[112:115], v[116:119], v[68:71], 0
  s_waitcnt lgkmcnt(4)
  buffer_store_dwordx4 v[120:123], v2, s[4:7], s29 offen offset:0 sc1
  v_mov_b64 v[98:99], 0
  v_mfma_f32_16x16x32_bf16 v[112:115], v[124:127], v[72:75], v[112:115]
  s_waitcnt lgkmcnt(2)
  v_mov_b64 v[36:37], 0
  v_exp_f32 v100, v16
  v_mfma_f32_16x16x32_bf16 v[112:115], v[104:107], v[76:79], v[112:115]
  s_waitcnt lgkmcnt(0)
  v_exp_f32 v101, v17
  v_mfma_f32_16x16x32_bf16 v[112:115], v[108:111], v[80:83], v[112:115]
  v_exp_f32 v102, v18
  v_mfma_f32_16x16x32_bf16 v[20:23], v[52:55], v[68:71], 0
  s_cmp_eq_u32 s14, 63
  v_exp_f32 v103, v19
  v_mfma_f32_16x16x32_bf16 v[20:23], v[56:59], v[72:75], v[20:23]
  s_cbranch_scc1 M_tdone
  v_cvt_pk_bf16_f32 v44, v100, v101
  v_cvt_pk_bf16_f32 v45, v102, v103
  v_mfma_f32_16x16x32_bf16 v[20:23], v[60:63], v[76:79], v[20:23]
  s_add_u32 s29, s29, 131072
  v_exp_f32 v100, v112
  v_mfma_f32_16x16x32_bf16 v[20:23], v[64:67], v[80:83], v[20:23]
  v_exp_f32 v101, v113
  v_exp_f32 v102, v114
  v_exp_f32 v103, v115
  v_cvt_pk_bf16_f32 v84, v100, v101
  v_cvt_pk_bf16_f32 v85, v102, v103
  v_cndmask_b32 v48, v84, 0, s[16:17]
  v_cndmask_b32 v49, v85, 0, s[16:17]
  v_cndmask_b32 v50, 0, v84, s[16:17]
  v_cndmask_b32 v51, 0, v85, s[16:17]
  v_exp_f32 v100, v20
  v_mfma_f32_16x16x16_bf16 v[88:91], v[12:13], v[48:49], 0
  v_exp_f32 v101, v21
  v_mfma_f32_16x16x16_bf16 v[24:27], v[120:121], v[48:49], 0
  v_exp_f32 v102, v22
  v_mfma_f32_16x16x16_bf16 v[116:119], v[120:121], v[50:51], 0
  v_exp_f32 v103, v23
  v_cvt_pk_bf16_f32 v46, v100, v101
  v_cvt_pk_bf16_f32 v47, v102, v103
  v_mov_b64 v[38:39], 0
  s_nop 0
  v_mfma_f32_16x16x32_bf16 v[88:91], v[12:15], v[44:47], v[88:91]
  v_mov_b64 v[40:41], 0
  v_mov_b64 v[42:43], 0
  v_mfma_f32_16x16x32_bf16 v[24:27], v[28:31], v[44:47], v[24:27]
  ds_read_b128 v[52:55], v4 offset:24576
  ds_read_b128 v[56:59], v4 offset:25600
  v_mfma_f32_16x16x32_bf16 v[116:119], v[32:35], v[44:47], v[116:119]
  s_nop 1
  v_rcp_f32 v89, v88
  v_subrev_u32 v100, s54, v88
  v_cmp_le_u32 vcc, s55, v100
  v_mul_f32 v24, v89, v24
  v_mul_f32 v25, v89, v25
  s_cbranch_vccnz T_slow_100
T_back_101:
  v_cvt_pk_bf16_f32 v124, v24, v25
  v_pk_mul_f32 v[26:27], v[26:27], v[88:89] op_sel:[0,1] op_sel_hi:[1,1]
  v_pk_mul_f32 v[116:117], v[116:117], v[88:89] op_sel:[0,1] op_sel_hi:[1,1]
  v_pk_mul_f32 v[118:119], v[118:119], v[88:89] op_sel:[0,1] op_sel_hi:[1,1]
  v_cvt_pk_bf16_f32 v125, v26, v27
  v_cvt_pk_bf16_f32 v126, v116, v117
  v_cvt_pk_bf16_f32 v127, v118, v119
  ds_write_b128 v11, v[124:127] offset:29184
  s_nop 0
  v_smfmac_f32_16x16x64_bf16 v[92:95], v[124:127], a[160:167], v0
  v_smfmac_f32_16x16x64_bf16 v[96:99], v[124:127], a[168:175], v0
  v_smfmac_f32_16x16x64_bf16 v[36:39], v[124:127], a[176:183], v0
  v_smfmac_f32_16x16x64_bf16 v[40:43], v[124:127], a[184:191], v0
  s_waitcnt lgkmcnt(0)
  s_barrier
  ds_read_b128 v[104:107], v11 offset:29696
  ds_read_b128 v[108:111], v11 offset:30208
  ds_read_b128 v[68:71], v11 offset:30720
  s_waitcnt lgkmcnt(2)
  v_smfmac_f32_16x16x64_bf16 v[92:95], v[104:107], a[192:199], v0
  s_waitcnt lgkmcnt(1)
  ds_read_b128 v[76:79], v4 offset:28672
  v_smfmac_f32_16x16x64_bf16 v[92:95], v[108:111], a[224:231], v0
  s_waitcnt lgkmcnt(1)
  ds_read_b128 v[80:83], v4 offset:29696
  v_smfmac_f32_16x16x64_bf16 v[92:95], v[68:71], a[240:247], v0
  ds_read_b128 v[60:63], v4 offset:26624
  v_smfmac_f32_16x16x64_bf16 v[96:99], v[104:107], a[200:207], v0
  ds_read_b128 v[64:67], v4 offset:27648
  v_smfmac_f32_16x16x64_bf16 v[96:99], v[108:111], a[232:239], v0
  ds_read_b128 v[28:31], v4 offset:30720
  s_nop 0
  v_cvt_pk_bf16_f32 v16, v92, v93
  v_cvt_pk_bf16_f32 v17, v94, v95
  v_bfi_b32 v16, 1, s57, v16
  v_smfmac_f32_16x16x64_bf16 v[96:99], v[68:71], a[248:255], v0
  buffer_store_dwordx2 v[16:17], v7, s[4:7], s20 offen offset:0
  v_smfmac_f32_16x16x64_bf16 v[36:39], v[104:107], a[208:215], v0
  ds_read_b128 v[32:35], v4 offset:31744
  v_smfmac_f32_16x16x64_bf16 v[36:39], v[108:111], v[52:59], v0
  s_waitcnt lgkmcnt(4)
  s_nop 0
  v_cvt_pk_bf16_f32 v18, v96, v97
  v_cvt_pk_bf16_f32 v19, v98, v99
  v_bfi_b32 v18, 1, s57, v18
  v_smfmac_f32_16x16x64_bf16 v[36:39], v[68:71], v[76:83], v0
  buffer_store_dwordx2 v[18:19], v7, s[4:7], s20 offen offset:64
  v_smfmac_f32_16x16x64_bf16 v[40:43], v[104:107], a[216:223], v0
  s_waitcnt lgkmcnt(2)
  ds_read_b128 v[116:119], v2 offset:31232
  v_smfmac_f32_16x16x64_bf16 v[40:43], v[108:111], v[60:67], v0
  s_waitcnt lgkmcnt(1)
  s_nop 0
  v_cvt_pk_bf16_f32 v20, v36, v37
  v_cvt_pk_bf16_f32 v21, v38, v39
  v_bfi_b32 v20, 1, s57, v20
  v_smfmac_f32_16x16x64_bf16 v[40:43], v[68:71], v[28:35], v0
  buffer_store_dwordx2 v[20:21], v7, s[4:7], s21 offen offset:0
  s_nop 6
  v_cvt_pk_bf16_f32 v22, v40, v41
  v_cvt_pk_bf16_f32 v23, v42, v43
  v_bfi_b32 v22, 1, s57, v22
  buffer_store_dwordx2 v[22:23], v7, s[4:7], s21 offen offset:64
  ds_read_b128 v[68:71], v4 offset:0
  ds_read_b128 v[72:75], v4 offset:1024
  ds_read_b128 v[76:79], v4 offset:4096
  ds_read_b128 v[80:83], v4 offset:5120
  ds_read_b128 v[84:87], v4 offset:8192
  ds_read_b128 v[88:91], v4 offset:9216
  v_mov_b64 v[16:17], 0
  v_mov_b64 v[18:19], 0
  v_mov_b64 v[20:21], 0
  v_mov_b64 v[22:23], 0
  v_mov_b64 v[24:25], 0
  v_mov_b64 v[26:27], 0
  s_mov_b32 s19, 0
  v_mov_b32 v49, -1
  s_waitcnt vmcnt(2)
  buffer_load_dwordx4 v[52:55], v2, s[4:7], s22 offen offset:0 sc1
  buffer_load_dwordx4 v[56:59], v2, s[4:7], s22 offen offset:1024 sc1
  buffer_load_dwordx4 v[60:63], v2, s[4:7], s22 offen offset:2048 sc1
  buffer_load_dwordx4 v[64:67], v2, s[4:7], s22 offen offset:3072 sc1
  ds_read_b128 v[92:95], v4 offset:2048
  ds_read_b128 v[96:99], v4 offset:3072
  ds_read_b128 v[100:103], v4 offset:6144
  ds_read_b128 v[104:107], v4 offset:7168
  ds_read_b128 v[108:111], v4 offset:10240
  ds_read_b128 v[112:115], v4 offset:11264
  ds_read_b64 v[44:45], v2 offset:32256
  s_waitcnt lgkmcnt(0)
  v_readfirstlane_b32 s38, v44
  v_readfirstlane_b32 s37, v45
  s_nop 0
  s_add_u32 s37, s37, 30
  s_cmp_ge_u32 s38, 30
  s_cselect_b32 s38, s37, s38
  s_cmp_ge_u32 s38, 64
  s_cselect_b32 s38, 100, s38
  s_sub_u32 s38, s38, 1
  s_max_i32 s30, s30, s38
  s_waitcnt lgkmcnt(12)
  s_waitcnt vmcnt(3)
  v_mfma_f32_16x16x32_bf16 v[120:123], v[116:119], v[52:55], 0
  v_xor_b32 v48, s57, v52
  v_bitop3_b32 v48, v48, v54, s57 bitop3:0xf6
  s_waitcnt vmcnt(2)
  v_mfma_f32_16x16x32_bf16 v[120:123], v[116:119], v[56:59], v[120:123]
  v_bitop3_b32 v48, v48, v56, s57 bitop3:0xf6
  v_bitop3_b32 v48, v48, v58, s57 bitop3:0xf6
  s_waitcnt vmcnt(1)
  v_mfma_f32_16x16x32_bf16 v[120:123], v[116:119], v[60:63], v[120:123]
  v_bitop3_b32 v48, v48, v60, s57 bitop3:0xf6
  v_bitop3_b32 v48, v48, v62, s57 bitop3:0xf6
  s_waitcnt vmcnt(0)
  v_mfma_f32_16x16x32_bf16 v[120:123], v[116:119], v[64:67], v[120:123]
  v_bitop3_b32 v48, v48, v64, s57 bitop3:0xf6
  v_bitop3_b32 v48, v48, v66, s57 bitop3:0xf6
  v_and_b32 v48, 1, v48
  v_cmp_ne_u32 vcc, 0, v48
  s_cbranch_vccnz T_p1re_103
T_p1ok_104:
  s_nop 2
  v_add_f32_dpp v120, v120, v120 row_ror:8 row_mask:0xf bank_mask:0xf
  v_add_f32_dpp v121, v121, v121 row_ror:8 row_mask:0xf bank_mask:0xf
  v_cvt_pk_bf16_f32 v48, v120, v121
  v_min_u32 v48, -2, v48
  buffer_store_dword v48, v8, s[4:7], s35 offen
  buffer_store_dword v49, v8, s[4:7], s26 offen
  s_barrier
  ds_read_b128 v[28:31], v2 offset:16384
  ds_read_b128 v[32:35], v2 offset:20480
  ds_read_b128 v[36:39], v2 offset:8192
  ds_read_b128 v[40:43], v2 offset:9216
  ds_read_b128 v[44:47], v2 offset:10240
  ds_read_b128 v[48:51], v2 offset:11264
  buffer_load_dwordx4 v[124:127], v3, s[4:7], s24 offen offset:0 sc1
  buffer_load_dwordx4 v[116:119], v3, s[4:7], s25 offen offset:0 sc1
  ds_read_b128 v[52:55], v2 offset:12288
  ds_read_b128 v[56:59], v2 offset:13312
  ds_read_b128 v[60:63], v2 offset:14336
  ds_read_b128 v[64:67], v2 offset:15360
  buffer_load_dwordx4 v[124:127], v3, s[4:7], s24 offen offset:0 sc1
  buffer_load_dwordx4 v[116:119], v3, s[4:7], s25 offen offset:0 sc1
  s_mov_b32 s19, 0
  s_branch T_loop_93
T_p1re_103:
  s_mov_b64 exec, vcc
  buffer_load_dwordx4 v[52:55], v2, s[4:7], s22 offen offset:0 sc1
  buffer_load_dwordx4 v[56:59], v2, s[4:7], s22 offen offset:1024 sc1
  buffer_load_dwordx4 v[60:63], v2, s[4:7], s22 offen offset:2048 sc1
  buffer_load_dwordx4 v[64:67], v2, s[4:7], s22 offen offset:3072 sc1
  s_mov_b64 exec, -1
  s_add_u32 s19, s19, 1
  s_cmp_gt_u32 s19, 32768
  s_cbranch_scc1 M_exit
  s_waitcnt vmcnt(3)
  v_mfma_f32_16x16x32_bf16 v[120:123], v[116:119], v[52:55], 0
  v_xor_b32 v48, s57, v52
  v_bitop3_b32 v48, v48, v54, s57 bitop3:0xf6
  s_waitcnt vmcnt(2)
  v_mfma_f32_16x16x32_bf16 v[120:123], v[116:119], v[56:59], v[120:123]
  v_bitop3_b32 v48, v48, v56, s57 bitop3:0xf6
  v_bitop3_b32 v48, v48, v58, s57 bitop3:0xf6
  s_waitcnt vmcnt(1)
  v_mfma_f32_16x16x32_bf16 v[120:123], v[116:119], v[60:63], v[120:123]
  v_bitop3_b32 v48, v48, v60, s57 bitop3:0xf6
  v_bitop3_b32 v48, v48, v62, s57 bitop3:0xf6
  s_waitcnt vmcnt(0)
  v_mfma_f32_16x16x32_bf16 v[120:123], v[116:119], v[64:67], v[120:123]
  v_bitop3_b32 v48, v48, v64, s57 bitop3:0xf6
  v_bitop3_b32 v48, v48, v66, s57 bitop3:0xf6
  v_and_b32 v48, 1, v48
  v_cmp_ne_u32 vcc, 0, v48
  s_cbranch_vccnz T_p1re_103
  s_branch T_p1ok_104
T_kvw_97:
  s_mov_b32 s19, 0
  s_branch T_kvok_106
T_kv_105:
  s_sleep 4
  s_add_u32 s19, s19, 1
  s_cmp_gt_u32 s19, 32768
  s_cbranch_scc1 M_exit
T_kvok_106:
  s_add_u32 s39, s99, 128
  s_mov_b32 s38, 0
  s_mov_b32 s37, 0
  s_atomic_or s38, s[58:59], s99 glc
  s_atomic_or s37, s[58:59], s39 glc
  s_waitcnt lgkmcnt(0)
  s_add_u32 s37, s37, 30
  s_cmp_ge_u32 s38, 30
  s_cselect_b32 s38, s37, s38
  s_cmp_ge_u32 s38, 64
  s_cselect_b32 s38, 100, s38
  s_sub_u32 s38, s38, 1
  s_max_i32 s30, s30, s38
  s_cmp_ge_i32 s14, s30
  s_cbranch_scc1 T_kv_105
  s_branch T_kvb_98
T_slow_100:
  s_nop 7
  v_max3_f32 v100, v16, v17, v18
  v_max3_f32 v100, v100, v19, v20
  v_max3_f32 v100, v100, v21, v22
  v_max3_f32 v100, v100, v23, v112
  v_max3_f32 v100, v100, v113, v114
  v_max_f32 v100, v100, v115
  v_mov_b32 v101, v100
  s_nop 1
  v_permlane32_swap_b32 v100, v101
  s_nop 1
  v_max_f32 v100, v100, v101
  v_mov_b32 v101, v100
  s_nop 1
  v_permlane16_swap_b32 v100, v101
  s_nop 1
  v_max_f32 v100, v100, v101
  v_sub_f32 v16, v16, v100
  v_sub_f32 v17, v17, v100
  v_sub_f32 v18, v18, v100
  v_sub_f32 v19, v19, v100
  v_exp_f32 v16, v16
  v_exp_f32 v17, v17
  v_exp_f32 v18, v18
  v_exp_f32 v19, v19
  v_sub_f32 v20, v20, v100
  v_sub_f32 v21, v21, v100
  v_sub_f32 v22, v22, v100
  v_sub_f32 v23, v23, v100
  v_exp_f32 v20, v20
  v_exp_f32 v21, v21
  v_exp_f32 v22, v22
  v_exp_f32 v23, v23
  v_sub_f32 v112, v112, v100
  v_sub_f32 v113, v113, v100
  v_sub_f32 v114, v114, v100
  v_sub_f32 v115, v115, v100
  v_exp_f32 v112, v112
  v_exp_f32 v113, v113
  v_exp_f32 v114, v114
  v_exp_f32 v115, v115
  s_nop 0
  v_cvt_pk_bf16_f32 v44, v16, v17
  v_cvt_pk_bf16_f32 v45, v18, v19
  v_cvt_pk_bf16_f32 v46, v20, v21
  v_cvt_pk_bf16_f32 v47, v22, v23
  v_cvt_pk_bf16_f32 v84, v112, v113
  v_cvt_pk_bf16_f32 v85, v114, v115
  v_cndmask_b32 v48, v84, 0, s[16:17]
  v_cndmask_b32 v49, v85, 0, s[16:17]
  v_cndmask_b32 v50, 0, v84, s[16:17]
  v_cndmask_b32 v51, 0, v85, s[16:17]
  s_nop 1
  v_mfma_f32_16x16x16_bf16 v[88:91], v[12:13], v[48:49], 0
  v_mfma_f32_16x16x16_bf16 v[24:27], v[120:121], v[48:49], 0
  v_mfma_f32_16x16x16_bf16 v[116:119], v[120:121], v[50:51], 0
  v_mfma_f32_16x16x32_bf16 v[88:91], v[12:15], v[44:47], v[88:91]
  v_mfma_f32_16x16x32_bf16 v[24:27], v[28:31], v[44:47], v[24:27]
  v_mfma_f32_16x16x32_bf16 v[116:119], v[32:35], v[44:47], v[116:119]
  s_nop 7
  s_nop 1
  v_rcp_f32 v89, v88
  s_nop 0
  v_mul_f32 v24, v89, v24
  v_mul_f32 v25, v89, v25
  s_branch T_back_101
T_w_90:
  s_mov_b32 s19, 0
  v_mov_b64 v[16:17], 0
  v_mov_b64 v[18:19], 0
  v_mov_b64 v[20:21], 0
  v_mov_b64 v[22:23], 0
  v_mov_b64 v[24:25], 0
  v_mov_b64 v[26:27], 0
  buffer_load_dwordx4 v[124:127], v3, s[4:7], s24 offen offset:1024 sc1
  buffer_load_dwordx4 v[116:119], v3, s[4:7], s25 offen offset:1024 sc1
  buffer_load_dwordx4 v[124:127], v3, s[4:7], s24 offen offset:1024 sc1
  buffer_load_dwordx4 v[116:119], v3, s[4:7], s25 offen offset:1024 sc1
  s_branch T_loop_107
.p2align 6
T_retry_108:
  s_mov_b64 exec, vcc
  buffer_load_dwordx4 v[124:127], v3, s[4:7], s24 offen offset:1024 sc1
  buffer_load_dwordx4 v[116:119], v3, s[4:7], s25 offen offset:1024 sc1
  s_mov_b64 exec, -1
  s_add_u32 s19, s19, 1
  s_cmp_gt_u32 s19, 32768
  s_cbranch_scc1 M_exit
T_loop_107:
  s_waitcnt vmcnt(3) lgkmcnt(0)
  v_max3_u32 v123, v124, v125, v126
  v_max_u32 v123, v123, v127
  v_mov_b32_dpp v120, v124 row_ror:8 row_mask:0xf bank_mask:0xf
  v_mov_b32_dpp v121, v125 row_ror:8 row_mask:0xf bank_mask:0xf
  s_waitcnt vmcnt(2)
  v_max3_u32 v123, v123, v116, v117
  v_max3_u32 v123, v123, v118, v119
  v_cmp_eq_u32 vcc, -1, v123
  s_cbranch_vccnz T_retry_108
  v_smfmac_f32_16x16x64_bf16 v[16:19], v[124:127], v[68:75], v0
  s_add_u32 s14, s14, 1
  ds_write_b128 v2, v[124:127] offset:1024
  v_mov_b32_dpp v122, v126 row_ror:8 row_mask:0xf bank_mask:0xf
  v_smfmac_f32_16x16x64_bf16 v[20:23], v[124:127], v[76:83], v0
  s_and_b32 s57, s14, 1
  v_mov_b32_dpp v123, v127 row_ror:8 row_mask:0xf bank_mask:0xf
  v_smfmac_f32_16x16x64_bf16 v[24:27], v[124:127], v[84:91], v0
  s_and_b32 s36, s14, 3
  ds_write_b128 v2, v[116:119] offset:5120
  v_smfmac_f32_16x16x64_bf16 v[16:19], v[120:123], v[92:99], v0
  s_lshl_b32 s36, s36, 13
  v_mov_b32_dpp v84, v116 row_ror:8 row_mask:0xf bank_mask:0xf
  v_smfmac_f32_16x16x64_bf16 v[20:23], v[120:123], v[100:107], v0
  s_add_u32 s26, s36, s23
  ds_read_b128 v[68:71], v4 offset:12288
  v_mov_b32_dpp v85, v117 row_ror:8 row_mask:0xf bank_mask:0xf
  v_smfmac_f32_16x16x64_bf16 v[24:27], v[120:123], v[108:115], v0
  s_add_u32 s36, s36, 8192
  ds_read_b128 v[72:75], v4 offset:13312
  v_mov_b32_dpp v86, v118 row_ror:8 row_mask:0xf bank_mask:0xf
  v_smfmac_f32_16x16x64_bf16 v[16:19], v[116:119], v[224:231], v0
  s_and_b32 s36, s36, 0x7fff
  ds_read_b128 v[76:79], v4 offset:14336
  v_mov_b32_dpp v87, v119 row_ror:8 row_mask:0xf bank_mask:0xf
  v_smfmac_f32_16x16x64_bf16 v[20:23], v[116:119], v[240:247], v0
  s_waitcnt lgkmcnt(3)
  s_barrier
  ds_read_b128 v[100:103], v2 offset:0
  v_smfmac_f32_16x16x64_bf16 v[24:27], v[116:119], a[0:7], v0
  s_mov_b32 m0, s31
  ds_read_b128 v[120:123], v1 offset:0
  v_smfmac_f32_16x16x64_bf16 v[16:19], v[84:87], v[232:239], v0
  s_cmp_ge_i32 s14, s30
  s_cbranch_scc1 T_kvw_111
T_kvb_112:
  v_smfmac_f32_16x16x64_bf16 v[20:23], v[84:87], v[248:255], v0
  ds_read_b128 v[80:83], v4 offset:15360
  v_smfmac_f32_16x16x64_bf16 v[24:27], v[84:87], a[8:15], v0
  s_waitcnt lgkmcnt(2)
  buffer_load_dwordx4 v9, s[4:7], s27 offen sc1 lds
  v_smfmac_f32_16x16x64_bf16 v[16:19], v[100:103], v[128:135], v0
  ds_read_b128 v[92:95], v2 offset:3072
  s_mov_b32 m0, s32
  v_smfmac_f32_16x16x64_bf16 v[20:23], v[100:103], v[144:151], v0
  ds_read_b128 v[96:99], v1 offset:3072
  v_smfmac_f32_16x16x64_bf16 v[24:27], v[100:103], v[68:75], v0
  s_waitcnt vmcnt(1) lgkmcnt(3)
  ds_read_b128 v[116:119], v2 offset:2048
  v_smfmac_f32_16x16x64_bf16 v[16:19], v[120:123], v[136:143], v0
  ds_read_b128 v[124:127], v1 offset:2048
  buffer_load_dwordx4 v9, s[4:7], s27 offen offset:128 sc1 lds
  v_smfmac_f32_16x16x64_bf16 v[20:23], v[120:123], v[152:159], v0
  s_waitcnt lgkmcnt(4)
  ds_read_b128 v[104:107], v2 offset:4096
  s_mov_b32 m0, s33
  v_smfmac_f32_16x16x64_bf16 v[24:27], v[120:123], v[76:83], v0
  s_waitcnt lgkmcnt(4)
  ds_read_b128 v[108:111], v1 offset:4096
  v_smfmac_f32_16x16x64_bf16 v[16:19], v[92:95], v[160:167], v0
  s_waitcnt lgkmcnt(4)
  ds_read_b128 v[112:115], v2 offset:7168
  v_smfmac_f32_16x16x64_bf16 v[16:19], v[96:99], v[168:175], v0
  s_waitcnt lgkmcnt(4)
  ds_read_b128 v[84:87], v1 offset:7168
  buffer_load_dwordx4 v10, s[4:7], s28 offen sc1 lds
  v_smfmac_f32_16x16x64_bf16 v[16:19], v[116:119], v[192:199], v0
  s_waitcnt lgkmcnt(4)
  ds_read_b128 v[88:91], v2 offset:6144
  s_mov_b32 m0, s34
  v_smfmac_f32_16x16x64_bf16 v[16:19], v[124:127], v[200:207], v0
  s_waitcnt lgkmcnt(4)
  ds_read_b128 v[100:103], v1 offset:6144
  v_smfmac_f32_16x16x64_bf16 v[16:19], v[104:107], a[16:23], v0
  s_waitcnt lgkmcnt(4)
  ds_read_b128 v[68:71], v4 offset:16384
  v_smfmac_f32_16x16x64_bf16 v[16:19], v[108:111], a[24:31], v0
  s_waitcnt lgkmcnt(4)
  ds_read_b128 v[72:75], v4 offset:17408
  buffer_load_dwordx4 v10, s[4:7], s28 offen offset:256 sc1 lds
  v_smfmac_f32_16x16x64_bf16 v[16:19], v[112:115], a[64:71], v0
  s_waitcnt lgkmcnt(4)
  ds_read_b128 v[76:79], v4 offset:18432
  v_smfmac_f32_16x16x64_bf16 v[16:19], v[84:87], a[72:79], v0
  s_waitcnt lgkmcnt(4)
  ds_read_b128 v[80:83], v4 offset:19456
  v_smfmac_f32_16x16x64_bf16 v[16:19], v[88:91], a[112:119], v0
  s_waitcnt lgkmcnt(4)
  v_smfmac_f32_16x16x64_bf16 v[16:19], v[100:103], a[120:127], v0
  s_add_u32 s24, s36, 145752064
  s_add_u32 s25, s36, 145756160
  v_smfmac_f32_16x16x64_bf16 v[20:23], v[92:95], v[176:183], v0
  s_add_u32 s35, s36, s23
  v_smfmac_f32_16x16x64_bf16 v[20:23], v[96:99], v[184:191], v0
  s_waitcnt lgkmcnt(2)
  v_smfmac_f32_16x16x64_bf16 v[20:23], v[116:119], v[68:75], v0
  s_waitcnt lgkmcnt(0)
  ds_read_b128 v[68:71], v4 offset:20480
  v_mul_f32 v16, s18, v16
  v_smfmac_f32_16x16x64_bf16 v[20:23], v[124:127], v[76:83], v0
  ds_read_b128 v[72:75], v4 offset:21504
  v_mul_f32 v17, s18, v17
  v_smfmac_f32_16x16x64_bf16 v[20:23], v[104:107], a[32:39], v0
  ds_read_b128 v[76:79], v4 offset:22528
  v_mul_f32 v18, s18, v18
  v_smfmac_f32_16x16x64_bf16 v[20:23], v[108:111], a[40:47], v0
  ds_read_b128 v[80:83], v4 offset:23552
  v_mul_f32 v19, s18, v19
  v_smfmac_f32_16x16x64_bf16 v[20:23], v[112:115], a[80:87], v0
  v_cvt_pk_bf16_f32 v120, v16, v17
  v_smfmac_f32_16x16x64_bf16 v[20:23], v[84:87], a[88:95], v0
  v_cvt_pk_bf16_f32 v121, v18, v19
  v_smfmac_f32_16x16x64_bf16 v[20:23], v[88:91], a[128:135], v0
  ds_write_b64 v5, v[120:121] offset:24576
  v_smfmac_f32_16x16x64_bf16 v[20:23], v[100:103], a[136:143], v0
  s_waitcnt lgkmcnt(3)
  v_smfmac_f32_16x16x64_bf16 v[24:27], v[92:95], v[68:75], v0
  s_waitcnt lgkmcnt(1)
  v_mov_b64 v[92:93], 0
  v_smfmac_f32_16x16x64_bf16 v[24:27], v[96:99], v[76:83], v0
  s_nop 1
  v_cvt_pk_bf16_f32 v122, v20, v21
  v_cvt_pk_bf16_f32 v123, v22, v23
  v_smfmac_f32_16x16x64_bf16 v[24:27], v[116:119], v[208:215], v0
  ds_write_b64 v5, v[122:123] offset:26880
  v_mov_b64 v[94:95], 0
  v_smfmac_f32_16x16x64_bf16 v[24:27], v[124:127], v[216:223], v0
  s_waitcnt lgkmcnt(1)
  s_barrier
  ds_read_b64_tr_b16 v[68:69], v6 offset:24576
  v_smfmac_f32_16x16x64_bf16 v[24:27], v[104:107], a[48:55], v0
  s_add_u32 s27, s27, 8192
  ds_read_b64_tr_b16 v[70:71], v6 offset:24640
  ds_read_b64_tr_b16 v[72:73], v6 offset:24832
  v_smfmac_f32_16x16x64_bf16 v[24:27], v[108:111], a[56:63], v0
  s_add_u32 s28, s28, 8192
  ds_read_b64_tr_b16 v[74:75], v6 offset:24896
  ds_read_b64_tr_b16 v[76:77], v6 offset:25088
  v_smfmac_f32_16x16x64_bf16 v[24:27], v[112:115], a[96:103], v0
  s_nop 0
  ds_read_b64_tr_b16 v[78:79], v6 offset:25152
  ds_read_b64_tr_b16 v[80:81], v6 offset:25344
  v_smfmac_f32_16x16x64_bf16 v[24:27], v[84:87], a[104:111], v0
  ds_read_b64_tr_b16 v[82:83], v6 offset:25408
  v_mov_b64 v[96:97], 0
  v_smfmac_f32_16x16x64_bf16 v[24:27], v[88:91], a[144:151], v0
  s_waitcnt lgkmcnt(8)
  s_barrier
  ds_read_b64_tr_b16 v[116:117], v6 offset:26880
  v_smfmac_f32_16x16x64_bf16 v[24:27], v[100:103], a[152:159], v0
  s_waitcnt lgkmcnt(7)
  ds_read_b64_tr_b16 v[118:119], v6 offset:26944
  v_mfma_f32_16x16x32_bf16 v[16:19], v[36:39], v[68:71], 0
  s_waitcnt lgkmcnt(6)
  ds_read_b64_tr_b16 v[124:125], v6 offset:27136
  ds_read_b64_tr_b16 v[126:127], v6 offset:27200
  v_mfma_f32_16x16x32_bf16 v[16:19], v[40:43], v[72:75], v[16:19]
  s_waitcnt lgkmcnt(6)
  ds_read_b64_tr_b16 v[104:105], v6 offset:27392
  ds_read_b64_tr_b16 v[106:107], v6 offset:27456
  v_mfma_f32_16x16x32_bf16 v[16:19], v[44:47], v[76:79], v[16:19]
  s_waitcnt lgkmcnt(6)
  ds_read_b64_tr_b16 v[108:109], v6 offset:27648
  ds_read_b64_tr_b16 v[110:111], v6 offset:27712
  v_mfma_f32_16x16x32_bf16 v[16:19], v[48:51], v[80:83], v[16:19]
  s_waitcnt lgkmcnt(6)
  v_cvt_pk_bf16_f32 v120, v24, v25
  v_cvt_pk_bf16_f32 v121, v26, v27
  v_mfma_f32_16x16x32_bf16 v[112:115], v[116:119], v[68:71], 0
  s_waitcnt lgkmcnt(4)
  v_mov_b64 v[98:99], 0
  v_mfma_f32_16x16x32_bf16 v[112:115], v[124:127], v[72:75], v[112:115]
  s_waitcnt lgkmcnt(2)
  buffer_store_dwordx4 v[120:123], v2, s[4:7], s29 offen offset:1024 sc1
  v_mov_b64 v[36:37], 0
  v_exp_f32 v100, v16
  v_mfma_f32_16x16x32_bf16 v[112:115], v[104:107], v[76:79], v[112:115]
  s_waitcnt lgkmcnt(0)
  v_exp_f32 v101, v17
  v_mfma_f32_16x16x32_bf16 v[112:115], v[108:111], v[80:83], v[112:115]
  v_exp_f32 v102, v18
  v_mfma_f32_16x16x32_bf16 v[20:23], v[52:55], v[68:71], 0
  s_cmp_eq_u32 s14, 63
  v_exp_f32 v103, v19
  v_mfma_f32_16x16x32_bf16 v[20:23], v[56:59], v[72:75], v[20:23]
  s_cbranch_scc1 M_tdone
  v_cvt_pk_bf16_f32 v44, v100, v101
  v_cvt_pk_bf16_f32 v45, v102, v103
  v_mfma_f32_16x16x32_bf16 v[20:23], v[60:63], v[76:79], v[20:23]
  s_add_u32 s29, s29, 131072
  v_exp_f32 v100, v112
  v_mfma_f32_16x16x32_bf16 v[20:23], v[64:67], v[80:83], v[20:23]
  v_exp_f32 v101, v113
  v_exp_f32 v102, v114
  v_exp_f32 v103, v115
  v_cvt_pk_bf16_f32 v84, v100, v101
  v_cvt_pk_bf16_f32 v85, v102, v103
  v_cndmask_b32 v48, v84, 0, s[16:17]
  v_cndmask_b32 v49, v85, 0, s[16:17]
  v_cndmask_b32 v50, 0, v84, s[16:17]
  v_cndmask_b32 v51, 0, v85, s[16:17]
  v_exp_f32 v100, v20
  v_mfma_f32_16x16x16_bf16 v[88:91], v[12:13], v[48:49], 0
  v_exp_f32 v101, v21
  v_mfma_f32_16x16x16_bf16 v[24:27], v[120:121], v[48:49], 0
  v_exp_f32 v102, v22
  v_mfma_f32_16x16x16_bf16 v[116:119], v[120:121], v[50:51], 0
  v_exp_f32 v103, v23
  v_cvt_pk_bf16_f32 v46, v100, v101
  v_cvt_pk_bf16_f32 v47, v102, v103
  v_mov_b64 v[38:39], 0
  s_nop 0
  v_mfma_f32_16x16x32_bf16 v[88:91], v[12:15], v[44:47], v[88:91]
  v_mov_b64 v[40:41], 0
  v_mov_b64 v[42:43], 0
  v_mfma_f32_16x16x32_bf16 v[24:27], v[28:31], v[44:47], v[24:27]
  ds_read_b128 v[52:55], v4 offset:24576
  ds_read_b128 v[56:59], v4 offset:25600
  v_mfma_f32_16x16x32_bf16 v[116:119], v[32:35], v[44:47], v[116:119]
  s_nop 1
  v_rcp_f32 v89, v88
  v_subrev_u32 v100, s54, v88
  v_cmp_le_u32 vcc, s55, v100
  v_mul_f32 v24, v89, v24
  v_mul_f32 v25, v89, v25
  s_cbranch_vccnz T_slow_114
T_back_115:
  v_cvt_pk_bf16_f32 v124, v24, v25
  v_pk_mul_f32 v[26:27], v[26:27], v[88:89] op_sel:[0,1] op_sel_hi:[1,1]
  v_pk_mul_f32 v[116:117], v[116:117], v[88:89] op_sel:[0,1] op_sel_hi:[1,1]
  v_pk_mul_f32 v[118:119], v[118:119], v[88:89] op_sel:[0,1] op_sel_hi:[1,1]
  v_cvt_pk_bf16_f32 v125, v26, v27
  v_cvt_pk_bf16_f32 v126, v116, v117
  v_cvt_pk_bf16_f32 v127, v118, v119
  ds_write_b128 v11, v[124:127] offset:29696
  s_nop 0
  v_smfmac_f32_16x16x64_bf16 v[92:95], v[124:127], a[160:167], v0
  v_smfmac_f32_16x16x64_bf16 v[96:99], v[124:127], a[168:175], v0
  v_smfmac_f32_16x16x64_bf16 v[36:39], v[124:127], a[176:183], v0
  v_smfmac_f32_16x16x64_bf16 v[40:43], v[124:127], a[184:191], v0
  s_waitcnt lgkmcnt(0)
  s_barrier
  ds_read_b128 v[104:107], v11 offset:29184
  ds_read_b128 v[108:111], v11 offset:30720
  ds_read_b128 v[68:71], v11 offset:30208
  s_waitcnt lgkmcnt(2)
  v_smfmac_f32_16x16x64_bf16 v[92:95], v[104:107], a[192:199], v0
  s_waitcnt lgkmcnt(1)
  ds_read_b128 v[76:79], v4 offset:28672
  v_smfmac_f32_16x16x64_bf16 v[92:95], v[108:111], a[224:231], v0
  s_waitcnt lgkmcnt(1)
  ds_read_b128 v[80:83], v4 offset:29696
  v_smfmac_f32_16x16x64_bf16 v[92:95], v[68:71], a[240:247], v0
  ds_read_b128 v[60:63], v4 offset:26624
  v_smfmac_f32_16x16x64_bf16 v[96:99], v[104:107], a[200:207], v0
  ds_read_b128 v[64:67], v4 offset:27648
  v_smfmac_f32_16x16x64_bf16 v[96:99], v[108:111], a[232:239], v0
  ds_read_b128 v[28:31], v4 offset:30720
  s_nop 0
  v_cvt_pk_bf16_f32 v16, v92, v93
  v_cvt_pk_bf16_f32 v17, v94, v95
  v_bfi_b32 v16, 1, s57, v16
  v_smfmac_f32_16x16x64_bf16 v[96:99], v[68:71], a[248:255], v0
  buffer_store_dwordx2 v[16:17], v7, s[4:7], s20 offen offset:0
  v_smfmac_f32_16x16x64_bf16 v[36:39], v[104:107], a[208:215], v0
  ds_read_b128 v[32:35], v4 offset:31744
  v_smfmac_f32_16x16x64_bf16 v[36:39], v[108:111], v[52:59], v0
  s_waitcnt lgkmcnt(4)
  s_nop 0
  v_cvt_pk_bf16_f32 v18, v96, v97
  v_cvt_pk_bf16_f32 v19, v98, v99
  v_bfi_b32 v18, 1, s57, v18
  v_smfmac_f32_16x16x64_bf16 v[36:39], v[68:71], v[76:83], v0
  buffer_store_dwordx2 v[18:19], v7, s[4:7], s20 offen offset:64
  v_smfmac_f32_16x16x64_bf16 v[40:43], v[104:107], a[216:223], v0
  s_waitcnt lgkmcnt(2)
  ds_read_b128 v[116:119], v2 offset:31232
  v_smfmac_f32_16x16x64_bf16 v[40:43], v[108:111], v[60:67], v0
  s_waitcnt lgkmcnt(1)
  s_nop 0
  v_cvt_pk_bf16_f32 v20, v36, v37
  v_cvt_pk_bf16_f32 v21, v38, v39
  v_bfi_b32 v20, 1, s57, v20
  v_smfmac_f32_16x16x64_bf16 v[40:43], v[68:71], v[28:35], v0
  buffer_store_dwordx2 v[20:21], v7, s[4:7], s21 offen offset:0
  s_nop 6
  v_cvt_pk_bf16_f32 v22, v40, v41
  v_cvt_pk_bf16_f32 v23, v42, v43
  v_bfi_b32 v22, 1, s57, v22
  buffer_store_dwordx2 v[22:23], v7, s[4:7], s21 offen offset:64
  ds_read_b128 v[68:71], v4 offset:0
  ds_read_b128 v[72:75], v4 offset:1024
  ds_read_b128 v[76:79], v4 offset:4096
  ds_read_b128 v[80:83], v4 offset:5120
  ds_read_b128 v[84:87], v4 offset:8192
  ds_read_b128 v[88:91], v4 offset:9216
  ds_read_b128 v[92:95], v4 offset:2048
  ds_read_b128 v[96:99], v4 offset:3072
  ds_read_b128 v[100:103], v4 offset:6144
  ds_read_b128 v[104:107], v4 offset:7168
  ds_read_b128 v[108:111], v4 offset:10240
  ds_read_b128 v[112:115], v4 offset:11264
  v_mov_b64 v[16:17], 0
  v_mov_b64 v[18:19], 0
  v_mov_b64 v[20:21], 0
  v_mov_b64 v[22:23], 0
  v_mov_b64 v[24:25], 0
  v_mov_b64 v[26:27], 0
  s_mov_b32 s19, 0
  v_mov_b32 v49, -1
  ds_read_b64 v[44:45], v2 offset:32256
  s_waitcnt lgkmcnt(0)
  v_readfirstlane_b32 s38, v44
  v_readfirstlane_b32 s37, v45
  s_nop 0
  s_add_u32 s37, s37, 30
  s_cmp_ge_u32 s38, 30
  s_cselect_b32 s38, s37, s38
  s_cmp_ge_u32 s38, 64
  s_cselect_b32 s38, 100, s38
  s_sub_u32 s38, s38, 1
  s_max_i32 s30, s30, s38
  s_waitcnt vmcnt(0)
  buffer_load_dwordx4 v[52:55], v2, s[4:7], s22 offen offset:0 sc1
  buffer_load_dwordx4 v[56:59], v2, s[4:7], s22 offen offset:1024 sc1
  buffer_load_dwordx4 v[60:63], v2, s[4:7], s22 offen offset:2048 sc1
  buffer_load_dwordx4 v[64:67], v2, s[4:7], s22 offen offset:3072 sc1
  s_waitcnt lgkmcnt(12)
  s_waitcnt vmcnt(3)
  v_mfma_f32_16x16x32_bf16 v[120:123], v[116:119], v[52:55], 0
  v_xor_b32 v48, s57, v52
  v_bitop3_b32 v48, v48, v54, s57 bitop3:0xf6
  s_waitcnt vmcnt(2)
  v_mfma_f32_16x16x32_bf16 v[120:123], v[116:119], v[56:59], v[120:123]
  v_bitop3_b32 v48, v48, v56, s57 bitop3:0xf6
  v_bitop3_b32 v48, v48, v58, s57 bitop3:0xf6
  s_waitcnt vmcnt(1)
  v_mfma_f32_16x16x32_bf16 v[120:123], v[116:119], v[60:63], v[120:123]
  v_bitop3_b32 v48, v48, v60, s57 bitop3:0xf6
  v_bitop3_b32 v48, v48, v62, s57 bitop3:0xf6
  s_waitcnt vmcnt(0)
  v_mfma_f32_16x16x32_bf16 v[120:123], v[116:119], v[64:67], v[120:123]
  v_bitop3_b32 v48, v48, v64, s57 bitop3:0xf6
  v_bitop3_b32 v48, v48, v66, s57 bitop3:0xf6
  v_and_b32 v48, 1, v48
  v_cmp_ne_u32 vcc, 0, v48
  s_cbranch_vccnz T_p1re_117
T_p1ok_118:
  s_nop 2
  v_add_f32_dpp v120, v120, v120 row_ror:8 row_mask:0xf bank_mask:0xf
  v_add_f32_dpp v121, v121, v121 row_ror:8 row_mask:0xf bank_mask:0xf
  v_cvt_pk_bf16_f32 v48, v120, v121
  v_min_u32 v48, -2, v48
  buffer_store_dword v48, v8, s[4:7], s35 offen
  buffer_store_dword v49, v8, s[4:7], s26 offen
  s_barrier
  ds_read_b128 v[28:31], v2 offset:17408
  ds_read_b128 v[32:35], v2 offset:21504
  ds_read_b128 v[36:39], v2 offset:8192
  ds_read_b128 v[40:43], v2 offset:9216
  ds_read_b128 v[44:47], v2 offset:10240
  ds_read_b128 v[48:51], v2 offset:11264
  buffer_load_dwordx4 v[124:127], v3, s[4:7], s24 offen offset:1024 sc1
  buffer_load_dwordx4 v[116:119], v3, s[4:7], s25 offen offset:1024 sc1
  ds_read_b128 v[52:55], v2 offset:12288
  ds_read_b128 v[56:59], v2 offset:13312
  ds_read_b128 v[60:63], v2 offset:14336
  ds_read_b128 v[64:67], v2 offset:15360
  buffer_load_dwordx4 v[124:127], v3, s[4:7], s24 offen offset:1024 sc1
  buffer_load_dwordx4 v[116:119], v3, s[4:7], s25 offen offset:1024 sc1
  s_mov_b32 s19, 0
  s_branch T_loop_107
T_p1re_117:
  s_mov_b64 exec, vcc
  buffer_load_dwordx4 v[52:55], v2, s[4:7], s22 offen offset:0 sc1
  buffer_load_dwordx4 v[56:59], v2, s[4:7], s22 offen offset:1024 sc1
  buffer_load_dwordx4 v[60:63], v2, s[4:7], s22 offen offset:2048 sc1
  buffer_load_dwordx4 v[64:67], v2, s[4:7], s22 offen offset:3072 sc1
  s_mov_b64 exec, -1
  s_add_u32 s19, s19, 1
  s_cmp_gt_u32 s19, 32768
  s_cbranch_scc1 M_exit
  s_waitcnt vmcnt(3)
  v_mfma_f32_16x16x32_bf16 v[120:123], v[116:119], v[52:55], 0
  v_xor_b32 v48, s57, v52
  v_bitop3_b32 v48, v48, v54, s57 bitop3:0xf6
  s_waitcnt vmcnt(2)
  v_mfma_f32_16x16x32_bf16 v[120:123], v[116:119], v[56:59], v[120:123]
  v_bitop3_b32 v48, v48, v56, s57 bitop3:0xf6
  v_bitop3_b32 v48, v48, v58, s57 bitop3:0xf6
  s_waitcnt vmcnt(1)
  v_mfma_f32_16x16x32_bf16 v[120:123], v[116:119], v[60:63], v[120:123]
  v_bitop3_b32 v48, v48, v60, s57 bitop3:0xf6
  v_bitop3_b32 v48, v48, v62, s57 bitop3:0xf6
  s_waitcnt vmcnt(0)
  v_mfma_f32_16x16x32_bf16 v[120:123], v[116:119], v[64:67], v[120:123]
  v_bitop3_b32 v48, v48, v64, s57 bitop3:0xf6
  v_bitop3_b32 v48, v48, v66, s57 bitop3:0xf6
  v_and_b32 v48, 1, v48
  v_cmp_ne_u32 vcc, 0, v48
  s_cbranch_vccnz T_p1re_117
  s_branch T_p1ok_118
T_kvw_111:
  s_mov_b32 s19, 0
  s_branch T_kvok_120
T_kv_119:
  s_sleep 4
  s_add_u32 s19, s19, 1
  s_cmp_gt_u32 s19, 32768
  s_cbranch_scc1 M_exit
T_kvok_120:
  s_add_u32 s39, s99, 128
  s_mov_b32 s38, 0
  s_mov_b32 s37, 0
  s_atomic_or s38, s[58:59], s99 glc
  s_atomic_or s37, s[58:59], s39 glc
  s_waitcnt lgkmcnt(0)
  s_add_u32 s37, s37, 30
  s_cmp_ge_u32 s38, 30
  s_cselect_b32 s38, s37, s38
  s_cmp_ge_u32 s38, 64
  s_cselect_b32 s38, 100, s38
  s_sub_u32 s38, s38, 1
  s_max_i32 s30, s30, s38
  s_cmp_ge_i32 s14, s30
  s_cbranch_scc1 T_kv_119
  s_branch T_kvb_112
T_slow_114:
  s_nop 7
  v_max3_f32 v100, v16, v17, v18
  v_max3_f32 v100, v100, v19, v20
  v_max3_f32 v100, v100, v21, v22
  v_max3_f32 v100, v100, v23, v112
  v_max3_f32 v100, v100, v113, v114
  v_max_f32 v100, v100, v115
  v_mov_b32 v101, v100
  s_nop 1
  v_permlane32_swap_b32 v100, v101
  s_nop 1
  v_max_f32 v100, v100, v101
  v_mov_b32 v101, v100
  s_nop 1
  v_permlane16_swap_b32 v100, v101
  s_nop 1
  v_max_f32 v100, v100, v101
  v_sub_f32 v16, v16, v100
  v_sub_f32 v17, v17, v100
  v_sub_f32 v18, v18, v100
  v_sub_f32 v19, v19, v100
  v_exp_f32 v16, v16
  v_exp_f32 v17, v17
  v_exp_f32 v18, v18
  v_exp_f32 v19, v19
  v_sub_f32 v20, v20, v100
  v_sub_f32 v21, v21, v100
  v_sub_f32 v22, v22, v100
  v_sub_f32 v23, v23, v100
  v_exp_f32 v20, v20
  v_exp_f32 v21, v21
  v_exp_f32 v22, v22
  v_exp_f32 v23, v23
  v_sub_f32 v112, v112, v100
  v_sub_f32 v113, v113, v100
  v_sub_f32 v114, v114, v100
  v_sub_f32 v115, v115, v100
  v_exp_f32 v112, v112
  v_exp_f32 v113, v113
  v_exp_f32 v114, v114
  v_exp_f32 v115, v115
  s_nop 0
  v_cvt_pk_bf16_f32 v44, v16, v17
  v_cvt_pk_bf16_f32 v45, v18, v19
  v_cvt_pk_bf16_f32 v46, v20, v21
  v_cvt_pk_bf16_f32 v47, v22, v23
  v_cvt_pk_bf16_f32 v84, v112, v113
  v_cvt_pk_bf16_f32 v85, v114, v115
  v_cndmask_b32 v48, v84, 0, s[16:17]
  v_cndmask_b32 v49, v85, 0, s[16:17]
  v_cndmask_b32 v50, 0, v84, s[16:17]
  v_cndmask_b32 v51, 0, v85, s[16:17]
  s_nop 1
  v_mfma_f32_16x16x16_bf16 v[88:91], v[12:13], v[48:49], 0
  v_mfma_f32_16x16x16_bf16 v[24:27], v[120:121], v[48:49], 0
  v_mfma_f32_16x16x16_bf16 v[116:119], v[120:121], v[50:51], 0
  v_mfma_f32_16x16x32_bf16 v[88:91], v[12:15], v[44:47], v[88:91]
  v_mfma_f32_16x16x32_bf16 v[24:27], v[28:31], v[44:47], v[24:27]
  v_mfma_f32_16x16x32_bf16 v[116:119], v[32:35], v[44:47], v[116:119]
  s_nop 7
  s_nop 1
  v_rcp_f32 v89, v88
  s_nop 0
  v_mul_f32 v24, v89, v24
  v_mul_f32 v25, v89, v25
  s_branch T_back_115
T_w_91:
  s_mov_b32 s19, 0
  v_mov_b64 v[16:17], 0
  v_mov_b64 v[18:19], 0
  v_mov_b64 v[20:21], 0
  v_mov_b64 v[22:23], 0
  v_mov_b64 v[24:25], 0
  v_mov_b64 v[26:27], 0
  buffer_load_dwordx4 v[124:127], v3, s[4:7], s24 offen offset:2048 sc1
  buffer_load_dwordx4 v[116:119], v3, s[4:7], s25 offen offset:2048 sc1
  buffer_load_dwordx4 v[124:127], v3, s[4:7], s24 offen offset:2048 sc1
  buffer_load_dwordx4 v[116:119], v3, s[4:7], s25 offen offset:2048 sc1
  s_branch T_loop_121
.p2align 6
T_retry_122:
  s_mov_b64 exec, vcc
  buffer_load_dwordx4 v[124:127], v3, s[4:7], s24 offen offset:2048 sc1
  buffer_load_dwordx4 v[116:119], v3, s[4:7], s25 offen offset:2048 sc1
  s_mov_b64 exec, -1
  s_add_u32 s19, s19, 1
  s_cmp_gt_u32 s19, 32768
  s_cbranch_scc1 M_exit
T_loop_121:
  s_waitcnt vmcnt(3) lgkmcnt(0)
  v_max3_u32 v123, v124, v125, v126
  v_max_u32 v123, v123, v127
  v_mov_b32_dpp v120, v124 row_ror:8 row_mask:0xf bank_mask:0xf
  v_mov_b32_dpp v121, v125 row_ror:8 row_mask:0xf bank_mask:0xf
  s_waitcnt vmcnt(2)
  v_max3_u32 v123, v123, v116, v117
  v_max3_u32 v123, v123, v118, v119
  v_cmp_eq_u32 vcc, -1, v123
  s_cbranch_vccnz T_retry_122
  v_smfmac_f32_16x16x64_bf16 v[16:19], v[124:127], v[68:75], v0
  s_add_u32 s14, s14, 1
  ds_write_b128 v2, v[124:127] offset:2048
  v_mov_b32_dpp v122, v126 row_ror:8 row_mask:0xf bank_mask:0xf
  v_smfmac_f32_16x16x64_bf16 v[20:23], v[124:127], v[76:83], v0
  s_and_b32 s57, s14, 1
  v_mov_b32_dpp v123, v127 row_ror:8 row_mask:0xf bank_mask:0xf
  v_smfmac_f32_16x16x64_bf16 v[24:27], v[124:127], v[84:91], v0
  s_and_b32 s36, s14, 3
  ds_write_b128 v2, v[116:119] offset:6144
  v_smfmac_f32_16x16x64_bf16 v[16:19], v[120:123], v[92:99], v0
  s_lshl_b32 s36, s36, 13
  v_mov_b32_dpp v84, v116 row_ror:8 row_mask:0xf bank_mask:0xf
  v_smfmac_f32_16x16x64_bf16 v[20:23], v[120:123], v[100:107], v0
  s_add_u32 s26, s36, s23
  ds_read_b128 v[68:71], v4 offset:12288
  v_mov_b32_dpp v85, v117 row_ror:8 row_mask:0xf bank_mask:0xf
  v_smfmac_f32_16x16x64_bf16 v[24:27], v[120:123], v[108:115], v0
  s_add_u32 s36, s36, 8192
  ds_read_b128 v[72:75], v4 offset:13312
  v_mov_b32_dpp v86, v118 row_ror:8 row_mask:0xf bank_mask:0xf
  v_smfmac_f32_16x16x64_bf16 v[16:19], v[116:119], v[224:231], v0
  s_and_b32 s36, s36, 0x7fff
  ds_read_b128 v[76:79], v4 offset:14336
  v_mov_b32_dpp v87, v119 row_ror:8 row_mask:0xf bank_mask:0xf
  v_smfmac_f32_16x16x64_bf16 v[20:23], v[116:119], v[240:247], v0
  s_waitcnt lgkmcnt(3)
  s_barrier
  ds_read_b128 v[100:103], v2 offset:3072
  v_smfmac_f32_16x16x64_bf16 v[24:27], v[116:119], a[0:7], v0
  s_mov_b32 m0, s31
  ds_read_b128 v[120:123], v1 offset:3072
  v_smfmac_f32_16x16x64_bf16 v[16:19], v[84:87], v[232:239], v0
  s_cmp_ge_i32 s14, s30
  s_cbranch_scc1 T_kvw_125
T_kvb_126:
  v_smfmac_f32_16x16x64_bf16 v[20:23], v[84:87], v[248:255], v0
  ds_read_b128 v[80:83], v4 offset:15360
  v_smfmac_f32_16x16x64_bf16 v[24:27], v[84:87], a[8:15], v0
  s_waitcnt lgkmcnt(2)
  v_smfmac_f32_16x16x64_bf16 v[16:19], v[100:103], v[128:135], v0
  ds_read_b128 v[92:95], v2 offset:0
  buffer_load_dwordx4 v9, s[4:7], s27 offen sc1 lds
  v_smfmac_f32_16x16x64_bf16 v[20:23], v[100:103], v[144:151], v0
  ds_read_b128 v[96:99], v1 offset:0
  s_mov_b32 m0, s32
  v_smfmac_f32_16x16x64_bf16 v[24:27], v[100:103], v[68:75], v0
  s_waitcnt vmcnt(1) lgkmcnt(3)
  ds_read_b128 v[116:119], v2 offset:1024
  v_smfmac_f32_16x16x64_bf16 v[16:19], v[120:123], v[136:143], v0
  ds_read_b128 v[124:127], v1 offset:1024
  v_smfmac_f32_16x16x64_bf16 v[20:23], v[120:123], v[152:159], v0
  s_waitcnt lgkmcnt(4)
  ds_read_b128 v[104:107], v2 offset:7168
  buffer_load_dwordx4 v9, s[4:7], s27 offen offset:128 sc1 lds
  v_smfmac_f32_16x16x64_bf16 v[24:27], v[120:123], v[76:83], v0
  s_waitcnt lgkmcnt(4)
  ds_read_b128 v[108:111], v1 offset:7168
  s_mov_b32 m0, s33
  v_smfmac_f32_16x16x64_bf16 v[16:19], v[92:95], v[160:167], v0
  s_waitcnt lgkmcnt(4)
  ds_read_b128 v[112:115], v2 offset:4096
  v_mov_b32 v122, s98
  v_smfmac_f32_16x16x64_bf16 v[16:19], v[96:99], v[168:175], v0
  s_waitcnt lgkmcnt(4)
  ds_read_b128 v[84:87], v1 offset:4096
  v_smfmac_f32_16x16x64_bf16 v[16:19], v[116:119], v[192:199], v0
  s_waitcnt lgkmcnt(4)
  ds_read_b128 v[88:91], v2 offset:5120
  buffer_load_dwordx4 v10, s[4:7], s28 offen sc1 lds
  v_smfmac_f32_16x16x64_bf16 v[16:19], v[124:127], v[200:207], v0
  s_waitcnt lgkmcnt(4)
  ds_read_b128 v[100:103], v1 offset:5120
  s_mov_b32 m0, s34
  v_smfmac_f32_16x16x64_bf16 v[16:19], v[104:107], a[16:23], v0
  s_waitcnt lgkmcnt(4)
  ds_read_b128 v[68:71], v4 offset:16384
  v_smfmac_f32_16x16x64_bf16 v[16:19], v[108:111], a[24:31], v0
  s_waitcnt lgkmcnt(4)
  ds_read_b128 v[72:75], v4 offset:17408
  v_smfmac_f32_16x16x64_bf16 v[16:19], v[112:115], a[64:71], v0
  s_waitcnt lgkmcnt(4)
  ds_read_b128 v[76:79], v4 offset:18432
  buffer_load_dwordx4 v10, s[4:7], s28 offen offset:256 sc1 lds
  v_smfmac_f32_16x16x64_bf16 v[16:19], v[84:87], a[72:79], v0
  s_waitcnt lgkmcnt(4)
  ds_read_b128 v[80:83], v4 offset:19456
  v_smfmac_f32_16x16x64_bf16 v[16:19], v[88:91], a[112:119], v0
  s_waitcnt lgkmcnt(4)
  v_smfmac_f32_16x16x64_bf16 v[16:19], v[100:103], a[120:127], v0
  s_add_u32 s24, s36, 145752064
  s_add_u32 s25, s36, 145756160
  v_smfmac_f32_16x16x64_bf16 v[20:23], v[92:95], v[176:183], v0
  buffer_store_dword v122, v8, s[4:7], s15 offen sc1
  s_add_u32 s35, s36, s23
  v_smfmac_f32_16x16x64_bf16 v[20:23], v[96:99], v[184:191], v0
  s_waitcnt lgkmcnt(2)
  s_add_u32 s98, s14, 1
  v_smfmac_f32_16x16x64_bf16 v[20:23], v[116:119], v[68:75], v0
  s_waitcnt lgkmcnt(0)
  ds_read_b128 v[68:71], v4 offset:20480
  v_mul_f32 v16, s18, v16
  v_smfmac_f32_16x16x64_bf16 v[20:23], v[124:127], v[76:83], v0
  ds_read_b128 v[72:75], v4 offset:21504
  v_mul_f32 v17, s18, v17
  v_smfmac_f32_16x16x64_bf16 v[20:23], v[104:107], a[32:39], v0
  ds_read_b128 v[76:79], v4 offset:22528
  v_mul_f32 v18, s18, v18
  v_smfmac_f32_16x16x64_bf16 v[20:23], v[108:111], a[40:47], v0
  ds_read_b128 v[80:83], v4 offset:23552
  v_mul_f32 v19, s18, v19
  v_smfmac_f32_16x16x64_bf16 v[20:23], v[112:115], a[80:87], v0
  v_cvt_pk_bf16_f32 v120, v16, v17
  v_smfmac_f32_16x16x64_bf16 v[20:23], v[84:87], a[88:95], v0
  v_cvt_pk_bf16_f32 v121, v18, v19
  v_smfmac_f32_16x16x64_bf16 v[20:23], v[88:91], a[128:135], v0
  ds_write_b64 v5, v[120:121] offset:24576
  v_smfmac_f32_16x16x64_bf16 v[20:23], v[100:103], a[136:143], v0
  s_waitcnt lgkmcnt(3)
  v_smfmac_f32_16x16x64_bf16 v[24:27], v[92:95], v[68:75], v0
  s_waitcnt lgkmcnt(1)
  v_mov_b64 v[92:93], 0
  v_smfmac_f32_16x16x64_bf16 v[24:27], v[96:99], v[76:83], v0
  s_nop 1
  v_cvt_pk_bf16_f32 v122, v20, v21
  v_cvt_pk_bf16_f32 v123, v22, v23
  v_smfmac_f32_16x16x64_bf16 v[24:27], v[116:119], v[208:215], v0
  ds_write_b64 v5, v[122:123] offset:26880
  v_mov_b64 v[94:95], 0
  v_smfmac_f32_16x16x64_bf16 v[24:27], v[124:127], v[216:223], v0
  s_waitcnt lgkmcnt(1)
  s_barrier
  ds_read_b64_tr_b16 v[68:69], v6 offset:24576
  v_smfmac_f32_16x16x64_bf16 v[24:27], v[104:107], a[48:55], v0
  s_add_u32 s27, s27, 8192
  ds_read_b64_tr_b16 v[70:71], v6 offset:24640
  ds_read_b64_tr_b16 v[72:73], v6 offset:24832
  v_smfmac_f32_16x16x64_bf16 v[24:27], v[108:111], a[56:63], v0
  s_add_u32 s28, s28, 8192
  ds_read_b64_tr_b16 v[74:75], v6 offset:24896
  ds_read_b64_tr_b16 v[76:77], v6 offset:25088
  v_smfmac_f32_16x16x64_bf16 v[24:27], v[112:115], a[96:103], v0
  s_nop 0
  ds_read_b64_tr_b16 v[78:79], v6 offset:25152
  ds_read_b64_tr_b16 v[80:81], v6 offset:25344
  v_smfmac_f32_16x16x64_bf16 v[24:27], v[84:87], a[104:111], v0
  ds_read_b64_tr_b16 v[82:83], v6 offset:25408
  v_mov_b64 v[96:97], 0
  v_smfmac_f32_16x16x64_bf16 v[24:27], v[88:91], a[144:151], v0
  s_waitcnt lgkmcnt(8)
  s_barrier
  ds_read_b64_tr_b16 v[116:117], v6 offset:26880
  v_smfmac_f32_16x16x64_bf16 v[24:27], v[100:103], a[152:159], v0
  s_waitcnt lgkmcnt(7)
  ds_read_b64_tr_b16 v[118:119], v6 offset:26944
  v_mfma_f32_16x16x32_bf16 v[16:19], v[36:39], v[68:71], 0
  s_waitcnt lgkmcnt(6)
  ds_read_b64_tr_b16 v[124:125], v6 offset:27136
  ds_read_b64_tr_b16 v[126:127], v6 offset:27200
  v_mfma_f32_16x16x32_bf16 v[16:19], v[40:43], v[72:75], v[16:19]
  s_waitcnt lgkmcnt(6)
  ds_read_b64_tr_b16 v[104:105], v6 offset:27392
  ds_read_b64_tr_b16 v[106:107], v6 offset:27456
  v_mfma_f32_16x16x32_bf16 v[16:19], v[44:47], v[76:79], v[16:19]
  s_waitcnt lgkmcnt(6)
  ds_read_b64_tr_b16 v[108:109], v6 offset:27648
  ds_read_b64_tr_b16 v[110:111], v6 offset:27712
  v_mfma_f32_16x16x32_bf16 v[16:19], v[48:51], v[80:83], v[16:19]
  s_waitcnt lgkmcnt(6)
  v_cvt_pk_bf16_f32 v120, v24, v25
  v_cvt_pk_bf16_f32 v121, v26, v27
  v_mfma_f32_16x16x32_bf16 v[112:115], v[116:119], v[68:71], 0
  s_waitcnt lgkmcnt(4)
  v_mov_b64 v[98:99], 0
  v_mfma_f32_16x16x32_bf16 v[112:115], v[124:127], v[72:75], v[112:115]
  s_waitcnt lgkmcnt(2)
  v_mov_b64 v[36:37], 0
  v_exp_f32 v100, v16
  v_mfma_f32_16x16x32_bf16 v[112:115], v[104:107], v[76:79], v[112:115]
  s_waitcnt lgkmcnt(0)
  buffer_store_dwordx4 v[120:123], v2, s[4:7], s29 offen offset:2048 sc1
  v_exp_f32 v101, v17
  v_mfma_f32_16x16x32_bf16 v[112:115], v[108:111], v[80:83], v[112:115]
  v_exp_f32 v102, v18
  v_mfma_f32_16x16x32_bf16 v[20:23], v[52:55], v[68:71], 0
  s_cmp_eq_u32 s14, 63
  v_exp_f32 v103, v19
  v_mfma_f32_16x16x32_bf16 v[20:23], v[56:59], v[72:75], v[20:23]
  s_cbranch_scc1 M_tdone
  v_cvt_pk_bf16_f32 v44, v100, v101
  v_cvt_pk_bf16_f32 v45, v102, v103
  v_mfma_f32_16x16x32_bf16 v[20:23], v[60:63], v[76:79], v[20:23]
  s_add_u32 s29, s29, 131072
  v_exp_f32 v100, v112
  v_mfma_f32_16x16x32_bf16 v[20:23], v[64:67], v[80:83], v[20:23]
  v_exp_f32 v101, v113
  v_exp_f32 v102, v114
  v_exp_f32 v103, v115
  v_cvt_pk_bf16_f32 v84, v100, v101
  v_cvt_pk_bf16_f32 v85, v102, v103
  v_cndmask_b32 v48, v84, 0, s[16:17]
  v_cndmask_b32 v49, v85, 0, s[16:17]
  v_cndmask_b32 v50, 0, v84, s[16:17]
  v_cndmask_b32 v51, 0, v85, s[16:17]
  v_exp_f32 v100, v20
  v_mfma_f32_16x16x16_bf16 v[88:91], v[12:13], v[48:49], 0
  v_exp_f32 v101, v21
  v_mfma_f32_16x16x16_bf16 v[24:27], v[120:121], v[48:49], 0
  v_exp_f32 v102, v22
  v_mfma_f32_16x16x16_bf16 v[116:119], v[120:121], v[50:51], 0
  v_exp_f32 v103, v23
  v_cvt_pk_bf16_f32 v46, v100, v101
  v_cvt_pk_bf16_f32 v47, v102, v103
  v_mov_b64 v[38:39], 0
  s_nop 0
  v_mfma_f32_16x16x32_bf16 v[88:91], v[12:15], v[44:47], v[88:91]
  v_mov_b64 v[40:41], 0
  v_mov_b64 v[42:43], 0
  v_mfma_f32_16x16x32_bf16 v[24:27], v[28:31], v[44:47], v[24:27]
  ds_read_b128 v[52:55], v4 offset:24576
  ds_read_b128 v[56:59], v4 offset:25600
  v_mfma_f32_16x16x32_bf16 v[116:119], v[32:35], v[44:47], v[116:119]
  s_nop 1
  v_rcp_f32 v89, v88
  v_subrev_u32 v100, s54, v88
  v_cmp_le_u32 vcc, s55, v100
  v_mul_f32 v24, v89, v24
  v_mul_f32 v25, v89, v25
  s_cbranch_vccnz T_slow_128
T_back_129:
  v_cvt_pk_bf16_f32 v124, v24, v25
  v_pk_mul_f32 v[26:27], v[26:27], v[88:89] op_sel:[0,1] op_sel_hi:[1,1]
  v_pk_mul_f32 v[116:117], v[116:117], v[88:89] op_sel:[0,1] op_sel_hi:[1,1]
  v_pk_mul_f32 v[118:119], v[118:119], v[88:89] op_sel:[0,1] op_sel_hi:[1,1]
  v_cvt_pk_bf16_f32 v125, v26, v27
  v_cvt_pk_bf16_f32 v126, v116, v117
  v_cvt_pk_bf16_f32 v127, v118, v119
  ds_write_b128 v11, v[124:127] offset:30208
  s_nop 0
  v_smfmac_f32_16x16x64_bf16 v[92:95], v[124:127], a[160:167], v0
  v_smfmac_f32_16x16x64_bf16 v[96:99], v[124:127], a[168:175], v0
  v_smfmac_f32_16x16x64_bf16 v[36:39], v[124:127], a[176:183], v0
  v_smfmac_f32_16x16x64_bf16 v[40:43], v[124:127], a[184:191], v0
  s_waitcnt lgkmcnt(0)
  s_barrier
  ds_read_b128 v[104:107], v11 offset:30720
  ds_read_b128 v[108:111], v11 offset:29184
  ds_read_b128 v[68:71], v11 offset:29696
  s_waitcnt lgkmcnt(2)
  v_smfmac_f32_16x16x64_bf16 v[92:95], v[104:107], a[192:199], v0
  s_waitcnt lgkmcnt(1)
  ds_read_b128 v[76:79], v4 offset:28672
  v_smfmac_f32_16x16x64_bf16 v[92:95], v[108:111], a[224:231], v0
  s_waitcnt lgkmcnt(1)
  ds_read_b128 v[80:83], v4 offset:29696
  v_smfmac_f32_16x16x64_bf16 v[92:95], v[68:71], a[240:247], v0
  ds_read_b128 v[60:63], v4 offset:26624
  v_smfmac_f32_16x16x64_bf16 v[96:99], v[104:107], a[200:207], v0
  ds_read_b128 v[64:67], v4 offset:27648
  v_smfmac_f32_16x16x64_bf16 v[96:99], v[108:111], a[232:239], v0
  ds_read_b128 v[28:31], v4 offset:30720
  s_nop 0
  v_cvt_pk_bf16_f32 v16, v92, v93
  v_cvt_pk_bf16_f32 v17, v94, v95
  v_bfi_b32 v16, 1, s57, v16
  v_smfmac_f32_16x16x64_bf16 v[96:99], v[68:71], a[248:255], v0
  buffer_store_dwordx2 v[16:17], v7, s[4:7], s20 offen offset:0
  v_smfmac_f32_16x16x64_bf16 v[36:39], v[104:107], a[208:215], v0
  ds_read_b128 v[32:35], v4 offset:31744
  v_smfmac_f32_16x16x64_bf16 v[36:39], v[108:111], v[52:59], v0
  s_waitcnt lgkmcnt(4)
  s_nop 0
  v_cvt_pk_bf16_f32 v18, v96, v97
  v_cvt_pk_bf16_f32 v19, v98, v99
  v_bfi_b32 v18, 1, s57, v18
  v_smfmac_f32_16x16x64_bf16 v[36:39], v[68:71], v[76:83], v0
  buffer_store_dwordx2 v[18:19], v7, s[4:7], s20 offen offset:64
  v_smfmac_f32_16x16x64_bf16 v[40:43], v[104:107], a[216:223], v0
  s_waitcnt lgkmcnt(2)
  v_smfmac_f32_16x16x64_bf16 v[40:43], v[108:111], v[60:67], v0
  s_waitcnt lgkmcnt(0)
  s_nop 0
  v_cvt_pk_bf16_f32 v20, v36, v37
  v_cvt_pk_bf16_f32 v21, v38, v39
  v_bfi_b32 v20, 1, s57, v20
  v_smfmac_f32_16x16x64_bf16 v[40:43], v[68:71], v[28:35], v0
  buffer_store_dwordx2 v[20:21], v7, s[4:7], s21 offen offset:0
  s_nop 6
  v_cvt_pk_bf16_f32 v22, v40, v41
  v_cvt_pk_bf16_f32 v23, v42, v43
  v_bfi_b32 v22, 1, s57, v22
  buffer_store_dwordx2 v[22:23], v7, s[4:7], s21 offen offset:64
  ds_read_b128 v[68:71], v4 offset:0
  ds_read_b128 v[72:75], v4 offset:1024
  ds_read_b128 v[76:79], v4 offset:4096
  ds_read_b128 v[80:83], v4 offset:5120
  ds_read_b128 v[84:87], v4 offset:8192
  ds_read_b128 v[88:91], v4 offset:9216
  ds_read_b128 v[92:95], v4 offset:2048
  ds_read_b128 v[96:99], v4 offset:3072
  ds_read_b128 v[100:103], v4 offset:6144
  ds_read_b128 v[104:107], v4 offset:7168
  ds_read_b128 v[108:111], v4 offset:10240
  ds_read_b128 v[112:115], v4 offset:11264
  v_mov_b64 v[16:17], 0
  v_mov_b64 v[18:19], 0
  v_mov_b64 v[20:21], 0
  v_mov_b64 v[22:23], 0
  v_mov_b64 v[24:25], 0
  v_mov_b64 v[26:27], 0
  ds_read_b64 v[44:45], v2 offset:32256
  s_waitcnt lgkmcnt(0)
  v_readfirstlane_b32 s38, v44
  v_readfirstlane_b32 s37, v45
  s_nop 0
  s_add_u32 s37, s37, 30
  s_cmp_ge_u32 s38, 30
  s_cselect_b32 s38, s37, s38
  s_cmp_ge_u32 s38, 64
  s_cselect_b32 s38, 100, s38
  s_sub_u32 s38, s38, 1
  s_max_i32 s30, s30, s38
  s_waitcnt vmcnt(4)
  s_barrier
  ds_read_b128 v[28:31], v2 offset:18432
  ds_read_b128 v[32:35], v2 offset:22528
  ds_read_b128 v[36:39], v2 offset:8192
  ds_read_b128 v[40:43], v2 offset:9216
  ds_read_b128 v[44:47], v2 offset:10240
  ds_read_b128 v[48:51], v2 offset:11264
  buffer_load_dwordx4 v[124:127], v3, s[4:7], s24 offen offset:2048 sc1
  buffer_load_dwordx4 v[116:119], v3, s[4:7], s25 offen offset:2048 sc1
  ds_read_b128 v[52:55], v2 offset:12288
  ds_read_b128 v[56:59], v2 offset:13312
  ds_read_b128 v[60:63], v2 offset:14336
  ds_read_b128 v[64:67], v2 offset:15360
  buffer_load_dwordx4 v[124:127], v3, s[4:7], s24 offen offset:2048 sc1
  buffer_load_dwordx4 v[116:119], v3, s[4:7], s25 offen offset:2048 sc1
  s_mov_b32 s19, 0
  s_branch T_loop_121
T_kvw_125:
  s_mov_b32 s19, 0
  s_branch T_kvok_134
T_kv_133:
  s_sleep 4
  s_add_u32 s19, s19, 1
  s_cmp_gt_u32 s19, 32768
  s_cbranch_scc1 M_exit
T_kvok_134:
  s_add_u32 s39, s99, 128
  s_mov_b32 s38, 0
  s_mov_b32 s37, 0
  s_atomic_or s38, s[58:59], s99 glc
  s_atomic_or s37, s[58:59], s39 glc
  s_waitcnt lgkmcnt(0)
  s_add_u32 s37, s37, 30
  s_cmp_ge_u32 s38, 30
  s_cselect_b32 s38, s37, s38
  s_cmp_ge_u32 s38, 64
  s_cselect_b32 s38, 100, s38
  s_sub_u32 s38, s38, 1
  s_max_i32 s30, s30, s38
  s_cmp_ge_i32 s14, s30
  s_cbranch_scc1 T_kv_133
  s_branch T_kvb_126
T_slow_128:
  s_nop 7
  v_max3_f32 v100, v16, v17, v18
  v_max3_f32 v100, v100, v19, v20
  v_max3_f32 v100, v100, v21, v22
  v_max3_f32 v100, v100, v23, v112
  v_max3_f32 v100, v100, v113, v114
  v_max_f32 v100, v100, v115
  v_mov_b32 v101, v100
  s_nop 1
  v_permlane32_swap_b32 v100, v101
  s_nop 1
  v_max_f32 v100, v100, v101
  v_mov_b32 v101, v100
  s_nop 1
  v_permlane16_swap_b32 v100, v101
  s_nop 1
  v_max_f32 v100, v100, v101
  v_sub_f32 v16, v16, v100
  v_sub_f32 v17, v17, v100
  v_sub_f32 v18, v18, v100
  v_sub_f32 v19, v19, v100
  v_exp_f32 v16, v16
  v_exp_f32 v17, v17
  v_exp_f32 v18, v18
  v_exp_f32 v19, v19
  v_sub_f32 v20, v20, v100
  v_sub_f32 v21, v21, v100
  v_sub_f32 v22, v22, v100
  v_sub_f32 v23, v23, v100
  v_exp_f32 v20, v20
  v_exp_f32 v21, v21
  v_exp_f32 v22, v22
  v_exp_f32 v23, v23
  v_sub_f32 v112, v112, v100
  v_sub_f32 v113, v113, v100
  v_sub_f32 v114, v114, v100
  v_sub_f32 v115, v115, v100
  v_exp_f32 v112, v112
  v_exp_f32 v113, v113
  v_exp_f32 v114, v114
  v_exp_f32 v115, v115
  s_nop 0
  v_cvt_pk_bf16_f32 v44, v16, v17
  v_cvt_pk_bf16_f32 v45, v18, v19
  v_cvt_pk_bf16_f32 v46, v20, v21
  v_cvt_pk_bf16_f32 v47, v22, v23
  v_cvt_pk_bf16_f32 v84, v112, v113
  v_cvt_pk_bf16_f32 v85, v114, v115
  v_cndmask_b32 v48, v84, 0, s[16:17]
  v_cndmask_b32 v49, v85, 0, s[16:17]
  v_cndmask_b32 v50, 0, v84, s[16:17]
  v_cndmask_b32 v51, 0, v85, s[16:17]
  s_nop 1
  v_mfma_f32_16x16x16_bf16 v[88:91], v[12:13], v[48:49], 0
  v_mfma_f32_16x16x16_bf16 v[24:27], v[120:121], v[48:49], 0
  v_mfma_f32_16x16x16_bf16 v[116:119], v[120:121], v[50:51], 0
  v_mfma_f32_16x16x32_bf16 v[88:91], v[12:15], v[44:47], v[88:91]
  v_mfma_f32_16x16x32_bf16 v[24:27], v[28:31], v[44:47], v[24:27]
  v_mfma_f32_16x16x32_bf16 v[116:119], v[32:35], v[44:47], v[116:119]
  s_nop 7
  s_nop 1
  v_rcp_f32 v89, v88
  s_nop 0
  v_mul_f32 v24, v89, v24
  v_mul_f32 v25, v89, v25
  s_branch T_back_129
T_w_92:
  s_mov_b32 s19, 0
  v_mov_b64 v[16:17], 0
  v_mov_b64 v[18:19], 0
  v_mov_b64 v[20:21], 0
  v_mov_b64 v[22:23], 0
  v_mov_b64 v[24:25], 0
  v_mov_b64 v[26:27], 0
  buffer_load_dwordx4 v[124:127], v3, s[4:7], s24 offen offset:3072 sc1
  buffer_load_dwordx4 v[116:119], v3, s[4:7], s25 offen offset:3072 sc1
  buffer_load_dwordx4 v[124:127], v3, s[4:7], s24 offen offset:3072 sc1
  buffer_load_dwordx4 v[116:119], v3, s[4:7], s25 offen offset:3072 sc1
  s_branch T_loop_135
.p2align 6
T_retry_136:
  s_mov_b64 exec, vcc
  buffer_load_dwordx4 v[124:127], v3, s[4:7], s24 offen offset:3072 sc1
  buffer_load_dwordx4 v[116:119], v3, s[4:7], s25 offen offset:3072 sc1
  s_mov_b64 exec, -1
  s_add_u32 s19, s19, 1
  s_cmp_gt_u32 s19, 32768
  s_cbranch_scc1 M_exit
T_loop_135:
  s_waitcnt vmcnt(3) lgkmcnt(0)
  v_max3_u32 v123, v124, v125, v126
  v_max_u32 v123, v123, v127
  v_mov_b32_dpp v120, v124 row_ror:8 row_mask:0xf bank_mask:0xf
  v_mov_b32_dpp v121, v125 row_ror:8 row_mask:0xf bank_mask:0xf
  s_waitcnt vmcnt(2)
  v_max3_u32 v123, v123, v116, v117
  v_max3_u32 v123, v123, v118, v119
  v_cmp_eq_u32 vcc, -1, v123
  s_cbranch_vccnz T_retry_136
  v_smfmac_f32_16x16x64_bf16 v[16:19], v[124:127], v[68:75], v0
  s_add_u32 s14, s14, 1
  ds_write_b128 v2, v[124:127] offset:3072
  v_mov_b32_dpp v122, v126 row_ror:8 row_mask:0xf bank_mask:0xf
  v_smfmac_f32_16x16x64_bf16 v[20:23], v[124:127], v[76:83], v0
  s_and_b32 s57, s14, 1
  v_mov_b32_dpp v123, v127 row_ror:8 row_mask:0xf bank_mask:0xf
  v_smfmac_f32_16x16x64_bf16 v[24:27], v[124:127], v[84:91], v0
  s_and_b32 s36, s14, 3
  ds_write_b128 v2, v[116:119] offset:7168
  v_smfmac_f32_16x16x64_bf16 v[16:19], v[120:123], v[92:99], v0
  s_lshl_b32 s36, s36, 13
  v_mov_b32_dpp v84, v116 row_ror:8 row_mask:0xf bank_mask:0xf
  v_smfmac_f32_16x16x64_bf16 v[20:23], v[120:123], v[100:107], v0
  s_add_u32 s26, s36, s23
  ds_read_b128 v[68:71], v4 offset:12288
  v_mov_b32_dpp v85, v117 row_ror:8 row_mask:0xf bank_mask:0xf
  v_smfmac_f32_16x16x64_bf16 v[24:27], v[120:123], v[108:115], v0
  s_add_u32 s36, s36, 8192
  ds_read_b128 v[72:75], v4 offset:13312
  v_mov_b32_dpp v86, v118 row_ror:8 row_mask:0xf bank_mask:0xf
  v_smfmac_f32_16x16x64_bf16 v[16:19], v[116:119], v[224:231], v0
  s_and_b32 s36, s36, 0x7fff
  ds_read_b128 v[76:79], v4 offset:14336
  v_mov_b32_dpp v87, v119 row_ror:8 row_mask:0xf bank_mask:0xf
  v_smfmac_f32_16x16x64_bf16 v[20:23], v[116:119], v[240:247], v0
  s_waitcnt lgkmcnt(3)
  s_barrier
  ds_read_b128 v[100:103], v2 offset:2048
  v_smfmac_f32_16x16x64_bf16 v[24:27], v[116:119], a[0:7], v0
  s_mov_b32 m0, s31
  ds_read_b128 v[120:123], v1 offset:2048
  v_smfmac_f32_16x16x64_bf16 v[16:19], v[84:87], v[232:239], v0
  s_cmp_ge_i32 s14, s30
  s_cbranch_scc1 T_kvw_139
T_kvb_140:
  v_smfmac_f32_16x16x64_bf16 v[20:23], v[84:87], v[248:255], v0
  ds_read_b128 v[80:83], v4 offset:15360
  v_smfmac_f32_16x16x64_bf16 v[24:27], v[84:87], a[8:15], v0
  s_waitcnt lgkmcnt(2)
  v_smfmac_f32_16x16x64_bf16 v[16:19], v[100:103], v[128:135], v0
  ds_read_b128 v[92:95], v2 offset:1024
  v_smfmac_f32_16x16x64_bf16 v[20:23], v[100:103], v[144:151], v0
  ds_read_b128 v[96:99], v1 offset:1024
  buffer_load_dwordx4 v9, s[4:7], s27 offen sc1 lds
  v_smfmac_f32_16x16x64_bf16 v[24:27], v[100:103], v[68:75], v0
  s_waitcnt vmcnt(1) lgkmcnt(3)
  ds_read_b128 v[116:119], v2 offset:0
  s_mov_b32 m0, s32
  v_smfmac_f32_16x16x64_bf16 v[16:19], v[120:123], v[136:143], v0
  ds_read_b128 v[124:127], v1 offset:0
  v_smfmac_f32_16x16x64_bf16 v[20:23], v[120:123], v[152:159], v0
  s_waitcnt lgkmcnt(4)
  ds_read_b128 v[104:107], v2 offset:6144
  v_smfmac_f32_16x16x64_bf16 v[24:27], v[120:123], v[76:83], v0
  s_waitcnt lgkmcnt(4)
  ds_read_b128 v[108:111], v1 offset:6144
  buffer_load_dwordx4 v9, s[4:7], s27 offen offset:128 sc1 lds
  v_smfmac_f32_16x16x64_bf16 v[16:19], v[92:95], v[160:167], v0
  s_waitcnt lgkmcnt(4)
  ds_read_b128 v[112:115], v2 offset:5120
  s_mov_b32 m0, s33
  v_smfmac_f32_16x16x64_bf16 v[16:19], v[96:99], v[168:175], v0
  s_waitcnt lgkmcnt(4)
  ds_read_b128 v[84:87], v1 offset:5120
  v_smfmac_f32_16x16x64_bf16 v[16:19], v[116:119], v[192:199], v0
  s_waitcnt lgkmcnt(4)
  ds_read_b128 v[88:91], v2 offset:4096
  v_smfmac_f32_16x16x64_bf16 v[16:19], v[124:127], v[200:207], v0
  s_waitcnt lgkmcnt(4)
  ds_read_b128 v[100:103], v1 offset:4096
  buffer_load_dwordx4 v10, s[4:7], s28 offen sc1 lds
  v_smfmac_f32_16x16x64_bf16 v[16:19], v[104:107], a[16:23], v0
  s_waitcnt lgkmcnt(4)
  ds_read_b128 v[68:71], v4 offset:16384
  s_mov_b32 m0, s34
  v_smfmac_f32_16x16x64_bf16 v[16:19], v[108:111], a[24:31], v0
  s_waitcnt lgkmcnt(4)
  ds_read_b128 v[72:75], v4 offset:17408
  v_smfmac_f32_16x16x64_bf16 v[16:19], v[112:115], a[64:71], v0
  s_waitcnt lgkmcnt(4)
  ds_read_b128 v[76:79], v4 offset:18432
  v_smfmac_f32_16x16x64_bf16 v[16:19], v[84:87], a[72:79], v0
  s_waitcnt lgkmcnt(4)
  ds_read_b128 v[80:83], v4 offset:19456
  buffer_load_dwordx4 v10, s[4:7], s28 offen offset:256 sc1 lds
  v_smfmac_f32_16x16x64_bf16 v[16:19], v[88:91], a[112:119], v0
  s_waitcnt lgkmcnt(4)
  s_mov_b32 m0, 32256
  v_smfmac_f32_16x16x64_bf16 v[16:19], v[100:103], a[120:127], v0
  s_add_u32 s24, s36, 145752064
  s_add_u32 s25, s36, 145756160
  v_smfmac_f32_16x16x64_bf16 v[20:23], v[92:95], v[176:183], v0
  s_add_u32 s35, s36, s23
  v_smfmac_f32_16x16x64_bf16 v[20:23], v[96:99], v[184:191], v0
  s_waitcnt lgkmcnt(2)
  buffer_load_dword v8, s[4:7], s99 offen sc1 lds
  v_smfmac_f32_16x16x64_bf16 v[20:23], v[116:119], v[68:75], v0
  s_waitcnt lgkmcnt(0)
  ds_read_b128 v[68:71], v4 offset:20480
  v_mul_f32 v16, s18, v16
  v_smfmac_f32_16x16x64_bf16 v[20:23], v[124:127], v[76:83], v0
  ds_read_b128 v[72:75], v4 offset:21504
  v_mul_f32 v17, s18, v17
  v_smfmac_f32_16x16x64_bf16 v[20:23], v[104:107], a[32:39], v0
  ds_read_b128 v[76:79], v4 offset:22528
  v_mul_f32 v18, s18, v18
  v_smfmac_f32_16x16x64_bf16 v[20:23], v[108:111], a[40:47], v0
  ds_read_b128 v[80:83], v4 offset:23552
  v_mul_f32 v19, s18, v19
  v_smfmac_f32_16x16x64_bf16 v[20:23], v[112:115], a[80:87], v0
  v_cvt_pk_bf16_f32 v120, v16, v17
  v_smfmac_f32_16x16x64_bf16 v[20:23], v[84:87], a[88:95], v0
  v_cvt_pk_bf16_f32 v121, v18, v19
  v_smfmac_f32_16x16x64_bf16 v[20:23], v[88:91], a[128:135], v0
  ds_write_b64 v5, v[120:121] offset:24576
  v_smfmac_f32_16x16x64_bf16 v[20:23], v[100:103], a[136:143], v0
  s_waitcnt lgkmcnt(3)
  v_smfmac_f32_16x16x64_bf16 v[24:27], v[92:95], v[68:75], v0
  s_waitcnt lgkmcnt(1)
  v_mov_b64 v[92:93], 0
  v_smfmac_f32_16x16x64_bf16 v[24:27], v[96:99], v[76:83], v0
  s_nop 1
  v_cvt_pk_bf16_f32 v122, v20, v21
  v_cvt_pk_bf16_f32 v123, v22, v23
  v_smfmac_f32_16x16x64_bf16 v[24:27], v[116:119], v[208:215], v0
  ds_write_b64 v5, v[122:123] offset:26880
  v_mov_b64 v[94:95], 0
  v_smfmac_f32_16x16x64_bf16 v[24:27], v[124:127], v[216:223], v0
  s_waitcnt lgkmcnt(1)
  s_barrier
  ds_read_b64_tr_b16 v[68:69], v6 offset:24576
  v_smfmac_f32_16x16x64_bf16 v[24:27], v[104:107], a[48:55], v0
  s_add_u32 s27, s27, 8192
  ds_read_b64_tr_b16 v[70:71], v6 offset:24640
  ds_read_b64_tr_b16 v[72:73], v6 offset:24832
  v_smfmac_f32_16x16x64_bf16 v[24:27], v[108:111], a[56:63], v0
  s_add_u32 s28, s28, 8192
  ds_read_b64_tr_b16 v[74:75], v6 offset:24896
  ds_read_b64_tr_b16 v[76:77], v6 offset:25088
  v_smfmac_f32_16x16x64_bf16 v[24:27], v[112:115], a[96:103], v0
  s_nop 0
  ds_read_b64_tr_b16 v[78:79], v6 offset:25152
  ds_read_b64_tr_b16 v[80:81], v6 offset:25344
  v_smfmac_f32_16x16x64_bf16 v[24:27], v[84:87], a[104:111], v0
  ds_read_b64_tr_b16 v[82:83], v6 offset:25408
  v_mov_b64 v[96:97], 0
  v_smfmac_f32_16x16x64_bf16 v[24:27], v[88:91], a[144:151], v0
  s_waitcnt lgkmcnt(8)
  s_barrier
  ds_read_b64_tr_b16 v[116:117], v6 offset:26880
  v_smfmac_f32_16x16x64_bf16 v[24:27], v[100:103], a[152:159], v0
  s_waitcnt lgkmcnt(7)
  ds_read_b64_tr_b16 v[118:119], v6 offset:26944
  v_mfma_f32_16x16x32_bf16 v[16:19], v[36:39], v[68:71], 0
  s_waitcnt lgkmcnt(6)
  ds_read_b64_tr_b16 v[124:125], v6 offset:27136
  ds_read_b64_tr_b16 v[126:127], v6 offset:27200
  v_mfma_f32_16x16x32_bf16 v[16:19], v[40:43], v[72:75], v[16:19]
  s_waitcnt lgkmcnt(6)
  ds_read_b64_tr_b16 v[104:105], v6 offset:27392
  ds_read_b64_tr_b16 v[106:107], v6 offset:27456
  v_mfma_f32_16x16x32_bf16 v[16:19], v[44:47], v[76:79], v[16:19]
  s_waitcnt lgkmcnt(6)
  ds_read_b64_tr_b16 v[108:109], v6 offset:27648
  ds_read_b64_tr_b16 v[110:111], v6 offset:27712
  v_mfma_f32_16x16x32_bf16 v[16:19], v[48:51], v[80:83], v[16:19]
  s_waitcnt lgkmcnt(6)
  v_cvt_pk_bf16_f32 v120, v24, v25
  v_cvt_pk_bf16_f32 v121, v26, v27
  v_mfma_f32_16x16x32_bf16 v[112:115], v[116:119], v[68:71], 0
  s_waitcnt lgkmcnt(4)
  v_mov_b64 v[98:99], 0
  v_mfma_f32_16x16x32_bf16 v[112:115], v[124:127], v[72:75], v[112:115]
  s_waitcnt lgkmcnt(2)
  v_mov_b64 v[36:37], 0
  v_exp_f32 v100, v16
  v_mfma_f32_16x16x32_bf16 v[112:115], v[104:107], v[76:79], v[112:115]
  s_waitcnt lgkmcnt(0)
  v_exp_f32 v101, v17
  v_mfma_f32_16x16x32_bf16 v[112:115], v[108:111], v[80:83], v[112:115]
  buffer_store_dwordx4 v[120:123], v2, s[4:7], s29 offen offset:3072 sc1
  v_exp_f32 v102, v18
  v_mfma_f32_16x16x32_bf16 v[20:23], v[52:55], v[68:71], 0
  s_cmp_eq_u32 s14, 63
  v_exp_f32 v103, v19
  v_mfma_f32_16x16x32_bf16 v[20:23], v[56:59], v[72:75], v[20:23]
  s_cbranch_scc1 M_tdone
  v_cvt_pk_bf16_f32 v44, v100, v101
  v_cvt_pk_bf16_f32 v45, v102, v103
  v_mfma_f32_16x16x32_bf16 v[20:23], v[60:63], v[76:79], v[20:23]
  s_add_u32 s29, s29, 131072
  v_exp_f32 v100, v112
  v_mfma_f32_16x16x32_bf16 v[20:23], v[64:67], v[80:83], v[20:23]
  v_exp_f32 v101, v113
  v_exp_f32 v102, v114
  v_exp_f32 v103, v115
  v_cvt_pk_bf16_f32 v84, v100, v101
  v_cvt_pk_bf16_f32 v85, v102, v103
  v_cndmask_b32 v48, v84, 0, s[16:17]
  v_cndmask_b32 v49, v85, 0, s[16:17]
  v_cndmask_b32 v50, 0, v84, s[16:17]
  v_cndmask_b32 v51, 0, v85, s[16:17]
  v_exp_f32 v100, v20
  v_mfma_f32_16x16x16_bf16 v[88:91], v[12:13], v[48:49], 0
  v_exp_f32 v101, v21
  v_mfma_f32_16x16x16_bf16 v[24:27], v[120:121], v[48:49], 0
  v_exp_f32 v102, v22
  v_mfma_f32_16x16x16_bf16 v[116:119], v[120:121], v[50:51], 0
  v_exp_f32 v103, v23
  v_cvt_pk_bf16_f32 v46, v100, v101
  v_cvt_pk_bf16_f32 v47, v102, v103
  v_mov_b64 v[38:39], 0
  s_nop 0
  v_mfma_f32_16x16x32_bf16 v[88:91], v[12:15], v[44:47], v[88:91]
  v_mov_b64 v[40:41], 0
  v_mov_b64 v[42:43], 0
  v_mfma_f32_16x16x32_bf16 v[24:27], v[28:31], v[44:47], v[24:27]
  ds_read_b128 v[52:55], v4 offset:24576
  ds_read_b128 v[56:59], v4 offset:25600
  v_mfma_f32_16x16x32_bf16 v[116:119], v[32:35], v[44:47], v[116:119]
  s_nop 1
  v_rcp_f32 v89, v88
  v_subrev_u32 v100, s54, v88
  v_cmp_le_u32 vcc, s55, v100
  v_mul_f32 v24, v89, v24
  v_mul_f32 v25, v89, v25
  s_cbranch_vccnz T_slow_142
T_back_143:
  v_cvt_pk_bf16_f32 v124, v24, v25
  v_pk_mul_f32 v[26:27], v[26:27], v[88:89] op_sel:[0,1] op_sel_hi:[1,1]
  v_pk_mul_f32 v[116:117], v[116:117], v[88:89] op_sel:[0,1] op_sel_hi:[1,1]
  v_pk_mul_f32 v[118:119], v[118:119], v[88:89] op_sel:[0,1] op_sel_hi:[1,1]
  v_cvt_pk_bf16_f32 v125, v26, v27
  v_cvt_pk_bf16_f32 v126, v116, v117
  v_cvt_pk_bf16_f32 v127, v118, v119
  ds_write_b128 v11, v[124:127] offset:30720
  s_nop 0
  v_smfmac_f32_16x16x64_bf16 v[92:95], v[124:127], a[160:167], v0
  v_smfmac_f32_16x16x64_bf16 v[96:99], v[124:127], a[168:175], v0
  v_smfmac_f32_16x16x64_bf16 v[36:39], v[124:127], a[176:183], v0
  v_smfmac_f32_16x16x64_bf16 v[40:43], v[124:127], a[184:191], v0
  s_waitcnt lgkmcnt(0)
  s_barrier
  ds_read_b128 v[104:107], v11 offset:30208
  ds_read_b128 v[108:111], v11 offset:29696
  ds_read_b128 v[68:71], v11 offset:29184
  s_waitcnt lgkmcnt(2)
  v_smfmac_f32_16x16x64_bf16 v[92:95], v[104:107], a[192:199], v0
  s_waitcnt lgkmcnt(1)
  ds_read_b128 v[76:79], v4 offset:28672
  v_smfmac_f32_16x16x64_bf16 v[92:95], v[108:111], a[224:231], v0
  s_waitcnt lgkmcnt(1)
  ds_read_b128 v[80:83], v4 offset:29696
  v_smfmac_f32_16x16x64_bf16 v[92:95], v[68:71], a[240:247], v0
  ds_read_b128 v[60:63], v4 offset:26624
  v_smfmac_f32_16x16x64_bf16 v[96:99], v[104:107], a[200:207], v0
  ds_read_b128 v[64:67], v4 offset:27648
  v_smfmac_f32_16x16x64_bf16 v[96:99], v[108:111], a[232:239], v0
  ds_read_b128 v[28:31], v4 offset:30720
  s_nop 0
  v_cvt_pk_bf16_f32 v16, v92, v93
  v_cvt_pk_bf16_f32 v17, v94, v95
  v_bfi_b32 v16, 1, s57, v16
  v_smfmac_f32_16x16x64_bf16 v[96:99], v[68:71], a[248:255], v0
  buffer_store_dwordx2 v[16:17], v7, s[4:7], s20 offen offset:0
  v_smfmac_f32_16x16x64_bf16 v[36:39], v[104:107], a[208:215], v0
  ds_read_b128 v[32:35], v4 offset:31744
  v_smfmac_f32_16x16x64_bf16 v[36:39], v[108:111], v[52:59], v0
  s_waitcnt lgkmcnt(4)
  s_nop 0
  v_cvt_pk_bf16_f32 v18, v96, v97
  v_cvt_pk_bf16_f32 v19, v98, v99
  v_bfi_b32 v18, 1, s57, v18
  v_smfmac_f32_16x16x64_bf16 v[36:39], v[68:71], v[76:83], v0
  buffer_store_dwordx2 v[18:19], v7, s[4:7], s20 offen offset:64
  v_smfmac_f32_16x16x64_bf16 v[40:43], v[104:107], a[216:223], v0
  s_waitcnt lgkmcnt(2)
  v_smfmac_f32_16x16x64_bf16 v[40:43], v[108:111], v[60:67], v0
  s_waitcnt lgkmcnt(0)
  s_nop 0
  v_cvt_pk_bf16_f32 v20, v36, v37
  v_cvt_pk_bf16_f32 v21, v38, v39
  v_bfi_b32 v20, 1, s57, v20
  v_smfmac_f32_16x16x64_bf16 v[40:43], v[68:71], v[28:35], v0
  buffer_store_dwordx2 v[20:21], v7, s[4:7], s21 offen offset:0
  s_nop 6
  v_cvt_pk_bf16_f32 v22, v40, v41
  v_cvt_pk_bf16_f32 v23, v42, v43
  v_bfi_b32 v22, 1, s57, v22
  buffer_store_dwordx2 v[22:23], v7, s[4:7], s21 offen offset:64
  ds_read_b128 v[68:71], v4 offset:0
  ds_read_b128 v[72:75], v4 offset:1024
  ds_read_b128 v[76:79], v4 offset:4096
  ds_read_b128 v[80:83], v4 offset:5120
  ds_read_b128 v[84:87], v4 offset:8192
  ds_read_b128 v[88:91], v4 offset:9216
  ds_read_b128 v[92:95], v4 offset:2048
  ds_read_b128 v[96:99], v4 offset:3072
  ds_read_b128 v[100:103], v4 offset:6144
  ds_read_b128 v[104:107], v4 offset:7168
  ds_read_b128 v[108:111], v4 offset:10240
  ds_read_b128 v[112:115], v4 offset:11264
  v_mov_b64 v[16:17], 0
  v_mov_b64 v[18:19], 0
  v_mov_b64 v[20:21], 0
  v_mov_b64 v[22:23], 0
  v_mov_b64 v[24:25], 0
  v_mov_b64 v[26:27], 0
  ds_read_b64 v[44:45], v2 offset:32256
  s_waitcnt lgkmcnt(0)
  v_readfirstlane_b32 s38, v44
  v_readfirstlane_b32 s37, v45
  s_nop 0
  s_add_u32 s37, s37, 30
  s_cmp_ge_u32 s38, 30
  s_cselect_b32 s38, s37, s38
  s_cmp_ge_u32 s38, 64
  s_cselect_b32 s38, 100, s38
  s_sub_u32 s38, s38, 1
  s_max_i32 s30, s30, s38
  s_waitcnt vmcnt(4)
  s_barrier
  ds_read_b128 v[28:31], v2 offset:19456
  ds_read_b128 v[32:35], v2 offset:23552
  ds_read_b128 v[36:39], v2 offset:8192
  ds_read_b128 v[40:43], v2 offset:9216
  ds_read_b128 v[44:47], v2 offset:10240
  ds_read_b128 v[48:51], v2 offset:11264
  buffer_load_dwordx4 v[124:127], v3, s[4:7], s24 offen offset:3072 sc1
  buffer_load_dwordx4 v[116:119], v3, s[4:7], s25 offen offset:3072 sc1
  ds_read_b128 v[52:55], v2 offset:12288
  ds_read_b128 v[56:59], v2 offset:13312
  ds_read_b128 v[60:63], v2 offset:14336
  ds_read_b128 v[64:67], v2 offset:15360
  buffer_load_dwordx4 v[124:127], v3, s[4:7], s24 offen offset:3072 sc1
  buffer_load_dwordx4 v[116:119], v3, s[4:7], s25 offen offset:3072 sc1
  s_mov_b32 s19, 0
  s_branch T_loop_135
T_kvw_139:
  s_mov_b32 s19, 0
  s_branch T_kvok_148
T_kv_147:
  s_sleep 4
  s_add_u32 s19, s19, 1
  s_cmp_gt_u32 s19, 32768
  s_cbranch_scc1 M_exit
T_kvok_148:
  s_add_u32 s39, s99, 128
  s_mov_b32 s38, 0
  s_mov_b32 s37, 0
  s_atomic_or s38, s[58:59], s99 glc
  s_atomic_or s37, s[58:59], s39 glc
  s_waitcnt lgkmcnt(0)
  s_add_u32 s37, s37, 30
  s_cmp_ge_u32 s38, 30
  s_cselect_b32 s38, s37, s38
  s_cmp_ge_u32 s38, 64
  s_cselect_b32 s38, 100, s38
  s_sub_u32 s38, s38, 1
  s_max_i32 s30, s30, s38
  s_cmp_ge_i32 s14, s30
  s_cbranch_scc1 T_kv_147
  s_branch T_kvb_140
T_slow_142:
  s_nop 7
  v_max3_f32 v100, v16, v17, v18
  v_max3_f32 v100, v100, v19, v20
  v_max3_f32 v100, v100, v21, v22
  v_max3_f32 v100, v100, v23, v112
  v_max3_f32 v100, v100, v113, v114
  v_max_f32 v100, v100, v115
  v_mov_b32 v101, v100
  s_nop 1
  v_permlane32_swap_b32 v100, v101
  s_nop 1
  v_max_f32 v100, v100, v101
  v_mov_b32 v101, v100
  s_nop 1
  v_permlane16_swap_b32 v100, v101
  s_nop 1
  v_max_f32 v100, v100, v101
  v_sub_f32 v16, v16, v100
  v_sub_f32 v17, v17, v100
  v_sub_f32 v18, v18, v100
  v_sub_f32 v19, v19, v100
  v_exp_f32 v16, v16
  v_exp_f32 v17, v17
  v_exp_f32 v18, v18
  v_exp_f32 v19, v19
  v_sub_f32 v20, v20, v100
  v_sub_f32 v21, v21, v100
  v_sub_f32 v22, v22, v100
  v_sub_f32 v23, v23, v100
  v_exp_f32 v20, v20
  v_exp_f32 v21, v21
  v_exp_f32 v22, v22
  v_exp_f32 v23, v23
  v_sub_f32 v112, v112, v100
  v_sub_f32 v113, v113, v100
  v_sub_f32 v114, v114, v100
  v_sub_f32 v115, v115, v100
  v_exp_f32 v112, v112
  v_exp_f32 v113, v113
  v_exp_f32 v114, v114
  v_exp_f32 v115, v115
  s_nop 0
  v_cvt_pk_bf16_f32 v44, v16, v17
  v_cvt_pk_bf16_f32 v45, v18, v19
  v_cvt_pk_bf16_f32 v46, v20, v21
  v_cvt_pk_bf16_f32 v47, v22, v23
  v_cvt_pk_bf16_f32 v84, v112, v113
  v_cvt_pk_bf16_f32 v85, v114, v115
  v_cndmask_b32 v48, v84, 0, s[16:17]
  v_cndmask_b32 v49, v85, 0, s[16:17]
  v_cndmask_b32 v50, 0, v84, s[16:17]
  v_cndmask_b32 v51, 0, v85, s[16:17]
  s_nop 1
  v_mfma_f32_16x16x16_bf16 v[88:91], v[12:13], v[48:49], 0
  v_mfma_f32_16x16x16_bf16 v[24:27], v[120:121], v[48:49], 0
  v_mfma_f32_16x16x16_bf16 v[116:119], v[120:121], v[50:51], 0
  v_mfma_f32_16x16x32_bf16 v[88:91], v[12:15], v[44:47], v[88:91]
  v_mfma_f32_16x16x32_bf16 v[24:27], v[28:31], v[44:47], v[24:27]
  v_mfma_f32_16x16x32_bf16 v[116:119], v[32:35], v[44:47], v[116:119]
  s_nop 7
  s_nop 1
  v_rcp_f32 v89, v88
  s_nop 0
  v_mul_f32 v24, v89, v24
  v_mul_f32 v25, v89, v25
  s_branch T_back_143
M_global:
  s_cmp_eq_u32 s13, 1
  s_cbranch_scc1 T_w_150
  s_cmp_eq_u32 s13, 2
  s_cbranch_scc1 T_w_151
  s_cmp_eq_u32 s13, 3
  s_cbranch_scc1 T_w_152
T_w_149:
  s_mov_b32 s19, 0
  v_mov_b64 v[16:17], 0
  v_mov_b64 v[18:19], 0
  v_mov_b64 v[20:21], 0
  v_mov_b64 v[22:23], 0
  v_mov_b64 v[24:25], 0
  v_mov_b64 v[26:27], 0
  buffer_load_dwordx4 v[124:127], v3, s[4:7], s24 offen offset:0 sc1
  buffer_load_dwordx4 v[116:119], v3, s[4:7], s25 offen offset:0 sc1
  buffer_load_dwordx4 v[124:127], v3, s[4:7], s24 offen offset:0 sc1
  buffer_load_dwordx4 v[116:119], v3, s[4:7], s25 offen offset:0 sc1
  s_branch T_loop_153
.p2align 6
T_retry_154:
  s_mov_b64 exec, vcc
  buffer_load_dwordx4 v[124:127], v3, s[4:7], s24 offen offset:0 sc1
  buffer_load_dwordx4 v[116:119], v3, s[4:7], s25 offen offset:0 sc1
  s_mov_b64 exec, -1
  s_add_u32 s19, s19, 1
  s_cmp_gt_u32 s19, 32768
  s_cbranch_scc1 M_exit
T_loop_153:
  s_waitcnt vmcnt(3) lgkmcnt(0)
  v_max3_u32 v123, v124, v125, v126
  v_max_u32 v123, v123, v127
  v_mov_b32_dpp v120, v124 row_ror:8 row_mask:0xf bank_mask:0xf
  v_mov_b32_dpp v121, v125 row_ror:8 row_mask:0xf bank_mask:0xf
  s_waitcnt vmcnt(2)
  v_max3_u32 v123, v123, v116, v117
  v_max3_u32 v123, v123, v118, v119
  v_cmp_eq_u32 vcc, -1, v123
  s_cbranch_vccnz T_retry_154
  v_smfmac_f32_16x16x64_bf16 v[16:19], v[124:127], v[68:75], v0
  s_add_u32 s14, s14, 1
  ds_write_b128 v2, v[124:127] offset:0
  v_mov_b32_dpp v122, v126 row_ror:8 row_mask:0xf bank_mask:0xf
  v_smfmac_f32_16x16x64_bf16 v[20:23], v[124:127], v[76:83], v0
  s_and_b32 s57, s14, 1
  v_mov_b32_dpp v123, v127 row_ror:8 row_mask:0xf bank_mask:0xf
  v_smfmac_f32_16x16x64_bf16 v[24:27], v[124:127], v[84:91], v0
  s_and_b32 s36, s14, 3
  ds_write_b128 v2, v[116:119] offset:4096
  v_smfmac_f32_16x16x64_bf16 v[16:19], v[120:123], v[92:99], v0
  s_lshl_b32 s36, s36, 13
  v_mov_b32_dpp v84, v116 row_ror:8 row_mask:0xf bank_mask:0xf
  v_smfmac_f32_16x16x64_bf16 v[20:23], v[120:123], v[100:107], v0
  s_add_u32 s26, s36, s23
  ds_read_b128 v[68:71], v4 offset:12288
  v_mov_b32_dpp v85, v117 row_ror:8 row_mask:0xf bank_mask:0xf
  v_smfmac_f32_16x16x64_bf16 v[24:27], v[120:123], v[108:115], v0
  s_add_u32 s36, s36, 8192
  ds_read_b128 v[72:75], v4 offset:13312
  v_mov_b32_dpp v86, v118 row_ror:8 row_mask:0xf bank_mask:0xf
  v_smfmac_f32_16x16x64_bf16 v[16:19], v[116:119], v[224:231], v0
  s_and_b32 s36, s36, 0x7fff
  ds_read_b128 v[76:79], v4 offset:14336
  v_mov_b32_dpp v87, v119 row_ror:8 row_mask:0xf bank_mask:0xf
  v_smfmac_f32_16x16x64_bf16 v[20:23], v[116:119], v[240:247], v0
  s_waitcnt lgkmcnt(3)
  s_barrier
  ds_read_b128 v[100:103], v2 offset:1024
  v_smfmac_f32_16x16x64_bf16 v[24:27], v[116:119], a[0:7], v0
  s_mov_b32 m0, s31
  ds_read_b128 v[120:123], v1 offset:1024
  v_smfmac_f32_16x16x64_bf16 v[16:19], v[84:87], v[232:239], v0
  s_cmp_ge_i32 s14, s30
  s_cbranch_scc1 T_kvw_157
T_kvb_158:
  v_smfmac_f32_16x16x64_bf16 v[20:23], v[84:87], v[248:255], v0
  ds_read_b128 v[80:83], v4 offset:15360
  buffer_load_dwordx4 v9, s[4:7], s27 offen sc1 lds
  v_smfmac_f32_16x16x64_bf16 v[24:27], v[84:87], a[8:15], v0
  s_waitcnt lgkmcnt(2)
  s_mov_b32 m0, s32
  v_smfmac_f32_16x16x64_bf16 v[16:19], v[100:103], v[128:135], v0
  ds_read_b128 v[92:95], v2 offset:2048
  v_smfmac_f32_16x16x64_bf16 v[20:23], v[100:103], v[144:151], v0
  ds_read_b128 v[96:99], v1 offset:2048
  v_smfmac_f32_16x16x64_bf16 v[24:27], v[100:103], v[68:75], v0
  s_waitcnt vmcnt(1) lgkmcnt(3)
  ds_read_b128 v[116:119], v2 offset:3072
  buffer_load_dwordx4 v9, s[4:7], s27 offen offset:128 sc1 lds
  v_smfmac_f32_16x16x64_bf16 v[16:19], v[120:123], v[136:143], v0
  ds_read_b128 v[124:127], v1 offset:3072
  s_mov_b32 m0, s33
  v_smfmac_f32_16x16x64_bf16 v[20:23], v[120:123], v[152:159], v0
  s_waitcnt lgkmcnt(4)
  ds_read_b128 v[104:107], v2 offset:5120
  v_smfmac_f32_16x16x64_bf16 v[24:27], v[120:123], v[76:83], v0
  s_waitcnt lgkmcnt(4)
  ds_read_b128 v[108:111], v1 offset:5120
  v_smfmac_f32_16x16x64_bf16 v[16:19], v[92:95], v[160:167], v0
  s_waitcnt lgkmcnt(4)
  ds_read_b128 v[112:115], v2 offset:6144
  buffer_load_dwordx4 v10, s[4:7], s28 offen sc1 lds
  v_smfmac_f32_16x16x64_bf16 v[16:19], v[96:99], v[168:175], v0
  s_waitcnt lgkmcnt(4)
  ds_read_b128 v[84:87], v1 offset:6144
  s_mov_b32 m0, s34
  v_smfmac_f32_16x16x64_bf16 v[16:19], v[116:119], v[192:199], v0
  s_waitcnt lgkmcnt(4)
  ds_read_b128 v[88:91], v2 offset:7168
  v_smfmac_f32_16x16x64_bf16 v[16:19], v[124:127], v[200:207], v0
  s_waitcnt lgkmcnt(4)
  ds_read_b128 v[100:103], v1 offset:7168
  v_smfmac_f32_16x16x64_bf16 v[16:19], v[104:107], a[16:23], v0
  s_waitcnt lgkmcnt(4)
  ds_read_b128 v[68:71], v4 offset:16384
  buffer_load_dwordx4 v10, s[4:7], s28 offen offset:256 sc1 lds
  v_smfmac_f32_16x16x64_bf16 v[16:19], v[108:111], a[24:31], v0
  s_waitcnt lgkmcnt(4)
  ds_read_b128 v[72:75], v4 offset:17408
  v_smfmac_f32_16x16x64_bf16 v[16:19], v[112:115], a[64:71], v0
  s_waitcnt lgkmcnt(4)
  ds_read_b128 v[76:79], v4 offset:18432
  v_smfmac_f32_16x16x64_bf16 v[16:19], v[84:87], a[72:79], v0
  s_waitcnt lgkmcnt(4)
  ds_read_b128 v[80:83], v4 offset:19456
  v_smfmac_f32_16x16x64_bf16 v[16:19], v[88:91], a[112:119], v0
  s_waitcnt lgkmcnt(4)
  v_smfmac_f32_16x16x64_bf16 v[16:19], v[100:103], a[120:127], v0
  s_add_u32 s24, s36, 145752064
  s_add_u32 s25, s36, 145756160
  v_smfmac_f32_16x16x64_bf16 v[20:23], v[92:95], v[176:183], v0
  s_add_u32 s35, s36, s23
  v_smfmac_f32_16x16x64_bf16 v[20:23], v[96:99], v[184:191], v0
  s_waitcnt lgkmcnt(2)
  v_smfmac_f32_16x16x64_bf16 v[20:23], v[116:119], v[68:75], v0
  s_waitcnt lgkmcnt(0)
  ds_read_b128 v[68:71], v4 offset:20480
  v_mul_f32 v16, s18, v16
  v_smfmac_f32_16x16x64_bf16 v[20:23], v[124:127], v[76:83], v0
  ds_read_b128 v[72:75], v4 offset:21504
  v_mul_f32 v17, s18, v17
  v_smfmac_f32_16x16x64_bf16 v[20:23], v[104:107], a[32:39], v0
  ds_read_b128 v[76:79], v4 offset:22528
  v_mul_f32 v18, s18, v18
  v_smfmac_f32_16x16x64_bf16 v[20:23], v[108:111], a[40:47], v0
  ds_read_b128 v[80:83], v4 offset:23552
  v_mul_f32 v19, s18, v19
  v_smfmac_f32_16x16x64_bf16 v[20:23], v[112:115], a[80:87], v0
  v_cvt_pk_bf16_f32 v120, v16, v17
  v_smfmac_f32_16x16x64_bf16 v[20:23], v[84:87], a[88:95], v0
  v_cvt_pk_bf16_f32 v121, v18, v19
  v_smfmac_f32_16x16x64_bf16 v[20:23], v[88:91], a[128:135], v0
  ds_write_b64 v5, v[120:121] offset:24576
  v_smfmac_f32_16x16x64_bf16 v[20:23], v[100:103], a[136:143], v0
  s_waitcnt lgkmcnt(3)
  v_smfmac_f32_16x16x64_bf16 v[24:27], v[92:95], v[68:75], v0
  s_waitcnt lgkmcnt(1)
  v_mov_b64 v[92:93], 0
  v_smfmac_f32_16x16x64_bf16 v[24:27], v[96:99], v[76:83], v0
  s_nop 1
  v_cvt_pk_bf16_f32 v122, v20, v21
  v_cvt_pk_bf16_f32 v123, v22, v23
  v_smfmac_f32_16x16x64_bf16 v[24:27], v[116:119], v[208:215], v0
  ds_write_b64 v5, v[122:123] offset:26880
  v_mov_b64 v[94:95], 0
  v_smfmac_f32_16x16x64_bf16 v[24:27], v[124:127], v[216:223], v0
  s_waitcnt lgkmcnt(1)
  s_barrier
  ds_read_b64_tr_b16 v[68:69], v6 offset:24576
  v_smfmac_f32_16x16x64_bf16 v[24:27], v[104:107], a[48:55], v0
  s_add_u32 s27, s27, 8192
  ds_read_b64_tr_b16 v[70:71], v6 offset:24640
  ds_read_b64_tr_b16 v[72:73], v6 offset:24832
  v_smfmac_f32_16x16x64_bf16 v[24:27], v[108:111], a[56:63], v0
  s_add_u32 s28, s28, 8192
  ds_read_b64_tr_b16 v[74:75], v6 offset:24896
  ds_read_b64_tr_b16 v[76:77], v6 offset:25088
  v_smfmac_f32_16x16x64_bf16 v[24:27], v[112:115], a[96:103], v0
  s_nop 0
  ds_read_b64_tr_b16 v[78:79], v6 offset:25152
  ds_read_b64_tr_b16 v[80:81], v6 offset:25344
  v_smfmac_f32_16x16x64_bf16 v[24:27], v[84:87], a[104:111], v0
  ds_read_b64_tr_b16 v[82:83], v6 offset:25408
  v_mov_b64 v[96:97], 0
  v_smfmac_f32_16x16x64_bf16 v[24:27], v[88:91], a[144:151], v0
  s_waitcnt lgkmcnt(8)
  s_barrier
  ds_read_b64_tr_b16 v[116:117], v6 offset:26880
  v_smfmac_f32_16x16x64_bf16 v[24:27], v[100:103], a[152:159], v0
  s_waitcnt lgkmcnt(7)
  ds_read_b64_tr_b16 v[118:119], v6 offset:26944
  v_mfma_f32_16x16x32_bf16 v[16:19], v[36:39], v[68:71], 0
  s_waitcnt lgkmcnt(6)
  ds_read_b64_tr_b16 v[124:125], v6 offset:27136
  ds_read_b64_tr_b16 v[126:127], v6 offset:27200
  v_mfma_f32_16x16x32_bf16 v[16:19], v[40:43], v[72:75], v[16:19]
  s_waitcnt lgkmcnt(6)
  ds_read_b64_tr_b16 v[104:105], v6 offset:27392
  ds_read_b64_tr_b16 v[106:107], v6 offset:27456
  v_mfma_f32_16x16x32_bf16 v[16:19], v[44:47], v[76:79], v[16:19]
  s_waitcnt lgkmcnt(6)
  ds_read_b64_tr_b16 v[108:109], v6 offset:27648
  ds_read_b64_tr_b16 v[110:111], v6 offset:27712
  v_mfma_f32_16x16x32_bf16 v[16:19], v[48:51], v[80:83], v[16:19]
  s_waitcnt lgkmcnt(6)
  v_cvt_pk_bf16_f32 v120, v24, v25
  v_cvt_pk_bf16_f32 v121, v26, v27
  v_mfma_f32_16x16x32_bf16 v[112:115], v[116:119], v[68:71], 0
  s_waitcnt lgkmcnt(4)
  buffer_store_dwordx4 v[120:123], v2, s[4:7], s29 offen offset:0 sc1
  v_mov_b64 v[98:99], 0
  v_mfma_f32_16x16x32_bf16 v[112:115], v[124:127], v[72:75], v[112:115]
  s_waitcnt lgkmcnt(2)
  v_mov_b64 v[36:37], 0
  v_exp_f32 v100, v16
  v_mfma_f32_16x16x32_bf16 v[112:115], v[104:107], v[76:79], v[112:115]
  s_waitcnt lgkmcnt(0)
  v_exp_f32 v101, v17
  v_mfma_f32_16x16x32_bf16 v[112:115], v[108:111], v[80:83], v[112:115]
  v_exp_f32 v102, v18
  v_mfma_f32_16x16x32_bf16 v[20:23], v[52:55], v[68:71], 0
  s_cmp_eq_u32 s14, 63
  v_exp_f32 v103, v19
  v_mfma_f32_16x16x32_bf16 v[20:23], v[56:59], v[72:75], v[20:23]
  s_cbranch_scc1 M_tdone
  v_cvt_pk_bf16_f32 v44, v100, v101
  v_cvt_pk_bf16_f32 v45, v102, v103
  v_mfma_f32_16x16x32_bf16 v[20:23], v[60:63], v[76:79], v[20:23]
  s_add_u32 s29, s29, 131072
  v_exp_f32 v100, v112
  v_mfma_f32_16x16x32_bf16 v[20:23], v[64:67], v[80:83], v[20:23]
  v_exp_f32 v101, v113
  v_exp_f32 v102, v114
  v_exp_f32 v103, v115
  v_cvt_pk_bf16_f32 v84, v100, v101
  v_cvt_pk_bf16_f32 v85, v102, v103
  v_cndmask_b32 v48, v84, 0, s[16:17]
  v_cndmask_b32 v49, v85, 0, s[16:17]
  v_cndmask_b32 v50, 0, v84, s[16:17]
  v_cndmask_b32 v51, 0, v85, s[16:17]
  v_exp_f32 v100, v20
  v_mfma_f32_16x16x16_bf16 v[88:91], v[12:13], v[48:49], 0
  v_exp_f32 v101, v21
  v_mfma_f32_16x16x16_bf16 v[24:27], v[120:121], v[48:49], 0
  v_exp_f32 v102, v22
  v_mfma_f32_16x16x16_bf16 v[116:119], v[120:121], v[50:51], 0
  v_exp_f32 v103, v23
  v_cvt_pk_bf16_f32 v46, v100, v101
  v_cvt_pk_bf16_f32 v47, v102, v103
  v_mov_b64 v[38:39], 0
  s_nop 0
  v_mfma_f32_16x16x32_bf16 v[88:91], v[12:15], v[44:47], v[88:91]
  v_mov_b64 v[40:41], 0
  v_mov_b64 v[42:43], 0
  v_mfma_f32_16x16x32_bf16 v[24:27], v[28:31], v[44:47], v[24:27]
  ds_read_b128 v[52:55], v4 offset:24576
  ds_read_b128 v[56:59], v4 offset:25600
  v_mfma_f32_16x16x32_bf16 v[116:119], v[32:35], v[44:47], v[116:119]
  s_nop 1
  v_rcp_f32 v89, v88
  v_subrev_u32 v100, s54, v88
  v_cmp_le_u32 vcc, s55, v100
  v_mul_f32 v24, v89, v24
  v_mul_f32 v25, v89, v25
  s_cbranch_vccnz T_slow_160
T_back_161:
  v_cvt_pk_bf16_f32 v124, v24, v25
  v_pk_mul_f32 v[26:27], v[26:27], v[88:89] op_sel:[0,1] op_sel_hi:[1,1]
  v_pk_mul_f32 v[116:117], v[116:117], v[88:89] op_sel:[0,1] op_sel_hi:[1,1]
  v_pk_mul_f32 v[118:119], v[118:119], v[88:89] op_sel:[0,1] op_sel_hi:[1,1]
  v_cvt_pk_bf16_f32 v125, v26, v27
  v_cvt_pk_bf16_f32 v126, v116, v117
  v_cvt_pk_bf16_f32 v127, v118, v119
  ds_write_b128 v11, v[124:127] offset:29184
  s_nop 0
  v_smfmac_f32_16x16x64_bf16 v[92:95], v[124:127], a[160:167], v0
  v_smfmac_f32_16x16x64_bf16 v[96:99], v[124:127], a[168:175], v0
  v_smfmac_f32_16x16x64_bf16 v[36:39], v[124:127], a[176:183], v0
  v_smfmac_f32_16x16x64_bf16 v[40:43], v[124:127], a[184:191], v0
  s_waitcnt lgkmcnt(0)
  s_barrier
  ds_read_b128 v[104:107], v11 offset:29696
  ds_read_b128 v[108:111], v11 offset:30208
  ds_read_b128 v[68:71], v11 offset:30720
  s_waitcnt lgkmcnt(2)
  v_smfmac_f32_16x16x64_bf16 v[92:95], v[104:107], a[192:199], v0
  s_waitcnt lgkmcnt(1)
  ds_read_b128 v[76:79], v4 offset:28672
  v_smfmac_f32_16x16x64_bf16 v[92:95], v[108:111], a[224:231], v0
  s_waitcnt lgkmcnt(1)
  ds_read_b128 v[80:83], v4 offset:29696
  v_smfmac_f32_16x16x64_bf16 v[92:95], v[68:71], a[240:247], v0
  ds_read_b128 v[60:63], v4 offset:26624
  v_smfmac_f32_16x16x64_bf16 v[96:99], v[104:107], a[200:207], v0
  ds_read_b128 v[64:67], v4 offset:27648
  v_smfmac_f32_16x16x64_bf16 v[96:99], v[108:111], a[232:239], v0
  ds_read_b128 v[28:31], v4 offset:30720
  s_nop 0
  v_cvt_pk_bf16_f32 v16, v92, v93
  v_cvt_pk_bf16_f32 v17, v94, v95
  v_bfi_b32 v16, 1, s57, v16
  v_smfmac_f32_16x16x64_bf16 v[96:99], v[68:71], a[248:255], v0
  buffer_store_dwordx2 v[16:17], v7, s[4:7], s20 offen offset:0 sc1
  v_smfmac_f32_16x16x64_bf16 v[36:39], v[104:107], a[208:215], v0
  ds_read_b128 v[32:35], v4 offset:31744
  v_smfmac_f32_16x16x64_bf16 v[36:39], v[108:111], v[52:59], v0
  s_waitcnt lgkmcnt(4)
  s_nop 0
  v_cvt_pk_bf16_f32 v18, v96, v97
  v_cvt_pk_bf16_f32 v19, v98, v99
  v_bfi_b32 v18, 1, s57, v18
  v_smfmac_f32_16x16x64_bf16 v[36:39], v[68:71], v[76:83], v0
  buffer_store_dwordx2 v[18:19], v7, s[4:7], s20 offen offset:64 sc1
  v_smfmac_f32_16x16x64_bf16 v[40:43], v[104:107], a[216:223], v0
  s_waitcnt lgkmcnt(2)
  ds_read_b128 v[116:119], v2 offset:31232
  v_smfmac_f32_16x16x64_bf16 v[40:43], v[108:111], v[60:67], v0
  s_waitcnt lgkmcnt(1)
  s_nop 0
  v_cvt_pk_bf16_f32 v20, v36, v37
  v_cvt_pk_bf16_f32 v21, v38, v39
  v_bfi_b32 v20, 1, s57, v20
  v_smfmac_f32_16x16x64_bf16 v[40:43], v[68:71], v[28:35], v0
  buffer_store_dwordx2 v[20:21], v7, s[4:7], s21 offen offset:0 sc1
  s_nop 6
  v_cvt_pk_bf16_f32 v22, v40, v41
  v_cvt_pk_bf16_f32 v23, v42, v43
  v_bfi_b32 v22, 1, s57, v22
  buffer_store_dwordx2 v[22:23], v7, s[4:7], s21 offen offset:64 sc1
  ds_read_b128 v[68:71], v4 offset:0
  ds_read_b128 v[72:75], v4 offset:1024
  ds_read_b128 v[76:79], v4 offset:4096
  ds_read_b128 v[80:83], v4 offset:5120
  ds_read_b128 v[84:87], v4 offset:8192
  ds_read_b128 v[88:91], v4 offset:9216
  v_mov_b64 v[16:17], 0
  v_mov_b64 v[18:19], 0
  v_mov_b64 v[20:21], 0
  v_mov_b64 v[22:23], 0
  v_mov_b64 v[24:25], 0
  v_mov_b64 v[26:27], 0
  s_mov_b32 s19, 0
  v_mov_b32 v49, -1
  s_waitcnt vmcnt(2)
  buffer_load_dwordx4 v[52:55], v2, s[4:7], s22 offen offset:0 sc1
  buffer_load_dwordx4 v[56:59], v2, s[4:7], s22 offen offset:1024 sc1
  buffer_load_dwordx4 v[60:63], v2, s[4:7], s22 offen offset:2048 sc1
  buffer_load_dwordx4 v[64:67], v2, s[4:7], s22 offen offset:3072 sc1
  ds_read_b128 v[92:95], v4 offset:2048
  ds_read_b128 v[96:99], v4 offset:3072
  ds_read_b128 v[100:103], v4 offset:6144
  ds_read_b128 v[104:107], v4 offset:7168
  ds_read_b128 v[108:111], v4 offset:10240
  ds_read_b128 v[112:115], v4 offset:11264
  ds_read_b64 v[44:45], v2 offset:32256
  s_waitcnt lgkmcnt(0)
  v_readfirstlane_b32 s38, v44
  v_readfirstlane_b32 s37, v45
  s_nop 0
  s_add_u32 s37, s37, 30
  s_cmp_ge_u32 s38, 30
  s_cselect_b32 s38, s37, s38
  s_cmp_ge_u32 s38, 64
  s_cselect_b32 s38, 100, s38
  s_sub_u32 s38, s38, 1
  s_max_i32 s30, s30, s38
  s_waitcnt lgkmcnt(12)
  s_waitcnt vmcnt(3)
  v_mfma_f32_16x16x32_bf16 v[120:123], v[116:119], v[52:55], 0
  v_xor_b32 v48, s57, v52
  v_bitop3_b32 v48, v48, v54, s57 bitop3:0xf6
  s_waitcnt vmcnt(2)
  v_mfma_f32_16x16x32_bf16 v[120:123], v[116:119], v[56:59], v[120:123]
  v_bitop3_b32 v48, v48, v56, s57 bitop3:0xf6
  v_bitop3_b32 v48, v48, v58, s57 bitop3:0xf6
  s_waitcnt vmcnt(1)
  v_mfma_f32_16x16x32_bf16 v[120:123], v[116:119], v[60:63], v[120:123]
  v_bitop3_b32 v48, v48, v60, s57 bitop3:0xf6
  v_bitop3_b32 v48, v48, v62, s57 bitop3:0xf6
  s_waitcnt vmcnt(0)
  v_mfma_f32_16x16x32_bf16 v[120:123], v[116:119], v[64:67], v[120:123]
  v_bitop3_b32 v48, v48, v64, s57 bitop3:0xf6
  v_bitop3_b32 v48, v48, v66, s57 bitop3:0xf6
  v_and_b32 v48, 1, v48
  v_cmp_ne_u32 vcc, 0, v48
  s_cbranch_vccnz T_p1re_163
T_p1ok_164:
  s_nop 2
  v_add_f32_dpp v120, v120, v120 row_ror:8 row_mask:0xf bank_mask:0xf
  v_add_f32_dpp v121, v121, v121 row_ror:8 row_mask:0xf bank_mask:0xf
  v_cvt_pk_bf16_f32 v48, v120, v121
  v_min_u32 v48, -2, v48
  buffer_store_dword v48, v8, s[4:7], s35 offen sc1
  buffer_store_dword v49, v8, s[4:7], s26 offen sc1
  s_barrier
  ds_read_b128 v[28:31], v2 offset:16384
  ds_read_b128 v[32:35], v2 offset:20480
  ds_read_b128 v[36:39], v2 offset:8192
  ds_read_b128 v[40:43], v2 offset:9216
  ds_read_b128 v[44:47], v2 offset:10240
  ds_read_b128 v[48:51], v2 offset:11264
  buffer_load_dwordx4 v[124:127], v3, s[4:7], s24 offen offset:0 sc1
  buffer_load_dwordx4 v[116:119], v3, s[4:7], s25 offen offset:0 sc1
  ds_read_b128 v[52:55], v2 offset:12288
  ds_read_b128 v[56:59], v2 offset:13312
  ds_read_b128 v[60:63], v2 offset:14336
  ds_read_b128 v[64:67], v2 offset:15360
  buffer_load_dwordx4 v[124:127], v3, s[4:7], s24 offen offset:0 sc1
  buffer_load_dwordx4 v[116:119], v3, s[4:7], s25 offen offset:0 sc1
  s_mov_b32 s19, 0
  s_branch T_loop_153
T_p1re_163:
  s_mov_b64 exec, vcc
  buffer_load_dwordx4 v[52:55], v2, s[4:7], s22 offen offset:0 sc1
  buffer_load_dwordx4 v[56:59], v2, s[4:7], s22 offen offset:1024 sc1
  buffer_load_dwordx4 v[60:63], v2, s[4:7], s22 offen offset:2048 sc1
  buffer_load_dwordx4 v[64:67], v2, s[4:7], s22 offen offset:3072 sc1
  s_mov_b64 exec, -1
  s_add_u32 s19, s19, 1
  s_cmp_gt_u32 s19, 32768
  s_cbranch_scc1 M_exit
  s_waitcnt vmcnt(3)
  v_mfma_f32_16x16x32_bf16 v[120:123], v[116:119], v[52:55], 0
  v_xor_b32 v48, s57, v52
  v_bitop3_b32 v48, v48, v54, s57 bitop3:0xf6
  s_waitcnt vmcnt(2)
  v_mfma_f32_16x16x32_bf16 v[120:123], v[116:119], v[56:59], v[120:123]
  v_bitop3_b32 v48, v48, v56, s57 bitop3:0xf6
  v_bitop3_b32 v48, v48, v58, s57 bitop3:0xf6
  s_waitcnt vmcnt(1)
  v_mfma_f32_16x16x32_bf16 v[120:123], v[116:119], v[60:63], v[120:123]
  v_bitop3_b32 v48, v48, v60, s57 bitop3:0xf6
  v_bitop3_b32 v48, v48, v62, s57 bitop3:0xf6
  s_waitcnt vmcnt(0)
  v_mfma_f32_16x16x32_bf16 v[120:123], v[116:119], v[64:67], v[120:123]
  v_bitop3_b32 v48, v48, v64, s57 bitop3:0xf6
  v_bitop3_b32 v48, v48, v66, s57 bitop3:0xf6
  v_and_b32 v48, 1, v48
  v_cmp_ne_u32 vcc, 0, v48
  s_cbranch_vccnz T_p1re_163
  s_branch T_p1ok_164
T_kvw_157:
  s_mov_b32 s19, 0
  s_branch T_kvok_166
T_kv_165:
  s_sleep 4
  s_add_u32 s19, s19, 1
  s_cmp_gt_u32 s19, 32768
  s_cbranch_scc1 M_exit
T_kvok_166:
  s_add_u32 s39, s99, 128
  s_mov_b32 s38, 0
  s_mov_b32 s37, 0
  s_atomic_or s38, s[58:59], s99 glc
  s_atomic_or s37, s[58:59], s39 glc
  s_waitcnt lgkmcnt(0)
  s_add_u32 s37, s37, 30
  s_cmp_ge_u32 s38, 30
  s_cselect_b32 s38, s37, s38
  s_cmp_ge_u32 s38, 64
  s_cselect_b32 s38, 100, s38
  s_sub_u32 s38, s38, 1
  s_max_i32 s30, s30, s38
  s_cmp_ge_i32 s14, s30
  s_cbranch_scc1 T_kv_165
  s_branch T_kvb_158
T_slow_160:
  s_nop 7
  v_max3_f32 v100, v16, v17, v18
  v_max3_f32 v100, v100, v19, v20
  v_max3_f32 v100, v100, v21, v22
  v_max3_f32 v100, v100, v23, v112
  v_max3_f32 v100, v100, v113, v114
  v_max_f32 v100, v100, v115
  v_mov_b32 v101, v100
  s_nop 1
  v_permlane32_swap_b32 v100, v101
  s_nop 1
  v_max_f32 v100, v100, v101
  v_mov_b32 v101, v100
  s_nop 1
  v_permlane16_swap_b32 v100, v101
  s_nop 1
  v_max_f32 v100, v100, v101
  v_sub_f32 v16, v16, v100
  v_sub_f32 v17, v17, v100
  v_sub_f32 v18, v18, v100
  v_sub_f32 v19, v19, v100
  v_exp_f32 v16, v16
  v_exp_f32 v17, v17
  v_exp_f32 v18, v18
  v_exp_f32 v19, v19
  v_sub_f32 v20, v20, v100
  v_sub_f32 v21, v21, v100
  v_sub_f32 v22, v22, v100
  v_sub_f32 v23, v23, v100
  v_exp_f32 v20, v20
  v_exp_f32 v21, v21
  v_exp_f32 v22, v22
  v_exp_f32 v23, v23
  v_sub_f32 v112, v112, v100
  v_sub_f32 v113, v113, v100
  v_sub_f32 v114, v114, v100
  v_sub_f32 v115, v115, v100
  v_exp_f32 v112, v112
  v_exp_f32 v113, v113
  v_exp_f32 v114, v114
  v_exp_f32 v115, v115
  s_nop 0
  v_cvt_pk_bf16_f32 v44, v16, v17
  v_cvt_pk_bf16_f32 v45, v18, v19
  v_cvt_pk_bf16_f32 v46, v20, v21
  v_cvt_pk_bf16_f32 v47, v22, v23
  v_cvt_pk_bf16_f32 v84, v112, v113
  v_cvt_pk_bf16_f32 v85, v114, v115
  v_cndmask_b32 v48, v84, 0, s[16:17]
  v_cndmask_b32 v49, v85, 0, s[16:17]
  v_cndmask_b32 v50, 0, v84, s[16:17]
  v_cndmask_b32 v51, 0, v85, s[16:17]
  s_nop 1
  v_mfma_f32_16x16x16_bf16 v[88:91], v[12:13], v[48:49], 0
  v_mfma_f32_16x16x16_bf16 v[24:27], v[120:121], v[48:49], 0
  v_mfma_f32_16x16x16_bf16 v[116:119], v[120:121], v[50:51], 0
  v_mfma_f32_16x16x32_bf16 v[88:91], v[12:15], v[44:47], v[88:91]
  v_mfma_f32_16x16x32_bf16 v[24:27], v[28:31], v[44:47], v[24:27]
  v_mfma_f32_16x16x32_bf16 v[116:119], v[32:35], v[44:47], v[116:119]
  s_nop 7
  s_nop 1
  v_rcp_f32 v89, v88
  s_nop 0
  v_mul_f32 v24, v89, v24
  v_mul_f32 v25, v89, v25
  s_branch T_back_161
T_w_150:
  s_mov_b32 s19, 0
  v_mov_b64 v[16:17], 0
  v_mov_b64 v[18:19], 0
  v_mov_b64 v[20:21], 0
  v_mov_b64 v[22:23], 0
  v_mov_b64 v[24:25], 0
  v_mov_b64 v[26:27], 0
  buffer_load_dwordx4 v[124:127], v3, s[4:7], s24 offen offset:1024 sc1
  buffer_load_dwordx4 v[116:119], v3, s[4:7], s25 offen offset:1024 sc1
  buffer_load_dwordx4 v[124:127], v3, s[4:7], s24 offen offset:1024 sc1
  buffer_load_dwordx4 v[116:119], v3, s[4:7], s25 offen offset:1024 sc1
  s_branch T_loop_167
.p2align 6
T_retry_168:
  s_mov_b64 exec, vcc
  buffer_load_dwordx4 v[124:127], v3, s[4:7], s24 offen offset:1024 sc1
  buffer_load_dwordx4 v[116:119], v3, s[4:7], s25 offen offset:1024 sc1
  s_mov_b64 exec, -1
  s_add_u32 s19, s19, 1
  s_cmp_gt_u32 s19, 32768
  s_cbranch_scc1 M_exit
T_loop_167:
  s_waitcnt vmcnt(3) lgkmcnt(0)
  v_max3_u32 v123, v124, v125, v126
  v_max_u32 v123, v123, v127
  v_mov_b32_dpp v120, v124 row_ror:8 row_mask:0xf bank_mask:0xf
  v_mov_b32_dpp v121, v125 row_ror:8 row_mask:0xf bank_mask:0xf
  s_waitcnt vmcnt(2)
  v_max3_u32 v123, v123, v116, v117
  v_max3_u32 v123, v123, v118, v119
  v_cmp_eq_u32 vcc, -1, v123
  s_cbranch_vccnz T_retry_168
  v_smfmac_f32_16x16x64_bf16 v[16:19], v[124:127], v[68:75], v0
  s_add_u32 s14, s14, 1
  ds_write_b128 v2, v[124:127] offset:1024
  v_mov_b32_dpp v122, v126 row_ror:8 row_mask:0xf bank_mask:0xf
  v_smfmac_f32_16x16x64_bf16 v[20:23], v[124:127], v[76:83], v0
  s_and_b32 s57, s14, 1
  v_mov_b32_dpp v123, v127 row_ror:8 row_mask:0xf bank_mask:0xf
  v_smfmac_f32_16x16x64_bf16 v[24:27], v[124:127], v[84:91], v0
  s_and_b32 s36, s14, 3
  ds_write_b128 v2, v[116:119] offset:5120
  v_smfmac_f32_16x16x64_bf16 v[16:19], v[120:123], v[92:99], v0
  s_lshl_b32 s36, s36, 13
  v_mov_b32_dpp v84, v116 row_ror:8 row_mask:0xf bank_mask:0xf
  v_smfmac_f32_16x16x64_bf16 v[20:23], v[120:123], v[100:107], v0
  s_add_u32 s26, s36, s23
  ds_read_b128 v[68:71], v4 offset:12288
  v_mov_b32_dpp v85, v117 row_ror:8 row_mask:0xf bank_mask:0xf
  v_smfmac_f32_16x16x64_bf16 v[24:27], v[120:123], v[108:115], v0
  s_add_u32 s36, s36, 8192
  ds_read_b128 v[72:75], v4 offset:13312
  v_mov_b32_dpp v86, v118 row_ror:8 row_mask:0xf bank_mask:0xf
  v_smfmac_f32_16x16x64_bf16 v[16:19], v[116:119], v[224:231], v0
  s_and_b32 s36, s36, 0x7fff
  ds_read_b128 v[76:79], v4 offset:14336
  v_mov_b32_dpp v87, v119 row_ror:8 row_mask:0xf bank_mask:0xf
  v_smfmac_f32_16x16x64_bf16 v[20:23], v[116:119], v[240:247], v0
  s_waitcnt lgkmcnt(3)
  s_barrier
  ds_read_b128 v[100:103], v2 offset:0
  v_smfmac_f32_16x16x64_bf16 v[24:27], v[116:119], a[0:7], v0
  s_mov_b32 m0, s31
  ds_read_b128 v[120:123], v1 offset:0
  v_smfmac_f32_16x16x64_bf16 v[16:19], v[84:87], v[232:239], v0
  s_cmp_ge_i32 s14, s30
  s_cbranch_scc1 T_kvw_171
T_kvb_172:
  v_smfmac_f32_16x16x64_bf16 v[20:23], v[84:87], v[248:255], v0
  ds_read_b128 v[80:83], v4 offset:15360
  v_smfmac_f32_16x16x64_bf16 v[24:27], v[84:87], a[8:15], v0
  s_waitcnt lgkmcnt(2)
  buffer_load_dwordx4 v9, s[4:7], s27 offen sc1 lds
  v_smfmac_f32_16x16x64_bf16 v[16:19], v[100:103], v[128:135], v0
  ds_read_b128 v[92:95], v2 offset:3072
  s_mov_b32 m0, s32
  v_smfmac_f32_16x16x64_bf16 v[20:23], v[100:103], v[144:151], v0
  ds_read_b128 v[96:99], v1 offset:3072
  v_smfmac_f32_16x16x64_bf16 v[24:27], v[100:103], v[68:75], v0
  s_waitcnt vmcnt(1) lgkmcnt(3)
  ds_read_b128 v[116:119], v2 offset:2048
  v_smfmac_f32_16x16x64_bf16 v[16:19], v[120:123], v[136:143], v0
  ds_read_b128 v[124:127], v1 offset:2048
  buffer_load_dwordx4 v9, s[4:7], s27 offen offset:128 sc1 lds
  v_smfmac_f32_16x16x64_bf16 v[20:23], v[120:123], v[152:159], v0
  s_waitcnt lgkmcnt(4)
  ds_read_b128 v[104:107], v2 offset:4096
  s_mov_b32 m0, s33
  v_smfmac_f32_16x16x64_bf16 v[24:27], v[120:123], v[76:83], v0
  s_waitcnt lgkmcnt(4)
  ds_read_b128 v[108:111], v1 offset:4096
  v_smfmac_f32_16x16x64_bf16 v[16:19], v[92:95], v[160:167], v0
  s_waitcnt lgkmcnt(4)
  ds_read_b128 v[112:115], v2 offset:7168
  v_smfmac_f32_16x16x64_bf16 v[16:19], v[96:99], v[168:175], v0
  s_waitcnt lgkmcnt(4)
  ds_read_b128 v[84:87], v1 offset:7168
  buffer_load_dwordx4 v10, s[4:7], s28 offen sc1 lds
  v_smfmac_f32_16x16x64_bf16 v[16:19], v[116:119], v[192:199], v0
  s_waitcnt lgkmcnt(4)
  ds_read_b128 v[88:91], v2 offset:6144
  s_mov_b32 m0, s34
  v_smfmac_f32_16x16x64_bf16 v[16:19], v[124:127], v[200:207], v0
  s_waitcnt lgkmcnt(4)
  ds_read_b128 v[100:103], v1 offset:6144
  v_smfmac_f32_16x16x64_bf16 v[16:19], v[104:107], a[16:23], v0
  s_waitcnt lgkmcnt(4)
  ds_read_b128 v[68:71], v4 offset:16384
  v_smfmac_f32_16x16x64_bf16 v[16:19], v[108:111], a[24:31], v0
  s_waitcnt lgkmcnt(4)
  ds_read_b128 v[72:75], v4 offset:17408
  buffer_load_dwordx4 v10, s[4:7], s28 offen offset:256 sc1 lds
  v_smfmac_f32_16x16x64_bf16 v[16:19], v[112:115], a[64:71], v0
  s_waitcnt lgkmcnt(4)
  ds_read_b128 v[76:79], v4 offset:18432
  v_smfmac_f32_16x16x64_bf16 v[16:19], v[84:87], a[72:79], v0
  s_waitcnt lgkmcnt(4)
  ds_read_b128 v[80:83], v4 offset:19456
  v_smfmac_f32_16x16x64_bf16 v[16:19], v[88:91], a[112:119], v0
  s_waitcnt lgkmcnt(4)
  v_smfmac_f32_16x16x64_bf16 v[16:19], v[100:103], a[120:127], v0
  s_add_u32 s24, s36, 145752064
  s_add_u32 s25, s36, 145756160
  v_smfmac_f32_16x16x64_bf16 v[20:23], v[92:95], v[176:183], v0
  s_add_u32 s35, s36, s23
  v_smfmac_f32_16x16x64_bf16 v[20:23], v[96:99], v[184:191], v0
  s_waitcnt lgkmcnt(2)
  v_smfmac_f32_16x16x64_bf16 v[20:23], v[116:119], v[68:75], v0
  s_waitcnt lgkmcnt(0)
  ds_read_b128 v[68:71], v4 offset:20480
  v_mul_f32 v16, s18, v16
  v_smfmac_f32_16x16x64_bf16 v[20:23], v[124:127], v[76:83], v0
  ds_read_b128 v[72:75], v4 offset:21504
  v_mul_f32 v17, s18, v17
  v_smfmac_f32_16x16x64_bf16 v[20:23], v[104:107], a[32:39], v0
  ds_read_b128 v[76:79], v4 offset:22528
  v_mul_f32 v18, s18, v18
  v_smfmac_f32_16x16x64_bf16 v[20:23], v[108:111], a[40:47], v0
  ds_read_b128 v[80:83], v4 offset:23552
  v_mul_f32 v19, s18, v19
  v_smfmac_f32_16x16x64_bf16 v[20:23], v[112:115], a[80:87], v0
  v_cvt_pk_bf16_f32 v120, v16, v17
  v_smfmac_f32_16x16x64_bf16 v[20:23], v[84:87], a[88:95], v0
  v_cvt_pk_bf16_f32 v121, v18, v19
  v_smfmac_f32_16x16x64_bf16 v[20:23], v[88:91], a[128:135], v0
  ds_write_b64 v5, v[120:121] offset:24576
  v_smfmac_f32_16x16x64_bf16 v[20:23], v[100:103], a[136:143], v0
  s_waitcnt lgkmcnt(3)
  v_smfmac_f32_16x16x64_bf16 v[24:27], v[92:95], v[68:75], v0
  s_waitcnt lgkmcnt(1)
  v_mov_b64 v[92:93], 0
  v_smfmac_f32_16x16x64_bf16 v[24:27], v[96:99], v[76:83], v0
  s_nop 1
  v_cvt_pk_bf16_f32 v122, v20, v21
  v_cvt_pk_bf16_f32 v123, v22, v23
  v_smfmac_f32_16x16x64_bf16 v[24:27], v[116:119], v[208:215], v0
  ds_write_b64 v5, v[122:123] offset:26880
  v_mov_b64 v[94:95], 0
  v_smfmac_f32_16x16x64_bf16 v[24:27], v[124:127], v[216:223], v0
  s_waitcnt lgkmcnt(1)
  s_barrier
  ds_read_b64_tr_b16 v[68:69], v6 offset:24576
  v_smfmac_f32_16x16x64_bf16 v[24:27], v[104:107], a[48:55], v0
  s_add_u32 s27, s27, 8192
  ds_read_b64_tr_b16 v[70:71], v6 offset:24640
  ds_read_b64_tr_b16 v[72:73], v6 offset:24832
  v_smfmac_f32_16x16x64_bf16 v[24:27], v[108:111], a[56:63], v0
  s_add_u32 s28, s28, 8192
  ds_read_b64_tr_b16 v[74:75], v6 offset:24896
  ds_read_b64_tr_b16 v[76:77], v6 offset:25088
  v_smfmac_f32_16x16x64_bf16 v[24:27], v[112:115], a[96:103], v0
  s_nop 0
  ds_read_b64_tr_b16 v[78:79], v6 offset:25152
  ds_read_b64_tr_b16 v[80:81], v6 offset:25344
  v_smfmac_f32_16x16x64_bf16 v[24:27], v[84:87], a[104:111], v0
  ds_read_b64_tr_b16 v[82:83], v6 offset:25408
  v_mov_b64 v[96:97], 0
  v_smfmac_f32_16x16x64_bf16 v[24:27], v[88:91], a[144:151], v0
  s_waitcnt lgkmcnt(8)
  s_barrier
  ds_read_b64_tr_b16 v[116:117], v6 offset:26880
  v_smfmac_f32_16x16x64_bf16 v[24:27], v[100:103], a[152:159], v0
  s_waitcnt lgkmcnt(7)
  ds_read_b64_tr_b16 v[118:119], v6 offset:26944
  v_mfma_f32_16x16x32_bf16 v[16:19], v[36:39], v[68:71], 0
  s_waitcnt lgkmcnt(6)
  ds_read_b64_tr_b16 v[124:125], v6 offset:27136
  ds_read_b64_tr_b16 v[126:127], v6 offset:27200
  v_mfma_f32_16x16x32_bf16 v[16:19], v[40:43], v[72:75], v[16:19]
  s_waitcnt lgkmcnt(6)
  ds_read_b64_tr_b16 v[104:105], v6 offset:27392
  ds_read_b64_tr_b16 v[106:107], v6 offset:27456
  v_mfma_f32_16x16x32_bf16 v[16:19], v[44:47], v[76:79], v[16:19]
  s_waitcnt lgkmcnt(6)
  ds_read_b64_tr_b16 v[108:109], v6 offset:27648
  ds_read_b64_tr_b16 v[110:111], v6 offset:27712
  v_mfma_f32_16x16x32_bf16 v[16:19], v[48:51], v[80:83], v[16:19]
  s_waitcnt lgkmcnt(6)
  v_cvt_pk_bf16_f32 v120, v24, v25
  v_cvt_pk_bf16_f32 v121, v26, v27
  v_mfma_f32_16x16x32_bf16 v[112:115], v[116:119], v[68:71], 0
  s_waitcnt lgkmcnt(4)
  v_mov_b64 v[98:99], 0
  v_mfma_f32_16x16x32_bf16 v[112:115], v[124:127], v[72:75], v[112:115]
  s_waitcnt lgkmcnt(2)
  buffer_store_dwordx4 v[120:123], v2, s[4:7], s29 offen offset:1024 sc1
  v_mov_b64 v[36:37], 0
  v_exp_f32 v100, v16
  v_mfma_f32_16x16x32_bf16 v[112:115], v[104:107], v[76:79], v[112:115]
  s_waitcnt lgkmcnt(0)
  v_exp_f32 v101, v17
  v_mfma_f32_16x16x32_bf16 v[112:115], v[108:111], v[80:83], v[112:115]
  v_exp_f32 v102, v18
  v_mfma_f32_16x16x32_bf16 v[20:23], v[52:55], v[68:71], 0
  s_cmp_eq_u32 s14, 63
  v_exp_f32 v103, v19
  v_mfma_f32_16x16x32_bf16 v[20:23], v[56:59], v[72:75], v[20:23]
  s_cbranch_scc1 M_tdone
  v_cvt_pk_bf16_f32 v44, v100, v101
  v_cvt_pk_bf16_f32 v45, v102, v103
  v_mfma_f32_16x16x32_bf16 v[20:23], v[60:63], v[76:79], v[20:23]
  s_add_u32 s29, s29, 131072
  v_exp_f32 v100, v112
  v_mfma_f32_16x16x32_bf16 v[20:23], v[64:67], v[80:83], v[20:23]
  v_exp_f32 v101, v113
  v_exp_f32 v102, v114
  v_exp_f32 v103, v115
  v_cvt_pk_bf16_f32 v84, v100, v101
  v_cvt_pk_bf16_f32 v85, v102, v103
  v_cndmask_b32 v48, v84, 0, s[16:17]
  v_cndmask_b32 v49, v85, 0, s[16:17]
  v_cndmask_b32 v50, 0, v84, s[16:17]
  v_cndmask_b32 v51, 0, v85, s[16:17]
  v_exp_f32 v100, v20
  v_mfma_f32_16x16x16_bf16 v[88:91], v[12:13], v[48:49], 0
  v_exp_f32 v101, v21
  v_mfma_f32_16x16x16_bf16 v[24:27], v[120:121], v[48:49], 0
  v_exp_f32 v102, v22
  v_mfma_f32_16x16x16_bf16 v[116:119], v[120:121], v[50:51], 0
  v_exp_f32 v103, v23
  v_cvt_pk_bf16_f32 v46, v100, v101
  v_cvt_pk_bf16_f32 v47, v102, v103
  v_mov_b64 v[38:39], 0
  s_nop 0
  v_mfma_f32_16x16x32_bf16 v[88:91], v[12:15], v[44:47], v[88:91]
  v_mov_b64 v[40:41], 0
  v_mov_b64 v[42:43], 0
  v_mfma_f32_16x16x32_bf16 v[24:27], v[28:31], v[44:47], v[24:27]
  ds_read_b128 v[52:55], v4 offset:24576
  ds_read_b128 v[56:59], v4 offset:25600
  v_mfma_f32_16x16x32_bf16 v[116:119], v[32:35], v[44:47], v[116:119]
  s_nop 1
  v_rcp_f32 v89, v88
  v_subrev_u32 v100, s54, v88
  v_cmp_le_u32 vcc, s55, v100
  v_mul_f32 v24, v89, v24
  v_mul_f32 v25, v89, v25
  s_cbranch_vccnz T_slow_174
T_back_175:
  v_cvt_pk_bf16_f32 v124, v24, v25
  v_pk_mul_f32 v[26:27], v[26:27], v[88:89] op_sel:[0,1] op_sel_hi:[1,1]
  v_pk_mul_f32 v[116:117], v[116:117], v[88:89] op_sel:[0,1] op_sel_hi:[1,1]
  v_pk_mul_f32 v[118:119], v[118:119], v[88:89] op_sel:[0,1] op_sel_hi:[1,1]
  v_cvt_pk_bf16_f32 v125, v26, v27
  v_cvt_pk_bf16_f32 v126, v116, v117
  v_cvt_pk_bf16_f32 v127, v118, v119
  ds_write_b128 v11, v[124:127] offset:29696
  s_nop 0
  v_smfmac_f32_16x16x64_bf16 v[92:95], v[124:127], a[160:167], v0
  v_smfmac_f32_16x16x64_bf16 v[96:99], v[124:127], a[168:175], v0
  v_smfmac_f32_16x16x64_bf16 v[36:39], v[124:127], a[176:183], v0
  v_smfmac_f32_16x16x64_bf16 v[40:43], v[124:127], a[184:191], v0
  s_waitcnt lgkmcnt(0)
  s_barrier
  ds_read_b128 v[104:107], v11 offset:29184
  ds_read_b128 v[108:111], v11 offset:30720
  ds_read_b128 v[68:71], v11 offset:30208
  s_waitcnt lgkmcnt(2)
  v_smfmac_f32_16x16x64_bf16 v[92:95], v[104:107], a[192:199], v0
  s_waitcnt lgkmcnt(1)
  ds_read_b128 v[76:79], v4 offset:28672
  v_smfmac_f32_16x16x64_bf16 v[92:95], v[108:111], a[224:231], v0
  s_waitcnt lgkmcnt(1)
  ds_read_b128 v[80:83], v4 offset:29696
  v_smfmac_f32_16x16x64_bf16 v[92:95], v[68:71], a[240:247], v0
  ds_read_b128 v[60:63], v4 offset:26624
  v_smfmac_f32_16x16x64_bf16 v[96:99], v[104:107], a[200:207], v0
  ds_read_b128 v[64:67], v4 offset:27648
  v_smfmac_f32_16x16x64_bf16 v[96:99], v[108:111], a[232:239], v0
  ds_read_b128 v[28:31], v4 offset:30720
  s_nop 0
  v_cvt_pk_bf16_f32 v16, v92, v93
  v_cvt_pk_bf16_f32 v17, v94, v95
  v_bfi_b32 v16, 1, s57, v16
  v_smfmac_f32_16x16x64_bf16 v[96:99], v[68:71], a[248:255], v0
  buffer_store_dwordx2 v[16:17], v7, s[4:7], s20 offen offset:0 sc1
  v_smfmac_f32_16x16x64_bf16 v[36:39], v[104:107], a[208:215], v0
  ds_read_b128 v[32:35], v4 offset:31744
  v_smfmac_f32_16x16x64_bf16 v[36:39], v[108:111], v[52:59], v0
  s_waitcnt lgkmcnt(4)
  s_nop 0
  v_cvt_pk_bf16_f32 v18, v96, v97
  v_cvt_pk_bf16_f32 v19, v98, v99
  v_bfi_b32 v18, 1, s57, v18
  v_smfmac_f32_16x16x64_bf16 v[36:39], v[68:71], v[76:83], v0
  buffer_store_dwordx2 v[18:19], v7, s[4:7], s20 offen offset:64 sc1
  v_smfmac_f32_16x16x64_bf16 v[40:43], v[104:107], a[216:223], v0
  s_waitcnt lgkmcnt(2)
  ds_read_b128 v[116:119], v2 offset:31232
  v_smfmac_f32_16x16x64_bf16 v[40:43], v[108:111], v[60:67], v0
  s_waitcnt lgkmcnt(1)
  s_nop 0
  v_cvt_pk_bf16_f32 v20, v36, v37
  v_cvt_pk_bf16_f32 v21, v38, v39
  v_bfi_b32 v20, 1, s57, v20
  v_smfmac_f32_16x16x64_bf16 v[40:43], v[68:71], v[28:35], v0
  buffer_store_dwordx2 v[20:21], v7, s[4:7], s21 offen offset:0 sc1
  s_nop 6
  v_cvt_pk_bf16_f32 v22, v40, v41
  v_cvt_pk_bf16_f32 v23, v42, v43
  v_bfi_b32 v22, 1, s57, v22
  buffer_store_dwordx2 v[22:23], v7, s[4:7], s21 offen offset:64 sc1
  ds_read_b128 v[68:71], v4 offset:0
  ds_read_b128 v[72:75], v4 offset:1024
  ds_read_b128 v[76:79], v4 offset:4096
  ds_read_b128 v[80:83], v4 offset:5120
  ds_read_b128 v[84:87], v4 offset:8192
  ds_read_b128 v[88:91], v4 offset:9216
  ds_read_b128 v[92:95], v4 offset:2048
  ds_read_b128 v[96:99], v4 offset:3072
  ds_read_b128 v[100:103], v4 offset:6144
  ds_read_b128 v[104:107], v4 offset:7168
  ds_read_b128 v[108:111], v4 offset:10240
  ds_read_b128 v[112:115], v4 offset:11264
  v_mov_b64 v[16:17], 0
  v_mov_b64 v[18:19], 0
  v_mov_b64 v[20:21], 0
  v_mov_b64 v[22:23], 0
  v_mov_b64 v[24:25], 0
  v_mov_b64 v[26:27], 0
  s_mov_b32 s19, 0
  v_mov_b32 v49, -1
  ds_read_b64 v[44:45], v2 offset:32256
  s_waitcnt lgkmcnt(0)
  v_readfirstlane_b32 s38, v44
  v_readfirstlane_b32 s37, v45
  s_nop 0
  s_add_u32 s37, s37, 30
  s_cmp_ge_u32 s38, 30
  s_cselect_b32 s38, s37, s38
  s_cmp_ge_u32 s38, 64
  s_cselect_b32 s38, 100, s38
  s_sub_u32 s38, s38, 1
  s_max_i32 s30, s30, s38
  s_waitcnt vmcnt(0)
  buffer_load_dwordx4 v[52:55], v2, s[4:7], s22 offen offset:0 sc1
  buffer_load_dwordx4 v[56:59], v2, s[4:7], s22 offen offset:1024 sc1
  buffer_load_dwordx4 v[60:63], v2, s[4:7], s22 offen offset:2048 sc1
  buffer_load_dwordx4 v[64:67], v2, s[4:7], s22 offen offset:3072 sc1
  s_waitcnt lgkmcnt(12)
  s_waitcnt vmcnt(3)
  v_mfma_f32_16x16x32_bf16 v[120:123], v[116:119], v[52:55], 0
  v_xor_b32 v48, s57, v52
  v_bitop3_b32 v48, v48, v54, s57 bitop3:0xf6
  s_waitcnt vmcnt(2)
  v_mfma_f32_16x16x32_bf16 v[120:123], v[116:119], v[56:59], v[120:123]
  v_bitop3_b32 v48, v48, v56, s57 bitop3:0xf6
  v_bitop3_b32 v48, v48, v58, s57 bitop3:0xf6
  s_waitcnt vmcnt(1)
  v_mfma_f32_16x16x32_bf16 v[120:123], v[116:119], v[60:63], v[120:123]
  v_bitop3_b32 v48, v48, v60, s57 bitop3:0xf6
  v_bitop3_b32 v48, v48, v62, s57 bitop3:0xf6
  s_waitcnt vmcnt(0)
  v_mfma_f32_16x16x32_bf16 v[120:123], v[116:119], v[64:67], v[120:123]
  v_bitop3_b32 v48, v48, v64, s57 bitop3:0xf6
  v_bitop3_b32 v48, v48, v66, s57 bitop3:0xf6
  v_and_b32 v48, 1, v48
  v_cmp_ne_u32 vcc, 0, v48
  s_cbranch_vccnz T_p1re_177
T_p1ok_178:
  s_nop 2
  v_add_f32_dpp v120, v120, v120 row_ror:8 row_mask:0xf bank_mask:0xf
  v_add_f32_dpp v121, v121, v121 row_ror:8 row_mask:0xf bank_mask:0xf
  v_cvt_pk_bf16_f32 v48, v120, v121
  v_min_u32 v48, -2, v48
  buffer_store_dword v48, v8, s[4:7], s35 offen sc1
  buffer_store_dword v49, v8, s[4:7], s26 offen sc1
  s_barrier
  ds_read_b128 v[28:31], v2 offset:17408
  ds_read_b128 v[32:35], v2 offset:21504
  ds_read_b128 v[36:39], v2 offset:8192
  ds_read_b128 v[40:43], v2 offset:9216
  ds_read_b128 v[44:47], v2 offset:10240
  ds_read_b128 v[48:51], v2 offset:11264
  buffer_load_dwordx4 v[124:127], v3, s[4:7], s24 offen offset:1024 sc1
  buffer_load_dwordx4 v[116:119], v3, s[4:7], s25 offen offset:1024 sc1
  ds_read_b128 v[52:55], v2 offset:12288
  ds_read_b128 v[56:59], v2 offset:13312
  ds_read_b128 v[60:63], v2 offset:14336
  ds_read_b128 v[64:67], v2 offset:15360
  buffer_load_dwordx4 v[124:127], v3, s[4:7], s24 offen offset:1024 sc1
  buffer_load_dwordx4 v[116:119], v3, s[4:7], s25 offen offset:1024 sc1
  s_mov_b32 s19, 0
  s_branch T_loop_167
T_p1re_177:
  s_mov_b64 exec, vcc
  buffer_load_dwordx4 v[52:55], v2, s[4:7], s22 offen offset:0 sc1
  buffer_load_dwordx4 v[56:59], v2, s[4:7], s22 offen offset:1024 sc1
  buffer_load_dwordx4 v[60:63], v2, s[4:7], s22 offen offset:2048 sc1
  buffer_load_dwordx4 v[64:67], v2, s[4:7], s22 offen offset:3072 sc1
  s_mov_b64 exec, -1
  s_add_u32 s19, s19, 1
  s_cmp_gt_u32 s19, 32768
  s_cbranch_scc1 M_exit
  s_waitcnt vmcnt(3)
  v_mfma_f32_16x16x32_bf16 v[120:123], v[116:119], v[52:55], 0
  v_xor_b32 v48, s57, v52
  v_bitop3_b32 v48, v48, v54, s57 bitop3:0xf6
  s_waitcnt vmcnt(2)
  v_mfma_f32_16x16x32_bf16 v[120:123], v[116:119], v[56:59], v[120:123]
  v_bitop3_b32 v48, v48, v56, s57 bitop3:0xf6
  v_bitop3_b32 v48, v48, v58, s57 bitop3:0xf6
  s_waitcnt vmcnt(1)
  v_mfma_f32_16x16x32_bf16 v[120:123], v[116:119], v[60:63], v[120:123]
  v_bitop3_b32 v48, v48, v60, s57 bitop3:0xf6
  v_bitop3_b32 v48, v48, v62, s57 bitop3:0xf6
  s_waitcnt vmcnt(0)
  v_mfma_f32_16x16x32_bf16 v[120:123], v[116:119], v[64:67], v[120:123]
  v_bitop3_b32 v48, v48, v64, s57 bitop3:0xf6
  v_bitop3_b32 v48, v48, v66, s57 bitop3:0xf6
  v_and_b32 v48, 1, v48
  v_cmp_ne_u32 vcc, 0, v48
  s_cbranch_vccnz T_p1re_177
  s_branch T_p1ok_178
T_kvw_171:
  s_mov_b32 s19, 0
  s_branch T_kvok_180
T_kv_179:
  s_sleep 4
  s_add_u32 s19, s19, 1
  s_cmp_gt_u32 s19, 32768
  s_cbranch_scc1 M_exit
T_kvok_180:
  s_add_u32 s39, s99, 128
  s_mov_b32 s38, 0
  s_mov_b32 s37, 0
  s_atomic_or s38, s[58:59], s99 glc
  s_atomic_or s37, s[58:59], s39 glc
  s_waitcnt lgkmcnt(0)
  s_add_u32 s37, s37, 30
  s_cmp_ge_u32 s38, 30
  s_cselect_b32 s38, s37, s38
  s_cmp_ge_u32 s38, 64
  s_cselect_b32 s38, 100, s38
  s_sub_u32 s38, s38, 1
  s_max_i32 s30, s30, s38
  s_cmp_ge_i32 s14, s30
  s_cbranch_scc1 T_kv_179
  s_branch T_kvb_172
T_slow_174:
  s_nop 7
  v_max3_f32 v100, v16, v17, v18
  v_max3_f32 v100, v100, v19, v20
  v_max3_f32 v100, v100, v21, v22
  v_max3_f32 v100, v100, v23, v112
  v_max3_f32 v100, v100, v113, v114
  v_max_f32 v100, v100, v115
  v_mov_b32 v101, v100
  s_nop 1
  v_permlane32_swap_b32 v100, v101
  s_nop 1
  v_max_f32 v100, v100, v101
  v_mov_b32 v101, v100
  s_nop 1
  v_permlane16_swap_b32 v100, v101
  s_nop 1
  v_max_f32 v100, v100, v101
  v_sub_f32 v16, v16, v100
  v_sub_f32 v17, v17, v100
  v_sub_f32 v18, v18, v100
  v_sub_f32 v19, v19, v100
  v_exp_f32 v16, v16
  v_exp_f32 v17, v17
  v_exp_f32 v18, v18
  v_exp_f32 v19, v19
  v_sub_f32 v20, v20, v100
  v_sub_f32 v21, v21, v100
  v_sub_f32 v22, v22, v100
  v_sub_f32 v23, v23, v100
  v_exp_f32 v20, v20
  v_exp_f32 v21, v21
  v_exp_f32 v22, v22
  v_exp_f32 v23, v23
  v_sub_f32 v112, v112, v100
  v_sub_f32 v113, v113, v100
  v_sub_f32 v114, v114, v100
  v_sub_f32 v115, v115, v100
  v_exp_f32 v112, v112
  v_exp_f32 v113, v113
  v_exp_f32 v114, v114
  v_exp_f32 v115, v115
  s_nop 0
  v_cvt_pk_bf16_f32 v44, v16, v17
  v_cvt_pk_bf16_f32 v45, v18, v19
  v_cvt_pk_bf16_f32 v46, v20, v21
  v_cvt_pk_bf16_f32 v47, v22, v23
  v_cvt_pk_bf16_f32 v84, v112, v113
  v_cvt_pk_bf16_f32 v85, v114, v115
  v_cndmask_b32 v48, v84, 0, s[16:17]
  v_cndmask_b32 v49, v85, 0, s[16:17]
  v_cndmask_b32 v50, 0, v84, s[16:17]
  v_cndmask_b32 v51, 0, v85, s[16:17]
  s_nop 1
  v_mfma_f32_16x16x16_bf16 v[88:91], v[12:13], v[48:49], 0
  v_mfma_f32_16x16x16_bf16 v[24:27], v[120:121], v[48:49], 0
  v_mfma_f32_16x16x16_bf16 v[116:119], v[120:121], v[50:51], 0
  v_mfma_f32_16x16x32_bf16 v[88:91], v[12:15], v[44:47], v[88:91]
  v_mfma_f32_16x16x32_bf16 v[24:27], v[28:31], v[44:47], v[24:27]
  v_mfma_f32_16x16x32_bf16 v[116:119], v[32:35], v[44:47], v[116:119]
  s_nop 7
  s_nop 1
  v_rcp_f32 v89, v88
  s_nop 0
  v_mul_f32 v24, v89, v24
  v_mul_f32 v25, v89, v25
  s_branch T_back_175
T_w_151:
  s_mov_b32 s19, 0
  v_mov_b64 v[16:17], 0
  v_mov_b64 v[18:19], 0
  v_mov_b64 v[20:21], 0
  v_mov_b64 v[22:23], 0
  v_mov_b64 v[24:25], 0
  v_mov_b64 v[26:27], 0
  buffer_load_dwordx4 v[124:127], v3, s[4:7], s24 offen offset:2048 sc1
  buffer_load_dwordx4 v[116:119], v3, s[4:7], s25 offen offset:2048 sc1
  buffer_load_dwordx4 v[124:127], v3, s[4:7], s24 offen offset:2048 sc1
  buffer_load_dwordx4 v[116:119], v3, s[4:7], s25 offen offset:2048 sc1
  s_branch T_loop_181
.p2align 6
T_retry_182:
  s_mov_b64 exec, vcc
  buffer_load_dwordx4 v[124:127], v3, s[4:7], s24 offen offset:2048 sc1
  buffer_load_dwordx4 v[116:119], v3, s[4:7], s25 offen offset:2048 sc1
  s_mov_b64 exec, -1
  s_add_u32 s19, s19, 1
  s_cmp_gt_u32 s19, 32768
  s_cbranch_scc1 M_exit
T_loop_181:
  s_waitcnt vmcnt(3) lgkmcnt(0)
  v_max3_u32 v123, v124, v125, v126
  v_max_u32 v123, v123, v127
  v_mov_b32_dpp v120, v124 row_ror:8 row_mask:0xf bank_mask:0xf
  v_mov_b32_dpp v121, v125 row_ror:8 row_mask:0xf bank_mask:0xf
  s_waitcnt vmcnt(2)
  v_max3_u32 v123, v123, v116, v117
  v_max3_u32 v123, v123, v118, v119
  v_cmp_eq_u32 vcc, -1, v123
  s_cbranch_vccnz T_retry_182
  v_smfmac_f32_16x16x64_bf16 v[16:19], v[124:127], v[68:75], v0
  s_add_u32 s14, s14, 1
  ds_write_b128 v2, v[124:127] offset:2048
  v_mov_b32_dpp v122, v126 row_ror:8 row_mask:0xf bank_mask:0xf
  v_smfmac_f32_16x16x64_bf16 v[20:23], v[124:127], v[76:83], v0
  s_and_b32 s57, s14, 1
  v_mov_b32_dpp v123, v127 row_ror:8 row_mask:0xf bank_mask:0xf
  v_smfmac_f32_16x16x64_bf16 v[24:27], v[124:127], v[84:91], v0
  s_and_b32 s36, s14, 3
  ds_write_b128 v2, v[116:119] offset:6144
  v_smfmac_f32_16x16x64_bf16 v[16:19], v[120:123], v[92:99], v0
  s_lshl_b32 s36, s36, 13
  v_mov_b32_dpp v84, v116 row_ror:8 row_mask:0xf bank_mask:0xf
  v_smfmac_f32_16x16x64_bf16 v[20:23], v[120:123], v[100:107], v0
  s_add_u32 s26, s36, s23
  ds_read_b128 v[68:71], v4 offset:12288
  v_mov_b32_dpp v85, v117 row_ror:8 row_mask:0xf bank_mask:0xf
  v_smfmac_f32_16x16x64_bf16 v[24:27], v[120:123], v[108:115], v0
  s_add_u32 s36, s36, 8192
  ds_read_b128 v[72:75], v4 offset:13312
  v_mov_b32_dpp v86, v118 row_ror:8 row_mask:0xf bank_mask:0xf
  v_smfmac_f32_16x16x64_bf16 v[16:19], v[116:119], v[224:231], v0
  s_and_b32 s36, s36, 0x7fff
  ds_read_b128 v[76:79], v4 offset:14336
  v_mov_b32_dpp v87, v119 row_ror:8 row_mask:0xf bank_mask:0xf
  v_smfmac_f32_16x16x64_bf16 v[20:23], v[116:119], v[240:247], v0
  s_waitcnt lgkmcnt(3)
  s_barrier
  ds_read_b128 v[100:103], v2 offset:3072
  v_smfmac_f32_16x16x64_bf16 v[24:27], v[116:119], a[0:7], v0
  s_mov_b32 m0, s31
  ds_read_b128 v[120:123], v1 offset:3072
  v_smfmac_f32_16x16x64_bf16 v[16:19], v[84:87], v[232:239], v0
  s_cmp_ge_i32 s14, s30
  s_cbranch_scc1 T_kvw_185
T_kvb_186:
  v_smfmac_f32_16x16x64_bf16 v[20:23], v[84:87], v[248:255], v0
  ds_read_b128 v[80:83], v4 offset:15360
  v_smfmac_f32_16x16x64_bf16 v[24:27], v[84:87], a[8:15], v0
  s_waitcnt lgkmcnt(2)
  v_smfmac_f32_16x16x64_bf16 v[16:19], v[100:103], v[128:135], v0
  ds_read_b128 v[92:95], v2 offset:0
  buffer_load_dwordx4 v9, s[4:7], s27 offen sc1 lds
  v_smfmac_f32_16x16x64_bf16 v[20:23], v[100:103], v[144:151], v0
  ds_read_b128 v[96:99], v1 offset:0
  s_mov_b32 m0, s32
  v_smfmac_f32_16x16x64_bf16 v[24:27], v[100:103], v[68:75], v0
  s_waitcnt vmcnt(1) lgkmcnt(3)
  ds_read_b128 v[116:119], v2 offset:1024
  v_smfmac_f32_16x16x64_bf16 v[16:19], v[120:123], v[136:143], v0
  ds_read_b128 v[124:127], v1 offset:1024
  v_smfmac_f32_16x16x64_bf16 v[20:23], v[120:123], v[152:159], v0
  s_waitcnt lgkmcnt(4)
  ds_read_b128 v[104:107], v2 offset:7168
  buffer_load_dwordx4 v9, s[4:7], s27 offen offset:128 sc1 lds
  v_smfmac_f32_16x16x64_bf16 v[24:27], v[120:123], v[76:83], v0
  s_waitcnt lgkmcnt(4)
  ds_read_b128 v[108:111], v1 offset:7168
  s_mov_b32 m0, s33
  v_smfmac_f32_16x16x64_bf16 v[16:19], v[92:95], v[160:167], v0
  s_waitcnt lgkmcnt(4)
  ds_read_b128 v[112:115], v2 offset:4096
  v_mov_b32 v122, s98
  v_smfmac_f32_16x16x64_bf16 v[16:19], v[96:99], v[168:175], v0
  s_waitcnt lgkmcnt(4)
  ds_read_b128 v[84:87], v1 offset:4096
  v_smfmac_f32_16x16x64_bf16 v[16:19], v[116:119], v[192:199], v0
  s_waitcnt lgkmcnt(4)
  ds_read_b128 v[88:91], v2 offset:5120
  buffer_load_dwordx4 v10, s[4:7], s28 offen sc1 lds
  v_smfmac_f32_16x16x64_bf16 v[16:19], v[124:127], v[200:207], v0
  s_waitcnt lgkmcnt(4)
  ds_read_b128 v[100:103], v1 offset:5120
  s_mov_b32 m0, s34
  v_smfmac_f32_16x16x64_bf16 v[16:19], v[104:107], a[16:23], v0
  s_waitcnt lgkmcnt(4)
  ds_read_b128 v[68:71], v4 offset:16384
  v_smfmac_f32_16x16x64_bf16 v[16:19], v[108:111], a[24:31], v0
  s_waitcnt lgkmcnt(4)
  ds_read_b128 v[72:75], v4 offset:17408
  v_smfmac_f32_16x16x64_bf16 v[16:19], v[112:115], a[64:71], v0
  s_waitcnt lgkmcnt(4)
  ds_read_b128 v[76:79], v4 offset:18432
  buffer_load_dwordx4 v10, s[4:7], s28 offen offset:256 sc1 lds
  v_smfmac_f32_16x16x64_bf16 v[16:19], v[84:87], a[72:79], v0
  s_waitcnt lgkmcnt(4)
  ds_read_b128 v[80:83], v4 offset:19456
  v_smfmac_f32_16x16x64_bf16 v[16:19], v[88:91], a[112:119], v0
  s_waitcnt lgkmcnt(4)
  v_smfmac_f32_16x16x64_bf16 v[16:19], v[100:103], a[120:127], v0
  s_add_u32 s24, s36, 145752064
  s_add_u32 s25, s36, 145756160
  v_smfmac_f32_16x16x64_bf16 v[20:23], v[92:95], v[176:183], v0
  buffer_store_dword v122, v8, s[4:7], s15 offen sc1
  s_add_u32 s35, s36, s23
  v_smfmac_f32_16x16x64_bf16 v[20:23], v[96:99], v[184:191], v0
  s_waitcnt lgkmcnt(2)
  s_add_u32 s98, s14, 1
  v_smfmac_f32_16x16x64_bf16 v[20:23], v[116:119], v[68:75], v0
  s_waitcnt lgkmcnt(0)
  ds_read_b128 v[68:71], v4 offset:20480
  v_mul_f32 v16, s18, v16
  v_smfmac_f32_16x16x64_bf16 v[20:23], v[124:127], v[76:83], v0
  ds_read_b128 v[72:75], v4 offset:21504
  v_mul_f32 v17, s18, v17
  v_smfmac_f32_16x16x64_bf16 v[20:23], v[104:107], a[32:39], v0
  ds_read_b128 v[76:79], v4 offset:22528
  v_mul_f32 v18, s18, v18
  v_smfmac_f32_16x16x64_bf16 v[20:23], v[108:111], a[40:47], v0
  ds_read_b128 v[80:83], v4 offset:23552
  v_mul_f32 v19, s18, v19
  v_smfmac_f32_16x16x64_bf16 v[20:23], v[112:115], a[80:87], v0
  v_cvt_pk_bf16_f32 v120, v16, v17
  v_smfmac_f32_16x16x64_bf16 v[20:23], v[84:87], a[88:95], v0
  v_cvt_pk_bf16_f32 v121, v18, v19
  v_smfmac_f32_16x16x64_bf16 v[20:23], v[88:91], a[128:135], v0
  ds_write_b64 v5, v[120:121] offset:24576
  v_smfmac_f32_16x16x64_bf16 v[20:23], v[100:103], a[136:143], v0
  s_waitcnt lgkmcnt(3)
  v_smfmac_f32_16x16x64_bf16 v[24:27], v[92:95], v[68:75], v0
  s_waitcnt lgkmcnt(1)
  v_mov_b64 v[92:93], 0
  v_smfmac_f32_16x16x64_bf16 v[24:27], v[96:99], v[76:83], v0
  s_nop 1
  v_cvt_pk_bf16_f32 v122, v20, v21
  v_cvt_pk_bf16_f32 v123, v22, v23
  v_smfmac_f32_16x16x64_bf16 v[24:27], v[116:119], v[208:215], v0
  ds_write_b64 v5, v[122:123] offset:26880
  v_mov_b64 v[94:95], 0
  v_smfmac_f32_16x16x64_bf16 v[24:27], v[124:127], v[216:223], v0
  s_waitcnt lgkmcnt(1)
  s_barrier
  ds_read_b64_tr_b16 v[68:69], v6 offset:24576
  v_smfmac_f32_16x16x64_bf16 v[24:27], v[104:107], a[48:55], v0
  s_add_u32 s27, s27, 8192
  ds_read_b64_tr_b16 v[70:71], v6 offset:24640
  ds_read_b64_tr_b16 v[72:73], v6 offset:24832
  v_smfmac_f32_16x16x64_bf16 v[24:27], v[108:111], a[56:63], v0
  s_add_u32 s28, s28, 8192
  ds_read_b64_tr_b16 v[74:75], v6 offset:24896
  ds_read_b64_tr_b16 v[76:77], v6 offset:25088
  v_smfmac_f32_16x16x64_bf16 v[24:27], v[112:115], a[96:103], v0
  s_nop 0
  ds_read_b64_tr_b16 v[78:79], v6 offset:25152
  ds_read_b64_tr_b16 v[80:81], v6 offset:25344
  v_smfmac_f32_16x16x64_bf16 v[24:27], v[84:87], a[104:111], v0
  ds_read_b64_tr_b16 v[82:83], v6 offset:25408
  v_mov_b64 v[96:97], 0
  v_smfmac_f32_16x16x64_bf16 v[24:27], v[88:91], a[144:151], v0
  s_waitcnt lgkmcnt(8)
  s_barrier
  ds_read_b64_tr_b16 v[116:117], v6 offset:26880
  v_smfmac_f32_16x16x64_bf16 v[24:27], v[100:103], a[152:159], v0
  s_waitcnt lgkmcnt(7)
  ds_read_b64_tr_b16 v[118:119], v6 offset:26944
  v_mfma_f32_16x16x32_bf16 v[16:19], v[36:39], v[68:71], 0
  s_waitcnt lgkmcnt(6)
  ds_read_b64_tr_b16 v[124:125], v6 offset:27136
  ds_read_b64_tr_b16 v[126:127], v6 offset:27200
  v_mfma_f32_16x16x32_bf16 v[16:19], v[40:43], v[72:75], v[16:19]
  s_waitcnt lgkmcnt(6)
  ds_read_b64_tr_b16 v[104:105], v6 offset:27392
  ds_read_b64_tr_b16 v[106:107], v6 offset:27456
  v_mfma_f32_16x16x32_bf16 v[16:19], v[44:47], v[76:79], v[16:19]
  s_waitcnt lgkmcnt(6)
  ds_read_b64_tr_b16 v[108:109], v6 offset:27648
  ds_read_b64_tr_b16 v[110:111], v6 offset:27712
  v_mfma_f32_16x16x32_bf16 v[16:19], v[48:51], v[80:83], v[16:19]
  s_waitcnt lgkmcnt(6)
  v_cvt_pk_bf16_f32 v120, v24, v25
  v_cvt_pk_bf16_f32 v121, v26, v27
  v_mfma_f32_16x16x32_bf16 v[112:115], v[116:119], v[68:71], 0
  s_waitcnt lgkmcnt(4)
  v_mov_b64 v[98:99], 0
  v_mfma_f32_16x16x32_bf16 v[112:115], v[124:127], v[72:75], v[112:115]
  s_waitcnt lgkmcnt(2)
  v_mov_b64 v[36:37], 0
  v_exp_f32 v100, v16
  v_mfma_f32_16x16x32_bf16 v[112:115], v[104:107], v[76:79], v[112:115]
  s_waitcnt lgkmcnt(0)
  buffer_store_dwordx4 v[120:123], v2, s[4:7], s29 offen offset:2048 sc1
  v_exp_f32 v101, v17
  v_mfma_f32_16x16x32_bf16 v[112:115], v[108:111], v[80:83], v[112:115]
  v_exp_f32 v102, v18
  v_mfma_f32_16x16x32_bf16 v[20:23], v[52:55], v[68:71], 0
  s_cmp_eq_u32 s14, 63
  v_exp_f32 v103, v19
  v_mfma_f32_16x16x32_bf16 v[20:23], v[56:59], v[72:75], v[20:23]
  s_cbranch_scc1 M_tdone
  v_cvt_pk_bf16_f32 v44, v100, v101
  v_cvt_pk_bf16_f32 v45, v102, v103
  v_mfma_f32_16x16x32_bf16 v[20:23], v[60:63], v[76:79], v[20:23]
  s_add_u32 s29, s29, 131072
  v_exp_f32 v100, v112
  v_mfma_f32_16x16x32_bf16 v[20:23], v[64:67], v[80:83], v[20:23]
  v_exp_f32 v101, v113
  v_exp_f32 v102, v114
  v_exp_f32 v103, v115
  v_cvt_pk_bf16_f32 v84, v100, v101
  v_cvt_pk_bf16_f32 v85, v102, v103
  v_cndmask_b32 v48, v84, 0, s[16:17]
  v_cndmask_b32 v49, v85, 0, s[16:17]
  v_cndmask_b32 v50, 0, v84, s[16:17]
  v_cndmask_b32 v51, 0, v85, s[16:17]
  v_exp_f32 v100, v20
  v_mfma_f32_16x16x16_bf16 v[88:91], v[12:13], v[48:49], 0
  v_exp_f32 v101, v21
  v_mfma_f32_16x16x16_bf16 v[24:27], v[120:121], v[48:49], 0
  v_exp_f32 v102, v22
  v_mfma_f32_16x16x16_bf16 v[116:119], v[120:121], v[50:51], 0
  v_exp_f32 v103, v23
  v_cvt_pk_bf16_f32 v46, v100, v101
  v_cvt_pk_bf16_f32 v47, v102, v103
  v_mov_b64 v[38:39], 0
  s_nop 0
  v_mfma_f32_16x16x32_bf16 v[88:91], v[12:15], v[44:47], v[88:91]
  v_mov_b64 v[40:41], 0
  v_mov_b64 v[42:43], 0
  v_mfma_f32_16x16x32_bf16 v[24:27], v[28:31], v[44:47], v[24:27]
  ds_read_b128 v[52:55], v4 offset:24576
  ds_read_b128 v[56:59], v4 offset:25600
  v_mfma_f32_16x16x32_bf16 v[116:119], v[32:35], v[44:47], v[116:119]
  s_nop 1
  v_rcp_f32 v89, v88
  v_subrev_u32 v100, s54, v88
  v_cmp_le_u32 vcc, s55, v100
  v_mul_f32 v24, v89, v24
  v_mul_f32 v25, v89, v25
  s_cbranch_vccnz T_slow_188
T_back_189:
  v_cvt_pk_bf16_f32 v124, v24, v25
  v_pk_mul_f32 v[26:27], v[26:27], v[88:89] op_sel:[0,1] op_sel_hi:[1,1]
  v_pk_mul_f32 v[116:117], v[116:117], v[88:89] op_sel:[0,1] op_sel_hi:[1,1]
  v_pk_mul_f32 v[118:119], v[118:119], v[88:89] op_sel:[0,1] op_sel_hi:[1,1]
  v_cvt_pk_bf16_f32 v125, v26, v27
  v_cvt_pk_bf16_f32 v126, v116, v117
  v_cvt_pk_bf16_f32 v127, v118, v119
  ds_write_b128 v11, v[124:127] offset:30208
  s_nop 0
  v_smfmac_f32_16x16x64_bf16 v[92:95], v[124:127], a[160:167], v0
  v_smfmac_f32_16x16x64_bf16 v[96:99], v[124:127], a[168:175], v0
  v_smfmac_f32_16x16x64_bf16 v[36:39], v[124:127], a[176:183], v0
  v_smfmac_f32_16x16x64_bf16 v[40:43], v[124:127], a[184:191], v0
  s_waitcnt lgkmcnt(0)
  s_barrier
  ds_read_b128 v[104:107], v11 offset:30720
  ds_read_b128 v[108:111], v11 offset:29184
  ds_read_b128 v[68:71], v11 offset:29696
  s_waitcnt lgkmcnt(2)
  v_smfmac_f32_16x16x64_bf16 v[92:95], v[104:107], a[192:199], v0
  s_waitcnt lgkmcnt(1)
  ds_read_b128 v[76:79], v4 offset:28672
  v_smfmac_f32_16x16x64_bf16 v[92:95], v[108:111], a[224:231], v0
  s_waitcnt lgkmcnt(1)
  ds_read_b128 v[80:83], v4 offset:29696
  v_smfmac_f32_16x16x64_bf16 v[92:95], v[68:71], a[240:247], v0
  ds_read_b128 v[60:63], v4 offset:26624
  v_smfmac_f32_16x16x64_bf16 v[96:99], v[104:107], a[200:207], v0
  ds_read_b128 v[64:67], v4 offset:27648
  v_smfmac_f32_16x16x64_bf16 v[96:99], v[108:111], a[232:239], v0
  ds_read_b128 v[28:31], v4 offset:30720
  s_nop 0
  v_cvt_pk_bf16_f32 v16, v92, v93
  v_cvt_pk_bf16_f32 v17, v94, v95
  v_bfi_b32 v16, 1, s57, v16
  v_smfmac_f32_16x16x64_bf16 v[96:99], v[68:71], a[248:255], v0
  buffer_store_dwordx2 v[16:17], v7, s[4:7], s20 offen offset:0 sc1
  v_smfmac_f32_16x16x64_bf16 v[36:39], v[104:107], a[208:215], v0
  ds_read_b128 v[32:35], v4 offset:31744
  v_smfmac_f32_16x16x64_bf16 v[36:39], v[108:111], v[52:59], v0
  s_waitcnt lgkmcnt(4)
  s_nop 0
  v_cvt_pk_bf16_f32 v18, v96, v97
  v_cvt_pk_bf16_f32 v19, v98, v99
  v_bfi_b32 v18, 1, s57, v18
  v_smfmac_f32_16x16x64_bf16 v[36:39], v[68:71], v[76:83], v0
  buffer_store_dwordx2 v[18:19], v7, s[4:7], s20 offen offset:64 sc1
  v_smfmac_f32_16x16x64_bf16 v[40:43], v[104:107], a[216:223], v0
  s_waitcnt lgkmcnt(2)
  v_smfmac_f32_16x16x64_bf16 v[40:43], v[108:111], v[60:67], v0
  s_waitcnt lgkmcnt(0)
  s_nop 0
  v_cvt_pk_bf16_f32 v20, v36, v37
  v_cvt_pk_bf16_f32 v21, v38, v39
  v_bfi_b32 v20, 1, s57, v20
  v_smfmac_f32_16x16x64_bf16 v[40:43], v[68:71], v[28:35], v0
  buffer_store_dwordx2 v[20:21], v7, s[4:7], s21 offen offset:0 sc1
  s_nop 6
  v_cvt_pk_bf16_f32 v22, v40, v41
  v_cvt_pk_bf16_f32 v23, v42, v43
  v_bfi_b32 v22, 1, s57, v22
  buffer_store_dwordx2 v[22:23], v7, s[4:7], s21 offen offset:64 sc1
  ds_read_b128 v[68:71], v4 offset:0
  ds_read_b128 v[72:75], v4 offset:1024
  ds_read_b128 v[76:79], v4 offset:4096
  ds_read_b128 v[80:83], v4 offset:5120
  ds_read_b128 v[84:87], v4 offset:8192
  ds_read_b128 v[88:91], v4 offset:9216
  ds_read_b128 v[92:95], v4 offset:2048
  ds_read_b128 v[96:99], v4 offset:3072
  ds_read_b128 v[100:103], v4 offset:6144
  ds_read_b128 v[104:107], v4 offset:7168
  ds_read_b128 v[108:111], v4 offset:10240
  ds_read_b128 v[112:115], v4 offset:11264
  v_mov_b64 v[16:17], 0
  v_mov_b64 v[18:19], 0
  v_mov_b64 v[20:21], 0
  v_mov_b64 v[22:23], 0
  v_mov_b64 v[24:25], 0
  v_mov_b64 v[26:27], 0
  ds_read_b64 v[44:45], v2 offset:32256
  s_waitcnt lgkmcnt(0)
  v_readfirstlane_b32 s38, v44
  v_readfirstlane_b32 s37, v45
  s_nop 0
  s_add_u32 s37, s37, 30
  s_cmp_ge_u32 s38, 30
  s_cselect_b32 s38, s37, s38
  s_cmp_ge_u32 s38, 64
  s_cselect_b32 s38, 100, s38
  s_sub_u32 s38, s38, 1
  s_max_i32 s30, s30, s38
  s_waitcnt vmcnt(4)
  s_barrier
  ds_read_b128 v[28:31], v2 offset:18432
  ds_read_b128 v[32:35], v2 offset:22528
  ds_read_b128 v[36:39], v2 offset:8192
  ds_read_b128 v[40:43], v2 offset:9216
  ds_read_b128 v[44:47], v2 offset:10240
  ds_read_b128 v[48:51], v2 offset:11264
  buffer_load_dwordx4 v[124:127], v3, s[4:7], s24 offen offset:2048 sc1
  buffer_load_dwordx4 v[116:119], v3, s[4:7], s25 offen offset:2048 sc1
  ds_read_b128 v[52:55], v2 offset:12288
  ds_read_b128 v[56:59], v2 offset:13312
  ds_read_b128 v[60:63], v2 offset:14336
  ds_read_b128 v[64:67], v2 offset:15360
  buffer_load_dwordx4 v[124:127], v3, s[4:7], s24 offen offset:2048 sc1
  buffer_load_dwordx4 v[116:119], v3, s[4:7], s25 offen offset:2048 sc1
  s_mov_b32 s19, 0
  s_branch T_loop_181
T_kvw_185:
  s_mov_b32 s19, 0
  s_branch T_kvok_194
T_kv_193:
  s_sleep 4
  s_add_u32 s19, s19, 1
  s_cmp_gt_u32 s19, 32768
  s_cbranch_scc1 M_exit
T_kvok_194:
  s_add_u32 s39, s99, 128
  s_mov_b32 s38, 0
  s_mov_b32 s37, 0
  s_atomic_or s38, s[58:59], s99 glc
  s_atomic_or s37, s[58:59], s39 glc
  s_waitcnt lgkmcnt(0)
  s_add_u32 s37, s37, 30
  s_cmp_ge_u32 s38, 30
  s_cselect_b32 s38, s37, s38
  s_cmp_ge_u32 s38, 64
  s_cselect_b32 s38, 100, s38
  s_sub_u32 s38, s38, 1
  s_max_i32 s30, s30, s38
  s_cmp_ge_i32 s14, s30
  s_cbranch_scc1 T_kv_193
  s_branch T_kvb_186
T_slow_188:
  s_nop 7
  v_max3_f32 v100, v16, v17, v18
  v_max3_f32 v100, v100, v19, v20
  v_max3_f32 v100, v100, v21, v22
  v_max3_f32 v100, v100, v23, v112
  v_max3_f32 v100, v100, v113, v114
  v_max_f32 v100, v100, v115
  v_mov_b32 v101, v100
  s_nop 1
  v_permlane32_swap_b32 v100, v101
  s_nop 1
  v_max_f32 v100, v100, v101
  v_mov_b32 v101, v100
  s_nop 1
  v_permlane16_swap_b32 v100, v101
  s_nop 1
  v_max_f32 v100, v100, v101
  v_sub_f32 v16, v16, v100
  v_sub_f32 v17, v17, v100
  v_sub_f32 v18, v18, v100
  v_sub_f32 v19, v19, v100
  v_exp_f32 v16, v16
  v_exp_f32 v17, v17
  v_exp_f32 v18, v18
  v_exp_f32 v19, v19
  v_sub_f32 v20, v20, v100
  v_sub_f32 v21, v21, v100
  v_sub_f32 v22, v22, v100
  v_sub_f32 v23, v23, v100
  v_exp_f32 v20, v20
  v_exp_f32 v21, v21
  v_exp_f32 v22, v22
  v_exp_f32 v23, v23
  v_sub_f32 v112, v112, v100
  v_sub_f32 v113, v113, v100
  v_sub_f32 v114, v114, v100
  v_sub_f32 v115, v115, v100
  v_exp_f32 v112, v112
  v_exp_f32 v113, v113
  v_exp_f32 v114, v114
  v_exp_f32 v115, v115
  s_nop 0
  v_cvt_pk_bf16_f32 v44, v16, v17
  v_cvt_pk_bf16_f32 v45, v18, v19
  v_cvt_pk_bf16_f32 v46, v20, v21
  v_cvt_pk_bf16_f32 v47, v22, v23
  v_cvt_pk_bf16_f32 v84, v112, v113
  v_cvt_pk_bf16_f32 v85, v114, v115
  v_cndmask_b32 v48, v84, 0, s[16:17]
  v_cndmask_b32 v49, v85, 0, s[16:17]
  v_cndmask_b32 v50, 0, v84, s[16:17]
  v_cndmask_b32 v51, 0, v85, s[16:17]
  s_nop 1
  v_mfma_f32_16x16x16_bf16 v[88:91], v[12:13], v[48:49], 0
  v_mfma_f32_16x16x16_bf16 v[24:27], v[120:121], v[48:49], 0
  v_mfma_f32_16x16x16_bf16 v[116:119], v[120:121], v[50:51], 0
  v_mfma_f32_16x16x32_bf16 v[88:91], v[12:15], v[44:47], v[88:91]
  v_mfma_f32_16x16x32_bf16 v[24:27], v[28:31], v[44:47], v[24:27]
  v_mfma_f32_16x16x32_bf16 v[116:119], v[32:35], v[44:47], v[116:119]
  s_nop 7
  s_nop 1
  v_rcp_f32 v89, v88
  s_nop 0
  v_mul_f32 v24, v89, v24
  v_mul_f32 v25, v89, v25
  s_branch T_back_189
T_w_152:
  s_mov_b32 s19, 0
  v_mov_b64 v[16:17], 0
  v_mov_b64 v[18:19], 0
  v_mov_b64 v[20:21], 0
  v_mov_b64 v[22:23], 0
  v_mov_b64 v[24:25], 0
  v_mov_b64 v[26:27], 0
  buffer_load_dwordx4 v[124:127], v3, s[4:7], s24 offen offset:3072 sc1
  buffer_load_dwordx4 v[116:119], v3, s[4:7], s25 offen offset:3072 sc1
  buffer_load_dwordx4 v[124:127], v3, s[4:7], s24 offen offset:3072 sc1
  buffer_load_dwordx4 v[116:119], v3, s[4:7], s25 offen offset:3072 sc1
  s_branch T_loop_195
.p2align 6
T_retry_196:
  s_mov_b64 exec, vcc
  buffer_load_dwordx4 v[124:127], v3, s[4:7], s24 offen offset:3072 sc1
  buffer_load_dwordx4 v[116:119], v3, s[4:7], s25 offen offset:3072 sc1
  s_mov_b64 exec, -1
  s_add_u32 s19, s19, 1
  s_cmp_gt_u32 s19, 32768
  s_cbranch_scc1 M_exit
T_loop_195:
  s_waitcnt vmcnt(3) lgkmcnt(0)
  v_max3_u32 v123, v124, v125, v126
  v_max_u32 v123, v123, v127
  v_mov_b32_dpp v120, v124 row_ror:8 row_mask:0xf bank_mask:0xf
  v_mov_b32_dpp v121, v125 row_ror:8 row_mask:0xf bank_mask:0xf
  s_waitcnt vmcnt(2)
  v_max3_u32 v123, v123, v116, v117
  v_max3_u32 v123, v123, v118, v119
  v_cmp_eq_u32 vcc, -1, v123
  s_cbranch_vccnz T_retry_196
  v_smfmac_f32_16x16x64_bf16 v[16:19], v[124:127], v[68:75], v0
  s_add_u32 s14, s14, 1
  ds_write_b128 v2, v[124:127] offset:3072
  v_mov_b32_dpp v122, v126 row_ror:8 row_mask:0xf bank_mask:0xf
  v_smfmac_f32_16x16x64_bf16 v[20:23], v[124:127], v[76:83], v0
  s_and_b32 s57, s14, 1
  v_mov_b32_dpp v123, v127 row_ror:8 row_mask:0xf bank_mask:0xf
  v_smfmac_f32_16x16x64_bf16 v[24:27], v[124:127], v[84:91], v0
  s_and_b32 s36, s14, 3
  ds_write_b128 v2, v[116:119] offset:7168
  v_smfmac_f32_16x16x64_bf16 v[16:19], v[120:123], v[92:99], v0
  s_lshl_b32 s36, s36, 13
  v_mov_b32_dpp v84, v116 row_ror:8 row_mask:0xf bank_mask:0xf
  v_smfmac_f32_16x16x64_bf16 v[20:23], v[120:123], v[100:107], v0
  s_add_u32 s26, s36, s23
  ds_read_b128 v[68:71], v4 offset:12288
  v_mov_b32_dpp v85, v117 row_ror:8 row_mask:0xf bank_mask:0xf
  v_smfmac_f32_16x16x64_bf16 v[24:27], v[120:123], v[108:115], v0
  s_add_u32 s36, s36, 8192
  ds_read_b128 v[72:75], v4 offset:13312
  v_mov_b32_dpp v86, v118 row_ror:8 row_mask:0xf bank_mask:0xf
  v_smfmac_f32_16x16x64_bf16 v[16:19], v[116:119], v[224:231], v0
  s_and_b32 s36, s36, 0x7fff
  ds_read_b128 v[76:79], v4 offset:14336
  v_mov_b32_dpp v87, v119 row_ror:8 row_mask:0xf bank_mask:0xf
  v_smfmac_f32_16x16x64_bf16 v[20:23], v[116:119], v[240:247], v0
  s_waitcnt lgkmcnt(3)
  s_barrier
  ds_read_b128 v[100:103], v2 offset:2048
  v_smfmac_f32_16x16x64_bf16 v[24:27], v[116:119], a[0:7], v0
  s_mov_b32 m0, s31
  ds_read_b128 v[120:123], v1 offset:2048
  v_smfmac_f32_16x16x64_bf16 v[16:19], v[84:87], v[232:239], v0
  s_cmp_ge_i32 s14, s30
  s_cbranch_scc1 T_kvw_199
T_kvb_200:
  v_smfmac_f32_16x16x64_bf16 v[20:23], v[84:87], v[248:255], v0
  ds_read_b128 v[80:83], v4 offset:15360
  v_smfmac_f32_16x16x64_bf16 v[24:27], v[84:87], a[8:15], v0
  s_waitcnt lgkmcnt(2)
  v_smfmac_f32_16x16x64_bf16 v[16:19], v[100:103], v[128:135], v0
  ds_read_b128 v[92:95], v2 offset:1024
  v_smfmac_f32_16x16x64_bf16 v[20:23], v[100:103], v[144:151], v0
  ds_read_b128 v[96:99], v1 offset:1024
  buffer_load_dwordx4 v9, s[4:7], s27 offen sc1 lds
  v_smfmac_f32_16x16x64_bf16 v[24:27], v[100:103], v[68:75], v0
  s_waitcnt vmcnt(1) lgkmcnt(3)
  ds_read_b128 v[116:119], v2 offset:0
  s_mov_b32 m0, s32
  v_smfmac_f32_16x16x64_bf16 v[16:19], v[120:123], v[136:143], v0
  ds_read_b128 v[124:127], v1 offset:0
  v_smfmac_f32_16x16x64_bf16 v[20:23], v[120:123], v[152:159], v0
  s_waitcnt lgkmcnt(4)
  ds_read_b128 v[104:107], v2 offset:6144
  v_smfmac_f32_16x16x64_bf16 v[24:27], v[120:123], v[76:83], v0
  s_waitcnt lgkmcnt(4)
  ds_read_b128 v[108:111], v1 offset:6144
  buffer_load_dwordx4 v9, s[4:7], s27 offen offset:128 sc1 lds
  v_smfmac_f32_16x16x64_bf16 v[16:19], v[92:95], v[160:167], v0
  s_waitcnt lgkmcnt(4)
  ds_read_b128 v[112:115], v2 offset:5120
  s_mov_b32 m0, s33
  v_smfmac_f32_16x16x64_bf16 v[16:19], v[96:99], v[168:175], v0
  s_waitcnt lgkmcnt(4)
  ds_read_b128 v[84:87], v1 offset:5120
  v_smfmac_f32_16x16x64_bf16 v[16:19], v[116:119], v[192:199], v0
  s_waitcnt lgkmcnt(4)
  ds_read_b128 v[88:91], v2 offset:4096
  v_smfmac_f32_16x16x64_bf16 v[16:19], v[124:127], v[200:207], v0
  s_waitcnt lgkmcnt(4)
  ds_read_b128 v[100:103], v1 offset:4096
  buffer_load_dwordx4 v10, s[4:7], s28 offen sc1 lds
  v_smfmac_f32_16x16x64_bf16 v[16:19], v[104:107], a[16:23], v0
  s_waitcnt lgkmcnt(4)
  ds_read_b128 v[68:71], v4 offset:16384
  s_mov_b32 m0, s34
  v_smfmac_f32_16x16x64_bf16 v[16:19], v[108:111], a[24:31], v0
  s_waitcnt lgkmcnt(4)
  ds_read_b128 v[72:75], v4 offset:17408
  v_smfmac_f32_16x16x64_bf16 v[16:19], v[112:115], a[64:71], v0
  s_waitcnt lgkmcnt(4)
  ds_read_b128 v[76:79], v4 offset:18432
  v_smfmac_f32_16x16x64_bf16 v[16:19], v[84:87], a[72:79], v0
  s_waitcnt lgkmcnt(4)
  ds_read_b128 v[80:83], v4 offset:19456
  buffer_load_dwordx4 v10, s[4:7], s28 offen offset:256 sc1 lds
  v_smfmac_f32_16x16x64_bf16 v[16:19], v[88:91], a[112:119], v0
  s_waitcnt lgkmcnt(4)
  s_mov_b32 m0, 32256
  v_smfmac_f32_16x16x64_bf16 v[16:19], v[100:103], a[120:127], v0
  s_add_u32 s24, s36, 145752064
  s_add_u32 s25, s36, 145756160
  v_smfmac_f32_16x16x64_bf16 v[20:23], v[92:95], v[176:183], v0
  s_add_u32 s35, s36, s23
  v_smfmac_f32_16x16x64_bf16 v[20:23], v[96:99], v[184:191], v0
  s_waitcnt lgkmcnt(2)
  buffer_load_dword v8, s[4:7], s99 offen sc1 lds
  v_smfmac_f32_16x16x64_bf16 v[20:23], v[116:119], v[68:75], v0
  s_waitcnt lgkmcnt(0)
  ds_read_b128 v[68:71], v4 offset:20480
  v_mul_f32 v16, s18, v16
  v_smfmac_f32_16x16x64_bf16 v[20:23], v[124:127], v[76:83], v0
  ds_read_b128 v[72:75], v4 offset:21504
  v_mul_f32 v17, s18, v17
  v_smfmac_f32_16x16x64_bf16 v[20:23], v[104:107], a[32:39], v0
  ds_read_b128 v[76:79], v4 offset:22528
  v_mul_f32 v18, s18, v18
  v_smfmac_f32_16x16x64_bf16 v[20:23], v[108:111], a[40:47], v0
  ds_read_b128 v[80:83], v4 offset:23552
  v_mul_f32 v19, s18, v19
  v_smfmac_f32_16x16x64_bf16 v[20:23], v[112:115], a[80:87], v0
  v_cvt_pk_bf16_f32 v120, v16, v17
  v_smfmac_f32_16x16x64_bf16 v[20:23], v[84:87], a[88:95], v0
  v_cvt_pk_bf16_f32 v121, v18, v19
  v_smfmac_f32_16x16x64_bf16 v[20:23], v[88:91], a[128:135], v0
  ds_write_b64 v5, v[120:121] offset:24576
  v_smfmac_f32_16x16x64_bf16 v[20:23], v[100:103], a[136:143], v0
  s_waitcnt lgkmcnt(3)
  v_smfmac_f32_16x16x64_bf16 v[24:27], v[92:95], v[68:75], v0
  s_waitcnt lgkmcnt(1)
  v_mov_b64 v[92:93], 0
  v_smfmac_f32_16x16x64_bf16 v[24:27], v[96:99], v[76:83], v0
  s_nop 1
  v_cvt_pk_bf16_f32 v122, v20, v21
  v_cvt_pk_bf16_f32 v123, v22, v23
  v_smfmac_f32_16x16x64_bf16 v[24:27], v[116:119], v[208:215], v0
  ds_write_b64 v5, v[122:123] offset:26880
  v_mov_b64 v[94:95], 0
  v_smfmac_f32_16x16x64_bf16 v[24:27], v[124:127], v[216:223], v0
  s_waitcnt lgkmcnt(1)
  s_barrier
  ds_read_b64_tr_b16 v[68:69], v6 offset:24576
  v_smfmac_f32_16x16x64_bf16 v[24:27], v[104:107], a[48:55], v0
  s_add_u32 s27, s27, 8192
  ds_read_b64_tr_b16 v[70:71], v6 offset:24640
  ds_read_b64_tr_b16 v[72:73], v6 offset:24832
  v_smfmac_f32_16x16x64_bf16 v[24:27], v[108:111], a[56:63], v0
  s_add_u32 s28, s28, 8192
  ds_read_b64_tr_b16 v[74:75], v6 offset:24896
  ds_read_b64_tr_b16 v[76:77], v6 offset:25088
  v_smfmac_f32_16x16x64_bf16 v[24:27], v[112:115], a[96:103], v0
  s_nop 0
  ds_read_b64_tr_b16 v[78:79], v6 offset:25152
  ds_read_b64_tr_b16 v[80:81], v6 offset:25344
  v_smfmac_f32_16x16x64_bf16 v[24:27], v[84:87], a[104:111], v0
  ds_read_b64_tr_b16 v[82:83], v6 offset:25408
  v_mov_b64 v[96:97], 0
  v_smfmac_f32_16x16x64_bf16 v[24:27], v[88:91], a[144:151], v0
  s_waitcnt lgkmcnt(8)
  s_barrier
  ds_read_b64_tr_b16 v[116:117], v6 offset:26880
  v_smfmac_f32_16x16x64_bf16 v[24:27], v[100:103], a[152:159], v0
  s_waitcnt lgkmcnt(7)
  ds_read_b64_tr_b16 v[118:119], v6 offset:26944
  v_mfma_f32_16x16x32_bf16 v[16:19], v[36:39], v[68:71], 0
  s_waitcnt lgkmcnt(6)
  ds_read_b64_tr_b16 v[124:125], v6 offset:27136
  ds_read_b64_tr_b16 v[126:127], v6 offset:27200
  v_mfma_f32_16x16x32_bf16 v[16:19], v[40:43], v[72:75], v[16:19]
  s_waitcnt lgkmcnt(6)
  ds_read_b64_tr_b16 v[104:105], v6 offset:27392
  ds_read_b64_tr_b16 v[106:107], v6 offset:27456
  v_mfma_f32_16x16x32_bf16 v[16:19], v[44:47], v[76:79], v[16:19]
  s_waitcnt lgkmcnt(6)
  ds_read_b64_tr_b16 v[108:109], v6 offset:27648
  ds_read_b64_tr_b16 v[110:111], v6 offset:27712
  v_mfma_f32_16x16x32_bf16 v[16:19], v[48:51], v[80:83], v[16:19]
  s_waitcnt lgkmcnt(6)
  v_cvt_pk_bf16_f32 v120, v24, v25
  v_cvt_pk_bf16_f32 v121, v26, v27
  v_mfma_f32_16x16x32_bf16 v[112:115], v[116:119], v[68:71], 0
  s_waitcnt lgkmcnt(4)
  v_mov_b64 v[98:99], 0
  v_mfma_f32_16x16x32_bf16 v[112:115], v[124:127], v[72:75], v[112:115]
  s_waitcnt lgkmcnt(2)
  v_mov_b64 v[36:37], 0
  v_exp_f32 v100, v16
  v_mfma_f32_16x16x32_bf16 v[112:115], v[104:107], v[76:79], v[112:115]
  s_waitcnt lgkmcnt(0)
  v_exp_f32 v101, v17
  v_mfma_f32_16x16x32_bf16 v[112:115], v[108:111], v[80:83], v[112:115]
  buffer_store_dwordx4 v[120:123], v2, s[4:7], s29 offen offset:3072 sc1
  v_exp_f32 v102, v18
  v_mfma_f32_16x16x32_bf16 v[20:23], v[52:55], v[68:71], 0
  s_cmp_eq_u32 s14, 63
  v_exp_f32 v103, v19
  v_mfma_f32_16x16x32_bf16 v[20:23], v[56:59], v[72:75], v[20:23]
  s_cbranch_scc1 M_tdone
  v_cvt_pk_bf16_f32 v44, v100, v101
  v_cvt_pk_bf16_f32 v45, v102, v103
  v_mfma_f32_16x16x32_bf16 v[20:23], v[60:63], v[76:79], v[20:23]
  s_add_u32 s29, s29, 131072
  v_exp_f32 v100, v112
  v_mfma_f32_16x16x32_bf16 v[20:23], v[64:67], v[80:83], v[20:23]
  v_exp_f32 v101, v113
  v_exp_f32 v102, v114
  v_exp_f32 v103, v115
  v_cvt_pk_bf16_f32 v84, v100, v101
  v_cvt_pk_bf16_f32 v85, v102, v103
  v_cndmask_b32 v48, v84, 0, s[16:17]
  v_cndmask_b32 v49, v85, 0, s[16:17]
  v_cndmask_b32 v50, 0, v84, s[16:17]
  v_cndmask_b32 v51, 0, v85, s[16:17]
  v_exp_f32 v100, v20
  v_mfma_f32_16x16x16_bf16 v[88:91], v[12:13], v[48:49], 0
  v_exp_f32 v101, v21
  v_mfma_f32_16x16x16_bf16 v[24:27], v[120:121], v[48:49], 0
  v_exp_f32 v102, v22
  v_mfma_f32_16x16x16_bf16 v[116:119], v[120:121], v[50:51], 0
  v_exp_f32 v103, v23
  v_cvt_pk_bf16_f32 v46, v100, v101
  v_cvt_pk_bf16_f32 v47, v102, v103
  v_mov_b64 v[38:39], 0
  s_nop 0
  v_mfma_f32_16x16x32_bf16 v[88:91], v[12:15], v[44:47], v[88:91]
  v_mov_b64 v[40:41], 0
  v_mov_b64 v[42:43], 0
  v_mfma_f32_16x16x32_bf16 v[24:27], v[28:31], v[44:47], v[24:27]
  ds_read_b128 v[52:55], v4 offset:24576
  ds_read_b128 v[56:59], v4 offset:25600
  v_mfma_f32_16x16x32_bf16 v[116:119], v[32:35], v[44:47], v[116:119]
  s_nop 1
  v_rcp_f32 v89, v88
  v_subrev_u32 v100, s54, v88
  v_cmp_le_u32 vcc, s55, v100
  v_mul_f32 v24, v89, v24
  v_mul_f32 v25, v89, v25
  s_cbranch_vccnz T_slow_202
T_back_203:
  v_cvt_pk_bf16_f32 v124, v24, v25
  v_pk_mul_f32 v[26:27], v[26:27], v[88:89] op_sel:[0,1] op_sel_hi:[1,1]
  v_pk_mul_f32 v[116:117], v[116:117], v[88:89] op_sel:[0,1] op_sel_hi:[1,1]
  v_pk_mul_f32 v[118:119], v[118:119], v[88:89] op_sel:[0,1] op_sel_hi:[1,1]
  v_cvt_pk_bf16_f32 v125, v26, v27
  v_cvt_pk_bf16_f32 v126, v116, v117
  v_cvt_pk_bf16_f32 v127, v118, v119
  ds_write_b128 v11, v[124:127] offset:30720
  s_nop 0
  v_smfmac_f32_16x16x64_bf16 v[92:95], v[124:127], a[160:167], v0
  v_smfmac_f32_16x16x64_bf16 v[96:99], v[124:127], a[168:175], v0
  v_smfmac_f32_16x16x64_bf16 v[36:39], v[124:127], a[176:183], v0
  v_smfmac_f32_16x16x64_bf16 v[40:43], v[124:127], a[184:191], v0
  s_waitcnt lgkmcnt(0)
  s_barrier
  ds_read_b128 v[104:107], v11 offset:30208
  ds_read_b128 v[108:111], v11 offset:29696
  ds_read_b128 v[68:71], v11 offset:29184
  s_waitcnt lgkmcnt(2)
  v_smfmac_f32_16x16x64_bf16 v[92:95], v[104:107], a[192:199], v0
  s_waitcnt lgkmcnt(1)
  ds_read_b128 v[76:79], v4 offset:28672
  v_smfmac_f32_16x16x64_bf16 v[92:95], v[108:111], a[224:231], v0
  s_waitcnt lgkmcnt(1)
  ds_read_b128 v[80:83], v4 offset:29696
  v_smfmac_f32_16x16x64_bf16 v[92:95], v[68:71], a[240:247], v0
  ds_read_b128 v[60:63], v4 offset:26624
  v_smfmac_f32_16x16x64_bf16 v[96:99], v[104:107], a[200:207], v0
  ds_read_b128 v[64:67], v4 offset:27648
  v_smfmac_f32_16x16x64_bf16 v[96:99], v[108:111], a[232:239], v0
  ds_read_b128 v[28:31], v4 offset:30720
  s_nop 0
  v_cvt_pk_bf16_f32 v16, v92, v93
  v_cvt_pk_bf16_f32 v17, v94, v95
  v_bfi_b32 v16, 1, s57, v16
  v_smfmac_f32_16x16x64_bf16 v[96:99], v[68:71], a[248:255], v0
  buffer_store_dwordx2 v[16:17], v7, s[4:7], s20 offen offset:0 sc1
  v_smfmac_f32_16x16x64_bf16 v[36:39], v[104:107], a[208:215], v0
  ds_read_b128 v[32:35], v4 offset:31744
  v_smfmac_f32_16x16x64_bf16 v[36:39], v[108:111], v[52:59], v0
  s_waitcnt lgkmcnt(4)
  s_nop 0
  v_cvt_pk_bf16_f32 v18, v96, v97
  v_cvt_pk_bf16_f32 v19, v98, v99
  v_bfi_b32 v18, 1, s57, v18
  v_smfmac_f32_16x16x64_bf16 v[36:39], v[68:71], v[76:83], v0
  buffer_store_dwordx2 v[18:19], v7, s[4:7], s20 offen offset:64 sc1
  v_smfmac_f32_16x16x64_bf16 v[40:43], v[104:107], a[216:223], v0
  s_waitcnt lgkmcnt(2)
  v_smfmac_f32_16x16x64_bf16 v[40:43], v[108:111], v[60:67], v0
  s_waitcnt lgkmcnt(0)
  s_nop 0
  v_cvt_pk_bf16_f32 v20, v36, v37
  v_cvt_pk_bf16_f32 v21, v38, v39
  v_bfi_b32 v20, 1, s57, v20
  v_smfmac_f32_16x16x64_bf16 v[40:43], v[68:71], v[28:35], v0
  buffer_store_dwordx2 v[20:21], v7, s[4:7], s21 offen offset:0 sc1
  s_nop 6
  v_cvt_pk_bf16_f32 v22, v40, v41
  v_cvt_pk_bf16_f32 v23, v42, v43
  v_bfi_b32 v22, 1, s57, v22
  buffer_store_dwordx2 v[22:23], v7, s[4:7], s21 offen offset:64 sc1
  ds_read_b128 v[68:71], v4 offset:0
  ds_read_b128 v[72:75], v4 offset:1024
  ds_read_b128 v[76:79], v4 offset:4096
  ds_read_b128 v[80:83], v4 offset:5120
  ds_read_b128 v[84:87], v4 offset:8192
  ds_read_b128 v[88:91], v4 offset:9216
  ds_read_b128 v[92:95], v4 offset:2048
  ds_read_b128 v[96:99], v4 offset:3072
  ds_read_b128 v[100:103], v4 offset:6144
  ds_read_b128 v[104:107], v4 offset:7168
  ds_read_b128 v[108:111], v4 offset:10240
  ds_read_b128 v[112:115], v4 offset:11264
  v_mov_b64 v[16:17], 0
  v_mov_b64 v[18:19], 0
  v_mov_b64 v[20:21], 0
  v_mov_b64 v[22:23], 0
  v_mov_b64 v[24:25], 0
  v_mov_b64 v[26:27], 0
  ds_read_b64 v[44:45], v2 offset:32256
  s_waitcnt lgkmcnt(0)
  v_readfirstlane_b32 s38, v44
  v_readfirstlane_b32 s37, v45
  s_nop 0
  s_add_u32 s37, s37, 30
  s_cmp_ge_u32 s38, 30
  s_cselect_b32 s38, s37, s38
  s_cmp_ge_u32 s38, 64
  s_cselect_b32 s38, 100, s38
  s_sub_u32 s38, s38, 1
  s_max_i32 s30, s30, s38
  s_waitcnt vmcnt(4)
  s_barrier
  ds_read_b128 v[28:31], v2 offset:19456
  ds_read_b128 v[32:35], v2 offset:23552
  ds_read_b128 v[36:39], v2 offset:8192
  ds_read_b128 v[40:43], v2 offset:9216
  ds_read_b128 v[44:47], v2 offset:10240
  ds_read_b128 v[48:51], v2 offset:11264
  buffer_load_dwordx4 v[124:127], v3, s[4:7], s24 offen offset:3072 sc1
  buffer_load_dwordx4 v[116:119], v3, s[4:7], s25 offen offset:3072 sc1
  ds_read_b128 v[52:55], v2 offset:12288
  ds_read_b128 v[56:59], v2 offset:13312
  ds_read_b128 v[60:63], v2 offset:14336
  ds_read_b128 v[64:67], v2 offset:15360
  buffer_load_dwordx4 v[124:127], v3, s[4:7], s24 offen offset:3072 sc1
  buffer_load_dwordx4 v[116:119], v3, s[4:7], s25 offen offset:3072 sc1
  s_mov_b32 s19, 0
  s_branch T_loop_195
T_kvw_199:
  s_mov_b32 s19, 0
  s_branch T_kvok_208
T_kv_207:
  s_sleep 4
  s_add_u32 s19, s19, 1
  s_cmp_gt_u32 s19, 32768
  s_cbranch_scc1 M_exit
T_kvok_208:
  s_add_u32 s39, s99, 128
  s_mov_b32 s38, 0
  s_mov_b32 s37, 0
  s_atomic_or s38, s[58:59], s99 glc
  s_atomic_or s37, s[58:59], s39 glc
  s_waitcnt lgkmcnt(0)
  s_add_u32 s37, s37, 30
  s_cmp_ge_u32 s38, 30
  s_cselect_b32 s38, s37, s38
  s_cmp_ge_u32 s38, 64
  s_cselect_b32 s38, 100, s38
  s_sub_u32 s38, s38, 1
  s_max_i32 s30, s30, s38
  s_cmp_ge_i32 s14, s30
  s_cbranch_scc1 T_kv_207
  s_branch T_kvb_200
T_slow_202:
  s_nop 7
  v_max3_f32 v100, v16, v17, v18
  v_max3_f32 v100, v100, v19, v20
  v_max3_f32 v100, v100, v21, v22
  v_max3_f32 v100, v100, v23, v112
  v_max3_f32 v100, v100, v113, v114
  v_max_f32 v100, v100, v115
  v_mov_b32 v101, v100
  s_nop 1
  v_permlane32_swap_b32 v100, v101
  s_nop 1
  v_max_f32 v100, v100, v101
  v_mov_b32 v101, v100
  s_nop 1
  v_permlane16_swap_b32 v100, v101
  s_nop 1
  v_max_f32 v100, v100, v101
  v_sub_f32 v16, v16, v100
  v_sub_f32 v17, v17, v100
  v_sub_f32 v18, v18, v100
  v_sub_f32 v19, v19, v100
  v_exp_f32 v16, v16
  v_exp_f32 v17, v17
  v_exp_f32 v18, v18
  v_exp_f32 v19, v19
  v_sub_f32 v20, v20, v100
  v_sub_f32 v21, v21, v100
  v_sub_f32 v22, v22, v100
  v_sub_f32 v23, v23, v100
  v_exp_f32 v20, v20
  v_exp_f32 v21, v21
  v_exp_f32 v22, v22
  v_exp_f32 v23, v23
  v_sub_f32 v112, v112, v100
  v_sub_f32 v113, v113, v100
  v_sub_f32 v114, v114, v100
  v_sub_f32 v115, v115, v100
  v_exp_f32 v112, v112
  v_exp_f32 v113, v113
  v_exp_f32 v114, v114
  v_exp_f32 v115, v115
  s_nop 0
  v_cvt_pk_bf16_f32 v44, v16, v17
  v_cvt_pk_bf16_f32 v45, v18, v19
  v_cvt_pk_bf16_f32 v46, v20, v21
  v_cvt_pk_bf16_f32 v47, v22, v23
  v_cvt_pk_bf16_f32 v84, v112, v113
  v_cvt_pk_bf16_f32 v85, v114, v115
  v_cndmask_b32 v48, v84, 0, s[16:17]
  v_cndmask_b32 v49, v85, 0, s[16:17]
  v_cndmask_b32 v50, 0, v84, s[16:17]
  v_cndmask_b32 v51, 0, v85, s[16:17]
  s_nop 1
  v_mfma_f32_16x16x16_bf16 v[88:91], v[12:13], v[48:49], 0
  v_mfma_f32_16x16x16_bf16 v[24:27], v[120:121], v[48:49], 0
  v_mfma_f32_16x16x16_bf16 v[116:119], v[120:121], v[50:51], 0
  v_mfma_f32_16x16x32_bf16 v[88:91], v[12:15], v[44:47], v[88:91]
  v_mfma_f32_16x16x32_bf16 v[24:27], v[28:31], v[44:47], v[24:27]
  v_mfma_f32_16x16x32_bf16 v[116:119], v[32:35], v[44:47], v[116:119]
  s_nop 7
  s_nop 1
  v_rcp_f32 v89, v88
  s_nop 0
  v_mul_f32 v24, v89, v24
  v_mul_f32 v25, v89, v25
  s_branch T_back_203
M_tdone:
  v_mov_b32 v16, 64
  v_or_b32 v17, s13, v2
  v_min_u32 v17, 1, v17
  v_lshlrev_b32 v17, 30, v17
  s_waitcnt vmcnt(0)
  s_barrier
  buffer_store_dword v16, v17, s[4:7], s15 offen sc1
M_done:
M_exit:
  s_endpgm
.p2align 6
.type M_table,@object
M_table:
.long 0x1, 0x3f, 0xffffffff, 0x17, 0x1, 0x7, 0x800, 0x0, 0x8, 0x0, 0x0, 0x0, 0x0, 0x0, 0x0, 0x0
.long 0x1, 0x28, 0xffffffff, 0x1b, 0x1, 0x6, 0x1000, 0x0, 0x8, 0x1, 0x0, 0x0, 0x0, 0x0, 0x0, 0x0
.long 0x2, 0x0, 0x1, 0x1e, 0x1, 0x5, 0x1800, 0x0, 0x8, 0x0, 0x0, 0x0, 0x0, 0x0, 0x0, 0x0
.long 0x2, 0x1e, 0x1, 0x22, 0x1, 0x4, 0x2000, 0x0, 0x8, 0x1, 0x0, 0x0, 0x0, 0x0, 0x0, 0x0
.long 0x0, 0x0, 0x1, 0x20, 0x2, 0x3, 0x20, 0x0, 0x8, 0x2, 0x0, 0x0, 0x0, 0x0, 0x0, 0x0
.long 0x0, 0x3f, 0xffffffff, 0x20, 0x2, 0x2, 0x18, 0x1, 0x10, 0x0, 0x0, 0x0, 0x0, 0x0, 0x0, 0x0
.long 0x1, 0xd, 0xffffffff, 0xe, 0x0, 0x0, 0x8, 0x0, 0x8, 0x2, 0x0, 0x0, 0x0, 0x0, 0x0, 0x0
.size M_table, 448
.section .rodata,"a"
.p2align 6
.amdhsa_kernel gated_mix__compressed_kv_cla__memory_aug_recurrent_mem_tr__prompt_kernel
.amdhsa_next_free_vgpr 512
.amdhsa_next_free_sgpr 102
.amdhsa_accum_offset 256
.amdhsa_group_segment_fixed_size 0
.amdhsa_kernarg_size 136
.amdhsa_user_sgpr_count 2
.amdhsa_user_sgpr_kernarg_segment_ptr 1
.amdhsa_system_sgpr_workgroup_id_x 1
.end_amdhsa_kernel
```

```asm
; @launch grid=(256,1,1) block=(256,1,1) lds=163840
.amdgcn_target "amdgcn-amd-amdhsa--gfx950"
.text
.globl gated_mix__compressed_kv_cla__memory_aug_recurrent_mem_tr__prompt_kernel
.p2align 8
.type gated_mix__compressed_kv_cla__memory_aug_recurrent_mem_tr__prompt_kernel,@function
gated_mix__compressed_kv_cla__memory_aug_recurrent_mem_tr__prompt_kernel:
  s_cmp_ge_u32 s2, 256
  s_cbranch_scc1 M_exit
  s_lshr_b32 s77, s2, 3
  s_and_b32 s76, s2, 7
  s_cbranch_scc0 M_team
  s_load_dwordx4 s[72:75], s[0:1], 120
  v_lshrrev_b32 v3, 6, v0
  v_and_b32 v1, 63, v0
  v_readfirstlane_b32 s16, v3
  v_lshlrev_b32 v2, 4, v1
  s_waitcnt lgkmcnt(0)
  s_mov_b64 s[4:5], s[74:75]
  s_mov_b64 s[74:75], s[72:73]
  s_mov_b64 s[72:73], s[4:5]
  s_and_b32 s5, s5, 0xffff
  s_mov_b32 s6, 268435456
  s_mov_b32 s7, 0x20000
  s_sub_u32 s66, s76, 1
  s_lshl_b32 s66, s66, 5
  s_add_u32 s66, s66, s77
  s_mul_i32 s64, s66, 9363
  s_lshr_b32 s64, s64, 16
  s_mul_i32 s67, s64, 7
  s_sub_u32 s65, s66, s67
  s_lshl_b32 s31, s66, 7
  s_add_u32 s31, s31, 148897792
  s_lshl_b32 s67, s67, 7
  s_add_u32 s67, s67, 148897792
  s_getpc_b64 s[76:77]
M_pc:
  s_add_u32 s76, s76, M_table-M_pc
  s_addc_u32 s77, s77, 0
  s_lshl_b32 s26, s65, 6
  s_load_dwordx16 s[48:63], s[76:77], s26
  s_waitcnt lgkmcnt(0)
  s_mov_b32 s23, s51
  s_cmp_lg_u32 s48, 1
  s_cbranch_scc1 M_nobpf
  s_load_dwordx8 s[36:43], s[0:1], 64
  s_mul_i32 s76, s64, 3
  s_add_u32 s76, s76, s57
  v_lshlrev_b32 v4, 7, v0
  s_mov_b32 s10, 4194304
  s_mov_b32 s11, 0x20000
  s_waitcnt lgkmcnt(0)
  s_mov_b32 s8, s42
  s_and_b32 s9, s43, 0xffff
  s_mul_i32 s77, s76, 43776
  s_add_u32 s77, s77, 0
  v_min_u32 v5, 32640, v4
  v_add_u32 v5, s77, v5
  s_add_u32 s77, s77, 32768
  buffer_load_dword v6, v5, s[8:11], 0 offen
  v_min_u32 v5, 10880, v4
  v_add_u32 v5, s77, v5
  s_add_u32 s77, s77, 32768
  buffer_load_dword v6, v5, s[8:11], 0 offen
  s_mov_b32 s8, s38
  s_and_b32 s9, s39, 0xffff
  s_mul_i32 s77, s76, 21888
  s_add_u32 s77, s77, 2097152
  v_min_u32 v5, 21760, v4
  v_add_u32 v5, s77, v5
  s_add_u32 s77, s77, 32768
  buffer_load_dword v6, v5, s[8:11], 0 offen
  s_mov_b32 s8, s40
  s_and_b32 s9, s41, 0xffff
  s_mul_i32 s77, s76, 21888
  s_add_u32 s77, s77, 2097152
  v_min_u32 v5, 21760, v4
  v_add_u32 v5, s77, v5
  s_add_u32 s77, s77, 32768
  buffer_load_dword v6, v5, s[8:11], 0 offen
  s_mov_b32 s8, s36
  s_and_b32 s9, s37, 0xffff
  s_mul_i32 s77, s76, 21888
  s_add_u32 s77, s77, 2097152
  v_min_u32 v5, 21760, v4
  v_add_u32 v5, s77, v5
  s_add_u32 s77, s77, 32768
  buffer_load_dword v6, v5, s[8:11], 0 offen
  s_waitcnt vmcnt(0)
M_nobpf:
  s_lshr_b32 s29, s16, 1
  s_cmp_eq_u32 s29, 0
  s_cselect_b32 s26, 2, 8
  s_cselect_b32 s27, 3, 4
  s_cselect_b32 s28, 9, 10
  s_cmp_eq_u32 s48, 1
  s_cselect_b32 s26, s27, s26
  s_cmp_eq_u32 s48, 2
  s_cselect_b32 s26, s28, s26
  s_lshl_b32 s26, s26, 3
  s_load_dwordx2 s[8:9], s[0:1], s26
  s_cmp_eq_u32 s48, 1
  s_cselect_b32 s26, 8, 0
  s_load_dwordx2 s[12:13], s[0:1], s26
  s_cmp_eq_u32 s29, 0
  s_cselect_b32 s21, 0, 3
  s_cselect_b32 s27, 1, 2
  s_cselect_b32 s28, 4, 5
  s_cmp_eq_u32 s48, 1
  s_cselect_b32 s21, s27, s21
  s_cmp_eq_u32 s48, 2
  s_cselect_b32 s21, s28, s21
  s_lshl_b32 s21, s21, 5
  s_add_u32 s21, s21, s64
  s_lshl_b32 s21, s21, 6
  s_add_u32 s21, s21, s49
  s_and_b32 s27, s16, 1
  s_lshl_b32 s21, s21, 1
  s_add_u32 s21, s21, s27
  s_lshl_b32 s21, s21, 12
  s_lshl_b32 s22, s50, 13
  s_lshl_b32 s19, s49, 15
  s_lshl_b32 s20, s50, 15
  s_lshl_b32 s17, s64, 1
  s_add_u32 s17, s17, s27
  s_lshl_b32 s17, s17, 7
  s_mov_b32 s18, 8192
  s_mov_b32 s24, 0x3e0293ee
  s_waitcnt lgkmcnt(0)
  s_and_b32 s9, s9, 0xffff
  s_mov_b32 s10, 4194304
  s_mov_b32 s11, 0x20000
  s_and_b32 s13, s13, 0xffff
  s_mov_b32 s14, 2097152
  s_mov_b32 s15, 0x20000
  s_cmp_eq_u32 s48, 0
  s_cselect_b32 s32, 0, s16
  s_lshr_b32 s32, s32, 1
  v_lshrrev_b32 v144, 4, v1
  v_and_b32 v56, 0xff, v2
  v_lshl_add_u32 v56, v144, 9, v56
  v_and_b32 v146, 15, v1
  v_and_b32 v144, 8, v1
  v_add_u32 v144, v144, v146
  s_cmp_lg_u32 s32, 0
  s_cselect_b64 vcc, -1, 0
  s_cselect_b32 s26, 8, 16
  v_cndmask_b32 v144, v146, v144, vcc
  v_lshrrev_b32 v145, 4, v1
  v_add_u32 v148, s26, v144
  v_xor_b32 v147, 0, v145
  v_xor_b32 v147, v147, v146
  v_lshlrev_b32 v147, 4, v147
  v_lshl_add_u32 v8, v144, 8, v147
  v_xor_b32 v147, 8, v145
  v_xor_b32 v147, v147, v146
  v_lshlrev_b32 v147, 4, v147
  v_lshl_add_u32 v9, v148, 8, v147
  v_xor_b32 v147, 4, v145
  v_xor_b32 v147, v147, v146
  v_lshlrev_b32 v147, 4, v147
  v_lshl_add_u32 v10, v144, 8, v147
  v_xor_b32 v147, 12, v145
  v_xor_b32 v147, v147, v146
  v_lshlrev_b32 v147, 4, v147
  v_lshl_add_u32 v11, v148, 8, v147
  v_xor_b32 v147, 8, v145
  v_xor_b32 v147, v147, v146
  v_lshlrev_b32 v147, 4, v147
  v_lshl_add_u32 v12, v144, 8, v147
  v_xor_b32 v147, 0, v145
  v_xor_b32 v147, v147, v146
  v_lshlrev_b32 v147, 4, v147
  v_lshl_add_u32 v13, v148, 8, v147
  v_xor_b32 v147, 12, v145
  v_xor_b32 v147, v147, v146
  v_lshlrev_b32 v147, 4, v147
  v_lshl_add_u32 v14, v144, 8, v147
  v_xor_b32 v147, 4, v145
  v_xor_b32 v147, v147, v146
  v_lshlrev_b32 v147, 4, v147
  v_lshl_add_u32 v15, v148, 8, v147
  v_lshrrev_b32 v144, 4, v1
  s_lshl_b32 s26, s16, 8
  v_add_u32 v145, 0, v144
  v_or_b32 v147, 0, v144
  v_xor_b32 v147, v147, v146
  v_lshlrev_b32 v147, 4, v147
  v_lshl_add_u32 v147, v145, 10, v147
  v_add_u32 v16, s26, v147
  v_add_u32 v145, 4, v144
  v_or_b32 v147, 4, v144
  v_xor_b32 v147, v147, v146
  v_lshlrev_b32 v147, 4, v147
  v_lshl_add_u32 v147, v145, 10, v147
  v_add_u32 v17, s26, v147
  v_add_u32 v145, 8, v144
  v_or_b32 v147, 8, v144
  v_xor_b32 v147, v147, v146
  v_lshlrev_b32 v147, 4, v147
  v_lshl_add_u32 v147, v145, 10, v147
  v_add_u32 v18, s26, v147
  v_add_u32 v145, 12, v144
  v_or_b32 v147, 12, v144
  v_xor_b32 v147, v147, v146
  v_lshlrev_b32 v147, 4, v147
  v_lshl_add_u32 v147, v145, 10, v147
  v_add_u32 v19, s26, v147
  v_add_u32 v145, 16, v144
  v_or_b32 v147, 8, v144
  v_xor_b32 v147, v147, v146
  v_lshlrev_b32 v147, 4, v147
  v_lshl_add_u32 v147, v145, 10, v147
  v_add_u32 v20, s26, v147
  v_add_u32 v145, 20, v144
  v_or_b32 v147, 12, v144
  v_xor_b32 v147, v147, v146
  v_lshlrev_b32 v147, 4, v147
  v_lshl_add_u32 v147, v145, 10, v147
  v_add_u32 v21, s26, v147
  v_add_u32 v145, 24, v144
  v_or_b32 v147, 0, v144
  v_xor_b32 v147, v147, v146
  v_lshlrev_b32 v147, 4, v147
  v_lshl_add_u32 v147, v145, 10, v147
  v_add_u32 v22, s26, v147
  v_add_u32 v145, 28, v144
  v_or_b32 v147, 4, v144
  v_xor_b32 v147, v147, v146
  v_lshlrev_b32 v147, 4, v147
  v_lshl_add_u32 v147, v145, 10, v147
  v_add_u32 v23, s26, v147
  v_lshrrev_b32 v144, 3, v1
  v_mul_lo_u32 v144, v144, s18
  v_and_b32 v145, 7, v1
  v_lshl_add_u32 v144, v145, 4, v144
  s_lshl_b32 s28, s16, 15
  s_add_u32 s28, s28, 32768
  s_lshl_b32 s29, s18, 3
  s_add_u32 m0, s28, 0
  s_nop 0
  buffer_load_dwordx4 v144, s[8:11], s17 offen lds
  s_add_u32 s17, s17, s29
  s_add_u32 m0, s28, 1024
  s_nop 0
  buffer_load_dwordx4 v144, s[8:11], s17 offen lds
  s_add_u32 s17, s17, s29
  s_add_u32 m0, s28, 2048
  s_nop 0
  buffer_load_dwordx4 v144, s[8:11], s17 offen lds
  s_add_u32 s17, s17, s29
  s_add_u32 m0, s28, 3072
  s_nop 0
  buffer_load_dwordx4 v144, s[8:11], s17 offen lds
  s_add_u32 s17, s17, s29
  s_add_u32 m0, s28, 4096
  s_nop 0
  buffer_load_dwordx4 v144, s[8:11], s17 offen lds
  s_add_u32 s17, s17, s29
  s_add_u32 m0, s28, 5120
  s_nop 0
  buffer_load_dwordx4 v144, s[8:11], s17 offen lds
  s_add_u32 s17, s17, s29
  s_add_u32 m0, s28, 6144
  s_nop 0
  buffer_load_dwordx4 v144, s[8:11], s17 offen lds
  s_add_u32 s17, s17, s29
  s_add_u32 m0, s28, 7168
  s_nop 0
  buffer_load_dwordx4 v144, s[8:11], s17 offen lds
  s_add_u32 s17, s17, s29
  s_add_u32 m0, s28, 8192
  s_nop 0
  buffer_load_dwordx4 v144, s[8:11], s17 offen lds
  s_add_u32 s17, s17, s29
  s_add_u32 m0, s28, 9216
  s_nop 0
  buffer_load_dwordx4 v144, s[8:11], s17 offen lds
  s_add_u32 s17, s17, s29
  s_add_u32 m0, s28, 10240
  s_nop 0
  buffer_load_dwordx4 v144, s[8:11], s17 offen lds
  s_add_u32 s17, s17, s29
  s_add_u32 m0, s28, 11264
  s_nop 0
  buffer_load_dwordx4 v144, s[8:11], s17 offen lds
  s_add_u32 s17, s17, s29
  s_add_u32 m0, s28, 12288
  s_nop 0
  buffer_load_dwordx4 v144, s[8:11], s17 offen lds
  s_add_u32 s17, s17, s29
  s_add_u32 m0, s28, 13312
  s_nop 0
  buffer_load_dwordx4 v144, s[8:11], s17 offen lds
  s_add_u32 s17, s17, s29
  s_add_u32 m0, s28, 14336
  s_nop 0
  buffer_load_dwordx4 v144, s[8:11], s17 offen lds
  s_add_u32 s17, s17, s29
  s_add_u32 m0, s28, 15360
  s_nop 0
  buffer_load_dwordx4 v144, s[8:11], s17 offen lds
  s_add_u32 s17, s17, s29
  s_add_u32 m0, s28, 16384
  s_nop 0
  buffer_load_dwordx4 v144, s[8:11], s17 offen lds
  s_add_u32 s17, s17, s29
  s_add_u32 m0, s28, 17408
  s_nop 0
  buffer_load_dwordx4 v144, s[8:11], s17 offen lds
  s_add_u32 s17, s17, s29
  s_add_u32 m0, s28, 18432
  s_nop 0
  buffer_load_dwordx4 v144, s[8:11], s17 offen lds
  s_add_u32 s17, s17, s29
  s_add_u32 m0, s28, 19456
  s_nop 0
  buffer_load_dwordx4 v144, s[8:11], s17 offen lds
  s_add_u32 s17, s17, s29
  s_add_u32 m0, s28, 20480
  s_nop 0
  buffer_load_dwordx4 v144, s[8:11], s17 offen lds
  s_add_u32 s17, s17, s29
  s_add_u32 m0, s28, 21504
  s_nop 0
  buffer_load_dwordx4 v144, s[8:11], s17 offen lds
  s_add_u32 s17, s17, s29
  s_add_u32 m0, s28, 22528
  s_nop 0
  buffer_load_dwordx4 v144, s[8:11], s17 offen lds
  s_add_u32 s17, s17, s29
  s_add_u32 m0, s28, 23552
  s_nop 0
  buffer_load_dwordx4 v144, s[8:11], s17 offen lds
  s_add_u32 s17, s17, s29
  s_add_u32 m0, s28, 24576
  s_nop 0
  buffer_load_dwordx4 v144, s[8:11], s17 offen lds
  s_add_u32 s17, s17, s29
  s_add_u32 m0, s28, 25600
  s_nop 0
  buffer_load_dwordx4 v144, s[8:11], s17 offen lds
  s_add_u32 s17, s17, s29
  s_add_u32 m0, s28, 26624
  s_nop 0
  buffer_load_dwordx4 v144, s[8:11], s17 offen lds
  s_add_u32 s17, s17, s29
  s_add_u32 m0, s28, 27648
  s_nop 0
  buffer_load_dwordx4 v144, s[8:11], s17 offen lds
  s_add_u32 s17, s17, s29
  s_add_u32 m0, s28, 28672
  s_nop 0
  buffer_load_dwordx4 v144, s[8:11], s17 offen lds
  s_add_u32 s17, s17, s29
  s_add_u32 m0, s28, 29696
  s_nop 0
  buffer_load_dwordx4 v144, s[8:11], s17 offen lds
  s_add_u32 s17, s17, s29
  s_add_u32 m0, s28, 30720
  s_nop 0
  buffer_load_dwordx4 v144, s[8:11], s17 offen lds
  s_add_u32 s17, s17, s29
  s_add_u32 m0, s28, 31744
  s_nop 0
  buffer_load_dwordx4 v144, s[8:11], s17 offen lds
  s_add_u32 s17, s17, s29
  s_lshl_b32 s25, s16, 13
  s_add_u32 m0, s25, 0
  s_nop 0
  buffer_load_dwordx4 v16, s[12:15], s19 offen lds
  s_add_u32 m0, s25, 1024
  s_nop 0
  buffer_load_dwordx4 v17, s[12:15], s19 offen lds
  s_add_u32 m0, s25, 2048
  s_nop 0
  buffer_load_dwordx4 v18, s[12:15], s19 offen lds
  s_add_u32 m0, s25, 3072
  s_nop 0
  buffer_load_dwordx4 v19, s[12:15], s19 offen lds
  s_add_u32 m0, s25, 4096
  s_nop 0
  buffer_load_dwordx4 v20, s[12:15], s19 offen lds
  s_add_u32 m0, s25, 5120
  s_nop 0
  buffer_load_dwordx4 v21, s[12:15], s19 offen lds
  s_add_u32 m0, s25, 6144
  s_nop 0
  buffer_load_dwordx4 v22, s[12:15], s19 offen lds
  s_add_u32 m0, s25, 7168
  s_nop 0
  buffer_load_dwordx4 v23, s[12:15], s19 offen lds
  s_cmp_gt_u32 s23, 1
  s_cselect_b32 s26, s20, 0
  s_add_u32 s19, s19, s26
  s_add_u32 s25, s25, 32768
  s_and_b32 s25, s25, 0x1ffff
  s_cmp_lg_u32 s16, 3
  s_cbranch_scc1 M_noinit
  s_mov_b32 s79, 0
  s_atomic_swap s79, s[72:73], s31 glc
  s_waitcnt lgkmcnt(0)
  s_mov_b32 s79, 1
  s_atomic_add s79, s[74:75], 128
M_noinit:
  s_cmp_lg_u32 s65, 3
  s_cbranch_scc1 M_noarm
  v_lshlrev_b32 v4, 4, v0
  v_mov_b64 v[60:61], -1
  v_mov_b64 v[62:63], -1
  s_mul_i32 s76, s64, 4096
  s_add_u32 s77, s76, 142868480
  buffer_store_dwordx4 v[60:63], v4, s[4:7], s77 offen sc1
  s_add_u32 s77, s76, 142999552
  buffer_store_dwordx4 v[60:63], v4, s[4:7], s77 offen sc1
  s_add_u32 s77, s76, 143130624
  buffer_store_dwordx4 v[60:63], v4, s[4:7], s77 offen sc1
  s_add_u32 s77, s76, 143261696
  buffer_store_dwordx4 v[60:63], v4, s[4:7], s77 offen sc1
  s_add_u32 s77, s76, 143392768
  buffer_store_dwordx4 v[60:63], v4, s[4:7], s77 offen sc1
  s_add_u32 s77, s76, 143523840
  buffer_store_dwordx4 v[60:63], v4, s[4:7], s77 offen sc1
M_noarm:
  s_mul_i32 s76, s64, 3
  s_add_u32 s76, s76, s57
  s_mul_i32 s76, s76, 24576
  v_lshlrev_b32 v4, 7, v0
  v_add_u32 v4, s76, v4
  buffer_load_dword v5, v4, s[12:15], 0 offen
  v_bfe_u32 v148, v1, 2, 2
  v_lshrrev_b32 v149, 5, v1
  v_lshl_add_u32 v148, v149, 4, v148
  v_bfe_u32 v149, v1, 4, 1
  v_lshl_add_u32 v148, v149, 3, v148
  v_and_b32 v149, 3, v1
  v_and_b32 v150, 2, v149
  v_add_u32 v150, v150, v149
  s_cmp_lg_u32 s32, 0
  s_cselect_b64 vcc, -1, 0
  s_cselect_b32 s26, 32, 16
  v_cndmask_b32 v149, v150, v149, vcc
  v_lshlrev_b32 v149, 3, v149
  v_lshl_add_u32 v148, v148, 7, v149
  v_add_u32 v152, s28, v148
  v_add_u32 v153, 512, v152
  v_add_u32 v154, s26, v152
  v_add_u32 v155, s26, v153
  s_waitcnt vmcnt(37)
  ds_read_b64_tr_b16 a[0:1], v152 offset:0
  ds_read_b64_tr_b16 a[2:3], v153 offset:0
  ds_read_b64_tr_b16 a[4:5], v154 offset:0
  ds_read_b64_tr_b16 a[6:7], v155 offset:0
  ds_read_b64_tr_b16 a[8:9], v152 offset:64
  ds_read_b64_tr_b16 a[10:11], v153 offset:64
  ds_read_b64_tr_b16 a[12:13], v154 offset:64
  ds_read_b64_tr_b16 a[14:15], v155 offset:64
  s_waitcnt lgkmcnt(0)
  s_add_u32 m0, s28, 0
  s_nop 0
  buffer_load_dwordx4 v144, s[8:11], s17 offen lds
  s_add_u32 s17, s17, s29
  s_add_u32 m0, s28, 1024
  s_nop 0
  buffer_load_dwordx4 v144, s[8:11], s17 offen lds
  s_add_u32 s17, s17, s29
  s_add_u32 m0, s28, 2048
  s_nop 0
  buffer_load_dwordx4 v144, s[8:11], s17 offen lds
  s_add_u32 s17, s17, s29
  s_add_u32 m0, s28, 3072
  s_nop 0
  buffer_load_dwordx4 v144, s[8:11], s17 offen lds
  s_add_u32 s17, s17, s29
  s_waitcnt vmcnt(37)
  ds_read_b64_tr_b16 a[16:17], v152 offset:4096
  ds_read_b64_tr_b16 a[18:19], v153 offset:4096
  ds_read_b64_tr_b16 a[20:21], v154 offset:4096
  ds_read_b64_tr_b16 a[22:23], v155 offset:4096
  ds_read_b64_tr_b16 a[24:25], v152 offset:4160
  ds_read_b64_tr_b16 a[26:27], v153 offset:4160
  ds_read_b64_tr_b16 a[28:29], v154 offset:4160
  ds_read_b64_tr_b16 a[30:31], v155 offset:4160
  s_waitcnt lgkmcnt(0)
  s_add_u32 m0, s28, 4096
  s_nop 0
  buffer_load_dwordx4 v144, s[8:11], s17 offen lds
  s_add_u32 s17, s17, s29
  s_add_u32 m0, s28, 5120
  s_nop 0
  buffer_load_dwordx4 v144, s[8:11], s17 offen lds
  s_add_u32 s17, s17, s29
  s_add_u32 m0, s28, 6144
  s_nop 0
  buffer_load_dwordx4 v144, s[8:11], s17 offen lds
  s_add_u32 s17, s17, s29
  s_add_u32 m0, s28, 7168
  s_nop 0
  buffer_load_dwordx4 v144, s[8:11], s17 offen lds
  s_add_u32 s17, s17, s29
  s_waitcnt vmcnt(37)
  ds_read_b64_tr_b16 a[32:33], v152 offset:8192
  ds_read_b64_tr_b16 a[34:35], v153 offset:8192
  ds_read_b64_tr_b16 a[36:37], v154 offset:8192
  ds_read_b64_tr_b16 a[38:39], v155 offset:8192
  ds_read_b64_tr_b16 a[40:41], v152 offset:8256
  ds_read_b64_tr_b16 a[42:43], v153 offset:8256
  ds_read_b64_tr_b16 a[44:45], v154 offset:8256
  ds_read_b64_tr_b16 a[46:47], v155 offset:8256
  s_waitcnt lgkmcnt(0)
  s_add_u32 m0, s28, 8192
  s_nop 0
  buffer_load_dwordx4 v144, s[8:11], s17 offen lds
  s_add_u32 s17, s17, s29
  s_add_u32 m0, s28, 9216
  s_nop 0
  buffer_load_dwordx4 v144, s[8:11], s17 offen lds
  s_add_u32 s17, s17, s29
  s_add_u32 m0, s28, 10240
  s_nop 0
  buffer_load_dwordx4 v144, s[8:11], s17 offen lds
  s_add_u32 s17, s17, s29
  s_add_u32 m0, s28, 11264
  s_nop 0
  buffer_load_dwordx4 v144, s[8:11], s17 offen lds
  s_add_u32 s17, s17, s29
  s_waitcnt vmcnt(37)
  ds_read_b64_tr_b16 a[48:49], v152 offset:12288
  ds_read_b64_tr_b16 a[50:51], v153 offset:12288
  ds_read_b64_tr_b16 a[52:53], v154 offset:12288
  ds_read_b64_tr_b16 a[54:55], v155 offset:12288
  ds_read_b64_tr_b16 a[56:57], v152 offset:12352
  ds_read_b64_tr_b16 a[58:59], v153 offset:12352
  ds_read_b64_tr_b16 a[60:61], v154 offset:12352
  ds_read_b64_tr_b16 a[62:63], v155 offset:12352
  s_waitcnt lgkmcnt(0)
  s_add_u32 m0, s28, 12288
  s_nop 0
  buffer_load_dwordx4 v144, s[8:11], s17 offen lds
  s_add_u32 s17, s17, s29
  s_add_u32 m0, s28, 13312
  s_nop 0
  buffer_load_dwordx4 v144, s[8:11], s17 offen lds
  s_add_u32 s17, s17, s29
  s_add_u32 m0, s28, 14336
  s_nop 0
  buffer_load_dwordx4 v144, s[8:11], s17 offen lds
  s_add_u32 s17, s17, s29
  s_add_u32 m0, s28, 15360
  s_nop 0
  buffer_load_dwordx4 v144, s[8:11], s17 offen lds
  s_add_u32 s17, s17, s29
  s_waitcnt vmcnt(37)
  ds_read_b64_tr_b16 a[64:65], v152 offset:16384
  ds_read_b64_tr_b16 a[66:67], v153 offset:16384
  ds_read_b64_tr_b16 a[68:69], v154 offset:16384
  ds_read_b64_tr_b16 a[70:71], v155 offset:16384
  ds_read_b64_tr_b16 a[72:73], v152 offset:16448
  ds_read_b64_tr_b16 a[74:75], v153 offset:16448
  ds_read_b64_tr_b16 a[76:77], v154 offset:16448
  ds_read_b64_tr_b16 a[78:79], v155 offset:16448
  s_waitcnt lgkmcnt(0)
  s_add_u32 m0, s28, 16384
  s_nop 0
  buffer_load_dwordx4 v144, s[8:11], s17 offen lds
  s_add_u32 s17, s17, s29
  s_add_u32 m0, s28, 17408
  s_nop 0
  buffer_load_dwordx4 v144, s[8:11], s17 offen lds
  s_add_u32 s17, s17, s29
  s_add_u32 m0, s28, 18432
  s_nop 0
  buffer_load_dwordx4 v144, s[8:11], s17 offen lds
  s_add_u32 s17, s17, s29
  s_add_u32 m0, s28, 19456
  s_nop 0
  buffer_load_dwordx4 v144, s[8:11], s17 offen lds
  s_add_u32 s17, s17, s29
  s_waitcnt vmcnt(37)
  ds_read_b64_tr_b16 a[80:81], v152 offset:20480
  ds_read_b64_tr_b16 a[82:83], v153 offset:20480
  ds_read_b64_tr_b16 a[84:85], v154 offset:20480
  ds_read_b64_tr_b16 a[86:87], v155 offset:20480
  ds_read_b64_tr_b16 a[88:89], v152 offset:20544
  ds_read_b64_tr_b16 a[90:91], v153 offset:20544
  ds_read_b64_tr_b16 a[92:93], v154 offset:20544
  ds_read_b64_tr_b16 a[94:95], v155 offset:20544
  s_waitcnt lgkmcnt(0)
  s_add_u32 m0, s28, 20480
  s_nop 0
  buffer_load_dwordx4 v144, s[8:11], s17 offen lds
  s_add_u32 s17, s17, s29
  s_add_u32 m0, s28, 21504
  s_nop 0
  buffer_load_dwordx4 v144, s[8:11], s17 offen lds
  s_add_u32 s17, s17, s29
  s_add_u32 m0, s28, 22528
  s_nop 0
  buffer_load_dwordx4 v144, s[8:11], s17 offen lds
  s_add_u32 s17, s17, s29
  s_add_u32 m0, s28, 23552
  s_nop 0
  buffer_load_dwordx4 v144, s[8:11], s17 offen lds
  s_add_u32 s17, s17, s29
  s_waitcnt vmcnt(37)
  ds_read_b64_tr_b16 a[96:97], v152 offset:24576
  ds_read_b64_tr_b16 a[98:99], v153 offset:24576
  ds_read_b64_tr_b16 a[100:101], v154 offset:24576
  ds_read_b64_tr_b16 a[102:103], v155 offset:24576
  ds_read_b64_tr_b16 a[104:105], v152 offset:24640
  ds_read_b64_tr_b16 a[106:107], v153 offset:24640
  ds_read_b64_tr_b16 a[108:109], v154 offset:24640
  ds_read_b64_tr_b16 a[110:111], v155 offset:24640
  s_waitcnt lgkmcnt(0)
  s_add_u32 m0, s28, 24576
  s_nop 0
  buffer_load_dwordx4 v144, s[8:11], s17 offen lds
  s_add_u32 s17, s17, s29
  s_add_u32 m0, s28, 25600
  s_nop 0
  buffer_load_dwordx4 v144, s[8:11], s17 offen lds
  s_add_u32 s17, s17, s29
  s_add_u32 m0, s28, 26624
  s_nop 0
  buffer_load_dwordx4 v144, s[8:11], s17 offen lds
  s_add_u32 s17, s17, s29
  s_add_u32 m0, s28, 27648
  s_nop 0
  buffer_load_dwordx4 v144, s[8:11], s17 offen lds
  s_add_u32 s17, s17, s29
  s_waitcnt vmcnt(37)
  ds_read_b64_tr_b16 a[112:113], v152 offset:28672
  ds_read_b64_tr_b16 a[114:115], v153 offset:28672
  ds_read_b64_tr_b16 a[116:117], v154 offset:28672
  ds_read_b64_tr_b16 a[118:119], v155 offset:28672
  ds_read_b64_tr_b16 a[120:121], v152 offset:28736
  ds_read_b64_tr_b16 a[122:123], v153 offset:28736
  ds_read_b64_tr_b16 a[124:125], v154 offset:28736
  ds_read_b64_tr_b16 a[126:127], v155 offset:28736
  s_waitcnt lgkmcnt(0)
  s_add_u32 m0, s28, 28672
  s_nop 0
  buffer_load_dwordx4 v144, s[8:11], s17 offen lds
  s_add_u32 s17, s17, s29
  s_add_u32 m0, s28, 29696
  s_nop 0
  buffer_load_dwordx4 v144, s[8:11], s17 offen lds
  s_add_u32 s17, s17, s29
  s_add_u32 m0, s28, 30720
  s_nop 0
  buffer_load_dwordx4 v144, s[8:11], s17 offen lds
  s_add_u32 s17, s17, s29
  s_add_u32 m0, s28, 31744
  s_nop 0
  buffer_load_dwordx4 v144, s[8:11], s17 offen lds
  s_add_u32 s17, s17, s29
  s_waitcnt vmcnt(28)
  ds_read_b64_tr_b16 a[128:129], v152 offset:0
  ds_read_b64_tr_b16 a[130:131], v153 offset:0
  ds_read_b64_tr_b16 a[132:133], v154 offset:0
  ds_read_b64_tr_b16 a[134:135], v155 offset:0
  ds_read_b64_tr_b16 a[136:137], v152 offset:64
  ds_read_b64_tr_b16 a[138:139], v153 offset:64
  ds_read_b64_tr_b16 a[140:141], v154 offset:64
  ds_read_b64_tr_b16 a[142:143], v155 offset:64
  s_waitcnt lgkmcnt(0)
  s_waitcnt vmcnt(24)
  ds_read_b64_tr_b16 a[144:145], v152 offset:4096
  ds_read_b64_tr_b16 a[146:147], v153 offset:4096
  ds_read_b64_tr_b16 a[148:149], v154 offset:4096
  ds_read_b64_tr_b16 a[150:151], v155 offset:4096
  ds_read_b64_tr_b16 a[152:153], v152 offset:4160
  ds_read_b64_tr_b16 a[154:155], v153 offset:4160
  ds_read_b64_tr_b16 a[156:157], v154 offset:4160
  ds_read_b64_tr_b16 a[158:159], v155 offset:4160
  s_waitcnt lgkmcnt(0)
  s_waitcnt vmcnt(20)
  ds_read_b64_tr_b16 a[160:161], v152 offset:8192
  ds_read_b64_tr_b16 a[162:163], v153 offset:8192
  ds_read_b64_tr_b16 a[164:165], v154 offset:8192
  ds_read_b64_tr_b16 a[166:167], v155 offset:8192
  ds_read_b64_tr_b16 a[168:169], v152 offset:8256
  ds_read_b64_tr_b16 a[170:171], v153 offset:8256
  ds_read_b64_tr_b16 a[172:173], v154 offset:8256
  ds_read_b64_tr_b16 a[174:175], v155 offset:8256
  s_waitcnt lgkmcnt(0)
  s_waitcnt vmcnt(16)
  ds_read_b64_tr_b16 a[176:177], v152 offset:12288
  ds_read_b64_tr_b16 a[178:179], v153 offset:12288
  ds_read_b64_tr_b16 a[180:181], v154 offset:12288
  ds_read_b64_tr_b16 a[182:183], v155 offset:12288
  ds_read_b64_tr_b16 a[184:185], v152 offset:12352
  ds_read_b64_tr_b16 a[186:187], v153 offset:12352
  ds_read_b64_tr_b16 a[188:189], v154 offset:12352
  ds_read_b64_tr_b16 a[190:191], v155 offset:12352
  s_waitcnt lgkmcnt(0)
  s_waitcnt vmcnt(12)
  ds_read_b64_tr_b16 a[192:193], v152 offset:16384
  ds_read_b64_tr_b16 a[194:195], v153 offset:16384
  ds_read_b64_tr_b16 a[196:197], v154 offset:16384
  ds_read_b64_tr_b16 a[198:199], v155 offset:16384
  ds_read_b64_tr_b16 a[200:201], v152 offset:16448
  ds_read_b64_tr_b16 a[202:203], v153 offset:16448
  ds_read_b64_tr_b16 a[204:205], v154 offset:16448
  ds_read_b64_tr_b16 a[206:207], v155 offset:16448
  s_waitcnt lgkmcnt(0)
  s_waitcnt vmcnt(8)
  ds_read_b64_tr_b16 a[208:209], v152 offset:20480
  ds_read_b64_tr_b16 a[210:211], v153 offset:20480
  ds_read_b64_tr_b16 a[212:213], v154 offset:20480
  ds_read_b64_tr_b16 a[214:215], v155 offset:20480
  ds_read_b64_tr_b16 a[216:217], v152 offset:20544
  ds_read_b64_tr_b16 a[218:219], v153 offset:20544
  ds_read_b64_tr_b16 a[220:221], v154 offset:20544
  ds_read_b64_tr_b16 a[222:223], v155 offset:20544
  s_waitcnt lgkmcnt(0)
  s_waitcnt vmcnt(4)
  ds_read_b64_tr_b16 a[224:225], v152 offset:24576
  ds_read_b64_tr_b16 a[226:227], v153 offset:24576
  ds_read_b64_tr_b16 a[228:229], v154 offset:24576
  ds_read_b64_tr_b16 a[230:231], v155 offset:24576
  ds_read_b64_tr_b16 a[232:233], v152 offset:24640
  ds_read_b64_tr_b16 a[234:235], v153 offset:24640
  ds_read_b64_tr_b16 a[236:237], v154 offset:24640
  ds_read_b64_tr_b16 a[238:239], v155 offset:24640
  s_waitcnt lgkmcnt(0)
  s_waitcnt vmcnt(0)
  ds_read_b64_tr_b16 a[240:241], v152 offset:28672
  ds_read_b64_tr_b16 a[242:243], v153 offset:28672
  ds_read_b64_tr_b16 a[244:245], v154 offset:28672
  ds_read_b64_tr_b16 a[246:247], v155 offset:28672
  ds_read_b64_tr_b16 a[248:249], v152 offset:28736
  ds_read_b64_tr_b16 a[250:251], v153 offset:28736
  ds_read_b64_tr_b16 a[252:253], v154 offset:28736
  ds_read_b64_tr_b16 a[254:255], v155 offset:28736
  s_waitcnt lgkmcnt(0)
  s_barrier
  s_add_u32 m0, s25, 0
  s_nop 0
  buffer_load_dwordx4 v16, s[12:15], s19 offen lds
  s_add_u32 m0, s25, 1024
  s_nop 0
  buffer_load_dwordx4 v17, s[12:15], s19 offen lds
  s_add_u32 m0, s25, 2048
  s_nop 0
  buffer_load_dwordx4 v18, s[12:15], s19 offen lds
  s_add_u32 m0, s25, 3072
  s_nop 0
  buffer_load_dwordx4 v19, s[12:15], s19 offen lds
  s_add_u32 m0, s25, 4096
  s_nop 0
  buffer_load_dwordx4 v20, s[12:15], s19 offen lds
  s_add_u32 m0, s25, 5120
  s_nop 0
  buffer_load_dwordx4 v21, s[12:15], s19 offen lds
  s_add_u32 m0, s25, 6144
  s_nop 0
  buffer_load_dwordx4 v22, s[12:15], s19 offen lds
  s_add_u32 m0, s25, 7168
  s_nop 0
  buffer_load_dwordx4 v23, s[12:15], s19 offen lds
  s_cmp_gt_u32 s23, 2
  s_cselect_b32 s26, s20, 0
  s_add_u32 s19, s19, s26
  s_add_u32 s25, s25, 32768
  s_and_b32 s25, s25, 0x1ffff
  s_waitcnt vmcnt(0)
  s_barrier
  s_load_dwordx2 s[8:9], s[0:1], 40
  s_mul_i32 s76, s66, 18816
  v_min_u32 v200, 146, v0
  v_lshl_add_u32 v200, v200, 7, s76
  s_waitcnt lgkmcnt(0)
  s_and_b32 s9, s9, 0xffff
  buffer_load_dword v201, v200, s[8:11], 0 offen
  s_cmp_lg_u32 s32, 0
  s_cbranch_scc1 P_v_1
  s_cmp_eq_u32 s48, 0
  s_cbranch_scc1 P_q_3
  s_mov_b32 s27, s21
  v_mov_b32 v7, 0x40000000
  s_mov_b32 s29, -2
  v_min_u32 v145, 1, v0
  v_lshlrev_b32 v145, 30, v145
  ds_read_b128 v[24:27], v8 offset:0
  ds_read_b128 v[28:31], v9 offset:0
  ds_read_b128 v[32:35], v10 offset:0
  ds_read_b128 v[36:39], v11 offset:0
  ds_read_b128 v[40:43], v12 offset:0
  ds_read_b128 v[44:47], v13 offset:0
.p2align 6
G_top_4:
  s_waitcnt lgkmcnt(5)
  v_mfma_f32_16x16x32_bf16 v[64:67], a[0:3], v[24:27], 0
  s_add_u32 m0, s25, 0
  ds_read_b128 v[48:51], v14 offset:0
  v_mfma_f32_16x16x32_bf16 v[68:71], a[4:7], v[24:27], 0
  v_mfma_f32_16x16x32_bf16 v[80:83], a[8:11], v[24:27], 0
  buffer_load_dwordx4 v16, s[12:15], s19 offen lds
  v_mfma_f32_16x16x32_bf16 v[84:87], a[12:15], v[24:27], 0
  s_waitcnt lgkmcnt(5)
  v_mfma_f32_16x16x32_bf16 v[72:75], a[0:3], v[28:31], 0
  ds_read_b128 v[52:55], v15 offset:0
  v_mfma_f32_16x16x32_bf16 v[76:79], a[4:7], v[28:31], 0
  v_cvt_pk_bf16_f32 v128, v96, v97
  v_cvt_pk_bf16_f32 v129, v98, v99
  v_mfma_f32_16x16x32_bf16 v[88:91], a[8:11], v[28:31], 0
  v_mfma_f32_16x16x32_bf16 v[92:95], a[12:15], v[28:31], 0
  s_waitcnt lgkmcnt(5)
  v_cvt_pk_bf16_f32 v130, v100, v101
  v_cvt_pk_bf16_f32 v131, v102, v103
  v_mfma_f32_16x16x32_bf16 v[64:67], a[16:19], v[32:35], v[64:67]
  s_add_u32 m0, s25, 1024
  ds_read_b128 v[24:27], v8 offset:8192
  v_mfma_f32_16x16x32_bf16 v[68:71], a[20:23], v[32:35], v[68:71]
  v_mfma_f32_16x16x32_bf16 v[80:83], a[24:27], v[32:35], v[80:83]
  buffer_load_dwordx4 v17, s[12:15], s19 offen lds
  v_mfma_f32_16x16x32_bf16 v[84:87], a[28:31], v[32:35], v[84:87]
  s_waitcnt lgkmcnt(5)
  v_mfma_f32_16x16x32_bf16 v[72:75], a[16:19], v[36:39], v[72:75]
  ds_read_b128 v[28:31], v9 offset:8192
  v_mfma_f32_16x16x32_bf16 v[76:79], a[20:23], v[36:39], v[76:79]
  v_mfma_f32_16x16x32_bf16 v[88:91], a[24:27], v[36:39], v[88:91]
  v_mfma_f32_16x16x32_bf16 v[92:95], a[28:31], v[36:39], v[92:95]
  s_waitcnt lgkmcnt(5)
  v_mfma_f32_16x16x32_bf16 v[64:67], a[32:35], v[40:43], v[64:67]
  s_add_u32 m0, s25, 2048
  ds_read_b128 v[32:35], v10 offset:8192
  v_mfma_f32_16x16x32_bf16 v[68:71], a[36:39], v[40:43], v[68:71]
  v_cvt_pk_bf16_f32 v132, v104, v105
  v_cvt_pk_bf16_f32 v133, v106, v107
  v_mfma_f32_16x16x32_bf16 v[80:83], a[40:43], v[40:43], v[80:83]
  buffer_load_dwordx4 v18, s[12:15], s19 offen lds
  v_mfma_f32_16x16x32_bf16 v[84:87], a[44:47], v[40:43], v[84:87]
  s_waitcnt lgkmcnt(5)
  v_cvt_pk_bf16_f32 v134, v108, v109
  v_cvt_pk_bf16_f32 v135, v110, v111
  v_mfma_f32_16x16x32_bf16 v[72:75], a[32:35], v[44:47], v[72:75]
  ds_read_b128 v[36:39], v11 offset:8192
  v_mfma_f32_16x16x32_bf16 v[76:79], a[36:39], v[44:47], v[76:79]
  v_mfma_f32_16x16x32_bf16 v[88:91], a[40:43], v[44:47], v[88:91]
  v_mfma_f32_16x16x32_bf16 v[92:95], a[44:47], v[44:47], v[92:95]
  s_waitcnt lgkmcnt(5)
  v_mfma_f32_16x16x32_bf16 v[64:67], a[48:51], v[48:51], v[64:67]
  s_add_u32 m0, s25, 3072
  ds_read_b128 v[40:43], v12 offset:8192
  v_mfma_f32_16x16x32_bf16 v[68:71], a[52:55], v[48:51], v[68:71]
  v_mfma_f32_16x16x32_bf16 v[80:83], a[56:59], v[48:51], v[80:83]
  buffer_load_dwordx4 v19, s[12:15], s19 offen lds
  v_mfma_f32_16x16x32_bf16 v[84:87], a[60:63], v[48:51], v[84:87]
  s_waitcnt lgkmcnt(5)
  v_mfma_f32_16x16x32_bf16 v[72:75], a[48:51], v[52:55], v[72:75]
  ds_read_b128 v[44:47], v13 offset:8192
  v_mfma_f32_16x16x32_bf16 v[76:79], a[52:55], v[52:55], v[76:79]
  v_cvt_pk_bf16_f32 v136, v112, v113
  v_cvt_pk_bf16_f32 v137, v114, v115
  v_mfma_f32_16x16x32_bf16 v[88:91], a[56:59], v[52:55], v[88:91]
  v_mfma_f32_16x16x32_bf16 v[92:95], a[60:63], v[52:55], v[92:95]
  s_waitcnt lgkmcnt(5)
  v_cvt_pk_bf16_f32 v138, v116, v117
  v_cvt_pk_bf16_f32 v139, v118, v119
  v_mfma_f32_16x16x32_bf16 v[64:67], a[64:67], v[24:27], v[64:67]
  s_add_u32 m0, s25, 4096
  ds_read_b128 v[48:51], v14 offset:8192
  v_mfma_f32_16x16x32_bf16 v[68:71], a[68:71], v[24:27], v[68:71]
  v_mfma_f32_16x16x32_bf16 v[80:83], a[72:75], v[24:27], v[80:83]
  buffer_load_dwordx4 v20, s[12:15], s19 offen lds
  v_mfma_f32_16x16x32_bf16 v[84:87], a[76:79], v[24:27], v[84:87]
  s_waitcnt lgkmcnt(5)
  v_mfma_f32_16x16x32_bf16 v[72:75], a[64:67], v[28:31], v[72:75]
  ds_read_b128 v[52:55], v15 offset:8192
  v_mfma_f32_16x16x32_bf16 v[76:79], a[68:71], v[28:31], v[76:79]
  v_mfma_f32_16x16x32_bf16 v[88:91], a[72:75], v[28:31], v[88:91]
  v_mfma_f32_16x16x32_bf16 v[92:95], a[76:79], v[28:31], v[92:95]
  s_waitcnt lgkmcnt(5)
  v_mfma_f32_16x16x32_bf16 v[64:67], a[80:83], v[32:35], v[64:67]
  s_add_u32 m0, s25, 5120
  ds_read_b128 v[24:27], v8 offset:16384
  v_mfma_f32_16x16x32_bf16 v[68:71], a[84:87], v[32:35], v[68:71]
  v_cvt_pk_bf16_f32 v140, v120, v121
  v_cvt_pk_bf16_f32 v141, v122, v123
  v_mfma_f32_16x16x32_bf16 v[80:83], a[88:91], v[32:35], v[80:83]
  buffer_load_dwordx4 v21, s[12:15], s19 offen lds
  v_mfma_f32_16x16x32_bf16 v[84:87], a[92:95], v[32:35], v[84:87]
  s_waitcnt lgkmcnt(5)
  v_cvt_pk_bf16_f32 v142, v124, v125
  v_cvt_pk_bf16_f32 v143, v126, v127
  v_mfma_f32_16x16x32_bf16 v[72:75], a[80:83], v[36:39], v[72:75]
  ds_read_b128 v[28:31], v9 offset:16384
  v_mfma_f32_16x16x32_bf16 v[76:79], a[84:87], v[36:39], v[76:79]
  v_mfma_f32_16x16x32_bf16 v[88:91], a[88:91], v[36:39], v[88:91]
  v_mfma_f32_16x16x32_bf16 v[92:95], a[92:95], v[36:39], v[92:95]
  s_waitcnt lgkmcnt(5)
  v_mfma_f32_16x16x32_bf16 v[64:67], a[96:99], v[40:43], v[64:67]
  s_add_u32 m0, s25, 6144
  ds_read_b128 v[32:35], v10 offset:16384
  v_mfma_f32_16x16x32_bf16 v[68:71], a[100:103], v[40:43], v[68:71]
  v_mfma_f32_16x16x32_bf16 v[80:83], a[104:107], v[40:43], v[80:83]
  buffer_load_dwordx4 v22, s[12:15], s19 offen lds
  v_mfma_f32_16x16x32_bf16 v[84:87], a[108:111], v[40:43], v[84:87]
  s_waitcnt lgkmcnt(5)
  v_mfma_f32_16x16x32_bf16 v[72:75], a[96:99], v[44:47], v[72:75]
  ds_read_b128 v[36:39], v11 offset:16384
  v_mfma_f32_16x16x32_bf16 v[76:79], a[100:103], v[44:47], v[76:79]
  v_mfma_f32_16x16x32_bf16 v[88:91], a[104:107], v[44:47], v[88:91]
  v_mfma_f32_16x16x32_bf16 v[92:95], a[108:111], v[44:47], v[92:95]
  s_waitcnt lgkmcnt(5)
  v_mfma_f32_16x16x32_bf16 v[64:67], a[112:115], v[48:51], v[64:67]
  s_add_u32 m0, s25, 7168
  ds_read_b128 v[40:43], v12 offset:16384
  v_mfma_f32_16x16x32_bf16 v[68:71], a[116:119], v[48:51], v[68:71]
  v_mfma_f32_16x16x32_bf16 v[80:83], a[120:123], v[48:51], v[80:83]
  buffer_load_dwordx4 v23, s[12:15], s19 offen lds
  v_mfma_f32_16x16x32_bf16 v[84:87], a[124:127], v[48:51], v[84:87]
  s_waitcnt lgkmcnt(5)
  v_mfma_f32_16x16x32_bf16 v[72:75], a[112:115], v[52:55], v[72:75]
  s_cmp_gt_u32 s23, 3
  ds_read_b128 v[44:47], v13 offset:16384
  v_mfma_f32_16x16x32_bf16 v[76:79], a[116:119], v[52:55], v[76:79]
  v_mfma_f32_16x16x32_bf16 v[88:91], a[120:123], v[52:55], v[88:91]
  s_cselect_b32 s26, s20, 0
  v_mfma_f32_16x16x32_bf16 v[92:95], a[124:127], v[52:55], v[92:95]
  s_waitcnt lgkmcnt(5)
  v_mfma_f32_16x16x32_bf16 v[64:67], a[128:131], v[24:27], v[64:67]
  s_add_u32 s19, s19, s26
  ds_read_b128 v[48:51], v14 offset:16384
  v_mfma_f32_16x16x32_bf16 v[68:71], a[132:135], v[24:27], v[68:71]
  v_mfma_f32_16x16x32_bf16 v[80:83], a[136:139], v[24:27], v[80:83]
  s_add_u32 s25, s25, 32768
  v_mfma_f32_16x16x32_bf16 v[84:87], a[140:143], v[24:27], v[84:87]
  s_waitcnt lgkmcnt(5)
  v_mfma_f32_16x16x32_bf16 v[72:75], a[128:131], v[28:31], v[72:75]
  s_and_b32 s25, s25, 0x1ffff
  ds_read_b128 v[52:55], v15 offset:16384
  v_mfma_f32_16x16x32_bf16 v[76:79], a[132:135], v[28:31], v[76:79]
  v_mfma_f32_16x16x32_bf16 v[88:91], a[136:139], v[28:31], v[88:91]
  buffer_store_dwordx4 v[128:131], v7, s[4:7], s21 offen offset:0 sc1
  v_mfma_f32_16x16x32_bf16 v[92:95], a[140:143], v[28:31], v[92:95]
  s_waitcnt lgkmcnt(5)
  v_mfma_f32_16x16x32_bf16 v[64:67], a[144:147], v[32:35], v[64:67]
  ds_read_b128 v[24:27], v8 offset:24576
  v_mfma_f32_16x16x32_bf16 v[68:71], a[148:151], v[32:35], v[68:71]
  v_mfma_f32_16x16x32_bf16 v[80:83], a[152:155], v[32:35], v[80:83]
  v_mfma_f32_16x16x32_bf16 v[84:87], a[156:159], v[32:35], v[84:87]
  s_waitcnt lgkmcnt(5)
  v_mfma_f32_16x16x32_bf16 v[72:75], a[144:147], v[36:39], v[72:75]
  ds_read_b128 v[28:31], v9 offset:24576
  v_mfma_f32_16x16x32_bf16 v[76:79], a[148:151], v[36:39], v[76:79]
  v_mfma_f32_16x16x32_bf16 v[88:91], a[152:155], v[36:39], v[88:91]
  buffer_store_dwordx4 v[132:135], v7, s[4:7], s21 offen offset:256 sc1
  v_mfma_f32_16x16x32_bf16 v[92:95], a[156:159], v[36:39], v[92:95]
  s_waitcnt lgkmcnt(5)
  v_mfma_f32_16x16x32_bf16 v[64:67], a[160:163], v[40:43], v[64:67]
  ds_read_b128 v[32:35], v10 offset:24576
  v_mfma_f32_16x16x32_bf16 v[68:71], a[164:167], v[40:43], v[68:71]
  v_mfma_f32_16x16x32_bf16 v[80:83], a[168:171], v[40:43], v[80:83]
  v_mfma_f32_16x16x32_bf16 v[84:87], a[172:175], v[40:43], v[84:87]
  s_waitcnt lgkmcnt(5)
  v_mfma_f32_16x16x32_bf16 v[72:75], a[160:163], v[44:47], v[72:75]
  ds_read_b128 v[36:39], v11 offset:24576
  v_mfma_f32_16x16x32_bf16 v[76:79], a[164:167], v[44:47], v[76:79]
  v_mfma_f32_16x16x32_bf16 v[88:91], a[168:171], v[44:47], v[88:91]
  buffer_store_dwordx4 v[136:139], v7, s[4:7], s21 offen offset:2048 sc1
  v_mfma_f32_16x16x32_bf16 v[92:95], a[172:175], v[44:47], v[92:95]
  s_waitcnt lgkmcnt(5)
  v_mfma_f32_16x16x32_bf16 v[64:67], a[176:179], v[48:51], v[64:67]
  ds_read_b128 v[40:43], v12 offset:24576
  v_mfma_f32_16x16x32_bf16 v[68:71], a[180:183], v[48:51], v[68:71]
  v_mfma_f32_16x16x32_bf16 v[80:83], a[184:187], v[48:51], v[80:83]
  v_mfma_f32_16x16x32_bf16 v[84:87], a[188:191], v[48:51], v[84:87]
  s_waitcnt lgkmcnt(5)
  v_mfma_f32_16x16x32_bf16 v[72:75], a[176:179], v[52:55], v[72:75]
  ds_read_b128 v[44:47], v13 offset:24576
  v_mfma_f32_16x16x32_bf16 v[76:79], a[180:183], v[52:55], v[76:79]
  v_mfma_f32_16x16x32_bf16 v[88:91], a[184:187], v[52:55], v[88:91]
  buffer_store_dwordx4 v[140:143], v7, s[4:7], s21 offen offset:2304 sc1
  v_mfma_f32_16x16x32_bf16 v[92:95], a[188:191], v[52:55], v[92:95]
  s_waitcnt lgkmcnt(5)
  v_mfma_f32_16x16x32_bf16 v[64:67], a[192:195], v[24:27], v[64:67]
  s_mov_b32 s21, s27
  ds_read_b128 v[48:51], v14 offset:24576
  v_mfma_f32_16x16x32_bf16 v[68:71], a[196:199], v[24:27], v[68:71]
  v_mov_b32 v7, v56
  v_mfma_f32_16x16x32_bf16 v[80:83], a[200:203], v[24:27], v[80:83]
  v_mfma_f32_16x16x32_bf16 v[84:87], a[204:207], v[24:27], v[84:87]
  s_waitcnt lgkmcnt(5)
  v_mfma_f32_16x16x32_bf16 v[72:75], a[192:195], v[28:31], v[72:75]
  s_add_u32 s27, s27, s22
  ds_read_b128 v[52:55], v15 offset:24576
  v_mfma_f32_16x16x32_bf16 v[76:79], a[196:199], v[28:31], v[76:79]
  v_mfma_f32_16x16x32_bf16 v[88:91], a[200:203], v[28:31], v[88:91]
  s_waitcnt vmcnt(13)
  s_barrier
  v_mfma_f32_16x16x32_bf16 v[92:95], a[204:207], v[28:31], v[92:95]
  s_waitcnt lgkmcnt(5)
  v_mfma_f32_16x16x32_bf16 v[64:67], a[208:211], v[32:35], v[64:67]
  ds_read_b128 v[24:27], v8 offset:32768
  v_mfma_f32_16x16x32_bf16 v[68:71], a[212:215], v[32:35], v[68:71]
  v_mfma_f32_16x16x32_bf16 v[80:83], a[216:219], v[32:35], v[80:83]
  v_mfma_f32_16x16x32_bf16 v[84:87], a[220:223], v[32:35], v[84:87]
  s_waitcnt lgkmcnt(5)
  v_mfma_f32_16x16x32_bf16 v[72:75], a[208:211], v[36:39], v[72:75]
  s_add_u32 s29, s29, 1
  ds_read_b128 v[28:31], v9 offset:32768
  v_mfma_f32_16x16x32_bf16 v[76:79], a[212:215], v[36:39], v[76:79]
  v_mfma_f32_16x16x32_bf16 v[88:91], a[216:219], v[36:39], v[88:91]
  s_max_i32 s30, s29, 0
  v_mfma_f32_16x16x32_bf16 v[92:95], a[220:223], v[36:39], v[92:95]
  s_waitcnt lgkmcnt(5)
  v_mov_b32 v144, s30
  v_mfma_f32_16x16x32_bf16 v[64:67], a[224:227], v[40:43], v[64:67]
  ds_read_b128 v[32:35], v10 offset:32768
  v_mfma_f32_16x16x32_bf16 v[68:71], a[228:231], v[40:43], v[68:71]
  v_mfma_f32_16x16x32_bf16 v[80:83], a[232:235], v[40:43], v[80:83]
  buffer_store_dword v144, v145, s[4:7], s31 offen sc1
  v_mfma_f32_16x16x32_bf16 v[84:87], a[236:239], v[40:43], v[84:87]
  s_waitcnt lgkmcnt(5)
  v_mfma_f32_16x16x32_bf16 v[72:75], a[224:227], v[44:47], v[72:75]
  ds_read_b128 v[36:39], v11 offset:32768
  v_mfma_f32_16x16x32_bf16 v[76:79], a[228:231], v[44:47], v[76:79]
  v_mfma_f32_16x16x32_bf16 v[88:91], a[232:235], v[44:47], v[88:91]
  v_mfma_f32_16x16x32_bf16 v[92:95], a[236:239], v[44:47], v[92:95]
  s_waitcnt lgkmcnt(5)
  v_mfma_f32_16x16x32_bf16 v[64:67], a[240:243], v[48:51], v[64:67]
  s_sub_u32 s23, s23, 1
  ds_read_b128 v[40:43], v12 offset:32768
  v_mfma_f32_16x16x32_bf16 v[68:71], a[244:247], v[48:51], v[68:71]
  v_mfma_f32_16x16x32_bf16 v[80:83], a[248:251], v[48:51], v[80:83]
  v_mfma_f32_16x16x32_bf16 v[84:87], a[252:255], v[48:51], v[84:87]
  s_waitcnt lgkmcnt(5)
  v_mfma_f32_16x16x32_bf16 v[72:75], a[240:243], v[52:55], v[72:75]
  s_cmp_eq_u32 s23, 0
  ds_read_b128 v[44:47], v13 offset:32768
  v_mfma_f32_16x16x32_bf16 v[76:79], a[244:247], v[52:55], v[76:79]
  v_mfma_f32_16x16x32_bf16 v[88:91], a[248:251], v[52:55], v[88:91]
  v_mfma_f32_16x16x32_bf16 v[92:95], a[252:255], v[52:55], v[92:95]
  s_cbranch_scc1 G_done0_5
  s_waitcnt lgkmcnt(5)
  v_mfma_f32_16x16x32_bf16 v[96:99], a[0:3], v[24:27], 0
  s_add_u32 m0, s25, 0
  ds_read_b128 v[48:51], v14 offset:32768
  v_mfma_f32_16x16x32_bf16 v[100:103], a[4:7], v[24:27], 0
  v_mfma_f32_16x16x32_bf16 v[112:115], a[8:11], v[24:27], 0
  buffer_load_dwordx4 v16, s[12:15], s19 offen lds
  v_mfma_f32_16x16x32_bf16 v[116:119], a[12:15], v[24:27], 0
  s_waitcnt lgkmcnt(5)
  v_mfma_f32_16x16x32_bf16 v[104:107], a[0:3], v[28:31], 0
  ds_read_b128 v[52:55], v15 offset:32768
  v_mfma_f32_16x16x32_bf16 v[108:111], a[4:7], v[28:31], 0
  v_cvt_pk_bf16_f32 v128, v64, v65
  v_cvt_pk_bf16_f32 v129, v66, v67
  v_mfma_f32_16x16x32_bf16 v[120:123], a[8:11], v[28:31], 0
  v_mfma_f32_16x16x32_bf16 v[124:127], a[12:15], v[28:31], 0
  s_waitcnt lgkmcnt(5)
  v_cvt_pk_bf16_f32 v130, v68, v69
  v_cvt_pk_bf16_f32 v131, v70, v71
  v_mfma_f32_16x16x32_bf16 v[96:99], a[16:19], v[32:35], v[96:99]
  s_add_u32 m0, s25, 1024
  ds_read_b128 v[24:27], v8 offset:40960
  v_mfma_f32_16x16x32_bf16 v[100:103], a[20:23], v[32:35], v[100:103]
  v_mfma_f32_16x16x32_bf16 v[112:115], a[24:27], v[32:35], v[112:115]
  buffer_load_dwordx4 v17, s[12:15], s19 offen lds
  v_mfma_f32_16x16x32_bf16 v[116:119], a[28:31], v[32:35], v[116:119]
  s_waitcnt lgkmcnt(5)
  v_mfma_f32_16x16x32_bf16 v[104:107], a[16:19], v[36:39], v[104:107]
  ds_read_b128 v[28:31], v9 offset:40960
  v_mfma_f32_16x16x32_bf16 v[108:111], a[20:23], v[36:39], v[108:111]
  v_mfma_f32_16x16x32_bf16 v[120:123], a[24:27], v[36:39], v[120:123]
  v_mfma_f32_16x16x32_bf16 v[124:127], a[28:31], v[36:39], v[124:127]
  s_waitcnt lgkmcnt(5)
  v_mfma_f32_16x16x32_bf16 v[96:99], a[32:35], v[40:43], v[96:99]
  s_add_u32 m0, s25, 2048
  ds_read_b128 v[32:35], v10 offset:40960
  v_mfma_f32_16x16x32_bf16 v[100:103], a[36:39], v[40:43], v[100:103]
  v_cvt_pk_bf16_f32 v132, v72, v73
  v_cvt_pk_bf16_f32 v133, v74, v75
  v_mfma_f32_16x16x32_bf16 v[112:115], a[40:43], v[40:43], v[112:115]
  buffer_load_dwordx4 v18, s[12:15], s19 offen lds
  v_mfma_f32_16x16x32_bf16 v[116:119], a[44:47], v[40:43], v[116:119]
  s_waitcnt lgkmcnt(5)
  v_cvt_pk_bf16_f32 v134, v76, v77
  v_cvt_pk_bf16_f32 v135, v78, v79
  v_mfma_f32_16x16x32_bf16 v[104:107], a[32:35], v[44:47], v[104:107]
  ds_read_b128 v[36:39], v11 offset:40960
  v_mfma_f32_16x16x32_bf16 v[108:111], a[36:39], v[44:47], v[108:111]
  v_mfma_f32_16x16x32_bf16 v[120:123], a[40:43], v[44:47], v[120:123]
  v_mfma_f32_16x16x32_bf16 v[124:127], a[44:47], v[44:47], v[124:127]
  s_waitcnt lgkmcnt(5)
  v_mfma_f32_16x16x32_bf16 v[96:99], a[48:51], v[48:51], v[96:99]
  s_add_u32 m0, s25, 3072
  ds_read_b128 v[40:43], v12 offset:40960
  v_mfma_f32_16x16x32_bf16 v[100:103], a[52:55], v[48:51], v[100:103]
  v_mfma_f32_16x16x32_bf16 v[112:115], a[56:59], v[48:51], v[112:115]
  buffer_load_dwordx4 v19, s[12:15], s19 offen lds
  v_mfma_f32_16x16x32_bf16 v[116:119], a[60:63], v[48:51], v[116:119]
  s_waitcnt lgkmcnt(5)
  v_mfma_f32_16x16x32_bf16 v[104:107], a[48:51], v[52:55], v[104:107]
  ds_read_b128 v[44:47], v13 offset:40960
  v_mfma_f32_16x16x32_bf16 v[108:111], a[52:55], v[52:55], v[108:111]
  v_cvt_pk_bf16_f32 v136, v80, v81
  v_cvt_pk_bf16_f32 v137, v82, v83
  v_mfma_f32_16x16x32_bf16 v[120:123], a[56:59], v[52:55], v[120:123]
  v_mfma_f32_16x16x32_bf16 v[124:127], a[60:63], v[52:55], v[124:127]
  s_waitcnt lgkmcnt(5)
  v_cvt_pk_bf16_f32 v138, v84, v85
  v_cvt_pk_bf16_f32 v139, v86, v87
  v_mfma_f32_16x16x32_bf16 v[96:99], a[64:67], v[24:27], v[96:99]
  s_add_u32 m0, s25, 4096
  ds_read_b128 v[48:51], v14 offset:40960
  v_mfma_f32_16x16x32_bf16 v[100:103], a[68:71], v[24:27], v[100:103]
  v_mfma_f32_16x16x32_bf16 v[112:115], a[72:75], v[24:27], v[112:115]
  buffer_load_dwordx4 v20, s[12:15], s19 offen lds
  v_mfma_f32_16x16x32_bf16 v[116:119], a[76:79], v[24:27], v[116:119]
  s_waitcnt lgkmcnt(5)
  v_mfma_f32_16x16x32_bf16 v[104:107], a[64:67], v[28:31], v[104:107]
  ds_read_b128 v[52:55], v15 offset:40960
  v_mfma_f32_16x16x32_bf16 v[108:111], a[68:71], v[28:31], v[108:111]
  v_mfma_f32_16x16x32_bf16 v[120:123], a[72:75], v[28:31], v[120:123]
  v_mfma_f32_16x16x32_bf16 v[124:127], a[76:79], v[28:31], v[124:127]
  s_waitcnt lgkmcnt(5)
  v_mfma_f32_16x16x32_bf16 v[96:99], a[80:83], v[32:35], v[96:99]
  s_add_u32 m0, s25, 5120
  ds_read_b128 v[24:27], v8 offset:49152
  v_mfma_f32_16x16x32_bf16 v[100:103], a[84:87], v[32:35], v[100:103]
  v_cvt_pk_bf16_f32 v140, v88, v89
  v_cvt_pk_bf16_f32 v141, v90, v91
  v_mfma_f32_16x16x32_bf16 v[112:115], a[88:91], v[32:35], v[112:115]
  buffer_load_dwordx4 v21, s[12:15], s19 offen lds
  v_mfma_f32_16x16x32_bf16 v[116:119], a[92:95], v[32:35], v[116:119]
  s_waitcnt lgkmcnt(5)
  v_cvt_pk_bf16_f32 v142, v92, v93
  v_cvt_pk_bf16_f32 v143, v94, v95
  v_mfma_f32_16x16x32_bf16 v[104:107], a[80:83], v[36:39], v[104:107]
  ds_read_b128 v[28:31], v9 offset:49152
  v_mfma_f32_16x16x32_bf16 v[108:111], a[84:87], v[36:39], v[108:111]
  v_mfma_f32_16x16x32_bf16 v[120:123], a[88:91], v[36:39], v[120:123]
  v_mfma_f32_16x16x32_bf16 v[124:127], a[92:95], v[36:39], v[124:127]
  s_waitcnt lgkmcnt(5)
  v_mfma_f32_16x16x32_bf16 v[96:99], a[96:99], v[40:43], v[96:99]
  s_add_u32 m0, s25, 6144
  ds_read_b128 v[32:35], v10 offset:49152
  v_mfma_f32_16x16x32_bf16 v[100:103], a[100:103], v[40:43], v[100:103]
  v_mfma_f32_16x16x32_bf16 v[112:115], a[104:107], v[40:43], v[112:115]
  buffer_load_dwordx4 v22, s[12:15], s19 offen lds
  v_mfma_f32_16x16x32_bf16 v[116:119], a[108:111], v[40:43], v[116:119]
  s_waitcnt lgkmcnt(5)
  v_mfma_f32_16x16x32_bf16 v[104:107], a[96:99], v[44:47], v[104:107]
  ds_read_b128 v[36:39], v11 offset:49152
  v_mfma_f32_16x16x32_bf16 v[108:111], a[100:103], v[44:47], v[108:111]
  v_mfma_f32_16x16x32_bf16 v[120:123], a[104:107], v[44:47], v[120:123]
  v_mfma_f32_16x16x32_bf16 v[124:127], a[108:111], v[44:47], v[124:127]
  s_waitcnt lgkmcnt(5)
  v_mfma_f32_16x16x32_bf16 v[96:99], a[112:115], v[48:51], v[96:99]
  s_add_u32 m0, s25, 7168
  ds_read_b128 v[40:43], v12 offset:49152
  v_mfma_f32_16x16x32_bf16 v[100:103], a[116:119], v[48:51], v[100:103]
  v_mfma_f32_16x16x32_bf16 v[112:115], a[120:123], v[48:51], v[112:115]
  buffer_load_dwordx4 v23, s[12:15], s19 offen lds
  v_mfma_f32_16x16x32_bf16 v[116:119], a[124:127], v[48:51], v[116:119]
  s_waitcnt lgkmcnt(5)
  v_mfma_f32_16x16x32_bf16 v[104:107], a[112:115], v[52:55], v[104:107]
  s_cmp_gt_u32 s23, 3
  ds_read_b128 v[44:47], v13 offset:49152
  v_mfma_f32_16x16x32_bf16 v[108:111], a[116:119], v[52:55], v[108:111]
  v_mfma_f32_16x16x32_bf16 v[120:123], a[120:123], v[52:55], v[120:123]
  s_cselect_b32 s26, s20, 0
  v_mfma_f32_16x16x32_bf16 v[124:127], a[124:127], v[52:55], v[124:127]
  s_waitcnt lgkmcnt(5)
  v_mfma_f32_16x16x32_bf16 v[96:99], a[128:131], v[24:27], v[96:99]
  s_add_u32 s19, s19, s26
  ds_read_b128 v[48:51], v14 offset:49152
  v_mfma_f32_16x16x32_bf16 v[100:103], a[132:135], v[24:27], v[100:103]
  v_mfma_f32_16x16x32_bf16 v[112:115], a[136:139], v[24:27], v[112:115]
  s_add_u32 s25, s25, 32768
  v_mfma_f32_16x16x32_bf16 v[116:119], a[140:143], v[24:27], v[116:119]
  s_waitcnt lgkmcnt(5)
  v_mfma_f32_16x16x32_bf16 v[104:107], a[128:131], v[28:31], v[104:107]
  s_and_b32 s25, s25, 0x1ffff
  ds_read_b128 v[52:55], v15 offset:49152
  v_mfma_f32_16x16x32_bf16 v[108:111], a[132:135], v[28:31], v[108:111]
  v_mfma_f32_16x16x32_bf16 v[120:123], a[136:139], v[28:31], v[120:123]
  buffer_store_dwordx4 v[128:131], v7, s[4:7], s21 offen offset:0 sc1
  v_mfma_f32_16x16x32_bf16 v[124:127], a[140:143], v[28:31], v[124:127]
  s_waitcnt lgkmcnt(5)
  v_mfma_f32_16x16x32_bf16 v[96:99], a[144:147], v[32:35], v[96:99]
  ds_read_b128 v[24:27], v8 offset:57344
  v_mfma_f32_16x16x32_bf16 v[100:103], a[148:151], v[32:35], v[100:103]
  v_mfma_f32_16x16x32_bf16 v[112:115], a[152:155], v[32:35], v[112:115]
  v_mfma_f32_16x16x32_bf16 v[116:119], a[156:159], v[32:35], v[116:119]
  s_waitcnt lgkmcnt(5)
  v_xor_b32 v8, 0x10000, v8
  v_mfma_f32_16x16x32_bf16 v[104:107], a[144:147], v[36:39], v[104:107]
  ds_read_b128 v[28:31], v9 offset:57344
  v_mfma_f32_16x16x32_bf16 v[108:111], a[148:151], v[36:39], v[108:111]
  v_mfma_f32_16x16x32_bf16 v[120:123], a[152:155], v[36:39], v[120:123]
  buffer_store_dwordx4 v[132:135], v7, s[4:7], s21 offen offset:256 sc1
  v_mfma_f32_16x16x32_bf16 v[124:127], a[156:159], v[36:39], v[124:127]
  s_waitcnt lgkmcnt(5)
  v_xor_b32 v9, 0x10000, v9
  v_mfma_f32_16x16x32_bf16 v[96:99], a[160:163], v[40:43], v[96:99]
  ds_read_b128 v[32:35], v10 offset:57344
  v_mfma_f32_16x16x32_bf16 v[100:103], a[164:167], v[40:43], v[100:103]
  v_mfma_f32_16x16x32_bf16 v[112:115], a[168:171], v[40:43], v[112:115]
  v_mfma_f32_16x16x32_bf16 v[116:119], a[172:175], v[40:43], v[116:119]
  s_waitcnt lgkmcnt(5)
  v_xor_b32 v10, 0x10000, v10
  v_mfma_f32_16x16x32_bf16 v[104:107], a[160:163], v[44:47], v[104:107]
  ds_read_b128 v[36:39], v11 offset:57344
  v_mfma_f32_16x16x32_bf16 v[108:111], a[164:167], v[44:47], v[108:111]
  v_mfma_f32_16x16x32_bf16 v[120:123], a[168:171], v[44:47], v[120:123]
  buffer_store_dwordx4 v[136:139], v7, s[4:7], s21 offen offset:2048 sc1
  v_mfma_f32_16x16x32_bf16 v[124:127], a[172:175], v[44:47], v[124:127]
  s_waitcnt lgkmcnt(5)
  v_xor_b32 v11, 0x10000, v11
  v_mfma_f32_16x16x32_bf16 v[96:99], a[176:179], v[48:51], v[96:99]
  ds_read_b128 v[40:43], v12 offset:57344
  v_mfma_f32_16x16x32_bf16 v[100:103], a[180:183], v[48:51], v[100:103]
  v_mfma_f32_16x16x32_bf16 v[112:115], a[184:187], v[48:51], v[112:115]
  v_mfma_f32_16x16x32_bf16 v[116:119], a[188:191], v[48:51], v[116:119]
  s_waitcnt lgkmcnt(5)
  v_xor_b32 v12, 0x10000, v12
  v_mfma_f32_16x16x32_bf16 v[104:107], a[176:179], v[52:55], v[104:107]
  ds_read_b128 v[44:47], v13 offset:57344
  v_mfma_f32_16x16x32_bf16 v[108:111], a[180:183], v[52:55], v[108:111]
  v_mfma_f32_16x16x32_bf16 v[120:123], a[184:187], v[52:55], v[120:123]
  buffer_store_dwordx4 v[140:143], v7, s[4:7], s21 offen offset:2304 sc1
  v_mfma_f32_16x16x32_bf16 v[124:127], a[188:191], v[52:55], v[124:127]
  s_waitcnt lgkmcnt(5)
  v_xor_b32 v13, 0x10000, v13
  v_mfma_f32_16x16x32_bf16 v[96:99], a[192:195], v[24:27], v[96:99]
  s_mov_b32 s21, s27
  ds_read_b128 v[48:51], v14 offset:57344
  v_mfma_f32_16x16x32_bf16 v[100:103], a[196:199], v[24:27], v[100:103]
  v_mov_b32 v7, v56
  v_mfma_f32_16x16x32_bf16 v[112:115], a[200:203], v[24:27], v[112:115]
  v_mfma_f32_16x16x32_bf16 v[116:119], a[204:207], v[24:27], v[116:119]
  s_waitcnt lgkmcnt(5)
  v_xor_b32 v14, 0x10000, v14
  v_mfma_f32_16x16x32_bf16 v[104:107], a[192:195], v[28:31], v[104:107]
  s_add_u32 s27, s27, s22
  ds_read_b128 v[52:55], v15 offset:57344
  v_mfma_f32_16x16x32_bf16 v[108:111], a[196:199], v[28:31], v[108:111]
  v_mfma_f32_16x16x32_bf16 v[120:123], a[200:203], v[28:31], v[120:123]
  s_waitcnt vmcnt(13)
  s_barrier
  v_mfma_f32_16x16x32_bf16 v[124:127], a[204:207], v[28:31], v[124:127]
  s_waitcnt lgkmcnt(5)
  v_xor_b32 v15, 0x10000, v15
  v_mfma_f32_16x16x32_bf16 v[96:99], a[208:211], v[32:35], v[96:99]
  ds_read_b128 v[24:27], v8 offset:0
  v_mfma_f32_16x16x32_bf16 v[100:103], a[212:215], v[32:35], v[100:103]
  v_mfma_f32_16x16x32_bf16 v[112:115], a[216:219], v[32:35], v[112:115]
  v_mfma_f32_16x16x32_bf16 v[116:119], a[220:223], v[32:35], v[116:119]
  s_waitcnt lgkmcnt(5)
  v_mfma_f32_16x16x32_bf16 v[104:107], a[208:211], v[36:39], v[104:107]
  s_add_u32 s29, s29, 1
  ds_read_b128 v[28:31], v9 offset:0
  v_mfma_f32_16x16x32_bf16 v[108:111], a[212:215], v[36:39], v[108:111]
  v_mfma_f32_16x16x32_bf16 v[120:123], a[216:219], v[36:39], v[120:123]
  s_max_i32 s30, s29, 0
  v_mfma_f32_16x16x32_bf16 v[124:127], a[220:223], v[36:39], v[124:127]
  s_waitcnt lgkmcnt(5)
  v_mov_b32 v144, s30
  v_mfma_f32_16x16x32_bf16 v[96:99], a[224:227], v[40:43], v[96:99]
  ds_read_b128 v[32:35], v10 offset:0
  v_mfma_f32_16x16x32_bf16 v[100:103], a[228:231], v[40:43], v[100:103]
  v_mfma_f32_16x16x32_bf16 v[112:115], a[232:235], v[40:43], v[112:115]
  buffer_store_dword v144, v145, s[4:7], s31 offen sc1
  v_mfma_f32_16x16x32_bf16 v[116:119], a[236:239], v[40:43], v[116:119]
  s_waitcnt lgkmcnt(5)
  v_mfma_f32_16x16x32_bf16 v[104:107], a[224:227], v[44:47], v[104:107]
  ds_read_b128 v[36:39], v11 offset:0
  v_mfma_f32_16x16x32_bf16 v[108:111], a[228:231], v[44:47], v[108:111]
  v_mfma_f32_16x16x32_bf16 v[120:123], a[232:235], v[44:47], v[120:123]
  v_mfma_f32_16x16x32_bf16 v[124:127], a[236:239], v[44:47], v[124:127]
  s_waitcnt lgkmcnt(5)
  v_mfma_f32_16x16x32_bf16 v[96:99], a[240:243], v[48:51], v[96:99]
  s_sub_u32 s23, s23, 1
  ds_read_b128 v[40:43], v12 offset:0
  v_mfma_f32_16x16x32_bf16 v[100:103], a[244:247], v[48:51], v[100:103]
  v_mfma_f32_16x16x32_bf16 v[112:115], a[248:251], v[48:51], v[112:115]
  v_mfma_f32_16x16x32_bf16 v[116:119], a[252:255], v[48:51], v[116:119]
  s_waitcnt lgkmcnt(5)
  v_mfma_f32_16x16x32_bf16 v[104:107], a[240:243], v[52:55], v[104:107]
  s_cmp_eq_u32 s23, 0
  ds_read_b128 v[44:47], v13 offset:0
  v_mfma_f32_16x16x32_bf16 v[108:111], a[244:247], v[52:55], v[108:111]
  v_mfma_f32_16x16x32_bf16 v[120:123], a[248:251], v[52:55], v[120:123]
  v_mfma_f32_16x16x32_bf16 v[124:127], a[252:255], v[52:55], v[124:127]
  s_cbranch_scc1 G_done1_6
  s_branch G_top_4
G_done0_5:
  s_nop 7
  s_nop 3
  v_cvt_pk_bf16_f32 v128, v64, v65
  v_cvt_pk_bf16_f32 v129, v66, v67
  v_cvt_pk_bf16_f32 v130, v68, v69
  v_cvt_pk_bf16_f32 v131, v70, v71
  buffer_store_dwordx4 v[128:131], v7, s[4:7], s21 offen offset:0 sc1
  v_cvt_pk_bf16_f32 v132, v72, v73
  v_cvt_pk_bf16_f32 v133, v74, v75
  v_cvt_pk_bf16_f32 v134, v76, v77
  v_cvt_pk_bf16_f32 v135, v78, v79
  buffer_store_dwordx4 v[132:135], v7, s[4:7], s21 offen offset:256 sc1
  v_cvt_pk_bf16_f32 v136, v80, v81
  v_cvt_pk_bf16_f32 v137, v82, v83
  v_cvt_pk_bf16_f32 v138, v84, v85
  v_cvt_pk_bf16_f32 v139, v86, v87
  buffer_store_dwordx4 v[136:139], v7, s[4:7], s21 offen offset:2048 sc1
  v_cvt_pk_bf16_f32 v140, v88, v89
  v_cvt_pk_bf16_f32 v141, v90, v91
  v_cvt_pk_bf16_f32 v142, v92, v93
  v_cvt_pk_bf16_f32 v143, v94, v95
  buffer_store_dwordx4 v[140:143], v7, s[4:7], s21 offen offset:2304 sc1
  s_branch G_fin_7
G_done1_6:
  s_nop 7
  s_nop 3
  v_cvt_pk_bf16_f32 v128, v96, v97
  v_cvt_pk_bf16_f32 v129, v98, v99
  v_cvt_pk_bf16_f32 v130, v100, v101
  v_cvt_pk_bf16_f32 v131, v102, v103
  buffer_store_dwordx4 v[128:131], v7, s[4:7], s21 offen offset:0 sc1
  v_cvt_pk_bf16_f32 v132, v104, v105
  v_cvt_pk_bf16_f32 v133, v106, v107
  v_cvt_pk_bf16_f32 v134, v108, v109
  v_cvt_pk_bf16_f32 v135, v110, v111
  buffer_store_dwordx4 v[132:135], v7, s[4:7], s21 offen offset:256 sc1
  v_cvt_pk_bf16_f32 v136, v112, v113
  v_cvt_pk_bf16_f32 v137, v114, v115
  v_cvt_pk_bf16_f32 v138, v116, v117
  v_cvt_pk_bf16_f32 v139, v118, v119
  buffer_store_dwordx4 v[136:139], v7, s[4:7], s21 offen offset:2048 sc1
  v_cvt_pk_bf16_f32 v140, v120, v121
  v_cvt_pk_bf16_f32 v141, v122, v123
  v_cvt_pk_bf16_f32 v142, v124, v125
  v_cvt_pk_bf16_f32 v143, v126, v127
  buffer_store_dwordx4 v[140:143], v7, s[4:7], s21 offen offset:2304 sc1
G_fin_7:
  s_waitcnt vmcnt(0) lgkmcnt(0)
  s_barrier
  s_add_u32 s30, s29, 2
  v_mov_b32 v144, s30
  v_min_u32 v145, 1, v0
  v_lshlrev_b32 v145, 30, v145
  buffer_store_dword v144, v145, s[4:7], s31 offen sc1
  s_branch P_end_2
P_q_3:
  s_mov_b32 s27, s21
  v_mov_b32 v7, 0x40000000
  s_mov_b32 s29, -2
  v_min_u32 v145, 1, v0
  v_lshlrev_b32 v145, 30, v145
  ds_read_b128 v[24:27], v8 offset:0
  ds_read_b128 v[28:31], v9 offset:0
  ds_read_b128 v[32:35], v10 offset:0
  ds_read_b128 v[36:39], v11 offset:0
  ds_read_b128 v[40:43], v12 offset:0
  ds_read_b128 v[44:47], v13 offset:0
.p2align 6
G_top_8:
  s_waitcnt lgkmcnt(5)
  v_mfma_f32_16x16x32_bf16 v[64:67], a[0:3], v[24:27], 0
  s_add_u32 m0, s25, 0
  ds_read_b128 v[48:51], v14 offset:0
  v_mfma_f32_16x16x32_bf16 v[68:71], a[4:7], v[24:27], 0
  v_mfma_f32_16x16x32_bf16 v[80:83], a[8:11], v[24:27], 0
  buffer_load_dwordx4 v16, s[12:15], s19 offen lds
  v_mfma_f32_16x16x32_bf16 v[84:87], a[12:15], v[24:27], 0
  s_waitcnt lgkmcnt(5)
  v_mfma_f32_16x16x32_bf16 v[72:75], a[0:3], v[28:31], 0
  ds_read_b128 v[52:55], v15 offset:0
  v_mfma_f32_16x16x32_bf16 v[76:79], a[4:7], v[28:31], 0
  v_mul_f32 v96, s24, v96
  v_mul_f32 v97, s24, v97
  v_mfma_f32_16x16x32_bf16 v[88:91], a[8:11], v[28:31], 0
  v_mfma_f32_16x16x32_bf16 v[92:95], a[12:15], v[28:31], 0
  s_waitcnt lgkmcnt(5)
  v_cvt_pk_bf16_f32 v128, v96, v97
  v_mul_f32 v98, s24, v98
  v_mfma_f32_16x16x32_bf16 v[64:67], a[16:19], v[32:35], v[64:67]
  s_add_u32 m0, s25, 1024
  ds_read_b128 v[24:27], v8 offset:8192
  v_mfma_f32_16x16x32_bf16 v[68:71], a[20:23], v[32:35], v[68:71]
  v_mul_f32 v99, s24, v99
  v_cvt_pk_bf16_f32 v129, v98, v99
  v_mfma_f32_16x16x32_bf16 v[80:83], a[24:27], v[32:35], v[80:83]
  buffer_load_dwordx4 v17, s[12:15], s19 offen lds
  v_mfma_f32_16x16x32_bf16 v[84:87], a[28:31], v[32:35], v[84:87]
  s_waitcnt lgkmcnt(5)
  v_mul_f32 v100, s24, v100
  v_mul_f32 v101, s24, v101
  v_mfma_f32_16x16x32_bf16 v[72:75], a[16:19], v[36:39], v[72:75]
  ds_read_b128 v[28:31], v9 offset:8192
  v_mfma_f32_16x16x32_bf16 v[76:79], a[20:23], v[36:39], v[76:79]
  v_cvt_pk_bf16_f32 v130, v100, v101
  v_mul_f32 v102, s24, v102
  v_mfma_f32_16x16x32_bf16 v[88:91], a[24:27], v[36:39], v[88:91]
  v_mfma_f32_16x16x32_bf16 v[92:95], a[28:31], v[36:39], v[92:95]
  s_waitcnt lgkmcnt(5)
  v_mul_f32 v103, s24, v103
  v_cvt_pk_bf16_f32 v131, v102, v103
  v_mfma_f32_16x16x32_bf16 v[64:67], a[32:35], v[40:43], v[64:67]
  s_add_u32 m0, s25, 2048
  ds_read_b128 v[32:35], v10 offset:8192
  v_mfma_f32_16x16x32_bf16 v[68:71], a[36:39], v[40:43], v[68:71]
  v_mul_f32 v104, s24, v104
  v_mul_f32 v105, s24, v105
  v_mfma_f32_16x16x32_bf16 v[80:83], a[40:43], v[40:43], v[80:83]
  buffer_load_dwordx4 v18, s[12:15], s19 offen lds
  v_mfma_f32_16x16x32_bf16 v[84:87], a[44:47], v[40:43], v[84:87]
  s_waitcnt lgkmcnt(5)
  v_cvt_pk_bf16_f32 v132, v104, v105
  v_mul_f32 v106, s24, v106
  v_mfma_f32_16x16x32_bf16 v[72:75], a[32:35], v[44:47], v[72:75]
  ds_read_b128 v[36:39], v11 offset:8192
  v_mfma_f32_16x16x32_bf16 v[76:79], a[36:39], v[44:47], v[76:79]
  v_mul_f32 v107, s24, v107
  v_cvt_pk_bf16_f32 v133, v106, v107
  v_mfma_f32_16x16x32_bf16 v[88:91], a[40:43], v[44:47], v[88:91]
  v_mfma_f32_16x16x32_bf16 v[92:95], a[44:47], v[44:47], v[92:95]
  s_waitcnt lgkmcnt(5)
  v_mul_f32 v108, s24, v108
  v_mul_f32 v109, s24, v109
  v_mfma_f32_16x16x32_bf16 v[64:67], a[48:51], v[48:51], v[64:67]
  s_add_u32 m0, s25, 3072
  ds_read_b128 v[40:43], v12 offset:8192
  v_mfma_f32_16x16x32_bf16 v[68:71], a[52:55], v[48:51], v[68:71]
  v_cvt_pk_bf16_f32 v134, v108, v109
  v_mul_f32 v110, s24, v110
  v_mfma_f32_16x16x32_bf16 v[80:83], a[56:59], v[48:51], v[80:83]
  buffer_load_dwordx4 v19, s[12:15], s19 offen lds
  v_mfma_f32_16x16x32_bf16 v[84:87], a[60:63], v[48:51], v[84:87]
  s_waitcnt lgkmcnt(5)
  v_mul_f32 v111, s24, v111
  v_cvt_pk_bf16_f32 v135, v110, v111
  v_mfma_f32_16x16x32_bf16 v[72:75], a[48:51], v[52:55], v[72:75]
  ds_read_b128 v[44:47], v13 offset:8192
  v_mfma_f32_16x16x32_bf16 v[76:79], a[52:55], v[52:55], v[76:79]
  v_mul_f32 v112, s24, v112
  v_mul_f32 v113, s24, v113
  v_mfma_f32_16x16x32_bf16 v[88:91], a[56:59], v[52:55], v[88:91]
  v_mfma_f32_16x16x32_bf16 v[92:95], a[60:63], v[52:55], v[92:95]
  s_waitcnt lgkmcnt(5)
  v_cvt_pk_bf16_f32 v136, v112, v113
  v_mul_f32 v114, s24, v114
  v_mfma_f32_16x16x32_bf16 v[64:67], a[64:67], v[24:27], v[64:67]
  s_add_u32 m0, s25, 4096
  ds_read_b128 v[48:51], v14 offset:8192
  v_mfma_f32_16x16x32_bf16 v[68:71], a[68:71], v[24:27], v[68:71]
  v_mul_f32 v115, s24, v115
  v_cvt_pk_bf16_f32 v137, v114, v115
  v_mfma_f32_16x16x32_bf16 v[80:83], a[72:75], v[24:27], v[80:83]
  buffer_load_dwordx4 v20, s[12:15], s19 offen lds
  v_mfma_f32_16x16x32_bf16 v[84:87], a[76:79], v[24:27], v[84:87]
  s_waitcnt lgkmcnt(5)
  v_mul_f32 v116, s24, v116
  v_mul_f32 v117, s24, v117
  v_mfma_f32_16x16x32_bf16 v[72:75], a[64:67], v[28:31], v[72:75]
  ds_read_b128 v[52:55], v15 offset:8192
  v_mfma_f32_16x16x32_bf16 v[76:79], a[68:71], v[28:31], v[76:79]
  v_cvt_pk_bf16_f32 v138, v116, v117
  v_mul_f32 v118, s24, v118
  v_mfma_f32_16x16x32_bf16 v[88:91], a[72:75], v[28:31], v[88:91]
  v_mfma_f32_16x16x32_bf16 v[92:95], a[76:79], v[28:31], v[92:95]
  s_waitcnt lgkmcnt(5)
  v_mul_f32 v119, s24, v119
  v_cvt_pk_bf16_f32 v139, v118, v119
  v_mfma_f32_16x16x32_bf16 v[64:67], a[80:83], v[32:35], v[64:67]
  s_add_u32 m0, s25, 5120
  ds_read_b128 v[24:27], v8 offset:16384
  v_mfma_f32_16x16x32_bf16 v[68:71], a[84:87], v[32:35], v[68:71]
  v_mul_f32 v120, s24, v120
  v_mul_f32 v121, s24, v121
  v_mfma_f32_16x16x32_bf16 v[80:83], a[88:91], v[32:35], v[80:83]
  buffer_load_dwordx4 v21, s[12:15], s19 offen lds
  v_mfma_f32_16x16x32_bf16 v[84:87], a[92:95], v[32:35], v[84:87]
  s_waitcnt lgkmcnt(5)
  v_cvt_pk_bf16_f32 v140, v120, v121
  v_mul_f32 v122, s24, v122
  v_mfma_f32_16x16x32_bf16 v[72:75], a[80:83], v[36:39], v[72:75]
  ds_read_b128 v[28:31], v9 offset:16384
  v_mfma_f32_16x16x32_bf16 v[76:79], a[84:87], v[36:39], v[76:79]
  v_mul_f32 v123, s24, v123
  v_cvt_pk_bf16_f32 v141, v122, v123
  v_mfma_f32_16x16x32_bf16 v[88:91], a[88:91], v[36:39], v[88:91]
  v_mfma_f32_16x16x32_bf16 v[92:95], a[92:95], v[36:39], v[92:95]
  s_waitcnt lgkmcnt(5)
  v_mul_f32 v124, s24, v124
  v_mul_f32 v125, s24, v125
  v_mfma_f32_16x16x32_bf16 v[64:67], a[96:99], v[40:43], v[64:67]
  s_add_u32 m0, s25, 6144
  ds_read_b128 v[32:35], v10 offset:16384
  v_mfma_f32_16x16x32_bf16 v[68:71], a[100:103], v[40:43], v[68:71]
  v_cvt_pk_bf16_f32 v142, v124, v125
  v_mul_f32 v126, s24, v126
  v_mfma_f32_16x16x32_bf16 v[80:83], a[104:107], v[40:43], v[80:83]
  buffer_load_dwordx4 v22, s[12:15], s19 offen lds
  v_mfma_f32_16x16x32_bf16 v[84:87], a[108:111], v[40:43], v[84:87]
  s_waitcnt lgkmcnt(5)
  v_mul_f32 v127, s24, v127
  v_cvt_pk_bf16_f32 v143, v126, v127
  v_mfma_f32_16x16x32_bf16 v[72:75], a[96:99], v[44:47], v[72:75]
  ds_read_b128 v[36:39], v11 offset:16384
  v_mfma_f32_16x16x32_bf16 v[76:79], a[100:103], v[44:47], v[76:79]
  v_mfma_f32_16x16x32_bf16 v[88:91], a[104:107], v[44:47], v[88:91]
  v_mfma_f32_16x16x32_bf16 v[92:95], a[108:111], v[44:47], v[92:95]
  s_waitcnt lgkmcnt(5)
  v_mfma_f32_16x16x32_bf16 v[64:67], a[112:115], v[48:51], v[64:67]
  s_add_u32 m0, s25, 7168
  ds_read_b128 v[40:43], v12 offset:16384
  v_mfma_f32_16x16x32_bf16 v[68:71], a[116:119], v[48:51], v[68:71]
  v_mfma_f32_16x16x32_bf16 v[80:83], a[120:123], v[48:51], v[80:83]
  buffer_load_dwordx4 v23, s[12:15], s19 offen lds
  v_mfma_f32_16x16x32_bf16 v[84:87], a[124:127], v[48:51], v[84:87]
  s_waitcnt lgkmcnt(5)
  v_mfma_f32_16x16x32_bf16 v[72:75], a[112:115], v[52:55], v[72:75]
  s_cmp_gt_u32 s23, 3
  ds_read_b128 v[44:47], v13 offset:16384
  v_mfma_f32_16x16x32_bf16 v[76:79], a[116:119], v[52:55], v[76:79]
  v_mfma_f32_16x16x32_bf16 v[88:91], a[120:123], v[52:55], v[88:91]
  s_cselect_b32 s26, s20, 0
  v_mfma_f32_16x16x32_bf16 v[92:95], a[124:127], v[52:55], v[92:95]
  s_waitcnt lgkmcnt(5)
  v_mfma_f32_16x16x32_bf16 v[64:67], a[128:131], v[24:27], v[64:67]
  s_add_u32 s19, s19, s26
  ds_read_b128 v[48:51], v14 offset:16384
  v_mfma_f32_16x16x32_bf16 v[68:71], a[132:135], v[24:27], v[68:71]
  v_mfma_f32_16x16x32_bf16 v[80:83], a[136:139], v[24:27], v[80:83]
  s_add_u32 s25, s25, 32768
  v_mfma_f32_16x16x32_bf16 v[84:87], a[140:143], v[24:27], v[84:87]
  s_waitcnt lgkmcnt(5)
  v_mfma_f32_16x16x32_bf16 v[72:75], a[128:131], v[28:31], v[72:75]
  s_and_b32 s25, s25, 0x1ffff
  ds_read_b128 v[52:55], v15 offset:16384
  v_mfma_f32_16x16x32_bf16 v[76:79], a[132:135], v[28:31], v[76:79]
  v_mfma_f32_16x16x32_bf16 v[88:91], a[136:139], v[28:31], v[88:91]
  buffer_store_dwordx4 v[128:131], v7, s[4:7], s21 offen offset:0 sc1
  v_mfma_f32_16x16x32_bf16 v[92:95], a[140:143], v[28:31], v[92:95]
  s_waitcnt lgkmcnt(5)
  v_mfma_f32_16x16x32_bf16 v[64:67], a[144:147], v[32:35], v[64:67]
  ds_read_b128 v[24:27], v8 offset:24576
  v_mfma_f32_16x16x32_bf16 v[68:71], a[148:151], v[32:35], v[68:71]
  v_mfma_f32_16x16x32_bf16 v[80:83], a[152:155], v[32:35], v[80:83]
  v_mfma_f32_16x16x32_bf16 v[84:87], a[156:159], v[32:35], v[84:87]
  s_waitcnt lgkmcnt(5)
  v_mfma_f32_16x16x32_bf16 v[72:75], a[144:147], v[36:39], v[72:75]
  ds_read_b128 v[28:31], v9 offset:24576
  v_mfma_f32_16x16x32_bf16 v[76:79], a[148:151], v[36:39], v[76:79]
  v_mfma_f32_16x16x32_bf16 v[88:91], a[152:155], v[36:39], v[88:91]
  buffer_store_dwordx4 v[132:135], v7, s[4:7], s21 offen offset:256 sc1
  v_mfma_f32_16x16x32_bf16 v[92:95], a[156:159], v[36:39], v[92:95]
  s_waitcnt lgkmcnt(5)
  v_mfma_f32_16x16x32_bf16 v[64:67], a[160:163], v[40:43], v[64:67]
  ds_read_b128 v[32:35], v10 offset:24576
  v_mfma_f32_16x16x32_bf16 v[68:71], a[164:167], v[40:43], v[68:71]
  v_mfma_f32_16x16x32_bf16 v[80:83], a[168:171], v[40:43], v[80:83]
  v_mfma_f32_16x16x32_bf16 v[84:87], a[172:175], v[40:43], v[84:87]
  s_waitcnt lgkmcnt(5)
  v_mfma_f32_16x16x32_bf16 v[72:75], a[160:163], v[44:47], v[72:75]
  ds_read_b128 v[36:39], v11 offset:24576
  v_mfma_f32_16x16x32_bf16 v[76:79], a[164:167], v[44:47], v[76:79]
  v_mfma_f32_16x16x32_bf16 v[88:91], a[168:171], v[44:47], v[88:91]
  buffer_store_dwordx4 v[136:139], v7, s[4:7], s21 offen offset:2048 sc1
  v_mfma_f32_16x16x32_bf16 v[92:95], a[172:175], v[44:47], v[92:95]
  s_waitcnt lgkmcnt(5)
  v_mfma_f32_16x16x32_bf16 v[64:67], a[176:179], v[48:51], v[64:67]
  ds_read_b128 v[40:43], v12 offset:24576
  v_mfma_f32_16x16x32_bf16 v[68:71], a[180:183], v[48:51], v[68:71]
  v_mfma_f32_16x16x32_bf16 v[80:83], a[184:187], v[48:51], v[80:83]
  v_mfma_f32_16x16x32_bf16 v[84:87], a[188:191], v[48:51], v[84:87]
  s_waitcnt lgkmcnt(5)
  v_mfma_f32_16x16x32_bf16 v[72:75], a[176:179], v[52:55], v[72:75]
  ds_read_b128 v[44:47], v13 offset:24576
  v_mfma_f32_16x16x32_bf16 v[76:79], a[180:183], v[52:55], v[76:79]
  v_mfma_f32_16x16x32_bf16 v[88:91], a[184:187], v[52:55], v[88:91]
  buffer_store_dwordx4 v[140:143], v7, s[4:7], s21 offen offset:2304 sc1
  v_mfma_f32_16x16x32_bf16 v[92:95], a[188:191], v[52:55], v[92:95]
  s_waitcnt lgkmcnt(5)
  v_mfma_f32_16x16x32_bf16 v[64:67], a[192:195], v[24:27], v[64:67]
  s_mov_b32 s21, s27
  ds_read_b128 v[48:51], v14 offset:24576
  v_mfma_f32_16x16x32_bf16 v[68:71], a[196:199], v[24:27], v[68:71]
  v_mov_b32 v7, v56
  v_mfma_f32_16x16x32_bf16 v[80:83], a[200:203], v[24:27], v[80:83]
  v_mfma_f32_16x16x32_bf16 v[84:87], a[204:207], v[24:27], v[84:87]
  s_waitcnt lgkmcnt(5)
  v_mfma_f32_16x16x32_bf16 v[72:75], a[192:195], v[28:31], v[72:75]
  s_add_u32 s27, s27, s22
  ds_read_b128 v[52:55], v15 offset:24576
  v_mfma_f32_16x16x32_bf16 v[76:79], a[196:199], v[28:31], v[76:79]
  v_mfma_f32_16x16x32_bf16 v[88:91], a[200:203], v[28:31], v[88:91]
  s_waitcnt vmcnt(13)
  s_barrier
  v_mfma_f32_16x16x32_bf16 v[92:95], a[204:207], v[28:31], v[92:95]
  s_waitcnt lgkmcnt(5)
  v_mfma_f32_16x16x32_bf16 v[64:67], a[208:211], v[32:35], v[64:67]
  ds_read_b128 v[24:27], v8 offset:32768
  v_mfma_f32_16x16x32_bf16 v[68:71], a[212:215], v[32:35], v[68:71]
  v_mfma_f32_16x16x32_bf16 v[80:83], a[216:219], v[32:35], v[80:83]
  v_mfma_f32_16x16x32_bf16 v[84:87], a[220:223], v[32:35], v[84:87]
  s_waitcnt lgkmcnt(5)
  v_mfma_f32_16x16x32_bf16 v[72:75], a[208:211], v[36:39], v[72:75]
  s_add_u32 s29, s29, 1
  ds_read_b128 v[28:31], v9 offset:32768
  v_mfma_f32_16x16x32_bf16 v[76:79], a[212:215], v[36:39], v[76:79]
  v_mfma_f32_16x16x32_bf16 v[88:91], a[216:219], v[36:39], v[88:91]
  s_max_i32 s30, s29, 0
  v_mfma_f32_16x16x32_bf16 v[92:95], a[220:223], v[36:39], v[92:95]
  s_waitcnt lgkmcnt(5)
  v_mov_b32 v144, s30
  v_mfma_f32_16x16x32_bf16 v[64:67], a[224:227], v[40:43], v[64:67]
  ds_read_b128 v[32:35], v10 offset:32768
  v_mfma_f32_16x16x32_bf16 v[68:71], a[228:231], v[40:43], v[68:71]
  v_mfma_f32_16x16x32_bf16 v[80:83], a[232:235], v[40:43], v[80:83]
  buffer_store_dword v144, v145, s[4:7], s31 offen sc1
  v_mfma_f32_16x16x32_bf16 v[84:87], a[236:239], v[40:43], v[84:87]
  s_waitcnt lgkmcnt(5)
  v_mfma_f32_16x16x32_bf16 v[72:75], a[224:227], v[44:47], v[72:75]
  ds_read_b128 v[36:39], v11 offset:32768
  v_mfma_f32_16x16x32_bf16 v[76:79], a[228:231], v[44:47], v[76:79]
  v_mfma_f32_16x16x32_bf16 v[88:91], a[232:235], v[44:47], v[88:91]
  v_mfma_f32_16x16x32_bf16 v[92:95], a[236:239], v[44:47], v[92:95]
  s_waitcnt lgkmcnt(5)
  v_mfma_f32_16x16x32_bf16 v[64:67], a[240:243], v[48:51], v[64:67]
  s_sub_u32 s23, s23, 1
  ds_read_b128 v[40:43], v12 offset:32768
  v_mfma_f32_16x16x32_bf16 v[68:71], a[244:247], v[48:51], v[68:71]
  v_mfma_f32_16x16x32_bf16 v[80:83], a[248:251], v[48:51], v[80:83]
  v_mfma_f32_16x16x32_bf16 v[84:87], a[252:255], v[48:51], v[84:87]
  s_waitcnt lgkmcnt(5)
  v_mfma_f32_16x16x32_bf16 v[72:75], a[240:243], v[52:55], v[72:75]
  s_cmp_eq_u32 s23, 0
  ds_read_b128 v[44:47], v13 offset:32768
  v_mfma_f32_16x16x32_bf16 v[76:79], a[244:247], v[52:55], v[76:79]
  v_mfma_f32_16x16x32_bf16 v[88:91], a[248:251], v[52:55], v[88:91]
  v_mfma_f32_16x16x32_bf16 v[92:95], a[252:255], v[52:55], v[92:95]
  s_cbranch_scc1 G_done0_9
  s_waitcnt lgkmcnt(5)
  v_mfma_f32_16x16x32_bf16 v[96:99], a[0:3], v[24:27], 0
  s_add_u32 m0, s25, 0
  ds_read_b128 v[48:51], v14 offset:32768
  v_mfma_f32_16x16x32_bf16 v[100:103], a[4:7], v[24:27], 0
  v_mfma_f32_16x16x32_bf16 v[112:115], a[8:11], v[24:27], 0
  buffer_load_dwordx4 v16, s[12:15], s19 offen lds
  v_mfma_f32_16x16x32_bf16 v[116:119], a[12:15], v[24:27], 0
  s_waitcnt lgkmcnt(5)
  v_mfma_f32_16x16x32_bf16 v[104:107], a[0:3], v[28:31], 0
  ds_read_b128 v[52:55], v15 offset:32768
  v_mfma_f32_16x16x32_bf16 v[108:111], a[4:7], v[28:31], 0
  v_mul_f32 v64, s24, v64
  v_mul_f32 v65, s24, v65
  v_mfma_f32_16x16x32_bf16 v[120:123], a[8:11], v[28:31], 0
  v_mfma_f32_16x16x32_bf16 v[124:127], a[12:15], v[28:31], 0
  s_waitcnt lgkmcnt(5)
  v_cvt_pk_bf16_f32 v128, v64, v65
  v_mul_f32 v66, s24, v66
  v_mfma_f32_16x16x32_bf16 v[96:99], a[16:19], v[32:35], v[96:99]
  s_add_u32 m0, s25, 1024
  ds_read_b128 v[24:27], v8 offset:40960
  v_mfma_f32_16x16x32_bf16 v[100:103], a[20:23], v[32:35], v[100:103]
  v_mul_f32 v67, s24, v67
  v_cvt_pk_bf16_f32 v129, v66, v67
  v_mfma_f32_16x16x32_bf16 v[112:115], a[24:27], v[32:35], v[112:115]
  buffer_load_dwordx4 v17, s[12:15], s19 offen lds
  v_mfma_f32_16x16x32_bf16 v[116:119], a[28:31], v[32:35], v[116:119]
  s_waitcnt lgkmcnt(5)
  v_mul_f32 v68, s24, v68
  v_mul_f32 v69, s24, v69
  v_mfma_f32_16x16x32_bf16 v[104:107], a[16:19], v[36:39], v[104:107]
  ds_read_b128 v[28:31], v9 offset:40960
  v_mfma_f32_16x16x32_bf16 v[108:111], a[20:23], v[36:39], v[108:111]
  v_cvt_pk_bf16_f32 v130, v68, v69
  v_mul_f32 v70, s24, v70
  v_mfma_f32_16x16x32_bf16 v[120:123], a[24:27], v[36:39], v[120:123]
  v_mfma_f32_16x16x32_bf16 v[124:127], a[28:31], v[36:39], v[124:127]
  s_waitcnt lgkmcnt(5)
  v_mul_f32 v71, s24, v71
  v_cvt_pk_bf16_f32 v131, v70, v71
  v_mfma_f32_16x16x32_bf16 v[96:99], a[32:35], v[40:43], v[96:99]
  s_add_u32 m0, s25, 2048
  ds_read_b128 v[32:35], v10 offset:40960
  v_mfma_f32_16x16x32_bf16 v[100:103], a[36:39], v[40:43], v[100:103]
  v_mul_f32 v72, s24, v72
  v_mul_f32 v73, s24, v73
  v_mfma_f32_16x16x32_bf16 v[112:115], a[40:43], v[40:43], v[112:115]
  buffer_load_dwordx4 v18, s[12:15], s19 offen lds
  v_mfma_f32_16x16x32_bf16 v[116:119], a[44:47], v[40:43], v[116:119]
  s_waitcnt lgkmcnt(5)
  v_cvt_pk_bf16_f32 v132, v72, v73
  v_mul_f32 v74, s24, v74
  v_mfma_f32_16x16x32_bf16 v[104:107], a[32:35], v[44:47], v[104:107]
  ds_read_b128 v[36:39], v11 offset:40960
  v_mfma_f32_16x16x32_bf16 v[108:111], a[36:39], v[44:47], v[108:111]
  v_mul_f32 v75, s24, v75
  v_cvt_pk_bf16_f32 v133, v74, v75
  v_mfma_f32_16x16x32_bf16 v[120:123], a[40:43], v[44:47], v[120:123]
  v_mfma_f32_16x16x32_bf16 v[124:127], a[44:47], v[44:47], v[124:127]
  s_waitcnt lgkmcnt(5)
  v_mul_f32 v76, s24, v76
  v_mul_f32 v77, s24, v77
  v_mfma_f32_16x16x32_bf16 v[96:99], a[48:51], v[48:51], v[96:99]
  s_add_u32 m0, s25, 3072
  ds_read_b128 v[40:43], v12 offset:40960
  v_mfma_f32_16x16x32_bf16 v[100:103], a[52:55], v[48:51], v[100:103]
  v_cvt_pk_bf16_f32 v134, v76, v77
  v_mul_f32 v78, s24, v78
  v_mfma_f32_16x16x32_bf16 v[112:115], a[56:59], v[48:51], v[112:115]
  buffer_load_dwordx4 v19, s[12:15], s19 offen lds
  v_mfma_f32_16x16x32_bf16 v[116:119], a[60:63], v[48:51], v[116:119]
  s_waitcnt lgkmcnt(5)
  v_mul_f32 v79, s24, v79
  v_cvt_pk_bf16_f32 v135, v78, v79
  v_mfma_f32_16x16x32_bf16 v[104:107], a[48:51], v[52:55], v[104:107]
  ds_read_b128 v[44:47], v13 offset:40960
  v_mfma_f32_16x16x32_bf16 v[108:111], a[52:55], v[52:55], v[108:111]
  v_mul_f32 v80, s24, v80
  v_mul_f32 v81, s24, v81
  v_mfma_f32_16x16x32_bf16 v[120:123], a[56:59], v[52:55], v[120:123]
  v_mfma_f32_16x16x32_bf16 v[124:127], a[60:63], v[52:55], v[124:127]
  s_waitcnt lgkmcnt(5)
  v_cvt_pk_bf16_f32 v136, v80, v81
  v_mul_f32 v82, s24, v82
  v_mfma_f32_16x16x32_bf16 v[96:99], a[64:67], v[24:27], v[96:99]
  s_add_u32 m0, s25, 4096
  ds_read_b128 v[48:51], v14 offset:40960
  v_mfma_f32_16x16x32_bf16 v[100:103], a[68:71], v[24:27], v[100:103]
  v_mul_f32 v83, s24, v83
  v_cvt_pk_bf16_f32 v137, v82, v83
  v_mfma_f32_16x16x32_bf16 v[112:115], a[72:75], v[24:27], v[112:115]
  buffer_load_dwordx4 v20, s[12:15], s19 offen lds
  v_mfma_f32_16x16x32_bf16 v[116:119], a[76:79], v[24:27], v[116:119]
  s_waitcnt lgkmcnt(5)
  v_mul_f32 v84, s24, v84
  v_mul_f32 v85, s24, v85
  v_mfma_f32_16x16x32_bf16 v[104:107], a[64:67], v[28:31], v[104:107]
  ds_read_b128 v[52:55], v15 offset:40960
  v_mfma_f32_16x16x32_bf16 v[108:111], a[68:71], v[28:31], v[108:111]
  v_cvt_pk_bf16_f32 v138, v84, v85
  v_mul_f32 v86, s24, v86
  v_mfma_f32_16x16x32_bf16 v[120:123], a[72:75], v[28:31], v[120:123]
  v_mfma_f32_16x16x32_bf16 v[124:127], a[76:79], v[28:31], v[124:127]
  s_waitcnt lgkmcnt(5)
  v_mul_f32 v87, s24, v87
  v_cvt_pk_bf16_f32 v139, v86, v87
  v_mfma_f32_16x16x32_bf16 v[96:99], a[80:83], v[32:35], v[96:99]
  s_add_u32 m0, s25, 5120
  ds_read_b128 v[24:27], v8 offset:49152
  v_mfma_f32_16x16x32_bf16 v[100:103], a[84:87], v[32:35], v[100:103]
  v_mul_f32 v88, s24, v88
  v_mul_f32 v89, s24, v89
  v_mfma_f32_16x16x32_bf16 v[112:115], a[88:91], v[32:35], v[112:115]
  buffer_load_dwordx4 v21, s[12:15], s19 offen lds
  v_mfma_f32_16x16x32_bf16 v[116:119], a[92:95], v[32:35], v[116:119]
  s_waitcnt lgkmcnt(5)
  v_cvt_pk_bf16_f32 v140, v88, v89
  v_mul_f32 v90, s24, v90
  v_mfma_f32_16x16x32_bf16 v[104:107], a[80:83], v[36:39], v[104:107]
  ds_read_b128 v[28:31], v9 offset:49152
  v_mfma_f32_16x16x32_bf16 v[108:111], a[84:87], v[36:39], v[108:111]
  v_mul_f32 v91, s24, v91
  v_cvt_pk_bf16_f32 v141, v90, v91
  v_mfma_f32_16x16x32_bf16 v[120:123], a[88:91], v[36:39], v[120:123]
  v_mfma_f32_16x16x32_bf16 v[124:127], a[92:95], v[36:39], v[124:127]
  s_waitcnt lgkmcnt(5)
  v_mul_f32 v92, s24, v92
  v_mul_f32 v93, s24, v93
  v_mfma_f32_16x16x32_bf16 v[96:99], a[96:99], v[40:43], v[96:99]
  s_add_u32 m0, s25, 6144
  ds_read_b128 v[32:35], v10 offset:49152
  v_mfma_f32_16x16x32_bf16 v[100:103], a[100:103], v[40:43], v[100:103]
  v_cvt_pk_bf16_f32 v142, v92, v93
  v_mul_f32 v94, s24, v94
  v_mfma_f32_16x16x32_bf16 v[112:115], a[104:107], v[40:43], v[112:115]
  buffer_load_dwordx4 v22, s[12:15], s19 offen lds
  v_mfma_f32_16x16x32_bf16 v[116:119], a[108:111], v[40:43], v[116:119]
  s_waitcnt lgkmcnt(5)
  v_mul_f32 v95, s24, v95
  v_cvt_pk_bf16_f32 v143, v94, v95
  v_mfma_f32_16x16x32_bf16 v[104:107], a[96:99], v[44:47], v[104:107]
  ds_read_b128 v[36:39], v11 offset:49152
  v_mfma_f32_16x16x32_bf16 v[108:111], a[100:103], v[44:47], v[108:111]
  v_mfma_f32_16x16x32_bf16 v[120:123], a[104:107], v[44:47], v[120:123]
  v_mfma_f32_16x16x32_bf16 v[124:127], a[108:111], v[44:47], v[124:127]
  s_waitcnt lgkmcnt(5)
  v_mfma_f32_16x16x32_bf16 v[96:99], a[112:115], v[48:51], v[96:99]
  s_add_u32 m0, s25, 7168
  ds_read_b128 v[40:43], v12 offset:49152
  v_mfma_f32_16x16x32_bf16 v[100:103], a[116:119], v[48:51], v[100:103]
  v_mfma_f32_16x16x32_bf16 v[112:115], a[120:123], v[48:51], v[112:115]
  buffer_load_dwordx4 v23, s[12:15], s19 offen lds
  v_mfma_f32_16x16x32_bf16 v[116:119], a[124:127], v[48:51], v[116:119]
  s_waitcnt lgkmcnt(5)
  v_mfma_f32_16x16x32_bf16 v[104:107], a[112:115], v[52:55], v[104:107]
  s_cmp_gt_u32 s23, 3
  ds_read_b128 v[44:47], v13 offset:49152
  v_mfma_f32_16x16x32_bf16 v[108:111], a[116:119], v[52:55], v[108:111]
  v_mfma_f32_16x16x32_bf16 v[120:123], a[120:123], v[52:55], v[120:123]
  s_cselect_b32 s26, s20, 0
  v_mfma_f32_16x16x32_bf16 v[124:127], a[124:127], v[52:55], v[124:127]
  s_waitcnt lgkmcnt(5)
  v_mfma_f32_16x16x32_bf16 v[96:99], a[128:131], v[24:27], v[96:99]
  s_add_u32 s19, s19, s26
  ds_read_b128 v[48:51], v14 offset:49152
  v_mfma_f32_16x16x32_bf16 v[100:103], a[132:135], v[24:27], v[100:103]
  v_mfma_f32_16x16x32_bf16 v[112:115], a[136:139], v[24:27], v[112:115]
  s_add_u32 s25, s25, 32768
  v_mfma_f32_16x16x32_bf16 v[116:119], a[140:143], v[24:27], v[116:119]
  s_waitcnt lgkmcnt(5)
  v_mfma_f32_16x16x32_bf16 v[104:107], a[128:131], v[28:31], v[104:107]
  s_and_b32 s25, s25, 0x1ffff
  ds_read_b128 v[52:55], v15 offset:49152
  v_mfma_f32_16x16x32_bf16 v[108:111], a[132:135], v[28:31], v[108:111]
  v_mfma_f32_16x16x32_bf16 v[120:123], a[136:139], v[28:31], v[120:123]
  buffer_store_dwordx4 v[128:131], v7, s[4:7], s21 offen offset:0 sc1
  v_mfma_f32_16x16x32_bf16 v[124:127], a[140:143], v[28:31], v[124:127]
  s_waitcnt lgkmcnt(5)
  v_mfma_f32_16x16x32_bf16 v[96:99], a[144:147], v[32:35], v[96:99]
  ds_read_b128 v[24:27], v8 offset:57344
  v_mfma_f32_16x16x32_bf16 v[100:103], a[148:151], v[32:35], v[100:103]
  v_mfma_f32_16x16x32_bf16 v[112:115], a[152:155], v[32:35], v[112:115]
  v_mfma_f32_16x16x32_bf16 v[116:119], a[156:159], v[32:35], v[116:119]
  s_waitcnt lgkmcnt(5)
  v_xor_b32 v8, 0x10000, v8
  v_mfma_f32_16x16x32_bf16 v[104:107], a[144:147], v[36:39], v[104:107]
  ds_read_b128 v[28:31], v9 offset:57344
  v_mfma_f32_16x16x32_bf16 v[108:111], a[148:151], v[36:39], v[108:111]
  v_mfma_f32_16x16x32_bf16 v[120:123], a[152:155], v[36:39], v[120:123]
  buffer_store_dwordx4 v[132:135], v7, s[4:7], s21 offen offset:256 sc1
  v_mfma_f32_16x16x32_bf16 v[124:127], a[156:159], v[36:39], v[124:127]
  s_waitcnt lgkmcnt(5)
  v_xor_b32 v9, 0x10000, v9
  v_mfma_f32_16x16x32_bf16 v[96:99], a[160:163], v[40:43], v[96:99]
  ds_read_b128 v[32:35], v10 offset:57344
  v_mfma_f32_16x16x32_bf16 v[100:103], a[164:167], v[40:43], v[100:103]
  v_mfma_f32_16x16x32_bf16 v[112:115], a[168:171], v[40:43], v[112:115]
  v_mfma_f32_16x16x32_bf16 v[116:119], a[172:175], v[40:43], v[116:119]
  s_waitcnt lgkmcnt(5)
  v_xor_b32 v10, 0x10000, v10
  v_mfma_f32_16x16x32_bf16 v[104:107], a[160:163], v[44:47], v[104:107]
  ds_read_b128 v[36:39], v11 offset:57344
  v_mfma_f32_16x16x32_bf16 v[108:111], a[164:167], v[44:47], v[108:111]
  v_mfma_f32_16x16x32_bf16 v[120:123], a[168:171], v[44:47], v[120:123]
  buffer_store_dwordx4 v[136:139], v7, s[4:7], s21 offen offset:2048 sc1
  v_mfma_f32_16x16x32_bf16 v[124:127], a[172:175], v[44:47], v[124:127]
  s_waitcnt lgkmcnt(5)
  v_xor_b32 v11, 0x10000, v11
  v_mfma_f32_16x16x32_bf16 v[96:99], a[176:179], v[48:51], v[96:99]
  ds_read_b128 v[40:43], v12 offset:57344
  v_mfma_f32_16x16x32_bf16 v[100:103], a[180:183], v[48:51], v[100:103]
  v_mfma_f32_16x16x32_bf16 v[112:115], a[184:187], v[48:51], v[112:115]
  v_mfma_f32_16x16x32_bf16 v[116:119], a[188:191], v[48:51], v[116:119]
  s_waitcnt lgkmcnt(5)
  v_xor_b32 v12, 0x10000, v12
  v_mfma_f32_16x16x32_bf16 v[104:107], a[176:179], v[52:55], v[104:107]
  ds_read_b128 v[44:47], v13 offset:57344
  v_mfma_f32_16x16x32_bf16 v[108:111], a[180:183], v[52:55], v[108:111]
  v_mfma_f32_16x16x32_bf16 v[120:123], a[184:187], v[52:55], v[120:123]
  buffer_store_dwordx4 v[140:143], v7, s[4:7], s21 offen offset:2304 sc1
  v_mfma_f32_16x16x32_bf16 v[124:127], a[188:191], v[52:55], v[124:127]
  s_waitcnt lgkmcnt(5)
  v_xor_b32 v13, 0x10000, v13
  v_mfma_f32_16x16x32_bf16 v[96:99], a[192:195], v[24:27], v[96:99]
  s_mov_b32 s21, s27
  ds_read_b128 v[48:51], v14 offset:57344
  v_mfma_f32_16x16x32_bf16 v[100:103], a[196:199], v[24:27], v[100:103]
  v_mov_b32 v7, v56
  v_mfma_f32_16x16x32_bf16 v[112:115], a[200:203], v[24:27], v[112:115]
  v_mfma_f32_16x16x32_bf16 v[116:119], a[204:207], v[24:27], v[116:119]
  s_waitcnt lgkmcnt(5)
  v_xor_b32 v14, 0x10000, v14
  v_mfma_f32_16x16x32_bf16 v[104:107], a[192:195], v[28:31], v[104:107]
  s_add_u32 s27, s27, s22
  ds_read_b128 v[52:55], v15 offset:57344
  v_mfma_f32_16x16x32_bf16 v[108:111], a[196:199], v[28:31], v[108:111]
  v_mfma_f32_16x16x32_bf16 v[120:123], a[200:203], v[28:31], v[120:123]
  s_waitcnt vmcnt(13)
  s_barrier
  v_mfma_f32_16x16x32_bf16 v[124:127], a[204:207], v[28:31], v[124:127]
  s_waitcnt lgkmcnt(5)
  v_xor_b32 v15, 0x10000, v15
  v_mfma_f32_16x16x32_bf16 v[96:99], a[208:211], v[32:35], v[96:99]
  ds_read_b128 v[24:27], v8 offset:0
  v_mfma_f32_16x16x32_bf16 v[100:103], a[212:215], v[32:35], v[100:103]
  v_mfma_f32_16x16x32_bf16 v[112:115], a[216:219], v[32:35], v[112:115]
  v_mfma_f32_16x16x32_bf16 v[116:119], a[220:223], v[32:35], v[116:119]
  s_waitcnt lgkmcnt(5)
  v_mfma_f32_16x16x32_bf16 v[104:107], a[208:211], v[36:39], v[104:107]
  s_add_u32 s29, s29, 1
  ds_read_b128 v[28:31], v9 offset:0
  v_mfma_f32_16x16x32_bf16 v[108:111], a[212:215], v[36:39], v[108:111]
  v_mfma_f32_16x16x32_bf16 v[120:123], a[216:219], v[36:39], v[120:123]
  s_max_i32 s30, s29, 0
  v_mfma_f32_16x16x32_bf16 v[124:127], a[220:223], v[36:39], v[124:127]
  s_waitcnt lgkmcnt(5)
  v_mov_b32 v144, s30
  v_mfma_f32_16x16x32_bf16 v[96:99], a[224:227], v[40:43], v[96:99]
  ds_read_b128 v[32:35], v10 offset:0
  v_mfma_f32_16x16x32_bf16 v[100:103], a[228:231], v[40:43], v[100:103]
  v_mfma_f32_16x16x32_bf16 v[112:115], a[232:235], v[40:43], v[112:115]
  buffer_store_dword v144, v145, s[4:7], s31 offen sc1
  v_mfma_f32_16x16x32_bf16 v[116:119], a[236:239], v[40:43], v[116:119]
  s_waitcnt lgkmcnt(5)
  v_mfma_f32_16x16x32_bf16 v[104:107], a[224:227], v[44:47], v[104:107]
  ds_read_b128 v[36:39], v11 offset:0
  v_mfma_f32_16x16x32_bf16 v[108:111], a[228:231], v[44:47], v[108:111]
  v_mfma_f32_16x16x32_bf16 v[120:123], a[232:235], v[44:47], v[120:123]
  v_mfma_f32_16x16x32_bf16 v[124:127], a[236:239], v[44:47], v[124:127]
  s_waitcnt lgkmcnt(5)
  v_mfma_f32_16x16x32_bf16 v[96:99], a[240:243], v[48:51], v[96:99]
  s_sub_u32 s23, s23, 1
  ds_read_b128 v[40:43], v12 offset:0
  v_mfma_f32_16x16x32_bf16 v[100:103], a[244:247], v[48:51], v[100:103]
  v_mfma_f32_16x16x32_bf16 v[112:115], a[248:251], v[48:51], v[112:115]
  v_mfma_f32_16x16x32_bf16 v[116:119], a[252:255], v[48:51], v[116:119]
  s_waitcnt lgkmcnt(5)
  v_mfma_f32_16x16x32_bf16 v[104:107], a[240:243], v[52:55], v[104:107]
  s_cmp_eq_u32 s23, 0
  ds_read_b128 v[44:47], v13 offset:0
  v_mfma_f32_16x16x32_bf16 v[108:111], a[244:247], v[52:55], v[108:111]
  v_mfma_f32_16x16x32_bf16 v[120:123], a[248:251], v[52:55], v[120:123]
  v_mfma_f32_16x16x32_bf16 v[124:127], a[252:255], v[52:55], v[124:127]
  s_cbranch_scc1 G_done1_10
  s_branch G_top_8
G_done0_9:
  s_nop 7
  s_nop 3
  v_mul_f32 v64, s24, v64
  v_mul_f32 v65, s24, v65
  v_cvt_pk_bf16_f32 v128, v64, v65
  v_mul_f32 v66, s24, v66
  v_mul_f32 v67, s24, v67
  v_cvt_pk_bf16_f32 v129, v66, v67
  v_mul_f32 v68, s24, v68
  v_mul_f32 v69, s24, v69
  v_cvt_pk_bf16_f32 v130, v68, v69
  v_mul_f32 v70, s24, v70
  v_mul_f32 v71, s24, v71
  v_cvt_pk_bf16_f32 v131, v70, v71
  buffer_store_dwordx4 v[128:131], v7, s[4:7], s21 offen offset:0 sc1
  v_mul_f32 v72, s24, v72
  v_mul_f32 v73, s24, v73
  v_cvt_pk_bf16_f32 v132, v72, v73
  v_mul_f32 v74, s24, v74
  v_mul_f32 v75, s24, v75
  v_cvt_pk_bf16_f32 v133, v74, v75
  v_mul_f32 v76, s24, v76
  v_mul_f32 v77, s24, v77
  v_cvt_pk_bf16_f32 v134, v76, v77
  v_mul_f32 v78, s24, v78
  v_mul_f32 v79, s24, v79
  v_cvt_pk_bf16_f32 v135, v78, v79
  buffer_store_dwordx4 v[132:135], v7, s[4:7], s21 offen offset:256 sc1
  v_mul_f32 v80, s24, v80
  v_mul_f32 v81, s24, v81
  v_cvt_pk_bf16_f32 v136, v80, v81
  v_mul_f32 v82, s24, v82
  v_mul_f32 v83, s24, v83
  v_cvt_pk_bf16_f32 v137, v82, v83
  v_mul_f32 v84, s24, v84
  v_mul_f32 v85, s24, v85
  v_cvt_pk_bf16_f32 v138, v84, v85
  v_mul_f32 v86, s24, v86
  v_mul_f32 v87, s24, v87
  v_cvt_pk_bf16_f32 v139, v86, v87
  buffer_store_dwordx4 v[136:139], v7, s[4:7], s21 offen offset:2048 sc1
  v_mul_f32 v88, s24, v88
  v_mul_f32 v89, s24, v89
  v_cvt_pk_bf16_f32 v140, v88, v89
  v_mul_f32 v90, s24, v90
  v_mul_f32 v91, s24, v91
  v_cvt_pk_bf16_f32 v141, v90, v91
  v_mul_f32 v92, s24, v92
  v_mul_f32 v93, s24, v93
  v_cvt_pk_bf16_f32 v142, v92, v93
  v_mul_f32 v94, s24, v94
  v_mul_f32 v95, s24, v95
  v_cvt_pk_bf16_f32 v143, v94, v95
  buffer_store_dwordx4 v[140:143], v7, s[4:7], s21 offen offset:2304 sc1
  s_branch G_fin_11
G_done1_10:
  s_nop 7
  s_nop 3
  v_mul_f32 v96, s24, v96
  v_mul_f32 v97, s24, v97
  v_cvt_pk_bf16_f32 v128, v96, v97
  v_mul_f32 v98, s24, v98
  v_mul_f32 v99, s24, v99
  v_cvt_pk_bf16_f32 v129, v98, v99
  v_mul_f32 v100, s24, v100
  v_mul_f32 v101, s24, v101
  v_cvt_pk_bf16_f32 v130, v100, v101
  v_mul_f32 v102, s24, v102
  v_mul_f32 v103, s24, v103
  v_cvt_pk_bf16_f32 v131, v102, v103
  buffer_store_dwordx4 v[128:131], v7, s[4:7], s21 offen offset:0 sc1
  v_mul_f32 v104, s24, v104
  v_mul_f32 v105, s24, v105
  v_cvt_pk_bf16_f32 v132, v104, v105
  v_mul_f32 v106, s24, v106
  v_mul_f32 v107, s24, v107
  v_cvt_pk_bf16_f32 v133, v106, v107
  v_mul_f32 v108, s24, v108
  v_mul_f32 v109, s24, v109
  v_cvt_pk_bf16_f32 v134, v108, v109
  v_mul_f32 v110, s24, v110
  v_mul_f32 v111, s24, v111
  v_cvt_pk_bf16_f32 v135, v110, v111
  buffer_store_dwordx4 v[132:135], v7, s[4:7], s21 offen offset:256 sc1
  v_mul_f32 v112, s24, v112
  v_mul_f32 v113, s24, v113
  v_cvt_pk_bf16_f32 v136, v112, v113
  v_mul_f32 v114, s24, v114
  v_mul_f32 v115, s24, v115
  v_cvt_pk_bf16_f32 v137, v114, v115
  v_mul_f32 v116, s24, v116
  v_mul_f32 v117, s24, v117
  v_cvt_pk_bf16_f32 v138, v116, v117
  v_mul_f32 v118, s24, v118
  v_mul_f32 v119, s24, v119
  v_cvt_pk_bf16_f32 v139, v118, v119
  buffer_store_dwordx4 v[136:139], v7, s[4:7], s21 offen offset:2048 sc1
  v_mul_f32 v120, s24, v120
  v_mul_f32 v121, s24, v121
  v_cvt_pk_bf16_f32 v140, v120, v121
  v_mul_f32 v122, s24, v122
  v_mul_f32 v123, s24, v123
  v_cvt_pk_bf16_f32 v141, v122, v123
  v_mul_f32 v124, s24, v124
  v_mul_f32 v125, s24, v125
  v_cvt_pk_bf16_f32 v142, v124, v125
  v_mul_f32 v126, s24, v126
  v_mul_f32 v127, s24, v127
  v_cvt_pk_bf16_f32 v143, v126, v127
  buffer_store_dwordx4 v[140:143], v7, s[4:7], s21 offen offset:2304 sc1
G_fin_11:
  s_waitcnt vmcnt(0) lgkmcnt(0)
  s_barrier
  s_add_u32 s30, s29, 2
  v_mov_b32 v144, s30
  v_min_u32 v145, 1, v0
  v_lshlrev_b32 v145, 30, v145
  buffer_store_dword v144, v145, s[4:7], s31 offen sc1
  s_branch P_end_2
P_v_1:
  s_mov_b32 s27, s21
  v_mov_b32 v7, 0x40000000
  s_mov_b32 s29, -2
  v_min_u32 v145, 1, v0
  v_lshlrev_b32 v145, 30, v145
  ds_read_b128 v[24:27], v8 offset:0
  ds_read_b128 v[28:31], v9 offset:0
  ds_read_b128 v[32:35], v10 offset:0
  ds_read_b128 v[36:39], v11 offset:0
  ds_read_b128 v[40:43], v12 offset:0
  ds_read_b128 v[44:47], v13 offset:0
.p2align 6
G_top_12:
  s_waitcnt lgkmcnt(5)
  v_mfma_f32_16x16x32_bf16 v[64:67], v[24:27], a[0:3], 0
  s_add_u32 m0, s25, 0
  ds_read_b128 v[48:51], v14 offset:0
  v_mfma_f32_16x16x32_bf16 v[72:75], v[24:27], a[4:7], 0
  v_mfma_f32_16x16x32_bf16 v[80:83], v[24:27], a[8:11], 0
  buffer_load_dwordx4 v16, s[12:15], s19 offen lds
  v_mfma_f32_16x16x32_bf16 v[88:91], v[24:27], a[12:15], 0
  s_waitcnt lgkmcnt(5)
  v_mfma_f32_16x16x32_bf16 v[68:71], v[28:31], a[0:3], 0
  ds_read_b128 v[52:55], v15 offset:0
  v_mfma_f32_16x16x32_bf16 v[76:79], v[28:31], a[4:7], 0
  v_cvt_pk_bf16_f32 v128, v96, v97
  v_cvt_pk_bf16_f32 v129, v98, v99
  v_mfma_f32_16x16x32_bf16 v[84:87], v[28:31], a[8:11], 0
  v_mfma_f32_16x16x32_bf16 v[92:95], v[28:31], a[12:15], 0
  s_waitcnt lgkmcnt(5)
  v_cvt_pk_bf16_f32 v130, v100, v101
  v_cvt_pk_bf16_f32 v131, v102, v103
  v_mfma_f32_16x16x32_bf16 v[64:67], v[32:35], a[16:19], v[64:67]
  s_add_u32 m0, s25, 1024
  ds_read_b128 v[24:27], v8 offset:8192
  v_mfma_f32_16x16x32_bf16 v[72:75], v[32:35], a[20:23], v[72:75]
  v_mfma_f32_16x16x32_bf16 v[80:83], v[32:35], a[24:27], v[80:83]
  buffer_load_dwordx4 v17, s[12:15], s19 offen lds
  v_mfma_f32_16x16x32_bf16 v[88:91], v[32:35], a[28:31], v[88:91]
  s_waitcnt lgkmcnt(5)
  v_mfma_f32_16x16x32_bf16 v[68:71], v[36:39], a[16:19], v[68:71]
  ds_read_b128 v[28:31], v9 offset:8192
  v_mfma_f32_16x16x32_bf16 v[76:79], v[36:39], a[20:23], v[76:79]
  v_mfma_f32_16x16x32_bf16 v[84:87], v[36:39], a[24:27], v[84:87]
  v_mfma_f32_16x16x32_bf16 v[92:95], v[36:39], a[28:31], v[92:95]
  s_waitcnt lgkmcnt(5)
  v_mfma_f32_16x16x32_bf16 v[64:67], v[40:43], a[32:35], v[64:67]
  s_add_u32 m0, s25, 2048
  ds_read_b128 v[32:35], v10 offset:8192
  v_mfma_f32_16x16x32_bf16 v[72:75], v[40:43], a[36:39], v[72:75]
  v_cvt_pk_bf16_f32 v132, v104, v105
  v_cvt_pk_bf16_f32 v133, v106, v107
  v_mfma_f32_16x16x32_bf16 v[80:83], v[40:43], a[40:43], v[80:83]
  buffer_load_dwordx4 v18, s[12:15], s19 offen lds
  v_mfma_f32_16x16x32_bf16 v[88:91], v[40:43], a[44:47], v[88:91]
  s_waitcnt lgkmcnt(5)
  v_cvt_pk_bf16_f32 v134, v108, v109
  v_cvt_pk_bf16_f32 v135, v110, v111
  v_mfma_f32_16x16x32_bf16 v[68:71], v[44:47], a[32:35], v[68:71]
  ds_read_b128 v[36:39], v11 offset:8192
  v_mfma_f32_16x16x32_bf16 v[76:79], v[44:47], a[36:39], v[76:79]
  v_mfma_f32_16x16x32_bf16 v[84:87], v[44:47], a[40:43], v[84:87]
  v_mfma_f32_16x16x32_bf16 v[92:95], v[44:47], a[44:47], v[92:95]
  s_waitcnt lgkmcnt(5)
  v_mfma_f32_16x16x32_bf16 v[64:67], v[48:51], a[48:51], v[64:67]
  s_add_u32 m0, s25, 3072
  ds_read_b128 v[40:43], v12 offset:8192
  v_mfma_f32_16x16x32_bf16 v[72:75], v[48:51], a[52:55], v[72:75]
  v_mfma_f32_16x16x32_bf16 v[80:83], v[48:51], a[56:59], v[80:83]
  buffer_load_dwordx4 v19, s[12:15], s19 offen lds
  v_mfma_f32_16x16x32_bf16 v[88:91], v[48:51], a[60:63], v[88:91]
  s_waitcnt lgkmcnt(5)
  v_mfma_f32_16x16x32_bf16 v[68:71], v[52:55], a[48:51], v[68:71]
  ds_read_b128 v[44:47], v13 offset:8192
  v_mfma_f32_16x16x32_bf16 v[76:79], v[52:55], a[52:55], v[76:79]
  v_cvt_pk_bf16_f32 v136, v112, v113
  v_cvt_pk_bf16_f32 v137, v114, v115
  v_mfma_f32_16x16x32_bf16 v[84:87], v[52:55], a[56:59], v[84:87]
  v_mfma_f32_16x16x32_bf16 v[92:95], v[52:55], a[60:63], v[92:95]
  s_waitcnt lgkmcnt(5)
  v_cvt_pk_bf16_f32 v138, v116, v117
  v_cvt_pk_bf16_f32 v139, v118, v119
  v_mfma_f32_16x16x32_bf16 v[64:67], v[24:27], a[64:67], v[64:67]
  s_add_u32 m0, s25, 4096
  ds_read_b128 v[48:51], v14 offset:8192
  v_mfma_f32_16x16x32_bf16 v[72:75], v[24:27], a[68:71], v[72:75]
  v_mfma_f32_16x16x32_bf16 v[80:83], v[24:27], a[72:75], v[80:83]
  buffer_load_dwordx4 v20, s[12:15], s19 offen lds
  v_mfma_f32_16x16x32_bf16 v[88:91], v[24:27], a[76:79], v[88:91]
  s_waitcnt lgkmcnt(5)
  v_mfma_f32_16x16x32_bf16 v[68:71], v[28:31], a[64:67], v[68:71]
  ds_read_b128 v[52:55], v15 offset:8192
  v_mfma_f32_16x16x32_bf16 v[76:79], v[28:31], a[68:71], v[76:79]
  v_mfma_f32_16x16x32_bf16 v[84:87], v[28:31], a[72:75], v[84:87]
  v_mfma_f32_16x16x32_bf16 v[92:95], v[28:31], a[76:79], v[92:95]
  s_waitcnt lgkmcnt(5)
  v_mfma_f32_16x16x32_bf16 v[64:67], v[32:35], a[80:83], v[64:67]
  s_add_u32 m0, s25, 5120
  ds_read_b128 v[24:27], v8 offset:16384
  v_mfma_f32_16x16x32_bf16 v[72:75], v[32:35], a[84:87], v[72:75]
  v_cvt_pk_bf16_f32 v140, v120, v121
  v_cvt_pk_bf16_f32 v141, v122, v123
  v_mfma_f32_16x16x32_bf16 v[80:83], v[32:35], a[88:91], v[80:83]
  buffer_load_dwordx4 v21, s[12:15], s19 offen lds
  v_mfma_f32_16x16x32_bf16 v[88:91], v[32:35], a[92:95], v[88:91]
  s_waitcnt lgkmcnt(5)
  v_cvt_pk_bf16_f32 v142, v124, v125
  v_cvt_pk_bf16_f32 v143, v126, v127
  v_mfma_f32_16x16x32_bf16 v[68:71], v[36:39], a[80:83], v[68:71]
  ds_read_b128 v[28:31], v9 offset:16384
  v_mfma_f32_16x16x32_bf16 v[76:79], v[36:39], a[84:87], v[76:79]
  v_mfma_f32_16x16x32_bf16 v[84:87], v[36:39], a[88:91], v[84:87]
  v_mfma_f32_16x16x32_bf16 v[92:95], v[36:39], a[92:95], v[92:95]
  s_waitcnt lgkmcnt(5)
  v_mfma_f32_16x16x32_bf16 v[64:67], v[40:43], a[96:99], v[64:67]
  s_add_u32 m0, s25, 6144
  ds_read_b128 v[32:35], v10 offset:16384
  v_mfma_f32_16x16x32_bf16 v[72:75], v[40:43], a[100:103], v[72:75]
  v_mfma_f32_16x16x32_bf16 v[80:83], v[40:43], a[104:107], v[80:83]
  buffer_load_dwordx4 v22, s[12:15], s19 offen lds
  v_mfma_f32_16x16x32_bf16 v[88:91], v[40:43], a[108:111], v[88:91]
  s_waitcnt lgkmcnt(5)
  v_mfma_f32_16x16x32_bf16 v[68:71], v[44:47], a[96:99], v[68:71]
  ds_read_b128 v[36:39], v11 offset:16384
  v_mfma_f32_16x16x32_bf16 v[76:79], v[44:47], a[100:103], v[76:79]
  v_mfma_f32_16x16x32_bf16 v[84:87], v[44:47], a[104:107], v[84:87]
  v_mfma_f32_16x16x32_bf16 v[92:95], v[44:47], a[108:111], v[92:95]
  s_waitcnt lgkmcnt(5)
  v_mfma_f32_16x16x32_bf16 v[64:67], v[48:51], a[112:115], v[64:67]
  s_add_u32 m0, s25, 7168
  ds_read_b128 v[40:43], v12 offset:16384
  v_mfma_f32_16x16x32_bf16 v[72:75], v[48:51], a[116:119], v[72:75]
  v_mfma_f32_16x16x32_bf16 v[80:83], v[48:51], a[120:123], v[80:83]
  buffer_load_dwordx4 v23, s[12:15], s19 offen lds
  v_mfma_f32_16x16x32_bf16 v[88:91], v[48:51], a[124:127], v[88:91]
  s_waitcnt lgkmcnt(5)
  v_mfma_f32_16x16x32_bf16 v[68:71], v[52:55], a[112:115], v[68:71]
  s_cmp_gt_u32 s23, 3
  ds_read_b128 v[44:47], v13 offset:16384
  v_mfma_f32_16x16x32_bf16 v[76:79], v[52:55], a[116:119], v[76:79]
  v_mfma_f32_16x16x32_bf16 v[84:87], v[52:55], a[120:123], v[84:87]
  s_cselect_b32 s26, s20, 0
  v_mfma_f32_16x16x32_bf16 v[92:95], v[52:55], a[124:127], v[92:95]
  s_waitcnt lgkmcnt(5)
  v_mfma_f32_16x16x32_bf16 v[64:67], v[24:27], a[128:131], v[64:67]
  s_add_u32 s19, s19, s26
  ds_read_b128 v[48:51], v14 offset:16384
  v_mfma_f32_16x16x32_bf16 v[72:75], v[24:27], a[132:135], v[72:75]
  v_mfma_f32_16x16x32_bf16 v[80:83], v[24:27], a[136:139], v[80:83]
  s_add_u32 s25, s25, 32768
  v_mfma_f32_16x16x32_bf16 v[88:91], v[24:27], a[140:143], v[88:91]
  s_waitcnt lgkmcnt(5)
  v_mfma_f32_16x16x32_bf16 v[68:71], v[28:31], a[128:131], v[68:71]
  s_and_b32 s25, s25, 0x1ffff
  ds_read_b128 v[52:55], v15 offset:16384
  v_mfma_f32_16x16x32_bf16 v[76:79], v[28:31], a[132:135], v[76:79]
  v_mfma_f32_16x16x32_bf16 v[84:87], v[28:31], a[136:139], v[84:87]
  buffer_store_dwordx4 v[128:131], v7, s[4:7], s21 offen offset:0 sc1
  v_mfma_f32_16x16x32_bf16 v[92:95], v[28:31], a[140:143], v[92:95]
  s_waitcnt lgkmcnt(5)
  v_mfma_f32_16x16x32_bf16 v[64:67], v[32:35], a[144:147], v[64:67]
  ds_read_b128 v[24:27], v8 offset:24576
  v_mfma_f32_16x16x32_bf16 v[72:75], v[32:35], a[148:151], v[72:75]
  v_mfma_f32_16x16x32_bf16 v[80:83], v[32:35], a[152:155], v[80:83]
  v_mfma_f32_16x16x32_bf16 v[88:91], v[32:35], a[156:159], v[88:91]
  s_waitcnt lgkmcnt(5)
  v_mfma_f32_16x16x32_bf16 v[68:71], v[36:39], a[144:147], v[68:71]
  ds_read_b128 v[28:31], v9 offset:24576
  v_mfma_f32_16x16x32_bf16 v[76:79], v[36:39], a[148:151], v[76:79]
  v_mfma_f32_16x16x32_bf16 v[84:87], v[36:39], a[152:155], v[84:87]
  buffer_store_dwordx4 v[132:135], v7, s[4:7], s21 offen offset:256 sc1
  v_mfma_f32_16x16x32_bf16 v[92:95], v[36:39], a[156:159], v[92:95]
  s_waitcnt lgkmcnt(5)
  v_mfma_f32_16x16x32_bf16 v[64:67], v[40:43], a[160:163], v[64:67]
  ds_read_b128 v[32:35], v10 offset:24576
  v_mfma_f32_16x16x32_bf16 v[72:75], v[40:43], a[164:167], v[72:75]
  v_mfma_f32_16x16x32_bf16 v[80:83], v[40:43], a[168:171], v[80:83]
  v_mfma_f32_16x16x32_bf16 v[88:91], v[40:43], a[172:175], v[88:91]
  s_waitcnt lgkmcnt(5)
  v_mfma_f32_16x16x32_bf16 v[68:71], v[44:47], a[160:163], v[68:71]
  ds_read_b128 v[36:39], v11 offset:24576
  v_mfma_f32_16x16x32_bf16 v[76:79], v[44:47], a[164:167], v[76:79]
  v_mfma_f32_16x16x32_bf16 v[84:87], v[44:47], a[168:171], v[84:87]
  buffer_store_dwordx4 v[136:139], v7, s[4:7], s21 offen offset:2048 sc1
  v_mfma_f32_16x16x32_bf16 v[92:95], v[44:47], a[172:175], v[92:95]
  s_waitcnt lgkmcnt(5)
  v_mfma_f32_16x16x32_bf16 v[64:67], v[48:51], a[176:179], v[64:67]
  ds_read_b128 v[40:43], v12 offset:24576
  v_mfma_f32_16x16x32_bf16 v[72:75], v[48:51], a[180:183], v[72:75]
  v_mfma_f32_16x16x32_bf16 v[80:83], v[48:51], a[184:187], v[80:83]
  v_mfma_f32_16x16x32_bf16 v[88:91], v[48:51], a[188:191], v[88:91]
  s_waitcnt lgkmcnt(5)
  v_mfma_f32_16x16x32_bf16 v[68:71], v[52:55], a[176:179], v[68:71]
  ds_read_b128 v[44:47], v13 offset:24576
  v_mfma_f32_16x16x32_bf16 v[76:79], v[52:55], a[180:183], v[76:79]
  v_mfma_f32_16x16x32_bf16 v[84:87], v[52:55], a[184:187], v[84:87]
  buffer_store_dwordx4 v[140:143], v7, s[4:7], s21 offen offset:2304 sc1
  v_mfma_f32_16x16x32_bf16 v[92:95], v[52:55], a[188:191], v[92:95]
  s_waitcnt lgkmcnt(5)
  v_mfma_f32_16x16x32_bf16 v[64:67], v[24:27], a[192:195], v[64:67]
  s_mov_b32 s21, s27
  ds_read_b128 v[48:51], v14 offset:24576
  v_mfma_f32_16x16x32_bf16 v[72:75], v[24:27], a[196:199], v[72:75]
  v_mov_b32 v7, v56
  v_mfma_f32_16x16x32_bf16 v[80:83], v[24:27], a[200:203], v[80:83]
  v_mfma_f32_16x16x32_bf16 v[88:91], v[24:27], a[204:207], v[88:91]
  s_waitcnt lgkmcnt(5)
  v_mfma_f32_16x16x32_bf16 v[68:71], v[28:31], a[192:195], v[68:71]
  s_add_u32 s27, s27, s22
  ds_read_b128 v[52:55], v15 offset:24576
  v_mfma_f32_16x16x32_bf16 v[76:79], v[28:31], a[196:199], v[76:79]
  v_mfma_f32_16x16x32_bf16 v[84:87], v[28:31], a[200:203], v[84:87]
  s_waitcnt vmcnt(13)
  s_barrier
  v_mfma_f32_16x16x32_bf16 v[92:95], v[28:31], a[204:207], v[92:95]
  s_waitcnt lgkmcnt(5)
  v_mfma_f32_16x16x32_bf16 v[64:67], v[32:35], a[208:211], v[64:67]
  ds_read_b128 v[24:27], v8 offset:32768
  v_mfma_f32_16x16x32_bf16 v[72:75], v[32:35], a[212:215], v[72:75]
  v_mfma_f32_16x16x32_bf16 v[80:83], v[32:35], a[216:219], v[80:83]
  v_mfma_f32_16x16x32_bf16 v[88:91], v[32:35], a[220:223], v[88:91]
  s_waitcnt lgkmcnt(5)
  v_mfma_f32_16x16x32_bf16 v[68:71], v[36:39], a[208:211], v[68:71]
  s_add_u32 s29, s29, 1
  ds_read_b128 v[28:31], v9 offset:32768
  v_mfma_f32_16x16x32_bf16 v[76:79], v[36:39], a[212:215], v[76:79]
  v_mfma_f32_16x16x32_bf16 v[84:87], v[36:39], a[216:219], v[84:87]
  s_max_i32 s30, s29, 0
  v_mfma_f32_16x16x32_bf16 v[92:95], v[36:39], a[220:223], v[92:95]
  s_waitcnt lgkmcnt(5)
  v_mov_b32 v144, s30
  v_mfma_f32_16x16x32_bf16 v[64:67], v[40:43], a[224:227], v[64:67]
  ds_read_b128 v[32:35], v10 offset:32768
  v_mfma_f32_16x16x32_bf16 v[72:75], v[40:43], a[228:231], v[72:75]
  v_mfma_f32_16x16x32_bf16 v[80:83], v[40:43], a[232:235], v[80:83]
  buffer_store_dword v144, v145, s[4:7], s31 offen sc1
  v_mfma_f32_16x16x32_bf16 v[88:91], v[40:43], a[236:239], v[88:91]
  s_waitcnt lgkmcnt(5)
  v_mfma_f32_16x16x32_bf16 v[68:71], v[44:47], a[224:227], v[68:71]
  ds_read_b128 v[36:39], v11 offset:32768
  v_mfma_f32_16x16x32_bf16 v[76:79], v[44:47], a[228:231], v[76:79]
  v_mfma_f32_16x16x32_bf16 v[84:87], v[44:47], a[232:235], v[84:87]
  v_mfma_f32_16x16x32_bf16 v[92:95], v[44:47], a[236:239], v[92:95]
  s_waitcnt lgkmcnt(5)
  v_mfma_f32_16x16x32_bf16 v[64:67], v[48:51], a[240:243], v[64:67]
  s_sub_u32 s23, s23, 1
  ds_read_b128 v[40:43], v12 offset:32768
  v_mfma_f32_16x16x32_bf16 v[72:75], v[48:51], a[244:247], v[72:75]
  v_mfma_f32_16x16x32_bf16 v[80:83], v[48:51], a[248:251], v[80:83]
  v_mfma_f32_16x16x32_bf16 v[88:91], v[48:51], a[252:255], v[88:91]
  s_waitcnt lgkmcnt(5)
  v_mfma_f32_16x16x32_bf16 v[68:71], v[52:55], a[240:243], v[68:71]
  s_cmp_eq_u32 s23, 0
  ds_read_b128 v[44:47], v13 offset:32768
  v_mfma_f32_16x16x32_bf16 v[76:79], v[52:55], a[244:247], v[76:79]
  v_mfma_f32_16x16x32_bf16 v[84:87], v[52:55], a[248:251], v[84:87]
  v_mfma_f32_16x16x32_bf16 v[92:95], v[52:55], a[252:255], v[92:95]
  s_cbranch_scc1 G_done0_13
  s_waitcnt lgkmcnt(5)
  v_mfma_f32_16x16x32_bf16 v[96:99], v[24:27], a[0:3], 0
  s_add_u32 m0, s25, 0
  ds_read_b128 v[48:51], v14 offset:32768
  v_mfma_f32_16x16x32_bf16 v[104:107], v[24:27], a[4:7], 0
  v_mfma_f32_16x16x32_bf16 v[112:115], v[24:27], a[8:11], 0
  buffer_load_dwordx4 v16, s[12:15], s19 offen lds
  v_mfma_f32_16x16x32_bf16 v[120:123], v[24:27], a[12:15], 0
  s_waitcnt lgkmcnt(5)
  v_mfma_f32_16x16x32_bf16 v[100:103], v[28:31], a[0:3], 0
  ds_read_b128 v[52:55], v15 offset:32768
  v_mfma_f32_16x16x32_bf16 v[108:111], v[28:31], a[4:7], 0
  v_cvt_pk_bf16_f32 v128, v64, v65
  v_cvt_pk_bf16_f32 v129, v66, v67
  v_mfma_f32_16x16x32_bf16 v[116:119], v[28:31], a[8:11], 0
  v_mfma_f32_16x16x32_bf16 v[124:127], v[28:31], a[12:15], 0
  s_waitcnt lgkmcnt(5)
  v_cvt_pk_bf16_f32 v130, v68, v69
  v_cvt_pk_bf16_f32 v131, v70, v71
  v_mfma_f32_16x16x32_bf16 v[96:99], v[32:35], a[16:19], v[96:99]
  s_add_u32 m0, s25, 1024
  ds_read_b128 v[24:27], v8 offset:40960
  v_mfma_f32_16x16x32_bf16 v[104:107], v[32:35], a[20:23], v[104:107]
  v_mfma_f32_16x16x32_bf16 v[112:115], v[32:35], a[24:27], v[112:115]
  buffer_load_dwordx4 v17, s[12:15], s19 offen lds
  v_mfma_f32_16x16x32_bf16 v[120:123], v[32:35], a[28:31], v[120:123]
  s_waitcnt lgkmcnt(5)
  v_mfma_f32_16x16x32_bf16 v[100:103], v[36:39], a[16:19], v[100:103]
  ds_read_b128 v[28:31], v9 offset:40960
  v_mfma_f32_16x16x32_bf16 v[108:111], v[36:39], a[20:23], v[108:111]
  v_mfma_f32_16x16x32_bf16 v[116:119], v[36:39], a[24:27], v[116:119]
  v_mfma_f32_16x16x32_bf16 v[124:127], v[36:39], a[28:31], v[124:127]
  s_waitcnt lgkmcnt(5)
  v_mfma_f32_16x16x32_bf16 v[96:99], v[40:43], a[32:35], v[96:99]
  s_add_u32 m0, s25, 2048
  ds_read_b128 v[32:35], v10 offset:40960
  v_mfma_f32_16x16x32_bf16 v[104:107], v[40:43], a[36:39], v[104:107]
  v_cvt_pk_bf16_f32 v132, v72, v73
  v_cvt_pk_bf16_f32 v133, v74, v75
  v_mfma_f32_16x16x32_bf16 v[112:115], v[40:43], a[40:43], v[112:115]
  buffer_load_dwordx4 v18, s[12:15], s19 offen lds
  v_mfma_f32_16x16x32_bf16 v[120:123], v[40:43], a[44:47], v[120:123]
  s_waitcnt lgkmcnt(5)
  v_cvt_pk_bf16_f32 v134, v76, v77
  v_cvt_pk_bf16_f32 v135, v78, v79
  v_mfma_f32_16x16x32_bf16 v[100:103], v[44:47], a[32:35], v[100:103]
  ds_read_b128 v[36:39], v11 offset:40960
  v_mfma_f32_16x16x32_bf16 v[108:111], v[44:47], a[36:39], v[108:111]
  v_mfma_f32_16x16x32_bf16 v[116:119], v[44:47], a[40:43], v[116:119]
  v_mfma_f32_16x16x32_bf16 v[124:127], v[44:47], a[44:47], v[124:127]
  s_waitcnt lgkmcnt(5)
  v_mfma_f32_16x16x32_bf16 v[96:99], v[48:51], a[48:51], v[96:99]
  s_add_u32 m0, s25, 3072
  ds_read_b128 v[40:43], v12 offset:40960
  v_mfma_f32_16x16x32_bf16 v[104:107], v[48:51], a[52:55], v[104:107]
  v_mfma_f32_16x16x32_bf16 v[112:115], v[48:51], a[56:59], v[112:115]
  buffer_load_dwordx4 v19, s[12:15], s19 offen lds
  v_mfma_f32_16x16x32_bf16 v[120:123], v[48:51], a[60:63], v[120:123]
  s_waitcnt lgkmcnt(5)
  v_mfma_f32_16x16x32_bf16 v[100:103], v[52:55], a[48:51], v[100:103]
  ds_read_b128 v[44:47], v13 offset:40960
  v_mfma_f32_16x16x32_bf16 v[108:111], v[52:55], a[52:55], v[108:111]
  v_cvt_pk_bf16_f32 v136, v80, v81
  v_cvt_pk_bf16_f32 v137, v82, v83
  v_mfma_f32_16x16x32_bf16 v[116:119], v[52:55], a[56:59], v[116:119]
  v_mfma_f32_16x16x32_bf16 v[124:127], v[52:55], a[60:63], v[124:127]
  s_waitcnt lgkmcnt(5)
  v_cvt_pk_bf16_f32 v138, v84, v85
  v_cvt_pk_bf16_f32 v139, v86, v87
  v_mfma_f32_16x16x32_bf16 v[96:99], v[24:27], a[64:67], v[96:99]
  s_add_u32 m0, s25, 4096
  ds_read_b128 v[48:51], v14 offset:40960
  v_mfma_f32_16x16x32_bf16 v[104:107], v[24:27], a[68:71], v[104:107]
  v_mfma_f32_16x16x32_bf16 v[112:115], v[24:27], a[72:75], v[112:115]
  buffer_load_dwordx4 v20, s[12:15], s19 offen lds
  v_mfma_f32_16x16x32_bf16 v[120:123], v[24:27], a[76:79], v[120:123]
  s_waitcnt lgkmcnt(5)
  v_mfma_f32_16x16x32_bf16 v[100:103], v[28:31], a[64:67], v[100:103]
  ds_read_b128 v[52:55], v15 offset:40960
  v_mfma_f32_16x16x32_bf16 v[108:111], v[28:31], a[68:71], v[108:111]
  v_mfma_f32_16x16x32_bf16 v[116:119], v[28:31], a[72:75], v[116:119]
  v_mfma_f32_16x16x32_bf16 v[124:127], v[28:31], a[76:79], v[124:127]
  s_waitcnt lgkmcnt(5)
  v_mfma_f32_16x16x32_bf16 v[96:99], v[32:35], a[80:83], v[96:99]
  s_add_u32 m0, s25, 5120
  ds_read_b128 v[24:27], v8 offset:49152
  v_mfma_f32_16x16x32_bf16 v[104:107], v[32:35], a[84:87], v[104:107]
  v_cvt_pk_bf16_f32 v140, v88, v89
  v_cvt_pk_bf16_f32 v141, v90, v91
  v_mfma_f32_16x16x32_bf16 v[112:115], v[32:35], a[88:91], v[112:115]
  buffer_load_dwordx4 v21, s[12:15], s19 offen lds
  v_mfma_f32_16x16x32_bf16 v[120:123], v[32:35], a[92:95], v[120:123]
  s_waitcnt lgkmcnt(5)
  v_cvt_pk_bf16_f32 v142, v92, v93
  v_cvt_pk_bf16_f32 v143, v94, v95
  v_mfma_f32_16x16x32_bf16 v[100:103], v[36:39], a[80:83], v[100:103]
  ds_read_b128 v[28:31], v9 offset:49152
  v_mfma_f32_16x16x32_bf16 v[108:111], v[36:39], a[84:87], v[108:111]
  v_mfma_f32_16x16x32_bf16 v[116:119], v[36:39], a[88:91], v[116:119]
  v_mfma_f32_16x16x32_bf16 v[124:127], v[36:39], a[92:95], v[124:127]
  s_waitcnt lgkmcnt(5)
  v_mfma_f32_16x16x32_bf16 v[96:99], v[40:43], a[96:99], v[96:99]
  s_add_u32 m0, s25, 6144
  ds_read_b128 v[32:35], v10 offset:49152
  v_mfma_f32_16x16x32_bf16 v[104:107], v[40:43], a[100:103], v[104:107]
  v_mfma_f32_16x16x32_bf16 v[112:115], v[40:43], a[104:107], v[112:115]
  buffer_load_dwordx4 v22, s[12:15], s19 offen lds
  v_mfma_f32_16x16x32_bf16 v[120:123], v[40:43], a[108:111], v[120:123]
  s_waitcnt lgkmcnt(5)
  v_mfma_f32_16x16x32_bf16 v[100:103], v[44:47], a[96:99], v[100:103]
  ds_read_b128 v[36:39], v11 offset:49152
  v_mfma_f32_16x16x32_bf16 v[108:111], v[44:47], a[100:103], v[108:111]
  v_mfma_f32_16x16x32_bf16 v[116:119], v[44:47], a[104:107], v[116:119]
  v_mfma_f32_16x16x32_bf16 v[124:127], v[44:47], a[108:111], v[124:127]
  s_waitcnt lgkmcnt(5)
  v_mfma_f32_16x16x32_bf16 v[96:99], v[48:51], a[112:115], v[96:99]
  s_add_u32 m0, s25, 7168
  ds_read_b128 v[40:43], v12 offset:49152
  v_mfma_f32_16x16x32_bf16 v[104:107], v[48:51], a[116:119], v[104:107]
  v_mfma_f32_16x16x32_bf16 v[112:115], v[48:51], a[120:123], v[112:115]
  buffer_load_dwordx4 v23, s[12:15], s19 offen lds
  v_mfma_f32_16x16x32_bf16 v[120:123], v[48:51], a[124:127], v[120:123]
  s_waitcnt lgkmcnt(5)
  v_mfma_f32_16x16x32_bf16 v[100:103], v[52:55], a[112:115], v[100:103]
  s_cmp_gt_u32 s23, 3
  ds_read_b128 v[44:47], v13 offset:49152
  v_mfma_f32_16x16x32_bf16 v[108:111], v[52:55], a[116:119], v[108:111]
  v_mfma_f32_16x16x32_bf16 v[116:119], v[52:55], a[120:123], v[116:119]
  s_cselect_b32 s26, s20, 0
  v_mfma_f32_16x16x32_bf16 v[124:127], v[52:55], a[124:127], v[124:127]
  s_waitcnt lgkmcnt(5)
  v_mfma_f32_16x16x32_bf16 v[96:99], v[24:27], a[128:131], v[96:99]
  s_add_u32 s19, s19, s26
  ds_read_b128 v[48:51], v14 offset:49152
  v_mfma_f32_16x16x32_bf16 v[104:107], v[24:27], a[132:135], v[104:107]
  v_mfma_f32_16x16x32_bf16 v[112:115], v[24:27], a[136:139], v[112:115]
  s_add_u32 s25, s25, 32768
  v_mfma_f32_16x16x32_bf16 v[120:123], v[24:27], a[140:143], v[120:123]
  s_waitcnt lgkmcnt(5)
  v_mfma_f32_16x16x32_bf16 v[100:103], v[28:31], a[128:131], v[100:103]
  s_and_b32 s25, s25, 0x1ffff
  ds_read_b128 v[52:55], v15 offset:49152
  v_mfma_f32_16x16x32_bf16 v[108:111], v[28:31], a[132:135], v[108:111]
  v_mfma_f32_16x16x32_bf16 v[116:119], v[28:31], a[136:139], v[116:119]
  buffer_store_dwordx4 v[128:131], v7, s[4:7], s21 offen offset:0 sc1
  v_mfma_f32_16x16x32_bf16 v[124:127], v[28:31], a[140:143], v[124:127]
  s_waitcnt lgkmcnt(5)
  v_mfma_f32_16x16x32_bf16 v[96:99], v[32:35], a[144:147], v[96:99]
  ds_read_b128 v[24:27], v8 offset:57344
  v_mfma_f32_16x16x32_bf16 v[104:107], v[32:35], a[148:151], v[104:107]
  v_mfma_f32_16x16x32_bf16 v[112:115], v[32:35], a[152:155], v[112:115]
  v_mfma_f32_16x16x32_bf16 v[120:123], v[32:35], a[156:159], v[120:123]
  s_waitcnt lgkmcnt(5)
  v_xor_b32 v8, 0x10000, v8
  v_mfma_f32_16x16x32_bf16 v[100:103], v[36:39], a[144:147], v[100:103]
  ds_read_b128 v[28:31], v9 offset:57344
  v_mfma_f32_16x16x32_bf16 v[108:111], v[36:39], a[148:151], v[108:111]
  v_mfma_f32_16x16x32_bf16 v[116:119], v[36:39], a[152:155], v[116:119]
  buffer_store_dwordx4 v[132:135], v7, s[4:7], s21 offen offset:256 sc1
  v_mfma_f32_16x16x32_bf16 v[124:127], v[36:39], a[156:159], v[124:127]
  s_waitcnt lgkmcnt(5)
  v_xor_b32 v9, 0x10000, v9
  v_mfma_f32_16x16x32_bf16 v[96:99], v[40:43], a[160:163], v[96:99]
  ds_read_b128 v[32:35], v10 offset:57344
  v_mfma_f32_16x16x32_bf16 v[104:107], v[40:43], a[164:167], v[104:107]
  v_mfma_f32_16x16x32_bf16 v[112:115], v[40:43], a[168:171], v[112:115]
  v_mfma_f32_16x16x32_bf16 v[120:123], v[40:43], a[172:175], v[120:123]
  s_waitcnt lgkmcnt(5)
  v_xor_b32 v10, 0x10000, v10
  v_mfma_f32_16x16x32_bf16 v[100:103], v[44:47], a[160:163], v[100:103]
  ds_read_b128 v[36:39], v11 offset:57344
  v_mfma_f32_16x16x32_bf16 v[108:111], v[44:47], a[164:167], v[108:111]
  v_mfma_f32_16x16x32_bf16 v[116:119], v[44:47], a[168:171], v[116:119]
  buffer_store_dwordx4 v[136:139], v7, s[4:7], s21 offen offset:2048 sc1
  v_mfma_f32_16x16x32_bf16 v[124:127], v[44:47], a[172:175], v[124:127]
  s_waitcnt lgkmcnt(5)
  v_xor_b32 v11, 0x10000, v11
  v_mfma_f32_16x16x32_bf16 v[96:99], v[48:51], a[176:179], v[96:99]
  ds_read_b128 v[40:43], v12 offset:57344
  v_mfma_f32_16x16x32_bf16 v[104:107], v[48:51], a[180:183], v[104:107]
  v_mfma_f32_16x16x32_bf16 v[112:115], v[48:51], a[184:187], v[112:115]
  v_mfma_f32_16x16x32_bf16 v[120:123], v[48:51], a[188:191], v[120:123]
  s_waitcnt lgkmcnt(5)
  v_xor_b32 v12, 0x10000, v12
  v_mfma_f32_16x16x32_bf16 v[100:103], v[52:55], a[176:179], v[100:103]
  ds_read_b128 v[44:47], v13 offset:57344
  v_mfma_f32_16x16x32_bf16 v[108:111], v[52:55], a[180:183], v[108:111]
  v_mfma_f32_16x16x32_bf16 v[116:119], v[52:55], a[184:187], v[116:119]
  buffer_store_dwordx4 v[140:143], v7, s[4:7], s21 offen offset:2304 sc1
  v_mfma_f32_16x16x32_bf16 v[124:127], v[52:55], a[188:191], v[124:127]
  s_waitcnt lgkmcnt(5)
  v_xor_b32 v13, 0x10000, v13
  v_mfma_f32_16x16x32_bf16 v[96:99], v[24:27], a[192:195], v[96:99]
  s_mov_b32 s21, s27
  ds_read_b128 v[48:51], v14 offset:57344
  v_mfma_f32_16x16x32_bf16 v[104:107], v[24:27], a[196:199], v[104:107]
  v_mov_b32 v7, v56
  v_mfma_f32_16x16x32_bf16 v[112:115], v[24:27], a[200:203], v[112:115]
  v_mfma_f32_16x16x32_bf16 v[120:123], v[24:27], a[204:207], v[120:123]
  s_waitcnt lgkmcnt(5)
  v_xor_b32 v14, 0x10000, v14
  v_mfma_f32_16x16x32_bf16 v[100:103], v[28:31], a[192:195], v[100:103]
  s_add_u32 s27, s27, s22
  ds_read_b128 v[52:55], v15 offset:57344
  v_mfma_f32_16x16x32_bf16 v[108:111], v[28:31], a[196:199], v[108:111]
  v_mfma_f32_16x16x32_bf16 v[116:119], v[28:31], a[200:203], v[116:119]
  s_waitcnt vmcnt(13)
  s_barrier
  v_mfma_f32_16x16x32_bf16 v[124:127], v[28:31], a[204:207], v[124:127]
  s_waitcnt lgkmcnt(5)
  v_xor_b32 v15, 0x10000, v15
  v_mfma_f32_16x16x32_bf16 v[96:99], v[32:35], a[208:211], v[96:99]
  ds_read_b128 v[24:27], v8 offset:0
  v_mfma_f32_16x16x32_bf16 v[104:107], v[32:35], a[212:215], v[104:107]
  v_mfma_f32_16x16x32_bf16 v[112:115], v[32:35], a[216:219], v[112:115]
  v_mfma_f32_16x16x32_bf16 v[120:123], v[32:35], a[220:223], v[120:123]
  s_waitcnt lgkmcnt(5)
  v_mfma_f32_16x16x32_bf16 v[100:103], v[36:39], a[208:211], v[100:103]
  s_add_u32 s29, s29, 1
  ds_read_b128 v[28:31], v9 offset:0
  v_mfma_f32_16x16x32_bf16 v[108:111], v[36:39], a[212:215], v[108:111]
  v_mfma_f32_16x16x32_bf16 v[116:119], v[36:39], a[216:219], v[116:119]
  s_max_i32 s30, s29, 0
  v_mfma_f32_16x16x32_bf16 v[124:127], v[36:39], a[220:223], v[124:127]
  s_waitcnt lgkmcnt(5)
  v_mov_b32 v144, s30
  v_mfma_f32_16x16x32_bf16 v[96:99], v[40:43], a[224:227], v[96:99]
  ds_read_b128 v[32:35], v10 offset:0
  v_mfma_f32_16x16x32_bf16 v[104:107], v[40:43], a[228:231], v[104:107]
  v_mfma_f32_16x16x32_bf16 v[112:115], v[40:43], a[232:235], v[112:115]
  buffer_store_dword v144, v145, s[4:7], s31 offen sc1
  v_mfma_f32_16x16x32_bf16 v[120:123], v[40:43], a[236:239], v[120:123]
  s_waitcnt lgkmcnt(5)
  v_mfma_f32_16x16x32_bf16 v[100:103], v[44:47], a[224:227], v[100:103]
  ds_read_b128 v[36:39], v11 offset:0
  v_mfma_f32_16x16x32_bf16 v[108:111], v[44:47], a[228:231], v[108:111]
  v_mfma_f32_16x16x32_bf16 v[116:119], v[44:47], a[232:235], v[116:119]
  v_mfma_f32_16x16x32_bf16 v[124:127], v[44:47], a[236:239], v[124:127]
  s_waitcnt lgkmcnt(5)
  v_mfma_f32_16x16x32_bf16 v[96:99], v[48:51], a[240:243], v[96:99]
  s_sub_u32 s23, s23, 1
  ds_read_b128 v[40:43], v12 offset:0
  v_mfma_f32_16x16x32_bf16 v[104:107], v[48:51], a[244:247], v[104:107]
  v_mfma_f32_16x16x32_bf16 v[112:115], v[48:51], a[248:251], v[112:115]
  v_mfma_f32_16x16x32_bf16 v[120:123], v[48:51], a[252:255], v[120:123]
  s_waitcnt lgkmcnt(5)
  v_mfma_f32_16x16x32_bf16 v[100:103], v[52:55], a[240:243], v[100:103]
  s_cmp_eq_u32 s23, 0
  ds_read_b128 v[44:47], v13 offset:0
  v_mfma_f32_16x16x32_bf16 v[108:111], v[52:55], a[244:247], v[108:111]
  v_mfma_f32_16x16x32_bf16 v[116:119], v[52:55], a[248:251], v[116:119]
  v_mfma_f32_16x16x32_bf16 v[124:127], v[52:55], a[252:255], v[124:127]
  s_cbranch_scc1 G_done1_14
  s_branch G_top_12
G_done0_13:
  s_nop 7
  s_nop 3
  v_cvt_pk_bf16_f32 v128, v64, v65
  v_cvt_pk_bf16_f32 v129, v66, v67
  v_cvt_pk_bf16_f32 v130, v68, v69
  v_cvt_pk_bf16_f32 v131, v70, v71
  buffer_store_dwordx4 v[128:131], v7, s[4:7], s21 offen offset:0 sc1
  v_cvt_pk_bf16_f32 v132, v72, v73
  v_cvt_pk_bf16_f32 v133, v74, v75
  v_cvt_pk_bf16_f32 v134, v76, v77
  v_cvt_pk_bf16_f32 v135, v78, v79
  buffer_store_dwordx4 v[132:135], v7, s[4:7], s21 offen offset:256 sc1
  v_cvt_pk_bf16_f32 v136, v80, v81
  v_cvt_pk_bf16_f32 v137, v82, v83
  v_cvt_pk_bf16_f32 v138, v84, v85
  v_cvt_pk_bf16_f32 v139, v86, v87
  buffer_store_dwordx4 v[136:139], v7, s[4:7], s21 offen offset:2048 sc1
  v_cvt_pk_bf16_f32 v140, v88, v89
  v_cvt_pk_bf16_f32 v141, v90, v91
  v_cvt_pk_bf16_f32 v142, v92, v93
  v_cvt_pk_bf16_f32 v143, v94, v95
  buffer_store_dwordx4 v[140:143], v7, s[4:7], s21 offen offset:2304 sc1
  s_branch G_fin_15
G_done1_14:
  s_nop 7
  s_nop 3
  v_cvt_pk_bf16_f32 v128, v96, v97
  v_cvt_pk_bf16_f32 v129, v98, v99
  v_cvt_pk_bf16_f32 v130, v100, v101
  v_cvt_pk_bf16_f32 v131, v102, v103
  buffer_store_dwordx4 v[128:131], v7, s[4:7], s21 offen offset:0 sc1
  v_cvt_pk_bf16_f32 v132, v104, v105
  v_cvt_pk_bf16_f32 v133, v106, v107
  v_cvt_pk_bf16_f32 v134, v108, v109
  v_cvt_pk_bf16_f32 v135, v110, v111
  buffer_store_dwordx4 v[132:135], v7, s[4:7], s21 offen offset:256 sc1
  v_cvt_pk_bf16_f32 v136, v112, v113
  v_cvt_pk_bf16_f32 v137, v114, v115
  v_cvt_pk_bf16_f32 v138, v116, v117
  v_cvt_pk_bf16_f32 v139, v118, v119
  buffer_store_dwordx4 v[136:139], v7, s[4:7], s21 offen offset:2048 sc1
  v_cvt_pk_bf16_f32 v140, v120, v121
  v_cvt_pk_bf16_f32 v141, v122, v123
  v_cvt_pk_bf16_f32 v142, v124, v125
  v_cvt_pk_bf16_f32 v143, v126, v127
  buffer_store_dwordx4 v[140:143], v7, s[4:7], s21 offen offset:2304 sc1
G_fin_15:
  s_waitcnt vmcnt(0) lgkmcnt(0)
  s_barrier
  s_add_u32 s30, s29, 2
  v_mov_b32 v144, s30
  v_min_u32 v145, 1, v0
  v_lshlrev_b32 v145, 30, v145
  buffer_store_dword v144, v145, s[4:7], s31 offen sc1
P_end_2:
  s_mov_b32 s71, 0
  s_branch M_sg_17
M_sw_16:
  s_sleep 8
  s_add_u32 s71, s71, 1
  s_cmp_gt_u32 s71, 262144
  s_cbranch_scc1 M_exit
M_sg_17:
  s_mov_b32 s79, 0
  s_atomic_or s79, s[74:75], 128 glc
  s_waitcnt lgkmcnt(0)
  s_cmp_lt_u32 s79, 256
  s_cbranch_scc1 M_sw_16
  s_cmp_eq_u32 s65, 6
  s_cbranch_scc1 M_follow
  s_mov_b32 s68, 0
  s_mov_b32 s36, -1
  s_mov_b32 s69, s53
  s_mov_b32 s70, s54
  s_load_dwordx2 s[8:9], s[0:1], 40
  s_mul_i32 s76, s64, 6
  s_add_u32 s76, s76, s65
  s_mul_i32 s76, s76, 21888
  v_min_u32 v200, 170, v0
  v_mul_u32_u24 v200, 128, v200
  v_add_u32 v200, s76, v200
  s_waitcnt lgkmcnt(0)
  s_and_b32 s9, s9, 0xffff
  s_mov_b32 s10, 4194304
  s_mov_b32 s11, 0x20000
M_att:
  s_mov_b32 s24, 0xf149f2ca
  s_mov_b32 s29, 0
  v_mov_b32 v6, 0
  v_mov_b32 v7, 0
  s_lshl_b32 s26, s16, 11
  v_add_u32 v3, s26, v2
  v_and_b32 v5, 31, v1
  v_lshrrev_b32 v12, 5, v1
  v_lshlrev_b32 v12, 2, v12
  v_sub_u32 v5, v5, v12
  s_lshl_b32 s26, s64, 19
  s_add_u32 s19, s26, 16777216
  s_add_u32 s20, s26, 33554432
  s_lshl_b32 s27, s69, 2
  s_add_u32 s27, s27, s16
  s_lshl_b32 s27, s27, 14
  s_add_u32 s25, s26, s27
  s_bfe_u32 s78, s70, 0x80000
  s_add_u32 s76, s67, 512
  s_mov_b32 s71, 0
  s_branch M_sg_19
M_sw_18:
  s_sleep 8
  s_add_u32 s71, s71, 1
  s_cmp_gt_u32 s71, 262144
  s_cbranch_scc1 M_exit
M_sg_19:
  s_mov_b32 s79, 0
  s_atomic_or s79, s[72:73], s76 glc
  s_waitcnt lgkmcnt(0)
  s_cmp_lt_u32 s79, s78
  s_cbranch_scc1 M_sw_18
  s_bfe_u32 s78, s70, 0x80008
  s_add_u32 s76, s67, 640
  s_mov_b32 s71, 0
  s_branch M_sg_21
M_sw_20:
  s_sleep 8
  s_add_u32 s71, s71, 1
  s_cmp_gt_u32 s71, 262144
  s_cbranch_scc1 M_exit
M_sg_21:
  s_mov_b32 s79, 0
  s_atomic_or s79, s[72:73], s76 glc
  s_waitcnt lgkmcnt(0)
  s_cmp_lt_u32 s79, s78
  s_cbranch_scc1 M_sw_20
  s_lshl_b32 s27, s69, 16
  s_add_u32 s27, s27, 16384
  s_add_u32 s17, s19, s27
M_kv_22:
  s_cmp_ge_u32 s17, s36
  s_cbranch_scc1 M_kvok_23
  s_mov_b32 s76, 0
  s_mov_b32 s78, 23
  s_mov_b32 s77, 335872
  s_cmp_eq_u32 s68, 1
  s_cmov_b32 s76, 128
  s_cmov_b32 s78, 27
  s_cmov_b32 s77, 114688
  s_cmp_eq_u32 s68, 2
  s_cmov_b32 s76, 768
  s_cmov_b32 s78, 14
  s_cmov_b32 s77, 0
  s_add_u32 s76, s76, s67
  s_mov_b32 s71, 0
  s_branch M_sg_25
M_sw_24:
  s_sleep 8
  s_add_u32 s71, s71, 1
  s_cmp_gt_u32 s71, 262144
  s_cbranch_scc1 M_exit
M_sg_25:
  s_mov_b32 s79, 0
  s_atomic_or s79, s[72:73], s76 glc
  s_waitcnt lgkmcnt(0)
  s_cmp_lt_u32 s79, s78
  s_cbranch_scc1 M_sw_24
  s_add_u32 s36, s77, s19
  s_add_u32 s68, s68, 1
  s_branch M_kv_22
M_kvok_23:
  s_add_u32 s28, s25, 0
  buffer_load_dwordx4 a[128:131], v2, s[4:7], s28 offen offset:0 sc1
  buffer_load_dwordx4 a[132:135], v2, s[4:7], s28 offen offset:1024 sc1
  buffer_load_dwordx4 a[136:139], v2, s[4:7], s28 offen offset:2048 sc1
  buffer_load_dwordx4 a[140:143], v2, s[4:7], s28 offen offset:3072 sc1
  s_add_u32 s28, s25, 4096
  buffer_load_dwordx4 a[144:147], v2, s[4:7], s28 offen offset:0 sc1
  buffer_load_dwordx4 a[148:151], v2, s[4:7], s28 offen offset:1024 sc1
  buffer_load_dwordx4 a[152:155], v2, s[4:7], s28 offen offset:2048 sc1
  buffer_load_dwordx4 a[156:159], v2, s[4:7], s28 offen offset:3072 sc1
  s_add_u32 s28, s25, 8192
  buffer_load_dwordx4 a[160:163], v2, s[4:7], s28 offen offset:0 sc1
  buffer_load_dwordx4 a[164:167], v2, s[4:7], s28 offen offset:1024 sc1
  buffer_load_dwordx4 a[168:171], v2, s[4:7], s28 offen offset:2048 sc1
  buffer_load_dwordx4 a[172:175], v2, s[4:7], s28 offen offset:3072 sc1
  s_add_u32 s28, s25, 12288
  buffer_load_dwordx4 a[176:179], v2, s[4:7], s28 offen offset:0 sc1
  buffer_load_dwordx4 a[180:183], v2, s[4:7], s28 offen offset:1024 sc1
  buffer_load_dwordx4 a[184:187], v2, s[4:7], s28 offen offset:2048 sc1
  buffer_load_dwordx4 a[188:191], v2, s[4:7], s28 offen offset:3072 sc1
A_again_26:
  s_lshl_b32 s27, s69, 16
  s_add_u32 s27, s27, 57344
  s_add_u32 s17, s19, s27
  s_add_u32 s18, s20, s27
  s_lshl_b32 s21, s16, 11
  s_mov_b32 m0, s21
  s_nop 0
  buffer_load_dwordx4 v3, s[4:7], s18 offen offset:0 sc1 lds
  buffer_load_dwordx4 v3, s[4:7], s18 offen offset:1024 sc1 lds
  s_add_u32 m0, s21, 8192
  s_nop 0
  buffer_load_dwordx4 v3, s[4:7], s17 offen offset:0 sc1 lds
  buffer_load_dwordx4 v3, s[4:7], s17 offen offset:1024 sc1 lds
  s_add_u32 s18, s18, 8192
  s_sub_u32 s18, s18, 8192
  s_max_i32 s18, s18, s20
  s_sub_u32 s17, s17, 8192
  s_max_i32 s17, s17, s19
  s_add_u32 s21, s21, 16384
  s_and_b32 s21, s21, 131071
  s_mov_b32 m0, s21
  s_nop 0
  buffer_load_dwordx4 v3, s[4:7], s18 offen offset:0 sc1 lds
  buffer_load_dwordx4 v3, s[4:7], s18 offen offset:1024 sc1 lds
  s_add_u32 m0, s21, 8192
  s_nop 0
  buffer_load_dwordx4 v3, s[4:7], s17 offen offset:0 sc1 lds
  buffer_load_dwordx4 v3, s[4:7], s17 offen offset:1024 sc1 lds
  s_sub_u32 s18, s18, 8192
  s_max_i32 s18, s18, s20
  s_sub_u32 s17, s17, 8192
  s_max_i32 s17, s17, s19
  s_add_u32 s21, s21, 16384
  s_and_b32 s21, s21, 131071
  s_mov_b32 m0, s21
  s_nop 0
  buffer_load_dwordx4 v3, s[4:7], s18 offen offset:0 sc1 lds
  buffer_load_dwordx4 v3, s[4:7], s18 offen offset:1024 sc1 lds
  s_add_u32 m0, s21, 8192
  s_nop 0
  buffer_load_dwordx4 v3, s[4:7], s17 offen offset:0 sc1 lds
  buffer_load_dwordx4 v3, s[4:7], s17 offen offset:1024 sc1 lds
  s_sub_u32 s18, s18, 8192
  s_max_i32 s18, s18, s20
  s_sub_u32 s17, s17, 8192
  s_max_i32 s17, s17, s19
  s_add_u32 s21, s21, 16384
  s_and_b32 s21, s21, 131071
  s_mov_b32 m0, s21
  s_nop 0
  buffer_load_dwordx4 v3, s[4:7], s18 offen offset:0 sc1 lds
  buffer_load_dwordx4 v3, s[4:7], s18 offen offset:1024 sc1 lds
  s_add_u32 m0, s21, 8192
  s_nop 0
  buffer_load_dwordx4 v3, s[4:7], s17 offen offset:0 sc1 lds
  buffer_load_dwordx4 v3, s[4:7], s17 offen offset:1024 sc1 lds
  s_sub_u32 s18, s18, 8192
  s_max_i32 s18, s18, s20
  s_sub_u32 s17, s17, 8192
  s_max_i32 s17, s17, s19
  s_add_u32 s21, s21, 16384
  s_and_b32 s21, s21, 131071
  s_mov_b32 m0, s21
  s_nop 0
  buffer_load_dwordx4 v3, s[4:7], s18 offen offset:0 sc1 lds
  buffer_load_dwordx4 v3, s[4:7], s18 offen offset:1024 sc1 lds
  s_add_u32 m0, s21, 8192
  s_nop 0
  buffer_load_dwordx4 v3, s[4:7], s17 offen offset:0 sc1 lds
  buffer_load_dwordx4 v3, s[4:7], s17 offen offset:1024 sc1 lds
  s_sub_u32 s18, s18, 8192
  s_max_i32 s18, s18, s20
  s_sub_u32 s17, s17, 8192
  s_max_i32 s17, s17, s19
  s_add_u32 s21, s21, 16384
  s_and_b32 s21, s21, 131071
  s_mov_b32 m0, s21
  s_nop 0
  buffer_load_dwordx4 v3, s[4:7], s18 offen offset:0 sc1 lds
  buffer_load_dwordx4 v3, s[4:7], s18 offen offset:1024 sc1 lds
  s_add_u32 m0, s21, 8192
  s_nop 0
  buffer_load_dwordx4 v3, s[4:7], s17 offen offset:0 sc1 lds
  buffer_load_dwordx4 v3, s[4:7], s17 offen offset:1024 sc1 lds
  v_accvgpr_write_b32 a0, 0
  v_accvgpr_write_b32 a1, 0
  v_accvgpr_write_b32 a2, 0
  v_accvgpr_write_b32 a3, 0
  v_accvgpr_write_b32 a4, 0
  v_accvgpr_write_b32 a5, 0
  v_accvgpr_write_b32 a6, 0
  v_accvgpr_write_b32 a7, 0
  v_accvgpr_write_b32 a8, 0
  v_accvgpr_write_b32 a9, 0
  v_accvgpr_write_b32 a10, 0
  v_accvgpr_write_b32 a11, 0
  v_accvgpr_write_b32 a12, 0
  v_accvgpr_write_b32 a13, 0
  v_accvgpr_write_b32 a14, 0
  v_accvgpr_write_b32 a15, 0
  v_accvgpr_write_b32 a16, 0
  v_accvgpr_write_b32 a17, 0
  v_accvgpr_write_b32 a18, 0
  v_accvgpr_write_b32 a19, 0
  v_accvgpr_write_b32 a20, 0
  v_accvgpr_write_b32 a21, 0
  v_accvgpr_write_b32 a22, 0
  v_accvgpr_write_b32 a23, 0
  v_accvgpr_write_b32 a24, 0
  v_accvgpr_write_b32 a25, 0
  v_accvgpr_write_b32 a26, 0
  v_accvgpr_write_b32 a27, 0
  v_accvgpr_write_b32 a28, 0
  v_accvgpr_write_b32 a29, 0
  v_accvgpr_write_b32 a30, 0
  v_accvgpr_write_b32 a31, 0
  v_accvgpr_write_b32 a32, 0
  v_accvgpr_write_b32 a33, 0
  v_accvgpr_write_b32 a34, 0
  v_accvgpr_write_b32 a35, 0
  v_accvgpr_write_b32 a36, 0
  v_accvgpr_write_b32 a37, 0
  v_accvgpr_write_b32 a38, 0
  v_accvgpr_write_b32 a39, 0
  v_accvgpr_write_b32 a40, 0
  v_accvgpr_write_b32 a41, 0
  v_accvgpr_write_b32 a42, 0
  v_accvgpr_write_b32 a43, 0
  v_accvgpr_write_b32 a44, 0
  v_accvgpr_write_b32 a45, 0
  v_accvgpr_write_b32 a46, 0
  v_accvgpr_write_b32 a47, 0
  v_accvgpr_write_b32 a48, 0
  v_accvgpr_write_b32 a49, 0
  v_accvgpr_write_b32 a50, 0
  v_accvgpr_write_b32 a51, 0
  v_accvgpr_write_b32 a52, 0
  v_accvgpr_write_b32 a53, 0
  v_accvgpr_write_b32 a54, 0
  v_accvgpr_write_b32 a55, 0
  v_accvgpr_write_b32 a56, 0
  v_accvgpr_write_b32 a57, 0
  v_accvgpr_write_b32 a58, 0
  v_accvgpr_write_b32 a59, 0
  v_accvgpr_write_b32 a60, 0
  v_accvgpr_write_b32 a61, 0
  v_accvgpr_write_b32 a62, 0
  v_accvgpr_write_b32 a63, 0
  v_accvgpr_write_b32 a64, 0
  v_accvgpr_write_b32 a65, 0
  v_accvgpr_write_b32 a66, 0
  v_accvgpr_write_b32 a67, 0
  v_accvgpr_write_b32 a68, 0
  v_accvgpr_write_b32 a69, 0
  v_accvgpr_write_b32 a70, 0
  v_accvgpr_write_b32 a71, 0
  v_accvgpr_write_b32 a72, 0
  v_accvgpr_write_b32 a73, 0
  v_accvgpr_write_b32 a74, 0
  v_accvgpr_write_b32 a75, 0
  v_accvgpr_write_b32 a76, 0
  v_accvgpr_write_b32 a77, 0
  v_accvgpr_write_b32 a78, 0
  v_accvgpr_write_b32 a79, 0
  v_accvgpr_write_b32 a80, 0
  v_accvgpr_write_b32 a81, 0
  v_accvgpr_write_b32 a82, 0
  v_accvgpr_write_b32 a83, 0
  v_accvgpr_write_b32 a84, 0
  v_accvgpr_write_b32 a85, 0
  v_accvgpr_write_b32 a86, 0
  v_accvgpr_write_b32 a87, 0
  v_accvgpr_write_b32 a88, 0
  v_accvgpr_write_b32 a89, 0
  v_accvgpr_write_b32 a90, 0
  v_accvgpr_write_b32 a91, 0
  v_accvgpr_write_b32 a92, 0
  v_accvgpr_write_b32 a93, 0
  v_accvgpr_write_b32 a94, 0
  v_accvgpr_write_b32 a95, 0
  v_accvgpr_write_b32 a96, 0
  v_accvgpr_write_b32 a97, 0
  v_accvgpr_write_b32 a98, 0
  v_accvgpr_write_b32 a99, 0
  v_accvgpr_write_b32 a100, 0
  v_accvgpr_write_b32 a101, 0
  v_accvgpr_write_b32 a102, 0
  v_accvgpr_write_b32 a103, 0
  v_accvgpr_write_b32 a104, 0
  v_accvgpr_write_b32 a105, 0
  v_accvgpr_write_b32 a106, 0
  v_accvgpr_write_b32 a107, 0
  v_accvgpr_write_b32 a108, 0
  v_accvgpr_write_b32 a109, 0
  v_accvgpr_write_b32 a110, 0
  v_accvgpr_write_b32 a111, 0
  v_accvgpr_write_b32 a112, 0
  v_accvgpr_write_b32 a113, 0
  v_accvgpr_write_b32 a114, 0
  v_accvgpr_write_b32 a115, 0
  v_accvgpr_write_b32 a116, 0
  v_accvgpr_write_b32 a117, 0
  v_accvgpr_write_b32 a118, 0
  v_accvgpr_write_b32 a119, 0
  v_accvgpr_write_b32 a120, 0
  v_accvgpr_write_b32 a121, 0
  v_accvgpr_write_b32 a122, 0
  v_accvgpr_write_b32 a123, 0
  v_accvgpr_write_b32 a124, 0
  v_accvgpr_write_b32 a125, 0
  v_accvgpr_write_b32 a126, 0
  v_accvgpr_write_b32 a127, 0
  v_mov_b32 v8, 0
  v_mov_b32 v9, 0
  v_mov_b32 v10, 0
  v_mov_b32 v11, 0
  v_mov_b32 v52, 0
  v_mov_b32 v53, 0
  v_mov_b32 v54, s24
  v_mov_b32 v55, s24
  v_mov_b32 v56, s24
  v_mov_b32 v57, s24
  v_mov_b32 v58, s24
  v_mov_b32 v59, s24
  v_mov_b32 v60, s24
  v_mov_b32 v61, s24
  v_mov_b32 v62, s24
  v_mov_b32 v63, s24
  v_mov_b32 v104, 0
  v_mov_b32 v105, 0
  v_mov_b32 v4, v2
  v_mov_b32 v64, s24
  v_mov_b32 v65, s24
  v_mov_b32 v66, s24
  v_mov_b32 v67, s24
  v_mov_b32 v68, s24
  v_mov_b32 v69, s24
  v_mov_b32 v70, s24
  v_mov_b32 v71, s24
  v_mov_b32 v72, s24
  v_mov_b32 v73, s24
  v_mov_b32 v74, s24
  v_mov_b32 v75, s24
  v_mov_b32 v76, s24
  v_mov_b32 v77, s24
  v_mov_b32 v78, s24
  v_mov_b32 v79, s24
  v_mov_b32 v12, s24
  v_cmp_le_i32 s[40:41], 0, v5
  v_cmp_le_i32 s[42:43], 1, v5
  v_cmp_le_i32 s[44:45], 2, v5
  v_cmp_le_i32 s[46:47], 3, v5
  v_cndmask_b32 v80, v12, v7, s[40:41]
  v_cndmask_b32 v81, v12, v7, s[42:43]
  v_cndmask_b32 v82, v12, v7, s[44:45]
  v_cndmask_b32 v83, v12, v7, s[46:47]
  v_cmp_le_i32 s[40:41], 8, v5
  v_cmp_le_i32 s[42:43], 9, v5
  v_cmp_le_i32 s[44:45], 10, v5
  v_cmp_le_i32 s[46:47], 11, v5
  v_cndmask_b32 v84, v12, v7, s[40:41]
  v_cndmask_b32 v85, v12, v7, s[42:43]
  v_cndmask_b32 v86, v12, v7, s[44:45]
  v_cndmask_b32 v87, v12, v7, s[46:47]
  v_cmp_le_i32 s[40:41], 16, v5
  v_cmp_le_i32 s[42:43], 17, v5
  v_cmp_le_i32 s[44:45], 18, v5
  v_cmp_le_i32 s[46:47], 19, v5
  v_cndmask_b32 v88, v12, v7, s[40:41]
  v_cndmask_b32 v89, v12, v7, s[42:43]
  v_cndmask_b32 v90, v12, v7, s[44:45]
  v_cndmask_b32 v91, v12, v7, s[46:47]
  v_cmp_le_i32 s[40:41], 24, v5
  v_cmp_le_i32 s[42:43], 25, v5
  v_cmp_le_i32 s[44:45], 26, v5
  v_cmp_le_i32 s[46:47], 27, v5
  v_cndmask_b32 v92, v12, v7, s[40:41]
  v_cndmask_b32 v93, v12, v7, s[42:43]
  v_cndmask_b32 v94, v12, v7, s[44:45]
  v_cndmask_b32 v95, v12, v7, s[46:47]
  s_lshl_b32 s22, s69, 3
  s_add_u32 s22, s22, 8
  s_lshl_b32 s26, s16, 1
  s_sub_u32 s23, 6, s26
  s_waitcnt vmcnt(20)
  s_barrier
  s_cmp_eq_u32 s23, 0
  s_cbranch_scc1 A_go_28
A_idle_27:
  s_waitcnt vmcnt(16)
  s_barrier
  s_sub_u32 s18, s18, 8192
  s_max_i32 s18, s18, s20
  s_sub_u32 s17, s17, 8192
  s_max_i32 s17, s17, s19
  s_add_u32 s21, s21, 16384
  s_and_b32 s21, s21, 131071
M_kv_29:
  s_cmp_ge_u32 s17, s36
  s_cbranch_scc1 M_kvok_30
  s_mov_b32 s76, 0
  s_mov_b32 s78, 23
  s_mov_b32 s77, 335872
  s_cmp_eq_u32 s68, 1
  s_cmov_b32 s76, 128
  s_cmov_b32 s78, 27
  s_cmov_b32 s77, 114688
  s_cmp_eq_u32 s68, 2
  s_cmov_b32 s76, 768
  s_cmov_b32 s78, 14
  s_cmov_b32 s77, 0
  s_add_u32 s76, s76, s67
  s_mov_b32 s71, 0
  s_branch M_sg_32
M_sw_31:
  s_sleep 8
  s_add_u32 s71, s71, 1
  s_cmp_gt_u32 s71, 262144
  s_cbranch_scc1 M_exit
M_sg_32:
  s_mov_b32 s79, 0
  s_atomic_or s79, s[72:73], s76 glc
  s_waitcnt lgkmcnt(0)
  s_cmp_lt_u32 s79, s78
  s_cbranch_scc1 M_sw_31
  s_add_u32 s36, s77, s19
  s_add_u32 s68, s68, 1
  s_branch M_kv_29
M_kvok_30:
  s_mov_b32 m0, s21
  s_nop 0
  buffer_load_dwordx4 v3, s[4:7], s18 offen offset:0 sc1 lds
  buffer_load_dwordx4 v3, s[4:7], s18 offen offset:1024 sc1 lds
  s_add_u32 m0, s21, 8192
  s_nop 0
  buffer_load_dwordx4 v3, s[4:7], s17 offen offset:0 sc1 lds
  buffer_load_dwordx4 v3, s[4:7], s17 offen offset:1024 sc1 lds
  v_add_u32 v4, 16384, v4
  v_and_b32 v4, 131071, v4
  s_sub_u32 s22, s22, 1
  s_sub_u32 s23, s23, 1
  s_cmp_lg_u32 s23, 0
  s_cbranch_scc1 A_idle_27
A_go_28:
  ds_read_b128 a[224:227], v4 offset:0
  ds_read_b128 a[228:231], v4 offset:2048
  ds_read_b128 a[232:235], v4 offset:4096
  ds_read_b128 a[236:239], v4 offset:6144
  ds_read_b128 a[240:243], v4 offset:1024
  ds_read_b128 a[244:247], v4 offset:3072
  ds_read_b128 a[248:251], v4 offset:5120
  ds_read_b128 a[252:255], v4 offset:7168
  ds_read_b128 a[192:195], v4 offset:8192
  ds_read_b128 a[196:199], v4 offset:9216
  ds_read_b128 a[200:203], v4 offset:10240
  ds_read_b128 a[204:207], v4 offset:11264
  ds_read_b128 a[208:211], v4 offset:12288
  ds_read_b128 a[212:215], v4 offset:13312
  ds_read_b128 a[216:219], v4 offset:14336
  ds_read_b128 a[220:223], v4 offset:15360
  v_add_u32 v4, 16384, v4
  v_and_b32 v4, 131071, v4
  s_waitcnt lgkmcnt(8)
.p2align 6
A_top_33:
  s_waitcnt lgkmcnt(7)
  v_mfma_f32_32x32x16_bf16 v[32:47], a[192:195], a[128:131], v[64:79]
  s_waitcnt lgkmcnt(6)
  v_exp_f32 v54, v54
  v_add_f32 v11, v11, v53
  v_cvt_pk_bf16_f32 v106, v52, v53
  v_mfma_f32_32x32x16_bf16 v[32:47], a[196:199], a[132:135], v[32:47]
  s_waitcnt lgkmcnt(4)
  v_exp_f32 v55, v55
  v_add_f32 v10, v10, v54
  v_mfma_f32_32x32x16_bf16 v[32:47], a[200:203], a[136:139], v[32:47]
  v_exp_f32 v56, v56
  v_add_f32 v11, v11, v55
  v_cvt_pk_bf16_f32 v107, v54, v55
  v_mfma_f32_32x32x16_bf16 v[32:47], a[204:207], a[140:143], v[32:47]
  s_waitcnt lgkmcnt(2)
  v_exp_f32 v57, v57
  v_add_f32 v10, v10, v56
  v_mfma_f32_32x32x16_bf16 v[32:47], a[208:211], a[144:147], v[32:47]
  v_exp_f32 v58, v58
  v_add_f32 v11, v11, v57
  v_cvt_pk_bf16_f32 v108, v56, v57
  v_mfma_f32_32x32x16_bf16 v[32:47], a[212:215], a[148:151], v[32:47]
  s_waitcnt lgkmcnt(0)
  v_exp_f32 v59, v59
  v_add_f32 v10, v10, v58
  v_mfma_f32_32x32x16_bf16 v[32:47], a[216:219], a[152:155], v[32:47]
  v_exp_f32 v60, v60
  v_add_f32 v11, v11, v59
  v_cvt_pk_bf16_f32 v109, v58, v59
  v_mfma_f32_32x32x16_bf16 v[32:47], a[220:223], a[156:159], v[32:47]
  s_waitcnt vmcnt(16)
  s_barrier
  v_exp_f32 v61, v61
  v_add_f32 v10, v10, v60
  v_mfma_f32_32x32x16_bf16 a[64:79], a[224:227], v[104:107], a[64:79]
  ds_read_b128 a[224:227], v4 offset:0
  v_exp_f32 v62, v62
  v_add_f32 v11, v11, v61
  v_cvt_pk_bf16_f32 v110, v60, v61
  v_mfma_f32_32x32x16_bf16 a[80:95], a[228:231], v[104:107], a[80:95]
  s_sub_u32 s18, s18, 8192
  ds_read_b128 a[228:231], v4 offset:2048
  v_exp_f32 v63, v63
  v_add_f32 v10, v10, v62
  v_mfma_f32_32x32x16_bf16 a[96:111], a[232:235], v[104:107], a[96:111]
  s_max_i32 s18, s18, s20
  ds_read_b128 a[232:235], v4 offset:4096
  v_exp_f32 v32, v32
  v_add_f32 v11, v11, v63
  v_cvt_pk_bf16_f32 v111, v62, v63
  v_mfma_f32_32x32x16_bf16 a[112:127], a[236:239], v[104:107], a[112:127]
  s_sub_u32 s17, s17, 8192
  ds_read_b128 a[236:239], v4 offset:6144
  v_exp_f32 v33, v33
  v_add_f32 v8, v8, v32
  v_mfma_f32_32x32x16_bf16 a[64:79], a[240:243], v[108:111], a[64:79]
  s_max_i32 s17, s17, s19
  ds_read_b128 a[240:243], v4 offset:1024
  v_exp_f32 v34, v34
  v_add_f32 v9, v9, v33
  v_cvt_pk_bf16_f32 v96, v32, v33
  v_mfma_f32_32x32x16_bf16 a[80:95], a[244:247], v[108:111], a[80:95]
  s_add_u32 s21, s21, 16384
  ds_read_b128 a[244:247], v4 offset:3072
  v_exp_f32 v35, v35
  v_add_f32 v8, v8, v34
  v_mfma_f32_32x32x16_bf16 a[96:111], a[248:251], v[108:111], a[96:111]
  s_and_b32 s21, s21, 131071
  ds_read_b128 a[248:251], v4 offset:5120
  v_exp_f32 v36, v36
  v_add_f32 v9, v9, v35
  v_cvt_pk_bf16_f32 v97, v34, v35
  v_mfma_f32_32x32x16_bf16 a[112:127], a[252:255], v[108:111], a[112:127]
  ds_read_b128 a[252:255], v4 offset:7168
  v_exp_f32 v37, v37
  v_add_f32 v8, v8, v36
  v_mfma_f32_32x32x16_bf16 v[48:63], a[192:195], a[160:163], v[80:95]
  s_add_u32 s23, s23, 1
  ds_read_b128 a[192:195], v4 offset:8192
  v_exp_f32 v38, v38
  v_add_f32 v9, v9, v37
  v_cvt_pk_bf16_f32 v98, v36, v37
  v_mfma_f32_32x32x16_bf16 v[48:63], a[196:199], a[164:167], v[48:63]
  s_sub_u32 s22, s22, 1
  ds_read_b128 a[196:199], v4 offset:9216
  v_exp_f32 v39, v39
  v_add_f32 v8, v8, v38
  v_mfma_f32_32x32x16_bf16 v[48:63], a[200:203], a[168:171], v[48:63]
  s_cmp_lt_u32 s23, 3
  ds_read_b128 a[200:203], v4 offset:10240
  v_exp_f32 v40, v40
  v_add_f32 v9, v9, v39
  v_cvt_pk_bf16_f32 v99, v38, v39
  v_mfma_f32_32x32x16_bf16 v[48:63], a[204:207], a[172:175], v[48:63]
  s_cbranch_scc1 A_upd_34
A_back_35:
  ds_read_b128 a[204:207], v4 offset:11264
  v_exp_f32 v41, v41
  v_add_f32 v8, v8, v40
  v_mfma_f32_32x32x16_bf16 v[48:63], a[208:211], a[176:179], v[48:63]
  s_cmp_lt_u32 s17, s36
  ds_read_b128 a[208:211], v4 offset:12288
  v_exp_f32 v42, v42
  v_add_f32 v9, v9, v41
  v_cvt_pk_bf16_f32 v100, v40, v41
  v_mfma_f32_32x32x16_bf16 v[48:63], a[212:215], a[180:183], v[48:63]
  s_cbranch_scc1 A_kvw_37
A_kvb_38:
  ds_read_b128 a[212:215], v4 offset:13312
  v_exp_f32 v43, v43
  v_add_f32 v8, v8, v42
  v_mfma_f32_32x32x16_bf16 v[48:63], a[216:219], a[184:187], v[48:63]
  s_mov_b32 m0, s21
  ds_read_b128 a[216:219], v4 offset:14336
  v_exp_f32 v44, v44
  v_add_f32 v9, v9, v43
  v_cvt_pk_bf16_f32 v101, v42, v43
  v_mfma_f32_32x32x16_bf16 v[48:63], a[220:223], a[188:191], v[48:63]
  s_waitcnt lgkmcnt(13)
  ds_read_b128 a[220:223], v4 offset:15360
  v_exp_f32 v45, v45
  v_add_f32 v8, v8, v44
  v_mfma_f32_32x32x16_bf16 a[0:15], a[224:227], v[96:99], a[0:15]
  buffer_load_dwordx4 v3, s[4:7], s18 offen offset:0 sc1 lds
  v_exp_f32 v46, v46
  v_add_f32 v9, v9, v45
  v_cvt_pk_bf16_f32 v102, v44, v45
  v_mfma_f32_32x32x16_bf16 a[16:31], a[228:231], v[96:99], a[16:31]
  s_waitcnt lgkmcnt(12)
  v_exp_f32 v47, v47
  v_add_f32 v8, v8, v46
  v_add_u32 v4, 16384, v4
  v_mfma_f32_32x32x16_bf16 a[32:47], a[232:235], v[96:99], a[32:47]
  buffer_load_dwordx4 v3, s[4:7], s18 offen offset:1024 sc1 lds
  v_exp_f32 v48, v48
  v_add_f32 v9, v9, v47
  v_cvt_pk_bf16_f32 v103, v46, v47
  v_mfma_f32_32x32x16_bf16 a[48:63], a[236:239], v[96:99], a[48:63]
  s_waitcnt lgkmcnt(10)
  s_add_u32 m0, s21, 8192
  v_exp_f32 v49, v49
  v_add_f32 v10, v10, v48
  v_and_b32 v4, 131071, v4
  v_mfma_f32_32x32x16_bf16 a[0:15], a[240:243], v[100:103], a[0:15]
  buffer_load_dwordx4 v3, s[4:7], s17 offen offset:0 sc1 lds
  v_exp_f32 v50, v50
  v_add_f32 v11, v11, v49
  v_cvt_pk_bf16_f32 v104, v48, v49
  v_mfma_f32_32x32x16_bf16 a[16:31], a[244:247], v[100:103], a[16:31]
  s_waitcnt lgkmcnt(8)
  s_cmp_lg_u32 s22, 0
  v_exp_f32 v51, v51
  v_add_f32 v10, v10, v50
  v_mfma_f32_32x32x16_bf16 a[32:47], a[248:251], v[100:103], a[32:47]
  buffer_load_dwordx4 v3, s[4:7], s17 offen offset:1024 sc1 lds
  v_exp_f32 v52, v52
  v_add_f32 v11, v11, v51
  v_cvt_pk_bf16_f32 v105, v50, v51
  v_mfma_f32_32x32x16_bf16 a[48:63], a[252:255], v[100:103], a[48:63]
  v_exp_f32 v53, v53
  v_add_f32 v10, v10, v52
  s_cbranch_scc1 A_top_33
  v_exp_f32 v54, v54
  v_add_f32 v11, v11, v53
  v_cvt_pk_bf16_f32 v106, v52, v53
  v_exp_f32 v55, v55
  v_add_f32 v10, v10, v54
  v_exp_f32 v56, v56
  v_add_f32 v11, v11, v55
  v_cvt_pk_bf16_f32 v107, v54, v55
  v_exp_f32 v57, v57
  v_add_f32 v10, v10, v56
  v_exp_f32 v58, v58
  v_add_f32 v11, v11, v57
  v_cvt_pk_bf16_f32 v108, v56, v57
  v_exp_f32 v59, v59
  v_add_f32 v10, v10, v58
  v_exp_f32 v60, v60
  v_add_f32 v11, v11, v59
  v_cvt_pk_bf16_f32 v109, v58, v59
  v_exp_f32 v61, v61
  v_add_f32 v10, v10, v60
  v_exp_f32 v62, v62
  v_add_f32 v11, v11, v61
  v_cvt_pk_bf16_f32 v110, v60, v61
  v_exp_f32 v63, v63
  v_add_f32 v10, v10, v62
  v_add_f32 v11, v11, v63
  v_cvt_pk_bf16_f32 v111, v62, v63
  s_nop 1
  v_mfma_f32_32x32x16_bf16 a[64:79], a[224:227], v[104:107], a[64:79]
  v_mfma_f32_32x32x16_bf16 a[80:95], a[228:231], v[104:107], a[80:95]
  v_mfma_f32_32x32x16_bf16 a[96:111], a[232:235], v[104:107], a[96:111]
  v_mfma_f32_32x32x16_bf16 a[112:127], a[236:239], v[104:107], a[112:127]
  v_mfma_f32_32x32x16_bf16 a[64:79], a[240:243], v[108:111], a[64:79]
  v_mfma_f32_32x32x16_bf16 a[80:95], a[244:247], v[108:111], a[80:95]
  v_mfma_f32_32x32x16_bf16 a[96:111], a[248:251], v[108:111], a[96:111]
  v_mfma_f32_32x32x16_bf16 a[112:127], a[252:255], v[108:111], a[112:127]
  v_add_f32 v8, v8, v9
  v_mov_b32 v9, v8
  s_nop 1
  v_permlane32_swap_b32 v8, v9
  s_nop 1
  v_add_f32 v8, v8, v9
  v_add_f32 v10, v10, v11
  v_mov_b32 v11, v10
  s_nop 1
  v_permlane32_swap_b32 v10, v11
  s_nop 1
  v_add_f32 v10, v10, v11
  v_subrev_u32 v12, 0x2f800000, v8
  v_subrev_u32 v13, 0x2f800000, v10
  v_max_u32 v12, v12, v13
  v_cmp_le_u32 vcc, 0x28000000, v12
  s_nop 1
  s_cmp_lg_u64 vcc, 0
  s_cselect_b32 s26, 1, 0
  v_mov_b32 v12, s26
  s_lshl_b32 s26, s16, 2
  s_add_u32 s26, s26, 131072
  v_mov_b32 v13, s26
  ds_write_b32 v13, v12
  v_mov_b32 v14, 131072
  s_waitcnt vmcnt(0) lgkmcnt(0)
  s_barrier
  ds_read_b128 v[16:19], v14
  v_rcp_f32 v8, v8
  v_rcp_f32 v10, v10
  s_waitcnt lgkmcnt(0)
  v_or3_b32 v12, v16, v17, v18
  v_or_b32 v12, v12, v19
  s_nop 0
  v_readfirstlane_b32 s26, v12
  s_nop 1
  s_cmp_gt_u32 s26, s29
  s_cbranch_scc1 A_slow_39
  s_add_u32 s28, s25, 100663296
  v_accvgpr_read_b32 v112, a0
  v_accvgpr_read_b32 v113, a1
  v_accvgpr_read_b32 v114, a2
  v_accvgpr_read_b32 v115, a3
  v_accvgpr_read_b32 v116, a4
  v_accvgpr_read_b32 v117, a5
  v_accvgpr_read_b32 v118, a6
  v_accvgpr_read_b32 v119, a7
  v_pk_mul_f32 v[112:113], v[112:113], v[8:9] op_sel_hi:[1,0]
  v_pk_mul_f32 v[114:115], v[114:115], v[8:9] op_sel_hi:[1,0]
  v_pk_mul_f32 v[116:117], v[116:117], v[8:9] op_sel_hi:[1,0]
  v_pk_mul_f32 v[118:119], v[118:119], v[8:9] op_sel_hi:[1,0]
  v_cvt_pk_bf16_f32 v120, v112, v113
  v_cvt_pk_bf16_f32 v121, v114, v115
  v_cvt_pk_bf16_f32 v122, v116, v117
  v_cvt_pk_bf16_f32 v123, v118, v119
  buffer_store_dwordx4 v[120:123], v2, s[4:7], s28 offen offset:0 sc1
  v_accvgpr_read_b32 v124, a8
  v_accvgpr_read_b32 v125, a9
  v_accvgpr_read_b32 v126, a10
  v_accvgpr_read_b32 v127, a11
  v_accvgpr_read_b32 v128, a12
  v_accvgpr_read_b32 v129, a13
  v_accvgpr_read_b32 v130, a14
  v_accvgpr_read_b32 v131, a15
  v_pk_mul_f32 v[124:125], v[124:125], v[8:9] op_sel_hi:[1,0]
  v_pk_mul_f32 v[126:127], v[126:127], v[8:9] op_sel_hi:[1,0]
  v_pk_mul_f32 v[128:129], v[128:129], v[8:9] op_sel_hi:[1,0]
  v_pk_mul_f32 v[130:131], v[130:131], v[8:9] op_sel_hi:[1,0]
  v_cvt_pk_bf16_f32 v132, v124, v125
  v_cvt_pk_bf16_f32 v133, v126, v127
  v_cvt_pk_bf16_f32 v134, v128, v129
  v_cvt_pk_bf16_f32 v135, v130, v131
  buffer_store_dwordx4 v[132:135], v2, s[4:7], s28 offen offset:1024 sc1
  v_accvgpr_read_b32 v136, a16
  v_accvgpr_read_b32 v137, a17
  v_accvgpr_read_b32 v138, a18
  v_accvgpr_read_b32 v139, a19
  v_accvgpr_read_b32 v140, a20
  v_accvgpr_read_b32 v141, a21
  v_accvgpr_read_b32 v142, a22
  v_accvgpr_read_b32 v143, a23
  v_pk_mul_f32 v[136:137], v[136:137], v[8:9] op_sel_hi:[1,0]
  v_pk_mul_f32 v[138:139], v[138:139], v[8:9] op_sel_hi:[1,0]
  v_pk_mul_f32 v[140:141], v[140:141], v[8:9] op_sel_hi:[1,0]
  v_pk_mul_f32 v[142:143], v[142:143], v[8:9] op_sel_hi:[1,0]
  v_cvt_pk_bf16_f32 v144, v136, v137
  v_cvt_pk_bf16_f32 v145, v138, v139
  v_cvt_pk_bf16_f32 v146, v140, v141
  v_cvt_pk_bf16_f32 v147, v142, v143
  buffer_store_dwordx4 v[144:147], v2, s[4:7], s28 offen offset:2048 sc1
  v_accvgpr_read_b32 v148, a24
  v_accvgpr_read_b32 v149, a25
  v_accvgpr_read_b32 v150, a26
  v_accvgpr_read_b32 v151, a27
  v_accvgpr_read_b32 v152, a28
  v_accvgpr_read_b32 v153, a29
  v_accvgpr_read_b32 v154, a30
  v_accvgpr_read_b32 v155, a31
  v_pk_mul_f32 v[148:149], v[148:149], v[8:9] op_sel_hi:[1,0]
  v_pk_mul_f32 v[150:151], v[150:151], v[8:9] op_sel_hi:[1,0]
  v_pk_mul_f32 v[152:153], v[152:153], v[8:9] op_sel_hi:[1,0]
  v_pk_mul_f32 v[154:155], v[154:155], v[8:9] op_sel_hi:[1,0]
  v_cvt_pk_bf16_f32 v156, v148, v149
  v_cvt_pk_bf16_f32 v157, v150, v151
  v_cvt_pk_bf16_f32 v158, v152, v153
  v_cvt_pk_bf16_f32 v159, v154, v155
  buffer_store_dwordx4 v[156:159], v2, s[4:7], s28 offen offset:3072 sc1
  s_add_u32 s28, s25, 100667392
  v_accvgpr_read_b32 v112, a32
  v_accvgpr_read_b32 v113, a33
  v_accvgpr_read_b32 v114, a34
  v_accvgpr_read_b32 v115, a35
  v_accvgpr_read_b32 v116, a36
  v_accvgpr_read_b32 v117, a37
  v_accvgpr_read_b32 v118, a38
  v_accvgpr_read_b32 v119, a39
  v_pk_mul_f32 v[112:113], v[112:113], v[8:9] op_sel_hi:[1,0]
  v_pk_mul_f32 v[114:115], v[114:115], v[8:9] op_sel_hi:[1,0]
  v_pk_mul_f32 v[116:117], v[116:117], v[8:9] op_sel_hi:[1,0]
  v_pk_mul_f32 v[118:119], v[118:119], v[8:9] op_sel_hi:[1,0]
  v_cvt_pk_bf16_f32 v120, v112, v113
  v_cvt_pk_bf16_f32 v121, v114, v115
  v_cvt_pk_bf16_f32 v122, v116, v117
  v_cvt_pk_bf16_f32 v123, v118, v119
  buffer_store_dwordx4 v[120:123], v2, s[4:7], s28 offen offset:0 sc1
  v_accvgpr_read_b32 v124, a40
  v_accvgpr_read_b32 v125, a41
  v_accvgpr_read_b32 v126, a42
  v_accvgpr_read_b32 v127, a43
  v_accvgpr_read_b32 v128, a44
  v_accvgpr_read_b32 v129, a45
  v_accvgpr_read_b32 v130, a46
  v_accvgpr_read_b32 v131, a47
  v_pk_mul_f32 v[124:125], v[124:125], v[8:9] op_sel_hi:[1,0]
  v_pk_mul_f32 v[126:127], v[126:127], v[8:9] op_sel_hi:[1,0]
  v_pk_mul_f32 v[128:129], v[128:129], v[8:9] op_sel_hi:[1,0]
  v_pk_mul_f32 v[130:131], v[130:131], v[8:9] op_sel_hi:[1,0]
  v_cvt_pk_bf16_f32 v132, v124, v125
  v_cvt_pk_bf16_f32 v133, v126, v127
  v_cvt_pk_bf16_f32 v134, v128, v129
  v_cvt_pk_bf16_f32 v135, v130, v131
  buffer_store_dwordx4 v[132:135], v2, s[4:7], s28 offen offset:1024 sc1
  v_accvgpr_read_b32 v136, a48
  v_accvgpr_read_b32 v137, a49
  v_accvgpr_read_b32 v138, a50
  v_accvgpr_read_b32 v139, a51
  v_accvgpr_read_b32 v140, a52
  v_accvgpr_read_b32 v141, a53
  v_accvgpr_read_b32 v142, a54
  v_accvgpr_read_b32 v143, a55
  v_pk_mul_f32 v[136:137], v[136:137], v[8:9] op_sel_hi:[1,0]
  v_pk_mul_f32 v[138:139], v[138:139], v[8:9] op_sel_hi:[1,0]
  v_pk_mul_f32 v[140:141], v[140:141], v[8:9] op_sel_hi:[1,0]
  v_pk_mul_f32 v[142:143], v[142:143], v[8:9] op_sel_hi:[1,0]
  v_cvt_pk_bf16_f32 v144, v136, v137
  v_cvt_pk_bf16_f32 v145, v138, v139
  v_cvt_pk_bf16_f32 v146, v140, v141
  v_cvt_pk_bf16_f32 v147, v142, v143
  buffer_store_dwordx4 v[144:147], v2, s[4:7], s28 offen offset:2048 sc1
  v_accvgpr_read_b32 v148, a56
  v_accvgpr_read_b32 v149, a57
  v_accvgpr_read_b32 v150, a58
  v_accvgpr_read_b32 v151, a59
  v_accvgpr_read_b32 v152, a60
  v_accvgpr_read_b32 v153, a61
  v_accvgpr_read_b32 v154, a62
  v_accvgpr_read_b32 v155, a63
  v_pk_mul_f32 v[148:149], v[148:149], v[8:9] op_sel_hi:[1,0]
  v_pk_mul_f32 v[150:151], v[150:151], v[8:9] op_sel_hi:[1,0]
  v_pk_mul_f32 v[152:153], v[152:153], v[8:9] op_sel_hi:[1,0]
  v_pk_mul_f32 v[154:155], v[154:155], v[8:9] op_sel_hi:[1,0]
  v_cvt_pk_bf16_f32 v156, v148, v149
  v_cvt_pk_bf16_f32 v157, v150, v151
  v_cvt_pk_bf16_f32 v158, v152, v153
  v_cvt_pk_bf16_f32 v159, v154, v155
  buffer_store_dwordx4 v[156:159], v2, s[4:7], s28 offen offset:3072 sc1
  s_add_u32 s28, s25, 100671488
  v_accvgpr_read_b32 v112, a64
  v_accvgpr_read_b32 v113, a65
  v_accvgpr_read_b32 v114, a66
  v_accvgpr_read_b32 v115, a67
  v_accvgpr_read_b32 v116, a68
  v_accvgpr_read_b32 v117, a69
  v_accvgpr_read_b32 v118, a70
  v_accvgpr_read_b32 v119, a71
  v_pk_mul_f32 v[112:113], v[112:113], v[10:11] op_sel_hi:[1,0]
  v_pk_mul_f32 v[114:115], v[114:115], v[10:11] op_sel_hi:[1,0]
  v_pk_mul_f32 v[116:117], v[116:117], v[10:11] op_sel_hi:[1,0]
  v_pk_mul_f32 v[118:119], v[118:119], v[10:11] op_sel_hi:[1,0]
  v_cvt_pk_bf16_f32 v120, v112, v113
  v_cvt_pk_bf16_f32 v121, v114, v115
  v_cvt_pk_bf16_f32 v122, v116, v117
  v_cvt_pk_bf16_f32 v123, v118, v119
  buffer_store_dwordx4 v[120:123], v2, s[4:7], s28 offen offset:0 sc1
  v_accvgpr_read_b32 v124, a72
  v_accvgpr_read_b32 v125, a73
  v_accvgpr_read_b32 v126, a74
  v_accvgpr_read_b32 v127, a75
  v_accvgpr_read_b32 v128, a76
  v_accvgpr_read_b32 v129, a77
  v_accvgpr_read_b32 v130, a78
  v_accvgpr_read_b32 v131, a79
  v_pk_mul_f32 v[124:125], v[124:125], v[10:11] op_sel_hi:[1,0]
  v_pk_mul_f32 v[126:127], v[126:127], v[10:11] op_sel_hi:[1,0]
  v_pk_mul_f32 v[128:129], v[128:129], v[10:11] op_sel_hi:[1,0]
  v_pk_mul_f32 v[130:131], v[130:131], v[10:11] op_sel_hi:[1,0]
  v_cvt_pk_bf16_f32 v132, v124, v125
  v_cvt_pk_bf16_f32 v133, v126, v127
  v_cvt_pk_bf16_f32 v134, v128, v129
  v_cvt_pk_bf16_f32 v135, v130, v131
  buffer_store_dwordx4 v[132:135], v2, s[4:7], s28 offen offset:1024 sc1
  v_accvgpr_read_b32 v136, a80
  v_accvgpr_read_b32 v137, a81
  v_accvgpr_read_b32 v138, a82
  v_accvgpr_read_b32 v139, a83
  v_accvgpr_read_b32 v140, a84
  v_accvgpr_read_b32 v141, a85
  v_accvgpr_read_b32 v142, a86
  v_accvgpr_read_b32 v143, a87
  v_pk_mul_f32 v[136:137], v[136:137], v[10:11] op_sel_hi:[1,0]
  v_pk_mul_f32 v[138:139], v[138:139], v[10:11] op_sel_hi:[1,0]
  v_pk_mul_f32 v[140:141], v[140:141], v[10:11] op_sel_hi:[1,0]
  v_pk_mul_f32 v[142:143], v[142:143], v[10:11] op_sel_hi:[1,0]
  v_cvt_pk_bf16_f32 v144, v136, v137
  v_cvt_pk_bf16_f32 v145, v138, v139
  v_cvt_pk_bf16_f32 v146, v140, v141
  v_cvt_pk_bf16_f32 v147, v142, v143
  buffer_store_dwordx4 v[144:147], v2, s[4:7], s28 offen offset:2048 sc1
  v_accvgpr_read_b32 v148, a88
  v_accvgpr_read_b32 v149, a89
  v_accvgpr_read_b32 v150, a90
  v_accvgpr_read_b32 v151, a91
  v_accvgpr_read_b32 v152, a92
  v_accvgpr_read_b32 v153, a93
  v_accvgpr_read_b32 v154, a94
  v_accvgpr_read_b32 v155, a95
  v_pk_mul_f32 v[148:149], v[148:149], v[10:11] op_sel_hi:[1,0]
  v_pk_mul_f32 v[150:151], v[150:151], v[10:11] op_sel_hi:[1,0]
  v_pk_mul_f32 v[152:153], v[152:153], v[10:11] op_sel_hi:[1,0]
  v_pk_mul_f32 v[154:155], v[154:155], v[10:11] op_sel_hi:[1,0]
  v_cvt_pk_bf16_f32 v156, v148, v149
  v_cvt_pk_bf16_f32 v157, v150, v151
  v_cvt_pk_bf16_f32 v158, v152, v153
  v_cvt_pk_bf16_f32 v159, v154, v155
  buffer_store_dwordx4 v[156:159], v2, s[4:7], s28 offen offset:3072 sc1
  s_add_u32 s28, s25, 100675584
  v_accvgpr_read_b32 v112, a96
  v_accvgpr_read_b32 v113, a97
  v_accvgpr_read_b32 v114, a98
  v_accvgpr_read_b32 v115, a99
  v_accvgpr_read_b32 v116, a100
  v_accvgpr_read_b32 v117, a101
  v_accvgpr_read_b32 v118, a102
  v_accvgpr_read_b32 v119, a103
  v_pk_mul_f32 v[112:113], v[112:113], v[10:11] op_sel_hi:[1,0]
  v_pk_mul_f32 v[114:115], v[114:115], v[10:11] op_sel_hi:[1,0]
  v_pk_mul_f32 v[116:117], v[116:117], v[10:11] op_sel_hi:[1,0]
  v_pk_mul_f32 v[118:119], v[118:119], v[10:11] op_sel_hi:[1,0]
  v_cvt_pk_bf16_f32 v120, v112, v113
  v_cvt_pk_bf16_f32 v121, v114, v115
  v_cvt_pk_bf16_f32 v122, v116, v117
  v_cvt_pk_bf16_f32 v123, v118, v119
  buffer_store_dwordx4 v[120:123], v2, s[4:7], s28 offen offset:0 sc1
  v_accvgpr_read_b32 v124, a104
  v_accvgpr_read_b32 v125, a105
  v_accvgpr_read_b32 v126, a106
  v_accvgpr_read_b32 v127, a107
  v_accvgpr_read_b32 v128, a108
  v_accvgpr_read_b32 v129, a109
  v_accvgpr_read_b32 v130, a110
  v_accvgpr_read_b32 v131, a111
  v_pk_mul_f32 v[124:125], v[124:125], v[10:11] op_sel_hi:[1,0]
  v_pk_mul_f32 v[126:127], v[126:127], v[10:11] op_sel_hi:[1,0]
  v_pk_mul_f32 v[128:129], v[128:129], v[10:11] op_sel_hi:[1,0]
  v_pk_mul_f32 v[130:131], v[130:131], v[10:11] op_sel_hi:[1,0]
  v_cvt_pk_bf16_f32 v132, v124, v125
  v_cvt_pk_bf16_f32 v133, v126, v127
  v_cvt_pk_bf16_f32 v134, v128, v129
  v_cvt_pk_bf16_f32 v135, v130, v131
  buffer_store_dwordx4 v[132:135], v2, s[4:7], s28 offen offset:1024 sc1
  v_accvgpr_read_b32 v136, a112
  v_accvgpr_read_b32 v137, a113
  v_accvgpr_read_b32 v138, a114
  v_accvgpr_read_b32 v139, a115
  v_accvgpr_read_b32 v140, a116
  v_accvgpr_read_b32 v141, a117
  v_accvgpr_read_b32 v142, a118
  v_accvgpr_read_b32 v143, a119
  v_pk_mul_f32 v[136:137], v[136:137], v[10:11] op_sel_hi:[1,0]
  v_pk_mul_f32 v[138:139], v[138:139], v[10:11] op_sel_hi:[1,0]
  v_pk_mul_f32 v[140:141], v[140:141], v[10:11] op_sel_hi:[1,0]
  v_pk_mul_f32 v[142:143], v[142:143], v[10:11] op_sel_hi:[1,0]
  v_cvt_pk_bf16_f32 v144, v136, v137
  v_cvt_pk_bf16_f32 v145, v138, v139
  v_cvt_pk_bf16_f32 v146, v140, v141
  v_cvt_pk_bf16_f32 v147, v142, v143
  buffer_store_dwordx4 v[144:147], v2, s[4:7], s28 offen offset:2048 sc1
  v_accvgpr_read_b32 v148, a120
  v_accvgpr_read_b32 v149, a121
  v_accvgpr_read_b32 v150, a122
  v_accvgpr_read_b32 v151, a123
  v_accvgpr_read_b32 v152, a124
  v_accvgpr_read_b32 v153, a125
  v_accvgpr_read_b32 v154, a126
  v_accvgpr_read_b32 v155, a127
  v_pk_mul_f32 v[148:149], v[148:149], v[10:11] op_sel_hi:[1,0]
  v_pk_mul_f32 v[150:151], v[150:151], v[10:11] op_sel_hi:[1,0]
  v_pk_mul_f32 v[152:153], v[152:153], v[10:11] op_sel_hi:[1,0]
  v_pk_mul_f32 v[154:155], v[154:155], v[10:11] op_sel_hi:[1,0]
  v_cvt_pk_bf16_f32 v156, v148, v149
  v_cvt_pk_bf16_f32 v157, v150, v151
  v_cvt_pk_bf16_f32 v158, v152, v153
  v_cvt_pk_bf16_f32 v159, v154, v155
  buffer_store_dwordx4 v[156:159], v2, s[4:7], s28 offen offset:3072 sc1
  s_branch A_out_36
A_kvw_37:
M_kv_40:
  s_cmp_ge_u32 s17, s36
  s_cbranch_scc1 M_kvok_41
  s_mov_b32 s76, 0
  s_mov_b32 s78, 23
  s_mov_b32 s77, 335872
  s_cmp_eq_u32 s68, 1
  s_cmov_b32 s76, 128
  s_cmov_b32 s78, 27
  s_cmov_b32 s77, 114688
  s_cmp_eq_u32 s68, 2
  s_cmov_b32 s76, 768
  s_cmov_b32 s78, 14
  s_cmov_b32 s77, 0
  s_add_u32 s76, s76, s67
  s_mov_b32 s71, 0
  s_branch M_sg_43
M_sw_42:
  s_sleep 8
  s_add_u32 s71, s71, 1
  s_cmp_gt_u32 s71, 262144
  s_cbranch_scc1 M_exit
M_sg_43:
  s_mov_b32 s79, 0
  s_atomic_or s79, s[72:73], s76 glc
  s_waitcnt lgkmcnt(0)
  s_cmp_lt_u32 s79, s78
  s_cbranch_scc1 M_sw_42
  s_add_u32 s36, s77, s19
  s_add_u32 s68, s68, 1
  s_branch M_kv_40
M_kvok_41:
  s_branch A_kvb_38
A_upd_34:
  s_cmp_eq_u32 s23, 2
  s_cbranch_scc1 A_upd2_44
  v_mov_b32 v12, s24
  v_cmp_le_i32 s[40:41], 0, v5
  v_cmp_le_i32 s[42:43], 1, v5
  v_cmp_le_i32 s[44:45], 2, v5
  v_cmp_le_i32 s[46:47], 3, v5
  v_cndmask_b32 v64, v12, v6, s[40:41]
  v_cndmask_b32 v65, v12, v6, s[42:43]
  v_cndmask_b32 v66, v12, v6, s[44:45]
  v_cndmask_b32 v67, v12, v6, s[46:47]
  v_cmp_le_i32 s[40:41], 8, v5
  v_cmp_le_i32 s[42:43], 9, v5
  v_cmp_le_i32 s[44:45], 10, v5
  v_cmp_le_i32 s[46:47], 11, v5
  v_cndmask_b32 v68, v12, v6, s[40:41]
  v_cndmask_b32 v69, v12, v6, s[42:43]
  v_cndmask_b32 v70, v12, v6, s[44:45]
  v_cndmask_b32 v71, v12, v6, s[46:47]
  v_cmp_le_i32 s[40:41], 16, v5
  v_cmp_le_i32 s[42:43], 17, v5
  v_cmp_le_i32 s[44:45], 18, v5
  v_cmp_le_i32 s[46:47], 19, v5
  v_cndmask_b32 v72, v12, v6, s[40:41]
  v_cndmask_b32 v73, v12, v6, s[42:43]
  v_cndmask_b32 v74, v12, v6, s[44:45]
  v_cndmask_b32 v75, v12, v6, s[46:47]
  v_cmp_le_i32 s[40:41], 24, v5
  v_cmp_le_i32 s[42:43], 25, v5
  v_cmp_le_i32 s[44:45], 26, v5
  v_cmp_le_i32 s[46:47], 27, v5
  v_cndmask_b32 v76, v12, v6, s[40:41]
  v_cndmask_b32 v77, v12, v6, s[42:43]
  v_cndmask_b32 v78, v12, v6, s[44:45]
  v_cndmask_b32 v79, v12, v6, s[46:47]
  v_mov_b32 v80, v7
  v_mov_b32 v81, v7
  v_mov_b32 v82, v7
  v_mov_b32 v83, v7
  v_mov_b32 v84, v7
  v_mov_b32 v85, v7
  v_mov_b32 v86, v7
  v_mov_b32 v87, v7
  v_mov_b32 v88, v7
  v_mov_b32 v89, v7
  v_mov_b32 v90, v7
  v_mov_b32 v91, v7
  v_mov_b32 v92, v7
  v_mov_b32 v93, v7
  v_mov_b32 v94, v7
  v_mov_b32 v95, v7
  s_branch A_back_35
A_upd2_44:
  v_mov_b32 v64, v6
  v_mov_b32 v65, v6
  v_mov_b32 v66, v6
  v_mov_b32 v67, v6
  v_mov_b32 v68, v6
  v_mov_b32 v69, v6
  v_mov_b32 v70, v6
  v_mov_b32 v71, v6
  v_mov_b32 v72, v6
  v_mov_b32 v73, v6
  v_mov_b32 v74, v6
  v_mov_b32 v75, v6
  v_mov_b32 v76, v6
  v_mov_b32 v77, v6
  v_mov_b32 v78, v6
  v_mov_b32 v79, v6
  s_branch A_back_35
A_slow_39:
  s_mov_b32 s29, 1
  v_mov_b32 v64, s24
  v_mov_b32 v65, s24
  v_mov_b32 v66, s24
  v_mov_b32 v67, s24
  v_mov_b32 v68, s24
  v_mov_b32 v69, s24
  v_mov_b32 v70, s24
  v_mov_b32 v71, s24
  v_mov_b32 v72, s24
  v_mov_b32 v73, s24
  v_mov_b32 v74, s24
  v_mov_b32 v75, s24
  v_mov_b32 v76, s24
  v_mov_b32 v77, s24
  v_mov_b32 v78, s24
  v_mov_b32 v79, s24
  v_mov_b32 v12, s24
  v_cmp_le_i32 s[40:41], 0, v5
  v_cmp_le_i32 s[42:43], 1, v5
  v_cmp_le_i32 s[44:45], 2, v5
  v_cmp_le_i32 s[46:47], 3, v5
  v_cndmask_b32 v80, v12, v7, s[40:41]
  v_cndmask_b32 v81, v12, v7, s[42:43]
  v_cndmask_b32 v82, v12, v7, s[44:45]
  v_cndmask_b32 v83, v12, v7, s[46:47]
  v_cmp_le_i32 s[40:41], 8, v5
  v_cmp_le_i32 s[42:43], 9, v5
  v_cmp_le_i32 s[44:45], 10, v5
  v_cmp_le_i32 s[46:47], 11, v5
  v_cndmask_b32 v84, v12, v7, s[40:41]
  v_cndmask_b32 v85, v12, v7, s[42:43]
  v_cndmask_b32 v86, v12, v7, s[44:45]
  v_cndmask_b32 v87, v12, v7, s[46:47]
  v_cmp_le_i32 s[40:41], 16, v5
  v_cmp_le_i32 s[42:43], 17, v5
  v_cmp_le_i32 s[44:45], 18, v5
  v_cmp_le_i32 s[46:47], 19, v5
  v_cndmask_b32 v88, v12, v7, s[40:41]
  v_cndmask_b32 v89, v12, v7, s[42:43]
  v_cndmask_b32 v90, v12, v7, s[44:45]
  v_cndmask_b32 v91, v12, v7, s[46:47]
  v_cmp_le_i32 s[40:41], 24, v5
  v_cmp_le_i32 s[42:43], 25, v5
  v_cmp_le_i32 s[44:45], 26, v5
  v_cmp_le_i32 s[46:47], 27, v5
  v_cndmask_b32 v92, v12, v7, s[40:41]
  v_cndmask_b32 v93, v12, v7, s[42:43]
  v_cndmask_b32 v94, v12, v7, s[44:45]
  v_cndmask_b32 v95, v12, v7, s[46:47]
  v_mov_b32 v8, s24
  v_mov_b32 v10, s24
  s_add_u32 s17, s25, 16785408
  s_mov_b32 s23, 0
A_ml_45:
  s_add_u32 s28, s17, 4096
  buffer_load_dwordx4 a[192:195], v2, s[4:7], s17 offen offset:0 sc1
  buffer_load_dwordx4 a[196:199], v2, s[4:7], s17 offen offset:1024 sc1
  buffer_load_dwordx4 a[200:203], v2, s[4:7], s17 offen offset:2048 sc1
  buffer_load_dwordx4 a[204:207], v2, s[4:7], s17 offen offset:3072 sc1
  buffer_load_dwordx4 a[208:211], v2, s[4:7], s28 offen offset:0 sc1
  buffer_load_dwordx4 a[212:215], v2, s[4:7], s28 offen offset:1024 sc1
  buffer_load_dwordx4 a[216:219], v2, s[4:7], s28 offen offset:2048 sc1
  buffer_load_dwordx4 a[220:223], v2, s[4:7], s28 offen offset:3072 sc1
  s_waitcnt vmcnt(0)
  v_mfma_f32_32x32x16_bf16 v[32:47], a[192:195], a[128:131], v[64:79]
  v_mfma_f32_32x32x16_bf16 v[32:47], a[196:199], a[132:135], v[32:47]
  v_mfma_f32_32x32x16_bf16 v[32:47], a[200:203], a[136:139], v[32:47]
  v_mfma_f32_32x32x16_bf16 v[32:47], a[204:207], a[140:143], v[32:47]
  v_mfma_f32_32x32x16_bf16 v[32:47], a[208:211], a[144:147], v[32:47]
  v_mfma_f32_32x32x16_bf16 v[32:47], a[212:215], a[148:151], v[32:47]
  v_mfma_f32_32x32x16_bf16 v[32:47], a[216:219], a[152:155], v[32:47]
  v_mfma_f32_32x32x16_bf16 v[32:47], a[220:223], a[156:159], v[32:47]
  v_mfma_f32_32x32x16_bf16 v[48:63], a[192:195], a[160:163], v[80:95]
  v_mfma_f32_32x32x16_bf16 v[48:63], a[196:199], a[164:167], v[48:63]
  v_mfma_f32_32x32x16_bf16 v[48:63], a[200:203], a[168:171], v[48:63]
  v_mfma_f32_32x32x16_bf16 v[48:63], a[204:207], a[172:175], v[48:63]
  v_mfma_f32_32x32x16_bf16 v[48:63], a[208:211], a[176:179], v[48:63]
  v_mfma_f32_32x32x16_bf16 v[48:63], a[212:215], a[180:183], v[48:63]
  v_mfma_f32_32x32x16_bf16 v[48:63], a[216:219], a[184:187], v[48:63]
  v_mfma_f32_32x32x16_bf16 v[48:63], a[220:223], a[188:191], v[48:63]
  s_nop 7
  s_nop 3
  v_max3_f32 v8, v8, v32, v33
  v_max3_f32 v8, v8, v34, v35
  v_max3_f32 v8, v8, v36, v37
  v_max3_f32 v8, v8, v38, v39
  v_max3_f32 v8, v8, v40, v41
  v_max3_f32 v8, v8, v42, v43
  v_max3_f32 v8, v8, v44, v45
  v_max3_f32 v8, v8, v46, v47
  v_max3_f32 v10, v10, v48, v49
  v_max3_f32 v10, v10, v50, v51
  v_max3_f32 v10, v10, v52, v53
  v_max3_f32 v10, v10, v54, v55
  v_max3_f32 v10, v10, v56, v57
  v_max3_f32 v10, v10, v58, v59
  v_max3_f32 v10, v10, v60, v61
  v_max3_f32 v10, v10, v62, v63
  s_add_u32 s23, s23, 1
  s_cmp_lg_u32 s23, 1
  s_cbranch_scc1 A_m2_46
  v_mov_b32 v12, s24
  v_cmp_le_i32 s[40:41], 0, v5
  v_cmp_le_i32 s[42:43], 1, v5
  v_cmp_le_i32 s[44:45], 2, v5
  v_cmp_le_i32 s[46:47], 3, v5
  v_cndmask_b32 v64, v12, v6, s[40:41]
  v_cndmask_b32 v65, v12, v6, s[42:43]
  v_cndmask_b32 v66, v12, v6, s[44:45]
  v_cndmask_b32 v67, v12, v6, s[46:47]
  v_cmp_le_i32 s[40:41], 8, v5
  v_cmp_le_i32 s[42:43], 9, v5
  v_cmp_le_i32 s[44:45], 10, v5
  v_cmp_le_i32 s[46:47], 11, v5
  v_cndmask_b32 v68, v12, v6, s[40:41]
  v_cndmask_b32 v69, v12, v6, s[42:43]
  v_cndmask_b32 v70, v12, v6, s[44:45]
  v_cndmask_b32 v71, v12, v6, s[46:47]
  v_cmp_le_i32 s[40:41], 16, v5
  v_cmp_le_i32 s[42:43], 17, v5
  v_cmp_le_i32 s[44:45], 18, v5
  v_cmp_le_i32 s[46:47], 19, v5
  v_cndmask_b32 v72, v12, v6, s[40:41]
  v_cndmask_b32 v73, v12, v6, s[42:43]
  v_cndmask_b32 v74, v12, v6, s[44:45]
  v_cndmask_b32 v75, v12, v6, s[46:47]
  v_cmp_le_i32 s[40:41], 24, v5
  v_cmp_le_i32 s[42:43], 25, v5
  v_cmp_le_i32 s[44:45], 26, v5
  v_cmp_le_i32 s[46:47], 27, v5
  v_cndmask_b32 v76, v12, v6, s[40:41]
  v_cndmask_b32 v77, v12, v6, s[42:43]
  v_cndmask_b32 v78, v12, v6, s[44:45]
  v_cndmask_b32 v79, v12, v6, s[46:47]
  v_mov_b32 v80, v7
  v_mov_b32 v81, v7
  v_mov_b32 v82, v7
  v_mov_b32 v83, v7
  v_mov_b32 v84, v7
  v_mov_b32 v85, v7
  v_mov_b32 v86, v7
  v_mov_b32 v87, v7
  v_mov_b32 v88, v7
  v_mov_b32 v89, v7
  v_mov_b32 v90, v7
  v_mov_b32 v91, v7
  v_mov_b32 v92, v7
  v_mov_b32 v93, v7
  v_mov_b32 v94, v7
  v_mov_b32 v95, v7
A_m2_46:
  s_cmp_lg_u32 s23, 2
  s_cbranch_scc1 A_m3_47
  v_mov_b32 v64, v6
  v_mov_b32 v65, v6
  v_mov_b32 v66, v6
  v_mov_b32 v67, v6
  v_mov_b32 v68, v6
  v_mov_b32 v69, v6
  v_mov_b32 v70, v6
  v_mov_b32 v71, v6
  v_mov_b32 v72, v6
  v_mov_b32 v73, v6
  v_mov_b32 v74, v6
  v_mov_b32 v75, v6
  v_mov_b32 v76, v6
  v_mov_b32 v77, v6
  v_mov_b32 v78, v6
  v_mov_b32 v79, v6
A_m3_47:
  s_sub_u32 s17, s17, 8192
  s_cmp_ge_i32 s17, s19
  s_cbranch_scc1 A_ml_45
  v_mov_b32 v9, v8
  s_nop 1
  v_permlane32_swap_b32 v8, v9
  s_nop 1
  v_max_f32 v8, v8, v9
  v_sub_f32 v6, 0, v8
  v_mov_b32 v11, v10
  s_nop 1
  v_permlane32_swap_b32 v10, v11
  s_nop 1
  v_max_f32 v10, v10, v11
  v_sub_f32 v7, 0, v10
  s_branch A_again_26
A_out_36:
  s_mov_b32 s69, s55
  s_mov_b32 s70, s56
  s_sub_u32 s52, s52, 1
  s_cmp_lg_u32 s52, 0
  s_cbranch_scc1 M_att
  s_waitcnt vmcnt(0)
  s_barrier
  s_mov_b32 s30, 512
  v_mov_b32 v144, s30
  v_min_u32 v145, 1, v0
  v_lshlrev_b32 v145, 30, v145
  buffer_store_dword v144, v145, s[4:7], s31 offen sc1
  s_lshr_b32 s48, s64, 2
  s_bfe_u32 s49, s64, 0x10001
  s_and_b32 s50, s64, 1
  s_mul_i32 s50, s50, 6
  s_add_u32 s50, s50, s65
  s_mov_b32 s51, 12
  s_cmp_lt_u32 s50, 4
  s_cselect_b32 s23, 6, 5
  s_load_dwordx2 s[8:9], s[0:1], 40
  s_lshl_b32 s17, s48, 19
  s_lshl_b32 s26, s49, 2
  s_add_u32 s26, s26, s16
  s_lshl_b32 s27, s26, 7
  s_add_u32 s17, s17, s27
  s_mov_b32 s18, 1024
  s_lshl_b32 s21, s48, 6
  s_add_u32 s21, s21, s50
  s_lshl_b32 s21, s21, 3
  s_add_u32 s21, s21, s26
  s_lshl_b32 s21, s21, 12
  s_add_u32 s21, s21, 150994944
  s_lshl_b32 s22, s51, 15
  s_mov_b32 s24, 1.0
  s_waitcnt lgkmcnt(0)
  s_and_b32 s9, s9, 0xffff
  s_mov_b32 s10, 4194304
  s_mov_b32 s11, 0x20000
  s_mov_b32 s12, s4
  s_mov_b32 s13, s5
  s_mov_b32 s14, 268435456
  s_mov_b32 s15, 0x20000
  s_lshl_b32 s19, s48, 8
  s_add_u32 s19, s19, s50
  s_lshl_b32 s19, s19, 13
  s_add_u32 s19, s19, 100663296
  s_lshl_b32 s20, s51, 13
  v_lshrrev_b32 v144, 4, v1
  v_and_b32 v56, 0xff, v2
  v_lshl_add_u32 v56, v144, 9, v56
  s_mul_i32 s26, s16, 524288
  v_add_u32 v8, 0, v56
  v_add_u32 v16, 0, v2
  v_add_u32 v16, s26, v16
  v_add_u32 v9, 256, v56
  v_add_u32 v17, 1024, v2
  v_add_u32 v17, s26, v17
  v_add_u32 v10, 2048, v56
  v_add_u32 v18, 2048, v2
  v_add_u32 v18, s26, v18
  v_add_u32 v11, 2304, v56
  v_add_u32 v19, 3072, v2
  v_add_u32 v19, s26, v19
  v_add_u32 v12, 4096, v56
  v_add_u32 v20, 4096, v2
  v_add_u32 v20, s26, v20
  v_add_u32 v13, 4352, v56
  v_add_u32 v21, 5120, v2
  v_add_u32 v21, s26, v21
  v_add_u32 v14, 6144, v56
  v_add_u32 v22, 6144, v2
  v_add_u32 v22, s26, v22
  v_add_u32 v15, 6400, v56
  v_add_u32 v23, 7168, v2
  v_add_u32 v23, s26, v23
  v_lshrrev_b32 v144, 3, v1
  v_mul_lo_u32 v144, v144, s18
  v_and_b32 v145, 7, v1
  v_lshl_add_u32 v144, v145, 4, v144
  s_lshl_b32 s28, s16, 15
  s_add_u32 s28, s28, 32768
  s_lshl_b32 s29, s18, 3
  s_add_u32 m0, s28, 0
  s_nop 0
  buffer_load_dwordx4 v144, s[8:11], s17 offen lds
  s_add_u32 s17, s17, s29
  s_add_u32 m0, s28, 1024
  s_nop 0
  buffer_load_dwordx4 v144, s[8:11], s17 offen lds
  s_add_u32 s17, s17, s29
  s_add_u32 m0, s28, 2048
  s_nop 0
  buffer_load_dwordx4 v144, s[8:11], s17 offen lds
  s_add_u32 s17, s17, s29
  s_add_u32 m0, s28, 3072
  s_nop 0
  buffer_load_dwordx4 v144, s[8:11], s17 offen lds
  s_add_u32 s17, s17, s29
  s_add_u32 m0, s28, 4096
  s_nop 0
  buffer_load_dwordx4 v144, s[8:11], s17 offen lds
  s_add_u32 s17, s17, s29
  s_add_u32 m0, s28, 5120
  s_nop 0
  buffer_load_dwordx4 v144, s[8:11], s17 offen lds
  s_add_u32 s17, s17, s29
  s_add_u32 m0, s28, 6144
  s_nop 0
  buffer_load_dwordx4 v144, s[8:11], s17 offen lds
  s_add_u32 s17, s17, s29
  s_add_u32 m0, s28, 7168
  s_nop 0
  buffer_load_dwordx4 v144, s[8:11], s17 offen lds
  s_add_u32 s17, s17, s29
  s_add_u32 m0, s28, 8192
  s_nop 0
  buffer_load_dwordx4 v144, s[8:11], s17 offen lds
  s_add_u32 s17, s17, s29
  s_add_u32 m0, s28, 9216
  s_nop 0
  buffer_load_dwordx4 v144, s[8:11], s17 offen lds
  s_add_u32 s17, s17, s29
  s_add_u32 m0, s28, 10240
  s_nop 0
  buffer_load_dwordx4 v144, s[8:11], s17 offen lds
  s_add_u32 s17, s17, s29
  s_add_u32 m0, s28, 11264
  s_nop 0
  buffer_load_dwordx4 v144, s[8:11], s17 offen lds
  s_add_u32 s17, s17, s29
  s_add_u32 m0, s28, 12288
  s_nop 0
  buffer_load_dwordx4 v144, s[8:11], s17 offen lds
  s_add_u32 s17, s17, s29
  s_add_u32 m0, s28, 13312
  s_nop 0
  buffer_load_dwordx4 v144, s[8:11], s17 offen lds
  s_add_u32 s17, s17, s29
  s_add_u32 m0, s28, 14336
  s_nop 0
  buffer_load_dwordx4 v144, s[8:11], s17 offen lds
  s_add_u32 s17, s17, s29
  s_add_u32 m0, s28, 15360
  s_nop 0
  buffer_load_dwordx4 v144, s[8:11], s17 offen lds
  s_add_u32 s17, s17, s29
  s_add_u32 m0, s28, 16384
  s_nop 0
  buffer_load_dwordx4 v144, s[8:11], s17 offen lds
  s_add_u32 s17, s17, s29
  s_add_u32 m0, s28, 17408
  s_nop 0
  buffer_load_dwordx4 v144, s[8:11], s17 offen lds
  s_add_u32 s17, s17, s29
  s_add_u32 m0, s28, 18432
  s_nop 0
  buffer_load_dwordx4 v144, s[8:11], s17 offen lds
  s_add_u32 s17, s17, s29
  s_add_u32 m0, s28, 19456
  s_nop 0
  buffer_load_dwordx4 v144, s[8:11], s17 offen lds
  s_add_u32 s17, s17, s29
  s_add_u32 m0, s28, 20480
  s_nop 0
  buffer_load_dwordx4 v144, s[8:11], s17 offen lds
  s_add_u32 s17, s17, s29
  s_add_u32 m0, s28, 21504
  s_nop 0
  buffer_load_dwordx4 v144, s[8:11], s17 offen lds
  s_add_u32 s17, s17, s29
  s_add_u32 m0, s28, 22528
  s_nop 0
  buffer_load_dwordx4 v144, s[8:11], s17 offen lds
  s_add_u32 s17, s17, s29
  s_add_u32 m0, s28, 23552
  s_nop 0
  buffer_load_dwordx4 v144, s[8:11], s17 offen lds
  s_add_u32 s17, s17, s29
  s_add_u32 m0, s28, 24576
  s_nop 0
  buffer_load_dwordx4 v144, s[8:11], s17 offen lds
  s_add_u32 s17, s17, s29
  s_add_u32 m0, s28, 25600
  s_nop 0
  buffer_load_dwordx4 v144, s[8:11], s17 offen lds
  s_add_u32 s17, s17, s29
  s_add_u32 m0, s28, 26624
  s_nop 0
  buffer_load_dwordx4 v144, s[8:11], s17 offen lds
  s_add_u32 s17, s17, s29
  s_add_u32 m0, s28, 27648
  s_nop 0
  buffer_load_dwordx4 v144, s[8:11], s17 offen lds
  s_add_u32 s17, s17, s29
  s_add_u32 m0, s28, 28672
  s_nop 0
  buffer_load_dwordx4 v144, s[8:11], s17 offen lds
  s_add_u32 s17, s17, s29
  s_add_u32 m0, s28, 29696
  s_nop 0
  buffer_load_dwordx4 v144, s[8:11], s17 offen lds
  s_add_u32 s17, s17, s29
  s_add_u32 m0, s28, 30720
  s_nop 0
  buffer_load_dwordx4 v144, s[8:11], s17 offen lds
  s_add_u32 s17, s17, s29
  s_add_u32 m0, s28, 31744
  s_nop 0
  buffer_load_dwordx4 v144, s[8:11], s17 offen lds
  s_add_u32 s17, s17, s29
  v_bfe_u32 v148, v1, 2, 2
  v_lshrrev_b32 v149, 5, v1
  v_lshl_add_u32 v148, v149, 4, v148
  v_bfe_u32 v149, v1, 4, 1
  v_lshl_add_u32 v148, v149, 2, v148
  v_and_b32 v149, 3, v1
  v_lshlrev_b32 v149, 4, v149
  s_mov_b32 s26, 8
  v_lshl_add_u32 v148, v148, 7, v149
  v_add_u32 v152, s28, v148
  v_add_u32 v153, 1024, v152
  v_add_u32 v154, s26, v152
  v_add_u32 v155, s26, v153
  s_waitcnt vmcnt(28)
  ds_read_b64_tr_b16 a[0:1], v152 offset:0
  ds_read_b64_tr_b16 a[2:3], v153 offset:0
  ds_read_b64_tr_b16 a[4:5], v154 offset:0
  ds_read_b64_tr_b16 a[6:7], v155 offset:0
  ds_read_b64_tr_b16 a[8:9], v152 offset:64
  ds_read_b64_tr_b16 a[10:11], v153 offset:64
  ds_read_b64_tr_b16 a[12:13], v154 offset:64
  ds_read_b64_tr_b16 a[14:15], v155 offset:64
  s_waitcnt lgkmcnt(0)
  s_add_u32 m0, s28, 0
  s_nop 0
  buffer_load_dwordx4 v144, s[8:11], s17 offen lds
  s_add_u32 s17, s17, s29
  s_add_u32 m0, s28, 1024
  s_nop 0
  buffer_load_dwordx4 v144, s[8:11], s17 offen lds
  s_add_u32 s17, s17, s29
  s_add_u32 m0, s28, 2048
  s_nop 0
  buffer_load_dwordx4 v144, s[8:11], s17 offen lds
  s_add_u32 s17, s17, s29
  s_add_u32 m0, s28, 3072
  s_nop 0
  buffer_load_dwordx4 v144, s[8:11], s17 offen lds
  s_add_u32 s17, s17, s29
  s_waitcnt vmcnt(28)
  ds_read_b64_tr_b16 a[16:17], v152 offset:4096
  ds_read_b64_tr_b16 a[18:19], v153 offset:4096
  ds_read_b64_tr_b16 a[20:21], v154 offset:4096
  ds_read_b64_tr_b16 a[22:23], v155 offset:4096
  ds_read_b64_tr_b16 a[24:25], v152 offset:4160
  ds_read_b64_tr_b16 a[26:27], v153 offset:4160
  ds_read_b64_tr_b16 a[28:29], v154 offset:4160
  ds_read_b64_tr_b16 a[30:31], v155 offset:4160
  s_waitcnt lgkmcnt(0)
  s_add_u32 m0, s28, 4096
  s_nop 0
  buffer_load_dwordx4 v144, s[8:11], s17 offen lds
  s_add_u32 s17, s17, s29
  s_add_u32 m0, s28, 5120
  s_nop 0
  buffer_load_dwordx4 v144, s[8:11], s17 offen lds
  s_add_u32 s17, s17, s29
  s_add_u32 m0, s28, 6144
  s_nop 0
  buffer_load_dwordx4 v144, s[8:11], s17 offen lds
  s_add_u32 s17, s17, s29
  s_add_u32 m0, s28, 7168
  s_nop 0
  buffer_load_dwordx4 v144, s[8:11], s17 offen lds
  s_add_u32 s17, s17, s29
  s_waitcnt vmcnt(28)
  ds_read_b64_tr_b16 a[32:33], v152 offset:8192
  ds_read_b64_tr_b16 a[34:35], v153 offset:8192
  ds_read_b64_tr_b16 a[36:37], v154 offset:8192
  ds_read_b64_tr_b16 a[38:39], v155 offset:8192
  ds_read_b64_tr_b16 a[40:41], v152 offset:8256
  ds_read_b64_tr_b16 a[42:43], v153 offset:8256
  ds_read_b64_tr_b16 a[44:45], v154 offset:8256
  ds_read_b64_tr_b16 a[46:47], v155 offset:8256
  s_waitcnt lgkmcnt(0)
  s_add_u32 m0, s28, 8192
  s_nop 0
  buffer_load_dwordx4 v144, s[8:11], s17 offen lds
  s_add_u32 s17, s17, s29
  s_add_u32 m0, s28, 9216
  s_nop 0
  buffer_load_dwordx4 v144, s[8:11], s17 offen lds
  s_add_u32 s17, s17, s29
  s_add_u32 m0, s28, 10240
  s_nop 0
  buffer_load_dwordx4 v144, s[8:11], s17 offen lds
  s_add_u32 s17, s17, s29
  s_add_u32 m0, s28, 11264
  s_nop 0
  buffer_load_dwordx4 v144, s[8:11], s17 offen lds
  s_add_u32 s17, s17, s29
  s_waitcnt vmcnt(28)
  ds_read_b64_tr_b16 a[48:49], v152 offset:12288
  ds_read_b64_tr_b16 a[50:51], v153 offset:12288
  ds_read_b64_tr_b16 a[52:53], v154 offset:12288
  ds_read_b64_tr_b16 a[54:55], v155 offset:12288
  ds_read_b64_tr_b16 a[56:57], v152 offset:12352
  ds_read_b64_tr_b16 a[58:59], v153 offset:12352
  ds_read_b64_tr_b16 a[60:61], v154 offset:12352
  ds_read_b64_tr_b16 a[62:63], v155 offset:12352
  s_waitcnt lgkmcnt(0)
  s_add_u32 m0, s28, 12288
  s_nop 0
  buffer_load_dwordx4 v144, s[8:11], s17 offen lds
  s_add_u32 s17, s17, s29
  s_add_u32 m0, s28, 13312
  s_nop 0
  buffer_load_dwordx4 v144, s[8:11], s17 offen lds
  s_add_u32 s17, s17, s29
  s_add_u32 m0, s28, 14336
  s_nop 0
  buffer_load_dwordx4 v144, s[8:11], s17 offen lds
  s_add_u32 s17, s17, s29
  s_add_u32 m0, s28, 15360
  s_nop 0
  buffer_load_dwordx4 v144, s[8:11], s17 offen lds
  s_add_u32 s17, s17, s29
  s_waitcnt vmcnt(28)
  ds_read_b64_tr_b16 a[64:65], v152 offset:16384
  ds_read_b64_tr_b16 a[66:67], v153 offset:16384
  ds_read_b64_tr_b16 a[68:69], v154 offset:16384
  ds_read_b64_tr_b16 a[70:71], v155 offset:16384
  ds_read_b64_tr_b16 a[72:73], v152 offset:16448
  ds_read_b64_tr_b16 a[74:75], v153 offset:16448
  ds_read_b64_tr_b16 a[76:77], v154 offset:16448
  ds_read_b64_tr_b16 a[78:79], v155 offset:16448
  s_waitcnt lgkmcnt(0)
  s_add_u32 m0, s28, 16384
  s_nop 0
  buffer_load_dwordx4 v144, s[8:11], s17 offen lds
  s_add_u32 s17, s17, s29
  s_add_u32 m0, s28, 17408
  s_nop 0
  buffer_load_dwordx4 v144, s[8:11], s17 offen lds
  s_add_u32 s17, s17, s29
  s_add_u32 m0, s28, 18432
  s_nop 0
  buffer_load_dwordx4 v144, s[8:11], s17 offen lds
  s_add_u32 s17, s17, s29
  s_add_u32 m0, s28, 19456
  s_nop 0
  buffer_load_dwordx4 v144, s[8:11], s17 offen lds
  s_add_u32 s17, s17, s29
  s_waitcnt vmcnt(28)
  ds_read_b64_tr_b16 a[80:81], v152 offset:20480
  ds_read_b64_tr_b16 a[82:83], v153 offset:20480
  ds_read_b64_tr_b16 a[84:85], v154 offset:20480
  ds_read_b64_tr_b16 a[86:87], v155 offset:20480
  ds_read_b64_tr_b16 a[88:89], v152 offset:20544
  ds_read_b64_tr_b16 a[90:91], v153 offset:20544
  ds_read_b64_tr_b16 a[92:93], v154 offset:20544
  ds_read_b64_tr_b16 a[94:95], v155 offset:20544
  s_waitcnt lgkmcnt(0)
  s_add_u32 m0, s28, 20480
  s_nop 0
  buffer_load_dwordx4 v144, s[8:11], s17 offen lds
  s_add_u32 s17, s17, s29
  s_add_u32 m0, s28, 21504
  s_nop 0
  buffer_load_dwordx4 v144, s[8:11], s17 offen lds
  s_add_u32 s17, s17, s29
  s_add_u32 m0, s28, 22528
  s_nop 0
  buffer_load_dwordx4 v144, s[8:11], s17 offen lds
  s_add_u32 s17, s17, s29
  s_add_u32 m0, s28, 23552
  s_nop 0
  buffer_load_dwordx4 v144, s[8:11], s17 offen lds
  s_add_u32 s17, s17, s29
  s_waitcnt vmcnt(28)
  ds_read_b64_tr_b16 a[96:97], v152 offset:24576
  ds_read_b64_tr_b16 a[98:99], v153 offset:24576
  ds_read_b64_tr_b16 a[100:101], v154 offset:24576
  ds_read_b64_tr_b16 a[102:103], v155 offset:24576
  ds_read_b64_tr_b16 a[104:105], v152 offset:24640
  ds_read_b64_tr_b16 a[106:107], v153 offset:24640
  ds_read_b64_tr_b16 a[108:109], v154 offset:24640
  ds_read_b64_tr_b16 a[110:111], v155 offset:24640
  s_waitcnt lgkmcnt(0)
  s_add_u32 m0, s28, 24576
  s_nop 0
  buffer_load_dwordx4 v144, s[8:11], s17 offen lds
  s_add_u32 s17, s17, s29
  s_add_u32 m0, s28, 25600
  s_nop 0
  buffer_load_dwordx4 v144, s[8:11], s17 offen lds
  s_add_u32 s17, s17, s29
  s_add_u32 m0, s28, 26624
  s_nop 0
  buffer_load_dwordx4 v144, s[8:11], s17 offen lds
  s_add_u32 s17, s17, s29
  s_add_u32 m0, s28, 27648
  s_nop 0
  buffer_load_dwordx4 v144, s[8:11], s17 offen lds
  s_add_u32 s17, s17, s29
  s_waitcnt vmcnt(28)
  ds_read_b64_tr_b16 a[112:113], v152 offset:28672
  ds_read_b64_tr_b16 a[114:115], v153 offset:28672
  ds_read_b64_tr_b16 a[116:117], v154 offset:28672
  ds_read_b64_tr_b16 a[118:119], v155 offset:28672
  ds_read_b64_tr_b16 a[120:121], v152 offset:28736
  ds_read_b64_tr_b16 a[122:123], v153 offset:28736
  ds_read_b64_tr_b16 a[124:125], v154 offset:28736
  ds_read_b64_tr_b16 a[126:127], v155 offset:28736
  s_waitcnt lgkmcnt(0)
  s_add_u32 m0, s28, 28672
  s_nop 0
  buffer_load_dwordx4 v144, s[8:11], s17 offen lds
  s_add_u32 s17, s17, s29
  s_add_u32 m0, s28, 29696
  s_nop 0
  buffer_load_dwordx4 v144, s[8:11], s17 offen lds
  s_add_u32 s17, s17, s29
  s_add_u32 m0, s28, 30720
  s_nop 0
  buffer_load_dwordx4 v144, s[8:11], s17 offen lds
  s_add_u32 s17, s17, s29
  s_add_u32 m0, s28, 31744
  s_nop 0
  buffer_load_dwordx4 v144, s[8:11], s17 offen lds
  s_add_u32 s17, s17, s29
  s_waitcnt vmcnt(28)
  ds_read_b64_tr_b16 a[128:129], v152 offset:0
  ds_read_b64_tr_b16 a[130:131], v153 offset:0
  ds_read_b64_tr_b16 a[132:133], v154 offset:0
  ds_read_b64_tr_b16 a[134:135], v155 offset:0
  ds_read_b64_tr_b16 a[136:137], v152 offset:64
  ds_read_b64_tr_b16 a[138:139], v153 offset:64
  ds_read_b64_tr_b16 a[140:141], v154 offset:64
  ds_read_b64_tr_b16 a[142:143], v155 offset:64
  s_waitcnt lgkmcnt(0)
  s_waitcnt vmcnt(24)
  ds_read_b64_tr_b16 a[144:145], v152 offset:4096
  ds_read_b64_tr_b16 a[146:147], v153 offset:4096
  ds_read_b64_tr_b16 a[148:149], v154 offset:4096
  ds_read_b64_tr_b16 a[150:151], v155 offset:4096
  ds_read_b64_tr_b16 a[152:153], v152 offset:4160
  ds_read_b64_tr_b16 a[154:155], v153 offset:4160
  ds_read_b64_tr_b16 a[156:157], v154 offset:4160
  ds_read_b64_tr_b16 a[158:159], v155 offset:4160
  s_waitcnt lgkmcnt(0)
  s_waitcnt vmcnt(20)
  ds_read_b64_tr_b16 a[160:161], v152 offset:8192
  ds_read_b64_tr_b16 a[162:163], v153 offset:8192
  ds_read_b64_tr_b16 a[164:165], v154 offset:8192
  ds_read_b64_tr_b16 a[166:167], v155 offset:8192
  ds_read_b64_tr_b16 a[168:169], v152 offset:8256
  ds_read_b64_tr_b16 a[170:171], v153 offset:8256
  ds_read_b64_tr_b16 a[172:173], v154 offset:8256
  ds_read_b64_tr_b16 a[174:175], v155 offset:8256
  s_waitcnt lgkmcnt(0)
  s_waitcnt vmcnt(16)
  ds_read_b64_tr_b16 a[176:177], v152 offset:12288
  ds_read_b64_tr_b16 a[178:179], v153 offset:12288
  ds_read_b64_tr_b16 a[180:181], v154 offset:12288
  ds_read_b64_tr_b16 a[182:183], v155 offset:12288
  ds_read_b64_tr_b16 a[184:185], v152 offset:12352
  ds_read_b64_tr_b16 a[186:187], v153 offset:12352
  ds_read_b64_tr_b16 a[188:189], v154 offset:12352
  ds_read_b64_tr_b16 a[190:191], v155 offset:12352
  s_waitcnt lgkmcnt(0)
  s_waitcnt vmcnt(12)
  ds_read_b64_tr_b16 a[192:193], v152 offset:16384
  ds_read_b64_tr_b16 a[194:195], v153 offset:16384
  ds_read_b64_tr_b16 a[196:197], v154 offset:16384
  ds_read_b64_tr_b16 a[198:199], v155 offset:16384
  ds_read_b64_tr_b16 a[200:201], v152 offset:16448
  ds_read_b64_tr_b16 a[202:203], v153 offset:16448
  ds_read_b64_tr_b16 a[204:205], v154 offset:16448
  ds_read_b64_tr_b16 a[206:207], v155 offset:16448
  s_waitcnt lgkmcnt(0)
  s_waitcnt vmcnt(8)
  ds_read_b64_tr_b16 a[208:209], v152 offset:20480
  ds_read_b64_tr_b16 a[210:211], v153 offset:20480
  ds_read_b64_tr_b16 a[212:213], v154 offset:20480
  ds_read_b64_tr_b16 a[214:215], v155 offset:20480
  ds_read_b64_tr_b16 a[216:217], v152 offset:20544
  ds_read_b64_tr_b16 a[218:219], v153 offset:20544
  ds_read_b64_tr_b16 a[220:221], v154 offset:20544
  ds_read_b64_tr_b16 a[222:223], v155 offset:20544
  s_waitcnt lgkmcnt(0)
  s_waitcnt vmcnt(4)
  ds_read_b64_tr_b16 a[224:225], v152 offset:24576
  ds_read_b64_tr_b16 a[226:227], v153 offset:24576
  ds_read_b64_tr_b16 a[228:229], v154 offset:24576
  ds_read_b64_tr_b16 a[230:231], v155 offset:24576
  ds_read_b64_tr_b16 a[232:233], v152 offset:24640
  ds_read_b64_tr_b16 a[234:235], v153 offset:24640
  ds_read_b64_tr_b16 a[236:237], v154 offset:24640
  ds_read_b64_tr_b16 a[238:239], v155 offset:24640
  s_waitcnt lgkmcnt(0)
  s_waitcnt vmcnt(0)
  ds_read_b64_tr_b16 a[240:241], v152 offset:28672
  ds_read_b64_tr_b16 a[242:243], v153 offset:28672
  ds_read_b64_tr_b16 a[244:245], v154 offset:28672
  ds_read_b64_tr_b16 a[246:247], v155 offset:28672
  ds_read_b64_tr_b16 a[248:249], v152 offset:28736
  ds_read_b64_tr_b16 a[250:251], v153 offset:28736
  ds_read_b64_tr_b16 a[252:253], v154 offset:28736
  ds_read_b64_tr_b16 a[254:255], v155 offset:28736
  s_waitcnt lgkmcnt(0)
  v_min_u32 v4, 27, v1
  v_mul_u32_u24 v5, 37, v4
  v_lshrrev_b32 v5, 8, v5
  v_mul_u32_u24 v5, 7, v5
  v_sub_u32 v5, v4, v5
  v_mov_b32 v6, 0x200
  v_cmp_ne_u32 vcc, 6, v5
  s_mul_i32 s76, s48, 3584
  s_add_u32 s76, s76, 148897792
  v_cndmask_b32 v5, 0, v6, vcc
  v_lshl_add_u32 v4, v4, 7, s76
  s_mov_b32 s71, 0
  s_branch M_vg_49
M_vw_48:
  s_sleep 2
  s_add_u32 s71, s71, 1
  s_cmp_gt_u32 s71, 262144
  s_cbranch_scc1 M_exit
M_vg_49:
  buffer_load_dword v6, v4, s[4:7], 0 offen sc1
  s_waitcnt vmcnt(0)
  v_cmp_lt_u32 vcc, v6, v5
  s_cbranch_vccnz M_vw_48
  s_barrier
  s_lshl_b32 s25, s16, 13
  s_add_u32 m0, s25, 0
  s_nop 0
  buffer_load_dwordx4 v16, s[12:15], s19 offen sc1 lds
  s_add_u32 m0, s25, 1024
  s_nop 0
  buffer_load_dwordx4 v17, s[12:15], s19 offen sc1 lds
  s_add_u32 m0, s25, 2048
  s_nop 0
  buffer_load_dwordx4 v18, s[12:15], s19 offen sc1 lds
  s_add_u32 m0, s25, 3072
  s_nop 0
  buffer_load_dwordx4 v19, s[12:15], s19 offen sc1 lds
  s_add_u32 m0, s25, 4096
  s_nop 0
  buffer_load_dwordx4 v20, s[12:15], s19 offen sc1 lds
  s_add_u32 m0, s25, 5120
  s_nop 0
  buffer_load_dwordx4 v21, s[12:15], s19 offen sc1 lds
  s_add_u32 m0, s25, 6144
  s_nop 0
  buffer_load_dwordx4 v22, s[12:15], s19 offen sc1 lds
  s_add_u32 m0, s25, 7168
  s_nop 0
  buffer_load_dwordx4 v23, s[12:15], s19 offen sc1 lds
  s_cmp_gt_u32 s23, 1
  s_cselect_b32 s26, s20, 0
  s_add_u32 s19, s19, s26
  s_add_u32 s25, s25, 32768
  s_and_b32 s25, s25, 0x1ffff
  s_add_u32 m0, s25, 0
  s_nop 0
  buffer_load_dwordx4 v16, s[12:15], s19 offen sc1 lds
  s_add_u32 m0, s25, 1024
  s_nop 0
  buffer_load_dwordx4 v17, s[12:15], s19 offen sc1 lds
  s_add_u32 m0, s25, 2048
  s_nop 0
  buffer_load_dwordx4 v18, s[12:15], s19 offen sc1 lds
  s_add_u32 m0, s25, 3072
  s_nop 0
  buffer_load_dwordx4 v19, s[12:15], s19 offen sc1 lds
  s_add_u32 m0, s25, 4096
  s_nop 0
  buffer_load_dwordx4 v20, s[12:15], s19 offen sc1 lds
  s_add_u32 m0, s25, 5120
  s_nop 0
  buffer_load_dwordx4 v21, s[12:15], s19 offen sc1 lds
  s_add_u32 m0, s25, 6144
  s_nop 0
  buffer_load_dwordx4 v22, s[12:15], s19 offen sc1 lds
  s_add_u32 m0, s25, 7168
  s_nop 0
  buffer_load_dwordx4 v23, s[12:15], s19 offen sc1 lds
  s_cmp_gt_u32 s23, 2
  s_cselect_b32 s26, s20, 0
  s_add_u32 s19, s19, s26
  s_add_u32 s25, s25, 32768
  s_and_b32 s25, s25, 0x1ffff
  s_waitcnt vmcnt(0)
  s_barrier
  s_mov_b32 s27, s21
  v_mov_b32 v7, 0x40000000
  ds_read_b128 v[24:27], v8 offset:0
  ds_read_b128 v[28:31], v9 offset:0
  ds_read_b128 v[32:35], v10 offset:0
  ds_read_b128 v[36:39], v11 offset:0
  ds_read_b128 v[40:43], v12 offset:0
  ds_read_b128 v[44:47], v13 offset:0
.p2align 6
G_top_50:
  s_waitcnt lgkmcnt(5)
  v_mfma_f32_16x16x32_bf16 v[64:67], a[0:3], v[24:27], 0
  s_add_u32 m0, s25, 0
  ds_read_b128 v[48:51], v14 offset:0
  v_mfma_f32_16x16x32_bf16 v[68:71], a[4:7], v[24:27], 0
  v_mfma_f32_16x16x32_bf16 v[80:83], a[8:11], v[24:27], 0
  buffer_load_dwordx4 v16, s[12:15], s19 offen sc1 lds
  v_mfma_f32_16x16x32_bf16 v[84:87], a[12:15], v[24:27], 0
  s_waitcnt lgkmcnt(5)
  v_mfma_f32_16x16x32_bf16 v[72:75], a[0:3], v[28:31], 0
  ds_read_b128 v[52:55], v15 offset:0
  v_mfma_f32_16x16x32_bf16 v[76:79], a[4:7], v[28:31], 0
  v_cvt_pk_bf16_f32 v128, v96, v97
  v_cvt_pk_bf16_f32 v129, v98, v99
  v_mfma_f32_16x16x32_bf16 v[88:91], a[8:11], v[28:31], 0
  v_mfma_f32_16x16x32_bf16 v[92:95], a[12:15], v[28:31], 0
  s_waitcnt lgkmcnt(5)
  v_cvt_pk_bf16_f32 v130, v100, v101
  v_cvt_pk_bf16_f32 v131, v102, v103
  v_mfma_f32_16x16x32_bf16 v[64:67], a[16:19], v[32:35], v[64:67]
  s_add_u32 m0, s25, 1024
  ds_read_b128 v[24:27], v8 offset:8192
  v_mfma_f32_16x16x32_bf16 v[68:71], a[20:23], v[32:35], v[68:71]
  v_mfma_f32_16x16x32_bf16 v[80:83], a[24:27], v[32:35], v[80:83]
  buffer_load_dwordx4 v17, s[12:15], s19 offen sc1 lds
  v_mfma_f32_16x16x32_bf16 v[84:87], a[28:31], v[32:35], v[84:87]
  s_waitcnt lgkmcnt(5)
  v_mfma_f32_16x16x32_bf16 v[72:75], a[16:19], v[36:39], v[72:75]
  ds_read_b128 v[28:31], v9 offset:8192
  v_mfma_f32_16x16x32_bf16 v[76:79], a[20:23], v[36:39], v[76:79]
  v_mfma_f32_16x16x32_bf16 v[88:91], a[24:27], v[36:39], v[88:91]
  v_mfma_f32_16x16x32_bf16 v[92:95], a[28:31], v[36:39], v[92:95]
  s_waitcnt lgkmcnt(5)
  v_mfma_f32_16x16x32_bf16 v[64:67], a[32:35], v[40:43], v[64:67]
  s_add_u32 m0, s25, 2048
  ds_read_b128 v[32:35], v10 offset:8192
  v_mfma_f32_16x16x32_bf16 v[68:71], a[36:39], v[40:43], v[68:71]
  v_cvt_pk_bf16_f32 v132, v104, v105
  v_cvt_pk_bf16_f32 v133, v106, v107
  v_mfma_f32_16x16x32_bf16 v[80:83], a[40:43], v[40:43], v[80:83]
  buffer_load_dwordx4 v18, s[12:15], s19 offen sc1 lds
  v_mfma_f32_16x16x32_bf16 v[84:87], a[44:47], v[40:43], v[84:87]
  s_waitcnt lgkmcnt(5)
  v_cvt_pk_bf16_f32 v134, v108, v109
  v_cvt_pk_bf16_f32 v135, v110, v111
  v_mfma_f32_16x16x32_bf16 v[72:75], a[32:35], v[44:47], v[72:75]
  ds_read_b128 v[36:39], v11 offset:8192
  v_mfma_f32_16x16x32_bf16 v[76:79], a[36:39], v[44:47], v[76:79]
  v_mfma_f32_16x16x32_bf16 v[88:91], a[40:43], v[44:47], v[88:91]
  v_mfma_f32_16x16x32_bf16 v[92:95], a[44:47], v[44:47], v[92:95]
  s_waitcnt lgkmcnt(5)
  v_mfma_f32_16x16x32_bf16 v[64:67], a[48:51], v[48:51], v[64:67]
  s_add_u32 m0, s25, 3072
  ds_read_b128 v[40:43], v12 offset:8192
  v_mfma_f32_16x16x32_bf16 v[68:71], a[52:55], v[48:51], v[68:71]
  v_mfma_f32_16x16x32_bf16 v[80:83], a[56:59], v[48:51], v[80:83]
  buffer_load_dwordx4 v19, s[12:15], s19 offen sc1 lds
  v_mfma_f32_16x16x32_bf16 v[84:87], a[60:63], v[48:51], v[84:87]
  s_waitcnt lgkmcnt(5)
  v_mfma_f32_16x16x32_bf16 v[72:75], a[48:51], v[52:55], v[72:75]
  ds_read_b128 v[44:47], v13 offset:8192
  v_mfma_f32_16x16x32_bf16 v[76:79], a[52:55], v[52:55], v[76:79]
  v_cvt_pk_bf16_f32 v136, v112, v113
  v_cvt_pk_bf16_f32 v137, v114, v115
  v_mfma_f32_16x16x32_bf16 v[88:91], a[56:59], v[52:55], v[88:91]
  v_mfma_f32_16x16x32_bf16 v[92:95], a[60:63], v[52:55], v[92:95]
  s_waitcnt lgkmcnt(5)
  v_cvt_pk_bf16_f32 v138, v116, v117
  v_cvt_pk_bf16_f32 v139, v118, v119
  v_mfma_f32_16x16x32_bf16 v[64:67], a[64:67], v[24:27], v[64:67]
  s_add_u32 m0, s25, 4096
  ds_read_b128 v[48:51], v14 offset:8192
  v_mfma_f32_16x16x32_bf16 v[68:71], a[68:71], v[24:27], v[68:71]
  v_mfma_f32_16x16x32_bf16 v[80:83], a[72:75], v[24:27], v[80:83]
  buffer_load_dwordx4 v20, s[12:15], s19 offen sc1 lds
  v_mfma_f32_16x16x32_bf16 v[84:87], a[76:79], v[24:27], v[84:87]
  s_waitcnt lgkmcnt(5)
  v_mfma_f32_16x16x32_bf16 v[72:75], a[64:67], v[28:31], v[72:75]
  ds_read_b128 v[52:55], v15 offset:8192
  v_mfma_f32_16x16x32_bf16 v[76:79], a[68:71], v[28:31], v[76:79]
  v_mfma_f32_16x16x32_bf16 v[88:91], a[72:75], v[28:31], v[88:91]
  v_mfma_f32_16x16x32_bf16 v[92:95], a[76:79], v[28:31], v[92:95]
  s_waitcnt lgkmcnt(5)
  v_mfma_f32_16x16x32_bf16 v[64:67], a[80:83], v[32:35], v[64:67]
  s_add_u32 m0, s25, 5120
  ds_read_b128 v[24:27], v8 offset:16384
  v_mfma_f32_16x16x32_bf16 v[68:71], a[84:87], v[32:35], v[68:71]
  v_cvt_pk_bf16_f32 v140, v120, v121
  v_cvt_pk_bf16_f32 v141, v122, v123
  v_mfma_f32_16x16x32_bf16 v[80:83], a[88:91], v[32:35], v[80:83]
  buffer_load_dwordx4 v21, s[12:15], s19 offen sc1 lds
  v_mfma_f32_16x16x32_bf16 v[84:87], a[92:95], v[32:35], v[84:87]
  s_waitcnt lgkmcnt(5)
  v_cvt_pk_bf16_f32 v142, v124, v125
  v_cvt_pk_bf16_f32 v143, v126, v127
  v_mfma_f32_16x16x32_bf16 v[72:75], a[80:83], v[36:39], v[72:75]
  ds_read_b128 v[28:31], v9 offset:16384
  v_mfma_f32_16x16x32_bf16 v[76:79], a[84:87], v[36:39], v[76:79]
  v_mfma_f32_16x16x32_bf16 v[88:91], a[88:91], v[36:39], v[88:91]
  v_mfma_f32_16x16x32_bf16 v[92:95], a[92:95], v[36:39], v[92:95]
  s_waitcnt lgkmcnt(5)
  v_mfma_f32_16x16x32_bf16 v[64:67], a[96:99], v[40:43], v[64:67]
  s_add_u32 m0, s25, 6144
  ds_read_b128 v[32:35], v10 offset:16384
  v_mfma_f32_16x16x32_bf16 v[68:71], a[100:103], v[40:43], v[68:71]
  v_mfma_f32_16x16x32_bf16 v[80:83], a[104:107], v[40:43], v[80:83]
  buffer_load_dwordx4 v22, s[12:15], s19 offen sc1 lds
  v_mfma_f32_16x16x32_bf16 v[84:87], a[108:111], v[40:43], v[84:87]
  s_waitcnt lgkmcnt(5)
  v_mfma_f32_16x16x32_bf16 v[72:75], a[96:99], v[44:47], v[72:75]
  ds_read_b128 v[36:39], v11 offset:16384
  v_mfma_f32_16x16x32_bf16 v[76:79], a[100:103], v[44:47], v[76:79]
  v_mfma_f32_16x16x32_bf16 v[88:91], a[104:107], v[44:47], v[88:91]
  v_mfma_f32_16x16x32_bf16 v[92:95], a[108:111], v[44:47], v[92:95]
  s_waitcnt lgkmcnt(5)
  v_mfma_f32_16x16x32_bf16 v[64:67], a[112:115], v[48:51], v[64:67]
  s_add_u32 m0, s25, 7168
  ds_read_b128 v[40:43], v12 offset:16384
  v_mfma_f32_16x16x32_bf16 v[68:71], a[116:119], v[48:51], v[68:71]
  v_mfma_f32_16x16x32_bf16 v[80:83], a[120:123], v[48:51], v[80:83]
  buffer_load_dwordx4 v23, s[12:15], s19 offen sc1 lds
  v_mfma_f32_16x16x32_bf16 v[84:87], a[124:127], v[48:51], v[84:87]
  s_waitcnt lgkmcnt(5)
  v_mfma_f32_16x16x32_bf16 v[72:75], a[112:115], v[52:55], v[72:75]
  s_cmp_gt_u32 s23, 3
  ds_read_b128 v[44:47], v13 offset:16384
  v_mfma_f32_16x16x32_bf16 v[76:79], a[116:119], v[52:55], v[76:79]
  v_mfma_f32_16x16x32_bf16 v[88:91], a[120:123], v[52:55], v[88:91]
  s_cselect_b32 s26, s20, 0
  v_mfma_f32_16x16x32_bf16 v[92:95], a[124:127], v[52:55], v[92:95]
  s_waitcnt lgkmcnt(5)
  v_mfma_f32_16x16x32_bf16 v[64:67], a[128:131], v[24:27], v[64:67]
  s_add_u32 s19, s19, s26
  ds_read_b128 v[48:51], v14 offset:16384
  v_mfma_f32_16x16x32_bf16 v[68:71], a[132:135], v[24:27], v[68:71]
  v_mfma_f32_16x16x32_bf16 v[80:83], a[136:139], v[24:27], v[80:83]
  s_add_u32 s25, s25, 32768
  v_mfma_f32_16x16x32_bf16 v[84:87], a[140:143], v[24:27], v[84:87]
  s_waitcnt lgkmcnt(5)
  v_mfma_f32_16x16x32_bf16 v[72:75], a[128:131], v[28:31], v[72:75]
  s_and_b32 s25, s25, 0x1ffff
  ds_read_b128 v[52:55], v15 offset:16384
  v_mfma_f32_16x16x32_bf16 v[76:79], a[132:135], v[28:31], v[76:79]
  v_mfma_f32_16x16x32_bf16 v[88:91], a[136:139], v[28:31], v[88:91]
  buffer_store_dwordx4 v[128:131], v7, s[4:7], s21 offen offset:0 sc1
  v_mfma_f32_16x16x32_bf16 v[92:95], a[140:143], v[28:31], v[92:95]
  s_waitcnt lgkmcnt(5)
  v_mfma_f32_16x16x32_bf16 v[64:67], a[144:147], v[32:35], v[64:67]
  ds_read_b128 v[24:27], v8 offset:24576
  v_mfma_f32_16x16x32_bf16 v[68:71], a[148:151], v[32:35], v[68:71]
  v_mfma_f32_16x16x32_bf16 v[80:83], a[152:155], v[32:35], v[80:83]
  v_mfma_f32_16x16x32_bf16 v[84:87], a[156:159], v[32:35], v[84:87]
  s_waitcnt lgkmcnt(5)
  v_mfma_f32_16x16x32_bf16 v[72:75], a[144:147], v[36:39], v[72:75]
  ds_read_b128 v[28:31], v9 offset:24576
  v_mfma_f32_16x16x32_bf16 v[76:79], a[148:151], v[36:39], v[76:79]
  v_mfma_f32_16x16x32_bf16 v[88:91], a[152:155], v[36:39], v[88:91]
  buffer_store_dwordx4 v[132:135], v7, s[4:7], s21 offen offset:256 sc1
  v_mfma_f32_16x16x32_bf16 v[92:95], a[156:159], v[36:39], v[92:95]
  s_waitcnt lgkmcnt(5)
  v_mfma_f32_16x16x32_bf16 v[64:67], a[160:163], v[40:43], v[64:67]
  ds_read_b128 v[32:35], v10 offset:24576
  v_mfma_f32_16x16x32_bf16 v[68:71], a[164:167], v[40:43], v[68:71]
  v_mfma_f32_16x16x32_bf16 v[80:83], a[168:171], v[40:43], v[80:83]
  v_mfma_f32_16x16x32_bf16 v[84:87], a[172:175], v[40:43], v[84:87]
  s_waitcnt lgkmcnt(5)
  v_mfma_f32_16x16x32_bf16 v[72:75], a[160:163], v[44:47], v[72:75]
  ds_read_b128 v[36:39], v11 offset:24576
  v_mfma_f32_16x16x32_bf16 v[76:79], a[164:167], v[44:47], v[76:79]
  v_mfma_f32_16x16x32_bf16 v[88:91], a[168:171], v[44:47], v[88:91]
  buffer_store_dwordx4 v[136:139], v7, s[4:7], s21 offen offset:2048 sc1
  v_mfma_f32_16x16x32_bf16 v[92:95], a[172:175], v[44:47], v[92:95]
  s_waitcnt lgkmcnt(5)
  v_mfma_f32_16x16x32_bf16 v[64:67], a[176:179], v[48:51], v[64:67]
  ds_read_b128 v[40:43], v12 offset:24576
  v_mfma_f32_16x16x32_bf16 v[68:71], a[180:183], v[48:51], v[68:71]
  v_mfma_f32_16x16x32_bf16 v[80:83], a[184:187], v[48:51], v[80:83]
  v_mfma_f32_16x16x32_bf16 v[84:87], a[188:191], v[48:51], v[84:87]
  s_waitcnt lgkmcnt(5)
  v_mfma_f32_16x16x32_bf16 v[72:75], a[176:179], v[52:55], v[72:75]
  ds_read_b128 v[44:47], v13 offset:24576
  v_mfma_f32_16x16x32_bf16 v[76:79], a[180:183], v[52:55], v[76:79]
  v_mfma_f32_16x16x32_bf16 v[88:91], a[184:187], v[52:55], v[88:91]
  buffer_store_dwordx4 v[140:143], v7, s[4:7], s21 offen offset:2304 sc1
  v_mfma_f32_16x16x32_bf16 v[92:95], a[188:191], v[52:55], v[92:95]
  s_waitcnt lgkmcnt(5)
  v_mfma_f32_16x16x32_bf16 v[64:67], a[192:195], v[24:27], v[64:67]
  s_mov_b32 s21, s27
  ds_read_b128 v[48:51], v14 offset:24576
  v_mfma_f32_16x16x32_bf16 v[68:71], a[196:199], v[24:27], v[68:71]
  v_mov_b32 v7, v56
  v_mfma_f32_16x16x32_bf16 v[80:83], a[200:203], v[24:27], v[80:83]
  v_mfma_f32_16x16x32_bf16 v[84:87], a[204:207], v[24:27], v[84:87]
  s_waitcnt lgkmcnt(5)
  v_mfma_f32_16x16x32_bf16 v[72:75], a[192:195], v[28:31], v[72:75]
  s_add_u32 s27, s27, s22
  ds_read_b128 v[52:55], v15 offset:24576
  v_mfma_f32_16x16x32_bf16 v[76:79], a[196:199], v[28:31], v[76:79]
  v_mfma_f32_16x16x32_bf16 v[88:91], a[200:203], v[28:31], v[88:91]
  s_waitcnt vmcnt(16)
  s_barrier
  v_mfma_f32_16x16x32_bf16 v[92:95], a[204:207], v[28:31], v[92:95]
  s_waitcnt lgkmcnt(5)
  v_mfma_f32_16x16x32_bf16 v[64:67], a[208:211], v[32:35], v[64:67]
  ds_read_b128 v[24:27], v8 offset:32768
  v_mfma_f32_16x16x32_bf16 v[68:71], a[212:215], v[32:35], v[68:71]
  v_mfma_f32_16x16x32_bf16 v[80:83], a[216:219], v[32:35], v[80:83]
  v_mfma_f32_16x16x32_bf16 v[84:87], a[220:223], v[32:35], v[84:87]
  s_waitcnt lgkmcnt(5)
  v_mfma_f32_16x16x32_bf16 v[72:75], a[208:211], v[36:39], v[72:75]
  ds_read_b128 v[28:31], v9 offset:32768
  v_mfma_f32_16x16x32_bf16 v[76:79], a[212:215], v[36:39], v[76:79]
  v_mfma_f32_16x16x32_bf16 v[88:91], a[216:219], v[36:39], v[88:91]
  v_mfma_f32_16x16x32_bf16 v[92:95], a[220:223], v[36:39], v[92:95]
  s_waitcnt lgkmcnt(5)
  v_mfma_f32_16x16x32_bf16 v[64:67], a[224:227], v[40:43], v[64:67]
  ds_read_b128 v[32:35], v10 offset:32768
  v_mfma_f32_16x16x32_bf16 v[68:71], a[228:231], v[40:43], v[68:71]
  v_mfma_f32_16x16x32_bf16 v[80:83], a[232:235], v[40:43], v[80:83]
  v_mfma_f32_16x16x32_bf16 v[84:87], a[236:239], v[40:43], v[84:87]
  s_waitcnt lgkmcnt(5)
  v_mfma_f32_16x16x32_bf16 v[72:75], a[224:227], v[44:47], v[72:75]
  ds_read_b128 v[36:39], v11 offset:32768
  v_mfma_f32_16x16x32_bf16 v[76:79], a[228:231], v[44:47], v[76:79]
  v_mfma_f32_16x16x32_bf16 v[88:91], a[232:235], v[44:47], v[88:91]
  v_mfma_f32_16x16x32_bf16 v[92:95], a[236:239], v[44:47], v[92:95]
  s_waitcnt lgkmcnt(5)
  v_mfma_f32_16x16x32_bf16 v[64:67], a[240:243], v[48:51], v[64:67]
  s_sub_u32 s23, s23, 1
  ds_read_b128 v[40:43], v12 offset:32768
  v_mfma_f32_16x16x32_bf16 v[68:71], a[244:247], v[48:51], v[68:71]
  v_mfma_f32_16x16x32_bf16 v[80:83], a[248:251], v[48:51], v[80:83]
  v_mfma_f32_16x16x32_bf16 v[84:87], a[252:255], v[48:51], v[84:87]
  s_waitcnt lgkmcnt(5)
  v_mfma_f32_16x16x32_bf16 v[72:75], a[240:243], v[52:55], v[72:75]
  s_cmp_eq_u32 s23, 0
  ds_read_b128 v[44:47], v13 offset:32768
  v_mfma_f32_16x16x32_bf16 v[76:79], a[244:247], v[52:55], v[76:79]
  v_mfma_f32_16x16x32_bf16 v[88:91], a[248:251], v[52:55], v[88:91]
  v_mfma_f32_16x16x32_bf16 v[92:95], a[252:255], v[52:55], v[92:95]
  s_cbranch_scc1 G_done0_51
  s_waitcnt lgkmcnt(5)
  v_mfma_f32_16x16x32_bf16 v[96:99], a[0:3], v[24:27], 0
  s_add_u32 m0, s25, 0
  ds_read_b128 v[48:51], v14 offset:32768
  v_mfma_f32_16x16x32_bf16 v[100:103], a[4:7], v[24:27], 0
  v_mfma_f32_16x16x32_bf16 v[112:115], a[8:11], v[24:27], 0
  buffer_load_dwordx4 v16, s[12:15], s19 offen sc1 lds
  v_mfma_f32_16x16x32_bf16 v[116:119], a[12:15], v[24:27], 0
  s_waitcnt lgkmcnt(5)
  v_mfma_f32_16x16x32_bf16 v[104:107], a[0:3], v[28:31], 0
  ds_read_b128 v[52:55], v15 offset:32768
  v_mfma_f32_16x16x32_bf16 v[108:111], a[4:7], v[28:31], 0
  v_cvt_pk_bf16_f32 v128, v64, v65
  v_cvt_pk_bf16_f32 v129, v66, v67
  v_mfma_f32_16x16x32_bf16 v[120:123], a[8:11], v[28:31], 0
  v_mfma_f32_16x16x32_bf16 v[124:127], a[12:15], v[28:31], 0
  s_waitcnt lgkmcnt(5)
  v_cvt_pk_bf16_f32 v130, v68, v69
  v_cvt_pk_bf16_f32 v131, v70, v71
  v_mfma_f32_16x16x32_bf16 v[96:99], a[16:19], v[32:35], v[96:99]
  s_add_u32 m0, s25, 1024
  ds_read_b128 v[24:27], v8 offset:40960
  v_mfma_f32_16x16x32_bf16 v[100:103], a[20:23], v[32:35], v[100:103]
  v_mfma_f32_16x16x32_bf16 v[112:115], a[24:27], v[32:35], v[112:115]
  buffer_load_dwordx4 v17, s[12:15], s19 offen sc1 lds
  v_mfma_f32_16x16x32_bf16 v[116:119], a[28:31], v[32:35], v[116:119]
  s_waitcnt lgkmcnt(5)
  v_mfma_f32_16x16x32_bf16 v[104:107], a[16:19], v[36:39], v[104:107]
  ds_read_b128 v[28:31], v9 offset:40960
  v_mfma_f32_16x16x32_bf16 v[108:111], a[20:23], v[36:39], v[108:111]
  v_mfma_f32_16x16x32_bf16 v[120:123], a[24:27], v[36:39], v[120:123]
  v_mfma_f32_16x16x32_bf16 v[124:127], a[28:31], v[36:39], v[124:127]
  s_waitcnt lgkmcnt(5)
  v_mfma_f32_16x16x32_bf16 v[96:99], a[32:35], v[40:43], v[96:99]
  s_add_u32 m0, s25, 2048
  ds_read_b128 v[32:35], v10 offset:40960
  v_mfma_f32_16x16x32_bf16 v[100:103], a[36:39], v[40:43], v[100:103]
  v_cvt_pk_bf16_f32 v132, v72, v73
  v_cvt_pk_bf16_f32 v133, v74, v75
  v_mfma_f32_16x16x32_bf16 v[112:115], a[40:43], v[40:43], v[112:115]
  buffer_load_dwordx4 v18, s[12:15], s19 offen sc1 lds
  v_mfma_f32_16x16x32_bf16 v[116:119], a[44:47], v[40:43], v[116:119]
  s_waitcnt lgkmcnt(5)
  v_cvt_pk_bf16_f32 v134, v76, v77
  v_cvt_pk_bf16_f32 v135, v78, v79
  v_mfma_f32_16x16x32_bf16 v[104:107], a[32:35], v[44:47], v[104:107]
  ds_read_b128 v[36:39], v11 offset:40960
  v_mfma_f32_16x16x32_bf16 v[108:111], a[36:39], v[44:47], v[108:111]
  v_mfma_f32_16x16x32_bf16 v[120:123], a[40:43], v[44:47], v[120:123]
  v_mfma_f32_16x16x32_bf16 v[124:127], a[44:47], v[44:47], v[124:127]
  s_waitcnt lgkmcnt(5)
  v_mfma_f32_16x16x32_bf16 v[96:99], a[48:51], v[48:51], v[96:99]
  s_add_u32 m0, s25, 3072
  ds_read_b128 v[40:43], v12 offset:40960
  v_mfma_f32_16x16x32_bf16 v[100:103], a[52:55], v[48:51], v[100:103]
  v_mfma_f32_16x16x32_bf16 v[112:115], a[56:59], v[48:51], v[112:115]
  buffer_load_dwordx4 v19, s[12:15], s19 offen sc1 lds
  v_mfma_f32_16x16x32_bf16 v[116:119], a[60:63], v[48:51], v[116:119]
  s_waitcnt lgkmcnt(5)
  v_mfma_f32_16x16x32_bf16 v[104:107], a[48:51], v[52:55], v[104:107]
  ds_read_b128 v[44:47], v13 offset:40960
  v_mfma_f32_16x16x32_bf16 v[108:111], a[52:55], v[52:55], v[108:111]
  v_cvt_pk_bf16_f32 v136, v80, v81
  v_cvt_pk_bf16_f32 v137, v82, v83
  v_mfma_f32_16x16x32_bf16 v[120:123], a[56:59], v[52:55], v[120:123]
  v_mfma_f32_16x16x32_bf16 v[124:127], a[60:63], v[52:55], v[124:127]
  s_waitcnt lgkmcnt(5)
  v_cvt_pk_bf16_f32 v138, v84, v85
  v_cvt_pk_bf16_f32 v139, v86, v87
  v_mfma_f32_16x16x32_bf16 v[96:99], a[64:67], v[24:27], v[96:99]
  s_add_u32 m0, s25, 4096
  ds_read_b128 v[48:51], v14 offset:40960
  v_mfma_f32_16x16x32_bf16 v[100:103], a[68:71], v[24:27], v[100:103]
  v_mfma_f32_16x16x32_bf16 v[112:115], a[72:75], v[24:27], v[112:115]
  buffer_load_dwordx4 v20, s[12:15], s19 offen sc1 lds
  v_mfma_f32_16x16x32_bf16 v[116:119], a[76:79], v[24:27], v[116:119]
  s_waitcnt lgkmcnt(5)
  v_mfma_f32_16x16x32_bf16 v[104:107], a[64:67], v[28:31], v[104:107]
  ds_read_b128 v[52:55], v15 offset:40960
  v_mfma_f32_16x16x32_bf16 v[108:111], a[68:71], v[28:31], v[108:111]
  v_mfma_f32_16x16x32_bf16 v[120:123], a[72:75], v[28:31], v[120:123]
  v_mfma_f32_16x16x32_bf16 v[124:127], a[76:79], v[28:31], v[124:127]
  s_waitcnt lgkmcnt(5)
  v_mfma_f32_16x16x32_bf16 v[96:99], a[80:83], v[32:35], v[96:99]
  s_add_u32 m0, s25, 5120
  ds_read_b128 v[24:27], v8 offset:49152
  v_mfma_f32_16x16x32_bf16 v[100:103], a[84:87], v[32:35], v[100:103]
  v_cvt_pk_bf16_f32 v140, v88, v89
  v_cvt_pk_bf16_f32 v141, v90, v91
  v_mfma_f32_16x16x32_bf16 v[112:115], a[88:91], v[32:35], v[112:115]
  buffer_load_dwordx4 v21, s[12:15], s19 offen sc1 lds
  v_mfma_f32_16x16x32_bf16 v[116:119], a[92:95], v[32:35], v[116:119]
  s_waitcnt lgkmcnt(5)
  v_cvt_pk_bf16_f32 v142, v92, v93
  v_cvt_pk_bf16_f32 v143, v94, v95
  v_mfma_f32_16x16x32_bf16 v[104:107], a[80:83], v[36:39], v[104:107]
  ds_read_b128 v[28:31], v9 offset:49152
  v_mfma_f32_16x16x32_bf16 v[108:111], a[84:87], v[36:39], v[108:111]
  v_mfma_f32_16x16x32_bf16 v[120:123], a[88:91], v[36:39], v[120:123]
  v_mfma_f32_16x16x32_bf16 v[124:127], a[92:95], v[36:39], v[124:127]
  s_waitcnt lgkmcnt(5)
  v_mfma_f32_16x16x32_bf16 v[96:99], a[96:99], v[40:43], v[96:99]
  s_add_u32 m0, s25, 6144
  ds_read_b128 v[32:35], v10 offset:49152
  v_mfma_f32_16x16x32_bf16 v[100:103], a[100:103], v[40:43], v[100:103]
  v_mfma_f32_16x16x32_bf16 v[112:115], a[104:107], v[40:43], v[112:115]
  buffer_load_dwordx4 v22, s[12:15], s19 offen sc1 lds
  v_mfma_f32_16x16x32_bf16 v[116:119], a[108:111], v[40:43], v[116:119]
  s_waitcnt lgkmcnt(5)
  v_mfma_f32_16x16x32_bf16 v[104:107], a[96:99], v[44:47], v[104:107]
  ds_read_b128 v[36:39], v11 offset:49152
  v_mfma_f32_16x16x32_bf16 v[108:111], a[100:103], v[44:47], v[108:111]
  v_mfma_f32_16x16x32_bf16 v[120:123], a[104:107], v[44:47], v[120:123]
  v_mfma_f32_16x16x32_bf16 v[124:127], a[108:111], v[44:47], v[124:127]
  s_waitcnt lgkmcnt(5)
  v_mfma_f32_16x16x32_bf16 v[96:99], a[112:115], v[48:51], v[96:99]
  s_add_u32 m0, s25, 7168
  ds_read_b128 v[40:43], v12 offset:49152
  v_mfma_f32_16x16x32_bf16 v[100:103], a[116:119], v[48:51], v[100:103]
  v_mfma_f32_16x16x32_bf16 v[112:115], a[120:123], v[48:51], v[112:115]
  buffer_load_dwordx4 v23, s[12:15], s19 offen sc1 lds
  v_mfma_f32_16x16x32_bf16 v[116:119], a[124:127], v[48:51], v[116:119]
  s_waitcnt lgkmcnt(5)
  v_mfma_f32_16x16x32_bf16 v[104:107], a[112:115], v[52:55], v[104:107]
  s_cmp_gt_u32 s23, 3
  ds_read_b128 v[44:47], v13 offset:49152
  v_mfma_f32_16x16x32_bf16 v[108:111], a[116:119], v[52:55], v[108:111]
  v_mfma_f32_16x16x32_bf16 v[120:123], a[120:123], v[52:55], v[120:123]
  s_cselect_b32 s26, s20, 0
  v_mfma_f32_16x16x32_bf16 v[124:127], a[124:127], v[52:55], v[124:127]
  s_waitcnt lgkmcnt(5)
  v_mfma_f32_16x16x32_bf16 v[96:99], a[128:131], v[24:27], v[96:99]
  s_add_u32 s19, s19, s26
  ds_read_b128 v[48:51], v14 offset:49152
  v_mfma_f32_16x16x32_bf16 v[100:103], a[132:135], v[24:27], v[100:103]
  v_mfma_f32_16x16x32_bf16 v[112:115], a[136:139], v[24:27], v[112:115]
  s_add_u32 s25, s25, 32768
  v_mfma_f32_16x16x32_bf16 v[116:119], a[140:143], v[24:27], v[116:119]
  s_waitcnt lgkmcnt(5)
  v_mfma_f32_16x16x32_bf16 v[104:107], a[128:131], v[28:31], v[104:107]
  s_and_b32 s25, s25, 0x1ffff
  ds_read_b128 v[52:55], v15 offset:49152
  v_mfma_f32_16x16x32_bf16 v[108:111], a[132:135], v[28:31], v[108:111]
  v_mfma_f32_16x16x32_bf16 v[120:123], a[136:139], v[28:31], v[120:123]
  buffer_store_dwordx4 v[128:131], v7, s[4:7], s21 offen offset:0 sc1
  v_mfma_f32_16x16x32_bf16 v[124:127], a[140:143], v[28:31], v[124:127]
  s_waitcnt lgkmcnt(5)
  v_mfma_f32_16x16x32_bf16 v[96:99], a[144:147], v[32:35], v[96:99]
  ds_read_b128 v[24:27], v8 offset:57344
  v_mfma_f32_16x16x32_bf16 v[100:103], a[148:151], v[32:35], v[100:103]
  v_mfma_f32_16x16x32_bf16 v[112:115], a[152:155], v[32:35], v[112:115]
  v_mfma_f32_16x16x32_bf16 v[116:119], a[156:159], v[32:35], v[116:119]
  s_waitcnt lgkmcnt(5)
  v_xor_b32 v8, 0x10000, v8
  v_mfma_f32_16x16x32_bf16 v[104:107], a[144:147], v[36:39], v[104:107]
  ds_read_b128 v[28:31], v9 offset:57344
  v_mfma_f32_16x16x32_bf16 v[108:111], a[148:151], v[36:39], v[108:111]
  v_mfma_f32_16x16x32_bf16 v[120:123], a[152:155], v[36:39], v[120:123]
  buffer_store_dwordx4 v[132:135], v7, s[4:7], s21 offen offset:256 sc1
  v_mfma_f32_16x16x32_bf16 v[124:127], a[156:159], v[36:39], v[124:127]
  s_waitcnt lgkmcnt(5)
  v_xor_b32 v9, 0x10000, v9
  v_mfma_f32_16x16x32_bf16 v[96:99], a[160:163], v[40:43], v[96:99]
  ds_read_b128 v[32:35], v10 offset:57344
  v_mfma_f32_16x16x32_bf16 v[100:103], a[164:167], v[40:43], v[100:103]
  v_mfma_f32_16x16x32_bf16 v[112:115], a[168:171], v[40:43], v[112:115]
  v_mfma_f32_16x16x32_bf16 v[116:119], a[172:175], v[40:43], v[116:119]
  s_waitcnt lgkmcnt(5)
  v_xor_b32 v10, 0x10000, v10
  v_mfma_f32_16x16x32_bf16 v[104:107], a[160:163], v[44:47], v[104:107]
  ds_read_b128 v[36:39], v11 offset:57344
  v_mfma_f32_16x16x32_bf16 v[108:111], a[164:167], v[44:47], v[108:111]
  v_mfma_f32_16x16x32_bf16 v[120:123], a[168:171], v[44:47], v[120:123]
  buffer_store_dwordx4 v[136:139], v7, s[4:7], s21 offen offset:2048 sc1
  v_mfma_f32_16x16x32_bf16 v[124:127], a[172:175], v[44:47], v[124:127]
  s_waitcnt lgkmcnt(5)
  v_xor_b32 v11, 0x10000, v11
  v_mfma_f32_16x16x32_bf16 v[96:99], a[176:179], v[48:51], v[96:99]
  ds_read_b128 v[40:43], v12 offset:57344
  v_mfma_f32_16x16x32_bf16 v[100:103], a[180:183], v[48:51], v[100:103]
  v_mfma_f32_16x16x32_bf16 v[112:115], a[184:187], v[48:51], v[112:115]
  v_mfma_f32_16x16x32_bf16 v[116:119], a[188:191], v[48:51], v[116:119]
  s_waitcnt lgkmcnt(5)
  v_xor_b32 v12, 0x10000, v12
  v_mfma_f32_16x16x32_bf16 v[104:107], a[176:179], v[52:55], v[104:107]
  ds_read_b128 v[44:47], v13 offset:57344
  v_mfma_f32_16x16x32_bf16 v[108:111], a[180:183], v[52:55], v[108:111]
  v_mfma_f32_16x16x32_bf16 v[120:123], a[184:187], v[52:55], v[120:123]
  buffer_store_dwordx4 v[140:143], v7, s[4:7], s21 offen offset:2304 sc1
  v_mfma_f32_16x16x32_bf16 v[124:127], a[188:191], v[52:55], v[124:127]
  s_waitcnt lgkmcnt(5)
  v_xor_b32 v13, 0x10000, v13
  v_mfma_f32_16x16x32_bf16 v[96:99], a[192:195], v[24:27], v[96:99]
  s_mov_b32 s21, s27
  ds_read_b128 v[48:51], v14 offset:57344
  v_mfma_f32_16x16x32_bf16 v[100:103], a[196:199], v[24:27], v[100:103]
  v_mov_b32 v7, v56
  v_mfma_f32_16x16x32_bf16 v[112:115], a[200:203], v[24:27], v[112:115]
  v_mfma_f32_16x16x32_bf16 v[116:119], a[204:207], v[24:27], v[116:119]
  s_waitcnt lgkmcnt(5)
  v_xor_b32 v14, 0x10000, v14
  v_mfma_f32_16x16x32_bf16 v[104:107], a[192:195], v[28:31], v[104:107]
  s_add_u32 s27, s27, s22
  ds_read_b128 v[52:55], v15 offset:57344
  v_mfma_f32_16x16x32_bf16 v[108:111], a[196:199], v[28:31], v[108:111]
  v_mfma_f32_16x16x32_bf16 v[120:123], a[200:203], v[28:31], v[120:123]
  s_waitcnt vmcnt(16)
  s_barrier
  v_mfma_f32_16x16x32_bf16 v[124:127], a[204:207], v[28:31], v[124:127]
  s_waitcnt lgkmcnt(5)
  v_xor_b32 v15, 0x10000, v15
  v_mfma_f32_16x16x32_bf16 v[96:99], a[208:211], v[32:35], v[96:99]
  ds_read_b128 v[24:27], v8 offset:0
  v_mfma_f32_16x16x32_bf16 v[100:103], a[212:215], v[32:35], v[100:103]
  v_mfma_f32_16x16x32_bf16 v[112:115], a[216:219], v[32:35], v[112:115]
  v_mfma_f32_16x16x32_bf16 v[116:119], a[220:223], v[32:35], v[116:119]
  s_waitcnt lgkmcnt(5)
  v_mfma_f32_16x16x32_bf16 v[104:107], a[208:211], v[36:39], v[104:107]
  ds_read_b128 v[28:31], v9 offset:0
  v_mfma_f32_16x16x32_bf16 v[108:111], a[212:215], v[36:39], v[108:111]
  v_mfma_f32_16x16x32_bf16 v[120:123], a[216:219], v[36:39], v[120:123]
  v_mfma_f32_16x16x32_bf16 v[124:127], a[220:223], v[36:39], v[124:127]
  s_waitcnt lgkmcnt(5)
  v_mfma_f32_16x16x32_bf16 v[96:99], a[224:227], v[40:43], v[96:99]
  ds_read_b128 v[32:35], v10 offset:0
  v_mfma_f32_16x16x32_bf16 v[100:103], a[228:231], v[40:43], v[100:103]
  v_mfma_f32_16x16x32_bf16 v[112:115], a[232:235], v[40:43], v[112:115]
  v_mfma_f32_16x16x32_bf16 v[116:119], a[236:239], v[40:43], v[116:119]
  s_waitcnt lgkmcnt(5)
  v_mfma_f32_16x16x32_bf16 v[104:107], a[224:227], v[44:47], v[104:107]
  ds_read_b128 v[36:39], v11 offset:0
  v_mfma_f32_16x16x32_bf16 v[108:111], a[228:231], v[44:47], v[108:111]
  v_mfma_f32_16x16x32_bf16 v[120:123], a[232:235], v[44:47], v[120:123]
  v_mfma_f32_16x16x32_bf16 v[124:127], a[236:239], v[44:47], v[124:127]
  s_waitcnt lgkmcnt(5)
  v_mfma_f32_16x16x32_bf16 v[96:99], a[240:243], v[48:51], v[96:99]
  s_sub_u32 s23, s23, 1
  ds_read_b128 v[40:43], v12 offset:0
  v_mfma_f32_16x16x32_bf16 v[100:103], a[244:247], v[48:51], v[100:103]
  v_mfma_f32_16x16x32_bf16 v[112:115], a[248:251], v[48:51], v[112:115]
  v_mfma_f32_16x16x32_bf16 v[116:119], a[252:255], v[48:51], v[116:119]
  s_waitcnt lgkmcnt(5)
  v_mfma_f32_16x16x32_bf16 v[104:107], a[240:243], v[52:55], v[104:107]
  s_cmp_eq_u32 s23, 0
  ds_read_b128 v[44:47], v13 offset:0
  v_mfma_f32_16x16x32_bf16 v[108:111], a[244:247], v[52:55], v[108:111]
  v_mfma_f32_16x16x32_bf16 v[120:123], a[248:251], v[52:55], v[120:123]
  v_mfma_f32_16x16x32_bf16 v[124:127], a[252:255], v[52:55], v[124:127]
  s_cbranch_scc1 G_done1_52
  s_branch G_top_50
G_done0_51:
  s_nop 7
  s_nop 3
  v_cvt_pk_bf16_f32 v128, v64, v65
  v_cvt_pk_bf16_f32 v129, v66, v67
  v_cvt_pk_bf16_f32 v130, v68, v69
  v_cvt_pk_bf16_f32 v131, v70, v71
  buffer_store_dwordx4 v[128:131], v7, s[4:7], s21 offen offset:0 sc1
  v_cvt_pk_bf16_f32 v132, v72, v73
  v_cvt_pk_bf16_f32 v133, v74, v75
  v_cvt_pk_bf16_f32 v134, v76, v77
  v_cvt_pk_bf16_f32 v135, v78, v79
  buffer_store_dwordx4 v[132:135], v7, s[4:7], s21 offen offset:256 sc1
  v_cvt_pk_bf16_f32 v136, v80, v81
  v_cvt_pk_bf16_f32 v137, v82, v83
  v_cvt_pk_bf16_f32 v138, v84, v85
  v_cvt_pk_bf16_f32 v139, v86, v87
  buffer_store_dwordx4 v[136:139], v7, s[4:7], s21 offen offset:2048 sc1
  v_cvt_pk_bf16_f32 v140, v88, v89
  v_cvt_pk_bf16_f32 v141, v90, v91
  v_cvt_pk_bf16_f32 v142, v92, v93
  v_cvt_pk_bf16_f32 v143, v94, v95
  buffer_store_dwordx4 v[140:143], v7, s[4:7], s21 offen offset:2304 sc1
  s_branch G_fin_53
G_done1_52:
  s_nop 7
  s_nop 3
  v_cvt_pk_bf16_f32 v128, v96, v97
  v_cvt_pk_bf16_f32 v129, v98, v99
  v_cvt_pk_bf16_f32 v130, v100, v101
  v_cvt_pk_bf16_f32 v131, v102, v103
  buffer_store_dwordx4 v[128:131], v7, s[4:7], s21 offen offset:0 sc1
  v_cvt_pk_bf16_f32 v132, v104, v105
  v_cvt_pk_bf16_f32 v133, v106, v107
  v_cvt_pk_bf16_f32 v134, v108, v109
  v_cvt_pk_bf16_f32 v135, v110, v111
  buffer_store_dwordx4 v[132:135], v7, s[4:7], s21 offen offset:256 sc1
  v_cvt_pk_bf16_f32 v136, v112, v113
  v_cvt_pk_bf16_f32 v137, v114, v115
  v_cvt_pk_bf16_f32 v138, v116, v117
  v_cvt_pk_bf16_f32 v139, v118, v119
  buffer_store_dwordx4 v[136:139], v7, s[4:7], s21 offen offset:2048 sc1
  v_cvt_pk_bf16_f32 v140, v120, v121
  v_cvt_pk_bf16_f32 v141, v122, v123
  v_cvt_pk_bf16_f32 v142, v124, v125
  v_cvt_pk_bf16_f32 v143, v126, v127
  buffer_store_dwordx4 v[140:143], v7, s[4:7], s21 offen offset:2304 sc1
G_fin_53:
  s_waitcnt vmcnt(0) lgkmcnt(0)
  s_barrier
  s_waitcnt vmcnt(0)
  s_barrier
  s_mov_b32 s30, 768
  v_mov_b32 v144, s30
  v_min_u32 v145, 1, v0
  v_lshlrev_b32 v145, 30, v145
  buffer_store_dword v144, v145, s[4:7], s31 offen sc1
  s_mul_i32 s50, s64, 6
  s_add_u32 s50, s50, s65
  s_mul_i32 s76, s50, 21846
  s_lshr_b32 s76, s76, 16
  s_mul_i32 s77, s76, 3
  s_add_u32 s51, s50, 64
  s_cmp_eq_u32 s77, s50
  s_cselect_b32 s50, s76, s51
M_fin:
  s_lshr_b32 s48, s50, 2
  s_and_b32 s49, s50, 3
  s_load_dwordx2 s[8:9], s[0:1], 0
  s_load_dwordx2 s[12:13], s[0:1], 104
  s_load_dwordx2 s[32:33], s[0:1], 112
  v_and_b32 v4, 31, v1
  v_lshrrev_b32 v5, 5, v1
  v_lshlrev_b32 v5, 4, v5
  v_lshl_add_u32 v6, v4, 10, v5
  s_lshl_b32 s26, s16, 8
  s_lshl_b32 s27, s48, 15
  s_add_u32 s27, s27, s26
  s_waitcnt lgkmcnt(0)
  s_and_b32 s9, s9, 0xffff
  s_mov_b32 s10, 2097152
  s_mov_b32 s11, 0x20000
  s_and_b32 s13, s13, 0xffff
  s_mov_b32 s14, 1024
  s_mov_b32 s15, 0x20000
  s_and_b32 s33, s33, 0xffff
  s_mov_b32 s34, 2097152
  s_mov_b32 s35, 0x20000
  buffer_load_dwordx4 v[16:19], v6, s[8:11], s27 offen offset:0
  buffer_load_dwordx4 v[48:51], v5, s[12:15], s26 offen offset:0
  buffer_load_dwordx4 v[20:23], v6, s[8:11], s27 offen offset:32
  buffer_load_dwordx4 v[52:55], v5, s[12:15], s26 offen offset:32
  buffer_load_dwordx4 v[24:27], v6, s[8:11], s27 offen offset:64
  buffer_load_dwordx4 v[56:59], v5, s[12:15], s26 offen offset:64
  buffer_load_dwordx4 v[28:31], v6, s[8:11], s27 offen offset:96
  buffer_load_dwordx4 v[60:63], v5, s[12:15], s26 offen offset:96
  buffer_load_dwordx4 v[32:35], v6, s[8:11], s27 offen offset:128
  buffer_load_dwordx4 v[64:67], v5, s[12:15], s26 offen offset:128
  buffer_load_dwordx4 v[36:39], v6, s[8:11], s27 offen offset:160
  buffer_load_dwordx4 v[68:71], v5, s[12:15], s26 offen offset:160
  buffer_load_dwordx4 v[40:43], v6, s[8:11], s27 offen offset:192
  buffer_load_dwordx4 v[72:75], v5, s[12:15], s26 offen offset:192
  buffer_load_dwordx4 v[44:47], v6, s[8:11], s27 offen offset:224
  buffer_load_dwordx4 v[76:79], v5, s[12:15], s26 offen offset:224
  s_lshl_b32 s28, s48, 2
  s_add_u32 s28, s28, s49
  s_lshl_b32 s28, s28, 2
  s_add_u32 s28, s28, s16
  s_lshl_b32 s28, s28, 11
  s_waitcnt vmcnt(14)
  v_mfma_f32_32x32x16_bf16 v[80:95], v[48:51], v[16:19], 0
  s_waitcnt vmcnt(12)
  v_mfma_f32_32x32x16_bf16 v[80:95], v[52:55], v[20:23], v[80:95]
  s_waitcnt vmcnt(10)
  v_mfma_f32_32x32x16_bf16 v[80:95], v[56:59], v[24:27], v[80:95]
  s_waitcnt vmcnt(8)
  v_mfma_f32_32x32x16_bf16 v[80:95], v[60:63], v[28:31], v[80:95]
  s_waitcnt vmcnt(6)
  v_mfma_f32_32x32x16_bf16 v[80:95], v[64:67], v[32:35], v[80:95]
  s_waitcnt vmcnt(4)
  v_mfma_f32_32x32x16_bf16 v[80:95], v[68:71], v[36:39], v[80:95]
  s_waitcnt vmcnt(2)
  v_mfma_f32_32x32x16_bf16 v[80:95], v[72:75], v[40:43], v[80:95]
  s_waitcnt vmcnt(0)
  v_mfma_f32_32x32x16_bf16 v[80:95], v[76:79], v[44:47], v[80:95]
  s_mul_i32 s76, s48, 43
  s_lshr_b32 s76, s76, 9
  s_mul_i32 s76, s76, 12
  s_sub_u32 s76, s48, s76
  s_cmp_ge_u32 s76, 6
  s_addc_u32 s76, s76, 0
  s_and_b32 s77, s49, 2
  s_mul_i32 s77, s77, 7
  s_add_u32 s76, s76, s77
  v_mov_b32 v193, 0x300
  s_lshl_b32 s76, s76, 7
  s_add_u32 s76, s76, 148897792
  v_and_b32 v192, 7, v1
  v_mul_u32_u24 v192, 3584, v192
  v_add_u32 v192, s76, v192
  s_mov_b32 s71, 0
  s_branch M_vg_55
M_vw_54:
  s_sleep 2
  s_add_u32 s71, s71, 1
  s_cmp_gt_u32 s71, 262144
  s_cbranch_scc1 M_exit
M_vg_55:
  buffer_load_dword v194, v192, s[4:7], 0 offen sc1
  s_waitcnt vmcnt(0)
  v_cmp_lt_u32 vcc, v194, v193
  s_cbranch_vccnz M_vw_54
  s_add_u32 s29, s28, 150994944
  buffer_load_dwordx4 v[96:99], v2, s[4:7], s29 offen offset:0 sc1
  buffer_load_dwordx4 v[100:103], v2, s[4:7], s29 offen offset:1024 sc1
  s_add_u32 s29, s28, 153092096
  buffer_load_dwordx4 v[104:107], v2, s[4:7], s29 offen offset:0 sc1
  buffer_load_dwordx4 v[108:111], v2, s[4:7], s29 offen offset:1024 sc1
  s_add_u32 s29, s28, 155189248
  buffer_load_dwordx4 v[112:115], v2, s[4:7], s29 offen offset:0 sc1
  buffer_load_dwordx4 v[116:119], v2, s[4:7], s29 offen offset:1024 sc1
  s_add_u32 s29, s28, 157286400
  buffer_load_dwordx4 v[120:123], v2, s[4:7], s29 offen offset:0 sc1
  buffer_load_dwordx4 v[124:127], v2, s[4:7], s29 offen offset:1024 sc1
  s_add_u32 s29, s28, 159383552
  buffer_load_dwordx4 v[128:131], v2, s[4:7], s29 offen offset:0 sc1
  buffer_load_dwordx4 v[132:135], v2, s[4:7], s29 offen offset:1024 sc1
  s_add_u32 s29, s28, 161480704
  buffer_load_dwordx4 v[136:139], v2, s[4:7], s29 offen offset:0 sc1
  buffer_load_dwordx4 v[140:143], v2, s[4:7], s29 offen offset:1024 sc1
  s_add_u32 s29, s28, 163577856
  buffer_load_dwordx4 v[144:147], v2, s[4:7], s29 offen offset:0 sc1
  buffer_load_dwordx4 v[148:151], v2, s[4:7], s29 offen offset:1024 sc1
  s_add_u32 s29, s28, 165675008
  buffer_load_dwordx4 v[152:155], v2, s[4:7], s29 offen offset:0 sc1
  buffer_load_dwordx4 v[156:159], v2, s[4:7], s29 offen offset:1024 sc1
  v_lshlrev_b32 v7, 4, v4
  s_lshl_b32 s26, s16, 2
  v_add_u32 v4, s26, v7
  s_barrier
  ds_write_b32 v4, v80
  s_waitcnt lgkmcnt(0)
  s_barrier
  ds_read_b128 v[84:87], v7
  s_waitcnt lgkmcnt(0)
  v_add_f32 v80, v84, v85
  v_add_f32 v81, v86, v87
  v_add_f32 v80, v80, v81
  v_mul_f32 v80, 0xbfb8aa3b, v80
  v_exp_f32 v80, v80
  s_nop 0
  v_add_f32 v80, 1.0, v80
  v_rcp_f32 v80, v80
  s_nop 0
  v_sub_f32 v82, 1.0, v80
  s_waitcnt vmcnt(14)
  v_lshlrev_b32 v160, 16, v96
  v_and_b32 v161, 0xffff0000, v96
  v_lshlrev_b32 v162, 16, v97
  v_and_b32 v163, 0xffff0000, v97
  v_lshlrev_b32 v164, 16, v98
  v_and_b32 v165, 0xffff0000, v98
  v_lshlrev_b32 v166, 16, v99
  v_and_b32 v167, 0xffff0000, v99
  v_lshlrev_b32 v168, 16, v100
  v_and_b32 v169, 0xffff0000, v100
  v_lshlrev_b32 v170, 16, v101
  v_and_b32 v171, 0xffff0000, v101
  v_lshlrev_b32 v172, 16, v102
  v_and_b32 v173, 0xffff0000, v102
  v_lshlrev_b32 v174, 16, v103
  v_and_b32 v175, 0xffff0000, v103
  s_waitcnt vmcnt(12)
  v_lshlrev_b32 v8, 16, v104
  v_and_b32 v9, 0xffff0000, v104
  v_pk_add_f32 v[160:161], v[160:161], v[8:9]
  v_lshlrev_b32 v10, 16, v105
  v_and_b32 v11, 0xffff0000, v105
  v_pk_add_f32 v[162:163], v[162:163], v[10:11]
  v_lshlrev_b32 v12, 16, v106
  v_and_b32 v13, 0xffff0000, v106
  v_pk_add_f32 v[164:165], v[164:165], v[12:13]
  v_lshlrev_b32 v14, 16, v107
  v_and_b32 v15, 0xffff0000, v107
  v_pk_add_f32 v[166:167], v[166:167], v[14:15]
  v_lshlrev_b32 v8, 16, v108
  v_and_b32 v9, 0xffff0000, v108
  v_pk_add_f32 v[168:169], v[168:169], v[8:9]
  v_lshlrev_b32 v10, 16, v109
  v_and_b32 v11, 0xffff0000, v109
  v_pk_add_f32 v[170:171], v[170:171], v[10:11]
  v_lshlrev_b32 v12, 16, v110
  v_and_b32 v13, 0xffff0000, v110
  v_pk_add_f32 v[172:173], v[172:173], v[12:13]
  v_lshlrev_b32 v14, 16, v111
  v_and_b32 v15, 0xffff0000, v111
  v_pk_add_f32 v[174:175], v[174:175], v[14:15]
  s_waitcnt vmcnt(10)
  v_lshlrev_b32 v8, 16, v112
  v_and_b32 v9, 0xffff0000, v112
  v_pk_add_f32 v[160:161], v[160:161], v[8:9]
  v_lshlrev_b32 v10, 16, v113
  v_and_b32 v11, 0xffff0000, v113
  v_pk_add_f32 v[162:163], v[162:163], v[10:11]
  v_lshlrev_b32 v12, 16, v114
  v_and_b32 v13, 0xffff0000, v114
  v_pk_add_f32 v[164:165], v[164:165], v[12:13]
  v_lshlrev_b32 v14, 16, v115
  v_and_b32 v15, 0xffff0000, v115
  v_pk_add_f32 v[166:167], v[166:167], v[14:15]
  v_lshlrev_b32 v8, 16, v116
  v_and_b32 v9, 0xffff0000, v116
  v_pk_add_f32 v[168:169], v[168:169], v[8:9]
  v_lshlrev_b32 v10, 16, v117
  v_and_b32 v11, 0xffff0000, v117
  v_pk_add_f32 v[170:171], v[170:171], v[10:11]
  v_lshlrev_b32 v12, 16, v118
  v_and_b32 v13, 0xffff0000, v118
  v_pk_add_f32 v[172:173], v[172:173], v[12:13]
  v_lshlrev_b32 v14, 16, v119
  v_and_b32 v15, 0xffff0000, v119
  v_pk_add_f32 v[174:175], v[174:175], v[14:15]
  s_waitcnt vmcnt(8)
  v_lshlrev_b32 v8, 16, v120
  v_and_b32 v9, 0xffff0000, v120
  v_pk_add_f32 v[160:161], v[160:161], v[8:9]
  v_lshlrev_b32 v10, 16, v121
  v_and_b32 v11, 0xffff0000, v121
  v_pk_add_f32 v[162:163], v[162:163], v[10:11]
  v_lshlrev_b32 v12, 16, v122
  v_and_b32 v13, 0xffff0000, v122
  v_pk_add_f32 v[164:165], v[164:165], v[12:13]
  v_lshlrev_b32 v14, 16, v123
  v_and_b32 v15, 0xffff0000, v123
  v_pk_add_f32 v[166:167], v[166:167], v[14:15]
  v_lshlrev_b32 v8, 16, v124
  v_and_b32 v9, 0xffff0000, v124
  v_pk_add_f32 v[168:169], v[168:169], v[8:9]
  v_lshlrev_b32 v10, 16, v125
  v_and_b32 v11, 0xffff0000, v125
  v_pk_add_f32 v[170:171], v[170:171], v[10:11]
  v_lshlrev_b32 v12, 16, v126
  v_and_b32 v13, 0xffff0000, v126
  v_pk_add_f32 v[172:173], v[172:173], v[12:13]
  v_lshlrev_b32 v14, 16, v127
  v_and_b32 v15, 0xffff0000, v127
  v_pk_add_f32 v[174:175], v[174:175], v[14:15]
  s_waitcnt vmcnt(6)
  v_lshlrev_b32 v8, 16, v128
  v_and_b32 v9, 0xffff0000, v128
  v_pk_add_f32 v[160:161], v[160:161], v[8:9]
  v_lshlrev_b32 v10, 16, v129
  v_and_b32 v11, 0xffff0000, v129
  v_pk_add_f32 v[162:163], v[162:163], v[10:11]
  v_lshlrev_b32 v12, 16, v130
  v_and_b32 v13, 0xffff0000, v130
  v_pk_add_f32 v[164:165], v[164:165], v[12:13]
  v_lshlrev_b32 v14, 16, v131
  v_and_b32 v15, 0xffff0000, v131
  v_pk_add_f32 v[166:167], v[166:167], v[14:15]
  v_lshlrev_b32 v8, 16, v132
  v_and_b32 v9, 0xffff0000, v132
  v_pk_add_f32 v[168:169], v[168:169], v[8:9]
  v_lshlrev_b32 v10, 16, v133
  v_and_b32 v11, 0xffff0000, v133
  v_pk_add_f32 v[170:171], v[170:171], v[10:11]
  v_lshlrev_b32 v12, 16, v134
  v_and_b32 v13, 0xffff0000, v134
  v_pk_add_f32 v[172:173], v[172:173], v[12:13]
  v_lshlrev_b32 v14, 16, v135
  v_and_b32 v15, 0xffff0000, v135
  v_pk_add_f32 v[174:175], v[174:175], v[14:15]
  s_waitcnt vmcnt(4)
  v_lshlrev_b32 v8, 16, v136
  v_and_b32 v9, 0xffff0000, v136
  v_pk_add_f32 v[160:161], v[160:161], v[8:9]
  v_lshlrev_b32 v10, 16, v137
  v_and_b32 v11, 0xffff0000, v137
  v_pk_add_f32 v[162:163], v[162:163], v[10:11]
  v_lshlrev_b32 v12, 16, v138
  v_and_b32 v13, 0xffff0000, v138
  v_pk_add_f32 v[164:165], v[164:165], v[12:13]
  v_lshlrev_b32 v14, 16, v139
  v_and_b32 v15, 0xffff0000, v139
  v_pk_add_f32 v[166:167], v[166:167], v[14:15]
  v_lshlrev_b32 v8, 16, v140
  v_and_b32 v9, 0xffff0000, v140
  v_pk_add_f32 v[168:169], v[168:169], v[8:9]
  v_lshlrev_b32 v10, 16, v141
  v_and_b32 v11, 0xffff0000, v141
  v_pk_add_f32 v[170:171], v[170:171], v[10:11]
  v_lshlrev_b32 v12, 16, v142
  v_and_b32 v13, 0xffff0000, v142
  v_pk_add_f32 v[172:173], v[172:173], v[12:13]
  v_lshlrev_b32 v14, 16, v143
  v_and_b32 v15, 0xffff0000, v143
  v_pk_add_f32 v[174:175], v[174:175], v[14:15]
  s_waitcnt vmcnt(2)
  v_lshlrev_b32 v8, 16, v144
  v_and_b32 v9, 0xffff0000, v144
  v_pk_add_f32 v[160:161], v[160:161], v[8:9]
  v_lshlrev_b32 v10, 16, v145
  v_and_b32 v11, 0xffff0000, v145
  v_pk_add_f32 v[162:163], v[162:163], v[10:11]
  v_lshlrev_b32 v12, 16, v146
  v_and_b32 v13, 0xffff0000, v146
  v_pk_add_f32 v[164:165], v[164:165], v[12:13]
  v_lshlrev_b32 v14, 16, v147
  v_and_b32 v15, 0xffff0000, v147
  v_pk_add_f32 v[166:167], v[166:167], v[14:15]
  v_lshlrev_b32 v8, 16, v148
  v_and_b32 v9, 0xffff0000, v148
  v_pk_add_f32 v[168:169], v[168:169], v[8:9]
  v_lshlrev_b32 v10, 16, v149
  v_and_b32 v11, 0xffff0000, v149
  v_pk_add_f32 v[170:171], v[170:171], v[10:11]
  v_lshlrev_b32 v12, 16, v150
  v_and_b32 v13, 0xffff0000, v150
  v_pk_add_f32 v[172:173], v[172:173], v[12:13]
  v_lshlrev_b32 v14, 16, v151
  v_and_b32 v15, 0xffff0000, v151
  v_pk_add_f32 v[174:175], v[174:175], v[14:15]
  s_waitcnt vmcnt(0)
  v_lshlrev_b32 v8, 16, v152
  v_and_b32 v9, 0xffff0000, v152
  v_pk_add_f32 v[160:161], v[160:161], v[8:9]
  v_lshlrev_b32 v10, 16, v153
  v_and_b32 v11, 0xffff0000, v153
  v_pk_add_f32 v[162:163], v[162:163], v[10:11]
  v_lshlrev_b32 v12, 16, v154
  v_and_b32 v13, 0xffff0000, v154
  v_pk_add_f32 v[164:165], v[164:165], v[12:13]
  v_lshlrev_b32 v14, 16, v155
  v_and_b32 v15, 0xffff0000, v155
  v_pk_add_f32 v[166:167], v[166:167], v[14:15]
  v_lshlrev_b32 v8, 16, v156
  v_and_b32 v9, 0xffff0000, v156
  v_pk_add_f32 v[168:169], v[168:169], v[8:9]
  v_lshlrev_b32 v10, 16, v157
  v_and_b32 v11, 0xffff0000, v157
  v_pk_add_f32 v[170:171], v[170:171], v[10:11]
  v_lshlrev_b32 v12, 16, v158
  v_and_b32 v13, 0xffff0000, v158
  v_pk_add_f32 v[172:173], v[172:173], v[12:13]
  v_lshlrev_b32 v14, 16, v159
  v_and_b32 v15, 0xffff0000, v159
  v_pk_add_f32 v[174:175], v[174:175], v[14:15]
  s_and_b32 s76, s48, 1
  s_lshl_b32 s76, s76, 1
  s_lshr_b32 s77, s49, 1
  s_add_u32 s76, s76, s77
  s_mul_i32 s76, s76, 7
  s_add_u32 s76, s76, 6
  s_lshr_b32 s77, s48, 1
  s_add_u32 s77, s77, 0x201
  v_mov_b32 v193, s77
  s_lshl_b32 s76, s76, 7
  s_add_u32 s76, s76, 148897792
  v_and_b32 v192, 7, v1
  v_mul_u32_u24 v192, 3584, v192
  v_add_u32 v192, s76, v192
  s_mov_b32 s71, 0
  s_branch M_vg_57
M_vw_56:
  s_sleep 2
  s_add_u32 s71, s71, 1
  s_cmp_gt_u32 s71, 262144
  s_cbranch_scc1 M_exit
M_vg_57:
  buffer_load_dword v194, v192, s[4:7], 0 offen sc1
  s_waitcnt vmcnt(0)
  v_cmp_lt_u32 vcc, v194, v193
  s_cbranch_vccnz M_vw_56
  s_add_u32 s29, s28, 167772160
  buffer_load_dwordx4 v[96:99], v2, s[4:7], s29 offen offset:0 sc1
  buffer_load_dwordx4 v[100:103], v2, s[4:7], s29 offen offset:1024 sc1
  s_add_u32 s29, s28, 169869312
  buffer_load_dwordx4 v[104:107], v2, s[4:7], s29 offen offset:0 sc1
  buffer_load_dwordx4 v[108:111], v2, s[4:7], s29 offen offset:1024 sc1
  s_add_u32 s29, s28, 171966464
  buffer_load_dwordx4 v[112:115], v2, s[4:7], s29 offen offset:0 sc1
  buffer_load_dwordx4 v[116:119], v2, s[4:7], s29 offen offset:1024 sc1
  s_add_u32 s29, s28, 174063616
  buffer_load_dwordx4 v[120:123], v2, s[4:7], s29 offen offset:0 sc1
  buffer_load_dwordx4 v[124:127], v2, s[4:7], s29 offen offset:1024 sc1
  s_add_u32 s29, s28, 176160768
  buffer_load_dwordx4 v[128:131], v2, s[4:7], s29 offen offset:0 sc1
  buffer_load_dwordx4 v[132:135], v2, s[4:7], s29 offen offset:1024 sc1
  s_add_u32 s29, s28, 178257920
  buffer_load_dwordx4 v[136:139], v2, s[4:7], s29 offen offset:0 sc1
  buffer_load_dwordx4 v[140:143], v2, s[4:7], s29 offen offset:1024 sc1
  s_add_u32 s29, s28, 180355072
  buffer_load_dwordx4 v[144:147], v2, s[4:7], s29 offen offset:0 sc1
  buffer_load_dwordx4 v[148:151], v2, s[4:7], s29 offen offset:1024 sc1
  s_add_u32 s29, s28, 182452224
  buffer_load_dwordx4 v[152:155], v2, s[4:7], s29 offen offset:0 sc1
  buffer_load_dwordx4 v[156:159], v2, s[4:7], s29 offen offset:1024 sc1
  v_pk_mul_f32 v[160:161], v[160:161], v[80:81] op_sel_hi:[1,0]
  v_pk_mul_f32 v[162:163], v[162:163], v[80:81] op_sel_hi:[1,0]
  v_pk_mul_f32 v[164:165], v[164:165], v[80:81] op_sel_hi:[1,0]
  v_pk_mul_f32 v[166:167], v[166:167], v[80:81] op_sel_hi:[1,0]
  v_pk_mul_f32 v[168:169], v[168:169], v[80:81] op_sel_hi:[1,0]
  v_pk_mul_f32 v[170:171], v[170:171], v[80:81] op_sel_hi:[1,0]
  v_pk_mul_f32 v[172:173], v[172:173], v[80:81] op_sel_hi:[1,0]
  v_pk_mul_f32 v[174:175], v[174:175], v[80:81] op_sel_hi:[1,0]
  s_waitcnt vmcnt(14)
  v_lshlrev_b32 v176, 16, v96
  v_and_b32 v177, 0xffff0000, v96
  v_lshlrev_b32 v178, 16, v97
  v_and_b32 v179, 0xffff0000, v97
  v_lshlrev_b32 v180, 16, v98
  v_and_b32 v181, 0xffff0000, v98
  v_lshlrev_b32 v182, 16, v99
  v_and_b32 v183, 0xffff0000, v99
  v_lshlrev_b32 v184, 16, v100
  v_and_b32 v185, 0xffff0000, v100
  v_lshlrev_b32 v186, 16, v101
  v_and_b32 v187, 0xffff0000, v101
  v_lshlrev_b32 v188, 16, v102
  v_and_b32 v189, 0xffff0000, v102
  v_lshlrev_b32 v190, 16, v103
  v_and_b32 v191, 0xffff0000, v103
  s_waitcnt vmcnt(12)
  v_lshlrev_b32 v8, 16, v104
  v_and_b32 v9, 0xffff0000, v104
  v_pk_add_f32 v[176:177], v[176:177], v[8:9]
  v_lshlrev_b32 v10, 16, v105
  v_and_b32 v11, 0xffff0000, v105
  v_pk_add_f32 v[178:179], v[178:179], v[10:11]
  v_lshlrev_b32 v12, 16, v106
  v_and_b32 v13, 0xffff0000, v106
  v_pk_add_f32 v[180:181], v[180:181], v[12:13]
  v_lshlrev_b32 v14, 16, v107
  v_and_b32 v15, 0xffff0000, v107
  v_pk_add_f32 v[182:183], v[182:183], v[14:15]
  v_lshlrev_b32 v8, 16, v108
  v_and_b32 v9, 0xffff0000, v108
  v_pk_add_f32 v[184:185], v[184:185], v[8:9]
  v_lshlrev_b32 v10, 16, v109
  v_and_b32 v11, 0xffff0000, v109
  v_pk_add_f32 v[186:187], v[186:187], v[10:11]
  v_lshlrev_b32 v12, 16, v110
  v_and_b32 v13, 0xffff0000, v110
  v_pk_add_f32 v[188:189], v[188:189], v[12:13]
  v_lshlrev_b32 v14, 16, v111
  v_and_b32 v15, 0xffff0000, v111
  v_pk_add_f32 v[190:191], v[190:191], v[14:15]
  s_waitcnt vmcnt(10)
  v_lshlrev_b32 v8, 16, v112
  v_and_b32 v9, 0xffff0000, v112
  v_pk_add_f32 v[176:177], v[176:177], v[8:9]
  v_lshlrev_b32 v10, 16, v113
  v_and_b32 v11, 0xffff0000, v113
  v_pk_add_f32 v[178:179], v[178:179], v[10:11]
  v_lshlrev_b32 v12, 16, v114
  v_and_b32 v13, 0xffff0000, v114
  v_pk_add_f32 v[180:181], v[180:181], v[12:13]
  v_lshlrev_b32 v14, 16, v115
  v_and_b32 v15, 0xffff0000, v115
  v_pk_add_f32 v[182:183], v[182:183], v[14:15]
  v_lshlrev_b32 v8, 16, v116
  v_and_b32 v9, 0xffff0000, v116
  v_pk_add_f32 v[184:185], v[184:185], v[8:9]
  v_lshlrev_b32 v10, 16, v117
  v_and_b32 v11, 0xffff0000, v117
  v_pk_add_f32 v[186:187], v[186:187], v[10:11]
  v_lshlrev_b32 v12, 16, v118
  v_and_b32 v13, 0xffff0000, v118
  v_pk_add_f32 v[188:189], v[188:189], v[12:13]
  v_lshlrev_b32 v14, 16, v119
  v_and_b32 v15, 0xffff0000, v119
  v_pk_add_f32 v[190:191], v[190:191], v[14:15]
  s_waitcnt vmcnt(8)
  v_lshlrev_b32 v8, 16, v120
  v_and_b32 v9, 0xffff0000, v120
  v_pk_add_f32 v[176:177], v[176:177], v[8:9]
  v_lshlrev_b32 v10, 16, v121
  v_and_b32 v11, 0xffff0000, v121
  v_pk_add_f32 v[178:179], v[178:179], v[10:11]
  v_lshlrev_b32 v12, 16, v122
  v_and_b32 v13, 0xffff0000, v122
  v_pk_add_f32 v[180:181], v[180:181], v[12:13]
  v_lshlrev_b32 v14, 16, v123
  v_and_b32 v15, 0xffff0000, v123
  v_pk_add_f32 v[182:183], v[182:183], v[14:15]
  v_lshlrev_b32 v8, 16, v124
  v_and_b32 v9, 0xffff0000, v124
  v_pk_add_f32 v[184:185], v[184:185], v[8:9]
  v_lshlrev_b32 v10, 16, v125
  v_and_b32 v11, 0xffff0000, v125
  v_pk_add_f32 v[186:187], v[186:187], v[10:11]
  v_lshlrev_b32 v12, 16, v126
  v_and_b32 v13, 0xffff0000, v126
  v_pk_add_f32 v[188:189], v[188:189], v[12:13]
  v_lshlrev_b32 v14, 16, v127
  v_and_b32 v15, 0xffff0000, v127
  v_pk_add_f32 v[190:191], v[190:191], v[14:15]
  s_waitcnt vmcnt(6)
  v_lshlrev_b32 v8, 16, v128
  v_and_b32 v9, 0xffff0000, v128
  v_pk_add_f32 v[176:177], v[176:177], v[8:9]
  v_lshlrev_b32 v10, 16, v129
  v_and_b32 v11, 0xffff0000, v129
  v_pk_add_f32 v[178:179], v[178:179], v[10:11]
  v_lshlrev_b32 v12, 16, v130
  v_and_b32 v13, 0xffff0000, v130
  v_pk_add_f32 v[180:181], v[180:181], v[12:13]
  v_lshlrev_b32 v14, 16, v131
  v_and_b32 v15, 0xffff0000, v131
  v_pk_add_f32 v[182:183], v[182:183], v[14:15]
  v_lshlrev_b32 v8, 16, v132
  v_and_b32 v9, 0xffff0000, v132
  v_pk_add_f32 v[184:185], v[184:185], v[8:9]
  v_lshlrev_b32 v10, 16, v133
  v_and_b32 v11, 0xffff0000, v133
  v_pk_add_f32 v[186:187], v[186:187], v[10:11]
  v_lshlrev_b32 v12, 16, v134
  v_and_b32 v13, 0xffff0000, v134
  v_pk_add_f32 v[188:189], v[188:189], v[12:13]
  v_lshlrev_b32 v14, 16, v135
  v_and_b32 v15, 0xffff0000, v135
  v_pk_add_f32 v[190:191], v[190:191], v[14:15]
  s_waitcnt vmcnt(4)
  v_lshlrev_b32 v8, 16, v136
  v_and_b32 v9, 0xffff0000, v136
  v_pk_add_f32 v[176:177], v[176:177], v[8:9]
  v_lshlrev_b32 v10, 16, v137
  v_and_b32 v11, 0xffff0000, v137
  v_pk_add_f32 v[178:179], v[178:179], v[10:11]
  v_lshlrev_b32 v12, 16, v138
  v_and_b32 v13, 0xffff0000, v138
  v_pk_add_f32 v[180:181], v[180:181], v[12:13]
  v_lshlrev_b32 v14, 16, v139
  v_and_b32 v15, 0xffff0000, v139
  v_pk_add_f32 v[182:183], v[182:183], v[14:15]
  v_lshlrev_b32 v8, 16, v140
  v_and_b32 v9, 0xffff0000, v140
  v_pk_add_f32 v[184:185], v[184:185], v[8:9]
  v_lshlrev_b32 v10, 16, v141
  v_and_b32 v11, 0xffff0000, v141
  v_pk_add_f32 v[186:187], v[186:187], v[10:11]
  v_lshlrev_b32 v12, 16, v142
  v_and_b32 v13, 0xffff0000, v142
  v_pk_add_f32 v[188:189], v[188:189], v[12:13]
  v_lshlrev_b32 v14, 16, v143
  v_and_b32 v15, 0xffff0000, v143
  v_pk_add_f32 v[190:191], v[190:191], v[14:15]
  s_waitcnt vmcnt(2)
  v_lshlrev_b32 v8, 16, v144
  v_and_b32 v9, 0xffff0000, v144
  v_pk_add_f32 v[176:177], v[176:177], v[8:9]
  v_lshlrev_b32 v10, 16, v145
  v_and_b32 v11, 0xffff0000, v145
  v_pk_add_f32 v[178:179], v[178:179], v[10:11]
  v_lshlrev_b32 v12, 16, v146
  v_and_b32 v13, 0xffff0000, v146
  v_pk_add_f32 v[180:181], v[180:181], v[12:13]
  v_lshlrev_b32 v14, 16, v147
  v_and_b32 v15, 0xffff0000, v147
  v_pk_add_f32 v[182:183], v[182:183], v[14:15]
  v_lshlrev_b32 v8, 16, v148
  v_and_b32 v9, 0xffff0000, v148
  v_pk_add_f32 v[184:185], v[184:185], v[8:9]
  v_lshlrev_b32 v10, 16, v149
  v_and_b32 v11, 0xffff0000, v149
  v_pk_add_f32 v[186:187], v[186:187], v[10:11]
  v_lshlrev_b32 v12, 16, v150
  v_and_b32 v13, 0xffff0000, v150
  v_pk_add_f32 v[188:189], v[188:189], v[12:13]
  v_lshlrev_b32 v14, 16, v151
  v_and_b32 v15, 0xffff0000, v151
  v_pk_add_f32 v[190:191], v[190:191], v[14:15]
  s_waitcnt vmcnt(0)
  v_lshlrev_b32 v8, 16, v152
  v_and_b32 v9, 0xffff0000, v152
  v_pk_add_f32 v[176:177], v[176:177], v[8:9]
  v_lshlrev_b32 v10, 16, v153
  v_and_b32 v11, 0xffff0000, v153
  v_pk_add_f32 v[178:179], v[178:179], v[10:11]
  v_lshlrev_b32 v12, 16, v154
  v_and_b32 v13, 0xffff0000, v154
  v_pk_add_f32 v[180:181], v[180:181], v[12:13]
  v_lshlrev_b32 v14, 16, v155
  v_and_b32 v15, 0xffff0000, v155
  v_pk_add_f32 v[182:183], v[182:183], v[14:15]
  v_lshlrev_b32 v8, 16, v156
  v_and_b32 v9, 0xffff0000, v156
  v_pk_add_f32 v[184:185], v[184:185], v[8:9]
  v_lshlrev_b32 v10, 16, v157
  v_and_b32 v11, 0xffff0000, v157
  v_pk_add_f32 v[186:187], v[186:187], v[10:11]
  v_lshlrev_b32 v12, 16, v158
  v_and_b32 v13, 0xffff0000, v158
  v_pk_add_f32 v[188:189], v[188:189], v[12:13]
  v_lshlrev_b32 v14, 16, v159
  v_and_b32 v15, 0xffff0000, v159
  v_pk_add_f32 v[190:191], v[190:191], v[14:15]
  v_pk_fma_f32 v[160:161], v[176:177], v[82:83], v[160:161] op_sel_hi:[1,0,1]
  v_cvt_pk_bf16_f32 v16, v160, v161
  v_pk_fma_f32 v[162:163], v[178:179], v[82:83], v[162:163] op_sel_hi:[1,0,1]
  v_cvt_pk_bf16_f32 v17, v162, v163
  v_pk_fma_f32 v[164:165], v[180:181], v[82:83], v[164:165] op_sel_hi:[1,0,1]
  v_cvt_pk_bf16_f32 v18, v164, v165
  v_pk_fma_f32 v[166:167], v[182:183], v[82:83], v[166:167] op_sel_hi:[1,0,1]
  v_cvt_pk_bf16_f32 v19, v166, v167
  v_pk_fma_f32 v[168:169], v[184:185], v[82:83], v[168:169] op_sel_hi:[1,0,1]
  v_cvt_pk_bf16_f32 v20, v168, v169
  v_pk_fma_f32 v[170:171], v[186:187], v[82:83], v[170:171] op_sel_hi:[1,0,1]
  v_cvt_pk_bf16_f32 v21, v170, v171
  v_pk_fma_f32 v[172:173], v[188:189], v[82:83], v[172:173] op_sel_hi:[1,0,1]
  v_cvt_pk_bf16_f32 v22, v172, v173
  v_pk_fma_f32 v[174:175], v[190:191], v[82:83], v[174:175] op_sel_hi:[1,0,1]
  v_cvt_pk_bf16_f32 v23, v174, v175
  s_lshl_b32 s26, s49, 2
  s_add_u32 s26, s26, s16
  s_lshl_b32 s26, s26, 6
  s_lshl_b32 s27, s48, 15
  s_add_u32 s26, s26, s27
  buffer_store_dwordx4 v[16:19], v6, s[32:35], s26 offen offset:0
  buffer_store_dwordx4 v[20:23], v6, s[32:35], s26 offen offset:32
  s_cmp_lt_u32 s50, 64
  s_mov_b32 s50, s51
  s_cbranch_scc1 M_fin
  s_branch M_done
M_follow:
  s_lshr_b32 s48, s64, 2
  s_and_b32 s49, s64, 1
  s_bfe_u32 s50, s64, 0x10001
  s_mov_b32 s51, 2
  s_mov_b32 s23, 32
  s_load_dwordx2 s[8:9], s[0:1], 88
  s_lshl_b32 s17, s48, 19
  s_lshl_b32 s26, s49, 2
  s_add_u32 s26, s26, s16
  s_lshl_b32 s27, s26, 7
  s_add_u32 s17, s17, s27
  s_mov_b32 s18, 1024
  s_lshl_b32 s21, s48, 6
  s_add_u32 s21, s21, s50
  s_lshl_b32 s21, s21, 3
  s_add_u32 s21, s21, s26
  s_lshl_b32 s21, s21, 12
  s_add_u32 s21, s21, 167772160
  s_lshl_b32 s22, s51, 15
  s_mov_b32 s24, 1.0
  s_waitcnt lgkmcnt(0)
  s_and_b32 s9, s9, 0xffff
  s_mov_b32 s10, 4194304
  s_mov_b32 s11, 0x20000
  v_lshrrev_b32 v144, 4, v1
  v_and_b32 v56, 0xff, v2
  v_lshl_add_u32 v56, v144, 9, v56
  s_mul_i32 s26, s16, 0
  v_add_u32 v8, 0, v56
  v_add_u32 v16, 0, v2
  v_add_u32 v16, s26, v16
  v_add_u32 v9, 256, v56
  v_add_u32 v17, 1024, v2
  v_add_u32 v17, s26, v17
  v_add_u32 v10, 2048, v56
  v_add_u32 v18, 2048, v2
  v_add_u32 v18, s26, v18
  v_add_u32 v11, 2304, v56
  v_add_u32 v19, 3072, v2
  v_add_u32 v19, s26, v19
  v_add_u32 v12, 4096, v56
  v_add_u32 v20, 4096, v2
  v_add_u32 v20, s26, v20
  v_add_u32 v13, 4352, v56
  v_add_u32 v21, 5120, v2
  v_add_u32 v21, s26, v21
  v_add_u32 v14, 6144, v56
  v_add_u32 v22, 6144, v2
  v_add_u32 v22, s26, v22
  v_add_u32 v15, 6400, v56
  v_add_u32 v23, 7168, v2
  v_add_u32 v23, s26, v23
  v_mov_b32 v20, v56
  v_lshrrev_b32 v144, 3, v1
  v_mul_lo_u32 v144, v144, s18
  v_and_b32 v145, 7, v1
  v_lshl_add_u32 v144, v145, 4, v144
  s_lshl_b32 s28, s16, 15
  s_add_u32 s28, s28, 32768
  s_lshl_b32 s29, s18, 3
  s_add_u32 m0, s28, 0
  s_nop 0
  buffer_load_dwordx4 v144, s[8:11], s17 offen lds
  s_add_u32 s17, s17, s29
  s_add_u32 m0, s28, 1024
  s_nop 0
  buffer_load_dwordx4 v144, s[8:11], s17 offen lds
  s_add_u32 s17, s17, s29
  s_add_u32 m0, s28, 2048
  s_nop 0
  buffer_load_dwordx4 v144, s[8:11], s17 offen lds
  s_add_u32 s17, s17, s29
  s_add_u32 m0, s28, 3072
  s_nop 0
  buffer_load_dwordx4 v144, s[8:11], s17 offen lds
  s_add_u32 s17, s17, s29
  s_add_u32 m0, s28, 4096
  s_nop 0
  buffer_load_dwordx4 v144, s[8:11], s17 offen lds
  s_add_u32 s17, s17, s29
  s_add_u32 m0, s28, 5120
  s_nop 0
  buffer_load_dwordx4 v144, s[8:11], s17 offen lds
  s_add_u32 s17, s17, s29
  s_add_u32 m0, s28, 6144
  s_nop 0
  buffer_load_dwordx4 v144, s[8:11], s17 offen lds
  s_add_u32 s17, s17, s29
  s_add_u32 m0, s28, 7168
  s_nop 0
  buffer_load_dwordx4 v144, s[8:11], s17 offen lds
  s_add_u32 s17, s17, s29
  s_add_u32 m0, s28, 8192
  s_nop 0
  buffer_load_dwordx4 v144, s[8:11], s17 offen lds
  s_add_u32 s17, s17, s29
  s_add_u32 m0, s28, 9216
  s_nop 0
  buffer_load_dwordx4 v144, s[8:11], s17 offen lds
  s_add_u32 s17, s17, s29
  s_add_u32 m0, s28, 10240
  s_nop 0
  buffer_load_dwordx4 v144, s[8:11], s17 offen lds
  s_add_u32 s17, s17, s29
  s_add_u32 m0, s28, 11264
  s_nop 0
  buffer_load_dwordx4 v144, s[8:11], s17 offen lds
  s_add_u32 s17, s17, s29
  s_add_u32 m0, s28, 12288
  s_nop 0
  buffer_load_dwordx4 v144, s[8:11], s17 offen lds
  s_add_u32 s17, s17, s29
  s_add_u32 m0, s28, 13312
  s_nop 0
  buffer_load_dwordx4 v144, s[8:11], s17 offen lds
  s_add_u32 s17, s17, s29
  s_add_u32 m0, s28, 14336
  s_nop 0
  buffer_load_dwordx4 v144, s[8:11], s17 offen lds
  s_add_u32 s17, s17, s29
  s_add_u32 m0, s28, 15360
  s_nop 0
  buffer_load_dwordx4 v144, s[8:11], s17 offen lds
  s_add_u32 s17, s17, s29
  s_add_u32 m0, s28, 16384
  s_nop 0
  buffer_load_dwordx4 v144, s[8:11], s17 offen lds
  s_add_u32 s17, s17, s29
  s_add_u32 m0, s28, 17408
  s_nop 0
  buffer_load_dwordx4 v144, s[8:11], s17 offen lds
  s_add_u32 s17, s17, s29
  s_add_u32 m0, s28, 18432
  s_nop 0
  buffer_load_dwordx4 v144, s[8:11], s17 offen lds
  s_add_u32 s17, s17, s29
  s_add_u32 m0, s28, 19456
  s_nop 0
  buffer_load_dwordx4 v144, s[8:11], s17 offen lds
  s_add_u32 s17, s17, s29
  s_add_u32 m0, s28, 20480
  s_nop 0
  buffer_load_dwordx4 v144, s[8:11], s17 offen lds
  s_add_u32 s17, s17, s29
  s_add_u32 m0, s28, 21504
  s_nop 0
  buffer_load_dwordx4 v144, s[8:11], s17 offen lds
  s_add_u32 s17, s17, s29
  s_add_u32 m0, s28, 22528
  s_nop 0
  buffer_load_dwordx4 v144, s[8:11], s17 offen lds
  s_add_u32 s17, s17, s29
  s_add_u32 m0, s28, 23552
  s_nop 0
  buffer_load_dwordx4 v144, s[8:11], s17 offen lds
  s_add_u32 s17, s17, s29
  s_add_u32 m0, s28, 24576
  s_nop 0
  buffer_load_dwordx4 v144, s[8:11], s17 offen lds
  s_add_u32 s17, s17, s29
  s_add_u32 m0, s28, 25600
  s_nop 0
  buffer_load_dwordx4 v144, s[8:11], s17 offen lds
  s_add_u32 s17, s17, s29
  s_add_u32 m0, s28, 26624
  s_nop 0
  buffer_load_dwordx4 v144, s[8:11], s17 offen lds
  s_add_u32 s17, s17, s29
  s_add_u32 m0, s28, 27648
  s_nop 0
  buffer_load_dwordx4 v144, s[8:11], s17 offen lds
  s_add_u32 s17, s17, s29
  s_add_u32 m0, s28, 28672
  s_nop 0
  buffer_load_dwordx4 v144, s[8:11], s17 offen lds
  s_add_u32 s17, s17, s29
  s_add_u32 m0, s28, 29696
  s_nop 0
  buffer_load_dwordx4 v144, s[8:11], s17 offen lds
  s_add_u32 s17, s17, s29
  s_add_u32 m0, s28, 30720
  s_nop 0
  buffer_load_dwordx4 v144, s[8:11], s17 offen lds
  s_add_u32 s17, s17, s29
  s_add_u32 m0, s28, 31744
  s_nop 0
  buffer_load_dwordx4 v144, s[8:11], s17 offen lds
  s_add_u32 s17, s17, s29
  v_bfe_u32 v148, v1, 2, 2
  v_lshrrev_b32 v149, 5, v1
  v_lshl_add_u32 v148, v149, 4, v148
  v_bfe_u32 v149, v1, 4, 1
  v_lshl_add_u32 v148, v149, 2, v148
  v_and_b32 v149, 3, v1
  v_lshlrev_b32 v149, 4, v149
  s_mov_b32 s26, 8
  v_lshl_add_u32 v148, v148, 7, v149
  v_add_u32 v152, s28, v148
  v_add_u32 v153, 1024, v152
  v_add_u32 v154, s26, v152
  v_add_u32 v155, s26, v153
  s_waitcnt vmcnt(28)
  ds_read_b64_tr_b16 a[0:1], v152 offset:0
  ds_read_b64_tr_b16 a[2:3], v153 offset:0
  ds_read_b64_tr_b16 a[4:5], v154 offset:0
  ds_read_b64_tr_b16 a[6:7], v155 offset:0
  ds_read_b64_tr_b16 a[8:9], v152 offset:64
  ds_read_b64_tr_b16 a[10:11], v153 offset:64
  ds_read_b64_tr_b16 a[12:13], v154 offset:64
  ds_read_b64_tr_b16 a[14:15], v155 offset:64
  s_waitcnt lgkmcnt(0)
  s_add_u32 m0, s28, 0
  s_nop 0
  buffer_load_dwordx4 v144, s[8:11], s17 offen lds
  s_add_u32 s17, s17, s29
  s_add_u32 m0, s28, 1024
  s_nop 0
  buffer_load_dwordx4 v144, s[8:11], s17 offen lds
  s_add_u32 s17, s17, s29
  s_add_u32 m0, s28, 2048
  s_nop 0
  buffer_load_dwordx4 v144, s[8:11], s17 offen lds
  s_add_u32 s17, s17, s29
  s_add_u32 m0, s28, 3072
  s_nop 0
  buffer_load_dwordx4 v144, s[8:11], s17 offen lds
  s_add_u32 s17, s17, s29
  s_waitcnt vmcnt(28)
  ds_read_b64_tr_b16 a[16:17], v152 offset:4096
  ds_read_b64_tr_b16 a[18:19], v153 offset:4096
  ds_read_b64_tr_b16 a[20:21], v154 offset:4096
  ds_read_b64_tr_b16 a[22:23], v155 offset:4096
  ds_read_b64_tr_b16 a[24:25], v152 offset:4160
  ds_read_b64_tr_b16 a[26:27], v153 offset:4160
  ds_read_b64_tr_b16 a[28:29], v154 offset:4160
  ds_read_b64_tr_b16 a[30:31], v155 offset:4160
  s_waitcnt lgkmcnt(0)
  s_add_u32 m0, s28, 4096
  s_nop 0
  buffer_load_dwordx4 v144, s[8:11], s17 offen lds
  s_add_u32 s17, s17, s29
  s_add_u32 m0, s28, 5120
  s_nop 0
  buffer_load_dwordx4 v144, s[8:11], s17 offen lds
  s_add_u32 s17, s17, s29
  s_add_u32 m0, s28, 6144
  s_nop 0
  buffer_load_dwordx4 v144, s[8:11], s17 offen lds
  s_add_u32 s17, s17, s29
  s_add_u32 m0, s28, 7168
  s_nop 0
  buffer_load_dwordx4 v144, s[8:11], s17 offen lds
  s_add_u32 s17, s17, s29
  s_waitcnt vmcnt(28)
  ds_read_b64_tr_b16 a[32:33], v152 offset:8192
  ds_read_b64_tr_b16 a[34:35], v153 offset:8192
  ds_read_b64_tr_b16 a[36:37], v154 offset:8192
  ds_read_b64_tr_b16 a[38:39], v155 offset:8192
  ds_read_b64_tr_b16 a[40:41], v152 offset:8256
  ds_read_b64_tr_b16 a[42:43], v153 offset:8256
  ds_read_b64_tr_b16 a[44:45], v154 offset:8256
  ds_read_b64_tr_b16 a[46:47], v155 offset:8256
  s_waitcnt lgkmcnt(0)
  s_add_u32 m0, s28, 8192
  s_nop 0
  buffer_load_dwordx4 v144, s[8:11], s17 offen lds
  s_add_u32 s17, s17, s29
  s_add_u32 m0, s28, 9216
  s_nop 0
  buffer_load_dwordx4 v144, s[8:11], s17 offen lds
  s_add_u32 s17, s17, s29
  s_add_u32 m0, s28, 10240
  s_nop 0
  buffer_load_dwordx4 v144, s[8:11], s17 offen lds
  s_add_u32 s17, s17, s29
  s_add_u32 m0, s28, 11264
  s_nop 0
  buffer_load_dwordx4 v144, s[8:11], s17 offen lds
  s_add_u32 s17, s17, s29
  s_waitcnt vmcnt(28)
  ds_read_b64_tr_b16 a[48:49], v152 offset:12288
  ds_read_b64_tr_b16 a[50:51], v153 offset:12288
  ds_read_b64_tr_b16 a[52:53], v154 offset:12288
  ds_read_b64_tr_b16 a[54:55], v155 offset:12288
  ds_read_b64_tr_b16 a[56:57], v152 offset:12352
  ds_read_b64_tr_b16 a[58:59], v153 offset:12352
  ds_read_b64_tr_b16 a[60:61], v154 offset:12352
  ds_read_b64_tr_b16 a[62:63], v155 offset:12352
  s_waitcnt lgkmcnt(0)
  s_add_u32 m0, s28, 12288
  s_nop 0
  buffer_load_dwordx4 v144, s[8:11], s17 offen lds
  s_add_u32 s17, s17, s29
  s_add_u32 m0, s28, 13312
  s_nop 0
  buffer_load_dwordx4 v144, s[8:11], s17 offen lds
  s_add_u32 s17, s17, s29
  s_add_u32 m0, s28, 14336
  s_nop 0
  buffer_load_dwordx4 v144, s[8:11], s17 offen lds
  s_add_u32 s17, s17, s29
  s_add_u32 m0, s28, 15360
  s_nop 0
  buffer_load_dwordx4 v144, s[8:11], s17 offen lds
  s_add_u32 s17, s17, s29
  s_waitcnt vmcnt(28)
  ds_read_b64_tr_b16 a[64:65], v152 offset:16384
  ds_read_b64_tr_b16 a[66:67], v153 offset:16384
  ds_read_b64_tr_b16 a[68:69], v154 offset:16384
  ds_read_b64_tr_b16 a[70:71], v155 offset:16384
  ds_read_b64_tr_b16 a[72:73], v152 offset:16448
  ds_read_b64_tr_b16 a[74:75], v153 offset:16448
  ds_read_b64_tr_b16 a[76:77], v154 offset:16448
  ds_read_b64_tr_b16 a[78:79], v155 offset:16448
  s_waitcnt lgkmcnt(0)
  s_add_u32 m0, s28, 16384
  s_nop 0
  buffer_load_dwordx4 v144, s[8:11], s17 offen lds
  s_add_u32 s17, s17, s29
  s_add_u32 m0, s28, 17408
  s_nop 0
  buffer_load_dwordx4 v144, s[8:11], s17 offen lds
  s_add_u32 s17, s17, s29
  s_add_u32 m0, s28, 18432
  s_nop 0
  buffer_load_dwordx4 v144, s[8:11], s17 offen lds
  s_add_u32 s17, s17, s29
  s_add_u32 m0, s28, 19456
  s_nop 0
  buffer_load_dwordx4 v144, s[8:11], s17 offen lds
  s_add_u32 s17, s17, s29
  s_waitcnt vmcnt(28)
  ds_read_b64_tr_b16 a[80:81], v152 offset:20480
  ds_read_b64_tr_b16 a[82:83], v153 offset:20480
  ds_read_b64_tr_b16 a[84:85], v154 offset:20480
  ds_read_b64_tr_b16 a[86:87], v155 offset:20480
  ds_read_b64_tr_b16 a[88:89], v152 offset:20544
  ds_read_b64_tr_b16 a[90:91], v153 offset:20544
  ds_read_b64_tr_b16 a[92:93], v154 offset:20544
  ds_read_b64_tr_b16 a[94:95], v155 offset:20544
  s_waitcnt lgkmcnt(0)
  s_add_u32 m0, s28, 20480
  s_nop 0
  buffer_load_dwordx4 v144, s[8:11], s17 offen lds
  s_add_u32 s17, s17, s29
  s_add_u32 m0, s28, 21504
  s_nop 0
  buffer_load_dwordx4 v144, s[8:11], s17 offen lds
  s_add_u32 s17, s17, s29
  s_add_u32 m0, s28, 22528
  s_nop 0
  buffer_load_dwordx4 v144, s[8:11], s17 offen lds
  s_add_u32 s17, s17, s29
  s_add_u32 m0, s28, 23552
  s_nop 0
  buffer_load_dwordx4 v144, s[8:11], s17 offen lds
  s_add_u32 s17, s17, s29
  s_waitcnt vmcnt(28)
  ds_read_b64_tr_b16 a[96:97], v152 offset:24576
  ds_read_b64_tr_b16 a[98:99], v153 offset:24576
  ds_read_b64_tr_b16 a[100:101], v154 offset:24576
  ds_read_b64_tr_b16 a[102:103], v155 offset:24576
  ds_read_b64_tr_b16 a[104:105], v152 offset:24640
  ds_read_b64_tr_b16 a[106:107], v153 offset:24640
  ds_read_b64_tr_b16 a[108:109], v154 offset:24640
  ds_read_b64_tr_b16 a[110:111], v155 offset:24640
  s_waitcnt lgkmcnt(0)
  s_add_u32 m0, s28, 24576
  s_nop 0
  buffer_load_dwordx4 v144, s[8:11], s17 offen lds
  s_add_u32 s17, s17, s29
  s_add_u32 m0, s28, 25600
  s_nop 0
  buffer_load_dwordx4 v144, s[8:11], s17 offen lds
  s_add_u32 s17, s17, s29
  s_add_u32 m0, s28, 26624
  s_nop 0
  buffer_load_dwordx4 v144, s[8:11], s17 offen lds
  s_add_u32 s17, s17, s29
  s_add_u32 m0, s28, 27648
  s_nop 0
  buffer_load_dwordx4 v144, s[8:11], s17 offen lds
  s_add_u32 s17, s17, s29
  s_waitcnt vmcnt(28)
  ds_read_b64_tr_b16 a[112:113], v152 offset:28672
  ds_read_b64_tr_b16 a[114:115], v153 offset:28672
  ds_read_b64_tr_b16 a[116:117], v154 offset:28672
  ds_read_b64_tr_b16 a[118:119], v155 offset:28672
  ds_read_b64_tr_b16 a[120:121], v152 offset:28736
  ds_read_b64_tr_b16 a[122:123], v153 offset:28736
  ds_read_b64_tr_b16 a[124:125], v154 offset:28736
  ds_read_b64_tr_b16 a[126:127], v155 offset:28736
  s_waitcnt lgkmcnt(0)
  s_add_u32 m0, s28, 28672
  s_nop 0
  buffer_load_dwordx4 v144, s[8:11], s17 offen lds
  s_add_u32 s17, s17, s29
  s_add_u32 m0, s28, 29696
  s_nop 0
  buffer_load_dwordx4 v144, s[8:11], s17 offen lds
  s_add_u32 s17, s17, s29
  s_add_u32 m0, s28, 30720
  s_nop 0
  buffer_load_dwordx4 v144, s[8:11], s17 offen lds
  s_add_u32 s17, s17, s29
  s_add_u32 m0, s28, 31744
  s_nop 0
  buffer_load_dwordx4 v144, s[8:11], s17 offen lds
  s_add_u32 s17, s17, s29
  s_waitcnt vmcnt(28)
  ds_read_b64_tr_b16 a[128:129], v152 offset:0
  ds_read_b64_tr_b16 a[130:131], v153 offset:0
  ds_read_b64_tr_b16 a[132:133], v154 offset:0
  ds_read_b64_tr_b16 a[134:135], v155 offset:0
  ds_read_b64_tr_b16 a[136:137], v152 offset:64
  ds_read_b64_tr_b16 a[138:139], v153 offset:64
  ds_read_b64_tr_b16 a[140:141], v154 offset:64
  ds_read_b64_tr_b16 a[142:143], v155 offset:64
  s_waitcnt lgkmcnt(0)
  s_waitcnt vmcnt(24)
  ds_read_b64_tr_b16 a[144:145], v152 offset:4096
  ds_read_b64_tr_b16 a[146:147], v153 offset:4096
  ds_read_b64_tr_b16 a[148:149], v154 offset:4096
  ds_read_b64_tr_b16 a[150:151], v155 offset:4096
  ds_read_b64_tr_b16 a[152:153], v152 offset:4160
  ds_read_b64_tr_b16 a[154:155], v153 offset:4160
  ds_read_b64_tr_b16 a[156:157], v154 offset:4160
  ds_read_b64_tr_b16 a[158:159], v155 offset:4160
  s_waitcnt lgkmcnt(0)
  s_waitcnt vmcnt(20)
  ds_read_b64_tr_b16 a[160:161], v152 offset:8192
  ds_read_b64_tr_b16 a[162:163], v153 offset:8192
  ds_read_b64_tr_b16 a[164:165], v154 offset:8192
  ds_read_b64_tr_b16 a[166:167], v155 offset:8192
  ds_read_b64_tr_b16 a[168:169], v152 offset:8256
  ds_read_b64_tr_b16 a[170:171], v153 offset:8256
  ds_read_b64_tr_b16 a[172:173], v154 offset:8256
  ds_read_b64_tr_b16 a[174:175], v155 offset:8256
  s_waitcnt lgkmcnt(0)
  s_waitcnt vmcnt(16)
  ds_read_b64_tr_b16 a[176:177], v152 offset:12288
  ds_read_b64_tr_b16 a[178:179], v153 offset:12288
  ds_read_b64_tr_b16 a[180:181], v154 offset:12288
  ds_read_b64_tr_b16 a[182:183], v155 offset:12288
  ds_read_b64_tr_b16 a[184:185], v152 offset:12352
  ds_read_b64_tr_b16 a[186:187], v153 offset:12352
  ds_read_b64_tr_b16 a[188:189], v154 offset:12352
  ds_read_b64_tr_b16 a[190:191], v155 offset:12352
  s_waitcnt lgkmcnt(0)
  s_waitcnt vmcnt(12)
  ds_read_b64_tr_b16 a[192:193], v152 offset:16384
  ds_read_b64_tr_b16 a[194:195], v153 offset:16384
  ds_read_b64_tr_b16 a[196:197], v154 offset:16384
  ds_read_b64_tr_b16 a[198:199], v155 offset:16384
  ds_read_b64_tr_b16 a[200:201], v152 offset:16448
  ds_read_b64_tr_b16 a[202:203], v153 offset:16448
  ds_read_b64_tr_b16 a[204:205], v154 offset:16448
  ds_read_b64_tr_b16 a[206:207], v155 offset:16448
  s_waitcnt lgkmcnt(0)
  s_waitcnt vmcnt(8)
  ds_read_b64_tr_b16 a[208:209], v152 offset:20480
  ds_read_b64_tr_b16 a[210:211], v153 offset:20480
  ds_read_b64_tr_b16 a[212:213], v154 offset:20480
  ds_read_b64_tr_b16 a[214:215], v155 offset:20480
  ds_read_b64_tr_b16 a[216:217], v152 offset:20544
  ds_read_b64_tr_b16 a[218:219], v153 offset:20544
  ds_read_b64_tr_b16 a[220:221], v154 offset:20544
  ds_read_b64_tr_b16 a[222:223], v155 offset:20544
  s_waitcnt lgkmcnt(0)
  s_waitcnt vmcnt(4)
  ds_read_b64_tr_b16 a[224:225], v152 offset:24576
  ds_read_b64_tr_b16 a[226:227], v153 offset:24576
  ds_read_b64_tr_b16 a[228:229], v154 offset:24576
  ds_read_b64_tr_b16 a[230:231], v155 offset:24576
  ds_read_b64_tr_b16 a[232:233], v152 offset:24640
  ds_read_b64_tr_b16 a[234:235], v153 offset:24640
  ds_read_b64_tr_b16 a[236:237], v154 offset:24640
  ds_read_b64_tr_b16 a[238:239], v155 offset:24640
  s_waitcnt lgkmcnt(0)
  s_waitcnt vmcnt(0)
  ds_read_b64_tr_b16 a[240:241], v152 offset:28672
  ds_read_b64_tr_b16 a[242:243], v153 offset:28672
  ds_read_b64_tr_b16 a[244:245], v154 offset:28672
  ds_read_b64_tr_b16 a[246:247], v155 offset:28672
  ds_read_b64_tr_b16 a[248:249], v152 offset:28736
  ds_read_b64_tr_b16 a[250:251], v153 offset:28736
  ds_read_b64_tr_b16 a[252:253], v154 offset:28736
  ds_read_b64_tr_b16 a[254:255], v155 offset:28736
  s_waitcnt lgkmcnt(0)
  s_lshl_b32 s26, s48, 2
  s_add_u32 s26, s26, s16
  s_lshl_b32 s27, s26, 6
  s_add_u32 s27, s27, s50
  s_lshl_b32 s19, s27, 13
  s_lshl_b32 s27, s50, 5
  s_add_u32 s27, s27, s26
  s_mul_i32 s27, s27, 4096
  s_add_u32 s20, s27, 135266304
  s_lshl_b32 s25, s16, 12
  s_add_u32 s25, s25, 65536
  s_lshl_b32 s26, s16, 13
  v_add_u32 v3, s26, v2
  v_lshrrev_b32 v16, 5, v1
  v_and_b32 v17, 31, v1
  v_bfe_u32 v18, v1, 4, 1
  v_lshl_add_u32 v18, v18, 1, v16
  v_and_b32 v19, 15, v1
  v_lshl_add_u32 v18, v18, 4, v19
  v_lshl_add_u32 v5, v18, 4, s25
  v_bfe_u32 v18, v1, 2, 2
  v_lshl_add_u32 v18, v16, 2, v18
  v_and_b32 v19, 1, v1
  v_lshl_add_u32 v18, v19, 4, v18
  v_lshl_add_u32 v4, v18, 4, s25
  v_lshlrev_b32 v16, 2, v16
  v_sub_u32 v17, v17, v16
  v_mov_b32 v18, 0xf149f2ca
  v_cmp_le_i32 vcc, 0, v17
  s_nop 1
  v_cndmask_b32 v240, v18, 0, vcc
  v_cmp_le_i32 vcc, 1, v17
  s_nop 1
  v_cndmask_b32 v241, v18, 0, vcc
  v_cmp_le_i32 vcc, 2, v17
  s_nop 1
  v_cndmask_b32 v242, v18, 0, vcc
  v_cmp_le_i32 vcc, 3, v17
  s_nop 1
  v_cndmask_b32 v243, v18, 0, vcc
  v_cmp_le_i32 vcc, 8, v17
  s_nop 1
  v_cndmask_b32 v244, v18, 0, vcc
  v_cmp_le_i32 vcc, 9, v17
  s_nop 1
  v_cndmask_b32 v245, v18, 0, vcc
  v_cmp_le_i32 vcc, 10, v17
  s_nop 1
  v_cndmask_b32 v246, v18, 0, vcc
  v_cmp_le_i32 vcc, 11, v17
  s_nop 1
  v_cndmask_b32 v247, v18, 0, vcc
  v_cmp_le_i32 vcc, 16, v17
  s_nop 1
  v_cndmask_b32 v248, v18, 0, vcc
  v_cmp_le_i32 vcc, 17, v17
  s_nop 1
  v_cndmask_b32 v249, v18, 0, vcc
  v_cmp_le_i32 vcc, 18, v17
  s_nop 1
  v_cndmask_b32 v250, v18, 0, vcc
  v_cmp_le_i32 vcc, 19, v17
  s_nop 1
  v_cndmask_b32 v251, v18, 0, vcc
  v_cmp_le_i32 vcc, 24, v17
  s_nop 1
  v_cndmask_b32 v252, v18, 0, vcc
  v_cmp_le_i32 vcc, 25, v17
  s_nop 1
  v_cndmask_b32 v253, v18, 0, vcc
  v_cmp_le_i32 vcc, 26, v17
  s_nop 1
  v_cndmask_b32 v254, v18, 0, vcc
  v_cmp_le_i32 vcc, 27, v17
  s_nop 1
  v_cndmask_b32 v255, v18, 0, vcc
  v_mov_b32 v21, v2
  s_barrier
  s_lshl_b32 s77, s48, 2
  s_add_u32 s77, s77, s16
  s_mul_i32 s78, s77, 896
  s_add_u32 s76, s78, 148898304
  s_mov_b32 s71, 0
  s_branch M_sg_60
M_sw_59:
  s_sleep 8
  s_add_u32 s71, s71, 1
  s_cmp_gt_u32 s71, 262144
  s_cbranch_scc1 M_exit
M_sg_60:
  s_mov_b32 s79, 0
  s_atomic_or s79, s[72:73], s76 glc
  s_waitcnt lgkmcnt(0)
  s_cmp_lt_u32 s79, 16
  s_cbranch_scc1 M_sw_59
  s_add_u32 s76, s78, 148898048
  s_mov_b32 s71, 0
  s_branch M_sg_62
M_sw_61:
  s_sleep 8
  s_add_u32 s71, s71, 1
  s_cmp_gt_u32 s71, 262144
  s_cbranch_scc1 M_exit
M_sg_62:
  s_mov_b32 s79, 0
  s_atomic_or s79, s[72:73], s76 glc
  s_waitcnt lgkmcnt(0)
  s_cmp_lt_u32 s79, 16
  s_cbranch_scc1 M_sw_61
M_xok_58:
  s_lshl_b32 s77, s77, 7
  s_add_u32 s54, s77, 148926464
  s_add_u32 s52, s50, 1
  s_mov_b32 s53, 0
  s_mov_b32 s30, 0x200
  s_add_u32 s28, s19, 50331648
  buffer_load_dwordx4 v[144:147], v21, s[4:7], s28 offen offset:0 sc1
  buffer_load_dwordx4 v[148:151], v21, s[4:7], s28 offen offset:1024 sc1
  buffer_load_dwordx4 v[152:155], v21, s[4:7], s28 offen offset:2048 sc1
  buffer_load_dwordx4 v[156:159], v21, s[4:7], s28 offen offset:3072 sc1
  s_add_u32 s29, s19, 50335744
  buffer_load_dwordx4 v[160:163], v21, s[4:7], s29 offen offset:0 sc1
  buffer_load_dwordx4 v[164:167], v21, s[4:7], s29 offen offset:1024 sc1
  buffer_load_dwordx4 v[168:171], v21, s[4:7], s29 offen offset:2048 sc1
  buffer_load_dwordx4 v[172:175], v21, s[4:7], s29 offen offset:3072 sc1
  s_add_u32 s28, s19, 67108864
  buffer_load_dwordx4 v[176:179], v21, s[4:7], s28 offen offset:0 sc1
  buffer_load_dwordx4 v[180:183], v21, s[4:7], s28 offen offset:1024 sc1
  buffer_load_dwordx4 v[184:187], v21, s[4:7], s28 offen offset:2048 sc1
  buffer_load_dwordx4 v[188:191], v21, s[4:7], s28 offen offset:3072 sc1
  s_add_u32 s29, s19, 67112960
  buffer_load_dwordx4 v[192:195], v21, s[4:7], s29 offen offset:0 sc1
  buffer_load_dwordx4 v[196:199], v21, s[4:7], s29 offen offset:1024 sc1
  buffer_load_dwordx4 v[200:203], v21, s[4:7], s29 offen offset:2048 sc1
  buffer_load_dwordx4 v[204:207], v21, s[4:7], s29 offen offset:3072 sc1
  s_add_u32 s28, s19, 83886080
  buffer_load_dwordx4 v[208:211], v21, s[4:7], s28 offen offset:0 sc1
  buffer_load_dwordx4 v[212:215], v21, s[4:7], s28 offen offset:1024 sc1
  buffer_load_dwordx4 v[216:219], v21, s[4:7], s28 offen offset:2048 sc1
  buffer_load_dwordx4 v[220:223], v21, s[4:7], s28 offen offset:3072 sc1
  s_add_u32 s29, s19, 83890176
  buffer_load_dwordx4 v[224:227], v21, s[4:7], s29 offen offset:0 sc1
  buffer_load_dwordx4 v[228:231], v21, s[4:7], s29 offen offset:1024 sc1
  buffer_load_dwordx4 v[232:235], v21, s[4:7], s29 offen offset:2048 sc1
  buffer_load_dwordx4 v[236:239], v21, s[4:7], s29 offen offset:3072 sc1
  s_mov_b32 s24, 0
  v_mov_b32 v22, 0x40000000
  s_sub_u32 s21, s21, s22
F_top_63:
  s_waitcnt vmcnt(8)
  v_mfma_f32_32x32x16_bf16 v[24:39], v[176:179], v[144:147], v[240:255]
  s_nop 1
  v_cvt_pk_bf16_f32 v128, v64, v65
  v_cvt_pk_bf16_f32 v129, v66, v67
  v_cvt_pk_bf16_f32 v130, v68, v69
  v_cvt_pk_bf16_f32 v131, v70, v71
  v_mfma_f32_32x32x16_bf16 v[24:39], v[180:183], v[148:151], v[24:39]
  buffer_store_dwordx4 v[128:131], v22, s[4:7], s21 offen offset:0 sc1
  v_mfma_f32_32x32x16_bf16 v[24:39], v[184:187], v[152:155], v[24:39]
  v_cvt_pk_bf16_f32 v132, v72, v73
  v_cvt_pk_bf16_f32 v133, v74, v75
  v_cvt_pk_bf16_f32 v134, v76, v77
  v_cvt_pk_bf16_f32 v135, v78, v79
  v_mfma_f32_32x32x16_bf16 v[24:39], v[188:191], v[156:159], v[24:39]
  buffer_store_dwordx4 v[132:135], v22, s[4:7], s21 offen offset:256 sc1
  v_mfma_f32_32x32x16_bf16 v[24:39], v[192:195], v[160:163], v[24:39]
  v_cvt_pk_bf16_f32 v136, v80, v81
  v_cvt_pk_bf16_f32 v137, v82, v83
  v_cvt_pk_bf16_f32 v138, v84, v85
  v_cvt_pk_bf16_f32 v139, v86, v87
  v_mfma_f32_32x32x16_bf16 v[24:39], v[196:199], v[164:167], v[24:39]
  buffer_store_dwordx4 v[136:139], v22, s[4:7], s21 offen offset:2048 sc1
  v_mfma_f32_32x32x16_bf16 v[24:39], v[200:203], v[168:171], v[24:39]
  v_cvt_pk_bf16_f32 v140, v88, v89
  v_cvt_pk_bf16_f32 v141, v90, v91
  v_cvt_pk_bf16_f32 v142, v92, v93
  v_cvt_pk_bf16_f32 v143, v94, v95
  v_mfma_f32_32x32x16_bf16 v[24:39], v[204:207], v[172:175], v[24:39]
  buffer_store_dwordx4 v[140:143], v22, s[4:7], s21 offen offset:2304 sc1
  s_add_u32 s21, s21, s22
  v_mov_b32 v22, v20
  s_cmp_lg_u32 s24, 0
  s_cbranch_scc1 F_have_64
  s_cmp_le_u32 s52, 58
  s_cbranch_scc1 M_dp_65
  s_mov_b32 s71, 0
  v_add_u32 v16, s25, v2
  s_branch M_dp_67
M_dp_66:
  s_sleep 1
  s_add_u32 s71, s71, 1
  s_cmp_gt_u32 s71, 262144
  s_cbranch_scc1 M_exit
M_dp_67:
  buffer_load_dword v23, off, s[4:7], s54 sc1
  buffer_load_dwordx4 v[96:99], v2, s[4:7], s20 offen offset:0 sc1
  buffer_load_dwordx4 v[100:103], v2, s[4:7], s20 offen offset:1024 sc1
  buffer_load_dwordx4 v[104:107], v2, s[4:7], s20 offen offset:2048 sc1
  buffer_load_dwordx4 v[108:111], v2, s[4:7], s20 offen offset:3072 sc1
  s_waitcnt vmcnt(3)
  v_max_u32 v17, v96, v97
  v_max3_u32 v17, v17, v98, v99
  s_waitcnt vmcnt(2)
  v_max3_u32 v17, v17, v100, v101
  v_max3_u32 v17, v17, v102, v103
  s_waitcnt vmcnt(1)
  v_max3_u32 v17, v17, v104, v105
  v_max3_u32 v17, v17, v106, v107
  s_waitcnt vmcnt(0)
  v_max3_u32 v17, v17, v108, v109
  v_max3_u32 v17, v17, v110, v111
  v_cmp_eq_u32 vcc, -1, v17
  s_cbranch_vccz M_dp_68
  v_cmp_gt_u32 vcc, s52, v23
  s_cbranch_vccnz M_dp_66
  s_branch M_dp_65
M_dp_68:
  ds_write_b128 v16, v[96:99] offset:0
  ds_write_b128 v16, v[100:103] offset:1024
  ds_write_b128 v16, v[104:107] offset:2048
  ds_write_b128 v16, v[108:111] offset:3072
  s_branch F_have_64
M_dp_65:
  v_mov_b32 v16, s54
  v_mov_b32 v17, s52
  s_mov_b32 s71, 0
  s_branch M_vg_70
M_vw_69:
  s_sleep 2
  s_add_u32 s71, s71, 1
  s_cmp_gt_u32 s71, 262144
  s_cbranch_scc1 M_exit
M_vg_70:
  buffer_load_dword v23, v16, s[4:7], 0 offen sc1
  s_waitcnt vmcnt(0)
  v_cmp_lt_u32 vcc, v23, v17
  s_cbranch_vccnz M_vw_69
  s_mov_b32 m0, s25
  s_nop 0
  buffer_load_dwordx4 v2, s[4:7], s20 offen offset:0 sc1 lds
  buffer_load_dwordx4 v2, s[4:7], s20 offen offset:1024 sc1 lds
  buffer_load_dwordx4 v2, s[4:7], s20 offen offset:2048 sc1 lds
  buffer_load_dwordx4 v2, s[4:7], s20 offen offset:3072 sc1 lds
  s_waitcnt vmcnt(0)
F_have_64:
  ds_read_b64_tr_b16 v[176:177], v4 offset:8
  ds_read_b64_tr_b16 v[178:179], v4 offset:136
  ds_read_b64_tr_b16 v[180:181], v4 offset:520
  ds_read_b64_tr_b16 v[182:183], v4 offset:648
  ds_read_b64_tr_b16 v[184:185], v4 offset:1032
  ds_read_b64_tr_b16 v[186:187], v4 offset:1160
  ds_read_b64_tr_b16 v[188:189], v4 offset:1544
  ds_read_b64_tr_b16 v[190:191], v4 offset:1672
  ds_read_b64_tr_b16 v[192:193], v4 offset:2056
  ds_read_b64_tr_b16 v[194:195], v4 offset:2184
  ds_read_b64_tr_b16 v[196:197], v4 offset:2568
  ds_read_b64_tr_b16 v[198:199], v4 offset:2696
  s_sub_u32 s23, s23, 1
  s_cmp_gt_u32 s23, 0
  s_cselect_b32 s26, s51, 0
  s_cselect_b32 s27, 0, 0x40000000
  v_or_b32 v21, s27, v21
  s_lshl_b32 s27, s26, 13
  s_add_u32 s19, s19, s27
  s_mul_i32 s27, s26, 131072
  s_add_u32 s20, s20, s27
  s_cmp_lg_u32 s23, 24
  s_cbranch_scc1 M_xok_71
  s_lshl_b32 s77, s48, 2
  s_add_u32 s77, s77, s16
  s_mul_i32 s78, s77, 896
  s_add_u32 s76, s78, 148898304
  s_mov_b32 s71, 0
  s_branch M_sg_73
M_sw_72:
  s_sleep 8
  s_add_u32 s71, s71, 1
  s_cmp_gt_u32 s71, 262144
  s_cbranch_scc1 M_exit
M_sg_73:
  s_mov_b32 s79, 0
  s_atomic_or s79, s[72:73], s76 glc
  s_waitcnt lgkmcnt(0)
  s_cmp_lt_u32 s79, 32
  s_cbranch_scc1 M_sw_72
  s_add_u32 s76, s78, 148898432
  s_mov_b32 s71, 0
  s_branch M_sg_75
M_sw_74:
  s_sleep 8
  s_add_u32 s71, s71, 1
  s_cmp_gt_u32 s71, 262144
  s_cbranch_scc1 M_exit
M_sg_75:
  s_mov_b32 s79, 0
  s_atomic_or s79, s[72:73], s76 glc
  s_waitcnt lgkmcnt(0)
  s_cmp_lt_u32 s79, 32
  s_cbranch_scc1 M_sw_74
  s_add_u32 s76, s78, 148898048
  s_mov_b32 s71, 0
  s_branch M_sg_77
M_sw_76:
  s_sleep 8
  s_add_u32 s71, s71, 1
  s_cmp_gt_u32 s71, 262144
  s_cbranch_scc1 M_exit
M_sg_77:
  s_mov_b32 s79, 0
  s_atomic_or s79, s[72:73], s76 glc
  s_waitcnt lgkmcnt(0)
  s_cmp_lt_u32 s79, 30
  s_cbranch_scc1 M_sw_76
  s_add_u32 s76, s78, 148898176
  s_mov_b32 s71, 0
  s_branch M_sg_79
M_sw_78:
  s_sleep 8
  s_add_u32 s71, s71, 1
  s_cmp_gt_u32 s71, 262144
  s_cbranch_scc1 M_exit
M_sg_79:
  s_mov_b32 s79, 0
  s_atomic_or s79, s[72:73], s76 glc
  s_waitcnt lgkmcnt(0)
  s_cmp_lt_u32 s79, 34
  s_cbranch_scc1 M_sw_78
M_xok_71:
  s_waitcnt lgkmcnt(10)
  v_mfma_f32_32x32x16_bf16 v[40:55], v[176:179], v[144:147], 0
  ds_read_b64_tr_b16 v[200:201], v4 offset:3080
  ds_read_b64_tr_b16 v[202:203], v4 offset:3208
  v_max_f32 v6, v24, v25
  s_waitcnt lgkmcnt(10)
  v_mfma_f32_32x32x16_bf16 v[40:55], v[180:183], v[148:151], v[40:55]
  ds_read_b64_tr_b16 v[204:205], v4 offset:3592
  ds_read_b64_tr_b16 v[206:207], v4 offset:3720
  v_max3_f32 v6, v6, v26, v27
  s_waitcnt lgkmcnt(10)
  v_mfma_f32_32x32x16_bf16 v[40:55], v[184:187], v[152:155], v[40:55]
  ds_read_b64 v[56:57], v5 offset:0
  ds_read_b64 v[58:59], v5 offset:1024
  v_max3_f32 v6, v6, v28, v29
  s_waitcnt lgkmcnt(10)
  v_mfma_f32_32x32x16_bf16 v[40:55], v[188:191], v[156:159], v[40:55]
  ds_read_b64 v[60:61], v5 offset:2048
  ds_read_b64 v[62:63], v5 offset:3072
  v_max3_f32 v6, v6, v30, v31
  s_waitcnt lgkmcnt(10)
  v_mfma_f32_32x32x16_bf16 v[40:55], v[192:195], v[160:163], v[40:55]
  v_max3_f32 v6, v6, v32, v33
  s_waitcnt lgkmcnt(8)
  v_mfma_f32_32x32x16_bf16 v[40:55], v[196:199], v[164:167], v[40:55]
  v_max3_f32 v6, v6, v34, v35
  s_waitcnt lgkmcnt(6)
  v_mfma_f32_32x32x16_bf16 v[40:55], v[200:203], v[168:171], v[40:55]
  v_max3_f32 v6, v6, v36, v37
  s_waitcnt lgkmcnt(4)
  v_mfma_f32_32x32x16_bf16 v[40:55], v[204:207], v[172:175], v[40:55]
  v_max3_f32 v6, v6, v38, v39
  s_add_u32 s28, s19, 50331648
  buffer_load_dwordx4 v[144:147], v21, s[4:7], s28 offen offset:0 sc1
  buffer_load_dwordx4 v[148:151], v21, s[4:7], s28 offen offset:1024 sc1
  s_nop 7
  v_max3_f32 v6, v6, v40, v41
  v_max3_f32 v6, v6, v42, v43
  v_mov_b32 v16, v6
  s_nop 1
  v_permlane32_swap_b32 v6, v16
  s_nop 1
  v_max_f32 v6, v6, v16
  v_pk_add_f32 v[24:25], v[24:25], v[6:7] op_sel_hi:[1,0] neg_lo:[0,1] neg_hi:[0,1]
  v_pk_add_f32 v[26:27], v[26:27], v[6:7] op_sel_hi:[1,0] neg_lo:[0,1] neg_hi:[0,1]
  v_pk_add_f32 v[28:29], v[28:29], v[6:7] op_sel_hi:[1,0] neg_lo:[0,1] neg_hi:[0,1]
  v_pk_add_f32 v[30:31], v[30:31], v[6:7] op_sel_hi:[1,0] neg_lo:[0,1] neg_hi:[0,1]
  v_pk_add_f32 v[32:33], v[32:33], v[6:7] op_sel_hi:[1,0] neg_lo:[0,1] neg_hi:[0,1]
  v_pk_add_f32 v[34:35], v[34:35], v[6:7] op_sel_hi:[1,0] neg_lo:[0,1] neg_hi:[0,1]
  v_pk_add_f32 v[36:37], v[36:37], v[6:7] op_sel_hi:[1,0] neg_lo:[0,1] neg_hi:[0,1]
  v_pk_add_f32 v[38:39], v[38:39], v[6:7] op_sel_hi:[1,0] neg_lo:[0,1] neg_hi:[0,1]
  v_pk_add_f32 v[40:41], v[40:41], v[6:7] op_sel_hi:[1,0] neg_lo:[0,1] neg_hi:[0,1]
  v_pk_add_f32 v[42:43], v[42:43], v[6:7] op_sel_hi:[1,0] neg_lo:[0,1] neg_hi:[0,1]
  v_exp_f32 v24, v24
  v_exp_f32 v25, v25
  v_exp_f32 v26, v26
  v_exp_f32 v27, v27
  v_exp_f32 v28, v28
  v_exp_f32 v29, v29
  v_exp_f32 v30, v30
  v_exp_f32 v31, v31
  v_exp_f32 v32, v32
  v_exp_f32 v33, v33
  buffer_load_dwordx4 v[152:155], v21, s[4:7], s28 offen offset:2048 sc1
  v_exp_f32 v34, v34
  v_exp_f32 v35, v35
  v_exp_f32 v36, v36
  v_exp_f32 v37, v37
  v_exp_f32 v38, v38
  v_exp_f32 v39, v39
  v_exp_f32 v40, v40
  v_exp_f32 v41, v41
  v_exp_f32 v42, v42
  v_exp_f32 v43, v43
  v_pk_add_f32 v[16:17], v[24:25], v[26:27]
  v_pk_add_f32 v[16:17], v[16:17], v[28:29]
  v_pk_add_f32 v[16:17], v[16:17], v[30:31]
  v_pk_add_f32 v[16:17], v[16:17], v[32:33]
  v_pk_add_f32 v[16:17], v[16:17], v[34:35]
  v_pk_add_f32 v[16:17], v[16:17], v[36:37]
  v_pk_add_f32 v[16:17], v[16:17], v[38:39]
  v_pk_add_f32 v[16:17], v[16:17], v[40:41]
  v_pk_add_f32 v[16:17], v[16:17], v[42:43]
  v_add_f32 v16, v16, v17
  v_mov_b32 v17, v16
  buffer_load_dwordx4 v[156:159], v21, s[4:7], s28 offen offset:3072 sc1
  s_nop 0
  v_permlane32_swap_b32 v16, v17
  s_nop 1
  v_add_f32 v16, v16, v17
  v_rcp_f32 v6, v16
  s_nop 0
  v_pk_mul_f32 v[24:25], v[24:25], v[6:7] op_sel_hi:[1,0]
  v_pk_mul_f32 v[26:27], v[26:27], v[6:7] op_sel_hi:[1,0]
  v_pk_mul_f32 v[28:29], v[28:29], v[6:7] op_sel_hi:[1,0]
  v_pk_mul_f32 v[30:31], v[30:31], v[6:7] op_sel_hi:[1,0]
  v_pk_mul_f32 v[32:33], v[32:33], v[6:7] op_sel_hi:[1,0]
  v_pk_mul_f32 v[34:35], v[34:35], v[6:7] op_sel_hi:[1,0]
  v_pk_mul_f32 v[36:37], v[36:37], v[6:7] op_sel_hi:[1,0]
  v_pk_mul_f32 v[38:39], v[38:39], v[6:7] op_sel_hi:[1,0]
  v_pk_mul_f32 v[40:41], v[40:41], v[6:7] op_sel_hi:[1,0]
  v_pk_mul_f32 v[42:43], v[42:43], v[6:7] op_sel_hi:[1,0]
  v_cvt_pk_bf16_f32 v128, v24, v25
  v_cvt_pk_bf16_f32 v129, v26, v27
  v_cvt_pk_bf16_f32 v130, v28, v29
  v_cvt_pk_bf16_f32 v131, v30, v31
  v_cvt_pk_bf16_f32 v132, v32, v33
  v_cvt_pk_bf16_f32 v133, v34, v35
  v_cvt_pk_bf16_f32 v134, v36, v37
  v_cvt_pk_bf16_f32 v135, v38, v39
  v_cvt_pk_bf16_f32 v136, v40, v41
  v_cvt_pk_bf16_f32 v137, v42, v43
  s_waitcnt vmcnt(8) lgkmcnt(0)
  v_mfma_f32_32x32x16_bf16 v[64:79], v[208:211], v[128:131], 0
  s_add_u32 s29, s19, 50335744
  buffer_load_dwordx4 v[160:163], v21, s[4:7], s29 offen offset:0 sc1
  v_mfma_f32_32x32x16_bf16 v[64:79], v[212:215], v[132:135], v[64:79]
  v_mfma_f32_32x32x8_bf16 v[64:79], v[56:57], v[136:137], v[64:79]
  v_mfma_f32_32x32x16_bf16 v[80:95], v[216:219], v[128:131], 0
  buffer_load_dwordx4 v[164:167], v21, s[4:7], s29 offen offset:1024 sc1
  v_mfma_f32_32x32x16_bf16 v[80:95], v[220:223], v[132:135], v[80:95]
  v_cvt_pk_bf16_f32 v24, v64, v65
  v_cvt_pk_bf16_f32 v25, v66, v67
  v_cvt_pk_bf16_f32 v26, v68, v69
  v_cvt_pk_bf16_f32 v27, v70, v71
  v_mfma_f32_32x32x8_bf16 v[80:95], v[58:59], v[136:137], v[80:95]
  ds_write_b128 v3, v[24:27] offset:0
  v_cvt_pk_bf16_f32 v28, v72, v73
  v_cvt_pk_bf16_f32 v29, v74, v75
  v_cvt_pk_bf16_f32 v30, v76, v77
  v_cvt_pk_bf16_f32 v31, v78, v79
  v_mfma_f32_32x32x16_bf16 v[96:111], v[224:227], v[128:131], 0
  ds_write_b128 v3, v[28:31] offset:1024
  buffer_load_dwordx4 v[168:171], v21, s[4:7], s29 offen offset:2048 sc1
  v_mfma_f32_32x32x16_bf16 v[96:111], v[228:231], v[132:135], v[96:111]
  v_cvt_pk_bf16_f32 v32, v80, v81
  v_cvt_pk_bf16_f32 v33, v82, v83
  v_cvt_pk_bf16_f32 v34, v84, v85
  v_cvt_pk_bf16_f32 v35, v86, v87
  v_mfma_f32_32x32x8_bf16 v[96:111], v[60:61], v[136:137], v[96:111]
  ds_write_b128 v3, v[32:35] offset:2048
  v_cvt_pk_bf16_f32 v36, v88, v89
  v_cvt_pk_bf16_f32 v37, v90, v91
  v_cvt_pk_bf16_f32 v38, v92, v93
  v_cvt_pk_bf16_f32 v39, v94, v95
  v_mfma_f32_32x32x16_bf16 v[112:127], v[232:235], v[128:131], 0
  ds_write_b128 v3, v[36:39] offset:3072
  buffer_load_dwordx4 v[172:175], v21, s[4:7], s29 offen offset:3072 sc1
  v_mfma_f32_32x32x16_bf16 v[112:127], v[236:239], v[132:135], v[112:127]
  v_cvt_pk_bf16_f32 v40, v96, v97
  v_cvt_pk_bf16_f32 v41, v98, v99
  v_cvt_pk_bf16_f32 v42, v100, v101
  v_cvt_pk_bf16_f32 v43, v102, v103
  v_mfma_f32_32x32x8_bf16 v[112:127], v[62:63], v[136:137], v[112:127]
  ds_write_b128 v3, v[40:43] offset:4096
  v_cvt_pk_bf16_f32 v44, v104, v105
  v_cvt_pk_bf16_f32 v45, v106, v107
  v_cvt_pk_bf16_f32 v46, v108, v109
  v_cvt_pk_bf16_f32 v47, v110, v111
  ds_write_b128 v3, v[44:47] offset:5120
  s_nop 5
  v_cvt_pk_bf16_f32 v48, v112, v113
  v_cvt_pk_bf16_f32 v49, v114, v115
  v_cvt_pk_bf16_f32 v50, v116, v117
  v_cvt_pk_bf16_f32 v51, v118, v119
  ds_write_b128 v3, v[48:51] offset:6144
  v_cvt_pk_bf16_f32 v52, v120, v121
  v_cvt_pk_bf16_f32 v53, v122, v123
  v_cvt_pk_bf16_f32 v54, v124, v125
  v_cvt_pk_bf16_f32 v55, v126, v127
  ds_write_b128 v3, v[52:55] offset:7168
  s_waitcnt vmcnt(8)
  s_waitcnt lgkmcnt(0)
  s_barrier
  ds_read_b128 v[24:27], v8 offset:0
  ds_read_b128 v[28:31], v9 offset:0
  ds_read_b128 v[32:35], v10 offset:0
  ds_read_b128 v[36:39], v11 offset:0
  ds_read_b128 v[40:43], v12 offset:0
  ds_read_b128 v[44:47], v13 offset:0
  buffer_load_dword v23, off, s[4:7], s54 sc1
  v_mov_b32 v16, s30
  v_min_u32 v17, 1, v0
  v_lshlrev_b32 v17, 30, v17
  buffer_store_dword v16, v17, s[4:7], s31 offen sc1
  s_add_u32 s30, s30, 1
  s_add_u32 s52, s52, 2
  s_waitcnt lgkmcnt(5)
  v_mfma_f32_16x16x32_bf16 v[64:67], a[0:3], v[24:27], 0
  s_add_u32 s28, s19, 67108864
  ds_read_b128 v[48:51], v14 offset:0
  v_mfma_f32_16x16x32_bf16 v[68:71], a[4:7], v[24:27], 0
  v_mfma_f32_16x16x32_bf16 v[80:83], a[8:11], v[24:27], 0
  v_mfma_f32_16x16x32_bf16 v[84:87], a[12:15], v[24:27], 0
  s_waitcnt lgkmcnt(5)
  v_mfma_f32_16x16x32_bf16 v[72:75], a[0:3], v[28:31], 0
  ds_read_b128 v[52:55], v15 offset:0
  v_mfma_f32_16x16x32_bf16 v[76:79], a[4:7], v[28:31], 0
  v_mfma_f32_16x16x32_bf16 v[88:91], a[8:11], v[28:31], 0
  buffer_load_dwordx4 v[176:179], v21, s[4:7], s28 offen offset:0 sc1
  v_mfma_f32_16x16x32_bf16 v[92:95], a[12:15], v[28:31], 0
  s_waitcnt lgkmcnt(5)
  v_mfma_f32_16x16x32_bf16 v[64:67], a[16:19], v[32:35], v[64:67]
  ds_read_b128 v[24:27], v8 offset:8192
  v_mfma_f32_16x16x32_bf16 v[68:71], a[20:23], v[32:35], v[68:71]
  v_mfma_f32_16x16x32_bf16 v[80:83], a[24:27], v[32:35], v[80:83]
  v_mfma_f32_16x16x32_bf16 v[84:87], a[28:31], v[32:35], v[84:87]
  s_waitcnt lgkmcnt(5)
  v_mfma_f32_16x16x32_bf16 v[72:75], a[16:19], v[36:39], v[72:75]
  ds_read_b128 v[28:31], v9 offset:8192
  v_mfma_f32_16x16x32_bf16 v[76:79], a[20:23], v[36:39], v[76:79]
  v_mfma_f32_16x16x32_bf16 v[88:91], a[24:27], v[36:39], v[88:91]
  buffer_load_dwordx4 v[180:183], v21, s[4:7], s28 offen offset:1024 sc1
  v_mfma_f32_16x16x32_bf16 v[92:95], a[28:31], v[36:39], v[92:95]
  s_waitcnt lgkmcnt(5)
  v_mfma_f32_16x16x32_bf16 v[64:67], a[32:35], v[40:43], v[64:67]
  ds_read_b128 v[32:35], v10 offset:8192
  v_mfma_f32_16x16x32_bf16 v[68:71], a[36:39], v[40:43], v[68:71]
  v_mfma_f32_16x16x32_bf16 v[80:83], a[40:43], v[40:43], v[80:83]
  v_mfma_f32_16x16x32_bf16 v[84:87], a[44:47], v[40:43], v[84:87]
  s_waitcnt lgkmcnt(5)
  v_mfma_f32_16x16x32_bf16 v[72:75], a[32:35], v[44:47], v[72:75]
  ds_read_b128 v[36:39], v11 offset:8192
  v_mfma_f32_16x16x32_bf16 v[76:79], a[36:39], v[44:47], v[76:79]
  v_mfma_f32_16x16x32_bf16 v[88:91], a[40:43], v[44:47], v[88:91]
  buffer_load_dwordx4 v[184:187], v21, s[4:7], s28 offen offset:2048 sc1
  v_mfma_f32_16x16x32_bf16 v[92:95], a[44:47], v[44:47], v[92:95]
  s_waitcnt lgkmcnt(5)
  v_mfma_f32_16x16x32_bf16 v[64:67], a[48:51], v[48:51], v[64:67]
  ds_read_b128 v[40:43], v12 offset:8192
  v_mfma_f32_16x16x32_bf16 v[68:71], a[52:55], v[48:51], v[68:71]
  v_mfma_f32_16x16x32_bf16 v[80:83], a[56:59], v[48:51], v[80:83]
  v_mfma_f32_16x16x32_bf16 v[84:87], a[60:63], v[48:51], v[84:87]
  s_waitcnt lgkmcnt(5)
  v_mfma_f32_16x16x32_bf16 v[72:75], a[48:51], v[52:55], v[72:75]
  ds_read_b128 v[44:47], v13 offset:8192
  v_mfma_f32_16x16x32_bf16 v[76:79], a[52:55], v[52:55], v[76:79]
  v_mfma_f32_16x16x32_bf16 v[88:91], a[56:59], v[52:55], v[88:91]
  buffer_load_dwordx4 v[188:191], v21, s[4:7], s28 offen offset:3072 sc1
  v_mfma_f32_16x16x32_bf16 v[92:95], a[60:63], v[52:55], v[92:95]
  s_waitcnt lgkmcnt(5)
  v_mfma_f32_16x16x32_bf16 v[64:67], a[64:67], v[24:27], v[64:67]
  s_add_u32 s29, s19, 67112960
  ds_read_b128 v[48:51], v14 offset:8192
  v_mfma_f32_16x16x32_bf16 v[68:71], a[68:71], v[24:27], v[68:71]
  v_mfma_f32_16x16x32_bf16 v[80:83], a[72:75], v[24:27], v[80:83]
  v_mfma_f32_16x16x32_bf16 v[84:87], a[76:79], v[24:27], v[84:87]
  s_waitcnt lgkmcnt(5)
  v_mfma_f32_16x16x32_bf16 v[72:75], a[64:67], v[28:31], v[72:75]
  ds_read_b128 v[52:55], v15 offset:8192
  v_mfma_f32_16x16x32_bf16 v[76:79], a[68:71], v[28:31], v[76:79]
  v_mfma_f32_16x16x32_bf16 v[88:91], a[72:75], v[28:31], v[88:91]
  buffer_load_dwordx4 v[192:195], v21, s[4:7], s29 offen offset:0 sc1
  v_mfma_f32_16x16x32_bf16 v[92:95], a[76:79], v[28:31], v[92:95]
  s_waitcnt lgkmcnt(5)
  v_mfma_f32_16x16x32_bf16 v[64:67], a[80:83], v[32:35], v[64:67]
  ds_read_b128 v[24:27], v8 offset:16384
  v_mfma_f32_16x16x32_bf16 v[68:71], a[84:87], v[32:35], v[68:71]
  v_mfma_f32_16x16x32_bf16 v[80:83], a[88:91], v[32:35], v[80:83]
  v_mfma_f32_16x16x32_bf16 v[84:87], a[92:95], v[32:35], v[84:87]
  s_waitcnt lgkmcnt(5)
  v_mfma_f32_16x16x32_bf16 v[72:75], a[80:83], v[36:39], v[72:75]
  ds_read_b128 v[28:31], v9 offset:16384
  v_mfma_f32_16x16x32_bf16 v[76:79], a[84:87], v[36:39], v[76:79]
  v_mfma_f32_16x16x32_bf16 v[88:91], a[88:91], v[36:39], v[88:91]
  buffer_load_dwordx4 v[196:199], v21, s[4:7], s29 offen offset:1024 sc1
  v_mfma_f32_16x16x32_bf16 v[92:95], a[92:95], v[36:39], v[92:95]
  s_waitcnt lgkmcnt(5)
  v_mfma_f32_16x16x32_bf16 v[64:67], a[96:99], v[40:43], v[64:67]
  ds_read_b128 v[32:35], v10 offset:16384
  v_mfma_f32_16x16x32_bf16 v[68:71], a[100:103], v[40:43], v[68:71]
  v_mfma_f32_16x16x32_bf16 v[80:83], a[104:107], v[40:43], v[80:83]
  v_mfma_f32_16x16x32_bf16 v[84:87], a[108:111], v[40:43], v[84:87]
  s_waitcnt lgkmcnt(5)
  s_waitcnt vmcnt(7)
  v_readfirstlane_b32 s53, v23
  s_nop 0
  s_cmp_ge_u32 s53, s52
  s_cselect_b32 s24, 1, 0
  s_cbranch_scc0 F_nopre_80
  s_mov_b32 m0, s25
  s_nop 0
  buffer_load_dwordx4 v2, s[4:7], s20 offen offset:0 sc1 lds
  buffer_load_dwordx4 v2, s[4:7], s20 offen offset:1024 sc1 lds
  buffer_load_dwordx4 v2, s[4:7], s20 offen offset:2048 sc1 lds
  buffer_load_dwordx4 v2, s[4:7], s20 offen offset:3072 sc1 lds
F_nopre_80:
  v_mfma_f32_16x16x32_bf16 v[72:75], a[96:99], v[44:47], v[72:75]
  ds_read_b128 v[36:39], v11 offset:16384
  v_mfma_f32_16x16x32_bf16 v[76:79], a[100:103], v[44:47], v[76:79]
  v_mfma_f32_16x16x32_bf16 v[88:91], a[104:107], v[44:47], v[88:91]
  buffer_load_dwordx4 v[200:203], v21, s[4:7], s29 offen offset:2048 sc1
  v_mfma_f32_16x16x32_bf16 v[92:95], a[108:111], v[44:47], v[92:95]
  s_waitcnt lgkmcnt(5)
  v_mfma_f32_16x16x32_bf16 v[64:67], a[112:115], v[48:51], v[64:67]
  ds_read_b128 v[40:43], v12 offset:16384
  v_mfma_f32_16x16x32_bf16 v[68:71], a[116:119], v[48:51], v[68:71]
  v_mfma_f32_16x16x32_bf16 v[80:83], a[120:123], v[48:51], v[80:83]
  v_mfma_f32_16x16x32_bf16 v[84:87], a[124:127], v[48:51], v[84:87]
  s_waitcnt lgkmcnt(5)
  v_mfma_f32_16x16x32_bf16 v[72:75], a[112:115], v[52:55], v[72:75]
  ds_read_b128 v[44:47], v13 offset:16384
  v_mfma_f32_16x16x32_bf16 v[76:79], a[116:119], v[52:55], v[76:79]
  v_mfma_f32_16x16x32_bf16 v[88:91], a[120:123], v[52:55], v[88:91]
  buffer_load_dwordx4 v[204:207], v21, s[4:7], s29 offen offset:3072 sc1
  v_mfma_f32_16x16x32_bf16 v[92:95], a[124:127], v[52:55], v[92:95]
  s_waitcnt lgkmcnt(5)
  v_mfma_f32_16x16x32_bf16 v[64:67], a[128:131], v[24:27], v[64:67]
  s_add_u32 s28, s19, 83886080
  ds_read_b128 v[48:51], v14 offset:16384
  v_mfma_f32_16x16x32_bf16 v[68:71], a[132:135], v[24:27], v[68:71]
  v_mfma_f32_16x16x32_bf16 v[80:83], a[136:139], v[24:27], v[80:83]
  v_mfma_f32_16x16x32_bf16 v[84:87], a[140:143], v[24:27], v[84:87]
  s_waitcnt lgkmcnt(5)
  v_mfma_f32_16x16x32_bf16 v[72:75], a[128:131], v[28:31], v[72:75]
  ds_read_b128 v[52:55], v15 offset:16384
  v_mfma_f32_16x16x32_bf16 v[76:79], a[132:135], v[28:31], v[76:79]
  v_mfma_f32_16x16x32_bf16 v[88:91], a[136:139], v[28:31], v[88:91]
  buffer_load_dwordx4 v[208:211], v21, s[4:7], s28 offen offset:0 sc1
  v_mfma_f32_16x16x32_bf16 v[92:95], a[140:143], v[28:31], v[92:95]
  s_waitcnt lgkmcnt(5)
  v_mfma_f32_16x16x32_bf16 v[64:67], a[144:147], v[32:35], v[64:67]
  ds_read_b128 v[24:27], v8 offset:24576
  v_mfma_f32_16x16x32_bf16 v[68:71], a[148:151], v[32:35], v[68:71]
  v_mfma_f32_16x16x32_bf16 v[80:83], a[152:155], v[32:35], v[80:83]
  v_mfma_f32_16x16x32_bf16 v[84:87], a[156:159], v[32:35], v[84:87]
  s_waitcnt lgkmcnt(5)
  v_mfma_f32_16x16x32_bf16 v[72:75], a[144:147], v[36:39], v[72:75]
  ds_read_b128 v[28:31], v9 offset:24576
  v_mfma_f32_16x16x32_bf16 v[76:79], a[148:151], v[36:39], v[76:79]
  v_mfma_f32_16x16x32_bf16 v[88:91], a[152:155], v[36:39], v[88:91]
  buffer_load_dwordx4 v[212:215], v21, s[4:7], s28 offen offset:1024 sc1
  v_mfma_f32_16x16x32_bf16 v[92:95], a[156:159], v[36:39], v[92:95]
  s_waitcnt lgkmcnt(5)
  v_mfma_f32_16x16x32_bf16 v[64:67], a[160:163], v[40:43], v[64:67]
  ds_read_b128 v[32:35], v10 offset:24576
  v_mfma_f32_16x16x32_bf16 v[68:71], a[164:167], v[40:43], v[68:71]
  v_mfma_f32_16x16x32_bf16 v[80:83], a[168:171], v[40:43], v[80:83]
  v_mfma_f32_16x16x32_bf16 v[84:87], a[172:175], v[40:43], v[84:87]
  s_waitcnt lgkmcnt(5)
  v_mfma_f32_16x16x32_bf16 v[72:75], a[160:163], v[44:47], v[72:75]
  ds_read_b128 v[36:39], v11 offset:24576
  v_mfma_f32_16x16x32_bf16 v[76:79], a[164:167], v[44:47], v[76:79]
  v_mfma_f32_16x16x32_bf16 v[88:91], a[168:171], v[44:47], v[88:91]
  buffer_load_dwordx4 v[216:219], v21, s[4:7], s28 offen offset:2048 sc1
  v_mfma_f32_16x16x32_bf16 v[92:95], a[172:175], v[44:47], v[92:95]
  s_waitcnt lgkmcnt(5)
  v_mfma_f32_16x16x32_bf16 v[64:67], a[176:179], v[48:51], v[64:67]
  ds_read_b128 v[40:43], v12 offset:24576
  v_mfma_f32_16x16x32_bf16 v[68:71], a[180:183], v[48:51], v[68:71]
  v_mfma_f32_16x16x32_bf16 v[80:83], a[184:187], v[48:51], v[80:83]
  v_mfma_f32_16x16x32_bf16 v[84:87], a[188:191], v[48:51], v[84:87]
  s_waitcnt lgkmcnt(5)
  v_mfma_f32_16x16x32_bf16 v[72:75], a[176:179], v[52:55], v[72:75]
  ds_read_b128 v[44:47], v13 offset:24576
  v_mfma_f32_16x16x32_bf16 v[76:79], a[180:183], v[52:55], v[76:79]
  v_mfma_f32_16x16x32_bf16 v[88:91], a[184:187], v[52:55], v[88:91]
  buffer_load_dwordx4 v[220:223], v21, s[4:7], s28 offen offset:3072 sc1
  v_mfma_f32_16x16x32_bf16 v[92:95], a[188:191], v[52:55], v[92:95]
  s_waitcnt lgkmcnt(5)
  v_mfma_f32_16x16x32_bf16 v[64:67], a[192:195], v[24:27], v[64:67]
  s_add_u32 s29, s19, 83890176
  ds_read_b128 v[48:51], v14 offset:24576
  v_mfma_f32_16x16x32_bf16 v[68:71], a[196:199], v[24:27], v[68:71]
  v_mfma_f32_16x16x32_bf16 v[80:83], a[200:203], v[24:27], v[80:83]
  v_mfma_f32_16x16x32_bf16 v[84:87], a[204:207], v[24:27], v[84:87]
  s_waitcnt lgkmcnt(5)
  v_mfma_f32_16x16x32_bf16 v[72:75], a[192:195], v[28:31], v[72:75]
  ds_read_b128 v[52:55], v15 offset:24576
  v_mfma_f32_16x16x32_bf16 v[76:79], a[196:199], v[28:31], v[76:79]
  v_mfma_f32_16x16x32_bf16 v[88:91], a[200:203], v[28:31], v[88:91]
  buffer_load_dwordx4 v[224:227], v21, s[4:7], s29 offen offset:0 sc1
  v_mfma_f32_16x16x32_bf16 v[92:95], a[204:207], v[28:31], v[92:95]
  s_waitcnt lgkmcnt(5)
  v_mfma_f32_16x16x32_bf16 v[64:67], a[208:211], v[32:35], v[64:67]
  v_mfma_f32_16x16x32_bf16 v[68:71], a[212:215], v[32:35], v[68:71]
  v_mfma_f32_16x16x32_bf16 v[80:83], a[216:219], v[32:35], v[80:83]
  v_mfma_f32_16x16x32_bf16 v[84:87], a[220:223], v[32:35], v[84:87]
  s_waitcnt lgkmcnt(4)
  v_mfma_f32_16x16x32_bf16 v[72:75], a[208:211], v[36:39], v[72:75]
  v_mfma_f32_16x16x32_bf16 v[76:79], a[212:215], v[36:39], v[76:79]
  v_xor_b32 v8, 0x8000, v8
  v_mfma_f32_16x16x32_bf16 v[88:91], a[216:219], v[36:39], v[88:91]
  buffer_load_dwordx4 v[228:231], v21, s[4:7], s29 offen offset:1024 sc1
  v_mfma_f32_16x16x32_bf16 v[92:95], a[220:223], v[36:39], v[92:95]
  s_waitcnt lgkmcnt(3)
  v_xor_b32 v9, 0x8000, v9
  v_mfma_f32_16x16x32_bf16 v[64:67], a[224:227], v[40:43], v[64:67]
  v_mfma_f32_16x16x32_bf16 v[68:71], a[228:231], v[40:43], v[68:71]
  v_xor_b32 v10, 0x8000, v10
  v_mfma_f32_16x16x32_bf16 v[80:83], a[232:235], v[40:43], v[80:83]
  v_mfma_f32_16x16x32_bf16 v[84:87], a[236:239], v[40:43], v[84:87]
  s_waitcnt lgkmcnt(2)
  v_xor_b32 v11, 0x8000, v11
  v_mfma_f32_16x16x32_bf16 v[72:75], a[224:227], v[44:47], v[72:75]
  v_mfma_f32_16x16x32_bf16 v[76:79], a[228:231], v[44:47], v[76:79]
  v_xor_b32 v12, 0x8000, v12
  v_mfma_f32_16x16x32_bf16 v[88:91], a[232:235], v[44:47], v[88:91]
  buffer_load_dwordx4 v[232:235], v21, s[4:7], s29 offen offset:2048 sc1
  v_mfma_f32_16x16x32_bf16 v[92:95], a[236:239], v[44:47], v[92:95]
  s_waitcnt lgkmcnt(1)
  v_xor_b32 v13, 0x8000, v13
  v_mfma_f32_16x16x32_bf16 v[64:67], a[240:243], v[48:51], v[64:67]
  v_mfma_f32_16x16x32_bf16 v[68:71], a[244:247], v[48:51], v[68:71]
  v_xor_b32 v14, 0x8000, v14
  v_mfma_f32_16x16x32_bf16 v[80:83], a[248:251], v[48:51], v[80:83]
  v_mfma_f32_16x16x32_bf16 v[84:87], a[252:255], v[48:51], v[84:87]
  s_waitcnt lgkmcnt(0)
  v_xor_b32 v15, 0x8000, v15
  v_mfma_f32_16x16x32_bf16 v[72:75], a[240:243], v[52:55], v[72:75]
  v_mfma_f32_16x16x32_bf16 v[76:79], a[244:247], v[52:55], v[76:79]
  v_xor_b32 v3, 0x8000, v3
  v_mfma_f32_16x16x32_bf16 v[88:91], a[248:251], v[52:55], v[88:91]
  buffer_load_dwordx4 v[236:239], v21, s[4:7], s29 offen offset:3072 sc1
  v_mfma_f32_16x16x32_bf16 v[92:95], a[252:255], v[52:55], v[92:95]
  s_cmp_gt_u32 s23, 0
  s_cbranch_scc1 F_top_63
  s_nop 2
  v_cvt_pk_bf16_f32 v128, v64, v65
  v_cvt_pk_bf16_f32 v129, v66, v67
  v_cvt_pk_bf16_f32 v130, v68, v69
  v_cvt_pk_bf16_f32 v131, v70, v71
  buffer_store_dwordx4 v[128:131], v22, s[4:7], s21 offen offset:0 sc1
  v_cvt_pk_bf16_f32 v132, v72, v73
  v_cvt_pk_bf16_f32 v133, v74, v75
  v_cvt_pk_bf16_f32 v134, v76, v77
  v_cvt_pk_bf16_f32 v135, v78, v79
  buffer_store_dwordx4 v[132:135], v22, s[4:7], s21 offen offset:256 sc1
  v_cvt_pk_bf16_f32 v136, v80, v81
  v_cvt_pk_bf16_f32 v137, v82, v83
  v_cvt_pk_bf16_f32 v138, v84, v85
  v_cvt_pk_bf16_f32 v139, v86, v87
  buffer_store_dwordx4 v[136:139], v22, s[4:7], s21 offen offset:2048 sc1
  v_cvt_pk_bf16_f32 v140, v88, v89
  v_cvt_pk_bf16_f32 v141, v90, v91
  v_cvt_pk_bf16_f32 v142, v92, v93
  v_cvt_pk_bf16_f32 v143, v94, v95
  buffer_store_dwordx4 v[140:143], v22, s[4:7], s21 offen offset:2304 sc1
  s_waitcnt vmcnt(0) lgkmcnt(0)
  s_barrier
  v_mov_b32 v144, s30
  v_min_u32 v145, 1, v0
  v_lshlrev_b32 v145, 30, v145
  buffer_store_dword v144, v145, s[4:7], s31 offen sc1
  s_branch M_done
M_team:
  s_mov_b32 s12, s77
  s_load_dwordx4 s[60:63], s[0:1], 64
  s_load_dwordx4 s[64:67], s[0:1], 80
  s_load_dwordx4 s[68:71], s[0:1], 120
  s_load_dwordx2 s[72:73], s[0:1], 56
  v_lshrrev_b32 v1, 6, v0
  v_and_b32 v20, 63, v0
  v_readfirstlane_b32 s13, v1
  s_waitcnt lgkmcnt(0)
  s_mov_b32 s8, s60
  s_and_b32 s9, s61, 0xffff
  s_mov_b32 s10, 0x400000
  s_mov_b32 s11, 0x20000
  s_mov_b32 s40, s62
  s_and_b32 s41, s63, 0xffff
  s_mov_b32 s42, 0x400000
  s_mov_b32 s43, 0x20000
  s_mov_b32 s44, s64
  s_and_b32 s45, s65, 0xffff
  s_mov_b32 s46, 0x400000
  s_mov_b32 s47, 0x20000
  s_mov_b32 s48, s66
  s_and_b32 s49, s67, 0xffff
  s_mov_b32 s50, 0x400000
  s_mov_b32 s51, 0x20000
  s_mov_b32 s4, s70
  s_and_b32 s5, s71, 0xffff
  s_mov_b32 s6, 0x10000000
  s_mov_b32 s7, 0x20000
  s_mov_b32 s76, s72
  s_and_b32 s77, s73, 0xffff
  s_mov_b32 s78, 0x2000
  s_mov_b32 s79, 0x20000
  s_mov_b32 s72, s68
  s_and_b32 s73, s69, 0xffff
  s_mov_b32 s74, 0x100
  s_mov_b32 s75, 0x20000
  s_mov_b64 s[52:53], s[68:69]
  s_mov_b64 s[58:59], s[70:71]
  s_mul_i32 s99, s12, 896
  s_add_u32 s99, s99, 148898048
  s_lshl_b32 s15, s12, 7
  s_add_u32 s15, s15, 148926464
  v_lshrrev_b32 v21, 4, v20
  v_and_b32 v22, 15, v20
  v_and_b32 v23, 1, v21
  v_lshrrev_b32 v24, 1, v21
  v_lshlrev_b32 v2, 4, v20
  s_lshl_b32 s36, s13, 10
  v_add_u32 v59, s36, v2
  s_lshl_b32 s37, s13, 15
  s_add_u32 s37, s37, 32768
  v_add_u32 v4, s37, v2
  v_lshrrev_b32 v25, 2, v20
  v_lshlrev_b32 v25, 13, v25
  v_and_b32 v1, 3, v20
  v_lshl_add_u32 v25, v1, 4, v25
  s_lshl_b32 s36, s13, 6
  s_lshl_b32 s38, s12, 8
  s_add_u32 s36, s36, s38
  v_add_u32 v25, s36, v25
  v_lshrrev_b32 v26, 3, v20
  v_lshlrev_b32 v26, 10, v26
  v_and_b32 v1, 7, v20
  v_lshl_add_u32 v26, v1, 4, v26
  s_lshl_b32 s36, s13, 7
  s_lshl_b32 s38, s12, 17
  s_add_u32 s36, s36, s38
  v_add_u32 v26, s36, v26
  v_bfe_u32 v29, v20, 2, 1
  v_bfe_u32 v30, v20, 3, 1
  v_and_b32 v31, 3, v20
  v_lshl_add_u32 v27, v21, 2, v29
  v_lshlrev_b32 v27, 6, v27
  v_lshl_add_u32 v27, v30, 5, v27
  v_lshl_add_u32 v27, v31, 3, v27
  v_add_u32 v27, s37, v27
  v_xor_b32 v36, 1, v30
  v_lshl_add_u32 v36, v36, 11, v27
  v_lshl_add_u32 v27, v30, 11, v27
  v_lshl_add_u32 v28, v23, 2, v24
  v_lshl_add_u32 v28, v28, 2, v29
  v_lshlrev_b32 v28, 7, v28
  v_lshl_add_u32 v28, v30, 6, v28
  v_lshl_add_u32 v28, v31, 4, v28
  v_add_u32 v28, s37, v28
  s_mov_b32 s39, s37
  s_xor_b32 s36, s13, 0
  s_lshl_b32 s36, s36, 15
  s_add_u32 m0, s39, 0
  s_add_u32 s37, s36, 0
  buffer_load_dwordx4 v26, s[48:51], s37 offen lds
  s_add_u32 m0, s39, 1024
  s_add_u32 s37, s36, 8192
  buffer_load_dwordx4 v26, s[48:51], s37 offen lds
  s_add_u32 m0, s39, 2048
  s_add_u32 s37, s36, 16384
  buffer_load_dwordx4 v26, s[48:51], s37 offen lds
  s_add_u32 m0, s39, 3072
  s_add_u32 s37, s36, 24576
  buffer_load_dwordx4 v26, s[48:51], s37 offen lds
  s_xor_b32 s36, s13, 0
  s_lshl_b32 s36, s36, 15
  s_add_u32 m0, s39, 4096
  s_add_u32 s37, s36, 512
  buffer_load_dwordx4 v26, s[48:51], s37 offen lds
  s_add_u32 m0, s39, 5120
  s_add_u32 s37, s36, 8704
  buffer_load_dwordx4 v26, s[48:51], s37 offen lds
  s_add_u32 m0, s39, 6144
  s_add_u32 s37, s36, 16896
  buffer_load_dwordx4 v26, s[48:51], s37 offen lds
  s_add_u32 m0, s39, 7168
  s_add_u32 s37, s36, 25088
  buffer_load_dwordx4 v26, s[48:51], s37 offen lds
  v_mov_b32 v0, 0x4444
  v_mov_b32 v1, 0xeeee
  v_cmp_lt_u32 vcc, 7, v22
  s_nop 1
  v_cndmask_b32 v32, v0, v1, vcc
  v_mov_b32 v0, v32
  v_and_b32 v32, 7, v20
  v_lshlrev_b32 v32, 4, v32
  v_lshl_add_u32 v11, v21, 7, v32
  v_xor_b32 v1, 128, v2
  v_lshl_add_u32 v33, v24, 4, v22
  s_lshl_b32 s36, s13, 5
  v_add_u32 v33, s36, v33
  v_lshlrev_b32 v33, 3, v33
  v_mul_u32_u24 v34, 1152, v23
  v_add_u32 v5, v33, v34
  v_bfe_u32 v33, v20, 2, 2
  v_lshl_add_u32 v33, v23, 2, v33
  v_lshl_add_u32 v33, v24, 4, v33
  v_lshlrev_b32 v33, 3, v33
  v_and_b32 v34, 1, v20
  v_mul_u32_u24 v34, 1152, v34
  v_add_u32 v6, v33, v34
  s_lshl_b32 s36, s13, 3
  v_lshrrev_b32 v33, 3, v20
  v_add_u32 v33, s36, v33
  v_mul_u32_u24 v34, 0, v33
  v_add_u32 v34, s12, v34
  v_and_b32 v34, 31, v34
  v_lshrrev_b32 v37, 1, v32
  v_lshl_add_u32 v33, v33, 13, v37
  v_lshl_add_u32 v7, v34, 7, v33
  v_and_b32 v37, 1, v20
  v_bfe_u32 v38, v20, 1, 1
  v_lshl_add_u32 v37, v29, 1, v37
  s_lshr_b32 s36, s12, 3
  s_lshl_b32 s36, s36, 10
  s_and_b32 s37, s12, 1
  s_lshl_b32 s37, s37, 9
  s_add_u32 s36, s36, s37
  s_and_b32 s37, s12, 6
  s_lshl_b32 s37, s37, 5
  s_add_u32 s36, s36, s37
  v_lshlrev_b32 v33, 4, v21
  v_lshl_add_u32 v33, v37, 2, v33
  v_lshl_add_u32 v33, v38, 8, v33
  v_lshl_add_u32 v33, v30, 30, v33
  v_add_u32 v8, s36, v33
  v_mov_b32 v39, v21
  s_lshr_b32 s36, s12, 2
  s_lshl_b32 s36, s36, 6
  s_and_b32 s37, s12, 1
  s_lshl_b32 s37, s37, 5
  s_add_u32 s36, s36, s37
  s_and_b32 s37, s12, 2
  s_lshl_b32 s37, s37, 11
  s_add_u32 s36, s36, s37
  v_lshlrev_b32 v35, 10, v39
  v_lshl_add_u32 v35, v37, 2, v35
  v_lshl_add_u32 v35, v38, 4, v35
  v_add_u32 v35, s36, v35
  buffer_load_ushort v44, v35, s[76:79], 0 offen offset:0
  buffer_load_ushort v45, v35, s[76:79], 0 offen offset:2
  buffer_load_ushort v46, v35, s[76:79], 0 offen offset:512
  buffer_load_ushort v47, v35, s[76:79], 0 offen offset:514
  v_lshlrev_b32 v33, 4, v29
  v_mov_b32 v34, 0x3f80
  v_lshlrev_b32 v33, v33, v34
  v_and_b32 v34, 1, v20
  v_lshl_add_u32 v34, v34, 1, v30
  v_cmp_eq_u32 vcc, 0, v34
  s_nop 1
  v_cndmask_b32 v48, 0, v33, vcc
  v_cmp_eq_u32 vcc, 1, v34
  s_nop 1
  v_cndmask_b32 v49, 0, v33, vcc
  v_cmp_eq_u32 vcc, 2, v34
  s_nop 1
  v_cndmask_b32 v50, 0, v33, vcc
  v_cmp_eq_u32 vcc, 3, v34
  s_nop 1
  v_cndmask_b32 v51, 0, v33, vcc
  ds_write_b128 v2, v[48:51] offset:31232
  v_lshlrev_b32 v33, 9, v21
  s_lshl_b32 s36, s13, 11
  v_add_u32 v33, s36, v33
  v_lshl_add_u32 v10, v22, 4, v33
  v_lshl_add_u32 v33, v30, 8, v33
  v_add_u32 v9, v33, v32
  v_mov_b32 v12, 0x3f803f80
  v_mov_b32 v13, 0x3f803f80
  v_mov_b32 v14, 0x3f803f80
  v_mov_b32 v15, 0x3f803f80
  s_mov_b32 s2, 0x3f803f80
  s_mov_b32 s3, 0x3f803f80
  s_mov_b32 s98, 0
  v_and_b32 v33, 1, v20
  v_mul_u32_u24 v33, 128, v33
  v_min_u32 v34, 1, v20
  v_lshlrev_b32 v34, 30, v34
  s_cmp_eq_u32 s13, 3
  s_cselect_b64 vcc, -1, 0
  v_cndmask_b32 v19, v34, v33, vcc
  v_mov_b64 v[60:61], 0
  v_mov_b32 v62, 32256
  ds_write_b64 v62, v[60:61]
  s_mov_b32 s16, 0
  s_mov_b32 s17, -1
  s_mov_b32 s18, 0x3e0293ee
  s_mov_b32 s54, 0x2f800000
  s_mov_b32 s55, 0x28000000
  s_lshl_b32 s36, s13, 10
  s_add_u32 s31, s36, 8192
  s_add_u32 s32, s36, 12160
  s_add_u32 s33, s36, 16384
  s_add_u32 s34, s36, 20224
  s_lshl_b32 s36, s12, 19
  s_add_u32 s27, s36, 67108864
  s_add_u32 s28, s36, 83886080
  s_mul_i32 s36, s12, 4096
  s_add_u32 s29, s36, 135266304
  s_lshl_b32 s36, s12, 13
  s_add_u32 s22, s36, 144703488
  s_add_u32 s23, s36, 144707584
  s_mov_b32 s20, 144703488
  s_mov_b32 s21, 144707584
  v_mov_b32 v40, -1
  v_mov_b32 v41, -1
  v_mov_b32 v42, -1
  v_mov_b32 v43, -1
  s_lshl_b32 s36, s13, 13
  s_add_u32 s36, s36, 145752064
  s_add_u32 s37, s36, 4096
  buffer_store_dwordx4 v[40:43], v59, s[4:7], s22 offen sc1
  buffer_store_dwordx4 v[40:43], v59, s[4:7], s23 offen sc1
  buffer_store_dword v40, v8, s[4:7], s36 offen sc1
  buffer_store_dword v40, v8, s[4:7], s37 offen sc1
  v_mov_b32 v52, 0
  v_min_u32 v53, 1, v59
  v_lshlrev_b32 v53, 30, v53
  buffer_store_dword v52, v53, s[4:7], s15 offen sc1
  s_xor_b32 s36, s13, 1
  s_lshl_b32 s36, s36, 15
  s_add_u32 m0, s39, 8192
  s_add_u32 s37, s36, 0
  buffer_load_dwordx4 v26, s[48:51], s37 offen lds
  s_add_u32 m0, s39, 9216
  s_add_u32 s37, s36, 8192
  buffer_load_dwordx4 v26, s[48:51], s37 offen lds
  s_add_u32 m0, s39, 10240
  s_add_u32 s37, s36, 16384
  buffer_load_dwordx4 v26, s[48:51], s37 offen lds
  s_add_u32 m0, s39, 11264
  s_add_u32 s37, s36, 24576
  buffer_load_dwordx4 v26, s[48:51], s37 offen lds
  s_xor_b32 s36, s13, 1
  s_lshl_b32 s36, s36, 15
  s_add_u32 m0, s39, 12288
  s_add_u32 s37, s36, 512
  buffer_load_dwordx4 v26, s[48:51], s37 offen lds
  s_add_u32 m0, s39, 13312
  s_add_u32 s37, s36, 8704
  buffer_load_dwordx4 v26, s[48:51], s37 offen lds
  s_add_u32 m0, s39, 14336
  s_add_u32 s37, s36, 16896
  buffer_load_dwordx4 v26, s[48:51], s37 offen lds
  s_add_u32 m0, s39, 15360
  s_add_u32 s37, s36, 25088
  buffer_load_dwordx4 v26, s[48:51], s37 offen lds
  s_waitcnt vmcnt(21)
  ds_read_b64_tr_b16 a[160:161], v28 offset:0
  ds_read_b64_tr_b16 a[162:163], v28 offset:256
  ds_read_b64_tr_b16 a[164:165], v28 offset:1024
  ds_read_b64_tr_b16 a[166:167], v28 offset:1280
  ds_read_b64_tr_b16 a[168:169], v28 offset:8
  ds_read_b64_tr_b16 a[170:171], v28 offset:264
  ds_read_b64_tr_b16 a[172:173], v28 offset:1032
  ds_read_b64_tr_b16 a[174:175], v28 offset:1288
  s_waitcnt lgkmcnt(0)
  s_xor_b32 s36, s13, 2
  s_lshl_b32 s36, s36, 15
  s_add_u32 m0, s39, 0
  s_add_u32 s37, s36, 0
  buffer_load_dwordx4 v26, s[48:51], s37 offen lds
  s_add_u32 m0, s39, 1024
  s_add_u32 s37, s36, 8192
  buffer_load_dwordx4 v26, s[48:51], s37 offen lds
  s_add_u32 m0, s39, 2048
  s_add_u32 s37, s36, 16384
  buffer_load_dwordx4 v26, s[48:51], s37 offen lds
  s_add_u32 m0, s39, 3072
  s_add_u32 s37, s36, 24576
  buffer_load_dwordx4 v26, s[48:51], s37 offen lds
  s_waitcnt vmcnt(21)
  ds_read_b64_tr_b16 a[176:177], v28 offset:4096
  ds_read_b64_tr_b16 a[178:179], v28 offset:4352
  ds_read_b64_tr_b16 a[180:181], v28 offset:5120
  ds_read_b64_tr_b16 a[182:183], v28 offset:5376
  ds_read_b64_tr_b16 a[184:185], v28 offset:4104
  ds_read_b64_tr_b16 a[186:187], v28 offset:4360
  ds_read_b64_tr_b16 a[188:189], v28 offset:5128
  ds_read_b64_tr_b16 a[190:191], v28 offset:5384
  s_waitcnt lgkmcnt(0)
  s_xor_b32 s36, s13, 3
  s_lshl_b32 s36, s36, 15
  s_add_u32 m0, s39, 4096
  s_add_u32 s37, s36, 0
  buffer_load_dwordx4 v26, s[48:51], s37 offen lds
  s_add_u32 m0, s39, 5120
  s_add_u32 s37, s36, 8192
  buffer_load_dwordx4 v26, s[48:51], s37 offen lds
  s_add_u32 m0, s39, 6144
  s_add_u32 s37, s36, 16384
  buffer_load_dwordx4 v26, s[48:51], s37 offen lds
  s_add_u32 m0, s39, 7168
  s_add_u32 s37, s36, 24576
  buffer_load_dwordx4 v26, s[48:51], s37 offen lds
  s_waitcnt vmcnt(12)
  ds_read_b64_tr_b16 a[192:193], v28 offset:8192
  ds_read_b64_tr_b16 a[194:195], v28 offset:8448
  ds_read_b64_tr_b16 a[196:197], v28 offset:9216
  ds_read_b64_tr_b16 a[198:199], v28 offset:9472
  ds_read_b64_tr_b16 a[200:201], v28 offset:8200
  ds_read_b64_tr_b16 a[202:203], v28 offset:8456
  ds_read_b64_tr_b16 a[204:205], v28 offset:9224
  ds_read_b64_tr_b16 a[206:207], v28 offset:9480
  s_waitcnt lgkmcnt(0)
  s_xor_b32 s36, s13, 2
  s_lshl_b32 s36, s36, 19
  s_add_u32 m0, s39, 8192
  s_add_u32 s37, s36, 0
  buffer_load_dwordx4 v25, s[8:11], s37 offen lds
  s_add_u32 m0, s39, 9216
  s_add_u32 s37, s36, 131072
  buffer_load_dwordx4 v25, s[8:11], s37 offen lds
  s_add_u32 m0, s39, 10240
  s_add_u32 s37, s36, 262144
  buffer_load_dwordx4 v25, s[8:11], s37 offen lds
  s_add_u32 m0, s39, 11264
  s_add_u32 s37, s36, 393216
  buffer_load_dwordx4 v25, s[8:11], s37 offen lds
  s_barrier
  s_cmp_lg_u32 s13, 0
  s_cbranch_scc1 T_arm_81
  s_getreg_b32 s36, hwreg(HW_REG_XCC_ID, 0, 3)
  s_lshl_b32 s36, s36, 3
  s_lshl_b64 s[60:61], 1, s36
  s_mov_b32 s62, 1
  s_atomic_add_x2 s[60:61], s[52:53], 0
  s_atomic_add s62, s[52:53], 128
  v_lshl_or_b32 v44, v45, 16, v44
  v_lshl_or_b32 v46, v47, 16, v46
  v_min_u32 v44, -2, v44
  v_min_u32 v46, -2, v46
  s_mov_b32 s36, 145752064
  s_mov_b32 s37, 145756160
  buffer_store_dword v44, v8, s[4:7], s36 offen sc1
  buffer_store_dword v46, v8, s[4:7], s37 offen sc1
T_arm_81:
  s_waitcnt vmcnt(12)
  ds_read_b64_tr_b16 a[208:209], v28 offset:12288
  ds_read_b64_tr_b16 a[210:211], v28 offset:12544
  ds_read_b64_tr_b16 a[212:213], v28 offset:13312
  ds_read_b64_tr_b16 a[214:215], v28 offset:13568
  ds_read_b64_tr_b16 a[216:217], v28 offset:12296
  ds_read_b64_tr_b16 a[218:219], v28 offset:12552
  ds_read_b64_tr_b16 a[220:221], v28 offset:13320
  ds_read_b64_tr_b16 a[222:223], v28 offset:13576
  s_waitcnt lgkmcnt(0)
  s_xor_b32 s36, s13, 3
  s_lshl_b32 s36, s36, 19
  s_add_u32 m0, s39, 12288
  s_add_u32 s37, s36, 0
  buffer_load_dwordx4 v25, s[8:11], s37 offen lds
  s_add_u32 m0, s39, 13312
  s_add_u32 s37, s36, 131072
  buffer_load_dwordx4 v25, s[8:11], s37 offen lds
  s_add_u32 m0, s39, 14336
  s_add_u32 s37, s36, 262144
  buffer_load_dwordx4 v25, s[8:11], s37 offen lds
  s_add_u32 m0, s39, 15360
  s_add_u32 s37, s36, 393216
  buffer_load_dwordx4 v25, s[8:11], s37 offen lds
  s_waitcnt vmcnt(12)
  ds_read_b64_tr_b16 a[224:225], v28 offset:0
  ds_read_b64_tr_b16 a[226:227], v28 offset:256
  ds_read_b64_tr_b16 a[228:229], v28 offset:1024
  ds_read_b64_tr_b16 a[230:231], v28 offset:1280
  ds_read_b64_tr_b16 a[232:233], v28 offset:8
  ds_read_b64_tr_b16 a[234:235], v28 offset:264
  ds_read_b64_tr_b16 a[236:237], v28 offset:1032
  ds_read_b64_tr_b16 a[238:239], v28 offset:1288
  s_waitcnt lgkmcnt(0)
  s_xor_b32 s36, s13, 4
  s_lshl_b32 s36, s36, 19
  s_add_u32 m0, s39, 0
  s_add_u32 s37, s36, 0
  buffer_load_dwordx4 v25, s[8:11], s37 offen lds
  s_add_u32 m0, s39, 1024
  s_add_u32 s37, s36, 131072
  buffer_load_dwordx4 v25, s[8:11], s37 offen lds
  s_add_u32 m0, s39, 2048
  s_add_u32 s37, s36, 262144
  buffer_load_dwordx4 v25, s[8:11], s37 offen lds
  s_add_u32 m0, s39, 3072
  s_add_u32 s37, s36, 393216
  buffer_load_dwordx4 v25, s[8:11], s37 offen lds
  s_waitcnt vmcnt(12)
  ds_read_b64_tr_b16 a[240:241], v28 offset:4096
  ds_read_b64_tr_b16 a[242:243], v28 offset:4352
  ds_read_b64_tr_b16 a[244:245], v28 offset:5120
  ds_read_b64_tr_b16 a[246:247], v28 offset:5376
  ds_read_b64_tr_b16 a[248:249], v28 offset:4104
  ds_read_b64_tr_b16 a[250:251], v28 offset:4360
  ds_read_b64_tr_b16 a[252:253], v28 offset:5128
  ds_read_b64_tr_b16 a[254:255], v28 offset:5384
  s_waitcnt lgkmcnt(0)
  s_xor_b32 s36, s13, 5
  s_lshl_b32 s36, s36, 19
  s_add_u32 m0, s39, 4096
  s_add_u32 s37, s36, 0
  buffer_load_dwordx4 v25, s[8:11], s37 offen lds
  s_add_u32 m0, s39, 5120
  s_add_u32 s37, s36, 131072
  buffer_load_dwordx4 v25, s[8:11], s37 offen lds
  s_add_u32 m0, s39, 6144
  s_add_u32 s37, s36, 262144
  buffer_load_dwordx4 v25, s[8:11], s37 offen lds
  s_add_u32 m0, s39, 7168
  s_add_u32 s37, s36, 393216
  buffer_load_dwordx4 v25, s[8:11], s37 offen lds
  s_waitcnt vmcnt(12)
  ds_read_b64_tr_b16 v[160:161], v27 offset:8192
  ds_read_b64_tr_b16 v[162:163], v27 offset:8320
  ds_read_b64_tr_b16 v[164:165], v27 offset:9216
  ds_read_b64_tr_b16 v[166:167], v27 offset:9344
  ds_read_b64_tr_b16 v[168:169], v36 offset:8192
  ds_read_b64_tr_b16 v[170:171], v36 offset:8320
  ds_read_b64_tr_b16 v[172:173], v36 offset:9216
  ds_read_b64_tr_b16 v[174:175], v36 offset:9344
  s_waitcnt lgkmcnt(0)
  s_xor_b32 s36, s13, 4
  s_lshl_b32 s36, s36, 19
  s_add_u32 m0, s39, 8192
  s_add_u32 s37, s36, 0
  buffer_load_dwordx4 v25, s[40:43], s37 offen lds
  s_add_u32 m0, s39, 9216
  s_add_u32 s37, s36, 131072
  buffer_load_dwordx4 v25, s[40:43], s37 offen lds
  s_add_u32 m0, s39, 10240
  s_add_u32 s37, s36, 262144
  buffer_load_dwordx4 v25, s[40:43], s37 offen lds
  s_add_u32 m0, s39, 11264
  s_add_u32 s37, s36, 393216
  buffer_load_dwordx4 v25, s[40:43], s37 offen lds
  s_waitcnt vmcnt(12)
  ds_read_b64_tr_b16 v[192:193], v27 offset:12288
  ds_read_b64_tr_b16 v[194:195], v27 offset:12416
  ds_read_b64_tr_b16 v[196:197], v27 offset:13312
  ds_read_b64_tr_b16 v[198:199], v27 offset:13440
  ds_read_b64_tr_b16 v[200:201], v36 offset:12288
  ds_read_b64_tr_b16 v[202:203], v36 offset:12416
  ds_read_b64_tr_b16 v[204:205], v36 offset:13312
  ds_read_b64_tr_b16 v[206:207], v36 offset:13440
  s_waitcnt lgkmcnt(0)
  s_xor_b32 s36, s13, 5
  s_lshl_b32 s36, s36, 19
  s_add_u32 m0, s39, 12288
  s_add_u32 s37, s36, 0
  buffer_load_dwordx4 v25, s[40:43], s37 offen lds
  s_add_u32 m0, s39, 13312
  s_add_u32 s37, s36, 131072
  buffer_load_dwordx4 v25, s[40:43], s37 offen lds
  s_add_u32 m0, s39, 14336
  s_add_u32 s37, s36, 262144
  buffer_load_dwordx4 v25, s[40:43], s37 offen lds
  s_add_u32 m0, s39, 15360
  s_add_u32 s37, s36, 393216
  buffer_load_dwordx4 v25, s[40:43], s37 offen lds
  s_waitcnt vmcnt(12)
  ds_read_b64_tr_b16 v[224:225], v27 offset:0
  ds_read_b64_tr_b16 v[226:227], v27 offset:128
  ds_read_b64_tr_b16 v[228:229], v27 offset:1024
  ds_read_b64_tr_b16 v[230:231], v27 offset:1152
  ds_read_b64_tr_b16 v[232:233], v36 offset:0
  ds_read_b64_tr_b16 v[234:235], v36 offset:128
  ds_read_b64_tr_b16 v[236:237], v36 offset:1024
  ds_read_b64_tr_b16 v[238:239], v36 offset:1152
  s_waitcnt lgkmcnt(0)
  s_xor_b32 s36, s13, 4
  s_lshl_b32 s36, s36, 19
  s_add_u32 m0, s39, 0
  s_add_u32 s37, s36, 0
  buffer_load_dwordx4 v25, s[44:47], s37 offen lds
  s_add_u32 m0, s39, 1024
  s_add_u32 s37, s36, 131072
  buffer_load_dwordx4 v25, s[44:47], s37 offen lds
  s_add_u32 m0, s39, 2048
  s_add_u32 s37, s36, 262144
  buffer_load_dwordx4 v25, s[44:47], s37 offen lds
  s_add_u32 m0, s39, 3072
  s_add_u32 s37, s36, 393216
  buffer_load_dwordx4 v25, s[44:47], s37 offen lds
  s_waitcnt vmcnt(12)
  ds_read_b64_tr_b16 a[16:17], v27 offset:4096
  ds_read_b64_tr_b16 a[18:19], v27 offset:4224
  ds_read_b64_tr_b16 a[20:21], v27 offset:5120
  ds_read_b64_tr_b16 a[22:23], v27 offset:5248
  ds_read_b64_tr_b16 a[24:25], v36 offset:4096
  ds_read_b64_tr_b16 a[26:27], v36 offset:4224
  ds_read_b64_tr_b16 a[28:29], v36 offset:5120
  ds_read_b64_tr_b16 a[30:31], v36 offset:5248
  s_waitcnt lgkmcnt(0)
  s_xor_b32 s36, s13, 5
  s_lshl_b32 s36, s36, 19
  s_add_u32 m0, s39, 4096
  s_add_u32 s37, s36, 0
  buffer_load_dwordx4 v25, s[44:47], s37 offen lds
  s_add_u32 m0, s39, 5120
  s_add_u32 s37, s36, 131072
  buffer_load_dwordx4 v25, s[44:47], s37 offen lds
  s_add_u32 m0, s39, 6144
  s_add_u32 s37, s36, 262144
  buffer_load_dwordx4 v25, s[44:47], s37 offen lds
  s_add_u32 m0, s39, 7168
  s_add_u32 s37, s36, 393216
  buffer_load_dwordx4 v25, s[44:47], s37 offen lds
  s_waitcnt vmcnt(12)
  ds_read_b64_tr_b16 v[240:241], v27 offset:8192
  ds_read_b64_tr_b16 v[242:243], v27 offset:8320
  ds_read_b64_tr_b16 v[244:245], v27 offset:9216
  ds_read_b64_tr_b16 v[246:247], v27 offset:9344
  ds_read_b64_tr_b16 v[248:249], v36 offset:8192
  ds_read_b64_tr_b16 v[250:251], v36 offset:8320
  ds_read_b64_tr_b16 v[252:253], v36 offset:9216
  ds_read_b64_tr_b16 v[254:255], v36 offset:9344
  s_waitcnt lgkmcnt(0)
  s_xor_b32 s36, s13, 6
  s_lshl_b32 s36, s36, 19
  s_add_u32 m0, s39, 8192
  s_add_u32 s37, s36, 0
  buffer_load_dwordx4 v25, s[8:11], s37 offen lds
  s_add_u32 m0, s39, 9216
  s_add_u32 s37, s36, 131072
  buffer_load_dwordx4 v25, s[8:11], s37 offen lds
  s_add_u32 m0, s39, 10240
  s_add_u32 s37, s36, 262144
  buffer_load_dwordx4 v25, s[8:11], s37 offen lds
  s_add_u32 m0, s39, 11264
  s_add_u32 s37, s36, 393216
  buffer_load_dwordx4 v25, s[8:11], s37 offen lds
  s_waitcnt vmcnt(12)
  ds_read_b64_tr_b16 a[32:33], v27 offset:12288
  ds_read_b64_tr_b16 a[34:35], v27 offset:12416
  ds_read_b64_tr_b16 a[36:37], v27 offset:13312
  ds_read_b64_tr_b16 a[38:39], v27 offset:13440
  ds_read_b64_tr_b16 a[40:41], v36 offset:12288
  ds_read_b64_tr_b16 a[42:43], v36 offset:12416
  ds_read_b64_tr_b16 a[44:45], v36 offset:13312
  ds_read_b64_tr_b16 a[46:47], v36 offset:13440
  s_waitcnt lgkmcnt(0)
  s_xor_b32 s36, s13, 7
  s_lshl_b32 s36, s36, 19
  s_add_u32 m0, s39, 12288
  s_add_u32 s37, s36, 0
  buffer_load_dwordx4 v25, s[8:11], s37 offen lds
  s_add_u32 m0, s39, 13312
  s_add_u32 s37, s36, 131072
  buffer_load_dwordx4 v25, s[8:11], s37 offen lds
  s_add_u32 m0, s39, 14336
  s_add_u32 s37, s36, 262144
  buffer_load_dwordx4 v25, s[8:11], s37 offen lds
  s_add_u32 m0, s39, 15360
  s_add_u32 s37, s36, 393216
  buffer_load_dwordx4 v25, s[8:11], s37 offen lds
  s_waitcnt vmcnt(12)
  ds_read_b64_tr_b16 a[0:1], v27 offset:0
  ds_read_b64_tr_b16 a[2:3], v27 offset:128
  ds_read_b64_tr_b16 a[4:5], v27 offset:1024
  ds_read_b64_tr_b16 a[6:7], v27 offset:1152
  ds_read_b64_tr_b16 a[8:9], v36 offset:0
  ds_read_b64_tr_b16 a[10:11], v36 offset:128
  ds_read_b64_tr_b16 a[12:13], v36 offset:1024
  ds_read_b64_tr_b16 a[14:15], v36 offset:1152
  s_waitcnt lgkmcnt(0)
  s_xor_b32 s36, s13, 6
  s_lshl_b32 s36, s36, 19
  s_add_u32 m0, s39, 0
  s_add_u32 s37, s36, 0
  buffer_load_dwordx4 v25, s[40:43], s37 offen lds
  s_add_u32 m0, s39, 1024
  s_add_u32 s37, s36, 131072
  buffer_load_dwordx4 v25, s[40:43], s37 offen lds
  s_add_u32 m0, s39, 2048
  s_add_u32 s37, s36, 262144
  buffer_load_dwordx4 v25, s[40:43], s37 offen lds
  s_add_u32 m0, s39, 3072
  s_add_u32 s37, s36, 393216
  buffer_load_dwordx4 v25, s[40:43], s37 offen lds
  s_waitcnt vmcnt(12)
  ds_read_b64_tr_b16 a[48:49], v27 offset:4096
  ds_read_b64_tr_b16 a[50:51], v27 offset:4224
  ds_read_b64_tr_b16 a[52:53], v27 offset:5120
  ds_read_b64_tr_b16 a[54:55], v27 offset:5248
  ds_read_b64_tr_b16 a[56:57], v36 offset:4096
  ds_read_b64_tr_b16 a[58:59], v36 offset:4224
  ds_read_b64_tr_b16 a[60:61], v36 offset:5120
  ds_read_b64_tr_b16 a[62:63], v36 offset:5248
  s_waitcnt lgkmcnt(0)
  s_xor_b32 s36, s13, 7
  s_lshl_b32 s36, s36, 19
  s_add_u32 m0, s39, 4096
  s_add_u32 s37, s36, 0
  buffer_load_dwordx4 v25, s[40:43], s37 offen lds
  s_add_u32 m0, s39, 5120
  s_add_u32 s37, s36, 131072
  buffer_load_dwordx4 v25, s[40:43], s37 offen lds
  s_add_u32 m0, s39, 6144
  s_add_u32 s37, s36, 262144
  buffer_load_dwordx4 v25, s[40:43], s37 offen lds
  s_add_u32 m0, s39, 7168
  s_add_u32 s37, s36, 393216
  buffer_load_dwordx4 v25, s[40:43], s37 offen lds
  s_waitcnt vmcnt(12)
  ds_read_b64_tr_b16 a[64:65], v27 offset:8192
  ds_read_b64_tr_b16 a[66:67], v27 offset:8320
  ds_read_b64_tr_b16 a[68:69], v27 offset:9216
  ds_read_b64_tr_b16 a[70:71], v27 offset:9344
  ds_read_b64_tr_b16 a[72:73], v36 offset:8192
  ds_read_b64_tr_b16 a[74:75], v36 offset:8320
  ds_read_b64_tr_b16 a[76:77], v36 offset:9216
  ds_read_b64_tr_b16 a[78:79], v36 offset:9344
  s_waitcnt lgkmcnt(0)
  s_xor_b32 s36, s13, 6
  s_lshl_b32 s36, s36, 19
  s_add_u32 m0, s39, 8192
  s_add_u32 s37, s36, 0
  buffer_load_dwordx4 v25, s[44:47], s37 offen lds
  s_add_u32 m0, s39, 9216
  s_add_u32 s37, s36, 131072
  buffer_load_dwordx4 v25, s[44:47], s37 offen lds
  s_add_u32 m0, s39, 10240
  s_add_u32 s37, s36, 262144
  buffer_load_dwordx4 v25, s[44:47], s37 offen lds
  s_add_u32 m0, s39, 11264
  s_add_u32 s37, s36, 393216
  buffer_load_dwordx4 v25, s[44:47], s37 offen lds
  s_waitcnt vmcnt(12)
  ds_read_b64_tr_b16 a[112:113], v27 offset:12288
  ds_read_b64_tr_b16 a[114:115], v27 offset:12416
  ds_read_b64_tr_b16 a[116:117], v27 offset:13312
  ds_read_b64_tr_b16 a[118:119], v27 offset:13440
  ds_read_b64_tr_b16 a[120:121], v36 offset:12288
  ds_read_b64_tr_b16 a[122:123], v36 offset:12416
  ds_read_b64_tr_b16 a[124:125], v36 offset:13312
  ds_read_b64_tr_b16 a[126:127], v36 offset:13440
  s_waitcnt lgkmcnt(0)
  s_xor_b32 s36, s13, 7
  s_lshl_b32 s36, s36, 19
  s_add_u32 m0, s39, 12288
  s_add_u32 s37, s36, 0
  buffer_load_dwordx4 v25, s[44:47], s37 offen lds
  s_add_u32 m0, s39, 13312
  s_add_u32 s37, s36, 131072
  buffer_load_dwordx4 v25, s[44:47], s37 offen lds
  s_add_u32 m0, s39, 14336
  s_add_u32 s37, s36, 262144
  buffer_load_dwordx4 v25, s[44:47], s37 offen lds
  s_add_u32 m0, s39, 15360
  s_add_u32 s37, s36, 393216
  buffer_load_dwordx4 v25, s[44:47], s37 offen lds
  s_waitcnt vmcnt(12)
  ds_read_b64_tr_b16 a[80:81], v27 offset:0
  ds_read_b64_tr_b16 a[82:83], v27 offset:128
  ds_read_b64_tr_b16 a[84:85], v27 offset:1024
  ds_read_b64_tr_b16 a[86:87], v27 offset:1152
  ds_read_b64_tr_b16 a[88:89], v36 offset:0
  ds_read_b64_tr_b16 a[90:91], v36 offset:128
  ds_read_b64_tr_b16 a[92:93], v36 offset:1024
  ds_read_b64_tr_b16 a[94:95], v36 offset:1152
  s_waitcnt lgkmcnt(0)
  s_xor_b32 s36, s13, 1
  s_lshl_b32 s36, s36, 19
  s_add_u32 m0, s39, 16384
  s_add_u32 s37, s36, 0
  buffer_load_dwordx4 v25, s[8:11], s37 offen lds
  s_add_u32 m0, s39, 17408
  s_add_u32 s37, s36, 131072
  buffer_load_dwordx4 v25, s[8:11], s37 offen lds
  s_add_u32 m0, s39, 18432
  s_add_u32 s37, s36, 262144
  buffer_load_dwordx4 v25, s[8:11], s37 offen lds
  s_add_u32 m0, s39, 19456
  s_add_u32 s37, s36, 393216
  buffer_load_dwordx4 v25, s[8:11], s37 offen lds
  s_waitcnt vmcnt(12)
  ds_read_b64_tr_b16 a[128:129], v27 offset:4096
  ds_read_b64_tr_b16 a[130:131], v27 offset:4224
  ds_read_b64_tr_b16 a[132:133], v27 offset:5120
  ds_read_b64_tr_b16 a[134:135], v27 offset:5248
  ds_read_b64_tr_b16 a[136:137], v36 offset:4096
  ds_read_b64_tr_b16 a[138:139], v36 offset:4224
  ds_read_b64_tr_b16 a[140:141], v36 offset:5120
  ds_read_b64_tr_b16 a[142:143], v36 offset:5248
  s_waitcnt lgkmcnt(0)
  s_xor_b32 s36, s13, 0
  s_lshl_b32 s36, s36, 19
  s_add_u32 m0, s39, 0
  s_add_u32 s37, s36, 0
  buffer_load_dwordx4 v25, s[8:11], s37 offen lds
  s_add_u32 m0, s39, 1024
  s_add_u32 s37, s36, 131072
  buffer_load_dwordx4 v25, s[8:11], s37 offen lds
  s_add_u32 m0, s39, 2048
  s_add_u32 s37, s36, 262144
  buffer_load_dwordx4 v25, s[8:11], s37 offen lds
  s_add_u32 m0, s39, 3072
  s_add_u32 s37, s36, 393216
  buffer_load_dwordx4 v25, s[8:11], s37 offen lds
  s_waitcnt vmcnt(12)
  ds_read_b64_tr_b16 a[96:97], v27 offset:8192
  ds_read_b64_tr_b16 a[98:99], v27 offset:8320
  ds_read_b64_tr_b16 a[100:101], v27 offset:9216
  ds_read_b64_tr_b16 a[102:103], v27 offset:9344
  ds_read_b64_tr_b16 a[104:105], v36 offset:8192
  ds_read_b64_tr_b16 a[106:107], v36 offset:8320
  ds_read_b64_tr_b16 a[108:109], v36 offset:9216
  ds_read_b64_tr_b16 a[110:111], v36 offset:9344
  s_waitcnt lgkmcnt(0)
  s_xor_b32 s36, s13, 1
  s_lshl_b32 s36, s36, 19
  s_add_u32 m0, s39, 8192
  s_add_u32 s37, s36, 0
  buffer_load_dwordx4 v25, s[40:43], s37 offen lds
  s_add_u32 m0, s39, 9216
  s_add_u32 s37, s36, 131072
  buffer_load_dwordx4 v25, s[40:43], s37 offen lds
  s_add_u32 m0, s39, 10240
  s_add_u32 s37, s36, 262144
  buffer_load_dwordx4 v25, s[40:43], s37 offen lds
  s_add_u32 m0, s39, 11264
  s_add_u32 s37, s36, 393216
  buffer_load_dwordx4 v25, s[40:43], s37 offen lds
  s_waitcnt vmcnt(12)
  ds_read_b64_tr_b16 a[144:145], v27 offset:12288
  ds_read_b64_tr_b16 a[146:147], v27 offset:12416
  ds_read_b64_tr_b16 a[148:149], v27 offset:13312
  ds_read_b64_tr_b16 a[150:151], v27 offset:13440
  ds_read_b64_tr_b16 a[152:153], v36 offset:12288
  ds_read_b64_tr_b16 a[154:155], v36 offset:12416
  ds_read_b64_tr_b16 a[156:157], v36 offset:13312
  ds_read_b64_tr_b16 a[158:159], v36 offset:13440
  s_waitcnt lgkmcnt(0)
  s_xor_b32 s36, s13, 0
  s_lshl_b32 s36, s36, 19
  s_add_u32 m0, s39, 4096
  s_add_u32 s37, s36, 0
  buffer_load_dwordx4 v25, s[40:43], s37 offen lds
  s_add_u32 m0, s39, 5120
  s_add_u32 s37, s36, 131072
  buffer_load_dwordx4 v25, s[40:43], s37 offen lds
  s_add_u32 m0, s39, 6144
  s_add_u32 s37, s36, 262144
  buffer_load_dwordx4 v25, s[40:43], s37 offen lds
  s_add_u32 m0, s39, 7168
  s_add_u32 s37, s36, 393216
  buffer_load_dwordx4 v25, s[40:43], s37 offen lds
  s_waitcnt vmcnt(12)
  ds_read_b64_tr_b16 v[128:129], v27 offset:16384
  ds_read_b64_tr_b16 v[130:131], v27 offset:16512
  ds_read_b64_tr_b16 v[132:133], v27 offset:17408
  ds_read_b64_tr_b16 v[134:135], v27 offset:17536
  ds_read_b64_tr_b16 v[136:137], v36 offset:16384
  ds_read_b64_tr_b16 v[138:139], v36 offset:16512
  ds_read_b64_tr_b16 v[140:141], v36 offset:17408
  ds_read_b64_tr_b16 v[142:143], v36 offset:17536
  s_waitcnt lgkmcnt(0)
  s_xor_b32 s36, s13, 2
  s_lshl_b32 s36, s36, 19
  s_add_u32 m0, s39, 12288
  s_add_u32 s37, s36, 0
  buffer_load_dwordx4 v25, s[40:43], s37 offen lds
  s_add_u32 m0, s39, 13312
  s_add_u32 s37, s36, 131072
  buffer_load_dwordx4 v25, s[40:43], s37 offen lds
  s_add_u32 m0, s39, 14336
  s_add_u32 s37, s36, 262144
  buffer_load_dwordx4 v25, s[40:43], s37 offen lds
  s_add_u32 m0, s39, 15360
  s_add_u32 s37, s36, 393216
  buffer_load_dwordx4 v25, s[40:43], s37 offen lds
  s_waitcnt vmcnt(12)
  ds_read_b64_tr_b16 v[64:65], v27 offset:0
  ds_read_b64_tr_b16 v[66:67], v27 offset:128
  ds_read_b64_tr_b16 v[68:69], v27 offset:1024
  ds_read_b64_tr_b16 v[70:71], v27 offset:1152
  ds_read_b64_tr_b16 v[72:73], v36 offset:0
  ds_read_b64_tr_b16 v[74:75], v36 offset:128
  ds_read_b64_tr_b16 v[76:77], v36 offset:1024
  ds_read_b64_tr_b16 v[78:79], v36 offset:1152
  s_waitcnt lgkmcnt(0)
  ds_write_b128 v4, v[64:67] offset:0
  ds_write_b128 v4, v[68:71] offset:1024
  ds_write_b128 v4, v[72:75] offset:2048
  ds_write_b128 v4, v[76:79] offset:3072
  s_waitcnt lgkmcnt(0)
  s_xor_b32 s36, s13, 3
  s_lshl_b32 s36, s36, 19
  s_add_u32 m0, s39, 16384
  s_add_u32 s37, s36, 0
  buffer_load_dwordx4 v25, s[40:43], s37 offen lds
  s_add_u32 m0, s39, 17408
  s_add_u32 s37, s36, 131072
  buffer_load_dwordx4 v25, s[40:43], s37 offen lds
  s_add_u32 m0, s39, 18432
  s_add_u32 s37, s36, 262144
  buffer_load_dwordx4 v25, s[40:43], s37 offen lds
  s_add_u32 m0, s39, 19456
  s_add_u32 s37, s36, 393216
  buffer_load_dwordx4 v25, s[40:43], s37 offen lds
  s_waitcnt vmcnt(12)
  ds_read_b64_tr_b16 v[144:145], v27 offset:8192
  ds_read_b64_tr_b16 v[146:147], v27 offset:8320
  ds_read_b64_tr_b16 v[148:149], v27 offset:9216
  ds_read_b64_tr_b16 v[150:151], v27 offset:9344
  ds_read_b64_tr_b16 v[152:153], v36 offset:8192
  ds_read_b64_tr_b16 v[154:155], v36 offset:8320
  ds_read_b64_tr_b16 v[156:157], v36 offset:9216
  ds_read_b64_tr_b16 v[158:159], v36 offset:9344
  s_waitcnt lgkmcnt(0)
  s_xor_b32 s36, s13, 3
  s_lshl_b32 s36, s36, 19
  s_add_u32 m0, s39, 24576
  s_add_u32 s37, s36, 0
  buffer_load_dwordx4 v25, s[44:47], s37 offen lds
  s_add_u32 m0, s39, 25600
  s_add_u32 s37, s36, 131072
  buffer_load_dwordx4 v25, s[44:47], s37 offen lds
  s_add_u32 m0, s39, 26624
  s_add_u32 s37, s36, 262144
  buffer_load_dwordx4 v25, s[44:47], s37 offen lds
  s_add_u32 m0, s39, 27648
  s_add_u32 s37, s36, 393216
  buffer_load_dwordx4 v25, s[44:47], s37 offen lds
  buffer_load_dwordx2 v[54:55], off, s[72:75], 0 sc1
  buffer_load_dword v56, off, s[72:75], 0 offset:128 sc1
  s_waitcnt vmcnt(14)
  ds_read_b64_tr_b16 v[64:65], v27 offset:4096
  ds_read_b64_tr_b16 v[66:67], v27 offset:4224
  ds_read_b64_tr_b16 v[68:69], v27 offset:5120
  ds_read_b64_tr_b16 v[70:71], v27 offset:5248
  ds_read_b64_tr_b16 v[72:73], v36 offset:4096
  ds_read_b64_tr_b16 v[74:75], v36 offset:4224
  ds_read_b64_tr_b16 v[76:77], v36 offset:5120
  ds_read_b64_tr_b16 v[78:79], v36 offset:5248
  s_waitcnt lgkmcnt(0)
  ds_write_b128 v4, v[64:67] offset:4096
  ds_write_b128 v4, v[68:71] offset:5120
  ds_write_b128 v4, v[72:75] offset:6144
  ds_write_b128 v4, v[76:79] offset:7168
  s_waitcnt lgkmcnt(0)
  s_xor_b32 s36, s13, 2
  s_lshl_b32 s36, s36, 19
  s_add_u32 m0, s39, 20480
  s_add_u32 s37, s36, 0
  buffer_load_dwordx4 v25, s[44:47], s37 offen lds
  s_add_u32 m0, s39, 21504
  s_add_u32 s37, s36, 131072
  buffer_load_dwordx4 v25, s[44:47], s37 offen lds
  s_add_u32 m0, s39, 22528
  s_add_u32 s37, s36, 262144
  buffer_load_dwordx4 v25, s[44:47], s37 offen lds
  s_add_u32 m0, s39, 23552
  s_add_u32 s37, s36, 393216
  buffer_load_dwordx4 v25, s[44:47], s37 offen lds
  s_waitcnt vmcnt(14)
  ds_read_b64_tr_b16 v[176:177], v27 offset:12288
  ds_read_b64_tr_b16 v[178:179], v27 offset:12416
  ds_read_b64_tr_b16 v[180:181], v27 offset:13312
  ds_read_b64_tr_b16 v[182:183], v27 offset:13440
  ds_read_b64_tr_b16 v[184:185], v36 offset:12288
  ds_read_b64_tr_b16 v[186:187], v36 offset:12416
  ds_read_b64_tr_b16 v[188:189], v36 offset:13312
  ds_read_b64_tr_b16 v[190:191], v36 offset:13440
  s_waitcnt lgkmcnt(0)
  s_xor_b32 s36, s13, 0
  s_lshl_b32 s36, s36, 19
  s_add_u32 m0, s39, 8192
  s_add_u32 s37, s36, 0
  buffer_load_dwordx4 v25, s[44:47], s37 offen lds
  s_add_u32 m0, s39, 9216
  s_add_u32 s37, s36, 131072
  buffer_load_dwordx4 v25, s[44:47], s37 offen lds
  s_add_u32 m0, s39, 10240
  s_add_u32 s37, s36, 262144
  buffer_load_dwordx4 v25, s[44:47], s37 offen lds
  s_add_u32 m0, s39, 11264
  s_add_u32 s37, s36, 393216
  buffer_load_dwordx4 v25, s[44:47], s37 offen lds
  s_waitcnt vmcnt(14)
  ds_read_b64_tr_b16 v[64:65], v27 offset:16384
  ds_read_b64_tr_b16 v[66:67], v27 offset:16512
  ds_read_b64_tr_b16 v[68:69], v27 offset:17408
  ds_read_b64_tr_b16 v[70:71], v27 offset:17536
  ds_read_b64_tr_b16 v[72:73], v36 offset:16384
  ds_read_b64_tr_b16 v[74:75], v36 offset:16512
  ds_read_b64_tr_b16 v[76:77], v36 offset:17408
  ds_read_b64_tr_b16 v[78:79], v36 offset:17536
  s_waitcnt lgkmcnt(0)
  ds_write_b128 v4, v[64:67] offset:16384
  ds_write_b128 v4, v[68:71] offset:17408
  ds_write_b128 v4, v[72:75] offset:18432
  ds_write_b128 v4, v[76:79] offset:19456
  s_waitcnt lgkmcnt(0)
  s_xor_b32 s36, s13, 1
  s_lshl_b32 s36, s36, 19
  s_add_u32 m0, s39, 12288
  s_add_u32 s37, s36, 0
  buffer_load_dwordx4 v25, s[44:47], s37 offen lds
  s_add_u32 m0, s39, 13312
  s_add_u32 s37, s36, 131072
  buffer_load_dwordx4 v25, s[44:47], s37 offen lds
  s_add_u32 m0, s39, 14336
  s_add_u32 s37, s36, 262144
  buffer_load_dwordx4 v25, s[44:47], s37 offen lds
  s_add_u32 m0, s39, 15360
  s_add_u32 s37, s36, 393216
  buffer_load_dwordx4 v25, s[44:47], s37 offen lds
  s_waitcnt vmcnt(14)
  ds_read_b64_tr_b16 v[208:209], v27 offset:24576
  ds_read_b64_tr_b16 v[210:211], v27 offset:24704
  ds_read_b64_tr_b16 v[212:213], v27 offset:25600
  ds_read_b64_tr_b16 v[214:215], v27 offset:25728
  ds_read_b64_tr_b16 v[216:217], v36 offset:24576
  ds_read_b64_tr_b16 v[218:219], v36 offset:24704
  ds_read_b64_tr_b16 v[220:221], v36 offset:25600
  ds_read_b64_tr_b16 v[222:223], v36 offset:25728
  s_waitcnt lgkmcnt(0)
  s_xor_b32 s36, s13, 2
  s_lshl_b32 s36, s36, 15
  s_add_u32 m0, s39, 24576
  s_add_u32 s37, s36, 512
  buffer_load_dwordx4 v26, s[48:51], s37 offen lds
  s_add_u32 m0, s39, 25600
  s_add_u32 s37, s36, 8704
  buffer_load_dwordx4 v26, s[48:51], s37 offen lds
  s_add_u32 m0, s39, 26624
  s_add_u32 s37, s36, 16896
  buffer_load_dwordx4 v26, s[48:51], s37 offen lds
  s_add_u32 m0, s39, 27648
  s_add_u32 s37, s36, 25088
  buffer_load_dwordx4 v26, s[48:51], s37 offen lds
  s_waitcnt vmcnt(12)
  ds_read_b64_tr_b16 v[64:65], v27 offset:20480
  ds_read_b64_tr_b16 v[66:67], v27 offset:20608
  ds_read_b64_tr_b16 v[68:69], v27 offset:21504
  ds_read_b64_tr_b16 v[70:71], v27 offset:21632
  ds_read_b64_tr_b16 v[72:73], v36 offset:20480
  ds_read_b64_tr_b16 v[74:75], v36 offset:20608
  ds_read_b64_tr_b16 v[76:77], v36 offset:21504
  ds_read_b64_tr_b16 v[78:79], v36 offset:21632
  s_waitcnt lgkmcnt(0)
  ds_write_b128 v4, v[64:67] offset:20480
  ds_write_b128 v4, v[68:71] offset:21504
  ds_write_b128 v4, v[72:75] offset:22528
  ds_write_b128 v4, v[76:79] offset:23552
  s_waitcnt lgkmcnt(0)
  s_xor_b32 s36, s13, 3
  s_lshl_b32 s36, s36, 15
  s_add_u32 m0, s39, 28672
  s_add_u32 s37, s36, 512
  buffer_load_dwordx4 v26, s[48:51], s37 offen lds
  s_add_u32 m0, s39, 29696
  s_add_u32 s37, s36, 8704
  buffer_load_dwordx4 v26, s[48:51], s37 offen lds
  s_add_u32 m0, s39, 30720
  s_add_u32 s37, s36, 16896
  buffer_load_dwordx4 v26, s[48:51], s37 offen lds
  s_add_u32 m0, s39, 31744
  s_add_u32 s37, s36, 25088
  buffer_load_dwordx4 v26, s[48:51], s37 offen lds
  s_mov_b32 s19, 0
  s_branch T_arrgo_83
T_arr_82:
  s_add_u32 s19, s19, 1
  s_cmp_gt_u32 s19, 32768
  s_cbranch_scc1 M_exit
  buffer_load_dwordx2 v[54:55], off, s[72:75], 0 sc1
  buffer_load_dword v56, off, s[72:75], 0 offset:128 sc1
  s_waitcnt vmcnt(0)
T_arrgo_83:
  v_sad_u8 v57, v54, 0, 0
  v_sad_u8 v57, v55, 0, v57
  v_or_b32 v58, v54, v55
  v_cmp_gt_u32 vcc, 32, v57
  s_cbranch_vccnz T_arr_82
  v_cmp_gt_u32 vcc, 0x100, v56
  s_cbranch_vccnz T_arr_82
  v_readfirstlane_b32 s36, v58
  s_nop 0
  s_and_b32 s36, s36, 0x20202020
  s_cselect_b32 s56, 0, 1
  s_mov_b32 s14, -1
  s_mov_b32 s30, -1
  s_mov_b32 s19, 0
  s_branch T_kvok_85
T_kv_84:
  s_sleep 4
  s_add_u32 s19, s19, 1
  s_cmp_gt_u32 s19, 32768
  s_cbranch_scc1 M_exit
T_kvok_85:
  s_add_u32 s39, s99, 128
  s_mov_b32 s38, 0
  s_mov_b32 s37, 0
  s_atomic_or s38, s[58:59], s99 glc
  s_atomic_or s37, s[58:59], s39 glc
  s_waitcnt lgkmcnt(0)
  s_add_u32 s37, s37, 30
  s_cmp_ge_u32 s38, 30
  s_cselect_b32 s38, s37, s38
  s_cmp_ge_u32 s38, 64
  s_cselect_b32 s38, 100, s38
  s_sub_u32 s38, s38, 1
  s_max_i32 s30, s30, s38
  s_cmp_ge_i32 s14, s30
  s_cbranch_scc1 T_kv_84
  s_mov_b32 m0, s31
  s_nop 0
  buffer_load_dwordx4 v9, s[4:7], s27 offen sc1 lds
  s_mov_b32 m0, s32
  s_nop 0
  buffer_load_dwordx4 v9, s[4:7], s27 offen offset:128 sc1 lds
  s_mov_b32 m0, s33
  s_nop 0
  buffer_load_dwordx4 v10, s[4:7], s28 offen sc1 lds
  s_mov_b32 m0, s34
  s_nop 0
  buffer_load_dwordx4 v10, s[4:7], s28 offen offset:256 sc1 lds
  s_add_u32 s27, s27, 8192
  s_add_u32 s28, s28, 8192
  s_lshl_b32 s36, s12, 10
  s_add_u32 s36, s36, 145752064
  buffer_load_dwordx4 v[40:43], v2, s[4:7], s36 offen sc1
  s_waitcnt vmcnt(17)
  ds_read_b64_tr_b16 v[64:65], v27 offset:8192
  ds_read_b64_tr_b16 v[66:67], v27 offset:8320
  ds_read_b64_tr_b16 v[68:69], v27 offset:9216
  ds_read_b64_tr_b16 v[70:71], v27 offset:9344
  ds_read_b64_tr_b16 v[72:73], v36 offset:8192
  ds_read_b64_tr_b16 v[74:75], v36 offset:8320
  ds_read_b64_tr_b16 v[76:77], v36 offset:9216
  ds_read_b64_tr_b16 v[78:79], v36 offset:9344
  s_waitcnt lgkmcnt(0)
  ds_write_b128 v4, v[64:67] offset:8192
  ds_write_b128 v4, v[68:71] offset:9216
  ds_write_b128 v4, v[72:75] offset:10240
  ds_write_b128 v4, v[76:79] offset:11264
  s_waitcnt lgkmcnt(0)
  s_waitcnt vmcnt(13)
  ds_read_b64_tr_b16 v[64:65], v27 offset:12288
  ds_read_b64_tr_b16 v[66:67], v27 offset:12416
  ds_read_b64_tr_b16 v[68:69], v27 offset:13312
  ds_read_b64_tr_b16 v[70:71], v27 offset:13440
  ds_read_b64_tr_b16 v[72:73], v36 offset:12288
  ds_read_b64_tr_b16 v[74:75], v36 offset:12416
  ds_read_b64_tr_b16 v[76:77], v36 offset:13312
  ds_read_b64_tr_b16 v[78:79], v36 offset:13440
  s_waitcnt lgkmcnt(0)
  ds_write_b128 v4, v[64:67] offset:12288
  ds_write_b128 v4, v[68:71] offset:13312
  ds_write_b128 v4, v[72:75] offset:14336
  ds_write_b128 v4, v[76:79] offset:15360
  s_waitcnt lgkmcnt(0)
  s_waitcnt vmcnt(9)
  ds_read_b64_tr_b16 v[64:65], v28 offset:24576
  ds_read_b64_tr_b16 v[66:67], v28 offset:24832
  ds_read_b64_tr_b16 v[68:69], v28 offset:25600
  ds_read_b64_tr_b16 v[70:71], v28 offset:25856
  ds_read_b64_tr_b16 v[72:73], v28 offset:24584
  ds_read_b64_tr_b16 v[74:75], v28 offset:24840
  ds_read_b64_tr_b16 v[76:77], v28 offset:25608
  ds_read_b64_tr_b16 v[78:79], v28 offset:25864
  s_waitcnt lgkmcnt(0)
  ds_write_b128 v4, v[64:67] offset:24576
  ds_write_b128 v4, v[68:71] offset:25600
  ds_write_b128 v4, v[72:75] offset:26624
  ds_write_b128 v4, v[76:79] offset:27648
  s_waitcnt lgkmcnt(0)
  s_waitcnt vmcnt(5)
  ds_read_b64_tr_b16 v[64:65], v28 offset:28672
  ds_read_b64_tr_b16 v[66:67], v28 offset:28928
  ds_read_b64_tr_b16 v[68:69], v28 offset:29696
  ds_read_b64_tr_b16 v[70:71], v28 offset:29952
  ds_read_b64_tr_b16 v[72:73], v28 offset:28680
  ds_read_b64_tr_b16 v[74:75], v28 offset:28936
  ds_read_b64_tr_b16 v[76:77], v28 offset:29704
  ds_read_b64_tr_b16 v[78:79], v28 offset:29960
  s_waitcnt lgkmcnt(0)
  ds_write_b128 v4, v[64:67] offset:28672
  ds_write_b128 v4, v[68:71] offset:29696
  ds_write_b128 v4, v[72:75] offset:30720
  ds_write_b128 v4, v[76:79] offset:31744
  s_waitcnt lgkmcnt(0)
  s_mov_b32 s14, 1
  s_cmp_lt_i32 s14, s30
  s_cbranch_scc1 T_kv2_86
  s_mov_b32 s19, 0
  s_branch T_kvok_88
T_kv_87:
  s_sleep 4
  s_add_u32 s19, s19, 1
  s_cmp_gt_u32 s19, 32768
  s_cbranch_scc1 M_exit
T_kvok_88:
  s_add_u32 s39, s99, 128
  s_mov_b32 s38, 0
  s_mov_b32 s37, 0
  s_atomic_or s38, s[58:59], s99 glc
  s_atomic_or s37, s[58:59], s39 glc
  s_waitcnt lgkmcnt(0)
  s_add_u32 s37, s37, 30
  s_cmp_ge_u32 s38, 30
  s_cselect_b32 s38, s37, s38
  s_cmp_ge_u32 s38, 64
  s_cselect_b32 s38, 100, s38
  s_sub_u32 s38, s38, 1
  s_max_i32 s30, s30, s38
  s_cmp_ge_i32 s14, s30
  s_cbranch_scc1 T_kv_87
T_kv2_86:
  s_waitcnt vmcnt(0) lgkmcnt(0)
  s_barrier
  s_cmp_ge_u32 s13, 2
  s_cselect_b64 vcc, -1, 0
  v_cndmask_b32 v3, v8, v19, vcc
  ds_read_b128 v[68:71], v4 offset:0
  ds_read_b128 v[72:75], v4 offset:1024
  ds_read_b128 v[76:79], v4 offset:4096
  ds_read_b128 v[80:83], v4 offset:5120
  ds_read_b128 v[84:87], v4 offset:8192
  ds_read_b128 v[88:91], v4 offset:9216
  ds_read_b128 v[92:95], v4 offset:2048
  ds_read_b128 v[96:99], v4 offset:3072
  ds_read_b128 v[100:103], v4 offset:6144
  ds_read_b128 v[104:107], v4 offset:7168
  ds_read_b128 v[108:111], v4 offset:10240
  ds_read_b128 v[112:115], v4 offset:11264
  ds_read_b128 v[28:31], v59 offset:16384
  ds_read_b128 v[32:35], v59 offset:20480
  ds_read_b128 v[36:39], v2 offset:8192
  ds_read_b128 v[40:43], v2 offset:9216
  ds_read_b128 v[44:47], v2 offset:10240
  ds_read_b128 v[48:51], v2 offset:11264
  ds_read_b128 v[52:55], v2 offset:12288
  ds_read_b128 v[56:59], v2 offset:13312
  ds_read_b128 v[60:63], v2 offset:14336
  ds_read_b128 v[64:67], v2 offset:15360
  s_and_b32 s36, s13, 1
  s_lshl_b32 s36, s36, 12
  s_add_u32 s22, s22, s36
  s_add_u32 s23, s36, 145752064
  s_mov_b32 s14, -1
  s_and_b32 s57, s14, 1
  s_and_b32 s36, s14, 3
  s_lshl_b32 s36, s36, 13
  s_add_u32 s26, s36, s23
  s_add_u32 s36, s36, 8192
  s_and_b32 s36, s36, 0x7fff
  s_add_u32 s24, s36, 145752064
  s_add_u32 s25, s36, 145756160
  s_add_u32 s35, s36, s23
  s_waitcnt lgkmcnt(0)
  s_cmp_lg_u32 s56, 0
  s_cbranch_scc1 M_global
  s_cmp_eq_u32 s13, 1
  s_cbranch_scc1 T_w_90
  s_cmp_eq_u32 s13, 2
  s_cbranch_scc1 T_w_91
  s_cmp_eq_u32 s13, 3
  s_cbranch_scc1 T_w_92
T_w_89:
  s_mov_b32 s19, 0
  v_mov_b64 v[16:17], 0
  v_mov_b64 v[18:19], 0
  v_mov_b64 v[20:21], 0
  v_mov_b64 v[22:23], 0
  v_mov_b64 v[24:25], 0
  v_mov_b64 v[26:27], 0
  buffer_load_dwordx4 v[124:127], v2, s[4:7], s24 offen offset:0 sc1
  buffer_load_dwordx4 v[116:119], v2, s[4:7], s25 offen offset:0 sc1
  buffer_load_dwordx4 v[124:127], v2, s[4:7], s24 offen offset:0 sc1
  buffer_load_dwordx4 v[116:119], v2, s[4:7], s25 offen offset:0 sc1
  s_branch T_loop_93
.p2align 6
T_retry_94:
  s_mov_b64 exec, vcc
  buffer_load_dwordx4 v[124:127], v2, s[4:7], s24 offen offset:0 sc1
  buffer_load_dwordx4 v[116:119], v2, s[4:7], s25 offen offset:0 sc1
  s_mov_b64 exec, -1
  s_add_u32 s19, s19, 1
  s_cmp_gt_u32 s19, 32768
  s_cbranch_scc1 M_exit
T_loop_93:
  s_waitcnt vmcnt(3) lgkmcnt(0)
  v_max3_u32 v123, v124, v125, v126
  v_max_u32 v123, v123, v127
  v_mov_b32_dpp v120, v124 row_ror:8 row_mask:0xf bank_mask:0xf
  v_mov_b32_dpp v121, v125 row_ror:8 row_mask:0xf bank_mask:0xf
  s_waitcnt vmcnt(2)
  v_max3_u32 v123, v123, v116, v117
  v_max3_u32 v123, v123, v118, v119
  v_cmp_eq_u32 vcc, -1, v123
  s_cbranch_vccnz T_retry_94
  v_smfmac_f32_16x16x64_bf16 v[16:19], v[124:127], v[68:75], v0
  s_add_u32 s14, s14, 1
  ds_write_b128 v2, v[124:127] offset:0
  v_mov_b32_dpp v122, v126 row_ror:8 row_mask:0xf bank_mask:0xf
  v_smfmac_f32_16x16x64_bf16 v[20:23], v[124:127], v[76:83], v0
  s_and_b32 s57, s14, 1
  v_mov_b32_dpp v123, v127 row_ror:8 row_mask:0xf bank_mask:0xf
  v_smfmac_f32_16x16x64_bf16 v[24:27], v[124:127], v[84:91], v0
  s_and_b32 s36, s14, 3
  ds_write_b128 v2, v[116:119] offset:4096
  v_smfmac_f32_16x16x64_bf16 v[16:19], v[120:123], v[92:99], v0
  s_lshl_b32 s36, s36, 13
  v_mov_b32_dpp v84, v116 row_ror:8 row_mask:0xf bank_mask:0xf
  v_smfmac_f32_16x16x64_bf16 v[20:23], v[120:123], v[100:107], v0
  s_add_u32 s26, s36, s23
  ds_read_b128 v[68:71], v4 offset:12288
  v_mov_b32_dpp v85, v117 row_ror:8 row_mask:0xf bank_mask:0xf
  v_smfmac_f32_16x16x64_bf16 v[24:27], v[120:123], v[108:115], v0
  s_add_u32 s36, s36, 8192
  ds_read_b128 v[72:75], v4 offset:13312
  v_mov_b32_dpp v86, v118 row_ror:8 row_mask:0xf bank_mask:0xf
  v_smfmac_f32_16x16x64_bf16 v[16:19], v[116:119], v[224:231], v0
  s_and_b32 s36, s36, 0x7fff
  ds_read_b128 v[76:79], v4 offset:14336
  v_mov_b32_dpp v87, v119 row_ror:8 row_mask:0xf bank_mask:0xf
  v_smfmac_f32_16x16x64_bf16 v[20:23], v[116:119], v[240:247], v0
  s_waitcnt lgkmcnt(3)
  s_barrier
  ds_read_b128 v[100:103], v2 offset:1024
  v_smfmac_f32_16x16x64_bf16 v[24:27], v[116:119], a[0:7], v0
  s_mov_b32 m0, s31
  ds_read_b128 v[120:123], v1 offset:1024
  v_smfmac_f32_16x16x64_bf16 v[16:19], v[84:87], v[232:239], v0
  s_cmp_ge_i32 s14, s30
  s_cbranch_scc1 T_kvw_97
T_kvb_98:
  v_smfmac_f32_16x16x64_bf16 v[20:23], v[84:87], v[248:255], v0
  ds_read_b128 v[80:83], v4 offset:15360
  buffer_load_dwordx4 v9, s[4:7], s27 offen sc1 lds
  v_smfmac_f32_16x16x64_bf16 v[24:27], v[84:87], a[8:15], v0
  s_waitcnt lgkmcnt(2)
  s_mov_b32 m0, s32
  v_smfmac_f32_16x16x64_bf16 v[16:19], v[100:103], v[128:135], v0
  ds_read_b128 v[92:95], v2 offset:2048
  v_smfmac_f32_16x16x64_bf16 v[20:23], v[100:103], v[144:151], v0
  ds_read_b128 v[96:99], v1 offset:2048
  v_smfmac_f32_16x16x64_bf16 v[24:27], v[100:103], v[68:75], v0
  s_waitcnt vmcnt(1) lgkmcnt(3)
  ds_read_b128 v[116:119], v2 offset:3072
  buffer_load_dwordx4 v9, s[4:7], s27 offen offset:128 sc1 lds
  v_smfmac_f32_16x16x64_bf16 v[16:19], v[120:123], v[136:143], v0
  ds_read_b128 v[124:127], v1 offset:3072
  s_mov_b32 m0, s33
  v_smfmac_f32_16x16x64_bf16 v[20:23], v[120:123], v[152:159], v0
  s_waitcnt lgkmcnt(4)
  ds_read_b128 v[104:107], v2 offset:5120
  v_smfmac_f32_16x16x64_bf16 v[24:27], v[120:123], v[76:83], v0
  s_waitcnt lgkmcnt(4)
  ds_read_b128 v[108:111], v1 offset:5120
  v_smfmac_f32_16x16x64_bf16 v[16:19], v[92:95], v[160:167], v0
  s_waitcnt lgkmcnt(4)
  ds_read_b128 v[112:115], v2 offset:6144
  buffer_load_dwordx4 v10, s[4:7], s28 offen sc1 lds
  v_smfmac_f32_16x16x64_bf16 v[16:19], v[96:99], v[168:175], v0
  s_waitcnt lgkmcnt(4)
  ds_read_b128 v[84:87], v1 offset:6144
  s_mov_b32 m0, s34
  v_smfmac_f32_16x16x64_bf16 v[16:19], v[116:119], v[192:199], v0
  s_waitcnt lgkmcnt(4)
  ds_read_b128 v[88:91], v2 offset:7168
  v_smfmac_f32_16x16x64_bf16 v[16:19], v[124:127], v[200:207], v0
  s_waitcnt lgkmcnt(4)
  ds_read_b128 v[100:103], v1 offset:7168
  v_smfmac_f32_16x16x64_bf16 v[16:19], v[104:107], a[16:23], v0
  s_waitcnt lgkmcnt(4)
  ds_read_b128 v[68:71], v4 offset:16384
  buffer_load_dwordx4 v10, s[4:7], s28 offen offset:256 sc1 lds
  v_smfmac_f32_16x16x64_bf16 v[16:19], v[108:111], a[24:31], v0
  s_waitcnt lgkmcnt(4)
  ds_read_b128 v[72:75], v4 offset:17408
  v_smfmac_f32_16x16x64_bf16 v[16:19], v[112:115], a[64:71], v0
  s_waitcnt lgkmcnt(4)
  ds_read_b128 v[76:79], v4 offset:18432
  v_smfmac_f32_16x16x64_bf16 v[16:19], v[84:87], a[72:79], v0
  s_waitcnt lgkmcnt(4)
  ds_read_b128 v[80:83], v4 offset:19456
  v_smfmac_f32_16x16x64_bf16 v[16:19], v[88:91], a[112:119], v0
  s_waitcnt lgkmcnt(4)
  v_smfmac_f32_16x16x64_bf16 v[16:19], v[100:103], a[120:127], v0
  s_add_u32 s24, s36, 145752064
  s_add_u32 s25, s36, 145756160
  v_smfmac_f32_16x16x64_bf16 v[20:23], v[92:95], v[176:183], v0
  s_add_u32 s35, s36, s23
  v_smfmac_f32_16x16x64_bf16 v[20:23], v[96:99], v[184:191], v0
  s_waitcnt lgkmcnt(2)
  v_smfmac_f32_16x16x64_bf16 v[20:23], v[116:119], v[68:75], v0
  s_waitcnt lgkmcnt(0)
  ds_read_b128 v[68:71], v4 offset:20480
  v_mul_f32 v16, s18, v16
  v_smfmac_f32_16x16x64_bf16 v[20:23], v[124:127], v[76:83], v0
  ds_read_b128 v[72:75], v4 offset:21504
  v_mul_f32 v17, s18, v17
  v_smfmac_f32_16x16x64_bf16 v[20:23], v[104:107], a[32:39], v0
  ds_read_b128 v[76:79], v4 offset:22528
  v_mul_f32 v18, s18, v18
  v_smfmac_f32_16x16x64_bf16 v[20:23], v[108:111], a[40:47], v0
  ds_read_b128 v[80:83], v4 offset:23552
  v_mul_f32 v19, s18, v19
  v_smfmac_f32_16x16x64_bf16 v[20:23], v[112:115], a[80:87], v0
  v_cvt_pk_bf16_f32 v120, v16, v17
  v_smfmac_f32_16x16x64_bf16 v[20:23], v[84:87], a[88:95], v0
  v_cvt_pk_bf16_f32 v121, v18, v19
  v_smfmac_f32_16x16x64_bf16 v[20:23], v[88:91], a[128:135], v0
  ds_write_b64 v5, v[120:121] offset:24576
  v_smfmac_f32_16x16x64_bf16 v[20:23], v[100:103], a[136:143], v0
  s_waitcnt lgkmcnt(3)
  v_smfmac_f32_16x16x64_bf16 v[24:27], v[92:95], v[68:75], v0
  s_waitcnt lgkmcnt(1)
  v_mov_b64 v[92:93], 0
  v_smfmac_f32_16x16x64_bf16 v[24:27], v[96:99], v[76:83], v0
  s_nop 1
  v_cvt_pk_bf16_f32 v122, v20, v21
  v_cvt_pk_bf16_f32 v123, v22, v23
  v_smfmac_f32_16x16x64_bf16 v[24:27], v[116:119], v[208:215], v0
  ds_write_b64 v5, v[122:123] offset:26880
  v_mov_b64 v[94:95], 0
  v_smfmac_f32_16x16x64_bf16 v[24:27], v[124:127], v[216:223], v0
  s_waitcnt lgkmcnt(1)
  s_barrier
  ds_read_b64_tr_b16 v[68:69], v6 offset:24576
  v_smfmac_f32_16x16x64_bf16 v[24:27], v[104:107], a[48:55], v0
  s_add_u32 s27, s27, 8192
  ds_read_b64_tr_b16 v[70:71], v6 offset:24640
  ds_read_b64_tr_b16 v[72:73], v6 offset:24832
  v_smfmac_f32_16x16x64_bf16 v[24:27], v[108:111], a[56:63], v0
  s_add_u32 s28, s28, 8192
  ds_read_b64_tr_b16 v[74:75], v6 offset:24896
  ds_read_b64_tr_b16 v[76:77], v6 offset:25088
  v_smfmac_f32_16x16x64_bf16 v[24:27], v[112:115], a[96:103], v0
  s_nop 0
  ds_read_b64_tr_b16 v[78:79], v6 offset:25152
  ds_read_b64_tr_b16 v[80:81], v6 offset:25344
  v_smfmac_f32_16x16x64_bf16 v[24:27], v[84:87], a[104:111], v0
  ds_read_b64_tr_b16 v[82:83], v6 offset:25408
  v_mov_b64 v[96:97], 0
  v_smfmac_f32_16x16x64_bf16 v[24:27], v[88:91], a[144:151], v0
  s_waitcnt lgkmcnt(8)
  s_barrier
  ds_read_b64_tr_b16 v[116:117], v6 offset:26880
  v_smfmac_f32_16x16x64_bf16 v[24:27], v[100:103], a[152:159], v0
  s_waitcnt lgkmcnt(7)
  ds_read_b64_tr_b16 v[118:119], v6 offset:26944
  v_mfma_f32_16x16x32_bf16 v[16:19], v[36:39], v[68:71], 0
  s_waitcnt lgkmcnt(6)
  ds_read_b64_tr_b16 v[124:125], v6 offset:27136
  ds_read_b64_tr_b16 v[126:127], v6 offset:27200
  v_mfma_f32_16x16x32_bf16 v[16:19], v[40:43], v[72:75], v[16:19]
  s_waitcnt lgkmcnt(6)
  ds_read_b64_tr_b16 v[104:105], v6 offset:27392
  ds_read_b64_tr_b16 v[106:107], v6 offset:27456
  v_mfma_f32_16x16x32_bf16 v[16:19], v[44:47], v[76:79], v[16:19]
  s_waitcnt lgkmcnt(6)
  ds_read_b64_tr_b16 v[108:109], v6 offset:27648
  ds_read_b64_tr_b16 v[110:111], v6 offset:27712
  v_mfma_f32_16x16x32_bf16 v[16:19], v[48:51], v[80:83], v[16:19]
  s_waitcnt lgkmcnt(6)
  v_cvt_pk_bf16_f32 v120, v24, v25
  v_cvt_pk_bf16_f32 v121, v26, v27
  v_mfma_f32_16x16x32_bf16 v[112:115], v[116:119], v[68:71], 0
  s_waitcnt lgkmcnt(4)
  buffer_store_dwordx4 v[120:123], v2, s[4:7], s29 offen offset:0 sc1
  v_mov_b64 v[98:99], 0
  v_mfma_f32_16x16x32_bf16 v[112:115], v[124:127], v[72:75], v[112:115]
  s_waitcnt lgkmcnt(2)
  v_mov_b64 v[36:37], 0
  v_exp_f32 v100, v16
  v_mfma_f32_16x16x32_bf16 v[112:115], v[104:107], v[76:79], v[112:115]
  s_waitcnt lgkmcnt(0)
  v_exp_f32 v101, v17
  v_mfma_f32_16x16x32_bf16 v[112:115], v[108:111], v[80:83], v[112:115]
  v_exp_f32 v102, v18
  v_mfma_f32_16x16x32_bf16 v[20:23], v[52:55], v[68:71], 0
  s_cmp_eq_u32 s14, 63
  v_exp_f32 v103, v19
  v_mfma_f32_16x16x32_bf16 v[20:23], v[56:59], v[72:75], v[20:23]
  s_cbranch_scc1 M_tdone
  v_cvt_pk_bf16_f32 v44, v100, v101
  v_cvt_pk_bf16_f32 v45, v102, v103
  v_mfma_f32_16x16x32_bf16 v[20:23], v[60:63], v[76:79], v[20:23]
  s_add_u32 s29, s29, 131072
  v_exp_f32 v100, v112
  v_mfma_f32_16x16x32_bf16 v[20:23], v[64:67], v[80:83], v[20:23]
  v_exp_f32 v101, v113
  v_exp_f32 v102, v114
  v_exp_f32 v103, v115
  v_cvt_pk_bf16_f32 v84, v100, v101
  v_cvt_pk_bf16_f32 v85, v102, v103
  v_cndmask_b32 v48, v84, 0, s[16:17]
  v_cndmask_b32 v49, v85, 0, s[16:17]
  v_cndmask_b32 v50, 0, v84, s[16:17]
  v_cndmask_b32 v51, 0, v85, s[16:17]
  v_exp_f32 v100, v20
  v_mfma_f32_16x16x16_bf16 v[88:91], v[12:13], v[48:49], 0
  v_exp_f32 v101, v21
  v_mfma_f32_16x16x16_bf16 v[24:27], v[120:121], v[48:49], 0
  v_exp_f32 v102, v22
  v_mfma_f32_16x16x16_bf16 v[116:119], v[120:121], v[50:51], 0
  v_exp_f32 v103, v23
  v_cvt_pk_bf16_f32 v46, v100, v101
  v_cvt_pk_bf16_f32 v47, v102, v103
  v_mov_b64 v[38:39], 0
  s_nop 0
  v_mfma_f32_16x16x32_bf16 v[88:91], v[12:15], v[44:47], v[88:91]
  v_mov_b64 v[40:41], 0
  v_mov_b64 v[42:43], 0
  v_mfma_f32_16x16x32_bf16 v[24:27], v[28:31], v[44:47], v[24:27]
  ds_read_b128 v[52:55], v4 offset:24576
  ds_read_b128 v[56:59], v4 offset:25600
  v_mfma_f32_16x16x32_bf16 v[116:119], v[32:35], v[44:47], v[116:119]
  s_nop 1
  v_rcp_f32 v89, v88
  v_subrev_u32 v100, s54, v88
  v_cmp_le_u32 vcc, s55, v100
  v_mul_f32 v24, v89, v24
  v_mul_f32 v25, v89, v25
  s_cbranch_vccnz T_slow_100
T_back_101:
  v_cvt_pk_bf16_f32 v124, v24, v25
  v_pk_mul_f32 v[26:27], v[26:27], v[88:89] op_sel:[0,1] op_sel_hi:[1,1]
  v_pk_mul_f32 v[116:117], v[116:117], v[88:89] op_sel:[0,1] op_sel_hi:[1,1]
  v_pk_mul_f32 v[118:119], v[118:119], v[88:89] op_sel:[0,1] op_sel_hi:[1,1]
  v_cvt_pk_bf16_f32 v125, v26, v27
  v_cvt_pk_bf16_f32 v126, v116, v117
  v_cvt_pk_bf16_f32 v127, v118, v119
  ds_write_b128 v11, v[124:127] offset:29184
  s_nop 0
  v_smfmac_f32_16x16x64_bf16 v[92:95], v[124:127], a[160:167], v0
  v_smfmac_f32_16x16x64_bf16 v[96:99], v[124:127], a[168:175], v0
  v_smfmac_f32_16x16x64_bf16 v[36:39], v[124:127], a[176:183], v0
  v_smfmac_f32_16x16x64_bf16 v[40:43], v[124:127], a[184:191], v0
  s_waitcnt lgkmcnt(0)
  s_barrier
  ds_read_b128 v[104:107], v11 offset:29696
  ds_read_b128 v[108:111], v11 offset:30208
  ds_read_b128 v[68:71], v11 offset:30720
  s_waitcnt lgkmcnt(2)
  v_smfmac_f32_16x16x64_bf16 v[92:95], v[104:107], a[192:199], v0
  s_waitcnt lgkmcnt(1)
  ds_read_b128 v[76:79], v4 offset:28672
  v_smfmac_f32_16x16x64_bf16 v[92:95], v[108:111], a[224:231], v0
  s_waitcnt lgkmcnt(1)
  ds_read_b128 v[80:83], v4 offset:29696
  v_smfmac_f32_16x16x64_bf16 v[92:95], v[68:71], a[240:247], v0
  ds_read_b128 v[60:63], v4 offset:26624
  v_smfmac_f32_16x16x64_bf16 v[96:99], v[104:107], a[200:207], v0
  ds_read_b128 v[64:67], v4 offset:27648
  v_smfmac_f32_16x16x64_bf16 v[96:99], v[108:111], a[232:239], v0
  ds_read_b128 v[28:31], v4 offset:30720
  s_nop 0
  v_cvt_pk_bf16_f32 v16, v92, v93
  v_cvt_pk_bf16_f32 v17, v94, v95
  v_bfi_b32 v16, 1, s57, v16
  v_smfmac_f32_16x16x64_bf16 v[96:99], v[68:71], a[248:255], v0
  buffer_store_dwordx2 v[16:17], v7, s[4:7], s20 offen offset:0
  v_smfmac_f32_16x16x64_bf16 v[36:39], v[104:107], a[208:215], v0
  ds_read_b128 v[32:35], v4 offset:31744
  v_smfmac_f32_16x16x64_bf16 v[36:39], v[108:111], v[52:59], v0
  s_waitcnt lgkmcnt(4)
  s_nop 0
  v_cvt_pk_bf16_f32 v18, v96, v97
  v_cvt_pk_bf16_f32 v19, v98, v99
  v_bfi_b32 v18, 1, s57, v18
  v_smfmac_f32_16x16x64_bf16 v[36:39], v[68:71], v[76:83], v0
  buffer_store_dwordx2 v[18:19], v7, s[4:7], s20 offen offset:64
  v_smfmac_f32_16x16x64_bf16 v[40:43], v[104:107], a[216:223], v0
  s_waitcnt lgkmcnt(2)
  ds_read_b128 v[116:119], v2 offset:31232
  v_smfmac_f32_16x16x64_bf16 v[40:43], v[108:111], v[60:67], v0
  s_waitcnt lgkmcnt(1)
  s_nop 0
  v_cvt_pk_bf16_f32 v20, v36, v37
  v_cvt_pk_bf16_f32 v21, v38, v39
  v_bfi_b32 v20, 1, s57, v20
  v_smfmac_f32_16x16x64_bf16 v[40:43], v[68:71], v[28:35], v0
  buffer_store_dwordx2 v[20:21], v7, s[4:7], s21 offen offset:0
  s_nop 6
  v_cvt_pk_bf16_f32 v22, v40, v41
  v_cvt_pk_bf16_f32 v23, v42, v43
  v_bfi_b32 v22, 1, s57, v22
  buffer_store_dwordx2 v[22:23], v7, s[4:7], s21 offen offset:64
  ds_read_b128 v[68:71], v4 offset:0
  ds_read_b128 v[72:75], v4 offset:1024
  ds_read_b128 v[76:79], v4 offset:4096
  ds_read_b128 v[80:83], v4 offset:5120
  ds_read_b128 v[84:87], v4 offset:8192
  ds_read_b128 v[88:91], v4 offset:9216
  v_mov_b64 v[16:17], 0
  v_mov_b64 v[18:19], 0
  v_mov_b64 v[20:21], 0
  v_mov_b64 v[22:23], 0
  v_mov_b64 v[24:25], 0
  v_mov_b64 v[26:27], 0
  s_mov_b32 s19, 0
  v_mov_b32 v49, -1
  s_waitcnt vmcnt(2)
  buffer_load_dwordx4 v[52:55], v2, s[4:7], s22 offen offset:0 sc1
  buffer_load_dwordx4 v[56:59], v2, s[4:7], s22 offen offset:1024 sc1
  buffer_load_dwordx4 v[60:63], v2, s[4:7], s22 offen offset:2048 sc1
  buffer_load_dwordx4 v[64:67], v2, s[4:7], s22 offen offset:3072 sc1
  ds_read_b128 v[92:95], v4 offset:2048
  ds_read_b128 v[96:99], v4 offset:3072
  ds_read_b128 v[100:103], v4 offset:6144
  ds_read_b128 v[104:107], v4 offset:7168
  ds_read_b128 v[108:111], v4 offset:10240
  ds_read_b128 v[112:115], v4 offset:11264
  ds_read_b64 v[44:45], v2 offset:32256
  s_waitcnt lgkmcnt(0)
  v_readfirstlane_b32 s38, v44
  v_readfirstlane_b32 s37, v45
  s_nop 0
  s_add_u32 s37, s37, 30
  s_cmp_ge_u32 s38, 30
  s_cselect_b32 s38, s37, s38
  s_cmp_ge_u32 s38, 64
  s_cselect_b32 s38, 100, s38
  s_sub_u32 s38, s38, 1
  s_max_i32 s30, s30, s38
  s_waitcnt lgkmcnt(12)
  s_waitcnt vmcnt(3)
  v_mfma_f32_16x16x32_bf16 v[120:123], v[116:119], v[52:55], 0
  v_xor_b32 v48, s57, v52
  v_bitop3_b32 v48, v48, v54, s57 bitop3:0xf6
  s_waitcnt vmcnt(2)
  v_mfma_f32_16x16x32_bf16 v[120:123], v[116:119], v[56:59], v[120:123]
  v_bitop3_b32 v48, v48, v56, s57 bitop3:0xf6
  v_bitop3_b32 v48, v48, v58, s57 bitop3:0xf6
  s_waitcnt vmcnt(1)
  v_mfma_f32_16x16x32_bf16 v[120:123], v[116:119], v[60:63], v[120:123]
  v_bitop3_b32 v48, v48, v60, s57 bitop3:0xf6
  v_bitop3_b32 v48, v48, v62, s57 bitop3:0xf6
  s_waitcnt vmcnt(0)
  v_mfma_f32_16x16x32_bf16 v[120:123], v[116:119], v[64:67], v[120:123]
  v_bitop3_b32 v48, v48, v64, s57 bitop3:0xf6
  v_bitop3_b32 v48, v48, v66, s57 bitop3:0xf6
  v_and_b32 v48, 1, v48
  v_cmp_ne_u32 vcc, 0, v48
  s_cbranch_vccnz T_p1re_103
T_p1ok_104:
  s_nop 2
  v_add_f32_dpp v120, v120, v120 row_ror:8 row_mask:0xf bank_mask:0xf
  v_add_f32_dpp v121, v121, v121 row_ror:8 row_mask:0xf bank_mask:0xf
  v_cvt_pk_bf16_f32 v48, v120, v121
  buffer_store_dword v48, v8, s[4:7], s35 offen
  buffer_store_dword v49, v8, s[4:7], s26 offen
  s_barrier
  ds_read_b128 v[28:31], v2 offset:16384
  ds_read_b128 v[32:35], v2 offset:20480
  ds_read_b128 v[36:39], v2 offset:8192
  ds_read_b128 v[40:43], v2 offset:9216
  ds_read_b128 v[44:47], v2 offset:10240
  ds_read_b128 v[48:51], v2 offset:11264
  buffer_load_dwordx4 v[124:127], v2, s[4:7], s24 offen offset:0 sc1
  buffer_load_dwordx4 v[116:119], v2, s[4:7], s25 offen offset:0 sc1
  ds_read_b128 v[52:55], v2 offset:12288
  ds_read_b128 v[56:59], v2 offset:13312
  ds_read_b128 v[60:63], v2 offset:14336
  ds_read_b128 v[64:67], v2 offset:15360
  buffer_load_dwordx4 v[124:127], v2, s[4:7], s24 offen offset:0 sc1
  buffer_load_dwordx4 v[116:119], v2, s[4:7], s25 offen offset:0 sc1
  s_mov_b32 s19, 0
  s_branch T_loop_93
T_p1re_103:
  s_mov_b64 exec, vcc
  buffer_load_dwordx4 v[52:55], v2, s[4:7], s22 offen offset:0 sc1
  buffer_load_dwordx4 v[56:59], v2, s[4:7], s22 offen offset:1024 sc1
  buffer_load_dwordx4 v[60:63], v2, s[4:7], s22 offen offset:2048 sc1
  buffer_load_dwordx4 v[64:67], v2, s[4:7], s22 offen offset:3072 sc1
  s_mov_b64 exec, -1
  s_add_u32 s19, s19, 1
  s_cmp_gt_u32 s19, 32768
  s_cbranch_scc1 M_exit
  s_waitcnt vmcnt(3)
  v_mfma_f32_16x16x32_bf16 v[120:123], v[116:119], v[52:55], 0
  v_xor_b32 v48, s57, v52
  v_bitop3_b32 v48, v48, v54, s57 bitop3:0xf6
  s_waitcnt vmcnt(2)
  v_mfma_f32_16x16x32_bf16 v[120:123], v[116:119], v[56:59], v[120:123]
  v_bitop3_b32 v48, v48, v56, s57 bitop3:0xf6
  v_bitop3_b32 v48, v48, v58, s57 bitop3:0xf6
  s_waitcnt vmcnt(1)
  v_mfma_f32_16x16x32_bf16 v[120:123], v[116:119], v[60:63], v[120:123]
  v_bitop3_b32 v48, v48, v60, s57 bitop3:0xf6
  v_bitop3_b32 v48, v48, v62, s57 bitop3:0xf6
  s_waitcnt vmcnt(0)
  v_mfma_f32_16x16x32_bf16 v[120:123], v[116:119], v[64:67], v[120:123]
  v_bitop3_b32 v48, v48, v64, s57 bitop3:0xf6
  v_bitop3_b32 v48, v48, v66, s57 bitop3:0xf6
  v_and_b32 v48, 1, v48
  v_cmp_ne_u32 vcc, 0, v48
  s_cbranch_vccnz T_p1re_103
  s_branch T_p1ok_104
T_kvw_97:
  s_mov_b32 s19, 0
  s_branch T_kvok_106
T_kv_105:
  s_sleep 4
  s_add_u32 s19, s19, 1
  s_cmp_gt_u32 s19, 32768
  s_cbranch_scc1 M_exit
T_kvok_106:
  s_add_u32 s39, s99, 128
  s_mov_b32 s38, 0
  s_mov_b32 s37, 0
  s_atomic_or s38, s[58:59], s99 glc
  s_atomic_or s37, s[58:59], s39 glc
  s_waitcnt lgkmcnt(0)
  s_add_u32 s37, s37, 30
  s_cmp_ge_u32 s38, 30
  s_cselect_b32 s38, s37, s38
  s_cmp_ge_u32 s38, 64
  s_cselect_b32 s38, 100, s38
  s_sub_u32 s38, s38, 1
  s_max_i32 s30, s30, s38
  s_cmp_ge_i32 s14, s30
  s_cbranch_scc1 T_kv_105
  s_branch T_kvb_98
T_slow_100:
  s_nop 7
  v_max3_f32 v100, v16, v17, v18
  v_max3_f32 v100, v100, v19, v20
  v_max3_f32 v100, v100, v21, v22
  v_max3_f32 v100, v100, v23, v112
  v_max3_f32 v100, v100, v113, v114
  v_max_f32 v100, v100, v115
  v_mov_b32 v101, v100
  s_nop 1
  v_permlane32_swap_b32 v100, v101
  s_nop 1
  v_max_f32 v100, v100, v101
  v_mov_b32 v101, v100
  s_nop 1
  v_permlane16_swap_b32 v100, v101
  s_nop 1
  v_max_f32 v100, v100, v101
  v_sub_f32 v16, v16, v100
  v_sub_f32 v17, v17, v100
  v_sub_f32 v18, v18, v100
  v_sub_f32 v19, v19, v100
  v_exp_f32 v16, v16
  v_exp_f32 v17, v17
  v_exp_f32 v18, v18
  v_exp_f32 v19, v19
  v_sub_f32 v20, v20, v100
  v_sub_f32 v21, v21, v100
  v_sub_f32 v22, v22, v100
  v_sub_f32 v23, v23, v100
  v_exp_f32 v20, v20
  v_exp_f32 v21, v21
  v_exp_f32 v22, v22
  v_exp_f32 v23, v23
  v_sub_f32 v112, v112, v100
  v_sub_f32 v113, v113, v100
  v_sub_f32 v114, v114, v100
  v_sub_f32 v115, v115, v100
  v_exp_f32 v112, v112
  v_exp_f32 v113, v113
  v_exp_f32 v114, v114
  v_exp_f32 v115, v115
  s_nop 0
  v_cvt_pk_bf16_f32 v44, v16, v17
  v_cvt_pk_bf16_f32 v45, v18, v19
  v_cvt_pk_bf16_f32 v46, v20, v21
  v_cvt_pk_bf16_f32 v47, v22, v23
  v_cvt_pk_bf16_f32 v84, v112, v113
  v_cvt_pk_bf16_f32 v85, v114, v115
  v_cndmask_b32 v48, v84, 0, s[16:17]
  v_cndmask_b32 v49, v85, 0, s[16:17]
  v_cndmask_b32 v50, 0, v84, s[16:17]
  v_cndmask_b32 v51, 0, v85, s[16:17]
  s_nop 1
  v_mfma_f32_16x16x16_bf16 v[88:91], v[12:13], v[48:49], 0
  v_mfma_f32_16x16x16_bf16 v[24:27], v[120:121], v[48:49], 0
  v_mfma_f32_16x16x16_bf16 v[116:119], v[120:121], v[50:51], 0
  v_mfma_f32_16x16x32_bf16 v[88:91], v[12:15], v[44:47], v[88:91]
  v_mfma_f32_16x16x32_bf16 v[24:27], v[28:31], v[44:47], v[24:27]
  v_mfma_f32_16x16x32_bf16 v[116:119], v[32:35], v[44:47], v[116:119]
  s_nop 7
  s_nop 1
  v_rcp_f32 v89, v88
  s_nop 0
  v_mul_f32 v24, v89, v24
  v_mul_f32 v25, v89, v25
  s_branch T_back_101
T_w_90:
  s_mov_b32 s19, 0
  v_mov_b64 v[16:17], 0
  v_mov_b64 v[18:19], 0
  v_mov_b64 v[20:21], 0
  v_mov_b64 v[22:23], 0
  v_mov_b64 v[24:25], 0
  v_mov_b64 v[26:27], 0
  buffer_load_dwordx4 v[124:127], v2, s[4:7], s24 offen offset:1024 sc1
  buffer_load_dwordx4 v[116:119], v2, s[4:7], s25 offen offset:1024 sc1
  buffer_load_dwordx4 v[124:127], v2, s[4:7], s24 offen offset:1024 sc1
  buffer_load_dwordx4 v[116:119], v2, s[4:7], s25 offen offset:1024 sc1
  s_branch T_loop_107
.p2align 6
T_retry_108:
  s_mov_b64 exec, vcc
  buffer_load_dwordx4 v[124:127], v2, s[4:7], s24 offen offset:1024 sc1
  buffer_load_dwordx4 v[116:119], v2, s[4:7], s25 offen offset:1024 sc1
  s_mov_b64 exec, -1
  s_add_u32 s19, s19, 1
  s_cmp_gt_u32 s19, 32768
  s_cbranch_scc1 M_exit
T_loop_107:
  s_waitcnt vmcnt(3) lgkmcnt(0)
  v_max3_u32 v123, v124, v125, v126
  v_max_u32 v123, v123, v127
  v_mov_b32_dpp v120, v124 row_ror:8 row_mask:0xf bank_mask:0xf
  v_mov_b32_dpp v121, v125 row_ror:8 row_mask:0xf bank_mask:0xf
  s_waitcnt vmcnt(2)
  v_max3_u32 v123, v123, v116, v117
  v_max3_u32 v123, v123, v118, v119
  v_cmp_eq_u32 vcc, -1, v123
  s_cbranch_vccnz T_retry_108
  v_smfmac_f32_16x16x64_bf16 v[16:19], v[124:127], v[68:75], v0
  s_add_u32 s14, s14, 1
  ds_write_b128 v2, v[124:127] offset:1024
  v_mov_b32_dpp v122, v126 row_ror:8 row_mask:0xf bank_mask:0xf
  v_smfmac_f32_16x16x64_bf16 v[20:23], v[124:127], v[76:83], v0
  s_and_b32 s57, s14, 1
  v_mov_b32_dpp v123, v127 row_ror:8 row_mask:0xf bank_mask:0xf
  v_smfmac_f32_16x16x64_bf16 v[24:27], v[124:127], v[84:91], v0
  s_and_b32 s36, s14, 3
  ds_write_b128 v2, v[116:119] offset:5120
  v_smfmac_f32_16x16x64_bf16 v[16:19], v[120:123], v[92:99], v0
  s_lshl_b32 s36, s36, 13
  v_mov_b32_dpp v84, v116 row_ror:8 row_mask:0xf bank_mask:0xf
  v_smfmac_f32_16x16x64_bf16 v[20:23], v[120:123], v[100:107], v0
  s_add_u32 s26, s36, s23
  ds_read_b128 v[68:71], v4 offset:12288
  v_mov_b32_dpp v85, v117 row_ror:8 row_mask:0xf bank_mask:0xf
  v_smfmac_f32_16x16x64_bf16 v[24:27], v[120:123], v[108:115], v0
  s_add_u32 s36, s36, 8192
  ds_read_b128 v[72:75], v4 offset:13312
  v_mov_b32_dpp v86, v118 row_ror:8 row_mask:0xf bank_mask:0xf
  v_smfmac_f32_16x16x64_bf16 v[16:19], v[116:119], v[224:231], v0
  s_and_b32 s36, s36, 0x7fff
  ds_read_b128 v[76:79], v4 offset:14336
  v_mov_b32_dpp v87, v119 row_ror:8 row_mask:0xf bank_mask:0xf
  v_smfmac_f32_16x16x64_bf16 v[20:23], v[116:119], v[240:247], v0
  s_waitcnt lgkmcnt(3)
  s_barrier
  ds_read_b128 v[100:103], v2 offset:0
  v_smfmac_f32_16x16x64_bf16 v[24:27], v[116:119], a[0:7], v0
  s_mov_b32 m0, s31
  ds_read_b128 v[120:123], v1 offset:0
  v_smfmac_f32_16x16x64_bf16 v[16:19], v[84:87], v[232:239], v0
  s_cmp_ge_i32 s14, s30
  s_cbranch_scc1 T_kvw_111
T_kvb_112:
  v_smfmac_f32_16x16x64_bf16 v[20:23], v[84:87], v[248:255], v0
  ds_read_b128 v[80:83], v4 offset:15360
  v_smfmac_f32_16x16x64_bf16 v[24:27], v[84:87], a[8:15], v0
  s_waitcnt lgkmcnt(2)
  buffer_load_dwordx4 v9, s[4:7], s27 offen sc1 lds
  v_smfmac_f32_16x16x64_bf16 v[16:19], v[100:103], v[128:135], v0
  ds_read_b128 v[92:95], v2 offset:3072
  s_mov_b32 m0, s32
  v_smfmac_f32_16x16x64_bf16 v[20:23], v[100:103], v[144:151], v0
  ds_read_b128 v[96:99], v1 offset:3072
  v_smfmac_f32_16x16x64_bf16 v[24:27], v[100:103], v[68:75], v0
  s_waitcnt vmcnt(1) lgkmcnt(3)
  ds_read_b128 v[116:119], v2 offset:2048
  v_smfmac_f32_16x16x64_bf16 v[16:19], v[120:123], v[136:143], v0
  ds_read_b128 v[124:127], v1 offset:2048
  buffer_load_dwordx4 v9, s[4:7], s27 offen offset:128 sc1 lds
  v_smfmac_f32_16x16x64_bf16 v[20:23], v[120:123], v[152:159], v0
  s_waitcnt lgkmcnt(4)
  ds_read_b128 v[104:107], v2 offset:4096
  s_mov_b32 m0, s33
  v_smfmac_f32_16x16x64_bf16 v[24:27], v[120:123], v[76:83], v0
  s_waitcnt lgkmcnt(4)
  ds_read_b128 v[108:111], v1 offset:4096
  v_smfmac_f32_16x16x64_bf16 v[16:19], v[92:95], v[160:167], v0
  s_waitcnt lgkmcnt(4)
  ds_read_b128 v[112:115], v2 offset:7168
  v_smfmac_f32_16x16x64_bf16 v[16:19], v[96:99], v[168:175], v0
  s_waitcnt lgkmcnt(4)
  ds_read_b128 v[84:87], v1 offset:7168
  buffer_load_dwordx4 v10, s[4:7], s28 offen sc1 lds
  v_smfmac_f32_16x16x64_bf16 v[16:19], v[116:119], v[192:199], v0
  s_waitcnt lgkmcnt(4)
  ds_read_b128 v[88:91], v2 offset:6144
  s_mov_b32 m0, s34
  v_smfmac_f32_16x16x64_bf16 v[16:19], v[124:127], v[200:207], v0
  s_waitcnt lgkmcnt(4)
  ds_read_b128 v[100:103], v1 offset:6144
  v_smfmac_f32_16x16x64_bf16 v[16:19], v[104:107], a[16:23], v0
  s_waitcnt lgkmcnt(4)
  ds_read_b128 v[68:71], v4 offset:16384
  v_smfmac_f32_16x16x64_bf16 v[16:19], v[108:111], a[24:31], v0
  s_waitcnt lgkmcnt(4)
  ds_read_b128 v[72:75], v4 offset:17408
  buffer_load_dwordx4 v10, s[4:7], s28 offen offset:256 sc1 lds
  v_smfmac_f32_16x16x64_bf16 v[16:19], v[112:115], a[64:71], v0
  s_waitcnt lgkmcnt(4)
  ds_read_b128 v[76:79], v4 offset:18432
  v_smfmac_f32_16x16x64_bf16 v[16:19], v[84:87], a[72:79], v0
  s_waitcnt lgkmcnt(4)
  ds_read_b128 v[80:83], v4 offset:19456
  v_smfmac_f32_16x16x64_bf16 v[16:19], v[88:91], a[112:119], v0
  s_waitcnt lgkmcnt(4)
  v_smfmac_f32_16x16x64_bf16 v[16:19], v[100:103], a[120:127], v0
  s_add_u32 s24, s36, 145752064
  s_add_u32 s25, s36, 145756160
  v_smfmac_f32_16x16x64_bf16 v[20:23], v[92:95], v[176:183], v0
  s_add_u32 s35, s36, s23
  v_smfmac_f32_16x16x64_bf16 v[20:23], v[96:99], v[184:191], v0
  s_waitcnt lgkmcnt(2)
  v_smfmac_f32_16x16x64_bf16 v[20:23], v[116:119], v[68:75], v0
  s_waitcnt lgkmcnt(0)
  ds_read_b128 v[68:71], v4 offset:20480
  v_mul_f32 v16, s18, v16
  v_smfmac_f32_16x16x64_bf16 v[20:23], v[124:127], v[76:83], v0
  ds_read_b128 v[72:75], v4 offset:21504
  v_mul_f32 v17, s18, v17
  v_smfmac_f32_16x16x64_bf16 v[20:23], v[104:107], a[32:39], v0
  ds_read_b128 v[76:79], v4 offset:22528
  v_mul_f32 v18, s18, v18
  v_smfmac_f32_16x16x64_bf16 v[20:23], v[108:111], a[40:47], v0
  ds_read_b128 v[80:83], v4 offset:23552
  v_mul_f32 v19, s18, v19
  v_smfmac_f32_16x16x64_bf16 v[20:23], v[112:115], a[80:87], v0
  v_cvt_pk_bf16_f32 v120, v16, v17
  v_smfmac_f32_16x16x64_bf16 v[20:23], v[84:87], a[88:95], v0
  v_cvt_pk_bf16_f32 v121, v18, v19
  v_smfmac_f32_16x16x64_bf16 v[20:23], v[88:91], a[128:135], v0
  ds_write_b64 v5, v[120:121] offset:24576
  v_smfmac_f32_16x16x64_bf16 v[20:23], v[100:103], a[136:143], v0
  s_waitcnt lgkmcnt(3)
  v_smfmac_f32_16x16x64_bf16 v[24:27], v[92:95], v[68:75], v0
  s_waitcnt lgkmcnt(1)
  v_mov_b64 v[92:93], 0
  v_smfmac_f32_16x16x64_bf16 v[24:27], v[96:99], v[76:83], v0
  s_nop 1
  v_cvt_pk_bf16_f32 v122, v20, v21
  v_cvt_pk_bf16_f32 v123, v22, v23
  v_smfmac_f32_16x16x64_bf16 v[24:27], v[116:119], v[208:215], v0
  ds_write_b64 v5, v[122:123] offset:26880
  v_mov_b64 v[94:95], 0
  v_smfmac_f32_16x16x64_bf16 v[24:27], v[124:127], v[216:223], v0
  s_waitcnt lgkmcnt(1)
  s_barrier
  ds_read_b64_tr_b16 v[68:69], v6 offset:24576
  v_smfmac_f32_16x16x64_bf16 v[24:27], v[104:107], a[48:55], v0
  s_add_u32 s27, s27, 8192
  ds_read_b64_tr_b16 v[70:71], v6 offset:24640
  ds_read_b64_tr_b16 v[72:73], v6 offset:24832
  v_smfmac_f32_16x16x64_bf16 v[24:27], v[108:111], a[56:63], v0
  s_add_u32 s28, s28, 8192
  ds_read_b64_tr_b16 v[74:75], v6 offset:24896
  ds_read_b64_tr_b16 v[76:77], v6 offset:25088
  v_smfmac_f32_16x16x64_bf16 v[24:27], v[112:115], a[96:103], v0
  s_nop 0
  ds_read_b64_tr_b16 v[78:79], v6 offset:25152
  ds_read_b64_tr_b16 v[80:81], v6 offset:25344
  v_smfmac_f32_16x16x64_bf16 v[24:27], v[84:87], a[104:111], v0
  ds_read_b64_tr_b16 v[82:83], v6 offset:25408
  v_mov_b64 v[96:97], 0
  v_smfmac_f32_16x16x64_bf16 v[24:27], v[88:91], a[144:151], v0
  s_waitcnt lgkmcnt(8)
  s_barrier
  ds_read_b64_tr_b16 v[116:117], v6 offset:26880
  v_smfmac_f32_16x16x64_bf16 v[24:27], v[100:103], a[152:159], v0
  s_waitcnt lgkmcnt(7)
  ds_read_b64_tr_b16 v[118:119], v6 offset:26944
  v_mfma_f32_16x16x32_bf16 v[16:19], v[36:39], v[68:71], 0
  s_waitcnt lgkmcnt(6)
  ds_read_b64_tr_b16 v[124:125], v6 offset:27136
  ds_read_b64_tr_b16 v[126:127], v6 offset:27200
  v_mfma_f32_16x16x32_bf16 v[16:19], v[40:43], v[72:75], v[16:19]
  s_waitcnt lgkmcnt(6)
  ds_read_b64_tr_b16 v[104:105], v6 offset:27392
  ds_read_b64_tr_b16 v[106:107], v6 offset:27456
  v_mfma_f32_16x16x32_bf16 v[16:19], v[44:47], v[76:79], v[16:19]
  s_waitcnt lgkmcnt(6)
  ds_read_b64_tr_b16 v[108:109], v6 offset:27648
  ds_read_b64_tr_b16 v[110:111], v6 offset:27712
  v_mfma_f32_16x16x32_bf16 v[16:19], v[48:51], v[80:83], v[16:19]
  s_waitcnt lgkmcnt(6)
  v_cvt_pk_bf16_f32 v120, v24, v25
  v_cvt_pk_bf16_f32 v121, v26, v27
  v_mfma_f32_16x16x32_bf16 v[112:115], v[116:119], v[68:71], 0
  s_waitcnt lgkmcnt(4)
  v_mov_b64 v[98:99], 0
  v_mfma_f32_16x16x32_bf16 v[112:115], v[124:127], v[72:75], v[112:115]
  s_waitcnt lgkmcnt(2)
  buffer_store_dwordx4 v[120:123], v2, s[4:7], s29 offen offset:1024 sc1
  v_mov_b64 v[36:37], 0
  v_exp_f32 v100, v16
  v_mfma_f32_16x16x32_bf16 v[112:115], v[104:107], v[76:79], v[112:115]
  s_waitcnt lgkmcnt(0)
  v_exp_f32 v101, v17
  v_mfma_f32_16x16x32_bf16 v[112:115], v[108:111], v[80:83], v[112:115]
  v_exp_f32 v102, v18
  v_mfma_f32_16x16x32_bf16 v[20:23], v[52:55], v[68:71], 0
  s_cmp_eq_u32 s14, 63
  v_exp_f32 v103, v19
  v_mfma_f32_16x16x32_bf16 v[20:23], v[56:59], v[72:75], v[20:23]
  s_cbranch_scc1 M_tdone
  v_cvt_pk_bf16_f32 v44, v100, v101
  v_cvt_pk_bf16_f32 v45, v102, v103
  v_mfma_f32_16x16x32_bf16 v[20:23], v[60:63], v[76:79], v[20:23]
  s_add_u32 s29, s29, 131072
  v_exp_f32 v100, v112
  v_mfma_f32_16x16x32_bf16 v[20:23], v[64:67], v[80:83], v[20:23]
  v_exp_f32 v101, v113
  v_exp_f32 v102, v114
  v_exp_f32 v103, v115
  v_cvt_pk_bf16_f32 v84, v100, v101
  v_cvt_pk_bf16_f32 v85, v102, v103
  v_cndmask_b32 v48, v84, 0, s[16:17]
  v_cndmask_b32 v49, v85, 0, s[16:17]
  v_cndmask_b32 v50, 0, v84, s[16:17]
  v_cndmask_b32 v51, 0, v85, s[16:17]
  v_exp_f32 v100, v20
  v_mfma_f32_16x16x16_bf16 v[88:91], v[12:13], v[48:49], 0
  v_exp_f32 v101, v21
  v_mfma_f32_16x16x16_bf16 v[24:27], v[120:121], v[48:49], 0
  v_exp_f32 v102, v22
  v_mfma_f32_16x16x16_bf16 v[116:119], v[120:121], v[50:51], 0
  v_exp_f32 v103, v23
  v_cvt_pk_bf16_f32 v46, v100, v101
  v_cvt_pk_bf16_f32 v47, v102, v103
  v_mov_b64 v[38:39], 0
  s_nop 0
  v_mfma_f32_16x16x32_bf16 v[88:91], v[12:15], v[44:47], v[88:91]
  v_mov_b64 v[40:41], 0
  v_mov_b64 v[42:43], 0
  v_mfma_f32_16x16x32_bf16 v[24:27], v[28:31], v[44:47], v[24:27]
  ds_read_b128 v[52:55], v4 offset:24576
  ds_read_b128 v[56:59], v4 offset:25600
  v_mfma_f32_16x16x32_bf16 v[116:119], v[32:35], v[44:47], v[116:119]
  s_nop 1
  v_rcp_f32 v89, v88
  v_subrev_u32 v100, s54, v88
  v_cmp_le_u32 vcc, s55, v100
  v_mul_f32 v24, v89, v24
  v_mul_f32 v25, v89, v25
  s_cbranch_vccnz T_slow_114
T_back_115:
  v_cvt_pk_bf16_f32 v124, v24, v25
  v_pk_mul_f32 v[26:27], v[26:27], v[88:89] op_sel:[0,1] op_sel_hi:[1,1]
  v_pk_mul_f32 v[116:117], v[116:117], v[88:89] op_sel:[0,1] op_sel_hi:[1,1]
  v_pk_mul_f32 v[118:119], v[118:119], v[88:89] op_sel:[0,1] op_sel_hi:[1,1]
  v_cvt_pk_bf16_f32 v125, v26, v27
  v_cvt_pk_bf16_f32 v126, v116, v117
  v_cvt_pk_bf16_f32 v127, v118, v119
  ds_write_b128 v11, v[124:127] offset:29696
  s_nop 0
  v_smfmac_f32_16x16x64_bf16 v[92:95], v[124:127], a[160:167], v0
  v_smfmac_f32_16x16x64_bf16 v[96:99], v[124:127], a[168:175], v0
  v_smfmac_f32_16x16x64_bf16 v[36:39], v[124:127], a[176:183], v0
  v_smfmac_f32_16x16x64_bf16 v[40:43], v[124:127], a[184:191], v0
  s_waitcnt lgkmcnt(0)
  s_barrier
  ds_read_b128 v[104:107], v11 offset:29184
  ds_read_b128 v[108:111], v11 offset:30720
  ds_read_b128 v[68:71], v11 offset:30208
  s_waitcnt lgkmcnt(2)
  v_smfmac_f32_16x16x64_bf16 v[92:95], v[104:107], a[192:199], v0
  s_waitcnt lgkmcnt(1)
  ds_read_b128 v[76:79], v4 offset:28672
  v_smfmac_f32_16x16x64_bf16 v[92:95], v[108:111], a[224:231], v0
  s_waitcnt lgkmcnt(1)
  ds_read_b128 v[80:83], v4 offset:29696
  v_smfmac_f32_16x16x64_bf16 v[92:95], v[68:71], a[240:247], v0
  ds_read_b128 v[60:63], v4 offset:26624
  v_smfmac_f32_16x16x64_bf16 v[96:99], v[104:107], a[200:207], v0
  ds_read_b128 v[64:67], v4 offset:27648
  v_smfmac_f32_16x16x64_bf16 v[96:99], v[108:111], a[232:239], v0
  ds_read_b128 v[28:31], v4 offset:30720
  s_nop 0
  v_cvt_pk_bf16_f32 v16, v92, v93
  v_cvt_pk_bf16_f32 v17, v94, v95
  v_bfi_b32 v16, 1, s57, v16
  v_smfmac_f32_16x16x64_bf16 v[96:99], v[68:71], a[248:255], v0
  buffer_store_dwordx2 v[16:17], v7, s[4:7], s20 offen offset:0
  v_smfmac_f32_16x16x64_bf16 v[36:39], v[104:107], a[208:215], v0
  ds_read_b128 v[32:35], v4 offset:31744
  v_smfmac_f32_16x16x64_bf16 v[36:39], v[108:111], v[52:59], v0
  s_waitcnt lgkmcnt(4)
  s_nop 0
  v_cvt_pk_bf16_f32 v18, v96, v97
  v_cvt_pk_bf16_f32 v19, v98, v99
  v_bfi_b32 v18, 1, s57, v18
  v_smfmac_f32_16x16x64_bf16 v[36:39], v[68:71], v[76:83], v0
  buffer_store_dwordx2 v[18:19], v7, s[4:7], s20 offen offset:64
  v_smfmac_f32_16x16x64_bf16 v[40:43], v[104:107], a[216:223], v0
  s_waitcnt lgkmcnt(2)
  ds_read_b128 v[116:119], v2 offset:31232
  v_smfmac_f32_16x16x64_bf16 v[40:43], v[108:111], v[60:67], v0
  s_waitcnt lgkmcnt(1)
  s_nop 0
  v_cvt_pk_bf16_f32 v20, v36, v37
  v_cvt_pk_bf16_f32 v21, v38, v39
  v_bfi_b32 v20, 1, s57, v20
  v_smfmac_f32_16x16x64_bf16 v[40:43], v[68:71], v[28:35], v0
  buffer_store_dwordx2 v[20:21], v7, s[4:7], s21 offen offset:0
  s_nop 6
  v_cvt_pk_bf16_f32 v22, v40, v41
  v_cvt_pk_bf16_f32 v23, v42, v43
  v_bfi_b32 v22, 1, s57, v22
  buffer_store_dwordx2 v[22:23], v7, s[4:7], s21 offen offset:64
  ds_read_b128 v[68:71], v4 offset:0
  ds_read_b128 v[72:75], v4 offset:1024
  ds_read_b128 v[76:79], v4 offset:4096
  ds_read_b128 v[80:83], v4 offset:5120
  ds_read_b128 v[84:87], v4 offset:8192
  ds_read_b128 v[88:91], v4 offset:9216
  ds_read_b128 v[92:95], v4 offset:2048
  ds_read_b128 v[96:99], v4 offset:3072
  ds_read_b128 v[100:103], v4 offset:6144
  ds_read_b128 v[104:107], v4 offset:7168
  ds_read_b128 v[108:111], v4 offset:10240
  ds_read_b128 v[112:115], v4 offset:11264
  v_mov_b64 v[16:17], 0
  v_mov_b64 v[18:19], 0
  v_mov_b64 v[20:21], 0
  v_mov_b64 v[22:23], 0
  v_mov_b64 v[24:25], 0
  v_mov_b64 v[26:27], 0
  s_mov_b32 s19, 0
  v_mov_b32 v49, -1
  ds_read_b64 v[44:45], v2 offset:32256
  s_waitcnt lgkmcnt(0)
  v_readfirstlane_b32 s38, v44
  v_readfirstlane_b32 s37, v45
  s_nop 0
  s_add_u32 s37, s37, 30
  s_cmp_ge_u32 s38, 30
  s_cselect_b32 s38, s37, s38
  s_cmp_ge_u32 s38, 64
  s_cselect_b32 s38, 100, s38
  s_sub_u32 s38, s38, 1
  s_max_i32 s30, s30, s38
  s_waitcnt vmcnt(0)
  buffer_load_dwordx4 v[52:55], v2, s[4:7], s22 offen offset:0 sc1
  buffer_load_dwordx4 v[56:59], v2, s[4:7], s22 offen offset:1024 sc1
  buffer_load_dwordx4 v[60:63], v2, s[4:7], s22 offen offset:2048 sc1
  buffer_load_dwordx4 v[64:67], v2, s[4:7], s22 offen offset:3072 sc1
  s_waitcnt lgkmcnt(12)
  s_waitcnt vmcnt(3)
  v_mfma_f32_16x16x32_bf16 v[120:123], v[116:119], v[52:55], 0
  v_xor_b32 v48, s57, v52
  v_bitop3_b32 v48, v48, v54, s57 bitop3:0xf6
  s_waitcnt vmcnt(2)
  v_mfma_f32_16x16x32_bf16 v[120:123], v[116:119], v[56:59], v[120:123]
  v_bitop3_b32 v48, v48, v56, s57 bitop3:0xf6
  v_bitop3_b32 v48, v48, v58, s57 bitop3:0xf6
  s_waitcnt vmcnt(1)
  v_mfma_f32_16x16x32_bf16 v[120:123], v[116:119], v[60:63], v[120:123]
  v_bitop3_b32 v48, v48, v60, s57 bitop3:0xf6
  v_bitop3_b32 v48, v48, v62, s57 bitop3:0xf6
  s_waitcnt vmcnt(0)
  v_mfma_f32_16x16x32_bf16 v[120:123], v[116:119], v[64:67], v[120:123]
  v_bitop3_b32 v48, v48, v64, s57 bitop3:0xf6
  v_bitop3_b32 v48, v48, v66, s57 bitop3:0xf6
  v_and_b32 v48, 1, v48
  v_cmp_ne_u32 vcc, 0, v48
  s_cbranch_vccnz T_p1re_117
T_p1ok_118:
  s_nop 2
  v_add_f32_dpp v120, v120, v120 row_ror:8 row_mask:0xf bank_mask:0xf
  v_add_f32_dpp v121, v121, v121 row_ror:8 row_mask:0xf bank_mask:0xf
  v_cvt_pk_bf16_f32 v48, v120, v121
  buffer_store_dword v48, v8, s[4:7], s35 offen
  buffer_store_dword v49, v8, s[4:7], s26 offen
  s_barrier
  ds_read_b128 v[28:31], v2 offset:17408
  ds_read_b128 v[32:35], v2 offset:21504
  ds_read_b128 v[36:39], v2 offset:8192
  ds_read_b128 v[40:43], v2 offset:9216
  ds_read_b128 v[44:47], v2 offset:10240
  ds_read_b128 v[48:51], v2 offset:11264
  buffer_load_dwordx4 v[124:127], v2, s[4:7], s24 offen offset:1024 sc1
  buffer_load_dwordx4 v[116:119], v2, s[4:7], s25 offen offset:1024 sc1
  ds_read_b128 v[52:55], v2 offset:12288
  ds_read_b128 v[56:59], v2 offset:13312
  ds_read_b128 v[60:63], v2 offset:14336
  ds_read_b128 v[64:67], v2 offset:15360
  buffer_load_dwordx4 v[124:127], v2, s[4:7], s24 offen offset:1024 sc1
  buffer_load_dwordx4 v[116:119], v2, s[4:7], s25 offen offset:1024 sc1
  s_mov_b32 s19, 0
  s_branch T_loop_107
T_p1re_117:
  s_mov_b64 exec, vcc
  buffer_load_dwordx4 v[52:55], v2, s[4:7], s22 offen offset:0 sc1
  buffer_load_dwordx4 v[56:59], v2, s[4:7], s22 offen offset:1024 sc1
  buffer_load_dwordx4 v[60:63], v2, s[4:7], s22 offen offset:2048 sc1
  buffer_load_dwordx4 v[64:67], v2, s[4:7], s22 offen offset:3072 sc1
  s_mov_b64 exec, -1
  s_add_u32 s19, s19, 1
  s_cmp_gt_u32 s19, 32768
  s_cbranch_scc1 M_exit
  s_waitcnt vmcnt(3)
  v_mfma_f32_16x16x32_bf16 v[120:123], v[116:119], v[52:55], 0
  v_xor_b32 v48, s57, v52
  v_bitop3_b32 v48, v48, v54, s57 bitop3:0xf6
  s_waitcnt vmcnt(2)
  v_mfma_f32_16x16x32_bf16 v[120:123], v[116:119], v[56:59], v[120:123]
  v_bitop3_b32 v48, v48, v56, s57 bitop3:0xf6
  v_bitop3_b32 v48, v48, v58, s57 bitop3:0xf6
  s_waitcnt vmcnt(1)
  v_mfma_f32_16x16x32_bf16 v[120:123], v[116:119], v[60:63], v[120:123]
  v_bitop3_b32 v48, v48, v60, s57 bitop3:0xf6
  v_bitop3_b32 v48, v48, v62, s57 bitop3:0xf6
  s_waitcnt vmcnt(0)
  v_mfma_f32_16x16x32_bf16 v[120:123], v[116:119], v[64:67], v[120:123]
  v_bitop3_b32 v48, v48, v64, s57 bitop3:0xf6
  v_bitop3_b32 v48, v48, v66, s57 bitop3:0xf6
  v_and_b32 v48, 1, v48
  v_cmp_ne_u32 vcc, 0, v48
  s_cbranch_vccnz T_p1re_117
  s_branch T_p1ok_118
T_kvw_111:
  s_mov_b32 s19, 0
  s_branch T_kvok_120
T_kv_119:
  s_sleep 4
  s_add_u32 s19, s19, 1
  s_cmp_gt_u32 s19, 32768
  s_cbranch_scc1 M_exit
T_kvok_120:
  s_add_u32 s39, s99, 128
  s_mov_b32 s38, 0
  s_mov_b32 s37, 0
  s_atomic_or s38, s[58:59], s99 glc
  s_atomic_or s37, s[58:59], s39 glc
  s_waitcnt lgkmcnt(0)
  s_add_u32 s37, s37, 30
  s_cmp_ge_u32 s38, 30
  s_cselect_b32 s38, s37, s38
  s_cmp_ge_u32 s38, 64
  s_cselect_b32 s38, 100, s38
  s_sub_u32 s38, s38, 1
  s_max_i32 s30, s30, s38
  s_cmp_ge_i32 s14, s30
  s_cbranch_scc1 T_kv_119
  s_branch T_kvb_112
T_slow_114:
  s_nop 7
  v_max3_f32 v100, v16, v17, v18
  v_max3_f32 v100, v100, v19, v20
  v_max3_f32 v100, v100, v21, v22
  v_max3_f32 v100, v100, v23, v112
  v_max3_f32 v100, v100, v113, v114
  v_max_f32 v100, v100, v115
  v_mov_b32 v101, v100
  s_nop 1
  v_permlane32_swap_b32 v100, v101
  s_nop 1
  v_max_f32 v100, v100, v101
  v_mov_b32 v101, v100
  s_nop 1
  v_permlane16_swap_b32 v100, v101
  s_nop 1
  v_max_f32 v100, v100, v101
  v_sub_f32 v16, v16, v100
  v_sub_f32 v17, v17, v100
  v_sub_f32 v18, v18, v100
  v_sub_f32 v19, v19, v100
  v_exp_f32 v16, v16
  v_exp_f32 v17, v17
  v_exp_f32 v18, v18
  v_exp_f32 v19, v19
  v_sub_f32 v20, v20, v100
  v_sub_f32 v21, v21, v100
  v_sub_f32 v22, v22, v100
  v_sub_f32 v23, v23, v100
  v_exp_f32 v20, v20
  v_exp_f32 v21, v21
  v_exp_f32 v22, v22
  v_exp_f32 v23, v23
  v_sub_f32 v112, v112, v100
  v_sub_f32 v113, v113, v100
  v_sub_f32 v114, v114, v100
  v_sub_f32 v115, v115, v100
  v_exp_f32 v112, v112
  v_exp_f32 v113, v113
  v_exp_f32 v114, v114
  v_exp_f32 v115, v115
  s_nop 0
  v_cvt_pk_bf16_f32 v44, v16, v17
  v_cvt_pk_bf16_f32 v45, v18, v19
  v_cvt_pk_bf16_f32 v46, v20, v21
  v_cvt_pk_bf16_f32 v47, v22, v23
  v_cvt_pk_bf16_f32 v84, v112, v113
  v_cvt_pk_bf16_f32 v85, v114, v115
  v_cndmask_b32 v48, v84, 0, s[16:17]
  v_cndmask_b32 v49, v85, 0, s[16:17]
  v_cndmask_b32 v50, 0, v84, s[16:17]
  v_cndmask_b32 v51, 0, v85, s[16:17]
  s_nop 1
  v_mfma_f32_16x16x16_bf16 v[88:91], v[12:13], v[48:49], 0
  v_mfma_f32_16x16x16_bf16 v[24:27], v[120:121], v[48:49], 0
  v_mfma_f32_16x16x16_bf16 v[116:119], v[120:121], v[50:51], 0
  v_mfma_f32_16x16x32_bf16 v[88:91], v[12:15], v[44:47], v[88:91]
  v_mfma_f32_16x16x32_bf16 v[24:27], v[28:31], v[44:47], v[24:27]
  v_mfma_f32_16x16x32_bf16 v[116:119], v[32:35], v[44:47], v[116:119]
  s_nop 7
  s_nop 1
  v_rcp_f32 v89, v88
  s_nop 0
  v_mul_f32 v24, v89, v24
  v_mul_f32 v25, v89, v25
  s_branch T_back_115
T_w_91:
  s_mov_b32 s19, 0
  v_mov_b64 v[16:17], 0
  v_mov_b64 v[18:19], 0
  v_mov_b64 v[20:21], 0
  v_mov_b64 v[22:23], 0
  v_mov_b64 v[24:25], 0
  v_mov_b64 v[26:27], 0
  buffer_load_dwordx4 v[124:127], v2, s[4:7], s24 offen offset:2048 sc1
  buffer_load_dwordx4 v[116:119], v2, s[4:7], s25 offen offset:2048 sc1
  buffer_load_dwordx4 v[124:127], v2, s[4:7], s24 offen offset:2048 sc1
  buffer_load_dwordx4 v[116:119], v2, s[4:7], s25 offen offset:2048 sc1
  s_branch T_loop_121
.p2align 6
T_retry_122:
  s_mov_b64 exec, vcc
  buffer_load_dwordx4 v[124:127], v2, s[4:7], s24 offen offset:2048 sc1
  buffer_load_dwordx4 v[116:119], v2, s[4:7], s25 offen offset:2048 sc1
  s_mov_b64 exec, -1
  s_add_u32 s19, s19, 1
  s_cmp_gt_u32 s19, 32768
  s_cbranch_scc1 M_exit
T_loop_121:
  s_waitcnt vmcnt(3) lgkmcnt(0)
  v_max3_u32 v123, v124, v125, v126
  v_max_u32 v123, v123, v127
  v_mov_b32_dpp v120, v124 row_ror:8 row_mask:0xf bank_mask:0xf
  v_mov_b32_dpp v121, v125 row_ror:8 row_mask:0xf bank_mask:0xf
  s_waitcnt vmcnt(2)
  v_max3_u32 v123, v123, v116, v117
  v_max3_u32 v123, v123, v118, v119
  v_cmp_eq_u32 vcc, -1, v123
  s_cbranch_vccnz T_retry_122
  v_smfmac_f32_16x16x64_bf16 v[16:19], v[124:127], v[68:75], v0
  s_add_u32 s14, s14, 1
  ds_write_b128 v2, v[124:127] offset:2048
  v_mov_b32_dpp v122, v126 row_ror:8 row_mask:0xf bank_mask:0xf
  v_smfmac_f32_16x16x64_bf16 v[20:23], v[124:127], v[76:83], v0
  s_and_b32 s57, s14, 1
  v_mov_b32_dpp v123, v127 row_ror:8 row_mask:0xf bank_mask:0xf
  v_smfmac_f32_16x16x64_bf16 v[24:27], v[124:127], v[84:91], v0
  s_and_b32 s36, s14, 3
  ds_write_b128 v2, v[116:119] offset:6144
  v_smfmac_f32_16x16x64_bf16 v[16:19], v[120:123], v[92:99], v0
  s_lshl_b32 s36, s36, 13
  v_mov_b32_dpp v84, v116 row_ror:8 row_mask:0xf bank_mask:0xf
  v_smfmac_f32_16x16x64_bf16 v[20:23], v[120:123], v[100:107], v0
  s_add_u32 s26, s36, s23
  ds_read_b128 v[68:71], v4 offset:12288
  v_mov_b32_dpp v85, v117 row_ror:8 row_mask:0xf bank_mask:0xf
  v_smfmac_f32_16x16x64_bf16 v[24:27], v[120:123], v[108:115], v0
  s_add_u32 s36, s36, 8192
  ds_read_b128 v[72:75], v4 offset:13312
  v_mov_b32_dpp v86, v118 row_ror:8 row_mask:0xf bank_mask:0xf
  v_smfmac_f32_16x16x64_bf16 v[16:19], v[116:119], v[224:231], v0
  s_and_b32 s36, s36, 0x7fff
  ds_read_b128 v[76:79], v4 offset:14336
  v_mov_b32_dpp v87, v119 row_ror:8 row_mask:0xf bank_mask:0xf
  v_smfmac_f32_16x16x64_bf16 v[20:23], v[116:119], v[240:247], v0
  s_waitcnt lgkmcnt(3)
  s_barrier
  ds_read_b128 v[100:103], v2 offset:3072
  v_smfmac_f32_16x16x64_bf16 v[24:27], v[116:119], a[0:7], v0
  s_mov_b32 m0, s31
  ds_read_b128 v[120:123], v1 offset:3072
  v_smfmac_f32_16x16x64_bf16 v[16:19], v[84:87], v[232:239], v0
  s_cmp_ge_i32 s14, s30
  s_cbranch_scc1 T_kvw_125
T_kvb_126:
  v_smfmac_f32_16x16x64_bf16 v[20:23], v[84:87], v[248:255], v0
  ds_read_b128 v[80:83], v4 offset:15360
  v_smfmac_f32_16x16x64_bf16 v[24:27], v[84:87], a[8:15], v0
  s_waitcnt lgkmcnt(2)
  v_smfmac_f32_16x16x64_bf16 v[16:19], v[100:103], v[128:135], v0
  ds_read_b128 v[92:95], v2 offset:0
  buffer_load_dwordx4 v9, s[4:7], s27 offen sc1 lds
  v_smfmac_f32_16x16x64_bf16 v[20:23], v[100:103], v[144:151], v0
  ds_read_b128 v[96:99], v1 offset:0
  s_mov_b32 m0, s32
  v_smfmac_f32_16x16x64_bf16 v[24:27], v[100:103], v[68:75], v0
  s_waitcnt vmcnt(1) lgkmcnt(3)
  ds_read_b128 v[116:119], v2 offset:1024
  v_smfmac_f32_16x16x64_bf16 v[16:19], v[120:123], v[136:143], v0
  ds_read_b128 v[124:127], v1 offset:1024
  v_smfmac_f32_16x16x64_bf16 v[20:23], v[120:123], v[152:159], v0
  s_waitcnt lgkmcnt(4)
  ds_read_b128 v[104:107], v2 offset:7168
  buffer_load_dwordx4 v9, s[4:7], s27 offen offset:128 sc1 lds
  v_smfmac_f32_16x16x64_bf16 v[24:27], v[120:123], v[76:83], v0
  s_waitcnt lgkmcnt(4)
  ds_read_b128 v[108:111], v1 offset:7168
  s_mov_b32 m0, s33
  v_smfmac_f32_16x16x64_bf16 v[16:19], v[92:95], v[160:167], v0
  s_waitcnt lgkmcnt(4)
  ds_read_b128 v[112:115], v2 offset:4096
  v_mov_b32 v122, s98
  v_smfmac_f32_16x16x64_bf16 v[16:19], v[96:99], v[168:175], v0
  s_waitcnt lgkmcnt(4)
  ds_read_b128 v[84:87], v1 offset:4096
  v_smfmac_f32_16x16x64_bf16 v[16:19], v[116:119], v[192:199], v0
  s_waitcnt lgkmcnt(4)
  ds_read_b128 v[88:91], v2 offset:5120
  buffer_load_dwordx4 v10, s[4:7], s28 offen sc1 lds
  v_smfmac_f32_16x16x64_bf16 v[16:19], v[124:127], v[200:207], v0
  s_waitcnt lgkmcnt(4)
  ds_read_b128 v[100:103], v1 offset:5120
  s_mov_b32 m0, s34
  v_smfmac_f32_16x16x64_bf16 v[16:19], v[104:107], a[16:23], v0
  s_waitcnt lgkmcnt(4)
  ds_read_b128 v[68:71], v4 offset:16384
  v_smfmac_f32_16x16x64_bf16 v[16:19], v[108:111], a[24:31], v0
  s_waitcnt lgkmcnt(4)
  ds_read_b128 v[72:75], v4 offset:17408
  v_smfmac_f32_16x16x64_bf16 v[16:19], v[112:115], a[64:71], v0
  s_waitcnt lgkmcnt(4)
  ds_read_b128 v[76:79], v4 offset:18432
  buffer_load_dwordx4 v10, s[4:7], s28 offen offset:256 sc1 lds
  v_smfmac_f32_16x16x64_bf16 v[16:19], v[84:87], a[72:79], v0
  s_waitcnt lgkmcnt(4)
  ds_read_b128 v[80:83], v4 offset:19456
  v_smfmac_f32_16x16x64_bf16 v[16:19], v[88:91], a[112:119], v0
  s_waitcnt lgkmcnt(4)
  v_smfmac_f32_16x16x64_bf16 v[16:19], v[100:103], a[120:127], v0
  s_add_u32 s24, s36, 145752064
  s_add_u32 s25, s36, 145756160
  v_smfmac_f32_16x16x64_bf16 v[20:23], v[92:95], v[176:183], v0
  buffer_store_dword v122, v3, s[4:7], s15 offen sc1
  s_add_u32 s35, s36, s23
  v_smfmac_f32_16x16x64_bf16 v[20:23], v[96:99], v[184:191], v0
  s_waitcnt lgkmcnt(2)
  s_add_u32 s98, s14, 1
  v_smfmac_f32_16x16x64_bf16 v[20:23], v[116:119], v[68:75], v0
  s_waitcnt lgkmcnt(0)
  ds_read_b128 v[68:71], v4 offset:20480
  v_mul_f32 v16, s18, v16
  v_smfmac_f32_16x16x64_bf16 v[20:23], v[124:127], v[76:83], v0
  ds_read_b128 v[72:75], v4 offset:21504
  v_mul_f32 v17, s18, v17
  v_smfmac_f32_16x16x64_bf16 v[20:23], v[104:107], a[32:39], v0
  ds_read_b128 v[76:79], v4 offset:22528
  v_mul_f32 v18, s18, v18
  v_smfmac_f32_16x16x64_bf16 v[20:23], v[108:111], a[40:47], v0
  ds_read_b128 v[80:83], v4 offset:23552
  v_mul_f32 v19, s18, v19
  v_smfmac_f32_16x16x64_bf16 v[20:23], v[112:115], a[80:87], v0
  v_cvt_pk_bf16_f32 v120, v16, v17
  v_smfmac_f32_16x16x64_bf16 v[20:23], v[84:87], a[88:95], v0
  v_cvt_pk_bf16_f32 v121, v18, v19
  v_smfmac_f32_16x16x64_bf16 v[20:23], v[88:91], a[128:135], v0
  ds_write_b64 v5, v[120:121] offset:24576
  v_smfmac_f32_16x16x64_bf16 v[20:23], v[100:103], a[136:143], v0
  s_waitcnt lgkmcnt(3)
  v_smfmac_f32_16x16x64_bf16 v[24:27], v[92:95], v[68:75], v0
  s_waitcnt lgkmcnt(1)
  v_mov_b64 v[92:93], 0
  v_smfmac_f32_16x16x64_bf16 v[24:27], v[96:99], v[76:83], v0
  s_nop 1
  v_cvt_pk_bf16_f32 v122, v20, v21
  v_cvt_pk_bf16_f32 v123, v22, v23
  v_smfmac_f32_16x16x64_bf16 v[24:27], v[116:119], v[208:215], v0
  ds_write_b64 v5, v[122:123] offset:26880
  v_mov_b64 v[94:95], 0
  v_smfmac_f32_16x16x64_bf16 v[24:27], v[124:127], v[216:223], v0
  s_waitcnt lgkmcnt(1)
  s_barrier
  ds_read_b64_tr_b16 v[68:69], v6 offset:24576
  v_smfmac_f32_16x16x64_bf16 v[24:27], v[104:107], a[48:55], v0
  s_add_u32 s27, s27, 8192
  ds_read_b64_tr_b16 v[70:71], v6 offset:24640
  ds_read_b64_tr_b16 v[72:73], v6 offset:24832
  v_smfmac_f32_16x16x64_bf16 v[24:27], v[108:111], a[56:63], v0
  s_add_u32 s28, s28, 8192
  ds_read_b64_tr_b16 v[74:75], v6 offset:24896
  ds_read_b64_tr_b16 v[76:77], v6 offset:25088
  v_smfmac_f32_16x16x64_bf16 v[24:27], v[112:115], a[96:103], v0
  s_nop 0
  ds_read_b64_tr_b16 v[78:79], v6 offset:25152
  ds_read_b64_tr_b16 v[80:81], v6 offset:25344
  v_smfmac_f32_16x16x64_bf16 v[24:27], v[84:87], a[104:111], v0
  ds_read_b64_tr_b16 v[82:83], v6 offset:25408
  v_mov_b64 v[96:97], 0
  v_smfmac_f32_16x16x64_bf16 v[24:27], v[88:91], a[144:151], v0
  s_waitcnt lgkmcnt(8)
  s_barrier
  ds_read_b64_tr_b16 v[116:117], v6 offset:26880
  v_smfmac_f32_16x16x64_bf16 v[24:27], v[100:103], a[152:159], v0
  s_waitcnt lgkmcnt(7)
  ds_read_b64_tr_b16 v[118:119], v6 offset:26944
  v_mfma_f32_16x16x32_bf16 v[16:19], v[36:39], v[68:71], 0
  s_waitcnt lgkmcnt(6)
  ds_read_b64_tr_b16 v[124:125], v6 offset:27136
  ds_read_b64_tr_b16 v[126:127], v6 offset:27200
  v_mfma_f32_16x16x32_bf16 v[16:19], v[40:43], v[72:75], v[16:19]
  s_waitcnt lgkmcnt(6)
  ds_read_b64_tr_b16 v[104:105], v6 offset:27392
  ds_read_b64_tr_b16 v[106:107], v6 offset:27456
  v_mfma_f32_16x16x32_bf16 v[16:19], v[44:47], v[76:79], v[16:19]
  s_waitcnt lgkmcnt(6)
  ds_read_b64_tr_b16 v[108:109], v6 offset:27648
  ds_read_b64_tr_b16 v[110:111], v6 offset:27712
  v_mfma_f32_16x16x32_bf16 v[16:19], v[48:51], v[80:83], v[16:19]
  s_waitcnt lgkmcnt(6)
  v_cvt_pk_bf16_f32 v120, v24, v25
  v_cvt_pk_bf16_f32 v121, v26, v27
  v_mfma_f32_16x16x32_bf16 v[112:115], v[116:119], v[68:71], 0
  s_waitcnt lgkmcnt(4)
  v_mov_b64 v[98:99], 0
  v_mfma_f32_16x16x32_bf16 v[112:115], v[124:127], v[72:75], v[112:115]
  s_waitcnt lgkmcnt(2)
  v_mov_b64 v[36:37], 0
  v_exp_f32 v100, v16
  v_mfma_f32_16x16x32_bf16 v[112:115], v[104:107], v[76:79], v[112:115]
  s_waitcnt lgkmcnt(0)
  buffer_store_dwordx4 v[120:123], v2, s[4:7], s29 offen offset:2048 sc1
  v_exp_f32 v101, v17
  v_mfma_f32_16x16x32_bf16 v[112:115], v[108:111], v[80:83], v[112:115]
  v_exp_f32 v102, v18
  v_mfma_f32_16x16x32_bf16 v[20:23], v[52:55], v[68:71], 0
  s_cmp_eq_u32 s14, 63
  v_exp_f32 v103, v19
  v_mfma_f32_16x16x32_bf16 v[20:23], v[56:59], v[72:75], v[20:23]
  s_cbranch_scc1 M_tdone
  v_cvt_pk_bf16_f32 v44, v100, v101
  v_cvt_pk_bf16_f32 v45, v102, v103
  v_mfma_f32_16x16x32_bf16 v[20:23], v[60:63], v[76:79], v[20:23]
  s_add_u32 s29, s29, 131072
  v_exp_f32 v100, v112
  v_mfma_f32_16x16x32_bf16 v[20:23], v[64:67], v[80:83], v[20:23]
  v_exp_f32 v101, v113
  v_exp_f32 v102, v114
  v_exp_f32 v103, v115
  v_cvt_pk_bf16_f32 v84, v100, v101
  v_cvt_pk_bf16_f32 v85, v102, v103
  v_cndmask_b32 v48, v84, 0, s[16:17]
  v_cndmask_b32 v49, v85, 0, s[16:17]
  v_cndmask_b32 v50, 0, v84, s[16:17]
  v_cndmask_b32 v51, 0, v85, s[16:17]
  v_exp_f32 v100, v20
  v_mfma_f32_16x16x16_bf16 v[88:91], v[12:13], v[48:49], 0
  v_exp_f32 v101, v21
  v_mfma_f32_16x16x16_bf16 v[24:27], v[120:121], v[48:49], 0
  v_exp_f32 v102, v22
  v_mfma_f32_16x16x16_bf16 v[116:119], v[120:121], v[50:51], 0
  v_exp_f32 v103, v23
  v_cvt_pk_bf16_f32 v46, v100, v101
  v_cvt_pk_bf16_f32 v47, v102, v103
  v_mov_b64 v[38:39], 0
  s_nop 0
  v_mfma_f32_16x16x32_bf16 v[88:91], v[12:15], v[44:47], v[88:91]
  v_mov_b64 v[40:41], 0
  v_mov_b64 v[42:43], 0
  v_mfma_f32_16x16x32_bf16 v[24:27], v[28:31], v[44:47], v[24:27]
  ds_read_b128 v[52:55], v4 offset:24576
  ds_read_b128 v[56:59], v4 offset:25600
  v_mfma_f32_16x16x32_bf16 v[116:119], v[32:35], v[44:47], v[116:119]
  s_nop 1
  v_rcp_f32 v89, v88
  v_subrev_u32 v100, s54, v88
  v_cmp_le_u32 vcc, s55, v100
  v_mul_f32 v24, v89, v24
  v_mul_f32 v25, v89, v25
  s_cbranch_vccnz T_slow_128
T_back_129:
  v_cvt_pk_bf16_f32 v124, v24, v25
  v_pk_mul_f32 v[26:27], v[26:27], v[88:89] op_sel:[0,1] op_sel_hi:[1,1]
  v_pk_mul_f32 v[116:117], v[116:117], v[88:89] op_sel:[0,1] op_sel_hi:[1,1]
  v_pk_mul_f32 v[118:119], v[118:119], v[88:89] op_sel:[0,1] op_sel_hi:[1,1]
  v_cvt_pk_bf16_f32 v125, v26, v27
  v_cvt_pk_bf16_f32 v126, v116, v117
  v_cvt_pk_bf16_f32 v127, v118, v119
  ds_write_b128 v11, v[124:127] offset:30208
  s_nop 0
  v_smfmac_f32_16x16x64_bf16 v[92:95], v[124:127], a[160:167], v0
  v_smfmac_f32_16x16x64_bf16 v[96:99], v[124:127], a[168:175], v0
  v_smfmac_f32_16x16x64_bf16 v[36:39], v[124:127], a[176:183], v0
  v_smfmac_f32_16x16x64_bf16 v[40:43], v[124:127], a[184:191], v0
  s_waitcnt lgkmcnt(0)
  s_barrier
  ds_read_b128 v[104:107], v11 offset:30720
  ds_read_b128 v[108:111], v11 offset:29184
  ds_read_b128 v[68:71], v11 offset:29696
  s_waitcnt lgkmcnt(2)
  v_smfmac_f32_16x16x64_bf16 v[92:95], v[104:107], a[192:199], v0
  s_waitcnt lgkmcnt(1)
  ds_read_b128 v[76:79], v4 offset:28672
  v_smfmac_f32_16x16x64_bf16 v[92:95], v[108:111], a[224:231], v0
  s_waitcnt lgkmcnt(1)
  ds_read_b128 v[80:83], v4 offset:29696
  v_smfmac_f32_16x16x64_bf16 v[92:95], v[68:71], a[240:247], v0
  ds_read_b128 v[60:63], v4 offset:26624
  v_smfmac_f32_16x16x64_bf16 v[96:99], v[104:107], a[200:207], v0
  ds_read_b128 v[64:67], v4 offset:27648
  v_smfmac_f32_16x16x64_bf16 v[96:99], v[108:111], a[232:239], v0
  ds_read_b128 v[28:31], v4 offset:30720
  s_nop 0
  v_cvt_pk_bf16_f32 v16, v92, v93
  v_cvt_pk_bf16_f32 v17, v94, v95
  v_bfi_b32 v16, 1, s57, v16
  v_smfmac_f32_16x16x64_bf16 v[96:99], v[68:71], a[248:255], v0
  buffer_store_dwordx2 v[16:17], v7, s[4:7], s20 offen offset:0
  v_smfmac_f32_16x16x64_bf16 v[36:39], v[104:107], a[208:215], v0
  ds_read_b128 v[32:35], v4 offset:31744
  v_smfmac_f32_16x16x64_bf16 v[36:39], v[108:111], v[52:59], v0
  s_waitcnt lgkmcnt(4)
  s_nop 0
  v_cvt_pk_bf16_f32 v18, v96, v97
  v_cvt_pk_bf16_f32 v19, v98, v99
  v_bfi_b32 v18, 1, s57, v18
  v_smfmac_f32_16x16x64_bf16 v[36:39], v[68:71], v[76:83], v0
  buffer_store_dwordx2 v[18:19], v7, s[4:7], s20 offen offset:64
  v_smfmac_f32_16x16x64_bf16 v[40:43], v[104:107], a[216:223], v0
  s_waitcnt lgkmcnt(2)
  v_smfmac_f32_16x16x64_bf16 v[40:43], v[108:111], v[60:67], v0
  s_waitcnt lgkmcnt(0)
  s_nop 0
  v_cvt_pk_bf16_f32 v20, v36, v37
  v_cvt_pk_bf16_f32 v21, v38, v39
  v_bfi_b32 v20, 1, s57, v20
  v_smfmac_f32_16x16x64_bf16 v[40:43], v[68:71], v[28:35], v0
  buffer_store_dwordx2 v[20:21], v7, s[4:7], s21 offen offset:0
  s_nop 6
  v_cvt_pk_bf16_f32 v22, v40, v41
  v_cvt_pk_bf16_f32 v23, v42, v43
  v_bfi_b32 v22, 1, s57, v22
  buffer_store_dwordx2 v[22:23], v7, s[4:7], s21 offen offset:64
  ds_read_b128 v[68:71], v4 offset:0
  ds_read_b128 v[72:75], v4 offset:1024
  ds_read_b128 v[76:79], v4 offset:4096
  ds_read_b128 v[80:83], v4 offset:5120
  ds_read_b128 v[84:87], v4 offset:8192
  ds_read_b128 v[88:91], v4 offset:9216
  ds_read_b128 v[92:95], v4 offset:2048
  ds_read_b128 v[96:99], v4 offset:3072
  ds_read_b128 v[100:103], v4 offset:6144
  ds_read_b128 v[104:107], v4 offset:7168
  ds_read_b128 v[108:111], v4 offset:10240
  ds_read_b128 v[112:115], v4 offset:11264
  v_mov_b64 v[16:17], 0
  v_mov_b64 v[18:19], 0
  v_mov_b64 v[20:21], 0
  v_mov_b64 v[22:23], 0
  v_mov_b64 v[24:25], 0
  v_mov_b64 v[26:27], 0
  ds_read_b64 v[44:45], v2 offset:32256
  s_waitcnt lgkmcnt(0)
  v_readfirstlane_b32 s38, v44
  v_readfirstlane_b32 s37, v45
  s_nop 0
  s_add_u32 s37, s37, 30
  s_cmp_ge_u32 s38, 30
  s_cselect_b32 s38, s37, s38
  s_cmp_ge_u32 s38, 64
  s_cselect_b32 s38, 100, s38
  s_sub_u32 s38, s38, 1
  s_max_i32 s30, s30, s38
  s_waitcnt vmcnt(4)
  s_barrier
  ds_read_b128 v[28:31], v2 offset:18432
  ds_read_b128 v[32:35], v2 offset:22528
  ds_read_b128 v[36:39], v2 offset:8192
  ds_read_b128 v[40:43], v2 offset:9216
  ds_read_b128 v[44:47], v2 offset:10240
  ds_read_b128 v[48:51], v2 offset:11264
  buffer_load_dwordx4 v[124:127], v2, s[4:7], s24 offen offset:2048 sc1
  buffer_load_dwordx4 v[116:119], v2, s[4:7], s25 offen offset:2048 sc1
  ds_read_b128 v[52:55], v2 offset:12288
  ds_read_b128 v[56:59], v2 offset:13312
  ds_read_b128 v[60:63], v2 offset:14336
  ds_read_b128 v[64:67], v2 offset:15360
  buffer_load_dwordx4 v[124:127], v2, s[4:7], s24 offen offset:2048 sc1
  buffer_load_dwordx4 v[116:119], v2, s[4:7], s25 offen offset:2048 sc1
  s_mov_b32 s19, 0
  s_branch T_loop_121
T_kvw_125:
  s_mov_b32 s19, 0
  s_branch T_kvok_134
T_kv_133:
  s_sleep 4
  s_add_u32 s19, s19, 1
  s_cmp_gt_u32 s19, 32768
  s_cbranch_scc1 M_exit
T_kvok_134:
  s_add_u32 s39, s99, 128
  s_mov_b32 s38, 0
  s_mov_b32 s37, 0
  s_atomic_or s38, s[58:59], s99 glc
  s_atomic_or s37, s[58:59], s39 glc
  s_waitcnt lgkmcnt(0)
  s_add_u32 s37, s37, 30
  s_cmp_ge_u32 s38, 30
  s_cselect_b32 s38, s37, s38
  s_cmp_ge_u32 s38, 64
  s_cselect_b32 s38, 100, s38
  s_sub_u32 s38, s38, 1
  s_max_i32 s30, s30, s38
  s_cmp_ge_i32 s14, s30
  s_cbranch_scc1 T_kv_133
  s_branch T_kvb_126
T_slow_128:
  s_nop 7
  v_max3_f32 v100, v16, v17, v18
  v_max3_f32 v100, v100, v19, v20
  v_max3_f32 v100, v100, v21, v22
  v_max3_f32 v100, v100, v23, v112
  v_max3_f32 v100, v100, v113, v114
  v_max_f32 v100, v100, v115
  v_mov_b32 v101, v100
  s_nop 1
  v_permlane32_swap_b32 v100, v101
  s_nop 1
  v_max_f32 v100, v100, v101
  v_mov_b32 v101, v100
  s_nop 1
  v_permlane16_swap_b32 v100, v101
  s_nop 1
  v_max_f32 v100, v100, v101
  v_sub_f32 v16, v16, v100
  v_sub_f32 v17, v17, v100
  v_sub_f32 v18, v18, v100
  v_sub_f32 v19, v19, v100
  v_exp_f32 v16, v16
  v_exp_f32 v17, v17
  v_exp_f32 v18, v18
  v_exp_f32 v19, v19
  v_sub_f32 v20, v20, v100
  v_sub_f32 v21, v21, v100
  v_sub_f32 v22, v22, v100
  v_sub_f32 v23, v23, v100
  v_exp_f32 v20, v20
  v_exp_f32 v21, v21
  v_exp_f32 v22, v22
  v_exp_f32 v23, v23
  v_sub_f32 v112, v112, v100
  v_sub_f32 v113, v113, v100
  v_sub_f32 v114, v114, v100
  v_sub_f32 v115, v115, v100
  v_exp_f32 v112, v112
  v_exp_f32 v113, v113
  v_exp_f32 v114, v114
  v_exp_f32 v115, v115
  s_nop 0
  v_cvt_pk_bf16_f32 v44, v16, v17
  v_cvt_pk_bf16_f32 v45, v18, v19
  v_cvt_pk_bf16_f32 v46, v20, v21
  v_cvt_pk_bf16_f32 v47, v22, v23
  v_cvt_pk_bf16_f32 v84, v112, v113
  v_cvt_pk_bf16_f32 v85, v114, v115
  v_cndmask_b32 v48, v84, 0, s[16:17]
  v_cndmask_b32 v49, v85, 0, s[16:17]
  v_cndmask_b32 v50, 0, v84, s[16:17]
  v_cndmask_b32 v51, 0, v85, s[16:17]
  s_nop 1
  v_mfma_f32_16x16x16_bf16 v[88:91], v[12:13], v[48:49], 0
  v_mfma_f32_16x16x16_bf16 v[24:27], v[120:121], v[48:49], 0
  v_mfma_f32_16x16x16_bf16 v[116:119], v[120:121], v[50:51], 0
  v_mfma_f32_16x16x32_bf16 v[88:91], v[12:15], v[44:47], v[88:91]
  v_mfma_f32_16x16x32_bf16 v[24:27], v[28:31], v[44:47], v[24:27]
  v_mfma_f32_16x16x32_bf16 v[116:119], v[32:35], v[44:47], v[116:119]
  s_nop 7
  s_nop 1
  v_rcp_f32 v89, v88
  s_nop 0
  v_mul_f32 v24, v89, v24
  v_mul_f32 v25, v89, v25
  s_branch T_back_129
T_w_92:
  s_mov_b32 s19, 0
  v_mov_b64 v[16:17], 0
  v_mov_b64 v[18:19], 0
  v_mov_b64 v[20:21], 0
  v_mov_b64 v[22:23], 0
  v_mov_b64 v[24:25], 0
  v_mov_b64 v[26:27], 0
  buffer_load_dwordx4 v[124:127], v2, s[4:7], s24 offen offset:3072 sc1
  buffer_load_dwordx4 v[116:119], v2, s[4:7], s25 offen offset:3072 sc1
  buffer_load_dwordx4 v[124:127], v2, s[4:7], s24 offen offset:3072 sc1
  buffer_load_dwordx4 v[116:119], v2, s[4:7], s25 offen offset:3072 sc1
  s_branch T_loop_135
.p2align 6
T_retry_136:
  s_mov_b64 exec, vcc
  buffer_load_dwordx4 v[124:127], v2, s[4:7], s24 offen offset:3072 sc1
  buffer_load_dwordx4 v[116:119], v2, s[4:7], s25 offen offset:3072 sc1
  s_mov_b64 exec, -1
  s_add_u32 s19, s19, 1
  s_cmp_gt_u32 s19, 32768
  s_cbranch_scc1 M_exit
T_loop_135:
  s_waitcnt vmcnt(3) lgkmcnt(0)
  v_max3_u32 v123, v124, v125, v126
  v_max_u32 v123, v123, v127
  v_mov_b32_dpp v120, v124 row_ror:8 row_mask:0xf bank_mask:0xf
  v_mov_b32_dpp v121, v125 row_ror:8 row_mask:0xf bank_mask:0xf
  s_waitcnt vmcnt(2)
  v_max3_u32 v123, v123, v116, v117
  v_max3_u32 v123, v123, v118, v119
  v_cmp_eq_u32 vcc, -1, v123
  s_cbranch_vccnz T_retry_136
  v_smfmac_f32_16x16x64_bf16 v[16:19], v[124:127], v[68:75], v0
  s_add_u32 s14, s14, 1
  ds_write_b128 v2, v[124:127] offset:3072
  v_mov_b32_dpp v122, v126 row_ror:8 row_mask:0xf bank_mask:0xf
  v_smfmac_f32_16x16x64_bf16 v[20:23], v[124:127], v[76:83], v0
  s_and_b32 s57, s14, 1
  v_mov_b32_dpp v123, v127 row_ror:8 row_mask:0xf bank_mask:0xf
  v_smfmac_f32_16x16x64_bf16 v[24:27], v[124:127], v[84:91], v0
  s_and_b32 s36, s14, 3
  ds_write_b128 v2, v[116:119] offset:7168
  v_smfmac_f32_16x16x64_bf16 v[16:19], v[120:123], v[92:99], v0
  s_lshl_b32 s36, s36, 13
  v_mov_b32_dpp v84, v116 row_ror:8 row_mask:0xf bank_mask:0xf
  v_smfmac_f32_16x16x64_bf16 v[20:23], v[120:123], v[100:107], v0
  s_add_u32 s26, s36, s23
  ds_read_b128 v[68:71], v4 offset:12288
  v_mov_b32_dpp v85, v117 row_ror:8 row_mask:0xf bank_mask:0xf
  v_smfmac_f32_16x16x64_bf16 v[24:27], v[120:123], v[108:115], v0
  s_add_u32 s36, s36, 8192
  ds_read_b128 v[72:75], v4 offset:13312
  v_mov_b32_dpp v86, v118 row_ror:8 row_mask:0xf bank_mask:0xf
  v_smfmac_f32_16x16x64_bf16 v[16:19], v[116:119], v[224:231], v0
  s_and_b32 s36, s36, 0x7fff
  ds_read_b128 v[76:79], v4 offset:14336
  v_mov_b32_dpp v87, v119 row_ror:8 row_mask:0xf bank_mask:0xf
  v_smfmac_f32_16x16x64_bf16 v[20:23], v[116:119], v[240:247], v0
  s_waitcnt lgkmcnt(3)
  s_barrier
  ds_read_b128 v[100:103], v2 offset:2048
  v_smfmac_f32_16x16x64_bf16 v[24:27], v[116:119], a[0:7], v0
  s_mov_b32 m0, s31
  ds_read_b128 v[120:123], v1 offset:2048
  v_smfmac_f32_16x16x64_bf16 v[16:19], v[84:87], v[232:239], v0
  s_cmp_ge_i32 s14, s30
  s_cbranch_scc1 T_kvw_139
T_kvb_140:
  v_smfmac_f32_16x16x64_bf16 v[20:23], v[84:87], v[248:255], v0
  ds_read_b128 v[80:83], v4 offset:15360
  v_smfmac_f32_16x16x64_bf16 v[24:27], v[84:87], a[8:15], v0
  s_waitcnt lgkmcnt(2)
  v_smfmac_f32_16x16x64_bf16 v[16:19], v[100:103], v[128:135], v0
  ds_read_b128 v[92:95], v2 offset:1024
  v_smfmac_f32_16x16x64_bf16 v[20:23], v[100:103], v[144:151], v0
  ds_read_b128 v[96:99], v1 offset:1024
  buffer_load_dwordx4 v9, s[4:7], s27 offen sc1 lds
  v_smfmac_f32_16x16x64_bf16 v[24:27], v[100:103], v[68:75], v0
  s_waitcnt vmcnt(1) lgkmcnt(3)
  ds_read_b128 v[116:119], v2 offset:0
  s_mov_b32 m0, s32
  v_smfmac_f32_16x16x64_bf16 v[16:19], v[120:123], v[136:143], v0
  ds_read_b128 v[124:127], v1 offset:0
  v_smfmac_f32_16x16x64_bf16 v[20:23], v[120:123], v[152:159], v0
  s_waitcnt lgkmcnt(4)
  ds_read_b128 v[104:107], v2 offset:6144
  v_smfmac_f32_16x16x64_bf16 v[24:27], v[120:123], v[76:83], v0
  s_waitcnt lgkmcnt(4)
  ds_read_b128 v[108:111], v1 offset:6144
  buffer_load_dwordx4 v9, s[4:7], s27 offen offset:128 sc1 lds
  v_smfmac_f32_16x16x64_bf16 v[16:19], v[92:95], v[160:167], v0
  s_waitcnt lgkmcnt(4)
  ds_read_b128 v[112:115], v2 offset:5120
  s_mov_b32 m0, s33
  v_smfmac_f32_16x16x64_bf16 v[16:19], v[96:99], v[168:175], v0
  s_waitcnt lgkmcnt(4)
  ds_read_b128 v[84:87], v1 offset:5120
  v_smfmac_f32_16x16x64_bf16 v[16:19], v[116:119], v[192:199], v0
  s_waitcnt lgkmcnt(4)
  ds_read_b128 v[88:91], v2 offset:4096
  v_smfmac_f32_16x16x64_bf16 v[16:19], v[124:127], v[200:207], v0
  s_waitcnt lgkmcnt(4)
  ds_read_b128 v[100:103], v1 offset:4096
  buffer_load_dwordx4 v10, s[4:7], s28 offen sc1 lds
  v_smfmac_f32_16x16x64_bf16 v[16:19], v[104:107], a[16:23], v0
  s_waitcnt lgkmcnt(4)
  ds_read_b128 v[68:71], v4 offset:16384
  s_mov_b32 m0, s34
  v_smfmac_f32_16x16x64_bf16 v[16:19], v[108:111], a[24:31], v0
  s_waitcnt lgkmcnt(4)
  ds_read_b128 v[72:75], v4 offset:17408
  v_smfmac_f32_16x16x64_bf16 v[16:19], v[112:115], a[64:71], v0
  s_waitcnt lgkmcnt(4)
  ds_read_b128 v[76:79], v4 offset:18432
  v_smfmac_f32_16x16x64_bf16 v[16:19], v[84:87], a[72:79], v0
  s_waitcnt lgkmcnt(4)
  ds_read_b128 v[80:83], v4 offset:19456
  buffer_load_dwordx4 v10, s[4:7], s28 offen offset:256 sc1 lds
  v_smfmac_f32_16x16x64_bf16 v[16:19], v[88:91], a[112:119], v0
  s_waitcnt lgkmcnt(4)
  s_mov_b32 m0, 32256
  v_smfmac_f32_16x16x64_bf16 v[16:19], v[100:103], a[120:127], v0
  s_add_u32 s24, s36, 145752064
  s_add_u32 s25, s36, 145756160
  v_smfmac_f32_16x16x64_bf16 v[20:23], v[92:95], v[176:183], v0
  s_add_u32 s35, s36, s23
  v_smfmac_f32_16x16x64_bf16 v[20:23], v[96:99], v[184:191], v0
  s_waitcnt lgkmcnt(2)
  buffer_load_dword v3, s[4:7], s99 offen sc1 lds
  v_smfmac_f32_16x16x64_bf16 v[20:23], v[116:119], v[68:75], v0
  s_waitcnt lgkmcnt(0)
  ds_read_b128 v[68:71], v4 offset:20480
  v_mul_f32 v16, s18, v16
  v_smfmac_f32_16x16x64_bf16 v[20:23], v[124:127], v[76:83], v0
  ds_read_b128 v[72:75], v4 offset:21504
  v_mul_f32 v17, s18, v17
  v_smfmac_f32_16x16x64_bf16 v[20:23], v[104:107], a[32:39], v0
  ds_read_b128 v[76:79], v4 offset:22528
  v_mul_f32 v18, s18, v18
  v_smfmac_f32_16x16x64_bf16 v[20:23], v[108:111], a[40:47], v0
  ds_read_b128 v[80:83], v4 offset:23552
  v_mul_f32 v19, s18, v19
  v_smfmac_f32_16x16x64_bf16 v[20:23], v[112:115], a[80:87], v0
  v_cvt_pk_bf16_f32 v120, v16, v17
  v_smfmac_f32_16x16x64_bf16 v[20:23], v[84:87], a[88:95], v0
  v_cvt_pk_bf16_f32 v121, v18, v19
  v_smfmac_f32_16x16x64_bf16 v[20:23], v[88:91], a[128:135], v0
  ds_write_b64 v5, v[120:121] offset:24576
  v_smfmac_f32_16x16x64_bf16 v[20:23], v[100:103], a[136:143], v0
  s_waitcnt lgkmcnt(3)
  v_smfmac_f32_16x16x64_bf16 v[24:27], v[92:95], v[68:75], v0
  s_waitcnt lgkmcnt(1)
  v_mov_b64 v[92:93], 0
  v_smfmac_f32_16x16x64_bf16 v[24:27], v[96:99], v[76:83], v0
  s_nop 1
  v_cvt_pk_bf16_f32 v122, v20, v21
  v_cvt_pk_bf16_f32 v123, v22, v23
  v_smfmac_f32_16x16x64_bf16 v[24:27], v[116:119], v[208:215], v0
  ds_write_b64 v5, v[122:123] offset:26880
  v_mov_b64 v[94:95], 0
  v_smfmac_f32_16x16x64_bf16 v[24:27], v[124:127], v[216:223], v0
  s_waitcnt lgkmcnt(1)
  s_barrier
  ds_read_b64_tr_b16 v[68:69], v6 offset:24576
  v_smfmac_f32_16x16x64_bf16 v[24:27], v[104:107], a[48:55], v0
  s_add_u32 s27, s27, 8192
  ds_read_b64_tr_b16 v[70:71], v6 offset:24640
  ds_read_b64_tr_b16 v[72:73], v6 offset:24832
  v_smfmac_f32_16x16x64_bf16 v[24:27], v[108:111], a[56:63], v0
  s_add_u32 s28, s28, 8192
  ds_read_b64_tr_b16 v[74:75], v6 offset:24896
  ds_read_b64_tr_b16 v[76:77], v6 offset:25088
  v_smfmac_f32_16x16x64_bf16 v[24:27], v[112:115], a[96:103], v0
  s_nop 0
  ds_read_b64_tr_b16 v[78:79], v6 offset:25152
  ds_read_b64_tr_b16 v[80:81], v6 offset:25344
  v_smfmac_f32_16x16x64_bf16 v[24:27], v[84:87], a[104:111], v0
  ds_read_b64_tr_b16 v[82:83], v6 offset:25408
  v_mov_b64 v[96:97], 0
  v_smfmac_f32_16x16x64_bf16 v[24:27], v[88:91], a[144:151], v0
  s_waitcnt lgkmcnt(8)
  s_barrier
  ds_read_b64_tr_b16 v[116:117], v6 offset:26880
  v_smfmac_f32_16x16x64_bf16 v[24:27], v[100:103], a[152:159], v0
  s_waitcnt lgkmcnt(7)
  ds_read_b64_tr_b16 v[118:119], v6 offset:26944
  v_mfma_f32_16x16x32_bf16 v[16:19], v[36:39], v[68:71], 0
  s_waitcnt lgkmcnt(6)
  ds_read_b64_tr_b16 v[124:125], v6 offset:27136
  ds_read_b64_tr_b16 v[126:127], v6 offset:27200
  v_mfma_f32_16x16x32_bf16 v[16:19], v[40:43], v[72:75], v[16:19]
  s_waitcnt lgkmcnt(6)
  ds_read_b64_tr_b16 v[104:105], v6 offset:27392
  ds_read_b64_tr_b16 v[106:107], v6 offset:27456
  v_mfma_f32_16x16x32_bf16 v[16:19], v[44:47], v[76:79], v[16:19]
  s_waitcnt lgkmcnt(6)
  ds_read_b64_tr_b16 v[108:109], v6 offset:27648
  ds_read_b64_tr_b16 v[110:111], v6 offset:27712
  v_mfma_f32_16x16x32_bf16 v[16:19], v[48:51], v[80:83], v[16:19]
  s_waitcnt lgkmcnt(6)
  v_cvt_pk_bf16_f32 v120, v24, v25
  v_cvt_pk_bf16_f32 v121, v26, v27
  v_mfma_f32_16x16x32_bf16 v[112:115], v[116:119], v[68:71], 0
  s_waitcnt lgkmcnt(4)
  v_mov_b64 v[98:99], 0
  v_mfma_f32_16x16x32_bf16 v[112:115], v[124:127], v[72:75], v[112:115]
  s_waitcnt lgkmcnt(2)
  v_mov_b64 v[36:37], 0
  v_exp_f32 v100, v16
  v_mfma_f32_16x16x32_bf16 v[112:115], v[104:107], v[76:79], v[112:115]
  s_waitcnt lgkmcnt(0)
  v_exp_f32 v101, v17
  v_mfma_f32_16x16x32_bf16 v[112:115], v[108:111], v[80:83], v[112:115]
  buffer_store_dwordx4 v[120:123], v2, s[4:7], s29 offen offset:3072 sc1
  v_exp_f32 v102, v18
  v_mfma_f32_16x16x32_bf16 v[20:23], v[52:55], v[68:71], 0
  s_cmp_eq_u32 s14, 63
  v_exp_f32 v103, v19
  v_mfma_f32_16x16x32_bf16 v[20:23], v[56:59], v[72:75], v[20:23]
  s_cbranch_scc1 M_tdone
  v_cvt_pk_bf16_f32 v44, v100, v101
  v_cvt_pk_bf16_f32 v45, v102, v103
  v_mfma_f32_16x16x32_bf16 v[20:23], v[60:63], v[76:79], v[20:23]
  s_add_u32 s29, s29, 131072
  v_exp_f32 v100, v112
  v_mfma_f32_16x16x32_bf16 v[20:23], v[64:67], v[80:83], v[20:23]
  v_exp_f32 v101, v113
  v_exp_f32 v102, v114
  v_exp_f32 v103, v115
  v_cvt_pk_bf16_f32 v84, v100, v101
  v_cvt_pk_bf16_f32 v85, v102, v103
  v_cndmask_b32 v48, v84, 0, s[16:17]
  v_cndmask_b32 v49, v85, 0, s[16:17]
  v_cndmask_b32 v50, 0, v84, s[16:17]
  v_cndmask_b32 v51, 0, v85, s[16:17]
  v_exp_f32 v100, v20
  v_mfma_f32_16x16x16_bf16 v[88:91], v[12:13], v[48:49], 0
  v_exp_f32 v101, v21
  v_mfma_f32_16x16x16_bf16 v[24:27], v[120:121], v[48:49], 0
  v_exp_f32 v102, v22
  v_mfma_f32_16x16x16_bf16 v[116:119], v[120:121], v[50:51], 0
  v_exp_f32 v103, v23
  v_cvt_pk_bf16_f32 v46, v100, v101
  v_cvt_pk_bf16_f32 v47, v102, v103
  v_mov_b64 v[38:39], 0
  s_nop 0
  v_mfma_f32_16x16x32_bf16 v[88:91], v[12:15], v[44:47], v[88:91]
  v_mov_b64 v[40:41], 0
  v_mov_b64 v[42:43], 0
  v_mfma_f32_16x16x32_bf16 v[24:27], v[28:31], v[44:47], v[24:27]
  ds_read_b128 v[52:55], v4 offset:24576
  ds_read_b128 v[56:59], v4 offset:25600
  v_mfma_f32_16x16x32_bf16 v[116:119], v[32:35], v[44:47], v[116:119]
  s_nop 1
  v_rcp_f32 v89, v88
  v_subrev_u32 v100, s54, v88
  v_cmp_le_u32 vcc, s55, v100
  v_mul_f32 v24, v89, v24
  v_mul_f32 v25, v89, v25
  s_cbranch_vccnz T_slow_142
T_back_143:
  v_cvt_pk_bf16_f32 v124, v24, v25
  v_pk_mul_f32 v[26:27], v[26:27], v[88:89] op_sel:[0,1] op_sel_hi:[1,1]
  v_pk_mul_f32 v[116:117], v[116:117], v[88:89] op_sel:[0,1] op_sel_hi:[1,1]
  v_pk_mul_f32 v[118:119], v[118:119], v[88:89] op_sel:[0,1] op_sel_hi:[1,1]
  v_cvt_pk_bf16_f32 v125, v26, v27
  v_cvt_pk_bf16_f32 v126, v116, v117
  v_cvt_pk_bf16_f32 v127, v118, v119
  ds_write_b128 v11, v[124:127] offset:30720
  s_nop 0
  v_smfmac_f32_16x16x64_bf16 v[92:95], v[124:127], a[160:167], v0
  v_smfmac_f32_16x16x64_bf16 v[96:99], v[124:127], a[168:175], v0
  v_smfmac_f32_16x16x64_bf16 v[36:39], v[124:127], a[176:183], v0
  v_smfmac_f32_16x16x64_bf16 v[40:43], v[124:127], a[184:191], v0
  s_waitcnt lgkmcnt(0)
  s_barrier
  ds_read_b128 v[104:107], v11 offset:30208
  ds_read_b128 v[108:111], v11 offset:29696
  ds_read_b128 v[68:71], v11 offset:29184
  s_waitcnt lgkmcnt(2)
  v_smfmac_f32_16x16x64_bf16 v[92:95], v[104:107], a[192:199], v0
  s_waitcnt lgkmcnt(1)
  ds_read_b128 v[76:79], v4 offset:28672
  v_smfmac_f32_16x16x64_bf16 v[92:95], v[108:111], a[224:231], v0
  s_waitcnt lgkmcnt(1)
  ds_read_b128 v[80:83], v4 offset:29696
  v_smfmac_f32_16x16x64_bf16 v[92:95], v[68:71], a[240:247], v0
  ds_read_b128 v[60:63], v4 offset:26624
  v_smfmac_f32_16x16x64_bf16 v[96:99], v[104:107], a[200:207], v0
  ds_read_b128 v[64:67], v4 offset:27648
  v_smfmac_f32_16x16x64_bf16 v[96:99], v[108:111], a[232:239], v0
  ds_read_b128 v[28:31], v4 offset:30720
  s_nop 0
  v_cvt_pk_bf16_f32 v16, v92, v93
  v_cvt_pk_bf16_f32 v17, v94, v95
  v_bfi_b32 v16, 1, s57, v16
  v_smfmac_f32_16x16x64_bf16 v[96:99], v[68:71], a[248:255], v0
  buffer_store_dwordx2 v[16:17], v7, s[4:7], s20 offen offset:0
  v_smfmac_f32_16x16x64_bf16 v[36:39], v[104:107], a[208:215], v0
  ds_read_b128 v[32:35], v4 offset:31744
  v_smfmac_f32_16x16x64_bf16 v[36:39], v[108:111], v[52:59], v0
  s_waitcnt lgkmcnt(4)
  s_nop 0
  v_cvt_pk_bf16_f32 v18, v96, v97
  v_cvt_pk_bf16_f32 v19, v98, v99
  v_bfi_b32 v18, 1, s57, v18
  v_smfmac_f32_16x16x64_bf16 v[36:39], v[68:71], v[76:83], v0
  buffer_store_dwordx2 v[18:19], v7, s[4:7], s20 offen offset:64
  v_smfmac_f32_16x16x64_bf16 v[40:43], v[104:107], a[216:223], v0
  s_waitcnt lgkmcnt(2)
  v_smfmac_f32_16x16x64_bf16 v[40:43], v[108:111], v[60:67], v0
  s_waitcnt lgkmcnt(0)
  s_nop 0
  v_cvt_pk_bf16_f32 v20, v36, v37
  v_cvt_pk_bf16_f32 v21, v38, v39
  v_bfi_b32 v20, 1, s57, v20
  v_smfmac_f32_16x16x64_bf16 v[40:43], v[68:71], v[28:35], v0
  buffer_store_dwordx2 v[20:21], v7, s[4:7], s21 offen offset:0
  s_nop 6
  v_cvt_pk_bf16_f32 v22, v40, v41
  v_cvt_pk_bf16_f32 v23, v42, v43
  v_bfi_b32 v22, 1, s57, v22
  buffer_store_dwordx2 v[22:23], v7, s[4:7], s21 offen offset:64
  ds_read_b128 v[68:71], v4 offset:0
  ds_read_b128 v[72:75], v4 offset:1024
  ds_read_b128 v[76:79], v4 offset:4096
  ds_read_b128 v[80:83], v4 offset:5120
  ds_read_b128 v[84:87], v4 offset:8192
  ds_read_b128 v[88:91], v4 offset:9216
  ds_read_b128 v[92:95], v4 offset:2048
  ds_read_b128 v[96:99], v4 offset:3072
  ds_read_b128 v[100:103], v4 offset:6144
  ds_read_b128 v[104:107], v4 offset:7168
  ds_read_b128 v[108:111], v4 offset:10240
  ds_read_b128 v[112:115], v4 offset:11264
  v_mov_b64 v[16:17], 0
  v_mov_b64 v[18:19], 0
  v_mov_b64 v[20:21], 0
  v_mov_b64 v[22:23], 0
  v_mov_b64 v[24:25], 0
  v_mov_b64 v[26:27], 0
  ds_read_b64 v[44:45], v2 offset:32256
  s_waitcnt lgkmcnt(0)
  v_readfirstlane_b32 s38, v44
  v_readfirstlane_b32 s37, v45
  s_nop 0
  s_add_u32 s37, s37, 30
  s_cmp_ge_u32 s38, 30
  s_cselect_b32 s38, s37, s38
  s_cmp_ge_u32 s38, 64
  s_cselect_b32 s38, 100, s38
  s_sub_u32 s38, s38, 1
  s_max_i32 s30, s30, s38
  s_waitcnt vmcnt(4)
  s_barrier
  ds_read_b128 v[28:31], v2 offset:19456
  ds_read_b128 v[32:35], v2 offset:23552
  ds_read_b128 v[36:39], v2 offset:8192
  ds_read_b128 v[40:43], v2 offset:9216
  ds_read_b128 v[44:47], v2 offset:10240
  ds_read_b128 v[48:51], v2 offset:11264
  buffer_load_dwordx4 v[124:127], v2, s[4:7], s24 offen offset:3072 sc1
  buffer_load_dwordx4 v[116:119], v2, s[4:7], s25 offen offset:3072 sc1
  ds_read_b128 v[52:55], v2 offset:12288
  ds_read_b128 v[56:59], v2 offset:13312
  ds_read_b128 v[60:63], v2 offset:14336
  ds_read_b128 v[64:67], v2 offset:15360
  buffer_load_dwordx4 v[124:127], v2, s[4:7], s24 offen offset:3072 sc1
  buffer_load_dwordx4 v[116:119], v2, s[4:7], s25 offen offset:3072 sc1
  s_mov_b32 s19, 0
  s_branch T_loop_135
T_kvw_139:
  s_mov_b32 s19, 0
  s_branch T_kvok_148
T_kv_147:
  s_sleep 4
  s_add_u32 s19, s19, 1
  s_cmp_gt_u32 s19, 32768
  s_cbranch_scc1 M_exit
T_kvok_148:
  s_add_u32 s39, s99, 128
  s_mov_b32 s38, 0
  s_mov_b32 s37, 0
  s_atomic_or s38, s[58:59], s99 glc
  s_atomic_or s37, s[58:59], s39 glc
  s_waitcnt lgkmcnt(0)
  s_add_u32 s37, s37, 30
  s_cmp_ge_u32 s38, 30
  s_cselect_b32 s38, s37, s38
  s_cmp_ge_u32 s38, 64
  s_cselect_b32 s38, 100, s38
  s_sub_u32 s38, s38, 1
  s_max_i32 s30, s30, s38
  s_cmp_ge_i32 s14, s30
  s_cbranch_scc1 T_kv_147
  s_branch T_kvb_140
T_slow_142:
  s_nop 7
  v_max3_f32 v100, v16, v17, v18
  v_max3_f32 v100, v100, v19, v20
  v_max3_f32 v100, v100, v21, v22
  v_max3_f32 v100, v100, v23, v112
  v_max3_f32 v100, v100, v113, v114
  v_max_f32 v100, v100, v115
  v_mov_b32 v101, v100
  s_nop 1
  v_permlane32_swap_b32 v100, v101
  s_nop 1
  v_max_f32 v100, v100, v101
  v_mov_b32 v101, v100
  s_nop 1
  v_permlane16_swap_b32 v100, v101
  s_nop 1
  v_max_f32 v100, v100, v101
  v_sub_f32 v16, v16, v100
  v_sub_f32 v17, v17, v100
  v_sub_f32 v18, v18, v100
  v_sub_f32 v19, v19, v100
  v_exp_f32 v16, v16
  v_exp_f32 v17, v17
  v_exp_f32 v18, v18
  v_exp_f32 v19, v19
  v_sub_f32 v20, v20, v100
  v_sub_f32 v21, v21, v100
  v_sub_f32 v22, v22, v100
  v_sub_f32 v23, v23, v100
  v_exp_f32 v20, v20
  v_exp_f32 v21, v21
  v_exp_f32 v22, v22
  v_exp_f32 v23, v23
  v_sub_f32 v112, v112, v100
  v_sub_f32 v113, v113, v100
  v_sub_f32 v114, v114, v100
  v_sub_f32 v115, v115, v100
  v_exp_f32 v112, v112
  v_exp_f32 v113, v113
  v_exp_f32 v114, v114
  v_exp_f32 v115, v115
  s_nop 0
  v_cvt_pk_bf16_f32 v44, v16, v17
  v_cvt_pk_bf16_f32 v45, v18, v19
  v_cvt_pk_bf16_f32 v46, v20, v21
  v_cvt_pk_bf16_f32 v47, v22, v23
  v_cvt_pk_bf16_f32 v84, v112, v113
  v_cvt_pk_bf16_f32 v85, v114, v115
  v_cndmask_b32 v48, v84, 0, s[16:17]
  v_cndmask_b32 v49, v85, 0, s[16:17]
  v_cndmask_b32 v50, 0, v84, s[16:17]
  v_cndmask_b32 v51, 0, v85, s[16:17]
  s_nop 1
  v_mfma_f32_16x16x16_bf16 v[88:91], v[12:13], v[48:49], 0
  v_mfma_f32_16x16x16_bf16 v[24:27], v[120:121], v[48:49], 0
  v_mfma_f32_16x16x16_bf16 v[116:119], v[120:121], v[50:51], 0
  v_mfma_f32_16x16x32_bf16 v[88:91], v[12:15], v[44:47], v[88:91]
  v_mfma_f32_16x16x32_bf16 v[24:27], v[28:31], v[44:47], v[24:27]
  v_mfma_f32_16x16x32_bf16 v[116:119], v[32:35], v[44:47], v[116:119]
  s_nop 7
  s_nop 1
  v_rcp_f32 v89, v88
  s_nop 0
  v_mul_f32 v24, v89, v24
  v_mul_f32 v25, v89, v25
  s_branch T_back_143
M_global:
  s_cmp_eq_u32 s13, 1
  s_cbranch_scc1 T_w_150
  s_cmp_eq_u32 s13, 2
  s_cbranch_scc1 T_w_151
  s_cmp_eq_u32 s13, 3
  s_cbranch_scc1 T_w_152
T_w_149:
  s_mov_b32 s19, 0
  v_mov_b64 v[16:17], 0
  v_mov_b64 v[18:19], 0
  v_mov_b64 v[20:21], 0
  v_mov_b64 v[22:23], 0
  v_mov_b64 v[24:25], 0
  v_mov_b64 v[26:27], 0
  buffer_load_dwordx4 v[124:127], v2, s[4:7], s24 offen offset:0 sc1
  buffer_load_dwordx4 v[116:119], v2, s[4:7], s25 offen offset:0 sc1
  buffer_load_dwordx4 v[124:127], v2, s[4:7], s24 offen offset:0 sc1
  buffer_load_dwordx4 v[116:119], v2, s[4:7], s25 offen offset:0 sc1
  s_branch T_loop_153
.p2align 6
T_retry_154:
  s_mov_b64 exec, vcc
  buffer_load_dwordx4 v[124:127], v2, s[4:7], s24 offen offset:0 sc1
  buffer_load_dwordx4 v[116:119], v2, s[4:7], s25 offen offset:0 sc1
  s_mov_b64 exec, -1
  s_add_u32 s19, s19, 1
  s_cmp_gt_u32 s19, 32768
  s_cbranch_scc1 M_exit
T_loop_153:
  s_waitcnt vmcnt(3) lgkmcnt(0)
  v_max3_u32 v123, v124, v125, v126
  v_max_u32 v123, v123, v127
  v_mov_b32_dpp v120, v124 row_ror:8 row_mask:0xf bank_mask:0xf
  v_mov_b32_dpp v121, v125 row_ror:8 row_mask:0xf bank_mask:0xf
  s_waitcnt vmcnt(2)
  v_max3_u32 v123, v123, v116, v117
  v_max3_u32 v123, v123, v118, v119
  v_cmp_eq_u32 vcc, -1, v123
  s_cbranch_vccnz T_retry_154
  v_smfmac_f32_16x16x64_bf16 v[16:19], v[124:127], v[68:75], v0
  s_add_u32 s14, s14, 1
  ds_write_b128 v2, v[124:127] offset:0
  v_mov_b32_dpp v122, v126 row_ror:8 row_mask:0xf bank_mask:0xf
  v_smfmac_f32_16x16x64_bf16 v[20:23], v[124:127], v[76:83], v0
  s_and_b32 s57, s14, 1
  v_mov_b32_dpp v123, v127 row_ror:8 row_mask:0xf bank_mask:0xf
  v_smfmac_f32_16x16x64_bf16 v[24:27], v[124:127], v[84:91], v0
  s_and_b32 s36, s14, 3
  ds_write_b128 v2, v[116:119] offset:4096
  v_smfmac_f32_16x16x64_bf16 v[16:19], v[120:123], v[92:99], v0
  s_lshl_b32 s36, s36, 13
  v_mov_b32_dpp v84, v116 row_ror:8 row_mask:0xf bank_mask:0xf
  v_smfmac_f32_16x16x64_bf16 v[20:23], v[120:123], v[100:107], v0
  s_add_u32 s26, s36, s23
  ds_read_b128 v[68:71], v4 offset:12288
  v_mov_b32_dpp v85, v117 row_ror:8 row_mask:0xf bank_mask:0xf
  v_smfmac_f32_16x16x64_bf16 v[24:27], v[120:123], v[108:115], v0
  s_add_u32 s36, s36, 8192
  ds_read_b128 v[72:75], v4 offset:13312
  v_mov_b32_dpp v86, v118 row_ror:8 row_mask:0xf bank_mask:0xf
  v_smfmac_f32_16x16x64_bf16 v[16:19], v[116:119], v[224:231], v0
  s_and_b32 s36, s36, 0x7fff
  ds_read_b128 v[76:79], v4 offset:14336
  v_mov_b32_dpp v87, v119 row_ror:8 row_mask:0xf bank_mask:0xf
  v_smfmac_f32_16x16x64_bf16 v[20:23], v[116:119], v[240:247], v0
  s_waitcnt lgkmcnt(3)
  s_barrier
  ds_read_b128 v[100:103], v2 offset:1024
  v_smfmac_f32_16x16x64_bf16 v[24:27], v[116:119], a[0:7], v0
  s_mov_b32 m0, s31
  ds_read_b128 v[120:123], v1 offset:1024
  v_smfmac_f32_16x16x64_bf16 v[16:19], v[84:87], v[232:239], v0
  s_cmp_ge_i32 s14, s30
  s_cbranch_scc1 T_kvw_157
T_kvb_158:
  v_smfmac_f32_16x16x64_bf16 v[20:23], v[84:87], v[248:255], v0
  ds_read_b128 v[80:83], v4 offset:15360
  buffer_load_dwordx4 v9, s[4:7], s27 offen sc1 lds
  v_smfmac_f32_16x16x64_bf16 v[24:27], v[84:87], a[8:15], v0
  s_waitcnt lgkmcnt(2)
  s_mov_b32 m0, s32
  v_smfmac_f32_16x16x64_bf16 v[16:19], v[100:103], v[128:135], v0
  ds_read_b128 v[92:95], v2 offset:2048
  v_smfmac_f32_16x16x64_bf16 v[20:23], v[100:103], v[144:151], v0
  ds_read_b128 v[96:99], v1 offset:2048
  v_smfmac_f32_16x16x64_bf16 v[24:27], v[100:103], v[68:75], v0
  s_waitcnt vmcnt(1) lgkmcnt(3)
  ds_read_b128 v[116:119], v2 offset:3072
  buffer_load_dwordx4 v9, s[4:7], s27 offen offset:128 sc1 lds
  v_smfmac_f32_16x16x64_bf16 v[16:19], v[120:123], v[136:143], v0
  ds_read_b128 v[124:127], v1 offset:3072
  s_mov_b32 m0, s33
  v_smfmac_f32_16x16x64_bf16 v[20:23], v[120:123], v[152:159], v0
  s_waitcnt lgkmcnt(4)
  ds_read_b128 v[104:107], v2 offset:5120
  v_smfmac_f32_16x16x64_bf16 v[24:27], v[120:123], v[76:83], v0
  s_waitcnt lgkmcnt(4)
  ds_read_b128 v[108:111], v1 offset:5120
  v_smfmac_f32_16x16x64_bf16 v[16:19], v[92:95], v[160:167], v0
  s_waitcnt lgkmcnt(4)
  ds_read_b128 v[112:115], v2 offset:6144
  buffer_load_dwordx4 v10, s[4:7], s28 offen sc1 lds
  v_smfmac_f32_16x16x64_bf16 v[16:19], v[96:99], v[168:175], v0
  s_waitcnt lgkmcnt(4)
  ds_read_b128 v[84:87], v1 offset:6144
  s_mov_b32 m0, s34
  v_smfmac_f32_16x16x64_bf16 v[16:19], v[116:119], v[192:199], v0
  s_waitcnt lgkmcnt(4)
  ds_read_b128 v[88:91], v2 offset:7168
  v_smfmac_f32_16x16x64_bf16 v[16:19], v[124:127], v[200:207], v0
  s_waitcnt lgkmcnt(4)
  ds_read_b128 v[100:103], v1 offset:7168
  v_smfmac_f32_16x16x64_bf16 v[16:19], v[104:107], a[16:23], v0
  s_waitcnt lgkmcnt(4)
  ds_read_b128 v[68:71], v4 offset:16384
  buffer_load_dwordx4 v10, s[4:7], s28 offen offset:256 sc1 lds
  v_smfmac_f32_16x16x64_bf16 v[16:19], v[108:111], a[24:31], v0
  s_waitcnt lgkmcnt(4)
  ds_read_b128 v[72:75], v4 offset:17408
  v_smfmac_f32_16x16x64_bf16 v[16:19], v[112:115], a[64:71], v0
  s_waitcnt lgkmcnt(4)
  ds_read_b128 v[76:79], v4 offset:18432
  v_smfmac_f32_16x16x64_bf16 v[16:19], v[84:87], a[72:79], v0
  s_waitcnt lgkmcnt(4)
  ds_read_b128 v[80:83], v4 offset:19456
  v_smfmac_f32_16x16x64_bf16 v[16:19], v[88:91], a[112:119], v0
  s_waitcnt lgkmcnt(4)
  v_smfmac_f32_16x16x64_bf16 v[16:19], v[100:103], a[120:127], v0
  s_add_u32 s24, s36, 145752064
  s_add_u32 s25, s36, 145756160
  v_smfmac_f32_16x16x64_bf16 v[20:23], v[92:95], v[176:183], v0
  s_add_u32 s35, s36, s23
  v_smfmac_f32_16x16x64_bf16 v[20:23], v[96:99], v[184:191], v0
  s_waitcnt lgkmcnt(2)
  v_smfmac_f32_16x16x64_bf16 v[20:23], v[116:119], v[68:75], v0
  s_waitcnt lgkmcnt(0)
  ds_read_b128 v[68:71], v4 offset:20480
  v_mul_f32 v16, s18, v16
  v_smfmac_f32_16x16x64_bf16 v[20:23], v[124:127], v[76:83], v0
  ds_read_b128 v[72:75], v4 offset:21504
  v_mul_f32 v17, s18, v17
  v_smfmac_f32_16x16x64_bf16 v[20:23], v[104:107], a[32:39], v0
  ds_read_b128 v[76:79], v4 offset:22528
  v_mul_f32 v18, s18, v18
  v_smfmac_f32_16x16x64_bf16 v[20:23], v[108:111], a[40:47], v0
  ds_read_b128 v[80:83], v4 offset:23552
  v_mul_f32 v19, s18, v19
  v_smfmac_f32_16x16x64_bf16 v[20:23], v[112:115], a[80:87], v0
  v_cvt_pk_bf16_f32 v120, v16, v17
  v_smfmac_f32_16x16x64_bf16 v[20:23], v[84:87], a[88:95], v0
  v_cvt_pk_bf16_f32 v121, v18, v19
  v_smfmac_f32_16x16x64_bf16 v[20:23], v[88:91], a[128:135], v0
  ds_write_b64 v5, v[120:121] offset:24576
  v_smfmac_f32_16x16x64_bf16 v[20:23], v[100:103], a[136:143], v0
  s_waitcnt lgkmcnt(3)
  v_smfmac_f32_16x16x64_bf16 v[24:27], v[92:95], v[68:75], v0
  s_waitcnt lgkmcnt(1)
  v_mov_b64 v[92:93], 0
  v_smfmac_f32_16x16x64_bf16 v[24:27], v[96:99], v[76:83], v0
  s_nop 1
  v_cvt_pk_bf16_f32 v122, v20, v21
  v_cvt_pk_bf16_f32 v123, v22, v23
  v_smfmac_f32_16x16x64_bf16 v[24:27], v[116:119], v[208:215], v0
  ds_write_b64 v5, v[122:123] offset:26880
  v_mov_b64 v[94:95], 0
  v_smfmac_f32_16x16x64_bf16 v[24:27], v[124:127], v[216:223], v0
  s_waitcnt lgkmcnt(1)
  s_barrier
  ds_read_b64_tr_b16 v[68:69], v6 offset:24576
  v_smfmac_f32_16x16x64_bf16 v[24:27], v[104:107], a[48:55], v0
  s_add_u32 s27, s27, 8192
  ds_read_b64_tr_b16 v[70:71], v6 offset:24640
  ds_read_b64_tr_b16 v[72:73], v6 offset:24832
  v_smfmac_f32_16x16x64_bf16 v[24:27], v[108:111], a[56:63], v0
  s_add_u32 s28, s28, 8192
  ds_read_b64_tr_b16 v[74:75], v6 offset:24896
  ds_read_b64_tr_b16 v[76:77], v6 offset:25088
  v_smfmac_f32_16x16x64_bf16 v[24:27], v[112:115], a[96:103], v0
  s_nop 0
  ds_read_b64_tr_b16 v[78:79], v6 offset:25152
  ds_read_b64_tr_b16 v[80:81], v6 offset:25344
  v_smfmac_f32_16x16x64_bf16 v[24:27], v[84:87], a[104:111], v0
  ds_read_b64_tr_b16 v[82:83], v6 offset:25408
  v_mov_b64 v[96:97], 0
  v_smfmac_f32_16x16x64_bf16 v[24:27], v[88:91], a[144:151], v0
  s_waitcnt lgkmcnt(8)
  s_barrier
  ds_read_b64_tr_b16 v[116:117], v6 offset:26880
  v_smfmac_f32_16x16x64_bf16 v[24:27], v[100:103], a[152:159], v0
  s_waitcnt lgkmcnt(7)
  ds_read_b64_tr_b16 v[118:119], v6 offset:26944
  v_mfma_f32_16x16x32_bf16 v[16:19], v[36:39], v[68:71], 0
  s_waitcnt lgkmcnt(6)
  ds_read_b64_tr_b16 v[124:125], v6 offset:27136
  ds_read_b64_tr_b16 v[126:127], v6 offset:27200
  v_mfma_f32_16x16x32_bf16 v[16:19], v[40:43], v[72:75], v[16:19]
  s_waitcnt lgkmcnt(6)
  ds_read_b64_tr_b16 v[104:105], v6 offset:27392
  ds_read_b64_tr_b16 v[106:107], v6 offset:27456
  v_mfma_f32_16x16x32_bf16 v[16:19], v[44:47], v[76:79], v[16:19]
  s_waitcnt lgkmcnt(6)
  ds_read_b64_tr_b16 v[108:109], v6 offset:27648
  ds_read_b64_tr_b16 v[110:111], v6 offset:27712
  v_mfma_f32_16x16x32_bf16 v[16:19], v[48:51], v[80:83], v[16:19]
  s_waitcnt lgkmcnt(6)
  v_cvt_pk_bf16_f32 v120, v24, v25
  v_cvt_pk_bf16_f32 v121, v26, v27
  v_mfma_f32_16x16x32_bf16 v[112:115], v[116:119], v[68:71], 0
  s_waitcnt lgkmcnt(4)
  buffer_store_dwordx4 v[120:123], v2, s[4:7], s29 offen offset:0 sc1
  v_mov_b64 v[98:99], 0
  v_mfma_f32_16x16x32_bf16 v[112:115], v[124:127], v[72:75], v[112:115]
  s_waitcnt lgkmcnt(2)
  v_mov_b64 v[36:37], 0
  v_exp_f32 v100, v16
  v_mfma_f32_16x16x32_bf16 v[112:115], v[104:107], v[76:79], v[112:115]
  s_waitcnt lgkmcnt(0)
  v_exp_f32 v101, v17
  v_mfma_f32_16x16x32_bf16 v[112:115], v[108:111], v[80:83], v[112:115]
  v_exp_f32 v102, v18
  v_mfma_f32_16x16x32_bf16 v[20:23], v[52:55], v[68:71], 0
  s_cmp_eq_u32 s14, 63
  v_exp_f32 v103, v19
  v_mfma_f32_16x16x32_bf16 v[20:23], v[56:59], v[72:75], v[20:23]
  s_cbranch_scc1 M_tdone
  v_cvt_pk_bf16_f32 v44, v100, v101
  v_cvt_pk_bf16_f32 v45, v102, v103
  v_mfma_f32_16x16x32_bf16 v[20:23], v[60:63], v[76:79], v[20:23]
  s_add_u32 s29, s29, 131072
  v_exp_f32 v100, v112
  v_mfma_f32_16x16x32_bf16 v[20:23], v[64:67], v[80:83], v[20:23]
  v_exp_f32 v101, v113
  v_exp_f32 v102, v114
  v_exp_f32 v103, v115
  v_cvt_pk_bf16_f32 v84, v100, v101
  v_cvt_pk_bf16_f32 v85, v102, v103
  v_cndmask_b32 v48, v84, 0, s[16:17]
  v_cndmask_b32 v49, v85, 0, s[16:17]
  v_cndmask_b32 v50, 0, v84, s[16:17]
  v_cndmask_b32 v51, 0, v85, s[16:17]
  v_exp_f32 v100, v20
  v_mfma_f32_16x16x16_bf16 v[88:91], v[12:13], v[48:49], 0
  v_exp_f32 v101, v21
  v_mfma_f32_16x16x16_bf16 v[24:27], v[120:121], v[48:49], 0
  v_exp_f32 v102, v22
  v_mfma_f32_16x16x16_bf16 v[116:119], v[120:121], v[50:51], 0
  v_exp_f32 v103, v23
  v_cvt_pk_bf16_f32 v46, v100, v101
  v_cvt_pk_bf16_f32 v47, v102, v103
  v_mov_b64 v[38:39], 0
  s_nop 0
  v_mfma_f32_16x16x32_bf16 v[88:91], v[12:15], v[44:47], v[88:91]
  v_mov_b64 v[40:41], 0
  v_mov_b64 v[42:43], 0
  v_mfma_f32_16x16x32_bf16 v[24:27], v[28:31], v[44:47], v[24:27]
  ds_read_b128 v[52:55], v4 offset:24576
  ds_read_b128 v[56:59], v4 offset:25600
  v_mfma_f32_16x16x32_bf16 v[116:119], v[32:35], v[44:47], v[116:119]
  s_nop 1
  v_rcp_f32 v89, v88
  v_subrev_u32 v100, s54, v88
  v_cmp_le_u32 vcc, s55, v100
  v_mul_f32 v24, v89, v24
  v_mul_f32 v25, v89, v25
  s_cbranch_vccnz T_slow_160
T_back_161:
  v_cvt_pk_bf16_f32 v124, v24, v25
  v_pk_mul_f32 v[26:27], v[26:27], v[88:89] op_sel:[0,1] op_sel_hi:[1,1]
  v_pk_mul_f32 v[116:117], v[116:117], v[88:89] op_sel:[0,1] op_sel_hi:[1,1]
  v_pk_mul_f32 v[118:119], v[118:119], v[88:89] op_sel:[0,1] op_sel_hi:[1,1]
  v_cvt_pk_bf16_f32 v125, v26, v27
  v_cvt_pk_bf16_f32 v126, v116, v117
  v_cvt_pk_bf16_f32 v127, v118, v119
  ds_write_b128 v11, v[124:127] offset:29184
  s_nop 0
  v_smfmac_f32_16x16x64_bf16 v[92:95], v[124:127], a[160:167], v0
  v_smfmac_f32_16x16x64_bf16 v[96:99], v[124:127], a[168:175], v0
  v_smfmac_f32_16x16x64_bf16 v[36:39], v[124:127], a[176:183], v0
  v_smfmac_f32_16x16x64_bf16 v[40:43], v[124:127], a[184:191], v0
  s_waitcnt lgkmcnt(0)
  s_barrier
  ds_read_b128 v[104:107], v11 offset:29696
  ds_read_b128 v[108:111], v11 offset:30208
  ds_read_b128 v[68:71], v11 offset:30720
  s_waitcnt lgkmcnt(2)
  v_smfmac_f32_16x16x64_bf16 v[92:95], v[104:107], a[192:199], v0
  s_waitcnt lgkmcnt(1)
  ds_read_b128 v[76:79], v4 offset:28672
  v_smfmac_f32_16x16x64_bf16 v[92:95], v[108:111], a[224:231], v0
  s_waitcnt lgkmcnt(1)
  ds_read_b128 v[80:83], v4 offset:29696
  v_smfmac_f32_16x16x64_bf16 v[92:95], v[68:71], a[240:247], v0
  ds_read_b128 v[60:63], v4 offset:26624
  v_smfmac_f32_16x16x64_bf16 v[96:99], v[104:107], a[200:207], v0
  ds_read_b128 v[64:67], v4 offset:27648
  v_smfmac_f32_16x16x64_bf16 v[96:99], v[108:111], a[232:239], v0
  ds_read_b128 v[28:31], v4 offset:30720
  s_nop 0
  v_cvt_pk_bf16_f32 v16, v92, v93
  v_cvt_pk_bf16_f32 v17, v94, v95
  v_bfi_b32 v16, 1, s57, v16
  v_smfmac_f32_16x16x64_bf16 v[96:99], v[68:71], a[248:255], v0
  buffer_store_dwordx2 v[16:17], v7, s[4:7], s20 offen offset:0 sc1
  v_smfmac_f32_16x16x64_bf16 v[36:39], v[104:107], a[208:215], v0
  ds_read_b128 v[32:35], v4 offset:31744
  v_smfmac_f32_16x16x64_bf16 v[36:39], v[108:111], v[52:59], v0
  s_waitcnt lgkmcnt(4)
  s_nop 0
  v_cvt_pk_bf16_f32 v18, v96, v97
  v_cvt_pk_bf16_f32 v19, v98, v99
  v_bfi_b32 v18, 1, s57, v18
  v_smfmac_f32_16x16x64_bf16 v[36:39], v[68:71], v[76:83], v0
  buffer_store_dwordx2 v[18:19], v7, s[4:7], s20 offen offset:64 sc1
  v_smfmac_f32_16x16x64_bf16 v[40:43], v[104:107], a[216:223], v0
  s_waitcnt lgkmcnt(2)
  ds_read_b128 v[116:119], v2 offset:31232
  v_smfmac_f32_16x16x64_bf16 v[40:43], v[108:111], v[60:67], v0
  s_waitcnt lgkmcnt(1)
  s_nop 0
  v_cvt_pk_bf16_f32 v20, v36, v37
  v_cvt_pk_bf16_f32 v21, v38, v39
  v_bfi_b32 v20, 1, s57, v20
  v_smfmac_f32_16x16x64_bf16 v[40:43], v[68:71], v[28:35], v0
  buffer_store_dwordx2 v[20:21], v7, s[4:7], s21 offen offset:0 sc1
  s_nop 6
  v_cvt_pk_bf16_f32 v22, v40, v41
  v_cvt_pk_bf16_f32 v23, v42, v43
  v_bfi_b32 v22, 1, s57, v22
  buffer_store_dwordx2 v[22:23], v7, s[4:7], s21 offen offset:64 sc1
  ds_read_b128 v[68:71], v4 offset:0
  ds_read_b128 v[72:75], v4 offset:1024
  ds_read_b128 v[76:79], v4 offset:4096
  ds_read_b128 v[80:83], v4 offset:5120
  ds_read_b128 v[84:87], v4 offset:8192
  ds_read_b128 v[88:91], v4 offset:9216
  v_mov_b64 v[16:17], 0
  v_mov_b64 v[18:19], 0
  v_mov_b64 v[20:21], 0
  v_mov_b64 v[22:23], 0
  v_mov_b64 v[24:25], 0
  v_mov_b64 v[26:27], 0
  s_mov_b32 s19, 0
  v_mov_b32 v49, -1
  s_waitcnt vmcnt(2)
  buffer_load_dwordx4 v[52:55], v2, s[4:7], s22 offen offset:0 sc1
  buffer_load_dwordx4 v[56:59], v2, s[4:7], s22 offen offset:1024 sc1
  buffer_load_dwordx4 v[60:63], v2, s[4:7], s22 offen offset:2048 sc1
  buffer_load_dwordx4 v[64:67], v2, s[4:7], s22 offen offset:3072 sc1
  ds_read_b128 v[92:95], v4 offset:2048
  ds_read_b128 v[96:99], v4 offset:3072
  ds_read_b128 v[100:103], v4 offset:6144
  ds_read_b128 v[104:107], v4 offset:7168
  ds_read_b128 v[108:111], v4 offset:10240
  ds_read_b128 v[112:115], v4 offset:11264
  ds_read_b64 v[44:45], v2 offset:32256
  s_waitcnt lgkmcnt(0)
  v_readfirstlane_b32 s38, v44
  v_readfirstlane_b32 s37, v45
  s_nop 0
  s_add_u32 s37, s37, 30
  s_cmp_ge_u32 s38, 30
  s_cselect_b32 s38, s37, s38
  s_cmp_ge_u32 s38, 64
  s_cselect_b32 s38, 100, s38
  s_sub_u32 s38, s38, 1
  s_max_i32 s30, s30, s38
  s_waitcnt lgkmcnt(12)
  s_waitcnt vmcnt(3)
  v_mfma_f32_16x16x32_bf16 v[120:123], v[116:119], v[52:55], 0
  v_xor_b32 v48, s57, v52
  v_bitop3_b32 v48, v48, v54, s57 bitop3:0xf6
  s_waitcnt vmcnt(2)
  v_mfma_f32_16x16x32_bf16 v[120:123], v[116:119], v[56:59], v[120:123]
  v_bitop3_b32 v48, v48, v56, s57 bitop3:0xf6
  v_bitop3_b32 v48, v48, v58, s57 bitop3:0xf6
  s_waitcnt vmcnt(1)
  v_mfma_f32_16x16x32_bf16 v[120:123], v[116:119], v[60:63], v[120:123]
  v_bitop3_b32 v48, v48, v60, s57 bitop3:0xf6
  v_bitop3_b32 v48, v48, v62, s57 bitop3:0xf6
  s_waitcnt vmcnt(0)
  v_mfma_f32_16x16x32_bf16 v[120:123], v[116:119], v[64:67], v[120:123]
  v_bitop3_b32 v48, v48, v64, s57 bitop3:0xf6
  v_bitop3_b32 v48, v48, v66, s57 bitop3:0xf6
  v_and_b32 v48, 1, v48
  v_cmp_ne_u32 vcc, 0, v48
  s_cbranch_vccnz T_p1re_163
T_p1ok_164:
  s_nop 2
  v_add_f32_dpp v120, v120, v120 row_ror:8 row_mask:0xf bank_mask:0xf
  v_add_f32_dpp v121, v121, v121 row_ror:8 row_mask:0xf bank_mask:0xf
  v_cvt_pk_bf16_f32 v48, v120, v121
  buffer_store_dword v48, v8, s[4:7], s35 offen sc1
  buffer_store_dword v49, v8, s[4:7], s26 offen sc1
  s_barrier
  ds_read_b128 v[28:31], v2 offset:16384
  ds_read_b128 v[32:35], v2 offset:20480
  ds_read_b128 v[36:39], v2 offset:8192
  ds_read_b128 v[40:43], v2 offset:9216
  ds_read_b128 v[44:47], v2 offset:10240
  ds_read_b128 v[48:51], v2 offset:11264
  buffer_load_dwordx4 v[124:127], v2, s[4:7], s24 offen offset:0 sc1
  buffer_load_dwordx4 v[116:119], v2, s[4:7], s25 offen offset:0 sc1
  ds_read_b128 v[52:55], v2 offset:12288
  ds_read_b128 v[56:59], v2 offset:13312
  ds_read_b128 v[60:63], v2 offset:14336
  ds_read_b128 v[64:67], v2 offset:15360
  buffer_load_dwordx4 v[124:127], v2, s[4:7], s24 offen offset:0 sc1
  buffer_load_dwordx4 v[116:119], v2, s[4:7], s25 offen offset:0 sc1
  s_mov_b32 s19, 0
  s_branch T_loop_153
T_p1re_163:
  s_mov_b64 exec, vcc
  buffer_load_dwordx4 v[52:55], v2, s[4:7], s22 offen offset:0 sc1
  buffer_load_dwordx4 v[56:59], v2, s[4:7], s22 offen offset:1024 sc1
  buffer_load_dwordx4 v[60:63], v2, s[4:7], s22 offen offset:2048 sc1
  buffer_load_dwordx4 v[64:67], v2, s[4:7], s22 offen offset:3072 sc1
  s_mov_b64 exec, -1
  s_add_u32 s19, s19, 1
  s_cmp_gt_u32 s19, 32768
  s_cbranch_scc1 M_exit
  s_waitcnt vmcnt(3)
  v_mfma_f32_16x16x32_bf16 v[120:123], v[116:119], v[52:55], 0
  v_xor_b32 v48, s57, v52
  v_bitop3_b32 v48, v48, v54, s57 bitop3:0xf6
  s_waitcnt vmcnt(2)
  v_mfma_f32_16x16x32_bf16 v[120:123], v[116:119], v[56:59], v[120:123]
  v_bitop3_b32 v48, v48, v56, s57 bitop3:0xf6
  v_bitop3_b32 v48, v48, v58, s57 bitop3:0xf6
  s_waitcnt vmcnt(1)
  v_mfma_f32_16x16x32_bf16 v[120:123], v[116:119], v[60:63], v[120:123]
  v_bitop3_b32 v48, v48, v60, s57 bitop3:0xf6
  v_bitop3_b32 v48, v48, v62, s57 bitop3:0xf6
  s_waitcnt vmcnt(0)
  v_mfma_f32_16x16x32_bf16 v[120:123], v[116:119], v[64:67], v[120:123]
  v_bitop3_b32 v48, v48, v64, s57 bitop3:0xf6
  v_bitop3_b32 v48, v48, v66, s57 bitop3:0xf6
  v_and_b32 v48, 1, v48
  v_cmp_ne_u32 vcc, 0, v48
  s_cbranch_vccnz T_p1re_163
  s_branch T_p1ok_164
T_kvw_157:
  s_mov_b32 s19, 0
  s_branch T_kvok_166
T_kv_165:
  s_sleep 4
  s_add_u32 s19, s19, 1
  s_cmp_gt_u32 s19, 32768
  s_cbranch_scc1 M_exit
T_kvok_166:
  s_add_u32 s39, s99, 128
  s_mov_b32 s38, 0
  s_mov_b32 s37, 0
  s_atomic_or s38, s[58:59], s99 glc
  s_atomic_or s37, s[58:59], s39 glc
  s_waitcnt lgkmcnt(0)
  s_add_u32 s37, s37, 30
  s_cmp_ge_u32 s38, 30
  s_cselect_b32 s38, s37, s38
  s_cmp_ge_u32 s38, 64
  s_cselect_b32 s38, 100, s38
  s_sub_u32 s38, s38, 1
  s_max_i32 s30, s30, s38
  s_cmp_ge_i32 s14, s30
  s_cbranch_scc1 T_kv_165
  s_branch T_kvb_158
T_slow_160:
  s_nop 7
  v_max3_f32 v100, v16, v17, v18
  v_max3_f32 v100, v100, v19, v20
  v_max3_f32 v100, v100, v21, v22
  v_max3_f32 v100, v100, v23, v112
  v_max3_f32 v100, v100, v113, v114
  v_max_f32 v100, v100, v115
  v_mov_b32 v101, v100
  s_nop 1
  v_permlane32_swap_b32 v100, v101
  s_nop 1
  v_max_f32 v100, v100, v101
  v_mov_b32 v101, v100
  s_nop 1
  v_permlane16_swap_b32 v100, v101
  s_nop 1
  v_max_f32 v100, v100, v101
  v_sub_f32 v16, v16, v100
  v_sub_f32 v17, v17, v100
  v_sub_f32 v18, v18, v100
  v_sub_f32 v19, v19, v100
  v_exp_f32 v16, v16
  v_exp_f32 v17, v17
  v_exp_f32 v18, v18
  v_exp_f32 v19, v19
  v_sub_f32 v20, v20, v100
  v_sub_f32 v21, v21, v100
  v_sub_f32 v22, v22, v100
  v_sub_f32 v23, v23, v100
  v_exp_f32 v20, v20
  v_exp_f32 v21, v21
  v_exp_f32 v22, v22
  v_exp_f32 v23, v23
  v_sub_f32 v112, v112, v100
  v_sub_f32 v113, v113, v100
  v_sub_f32 v114, v114, v100
  v_sub_f32 v115, v115, v100
  v_exp_f32 v112, v112
  v_exp_f32 v113, v113
  v_exp_f32 v114, v114
  v_exp_f32 v115, v115
  s_nop 0
  v_cvt_pk_bf16_f32 v44, v16, v17
  v_cvt_pk_bf16_f32 v45, v18, v19
  v_cvt_pk_bf16_f32 v46, v20, v21
  v_cvt_pk_bf16_f32 v47, v22, v23
  v_cvt_pk_bf16_f32 v84, v112, v113
  v_cvt_pk_bf16_f32 v85, v114, v115
  v_cndmask_b32 v48, v84, 0, s[16:17]
  v_cndmask_b32 v49, v85, 0, s[16:17]
  v_cndmask_b32 v50, 0, v84, s[16:17]
  v_cndmask_b32 v51, 0, v85, s[16:17]
  s_nop 1
  v_mfma_f32_16x16x16_bf16 v[88:91], v[12:13], v[48:49], 0
  v_mfma_f32_16x16x16_bf16 v[24:27], v[120:121], v[48:49], 0
  v_mfma_f32_16x16x16_bf16 v[116:119], v[120:121], v[50:51], 0
  v_mfma_f32_16x16x32_bf16 v[88:91], v[12:15], v[44:47], v[88:91]
  v_mfma_f32_16x16x32_bf16 v[24:27], v[28:31], v[44:47], v[24:27]
  v_mfma_f32_16x16x32_bf16 v[116:119], v[32:35], v[44:47], v[116:119]
  s_nop 7
  s_nop 1
  v_rcp_f32 v89, v88
  s_nop 0
  v_mul_f32 v24, v89, v24
  v_mul_f32 v25, v89, v25
  s_branch T_back_161
T_w_150:
  s_mov_b32 s19, 0
  v_mov_b64 v[16:17], 0
  v_mov_b64 v[18:19], 0
  v_mov_b64 v[20:21], 0
  v_mov_b64 v[22:23], 0
  v_mov_b64 v[24:25], 0
  v_mov_b64 v[26:27], 0
  buffer_load_dwordx4 v[124:127], v2, s[4:7], s24 offen offset:1024 sc1
  buffer_load_dwordx4 v[116:119], v2, s[4:7], s25 offen offset:1024 sc1
  buffer_load_dwordx4 v[124:127], v2, s[4:7], s24 offen offset:1024 sc1
  buffer_load_dwordx4 v[116:119], v2, s[4:7], s25 offen offset:1024 sc1
  s_branch T_loop_167
.p2align 6
T_retry_168:
  s_mov_b64 exec, vcc
  buffer_load_dwordx4 v[124:127], v2, s[4:7], s24 offen offset:1024 sc1
  buffer_load_dwordx4 v[116:119], v2, s[4:7], s25 offen offset:1024 sc1
  s_mov_b64 exec, -1
  s_add_u32 s19, s19, 1
  s_cmp_gt_u32 s19, 32768
  s_cbranch_scc1 M_exit
T_loop_167:
  s_waitcnt vmcnt(3) lgkmcnt(0)
  v_max3_u32 v123, v124, v125, v126
  v_max_u32 v123, v123, v127
  v_mov_b32_dpp v120, v124 row_ror:8 row_mask:0xf bank_mask:0xf
  v_mov_b32_dpp v121, v125 row_ror:8 row_mask:0xf bank_mask:0xf
  s_waitcnt vmcnt(2)
  v_max3_u32 v123, v123, v116, v117
  v_max3_u32 v123, v123, v118, v119
  v_cmp_eq_u32 vcc, -1, v123
  s_cbranch_vccnz T_retry_168
  v_smfmac_f32_16x16x64_bf16 v[16:19], v[124:127], v[68:75], v0
  s_add_u32 s14, s14, 1
  ds_write_b128 v2, v[124:127] offset:1024
  v_mov_b32_dpp v122, v126 row_ror:8 row_mask:0xf bank_mask:0xf
  v_smfmac_f32_16x16x64_bf16 v[20:23], v[124:127], v[76:83], v0
  s_and_b32 s57, s14, 1
  v_mov_b32_dpp v123, v127 row_ror:8 row_mask:0xf bank_mask:0xf
  v_smfmac_f32_16x16x64_bf16 v[24:27], v[124:127], v[84:91], v0
  s_and_b32 s36, s14, 3
  ds_write_b128 v2, v[116:119] offset:5120
  v_smfmac_f32_16x16x64_bf16 v[16:19], v[120:123], v[92:99], v0
  s_lshl_b32 s36, s36, 13
  v_mov_b32_dpp v84, v116 row_ror:8 row_mask:0xf bank_mask:0xf
  v_smfmac_f32_16x16x64_bf16 v[20:23], v[120:123], v[100:107], v0
  s_add_u32 s26, s36, s23
  ds_read_b128 v[68:71], v4 offset:12288
  v_mov_b32_dpp v85, v117 row_ror:8 row_mask:0xf bank_mask:0xf
  v_smfmac_f32_16x16x64_bf16 v[24:27], v[120:123], v[108:115], v0
  s_add_u32 s36, s36, 8192
  ds_read_b128 v[72:75], v4 offset:13312
  v_mov_b32_dpp v86, v118 row_ror:8 row_mask:0xf bank_mask:0xf
  v_smfmac_f32_16x16x64_bf16 v[16:19], v[116:119], v[224:231], v0
  s_and_b32 s36, s36, 0x7fff
  ds_read_b128 v[76:79], v4 offset:14336
  v_mov_b32_dpp v87, v119 row_ror:8 row_mask:0xf bank_mask:0xf
  v_smfmac_f32_16x16x64_bf16 v[20:23], v[116:119], v[240:247], v0
  s_waitcnt lgkmcnt(3)
  s_barrier
  ds_read_b128 v[100:103], v2 offset:0
  v_smfmac_f32_16x16x64_bf16 v[24:27], v[116:119], a[0:7], v0
  s_mov_b32 m0, s31
  ds_read_b128 v[120:123], v1 offset:0
  v_smfmac_f32_16x16x64_bf16 v[16:19], v[84:87], v[232:239], v0
  s_cmp_ge_i32 s14, s30
  s_cbranch_scc1 T_kvw_171
T_kvb_172:
  v_smfmac_f32_16x16x64_bf16 v[20:23], v[84:87], v[248:255], v0
  ds_read_b128 v[80:83], v4 offset:15360
  v_smfmac_f32_16x16x64_bf16 v[24:27], v[84:87], a[8:15], v0
  s_waitcnt lgkmcnt(2)
  buffer_load_dwordx4 v9, s[4:7], s27 offen sc1 lds
  v_smfmac_f32_16x16x64_bf16 v[16:19], v[100:103], v[128:135], v0
  ds_read_b128 v[92:95], v2 offset:3072
  s_mov_b32 m0, s32
  v_smfmac_f32_16x16x64_bf16 v[20:23], v[100:103], v[144:151], v0
  ds_read_b128 v[96:99], v1 offset:3072
  v_smfmac_f32_16x16x64_bf16 v[24:27], v[100:103], v[68:75], v0
  s_waitcnt vmcnt(1) lgkmcnt(3)
  ds_read_b128 v[116:119], v2 offset:2048
  v_smfmac_f32_16x16x64_bf16 v[16:19], v[120:123], v[136:143], v0
  ds_read_b128 v[124:127], v1 offset:2048
  buffer_load_dwordx4 v9, s[4:7], s27 offen offset:128 sc1 lds
  v_smfmac_f32_16x16x64_bf16 v[20:23], v[120:123], v[152:159], v0
  s_waitcnt lgkmcnt(4)
  ds_read_b128 v[104:107], v2 offset:4096
  s_mov_b32 m0, s33
  v_smfmac_f32_16x16x64_bf16 v[24:27], v[120:123], v[76:83], v0
  s_waitcnt lgkmcnt(4)
  ds_read_b128 v[108:111], v1 offset:4096
  v_smfmac_f32_16x16x64_bf16 v[16:19], v[92:95], v[160:167], v0
  s_waitcnt lgkmcnt(4)
  ds_read_b128 v[112:115], v2 offset:7168
  v_smfmac_f32_16x16x64_bf16 v[16:19], v[96:99], v[168:175], v0
  s_waitcnt lgkmcnt(4)
  ds_read_b128 v[84:87], v1 offset:7168
  buffer_load_dwordx4 v10, s[4:7], s28 offen sc1 lds
  v_smfmac_f32_16x16x64_bf16 v[16:19], v[116:119], v[192:199], v0
  s_waitcnt lgkmcnt(4)
  ds_read_b128 v[88:91], v2 offset:6144
  s_mov_b32 m0, s34
  v_smfmac_f32_16x16x64_bf16 v[16:19], v[124:127], v[200:207], v0
  s_waitcnt lgkmcnt(4)
  ds_read_b128 v[100:103], v1 offset:6144
  v_smfmac_f32_16x16x64_bf16 v[16:19], v[104:107], a[16:23], v0
  s_waitcnt lgkmcnt(4)
  ds_read_b128 v[68:71], v4 offset:16384
  v_smfmac_f32_16x16x64_bf16 v[16:19], v[108:111], a[24:31], v0
  s_waitcnt lgkmcnt(4)
  ds_read_b128 v[72:75], v4 offset:17408
  buffer_load_dwordx4 v10, s[4:7], s28 offen offset:256 sc1 lds
  v_smfmac_f32_16x16x64_bf16 v[16:19], v[112:115], a[64:71], v0
  s_waitcnt lgkmcnt(4)
  ds_read_b128 v[76:79], v4 offset:18432
  v_smfmac_f32_16x16x64_bf16 v[16:19], v[84:87], a[72:79], v0
  s_waitcnt lgkmcnt(4)
  ds_read_b128 v[80:83], v4 offset:19456
  v_smfmac_f32_16x16x64_bf16 v[16:19], v[88:91], a[112:119], v0
  s_waitcnt lgkmcnt(4)
  v_smfmac_f32_16x16x64_bf16 v[16:19], v[100:103], a[120:127], v0
  s_add_u32 s24, s36, 145752064
  s_add_u32 s25, s36, 145756160
  v_smfmac_f32_16x16x64_bf16 v[20:23], v[92:95], v[176:183], v0
  s_add_u32 s35, s36, s23
  v_smfmac_f32_16x16x64_bf16 v[20:23], v[96:99], v[184:191], v0
  s_waitcnt lgkmcnt(2)
  v_smfmac_f32_16x16x64_bf16 v[20:23], v[116:119], v[68:75], v0
  s_waitcnt lgkmcnt(0)
  ds_read_b128 v[68:71], v4 offset:20480
  v_mul_f32 v16, s18, v16
  v_smfmac_f32_16x16x64_bf16 v[20:23], v[124:127], v[76:83], v0
  ds_read_b128 v[72:75], v4 offset:21504
  v_mul_f32 v17, s18, v17
  v_smfmac_f32_16x16x64_bf16 v[20:23], v[104:107], a[32:39], v0
  ds_read_b128 v[76:79], v4 offset:22528
  v_mul_f32 v18, s18, v18
  v_smfmac_f32_16x16x64_bf16 v[20:23], v[108:111], a[40:47], v0
  ds_read_b128 v[80:83], v4 offset:23552
  v_mul_f32 v19, s18, v19
  v_smfmac_f32_16x16x64_bf16 v[20:23], v[112:115], a[80:87], v0
  v_cvt_pk_bf16_f32 v120, v16, v17
  v_smfmac_f32_16x16x64_bf16 v[20:23], v[84:87], a[88:95], v0
  v_cvt_pk_bf16_f32 v121, v18, v19
  v_smfmac_f32_16x16x64_bf16 v[20:23], v[88:91], a[128:135], v0
  ds_write_b64 v5, v[120:121] offset:24576
  v_smfmac_f32_16x16x64_bf16 v[20:23], v[100:103], a[136:143], v0
  s_waitcnt lgkmcnt(3)
  v_smfmac_f32_16x16x64_bf16 v[24:27], v[92:95], v[68:75], v0
  s_waitcnt lgkmcnt(1)
  v_mov_b64 v[92:93], 0
  v_smfmac_f32_16x16x64_bf16 v[24:27], v[96:99], v[76:83], v0
  s_nop 1
  v_cvt_pk_bf16_f32 v122, v20, v21
  v_cvt_pk_bf16_f32 v123, v22, v23
  v_smfmac_f32_16x16x64_bf16 v[24:27], v[116:119], v[208:215], v0
  ds_write_b64 v5, v[122:123] offset:26880
  v_mov_b64 v[94:95], 0
  v_smfmac_f32_16x16x64_bf16 v[24:27], v[124:127], v[216:223], v0
  s_waitcnt lgkmcnt(1)
  s_barrier
  ds_read_b64_tr_b16 v[68:69], v6 offset:24576
  v_smfmac_f32_16x16x64_bf16 v[24:27], v[104:107], a[48:55], v0
  s_add_u32 s27, s27, 8192
  ds_read_b64_tr_b16 v[70:71], v6 offset:24640
  ds_read_b64_tr_b16 v[72:73], v6 offset:24832
  v_smfmac_f32_16x16x64_bf16 v[24:27], v[108:111], a[56:63], v0
  s_add_u32 s28, s28, 8192
  ds_read_b64_tr_b16 v[74:75], v6 offset:24896
  ds_read_b64_tr_b16 v[76:77], v6 offset:25088
  v_smfmac_f32_16x16x64_bf16 v[24:27], v[112:115], a[96:103], v0
  s_nop 0
  ds_read_b64_tr_b16 v[78:79], v6 offset:25152
  ds_read_b64_tr_b16 v[80:81], v6 offset:25344
  v_smfmac_f32_16x16x64_bf16 v[24:27], v[84:87], a[104:111], v0
  ds_read_b64_tr_b16 v[82:83], v6 offset:25408
  v_mov_b64 v[96:97], 0
  v_smfmac_f32_16x16x64_bf16 v[24:27], v[88:91], a[144:151], v0
  s_waitcnt lgkmcnt(8)
  s_barrier
  ds_read_b64_tr_b16 v[116:117], v6 offset:26880
  v_smfmac_f32_16x16x64_bf16 v[24:27], v[100:103], a[152:159], v0
  s_waitcnt lgkmcnt(7)
  ds_read_b64_tr_b16 v[118:119], v6 offset:26944
  v_mfma_f32_16x16x32_bf16 v[16:19], v[36:39], v[68:71], 0
  s_waitcnt lgkmcnt(6)
  ds_read_b64_tr_b16 v[124:125], v6 offset:27136
  ds_read_b64_tr_b16 v[126:127], v6 offset:27200
  v_mfma_f32_16x16x32_bf16 v[16:19], v[40:43], v[72:75], v[16:19]
  s_waitcnt lgkmcnt(6)
  ds_read_b64_tr_b16 v[104:105], v6 offset:27392
  ds_read_b64_tr_b16 v[106:107], v6 offset:27456
  v_mfma_f32_16x16x32_bf16 v[16:19], v[44:47], v[76:79], v[16:19]
  s_waitcnt lgkmcnt(6)
  ds_read_b64_tr_b16 v[108:109], v6 offset:27648
  ds_read_b64_tr_b16 v[110:111], v6 offset:27712
  v_mfma_f32_16x16x32_bf16 v[16:19], v[48:51], v[80:83], v[16:19]
  s_waitcnt lgkmcnt(6)
  v_cvt_pk_bf16_f32 v120, v24, v25
  v_cvt_pk_bf16_f32 v121, v26, v27
  v_mfma_f32_16x16x32_bf16 v[112:115], v[116:119], v[68:71], 0
  s_waitcnt lgkmcnt(4)
  v_mov_b64 v[98:99], 0
  v_mfma_f32_16x16x32_bf16 v[112:115], v[124:127], v[72:75], v[112:115]
  s_waitcnt lgkmcnt(2)
  buffer_store_dwordx4 v[120:123], v2, s[4:7], s29 offen offset:1024 sc1
  v_mov_b64 v[36:37], 0
  v_exp_f32 v100, v16
  v_mfma_f32_16x16x32_bf16 v[112:115], v[104:107], v[76:79], v[112:115]
  s_waitcnt lgkmcnt(0)
  v_exp_f32 v101, v17
  v_mfma_f32_16x16x32_bf16 v[112:115], v[108:111], v[80:83], v[112:115]
  v_exp_f32 v102, v18
  v_mfma_f32_16x16x32_bf16 v[20:23], v[52:55], v[68:71], 0
  s_cmp_eq_u32 s14, 63
  v_exp_f32 v103, v19
  v_mfma_f32_16x16x32_bf16 v[20:23], v[56:59], v[72:75], v[20:23]
  s_cbranch_scc1 M_tdone
  v_cvt_pk_bf16_f32 v44, v100, v101
  v_cvt_pk_bf16_f32 v45, v102, v103
  v_mfma_f32_16x16x32_bf16 v[20:23], v[60:63], v[76:79], v[20:23]
  s_add_u32 s29, s29, 131072
  v_exp_f32 v100, v112
  v_mfma_f32_16x16x32_bf16 v[20:23], v[64:67], v[80:83], v[20:23]
  v_exp_f32 v101, v113
  v_exp_f32 v102, v114
  v_exp_f32 v103, v115
  v_cvt_pk_bf16_f32 v84, v100, v101
  v_cvt_pk_bf16_f32 v85, v102, v103
  v_cndmask_b32 v48, v84, 0, s[16:17]
  v_cndmask_b32 v49, v85, 0, s[16:17]
  v_cndmask_b32 v50, 0, v84, s[16:17]
  v_cndmask_b32 v51, 0, v85, s[16:17]
  v_exp_f32 v100, v20
  v_mfma_f32_16x16x16_bf16 v[88:91], v[12:13], v[48:49], 0
  v_exp_f32 v101, v21
  v_mfma_f32_16x16x16_bf16 v[24:27], v[120:121], v[48:49], 0
  v_exp_f32 v102, v22
  v_mfma_f32_16x16x16_bf16 v[116:119], v[120:121], v[50:51], 0
  v_exp_f32 v103, v23
  v_cvt_pk_bf16_f32 v46, v100, v101
  v_cvt_pk_bf16_f32 v47, v102, v103
  v_mov_b64 v[38:39], 0
  s_nop 0
  v_mfma_f32_16x16x32_bf16 v[88:91], v[12:15], v[44:47], v[88:91]
  v_mov_b64 v[40:41], 0
  v_mov_b64 v[42:43], 0
  v_mfma_f32_16x16x32_bf16 v[24:27], v[28:31], v[44:47], v[24:27]
  ds_read_b128 v[52:55], v4 offset:24576
  ds_read_b128 v[56:59], v4 offset:25600
  v_mfma_f32_16x16x32_bf16 v[116:119], v[32:35], v[44:47], v[116:119]
  s_nop 1
  v_rcp_f32 v89, v88
  v_subrev_u32 v100, s54, v88
  v_cmp_le_u32 vcc, s55, v100
  v_mul_f32 v24, v89, v24
  v_mul_f32 v25, v89, v25
  s_cbranch_vccnz T_slow_174
T_back_175:
  v_cvt_pk_bf16_f32 v124, v24, v25
  v_pk_mul_f32 v[26:27], v[26:27], v[88:89] op_sel:[0,1] op_sel_hi:[1,1]
  v_pk_mul_f32 v[116:117], v[116:117], v[88:89] op_sel:[0,1] op_sel_hi:[1,1]
  v_pk_mul_f32 v[118:119], v[118:119], v[88:89] op_sel:[0,1] op_sel_hi:[1,1]
  v_cvt_pk_bf16_f32 v125, v26, v27
  v_cvt_pk_bf16_f32 v126, v116, v117
  v_cvt_pk_bf16_f32 v127, v118, v119
  ds_write_b128 v11, v[124:127] offset:29696
  s_nop 0
  v_smfmac_f32_16x16x64_bf16 v[92:95], v[124:127], a[160:167], v0
  v_smfmac_f32_16x16x64_bf16 v[96:99], v[124:127], a[168:175], v0
  v_smfmac_f32_16x16x64_bf16 v[36:39], v[124:127], a[176:183], v0
  v_smfmac_f32_16x16x64_bf16 v[40:43], v[124:127], a[184:191], v0
  s_waitcnt lgkmcnt(0)
  s_barrier
  ds_read_b128 v[104:107], v11 offset:29184
  ds_read_b128 v[108:111], v11 offset:30720
  ds_read_b128 v[68:71], v11 offset:30208
  s_waitcnt lgkmcnt(2)
  v_smfmac_f32_16x16x64_bf16 v[92:95], v[104:107], a[192:199], v0
  s_waitcnt lgkmcnt(1)
  ds_read_b128 v[76:79], v4 offset:28672
  v_smfmac_f32_16x16x64_bf16 v[92:95], v[108:111], a[224:231], v0
  s_waitcnt lgkmcnt(1)
  ds_read_b128 v[80:83], v4 offset:29696
  v_smfmac_f32_16x16x64_bf16 v[92:95], v[68:71], a[240:247], v0
  ds_read_b128 v[60:63], v4 offset:26624
  v_smfmac_f32_16x16x64_bf16 v[96:99], v[104:107], a[200:207], v0
  ds_read_b128 v[64:67], v4 offset:27648
  v_smfmac_f32_16x16x64_bf16 v[96:99], v[108:111], a[232:239], v0
  ds_read_b128 v[28:31], v4 offset:30720
  s_nop 0
  v_cvt_pk_bf16_f32 v16, v92, v93
  v_cvt_pk_bf16_f32 v17, v94, v95
  v_bfi_b32 v16, 1, s57, v16
  v_smfmac_f32_16x16x64_bf16 v[96:99], v[68:71], a[248:255], v0
  buffer_store_dwordx2 v[16:17], v7, s[4:7], s20 offen offset:0 sc1
  v_smfmac_f32_16x16x64_bf16 v[36:39], v[104:107], a[208:215], v0
  ds_read_b128 v[32:35], v4 offset:31744
  v_smfmac_f32_16x16x64_bf16 v[36:39], v[108:111], v[52:59], v0
  s_waitcnt lgkmcnt(4)
  s_nop 0
  v_cvt_pk_bf16_f32 v18, v96, v97
  v_cvt_pk_bf16_f32 v19, v98, v99
  v_bfi_b32 v18, 1, s57, v18
  v_smfmac_f32_16x16x64_bf16 v[36:39], v[68:71], v[76:83], v0
  buffer_store_dwordx2 v[18:19], v7, s[4:7], s20 offen offset:64 sc1
  v_smfmac_f32_16x16x64_bf16 v[40:43], v[104:107], a[216:223], v0
  s_waitcnt lgkmcnt(2)
  ds_read_b128 v[116:119], v2 offset:31232
  v_smfmac_f32_16x16x64_bf16 v[40:43], v[108:111], v[60:67], v0
  s_waitcnt lgkmcnt(1)
  s_nop 0
  v_cvt_pk_bf16_f32 v20, v36, v37
  v_cvt_pk_bf16_f32 v21, v38, v39
  v_bfi_b32 v20, 1, s57, v20
  v_smfmac_f32_16x16x64_bf16 v[40:43], v[68:71], v[28:35], v0
  buffer_store_dwordx2 v[20:21], v7, s[4:7], s21 offen offset:0 sc1
  s_nop 6
  v_cvt_pk_bf16_f32 v22, v40, v41
  v_cvt_pk_bf16_f32 v23, v42, v43
  v_bfi_b32 v22, 1, s57, v22
  buffer_store_dwordx2 v[22:23], v7, s[4:7], s21 offen offset:64 sc1
  ds_read_b128 v[68:71], v4 offset:0
  ds_read_b128 v[72:75], v4 offset:1024
  ds_read_b128 v[76:79], v4 offset:4096
  ds_read_b128 v[80:83], v4 offset:5120
  ds_read_b128 v[84:87], v4 offset:8192
  ds_read_b128 v[88:91], v4 offset:9216
  ds_read_b128 v[92:95], v4 offset:2048
  ds_read_b128 v[96:99], v4 offset:3072
  ds_read_b128 v[100:103], v4 offset:6144
  ds_read_b128 v[104:107], v4 offset:7168
  ds_read_b128 v[108:111], v4 offset:10240
  ds_read_b128 v[112:115], v4 offset:11264
  v_mov_b64 v[16:17], 0
  v_mov_b64 v[18:19], 0
  v_mov_b64 v[20:21], 0
  v_mov_b64 v[22:23], 0
  v_mov_b64 v[24:25], 0
  v_mov_b64 v[26:27], 0
  s_mov_b32 s19, 0
  v_mov_b32 v49, -1
  ds_read_b64 v[44:45], v2 offset:32256
  s_waitcnt lgkmcnt(0)
  v_readfirstlane_b32 s38, v44
  v_readfirstlane_b32 s37, v45
  s_nop 0
  s_add_u32 s37, s37, 30
  s_cmp_ge_u32 s38, 30
  s_cselect_b32 s38, s37, s38
  s_cmp_ge_u32 s38, 64
  s_cselect_b32 s38, 100, s38
  s_sub_u32 s38, s38, 1
  s_max_i32 s30, s30, s38
  s_waitcnt vmcnt(0)
  buffer_load_dwordx4 v[52:55], v2, s[4:7], s22 offen offset:0 sc1
  buffer_load_dwordx4 v[56:59], v2, s[4:7], s22 offen offset:1024 sc1
  buffer_load_dwordx4 v[60:63], v2, s[4:7], s22 offen offset:2048 sc1
  buffer_load_dwordx4 v[64:67], v2, s[4:7], s22 offen offset:3072 sc1
  s_waitcnt lgkmcnt(12)
  s_waitcnt vmcnt(3)
  v_mfma_f32_16x16x32_bf16 v[120:123], v[116:119], v[52:55], 0
  v_xor_b32 v48, s57, v52
  v_bitop3_b32 v48, v48, v54, s57 bitop3:0xf6
  s_waitcnt vmcnt(2)
  v_mfma_f32_16x16x32_bf16 v[120:123], v[116:119], v[56:59], v[120:123]
  v_bitop3_b32 v48, v48, v56, s57 bitop3:0xf6
  v_bitop3_b32 v48, v48, v58, s57 bitop3:0xf6
  s_waitcnt vmcnt(1)
  v_mfma_f32_16x16x32_bf16 v[120:123], v[116:119], v[60:63], v[120:123]
  v_bitop3_b32 v48, v48, v60, s57 bitop3:0xf6
  v_bitop3_b32 v48, v48, v62, s57 bitop3:0xf6
  s_waitcnt vmcnt(0)
  v_mfma_f32_16x16x32_bf16 v[120:123], v[116:119], v[64:67], v[120:123]
  v_bitop3_b32 v48, v48, v64, s57 bitop3:0xf6
  v_bitop3_b32 v48, v48, v66, s57 bitop3:0xf6
  v_and_b32 v48, 1, v48
  v_cmp_ne_u32 vcc, 0, v48
  s_cbranch_vccnz T_p1re_177
T_p1ok_178:
  s_nop 2
  v_add_f32_dpp v120, v120, v120 row_ror:8 row_mask:0xf bank_mask:0xf
  v_add_f32_dpp v121, v121, v121 row_ror:8 row_mask:0xf bank_mask:0xf
  v_cvt_pk_bf16_f32 v48, v120, v121
  buffer_store_dword v48, v8, s[4:7], s35 offen sc1
  buffer_store_dword v49, v8, s[4:7], s26 offen sc1
  s_barrier
  ds_read_b128 v[28:31], v2 offset:17408
  ds_read_b128 v[32:35], v2 offset:21504
  ds_read_b128 v[36:39], v2 offset:8192
  ds_read_b128 v[40:43], v2 offset:9216
  ds_read_b128 v[44:47], v2 offset:10240
  ds_read_b128 v[48:51], v2 offset:11264
  buffer_load_dwordx4 v[124:127], v2, s[4:7], s24 offen offset:1024 sc1
  buffer_load_dwordx4 v[116:119], v2, s[4:7], s25 offen offset:1024 sc1
  ds_read_b128 v[52:55], v2 offset:12288
  ds_read_b128 v[56:59], v2 offset:13312
  ds_read_b128 v[60:63], v2 offset:14336
  ds_read_b128 v[64:67], v2 offset:15360
  buffer_load_dwordx4 v[124:127], v2, s[4:7], s24 offen offset:1024 sc1
  buffer_load_dwordx4 v[116:119], v2, s[4:7], s25 offen offset:1024 sc1
  s_mov_b32 s19, 0
  s_branch T_loop_167
T_p1re_177:
  s_mov_b64 exec, vcc
  buffer_load_dwordx4 v[52:55], v2, s[4:7], s22 offen offset:0 sc1
  buffer_load_dwordx4 v[56:59], v2, s[4:7], s22 offen offset:1024 sc1
  buffer_load_dwordx4 v[60:63], v2, s[4:7], s22 offen offset:2048 sc1
  buffer_load_dwordx4 v[64:67], v2, s[4:7], s22 offen offset:3072 sc1
  s_mov_b64 exec, -1
  s_add_u32 s19, s19, 1
  s_cmp_gt_u32 s19, 32768
  s_cbranch_scc1 M_exit
  s_waitcnt vmcnt(3)
  v_mfma_f32_16x16x32_bf16 v[120:123], v[116:119], v[52:55], 0
  v_xor_b32 v48, s57, v52
  v_bitop3_b32 v48, v48, v54, s57 bitop3:0xf6
  s_waitcnt vmcnt(2)
  v_mfma_f32_16x16x32_bf16 v[120:123], v[116:119], v[56:59], v[120:123]
  v_bitop3_b32 v48, v48, v56, s57 bitop3:0xf6
  v_bitop3_b32 v48, v48, v58, s57 bitop3:0xf6
  s_waitcnt vmcnt(1)
  v_mfma_f32_16x16x32_bf16 v[120:123], v[116:119], v[60:63], v[120:123]
  v_bitop3_b32 v48, v48, v60, s57 bitop3:0xf6
  v_bitop3_b32 v48, v48, v62, s57 bitop3:0xf6
  s_waitcnt vmcnt(0)
  v_mfma_f32_16x16x32_bf16 v[120:123], v[116:119], v[64:67], v[120:123]
  v_bitop3_b32 v48, v48, v64, s57 bitop3:0xf6
  v_bitop3_b32 v48, v48, v66, s57 bitop3:0xf6
  v_and_b32 v48, 1, v48
  v_cmp_ne_u32 vcc, 0, v48
  s_cbranch_vccnz T_p1re_177
  s_branch T_p1ok_178
T_kvw_171:
  s_mov_b32 s19, 0
  s_branch T_kvok_180
T_kv_179:
  s_sleep 4
  s_add_u32 s19, s19, 1
  s_cmp_gt_u32 s19, 32768
  s_cbranch_scc1 M_exit
T_kvok_180:
  s_add_u32 s39, s99, 128
  s_mov_b32 s38, 0
  s_mov_b32 s37, 0
  s_atomic_or s38, s[58:59], s99 glc
  s_atomic_or s37, s[58:59], s39 glc
  s_waitcnt lgkmcnt(0)
  s_add_u32 s37, s37, 30
  s_cmp_ge_u32 s38, 30
  s_cselect_b32 s38, s37, s38
  s_cmp_ge_u32 s38, 64
  s_cselect_b32 s38, 100, s38
  s_sub_u32 s38, s38, 1
  s_max_i32 s30, s30, s38
  s_cmp_ge_i32 s14, s30
  s_cbranch_scc1 T_kv_179
  s_branch T_kvb_172
T_slow_174:
  s_nop 7
  v_max3_f32 v100, v16, v17, v18
  v_max3_f32 v100, v100, v19, v20
  v_max3_f32 v100, v100, v21, v22
  v_max3_f32 v100, v100, v23, v112
  v_max3_f32 v100, v100, v113, v114
  v_max_f32 v100, v100, v115
  v_mov_b32 v101, v100
  s_nop 1
  v_permlane32_swap_b32 v100, v101
  s_nop 1
  v_max_f32 v100, v100, v101
  v_mov_b32 v101, v100
  s_nop 1
  v_permlane16_swap_b32 v100, v101
  s_nop 1
  v_max_f32 v100, v100, v101
  v_sub_f32 v16, v16, v100
  v_sub_f32 v17, v17, v100
  v_sub_f32 v18, v18, v100
  v_sub_f32 v19, v19, v100
  v_exp_f32 v16, v16
  v_exp_f32 v17, v17
  v_exp_f32 v18, v18
  v_exp_f32 v19, v19
  v_sub_f32 v20, v20, v100
  v_sub_f32 v21, v21, v100
  v_sub_f32 v22, v22, v100
  v_sub_f32 v23, v23, v100
  v_exp_f32 v20, v20
  v_exp_f32 v21, v21
  v_exp_f32 v22, v22
  v_exp_f32 v23, v23
  v_sub_f32 v112, v112, v100
  v_sub_f32 v113, v113, v100
  v_sub_f32 v114, v114, v100
  v_sub_f32 v115, v115, v100
  v_exp_f32 v112, v112
  v_exp_f32 v113, v113
  v_exp_f32 v114, v114
  v_exp_f32 v115, v115
  s_nop 0
  v_cvt_pk_bf16_f32 v44, v16, v17
  v_cvt_pk_bf16_f32 v45, v18, v19
  v_cvt_pk_bf16_f32 v46, v20, v21
  v_cvt_pk_bf16_f32 v47, v22, v23
  v_cvt_pk_bf16_f32 v84, v112, v113
  v_cvt_pk_bf16_f32 v85, v114, v115
  v_cndmask_b32 v48, v84, 0, s[16:17]
  v_cndmask_b32 v49, v85, 0, s[16:17]
  v_cndmask_b32 v50, 0, v84, s[16:17]
  v_cndmask_b32 v51, 0, v85, s[16:17]
  s_nop 1
  v_mfma_f32_16x16x16_bf16 v[88:91], v[12:13], v[48:49], 0
  v_mfma_f32_16x16x16_bf16 v[24:27], v[120:121], v[48:49], 0
  v_mfma_f32_16x16x16_bf16 v[116:119], v[120:121], v[50:51], 0
  v_mfma_f32_16x16x32_bf16 v[88:91], v[12:15], v[44:47], v[88:91]
  v_mfma_f32_16x16x32_bf16 v[24:27], v[28:31], v[44:47], v[24:27]
  v_mfma_f32_16x16x32_bf16 v[116:119], v[32:35], v[44:47], v[116:119]
  s_nop 7
  s_nop 1
  v_rcp_f32 v89, v88
  s_nop 0
  v_mul_f32 v24, v89, v24
  v_mul_f32 v25, v89, v25
  s_branch T_back_175
T_w_151:
  s_mov_b32 s19, 0
  v_mov_b64 v[16:17], 0
  v_mov_b64 v[18:19], 0
  v_mov_b64 v[20:21], 0
  v_mov_b64 v[22:23], 0
  v_mov_b64 v[24:25], 0
  v_mov_b64 v[26:27], 0
  buffer_load_dwordx4 v[124:127], v2, s[4:7], s24 offen offset:2048 sc1
  buffer_load_dwordx4 v[116:119], v2, s[4:7], s25 offen offset:2048 sc1
  buffer_load_dwordx4 v[124:127], v2, s[4:7], s24 offen offset:2048 sc1
  buffer_load_dwordx4 v[116:119], v2, s[4:7], s25 offen offset:2048 sc1
  s_branch T_loop_181
.p2align 6
T_retry_182:
  s_mov_b64 exec, vcc
  buffer_load_dwordx4 v[124:127], v2, s[4:7], s24 offen offset:2048 sc1
  buffer_load_dwordx4 v[116:119], v2, s[4:7], s25 offen offset:2048 sc1
  s_mov_b64 exec, -1
  s_add_u32 s19, s19, 1
  s_cmp_gt_u32 s19, 32768
  s_cbranch_scc1 M_exit
T_loop_181:
  s_waitcnt vmcnt(3) lgkmcnt(0)
  v_max3_u32 v123, v124, v125, v126
  v_max_u32 v123, v123, v127
  v_mov_b32_dpp v120, v124 row_ror:8 row_mask:0xf bank_mask:0xf
  v_mov_b32_dpp v121, v125 row_ror:8 row_mask:0xf bank_mask:0xf
  s_waitcnt vmcnt(2)
  v_max3_u32 v123, v123, v116, v117
  v_max3_u32 v123, v123, v118, v119
  v_cmp_eq_u32 vcc, -1, v123
  s_cbranch_vccnz T_retry_182
  v_smfmac_f32_16x16x64_bf16 v[16:19], v[124:127], v[68:75], v0
  s_add_u32 s14, s14, 1
  ds_write_b128 v2, v[124:127] offset:2048
  v_mov_b32_dpp v122, v126 row_ror:8 row_mask:0xf bank_mask:0xf
  v_smfmac_f32_16x16x64_bf16 v[20:23], v[124:127], v[76:83], v0
  s_and_b32 s57, s14, 1
  v_mov_b32_dpp v123, v127 row_ror:8 row_mask:0xf bank_mask:0xf
  v_smfmac_f32_16x16x64_bf16 v[24:27], v[124:127], v[84:91], v0
  s_and_b32 s36, s14, 3
  ds_write_b128 v2, v[116:119] offset:6144
  v_smfmac_f32_16x16x64_bf16 v[16:19], v[120:123], v[92:99], v0
  s_lshl_b32 s36, s36, 13
  v_mov_b32_dpp v84, v116 row_ror:8 row_mask:0xf bank_mask:0xf
  v_smfmac_f32_16x16x64_bf16 v[20:23], v[120:123], v[100:107], v0
  s_add_u32 s26, s36, s23
  ds_read_b128 v[68:71], v4 offset:12288
  v_mov_b32_dpp v85, v117 row_ror:8 row_mask:0xf bank_mask:0xf
  v_smfmac_f32_16x16x64_bf16 v[24:27], v[120:123], v[108:115], v0
  s_add_u32 s36, s36, 8192
  ds_read_b128 v[72:75], v4 offset:13312
  v_mov_b32_dpp v86, v118 row_ror:8 row_mask:0xf bank_mask:0xf
  v_smfmac_f32_16x16x64_bf16 v[16:19], v[116:119], v[224:231], v0
  s_and_b32 s36, s36, 0x7fff
  ds_read_b128 v[76:79], v4 offset:14336
  v_mov_b32_dpp v87, v119 row_ror:8 row_mask:0xf bank_mask:0xf
  v_smfmac_f32_16x16x64_bf16 v[20:23], v[116:119], v[240:247], v0
  s_waitcnt lgkmcnt(3)
  s_barrier
  ds_read_b128 v[100:103], v2 offset:3072
  v_smfmac_f32_16x16x64_bf16 v[24:27], v[116:119], a[0:7], v0
  s_mov_b32 m0, s31
  ds_read_b128 v[120:123], v1 offset:3072
  v_smfmac_f32_16x16x64_bf16 v[16:19], v[84:87], v[232:239], v0
  s_cmp_ge_i32 s14, s30
  s_cbranch_scc1 T_kvw_185
T_kvb_186:
  v_smfmac_f32_16x16x64_bf16 v[20:23], v[84:87], v[248:255], v0
  ds_read_b128 v[80:83], v4 offset:15360
  v_smfmac_f32_16x16x64_bf16 v[24:27], v[84:87], a[8:15], v0
  s_waitcnt lgkmcnt(2)
  v_smfmac_f32_16x16x64_bf16 v[16:19], v[100:103], v[128:135], v0
  ds_read_b128 v[92:95], v2 offset:0
  buffer_load_dwordx4 v9, s[4:7], s27 offen sc1 lds
  v_smfmac_f32_16x16x64_bf16 v[20:23], v[100:103], v[144:151], v0
  ds_read_b128 v[96:99], v1 offset:0
  s_mov_b32 m0, s32
  v_smfmac_f32_16x16x64_bf16 v[24:27], v[100:103], v[68:75], v0
  s_waitcnt vmcnt(1) lgkmcnt(3)
  ds_read_b128 v[116:119], v2 offset:1024
  v_smfmac_f32_16x16x64_bf16 v[16:19], v[120:123], v[136:143], v0
  ds_read_b128 v[124:127], v1 offset:1024
  v_smfmac_f32_16x16x64_bf16 v[20:23], v[120:123], v[152:159], v0
  s_waitcnt lgkmcnt(4)
  ds_read_b128 v[104:107], v2 offset:7168
  buffer_load_dwordx4 v9, s[4:7], s27 offen offset:128 sc1 lds
  v_smfmac_f32_16x16x64_bf16 v[24:27], v[120:123], v[76:83], v0
  s_waitcnt lgkmcnt(4)
  ds_read_b128 v[108:111], v1 offset:7168
  s_mov_b32 m0, s33
  v_smfmac_f32_16x16x64_bf16 v[16:19], v[92:95], v[160:167], v0
  s_waitcnt lgkmcnt(4)
  ds_read_b128 v[112:115], v2 offset:4096
  v_mov_b32 v122, s98
  v_smfmac_f32_16x16x64_bf16 v[16:19], v[96:99], v[168:175], v0
  s_waitcnt lgkmcnt(4)
  ds_read_b128 v[84:87], v1 offset:4096
  v_smfmac_f32_16x16x64_bf16 v[16:19], v[116:119], v[192:199], v0
  s_waitcnt lgkmcnt(4)
  ds_read_b128 v[88:91], v2 offset:5120
  buffer_load_dwordx4 v10, s[4:7], s28 offen sc1 lds
  v_smfmac_f32_16x16x64_bf16 v[16:19], v[124:127], v[200:207], v0
  s_waitcnt lgkmcnt(4)
  ds_read_b128 v[100:103], v1 offset:5120
  s_mov_b32 m0, s34
  v_smfmac_f32_16x16x64_bf16 v[16:19], v[104:107], a[16:23], v0
  s_waitcnt lgkmcnt(4)
  ds_read_b128 v[68:71], v4 offset:16384
  v_smfmac_f32_16x16x64_bf16 v[16:19], v[108:111], a[24:31], v0
  s_waitcnt lgkmcnt(4)
  ds_read_b128 v[72:75], v4 offset:17408
  v_smfmac_f32_16x16x64_bf16 v[16:19], v[112:115], a[64:71], v0
  s_waitcnt lgkmcnt(4)
  ds_read_b128 v[76:79], v4 offset:18432
  buffer_load_dwordx4 v10, s[4:7], s28 offen offset:256 sc1 lds
  v_smfmac_f32_16x16x64_bf16 v[16:19], v[84:87], a[72:79], v0
  s_waitcnt lgkmcnt(4)
  ds_read_b128 v[80:83], v4 offset:19456
  v_smfmac_f32_16x16x64_bf16 v[16:19], v[88:91], a[112:119], v0
  s_waitcnt lgkmcnt(4)
  v_smfmac_f32_16x16x64_bf16 v[16:19], v[100:103], a[120:127], v0
  s_add_u32 s24, s36, 145752064
  s_add_u32 s25, s36, 145756160
  v_smfmac_f32_16x16x64_bf16 v[20:23], v[92:95], v[176:183], v0
  buffer_store_dword v122, v3, s[4:7], s15 offen sc1
  s_add_u32 s35, s36, s23
  v_smfmac_f32_16x16x64_bf16 v[20:23], v[96:99], v[184:191], v0
  s_waitcnt lgkmcnt(2)
  s_add_u32 s98, s14, 1
  v_smfmac_f32_16x16x64_bf16 v[20:23], v[116:119], v[68:75], v0
  s_waitcnt lgkmcnt(0)
  ds_read_b128 v[68:71], v4 offset:20480
  v_mul_f32 v16, s18, v16
  v_smfmac_f32_16x16x64_bf16 v[20:23], v[124:127], v[76:83], v0
  ds_read_b128 v[72:75], v4 offset:21504
  v_mul_f32 v17, s18, v17
  v_smfmac_f32_16x16x64_bf16 v[20:23], v[104:107], a[32:39], v0
  ds_read_b128 v[76:79], v4 offset:22528
  v_mul_f32 v18, s18, v18
  v_smfmac_f32_16x16x64_bf16 v[20:23], v[108:111], a[40:47], v0
  ds_read_b128 v[80:83], v4 offset:23552
  v_mul_f32 v19, s18, v19
  v_smfmac_f32_16x16x64_bf16 v[20:23], v[112:115], a[80:87], v0
  v_cvt_pk_bf16_f32 v120, v16, v17
  v_smfmac_f32_16x16x64_bf16 v[20:23], v[84:87], a[88:95], v0
  v_cvt_pk_bf16_f32 v121, v18, v19
  v_smfmac_f32_16x16x64_bf16 v[20:23], v[88:91], a[128:135], v0
  ds_write_b64 v5, v[120:121] offset:24576
  v_smfmac_f32_16x16x64_bf16 v[20:23], v[100:103], a[136:143], v0
  s_waitcnt lgkmcnt(3)
  v_smfmac_f32_16x16x64_bf16 v[24:27], v[92:95], v[68:75], v0
  s_waitcnt lgkmcnt(1)
  v_mov_b64 v[92:93], 0
  v_smfmac_f32_16x16x64_bf16 v[24:27], v[96:99], v[76:83], v0
  s_nop 1
  v_cvt_pk_bf16_f32 v122, v20, v21
  v_cvt_pk_bf16_f32 v123, v22, v23
  v_smfmac_f32_16x16x64_bf16 v[24:27], v[116:119], v[208:215], v0
  ds_write_b64 v5, v[122:123] offset:26880
  v_mov_b64 v[94:95], 0
  v_smfmac_f32_16x16x64_bf16 v[24:27], v[124:127], v[216:223], v0
  s_waitcnt lgkmcnt(1)
  s_barrier
  ds_read_b64_tr_b16 v[68:69], v6 offset:24576
  v_smfmac_f32_16x16x64_bf16 v[24:27], v[104:107], a[48:55], v0
  s_add_u32 s27, s27, 8192
  ds_read_b64_tr_b16 v[70:71], v6 offset:24640
  ds_read_b64_tr_b16 v[72:73], v6 offset:24832
  v_smfmac_f32_16x16x64_bf16 v[24:27], v[108:111], a[56:63], v0
  s_add_u32 s28, s28, 8192
  ds_read_b64_tr_b16 v[74:75], v6 offset:24896
  ds_read_b64_tr_b16 v[76:77], v6 offset:25088
  v_smfmac_f32_16x16x64_bf16 v[24:27], v[112:115], a[96:103], v0
  s_nop 0
  ds_read_b64_tr_b16 v[78:79], v6 offset:25152
  ds_read_b64_tr_b16 v[80:81], v6 offset:25344
  v_smfmac_f32_16x16x64_bf16 v[24:27], v[84:87], a[104:111], v0
  ds_read_b64_tr_b16 v[82:83], v6 offset:25408
  v_mov_b64 v[96:97], 0
  v_smfmac_f32_16x16x64_bf16 v[24:27], v[88:91], a[144:151], v0
  s_waitcnt lgkmcnt(8)
  s_barrier
  ds_read_b64_tr_b16 v[116:117], v6 offset:26880
  v_smfmac_f32_16x16x64_bf16 v[24:27], v[100:103], a[152:159], v0
  s_waitcnt lgkmcnt(7)
  ds_read_b64_tr_b16 v[118:119], v6 offset:26944
  v_mfma_f32_16x16x32_bf16 v[16:19], v[36:39], v[68:71], 0
  s_waitcnt lgkmcnt(6)
  ds_read_b64_tr_b16 v[124:125], v6 offset:27136
  ds_read_b64_tr_b16 v[126:127], v6 offset:27200
  v_mfma_f32_16x16x32_bf16 v[16:19], v[40:43], v[72:75], v[16:19]
  s_waitcnt lgkmcnt(6)
  ds_read_b64_tr_b16 v[104:105], v6 offset:27392
  ds_read_b64_tr_b16 v[106:107], v6 offset:27456
  v_mfma_f32_16x16x32_bf16 v[16:19], v[44:47], v[76:79], v[16:19]
  s_waitcnt lgkmcnt(6)
  ds_read_b64_tr_b16 v[108:109], v6 offset:27648
  ds_read_b64_tr_b16 v[110:111], v6 offset:27712
  v_mfma_f32_16x16x32_bf16 v[16:19], v[48:51], v[80:83], v[16:19]
  s_waitcnt lgkmcnt(6)
  v_cvt_pk_bf16_f32 v120, v24, v25
  v_cvt_pk_bf16_f32 v121, v26, v27
  v_mfma_f32_16x16x32_bf16 v[112:115], v[116:119], v[68:71], 0
  s_waitcnt lgkmcnt(4)
  v_mov_b64 v[98:99], 0
  v_mfma_f32_16x16x32_bf16 v[112:115], v[124:127], v[72:75], v[112:115]
  s_waitcnt lgkmcnt(2)
  v_mov_b64 v[36:37], 0
  v_exp_f32 v100, v16
  v_mfma_f32_16x16x32_bf16 v[112:115], v[104:107], v[76:79], v[112:115]
  s_waitcnt lgkmcnt(0)
  buffer_store_dwordx4 v[120:123], v2, s[4:7], s29 offen offset:2048 sc1
  v_exp_f32 v101, v17
  v_mfma_f32_16x16x32_bf16 v[112:115], v[108:111], v[80:83], v[112:115]
  v_exp_f32 v102, v18
  v_mfma_f32_16x16x32_bf16 v[20:23], v[52:55], v[68:71], 0
  s_cmp_eq_u32 s14, 63
  v_exp_f32 v103, v19
  v_mfma_f32_16x16x32_bf16 v[20:23], v[56:59], v[72:75], v[20:23]
  s_cbranch_scc1 M_tdone
  v_cvt_pk_bf16_f32 v44, v100, v101
  v_cvt_pk_bf16_f32 v45, v102, v103
  v_mfma_f32_16x16x32_bf16 v[20:23], v[60:63], v[76:79], v[20:23]
  s_add_u32 s29, s29, 131072
  v_exp_f32 v100, v112
  v_mfma_f32_16x16x32_bf16 v[20:23], v[64:67], v[80:83], v[20:23]
  v_exp_f32 v101, v113
  v_exp_f32 v102, v114
  v_exp_f32 v103, v115
  v_cvt_pk_bf16_f32 v84, v100, v101
  v_cvt_pk_bf16_f32 v85, v102, v103
  v_cndmask_b32 v48, v84, 0, s[16:17]
  v_cndmask_b32 v49, v85, 0, s[16:17]
  v_cndmask_b32 v50, 0, v84, s[16:17]
  v_cndmask_b32 v51, 0, v85, s[16:17]
  v_exp_f32 v100, v20
  v_mfma_f32_16x16x16_bf16 v[88:91], v[12:13], v[48:49], 0
  v_exp_f32 v101, v21
  v_mfma_f32_16x16x16_bf16 v[24:27], v[120:121], v[48:49], 0
  v_exp_f32 v102, v22
  v_mfma_f32_16x16x16_bf16 v[116:119], v[120:121], v[50:51], 0
  v_exp_f32 v103, v23
  v_cvt_pk_bf16_f32 v46, v100, v101
  v_cvt_pk_bf16_f32 v47, v102, v103
  v_mov_b64 v[38:39], 0
  s_nop 0
  v_mfma_f32_16x16x32_bf16 v[88:91], v[12:15], v[44:47], v[88:91]
  v_mov_b64 v[40:41], 0
  v_mov_b64 v[42:43], 0
  v_mfma_f32_16x16x32_bf16 v[24:27], v[28:31], v[44:47], v[24:27]
  ds_read_b128 v[52:55], v4 offset:24576
  ds_read_b128 v[56:59], v4 offset:25600
  v_mfma_f32_16x16x32_bf16 v[116:119], v[32:35], v[44:47], v[116:119]
  s_nop 1
  v_rcp_f32 v89, v88
  v_subrev_u32 v100, s54, v88
  v_cmp_le_u32 vcc, s55, v100
  v_mul_f32 v24, v89, v24
  v_mul_f32 v25, v89, v25
  s_cbranch_vccnz T_slow_188
T_back_189:
  v_cvt_pk_bf16_f32 v124, v24, v25
  v_pk_mul_f32 v[26:27], v[26:27], v[88:89] op_sel:[0,1] op_sel_hi:[1,1]
  v_pk_mul_f32 v[116:117], v[116:117], v[88:89] op_sel:[0,1] op_sel_hi:[1,1]
  v_pk_mul_f32 v[118:119], v[118:119], v[88:89] op_sel:[0,1] op_sel_hi:[1,1]
  v_cvt_pk_bf16_f32 v125, v26, v27
  v_cvt_pk_bf16_f32 v126, v116, v117
  v_cvt_pk_bf16_f32 v127, v118, v119
  ds_write_b128 v11, v[124:127] offset:30208
  s_nop 0
  v_smfmac_f32_16x16x64_bf16 v[92:95], v[124:127], a[160:167], v0
  v_smfmac_f32_16x16x64_bf16 v[96:99], v[124:127], a[168:175], v0
  v_smfmac_f32_16x16x64_bf16 v[36:39], v[124:127], a[176:183], v0
  v_smfmac_f32_16x16x64_bf16 v[40:43], v[124:127], a[184:191], v0
  s_waitcnt lgkmcnt(0)
  s_barrier
  ds_read_b128 v[104:107], v11 offset:30720
  ds_read_b128 v[108:111], v11 offset:29184
  ds_read_b128 v[68:71], v11 offset:29696
  s_waitcnt lgkmcnt(2)
  v_smfmac_f32_16x16x64_bf16 v[92:95], v[104:107], a[192:199], v0
  s_waitcnt lgkmcnt(1)
  ds_read_b128 v[76:79], v4 offset:28672
  v_smfmac_f32_16x16x64_bf16 v[92:95], v[108:111], a[224:231], v0
  s_waitcnt lgkmcnt(1)
  ds_read_b128 v[80:83], v4 offset:29696
  v_smfmac_f32_16x16x64_bf16 v[92:95], v[68:71], a[240:247], v0
  ds_read_b128 v[60:63], v4 offset:26624
  v_smfmac_f32_16x16x64_bf16 v[96:99], v[104:107], a[200:207], v0
  ds_read_b128 v[64:67], v4 offset:27648
  v_smfmac_f32_16x16x64_bf16 v[96:99], v[108:111], a[232:239], v0
  ds_read_b128 v[28:31], v4 offset:30720
  s_nop 0
  v_cvt_pk_bf16_f32 v16, v92, v93
  v_cvt_pk_bf16_f32 v17, v94, v95
  v_bfi_b32 v16, 1, s57, v16
  v_smfmac_f32_16x16x64_bf16 v[96:99], v[68:71], a[248:255], v0
  buffer_store_dwordx2 v[16:17], v7, s[4:7], s20 offen offset:0 sc1
  v_smfmac_f32_16x16x64_bf16 v[36:39], v[104:107], a[208:215], v0
  ds_read_b128 v[32:35], v4 offset:31744
  v_smfmac_f32_16x16x64_bf16 v[36:39], v[108:111], v[52:59], v0
  s_waitcnt lgkmcnt(4)
  s_nop 0
  v_cvt_pk_bf16_f32 v18, v96, v97
  v_cvt_pk_bf16_f32 v19, v98, v99
  v_bfi_b32 v18, 1, s57, v18
  v_smfmac_f32_16x16x64_bf16 v[36:39], v[68:71], v[76:83], v0
  buffer_store_dwordx2 v[18:19], v7, s[4:7], s20 offen offset:64 sc1
  v_smfmac_f32_16x16x64_bf16 v[40:43], v[104:107], a[216:223], v0
  s_waitcnt lgkmcnt(2)
  v_smfmac_f32_16x16x64_bf16 v[40:43], v[108:111], v[60:67], v0
  s_waitcnt lgkmcnt(0)
  s_nop 0
  v_cvt_pk_bf16_f32 v20, v36, v37
  v_cvt_pk_bf16_f32 v21, v38, v39
  v_bfi_b32 v20, 1, s57, v20
  v_smfmac_f32_16x16x64_bf16 v[40:43], v[68:71], v[28:35], v0
  buffer_store_dwordx2 v[20:21], v7, s[4:7], s21 offen offset:0 sc1
  s_nop 6
  v_cvt_pk_bf16_f32 v22, v40, v41
  v_cvt_pk_bf16_f32 v23, v42, v43
  v_bfi_b32 v22, 1, s57, v22
  buffer_store_dwordx2 v[22:23], v7, s[4:7], s21 offen offset:64 sc1
  ds_read_b128 v[68:71], v4 offset:0
  ds_read_b128 v[72:75], v4 offset:1024
  ds_read_b128 v[76:79], v4 offset:4096
  ds_read_b128 v[80:83], v4 offset:5120
  ds_read_b128 v[84:87], v4 offset:8192
  ds_read_b128 v[88:91], v4 offset:9216
  ds_read_b128 v[92:95], v4 offset:2048
  ds_read_b128 v[96:99], v4 offset:3072
  ds_read_b128 v[100:103], v4 offset:6144
  ds_read_b128 v[104:107], v4 offset:7168
  ds_read_b128 v[108:111], v4 offset:10240
  ds_read_b128 v[112:115], v4 offset:11264
  v_mov_b64 v[16:17], 0
  v_mov_b64 v[18:19], 0
  v_mov_b64 v[20:21], 0
  v_mov_b64 v[22:23], 0
  v_mov_b64 v[24:25], 0
  v_mov_b64 v[26:27], 0
  ds_read_b64 v[44:45], v2 offset:32256
  s_waitcnt lgkmcnt(0)
  v_readfirstlane_b32 s38, v44
  v_readfirstlane_b32 s37, v45
  s_nop 0
  s_add_u32 s37, s37, 30
  s_cmp_ge_u32 s38, 30
  s_cselect_b32 s38, s37, s38
  s_cmp_ge_u32 s38, 64
  s_cselect_b32 s38, 100, s38
  s_sub_u32 s38, s38, 1
  s_max_i32 s30, s30, s38
  s_waitcnt vmcnt(4)
  s_barrier
  ds_read_b128 v[28:31], v2 offset:18432
  ds_read_b128 v[32:35], v2 offset:22528
  ds_read_b128 v[36:39], v2 offset:8192
  ds_read_b128 v[40:43], v2 offset:9216
  ds_read_b128 v[44:47], v2 offset:10240
  ds_read_b128 v[48:51], v2 offset:11264
  buffer_load_dwordx4 v[124:127], v2, s[4:7], s24 offen offset:2048 sc1
  buffer_load_dwordx4 v[116:119], v2, s[4:7], s25 offen offset:2048 sc1
  ds_read_b128 v[52:55], v2 offset:12288
  ds_read_b128 v[56:59], v2 offset:13312
  ds_read_b128 v[60:63], v2 offset:14336
  ds_read_b128 v[64:67], v2 offset:15360
  buffer_load_dwordx4 v[124:127], v2, s[4:7], s24 offen offset:2048 sc1
  buffer_load_dwordx4 v[116:119], v2, s[4:7], s25 offen offset:2048 sc1
  s_mov_b32 s19, 0
  s_branch T_loop_181
T_kvw_185:
  s_mov_b32 s19, 0
  s_branch T_kvok_194
T_kv_193:
  s_sleep 4
  s_add_u32 s19, s19, 1
  s_cmp_gt_u32 s19, 32768
  s_cbranch_scc1 M_exit
T_kvok_194:
  s_add_u32 s39, s99, 128
  s_mov_b32 s38, 0
  s_mov_b32 s37, 0
  s_atomic_or s38, s[58:59], s99 glc
  s_atomic_or s37, s[58:59], s39 glc
  s_waitcnt lgkmcnt(0)
  s_add_u32 s37, s37, 30
  s_cmp_ge_u32 s38, 30
  s_cselect_b32 s38, s37, s38
  s_cmp_ge_u32 s38, 64
  s_cselect_b32 s38, 100, s38
  s_sub_u32 s38, s38, 1
  s_max_i32 s30, s30, s38
  s_cmp_ge_i32 s14, s30
  s_cbranch_scc1 T_kv_193
  s_branch T_kvb_186
T_slow_188:
  s_nop 7
  v_max3_f32 v100, v16, v17, v18
  v_max3_f32 v100, v100, v19, v20
  v_max3_f32 v100, v100, v21, v22
  v_max3_f32 v100, v100, v23, v112
  v_max3_f32 v100, v100, v113, v114
  v_max_f32 v100, v100, v115
  v_mov_b32 v101, v100
  s_nop 1
  v_permlane32_swap_b32 v100, v101
  s_nop 1
  v_max_f32 v100, v100, v101
  v_mov_b32 v101, v100
  s_nop 1
  v_permlane16_swap_b32 v100, v101
  s_nop 1
  v_max_f32 v100, v100, v101
  v_sub_f32 v16, v16, v100
  v_sub_f32 v17, v17, v100
  v_sub_f32 v18, v18, v100
  v_sub_f32 v19, v19, v100
  v_exp_f32 v16, v16
  v_exp_f32 v17, v17
  v_exp_f32 v18, v18
  v_exp_f32 v19, v19
  v_sub_f32 v20, v20, v100
  v_sub_f32 v21, v21, v100
  v_sub_f32 v22, v22, v100
  v_sub_f32 v23, v23, v100
  v_exp_f32 v20, v20
  v_exp_f32 v21, v21
  v_exp_f32 v22, v22
  v_exp_f32 v23, v23
  v_sub_f32 v112, v112, v100
  v_sub_f32 v113, v113, v100
  v_sub_f32 v114, v114, v100
  v_sub_f32 v115, v115, v100
  v_exp_f32 v112, v112
  v_exp_f32 v113, v113
  v_exp_f32 v114, v114
  v_exp_f32 v115, v115
  s_nop 0
  v_cvt_pk_bf16_f32 v44, v16, v17
  v_cvt_pk_bf16_f32 v45, v18, v19
  v_cvt_pk_bf16_f32 v46, v20, v21
  v_cvt_pk_bf16_f32 v47, v22, v23
  v_cvt_pk_bf16_f32 v84, v112, v113
  v_cvt_pk_bf16_f32 v85, v114, v115
  v_cndmask_b32 v48, v84, 0, s[16:17]
  v_cndmask_b32 v49, v85, 0, s[16:17]
  v_cndmask_b32 v50, 0, v84, s[16:17]
  v_cndmask_b32 v51, 0, v85, s[16:17]
  s_nop 1
  v_mfma_f32_16x16x16_bf16 v[88:91], v[12:13], v[48:49], 0
  v_mfma_f32_16x16x16_bf16 v[24:27], v[120:121], v[48:49], 0
  v_mfma_f32_16x16x16_bf16 v[116:119], v[120:121], v[50:51], 0
  v_mfma_f32_16x16x32_bf16 v[88:91], v[12:15], v[44:47], v[88:91]
  v_mfma_f32_16x16x32_bf16 v[24:27], v[28:31], v[44:47], v[24:27]
  v_mfma_f32_16x16x32_bf16 v[116:119], v[32:35], v[44:47], v[116:119]
  s_nop 7
  s_nop 1
  v_rcp_f32 v89, v88
  s_nop 0
  v_mul_f32 v24, v89, v24
  v_mul_f32 v25, v89, v25
  s_branch T_back_189
T_w_152:
  s_mov_b32 s19, 0
  v_mov_b64 v[16:17], 0
  v_mov_b64 v[18:19], 0
  v_mov_b64 v[20:21], 0
  v_mov_b64 v[22:23], 0
  v_mov_b64 v[24:25], 0
  v_mov_b64 v[26:27], 0
  buffer_load_dwordx4 v[124:127], v2, s[4:7], s24 offen offset:3072 sc1
  buffer_load_dwordx4 v[116:119], v2, s[4:7], s25 offen offset:3072 sc1
  buffer_load_dwordx4 v[124:127], v2, s[4:7], s24 offen offset:3072 sc1
  buffer_load_dwordx4 v[116:119], v2, s[4:7], s25 offen offset:3072 sc1
  s_branch T_loop_195
.p2align 6
T_retry_196:
  s_mov_b64 exec, vcc
  buffer_load_dwordx4 v[124:127], v2, s[4:7], s24 offen offset:3072 sc1
  buffer_load_dwordx4 v[116:119], v2, s[4:7], s25 offen offset:3072 sc1
  s_mov_b64 exec, -1
  s_add_u32 s19, s19, 1
  s_cmp_gt_u32 s19, 32768
  s_cbranch_scc1 M_exit
T_loop_195:
  s_waitcnt vmcnt(3) lgkmcnt(0)
  v_max3_u32 v123, v124, v125, v126
  v_max_u32 v123, v123, v127
  v_mov_b32_dpp v120, v124 row_ror:8 row_mask:0xf bank_mask:0xf
  v_mov_b32_dpp v121, v125 row_ror:8 row_mask:0xf bank_mask:0xf
  s_waitcnt vmcnt(2)
  v_max3_u32 v123, v123, v116, v117
  v_max3_u32 v123, v123, v118, v119
  v_cmp_eq_u32 vcc, -1, v123
  s_cbranch_vccnz T_retry_196
  v_smfmac_f32_16x16x64_bf16 v[16:19], v[124:127], v[68:75], v0
  s_add_u32 s14, s14, 1
  ds_write_b128 v2, v[124:127] offset:3072
  v_mov_b32_dpp v122, v126 row_ror:8 row_mask:0xf bank_mask:0xf
  v_smfmac_f32_16x16x64_bf16 v[20:23], v[124:127], v[76:83], v0
  s_and_b32 s57, s14, 1
  v_mov_b32_dpp v123, v127 row_ror:8 row_mask:0xf bank_mask:0xf
  v_smfmac_f32_16x16x64_bf16 v[24:27], v[124:127], v[84:91], v0
  s_and_b32 s36, s14, 3
  ds_write_b128 v2, v[116:119] offset:7168
  v_smfmac_f32_16x16x64_bf16 v[16:19], v[120:123], v[92:99], v0
  s_lshl_b32 s36, s36, 13
  v_mov_b32_dpp v84, v116 row_ror:8 row_mask:0xf bank_mask:0xf
  v_smfmac_f32_16x16x64_bf16 v[20:23], v[120:123], v[100:107], v0
  s_add_u32 s26, s36, s23
  ds_read_b128 v[68:71], v4 offset:12288
  v_mov_b32_dpp v85, v117 row_ror:8 row_mask:0xf bank_mask:0xf
  v_smfmac_f32_16x16x64_bf16 v[24:27], v[120:123], v[108:115], v0
  s_add_u32 s36, s36, 8192
  ds_read_b128 v[72:75], v4 offset:13312
  v_mov_b32_dpp v86, v118 row_ror:8 row_mask:0xf bank_mask:0xf
  v_smfmac_f32_16x16x64_bf16 v[16:19], v[116:119], v[224:231], v0
  s_and_b32 s36, s36, 0x7fff
  ds_read_b128 v[76:79], v4 offset:14336
  v_mov_b32_dpp v87, v119 row_ror:8 row_mask:0xf bank_mask:0xf
  v_smfmac_f32_16x16x64_bf16 v[20:23], v[116:119], v[240:247], v0
  s_waitcnt lgkmcnt(3)
  s_barrier
  ds_read_b128 v[100:103], v2 offset:2048
  v_smfmac_f32_16x16x64_bf16 v[24:27], v[116:119], a[0:7], v0
  s_mov_b32 m0, s31
  ds_read_b128 v[120:123], v1 offset:2048
  v_smfmac_f32_16x16x64_bf16 v[16:19], v[84:87], v[232:239], v0
  s_cmp_ge_i32 s14, s30
  s_cbranch_scc1 T_kvw_199
T_kvb_200:
  v_smfmac_f32_16x16x64_bf16 v[20:23], v[84:87], v[248:255], v0
  ds_read_b128 v[80:83], v4 offset:15360
  v_smfmac_f32_16x16x64_bf16 v[24:27], v[84:87], a[8:15], v0
  s_waitcnt lgkmcnt(2)
  v_smfmac_f32_16x16x64_bf16 v[16:19], v[100:103], v[128:135], v0
  ds_read_b128 v[92:95], v2 offset:1024
  v_smfmac_f32_16x16x64_bf16 v[20:23], v[100:103], v[144:151], v0
  ds_read_b128 v[96:99], v1 offset:1024
  buffer_load_dwordx4 v9, s[4:7], s27 offen sc1 lds
  v_smfmac_f32_16x16x64_bf16 v[24:27], v[100:103], v[68:75], v0
  s_waitcnt vmcnt(1) lgkmcnt(3)
  ds_read_b128 v[116:119], v2 offset:0
  s_mov_b32 m0, s32
  v_smfmac_f32_16x16x64_bf16 v[16:19], v[120:123], v[136:143], v0
  ds_read_b128 v[124:127], v1 offset:0
  v_smfmac_f32_16x16x64_bf16 v[20:23], v[120:123], v[152:159], v0
  s_waitcnt lgkmcnt(4)
  ds_read_b128 v[104:107], v2 offset:6144
  v_smfmac_f32_16x16x64_bf16 v[24:27], v[120:123], v[76:83], v0
  s_waitcnt lgkmcnt(4)
  ds_read_b128 v[108:111], v1 offset:6144
  buffer_load_dwordx4 v9, s[4:7], s27 offen offset:128 sc1 lds
  v_smfmac_f32_16x16x64_bf16 v[16:19], v[92:95], v[160:167], v0
  s_waitcnt lgkmcnt(4)
  ds_read_b128 v[112:115], v2 offset:5120
  s_mov_b32 m0, s33
  v_smfmac_f32_16x16x64_bf16 v[16:19], v[96:99], v[168:175], v0
  s_waitcnt lgkmcnt(4)
  ds_read_b128 v[84:87], v1 offset:5120
  v_smfmac_f32_16x16x64_bf16 v[16:19], v[116:119], v[192:199], v0
  s_waitcnt lgkmcnt(4)
  ds_read_b128 v[88:91], v2 offset:4096
  v_smfmac_f32_16x16x64_bf16 v[16:19], v[124:127], v[200:207], v0
  s_waitcnt lgkmcnt(4)
  ds_read_b128 v[100:103], v1 offset:4096
  buffer_load_dwordx4 v10, s[4:7], s28 offen sc1 lds
  v_smfmac_f32_16x16x64_bf16 v[16:19], v[104:107], a[16:23], v0
  s_waitcnt lgkmcnt(4)
  ds_read_b128 v[68:71], v4 offset:16384
  s_mov_b32 m0, s34
  v_smfmac_f32_16x16x64_bf16 v[16:19], v[108:111], a[24:31], v0
  s_waitcnt lgkmcnt(4)
  ds_read_b128 v[72:75], v4 offset:17408
  v_smfmac_f32_16x16x64_bf16 v[16:19], v[112:115], a[64:71], v0
  s_waitcnt lgkmcnt(4)
  ds_read_b128 v[76:79], v4 offset:18432
  v_smfmac_f32_16x16x64_bf16 v[16:19], v[84:87], a[72:79], v0
  s_waitcnt lgkmcnt(4)
  ds_read_b128 v[80:83], v4 offset:19456
  buffer_load_dwordx4 v10, s[4:7], s28 offen offset:256 sc1 lds
  v_smfmac_f32_16x16x64_bf16 v[16:19], v[88:91], a[112:119], v0
  s_waitcnt lgkmcnt(4)
  s_mov_b32 m0, 32256
  v_smfmac_f32_16x16x64_bf16 v[16:19], v[100:103], a[120:127], v0
  s_add_u32 s24, s36, 145752064
  s_add_u32 s25, s36, 145756160
  v_smfmac_f32_16x16x64_bf16 v[20:23], v[92:95], v[176:183], v0
  s_add_u32 s35, s36, s23
  v_smfmac_f32_16x16x64_bf16 v[20:23], v[96:99], v[184:191], v0
  s_waitcnt lgkmcnt(2)
  buffer_load_dword v3, s[4:7], s99 offen sc1 lds
  v_smfmac_f32_16x16x64_bf16 v[20:23], v[116:119], v[68:75], v0
  s_waitcnt lgkmcnt(0)
  ds_read_b128 v[68:71], v4 offset:20480
  v_mul_f32 v16, s18, v16
  v_smfmac_f32_16x16x64_bf16 v[20:23], v[124:127], v[76:83], v0
  ds_read_b128 v[72:75], v4 offset:21504
  v_mul_f32 v17, s18, v17
  v_smfmac_f32_16x16x64_bf16 v[20:23], v[104:107], a[32:39], v0
  ds_read_b128 v[76:79], v4 offset:22528
  v_mul_f32 v18, s18, v18
  v_smfmac_f32_16x16x64_bf16 v[20:23], v[108:111], a[40:47], v0
  ds_read_b128 v[80:83], v4 offset:23552
  v_mul_f32 v19, s18, v19
  v_smfmac_f32_16x16x64_bf16 v[20:23], v[112:115], a[80:87], v0
  v_cvt_pk_bf16_f32 v120, v16, v17
  v_smfmac_f32_16x16x64_bf16 v[20:23], v[84:87], a[88:95], v0
  v_cvt_pk_bf16_f32 v121, v18, v19
  v_smfmac_f32_16x16x64_bf16 v[20:23], v[88:91], a[128:135], v0
  ds_write_b64 v5, v[120:121] offset:24576
  v_smfmac_f32_16x16x64_bf16 v[20:23], v[100:103], a[136:143], v0
  s_waitcnt lgkmcnt(3)
  v_smfmac_f32_16x16x64_bf16 v[24:27], v[92:95], v[68:75], v0
  s_waitcnt lgkmcnt(1)
  v_mov_b64 v[92:93], 0
  v_smfmac_f32_16x16x64_bf16 v[24:27], v[96:99], v[76:83], v0
  s_nop 1
  v_cvt_pk_bf16_f32 v122, v20, v21
  v_cvt_pk_bf16_f32 v123, v22, v23
  v_smfmac_f32_16x16x64_bf16 v[24:27], v[116:119], v[208:215], v0
  ds_write_b64 v5, v[122:123] offset:26880
  v_mov_b64 v[94:95], 0
  v_smfmac_f32_16x16x64_bf16 v[24:27], v[124:127], v[216:223], v0
  s_waitcnt lgkmcnt(1)
  s_barrier
  ds_read_b64_tr_b16 v[68:69], v6 offset:24576
  v_smfmac_f32_16x16x64_bf16 v[24:27], v[104:107], a[48:55], v0
  s_add_u32 s27, s27, 8192
  ds_read_b64_tr_b16 v[70:71], v6 offset:24640
  ds_read_b64_tr_b16 v[72:73], v6 offset:24832
  v_smfmac_f32_16x16x64_bf16 v[24:27], v[108:111], a[56:63], v0
  s_add_u32 s28, s28, 8192
  ds_read_b64_tr_b16 v[74:75], v6 offset:24896
  ds_read_b64_tr_b16 v[76:77], v6 offset:25088
  v_smfmac_f32_16x16x64_bf16 v[24:27], v[112:115], a[96:103], v0
  s_nop 0
  ds_read_b64_tr_b16 v[78:79], v6 offset:25152
  ds_read_b64_tr_b16 v[80:81], v6 offset:25344
  v_smfmac_f32_16x16x64_bf16 v[24:27], v[84:87], a[104:111], v0
  ds_read_b64_tr_b16 v[82:83], v6 offset:25408
  v_mov_b64 v[96:97], 0
  v_smfmac_f32_16x16x64_bf16 v[24:27], v[88:91], a[144:151], v0
  s_waitcnt lgkmcnt(8)
  s_barrier
  ds_read_b64_tr_b16 v[116:117], v6 offset:26880
  v_smfmac_f32_16x16x64_bf16 v[24:27], v[100:103], a[152:159], v0
  s_waitcnt lgkmcnt(7)
  ds_read_b64_tr_b16 v[118:119], v6 offset:26944
  v_mfma_f32_16x16x32_bf16 v[16:19], v[36:39], v[68:71], 0
  s_waitcnt lgkmcnt(6)
  ds_read_b64_tr_b16 v[124:125], v6 offset:27136
  ds_read_b64_tr_b16 v[126:127], v6 offset:27200
  v_mfma_f32_16x16x32_bf16 v[16:19], v[40:43], v[72:75], v[16:19]
  s_waitcnt lgkmcnt(6)
  ds_read_b64_tr_b16 v[104:105], v6 offset:27392
  ds_read_b64_tr_b16 v[106:107], v6 offset:27456
  v_mfma_f32_16x16x32_bf16 v[16:19], v[44:47], v[76:79], v[16:19]
  s_waitcnt lgkmcnt(6)
  ds_read_b64_tr_b16 v[108:109], v6 offset:27648
  ds_read_b64_tr_b16 v[110:111], v6 offset:27712
  v_mfma_f32_16x16x32_bf16 v[16:19], v[48:51], v[80:83], v[16:19]
  s_waitcnt lgkmcnt(6)
  v_cvt_pk_bf16_f32 v120, v24, v25
  v_cvt_pk_bf16_f32 v121, v26, v27
  v_mfma_f32_16x16x32_bf16 v[112:115], v[116:119], v[68:71], 0
  s_waitcnt lgkmcnt(4)
  v_mov_b64 v[98:99], 0
  v_mfma_f32_16x16x32_bf16 v[112:115], v[124:127], v[72:75], v[112:115]
  s_waitcnt lgkmcnt(2)
  v_mov_b64 v[36:37], 0
  v_exp_f32 v100, v16
  v_mfma_f32_16x16x32_bf16 v[112:115], v[104:107], v[76:79], v[112:115]
  s_waitcnt lgkmcnt(0)
  v_exp_f32 v101, v17
  v_mfma_f32_16x16x32_bf16 v[112:115], v[108:111], v[80:83], v[112:115]
  buffer_store_dwordx4 v[120:123], v2, s[4:7], s29 offen offset:3072 sc1
  v_exp_f32 v102, v18
  v_mfma_f32_16x16x32_bf16 v[20:23], v[52:55], v[68:71], 0
  s_cmp_eq_u32 s14, 63
  v_exp_f32 v103, v19
  v_mfma_f32_16x16x32_bf16 v[20:23], v[56:59], v[72:75], v[20:23]
  s_cbranch_scc1 M_tdone
  v_cvt_pk_bf16_f32 v44, v100, v101
  v_cvt_pk_bf16_f32 v45, v102, v103
  v_mfma_f32_16x16x32_bf16 v[20:23], v[60:63], v[76:79], v[20:23]
  s_add_u32 s29, s29, 131072
  v_exp_f32 v100, v112
  v_mfma_f32_16x16x32_bf16 v[20:23], v[64:67], v[80:83], v[20:23]
  v_exp_f32 v101, v113
  v_exp_f32 v102, v114
  v_exp_f32 v103, v115
  v_cvt_pk_bf16_f32 v84, v100, v101
  v_cvt_pk_bf16_f32 v85, v102, v103
  v_cndmask_b32 v48, v84, 0, s[16:17]
  v_cndmask_b32 v49, v85, 0, s[16:17]
  v_cndmask_b32 v50, 0, v84, s[16:17]
  v_cndmask_b32 v51, 0, v85, s[16:17]
  v_exp_f32 v100, v20
  v_mfma_f32_16x16x16_bf16 v[88:91], v[12:13], v[48:49], 0
  v_exp_f32 v101, v21
  v_mfma_f32_16x16x16_bf16 v[24:27], v[120:121], v[48:49], 0
  v_exp_f32 v102, v22
  v_mfma_f32_16x16x16_bf16 v[116:119], v[120:121], v[50:51], 0
  v_exp_f32 v103, v23
  v_cvt_pk_bf16_f32 v46, v100, v101
  v_cvt_pk_bf16_f32 v47, v102, v103
  v_mov_b64 v[38:39], 0
  s_nop 0
  v_mfma_f32_16x16x32_bf16 v[88:91], v[12:15], v[44:47], v[88:91]
  v_mov_b64 v[40:41], 0
  v_mov_b64 v[42:43], 0
  v_mfma_f32_16x16x32_bf16 v[24:27], v[28:31], v[44:47], v[24:27]
  ds_read_b128 v[52:55], v4 offset:24576
  ds_read_b128 v[56:59], v4 offset:25600
  v_mfma_f32_16x16x32_bf16 v[116:119], v[32:35], v[44:47], v[116:119]
  s_nop 1
  v_rcp_f32 v89, v88
  v_subrev_u32 v100, s54, v88
  v_cmp_le_u32 vcc, s55, v100
  v_mul_f32 v24, v89, v24
  v_mul_f32 v25, v89, v25
  s_cbranch_vccnz T_slow_202
T_back_203:
  v_cvt_pk_bf16_f32 v124, v24, v25
  v_pk_mul_f32 v[26:27], v[26:27], v[88:89] op_sel:[0,1] op_sel_hi:[1,1]
  v_pk_mul_f32 v[116:117], v[116:117], v[88:89] op_sel:[0,1] op_sel_hi:[1,1]
  v_pk_mul_f32 v[118:119], v[118:119], v[88:89] op_sel:[0,1] op_sel_hi:[1,1]
  v_cvt_pk_bf16_f32 v125, v26, v27
  v_cvt_pk_bf16_f32 v126, v116, v117
  v_cvt_pk_bf16_f32 v127, v118, v119
  ds_write_b128 v11, v[124:127] offset:30720
  s_nop 0
  v_smfmac_f32_16x16x64_bf16 v[92:95], v[124:127], a[160:167], v0
  v_smfmac_f32_16x16x64_bf16 v[96:99], v[124:127], a[168:175], v0
  v_smfmac_f32_16x16x64_bf16 v[36:39], v[124:127], a[176:183], v0
  v_smfmac_f32_16x16x64_bf16 v[40:43], v[124:127], a[184:191], v0
  s_waitcnt lgkmcnt(0)
  s_barrier
  ds_read_b128 v[104:107], v11 offset:30208
  ds_read_b128 v[108:111], v11 offset:29696
  ds_read_b128 v[68:71], v11 offset:29184
  s_waitcnt lgkmcnt(2)
  v_smfmac_f32_16x16x64_bf16 v[92:95], v[104:107], a[192:199], v0
  s_waitcnt lgkmcnt(1)
  ds_read_b128 v[76:79], v4 offset:28672
  v_smfmac_f32_16x16x64_bf16 v[92:95], v[108:111], a[224:231], v0
  s_waitcnt lgkmcnt(1)
  ds_read_b128 v[80:83], v4 offset:29696
  v_smfmac_f32_16x16x64_bf16 v[92:95], v[68:71], a[240:247], v0
  ds_read_b128 v[60:63], v4 offset:26624
  v_smfmac_f32_16x16x64_bf16 v[96:99], v[104:107], a[200:207], v0
  ds_read_b128 v[64:67], v4 offset:27648
  v_smfmac_f32_16x16x64_bf16 v[96:99], v[108:111], a[232:239], v0
  ds_read_b128 v[28:31], v4 offset:30720
  s_nop 0
  v_cvt_pk_bf16_f32 v16, v92, v93
  v_cvt_pk_bf16_f32 v17, v94, v95
  v_bfi_b32 v16, 1, s57, v16
  v_smfmac_f32_16x16x64_bf16 v[96:99], v[68:71], a[248:255], v0
  buffer_store_dwordx2 v[16:17], v7, s[4:7], s20 offen offset:0 sc1
  v_smfmac_f32_16x16x64_bf16 v[36:39], v[104:107], a[208:215], v0
  ds_read_b128 v[32:35], v4 offset:31744
  v_smfmac_f32_16x16x64_bf16 v[36:39], v[108:111], v[52:59], v0
  s_waitcnt lgkmcnt(4)
  s_nop 0
  v_cvt_pk_bf16_f32 v18, v96, v97
  v_cvt_pk_bf16_f32 v19, v98, v99
  v_bfi_b32 v18, 1, s57, v18
  v_smfmac_f32_16x16x64_bf16 v[36:39], v[68:71], v[76:83], v0
  buffer_store_dwordx2 v[18:19], v7, s[4:7], s20 offen offset:64 sc1
  v_smfmac_f32_16x16x64_bf16 v[40:43], v[104:107], a[216:223], v0
  s_waitcnt lgkmcnt(2)
  v_smfmac_f32_16x16x64_bf16 v[40:43], v[108:111], v[60:67], v0
  s_waitcnt lgkmcnt(0)
  s_nop 0
  v_cvt_pk_bf16_f32 v20, v36, v37
  v_cvt_pk_bf16_f32 v21, v38, v39
  v_bfi_b32 v20, 1, s57, v20
  v_smfmac_f32_16x16x64_bf16 v[40:43], v[68:71], v[28:35], v0
  buffer_store_dwordx2 v[20:21], v7, s[4:7], s21 offen offset:0 sc1
  s_nop 6
  v_cvt_pk_bf16_f32 v22, v40, v41
  v_cvt_pk_bf16_f32 v23, v42, v43
  v_bfi_b32 v22, 1, s57, v22
  buffer_store_dwordx2 v[22:23], v7, s[4:7], s21 offen offset:64 sc1
  ds_read_b128 v[68:71], v4 offset:0
  ds_read_b128 v[72:75], v4 offset:1024
  ds_read_b128 v[76:79], v4 offset:4096
  ds_read_b128 v[80:83], v4 offset:5120
  ds_read_b128 v[84:87], v4 offset:8192
  ds_read_b128 v[88:91], v4 offset:9216
  ds_read_b128 v[92:95], v4 offset:2048
  ds_read_b128 v[96:99], v4 offset:3072
  ds_read_b128 v[100:103], v4 offset:6144
  ds_read_b128 v[104:107], v4 offset:7168
  ds_read_b128 v[108:111], v4 offset:10240
  ds_read_b128 v[112:115], v4 offset:11264
  v_mov_b64 v[16:17], 0
  v_mov_b64 v[18:19], 0
  v_mov_b64 v[20:21], 0
  v_mov_b64 v[22:23], 0
  v_mov_b64 v[24:25], 0
  v_mov_b64 v[26:27], 0
  ds_read_b64 v[44:45], v2 offset:32256
  s_waitcnt lgkmcnt(0)
  v_readfirstlane_b32 s38, v44
  v_readfirstlane_b32 s37, v45
  s_nop 0
  s_add_u32 s37, s37, 30
  s_cmp_ge_u32 s38, 30
  s_cselect_b32 s38, s37, s38
  s_cmp_ge_u32 s38, 64
  s_cselect_b32 s38, 100, s38
  s_sub_u32 s38, s38, 1
  s_max_i32 s30, s30, s38
  s_waitcnt vmcnt(4)
  s_barrier
  ds_read_b128 v[28:31], v2 offset:19456
  ds_read_b128 v[32:35], v2 offset:23552
  ds_read_b128 v[36:39], v2 offset:8192
  ds_read_b128 v[40:43], v2 offset:9216
  ds_read_b128 v[44:47], v2 offset:10240
  ds_read_b128 v[48:51], v2 offset:11264
  buffer_load_dwordx4 v[124:127], v2, s[4:7], s24 offen offset:3072 sc1
  buffer_load_dwordx4 v[116:119], v2, s[4:7], s25 offen offset:3072 sc1
  ds_read_b128 v[52:55], v2 offset:12288
  ds_read_b128 v[56:59], v2 offset:13312
  ds_read_b128 v[60:63], v2 offset:14336
  ds_read_b128 v[64:67], v2 offset:15360
  buffer_load_dwordx4 v[124:127], v2, s[4:7], s24 offen offset:3072 sc1
  buffer_load_dwordx4 v[116:119], v2, s[4:7], s25 offen offset:3072 sc1
  s_mov_b32 s19, 0
  s_branch T_loop_195
T_kvw_199:
  s_mov_b32 s19, 0
  s_branch T_kvok_208
T_kv_207:
  s_sleep 4
  s_add_u32 s19, s19, 1
  s_cmp_gt_u32 s19, 32768
  s_cbranch_scc1 M_exit
T_kvok_208:
  s_add_u32 s39, s99, 128
  s_mov_b32 s38, 0
  s_mov_b32 s37, 0
  s_atomic_or s38, s[58:59], s99 glc
  s_atomic_or s37, s[58:59], s39 glc
  s_waitcnt lgkmcnt(0)
  s_add_u32 s37, s37, 30
  s_cmp_ge_u32 s38, 30
  s_cselect_b32 s38, s37, s38
  s_cmp_ge_u32 s38, 64
  s_cselect_b32 s38, 100, s38
  s_sub_u32 s38, s38, 1
  s_max_i32 s30, s30, s38
  s_cmp_ge_i32 s14, s30
  s_cbranch_scc1 T_kv_207
  s_branch T_kvb_200
T_slow_202:
  s_nop 7
  v_max3_f32 v100, v16, v17, v18
  v_max3_f32 v100, v100, v19, v20
  v_max3_f32 v100, v100, v21, v22
  v_max3_f32 v100, v100, v23, v112
  v_max3_f32 v100, v100, v113, v114
  v_max_f32 v100, v100, v115
  v_mov_b32 v101, v100
  s_nop 1
  v_permlane32_swap_b32 v100, v101
  s_nop 1
  v_max_f32 v100, v100, v101
  v_mov_b32 v101, v100
  s_nop 1
  v_permlane16_swap_b32 v100, v101
  s_nop 1
  v_max_f32 v100, v100, v101
  v_sub_f32 v16, v16, v100
  v_sub_f32 v17, v17, v100
  v_sub_f32 v18, v18, v100
  v_sub_f32 v19, v19, v100
  v_exp_f32 v16, v16
  v_exp_f32 v17, v17
  v_exp_f32 v18, v18
  v_exp_f32 v19, v19
  v_sub_f32 v20, v20, v100
  v_sub_f32 v21, v21, v100
  v_sub_f32 v22, v22, v100
  v_sub_f32 v23, v23, v100
  v_exp_f32 v20, v20
  v_exp_f32 v21, v21
  v_exp_f32 v22, v22
  v_exp_f32 v23, v23
  v_sub_f32 v112, v112, v100
  v_sub_f32 v113, v113, v100
  v_sub_f32 v114, v114, v100
  v_sub_f32 v115, v115, v100
  v_exp_f32 v112, v112
  v_exp_f32 v113, v113
  v_exp_f32 v114, v114
  v_exp_f32 v115, v115
  s_nop 0
  v_cvt_pk_bf16_f32 v44, v16, v17
  v_cvt_pk_bf16_f32 v45, v18, v19
  v_cvt_pk_bf16_f32 v46, v20, v21
  v_cvt_pk_bf16_f32 v47, v22, v23
  v_cvt_pk_bf16_f32 v84, v112, v113
  v_cvt_pk_bf16_f32 v85, v114, v115
  v_cndmask_b32 v48, v84, 0, s[16:17]
  v_cndmask_b32 v49, v85, 0, s[16:17]
  v_cndmask_b32 v50, 0, v84, s[16:17]
  v_cndmask_b32 v51, 0, v85, s[16:17]
  s_nop 1
  v_mfma_f32_16x16x16_bf16 v[88:91], v[12:13], v[48:49], 0
  v_mfma_f32_16x16x16_bf16 v[24:27], v[120:121], v[48:49], 0
  v_mfma_f32_16x16x16_bf16 v[116:119], v[120:121], v[50:51], 0
  v_mfma_f32_16x16x32_bf16 v[88:91], v[12:15], v[44:47], v[88:91]
  v_mfma_f32_16x16x32_bf16 v[24:27], v[28:31], v[44:47], v[24:27]
  v_mfma_f32_16x16x32_bf16 v[116:119], v[32:35], v[44:47], v[116:119]
  s_nop 7
  s_nop 1
  v_rcp_f32 v89, v88
  s_nop 0
  v_mul_f32 v24, v89, v24
  v_mul_f32 v25, v89, v25
  s_branch T_back_203
M_tdone:
  v_mov_b32 v16, 64
  v_or_b32 v17, s13, v2
  v_min_u32 v17, 1, v17
  v_lshlrev_b32 v17, 30, v17
  s_waitcnt vmcnt(0)
  s_barrier
  buffer_store_dword v16, v17, s[4:7], s15 offen sc1
M_done:
M_exit:
  s_endpgm
.p2align 6
.type M_table,@object
M_table:
.long 0x1, 0x3f, 0xffffffff, 0x17, 0x1, 0x7, 0x800, 0x0, 0x8, 0x0, 0x0, 0x0, 0x0, 0x0, 0x0, 0x0
.long 0x1, 0x28, 0xffffffff, 0x1b, 0x1, 0x6, 0x1000, 0x0, 0x8, 0x1, 0x0, 0x0, 0x0, 0x0, 0x0, 0x0
.long 0x2, 0x0, 0x1, 0x1e, 0x1, 0x5, 0x1800, 0x0, 0x8, 0x0, 0x0, 0x0, 0x0, 0x0, 0x0, 0x0
.long 0x2, 0x1e, 0x1, 0x22, 0x1, 0x4, 0x2000, 0x0, 0x8, 0x1, 0x0, 0x0, 0x0, 0x0, 0x0, 0x0
.long 0x0, 0x0, 0x1, 0x20, 0x2, 0x3, 0x20, 0x0, 0x8, 0x2, 0x0, 0x0, 0x0, 0x0, 0x0, 0x0
.long 0x0, 0x3f, 0xffffffff, 0x20, 0x2, 0x2, 0x18, 0x1, 0x10, 0x0, 0x0, 0x0, 0x0, 0x0, 0x0, 0x0
.long 0x1, 0xd, 0xffffffff, 0xe, 0x0, 0x0, 0x8, 0x0, 0x8, 0x2, 0x0, 0x0, 0x0, 0x0, 0x0, 0x0
.size M_table, 448
.section .rodata,"a"
.p2align 6
.amdhsa_kernel gated_mix__compressed_kv_cla__memory_aug_recurrent_mem_tr__prompt_kernel
.amdhsa_next_free_vgpr 512
.amdhsa_next_free_sgpr 102
.amdhsa_accum_offset 256
.amdhsa_group_segment_fixed_size 0
.amdhsa_kernarg_size 136
.amdhsa_user_sgpr_count 2
.amdhsa_user_sgpr_kernarg_segment_ptr 1
.amdhsa_system_sgpr_workgroup_id_x 1
.end_amdhsa_kernel
```

```asm
; @launch grid=(256,1,1) block=(256,1,1) lds=163840
.amdgcn_target "amdgcn-amd-amdhsa--gfx950"
.text
.globl gated_mix__compressed_kv_cla__memory_aug_recurrent_mem_tr__prompt_kernel
.p2align 8
.type gated_mix__compressed_kv_cla__memory_aug_recurrent_mem_tr__prompt_kernel,@function
gated_mix__compressed_kv_cla__memory_aug_recurrent_mem_tr__prompt_kernel:
  s_cmp_ge_u32 s2, 256
  s_cbranch_scc1 M_exit
  s_lshr_b32 s77, s2, 3
  s_and_b32 s76, s2, 7
  s_cbranch_scc1 M_worker
  s_mov_b32 s12, s77
  s_load_dwordx4 s[60:63], s[0:1], 64
  s_load_dwordx4 s[64:67], s[0:1], 80
  s_load_dwordx4 s[68:71], s[0:1], 120
  s_load_dwordx2 s[72:73], s[0:1], 56
  v_lshrrev_b32 v1, 6, v0
  v_and_b32 v20, 63, v0
  v_readfirstlane_b32 s13, v1
  v_lshrrev_b32 v26, 3, v20
  v_lshlrev_b32 v26, 10, v26
  v_and_b32 v1, 7, v20
  v_lshl_add_u32 v26, v1, 4, v26
  s_lshl_b32 s36, s13, 7
  s_lshl_b32 s38, s12, 17
  s_add_u32 s36, s36, s38
  v_add_u32 v26, s36, v26
  s_lshl_b32 s39, s13, 15
  s_add_u32 s39, s39, 32768
  s_waitcnt lgkmcnt(0)
  s_mov_b32 s48, s66
  s_and_b32 s49, s67, 0xffff
  s_mov_b32 s50, 0x400000
  s_mov_b32 s51, 0x20000
  s_xor_b32 s36, s13, 0
  s_lshl_b32 s36, s36, 15
  s_add_u32 m0, s39, 0
  s_add_u32 s37, s36, 0
  buffer_load_dwordx4 v26, s[48:51], s37 offen lds
  s_add_u32 m0, s39, 1024
  s_add_u32 s37, s36, 8192
  buffer_load_dwordx4 v26, s[48:51], s37 offen lds
  s_add_u32 m0, s39, 2048
  s_add_u32 s37, s36, 16384
  buffer_load_dwordx4 v26, s[48:51], s37 offen lds
  s_add_u32 m0, s39, 3072
  s_add_u32 s37, s36, 24576
  buffer_load_dwordx4 v26, s[48:51], s37 offen lds
  s_xor_b32 s36, s13, 0
  s_lshl_b32 s36, s36, 15
  s_add_u32 m0, s39, 4096
  s_add_u32 s37, s36, 512
  buffer_load_dwordx4 v26, s[48:51], s37 offen lds
  s_add_u32 m0, s39, 5120
  s_add_u32 s37, s36, 8704
  buffer_load_dwordx4 v26, s[48:51], s37 offen lds
  s_add_u32 m0, s39, 6144
  s_add_u32 s37, s36, 16896
  buffer_load_dwordx4 v26, s[48:51], s37 offen lds
  s_add_u32 m0, s39, 7168
  s_add_u32 s37, s36, 25088
  buffer_load_dwordx4 v26, s[48:51], s37 offen lds
  s_xor_b32 s36, s13, 1
  s_lshl_b32 s36, s36, 15
  s_add_u32 m0, s39, 8192
  s_add_u32 s37, s36, 0
  buffer_load_dwordx4 v26, s[48:51], s37 offen lds
  s_add_u32 m0, s39, 9216
  s_add_u32 s37, s36, 8192
  buffer_load_dwordx4 v26, s[48:51], s37 offen lds
  s_add_u32 m0, s39, 10240
  s_add_u32 s37, s36, 16384
  buffer_load_dwordx4 v26, s[48:51], s37 offen lds
  s_add_u32 m0, s39, 11264
  s_add_u32 s37, s36, 24576
  buffer_load_dwordx4 v26, s[48:51], s37 offen lds
  s_xor_b32 s36, s13, 1
  s_lshl_b32 s36, s36, 15
  s_add_u32 m0, s39, 12288
  s_add_u32 s37, s36, 512
  buffer_load_dwordx4 v26, s[48:51], s37 offen lds
  s_add_u32 m0, s39, 13312
  s_add_u32 s37, s36, 8704
  buffer_load_dwordx4 v26, s[48:51], s37 offen lds
  s_add_u32 m0, s39, 14336
  s_add_u32 s37, s36, 16896
  buffer_load_dwordx4 v26, s[48:51], s37 offen lds
  s_add_u32 m0, s39, 15360
  s_add_u32 s37, s36, 25088
  buffer_load_dwordx4 v26, s[48:51], s37 offen lds
  s_mov_b32 s8, s60
  s_and_b32 s9, s61, 0xffff
  s_mov_b32 s10, 0x400000
  s_mov_b32 s11, 0x20000
  s_mov_b32 s40, s62
  s_and_b32 s41, s63, 0xffff
  s_mov_b32 s42, 0x400000
  s_mov_b32 s43, 0x20000
  s_mov_b32 s44, s64
  s_and_b32 s45, s65, 0xffff
  s_mov_b32 s46, 0x400000
  s_mov_b32 s47, 0x20000
  s_mov_b32 s4, s70
  s_and_b32 s5, s71, 0xffff
  s_mov_b32 s6, 0x10000000
  s_mov_b32 s7, 0x20000
  s_mov_b32 s76, s72
  s_and_b32 s77, s73, 0xffff
  s_mov_b32 s78, 0x2000
  s_mov_b32 s79, 0x20000
  s_mov_b32 s72, s68
  s_and_b32 s73, s69, 0xffff
  s_mov_b32 s74, 0x100
  s_mov_b32 s75, 0x20000
  s_mov_b64 s[52:53], s[68:69]
  s_mov_b64 s[58:59], s[70:71]
  s_mul_i32 s99, s12, 896
  s_add_u32 s99, s99, 148898048
  s_lshl_b32 s15, s12, 7
  s_add_u32 s15, s15, 148926464
  v_lshrrev_b32 v21, 4, v20
  v_and_b32 v22, 15, v20
  v_and_b32 v23, 1, v21
  v_lshrrev_b32 v24, 1, v21
  v_lshlrev_b32 v2, 4, v20
  s_lshl_b32 s36, s13, 10
  v_add_u32 v59, s36, v2
  s_mov_b32 s37, s39
  v_add_u32 v4, s37, v2
  v_lshrrev_b32 v25, 2, v20
  v_lshlrev_b32 v25, 13, v25
  v_and_b32 v1, 3, v20
  v_lshl_add_u32 v25, v1, 4, v25
  s_lshl_b32 s36, s13, 6
  s_lshl_b32 s38, s12, 8
  s_add_u32 s36, s36, s38
  v_add_u32 v25, s36, v25
  v_bfe_u32 v29, v20, 2, 1
  v_bfe_u32 v30, v20, 3, 1
  v_and_b32 v31, 3, v20
  v_lshl_add_u32 v27, v21, 2, v29
  v_lshlrev_b32 v27, 6, v27
  v_lshl_add_u32 v27, v30, 5, v27
  v_lshl_add_u32 v27, v31, 3, v27
  v_add_u32 v27, s37, v27
  v_xor_b32 v36, 1, v30
  v_lshl_add_u32 v36, v36, 11, v27
  v_lshl_add_u32 v27, v30, 11, v27
  v_lshl_add_u32 v28, v23, 2, v24
  v_lshl_add_u32 v28, v28, 2, v29
  v_lshlrev_b32 v28, 7, v28
  v_lshl_add_u32 v28, v30, 6, v28
  v_lshl_add_u32 v28, v31, 4, v28
  v_add_u32 v28, s37, v28
  v_mov_b32 v0, 0x4444
  v_mov_b32 v1, 0xeeee
  v_cmp_lt_u32 vcc, 7, v22
  s_nop 1
  v_cndmask_b32 v32, v0, v1, vcc
  v_mov_b32 v0, v32
  v_and_b32 v32, 7, v20
  v_lshlrev_b32 v32, 4, v32
  v_lshl_add_u32 v11, v21, 7, v32
  v_xor_b32 v1, 128, v2
  v_lshl_add_u32 v33, v24, 4, v22
  s_lshl_b32 s36, s13, 5
  v_add_u32 v33, s36, v33
  v_lshlrev_b32 v33, 3, v33
  v_mul_u32_u24 v34, 1152, v23
  v_add_u32 v5, v33, v34
  v_bfe_u32 v33, v20, 2, 2
  v_lshl_add_u32 v33, v23, 2, v33
  v_lshl_add_u32 v33, v24, 4, v33
  v_lshlrev_b32 v33, 3, v33
  v_and_b32 v34, 1, v20
  v_mul_u32_u24 v34, 1152, v34
  v_add_u32 v6, v33, v34
  s_lshl_b32 s36, s13, 3
  v_lshrrev_b32 v33, 3, v20
  v_add_u32 v33, s36, v33
  v_mul_u32_u24 v34, 0, v33
  v_add_u32 v34, s12, v34
  v_and_b32 v34, 31, v34
  v_lshrrev_b32 v37, 1, v32
  v_lshl_add_u32 v33, v33, 13, v37
  v_lshl_add_u32 v7, v34, 7, v33
  v_and_b32 v37, 1, v20
  v_bfe_u32 v38, v20, 1, 1
  v_lshl_add_u32 v37, v29, 1, v37
  s_lshr_b32 s36, s12, 3
  s_lshl_b32 s36, s36, 10
  s_and_b32 s37, s12, 1
  s_lshl_b32 s37, s37, 9
  s_add_u32 s36, s36, s37
  s_and_b32 s37, s12, 6
  s_lshl_b32 s37, s37, 5
  s_add_u32 s36, s36, s37
  v_lshlrev_b32 v33, 4, v21
  v_lshl_add_u32 v33, v37, 2, v33
  v_lshl_add_u32 v33, v38, 8, v33
  v_lshl_add_u32 v33, v30, 30, v33
  v_add_u32 v8, s36, v33
  v_mov_b32 v39, v21
  s_lshr_b32 s36, s12, 2
  s_lshl_b32 s36, s36, 6
  s_and_b32 s37, s12, 1
  s_lshl_b32 s37, s37, 5
  s_add_u32 s36, s36, s37
  s_and_b32 s37, s12, 2
  s_lshl_b32 s37, s37, 11
  s_add_u32 s36, s36, s37
  v_lshlrev_b32 v35, 10, v39
  v_lshl_add_u32 v35, v37, 2, v35
  v_lshl_add_u32 v35, v38, 4, v35
  v_add_u32 v35, s36, v35
  buffer_load_ushort v44, v35, s[76:79], 0 offen offset:0
  buffer_load_ushort v45, v35, s[76:79], 0 offen offset:2
  buffer_load_ushort v46, v35, s[76:79], 0 offen offset:512
  buffer_load_ushort v47, v35, s[76:79], 0 offen offset:514
  v_lshlrev_b32 v33, 4, v29
  v_mov_b32 v34, 0x3f80
  v_lshlrev_b32 v33, v33, v34
  v_and_b32 v34, 1, v20
  v_lshl_add_u32 v34, v34, 1, v30
  v_cmp_eq_u32 vcc, 0, v34
  s_nop 1
  v_cndmask_b32 v48, 0, v33, vcc
  v_cmp_eq_u32 vcc, 1, v34
  s_nop 1
  v_cndmask_b32 v49, 0, v33, vcc
  v_cmp_eq_u32 vcc, 2, v34
  s_nop 1
  v_cndmask_b32 v50, 0, v33, vcc
  v_cmp_eq_u32 vcc, 3, v34
  s_nop 1
  v_cndmask_b32 v51, 0, v33, vcc
  ds_write_b128 v2, v[48:51] offset:31232
  v_lshlrev_b32 v33, 9, v21
  s_lshl_b32 s36, s13, 11
  v_add_u32 v33, s36, v33
  v_lshl_add_u32 v10, v22, 4, v33
  v_lshl_add_u32 v33, v30, 8, v33
  v_add_u32 v9, v33, v32
  v_mov_b32 v12, 0x3f803f80
  v_mov_b32 v13, 0x3f803f80
  v_mov_b32 v14, 0x3f803f80
  v_mov_b32 v15, 0x3f803f80
  s_mov_b32 s2, 0x3f803f80
  s_mov_b32 s3, 0x3f803f80
  s_mov_b32 s98, 0
  v_and_b32 v33, 1, v20
  v_mul_u32_u24 v33, 128, v33
  v_min_u32 v34, 1, v20
  v_lshlrev_b32 v34, 30, v34
  s_cmp_eq_u32 s13, 3
  s_cselect_b64 vcc, -1, 0
  v_cndmask_b32 v19, v34, v33, vcc
  v_mov_b64 v[60:61], 0
  v_mov_b32 v62, 32256
  ds_write_b64 v62, v[60:61]
  s_mov_b32 s16, 0
  s_mov_b32 s17, -1
  s_mov_b32 s18, 0x3e0293ee
  s_mov_b32 s54, 0x2f800000
  s_mov_b32 s55, 0x28000000
  s_lshl_b32 s36, s13, 10
  s_add_u32 s31, s36, 8192
  s_add_u32 s32, s36, 12160
  s_add_u32 s33, s36, 16384
  s_add_u32 s34, s36, 20224
  s_lshl_b32 s36, s12, 19
  s_add_u32 s27, s36, 67108864
  s_add_u32 s28, s36, 83886080
  s_mul_i32 s36, s12, 4096
  s_add_u32 s29, s36, 135266304
  s_lshl_b32 s36, s12, 13
  s_add_u32 s22, s36, 144703488
  s_add_u32 s23, s36, 144707584
  s_mov_b32 s20, 144703488
  s_mov_b32 s21, 144707584
  v_mov_b32 v40, -1
  v_mov_b32 v41, -1
  v_mov_b32 v42, -1
  v_mov_b32 v43, -1
  s_lshl_b32 s36, s13, 13
  s_add_u32 s36, s36, 145752064
  s_add_u32 s37, s36, 4096
  buffer_store_dwordx4 v[40:43], v59, s[4:7], s22 offen sc1
  buffer_store_dwordx4 v[40:43], v59, s[4:7], s23 offen sc1
  buffer_store_dword v40, v8, s[4:7], s36 offen sc1
  buffer_store_dword v40, v8, s[4:7], s37 offen sc1
  v_mov_b32 v52, 0
  v_min_u32 v53, 1, v59
  v_lshlrev_b32 v53, 30, v53
  buffer_store_dword v52, v53, s[4:7], s15 offen sc1
  s_waitcnt vmcnt(21)
  ds_read_b64_tr_b16 a[160:161], v28 offset:0
  ds_read_b64_tr_b16 a[162:163], v28 offset:256
  ds_read_b64_tr_b16 a[164:165], v28 offset:1024
  ds_read_b64_tr_b16 a[166:167], v28 offset:1280
  ds_read_b64_tr_b16 a[168:169], v28 offset:8
  ds_read_b64_tr_b16 a[170:171], v28 offset:264
  ds_read_b64_tr_b16 a[172:173], v28 offset:1032
  ds_read_b64_tr_b16 a[174:175], v28 offset:1288
  s_waitcnt lgkmcnt(0)
  s_xor_b32 s36, s13, 2
  s_lshl_b32 s36, s36, 15
  s_add_u32 m0, s39, 0
  s_add_u32 s37, s36, 0
  buffer_load_dwordx4 v26, s[48:51], s37 offen lds
  s_add_u32 m0, s39, 1024
  s_add_u32 s37, s36, 8192
  buffer_load_dwordx4 v26, s[48:51], s37 offen lds
  s_add_u32 m0, s39, 2048
  s_add_u32 s37, s36, 16384
  buffer_load_dwordx4 v26, s[48:51], s37 offen lds
  s_add_u32 m0, s39, 3072
  s_add_u32 s37, s36, 24576
  buffer_load_dwordx4 v26, s[48:51], s37 offen lds
  s_waitcnt vmcnt(21)
  ds_read_b64_tr_b16 a[176:177], v28 offset:4096
  ds_read_b64_tr_b16 a[178:179], v28 offset:4352
  ds_read_b64_tr_b16 a[180:181], v28 offset:5120
  ds_read_b64_tr_b16 a[182:183], v28 offset:5376
  ds_read_b64_tr_b16 a[184:185], v28 offset:4104
  ds_read_b64_tr_b16 a[186:187], v28 offset:4360
  ds_read_b64_tr_b16 a[188:189], v28 offset:5128
  ds_read_b64_tr_b16 a[190:191], v28 offset:5384
  s_waitcnt lgkmcnt(0)
  s_xor_b32 s36, s13, 3
  s_lshl_b32 s36, s36, 15
  s_add_u32 m0, s39, 4096
  s_add_u32 s37, s36, 0
  buffer_load_dwordx4 v26, s[48:51], s37 offen lds
  s_add_u32 m0, s39, 5120
  s_add_u32 s37, s36, 8192
  buffer_load_dwordx4 v26, s[48:51], s37 offen lds
  s_add_u32 m0, s39, 6144
  s_add_u32 s37, s36, 16384
  buffer_load_dwordx4 v26, s[48:51], s37 offen lds
  s_add_u32 m0, s39, 7168
  s_add_u32 s37, s36, 24576
  buffer_load_dwordx4 v26, s[48:51], s37 offen lds
  s_waitcnt vmcnt(21)
  ds_read_b64_tr_b16 a[192:193], v28 offset:8192
  ds_read_b64_tr_b16 a[194:195], v28 offset:8448
  ds_read_b64_tr_b16 a[196:197], v28 offset:9216
  ds_read_b64_tr_b16 a[198:199], v28 offset:9472
  ds_read_b64_tr_b16 a[200:201], v28 offset:8200
  ds_read_b64_tr_b16 a[202:203], v28 offset:8456
  ds_read_b64_tr_b16 a[204:205], v28 offset:9224
  ds_read_b64_tr_b16 a[206:207], v28 offset:9480
  s_waitcnt lgkmcnt(0)
  s_xor_b32 s36, s13, 2
  s_lshl_b32 s36, s36, 19
  s_add_u32 m0, s39, 8192
  s_add_u32 s37, s36, 0
  buffer_load_dwordx4 v25, s[8:11], s37 offen lds
  s_add_u32 m0, s39, 9216
  s_add_u32 s37, s36, 131072
  buffer_load_dwordx4 v25, s[8:11], s37 offen lds
  s_add_u32 m0, s39, 10240
  s_add_u32 s37, s36, 262144
  buffer_load_dwordx4 v25, s[8:11], s37 offen lds
  s_add_u32 m0, s39, 11264
  s_add_u32 s37, s36, 393216
  buffer_load_dwordx4 v25, s[8:11], s37 offen lds
  s_waitcnt vmcnt(21)
  ds_read_b64_tr_b16 a[208:209], v28 offset:12288
  ds_read_b64_tr_b16 a[210:211], v28 offset:12544
  ds_read_b64_tr_b16 a[212:213], v28 offset:13312
  ds_read_b64_tr_b16 a[214:215], v28 offset:13568
  ds_read_b64_tr_b16 a[216:217], v28 offset:12296
  ds_read_b64_tr_b16 a[218:219], v28 offset:12552
  ds_read_b64_tr_b16 a[220:221], v28 offset:13320
  ds_read_b64_tr_b16 a[222:223], v28 offset:13576
  s_waitcnt lgkmcnt(0)
  s_xor_b32 s36, s13, 3
  s_lshl_b32 s36, s36, 19
  s_add_u32 m0, s39, 12288
  s_add_u32 s37, s36, 0
  buffer_load_dwordx4 v25, s[8:11], s37 offen lds
  s_add_u32 m0, s39, 13312
  s_add_u32 s37, s36, 131072
  buffer_load_dwordx4 v25, s[8:11], s37 offen lds
  s_add_u32 m0, s39, 14336
  s_add_u32 s37, s36, 262144
  buffer_load_dwordx4 v25, s[8:11], s37 offen lds
  s_add_u32 m0, s39, 15360
  s_add_u32 s37, s36, 393216
  buffer_load_dwordx4 v25, s[8:11], s37 offen lds
  s_waitcnt vmcnt(12)
  ds_read_b64_tr_b16 a[224:225], v28 offset:0
  ds_read_b64_tr_b16 a[226:227], v28 offset:256
  ds_read_b64_tr_b16 a[228:229], v28 offset:1024
  ds_read_b64_tr_b16 a[230:231], v28 offset:1280
  ds_read_b64_tr_b16 a[232:233], v28 offset:8
  ds_read_b64_tr_b16 a[234:235], v28 offset:264
  ds_read_b64_tr_b16 a[236:237], v28 offset:1032
  ds_read_b64_tr_b16 a[238:239], v28 offset:1288
  s_waitcnt lgkmcnt(0)
  s_xor_b32 s36, s13, 4
  s_lshl_b32 s36, s36, 19
  s_add_u32 m0, s39, 0
  s_add_u32 s37, s36, 0
  buffer_load_dwordx4 v25, s[8:11], s37 offen lds
  s_add_u32 m0, s39, 1024
  s_add_u32 s37, s36, 131072
  buffer_load_dwordx4 v25, s[8:11], s37 offen lds
  s_add_u32 m0, s39, 2048
  s_add_u32 s37, s36, 262144
  buffer_load_dwordx4 v25, s[8:11], s37 offen lds
  s_add_u32 m0, s39, 3072
  s_add_u32 s37, s36, 393216
  buffer_load_dwordx4 v25, s[8:11], s37 offen lds
  s_barrier
  s_cmp_lg_u32 s13, 0
  s_cbranch_scc1 T_arm_1
  s_getreg_b32 s36, hwreg(HW_REG_XCC_ID, 0, 3)
  s_lshl_b32 s36, s36, 3
  s_lshl_b64 s[60:61], 1, s36
  s_mov_b32 s62, 1
  s_atomic_add_x2 s[60:61], s[52:53], 0
  s_atomic_add s62, s[52:53], 128
  v_lshl_or_b32 v44, v45, 16, v44
  v_lshl_or_b32 v46, v47, 16, v46
  v_min_u32 v44, -2, v44
  v_min_u32 v46, -2, v46
  s_mov_b32 s36, 145752064
  s_mov_b32 s37, 145756160
  buffer_store_dword v44, v8, s[4:7], s36 offen sc1
  buffer_store_dword v46, v8, s[4:7], s37 offen sc1
T_arm_1:
  s_waitcnt vmcnt(12)
  ds_read_b64_tr_b16 a[240:241], v28 offset:4096
  ds_read_b64_tr_b16 a[242:243], v28 offset:4352
  ds_read_b64_tr_b16 a[244:245], v28 offset:5120
  ds_read_b64_tr_b16 a[246:247], v28 offset:5376
  ds_read_b64_tr_b16 a[248:249], v28 offset:4104
  ds_read_b64_tr_b16 a[250:251], v28 offset:4360
  ds_read_b64_tr_b16 a[252:253], v28 offset:5128
  ds_read_b64_tr_b16 a[254:255], v28 offset:5384
  s_waitcnt lgkmcnt(0)
  s_xor_b32 s36, s13, 5
  s_lshl_b32 s36, s36, 19
  s_add_u32 m0, s39, 4096
  s_add_u32 s37, s36, 0
  buffer_load_dwordx4 v25, s[8:11], s37 offen lds
  s_add_u32 m0, s39, 5120
  s_add_u32 s37, s36, 131072
  buffer_load_dwordx4 v25, s[8:11], s37 offen lds
  s_add_u32 m0, s39, 6144
  s_add_u32 s37, s36, 262144
  buffer_load_dwordx4 v25, s[8:11], s37 offen lds
  s_add_u32 m0, s39, 7168
  s_add_u32 s37, s36, 393216
  buffer_load_dwordx4 v25, s[8:11], s37 offen lds
  s_waitcnt vmcnt(12)
  ds_read_b64_tr_b16 v[160:161], v27 offset:8192
  ds_read_b64_tr_b16 v[162:163], v27 offset:8320
  ds_read_b64_tr_b16 v[164:165], v27 offset:9216
  ds_read_b64_tr_b16 v[166:167], v27 offset:9344
  ds_read_b64_tr_b16 v[168:169], v36 offset:8192
  ds_read_b64_tr_b16 v[170:171], v36 offset:8320
  ds_read_b64_tr_b16 v[172:173], v36 offset:9216
  ds_read_b64_tr_b16 v[174:175], v36 offset:9344
  s_waitcnt lgkmcnt(0)
  s_xor_b32 s36, s13, 4
  s_lshl_b32 s36, s36, 19
  s_add_u32 m0, s39, 8192
  s_add_u32 s37, s36, 0
  buffer_load_dwordx4 v25, s[40:43], s37 offen lds
  s_add_u32 m0, s39, 9216
  s_add_u32 s37, s36, 131072
  buffer_load_dwordx4 v25, s[40:43], s37 offen lds
  s_add_u32 m0, s39, 10240
  s_add_u32 s37, s36, 262144
  buffer_load_dwordx4 v25, s[40:43], s37 offen lds
  s_add_u32 m0, s39, 11264
  s_add_u32 s37, s36, 393216
  buffer_load_dwordx4 v25, s[40:43], s37 offen lds
  s_waitcnt vmcnt(12)
  ds_read_b64_tr_b16 v[192:193], v27 offset:12288
  ds_read_b64_tr_b16 v[194:195], v27 offset:12416
  ds_read_b64_tr_b16 v[196:197], v27 offset:13312
  ds_read_b64_tr_b16 v[198:199], v27 offset:13440
  ds_read_b64_tr_b16 v[200:201], v36 offset:12288
  ds_read_b64_tr_b16 v[202:203], v36 offset:12416
  ds_read_b64_tr_b16 v[204:205], v36 offset:13312
  ds_read_b64_tr_b16 v[206:207], v36 offset:13440
  s_waitcnt lgkmcnt(0)
  s_xor_b32 s36, s13, 5
  s_lshl_b32 s36, s36, 19
  s_add_u32 m0, s39, 12288
  s_add_u32 s37, s36, 0
  buffer_load_dwordx4 v25, s[40:43], s37 offen lds
  s_add_u32 m0, s39, 13312
  s_add_u32 s37, s36, 131072
  buffer_load_dwordx4 v25, s[40:43], s37 offen lds
  s_add_u32 m0, s39, 14336
  s_add_u32 s37, s36, 262144
  buffer_load_dwordx4 v25, s[40:43], s37 offen lds
  s_add_u32 m0, s39, 15360
  s_add_u32 s37, s36, 393216
  buffer_load_dwordx4 v25, s[40:43], s37 offen lds
  s_waitcnt vmcnt(12)
  ds_read_b64_tr_b16 v[224:225], v27 offset:0
  ds_read_b64_tr_b16 v[226:227], v27 offset:128
  ds_read_b64_tr_b16 v[228:229], v27 offset:1024
  ds_read_b64_tr_b16 v[230:231], v27 offset:1152
  ds_read_b64_tr_b16 v[232:233], v36 offset:0
  ds_read_b64_tr_b16 v[234:235], v36 offset:128
  ds_read_b64_tr_b16 v[236:237], v36 offset:1024
  ds_read_b64_tr_b16 v[238:239], v36 offset:1152
  s_waitcnt lgkmcnt(0)
  s_xor_b32 s36, s13, 4
  s_lshl_b32 s36, s36, 19
  s_add_u32 m0, s39, 0
  s_add_u32 s37, s36, 0
  buffer_load_dwordx4 v25, s[44:47], s37 offen lds
  s_add_u32 m0, s39, 1024
  s_add_u32 s37, s36, 131072
  buffer_load_dwordx4 v25, s[44:47], s37 offen lds
  s_add_u32 m0, s39, 2048
  s_add_u32 s37, s36, 262144
  buffer_load_dwordx4 v25, s[44:47], s37 offen lds
  s_add_u32 m0, s39, 3072
  s_add_u32 s37, s36, 393216
  buffer_load_dwordx4 v25, s[44:47], s37 offen lds
  s_waitcnt vmcnt(12)
  ds_read_b64_tr_b16 a[16:17], v27 offset:4096
  ds_read_b64_tr_b16 a[18:19], v27 offset:4224
  ds_read_b64_tr_b16 a[20:21], v27 offset:5120
  ds_read_b64_tr_b16 a[22:23], v27 offset:5248
  ds_read_b64_tr_b16 a[24:25], v36 offset:4096
  ds_read_b64_tr_b16 a[26:27], v36 offset:4224
  ds_read_b64_tr_b16 a[28:29], v36 offset:5120
  ds_read_b64_tr_b16 a[30:31], v36 offset:5248
  s_waitcnt lgkmcnt(0)
  s_xor_b32 s36, s13, 5
  s_lshl_b32 s36, s36, 19
  s_add_u32 m0, s39, 4096
  s_add_u32 s37, s36, 0
  buffer_load_dwordx4 v25, s[44:47], s37 offen lds
  s_add_u32 m0, s39, 5120
  s_add_u32 s37, s36, 131072
  buffer_load_dwordx4 v25, s[44:47], s37 offen lds
  s_add_u32 m0, s39, 6144
  s_add_u32 s37, s36, 262144
  buffer_load_dwordx4 v25, s[44:47], s37 offen lds
  s_add_u32 m0, s39, 7168
  s_add_u32 s37, s36, 393216
  buffer_load_dwordx4 v25, s[44:47], s37 offen lds
  s_waitcnt vmcnt(12)
  ds_read_b64_tr_b16 v[240:241], v27 offset:8192
  ds_read_b64_tr_b16 v[242:243], v27 offset:8320
  ds_read_b64_tr_b16 v[244:245], v27 offset:9216
  ds_read_b64_tr_b16 v[246:247], v27 offset:9344
  ds_read_b64_tr_b16 v[248:249], v36 offset:8192
  ds_read_b64_tr_b16 v[250:251], v36 offset:8320
  ds_read_b64_tr_b16 v[252:253], v36 offset:9216
  ds_read_b64_tr_b16 v[254:255], v36 offset:9344
  s_waitcnt lgkmcnt(0)
  s_xor_b32 s36, s13, 6
  s_lshl_b32 s36, s36, 19
  s_add_u32 m0, s39, 8192
  s_add_u32 s37, s36, 0
  buffer_load_dwordx4 v25, s[8:11], s37 offen lds
  s_add_u32 m0, s39, 9216
  s_add_u32 s37, s36, 131072
  buffer_load_dwordx4 v25, s[8:11], s37 offen lds
  s_add_u32 m0, s39, 10240
  s_add_u32 s37, s36, 262144
  buffer_load_dwordx4 v25, s[8:11], s37 offen lds
  s_add_u32 m0, s39, 11264
  s_add_u32 s37, s36, 393216
  buffer_load_dwordx4 v25, s[8:11], s37 offen lds
  s_waitcnt vmcnt(12)
  ds_read_b64_tr_b16 a[32:33], v27 offset:12288
  ds_read_b64_tr_b16 a[34:35], v27 offset:12416
  ds_read_b64_tr_b16 a[36:37], v27 offset:13312
  ds_read_b64_tr_b16 a[38:39], v27 offset:13440
  ds_read_b64_tr_b16 a[40:41], v36 offset:12288
  ds_read_b64_tr_b16 a[42:43], v36 offset:12416
  ds_read_b64_tr_b16 a[44:45], v36 offset:13312
  ds_read_b64_tr_b16 a[46:47], v36 offset:13440
  s_waitcnt lgkmcnt(0)
  s_xor_b32 s36, s13, 7
  s_lshl_b32 s36, s36, 19
  s_add_u32 m0, s39, 12288
  s_add_u32 s37, s36, 0
  buffer_load_dwordx4 v25, s[8:11], s37 offen lds
  s_add_u32 m0, s39, 13312
  s_add_u32 s37, s36, 131072
  buffer_load_dwordx4 v25, s[8:11], s37 offen lds
  s_add_u32 m0, s39, 14336
  s_add_u32 s37, s36, 262144
  buffer_load_dwordx4 v25, s[8:11], s37 offen lds
  s_add_u32 m0, s39, 15360
  s_add_u32 s37, s36, 393216
  buffer_load_dwordx4 v25, s[8:11], s37 offen lds
  s_waitcnt vmcnt(12)
  ds_read_b64_tr_b16 a[0:1], v27 offset:0
  ds_read_b64_tr_b16 a[2:3], v27 offset:128
  ds_read_b64_tr_b16 a[4:5], v27 offset:1024
  ds_read_b64_tr_b16 a[6:7], v27 offset:1152
  ds_read_b64_tr_b16 a[8:9], v36 offset:0
  ds_read_b64_tr_b16 a[10:11], v36 offset:128
  ds_read_b64_tr_b16 a[12:13], v36 offset:1024
  ds_read_b64_tr_b16 a[14:15], v36 offset:1152
  s_waitcnt lgkmcnt(0)
  s_xor_b32 s36, s13, 6
  s_lshl_b32 s36, s36, 19
  s_add_u32 m0, s39, 0
  s_add_u32 s37, s36, 0
  buffer_load_dwordx4 v25, s[40:43], s37 offen lds
  s_add_u32 m0, s39, 1024
  s_add_u32 s37, s36, 131072
  buffer_load_dwordx4 v25, s[40:43], s37 offen lds
  s_add_u32 m0, s39, 2048
  s_add_u32 s37, s36, 262144
  buffer_load_dwordx4 v25, s[40:43], s37 offen lds
  s_add_u32 m0, s39, 3072
  s_add_u32 s37, s36, 393216
  buffer_load_dwordx4 v25, s[40:43], s37 offen lds
  s_waitcnt vmcnt(12)
  ds_read_b64_tr_b16 a[48:49], v27 offset:4096
  ds_read_b64_tr_b16 a[50:51], v27 offset:4224
  ds_read_b64_tr_b16 a[52:53], v27 offset:5120
  ds_read_b64_tr_b16 a[54:55], v27 offset:5248
  ds_read_b64_tr_b16 a[56:57], v36 offset:4096
  ds_read_b64_tr_b16 a[58:59], v36 offset:4224
  ds_read_b64_tr_b16 a[60:61], v36 offset:5120
  ds_read_b64_tr_b16 a[62:63], v36 offset:5248
  s_waitcnt lgkmcnt(0)
  s_xor_b32 s36, s13, 7
  s_lshl_b32 s36, s36, 19
  s_add_u32 m0, s39, 4096
  s_add_u32 s37, s36, 0
  buffer_load_dwordx4 v25, s[40:43], s37 offen lds
  s_add_u32 m0, s39, 5120
  s_add_u32 s37, s36, 131072
  buffer_load_dwordx4 v25, s[40:43], s37 offen lds
  s_add_u32 m0, s39, 6144
  s_add_u32 s37, s36, 262144
  buffer_load_dwordx4 v25, s[40:43], s37 offen lds
  s_add_u32 m0, s39, 7168
  s_add_u32 s37, s36, 393216
  buffer_load_dwordx4 v25, s[40:43], s37 offen lds
  s_waitcnt vmcnt(12)
  ds_read_b64_tr_b16 a[64:65], v27 offset:8192
  ds_read_b64_tr_b16 a[66:67], v27 offset:8320
  ds_read_b64_tr_b16 a[68:69], v27 offset:9216
  ds_read_b64_tr_b16 a[70:71], v27 offset:9344
  ds_read_b64_tr_b16 a[72:73], v36 offset:8192
  ds_read_b64_tr_b16 a[74:75], v36 offset:8320
  ds_read_b64_tr_b16 a[76:77], v36 offset:9216
  ds_read_b64_tr_b16 a[78:79], v36 offset:9344
  s_waitcnt lgkmcnt(0)
  s_xor_b32 s36, s13, 6
  s_lshl_b32 s36, s36, 19
  s_add_u32 m0, s39, 8192
  s_add_u32 s37, s36, 0
  buffer_load_dwordx4 v25, s[44:47], s37 offen lds
  s_add_u32 m0, s39, 9216
  s_add_u32 s37, s36, 131072
  buffer_load_dwordx4 v25, s[44:47], s37 offen lds
  s_add_u32 m0, s39, 10240
  s_add_u32 s37, s36, 262144
  buffer_load_dwordx4 v25, s[44:47], s37 offen lds
  s_add_u32 m0, s39, 11264
  s_add_u32 s37, s36, 393216
  buffer_load_dwordx4 v25, s[44:47], s37 offen lds
  s_waitcnt vmcnt(12)
  ds_read_b64_tr_b16 a[112:113], v27 offset:12288
  ds_read_b64_tr_b16 a[114:115], v27 offset:12416
  ds_read_b64_tr_b16 a[116:117], v27 offset:13312
  ds_read_b64_tr_b16 a[118:119], v27 offset:13440
  ds_read_b64_tr_b16 a[120:121], v36 offset:12288
  ds_read_b64_tr_b16 a[122:123], v36 offset:12416
  ds_read_b64_tr_b16 a[124:125], v36 offset:13312
  ds_read_b64_tr_b16 a[126:127], v36 offset:13440
  s_waitcnt lgkmcnt(0)
  s_xor_b32 s36, s13, 7
  s_lshl_b32 s36, s36, 19
  s_add_u32 m0, s39, 12288
  s_add_u32 s37, s36, 0
  buffer_load_dwordx4 v25, s[44:47], s37 offen lds
  s_add_u32 m0, s39, 13312
  s_add_u32 s37, s36, 131072
  buffer_load_dwordx4 v25, s[44:47], s37 offen lds
  s_add_u32 m0, s39, 14336
  s_add_u32 s37, s36, 262144
  buffer_load_dwordx4 v25, s[44:47], s37 offen lds
  s_add_u32 m0, s39, 15360
  s_add_u32 s37, s36, 393216
  buffer_load_dwordx4 v25, s[44:47], s37 offen lds
  s_waitcnt vmcnt(12)
  ds_read_b64_tr_b16 a[80:81], v27 offset:0
  ds_read_b64_tr_b16 a[82:83], v27 offset:128
  ds_read_b64_tr_b16 a[84:85], v27 offset:1024
  ds_read_b64_tr_b16 a[86:87], v27 offset:1152
  ds_read_b64_tr_b16 a[88:89], v36 offset:0
  ds_read_b64_tr_b16 a[90:91], v36 offset:128
  ds_read_b64_tr_b16 a[92:93], v36 offset:1024
  ds_read_b64_tr_b16 a[94:95], v36 offset:1152
  s_waitcnt lgkmcnt(0)
  s_xor_b32 s36, s13, 1
  s_lshl_b32 s36, s36, 19
  s_add_u32 m0, s39, 16384
  s_add_u32 s37, s36, 0
  buffer_load_dwordx4 v25, s[8:11], s37 offen lds
  s_add_u32 m0, s39, 17408
  s_add_u32 s37, s36, 131072
  buffer_load_dwordx4 v25, s[8:11], s37 offen lds
  s_add_u32 m0, s39, 18432
  s_add_u32 s37, s36, 262144
  buffer_load_dwordx4 v25, s[8:11], s37 offen lds
  s_add_u32 m0, s39, 19456
  s_add_u32 s37, s36, 393216
  buffer_load_dwordx4 v25, s[8:11], s37 offen lds
  s_waitcnt vmcnt(12)
  ds_read_b64_tr_b16 a[128:129], v27 offset:4096
  ds_read_b64_tr_b16 a[130:131], v27 offset:4224
  ds_read_b64_tr_b16 a[132:133], v27 offset:5120
  ds_read_b64_tr_b16 a[134:135], v27 offset:5248
  ds_read_b64_tr_b16 a[136:137], v36 offset:4096
  ds_read_b64_tr_b16 a[138:139], v36 offset:4224
  ds_read_b64_tr_b16 a[140:141], v36 offset:5120
  ds_read_b64_tr_b16 a[142:143], v36 offset:5248
  s_waitcnt lgkmcnt(0)
  s_xor_b32 s36, s13, 0
  s_lshl_b32 s36, s36, 19
  s_add_u32 m0, s39, 0
  s_add_u32 s37, s36, 0
  buffer_load_dwordx4 v25, s[8:11], s37 offen lds
  s_add_u32 m0, s39, 1024
  s_add_u32 s37, s36, 131072
  buffer_load_dwordx4 v25, s[8:11], s37 offen lds
  s_add_u32 m0, s39, 2048
  s_add_u32 s37, s36, 262144
  buffer_load_dwordx4 v25, s[8:11], s37 offen lds
  s_add_u32 m0, s39, 3072
  s_add_u32 s37, s36, 393216
  buffer_load_dwordx4 v25, s[8:11], s37 offen lds
  s_waitcnt vmcnt(12)
  ds_read_b64_tr_b16 a[96:97], v27 offset:8192
  ds_read_b64_tr_b16 a[98:99], v27 offset:8320
  ds_read_b64_tr_b16 a[100:101], v27 offset:9216
  ds_read_b64_tr_b16 a[102:103], v27 offset:9344
  ds_read_b64_tr_b16 a[104:105], v36 offset:8192
  ds_read_b64_tr_b16 a[106:107], v36 offset:8320
  ds_read_b64_tr_b16 a[108:109], v36 offset:9216
  ds_read_b64_tr_b16 a[110:111], v36 offset:9344
  s_waitcnt lgkmcnt(0)
  s_xor_b32 s36, s13, 1
  s_lshl_b32 s36, s36, 19
  s_add_u32 m0, s39, 8192
  s_add_u32 s37, s36, 0
  buffer_load_dwordx4 v25, s[40:43], s37 offen lds
  s_add_u32 m0, s39, 9216
  s_add_u32 s37, s36, 131072
  buffer_load_dwordx4 v25, s[40:43], s37 offen lds
  s_add_u32 m0, s39, 10240
  s_add_u32 s37, s36, 262144
  buffer_load_dwordx4 v25, s[40:43], s37 offen lds
  s_add_u32 m0, s39, 11264
  s_add_u32 s37, s36, 393216
  buffer_load_dwordx4 v25, s[40:43], s37 offen lds
  s_waitcnt vmcnt(12)
  ds_read_b64_tr_b16 a[144:145], v27 offset:12288
  ds_read_b64_tr_b16 a[146:147], v27 offset:12416
  ds_read_b64_tr_b16 a[148:149], v27 offset:13312
  ds_read_b64_tr_b16 a[150:151], v27 offset:13440
  ds_read_b64_tr_b16 a[152:153], v36 offset:12288
  ds_read_b64_tr_b16 a[154:155], v36 offset:12416
  ds_read_b64_tr_b16 a[156:157], v36 offset:13312
  ds_read_b64_tr_b16 a[158:159], v36 offset:13440
  s_waitcnt lgkmcnt(0)
  s_xor_b32 s36, s13, 0
  s_lshl_b32 s36, s36, 19
  s_add_u32 m0, s39, 4096
  s_add_u32 s37, s36, 0
  buffer_load_dwordx4 v25, s[40:43], s37 offen lds
  s_add_u32 m0, s39, 5120
  s_add_u32 s37, s36, 131072
  buffer_load_dwordx4 v25, s[40:43], s37 offen lds
  s_add_u32 m0, s39, 6144
  s_add_u32 s37, s36, 262144
  buffer_load_dwordx4 v25, s[40:43], s37 offen lds
  s_add_u32 m0, s39, 7168
  s_add_u32 s37, s36, 393216
  buffer_load_dwordx4 v25, s[40:43], s37 offen lds
  s_waitcnt vmcnt(12)
  ds_read_b64_tr_b16 v[128:129], v27 offset:16384
  ds_read_b64_tr_b16 v[130:131], v27 offset:16512
  ds_read_b64_tr_b16 v[132:133], v27 offset:17408
  ds_read_b64_tr_b16 v[134:135], v27 offset:17536
  ds_read_b64_tr_b16 v[136:137], v36 offset:16384
  ds_read_b64_tr_b16 v[138:139], v36 offset:16512
  ds_read_b64_tr_b16 v[140:141], v36 offset:17408
  ds_read_b64_tr_b16 v[142:143], v36 offset:17536
  s_waitcnt lgkmcnt(0)
  s_xor_b32 s36, s13, 2
  s_lshl_b32 s36, s36, 19
  s_add_u32 m0, s39, 12288
  s_add_u32 s37, s36, 0
  buffer_load_dwordx4 v25, s[40:43], s37 offen lds
  s_add_u32 m0, s39, 13312
  s_add_u32 s37, s36, 131072
  buffer_load_dwordx4 v25, s[40:43], s37 offen lds
  s_add_u32 m0, s39, 14336
  s_add_u32 s37, s36, 262144
  buffer_load_dwordx4 v25, s[40:43], s37 offen lds
  s_add_u32 m0, s39, 15360
  s_add_u32 s37, s36, 393216
  buffer_load_dwordx4 v25, s[40:43], s37 offen lds
  s_waitcnt vmcnt(12)
  ds_read_b64_tr_b16 v[64:65], v27 offset:0
  ds_read_b64_tr_b16 v[66:67], v27 offset:128
  ds_read_b64_tr_b16 v[68:69], v27 offset:1024
  ds_read_b64_tr_b16 v[70:71], v27 offset:1152
  ds_read_b64_tr_b16 v[72:73], v36 offset:0
  ds_read_b64_tr_b16 v[74:75], v36 offset:128
  ds_read_b64_tr_b16 v[76:77], v36 offset:1024
  ds_read_b64_tr_b16 v[78:79], v36 offset:1152
  s_waitcnt lgkmcnt(0)
  ds_write_b128 v4, v[64:67] offset:0
  ds_write_b128 v4, v[68:71] offset:1024
  ds_write_b128 v4, v[72:75] offset:2048
  ds_write_b128 v4, v[76:79] offset:3072
  s_waitcnt lgkmcnt(0)
  s_xor_b32 s36, s13, 3
  s_lshl_b32 s36, s36, 19
  s_add_u32 m0, s39, 16384
  s_add_u32 s37, s36, 0
  buffer_load_dwordx4 v25, s[40:43], s37 offen lds
  s_add_u32 m0, s39, 17408
  s_add_u32 s37, s36, 131072
  buffer_load_dwordx4 v25, s[40:43], s37 offen lds
  s_add_u32 m0, s39, 18432
  s_add_u32 s37, s36, 262144
  buffer_load_dwordx4 v25, s[40:43], s37 offen lds
  s_add_u32 m0, s39, 19456
  s_add_u32 s37, s36, 393216
  buffer_load_dwordx4 v25, s[40:43], s37 offen lds
  s_waitcnt vmcnt(12)
  ds_read_b64_tr_b16 v[144:145], v27 offset:8192
  ds_read_b64_tr_b16 v[146:147], v27 offset:8320
  ds_read_b64_tr_b16 v[148:149], v27 offset:9216
  ds_read_b64_tr_b16 v[150:151], v27 offset:9344
  ds_read_b64_tr_b16 v[152:153], v36 offset:8192
  ds_read_b64_tr_b16 v[154:155], v36 offset:8320
  ds_read_b64_tr_b16 v[156:157], v36 offset:9216
  ds_read_b64_tr_b16 v[158:159], v36 offset:9344
  s_waitcnt lgkmcnt(0)
  s_xor_b32 s36, s13, 3
  s_lshl_b32 s36, s36, 19
  s_add_u32 m0, s39, 24576
  s_add_u32 s37, s36, 0
  buffer_load_dwordx4 v25, s[44:47], s37 offen lds
  s_add_u32 m0, s39, 25600
  s_add_u32 s37, s36, 131072
  buffer_load_dwordx4 v25, s[44:47], s37 offen lds
  s_add_u32 m0, s39, 26624
  s_add_u32 s37, s36, 262144
  buffer_load_dwordx4 v25, s[44:47], s37 offen lds
  s_add_u32 m0, s39, 27648
  s_add_u32 s37, s36, 393216
  buffer_load_dwordx4 v25, s[44:47], s37 offen lds
  buffer_load_dwordx2 v[54:55], off, s[72:75], 0 sc1
  buffer_load_dword v56, off, s[72:75], 0 offset:128 sc1
  s_waitcnt vmcnt(14)
  ds_read_b64_tr_b16 v[64:65], v27 offset:4096
  ds_read_b64_tr_b16 v[66:67], v27 offset:4224
  ds_read_b64_tr_b16 v[68:69], v27 offset:5120
  ds_read_b64_tr_b16 v[70:71], v27 offset:5248
  ds_read_b64_tr_b16 v[72:73], v36 offset:4096
  ds_read_b64_tr_b16 v[74:75], v36 offset:4224
  ds_read_b64_tr_b16 v[76:77], v36 offset:5120
  ds_read_b64_tr_b16 v[78:79], v36 offset:5248
  s_waitcnt lgkmcnt(0)
  ds_write_b128 v4, v[64:67] offset:4096
  ds_write_b128 v4, v[68:71] offset:5120
  ds_write_b128 v4, v[72:75] offset:6144
  ds_write_b128 v4, v[76:79] offset:7168
  s_waitcnt lgkmcnt(0)
  s_xor_b32 s36, s13, 2
  s_lshl_b32 s36, s36, 19
  s_add_u32 m0, s39, 20480
  s_add_u32 s37, s36, 0
  buffer_load_dwordx4 v25, s[44:47], s37 offen lds
  s_add_u32 m0, s39, 21504
  s_add_u32 s37, s36, 131072
  buffer_load_dwordx4 v25, s[44:47], s37 offen lds
  s_add_u32 m0, s39, 22528
  s_add_u32 s37, s36, 262144
  buffer_load_dwordx4 v25, s[44:47], s37 offen lds
  s_add_u32 m0, s39, 23552
  s_add_u32 s37, s36, 393216
  buffer_load_dwordx4 v25, s[44:47], s37 offen lds
  s_waitcnt vmcnt(14)
  ds_read_b64_tr_b16 v[176:177], v27 offset:12288
  ds_read_b64_tr_b16 v[178:179], v27 offset:12416
  ds_read_b64_tr_b16 v[180:181], v27 offset:13312
  ds_read_b64_tr_b16 v[182:183], v27 offset:13440
  ds_read_b64_tr_b16 v[184:185], v36 offset:12288
  ds_read_b64_tr_b16 v[186:187], v36 offset:12416
  ds_read_b64_tr_b16 v[188:189], v36 offset:13312
  ds_read_b64_tr_b16 v[190:191], v36 offset:13440
  s_waitcnt lgkmcnt(0)
  s_xor_b32 s36, s13, 0
  s_lshl_b32 s36, s36, 19
  s_add_u32 m0, s39, 8192
  s_add_u32 s37, s36, 0
  buffer_load_dwordx4 v25, s[44:47], s37 offen lds
  s_add_u32 m0, s39, 9216
  s_add_u32 s37, s36, 131072
  buffer_load_dwordx4 v25, s[44:47], s37 offen lds
  s_add_u32 m0, s39, 10240
  s_add_u32 s37, s36, 262144
  buffer_load_dwordx4 v25, s[44:47], s37 offen lds
  s_add_u32 m0, s39, 11264
  s_add_u32 s37, s36, 393216
  buffer_load_dwordx4 v25, s[44:47], s37 offen lds
  s_waitcnt vmcnt(14)
  ds_read_b64_tr_b16 v[64:65], v27 offset:16384
  ds_read_b64_tr_b16 v[66:67], v27 offset:16512
  ds_read_b64_tr_b16 v[68:69], v27 offset:17408
  ds_read_b64_tr_b16 v[70:71], v27 offset:17536
  ds_read_b64_tr_b16 v[72:73], v36 offset:16384
  ds_read_b64_tr_b16 v[74:75], v36 offset:16512
  ds_read_b64_tr_b16 v[76:77], v36 offset:17408
  ds_read_b64_tr_b16 v[78:79], v36 offset:17536
  s_waitcnt lgkmcnt(0)
  ds_write_b128 v4, v[64:67] offset:16384
  ds_write_b128 v4, v[68:71] offset:17408
  ds_write_b128 v4, v[72:75] offset:18432
  ds_write_b128 v4, v[76:79] offset:19456
  s_waitcnt lgkmcnt(0)
  s_xor_b32 s36, s13, 1
  s_lshl_b32 s36, s36, 19
  s_add_u32 m0, s39, 12288
  s_add_u32 s37, s36, 0
  buffer_load_dwordx4 v25, s[44:47], s37 offen lds
  s_add_u32 m0, s39, 13312
  s_add_u32 s37, s36, 131072
  buffer_load_dwordx4 v25, s[44:47], s37 offen lds
  s_add_u32 m0, s39, 14336
  s_add_u32 s37, s36, 262144
  buffer_load_dwordx4 v25, s[44:47], s37 offen lds
  s_add_u32 m0, s39, 15360
  s_add_u32 s37, s36, 393216
  buffer_load_dwordx4 v25, s[44:47], s37 offen lds
  s_waitcnt vmcnt(14)
  ds_read_b64_tr_b16 v[208:209], v27 offset:24576
  ds_read_b64_tr_b16 v[210:211], v27 offset:24704
  ds_read_b64_tr_b16 v[212:213], v27 offset:25600
  ds_read_b64_tr_b16 v[214:215], v27 offset:25728
  ds_read_b64_tr_b16 v[216:217], v36 offset:24576
  ds_read_b64_tr_b16 v[218:219], v36 offset:24704
  ds_read_b64_tr_b16 v[220:221], v36 offset:25600
  ds_read_b64_tr_b16 v[222:223], v36 offset:25728
  s_waitcnt lgkmcnt(0)
  s_xor_b32 s36, s13, 2
  s_lshl_b32 s36, s36, 15
  s_add_u32 m0, s39, 24576
  s_add_u32 s37, s36, 512
  buffer_load_dwordx4 v26, s[48:51], s37 offen lds
  s_add_u32 m0, s39, 25600
  s_add_u32 s37, s36, 8704
  buffer_load_dwordx4 v26, s[48:51], s37 offen lds
  s_add_u32 m0, s39, 26624
  s_add_u32 s37, s36, 16896
  buffer_load_dwordx4 v26, s[48:51], s37 offen lds
  s_add_u32 m0, s39, 27648
  s_add_u32 s37, s36, 25088
  buffer_load_dwordx4 v26, s[48:51], s37 offen lds
  s_waitcnt vmcnt(12)
  ds_read_b64_tr_b16 v[64:65], v27 offset:20480
  ds_read_b64_tr_b16 v[66:67], v27 offset:20608
  ds_read_b64_tr_b16 v[68:69], v27 offset:21504
  ds_read_b64_tr_b16 v[70:71], v27 offset:21632
  ds_read_b64_tr_b16 v[72:73], v36 offset:20480
  ds_read_b64_tr_b16 v[74:75], v36 offset:20608
  ds_read_b64_tr_b16 v[76:77], v36 offset:21504
  ds_read_b64_tr_b16 v[78:79], v36 offset:21632
  s_waitcnt lgkmcnt(0)
  ds_write_b128 v4, v[64:67] offset:20480
  ds_write_b128 v4, v[68:71] offset:21504
  ds_write_b128 v4, v[72:75] offset:22528
  ds_write_b128 v4, v[76:79] offset:23552
  s_waitcnt lgkmcnt(0)
  s_xor_b32 s36, s13, 3
  s_lshl_b32 s36, s36, 15
  s_add_u32 m0, s39, 28672
  s_add_u32 s37, s36, 512
  buffer_load_dwordx4 v26, s[48:51], s37 offen lds
  s_add_u32 m0, s39, 29696
  s_add_u32 s37, s36, 8704
  buffer_load_dwordx4 v26, s[48:51], s37 offen lds
  s_add_u32 m0, s39, 30720
  s_add_u32 s37, s36, 16896
  buffer_load_dwordx4 v26, s[48:51], s37 offen lds
  s_add_u32 m0, s39, 31744
  s_add_u32 s37, s36, 25088
  buffer_load_dwordx4 v26, s[48:51], s37 offen lds
  s_mov_b32 s19, 0
  s_branch T_arrgo_3
T_arr_2:
  s_add_u32 s19, s19, 1
  s_cmp_gt_u32 s19, 32768
  s_cbranch_scc1 M_exit
  buffer_load_dwordx2 v[54:55], off, s[72:75], 0 sc1
  buffer_load_dword v56, off, s[72:75], 0 offset:128 sc1
  s_waitcnt vmcnt(0)
T_arrgo_3:
  v_sad_u8 v57, v54, 0, 0
  v_sad_u8 v57, v55, 0, v57
  v_or_b32 v58, v54, v55
  v_cmp_gt_u32 vcc, 32, v57
  s_cbranch_vccnz T_arr_2
  v_cmp_gt_u32 vcc, 0x100, v56
  s_cbranch_vccnz T_arr_2
  v_readfirstlane_b32 s36, v58
  s_nop 0
  s_and_b32 s36, s36, 0x20202020
  s_cselect_b32 s56, 0, 1
  s_mov_b32 s14, -1
  s_mov_b32 s30, -1
  s_mov_b32 s19, 0
  s_branch T_kvok_5
T_kv_4:
  s_sleep 4
  s_add_u32 s19, s19, 1
  s_cmp_gt_u32 s19, 32768
  s_cbranch_scc1 M_exit
T_kvok_5:
  s_add_u32 s39, s99, 128
  s_mov_b32 s38, 0
  s_mov_b32 s37, 0
  s_atomic_or s38, s[58:59], s99 glc
  s_atomic_or s37, s[58:59], s39 glc
  s_waitcnt lgkmcnt(0)
  s_add_u32 s37, s37, 30
  s_cmp_ge_u32 s38, 30
  s_cselect_b32 s38, s37, s38
  s_cmp_ge_u32 s38, 64
  s_cselect_b32 s38, 100, s38
  s_sub_u32 s38, s38, 1
  s_max_i32 s30, s30, s38
  s_cmp_ge_i32 s14, s30
  s_cbranch_scc1 T_kv_4
  s_mov_b32 m0, s31
  s_nop 0
  buffer_load_dwordx4 v9, s[4:7], s27 offen sc1 lds
  s_mov_b32 m0, s32
  s_nop 0
  buffer_load_dwordx4 v9, s[4:7], s27 offen offset:128 sc1 lds
  s_mov_b32 m0, s33
  s_nop 0
  buffer_load_dwordx4 v10, s[4:7], s28 offen sc1 lds
  s_mov_b32 m0, s34
  s_nop 0
  buffer_load_dwordx4 v10, s[4:7], s28 offen offset:256 sc1 lds
  s_add_u32 s27, s27, 8192
  s_add_u32 s28, s28, 8192
  s_lshl_b32 s36, s12, 10
  s_add_u32 s36, s36, 145752064
  buffer_load_dwordx4 v[40:43], v2, s[4:7], s36 offen sc1
  s_waitcnt vmcnt(17)
  ds_read_b64_tr_b16 v[64:65], v27 offset:8192
  ds_read_b64_tr_b16 v[66:67], v27 offset:8320
  ds_read_b64_tr_b16 v[68:69], v27 offset:9216
  ds_read_b64_tr_b16 v[70:71], v27 offset:9344
  ds_read_b64_tr_b16 v[72:73], v36 offset:8192
  ds_read_b64_tr_b16 v[74:75], v36 offset:8320
  ds_read_b64_tr_b16 v[76:77], v36 offset:9216
  ds_read_b64_tr_b16 v[78:79], v36 offset:9344
  s_waitcnt lgkmcnt(0)
  ds_write_b128 v4, v[64:67] offset:8192
  ds_write_b128 v4, v[68:71] offset:9216
  ds_write_b128 v4, v[72:75] offset:10240
  ds_write_b128 v4, v[76:79] offset:11264
  s_waitcnt lgkmcnt(0)
  s_waitcnt vmcnt(13)
  ds_read_b64_tr_b16 v[64:65], v27 offset:12288
  ds_read_b64_tr_b16 v[66:67], v27 offset:12416
  ds_read_b64_tr_b16 v[68:69], v27 offset:13312
  ds_read_b64_tr_b16 v[70:71], v27 offset:13440
  ds_read_b64_tr_b16 v[72:73], v36 offset:12288
  ds_read_b64_tr_b16 v[74:75], v36 offset:12416
  ds_read_b64_tr_b16 v[76:77], v36 offset:13312
  ds_read_b64_tr_b16 v[78:79], v36 offset:13440
  s_waitcnt lgkmcnt(0)
  ds_write_b128 v4, v[64:67] offset:12288
  ds_write_b128 v4, v[68:71] offset:13312
  ds_write_b128 v4, v[72:75] offset:14336
  ds_write_b128 v4, v[76:79] offset:15360
  s_waitcnt lgkmcnt(0)
  s_waitcnt vmcnt(9)
  ds_read_b64_tr_b16 v[64:65], v28 offset:24576
  ds_read_b64_tr_b16 v[66:67], v28 offset:24832
  ds_read_b64_tr_b16 v[68:69], v28 offset:25600
  ds_read_b64_tr_b16 v[70:71], v28 offset:25856
  ds_read_b64_tr_b16 v[72:73], v28 offset:24584
  ds_read_b64_tr_b16 v[74:75], v28 offset:24840
  ds_read_b64_tr_b16 v[76:77], v28 offset:25608
  ds_read_b64_tr_b16 v[78:79], v28 offset:25864
  s_waitcnt lgkmcnt(0)
  ds_write_b128 v4, v[64:67] offset:24576
  ds_write_b128 v4, v[68:71] offset:25600
  ds_write_b128 v4, v[72:75] offset:26624
  ds_write_b128 v4, v[76:79] offset:27648
  s_waitcnt lgkmcnt(0)
  s_waitcnt vmcnt(5)
  ds_read_b64_tr_b16 v[64:65], v28 offset:28672
  ds_read_b64_tr_b16 v[66:67], v28 offset:28928
  ds_read_b64_tr_b16 v[68:69], v28 offset:29696
  ds_read_b64_tr_b16 v[70:71], v28 offset:29952
  ds_read_b64_tr_b16 v[72:73], v28 offset:28680
  ds_read_b64_tr_b16 v[74:75], v28 offset:28936
  ds_read_b64_tr_b16 v[76:77], v28 offset:29704
  ds_read_b64_tr_b16 v[78:79], v28 offset:29960
  s_waitcnt lgkmcnt(0)
  ds_write_b128 v4, v[64:67] offset:28672
  ds_write_b128 v4, v[68:71] offset:29696
  ds_write_b128 v4, v[72:75] offset:30720
  ds_write_b128 v4, v[76:79] offset:31744
  s_waitcnt lgkmcnt(0)
  s_mov_b32 s14, 1
  s_cmp_lt_i32 s14, s30
  s_cbranch_scc1 T_kv2_6
  s_mov_b32 s19, 0
  s_branch T_kvok_8
T_kv_7:
  s_sleep 4
  s_add_u32 s19, s19, 1
  s_cmp_gt_u32 s19, 32768
  s_cbranch_scc1 M_exit
T_kvok_8:
  s_add_u32 s39, s99, 128
  s_mov_b32 s38, 0
  s_mov_b32 s37, 0
  s_atomic_or s38, s[58:59], s99 glc
  s_atomic_or s37, s[58:59], s39 glc
  s_waitcnt lgkmcnt(0)
  s_add_u32 s37, s37, 30
  s_cmp_ge_u32 s38, 30
  s_cselect_b32 s38, s37, s38
  s_cmp_ge_u32 s38, 64
  s_cselect_b32 s38, 100, s38
  s_sub_u32 s38, s38, 1
  s_max_i32 s30, s30, s38
  s_cmp_ge_i32 s14, s30
  s_cbranch_scc1 T_kv_7
T_kv2_6:
  s_waitcnt vmcnt(0) lgkmcnt(0)
  s_barrier
  s_cmp_ge_u32 s13, 2
  s_cselect_b64 vcc, -1, 0
  v_cndmask_b32 v3, v8, v19, vcc
  ds_read_b128 v[68:71], v4 offset:0
  ds_read_b128 v[72:75], v4 offset:1024
  ds_read_b128 v[76:79], v4 offset:4096
  ds_read_b128 v[80:83], v4 offset:5120
  ds_read_b128 v[84:87], v4 offset:8192
  ds_read_b128 v[88:91], v4 offset:9216
  ds_read_b128 v[92:95], v4 offset:2048
  ds_read_b128 v[96:99], v4 offset:3072
  ds_read_b128 v[100:103], v4 offset:6144
  ds_read_b128 v[104:107], v4 offset:7168
  ds_read_b128 v[108:111], v4 offset:10240
  ds_read_b128 v[112:115], v4 offset:11264
  ds_read_b128 v[28:31], v59 offset:16384
  ds_read_b128 v[32:35], v59 offset:20480
  ds_read_b128 v[36:39], v2 offset:8192
  ds_read_b128 v[40:43], v2 offset:9216
  ds_read_b128 v[44:47], v2 offset:10240
  ds_read_b128 v[48:51], v2 offset:11264
  ds_read_b128 v[52:55], v2 offset:12288
  ds_read_b128 v[56:59], v2 offset:13312
  ds_read_b128 v[60:63], v2 offset:14336
  ds_read_b128 v[64:67], v2 offset:15360
  s_and_b32 s36, s13, 1
  s_lshl_b32 s36, s36, 12
  s_add_u32 s22, s22, s36
  s_add_u32 s23, s36, 145752064
  s_mov_b32 s14, -1
  s_and_b32 s57, s14, 1
  s_and_b32 s36, s14, 3
  s_lshl_b32 s36, s36, 13
  s_add_u32 s26, s36, s23
  s_add_u32 s36, s36, 8192
  s_and_b32 s36, s36, 0x7fff
  s_add_u32 s24, s36, 145752064
  s_add_u32 s25, s36, 145756160
  s_add_u32 s35, s36, s23
  s_waitcnt lgkmcnt(0)
  s_cmp_lg_u32 s56, 0
  s_cbranch_scc1 M_global
  s_cmp_eq_u32 s13, 1
  s_cbranch_scc1 T_w_10
  s_cmp_eq_u32 s13, 2
  s_cbranch_scc1 T_w_11
  s_cmp_eq_u32 s13, 3
  s_cbranch_scc1 T_w_12
T_w_9:
  s_mov_b32 s19, 0
  v_mov_b64 v[16:17], 0
  v_mov_b64 v[18:19], 0
  v_mov_b64 v[20:21], 0
  v_mov_b64 v[22:23], 0
  v_mov_b64 v[24:25], 0
  v_mov_b64 v[26:27], 0
  buffer_load_dwordx4 v[124:127], v2, s[4:7], s24 offen offset:0 sc1
  buffer_load_dwordx4 v[116:119], v2, s[4:7], s25 offen offset:0 sc1
  buffer_load_dwordx4 v[124:127], v2, s[4:7], s24 offen offset:0 sc1
  buffer_load_dwordx4 v[116:119], v2, s[4:7], s25 offen offset:0 sc1
  s_branch T_loop_13
.p2align 6
T_retry_14:
  s_mov_b64 exec, vcc
  buffer_load_dwordx4 v[124:127], v2, s[4:7], s24 offen offset:0 sc1
  buffer_load_dwordx4 v[116:119], v2, s[4:7], s25 offen offset:0 sc1
  s_mov_b64 exec, -1
  s_add_u32 s19, s19, 1
  s_cmp_gt_u32 s19, 32768
  s_cbranch_scc1 M_exit
T_loop_13:
  s_waitcnt vmcnt(3) lgkmcnt(0)
  v_max3_u32 v123, v124, v125, v126
  v_max_u32 v123, v123, v127
  v_mov_b32_dpp v120, v124 row_ror:8 row_mask:0xf bank_mask:0xf
  v_mov_b32_dpp v121, v125 row_ror:8 row_mask:0xf bank_mask:0xf
  s_waitcnt vmcnt(2)
  v_max3_u32 v123, v123, v116, v117
  v_max3_u32 v123, v123, v118, v119
  v_cmp_eq_u32 vcc, -1, v123
  s_cbranch_vccnz T_retry_14
  v_smfmac_f32_16x16x64_bf16 v[16:19], v[124:127], v[68:75], v0
  s_add_u32 s14, s14, 1
  ds_write_b128 v2, v[124:127] offset:0
  v_mov_b32_dpp v122, v126 row_ror:8 row_mask:0xf bank_mask:0xf
  v_smfmac_f32_16x16x64_bf16 v[20:23], v[124:127], v[76:83], v0
  s_and_b32 s57, s14, 1
  v_mov_b32_dpp v123, v127 row_ror:8 row_mask:0xf bank_mask:0xf
  v_smfmac_f32_16x16x64_bf16 v[24:27], v[124:127], v[84:91], v0
  s_and_b32 s36, s14, 3
  ds_write_b128 v2, v[116:119] offset:4096
  v_smfmac_f32_16x16x64_bf16 v[16:19], v[120:123], v[92:99], v0
  s_lshl_b32 s36, s36, 13
  v_mov_b32_dpp v84, v116 row_ror:8 row_mask:0xf bank_mask:0xf
  v_smfmac_f32_16x16x64_bf16 v[20:23], v[120:123], v[100:107], v0
  s_add_u32 s26, s36, s23
  ds_read_b128 v[68:71], v4 offset:12288
  v_mov_b32_dpp v85, v117 row_ror:8 row_mask:0xf bank_mask:0xf
  v_smfmac_f32_16x16x64_bf16 v[24:27], v[120:123], v[108:115], v0
  s_add_u32 s36, s36, 8192
  ds_read_b128 v[72:75], v4 offset:13312
  v_mov_b32_dpp v86, v118 row_ror:8 row_mask:0xf bank_mask:0xf
  v_smfmac_f32_16x16x64_bf16 v[16:19], v[116:119], v[224:231], v0
  s_and_b32 s36, s36, 0x7fff
  ds_read_b128 v[76:79], v4 offset:14336
  v_mov_b32_dpp v87, v119 row_ror:8 row_mask:0xf bank_mask:0xf
  v_smfmac_f32_16x16x64_bf16 v[20:23], v[116:119], v[240:247], v0
  s_waitcnt lgkmcnt(3)
  s_barrier
  ds_read_b128 v[100:103], v2 offset:1024
  v_smfmac_f32_16x16x64_bf16 v[24:27], v[116:119], a[0:7], v0
  s_mov_b32 m0, s31
  ds_read_b128 v[120:123], v1 offset:1024
  v_smfmac_f32_16x16x64_bf16 v[16:19], v[84:87], v[232:239], v0
  s_cmp_ge_i32 s14, s30
  s_cbranch_scc1 T_kvw_17
T_kvb_18:
  v_smfmac_f32_16x16x64_bf16 v[20:23], v[84:87], v[248:255], v0
  ds_read_b128 v[80:83], v4 offset:15360
  buffer_load_dwordx4 v9, s[4:7], s27 offen sc1 lds
  v_smfmac_f32_16x16x64_bf16 v[24:27], v[84:87], a[8:15], v0
  s_waitcnt lgkmcnt(2)
  s_mov_b32 m0, s32
  v_smfmac_f32_16x16x64_bf16 v[16:19], v[100:103], v[128:135], v0
  ds_read_b128 v[92:95], v2 offset:2048
  v_smfmac_f32_16x16x64_bf16 v[20:23], v[100:103], v[144:151], v0
  ds_read_b128 v[96:99], v1 offset:2048
  v_smfmac_f32_16x16x64_bf16 v[24:27], v[100:103], v[68:75], v0
  s_waitcnt vmcnt(1) lgkmcnt(3)
  ds_read_b128 v[116:119], v2 offset:3072
  buffer_load_dwordx4 v9, s[4:7], s27 offen offset:128 sc1 lds
  v_smfmac_f32_16x16x64_bf16 v[16:19], v[120:123], v[136:143], v0
  ds_read_b128 v[124:127], v1 offset:3072
  s_mov_b32 m0, s33
  v_smfmac_f32_16x16x64_bf16 v[20:23], v[120:123], v[152:159], v0
  s_waitcnt lgkmcnt(4)
  ds_read_b128 v[104:107], v2 offset:5120
  v_smfmac_f32_16x16x64_bf16 v[24:27], v[120:123], v[76:83], v0
  s_waitcnt lgkmcnt(4)
  ds_read_b128 v[108:111], v1 offset:5120
  v_smfmac_f32_16x16x64_bf16 v[16:19], v[92:95], v[160:167], v0
  s_waitcnt lgkmcnt(4)
  ds_read_b128 v[112:115], v2 offset:6144
  buffer_load_dwordx4 v10, s[4:7], s28 offen sc1 lds
  v_smfmac_f32_16x16x64_bf16 v[16:19], v[96:99], v[168:175], v0
  s_waitcnt lgkmcnt(4)
  ds_read_b128 v[84:87], v1 offset:6144
  s_mov_b32 m0, s34
  v_smfmac_f32_16x16x64_bf16 v[16:19], v[116:119], v[192:199], v0
  s_waitcnt lgkmcnt(4)
  ds_read_b128 v[88:91], v2 offset:7168
  v_smfmac_f32_16x16x64_bf16 v[16:19], v[124:127], v[200:207], v0
  s_waitcnt lgkmcnt(4)
  ds_read_b128 v[100:103], v1 offset:7168
  v_smfmac_f32_16x16x64_bf16 v[16:19], v[104:107], a[16:23], v0
  s_waitcnt lgkmcnt(4)
  ds_read_b128 v[68:71], v4 offset:16384
  buffer_load_dwordx4 v10, s[4:7], s28 offen offset:256 sc1 lds
  v_smfmac_f32_16x16x64_bf16 v[16:19], v[108:111], a[24:31], v0
  s_waitcnt lgkmcnt(4)
  ds_read_b128 v[72:75], v4 offset:17408
  v_smfmac_f32_16x16x64_bf16 v[16:19], v[112:115], a[64:71], v0
  s_waitcnt lgkmcnt(4)
  ds_read_b128 v[76:79], v4 offset:18432
  v_smfmac_f32_16x16x64_bf16 v[16:19], v[84:87], a[72:79], v0
  s_waitcnt lgkmcnt(4)
  ds_read_b128 v[80:83], v4 offset:19456
  v_smfmac_f32_16x16x64_bf16 v[16:19], v[88:91], a[112:119], v0
  s_waitcnt lgkmcnt(4)
  v_smfmac_f32_16x16x64_bf16 v[16:19], v[100:103], a[120:127], v0
  s_add_u32 s24, s36, 145752064
  s_add_u32 s25, s36, 145756160
  v_smfmac_f32_16x16x64_bf16 v[20:23], v[92:95], v[176:183], v0
  s_add_u32 s35, s36, s23
  v_smfmac_f32_16x16x64_bf16 v[20:23], v[96:99], v[184:191], v0
  s_waitcnt lgkmcnt(2)
  v_smfmac_f32_16x16x64_bf16 v[20:23], v[116:119], v[68:75], v0
  s_waitcnt lgkmcnt(0)
  ds_read_b128 v[68:71], v4 offset:20480
  v_mul_f32 v16, s18, v16
  v_smfmac_f32_16x16x64_bf16 v[20:23], v[124:127], v[76:83], v0
  ds_read_b128 v[72:75], v4 offset:21504
  v_mul_f32 v17, s18, v17
  v_smfmac_f32_16x16x64_bf16 v[20:23], v[104:107], a[32:39], v0
  ds_read_b128 v[76:79], v4 offset:22528
  v_mul_f32 v18, s18, v18
  v_smfmac_f32_16x16x64_bf16 v[20:23], v[108:111], a[40:47], v0
  ds_read_b128 v[80:83], v4 offset:23552
  v_mul_f32 v19, s18, v19
  v_smfmac_f32_16x16x64_bf16 v[20:23], v[112:115], a[80:87], v0
  v_cvt_pk_bf16_f32 v120, v16, v17
  v_smfmac_f32_16x16x64_bf16 v[20:23], v[84:87], a[88:95], v0
  v_cvt_pk_bf16_f32 v121, v18, v19
  v_smfmac_f32_16x16x64_bf16 v[20:23], v[88:91], a[128:135], v0
  ds_write_b64 v5, v[120:121] offset:24576
  v_smfmac_f32_16x16x64_bf16 v[20:23], v[100:103], a[136:143], v0
  s_waitcnt lgkmcnt(3)
  v_smfmac_f32_16x16x64_bf16 v[24:27], v[92:95], v[68:75], v0
  s_waitcnt lgkmcnt(1)
  v_mov_b64 v[92:93], 0
  v_smfmac_f32_16x16x64_bf16 v[24:27], v[96:99], v[76:83], v0
  s_nop 1
  v_cvt_pk_bf16_f32 v122, v20, v21
  v_cvt_pk_bf16_f32 v123, v22, v23
  v_smfmac_f32_16x16x64_bf16 v[24:27], v[116:119], v[208:215], v0
  ds_write_b64 v5, v[122:123] offset:26880
  v_mov_b64 v[94:95], 0
  v_smfmac_f32_16x16x64_bf16 v[24:27], v[124:127], v[216:223], v0
  s_waitcnt lgkmcnt(1)
  s_barrier
  ds_read_b64_tr_b16 v[68:69], v6 offset:24576
  v_smfmac_f32_16x16x64_bf16 v[24:27], v[104:107], a[48:55], v0
  s_add_u32 s27, s27, 8192
  ds_read_b64_tr_b16 v[70:71], v6 offset:24640
  ds_read_b64_tr_b16 v[72:73], v6 offset:24832
  v_smfmac_f32_16x16x64_bf16 v[24:27], v[108:111], a[56:63], v0
  s_add_u32 s28, s28, 8192
  ds_read_b64_tr_b16 v[74:75], v6 offset:24896
  ds_read_b64_tr_b16 v[76:77], v6 offset:25088
  v_smfmac_f32_16x16x64_bf16 v[24:27], v[112:115], a[96:103], v0
  s_nop 0
  ds_read_b64_tr_b16 v[78:79], v6 offset:25152
  ds_read_b64_tr_b16 v[80:81], v6 offset:25344
  v_smfmac_f32_16x16x64_bf16 v[24:27], v[84:87], a[104:111], v0
  ds_read_b64_tr_b16 v[82:83], v6 offset:25408
  v_mov_b64 v[96:97], 0
  v_smfmac_f32_16x16x64_bf16 v[24:27], v[88:91], a[144:151], v0
  s_waitcnt lgkmcnt(8)
  s_barrier
  ds_read_b64_tr_b16 v[116:117], v6 offset:26880
  v_smfmac_f32_16x16x64_bf16 v[24:27], v[100:103], a[152:159], v0
  s_waitcnt lgkmcnt(7)
  ds_read_b64_tr_b16 v[118:119], v6 offset:26944
  v_mfma_f32_16x16x32_bf16 v[16:19], v[36:39], v[68:71], 0
  s_waitcnt lgkmcnt(6)
  ds_read_b64_tr_b16 v[124:125], v6 offset:27136
  ds_read_b64_tr_b16 v[126:127], v6 offset:27200
  v_mfma_f32_16x16x32_bf16 v[16:19], v[40:43], v[72:75], v[16:19]
  s_waitcnt lgkmcnt(6)
  ds_read_b64_tr_b16 v[104:105], v6 offset:27392
  ds_read_b64_tr_b16 v[106:107], v6 offset:27456
  v_mfma_f32_16x16x32_bf16 v[16:19], v[44:47], v[76:79], v[16:19]
  s_waitcnt lgkmcnt(6)
  ds_read_b64_tr_b16 v[108:109], v6 offset:27648
  ds_read_b64_tr_b16 v[110:111], v6 offset:27712
  v_mfma_f32_16x16x32_bf16 v[16:19], v[48:51], v[80:83], v[16:19]
  s_waitcnt lgkmcnt(6)
  v_cvt_pk_bf16_f32 v120, v24, v25
  v_cvt_pk_bf16_f32 v121, v26, v27
  v_mfma_f32_16x16x32_bf16 v[112:115], v[116:119], v[68:71], 0
  s_waitcnt lgkmcnt(4)
  buffer_store_dwordx4 v[120:123], v2, s[4:7], s29 offen offset:0 sc1
  v_mov_b64 v[98:99], 0
  v_mfma_f32_16x16x32_bf16 v[112:115], v[124:127], v[72:75], v[112:115]
  s_waitcnt lgkmcnt(2)
  v_mov_b64 v[36:37], 0
  v_exp_f32 v100, v16
  v_mfma_f32_16x16x32_bf16 v[112:115], v[104:107], v[76:79], v[112:115]
  s_waitcnt lgkmcnt(0)
  v_exp_f32 v101, v17
  v_mfma_f32_16x16x32_bf16 v[112:115], v[108:111], v[80:83], v[112:115]
  v_exp_f32 v102, v18
  v_mfma_f32_16x16x32_bf16 v[20:23], v[52:55], v[68:71], 0
  s_cmp_eq_u32 s14, 63
  v_exp_f32 v103, v19
  v_mfma_f32_16x16x32_bf16 v[20:23], v[56:59], v[72:75], v[20:23]
  s_cbranch_scc1 M_tdone
  v_cvt_pk_bf16_f32 v44, v100, v101
  v_cvt_pk_bf16_f32 v45, v102, v103
  v_mfma_f32_16x16x32_bf16 v[20:23], v[60:63], v[76:79], v[20:23]
  s_add_u32 s29, s29, 131072
  v_exp_f32 v100, v112
  v_mfma_f32_16x16x32_bf16 v[20:23], v[64:67], v[80:83], v[20:23]
  v_exp_f32 v101, v113
  v_exp_f32 v102, v114
  v_exp_f32 v103, v115
  v_cvt_pk_bf16_f32 v84, v100, v101
  v_cvt_pk_bf16_f32 v85, v102, v103
  v_cndmask_b32 v48, v84, 0, s[16:17]
  v_cndmask_b32 v49, v85, 0, s[16:17]
  v_cndmask_b32 v50, 0, v84, s[16:17]
  v_cndmask_b32 v51, 0, v85, s[16:17]
  v_exp_f32 v100, v20
  v_mfma_f32_16x16x16_bf16 v[88:91], v[12:13], v[48:49], 0
  v_exp_f32 v101, v21
  v_mfma_f32_16x16x16_bf16 v[24:27], v[120:121], v[48:49], 0
  v_exp_f32 v102, v22
  v_mfma_f32_16x16x16_bf16 v[116:119], v[120:121], v[50:51], 0
  v_exp_f32 v103, v23
  v_cvt_pk_bf16_f32 v46, v100, v101
  v_cvt_pk_bf16_f32 v47, v102, v103
  v_mov_b64 v[38:39], 0
  s_nop 0
  v_mfma_f32_16x16x32_bf16 v[88:91], v[12:15], v[44:47], v[88:91]
  v_mov_b64 v[40:41], 0
  v_mov_b64 v[42:43], 0
  v_mfma_f32_16x16x32_bf16 v[24:27], v[28:31], v[44:47], v[24:27]
  ds_read_b128 v[52:55], v4 offset:24576
  ds_read_b128 v[56:59], v4 offset:25600
  v_mfma_f32_16x16x32_bf16 v[116:119], v[32:35], v[44:47], v[116:119]
  s_nop 1
  v_rcp_f32 v89, v88
  v_subrev_u32 v100, s54, v88
  v_cmp_le_u32 vcc, s55, v100
  v_mul_f32 v24, v89, v24
  v_mul_f32 v25, v89, v25
  s_cbranch_vccnz T_slow_20
T_back_21:
  v_cvt_pk_bf16_f32 v124, v24, v25
  v_pk_mul_f32 v[26:27], v[26:27], v[88:89] op_sel:[0,1] op_sel_hi:[1,1]
  v_pk_mul_f32 v[116:117], v[116:117], v[88:89] op_sel:[0,1] op_sel_hi:[1,1]
  v_pk_mul_f32 v[118:119], v[118:119], v[88:89] op_sel:[0,1] op_sel_hi:[1,1]
  v_cvt_pk_bf16_f32 v125, v26, v27
  v_cvt_pk_bf16_f32 v126, v116, v117
  v_cvt_pk_bf16_f32 v127, v118, v119
  ds_write_b128 v11, v[124:127] offset:29184
  s_nop 0
  v_smfmac_f32_16x16x64_bf16 v[92:95], v[124:127], a[160:167], v0
  v_smfmac_f32_16x16x64_bf16 v[96:99], v[124:127], a[168:175], v0
  v_smfmac_f32_16x16x64_bf16 v[36:39], v[124:127], a[176:183], v0
  v_smfmac_f32_16x16x64_bf16 v[40:43], v[124:127], a[184:191], v0
  s_waitcnt lgkmcnt(0)
  s_barrier
  ds_read_b128 v[104:107], v11 offset:29696
  ds_read_b128 v[108:111], v11 offset:30208
  ds_read_b128 v[68:71], v11 offset:30720
  s_waitcnt lgkmcnt(2)
  v_smfmac_f32_16x16x64_bf16 v[92:95], v[104:107], a[192:199], v0
  s_waitcnt lgkmcnt(1)
  ds_read_b128 v[76:79], v4 offset:28672
  v_smfmac_f32_16x16x64_bf16 v[92:95], v[108:111], a[224:231], v0
  s_waitcnt lgkmcnt(1)
  ds_read_b128 v[80:83], v4 offset:29696
  v_smfmac_f32_16x16x64_bf16 v[92:95], v[68:71], a[240:247], v0
  ds_read_b128 v[60:63], v4 offset:26624
  v_smfmac_f32_16x16x64_bf16 v[96:99], v[104:107], a[200:207], v0
  ds_read_b128 v[64:67], v4 offset:27648
  v_smfmac_f32_16x16x64_bf16 v[96:99], v[108:111], a[232:239], v0
  ds_read_b128 v[28:31], v4 offset:30720
  s_nop 0
  v_cvt_pk_bf16_f32 v16, v92, v93
  v_cvt_pk_bf16_f32 v17, v94, v95
  v_bfi_b32 v16, 1, s57, v16
  v_smfmac_f32_16x16x64_bf16 v[96:99], v[68:71], a[248:255], v0
  buffer_store_dwordx2 v[16:17], v7, s[4:7], s20 offen offset:0
  v_smfmac_f32_16x16x64_bf16 v[36:39], v[104:107], a[208:215], v0
  ds_read_b128 v[32:35], v4 offset:31744
  v_smfmac_f32_16x16x64_bf16 v[36:39], v[108:111], v[52:59], v0
  s_waitcnt lgkmcnt(4)
  s_nop 0
  v_cvt_pk_bf16_f32 v18, v96, v97
  v_cvt_pk_bf16_f32 v19, v98, v99
  v_bfi_b32 v18, 1, s57, v18
  v_smfmac_f32_16x16x64_bf16 v[36:39], v[68:71], v[76:83], v0
  buffer_store_dwordx2 v[18:19], v7, s[4:7], s20 offen offset:64
  v_smfmac_f32_16x16x64_bf16 v[40:43], v[104:107], a[216:223], v0
  s_waitcnt lgkmcnt(2)
  ds_read_b128 v[116:119], v2 offset:31232
  v_smfmac_f32_16x16x64_bf16 v[40:43], v[108:111], v[60:67], v0
  s_waitcnt lgkmcnt(1)
  s_nop 0
  v_cvt_pk_bf16_f32 v20, v36, v37
  v_cvt_pk_bf16_f32 v21, v38, v39
  v_bfi_b32 v20, 1, s57, v20
  v_smfmac_f32_16x16x64_bf16 v[40:43], v[68:71], v[28:35], v0
  buffer_store_dwordx2 v[20:21], v7, s[4:7], s21 offen offset:0
  s_nop 6
  v_cvt_pk_bf16_f32 v22, v40, v41
  v_cvt_pk_bf16_f32 v23, v42, v43
  v_bfi_b32 v22, 1, s57, v22
  buffer_store_dwordx2 v[22:23], v7, s[4:7], s21 offen offset:64
  ds_read_b128 v[68:71], v4 offset:0
  ds_read_b128 v[72:75], v4 offset:1024
  ds_read_b128 v[76:79], v4 offset:4096
  ds_read_b128 v[80:83], v4 offset:5120
  ds_read_b128 v[84:87], v4 offset:8192
  ds_read_b128 v[88:91], v4 offset:9216
  v_mov_b64 v[16:17], 0
  v_mov_b64 v[18:19], 0
  v_mov_b64 v[20:21], 0
  v_mov_b64 v[22:23], 0
  v_mov_b64 v[24:25], 0
  v_mov_b64 v[26:27], 0
  s_mov_b32 s19, 0
  v_mov_b32 v49, -1
  s_waitcnt vmcnt(2)
  buffer_load_dwordx4 v[52:55], v2, s[4:7], s22 offen offset:0 sc1
  buffer_load_dwordx4 v[56:59], v2, s[4:7], s22 offen offset:1024 sc1
  buffer_load_dwordx4 v[60:63], v2, s[4:7], s22 offen offset:2048 sc1
  buffer_load_dwordx4 v[64:67], v2, s[4:7], s22 offen offset:3072 sc1
  ds_read_b128 v[92:95], v4 offset:2048
  ds_read_b128 v[96:99], v4 offset:3072
  ds_read_b128 v[100:103], v4 offset:6144
  ds_read_b128 v[104:107], v4 offset:7168
  ds_read_b128 v[108:111], v4 offset:10240
  ds_read_b128 v[112:115], v4 offset:11264
  ds_read_b64 v[44:45], v2 offset:32256
  s_waitcnt lgkmcnt(0)
  v_readfirstlane_b32 s38, v44
  v_readfirstlane_b32 s37, v45
  s_nop 0
  s_add_u32 s37, s37, 30
  s_cmp_ge_u32 s38, 30
  s_cselect_b32 s38, s37, s38
  s_cmp_ge_u32 s38, 64
  s_cselect_b32 s38, 100, s38
  s_sub_u32 s38, s38, 1
  s_max_i32 s30, s30, s38
  s_waitcnt lgkmcnt(12)
  s_waitcnt vmcnt(3)
  v_mfma_f32_16x16x32_bf16 v[120:123], v[116:119], v[52:55], 0
  v_xor_b32 v48, s57, v52
  v_bitop3_b32 v48, v48, v54, s57 bitop3:0xf6
  s_waitcnt vmcnt(2)
  v_mfma_f32_16x16x32_bf16 v[120:123], v[116:119], v[56:59], v[120:123]
  v_bitop3_b32 v48, v48, v56, s57 bitop3:0xf6
  v_bitop3_b32 v48, v48, v58, s57 bitop3:0xf6
  s_waitcnt vmcnt(1)
  v_mfma_f32_16x16x32_bf16 v[120:123], v[116:119], v[60:63], v[120:123]
  v_bitop3_b32 v48, v48, v60, s57 bitop3:0xf6
  v_bitop3_b32 v48, v48, v62, s57 bitop3:0xf6
  s_waitcnt vmcnt(0)
  v_mfma_f32_16x16x32_bf16 v[120:123], v[116:119], v[64:67], v[120:123]
  v_bitop3_b32 v48, v48, v64, s57 bitop3:0xf6
  v_bitop3_b32 v48, v48, v66, s57 bitop3:0xf6
  v_and_b32 v48, 1, v48
  v_cmp_ne_u32 vcc, 0, v48
  s_cbranch_vccnz T_p1re_23
T_p1ok_24:
  s_nop 2
  v_add_f32_dpp v120, v120, v120 row_ror:8 row_mask:0xf bank_mask:0xf
  v_add_f32_dpp v121, v121, v121 row_ror:8 row_mask:0xf bank_mask:0xf
  v_cvt_pk_bf16_f32 v48, v120, v121
  buffer_store_dword v48, v8, s[4:7], s35 offen
  buffer_store_dword v49, v8, s[4:7], s26 offen
  s_barrier
  ds_read_b128 v[28:31], v2 offset:16384
  ds_read_b128 v[32:35], v2 offset:20480
  ds_read_b128 v[36:39], v2 offset:8192
  ds_read_b128 v[40:43], v2 offset:9216
  ds_read_b128 v[44:47], v2 offset:10240
  ds_read_b128 v[48:51], v2 offset:11264
  buffer_load_dwordx4 v[124:127], v2, s[4:7], s24 offen offset:0 sc1
  buffer_load_dwordx4 v[116:119], v2, s[4:7], s25 offen offset:0 sc1
  ds_read_b128 v[52:55], v2 offset:12288
  ds_read_b128 v[56:59], v2 offset:13312
  ds_read_b128 v[60:63], v2 offset:14336
  ds_read_b128 v[64:67], v2 offset:15360
  buffer_load_dwordx4 v[124:127], v2, s[4:7], s24 offen offset:0 sc1
  buffer_load_dwordx4 v[116:119], v2, s[4:7], s25 offen offset:0 sc1
  s_mov_b32 s19, 0
  s_branch T_loop_13
T_p1re_23:
  s_mov_b64 exec, vcc
  buffer_load_dwordx4 v[52:55], v2, s[4:7], s22 offen offset:0 sc1
  buffer_load_dwordx4 v[56:59], v2, s[4:7], s22 offen offset:1024 sc1
  buffer_load_dwordx4 v[60:63], v2, s[4:7], s22 offen offset:2048 sc1
  buffer_load_dwordx4 v[64:67], v2, s[4:7], s22 offen offset:3072 sc1
  s_mov_b64 exec, -1
  s_add_u32 s19, s19, 1
  s_cmp_gt_u32 s19, 32768
  s_cbranch_scc1 M_exit
  s_waitcnt vmcnt(3)
  v_mfma_f32_16x16x32_bf16 v[120:123], v[116:119], v[52:55], 0
  v_xor_b32 v48, s57, v52
  v_bitop3_b32 v48, v48, v54, s57 bitop3:0xf6
  s_waitcnt vmcnt(2)
  v_mfma_f32_16x16x32_bf16 v[120:123], v[116:119], v[56:59], v[120:123]
  v_bitop3_b32 v48, v48, v56, s57 bitop3:0xf6
  v_bitop3_b32 v48, v48, v58, s57 bitop3:0xf6
  s_waitcnt vmcnt(1)
  v_mfma_f32_16x16x32_bf16 v[120:123], v[116:119], v[60:63], v[120:123]
  v_bitop3_b32 v48, v48, v60, s57 bitop3:0xf6
  v_bitop3_b32 v48, v48, v62, s57 bitop3:0xf6
  s_waitcnt vmcnt(0)
  v_mfma_f32_16x16x32_bf16 v[120:123], v[116:119], v[64:67], v[120:123]
  v_bitop3_b32 v48, v48, v64, s57 bitop3:0xf6
  v_bitop3_b32 v48, v48, v66, s57 bitop3:0xf6
  v_and_b32 v48, 1, v48
  v_cmp_ne_u32 vcc, 0, v48
  s_cbranch_vccnz T_p1re_23
  s_branch T_p1ok_24
T_kvw_17:
  s_mov_b32 s19, 0
  s_branch T_kvok_26
T_kv_25:
  s_sleep 4
  s_add_u32 s19, s19, 1
  s_cmp_gt_u32 s19, 32768
  s_cbranch_scc1 M_exit
T_kvok_26:
  s_add_u32 s39, s99, 128
  s_mov_b32 s38, 0
  s_mov_b32 s37, 0
  s_atomic_or s38, s[58:59], s99 glc
  s_atomic_or s37, s[58:59], s39 glc
  s_waitcnt lgkmcnt(0)
  s_add_u32 s37, s37, 30
  s_cmp_ge_u32 s38, 30
  s_cselect_b32 s38, s37, s38
  s_cmp_ge_u32 s38, 64
  s_cselect_b32 s38, 100, s38
  s_sub_u32 s38, s38, 1
  s_max_i32 s30, s30, s38
  s_cmp_ge_i32 s14, s30
  s_cbranch_scc1 T_kv_25
  s_branch T_kvb_18
T_slow_20:
  s_nop 7
  v_max3_f32 v100, v16, v17, v18
  v_max3_f32 v100, v100, v19, v20
  v_max3_f32 v100, v100, v21, v22
  v_max3_f32 v100, v100, v23, v112
  v_max3_f32 v100, v100, v113, v114
  v_max_f32 v100, v100, v115
  v_mov_b32 v101, v100
  s_nop 1
  v_permlane32_swap_b32 v100, v101
  s_nop 1
  v_max_f32 v100, v100, v101
  v_mov_b32 v101, v100
  s_nop 1
  v_permlane16_swap_b32 v100, v101
  s_nop 1
  v_max_f32 v100, v100, v101
  v_sub_f32 v16, v16, v100
  v_sub_f32 v17, v17, v100
  v_sub_f32 v18, v18, v100
  v_sub_f32 v19, v19, v100
  v_exp_f32 v16, v16
  v_exp_f32 v17, v17
  v_exp_f32 v18, v18
  v_exp_f32 v19, v19
  v_sub_f32 v20, v20, v100
  v_sub_f32 v21, v21, v100
  v_sub_f32 v22, v22, v100
  v_sub_f32 v23, v23, v100
  v_exp_f32 v20, v20
  v_exp_f32 v21, v21
  v_exp_f32 v22, v22
  v_exp_f32 v23, v23
  v_sub_f32 v112, v112, v100
  v_sub_f32 v113, v113, v100
  v_sub_f32 v114, v114, v100
  v_sub_f32 v115, v115, v100
  v_exp_f32 v112, v112
  v_exp_f32 v113, v113
  v_exp_f32 v114, v114
  v_exp_f32 v115, v115
  s_nop 0
  v_cvt_pk_bf16_f32 v44, v16, v17
  v_cvt_pk_bf16_f32 v45, v18, v19
  v_cvt_pk_bf16_f32 v46, v20, v21
  v_cvt_pk_bf16_f32 v47, v22, v23
  v_cvt_pk_bf16_f32 v84, v112, v113
  v_cvt_pk_bf16_f32 v85, v114, v115
  v_cndmask_b32 v48, v84, 0, s[16:17]
  v_cndmask_b32 v49, v85, 0, s[16:17]
  v_cndmask_b32 v50, 0, v84, s[16:17]
  v_cndmask_b32 v51, 0, v85, s[16:17]
  s_nop 1
  v_mfma_f32_16x16x16_bf16 v[88:91], v[12:13], v[48:49], 0
  v_mfma_f32_16x16x16_bf16 v[24:27], v[120:121], v[48:49], 0
  v_mfma_f32_16x16x16_bf16 v[116:119], v[120:121], v[50:51], 0
  v_mfma_f32_16x16x32_bf16 v[88:91], v[12:15], v[44:47], v[88:91]
  v_mfma_f32_16x16x32_bf16 v[24:27], v[28:31], v[44:47], v[24:27]
  v_mfma_f32_16x16x32_bf16 v[116:119], v[32:35], v[44:47], v[116:119]
  s_nop 7
  s_nop 1
  v_rcp_f32 v89, v88
  s_nop 0
  v_mul_f32 v24, v89, v24
  v_mul_f32 v25, v89, v25
  s_branch T_back_21
T_w_10:
  s_mov_b32 s19, 0
  v_mov_b64 v[16:17], 0
  v_mov_b64 v[18:19], 0
  v_mov_b64 v[20:21], 0
  v_mov_b64 v[22:23], 0
  v_mov_b64 v[24:25], 0
  v_mov_b64 v[26:27], 0
  buffer_load_dwordx4 v[124:127], v2, s[4:7], s24 offen offset:1024 sc1
  buffer_load_dwordx4 v[116:119], v2, s[4:7], s25 offen offset:1024 sc1
  buffer_load_dwordx4 v[124:127], v2, s[4:7], s24 offen offset:1024 sc1
  buffer_load_dwordx4 v[116:119], v2, s[4:7], s25 offen offset:1024 sc1
  s_branch T_loop_27
.p2align 6
T_retry_28:
  s_mov_b64 exec, vcc
  buffer_load_dwordx4 v[124:127], v2, s[4:7], s24 offen offset:1024 sc1
  buffer_load_dwordx4 v[116:119], v2, s[4:7], s25 offen offset:1024 sc1
  s_mov_b64 exec, -1
  s_add_u32 s19, s19, 1
  s_cmp_gt_u32 s19, 32768
  s_cbranch_scc1 M_exit
T_loop_27:
  s_waitcnt vmcnt(3) lgkmcnt(0)
  v_max3_u32 v123, v124, v125, v126
  v_max_u32 v123, v123, v127
  v_mov_b32_dpp v120, v124 row_ror:8 row_mask:0xf bank_mask:0xf
  v_mov_b32_dpp v121, v125 row_ror:8 row_mask:0xf bank_mask:0xf
  s_waitcnt vmcnt(2)
  v_max3_u32 v123, v123, v116, v117
  v_max3_u32 v123, v123, v118, v119
  v_cmp_eq_u32 vcc, -1, v123
  s_cbranch_vccnz T_retry_28
  v_smfmac_f32_16x16x64_bf16 v[16:19], v[124:127], v[68:75], v0
  s_add_u32 s14, s14, 1
  ds_write_b128 v2, v[124:127] offset:1024
  v_mov_b32_dpp v122, v126 row_ror:8 row_mask:0xf bank_mask:0xf
  v_smfmac_f32_16x16x64_bf16 v[20:23], v[124:127], v[76:83], v0
  s_and_b32 s57, s14, 1
  v_mov_b32_dpp v123, v127 row_ror:8 row_mask:0xf bank_mask:0xf
  v_smfmac_f32_16x16x64_bf16 v[24:27], v[124:127], v[84:91], v0
  s_and_b32 s36, s14, 3
  ds_write_b128 v2, v[116:119] offset:5120
  v_smfmac_f32_16x16x64_bf16 v[16:19], v[120:123], v[92:99], v0
  s_lshl_b32 s36, s36, 13
  v_mov_b32_dpp v84, v116 row_ror:8 row_mask:0xf bank_mask:0xf
  v_smfmac_f32_16x16x64_bf16 v[20:23], v[120:123], v[100:107], v0
  s_add_u32 s26, s36, s23
  ds_read_b128 v[68:71], v4 offset:12288
  v_mov_b32_dpp v85, v117 row_ror:8 row_mask:0xf bank_mask:0xf
  v_smfmac_f32_16x16x64_bf16 v[24:27], v[120:123], v[108:115], v0
  s_add_u32 s36, s36, 8192
  ds_read_b128 v[72:75], v4 offset:13312
  v_mov_b32_dpp v86, v118 row_ror:8 row_mask:0xf bank_mask:0xf
  v_smfmac_f32_16x16x64_bf16 v[16:19], v[116:119], v[224:231], v0
  s_and_b32 s36, s36, 0x7fff
  ds_read_b128 v[76:79], v4 offset:14336
  v_mov_b32_dpp v87, v119 row_ror:8 row_mask:0xf bank_mask:0xf
  v_smfmac_f32_16x16x64_bf16 v[20:23], v[116:119], v[240:247], v0
  s_waitcnt lgkmcnt(3)
  s_barrier
  ds_read_b128 v[100:103], v2 offset:0
  v_smfmac_f32_16x16x64_bf16 v[24:27], v[116:119], a[0:7], v0
  s_mov_b32 m0, s31
  ds_read_b128 v[120:123], v1 offset:0
  v_smfmac_f32_16x16x64_bf16 v[16:19], v[84:87], v[232:239], v0
  s_cmp_ge_i32 s14, s30
  s_cbranch_scc1 T_kvw_31
T_kvb_32:
  v_smfmac_f32_16x16x64_bf16 v[20:23], v[84:87], v[248:255], v0
  ds_read_b128 v[80:83], v4 offset:15360
  v_smfmac_f32_16x16x64_bf16 v[24:27], v[84:87], a[8:15], v0
  s_waitcnt lgkmcnt(2)
  buffer_load_dwordx4 v9, s[4:7], s27 offen sc1 lds
  v_smfmac_f32_16x16x64_bf16 v[16:19], v[100:103], v[128:135], v0
  ds_read_b128 v[92:95], v2 offset:3072
  s_mov_b32 m0, s32
  v_smfmac_f32_16x16x64_bf16 v[20:23], v[100:103], v[144:151], v0
  ds_read_b128 v[96:99], v1 offset:3072
  v_smfmac_f32_16x16x64_bf16 v[24:27], v[100:103], v[68:75], v0
  s_waitcnt vmcnt(1) lgkmcnt(3)
  ds_read_b128 v[116:119], v2 offset:2048
  v_smfmac_f32_16x16x64_bf16 v[16:19], v[120:123], v[136:143], v0
  ds_read_b128 v[124:127], v1 offset:2048
  buffer_load_dwordx4 v9, s[4:7], s27 offen offset:128 sc1 lds
  v_smfmac_f32_16x16x64_bf16 v[20:23], v[120:123], v[152:159], v0
  s_waitcnt lgkmcnt(4)
  ds_read_b128 v[104:107], v2 offset:4096
  s_mov_b32 m0, s33
  v_smfmac_f32_16x16x64_bf16 v[24:27], v[120:123], v[76:83], v0
  s_waitcnt lgkmcnt(4)
  ds_read_b128 v[108:111], v1 offset:4096
  v_smfmac_f32_16x16x64_bf16 v[16:19], v[92:95], v[160:167], v0
  s_waitcnt lgkmcnt(4)
  ds_read_b128 v[112:115], v2 offset:7168
  v_smfmac_f32_16x16x64_bf16 v[16:19], v[96:99], v[168:175], v0
  s_waitcnt lgkmcnt(4)
  ds_read_b128 v[84:87], v1 offset:7168
  buffer_load_dwordx4 v10, s[4:7], s28 offen sc1 lds
  v_smfmac_f32_16x16x64_bf16 v[16:19], v[116:119], v[192:199], v0
  s_waitcnt lgkmcnt(4)
  ds_read_b128 v[88:91], v2 offset:6144
  s_mov_b32 m0, s34
  v_smfmac_f32_16x16x64_bf16 v[16:19], v[124:127], v[200:207], v0
  s_waitcnt lgkmcnt(4)
  ds_read_b128 v[100:103], v1 offset:6144
  v_smfmac_f32_16x16x64_bf16 v[16:19], v[104:107], a[16:23], v0
  s_waitcnt lgkmcnt(4)
  ds_read_b128 v[68:71], v4 offset:16384
  v_smfmac_f32_16x16x64_bf16 v[16:19], v[108:111], a[24:31], v0
  s_waitcnt lgkmcnt(4)
  ds_read_b128 v[72:75], v4 offset:17408
  buffer_load_dwordx4 v10, s[4:7], s28 offen offset:256 sc1 lds
  v_smfmac_f32_16x16x64_bf16 v[16:19], v[112:115], a[64:71], v0
  s_waitcnt lgkmcnt(4)
  ds_read_b128 v[76:79], v4 offset:18432
  v_smfmac_f32_16x16x64_bf16 v[16:19], v[84:87], a[72:79], v0
  s_waitcnt lgkmcnt(4)
  ds_read_b128 v[80:83], v4 offset:19456
  v_smfmac_f32_16x16x64_bf16 v[16:19], v[88:91], a[112:119], v0
  s_waitcnt lgkmcnt(4)
  v_smfmac_f32_16x16x64_bf16 v[16:19], v[100:103], a[120:127], v0
  s_add_u32 s24, s36, 145752064
  s_add_u32 s25, s36, 145756160
  v_smfmac_f32_16x16x64_bf16 v[20:23], v[92:95], v[176:183], v0
  s_add_u32 s35, s36, s23
  v_smfmac_f32_16x16x64_bf16 v[20:23], v[96:99], v[184:191], v0
  s_waitcnt lgkmcnt(2)
  v_smfmac_f32_16x16x64_bf16 v[20:23], v[116:119], v[68:75], v0
  s_waitcnt lgkmcnt(0)
  ds_read_b128 v[68:71], v4 offset:20480
  v_mul_f32 v16, s18, v16
  v_smfmac_f32_16x16x64_bf16 v[20:23], v[124:127], v[76:83], v0
  ds_read_b128 v[72:75], v4 offset:21504
  v_mul_f32 v17, s18, v17
  v_smfmac_f32_16x16x64_bf16 v[20:23], v[104:107], a[32:39], v0
  ds_read_b128 v[76:79], v4 offset:22528
  v_mul_f32 v18, s18, v18
  v_smfmac_f32_16x16x64_bf16 v[20:23], v[108:111], a[40:47], v0
  ds_read_b128 v[80:83], v4 offset:23552
  v_mul_f32 v19, s18, v19
  v_smfmac_f32_16x16x64_bf16 v[20:23], v[112:115], a[80:87], v0
  v_cvt_pk_bf16_f32 v120, v16, v17
  v_smfmac_f32_16x16x64_bf16 v[20:23], v[84:87], a[88:95], v0
  v_cvt_pk_bf16_f32 v121, v18, v19
  v_smfmac_f32_16x16x64_bf16 v[20:23], v[88:91], a[128:135], v0
  ds_write_b64 v5, v[120:121] offset:24576
  v_smfmac_f32_16x16x64_bf16 v[20:23], v[100:103], a[136:143], v0
  s_waitcnt lgkmcnt(3)
  v_smfmac_f32_16x16x64_bf16 v[24:27], v[92:95], v[68:75], v0
  s_waitcnt lgkmcnt(1)
  v_mov_b64 v[92:93], 0
  v_smfmac_f32_16x16x64_bf16 v[24:27], v[96:99], v[76:83], v0
  s_nop 1
  v_cvt_pk_bf16_f32 v122, v20, v21
  v_cvt_pk_bf16_f32 v123, v22, v23
  v_smfmac_f32_16x16x64_bf16 v[24:27], v[116:119], v[208:215], v0
  ds_write_b64 v5, v[122:123] offset:26880
  v_mov_b64 v[94:95], 0
  v_smfmac_f32_16x16x64_bf16 v[24:27], v[124:127], v[216:223], v0
  s_waitcnt lgkmcnt(1)
  s_barrier
  ds_read_b64_tr_b16 v[68:69], v6 offset:24576
  v_smfmac_f32_16x16x64_bf16 v[24:27], v[104:107], a[48:55], v0
  s_add_u32 s27, s27, 8192
  ds_read_b64_tr_b16 v[70:71], v6 offset:24640
  ds_read_b64_tr_b16 v[72:73], v6 offset:24832
  v_smfmac_f32_16x16x64_bf16 v[24:27], v[108:111], a[56:63], v0
  s_add_u32 s28, s28, 8192
  ds_read_b64_tr_b16 v[74:75], v6 offset:24896
  ds_read_b64_tr_b16 v[76:77], v6 offset:25088
  v_smfmac_f32_16x16x64_bf16 v[24:27], v[112:115], a[96:103], v0
  s_nop 0
  ds_read_b64_tr_b16 v[78:79], v6 offset:25152
  ds_read_b64_tr_b16 v[80:81], v6 offset:25344
  v_smfmac_f32_16x16x64_bf16 v[24:27], v[84:87], a[104:111], v0
  ds_read_b64_tr_b16 v[82:83], v6 offset:25408
  v_mov_b64 v[96:97], 0
  v_smfmac_f32_16x16x64_bf16 v[24:27], v[88:91], a[144:151], v0
  s_waitcnt lgkmcnt(8)
  s_barrier
  ds_read_b64_tr_b16 v[116:117], v6 offset:26880
  v_smfmac_f32_16x16x64_bf16 v[24:27], v[100:103], a[152:159], v0
  s_waitcnt lgkmcnt(7)
  ds_read_b64_tr_b16 v[118:119], v6 offset:26944
  v_mfma_f32_16x16x32_bf16 v[16:19], v[36:39], v[68:71], 0
  s_waitcnt lgkmcnt(6)
  ds_read_b64_tr_b16 v[124:125], v6 offset:27136
  ds_read_b64_tr_b16 v[126:127], v6 offset:27200
  v_mfma_f32_16x16x32_bf16 v[16:19], v[40:43], v[72:75], v[16:19]
  s_waitcnt lgkmcnt(6)
  ds_read_b64_tr_b16 v[104:105], v6 offset:27392
  ds_read_b64_tr_b16 v[106:107], v6 offset:27456
  v_mfma_f32_16x16x32_bf16 v[16:19], v[44:47], v[76:79], v[16:19]
  s_waitcnt lgkmcnt(6)
  ds_read_b64_tr_b16 v[108:109], v6 offset:27648
  ds_read_b64_tr_b16 v[110:111], v6 offset:27712
  v_mfma_f32_16x16x32_bf16 v[16:19], v[48:51], v[80:83], v[16:19]
  s_waitcnt lgkmcnt(6)
  v_cvt_pk_bf16_f32 v120, v24, v25
  v_cvt_pk_bf16_f32 v121, v26, v27
  v_mfma_f32_16x16x32_bf16 v[112:115], v[116:119], v[68:71], 0
  s_waitcnt lgkmcnt(4)
  v_mov_b64 v[98:99], 0
  v_mfma_f32_16x16x32_bf16 v[112:115], v[124:127], v[72:75], v[112:115]
  s_waitcnt lgkmcnt(2)
  buffer_store_dwordx4 v[120:123], v2, s[4:7], s29 offen offset:1024 sc1
  v_mov_b64 v[36:37], 0
  v_exp_f32 v100, v16
  v_mfma_f32_16x16x32_bf16 v[112:115], v[104:107], v[76:79], v[112:115]
  s_waitcnt lgkmcnt(0)
  v_exp_f32 v101, v17
  v_mfma_f32_16x16x32_bf16 v[112:115], v[108:111], v[80:83], v[112:115]
  v_exp_f32 v102, v18
  v_mfma_f32_16x16x32_bf16 v[20:23], v[52:55], v[68:71], 0
  s_cmp_eq_u32 s14, 63
  v_exp_f32 v103, v19
  v_mfma_f32_16x16x32_bf16 v[20:23], v[56:59], v[72:75], v[20:23]
  s_cbranch_scc1 M_tdone
  v_cvt_pk_bf16_f32 v44, v100, v101
  v_cvt_pk_bf16_f32 v45, v102, v103
  v_mfma_f32_16x16x32_bf16 v[20:23], v[60:63], v[76:79], v[20:23]
  s_add_u32 s29, s29, 131072
  v_exp_f32 v100, v112
  v_mfma_f32_16x16x32_bf16 v[20:23], v[64:67], v[80:83], v[20:23]
  v_exp_f32 v101, v113
  v_exp_f32 v102, v114
  v_exp_f32 v103, v115
  v_cvt_pk_bf16_f32 v84, v100, v101
  v_cvt_pk_bf16_f32 v85, v102, v103
  v_cndmask_b32 v48, v84, 0, s[16:17]
  v_cndmask_b32 v49, v85, 0, s[16:17]
  v_cndmask_b32 v50, 0, v84, s[16:17]
  v_cndmask_b32 v51, 0, v85, s[16:17]
  v_exp_f32 v100, v20
  v_mfma_f32_16x16x16_bf16 v[88:91], v[12:13], v[48:49], 0
  v_exp_f32 v101, v21
  v_mfma_f32_16x16x16_bf16 v[24:27], v[120:121], v[48:49], 0
  v_exp_f32 v102, v22
  v_mfma_f32_16x16x16_bf16 v[116:119], v[120:121], v[50:51], 0
  v_exp_f32 v103, v23
  v_cvt_pk_bf16_f32 v46, v100, v101
  v_cvt_pk_bf16_f32 v47, v102, v103
  v_mov_b64 v[38:39], 0
  s_nop 0
  v_mfma_f32_16x16x32_bf16 v[88:91], v[12:15], v[44:47], v[88:91]
  v_mov_b64 v[40:41], 0
  v_mov_b64 v[42:43], 0
  v_mfma_f32_16x16x32_bf16 v[24:27], v[28:31], v[44:47], v[24:27]
  ds_read_b128 v[52:55], v4 offset:24576
  ds_read_b128 v[56:59], v4 offset:25600
  v_mfma_f32_16x16x32_bf16 v[116:119], v[32:35], v[44:47], v[116:119]
  s_nop 1
  v_rcp_f32 v89, v88
  v_subrev_u32 v100, s54, v88
  v_cmp_le_u32 vcc, s55, v100
  v_mul_f32 v24, v89, v24
  v_mul_f32 v25, v89, v25
  s_cbranch_vccnz T_slow_34
T_back_35:
  v_cvt_pk_bf16_f32 v124, v24, v25
  v_pk_mul_f32 v[26:27], v[26:27], v[88:89] op_sel:[0,1] op_sel_hi:[1,1]
  v_pk_mul_f32 v[116:117], v[116:117], v[88:89] op_sel:[0,1] op_sel_hi:[1,1]
  v_pk_mul_f32 v[118:119], v[118:119], v[88:89] op_sel:[0,1] op_sel_hi:[1,1]
  v_cvt_pk_bf16_f32 v125, v26, v27
  v_cvt_pk_bf16_f32 v126, v116, v117
  v_cvt_pk_bf16_f32 v127, v118, v119
  ds_write_b128 v11, v[124:127] offset:29696
  s_nop 0
  v_smfmac_f32_16x16x64_bf16 v[92:95], v[124:127], a[160:167], v0
  v_smfmac_f32_16x16x64_bf16 v[96:99], v[124:127], a[168:175], v0
  v_smfmac_f32_16x16x64_bf16 v[36:39], v[124:127], a[176:183], v0
  v_smfmac_f32_16x16x64_bf16 v[40:43], v[124:127], a[184:191], v0
  s_waitcnt lgkmcnt(0)
  s_barrier
  ds_read_b128 v[104:107], v11 offset:29184
  ds_read_b128 v[108:111], v11 offset:30720
  ds_read_b128 v[68:71], v11 offset:30208
  s_waitcnt lgkmcnt(2)
  v_smfmac_f32_16x16x64_bf16 v[92:95], v[104:107], a[192:199], v0
  s_waitcnt lgkmcnt(1)
  ds_read_b128 v[76:79], v4 offset:28672
  v_smfmac_f32_16x16x64_bf16 v[92:95], v[108:111], a[224:231], v0
  s_waitcnt lgkmcnt(1)
  ds_read_b128 v[80:83], v4 offset:29696
  v_smfmac_f32_16x16x64_bf16 v[92:95], v[68:71], a[240:247], v0
  ds_read_b128 v[60:63], v4 offset:26624
  v_smfmac_f32_16x16x64_bf16 v[96:99], v[104:107], a[200:207], v0
  ds_read_b128 v[64:67], v4 offset:27648
  v_smfmac_f32_16x16x64_bf16 v[96:99], v[108:111], a[232:239], v0
  ds_read_b128 v[28:31], v4 offset:30720
  s_nop 0
  v_cvt_pk_bf16_f32 v16, v92, v93
  v_cvt_pk_bf16_f32 v17, v94, v95
  v_bfi_b32 v16, 1, s57, v16
  v_smfmac_f32_16x16x64_bf16 v[96:99], v[68:71], a[248:255], v0
  buffer_store_dwordx2 v[16:17], v7, s[4:7], s20 offen offset:0
  v_smfmac_f32_16x16x64_bf16 v[36:39], v[104:107], a[208:215], v0
  ds_read_b128 v[32:35], v4 offset:31744
  v_smfmac_f32_16x16x64_bf16 v[36:39], v[108:111], v[52:59], v0
  s_waitcnt lgkmcnt(4)
  s_nop 0
  v_cvt_pk_bf16_f32 v18, v96, v97
  v_cvt_pk_bf16_f32 v19, v98, v99
  v_bfi_b32 v18, 1, s57, v18
  v_smfmac_f32_16x16x64_bf16 v[36:39], v[68:71], v[76:83], v0
  buffer_store_dwordx2 v[18:19], v7, s[4:7], s20 offen offset:64
  v_smfmac_f32_16x16x64_bf16 v[40:43], v[104:107], a[216:223], v0
  s_waitcnt lgkmcnt(2)
  ds_read_b128 v[116:119], v2 offset:31232
  v_smfmac_f32_16x16x64_bf16 v[40:43], v[108:111], v[60:67], v0
  s_waitcnt lgkmcnt(1)
  s_nop 0
  v_cvt_pk_bf16_f32 v20, v36, v37
  v_cvt_pk_bf16_f32 v21, v38, v39
  v_bfi_b32 v20, 1, s57, v20
  v_smfmac_f32_16x16x64_bf16 v[40:43], v[68:71], v[28:35], v0
  buffer_store_dwordx2 v[20:21], v7, s[4:7], s21 offen offset:0
  s_nop 6
  v_cvt_pk_bf16_f32 v22, v40, v41
  v_cvt_pk_bf16_f32 v23, v42, v43
  v_bfi_b32 v22, 1, s57, v22
  buffer_store_dwordx2 v[22:23], v7, s[4:7], s21 offen offset:64
  ds_read_b128 v[68:71], v4 offset:0
  ds_read_b128 v[72:75], v4 offset:1024
  ds_read_b128 v[76:79], v4 offset:4096
  ds_read_b128 v[80:83], v4 offset:5120
  ds_read_b128 v[84:87], v4 offset:8192
  ds_read_b128 v[88:91], v4 offset:9216
  ds_read_b128 v[92:95], v4 offset:2048
  ds_read_b128 v[96:99], v4 offset:3072
  ds_read_b128 v[100:103], v4 offset:6144
  ds_read_b128 v[104:107], v4 offset:7168
  ds_read_b128 v[108:111], v4 offset:10240
  ds_read_b128 v[112:115], v4 offset:11264
  v_mov_b64 v[16:17], 0
  v_mov_b64 v[18:19], 0
  v_mov_b64 v[20:21], 0
  v_mov_b64 v[22:23], 0
  v_mov_b64 v[24:25], 0
  v_mov_b64 v[26:27], 0
  s_mov_b32 s19, 0
  v_mov_b32 v49, -1
  ds_read_b64 v[44:45], v2 offset:32256
  s_waitcnt lgkmcnt(0)
  v_readfirstlane_b32 s38, v44
  v_readfirstlane_b32 s37, v45
  s_nop 0
  s_add_u32 s37, s37, 30
  s_cmp_ge_u32 s38, 30
  s_cselect_b32 s38, s37, s38
  s_cmp_ge_u32 s38, 64
  s_cselect_b32 s38, 100, s38
  s_sub_u32 s38, s38, 1
  s_max_i32 s30, s30, s38
  s_waitcnt vmcnt(0)
  buffer_load_dwordx4 v[52:55], v2, s[4:7], s22 offen offset:0 sc1
  buffer_load_dwordx4 v[56:59], v2, s[4:7], s22 offen offset:1024 sc1
  buffer_load_dwordx4 v[60:63], v2, s[4:7], s22 offen offset:2048 sc1
  buffer_load_dwordx4 v[64:67], v2, s[4:7], s22 offen offset:3072 sc1
  s_waitcnt lgkmcnt(12)
  s_waitcnt vmcnt(3)
  v_mfma_f32_16x16x32_bf16 v[120:123], v[116:119], v[52:55], 0
  v_xor_b32 v48, s57, v52
  v_bitop3_b32 v48, v48, v54, s57 bitop3:0xf6
  s_waitcnt vmcnt(2)
  v_mfma_f32_16x16x32_bf16 v[120:123], v[116:119], v[56:59], v[120:123]
  v_bitop3_b32 v48, v48, v56, s57 bitop3:0xf6
  v_bitop3_b32 v48, v48, v58, s57 bitop3:0xf6
  s_waitcnt vmcnt(1)
  v_mfma_f32_16x16x32_bf16 v[120:123], v[116:119], v[60:63], v[120:123]
  v_bitop3_b32 v48, v48, v60, s57 bitop3:0xf6
  v_bitop3_b32 v48, v48, v62, s57 bitop3:0xf6
  s_waitcnt vmcnt(0)
  v_mfma_f32_16x16x32_bf16 v[120:123], v[116:119], v[64:67], v[120:123]
  v_bitop3_b32 v48, v48, v64, s57 bitop3:0xf6
  v_bitop3_b32 v48, v48, v66, s57 bitop3:0xf6
  v_and_b32 v48, 1, v48
  v_cmp_ne_u32 vcc, 0, v48
  s_cbranch_vccnz T_p1re_37
T_p1ok_38:
  s_nop 2
  v_add_f32_dpp v120, v120, v120 row_ror:8 row_mask:0xf bank_mask:0xf
  v_add_f32_dpp v121, v121, v121 row_ror:8 row_mask:0xf bank_mask:0xf
  v_cvt_pk_bf16_f32 v48, v120, v121
  buffer_store_dword v48, v8, s[4:7], s35 offen
  buffer_store_dword v49, v8, s[4:7], s26 offen
  s_barrier
  ds_read_b128 v[28:31], v2 offset:17408
  ds_read_b128 v[32:35], v2 offset:21504
  ds_read_b128 v[36:39], v2 offset:8192
  ds_read_b128 v[40:43], v2 offset:9216
  ds_read_b128 v[44:47], v2 offset:10240
  ds_read_b128 v[48:51], v2 offset:11264
  buffer_load_dwordx4 v[124:127], v2, s[4:7], s24 offen offset:1024 sc1
  buffer_load_dwordx4 v[116:119], v2, s[4:7], s25 offen offset:1024 sc1
  ds_read_b128 v[52:55], v2 offset:12288
  ds_read_b128 v[56:59], v2 offset:13312
  ds_read_b128 v[60:63], v2 offset:14336
  ds_read_b128 v[64:67], v2 offset:15360
  buffer_load_dwordx4 v[124:127], v2, s[4:7], s24 offen offset:1024 sc1
  buffer_load_dwordx4 v[116:119], v2, s[4:7], s25 offen offset:1024 sc1
  s_mov_b32 s19, 0
  s_branch T_loop_27
T_p1re_37:
  s_mov_b64 exec, vcc
  buffer_load_dwordx4 v[52:55], v2, s[4:7], s22 offen offset:0 sc1
  buffer_load_dwordx4 v[56:59], v2, s[4:7], s22 offen offset:1024 sc1
  buffer_load_dwordx4 v[60:63], v2, s[4:7], s22 offen offset:2048 sc1
  buffer_load_dwordx4 v[64:67], v2, s[4:7], s22 offen offset:3072 sc1
  s_mov_b64 exec, -1
  s_add_u32 s19, s19, 1
  s_cmp_gt_u32 s19, 32768
  s_cbranch_scc1 M_exit
  s_waitcnt vmcnt(3)
  v_mfma_f32_16x16x32_bf16 v[120:123], v[116:119], v[52:55], 0
  v_xor_b32 v48, s57, v52
  v_bitop3_b32 v48, v48, v54, s57 bitop3:0xf6
  s_waitcnt vmcnt(2)
  v_mfma_f32_16x16x32_bf16 v[120:123], v[116:119], v[56:59], v[120:123]
  v_bitop3_b32 v48, v48, v56, s57 bitop3:0xf6
  v_bitop3_b32 v48, v48, v58, s57 bitop3:0xf6
  s_waitcnt vmcnt(1)
  v_mfma_f32_16x16x32_bf16 v[120:123], v[116:119], v[60:63], v[120:123]
  v_bitop3_b32 v48, v48, v60, s57 bitop3:0xf6
  v_bitop3_b32 v48, v48, v62, s57 bitop3:0xf6
  s_waitcnt vmcnt(0)
  v_mfma_f32_16x16x32_bf16 v[120:123], v[116:119], v[64:67], v[120:123]
  v_bitop3_b32 v48, v48, v64, s57 bitop3:0xf6
  v_bitop3_b32 v48, v48, v66, s57 bitop3:0xf6
  v_and_b32 v48, 1, v48
  v_cmp_ne_u32 vcc, 0, v48
  s_cbranch_vccnz T_p1re_37
  s_branch T_p1ok_38
T_kvw_31:
  s_mov_b32 s19, 0
  s_branch T_kvok_40
T_kv_39:
  s_sleep 4
  s_add_u32 s19, s19, 1
  s_cmp_gt_u32 s19, 32768
  s_cbranch_scc1 M_exit
T_kvok_40:
  s_add_u32 s39, s99, 128
  s_mov_b32 s38, 0
  s_mov_b32 s37, 0
  s_atomic_or s38, s[58:59], s99 glc
  s_atomic_or s37, s[58:59], s39 glc
  s_waitcnt lgkmcnt(0)
  s_add_u32 s37, s37, 30
  s_cmp_ge_u32 s38, 30
  s_cselect_b32 s38, s37, s38
  s_cmp_ge_u32 s38, 64
  s_cselect_b32 s38, 100, s38
  s_sub_u32 s38, s38, 1
  s_max_i32 s30, s30, s38
  s_cmp_ge_i32 s14, s30
  s_cbranch_scc1 T_kv_39
  s_branch T_kvb_32
T_slow_34:
  s_nop 7
  v_max3_f32 v100, v16, v17, v18
  v_max3_f32 v100, v100, v19, v20
  v_max3_f32 v100, v100, v21, v22
  v_max3_f32 v100, v100, v23, v112
  v_max3_f32 v100, v100, v113, v114
  v_max_f32 v100, v100, v115
  v_mov_b32 v101, v100
  s_nop 1
  v_permlane32_swap_b32 v100, v101
  s_nop 1
  v_max_f32 v100, v100, v101
  v_mov_b32 v101, v100
  s_nop 1
  v_permlane16_swap_b32 v100, v101
  s_nop 1
  v_max_f32 v100, v100, v101
  v_sub_f32 v16, v16, v100
  v_sub_f32 v17, v17, v100
  v_sub_f32 v18, v18, v100
  v_sub_f32 v19, v19, v100
  v_exp_f32 v16, v16
  v_exp_f32 v17, v17
  v_exp_f32 v18, v18
  v_exp_f32 v19, v19
  v_sub_f32 v20, v20, v100
  v_sub_f32 v21, v21, v100
  v_sub_f32 v22, v22, v100
  v_sub_f32 v23, v23, v100
  v_exp_f32 v20, v20
  v_exp_f32 v21, v21
  v_exp_f32 v22, v22
  v_exp_f32 v23, v23
  v_sub_f32 v112, v112, v100
  v_sub_f32 v113, v113, v100
  v_sub_f32 v114, v114, v100
  v_sub_f32 v115, v115, v100
  v_exp_f32 v112, v112
  v_exp_f32 v113, v113
  v_exp_f32 v114, v114
  v_exp_f32 v115, v115
  s_nop 0
  v_cvt_pk_bf16_f32 v44, v16, v17
  v_cvt_pk_bf16_f32 v45, v18, v19
  v_cvt_pk_bf16_f32 v46, v20, v21
  v_cvt_pk_bf16_f32 v47, v22, v23
  v_cvt_pk_bf16_f32 v84, v112, v113
  v_cvt_pk_bf16_f32 v85, v114, v115
  v_cndmask_b32 v48, v84, 0, s[16:17]
  v_cndmask_b32 v49, v85, 0, s[16:17]
  v_cndmask_b32 v50, 0, v84, s[16:17]
  v_cndmask_b32 v51, 0, v85, s[16:17]
  s_nop 1
  v_mfma_f32_16x16x16_bf16 v[88:91], v[12:13], v[48:49], 0
  v_mfma_f32_16x16x16_bf16 v[24:27], v[120:121], v[48:49], 0
  v_mfma_f32_16x16x16_bf16 v[116:119], v[120:121], v[50:51], 0
  v_mfma_f32_16x16x32_bf16 v[88:91], v[12:15], v[44:47], v[88:91]
  v_mfma_f32_16x16x32_bf16 v[24:27], v[28:31], v[44:47], v[24:27]
  v_mfma_f32_16x16x32_bf16 v[116:119], v[32:35], v[44:47], v[116:119]
  s_nop 7
  s_nop 1
  v_rcp_f32 v89, v88
  s_nop 0
  v_mul_f32 v24, v89, v24
  v_mul_f32 v25, v89, v25
  s_branch T_back_35
T_w_11:
  s_mov_b32 s19, 0
  v_mov_b64 v[16:17], 0
  v_mov_b64 v[18:19], 0
  v_mov_b64 v[20:21], 0
  v_mov_b64 v[22:23], 0
  v_mov_b64 v[24:25], 0
  v_mov_b64 v[26:27], 0
  buffer_load_dwordx4 v[124:127], v2, s[4:7], s24 offen offset:2048 sc1
  buffer_load_dwordx4 v[116:119], v2, s[4:7], s25 offen offset:2048 sc1
  buffer_load_dwordx4 v[124:127], v2, s[4:7], s24 offen offset:2048 sc1
  buffer_load_dwordx4 v[116:119], v2, s[4:7], s25 offen offset:2048 sc1
  s_branch T_loop_41
.p2align 6
T_retry_42:
  s_mov_b64 exec, vcc
  buffer_load_dwordx4 v[124:127], v2, s[4:7], s24 offen offset:2048 sc1
  buffer_load_dwordx4 v[116:119], v2, s[4:7], s25 offen offset:2048 sc1
  s_mov_b64 exec, -1
  s_add_u32 s19, s19, 1
  s_cmp_gt_u32 s19, 32768
  s_cbranch_scc1 M_exit
T_loop_41:
  s_waitcnt vmcnt(3) lgkmcnt(0)
  v_max3_u32 v123, v124, v125, v126
  v_max_u32 v123, v123, v127
  v_mov_b32_dpp v120, v124 row_ror:8 row_mask:0xf bank_mask:0xf
  v_mov_b32_dpp v121, v125 row_ror:8 row_mask:0xf bank_mask:0xf
  s_waitcnt vmcnt(2)
  v_max3_u32 v123, v123, v116, v117
  v_max3_u32 v123, v123, v118, v119
  v_cmp_eq_u32 vcc, -1, v123
  s_cbranch_vccnz T_retry_42
  v_smfmac_f32_16x16x64_bf16 v[16:19], v[124:127], v[68:75], v0
  s_add_u32 s14, s14, 1
  ds_write_b128 v2, v[124:127] offset:2048
  v_mov_b32_dpp v122, v126 row_ror:8 row_mask:0xf bank_mask:0xf
  v_smfmac_f32_16x16x64_bf16 v[20:23], v[124:127], v[76:83], v0
  s_and_b32 s57, s14, 1
  v_mov_b32_dpp v123, v127 row_ror:8 row_mask:0xf bank_mask:0xf
  v_smfmac_f32_16x16x64_bf16 v[24:27], v[124:127], v[84:91], v0
  s_and_b32 s36, s14, 3
  ds_write_b128 v2, v[116:119] offset:6144
  v_smfmac_f32_16x16x64_bf16 v[16:19], v[120:123], v[92:99], v0
  s_lshl_b32 s36, s36, 13
  v_mov_b32_dpp v84, v116 row_ror:8 row_mask:0xf bank_mask:0xf
  v_smfmac_f32_16x16x64_bf16 v[20:23], v[120:123], v[100:107], v0
  s_add_u32 s26, s36, s23
  ds_read_b128 v[68:71], v4 offset:12288
  v_mov_b32_dpp v85, v117 row_ror:8 row_mask:0xf bank_mask:0xf
  v_smfmac_f32_16x16x64_bf16 v[24:27], v[120:123], v[108:115], v0
  s_add_u32 s36, s36, 8192
  ds_read_b128 v[72:75], v4 offset:13312
  v_mov_b32_dpp v86, v118 row_ror:8 row_mask:0xf bank_mask:0xf
  v_smfmac_f32_16x16x64_bf16 v[16:19], v[116:119], v[224:231], v0
  s_and_b32 s36, s36, 0x7fff
  ds_read_b128 v[76:79], v4 offset:14336
  v_mov_b32_dpp v87, v119 row_ror:8 row_mask:0xf bank_mask:0xf
  v_smfmac_f32_16x16x64_bf16 v[20:23], v[116:119], v[240:247], v0
  s_waitcnt lgkmcnt(3)
  s_barrier
  ds_read_b128 v[100:103], v2 offset:3072
  v_smfmac_f32_16x16x64_bf16 v[24:27], v[116:119], a[0:7], v0
  s_mov_b32 m0, s31
  ds_read_b128 v[120:123], v1 offset:3072
  v_smfmac_f32_16x16x64_bf16 v[16:19], v[84:87], v[232:239], v0
  s_cmp_ge_i32 s14, s30
  s_cbranch_scc1 T_kvw_45
T_kvb_46:
  v_smfmac_f32_16x16x64_bf16 v[20:23], v[84:87], v[248:255], v0
  ds_read_b128 v[80:83], v4 offset:15360
  v_smfmac_f32_16x16x64_bf16 v[24:27], v[84:87], a[8:15], v0
  s_waitcnt lgkmcnt(2)
  v_smfmac_f32_16x16x64_bf16 v[16:19], v[100:103], v[128:135], v0
  ds_read_b128 v[92:95], v2 offset:0
  buffer_load_dwordx4 v9, s[4:7], s27 offen sc1 lds
  v_smfmac_f32_16x16x64_bf16 v[20:23], v[100:103], v[144:151], v0
  ds_read_b128 v[96:99], v1 offset:0
  s_mov_b32 m0, s32
  v_smfmac_f32_16x16x64_bf16 v[24:27], v[100:103], v[68:75], v0
  s_waitcnt vmcnt(1) lgkmcnt(3)
  ds_read_b128 v[116:119], v2 offset:1024
  v_smfmac_f32_16x16x64_bf16 v[16:19], v[120:123], v[136:143], v0
  ds_read_b128 v[124:127], v1 offset:1024
  v_smfmac_f32_16x16x64_bf16 v[20:23], v[120:123], v[152:159], v0
  s_waitcnt lgkmcnt(4)
  ds_read_b128 v[104:107], v2 offset:7168
  buffer_load_dwordx4 v9, s[4:7], s27 offen offset:128 sc1 lds
  v_smfmac_f32_16x16x64_bf16 v[24:27], v[120:123], v[76:83], v0
  s_waitcnt lgkmcnt(4)
  ds_read_b128 v[108:111], v1 offset:7168
  s_mov_b32 m0, s33
  v_smfmac_f32_16x16x64_bf16 v[16:19], v[92:95], v[160:167], v0
  s_waitcnt lgkmcnt(4)
  ds_read_b128 v[112:115], v2 offset:4096
  v_mov_b32 v122, s98
  v_smfmac_f32_16x16x64_bf16 v[16:19], v[96:99], v[168:175], v0
  s_waitcnt lgkmcnt(4)
  ds_read_b128 v[84:87], v1 offset:4096
  v_smfmac_f32_16x16x64_bf16 v[16:19], v[116:119], v[192:199], v0
  s_waitcnt lgkmcnt(4)
  ds_read_b128 v[88:91], v2 offset:5120
  buffer_load_dwordx4 v10, s[4:7], s28 offen sc1 lds
  v_smfmac_f32_16x16x64_bf16 v[16:19], v[124:127], v[200:207], v0
  s_waitcnt lgkmcnt(4)
  ds_read_b128 v[100:103], v1 offset:5120
  s_mov_b32 m0, s34
  v_smfmac_f32_16x16x64_bf16 v[16:19], v[104:107], a[16:23], v0
  s_waitcnt lgkmcnt(4)
  ds_read_b128 v[68:71], v4 offset:16384
  v_smfmac_f32_16x16x64_bf16 v[16:19], v[108:111], a[24:31], v0
  s_waitcnt lgkmcnt(4)
  ds_read_b128 v[72:75], v4 offset:17408
  v_smfmac_f32_16x16x64_bf16 v[16:19], v[112:115], a[64:71], v0
  s_waitcnt lgkmcnt(4)
  ds_read_b128 v[76:79], v4 offset:18432
  buffer_load_dwordx4 v10, s[4:7], s28 offen offset:256 sc1 lds
  v_smfmac_f32_16x16x64_bf16 v[16:19], v[84:87], a[72:79], v0
  s_waitcnt lgkmcnt(4)
  ds_read_b128 v[80:83], v4 offset:19456
  v_smfmac_f32_16x16x64_bf16 v[16:19], v[88:91], a[112:119], v0
  s_waitcnt lgkmcnt(4)
  v_smfmac_f32_16x16x64_bf16 v[16:19], v[100:103], a[120:127], v0
  s_add_u32 s24, s36, 145752064
  s_add_u32 s25, s36, 145756160
  v_smfmac_f32_16x16x64_bf16 v[20:23], v[92:95], v[176:183], v0
  buffer_store_dword v122, v3, s[4:7], s15 offen sc1
  s_add_u32 s35, s36, s23
  v_smfmac_f32_16x16x64_bf16 v[20:23], v[96:99], v[184:191], v0
  s_waitcnt lgkmcnt(2)
  s_add_u32 s98, s14, 1
  v_smfmac_f32_16x16x64_bf16 v[20:23], v[116:119], v[68:75], v0
  s_waitcnt lgkmcnt(0)
  ds_read_b128 v[68:71], v4 offset:20480
  v_mul_f32 v16, s18, v16
  v_smfmac_f32_16x16x64_bf16 v[20:23], v[124:127], v[76:83], v0
  ds_read_b128 v[72:75], v4 offset:21504
  v_mul_f32 v17, s18, v17
  v_smfmac_f32_16x16x64_bf16 v[20:23], v[104:107], a[32:39], v0
  ds_read_b128 v[76:79], v4 offset:22528
  v_mul_f32 v18, s18, v18
  v_smfmac_f32_16x16x64_bf16 v[20:23], v[108:111], a[40:47], v0
  ds_read_b128 v[80:83], v4 offset:23552
  v_mul_f32 v19, s18, v19
  v_smfmac_f32_16x16x64_bf16 v[20:23], v[112:115], a[80:87], v0
  v_cvt_pk_bf16_f32 v120, v16, v17
  v_smfmac_f32_16x16x64_bf16 v[20:23], v[84:87], a[88:95], v0
  v_cvt_pk_bf16_f32 v121, v18, v19
  v_smfmac_f32_16x16x64_bf16 v[20:23], v[88:91], a[128:135], v0
  ds_write_b64 v5, v[120:121] offset:24576
  v_smfmac_f32_16x16x64_bf16 v[20:23], v[100:103], a[136:143], v0
  s_waitcnt lgkmcnt(3)
  v_smfmac_f32_16x16x64_bf16 v[24:27], v[92:95], v[68:75], v0
  s_waitcnt lgkmcnt(1)
  v_mov_b64 v[92:93], 0
  v_smfmac_f32_16x16x64_bf16 v[24:27], v[96:99], v[76:83], v0
  s_nop 1
  v_cvt_pk_bf16_f32 v122, v20, v21
  v_cvt_pk_bf16_f32 v123, v22, v23
  v_smfmac_f32_16x16x64_bf16 v[24:27], v[116:119], v[208:215], v0
  ds_write_b64 v5, v[122:123] offset:26880
  v_mov_b64 v[94:95], 0
  v_smfmac_f32_16x16x64_bf16 v[24:27], v[124:127], v[216:223], v0
  s_waitcnt lgkmcnt(1)
  s_barrier
  ds_read_b64_tr_b16 v[68:69], v6 offset:24576
  v_smfmac_f32_16x16x64_bf16 v[24:27], v[104:107], a[48:55], v0
  s_add_u32 s27, s27, 8192
  ds_read_b64_tr_b16 v[70:71], v6 offset:24640
  ds_read_b64_tr_b16 v[72:73], v6 offset:24832
  v_smfmac_f32_16x16x64_bf16 v[24:27], v[108:111], a[56:63], v0
  s_add_u32 s28, s28, 8192
  ds_read_b64_tr_b16 v[74:75], v6 offset:24896
  ds_read_b64_tr_b16 v[76:77], v6 offset:25088
  v_smfmac_f32_16x16x64_bf16 v[24:27], v[112:115], a[96:103], v0
  s_nop 0
  ds_read_b64_tr_b16 v[78:79], v6 offset:25152
  ds_read_b64_tr_b16 v[80:81], v6 offset:25344
  v_smfmac_f32_16x16x64_bf16 v[24:27], v[84:87], a[104:111], v0
  ds_read_b64_tr_b16 v[82:83], v6 offset:25408
  v_mov_b64 v[96:97], 0
  v_smfmac_f32_16x16x64_bf16 v[24:27], v[88:91], a[144:151], v0
  s_waitcnt lgkmcnt(8)
  s_barrier
  ds_read_b64_tr_b16 v[116:117], v6 offset:26880
  v_smfmac_f32_16x16x64_bf16 v[24:27], v[100:103], a[152:159], v0
  s_waitcnt lgkmcnt(7)
  ds_read_b64_tr_b16 v[118:119], v6 offset:26944
  v_mfma_f32_16x16x32_bf16 v[16:19], v[36:39], v[68:71], 0
  s_waitcnt lgkmcnt(6)
  ds_read_b64_tr_b16 v[124:125], v6 offset:27136
  ds_read_b64_tr_b16 v[126:127], v6 offset:27200
  v_mfma_f32_16x16x32_bf16 v[16:19], v[40:43], v[72:75], v[16:19]
  s_waitcnt lgkmcnt(6)
  ds_read_b64_tr_b16 v[104:105], v6 offset:27392
  ds_read_b64_tr_b16 v[106:107], v6 offset:27456
  v_mfma_f32_16x16x32_bf16 v[16:19], v[44:47], v[76:79], v[16:19]
  s_waitcnt lgkmcnt(6)
  ds_read_b64_tr_b16 v[108:109], v6 offset:27648
  ds_read_b64_tr_b16 v[110:111], v6 offset:27712
  v_mfma_f32_16x16x32_bf16 v[16:19], v[48:51], v[80:83], v[16:19]
  s_waitcnt lgkmcnt(6)
  v_cvt_pk_bf16_f32 v120, v24, v25
  v_cvt_pk_bf16_f32 v121, v26, v27
  v_mfma_f32_16x16x32_bf16 v[112:115], v[116:119], v[68:71], 0
  s_waitcnt lgkmcnt(4)
  v_mov_b64 v[98:99], 0
  v_mfma_f32_16x16x32_bf16 v[112:115], v[124:127], v[72:75], v[112:115]
  s_waitcnt lgkmcnt(2)
  v_mov_b64 v[36:37], 0
  v_exp_f32 v100, v16
  v_mfma_f32_16x16x32_bf16 v[112:115], v[104:107], v[76:79], v[112:115]
  s_waitcnt lgkmcnt(0)
  buffer_store_dwordx4 v[120:123], v2, s[4:7], s29 offen offset:2048 sc1
  v_exp_f32 v101, v17
  v_mfma_f32_16x16x32_bf16 v[112:115], v[108:111], v[80:83], v[112:115]
  v_exp_f32 v102, v18
  v_mfma_f32_16x16x32_bf16 v[20:23], v[52:55], v[68:71], 0
  s_cmp_eq_u32 s14, 63
  v_exp_f32 v103, v19
  v_mfma_f32_16x16x32_bf16 v[20:23], v[56:59], v[72:75], v[20:23]
  s_cbranch_scc1 M_tdone
  v_cvt_pk_bf16_f32 v44, v100, v101
  v_cvt_pk_bf16_f32 v45, v102, v103
  v_mfma_f32_16x16x32_bf16 v[20:23], v[60:63], v[76:79], v[20:23]
  s_add_u32 s29, s29, 131072
  v_exp_f32 v100, v112
  v_mfma_f32_16x16x32_bf16 v[20:23], v[64:67], v[80:83], v[20:23]
  v_exp_f32 v101, v113
  v_exp_f32 v102, v114
  v_exp_f32 v103, v115
  v_cvt_pk_bf16_f32 v84, v100, v101
  v_cvt_pk_bf16_f32 v85, v102, v103
  v_cndmask_b32 v48, v84, 0, s[16:17]
  v_cndmask_b32 v49, v85, 0, s[16:17]
  v_cndmask_b32 v50, 0, v84, s[16:17]
  v_cndmask_b32 v51, 0, v85, s[16:17]
  v_exp_f32 v100, v20
  v_mfma_f32_16x16x16_bf16 v[88:91], v[12:13], v[48:49], 0
  v_exp_f32 v101, v21
  v_mfma_f32_16x16x16_bf16 v[24:27], v[120:121], v[48:49], 0
  v_exp_f32 v102, v22
  v_mfma_f32_16x16x16_bf16 v[116:119], v[120:121], v[50:51], 0
  v_exp_f32 v103, v23
  v_cvt_pk_bf16_f32 v46, v100, v101
  v_cvt_pk_bf16_f32 v47, v102, v103
  v_mov_b64 v[38:39], 0
  s_nop 0
  v_mfma_f32_16x16x32_bf16 v[88:91], v[12:15], v[44:47], v[88:91]
  v_mov_b64 v[40:41], 0
  v_mov_b64 v[42:43], 0
  v_mfma_f32_16x16x32_bf16 v[24:27], v[28:31], v[44:47], v[24:27]
  ds_read_b128 v[52:55], v4 offset:24576
  ds_read_b128 v[56:59], v4 offset:25600
  v_mfma_f32_16x16x32_bf16 v[116:119], v[32:35], v[44:47], v[116:119]
  s_nop 1
  v_rcp_f32 v89, v88
  v_subrev_u32 v100, s54, v88
  v_cmp_le_u32 vcc, s55, v100
  v_mul_f32 v24, v89, v24
  v_mul_f32 v25, v89, v25
  s_cbranch_vccnz T_slow_48
T_back_49:
  v_cvt_pk_bf16_f32 v124, v24, v25
  v_pk_mul_f32 v[26:27], v[26:27], v[88:89] op_sel:[0,1] op_sel_hi:[1,1]
  v_pk_mul_f32 v[116:117], v[116:117], v[88:89] op_sel:[0,1] op_sel_hi:[1,1]
  v_pk_mul_f32 v[118:119], v[118:119], v[88:89] op_sel:[0,1] op_sel_hi:[1,1]
  v_cvt_pk_bf16_f32 v125, v26, v27
  v_cvt_pk_bf16_f32 v126, v116, v117
  v_cvt_pk_bf16_f32 v127, v118, v119
  ds_write_b128 v11, v[124:127] offset:30208
  s_nop 0
  v_smfmac_f32_16x16x64_bf16 v[92:95], v[124:127], a[160:167], v0
  v_smfmac_f32_16x16x64_bf16 v[96:99], v[124:127], a[168:175], v0
  v_smfmac_f32_16x16x64_bf16 v[36:39], v[124:127], a[176:183], v0
  v_smfmac_f32_16x16x64_bf16 v[40:43], v[124:127], a[184:191], v0
  s_waitcnt lgkmcnt(0)
  s_barrier
  ds_read_b128 v[104:107], v11 offset:30720
  ds_read_b128 v[108:111], v11 offset:29184
  ds_read_b128 v[68:71], v11 offset:29696
  s_waitcnt lgkmcnt(2)
  v_smfmac_f32_16x16x64_bf16 v[92:95], v[104:107], a[192:199], v0
  s_waitcnt lgkmcnt(1)
  ds_read_b128 v[76:79], v4 offset:28672
  v_smfmac_f32_16x16x64_bf16 v[92:95], v[108:111], a[224:231], v0
  s_waitcnt lgkmcnt(1)
  ds_read_b128 v[80:83], v4 offset:29696
  v_smfmac_f32_16x16x64_bf16 v[92:95], v[68:71], a[240:247], v0
  ds_read_b128 v[60:63], v4 offset:26624
  v_smfmac_f32_16x16x64_bf16 v[96:99], v[104:107], a[200:207], v0
  ds_read_b128 v[64:67], v4 offset:27648
  v_smfmac_f32_16x16x64_bf16 v[96:99], v[108:111], a[232:239], v0
  ds_read_b128 v[28:31], v4 offset:30720
  s_nop 0
  v_cvt_pk_bf16_f32 v16, v92, v93
  v_cvt_pk_bf16_f32 v17, v94, v95
  v_bfi_b32 v16, 1, s57, v16
  v_smfmac_f32_16x16x64_bf16 v[96:99], v[68:71], a[248:255], v0
  buffer_store_dwordx2 v[16:17], v7, s[4:7], s20 offen offset:0
  v_smfmac_f32_16x16x64_bf16 v[36:39], v[104:107], a[208:215], v0
  ds_read_b128 v[32:35], v4 offset:31744
  v_smfmac_f32_16x16x64_bf16 v[36:39], v[108:111], v[52:59], v0
  s_waitcnt lgkmcnt(4)
  s_nop 0
  v_cvt_pk_bf16_f32 v18, v96, v97
  v_cvt_pk_bf16_f32 v19, v98, v99
  v_bfi_b32 v18, 1, s57, v18
  v_smfmac_f32_16x16x64_bf16 v[36:39], v[68:71], v[76:83], v0
  buffer_store_dwordx2 v[18:19], v7, s[4:7], s20 offen offset:64
  v_smfmac_f32_16x16x64_bf16 v[40:43], v[104:107], a[216:223], v0
  s_waitcnt lgkmcnt(2)
  v_smfmac_f32_16x16x64_bf16 v[40:43], v[108:111], v[60:67], v0
  s_waitcnt lgkmcnt(0)
  s_nop 0
  v_cvt_pk_bf16_f32 v20, v36, v37
  v_cvt_pk_bf16_f32 v21, v38, v39
  v_bfi_b32 v20, 1, s57, v20
  v_smfmac_f32_16x16x64_bf16 v[40:43], v[68:71], v[28:35], v0
  buffer_store_dwordx2 v[20:21], v7, s[4:7], s21 offen offset:0
  s_nop 6
  v_cvt_pk_bf16_f32 v22, v40, v41
  v_cvt_pk_bf16_f32 v23, v42, v43
  v_bfi_b32 v22, 1, s57, v22
  buffer_store_dwordx2 v[22:23], v7, s[4:7], s21 offen offset:64
  ds_read_b128 v[68:71], v4 offset:0
  ds_read_b128 v[72:75], v4 offset:1024
  ds_read_b128 v[76:79], v4 offset:4096
  ds_read_b128 v[80:83], v4 offset:5120
  ds_read_b128 v[84:87], v4 offset:8192
  ds_read_b128 v[88:91], v4 offset:9216
  ds_read_b128 v[92:95], v4 offset:2048
  ds_read_b128 v[96:99], v4 offset:3072
  ds_read_b128 v[100:103], v4 offset:6144
  ds_read_b128 v[104:107], v4 offset:7168
  ds_read_b128 v[108:111], v4 offset:10240
  ds_read_b128 v[112:115], v4 offset:11264
  v_mov_b64 v[16:17], 0
  v_mov_b64 v[18:19], 0
  v_mov_b64 v[20:21], 0
  v_mov_b64 v[22:23], 0
  v_mov_b64 v[24:25], 0
  v_mov_b64 v[26:27], 0
  ds_read_b64 v[44:45], v2 offset:32256
  s_waitcnt lgkmcnt(0)
  v_readfirstlane_b32 s38, v44
  v_readfirstlane_b32 s37, v45
  s_nop 0
  s_add_u32 s37, s37, 30
  s_cmp_ge_u32 s38, 30
  s_cselect_b32 s38, s37, s38
  s_cmp_ge_u32 s38, 64
  s_cselect_b32 s38, 100, s38
  s_sub_u32 s38, s38, 1
  s_max_i32 s30, s30, s38
  s_waitcnt vmcnt(4)
  s_barrier
  ds_read_b128 v[28:31], v2 offset:18432
  ds_read_b128 v[32:35], v2 offset:22528
  ds_read_b128 v[36:39], v2 offset:8192
  ds_read_b128 v[40:43], v2 offset:9216
  ds_read_b128 v[44:47], v2 offset:10240
  ds_read_b128 v[48:51], v2 offset:11264
  buffer_load_dwordx4 v[124:127], v2, s[4:7], s24 offen offset:2048 sc1
  buffer_load_dwordx4 v[116:119], v2, s[4:7], s25 offen offset:2048 sc1
  ds_read_b128 v[52:55], v2 offset:12288
  ds_read_b128 v[56:59], v2 offset:13312
  ds_read_b128 v[60:63], v2 offset:14336
  ds_read_b128 v[64:67], v2 offset:15360
  buffer_load_dwordx4 v[124:127], v2, s[4:7], s24 offen offset:2048 sc1
  buffer_load_dwordx4 v[116:119], v2, s[4:7], s25 offen offset:2048 sc1
  s_mov_b32 s19, 0
  s_branch T_loop_41
T_kvw_45:
  s_mov_b32 s19, 0
  s_branch T_kvok_54
T_kv_53:
  s_sleep 4
  s_add_u32 s19, s19, 1
  s_cmp_gt_u32 s19, 32768
  s_cbranch_scc1 M_exit
T_kvok_54:
  s_add_u32 s39, s99, 128
  s_mov_b32 s38, 0
  s_mov_b32 s37, 0
  s_atomic_or s38, s[58:59], s99 glc
  s_atomic_or s37, s[58:59], s39 glc
  s_waitcnt lgkmcnt(0)
  s_add_u32 s37, s37, 30
  s_cmp_ge_u32 s38, 30
  s_cselect_b32 s38, s37, s38
  s_cmp_ge_u32 s38, 64
  s_cselect_b32 s38, 100, s38
  s_sub_u32 s38, s38, 1
  s_max_i32 s30, s30, s38
  s_cmp_ge_i32 s14, s30
  s_cbranch_scc1 T_kv_53
  s_branch T_kvb_46
T_slow_48:
  s_nop 7
  v_max3_f32 v100, v16, v17, v18
  v_max3_f32 v100, v100, v19, v20
  v_max3_f32 v100, v100, v21, v22
  v_max3_f32 v100, v100, v23, v112
  v_max3_f32 v100, v100, v113, v114
  v_max_f32 v100, v100, v115
  v_mov_b32 v101, v100
  s_nop 1
  v_permlane32_swap_b32 v100, v101
  s_nop 1
  v_max_f32 v100, v100, v101
  v_mov_b32 v101, v100
  s_nop 1
  v_permlane16_swap_b32 v100, v101
  s_nop 1
  v_max_f32 v100, v100, v101
  v_sub_f32 v16, v16, v100
  v_sub_f32 v17, v17, v100
  v_sub_f32 v18, v18, v100
  v_sub_f32 v19, v19, v100
  v_exp_f32 v16, v16
  v_exp_f32 v17, v17
  v_exp_f32 v18, v18
  v_exp_f32 v19, v19
  v_sub_f32 v20, v20, v100
  v_sub_f32 v21, v21, v100
  v_sub_f32 v22, v22, v100
  v_sub_f32 v23, v23, v100
  v_exp_f32 v20, v20
  v_exp_f32 v21, v21
  v_exp_f32 v22, v22
  v_exp_f32 v23, v23
  v_sub_f32 v112, v112, v100
  v_sub_f32 v113, v113, v100
  v_sub_f32 v114, v114, v100
  v_sub_f32 v115, v115, v100
  v_exp_f32 v112, v112
  v_exp_f32 v113, v113
  v_exp_f32 v114, v114
  v_exp_f32 v115, v115
  s_nop 0
  v_cvt_pk_bf16_f32 v44, v16, v17
  v_cvt_pk_bf16_f32 v45, v18, v19
  v_cvt_pk_bf16_f32 v46, v20, v21
  v_cvt_pk_bf16_f32 v47, v22, v23
  v_cvt_pk_bf16_f32 v84, v112, v113
  v_cvt_pk_bf16_f32 v85, v114, v115
  v_cndmask_b32 v48, v84, 0, s[16:17]
  v_cndmask_b32 v49, v85, 0, s[16:17]
  v_cndmask_b32 v50, 0, v84, s[16:17]
  v_cndmask_b32 v51, 0, v85, s[16:17]
  s_nop 1
  v_mfma_f32_16x16x16_bf16 v[88:91], v[12:13], v[48:49], 0
  v_mfma_f32_16x16x16_bf16 v[24:27], v[120:121], v[48:49], 0
  v_mfma_f32_16x16x16_bf16 v[116:119], v[120:121], v[50:51], 0
  v_mfma_f32_16x16x32_bf16 v[88:91], v[12:15], v[44:47], v[88:91]
  v_mfma_f32_16x16x32_bf16 v[24:27], v[28:31], v[44:47], v[24:27]
  v_mfma_f32_16x16x32_bf16 v[116:119], v[32:35], v[44:47], v[116:119]
  s_nop 7
  s_nop 1
  v_rcp_f32 v89, v88
  s_nop 0
  v_mul_f32 v24, v89, v24
  v_mul_f32 v25, v89, v25
  s_branch T_back_49
T_w_12:
  s_mov_b32 s19, 0
  v_mov_b64 v[16:17], 0
  v_mov_b64 v[18:19], 0
  v_mov_b64 v[20:21], 0
  v_mov_b64 v[22:23], 0
  v_mov_b64 v[24:25], 0
  v_mov_b64 v[26:27], 0
  buffer_load_dwordx4 v[124:127], v2, s[4:7], s24 offen offset:3072 sc1
  buffer_load_dwordx4 v[116:119], v2, s[4:7], s25 offen offset:3072 sc1
  buffer_load_dwordx4 v[124:127], v2, s[4:7], s24 offen offset:3072 sc1
  buffer_load_dwordx4 v[116:119], v2, s[4:7], s25 offen offset:3072 sc1
  s_branch T_loop_55
.p2align 6
T_retry_56:
  s_mov_b64 exec, vcc
  buffer_load_dwordx4 v[124:127], v2, s[4:7], s24 offen offset:3072 sc1
  buffer_load_dwordx4 v[116:119], v2, s[4:7], s25 offen offset:3072 sc1
  s_mov_b64 exec, -1
  s_add_u32 s19, s19, 1
  s_cmp_gt_u32 s19, 32768
  s_cbranch_scc1 M_exit
T_loop_55:
  s_waitcnt vmcnt(3) lgkmcnt(0)
  v_max3_u32 v123, v124, v125, v126
  v_max_u32 v123, v123, v127
  v_mov_b32_dpp v120, v124 row_ror:8 row_mask:0xf bank_mask:0xf
  v_mov_b32_dpp v121, v125 row_ror:8 row_mask:0xf bank_mask:0xf
  s_waitcnt vmcnt(2)
  v_max3_u32 v123, v123, v116, v117
  v_max3_u32 v123, v123, v118, v119
  v_cmp_eq_u32 vcc, -1, v123
  s_cbranch_vccnz T_retry_56
  v_smfmac_f32_16x16x64_bf16 v[16:19], v[124:127], v[68:75], v0
  s_add_u32 s14, s14, 1
  ds_write_b128 v2, v[124:127] offset:3072
  v_mov_b32_dpp v122, v126 row_ror:8 row_mask:0xf bank_mask:0xf
  v_smfmac_f32_16x16x64_bf16 v[20:23], v[124:127], v[76:83], v0
  s_and_b32 s57, s14, 1
  v_mov_b32_dpp v123, v127 row_ror:8 row_mask:0xf bank_mask:0xf
  v_smfmac_f32_16x16x64_bf16 v[24:27], v[124:127], v[84:91], v0
  s_and_b32 s36, s14, 3
  ds_write_b128 v2, v[116:119] offset:7168
  v_smfmac_f32_16x16x64_bf16 v[16:19], v[120:123], v[92:99], v0
  s_lshl_b32 s36, s36, 13
  v_mov_b32_dpp v84, v116 row_ror:8 row_mask:0xf bank_mask:0xf
  v_smfmac_f32_16x16x64_bf16 v[20:23], v[120:123], v[100:107], v0
  s_add_u32 s26, s36, s23
  ds_read_b128 v[68:71], v4 offset:12288
  v_mov_b32_dpp v85, v117 row_ror:8 row_mask:0xf bank_mask:0xf
  v_smfmac_f32_16x16x64_bf16 v[24:27], v[120:123], v[108:115], v0
  s_add_u32 s36, s36, 8192
  ds_read_b128 v[72:75], v4 offset:13312
  v_mov_b32_dpp v86, v118 row_ror:8 row_mask:0xf bank_mask:0xf
  v_smfmac_f32_16x16x64_bf16 v[16:19], v[116:119], v[224:231], v0
  s_and_b32 s36, s36, 0x7fff
  ds_read_b128 v[76:79], v4 offset:14336
  v_mov_b32_dpp v87, v119 row_ror:8 row_mask:0xf bank_mask:0xf
  v_smfmac_f32_16x16x64_bf16 v[20:23], v[116:119], v[240:247], v0
  s_waitcnt lgkmcnt(3)
  s_barrier
  ds_read_b128 v[100:103], v2 offset:2048
  v_smfmac_f32_16x16x64_bf16 v[24:27], v[116:119], a[0:7], v0
  s_mov_b32 m0, s31
  ds_read_b128 v[120:123], v1 offset:2048
  v_smfmac_f32_16x16x64_bf16 v[16:19], v[84:87], v[232:239], v0
  s_cmp_ge_i32 s14, s30
  s_cbranch_scc1 T_kvw_59
T_kvb_60:
  v_smfmac_f32_16x16x64_bf16 v[20:23], v[84:87], v[248:255], v0
  ds_read_b128 v[80:83], v4 offset:15360
  v_smfmac_f32_16x16x64_bf16 v[24:27], v[84:87], a[8:15], v0
  s_waitcnt lgkmcnt(2)
  v_smfmac_f32_16x16x64_bf16 v[16:19], v[100:103], v[128:135], v0
  ds_read_b128 v[92:95], v2 offset:1024
  v_smfmac_f32_16x16x64_bf16 v[20:23], v[100:103], v[144:151], v0
  ds_read_b128 v[96:99], v1 offset:1024
  buffer_load_dwordx4 v9, s[4:7], s27 offen sc1 lds
  v_smfmac_f32_16x16x64_bf16 v[24:27], v[100:103], v[68:75], v0
  s_waitcnt vmcnt(1) lgkmcnt(3)
  ds_read_b128 v[116:119], v2 offset:0
  s_mov_b32 m0, s32
  v_smfmac_f32_16x16x64_bf16 v[16:19], v[120:123], v[136:143], v0
  ds_read_b128 v[124:127], v1 offset:0
  v_smfmac_f32_16x16x64_bf16 v[20:23], v[120:123], v[152:159], v0
  s_waitcnt lgkmcnt(4)
  ds_read_b128 v[104:107], v2 offset:6144
  v_smfmac_f32_16x16x64_bf16 v[24:27], v[120:123], v[76:83], v0
  s_waitcnt lgkmcnt(4)
  ds_read_b128 v[108:111], v1 offset:6144
  buffer_load_dwordx4 v9, s[4:7], s27 offen offset:128 sc1 lds
  v_smfmac_f32_16x16x64_bf16 v[16:19], v[92:95], v[160:167], v0
  s_waitcnt lgkmcnt(4)
  ds_read_b128 v[112:115], v2 offset:5120
  s_mov_b32 m0, s33
  v_smfmac_f32_16x16x64_bf16 v[16:19], v[96:99], v[168:175], v0
  s_waitcnt lgkmcnt(4)
  ds_read_b128 v[84:87], v1 offset:5120
  v_smfmac_f32_16x16x64_bf16 v[16:19], v[116:119], v[192:199], v0
  s_waitcnt lgkmcnt(4)
  ds_read_b128 v[88:91], v2 offset:4096
  v_smfmac_f32_16x16x64_bf16 v[16:19], v[124:127], v[200:207], v0
  s_waitcnt lgkmcnt(4)
  ds_read_b128 v[100:103], v1 offset:4096
  buffer_load_dwordx4 v10, s[4:7], s28 offen sc1 lds
  v_smfmac_f32_16x16x64_bf16 v[16:19], v[104:107], a[16:23], v0
  s_waitcnt lgkmcnt(4)
  ds_read_b128 v[68:71], v4 offset:16384
  s_mov_b32 m0, s34
  v_smfmac_f32_16x16x64_bf16 v[16:19], v[108:111], a[24:31], v0
  s_waitcnt lgkmcnt(4)
  ds_read_b128 v[72:75], v4 offset:17408
  v_smfmac_f32_16x16x64_bf16 v[16:19], v[112:115], a[64:71], v0
  s_waitcnt lgkmcnt(4)
  ds_read_b128 v[76:79], v4 offset:18432
  v_smfmac_f32_16x16x64_bf16 v[16:19], v[84:87], a[72:79], v0
  s_waitcnt lgkmcnt(4)
  ds_read_b128 v[80:83], v4 offset:19456
  buffer_load_dwordx4 v10, s[4:7], s28 offen offset:256 sc1 lds
  v_smfmac_f32_16x16x64_bf16 v[16:19], v[88:91], a[112:119], v0
  s_waitcnt lgkmcnt(4)
  s_mov_b32 m0, 32256
  v_smfmac_f32_16x16x64_bf16 v[16:19], v[100:103], a[120:127], v0
  s_add_u32 s24, s36, 145752064
  s_add_u32 s25, s36, 145756160
  v_smfmac_f32_16x16x64_bf16 v[20:23], v[92:95], v[176:183], v0
  s_add_u32 s35, s36, s23
  v_smfmac_f32_16x16x64_bf16 v[20:23], v[96:99], v[184:191], v0
  s_waitcnt lgkmcnt(2)
  buffer_load_dword v3, s[4:7], s99 offen sc1 lds
  v_smfmac_f32_16x16x64_bf16 v[20:23], v[116:119], v[68:75], v0
  s_waitcnt lgkmcnt(0)
  ds_read_b128 v[68:71], v4 offset:20480
  v_mul_f32 v16, s18, v16
  v_smfmac_f32_16x16x64_bf16 v[20:23], v[124:127], v[76:83], v0
  ds_read_b128 v[72:75], v4 offset:21504
  v_mul_f32 v17, s18, v17
  v_smfmac_f32_16x16x64_bf16 v[20:23], v[104:107], a[32:39], v0
  ds_read_b128 v[76:79], v4 offset:22528
  v_mul_f32 v18, s18, v18
  v_smfmac_f32_16x16x64_bf16 v[20:23], v[108:111], a[40:47], v0
  ds_read_b128 v[80:83], v4 offset:23552
  v_mul_f32 v19, s18, v19
  v_smfmac_f32_16x16x64_bf16 v[20:23], v[112:115], a[80:87], v0
  v_cvt_pk_bf16_f32 v120, v16, v17
  v_smfmac_f32_16x16x64_bf16 v[20:23], v[84:87], a[88:95], v0
  v_cvt_pk_bf16_f32 v121, v18, v19
  v_smfmac_f32_16x16x64_bf16 v[20:23], v[88:91], a[128:135], v0
  ds_write_b64 v5, v[120:121] offset:24576
  v_smfmac_f32_16x16x64_bf16 v[20:23], v[100:103], a[136:143], v0
  s_waitcnt lgkmcnt(3)
  v_smfmac_f32_16x16x64_bf16 v[24:27], v[92:95], v[68:75], v0
  s_waitcnt lgkmcnt(1)
  v_mov_b64 v[92:93], 0
  v_smfmac_f32_16x16x64_bf16 v[24:27], v[96:99], v[76:83], v0
  s_nop 1
  v_cvt_pk_bf16_f32 v122, v20, v21
  v_cvt_pk_bf16_f32 v123, v22, v23
  v_smfmac_f32_16x16x64_bf16 v[24:27], v[116:119], v[208:215], v0
  ds_write_b64 v5, v[122:123] offset:26880
  v_mov_b64 v[94:95], 0
  v_smfmac_f32_16x16x64_bf16 v[24:27], v[124:127], v[216:223], v0
  s_waitcnt lgkmcnt(1)
  s_barrier
  ds_read_b64_tr_b16 v[68:69], v6 offset:24576
  v_smfmac_f32_16x16x64_bf16 v[24:27], v[104:107], a[48:55], v0
  s_add_u32 s27, s27, 8192
  ds_read_b64_tr_b16 v[70:71], v6 offset:24640
  ds_read_b64_tr_b16 v[72:73], v6 offset:24832
  v_smfmac_f32_16x16x64_bf16 v[24:27], v[108:111], a[56:63], v0
  s_add_u32 s28, s28, 8192
  ds_read_b64_tr_b16 v[74:75], v6 offset:24896
  ds_read_b64_tr_b16 v[76:77], v6 offset:25088
  v_smfmac_f32_16x16x64_bf16 v[24:27], v[112:115], a[96:103], v0
  s_nop 0
  ds_read_b64_tr_b16 v[78:79], v6 offset:25152
  ds_read_b64_tr_b16 v[80:81], v6 offset:25344
  v_smfmac_f32_16x16x64_bf16 v[24:27], v[84:87], a[104:111], v0
  ds_read_b64_tr_b16 v[82:83], v6 offset:25408
  v_mov_b64 v[96:97], 0
  v_smfmac_f32_16x16x64_bf16 v[24:27], v[88:91], a[144:151], v0
  s_waitcnt lgkmcnt(8)
  s_barrier
  ds_read_b64_tr_b16 v[116:117], v6 offset:26880
  v_smfmac_f32_16x16x64_bf16 v[24:27], v[100:103], a[152:159], v0
  s_waitcnt lgkmcnt(7)
  ds_read_b64_tr_b16 v[118:119], v6 offset:26944
  v_mfma_f32_16x16x32_bf16 v[16:19], v[36:39], v[68:71], 0
  s_waitcnt lgkmcnt(6)
  ds_read_b64_tr_b16 v[124:125], v6 offset:27136
  ds_read_b64_tr_b16 v[126:127], v6 offset:27200
  v_mfma_f32_16x16x32_bf16 v[16:19], v[40:43], v[72:75], v[16:19]
  s_waitcnt lgkmcnt(6)
  ds_read_b64_tr_b16 v[104:105], v6 offset:27392
  ds_read_b64_tr_b16 v[106:107], v6 offset:27456
  v_mfma_f32_16x16x32_bf16 v[16:19], v[44:47], v[76:79], v[16:19]
  s_waitcnt lgkmcnt(6)
  ds_read_b64_tr_b16 v[108:109], v6 offset:27648
  ds_read_b64_tr_b16 v[110:111], v6 offset:27712
  v_mfma_f32_16x16x32_bf16 v[16:19], v[48:51], v[80:83], v[16:19]
  s_waitcnt lgkmcnt(6)
  v_cvt_pk_bf16_f32 v120, v24, v25
  v_cvt_pk_bf16_f32 v121, v26, v27
  v_mfma_f32_16x16x32_bf16 v[112:115], v[116:119], v[68:71], 0
  s_waitcnt lgkmcnt(4)
  v_mov_b64 v[98:99], 0
  v_mfma_f32_16x16x32_bf16 v[112:115], v[124:127], v[72:75], v[112:115]
  s_waitcnt lgkmcnt(2)
  v_mov_b64 v[36:37], 0
  v_exp_f32 v100, v16
  v_mfma_f32_16x16x32_bf16 v[112:115], v[104:107], v[76:79], v[112:115]
  s_waitcnt lgkmcnt(0)
  v_exp_f32 v101, v17
  v_mfma_f32_16x16x32_bf16 v[112:115], v[108:111], v[80:83], v[112:115]
  buffer_store_dwordx4 v[120:123], v2, s[4:7], s29 offen offset:3072 sc1
  v_exp_f32 v102, v18
  v_mfma_f32_16x16x32_bf16 v[20:23], v[52:55], v[68:71], 0
  s_cmp_eq_u32 s14, 63
  v_exp_f32 v103, v19
  v_mfma_f32_16x16x32_bf16 v[20:23], v[56:59], v[72:75], v[20:23]
  s_cbranch_scc1 M_tdone
  v_cvt_pk_bf16_f32 v44, v100, v101
  v_cvt_pk_bf16_f32 v45, v102, v103
  v_mfma_f32_16x16x32_bf16 v[20:23], v[60:63], v[76:79], v[20:23]
  s_add_u32 s29, s29, 131072
  v_exp_f32 v100, v112
  v_mfma_f32_16x16x32_bf16 v[20:23], v[64:67], v[80:83], v[20:23]
  v_exp_f32 v101, v113
  v_exp_f32 v102, v114
  v_exp_f32 v103, v115
  v_cvt_pk_bf16_f32 v84, v100, v101
  v_cvt_pk_bf16_f32 v85, v102, v103
  v_cndmask_b32 v48, v84, 0, s[16:17]
  v_cndmask_b32 v49, v85, 0, s[16:17]
  v_cndmask_b32 v50, 0, v84, s[16:17]
  v_cndmask_b32 v51, 0, v85, s[16:17]
  v_exp_f32 v100, v20
  v_mfma_f32_16x16x16_bf16 v[88:91], v[12:13], v[48:49], 0
  v_exp_f32 v101, v21
  v_mfma_f32_16x16x16_bf16 v[24:27], v[120:121], v[48:49], 0
  v_exp_f32 v102, v22
  v_mfma_f32_16x16x16_bf16 v[116:119], v[120:121], v[50:51], 0
  v_exp_f32 v103, v23
  v_cvt_pk_bf16_f32 v46, v100, v101
  v_cvt_pk_bf16_f32 v47, v102, v103
  v_mov_b64 v[38:39], 0
  s_nop 0
  v_mfma_f32_16x16x32_bf16 v[88:91], v[12:15], v[44:47], v[88:91]
  v_mov_b64 v[40:41], 0
  v_mov_b64 v[42:43], 0
  v_mfma_f32_16x16x32_bf16 v[24:27], v[28:31], v[44:47], v[24:27]
  ds_read_b128 v[52:55], v4 offset:24576
  ds_read_b128 v[56:59], v4 offset:25600
  v_mfma_f32_16x16x32_bf16 v[116:119], v[32:35], v[44:47], v[116:119]
  s_nop 1
  v_rcp_f32 v89, v88
  v_subrev_u32 v100, s54, v88
  v_cmp_le_u32 vcc, s55, v100
  v_mul_f32 v24, v89, v24
  v_mul_f32 v25, v89, v25
  s_cbranch_vccnz T_slow_62
T_back_63:
  v_cvt_pk_bf16_f32 v124, v24, v25
  v_pk_mul_f32 v[26:27], v[26:27], v[88:89] op_sel:[0,1] op_sel_hi:[1,1]
  v_pk_mul_f32 v[116:117], v[116:117], v[88:89] op_sel:[0,1] op_sel_hi:[1,1]
  v_pk_mul_f32 v[118:119], v[118:119], v[88:89] op_sel:[0,1] op_sel_hi:[1,1]
  v_cvt_pk_bf16_f32 v125, v26, v27
  v_cvt_pk_bf16_f32 v126, v116, v117
  v_cvt_pk_bf16_f32 v127, v118, v119
  ds_write_b128 v11, v[124:127] offset:30720
  s_nop 0
  v_smfmac_f32_16x16x64_bf16 v[92:95], v[124:127], a[160:167], v0
  v_smfmac_f32_16x16x64_bf16 v[96:99], v[124:127], a[168:175], v0
  v_smfmac_f32_16x16x64_bf16 v[36:39], v[124:127], a[176:183], v0
  v_smfmac_f32_16x16x64_bf16 v[40:43], v[124:127], a[184:191], v0
  s_waitcnt lgkmcnt(0)
  s_barrier
  ds_read_b128 v[104:107], v11 offset:30208
  ds_read_b128 v[108:111], v11 offset:29696
  ds_read_b128 v[68:71], v11 offset:29184
  s_waitcnt lgkmcnt(2)
  v_smfmac_f32_16x16x64_bf16 v[92:95], v[104:107], a[192:199], v0
  s_waitcnt lgkmcnt(1)
  ds_read_b128 v[76:79], v4 offset:28672
  v_smfmac_f32_16x16x64_bf16 v[92:95], v[108:111], a[224:231], v0
  s_waitcnt lgkmcnt(1)
  ds_read_b128 v[80:83], v4 offset:29696
  v_smfmac_f32_16x16x64_bf16 v[92:95], v[68:71], a[240:247], v0
  ds_read_b128 v[60:63], v4 offset:26624
  v_smfmac_f32_16x16x64_bf16 v[96:99], v[104:107], a[200:207], v0
  ds_read_b128 v[64:67], v4 offset:27648
  v_smfmac_f32_16x16x64_bf16 v[96:99], v[108:111], a[232:239], v0
  ds_read_b128 v[28:31], v4 offset:30720
  s_nop 0
  v_cvt_pk_bf16_f32 v16, v92, v93
  v_cvt_pk_bf16_f32 v17, v94, v95
  v_bfi_b32 v16, 1, s57, v16
  v_smfmac_f32_16x16x64_bf16 v[96:99], v[68:71], a[248:255], v0
  buffer_store_dwordx2 v[16:17], v7, s[4:7], s20 offen offset:0
  v_smfmac_f32_16x16x64_bf16 v[36:39], v[104:107], a[208:215], v0
  ds_read_b128 v[32:35], v4 offset:31744
  v_smfmac_f32_16x16x64_bf16 v[36:39], v[108:111], v[52:59], v0
  s_waitcnt lgkmcnt(4)
  s_nop 0
  v_cvt_pk_bf16_f32 v18, v96, v97
  v_cvt_pk_bf16_f32 v19, v98, v99
  v_bfi_b32 v18, 1, s57, v18
  v_smfmac_f32_16x16x64_bf16 v[36:39], v[68:71], v[76:83], v0
  buffer_store_dwordx2 v[18:19], v7, s[4:7], s20 offen offset:64
  v_smfmac_f32_16x16x64_bf16 v[40:43], v[104:107], a[216:223], v0
  s_waitcnt lgkmcnt(2)
  v_smfmac_f32_16x16x64_bf16 v[40:43], v[108:111], v[60:67], v0
  s_waitcnt lgkmcnt(0)
  s_nop 0
  v_cvt_pk_bf16_f32 v20, v36, v37
  v_cvt_pk_bf16_f32 v21, v38, v39
  v_bfi_b32 v20, 1, s57, v20
  v_smfmac_f32_16x16x64_bf16 v[40:43], v[68:71], v[28:35], v0
  buffer_store_dwordx2 v[20:21], v7, s[4:7], s21 offen offset:0
  s_nop 6
  v_cvt_pk_bf16_f32 v22, v40, v41
  v_cvt_pk_bf16_f32 v23, v42, v43
  v_bfi_b32 v22, 1, s57, v22
  buffer_store_dwordx2 v[22:23], v7, s[4:7], s21 offen offset:64
  ds_read_b128 v[68:71], v4 offset:0
  ds_read_b128 v[72:75], v4 offset:1024
  ds_read_b128 v[76:79], v4 offset:4096
  ds_read_b128 v[80:83], v4 offset:5120
  ds_read_b128 v[84:87], v4 offset:8192
  ds_read_b128 v[88:91], v4 offset:9216
  ds_read_b128 v[92:95], v4 offset:2048
  ds_read_b128 v[96:99], v4 offset:3072
  ds_read_b128 v[100:103], v4 offset:6144
  ds_read_b128 v[104:107], v4 offset:7168
  ds_read_b128 v[108:111], v4 offset:10240
  ds_read_b128 v[112:115], v4 offset:11264
  v_mov_b64 v[16:17], 0
  v_mov_b64 v[18:19], 0
  v_mov_b64 v[20:21], 0
  v_mov_b64 v[22:23], 0
  v_mov_b64 v[24:25], 0
  v_mov_b64 v[26:27], 0
  ds_read_b64 v[44:45], v2 offset:32256
  s_waitcnt lgkmcnt(0)
  v_readfirstlane_b32 s38, v44
  v_readfirstlane_b32 s37, v45
  s_nop 0
  s_add_u32 s37, s37, 30
  s_cmp_ge_u32 s38, 30
  s_cselect_b32 s38, s37, s38
  s_cmp_ge_u32 s38, 64
  s_cselect_b32 s38, 100, s38
  s_sub_u32 s38, s38, 1
  s_max_i32 s30, s30, s38
  s_waitcnt vmcnt(4)
  s_barrier
  ds_read_b128 v[28:31], v2 offset:19456
  ds_read_b128 v[32:35], v2 offset:23552
  ds_read_b128 v[36:39], v2 offset:8192
  ds_read_b128 v[40:43], v2 offset:9216
  ds_read_b128 v[44:47], v2 offset:10240
  ds_read_b128 v[48:51], v2 offset:11264
  buffer_load_dwordx4 v[124:127], v2, s[4:7], s24 offen offset:3072 sc1
  buffer_load_dwordx4 v[116:119], v2, s[4:7], s25 offen offset:3072 sc1
  ds_read_b128 v[52:55], v2 offset:12288
  ds_read_b128 v[56:59], v2 offset:13312
  ds_read_b128 v[60:63], v2 offset:14336
  ds_read_b128 v[64:67], v2 offset:15360
  buffer_load_dwordx4 v[124:127], v2, s[4:7], s24 offen offset:3072 sc1
  buffer_load_dwordx4 v[116:119], v2, s[4:7], s25 offen offset:3072 sc1
  s_mov_b32 s19, 0
  s_branch T_loop_55
T_kvw_59:
  s_mov_b32 s19, 0
  s_branch T_kvok_68
T_kv_67:
  s_sleep 4
  s_add_u32 s19, s19, 1
  s_cmp_gt_u32 s19, 32768
  s_cbranch_scc1 M_exit
T_kvok_68:
  s_add_u32 s39, s99, 128
  s_mov_b32 s38, 0
  s_mov_b32 s37, 0
  s_atomic_or s38, s[58:59], s99 glc
  s_atomic_or s37, s[58:59], s39 glc
  s_waitcnt lgkmcnt(0)
  s_add_u32 s37, s37, 30
  s_cmp_ge_u32 s38, 30
  s_cselect_b32 s38, s37, s38
  s_cmp_ge_u32 s38, 64
  s_cselect_b32 s38, 100, s38
  s_sub_u32 s38, s38, 1
  s_max_i32 s30, s30, s38
  s_cmp_ge_i32 s14, s30
  s_cbranch_scc1 T_kv_67
  s_branch T_kvb_60
T_slow_62:
  s_nop 7
  v_max3_f32 v100, v16, v17, v18
  v_max3_f32 v100, v100, v19, v20
  v_max3_f32 v100, v100, v21, v22
  v_max3_f32 v100, v100, v23, v112
  v_max3_f32 v100, v100, v113, v114
  v_max_f32 v100, v100, v115
  v_mov_b32 v101, v100
  s_nop 1
  v_permlane32_swap_b32 v100, v101
  s_nop 1
  v_max_f32 v100, v100, v101
  v_mov_b32 v101, v100
  s_nop 1
  v_permlane16_swap_b32 v100, v101
  s_nop 1
  v_max_f32 v100, v100, v101
  v_sub_f32 v16, v16, v100
  v_sub_f32 v17, v17, v100
  v_sub_f32 v18, v18, v100
  v_sub_f32 v19, v19, v100
  v_exp_f32 v16, v16
  v_exp_f32 v17, v17
  v_exp_f32 v18, v18
  v_exp_f32 v19, v19
  v_sub_f32 v20, v20, v100
  v_sub_f32 v21, v21, v100
  v_sub_f32 v22, v22, v100
  v_sub_f32 v23, v23, v100
  v_exp_f32 v20, v20
  v_exp_f32 v21, v21
  v_exp_f32 v22, v22
  v_exp_f32 v23, v23
  v_sub_f32 v112, v112, v100
  v_sub_f32 v113, v113, v100
  v_sub_f32 v114, v114, v100
  v_sub_f32 v115, v115, v100
  v_exp_f32 v112, v112
  v_exp_f32 v113, v113
  v_exp_f32 v114, v114
  v_exp_f32 v115, v115
  s_nop 0
  v_cvt_pk_bf16_f32 v44, v16, v17
  v_cvt_pk_bf16_f32 v45, v18, v19
  v_cvt_pk_bf16_f32 v46, v20, v21
  v_cvt_pk_bf16_f32 v47, v22, v23
  v_cvt_pk_bf16_f32 v84, v112, v113
  v_cvt_pk_bf16_f32 v85, v114, v115
  v_cndmask_b32 v48, v84, 0, s[16:17]
  v_cndmask_b32 v49, v85, 0, s[16:17]
  v_cndmask_b32 v50, 0, v84, s[16:17]
  v_cndmask_b32 v51, 0, v85, s[16:17]
  s_nop 1
  v_mfma_f32_16x16x16_bf16 v[88:91], v[12:13], v[48:49], 0
  v_mfma_f32_16x16x16_bf16 v[24:27], v[120:121], v[48:49], 0
  v_mfma_f32_16x16x16_bf16 v[116:119], v[120:121], v[50:51], 0
  v_mfma_f32_16x16x32_bf16 v[88:91], v[12:15], v[44:47], v[88:91]
  v_mfma_f32_16x16x32_bf16 v[24:27], v[28:31], v[44:47], v[24:27]
  v_mfma_f32_16x16x32_bf16 v[116:119], v[32:35], v[44:47], v[116:119]
  s_nop 7
  s_nop 1
  v_rcp_f32 v89, v88
  s_nop 0
  v_mul_f32 v24, v89, v24
  v_mul_f32 v25, v89, v25
  s_branch T_back_63
M_global:
  s_cmp_eq_u32 s13, 1
  s_cbranch_scc1 T_w_70
  s_cmp_eq_u32 s13, 2
  s_cbranch_scc1 T_w_71
  s_cmp_eq_u32 s13, 3
  s_cbranch_scc1 T_w_72
T_w_69:
  s_mov_b32 s19, 0
  v_mov_b64 v[16:17], 0
  v_mov_b64 v[18:19], 0
  v_mov_b64 v[20:21], 0
  v_mov_b64 v[22:23], 0
  v_mov_b64 v[24:25], 0
  v_mov_b64 v[26:27], 0
  buffer_load_dwordx4 v[124:127], v2, s[4:7], s24 offen offset:0 sc1
  buffer_load_dwordx4 v[116:119], v2, s[4:7], s25 offen offset:0 sc1
  buffer_load_dwordx4 v[124:127], v2, s[4:7], s24 offen offset:0 sc1
  buffer_load_dwordx4 v[116:119], v2, s[4:7], s25 offen offset:0 sc1
  s_branch T_loop_73
.p2align 6
T_retry_74:
  s_mov_b64 exec, vcc
  buffer_load_dwordx4 v[124:127], v2, s[4:7], s24 offen offset:0 sc1
  buffer_load_dwordx4 v[116:119], v2, s[4:7], s25 offen offset:0 sc1
  s_mov_b64 exec, -1
  s_add_u32 s19, s19, 1
  s_cmp_gt_u32 s19, 32768
  s_cbranch_scc1 M_exit
T_loop_73:
  s_waitcnt vmcnt(3) lgkmcnt(0)
  v_max3_u32 v123, v124, v125, v126
  v_max_u32 v123, v123, v127
  v_mov_b32_dpp v120, v124 row_ror:8 row_mask:0xf bank_mask:0xf
  v_mov_b32_dpp v121, v125 row_ror:8 row_mask:0xf bank_mask:0xf
  s_waitcnt vmcnt(2)
  v_max3_u32 v123, v123, v116, v117
  v_max3_u32 v123, v123, v118, v119
  v_cmp_eq_u32 vcc, -1, v123
  s_cbranch_vccnz T_retry_74
  v_smfmac_f32_16x16x64_bf16 v[16:19], v[124:127], v[68:75], v0
  s_add_u32 s14, s14, 1
  ds_write_b128 v2, v[124:127] offset:0
  v_mov_b32_dpp v122, v126 row_ror:8 row_mask:0xf bank_mask:0xf
  v_smfmac_f32_16x16x64_bf16 v[20:23], v[124:127], v[76:83], v0
  s_and_b32 s57, s14, 1
  v_mov_b32_dpp v123, v127 row_ror:8 row_mask:0xf bank_mask:0xf
  v_smfmac_f32_16x16x64_bf16 v[24:27], v[124:127], v[84:91], v0
  s_and_b32 s36, s14, 3
  ds_write_b128 v2, v[116:119] offset:4096
  v_smfmac_f32_16x16x64_bf16 v[16:19], v[120:123], v[92:99], v0
  s_lshl_b32 s36, s36, 13
  v_mov_b32_dpp v84, v116 row_ror:8 row_mask:0xf bank_mask:0xf
  v_smfmac_f32_16x16x64_bf16 v[20:23], v[120:123], v[100:107], v0
  s_add_u32 s26, s36, s23
  ds_read_b128 v[68:71], v4 offset:12288
  v_mov_b32_dpp v85, v117 row_ror:8 row_mask:0xf bank_mask:0xf
  v_smfmac_f32_16x16x64_bf16 v[24:27], v[120:123], v[108:115], v0
  s_add_u32 s36, s36, 8192
  ds_read_b128 v[72:75], v4 offset:13312
  v_mov_b32_dpp v86, v118 row_ror:8 row_mask:0xf bank_mask:0xf
  v_smfmac_f32_16x16x64_bf16 v[16:19], v[116:119], v[224:231], v0
  s_and_b32 s36, s36, 0x7fff
  ds_read_b128 v[76:79], v4 offset:14336
  v_mov_b32_dpp v87, v119 row_ror:8 row_mask:0xf bank_mask:0xf
  v_smfmac_f32_16x16x64_bf16 v[20:23], v[116:119], v[240:247], v0
  s_waitcnt lgkmcnt(3)
  s_barrier
  ds_read_b128 v[100:103], v2 offset:1024
  v_smfmac_f32_16x16x64_bf16 v[24:27], v[116:119], a[0:7], v0
  s_mov_b32 m0, s31
  ds_read_b128 v[120:123], v1 offset:1024
  v_smfmac_f32_16x16x64_bf16 v[16:19], v[84:87], v[232:239], v0
  s_cmp_ge_i32 s14, s30
  s_cbranch_scc1 T_kvw_77
T_kvb_78:
  v_smfmac_f32_16x16x64_bf16 v[20:23], v[84:87], v[248:255], v0
  ds_read_b128 v[80:83], v4 offset:15360
  buffer_load_dwordx4 v9, s[4:7], s27 offen sc1 lds
  v_smfmac_f32_16x16x64_bf16 v[24:27], v[84:87], a[8:15], v0
  s_waitcnt lgkmcnt(2)
  s_mov_b32 m0, s32
  v_smfmac_f32_16x16x64_bf16 v[16:19], v[100:103], v[128:135], v0
  ds_read_b128 v[92:95], v2 offset:2048
  v_smfmac_f32_16x16x64_bf16 v[20:23], v[100:103], v[144:151], v0
  ds_read_b128 v[96:99], v1 offset:2048
  v_smfmac_f32_16x16x64_bf16 v[24:27], v[100:103], v[68:75], v0
  s_waitcnt vmcnt(1) lgkmcnt(3)
  ds_read_b128 v[116:119], v2 offset:3072
  buffer_load_dwordx4 v9, s[4:7], s27 offen offset:128 sc1 lds
  v_smfmac_f32_16x16x64_bf16 v[16:19], v[120:123], v[136:143], v0
  ds_read_b128 v[124:127], v1 offset:3072
  s_mov_b32 m0, s33
  v_smfmac_f32_16x16x64_bf16 v[20:23], v[120:123], v[152:159], v0
  s_waitcnt lgkmcnt(4)
  ds_read_b128 v[104:107], v2 offset:5120
  v_smfmac_f32_16x16x64_bf16 v[24:27], v[120:123], v[76:83], v0
  s_waitcnt lgkmcnt(4)
  ds_read_b128 v[108:111], v1 offset:5120
  v_smfmac_f32_16x16x64_bf16 v[16:19], v[92:95], v[160:167], v0
  s_waitcnt lgkmcnt(4)
  ds_read_b128 v[112:115], v2 offset:6144
  buffer_load_dwordx4 v10, s[4:7], s28 offen sc1 lds
  v_smfmac_f32_16x16x64_bf16 v[16:19], v[96:99], v[168:175], v0
  s_waitcnt lgkmcnt(4)
  ds_read_b128 v[84:87], v1 offset:6144
  s_mov_b32 m0, s34
  v_smfmac_f32_16x16x64_bf16 v[16:19], v[116:119], v[192:199], v0
  s_waitcnt lgkmcnt(4)
  ds_read_b128 v[88:91], v2 offset:7168
  v_smfmac_f32_16x16x64_bf16 v[16:19], v[124:127], v[200:207], v0
  s_waitcnt lgkmcnt(4)
  ds_read_b128 v[100:103], v1 offset:7168
  v_smfmac_f32_16x16x64_bf16 v[16:19], v[104:107], a[16:23], v0
  s_waitcnt lgkmcnt(4)
  ds_read_b128 v[68:71], v4 offset:16384
  buffer_load_dwordx4 v10, s[4:7], s28 offen offset:256 sc1 lds
  v_smfmac_f32_16x16x64_bf16 v[16:19], v[108:111], a[24:31], v0
  s_waitcnt lgkmcnt(4)
  ds_read_b128 v[72:75], v4 offset:17408
  v_smfmac_f32_16x16x64_bf16 v[16:19], v[112:115], a[64:71], v0
  s_waitcnt lgkmcnt(4)
  ds_read_b128 v[76:79], v4 offset:18432
  v_smfmac_f32_16x16x64_bf16 v[16:19], v[84:87], a[72:79], v0
  s_waitcnt lgkmcnt(4)
  ds_read_b128 v[80:83], v4 offset:19456
  v_smfmac_f32_16x16x64_bf16 v[16:19], v[88:91], a[112:119], v0
  s_waitcnt lgkmcnt(4)
  v_smfmac_f32_16x16x64_bf16 v[16:19], v[100:103], a[120:127], v0
  s_add_u32 s24, s36, 145752064
  s_add_u32 s25, s36, 145756160
  v_smfmac_f32_16x16x64_bf16 v[20:23], v[92:95], v[176:183], v0
  s_add_u32 s35, s36, s23
  v_smfmac_f32_16x16x64_bf16 v[20:23], v[96:99], v[184:191], v0
  s_waitcnt lgkmcnt(2)
  v_smfmac_f32_16x16x64_bf16 v[20:23], v[116:119], v[68:75], v0
  s_waitcnt lgkmcnt(0)
  ds_read_b128 v[68:71], v4 offset:20480
  v_mul_f32 v16, s18, v16
  v_smfmac_f32_16x16x64_bf16 v[20:23], v[124:127], v[76:83], v0
  ds_read_b128 v[72:75], v4 offset:21504
  v_mul_f32 v17, s18, v17
  v_smfmac_f32_16x16x64_bf16 v[20:23], v[104:107], a[32:39], v0
  ds_read_b128 v[76:79], v4 offset:22528
  v_mul_f32 v18, s18, v18
  v_smfmac_f32_16x16x64_bf16 v[20:23], v[108:111], a[40:47], v0
  ds_read_b128 v[80:83], v4 offset:23552
  v_mul_f32 v19, s18, v19
  v_smfmac_f32_16x16x64_bf16 v[20:23], v[112:115], a[80:87], v0
  v_cvt_pk_bf16_f32 v120, v16, v17
  v_smfmac_f32_16x16x64_bf16 v[20:23], v[84:87], a[88:95], v0
  v_cvt_pk_bf16_f32 v121, v18, v19
  v_smfmac_f32_16x16x64_bf16 v[20:23], v[88:91], a[128:135], v0
  ds_write_b64 v5, v[120:121] offset:24576
  v_smfmac_f32_16x16x64_bf16 v[20:23], v[100:103], a[136:143], v0
  s_waitcnt lgkmcnt(3)
  v_smfmac_f32_16x16x64_bf16 v[24:27], v[92:95], v[68:75], v0
  s_waitcnt lgkmcnt(1)
  v_mov_b64 v[92:93], 0
  v_smfmac_f32_16x16x64_bf16 v[24:27], v[96:99], v[76:83], v0
  s_nop 1
  v_cvt_pk_bf16_f32 v122, v20, v21
  v_cvt_pk_bf16_f32 v123, v22, v23
  v_smfmac_f32_16x16x64_bf16 v[24:27], v[116:119], v[208:215], v0
  ds_write_b64 v5, v[122:123] offset:26880
  v_mov_b64 v[94:95], 0
  v_smfmac_f32_16x16x64_bf16 v[24:27], v[124:127], v[216:223], v0
  s_waitcnt lgkmcnt(1)
  s_barrier
  ds_read_b64_tr_b16 v[68:69], v6 offset:24576
  v_smfmac_f32_16x16x64_bf16 v[24:27], v[104:107], a[48:55], v0
  s_add_u32 s27, s27, 8192
  ds_read_b64_tr_b16 v[70:71], v6 offset:24640
  ds_read_b64_tr_b16 v[72:73], v6 offset:24832
  v_smfmac_f32_16x16x64_bf16 v[24:27], v[108:111], a[56:63], v0
  s_add_u32 s28, s28, 8192
  ds_read_b64_tr_b16 v[74:75], v6 offset:24896
  ds_read_b64_tr_b16 v[76:77], v6 offset:25088
  v_smfmac_f32_16x16x64_bf16 v[24:27], v[112:115], a[96:103], v0
  s_nop 0
  ds_read_b64_tr_b16 v[78:79], v6 offset:25152
  ds_read_b64_tr_b16 v[80:81], v6 offset:25344
  v_smfmac_f32_16x16x64_bf16 v[24:27], v[84:87], a[104:111], v0
  ds_read_b64_tr_b16 v[82:83], v6 offset:25408
  v_mov_b64 v[96:97], 0
  v_smfmac_f32_16x16x64_bf16 v[24:27], v[88:91], a[144:151], v0
  s_waitcnt lgkmcnt(8)
  s_barrier
  ds_read_b64_tr_b16 v[116:117], v6 offset:26880
  v_smfmac_f32_16x16x64_bf16 v[24:27], v[100:103], a[152:159], v0
  s_waitcnt lgkmcnt(7)
  ds_read_b64_tr_b16 v[118:119], v6 offset:26944
  v_mfma_f32_16x16x32_bf16 v[16:19], v[36:39], v[68:71], 0
  s_waitcnt lgkmcnt(6)
  ds_read_b64_tr_b16 v[124:125], v6 offset:27136
  ds_read_b64_tr_b16 v[126:127], v6 offset:27200
  v_mfma_f32_16x16x32_bf16 v[16:19], v[40:43], v[72:75], v[16:19]
  s_waitcnt lgkmcnt(6)
  ds_read_b64_tr_b16 v[104:105], v6 offset:27392
  ds_read_b64_tr_b16 v[106:107], v6 offset:27456
  v_mfma_f32_16x16x32_bf16 v[16:19], v[44:47], v[76:79], v[16:19]
  s_waitcnt lgkmcnt(6)
  ds_read_b64_tr_b16 v[108:109], v6 offset:27648
  ds_read_b64_tr_b16 v[110:111], v6 offset:27712
  v_mfma_f32_16x16x32_bf16 v[16:19], v[48:51], v[80:83], v[16:19]
  s_waitcnt lgkmcnt(6)
  v_cvt_pk_bf16_f32 v120, v24, v25
  v_cvt_pk_bf16_f32 v121, v26, v27
  v_mfma_f32_16x16x32_bf16 v[112:115], v[116:119], v[68:71], 0
  s_waitcnt lgkmcnt(4)
  buffer_store_dwordx4 v[120:123], v2, s[4:7], s29 offen offset:0 sc1
  v_mov_b64 v[98:99], 0
  v_mfma_f32_16x16x32_bf16 v[112:115], v[124:127], v[72:75], v[112:115]
  s_waitcnt lgkmcnt(2)
  v_mov_b64 v[36:37], 0
  v_exp_f32 v100, v16
  v_mfma_f32_16x16x32_bf16 v[112:115], v[104:107], v[76:79], v[112:115]
  s_waitcnt lgkmcnt(0)
  v_exp_f32 v101, v17
  v_mfma_f32_16x16x32_bf16 v[112:115], v[108:111], v[80:83], v[112:115]
  v_exp_f32 v102, v18
  v_mfma_f32_16x16x32_bf16 v[20:23], v[52:55], v[68:71], 0
  s_cmp_eq_u32 s14, 63
  v_exp_f32 v103, v19
  v_mfma_f32_16x16x32_bf16 v[20:23], v[56:59], v[72:75], v[20:23]
  s_cbranch_scc1 M_tdone
  v_cvt_pk_bf16_f32 v44, v100, v101
  v_cvt_pk_bf16_f32 v45, v102, v103
  v_mfma_f32_16x16x32_bf16 v[20:23], v[60:63], v[76:79], v[20:23]
  s_add_u32 s29, s29, 131072
  v_exp_f32 v100, v112
  v_mfma_f32_16x16x32_bf16 v[20:23], v[64:67], v[80:83], v[20:23]
  v_exp_f32 v101, v113
  v_exp_f32 v102, v114
  v_exp_f32 v103, v115
  v_cvt_pk_bf16_f32 v84, v100, v101
  v_cvt_pk_bf16_f32 v85, v102, v103
  v_cndmask_b32 v48, v84, 0, s[16:17]
  v_cndmask_b32 v49, v85, 0, s[16:17]
  v_cndmask_b32 v50, 0, v84, s[16:17]
  v_cndmask_b32 v51, 0, v85, s[16:17]
  v_exp_f32 v100, v20
  v_mfma_f32_16x16x16_bf16 v[88:91], v[12:13], v[48:49], 0
  v_exp_f32 v101, v21
  v_mfma_f32_16x16x16_bf16 v[24:27], v[120:121], v[48:49], 0
  v_exp_f32 v102, v22
  v_mfma_f32_16x16x16_bf16 v[116:119], v[120:121], v[50:51], 0
  v_exp_f32 v103, v23
  v_cvt_pk_bf16_f32 v46, v100, v101
  v_cvt_pk_bf16_f32 v47, v102, v103
  v_mov_b64 v[38:39], 0
  s_nop 0
  v_mfma_f32_16x16x32_bf16 v[88:91], v[12:15], v[44:47], v[88:91]
  v_mov_b64 v[40:41], 0
  v_mov_b64 v[42:43], 0
  v_mfma_f32_16x16x32_bf16 v[24:27], v[28:31], v[44:47], v[24:27]
  ds_read_b128 v[52:55], v4 offset:24576
  ds_read_b128 v[56:59], v4 offset:25600
  v_mfma_f32_16x16x32_bf16 v[116:119], v[32:35], v[44:47], v[116:119]
  s_nop 1
  v_rcp_f32 v89, v88
  v_subrev_u32 v100, s54, v88
  v_cmp_le_u32 vcc, s55, v100
  v_mul_f32 v24, v89, v24
  v_mul_f32 v25, v89, v25
  s_cbranch_vccnz T_slow_80
T_back_81:
  v_cvt_pk_bf16_f32 v124, v24, v25
  v_pk_mul_f32 v[26:27], v[26:27], v[88:89] op_sel:[0,1] op_sel_hi:[1,1]
  v_pk_mul_f32 v[116:117], v[116:117], v[88:89] op_sel:[0,1] op_sel_hi:[1,1]
  v_pk_mul_f32 v[118:119], v[118:119], v[88:89] op_sel:[0,1] op_sel_hi:[1,1]
  v_cvt_pk_bf16_f32 v125, v26, v27
  v_cvt_pk_bf16_f32 v126, v116, v117
  v_cvt_pk_bf16_f32 v127, v118, v119
  ds_write_b128 v11, v[124:127] offset:29184
  s_nop 0
  v_smfmac_f32_16x16x64_bf16 v[92:95], v[124:127], a[160:167], v0
  v_smfmac_f32_16x16x64_bf16 v[96:99], v[124:127], a[168:175], v0
  v_smfmac_f32_16x16x64_bf16 v[36:39], v[124:127], a[176:183], v0
  v_smfmac_f32_16x16x64_bf16 v[40:43], v[124:127], a[184:191], v0
  s_waitcnt lgkmcnt(0)
  s_barrier
  ds_read_b128 v[104:107], v11 offset:29696
  ds_read_b128 v[108:111], v11 offset:30208
  ds_read_b128 v[68:71], v11 offset:30720
  s_waitcnt lgkmcnt(2)
  v_smfmac_f32_16x16x64_bf16 v[92:95], v[104:107], a[192:199], v0
  s_waitcnt lgkmcnt(1)
  ds_read_b128 v[76:79], v4 offset:28672
  v_smfmac_f32_16x16x64_bf16 v[92:95], v[108:111], a[224:231], v0
  s_waitcnt lgkmcnt(1)
  ds_read_b128 v[80:83], v4 offset:29696
  v_smfmac_f32_16x16x64_bf16 v[92:95], v[68:71], a[240:247], v0
  ds_read_b128 v[60:63], v4 offset:26624
  v_smfmac_f32_16x16x64_bf16 v[96:99], v[104:107], a[200:207], v0
  ds_read_b128 v[64:67], v4 offset:27648
  v_smfmac_f32_16x16x64_bf16 v[96:99], v[108:111], a[232:239], v0
  ds_read_b128 v[28:31], v4 offset:30720
  s_nop 0
  v_cvt_pk_bf16_f32 v16, v92, v93
  v_cvt_pk_bf16_f32 v17, v94, v95
  v_bfi_b32 v16, 1, s57, v16
  v_smfmac_f32_16x16x64_bf16 v[96:99], v[68:71], a[248:255], v0
  buffer_store_dwordx2 v[16:17], v7, s[4:7], s20 offen offset:0 sc1
  v_smfmac_f32_16x16x64_bf16 v[36:39], v[104:107], a[208:215], v0
  ds_read_b128 v[32:35], v4 offset:31744
  v_smfmac_f32_16x16x64_bf16 v[36:39], v[108:111], v[52:59], v0
  s_waitcnt lgkmcnt(4)
  s_nop 0
  v_cvt_pk_bf16_f32 v18, v96, v97
  v_cvt_pk_bf16_f32 v19, v98, v99
  v_bfi_b32 v18, 1, s57, v18
  v_smfmac_f32_16x16x64_bf16 v[36:39], v[68:71], v[76:83], v0
  buffer_store_dwordx2 v[18:19], v7, s[4:7], s20 offen offset:64 sc1
  v_smfmac_f32_16x16x64_bf16 v[40:43], v[104:107], a[216:223], v0
  s_waitcnt lgkmcnt(2)
  ds_read_b128 v[116:119], v2 offset:31232
  v_smfmac_f32_16x16x64_bf16 v[40:43], v[108:111], v[60:67], v0
  s_waitcnt lgkmcnt(1)
  s_nop 0
  v_cvt_pk_bf16_f32 v20, v36, v37
  v_cvt_pk_bf16_f32 v21, v38, v39
  v_bfi_b32 v20, 1, s57, v20
  v_smfmac_f32_16x16x64_bf16 v[40:43], v[68:71], v[28:35], v0
  buffer_store_dwordx2 v[20:21], v7, s[4:7], s21 offen offset:0 sc1
  s_nop 6
  v_cvt_pk_bf16_f32 v22, v40, v41
  v_cvt_pk_bf16_f32 v23, v42, v43
  v_bfi_b32 v22, 1, s57, v22
  buffer_store_dwordx2 v[22:23], v7, s[4:7], s21 offen offset:64 sc1
  ds_read_b128 v[68:71], v4 offset:0
  ds_read_b128 v[72:75], v4 offset:1024
  ds_read_b128 v[76:79], v4 offset:4096
  ds_read_b128 v[80:83], v4 offset:5120
  ds_read_b128 v[84:87], v4 offset:8192
  ds_read_b128 v[88:91], v4 offset:9216
  v_mov_b64 v[16:17], 0
  v_mov_b64 v[18:19], 0
  v_mov_b64 v[20:21], 0
  v_mov_b64 v[22:23], 0
  v_mov_b64 v[24:25], 0
  v_mov_b64 v[26:27], 0
  s_mov_b32 s19, 0
  v_mov_b32 v49, -1
  s_waitcnt vmcnt(2)
  buffer_load_dwordx4 v[52:55], v2, s[4:7], s22 offen offset:0 sc1
  buffer_load_dwordx4 v[56:59], v2, s[4:7], s22 offen offset:1024 sc1
  buffer_load_dwordx4 v[60:63], v2, s[4:7], s22 offen offset:2048 sc1
  buffer_load_dwordx4 v[64:67], v2, s[4:7], s22 offen offset:3072 sc1
  ds_read_b128 v[92:95], v4 offset:2048
  ds_read_b128 v[96:99], v4 offset:3072
  ds_read_b128 v[100:103], v4 offset:6144
  ds_read_b128 v[104:107], v4 offset:7168
  ds_read_b128 v[108:111], v4 offset:10240
  ds_read_b128 v[112:115], v4 offset:11264
  ds_read_b64 v[44:45], v2 offset:32256
  s_waitcnt lgkmcnt(0)
  v_readfirstlane_b32 s38, v44
  v_readfirstlane_b32 s37, v45
  s_nop 0
  s_add_u32 s37, s37, 30
  s_cmp_ge_u32 s38, 30
  s_cselect_b32 s38, s37, s38
  s_cmp_ge_u32 s38, 64
  s_cselect_b32 s38, 100, s38
  s_sub_u32 s38, s38, 1
  s_max_i32 s30, s30, s38
  s_waitcnt lgkmcnt(12)
  s_waitcnt vmcnt(3)
  v_mfma_f32_16x16x32_bf16 v[120:123], v[116:119], v[52:55], 0
  v_xor_b32 v48, s57, v52
  v_bitop3_b32 v48, v48, v54, s57 bitop3:0xf6
  s_waitcnt vmcnt(2)
  v_mfma_f32_16x16x32_bf16 v[120:123], v[116:119], v[56:59], v[120:123]
  v_bitop3_b32 v48, v48, v56, s57 bitop3:0xf6
  v_bitop3_b32 v48, v48, v58, s57 bitop3:0xf6
  s_waitcnt vmcnt(1)
  v_mfma_f32_16x16x32_bf16 v[120:123], v[116:119], v[60:63], v[120:123]
  v_bitop3_b32 v48, v48, v60, s57 bitop3:0xf6
  v_bitop3_b32 v48, v48, v62, s57 bitop3:0xf6
  s_waitcnt vmcnt(0)
  v_mfma_f32_16x16x32_bf16 v[120:123], v[116:119], v[64:67], v[120:123]
  v_bitop3_b32 v48, v48, v64, s57 bitop3:0xf6
  v_bitop3_b32 v48, v48, v66, s57 bitop3:0xf6
  v_and_b32 v48, 1, v48
  v_cmp_ne_u32 vcc, 0, v48
  s_cbranch_vccnz T_p1re_83
T_p1ok_84:
  s_nop 2
  v_add_f32_dpp v120, v120, v120 row_ror:8 row_mask:0xf bank_mask:0xf
  v_add_f32_dpp v121, v121, v121 row_ror:8 row_mask:0xf bank_mask:0xf
  v_cvt_pk_bf16_f32 v48, v120, v121
  buffer_store_dword v48, v8, s[4:7], s35 offen sc1
  buffer_store_dword v49, v8, s[4:7], s26 offen sc1
  s_barrier
  ds_read_b128 v[28:31], v2 offset:16384
  ds_read_b128 v[32:35], v2 offset:20480
  ds_read_b128 v[36:39], v2 offset:8192
  ds_read_b128 v[40:43], v2 offset:9216
  ds_read_b128 v[44:47], v2 offset:10240
  ds_read_b128 v[48:51], v2 offset:11264
  buffer_load_dwordx4 v[124:127], v2, s[4:7], s24 offen offset:0 sc1
  buffer_load_dwordx4 v[116:119], v2, s[4:7], s25 offen offset:0 sc1
  ds_read_b128 v[52:55], v2 offset:12288
  ds_read_b128 v[56:59], v2 offset:13312
  ds_read_b128 v[60:63], v2 offset:14336
  ds_read_b128 v[64:67], v2 offset:15360
  buffer_load_dwordx4 v[124:127], v2, s[4:7], s24 offen offset:0 sc1
  buffer_load_dwordx4 v[116:119], v2, s[4:7], s25 offen offset:0 sc1
  s_mov_b32 s19, 0
  s_branch T_loop_73
T_p1re_83:
  s_mov_b64 exec, vcc
  buffer_load_dwordx4 v[52:55], v2, s[4:7], s22 offen offset:0 sc1
  buffer_load_dwordx4 v[56:59], v2, s[4:7], s22 offen offset:1024 sc1
  buffer_load_dwordx4 v[60:63], v2, s[4:7], s22 offen offset:2048 sc1
  buffer_load_dwordx4 v[64:67], v2, s[4:7], s22 offen offset:3072 sc1
  s_mov_b64 exec, -1
  s_add_u32 s19, s19, 1
  s_cmp_gt_u32 s19, 32768
  s_cbranch_scc1 M_exit
  s_waitcnt vmcnt(3)
  v_mfma_f32_16x16x32_bf16 v[120:123], v[116:119], v[52:55], 0
  v_xor_b32 v48, s57, v52
  v_bitop3_b32 v48, v48, v54, s57 bitop3:0xf6
  s_waitcnt vmcnt(2)
  v_mfma_f32_16x16x32_bf16 v[120:123], v[116:119], v[56:59], v[120:123]
  v_bitop3_b32 v48, v48, v56, s57 bitop3:0xf6
  v_bitop3_b32 v48, v48, v58, s57 bitop3:0xf6
  s_waitcnt vmcnt(1)
  v_mfma_f32_16x16x32_bf16 v[120:123], v[116:119], v[60:63], v[120:123]
  v_bitop3_b32 v48, v48, v60, s57 bitop3:0xf6
  v_bitop3_b32 v48, v48, v62, s57 bitop3:0xf6
  s_waitcnt vmcnt(0)
  v_mfma_f32_16x16x32_bf16 v[120:123], v[116:119], v[64:67], v[120:123]
  v_bitop3_b32 v48, v48, v64, s57 bitop3:0xf6
  v_bitop3_b32 v48, v48, v66, s57 bitop3:0xf6
  v_and_b32 v48, 1, v48
  v_cmp_ne_u32 vcc, 0, v48
  s_cbranch_vccnz T_p1re_83
  s_branch T_p1ok_84
T_kvw_77:
  s_mov_b32 s19, 0
  s_branch T_kvok_86
T_kv_85:
  s_sleep 4
  s_add_u32 s19, s19, 1
  s_cmp_gt_u32 s19, 32768
  s_cbranch_scc1 M_exit
T_kvok_86:
  s_add_u32 s39, s99, 128
  s_mov_b32 s38, 0
  s_mov_b32 s37, 0
  s_atomic_or s38, s[58:59], s99 glc
  s_atomic_or s37, s[58:59], s39 glc
  s_waitcnt lgkmcnt(0)
  s_add_u32 s37, s37, 30
  s_cmp_ge_u32 s38, 30
  s_cselect_b32 s38, s37, s38
  s_cmp_ge_u32 s38, 64
  s_cselect_b32 s38, 100, s38
  s_sub_u32 s38, s38, 1
  s_max_i32 s30, s30, s38
  s_cmp_ge_i32 s14, s30
  s_cbranch_scc1 T_kv_85
  s_branch T_kvb_78
T_slow_80:
  s_nop 7
  v_max3_f32 v100, v16, v17, v18
  v_max3_f32 v100, v100, v19, v20
  v_max3_f32 v100, v100, v21, v22
  v_max3_f32 v100, v100, v23, v112
  v_max3_f32 v100, v100, v113, v114
  v_max_f32 v100, v100, v115
  v_mov_b32 v101, v100
  s_nop 1
  v_permlane32_swap_b32 v100, v101
  s_nop 1
  v_max_f32 v100, v100, v101
  v_mov_b32 v101, v100
  s_nop 1
  v_permlane16_swap_b32 v100, v101
  s_nop 1
  v_max_f32 v100, v100, v101
  v_sub_f32 v16, v16, v100
  v_sub_f32 v17, v17, v100
  v_sub_f32 v18, v18, v100
  v_sub_f32 v19, v19, v100
  v_exp_f32 v16, v16
  v_exp_f32 v17, v17
  v_exp_f32 v18, v18
  v_exp_f32 v19, v19
  v_sub_f32 v20, v20, v100
  v_sub_f32 v21, v21, v100
  v_sub_f32 v22, v22, v100
  v_sub_f32 v23, v23, v100
  v_exp_f32 v20, v20
  v_exp_f32 v21, v21
  v_exp_f32 v22, v22
  v_exp_f32 v23, v23
  v_sub_f32 v112, v112, v100
  v_sub_f32 v113, v113, v100
  v_sub_f32 v114, v114, v100
  v_sub_f32 v115, v115, v100
  v_exp_f32 v112, v112
  v_exp_f32 v113, v113
  v_exp_f32 v114, v114
  v_exp_f32 v115, v115
  s_nop 0
  v_cvt_pk_bf16_f32 v44, v16, v17
  v_cvt_pk_bf16_f32 v45, v18, v19
  v_cvt_pk_bf16_f32 v46, v20, v21
  v_cvt_pk_bf16_f32 v47, v22, v23
  v_cvt_pk_bf16_f32 v84, v112, v113
  v_cvt_pk_bf16_f32 v85, v114, v115
  v_cndmask_b32 v48, v84, 0, s[16:17]
  v_cndmask_b32 v49, v85, 0, s[16:17]
  v_cndmask_b32 v50, 0, v84, s[16:17]
  v_cndmask_b32 v51, 0, v85, s[16:17]
  s_nop 1
  v_mfma_f32_16x16x16_bf16 v[88:91], v[12:13], v[48:49], 0
  v_mfma_f32_16x16x16_bf16 v[24:27], v[120:121], v[48:49], 0
  v_mfma_f32_16x16x16_bf16 v[116:119], v[120:121], v[50:51], 0
  v_mfma_f32_16x16x32_bf16 v[88:91], v[12:15], v[44:47], v[88:91]
  v_mfma_f32_16x16x32_bf16 v[24:27], v[28:31], v[44:47], v[24:27]
  v_mfma_f32_16x16x32_bf16 v[116:119], v[32:35], v[44:47], v[116:119]
  s_nop 7
  s_nop 1
  v_rcp_f32 v89, v88
  s_nop 0
  v_mul_f32 v24, v89, v24
  v_mul_f32 v25, v89, v25
  s_branch T_back_81
T_w_70:
  s_mov_b32 s19, 0
  v_mov_b64 v[16:17], 0
  v_mov_b64 v[18:19], 0
  v_mov_b64 v[20:21], 0
  v_mov_b64 v[22:23], 0
  v_mov_b64 v[24:25], 0
  v_mov_b64 v[26:27], 0
  buffer_load_dwordx4 v[124:127], v2, s[4:7], s24 offen offset:1024 sc1
  buffer_load_dwordx4 v[116:119], v2, s[4:7], s25 offen offset:1024 sc1
  buffer_load_dwordx4 v[124:127], v2, s[4:7], s24 offen offset:1024 sc1
  buffer_load_dwordx4 v[116:119], v2, s[4:7], s25 offen offset:1024 sc1
  s_branch T_loop_87
.p2align 6
T_retry_88:
  s_mov_b64 exec, vcc
  buffer_load_dwordx4 v[124:127], v2, s[4:7], s24 offen offset:1024 sc1
  buffer_load_dwordx4 v[116:119], v2, s[4:7], s25 offen offset:1024 sc1
  s_mov_b64 exec, -1
  s_add_u32 s19, s19, 1
  s_cmp_gt_u32 s19, 32768
  s_cbranch_scc1 M_exit
T_loop_87:
  s_waitcnt vmcnt(3) lgkmcnt(0)
  v_max3_u32 v123, v124, v125, v126
  v_max_u32 v123, v123, v127
  v_mov_b32_dpp v120, v124 row_ror:8 row_mask:0xf bank_mask:0xf
  v_mov_b32_dpp v121, v125 row_ror:8 row_mask:0xf bank_mask:0xf
  s_waitcnt vmcnt(2)
  v_max3_u32 v123, v123, v116, v117
  v_max3_u32 v123, v123, v118, v119
  v_cmp_eq_u32 vcc, -1, v123
  s_cbranch_vccnz T_retry_88
  v_smfmac_f32_16x16x64_bf16 v[16:19], v[124:127], v[68:75], v0
  s_add_u32 s14, s14, 1
  ds_write_b128 v2, v[124:127] offset:1024
  v_mov_b32_dpp v122, v126 row_ror:8 row_mask:0xf bank_mask:0xf
  v_smfmac_f32_16x16x64_bf16 v[20:23], v[124:127], v[76:83], v0
  s_and_b32 s57, s14, 1
  v_mov_b32_dpp v123, v127 row_ror:8 row_mask:0xf bank_mask:0xf
  v_smfmac_f32_16x16x64_bf16 v[24:27], v[124:127], v[84:91], v0
  s_and_b32 s36, s14, 3
  ds_write_b128 v2, v[116:119] offset:5120
  v_smfmac_f32_16x16x64_bf16 v[16:19], v[120:123], v[92:99], v0
  s_lshl_b32 s36, s36, 13
  v_mov_b32_dpp v84, v116 row_ror:8 row_mask:0xf bank_mask:0xf
  v_smfmac_f32_16x16x64_bf16 v[20:23], v[120:123], v[100:107], v0
  s_add_u32 s26, s36, s23
  ds_read_b128 v[68:71], v4 offset:12288
  v_mov_b32_dpp v85, v117 row_ror:8 row_mask:0xf bank_mask:0xf
  v_smfmac_f32_16x16x64_bf16 v[24:27], v[120:123], v[108:115], v0
  s_add_u32 s36, s36, 8192
  ds_read_b128 v[72:75], v4 offset:13312
  v_mov_b32_dpp v86, v118 row_ror:8 row_mask:0xf bank_mask:0xf
  v_smfmac_f32_16x16x64_bf16 v[16:19], v[116:119], v[224:231], v0
  s_and_b32 s36, s36, 0x7fff
  ds_read_b128 v[76:79], v4 offset:14336
  v_mov_b32_dpp v87, v119 row_ror:8 row_mask:0xf bank_mask:0xf
  v_smfmac_f32_16x16x64_bf16 v[20:23], v[116:119], v[240:247], v0
  s_waitcnt lgkmcnt(3)
  s_barrier
  ds_read_b128 v[100:103], v2 offset:0
  v_smfmac_f32_16x16x64_bf16 v[24:27], v[116:119], a[0:7], v0
  s_mov_b32 m0, s31
  ds_read_b128 v[120:123], v1 offset:0
  v_smfmac_f32_16x16x64_bf16 v[16:19], v[84:87], v[232:239], v0
  s_cmp_ge_i32 s14, s30
  s_cbranch_scc1 T_kvw_91
T_kvb_92:
  v_smfmac_f32_16x16x64_bf16 v[20:23], v[84:87], v[248:255], v0
  ds_read_b128 v[80:83], v4 offset:15360
  v_smfmac_f32_16x16x64_bf16 v[24:27], v[84:87], a[8:15], v0
  s_waitcnt lgkmcnt(2)
  buffer_load_dwordx4 v9, s[4:7], s27 offen sc1 lds
  v_smfmac_f32_16x16x64_bf16 v[16:19], v[100:103], v[128:135], v0
  ds_read_b128 v[92:95], v2 offset:3072
  s_mov_b32 m0, s32
  v_smfmac_f32_16x16x64_bf16 v[20:23], v[100:103], v[144:151], v0
  ds_read_b128 v[96:99], v1 offset:3072
  v_smfmac_f32_16x16x64_bf16 v[24:27], v[100:103], v[68:75], v0
  s_waitcnt vmcnt(1) lgkmcnt(3)
  ds_read_b128 v[116:119], v2 offset:2048
  v_smfmac_f32_16x16x64_bf16 v[16:19], v[120:123], v[136:143], v0
  ds_read_b128 v[124:127], v1 offset:2048
  buffer_load_dwordx4 v9, s[4:7], s27 offen offset:128 sc1 lds
  v_smfmac_f32_16x16x64_bf16 v[20:23], v[120:123], v[152:159], v0
  s_waitcnt lgkmcnt(4)
  ds_read_b128 v[104:107], v2 offset:4096
  s_mov_b32 m0, s33
  v_smfmac_f32_16x16x64_bf16 v[24:27], v[120:123], v[76:83], v0
  s_waitcnt lgkmcnt(4)
  ds_read_b128 v[108:111], v1 offset:4096
  v_smfmac_f32_16x16x64_bf16 v[16:19], v[92:95], v[160:167], v0
  s_waitcnt lgkmcnt(4)
  ds_read_b128 v[112:115], v2 offset:7168
  v_smfmac_f32_16x16x64_bf16 v[16:19], v[96:99], v[168:175], v0
  s_waitcnt lgkmcnt(4)
  ds_read_b128 v[84:87], v1 offset:7168
  buffer_load_dwordx4 v10, s[4:7], s28 offen sc1 lds
  v_smfmac_f32_16x16x64_bf16 v[16:19], v[116:119], v[192:199], v0
  s_waitcnt lgkmcnt(4)
  ds_read_b128 v[88:91], v2 offset:6144
  s_mov_b32 m0, s34
  v_smfmac_f32_16x16x64_bf16 v[16:19], v[124:127], v[200:207], v0
  s_waitcnt lgkmcnt(4)
  ds_read_b128 v[100:103], v1 offset:6144
  v_smfmac_f32_16x16x64_bf16 v[16:19], v[104:107], a[16:23], v0
  s_waitcnt lgkmcnt(4)
  ds_read_b128 v[68:71], v4 offset:16384
  v_smfmac_f32_16x16x64_bf16 v[16:19], v[108:111], a[24:31], v0
  s_waitcnt lgkmcnt(4)
  ds_read_b128 v[72:75], v4 offset:17408
  buffer_load_dwordx4 v10, s[4:7], s28 offen offset:256 sc1 lds
  v_smfmac_f32_16x16x64_bf16 v[16:19], v[112:115], a[64:71], v0
  s_waitcnt lgkmcnt(4)
  ds_read_b128 v[76:79], v4 offset:18432
  v_smfmac_f32_16x16x64_bf16 v[16:19], v[84:87], a[72:79], v0
  s_waitcnt lgkmcnt(4)
  ds_read_b128 v[80:83], v4 offset:19456
  v_smfmac_f32_16x16x64_bf16 v[16:19], v[88:91], a[112:119], v0
  s_waitcnt lgkmcnt(4)
  v_smfmac_f32_16x16x64_bf16 v[16:19], v[100:103], a[120:127], v0
  s_add_u32 s24, s36, 145752064
  s_add_u32 s25, s36, 145756160
  v_smfmac_f32_16x16x64_bf16 v[20:23], v[92:95], v[176:183], v0
  s_add_u32 s35, s36, s23
  v_smfmac_f32_16x16x64_bf16 v[20:23], v[96:99], v[184:191], v0
  s_waitcnt lgkmcnt(2)
  v_smfmac_f32_16x16x64_bf16 v[20:23], v[116:119], v[68:75], v0
  s_waitcnt lgkmcnt(0)
  ds_read_b128 v[68:71], v4 offset:20480
  v_mul_f32 v16, s18, v16
  v_smfmac_f32_16x16x64_bf16 v[20:23], v[124:127], v[76:83], v0
  ds_read_b128 v[72:75], v4 offset:21504
  v_mul_f32 v17, s18, v17
  v_smfmac_f32_16x16x64_bf16 v[20:23], v[104:107], a[32:39], v0
  ds_read_b128 v[76:79], v4 offset:22528
  v_mul_f32 v18, s18, v18
  v_smfmac_f32_16x16x64_bf16 v[20:23], v[108:111], a[40:47], v0
  ds_read_b128 v[80:83], v4 offset:23552
  v_mul_f32 v19, s18, v19
  v_smfmac_f32_16x16x64_bf16 v[20:23], v[112:115], a[80:87], v0
  v_cvt_pk_bf16_f32 v120, v16, v17
  v_smfmac_f32_16x16x64_bf16 v[20:23], v[84:87], a[88:95], v0
  v_cvt_pk_bf16_f32 v121, v18, v19
  v_smfmac_f32_16x16x64_bf16 v[20:23], v[88:91], a[128:135], v0
  ds_write_b64 v5, v[120:121] offset:24576
  v_smfmac_f32_16x16x64_bf16 v[20:23], v[100:103], a[136:143], v0
  s_waitcnt lgkmcnt(3)
  v_smfmac_f32_16x16x64_bf16 v[24:27], v[92:95], v[68:75], v0
  s_waitcnt lgkmcnt(1)
  v_mov_b64 v[92:93], 0
  v_smfmac_f32_16x16x64_bf16 v[24:27], v[96:99], v[76:83], v0
  s_nop 1
  v_cvt_pk_bf16_f32 v122, v20, v21
  v_cvt_pk_bf16_f32 v123, v22, v23
  v_smfmac_f32_16x16x64_bf16 v[24:27], v[116:119], v[208:215], v0
  ds_write_b64 v5, v[122:123] offset:26880
  v_mov_b64 v[94:95], 0
  v_smfmac_f32_16x16x64_bf16 v[24:27], v[124:127], v[216:223], v0
  s_waitcnt lgkmcnt(1)
  s_barrier
  ds_read_b64_tr_b16 v[68:69], v6 offset:24576
  v_smfmac_f32_16x16x64_bf16 v[24:27], v[104:107], a[48:55], v0
  s_add_u32 s27, s27, 8192
  ds_read_b64_tr_b16 v[70:71], v6 offset:24640
  ds_read_b64_tr_b16 v[72:73], v6 offset:24832
  v_smfmac_f32_16x16x64_bf16 v[24:27], v[108:111], a[56:63], v0
  s_add_u32 s28, s28, 8192
  ds_read_b64_tr_b16 v[74:75], v6 offset:24896
  ds_read_b64_tr_b16 v[76:77], v6 offset:25088
  v_smfmac_f32_16x16x64_bf16 v[24:27], v[112:115], a[96:103], v0
  s_nop 0
  ds_read_b64_tr_b16 v[78:79], v6 offset:25152
  ds_read_b64_tr_b16 v[80:81], v6 offset:25344
  v_smfmac_f32_16x16x64_bf16 v[24:27], v[84:87], a[104:111], v0
  ds_read_b64_tr_b16 v[82:83], v6 offset:25408
  v_mov_b64 v[96:97], 0
  v_smfmac_f32_16x16x64_bf16 v[24:27], v[88:91], a[144:151], v0
  s_waitcnt lgkmcnt(8)
  s_barrier
  ds_read_b64_tr_b16 v[116:117], v6 offset:26880
  v_smfmac_f32_16x16x64_bf16 v[24:27], v[100:103], a[152:159], v0
  s_waitcnt lgkmcnt(7)
  ds_read_b64_tr_b16 v[118:119], v6 offset:26944
  v_mfma_f32_16x16x32_bf16 v[16:19], v[36:39], v[68:71], 0
  s_waitcnt lgkmcnt(6)
  ds_read_b64_tr_b16 v[124:125], v6 offset:27136
  ds_read_b64_tr_b16 v[126:127], v6 offset:27200
  v_mfma_f32_16x16x32_bf16 v[16:19], v[40:43], v[72:75], v[16:19]
  s_waitcnt lgkmcnt(6)
  ds_read_b64_tr_b16 v[104:105], v6 offset:27392
  ds_read_b64_tr_b16 v[106:107], v6 offset:27456
  v_mfma_f32_16x16x32_bf16 v[16:19], v[44:47], v[76:79], v[16:19]
  s_waitcnt lgkmcnt(6)
  ds_read_b64_tr_b16 v[108:109], v6 offset:27648
  ds_read_b64_tr_b16 v[110:111], v6 offset:27712
  v_mfma_f32_16x16x32_bf16 v[16:19], v[48:51], v[80:83], v[16:19]
  s_waitcnt lgkmcnt(6)
  v_cvt_pk_bf16_f32 v120, v24, v25
  v_cvt_pk_bf16_f32 v121, v26, v27
  v_mfma_f32_16x16x32_bf16 v[112:115], v[116:119], v[68:71], 0
  s_waitcnt lgkmcnt(4)
  v_mov_b64 v[98:99], 0
  v_mfma_f32_16x16x32_bf16 v[112:115], v[124:127], v[72:75], v[112:115]
  s_waitcnt lgkmcnt(2)
  buffer_store_dwordx4 v[120:123], v2, s[4:7], s29 offen offset:1024 sc1
  v_mov_b64 v[36:37], 0
  v_exp_f32 v100, v16
  v_mfma_f32_16x16x32_bf16 v[112:115], v[104:107], v[76:79], v[112:115]
  s_waitcnt lgkmcnt(0)
  v_exp_f32 v101, v17
  v_mfma_f32_16x16x32_bf16 v[112:115], v[108:111], v[80:83], v[112:115]
  v_exp_f32 v102, v18
  v_mfma_f32_16x16x32_bf16 v[20:23], v[52:55], v[68:71], 0
  s_cmp_eq_u32 s14, 63
  v_exp_f32 v103, v19
  v_mfma_f32_16x16x32_bf16 v[20:23], v[56:59], v[72:75], v[20:23]
  s_cbranch_scc1 M_tdone
  v_cvt_pk_bf16_f32 v44, v100, v101
  v_cvt_pk_bf16_f32 v45, v102, v103
  v_mfma_f32_16x16x32_bf16 v[20:23], v[60:63], v[76:79], v[20:23]
  s_add_u32 s29, s29, 131072
  v_exp_f32 v100, v112
  v_mfma_f32_16x16x32_bf16 v[20:23], v[64:67], v[80:83], v[20:23]
  v_exp_f32 v101, v113
  v_exp_f32 v102, v114
  v_exp_f32 v103, v115
  v_cvt_pk_bf16_f32 v84, v100, v101
  v_cvt_pk_bf16_f32 v85, v102, v103
  v_cndmask_b32 v48, v84, 0, s[16:17]
  v_cndmask_b32 v49, v85, 0, s[16:17]
  v_cndmask_b32 v50, 0, v84, s[16:17]
  v_cndmask_b32 v51, 0, v85, s[16:17]
  v_exp_f32 v100, v20
  v_mfma_f32_16x16x16_bf16 v[88:91], v[12:13], v[48:49], 0
  v_exp_f32 v101, v21
  v_mfma_f32_16x16x16_bf16 v[24:27], v[120:121], v[48:49], 0
  v_exp_f32 v102, v22
  v_mfma_f32_16x16x16_bf16 v[116:119], v[120:121], v[50:51], 0
  v_exp_f32 v103, v23
  v_cvt_pk_bf16_f32 v46, v100, v101
  v_cvt_pk_bf16_f32 v47, v102, v103
  v_mov_b64 v[38:39], 0
  s_nop 0
  v_mfma_f32_16x16x32_bf16 v[88:91], v[12:15], v[44:47], v[88:91]
  v_mov_b64 v[40:41], 0
  v_mov_b64 v[42:43], 0
  v_mfma_f32_16x16x32_bf16 v[24:27], v[28:31], v[44:47], v[24:27]
  ds_read_b128 v[52:55], v4 offset:24576
  ds_read_b128 v[56:59], v4 offset:25600
  v_mfma_f32_16x16x32_bf16 v[116:119], v[32:35], v[44:47], v[116:119]
  s_nop 1
  v_rcp_f32 v89, v88
  v_subrev_u32 v100, s54, v88
  v_cmp_le_u32 vcc, s55, v100
  v_mul_f32 v24, v89, v24
  v_mul_f32 v25, v89, v25
  s_cbranch_vccnz T_slow_94
T_back_95:
  v_cvt_pk_bf16_f32 v124, v24, v25
  v_pk_mul_f32 v[26:27], v[26:27], v[88:89] op_sel:[0,1] op_sel_hi:[1,1]
  v_pk_mul_f32 v[116:117], v[116:117], v[88:89] op_sel:[0,1] op_sel_hi:[1,1]
  v_pk_mul_f32 v[118:119], v[118:119], v[88:89] op_sel:[0,1] op_sel_hi:[1,1]
  v_cvt_pk_bf16_f32 v125, v26, v27
  v_cvt_pk_bf16_f32 v126, v116, v117
  v_cvt_pk_bf16_f32 v127, v118, v119
  ds_write_b128 v11, v[124:127] offset:29696
  s_nop 0
  v_smfmac_f32_16x16x64_bf16 v[92:95], v[124:127], a[160:167], v0
  v_smfmac_f32_16x16x64_bf16 v[96:99], v[124:127], a[168:175], v0
  v_smfmac_f32_16x16x64_bf16 v[36:39], v[124:127], a[176:183], v0
  v_smfmac_f32_16x16x64_bf16 v[40:43], v[124:127], a[184:191], v0
  s_waitcnt lgkmcnt(0)
  s_barrier
  ds_read_b128 v[104:107], v11 offset:29184
  ds_read_b128 v[108:111], v11 offset:30720
  ds_read_b128 v[68:71], v11 offset:30208
  s_waitcnt lgkmcnt(2)
  v_smfmac_f32_16x16x64_bf16 v[92:95], v[104:107], a[192:199], v0
  s_waitcnt lgkmcnt(1)
  ds_read_b128 v[76:79], v4 offset:28672
  v_smfmac_f32_16x16x64_bf16 v[92:95], v[108:111], a[224:231], v0
  s_waitcnt lgkmcnt(1)
  ds_read_b128 v[80:83], v4 offset:29696
  v_smfmac_f32_16x16x64_bf16 v[92:95], v[68:71], a[240:247], v0
  ds_read_b128 v[60:63], v4 offset:26624
  v_smfmac_f32_16x16x64_bf16 v[96:99], v[104:107], a[200:207], v0
  ds_read_b128 v[64:67], v4 offset:27648
  v_smfmac_f32_16x16x64_bf16 v[96:99], v[108:111], a[232:239], v0
  ds_read_b128 v[28:31], v4 offset:30720
  s_nop 0
  v_cvt_pk_bf16_f32 v16, v92, v93
  v_cvt_pk_bf16_f32 v17, v94, v95
  v_bfi_b32 v16, 1, s57, v16
  v_smfmac_f32_16x16x64_bf16 v[96:99], v[68:71], a[248:255], v0
  buffer_store_dwordx2 v[16:17], v7, s[4:7], s20 offen offset:0 sc1
  v_smfmac_f32_16x16x64_bf16 v[36:39], v[104:107], a[208:215], v0
  ds_read_b128 v[32:35], v4 offset:31744
  v_smfmac_f32_16x16x64_bf16 v[36:39], v[108:111], v[52:59], v0
  s_waitcnt lgkmcnt(4)
  s_nop 0
  v_cvt_pk_bf16_f32 v18, v96, v97
  v_cvt_pk_bf16_f32 v19, v98, v99
  v_bfi_b32 v18, 1, s57, v18
  v_smfmac_f32_16x16x64_bf16 v[36:39], v[68:71], v[76:83], v0
  buffer_store_dwordx2 v[18:19], v7, s[4:7], s20 offen offset:64 sc1
  v_smfmac_f32_16x16x64_bf16 v[40:43], v[104:107], a[216:223], v0
  s_waitcnt lgkmcnt(2)
  ds_read_b128 v[116:119], v2 offset:31232
  v_smfmac_f32_16x16x64_bf16 v[40:43], v[108:111], v[60:67], v0
  s_waitcnt lgkmcnt(1)
  s_nop 0
  v_cvt_pk_bf16_f32 v20, v36, v37
  v_cvt_pk_bf16_f32 v21, v38, v39
  v_bfi_b32 v20, 1, s57, v20
  v_smfmac_f32_16x16x64_bf16 v[40:43], v[68:71], v[28:35], v0
  buffer_store_dwordx2 v[20:21], v7, s[4:7], s21 offen offset:0 sc1
  s_nop 6
  v_cvt_pk_bf16_f32 v22, v40, v41
  v_cvt_pk_bf16_f32 v23, v42, v43
  v_bfi_b32 v22, 1, s57, v22
  buffer_store_dwordx2 v[22:23], v7, s[4:7], s21 offen offset:64 sc1
  ds_read_b128 v[68:71], v4 offset:0
  ds_read_b128 v[72:75], v4 offset:1024
  ds_read_b128 v[76:79], v4 offset:4096
  ds_read_b128 v[80:83], v4 offset:5120
  ds_read_b128 v[84:87], v4 offset:8192
  ds_read_b128 v[88:91], v4 offset:9216
  ds_read_b128 v[92:95], v4 offset:2048
  ds_read_b128 v[96:99], v4 offset:3072
  ds_read_b128 v[100:103], v4 offset:6144
  ds_read_b128 v[104:107], v4 offset:7168
  ds_read_b128 v[108:111], v4 offset:10240
  ds_read_b128 v[112:115], v4 offset:11264
  v_mov_b64 v[16:17], 0
  v_mov_b64 v[18:19], 0
  v_mov_b64 v[20:21], 0
  v_mov_b64 v[22:23], 0
  v_mov_b64 v[24:25], 0
  v_mov_b64 v[26:27], 0
  s_mov_b32 s19, 0
  v_mov_b32 v49, -1
  ds_read_b64 v[44:45], v2 offset:32256
  s_waitcnt lgkmcnt(0)
  v_readfirstlane_b32 s38, v44
  v_readfirstlane_b32 s37, v45
  s_nop 0
  s_add_u32 s37, s37, 30
  s_cmp_ge_u32 s38, 30
  s_cselect_b32 s38, s37, s38
  s_cmp_ge_u32 s38, 64
  s_cselect_b32 s38, 100, s38
  s_sub_u32 s38, s38, 1
  s_max_i32 s30, s30, s38
  s_waitcnt vmcnt(0)
  buffer_load_dwordx4 v[52:55], v2, s[4:7], s22 offen offset:0 sc1
  buffer_load_dwordx4 v[56:59], v2, s[4:7], s22 offen offset:1024 sc1
  buffer_load_dwordx4 v[60:63], v2, s[4:7], s22 offen offset:2048 sc1
  buffer_load_dwordx4 v[64:67], v2, s[4:7], s22 offen offset:3072 sc1
  s_waitcnt lgkmcnt(12)
  s_waitcnt vmcnt(3)
  v_mfma_f32_16x16x32_bf16 v[120:123], v[116:119], v[52:55], 0
  v_xor_b32 v48, s57, v52
  v_bitop3_b32 v48, v48, v54, s57 bitop3:0xf6
  s_waitcnt vmcnt(2)
  v_mfma_f32_16x16x32_bf16 v[120:123], v[116:119], v[56:59], v[120:123]
  v_bitop3_b32 v48, v48, v56, s57 bitop3:0xf6
  v_bitop3_b32 v48, v48, v58, s57 bitop3:0xf6
  s_waitcnt vmcnt(1)
  v_mfma_f32_16x16x32_bf16 v[120:123], v[116:119], v[60:63], v[120:123]
  v_bitop3_b32 v48, v48, v60, s57 bitop3:0xf6
  v_bitop3_b32 v48, v48, v62, s57 bitop3:0xf6
  s_waitcnt vmcnt(0)
  v_mfma_f32_16x16x32_bf16 v[120:123], v[116:119], v[64:67], v[120:123]
  v_bitop3_b32 v48, v48, v64, s57 bitop3:0xf6
  v_bitop3_b32 v48, v48, v66, s57 bitop3:0xf6
  v_and_b32 v48, 1, v48
  v_cmp_ne_u32 vcc, 0, v48
  s_cbranch_vccnz T_p1re_97
T_p1ok_98:
  s_nop 2
  v_add_f32_dpp v120, v120, v120 row_ror:8 row_mask:0xf bank_mask:0xf
  v_add_f32_dpp v121, v121, v121 row_ror:8 row_mask:0xf bank_mask:0xf
  v_cvt_pk_bf16_f32 v48, v120, v121
  buffer_store_dword v48, v8, s[4:7], s35 offen sc1
  buffer_store_dword v49, v8, s[4:7], s26 offen sc1
  s_barrier
  ds_read_b128 v[28:31], v2 offset:17408
  ds_read_b128 v[32:35], v2 offset:21504
  ds_read_b128 v[36:39], v2 offset:8192
  ds_read_b128 v[40:43], v2 offset:9216
  ds_read_b128 v[44:47], v2 offset:10240
  ds_read_b128 v[48:51], v2 offset:11264
  buffer_load_dwordx4 v[124:127], v2, s[4:7], s24 offen offset:1024 sc1
  buffer_load_dwordx4 v[116:119], v2, s[4:7], s25 offen offset:1024 sc1
  ds_read_b128 v[52:55], v2 offset:12288
  ds_read_b128 v[56:59], v2 offset:13312
  ds_read_b128 v[60:63], v2 offset:14336
  ds_read_b128 v[64:67], v2 offset:15360
  buffer_load_dwordx4 v[124:127], v2, s[4:7], s24 offen offset:1024 sc1
  buffer_load_dwordx4 v[116:119], v2, s[4:7], s25 offen offset:1024 sc1
  s_mov_b32 s19, 0
  s_branch T_loop_87
T_p1re_97:
  s_mov_b64 exec, vcc
  buffer_load_dwordx4 v[52:55], v2, s[4:7], s22 offen offset:0 sc1
  buffer_load_dwordx4 v[56:59], v2, s[4:7], s22 offen offset:1024 sc1
  buffer_load_dwordx4 v[60:63], v2, s[4:7], s22 offen offset:2048 sc1
  buffer_load_dwordx4 v[64:67], v2, s[4:7], s22 offen offset:3072 sc1
  s_mov_b64 exec, -1
  s_add_u32 s19, s19, 1
  s_cmp_gt_u32 s19, 32768
  s_cbranch_scc1 M_exit
  s_waitcnt vmcnt(3)
  v_mfma_f32_16x16x32_bf16 v[120:123], v[116:119], v[52:55], 0
  v_xor_b32 v48, s57, v52
  v_bitop3_b32 v48, v48, v54, s57 bitop3:0xf6
  s_waitcnt vmcnt(2)
  v_mfma_f32_16x16x32_bf16 v[120:123], v[116:119], v[56:59], v[120:123]
  v_bitop3_b32 v48, v48, v56, s57 bitop3:0xf6
  v_bitop3_b32 v48, v48, v58, s57 bitop3:0xf6
  s_waitcnt vmcnt(1)
  v_mfma_f32_16x16x32_bf16 v[120:123], v[116:119], v[60:63], v[120:123]
  v_bitop3_b32 v48, v48, v60, s57 bitop3:0xf6
  v_bitop3_b32 v48, v48, v62, s57 bitop3:0xf6
  s_waitcnt vmcnt(0)
  v_mfma_f32_16x16x32_bf16 v[120:123], v[116:119], v[64:67], v[120:123]
  v_bitop3_b32 v48, v48, v64, s57 bitop3:0xf6
  v_bitop3_b32 v48, v48, v66, s57 bitop3:0xf6
  v_and_b32 v48, 1, v48
  v_cmp_ne_u32 vcc, 0, v48
  s_cbranch_vccnz T_p1re_97
  s_branch T_p1ok_98
T_kvw_91:
  s_mov_b32 s19, 0
  s_branch T_kvok_100
T_kv_99:
  s_sleep 4
  s_add_u32 s19, s19, 1
  s_cmp_gt_u32 s19, 32768
  s_cbranch_scc1 M_exit
T_kvok_100:
  s_add_u32 s39, s99, 128
  s_mov_b32 s38, 0
  s_mov_b32 s37, 0
  s_atomic_or s38, s[58:59], s99 glc
  s_atomic_or s37, s[58:59], s39 glc
  s_waitcnt lgkmcnt(0)
  s_add_u32 s37, s37, 30
  s_cmp_ge_u32 s38, 30
  s_cselect_b32 s38, s37, s38
  s_cmp_ge_u32 s38, 64
  s_cselect_b32 s38, 100, s38
  s_sub_u32 s38, s38, 1
  s_max_i32 s30, s30, s38
  s_cmp_ge_i32 s14, s30
  s_cbranch_scc1 T_kv_99
  s_branch T_kvb_92
T_slow_94:
  s_nop 7
  v_max3_f32 v100, v16, v17, v18
  v_max3_f32 v100, v100, v19, v20
  v_max3_f32 v100, v100, v21, v22
  v_max3_f32 v100, v100, v23, v112
  v_max3_f32 v100, v100, v113, v114
  v_max_f32 v100, v100, v115
  v_mov_b32 v101, v100
  s_nop 1
  v_permlane32_swap_b32 v100, v101
  s_nop 1
  v_max_f32 v100, v100, v101
  v_mov_b32 v101, v100
  s_nop 1
  v_permlane16_swap_b32 v100, v101
  s_nop 1
  v_max_f32 v100, v100, v101
  v_sub_f32 v16, v16, v100
  v_sub_f32 v17, v17, v100
  v_sub_f32 v18, v18, v100
  v_sub_f32 v19, v19, v100
  v_exp_f32 v16, v16
  v_exp_f32 v17, v17
  v_exp_f32 v18, v18
  v_exp_f32 v19, v19
  v_sub_f32 v20, v20, v100
  v_sub_f32 v21, v21, v100
  v_sub_f32 v22, v22, v100
  v_sub_f32 v23, v23, v100
  v_exp_f32 v20, v20
  v_exp_f32 v21, v21
  v_exp_f32 v22, v22
  v_exp_f32 v23, v23
  v_sub_f32 v112, v112, v100
  v_sub_f32 v113, v113, v100
  v_sub_f32 v114, v114, v100
  v_sub_f32 v115, v115, v100
  v_exp_f32 v112, v112
  v_exp_f32 v113, v113
  v_exp_f32 v114, v114
  v_exp_f32 v115, v115
  s_nop 0
  v_cvt_pk_bf16_f32 v44, v16, v17
  v_cvt_pk_bf16_f32 v45, v18, v19
  v_cvt_pk_bf16_f32 v46, v20, v21
  v_cvt_pk_bf16_f32 v47, v22, v23
  v_cvt_pk_bf16_f32 v84, v112, v113
  v_cvt_pk_bf16_f32 v85, v114, v115
  v_cndmask_b32 v48, v84, 0, s[16:17]
  v_cndmask_b32 v49, v85, 0, s[16:17]
  v_cndmask_b32 v50, 0, v84, s[16:17]
  v_cndmask_b32 v51, 0, v85, s[16:17]
  s_nop 1
  v_mfma_f32_16x16x16_bf16 v[88:91], v[12:13], v[48:49], 0
  v_mfma_f32_16x16x16_bf16 v[24:27], v[120:121], v[48:49], 0
  v_mfma_f32_16x16x16_bf16 v[116:119], v[120:121], v[50:51], 0
  v_mfma_f32_16x16x32_bf16 v[88:91], v[12:15], v[44:47], v[88:91]
  v_mfma_f32_16x16x32_bf16 v[24:27], v[28:31], v[44:47], v[24:27]
  v_mfma_f32_16x16x32_bf16 v[116:119], v[32:35], v[44:47], v[116:119]
  s_nop 7
  s_nop 1
  v_rcp_f32 v89, v88
  s_nop 0
  v_mul_f32 v24, v89, v24
  v_mul_f32 v25, v89, v25
  s_branch T_back_95
T_w_71:
  s_mov_b32 s19, 0
  v_mov_b64 v[16:17], 0
  v_mov_b64 v[18:19], 0
  v_mov_b64 v[20:21], 0
  v_mov_b64 v[22:23], 0
  v_mov_b64 v[24:25], 0
  v_mov_b64 v[26:27], 0
  buffer_load_dwordx4 v[124:127], v2, s[4:7], s24 offen offset:2048 sc1
  buffer_load_dwordx4 v[116:119], v2, s[4:7], s25 offen offset:2048 sc1
  buffer_load_dwordx4 v[124:127], v2, s[4:7], s24 offen offset:2048 sc1
  buffer_load_dwordx4 v[116:119], v2, s[4:7], s25 offen offset:2048 sc1
  s_branch T_loop_101
.p2align 6
T_retry_102:
  s_mov_b64 exec, vcc
  buffer_load_dwordx4 v[124:127], v2, s[4:7], s24 offen offset:2048 sc1
  buffer_load_dwordx4 v[116:119], v2, s[4:7], s25 offen offset:2048 sc1
  s_mov_b64 exec, -1
  s_add_u32 s19, s19, 1
  s_cmp_gt_u32 s19, 32768
  s_cbranch_scc1 M_exit
T_loop_101:
  s_waitcnt vmcnt(3) lgkmcnt(0)
  v_max3_u32 v123, v124, v125, v126
  v_max_u32 v123, v123, v127
  v_mov_b32_dpp v120, v124 row_ror:8 row_mask:0xf bank_mask:0xf
  v_mov_b32_dpp v121, v125 row_ror:8 row_mask:0xf bank_mask:0xf
  s_waitcnt vmcnt(2)
  v_max3_u32 v123, v123, v116, v117
  v_max3_u32 v123, v123, v118, v119
  v_cmp_eq_u32 vcc, -1, v123
  s_cbranch_vccnz T_retry_102
  v_smfmac_f32_16x16x64_bf16 v[16:19], v[124:127], v[68:75], v0
  s_add_u32 s14, s14, 1
  ds_write_b128 v2, v[124:127] offset:2048
  v_mov_b32_dpp v122, v126 row_ror:8 row_mask:0xf bank_mask:0xf
  v_smfmac_f32_16x16x64_bf16 v[20:23], v[124:127], v[76:83], v0
  s_and_b32 s57, s14, 1
  v_mov_b32_dpp v123, v127 row_ror:8 row_mask:0xf bank_mask:0xf
  v_smfmac_f32_16x16x64_bf16 v[24:27], v[124:127], v[84:91], v0
  s_and_b32 s36, s14, 3
  ds_write_b128 v2, v[116:119] offset:6144
  v_smfmac_f32_16x16x64_bf16 v[16:19], v[120:123], v[92:99], v0
  s_lshl_b32 s36, s36, 13
  v_mov_b32_dpp v84, v116 row_ror:8 row_mask:0xf bank_mask:0xf
  v_smfmac_f32_16x16x64_bf16 v[20:23], v[120:123], v[100:107], v0
  s_add_u32 s26, s36, s23
  ds_read_b128 v[68:71], v4 offset:12288
  v_mov_b32_dpp v85, v117 row_ror:8 row_mask:0xf bank_mask:0xf
  v_smfmac_f32_16x16x64_bf16 v[24:27], v[120:123], v[108:115], v0
  s_add_u32 s36, s36, 8192
  ds_read_b128 v[72:75], v4 offset:13312
  v_mov_b32_dpp v86, v118 row_ror:8 row_mask:0xf bank_mask:0xf
  v_smfmac_f32_16x16x64_bf16 v[16:19], v[116:119], v[224:231], v0
  s_and_b32 s36, s36, 0x7fff
  ds_read_b128 v[76:79], v4 offset:14336
  v_mov_b32_dpp v87, v119 row_ror:8 row_mask:0xf bank_mask:0xf
  v_smfmac_f32_16x16x64_bf16 v[20:23], v[116:119], v[240:247], v0
  s_waitcnt lgkmcnt(3)
  s_barrier
  ds_read_b128 v[100:103], v2 offset:3072
  v_smfmac_f32_16x16x64_bf16 v[24:27], v[116:119], a[0:7], v0
  s_mov_b32 m0, s31
  ds_read_b128 v[120:123], v1 offset:3072
  v_smfmac_f32_16x16x64_bf16 v[16:19], v[84:87], v[232:239], v0
  s_cmp_ge_i32 s14, s30
  s_cbranch_scc1 T_kvw_105
T_kvb_106:
  v_smfmac_f32_16x16x64_bf16 v[20:23], v[84:87], v[248:255], v0
  ds_read_b128 v[80:83], v4 offset:15360
  v_smfmac_f32_16x16x64_bf16 v[24:27], v[84:87], a[8:15], v0
  s_waitcnt lgkmcnt(2)
  v_smfmac_f32_16x16x64_bf16 v[16:19], v[100:103], v[128:135], v0
  ds_read_b128 v[92:95], v2 offset:0
  buffer_load_dwordx4 v9, s[4:7], s27 offen sc1 lds
  v_smfmac_f32_16x16x64_bf16 v[20:23], v[100:103], v[144:151], v0
  ds_read_b128 v[96:99], v1 offset:0
  s_mov_b32 m0, s32
  v_smfmac_f32_16x16x64_bf16 v[24:27], v[100:103], v[68:75], v0
  s_waitcnt vmcnt(1) lgkmcnt(3)
  ds_read_b128 v[116:119], v2 offset:1024
  v_smfmac_f32_16x16x64_bf16 v[16:19], v[120:123], v[136:143], v0
  ds_read_b128 v[124:127], v1 offset:1024
  v_smfmac_f32_16x16x64_bf16 v[20:23], v[120:123], v[152:159], v0
  s_waitcnt lgkmcnt(4)
  ds_read_b128 v[104:107], v2 offset:7168
  buffer_load_dwordx4 v9, s[4:7], s27 offen offset:128 sc1 lds
  v_smfmac_f32_16x16x64_bf16 v[24:27], v[120:123], v[76:83], v0
  s_waitcnt lgkmcnt(4)
  ds_read_b128 v[108:111], v1 offset:7168
  s_mov_b32 m0, s33
  v_smfmac_f32_16x16x64_bf16 v[16:19], v[92:95], v[160:167], v0
  s_waitcnt lgkmcnt(4)
  ds_read_b128 v[112:115], v2 offset:4096
  v_mov_b32 v122, s98
  v_smfmac_f32_16x16x64_bf16 v[16:19], v[96:99], v[168:175], v0
  s_waitcnt lgkmcnt(4)
  ds_read_b128 v[84:87], v1 offset:4096
  v_smfmac_f32_16x16x64_bf16 v[16:19], v[116:119], v[192:199], v0
  s_waitcnt lgkmcnt(4)
  ds_read_b128 v[88:91], v2 offset:5120
  buffer_load_dwordx4 v10, s[4:7], s28 offen sc1 lds
  v_smfmac_f32_16x16x64_bf16 v[16:19], v[124:127], v[200:207], v0
  s_waitcnt lgkmcnt(4)
  ds_read_b128 v[100:103], v1 offset:5120
  s_mov_b32 m0, s34
  v_smfmac_f32_16x16x64_bf16 v[16:19], v[104:107], a[16:23], v0
  s_waitcnt lgkmcnt(4)
  ds_read_b128 v[68:71], v4 offset:16384
  v_smfmac_f32_16x16x64_bf16 v[16:19], v[108:111], a[24:31], v0
  s_waitcnt lgkmcnt(4)
  ds_read_b128 v[72:75], v4 offset:17408
  v_smfmac_f32_16x16x64_bf16 v[16:19], v[112:115], a[64:71], v0
  s_waitcnt lgkmcnt(4)
  ds_read_b128 v[76:79], v4 offset:18432
  buffer_load_dwordx4 v10, s[4:7], s28 offen offset:256 sc1 lds
  v_smfmac_f32_16x16x64_bf16 v[16:19], v[84:87], a[72:79], v0
  s_waitcnt lgkmcnt(4)
  ds_read_b128 v[80:83], v4 offset:19456
  v_smfmac_f32_16x16x64_bf16 v[16:19], v[88:91], a[112:119], v0
  s_waitcnt lgkmcnt(4)
  v_smfmac_f32_16x16x64_bf16 v[16:19], v[100:103], a[120:127], v0
  s_add_u32 s24, s36, 145752064
  s_add_u32 s25, s36, 145756160
  v_smfmac_f32_16x16x64_bf16 v[20:23], v[92:95], v[176:183], v0
  buffer_store_dword v122, v3, s[4:7], s15 offen sc1
  s_add_u32 s35, s36, s23
  v_smfmac_f32_16x16x64_bf16 v[20:23], v[96:99], v[184:191], v0
  s_waitcnt lgkmcnt(2)
  s_add_u32 s98, s14, 1
  v_smfmac_f32_16x16x64_bf16 v[20:23], v[116:119], v[68:75], v0
  s_waitcnt lgkmcnt(0)
  ds_read_b128 v[68:71], v4 offset:20480
  v_mul_f32 v16, s18, v16
  v_smfmac_f32_16x16x64_bf16 v[20:23], v[124:127], v[76:83], v0
  ds_read_b128 v[72:75], v4 offset:21504
  v_mul_f32 v17, s18, v17
  v_smfmac_f32_16x16x64_bf16 v[20:23], v[104:107], a[32:39], v0
  ds_read_b128 v[76:79], v4 offset:22528
  v_mul_f32 v18, s18, v18
  v_smfmac_f32_16x16x64_bf16 v[20:23], v[108:111], a[40:47], v0
  ds_read_b128 v[80:83], v4 offset:23552
  v_mul_f32 v19, s18, v19
  v_smfmac_f32_16x16x64_bf16 v[20:23], v[112:115], a[80:87], v0
  v_cvt_pk_bf16_f32 v120, v16, v17
  v_smfmac_f32_16x16x64_bf16 v[20:23], v[84:87], a[88:95], v0
  v_cvt_pk_bf16_f32 v121, v18, v19
  v_smfmac_f32_16x16x64_bf16 v[20:23], v[88:91], a[128:135], v0
  ds_write_b64 v5, v[120:121] offset:24576
  v_smfmac_f32_16x16x64_bf16 v[20:23], v[100:103], a[136:143], v0
  s_waitcnt lgkmcnt(3)
  v_smfmac_f32_16x16x64_bf16 v[24:27], v[92:95], v[68:75], v0
  s_waitcnt lgkmcnt(1)
  v_mov_b64 v[92:93], 0
  v_smfmac_f32_16x16x64_bf16 v[24:27], v[96:99], v[76:83], v0
  s_nop 1
  v_cvt_pk_bf16_f32 v122, v20, v21
  v_cvt_pk_bf16_f32 v123, v22, v23
  v_smfmac_f32_16x16x64_bf16 v[24:27], v[116:119], v[208:215], v0
  ds_write_b64 v5, v[122:123] offset:26880
  v_mov_b64 v[94:95], 0
  v_smfmac_f32_16x16x64_bf16 v[24:27], v[124:127], v[216:223], v0
  s_waitcnt lgkmcnt(1)
  s_barrier
  ds_read_b64_tr_b16 v[68:69], v6 offset:24576
  v_smfmac_f32_16x16x64_bf16 v[24:27], v[104:107], a[48:55], v0
  s_add_u32 s27, s27, 8192
  ds_read_b64_tr_b16 v[70:71], v6 offset:24640
  ds_read_b64_tr_b16 v[72:73], v6 offset:24832
  v_smfmac_f32_16x16x64_bf16 v[24:27], v[108:111], a[56:63], v0
  s_add_u32 s28, s28, 8192
  ds_read_b64_tr_b16 v[74:75], v6 offset:24896
  ds_read_b64_tr_b16 v[76:77], v6 offset:25088
  v_smfmac_f32_16x16x64_bf16 v[24:27], v[112:115], a[96:103], v0
  s_nop 0
  ds_read_b64_tr_b16 v[78:79], v6 offset:25152
  ds_read_b64_tr_b16 v[80:81], v6 offset:25344
  v_smfmac_f32_16x16x64_bf16 v[24:27], v[84:87], a[104:111], v0
  ds_read_b64_tr_b16 v[82:83], v6 offset:25408
  v_mov_b64 v[96:97], 0
  v_smfmac_f32_16x16x64_bf16 v[24:27], v[88:91], a[144:151], v0
  s_waitcnt lgkmcnt(8)
  s_barrier
  ds_read_b64_tr_b16 v[116:117], v6 offset:26880
  v_smfmac_f32_16x16x64_bf16 v[24:27], v[100:103], a[152:159], v0
  s_waitcnt lgkmcnt(7)
  ds_read_b64_tr_b16 v[118:119], v6 offset:26944
  v_mfma_f32_16x16x32_bf16 v[16:19], v[36:39], v[68:71], 0
  s_waitcnt lgkmcnt(6)
  ds_read_b64_tr_b16 v[124:125], v6 offset:27136
  ds_read_b64_tr_b16 v[126:127], v6 offset:27200
  v_mfma_f32_16x16x32_bf16 v[16:19], v[40:43], v[72:75], v[16:19]
  s_waitcnt lgkmcnt(6)
  ds_read_b64_tr_b16 v[104:105], v6 offset:27392
  ds_read_b64_tr_b16 v[106:107], v6 offset:27456
  v_mfma_f32_16x16x32_bf16 v[16:19], v[44:47], v[76:79], v[16:19]
  s_waitcnt lgkmcnt(6)
  ds_read_b64_tr_b16 v[108:109], v6 offset:27648
  ds_read_b64_tr_b16 v[110:111], v6 offset:27712
  v_mfma_f32_16x16x32_bf16 v[16:19], v[48:51], v[80:83], v[16:19]
  s_waitcnt lgkmcnt(6)
  v_cvt_pk_bf16_f32 v120, v24, v25
  v_cvt_pk_bf16_f32 v121, v26, v27
  v_mfma_f32_16x16x32_bf16 v[112:115], v[116:119], v[68:71], 0
  s_waitcnt lgkmcnt(4)
  v_mov_b64 v[98:99], 0
  v_mfma_f32_16x16x32_bf16 v[112:115], v[124:127], v[72:75], v[112:115]
  s_waitcnt lgkmcnt(2)
  v_mov_b64 v[36:37], 0
  v_exp_f32 v100, v16
  v_mfma_f32_16x16x32_bf16 v[112:115], v[104:107], v[76:79], v[112:115]
  s_waitcnt lgkmcnt(0)
  buffer_store_dwordx4 v[120:123], v2, s[4:7], s29 offen offset:2048 sc1
  v_exp_f32 v101, v17
  v_mfma_f32_16x16x32_bf16 v[112:115], v[108:111], v[80:83], v[112:115]
  v_exp_f32 v102, v18
  v_mfma_f32_16x16x32_bf16 v[20:23], v[52:55], v[68:71], 0
  s_cmp_eq_u32 s14, 63
  v_exp_f32 v103, v19
  v_mfma_f32_16x16x32_bf16 v[20:23], v[56:59], v[72:75], v[20:23]
  s_cbranch_scc1 M_tdone
  v_cvt_pk_bf16_f32 v44, v100, v101
  v_cvt_pk_bf16_f32 v45, v102, v103
  v_mfma_f32_16x16x32_bf16 v[20:23], v[60:63], v[76:79], v[20:23]
  s_add_u32 s29, s29, 131072
  v_exp_f32 v100, v112
  v_mfma_f32_16x16x32_bf16 v[20:23], v[64:67], v[80:83], v[20:23]
  v_exp_f32 v101, v113
  v_exp_f32 v102, v114
  v_exp_f32 v103, v115
  v_cvt_pk_bf16_f32 v84, v100, v101
  v_cvt_pk_bf16_f32 v85, v102, v103
  v_cndmask_b32 v48, v84, 0, s[16:17]
  v_cndmask_b32 v49, v85, 0, s[16:17]
  v_cndmask_b32 v50, 0, v84, s[16:17]
  v_cndmask_b32 v51, 0, v85, s[16:17]
  v_exp_f32 v100, v20
  v_mfma_f32_16x16x16_bf16 v[88:91], v[12:13], v[48:49], 0
  v_exp_f32 v101, v21
  v_mfma_f32_16x16x16_bf16 v[24:27], v[120:121], v[48:49], 0
  v_exp_f32 v102, v22
  v_mfma_f32_16x16x16_bf16 v[116:119], v[120:121], v[50:51], 0
  v_exp_f32 v103, v23
  v_cvt_pk_bf16_f32 v46, v100, v101
  v_cvt_pk_bf16_f32 v47, v102, v103
  v_mov_b64 v[38:39], 0
  s_nop 0
  v_mfma_f32_16x16x32_bf16 v[88:91], v[12:15], v[44:47], v[88:91]
  v_mov_b64 v[40:41], 0
  v_mov_b64 v[42:43], 0
  v_mfma_f32_16x16x32_bf16 v[24:27], v[28:31], v[44:47], v[24:27]
  ds_read_b128 v[52:55], v4 offset:24576
  ds_read_b128 v[56:59], v4 offset:25600
  v_mfma_f32_16x16x32_bf16 v[116:119], v[32:35], v[44:47], v[116:119]
  s_nop 1
  v_rcp_f32 v89, v88
  v_subrev_u32 v100, s54, v88
  v_cmp_le_u32 vcc, s55, v100
  v_mul_f32 v24, v89, v24
  v_mul_f32 v25, v89, v25
  s_cbranch_vccnz T_slow_108
T_back_109:
  v_cvt_pk_bf16_f32 v124, v24, v25
  v_pk_mul_f32 v[26:27], v[26:27], v[88:89] op_sel:[0,1] op_sel_hi:[1,1]
  v_pk_mul_f32 v[116:117], v[116:117], v[88:89] op_sel:[0,1] op_sel_hi:[1,1]
  v_pk_mul_f32 v[118:119], v[118:119], v[88:89] op_sel:[0,1] op_sel_hi:[1,1]
  v_cvt_pk_bf16_f32 v125, v26, v27
  v_cvt_pk_bf16_f32 v126, v116, v117
  v_cvt_pk_bf16_f32 v127, v118, v119
  ds_write_b128 v11, v[124:127] offset:30208
  s_nop 0
  v_smfmac_f32_16x16x64_bf16 v[92:95], v[124:127], a[160:167], v0
  v_smfmac_f32_16x16x64_bf16 v[96:99], v[124:127], a[168:175], v0
  v_smfmac_f32_16x16x64_bf16 v[36:39], v[124:127], a[176:183], v0
  v_smfmac_f32_16x16x64_bf16 v[40:43], v[124:127], a[184:191], v0
  s_waitcnt lgkmcnt(0)
  s_barrier
  ds_read_b128 v[104:107], v11 offset:30720
  ds_read_b128 v[108:111], v11 offset:29184
  ds_read_b128 v[68:71], v11 offset:29696
  s_waitcnt lgkmcnt(2)
  v_smfmac_f32_16x16x64_bf16 v[92:95], v[104:107], a[192:199], v0
  s_waitcnt lgkmcnt(1)
  ds_read_b128 v[76:79], v4 offset:28672
  v_smfmac_f32_16x16x64_bf16 v[92:95], v[108:111], a[224:231], v0
  s_waitcnt lgkmcnt(1)
  ds_read_b128 v[80:83], v4 offset:29696
  v_smfmac_f32_16x16x64_bf16 v[92:95], v[68:71], a[240:247], v0
  ds_read_b128 v[60:63], v4 offset:26624
  v_smfmac_f32_16x16x64_bf16 v[96:99], v[104:107], a[200:207], v0
  ds_read_b128 v[64:67], v4 offset:27648
  v_smfmac_f32_16x16x64_bf16 v[96:99], v[108:111], a[232:239], v0
  ds_read_b128 v[28:31], v4 offset:30720
  s_nop 0
  v_cvt_pk_bf16_f32 v16, v92, v93
  v_cvt_pk_bf16_f32 v17, v94, v95
  v_bfi_b32 v16, 1, s57, v16
  v_smfmac_f32_16x16x64_bf16 v[96:99], v[68:71], a[248:255], v0
  buffer_store_dwordx2 v[16:17], v7, s[4:7], s20 offen offset:0 sc1
  v_smfmac_f32_16x16x64_bf16 v[36:39], v[104:107], a[208:215], v0
  ds_read_b128 v[32:35], v4 offset:31744
  v_smfmac_f32_16x16x64_bf16 v[36:39], v[108:111], v[52:59], v0
  s_waitcnt lgkmcnt(4)
  s_nop 0
  v_cvt_pk_bf16_f32 v18, v96, v97
  v_cvt_pk_bf16_f32 v19, v98, v99
  v_bfi_b32 v18, 1, s57, v18
  v_smfmac_f32_16x16x64_bf16 v[36:39], v[68:71], v[76:83], v0
  buffer_store_dwordx2 v[18:19], v7, s[4:7], s20 offen offset:64 sc1
  v_smfmac_f32_16x16x64_bf16 v[40:43], v[104:107], a[216:223], v0
  s_waitcnt lgkmcnt(2)
  v_smfmac_f32_16x16x64_bf16 v[40:43], v[108:111], v[60:67], v0
  s_waitcnt lgkmcnt(0)
  s_nop 0
  v_cvt_pk_bf16_f32 v20, v36, v37
  v_cvt_pk_bf16_f32 v21, v38, v39
  v_bfi_b32 v20, 1, s57, v20
  v_smfmac_f32_16x16x64_bf16 v[40:43], v[68:71], v[28:35], v0
  buffer_store_dwordx2 v[20:21], v7, s[4:7], s21 offen offset:0 sc1
  s_nop 6
  v_cvt_pk_bf16_f32 v22, v40, v41
  v_cvt_pk_bf16_f32 v23, v42, v43
  v_bfi_b32 v22, 1, s57, v22
  buffer_store_dwordx2 v[22:23], v7, s[4:7], s21 offen offset:64 sc1
  ds_read_b128 v[68:71], v4 offset:0
  ds_read_b128 v[72:75], v4 offset:1024
  ds_read_b128 v[76:79], v4 offset:4096
  ds_read_b128 v[80:83], v4 offset:5120
  ds_read_b128 v[84:87], v4 offset:8192
  ds_read_b128 v[88:91], v4 offset:9216
  ds_read_b128 v[92:95], v4 offset:2048
  ds_read_b128 v[96:99], v4 offset:3072
  ds_read_b128 v[100:103], v4 offset:6144
  ds_read_b128 v[104:107], v4 offset:7168
  ds_read_b128 v[108:111], v4 offset:10240
  ds_read_b128 v[112:115], v4 offset:11264
  v_mov_b64 v[16:17], 0
  v_mov_b64 v[18:19], 0
  v_mov_b64 v[20:21], 0
  v_mov_b64 v[22:23], 0
  v_mov_b64 v[24:25], 0
  v_mov_b64 v[26:27], 0
  ds_read_b64 v[44:45], v2 offset:32256
  s_waitcnt lgkmcnt(0)
  v_readfirstlane_b32 s38, v44
  v_readfirstlane_b32 s37, v45
  s_nop 0
  s_add_u32 s37, s37, 30
  s_cmp_ge_u32 s38, 30
  s_cselect_b32 s38, s37, s38
  s_cmp_ge_u32 s38, 64
  s_cselect_b32 s38, 100, s38
  s_sub_u32 s38, s38, 1
  s_max_i32 s30, s30, s38
  s_waitcnt vmcnt(4)
  s_barrier
  ds_read_b128 v[28:31], v2 offset:18432
  ds_read_b128 v[32:35], v2 offset:22528
  ds_read_b128 v[36:39], v2 offset:8192
  ds_read_b128 v[40:43], v2 offset:9216
  ds_read_b128 v[44:47], v2 offset:10240
  ds_read_b128 v[48:51], v2 offset:11264
  buffer_load_dwordx4 v[124:127], v2, s[4:7], s24 offen offset:2048 sc1
  buffer_load_dwordx4 v[116:119], v2, s[4:7], s25 offen offset:2048 sc1
  ds_read_b128 v[52:55], v2 offset:12288
  ds_read_b128 v[56:59], v2 offset:13312
  ds_read_b128 v[60:63], v2 offset:14336
  ds_read_b128 v[64:67], v2 offset:15360
  buffer_load_dwordx4 v[124:127], v2, s[4:7], s24 offen offset:2048 sc1
  buffer_load_dwordx4 v[116:119], v2, s[4:7], s25 offen offset:2048 sc1
  s_mov_b32 s19, 0
  s_branch T_loop_101
T_kvw_105:
  s_mov_b32 s19, 0
  s_branch T_kvok_114
T_kv_113:
  s_sleep 4
  s_add_u32 s19, s19, 1
  s_cmp_gt_u32 s19, 32768
  s_cbranch_scc1 M_exit
T_kvok_114:
  s_add_u32 s39, s99, 128
  s_mov_b32 s38, 0
  s_mov_b32 s37, 0
  s_atomic_or s38, s[58:59], s99 glc
  s_atomic_or s37, s[58:59], s39 glc
  s_waitcnt lgkmcnt(0)
  s_add_u32 s37, s37, 30
  s_cmp_ge_u32 s38, 30
  s_cselect_b32 s38, s37, s38
  s_cmp_ge_u32 s38, 64
  s_cselect_b32 s38, 100, s38
  s_sub_u32 s38, s38, 1
  s_max_i32 s30, s30, s38
  s_cmp_ge_i32 s14, s30
  s_cbranch_scc1 T_kv_113
  s_branch T_kvb_106
T_slow_108:
  s_nop 7
  v_max3_f32 v100, v16, v17, v18
  v_max3_f32 v100, v100, v19, v20
  v_max3_f32 v100, v100, v21, v22
  v_max3_f32 v100, v100, v23, v112
  v_max3_f32 v100, v100, v113, v114
  v_max_f32 v100, v100, v115
  v_mov_b32 v101, v100
  s_nop 1
  v_permlane32_swap_b32 v100, v101
  s_nop 1
  v_max_f32 v100, v100, v101
  v_mov_b32 v101, v100
  s_nop 1
  v_permlane16_swap_b32 v100, v101
  s_nop 1
  v_max_f32 v100, v100, v101
  v_sub_f32 v16, v16, v100
  v_sub_f32 v17, v17, v100
  v_sub_f32 v18, v18, v100
  v_sub_f32 v19, v19, v100
  v_exp_f32 v16, v16
  v_exp_f32 v17, v17
  v_exp_f32 v18, v18
  v_exp_f32 v19, v19
  v_sub_f32 v20, v20, v100
  v_sub_f32 v21, v21, v100
  v_sub_f32 v22, v22, v100
  v_sub_f32 v23, v23, v100
  v_exp_f32 v20, v20
  v_exp_f32 v21, v21
  v_exp_f32 v22, v22
  v_exp_f32 v23, v23
  v_sub_f32 v112, v112, v100
  v_sub_f32 v113, v113, v100
  v_sub_f32 v114, v114, v100
  v_sub_f32 v115, v115, v100
  v_exp_f32 v112, v112
  v_exp_f32 v113, v113
  v_exp_f32 v114, v114
  v_exp_f32 v115, v115
  s_nop 0
  v_cvt_pk_bf16_f32 v44, v16, v17
  v_cvt_pk_bf16_f32 v45, v18, v19
  v_cvt_pk_bf16_f32 v46, v20, v21
  v_cvt_pk_bf16_f32 v47, v22, v23
  v_cvt_pk_bf16_f32 v84, v112, v113
  v_cvt_pk_bf16_f32 v85, v114, v115
  v_cndmask_b32 v48, v84, 0, s[16:17]
  v_cndmask_b32 v49, v85, 0, s[16:17]
  v_cndmask_b32 v50, 0, v84, s[16:17]
  v_cndmask_b32 v51, 0, v85, s[16:17]
  s_nop 1
  v_mfma_f32_16x16x16_bf16 v[88:91], v[12:13], v[48:49], 0
  v_mfma_f32_16x16x16_bf16 v[24:27], v[120:121], v[48:49], 0
  v_mfma_f32_16x16x16_bf16 v[116:119], v[120:121], v[50:51], 0
  v_mfma_f32_16x16x32_bf16 v[88:91], v[12:15], v[44:47], v[88:91]
  v_mfma_f32_16x16x32_bf16 v[24:27], v[28:31], v[44:47], v[24:27]
  v_mfma_f32_16x16x32_bf16 v[116:119], v[32:35], v[44:47], v[116:119]
  s_nop 7
  s_nop 1
  v_rcp_f32 v89, v88
  s_nop 0
  v_mul_f32 v24, v89, v24
  v_mul_f32 v25, v89, v25
  s_branch T_back_109
T_w_72:
  s_mov_b32 s19, 0
  v_mov_b64 v[16:17], 0
  v_mov_b64 v[18:19], 0
  v_mov_b64 v[20:21], 0
  v_mov_b64 v[22:23], 0
  v_mov_b64 v[24:25], 0
  v_mov_b64 v[26:27], 0
  buffer_load_dwordx4 v[124:127], v2, s[4:7], s24 offen offset:3072 sc1
  buffer_load_dwordx4 v[116:119], v2, s[4:7], s25 offen offset:3072 sc1
  buffer_load_dwordx4 v[124:127], v2, s[4:7], s24 offen offset:3072 sc1
  buffer_load_dwordx4 v[116:119], v2, s[4:7], s25 offen offset:3072 sc1
  s_branch T_loop_115
.p2align 6
T_retry_116:
  s_mov_b64 exec, vcc
  buffer_load_dwordx4 v[124:127], v2, s[4:7], s24 offen offset:3072 sc1
  buffer_load_dwordx4 v[116:119], v2, s[4:7], s25 offen offset:3072 sc1
  s_mov_b64 exec, -1
  s_add_u32 s19, s19, 1
  s_cmp_gt_u32 s19, 32768
  s_cbranch_scc1 M_exit
T_loop_115:
  s_waitcnt vmcnt(3) lgkmcnt(0)
  v_max3_u32 v123, v124, v125, v126
  v_max_u32 v123, v123, v127
  v_mov_b32_dpp v120, v124 row_ror:8 row_mask:0xf bank_mask:0xf
  v_mov_b32_dpp v121, v125 row_ror:8 row_mask:0xf bank_mask:0xf
  s_waitcnt vmcnt(2)
  v_max3_u32 v123, v123, v116, v117
  v_max3_u32 v123, v123, v118, v119
  v_cmp_eq_u32 vcc, -1, v123
  s_cbranch_vccnz T_retry_116
  v_smfmac_f32_16x16x64_bf16 v[16:19], v[124:127], v[68:75], v0
  s_add_u32 s14, s14, 1
  ds_write_b128 v2, v[124:127] offset:3072
  v_mov_b32_dpp v122, v126 row_ror:8 row_mask:0xf bank_mask:0xf
  v_smfmac_f32_16x16x64_bf16 v[20:23], v[124:127], v[76:83], v0
  s_and_b32 s57, s14, 1
  v_mov_b32_dpp v123, v127 row_ror:8 row_mask:0xf bank_mask:0xf
  v_smfmac_f32_16x16x64_bf16 v[24:27], v[124:127], v[84:91], v0
  s_and_b32 s36, s14, 3
  ds_write_b128 v2, v[116:119] offset:7168
  v_smfmac_f32_16x16x64_bf16 v[16:19], v[120:123], v[92:99], v0
  s_lshl_b32 s36, s36, 13
  v_mov_b32_dpp v84, v116 row_ror:8 row_mask:0xf bank_mask:0xf
  v_smfmac_f32_16x16x64_bf16 v[20:23], v[120:123], v[100:107], v0
  s_add_u32 s26, s36, s23
  ds_read_b128 v[68:71], v4 offset:12288
  v_mov_b32_dpp v85, v117 row_ror:8 row_mask:0xf bank_mask:0xf
  v_smfmac_f32_16x16x64_bf16 v[24:27], v[120:123], v[108:115], v0
  s_add_u32 s36, s36, 8192
  ds_read_b128 v[72:75], v4 offset:13312
  v_mov_b32_dpp v86, v118 row_ror:8 row_mask:0xf bank_mask:0xf
  v_smfmac_f32_16x16x64_bf16 v[16:19], v[116:119], v[224:231], v0
  s_and_b32 s36, s36, 0x7fff
  ds_read_b128 v[76:79], v4 offset:14336
  v_mov_b32_dpp v87, v119 row_ror:8 row_mask:0xf bank_mask:0xf
  v_smfmac_f32_16x16x64_bf16 v[20:23], v[116:119], v[240:247], v0
  s_waitcnt lgkmcnt(3)
  s_barrier
  ds_read_b128 v[100:103], v2 offset:2048
  v_smfmac_f32_16x16x64_bf16 v[24:27], v[116:119], a[0:7], v0
  s_mov_b32 m0, s31
  ds_read_b128 v[120:123], v1 offset:2048
  v_smfmac_f32_16x16x64_bf16 v[16:19], v[84:87], v[232:239], v0
  s_cmp_ge_i32 s14, s30
  s_cbranch_scc1 T_kvw_119
T_kvb_120:
  v_smfmac_f32_16x16x64_bf16 v[20:23], v[84:87], v[248:255], v0
  ds_read_b128 v[80:83], v4 offset:15360
  v_smfmac_f32_16x16x64_bf16 v[24:27], v[84:87], a[8:15], v0
  s_waitcnt lgkmcnt(2)
  v_smfmac_f32_16x16x64_bf16 v[16:19], v[100:103], v[128:135], v0
  ds_read_b128 v[92:95], v2 offset:1024
  v_smfmac_f32_16x16x64_bf16 v[20:23], v[100:103], v[144:151], v0
  ds_read_b128 v[96:99], v1 offset:1024
  buffer_load_dwordx4 v9, s[4:7], s27 offen sc1 lds
  v_smfmac_f32_16x16x64_bf16 v[24:27], v[100:103], v[68:75], v0
  s_waitcnt vmcnt(1) lgkmcnt(3)
  ds_read_b128 v[116:119], v2 offset:0
  s_mov_b32 m0, s32
  v_smfmac_f32_16x16x64_bf16 v[16:19], v[120:123], v[136:143], v0
  ds_read_b128 v[124:127], v1 offset:0
  v_smfmac_f32_16x16x64_bf16 v[20:23], v[120:123], v[152:159], v0
  s_waitcnt lgkmcnt(4)
  ds_read_b128 v[104:107], v2 offset:6144
  v_smfmac_f32_16x16x64_bf16 v[24:27], v[120:123], v[76:83], v0
  s_waitcnt lgkmcnt(4)
  ds_read_b128 v[108:111], v1 offset:6144
  buffer_load_dwordx4 v9, s[4:7], s27 offen offset:128 sc1 lds
  v_smfmac_f32_16x16x64_bf16 v[16:19], v[92:95], v[160:167], v0
  s_waitcnt lgkmcnt(4)
  ds_read_b128 v[112:115], v2 offset:5120
  s_mov_b32 m0, s33
  v_smfmac_f32_16x16x64_bf16 v[16:19], v[96:99], v[168:175], v0
  s_waitcnt lgkmcnt(4)
  ds_read_b128 v[84:87], v1 offset:5120
  v_smfmac_f32_16x16x64_bf16 v[16:19], v[116:119], v[192:199], v0
  s_waitcnt lgkmcnt(4)
  ds_read_b128 v[88:91], v2 offset:4096
  v_smfmac_f32_16x16x64_bf16 v[16:19], v[124:127], v[200:207], v0
  s_waitcnt lgkmcnt(4)
  ds_read_b128 v[100:103], v1 offset:4096
  buffer_load_dwordx4 v10, s[4:7], s28 offen sc1 lds
  v_smfmac_f32_16x16x64_bf16 v[16:19], v[104:107], a[16:23], v0
  s_waitcnt lgkmcnt(4)
  ds_read_b128 v[68:71], v4 offset:16384
  s_mov_b32 m0, s34
  v_smfmac_f32_16x16x64_bf16 v[16:19], v[108:111], a[24:31], v0
  s_waitcnt lgkmcnt(4)
  ds_read_b128 v[72:75], v4 offset:17408
  v_smfmac_f32_16x16x64_bf16 v[16:19], v[112:115], a[64:71], v0
  s_waitcnt lgkmcnt(4)
  ds_read_b128 v[76:79], v4 offset:18432
  v_smfmac_f32_16x16x64_bf16 v[16:19], v[84:87], a[72:79], v0
  s_waitcnt lgkmcnt(4)
  ds_read_b128 v[80:83], v4 offset:19456
  buffer_load_dwordx4 v10, s[4:7], s28 offen offset:256 sc1 lds
  v_smfmac_f32_16x16x64_bf16 v[16:19], v[88:91], a[112:119], v0
  s_waitcnt lgkmcnt(4)
  s_mov_b32 m0, 32256
  v_smfmac_f32_16x16x64_bf16 v[16:19], v[100:103], a[120:127], v0
  s_add_u32 s24, s36, 145752064
  s_add_u32 s25, s36, 145756160
  v_smfmac_f32_16x16x64_bf16 v[20:23], v[92:95], v[176:183], v0
  s_add_u32 s35, s36, s23
  v_smfmac_f32_16x16x64_bf16 v[20:23], v[96:99], v[184:191], v0
  s_waitcnt lgkmcnt(2)
  buffer_load_dword v3, s[4:7], s99 offen sc1 lds
  v_smfmac_f32_16x16x64_bf16 v[20:23], v[116:119], v[68:75], v0
  s_waitcnt lgkmcnt(0)
  ds_read_b128 v[68:71], v4 offset:20480
  v_mul_f32 v16, s18, v16
  v_smfmac_f32_16x16x64_bf16 v[20:23], v[124:127], v[76:83], v0
  ds_read_b128 v[72:75], v4 offset:21504
  v_mul_f32 v17, s18, v17
  v_smfmac_f32_16x16x64_bf16 v[20:23], v[104:107], a[32:39], v0
  ds_read_b128 v[76:79], v4 offset:22528
  v_mul_f32 v18, s18, v18
  v_smfmac_f32_16x16x64_bf16 v[20:23], v[108:111], a[40:47], v0
  ds_read_b128 v[80:83], v4 offset:23552
  v_mul_f32 v19, s18, v19
  v_smfmac_f32_16x16x64_bf16 v[20:23], v[112:115], a[80:87], v0
  v_cvt_pk_bf16_f32 v120, v16, v17
  v_smfmac_f32_16x16x64_bf16 v[20:23], v[84:87], a[88:95], v0
  v_cvt_pk_bf16_f32 v121, v18, v19
  v_smfmac_f32_16x16x64_bf16 v[20:23], v[88:91], a[128:135], v0
  ds_write_b64 v5, v[120:121] offset:24576
  v_smfmac_f32_16x16x64_bf16 v[20:23], v[100:103], a[136:143], v0
  s_waitcnt lgkmcnt(3)
  v_smfmac_f32_16x16x64_bf16 v[24:27], v[92:95], v[68:75], v0
  s_waitcnt lgkmcnt(1)
  v_mov_b64 v[92:93], 0
  v_smfmac_f32_16x16x64_bf16 v[24:27], v[96:99], v[76:83], v0
  s_nop 1
  v_cvt_pk_bf16_f32 v122, v20, v21
  v_cvt_pk_bf16_f32 v123, v22, v23
  v_smfmac_f32_16x16x64_bf16 v[24:27], v[116:119], v[208:215], v0
  ds_write_b64 v5, v[122:123] offset:26880
  v_mov_b64 v[94:95], 0
  v_smfmac_f32_16x16x64_bf16 v[24:27], v[124:127], v[216:223], v0
  s_waitcnt lgkmcnt(1)
  s_barrier
  ds_read_b64_tr_b16 v[68:69], v6 offset:24576
  v_smfmac_f32_16x16x64_bf16 v[24:27], v[104:107], a[48:55], v0
  s_add_u32 s27, s27, 8192
  ds_read_b64_tr_b16 v[70:71], v6 offset:24640
  ds_read_b64_tr_b16 v[72:73], v6 offset:24832
  v_smfmac_f32_16x16x64_bf16 v[24:27], v[108:111], a[56:63], v0
  s_add_u32 s28, s28, 8192
  ds_read_b64_tr_b16 v[74:75], v6 offset:24896
  ds_read_b64_tr_b16 v[76:77], v6 offset:25088
  v_smfmac_f32_16x16x64_bf16 v[24:27], v[112:115], a[96:103], v0
  s_nop 0
  ds_read_b64_tr_b16 v[78:79], v6 offset:25152
  ds_read_b64_tr_b16 v[80:81], v6 offset:25344
  v_smfmac_f32_16x16x64_bf16 v[24:27], v[84:87], a[104:111], v0
  ds_read_b64_tr_b16 v[82:83], v6 offset:25408
  v_mov_b64 v[96:97], 0
  v_smfmac_f32_16x16x64_bf16 v[24:27], v[88:91], a[144:151], v0
  s_waitcnt lgkmcnt(8)
  s_barrier
  ds_read_b64_tr_b16 v[116:117], v6 offset:26880
  v_smfmac_f32_16x16x64_bf16 v[24:27], v[100:103], a[152:159], v0
  s_waitcnt lgkmcnt(7)
  ds_read_b64_tr_b16 v[118:119], v6 offset:26944
  v_mfma_f32_16x16x32_bf16 v[16:19], v[36:39], v[68:71], 0
  s_waitcnt lgkmcnt(6)
  ds_read_b64_tr_b16 v[124:125], v6 offset:27136
  ds_read_b64_tr_b16 v[126:127], v6 offset:27200
  v_mfma_f32_16x16x32_bf16 v[16:19], v[40:43], v[72:75], v[16:19]
  s_waitcnt lgkmcnt(6)
  ds_read_b64_tr_b16 v[104:105], v6 offset:27392
  ds_read_b64_tr_b16 v[106:107], v6 offset:27456
  v_mfma_f32_16x16x32_bf16 v[16:19], v[44:47], v[76:79], v[16:19]
  s_waitcnt lgkmcnt(6)
  ds_read_b64_tr_b16 v[108:109], v6 offset:27648
  ds_read_b64_tr_b16 v[110:111], v6 offset:27712
  v_mfma_f32_16x16x32_bf16 v[16:19], v[48:51], v[80:83], v[16:19]
  s_waitcnt lgkmcnt(6)
  v_cvt_pk_bf16_f32 v120, v24, v25
  v_cvt_pk_bf16_f32 v121, v26, v27
  v_mfma_f32_16x16x32_bf16 v[112:115], v[116:119], v[68:71], 0
  s_waitcnt lgkmcnt(4)
  v_mov_b64 v[98:99], 0
  v_mfma_f32_16x16x32_bf16 v[112:115], v[124:127], v[72:75], v[112:115]
  s_waitcnt lgkmcnt(2)
  v_mov_b64 v[36:37], 0
  v_exp_f32 v100, v16
  v_mfma_f32_16x16x32_bf16 v[112:115], v[104:107], v[76:79], v[112:115]
  s_waitcnt lgkmcnt(0)
  v_exp_f32 v101, v17
  v_mfma_f32_16x16x32_bf16 v[112:115], v[108:111], v[80:83], v[112:115]
  buffer_store_dwordx4 v[120:123], v2, s[4:7], s29 offen offset:3072 sc1
  v_exp_f32 v102, v18
  v_mfma_f32_16x16x32_bf16 v[20:23], v[52:55], v[68:71], 0
  s_cmp_eq_u32 s14, 63
  v_exp_f32 v103, v19
  v_mfma_f32_16x16x32_bf16 v[20:23], v[56:59], v[72:75], v[20:23]
  s_cbranch_scc1 M_tdone
  v_cvt_pk_bf16_f32 v44, v100, v101
  v_cvt_pk_bf16_f32 v45, v102, v103
  v_mfma_f32_16x16x32_bf16 v[20:23], v[60:63], v[76:79], v[20:23]
  s_add_u32 s29, s29, 131072
  v_exp_f32 v100, v112
  v_mfma_f32_16x16x32_bf16 v[20:23], v[64:67], v[80:83], v[20:23]
  v_exp_f32 v101, v113
  v_exp_f32 v102, v114
  v_exp_f32 v103, v115
  v_cvt_pk_bf16_f32 v84, v100, v101
  v_cvt_pk_bf16_f32 v85, v102, v103
  v_cndmask_b32 v48, v84, 0, s[16:17]
  v_cndmask_b32 v49, v85, 0, s[16:17]
  v_cndmask_b32 v50, 0, v84, s[16:17]
  v_cndmask_b32 v51, 0, v85, s[16:17]
  v_exp_f32 v100, v20
  v_mfma_f32_16x16x16_bf16 v[88:91], v[12:13], v[48:49], 0
  v_exp_f32 v101, v21
  v_mfma_f32_16x16x16_bf16 v[24:27], v[120:121], v[48:49], 0
  v_exp_f32 v102, v22
  v_mfma_f32_16x16x16_bf16 v[116:119], v[120:121], v[50:51], 0
  v_exp_f32 v103, v23
  v_cvt_pk_bf16_f32 v46, v100, v101
  v_cvt_pk_bf16_f32 v47, v102, v103
  v_mov_b64 v[38:39], 0
  s_nop 0
  v_mfma_f32_16x16x32_bf16 v[88:91], v[12:15], v[44:47], v[88:91]
  v_mov_b64 v[40:41], 0
  v_mov_b64 v[42:43], 0
  v_mfma_f32_16x16x32_bf16 v[24:27], v[28:31], v[44:47], v[24:27]
  ds_read_b128 v[52:55], v4 offset:24576
  ds_read_b128 v[56:59], v4 offset:25600
  v_mfma_f32_16x16x32_bf16 v[116:119], v[32:35], v[44:47], v[116:119]
  s_nop 1
  v_rcp_f32 v89, v88
  v_subrev_u32 v100, s54, v88
  v_cmp_le_u32 vcc, s55, v100
  v_mul_f32 v24, v89, v24
  v_mul_f32 v25, v89, v25
  s_cbranch_vccnz T_slow_122
T_back_123:
  v_cvt_pk_bf16_f32 v124, v24, v25
  v_pk_mul_f32 v[26:27], v[26:27], v[88:89] op_sel:[0,1] op_sel_hi:[1,1]
  v_pk_mul_f32 v[116:117], v[116:117], v[88:89] op_sel:[0,1] op_sel_hi:[1,1]
  v_pk_mul_f32 v[118:119], v[118:119], v[88:89] op_sel:[0,1] op_sel_hi:[1,1]
  v_cvt_pk_bf16_f32 v125, v26, v27
  v_cvt_pk_bf16_f32 v126, v116, v117
  v_cvt_pk_bf16_f32 v127, v118, v119
  ds_write_b128 v11, v[124:127] offset:30720
  s_nop 0
  v_smfmac_f32_16x16x64_bf16 v[92:95], v[124:127], a[160:167], v0
  v_smfmac_f32_16x16x64_bf16 v[96:99], v[124:127], a[168:175], v0
  v_smfmac_f32_16x16x64_bf16 v[36:39], v[124:127], a[176:183], v0
  v_smfmac_f32_16x16x64_bf16 v[40:43], v[124:127], a[184:191], v0
  s_waitcnt lgkmcnt(0)
  s_barrier
  ds_read_b128 v[104:107], v11 offset:30208
  ds_read_b128 v[108:111], v11 offset:29696
  ds_read_b128 v[68:71], v11 offset:29184
  s_waitcnt lgkmcnt(2)
  v_smfmac_f32_16x16x64_bf16 v[92:95], v[104:107], a[192:199], v0
  s_waitcnt lgkmcnt(1)
  ds_read_b128 v[76:79], v4 offset:28672
  v_smfmac_f32_16x16x64_bf16 v[92:95], v[108:111], a[224:231], v0
  s_waitcnt lgkmcnt(1)
  ds_read_b128 v[80:83], v4 offset:29696
  v_smfmac_f32_16x16x64_bf16 v[92:95], v[68:71], a[240:247], v0
  ds_read_b128 v[60:63], v4 offset:26624
  v_smfmac_f32_16x16x64_bf16 v[96:99], v[104:107], a[200:207], v0
  ds_read_b128 v[64:67], v4 offset:27648
  v_smfmac_f32_16x16x64_bf16 v[96:99], v[108:111], a[232:239], v0
  ds_read_b128 v[28:31], v4 offset:30720
  s_nop 0
  v_cvt_pk_bf16_f32 v16, v92, v93
  v_cvt_pk_bf16_f32 v17, v94, v95
  v_bfi_b32 v16, 1, s57, v16
  v_smfmac_f32_16x16x64_bf16 v[96:99], v[68:71], a[248:255], v0
  buffer_store_dwordx2 v[16:17], v7, s[4:7], s20 offen offset:0 sc1
  v_smfmac_f32_16x16x64_bf16 v[36:39], v[104:107], a[208:215], v0
  ds_read_b128 v[32:35], v4 offset:31744
  v_smfmac_f32_16x16x64_bf16 v[36:39], v[108:111], v[52:59], v0
  s_waitcnt lgkmcnt(4)
  s_nop 0
  v_cvt_pk_bf16_f32 v18, v96, v97
  v_cvt_pk_bf16_f32 v19, v98, v99
  v_bfi_b32 v18, 1, s57, v18
  v_smfmac_f32_16x16x64_bf16 v[36:39], v[68:71], v[76:83], v0
  buffer_store_dwordx2 v[18:19], v7, s[4:7], s20 offen offset:64 sc1
  v_smfmac_f32_16x16x64_bf16 v[40:43], v[104:107], a[216:223], v0
  s_waitcnt lgkmcnt(2)
  v_smfmac_f32_16x16x64_bf16 v[40:43], v[108:111], v[60:67], v0
  s_waitcnt lgkmcnt(0)
  s_nop 0
  v_cvt_pk_bf16_f32 v20, v36, v37
  v_cvt_pk_bf16_f32 v21, v38, v39
  v_bfi_b32 v20, 1, s57, v20
  v_smfmac_f32_16x16x64_bf16 v[40:43], v[68:71], v[28:35], v0
  buffer_store_dwordx2 v[20:21], v7, s[4:7], s21 offen offset:0 sc1
  s_nop 6
  v_cvt_pk_bf16_f32 v22, v40, v41
  v_cvt_pk_bf16_f32 v23, v42, v43
  v_bfi_b32 v22, 1, s57, v22
  buffer_store_dwordx2 v[22:23], v7, s[4:7], s21 offen offset:64 sc1
  ds_read_b128 v[68:71], v4 offset:0
  ds_read_b128 v[72:75], v4 offset:1024
  ds_read_b128 v[76:79], v4 offset:4096
  ds_read_b128 v[80:83], v4 offset:5120
  ds_read_b128 v[84:87], v4 offset:8192
  ds_read_b128 v[88:91], v4 offset:9216
  ds_read_b128 v[92:95], v4 offset:2048
  ds_read_b128 v[96:99], v4 offset:3072
  ds_read_b128 v[100:103], v4 offset:6144
  ds_read_b128 v[104:107], v4 offset:7168
  ds_read_b128 v[108:111], v4 offset:10240
  ds_read_b128 v[112:115], v4 offset:11264
  v_mov_b64 v[16:17], 0
  v_mov_b64 v[18:19], 0
  v_mov_b64 v[20:21], 0
  v_mov_b64 v[22:23], 0
  v_mov_b64 v[24:25], 0
  v_mov_b64 v[26:27], 0
  ds_read_b64 v[44:45], v2 offset:32256
  s_waitcnt lgkmcnt(0)
  v_readfirstlane_b32 s38, v44
  v_readfirstlane_b32 s37, v45
  s_nop 0
  s_add_u32 s37, s37, 30
  s_cmp_ge_u32 s38, 30
  s_cselect_b32 s38, s37, s38
  s_cmp_ge_u32 s38, 64
  s_cselect_b32 s38, 100, s38
  s_sub_u32 s38, s38, 1
  s_max_i32 s30, s30, s38
  s_waitcnt vmcnt(4)
  s_barrier
  ds_read_b128 v[28:31], v2 offset:19456
  ds_read_b128 v[32:35], v2 offset:23552
  ds_read_b128 v[36:39], v2 offset:8192
  ds_read_b128 v[40:43], v2 offset:9216
  ds_read_b128 v[44:47], v2 offset:10240
  ds_read_b128 v[48:51], v2 offset:11264
  buffer_load_dwordx4 v[124:127], v2, s[4:7], s24 offen offset:3072 sc1
  buffer_load_dwordx4 v[116:119], v2, s[4:7], s25 offen offset:3072 sc1
  ds_read_b128 v[52:55], v2 offset:12288
  ds_read_b128 v[56:59], v2 offset:13312
  ds_read_b128 v[60:63], v2 offset:14336
  ds_read_b128 v[64:67], v2 offset:15360
  buffer_load_dwordx4 v[124:127], v2, s[4:7], s24 offen offset:3072 sc1
  buffer_load_dwordx4 v[116:119], v2, s[4:7], s25 offen offset:3072 sc1
  s_mov_b32 s19, 0
  s_branch T_loop_115
T_kvw_119:
  s_mov_b32 s19, 0
  s_branch T_kvok_128
T_kv_127:
  s_sleep 4
  s_add_u32 s19, s19, 1
  s_cmp_gt_u32 s19, 32768
  s_cbranch_scc1 M_exit
T_kvok_128:
  s_add_u32 s39, s99, 128
  s_mov_b32 s38, 0
  s_mov_b32 s37, 0
  s_atomic_or s38, s[58:59], s99 glc
  s_atomic_or s37, s[58:59], s39 glc
  s_waitcnt lgkmcnt(0)
  s_add_u32 s37, s37, 30
  s_cmp_ge_u32 s38, 30
  s_cselect_b32 s38, s37, s38
  s_cmp_ge_u32 s38, 64
  s_cselect_b32 s38, 100, s38
  s_sub_u32 s38, s38, 1
  s_max_i32 s30, s30, s38
  s_cmp_ge_i32 s14, s30
  s_cbranch_scc1 T_kv_127
  s_branch T_kvb_120
T_slow_122:
  s_nop 7
  v_max3_f32 v100, v16, v17, v18
  v_max3_f32 v100, v100, v19, v20
  v_max3_f32 v100, v100, v21, v22
  v_max3_f32 v100, v100, v23, v112
  v_max3_f32 v100, v100, v113, v114
  v_max_f32 v100, v100, v115
  v_mov_b32 v101, v100
  s_nop 1
  v_permlane32_swap_b32 v100, v101
  s_nop 1
  v_max_f32 v100, v100, v101
  v_mov_b32 v101, v100
  s_nop 1
  v_permlane16_swap_b32 v100, v101
  s_nop 1
  v_max_f32 v100, v100, v101
  v_sub_f32 v16, v16, v100
  v_sub_f32 v17, v17, v100
  v_sub_f32 v18, v18, v100
  v_sub_f32 v19, v19, v100
  v_exp_f32 v16, v16
  v_exp_f32 v17, v17
  v_exp_f32 v18, v18
  v_exp_f32 v19, v19
  v_sub_f32 v20, v20, v100
  v_sub_f32 v21, v21, v100
  v_sub_f32 v22, v22, v100
  v_sub_f32 v23, v23, v100
  v_exp_f32 v20, v20
  v_exp_f32 v21, v21
  v_exp_f32 v22, v22
  v_exp_f32 v23, v23
  v_sub_f32 v112, v112, v100
  v_sub_f32 v113, v113, v100
  v_sub_f32 v114, v114, v100
  v_sub_f32 v115, v115, v100
  v_exp_f32 v112, v112
  v_exp_f32 v113, v113
  v_exp_f32 v114, v114
  v_exp_f32 v115, v115
  s_nop 0
  v_cvt_pk_bf16_f32 v44, v16, v17
  v_cvt_pk_bf16_f32 v45, v18, v19
  v_cvt_pk_bf16_f32 v46, v20, v21
  v_cvt_pk_bf16_f32 v47, v22, v23
  v_cvt_pk_bf16_f32 v84, v112, v113
  v_cvt_pk_bf16_f32 v85, v114, v115
  v_cndmask_b32 v48, v84, 0, s[16:17]
  v_cndmask_b32 v49, v85, 0, s[16:17]
  v_cndmask_b32 v50, 0, v84, s[16:17]
  v_cndmask_b32 v51, 0, v85, s[16:17]
  s_nop 1
  v_mfma_f32_16x16x16_bf16 v[88:91], v[12:13], v[48:49], 0
  v_mfma_f32_16x16x16_bf16 v[24:27], v[120:121], v[48:49], 0
  v_mfma_f32_16x16x16_bf16 v[116:119], v[120:121], v[50:51], 0
  v_mfma_f32_16x16x32_bf16 v[88:91], v[12:15], v[44:47], v[88:91]
  v_mfma_f32_16x16x32_bf16 v[24:27], v[28:31], v[44:47], v[24:27]
  v_mfma_f32_16x16x32_bf16 v[116:119], v[32:35], v[44:47], v[116:119]
  s_nop 7
  s_nop 1
  v_rcp_f32 v89, v88
  s_nop 0
  v_mul_f32 v24, v89, v24
  v_mul_f32 v25, v89, v25
  s_branch T_back_123
M_tdone:
  v_mov_b32 v16, 64
  v_or_b32 v17, s13, v2
  v_min_u32 v17, 1, v17
  v_lshlrev_b32 v17, 30, v17
  s_waitcnt vmcnt(0)
  s_barrier
  buffer_store_dword v16, v17, s[4:7], s15 offen sc1
  s_branch M_done
M_worker:
  s_load_dwordx4 s[72:75], s[0:1], 120
  v_lshrrev_b32 v3, 6, v0
  v_and_b32 v1, 63, v0
  v_readfirstlane_b32 s16, v3
  v_lshlrev_b32 v2, 4, v1
  s_waitcnt lgkmcnt(0)
  s_mov_b64 s[4:5], s[74:75]
  s_mov_b64 s[74:75], s[72:73]
  s_mov_b64 s[72:73], s[4:5]
  s_and_b32 s5, s5, 0xffff
  s_mov_b32 s6, 268435456
  s_mov_b32 s7, 0x20000
  s_sub_u32 s66, s76, 1
  s_lshl_b32 s66, s66, 5
  s_add_u32 s66, s66, s77
  s_mul_i32 s64, s66, 9363
  s_lshr_b32 s64, s64, 16
  s_mul_i32 s67, s64, 7
  s_sub_u32 s65, s66, s67
  s_lshl_b32 s31, s66, 7
  s_add_u32 s31, s31, 148897792
  s_lshl_b32 s67, s67, 7
  s_add_u32 s67, s67, 148897792
  s_getpc_b64 s[76:77]
M_pc:
  s_add_u32 s76, s76, M_table-M_pc
  s_addc_u32 s77, s77, 0
  s_lshl_b32 s26, s65, 6
  s_load_dwordx16 s[48:63], s[76:77], s26
  s_waitcnt lgkmcnt(0)
  s_mov_b32 s23, s51
  s_cmp_lg_u32 s48, 1
  s_cbranch_scc1 M_nobpf
  s_load_dwordx8 s[36:43], s[0:1], 64
  s_mul_i32 s76, s64, 3
  s_add_u32 s76, s76, s57
  v_lshlrev_b32 v4, 7, v0
  s_mov_b32 s10, 4194304
  s_mov_b32 s11, 0x20000
  s_waitcnt lgkmcnt(0)
  s_mov_b32 s8, s42
  s_and_b32 s9, s43, 0xffff
  s_mul_i32 s77, s76, 43776
  s_add_u32 s77, s77, 0
  v_min_u32 v5, 32640, v4
  v_add_u32 v5, s77, v5
  s_add_u32 s77, s77, 32768
  buffer_load_dword v6, v5, s[8:11], 0 offen
  v_min_u32 v5, 10880, v4
  v_add_u32 v5, s77, v5
  s_add_u32 s77, s77, 32768
  buffer_load_dword v6, v5, s[8:11], 0 offen
  s_mov_b32 s8, s38
  s_and_b32 s9, s39, 0xffff
  s_mul_i32 s77, s76, 21888
  s_add_u32 s77, s77, 2097152
  v_min_u32 v5, 21760, v4
  v_add_u32 v5, s77, v5
  s_add_u32 s77, s77, 32768
  buffer_load_dword v6, v5, s[8:11], 0 offen
  s_mov_b32 s8, s40
  s_and_b32 s9, s41, 0xffff
  s_mul_i32 s77, s76, 21888
  s_add_u32 s77, s77, 2097152
  v_min_u32 v5, 21760, v4
  v_add_u32 v5, s77, v5
  s_add_u32 s77, s77, 32768
  buffer_load_dword v6, v5, s[8:11], 0 offen
  s_mov_b32 s8, s36
  s_and_b32 s9, s37, 0xffff
  s_mul_i32 s77, s76, 21888
  s_add_u32 s77, s77, 2097152
  v_min_u32 v5, 21760, v4
  v_add_u32 v5, s77, v5
  s_add_u32 s77, s77, 32768
  buffer_load_dword v6, v5, s[8:11], 0 offen
  s_waitcnt vmcnt(0)
M_nobpf:
  s_lshr_b32 s29, s16, 1
  s_cmp_eq_u32 s29, 0
  s_cselect_b32 s26, 2, 8
  s_cselect_b32 s27, 3, 4
  s_cselect_b32 s28, 9, 10
  s_cmp_eq_u32 s48, 1
  s_cselect_b32 s26, s27, s26
  s_cmp_eq_u32 s48, 2
  s_cselect_b32 s26, s28, s26
  s_lshl_b32 s26, s26, 3
  s_load_dwordx2 s[8:9], s[0:1], s26
  s_cmp_eq_u32 s48, 1
  s_cselect_b32 s26, 8, 0
  s_load_dwordx2 s[12:13], s[0:1], s26
  s_cmp_eq_u32 s29, 0
  s_cselect_b32 s21, 0, 3
  s_cselect_b32 s27, 1, 2
  s_cselect_b32 s28, 4, 5
  s_cmp_eq_u32 s48, 1
  s_cselect_b32 s21, s27, s21
  s_cmp_eq_u32 s48, 2
  s_cselect_b32 s21, s28, s21
  s_lshl_b32 s21, s21, 5
  s_add_u32 s21, s21, s64
  s_lshl_b32 s21, s21, 6
  s_add_u32 s21, s21, s49
  s_and_b32 s27, s16, 1
  s_lshl_b32 s21, s21, 1
  s_add_u32 s21, s21, s27
  s_lshl_b32 s21, s21, 12
  s_lshl_b32 s22, s50, 13
  s_lshl_b32 s19, s49, 15
  s_lshl_b32 s20, s50, 15
  s_lshl_b32 s17, s64, 1
  s_add_u32 s17, s17, s27
  s_lshl_b32 s17, s17, 7
  s_mov_b32 s18, 8192
  s_mov_b32 s24, 0x3e0293ee
  s_waitcnt lgkmcnt(0)
  s_and_b32 s9, s9, 0xffff
  s_mov_b32 s10, 4194304
  s_mov_b32 s11, 0x20000
  s_and_b32 s13, s13, 0xffff
  s_mov_b32 s14, 2097152
  s_mov_b32 s15, 0x20000
  s_cmp_eq_u32 s48, 0
  s_cselect_b32 s32, 0, s16
  s_lshr_b32 s32, s32, 1
  v_lshrrev_b32 v144, 4, v1
  v_and_b32 v56, 0xff, v2
  v_lshl_add_u32 v56, v144, 9, v56
  v_and_b32 v146, 15, v1
  v_and_b32 v144, 8, v1
  v_add_u32 v144, v144, v146
  s_cmp_lg_u32 s32, 0
  s_cselect_b64 vcc, -1, 0
  s_cselect_b32 s26, 8, 16
  v_cndmask_b32 v144, v146, v144, vcc
  v_lshrrev_b32 v145, 4, v1
  v_add_u32 v148, s26, v144
  v_xor_b32 v147, 0, v145
  v_xor_b32 v147, v147, v146
  v_lshlrev_b32 v147, 4, v147
  v_lshl_add_u32 v8, v144, 8, v147
  v_xor_b32 v147, 8, v145
  v_xor_b32 v147, v147, v146
  v_lshlrev_b32 v147, 4, v147
  v_lshl_add_u32 v9, v148, 8, v147
  v_xor_b32 v147, 4, v145
  v_xor_b32 v147, v147, v146
  v_lshlrev_b32 v147, 4, v147
  v_lshl_add_u32 v10, v144, 8, v147
  v_xor_b32 v147, 12, v145
  v_xor_b32 v147, v147, v146
  v_lshlrev_b32 v147, 4, v147
  v_lshl_add_u32 v11, v148, 8, v147
  v_xor_b32 v147, 8, v145
  v_xor_b32 v147, v147, v146
  v_lshlrev_b32 v147, 4, v147
  v_lshl_add_u32 v12, v144, 8, v147
  v_xor_b32 v147, 0, v145
  v_xor_b32 v147, v147, v146
  v_lshlrev_b32 v147, 4, v147
  v_lshl_add_u32 v13, v148, 8, v147
  v_xor_b32 v147, 12, v145
  v_xor_b32 v147, v147, v146
  v_lshlrev_b32 v147, 4, v147
  v_lshl_add_u32 v14, v144, 8, v147
  v_xor_b32 v147, 4, v145
  v_xor_b32 v147, v147, v146
  v_lshlrev_b32 v147, 4, v147
  v_lshl_add_u32 v15, v148, 8, v147
  v_lshrrev_b32 v144, 4, v1
  s_lshl_b32 s26, s16, 8
  v_add_u32 v145, 0, v144
  v_or_b32 v147, 0, v144
  v_xor_b32 v147, v147, v146
  v_lshlrev_b32 v147, 4, v147
  v_lshl_add_u32 v147, v145, 10, v147
  v_add_u32 v16, s26, v147
  v_add_u32 v145, 4, v144
  v_or_b32 v147, 4, v144
  v_xor_b32 v147, v147, v146
  v_lshlrev_b32 v147, 4, v147
  v_lshl_add_u32 v147, v145, 10, v147
  v_add_u32 v17, s26, v147
  v_add_u32 v145, 8, v144
  v_or_b32 v147, 8, v144
  v_xor_b32 v147, v147, v146
  v_lshlrev_b32 v147, 4, v147
  v_lshl_add_u32 v147, v145, 10, v147
  v_add_u32 v18, s26, v147
  v_add_u32 v145, 12, v144
  v_or_b32 v147, 12, v144
  v_xor_b32 v147, v147, v146
  v_lshlrev_b32 v147, 4, v147
  v_lshl_add_u32 v147, v145, 10, v147
  v_add_u32 v19, s26, v147
  v_add_u32 v145, 16, v144
  v_or_b32 v147, 8, v144
  v_xor_b32 v147, v147, v146
  v_lshlrev_b32 v147, 4, v147
  v_lshl_add_u32 v147, v145, 10, v147
  v_add_u32 v20, s26, v147
  v_add_u32 v145, 20, v144
  v_or_b32 v147, 12, v144
  v_xor_b32 v147, v147, v146
  v_lshlrev_b32 v147, 4, v147
  v_lshl_add_u32 v147, v145, 10, v147
  v_add_u32 v21, s26, v147
  v_add_u32 v145, 24, v144
  v_or_b32 v147, 0, v144
  v_xor_b32 v147, v147, v146
  v_lshlrev_b32 v147, 4, v147
  v_lshl_add_u32 v147, v145, 10, v147
  v_add_u32 v22, s26, v147
  v_add_u32 v145, 28, v144
  v_or_b32 v147, 4, v144
  v_xor_b32 v147, v147, v146
  v_lshlrev_b32 v147, 4, v147
  v_lshl_add_u32 v147, v145, 10, v147
  v_add_u32 v23, s26, v147
  v_lshrrev_b32 v144, 3, v1
  v_mul_lo_u32 v144, v144, s18
  v_and_b32 v145, 7, v1
  v_lshl_add_u32 v144, v145, 4, v144
  s_lshl_b32 s28, s16, 15
  s_add_u32 s28, s28, 32768
  s_lshl_b32 s29, s18, 3
  s_add_u32 m0, s28, 0
  s_nop 0
  buffer_load_dwordx4 v144, s[8:11], s17 offen lds
  s_add_u32 s17, s17, s29
  s_add_u32 m0, s28, 1024
  s_nop 0
  buffer_load_dwordx4 v144, s[8:11], s17 offen lds
  s_add_u32 s17, s17, s29
  s_add_u32 m0, s28, 2048
  s_nop 0
  buffer_load_dwordx4 v144, s[8:11], s17 offen lds
  s_add_u32 s17, s17, s29
  s_add_u32 m0, s28, 3072
  s_nop 0
  buffer_load_dwordx4 v144, s[8:11], s17 offen lds
  s_add_u32 s17, s17, s29
  s_add_u32 m0, s28, 4096
  s_nop 0
  buffer_load_dwordx4 v144, s[8:11], s17 offen lds
  s_add_u32 s17, s17, s29
  s_add_u32 m0, s28, 5120
  s_nop 0
  buffer_load_dwordx4 v144, s[8:11], s17 offen lds
  s_add_u32 s17, s17, s29
  s_add_u32 m0, s28, 6144
  s_nop 0
  buffer_load_dwordx4 v144, s[8:11], s17 offen lds
  s_add_u32 s17, s17, s29
  s_add_u32 m0, s28, 7168
  s_nop 0
  buffer_load_dwordx4 v144, s[8:11], s17 offen lds
  s_add_u32 s17, s17, s29
  s_add_u32 m0, s28, 8192
  s_nop 0
  buffer_load_dwordx4 v144, s[8:11], s17 offen lds
  s_add_u32 s17, s17, s29
  s_add_u32 m0, s28, 9216
  s_nop 0
  buffer_load_dwordx4 v144, s[8:11], s17 offen lds
  s_add_u32 s17, s17, s29
  s_add_u32 m0, s28, 10240
  s_nop 0
  buffer_load_dwordx4 v144, s[8:11], s17 offen lds
  s_add_u32 s17, s17, s29
  s_add_u32 m0, s28, 11264
  s_nop 0
  buffer_load_dwordx4 v144, s[8:11], s17 offen lds
  s_add_u32 s17, s17, s29
  s_add_u32 m0, s28, 12288
  s_nop 0
  buffer_load_dwordx4 v144, s[8:11], s17 offen lds
  s_add_u32 s17, s17, s29
  s_add_u32 m0, s28, 13312
  s_nop 0
  buffer_load_dwordx4 v144, s[8:11], s17 offen lds
  s_add_u32 s17, s17, s29
  s_add_u32 m0, s28, 14336
  s_nop 0
  buffer_load_dwordx4 v144, s[8:11], s17 offen lds
  s_add_u32 s17, s17, s29
  s_add_u32 m0, s28, 15360
  s_nop 0
  buffer_load_dwordx4 v144, s[8:11], s17 offen lds
  s_add_u32 s17, s17, s29
  s_add_u32 m0, s28, 16384
  s_nop 0
  buffer_load_dwordx4 v144, s[8:11], s17 offen lds
  s_add_u32 s17, s17, s29
  s_add_u32 m0, s28, 17408
  s_nop 0
  buffer_load_dwordx4 v144, s[8:11], s17 offen lds
  s_add_u32 s17, s17, s29
  s_add_u32 m0, s28, 18432
  s_nop 0
  buffer_load_dwordx4 v144, s[8:11], s17 offen lds
  s_add_u32 s17, s17, s29
  s_add_u32 m0, s28, 19456
  s_nop 0
  buffer_load_dwordx4 v144, s[8:11], s17 offen lds
  s_add_u32 s17, s17, s29
  s_add_u32 m0, s28, 20480
  s_nop 0
  buffer_load_dwordx4 v144, s[8:11], s17 offen lds
  s_add_u32 s17, s17, s29
  s_add_u32 m0, s28, 21504
  s_nop 0
  buffer_load_dwordx4 v144, s[8:11], s17 offen lds
  s_add_u32 s17, s17, s29
  s_add_u32 m0, s28, 22528
  s_nop 0
  buffer_load_dwordx4 v144, s[8:11], s17 offen lds
  s_add_u32 s17, s17, s29
  s_add_u32 m0, s28, 23552
  s_nop 0
  buffer_load_dwordx4 v144, s[8:11], s17 offen lds
  s_add_u32 s17, s17, s29
  s_add_u32 m0, s28, 24576
  s_nop 0
  buffer_load_dwordx4 v144, s[8:11], s17 offen lds
  s_add_u32 s17, s17, s29
  s_add_u32 m0, s28, 25600
  s_nop 0
  buffer_load_dwordx4 v144, s[8:11], s17 offen lds
  s_add_u32 s17, s17, s29
  s_add_u32 m0, s28, 26624
  s_nop 0
  buffer_load_dwordx4 v144, s[8:11], s17 offen lds
  s_add_u32 s17, s17, s29
  s_add_u32 m0, s28, 27648
  s_nop 0
  buffer_load_dwordx4 v144, s[8:11], s17 offen lds
  s_add_u32 s17, s17, s29
  s_add_u32 m0, s28, 28672
  s_nop 0
  buffer_load_dwordx4 v144, s[8:11], s17 offen lds
  s_add_u32 s17, s17, s29
  s_add_u32 m0, s28, 29696
  s_nop 0
  buffer_load_dwordx4 v144, s[8:11], s17 offen lds
  s_add_u32 s17, s17, s29
  s_add_u32 m0, s28, 30720
  s_nop 0
  buffer_load_dwordx4 v144, s[8:11], s17 offen lds
  s_add_u32 s17, s17, s29
  s_add_u32 m0, s28, 31744
  s_nop 0
  buffer_load_dwordx4 v144, s[8:11], s17 offen lds
  s_add_u32 s17, s17, s29
  s_lshl_b32 s25, s16, 13
  s_add_u32 m0, s25, 0
  s_nop 0
  buffer_load_dwordx4 v16, s[12:15], s19 offen lds
  s_add_u32 m0, s25, 1024
  s_nop 0
  buffer_load_dwordx4 v17, s[12:15], s19 offen lds
  s_add_u32 m0, s25, 2048
  s_nop 0
  buffer_load_dwordx4 v18, s[12:15], s19 offen lds
  s_add_u32 m0, s25, 3072
  s_nop 0
  buffer_load_dwordx4 v19, s[12:15], s19 offen lds
  s_add_u32 m0, s25, 4096
  s_nop 0
  buffer_load_dwordx4 v20, s[12:15], s19 offen lds
  s_add_u32 m0, s25, 5120
  s_nop 0
  buffer_load_dwordx4 v21, s[12:15], s19 offen lds
  s_add_u32 m0, s25, 6144
  s_nop 0
  buffer_load_dwordx4 v22, s[12:15], s19 offen lds
  s_add_u32 m0, s25, 7168
  s_nop 0
  buffer_load_dwordx4 v23, s[12:15], s19 offen lds
  s_cmp_gt_u32 s23, 1
  s_cselect_b32 s26, s20, 0
  s_add_u32 s19, s19, s26
  s_add_u32 s25, s25, 32768
  s_and_b32 s25, s25, 0x1ffff
  s_cmp_lg_u32 s16, 3
  s_cbranch_scc1 M_noinit
  s_mov_b32 s79, 0
  s_atomic_swap s79, s[72:73], s31 glc
  s_waitcnt lgkmcnt(0)
  s_mov_b32 s79, 1
  s_atomic_add s79, s[74:75], 128
M_noinit:
  s_cmp_lg_u32 s65, 3
  s_cbranch_scc1 M_noarm
  v_lshlrev_b32 v4, 4, v0
  v_mov_b64 v[60:61], -1
  v_mov_b64 v[62:63], -1
  s_mul_i32 s76, s64, 4096
  s_add_u32 s77, s76, 142868480
  buffer_store_dwordx4 v[60:63], v4, s[4:7], s77 offen sc1
  s_add_u32 s77, s76, 142999552
  buffer_store_dwordx4 v[60:63], v4, s[4:7], s77 offen sc1
  s_add_u32 s77, s76, 143130624
  buffer_store_dwordx4 v[60:63], v4, s[4:7], s77 offen sc1
  s_add_u32 s77, s76, 143261696
  buffer_store_dwordx4 v[60:63], v4, s[4:7], s77 offen sc1
  s_add_u32 s77, s76, 143392768
  buffer_store_dwordx4 v[60:63], v4, s[4:7], s77 offen sc1
  s_add_u32 s77, s76, 143523840
  buffer_store_dwordx4 v[60:63], v4, s[4:7], s77 offen sc1
M_noarm:
  s_mul_i32 s76, s64, 3
  s_add_u32 s76, s76, s57
  s_mul_i32 s76, s76, 24576
  v_lshlrev_b32 v4, 7, v0
  v_add_u32 v4, s76, v4
  buffer_load_dword v5, v4, s[12:15], 0 offen
  v_bfe_u32 v148, v1, 2, 2
  v_lshrrev_b32 v149, 5, v1
  v_lshl_add_u32 v148, v149, 4, v148
  v_bfe_u32 v149, v1, 4, 1
  v_lshl_add_u32 v148, v149, 3, v148
  v_and_b32 v149, 3, v1
  v_and_b32 v150, 2, v149
  v_add_u32 v150, v150, v149
  s_cmp_lg_u32 s32, 0
  s_cselect_b64 vcc, -1, 0
  s_cselect_b32 s26, 32, 16
  v_cndmask_b32 v149, v150, v149, vcc
  v_lshlrev_b32 v149, 3, v149
  v_lshl_add_u32 v148, v148, 7, v149
  v_add_u32 v152, s28, v148
  v_add_u32 v153, 512, v152
  v_add_u32 v154, s26, v152
  v_add_u32 v155, s26, v153
  s_waitcnt vmcnt(37)
  ds_read_b64_tr_b16 a[0:1], v152 offset:0
  ds_read_b64_tr_b16 a[2:3], v153 offset:0
  ds_read_b64_tr_b16 a[4:5], v154 offset:0
  ds_read_b64_tr_b16 a[6:7], v155 offset:0
  ds_read_b64_tr_b16 a[8:9], v152 offset:64
  ds_read_b64_tr_b16 a[10:11], v153 offset:64
  ds_read_b64_tr_b16 a[12:13], v154 offset:64
  ds_read_b64_tr_b16 a[14:15], v155 offset:64
  s_waitcnt lgkmcnt(0)
  s_add_u32 m0, s28, 0
  s_nop 0
  buffer_load_dwordx4 v144, s[8:11], s17 offen lds
  s_add_u32 s17, s17, s29
  s_add_u32 m0, s28, 1024
  s_nop 0
  buffer_load_dwordx4 v144, s[8:11], s17 offen lds
  s_add_u32 s17, s17, s29
  s_add_u32 m0, s28, 2048
  s_nop 0
  buffer_load_dwordx4 v144, s[8:11], s17 offen lds
  s_add_u32 s17, s17, s29
  s_add_u32 m0, s28, 3072
  s_nop 0
  buffer_load_dwordx4 v144, s[8:11], s17 offen lds
  s_add_u32 s17, s17, s29
  s_waitcnt vmcnt(37)
  ds_read_b64_tr_b16 a[16:17], v152 offset:4096
  ds_read_b64_tr_b16 a[18:19], v153 offset:4096
  ds_read_b64_tr_b16 a[20:21], v154 offset:4096
  ds_read_b64_tr_b16 a[22:23], v155 offset:4096
  ds_read_b64_tr_b16 a[24:25], v152 offset:4160
  ds_read_b64_tr_b16 a[26:27], v153 offset:4160
  ds_read_b64_tr_b16 a[28:29], v154 offset:4160
  ds_read_b64_tr_b16 a[30:31], v155 offset:4160
  s_waitcnt lgkmcnt(0)
  s_add_u32 m0, s28, 4096
  s_nop 0
  buffer_load_dwordx4 v144, s[8:11], s17 offen lds
  s_add_u32 s17, s17, s29
  s_add_u32 m0, s28, 5120
  s_nop 0
  buffer_load_dwordx4 v144, s[8:11], s17 offen lds
  s_add_u32 s17, s17, s29
  s_add_u32 m0, s28, 6144
  s_nop 0
  buffer_load_dwordx4 v144, s[8:11], s17 offen lds
  s_add_u32 s17, s17, s29
  s_add_u32 m0, s28, 7168
  s_nop 0
  buffer_load_dwordx4 v144, s[8:11], s17 offen lds
  s_add_u32 s17, s17, s29
  s_waitcnt vmcnt(37)
  ds_read_b64_tr_b16 a[32:33], v152 offset:8192
  ds_read_b64_tr_b16 a[34:35], v153 offset:8192
  ds_read_b64_tr_b16 a[36:37], v154 offset:8192
  ds_read_b64_tr_b16 a[38:39], v155 offset:8192
  ds_read_b64_tr_b16 a[40:41], v152 offset:8256
  ds_read_b64_tr_b16 a[42:43], v153 offset:8256
  ds_read_b64_tr_b16 a[44:45], v154 offset:8256
  ds_read_b64_tr_b16 a[46:47], v155 offset:8256
  s_waitcnt lgkmcnt(0)
  s_add_u32 m0, s28, 8192
  s_nop 0
  buffer_load_dwordx4 v144, s[8:11], s17 offen lds
  s_add_u32 s17, s17, s29
  s_add_u32 m0, s28, 9216
  s_nop 0
  buffer_load_dwordx4 v144, s[8:11], s17 offen lds
  s_add_u32 s17, s17, s29
  s_add_u32 m0, s28, 10240
  s_nop 0
  buffer_load_dwordx4 v144, s[8:11], s17 offen lds
  s_add_u32 s17, s17, s29
  s_add_u32 m0, s28, 11264
  s_nop 0
  buffer_load_dwordx4 v144, s[8:11], s17 offen lds
  s_add_u32 s17, s17, s29
  s_waitcnt vmcnt(37)
  ds_read_b64_tr_b16 a[48:49], v152 offset:12288
  ds_read_b64_tr_b16 a[50:51], v153 offset:12288
  ds_read_b64_tr_b16 a[52:53], v154 offset:12288
  ds_read_b64_tr_b16 a[54:55], v155 offset:12288
  ds_read_b64_tr_b16 a[56:57], v152 offset:12352
  ds_read_b64_tr_b16 a[58:59], v153 offset:12352
  ds_read_b64_tr_b16 a[60:61], v154 offset:12352
  ds_read_b64_tr_b16 a[62:63], v155 offset:12352
  s_waitcnt lgkmcnt(0)
  s_add_u32 m0, s28, 12288
  s_nop 0
  buffer_load_dwordx4 v144, s[8:11], s17 offen lds
  s_add_u32 s17, s17, s29
  s_add_u32 m0, s28, 13312
  s_nop 0
  buffer_load_dwordx4 v144, s[8:11], s17 offen lds
  s_add_u32 s17, s17, s29
  s_add_u32 m0, s28, 14336
  s_nop 0
  buffer_load_dwordx4 v144, s[8:11], s17 offen lds
  s_add_u32 s17, s17, s29
  s_add_u32 m0, s28, 15360
  s_nop 0
  buffer_load_dwordx4 v144, s[8:11], s17 offen lds
  s_add_u32 s17, s17, s29
  s_waitcnt vmcnt(37)
  ds_read_b64_tr_b16 a[64:65], v152 offset:16384
  ds_read_b64_tr_b16 a[66:67], v153 offset:16384
  ds_read_b64_tr_b16 a[68:69], v154 offset:16384
  ds_read_b64_tr_b16 a[70:71], v155 offset:16384
  ds_read_b64_tr_b16 a[72:73], v152 offset:16448
  ds_read_b64_tr_b16 a[74:75], v153 offset:16448
  ds_read_b64_tr_b16 a[76:77], v154 offset:16448
  ds_read_b64_tr_b16 a[78:79], v155 offset:16448
  s_waitcnt lgkmcnt(0)
  s_add_u32 m0, s28, 16384
  s_nop 0
  buffer_load_dwordx4 v144, s[8:11], s17 offen lds
  s_add_u32 s17, s17, s29
  s_add_u32 m0, s28, 17408
  s_nop 0
  buffer_load_dwordx4 v144, s[8:11], s17 offen lds
  s_add_u32 s17, s17, s29
  s_add_u32 m0, s28, 18432
  s_nop 0
  buffer_load_dwordx4 v144, s[8:11], s17 offen lds
  s_add_u32 s17, s17, s29
  s_add_u32 m0, s28, 19456
  s_nop 0
  buffer_load_dwordx4 v144, s[8:11], s17 offen lds
  s_add_u32 s17, s17, s29
  s_waitcnt vmcnt(37)
  ds_read_b64_tr_b16 a[80:81], v152 offset:20480
  ds_read_b64_tr_b16 a[82:83], v153 offset:20480
  ds_read_b64_tr_b16 a[84:85], v154 offset:20480
  ds_read_b64_tr_b16 a[86:87], v155 offset:20480
  ds_read_b64_tr_b16 a[88:89], v152 offset:20544
  ds_read_b64_tr_b16 a[90:91], v153 offset:20544
  ds_read_b64_tr_b16 a[92:93], v154 offset:20544
  ds_read_b64_tr_b16 a[94:95], v155 offset:20544
  s_waitcnt lgkmcnt(0)
  s_add_u32 m0, s28, 20480
  s_nop 0
  buffer_load_dwordx4 v144, s[8:11], s17 offen lds
  s_add_u32 s17, s17, s29
  s_add_u32 m0, s28, 21504
  s_nop 0
  buffer_load_dwordx4 v144, s[8:11], s17 offen lds
  s_add_u32 s17, s17, s29
  s_add_u32 m0, s28, 22528
  s_nop 0
  buffer_load_dwordx4 v144, s[8:11], s17 offen lds
  s_add_u32 s17, s17, s29
  s_add_u32 m0, s28, 23552
  s_nop 0
  buffer_load_dwordx4 v144, s[8:11], s17 offen lds
  s_add_u32 s17, s17, s29
  s_waitcnt vmcnt(37)
  ds_read_b64_tr_b16 a[96:97], v152 offset:24576
  ds_read_b64_tr_b16 a[98:99], v153 offset:24576
  ds_read_b64_tr_b16 a[100:101], v154 offset:24576
  ds_read_b64_tr_b16 a[102:103], v155 offset:24576
  ds_read_b64_tr_b16 a[104:105], v152 offset:24640
  ds_read_b64_tr_b16 a[106:107], v153 offset:24640
  ds_read_b64_tr_b16 a[108:109], v154 offset:24640
  ds_read_b64_tr_b16 a[110:111], v155 offset:24640
  s_waitcnt lgkmcnt(0)
  s_add_u32 m0, s28, 24576
  s_nop 0
  buffer_load_dwordx4 v144, s[8:11], s17 offen lds
  s_add_u32 s17, s17, s29
  s_add_u32 m0, s28, 25600
  s_nop 0
  buffer_load_dwordx4 v144, s[8:11], s17 offen lds
  s_add_u32 s17, s17, s29
  s_add_u32 m0, s28, 26624
  s_nop 0
  buffer_load_dwordx4 v144, s[8:11], s17 offen lds
  s_add_u32 s17, s17, s29
  s_add_u32 m0, s28, 27648
  s_nop 0
  buffer_load_dwordx4 v144, s[8:11], s17 offen lds
  s_add_u32 s17, s17, s29
  s_waitcnt vmcnt(37)
  ds_read_b64_tr_b16 a[112:113], v152 offset:28672
  ds_read_b64_tr_b16 a[114:115], v153 offset:28672
  ds_read_b64_tr_b16 a[116:117], v154 offset:28672
  ds_read_b64_tr_b16 a[118:119], v155 offset:28672
  ds_read_b64_tr_b16 a[120:121], v152 offset:28736
  ds_read_b64_tr_b16 a[122:123], v153 offset:28736
  ds_read_b64_tr_b16 a[124:125], v154 offset:28736
  ds_read_b64_tr_b16 a[126:127], v155 offset:28736
  s_waitcnt lgkmcnt(0)
  s_add_u32 m0, s28, 28672
  s_nop 0
  buffer_load_dwordx4 v144, s[8:11], s17 offen lds
  s_add_u32 s17, s17, s29
  s_add_u32 m0, s28, 29696
  s_nop 0
  buffer_load_dwordx4 v144, s[8:11], s17 offen lds
  s_add_u32 s17, s17, s29
  s_add_u32 m0, s28, 30720
  s_nop 0
  buffer_load_dwordx4 v144, s[8:11], s17 offen lds
  s_add_u32 s17, s17, s29
  s_add_u32 m0, s28, 31744
  s_nop 0
  buffer_load_dwordx4 v144, s[8:11], s17 offen lds
  s_add_u32 s17, s17, s29
  s_waitcnt vmcnt(28)
  ds_read_b64_tr_b16 a[128:129], v152 offset:0
  ds_read_b64_tr_b16 a[130:131], v153 offset:0
  ds_read_b64_tr_b16 a[132:133], v154 offset:0
  ds_read_b64_tr_b16 a[134:135], v155 offset:0
  ds_read_b64_tr_b16 a[136:137], v152 offset:64
  ds_read_b64_tr_b16 a[138:139], v153 offset:64
  ds_read_b64_tr_b16 a[140:141], v154 offset:64
  ds_read_b64_tr_b16 a[142:143], v155 offset:64
  s_waitcnt lgkmcnt(0)
  s_waitcnt vmcnt(24)
  ds_read_b64_tr_b16 a[144:145], v152 offset:4096
  ds_read_b64_tr_b16 a[146:147], v153 offset:4096
  ds_read_b64_tr_b16 a[148:149], v154 offset:4096
  ds_read_b64_tr_b16 a[150:151], v155 offset:4096
  ds_read_b64_tr_b16 a[152:153], v152 offset:4160
  ds_read_b64_tr_b16 a[154:155], v153 offset:4160
  ds_read_b64_tr_b16 a[156:157], v154 offset:4160
  ds_read_b64_tr_b16 a[158:159], v155 offset:4160
  s_waitcnt lgkmcnt(0)
  s_waitcnt vmcnt(20)
  ds_read_b64_tr_b16 a[160:161], v152 offset:8192
  ds_read_b64_tr_b16 a[162:163], v153 offset:8192
  ds_read_b64_tr_b16 a[164:165], v154 offset:8192
  ds_read_b64_tr_b16 a[166:167], v155 offset:8192
  ds_read_b64_tr_b16 a[168:169], v152 offset:8256
  ds_read_b64_tr_b16 a[170:171], v153 offset:8256
  ds_read_b64_tr_b16 a[172:173], v154 offset:8256
  ds_read_b64_tr_b16 a[174:175], v155 offset:8256
  s_waitcnt lgkmcnt(0)
  s_waitcnt vmcnt(16)
  ds_read_b64_tr_b16 a[176:177], v152 offset:12288
  ds_read_b64_tr_b16 a[178:179], v153 offset:12288
  ds_read_b64_tr_b16 a[180:181], v154 offset:12288
  ds_read_b64_tr_b16 a[182:183], v155 offset:12288
  ds_read_b64_tr_b16 a[184:185], v152 offset:12352
  ds_read_b64_tr_b16 a[186:187], v153 offset:12352
  ds_read_b64_tr_b16 a[188:189], v154 offset:12352
  ds_read_b64_tr_b16 a[190:191], v155 offset:12352
  s_waitcnt lgkmcnt(0)
  s_waitcnt vmcnt(12)
  ds_read_b64_tr_b16 a[192:193], v152 offset:16384
  ds_read_b64_tr_b16 a[194:195], v153 offset:16384
  ds_read_b64_tr_b16 a[196:197], v154 offset:16384
  ds_read_b64_tr_b16 a[198:199], v155 offset:16384
  ds_read_b64_tr_b16 a[200:201], v152 offset:16448
  ds_read_b64_tr_b16 a[202:203], v153 offset:16448
  ds_read_b64_tr_b16 a[204:205], v154 offset:16448
  ds_read_b64_tr_b16 a[206:207], v155 offset:16448
  s_waitcnt lgkmcnt(0)
  s_waitcnt vmcnt(8)
  ds_read_b64_tr_b16 a[208:209], v152 offset:20480
  ds_read_b64_tr_b16 a[210:211], v153 offset:20480
  ds_read_b64_tr_b16 a[212:213], v154 offset:20480
  ds_read_b64_tr_b16 a[214:215], v155 offset:20480
  ds_read_b64_tr_b16 a[216:217], v152 offset:20544
  ds_read_b64_tr_b16 a[218:219], v153 offset:20544
  ds_read_b64_tr_b16 a[220:221], v154 offset:20544
  ds_read_b64_tr_b16 a[222:223], v155 offset:20544
  s_waitcnt lgkmcnt(0)
  s_waitcnt vmcnt(4)
  ds_read_b64_tr_b16 a[224:225], v152 offset:24576
  ds_read_b64_tr_b16 a[226:227], v153 offset:24576
  ds_read_b64_tr_b16 a[228:229], v154 offset:24576
  ds_read_b64_tr_b16 a[230:231], v155 offset:24576
  ds_read_b64_tr_b16 a[232:233], v152 offset:24640
  ds_read_b64_tr_b16 a[234:235], v153 offset:24640
  ds_read_b64_tr_b16 a[236:237], v154 offset:24640
  ds_read_b64_tr_b16 a[238:239], v155 offset:24640
  s_waitcnt lgkmcnt(0)
  s_waitcnt vmcnt(0)
  ds_read_b64_tr_b16 a[240:241], v152 offset:28672
  ds_read_b64_tr_b16 a[242:243], v153 offset:28672
  ds_read_b64_tr_b16 a[244:245], v154 offset:28672
  ds_read_b64_tr_b16 a[246:247], v155 offset:28672
  ds_read_b64_tr_b16 a[248:249], v152 offset:28736
  ds_read_b64_tr_b16 a[250:251], v153 offset:28736
  ds_read_b64_tr_b16 a[252:253], v154 offset:28736
  ds_read_b64_tr_b16 a[254:255], v155 offset:28736
  s_waitcnt lgkmcnt(0)
  s_barrier
  s_add_u32 m0, s25, 0
  s_nop 0
  buffer_load_dwordx4 v16, s[12:15], s19 offen lds
  s_add_u32 m0, s25, 1024
  s_nop 0
  buffer_load_dwordx4 v17, s[12:15], s19 offen lds
  s_add_u32 m0, s25, 2048
  s_nop 0
  buffer_load_dwordx4 v18, s[12:15], s19 offen lds
  s_add_u32 m0, s25, 3072
  s_nop 0
  buffer_load_dwordx4 v19, s[12:15], s19 offen lds
  s_add_u32 m0, s25, 4096
  s_nop 0
  buffer_load_dwordx4 v20, s[12:15], s19 offen lds
  s_add_u32 m0, s25, 5120
  s_nop 0
  buffer_load_dwordx4 v21, s[12:15], s19 offen lds
  s_add_u32 m0, s25, 6144
  s_nop 0
  buffer_load_dwordx4 v22, s[12:15], s19 offen lds
  s_add_u32 m0, s25, 7168
  s_nop 0
  buffer_load_dwordx4 v23, s[12:15], s19 offen lds
  s_cmp_gt_u32 s23, 2
  s_cselect_b32 s26, s20, 0
  s_add_u32 s19, s19, s26
  s_add_u32 s25, s25, 32768
  s_and_b32 s25, s25, 0x1ffff
  s_waitcnt vmcnt(0)
  s_barrier
  s_load_dwordx2 s[8:9], s[0:1], 40
  s_mul_i32 s76, s66, 18816
  v_min_u32 v200, 146, v0
  v_lshl_add_u32 v200, v200, 7, s76
  s_waitcnt lgkmcnt(0)
  s_and_b32 s9, s9, 0xffff
  buffer_load_dword v201, v200, s[8:11], 0 offen
  s_cmp_lg_u32 s32, 0
  s_cbranch_scc1 P_v_129
  s_cmp_eq_u32 s48, 0
  s_cbranch_scc1 P_q_131
  s_mov_b32 s27, s21
  v_mov_b32 v7, 0x40000000
  s_mov_b32 s29, -2
  v_min_u32 v145, 1, v0
  v_lshlrev_b32 v145, 30, v145
  ds_read_b128 v[24:27], v8 offset:0
  ds_read_b128 v[28:31], v9 offset:0
  ds_read_b128 v[32:35], v10 offset:0
  ds_read_b128 v[36:39], v11 offset:0
  ds_read_b128 v[40:43], v12 offset:0
  ds_read_b128 v[44:47], v13 offset:0
.p2align 6
G_top_132:
  s_waitcnt lgkmcnt(5)
  v_mfma_f32_16x16x32_bf16 v[64:67], a[0:3], v[24:27], 0
  s_add_u32 m0, s25, 0
  ds_read_b128 v[48:51], v14 offset:0
  v_mfma_f32_16x16x32_bf16 v[68:71], a[4:7], v[24:27], 0
  v_mfma_f32_16x16x32_bf16 v[80:83], a[8:11], v[24:27], 0
  buffer_load_dwordx4 v16, s[12:15], s19 offen lds
  v_mfma_f32_16x16x32_bf16 v[84:87], a[12:15], v[24:27], 0
  s_waitcnt lgkmcnt(5)
  v_mfma_f32_16x16x32_bf16 v[72:75], a[0:3], v[28:31], 0
  ds_read_b128 v[52:55], v15 offset:0
  v_mfma_f32_16x16x32_bf16 v[76:79], a[4:7], v[28:31], 0
  v_cvt_pk_bf16_f32 v128, v96, v97
  v_cvt_pk_bf16_f32 v129, v98, v99
  v_mfma_f32_16x16x32_bf16 v[88:91], a[8:11], v[28:31], 0
  v_mfma_f32_16x16x32_bf16 v[92:95], a[12:15], v[28:31], 0
  s_waitcnt lgkmcnt(5)
  v_cvt_pk_bf16_f32 v130, v100, v101
  v_cvt_pk_bf16_f32 v131, v102, v103
  v_mfma_f32_16x16x32_bf16 v[64:67], a[16:19], v[32:35], v[64:67]
  s_add_u32 m0, s25, 1024
  ds_read_b128 v[24:27], v8 offset:8192
  v_mfma_f32_16x16x32_bf16 v[68:71], a[20:23], v[32:35], v[68:71]
  v_mfma_f32_16x16x32_bf16 v[80:83], a[24:27], v[32:35], v[80:83]
  buffer_load_dwordx4 v17, s[12:15], s19 offen lds
  v_mfma_f32_16x16x32_bf16 v[84:87], a[28:31], v[32:35], v[84:87]
  s_waitcnt lgkmcnt(5)
  v_mfma_f32_16x16x32_bf16 v[72:75], a[16:19], v[36:39], v[72:75]
  ds_read_b128 v[28:31], v9 offset:8192
  v_mfma_f32_16x16x32_bf16 v[76:79], a[20:23], v[36:39], v[76:79]
  v_mfma_f32_16x16x32_bf16 v[88:91], a[24:27], v[36:39], v[88:91]
  v_mfma_f32_16x16x32_bf16 v[92:95], a[28:31], v[36:39], v[92:95]
  s_waitcnt lgkmcnt(5)
  v_mfma_f32_16x16x32_bf16 v[64:67], a[32:35], v[40:43], v[64:67]
  s_add_u32 m0, s25, 2048
  ds_read_b128 v[32:35], v10 offset:8192
  v_mfma_f32_16x16x32_bf16 v[68:71], a[36:39], v[40:43], v[68:71]
  v_cvt_pk_bf16_f32 v132, v104, v105
  v_cvt_pk_bf16_f32 v133, v106, v107
  v_mfma_f32_16x16x32_bf16 v[80:83], a[40:43], v[40:43], v[80:83]
  buffer_load_dwordx4 v18, s[12:15], s19 offen lds
  v_mfma_f32_16x16x32_bf16 v[84:87], a[44:47], v[40:43], v[84:87]
  s_waitcnt lgkmcnt(5)
  v_cvt_pk_bf16_f32 v134, v108, v109
  v_cvt_pk_bf16_f32 v135, v110, v111
  v_mfma_f32_16x16x32_bf16 v[72:75], a[32:35], v[44:47], v[72:75]
  ds_read_b128 v[36:39], v11 offset:8192
  v_mfma_f32_16x16x32_bf16 v[76:79], a[36:39], v[44:47], v[76:79]
  v_mfma_f32_16x16x32_bf16 v[88:91], a[40:43], v[44:47], v[88:91]
  v_mfma_f32_16x16x32_bf16 v[92:95], a[44:47], v[44:47], v[92:95]
  s_waitcnt lgkmcnt(5)
  v_mfma_f32_16x16x32_bf16 v[64:67], a[48:51], v[48:51], v[64:67]
  s_add_u32 m0, s25, 3072
  ds_read_b128 v[40:43], v12 offset:8192
  v_mfma_f32_16x16x32_bf16 v[68:71], a[52:55], v[48:51], v[68:71]
  v_mfma_f32_16x16x32_bf16 v[80:83], a[56:59], v[48:51], v[80:83]
  buffer_load_dwordx4 v19, s[12:15], s19 offen lds
  v_mfma_f32_16x16x32_bf16 v[84:87], a[60:63], v[48:51], v[84:87]
  s_waitcnt lgkmcnt(5)
  v_mfma_f32_16x16x32_bf16 v[72:75], a[48:51], v[52:55], v[72:75]
  ds_read_b128 v[44:47], v13 offset:8192
  v_mfma_f32_16x16x32_bf16 v[76:79], a[52:55], v[52:55], v[76:79]
  v_cvt_pk_bf16_f32 v136, v112, v113
  v_cvt_pk_bf16_f32 v137, v114, v115
  v_mfma_f32_16x16x32_bf16 v[88:91], a[56:59], v[52:55], v[88:91]
  v_mfma_f32_16x16x32_bf16 v[92:95], a[60:63], v[52:55], v[92:95]
  s_waitcnt lgkmcnt(5)
  v_cvt_pk_bf16_f32 v138, v116, v117
  v_cvt_pk_bf16_f32 v139, v118, v119
  v_mfma_f32_16x16x32_bf16 v[64:67], a[64:67], v[24:27], v[64:67]
  s_add_u32 m0, s25, 4096
  ds_read_b128 v[48:51], v14 offset:8192
  v_mfma_f32_16x16x32_bf16 v[68:71], a[68:71], v[24:27], v[68:71]
  v_mfma_f32_16x16x32_bf16 v[80:83], a[72:75], v[24:27], v[80:83]
  buffer_load_dwordx4 v20, s[12:15], s19 offen lds
  v_mfma_f32_16x16x32_bf16 v[84:87], a[76:79], v[24:27], v[84:87]
  s_waitcnt lgkmcnt(5)
  v_mfma_f32_16x16x32_bf16 v[72:75], a[64:67], v[28:31], v[72:75]
  ds_read_b128 v[52:55], v15 offset:8192
  v_mfma_f32_16x16x32_bf16 v[76:79], a[68:71], v[28:31], v[76:79]
  v_mfma_f32_16x16x32_bf16 v[88:91], a[72:75], v[28:31], v[88:91]
  v_mfma_f32_16x16x32_bf16 v[92:95], a[76:79], v[28:31], v[92:95]
  s_waitcnt lgkmcnt(5)
  v_mfma_f32_16x16x32_bf16 v[64:67], a[80:83], v[32:35], v[64:67]
  s_add_u32 m0, s25, 5120
  ds_read_b128 v[24:27], v8 offset:16384
  v_mfma_f32_16x16x32_bf16 v[68:71], a[84:87], v[32:35], v[68:71]
  v_cvt_pk_bf16_f32 v140, v120, v121
  v_cvt_pk_bf16_f32 v141, v122, v123
  v_mfma_f32_16x16x32_bf16 v[80:83], a[88:91], v[32:35], v[80:83]
  buffer_load_dwordx4 v21, s[12:15], s19 offen lds
  v_mfma_f32_16x16x32_bf16 v[84:87], a[92:95], v[32:35], v[84:87]
  s_waitcnt lgkmcnt(5)
  v_cvt_pk_bf16_f32 v142, v124, v125
  v_cvt_pk_bf16_f32 v143, v126, v127
  v_mfma_f32_16x16x32_bf16 v[72:75], a[80:83], v[36:39], v[72:75]
  ds_read_b128 v[28:31], v9 offset:16384
  v_mfma_f32_16x16x32_bf16 v[76:79], a[84:87], v[36:39], v[76:79]
  v_mfma_f32_16x16x32_bf16 v[88:91], a[88:91], v[36:39], v[88:91]
  v_mfma_f32_16x16x32_bf16 v[92:95], a[92:95], v[36:39], v[92:95]
  s_waitcnt lgkmcnt(5)
  v_mfma_f32_16x16x32_bf16 v[64:67], a[96:99], v[40:43], v[64:67]
  s_add_u32 m0, s25, 6144
  ds_read_b128 v[32:35], v10 offset:16384
  v_mfma_f32_16x16x32_bf16 v[68:71], a[100:103], v[40:43], v[68:71]
  v_mfma_f32_16x16x32_bf16 v[80:83], a[104:107], v[40:43], v[80:83]
  buffer_load_dwordx4 v22, s[12:15], s19 offen lds
  v_mfma_f32_16x16x32_bf16 v[84:87], a[108:111], v[40:43], v[84:87]
  s_waitcnt lgkmcnt(5)
  v_mfma_f32_16x16x32_bf16 v[72:75], a[96:99], v[44:47], v[72:75]
  ds_read_b128 v[36:39], v11 offset:16384
  v_mfma_f32_16x16x32_bf16 v[76:79], a[100:103], v[44:47], v[76:79]
  v_mfma_f32_16x16x32_bf16 v[88:91], a[104:107], v[44:47], v[88:91]
  v_mfma_f32_16x16x32_bf16 v[92:95], a[108:111], v[44:47], v[92:95]
  s_waitcnt lgkmcnt(5)
  v_mfma_f32_16x16x32_bf16 v[64:67], a[112:115], v[48:51], v[64:67]
  s_add_u32 m0, s25, 7168
  ds_read_b128 v[40:43], v12 offset:16384
  v_mfma_f32_16x16x32_bf16 v[68:71], a[116:119], v[48:51], v[68:71]
  v_mfma_f32_16x16x32_bf16 v[80:83], a[120:123], v[48:51], v[80:83]
  buffer_load_dwordx4 v23, s[12:15], s19 offen lds
  v_mfma_f32_16x16x32_bf16 v[84:87], a[124:127], v[48:51], v[84:87]
  s_waitcnt lgkmcnt(5)
  v_mfma_f32_16x16x32_bf16 v[72:75], a[112:115], v[52:55], v[72:75]
  s_cmp_gt_u32 s23, 3
  ds_read_b128 v[44:47], v13 offset:16384
  v_mfma_f32_16x16x32_bf16 v[76:79], a[116:119], v[52:55], v[76:79]
  v_mfma_f32_16x16x32_bf16 v[88:91], a[120:123], v[52:55], v[88:91]
  s_cselect_b32 s26, s20, 0
  v_mfma_f32_16x16x32_bf16 v[92:95], a[124:127], v[52:55], v[92:95]
  s_waitcnt lgkmcnt(5)
  v_mfma_f32_16x16x32_bf16 v[64:67], a[128:131], v[24:27], v[64:67]
  s_add_u32 s19, s19, s26
  ds_read_b128 v[48:51], v14 offset:16384
  v_mfma_f32_16x16x32_bf16 v[68:71], a[132:135], v[24:27], v[68:71]
  v_mfma_f32_16x16x32_bf16 v[80:83], a[136:139], v[24:27], v[80:83]
  s_add_u32 s25, s25, 32768
  v_mfma_f32_16x16x32_bf16 v[84:87], a[140:143], v[24:27], v[84:87]
  s_waitcnt lgkmcnt(5)
  v_mfma_f32_16x16x32_bf16 v[72:75], a[128:131], v[28:31], v[72:75]
  s_and_b32 s25, s25, 0x1ffff
  ds_read_b128 v[52:55], v15 offset:16384
  v_mfma_f32_16x16x32_bf16 v[76:79], a[132:135], v[28:31], v[76:79]
  v_mfma_f32_16x16x32_bf16 v[88:91], a[136:139], v[28:31], v[88:91]
  buffer_store_dwordx4 v[128:131], v7, s[4:7], s21 offen offset:0 sc1
  v_mfma_f32_16x16x32_bf16 v[92:95], a[140:143], v[28:31], v[92:95]
  s_waitcnt lgkmcnt(5)
  v_mfma_f32_16x16x32_bf16 v[64:67], a[144:147], v[32:35], v[64:67]
  ds_read_b128 v[24:27], v8 offset:24576
  v_mfma_f32_16x16x32_bf16 v[68:71], a[148:151], v[32:35], v[68:71]
  v_mfma_f32_16x16x32_bf16 v[80:83], a[152:155], v[32:35], v[80:83]
  v_mfma_f32_16x16x32_bf16 v[84:87], a[156:159], v[32:35], v[84:87]
  s_waitcnt lgkmcnt(5)
  v_mfma_f32_16x16x32_bf16 v[72:75], a[144:147], v[36:39], v[72:75]
  ds_read_b128 v[28:31], v9 offset:24576
  v_mfma_f32_16x16x32_bf16 v[76:79], a[148:151], v[36:39], v[76:79]
  v_mfma_f32_16x16x32_bf16 v[88:91], a[152:155], v[36:39], v[88:91]
  buffer_store_dwordx4 v[132:135], v7, s[4:7], s21 offen offset:256 sc1
  v_mfma_f32_16x16x32_bf16 v[92:95], a[156:159], v[36:39], v[92:95]
  s_waitcnt lgkmcnt(5)
  v_mfma_f32_16x16x32_bf16 v[64:67], a[160:163], v[40:43], v[64:67]
  ds_read_b128 v[32:35], v10 offset:24576
  v_mfma_f32_16x16x32_bf16 v[68:71], a[164:167], v[40:43], v[68:71]
  v_mfma_f32_16x16x32_bf16 v[80:83], a[168:171], v[40:43], v[80:83]
  v_mfma_f32_16x16x32_bf16 v[84:87], a[172:175], v[40:43], v[84:87]
  s_waitcnt lgkmcnt(5)
  v_mfma_f32_16x16x32_bf16 v[72:75], a[160:163], v[44:47], v[72:75]
  ds_read_b128 v[36:39], v11 offset:24576
  v_mfma_f32_16x16x32_bf16 v[76:79], a[164:167], v[44:47], v[76:79]
  v_mfma_f32_16x16x32_bf16 v[88:91], a[168:171], v[44:47], v[88:91]
  buffer_store_dwordx4 v[136:139], v7, s[4:7], s21 offen offset:2048 sc1
  v_mfma_f32_16x16x32_bf16 v[92:95], a[172:175], v[44:47], v[92:95]
  s_waitcnt lgkmcnt(5)
  v_mfma_f32_16x16x32_bf16 v[64:67], a[176:179], v[48:51], v[64:67]
  ds_read_b128 v[40:43], v12 offset:24576
  v_mfma_f32_16x16x32_bf16 v[68:71], a[180:183], v[48:51], v[68:71]
  v_mfma_f32_16x16x32_bf16 v[80:83], a[184:187], v[48:51], v[80:83]
  v_mfma_f32_16x16x32_bf16 v[84:87], a[188:191], v[48:51], v[84:87]
  s_waitcnt lgkmcnt(5)
  v_mfma_f32_16x16x32_bf16 v[72:75], a[176:179], v[52:55], v[72:75]
  ds_read_b128 v[44:47], v13 offset:24576
  v_mfma_f32_16x16x32_bf16 v[76:79], a[180:183], v[52:55], v[76:79]
  v_mfma_f32_16x16x32_bf16 v[88:91], a[184:187], v[52:55], v[88:91]
  buffer_store_dwordx4 v[140:143], v7, s[4:7], s21 offen offset:2304 sc1
  v_mfma_f32_16x16x32_bf16 v[92:95], a[188:191], v[52:55], v[92:95]
  s_waitcnt lgkmcnt(5)
  v_mfma_f32_16x16x32_bf16 v[64:67], a[192:195], v[24:27], v[64:67]
  s_mov_b32 s21, s27
  ds_read_b128 v[48:51], v14 offset:24576
  v_mfma_f32_16x16x32_bf16 v[68:71], a[196:199], v[24:27], v[68:71]
  v_mov_b32 v7, v56
  v_mfma_f32_16x16x32_bf16 v[80:83], a[200:203], v[24:27], v[80:83]
  v_mfma_f32_16x16x32_bf16 v[84:87], a[204:207], v[24:27], v[84:87]
  s_waitcnt lgkmcnt(5)
  v_mfma_f32_16x16x32_bf16 v[72:75], a[192:195], v[28:31], v[72:75]
  s_add_u32 s27, s27, s22
  ds_read_b128 v[52:55], v15 offset:24576
  v_mfma_f32_16x16x32_bf16 v[76:79], a[196:199], v[28:31], v[76:79]
  v_mfma_f32_16x16x32_bf16 v[88:91], a[200:203], v[28:31], v[88:91]
  s_waitcnt vmcnt(13)
  s_barrier
  v_mfma_f32_16x16x32_bf16 v[92:95], a[204:207], v[28:31], v[92:95]
  s_waitcnt lgkmcnt(5)
  v_mfma_f32_16x16x32_bf16 v[64:67], a[208:211], v[32:35], v[64:67]
  ds_read_b128 v[24:27], v8 offset:32768
  v_mfma_f32_16x16x32_bf16 v[68:71], a[212:215], v[32:35], v[68:71]
  v_mfma_f32_16x16x32_bf16 v[80:83], a[216:219], v[32:35], v[80:83]
  v_mfma_f32_16x16x32_bf16 v[84:87], a[220:223], v[32:35], v[84:87]
  s_waitcnt lgkmcnt(5)
  v_mfma_f32_16x16x32_bf16 v[72:75], a[208:211], v[36:39], v[72:75]
  s_add_u32 s29, s29, 1
  ds_read_b128 v[28:31], v9 offset:32768
  v_mfma_f32_16x16x32_bf16 v[76:79], a[212:215], v[36:39], v[76:79]
  v_mfma_f32_16x16x32_bf16 v[88:91], a[216:219], v[36:39], v[88:91]
  s_max_i32 s30, s29, 0
  v_mfma_f32_16x16x32_bf16 v[92:95], a[220:223], v[36:39], v[92:95]
  s_waitcnt lgkmcnt(5)
  v_mov_b32 v144, s30
  v_mfma_f32_16x16x32_bf16 v[64:67], a[224:227], v[40:43], v[64:67]
  ds_read_b128 v[32:35], v10 offset:32768
  v_mfma_f32_16x16x32_bf16 v[68:71], a[228:231], v[40:43], v[68:71]
  v_mfma_f32_16x16x32_bf16 v[80:83], a[232:235], v[40:43], v[80:83]
  buffer_store_dword v144, v145, s[4:7], s31 offen sc1
  v_mfma_f32_16x16x32_bf16 v[84:87], a[236:239], v[40:43], v[84:87]
  s_waitcnt lgkmcnt(5)
  v_mfma_f32_16x16x32_bf16 v[72:75], a[224:227], v[44:47], v[72:75]
  ds_read_b128 v[36:39], v11 offset:32768
  v_mfma_f32_16x16x32_bf16 v[76:79], a[228:231], v[44:47], v[76:79]
  v_mfma_f32_16x16x32_bf16 v[88:91], a[232:235], v[44:47], v[88:91]
  v_mfma_f32_16x16x32_bf16 v[92:95], a[236:239], v[44:47], v[92:95]
  s_waitcnt lgkmcnt(5)
  v_mfma_f32_16x16x32_bf16 v[64:67], a[240:243], v[48:51], v[64:67]
  s_sub_u32 s23, s23, 1
  ds_read_b128 v[40:43], v12 offset:32768
  v_mfma_f32_16x16x32_bf16 v[68:71], a[244:247], v[48:51], v[68:71]
  v_mfma_f32_16x16x32_bf16 v[80:83], a[248:251], v[48:51], v[80:83]
  v_mfma_f32_16x16x32_bf16 v[84:87], a[252:255], v[48:51], v[84:87]
  s_waitcnt lgkmcnt(5)
  v_mfma_f32_16x16x32_bf16 v[72:75], a[240:243], v[52:55], v[72:75]
  s_cmp_eq_u32 s23, 0
  ds_read_b128 v[44:47], v13 offset:32768
  v_mfma_f32_16x16x32_bf16 v[76:79], a[244:247], v[52:55], v[76:79]
  v_mfma_f32_16x16x32_bf16 v[88:91], a[248:251], v[52:55], v[88:91]
  v_mfma_f32_16x16x32_bf16 v[92:95], a[252:255], v[52:55], v[92:95]
  s_cbranch_scc1 G_done0_133
  s_waitcnt lgkmcnt(5)
  v_mfma_f32_16x16x32_bf16 v[96:99], a[0:3], v[24:27], 0
  s_add_u32 m0, s25, 0
  ds_read_b128 v[48:51], v14 offset:32768
  v_mfma_f32_16x16x32_bf16 v[100:103], a[4:7], v[24:27], 0
  v_mfma_f32_16x16x32_bf16 v[112:115], a[8:11], v[24:27], 0
  buffer_load_dwordx4 v16, s[12:15], s19 offen lds
  v_mfma_f32_16x16x32_bf16 v[116:119], a[12:15], v[24:27], 0
  s_waitcnt lgkmcnt(5)
  v_mfma_f32_16x16x32_bf16 v[104:107], a[0:3], v[28:31], 0
  ds_read_b128 v[52:55], v15 offset:32768
  v_mfma_f32_16x16x32_bf16 v[108:111], a[4:7], v[28:31], 0
  v_cvt_pk_bf16_f32 v128, v64, v65
  v_cvt_pk_bf16_f32 v129, v66, v67
  v_mfma_f32_16x16x32_bf16 v[120:123], a[8:11], v[28:31], 0
  v_mfma_f32_16x16x32_bf16 v[124:127], a[12:15], v[28:31], 0
  s_waitcnt lgkmcnt(5)
  v_cvt_pk_bf16_f32 v130, v68, v69
  v_cvt_pk_bf16_f32 v131, v70, v71
  v_mfma_f32_16x16x32_bf16 v[96:99], a[16:19], v[32:35], v[96:99]
  s_add_u32 m0, s25, 1024
  ds_read_b128 v[24:27], v8 offset:40960
  v_mfma_f32_16x16x32_bf16 v[100:103], a[20:23], v[32:35], v[100:103]
  v_mfma_f32_16x16x32_bf16 v[112:115], a[24:27], v[32:35], v[112:115]
  buffer_load_dwordx4 v17, s[12:15], s19 offen lds
  v_mfma_f32_16x16x32_bf16 v[116:119], a[28:31], v[32:35], v[116:119]
  s_waitcnt lgkmcnt(5)
  v_mfma_f32_16x16x32_bf16 v[104:107], a[16:19], v[36:39], v[104:107]
  ds_read_b128 v[28:31], v9 offset:40960
  v_mfma_f32_16x16x32_bf16 v[108:111], a[20:23], v[36:39], v[108:111]
  v_mfma_f32_16x16x32_bf16 v[120:123], a[24:27], v[36:39], v[120:123]
  v_mfma_f32_16x16x32_bf16 v[124:127], a[28:31], v[36:39], v[124:127]
  s_waitcnt lgkmcnt(5)
  v_mfma_f32_16x16x32_bf16 v[96:99], a[32:35], v[40:43], v[96:99]
  s_add_u32 m0, s25, 2048
  ds_read_b128 v[32:35], v10 offset:40960
  v_mfma_f32_16x16x32_bf16 v[100:103], a[36:39], v[40:43], v[100:103]
  v_cvt_pk_bf16_f32 v132, v72, v73
  v_cvt_pk_bf16_f32 v133, v74, v75
  v_mfma_f32_16x16x32_bf16 v[112:115], a[40:43], v[40:43], v[112:115]
  buffer_load_dwordx4 v18, s[12:15], s19 offen lds
  v_mfma_f32_16x16x32_bf16 v[116:119], a[44:47], v[40:43], v[116:119]
  s_waitcnt lgkmcnt(5)
  v_cvt_pk_bf16_f32 v134, v76, v77
  v_cvt_pk_bf16_f32 v135, v78, v79
  v_mfma_f32_16x16x32_bf16 v[104:107], a[32:35], v[44:47], v[104:107]
  ds_read_b128 v[36:39], v11 offset:40960
  v_mfma_f32_16x16x32_bf16 v[108:111], a[36:39], v[44:47], v[108:111]
  v_mfma_f32_16x16x32_bf16 v[120:123], a[40:43], v[44:47], v[120:123]
  v_mfma_f32_16x16x32_bf16 v[124:127], a[44:47], v[44:47], v[124:127]
  s_waitcnt lgkmcnt(5)
  v_mfma_f32_16x16x32_bf16 v[96:99], a[48:51], v[48:51], v[96:99]
  s_add_u32 m0, s25, 3072
  ds_read_b128 v[40:43], v12 offset:40960
  v_mfma_f32_16x16x32_bf16 v[100:103], a[52:55], v[48:51], v[100:103]
  v_mfma_f32_16x16x32_bf16 v[112:115], a[56:59], v[48:51], v[112:115]
  buffer_load_dwordx4 v19, s[12:15], s19 offen lds
  v_mfma_f32_16x16x32_bf16 v[116:119], a[60:63], v[48:51], v[116:119]
  s_waitcnt lgkmcnt(5)
  v_mfma_f32_16x16x32_bf16 v[104:107], a[48:51], v[52:55], v[104:107]
  ds_read_b128 v[44:47], v13 offset:40960
  v_mfma_f32_16x16x32_bf16 v[108:111], a[52:55], v[52:55], v[108:111]
  v_cvt_pk_bf16_f32 v136, v80, v81
  v_cvt_pk_bf16_f32 v137, v82, v83
  v_mfma_f32_16x16x32_bf16 v[120:123], a[56:59], v[52:55], v[120:123]
  v_mfma_f32_16x16x32_bf16 v[124:127], a[60:63], v[52:55], v[124:127]
  s_waitcnt lgkmcnt(5)
  v_cvt_pk_bf16_f32 v138, v84, v85
  v_cvt_pk_bf16_f32 v139, v86, v87
  v_mfma_f32_16x16x32_bf16 v[96:99], a[64:67], v[24:27], v[96:99]
  s_add_u32 m0, s25, 4096
  ds_read_b128 v[48:51], v14 offset:40960
  v_mfma_f32_16x16x32_bf16 v[100:103], a[68:71], v[24:27], v[100:103]
  v_mfma_f32_16x16x32_bf16 v[112:115], a[72:75], v[24:27], v[112:115]
  buffer_load_dwordx4 v20, s[12:15], s19 offen lds
  v_mfma_f32_16x16x32_bf16 v[116:119], a[76:79], v[24:27], v[116:119]
  s_waitcnt lgkmcnt(5)
  v_mfma_f32_16x16x32_bf16 v[104:107], a[64:67], v[28:31], v[104:107]
  ds_read_b128 v[52:55], v15 offset:40960
  v_mfma_f32_16x16x32_bf16 v[108:111], a[68:71], v[28:31], v[108:111]
  v_mfma_f32_16x16x32_bf16 v[120:123], a[72:75], v[28:31], v[120:123]
  v_mfma_f32_16x16x32_bf16 v[124:127], a[76:79], v[28:31], v[124:127]
  s_waitcnt lgkmcnt(5)
  v_mfma_f32_16x16x32_bf16 v[96:99], a[80:83], v[32:35], v[96:99]
  s_add_u32 m0, s25, 5120
  ds_read_b128 v[24:27], v8 offset:49152
  v_mfma_f32_16x16x32_bf16 v[100:103], a[84:87], v[32:35], v[100:103]
  v_cvt_pk_bf16_f32 v140, v88, v89
  v_cvt_pk_bf16_f32 v141, v90, v91
  v_mfma_f32_16x16x32_bf16 v[112:115], a[88:91], v[32:35], v[112:115]
  buffer_load_dwordx4 v21, s[12:15], s19 offen lds
  v_mfma_f32_16x16x32_bf16 v[116:119], a[92:95], v[32:35], v[116:119]
  s_waitcnt lgkmcnt(5)
  v_cvt_pk_bf16_f32 v142, v92, v93
  v_cvt_pk_bf16_f32 v143, v94, v95
  v_mfma_f32_16x16x32_bf16 v[104:107], a[80:83], v[36:39], v[104:107]
  ds_read_b128 v[28:31], v9 offset:49152
  v_mfma_f32_16x16x32_bf16 v[108:111], a[84:87], v[36:39], v[108:111]
  v_mfma_f32_16x16x32_bf16 v[120:123], a[88:91], v[36:39], v[120:123]
  v_mfma_f32_16x16x32_bf16 v[124:127], a[92:95], v[36:39], v[124:127]
  s_waitcnt lgkmcnt(5)
  v_mfma_f32_16x16x32_bf16 v[96:99], a[96:99], v[40:43], v[96:99]
  s_add_u32 m0, s25, 6144
  ds_read_b128 v[32:35], v10 offset:49152
  v_mfma_f32_16x16x32_bf16 v[100:103], a[100:103], v[40:43], v[100:103]
  v_mfma_f32_16x16x32_bf16 v[112:115], a[104:107], v[40:43], v[112:115]
  buffer_load_dwordx4 v22, s[12:15], s19 offen lds
  v_mfma_f32_16x16x32_bf16 v[116:119], a[108:111], v[40:43], v[116:119]
  s_waitcnt lgkmcnt(5)
  v_mfma_f32_16x16x32_bf16 v[104:107], a[96:99], v[44:47], v[104:107]
  ds_read_b128 v[36:39], v11 offset:49152
  v_mfma_f32_16x16x32_bf16 v[108:111], a[100:103], v[44:47], v[108:111]
  v_mfma_f32_16x16x32_bf16 v[120:123], a[104:107], v[44:47], v[120:123]
  v_mfma_f32_16x16x32_bf16 v[124:127], a[108:111], v[44:47], v[124:127]
  s_waitcnt lgkmcnt(5)
  v_mfma_f32_16x16x32_bf16 v[96:99], a[112:115], v[48:51], v[96:99]
  s_add_u32 m0, s25, 7168
  ds_read_b128 v[40:43], v12 offset:49152
  v_mfma_f32_16x16x32_bf16 v[100:103], a[116:119], v[48:51], v[100:103]
  v_mfma_f32_16x16x32_bf16 v[112:115], a[120:123], v[48:51], v[112:115]
  buffer_load_dwordx4 v23, s[12:15], s19 offen lds
  v_mfma_f32_16x16x32_bf16 v[116:119], a[124:127], v[48:51], v[116:119]
  s_waitcnt lgkmcnt(5)
  v_mfma_f32_16x16x32_bf16 v[104:107], a[112:115], v[52:55], v[104:107]
  s_cmp_gt_u32 s23, 3
  ds_read_b128 v[44:47], v13 offset:49152
  v_mfma_f32_16x16x32_bf16 v[108:111], a[116:119], v[52:55], v[108:111]
  v_mfma_f32_16x16x32_bf16 v[120:123], a[120:123], v[52:55], v[120:123]
  s_cselect_b32 s26, s20, 0
  v_mfma_f32_16x16x32_bf16 v[124:127], a[124:127], v[52:55], v[124:127]
  s_waitcnt lgkmcnt(5)
  v_mfma_f32_16x16x32_bf16 v[96:99], a[128:131], v[24:27], v[96:99]
  s_add_u32 s19, s19, s26
  ds_read_b128 v[48:51], v14 offset:49152
  v_mfma_f32_16x16x32_bf16 v[100:103], a[132:135], v[24:27], v[100:103]
  v_mfma_f32_16x16x32_bf16 v[112:115], a[136:139], v[24:27], v[112:115]
  s_add_u32 s25, s25, 32768
  v_mfma_f32_16x16x32_bf16 v[116:119], a[140:143], v[24:27], v[116:119]
  s_waitcnt lgkmcnt(5)
  v_mfma_f32_16x16x32_bf16 v[104:107], a[128:131], v[28:31], v[104:107]
  s_and_b32 s25, s25, 0x1ffff
  ds_read_b128 v[52:55], v15 offset:49152
  v_mfma_f32_16x16x32_bf16 v[108:111], a[132:135], v[28:31], v[108:111]
  v_mfma_f32_16x16x32_bf16 v[120:123], a[136:139], v[28:31], v[120:123]
  buffer_store_dwordx4 v[128:131], v7, s[4:7], s21 offen offset:0 sc1
  v_mfma_f32_16x16x32_bf16 v[124:127], a[140:143], v[28:31], v[124:127]
  s_waitcnt lgkmcnt(5)
  v_mfma_f32_16x16x32_bf16 v[96:99], a[144:147], v[32:35], v[96:99]
  ds_read_b128 v[24:27], v8 offset:57344
  v_mfma_f32_16x16x32_bf16 v[100:103], a[148:151], v[32:35], v[100:103]
  v_mfma_f32_16x16x32_bf16 v[112:115], a[152:155], v[32:35], v[112:115]
  v_mfma_f32_16x16x32_bf16 v[116:119], a[156:159], v[32:35], v[116:119]
  s_waitcnt lgkmcnt(5)
  v_xor_b32 v8, 0x10000, v8
  v_mfma_f32_16x16x32_bf16 v[104:107], a[144:147], v[36:39], v[104:107]
  ds_read_b128 v[28:31], v9 offset:57344
  v_mfma_f32_16x16x32_bf16 v[108:111], a[148:151], v[36:39], v[108:111]
  v_mfma_f32_16x16x32_bf16 v[120:123], a[152:155], v[36:39], v[120:123]
  buffer_store_dwordx4 v[132:135], v7, s[4:7], s21 offen offset:256 sc1
  v_mfma_f32_16x16x32_bf16 v[124:127], a[156:159], v[36:39], v[124:127]
  s_waitcnt lgkmcnt(5)
  v_xor_b32 v9, 0x10000, v9
  v_mfma_f32_16x16x32_bf16 v[96:99], a[160:163], v[40:43], v[96:99]
  ds_read_b128 v[32:35], v10 offset:57344
  v_mfma_f32_16x16x32_bf16 v[100:103], a[164:167], v[40:43], v[100:103]
  v_mfma_f32_16x16x32_bf16 v[112:115], a[168:171], v[40:43], v[112:115]
  v_mfma_f32_16x16x32_bf16 v[116:119], a[172:175], v[40:43], v[116:119]
  s_waitcnt lgkmcnt(5)
  v_xor_b32 v10, 0x10000, v10
  v_mfma_f32_16x16x32_bf16 v[104:107], a[160:163], v[44:47], v[104:107]
  ds_read_b128 v[36:39], v11 offset:57344
  v_mfma_f32_16x16x32_bf16 v[108:111], a[164:167], v[44:47], v[108:111]
  v_mfma_f32_16x16x32_bf16 v[120:123], a[168:171], v[44:47], v[120:123]
  buffer_store_dwordx4 v[136:139], v7, s[4:7], s21 offen offset:2048 sc1
  v_mfma_f32_16x16x32_bf16 v[124:127], a[172:175], v[44:47], v[124:127]
  s_waitcnt lgkmcnt(5)
  v_xor_b32 v11, 0x10000, v11
  v_mfma_f32_16x16x32_bf16 v[96:99], a[176:179], v[48:51], v[96:99]
  ds_read_b128 v[40:43], v12 offset:57344
  v_mfma_f32_16x16x32_bf16 v[100:103], a[180:183], v[48:51], v[100:103]
  v_mfma_f32_16x16x32_bf16 v[112:115], a[184:187], v[48:51], v[112:115]
  v_mfma_f32_16x16x32_bf16 v[116:119], a[188:191], v[48:51], v[116:119]
  s_waitcnt lgkmcnt(5)
  v_xor_b32 v12, 0x10000, v12
  v_mfma_f32_16x16x32_bf16 v[104:107], a[176:179], v[52:55], v[104:107]
  ds_read_b128 v[44:47], v13 offset:57344
  v_mfma_f32_16x16x32_bf16 v[108:111], a[180:183], v[52:55], v[108:111]
  v_mfma_f32_16x16x32_bf16 v[120:123], a[184:187], v[52:55], v[120:123]
  buffer_store_dwordx4 v[140:143], v7, s[4:7], s21 offen offset:2304 sc1
  v_mfma_f32_16x16x32_bf16 v[124:127], a[188:191], v[52:55], v[124:127]
  s_waitcnt lgkmcnt(5)
  v_xor_b32 v13, 0x10000, v13
  v_mfma_f32_16x16x32_bf16 v[96:99], a[192:195], v[24:27], v[96:99]
  s_mov_b32 s21, s27
  ds_read_b128 v[48:51], v14 offset:57344
  v_mfma_f32_16x16x32_bf16 v[100:103], a[196:199], v[24:27], v[100:103]
  v_mov_b32 v7, v56
  v_mfma_f32_16x16x32_bf16 v[112:115], a[200:203], v[24:27], v[112:115]
  v_mfma_f32_16x16x32_bf16 v[116:119], a[204:207], v[24:27], v[116:119]
  s_waitcnt lgkmcnt(5)
  v_xor_b32 v14, 0x10000, v14
  v_mfma_f32_16x16x32_bf16 v[104:107], a[192:195], v[28:31], v[104:107]
  s_add_u32 s27, s27, s22
  ds_read_b128 v[52:55], v15 offset:57344
  v_mfma_f32_16x16x32_bf16 v[108:111], a[196:199], v[28:31], v[108:111]
  v_mfma_f32_16x16x32_bf16 v[120:123], a[200:203], v[28:31], v[120:123]
  s_waitcnt vmcnt(13)
  s_barrier
  v_mfma_f32_16x16x32_bf16 v[124:127], a[204:207], v[28:31], v[124:127]
  s_waitcnt lgkmcnt(5)
  v_xor_b32 v15, 0x10000, v15
  v_mfma_f32_16x16x32_bf16 v[96:99], a[208:211], v[32:35], v[96:99]
  ds_read_b128 v[24:27], v8 offset:0
  v_mfma_f32_16x16x32_bf16 v[100:103], a[212:215], v[32:35], v[100:103]
  v_mfma_f32_16x16x32_bf16 v[112:115], a[216:219], v[32:35], v[112:115]
  v_mfma_f32_16x16x32_bf16 v[116:119], a[220:223], v[32:35], v[116:119]
  s_waitcnt lgkmcnt(5)
  v_mfma_f32_16x16x32_bf16 v[104:107], a[208:211], v[36:39], v[104:107]
  s_add_u32 s29, s29, 1
  ds_read_b128 v[28:31], v9 offset:0
  v_mfma_f32_16x16x32_bf16 v[108:111], a[212:215], v[36:39], v[108:111]
  v_mfma_f32_16x16x32_bf16 v[120:123], a[216:219], v[36:39], v[120:123]
  s_max_i32 s30, s29, 0
  v_mfma_f32_16x16x32_bf16 v[124:127], a[220:223], v[36:39], v[124:127]
  s_waitcnt lgkmcnt(5)
  v_mov_b32 v144, s30
  v_mfma_f32_16x16x32_bf16 v[96:99], a[224:227], v[40:43], v[96:99]
  ds_read_b128 v[32:35], v10 offset:0
  v_mfma_f32_16x16x32_bf16 v[100:103], a[228:231], v[40:43], v[100:103]
  v_mfma_f32_16x16x32_bf16 v[112:115], a[232:235], v[40:43], v[112:115]
  buffer_store_dword v144, v145, s[4:7], s31 offen sc1
  v_mfma_f32_16x16x32_bf16 v[116:119], a[236:239], v[40:43], v[116:119]
  s_waitcnt lgkmcnt(5)
  v_mfma_f32_16x16x32_bf16 v[104:107], a[224:227], v[44:47], v[104:107]
  ds_read_b128 v[36:39], v11 offset:0
  v_mfma_f32_16x16x32_bf16 v[108:111], a[228:231], v[44:47], v[108:111]
  v_mfma_f32_16x16x32_bf16 v[120:123], a[232:235], v[44:47], v[120:123]
  v_mfma_f32_16x16x32_bf16 v[124:127], a[236:239], v[44:47], v[124:127]
  s_waitcnt lgkmcnt(5)
  v_mfma_f32_16x16x32_bf16 v[96:99], a[240:243], v[48:51], v[96:99]
  s_sub_u32 s23, s23, 1
  ds_read_b128 v[40:43], v12 offset:0
  v_mfma_f32_16x16x32_bf16 v[100:103], a[244:247], v[48:51], v[100:103]
  v_mfma_f32_16x16x32_bf16 v[112:115], a[248:251], v[48:51], v[112:115]
  v_mfma_f32_16x16x32_bf16 v[116:119], a[252:255], v[48:51], v[116:119]
  s_waitcnt lgkmcnt(5)
  v_mfma_f32_16x16x32_bf16 v[104:107], a[240:243], v[52:55], v[104:107]
  s_cmp_eq_u32 s23, 0
  ds_read_b128 v[44:47], v13 offset:0
  v_mfma_f32_16x16x32_bf16 v[108:111], a[244:247], v[52:55], v[108:111]
  v_mfma_f32_16x16x32_bf16 v[120:123], a[248:251], v[52:55], v[120:123]
  v_mfma_f32_16x16x32_bf16 v[124:127], a[252:255], v[52:55], v[124:127]
  s_cbranch_scc1 G_done1_134
  s_branch G_top_132
G_done0_133:
  s_nop 7
  s_nop 3
  v_cvt_pk_bf16_f32 v128, v64, v65
  v_cvt_pk_bf16_f32 v129, v66, v67
  v_cvt_pk_bf16_f32 v130, v68, v69
  v_cvt_pk_bf16_f32 v131, v70, v71
  buffer_store_dwordx4 v[128:131], v7, s[4:7], s21 offen offset:0 sc1
  v_cvt_pk_bf16_f32 v132, v72, v73
  v_cvt_pk_bf16_f32 v133, v74, v75
  v_cvt_pk_bf16_f32 v134, v76, v77
  v_cvt_pk_bf16_f32 v135, v78, v79
  buffer_store_dwordx4 v[132:135], v7, s[4:7], s21 offen offset:256 sc1
  v_cvt_pk_bf16_f32 v136, v80, v81
  v_cvt_pk_bf16_f32 v137, v82, v83
  v_cvt_pk_bf16_f32 v138, v84, v85
  v_cvt_pk_bf16_f32 v139, v86, v87
  buffer_store_dwordx4 v[136:139], v7, s[4:7], s21 offen offset:2048 sc1
  v_cvt_pk_bf16_f32 v140, v88, v89
  v_cvt_pk_bf16_f32 v141, v90, v91
  v_cvt_pk_bf16_f32 v142, v92, v93
  v_cvt_pk_bf16_f32 v143, v94, v95
  buffer_store_dwordx4 v[140:143], v7, s[4:7], s21 offen offset:2304 sc1
  s_branch G_fin_135
G_done1_134:
  s_nop 7
  s_nop 3
  v_cvt_pk_bf16_f32 v128, v96, v97
  v_cvt_pk_bf16_f32 v129, v98, v99
  v_cvt_pk_bf16_f32 v130, v100, v101
  v_cvt_pk_bf16_f32 v131, v102, v103
  buffer_store_dwordx4 v[128:131], v7, s[4:7], s21 offen offset:0 sc1
  v_cvt_pk_bf16_f32 v132, v104, v105
  v_cvt_pk_bf16_f32 v133, v106, v107
  v_cvt_pk_bf16_f32 v134, v108, v109
  v_cvt_pk_bf16_f32 v135, v110, v111
  buffer_store_dwordx4 v[132:135], v7, s[4:7], s21 offen offset:256 sc1
  v_cvt_pk_bf16_f32 v136, v112, v113
  v_cvt_pk_bf16_f32 v137, v114, v115
  v_cvt_pk_bf16_f32 v138, v116, v117
  v_cvt_pk_bf16_f32 v139, v118, v119
  buffer_store_dwordx4 v[136:139], v7, s[4:7], s21 offen offset:2048 sc1
  v_cvt_pk_bf16_f32 v140, v120, v121
  v_cvt_pk_bf16_f32 v141, v122, v123
  v_cvt_pk_bf16_f32 v142, v124, v125
  v_cvt_pk_bf16_f32 v143, v126, v127
  buffer_store_dwordx4 v[140:143], v7, s[4:7], s21 offen offset:2304 sc1
G_fin_135:
  s_waitcnt vmcnt(0) lgkmcnt(0)
  s_barrier
  s_add_u32 s30, s29, 2
  v_mov_b32 v144, s30
  v_min_u32 v145, 1, v0
  v_lshlrev_b32 v145, 30, v145
  buffer_store_dword v144, v145, s[4:7], s31 offen sc1
  s_branch P_end_130
P_q_131:
  s_mov_b32 s27, s21
  v_mov_b32 v7, 0x40000000
  s_mov_b32 s29, -2
  v_min_u32 v145, 1, v0
  v_lshlrev_b32 v145, 30, v145
  ds_read_b128 v[24:27], v8 offset:0
  ds_read_b128 v[28:31], v9 offset:0
  ds_read_b128 v[32:35], v10 offset:0
  ds_read_b128 v[36:39], v11 offset:0
  ds_read_b128 v[40:43], v12 offset:0
  ds_read_b128 v[44:47], v13 offset:0
.p2align 6
G_top_136:
  s_waitcnt lgkmcnt(5)
  v_mfma_f32_16x16x32_bf16 v[64:67], a[0:3], v[24:27], 0
  s_add_u32 m0, s25, 0
  ds_read_b128 v[48:51], v14 offset:0
  v_mfma_f32_16x16x32_bf16 v[68:71], a[4:7], v[24:27], 0
  v_mfma_f32_16x16x32_bf16 v[80:83], a[8:11], v[24:27], 0
  buffer_load_dwordx4 v16, s[12:15], s19 offen lds
  v_mfma_f32_16x16x32_bf16 v[84:87], a[12:15], v[24:27], 0
  s_waitcnt lgkmcnt(5)
  v_mfma_f32_16x16x32_bf16 v[72:75], a[0:3], v[28:31], 0
  ds_read_b128 v[52:55], v15 offset:0
  v_mfma_f32_16x16x32_bf16 v[76:79], a[4:7], v[28:31], 0
  v_mul_f32 v96, s24, v96
  v_mul_f32 v97, s24, v97
  v_mfma_f32_16x16x32_bf16 v[88:91], a[8:11], v[28:31], 0
  v_mfma_f32_16x16x32_bf16 v[92:95], a[12:15], v[28:31], 0
  s_waitcnt lgkmcnt(5)
  v_cvt_pk_bf16_f32 v128, v96, v97
  v_mul_f32 v98, s24, v98
  v_mfma_f32_16x16x32_bf16 v[64:67], a[16:19], v[32:35], v[64:67]
  s_add_u32 m0, s25, 1024
  ds_read_b128 v[24:27], v8 offset:8192
  v_mfma_f32_16x16x32_bf16 v[68:71], a[20:23], v[32:35], v[68:71]
  v_mul_f32 v99, s24, v99
  v_cvt_pk_bf16_f32 v129, v98, v99
  v_mfma_f32_16x16x32_bf16 v[80:83], a[24:27], v[32:35], v[80:83]
  buffer_load_dwordx4 v17, s[12:15], s19 offen lds
  v_mfma_f32_16x16x32_bf16 v[84:87], a[28:31], v[32:35], v[84:87]
  s_waitcnt lgkmcnt(5)
  v_mul_f32 v100, s24, v100
  v_mul_f32 v101, s24, v101
  v_mfma_f32_16x16x32_bf16 v[72:75], a[16:19], v[36:39], v[72:75]
  ds_read_b128 v[28:31], v9 offset:8192
  v_mfma_f32_16x16x32_bf16 v[76:79], a[20:23], v[36:39], v[76:79]
  v_cvt_pk_bf16_f32 v130, v100, v101
  v_mul_f32 v102, s24, v102
  v_mfma_f32_16x16x32_bf16 v[88:91], a[24:27], v[36:39], v[88:91]
  v_mfma_f32_16x16x32_bf16 v[92:95], a[28:31], v[36:39], v[92:95]
  s_waitcnt lgkmcnt(5)
  v_mul_f32 v103, s24, v103
  v_cvt_pk_bf16_f32 v131, v102, v103
  v_mfma_f32_16x16x32_bf16 v[64:67], a[32:35], v[40:43], v[64:67]
  s_add_u32 m0, s25, 2048
  ds_read_b128 v[32:35], v10 offset:8192
  v_mfma_f32_16x16x32_bf16 v[68:71], a[36:39], v[40:43], v[68:71]
  v_mul_f32 v104, s24, v104
  v_mul_f32 v105, s24, v105
  v_mfma_f32_16x16x32_bf16 v[80:83], a[40:43], v[40:43], v[80:83]
  buffer_load_dwordx4 v18, s[12:15], s19 offen lds
  v_mfma_f32_16x16x32_bf16 v[84:87], a[44:47], v[40:43], v[84:87]
  s_waitcnt lgkmcnt(5)
  v_cvt_pk_bf16_f32 v132, v104, v105
  v_mul_f32 v106, s24, v106
  v_mfma_f32_16x16x32_bf16 v[72:75], a[32:35], v[44:47], v[72:75]
  ds_read_b128 v[36:39], v11 offset:8192
  v_mfma_f32_16x16x32_bf16 v[76:79], a[36:39], v[44:47], v[76:79]
  v_mul_f32 v107, s24, v107
  v_cvt_pk_bf16_f32 v133, v106, v107
  v_mfma_f32_16x16x32_bf16 v[88:91], a[40:43], v[44:47], v[88:91]
  v_mfma_f32_16x16x32_bf16 v[92:95], a[44:47], v[44:47], v[92:95]
  s_waitcnt lgkmcnt(5)
  v_mul_f32 v108, s24, v108
  v_mul_f32 v109, s24, v109
  v_mfma_f32_16x16x32_bf16 v[64:67], a[48:51], v[48:51], v[64:67]
  s_add_u32 m0, s25, 3072
  ds_read_b128 v[40:43], v12 offset:8192
  v_mfma_f32_16x16x32_bf16 v[68:71], a[52:55], v[48:51], v[68:71]
  v_cvt_pk_bf16_f32 v134, v108, v109
  v_mul_f32 v110, s24, v110
  v_mfma_f32_16x16x32_bf16 v[80:83], a[56:59], v[48:51], v[80:83]
  buffer_load_dwordx4 v19, s[12:15], s19 offen lds
  v_mfma_f32_16x16x32_bf16 v[84:87], a[60:63], v[48:51], v[84:87]
  s_waitcnt lgkmcnt(5)
  v_mul_f32 v111, s24, v111
  v_cvt_pk_bf16_f32 v135, v110, v111
  v_mfma_f32_16x16x32_bf16 v[72:75], a[48:51], v[52:55], v[72:75]
  ds_read_b128 v[44:47], v13 offset:8192
  v_mfma_f32_16x16x32_bf16 v[76:79], a[52:55], v[52:55], v[76:79]
  v_mul_f32 v112, s24, v112
  v_mul_f32 v113, s24, v113
  v_mfma_f32_16x16x32_bf16 v[88:91], a[56:59], v[52:55], v[88:91]
  v_mfma_f32_16x16x32_bf16 v[92:95], a[60:63], v[52:55], v[92:95]
  s_waitcnt lgkmcnt(5)
  v_cvt_pk_bf16_f32 v136, v112, v113
  v_mul_f32 v114, s24, v114
  v_mfma_f32_16x16x32_bf16 v[64:67], a[64:67], v[24:27], v[64:67]
  s_add_u32 m0, s25, 4096
  ds_read_b128 v[48:51], v14 offset:8192
  v_mfma_f32_16x16x32_bf16 v[68:71], a[68:71], v[24:27], v[68:71]
  v_mul_f32 v115, s24, v115
  v_cvt_pk_bf16_f32 v137, v114, v115
  v_mfma_f32_16x16x32_bf16 v[80:83], a[72:75], v[24:27], v[80:83]
  buffer_load_dwordx4 v20, s[12:15], s19 offen lds
  v_mfma_f32_16x16x32_bf16 v[84:87], a[76:79], v[24:27], v[84:87]
  s_waitcnt lgkmcnt(5)
  v_mul_f32 v116, s24, v116
  v_mul_f32 v117, s24, v117
  v_mfma_f32_16x16x32_bf16 v[72:75], a[64:67], v[28:31], v[72:75]
  ds_read_b128 v[52:55], v15 offset:8192
  v_mfma_f32_16x16x32_bf16 v[76:79], a[68:71], v[28:31], v[76:79]
  v_cvt_pk_bf16_f32 v138, v116, v117
  v_mul_f32 v118, s24, v118
  v_mfma_f32_16x16x32_bf16 v[88:91], a[72:75], v[28:31], v[88:91]
  v_mfma_f32_16x16x32_bf16 v[92:95], a[76:79], v[28:31], v[92:95]
  s_waitcnt lgkmcnt(5)
  v_mul_f32 v119, s24, v119
  v_cvt_pk_bf16_f32 v139, v118, v119
  v_mfma_f32_16x16x32_bf16 v[64:67], a[80:83], v[32:35], v[64:67]
  s_add_u32 m0, s25, 5120
  ds_read_b128 v[24:27], v8 offset:16384
  v_mfma_f32_16x16x32_bf16 v[68:71], a[84:87], v[32:35], v[68:71]
  v_mul_f32 v120, s24, v120
  v_mul_f32 v121, s24, v121
  v_mfma_f32_16x16x32_bf16 v[80:83], a[88:91], v[32:35], v[80:83]
  buffer_load_dwordx4 v21, s[12:15], s19 offen lds
  v_mfma_f32_16x16x32_bf16 v[84:87], a[92:95], v[32:35], v[84:87]
  s_waitcnt lgkmcnt(5)
  v_cvt_pk_bf16_f32 v140, v120, v121
  v_mul_f32 v122, s24, v122
  v_mfma_f32_16x16x32_bf16 v[72:75], a[80:83], v[36:39], v[72:75]
  ds_read_b128 v[28:31], v9 offset:16384
  v_mfma_f32_16x16x32_bf16 v[76:79], a[84:87], v[36:39], v[76:79]
  v_mul_f32 v123, s24, v123
  v_cvt_pk_bf16_f32 v141, v122, v123
  v_mfma_f32_16x16x32_bf16 v[88:91], a[88:91], v[36:39], v[88:91]
  v_mfma_f32_16x16x32_bf16 v[92:95], a[92:95], v[36:39], v[92:95]
  s_waitcnt lgkmcnt(5)
  v_mul_f32 v124, s24, v124
  v_mul_f32 v125, s24, v125
  v_mfma_f32_16x16x32_bf16 v[64:67], a[96:99], v[40:43], v[64:67]
  s_add_u32 m0, s25, 6144
  ds_read_b128 v[32:35], v10 offset:16384
  v_mfma_f32_16x16x32_bf16 v[68:71], a[100:103], v[40:43], v[68:71]
  v_cvt_pk_bf16_f32 v142, v124, v125
  v_mul_f32 v126, s24, v126
  v_mfma_f32_16x16x32_bf16 v[80:83], a[104:107], v[40:43], v[80:83]
  buffer_load_dwordx4 v22, s[12:15], s19 offen lds
  v_mfma_f32_16x16x32_bf16 v[84:87], a[108:111], v[40:43], v[84:87]
  s_waitcnt lgkmcnt(5)
  v_mul_f32 v127, s24, v127
  v_cvt_pk_bf16_f32 v143, v126, v127
  v_mfma_f32_16x16x32_bf16 v[72:75], a[96:99], v[44:47], v[72:75]
  ds_read_b128 v[36:39], v11 offset:16384
  v_mfma_f32_16x16x32_bf16 v[76:79], a[100:103], v[44:47], v[76:79]
  v_mfma_f32_16x16x32_bf16 v[88:91], a[104:107], v[44:47], v[88:91]
  v_mfma_f32_16x16x32_bf16 v[92:95], a[108:111], v[44:47], v[92:95]
  s_waitcnt lgkmcnt(5)
  v_mfma_f32_16x16x32_bf16 v[64:67], a[112:115], v[48:51], v[64:67]
  s_add_u32 m0, s25, 7168
  ds_read_b128 v[40:43], v12 offset:16384
  v_mfma_f32_16x16x32_bf16 v[68:71], a[116:119], v[48:51], v[68:71]
  v_mfma_f32_16x16x32_bf16 v[80:83], a[120:123], v[48:51], v[80:83]
  buffer_load_dwordx4 v23, s[12:15], s19 offen lds
  v_mfma_f32_16x16x32_bf16 v[84:87], a[124:127], v[48:51], v[84:87]
  s_waitcnt lgkmcnt(5)
  v_mfma_f32_16x16x32_bf16 v[72:75], a[112:115], v[52:55], v[72:75]
  s_cmp_gt_u32 s23, 3
  ds_read_b128 v[44:47], v13 offset:16384
  v_mfma_f32_16x16x32_bf16 v[76:79], a[116:119], v[52:55], v[76:79]
  v_mfma_f32_16x16x32_bf16 v[88:91], a[120:123], v[52:55], v[88:91]
  s_cselect_b32 s26, s20, 0
  v_mfma_f32_16x16x32_bf16 v[92:95], a[124:127], v[52:55], v[92:95]
  s_waitcnt lgkmcnt(5)
  v_mfma_f32_16x16x32_bf16 v[64:67], a[128:131], v[24:27], v[64:67]
  s_add_u32 s19, s19, s26
  ds_read_b128 v[48:51], v14 offset:16384
  v_mfma_f32_16x16x32_bf16 v[68:71], a[132:135], v[24:27], v[68:71]
  v_mfma_f32_16x16x32_bf16 v[80:83], a[136:139], v[24:27], v[80:83]
  s_add_u32 s25, s25, 32768
  v_mfma_f32_16x16x32_bf16 v[84:87], a[140:143], v[24:27], v[84:87]
  s_waitcnt lgkmcnt(5)
  v_mfma_f32_16x16x32_bf16 v[72:75], a[128:131], v[28:31], v[72:75]
  s_and_b32 s25, s25, 0x1ffff
  ds_read_b128 v[52:55], v15 offset:16384
  v_mfma_f32_16x16x32_bf16 v[76:79], a[132:135], v[28:31], v[76:79]
  v_mfma_f32_16x16x32_bf16 v[88:91], a[136:139], v[28:31], v[88:91]
  buffer_store_dwordx4 v[128:131], v7, s[4:7], s21 offen offset:0 sc1
  v_mfma_f32_16x16x32_bf16 v[92:95], a[140:143], v[28:31], v[92:95]
  s_waitcnt lgkmcnt(5)
  v_mfma_f32_16x16x32_bf16 v[64:67], a[144:147], v[32:35], v[64:67]
  ds_read_b128 v[24:27], v8 offset:24576
  v_mfma_f32_16x16x32_bf16 v[68:71], a[148:151], v[32:35], v[68:71]
  v_mfma_f32_16x16x32_bf16 v[80:83], a[152:155], v[32:35], v[80:83]
  v_mfma_f32_16x16x32_bf16 v[84:87], a[156:159], v[32:35], v[84:87]
  s_waitcnt lgkmcnt(5)
  v_mfma_f32_16x16x32_bf16 v[72:75], a[144:147], v[36:39], v[72:75]
  ds_read_b128 v[28:31], v9 offset:24576
  v_mfma_f32_16x16x32_bf16 v[76:79], a[148:151], v[36:39], v[76:79]
  v_mfma_f32_16x16x32_bf16 v[88:91], a[152:155], v[36:39], v[88:91]
  buffer_store_dwordx4 v[132:135], v7, s[4:7], s21 offen offset:256 sc1
  v_mfma_f32_16x16x32_bf16 v[92:95], a[156:159], v[36:39], v[92:95]
  s_waitcnt lgkmcnt(5)
  v_mfma_f32_16x16x32_bf16 v[64:67], a[160:163], v[40:43], v[64:67]
  ds_read_b128 v[32:35], v10 offset:24576
  v_mfma_f32_16x16x32_bf16 v[68:71], a[164:167], v[40:43], v[68:71]
  v_mfma_f32_16x16x32_bf16 v[80:83], a[168:171], v[40:43], v[80:83]
  v_mfma_f32_16x16x32_bf16 v[84:87], a[172:175], v[40:43], v[84:87]
  s_waitcnt lgkmcnt(5)
  v_mfma_f32_16x16x32_bf16 v[72:75], a[160:163], v[44:47], v[72:75]
  ds_read_b128 v[36:39], v11 offset:24576
  v_mfma_f32_16x16x32_bf16 v[76:79], a[164:167], v[44:47], v[76:79]
  v_mfma_f32_16x16x32_bf16 v[88:91], a[168:171], v[44:47], v[88:91]
  buffer_store_dwordx4 v[136:139], v7, s[4:7], s21 offen offset:2048 sc1
  v_mfma_f32_16x16x32_bf16 v[92:95], a[172:175], v[44:47], v[92:95]
  s_waitcnt lgkmcnt(5)
  v_mfma_f32_16x16x32_bf16 v[64:67], a[176:179], v[48:51], v[64:67]
  ds_read_b128 v[40:43], v12 offset:24576
  v_mfma_f32_16x16x32_bf16 v[68:71], a[180:183], v[48:51], v[68:71]
  v_mfma_f32_16x16x32_bf16 v[80:83], a[184:187], v[48:51], v[80:83]
  v_mfma_f32_16x16x32_bf16 v[84:87], a[188:191], v[48:51], v[84:87]
  s_waitcnt lgkmcnt(5)
  v_mfma_f32_16x16x32_bf16 v[72:75], a[176:179], v[52:55], v[72:75]
  ds_read_b128 v[44:47], v13 offset:24576
  v_mfma_f32_16x16x32_bf16 v[76:79], a[180:183], v[52:55], v[76:79]
  v_mfma_f32_16x16x32_bf16 v[88:91], a[184:187], v[52:55], v[88:91]
  buffer_store_dwordx4 v[140:143], v7, s[4:7], s21 offen offset:2304 sc1
  v_mfma_f32_16x16x32_bf16 v[92:95], a[188:191], v[52:55], v[92:95]
  s_waitcnt lgkmcnt(5)
  v_mfma_f32_16x16x32_bf16 v[64:67], a[192:195], v[24:27], v[64:67]
  s_mov_b32 s21, s27
  ds_read_b128 v[48:51], v14 offset:24576
  v_mfma_f32_16x16x32_bf16 v[68:71], a[196:199], v[24:27], v[68:71]
  v_mov_b32 v7, v56
  v_mfma_f32_16x16x32_bf16 v[80:83], a[200:203], v[24:27], v[80:83]
  v_mfma_f32_16x16x32_bf16 v[84:87], a[204:207], v[24:27], v[84:87]
  s_waitcnt lgkmcnt(5)
  v_mfma_f32_16x16x32_bf16 v[72:75], a[192:195], v[28:31], v[72:75]
  s_add_u32 s27, s27, s22
  ds_read_b128 v[52:55], v15 offset:24576
  v_mfma_f32_16x16x32_bf16 v[76:79], a[196:199], v[28:31], v[76:79]
  v_mfma_f32_16x16x32_bf16 v[88:91], a[200:203], v[28:31], v[88:91]
  s_waitcnt vmcnt(13)
  s_barrier
  v_mfma_f32_16x16x32_bf16 v[92:95], a[204:207], v[28:31], v[92:95]
  s_waitcnt lgkmcnt(5)
  v_mfma_f32_16x16x32_bf16 v[64:67], a[208:211], v[32:35], v[64:67]
  ds_read_b128 v[24:27], v8 offset:32768
  v_mfma_f32_16x16x32_bf16 v[68:71], a[212:215], v[32:35], v[68:71]
  v_mfma_f32_16x16x32_bf16 v[80:83], a[216:219], v[32:35], v[80:83]
  v_mfma_f32_16x16x32_bf16 v[84:87], a[220:223], v[32:35], v[84:87]
  s_waitcnt lgkmcnt(5)
  v_mfma_f32_16x16x32_bf16 v[72:75], a[208:211], v[36:39], v[72:75]
  s_add_u32 s29, s29, 1
  ds_read_b128 v[28:31], v9 offset:32768
  v_mfma_f32_16x16x32_bf16 v[76:79], a[212:215], v[36:39], v[76:79]
  v_mfma_f32_16x16x32_bf16 v[88:91], a[216:219], v[36:39], v[88:91]
  s_max_i32 s30, s29, 0
  v_mfma_f32_16x16x32_bf16 v[92:95], a[220:223], v[36:39], v[92:95]
  s_waitcnt lgkmcnt(5)
  v_mov_b32 v144, s30
  v_mfma_f32_16x16x32_bf16 v[64:67], a[224:227], v[40:43], v[64:67]
  ds_read_b128 v[32:35], v10 offset:32768
  v_mfma_f32_16x16x32_bf16 v[68:71], a[228:231], v[40:43], v[68:71]
  v_mfma_f32_16x16x32_bf16 v[80:83], a[232:235], v[40:43], v[80:83]
  buffer_store_dword v144, v145, s[4:7], s31 offen sc1
  v_mfma_f32_16x16x32_bf16 v[84:87], a[236:239], v[40:43], v[84:87]
  s_waitcnt lgkmcnt(5)
  v_mfma_f32_16x16x32_bf16 v[72:75], a[224:227], v[44:47], v[72:75]
  ds_read_b128 v[36:39], v11 offset:32768
  v_mfma_f32_16x16x32_bf16 v[76:79], a[228:231], v[44:47], v[76:79]
  v_mfma_f32_16x16x32_bf16 v[88:91], a[232:235], v[44:47], v[88:91]
  v_mfma_f32_16x16x32_bf16 v[92:95], a[236:239], v[44:47], v[92:95]
  s_waitcnt lgkmcnt(5)
  v_mfma_f32_16x16x32_bf16 v[64:67], a[240:243], v[48:51], v[64:67]
  s_sub_u32 s23, s23, 1
  ds_read_b128 v[40:43], v12 offset:32768
  v_mfma_f32_16x16x32_bf16 v[68:71], a[244:247], v[48:51], v[68:71]
  v_mfma_f32_16x16x32_bf16 v[80:83], a[248:251], v[48:51], v[80:83]
  v_mfma_f32_16x16x32_bf16 v[84:87], a[252:255], v[48:51], v[84:87]
  s_waitcnt lgkmcnt(5)
  v_mfma_f32_16x16x32_bf16 v[72:75], a[240:243], v[52:55], v[72:75]
  s_cmp_eq_u32 s23, 0
  ds_read_b128 v[44:47], v13 offset:32768
  v_mfma_f32_16x16x32_bf16 v[76:79], a[244:247], v[52:55], v[76:79]
  v_mfma_f32_16x16x32_bf16 v[88:91], a[248:251], v[52:55], v[88:91]
  v_mfma_f32_16x16x32_bf16 v[92:95], a[252:255], v[52:55], v[92:95]
  s_cbranch_scc1 G_done0_137
  s_waitcnt lgkmcnt(5)
  v_mfma_f32_16x16x32_bf16 v[96:99], a[0:3], v[24:27], 0
  s_add_u32 m0, s25, 0
  ds_read_b128 v[48:51], v14 offset:32768
  v_mfma_f32_16x16x32_bf16 v[100:103], a[4:7], v[24:27], 0
  v_mfma_f32_16x16x32_bf16 v[112:115], a[8:11], v[24:27], 0
  buffer_load_dwordx4 v16, s[12:15], s19 offen lds
  v_mfma_f32_16x16x32_bf16 v[116:119], a[12:15], v[24:27], 0
  s_waitcnt lgkmcnt(5)
  v_mfma_f32_16x16x32_bf16 v[104:107], a[0:3], v[28:31], 0
  ds_read_b128 v[52:55], v15 offset:32768
  v_mfma_f32_16x16x32_bf16 v[108:111], a[4:7], v[28:31], 0
  v_mul_f32 v64, s24, v64
  v_mul_f32 v65, s24, v65
  v_mfma_f32_16x16x32_bf16 v[120:123], a[8:11], v[28:31], 0
  v_mfma_f32_16x16x32_bf16 v[124:127], a[12:15], v[28:31], 0
  s_waitcnt lgkmcnt(5)
  v_cvt_pk_bf16_f32 v128, v64, v65
  v_mul_f32 v66, s24, v66
  v_mfma_f32_16x16x32_bf16 v[96:99], a[16:19], v[32:35], v[96:99]
  s_add_u32 m0, s25, 1024
  ds_read_b128 v[24:27], v8 offset:40960
  v_mfma_f32_16x16x32_bf16 v[100:103], a[20:23], v[32:35], v[100:103]
  v_mul_f32 v67, s24, v67
  v_cvt_pk_bf16_f32 v129, v66, v67
  v_mfma_f32_16x16x32_bf16 v[112:115], a[24:27], v[32:35], v[112:115]
  buffer_load_dwordx4 v17, s[12:15], s19 offen lds
  v_mfma_f32_16x16x32_bf16 v[116:119], a[28:31], v[32:35], v[116:119]
  s_waitcnt lgkmcnt(5)
  v_mul_f32 v68, s24, v68
  v_mul_f32 v69, s24, v69
  v_mfma_f32_16x16x32_bf16 v[104:107], a[16:19], v[36:39], v[104:107]
  ds_read_b128 v[28:31], v9 offset:40960
  v_mfma_f32_16x16x32_bf16 v[108:111], a[20:23], v[36:39], v[108:111]
  v_cvt_pk_bf16_f32 v130, v68, v69
  v_mul_f32 v70, s24, v70
  v_mfma_f32_16x16x32_bf16 v[120:123], a[24:27], v[36:39], v[120:123]
  v_mfma_f32_16x16x32_bf16 v[124:127], a[28:31], v[36:39], v[124:127]
  s_waitcnt lgkmcnt(5)
  v_mul_f32 v71, s24, v71
  v_cvt_pk_bf16_f32 v131, v70, v71
  v_mfma_f32_16x16x32_bf16 v[96:99], a[32:35], v[40:43], v[96:99]
  s_add_u32 m0, s25, 2048
  ds_read_b128 v[32:35], v10 offset:40960
  v_mfma_f32_16x16x32_bf16 v[100:103], a[36:39], v[40:43], v[100:103]
  v_mul_f32 v72, s24, v72
  v_mul_f32 v73, s24, v73
  v_mfma_f32_16x16x32_bf16 v[112:115], a[40:43], v[40:43], v[112:115]
  buffer_load_dwordx4 v18, s[12:15], s19 offen lds
  v_mfma_f32_16x16x32_bf16 v[116:119], a[44:47], v[40:43], v[116:119]
  s_waitcnt lgkmcnt(5)
  v_cvt_pk_bf16_f32 v132, v72, v73
  v_mul_f32 v74, s24, v74
  v_mfma_f32_16x16x32_bf16 v[104:107], a[32:35], v[44:47], v[104:107]
  ds_read_b128 v[36:39], v11 offset:40960
  v_mfma_f32_16x16x32_bf16 v[108:111], a[36:39], v[44:47], v[108:111]
  v_mul_f32 v75, s24, v75
  v_cvt_pk_bf16_f32 v133, v74, v75
  v_mfma_f32_16x16x32_bf16 v[120:123], a[40:43], v[44:47], v[120:123]
  v_mfma_f32_16x16x32_bf16 v[124:127], a[44:47], v[44:47], v[124:127]
  s_waitcnt lgkmcnt(5)
  v_mul_f32 v76, s24, v76
  v_mul_f32 v77, s24, v77
  v_mfma_f32_16x16x32_bf16 v[96:99], a[48:51], v[48:51], v[96:99]
  s_add_u32 m0, s25, 3072
  ds_read_b128 v[40:43], v12 offset:40960
  v_mfma_f32_16x16x32_bf16 v[100:103], a[52:55], v[48:51], v[100:103]
  v_cvt_pk_bf16_f32 v134, v76, v77
  v_mul_f32 v78, s24, v78
  v_mfma_f32_16x16x32_bf16 v[112:115], a[56:59], v[48:51], v[112:115]
  buffer_load_dwordx4 v19, s[12:15], s19 offen lds
  v_mfma_f32_16x16x32_bf16 v[116:119], a[60:63], v[48:51], v[116:119]
  s_waitcnt lgkmcnt(5)
  v_mul_f32 v79, s24, v79
  v_cvt_pk_bf16_f32 v135, v78, v79
  v_mfma_f32_16x16x32_bf16 v[104:107], a[48:51], v[52:55], v[104:107]
  ds_read_b128 v[44:47], v13 offset:40960
  v_mfma_f32_16x16x32_bf16 v[108:111], a[52:55], v[52:55], v[108:111]
  v_mul_f32 v80, s24, v80
  v_mul_f32 v81, s24, v81
  v_mfma_f32_16x16x32_bf16 v[120:123], a[56:59], v[52:55], v[120:123]
  v_mfma_f32_16x16x32_bf16 v[124:127], a[60:63], v[52:55], v[124:127]
  s_waitcnt lgkmcnt(5)
  v_cvt_pk_bf16_f32 v136, v80, v81
  v_mul_f32 v82, s24, v82
  v_mfma_f32_16x16x32_bf16 v[96:99], a[64:67], v[24:27], v[96:99]
  s_add_u32 m0, s25, 4096
  ds_read_b128 v[48:51], v14 offset:40960
  v_mfma_f32_16x16x32_bf16 v[100:103], a[68:71], v[24:27], v[100:103]
  v_mul_f32 v83, s24, v83
  v_cvt_pk_bf16_f32 v137, v82, v83
  v_mfma_f32_16x16x32_bf16 v[112:115], a[72:75], v[24:27], v[112:115]
  buffer_load_dwordx4 v20, s[12:15], s19 offen lds
  v_mfma_f32_16x16x32_bf16 v[116:119], a[76:79], v[24:27], v[116:119]
  s_waitcnt lgkmcnt(5)
  v_mul_f32 v84, s24, v84
  v_mul_f32 v85, s24, v85
  v_mfma_f32_16x16x32_bf16 v[104:107], a[64:67], v[28:31], v[104:107]
  ds_read_b128 v[52:55], v15 offset:40960
  v_mfma_f32_16x16x32_bf16 v[108:111], a[68:71], v[28:31], v[108:111]
  v_cvt_pk_bf16_f32 v138, v84, v85
  v_mul_f32 v86, s24, v86
  v_mfma_f32_16x16x32_bf16 v[120:123], a[72:75], v[28:31], v[120:123]
  v_mfma_f32_16x16x32_bf16 v[124:127], a[76:79], v[28:31], v[124:127]
  s_waitcnt lgkmcnt(5)
  v_mul_f32 v87, s24, v87
  v_cvt_pk_bf16_f32 v139, v86, v87
  v_mfma_f32_16x16x32_bf16 v[96:99], a[80:83], v[32:35], v[96:99]
  s_add_u32 m0, s25, 5120
  ds_read_b128 v[24:27], v8 offset:49152
  v_mfma_f32_16x16x32_bf16 v[100:103], a[84:87], v[32:35], v[100:103]
  v_mul_f32 v88, s24, v88
  v_mul_f32 v89, s24, v89
  v_mfma_f32_16x16x32_bf16 v[112:115], a[88:91], v[32:35], v[112:115]
  buffer_load_dwordx4 v21, s[12:15], s19 offen lds
  v_mfma_f32_16x16x32_bf16 v[116:119], a[92:95], v[32:35], v[116:119]
  s_waitcnt lgkmcnt(5)
  v_cvt_pk_bf16_f32 v140, v88, v89
  v_mul_f32 v90, s24, v90
  v_mfma_f32_16x16x32_bf16 v[104:107], a[80:83], v[36:39], v[104:107]
  ds_read_b128 v[28:31], v9 offset:49152
  v_mfma_f32_16x16x32_bf16 v[108:111], a[84:87], v[36:39], v[108:111]
  v_mul_f32 v91, s24, v91
  v_cvt_pk_bf16_f32 v141, v90, v91
  v_mfma_f32_16x16x32_bf16 v[120:123], a[88:91], v[36:39], v[120:123]
  v_mfma_f32_16x16x32_bf16 v[124:127], a[92:95], v[36:39], v[124:127]
  s_waitcnt lgkmcnt(5)
  v_mul_f32 v92, s24, v92
  v_mul_f32 v93, s24, v93
  v_mfma_f32_16x16x32_bf16 v[96:99], a[96:99], v[40:43], v[96:99]
  s_add_u32 m0, s25, 6144
  ds_read_b128 v[32:35], v10 offset:49152
  v_mfma_f32_16x16x32_bf16 v[100:103], a[100:103], v[40:43], v[100:103]
  v_cvt_pk_bf16_f32 v142, v92, v93
  v_mul_f32 v94, s24, v94
  v_mfma_f32_16x16x32_bf16 v[112:115], a[104:107], v[40:43], v[112:115]
  buffer_load_dwordx4 v22, s[12:15], s19 offen lds
  v_mfma_f32_16x16x32_bf16 v[116:119], a[108:111], v[40:43], v[116:119]
  s_waitcnt lgkmcnt(5)
  v_mul_f32 v95, s24, v95
  v_cvt_pk_bf16_f32 v143, v94, v95
  v_mfma_f32_16x16x32_bf16 v[104:107], a[96:99], v[44:47], v[104:107]
  ds_read_b128 v[36:39], v11 offset:49152
  v_mfma_f32_16x16x32_bf16 v[108:111], a[100:103], v[44:47], v[108:111]
  v_mfma_f32_16x16x32_bf16 v[120:123], a[104:107], v[44:47], v[120:123]
  v_mfma_f32_16x16x32_bf16 v[124:127], a[108:111], v[44:47], v[124:127]
  s_waitcnt lgkmcnt(5)
  v_mfma_f32_16x16x32_bf16 v[96:99], a[112:115], v[48:51], v[96:99]
  s_add_u32 m0, s25, 7168
  ds_read_b128 v[40:43], v12 offset:49152
  v_mfma_f32_16x16x32_bf16 v[100:103], a[116:119], v[48:51], v[100:103]
  v_mfma_f32_16x16x32_bf16 v[112:115], a[120:123], v[48:51], v[112:115]
  buffer_load_dwordx4 v23, s[12:15], s19 offen lds
  v_mfma_f32_16x16x32_bf16 v[116:119], a[124:127], v[48:51], v[116:119]
  s_waitcnt lgkmcnt(5)
  v_mfma_f32_16x16x32_bf16 v[104:107], a[112:115], v[52:55], v[104:107]
  s_cmp_gt_u32 s23, 3
  ds_read_b128 v[44:47], v13 offset:49152
  v_mfma_f32_16x16x32_bf16 v[108:111], a[116:119], v[52:55], v[108:111]
  v_mfma_f32_16x16x32_bf16 v[120:123], a[120:123], v[52:55], v[120:123]
  s_cselect_b32 s26, s20, 0
  v_mfma_f32_16x16x32_bf16 v[124:127], a[124:127], v[52:55], v[124:127]
  s_waitcnt lgkmcnt(5)
  v_mfma_f32_16x16x32_bf16 v[96:99], a[128:131], v[24:27], v[96:99]
  s_add_u32 s19, s19, s26
  ds_read_b128 v[48:51], v14 offset:49152
  v_mfma_f32_16x16x32_bf16 v[100:103], a[132:135], v[24:27], v[100:103]
  v_mfma_f32_16x16x32_bf16 v[112:115], a[136:139], v[24:27], v[112:115]
  s_add_u32 s25, s25, 32768
  v_mfma_f32_16x16x32_bf16 v[116:119], a[140:143], v[24:27], v[116:119]
  s_waitcnt lgkmcnt(5)
  v_mfma_f32_16x16x32_bf16 v[104:107], a[128:131], v[28:31], v[104:107]
  s_and_b32 s25, s25, 0x1ffff
  ds_read_b128 v[52:55], v15 offset:49152
  v_mfma_f32_16x16x32_bf16 v[108:111], a[132:135], v[28:31], v[108:111]
  v_mfma_f32_16x16x32_bf16 v[120:123], a[136:139], v[28:31], v[120:123]
  buffer_store_dwordx4 v[128:131], v7, s[4:7], s21 offen offset:0 sc1
  v_mfma_f32_16x16x32_bf16 v[124:127], a[140:143], v[28:31], v[124:127]
  s_waitcnt lgkmcnt(5)
  v_mfma_f32_16x16x32_bf16 v[96:99], a[144:147], v[32:35], v[96:99]
  ds_read_b128 v[24:27], v8 offset:57344
  v_mfma_f32_16x16x32_bf16 v[100:103], a[148:151], v[32:35], v[100:103]
  v_mfma_f32_16x16x32_bf16 v[112:115], a[152:155], v[32:35], v[112:115]
  v_mfma_f32_16x16x32_bf16 v[116:119], a[156:159], v[32:35], v[116:119]
  s_waitcnt lgkmcnt(5)
  v_xor_b32 v8, 0x10000, v8
  v_mfma_f32_16x16x32_bf16 v[104:107], a[144:147], v[36:39], v[104:107]
  ds_read_b128 v[28:31], v9 offset:57344
  v_mfma_f32_16x16x32_bf16 v[108:111], a[148:151], v[36:39], v[108:111]
  v_mfma_f32_16x16x32_bf16 v[120:123], a[152:155], v[36:39], v[120:123]
  buffer_store_dwordx4 v[132:135], v7, s[4:7], s21 offen offset:256 sc1
  v_mfma_f32_16x16x32_bf16 v[124:127], a[156:159], v[36:39], v[124:127]
  s_waitcnt lgkmcnt(5)
  v_xor_b32 v9, 0x10000, v9
  v_mfma_f32_16x16x32_bf16 v[96:99], a[160:163], v[40:43], v[96:99]
  ds_read_b128 v[32:35], v10 offset:57344
  v_mfma_f32_16x16x32_bf16 v[100:103], a[164:167], v[40:43], v[100:103]
  v_mfma_f32_16x16x32_bf16 v[112:115], a[168:171], v[40:43], v[112:115]
  v_mfma_f32_16x16x32_bf16 v[116:119], a[172:175], v[40:43], v[116:119]
  s_waitcnt lgkmcnt(5)
  v_xor_b32 v10, 0x10000, v10
  v_mfma_f32_16x16x32_bf16 v[104:107], a[160:163], v[44:47], v[104:107]
  ds_read_b128 v[36:39], v11 offset:57344
  v_mfma_f32_16x16x32_bf16 v[108:111], a[164:167], v[44:47], v[108:111]
  v_mfma_f32_16x16x32_bf16 v[120:123], a[168:171], v[44:47], v[120:123]
  buffer_store_dwordx4 v[136:139], v7, s[4:7], s21 offen offset:2048 sc1
  v_mfma_f32_16x16x32_bf16 v[124:127], a[172:175], v[44:47], v[124:127]
  s_waitcnt lgkmcnt(5)
  v_xor_b32 v11, 0x10000, v11
  v_mfma_f32_16x16x32_bf16 v[96:99], a[176:179], v[48:51], v[96:99]
  ds_read_b128 v[40:43], v12 offset:57344
  v_mfma_f32_16x16x32_bf16 v[100:103], a[180:183], v[48:51], v[100:103]
  v_mfma_f32_16x16x32_bf16 v[112:115], a[184:187], v[48:51], v[112:115]
  v_mfma_f32_16x16x32_bf16 v[116:119], a[188:191], v[48:51], v[116:119]
  s_waitcnt lgkmcnt(5)
  v_xor_b32 v12, 0x10000, v12
  v_mfma_f32_16x16x32_bf16 v[104:107], a[176:179], v[52:55], v[104:107]
  ds_read_b128 v[44:47], v13 offset:57344
  v_mfma_f32_16x16x32_bf16 v[108:111], a[180:183], v[52:55], v[108:111]
  v_mfma_f32_16x16x32_bf16 v[120:123], a[184:187], v[52:55], v[120:123]
  buffer_store_dwordx4 v[140:143], v7, s[4:7], s21 offen offset:2304 sc1
  v_mfma_f32_16x16x32_bf16 v[124:127], a[188:191], v[52:55], v[124:127]
  s_waitcnt lgkmcnt(5)
  v_xor_b32 v13, 0x10000, v13
  v_mfma_f32_16x16x32_bf16 v[96:99], a[192:195], v[24:27], v[96:99]
  s_mov_b32 s21, s27
  ds_read_b128 v[48:51], v14 offset:57344
  v_mfma_f32_16x16x32_bf16 v[100:103], a[196:199], v[24:27], v[100:103]
  v_mov_b32 v7, v56
  v_mfma_f32_16x16x32_bf16 v[112:115], a[200:203], v[24:27], v[112:115]
  v_mfma_f32_16x16x32_bf16 v[116:119], a[204:207], v[24:27], v[116:119]
  s_waitcnt lgkmcnt(5)
  v_xor_b32 v14, 0x10000, v14
  v_mfma_f32_16x16x32_bf16 v[104:107], a[192:195], v[28:31], v[104:107]
  s_add_u32 s27, s27, s22
  ds_read_b128 v[52:55], v15 offset:57344
  v_mfma_f32_16x16x32_bf16 v[108:111], a[196:199], v[28:31], v[108:111]
  v_mfma_f32_16x16x32_bf16 v[120:123], a[200:203], v[28:31], v[120:123]
  s_waitcnt vmcnt(13)
  s_barrier
  v_mfma_f32_16x16x32_bf16 v[124:127], a[204:207], v[28:31], v[124:127]
  s_waitcnt lgkmcnt(5)
  v_xor_b32 v15, 0x10000, v15
  v_mfma_f32_16x16x32_bf16 v[96:99], a[208:211], v[32:35], v[96:99]
  ds_read_b128 v[24:27], v8 offset:0
  v_mfma_f32_16x16x32_bf16 v[100:103], a[212:215], v[32:35], v[100:103]
  v_mfma_f32_16x16x32_bf16 v[112:115], a[216:219], v[32:35], v[112:115]
  v_mfma_f32_16x16x32_bf16 v[116:119], a[220:223], v[32:35], v[116:119]
  s_waitcnt lgkmcnt(5)
  v_mfma_f32_16x16x32_bf16 v[104:107], a[208:211], v[36:39], v[104:107]
  s_add_u32 s29, s29, 1
  ds_read_b128 v[28:31], v9 offset:0
  v_mfma_f32_16x16x32_bf16 v[108:111], a[212:215], v[36:39], v[108:111]
  v_mfma_f32_16x16x32_bf16 v[120:123], a[216:219], v[36:39], v[120:123]
  s_max_i32 s30, s29, 0
  v_mfma_f32_16x16x32_bf16 v[124:127], a[220:223], v[36:39], v[124:127]
  s_waitcnt lgkmcnt(5)
  v_mov_b32 v144, s30
  v_mfma_f32_16x16x32_bf16 v[96:99], a[224:227], v[40:43], v[96:99]
  ds_read_b128 v[32:35], v10 offset:0
  v_mfma_f32_16x16x32_bf16 v[100:103], a[228:231], v[40:43], v[100:103]
  v_mfma_f32_16x16x32_bf16 v[112:115], a[232:235], v[40:43], v[112:115]
  buffer_store_dword v144, v145, s[4:7], s31 offen sc1
  v_mfma_f32_16x16x32_bf16 v[116:119], a[236:239], v[40:43], v[116:119]
  s_waitcnt lgkmcnt(5)
  v_mfma_f32_16x16x32_bf16 v[104:107], a[224:227], v[44:47], v[104:107]
  ds_read_b128 v[36:39], v11 offset:0
  v_mfma_f32_16x16x32_bf16 v[108:111], a[228:231], v[44:47], v[108:111]
  v_mfma_f32_16x16x32_bf16 v[120:123], a[232:235], v[44:47], v[120:123]
  v_mfma_f32_16x16x32_bf16 v[124:127], a[236:239], v[44:47], v[124:127]
  s_waitcnt lgkmcnt(5)
  v_mfma_f32_16x16x32_bf16 v[96:99], a[240:243], v[48:51], v[96:99]
  s_sub_u32 s23, s23, 1
  ds_read_b128 v[40:43], v12 offset:0
  v_mfma_f32_16x16x32_bf16 v[100:103], a[244:247], v[48:51], v[100:103]
  v_mfma_f32_16x16x32_bf16 v[112:115], a[248:251], v[48:51], v[112:115]
  v_mfma_f32_16x16x32_bf16 v[116:119], a[252:255], v[48:51], v[116:119]
  s_waitcnt lgkmcnt(5)
  v_mfma_f32_16x16x32_bf16 v[104:107], a[240:243], v[52:55], v[104:107]
  s_cmp_eq_u32 s23, 0
  ds_read_b128 v[44:47], v13 offset:0
  v_mfma_f32_16x16x32_bf16 v[108:111], a[244:247], v[52:55], v[108:111]
  v_mfma_f32_16x16x32_bf16 v[120:123], a[248:251], v[52:55], v[120:123]
  v_mfma_f32_16x16x32_bf16 v[124:127], a[252:255], v[52:55], v[124:127]
  s_cbranch_scc1 G_done1_138
  s_branch G_top_136
G_done0_137:
  s_nop 7
  s_nop 3
  v_mul_f32 v64, s24, v64
  v_mul_f32 v65, s24, v65
  v_cvt_pk_bf16_f32 v128, v64, v65
  v_mul_f32 v66, s24, v66
  v_mul_f32 v67, s24, v67
  v_cvt_pk_bf16_f32 v129, v66, v67
  v_mul_f32 v68, s24, v68
  v_mul_f32 v69, s24, v69
  v_cvt_pk_bf16_f32 v130, v68, v69
  v_mul_f32 v70, s24, v70
  v_mul_f32 v71, s24, v71
  v_cvt_pk_bf16_f32 v131, v70, v71
  buffer_store_dwordx4 v[128:131], v7, s[4:7], s21 offen offset:0 sc1
  v_mul_f32 v72, s24, v72
  v_mul_f32 v73, s24, v73
  v_cvt_pk_bf16_f32 v132, v72, v73
  v_mul_f32 v74, s24, v74
  v_mul_f32 v75, s24, v75
  v_cvt_pk_bf16_f32 v133, v74, v75
  v_mul_f32 v76, s24, v76
  v_mul_f32 v77, s24, v77
  v_cvt_pk_bf16_f32 v134, v76, v77
  v_mul_f32 v78, s24, v78
  v_mul_f32 v79, s24, v79
  v_cvt_pk_bf16_f32 v135, v78, v79
  buffer_store_dwordx4 v[132:135], v7, s[4:7], s21 offen offset:256 sc1
  v_mul_f32 v80, s24, v80
  v_mul_f32 v81, s24, v81
  v_cvt_pk_bf16_f32 v136, v80, v81
  v_mul_f32 v82, s24, v82
  v_mul_f32 v83, s24, v83
  v_cvt_pk_bf16_f32 v137, v82, v83
  v_mul_f32 v84, s24, v84
  v_mul_f32 v85, s24, v85
  v_cvt_pk_bf16_f32 v138, v84, v85
  v_mul_f32 v86, s24, v86
  v_mul_f32 v87, s24, v87
  v_cvt_pk_bf16_f32 v139, v86, v87
  buffer_store_dwordx4 v[136:139], v7, s[4:7], s21 offen offset:2048 sc1
  v_mul_f32 v88, s24, v88
  v_mul_f32 v89, s24, v89
  v_cvt_pk_bf16_f32 v140, v88, v89
  v_mul_f32 v90, s24, v90
  v_mul_f32 v91, s24, v91
  v_cvt_pk_bf16_f32 v141, v90, v91
  v_mul_f32 v92, s24, v92
  v_mul_f32 v93, s24, v93
  v_cvt_pk_bf16_f32 v142, v92, v93
  v_mul_f32 v94, s24, v94
  v_mul_f32 v95, s24, v95
  v_cvt_pk_bf16_f32 v143, v94, v95
  buffer_store_dwordx4 v[140:143], v7, s[4:7], s21 offen offset:2304 sc1
  s_branch G_fin_139
G_done1_138:
  s_nop 7
  s_nop 3
  v_mul_f32 v96, s24, v96
  v_mul_f32 v97, s24, v97
  v_cvt_pk_bf16_f32 v128, v96, v97
  v_mul_f32 v98, s24, v98
  v_mul_f32 v99, s24, v99
  v_cvt_pk_bf16_f32 v129, v98, v99
  v_mul_f32 v100, s24, v100
  v_mul_f32 v101, s24, v101
  v_cvt_pk_bf16_f32 v130, v100, v101
  v_mul_f32 v102, s24, v102
  v_mul_f32 v103, s24, v103
  v_cvt_pk_bf16_f32 v131, v102, v103
  buffer_store_dwordx4 v[128:131], v7, s[4:7], s21 offen offset:0 sc1
  v_mul_f32 v104, s24, v104
  v_mul_f32 v105, s24, v105
  v_cvt_pk_bf16_f32 v132, v104, v105
  v_mul_f32 v106, s24, v106
  v_mul_f32 v107, s24, v107
  v_cvt_pk_bf16_f32 v133, v106, v107
  v_mul_f32 v108, s24, v108
  v_mul_f32 v109, s24, v109
  v_cvt_pk_bf16_f32 v134, v108, v109
  v_mul_f32 v110, s24, v110
  v_mul_f32 v111, s24, v111
  v_cvt_pk_bf16_f32 v135, v110, v111
  buffer_store_dwordx4 v[132:135], v7, s[4:7], s21 offen offset:256 sc1
  v_mul_f32 v112, s24, v112
  v_mul_f32 v113, s24, v113
  v_cvt_pk_bf16_f32 v136, v112, v113
  v_mul_f32 v114, s24, v114
  v_mul_f32 v115, s24, v115
  v_cvt_pk_bf16_f32 v137, v114, v115
  v_mul_f32 v116, s24, v116
  v_mul_f32 v117, s24, v117
  v_cvt_pk_bf16_f32 v138, v116, v117
  v_mul_f32 v118, s24, v118
  v_mul_f32 v119, s24, v119
  v_cvt_pk_bf16_f32 v139, v118, v119
  buffer_store_dwordx4 v[136:139], v7, s[4:7], s21 offen offset:2048 sc1
  v_mul_f32 v120, s24, v120
  v_mul_f32 v121, s24, v121
  v_cvt_pk_bf16_f32 v140, v120, v121
  v_mul_f32 v122, s24, v122
  v_mul_f32 v123, s24, v123
  v_cvt_pk_bf16_f32 v141, v122, v123
  v_mul_f32 v124, s24, v124
  v_mul_f32 v125, s24, v125
  v_cvt_pk_bf16_f32 v142, v124, v125
  v_mul_f32 v126, s24, v126
  v_mul_f32 v127, s24, v127
  v_cvt_pk_bf16_f32 v143, v126, v127
  buffer_store_dwordx4 v[140:143], v7, s[4:7], s21 offen offset:2304 sc1
G_fin_139:
  s_waitcnt vmcnt(0) lgkmcnt(0)
  s_barrier
  s_add_u32 s30, s29, 2
  v_mov_b32 v144, s30
  v_min_u32 v145, 1, v0
  v_lshlrev_b32 v145, 30, v145
  buffer_store_dword v144, v145, s[4:7], s31 offen sc1
  s_branch P_end_130
P_v_129:
  s_mov_b32 s27, s21
  v_mov_b32 v7, 0x40000000
  s_mov_b32 s29, -2
  v_min_u32 v145, 1, v0
  v_lshlrev_b32 v145, 30, v145
  ds_read_b128 v[24:27], v8 offset:0
  ds_read_b128 v[28:31], v9 offset:0
  ds_read_b128 v[32:35], v10 offset:0
  ds_read_b128 v[36:39], v11 offset:0
  ds_read_b128 v[40:43], v12 offset:0
  ds_read_b128 v[44:47], v13 offset:0
.p2align 6
G_top_140:
  s_waitcnt lgkmcnt(5)
  v_mfma_f32_16x16x32_bf16 v[64:67], v[24:27], a[0:3], 0
  s_add_u32 m0, s25, 0
  ds_read_b128 v[48:51], v14 offset:0
  v_mfma_f32_16x16x32_bf16 v[72:75], v[24:27], a[4:7], 0
  v_mfma_f32_16x16x32_bf16 v[80:83], v[24:27], a[8:11], 0
  buffer_load_dwordx4 v16, s[12:15], s19 offen lds
  v_mfma_f32_16x16x32_bf16 v[88:91], v[24:27], a[12:15], 0
  s_waitcnt lgkmcnt(5)
  v_mfma_f32_16x16x32_bf16 v[68:71], v[28:31], a[0:3], 0
  ds_read_b128 v[52:55], v15 offset:0
  v_mfma_f32_16x16x32_bf16 v[76:79], v[28:31], a[4:7], 0
  v_cvt_pk_bf16_f32 v128, v96, v97
  v_cvt_pk_bf16_f32 v129, v98, v99
  v_mfma_f32_16x16x32_bf16 v[84:87], v[28:31], a[8:11], 0
  v_mfma_f32_16x16x32_bf16 v[92:95], v[28:31], a[12:15], 0
  s_waitcnt lgkmcnt(5)
  v_cvt_pk_bf16_f32 v130, v100, v101
  v_cvt_pk_bf16_f32 v131, v102, v103
  v_mfma_f32_16x16x32_bf16 v[64:67], v[32:35], a[16:19], v[64:67]
  s_add_u32 m0, s25, 1024
  ds_read_b128 v[24:27], v8 offset:8192
  v_mfma_f32_16x16x32_bf16 v[72:75], v[32:35], a[20:23], v[72:75]
  v_mfma_f32_16x16x32_bf16 v[80:83], v[32:35], a[24:27], v[80:83]
  buffer_load_dwordx4 v17, s[12:15], s19 offen lds
  v_mfma_f32_16x16x32_bf16 v[88:91], v[32:35], a[28:31], v[88:91]
  s_waitcnt lgkmcnt(5)
  v_mfma_f32_16x16x32_bf16 v[68:71], v[36:39], a[16:19], v[68:71]
  ds_read_b128 v[28:31], v9 offset:8192
  v_mfma_f32_16x16x32_bf16 v[76:79], v[36:39], a[20:23], v[76:79]
  v_mfma_f32_16x16x32_bf16 v[84:87], v[36:39], a[24:27], v[84:87]
  v_mfma_f32_16x16x32_bf16 v[92:95], v[36:39], a[28:31], v[92:95]
  s_waitcnt lgkmcnt(5)
  v_mfma_f32_16x16x32_bf16 v[64:67], v[40:43], a[32:35], v[64:67]
  s_add_u32 m0, s25, 2048
  ds_read_b128 v[32:35], v10 offset:8192
  v_mfma_f32_16x16x32_bf16 v[72:75], v[40:43], a[36:39], v[72:75]
  v_cvt_pk_bf16_f32 v132, v104, v105
  v_cvt_pk_bf16_f32 v133, v106, v107
  v_mfma_f32_16x16x32_bf16 v[80:83], v[40:43], a[40:43], v[80:83]
  buffer_load_dwordx4 v18, s[12:15], s19 offen lds
  v_mfma_f32_16x16x32_bf16 v[88:91], v[40:43], a[44:47], v[88:91]
  s_waitcnt lgkmcnt(5)
  v_cvt_pk_bf16_f32 v134, v108, v109
  v_cvt_pk_bf16_f32 v135, v110, v111
  v_mfma_f32_16x16x32_bf16 v[68:71], v[44:47], a[32:35], v[68:71]
  ds_read_b128 v[36:39], v11 offset:8192
  v_mfma_f32_16x16x32_bf16 v[76:79], v[44:47], a[36:39], v[76:79]
  v_mfma_f32_16x16x32_bf16 v[84:87], v[44:47], a[40:43], v[84:87]
  v_mfma_f32_16x16x32_bf16 v[92:95], v[44:47], a[44:47], v[92:95]
  s_waitcnt lgkmcnt(5)
  v_mfma_f32_16x16x32_bf16 v[64:67], v[48:51], a[48:51], v[64:67]
  s_add_u32 m0, s25, 3072
  ds_read_b128 v[40:43], v12 offset:8192
  v_mfma_f32_16x16x32_bf16 v[72:75], v[48:51], a[52:55], v[72:75]
  v_mfma_f32_16x16x32_bf16 v[80:83], v[48:51], a[56:59], v[80:83]
  buffer_load_dwordx4 v19, s[12:15], s19 offen lds
  v_mfma_f32_16x16x32_bf16 v[88:91], v[48:51], a[60:63], v[88:91]
  s_waitcnt lgkmcnt(5)
  v_mfma_f32_16x16x32_bf16 v[68:71], v[52:55], a[48:51], v[68:71]
  ds_read_b128 v[44:47], v13 offset:8192
  v_mfma_f32_16x16x32_bf16 v[76:79], v[52:55], a[52:55], v[76:79]
  v_cvt_pk_bf16_f32 v136, v112, v113
  v_cvt_pk_bf16_f32 v137, v114, v115
  v_mfma_f32_16x16x32_bf16 v[84:87], v[52:55], a[56:59], v[84:87]
  v_mfma_f32_16x16x32_bf16 v[92:95], v[52:55], a[60:63], v[92:95]
  s_waitcnt lgkmcnt(5)
  v_cvt_pk_bf16_f32 v138, v116, v117
  v_cvt_pk_bf16_f32 v139, v118, v119
  v_mfma_f32_16x16x32_bf16 v[64:67], v[24:27], a[64:67], v[64:67]
  s_add_u32 m0, s25, 4096
  ds_read_b128 v[48:51], v14 offset:8192
  v_mfma_f32_16x16x32_bf16 v[72:75], v[24:27], a[68:71], v[72:75]
  v_mfma_f32_16x16x32_bf16 v[80:83], v[24:27], a[72:75], v[80:83]
  buffer_load_dwordx4 v20, s[12:15], s19 offen lds
  v_mfma_f32_16x16x32_bf16 v[88:91], v[24:27], a[76:79], v[88:91]
  s_waitcnt lgkmcnt(5)
  v_mfma_f32_16x16x32_bf16 v[68:71], v[28:31], a[64:67], v[68:71]
  ds_read_b128 v[52:55], v15 offset:8192
  v_mfma_f32_16x16x32_bf16 v[76:79], v[28:31], a[68:71], v[76:79]
  v_mfma_f32_16x16x32_bf16 v[84:87], v[28:31], a[72:75], v[84:87]
  v_mfma_f32_16x16x32_bf16 v[92:95], v[28:31], a[76:79], v[92:95]
  s_waitcnt lgkmcnt(5)
  v_mfma_f32_16x16x32_bf16 v[64:67], v[32:35], a[80:83], v[64:67]
  s_add_u32 m0, s25, 5120
  ds_read_b128 v[24:27], v8 offset:16384
  v_mfma_f32_16x16x32_bf16 v[72:75], v[32:35], a[84:87], v[72:75]
  v_cvt_pk_bf16_f32 v140, v120, v121
  v_cvt_pk_bf16_f32 v141, v122, v123
  v_mfma_f32_16x16x32_bf16 v[80:83], v[32:35], a[88:91], v[80:83]
  buffer_load_dwordx4 v21, s[12:15], s19 offen lds
  v_mfma_f32_16x16x32_bf16 v[88:91], v[32:35], a[92:95], v[88:91]
  s_waitcnt lgkmcnt(5)
  v_cvt_pk_bf16_f32 v142, v124, v125
  v_cvt_pk_bf16_f32 v143, v126, v127
  v_mfma_f32_16x16x32_bf16 v[68:71], v[36:39], a[80:83], v[68:71]
  ds_read_b128 v[28:31], v9 offset:16384
  v_mfma_f32_16x16x32_bf16 v[76:79], v[36:39], a[84:87], v[76:79]
  v_mfma_f32_16x16x32_bf16 v[84:87], v[36:39], a[88:91], v[84:87]
  v_mfma_f32_16x16x32_bf16 v[92:95], v[36:39], a[92:95], v[92:95]
  s_waitcnt lgkmcnt(5)
  v_mfma_f32_16x16x32_bf16 v[64:67], v[40:43], a[96:99], v[64:67]
  s_add_u32 m0, s25, 6144
  ds_read_b128 v[32:35], v10 offset:16384
  v_mfma_f32_16x16x32_bf16 v[72:75], v[40:43], a[100:103], v[72:75]
  v_mfma_f32_16x16x32_bf16 v[80:83], v[40:43], a[104:107], v[80:83]
  buffer_load_dwordx4 v22, s[12:15], s19 offen lds
  v_mfma_f32_16x16x32_bf16 v[88:91], v[40:43], a[108:111], v[88:91]
  s_waitcnt lgkmcnt(5)
  v_mfma_f32_16x16x32_bf16 v[68:71], v[44:47], a[96:99], v[68:71]
  ds_read_b128 v[36:39], v11 offset:16384
  v_mfma_f32_16x16x32_bf16 v[76:79], v[44:47], a[100:103], v[76:79]
  v_mfma_f32_16x16x32_bf16 v[84:87], v[44:47], a[104:107], v[84:87]
  v_mfma_f32_16x16x32_bf16 v[92:95], v[44:47], a[108:111], v[92:95]
  s_waitcnt lgkmcnt(5)
  v_mfma_f32_16x16x32_bf16 v[64:67], v[48:51], a[112:115], v[64:67]
  s_add_u32 m0, s25, 7168
  ds_read_b128 v[40:43], v12 offset:16384
  v_mfma_f32_16x16x32_bf16 v[72:75], v[48:51], a[116:119], v[72:75]
  v_mfma_f32_16x16x32_bf16 v[80:83], v[48:51], a[120:123], v[80:83]
  buffer_load_dwordx4 v23, s[12:15], s19 offen lds
  v_mfma_f32_16x16x32_bf16 v[88:91], v[48:51], a[124:127], v[88:91]
  s_waitcnt lgkmcnt(5)
  v_mfma_f32_16x16x32_bf16 v[68:71], v[52:55], a[112:115], v[68:71]
  s_cmp_gt_u32 s23, 3
  ds_read_b128 v[44:47], v13 offset:16384
  v_mfma_f32_16x16x32_bf16 v[76:79], v[52:55], a[116:119], v[76:79]
  v_mfma_f32_16x16x32_bf16 v[84:87], v[52:55], a[120:123], v[84:87]
  s_cselect_b32 s26, s20, 0
  v_mfma_f32_16x16x32_bf16 v[92:95], v[52:55], a[124:127], v[92:95]
  s_waitcnt lgkmcnt(5)
  v_mfma_f32_16x16x32_bf16 v[64:67], v[24:27], a[128:131], v[64:67]
  s_add_u32 s19, s19, s26
  ds_read_b128 v[48:51], v14 offset:16384
  v_mfma_f32_16x16x32_bf16 v[72:75], v[24:27], a[132:135], v[72:75]
  v_mfma_f32_16x16x32_bf16 v[80:83], v[24:27], a[136:139], v[80:83]
  s_add_u32 s25, s25, 32768
  v_mfma_f32_16x16x32_bf16 v[88:91], v[24:27], a[140:143], v[88:91]
  s_waitcnt lgkmcnt(5)
  v_mfma_f32_16x16x32_bf16 v[68:71], v[28:31], a[128:131], v[68:71]
  s_and_b32 s25, s25, 0x1ffff
  ds_read_b128 v[52:55], v15 offset:16384
  v_mfma_f32_16x16x32_bf16 v[76:79], v[28:31], a[132:135], v[76:79]
  v_mfma_f32_16x16x32_bf16 v[84:87], v[28:31], a[136:139], v[84:87]
  buffer_store_dwordx4 v[128:131], v7, s[4:7], s21 offen offset:0 sc1
  v_mfma_f32_16x16x32_bf16 v[92:95], v[28:31], a[140:143], v[92:95]
  s_waitcnt lgkmcnt(5)
  v_mfma_f32_16x16x32_bf16 v[64:67], v[32:35], a[144:147], v[64:67]
  ds_read_b128 v[24:27], v8 offset:24576
  v_mfma_f32_16x16x32_bf16 v[72:75], v[32:35], a[148:151], v[72:75]
  v_mfma_f32_16x16x32_bf16 v[80:83], v[32:35], a[152:155], v[80:83]
  v_mfma_f32_16x16x32_bf16 v[88:91], v[32:35], a[156:159], v[88:91]
  s_waitcnt lgkmcnt(5)
  v_mfma_f32_16x16x32_bf16 v[68:71], v[36:39], a[144:147], v[68:71]
  ds_read_b128 v[28:31], v9 offset:24576
  v_mfma_f32_16x16x32_bf16 v[76:79], v[36:39], a[148:151], v[76:79]
  v_mfma_f32_16x16x32_bf16 v[84:87], v[36:39], a[152:155], v[84:87]
  buffer_store_dwordx4 v[132:135], v7, s[4:7], s21 offen offset:256 sc1
  v_mfma_f32_16x16x32_bf16 v[92:95], v[36:39], a[156:159], v[92:95]
  s_waitcnt lgkmcnt(5)
  v_mfma_f32_16x16x32_bf16 v[64:67], v[40:43], a[160:163], v[64:67]
  ds_read_b128 v[32:35], v10 offset:24576
  v_mfma_f32_16x16x32_bf16 v[72:75], v[40:43], a[164:167], v[72:75]
  v_mfma_f32_16x16x32_bf16 v[80:83], v[40:43], a[168:171], v[80:83]
  v_mfma_f32_16x16x32_bf16 v[88:91], v[40:43], a[172:175], v[88:91]
  s_waitcnt lgkmcnt(5)
  v_mfma_f32_16x16x32_bf16 v[68:71], v[44:47], a[160:163], v[68:71]
  ds_read_b128 v[36:39], v11 offset:24576
  v_mfma_f32_16x16x32_bf16 v[76:79], v[44:47], a[164:167], v[76:79]
  v_mfma_f32_16x16x32_bf16 v[84:87], v[44:47], a[168:171], v[84:87]
  buffer_store_dwordx4 v[136:139], v7, s[4:7], s21 offen offset:2048 sc1
  v_mfma_f32_16x16x32_bf16 v[92:95], v[44:47], a[172:175], v[92:95]
  s_waitcnt lgkmcnt(5)
  v_mfma_f32_16x16x32_bf16 v[64:67], v[48:51], a[176:179], v[64:67]
  ds_read_b128 v[40:43], v12 offset:24576
  v_mfma_f32_16x16x32_bf16 v[72:75], v[48:51], a[180:183], v[72:75]
  v_mfma_f32_16x16x32_bf16 v[80:83], v[48:51], a[184:187], v[80:83]
  v_mfma_f32_16x16x32_bf16 v[88:91], v[48:51], a[188:191], v[88:91]
  s_waitcnt lgkmcnt(5)
  v_mfma_f32_16x16x32_bf16 v[68:71], v[52:55], a[176:179], v[68:71]
  ds_read_b128 v[44:47], v13 offset:24576
  v_mfma_f32_16x16x32_bf16 v[76:79], v[52:55], a[180:183], v[76:79]
  v_mfma_f32_16x16x32_bf16 v[84:87], v[52:55], a[184:187], v[84:87]
  buffer_store_dwordx4 v[140:143], v7, s[4:7], s21 offen offset:2304 sc1
  v_mfma_f32_16x16x32_bf16 v[92:95], v[52:55], a[188:191], v[92:95]
  s_waitcnt lgkmcnt(5)
  v_mfma_f32_16x16x32_bf16 v[64:67], v[24:27], a[192:195], v[64:67]
  s_mov_b32 s21, s27
  ds_read_b128 v[48:51], v14 offset:24576
  v_mfma_f32_16x16x32_bf16 v[72:75], v[24:27], a[196:199], v[72:75]
  v_mov_b32 v7, v56
  v_mfma_f32_16x16x32_bf16 v[80:83], v[24:27], a[200:203], v[80:83]
  v_mfma_f32_16x16x32_bf16 v[88:91], v[24:27], a[204:207], v[88:91]
  s_waitcnt lgkmcnt(5)
  v_mfma_f32_16x16x32_bf16 v[68:71], v[28:31], a[192:195], v[68:71]
  s_add_u32 s27, s27, s22
  ds_read_b128 v[52:55], v15 offset:24576
  v_mfma_f32_16x16x32_bf16 v[76:79], v[28:31], a[196:199], v[76:79]
  v_mfma_f32_16x16x32_bf16 v[84:87], v[28:31], a[200:203], v[84:87]
  s_waitcnt vmcnt(13)
  s_barrier
  v_mfma_f32_16x16x32_bf16 v[92:95], v[28:31], a[204:207], v[92:95]
  s_waitcnt lgkmcnt(5)
  v_mfma_f32_16x16x32_bf16 v[64:67], v[32:35], a[208:211], v[64:67]
  ds_read_b128 v[24:27], v8 offset:32768
  v_mfma_f32_16x16x32_bf16 v[72:75], v[32:35], a[212:215], v[72:75]
  v_mfma_f32_16x16x32_bf16 v[80:83], v[32:35], a[216:219], v[80:83]
  v_mfma_f32_16x16x32_bf16 v[88:91], v[32:35], a[220:223], v[88:91]
  s_waitcnt lgkmcnt(5)
  v_mfma_f32_16x16x32_bf16 v[68:71], v[36:39], a[208:211], v[68:71]
  s_add_u32 s29, s29, 1
  ds_read_b128 v[28:31], v9 offset:32768
  v_mfma_f32_16x16x32_bf16 v[76:79], v[36:39], a[212:215], v[76:79]
  v_mfma_f32_16x16x32_bf16 v[84:87], v[36:39], a[216:219], v[84:87]
  s_max_i32 s30, s29, 0
  v_mfma_f32_16x16x32_bf16 v[92:95], v[36:39], a[220:223], v[92:95]
  s_waitcnt lgkmcnt(5)
  v_mov_b32 v144, s30
  v_mfma_f32_16x16x32_bf16 v[64:67], v[40:43], a[224:227], v[64:67]
  ds_read_b128 v[32:35], v10 offset:32768
  v_mfma_f32_16x16x32_bf16 v[72:75], v[40:43], a[228:231], v[72:75]
  v_mfma_f32_16x16x32_bf16 v[80:83], v[40:43], a[232:235], v[80:83]
  buffer_store_dword v144, v145, s[4:7], s31 offen sc1
  v_mfma_f32_16x16x32_bf16 v[88:91], v[40:43], a[236:239], v[88:91]
  s_waitcnt lgkmcnt(5)
  v_mfma_f32_16x16x32_bf16 v[68:71], v[44:47], a[224:227], v[68:71]
  ds_read_b128 v[36:39], v11 offset:32768
  v_mfma_f32_16x16x32_bf16 v[76:79], v[44:47], a[228:231], v[76:79]
  v_mfma_f32_16x16x32_bf16 v[84:87], v[44:47], a[232:235], v[84:87]
  v_mfma_f32_16x16x32_bf16 v[92:95], v[44:47], a[236:239], v[92:95]
  s_waitcnt lgkmcnt(5)
  v_mfma_f32_16x16x32_bf16 v[64:67], v[48:51], a[240:243], v[64:67]
  s_sub_u32 s23, s23, 1
  ds_read_b128 v[40:43], v12 offset:32768
  v_mfma_f32_16x16x32_bf16 v[72:75], v[48:51], a[244:247], v[72:75]
  v_mfma_f32_16x16x32_bf16 v[80:83], v[48:51], a[248:251], v[80:83]
  v_mfma_f32_16x16x32_bf16 v[88:91], v[48:51], a[252:255], v[88:91]
  s_waitcnt lgkmcnt(5)
  v_mfma_f32_16x16x32_bf16 v[68:71], v[52:55], a[240:243], v[68:71]
  s_cmp_eq_u32 s23, 0
  ds_read_b128 v[44:47], v13 offset:32768
  v_mfma_f32_16x16x32_bf16 v[76:79], v[52:55], a[244:247], v[76:79]
  v_mfma_f32_16x16x32_bf16 v[84:87], v[52:55], a[248:251], v[84:87]
  v_mfma_f32_16x16x32_bf16 v[92:95], v[52:55], a[252:255], v[92:95]
  s_cbranch_scc1 G_done0_141
  s_waitcnt lgkmcnt(5)
  v_mfma_f32_16x16x32_bf16 v[96:99], v[24:27], a[0:3], 0
  s_add_u32 m0, s25, 0
  ds_read_b128 v[48:51], v14 offset:32768
  v_mfma_f32_16x16x32_bf16 v[104:107], v[24:27], a[4:7], 0
  v_mfma_f32_16x16x32_bf16 v[112:115], v[24:27], a[8:11], 0
  buffer_load_dwordx4 v16, s[12:15], s19 offen lds
  v_mfma_f32_16x16x32_bf16 v[120:123], v[24:27], a[12:15], 0
  s_waitcnt lgkmcnt(5)
  v_mfma_f32_16x16x32_bf16 v[100:103], v[28:31], a[0:3], 0
  ds_read_b128 v[52:55], v15 offset:32768
  v_mfma_f32_16x16x32_bf16 v[108:111], v[28:31], a[4:7], 0
  v_cvt_pk_bf16_f32 v128, v64, v65
  v_cvt_pk_bf16_f32 v129, v66, v67
  v_mfma_f32_16x16x32_bf16 v[116:119], v[28:31], a[8:11], 0
  v_mfma_f32_16x16x32_bf16 v[124:127], v[28:31], a[12:15], 0
  s_waitcnt lgkmcnt(5)
  v_cvt_pk_bf16_f32 v130, v68, v69
  v_cvt_pk_bf16_f32 v131, v70, v71
  v_mfma_f32_16x16x32_bf16 v[96:99], v[32:35], a[16:19], v[96:99]
  s_add_u32 m0, s25, 1024
  ds_read_b128 v[24:27], v8 offset:40960
  v_mfma_f32_16x16x32_bf16 v[104:107], v[32:35], a[20:23], v[104:107]
  v_mfma_f32_16x16x32_bf16 v[112:115], v[32:35], a[24:27], v[112:115]
  buffer_load_dwordx4 v17, s[12:15], s19 offen lds
  v_mfma_f32_16x16x32_bf16 v[120:123], v[32:35], a[28:31], v[120:123]
  s_waitcnt lgkmcnt(5)
  v_mfma_f32_16x16x32_bf16 v[100:103], v[36:39], a[16:19], v[100:103]
  ds_read_b128 v[28:31], v9 offset:40960
  v_mfma_f32_16x16x32_bf16 v[108:111], v[36:39], a[20:23], v[108:111]
  v_mfma_f32_16x16x32_bf16 v[116:119], v[36:39], a[24:27], v[116:119]
  v_mfma_f32_16x16x32_bf16 v[124:127], v[36:39], a[28:31], v[124:127]
  s_waitcnt lgkmcnt(5)
  v_mfma_f32_16x16x32_bf16 v[96:99], v[40:43], a[32:35], v[96:99]
  s_add_u32 m0, s25, 2048
  ds_read_b128 v[32:35], v10 offset:40960
  v_mfma_f32_16x16x32_bf16 v[104:107], v[40:43], a[36:39], v[104:107]
  v_cvt_pk_bf16_f32 v132, v72, v73
  v_cvt_pk_bf16_f32 v133, v74, v75
  v_mfma_f32_16x16x32_bf16 v[112:115], v[40:43], a[40:43], v[112:115]
  buffer_load_dwordx4 v18, s[12:15], s19 offen lds
  v_mfma_f32_16x16x32_bf16 v[120:123], v[40:43], a[44:47], v[120:123]
  s_waitcnt lgkmcnt(5)
  v_cvt_pk_bf16_f32 v134, v76, v77
  v_cvt_pk_bf16_f32 v135, v78, v79
  v_mfma_f32_16x16x32_bf16 v[100:103], v[44:47], a[32:35], v[100:103]
  ds_read_b128 v[36:39], v11 offset:40960
  v_mfma_f32_16x16x32_bf16 v[108:111], v[44:47], a[36:39], v[108:111]
  v_mfma_f32_16x16x32_bf16 v[116:119], v[44:47], a[40:43], v[116:119]
  v_mfma_f32_16x16x32_bf16 v[124:127], v[44:47], a[44:47], v[124:127]
  s_waitcnt lgkmcnt(5)
  v_mfma_f32_16x16x32_bf16 v[96:99], v[48:51], a[48:51], v[96:99]
  s_add_u32 m0, s25, 3072
  ds_read_b128 v[40:43], v12 offset:40960
  v_mfma_f32_16x16x32_bf16 v[104:107], v[48:51], a[52:55], v[104:107]
  v_mfma_f32_16x16x32_bf16 v[112:115], v[48:51], a[56:59], v[112:115]
  buffer_load_dwordx4 v19, s[12:15], s19 offen lds
  v_mfma_f32_16x16x32_bf16 v[120:123], v[48:51], a[60:63], v[120:123]
  s_waitcnt lgkmcnt(5)
  v_mfma_f32_16x16x32_bf16 v[100:103], v[52:55], a[48:51], v[100:103]
  ds_read_b128 v[44:47], v13 offset:40960
  v_mfma_f32_16x16x32_bf16 v[108:111], v[52:55], a[52:55], v[108:111]
  v_cvt_pk_bf16_f32 v136, v80, v81
  v_cvt_pk_bf16_f32 v137, v82, v83
  v_mfma_f32_16x16x32_bf16 v[116:119], v[52:55], a[56:59], v[116:119]
  v_mfma_f32_16x16x32_bf16 v[124:127], v[52:55], a[60:63], v[124:127]
  s_waitcnt lgkmcnt(5)
  v_cvt_pk_bf16_f32 v138, v84, v85
  v_cvt_pk_bf16_f32 v139, v86, v87
  v_mfma_f32_16x16x32_bf16 v[96:99], v[24:27], a[64:67], v[96:99]
  s_add_u32 m0, s25, 4096
  ds_read_b128 v[48:51], v14 offset:40960
  v_mfma_f32_16x16x32_bf16 v[104:107], v[24:27], a[68:71], v[104:107]
  v_mfma_f32_16x16x32_bf16 v[112:115], v[24:27], a[72:75], v[112:115]
  buffer_load_dwordx4 v20, s[12:15], s19 offen lds
  v_mfma_f32_16x16x32_bf16 v[120:123], v[24:27], a[76:79], v[120:123]
  s_waitcnt lgkmcnt(5)
  v_mfma_f32_16x16x32_bf16 v[100:103], v[28:31], a[64:67], v[100:103]
  ds_read_b128 v[52:55], v15 offset:40960
  v_mfma_f32_16x16x32_bf16 v[108:111], v[28:31], a[68:71], v[108:111]
  v_mfma_f32_16x16x32_bf16 v[116:119], v[28:31], a[72:75], v[116:119]
  v_mfma_f32_16x16x32_bf16 v[124:127], v[28:31], a[76:79], v[124:127]
  s_waitcnt lgkmcnt(5)
  v_mfma_f32_16x16x32_bf16 v[96:99], v[32:35], a[80:83], v[96:99]
  s_add_u32 m0, s25, 5120
  ds_read_b128 v[24:27], v8 offset:49152
  v_mfma_f32_16x16x32_bf16 v[104:107], v[32:35], a[84:87], v[104:107]
  v_cvt_pk_bf16_f32 v140, v88, v89
  v_cvt_pk_bf16_f32 v141, v90, v91
  v_mfma_f32_16x16x32_bf16 v[112:115], v[32:35], a[88:91], v[112:115]
  buffer_load_dwordx4 v21, s[12:15], s19 offen lds
  v_mfma_f32_16x16x32_bf16 v[120:123], v[32:35], a[92:95], v[120:123]
  s_waitcnt lgkmcnt(5)
  v_cvt_pk_bf16_f32 v142, v92, v93
  v_cvt_pk_bf16_f32 v143, v94, v95
  v_mfma_f32_16x16x32_bf16 v[100:103], v[36:39], a[80:83], v[100:103]
  ds_read_b128 v[28:31], v9 offset:49152
  v_mfma_f32_16x16x32_bf16 v[108:111], v[36:39], a[84:87], v[108:111]
  v_mfma_f32_16x16x32_bf16 v[116:119], v[36:39], a[88:91], v[116:119]
  v_mfma_f32_16x16x32_bf16 v[124:127], v[36:39], a[92:95], v[124:127]
  s_waitcnt lgkmcnt(5)
  v_mfma_f32_16x16x32_bf16 v[96:99], v[40:43], a[96:99], v[96:99]
  s_add_u32 m0, s25, 6144
  ds_read_b128 v[32:35], v10 offset:49152
  v_mfma_f32_16x16x32_bf16 v[104:107], v[40:43], a[100:103], v[104:107]
  v_mfma_f32_16x16x32_bf16 v[112:115], v[40:43], a[104:107], v[112:115]
  buffer_load_dwordx4 v22, s[12:15], s19 offen lds
  v_mfma_f32_16x16x32_bf16 v[120:123], v[40:43], a[108:111], v[120:123]
  s_waitcnt lgkmcnt(5)
  v_mfma_f32_16x16x32_bf16 v[100:103], v[44:47], a[96:99], v[100:103]
  ds_read_b128 v[36:39], v11 offset:49152
  v_mfma_f32_16x16x32_bf16 v[108:111], v[44:47], a[100:103], v[108:111]
  v_mfma_f32_16x16x32_bf16 v[116:119], v[44:47], a[104:107], v[116:119]
  v_mfma_f32_16x16x32_bf16 v[124:127], v[44:47], a[108:111], v[124:127]
  s_waitcnt lgkmcnt(5)
  v_mfma_f32_16x16x32_bf16 v[96:99], v[48:51], a[112:115], v[96:99]
  s_add_u32 m0, s25, 7168
  ds_read_b128 v[40:43], v12 offset:49152
  v_mfma_f32_16x16x32_bf16 v[104:107], v[48:51], a[116:119], v[104:107]
  v_mfma_f32_16x16x32_bf16 v[112:115], v[48:51], a[120:123], v[112:115]
  buffer_load_dwordx4 v23, s[12:15], s19 offen lds
  v_mfma_f32_16x16x32_bf16 v[120:123], v[48:51], a[124:127], v[120:123]
  s_waitcnt lgkmcnt(5)
  v_mfma_f32_16x16x32_bf16 v[100:103], v[52:55], a[112:115], v[100:103]
  s_cmp_gt_u32 s23, 3
  ds_read_b128 v[44:47], v13 offset:49152
  v_mfma_f32_16x16x32_bf16 v[108:111], v[52:55], a[116:119], v[108:111]
  v_mfma_f32_16x16x32_bf16 v[116:119], v[52:55], a[120:123], v[116:119]
  s_cselect_b32 s26, s20, 0
  v_mfma_f32_16x16x32_bf16 v[124:127], v[52:55], a[124:127], v[124:127]
  s_waitcnt lgkmcnt(5)
  v_mfma_f32_16x16x32_bf16 v[96:99], v[24:27], a[128:131], v[96:99]
  s_add_u32 s19, s19, s26
  ds_read_b128 v[48:51], v14 offset:49152
  v_mfma_f32_16x16x32_bf16 v[104:107], v[24:27], a[132:135], v[104:107]
  v_mfma_f32_16x16x32_bf16 v[112:115], v[24:27], a[136:139], v[112:115]
  s_add_u32 s25, s25, 32768
  v_mfma_f32_16x16x32_bf16 v[120:123], v[24:27], a[140:143], v[120:123]
  s_waitcnt lgkmcnt(5)
  v_mfma_f32_16x16x32_bf16 v[100:103], v[28:31], a[128:131], v[100:103]
  s_and_b32 s25, s25, 0x1ffff
  ds_read_b128 v[52:55], v15 offset:49152
  v_mfma_f32_16x16x32_bf16 v[108:111], v[28:31], a[132:135], v[108:111]
  v_mfma_f32_16x16x32_bf16 v[116:119], v[28:31], a[136:139], v[116:119]
  buffer_store_dwordx4 v[128:131], v7, s[4:7], s21 offen offset:0 sc1
  v_mfma_f32_16x16x32_bf16 v[124:127], v[28:31], a[140:143], v[124:127]
  s_waitcnt lgkmcnt(5)
  v_mfma_f32_16x16x32_bf16 v[96:99], v[32:35], a[144:147], v[96:99]
  ds_read_b128 v[24:27], v8 offset:57344
  v_mfma_f32_16x16x32_bf16 v[104:107], v[32:35], a[148:151], v[104:107]
  v_mfma_f32_16x16x32_bf16 v[112:115], v[32:35], a[152:155], v[112:115]
  v_mfma_f32_16x16x32_bf16 v[120:123], v[32:35], a[156:159], v[120:123]
  s_waitcnt lgkmcnt(5)
  v_xor_b32 v8, 0x10000, v8
  v_mfma_f32_16x16x32_bf16 v[100:103], v[36:39], a[144:147], v[100:103]
  ds_read_b128 v[28:31], v9 offset:57344
  v_mfma_f32_16x16x32_bf16 v[108:111], v[36:39], a[148:151], v[108:111]
  v_mfma_f32_16x16x32_bf16 v[116:119], v[36:39], a[152:155], v[116:119]
  buffer_store_dwordx4 v[132:135], v7, s[4:7], s21 offen offset:256 sc1
  v_mfma_f32_16x16x32_bf16 v[124:127], v[36:39], a[156:159], v[124:127]
  s_waitcnt lgkmcnt(5)
  v_xor_b32 v9, 0x10000, v9
  v_mfma_f32_16x16x32_bf16 v[96:99], v[40:43], a[160:163], v[96:99]
  ds_read_b128 v[32:35], v10 offset:57344
  v_mfma_f32_16x16x32_bf16 v[104:107], v[40:43], a[164:167], v[104:107]
  v_mfma_f32_16x16x32_bf16 v[112:115], v[40:43], a[168:171], v[112:115]
  v_mfma_f32_16x16x32_bf16 v[120:123], v[40:43], a[172:175], v[120:123]
  s_waitcnt lgkmcnt(5)
  v_xor_b32 v10, 0x10000, v10
  v_mfma_f32_16x16x32_bf16 v[100:103], v[44:47], a[160:163], v[100:103]
  ds_read_b128 v[36:39], v11 offset:57344
  v_mfma_f32_16x16x32_bf16 v[108:111], v[44:47], a[164:167], v[108:111]
  v_mfma_f32_16x16x32_bf16 v[116:119], v[44:47], a[168:171], v[116:119]
  buffer_store_dwordx4 v[136:139], v7, s[4:7], s21 offen offset:2048 sc1
  v_mfma_f32_16x16x32_bf16 v[124:127], v[44:47], a[172:175], v[124:127]
  s_waitcnt lgkmcnt(5)
  v_xor_b32 v11, 0x10000, v11
  v_mfma_f32_16x16x32_bf16 v[96:99], v[48:51], a[176:179], v[96:99]
  ds_read_b128 v[40:43], v12 offset:57344
  v_mfma_f32_16x16x32_bf16 v[104:107], v[48:51], a[180:183], v[104:107]
  v_mfma_f32_16x16x32_bf16 v[112:115], v[48:51], a[184:187], v[112:115]
  v_mfma_f32_16x16x32_bf16 v[120:123], v[48:51], a[188:191], v[120:123]
  s_waitcnt lgkmcnt(5)
  v_xor_b32 v12, 0x10000, v12
  v_mfma_f32_16x16x32_bf16 v[100:103], v[52:55], a[176:179], v[100:103]
  ds_read_b128 v[44:47], v13 offset:57344
  v_mfma_f32_16x16x32_bf16 v[108:111], v[52:55], a[180:183], v[108:111]
  v_mfma_f32_16x16x32_bf16 v[116:119], v[52:55], a[184:187], v[116:119]
  buffer_store_dwordx4 v[140:143], v7, s[4:7], s21 offen offset:2304 sc1
  v_mfma_f32_16x16x32_bf16 v[124:127], v[52:55], a[188:191], v[124:127]
  s_waitcnt lgkmcnt(5)
  v_xor_b32 v13, 0x10000, v13
  v_mfma_f32_16x16x32_bf16 v[96:99], v[24:27], a[192:195], v[96:99]
  s_mov_b32 s21, s27
  ds_read_b128 v[48:51], v14 offset:57344
  v_mfma_f32_16x16x32_bf16 v[104:107], v[24:27], a[196:199], v[104:107]
  v_mov_b32 v7, v56
  v_mfma_f32_16x16x32_bf16 v[112:115], v[24:27], a[200:203], v[112:115]
  v_mfma_f32_16x16x32_bf16 v[120:123], v[24:27], a[204:207], v[120:123]
  s_waitcnt lgkmcnt(5)
  v_xor_b32 v14, 0x10000, v14
  v_mfma_f32_16x16x32_bf16 v[100:103], v[28:31], a[192:195], v[100:103]
  s_add_u32 s27, s27, s22
  ds_read_b128 v[52:55], v15 offset:57344
  v_mfma_f32_16x16x32_bf16 v[108:111], v[28:31], a[196:199], v[108:111]
  v_mfma_f32_16x16x32_bf16 v[116:119], v[28:31], a[200:203], v[116:119]
  s_waitcnt vmcnt(13)
  s_barrier
  v_mfma_f32_16x16x32_bf16 v[124:127], v[28:31], a[204:207], v[124:127]
  s_waitcnt lgkmcnt(5)
  v_xor_b32 v15, 0x10000, v15
  v_mfma_f32_16x16x32_bf16 v[96:99], v[32:35], a[208:211], v[96:99]
  ds_read_b128 v[24:27], v8 offset:0
  v_mfma_f32_16x16x32_bf16 v[104:107], v[32:35], a[212:215], v[104:107]
  v_mfma_f32_16x16x32_bf16 v[112:115], v[32:35], a[216:219], v[112:115]
  v_mfma_f32_16x16x32_bf16 v[120:123], v[32:35], a[220:223], v[120:123]
  s_waitcnt lgkmcnt(5)
  v_mfma_f32_16x16x32_bf16 v[100:103], v[36:39], a[208:211], v[100:103]
  s_add_u32 s29, s29, 1
  ds_read_b128 v[28:31], v9 offset:0
  v_mfma_f32_16x16x32_bf16 v[108:111], v[36:39], a[212:215], v[108:111]
  v_mfma_f32_16x16x32_bf16 v[116:119], v[36:39], a[216:219], v[116:119]
  s_max_i32 s30, s29, 0
  v_mfma_f32_16x16x32_bf16 v[124:127], v[36:39], a[220:223], v[124:127]
  s_waitcnt lgkmcnt(5)
  v_mov_b32 v144, s30
  v_mfma_f32_16x16x32_bf16 v[96:99], v[40:43], a[224:227], v[96:99]
  ds_read_b128 v[32:35], v10 offset:0
  v_mfma_f32_16x16x32_bf16 v[104:107], v[40:43], a[228:231], v[104:107]
  v_mfma_f32_16x16x32_bf16 v[112:115], v[40:43], a[232:235], v[112:115]
  buffer_store_dword v144, v145, s[4:7], s31 offen sc1
  v_mfma_f32_16x16x32_bf16 v[120:123], v[40:43], a[236:239], v[120:123]
  s_waitcnt lgkmcnt(5)
  v_mfma_f32_16x16x32_bf16 v[100:103], v[44:47], a[224:227], v[100:103]
  ds_read_b128 v[36:39], v11 offset:0
  v_mfma_f32_16x16x32_bf16 v[108:111], v[44:47], a[228:231], v[108:111]
  v_mfma_f32_16x16x32_bf16 v[116:119], v[44:47], a[232:235], v[116:119]
  v_mfma_f32_16x16x32_bf16 v[124:127], v[44:47], a[236:239], v[124:127]
  s_waitcnt lgkmcnt(5)
  v_mfma_f32_16x16x32_bf16 v[96:99], v[48:51], a[240:243], v[96:99]
  s_sub_u32 s23, s23, 1
  ds_read_b128 v[40:43], v12 offset:0
  v_mfma_f32_16x16x32_bf16 v[104:107], v[48:51], a[244:247], v[104:107]
  v_mfma_f32_16x16x32_bf16 v[112:115], v[48:51], a[248:251], v[112:115]
  v_mfma_f32_16x16x32_bf16 v[120:123], v[48:51], a[252:255], v[120:123]
  s_waitcnt lgkmcnt(5)
  v_mfma_f32_16x16x32_bf16 v[100:103], v[52:55], a[240:243], v[100:103]
  s_cmp_eq_u32 s23, 0
  ds_read_b128 v[44:47], v13 offset:0
  v_mfma_f32_16x16x32_bf16 v[108:111], v[52:55], a[244:247], v[108:111]
  v_mfma_f32_16x16x32_bf16 v[116:119], v[52:55], a[248:251], v[116:119]
  v_mfma_f32_16x16x32_bf16 v[124:127], v[52:55], a[252:255], v[124:127]
  s_cbranch_scc1 G_done1_142
  s_branch G_top_140
G_done0_141:
  s_nop 7
  s_nop 3
  v_cvt_pk_bf16_f32 v128, v64, v65
  v_cvt_pk_bf16_f32 v129, v66, v67
  v_cvt_pk_bf16_f32 v130, v68, v69
  v_cvt_pk_bf16_f32 v131, v70, v71
  buffer_store_dwordx4 v[128:131], v7, s[4:7], s21 offen offset:0 sc1
  v_cvt_pk_bf16_f32 v132, v72, v73
  v_cvt_pk_bf16_f32 v133, v74, v75
  v_cvt_pk_bf16_f32 v134, v76, v77
  v_cvt_pk_bf16_f32 v135, v78, v79
  buffer_store_dwordx4 v[132:135], v7, s[4:7], s21 offen offset:256 sc1
  v_cvt_pk_bf16_f32 v136, v80, v81
  v_cvt_pk_bf16_f32 v137, v82, v83
  v_cvt_pk_bf16_f32 v138, v84, v85
  v_cvt_pk_bf16_f32 v139, v86, v87
  buffer_store_dwordx4 v[136:139], v7, s[4:7], s21 offen offset:2048 sc1
  v_cvt_pk_bf16_f32 v140, v88, v89
  v_cvt_pk_bf16_f32 v141, v90, v91
  v_cvt_pk_bf16_f32 v142, v92, v93
  v_cvt_pk_bf16_f32 v143, v94, v95
  buffer_store_dwordx4 v[140:143], v7, s[4:7], s21 offen offset:2304 sc1
  s_branch G_fin_143
G_done1_142:
  s_nop 7
  s_nop 3
  v_cvt_pk_bf16_f32 v128, v96, v97
  v_cvt_pk_bf16_f32 v129, v98, v99
  v_cvt_pk_bf16_f32 v130, v100, v101
  v_cvt_pk_bf16_f32 v131, v102, v103
  buffer_store_dwordx4 v[128:131], v7, s[4:7], s21 offen offset:0 sc1
  v_cvt_pk_bf16_f32 v132, v104, v105
  v_cvt_pk_bf16_f32 v133, v106, v107
  v_cvt_pk_bf16_f32 v134, v108, v109
  v_cvt_pk_bf16_f32 v135, v110, v111
  buffer_store_dwordx4 v[132:135], v7, s[4:7], s21 offen offset:256 sc1
  v_cvt_pk_bf16_f32 v136, v112, v113
  v_cvt_pk_bf16_f32 v137, v114, v115
  v_cvt_pk_bf16_f32 v138, v116, v117
  v_cvt_pk_bf16_f32 v139, v118, v119
  buffer_store_dwordx4 v[136:139], v7, s[4:7], s21 offen offset:2048 sc1
  v_cvt_pk_bf16_f32 v140, v120, v121
  v_cvt_pk_bf16_f32 v141, v122, v123
  v_cvt_pk_bf16_f32 v142, v124, v125
  v_cvt_pk_bf16_f32 v143, v126, v127
  buffer_store_dwordx4 v[140:143], v7, s[4:7], s21 offen offset:2304 sc1
G_fin_143:
  s_waitcnt vmcnt(0) lgkmcnt(0)
  s_barrier
  s_add_u32 s30, s29, 2
  v_mov_b32 v144, s30
  v_min_u32 v145, 1, v0
  v_lshlrev_b32 v145, 30, v145
  buffer_store_dword v144, v145, s[4:7], s31 offen sc1
P_end_130:
  s_mov_b32 s71, 0
  s_branch M_sg_145
M_sw_144:
  s_sleep 8
  s_add_u32 s71, s71, 1
  s_cmp_gt_u32 s71, 262144
  s_cbranch_scc1 M_exit
M_sg_145:
  s_mov_b32 s79, 0
  s_atomic_or s79, s[74:75], 128 glc
  s_waitcnt lgkmcnt(0)
  s_cmp_lt_u32 s79, 256
  s_cbranch_scc1 M_sw_144
  s_cmp_eq_u32 s65, 6
  s_cbranch_scc1 M_follow
  s_mov_b32 s68, 0
  s_mov_b32 s36, -1
  s_mov_b32 s69, s53
  s_mov_b32 s70, s54
  s_load_dwordx2 s[8:9], s[0:1], 40
  s_mul_i32 s76, s64, 6
  s_add_u32 s76, s76, s65
  s_mul_i32 s76, s76, 21888
  v_min_u32 v200, 170, v0
  v_mul_u32_u24 v200, 128, v200
  v_add_u32 v200, s76, v200
  s_waitcnt lgkmcnt(0)
  s_and_b32 s9, s9, 0xffff
  s_mov_b32 s10, 4194304
  s_mov_b32 s11, 0x20000
M_att:
  s_mov_b32 s24, 0xf149f2ca
  s_mov_b32 s29, 0
  v_mov_b32 v6, 0
  v_mov_b32 v7, 0
  s_lshl_b32 s26, s16, 11
  v_add_u32 v3, s26, v2
  v_and_b32 v5, 31, v1
  v_lshrrev_b32 v12, 5, v1
  v_lshlrev_b32 v12, 2, v12
  v_sub_u32 v5, v5, v12
  s_lshl_b32 s26, s64, 19
  s_add_u32 s19, s26, 16777216
  s_add_u32 s20, s26, 33554432
  s_lshl_b32 s27, s69, 2
  s_add_u32 s27, s27, s16
  s_lshl_b32 s27, s27, 14
  s_add_u32 s25, s26, s27
  s_bfe_u32 s78, s70, 0x80000
  s_add_u32 s76, s67, 512
  s_mov_b32 s71, 0
  s_branch M_sg_147
M_sw_146:
  s_sleep 8
  s_add_u32 s71, s71, 1
  s_cmp_gt_u32 s71, 262144
  s_cbranch_scc1 M_exit
M_sg_147:
  s_mov_b32 s79, 0
  s_atomic_or s79, s[72:73], s76 glc
  s_waitcnt lgkmcnt(0)
  s_cmp_lt_u32 s79, s78
  s_cbranch_scc1 M_sw_146
  s_bfe_u32 s78, s70, 0x80008
  s_add_u32 s76, s67, 640
  s_mov_b32 s71, 0
  s_branch M_sg_149
M_sw_148:
  s_sleep 8
  s_add_u32 s71, s71, 1
  s_cmp_gt_u32 s71, 262144
  s_cbranch_scc1 M_exit
M_sg_149:
  s_mov_b32 s79, 0
  s_atomic_or s79, s[72:73], s76 glc
  s_waitcnt lgkmcnt(0)
  s_cmp_lt_u32 s79, s78
  s_cbranch_scc1 M_sw_148
  s_lshl_b32 s27, s69, 16
  s_add_u32 s27, s27, 16384
  s_add_u32 s17, s19, s27
M_kv_150:
  s_cmp_ge_u32 s17, s36
  s_cbranch_scc1 M_kvok_151
  s_mov_b32 s76, 0
  s_mov_b32 s78, 23
  s_mov_b32 s77, 335872
  s_cmp_eq_u32 s68, 1
  s_cmov_b32 s76, 128
  s_cmov_b32 s78, 27
  s_cmov_b32 s77, 114688
  s_cmp_eq_u32 s68, 2
  s_cmov_b32 s76, 768
  s_cmov_b32 s78, 14
  s_cmov_b32 s77, 0
  s_add_u32 s76, s76, s67
  s_mov_b32 s71, 0
  s_branch M_sg_153
M_sw_152:
  s_sleep 8
  s_add_u32 s71, s71, 1
  s_cmp_gt_u32 s71, 262144
  s_cbranch_scc1 M_exit
M_sg_153:
  s_mov_b32 s79, 0
  s_atomic_or s79, s[72:73], s76 glc
  s_waitcnt lgkmcnt(0)
  s_cmp_lt_u32 s79, s78
  s_cbranch_scc1 M_sw_152
  s_add_u32 s36, s77, s19
  s_add_u32 s68, s68, 1
  s_branch M_kv_150
M_kvok_151:
  s_add_u32 s28, s25, 0
  buffer_load_dwordx4 a[128:131], v2, s[4:7], s28 offen offset:0 sc1
  buffer_load_dwordx4 a[132:135], v2, s[4:7], s28 offen offset:1024 sc1
  buffer_load_dwordx4 a[136:139], v2, s[4:7], s28 offen offset:2048 sc1
  buffer_load_dwordx4 a[140:143], v2, s[4:7], s28 offen offset:3072 sc1
  s_add_u32 s28, s25, 4096
  buffer_load_dwordx4 a[144:147], v2, s[4:7], s28 offen offset:0 sc1
  buffer_load_dwordx4 a[148:151], v2, s[4:7], s28 offen offset:1024 sc1
  buffer_load_dwordx4 a[152:155], v2, s[4:7], s28 offen offset:2048 sc1
  buffer_load_dwordx4 a[156:159], v2, s[4:7], s28 offen offset:3072 sc1
  s_add_u32 s28, s25, 8192
  buffer_load_dwordx4 a[160:163], v2, s[4:7], s28 offen offset:0 sc1
  buffer_load_dwordx4 a[164:167], v2, s[4:7], s28 offen offset:1024 sc1
  buffer_load_dwordx4 a[168:171], v2, s[4:7], s28 offen offset:2048 sc1
  buffer_load_dwordx4 a[172:175], v2, s[4:7], s28 offen offset:3072 sc1
  s_add_u32 s28, s25, 12288
  buffer_load_dwordx4 a[176:179], v2, s[4:7], s28 offen offset:0 sc1
  buffer_load_dwordx4 a[180:183], v2, s[4:7], s28 offen offset:1024 sc1
  buffer_load_dwordx4 a[184:187], v2, s[4:7], s28 offen offset:2048 sc1
  buffer_load_dwordx4 a[188:191], v2, s[4:7], s28 offen offset:3072 sc1
A_again_154:
  s_lshl_b32 s27, s69, 16
  s_add_u32 s27, s27, 57344
  s_add_u32 s17, s19, s27
  s_add_u32 s18, s20, s27
  s_lshl_b32 s21, s16, 11
  s_mov_b32 m0, s21
  s_nop 0
  buffer_load_dwordx4 v3, s[4:7], s18 offen offset:0 sc1 lds
  buffer_load_dwordx4 v3, s[4:7], s18 offen offset:1024 sc1 lds
  s_add_u32 m0, s21, 8192
  s_nop 0
  buffer_load_dwordx4 v3, s[4:7], s17 offen offset:0 sc1 lds
  buffer_load_dwordx4 v3, s[4:7], s17 offen offset:1024 sc1 lds
  s_add_u32 s18, s18, 8192
  s_sub_u32 s18, s18, 8192
  s_max_i32 s18, s18, s20
  s_sub_u32 s17, s17, 8192
  s_max_i32 s17, s17, s19
  s_add_u32 s21, s21, 16384
  s_and_b32 s21, s21, 131071
  s_mov_b32 m0, s21
  s_nop 0
  buffer_load_dwordx4 v3, s[4:7], s18 offen offset:0 sc1 lds
  buffer_load_dwordx4 v3, s[4:7], s18 offen offset:1024 sc1 lds
  s_add_u32 m0, s21, 8192
  s_nop 0
  buffer_load_dwordx4 v3, s[4:7], s17 offen offset:0 sc1 lds
  buffer_load_dwordx4 v3, s[4:7], s17 offen offset:1024 sc1 lds
  s_sub_u32 s18, s18, 8192
  s_max_i32 s18, s18, s20
  s_sub_u32 s17, s17, 8192
  s_max_i32 s17, s17, s19
  s_add_u32 s21, s21, 16384
  s_and_b32 s21, s21, 131071
  s_mov_b32 m0, s21
  s_nop 0
  buffer_load_dwordx4 v3, s[4:7], s18 offen offset:0 sc1 lds
  buffer_load_dwordx4 v3, s[4:7], s18 offen offset:1024 sc1 lds
  s_add_u32 m0, s21, 8192
  s_nop 0
  buffer_load_dwordx4 v3, s[4:7], s17 offen offset:0 sc1 lds
  buffer_load_dwordx4 v3, s[4:7], s17 offen offset:1024 sc1 lds
  s_sub_u32 s18, s18, 8192
  s_max_i32 s18, s18, s20
  s_sub_u32 s17, s17, 8192
  s_max_i32 s17, s17, s19
  s_add_u32 s21, s21, 16384
  s_and_b32 s21, s21, 131071
  s_mov_b32 m0, s21
  s_nop 0
  buffer_load_dwordx4 v3, s[4:7], s18 offen offset:0 sc1 lds
  buffer_load_dwordx4 v3, s[4:7], s18 offen offset:1024 sc1 lds
  s_add_u32 m0, s21, 8192
  s_nop 0
  buffer_load_dwordx4 v3, s[4:7], s17 offen offset:0 sc1 lds
  buffer_load_dwordx4 v3, s[4:7], s17 offen offset:1024 sc1 lds
  s_sub_u32 s18, s18, 8192
  s_max_i32 s18, s18, s20
  s_sub_u32 s17, s17, 8192
  s_max_i32 s17, s17, s19
  s_add_u32 s21, s21, 16384
  s_and_b32 s21, s21, 131071
  s_mov_b32 m0, s21
  s_nop 0
  buffer_load_dwordx4 v3, s[4:7], s18 offen offset:0 sc1 lds
  buffer_load_dwordx4 v3, s[4:7], s18 offen offset:1024 sc1 lds
  s_add_u32 m0, s21, 8192
  s_nop 0
  buffer_load_dwordx4 v3, s[4:7], s17 offen offset:0 sc1 lds
  buffer_load_dwordx4 v3, s[4:7], s17 offen offset:1024 sc1 lds
  s_sub_u32 s18, s18, 8192
  s_max_i32 s18, s18, s20
  s_sub_u32 s17, s17, 8192
  s_max_i32 s17, s17, s19
  s_add_u32 s21, s21, 16384
  s_and_b32 s21, s21, 131071
  s_mov_b32 m0, s21
  s_nop 0
  buffer_load_dwordx4 v3, s[4:7], s18 offen offset:0 sc1 lds
  buffer_load_dwordx4 v3, s[4:7], s18 offen offset:1024 sc1 lds
  s_add_u32 m0, s21, 8192
  s_nop 0
  buffer_load_dwordx4 v3, s[4:7], s17 offen offset:0 sc1 lds
  buffer_load_dwordx4 v3, s[4:7], s17 offen offset:1024 sc1 lds
  v_accvgpr_write_b32 a0, 0
  v_accvgpr_write_b32 a1, 0
  v_accvgpr_write_b32 a2, 0
  v_accvgpr_write_b32 a3, 0
  v_accvgpr_write_b32 a4, 0
  v_accvgpr_write_b32 a5, 0
  v_accvgpr_write_b32 a6, 0
  v_accvgpr_write_b32 a7, 0
  v_accvgpr_write_b32 a8, 0
  v_accvgpr_write_b32 a9, 0
  v_accvgpr_write_b32 a10, 0
  v_accvgpr_write_b32 a11, 0
  v_accvgpr_write_b32 a12, 0
  v_accvgpr_write_b32 a13, 0
  v_accvgpr_write_b32 a14, 0
  v_accvgpr_write_b32 a15, 0
  v_accvgpr_write_b32 a16, 0
  v_accvgpr_write_b32 a17, 0
  v_accvgpr_write_b32 a18, 0
  v_accvgpr_write_b32 a19, 0
  v_accvgpr_write_b32 a20, 0
  v_accvgpr_write_b32 a21, 0
  v_accvgpr_write_b32 a22, 0
  v_accvgpr_write_b32 a23, 0
  v_accvgpr_write_b32 a24, 0
  v_accvgpr_write_b32 a25, 0
  v_accvgpr_write_b32 a26, 0
  v_accvgpr_write_b32 a27, 0
  v_accvgpr_write_b32 a28, 0
  v_accvgpr_write_b32 a29, 0
  v_accvgpr_write_b32 a30, 0
  v_accvgpr_write_b32 a31, 0
  v_accvgpr_write_b32 a32, 0
  v_accvgpr_write_b32 a33, 0
  v_accvgpr_write_b32 a34, 0
  v_accvgpr_write_b32 a35, 0
  v_accvgpr_write_b32 a36, 0
  v_accvgpr_write_b32 a37, 0
  v_accvgpr_write_b32 a38, 0
  v_accvgpr_write_b32 a39, 0
  v_accvgpr_write_b32 a40, 0
  v_accvgpr_write_b32 a41, 0
  v_accvgpr_write_b32 a42, 0
  v_accvgpr_write_b32 a43, 0
  v_accvgpr_write_b32 a44, 0
  v_accvgpr_write_b32 a45, 0
  v_accvgpr_write_b32 a46, 0
  v_accvgpr_write_b32 a47, 0
  v_accvgpr_write_b32 a48, 0
  v_accvgpr_write_b32 a49, 0
  v_accvgpr_write_b32 a50, 0
  v_accvgpr_write_b32 a51, 0
  v_accvgpr_write_b32 a52, 0
  v_accvgpr_write_b32 a53, 0
  v_accvgpr_write_b32 a54, 0
  v_accvgpr_write_b32 a55, 0
  v_accvgpr_write_b32 a56, 0
  v_accvgpr_write_b32 a57, 0
  v_accvgpr_write_b32 a58, 0
  v_accvgpr_write_b32 a59, 0
  v_accvgpr_write_b32 a60, 0
  v_accvgpr_write_b32 a61, 0
  v_accvgpr_write_b32 a62, 0
  v_accvgpr_write_b32 a63, 0
  v_accvgpr_write_b32 a64, 0
  v_accvgpr_write_b32 a65, 0
  v_accvgpr_write_b32 a66, 0
  v_accvgpr_write_b32 a67, 0
  v_accvgpr_write_b32 a68, 0
  v_accvgpr_write_b32 a69, 0
  v_accvgpr_write_b32 a70, 0
  v_accvgpr_write_b32 a71, 0
  v_accvgpr_write_b32 a72, 0
  v_accvgpr_write_b32 a73, 0
  v_accvgpr_write_b32 a74, 0
  v_accvgpr_write_b32 a75, 0
  v_accvgpr_write_b32 a76, 0
  v_accvgpr_write_b32 a77, 0
  v_accvgpr_write_b32 a78, 0
  v_accvgpr_write_b32 a79, 0
  v_accvgpr_write_b32 a80, 0
  v_accvgpr_write_b32 a81, 0
  v_accvgpr_write_b32 a82, 0
  v_accvgpr_write_b32 a83, 0
  v_accvgpr_write_b32 a84, 0
  v_accvgpr_write_b32 a85, 0
  v_accvgpr_write_b32 a86, 0
  v_accvgpr_write_b32 a87, 0
  v_accvgpr_write_b32 a88, 0
  v_accvgpr_write_b32 a89, 0
  v_accvgpr_write_b32 a90, 0
  v_accvgpr_write_b32 a91, 0
  v_accvgpr_write_b32 a92, 0
  v_accvgpr_write_b32 a93, 0
  v_accvgpr_write_b32 a94, 0
  v_accvgpr_write_b32 a95, 0
  v_accvgpr_write_b32 a96, 0
  v_accvgpr_write_b32 a97, 0
  v_accvgpr_write_b32 a98, 0
  v_accvgpr_write_b32 a99, 0
  v_accvgpr_write_b32 a100, 0
  v_accvgpr_write_b32 a101, 0
  v_accvgpr_write_b32 a102, 0
  v_accvgpr_write_b32 a103, 0
  v_accvgpr_write_b32 a104, 0
  v_accvgpr_write_b32 a105, 0
  v_accvgpr_write_b32 a106, 0
  v_accvgpr_write_b32 a107, 0
  v_accvgpr_write_b32 a108, 0
  v_accvgpr_write_b32 a109, 0
  v_accvgpr_write_b32 a110, 0
  v_accvgpr_write_b32 a111, 0
  v_accvgpr_write_b32 a112, 0
  v_accvgpr_write_b32 a113, 0
  v_accvgpr_write_b32 a114, 0
  v_accvgpr_write_b32 a115, 0
  v_accvgpr_write_b32 a116, 0
  v_accvgpr_write_b32 a117, 0
  v_accvgpr_write_b32 a118, 0
  v_accvgpr_write_b32 a119, 0
  v_accvgpr_write_b32 a120, 0
  v_accvgpr_write_b32 a121, 0
  v_accvgpr_write_b32 a122, 0
  v_accvgpr_write_b32 a123, 0
  v_accvgpr_write_b32 a124, 0
  v_accvgpr_write_b32 a125, 0
  v_accvgpr_write_b32 a126, 0
  v_accvgpr_write_b32 a127, 0
  v_mov_b32 v8, 0
  v_mov_b32 v9, 0
  v_mov_b32 v10, 0
  v_mov_b32 v11, 0
  v_mov_b32 v52, 0
  v_mov_b32 v53, 0
  v_mov_b32 v54, s24
  v_mov_b32 v55, s24
  v_mov_b32 v56, s24
  v_mov_b32 v57, s24
  v_mov_b32 v58, s24
  v_mov_b32 v59, s24
  v_mov_b32 v60, s24
  v_mov_b32 v61, s24
  v_mov_b32 v62, s24
  v_mov_b32 v63, s24
  v_mov_b32 v104, 0
  v_mov_b32 v105, 0
  v_mov_b32 v4, v2
  v_mov_b32 v64, s24
  v_mov_b32 v65, s24
  v_mov_b32 v66, s24
  v_mov_b32 v67, s24
  v_mov_b32 v68, s24
  v_mov_b32 v69, s24
  v_mov_b32 v70, s24
  v_mov_b32 v71, s24
  v_mov_b32 v72, s24
  v_mov_b32 v73, s24
  v_mov_b32 v74, s24
  v_mov_b32 v75, s24
  v_mov_b32 v76, s24
  v_mov_b32 v77, s24
  v_mov_b32 v78, s24
  v_mov_b32 v79, s24
  v_mov_b32 v12, s24
  v_cmp_le_i32 s[40:41], 0, v5
  v_cmp_le_i32 s[42:43], 1, v5
  v_cmp_le_i32 s[44:45], 2, v5
  v_cmp_le_i32 s[46:47], 3, v5
  v_cndmask_b32 v80, v12, v7, s[40:41]
  v_cndmask_b32 v81, v12, v7, s[42:43]
  v_cndmask_b32 v82, v12, v7, s[44:45]
  v_cndmask_b32 v83, v12, v7, s[46:47]
  v_cmp_le_i32 s[40:41], 8, v5
  v_cmp_le_i32 s[42:43], 9, v5
  v_cmp_le_i32 s[44:45], 10, v5
  v_cmp_le_i32 s[46:47], 11, v5
  v_cndmask_b32 v84, v12, v7, s[40:41]
  v_cndmask_b32 v85, v12, v7, s[42:43]
  v_cndmask_b32 v86, v12, v7, s[44:45]
  v_cndmask_b32 v87, v12, v7, s[46:47]
  v_cmp_le_i32 s[40:41], 16, v5
  v_cmp_le_i32 s[42:43], 17, v5
  v_cmp_le_i32 s[44:45], 18, v5
  v_cmp_le_i32 s[46:47], 19, v5
  v_cndmask_b32 v88, v12, v7, s[40:41]
  v_cndmask_b32 v89, v12, v7, s[42:43]
  v_cndmask_b32 v90, v12, v7, s[44:45]
  v_cndmask_b32 v91, v12, v7, s[46:47]
  v_cmp_le_i32 s[40:41], 24, v5
  v_cmp_le_i32 s[42:43], 25, v5
  v_cmp_le_i32 s[44:45], 26, v5
  v_cmp_le_i32 s[46:47], 27, v5
  v_cndmask_b32 v92, v12, v7, s[40:41]
  v_cndmask_b32 v93, v12, v7, s[42:43]
  v_cndmask_b32 v94, v12, v7, s[44:45]
  v_cndmask_b32 v95, v12, v7, s[46:47]
  s_lshl_b32 s22, s69, 3
  s_add_u32 s22, s22, 8
  s_lshl_b32 s26, s16, 1
  s_sub_u32 s23, 6, s26
  s_waitcnt vmcnt(20)
  s_barrier
  s_cmp_eq_u32 s23, 0
  s_cbranch_scc1 A_go_156
A_idle_155:
  s_waitcnt vmcnt(16)
  s_barrier
  s_sub_u32 s18, s18, 8192
  s_max_i32 s18, s18, s20
  s_sub_u32 s17, s17, 8192
  s_max_i32 s17, s17, s19
  s_add_u32 s21, s21, 16384
  s_and_b32 s21, s21, 131071
M_kv_157:
  s_cmp_ge_u32 s17, s36
  s_cbranch_scc1 M_kvok_158
  s_mov_b32 s76, 0
  s_mov_b32 s78, 23
  s_mov_b32 s77, 335872
  s_cmp_eq_u32 s68, 1
  s_cmov_b32 s76, 128
  s_cmov_b32 s78, 27
  s_cmov_b32 s77, 114688
  s_cmp_eq_u32 s68, 2
  s_cmov_b32 s76, 768
  s_cmov_b32 s78, 14
  s_cmov_b32 s77, 0
  s_add_u32 s76, s76, s67
  s_mov_b32 s71, 0
  s_branch M_sg_160
M_sw_159:
  s_sleep 8
  s_add_u32 s71, s71, 1
  s_cmp_gt_u32 s71, 262144
  s_cbranch_scc1 M_exit
M_sg_160:
  s_mov_b32 s79, 0
  s_atomic_or s79, s[72:73], s76 glc
  s_waitcnt lgkmcnt(0)
  s_cmp_lt_u32 s79, s78
  s_cbranch_scc1 M_sw_159
  s_add_u32 s36, s77, s19
  s_add_u32 s68, s68, 1
  s_branch M_kv_157
M_kvok_158:
  s_mov_b32 m0, s21
  s_nop 0
  buffer_load_dwordx4 v3, s[4:7], s18 offen offset:0 sc1 lds
  buffer_load_dwordx4 v3, s[4:7], s18 offen offset:1024 sc1 lds
  s_add_u32 m0, s21, 8192
  s_nop 0
  buffer_load_dwordx4 v3, s[4:7], s17 offen offset:0 sc1 lds
  buffer_load_dwordx4 v3, s[4:7], s17 offen offset:1024 sc1 lds
  v_add_u32 v4, 16384, v4
  v_and_b32 v4, 131071, v4
  s_sub_u32 s22, s22, 1
  s_sub_u32 s23, s23, 1
  s_cmp_lg_u32 s23, 0
  s_cbranch_scc1 A_idle_155
A_go_156:
  ds_read_b128 a[224:227], v4 offset:0
  ds_read_b128 a[228:231], v4 offset:2048
  ds_read_b128 a[232:235], v4 offset:4096
  ds_read_b128 a[236:239], v4 offset:6144
  ds_read_b128 a[240:243], v4 offset:1024
  ds_read_b128 a[244:247], v4 offset:3072
  ds_read_b128 a[248:251], v4 offset:5120
  ds_read_b128 a[252:255], v4 offset:7168
  ds_read_b128 a[192:195], v4 offset:8192
  ds_read_b128 a[196:199], v4 offset:9216
  ds_read_b128 a[200:203], v4 offset:10240
  ds_read_b128 a[204:207], v4 offset:11264
  ds_read_b128 a[208:211], v4 offset:12288
  ds_read_b128 a[212:215], v4 offset:13312
  ds_read_b128 a[216:219], v4 offset:14336
  ds_read_b128 a[220:223], v4 offset:15360
  v_add_u32 v4, 16384, v4
  v_and_b32 v4, 131071, v4
  s_waitcnt lgkmcnt(8)
.p2align 6
A_top_161:
  s_waitcnt lgkmcnt(7)
  v_mfma_f32_32x32x16_bf16 v[32:47], a[192:195], a[128:131], v[64:79]
  s_waitcnt lgkmcnt(6)
  v_exp_f32 v54, v54
  v_add_f32 v11, v11, v53
  v_cvt_pk_bf16_f32 v106, v52, v53
  v_mfma_f32_32x32x16_bf16 v[32:47], a[196:199], a[132:135], v[32:47]
  s_waitcnt lgkmcnt(4)
  v_exp_f32 v55, v55
  v_add_f32 v10, v10, v54
  v_mfma_f32_32x32x16_bf16 v[32:47], a[200:203], a[136:139], v[32:47]
  v_exp_f32 v56, v56
  v_add_f32 v11, v11, v55
  v_cvt_pk_bf16_f32 v107, v54, v55
  v_mfma_f32_32x32x16_bf16 v[32:47], a[204:207], a[140:143], v[32:47]
  s_waitcnt lgkmcnt(2)
  v_exp_f32 v57, v57
  v_add_f32 v10, v10, v56
  v_mfma_f32_32x32x16_bf16 v[32:47], a[208:211], a[144:147], v[32:47]
  v_exp_f32 v58, v58
  v_add_f32 v11, v11, v57
  v_cvt_pk_bf16_f32 v108, v56, v57
  v_mfma_f32_32x32x16_bf16 v[32:47], a[212:215], a[148:151], v[32:47]
  s_waitcnt lgkmcnt(0)
  v_exp_f32 v59, v59
  v_add_f32 v10, v10, v58
  v_mfma_f32_32x32x16_bf16 v[32:47], a[216:219], a[152:155], v[32:47]
  v_exp_f32 v60, v60
  v_add_f32 v11, v11, v59
  v_cvt_pk_bf16_f32 v109, v58, v59
  v_mfma_f32_32x32x16_bf16 v[32:47], a[220:223], a[156:159], v[32:47]
  s_waitcnt vmcnt(16)
  s_barrier
  v_exp_f32 v61, v61
  v_add_f32 v10, v10, v60
  v_mfma_f32_32x32x16_bf16 a[64:79], a[224:227], v[104:107], a[64:79]
  ds_read_b128 a[224:227], v4 offset:0
  v_exp_f32 v62, v62
  v_add_f32 v11, v11, v61
  v_cvt_pk_bf16_f32 v110, v60, v61
  v_mfma_f32_32x32x16_bf16 a[80:95], a[228:231], v[104:107], a[80:95]
  s_sub_u32 s18, s18, 8192
  ds_read_b128 a[228:231], v4 offset:2048
  v_exp_f32 v63, v63
  v_add_f32 v10, v10, v62
  v_mfma_f32_32x32x16_bf16 a[96:111], a[232:235], v[104:107], a[96:111]
  s_max_i32 s18, s18, s20
  ds_read_b128 a[232:235], v4 offset:4096
  v_exp_f32 v32, v32
  v_add_f32 v11, v11, v63
  v_cvt_pk_bf16_f32 v111, v62, v63
  v_mfma_f32_32x32x16_bf16 a[112:127], a[236:239], v[104:107], a[112:127]
  s_sub_u32 s17, s17, 8192
  ds_read_b128 a[236:239], v4 offset:6144
  v_exp_f32 v33, v33
  v_add_f32 v8, v8, v32
  v_mfma_f32_32x32x16_bf16 a[64:79], a[240:243], v[108:111], a[64:79]
  s_max_i32 s17, s17, s19
  ds_read_b128 a[240:243], v4 offset:1024
  v_exp_f32 v34, v34
  v_add_f32 v9, v9, v33
  v_cvt_pk_bf16_f32 v96, v32, v33
  v_mfma_f32_32x32x16_bf16 a[80:95], a[244:247], v[108:111], a[80:95]
  s_add_u32 s21, s21, 16384
  ds_read_b128 a[244:247], v4 offset:3072
  v_exp_f32 v35, v35
  v_add_f32 v8, v8, v34
  v_mfma_f32_32x32x16_bf16 a[96:111], a[248:251], v[108:111], a[96:111]
  s_and_b32 s21, s21, 131071
  ds_read_b128 a[248:251], v4 offset:5120
  v_exp_f32 v36, v36
  v_add_f32 v9, v9, v35
  v_cvt_pk_bf16_f32 v97, v34, v35
  v_mfma_f32_32x32x16_bf16 a[112:127], a[252:255], v[108:111], a[112:127]
  ds_read_b128 a[252:255], v4 offset:7168
  v_exp_f32 v37, v37
  v_add_f32 v8, v8, v36
  v_mfma_f32_32x32x16_bf16 v[48:63], a[192:195], a[160:163], v[80:95]
  s_add_u32 s23, s23, 1
  ds_read_b128 a[192:195], v4 offset:8192
  v_exp_f32 v38, v38
  v_add_f32 v9, v9, v37
  v_cvt_pk_bf16_f32 v98, v36, v37
  v_mfma_f32_32x32x16_bf16 v[48:63], a[196:199], a[164:167], v[48:63]
  s_sub_u32 s22, s22, 1
  ds_read_b128 a[196:199], v4 offset:9216
  v_exp_f32 v39, v39
  v_add_f32 v8, v8, v38
  v_mfma_f32_32x32x16_bf16 v[48:63], a[200:203], a[168:171], v[48:63]
  s_cmp_lt_u32 s23, 3
  ds_read_b128 a[200:203], v4 offset:10240
  v_exp_f32 v40, v40
  v_add_f32 v9, v9, v39
  v_cvt_pk_bf16_f32 v99, v38, v39
  v_mfma_f32_32x32x16_bf16 v[48:63], a[204:207], a[172:175], v[48:63]
  s_cbranch_scc1 A_upd_162
A_back_163:
  ds_read_b128 a[204:207], v4 offset:11264
  v_exp_f32 v41, v41
  v_add_f32 v8, v8, v40
  v_mfma_f32_32x32x16_bf16 v[48:63], a[208:211], a[176:179], v[48:63]
  s_cmp_lt_u32 s17, s36
  ds_read_b128 a[208:211], v4 offset:12288
  v_exp_f32 v42, v42
  v_add_f32 v9, v9, v41
  v_cvt_pk_bf16_f32 v100, v40, v41
  v_mfma_f32_32x32x16_bf16 v[48:63], a[212:215], a[180:183], v[48:63]
  s_cbranch_scc1 A_kvw_165
A_kvb_166:
  ds_read_b128 a[212:215], v4 offset:13312
  v_exp_f32 v43, v43
  v_add_f32 v8, v8, v42
  v_mfma_f32_32x32x16_bf16 v[48:63], a[216:219], a[184:187], v[48:63]
  s_mov_b32 m0, s21
  ds_read_b128 a[216:219], v4 offset:14336
  v_exp_f32 v44, v44
  v_add_f32 v9, v9, v43
  v_cvt_pk_bf16_f32 v101, v42, v43
  v_mfma_f32_32x32x16_bf16 v[48:63], a[220:223], a[188:191], v[48:63]
  s_waitcnt lgkmcnt(13)
  ds_read_b128 a[220:223], v4 offset:15360
  v_exp_f32 v45, v45
  v_add_f32 v8, v8, v44
  v_mfma_f32_32x32x16_bf16 a[0:15], a[224:227], v[96:99], a[0:15]
  buffer_load_dwordx4 v3, s[4:7], s18 offen offset:0 sc1 lds
  v_exp_f32 v46, v46
  v_add_f32 v9, v9, v45
  v_cvt_pk_bf16_f32 v102, v44, v45
  v_mfma_f32_32x32x16_bf16 a[16:31], a[228:231], v[96:99], a[16:31]
  s_waitcnt lgkmcnt(12)
  v_exp_f32 v47, v47
  v_add_f32 v8, v8, v46
  v_add_u32 v4, 16384, v4
  v_mfma_f32_32x32x16_bf16 a[32:47], a[232:235], v[96:99], a[32:47]
  buffer_load_dwordx4 v3, s[4:7], s18 offen offset:1024 sc1 lds
  v_exp_f32 v48, v48
  v_add_f32 v9, v9, v47
  v_cvt_pk_bf16_f32 v103, v46, v47
  v_mfma_f32_32x32x16_bf16 a[48:63], a[236:239], v[96:99], a[48:63]
  s_waitcnt lgkmcnt(10)
  s_add_u32 m0, s21, 8192
  v_exp_f32 v49, v49
  v_add_f32 v10, v10, v48
  v_and_b32 v4, 131071, v4
  v_mfma_f32_32x32x16_bf16 a[0:15], a[240:243], v[100:103], a[0:15]
  buffer_load_dwordx4 v3, s[4:7], s17 offen offset:0 sc1 lds
  v_exp_f32 v50, v50
  v_add_f32 v11, v11, v49
  v_cvt_pk_bf16_f32 v104, v48, v49
  v_mfma_f32_32x32x16_bf16 a[16:31], a[244:247], v[100:103], a[16:31]
  s_waitcnt lgkmcnt(8)
  s_cmp_lg_u32 s22, 0
  v_exp_f32 v51, v51
  v_add_f32 v10, v10, v50
  v_mfma_f32_32x32x16_bf16 a[32:47], a[248:251], v[100:103], a[32:47]
  buffer_load_dwordx4 v3, s[4:7], s17 offen offset:1024 sc1 lds
  v_exp_f32 v52, v52
  v_add_f32 v11, v11, v51
  v_cvt_pk_bf16_f32 v105, v50, v51
  v_mfma_f32_32x32x16_bf16 a[48:63], a[252:255], v[100:103], a[48:63]
  v_exp_f32 v53, v53
  v_add_f32 v10, v10, v52
  s_cbranch_scc1 A_top_161
  v_exp_f32 v54, v54
  v_add_f32 v11, v11, v53
  v_cvt_pk_bf16_f32 v106, v52, v53
  v_exp_f32 v55, v55
  v_add_f32 v10, v10, v54
  v_exp_f32 v56, v56
  v_add_f32 v11, v11, v55
  v_cvt_pk_bf16_f32 v107, v54, v55
  v_exp_f32 v57, v57
  v_add_f32 v10, v10, v56
  v_exp_f32 v58, v58
  v_add_f32 v11, v11, v57
  v_cvt_pk_bf16_f32 v108, v56, v57
  v_exp_f32 v59, v59
  v_add_f32 v10, v10, v58
  v_exp_f32 v60, v60
  v_add_f32 v11, v11, v59
  v_cvt_pk_bf16_f32 v109, v58, v59
  v_exp_f32 v61, v61
  v_add_f32 v10, v10, v60
  v_exp_f32 v62, v62
  v_add_f32 v11, v11, v61
  v_cvt_pk_bf16_f32 v110, v60, v61
  v_exp_f32 v63, v63
  v_add_f32 v10, v10, v62
  v_add_f32 v11, v11, v63
  v_cvt_pk_bf16_f32 v111, v62, v63
  s_nop 1
  v_mfma_f32_32x32x16_bf16 a[64:79], a[224:227], v[104:107], a[64:79]
  v_mfma_f32_32x32x16_bf16 a[80:95], a[228:231], v[104:107], a[80:95]
  v_mfma_f32_32x32x16_bf16 a[96:111], a[232:235], v[104:107], a[96:111]
  v_mfma_f32_32x32x16_bf16 a[112:127], a[236:239], v[104:107], a[112:127]
  v_mfma_f32_32x32x16_bf16 a[64:79], a[240:243], v[108:111], a[64:79]
  v_mfma_f32_32x32x16_bf16 a[80:95], a[244:247], v[108:111], a[80:95]
  v_mfma_f32_32x32x16_bf16 a[96:111], a[248:251], v[108:111], a[96:111]
  v_mfma_f32_32x32x16_bf16 a[112:127], a[252:255], v[108:111], a[112:127]
  v_add_f32 v8, v8, v9
  v_mov_b32 v9, v8
  s_nop 1
  v_permlane32_swap_b32 v8, v9
  s_nop 1
  v_add_f32 v8, v8, v9
  v_add_f32 v10, v10, v11
  v_mov_b32 v11, v10
  s_nop 1
  v_permlane32_swap_b32 v10, v11
  s_nop 1
  v_add_f32 v10, v10, v11
  v_subrev_u32 v12, 0x2f800000, v8
  v_subrev_u32 v13, 0x2f800000, v10
  v_max_u32 v12, v12, v13
  v_cmp_le_u32 vcc, 0x28000000, v12
  s_nop 1
  s_cmp_lg_u64 vcc, 0
  s_cselect_b32 s26, 1, 0
  v_mov_b32 v12, s26
  s_lshl_b32 s26, s16, 2
  s_add_u32 s26, s26, 131072
  v_mov_b32 v13, s26
  ds_write_b32 v13, v12
  v_mov_b32 v14, 131072
  s_waitcnt vmcnt(0) lgkmcnt(0)
  s_barrier
  ds_read_b128 v[16:19], v14
  v_rcp_f32 v8, v8
  v_rcp_f32 v10, v10
  s_waitcnt lgkmcnt(0)
  v_or3_b32 v12, v16, v17, v18
  v_or_b32 v12, v12, v19
  s_nop 0
  v_readfirstlane_b32 s26, v12
  s_nop 1
  s_cmp_gt_u32 s26, s29
  s_cbranch_scc1 A_slow_167
  s_add_u32 s28, s25, 100663296
  v_accvgpr_read_b32 v112, a0
  v_accvgpr_read_b32 v113, a1
  v_accvgpr_read_b32 v114, a2
  v_accvgpr_read_b32 v115, a3
  v_accvgpr_read_b32 v116, a4
  v_accvgpr_read_b32 v117, a5
  v_accvgpr_read_b32 v118, a6
  v_accvgpr_read_b32 v119, a7
  v_pk_mul_f32 v[112:113], v[112:113], v[8:9] op_sel_hi:[1,0]
  v_pk_mul_f32 v[114:115], v[114:115], v[8:9] op_sel_hi:[1,0]
  v_pk_mul_f32 v[116:117], v[116:117], v[8:9] op_sel_hi:[1,0]
  v_pk_mul_f32 v[118:119], v[118:119], v[8:9] op_sel_hi:[1,0]
  v_cvt_pk_bf16_f32 v120, v112, v113
  v_cvt_pk_bf16_f32 v121, v114, v115
  v_cvt_pk_bf16_f32 v122, v116, v117
  v_cvt_pk_bf16_f32 v123, v118, v119
  buffer_store_dwordx4 v[120:123], v2, s[4:7], s28 offen offset:0 sc1
  v_accvgpr_read_b32 v124, a8
  v_accvgpr_read_b32 v125, a9
  v_accvgpr_read_b32 v126, a10
  v_accvgpr_read_b32 v127, a11
  v_accvgpr_read_b32 v128, a12
  v_accvgpr_read_b32 v129, a13
  v_accvgpr_read_b32 v130, a14
  v_accvgpr_read_b32 v131, a15
  v_pk_mul_f32 v[124:125], v[124:125], v[8:9] op_sel_hi:[1,0]
  v_pk_mul_f32 v[126:127], v[126:127], v[8:9] op_sel_hi:[1,0]
  v_pk_mul_f32 v[128:129], v[128:129], v[8:9] op_sel_hi:[1,0]
  v_pk_mul_f32 v[130:131], v[130:131], v[8:9] op_sel_hi:[1,0]
  v_cvt_pk_bf16_f32 v132, v124, v125
  v_cvt_pk_bf16_f32 v133, v126, v127
  v_cvt_pk_bf16_f32 v134, v128, v129
  v_cvt_pk_bf16_f32 v135, v130, v131
  buffer_store_dwordx4 v[132:135], v2, s[4:7], s28 offen offset:1024 sc1
  v_accvgpr_read_b32 v136, a16
  v_accvgpr_read_b32 v137, a17
  v_accvgpr_read_b32 v138, a18
  v_accvgpr_read_b32 v139, a19
  v_accvgpr_read_b32 v140, a20
  v_accvgpr_read_b32 v141, a21
  v_accvgpr_read_b32 v142, a22
  v_accvgpr_read_b32 v143, a23
  v_pk_mul_f32 v[136:137], v[136:137], v[8:9] op_sel_hi:[1,0]
  v_pk_mul_f32 v[138:139], v[138:139], v[8:9] op_sel_hi:[1,0]
  v_pk_mul_f32 v[140:141], v[140:141], v[8:9] op_sel_hi:[1,0]
  v_pk_mul_f32 v[142:143], v[142:143], v[8:9] op_sel_hi:[1,0]
  v_cvt_pk_bf16_f32 v144, v136, v137
  v_cvt_pk_bf16_f32 v145, v138, v139
  v_cvt_pk_bf16_f32 v146, v140, v141
  v_cvt_pk_bf16_f32 v147, v142, v143
  buffer_store_dwordx4 v[144:147], v2, s[4:7], s28 offen offset:2048 sc1
  v_accvgpr_read_b32 v148, a24
  v_accvgpr_read_b32 v149, a25
  v_accvgpr_read_b32 v150, a26
  v_accvgpr_read_b32 v151, a27
  v_accvgpr_read_b32 v152, a28
  v_accvgpr_read_b32 v153, a29
  v_accvgpr_read_b32 v154, a30
  v_accvgpr_read_b32 v155, a31
  v_pk_mul_f32 v[148:149], v[148:149], v[8:9] op_sel_hi:[1,0]
  v_pk_mul_f32 v[150:151], v[150:151], v[8:9] op_sel_hi:[1,0]
  v_pk_mul_f32 v[152:153], v[152:153], v[8:9] op_sel_hi:[1,0]
  v_pk_mul_f32 v[154:155], v[154:155], v[8:9] op_sel_hi:[1,0]
  v_cvt_pk_bf16_f32 v156, v148, v149
  v_cvt_pk_bf16_f32 v157, v150, v151
  v_cvt_pk_bf16_f32 v158, v152, v153
  v_cvt_pk_bf16_f32 v159, v154, v155
  buffer_store_dwordx4 v[156:159], v2, s[4:7], s28 offen offset:3072 sc1
  s_add_u32 s28, s25, 100667392
  v_accvgpr_read_b32 v112, a32
  v_accvgpr_read_b32 v113, a33
  v_accvgpr_read_b32 v114, a34
  v_accvgpr_read_b32 v115, a35
  v_accvgpr_read_b32 v116, a36
  v_accvgpr_read_b32 v117, a37
  v_accvgpr_read_b32 v118, a38
  v_accvgpr_read_b32 v119, a39
  v_pk_mul_f32 v[112:113], v[112:113], v[8:9] op_sel_hi:[1,0]
  v_pk_mul_f32 v[114:115], v[114:115], v[8:9] op_sel_hi:[1,0]
  v_pk_mul_f32 v[116:117], v[116:117], v[8:9] op_sel_hi:[1,0]
  v_pk_mul_f32 v[118:119], v[118:119], v[8:9] op_sel_hi:[1,0]
  v_cvt_pk_bf16_f32 v120, v112, v113
  v_cvt_pk_bf16_f32 v121, v114, v115
  v_cvt_pk_bf16_f32 v122, v116, v117
  v_cvt_pk_bf16_f32 v123, v118, v119
  buffer_store_dwordx4 v[120:123], v2, s[4:7], s28 offen offset:0 sc1
  v_accvgpr_read_b32 v124, a40
  v_accvgpr_read_b32 v125, a41
  v_accvgpr_read_b32 v126, a42
  v_accvgpr_read_b32 v127, a43
  v_accvgpr_read_b32 v128, a44
  v_accvgpr_read_b32 v129, a45
  v_accvgpr_read_b32 v130, a46
  v_accvgpr_read_b32 v131, a47
  v_pk_mul_f32 v[124:125], v[124:125], v[8:9] op_sel_hi:[1,0]
  v_pk_mul_f32 v[126:127], v[126:127], v[8:9] op_sel_hi:[1,0]
  v_pk_mul_f32 v[128:129], v[128:129], v[8:9] op_sel_hi:[1,0]
  v_pk_mul_f32 v[130:131], v[130:131], v[8:9] op_sel_hi:[1,0]
  v_cvt_pk_bf16_f32 v132, v124, v125
  v_cvt_pk_bf16_f32 v133, v126, v127
  v_cvt_pk_bf16_f32 v134, v128, v129
  v_cvt_pk_bf16_f32 v135, v130, v131
  buffer_store_dwordx4 v[132:135], v2, s[4:7], s28 offen offset:1024 sc1
  v_accvgpr_read_b32 v136, a48
  v_accvgpr_read_b32 v137, a49
  v_accvgpr_read_b32 v138, a50
  v_accvgpr_read_b32 v139, a51
  v_accvgpr_read_b32 v140, a52
  v_accvgpr_read_b32 v141, a53
  v_accvgpr_read_b32 v142, a54
  v_accvgpr_read_b32 v143, a55
  v_pk_mul_f32 v[136:137], v[136:137], v[8:9] op_sel_hi:[1,0]
  v_pk_mul_f32 v[138:139], v[138:139], v[8:9] op_sel_hi:[1,0]
  v_pk_mul_f32 v[140:141], v[140:141], v[8:9] op_sel_hi:[1,0]
  v_pk_mul_f32 v[142:143], v[142:143], v[8:9] op_sel_hi:[1,0]
  v_cvt_pk_bf16_f32 v144, v136, v137
  v_cvt_pk_bf16_f32 v145, v138, v139
  v_cvt_pk_bf16_f32 v146, v140, v141
  v_cvt_pk_bf16_f32 v147, v142, v143
  buffer_store_dwordx4 v[144:147], v2, s[4:7], s28 offen offset:2048 sc1
  v_accvgpr_read_b32 v148, a56
  v_accvgpr_read_b32 v149, a57
  v_accvgpr_read_b32 v150, a58
  v_accvgpr_read_b32 v151, a59
  v_accvgpr_read_b32 v152, a60
  v_accvgpr_read_b32 v153, a61
  v_accvgpr_read_b32 v154, a62
  v_accvgpr_read_b32 v155, a63
  v_pk_mul_f32 v[148:149], v[148:149], v[8:9] op_sel_hi:[1,0]
  v_pk_mul_f32 v[150:151], v[150:151], v[8:9] op_sel_hi:[1,0]
  v_pk_mul_f32 v[152:153], v[152:153], v[8:9] op_sel_hi:[1,0]
  v_pk_mul_f32 v[154:155], v[154:155], v[8:9] op_sel_hi:[1,0]
  v_cvt_pk_bf16_f32 v156, v148, v149
  v_cvt_pk_bf16_f32 v157, v150, v151
  v_cvt_pk_bf16_f32 v158, v152, v153
  v_cvt_pk_bf16_f32 v159, v154, v155
  buffer_store_dwordx4 v[156:159], v2, s[4:7], s28 offen offset:3072 sc1
  s_add_u32 s28, s25, 100671488
  v_accvgpr_read_b32 v112, a64
  v_accvgpr_read_b32 v113, a65
  v_accvgpr_read_b32 v114, a66
  v_accvgpr_read_b32 v115, a67
  v_accvgpr_read_b32 v116, a68
  v_accvgpr_read_b32 v117, a69
  v_accvgpr_read_b32 v118, a70
  v_accvgpr_read_b32 v119, a71
  v_pk_mul_f32 v[112:113], v[112:113], v[10:11] op_sel_hi:[1,0]
  v_pk_mul_f32 v[114:115], v[114:115], v[10:11] op_sel_hi:[1,0]
  v_pk_mul_f32 v[116:117], v[116:117], v[10:11] op_sel_hi:[1,0]
  v_pk_mul_f32 v[118:119], v[118:119], v[10:11] op_sel_hi:[1,0]
  v_cvt_pk_bf16_f32 v120, v112, v113
  v_cvt_pk_bf16_f32 v121, v114, v115
  v_cvt_pk_bf16_f32 v122, v116, v117
  v_cvt_pk_bf16_f32 v123, v118, v119
  buffer_store_dwordx4 v[120:123], v2, s[4:7], s28 offen offset:0 sc1
  v_accvgpr_read_b32 v124, a72
  v_accvgpr_read_b32 v125, a73
  v_accvgpr_read_b32 v126, a74
  v_accvgpr_read_b32 v127, a75
  v_accvgpr_read_b32 v128, a76
  v_accvgpr_read_b32 v129, a77
  v_accvgpr_read_b32 v130, a78
  v_accvgpr_read_b32 v131, a79
  v_pk_mul_f32 v[124:125], v[124:125], v[10:11] op_sel_hi:[1,0]
  v_pk_mul_f32 v[126:127], v[126:127], v[10:11] op_sel_hi:[1,0]
  v_pk_mul_f32 v[128:129], v[128:129], v[10:11] op_sel_hi:[1,0]
  v_pk_mul_f32 v[130:131], v[130:131], v[10:11] op_sel_hi:[1,0]
  v_cvt_pk_bf16_f32 v132, v124, v125
  v_cvt_pk_bf16_f32 v133, v126, v127
  v_cvt_pk_bf16_f32 v134, v128, v129
  v_cvt_pk_bf16_f32 v135, v130, v131
  buffer_store_dwordx4 v[132:135], v2, s[4:7], s28 offen offset:1024 sc1
  v_accvgpr_read_b32 v136, a80
  v_accvgpr_read_b32 v137, a81
  v_accvgpr_read_b32 v138, a82
  v_accvgpr_read_b32 v139, a83
  v_accvgpr_read_b32 v140, a84
  v_accvgpr_read_b32 v141, a85
  v_accvgpr_read_b32 v142, a86
  v_accvgpr_read_b32 v143, a87
  v_pk_mul_f32 v[136:137], v[136:137], v[10:11] op_sel_hi:[1,0]
  v_pk_mul_f32 v[138:139], v[138:139], v[10:11] op_sel_hi:[1,0]
  v_pk_mul_f32 v[140:141], v[140:141], v[10:11] op_sel_hi:[1,0]
  v_pk_mul_f32 v[142:143], v[142:143], v[10:11] op_sel_hi:[1,0]
  v_cvt_pk_bf16_f32 v144, v136, v137
  v_cvt_pk_bf16_f32 v145, v138, v139
  v_cvt_pk_bf16_f32 v146, v140, v141
  v_cvt_pk_bf16_f32 v147, v142, v143
  buffer_store_dwordx4 v[144:147], v2, s[4:7], s28 offen offset:2048 sc1
  v_accvgpr_read_b32 v148, a88
  v_accvgpr_read_b32 v149, a89
  v_accvgpr_read_b32 v150, a90
  v_accvgpr_read_b32 v151, a91
  v_accvgpr_read_b32 v152, a92
  v_accvgpr_read_b32 v153, a93
  v_accvgpr_read_b32 v154, a94
  v_accvgpr_read_b32 v155, a95
  v_pk_mul_f32 v[148:149], v[148:149], v[10:11] op_sel_hi:[1,0]
  v_pk_mul_f32 v[150:151], v[150:151], v[10:11] op_sel_hi:[1,0]
  v_pk_mul_f32 v[152:153], v[152:153], v[10:11] op_sel_hi:[1,0]
  v_pk_mul_f32 v[154:155], v[154:155], v[10:11] op_sel_hi:[1,0]
  v_cvt_pk_bf16_f32 v156, v148, v149
  v_cvt_pk_bf16_f32 v157, v150, v151
  v_cvt_pk_bf16_f32 v158, v152, v153
  v_cvt_pk_bf16_f32 v159, v154, v155
  buffer_store_dwordx4 v[156:159], v2, s[4:7], s28 offen offset:3072 sc1
  s_add_u32 s28, s25, 100675584
  v_accvgpr_read_b32 v112, a96
  v_accvgpr_read_b32 v113, a97
  v_accvgpr_read_b32 v114, a98
  v_accvgpr_read_b32 v115, a99
  v_accvgpr_read_b32 v116, a100
  v_accvgpr_read_b32 v117, a101
  v_accvgpr_read_b32 v118, a102
  v_accvgpr_read_b32 v119, a103
  v_pk_mul_f32 v[112:113], v[112:113], v[10:11] op_sel_hi:[1,0]
  v_pk_mul_f32 v[114:115], v[114:115], v[10:11] op_sel_hi:[1,0]
  v_pk_mul_f32 v[116:117], v[116:117], v[10:11] op_sel_hi:[1,0]
  v_pk_mul_f32 v[118:119], v[118:119], v[10:11] op_sel_hi:[1,0]
  v_cvt_pk_bf16_f32 v120, v112, v113
  v_cvt_pk_bf16_f32 v121, v114, v115
  v_cvt_pk_bf16_f32 v122, v116, v117
  v_cvt_pk_bf16_f32 v123, v118, v119
  buffer_store_dwordx4 v[120:123], v2, s[4:7], s28 offen offset:0 sc1
  v_accvgpr_read_b32 v124, a104
  v_accvgpr_read_b32 v125, a105
  v_accvgpr_read_b32 v126, a106
  v_accvgpr_read_b32 v127, a107
  v_accvgpr_read_b32 v128, a108
  v_accvgpr_read_b32 v129, a109
  v_accvgpr_read_b32 v130, a110
  v_accvgpr_read_b32 v131, a111
  v_pk_mul_f32 v[124:125], v[124:125], v[10:11] op_sel_hi:[1,0]
  v_pk_mul_f32 v[126:127], v[126:127], v[10:11] op_sel_hi:[1,0]
  v_pk_mul_f32 v[128:129], v[128:129], v[10:11] op_sel_hi:[1,0]
  v_pk_mul_f32 v[130:131], v[130:131], v[10:11] op_sel_hi:[1,0]
  v_cvt_pk_bf16_f32 v132, v124, v125
  v_cvt_pk_bf16_f32 v133, v126, v127
  v_cvt_pk_bf16_f32 v134, v128, v129
  v_cvt_pk_bf16_f32 v135, v130, v131
  buffer_store_dwordx4 v[132:135], v2, s[4:7], s28 offen offset:1024 sc1
  v_accvgpr_read_b32 v136, a112
  v_accvgpr_read_b32 v137, a113
  v_accvgpr_read_b32 v138, a114
  v_accvgpr_read_b32 v139, a115
  v_accvgpr_read_b32 v140, a116
  v_accvgpr_read_b32 v141, a117
  v_accvgpr_read_b32 v142, a118
  v_accvgpr_read_b32 v143, a119
  v_pk_mul_f32 v[136:137], v[136:137], v[10:11] op_sel_hi:[1,0]
  v_pk_mul_f32 v[138:139], v[138:139], v[10:11] op_sel_hi:[1,0]
  v_pk_mul_f32 v[140:141], v[140:141], v[10:11] op_sel_hi:[1,0]
  v_pk_mul_f32 v[142:143], v[142:143], v[10:11] op_sel_hi:[1,0]
  v_cvt_pk_bf16_f32 v144, v136, v137
  v_cvt_pk_bf16_f32 v145, v138, v139
  v_cvt_pk_bf16_f32 v146, v140, v141
  v_cvt_pk_bf16_f32 v147, v142, v143
  buffer_store_dwordx4 v[144:147], v2, s[4:7], s28 offen offset:2048 sc1
  v_accvgpr_read_b32 v148, a120
  v_accvgpr_read_b32 v149, a121
  v_accvgpr_read_b32 v150, a122
  v_accvgpr_read_b32 v151, a123
  v_accvgpr_read_b32 v152, a124
  v_accvgpr_read_b32 v153, a125
  v_accvgpr_read_b32 v154, a126
  v_accvgpr_read_b32 v155, a127
  v_pk_mul_f32 v[148:149], v[148:149], v[10:11] op_sel_hi:[1,0]
  v_pk_mul_f32 v[150:151], v[150:151], v[10:11] op_sel_hi:[1,0]
  v_pk_mul_f32 v[152:153], v[152:153], v[10:11] op_sel_hi:[1,0]
  v_pk_mul_f32 v[154:155], v[154:155], v[10:11] op_sel_hi:[1,0]
  v_cvt_pk_bf16_f32 v156, v148, v149
  v_cvt_pk_bf16_f32 v157, v150, v151
  v_cvt_pk_bf16_f32 v158, v152, v153
  v_cvt_pk_bf16_f32 v159, v154, v155
  buffer_store_dwordx4 v[156:159], v2, s[4:7], s28 offen offset:3072 sc1
  s_branch A_out_164
A_kvw_165:
M_kv_168:
  s_cmp_ge_u32 s17, s36
  s_cbranch_scc1 M_kvok_169
  s_mov_b32 s76, 0
  s_mov_b32 s78, 23
  s_mov_b32 s77, 335872
  s_cmp_eq_u32 s68, 1
  s_cmov_b32 s76, 128
  s_cmov_b32 s78, 27
  s_cmov_b32 s77, 114688
  s_cmp_eq_u32 s68, 2
  s_cmov_b32 s76, 768
  s_cmov_b32 s78, 14
  s_cmov_b32 s77, 0
  s_add_u32 s76, s76, s67
  s_mov_b32 s71, 0
  s_branch M_sg_171
M_sw_170:
  s_sleep 8
  s_add_u32 s71, s71, 1
  s_cmp_gt_u32 s71, 262144
  s_cbranch_scc1 M_exit
M_sg_171:
  s_mov_b32 s79, 0
  s_atomic_or s79, s[72:73], s76 glc
  s_waitcnt lgkmcnt(0)
  s_cmp_lt_u32 s79, s78
  s_cbranch_scc1 M_sw_170
  s_add_u32 s36, s77, s19
  s_add_u32 s68, s68, 1
  s_branch M_kv_168
M_kvok_169:
  s_branch A_kvb_166
A_upd_162:
  s_cmp_eq_u32 s23, 2
  s_cbranch_scc1 A_upd2_172
  v_mov_b32 v12, s24
  v_cmp_le_i32 s[40:41], 0, v5
  v_cmp_le_i32 s[42:43], 1, v5
  v_cmp_le_i32 s[44:45], 2, v5
  v_cmp_le_i32 s[46:47], 3, v5
  v_cndmask_b32 v64, v12, v6, s[40:41]
  v_cndmask_b32 v65, v12, v6, s[42:43]
  v_cndmask_b32 v66, v12, v6, s[44:45]
  v_cndmask_b32 v67, v12, v6, s[46:47]
  v_cmp_le_i32 s[40:41], 8, v5
  v_cmp_le_i32 s[42:43], 9, v5
  v_cmp_le_i32 s[44:45], 10, v5
  v_cmp_le_i32 s[46:47], 11, v5
  v_cndmask_b32 v68, v12, v6, s[40:41]
  v_cndmask_b32 v69, v12, v6, s[42:43]
  v_cndmask_b32 v70, v12, v6, s[44:45]
  v_cndmask_b32 v71, v12, v6, s[46:47]
  v_cmp_le_i32 s[40:41], 16, v5
  v_cmp_le_i32 s[42:43], 17, v5
  v_cmp_le_i32 s[44:45], 18, v5
  v_cmp_le_i32 s[46:47], 19, v5
  v_cndmask_b32 v72, v12, v6, s[40:41]
  v_cndmask_b32 v73, v12, v6, s[42:43]
  v_cndmask_b32 v74, v12, v6, s[44:45]
  v_cndmask_b32 v75, v12, v6, s[46:47]
  v_cmp_le_i32 s[40:41], 24, v5
  v_cmp_le_i32 s[42:43], 25, v5
  v_cmp_le_i32 s[44:45], 26, v5
  v_cmp_le_i32 s[46:47], 27, v5
  v_cndmask_b32 v76, v12, v6, s[40:41]
  v_cndmask_b32 v77, v12, v6, s[42:43]
  v_cndmask_b32 v78, v12, v6, s[44:45]
  v_cndmask_b32 v79, v12, v6, s[46:47]
  v_mov_b32 v80, v7
  v_mov_b32 v81, v7
  v_mov_b32 v82, v7
  v_mov_b32 v83, v7
  v_mov_b32 v84, v7
  v_mov_b32 v85, v7
  v_mov_b32 v86, v7
  v_mov_b32 v87, v7
  v_mov_b32 v88, v7
  v_mov_b32 v89, v7
  v_mov_b32 v90, v7
  v_mov_b32 v91, v7
  v_mov_b32 v92, v7
  v_mov_b32 v93, v7
  v_mov_b32 v94, v7
  v_mov_b32 v95, v7
  s_branch A_back_163
A_upd2_172:
  v_mov_b32 v64, v6
  v_mov_b32 v65, v6
  v_mov_b32 v66, v6
  v_mov_b32 v67, v6
  v_mov_b32 v68, v6
  v_mov_b32 v69, v6
  v_mov_b32 v70, v6
  v_mov_b32 v71, v6
  v_mov_b32 v72, v6
  v_mov_b32 v73, v6
  v_mov_b32 v74, v6
  v_mov_b32 v75, v6
  v_mov_b32 v76, v6
  v_mov_b32 v77, v6
  v_mov_b32 v78, v6
  v_mov_b32 v79, v6
  s_branch A_back_163
A_slow_167:
  s_mov_b32 s29, 1
  v_mov_b32 v64, s24
  v_mov_b32 v65, s24
  v_mov_b32 v66, s24
  v_mov_b32 v67, s24
  v_mov_b32 v68, s24
  v_mov_b32 v69, s24
  v_mov_b32 v70, s24
  v_mov_b32 v71, s24
  v_mov_b32 v72, s24
  v_mov_b32 v73, s24
  v_mov_b32 v74, s24
  v_mov_b32 v75, s24
  v_mov_b32 v76, s24
  v_mov_b32 v77, s24
  v_mov_b32 v78, s24
  v_mov_b32 v79, s24
  v_mov_b32 v12, s24
  v_cmp_le_i32 s[40:41], 0, v5
  v_cmp_le_i32 s[42:43], 1, v5
  v_cmp_le_i32 s[44:45], 2, v5
  v_cmp_le_i32 s[46:47], 3, v5
  v_cndmask_b32 v80, v12, v7, s[40:41]
  v_cndmask_b32 v81, v12, v7, s[42:43]
  v_cndmask_b32 v82, v12, v7, s[44:45]
  v_cndmask_b32 v83, v12, v7, s[46:47]
  v_cmp_le_i32 s[40:41], 8, v5
  v_cmp_le_i32 s[42:43], 9, v5
  v_cmp_le_i32 s[44:45], 10, v5
  v_cmp_le_i32 s[46:47], 11, v5
  v_cndmask_b32 v84, v12, v7, s[40:41]
  v_cndmask_b32 v85, v12, v7, s[42:43]
  v_cndmask_b32 v86, v12, v7, s[44:45]
  v_cndmask_b32 v87, v12, v7, s[46:47]
  v_cmp_le_i32 s[40:41], 16, v5
  v_cmp_le_i32 s[42:43], 17, v5
  v_cmp_le_i32 s[44:45], 18, v5
  v_cmp_le_i32 s[46:47], 19, v5
  v_cndmask_b32 v88, v12, v7, s[40:41]
  v_cndmask_b32 v89, v12, v7, s[42:43]
  v_cndmask_b32 v90, v12, v7, s[44:45]
  v_cndmask_b32 v91, v12, v7, s[46:47]
  v_cmp_le_i32 s[40:41], 24, v5
  v_cmp_le_i32 s[42:43], 25, v5
  v_cmp_le_i32 s[44:45], 26, v5
  v_cmp_le_i32 s[46:47], 27, v5
  v_cndmask_b32 v92, v12, v7, s[40:41]
  v_cndmask_b32 v93, v12, v7, s[42:43]
  v_cndmask_b32 v94, v12, v7, s[44:45]
  v_cndmask_b32 v95, v12, v7, s[46:47]
  v_mov_b32 v8, s24
  v_mov_b32 v10, s24
  s_add_u32 s17, s25, 16785408
  s_mov_b32 s23, 0
A_ml_173:
  s_add_u32 s28, s17, 4096
  buffer_load_dwordx4 a[192:195], v2, s[4:7], s17 offen offset:0 sc1
  buffer_load_dwordx4 a[196:199], v2, s[4:7], s17 offen offset:1024 sc1
  buffer_load_dwordx4 a[200:203], v2, s[4:7], s17 offen offset:2048 sc1
  buffer_load_dwordx4 a[204:207], v2, s[4:7], s17 offen offset:3072 sc1
  buffer_load_dwordx4 a[208:211], v2, s[4:7], s28 offen offset:0 sc1
  buffer_load_dwordx4 a[212:215], v2, s[4:7], s28 offen offset:1024 sc1
  buffer_load_dwordx4 a[216:219], v2, s[4:7], s28 offen offset:2048 sc1
  buffer_load_dwordx4 a[220:223], v2, s[4:7], s28 offen offset:3072 sc1
  s_waitcnt vmcnt(0)
  v_mfma_f32_32x32x16_bf16 v[32:47], a[192:195], a[128:131], v[64:79]
  v_mfma_f32_32x32x16_bf16 v[32:47], a[196:199], a[132:135], v[32:47]
  v_mfma_f32_32x32x16_bf16 v[32:47], a[200:203], a[136:139], v[32:47]
  v_mfma_f32_32x32x16_bf16 v[32:47], a[204:207], a[140:143], v[32:47]
  v_mfma_f32_32x32x16_bf16 v[32:47], a[208:211], a[144:147], v[32:47]
  v_mfma_f32_32x32x16_bf16 v[32:47], a[212:215], a[148:151], v[32:47]
  v_mfma_f32_32x32x16_bf16 v[32:47], a[216:219], a[152:155], v[32:47]
  v_mfma_f32_32x32x16_bf16 v[32:47], a[220:223], a[156:159], v[32:47]
  v_mfma_f32_32x32x16_bf16 v[48:63], a[192:195], a[160:163], v[80:95]
  v_mfma_f32_32x32x16_bf16 v[48:63], a[196:199], a[164:167], v[48:63]
  v_mfma_f32_32x32x16_bf16 v[48:63], a[200:203], a[168:171], v[48:63]
  v_mfma_f32_32x32x16_bf16 v[48:63], a[204:207], a[172:175], v[48:63]
  v_mfma_f32_32x32x16_bf16 v[48:63], a[208:211], a[176:179], v[48:63]
  v_mfma_f32_32x32x16_bf16 v[48:63], a[212:215], a[180:183], v[48:63]
  v_mfma_f32_32x32x16_bf16 v[48:63], a[216:219], a[184:187], v[48:63]
  v_mfma_f32_32x32x16_bf16 v[48:63], a[220:223], a[188:191], v[48:63]
  s_nop 7
  s_nop 3
  v_max3_f32 v8, v8, v32, v33
  v_max3_f32 v8, v8, v34, v35
  v_max3_f32 v8, v8, v36, v37
  v_max3_f32 v8, v8, v38, v39
  v_max3_f32 v8, v8, v40, v41
  v_max3_f32 v8, v8, v42, v43
  v_max3_f32 v8, v8, v44, v45
  v_max3_f32 v8, v8, v46, v47
  v_max3_f32 v10, v10, v48, v49
  v_max3_f32 v10, v10, v50, v51
  v_max3_f32 v10, v10, v52, v53
  v_max3_f32 v10, v10, v54, v55
  v_max3_f32 v10, v10, v56, v57
  v_max3_f32 v10, v10, v58, v59
  v_max3_f32 v10, v10, v60, v61
  v_max3_f32 v10, v10, v62, v63
  s_add_u32 s23, s23, 1
  s_cmp_lg_u32 s23, 1
  s_cbranch_scc1 A_m2_174
  v_mov_b32 v12, s24
  v_cmp_le_i32 s[40:41], 0, v5
  v_cmp_le_i32 s[42:43], 1, v5
  v_cmp_le_i32 s[44:45], 2, v5
  v_cmp_le_i32 s[46:47], 3, v5
  v_cndmask_b32 v64, v12, v6, s[40:41]
  v_cndmask_b32 v65, v12, v6, s[42:43]
  v_cndmask_b32 v66, v12, v6, s[44:45]
  v_cndmask_b32 v67, v12, v6, s[46:47]
  v_cmp_le_i32 s[40:41], 8, v5
  v_cmp_le_i32 s[42:43], 9, v5
  v_cmp_le_i32 s[44:45], 10, v5
  v_cmp_le_i32 s[46:47], 11, v5
  v_cndmask_b32 v68, v12, v6, s[40:41]
  v_cndmask_b32 v69, v12, v6, s[42:43]
  v_cndmask_b32 v70, v12, v6, s[44:45]
  v_cndmask_b32 v71, v12, v6, s[46:47]
  v_cmp_le_i32 s[40:41], 16, v5
  v_cmp_le_i32 s[42:43], 17, v5
  v_cmp_le_i32 s[44:45], 18, v5
  v_cmp_le_i32 s[46:47], 19, v5
  v_cndmask_b32 v72, v12, v6, s[40:41]
  v_cndmask_b32 v73, v12, v6, s[42:43]
  v_cndmask_b32 v74, v12, v6, s[44:45]
  v_cndmask_b32 v75, v12, v6, s[46:47]
  v_cmp_le_i32 s[40:41], 24, v5
  v_cmp_le_i32 s[42:43], 25, v5
  v_cmp_le_i32 s[44:45], 26, v5
  v_cmp_le_i32 s[46:47], 27, v5
  v_cndmask_b32 v76, v12, v6, s[40:41]
  v_cndmask_b32 v77, v12, v6, s[42:43]
  v_cndmask_b32 v78, v12, v6, s[44:45]
  v_cndmask_b32 v79, v12, v6, s[46:47]
  v_mov_b32 v80, v7
  v_mov_b32 v81, v7
  v_mov_b32 v82, v7
  v_mov_b32 v83, v7
  v_mov_b32 v84, v7
  v_mov_b32 v85, v7
  v_mov_b32 v86, v7
  v_mov_b32 v87, v7
  v_mov_b32 v88, v7
  v_mov_b32 v89, v7
  v_mov_b32 v90, v7
  v_mov_b32 v91, v7
  v_mov_b32 v92, v7
  v_mov_b32 v93, v7
  v_mov_b32 v94, v7
  v_mov_b32 v95, v7
A_m2_174:
  s_cmp_lg_u32 s23, 2
  s_cbranch_scc1 A_m3_175
  v_mov_b32 v64, v6
  v_mov_b32 v65, v6
  v_mov_b32 v66, v6
  v_mov_b32 v67, v6
  v_mov_b32 v68, v6
  v_mov_b32 v69, v6
  v_mov_b32 v70, v6
  v_mov_b32 v71, v6
  v_mov_b32 v72, v6
  v_mov_b32 v73, v6
  v_mov_b32 v74, v6
  v_mov_b32 v75, v6
  v_mov_b32 v76, v6
  v_mov_b32 v77, v6
  v_mov_b32 v78, v6
  v_mov_b32 v79, v6
A_m3_175:
  s_sub_u32 s17, s17, 8192
  s_cmp_ge_i32 s17, s19
  s_cbranch_scc1 A_ml_173
  v_mov_b32 v9, v8
  s_nop 1
  v_permlane32_swap_b32 v8, v9
  s_nop 1
  v_max_f32 v8, v8, v9
  v_sub_f32 v6, 0, v8
  v_mov_b32 v11, v10
  s_nop 1
  v_permlane32_swap_b32 v10, v11
  s_nop 1
  v_max_f32 v10, v10, v11
  v_sub_f32 v7, 0, v10
  s_branch A_again_154
A_out_164:
  s_mov_b32 s69, s55
  s_mov_b32 s70, s56
  s_sub_u32 s52, s52, 1
  s_cmp_lg_u32 s52, 0
  s_cbranch_scc1 M_att
  s_waitcnt vmcnt(0)
  s_barrier
  s_mov_b32 s30, 512
  v_mov_b32 v144, s30
  v_min_u32 v145, 1, v0
  v_lshlrev_b32 v145, 30, v145
  buffer_store_dword v144, v145, s[4:7], s31 offen sc1
  s_lshr_b32 s48, s64, 2
  s_bfe_u32 s49, s64, 0x10001
  s_and_b32 s50, s64, 1
  s_mul_i32 s50, s50, 6
  s_add_u32 s50, s50, s65
  s_mov_b32 s51, 12
  s_cmp_lt_u32 s50, 4
  s_cselect_b32 s23, 6, 5
  s_load_dwordx2 s[8:9], s[0:1], 40
  s_lshl_b32 s17, s48, 19
  s_lshl_b32 s26, s49, 2
  s_add_u32 s26, s26, s16
  s_lshl_b32 s27, s26, 7
  s_add_u32 s17, s17, s27
  s_mov_b32 s18, 1024
  s_lshl_b32 s21, s48, 6
  s_add_u32 s21, s21, s50
  s_lshl_b32 s21, s21, 3
  s_add_u32 s21, s21, s26
  s_lshl_b32 s21, s21, 12
  s_add_u32 s21, s21, 150994944
  s_lshl_b32 s22, s51, 15
  s_mov_b32 s24, 1.0
  s_waitcnt lgkmcnt(0)
  s_and_b32 s9, s9, 0xffff
  s_mov_b32 s10, 4194304
  s_mov_b32 s11, 0x20000
  s_mov_b32 s12, s4
  s_mov_b32 s13, s5
  s_mov_b32 s14, 268435456
  s_mov_b32 s15, 0x20000
  s_lshl_b32 s19, s48, 8
  s_add_u32 s19, s19, s50
  s_lshl_b32 s19, s19, 13
  s_add_u32 s19, s19, 100663296
  s_lshl_b32 s20, s51, 13
  v_lshrrev_b32 v144, 4, v1
  v_and_b32 v56, 0xff, v2
  v_lshl_add_u32 v56, v144, 9, v56
  s_mul_i32 s26, s16, 524288
  v_add_u32 v8, 0, v56
  v_add_u32 v16, 0, v2
  v_add_u32 v16, s26, v16
  v_add_u32 v9, 256, v56
  v_add_u32 v17, 1024, v2
  v_add_u32 v17, s26, v17
  v_add_u32 v10, 2048, v56
  v_add_u32 v18, 2048, v2
  v_add_u32 v18, s26, v18
  v_add_u32 v11, 2304, v56
  v_add_u32 v19, 3072, v2
  v_add_u32 v19, s26, v19
  v_add_u32 v12, 4096, v56
  v_add_u32 v20, 4096, v2
  v_add_u32 v20, s26, v20
  v_add_u32 v13, 4352, v56
  v_add_u32 v21, 5120, v2
  v_add_u32 v21, s26, v21
  v_add_u32 v14, 6144, v56
  v_add_u32 v22, 6144, v2
  v_add_u32 v22, s26, v22
  v_add_u32 v15, 6400, v56
  v_add_u32 v23, 7168, v2
  v_add_u32 v23, s26, v23
  v_lshrrev_b32 v144, 3, v1
  v_mul_lo_u32 v144, v144, s18
  v_and_b32 v145, 7, v1
  v_lshl_add_u32 v144, v145, 4, v144
  s_lshl_b32 s28, s16, 15
  s_add_u32 s28, s28, 32768
  s_lshl_b32 s29, s18, 3
  s_add_u32 m0, s28, 0
  s_nop 0
  buffer_load_dwordx4 v144, s[8:11], s17 offen lds
  s_add_u32 s17, s17, s29
  s_add_u32 m0, s28, 1024
  s_nop 0
  buffer_load_dwordx4 v144, s[8:11], s17 offen lds
  s_add_u32 s17, s17, s29
  s_add_u32 m0, s28, 2048
  s_nop 0
  buffer_load_dwordx4 v144, s[8:11], s17 offen lds
  s_add_u32 s17, s17, s29
  s_add_u32 m0, s28, 3072
  s_nop 0
  buffer_load_dwordx4 v144, s[8:11], s17 offen lds
  s_add_u32 s17, s17, s29
  s_add_u32 m0, s28, 4096
  s_nop 0
  buffer_load_dwordx4 v144, s[8:11], s17 offen lds
  s_add_u32 s17, s17, s29
  s_add_u32 m0, s28, 5120
  s_nop 0
  buffer_load_dwordx4 v144, s[8:11], s17 offen lds
  s_add_u32 s17, s17, s29
  s_add_u32 m0, s28, 6144
  s_nop 0
  buffer_load_dwordx4 v144, s[8:11], s17 offen lds
  s_add_u32 s17, s17, s29
  s_add_u32 m0, s28, 7168
  s_nop 0
  buffer_load_dwordx4 v144, s[8:11], s17 offen lds
  s_add_u32 s17, s17, s29
  s_add_u32 m0, s28, 8192
  s_nop 0
  buffer_load_dwordx4 v144, s[8:11], s17 offen lds
  s_add_u32 s17, s17, s29
  s_add_u32 m0, s28, 9216
  s_nop 0
  buffer_load_dwordx4 v144, s[8:11], s17 offen lds
  s_add_u32 s17, s17, s29
  s_add_u32 m0, s28, 10240
  s_nop 0
  buffer_load_dwordx4 v144, s[8:11], s17 offen lds
  s_add_u32 s17, s17, s29
  s_add_u32 m0, s28, 11264
  s_nop 0
  buffer_load_dwordx4 v144, s[8:11], s17 offen lds
  s_add_u32 s17, s17, s29
  s_add_u32 m0, s28, 12288
  s_nop 0
  buffer_load_dwordx4 v144, s[8:11], s17 offen lds
  s_add_u32 s17, s17, s29
  s_add_u32 m0, s28, 13312
  s_nop 0
  buffer_load_dwordx4 v144, s[8:11], s17 offen lds
  s_add_u32 s17, s17, s29
  s_add_u32 m0, s28, 14336
  s_nop 0
  buffer_load_dwordx4 v144, s[8:11], s17 offen lds
  s_add_u32 s17, s17, s29
  s_add_u32 m0, s28, 15360
  s_nop 0
  buffer_load_dwordx4 v144, s[8:11], s17 offen lds
  s_add_u32 s17, s17, s29
  s_add_u32 m0, s28, 16384
  s_nop 0
  buffer_load_dwordx4 v144, s[8:11], s17 offen lds
  s_add_u32 s17, s17, s29
  s_add_u32 m0, s28, 17408
  s_nop 0
  buffer_load_dwordx4 v144, s[8:11], s17 offen lds
  s_add_u32 s17, s17, s29
  s_add_u32 m0, s28, 18432
  s_nop 0
  buffer_load_dwordx4 v144, s[8:11], s17 offen lds
  s_add_u32 s17, s17, s29
  s_add_u32 m0, s28, 19456
  s_nop 0
  buffer_load_dwordx4 v144, s[8:11], s17 offen lds
  s_add_u32 s17, s17, s29
  s_add_u32 m0, s28, 20480
  s_nop 0
  buffer_load_dwordx4 v144, s[8:11], s17 offen lds
  s_add_u32 s17, s17, s29
  s_add_u32 m0, s28, 21504
  s_nop 0
  buffer_load_dwordx4 v144, s[8:11], s17 offen lds
  s_add_u32 s17, s17, s29
  s_add_u32 m0, s28, 22528
  s_nop 0
  buffer_load_dwordx4 v144, s[8:11], s17 offen lds
  s_add_u32 s17, s17, s29
  s_add_u32 m0, s28, 23552
  s_nop 0
  buffer_load_dwordx4 v144, s[8:11], s17 offen lds
  s_add_u32 s17, s17, s29
  s_add_u32 m0, s28, 24576
  s_nop 0
  buffer_load_dwordx4 v144, s[8:11], s17 offen lds
  s_add_u32 s17, s17, s29
  s_add_u32 m0, s28, 25600
  s_nop 0
  buffer_load_dwordx4 v144, s[8:11], s17 offen lds
  s_add_u32 s17, s17, s29
  s_add_u32 m0, s28, 26624
  s_nop 0
  buffer_load_dwordx4 v144, s[8:11], s17 offen lds
  s_add_u32 s17, s17, s29
  s_add_u32 m0, s28, 27648
  s_nop 0
  buffer_load_dwordx4 v144, s[8:11], s17 offen lds
  s_add_u32 s17, s17, s29
  s_add_u32 m0, s28, 28672
  s_nop 0
  buffer_load_dwordx4 v144, s[8:11], s17 offen lds
  s_add_u32 s17, s17, s29
  s_add_u32 m0, s28, 29696
  s_nop 0
  buffer_load_dwordx4 v144, s[8:11], s17 offen lds
  s_add_u32 s17, s17, s29
  s_add_u32 m0, s28, 30720
  s_nop 0
  buffer_load_dwordx4 v144, s[8:11], s17 offen lds
  s_add_u32 s17, s17, s29
  s_add_u32 m0, s28, 31744
  s_nop 0
  buffer_load_dwordx4 v144, s[8:11], s17 offen lds
  s_add_u32 s17, s17, s29
  v_bfe_u32 v148, v1, 2, 2
  v_lshrrev_b32 v149, 5, v1
  v_lshl_add_u32 v148, v149, 4, v148
  v_bfe_u32 v149, v1, 4, 1
  v_lshl_add_u32 v148, v149, 2, v148
  v_and_b32 v149, 3, v1
  v_lshlrev_b32 v149, 4, v149
  s_mov_b32 s26, 8
  v_lshl_add_u32 v148, v148, 7, v149
  v_add_u32 v152, s28, v148
  v_add_u32 v153, 1024, v152
  v_add_u32 v154, s26, v152
  v_add_u32 v155, s26, v153
  s_waitcnt vmcnt(28)
  ds_read_b64_tr_b16 a[0:1], v152 offset:0
  ds_read_b64_tr_b16 a[2:3], v153 offset:0
  ds_read_b64_tr_b16 a[4:5], v154 offset:0
  ds_read_b64_tr_b16 a[6:7], v155 offset:0
  ds_read_b64_tr_b16 a[8:9], v152 offset:64
  ds_read_b64_tr_b16 a[10:11], v153 offset:64
  ds_read_b64_tr_b16 a[12:13], v154 offset:64
  ds_read_b64_tr_b16 a[14:15], v155 offset:64
  s_waitcnt lgkmcnt(0)
  s_add_u32 m0, s28, 0
  s_nop 0
  buffer_load_dwordx4 v144, s[8:11], s17 offen lds
  s_add_u32 s17, s17, s29
  s_add_u32 m0, s28, 1024
  s_nop 0
  buffer_load_dwordx4 v144, s[8:11], s17 offen lds
  s_add_u32 s17, s17, s29
  s_add_u32 m0, s28, 2048
  s_nop 0
  buffer_load_dwordx4 v144, s[8:11], s17 offen lds
  s_add_u32 s17, s17, s29
  s_add_u32 m0, s28, 3072
  s_nop 0
  buffer_load_dwordx4 v144, s[8:11], s17 offen lds
  s_add_u32 s17, s17, s29
  s_waitcnt vmcnt(28)
  ds_read_b64_tr_b16 a[16:17], v152 offset:4096
  ds_read_b64_tr_b16 a[18:19], v153 offset:4096
  ds_read_b64_tr_b16 a[20:21], v154 offset:4096
  ds_read_b64_tr_b16 a[22:23], v155 offset:4096
  ds_read_b64_tr_b16 a[24:25], v152 offset:4160
  ds_read_b64_tr_b16 a[26:27], v153 offset:4160
  ds_read_b64_tr_b16 a[28:29], v154 offset:4160
  ds_read_b64_tr_b16 a[30:31], v155 offset:4160
  s_waitcnt lgkmcnt(0)
  s_add_u32 m0, s28, 4096
  s_nop 0
  buffer_load_dwordx4 v144, s[8:11], s17 offen lds
  s_add_u32 s17, s17, s29
  s_add_u32 m0, s28, 5120
  s_nop 0
  buffer_load_dwordx4 v144, s[8:11], s17 offen lds
  s_add_u32 s17, s17, s29
  s_add_u32 m0, s28, 6144
  s_nop 0
  buffer_load_dwordx4 v144, s[8:11], s17 offen lds
  s_add_u32 s17, s17, s29
  s_add_u32 m0, s28, 7168
  s_nop 0
  buffer_load_dwordx4 v144, s[8:11], s17 offen lds
  s_add_u32 s17, s17, s29
  s_waitcnt vmcnt(28)
  ds_read_b64_tr_b16 a[32:33], v152 offset:8192
  ds_read_b64_tr_b16 a[34:35], v153 offset:8192
  ds_read_b64_tr_b16 a[36:37], v154 offset:8192
  ds_read_b64_tr_b16 a[38:39], v155 offset:8192
  ds_read_b64_tr_b16 a[40:41], v152 offset:8256
  ds_read_b64_tr_b16 a[42:43], v153 offset:8256
  ds_read_b64_tr_b16 a[44:45], v154 offset:8256
  ds_read_b64_tr_b16 a[46:47], v155 offset:8256
  s_waitcnt lgkmcnt(0)
  s_add_u32 m0, s28, 8192
  s_nop 0
  buffer_load_dwordx4 v144, s[8:11], s17 offen lds
  s_add_u32 s17, s17, s29
  s_add_u32 m0, s28, 9216
  s_nop 0
  buffer_load_dwordx4 v144, s[8:11], s17 offen lds
  s_add_u32 s17, s17, s29
  s_add_u32 m0, s28, 10240
  s_nop 0
  buffer_load_dwordx4 v144, s[8:11], s17 offen lds
  s_add_u32 s17, s17, s29
  s_add_u32 m0, s28, 11264
  s_nop 0
  buffer_load_dwordx4 v144, s[8:11], s17 offen lds
  s_add_u32 s17, s17, s29
  s_waitcnt vmcnt(28)
  ds_read_b64_tr_b16 a[48:49], v152 offset:12288
  ds_read_b64_tr_b16 a[50:51], v153 offset:12288
  ds_read_b64_tr_b16 a[52:53], v154 offset:12288
  ds_read_b64_tr_b16 a[54:55], v155 offset:12288
  ds_read_b64_tr_b16 a[56:57], v152 offset:12352
  ds_read_b64_tr_b16 a[58:59], v153 offset:12352
  ds_read_b64_tr_b16 a[60:61], v154 offset:12352
  ds_read_b64_tr_b16 a[62:63], v155 offset:12352
  s_waitcnt lgkmcnt(0)
  s_add_u32 m0, s28, 12288
  s_nop 0
  buffer_load_dwordx4 v144, s[8:11], s17 offen lds
  s_add_u32 s17, s17, s29
  s_add_u32 m0, s28, 13312
  s_nop 0
  buffer_load_dwordx4 v144, s[8:11], s17 offen lds
  s_add_u32 s17, s17, s29
  s_add_u32 m0, s28, 14336
  s_nop 0
  buffer_load_dwordx4 v144, s[8:11], s17 offen lds
  s_add_u32 s17, s17, s29
  s_add_u32 m0, s28, 15360
  s_nop 0
  buffer_load_dwordx4 v144, s[8:11], s17 offen lds
  s_add_u32 s17, s17, s29
  s_waitcnt vmcnt(28)
  ds_read_b64_tr_b16 a[64:65], v152 offset:16384
  ds_read_b64_tr_b16 a[66:67], v153 offset:16384
  ds_read_b64_tr_b16 a[68:69], v154 offset:16384
  ds_read_b64_tr_b16 a[70:71], v155 offset:16384
  ds_read_b64_tr_b16 a[72:73], v152 offset:16448
  ds_read_b64_tr_b16 a[74:75], v153 offset:16448
  ds_read_b64_tr_b16 a[76:77], v154 offset:16448
  ds_read_b64_tr_b16 a[78:79], v155 offset:16448
  s_waitcnt lgkmcnt(0)
  s_add_u32 m0, s28, 16384
  s_nop 0
  buffer_load_dwordx4 v144, s[8:11], s17 offen lds
  s_add_u32 s17, s17, s29
  s_add_u32 m0, s28, 17408
  s_nop 0
  buffer_load_dwordx4 v144, s[8:11], s17 offen lds
  s_add_u32 s17, s17, s29
  s_add_u32 m0, s28, 18432
  s_nop 0
  buffer_load_dwordx4 v144, s[8:11], s17 offen lds
  s_add_u32 s17, s17, s29
  s_add_u32 m0, s28, 19456
  s_nop 0
  buffer_load_dwordx4 v144, s[8:11], s17 offen lds
  s_add_u32 s17, s17, s29
  s_waitcnt vmcnt(28)
  ds_read_b64_tr_b16 a[80:81], v152 offset:20480
  ds_read_b64_tr_b16 a[82:83], v153 offset:20480
  ds_read_b64_tr_b16 a[84:85], v154 offset:20480
  ds_read_b64_tr_b16 a[86:87], v155 offset:20480
  ds_read_b64_tr_b16 a[88:89], v152 offset:20544
  ds_read_b64_tr_b16 a[90:91], v153 offset:20544
  ds_read_b64_tr_b16 a[92:93], v154 offset:20544
  ds_read_b64_tr_b16 a[94:95], v155 offset:20544
  s_waitcnt lgkmcnt(0)
  s_add_u32 m0, s28, 20480
  s_nop 0
  buffer_load_dwordx4 v144, s[8:11], s17 offen lds
  s_add_u32 s17, s17, s29
  s_add_u32 m0, s28, 21504
  s_nop 0
  buffer_load_dwordx4 v144, s[8:11], s17 offen lds
  s_add_u32 s17, s17, s29
  s_add_u32 m0, s28, 22528
  s_nop 0
  buffer_load_dwordx4 v144, s[8:11], s17 offen lds
  s_add_u32 s17, s17, s29
  s_add_u32 m0, s28, 23552
  s_nop 0
  buffer_load_dwordx4 v144, s[8:11], s17 offen lds
  s_add_u32 s17, s17, s29
  s_waitcnt vmcnt(28)
  ds_read_b64_tr_b16 a[96:97], v152 offset:24576
  ds_read_b64_tr_b16 a[98:99], v153 offset:24576
  ds_read_b64_tr_b16 a[100:101], v154 offset:24576
  ds_read_b64_tr_b16 a[102:103], v155 offset:24576
  ds_read_b64_tr_b16 a[104:105], v152 offset:24640
  ds_read_b64_tr_b16 a[106:107], v153 offset:24640
  ds_read_b64_tr_b16 a[108:109], v154 offset:24640
  ds_read_b64_tr_b16 a[110:111], v155 offset:24640
  s_waitcnt lgkmcnt(0)
  s_add_u32 m0, s28, 24576
  s_nop 0
  buffer_load_dwordx4 v144, s[8:11], s17 offen lds
  s_add_u32 s17, s17, s29
  s_add_u32 m0, s28, 25600
  s_nop 0
  buffer_load_dwordx4 v144, s[8:11], s17 offen lds
  s_add_u32 s17, s17, s29
  s_add_u32 m0, s28, 26624
  s_nop 0
  buffer_load_dwordx4 v144, s[8:11], s17 offen lds
  s_add_u32 s17, s17, s29
  s_add_u32 m0, s28, 27648
  s_nop 0
  buffer_load_dwordx4 v144, s[8:11], s17 offen lds
  s_add_u32 s17, s17, s29
  s_waitcnt vmcnt(28)
  ds_read_b64_tr_b16 a[112:113], v152 offset:28672
  ds_read_b64_tr_b16 a[114:115], v153 offset:28672
  ds_read_b64_tr_b16 a[116:117], v154 offset:28672
  ds_read_b64_tr_b16 a[118:119], v155 offset:28672
  ds_read_b64_tr_b16 a[120:121], v152 offset:28736
  ds_read_b64_tr_b16 a[122:123], v153 offset:28736
  ds_read_b64_tr_b16 a[124:125], v154 offset:28736
  ds_read_b64_tr_b16 a[126:127], v155 offset:28736
  s_waitcnt lgkmcnt(0)
  s_add_u32 m0, s28, 28672
  s_nop 0
  buffer_load_dwordx4 v144, s[8:11], s17 offen lds
  s_add_u32 s17, s17, s29
  s_add_u32 m0, s28, 29696
  s_nop 0
  buffer_load_dwordx4 v144, s[8:11], s17 offen lds
  s_add_u32 s17, s17, s29
  s_add_u32 m0, s28, 30720
  s_nop 0
  buffer_load_dwordx4 v144, s[8:11], s17 offen lds
  s_add_u32 s17, s17, s29
  s_add_u32 m0, s28, 31744
  s_nop 0
  buffer_load_dwordx4 v144, s[8:11], s17 offen lds
  s_add_u32 s17, s17, s29
  s_waitcnt vmcnt(28)
  ds_read_b64_tr_b16 a[128:129], v152 offset:0
  ds_read_b64_tr_b16 a[130:131], v153 offset:0
  ds_read_b64_tr_b16 a[132:133], v154 offset:0
  ds_read_b64_tr_b16 a[134:135], v155 offset:0
  ds_read_b64_tr_b16 a[136:137], v152 offset:64
  ds_read_b64_tr_b16 a[138:139], v153 offset:64
  ds_read_b64_tr_b16 a[140:141], v154 offset:64
  ds_read_b64_tr_b16 a[142:143], v155 offset:64
  s_waitcnt lgkmcnt(0)
  s_waitcnt vmcnt(24)
  ds_read_b64_tr_b16 a[144:145], v152 offset:4096
  ds_read_b64_tr_b16 a[146:147], v153 offset:4096
  ds_read_b64_tr_b16 a[148:149], v154 offset:4096
  ds_read_b64_tr_b16 a[150:151], v155 offset:4096
  ds_read_b64_tr_b16 a[152:153], v152 offset:4160
  ds_read_b64_tr_b16 a[154:155], v153 offset:4160
  ds_read_b64_tr_b16 a[156:157], v154 offset:4160
  ds_read_b64_tr_b16 a[158:159], v155 offset:4160
  s_waitcnt lgkmcnt(0)
  s_waitcnt vmcnt(20)
  ds_read_b64_tr_b16 a[160:161], v152 offset:8192
  ds_read_b64_tr_b16 a[162:163], v153 offset:8192
  ds_read_b64_tr_b16 a[164:165], v154 offset:8192
  ds_read_b64_tr_b16 a[166:167], v155 offset:8192
  ds_read_b64_tr_b16 a[168:169], v152 offset:8256
  ds_read_b64_tr_b16 a[170:171], v153 offset:8256
  ds_read_b64_tr_b16 a[172:173], v154 offset:8256
  ds_read_b64_tr_b16 a[174:175], v155 offset:8256
  s_waitcnt lgkmcnt(0)
  s_waitcnt vmcnt(16)
  ds_read_b64_tr_b16 a[176:177], v152 offset:12288
  ds_read_b64_tr_b16 a[178:179], v153 offset:12288
  ds_read_b64_tr_b16 a[180:181], v154 offset:12288
  ds_read_b64_tr_b16 a[182:183], v155 offset:12288
  ds_read_b64_tr_b16 a[184:185], v152 offset:12352
  ds_read_b64_tr_b16 a[186:187], v153 offset:12352
  ds_read_b64_tr_b16 a[188:189], v154 offset:12352
  ds_read_b64_tr_b16 a[190:191], v155 offset:12352
  s_waitcnt lgkmcnt(0)
  s_waitcnt vmcnt(12)
  ds_read_b64_tr_b16 a[192:193], v152 offset:16384
  ds_read_b64_tr_b16 a[194:195], v153 offset:16384
  ds_read_b64_tr_b16 a[196:197], v154 offset:16384
  ds_read_b64_tr_b16 a[198:199], v155 offset:16384
  ds_read_b64_tr_b16 a[200:201], v152 offset:16448
  ds_read_b64_tr_b16 a[202:203], v153 offset:16448
  ds_read_b64_tr_b16 a[204:205], v154 offset:16448
  ds_read_b64_tr_b16 a[206:207], v155 offset:16448
  s_waitcnt lgkmcnt(0)
  s_waitcnt vmcnt(8)
  ds_read_b64_tr_b16 a[208:209], v152 offset:20480
  ds_read_b64_tr_b16 a[210:211], v153 offset:20480
  ds_read_b64_tr_b16 a[212:213], v154 offset:20480
  ds_read_b64_tr_b16 a[214:215], v155 offset:20480
  ds_read_b64_tr_b16 a[216:217], v152 offset:20544
  ds_read_b64_tr_b16 a[218:219], v153 offset:20544
  ds_read_b64_tr_b16 a[220:221], v154 offset:20544
  ds_read_b64_tr_b16 a[222:223], v155 offset:20544
  s_waitcnt lgkmcnt(0)
  s_waitcnt vmcnt(4)
  ds_read_b64_tr_b16 a[224:225], v152 offset:24576
  ds_read_b64_tr_b16 a[226:227], v153 offset:24576
  ds_read_b64_tr_b16 a[228:229], v154 offset:24576
  ds_read_b64_tr_b16 a[230:231], v155 offset:24576
  ds_read_b64_tr_b16 a[232:233], v152 offset:24640
  ds_read_b64_tr_b16 a[234:235], v153 offset:24640
  ds_read_b64_tr_b16 a[236:237], v154 offset:24640
  ds_read_b64_tr_b16 a[238:239], v155 offset:24640
  s_waitcnt lgkmcnt(0)
  s_waitcnt vmcnt(0)
  ds_read_b64_tr_b16 a[240:241], v152 offset:28672
  ds_read_b64_tr_b16 a[242:243], v153 offset:28672
  ds_read_b64_tr_b16 a[244:245], v154 offset:28672
  ds_read_b64_tr_b16 a[246:247], v155 offset:28672
  ds_read_b64_tr_b16 a[248:249], v152 offset:28736
  ds_read_b64_tr_b16 a[250:251], v153 offset:28736
  ds_read_b64_tr_b16 a[252:253], v154 offset:28736
  ds_read_b64_tr_b16 a[254:255], v155 offset:28736
  s_waitcnt lgkmcnt(0)
  v_min_u32 v4, 27, v1
  v_mul_u32_u24 v5, 37, v4
  v_lshrrev_b32 v5, 8, v5
  v_mul_u32_u24 v5, 7, v5
  v_sub_u32 v5, v4, v5
  v_mov_b32 v6, 0x200
  v_cmp_ne_u32 vcc, 6, v5
  s_mul_i32 s76, s48, 3584
  s_add_u32 s76, s76, 148897792
  v_cndmask_b32 v5, 0, v6, vcc
  v_lshl_add_u32 v4, v4, 7, s76
  s_mov_b32 s71, 0
  s_branch M_vg_177
M_vw_176:
  s_sleep 2
  s_add_u32 s71, s71, 1
  s_cmp_gt_u32 s71, 262144
  s_cbranch_scc1 M_exit
M_vg_177:
  buffer_load_dword v6, v4, s[4:7], 0 offen sc1
  s_waitcnt vmcnt(0)
  v_cmp_lt_u32 vcc, v6, v5
  s_cbranch_vccnz M_vw_176
  s_barrier
  s_lshl_b32 s25, s16, 13
  s_add_u32 m0, s25, 0
  s_nop 0
  buffer_load_dwordx4 v16, s[12:15], s19 offen sc1 lds
  s_add_u32 m0, s25, 1024
  s_nop 0
  buffer_load_dwordx4 v17, s[12:15], s19 offen sc1 lds
  s_add_u32 m0, s25, 2048
  s_nop 0
  buffer_load_dwordx4 v18, s[12:15], s19 offen sc1 lds
  s_add_u32 m0, s25, 3072
  s_nop 0
  buffer_load_dwordx4 v19, s[12:15], s19 offen sc1 lds
  s_add_u32 m0, s25, 4096
  s_nop 0
  buffer_load_dwordx4 v20, s[12:15], s19 offen sc1 lds
  s_add_u32 m0, s25, 5120
  s_nop 0
  buffer_load_dwordx4 v21, s[12:15], s19 offen sc1 lds
  s_add_u32 m0, s25, 6144
  s_nop 0
  buffer_load_dwordx4 v22, s[12:15], s19 offen sc1 lds
  s_add_u32 m0, s25, 7168
  s_nop 0
  buffer_load_dwordx4 v23, s[12:15], s19 offen sc1 lds
  s_cmp_gt_u32 s23, 1
  s_cselect_b32 s26, s20, 0
  s_add_u32 s19, s19, s26
  s_add_u32 s25, s25, 32768
  s_and_b32 s25, s25, 0x1ffff
  s_add_u32 m0, s25, 0
  s_nop 0
  buffer_load_dwordx4 v16, s[12:15], s19 offen sc1 lds
  s_add_u32 m0, s25, 1024
  s_nop 0
  buffer_load_dwordx4 v17, s[12:15], s19 offen sc1 lds
  s_add_u32 m0, s25, 2048
  s_nop 0
  buffer_load_dwordx4 v18, s[12:15], s19 offen sc1 lds
  s_add_u32 m0, s25, 3072
  s_nop 0
  buffer_load_dwordx4 v19, s[12:15], s19 offen sc1 lds
  s_add_u32 m0, s25, 4096
  s_nop 0
  buffer_load_dwordx4 v20, s[12:15], s19 offen sc1 lds
  s_add_u32 m0, s25, 5120
  s_nop 0
  buffer_load_dwordx4 v21, s[12:15], s19 offen sc1 lds
  s_add_u32 m0, s25, 6144
  s_nop 0
  buffer_load_dwordx4 v22, s[12:15], s19 offen sc1 lds
  s_add_u32 m0, s25, 7168
  s_nop 0
  buffer_load_dwordx4 v23, s[12:15], s19 offen sc1 lds
  s_cmp_gt_u32 s23, 2
  s_cselect_b32 s26, s20, 0
  s_add_u32 s19, s19, s26
  s_add_u32 s25, s25, 32768
  s_and_b32 s25, s25, 0x1ffff
  s_waitcnt vmcnt(0)
  s_barrier
  s_mov_b32 s27, s21
  v_mov_b32 v7, 0x40000000
  ds_read_b128 v[24:27], v8 offset:0
  ds_read_b128 v[28:31], v9 offset:0
  ds_read_b128 v[32:35], v10 offset:0
  ds_read_b128 v[36:39], v11 offset:0
  ds_read_b128 v[40:43], v12 offset:0
  ds_read_b128 v[44:47], v13 offset:0
.p2align 6
G_top_178:
  s_waitcnt lgkmcnt(5)
  v_mfma_f32_16x16x32_bf16 v[64:67], a[0:3], v[24:27], 0
  s_add_u32 m0, s25, 0
  ds_read_b128 v[48:51], v14 offset:0
  v_mfma_f32_16x16x32_bf16 v[68:71], a[4:7], v[24:27], 0
  v_mfma_f32_16x16x32_bf16 v[80:83], a[8:11], v[24:27], 0
  buffer_load_dwordx4 v16, s[12:15], s19 offen sc1 lds
  v_mfma_f32_16x16x32_bf16 v[84:87], a[12:15], v[24:27], 0
  s_waitcnt lgkmcnt(5)
  v_mfma_f32_16x16x32_bf16 v[72:75], a[0:3], v[28:31], 0
  ds_read_b128 v[52:55], v15 offset:0
  v_mfma_f32_16x16x32_bf16 v[76:79], a[4:7], v[28:31], 0
  v_cvt_pk_bf16_f32 v128, v96, v97
  v_cvt_pk_bf16_f32 v129, v98, v99
  v_mfma_f32_16x16x32_bf16 v[88:91], a[8:11], v[28:31], 0
  v_mfma_f32_16x16x32_bf16 v[92:95], a[12:15], v[28:31], 0
  s_waitcnt lgkmcnt(5)
  v_cvt_pk_bf16_f32 v130, v100, v101
  v_cvt_pk_bf16_f32 v131, v102, v103
  v_mfma_f32_16x16x32_bf16 v[64:67], a[16:19], v[32:35], v[64:67]
  s_add_u32 m0, s25, 1024
  ds_read_b128 v[24:27], v8 offset:8192
  v_mfma_f32_16x16x32_bf16 v[68:71], a[20:23], v[32:35], v[68:71]
  v_mfma_f32_16x16x32_bf16 v[80:83], a[24:27], v[32:35], v[80:83]
  buffer_load_dwordx4 v17, s[12:15], s19 offen sc1 lds
  v_mfma_f32_16x16x32_bf16 v[84:87], a[28:31], v[32:35], v[84:87]
  s_waitcnt lgkmcnt(5)
  v_mfma_f32_16x16x32_bf16 v[72:75], a[16:19], v[36:39], v[72:75]
  ds_read_b128 v[28:31], v9 offset:8192
  v_mfma_f32_16x16x32_bf16 v[76:79], a[20:23], v[36:39], v[76:79]
  v_mfma_f32_16x16x32_bf16 v[88:91], a[24:27], v[36:39], v[88:91]
  v_mfma_f32_16x16x32_bf16 v[92:95], a[28:31], v[36:39], v[92:95]
  s_waitcnt lgkmcnt(5)
  v_mfma_f32_16x16x32_bf16 v[64:67], a[32:35], v[40:43], v[64:67]
  s_add_u32 m0, s25, 2048
  ds_read_b128 v[32:35], v10 offset:8192
  v_mfma_f32_16x16x32_bf16 v[68:71], a[36:39], v[40:43], v[68:71]
  v_cvt_pk_bf16_f32 v132, v104, v105
  v_cvt_pk_bf16_f32 v133, v106, v107
  v_mfma_f32_16x16x32_bf16 v[80:83], a[40:43], v[40:43], v[80:83]
  buffer_load_dwordx4 v18, s[12:15], s19 offen sc1 lds
  v_mfma_f32_16x16x32_bf16 v[84:87], a[44:47], v[40:43], v[84:87]
  s_waitcnt lgkmcnt(5)
  v_cvt_pk_bf16_f32 v134, v108, v109
  v_cvt_pk_bf16_f32 v135, v110, v111
  v_mfma_f32_16x16x32_bf16 v[72:75], a[32:35], v[44:47], v[72:75]
  ds_read_b128 v[36:39], v11 offset:8192
  v_mfma_f32_16x16x32_bf16 v[76:79], a[36:39], v[44:47], v[76:79]
  v_mfma_f32_16x16x32_bf16 v[88:91], a[40:43], v[44:47], v[88:91]
  v_mfma_f32_16x16x32_bf16 v[92:95], a[44:47], v[44:47], v[92:95]
  s_waitcnt lgkmcnt(5)
  v_mfma_f32_16x16x32_bf16 v[64:67], a[48:51], v[48:51], v[64:67]
  s_add_u32 m0, s25, 3072
  ds_read_b128 v[40:43], v12 offset:8192
  v_mfma_f32_16x16x32_bf16 v[68:71], a[52:55], v[48:51], v[68:71]
  v_mfma_f32_16x16x32_bf16 v[80:83], a[56:59], v[48:51], v[80:83]
  buffer_load_dwordx4 v19, s[12:15], s19 offen sc1 lds
  v_mfma_f32_16x16x32_bf16 v[84:87], a[60:63], v[48:51], v[84:87]
  s_waitcnt lgkmcnt(5)
  v_mfma_f32_16x16x32_bf16 v[72:75], a[48:51], v[52:55], v[72:75]
  ds_read_b128 v[44:47], v13 offset:8192
  v_mfma_f32_16x16x32_bf16 v[76:79], a[52:55], v[52:55], v[76:79]
  v_cvt_pk_bf16_f32 v136, v112, v113
  v_cvt_pk_bf16_f32 v137, v114, v115
  v_mfma_f32_16x16x32_bf16 v[88:91], a[56:59], v[52:55], v[88:91]
  v_mfma_f32_16x16x32_bf16 v[92:95], a[60:63], v[52:55], v[92:95]
  s_waitcnt lgkmcnt(5)
  v_cvt_pk_bf16_f32 v138, v116, v117
  v_cvt_pk_bf16_f32 v139, v118, v119
  v_mfma_f32_16x16x32_bf16 v[64:67], a[64:67], v[24:27], v[64:67]
  s_add_u32 m0, s25, 4096
  ds_read_b128 v[48:51], v14 offset:8192
  v_mfma_f32_16x16x32_bf16 v[68:71], a[68:71], v[24:27], v[68:71]
  v_mfma_f32_16x16x32_bf16 v[80:83], a[72:75], v[24:27], v[80:83]
  buffer_load_dwordx4 v20, s[12:15], s19 offen sc1 lds
  v_mfma_f32_16x16x32_bf16 v[84:87], a[76:79], v[24:27], v[84:87]
  s_waitcnt lgkmcnt(5)
  v_mfma_f32_16x16x32_bf16 v[72:75], a[64:67], v[28:31], v[72:75]
  ds_read_b128 v[52:55], v15 offset:8192
  v_mfma_f32_16x16x32_bf16 v[76:79], a[68:71], v[28:31], v[76:79]
  v_mfma_f32_16x16x32_bf16 v[88:91], a[72:75], v[28:31], v[88:91]
  v_mfma_f32_16x16x32_bf16 v[92:95], a[76:79], v[28:31], v[92:95]
  s_waitcnt lgkmcnt(5)
  v_mfma_f32_16x16x32_bf16 v[64:67], a[80:83], v[32:35], v[64:67]
  s_add_u32 m0, s25, 5120
  ds_read_b128 v[24:27], v8 offset:16384
  v_mfma_f32_16x16x32_bf16 v[68:71], a[84:87], v[32:35], v[68:71]
  v_cvt_pk_bf16_f32 v140, v120, v121
  v_cvt_pk_bf16_f32 v141, v122, v123
  v_mfma_f32_16x16x32_bf16 v[80:83], a[88:91], v[32:35], v[80:83]
  buffer_load_dwordx4 v21, s[12:15], s19 offen sc1 lds
  v_mfma_f32_16x16x32_bf16 v[84:87], a[92:95], v[32:35], v[84:87]
  s_waitcnt lgkmcnt(5)
  v_cvt_pk_bf16_f32 v142, v124, v125
  v_cvt_pk_bf16_f32 v143, v126, v127
  v_mfma_f32_16x16x32_bf16 v[72:75], a[80:83], v[36:39], v[72:75]
  ds_read_b128 v[28:31], v9 offset:16384
  v_mfma_f32_16x16x32_bf16 v[76:79], a[84:87], v[36:39], v[76:79]
  v_mfma_f32_16x16x32_bf16 v[88:91], a[88:91], v[36:39], v[88:91]
  v_mfma_f32_16x16x32_bf16 v[92:95], a[92:95], v[36:39], v[92:95]
  s_waitcnt lgkmcnt(5)
  v_mfma_f32_16x16x32_bf16 v[64:67], a[96:99], v[40:43], v[64:67]
  s_add_u32 m0, s25, 6144
  ds_read_b128 v[32:35], v10 offset:16384
  v_mfma_f32_16x16x32_bf16 v[68:71], a[100:103], v[40:43], v[68:71]
  v_mfma_f32_16x16x32_bf16 v[80:83], a[104:107], v[40:43], v[80:83]
  buffer_load_dwordx4 v22, s[12:15], s19 offen sc1 lds
  v_mfma_f32_16x16x32_bf16 v[84:87], a[108:111], v[40:43], v[84:87]
  s_waitcnt lgkmcnt(5)
  v_mfma_f32_16x16x32_bf16 v[72:75], a[96:99], v[44:47], v[72:75]
  ds_read_b128 v[36:39], v11 offset:16384
  v_mfma_f32_16x16x32_bf16 v[76:79], a[100:103], v[44:47], v[76:79]
  v_mfma_f32_16x16x32_bf16 v[88:91], a[104:107], v[44:47], v[88:91]
  v_mfma_f32_16x16x32_bf16 v[92:95], a[108:111], v[44:47], v[92:95]
  s_waitcnt lgkmcnt(5)
  v_mfma_f32_16x16x32_bf16 v[64:67], a[112:115], v[48:51], v[64:67]
  s_add_u32 m0, s25, 7168
  ds_read_b128 v[40:43], v12 offset:16384
  v_mfma_f32_16x16x32_bf16 v[68:71], a[116:119], v[48:51], v[68:71]
  v_mfma_f32_16x16x32_bf16 v[80:83], a[120:123], v[48:51], v[80:83]
  buffer_load_dwordx4 v23, s[12:15], s19 offen sc1 lds
  v_mfma_f32_16x16x32_bf16 v[84:87], a[124:127], v[48:51], v[84:87]
  s_waitcnt lgkmcnt(5)
  v_mfma_f32_16x16x32_bf16 v[72:75], a[112:115], v[52:55], v[72:75]
  s_cmp_gt_u32 s23, 3
  ds_read_b128 v[44:47], v13 offset:16384
  v_mfma_f32_16x16x32_bf16 v[76:79], a[116:119], v[52:55], v[76:79]
  v_mfma_f32_16x16x32_bf16 v[88:91], a[120:123], v[52:55], v[88:91]
  s_cselect_b32 s26, s20, 0
  v_mfma_f32_16x16x32_bf16 v[92:95], a[124:127], v[52:55], v[92:95]
  s_waitcnt lgkmcnt(5)
  v_mfma_f32_16x16x32_bf16 v[64:67], a[128:131], v[24:27], v[64:67]
  s_add_u32 s19, s19, s26
  ds_read_b128 v[48:51], v14 offset:16384
  v_mfma_f32_16x16x32_bf16 v[68:71], a[132:135], v[24:27], v[68:71]
  v_mfma_f32_16x16x32_bf16 v[80:83], a[136:139], v[24:27], v[80:83]
  s_add_u32 s25, s25, 32768
  v_mfma_f32_16x16x32_bf16 v[84:87], a[140:143], v[24:27], v[84:87]
  s_waitcnt lgkmcnt(5)
  v_mfma_f32_16x16x32_bf16 v[72:75], a[128:131], v[28:31], v[72:75]
  s_and_b32 s25, s25, 0x1ffff
  ds_read_b128 v[52:55], v15 offset:16384
  v_mfma_f32_16x16x32_bf16 v[76:79], a[132:135], v[28:31], v[76:79]
  v_mfma_f32_16x16x32_bf16 v[88:91], a[136:139], v[28:31], v[88:91]
  buffer_store_dwordx4 v[128:131], v7, s[4:7], s21 offen offset:0 sc1
  v_mfma_f32_16x16x32_bf16 v[92:95], a[140:143], v[28:31], v[92:95]
  s_waitcnt lgkmcnt(5)
  v_mfma_f32_16x16x32_bf16 v[64:67], a[144:147], v[32:35], v[64:67]
  ds_read_b128 v[24:27], v8 offset:24576
  v_mfma_f32_16x16x32_bf16 v[68:71], a[148:151], v[32:35], v[68:71]
  v_mfma_f32_16x16x32_bf16 v[80:83], a[152:155], v[32:35], v[80:83]
  v_mfma_f32_16x16x32_bf16 v[84:87], a[156:159], v[32:35], v[84:87]
  s_waitcnt lgkmcnt(5)
  v_mfma_f32_16x16x32_bf16 v[72:75], a[144:147], v[36:39], v[72:75]
  ds_read_b128 v[28:31], v9 offset:24576
  v_mfma_f32_16x16x32_bf16 v[76:79], a[148:151], v[36:39], v[76:79]
  v_mfma_f32_16x16x32_bf16 v[88:91], a[152:155], v[36:39], v[88:91]
  buffer_store_dwordx4 v[132:135], v7, s[4:7], s21 offen offset:256 sc1
  v_mfma_f32_16x16x32_bf16 v[92:95], a[156:159], v[36:39], v[92:95]
  s_waitcnt lgkmcnt(5)
  v_mfma_f32_16x16x32_bf16 v[64:67], a[160:163], v[40:43], v[64:67]
  ds_read_b128 v[32:35], v10 offset:24576
  v_mfma_f32_16x16x32_bf16 v[68:71], a[164:167], v[40:43], v[68:71]
  v_mfma_f32_16x16x32_bf16 v[80:83], a[168:171], v[40:43], v[80:83]
  v_mfma_f32_16x16x32_bf16 v[84:87], a[172:175], v[40:43], v[84:87]
  s_waitcnt lgkmcnt(5)
  v_mfma_f32_16x16x32_bf16 v[72:75], a[160:163], v[44:47], v[72:75]
  ds_read_b128 v[36:39], v11 offset:24576
  v_mfma_f32_16x16x32_bf16 v[76:79], a[164:167], v[44:47], v[76:79]
  v_mfma_f32_16x16x32_bf16 v[88:91], a[168:171], v[44:47], v[88:91]
  buffer_store_dwordx4 v[136:139], v7, s[4:7], s21 offen offset:2048 sc1
  v_mfma_f32_16x16x32_bf16 v[92:95], a[172:175], v[44:47], v[92:95]
  s_waitcnt lgkmcnt(5)
  v_mfma_f32_16x16x32_bf16 v[64:67], a[176:179], v[48:51], v[64:67]
  ds_read_b128 v[40:43], v12 offset:24576
  v_mfma_f32_16x16x32_bf16 v[68:71], a[180:183], v[48:51], v[68:71]
  v_mfma_f32_16x16x32_bf16 v[80:83], a[184:187], v[48:51], v[80:83]
  v_mfma_f32_16x16x32_bf16 v[84:87], a[188:191], v[48:51], v[84:87]
  s_waitcnt lgkmcnt(5)
  v_mfma_f32_16x16x32_bf16 v[72:75], a[176:179], v[52:55], v[72:75]
  ds_read_b128 v[44:47], v13 offset:24576
  v_mfma_f32_16x16x32_bf16 v[76:79], a[180:183], v[52:55], v[76:79]
  v_mfma_f32_16x16x32_bf16 v[88:91], a[184:187], v[52:55], v[88:91]
  buffer_store_dwordx4 v[140:143], v7, s[4:7], s21 offen offset:2304 sc1
  v_mfma_f32_16x16x32_bf16 v[92:95], a[188:191], v[52:55], v[92:95]
  s_waitcnt lgkmcnt(5)
  v_mfma_f32_16x16x32_bf16 v[64:67], a[192:195], v[24:27], v[64:67]
  s_mov_b32 s21, s27
  ds_read_b128 v[48:51], v14 offset:24576
  v_mfma_f32_16x16x32_bf16 v[68:71], a[196:199], v[24:27], v[68:71]
  v_mov_b32 v7, v56
  v_mfma_f32_16x16x32_bf16 v[80:83], a[200:203], v[24:27], v[80:83]
  v_mfma_f32_16x16x32_bf16 v[84:87], a[204:207], v[24:27], v[84:87]
  s_waitcnt lgkmcnt(5)
  v_mfma_f32_16x16x32_bf16 v[72:75], a[192:195], v[28:31], v[72:75]
  s_add_u32 s27, s27, s22
  ds_read_b128 v[52:55], v15 offset:24576
  v_mfma_f32_16x16x32_bf16 v[76:79], a[196:199], v[28:31], v[76:79]
  v_mfma_f32_16x16x32_bf16 v[88:91], a[200:203], v[28:31], v[88:91]
  s_waitcnt vmcnt(16)
  s_barrier
  v_mfma_f32_16x16x32_bf16 v[92:95], a[204:207], v[28:31], v[92:95]
  s_waitcnt lgkmcnt(5)
  v_mfma_f32_16x16x32_bf16 v[64:67], a[208:211], v[32:35], v[64:67]
  ds_read_b128 v[24:27], v8 offset:32768
  v_mfma_f32_16x16x32_bf16 v[68:71], a[212:215], v[32:35], v[68:71]
  v_mfma_f32_16x16x32_bf16 v[80:83], a[216:219], v[32:35], v[80:83]
  v_mfma_f32_16x16x32_bf16 v[84:87], a[220:223], v[32:35], v[84:87]
  s_waitcnt lgkmcnt(5)
  v_mfma_f32_16x16x32_bf16 v[72:75], a[208:211], v[36:39], v[72:75]
  ds_read_b128 v[28:31], v9 offset:32768
  v_mfma_f32_16x16x32_bf16 v[76:79], a[212:215], v[36:39], v[76:79]
  v_mfma_f32_16x16x32_bf16 v[88:91], a[216:219], v[36:39], v[88:91]
  v_mfma_f32_16x16x32_bf16 v[92:95], a[220:223], v[36:39], v[92:95]
  s_waitcnt lgkmcnt(5)
  v_mfma_f32_16x16x32_bf16 v[64:67], a[224:227], v[40:43], v[64:67]
  ds_read_b128 v[32:35], v10 offset:32768
  v_mfma_f32_16x16x32_bf16 v[68:71], a[228:231], v[40:43], v[68:71]
  v_mfma_f32_16x16x32_bf16 v[80:83], a[232:235], v[40:43], v[80:83]
  v_mfma_f32_16x16x32_bf16 v[84:87], a[236:239], v[40:43], v[84:87]
  s_waitcnt lgkmcnt(5)
  v_mfma_f32_16x16x32_bf16 v[72:75], a[224:227], v[44:47], v[72:75]
  ds_read_b128 v[36:39], v11 offset:32768
  v_mfma_f32_16x16x32_bf16 v[76:79], a[228:231], v[44:47], v[76:79]
  v_mfma_f32_16x16x32_bf16 v[88:91], a[232:235], v[44:47], v[88:91]
  v_mfma_f32_16x16x32_bf16 v[92:95], a[236:239], v[44:47], v[92:95]
  s_waitcnt lgkmcnt(5)
  v_mfma_f32_16x16x32_bf16 v[64:67], a[240:243], v[48:51], v[64:67]
  s_sub_u32 s23, s23, 1
  ds_read_b128 v[40:43], v12 offset:32768
  v_mfma_f32_16x16x32_bf16 v[68:71], a[244:247], v[48:51], v[68:71]
  v_mfma_f32_16x16x32_bf16 v[80:83], a[248:251], v[48:51], v[80:83]
  v_mfma_f32_16x16x32_bf16 v[84:87], a[252:255], v[48:51], v[84:87]
  s_waitcnt lgkmcnt(5)
  v_mfma_f32_16x16x32_bf16 v[72:75], a[240:243], v[52:55], v[72:75]
  s_cmp_eq_u32 s23, 0
  ds_read_b128 v[44:47], v13 offset:32768
  v_mfma_f32_16x16x32_bf16 v[76:79], a[244:247], v[52:55], v[76:79]
  v_mfma_f32_16x16x32_bf16 v[88:91], a[248:251], v[52:55], v[88:91]
  v_mfma_f32_16x16x32_bf16 v[92:95], a[252:255], v[52:55], v[92:95]
  s_cbranch_scc1 G_done0_179
  s_waitcnt lgkmcnt(5)
  v_mfma_f32_16x16x32_bf16 v[96:99], a[0:3], v[24:27], 0
  s_add_u32 m0, s25, 0
  ds_read_b128 v[48:51], v14 offset:32768
  v_mfma_f32_16x16x32_bf16 v[100:103], a[4:7], v[24:27], 0
  v_mfma_f32_16x16x32_bf16 v[112:115], a[8:11], v[24:27], 0
  buffer_load_dwordx4 v16, s[12:15], s19 offen sc1 lds
  v_mfma_f32_16x16x32_bf16 v[116:119], a[12:15], v[24:27], 0
  s_waitcnt lgkmcnt(5)
  v_mfma_f32_16x16x32_bf16 v[104:107], a[0:3], v[28:31], 0
  ds_read_b128 v[52:55], v15 offset:32768
  v_mfma_f32_16x16x32_bf16 v[108:111], a[4:7], v[28:31], 0
  v_cvt_pk_bf16_f32 v128, v64, v65
  v_cvt_pk_bf16_f32 v129, v66, v67
  v_mfma_f32_16x16x32_bf16 v[120:123], a[8:11], v[28:31], 0
  v_mfma_f32_16x16x32_bf16 v[124:127], a[12:15], v[28:31], 0
  s_waitcnt lgkmcnt(5)
  v_cvt_pk_bf16_f32 v130, v68, v69
  v_cvt_pk_bf16_f32 v131, v70, v71
  v_mfma_f32_16x16x32_bf16 v[96:99], a[16:19], v[32:35], v[96:99]
  s_add_u32 m0, s25, 1024
  ds_read_b128 v[24:27], v8 offset:40960
  v_mfma_f32_16x16x32_bf16 v[100:103], a[20:23], v[32:35], v[100:103]
  v_mfma_f32_16x16x32_bf16 v[112:115], a[24:27], v[32:35], v[112:115]
  buffer_load_dwordx4 v17, s[12:15], s19 offen sc1 lds
  v_mfma_f32_16x16x32_bf16 v[116:119], a[28:31], v[32:35], v[116:119]
  s_waitcnt lgkmcnt(5)
  v_mfma_f32_16x16x32_bf16 v[104:107], a[16:19], v[36:39], v[104:107]
  ds_read_b128 v[28:31], v9 offset:40960
  v_mfma_f32_16x16x32_bf16 v[108:111], a[20:23], v[36:39], v[108:111]
  v_mfma_f32_16x16x32_bf16 v[120:123], a[24:27], v[36:39], v[120:123]
  v_mfma_f32_16x16x32_bf16 v[124:127], a[28:31], v[36:39], v[124:127]
  s_waitcnt lgkmcnt(5)
  v_mfma_f32_16x16x32_bf16 v[96:99], a[32:35], v[40:43], v[96:99]
  s_add_u32 m0, s25, 2048
  ds_read_b128 v[32:35], v10 offset:40960
  v_mfma_f32_16x16x32_bf16 v[100:103], a[36:39], v[40:43], v[100:103]
  v_cvt_pk_bf16_f32 v132, v72, v73
  v_cvt_pk_bf16_f32 v133, v74, v75
  v_mfma_f32_16x16x32_bf16 v[112:115], a[40:43], v[40:43], v[112:115]
  buffer_load_dwordx4 v18, s[12:15], s19 offen sc1 lds
  v_mfma_f32_16x16x32_bf16 v[116:119], a[44:47], v[40:43], v[116:119]
  s_waitcnt lgkmcnt(5)
  v_cvt_pk_bf16_f32 v134, v76, v77
  v_cvt_pk_bf16_f32 v135, v78, v79
  v_mfma_f32_16x16x32_bf16 v[104:107], a[32:35], v[44:47], v[104:107]
  ds_read_b128 v[36:39], v11 offset:40960
  v_mfma_f32_16x16x32_bf16 v[108:111], a[36:39], v[44:47], v[108:111]
  v_mfma_f32_16x16x32_bf16 v[120:123], a[40:43], v[44:47], v[120:123]
  v_mfma_f32_16x16x32_bf16 v[124:127], a[44:47], v[44:47], v[124:127]
  s_waitcnt lgkmcnt(5)
  v_mfma_f32_16x16x32_bf16 v[96:99], a[48:51], v[48:51], v[96:99]
  s_add_u32 m0, s25, 3072
  ds_read_b128 v[40:43], v12 offset:40960
  v_mfma_f32_16x16x32_bf16 v[100:103], a[52:55], v[48:51], v[100:103]
  v_mfma_f32_16x16x32_bf16 v[112:115], a[56:59], v[48:51], v[112:115]
  buffer_load_dwordx4 v19, s[12:15], s19 offen sc1 lds
  v_mfma_f32_16x16x32_bf16 v[116:119], a[60:63], v[48:51], v[116:119]
  s_waitcnt lgkmcnt(5)
  v_mfma_f32_16x16x32_bf16 v[104:107], a[48:51], v[52:55], v[104:107]
  ds_read_b128 v[44:47], v13 offset:40960
  v_mfma_f32_16x16x32_bf16 v[108:111], a[52:55], v[52:55], v[108:111]
  v_cvt_pk_bf16_f32 v136, v80, v81
  v_cvt_pk_bf16_f32 v137, v82, v83
  v_mfma_f32_16x16x32_bf16 v[120:123], a[56:59], v[52:55], v[120:123]
  v_mfma_f32_16x16x32_bf16 v[124:127], a[60:63], v[52:55], v[124:127]
  s_waitcnt lgkmcnt(5)
  v_cvt_pk_bf16_f32 v138, v84, v85
  v_cvt_pk_bf16_f32 v139, v86, v87
  v_mfma_f32_16x16x32_bf16 v[96:99], a[64:67], v[24:27], v[96:99]
  s_add_u32 m0, s25, 4096
  ds_read_b128 v[48:51], v14 offset:40960
  v_mfma_f32_16x16x32_bf16 v[100:103], a[68:71], v[24:27], v[100:103]
  v_mfma_f32_16x16x32_bf16 v[112:115], a[72:75], v[24:27], v[112:115]
  buffer_load_dwordx4 v20, s[12:15], s19 offen sc1 lds
  v_mfma_f32_16x16x32_bf16 v[116:119], a[76:79], v[24:27], v[116:119]
  s_waitcnt lgkmcnt(5)
  v_mfma_f32_16x16x32_bf16 v[104:107], a[64:67], v[28:31], v[104:107]
  ds_read_b128 v[52:55], v15 offset:40960
  v_mfma_f32_16x16x32_bf16 v[108:111], a[68:71], v[28:31], v[108:111]
  v_mfma_f32_16x16x32_bf16 v[120:123], a[72:75], v[28:31], v[120:123]
  v_mfma_f32_16x16x32_bf16 v[124:127], a[76:79], v[28:31], v[124:127]
  s_waitcnt lgkmcnt(5)
  v_mfma_f32_16x16x32_bf16 v[96:99], a[80:83], v[32:35], v[96:99]
  s_add_u32 m0, s25, 5120
  ds_read_b128 v[24:27], v8 offset:49152
  v_mfma_f32_16x16x32_bf16 v[100:103], a[84:87], v[32:35], v[100:103]
  v_cvt_pk_bf16_f32 v140, v88, v89
  v_cvt_pk_bf16_f32 v141, v90, v91
  v_mfma_f32_16x16x32_bf16 v[112:115], a[88:91], v[32:35], v[112:115]
  buffer_load_dwordx4 v21, s[12:15], s19 offen sc1 lds
  v_mfma_f32_16x16x32_bf16 v[116:119], a[92:95], v[32:35], v[116:119]
  s_waitcnt lgkmcnt(5)
  v_cvt_pk_bf16_f32 v142, v92, v93
  v_cvt_pk_bf16_f32 v143, v94, v95
  v_mfma_f32_16x16x32_bf16 v[104:107], a[80:83], v[36:39], v[104:107]
  ds_read_b128 v[28:31], v9 offset:49152
  v_mfma_f32_16x16x32_bf16 v[108:111], a[84:87], v[36:39], v[108:111]
  v_mfma_f32_16x16x32_bf16 v[120:123], a[88:91], v[36:39], v[120:123]
  v_mfma_f32_16x16x32_bf16 v[124:127], a[92:95], v[36:39], v[124:127]
  s_waitcnt lgkmcnt(5)
  v_mfma_f32_16x16x32_bf16 v[96:99], a[96:99], v[40:43], v[96:99]
  s_add_u32 m0, s25, 6144
  ds_read_b128 v[32:35], v10 offset:49152
  v_mfma_f32_16x16x32_bf16 v[100:103], a[100:103], v[40:43], v[100:103]
  v_mfma_f32_16x16x32_bf16 v[112:115], a[104:107], v[40:43], v[112:115]
  buffer_load_dwordx4 v22, s[12:15], s19 offen sc1 lds
  v_mfma_f32_16x16x32_bf16 v[116:119], a[108:111], v[40:43], v[116:119]
  s_waitcnt lgkmcnt(5)
  v_mfma_f32_16x16x32_bf16 v[104:107], a[96:99], v[44:47], v[104:107]
  ds_read_b128 v[36:39], v11 offset:49152
  v_mfma_f32_16x16x32_bf16 v[108:111], a[100:103], v[44:47], v[108:111]
  v_mfma_f32_16x16x32_bf16 v[120:123], a[104:107], v[44:47], v[120:123]
  v_mfma_f32_16x16x32_bf16 v[124:127], a[108:111], v[44:47], v[124:127]
  s_waitcnt lgkmcnt(5)
  v_mfma_f32_16x16x32_bf16 v[96:99], a[112:115], v[48:51], v[96:99]
  s_add_u32 m0, s25, 7168
  ds_read_b128 v[40:43], v12 offset:49152
  v_mfma_f32_16x16x32_bf16 v[100:103], a[116:119], v[48:51], v[100:103]
  v_mfma_f32_16x16x32_bf16 v[112:115], a[120:123], v[48:51], v[112:115]
  buffer_load_dwordx4 v23, s[12:15], s19 offen sc1 lds
  v_mfma_f32_16x16x32_bf16 v[116:119], a[124:127], v[48:51], v[116:119]
  s_waitcnt lgkmcnt(5)
  v_mfma_f32_16x16x32_bf16 v[104:107], a[112:115], v[52:55], v[104:107]
  s_cmp_gt_u32 s23, 3
  ds_read_b128 v[44:47], v13 offset:49152
  v_mfma_f32_16x16x32_bf16 v[108:111], a[116:119], v[52:55], v[108:111]
  v_mfma_f32_16x16x32_bf16 v[120:123], a[120:123], v[52:55], v[120:123]
  s_cselect_b32 s26, s20, 0
  v_mfma_f32_16x16x32_bf16 v[124:127], a[124:127], v[52:55], v[124:127]
  s_waitcnt lgkmcnt(5)
  v_mfma_f32_16x16x32_bf16 v[96:99], a[128:131], v[24:27], v[96:99]
  s_add_u32 s19, s19, s26
  ds_read_b128 v[48:51], v14 offset:49152
  v_mfma_f32_16x16x32_bf16 v[100:103], a[132:135], v[24:27], v[100:103]
  v_mfma_f32_16x16x32_bf16 v[112:115], a[136:139], v[24:27], v[112:115]
  s_add_u32 s25, s25, 32768
  v_mfma_f32_16x16x32_bf16 v[116:119], a[140:143], v[24:27], v[116:119]
  s_waitcnt lgkmcnt(5)
  v_mfma_f32_16x16x32_bf16 v[104:107], a[128:131], v[28:31], v[104:107]
  s_and_b32 s25, s25, 0x1ffff
  ds_read_b128 v[52:55], v15 offset:49152
  v_mfma_f32_16x16x32_bf16 v[108:111], a[132:135], v[28:31], v[108:111]
  v_mfma_f32_16x16x32_bf16 v[120:123], a[136:139], v[28:31], v[120:123]
  buffer_store_dwordx4 v[128:131], v7, s[4:7], s21 offen offset:0 sc1
  v_mfma_f32_16x16x32_bf16 v[124:127], a[140:143], v[28:31], v[124:127]
  s_waitcnt lgkmcnt(5)
  v_mfma_f32_16x16x32_bf16 v[96:99], a[144:147], v[32:35], v[96:99]
  ds_read_b128 v[24:27], v8 offset:57344
  v_mfma_f32_16x16x32_bf16 v[100:103], a[148:151], v[32:35], v[100:103]
  v_mfma_f32_16x16x32_bf16 v[112:115], a[152:155], v[32:35], v[112:115]
  v_mfma_f32_16x16x32_bf16 v[116:119], a[156:159], v[32:35], v[116:119]
  s_waitcnt lgkmcnt(5)
  v_xor_b32 v8, 0x10000, v8
  v_mfma_f32_16x16x32_bf16 v[104:107], a[144:147], v[36:39], v[104:107]
  ds_read_b128 v[28:31], v9 offset:57344
  v_mfma_f32_16x16x32_bf16 v[108:111], a[148:151], v[36:39], v[108:111]
  v_mfma_f32_16x16x32_bf16 v[120:123], a[152:155], v[36:39], v[120:123]
  buffer_store_dwordx4 v[132:135], v7, s[4:7], s21 offen offset:256 sc1
  v_mfma_f32_16x16x32_bf16 v[124:127], a[156:159], v[36:39], v[124:127]
  s_waitcnt lgkmcnt(5)
  v_xor_b32 v9, 0x10000, v9
  v_mfma_f32_16x16x32_bf16 v[96:99], a[160:163], v[40:43], v[96:99]
  ds_read_b128 v[32:35], v10 offset:57344
  v_mfma_f32_16x16x32_bf16 v[100:103], a[164:167], v[40:43], v[100:103]
  v_mfma_f32_16x16x32_bf16 v[112:115], a[168:171], v[40:43], v[112:115]
  v_mfma_f32_16x16x32_bf16 v[116:119], a[172:175], v[40:43], v[116:119]
  s_waitcnt lgkmcnt(5)
  v_xor_b32 v10, 0x10000, v10
  v_mfma_f32_16x16x32_bf16 v[104:107], a[160:163], v[44:47], v[104:107]
  ds_read_b128 v[36:39], v11 offset:57344
  v_mfma_f32_16x16x32_bf16 v[108:111], a[164:167], v[44:47], v[108:111]
  v_mfma_f32_16x16x32_bf16 v[120:123], a[168:171], v[44:47], v[120:123]
  buffer_store_dwordx4 v[136:139], v7, s[4:7], s21 offen offset:2048 sc1
  v_mfma_f32_16x16x32_bf16 v[124:127], a[172:175], v[44:47], v[124:127]
  s_waitcnt lgkmcnt(5)
  v_xor_b32 v11, 0x10000, v11
  v_mfma_f32_16x16x32_bf16 v[96:99], a[176:179], v[48:51], v[96:99]
  ds_read_b128 v[40:43], v12 offset:57344
  v_mfma_f32_16x16x32_bf16 v[100:103], a[180:183], v[48:51], v[100:103]
  v_mfma_f32_16x16x32_bf16 v[112:115], a[184:187], v[48:51], v[112:115]
  v_mfma_f32_16x16x32_bf16 v[116:119], a[188:191], v[48:51], v[116:119]
  s_waitcnt lgkmcnt(5)
  v_xor_b32 v12, 0x10000, v12
  v_mfma_f32_16x16x32_bf16 v[104:107], a[176:179], v[52:55], v[104:107]
  ds_read_b128 v[44:47], v13 offset:57344
  v_mfma_f32_16x16x32_bf16 v[108:111], a[180:183], v[52:55], v[108:111]
  v_mfma_f32_16x16x32_bf16 v[120:123], a[184:187], v[52:55], v[120:123]
  buffer_store_dwordx4 v[140:143], v7, s[4:7], s21 offen offset:2304 sc1
  v_mfma_f32_16x16x32_bf16 v[124:127], a[188:191], v[52:55], v[124:127]
  s_waitcnt lgkmcnt(5)
  v_xor_b32 v13, 0x10000, v13
  v_mfma_f32_16x16x32_bf16 v[96:99], a[192:195], v[24:27], v[96:99]
  s_mov_b32 s21, s27
  ds_read_b128 v[48:51], v14 offset:57344
  v_mfma_f32_16x16x32_bf16 v[100:103], a[196:199], v[24:27], v[100:103]
  v_mov_b32 v7, v56
  v_mfma_f32_16x16x32_bf16 v[112:115], a[200:203], v[24:27], v[112:115]
  v_mfma_f32_16x16x32_bf16 v[116:119], a[204:207], v[24:27], v[116:119]
  s_waitcnt lgkmcnt(5)
  v_xor_b32 v14, 0x10000, v14
  v_mfma_f32_16x16x32_bf16 v[104:107], a[192:195], v[28:31], v[104:107]
  s_add_u32 s27, s27, s22
  ds_read_b128 v[52:55], v15 offset:57344
  v_mfma_f32_16x16x32_bf16 v[108:111], a[196:199], v[28:31], v[108:111]
  v_mfma_f32_16x16x32_bf16 v[120:123], a[200:203], v[28:31], v[120:123]
  s_waitcnt vmcnt(16)
  s_barrier
  v_mfma_f32_16x16x32_bf16 v[124:127], a[204:207], v[28:31], v[124:127]
  s_waitcnt lgkmcnt(5)
  v_xor_b32 v15, 0x10000, v15
  v_mfma_f32_16x16x32_bf16 v[96:99], a[208:211], v[32:35], v[96:99]
  ds_read_b128 v[24:27], v8 offset:0
  v_mfma_f32_16x16x32_bf16 v[100:103], a[212:215], v[32:35], v[100:103]
  v_mfma_f32_16x16x32_bf16 v[112:115], a[216:219], v[32:35], v[112:115]
  v_mfma_f32_16x16x32_bf16 v[116:119], a[220:223], v[32:35], v[116:119]
  s_waitcnt lgkmcnt(5)
  v_mfma_f32_16x16x32_bf16 v[104:107], a[208:211], v[36:39], v[104:107]
  ds_read_b128 v[28:31], v9 offset:0
  v_mfma_f32_16x16x32_bf16 v[108:111], a[212:215], v[36:39], v[108:111]
  v_mfma_f32_16x16x32_bf16 v[120:123], a[216:219], v[36:39], v[120:123]
  v_mfma_f32_16x16x32_bf16 v[124:127], a[220:223], v[36:39], v[124:127]
  s_waitcnt lgkmcnt(5)
  v_mfma_f32_16x16x32_bf16 v[96:99], a[224:227], v[40:43], v[96:99]
  ds_read_b128 v[32:35], v10 offset:0
  v_mfma_f32_16x16x32_bf16 v[100:103], a[228:231], v[40:43], v[100:103]
  v_mfma_f32_16x16x32_bf16 v[112:115], a[232:235], v[40:43], v[112:115]
  v_mfma_f32_16x16x32_bf16 v[116:119], a[236:239], v[40:43], v[116:119]
  s_waitcnt lgkmcnt(5)
  v_mfma_f32_16x16x32_bf16 v[104:107], a[224:227], v[44:47], v[104:107]
  ds_read_b128 v[36:39], v11 offset:0
  v_mfma_f32_16x16x32_bf16 v[108:111], a[228:231], v[44:47], v[108:111]
  v_mfma_f32_16x16x32_bf16 v[120:123], a[232:235], v[44:47], v[120:123]
  v_mfma_f32_16x16x32_bf16 v[124:127], a[236:239], v[44:47], v[124:127]
  s_waitcnt lgkmcnt(5)
  v_mfma_f32_16x16x32_bf16 v[96:99], a[240:243], v[48:51], v[96:99]
  s_sub_u32 s23, s23, 1
  ds_read_b128 v[40:43], v12 offset:0
  v_mfma_f32_16x16x32_bf16 v[100:103], a[244:247], v[48:51], v[100:103]
  v_mfma_f32_16x16x32_bf16 v[112:115], a[248:251], v[48:51], v[112:115]
  v_mfma_f32_16x16x32_bf16 v[116:119], a[252:255], v[48:51], v[116:119]
  s_waitcnt lgkmcnt(5)
  v_mfma_f32_16x16x32_bf16 v[104:107], a[240:243], v[52:55], v[104:107]
  s_cmp_eq_u32 s23, 0
  ds_read_b128 v[44:47], v13 offset:0
  v_mfma_f32_16x16x32_bf16 v[108:111], a[244:247], v[52:55], v[108:111]
  v_mfma_f32_16x16x32_bf16 v[120:123], a[248:251], v[52:55], v[120:123]
  v_mfma_f32_16x16x32_bf16 v[124:127], a[252:255], v[52:55], v[124:127]
  s_cbranch_scc1 G_done1_180
  s_branch G_top_178
G_done0_179:
  s_nop 7
  s_nop 3
  v_cvt_pk_bf16_f32 v128, v64, v65
  v_cvt_pk_bf16_f32 v129, v66, v67
  v_cvt_pk_bf16_f32 v130, v68, v69
  v_cvt_pk_bf16_f32 v131, v70, v71
  buffer_store_dwordx4 v[128:131], v7, s[4:7], s21 offen offset:0 sc1
  v_cvt_pk_bf16_f32 v132, v72, v73
  v_cvt_pk_bf16_f32 v133, v74, v75
  v_cvt_pk_bf16_f32 v134, v76, v77
  v_cvt_pk_bf16_f32 v135, v78, v79
  buffer_store_dwordx4 v[132:135], v7, s[4:7], s21 offen offset:256 sc1
  v_cvt_pk_bf16_f32 v136, v80, v81
  v_cvt_pk_bf16_f32 v137, v82, v83
  v_cvt_pk_bf16_f32 v138, v84, v85
  v_cvt_pk_bf16_f32 v139, v86, v87
  buffer_store_dwordx4 v[136:139], v7, s[4:7], s21 offen offset:2048 sc1
  v_cvt_pk_bf16_f32 v140, v88, v89
  v_cvt_pk_bf16_f32 v141, v90, v91
  v_cvt_pk_bf16_f32 v142, v92, v93
  v_cvt_pk_bf16_f32 v143, v94, v95
  buffer_store_dwordx4 v[140:143], v7, s[4:7], s21 offen offset:2304 sc1
  s_branch G_fin_181
G_done1_180:
  s_nop 7
  s_nop 3
  v_cvt_pk_bf16_f32 v128, v96, v97
  v_cvt_pk_bf16_f32 v129, v98, v99
  v_cvt_pk_bf16_f32 v130, v100, v101
  v_cvt_pk_bf16_f32 v131, v102, v103
  buffer_store_dwordx4 v[128:131], v7, s[4:7], s21 offen offset:0 sc1
  v_cvt_pk_bf16_f32 v132, v104, v105
  v_cvt_pk_bf16_f32 v133, v106, v107
  v_cvt_pk_bf16_f32 v134, v108, v109
  v_cvt_pk_bf16_f32 v135, v110, v111
  buffer_store_dwordx4 v[132:135], v7, s[4:7], s21 offen offset:256 sc1
  v_cvt_pk_bf16_f32 v136, v112, v113
  v_cvt_pk_bf16_f32 v137, v114, v115
  v_cvt_pk_bf16_f32 v138, v116, v117
  v_cvt_pk_bf16_f32 v139, v118, v119
  buffer_store_dwordx4 v[136:139], v7, s[4:7], s21 offen offset:2048 sc1
  v_cvt_pk_bf16_f32 v140, v120, v121
  v_cvt_pk_bf16_f32 v141, v122, v123
  v_cvt_pk_bf16_f32 v142, v124, v125
  v_cvt_pk_bf16_f32 v143, v126, v127
  buffer_store_dwordx4 v[140:143], v7, s[4:7], s21 offen offset:2304 sc1
G_fin_181:
  s_waitcnt vmcnt(0) lgkmcnt(0)
  s_barrier
  s_waitcnt vmcnt(0)
  s_barrier
  s_mov_b32 s30, 768
  v_mov_b32 v144, s30
  v_min_u32 v145, 1, v0
  v_lshlrev_b32 v145, 30, v145
  buffer_store_dword v144, v145, s[4:7], s31 offen sc1
  s_mul_i32 s50, s64, 6
  s_add_u32 s50, s50, s65
  s_mul_i32 s76, s50, 21846
  s_lshr_b32 s76, s76, 16
  s_mul_i32 s77, s76, 3
  s_add_u32 s51, s50, 64
  s_cmp_eq_u32 s77, s50
  s_cselect_b32 s50, s76, s51
M_fin:
  s_lshr_b32 s48, s50, 2
  s_and_b32 s49, s50, 3
  s_load_dwordx2 s[8:9], s[0:1], 0
  s_load_dwordx2 s[12:13], s[0:1], 104
  s_load_dwordx2 s[32:33], s[0:1], 112
  v_and_b32 v4, 31, v1
  v_lshrrev_b32 v5, 5, v1
  v_lshlrev_b32 v5, 4, v5
  v_lshl_add_u32 v6, v4, 10, v5
  s_lshl_b32 s26, s16, 8
  s_lshl_b32 s27, s48, 15
  s_add_u32 s27, s27, s26
  s_waitcnt lgkmcnt(0)
  s_and_b32 s9, s9, 0xffff
  s_mov_b32 s10, 2097152
  s_mov_b32 s11, 0x20000
  s_and_b32 s13, s13, 0xffff
  s_mov_b32 s14, 1024
  s_mov_b32 s15, 0x20000
  s_and_b32 s33, s33, 0xffff
  s_mov_b32 s34, 2097152
  s_mov_b32 s35, 0x20000
  buffer_load_dwordx4 v[16:19], v6, s[8:11], s27 offen offset:0
  buffer_load_dwordx4 v[48:51], v5, s[12:15], s26 offen offset:0
  buffer_load_dwordx4 v[20:23], v6, s[8:11], s27 offen offset:32
  buffer_load_dwordx4 v[52:55], v5, s[12:15], s26 offen offset:32
  buffer_load_dwordx4 v[24:27], v6, s[8:11], s27 offen offset:64
  buffer_load_dwordx4 v[56:59], v5, s[12:15], s26 offen offset:64
  buffer_load_dwordx4 v[28:31], v6, s[8:11], s27 offen offset:96
  buffer_load_dwordx4 v[60:63], v5, s[12:15], s26 offen offset:96
  buffer_load_dwordx4 v[32:35], v6, s[8:11], s27 offen offset:128
  buffer_load_dwordx4 v[64:67], v5, s[12:15], s26 offen offset:128
  buffer_load_dwordx4 v[36:39], v6, s[8:11], s27 offen offset:160
  buffer_load_dwordx4 v[68:71], v5, s[12:15], s26 offen offset:160
  buffer_load_dwordx4 v[40:43], v6, s[8:11], s27 offen offset:192
  buffer_load_dwordx4 v[72:75], v5, s[12:15], s26 offen offset:192
  buffer_load_dwordx4 v[44:47], v6, s[8:11], s27 offen offset:224
  buffer_load_dwordx4 v[76:79], v5, s[12:15], s26 offen offset:224
  s_lshl_b32 s28, s48, 2
  s_add_u32 s28, s28, s49
  s_lshl_b32 s28, s28, 2
  s_add_u32 s28, s28, s16
  s_lshl_b32 s28, s28, 11
  s_waitcnt vmcnt(14)
  v_mfma_f32_32x32x16_bf16 v[80:95], v[48:51], v[16:19], 0
  s_waitcnt vmcnt(12)
  v_mfma_f32_32x32x16_bf16 v[80:95], v[52:55], v[20:23], v[80:95]
  s_waitcnt vmcnt(10)
  v_mfma_f32_32x32x16_bf16 v[80:95], v[56:59], v[24:27], v[80:95]
  s_waitcnt vmcnt(8)
  v_mfma_f32_32x32x16_bf16 v[80:95], v[60:63], v[28:31], v[80:95]
  s_waitcnt vmcnt(6)
  v_mfma_f32_32x32x16_bf16 v[80:95], v[64:67], v[32:35], v[80:95]
  s_waitcnt vmcnt(4)
  v_mfma_f32_32x32x16_bf16 v[80:95], v[68:71], v[36:39], v[80:95]
  s_waitcnt vmcnt(2)
  v_mfma_f32_32x32x16_bf16 v[80:95], v[72:75], v[40:43], v[80:95]
  s_waitcnt vmcnt(0)
  v_mfma_f32_32x32x16_bf16 v[80:95], v[76:79], v[44:47], v[80:95]
  s_mul_i32 s76, s48, 43
  s_lshr_b32 s76, s76, 9
  s_mul_i32 s76, s76, 12
  s_sub_u32 s76, s48, s76
  s_cmp_ge_u32 s76, 6
  s_addc_u32 s76, s76, 0
  s_and_b32 s77, s49, 2
  s_mul_i32 s77, s77, 7
  s_add_u32 s76, s76, s77
  v_mov_b32 v193, 0x300
  s_lshl_b32 s76, s76, 7
  s_add_u32 s76, s76, 148897792
  v_and_b32 v192, 7, v1
  v_mul_u32_u24 v192, 3584, v192
  v_add_u32 v192, s76, v192
  s_mov_b32 s71, 0
  s_branch M_vg_183
M_vw_182:
  s_sleep 2
  s_add_u32 s71, s71, 1
  s_cmp_gt_u32 s71, 262144
  s_cbranch_scc1 M_exit
M_vg_183:
  buffer_load_dword v194, v192, s[4:7], 0 offen sc1
  s_waitcnt vmcnt(0)
  v_cmp_lt_u32 vcc, v194, v193
  s_cbranch_vccnz M_vw_182
  s_add_u32 s29, s28, 150994944
  buffer_load_dwordx4 v[96:99], v2, s[4:7], s29 offen offset:0 sc1
  buffer_load_dwordx4 v[100:103], v2, s[4:7], s29 offen offset:1024 sc1
  s_add_u32 s29, s28, 153092096
  buffer_load_dwordx4 v[104:107], v2, s[4:7], s29 offen offset:0 sc1
  buffer_load_dwordx4 v[108:111], v2, s[4:7], s29 offen offset:1024 sc1
  s_add_u32 s29, s28, 155189248
  buffer_load_dwordx4 v[112:115], v2, s[4:7], s29 offen offset:0 sc1
  buffer_load_dwordx4 v[116:119], v2, s[4:7], s29 offen offset:1024 sc1
  s_add_u32 s29, s28, 157286400
  buffer_load_dwordx4 v[120:123], v2, s[4:7], s29 offen offset:0 sc1
  buffer_load_dwordx4 v[124:127], v2, s[4:7], s29 offen offset:1024 sc1
  s_add_u32 s29, s28, 159383552
  buffer_load_dwordx4 v[128:131], v2, s[4:7], s29 offen offset:0 sc1
  buffer_load_dwordx4 v[132:135], v2, s[4:7], s29 offen offset:1024 sc1
  s_add_u32 s29, s28, 161480704
  buffer_load_dwordx4 v[136:139], v2, s[4:7], s29 offen offset:0 sc1
  buffer_load_dwordx4 v[140:143], v2, s[4:7], s29 offen offset:1024 sc1
  s_add_u32 s29, s28, 163577856
  buffer_load_dwordx4 v[144:147], v2, s[4:7], s29 offen offset:0 sc1
  buffer_load_dwordx4 v[148:151], v2, s[4:7], s29 offen offset:1024 sc1
  s_add_u32 s29, s28, 165675008
  buffer_load_dwordx4 v[152:155], v2, s[4:7], s29 offen offset:0 sc1
  buffer_load_dwordx4 v[156:159], v2, s[4:7], s29 offen offset:1024 sc1
  v_lshlrev_b32 v7, 4, v4
  s_lshl_b32 s26, s16, 2
  v_add_u32 v4, s26, v7
  s_barrier
  ds_write_b32 v4, v80
  s_waitcnt lgkmcnt(0)
  s_barrier
  ds_read_b128 v[84:87], v7
  s_waitcnt lgkmcnt(0)
  v_add_f32 v80, v84, v85
  v_add_f32 v81, v86, v87
  v_add_f32 v80, v80, v81
  v_mul_f32 v80, 0xbfb8aa3b, v80
  v_exp_f32 v80, v80
  s_nop 0
  v_add_f32 v80, 1.0, v80
  v_rcp_f32 v80, v80
  s_nop 0
  v_sub_f32 v82, 1.0, v80
  s_waitcnt vmcnt(14)
  v_lshlrev_b32 v160, 16, v96
  v_and_b32 v161, 0xffff0000, v96
  v_lshlrev_b32 v162, 16, v97
  v_and_b32 v163, 0xffff0000, v97
  v_lshlrev_b32 v164, 16, v98
  v_and_b32 v165, 0xffff0000, v98
  v_lshlrev_b32 v166, 16, v99
  v_and_b32 v167, 0xffff0000, v99
  v_lshlrev_b32 v168, 16, v100
  v_and_b32 v169, 0xffff0000, v100
  v_lshlrev_b32 v170, 16, v101
  v_and_b32 v171, 0xffff0000, v101
  v_lshlrev_b32 v172, 16, v102
  v_and_b32 v173, 0xffff0000, v102
  v_lshlrev_b32 v174, 16, v103
  v_and_b32 v175, 0xffff0000, v103
  s_waitcnt vmcnt(12)
  v_lshlrev_b32 v8, 16, v104
  v_and_b32 v9, 0xffff0000, v104
  v_pk_add_f32 v[160:161], v[160:161], v[8:9]
  v_lshlrev_b32 v10, 16, v105
  v_and_b32 v11, 0xffff0000, v105
  v_pk_add_f32 v[162:163], v[162:163], v[10:11]
  v_lshlrev_b32 v12, 16, v106
  v_and_b32 v13, 0xffff0000, v106
  v_pk_add_f32 v[164:165], v[164:165], v[12:13]
  v_lshlrev_b32 v14, 16, v107
  v_and_b32 v15, 0xffff0000, v107
  v_pk_add_f32 v[166:167], v[166:167], v[14:15]
  v_lshlrev_b32 v8, 16, v108
  v_and_b32 v9, 0xffff0000, v108
  v_pk_add_f32 v[168:169], v[168:169], v[8:9]
  v_lshlrev_b32 v10, 16, v109
  v_and_b32 v11, 0xffff0000, v109
  v_pk_add_f32 v[170:171], v[170:171], v[10:11]
  v_lshlrev_b32 v12, 16, v110
  v_and_b32 v13, 0xffff0000, v110
  v_pk_add_f32 v[172:173], v[172:173], v[12:13]
  v_lshlrev_b32 v14, 16, v111
  v_and_b32 v15, 0xffff0000, v111
  v_pk_add_f32 v[174:175], v[174:175], v[14:15]
  s_waitcnt vmcnt(10)
  v_lshlrev_b32 v8, 16, v112
  v_and_b32 v9, 0xffff0000, v112
  v_pk_add_f32 v[160:161], v[160:161], v[8:9]
  v_lshlrev_b32 v10, 16, v113
  v_and_b32 v11, 0xffff0000, v113
  v_pk_add_f32 v[162:163], v[162:163], v[10:11]
  v_lshlrev_b32 v12, 16, v114
  v_and_b32 v13, 0xffff0000, v114
  v_pk_add_f32 v[164:165], v[164:165], v[12:13]
  v_lshlrev_b32 v14, 16, v115
  v_and_b32 v15, 0xffff0000, v115
  v_pk_add_f32 v[166:167], v[166:167], v[14:15]
  v_lshlrev_b32 v8, 16, v116
  v_and_b32 v9, 0xffff0000, v116
  v_pk_add_f32 v[168:169], v[168:169], v[8:9]
  v_lshlrev_b32 v10, 16, v117
  v_and_b32 v11, 0xffff0000, v117
  v_pk_add_f32 v[170:171], v[170:171], v[10:11]
  v_lshlrev_b32 v12, 16, v118
  v_and_b32 v13, 0xffff0000, v118
  v_pk_add_f32 v[172:173], v[172:173], v[12:13]
  v_lshlrev_b32 v14, 16, v119
  v_and_b32 v15, 0xffff0000, v119
  v_pk_add_f32 v[174:175], v[174:175], v[14:15]
  s_waitcnt vmcnt(8)
  v_lshlrev_b32 v8, 16, v120
  v_and_b32 v9, 0xffff0000, v120
  v_pk_add_f32 v[160:161], v[160:161], v[8:9]
  v_lshlrev_b32 v10, 16, v121
  v_and_b32 v11, 0xffff0000, v121
  v_pk_add_f32 v[162:163], v[162:163], v[10:11]
  v_lshlrev_b32 v12, 16, v122
  v_and_b32 v13, 0xffff0000, v122
  v_pk_add_f32 v[164:165], v[164:165], v[12:13]
  v_lshlrev_b32 v14, 16, v123
  v_and_b32 v15, 0xffff0000, v123
  v_pk_add_f32 v[166:167], v[166:167], v[14:15]
  v_lshlrev_b32 v8, 16, v124
  v_and_b32 v9, 0xffff0000, v124
  v_pk_add_f32 v[168:169], v[168:169], v[8:9]
  v_lshlrev_b32 v10, 16, v125
  v_and_b32 v11, 0xffff0000, v125
  v_pk_add_f32 v[170:171], v[170:171], v[10:11]
  v_lshlrev_b32 v12, 16, v126
  v_and_b32 v13, 0xffff0000, v126
  v_pk_add_f32 v[172:173], v[172:173], v[12:13]
  v_lshlrev_b32 v14, 16, v127
  v_and_b32 v15, 0xffff0000, v127
  v_pk_add_f32 v[174:175], v[174:175], v[14:15]
  s_waitcnt vmcnt(6)
  v_lshlrev_b32 v8, 16, v128
  v_and_b32 v9, 0xffff0000, v128
  v_pk_add_f32 v[160:161], v[160:161], v[8:9]
  v_lshlrev_b32 v10, 16, v129
  v_and_b32 v11, 0xffff0000, v129
  v_pk_add_f32 v[162:163], v[162:163], v[10:11]
  v_lshlrev_b32 v12, 16, v130
  v_and_b32 v13, 0xffff0000, v130
  v_pk_add_f32 v[164:165], v[164:165], v[12:13]
  v_lshlrev_b32 v14, 16, v131
  v_and_b32 v15, 0xffff0000, v131
  v_pk_add_f32 v[166:167], v[166:167], v[14:15]
  v_lshlrev_b32 v8, 16, v132
  v_and_b32 v9, 0xffff0000, v132
  v_pk_add_f32 v[168:169], v[168:169], v[8:9]
  v_lshlrev_b32 v10, 16, v133
  v_and_b32 v11, 0xffff0000, v133
  v_pk_add_f32 v[170:171], v[170:171], v[10:11]
  v_lshlrev_b32 v12, 16, v134
  v_and_b32 v13, 0xffff0000, v134
  v_pk_add_f32 v[172:173], v[172:173], v[12:13]
  v_lshlrev_b32 v14, 16, v135
  v_and_b32 v15, 0xffff0000, v135
  v_pk_add_f32 v[174:175], v[174:175], v[14:15]
  s_waitcnt vmcnt(4)
  v_lshlrev_b32 v8, 16, v136
  v_and_b32 v9, 0xffff0000, v136
  v_pk_add_f32 v[160:161], v[160:161], v[8:9]
  v_lshlrev_b32 v10, 16, v137
  v_and_b32 v11, 0xffff0000, v137
  v_pk_add_f32 v[162:163], v[162:163], v[10:11]
  v_lshlrev_b32 v12, 16, v138
  v_and_b32 v13, 0xffff0000, v138
  v_pk_add_f32 v[164:165], v[164:165], v[12:13]
  v_lshlrev_b32 v14, 16, v139
  v_and_b32 v15, 0xffff0000, v139
  v_pk_add_f32 v[166:167], v[166:167], v[14:15]
  v_lshlrev_b32 v8, 16, v140
  v_and_b32 v9, 0xffff0000, v140
  v_pk_add_f32 v[168:169], v[168:169], v[8:9]
  v_lshlrev_b32 v10, 16, v141
  v_and_b32 v11, 0xffff0000, v141
  v_pk_add_f32 v[170:171], v[170:171], v[10:11]
  v_lshlrev_b32 v12, 16, v142
  v_and_b32 v13, 0xffff0000, v142
  v_pk_add_f32 v[172:173], v[172:173], v[12:13]
  v_lshlrev_b32 v14, 16, v143
  v_and_b32 v15, 0xffff0000, v143
  v_pk_add_f32 v[174:175], v[174:175], v[14:15]
  s_waitcnt vmcnt(2)
  v_lshlrev_b32 v8, 16, v144
  v_and_b32 v9, 0xffff0000, v144
  v_pk_add_f32 v[160:161], v[160:161], v[8:9]
  v_lshlrev_b32 v10, 16, v145
  v_and_b32 v11, 0xffff0000, v145
  v_pk_add_f32 v[162:163], v[162:163], v[10:11]
  v_lshlrev_b32 v12, 16, v146
  v_and_b32 v13, 0xffff0000, v146
  v_pk_add_f32 v[164:165], v[164:165], v[12:13]
  v_lshlrev_b32 v14, 16, v147
  v_and_b32 v15, 0xffff0000, v147
  v_pk_add_f32 v[166:167], v[166:167], v[14:15]
  v_lshlrev_b32 v8, 16, v148
  v_and_b32 v9, 0xffff0000, v148
  v_pk_add_f32 v[168:169], v[168:169], v[8:9]
  v_lshlrev_b32 v10, 16, v149
  v_and_b32 v11, 0xffff0000, v149
  v_pk_add_f32 v[170:171], v[170:171], v[10:11]
  v_lshlrev_b32 v12, 16, v150
  v_and_b32 v13, 0xffff0000, v150
  v_pk_add_f32 v[172:173], v[172:173], v[12:13]
  v_lshlrev_b32 v14, 16, v151
  v_and_b32 v15, 0xffff0000, v151
  v_pk_add_f32 v[174:175], v[174:175], v[14:15]
  s_waitcnt vmcnt(0)
  v_lshlrev_b32 v8, 16, v152
  v_and_b32 v9, 0xffff0000, v152
  v_pk_add_f32 v[160:161], v[160:161], v[8:9]
  v_lshlrev_b32 v10, 16, v153
  v_and_b32 v11, 0xffff0000, v153
  v_pk_add_f32 v[162:163], v[162:163], v[10:11]
  v_lshlrev_b32 v12, 16, v154
  v_and_b32 v13, 0xffff0000, v154
  v_pk_add_f32 v[164:165], v[164:165], v[12:13]
  v_lshlrev_b32 v14, 16, v155
  v_and_b32 v15, 0xffff0000, v155
  v_pk_add_f32 v[166:167], v[166:167], v[14:15]
  v_lshlrev_b32 v8, 16, v156
  v_and_b32 v9, 0xffff0000, v156
  v_pk_add_f32 v[168:169], v[168:169], v[8:9]
  v_lshlrev_b32 v10, 16, v157
  v_and_b32 v11, 0xffff0000, v157
  v_pk_add_f32 v[170:171], v[170:171], v[10:11]
  v_lshlrev_b32 v12, 16, v158
  v_and_b32 v13, 0xffff0000, v158
  v_pk_add_f32 v[172:173], v[172:173], v[12:13]
  v_lshlrev_b32 v14, 16, v159
  v_and_b32 v15, 0xffff0000, v159
  v_pk_add_f32 v[174:175], v[174:175], v[14:15]
  s_and_b32 s76, s48, 1
  s_lshl_b32 s76, s76, 1
  s_lshr_b32 s77, s49, 1
  s_add_u32 s76, s76, s77
  s_mul_i32 s76, s76, 7
  s_add_u32 s76, s76, 6
  s_lshr_b32 s77, s48, 1
  s_add_u32 s77, s77, 0x201
  v_mov_b32 v193, s77
  s_lshl_b32 s76, s76, 7
  s_add_u32 s76, s76, 148897792
  v_and_b32 v192, 7, v1
  v_mul_u32_u24 v192, 3584, v192
  v_add_u32 v192, s76, v192
  s_mov_b32 s71, 0
  s_branch M_vg_185
M_vw_184:
  s_sleep 2
  s_add_u32 s71, s71, 1
  s_cmp_gt_u32 s71, 262144
  s_cbranch_scc1 M_exit
M_vg_185:
  buffer_load_dword v194, v192, s[4:7], 0 offen sc1
  s_waitcnt vmcnt(0)
  v_cmp_lt_u32 vcc, v194, v193
  s_cbranch_vccnz M_vw_184
  s_add_u32 s29, s28, 167772160
  buffer_load_dwordx4 v[96:99], v2, s[4:7], s29 offen offset:0 sc1
  buffer_load_dwordx4 v[100:103], v2, s[4:7], s29 offen offset:1024 sc1
  s_add_u32 s29, s28, 169869312
  buffer_load_dwordx4 v[104:107], v2, s[4:7], s29 offen offset:0 sc1
  buffer_load_dwordx4 v[108:111], v2, s[4:7], s29 offen offset:1024 sc1
  s_add_u32 s29, s28, 171966464
  buffer_load_dwordx4 v[112:115], v2, s[4:7], s29 offen offset:0 sc1
  buffer_load_dwordx4 v[116:119], v2, s[4:7], s29 offen offset:1024 sc1
  s_add_u32 s29, s28, 174063616
  buffer_load_dwordx4 v[120:123], v2, s[4:7], s29 offen offset:0 sc1
  buffer_load_dwordx4 v[124:127], v2, s[4:7], s29 offen offset:1024 sc1
  s_add_u32 s29, s28, 176160768
  buffer_load_dwordx4 v[128:131], v2, s[4:7], s29 offen offset:0 sc1
  buffer_load_dwordx4 v[132:135], v2, s[4:7], s29 offen offset:1024 sc1
  s_add_u32 s29, s28, 178257920
  buffer_load_dwordx4 v[136:139], v2, s[4:7], s29 offen offset:0 sc1
  buffer_load_dwordx4 v[140:143], v2, s[4:7], s29 offen offset:1024 sc1
  s_add_u32 s29, s28, 180355072
  buffer_load_dwordx4 v[144:147], v2, s[4:7], s29 offen offset:0 sc1
  buffer_load_dwordx4 v[148:151], v2, s[4:7], s29 offen offset:1024 sc1
  s_add_u32 s29, s28, 182452224
  buffer_load_dwordx4 v[152:155], v2, s[4:7], s29 offen offset:0 sc1
  buffer_load_dwordx4 v[156:159], v2, s[4:7], s29 offen offset:1024 sc1
  v_pk_mul_f32 v[160:161], v[160:161], v[80:81] op_sel_hi:[1,0]
  v_pk_mul_f32 v[162:163], v[162:163], v[80:81] op_sel_hi:[1,0]
  v_pk_mul_f32 v[164:165], v[164:165], v[80:81] op_sel_hi:[1,0]
  v_pk_mul_f32 v[166:167], v[166:167], v[80:81] op_sel_hi:[1,0]
  v_pk_mul_f32 v[168:169], v[168:169], v[80:81] op_sel_hi:[1,0]
  v_pk_mul_f32 v[170:171], v[170:171], v[80:81] op_sel_hi:[1,0]
  v_pk_mul_f32 v[172:173], v[172:173], v[80:81] op_sel_hi:[1,0]
  v_pk_mul_f32 v[174:175], v[174:175], v[80:81] op_sel_hi:[1,0]
  s_waitcnt vmcnt(14)
  v_lshlrev_b32 v176, 16, v96
  v_and_b32 v177, 0xffff0000, v96
  v_lshlrev_b32 v178, 16, v97
  v_and_b32 v179, 0xffff0000, v97
  v_lshlrev_b32 v180, 16, v98
  v_and_b32 v181, 0xffff0000, v98
  v_lshlrev_b32 v182, 16, v99
  v_and_b32 v183, 0xffff0000, v99
  v_lshlrev_b32 v184, 16, v100
  v_and_b32 v185, 0xffff0000, v100
  v_lshlrev_b32 v186, 16, v101
  v_and_b32 v187, 0xffff0000, v101
  v_lshlrev_b32 v188, 16, v102
  v_and_b32 v189, 0xffff0000, v102
  v_lshlrev_b32 v190, 16, v103
  v_and_b32 v191, 0xffff0000, v103
  s_waitcnt vmcnt(12)
  v_lshlrev_b32 v8, 16, v104
  v_and_b32 v9, 0xffff0000, v104
  v_pk_add_f32 v[176:177], v[176:177], v[8:9]
  v_lshlrev_b32 v10, 16, v105
  v_and_b32 v11, 0xffff0000, v105
  v_pk_add_f32 v[178:179], v[178:179], v[10:11]
  v_lshlrev_b32 v12, 16, v106
  v_and_b32 v13, 0xffff0000, v106
  v_pk_add_f32 v[180:181], v[180:181], v[12:13]
  v_lshlrev_b32 v14, 16, v107
  v_and_b32 v15, 0xffff0000, v107
  v_pk_add_f32 v[182:183], v[182:183], v[14:15]
  v_lshlrev_b32 v8, 16, v108
  v_and_b32 v9, 0xffff0000, v108
  v_pk_add_f32 v[184:185], v[184:185], v[8:9]
  v_lshlrev_b32 v10, 16, v109
  v_and_b32 v11, 0xffff0000, v109
  v_pk_add_f32 v[186:187], v[186:187], v[10:11]
  v_lshlrev_b32 v12, 16, v110
  v_and_b32 v13, 0xffff0000, v110
  v_pk_add_f32 v[188:189], v[188:189], v[12:13]
  v_lshlrev_b32 v14, 16, v111
  v_and_b32 v15, 0xffff0000, v111
  v_pk_add_f32 v[190:191], v[190:191], v[14:15]
  s_waitcnt vmcnt(10)
  v_lshlrev_b32 v8, 16, v112
  v_and_b32 v9, 0xffff0000, v112
  v_pk_add_f32 v[176:177], v[176:177], v[8:9]
  v_lshlrev_b32 v10, 16, v113
  v_and_b32 v11, 0xffff0000, v113
  v_pk_add_f32 v[178:179], v[178:179], v[10:11]
  v_lshlrev_b32 v12, 16, v114
  v_and_b32 v13, 0xffff0000, v114
  v_pk_add_f32 v[180:181], v[180:181], v[12:13]
  v_lshlrev_b32 v14, 16, v115
  v_and_b32 v15, 0xffff0000, v115
  v_pk_add_f32 v[182:183], v[182:183], v[14:15]
  v_lshlrev_b32 v8, 16, v116
  v_and_b32 v9, 0xffff0000, v116
  v_pk_add_f32 v[184:185], v[184:185], v[8:9]
  v_lshlrev_b32 v10, 16, v117
  v_and_b32 v11, 0xffff0000, v117
  v_pk_add_f32 v[186:187], v[186:187], v[10:11]
  v_lshlrev_b32 v12, 16, v118
  v_and_b32 v13, 0xffff0000, v118
  v_pk_add_f32 v[188:189], v[188:189], v[12:13]
  v_lshlrev_b32 v14, 16, v119
  v_and_b32 v15, 0xffff0000, v119
  v_pk_add_f32 v[190:191], v[190:191], v[14:15]
  s_waitcnt vmcnt(8)
  v_lshlrev_b32 v8, 16, v120
  v_and_b32 v9, 0xffff0000, v120
  v_pk_add_f32 v[176:177], v[176:177], v[8:9]
  v_lshlrev_b32 v10, 16, v121
  v_and_b32 v11, 0xffff0000, v121
  v_pk_add_f32 v[178:179], v[178:179], v[10:11]
  v_lshlrev_b32 v12, 16, v122
  v_and_b32 v13, 0xffff0000, v122
  v_pk_add_f32 v[180:181], v[180:181], v[12:13]
  v_lshlrev_b32 v14, 16, v123
  v_and_b32 v15, 0xffff0000, v123
  v_pk_add_f32 v[182:183], v[182:183], v[14:15]
  v_lshlrev_b32 v8, 16, v124
  v_and_b32 v9, 0xffff0000, v124
  v_pk_add_f32 v[184:185], v[184:185], v[8:9]
  v_lshlrev_b32 v10, 16, v125
  v_and_b32 v11, 0xffff0000, v125
  v_pk_add_f32 v[186:187], v[186:187], v[10:11]
  v_lshlrev_b32 v12, 16, v126
  v_and_b32 v13, 0xffff0000, v126
  v_pk_add_f32 v[188:189], v[188:189], v[12:13]
  v_lshlrev_b32 v14, 16, v127
  v_and_b32 v15, 0xffff0000, v127
  v_pk_add_f32 v[190:191], v[190:191], v[14:15]
  s_waitcnt vmcnt(6)
  v_lshlrev_b32 v8, 16, v128
  v_and_b32 v9, 0xffff0000, v128
  v_pk_add_f32 v[176:177], v[176:177], v[8:9]
  v_lshlrev_b32 v10, 16, v129
  v_and_b32 v11, 0xffff0000, v129
  v_pk_add_f32 v[178:179], v[178:179], v[10:11]
  v_lshlrev_b32 v12, 16, v130
  v_and_b32 v13, 0xffff0000, v130
  v_pk_add_f32 v[180:181], v[180:181], v[12:13]
  v_lshlrev_b32 v14, 16, v131
  v_and_b32 v15, 0xffff0000, v131
  v_pk_add_f32 v[182:183], v[182:183], v[14:15]
  v_lshlrev_b32 v8, 16, v132
  v_and_b32 v9, 0xffff0000, v132
  v_pk_add_f32 v[184:185], v[184:185], v[8:9]
  v_lshlrev_b32 v10, 16, v133
  v_and_b32 v11, 0xffff0000, v133
  v_pk_add_f32 v[186:187], v[186:187], v[10:11]
  v_lshlrev_b32 v12, 16, v134
  v_and_b32 v13, 0xffff0000, v134
  v_pk_add_f32 v[188:189], v[188:189], v[12:13]
  v_lshlrev_b32 v14, 16, v135
  v_and_b32 v15, 0xffff0000, v135
  v_pk_add_f32 v[190:191], v[190:191], v[14:15]
  s_waitcnt vmcnt(4)
  v_lshlrev_b32 v8, 16, v136
  v_and_b32 v9, 0xffff0000, v136
  v_pk_add_f32 v[176:177], v[176:177], v[8:9]
  v_lshlrev_b32 v10, 16, v137
  v_and_b32 v11, 0xffff0000, v137
  v_pk_add_f32 v[178:179], v[178:179], v[10:11]
  v_lshlrev_b32 v12, 16, v138
  v_and_b32 v13, 0xffff0000, v138
  v_pk_add_f32 v[180:181], v[180:181], v[12:13]
  v_lshlrev_b32 v14, 16, v139
  v_and_b32 v15, 0xffff0000, v139
  v_pk_add_f32 v[182:183], v[182:183], v[14:15]
  v_lshlrev_b32 v8, 16, v140
  v_and_b32 v9, 0xffff0000, v140
  v_pk_add_f32 v[184:185], v[184:185], v[8:9]
  v_lshlrev_b32 v10, 16, v141
  v_and_b32 v11, 0xffff0000, v141
  v_pk_add_f32 v[186:187], v[186:187], v[10:11]
  v_lshlrev_b32 v12, 16, v142
  v_and_b32 v13, 0xffff0000, v142
  v_pk_add_f32 v[188:189], v[188:189], v[12:13]
  v_lshlrev_b32 v14, 16, v143
  v_and_b32 v15, 0xffff0000, v143
  v_pk_add_f32 v[190:191], v[190:191], v[14:15]
  s_waitcnt vmcnt(2)
  v_lshlrev_b32 v8, 16, v144
  v_and_b32 v9, 0xffff0000, v144
  v_pk_add_f32 v[176:177], v[176:177], v[8:9]
  v_lshlrev_b32 v10, 16, v145
  v_and_b32 v11, 0xffff0000, v145
  v_pk_add_f32 v[178:179], v[178:179], v[10:11]
  v_lshlrev_b32 v12, 16, v146
  v_and_b32 v13, 0xffff0000, v146
  v_pk_add_f32 v[180:181], v[180:181], v[12:13]
  v_lshlrev_b32 v14, 16, v147
  v_and_b32 v15, 0xffff0000, v147
  v_pk_add_f32 v[182:183], v[182:183], v[14:15]
  v_lshlrev_b32 v8, 16, v148
  v_and_b32 v9, 0xffff0000, v148
  v_pk_add_f32 v[184:185], v[184:185], v[8:9]
  v_lshlrev_b32 v10, 16, v149
  v_and_b32 v11, 0xffff0000, v149
  v_pk_add_f32 v[186:187], v[186:187], v[10:11]
  v_lshlrev_b32 v12, 16, v150
  v_and_b32 v13, 0xffff0000, v150
  v_pk_add_f32 v[188:189], v[188:189], v[12:13]
  v_lshlrev_b32 v14, 16, v151
  v_and_b32 v15, 0xffff0000, v151
  v_pk_add_f32 v[190:191], v[190:191], v[14:15]
  s_waitcnt vmcnt(0)
  v_lshlrev_b32 v8, 16, v152
  v_and_b32 v9, 0xffff0000, v152
  v_pk_add_f32 v[176:177], v[176:177], v[8:9]
  v_lshlrev_b32 v10, 16, v153
  v_and_b32 v11, 0xffff0000, v153
  v_pk_add_f32 v[178:179], v[178:179], v[10:11]
  v_lshlrev_b32 v12, 16, v154
  v_and_b32 v13, 0xffff0000, v154
  v_pk_add_f32 v[180:181], v[180:181], v[12:13]
  v_lshlrev_b32 v14, 16, v155
  v_and_b32 v15, 0xffff0000, v155
  v_pk_add_f32 v[182:183], v[182:183], v[14:15]
  v_lshlrev_b32 v8, 16, v156
  v_and_b32 v9, 0xffff0000, v156
  v_pk_add_f32 v[184:185], v[184:185], v[8:9]
  v_lshlrev_b32 v10, 16, v157
  v_and_b32 v11, 0xffff0000, v157
  v_pk_add_f32 v[186:187], v[186:187], v[10:11]
  v_lshlrev_b32 v12, 16, v158
  v_and_b32 v13, 0xffff0000, v158
  v_pk_add_f32 v[188:189], v[188:189], v[12:13]
  v_lshlrev_b32 v14, 16, v159
  v_and_b32 v15, 0xffff0000, v159
  v_pk_add_f32 v[190:191], v[190:191], v[14:15]
  v_pk_fma_f32 v[160:161], v[176:177], v[82:83], v[160:161] op_sel_hi:[1,0,1]
  v_cvt_pk_bf16_f32 v16, v160, v161
  v_pk_fma_f32 v[162:163], v[178:179], v[82:83], v[162:163] op_sel_hi:[1,0,1]
  v_cvt_pk_bf16_f32 v17, v162, v163
  v_pk_fma_f32 v[164:165], v[180:181], v[82:83], v[164:165] op_sel_hi:[1,0,1]
  v_cvt_pk_bf16_f32 v18, v164, v165
  v_pk_fma_f32 v[166:167], v[182:183], v[82:83], v[166:167] op_sel_hi:[1,0,1]
  v_cvt_pk_bf16_f32 v19, v166, v167
  v_pk_fma_f32 v[168:169], v[184:185], v[82:83], v[168:169] op_sel_hi:[1,0,1]
  v_cvt_pk_bf16_f32 v20, v168, v169
  v_pk_fma_f32 v[170:171], v[186:187], v[82:83], v[170:171] op_sel_hi:[1,0,1]
  v_cvt_pk_bf16_f32 v21, v170, v171
  v_pk_fma_f32 v[172:173], v[188:189], v[82:83], v[172:173] op_sel_hi:[1,0,1]
  v_cvt_pk_bf16_f32 v22, v172, v173
  v_pk_fma_f32 v[174:175], v[190:191], v[82:83], v[174:175] op_sel_hi:[1,0,1]
  v_cvt_pk_bf16_f32 v23, v174, v175
  s_lshl_b32 s26, s49, 2
  s_add_u32 s26, s26, s16
  s_lshl_b32 s26, s26, 6
  s_lshl_b32 s27, s48, 15
  s_add_u32 s26, s26, s27
  buffer_store_dwordx4 v[16:19], v6, s[32:35], s26 offen offset:0
  buffer_store_dwordx4 v[20:23], v6, s[32:35], s26 offen offset:32
  s_cmp_lt_u32 s50, 64
  s_mov_b32 s50, s51
  s_cbranch_scc1 M_fin
  s_branch M_done
M_follow:
  s_lshr_b32 s48, s64, 2
  s_and_b32 s49, s64, 1
  s_bfe_u32 s50, s64, 0x10001
  s_mov_b32 s51, 2
  s_mov_b32 s23, 32
  s_load_dwordx2 s[8:9], s[0:1], 88
  s_lshl_b32 s17, s48, 19
  s_lshl_b32 s26, s49, 2
  s_add_u32 s26, s26, s16
  s_lshl_b32 s27, s26, 7
  s_add_u32 s17, s17, s27
  s_mov_b32 s18, 1024
  s_lshl_b32 s21, s48, 6
  s_add_u32 s21, s21, s50
  s_lshl_b32 s21, s21, 3
  s_add_u32 s21, s21, s26
  s_lshl_b32 s21, s21, 12
  s_add_u32 s21, s21, 167772160
  s_lshl_b32 s22, s51, 15
  s_mov_b32 s24, 1.0
  s_waitcnt lgkmcnt(0)
  s_and_b32 s9, s9, 0xffff
  s_mov_b32 s10, 4194304
  s_mov_b32 s11, 0x20000
  v_lshrrev_b32 v144, 4, v1
  v_and_b32 v56, 0xff, v2
  v_lshl_add_u32 v56, v144, 9, v56
  s_mul_i32 s26, s16, 0
  v_add_u32 v8, 0, v56
  v_add_u32 v16, 0, v2
  v_add_u32 v16, s26, v16
  v_add_u32 v9, 256, v56
  v_add_u32 v17, 1024, v2
  v_add_u32 v17, s26, v17
  v_add_u32 v10, 2048, v56
  v_add_u32 v18, 2048, v2
  v_add_u32 v18, s26, v18
  v_add_u32 v11, 2304, v56
  v_add_u32 v19, 3072, v2
  v_add_u32 v19, s26, v19
  v_add_u32 v12, 4096, v56
  v_add_u32 v20, 4096, v2
  v_add_u32 v20, s26, v20
  v_add_u32 v13, 4352, v56
  v_add_u32 v21, 5120, v2
  v_add_u32 v21, s26, v21
  v_add_u32 v14, 6144, v56
  v_add_u32 v22, 6144, v2
  v_add_u32 v22, s26, v22
  v_add_u32 v15, 6400, v56
  v_add_u32 v23, 7168, v2
  v_add_u32 v23, s26, v23
  v_mov_b32 v20, v56
  v_lshrrev_b32 v144, 3, v1
  v_mul_lo_u32 v144, v144, s18
  v_and_b32 v145, 7, v1
  v_lshl_add_u32 v144, v145, 4, v144
  s_lshl_b32 s28, s16, 15
  s_add_u32 s28, s28, 32768
  s_lshl_b32 s29, s18, 3
  s_add_u32 m0, s28, 0
  s_nop 0
  buffer_load_dwordx4 v144, s[8:11], s17 offen lds
  s_add_u32 s17, s17, s29
  s_add_u32 m0, s28, 1024
  s_nop 0
  buffer_load_dwordx4 v144, s[8:11], s17 offen lds
  s_add_u32 s17, s17, s29
  s_add_u32 m0, s28, 2048
  s_nop 0
  buffer_load_dwordx4 v144, s[8:11], s17 offen lds
  s_add_u32 s17, s17, s29
  s_add_u32 m0, s28, 3072
  s_nop 0
  buffer_load_dwordx4 v144, s[8:11], s17 offen lds
  s_add_u32 s17, s17, s29
  s_add_u32 m0, s28, 4096
  s_nop 0
  buffer_load_dwordx4 v144, s[8:11], s17 offen lds
  s_add_u32 s17, s17, s29
  s_add_u32 m0, s28, 5120
  s_nop 0
  buffer_load_dwordx4 v144, s[8:11], s17 offen lds
  s_add_u32 s17, s17, s29
  s_add_u32 m0, s28, 6144
  s_nop 0
  buffer_load_dwordx4 v144, s[8:11], s17 offen lds
  s_add_u32 s17, s17, s29
  s_add_u32 m0, s28, 7168
  s_nop 0
  buffer_load_dwordx4 v144, s[8:11], s17 offen lds
  s_add_u32 s17, s17, s29
  s_add_u32 m0, s28, 8192
  s_nop 0
  buffer_load_dwordx4 v144, s[8:11], s17 offen lds
  s_add_u32 s17, s17, s29
  s_add_u32 m0, s28, 9216
  s_nop 0
  buffer_load_dwordx4 v144, s[8:11], s17 offen lds
  s_add_u32 s17, s17, s29
  s_add_u32 m0, s28, 10240
  s_nop 0
  buffer_load_dwordx4 v144, s[8:11], s17 offen lds
  s_add_u32 s17, s17, s29
  s_add_u32 m0, s28, 11264
  s_nop 0
  buffer_load_dwordx4 v144, s[8:11], s17 offen lds
  s_add_u32 s17, s17, s29
  s_add_u32 m0, s28, 12288
  s_nop 0
  buffer_load_dwordx4 v144, s[8:11], s17 offen lds
  s_add_u32 s17, s17, s29
  s_add_u32 m0, s28, 13312
  s_nop 0
  buffer_load_dwordx4 v144, s[8:11], s17 offen lds
  s_add_u32 s17, s17, s29
  s_add_u32 m0, s28, 14336
  s_nop 0
  buffer_load_dwordx4 v144, s[8:11], s17 offen lds
  s_add_u32 s17, s17, s29
  s_add_u32 m0, s28, 15360
  s_nop 0
  buffer_load_dwordx4 v144, s[8:11], s17 offen lds
  s_add_u32 s17, s17, s29
  s_add_u32 m0, s28, 16384
  s_nop 0
  buffer_load_dwordx4 v144, s[8:11], s17 offen lds
  s_add_u32 s17, s17, s29
  s_add_u32 m0, s28, 17408
  s_nop 0
  buffer_load_dwordx4 v144, s[8:11], s17 offen lds
  s_add_u32 s17, s17, s29
  s_add_u32 m0, s28, 18432
  s_nop 0
  buffer_load_dwordx4 v144, s[8:11], s17 offen lds
  s_add_u32 s17, s17, s29
  s_add_u32 m0, s28, 19456
  s_nop 0
  buffer_load_dwordx4 v144, s[8:11], s17 offen lds
  s_add_u32 s17, s17, s29
  s_add_u32 m0, s28, 20480
  s_nop 0
  buffer_load_dwordx4 v144, s[8:11], s17 offen lds
  s_add_u32 s17, s17, s29
  s_add_u32 m0, s28, 21504
  s_nop 0
  buffer_load_dwordx4 v144, s[8:11], s17 offen lds
  s_add_u32 s17, s17, s29
  s_add_u32 m0, s28, 22528
  s_nop 0
  buffer_load_dwordx4 v144, s[8:11], s17 offen lds
  s_add_u32 s17, s17, s29
  s_add_u32 m0, s28, 23552
  s_nop 0
  buffer_load_dwordx4 v144, s[8:11], s17 offen lds
  s_add_u32 s17, s17, s29
  s_add_u32 m0, s28, 24576
  s_nop 0
  buffer_load_dwordx4 v144, s[8:11], s17 offen lds
  s_add_u32 s17, s17, s29
  s_add_u32 m0, s28, 25600
  s_nop 0
  buffer_load_dwordx4 v144, s[8:11], s17 offen lds
  s_add_u32 s17, s17, s29
  s_add_u32 m0, s28, 26624
  s_nop 0
  buffer_load_dwordx4 v144, s[8:11], s17 offen lds
  s_add_u32 s17, s17, s29
  s_add_u32 m0, s28, 27648
  s_nop 0
  buffer_load_dwordx4 v144, s[8:11], s17 offen lds
  s_add_u32 s17, s17, s29
  s_add_u32 m0, s28, 28672
  s_nop 0
  buffer_load_dwordx4 v144, s[8:11], s17 offen lds
  s_add_u32 s17, s17, s29
  s_add_u32 m0, s28, 29696
  s_nop 0
  buffer_load_dwordx4 v144, s[8:11], s17 offen lds
  s_add_u32 s17, s17, s29
  s_add_u32 m0, s28, 30720
  s_nop 0
  buffer_load_dwordx4 v144, s[8:11], s17 offen lds
  s_add_u32 s17, s17, s29
  s_add_u32 m0, s28, 31744
  s_nop 0
  buffer_load_dwordx4 v144, s[8:11], s17 offen lds
  s_add_u32 s17, s17, s29
  v_bfe_u32 v148, v1, 2, 2
  v_lshrrev_b32 v149, 5, v1
  v_lshl_add_u32 v148, v149, 4, v148
  v_bfe_u32 v149, v1, 4, 1
  v_lshl_add_u32 v148, v149, 2, v148
  v_and_b32 v149, 3, v1
  v_lshlrev_b32 v149, 4, v149
  s_mov_b32 s26, 8
  v_lshl_add_u32 v148, v148, 7, v149
  v_add_u32 v152, s28, v148
  v_add_u32 v153, 1024, v152
  v_add_u32 v154, s26, v152
  v_add_u32 v155, s26, v153
  s_waitcnt vmcnt(28)
  ds_read_b64_tr_b16 a[0:1], v152 offset:0
  ds_read_b64_tr_b16 a[2:3], v153 offset:0
  ds_read_b64_tr_b16 a[4:5], v154 offset:0
  ds_read_b64_tr_b16 a[6:7], v155 offset:0
  ds_read_b64_tr_b16 a[8:9], v152 offset:64
  ds_read_b64_tr_b16 a[10:11], v153 offset:64
  ds_read_b64_tr_b16 a[12:13], v154 offset:64
  ds_read_b64_tr_b16 a[14:15], v155 offset:64
  s_waitcnt lgkmcnt(0)
  s_add_u32 m0, s28, 0
  s_nop 0
  buffer_load_dwordx4 v144, s[8:11], s17 offen lds
  s_add_u32 s17, s17, s29
  s_add_u32 m0, s28, 1024
  s_nop 0
  buffer_load_dwordx4 v144, s[8:11], s17 offen lds
  s_add_u32 s17, s17, s29
  s_add_u32 m0, s28, 2048
  s_nop 0
  buffer_load_dwordx4 v144, s[8:11], s17 offen lds
  s_add_u32 s17, s17, s29
  s_add_u32 m0, s28, 3072
  s_nop 0
  buffer_load_dwordx4 v144, s[8:11], s17 offen lds
  s_add_u32 s17, s17, s29
  s_waitcnt vmcnt(28)
  ds_read_b64_tr_b16 a[16:17], v152 offset:4096
  ds_read_b64_tr_b16 a[18:19], v153 offset:4096
  ds_read_b64_tr_b16 a[20:21], v154 offset:4096
  ds_read_b64_tr_b16 a[22:23], v155 offset:4096
  ds_read_b64_tr_b16 a[24:25], v152 offset:4160
  ds_read_b64_tr_b16 a[26:27], v153 offset:4160
  ds_read_b64_tr_b16 a[28:29], v154 offset:4160
  ds_read_b64_tr_b16 a[30:31], v155 offset:4160
  s_waitcnt lgkmcnt(0)
  s_add_u32 m0, s28, 4096
  s_nop 0
  buffer_load_dwordx4 v144, s[8:11], s17 offen lds
  s_add_u32 s17, s17, s29
  s_add_u32 m0, s28, 5120
  s_nop 0
  buffer_load_dwordx4 v144, s[8:11], s17 offen lds
  s_add_u32 s17, s17, s29
  s_add_u32 m0, s28, 6144
  s_nop 0
  buffer_load_dwordx4 v144, s[8:11], s17 offen lds
  s_add_u32 s17, s17, s29
  s_add_u32 m0, s28, 7168
  s_nop 0
  buffer_load_dwordx4 v144, s[8:11], s17 offen lds
  s_add_u32 s17, s17, s29
  s_waitcnt vmcnt(28)
  ds_read_b64_tr_b16 a[32:33], v152 offset:8192
  ds_read_b64_tr_b16 a[34:35], v153 offset:8192
  ds_read_b64_tr_b16 a[36:37], v154 offset:8192
  ds_read_b64_tr_b16 a[38:39], v155 offset:8192
  ds_read_b64_tr_b16 a[40:41], v152 offset:8256
  ds_read_b64_tr_b16 a[42:43], v153 offset:8256
  ds_read_b64_tr_b16 a[44:45], v154 offset:8256
  ds_read_b64_tr_b16 a[46:47], v155 offset:8256
  s_waitcnt lgkmcnt(0)
  s_add_u32 m0, s28, 8192
  s_nop 0
  buffer_load_dwordx4 v144, s[8:11], s17 offen lds
  s_add_u32 s17, s17, s29
  s_add_u32 m0, s28, 9216
  s_nop 0
  buffer_load_dwordx4 v144, s[8:11], s17 offen lds
  s_add_u32 s17, s17, s29
  s_add_u32 m0, s28, 10240
  s_nop 0
  buffer_load_dwordx4 v144, s[8:11], s17 offen lds
  s_add_u32 s17, s17, s29
  s_add_u32 m0, s28, 11264
  s_nop 0
  buffer_load_dwordx4 v144, s[8:11], s17 offen lds
  s_add_u32 s17, s17, s29
  s_waitcnt vmcnt(28)
  ds_read_b64_tr_b16 a[48:49], v152 offset:12288
  ds_read_b64_tr_b16 a[50:51], v153 offset:12288
  ds_read_b64_tr_b16 a[52:53], v154 offset:12288
  ds_read_b64_tr_b16 a[54:55], v155 offset:12288
  ds_read_b64_tr_b16 a[56:57], v152 offset:12352
  ds_read_b64_tr_b16 a[58:59], v153 offset:12352
  ds_read_b64_tr_b16 a[60:61], v154 offset:12352
  ds_read_b64_tr_b16 a[62:63], v155 offset:12352
  s_waitcnt lgkmcnt(0)
  s_add_u32 m0, s28, 12288
  s_nop 0
  buffer_load_dwordx4 v144, s[8:11], s17 offen lds
  s_add_u32 s17, s17, s29
  s_add_u32 m0, s28, 13312
  s_nop 0
  buffer_load_dwordx4 v144, s[8:11], s17 offen lds
  s_add_u32 s17, s17, s29
  s_add_u32 m0, s28, 14336
  s_nop 0
  buffer_load_dwordx4 v144, s[8:11], s17 offen lds
  s_add_u32 s17, s17, s29
  s_add_u32 m0, s28, 15360
  s_nop 0
  buffer_load_dwordx4 v144, s[8:11], s17 offen lds
  s_add_u32 s17, s17, s29
  s_waitcnt vmcnt(28)
  ds_read_b64_tr_b16 a[64:65], v152 offset:16384
  ds_read_b64_tr_b16 a[66:67], v153 offset:16384
  ds_read_b64_tr_b16 a[68:69], v154 offset:16384
  ds_read_b64_tr_b16 a[70:71], v155 offset:16384
  ds_read_b64_tr_b16 a[72:73], v152 offset:16448
  ds_read_b64_tr_b16 a[74:75], v153 offset:16448
  ds_read_b64_tr_b16 a[76:77], v154 offset:16448
  ds_read_b64_tr_b16 a[78:79], v155 offset:16448
  s_waitcnt lgkmcnt(0)
  s_add_u32 m0, s28, 16384
  s_nop 0
  buffer_load_dwordx4 v144, s[8:11], s17 offen lds
  s_add_u32 s17, s17, s29
  s_add_u32 m0, s28, 17408
  s_nop 0
  buffer_load_dwordx4 v144, s[8:11], s17 offen lds
  s_add_u32 s17, s17, s29
  s_add_u32 m0, s28, 18432
  s_nop 0
  buffer_load_dwordx4 v144, s[8:11], s17 offen lds
  s_add_u32 s17, s17, s29
  s_add_u32 m0, s28, 19456
  s_nop 0
  buffer_load_dwordx4 v144, s[8:11], s17 offen lds
  s_add_u32 s17, s17, s29
  s_waitcnt vmcnt(28)
  ds_read_b64_tr_b16 a[80:81], v152 offset:20480
  ds_read_b64_tr_b16 a[82:83], v153 offset:20480
  ds_read_b64_tr_b16 a[84:85], v154 offset:20480
  ds_read_b64_tr_b16 a[86:87], v155 offset:20480
  ds_read_b64_tr_b16 a[88:89], v152 offset:20544
  ds_read_b64_tr_b16 a[90:91], v153 offset:20544
  ds_read_b64_tr_b16 a[92:93], v154 offset:20544
  ds_read_b64_tr_b16 a[94:95], v155 offset:20544
  s_waitcnt lgkmcnt(0)
  s_add_u32 m0, s28, 20480
  s_nop 0
  buffer_load_dwordx4 v144, s[8:11], s17 offen lds
  s_add_u32 s17, s17, s29
  s_add_u32 m0, s28, 21504
  s_nop 0
  buffer_load_dwordx4 v144, s[8:11], s17 offen lds
  s_add_u32 s17, s17, s29
  s_add_u32 m0, s28, 22528
  s_nop 0
  buffer_load_dwordx4 v144, s[8:11], s17 offen lds
  s_add_u32 s17, s17, s29
  s_add_u32 m0, s28, 23552
  s_nop 0
  buffer_load_dwordx4 v144, s[8:11], s17 offen lds
  s_add_u32 s17, s17, s29
  s_waitcnt vmcnt(28)
  ds_read_b64_tr_b16 a[96:97], v152 offset:24576
  ds_read_b64_tr_b16 a[98:99], v153 offset:24576
  ds_read_b64_tr_b16 a[100:101], v154 offset:24576
  ds_read_b64_tr_b16 a[102:103], v155 offset:24576
  ds_read_b64_tr_b16 a[104:105], v152 offset:24640
  ds_read_b64_tr_b16 a[106:107], v153 offset:24640
  ds_read_b64_tr_b16 a[108:109], v154 offset:24640
  ds_read_b64_tr_b16 a[110:111], v155 offset:24640
  s_waitcnt lgkmcnt(0)
  s_add_u32 m0, s28, 24576
  s_nop 0
  buffer_load_dwordx4 v144, s[8:11], s17 offen lds
  s_add_u32 s17, s17, s29
  s_add_u32 m0, s28, 25600
  s_nop 0
  buffer_load_dwordx4 v144, s[8:11], s17 offen lds
  s_add_u32 s17, s17, s29
  s_add_u32 m0, s28, 26624
  s_nop 0
  buffer_load_dwordx4 v144, s[8:11], s17 offen lds
  s_add_u32 s17, s17, s29
  s_add_u32 m0, s28, 27648
  s_nop 0
  buffer_load_dwordx4 v144, s[8:11], s17 offen lds
  s_add_u32 s17, s17, s29
  s_waitcnt vmcnt(28)
  ds_read_b64_tr_b16 a[112:113], v152 offset:28672
  ds_read_b64_tr_b16 a[114:115], v153 offset:28672
  ds_read_b64_tr_b16 a[116:117], v154 offset:28672
  ds_read_b64_tr_b16 a[118:119], v155 offset:28672
  ds_read_b64_tr_b16 a[120:121], v152 offset:28736
  ds_read_b64_tr_b16 a[122:123], v153 offset:28736
  ds_read_b64_tr_b16 a[124:125], v154 offset:28736
  ds_read_b64_tr_b16 a[126:127], v155 offset:28736
  s_waitcnt lgkmcnt(0)
  s_add_u32 m0, s28, 28672
  s_nop 0
  buffer_load_dwordx4 v144, s[8:11], s17 offen lds
  s_add_u32 s17, s17, s29
  s_add_u32 m0, s28, 29696
  s_nop 0
  buffer_load_dwordx4 v144, s[8:11], s17 offen lds
  s_add_u32 s17, s17, s29
  s_add_u32 m0, s28, 30720
  s_nop 0
  buffer_load_dwordx4 v144, s[8:11], s17 offen lds
  s_add_u32 s17, s17, s29
  s_add_u32 m0, s28, 31744
  s_nop 0
  buffer_load_dwordx4 v144, s[8:11], s17 offen lds
  s_add_u32 s17, s17, s29
  s_waitcnt vmcnt(28)
  ds_read_b64_tr_b16 a[128:129], v152 offset:0
  ds_read_b64_tr_b16 a[130:131], v153 offset:0
  ds_read_b64_tr_b16 a[132:133], v154 offset:0
  ds_read_b64_tr_b16 a[134:135], v155 offset:0
  ds_read_b64_tr_b16 a[136:137], v152 offset:64
  ds_read_b64_tr_b16 a[138:139], v153 offset:64
  ds_read_b64_tr_b16 a[140:141], v154 offset:64
  ds_read_b64_tr_b16 a[142:143], v155 offset:64
  s_waitcnt lgkmcnt(0)
  s_waitcnt vmcnt(24)
  ds_read_b64_tr_b16 a[144:145], v152 offset:4096
  ds_read_b64_tr_b16 a[146:147], v153 offset:4096
  ds_read_b64_tr_b16 a[148:149], v154 offset:4096
  ds_read_b64_tr_b16 a[150:151], v155 offset:4096
  ds_read_b64_tr_b16 a[152:153], v152 offset:4160
  ds_read_b64_tr_b16 a[154:155], v153 offset:4160
  ds_read_b64_tr_b16 a[156:157], v154 offset:4160
  ds_read_b64_tr_b16 a[158:159], v155 offset:4160
  s_waitcnt lgkmcnt(0)
  s_waitcnt vmcnt(20)
  ds_read_b64_tr_b16 a[160:161], v152 offset:8192
  ds_read_b64_tr_b16 a[162:163], v153 offset:8192
  ds_read_b64_tr_b16 a[164:165], v154 offset:8192
  ds_read_b64_tr_b16 a[166:167], v155 offset:8192
  ds_read_b64_tr_b16 a[168:169], v152 offset:8256
  ds_read_b64_tr_b16 a[170:171], v153 offset:8256
  ds_read_b64_tr_b16 a[172:173], v154 offset:8256
  ds_read_b64_tr_b16 a[174:175], v155 offset:8256
  s_waitcnt lgkmcnt(0)
  s_waitcnt vmcnt(16)
  ds_read_b64_tr_b16 a[176:177], v152 offset:12288
  ds_read_b64_tr_b16 a[178:179], v153 offset:12288
  ds_read_b64_tr_b16 a[180:181], v154 offset:12288
  ds_read_b64_tr_b16 a[182:183], v155 offset:12288
  ds_read_b64_tr_b16 a[184:185], v152 offset:12352
  ds_read_b64_tr_b16 a[186:187], v153 offset:12352
  ds_read_b64_tr_b16 a[188:189], v154 offset:12352
  ds_read_b64_tr_b16 a[190:191], v155 offset:12352
  s_waitcnt lgkmcnt(0)
  s_waitcnt vmcnt(12)
  ds_read_b64_tr_b16 a[192:193], v152 offset:16384
  ds_read_b64_tr_b16 a[194:195], v153 offset:16384
  ds_read_b64_tr_b16 a[196:197], v154 offset:16384
  ds_read_b64_tr_b16 a[198:199], v155 offset:16384
  ds_read_b64_tr_b16 a[200:201], v152 offset:16448
  ds_read_b64_tr_b16 a[202:203], v153 offset:16448
  ds_read_b64_tr_b16 a[204:205], v154 offset:16448
  ds_read_b64_tr_b16 a[206:207], v155 offset:16448
  s_waitcnt lgkmcnt(0)
  s_waitcnt vmcnt(8)
  ds_read_b64_tr_b16 a[208:209], v152 offset:20480
  ds_read_b64_tr_b16 a[210:211], v153 offset:20480
  ds_read_b64_tr_b16 a[212:213], v154 offset:20480
  ds_read_b64_tr_b16 a[214:215], v155 offset:20480
  ds_read_b64_tr_b16 a[216:217], v152 offset:20544
  ds_read_b64_tr_b16 a[218:219], v153 offset:20544
  ds_read_b64_tr_b16 a[220:221], v154 offset:20544
  ds_read_b64_tr_b16 a[222:223], v155 offset:20544
  s_waitcnt lgkmcnt(0)
  s_waitcnt vmcnt(4)
  ds_read_b64_tr_b16 a[224:225], v152 offset:24576
  ds_read_b64_tr_b16 a[226:227], v153 offset:24576
  ds_read_b64_tr_b16 a[228:229], v154 offset:24576
  ds_read_b64_tr_b16 a[230:231], v155 offset:24576
  ds_read_b64_tr_b16 a[232:233], v152 offset:24640
  ds_read_b64_tr_b16 a[234:235], v153 offset:24640
  ds_read_b64_tr_b16 a[236:237], v154 offset:24640
  ds_read_b64_tr_b16 a[238:239], v155 offset:24640
  s_waitcnt lgkmcnt(0)
  s_waitcnt vmcnt(0)
  ds_read_b64_tr_b16 a[240:241], v152 offset:28672
  ds_read_b64_tr_b16 a[242:243], v153 offset:28672
  ds_read_b64_tr_b16 a[244:245], v154 offset:28672
  ds_read_b64_tr_b16 a[246:247], v155 offset:28672
  ds_read_b64_tr_b16 a[248:249], v152 offset:28736
  ds_read_b64_tr_b16 a[250:251], v153 offset:28736
  ds_read_b64_tr_b16 a[252:253], v154 offset:28736
  ds_read_b64_tr_b16 a[254:255], v155 offset:28736
  s_waitcnt lgkmcnt(0)
  s_lshl_b32 s26, s48, 2
  s_add_u32 s26, s26, s16
  s_lshl_b32 s27, s26, 6
  s_add_u32 s27, s27, s50
  s_lshl_b32 s19, s27, 13
  s_lshl_b32 s27, s50, 5
  s_add_u32 s27, s27, s26
  s_mul_i32 s27, s27, 4096
  s_add_u32 s20, s27, 135266304
  s_lshl_b32 s25, s16, 12
  s_add_u32 s25, s25, 65536
  s_lshl_b32 s26, s16, 13
  v_add_u32 v3, s26, v2
  v_lshrrev_b32 v16, 5, v1
  v_and_b32 v17, 31, v1
  v_bfe_u32 v18, v1, 4, 1
  v_lshl_add_u32 v18, v18, 1, v16
  v_and_b32 v19, 15, v1
  v_lshl_add_u32 v18, v18, 4, v19
  v_lshl_add_u32 v5, v18, 4, s25
  v_bfe_u32 v18, v1, 2, 2
  v_lshl_add_u32 v18, v16, 2, v18
  v_and_b32 v19, 1, v1
  v_lshl_add_u32 v18, v19, 4, v18
  v_lshl_add_u32 v4, v18, 4, s25
  v_lshlrev_b32 v16, 2, v16
  v_sub_u32 v17, v17, v16
  v_mov_b32 v18, 0xf149f2ca
  v_cmp_le_i32 vcc, 0, v17
  s_nop 1
  v_cndmask_b32 v240, v18, 0, vcc
  v_cmp_le_i32 vcc, 1, v17
  s_nop 1
  v_cndmask_b32 v241, v18, 0, vcc
  v_cmp_le_i32 vcc, 2, v17
  s_nop 1
  v_cndmask_b32 v242, v18, 0, vcc
  v_cmp_le_i32 vcc, 3, v17
  s_nop 1
  v_cndmask_b32 v243, v18, 0, vcc
  v_cmp_le_i32 vcc, 8, v17
  s_nop 1
  v_cndmask_b32 v244, v18, 0, vcc
  v_cmp_le_i32 vcc, 9, v17
  s_nop 1
  v_cndmask_b32 v245, v18, 0, vcc
  v_cmp_le_i32 vcc, 10, v17
  s_nop 1
  v_cndmask_b32 v246, v18, 0, vcc
  v_cmp_le_i32 vcc, 11, v17
  s_nop 1
  v_cndmask_b32 v247, v18, 0, vcc
  v_cmp_le_i32 vcc, 16, v17
  s_nop 1
  v_cndmask_b32 v248, v18, 0, vcc
  v_cmp_le_i32 vcc, 17, v17
  s_nop 1
  v_cndmask_b32 v249, v18, 0, vcc
  v_cmp_le_i32 vcc, 18, v17
  s_nop 1
  v_cndmask_b32 v250, v18, 0, vcc
  v_cmp_le_i32 vcc, 19, v17
  s_nop 1
  v_cndmask_b32 v251, v18, 0, vcc
  v_cmp_le_i32 vcc, 24, v17
  s_nop 1
  v_cndmask_b32 v252, v18, 0, vcc
  v_cmp_le_i32 vcc, 25, v17
  s_nop 1
  v_cndmask_b32 v253, v18, 0, vcc
  v_cmp_le_i32 vcc, 26, v17
  s_nop 1
  v_cndmask_b32 v254, v18, 0, vcc
  v_cmp_le_i32 vcc, 27, v17
  s_nop 1
  v_cndmask_b32 v255, v18, 0, vcc
  v_mov_b32 v21, v2
  s_barrier
  s_lshl_b32 s77, s48, 2
  s_add_u32 s77, s77, s16
  s_mul_i32 s78, s77, 896
  s_add_u32 s76, s78, 148898304
  s_mov_b32 s71, 0
  s_branch M_sg_188
M_sw_187:
  s_sleep 8
  s_add_u32 s71, s71, 1
  s_cmp_gt_u32 s71, 262144
  s_cbranch_scc1 M_exit
M_sg_188:
  s_mov_b32 s79, 0
  s_atomic_or s79, s[72:73], s76 glc
  s_waitcnt lgkmcnt(0)
  s_cmp_lt_u32 s79, 16
  s_cbranch_scc1 M_sw_187
  s_add_u32 s76, s78, 148898048
  s_mov_b32 s71, 0
  s_branch M_sg_190
M_sw_189:
  s_sleep 8
  s_add_u32 s71, s71, 1
  s_cmp_gt_u32 s71, 262144
  s_cbranch_scc1 M_exit
M_sg_190:
  s_mov_b32 s79, 0
  s_atomic_or s79, s[72:73], s76 glc
  s_waitcnt lgkmcnt(0)
  s_cmp_lt_u32 s79, 16
  s_cbranch_scc1 M_sw_189
M_xok_186:
  s_lshl_b32 s77, s77, 7
  s_add_u32 s54, s77, 148926464
  s_add_u32 s52, s50, 1
  s_mov_b32 s53, 0
  s_mov_b32 s30, 0x200
  s_add_u32 s28, s19, 50331648
  buffer_load_dwordx4 v[144:147], v21, s[4:7], s28 offen offset:0 sc1
  buffer_load_dwordx4 v[148:151], v21, s[4:7], s28 offen offset:1024 sc1
  buffer_load_dwordx4 v[152:155], v21, s[4:7], s28 offen offset:2048 sc1
  buffer_load_dwordx4 v[156:159], v21, s[4:7], s28 offen offset:3072 sc1
  s_add_u32 s29, s19, 50335744
  buffer_load_dwordx4 v[160:163], v21, s[4:7], s29 offen offset:0 sc1
  buffer_load_dwordx4 v[164:167], v21, s[4:7], s29 offen offset:1024 sc1
  buffer_load_dwordx4 v[168:171], v21, s[4:7], s29 offen offset:2048 sc1
  buffer_load_dwordx4 v[172:175], v21, s[4:7], s29 offen offset:3072 sc1
  s_add_u32 s28, s19, 67108864
  buffer_load_dwordx4 v[176:179], v21, s[4:7], s28 offen offset:0 sc1
  buffer_load_dwordx4 v[180:183], v21, s[4:7], s28 offen offset:1024 sc1
  buffer_load_dwordx4 v[184:187], v21, s[4:7], s28 offen offset:2048 sc1
  buffer_load_dwordx4 v[188:191], v21, s[4:7], s28 offen offset:3072 sc1
  s_add_u32 s29, s19, 67112960
  buffer_load_dwordx4 v[192:195], v21, s[4:7], s29 offen offset:0 sc1
  buffer_load_dwordx4 v[196:199], v21, s[4:7], s29 offen offset:1024 sc1
  buffer_load_dwordx4 v[200:203], v21, s[4:7], s29 offen offset:2048 sc1
  buffer_load_dwordx4 v[204:207], v21, s[4:7], s29 offen offset:3072 sc1
  s_add_u32 s28, s19, 83886080
  buffer_load_dwordx4 v[208:211], v21, s[4:7], s28 offen offset:0 sc1
  buffer_load_dwordx4 v[212:215], v21, s[4:7], s28 offen offset:1024 sc1
  buffer_load_dwordx4 v[216:219], v21, s[4:7], s28 offen offset:2048 sc1
  buffer_load_dwordx4 v[220:223], v21, s[4:7], s28 offen offset:3072 sc1
  s_add_u32 s29, s19, 83890176
  buffer_load_dwordx4 v[224:227], v21, s[4:7], s29 offen offset:0 sc1
  buffer_load_dwordx4 v[228:231], v21, s[4:7], s29 offen offset:1024 sc1
  buffer_load_dwordx4 v[232:235], v21, s[4:7], s29 offen offset:2048 sc1
  buffer_load_dwordx4 v[236:239], v21, s[4:7], s29 offen offset:3072 sc1
  s_mov_b32 s24, 0
  v_mov_b32 v22, 0x40000000
  s_sub_u32 s21, s21, s22
F_top_191:
  s_waitcnt vmcnt(8)
  v_mfma_f32_32x32x16_bf16 v[24:39], v[176:179], v[144:147], v[240:255]
  s_nop 1
  v_cvt_pk_bf16_f32 v128, v64, v65
  v_cvt_pk_bf16_f32 v129, v66, v67
  v_cvt_pk_bf16_f32 v130, v68, v69
  v_cvt_pk_bf16_f32 v131, v70, v71
  v_mfma_f32_32x32x16_bf16 v[24:39], v[180:183], v[148:151], v[24:39]
  buffer_store_dwordx4 v[128:131], v22, s[4:7], s21 offen offset:0 sc1
  v_mfma_f32_32x32x16_bf16 v[24:39], v[184:187], v[152:155], v[24:39]
  v_cvt_pk_bf16_f32 v132, v72, v73
  v_cvt_pk_bf16_f32 v133, v74, v75
  v_cvt_pk_bf16_f32 v134, v76, v77
  v_cvt_pk_bf16_f32 v135, v78, v79
  v_mfma_f32_32x32x16_bf16 v[24:39], v[188:191], v[156:159], v[24:39]
  buffer_store_dwordx4 v[132:135], v22, s[4:7], s21 offen offset:256 sc1
  v_mfma_f32_32x32x16_bf16 v[24:39], v[192:195], v[160:163], v[24:39]
  v_cvt_pk_bf16_f32 v136, v80, v81
  v_cvt_pk_bf16_f32 v137, v82, v83
  v_cvt_pk_bf16_f32 v138, v84, v85
  v_cvt_pk_bf16_f32 v139, v86, v87
  v_mfma_f32_32x32x16_bf16 v[24:39], v[196:199], v[164:167], v[24:39]
  buffer_store_dwordx4 v[136:139], v22, s[4:7], s21 offen offset:2048 sc1
  v_mfma_f32_32x32x16_bf16 v[24:39], v[200:203], v[168:171], v[24:39]
  v_cvt_pk_bf16_f32 v140, v88, v89
  v_cvt_pk_bf16_f32 v141, v90, v91
  v_cvt_pk_bf16_f32 v142, v92, v93
  v_cvt_pk_bf16_f32 v143, v94, v95
  v_mfma_f32_32x32x16_bf16 v[24:39], v[204:207], v[172:175], v[24:39]
  buffer_store_dwordx4 v[140:143], v22, s[4:7], s21 offen offset:2304 sc1
  s_add_u32 s21, s21, s22
  v_mov_b32 v22, v20
  s_cmp_lg_u32 s24, 0
  s_cbranch_scc1 F_have_192
  s_cmp_le_u32 s52, 58
  s_cbranch_scc1 M_dp_193
  s_mov_b32 s71, 0
  v_add_u32 v16, s25, v2
  s_branch M_dp_195
M_dp_194:
  s_sleep 1
  s_add_u32 s71, s71, 1
  s_cmp_gt_u32 s71, 262144
  s_cbranch_scc1 M_exit
M_dp_195:
  buffer_load_dword v23, off, s[4:7], s54 sc1
  buffer_load_dwordx4 v[96:99], v2, s[4:7], s20 offen offset:0 sc1
  buffer_load_dwordx4 v[100:103], v2, s[4:7], s20 offen offset:1024 sc1
  buffer_load_dwordx4 v[104:107], v2, s[4:7], s20 offen offset:2048 sc1
  buffer_load_dwordx4 v[108:111], v2, s[4:7], s20 offen offset:3072 sc1
  s_waitcnt vmcnt(3)
  v_max_u32 v17, v96, v97
  v_max3_u32 v17, v17, v98, v99
  s_waitcnt vmcnt(2)
  v_max3_u32 v17, v17, v100, v101
  v_max3_u32 v17, v17, v102, v103
  s_waitcnt vmcnt(1)
  v_max3_u32 v17, v17, v104, v105
  v_max3_u32 v17, v17, v106, v107
  s_waitcnt vmcnt(0)
  v_max3_u32 v17, v17, v108, v109
  v_max3_u32 v17, v17, v110, v111
  v_cmp_eq_u32 vcc, -1, v17
  s_cbranch_vccz M_dp_196
  v_cmp_gt_u32 vcc, s52, v23
  s_cbranch_vccnz M_dp_194
  s_branch M_dp_193
M_dp_196:
  ds_write_b128 v16, v[96:99] offset:0
  ds_write_b128 v16, v[100:103] offset:1024
  ds_write_b128 v16, v[104:107] offset:2048
  ds_write_b128 v16, v[108:111] offset:3072
  s_branch F_have_192
M_dp_193:
  v_mov_b32 v16, s54
  v_mov_b32 v17, s52
  s_mov_b32 s71, 0
  s_branch M_vg_198
M_vw_197:
  s_sleep 2
  s_add_u32 s71, s71, 1
  s_cmp_gt_u32 s71, 262144
  s_cbranch_scc1 M_exit
M_vg_198:
  buffer_load_dword v23, v16, s[4:7], 0 offen sc1
  s_waitcnt vmcnt(0)
  v_cmp_lt_u32 vcc, v23, v17
  s_cbranch_vccnz M_vw_197
  s_mov_b32 m0, s25
  s_nop 0
  buffer_load_dwordx4 v2, s[4:7], s20 offen offset:0 sc1 lds
  buffer_load_dwordx4 v2, s[4:7], s20 offen offset:1024 sc1 lds
  buffer_load_dwordx4 v2, s[4:7], s20 offen offset:2048 sc1 lds
  buffer_load_dwordx4 v2, s[4:7], s20 offen offset:3072 sc1 lds
  s_waitcnt vmcnt(0)
F_have_192:
  ds_read_b64_tr_b16 v[176:177], v4 offset:8
  ds_read_b64_tr_b16 v[178:179], v4 offset:136
  ds_read_b64_tr_b16 v[180:181], v4 offset:520
  ds_read_b64_tr_b16 v[182:183], v4 offset:648
  ds_read_b64_tr_b16 v[184:185], v4 offset:1032
  ds_read_b64_tr_b16 v[186:187], v4 offset:1160
  ds_read_b64_tr_b16 v[188:189], v4 offset:1544
  ds_read_b64_tr_b16 v[190:191], v4 offset:1672
  ds_read_b64_tr_b16 v[192:193], v4 offset:2056
  ds_read_b64_tr_b16 v[194:195], v4 offset:2184
  ds_read_b64_tr_b16 v[196:197], v4 offset:2568
  ds_read_b64_tr_b16 v[198:199], v4 offset:2696
  s_sub_u32 s23, s23, 1
  s_cmp_gt_u32 s23, 0
  s_cselect_b32 s26, s51, 0
  s_cselect_b32 s27, 0, 0x40000000
  v_or_b32 v21, s27, v21
  s_lshl_b32 s27, s26, 13
  s_add_u32 s19, s19, s27
  s_mul_i32 s27, s26, 131072
  s_add_u32 s20, s20, s27
  s_cmp_lg_u32 s23, 24
  s_cbranch_scc1 M_xok_199
  s_lshl_b32 s77, s48, 2
  s_add_u32 s77, s77, s16
  s_mul_i32 s78, s77, 896
  s_add_u32 s76, s78, 148898304
  s_mov_b32 s71, 0
  s_branch M_sg_201
M_sw_200:
  s_sleep 8
  s_add_u32 s71, s71, 1
  s_cmp_gt_u32 s71, 262144
  s_cbranch_scc1 M_exit
M_sg_201:
  s_mov_b32 s79, 0
  s_atomic_or s79, s[72:73], s76 glc
  s_waitcnt lgkmcnt(0)
  s_cmp_lt_u32 s79, 32
  s_cbranch_scc1 M_sw_200
  s_add_u32 s76, s78, 148898432
  s_mov_b32 s71, 0
  s_branch M_sg_203
M_sw_202:
  s_sleep 8
  s_add_u32 s71, s71, 1
  s_cmp_gt_u32 s71, 262144
  s_cbranch_scc1 M_exit
M_sg_203:
  s_mov_b32 s79, 0
  s_atomic_or s79, s[72:73], s76 glc
  s_waitcnt lgkmcnt(0)
  s_cmp_lt_u32 s79, 32
  s_cbranch_scc1 M_sw_202
  s_add_u32 s76, s78, 148898048
  s_mov_b32 s71, 0
  s_branch M_sg_205
M_sw_204:
  s_sleep 8
  s_add_u32 s71, s71, 1
  s_cmp_gt_u32 s71, 262144
  s_cbranch_scc1 M_exit
M_sg_205:
  s_mov_b32 s79, 0
  s_atomic_or s79, s[72:73], s76 glc
  s_waitcnt lgkmcnt(0)
  s_cmp_lt_u32 s79, 30
  s_cbranch_scc1 M_sw_204
  s_add_u32 s76, s78, 148898176
  s_mov_b32 s71, 0
  s_branch M_sg_207
M_sw_206:
  s_sleep 8
  s_add_u32 s71, s71, 1
  s_cmp_gt_u32 s71, 262144
  s_cbranch_scc1 M_exit
M_sg_207:
  s_mov_b32 s79, 0
  s_atomic_or s79, s[72:73], s76 glc
  s_waitcnt lgkmcnt(0)
  s_cmp_lt_u32 s79, 34
  s_cbranch_scc1 M_sw_206
M_xok_199:
  s_waitcnt lgkmcnt(10)
  v_mfma_f32_32x32x16_bf16 v[40:55], v[176:179], v[144:147], 0
  ds_read_b64_tr_b16 v[200:201], v4 offset:3080
  ds_read_b64_tr_b16 v[202:203], v4 offset:3208
  v_max_f32 v6, v24, v25
  s_waitcnt lgkmcnt(10)
  v_mfma_f32_32x32x16_bf16 v[40:55], v[180:183], v[148:151], v[40:55]
  ds_read_b64_tr_b16 v[204:205], v4 offset:3592
  ds_read_b64_tr_b16 v[206:207], v4 offset:3720
  v_max3_f32 v6, v6, v26, v27
  s_waitcnt lgkmcnt(10)
  v_mfma_f32_32x32x16_bf16 v[40:55], v[184:187], v[152:155], v[40:55]
  ds_read_b64 v[56:57], v5 offset:0
  ds_read_b64 v[58:59], v5 offset:1024
  v_max3_f32 v6, v6, v28, v29
  s_waitcnt lgkmcnt(10)
  v_mfma_f32_32x32x16_bf16 v[40:55], v[188:191], v[156:159], v[40:55]
  ds_read_b64 v[60:61], v5 offset:2048
  ds_read_b64 v[62:63], v5 offset:3072
  v_max3_f32 v6, v6, v30, v31
  s_waitcnt lgkmcnt(10)
  v_mfma_f32_32x32x16_bf16 v[40:55], v[192:195], v[160:163], v[40:55]
  v_max3_f32 v6, v6, v32, v33
  s_waitcnt lgkmcnt(8)
  v_mfma_f32_32x32x16_bf16 v[40:55], v[196:199], v[164:167], v[40:55]
  v_max3_f32 v6, v6, v34, v35
  s_waitcnt lgkmcnt(6)
  v_mfma_f32_32x32x16_bf16 v[40:55], v[200:203], v[168:171], v[40:55]
  v_max3_f32 v6, v6, v36, v37
  s_waitcnt lgkmcnt(4)
  v_mfma_f32_32x32x16_bf16 v[40:55], v[204:207], v[172:175], v[40:55]
  v_max3_f32 v6, v6, v38, v39
  s_add_u32 s28, s19, 50331648
  buffer_load_dwordx4 v[144:147], v21, s[4:7], s28 offen offset:0 sc1
  buffer_load_dwordx4 v[148:151], v21, s[4:7], s28 offen offset:1024 sc1
  s_nop 7
  v_max3_f32 v6, v6, v40, v41
  v_max3_f32 v6, v6, v42, v43
  v_mov_b32 v16, v6
  s_nop 1
  v_permlane32_swap_b32 v6, v16
  s_nop 1
  v_max_f32 v6, v6, v16
  v_pk_add_f32 v[24:25], v[24:25], v[6:7] op_sel_hi:[1,0] neg_lo:[0,1] neg_hi:[0,1]
  v_pk_add_f32 v[26:27], v[26:27], v[6:7] op_sel_hi:[1,0] neg_lo:[0,1] neg_hi:[0,1]
  v_pk_add_f32 v[28:29], v[28:29], v[6:7] op_sel_hi:[1,0] neg_lo:[0,1] neg_hi:[0,1]
  v_pk_add_f32 v[30:31], v[30:31], v[6:7] op_sel_hi:[1,0] neg_lo:[0,1] neg_hi:[0,1]
  v_pk_add_f32 v[32:33], v[32:33], v[6:7] op_sel_hi:[1,0] neg_lo:[0,1] neg_hi:[0,1]
  v_pk_add_f32 v[34:35], v[34:35], v[6:7] op_sel_hi:[1,0] neg_lo:[0,1] neg_hi:[0,1]
  v_pk_add_f32 v[36:37], v[36:37], v[6:7] op_sel_hi:[1,0] neg_lo:[0,1] neg_hi:[0,1]
  v_pk_add_f32 v[38:39], v[38:39], v[6:7] op_sel_hi:[1,0] neg_lo:[0,1] neg_hi:[0,1]
  v_pk_add_f32 v[40:41], v[40:41], v[6:7] op_sel_hi:[1,0] neg_lo:[0,1] neg_hi:[0,1]
  v_pk_add_f32 v[42:43], v[42:43], v[6:7] op_sel_hi:[1,0] neg_lo:[0,1] neg_hi:[0,1]
  v_exp_f32 v24, v24
  v_exp_f32 v25, v25
  v_exp_f32 v26, v26
  v_exp_f32 v27, v27
  v_exp_f32 v28, v28
  v_exp_f32 v29, v29
  v_exp_f32 v30, v30
  v_exp_f32 v31, v31
  v_exp_f32 v32, v32
  v_exp_f32 v33, v33
  buffer_load_dwordx4 v[152:155], v21, s[4:7], s28 offen offset:2048 sc1
  v_exp_f32 v34, v34
  v_exp_f32 v35, v35
  v_exp_f32 v36, v36
  v_exp_f32 v37, v37
  v_exp_f32 v38, v38
  v_exp_f32 v39, v39
  v_exp_f32 v40, v40
  v_exp_f32 v41, v41
  v_exp_f32 v42, v42
  v_exp_f32 v43, v43
  v_pk_add_f32 v[16:17], v[24:25], v[26:27]
  v_pk_add_f32 v[16:17], v[16:17], v[28:29]
  v_pk_add_f32 v[16:17], v[16:17], v[30:31]
  v_pk_add_f32 v[16:17], v[16:17], v[32:33]
  v_pk_add_f32 v[16:17], v[16:17], v[34:35]
  v_pk_add_f32 v[16:17], v[16:17], v[36:37]
  v_pk_add_f32 v[16:17], v[16:17], v[38:39]
  v_pk_add_f32 v[16:17], v[16:17], v[40:41]
  v_pk_add_f32 v[16:17], v[16:17], v[42:43]
  v_add_f32 v16, v16, v17
  v_mov_b32 v17, v16
  buffer_load_dwordx4 v[156:159], v21, s[4:7], s28 offen offset:3072 sc1
  s_nop 0
  v_permlane32_swap_b32 v16, v17
  s_nop 1
  v_add_f32 v16, v16, v17
  v_rcp_f32 v6, v16
  s_nop 0
  v_pk_mul_f32 v[24:25], v[24:25], v[6:7] op_sel_hi:[1,0]
  v_pk_mul_f32 v[26:27], v[26:27], v[6:7] op_sel_hi:[1,0]
  v_pk_mul_f32 v[28:29], v[28:29], v[6:7] op_sel_hi:[1,0]
  v_pk_mul_f32 v[30:31], v[30:31], v[6:7] op_sel_hi:[1,0]
  v_pk_mul_f32 v[32:33], v[32:33], v[6:7] op_sel_hi:[1,0]
  v_pk_mul_f32 v[34:35], v[34:35], v[6:7] op_sel_hi:[1,0]
  v_pk_mul_f32 v[36:37], v[36:37], v[6:7] op_sel_hi:[1,0]
  v_pk_mul_f32 v[38:39], v[38:39], v[6:7] op_sel_hi:[1,0]
  v_pk_mul_f32 v[40:41], v[40:41], v[6:7] op_sel_hi:[1,0]
  v_pk_mul_f32 v[42:43], v[42:43], v[6:7] op_sel_hi:[1,0]
  v_cvt_pk_bf16_f32 v128, v24, v25
  v_cvt_pk_bf16_f32 v129, v26, v27
  v_cvt_pk_bf16_f32 v130, v28, v29
  v_cvt_pk_bf16_f32 v131, v30, v31
  v_cvt_pk_bf16_f32 v132, v32, v33
  v_cvt_pk_bf16_f32 v133, v34, v35
  v_cvt_pk_bf16_f32 v134, v36, v37
  v_cvt_pk_bf16_f32 v135, v38, v39
  v_cvt_pk_bf16_f32 v136, v40, v41
  v_cvt_pk_bf16_f32 v137, v42, v43
  s_waitcnt vmcnt(8) lgkmcnt(0)
  v_mfma_f32_32x32x16_bf16 v[64:79], v[208:211], v[128:131], 0
  s_add_u32 s29, s19, 50335744
  buffer_load_dwordx4 v[160:163], v21, s[4:7], s29 offen offset:0 sc1
  v_mfma_f32_32x32x16_bf16 v[64:79], v[212:215], v[132:135], v[64:79]
  v_mfma_f32_32x32x8_bf16 v[64:79], v[56:57], v[136:137], v[64:79]
  v_mfma_f32_32x32x16_bf16 v[80:95], v[216:219], v[128:131], 0
  buffer_load_dwordx4 v[164:167], v21, s[4:7], s29 offen offset:1024 sc1
  v_mfma_f32_32x32x16_bf16 v[80:95], v[220:223], v[132:135], v[80:95]
  v_cvt_pk_bf16_f32 v24, v64, v65
  v_cvt_pk_bf16_f32 v25, v66, v67
  v_cvt_pk_bf16_f32 v26, v68, v69
  v_cvt_pk_bf16_f32 v27, v70, v71
  v_mfma_f32_32x32x8_bf16 v[80:95], v[58:59], v[136:137], v[80:95]
  ds_write_b128 v3, v[24:27] offset:0
  v_cvt_pk_bf16_f32 v28, v72, v73
  v_cvt_pk_bf16_f32 v29, v74, v75
  v_cvt_pk_bf16_f32 v30, v76, v77
  v_cvt_pk_bf16_f32 v31, v78, v79
  v_mfma_f32_32x32x16_bf16 v[96:111], v[224:227], v[128:131], 0
  ds_write_b128 v3, v[28:31] offset:1024
  buffer_load_dwordx4 v[168:171], v21, s[4:7], s29 offen offset:2048 sc1
  v_mfma_f32_32x32x16_bf16 v[96:111], v[228:231], v[132:135], v[96:111]
  v_cvt_pk_bf16_f32 v32, v80, v81
  v_cvt_pk_bf16_f32 v33, v82, v83
  v_cvt_pk_bf16_f32 v34, v84, v85
  v_cvt_pk_bf16_f32 v35, v86, v87
  v_mfma_f32_32x32x8_bf16 v[96:111], v[60:61], v[136:137], v[96:111]
  ds_write_b128 v3, v[32:35] offset:2048
  v_cvt_pk_bf16_f32 v36, v88, v89
  v_cvt_pk_bf16_f32 v37, v90, v91
  v_cvt_pk_bf16_f32 v38, v92, v93
  v_cvt_pk_bf16_f32 v39, v94, v95
  v_mfma_f32_32x32x16_bf16 v[112:127], v[232:235], v[128:131], 0
  ds_write_b128 v3, v[36:39] offset:3072
  buffer_load_dwordx4 v[172:175], v21, s[4:7], s29 offen offset:3072 sc1
  v_mfma_f32_32x32x16_bf16 v[112:127], v[236:239], v[132:135], v[112:127]
  v_cvt_pk_bf16_f32 v40, v96, v97
  v_cvt_pk_bf16_f32 v41, v98, v99
  v_cvt_pk_bf16_f32 v42, v100, v101
  v_cvt_pk_bf16_f32 v43, v102, v103
  v_mfma_f32_32x32x8_bf16 v[112:127], v[62:63], v[136:137], v[112:127]
  ds_write_b128 v3, v[40:43] offset:4096
  v_cvt_pk_bf16_f32 v44, v104, v105
  v_cvt_pk_bf16_f32 v45, v106, v107
  v_cvt_pk_bf16_f32 v46, v108, v109
  v_cvt_pk_bf16_f32 v47, v110, v111
  ds_write_b128 v3, v[44:47] offset:5120
  s_nop 5
  v_cvt_pk_bf16_f32 v48, v112, v113
  v_cvt_pk_bf16_f32 v49, v114, v115
  v_cvt_pk_bf16_f32 v50, v116, v117
  v_cvt_pk_bf16_f32 v51, v118, v119
  ds_write_b128 v3, v[48:51] offset:6144
  v_cvt_pk_bf16_f32 v52, v120, v121
  v_cvt_pk_bf16_f32 v53, v122, v123
  v_cvt_pk_bf16_f32 v54, v124, v125
  v_cvt_pk_bf16_f32 v55, v126, v127
  ds_write_b128 v3, v[52:55] offset:7168
  s_waitcnt vmcnt(8)
  s_waitcnt lgkmcnt(0)
  s_barrier
  ds_read_b128 v[24:27], v8 offset:0
  ds_read_b128 v[28:31], v9 offset:0
  ds_read_b128 v[32:35], v10 offset:0
  ds_read_b128 v[36:39], v11 offset:0
  ds_read_b128 v[40:43], v12 offset:0
  ds_read_b128 v[44:47], v13 offset:0
  buffer_load_dword v23, off, s[4:7], s54 sc1
  v_mov_b32 v16, s30
  v_min_u32 v17, 1, v0
  v_lshlrev_b32 v17, 30, v17
  buffer_store_dword v16, v17, s[4:7], s31 offen sc1
  s_add_u32 s30, s30, 1
  s_add_u32 s52, s52, 2
  s_waitcnt lgkmcnt(5)
  v_mfma_f32_16x16x32_bf16 v[64:67], a[0:3], v[24:27], 0
  s_add_u32 s28, s19, 67108864
  ds_read_b128 v[48:51], v14 offset:0
  v_mfma_f32_16x16x32_bf16 v[68:71], a[4:7], v[24:27], 0
  v_mfma_f32_16x16x32_bf16 v[80:83], a[8:11], v[24:27], 0
  v_mfma_f32_16x16x32_bf16 v[84:87], a[12:15], v[24:27], 0
  s_waitcnt lgkmcnt(5)
  v_mfma_f32_16x16x32_bf16 v[72:75], a[0:3], v[28:31], 0
  ds_read_b128 v[52:55], v15 offset:0
  v_mfma_f32_16x16x32_bf16 v[76:79], a[4:7], v[28:31], 0
  v_mfma_f32_16x16x32_bf16 v[88:91], a[8:11], v[28:31], 0
  buffer_load_dwordx4 v[176:179], v21, s[4:7], s28 offen offset:0 sc1
  v_mfma_f32_16x16x32_bf16 v[92:95], a[12:15], v[28:31], 0
  s_waitcnt lgkmcnt(5)
  v_mfma_f32_16x16x32_bf16 v[64:67], a[16:19], v[32:35], v[64:67]
  ds_read_b128 v[24:27], v8 offset:8192
  v_mfma_f32_16x16x32_bf16 v[68:71], a[20:23], v[32:35], v[68:71]
  v_mfma_f32_16x16x32_bf16 v[80:83], a[24:27], v[32:35], v[80:83]
  v_mfma_f32_16x16x32_bf16 v[84:87], a[28:31], v[32:35], v[84:87]
  s_waitcnt lgkmcnt(5)
  v_mfma_f32_16x16x32_bf16 v[72:75], a[16:19], v[36:39], v[72:75]
  ds_read_b128 v[28:31], v9 offset:8192
  v_mfma_f32_16x16x32_bf16 v[76:79], a[20:23], v[36:39], v[76:79]
  v_mfma_f32_16x16x32_bf16 v[88:91], a[24:27], v[36:39], v[88:91]
  buffer_load_dwordx4 v[180:183], v21, s[4:7], s28 offen offset:1024 sc1
  v_mfma_f32_16x16x32_bf16 v[92:95], a[28:31], v[36:39], v[92:95]
  s_waitcnt lgkmcnt(5)
  v_mfma_f32_16x16x32_bf16 v[64:67], a[32:35], v[40:43], v[64:67]
  ds_read_b128 v[32:35], v10 offset:8192
  v_mfma_f32_16x16x32_bf16 v[68:71], a[36:39], v[40:43], v[68:71]
  v_mfma_f32_16x16x32_bf16 v[80:83], a[40:43], v[40:43], v[80:83]
  v_mfma_f32_16x16x32_bf16 v[84:87], a[44:47], v[40:43], v[84:87]
  s_waitcnt lgkmcnt(5)
  v_mfma_f32_16x16x32_bf16 v[72:75], a[32:35], v[44:47], v[72:75]
  ds_read_b128 v[36:39], v11 offset:8192
  v_mfma_f32_16x16x32_bf16 v[76:79], a[36:39], v[44:47], v[76:79]
  v_mfma_f32_16x16x32_bf16 v[88:91], a[40:43], v[44:47], v[88:91]
  buffer_load_dwordx4 v[184:187], v21, s[4:7], s28 offen offset:2048 sc1
  v_mfma_f32_16x16x32_bf16 v[92:95], a[44:47], v[44:47], v[92:95]
  s_waitcnt lgkmcnt(5)
  v_mfma_f32_16x16x32_bf16 v[64:67], a[48:51], v[48:51], v[64:67]
  ds_read_b128 v[40:43], v12 offset:8192
  v_mfma_f32_16x16x32_bf16 v[68:71], a[52:55], v[48:51], v[68:71]
  v_mfma_f32_16x16x32_bf16 v[80:83], a[56:59], v[48:51], v[80:83]
  v_mfma_f32_16x16x32_bf16 v[84:87], a[60:63], v[48:51], v[84:87]
  s_waitcnt lgkmcnt(5)
  v_mfma_f32_16x16x32_bf16 v[72:75], a[48:51], v[52:55], v[72:75]
  ds_read_b128 v[44:47], v13 offset:8192
  v_mfma_f32_16x16x32_bf16 v[76:79], a[52:55], v[52:55], v[76:79]
  v_mfma_f32_16x16x32_bf16 v[88:91], a[56:59], v[52:55], v[88:91]
  buffer_load_dwordx4 v[188:191], v21, s[4:7], s28 offen offset:3072 sc1
  v_mfma_f32_16x16x32_bf16 v[92:95], a[60:63], v[52:55], v[92:95]
  s_waitcnt lgkmcnt(5)
  v_mfma_f32_16x16x32_bf16 v[64:67], a[64:67], v[24:27], v[64:67]
  s_add_u32 s29, s19, 67112960
  ds_read_b128 v[48:51], v14 offset:8192
  v_mfma_f32_16x16x32_bf16 v[68:71], a[68:71], v[24:27], v[68:71]
  v_mfma_f32_16x16x32_bf16 v[80:83], a[72:75], v[24:27], v[80:83]
  v_mfma_f32_16x16x32_bf16 v[84:87], a[76:79], v[24:27], v[84:87]
  s_waitcnt lgkmcnt(5)
  v_mfma_f32_16x16x32_bf16 v[72:75], a[64:67], v[28:31], v[72:75]
  ds_read_b128 v[52:55], v15 offset:8192
  v_mfma_f32_16x16x32_bf16 v[76:79], a[68:71], v[28:31], v[76:79]
  v_mfma_f32_16x16x32_bf16 v[88:91], a[72:75], v[28:31], v[88:91]
  buffer_load_dwordx4 v[192:195], v21, s[4:7], s29 offen offset:0 sc1
  v_mfma_f32_16x16x32_bf16 v[92:95], a[76:79], v[28:31], v[92:95]
  s_waitcnt lgkmcnt(5)
  v_mfma_f32_16x16x32_bf16 v[64:67], a[80:83], v[32:35], v[64:67]
  ds_read_b128 v[24:27], v8 offset:16384
  v_mfma_f32_16x16x32_bf16 v[68:71], a[84:87], v[32:35], v[68:71]
  v_mfma_f32_16x16x32_bf16 v[80:83], a[88:91], v[32:35], v[80:83]
  v_mfma_f32_16x16x32_bf16 v[84:87], a[92:95], v[32:35], v[84:87]
  s_waitcnt lgkmcnt(5)
  v_mfma_f32_16x16x32_bf16 v[72:75], a[80:83], v[36:39], v[72:75]
  ds_read_b128 v[28:31], v9 offset:16384
  v_mfma_f32_16x16x32_bf16 v[76:79], a[84:87], v[36:39], v[76:79]
  v_mfma_f32_16x16x32_bf16 v[88:91], a[88:91], v[36:39], v[88:91]
  buffer_load_dwordx4 v[196:199], v21, s[4:7], s29 offen offset:1024 sc1
  v_mfma_f32_16x16x32_bf16 v[92:95], a[92:95], v[36:39], v[92:95]
  s_waitcnt lgkmcnt(5)
  v_mfma_f32_16x16x32_bf16 v[64:67], a[96:99], v[40:43], v[64:67]
  ds_read_b128 v[32:35], v10 offset:16384
  v_mfma_f32_16x16x32_bf16 v[68:71], a[100:103], v[40:43], v[68:71]
  v_mfma_f32_16x16x32_bf16 v[80:83], a[104:107], v[40:43], v[80:83]
  v_mfma_f32_16x16x32_bf16 v[84:87], a[108:111], v[40:43], v[84:87]
  s_waitcnt lgkmcnt(5)
  s_waitcnt vmcnt(7)
  v_readfirstlane_b32 s53, v23
  s_nop 0
  s_cmp_ge_u32 s53, s52
  s_cselect_b32 s24, 1, 0
  s_cbranch_scc0 F_nopre_208
  s_mov_b32 m0, s25
  s_nop 0
  buffer_load_dwordx4 v2, s[4:7], s20 offen offset:0 sc1 lds
  buffer_load_dwordx4 v2, s[4:7], s20 offen offset:1024 sc1 lds
  buffer_load_dwordx4 v2, s[4:7], s20 offen offset:2048 sc1 lds
  buffer_load_dwordx4 v2, s[4:7], s20 offen offset:3072 sc1 lds
F_nopre_208:
  v_mfma_f32_16x16x32_bf16 v[72:75], a[96:99], v[44:47], v[72:75]
  ds_read_b128 v[36:39], v11 offset:16384
  v_mfma_f32_16x16x32_bf16 v[76:79], a[100:103], v[44:47], v[76:79]
  v_mfma_f32_16x16x32_bf16 v[88:91], a[104:107], v[44:47], v[88:91]
  buffer_load_dwordx4 v[200:203], v21, s[4:7], s29 offen offset:2048 sc1
  v_mfma_f32_16x16x32_bf16 v[92:95], a[108:111], v[44:47], v[92:95]
  s_waitcnt lgkmcnt(5)
  v_mfma_f32_16x16x32_bf16 v[64:67], a[112:115], v[48:51], v[64:67]
  ds_read_b128 v[40:43], v12 offset:16384
  v_mfma_f32_16x16x32_bf16 v[68:71], a[116:119], v[48:51], v[68:71]
  v_mfma_f32_16x16x32_bf16 v[80:83], a[120:123], v[48:51], v[80:83]
  v_mfma_f32_16x16x32_bf16 v[84:87], a[124:127], v[48:51], v[84:87]
  s_waitcnt lgkmcnt(5)
  v_mfma_f32_16x16x32_bf16 v[72:75], a[112:115], v[52:55], v[72:75]
  ds_read_b128 v[44:47], v13 offset:16384
  v_mfma_f32_16x16x32_bf16 v[76:79], a[116:119], v[52:55], v[76:79]
  v_mfma_f32_16x16x32_bf16 v[88:91], a[120:123], v[52:55], v[88:91]
  buffer_load_dwordx4 v[204:207], v21, s[4:7], s29 offen offset:3072 sc1
  v_mfma_f32_16x16x32_bf16 v[92:95], a[124:127], v[52:55], v[92:95]
  s_waitcnt lgkmcnt(5)
  v_mfma_f32_16x16x32_bf16 v[64:67], a[128:131], v[24:27], v[64:67]
  s_add_u32 s28, s19, 83886080
  ds_read_b128 v[48:51], v14 offset:16384
  v_mfma_f32_16x16x32_bf16 v[68:71], a[132:135], v[24:27], v[68:71]
  v_mfma_f32_16x16x32_bf16 v[80:83], a[136:139], v[24:27], v[80:83]
  v_mfma_f32_16x16x32_bf16 v[84:87], a[140:143], v[24:27], v[84:87]
  s_waitcnt lgkmcnt(5)
  v_mfma_f32_16x16x32_bf16 v[72:75], a[128:131], v[28:31], v[72:75]
  ds_read_b128 v[52:55], v15 offset:16384
  v_mfma_f32_16x16x32_bf16 v[76:79], a[132:135], v[28:31], v[76:79]
  v_mfma_f32_16x16x32_bf16 v[88:91], a[136:139], v[28:31], v[88:91]
  buffer_load_dwordx4 v[208:211], v21, s[4:7], s28 offen offset:0 sc1
  v_mfma_f32_16x16x32_bf16 v[92:95], a[140:143], v[28:31], v[92:95]
  s_waitcnt lgkmcnt(5)
  v_mfma_f32_16x16x32_bf16 v[64:67], a[144:147], v[32:35], v[64:67]
  ds_read_b128 v[24:27], v8 offset:24576
  v_mfma_f32_16x16x32_bf16 v[68:71], a[148:151], v[32:35], v[68:71]
  v_mfma_f32_16x16x32_bf16 v[80:83], a[152:155], v[32:35], v[80:83]
  v_mfma_f32_16x16x32_bf16 v[84:87], a[156:159], v[32:35], v[84:87]
  s_waitcnt lgkmcnt(5)
  v_mfma_f32_16x16x32_bf16 v[72:75], a[144:147], v[36:39], v[72:75]
  ds_read_b128 v[28:31], v9 offset:24576
  v_mfma_f32_16x16x32_bf16 v[76:79], a[148:151], v[36:39], v[76:79]
  v_mfma_f32_16x16x32_bf16 v[88:91], a[152:155], v[36:39], v[88:91]
  buffer_load_dwordx4 v[212:215], v21, s[4:7], s28 offen offset:1024 sc1
  v_mfma_f32_16x16x32_bf16 v[92:95], a[156:159], v[36:39], v[92:95]
  s_waitcnt lgkmcnt(5)
  v_mfma_f32_16x16x32_bf16 v[64:67], a[160:163], v[40:43], v[64:67]
  ds_read_b128 v[32:35], v10 offset:24576
  v_mfma_f32_16x16x32_bf16 v[68:71], a[164:167], v[40:43], v[68:71]
  v_mfma_f32_16x16x32_bf16 v[80:83], a[168:171], v[40:43], v[80:83]
  v_mfma_f32_16x16x32_bf16 v[84:87], a[172:175], v[40:43], v[84:87]
  s_waitcnt lgkmcnt(5)
  v_mfma_f32_16x16x32_bf16 v[72:75], a[160:163], v[44:47], v[72:75]
  ds_read_b128 v[36:39], v11 offset:24576
  v_mfma_f32_16x16x32_bf16 v[76:79], a[164:167], v[44:47], v[76:79]
  v_mfma_f32_16x16x32_bf16 v[88:91], a[168:171], v[44:47], v[88:91]
  buffer_load_dwordx4 v[216:219], v21, s[4:7], s28 offen offset:2048 sc1
  v_mfma_f32_16x16x32_bf16 v[92:95], a[172:175], v[44:47], v[92:95]
  s_waitcnt lgkmcnt(5)
  v_mfma_f32_16x16x32_bf16 v[64:67], a[176:179], v[48:51], v[64:67]
  ds_read_b128 v[40:43], v12 offset:24576
  v_mfma_f32_16x16x32_bf16 v[68:71], a[180:183], v[48:51], v[68:71]
  v_mfma_f32_16x16x32_bf16 v[80:83], a[184:187], v[48:51], v[80:83]
  v_mfma_f32_16x16x32_bf16 v[84:87], a[188:191], v[48:51], v[84:87]
  s_waitcnt lgkmcnt(5)
  v_mfma_f32_16x16x32_bf16 v[72:75], a[176:179], v[52:55], v[72:75]
  ds_read_b128 v[44:47], v13 offset:24576
  v_mfma_f32_16x16x32_bf16 v[76:79], a[180:183], v[52:55], v[76:79]
  v_mfma_f32_16x16x32_bf16 v[88:91], a[184:187], v[52:55], v[88:91]
  buffer_load_dwordx4 v[220:223], v21, s[4:7], s28 offen offset:3072 sc1
  v_mfma_f32_16x16x32_bf16 v[92:95], a[188:191], v[52:55], v[92:95]
  s_waitcnt lgkmcnt(5)
  v_mfma_f32_16x16x32_bf16 v[64:67], a[192:195], v[24:27], v[64:67]
  s_add_u32 s29, s19, 83890176
  ds_read_b128 v[48:51], v14 offset:24576
  v_mfma_f32_16x16x32_bf16 v[68:71], a[196:199], v[24:27], v[68:71]
  v_mfma_f32_16x16x32_bf16 v[80:83], a[200:203], v[24:27], v[80:83]
  v_mfma_f32_16x16x32_bf16 v[84:87], a[204:207], v[24:27], v[84:87]
  s_waitcnt lgkmcnt(5)
  v_mfma_f32_16x16x32_bf16 v[72:75], a[192:195], v[28:31], v[72:75]
  ds_read_b128 v[52:55], v15 offset:24576
  v_mfma_f32_16x16x32_bf16 v[76:79], a[196:199], v[28:31], v[76:79]
  v_mfma_f32_16x16x32_bf16 v[88:91], a[200:203], v[28:31], v[88:91]
  buffer_load_dwordx4 v[224:227], v21, s[4:7], s29 offen offset:0 sc1
  v_mfma_f32_16x16x32_bf16 v[92:95], a[204:207], v[28:31], v[92:95]
  s_waitcnt lgkmcnt(5)
  v_mfma_f32_16x16x32_bf16 v[64:67], a[208:211], v[32:35], v[64:67]
  v_mfma_f32_16x16x32_bf16 v[68:71], a[212:215], v[32:35], v[68:71]
  v_mfma_f32_16x16x32_bf16 v[80:83], a[216:219], v[32:35], v[80:83]
  v_mfma_f32_16x16x32_bf16 v[84:87], a[220:223], v[32:35], v[84:87]
  s_waitcnt lgkmcnt(4)
  v_mfma_f32_16x16x32_bf16 v[72:75], a[208:211], v[36:39], v[72:75]
  v_mfma_f32_16x16x32_bf16 v[76:79], a[212:215], v[36:39], v[76:79]
  v_xor_b32 v8, 0x8000, v8
  v_mfma_f32_16x16x32_bf16 v[88:91], a[216:219], v[36:39], v[88:91]
  buffer_load_dwordx4 v[228:231], v21, s[4:7], s29 offen offset:1024 sc1
  v_mfma_f32_16x16x32_bf16 v[92:95], a[220:223], v[36:39], v[92:95]
  s_waitcnt lgkmcnt(3)
  v_xor_b32 v9, 0x8000, v9
  v_mfma_f32_16x16x32_bf16 v[64:67], a[224:227], v[40:43], v[64:67]
  v_mfma_f32_16x16x32_bf16 v[68:71], a[228:231], v[40:43], v[68:71]
  v_xor_b32 v10, 0x8000, v10
  v_mfma_f32_16x16x32_bf16 v[80:83], a[232:235], v[40:43], v[80:83]
  v_mfma_f32_16x16x32_bf16 v[84:87], a[236:239], v[40:43], v[84:87]
  s_waitcnt lgkmcnt(2)
  v_xor_b32 v11, 0x8000, v11
  v_mfma_f32_16x16x32_bf16 v[72:75], a[224:227], v[44:47], v[72:75]
  v_mfma_f32_16x16x32_bf16 v[76:79], a[228:231], v[44:47], v[76:79]
  v_xor_b32 v12, 0x8000, v12
  v_mfma_f32_16x16x32_bf16 v[88:91], a[232:235], v[44:47], v[88:91]
  buffer_load_dwordx4 v[232:235], v21, s[4:7], s29 offen offset:2048 sc1
  v_mfma_f32_16x16x32_bf16 v[92:95], a[236:239], v[44:47], v[92:95]
  s_waitcnt lgkmcnt(1)
  v_xor_b32 v13, 0x8000, v13
  v_mfma_f32_16x16x32_bf16 v[64:67], a[240:243], v[48:51], v[64:67]
  v_mfma_f32_16x16x32_bf16 v[68:71], a[244:247], v[48:51], v[68:71]
  v_xor_b32 v14, 0x8000, v14
  v_mfma_f32_16x16x32_bf16 v[80:83], a[248:251], v[48:51], v[80:83]
  v_mfma_f32_16x16x32_bf16 v[84:87], a[252:255], v[48:51], v[84:87]
  s_waitcnt lgkmcnt(0)
  v_xor_b32 v15, 0x8000, v15
  v_mfma_f32_16x16x32_bf16 v[72:75], a[240:243], v[52:55], v[72:75]
  v_mfma_f32_16x16x32_bf16 v[76:79], a[244:247], v[52:55], v[76:79]
  v_xor_b32 v3, 0x8000, v3
  v_mfma_f32_16x16x32_bf16 v[88:91], a[248:251], v[52:55], v[88:91]
  buffer_load_dwordx4 v[236:239], v21, s[4:7], s29 offen offset:3072 sc1
  v_mfma_f32_16x16x32_bf16 v[92:95], a[252:255], v[52:55], v[92:95]
  s_cmp_gt_u32 s23, 0
  s_cbranch_scc1 F_top_191
  s_nop 2
  v_cvt_pk_bf16_f32 v128, v64, v65
  v_cvt_pk_bf16_f32 v129, v66, v67
  v_cvt_pk_bf16_f32 v130, v68, v69
  v_cvt_pk_bf16_f32 v131, v70, v71
  buffer_store_dwordx4 v[128:131], v22, s[4:7], s21 offen offset:0 sc1
  v_cvt_pk_bf16_f32 v132, v72, v73
  v_cvt_pk_bf16_f32 v133, v74, v75
  v_cvt_pk_bf16_f32 v134, v76, v77
  v_cvt_pk_bf16_f32 v135, v78, v79
  buffer_store_dwordx4 v[132:135], v22, s[4:7], s21 offen offset:256 sc1
  v_cvt_pk_bf16_f32 v136, v80, v81
  v_cvt_pk_bf16_f32 v137, v82, v83
  v_cvt_pk_bf16_f32 v138, v84, v85
  v_cvt_pk_bf16_f32 v139, v86, v87
  buffer_store_dwordx4 v[136:139], v22, s[4:7], s21 offen offset:2048 sc1
  v_cvt_pk_bf16_f32 v140, v88, v89
  v_cvt_pk_bf16_f32 v141, v90, v91
  v_cvt_pk_bf16_f32 v142, v92, v93
  v_cvt_pk_bf16_f32 v143, v94, v95
  buffer_store_dwordx4 v[140:143], v22, s[4:7], s21 offen offset:2304 sc1
  s_waitcnt vmcnt(0) lgkmcnt(0)
  s_barrier
  v_mov_b32 v144, s30
  v_min_u32 v145, 1, v0
  v_lshlrev_b32 v145, 30, v145
  buffer_store_dword v144, v145, s[4:7], s31 offen sc1
M_done:
M_exit:
  s_endpgm
.p2align 6
.type M_table,@object
M_table:
.long 0x1, 0x3f, 0xffffffff, 0x17, 0x1, 0x7, 0x800, 0x0, 0x8, 0x0, 0x0, 0x0, 0x0, 0x0, 0x0, 0x0
.long 0x1, 0x28, 0xffffffff, 0x1b, 0x1, 0x6, 0x1000, 0x0, 0x8, 0x1, 0x0, 0x0, 0x0, 0x0, 0x0, 0x0
.long 0x2, 0x0, 0x1, 0x1e, 0x1, 0x5, 0x1800, 0x0, 0x8, 0x0, 0x0, 0x0, 0x0, 0x0, 0x0, 0x0
.long 0x2, 0x1e, 0x1, 0x22, 0x1, 0x4, 0x2000, 0x0, 0x8, 0x1, 0x0, 0x0, 0x0, 0x0, 0x0, 0x0
.long 0x0, 0x0, 0x1, 0x20, 0x2, 0x3, 0x20, 0x0, 0x8, 0x2, 0x0, 0x0, 0x0, 0x0, 0x0, 0x0
.long 0x0, 0x3f, 0xffffffff, 0x20, 0x2, 0x2, 0x18, 0x1, 0x10, 0x0, 0x0, 0x0, 0x0, 0x0, 0x0, 0x0
.long 0x1, 0xd, 0xffffffff, 0xe, 0x0, 0x0, 0x8, 0x0, 0x8, 0x2, 0x0, 0x0, 0x0, 0x0, 0x0, 0x0
.size M_table, 448
.section .rodata,"a"
.p2align 6
.amdhsa_kernel gated_mix__compressed_kv_cla__memory_aug_recurrent_mem_tr__prompt_kernel
.amdhsa_next_free_vgpr 512
.amdhsa_next_free_sgpr 102
.amdhsa_accum_offset 256
.amdhsa_group_segment_fixed_size 0
.amdhsa_kernarg_size 136
.amdhsa_user_sgpr_count 2
.amdhsa_user_sgpr_kernarg_segment_ptr 1
.amdhsa_system_sgpr_workgroup_id_x 1
.end_amdhsa_kernel
```

```asm
; @launch grid=(256,1,1) block=(256,1,1) lds=163840
.amdgcn_target "amdgcn-amd-amdhsa--gfx950"
.text
.globl gated_mix__compressed_kv_cla__memory_aug_recurrent_mem_tr__prompt_kernel
.p2align 8
.type gated_mix__compressed_kv_cla__memory_aug_recurrent_mem_tr__prompt_kernel,@function
gated_mix__compressed_kv_cla__memory_aug_recurrent_mem_tr__prompt_kernel:
  s_cmp_ge_u32 s2, 256
  s_cbranch_scc1 M_exit
  s_lshr_b32 s77, s2, 3
  s_and_b32 s76, s2, 7
  s_cbranch_scc1 M_worker
  s_mov_b32 s12, s77
  s_load_dwordx4 s[60:63], s[0:1], 64
  s_load_dwordx4 s[64:67], s[0:1], 80
  s_load_dwordx4 s[68:71], s[0:1], 120
  s_load_dwordx2 s[72:73], s[0:1], 56
  v_lshrrev_b32 v1, 6, v0
  v_and_b32 v20, 63, v0
  v_readfirstlane_b32 s13, v1
  v_lshrrev_b32 v26, 3, v20
  v_lshlrev_b32 v26, 10, v26
  v_and_b32 v1, 7, v20
  v_lshl_add_u32 v26, v1, 4, v26
  s_lshl_b32 s36, s13, 7
  s_lshl_b32 s38, s12, 17
  s_add_u32 s36, s36, s38
  v_add_u32 v26, s36, v26
  s_lshl_b32 s39, s13, 15
  s_add_u32 s39, s39, 32768
  s_waitcnt lgkmcnt(0)
  s_mov_b32 s48, s66
  s_and_b32 s49, s67, 0xffff
  s_mov_b32 s50, 0x400000
  s_mov_b32 s51, 0x20000
  s_xor_b32 s36, s13, 0
  s_lshl_b32 s36, s36, 15
  s_add_u32 m0, s39, 28672
  s_add_u32 s37, s36, 0
  buffer_load_dwordx4 v26, s[48:51], s37 offen lds
  s_add_u32 m0, s39, 29696
  s_add_u32 s37, s36, 8192
  buffer_load_dwordx4 v26, s[48:51], s37 offen lds
  s_add_u32 m0, s39, 30720
  s_add_u32 s37, s36, 16384
  buffer_load_dwordx4 v26, s[48:51], s37 offen lds
  s_add_u32 m0, s39, 31744
  s_add_u32 s37, s36, 24576
  buffer_load_dwordx4 v26, s[48:51], s37 offen lds
  s_xor_b32 s36, s13, 0
  s_lshl_b32 s36, s36, 15
  s_add_u32 m0, s39, 24576
  s_add_u32 s37, s36, 512
  buffer_load_dwordx4 v26, s[48:51], s37 offen lds
  s_add_u32 m0, s39, 25600
  s_add_u32 s37, s36, 8704
  buffer_load_dwordx4 v26, s[48:51], s37 offen lds
  s_add_u32 m0, s39, 26624
  s_add_u32 s37, s36, 16896
  buffer_load_dwordx4 v26, s[48:51], s37 offen lds
  s_add_u32 m0, s39, 27648
  s_add_u32 s37, s36, 25088
  buffer_load_dwordx4 v26, s[48:51], s37 offen lds
  s_xor_b32 s36, s13, 1
  s_lshl_b32 s36, s36, 15
  s_add_u32 m0, s39, 12288
  s_add_u32 s37, s36, 0
  buffer_load_dwordx4 v26, s[48:51], s37 offen lds
  s_add_u32 m0, s39, 13312
  s_add_u32 s37, s36, 8192
  buffer_load_dwordx4 v26, s[48:51], s37 offen lds
  s_add_u32 m0, s39, 14336
  s_add_u32 s37, s36, 16384
  buffer_load_dwordx4 v26, s[48:51], s37 offen lds
  s_add_u32 m0, s39, 15360
  s_add_u32 s37, s36, 24576
  buffer_load_dwordx4 v26, s[48:51], s37 offen lds
  s_xor_b32 s36, s13, 1
  s_lshl_b32 s36, s36, 15
  s_add_u32 m0, s39, 8192
  s_add_u32 s37, s36, 512
  buffer_load_dwordx4 v26, s[48:51], s37 offen lds
  s_add_u32 m0, s39, 9216
  s_add_u32 s37, s36, 8704
  buffer_load_dwordx4 v26, s[48:51], s37 offen lds
  s_add_u32 m0, s39, 10240
  s_add_u32 s37, s36, 16896
  buffer_load_dwordx4 v26, s[48:51], s37 offen lds
  s_add_u32 m0, s39, 11264
  s_add_u32 s37, s36, 25088
  buffer_load_dwordx4 v26, s[48:51], s37 offen lds
  s_mov_b32 s8, s60
  s_and_b32 s9, s61, 0xffff
  s_mov_b32 s10, 0x400000
  s_mov_b32 s11, 0x20000
  s_mov_b32 s40, s62
  s_and_b32 s41, s63, 0xffff
  s_mov_b32 s42, 0x400000
  s_mov_b32 s43, 0x20000
  s_mov_b32 s44, s64
  s_and_b32 s45, s65, 0xffff
  s_mov_b32 s46, 0x400000
  s_mov_b32 s47, 0x20000
  s_mov_b32 s4, s70
  s_and_b32 s5, s71, 0xffff
  s_mov_b32 s6, 0x10000000
  s_mov_b32 s7, 0x20000
  s_mov_b32 s76, s72
  s_and_b32 s77, s73, 0xffff
  s_mov_b32 s78, 0x2000
  s_mov_b32 s79, 0x20000
  s_mov_b32 s72, s68
  s_and_b32 s73, s69, 0xffff
  s_mov_b32 s74, 0x100
  s_mov_b32 s75, 0x20000
  s_mov_b64 s[52:53], s[68:69]
  s_mov_b64 s[58:59], s[70:71]
  s_mul_i32 s99, s12, 896
  s_add_u32 s99, s99, 148898048
  s_lshl_b32 s15, s12, 7
  s_add_u32 s15, s15, 148926464
  v_lshrrev_b32 v21, 4, v20
  v_and_b32 v22, 15, v20
  v_and_b32 v23, 1, v21
  v_lshrrev_b32 v24, 1, v21
  v_lshlrev_b32 v2, 4, v20
  s_lshl_b32 s36, s13, 10
  v_add_u32 v59, s36, v2
  s_mov_b32 s37, s39
  v_add_u32 v4, s37, v2
  v_lshrrev_b32 v25, 2, v20
  v_lshlrev_b32 v25, 13, v25
  v_and_b32 v1, 3, v20
  v_lshl_add_u32 v25, v1, 4, v25
  s_lshl_b32 s36, s13, 6
  s_lshl_b32 s38, s12, 8
  s_add_u32 s36, s36, s38
  v_add_u32 v25, s36, v25
  v_bfe_u32 v29, v20, 2, 1
  v_bfe_u32 v30, v20, 3, 1
  v_and_b32 v31, 3, v20
  v_lshl_add_u32 v27, v21, 2, v29
  v_lshlrev_b32 v27, 6, v27
  v_lshl_add_u32 v27, v30, 5, v27
  v_lshl_add_u32 v27, v31, 3, v27
  v_add_u32 v27, s37, v27
  v_xor_b32 v36, 1, v30
  v_lshl_add_u32 v36, v36, 11, v27
  v_lshl_add_u32 v27, v30, 11, v27
  v_lshl_add_u32 v28, v23, 2, v24
  v_lshl_add_u32 v28, v28, 2, v29
  v_lshlrev_b32 v28, 7, v28
  v_lshl_add_u32 v28, v30, 6, v28
  v_lshl_add_u32 v28, v31, 4, v28
  v_add_u32 v28, s37, v28
  v_lshrrev_b32 v25, 3, v20
  v_lshlrev_b32 v25, 13, v25
  v_and_b32 v1, 7, v20
  v_lshl_add_u32 v25, v1, 4, v25
  s_lshr_b32 s36, s13, 1
  s_lshl1_add_u32 s36, s12, s36
  s_lshl_b32 s36, s36, 7
  v_add_u32 v25, s36, v25
  v_lshl_add_u32 v27, v21, 2, v29
  v_lshlrev_b32 v27, 7, v27
  v_lshl_add_u32 v27, v30, 5, v27
  v_lshl_add_u32 v27, v31, 3, v27
  s_and_b32 s36, s13, 1
  s_lshl_b32 s36, s36, 6
  s_xor_b32 s37, s13, 1
  s_lshl_b32 s37, s37, 15
  s_add_u32 s37, s37, s36
  s_add_u32 s37, s37, 32768
  s_add_u32 s36, s36, s39
  v_add_u32 v36, s37, v27
  v_add_u32 v27, s36, v27
  v_lshlrev_b32 v101, 12, v30
  v_xor_b32 v100, 0x1000, v101
  v_mov_b32 v0, 0x4444
  v_mov_b32 v1, 0xeeee
  v_cmp_lt_u32 vcc, 7, v22
  s_nop 1
  v_cndmask_b32 v32, v0, v1, vcc
  v_mov_b32 v0, v32
  v_and_b32 v32, 7, v20
  v_lshlrev_b32 v32, 4, v32
  v_lshl_add_u32 v11, v21, 7, v32
  v_xor_b32 v1, 128, v2
  v_lshl_add_u32 v33, v24, 4, v22
  s_lshl_b32 s36, s13, 5
  v_add_u32 v33, s36, v33
  v_lshlrev_b32 v33, 3, v33
  v_mul_u32_u24 v34, 1152, v23
  v_add_u32 v5, v33, v34
  v_bfe_u32 v33, v20, 2, 2
  v_lshl_add_u32 v33, v23, 2, v33
  v_lshl_add_u32 v33, v24, 4, v33
  v_lshlrev_b32 v33, 3, v33
  v_and_b32 v34, 1, v20
  v_mul_u32_u24 v34, 1152, v34
  v_add_u32 v6, v33, v34
  s_lshl_b32 s36, s13, 3
  v_lshrrev_b32 v33, 3, v20
  v_add_u32 v33, s36, v33
  v_mul_u32_u24 v34, 0, v33
  v_add_u32 v34, s12, v34
  v_and_b32 v34, 31, v34
  v_lshrrev_b32 v37, 1, v32
  v_lshl_add_u32 v33, v33, 13, v37
  v_lshl_add_u32 v7, v34, 7, v33
  v_and_b32 v37, 1, v20
  v_bfe_u32 v38, v20, 1, 1
  v_lshl_add_u32 v37, v29, 1, v37
  s_lshr_b32 s36, s12, 3
  s_lshl_b32 s36, s36, 10
  s_and_b32 s37, s12, 1
  s_lshl_b32 s37, s37, 9
  s_add_u32 s36, s36, s37
  s_and_b32 s37, s12, 6
  s_lshl_b32 s37, s37, 5
  s_add_u32 s36, s36, s37
  v_lshlrev_b32 v33, 4, v21
  v_lshl_add_u32 v33, v37, 2, v33
  v_lshl_add_u32 v33, v38, 8, v33
  v_lshl_add_u32 v33, v30, 30, v33
  v_add_u32 v8, s36, v33
  v_mov_b32 v39, v21
  s_lshr_b32 s36, s12, 2
  s_lshl_b32 s36, s36, 6
  s_and_b32 s37, s12, 1
  s_lshl_b32 s37, s37, 5
  s_add_u32 s36, s36, s37
  s_and_b32 s37, s12, 2
  s_lshl_b32 s37, s37, 11
  s_add_u32 s36, s36, s37
  v_lshlrev_b32 v35, 10, v39
  v_lshl_add_u32 v35, v37, 2, v35
  v_lshl_add_u32 v35, v38, 4, v35
  v_add_u32 v35, s36, v35
  buffer_load_ushort v44, v35, s[76:79], 0 offen offset:0
  buffer_load_ushort v45, v35, s[76:79], 0 offen offset:2
  buffer_load_ushort v46, v35, s[76:79], 0 offen offset:512
  buffer_load_ushort v47, v35, s[76:79], 0 offen offset:514
  v_lshlrev_b32 v33, 4, v29
  v_mov_b32 v34, 0x3f80
  v_lshlrev_b32 v33, v33, v34
  v_and_b32 v34, 1, v20
  v_lshl_add_u32 v34, v34, 1, v30
  v_cmp_eq_u32 vcc, 0, v34
  s_nop 1
  v_cndmask_b32 v48, 0, v33, vcc
  v_cmp_eq_u32 vcc, 1, v34
  s_nop 1
  v_cndmask_b32 v49, 0, v33, vcc
  v_cmp_eq_u32 vcc, 2, v34
  s_nop 1
  v_cndmask_b32 v50, 0, v33, vcc
  v_cmp_eq_u32 vcc, 3, v34
  s_nop 1
  v_cndmask_b32 v51, 0, v33, vcc
  ds_write_b128 v2, v[48:51] offset:31232
  v_lshlrev_b32 v33, 9, v21
  s_lshl_b32 s36, s13, 11
  v_add_u32 v33, s36, v33
  v_lshl_add_u32 v10, v22, 4, v33
  v_lshl_add_u32 v33, v30, 8, v33
  v_add_u32 v9, v33, v32
  v_mov_b32 v12, 0x3f803f80
  v_mov_b32 v13, 0x3f803f80
  v_mov_b32 v14, 0x3f803f80
  v_mov_b32 v15, 0x3f803f80
  s_mov_b32 s2, 0x3f803f80
  s_mov_b32 s3, 0x3f803f80
  s_mov_b32 s98, 0
  v_and_b32 v33, 1, v20
  v_mul_u32_u24 v33, 128, v33
  v_min_u32 v34, 1, v20
  v_lshlrev_b32 v34, 30, v34
  s_cmp_eq_u32 s13, 3
  s_cselect_b64 vcc, -1, 0
  v_cndmask_b32 v19, v34, v33, vcc
  v_mov_b64 v[60:61], 0
  v_mov_b32 v62, 32256
  ds_write_b64 v62, v[60:61]
  s_mov_b32 s16, 0
  s_mov_b32 s17, -1
  s_mov_b32 s18, 0x3e0293ee
  s_mov_b32 s54, 0x2f800000
  s_mov_b32 s55, 0x28000000
  s_lshl_b32 s36, s13, 10
  s_add_u32 s31, s36, 8192
  s_add_u32 s32, s36, 12160
  s_add_u32 s33, s36, 16384
  s_add_u32 s34, s36, 20224
  s_lshl_b32 s36, s12, 19
  s_add_u32 s27, s36, 67108864
  s_add_u32 s28, s36, 83886080
  s_mul_i32 s36, s12, 4096
  s_add_u32 s29, s36, 135266304
  s_lshl_b32 s36, s12, 13
  s_add_u32 s22, s36, 144703488
  s_add_u32 s23, s36, 144707584
  s_mov_b32 s20, 144703488
  s_mov_b32 s21, 144707584
  v_mov_b32 v40, -1
  v_mov_b32 v41, -1
  v_mov_b32 v42, -1
  v_mov_b32 v43, -1
  s_lshl_b32 s36, s13, 13
  s_add_u32 s36, s36, 145752064
  s_add_u32 s37, s36, 4096
  buffer_store_dwordx4 v[40:43], v59, s[4:7], s22 offen sc1
  buffer_store_dwordx4 v[40:43], v59, s[4:7], s23 offen sc1
  buffer_store_dword v40, v8, s[4:7], s36 offen sc1
  buffer_store_dword v40, v8, s[4:7], s37 offen sc1
  v_mov_b32 v52, 0
  v_min_u32 v53, 1, v59
  v_lshlrev_b32 v53, 30, v53
  buffer_store_dword v52, v53, s[4:7], s15 offen sc1
  s_waitcnt vmcnt(21)
  ds_read_b64_tr_b16 a[160:161], v28 offset:28672
  ds_read_b64_tr_b16 a[162:163], v28 offset:28928
  ds_read_b64_tr_b16 a[164:165], v28 offset:29696
  ds_read_b64_tr_b16 a[166:167], v28 offset:29952
  ds_read_b64_tr_b16 a[168:169], v28 offset:28680
  ds_read_b64_tr_b16 a[170:171], v28 offset:28936
  ds_read_b64_tr_b16 a[172:173], v28 offset:29704
  ds_read_b64_tr_b16 a[174:175], v28 offset:29960
  s_waitcnt lgkmcnt(0)
  s_waitcnt vmcnt(17)
  ds_read_b64_tr_b16 a[176:177], v28 offset:24576
  ds_read_b64_tr_b16 a[178:179], v28 offset:24832
  ds_read_b64_tr_b16 a[180:181], v28 offset:25600
  ds_read_b64_tr_b16 a[182:183], v28 offset:25856
  ds_read_b64_tr_b16 a[184:185], v28 offset:24584
  ds_read_b64_tr_b16 a[186:187], v28 offset:24840
  ds_read_b64_tr_b16 a[188:189], v28 offset:25608
  ds_read_b64_tr_b16 a[190:191], v28 offset:25864
  s_waitcnt lgkmcnt(0)
  s_xor_b32 s36, s13, 2
  s_lshl_b32 s36, s36, 15
  s_add_u32 m0, s39, 28672
  s_add_u32 s37, s36, 0
  buffer_load_dwordx4 v26, s[48:51], s37 offen lds
  s_add_u32 m0, s39, 29696
  s_add_u32 s37, s36, 8192
  buffer_load_dwordx4 v26, s[48:51], s37 offen lds
  s_add_u32 m0, s39, 30720
  s_add_u32 s37, s36, 16384
  buffer_load_dwordx4 v26, s[48:51], s37 offen lds
  s_add_u32 m0, s39, 31744
  s_add_u32 s37, s36, 24576
  buffer_load_dwordx4 v26, s[48:51], s37 offen lds
  s_xor_b32 s36, s13, 3
  s_lshl_b32 s36, s36, 15
  s_add_u32 m0, s39, 24576
  s_add_u32 s37, s36, 0
  buffer_load_dwordx4 v26, s[48:51], s37 offen lds
  s_add_u32 m0, s39, 25600
  s_add_u32 s37, s36, 8192
  buffer_load_dwordx4 v26, s[48:51], s37 offen lds
  s_add_u32 m0, s39, 26624
  s_add_u32 s37, s36, 16384
  buffer_load_dwordx4 v26, s[48:51], s37 offen lds
  s_add_u32 m0, s39, 27648
  s_add_u32 s37, s36, 24576
  buffer_load_dwordx4 v26, s[48:51], s37 offen lds
  s_waitcnt vmcnt(21)
  ds_read_b64_tr_b16 a[192:193], v28 offset:12288
  ds_read_b64_tr_b16 a[194:195], v28 offset:12544
  ds_read_b64_tr_b16 a[196:197], v28 offset:13312
  ds_read_b64_tr_b16 a[198:199], v28 offset:13568
  ds_read_b64_tr_b16 a[200:201], v28 offset:12296
  ds_read_b64_tr_b16 a[202:203], v28 offset:12552
  ds_read_b64_tr_b16 a[204:205], v28 offset:13320
  ds_read_b64_tr_b16 a[206:207], v28 offset:13576
  s_waitcnt lgkmcnt(0)
  s_waitcnt vmcnt(17)
  ds_read_b64_tr_b16 a[208:209], v28 offset:8192
  ds_read_b64_tr_b16 a[210:211], v28 offset:8448
  ds_read_b64_tr_b16 a[212:213], v28 offset:9216
  ds_read_b64_tr_b16 a[214:215], v28 offset:9472
  ds_read_b64_tr_b16 a[216:217], v28 offset:8200
  ds_read_b64_tr_b16 a[218:219], v28 offset:8456
  ds_read_b64_tr_b16 a[220:221], v28 offset:9224
  ds_read_b64_tr_b16 a[222:223], v28 offset:9480
  s_waitcnt lgkmcnt(0)
  s_xor_b32 s36, s13, 2
  s_lshl_b32 s36, s36, 19
  s_add_u32 m0, s39, 12288
  s_add_u32 s37, s36, 0
  buffer_load_dwordx4 v25, s[8:11], s37 offen lds
  s_add_u32 m0, s39, 13312
  s_add_u32 s37, s36, 65536
  buffer_load_dwordx4 v25, s[8:11], s37 offen lds
  s_add_u32 m0, s39, 14336
  s_add_u32 s37, s36, 131072
  buffer_load_dwordx4 v25, s[8:11], s37 offen lds
  s_add_u32 m0, s39, 15360
  s_add_u32 s37, s36, 196608
  buffer_load_dwordx4 v25, s[8:11], s37 offen lds
  s_xor_b32 s36, s13, 2
  s_lshl_b32 s36, s36, 19
  s_add_u32 m0, s39, 8192
  s_add_u32 s37, s36, 262144
  buffer_load_dwordx4 v25, s[8:11], s37 offen lds
  s_add_u32 m0, s39, 9216
  s_add_u32 s37, s36, 327680
  buffer_load_dwordx4 v25, s[8:11], s37 offen lds
  s_add_u32 m0, s39, 10240
  s_add_u32 s37, s36, 393216
  buffer_load_dwordx4 v25, s[8:11], s37 offen lds
  s_add_u32 m0, s39, 11264
  s_add_u32 s37, s36, 458752
  buffer_load_dwordx4 v25, s[8:11], s37 offen lds
  s_waitcnt vmcnt(12)
  ds_read_b64_tr_b16 a[224:225], v28 offset:28672
  ds_read_b64_tr_b16 a[226:227], v28 offset:28928
  ds_read_b64_tr_b16 a[228:229], v28 offset:29696
  ds_read_b64_tr_b16 a[230:231], v28 offset:29952
  ds_read_b64_tr_b16 a[232:233], v28 offset:28680
  ds_read_b64_tr_b16 a[234:235], v28 offset:28936
  ds_read_b64_tr_b16 a[236:237], v28 offset:29704
  ds_read_b64_tr_b16 a[238:239], v28 offset:29960
  s_waitcnt lgkmcnt(0)
  s_waitcnt vmcnt(8)
  ds_read_b64_tr_b16 a[240:241], v28 offset:24576
  ds_read_b64_tr_b16 a[242:243], v28 offset:24832
  ds_read_b64_tr_b16 a[244:245], v28 offset:25600
  ds_read_b64_tr_b16 a[246:247], v28 offset:25856
  ds_read_b64_tr_b16 a[248:249], v28 offset:24584
  ds_read_b64_tr_b16 a[250:251], v28 offset:24840
  ds_read_b64_tr_b16 a[252:253], v28 offset:25608
  ds_read_b64_tr_b16 a[254:255], v28 offset:25864
  s_waitcnt lgkmcnt(0)
  s_xor_b32 s36, s13, 4
  s_lshl_b32 s36, s36, 19
  s_add_u32 m0, s39, 28672
  s_add_u32 s37, s36, 0
  buffer_load_dwordx4 v25, s[8:11], s37 offen lds
  s_add_u32 m0, s39, 29696
  s_add_u32 s37, s36, 65536
  buffer_load_dwordx4 v25, s[8:11], s37 offen lds
  s_add_u32 m0, s39, 30720
  s_add_u32 s37, s36, 131072
  buffer_load_dwordx4 v25, s[8:11], s37 offen lds
  s_add_u32 m0, s39, 31744
  s_add_u32 s37, s36, 196608
  buffer_load_dwordx4 v25, s[8:11], s37 offen lds
  s_xor_b32 s36, s13, 4
  s_lshl_b32 s36, s36, 19
  s_add_u32 m0, s39, 24576
  s_add_u32 s37, s36, 262144
  buffer_load_dwordx4 v25, s[8:11], s37 offen lds
  s_add_u32 m0, s39, 25600
  s_add_u32 s37, s36, 327680
  buffer_load_dwordx4 v25, s[8:11], s37 offen lds
  s_add_u32 m0, s39, 26624
  s_add_u32 s37, s36, 393216
  buffer_load_dwordx4 v25, s[8:11], s37 offen lds
  s_add_u32 m0, s39, 27648
  s_add_u32 s37, s36, 458752
  buffer_load_dwordx4 v25, s[8:11], s37 offen lds
  s_barrier
  s_cmp_lg_u32 s13, 0
  s_cbranch_scc1 T_arm_1
  s_getreg_b32 s36, hwreg(HW_REG_XCC_ID, 0, 3)
  s_lshl_b32 s36, s36, 3
  s_lshl_b64 s[60:61], 1, s36
  s_mov_b32 s62, 1
  s_atomic_add_x2 s[60:61], s[52:53], 0
  s_atomic_add s62, s[52:53], 128
  v_lshl_or_b32 v44, v45, 16, v44
  v_lshl_or_b32 v46, v47, 16, v46
  v_min_u32 v44, -2, v44
  v_min_u32 v46, -2, v46
  s_mov_b32 s36, 145752064
  s_mov_b32 s37, 145756160
  buffer_store_dword v44, v8, s[4:7], s36 offen sc1
  buffer_store_dword v46, v8, s[4:7], s37 offen sc1
T_arm_1:
  v_mad_u32_u24 v96, v100, 1, v27
  v_mad_u32_u24 v97, v101, 1, v27
  v_mad_u32_u24 v98, v100, 1, v36
  v_mad_u32_u24 v99, v101, 1, v36
  s_waitcnt vmcnt(8)
  s_barrier
  ds_read_b64_tr_b16 v[160:161], v96 offset:8192
  ds_read_b64_tr_b16 v[162:163], v96 offset:8448
  ds_read_b64_tr_b16 v[164:165], v96 offset:10240
  ds_read_b64_tr_b16 v[166:167], v96 offset:10496
  ds_read_b64_tr_b16 v[168:169], v97 offset:8192
  ds_read_b64_tr_b16 v[170:171], v97 offset:8448
  ds_read_b64_tr_b16 v[172:173], v97 offset:10240
  ds_read_b64_tr_b16 v[174:175], v97 offset:10496
  ds_read_b64_tr_b16 v[192:193], v98 offset:8192
  ds_read_b64_tr_b16 v[194:195], v98 offset:8448
  ds_read_b64_tr_b16 v[196:197], v98 offset:10240
  ds_read_b64_tr_b16 v[198:199], v98 offset:10496
  ds_read_b64_tr_b16 v[200:201], v99 offset:8192
  ds_read_b64_tr_b16 v[202:203], v99 offset:8448
  ds_read_b64_tr_b16 v[204:205], v99 offset:10240
  ds_read_b64_tr_b16 v[206:207], v99 offset:10496
  s_waitcnt lgkmcnt(0)
  s_barrier
  s_xor_b32 s36, s13, 4
  s_lshl_b32 s36, s36, 19
  s_add_u32 m0, s39, 12288
  s_add_u32 s37, s36, 0
  buffer_load_dwordx4 v25, s[40:43], s37 offen lds
  s_add_u32 m0, s39, 13312
  s_add_u32 s37, s36, 65536
  buffer_load_dwordx4 v25, s[40:43], s37 offen lds
  s_add_u32 m0, s39, 14336
  s_add_u32 s37, s36, 131072
  buffer_load_dwordx4 v25, s[40:43], s37 offen lds
  s_add_u32 m0, s39, 15360
  s_add_u32 s37, s36, 196608
  buffer_load_dwordx4 v25, s[40:43], s37 offen lds
  s_xor_b32 s36, s13, 4
  s_lshl_b32 s36, s36, 19
  s_add_u32 m0, s39, 8192
  s_add_u32 s37, s36, 262144
  buffer_load_dwordx4 v25, s[40:43], s37 offen lds
  s_add_u32 m0, s39, 9216
  s_add_u32 s37, s36, 327680
  buffer_load_dwordx4 v25, s[40:43], s37 offen lds
  s_add_u32 m0, s39, 10240
  s_add_u32 s37, s36, 393216
  buffer_load_dwordx4 v25, s[40:43], s37 offen lds
  s_add_u32 m0, s39, 11264
  s_add_u32 s37, s36, 458752
  buffer_load_dwordx4 v25, s[40:43], s37 offen lds
  v_mad_u32_u24 v96, v100, 1, v27
  v_mad_u32_u24 v97, v101, 1, v27
  v_mad_u32_u24 v98, v100, 1, v36
  v_mad_u32_u24 v99, v101, 1, v36
  s_waitcnt vmcnt(8)
  s_barrier
  ds_read_b64_tr_b16 v[224:225], v96 offset:24576
  ds_read_b64_tr_b16 v[226:227], v96 offset:24832
  ds_read_b64_tr_b16 v[228:229], v96 offset:26624
  ds_read_b64_tr_b16 v[230:231], v96 offset:26880
  ds_read_b64_tr_b16 v[232:233], v97 offset:24576
  ds_read_b64_tr_b16 v[234:235], v97 offset:24832
  ds_read_b64_tr_b16 v[236:237], v97 offset:26624
  ds_read_b64_tr_b16 v[238:239], v97 offset:26880
  ds_read_b64_tr_b16 a[16:17], v98 offset:24576
  ds_read_b64_tr_b16 a[18:19], v98 offset:24832
  ds_read_b64_tr_b16 a[20:21], v98 offset:26624
  ds_read_b64_tr_b16 a[22:23], v98 offset:26880
  ds_read_b64_tr_b16 a[24:25], v99 offset:24576
  ds_read_b64_tr_b16 a[26:27], v99 offset:24832
  ds_read_b64_tr_b16 a[28:29], v99 offset:26624
  ds_read_b64_tr_b16 a[30:31], v99 offset:26880
  s_waitcnt lgkmcnt(0)
  s_barrier
  s_xor_b32 s36, s13, 4
  s_lshl_b32 s36, s36, 19
  s_add_u32 m0, s39, 28672
  s_add_u32 s37, s36, 0
  buffer_load_dwordx4 v25, s[44:47], s37 offen lds
  s_add_u32 m0, s39, 29696
  s_add_u32 s37, s36, 65536
  buffer_load_dwordx4 v25, s[44:47], s37 offen lds
  s_add_u32 m0, s39, 30720
  s_add_u32 s37, s36, 131072
  buffer_load_dwordx4 v25, s[44:47], s37 offen lds
  s_add_u32 m0, s39, 31744
  s_add_u32 s37, s36, 196608
  buffer_load_dwordx4 v25, s[44:47], s37 offen lds
  s_xor_b32 s36, s13, 4
  s_lshl_b32 s36, s36, 19
  s_add_u32 m0, s39, 24576
  s_add_u32 s37, s36, 262144
  buffer_load_dwordx4 v25, s[44:47], s37 offen lds
  s_add_u32 m0, s39, 25600
  s_add_u32 s37, s36, 327680
  buffer_load_dwordx4 v25, s[44:47], s37 offen lds
  s_add_u32 m0, s39, 26624
  s_add_u32 s37, s36, 393216
  buffer_load_dwordx4 v25, s[44:47], s37 offen lds
  s_add_u32 m0, s39, 27648
  s_add_u32 s37, s36, 458752
  buffer_load_dwordx4 v25, s[44:47], s37 offen lds
  v_mad_u32_u24 v96, v100, 1, v27
  v_mad_u32_u24 v97, v101, 1, v27
  v_mad_u32_u24 v98, v100, 1, v36
  v_mad_u32_u24 v99, v101, 1, v36
  s_waitcnt vmcnt(8)
  s_barrier
  ds_read_b64_tr_b16 v[240:241], v96 offset:8192
  ds_read_b64_tr_b16 v[242:243], v96 offset:8448
  ds_read_b64_tr_b16 v[244:245], v96 offset:10240
  ds_read_b64_tr_b16 v[246:247], v96 offset:10496
  ds_read_b64_tr_b16 v[248:249], v97 offset:8192
  ds_read_b64_tr_b16 v[250:251], v97 offset:8448
  ds_read_b64_tr_b16 v[252:253], v97 offset:10240
  ds_read_b64_tr_b16 v[254:255], v97 offset:10496
  ds_read_b64_tr_b16 a[32:33], v98 offset:8192
  ds_read_b64_tr_b16 a[34:35], v98 offset:8448
  ds_read_b64_tr_b16 a[36:37], v98 offset:10240
  ds_read_b64_tr_b16 a[38:39], v98 offset:10496
  ds_read_b64_tr_b16 a[40:41], v99 offset:8192
  ds_read_b64_tr_b16 a[42:43], v99 offset:8448
  ds_read_b64_tr_b16 a[44:45], v99 offset:10240
  ds_read_b64_tr_b16 a[46:47], v99 offset:10496
  s_waitcnt lgkmcnt(0)
  s_barrier
  s_xor_b32 s36, s13, 6
  s_lshl_b32 s36, s36, 19
  s_add_u32 m0, s39, 12288
  s_add_u32 s37, s36, 0
  buffer_load_dwordx4 v25, s[8:11], s37 offen lds
  s_add_u32 m0, s39, 13312
  s_add_u32 s37, s36, 65536
  buffer_load_dwordx4 v25, s[8:11], s37 offen lds
  s_add_u32 m0, s39, 14336
  s_add_u32 s37, s36, 131072
  buffer_load_dwordx4 v25, s[8:11], s37 offen lds
  s_add_u32 m0, s39, 15360
  s_add_u32 s37, s36, 196608
  buffer_load_dwordx4 v25, s[8:11], s37 offen lds
  s_xor_b32 s36, s13, 6
  s_lshl_b32 s36, s36, 19
  s_add_u32 m0, s39, 8192
  s_add_u32 s37, s36, 262144
  buffer_load_dwordx4 v25, s[8:11], s37 offen lds
  s_add_u32 m0, s39, 9216
  s_add_u32 s37, s36, 327680
  buffer_load_dwordx4 v25, s[8:11], s37 offen lds
  s_add_u32 m0, s39, 10240
  s_add_u32 s37, s36, 393216
  buffer_load_dwordx4 v25, s[8:11], s37 offen lds
  s_add_u32 m0, s39, 11264
  s_add_u32 s37, s36, 458752
  buffer_load_dwordx4 v25, s[8:11], s37 offen lds
  v_mad_u32_u24 v96, v100, 1, v27
  v_mad_u32_u24 v97, v101, 1, v27
  v_mad_u32_u24 v98, v100, 1, v36
  v_mad_u32_u24 v99, v101, 1, v36
  s_waitcnt vmcnt(8)
  s_barrier
  ds_read_b64_tr_b16 a[0:1], v96 offset:24576
  ds_read_b64_tr_b16 a[2:3], v96 offset:24832
  ds_read_b64_tr_b16 a[4:5], v96 offset:26624
  ds_read_b64_tr_b16 a[6:7], v96 offset:26880
  ds_read_b64_tr_b16 a[8:9], v97 offset:24576
  ds_read_b64_tr_b16 a[10:11], v97 offset:24832
  ds_read_b64_tr_b16 a[12:13], v97 offset:26624
  ds_read_b64_tr_b16 a[14:15], v97 offset:26880
  ds_read_b64_tr_b16 a[48:49], v98 offset:24576
  ds_read_b64_tr_b16 a[50:51], v98 offset:24832
  ds_read_b64_tr_b16 a[52:53], v98 offset:26624
  ds_read_b64_tr_b16 a[54:55], v98 offset:26880
  ds_read_b64_tr_b16 a[56:57], v99 offset:24576
  ds_read_b64_tr_b16 a[58:59], v99 offset:24832
  ds_read_b64_tr_b16 a[60:61], v99 offset:26624
  ds_read_b64_tr_b16 a[62:63], v99 offset:26880
  s_waitcnt lgkmcnt(0)
  s_barrier
  s_xor_b32 s36, s13, 6
  s_lshl_b32 s36, s36, 19
  s_add_u32 m0, s39, 28672
  s_add_u32 s37, s36, 0
  buffer_load_dwordx4 v25, s[40:43], s37 offen lds
  s_add_u32 m0, s39, 29696
  s_add_u32 s37, s36, 65536
  buffer_load_dwordx4 v25, s[40:43], s37 offen lds
  s_add_u32 m0, s39, 30720
  s_add_u32 s37, s36, 131072
  buffer_load_dwordx4 v25, s[40:43], s37 offen lds
  s_add_u32 m0, s39, 31744
  s_add_u32 s37, s36, 196608
  buffer_load_dwordx4 v25, s[40:43], s37 offen lds
  s_xor_b32 s36, s13, 6
  s_lshl_b32 s36, s36, 19
  s_add_u32 m0, s39, 24576
  s_add_u32 s37, s36, 262144
  buffer_load_dwordx4 v25, s[40:43], s37 offen lds
  s_add_u32 m0, s39, 25600
  s_add_u32 s37, s36, 327680
  buffer_load_dwordx4 v25, s[40:43], s37 offen lds
  s_add_u32 m0, s39, 26624
  s_add_u32 s37, s36, 393216
  buffer_load_dwordx4 v25, s[40:43], s37 offen lds
  s_add_u32 m0, s39, 27648
  s_add_u32 s37, s36, 458752
  buffer_load_dwordx4 v25, s[40:43], s37 offen lds
  v_mad_u32_u24 v96, v100, 1, v27
  v_mad_u32_u24 v97, v101, 1, v27
  v_mad_u32_u24 v98, v100, 1, v36
  v_mad_u32_u24 v99, v101, 1, v36
  s_waitcnt vmcnt(8)
  s_barrier
  ds_read_b64_tr_b16 a[64:65], v96 offset:8192
  ds_read_b64_tr_b16 a[66:67], v96 offset:8448
  ds_read_b64_tr_b16 a[68:69], v96 offset:10240
  ds_read_b64_tr_b16 a[70:71], v96 offset:10496
  ds_read_b64_tr_b16 a[72:73], v97 offset:8192
  ds_read_b64_tr_b16 a[74:75], v97 offset:8448
  ds_read_b64_tr_b16 a[76:77], v97 offset:10240
  ds_read_b64_tr_b16 a[78:79], v97 offset:10496
  ds_read_b64_tr_b16 a[112:113], v98 offset:8192
  ds_read_b64_tr_b16 a[114:115], v98 offset:8448
  ds_read_b64_tr_b16 a[116:117], v98 offset:10240
  ds_read_b64_tr_b16 a[118:119], v98 offset:10496
  ds_read_b64_tr_b16 a[120:121], v99 offset:8192
  ds_read_b64_tr_b16 a[122:123], v99 offset:8448
  ds_read_b64_tr_b16 a[124:125], v99 offset:10240
  ds_read_b64_tr_b16 a[126:127], v99 offset:10496
  s_waitcnt lgkmcnt(0)
  s_barrier
  s_xor_b32 s36, s13, 6
  s_lshl_b32 s36, s36, 19
  s_add_u32 m0, s39, 12288
  s_add_u32 s37, s36, 0
  buffer_load_dwordx4 v25, s[44:47], s37 offen lds
  s_add_u32 m0, s39, 13312
  s_add_u32 s37, s36, 65536
  buffer_load_dwordx4 v25, s[44:47], s37 offen lds
  s_add_u32 m0, s39, 14336
  s_add_u32 s37, s36, 131072
  buffer_load_dwordx4 v25, s[44:47], s37 offen lds
  s_add_u32 m0, s39, 15360
  s_add_u32 s37, s36, 196608
  buffer_load_dwordx4 v25, s[44:47], s37 offen lds
  s_xor_b32 s36, s13, 6
  s_lshl_b32 s36, s36, 19
  s_add_u32 m0, s39, 8192
  s_add_u32 s37, s36, 262144
  buffer_load_dwordx4 v25, s[44:47], s37 offen lds
  s_add_u32 m0, s39, 9216
  s_add_u32 s37, s36, 327680
  buffer_load_dwordx4 v25, s[44:47], s37 offen lds
  s_add_u32 m0, s39, 10240
  s_add_u32 s37, s36, 393216
  buffer_load_dwordx4 v25, s[44:47], s37 offen lds
  s_add_u32 m0, s39, 11264
  s_add_u32 s37, s36, 458752
  buffer_load_dwordx4 v25, s[44:47], s37 offen lds
  v_mad_u32_u24 v96, v100, 1, v27
  v_mad_u32_u24 v97, v101, 1, v27
  v_mad_u32_u24 v98, v100, 1, v36
  v_mad_u32_u24 v99, v101, 1, v36
  s_waitcnt vmcnt(8)
  s_barrier
  ds_read_b64_tr_b16 a[80:81], v96 offset:24576
  ds_read_b64_tr_b16 a[82:83], v96 offset:24832
  ds_read_b64_tr_b16 a[84:85], v96 offset:26624
  ds_read_b64_tr_b16 a[86:87], v96 offset:26880
  ds_read_b64_tr_b16 a[88:89], v97 offset:24576
  ds_read_b64_tr_b16 a[90:91], v97 offset:24832
  ds_read_b64_tr_b16 a[92:93], v97 offset:26624
  ds_read_b64_tr_b16 a[94:95], v97 offset:26880
  ds_read_b64_tr_b16 a[128:129], v98 offset:24576
  ds_read_b64_tr_b16 a[130:131], v98 offset:24832
  ds_read_b64_tr_b16 a[132:133], v98 offset:26624
  ds_read_b64_tr_b16 a[134:135], v98 offset:26880
  ds_read_b64_tr_b16 a[136:137], v99 offset:24576
  ds_read_b64_tr_b16 a[138:139], v99 offset:24832
  ds_read_b64_tr_b16 a[140:141], v99 offset:26624
  ds_read_b64_tr_b16 a[142:143], v99 offset:26880
  s_waitcnt lgkmcnt(0)
  s_barrier
  s_xor_b32 s36, s13, 0
  s_lshl_b32 s36, s36, 19
  s_add_u32 m0, s39, 28672
  s_add_u32 s37, s36, 0
  buffer_load_dwordx4 v25, s[8:11], s37 offen lds
  s_add_u32 m0, s39, 29696
  s_add_u32 s37, s36, 65536
  buffer_load_dwordx4 v25, s[8:11], s37 offen lds
  s_add_u32 m0, s39, 30720
  s_add_u32 s37, s36, 131072
  buffer_load_dwordx4 v25, s[8:11], s37 offen lds
  s_add_u32 m0, s39, 31744
  s_add_u32 s37, s36, 196608
  buffer_load_dwordx4 v25, s[8:11], s37 offen lds
  s_xor_b32 s36, s13, 0
  s_lshl_b32 s36, s36, 19
  s_add_u32 m0, s39, 0
  s_add_u32 s37, s36, 262144
  buffer_load_dwordx4 v25, s[8:11], s37 offen lds
  s_add_u32 m0, s39, 1024
  s_add_u32 s37, s36, 327680
  buffer_load_dwordx4 v25, s[8:11], s37 offen lds
  s_add_u32 m0, s39, 2048
  s_add_u32 s37, s36, 393216
  buffer_load_dwordx4 v25, s[8:11], s37 offen lds
  s_add_u32 m0, s39, 3072
  s_add_u32 s37, s36, 458752
  buffer_load_dwordx4 v25, s[8:11], s37 offen lds
  v_mad_u32_u24 v96, v100, 1, v27
  v_mad_u32_u24 v97, v101, 1, v27
  v_mad_u32_u24 v98, v100, 1, v36
  v_mad_u32_u24 v99, v101, 1, v36
  s_waitcnt vmcnt(8)
  s_barrier
  ds_read_b64_tr_b16 a[96:97], v96 offset:8192
  ds_read_b64_tr_b16 a[98:99], v96 offset:8448
  ds_read_b64_tr_b16 a[100:101], v96 offset:10240
  ds_read_b64_tr_b16 a[102:103], v96 offset:10496
  ds_read_b64_tr_b16 a[104:105], v97 offset:8192
  ds_read_b64_tr_b16 a[106:107], v97 offset:8448
  ds_read_b64_tr_b16 a[108:109], v97 offset:10240
  ds_read_b64_tr_b16 a[110:111], v97 offset:10496
  ds_read_b64_tr_b16 a[144:145], v98 offset:8192
  ds_read_b64_tr_b16 a[146:147], v98 offset:8448
  ds_read_b64_tr_b16 a[148:149], v98 offset:10240
  ds_read_b64_tr_b16 a[150:151], v98 offset:10496
  ds_read_b64_tr_b16 a[152:153], v99 offset:8192
  ds_read_b64_tr_b16 a[154:155], v99 offset:8448
  ds_read_b64_tr_b16 a[156:157], v99 offset:10240
  ds_read_b64_tr_b16 a[158:159], v99 offset:10496
  s_waitcnt lgkmcnt(0)
  s_barrier
  s_xor_b32 s36, s13, 0
  s_lshl_b32 s36, s36, 19
  s_add_u32 m0, s39, 24576
  s_add_u32 s37, s36, 0
  buffer_load_dwordx4 v25, s[40:43], s37 offen lds
  s_add_u32 m0, s39, 25600
  s_add_u32 s37, s36, 65536
  buffer_load_dwordx4 v25, s[40:43], s37 offen lds
  s_add_u32 m0, s39, 26624
  s_add_u32 s37, s36, 131072
  buffer_load_dwordx4 v25, s[40:43], s37 offen lds
  s_add_u32 m0, s39, 27648
  s_add_u32 s37, s36, 196608
  buffer_load_dwordx4 v25, s[40:43], s37 offen lds
  s_xor_b32 s36, s13, 0
  s_lshl_b32 s36, s36, 19
  s_add_u32 m0, s39, 4096
  s_add_u32 s37, s36, 262144
  buffer_load_dwordx4 v25, s[40:43], s37 offen lds
  s_add_u32 m0, s39, 5120
  s_add_u32 s37, s36, 327680
  buffer_load_dwordx4 v25, s[40:43], s37 offen lds
  s_add_u32 m0, s39, 6144
  s_add_u32 s37, s36, 393216
  buffer_load_dwordx4 v25, s[40:43], s37 offen lds
  s_add_u32 m0, s39, 7168
  s_add_u32 s37, s36, 458752
  buffer_load_dwordx4 v25, s[40:43], s37 offen lds
  v_mad_u32_u24 v96, v100, 7, v27
  v_mad_u32_u24 v97, v101, 7, v27
  v_mad_u32_u24 v98, v100, 7, v36
  v_mad_u32_u24 v99, v101, 7, v36
  s_waitcnt vmcnt(8)
  s_barrier
  ds_read_b64_tr_b16 v[128:129], v98 offset:0
  ds_read_b64_tr_b16 v[130:131], v98 offset:256
  ds_read_b64_tr_b16 v[132:133], v98 offset:2048
  ds_read_b64_tr_b16 v[134:135], v98 offset:2304
  ds_read_b64_tr_b16 v[136:137], v99 offset:0
  ds_read_b64_tr_b16 v[138:139], v99 offset:256
  ds_read_b64_tr_b16 v[140:141], v99 offset:2048
  ds_read_b64_tr_b16 v[142:143], v99 offset:2304
  ds_read_b64_tr_b16 v[64:65], v96 offset:0
  ds_read_b64_tr_b16 v[66:67], v96 offset:256
  ds_read_b64_tr_b16 v[68:69], v96 offset:2048
  ds_read_b64_tr_b16 v[70:71], v96 offset:2304
  ds_read_b64_tr_b16 v[72:73], v97 offset:0
  ds_read_b64_tr_b16 v[74:75], v97 offset:256
  ds_read_b64_tr_b16 v[76:77], v97 offset:2048
  ds_read_b64_tr_b16 v[78:79], v97 offset:2304
  s_waitcnt lgkmcnt(0)
  s_barrier
  ds_write_b128 v4, v[64:67] offset:0
  ds_write_b128 v4, v[68:71] offset:1024
  ds_write_b128 v4, v[72:75] offset:2048
  ds_write_b128 v4, v[76:79] offset:3072
  s_xor_b32 s36, s13, 2
  s_lshl_b32 s36, s36, 19
  s_add_u32 m0, s39, 28672
  s_add_u32 s37, s36, 0
  buffer_load_dwordx4 v25, s[40:43], s37 offen lds
  s_add_u32 m0, s39, 29696
  s_add_u32 s37, s36, 65536
  buffer_load_dwordx4 v25, s[40:43], s37 offen lds
  s_add_u32 m0, s39, 30720
  s_add_u32 s37, s36, 131072
  buffer_load_dwordx4 v25, s[40:43], s37 offen lds
  s_add_u32 m0, s39, 31744
  s_add_u32 s37, s36, 196608
  buffer_load_dwordx4 v25, s[40:43], s37 offen lds
  s_xor_b32 s36, s13, 2
  s_lshl_b32 s36, s36, 19
  s_add_u32 m0, s39, 16384
  s_add_u32 s37, s36, 262144
  buffer_load_dwordx4 v25, s[40:43], s37 offen lds
  s_add_u32 m0, s39, 17408
  s_add_u32 s37, s36, 327680
  buffer_load_dwordx4 v25, s[40:43], s37 offen lds
  s_add_u32 m0, s39, 18432
  s_add_u32 s37, s36, 393216
  buffer_load_dwordx4 v25, s[40:43], s37 offen lds
  s_add_u32 m0, s39, 19456
  s_add_u32 s37, s36, 458752
  buffer_load_dwordx4 v25, s[40:43], s37 offen lds
  s_getpc_b64 s[60:61]
T_pc_2:
  s_add_u32 s60, s60, T_code-T_pc_2
  s_addc_u32 s61, s61, 0
  v_lshlrev_b32 v102, 3, v59
  v_min_u32 v102, 24576, v102
  global_load_dword v103, v102, s[60:61]
  buffer_load_dwordx2 v[54:55], off, s[72:75], 0 sc1
  buffer_load_dword v56, off, s[72:75], 0 offset:128 sc1
  v_mad_u32_u24 v96, v100, 5, v27
  v_mad_u32_u24 v97, v101, 5, v27
  v_mad_u32_u24 v98, v100, 5, v36
  v_mad_u32_u24 v99, v101, 5, v36
  s_waitcnt vmcnt(11)
  s_barrier
  ds_read_b64_tr_b16 v[144:145], v98 offset:4096
  ds_read_b64_tr_b16 v[146:147], v98 offset:4352
  ds_read_b64_tr_b16 v[148:149], v98 offset:6144
  ds_read_b64_tr_b16 v[150:151], v98 offset:6400
  ds_read_b64_tr_b16 v[152:153], v99 offset:4096
  ds_read_b64_tr_b16 v[154:155], v99 offset:4352
  ds_read_b64_tr_b16 v[156:157], v99 offset:6144
  ds_read_b64_tr_b16 v[158:159], v99 offset:6400
  ds_read_b64_tr_b16 v[64:65], v96 offset:4096
  ds_read_b64_tr_b16 v[66:67], v96 offset:4352
  ds_read_b64_tr_b16 v[68:69], v96 offset:6144
  ds_read_b64_tr_b16 v[70:71], v96 offset:6400
  ds_read_b64_tr_b16 v[72:73], v97 offset:4096
  ds_read_b64_tr_b16 v[74:75], v97 offset:4352
  ds_read_b64_tr_b16 v[76:77], v97 offset:6144
  ds_read_b64_tr_b16 v[78:79], v97 offset:6400
  s_waitcnt lgkmcnt(0)
  s_barrier
  ds_write_b128 v4, v[64:67] offset:4096
  ds_write_b128 v4, v[68:71] offset:5120
  ds_write_b128 v4, v[72:75] offset:6144
  ds_write_b128 v4, v[76:79] offset:7168
  s_xor_b32 s36, s13, 2
  s_lshl_b32 s36, s36, 19
  s_add_u32 m0, s39, 24576
  s_add_u32 s37, s36, 0
  buffer_load_dwordx4 v25, s[44:47], s37 offen lds
  s_add_u32 m0, s39, 25600
  s_add_u32 s37, s36, 65536
  buffer_load_dwordx4 v25, s[44:47], s37 offen lds
  s_add_u32 m0, s39, 26624
  s_add_u32 s37, s36, 131072
  buffer_load_dwordx4 v25, s[44:47], s37 offen lds
  s_add_u32 m0, s39, 27648
  s_add_u32 s37, s36, 196608
  buffer_load_dwordx4 v25, s[44:47], s37 offen lds
  s_xor_b32 s36, s13, 2
  s_lshl_b32 s36, s36, 19
  s_add_u32 m0, s39, 20480
  s_add_u32 s37, s36, 262144
  buffer_load_dwordx4 v25, s[44:47], s37 offen lds
  s_add_u32 m0, s39, 21504
  s_add_u32 s37, s36, 327680
  buffer_load_dwordx4 v25, s[44:47], s37 offen lds
  s_add_u32 m0, s39, 22528
  s_add_u32 s37, s36, 393216
  buffer_load_dwordx4 v25, s[44:47], s37 offen lds
  s_add_u32 m0, s39, 23552
  s_add_u32 s37, s36, 458752
  buffer_load_dwordx4 v25, s[44:47], s37 offen lds
  v_mad_u32_u24 v96, v100, 3, v27
  v_mad_u32_u24 v97, v101, 3, v27
  v_mad_u32_u24 v98, v100, 3, v36
  v_mad_u32_u24 v99, v101, 3, v36
  s_waitcnt vmcnt(11)
  s_barrier
  ds_read_b64_tr_b16 v[176:177], v96 offset:16384
  ds_read_b64_tr_b16 v[178:179], v96 offset:16640
  ds_read_b64_tr_b16 v[180:181], v96 offset:18432
  ds_read_b64_tr_b16 v[182:183], v96 offset:18688
  ds_read_b64_tr_b16 v[184:185], v97 offset:16384
  ds_read_b64_tr_b16 v[186:187], v97 offset:16640
  ds_read_b64_tr_b16 v[188:189], v97 offset:18432
  ds_read_b64_tr_b16 v[190:191], v97 offset:18688
  ds_read_b64_tr_b16 v[64:65], v98 offset:16384
  ds_read_b64_tr_b16 v[66:67], v98 offset:16640
  ds_read_b64_tr_b16 v[68:69], v98 offset:18432
  ds_read_b64_tr_b16 v[70:71], v98 offset:18688
  ds_read_b64_tr_b16 v[72:73], v99 offset:16384
  ds_read_b64_tr_b16 v[74:75], v99 offset:16640
  ds_read_b64_tr_b16 v[76:77], v99 offset:18432
  ds_read_b64_tr_b16 v[78:79], v99 offset:18688
  s_waitcnt lgkmcnt(0)
  s_barrier
  ds_write_b128 v4, v[64:67] offset:16384
  ds_write_b128 v4, v[68:71] offset:17408
  ds_write_b128 v4, v[72:75] offset:18432
  ds_write_b128 v4, v[76:79] offset:19456
  s_xor_b32 s36, s13, 0
  s_lshl_b32 s36, s36, 19
  s_add_u32 m0, s39, 8192
  s_add_u32 s37, s36, 0
  buffer_load_dwordx4 v25, s[44:47], s37 offen lds
  s_add_u32 m0, s39, 9216
  s_add_u32 s37, s36, 65536
  buffer_load_dwordx4 v25, s[44:47], s37 offen lds
  s_add_u32 m0, s39, 10240
  s_add_u32 s37, s36, 131072
  buffer_load_dwordx4 v25, s[44:47], s37 offen lds
  s_add_u32 m0, s39, 11264
  s_add_u32 s37, s36, 196608
  buffer_load_dwordx4 v25, s[44:47], s37 offen lds
  s_xor_b32 s36, s13, 0
  s_lshl_b32 s36, s36, 19
  s_add_u32 m0, s39, 12288
  s_add_u32 s37, s36, 262144
  buffer_load_dwordx4 v25, s[44:47], s37 offen lds
  s_add_u32 m0, s39, 13312
  s_add_u32 s37, s36, 327680
  buffer_load_dwordx4 v25, s[44:47], s37 offen lds
  s_add_u32 m0, s39, 14336
  s_add_u32 s37, s36, 393216
  buffer_load_dwordx4 v25, s[44:47], s37 offen lds
  s_add_u32 m0, s39, 15360
  s_add_u32 s37, s36, 458752
  buffer_load_dwordx4 v25, s[44:47], s37 offen lds
  v_mad_u32_u24 v96, v100, 1, v27
  v_mad_u32_u24 v97, v101, 1, v27
  v_mad_u32_u24 v98, v100, 1, v36
  v_mad_u32_u24 v99, v101, 1, v36
  s_waitcnt vmcnt(8)
  s_barrier
  ds_read_b64_tr_b16 v[208:209], v98 offset:20480
  ds_read_b64_tr_b16 v[210:211], v98 offset:20736
  ds_read_b64_tr_b16 v[212:213], v98 offset:22528
  ds_read_b64_tr_b16 v[214:215], v98 offset:22784
  ds_read_b64_tr_b16 v[216:217], v99 offset:20480
  ds_read_b64_tr_b16 v[218:219], v99 offset:20736
  ds_read_b64_tr_b16 v[220:221], v99 offset:22528
  ds_read_b64_tr_b16 v[222:223], v99 offset:22784
  ds_read_b64_tr_b16 v[64:65], v96 offset:20480
  ds_read_b64_tr_b16 v[66:67], v96 offset:20736
  ds_read_b64_tr_b16 v[68:69], v96 offset:22528
  ds_read_b64_tr_b16 v[70:71], v96 offset:22784
  ds_read_b64_tr_b16 v[72:73], v97 offset:20480
  ds_read_b64_tr_b16 v[74:75], v97 offset:20736
  ds_read_b64_tr_b16 v[76:77], v97 offset:22528
  ds_read_b64_tr_b16 v[78:79], v97 offset:22784
  s_waitcnt lgkmcnt(0)
  s_barrier
  ds_write_b128 v4, v[64:67] offset:20480
  ds_write_b128 v4, v[68:71] offset:21504
  ds_write_b128 v4, v[72:75] offset:22528
  ds_write_b128 v4, v[76:79] offset:23552
  s_xor_b32 s36, s13, 2
  s_lshl_b32 s36, s36, 15
  s_add_u32 m0, s39, 24576
  s_add_u32 s37, s36, 512
  buffer_load_dwordx4 v26, s[48:51], s37 offen lds
  s_add_u32 m0, s39, 25600
  s_add_u32 s37, s36, 8704
  buffer_load_dwordx4 v26, s[48:51], s37 offen lds
  s_add_u32 m0, s39, 26624
  s_add_u32 s37, s36, 16896
  buffer_load_dwordx4 v26, s[48:51], s37 offen lds
  s_add_u32 m0, s39, 27648
  s_add_u32 s37, s36, 25088
  buffer_load_dwordx4 v26, s[48:51], s37 offen lds
  s_xor_b32 s36, s13, 3
  s_lshl_b32 s36, s36, 15
  s_add_u32 m0, s39, 28672
  s_add_u32 s37, s36, 512
  buffer_load_dwordx4 v26, s[48:51], s37 offen lds
  s_add_u32 m0, s39, 29696
  s_add_u32 s37, s36, 8704
  buffer_load_dwordx4 v26, s[48:51], s37 offen lds
  s_add_u32 m0, s39, 30720
  s_add_u32 s37, s36, 16896
  buffer_load_dwordx4 v26, s[48:51], s37 offen lds
  s_add_u32 m0, s39, 31744
  s_add_u32 s37, s36, 25088
  buffer_load_dwordx4 v26, s[48:51], s37 offen lds
  s_mov_b32 s19, 0
  s_branch T_arrgo_4
T_arr_3:
  s_add_u32 s19, s19, 1
  s_cmp_gt_u32 s19, 32768
  s_cbranch_scc1 M_exit
  buffer_load_dwordx2 v[54:55], off, s[72:75], 0 sc1
  buffer_load_dword v56, off, s[72:75], 0 offset:128 sc1
  s_waitcnt vmcnt(0)
T_arrgo_4:
  v_sad_u8 v57, v54, 0, 0
  v_sad_u8 v57, v55, 0, v57
  v_or_b32 v58, v54, v55
  v_cmp_gt_u32 vcc, 32, v57
  s_cbranch_vccnz T_arr_3
  v_cmp_gt_u32 vcc, 0x100, v56
  s_cbranch_vccnz T_arr_3
  v_readfirstlane_b32 s36, v58
  s_nop 0
  s_and_b32 s36, s36, 0x20202020
  s_cselect_b32 s56, 0, 1
  s_mov_b32 s14, -1
  s_mov_b32 s30, -1
  s_mov_b32 s19, 0
  s_branch T_kvok_6
T_kv_5:
  s_sleep 4
  s_add_u32 s19, s19, 1
  s_cmp_gt_u32 s19, 32768
  s_cbranch_scc1 M_exit
T_kvok_6:
  s_add_u32 s39, s99, 128
  s_mov_b32 s38, 0
  s_mov_b32 s37, 0
  s_atomic_or s38, s[58:59], s99 glc
  s_atomic_or s37, s[58:59], s39 glc
  s_waitcnt lgkmcnt(0)
  s_lshl_b32 s38, s38, 1
  s_lshl1_add_u32 s37, s37, 1
  s_min_u32 s38, s38, s37
  s_cmp_ge_u32 s38, 64
  s_cselect_b32 s38, 100, s38
  s_sub_u32 s38, s38, 1
  s_max_i32 s30, s30, s38
  s_cmp_ge_i32 s14, s30
  s_cbranch_scc1 T_kv_5
  s_mov_b32 m0, s31
  s_nop 0
  buffer_load_dwordx4 v9, s[4:7], s27 offen sc1 lds
  s_mov_b32 m0, s32
  s_nop 0
  buffer_load_dwordx4 v9, s[4:7], s27 offen offset:128 sc1 lds
  s_mov_b32 m0, s33
  s_nop 0
  buffer_load_dwordx4 v10, s[4:7], s28 offen sc1 lds
  s_mov_b32 m0, s34
  s_nop 0
  buffer_load_dwordx4 v10, s[4:7], s28 offen offset:256 sc1 lds
  s_add_u32 s27, s27, 8192
  s_add_u32 s28, s28, 8192
  s_lshl_b32 s36, s12, 10
  s_add_u32 s36, s36, 145752064
  buffer_load_dwordx4 v[40:43], v2, s[4:7], s36 offen sc1
  v_mad_u32_u24 v96, v101, 1, v27
  v_mad_u32_u24 v97, v100, 1, v27
  v_mad_u32_u24 v98, v101, 1, v36
  v_mad_u32_u24 v99, v100, 1, v36
  s_waitcnt vmcnt(13)
  s_barrier
  ds_read_b64_tr_b16 v[64:65], v96 offset:8192
  ds_read_b64_tr_b16 v[66:67], v96 offset:8448
  ds_read_b64_tr_b16 v[68:69], v96 offset:10240
  ds_read_b64_tr_b16 v[70:71], v96 offset:10496
  ds_read_b64_tr_b16 v[72:73], v97 offset:8192
  ds_read_b64_tr_b16 v[74:75], v97 offset:8448
  ds_read_b64_tr_b16 v[76:77], v97 offset:10240
  ds_read_b64_tr_b16 v[78:79], v97 offset:10496
  ds_read_b64_tr_b16 v[80:81], v98 offset:8192
  ds_read_b64_tr_b16 v[82:83], v98 offset:8448
  ds_read_b64_tr_b16 v[84:85], v98 offset:10240
  ds_read_b64_tr_b16 v[86:87], v98 offset:10496
  ds_read_b64_tr_b16 v[88:89], v99 offset:8192
  ds_read_b64_tr_b16 v[90:91], v99 offset:8448
  ds_read_b64_tr_b16 v[92:93], v99 offset:10240
  ds_read_b64_tr_b16 v[94:95], v99 offset:10496
  s_waitcnt lgkmcnt(0)
  s_barrier
  ds_write_b128 v4, v[64:67] offset:8192
  ds_write_b128 v4, v[68:71] offset:9216
  ds_write_b128 v4, v[72:75] offset:10240
  ds_write_b128 v4, v[76:79] offset:11264
  ds_write_b128 v4, v[80:83] offset:12288
  ds_write_b128 v4, v[84:87] offset:13312
  ds_write_b128 v4, v[88:91] offset:14336
  ds_write_b128 v4, v[92:95] offset:15360
  s_waitcnt vmcnt(9)
  ds_read_b64_tr_b16 v[64:65], v28 offset:24576
  ds_read_b64_tr_b16 v[66:67], v28 offset:24832
  ds_read_b64_tr_b16 v[68:69], v28 offset:25600
  ds_read_b64_tr_b16 v[70:71], v28 offset:25856
  ds_read_b64_tr_b16 v[72:73], v28 offset:24584
  ds_read_b64_tr_b16 v[74:75], v28 offset:24840
  ds_read_b64_tr_b16 v[76:77], v28 offset:25608
  ds_read_b64_tr_b16 v[78:79], v28 offset:25864
  s_waitcnt lgkmcnt(0)
  ds_write_b128 v4, v[64:67] offset:24576
  ds_write_b128 v4, v[68:71] offset:25600
  ds_write_b128 v4, v[72:75] offset:26624
  ds_write_b128 v4, v[76:79] offset:27648
  s_waitcnt lgkmcnt(0)
  s_waitcnt vmcnt(5)
  ds_read_b64_tr_b16 v[64:65], v28 offset:28672
  ds_read_b64_tr_b16 v[66:67], v28 offset:28928
  ds_read_b64_tr_b16 v[68:69], v28 offset:29696
  ds_read_b64_tr_b16 v[70:71], v28 offset:29952
  ds_read_b64_tr_b16 v[72:73], v28 offset:28680
  ds_read_b64_tr_b16 v[74:75], v28 offset:28936
  ds_read_b64_tr_b16 v[76:77], v28 offset:29704
  ds_read_b64_tr_b16 v[78:79], v28 offset:29960
  s_waitcnt lgkmcnt(0)
  ds_write_b128 v4, v[64:67] offset:28672
  ds_write_b128 v4, v[68:71] offset:29696
  ds_write_b128 v4, v[72:75] offset:30720
  ds_write_b128 v4, v[76:79] offset:31744
  s_waitcnt lgkmcnt(0)
  s_mov_b32 s14, 1
  s_cmp_lt_i32 s14, s30
  s_cbranch_scc1 T_kv2_7
  s_mov_b32 s19, 0
  s_branch T_kvok_9
T_kv_8:
  s_sleep 4
  s_add_u32 s19, s19, 1
  s_cmp_gt_u32 s19, 32768
  s_cbranch_scc1 M_exit
T_kvok_9:
  s_add_u32 s39, s99, 128
  s_mov_b32 s38, 0
  s_mov_b32 s37, 0
  s_atomic_or s38, s[58:59], s99 glc
  s_atomic_or s37, s[58:59], s39 glc
  s_waitcnt lgkmcnt(0)
  s_lshl_b32 s38, s38, 1
  s_lshl1_add_u32 s37, s37, 1
  s_min_u32 s38, s38, s37
  s_cmp_ge_u32 s38, 64
  s_cselect_b32 s38, 100, s38
  s_sub_u32 s38, s38, 1
  s_max_i32 s30, s30, s38
  s_cmp_ge_i32 s14, s30
  s_cbranch_scc1 T_kv_8
T_kv2_7:
  s_waitcnt vmcnt(0) lgkmcnt(0)
  s_barrier
  s_cmp_ge_u32 s13, 2
  s_cselect_b64 vcc, -1, 0
  v_cndmask_b32 v3, v8, v19, vcc
  ds_read_b128 v[68:71], v4 offset:0
  ds_read_b128 v[72:75], v4 offset:1024
  ds_read_b128 v[76:79], v4 offset:4096
  ds_read_b128 v[80:83], v4 offset:5120
  ds_read_b128 v[84:87], v4 offset:8192
  ds_read_b128 v[88:91], v4 offset:9216
  ds_read_b128 v[92:95], v4 offset:2048
  ds_read_b128 v[96:99], v4 offset:3072
  ds_read_b128 v[100:103], v4 offset:6144
  ds_read_b128 v[104:107], v4 offset:7168
  ds_read_b128 v[108:111], v4 offset:10240
  ds_read_b128 v[112:115], v4 offset:11264
  ds_read_b128 v[28:31], v59 offset:16384
  ds_read_b128 v[32:35], v59 offset:20480
  ds_read_b128 v[36:39], v2 offset:8192
  ds_read_b128 v[40:43], v2 offset:9216
  ds_read_b128 v[44:47], v2 offset:10240
  ds_read_b128 v[48:51], v2 offset:11264
  ds_read_b128 v[52:55], v2 offset:12288
  ds_read_b128 v[56:59], v2 offset:13312
  ds_read_b128 v[60:63], v2 offset:14336
  ds_read_b128 v[64:67], v2 offset:15360
  s_and_b32 s36, s13, 1
  s_lshl_b32 s36, s36, 12
  s_add_u32 s22, s22, s36
  s_add_u32 s23, s36, 145752064
  s_mov_b32 s14, -1
  s_and_b32 s57, s14, 1
  s_and_b32 s36, s14, 3
  s_lshl_b32 s36, s36, 13
  s_add_u32 s26, s36, s23
  s_add_u32 s36, s36, 8192
  s_and_b32 s36, s36, 0x7fff
  s_add_u32 s24, s36, 145752064
  s_add_u32 s25, s36, 145756160
  s_add_u32 s35, s36, s23
  s_waitcnt lgkmcnt(0)
  s_cmp_lg_u32 s56, 0
  s_cbranch_scc1 M_global
T_code:
  s_cmp_eq_u32 s13, 1
  s_cbranch_scc1 T_w_11
  s_cmp_eq_u32 s13, 2
  s_cbranch_scc1 T_w_12
  s_cmp_eq_u32 s13, 3
  s_cbranch_scc1 T_w_13
T_w_10:
  s_mov_b32 s19, 0
  v_mov_b64 v[16:17], 0
  v_mov_b64 v[18:19], 0
  v_mov_b64 v[20:21], 0
  v_mov_b64 v[22:23], 0
  v_mov_b64 v[24:25], 0
  v_mov_b64 v[26:27], 0
  buffer_load_dwordx4 v[124:127], v2, s[4:7], s24 offen offset:0 sc1
  buffer_load_dwordx4 v[116:119], v2, s[4:7], s25 offen offset:0 sc1
  buffer_load_dwordx4 v[124:127], v2, s[4:7], s24 offen offset:0 sc1
  buffer_load_dwordx4 v[116:119], v2, s[4:7], s25 offen offset:0 sc1
  s_branch T_loop_14
.p2align 6
T_retry_15:
  s_mov_b64 exec, vcc
  buffer_load_dwordx4 v[124:127], v2, s[4:7], s24 offen offset:0 sc1
  buffer_load_dwordx4 v[116:119], v2, s[4:7], s25 offen offset:0 sc1
  s_mov_b64 exec, -1
  s_add_u32 s19, s19, 1
  s_cmp_gt_u32 s19, 32768
  s_cbranch_scc1 M_exit
T_loop_14:
  s_waitcnt vmcnt(3) lgkmcnt(0)
  v_max3_u32 v123, v124, v125, v126
  v_max_u32 v123, v123, v127
  v_mov_b32_dpp v120, v124 row_ror:8 row_mask:0xf bank_mask:0xf
  v_mov_b32_dpp v121, v125 row_ror:8 row_mask:0xf bank_mask:0xf
  s_waitcnt vmcnt(2)
  v_max3_u32 v123, v123, v116, v117
  v_max3_u32 v123, v123, v118, v119
  v_cmp_eq_u32 vcc, -1, v123
  s_cbranch_vccnz T_retry_15
  v_smfmac_f32_16x16x64_bf16 v[16:19], v[124:127], v[68:75], v0
  s_add_u32 s14, s14, 1
  ds_write_b128 v2, v[124:127] offset:0
  v_mov_b32_dpp v122, v126 row_ror:8 row_mask:0xf bank_mask:0xf
  v_smfmac_f32_16x16x64_bf16 v[20:23], v[124:127], v[76:83], v0
  s_and_b32 s57, s14, 1
  v_mov_b32_dpp v123, v127 row_ror:8 row_mask:0xf bank_mask:0xf
  v_smfmac_f32_16x16x64_bf16 v[24:27], v[124:127], v[84:91], v0
  s_and_b32 s36, s14, 3
  ds_write_b128 v2, v[116:119] offset:4096
  v_smfmac_f32_16x16x64_bf16 v[16:19], v[120:123], v[92:99], v0
  s_lshl_b32 s36, s36, 13
  v_mov_b32_dpp v84, v116 row_ror:8 row_mask:0xf bank_mask:0xf
  v_smfmac_f32_16x16x64_bf16 v[20:23], v[120:123], v[100:107], v0
  s_add_u32 s26, s36, s23
  ds_read_b128 v[68:71], v4 offset:12288
  v_mov_b32_dpp v85, v117 row_ror:8 row_mask:0xf bank_mask:0xf
  v_smfmac_f32_16x16x64_bf16 v[24:27], v[120:123], v[108:115], v0
  s_add_u32 s36, s36, 8192
  ds_read_b128 v[72:75], v4 offset:13312
  v_mov_b32_dpp v86, v118 row_ror:8 row_mask:0xf bank_mask:0xf
  v_smfmac_f32_16x16x64_bf16 v[16:19], v[116:119], v[224:231], v0
  s_and_b32 s36, s36, 0x7fff
  ds_read_b128 v[76:79], v4 offset:14336
  v_mov_b32_dpp v87, v119 row_ror:8 row_mask:0xf bank_mask:0xf
  v_smfmac_f32_16x16x64_bf16 v[20:23], v[116:119], v[240:247], v0
  s_waitcnt lgkmcnt(3)
  s_barrier
  ds_read_b128 v[100:103], v2 offset:1024
  v_smfmac_f32_16x16x64_bf16 v[24:27], v[116:119], a[0:7], v0
  s_mov_b32 m0, s31
  ds_read_b128 v[120:123], v1 offset:1024
  v_smfmac_f32_16x16x64_bf16 v[16:19], v[84:87], v[232:239], v0
  s_cmp_ge_i32 s14, s30
  s_cbranch_scc1 T_kvw_18
T_kvb_19:
  v_smfmac_f32_16x16x64_bf16 v[20:23], v[84:87], v[248:255], v0
  ds_read_b128 v[80:83], v4 offset:15360
  buffer_load_dwordx4 v9, s[4:7], s27 offen sc1 lds
  v_smfmac_f32_16x16x64_bf16 v[24:27], v[84:87], a[8:15], v0
  s_waitcnt lgkmcnt(2)
  s_mov_b32 m0, s32
  v_smfmac_f32_16x16x64_bf16 v[16:19], v[100:103], v[128:135], v0
  ds_read_b128 v[92:95], v2 offset:2048
  v_smfmac_f32_16x16x64_bf16 v[20:23], v[100:103], v[144:151], v0
  ds_read_b128 v[96:99], v1 offset:2048
  v_smfmac_f32_16x16x64_bf16 v[24:27], v[100:103], v[68:75], v0
  s_waitcnt vmcnt(1) lgkmcnt(3)
  ds_read_b128 v[116:119], v2 offset:3072
  buffer_load_dwordx4 v9, s[4:7], s27 offen offset:128 sc1 lds
  v_smfmac_f32_16x16x64_bf16 v[16:19], v[120:123], v[136:143], v0
  ds_read_b128 v[124:127], v1 offset:3072
  s_mov_b32 m0, s33
  v_smfmac_f32_16x16x64_bf16 v[20:23], v[120:123], v[152:159], v0
  s_waitcnt lgkmcnt(4)
  ds_read_b128 v[104:107], v2 offset:5120
  v_smfmac_f32_16x16x64_bf16 v[24:27], v[120:123], v[76:83], v0
  s_waitcnt lgkmcnt(4)
  ds_read_b128 v[108:111], v1 offset:5120
  v_smfmac_f32_16x16x64_bf16 v[16:19], v[92:95], v[160:167], v0
  s_waitcnt lgkmcnt(4)
  ds_read_b128 v[112:115], v2 offset:6144
  buffer_load_dwordx4 v10, s[4:7], s28 offen sc1 lds
  v_smfmac_f32_16x16x64_bf16 v[16:19], v[96:99], v[168:175], v0
  s_waitcnt lgkmcnt(4)
  ds_read_b128 v[84:87], v1 offset:6144
  s_mov_b32 m0, s34
  v_smfmac_f32_16x16x64_bf16 v[16:19], v[116:119], v[192:199], v0
  s_waitcnt lgkmcnt(4)
  ds_read_b128 v[88:91], v2 offset:7168
  v_smfmac_f32_16x16x64_bf16 v[16:19], v[124:127], v[200:207], v0
  s_waitcnt lgkmcnt(4)
  ds_read_b128 v[100:103], v1 offset:7168
  v_smfmac_f32_16x16x64_bf16 v[16:19], v[104:107], a[16:23], v0
  s_waitcnt lgkmcnt(4)
  ds_read_b128 v[68:71], v4 offset:16384
  buffer_load_dwordx4 v10, s[4:7], s28 offen offset:256 sc1 lds
  v_smfmac_f32_16x16x64_bf16 v[16:19], v[108:111], a[24:31], v0
  s_waitcnt lgkmcnt(4)
  ds_read_b128 v[72:75], v4 offset:17408
  v_smfmac_f32_16x16x64_bf16 v[16:19], v[112:115], a[64:71], v0
  s_waitcnt lgkmcnt(4)
  ds_read_b128 v[76:79], v4 offset:18432
  v_smfmac_f32_16x16x64_bf16 v[16:19], v[84:87], a[72:79], v0
  s_waitcnt lgkmcnt(4)
  ds_read_b128 v[80:83], v4 offset:19456
  v_smfmac_f32_16x16x64_bf16 v[16:19], v[88:91], a[112:119], v0
  s_waitcnt lgkmcnt(4)
  v_smfmac_f32_16x16x64_bf16 v[16:19], v[100:103], a[120:127], v0
  s_add_u32 s24, s36, 145752064
  s_add_u32 s25, s36, 145756160
  v_smfmac_f32_16x16x64_bf16 v[20:23], v[92:95], v[176:183], v0
  s_add_u32 s35, s36, s23
  v_smfmac_f32_16x16x64_bf16 v[20:23], v[96:99], v[184:191], v0
  s_waitcnt lgkmcnt(2)
  v_smfmac_f32_16x16x64_bf16 v[20:23], v[116:119], v[68:75], v0
  s_waitcnt lgkmcnt(0)
  ds_read_b128 v[68:71], v4 offset:20480
  v_mul_f32 v16, s18, v16
  v_smfmac_f32_16x16x64_bf16 v[20:23], v[124:127], v[76:83], v0
  ds_read_b128 v[72:75], v4 offset:21504
  v_mul_f32 v17, s18, v17
  v_smfmac_f32_16x16x64_bf16 v[20:23], v[104:107], a[32:39], v0
  ds_read_b128 v[76:79], v4 offset:22528
  v_mul_f32 v18, s18, v18
  v_smfmac_f32_16x16x64_bf16 v[20:23], v[108:111], a[40:47], v0
  ds_read_b128 v[80:83], v4 offset:23552
  v_mul_f32 v19, s18, v19
  v_smfmac_f32_16x16x64_bf16 v[20:23], v[112:115], a[80:87], v0
  v_cvt_pk_bf16_f32 v120, v16, v17
  v_smfmac_f32_16x16x64_bf16 v[20:23], v[84:87], a[88:95], v0
  v_cvt_pk_bf16_f32 v121, v18, v19
  v_smfmac_f32_16x16x64_bf16 v[20:23], v[88:91], a[128:135], v0
  ds_write_b64 v5, v[120:121] offset:24576
  v_smfmac_f32_16x16x64_bf16 v[20:23], v[100:103], a[136:143], v0
  s_waitcnt lgkmcnt(3)
  v_smfmac_f32_16x16x64_bf16 v[24:27], v[92:95], v[68:75], v0
  s_waitcnt lgkmcnt(1)
  v_mov_b64 v[92:93], 0
  v_smfmac_f32_16x16x64_bf16 v[24:27], v[96:99], v[76:83], v0
  s_nop 1
  v_cvt_pk_bf16_f32 v122, v20, v21
  v_cvt_pk_bf16_f32 v123, v22, v23
  v_smfmac_f32_16x16x64_bf16 v[24:27], v[116:119], v[208:215], v0
  ds_write_b64 v5, v[122:123] offset:26880
  v_mov_b64 v[94:95], 0
  v_smfmac_f32_16x16x64_bf16 v[24:27], v[124:127], v[216:223], v0
  s_waitcnt lgkmcnt(1)
  s_barrier
  ds_read_b64_tr_b16 v[68:69], v6 offset:24576
  v_smfmac_f32_16x16x64_bf16 v[24:27], v[104:107], a[48:55], v0
  s_add_u32 s27, s27, 8192
  ds_read_b64_tr_b16 v[70:71], v6 offset:24640
  ds_read_b64_tr_b16 v[72:73], v6 offset:24832
  v_smfmac_f32_16x16x64_bf16 v[24:27], v[108:111], a[56:63], v0
  s_add_u32 s28, s28, 8192
  ds_read_b64_tr_b16 v[74:75], v6 offset:24896
  ds_read_b64_tr_b16 v[76:77], v6 offset:25088
  v_smfmac_f32_16x16x64_bf16 v[24:27], v[112:115], a[96:103], v0
  s_nop 0
  ds_read_b64_tr_b16 v[78:79], v6 offset:25152
  ds_read_b64_tr_b16 v[80:81], v6 offset:25344
  v_smfmac_f32_16x16x64_bf16 v[24:27], v[84:87], a[104:111], v0
  ds_read_b64_tr_b16 v[82:83], v6 offset:25408
  v_mov_b64 v[96:97], 0
  v_smfmac_f32_16x16x64_bf16 v[24:27], v[88:91], a[144:151], v0
  s_waitcnt lgkmcnt(8)
  s_barrier
  ds_read_b64_tr_b16 v[116:117], v6 offset:26880
  v_smfmac_f32_16x16x64_bf16 v[24:27], v[100:103], a[152:159], v0
  s_waitcnt lgkmcnt(7)
  ds_read_b64_tr_b16 v[118:119], v6 offset:26944
  v_mfma_f32_16x16x32_bf16 v[16:19], v[36:39], v[68:71], 0
  s_waitcnt lgkmcnt(6)
  ds_read_b64_tr_b16 v[124:125], v6 offset:27136
  ds_read_b64_tr_b16 v[126:127], v6 offset:27200
  v_mfma_f32_16x16x32_bf16 v[16:19], v[40:43], v[72:75], v[16:19]
  s_waitcnt lgkmcnt(6)
  ds_read_b64_tr_b16 v[104:105], v6 offset:27392
  ds_read_b64_tr_b16 v[106:107], v6 offset:27456
  v_mfma_f32_16x16x32_bf16 v[16:19], v[44:47], v[76:79], v[16:19]
  s_waitcnt lgkmcnt(6)
  ds_read_b64_tr_b16 v[108:109], v6 offset:27648
  ds_read_b64_tr_b16 v[110:111], v6 offset:27712
  v_mfma_f32_16x16x32_bf16 v[16:19], v[48:51], v[80:83], v[16:19]
  s_waitcnt lgkmcnt(6)
  v_cvt_pk_bf16_f32 v120, v24, v25
  v_cvt_pk_bf16_f32 v121, v26, v27
  v_mfma_f32_16x16x32_bf16 v[112:115], v[116:119], v[68:71], 0
  s_waitcnt lgkmcnt(4)
  buffer_store_dwordx4 v[120:123], v2, s[4:7], s29 offen offset:0 sc1
  v_mov_b64 v[98:99], 0
  v_mfma_f32_16x16x32_bf16 v[112:115], v[124:127], v[72:75], v[112:115]
  s_waitcnt lgkmcnt(2)
  v_mov_b64 v[36:37], 0
  v_exp_f32 v100, v16
  v_mfma_f32_16x16x32_bf16 v[112:115], v[104:107], v[76:79], v[112:115]
  s_waitcnt lgkmcnt(0)
  v_exp_f32 v101, v17
  v_mfma_f32_16x16x32_bf16 v[112:115], v[108:111], v[80:83], v[112:115]
  v_exp_f32 v102, v18
  v_mfma_f32_16x16x32_bf16 v[20:23], v[52:55], v[68:71], 0
  s_cmp_eq_u32 s14, 63
  v_exp_f32 v103, v19
  v_mfma_f32_16x16x32_bf16 v[20:23], v[56:59], v[72:75], v[20:23]
  s_cbranch_scc1 M_tdone
  v_cvt_pk_bf16_f32 v44, v100, v101
  v_cvt_pk_bf16_f32 v45, v102, v103
  v_mfma_f32_16x16x32_bf16 v[20:23], v[60:63], v[76:79], v[20:23]
  s_add_u32 s29, s29, 131072
  v_exp_f32 v100, v112
  v_mfma_f32_16x16x32_bf16 v[20:23], v[64:67], v[80:83], v[20:23]
  v_exp_f32 v101, v113
  v_exp_f32 v102, v114
  v_exp_f32 v103, v115
  v_cvt_pk_bf16_f32 v84, v100, v101
  v_cvt_pk_bf16_f32 v85, v102, v103
  v_cndmask_b32 v48, v84, 0, s[16:17]
  v_cndmask_b32 v49, v85, 0, s[16:17]
  v_cndmask_b32 v50, 0, v84, s[16:17]
  v_cndmask_b32 v51, 0, v85, s[16:17]
  v_exp_f32 v100, v20
  v_mfma_f32_16x16x16_bf16 v[88:91], v[12:13], v[48:49], 0
  v_exp_f32 v101, v21
  v_mfma_f32_16x16x16_bf16 v[24:27], v[120:121], v[48:49], 0
  v_exp_f32 v102, v22
  v_mfma_f32_16x16x16_bf16 v[116:119], v[120:121], v[50:51], 0
  v_exp_f32 v103, v23
  v_cvt_pk_bf16_f32 v46, v100, v101
  v_cvt_pk_bf16_f32 v47, v102, v103
  v_mov_b64 v[38:39], 0
  s_nop 0
  v_mfma_f32_16x16x32_bf16 v[88:91], v[12:15], v[44:47], v[88:91]
  v_mov_b64 v[40:41], 0
  v_mov_b64 v[42:43], 0
  v_mfma_f32_16x16x32_bf16 v[24:27], v[28:31], v[44:47], v[24:27]
  ds_read_b128 v[52:55], v4 offset:24576
  ds_read_b128 v[56:59], v4 offset:25600
  v_mfma_f32_16x16x32_bf16 v[116:119], v[32:35], v[44:47], v[116:119]
  s_nop 1
  v_rcp_f32 v89, v88
  v_subrev_u32 v100, s54, v88
  v_cmp_le_u32 vcc, s55, v100
  v_mul_f32 v24, v89, v24
  v_mul_f32 v25, v89, v25
  s_cbranch_vccnz T_slow_21
T_back_22:
  v_cvt_pk_bf16_f32 v124, v24, v25
  v_pk_mul_f32 v[26:27], v[26:27], v[88:89] op_sel:[0,1] op_sel_hi:[1,1]
  v_pk_mul_f32 v[116:117], v[116:117], v[88:89] op_sel:[0,1] op_sel_hi:[1,1]
  v_pk_mul_f32 v[118:119], v[118:119], v[88:89] op_sel:[0,1] op_sel_hi:[1,1]
  v_cvt_pk_bf16_f32 v125, v26, v27
  v_cvt_pk_bf16_f32 v126, v116, v117
  v_cvt_pk_bf16_f32 v127, v118, v119
  ds_write_b128 v11, v[124:127] offset:29184
  s_nop 0
  v_smfmac_f32_16x16x64_bf16 v[92:95], v[124:127], a[160:167], v0
  v_smfmac_f32_16x16x64_bf16 v[96:99], v[124:127], a[168:175], v0
  v_smfmac_f32_16x16x64_bf16 v[36:39], v[124:127], a[176:183], v0
  v_smfmac_f32_16x16x64_bf16 v[40:43], v[124:127], a[184:191], v0
  s_waitcnt lgkmcnt(0)
  s_barrier
  ds_read_b128 v[104:107], v11 offset:29696
  ds_read_b128 v[108:111], v11 offset:30208
  ds_read_b128 v[68:71], v11 offset:30720
  s_waitcnt lgkmcnt(2)
  v_smfmac_f32_16x16x64_bf16 v[92:95], v[104:107], a[192:199], v0
  s_waitcnt lgkmcnt(1)
  ds_read_b128 v[76:79], v4 offset:28672
  v_smfmac_f32_16x16x64_bf16 v[92:95], v[108:111], a[224:231], v0
  s_waitcnt lgkmcnt(1)
  ds_read_b128 v[80:83], v4 offset:29696
  v_smfmac_f32_16x16x64_bf16 v[92:95], v[68:71], a[240:247], v0
  ds_read_b128 v[60:63], v4 offset:26624
  v_smfmac_f32_16x16x64_bf16 v[96:99], v[104:107], a[200:207], v0
  ds_read_b128 v[64:67], v4 offset:27648
  v_smfmac_f32_16x16x64_bf16 v[96:99], v[108:111], a[232:239], v0
  ds_read_b128 v[28:31], v4 offset:30720
  s_nop 0
  v_cvt_pk_bf16_f32 v16, v92, v93
  v_cvt_pk_bf16_f32 v17, v94, v95
  v_bfi_b32 v16, 1, s57, v16
  v_smfmac_f32_16x16x64_bf16 v[96:99], v[68:71], a[248:255], v0
  buffer_store_dwordx2 v[16:17], v7, s[4:7], s20 offen offset:0
  v_smfmac_f32_16x16x64_bf16 v[36:39], v[104:107], a[208:215], v0
  ds_read_b128 v[32:35], v4 offset:31744
  v_smfmac_f32_16x16x64_bf16 v[36:39], v[108:111], v[52:59], v0
  s_waitcnt lgkmcnt(4)
  s_nop 0
  v_cvt_pk_bf16_f32 v18, v96, v97
  v_cvt_pk_bf16_f32 v19, v98, v99
  v_bfi_b32 v18, 1, s57, v18
  v_smfmac_f32_16x16x64_bf16 v[36:39], v[68:71], v[76:83], v0
  buffer_store_dwordx2 v[18:19], v7, s[4:7], s20 offen offset:64
  v_smfmac_f32_16x16x64_bf16 v[40:43], v[104:107], a[216:223], v0
  s_waitcnt lgkmcnt(2)
  ds_read_b128 v[116:119], v2 offset:31232
  v_smfmac_f32_16x16x64_bf16 v[40:43], v[108:111], v[60:67], v0
  s_waitcnt lgkmcnt(1)
  s_nop 0
  v_cvt_pk_bf16_f32 v20, v36, v37
  v_cvt_pk_bf16_f32 v21, v38, v39
  v_bfi_b32 v20, 1, s57, v20
  v_smfmac_f32_16x16x64_bf16 v[40:43], v[68:71], v[28:35], v0
  buffer_store_dwordx2 v[20:21], v7, s[4:7], s21 offen offset:0
  s_nop 6
  v_cvt_pk_bf16_f32 v22, v40, v41
  v_cvt_pk_bf16_f32 v23, v42, v43
  v_bfi_b32 v22, 1, s57, v22
  buffer_store_dwordx2 v[22:23], v7, s[4:7], s21 offen offset:64
  ds_read_b128 v[68:71], v4 offset:0
  ds_read_b128 v[72:75], v4 offset:1024
  ds_read_b128 v[76:79], v4 offset:4096
  ds_read_b128 v[80:83], v4 offset:5120
  ds_read_b128 v[84:87], v4 offset:8192
  ds_read_b128 v[88:91], v4 offset:9216
  v_mov_b64 v[16:17], 0
  v_mov_b64 v[18:19], 0
  v_mov_b64 v[20:21], 0
  v_mov_b64 v[22:23], 0
  v_mov_b64 v[24:25], 0
  v_mov_b64 v[26:27], 0
  s_mov_b32 s19, 0
  v_mov_b32 v49, -1
  s_waitcnt vmcnt(2)
  buffer_load_dwordx4 v[52:55], v2, s[4:7], s22 offen offset:0 sc1
  buffer_load_dwordx4 v[56:59], v2, s[4:7], s22 offen offset:1024 sc1
  buffer_load_dwordx4 v[60:63], v2, s[4:7], s22 offen offset:2048 sc1
  buffer_load_dwordx4 v[64:67], v2, s[4:7], s22 offen offset:3072 sc1
  ds_read_b128 v[92:95], v4 offset:2048
  ds_read_b128 v[96:99], v4 offset:3072
  ds_read_b128 v[100:103], v4 offset:6144
  ds_read_b128 v[104:107], v4 offset:7168
  ds_read_b128 v[108:111], v4 offset:10240
  ds_read_b128 v[112:115], v4 offset:11264
  ds_read_b64 v[44:45], v2 offset:32256
  s_waitcnt lgkmcnt(0)
  v_readfirstlane_b32 s38, v44
  v_readfirstlane_b32 s37, v45
  s_nop 0
  s_lshl_b32 s38, s38, 1
  s_lshl1_add_u32 s37, s37, 1
  s_min_u32 s38, s38, s37
  s_cmp_ge_u32 s38, 64
  s_cselect_b32 s38, 100, s38
  s_sub_u32 s38, s38, 1
  s_max_i32 s30, s30, s38
  s_waitcnt lgkmcnt(12)
  s_waitcnt vmcnt(3)
  v_mfma_f32_16x16x32_bf16 v[120:123], v[116:119], v[52:55], 0
  v_xor_b32 v48, s57, v52
  v_bitop3_b32 v48, v48, v54, s57 bitop3:0xf6
  s_waitcnt vmcnt(2)
  v_mfma_f32_16x16x32_bf16 v[120:123], v[116:119], v[56:59], v[120:123]
  v_bitop3_b32 v48, v48, v56, s57 bitop3:0xf6
  v_bitop3_b32 v48, v48, v58, s57 bitop3:0xf6
  s_waitcnt vmcnt(1)
  v_mfma_f32_16x16x32_bf16 v[120:123], v[116:119], v[60:63], v[120:123]
  v_bitop3_b32 v48, v48, v60, s57 bitop3:0xf6
  v_bitop3_b32 v48, v48, v62, s57 bitop3:0xf6
  s_waitcnt vmcnt(0)
  v_mfma_f32_16x16x32_bf16 v[120:123], v[116:119], v[64:67], v[120:123]
  v_bitop3_b32 v48, v48, v64, s57 bitop3:0xf6
  v_bitop3_b32 v48, v48, v66, s57 bitop3:0xf6
  v_and_b32 v48, 1, v48
  v_cmp_ne_u32 vcc, 0, v48
  s_cbranch_vccnz T_p1re_24
T_p1ok_25:
  s_nop 2
  v_add_f32_dpp v120, v120, v120 row_ror:8 row_mask:0xf bank_mask:0xf
  v_add_f32_dpp v121, v121, v121 row_ror:8 row_mask:0xf bank_mask:0xf
  v_cvt_pk_bf16_f32 v48, v120, v121
  buffer_store_dword v48, v8, s[4:7], s35 offen
  buffer_store_dword v49, v8, s[4:7], s26 offen
  s_barrier
  ds_read_b128 v[28:31], v2 offset:16384
  ds_read_b128 v[32:35], v2 offset:20480
  ds_read_b128 v[36:39], v2 offset:8192
  ds_read_b128 v[40:43], v2 offset:9216
  ds_read_b128 v[44:47], v2 offset:10240
  ds_read_b128 v[48:51], v2 offset:11264
  buffer_load_dwordx4 v[124:127], v2, s[4:7], s24 offen offset:0 sc1
  buffer_load_dwordx4 v[116:119], v2, s[4:7], s25 offen offset:0 sc1
  ds_read_b128 v[52:55], v2 offset:12288
  ds_read_b128 v[56:59], v2 offset:13312
  ds_read_b128 v[60:63], v2 offset:14336
  ds_read_b128 v[64:67], v2 offset:15360
  buffer_load_dwordx4 v[124:127], v2, s[4:7], s24 offen offset:0 sc1
  buffer_load_dwordx4 v[116:119], v2, s[4:7], s25 offen offset:0 sc1
  s_mov_b32 s19, 0
  s_branch T_loop_14
T_p1re_24:
  s_mov_b64 exec, vcc
  buffer_load_dwordx4 v[52:55], v2, s[4:7], s22 offen offset:0 sc1
  buffer_load_dwordx4 v[56:59], v2, s[4:7], s22 offen offset:1024 sc1
  buffer_load_dwordx4 v[60:63], v2, s[4:7], s22 offen offset:2048 sc1
  buffer_load_dwordx4 v[64:67], v2, s[4:7], s22 offen offset:3072 sc1
  s_mov_b64 exec, -1
  s_add_u32 s19, s19, 1
  s_cmp_gt_u32 s19, 32768
  s_cbranch_scc1 M_exit
  s_waitcnt vmcnt(3)
  v_mfma_f32_16x16x32_bf16 v[120:123], v[116:119], v[52:55], 0
  v_xor_b32 v48, s57, v52
  v_bitop3_b32 v48, v48, v54, s57 bitop3:0xf6
  s_waitcnt vmcnt(2)
  v_mfma_f32_16x16x32_bf16 v[120:123], v[116:119], v[56:59], v[120:123]
  v_bitop3_b32 v48, v48, v56, s57 bitop3:0xf6
  v_bitop3_b32 v48, v48, v58, s57 bitop3:0xf6
  s_waitcnt vmcnt(1)
  v_mfma_f32_16x16x32_bf16 v[120:123], v[116:119], v[60:63], v[120:123]
  v_bitop3_b32 v48, v48, v60, s57 bitop3:0xf6
  v_bitop3_b32 v48, v48, v62, s57 bitop3:0xf6
  s_waitcnt vmcnt(0)
  v_mfma_f32_16x16x32_bf16 v[120:123], v[116:119], v[64:67], v[120:123]
  v_bitop3_b32 v48, v48, v64, s57 bitop3:0xf6
  v_bitop3_b32 v48, v48, v66, s57 bitop3:0xf6
  v_and_b32 v48, 1, v48
  v_cmp_ne_u32 vcc, 0, v48
  s_cbranch_vccnz T_p1re_24
  s_branch T_p1ok_25
T_kvw_18:
  s_mov_b32 s19, 0
  s_branch T_kvok_27
T_kv_26:
  s_sleep 4
  s_add_u32 s19, s19, 1
  s_cmp_gt_u32 s19, 32768
  s_cbranch_scc1 M_exit
T_kvok_27:
  s_add_u32 s39, s99, 128
  s_mov_b32 s38, 0
  s_mov_b32 s37, 0
  s_atomic_or s38, s[58:59], s99 glc
  s_atomic_or s37, s[58:59], s39 glc
  s_waitcnt lgkmcnt(0)
  s_lshl_b32 s38, s38, 1
  s_lshl1_add_u32 s37, s37, 1
  s_min_u32 s38, s38, s37
  s_cmp_ge_u32 s38, 64
  s_cselect_b32 s38, 100, s38
  s_sub_u32 s38, s38, 1
  s_max_i32 s30, s30, s38
  s_cmp_ge_i32 s14, s30
  s_cbranch_scc1 T_kv_26
  s_branch T_kvb_19
T_slow_21:
  s_nop 7
  v_max3_f32 v100, v16, v17, v18
  v_max3_f32 v100, v100, v19, v20
  v_max3_f32 v100, v100, v21, v22
  v_max3_f32 v100, v100, v23, v112
  v_max3_f32 v100, v100, v113, v114
  v_max_f32 v100, v100, v115
  v_mov_b32 v101, v100
  s_nop 1
  v_permlane32_swap_b32 v100, v101
  s_nop 1
  v_max_f32 v100, v100, v101
  v_mov_b32 v101, v100
  s_nop 1
  v_permlane16_swap_b32 v100, v101
  s_nop 1
  v_max_f32 v100, v100, v101
  v_sub_f32 v16, v16, v100
  v_sub_f32 v17, v17, v100
  v_sub_f32 v18, v18, v100
  v_sub_f32 v19, v19, v100
  v_exp_f32 v16, v16
  v_exp_f32 v17, v17
  v_exp_f32 v18, v18
  v_exp_f32 v19, v19
  v_sub_f32 v20, v20, v100
  v_sub_f32 v21, v21, v100
  v_sub_f32 v22, v22, v100
  v_sub_f32 v23, v23, v100
  v_exp_f32 v20, v20
  v_exp_f32 v21, v21
  v_exp_f32 v22, v22
  v_exp_f32 v23, v23
  v_sub_f32 v112, v112, v100
  v_sub_f32 v113, v113, v100
  v_sub_f32 v114, v114, v100
  v_sub_f32 v115, v115, v100
  v_exp_f32 v112, v112
  v_exp_f32 v113, v113
  v_exp_f32 v114, v114
  v_exp_f32 v115, v115
  s_nop 0
  v_cvt_pk_bf16_f32 v44, v16, v17
  v_cvt_pk_bf16_f32 v45, v18, v19
  v_cvt_pk_bf16_f32 v46, v20, v21
  v_cvt_pk_bf16_f32 v47, v22, v23
  v_cvt_pk_bf16_f32 v84, v112, v113
  v_cvt_pk_bf16_f32 v85, v114, v115
  v_cndmask_b32 v48, v84, 0, s[16:17]
  v_cndmask_b32 v49, v85, 0, s[16:17]
  v_cndmask_b32 v50, 0, v84, s[16:17]
  v_cndmask_b32 v51, 0, v85, s[16:17]
  s_nop 1
  v_mfma_f32_16x16x16_bf16 v[88:91], v[12:13], v[48:49], 0
  v_mfma_f32_16x16x16_bf16 v[24:27], v[120:121], v[48:49], 0
  v_mfma_f32_16x16x16_bf16 v[116:119], v[120:121], v[50:51], 0
  v_mfma_f32_16x16x32_bf16 v[88:91], v[12:15], v[44:47], v[88:91]
  v_mfma_f32_16x16x32_bf16 v[24:27], v[28:31], v[44:47], v[24:27]
  v_mfma_f32_16x16x32_bf16 v[116:119], v[32:35], v[44:47], v[116:119]
  s_nop 7
  s_nop 1
  v_rcp_f32 v89, v88
  s_nop 0
  v_mul_f32 v24, v89, v24
  v_mul_f32 v25, v89, v25
  s_branch T_back_22
T_w_11:
  s_mov_b32 s19, 0
  v_mov_b64 v[16:17], 0
  v_mov_b64 v[18:19], 0
  v_mov_b64 v[20:21], 0
  v_mov_b64 v[22:23], 0
  v_mov_b64 v[24:25], 0
  v_mov_b64 v[26:27], 0
  buffer_load_dwordx4 v[124:127], v2, s[4:7], s24 offen offset:1024 sc1
  buffer_load_dwordx4 v[116:119], v2, s[4:7], s25 offen offset:1024 sc1
  buffer_load_dwordx4 v[124:127], v2, s[4:7], s24 offen offset:1024 sc1
  buffer_load_dwordx4 v[116:119], v2, s[4:7], s25 offen offset:1024 sc1
  s_branch T_loop_28
.p2align 6
T_retry_29:
  s_mov_b64 exec, vcc
  buffer_load_dwordx4 v[124:127], v2, s[4:7], s24 offen offset:1024 sc1
  buffer_load_dwordx4 v[116:119], v2, s[4:7], s25 offen offset:1024 sc1
  s_mov_b64 exec, -1
  s_add_u32 s19, s19, 1
  s_cmp_gt_u32 s19, 32768
  s_cbranch_scc1 M_exit
T_loop_28:
  s_waitcnt vmcnt(3) lgkmcnt(0)
  v_max3_u32 v123, v124, v125, v126
  v_max_u32 v123, v123, v127
  v_mov_b32_dpp v120, v124 row_ror:8 row_mask:0xf bank_mask:0xf
  v_mov_b32_dpp v121, v125 row_ror:8 row_mask:0xf bank_mask:0xf
  s_waitcnt vmcnt(2)
  v_max3_u32 v123, v123, v116, v117
  v_max3_u32 v123, v123, v118, v119
  v_cmp_eq_u32 vcc, -1, v123
  s_cbranch_vccnz T_retry_29
  v_smfmac_f32_16x16x64_bf16 v[16:19], v[124:127], v[68:75], v0
  s_add_u32 s14, s14, 1
  ds_write_b128 v2, v[124:127] offset:1024
  v_mov_b32_dpp v122, v126 row_ror:8 row_mask:0xf bank_mask:0xf
  v_smfmac_f32_16x16x64_bf16 v[20:23], v[124:127], v[76:83], v0
  s_and_b32 s57, s14, 1
  v_mov_b32_dpp v123, v127 row_ror:8 row_mask:0xf bank_mask:0xf
  v_smfmac_f32_16x16x64_bf16 v[24:27], v[124:127], v[84:91], v0
  s_and_b32 s36, s14, 3
  ds_write_b128 v2, v[116:119] offset:5120
  v_smfmac_f32_16x16x64_bf16 v[16:19], v[120:123], v[92:99], v0
  s_lshl_b32 s36, s36, 13
  v_mov_b32_dpp v84, v116 row_ror:8 row_mask:0xf bank_mask:0xf
  v_smfmac_f32_16x16x64_bf16 v[20:23], v[120:123], v[100:107], v0
  s_add_u32 s26, s36, s23
  ds_read_b128 v[68:71], v4 offset:12288
  v_mov_b32_dpp v85, v117 row_ror:8 row_mask:0xf bank_mask:0xf
  v_smfmac_f32_16x16x64_bf16 v[24:27], v[120:123], v[108:115], v0
  s_add_u32 s36, s36, 8192
  ds_read_b128 v[72:75], v4 offset:13312
  v_mov_b32_dpp v86, v118 row_ror:8 row_mask:0xf bank_mask:0xf
  v_smfmac_f32_16x16x64_bf16 v[16:19], v[116:119], v[224:231], v0
  s_and_b32 s36, s36, 0x7fff
  ds_read_b128 v[76:79], v4 offset:14336
  v_mov_b32_dpp v87, v119 row_ror:8 row_mask:0xf bank_mask:0xf
  v_smfmac_f32_16x16x64_bf16 v[20:23], v[116:119], v[240:247], v0
  s_waitcnt lgkmcnt(3)
  s_barrier
  ds_read_b128 v[100:103], v2 offset:0
  v_smfmac_f32_16x16x64_bf16 v[24:27], v[116:119], a[0:7], v0
  s_mov_b32 m0, s31
  ds_read_b128 v[120:123], v1 offset:0
  v_smfmac_f32_16x16x64_bf16 v[16:19], v[84:87], v[232:239], v0
  s_cmp_ge_i32 s14, s30
  s_cbranch_scc1 T_kvw_32
T_kvb_33:
  v_smfmac_f32_16x16x64_bf16 v[20:23], v[84:87], v[248:255], v0
  ds_read_b128 v[80:83], v4 offset:15360
  v_smfmac_f32_16x16x64_bf16 v[24:27], v[84:87], a[8:15], v0
  s_waitcnt lgkmcnt(2)
  buffer_load_dwordx4 v9, s[4:7], s27 offen sc1 lds
  v_smfmac_f32_16x16x64_bf16 v[16:19], v[100:103], v[128:135], v0
  ds_read_b128 v[92:95], v2 offset:3072
  s_mov_b32 m0, s32
  v_smfmac_f32_16x16x64_bf16 v[20:23], v[100:103], v[144:151], v0
  ds_read_b128 v[96:99], v1 offset:3072
  v_smfmac_f32_16x16x64_bf16 v[24:27], v[100:103], v[68:75], v0
  s_waitcnt vmcnt(1) lgkmcnt(3)
  ds_read_b128 v[116:119], v2 offset:2048
  v_smfmac_f32_16x16x64_bf16 v[16:19], v[120:123], v[136:143], v0
  ds_read_b128 v[124:127], v1 offset:2048
  buffer_load_dwordx4 v9, s[4:7], s27 offen offset:128 sc1 lds
  v_smfmac_f32_16x16x64_bf16 v[20:23], v[120:123], v[152:159], v0
  s_waitcnt lgkmcnt(4)
  ds_read_b128 v[104:107], v2 offset:4096
  s_mov_b32 m0, s33
  v_smfmac_f32_16x16x64_bf16 v[24:27], v[120:123], v[76:83], v0
  s_waitcnt lgkmcnt(4)
  ds_read_b128 v[108:111], v1 offset:4096
  v_smfmac_f32_16x16x64_bf16 v[16:19], v[92:95], v[160:167], v0
  s_waitcnt lgkmcnt(4)
  ds_read_b128 v[112:115], v2 offset:7168
  v_smfmac_f32_16x16x64_bf16 v[16:19], v[96:99], v[168:175], v0
  s_waitcnt lgkmcnt(4)
  ds_read_b128 v[84:87], v1 offset:7168
  buffer_load_dwordx4 v10, s[4:7], s28 offen sc1 lds
  v_smfmac_f32_16x16x64_bf16 v[16:19], v[116:119], v[192:199], v0
  s_waitcnt lgkmcnt(4)
  ds_read_b128 v[88:91], v2 offset:6144
  s_mov_b32 m0, s34
  v_smfmac_f32_16x16x64_bf16 v[16:19], v[124:127], v[200:207], v0
  s_waitcnt lgkmcnt(4)
  ds_read_b128 v[100:103], v1 offset:6144
  v_smfmac_f32_16x16x64_bf16 v[16:19], v[104:107], a[16:23], v0
  s_waitcnt lgkmcnt(4)
  ds_read_b128 v[68:71], v4 offset:16384
  v_smfmac_f32_16x16x64_bf16 v[16:19], v[108:111], a[24:31], v0
  s_waitcnt lgkmcnt(4)
  ds_read_b128 v[72:75], v4 offset:17408
  buffer_load_dwordx4 v10, s[4:7], s28 offen offset:256 sc1 lds
  v_smfmac_f32_16x16x64_bf16 v[16:19], v[112:115], a[64:71], v0
  s_waitcnt lgkmcnt(4)
  ds_read_b128 v[76:79], v4 offset:18432
  v_smfmac_f32_16x16x64_bf16 v[16:19], v[84:87], a[72:79], v0
  s_waitcnt lgkmcnt(4)
  ds_read_b128 v[80:83], v4 offset:19456
  v_smfmac_f32_16x16x64_bf16 v[16:19], v[88:91], a[112:119], v0
  s_waitcnt lgkmcnt(4)
  v_smfmac_f32_16x16x64_bf16 v[16:19], v[100:103], a[120:127], v0
  s_add_u32 s24, s36, 145752064
  s_add_u32 s25, s36, 145756160
  v_smfmac_f32_16x16x64_bf16 v[20:23], v[92:95], v[176:183], v0
  s_add_u32 s35, s36, s23
  v_smfmac_f32_16x16x64_bf16 v[20:23], v[96:99], v[184:191], v0
  s_waitcnt lgkmcnt(2)
  v_smfmac_f32_16x16x64_bf16 v[20:23], v[116:119], v[68:75], v0
  s_waitcnt lgkmcnt(0)
  ds_read_b128 v[68:71], v4 offset:20480
  v_mul_f32 v16, s18, v16
  v_smfmac_f32_16x16x64_bf16 v[20:23], v[124:127], v[76:83], v0
  ds_read_b128 v[72:75], v4 offset:21504
  v_mul_f32 v17, s18, v17
  v_smfmac_f32_16x16x64_bf16 v[20:23], v[104:107], a[32:39], v0
  ds_read_b128 v[76:79], v4 offset:22528
  v_mul_f32 v18, s18, v18
  v_smfmac_f32_16x16x64_bf16 v[20:23], v[108:111], a[40:47], v0
  ds_read_b128 v[80:83], v4 offset:23552
  v_mul_f32 v19, s18, v19
  v_smfmac_f32_16x16x64_bf16 v[20:23], v[112:115], a[80:87], v0
  v_cvt_pk_bf16_f32 v120, v16, v17
  v_smfmac_f32_16x16x64_bf16 v[20:23], v[84:87], a[88:95], v0
  v_cvt_pk_bf16_f32 v121, v18, v19
  v_smfmac_f32_16x16x64_bf16 v[20:23], v[88:91], a[128:135], v0
  ds_write_b64 v5, v[120:121] offset:24576
  v_smfmac_f32_16x16x64_bf16 v[20:23], v[100:103], a[136:143], v0
  s_waitcnt lgkmcnt(3)
  v_smfmac_f32_16x16x64_bf16 v[24:27], v[92:95], v[68:75], v0
  s_waitcnt lgkmcnt(1)
  v_mov_b64 v[92:93], 0
  v_smfmac_f32_16x16x64_bf16 v[24:27], v[96:99], v[76:83], v0
  s_nop 1
  v_cvt_pk_bf16_f32 v122, v20, v21
  v_cvt_pk_bf16_f32 v123, v22, v23
  v_smfmac_f32_16x16x64_bf16 v[24:27], v[116:119], v[208:215], v0
  ds_write_b64 v5, v[122:123] offset:26880
  v_mov_b64 v[94:95], 0
  v_smfmac_f32_16x16x64_bf16 v[24:27], v[124:127], v[216:223], v0
  s_waitcnt lgkmcnt(1)
  s_barrier
  ds_read_b64_tr_b16 v[68:69], v6 offset:24576
  v_smfmac_f32_16x16x64_bf16 v[24:27], v[104:107], a[48:55], v0
  s_add_u32 s27, s27, 8192
  ds_read_b64_tr_b16 v[70:71], v6 offset:24640
  ds_read_b64_tr_b16 v[72:73], v6 offset:24832
  v_smfmac_f32_16x16x64_bf16 v[24:27], v[108:111], a[56:63], v0
  s_add_u32 s28, s28, 8192
  ds_read_b64_tr_b16 v[74:75], v6 offset:24896
  ds_read_b64_tr_b16 v[76:77], v6 offset:25088
  v_smfmac_f32_16x16x64_bf16 v[24:27], v[112:115], a[96:103], v0
  s_nop 0
  ds_read_b64_tr_b16 v[78:79], v6 offset:25152
  ds_read_b64_tr_b16 v[80:81], v6 offset:25344
  v_smfmac_f32_16x16x64_bf16 v[24:27], v[84:87], a[104:111], v0
  ds_read_b64_tr_b16 v[82:83], v6 offset:25408
  v_mov_b64 v[96:97], 0
  v_smfmac_f32_16x16x64_bf16 v[24:27], v[88:91], a[144:151], v0
  s_waitcnt lgkmcnt(8)
  s_barrier
  ds_read_b64_tr_b16 v[116:117], v6 offset:26880
  v_smfmac_f32_16x16x64_bf16 v[24:27], v[100:103], a[152:159], v0
  s_waitcnt lgkmcnt(7)
  ds_read_b64_tr_b16 v[118:119], v6 offset:26944
  v_mfma_f32_16x16x32_bf16 v[16:19], v[36:39], v[68:71], 0
  s_waitcnt lgkmcnt(6)
  ds_read_b64_tr_b16 v[124:125], v6 offset:27136
  ds_read_b64_tr_b16 v[126:127], v6 offset:27200
  v_mfma_f32_16x16x32_bf16 v[16:19], v[40:43], v[72:75], v[16:19]
  s_waitcnt lgkmcnt(6)
  ds_read_b64_tr_b16 v[104:105], v6 offset:27392
  ds_read_b64_tr_b16 v[106:107], v6 offset:27456
  v_mfma_f32_16x16x32_bf16 v[16:19], v[44:47], v[76:79], v[16:19]
  s_waitcnt lgkmcnt(6)
  ds_read_b64_tr_b16 v[108:109], v6 offset:27648
  ds_read_b64_tr_b16 v[110:111], v6 offset:27712
  v_mfma_f32_16x16x32_bf16 v[16:19], v[48:51], v[80:83], v[16:19]
  s_waitcnt lgkmcnt(6)
  v_cvt_pk_bf16_f32 v120, v24, v25
  v_cvt_pk_bf16_f32 v121, v26, v27
  v_mfma_f32_16x16x32_bf16 v[112:115], v[116:119], v[68:71], 0
  s_waitcnt lgkmcnt(4)
  v_mov_b64 v[98:99], 0
  v_mfma_f32_16x16x32_bf16 v[112:115], v[124:127], v[72:75], v[112:115]
  s_waitcnt lgkmcnt(2)
  buffer_store_dwordx4 v[120:123], v2, s[4:7], s29 offen offset:1024 sc1
  v_mov_b64 v[36:37], 0
  v_exp_f32 v100, v16
  v_mfma_f32_16x16x32_bf16 v[112:115], v[104:107], v[76:79], v[112:115]
  s_waitcnt lgkmcnt(0)
  v_exp_f32 v101, v17
  v_mfma_f32_16x16x32_bf16 v[112:115], v[108:111], v[80:83], v[112:115]
  v_exp_f32 v102, v18
  v_mfma_f32_16x16x32_bf16 v[20:23], v[52:55], v[68:71], 0
  s_cmp_eq_u32 s14, 63
  v_exp_f32 v103, v19
  v_mfma_f32_16x16x32_bf16 v[20:23], v[56:59], v[72:75], v[20:23]
  s_cbranch_scc1 M_tdone
  v_cvt_pk_bf16_f32 v44, v100, v101
  v_cvt_pk_bf16_f32 v45, v102, v103
  v_mfma_f32_16x16x32_bf16 v[20:23], v[60:63], v[76:79], v[20:23]
  s_add_u32 s29, s29, 131072
  v_exp_f32 v100, v112
  v_mfma_f32_16x16x32_bf16 v[20:23], v[64:67], v[80:83], v[20:23]
  v_exp_f32 v101, v113
  v_exp_f32 v102, v114
  v_exp_f32 v103, v115
  v_cvt_pk_bf16_f32 v84, v100, v101
  v_cvt_pk_bf16_f32 v85, v102, v103
  v_cndmask_b32 v48, v84, 0, s[16:17]
  v_cndmask_b32 v49, v85, 0, s[16:17]
  v_cndmask_b32 v50, 0, v84, s[16:17]
  v_cndmask_b32 v51, 0, v85, s[16:17]
  v_exp_f32 v100, v20
  v_mfma_f32_16x16x16_bf16 v[88:91], v[12:13], v[48:49], 0
  v_exp_f32 v101, v21
  v_mfma_f32_16x16x16_bf16 v[24:27], v[120:121], v[48:49], 0
  v_exp_f32 v102, v22
  v_mfma_f32_16x16x16_bf16 v[116:119], v[120:121], v[50:51], 0
  v_exp_f32 v103, v23
  v_cvt_pk_bf16_f32 v46, v100, v101
  v_cvt_pk_bf16_f32 v47, v102, v103
  v_mov_b64 v[38:39], 0
  s_nop 0
  v_mfma_f32_16x16x32_bf16 v[88:91], v[12:15], v[44:47], v[88:91]
  v_mov_b64 v[40:41], 0
  v_mov_b64 v[42:43], 0
  v_mfma_f32_16x16x32_bf16 v[24:27], v[28:31], v[44:47], v[24:27]
  ds_read_b128 v[52:55], v4 offset:24576
  ds_read_b128 v[56:59], v4 offset:25600
  v_mfma_f32_16x16x32_bf16 v[116:119], v[32:35], v[44:47], v[116:119]
  s_nop 1
  v_rcp_f32 v89, v88
  v_subrev_u32 v100, s54, v88
  v_cmp_le_u32 vcc, s55, v100
  v_mul_f32 v24, v89, v24
  v_mul_f32 v25, v89, v25
  s_cbranch_vccnz T_slow_35
T_back_36:
  v_cvt_pk_bf16_f32 v124, v24, v25
  v_pk_mul_f32 v[26:27], v[26:27], v[88:89] op_sel:[0,1] op_sel_hi:[1,1]
  v_pk_mul_f32 v[116:117], v[116:117], v[88:89] op_sel:[0,1] op_sel_hi:[1,1]
  v_pk_mul_f32 v[118:119], v[118:119], v[88:89] op_sel:[0,1] op_sel_hi:[1,1]
  v_cvt_pk_bf16_f32 v125, v26, v27
  v_cvt_pk_bf16_f32 v126, v116, v117
  v_cvt_pk_bf16_f32 v127, v118, v119
  ds_write_b128 v11, v[124:127] offset:29696
  s_nop 0
  v_smfmac_f32_16x16x64_bf16 v[92:95], v[124:127], a[160:167], v0
  v_smfmac_f32_16x16x64_bf16 v[96:99], v[124:127], a[168:175], v0
  v_smfmac_f32_16x16x64_bf16 v[36:39], v[124:127], a[176:183], v0
  v_smfmac_f32_16x16x64_bf16 v[40:43], v[124:127], a[184:191], v0
  s_waitcnt lgkmcnt(0)
  s_barrier
  ds_read_b128 v[104:107], v11 offset:29184
  ds_read_b128 v[108:111], v11 offset:30720
  ds_read_b128 v[68:71], v11 offset:30208
  s_waitcnt lgkmcnt(2)
  v_smfmac_f32_16x16x64_bf16 v[92:95], v[104:107], a[192:199], v0
  s_waitcnt lgkmcnt(1)
  ds_read_b128 v[76:79], v4 offset:28672
  v_smfmac_f32_16x16x64_bf16 v[92:95], v[108:111], a[224:231], v0
  s_waitcnt lgkmcnt(1)
  ds_read_b128 v[80:83], v4 offset:29696
  v_smfmac_f32_16x16x64_bf16 v[92:95], v[68:71], a[240:247], v0
  ds_read_b128 v[60:63], v4 offset:26624
  v_smfmac_f32_16x16x64_bf16 v[96:99], v[104:107], a[200:207], v0
  ds_read_b128 v[64:67], v4 offset:27648
  v_smfmac_f32_16x16x64_bf16 v[96:99], v[108:111], a[232:239], v0
  ds_read_b128 v[28:31], v4 offset:30720
  s_nop 0
  v_cvt_pk_bf16_f32 v16, v92, v93
  v_cvt_pk_bf16_f32 v17, v94, v95
  v_bfi_b32 v16, 1, s57, v16
  v_smfmac_f32_16x16x64_bf16 v[96:99], v[68:71], a[248:255], v0
  buffer_store_dwordx2 v[16:17], v7, s[4:7], s20 offen offset:0
  v_smfmac_f32_16x16x64_bf16 v[36:39], v[104:107], a[208:215], v0
  ds_read_b128 v[32:35], v4 offset:31744
  v_smfmac_f32_16x16x64_bf16 v[36:39], v[108:111], v[52:59], v0
  s_waitcnt lgkmcnt(4)
  s_nop 0
  v_cvt_pk_bf16_f32 v18, v96, v97
  v_cvt_pk_bf16_f32 v19, v98, v99
  v_bfi_b32 v18, 1, s57, v18
  v_smfmac_f32_16x16x64_bf16 v[36:39], v[68:71], v[76:83], v0
  buffer_store_dwordx2 v[18:19], v7, s[4:7], s20 offen offset:64
  v_smfmac_f32_16x16x64_bf16 v[40:43], v[104:107], a[216:223], v0
  s_waitcnt lgkmcnt(2)
  ds_read_b128 v[116:119], v2 offset:31232
  v_smfmac_f32_16x16x64_bf16 v[40:43], v[108:111], v[60:67], v0
  s_waitcnt lgkmcnt(1)
  s_nop 0
  v_cvt_pk_bf16_f32 v20, v36, v37
  v_cvt_pk_bf16_f32 v21, v38, v39
  v_bfi_b32 v20, 1, s57, v20
  v_smfmac_f32_16x16x64_bf16 v[40:43], v[68:71], v[28:35], v0
  buffer_store_dwordx2 v[20:21], v7, s[4:7], s21 offen offset:0
  s_nop 6
  v_cvt_pk_bf16_f32 v22, v40, v41
  v_cvt_pk_bf16_f32 v23, v42, v43
  v_bfi_b32 v22, 1, s57, v22
  buffer_store_dwordx2 v[22:23], v7, s[4:7], s21 offen offset:64
  ds_read_b128 v[68:71], v4 offset:0
  ds_read_b128 v[72:75], v4 offset:1024
  ds_read_b128 v[76:79], v4 offset:4096
  ds_read_b128 v[80:83], v4 offset:5120
  ds_read_b128 v[84:87], v4 offset:8192
  ds_read_b128 v[88:91], v4 offset:9216
  ds_read_b128 v[92:95], v4 offset:2048
  ds_read_b128 v[96:99], v4 offset:3072
  ds_read_b128 v[100:103], v4 offset:6144
  ds_read_b128 v[104:107], v4 offset:7168
  ds_read_b128 v[108:111], v4 offset:10240
  ds_read_b128 v[112:115], v4 offset:11264
  v_mov_b64 v[16:17], 0
  v_mov_b64 v[18:19], 0
  v_mov_b64 v[20:21], 0
  v_mov_b64 v[22:23], 0
  v_mov_b64 v[24:25], 0
  v_mov_b64 v[26:27], 0
  s_mov_b32 s19, 0
  v_mov_b32 v49, -1
  ds_read_b64 v[44:45], v2 offset:32256
  s_waitcnt lgkmcnt(0)
  v_readfirstlane_b32 s38, v44
  v_readfirstlane_b32 s37, v45
  s_nop 0
  s_lshl_b32 s38, s38, 1
  s_lshl1_add_u32 s37, s37, 1
  s_min_u32 s38, s38, s37
  s_cmp_ge_u32 s38, 64
  s_cselect_b32 s38, 100, s38
  s_sub_u32 s38, s38, 1
  s_max_i32 s30, s30, s38
  s_waitcnt vmcnt(0)
  buffer_load_dwordx4 v[52:55], v2, s[4:7], s22 offen offset:0 sc1
  buffer_load_dwordx4 v[56:59], v2, s[4:7], s22 offen offset:1024 sc1
  buffer_load_dwordx4 v[60:63], v2, s[4:7], s22 offen offset:2048 sc1
  buffer_load_dwordx4 v[64:67], v2, s[4:7], s22 offen offset:3072 sc1
  s_waitcnt lgkmcnt(12)
  s_waitcnt vmcnt(3)
  v_mfma_f32_16x16x32_bf16 v[120:123], v[116:119], v[52:55], 0
  v_xor_b32 v48, s57, v52
  v_bitop3_b32 v48, v48, v54, s57 bitop3:0xf6
  s_waitcnt vmcnt(2)
  v_mfma_f32_16x16x32_bf16 v[120:123], v[116:119], v[56:59], v[120:123]
  v_bitop3_b32 v48, v48, v56, s57 bitop3:0xf6
  v_bitop3_b32 v48, v48, v58, s57 bitop3:0xf6
  s_waitcnt vmcnt(1)
  v_mfma_f32_16x16x32_bf16 v[120:123], v[116:119], v[60:63], v[120:123]
  v_bitop3_b32 v48, v48, v60, s57 bitop3:0xf6
  v_bitop3_b32 v48, v48, v62, s57 bitop3:0xf6
  s_waitcnt vmcnt(0)
  v_mfma_f32_16x16x32_bf16 v[120:123], v[116:119], v[64:67], v[120:123]
  v_bitop3_b32 v48, v48, v64, s57 bitop3:0xf6
  v_bitop3_b32 v48, v48, v66, s57 bitop3:0xf6
  v_and_b32 v48, 1, v48
  v_cmp_ne_u32 vcc, 0, v48
  s_cbranch_vccnz T_p1re_38
T_p1ok_39:
  s_nop 2
  v_add_f32_dpp v120, v120, v120 row_ror:8 row_mask:0xf bank_mask:0xf
  v_add_f32_dpp v121, v121, v121 row_ror:8 row_mask:0xf bank_mask:0xf
  v_cvt_pk_bf16_f32 v48, v120, v121
  buffer_store_dword v48, v8, s[4:7], s35 offen
  buffer_store_dword v49, v8, s[4:7], s26 offen
  s_barrier
  ds_read_b128 v[28:31], v2 offset:17408
  ds_read_b128 v[32:35], v2 offset:21504
  ds_read_b128 v[36:39], v2 offset:8192
  ds_read_b128 v[40:43], v2 offset:9216
  ds_read_b128 v[44:47], v2 offset:10240
  ds_read_b128 v[48:51], v2 offset:11264
  buffer_load_dwordx4 v[124:127], v2, s[4:7], s24 offen offset:1024 sc1
  buffer_load_dwordx4 v[116:119], v2, s[4:7], s25 offen offset:1024 sc1
  ds_read_b128 v[52:55], v2 offset:12288
  ds_read_b128 v[56:59], v2 offset:13312
  ds_read_b128 v[60:63], v2 offset:14336
  ds_read_b128 v[64:67], v2 offset:15360
  buffer_load_dwordx4 v[124:127], v2, s[4:7], s24 offen offset:1024 sc1
  buffer_load_dwordx4 v[116:119], v2, s[4:7], s25 offen offset:1024 sc1
  s_mov_b32 s19, 0
  s_branch T_loop_28
T_p1re_38:
  s_mov_b64 exec, vcc
  buffer_load_dwordx4 v[52:55], v2, s[4:7], s22 offen offset:0 sc1
  buffer_load_dwordx4 v[56:59], v2, s[4:7], s22 offen offset:1024 sc1
  buffer_load_dwordx4 v[60:63], v2, s[4:7], s22 offen offset:2048 sc1
  buffer_load_dwordx4 v[64:67], v2, s[4:7], s22 offen offset:3072 sc1
  s_mov_b64 exec, -1
  s_add_u32 s19, s19, 1
  s_cmp_gt_u32 s19, 32768
  s_cbranch_scc1 M_exit
  s_waitcnt vmcnt(3)
  v_mfma_f32_16x16x32_bf16 v[120:123], v[116:119], v[52:55], 0
  v_xor_b32 v48, s57, v52
  v_bitop3_b32 v48, v48, v54, s57 bitop3:0xf6
  s_waitcnt vmcnt(2)
  v_mfma_f32_16x16x32_bf16 v[120:123], v[116:119], v[56:59], v[120:123]
  v_bitop3_b32 v48, v48, v56, s57 bitop3:0xf6
  v_bitop3_b32 v48, v48, v58, s57 bitop3:0xf6
  s_waitcnt vmcnt(1)
  v_mfma_f32_16x16x32_bf16 v[120:123], v[116:119], v[60:63], v[120:123]
  v_bitop3_b32 v48, v48, v60, s57 bitop3:0xf6
  v_bitop3_b32 v48, v48, v62, s57 bitop3:0xf6
  s_waitcnt vmcnt(0)
  v_mfma_f32_16x16x32_bf16 v[120:123], v[116:119], v[64:67], v[120:123]
  v_bitop3_b32 v48, v48, v64, s57 bitop3:0xf6
  v_bitop3_b32 v48, v48, v66, s57 bitop3:0xf6
  v_and_b32 v48, 1, v48
  v_cmp_ne_u32 vcc, 0, v48
  s_cbranch_vccnz T_p1re_38
  s_branch T_p1ok_39
T_kvw_32:
  s_mov_b32 s19, 0
  s_branch T_kvok_41
T_kv_40:
  s_sleep 4
  s_add_u32 s19, s19, 1
  s_cmp_gt_u32 s19, 32768
  s_cbranch_scc1 M_exit
T_kvok_41:
  s_add_u32 s39, s99, 128
  s_mov_b32 s38, 0
  s_mov_b32 s37, 0
  s_atomic_or s38, s[58:59], s99 glc
  s_atomic_or s37, s[58:59], s39 glc
  s_waitcnt lgkmcnt(0)
  s_lshl_b32 s38, s38, 1
  s_lshl1_add_u32 s37, s37, 1
  s_min_u32 s38, s38, s37
  s_cmp_ge_u32 s38, 64
  s_cselect_b32 s38, 100, s38
  s_sub_u32 s38, s38, 1
  s_max_i32 s30, s30, s38
  s_cmp_ge_i32 s14, s30
  s_cbranch_scc1 T_kv_40
  s_branch T_kvb_33
T_slow_35:
  s_nop 7
  v_max3_f32 v100, v16, v17, v18
  v_max3_f32 v100, v100, v19, v20
  v_max3_f32 v100, v100, v21, v22
  v_max3_f32 v100, v100, v23, v112
  v_max3_f32 v100, v100, v113, v114
  v_max_f32 v100, v100, v115
  v_mov_b32 v101, v100
  s_nop 1
  v_permlane32_swap_b32 v100, v101
  s_nop 1
  v_max_f32 v100, v100, v101
  v_mov_b32 v101, v100
  s_nop 1
  v_permlane16_swap_b32 v100, v101
  s_nop 1
  v_max_f32 v100, v100, v101
  v_sub_f32 v16, v16, v100
  v_sub_f32 v17, v17, v100
  v_sub_f32 v18, v18, v100
  v_sub_f32 v19, v19, v100
  v_exp_f32 v16, v16
  v_exp_f32 v17, v17
  v_exp_f32 v18, v18
  v_exp_f32 v19, v19
  v_sub_f32 v20, v20, v100
  v_sub_f32 v21, v21, v100
  v_sub_f32 v22, v22, v100
  v_sub_f32 v23, v23, v100
  v_exp_f32 v20, v20
  v_exp_f32 v21, v21
  v_exp_f32 v22, v22
  v_exp_f32 v23, v23
  v_sub_f32 v112, v112, v100
  v_sub_f32 v113, v113, v100
  v_sub_f32 v114, v114, v100
  v_sub_f32 v115, v115, v100
  v_exp_f32 v112, v112
  v_exp_f32 v113, v113
  v_exp_f32 v114, v114
  v_exp_f32 v115, v115
  s_nop 0
  v_cvt_pk_bf16_f32 v44, v16, v17
  v_cvt_pk_bf16_f32 v45, v18, v19
  v_cvt_pk_bf16_f32 v46, v20, v21
  v_cvt_pk_bf16_f32 v47, v22, v23
  v_cvt_pk_bf16_f32 v84, v112, v113
  v_cvt_pk_bf16_f32 v85, v114, v115
  v_cndmask_b32 v48, v84, 0, s[16:17]
  v_cndmask_b32 v49, v85, 0, s[16:17]
  v_cndmask_b32 v50, 0, v84, s[16:17]
  v_cndmask_b32 v51, 0, v85, s[16:17]
  s_nop 1
  v_mfma_f32_16x16x16_bf16 v[88:91], v[12:13], v[48:49], 0
  v_mfma_f32_16x16x16_bf16 v[24:27], v[120:121], v[48:49], 0
  v_mfma_f32_16x16x16_bf16 v[116:119], v[120:121], v[50:51], 0
  v_mfma_f32_16x16x32_bf16 v[88:91], v[12:15], v[44:47], v[88:91]
  v_mfma_f32_16x16x32_bf16 v[24:27], v[28:31], v[44:47], v[24:27]
  v_mfma_f32_16x16x32_bf16 v[116:119], v[32:35], v[44:47], v[116:119]
  s_nop 7
  s_nop 1
  v_rcp_f32 v89, v88
  s_nop 0
  v_mul_f32 v24, v89, v24
  v_mul_f32 v25, v89, v25
  s_branch T_back_36
T_w_12:
  s_mov_b32 s19, 0
  v_mov_b64 v[16:17], 0
  v_mov_b64 v[18:19], 0
  v_mov_b64 v[20:21], 0
  v_mov_b64 v[22:23], 0
  v_mov_b64 v[24:25], 0
  v_mov_b64 v[26:27], 0
  buffer_load_dwordx4 v[124:127], v2, s[4:7], s24 offen offset:2048 sc1
  buffer_load_dwordx4 v[116:119], v2, s[4:7], s25 offen offset:2048 sc1
  buffer_load_dwordx4 v[124:127], v2, s[4:7], s24 offen offset:2048 sc1
  buffer_load_dwordx4 v[116:119], v2, s[4:7], s25 offen offset:2048 sc1
  s_branch T_loop_42
.p2align 6
T_retry_43:
  s_mov_b64 exec, vcc
  buffer_load_dwordx4 v[124:127], v2, s[4:7], s24 offen offset:2048 sc1
  buffer_load_dwordx4 v[116:119], v2, s[4:7], s25 offen offset:2048 sc1
  s_mov_b64 exec, -1
  s_add_u32 s19, s19, 1
  s_cmp_gt_u32 s19, 32768
  s_cbranch_scc1 M_exit
T_loop_42:
  s_waitcnt vmcnt(3) lgkmcnt(0)
  v_max3_u32 v123, v124, v125, v126
  v_max_u32 v123, v123, v127
  v_mov_b32_dpp v120, v124 row_ror:8 row_mask:0xf bank_mask:0xf
  v_mov_b32_dpp v121, v125 row_ror:8 row_mask:0xf bank_mask:0xf
  s_waitcnt vmcnt(2)
  v_max3_u32 v123, v123, v116, v117
  v_max3_u32 v123, v123, v118, v119
  v_cmp_eq_u32 vcc, -1, v123
  s_cbranch_vccnz T_retry_43
  v_smfmac_f32_16x16x64_bf16 v[16:19], v[124:127], v[68:75], v0
  s_add_u32 s14, s14, 1
  ds_write_b128 v2, v[124:127] offset:2048
  v_mov_b32_dpp v122, v126 row_ror:8 row_mask:0xf bank_mask:0xf
  v_smfmac_f32_16x16x64_bf16 v[20:23], v[124:127], v[76:83], v0
  s_and_b32 s57, s14, 1
  v_mov_b32_dpp v123, v127 row_ror:8 row_mask:0xf bank_mask:0xf
  v_smfmac_f32_16x16x64_bf16 v[24:27], v[124:127], v[84:91], v0
  s_and_b32 s36, s14, 3
  ds_write_b128 v2, v[116:119] offset:6144
  v_smfmac_f32_16x16x64_bf16 v[16:19], v[120:123], v[92:99], v0
  s_lshl_b32 s36, s36, 13
  v_mov_b32_dpp v84, v116 row_ror:8 row_mask:0xf bank_mask:0xf
  v_smfmac_f32_16x16x64_bf16 v[20:23], v[120:123], v[100:107], v0
  s_add_u32 s26, s36, s23
  ds_read_b128 v[68:71], v4 offset:12288
  v_mov_b32_dpp v85, v117 row_ror:8 row_mask:0xf bank_mask:0xf
  v_smfmac_f32_16x16x64_bf16 v[24:27], v[120:123], v[108:115], v0
  s_add_u32 s36, s36, 8192
  ds_read_b128 v[72:75], v4 offset:13312
  v_mov_b32_dpp v86, v118 row_ror:8 row_mask:0xf bank_mask:0xf
  v_smfmac_f32_16x16x64_bf16 v[16:19], v[116:119], v[224:231], v0
  s_and_b32 s36, s36, 0x7fff
  ds_read_b128 v[76:79], v4 offset:14336
  v_mov_b32_dpp v87, v119 row_ror:8 row_mask:0xf bank_mask:0xf
  v_smfmac_f32_16x16x64_bf16 v[20:23], v[116:119], v[240:247], v0
  s_waitcnt lgkmcnt(3)
  s_barrier
  ds_read_b128 v[100:103], v2 offset:3072
  v_smfmac_f32_16x16x64_bf16 v[24:27], v[116:119], a[0:7], v0
  s_mov_b32 m0, s31
  ds_read_b128 v[120:123], v1 offset:3072
  v_smfmac_f32_16x16x64_bf16 v[16:19], v[84:87], v[232:239], v0
  s_cmp_ge_i32 s14, s30
  s_cbranch_scc1 T_kvw_46
T_kvb_47:
  v_smfmac_f32_16x16x64_bf16 v[20:23], v[84:87], v[248:255], v0
  ds_read_b128 v[80:83], v4 offset:15360
  v_smfmac_f32_16x16x64_bf16 v[24:27], v[84:87], a[8:15], v0
  s_waitcnt lgkmcnt(2)
  v_smfmac_f32_16x16x64_bf16 v[16:19], v[100:103], v[128:135], v0
  ds_read_b128 v[92:95], v2 offset:0
  buffer_load_dwordx4 v9, s[4:7], s27 offen sc1 lds
  v_smfmac_f32_16x16x64_bf16 v[20:23], v[100:103], v[144:151], v0
  ds_read_b128 v[96:99], v1 offset:0
  s_mov_b32 m0, s32
  v_smfmac_f32_16x16x64_bf16 v[24:27], v[100:103], v[68:75], v0
  s_waitcnt vmcnt(1) lgkmcnt(3)
  ds_read_b128 v[116:119], v2 offset:1024
  v_smfmac_f32_16x16x64_bf16 v[16:19], v[120:123], v[136:143], v0
  ds_read_b128 v[124:127], v1 offset:1024
  v_smfmac_f32_16x16x64_bf16 v[20:23], v[120:123], v[152:159], v0
  s_waitcnt lgkmcnt(4)
  ds_read_b128 v[104:107], v2 offset:7168
  buffer_load_dwordx4 v9, s[4:7], s27 offen offset:128 sc1 lds
  v_smfmac_f32_16x16x64_bf16 v[24:27], v[120:123], v[76:83], v0
  s_waitcnt lgkmcnt(4)
  ds_read_b128 v[108:111], v1 offset:7168
  s_mov_b32 m0, s33
  v_smfmac_f32_16x16x64_bf16 v[16:19], v[92:95], v[160:167], v0
  s_waitcnt lgkmcnt(4)
  ds_read_b128 v[112:115], v2 offset:4096
  v_mov_b32 v122, s98
  v_smfmac_f32_16x16x64_bf16 v[16:19], v[96:99], v[168:175], v0
  s_waitcnt lgkmcnt(4)
  ds_read_b128 v[84:87], v1 offset:4096
  v_smfmac_f32_16x16x64_bf16 v[16:19], v[116:119], v[192:199], v0
  s_waitcnt lgkmcnt(4)
  ds_read_b128 v[88:91], v2 offset:5120
  buffer_load_dwordx4 v10, s[4:7], s28 offen sc1 lds
  v_smfmac_f32_16x16x64_bf16 v[16:19], v[124:127], v[200:207], v0
  s_waitcnt lgkmcnt(4)
  ds_read_b128 v[100:103], v1 offset:5120
  s_mov_b32 m0, s34
  v_smfmac_f32_16x16x64_bf16 v[16:19], v[104:107], a[16:23], v0
  s_waitcnt lgkmcnt(4)
  ds_read_b128 v[68:71], v4 offset:16384
  v_smfmac_f32_16x16x64_bf16 v[16:19], v[108:111], a[24:31], v0
  s_waitcnt lgkmcnt(4)
  ds_read_b128 v[72:75], v4 offset:17408
  v_smfmac_f32_16x16x64_bf16 v[16:19], v[112:115], a[64:71], v0
  s_waitcnt lgkmcnt(4)
  ds_read_b128 v[76:79], v4 offset:18432
  buffer_load_dwordx4 v10, s[4:7], s28 offen offset:256 sc1 lds
  v_smfmac_f32_16x16x64_bf16 v[16:19], v[84:87], a[72:79], v0
  s_waitcnt lgkmcnt(4)
  ds_read_b128 v[80:83], v4 offset:19456
  v_smfmac_f32_16x16x64_bf16 v[16:19], v[88:91], a[112:119], v0
  s_waitcnt lgkmcnt(4)
  v_smfmac_f32_16x16x64_bf16 v[16:19], v[100:103], a[120:127], v0
  s_add_u32 s24, s36, 145752064
  s_add_u32 s25, s36, 145756160
  v_smfmac_f32_16x16x64_bf16 v[20:23], v[92:95], v[176:183], v0
  buffer_store_dword v122, v3, s[4:7], s15 offen sc1
  s_add_u32 s35, s36, s23
  v_smfmac_f32_16x16x64_bf16 v[20:23], v[96:99], v[184:191], v0
  s_waitcnt lgkmcnt(2)
  s_add_u32 s98, s14, 1
  v_smfmac_f32_16x16x64_bf16 v[20:23], v[116:119], v[68:75], v0
  s_waitcnt lgkmcnt(0)
  ds_read_b128 v[68:71], v4 offset:20480
  v_mul_f32 v16, s18, v16
  v_smfmac_f32_16x16x64_bf16 v[20:23], v[124:127], v[76:83], v0
  ds_read_b128 v[72:75], v4 offset:21504
  v_mul_f32 v17, s18, v17
  v_smfmac_f32_16x16x64_bf16 v[20:23], v[104:107], a[32:39], v0
  ds_read_b128 v[76:79], v4 offset:22528
  v_mul_f32 v18, s18, v18
  v_smfmac_f32_16x16x64_bf16 v[20:23], v[108:111], a[40:47], v0
  ds_read_b128 v[80:83], v4 offset:23552
  v_mul_f32 v19, s18, v19
  v_smfmac_f32_16x16x64_bf16 v[20:23], v[112:115], a[80:87], v0
  v_cvt_pk_bf16_f32 v120, v16, v17
  v_smfmac_f32_16x16x64_bf16 v[20:23], v[84:87], a[88:95], v0
  v_cvt_pk_bf16_f32 v121, v18, v19
  v_smfmac_f32_16x16x64_bf16 v[20:23], v[88:91], a[128:135], v0
  ds_write_b64 v5, v[120:121] offset:24576
  v_smfmac_f32_16x16x64_bf16 v[20:23], v[100:103], a[136:143], v0
  s_waitcnt lgkmcnt(3)
  v_smfmac_f32_16x16x64_bf16 v[24:27], v[92:95], v[68:75], v0
  s_waitcnt lgkmcnt(1)
  v_mov_b64 v[92:93], 0
  v_smfmac_f32_16x16x64_bf16 v[24:27], v[96:99], v[76:83], v0
  s_nop 1
  v_cvt_pk_bf16_f32 v122, v20, v21
  v_cvt_pk_bf16_f32 v123, v22, v23
  v_smfmac_f32_16x16x64_bf16 v[24:27], v[116:119], v[208:215], v0
  ds_write_b64 v5, v[122:123] offset:26880
  v_mov_b64 v[94:95], 0
  v_smfmac_f32_16x16x64_bf16 v[24:27], v[124:127], v[216:223], v0
  s_waitcnt lgkmcnt(1)
  s_barrier
  ds_read_b64_tr_b16 v[68:69], v6 offset:24576
  v_smfmac_f32_16x16x64_bf16 v[24:27], v[104:107], a[48:55], v0
  s_add_u32 s27, s27, 8192
  ds_read_b64_tr_b16 v[70:71], v6 offset:24640
  ds_read_b64_tr_b16 v[72:73], v6 offset:24832
  v_smfmac_f32_16x16x64_bf16 v[24:27], v[108:111], a[56:63], v0
  s_add_u32 s28, s28, 8192
  ds_read_b64_tr_b16 v[74:75], v6 offset:24896
  ds_read_b64_tr_b16 v[76:77], v6 offset:25088
  v_smfmac_f32_16x16x64_bf16 v[24:27], v[112:115], a[96:103], v0
  s_nop 0
  ds_read_b64_tr_b16 v[78:79], v6 offset:25152
  ds_read_b64_tr_b16 v[80:81], v6 offset:25344
  v_smfmac_f32_16x16x64_bf16 v[24:27], v[84:87], a[104:111], v0
  ds_read_b64_tr_b16 v[82:83], v6 offset:25408
  v_mov_b64 v[96:97], 0
  v_smfmac_f32_16x16x64_bf16 v[24:27], v[88:91], a[144:151], v0
  s_waitcnt lgkmcnt(8)
  s_barrier
  ds_read_b64_tr_b16 v[116:117], v6 offset:26880
  v_smfmac_f32_16x16x64_bf16 v[24:27], v[100:103], a[152:159], v0
  s_waitcnt lgkmcnt(7)
  ds_read_b64_tr_b16 v[118:119], v6 offset:26944
  v_mfma_f32_16x16x32_bf16 v[16:19], v[36:39], v[68:71], 0
  s_waitcnt lgkmcnt(6)
  ds_read_b64_tr_b16 v[124:125], v6 offset:27136
  ds_read_b64_tr_b16 v[126:127], v6 offset:27200
  v_mfma_f32_16x16x32_bf16 v[16:19], v[40:43], v[72:75], v[16:19]
  s_waitcnt lgkmcnt(6)
  ds_read_b64_tr_b16 v[104:105], v6 offset:27392
  ds_read_b64_tr_b16 v[106:107], v6 offset:27456
  v_mfma_f32_16x16x32_bf16 v[16:19], v[44:47], v[76:79], v[16:19]
  s_waitcnt lgkmcnt(6)
  ds_read_b64_tr_b16 v[108:109], v6 offset:27648
  ds_read_b64_tr_b16 v[110:111], v6 offset:27712
  v_mfma_f32_16x16x32_bf16 v[16:19], v[48:51], v[80:83], v[16:19]
  s_waitcnt lgkmcnt(6)
  v_cvt_pk_bf16_f32 v120, v24, v25
  v_cvt_pk_bf16_f32 v121, v26, v27
  v_mfma_f32_16x16x32_bf16 v[112:115], v[116:119], v[68:71], 0
  s_waitcnt lgkmcnt(4)
  v_mov_b64 v[98:99], 0
  v_mfma_f32_16x16x32_bf16 v[112:115], v[124:127], v[72:75], v[112:115]
  s_waitcnt lgkmcnt(2)
  v_mov_b64 v[36:37], 0
  v_exp_f32 v100, v16
  v_mfma_f32_16x16x32_bf16 v[112:115], v[104:107], v[76:79], v[112:115]
  s_waitcnt lgkmcnt(0)
  buffer_store_dwordx4 v[120:123], v2, s[4:7], s29 offen offset:2048 sc1
  v_exp_f32 v101, v17
  v_mfma_f32_16x16x32_bf16 v[112:115], v[108:111], v[80:83], v[112:115]
  v_exp_f32 v102, v18
  v_mfma_f32_16x16x32_bf16 v[20:23], v[52:55], v[68:71], 0
  s_cmp_eq_u32 s14, 63
  v_exp_f32 v103, v19
  v_mfma_f32_16x16x32_bf16 v[20:23], v[56:59], v[72:75], v[20:23]
  s_cbranch_scc1 M_tdone
  v_cvt_pk_bf16_f32 v44, v100, v101
  v_cvt_pk_bf16_f32 v45, v102, v103
  v_mfma_f32_16x16x32_bf16 v[20:23], v[60:63], v[76:79], v[20:23]
  s_add_u32 s29, s29, 131072
  v_exp_f32 v100, v112
  v_mfma_f32_16x16x32_bf16 v[20:23], v[64:67], v[80:83], v[20:23]
  v_exp_f32 v101, v113
  v_exp_f32 v102, v114
  v_exp_f32 v103, v115
  v_cvt_pk_bf16_f32 v84, v100, v101
  v_cvt_pk_bf16_f32 v85, v102, v103
  v_cndmask_b32 v48, v84, 0, s[16:17]
  v_cndmask_b32 v49, v85, 0, s[16:17]
  v_cndmask_b32 v50, 0, v84, s[16:17]
  v_cndmask_b32 v51, 0, v85, s[16:17]
  v_exp_f32 v100, v20
  v_mfma_f32_16x16x16_bf16 v[88:91], v[12:13], v[48:49], 0
  v_exp_f32 v101, v21
  v_mfma_f32_16x16x16_bf16 v[24:27], v[120:121], v[48:49], 0
  v_exp_f32 v102, v22
  v_mfma_f32_16x16x16_bf16 v[116:119], v[120:121], v[50:51], 0
  v_exp_f32 v103, v23
  v_cvt_pk_bf16_f32 v46, v100, v101
  v_cvt_pk_bf16_f32 v47, v102, v103
  v_mov_b64 v[38:39], 0
  s_nop 0
  v_mfma_f32_16x16x32_bf16 v[88:91], v[12:15], v[44:47], v[88:91]
  v_mov_b64 v[40:41], 0
  v_mov_b64 v[42:43], 0
  v_mfma_f32_16x16x32_bf16 v[24:27], v[28:31], v[44:47], v[24:27]
  ds_read_b128 v[52:55], v4 offset:24576
  ds_read_b128 v[56:59], v4 offset:25600
  v_mfma_f32_16x16x32_bf16 v[116:119], v[32:35], v[44:47], v[116:119]
  s_nop 1
  v_rcp_f32 v89, v88
  v_subrev_u32 v100, s54, v88
  v_cmp_le_u32 vcc, s55, v100
  v_mul_f32 v24, v89, v24
  v_mul_f32 v25, v89, v25
  s_cbranch_vccnz T_slow_49
T_back_50:
  v_cvt_pk_bf16_f32 v124, v24, v25
  v_pk_mul_f32 v[26:27], v[26:27], v[88:89] op_sel:[0,1] op_sel_hi:[1,1]
  v_pk_mul_f32 v[116:117], v[116:117], v[88:89] op_sel:[0,1] op_sel_hi:[1,1]
  v_pk_mul_f32 v[118:119], v[118:119], v[88:89] op_sel:[0,1] op_sel_hi:[1,1]
  v_cvt_pk_bf16_f32 v125, v26, v27
  v_cvt_pk_bf16_f32 v126, v116, v117
  v_cvt_pk_bf16_f32 v127, v118, v119
  ds_write_b128 v11, v[124:127] offset:30208
  s_nop 0
  v_smfmac_f32_16x16x64_bf16 v[92:95], v[124:127], a[160:167], v0
  v_smfmac_f32_16x16x64_bf16 v[96:99], v[124:127], a[168:175], v0
  v_smfmac_f32_16x16x64_bf16 v[36:39], v[124:127], a[176:183], v0
  v_smfmac_f32_16x16x64_bf16 v[40:43], v[124:127], a[184:191], v0
  s_waitcnt lgkmcnt(0)
  s_barrier
  ds_read_b128 v[104:107], v11 offset:30720
  ds_read_b128 v[108:111], v11 offset:29184
  ds_read_b128 v[68:71], v11 offset:29696
  s_waitcnt lgkmcnt(2)
  v_smfmac_f32_16x16x64_bf16 v[92:95], v[104:107], a[192:199], v0
  s_waitcnt lgkmcnt(1)
  ds_read_b128 v[76:79], v4 offset:28672
  v_smfmac_f32_16x16x64_bf16 v[92:95], v[108:111], a[224:231], v0
  s_waitcnt lgkmcnt(1)
  ds_read_b128 v[80:83], v4 offset:29696
  v_smfmac_f32_16x16x64_bf16 v[92:95], v[68:71], a[240:247], v0
  ds_read_b128 v[60:63], v4 offset:26624
  v_smfmac_f32_16x16x64_bf16 v[96:99], v[104:107], a[200:207], v0
  ds_read_b128 v[64:67], v4 offset:27648
  v_smfmac_f32_16x16x64_bf16 v[96:99], v[108:111], a[232:239], v0
  ds_read_b128 v[28:31], v4 offset:30720
  s_nop 0
  v_cvt_pk_bf16_f32 v16, v92, v93
  v_cvt_pk_bf16_f32 v17, v94, v95
  v_bfi_b32 v16, 1, s57, v16
  v_smfmac_f32_16x16x64_bf16 v[96:99], v[68:71], a[248:255], v0
  buffer_store_dwordx2 v[16:17], v7, s[4:7], s20 offen offset:0
  v_smfmac_f32_16x16x64_bf16 v[36:39], v[104:107], a[208:215], v0
  ds_read_b128 v[32:35], v4 offset:31744
  v_smfmac_f32_16x16x64_bf16 v[36:39], v[108:111], v[52:59], v0
  s_waitcnt lgkmcnt(4)
  s_nop 0
  v_cvt_pk_bf16_f32 v18, v96, v97
  v_cvt_pk_bf16_f32 v19, v98, v99
  v_bfi_b32 v18, 1, s57, v18
  v_smfmac_f32_16x16x64_bf16 v[36:39], v[68:71], v[76:83], v0
  buffer_store_dwordx2 v[18:19], v7, s[4:7], s20 offen offset:64
  v_smfmac_f32_16x16x64_bf16 v[40:43], v[104:107], a[216:223], v0
  s_waitcnt lgkmcnt(2)
  v_smfmac_f32_16x16x64_bf16 v[40:43], v[108:111], v[60:67], v0
  s_waitcnt lgkmcnt(0)
  s_nop 0
  v_cvt_pk_bf16_f32 v20, v36, v37
  v_cvt_pk_bf16_f32 v21, v38, v39
  v_bfi_b32 v20, 1, s57, v20
  v_smfmac_f32_16x16x64_bf16 v[40:43], v[68:71], v[28:35], v0
  buffer_store_dwordx2 v[20:21], v7, s[4:7], s21 offen offset:0
  s_nop 6
  v_cvt_pk_bf16_f32 v22, v40, v41
  v_cvt_pk_bf16_f32 v23, v42, v43
  v_bfi_b32 v22, 1, s57, v22
  buffer_store_dwordx2 v[22:23], v7, s[4:7], s21 offen offset:64
  ds_read_b128 v[68:71], v4 offset:0
  ds_read_b128 v[72:75], v4 offset:1024
  ds_read_b128 v[76:79], v4 offset:4096
  ds_read_b128 v[80:83], v4 offset:5120
  ds_read_b128 v[84:87], v4 offset:8192
  ds_read_b128 v[88:91], v4 offset:9216
  ds_read_b128 v[92:95], v4 offset:2048
  ds_read_b128 v[96:99], v4 offset:3072
  ds_read_b128 v[100:103], v4 offset:6144
  ds_read_b128 v[104:107], v4 offset:7168
  ds_read_b128 v[108:111], v4 offset:10240
  ds_read_b128 v[112:115], v4 offset:11264
  v_mov_b64 v[16:17], 0
  v_mov_b64 v[18:19], 0
  v_mov_b64 v[20:21], 0
  v_mov_b64 v[22:23], 0
  v_mov_b64 v[24:25], 0
  v_mov_b64 v[26:27], 0
  ds_read_b64 v[44:45], v2 offset:32256
  s_waitcnt lgkmcnt(0)
  v_readfirstlane_b32 s38, v44
  v_readfirstlane_b32 s37, v45
  s_nop 0
  s_lshl_b32 s38, s38, 1
  s_lshl1_add_u32 s37, s37, 1
  s_min_u32 s38, s38, s37
  s_cmp_ge_u32 s38, 64
  s_cselect_b32 s38, 100, s38
  s_sub_u32 s38, s38, 1
  s_max_i32 s30, s30, s38
  s_waitcnt vmcnt(4)
  s_barrier
  ds_read_b128 v[28:31], v2 offset:18432
  ds_read_b128 v[32:35], v2 offset:22528
  ds_read_b128 v[36:39], v2 offset:8192
  ds_read_b128 v[40:43], v2 offset:9216
  ds_read_b128 v[44:47], v2 offset:10240
  ds_read_b128 v[48:51], v2 offset:11264
  buffer_load_dwordx4 v[124:127], v2, s[4:7], s24 offen offset:2048 sc1
  buffer_load_dwordx4 v[116:119], v2, s[4:7], s25 offen offset:2048 sc1
  ds_read_b128 v[52:55], v2 offset:12288
  ds_read_b128 v[56:59], v2 offset:13312
  ds_read_b128 v[60:63], v2 offset:14336
  ds_read_b128 v[64:67], v2 offset:15360
  buffer_load_dwordx4 v[124:127], v2, s[4:7], s24 offen offset:2048 sc1
  buffer_load_dwordx4 v[116:119], v2, s[4:7], s25 offen offset:2048 sc1
  s_mov_b32 s19, 0
  s_branch T_loop_42
T_kvw_46:
  s_mov_b32 s19, 0
  s_branch T_kvok_55
T_kv_54:
  s_sleep 4
  s_add_u32 s19, s19, 1
  s_cmp_gt_u32 s19, 32768
  s_cbranch_scc1 M_exit
T_kvok_55:
  s_add_u32 s39, s99, 128
  s_mov_b32 s38, 0
  s_mov_b32 s37, 0
  s_atomic_or s38, s[58:59], s99 glc
  s_atomic_or s37, s[58:59], s39 glc
  s_waitcnt lgkmcnt(0)
  s_lshl_b32 s38, s38, 1
  s_lshl1_add_u32 s37, s37, 1
  s_min_u32 s38, s38, s37
  s_cmp_ge_u32 s38, 64
  s_cselect_b32 s38, 100, s38
  s_sub_u32 s38, s38, 1
  s_max_i32 s30, s30, s38
  s_cmp_ge_i32 s14, s30
  s_cbranch_scc1 T_kv_54
  s_branch T_kvb_47
T_slow_49:
  s_nop 7
  v_max3_f32 v100, v16, v17, v18
  v_max3_f32 v100, v100, v19, v20
  v_max3_f32 v100, v100, v21, v22
  v_max3_f32 v100, v100, v23, v112
  v_max3_f32 v100, v100, v113, v114
  v_max_f32 v100, v100, v115
  v_mov_b32 v101, v100
  s_nop 1
  v_permlane32_swap_b32 v100, v101
  s_nop 1
  v_max_f32 v100, v100, v101
  v_mov_b32 v101, v100
  s_nop 1
  v_permlane16_swap_b32 v100, v101
  s_nop 1
  v_max_f32 v100, v100, v101
  v_sub_f32 v16, v16, v100
  v_sub_f32 v17, v17, v100
  v_sub_f32 v18, v18, v100
  v_sub_f32 v19, v19, v100
  v_exp_f32 v16, v16
  v_exp_f32 v17, v17
  v_exp_f32 v18, v18
  v_exp_f32 v19, v19
  v_sub_f32 v20, v20, v100
  v_sub_f32 v21, v21, v100
  v_sub_f32 v22, v22, v100
  v_sub_f32 v23, v23, v100
  v_exp_f32 v20, v20
  v_exp_f32 v21, v21
  v_exp_f32 v22, v22
  v_exp_f32 v23, v23
  v_sub_f32 v112, v112, v100
  v_sub_f32 v113, v113, v100
  v_sub_f32 v114, v114, v100
  v_sub_f32 v115, v115, v100
  v_exp_f32 v112, v112
  v_exp_f32 v113, v113
  v_exp_f32 v114, v114
  v_exp_f32 v115, v115
  s_nop 0
  v_cvt_pk_bf16_f32 v44, v16, v17
  v_cvt_pk_bf16_f32 v45, v18, v19
  v_cvt_pk_bf16_f32 v46, v20, v21
  v_cvt_pk_bf16_f32 v47, v22, v23
  v_cvt_pk_bf16_f32 v84, v112, v113
  v_cvt_pk_bf16_f32 v85, v114, v115
  v_cndmask_b32 v48, v84, 0, s[16:17]
  v_cndmask_b32 v49, v85, 0, s[16:17]
  v_cndmask_b32 v50, 0, v84, s[16:17]
  v_cndmask_b32 v51, 0, v85, s[16:17]
  s_nop 1
  v_mfma_f32_16x16x16_bf16 v[88:91], v[12:13], v[48:49], 0
  v_mfma_f32_16x16x16_bf16 v[24:27], v[120:121], v[48:49], 0
  v_mfma_f32_16x16x16_bf16 v[116:119], v[120:121], v[50:51], 0
  v_mfma_f32_16x16x32_bf16 v[88:91], v[12:15], v[44:47], v[88:91]
  v_mfma_f32_16x16x32_bf16 v[24:27], v[28:31], v[44:47], v[24:27]
  v_mfma_f32_16x16x32_bf16 v[116:119], v[32:35], v[44:47], v[116:119]
  s_nop 7
  s_nop 1
  v_rcp_f32 v89, v88
  s_nop 0
  v_mul_f32 v24, v89, v24
  v_mul_f32 v25, v89, v25
  s_branch T_back_50
T_w_13:
  s_mov_b32 s19, 0
  v_mov_b64 v[16:17], 0
  v_mov_b64 v[18:19], 0
  v_mov_b64 v[20:21], 0
  v_mov_b64 v[22:23], 0
  v_mov_b64 v[24:25], 0
  v_mov_b64 v[26:27], 0
  buffer_load_dwordx4 v[124:127], v2, s[4:7], s24 offen offset:3072 sc1
  buffer_load_dwordx4 v[116:119], v2, s[4:7], s25 offen offset:3072 sc1
  buffer_load_dwordx4 v[124:127], v2, s[4:7], s24 offen offset:3072 sc1
  buffer_load_dwordx4 v[116:119], v2, s[4:7], s25 offen offset:3072 sc1
  s_branch T_loop_56
.p2align 6
T_retry_57:
  s_mov_b64 exec, vcc
  buffer_load_dwordx4 v[124:127], v2, s[4:7], s24 offen offset:3072 sc1
  buffer_load_dwordx4 v[116:119], v2, s[4:7], s25 offen offset:3072 sc1
  s_mov_b64 exec, -1
  s_add_u32 s19, s19, 1
  s_cmp_gt_u32 s19, 32768
  s_cbranch_scc1 M_exit
T_loop_56:
  s_waitcnt vmcnt(3) lgkmcnt(0)
  v_max3_u32 v123, v124, v125, v126
  v_max_u32 v123, v123, v127
  v_mov_b32_dpp v120, v124 row_ror:8 row_mask:0xf bank_mask:0xf
  v_mov_b32_dpp v121, v125 row_ror:8 row_mask:0xf bank_mask:0xf
  s_waitcnt vmcnt(2)
  v_max3_u32 v123, v123, v116, v117
  v_max3_u32 v123, v123, v118, v119
  v_cmp_eq_u32 vcc, -1, v123
  s_cbranch_vccnz T_retry_57
  v_smfmac_f32_16x16x64_bf16 v[16:19], v[124:127], v[68:75], v0
  s_add_u32 s14, s14, 1
  ds_write_b128 v2, v[124:127] offset:3072
  v_mov_b32_dpp v122, v126 row_ror:8 row_mask:0xf bank_mask:0xf
  v_smfmac_f32_16x16x64_bf16 v[20:23], v[124:127], v[76:83], v0
  s_and_b32 s57, s14, 1
  v_mov_b32_dpp v123, v127 row_ror:8 row_mask:0xf bank_mask:0xf
  v_smfmac_f32_16x16x64_bf16 v[24:27], v[124:127], v[84:91], v0
  s_and_b32 s36, s14, 3
  ds_write_b128 v2, v[116:119] offset:7168
  v_smfmac_f32_16x16x64_bf16 v[16:19], v[120:123], v[92:99], v0
  s_lshl_b32 s36, s36, 13
  v_mov_b32_dpp v84, v116 row_ror:8 row_mask:0xf bank_mask:0xf
  v_smfmac_f32_16x16x64_bf16 v[20:23], v[120:123], v[100:107], v0
  s_add_u32 s26, s36, s23
  ds_read_b128 v[68:71], v4 offset:12288
  v_mov_b32_dpp v85, v117 row_ror:8 row_mask:0xf bank_mask:0xf
  v_smfmac_f32_16x16x64_bf16 v[24:27], v[120:123], v[108:115], v0
  s_add_u32 s36, s36, 8192
  ds_read_b128 v[72:75], v4 offset:13312
  v_mov_b32_dpp v86, v118 row_ror:8 row_mask:0xf bank_mask:0xf
  v_smfmac_f32_16x16x64_bf16 v[16:19], v[116:119], v[224:231], v0
  s_and_b32 s36, s36, 0x7fff
  ds_read_b128 v[76:79], v4 offset:14336
  v_mov_b32_dpp v87, v119 row_ror:8 row_mask:0xf bank_mask:0xf
  v_smfmac_f32_16x16x64_bf16 v[20:23], v[116:119], v[240:247], v0
  s_waitcnt lgkmcnt(3)
  s_barrier
  ds_read_b128 v[100:103], v2 offset:2048
  v_smfmac_f32_16x16x64_bf16 v[24:27], v[116:119], a[0:7], v0
  s_mov_b32 m0, s31
  ds_read_b128 v[120:123], v1 offset:2048
  v_smfmac_f32_16x16x64_bf16 v[16:19], v[84:87], v[232:239], v0
  s_cmp_ge_i32 s14, s30
  s_cbranch_scc1 T_kvw_60
T_kvb_61:
  v_smfmac_f32_16x16x64_bf16 v[20:23], v[84:87], v[248:255], v0
  ds_read_b128 v[80:83], v4 offset:15360
  v_smfmac_f32_16x16x64_bf16 v[24:27], v[84:87], a[8:15], v0
  s_waitcnt lgkmcnt(2)
  v_smfmac_f32_16x16x64_bf16 v[16:19], v[100:103], v[128:135], v0
  ds_read_b128 v[92:95], v2 offset:1024
  v_smfmac_f32_16x16x64_bf16 v[20:23], v[100:103], v[144:151], v0
  ds_read_b128 v[96:99], v1 offset:1024
  buffer_load_dwordx4 v9, s[4:7], s27 offen sc1 lds
  v_smfmac_f32_16x16x64_bf16 v[24:27], v[100:103], v[68:75], v0
  s_waitcnt vmcnt(1) lgkmcnt(3)
  ds_read_b128 v[116:119], v2 offset:0
  s_mov_b32 m0, s32
  v_smfmac_f32_16x16x64_bf16 v[16:19], v[120:123], v[136:143], v0
  ds_read_b128 v[124:127], v1 offset:0
  v_smfmac_f32_16x16x64_bf16 v[20:23], v[120:123], v[152:159], v0
  s_waitcnt lgkmcnt(4)
  ds_read_b128 v[104:107], v2 offset:6144
  v_smfmac_f32_16x16x64_bf16 v[24:27], v[120:123], v[76:83], v0
  s_waitcnt lgkmcnt(4)
  ds_read_b128 v[108:111], v1 offset:6144
  buffer_load_dwordx4 v9, s[4:7], s27 offen offset:128 sc1 lds
  v_smfmac_f32_16x16x64_bf16 v[16:19], v[92:95], v[160:167], v0
  s_waitcnt lgkmcnt(4)
  ds_read_b128 v[112:115], v2 offset:5120
  s_mov_b32 m0, s33
  v_smfmac_f32_16x16x64_bf16 v[16:19], v[96:99], v[168:175], v0
  s_waitcnt lgkmcnt(4)
  ds_read_b128 v[84:87], v1 offset:5120
  v_smfmac_f32_16x16x64_bf16 v[16:19], v[116:119], v[192:199], v0
  s_waitcnt lgkmcnt(4)
  ds_read_b128 v[88:91], v2 offset:4096
  v_smfmac_f32_16x16x64_bf16 v[16:19], v[124:127], v[200:207], v0
  s_waitcnt lgkmcnt(4)
  ds_read_b128 v[100:103], v1 offset:4096
  buffer_load_dwordx4 v10, s[4:7], s28 offen sc1 lds
  v_smfmac_f32_16x16x64_bf16 v[16:19], v[104:107], a[16:23], v0
  s_waitcnt lgkmcnt(4)
  ds_read_b128 v[68:71], v4 offset:16384
  s_mov_b32 m0, s34
  v_smfmac_f32_16x16x64_bf16 v[16:19], v[108:111], a[24:31], v0
  s_waitcnt lgkmcnt(4)
  ds_read_b128 v[72:75], v4 offset:17408
  v_smfmac_f32_16x16x64_bf16 v[16:19], v[112:115], a[64:71], v0
  s_waitcnt lgkmcnt(4)
  ds_read_b128 v[76:79], v4 offset:18432
  v_smfmac_f32_16x16x64_bf16 v[16:19], v[84:87], a[72:79], v0
  s_waitcnt lgkmcnt(4)
  ds_read_b128 v[80:83], v4 offset:19456
  buffer_load_dwordx4 v10, s[4:7], s28 offen offset:256 sc1 lds
  v_smfmac_f32_16x16x64_bf16 v[16:19], v[88:91], a[112:119], v0
  s_waitcnt lgkmcnt(4)
  s_mov_b32 m0, 32256
  v_smfmac_f32_16x16x64_bf16 v[16:19], v[100:103], a[120:127], v0
  s_add_u32 s24, s36, 145752064
  s_add_u32 s25, s36, 145756160
  v_smfmac_f32_16x16x64_bf16 v[20:23], v[92:95], v[176:183], v0
  s_add_u32 s35, s36, s23
  v_smfmac_f32_16x16x64_bf16 v[20:23], v[96:99], v[184:191], v0
  s_waitcnt lgkmcnt(2)
  buffer_load_dword v3, s[4:7], s99 offen sc1 lds
  v_smfmac_f32_16x16x64_bf16 v[20:23], v[116:119], v[68:75], v0
  s_waitcnt lgkmcnt(0)
  ds_read_b128 v[68:71], v4 offset:20480
  v_mul_f32 v16, s18, v16
  v_smfmac_f32_16x16x64_bf16 v[20:23], v[124:127], v[76:83], v0
  ds_read_b128 v[72:75], v4 offset:21504
  v_mul_f32 v17, s18, v17
  v_smfmac_f32_16x16x64_bf16 v[20:23], v[104:107], a[32:39], v0
  ds_read_b128 v[76:79], v4 offset:22528
  v_mul_f32 v18, s18, v18
  v_smfmac_f32_16x16x64_bf16 v[20:23], v[108:111], a[40:47], v0
  ds_read_b128 v[80:83], v4 offset:23552
  v_mul_f32 v19, s18, v19
  v_smfmac_f32_16x16x64_bf16 v[20:23], v[112:115], a[80:87], v0
  v_cvt_pk_bf16_f32 v120, v16, v17
  v_smfmac_f32_16x16x64_bf16 v[20:23], v[84:87], a[88:95], v0
  v_cvt_pk_bf16_f32 v121, v18, v19
  v_smfmac_f32_16x16x64_bf16 v[20:23], v[88:91], a[128:135], v0
  ds_write_b64 v5, v[120:121] offset:24576
  v_smfmac_f32_16x16x64_bf16 v[20:23], v[100:103], a[136:143], v0
  s_waitcnt lgkmcnt(3)
  v_smfmac_f32_16x16x64_bf16 v[24:27], v[92:95], v[68:75], v0
  s_waitcnt lgkmcnt(1)
  v_mov_b64 v[92:93], 0
  v_smfmac_f32_16x16x64_bf16 v[24:27], v[96:99], v[76:83], v0
  s_nop 1
  v_cvt_pk_bf16_f32 v122, v20, v21
  v_cvt_pk_bf16_f32 v123, v22, v23
  v_smfmac_f32_16x16x64_bf16 v[24:27], v[116:119], v[208:215], v0
  ds_write_b64 v5, v[122:123] offset:26880
  v_mov_b64 v[94:95], 0
  v_smfmac_f32_16x16x64_bf16 v[24:27], v[124:127], v[216:223], v0
  s_waitcnt lgkmcnt(1)
  s_barrier
  ds_read_b64_tr_b16 v[68:69], v6 offset:24576
  v_smfmac_f32_16x16x64_bf16 v[24:27], v[104:107], a[48:55], v0
  s_add_u32 s27, s27, 8192
  ds_read_b64_tr_b16 v[70:71], v6 offset:24640
  ds_read_b64_tr_b16 v[72:73], v6 offset:24832
  v_smfmac_f32_16x16x64_bf16 v[24:27], v[108:111], a[56:63], v0
  s_add_u32 s28, s28, 8192
  ds_read_b64_tr_b16 v[74:75], v6 offset:24896
  ds_read_b64_tr_b16 v[76:77], v6 offset:25088
  v_smfmac_f32_16x16x64_bf16 v[24:27], v[112:115], a[96:103], v0
  s_nop 0
  ds_read_b64_tr_b16 v[78:79], v6 offset:25152
  ds_read_b64_tr_b16 v[80:81], v6 offset:25344
  v_smfmac_f32_16x16x64_bf16 v[24:27], v[84:87], a[104:111], v0
  ds_read_b64_tr_b16 v[82:83], v6 offset:25408
  v_mov_b64 v[96:97], 0
  v_smfmac_f32_16x16x64_bf16 v[24:27], v[88:91], a[144:151], v0
  s_waitcnt lgkmcnt(8)
  s_barrier
  ds_read_b64_tr_b16 v[116:117], v6 offset:26880
  v_smfmac_f32_16x16x64_bf16 v[24:27], v[100:103], a[152:159], v0
  s_waitcnt lgkmcnt(7)
  ds_read_b64_tr_b16 v[118:119], v6 offset:26944
  v_mfma_f32_16x16x32_bf16 v[16:19], v[36:39], v[68:71], 0
  s_waitcnt lgkmcnt(6)
  ds_read_b64_tr_b16 v[124:125], v6 offset:27136
  ds_read_b64_tr_b16 v[126:127], v6 offset:27200
  v_mfma_f32_16x16x32_bf16 v[16:19], v[40:43], v[72:75], v[16:19]
  s_waitcnt lgkmcnt(6)
  ds_read_b64_tr_b16 v[104:105], v6 offset:27392
  ds_read_b64_tr_b16 v[106:107], v6 offset:27456
  v_mfma_f32_16x16x32_bf16 v[16:19], v[44:47], v[76:79], v[16:19]
  s_waitcnt lgkmcnt(6)
  ds_read_b64_tr_b16 v[108:109], v6 offset:27648
  ds_read_b64_tr_b16 v[110:111], v6 offset:27712
  v_mfma_f32_16x16x32_bf16 v[16:19], v[48:51], v[80:83], v[16:19]
  s_waitcnt lgkmcnt(6)
  v_cvt_pk_bf16_f32 v120, v24, v25
  v_cvt_pk_bf16_f32 v121, v26, v27
  v_mfma_f32_16x16x32_bf16 v[112:115], v[116:119], v[68:71], 0
  s_waitcnt lgkmcnt(4)
  v_mov_b64 v[98:99], 0
  v_mfma_f32_16x16x32_bf16 v[112:115], v[124:127], v[72:75], v[112:115]
  s_waitcnt lgkmcnt(2)
  v_mov_b64 v[36:37], 0
  v_exp_f32 v100, v16
  v_mfma_f32_16x16x32_bf16 v[112:115], v[104:107], v[76:79], v[112:115]
  s_waitcnt lgkmcnt(0)
  v_exp_f32 v101, v17
  v_mfma_f32_16x16x32_bf16 v[112:115], v[108:111], v[80:83], v[112:115]
  buffer_store_dwordx4 v[120:123], v2, s[4:7], s29 offen offset:3072 sc1
  v_exp_f32 v102, v18
  v_mfma_f32_16x16x32_bf16 v[20:23], v[52:55], v[68:71], 0
  s_cmp_eq_u32 s14, 63
  v_exp_f32 v103, v19
  v_mfma_f32_16x16x32_bf16 v[20:23], v[56:59], v[72:75], v[20:23]
  s_cbranch_scc1 M_tdone
  v_cvt_pk_bf16_f32 v44, v100, v101
  v_cvt_pk_bf16_f32 v45, v102, v103
  v_mfma_f32_16x16x32_bf16 v[20:23], v[60:63], v[76:79], v[20:23]
  s_add_u32 s29, s29, 131072
  v_exp_f32 v100, v112
  v_mfma_f32_16x16x32_bf16 v[20:23], v[64:67], v[80:83], v[20:23]
  v_exp_f32 v101, v113
  v_exp_f32 v102, v114
  v_exp_f32 v103, v115
  v_cvt_pk_bf16_f32 v84, v100, v101
  v_cvt_pk_bf16_f32 v85, v102, v103
  v_cndmask_b32 v48, v84, 0, s[16:17]
  v_cndmask_b32 v49, v85, 0, s[16:17]
  v_cndmask_b32 v50, 0, v84, s[16:17]
  v_cndmask_b32 v51, 0, v85, s[16:17]
  v_exp_f32 v100, v20
  v_mfma_f32_16x16x16_bf16 v[88:91], v[12:13], v[48:49], 0
  v_exp_f32 v101, v21
  v_mfma_f32_16x16x16_bf16 v[24:27], v[120:121], v[48:49], 0
  v_exp_f32 v102, v22
  v_mfma_f32_16x16x16_bf16 v[116:119], v[120:121], v[50:51], 0
  v_exp_f32 v103, v23
  v_cvt_pk_bf16_f32 v46, v100, v101
  v_cvt_pk_bf16_f32 v47, v102, v103
  v_mov_b64 v[38:39], 0
  s_nop 0
  v_mfma_f32_16x16x32_bf16 v[88:91], v[12:15], v[44:47], v[88:91]
  v_mov_b64 v[40:41], 0
  v_mov_b64 v[42:43], 0
  v_mfma_f32_16x16x32_bf16 v[24:27], v[28:31], v[44:47], v[24:27]
  ds_read_b128 v[52:55], v4 offset:24576
  ds_read_b128 v[56:59], v4 offset:25600
  v_mfma_f32_16x16x32_bf16 v[116:119], v[32:35], v[44:47], v[116:119]
  s_nop 1
  v_rcp_f32 v89, v88
  v_subrev_u32 v100, s54, v88
  v_cmp_le_u32 vcc, s55, v100
  v_mul_f32 v24, v89, v24
  v_mul_f32 v25, v89, v25
  s_cbranch_vccnz T_slow_63
T_back_64:
  v_cvt_pk_bf16_f32 v124, v24, v25
  v_pk_mul_f32 v[26:27], v[26:27], v[88:89] op_sel:[0,1] op_sel_hi:[1,1]
  v_pk_mul_f32 v[116:117], v[116:117], v[88:89] op_sel:[0,1] op_sel_hi:[1,1]
  v_pk_mul_f32 v[118:119], v[118:119], v[88:89] op_sel:[0,1] op_sel_hi:[1,1]
  v_cvt_pk_bf16_f32 v125, v26, v27
  v_cvt_pk_bf16_f32 v126, v116, v117
  v_cvt_pk_bf16_f32 v127, v118, v119
  ds_write_b128 v11, v[124:127] offset:30720
  s_nop 0
  v_smfmac_f32_16x16x64_bf16 v[92:95], v[124:127], a[160:167], v0
  v_smfmac_f32_16x16x64_bf16 v[96:99], v[124:127], a[168:175], v0
  v_smfmac_f32_16x16x64_bf16 v[36:39], v[124:127], a[176:183], v0
  v_smfmac_f32_16x16x64_bf16 v[40:43], v[124:127], a[184:191], v0
  s_waitcnt lgkmcnt(0)
  s_barrier
  ds_read_b128 v[104:107], v11 offset:30208
  ds_read_b128 v[108:111], v11 offset:29696
  ds_read_b128 v[68:71], v11 offset:29184
  s_waitcnt lgkmcnt(2)
  v_smfmac_f32_16x16x64_bf16 v[92:95], v[104:107], a[192:199], v0
  s_waitcnt lgkmcnt(1)
  ds_read_b128 v[76:79], v4 offset:28672
  v_smfmac_f32_16x16x64_bf16 v[92:95], v[108:111], a[224:231], v0
  s_waitcnt lgkmcnt(1)
  ds_read_b128 v[80:83], v4 offset:29696
  v_smfmac_f32_16x16x64_bf16 v[92:95], v[68:71], a[240:247], v0
  ds_read_b128 v[60:63], v4 offset:26624
  v_smfmac_f32_16x16x64_bf16 v[96:99], v[104:107], a[200:207], v0
  ds_read_b128 v[64:67], v4 offset:27648
  v_smfmac_f32_16x16x64_bf16 v[96:99], v[108:111], a[232:239], v0
  ds_read_b128 v[28:31], v4 offset:30720
  s_nop 0
  v_cvt_pk_bf16_f32 v16, v92, v93
  v_cvt_pk_bf16_f32 v17, v94, v95
  v_bfi_b32 v16, 1, s57, v16
  v_smfmac_f32_16x16x64_bf16 v[96:99], v[68:71], a[248:255], v0
  buffer_store_dwordx2 v[16:17], v7, s[4:7], s20 offen offset:0
  v_smfmac_f32_16x16x64_bf16 v[36:39], v[104:107], a[208:215], v0
  ds_read_b128 v[32:35], v4 offset:31744
  v_smfmac_f32_16x16x64_bf16 v[36:39], v[108:111], v[52:59], v0
  s_waitcnt lgkmcnt(4)
  s_nop 0
  v_cvt_pk_bf16_f32 v18, v96, v97
  v_cvt_pk_bf16_f32 v19, v98, v99
  v_bfi_b32 v18, 1, s57, v18
  v_smfmac_f32_16x16x64_bf16 v[36:39], v[68:71], v[76:83], v0
  buffer_store_dwordx2 v[18:19], v7, s[4:7], s20 offen offset:64
  v_smfmac_f32_16x16x64_bf16 v[40:43], v[104:107], a[216:223], v0
  s_waitcnt lgkmcnt(2)
  v_smfmac_f32_16x16x64_bf16 v[40:43], v[108:111], v[60:67], v0
  s_waitcnt lgkmcnt(0)
  s_nop 0
  v_cvt_pk_bf16_f32 v20, v36, v37
  v_cvt_pk_bf16_f32 v21, v38, v39
  v_bfi_b32 v20, 1, s57, v20
  v_smfmac_f32_16x16x64_bf16 v[40:43], v[68:71], v[28:35], v0
  buffer_store_dwordx2 v[20:21], v7, s[4:7], s21 offen offset:0
  s_nop 6
  v_cvt_pk_bf16_f32 v22, v40, v41
  v_cvt_pk_bf16_f32 v23, v42, v43
  v_bfi_b32 v22, 1, s57, v22
  buffer_store_dwordx2 v[22:23], v7, s[4:7], s21 offen offset:64
  ds_read_b128 v[68:71], v4 offset:0
  ds_read_b128 v[72:75], v4 offset:1024
  ds_read_b128 v[76:79], v4 offset:4096
  ds_read_b128 v[80:83], v4 offset:5120
  ds_read_b128 v[84:87], v4 offset:8192
  ds_read_b128 v[88:91], v4 offset:9216
  ds_read_b128 v[92:95], v4 offset:2048
  ds_read_b128 v[96:99], v4 offset:3072
  ds_read_b128 v[100:103], v4 offset:6144
  ds_read_b128 v[104:107], v4 offset:7168
  ds_read_b128 v[108:111], v4 offset:10240
  ds_read_b128 v[112:115], v4 offset:11264
  v_mov_b64 v[16:17], 0
  v_mov_b64 v[18:19], 0
  v_mov_b64 v[20:21], 0
  v_mov_b64 v[22:23], 0
  v_mov_b64 v[24:25], 0
  v_mov_b64 v[26:27], 0
  ds_read_b64 v[44:45], v2 offset:32256
  s_waitcnt lgkmcnt(0)
  v_readfirstlane_b32 s38, v44
  v_readfirstlane_b32 s37, v45
  s_nop 0
  s_lshl_b32 s38, s38, 1
  s_lshl1_add_u32 s37, s37, 1
  s_min_u32 s38, s38, s37
  s_cmp_ge_u32 s38, 64
  s_cselect_b32 s38, 100, s38
  s_sub_u32 s38, s38, 1
  s_max_i32 s30, s30, s38
  s_waitcnt vmcnt(4)
  s_barrier
  ds_read_b128 v[28:31], v2 offset:19456
  ds_read_b128 v[32:35], v2 offset:23552
  ds_read_b128 v[36:39], v2 offset:8192
  ds_read_b128 v[40:43], v2 offset:9216
  ds_read_b128 v[44:47], v2 offset:10240
  ds_read_b128 v[48:51], v2 offset:11264
  buffer_load_dwordx4 v[124:127], v2, s[4:7], s24 offen offset:3072 sc1
  buffer_load_dwordx4 v[116:119], v2, s[4:7], s25 offen offset:3072 sc1
  ds_read_b128 v[52:55], v2 offset:12288
  ds_read_b128 v[56:59], v2 offset:13312
  ds_read_b128 v[60:63], v2 offset:14336
  ds_read_b128 v[64:67], v2 offset:15360
  buffer_load_dwordx4 v[124:127], v2, s[4:7], s24 offen offset:3072 sc1
  buffer_load_dwordx4 v[116:119], v2, s[4:7], s25 offen offset:3072 sc1
  s_mov_b32 s19, 0
  s_branch T_loop_56
T_kvw_60:
  s_mov_b32 s19, 0
  s_branch T_kvok_69
T_kv_68:
  s_sleep 4
  s_add_u32 s19, s19, 1
  s_cmp_gt_u32 s19, 32768
  s_cbranch_scc1 M_exit
T_kvok_69:
  s_add_u32 s39, s99, 128
  s_mov_b32 s38, 0
  s_mov_b32 s37, 0
  s_atomic_or s38, s[58:59], s99 glc
  s_atomic_or s37, s[58:59], s39 glc
  s_waitcnt lgkmcnt(0)
  s_lshl_b32 s38, s38, 1
  s_lshl1_add_u32 s37, s37, 1
  s_min_u32 s38, s38, s37
  s_cmp_ge_u32 s38, 64
  s_cselect_b32 s38, 100, s38
  s_sub_u32 s38, s38, 1
  s_max_i32 s30, s30, s38
  s_cmp_ge_i32 s14, s30
  s_cbranch_scc1 T_kv_68
  s_branch T_kvb_61
T_slow_63:
  s_nop 7
  v_max3_f32 v100, v16, v17, v18
  v_max3_f32 v100, v100, v19, v20
  v_max3_f32 v100, v100, v21, v22
  v_max3_f32 v100, v100, v23, v112
  v_max3_f32 v100, v100, v113, v114
  v_max_f32 v100, v100, v115
  v_mov_b32 v101, v100
  s_nop 1
  v_permlane32_swap_b32 v100, v101
  s_nop 1
  v_max_f32 v100, v100, v101
  v_mov_b32 v101, v100
  s_nop 1
  v_permlane16_swap_b32 v100, v101
  s_nop 1
  v_max_f32 v100, v100, v101
  v_sub_f32 v16, v16, v100
  v_sub_f32 v17, v17, v100
  v_sub_f32 v18, v18, v100
  v_sub_f32 v19, v19, v100
  v_exp_f32 v16, v16
  v_exp_f32 v17, v17
  v_exp_f32 v18, v18
  v_exp_f32 v19, v19
  v_sub_f32 v20, v20, v100
  v_sub_f32 v21, v21, v100
  v_sub_f32 v22, v22, v100
  v_sub_f32 v23, v23, v100
  v_exp_f32 v20, v20
  v_exp_f32 v21, v21
  v_exp_f32 v22, v22
  v_exp_f32 v23, v23
  v_sub_f32 v112, v112, v100
  v_sub_f32 v113, v113, v100
  v_sub_f32 v114, v114, v100
  v_sub_f32 v115, v115, v100
  v_exp_f32 v112, v112
  v_exp_f32 v113, v113
  v_exp_f32 v114, v114
  v_exp_f32 v115, v115
  s_nop 0
  v_cvt_pk_bf16_f32 v44, v16, v17
  v_cvt_pk_bf16_f32 v45, v18, v19
  v_cvt_pk_bf16_f32 v46, v20, v21
  v_cvt_pk_bf16_f32 v47, v22, v23
  v_cvt_pk_bf16_f32 v84, v112, v113
  v_cvt_pk_bf16_f32 v85, v114, v115
  v_cndmask_b32 v48, v84, 0, s[16:17]
  v_cndmask_b32 v49, v85, 0, s[16:17]
  v_cndmask_b32 v50, 0, v84, s[16:17]
  v_cndmask_b32 v51, 0, v85, s[16:17]
  s_nop 1
  v_mfma_f32_16x16x16_bf16 v[88:91], v[12:13], v[48:49], 0
  v_mfma_f32_16x16x16_bf16 v[24:27], v[120:121], v[48:49], 0
  v_mfma_f32_16x16x16_bf16 v[116:119], v[120:121], v[50:51], 0
  v_mfma_f32_16x16x32_bf16 v[88:91], v[12:15], v[44:47], v[88:91]
  v_mfma_f32_16x16x32_bf16 v[24:27], v[28:31], v[44:47], v[24:27]
  v_mfma_f32_16x16x32_bf16 v[116:119], v[32:35], v[44:47], v[116:119]
  s_nop 7
  s_nop 1
  v_rcp_f32 v89, v88
  s_nop 0
  v_mul_f32 v24, v89, v24
  v_mul_f32 v25, v89, v25
  s_branch T_back_64
M_global:
  s_cmp_eq_u32 s13, 1
  s_cbranch_scc1 T_w_71
  s_cmp_eq_u32 s13, 2
  s_cbranch_scc1 T_w_72
  s_cmp_eq_u32 s13, 3
  s_cbranch_scc1 T_w_73
T_w_70:
  s_mov_b32 s19, 0
  v_mov_b64 v[16:17], 0
  v_mov_b64 v[18:19], 0
  v_mov_b64 v[20:21], 0
  v_mov_b64 v[22:23], 0
  v_mov_b64 v[24:25], 0
  v_mov_b64 v[26:27], 0
  buffer_load_dwordx4 v[124:127], v2, s[4:7], s24 offen offset:0 sc1
  buffer_load_dwordx4 v[116:119], v2, s[4:7], s25 offen offset:0 sc1
  buffer_load_dwordx4 v[124:127], v2, s[4:7], s24 offen offset:0 sc1
  buffer_load_dwordx4 v[116:119], v2, s[4:7], s25 offen offset:0 sc1
  s_branch T_loop_74
.p2align 6
T_retry_75:
  s_mov_b64 exec, vcc
  buffer_load_dwordx4 v[124:127], v2, s[4:7], s24 offen offset:0 sc1
  buffer_load_dwordx4 v[116:119], v2, s[4:7], s25 offen offset:0 sc1
  s_mov_b64 exec, -1
  s_add_u32 s19, s19, 1
  s_cmp_gt_u32 s19, 32768
  s_cbranch_scc1 M_exit
T_loop_74:
  s_waitcnt vmcnt(3) lgkmcnt(0)
  v_max3_u32 v123, v124, v125, v126
  v_max_u32 v123, v123, v127
  v_mov_b32_dpp v120, v124 row_ror:8 row_mask:0xf bank_mask:0xf
  v_mov_b32_dpp v121, v125 row_ror:8 row_mask:0xf bank_mask:0xf
  s_waitcnt vmcnt(2)
  v_max3_u32 v123, v123, v116, v117
  v_max3_u32 v123, v123, v118, v119
  v_cmp_eq_u32 vcc, -1, v123
  s_cbranch_vccnz T_retry_75
  v_smfmac_f32_16x16x64_bf16 v[16:19], v[124:127], v[68:75], v0
  s_add_u32 s14, s14, 1
  ds_write_b128 v2, v[124:127] offset:0
  v_mov_b32_dpp v122, v126 row_ror:8 row_mask:0xf bank_mask:0xf
  v_smfmac_f32_16x16x64_bf16 v[20:23], v[124:127], v[76:83], v0
  s_and_b32 s57, s14, 1
  v_mov_b32_dpp v123, v127 row_ror:8 row_mask:0xf bank_mask:0xf
  v_smfmac_f32_16x16x64_bf16 v[24:27], v[124:127], v[84:91], v0
  s_and_b32 s36, s14, 3
  ds_write_b128 v2, v[116:119] offset:4096
  v_smfmac_f32_16x16x64_bf16 v[16:19], v[120:123], v[92:99], v0
  s_lshl_b32 s36, s36, 13
  v_mov_b32_dpp v84, v116 row_ror:8 row_mask:0xf bank_mask:0xf
  v_smfmac_f32_16x16x64_bf16 v[20:23], v[120:123], v[100:107], v0
  s_add_u32 s26, s36, s23
  ds_read_b128 v[68:71], v4 offset:12288
  v_mov_b32_dpp v85, v117 row_ror:8 row_mask:0xf bank_mask:0xf
  v_smfmac_f32_16x16x64_bf16 v[24:27], v[120:123], v[108:115], v0
  s_add_u32 s36, s36, 8192
  ds_read_b128 v[72:75], v4 offset:13312
  v_mov_b32_dpp v86, v118 row_ror:8 row_mask:0xf bank_mask:0xf
  v_smfmac_f32_16x16x64_bf16 v[16:19], v[116:119], v[224:231], v0
  s_and_b32 s36, s36, 0x7fff
  ds_read_b128 v[76:79], v4 offset:14336
  v_mov_b32_dpp v87, v119 row_ror:8 row_mask:0xf bank_mask:0xf
  v_smfmac_f32_16x16x64_bf16 v[20:23], v[116:119], v[240:247], v0
  s_waitcnt lgkmcnt(3)
  s_barrier
  ds_read_b128 v[100:103], v2 offset:1024
  v_smfmac_f32_16x16x64_bf16 v[24:27], v[116:119], a[0:7], v0
  s_mov_b32 m0, s31
  ds_read_b128 v[120:123], v1 offset:1024
  v_smfmac_f32_16x16x64_bf16 v[16:19], v[84:87], v[232:239], v0
  s_cmp_ge_i32 s14, s30
  s_cbranch_scc1 T_kvw_78
T_kvb_79:
  v_smfmac_f32_16x16x64_bf16 v[20:23], v[84:87], v[248:255], v0
  ds_read_b128 v[80:83], v4 offset:15360
  buffer_load_dwordx4 v9, s[4:7], s27 offen sc1 lds
  v_smfmac_f32_16x16x64_bf16 v[24:27], v[84:87], a[8:15], v0
  s_waitcnt lgkmcnt(2)
  s_mov_b32 m0, s32
  v_smfmac_f32_16x16x64_bf16 v[16:19], v[100:103], v[128:135], v0
  ds_read_b128 v[92:95], v2 offset:2048
  v_smfmac_f32_16x16x64_bf16 v[20:23], v[100:103], v[144:151], v0
  ds_read_b128 v[96:99], v1 offset:2048
  v_smfmac_f32_16x16x64_bf16 v[24:27], v[100:103], v[68:75], v0
  s_waitcnt vmcnt(1) lgkmcnt(3)
  ds_read_b128 v[116:119], v2 offset:3072
  buffer_load_dwordx4 v9, s[4:7], s27 offen offset:128 sc1 lds
  v_smfmac_f32_16x16x64_bf16 v[16:19], v[120:123], v[136:143], v0
  ds_read_b128 v[124:127], v1 offset:3072
  s_mov_b32 m0, s33
  v_smfmac_f32_16x16x64_bf16 v[20:23], v[120:123], v[152:159], v0
  s_waitcnt lgkmcnt(4)
  ds_read_b128 v[104:107], v2 offset:5120
  v_smfmac_f32_16x16x64_bf16 v[24:27], v[120:123], v[76:83], v0
  s_waitcnt lgkmcnt(4)
  ds_read_b128 v[108:111], v1 offset:5120
  v_smfmac_f32_16x16x64_bf16 v[16:19], v[92:95], v[160:167], v0
  s_waitcnt lgkmcnt(4)
  ds_read_b128 v[112:115], v2 offset:6144
  buffer_load_dwordx4 v10, s[4:7], s28 offen sc1 lds
  v_smfmac_f32_16x16x64_bf16 v[16:19], v[96:99], v[168:175], v0
  s_waitcnt lgkmcnt(4)
  ds_read_b128 v[84:87], v1 offset:6144
  s_mov_b32 m0, s34
  v_smfmac_f32_16x16x64_bf16 v[16:19], v[116:119], v[192:199], v0
  s_waitcnt lgkmcnt(4)
  ds_read_b128 v[88:91], v2 offset:7168
  v_smfmac_f32_16x16x64_bf16 v[16:19], v[124:127], v[200:207], v0
  s_waitcnt lgkmcnt(4)
  ds_read_b128 v[100:103], v1 offset:7168
  v_smfmac_f32_16x16x64_bf16 v[16:19], v[104:107], a[16:23], v0
  s_waitcnt lgkmcnt(4)
  ds_read_b128 v[68:71], v4 offset:16384
  buffer_load_dwordx4 v10, s[4:7], s28 offen offset:256 sc1 lds
  v_smfmac_f32_16x16x64_bf16 v[16:19], v[108:111], a[24:31], v0
  s_waitcnt lgkmcnt(4)
  ds_read_b128 v[72:75], v4 offset:17408
  v_smfmac_f32_16x16x64_bf16 v[16:19], v[112:115], a[64:71], v0
  s_waitcnt lgkmcnt(4)
  ds_read_b128 v[76:79], v4 offset:18432
  v_smfmac_f32_16x16x64_bf16 v[16:19], v[84:87], a[72:79], v0
  s_waitcnt lgkmcnt(4)
  ds_read_b128 v[80:83], v4 offset:19456
  v_smfmac_f32_16x16x64_bf16 v[16:19], v[88:91], a[112:119], v0
  s_waitcnt lgkmcnt(4)
  v_smfmac_f32_16x16x64_bf16 v[16:19], v[100:103], a[120:127], v0
  s_add_u32 s24, s36, 145752064
  s_add_u32 s25, s36, 145756160
  v_smfmac_f32_16x16x64_bf16 v[20:23], v[92:95], v[176:183], v0
  s_add_u32 s35, s36, s23
  v_smfmac_f32_16x16x64_bf16 v[20:23], v[96:99], v[184:191], v0
  s_waitcnt lgkmcnt(2)
  v_smfmac_f32_16x16x64_bf16 v[20:23], v[116:119], v[68:75], v0
  s_waitcnt lgkmcnt(0)
  ds_read_b128 v[68:71], v4 offset:20480
  v_mul_f32 v16, s18, v16
  v_smfmac_f32_16x16x64_bf16 v[20:23], v[124:127], v[76:83], v0
  ds_read_b128 v[72:75], v4 offset:21504
  v_mul_f32 v17, s18, v17
  v_smfmac_f32_16x16x64_bf16 v[20:23], v[104:107], a[32:39], v0
  ds_read_b128 v[76:79], v4 offset:22528
  v_mul_f32 v18, s18, v18
  v_smfmac_f32_16x16x64_bf16 v[20:23], v[108:111], a[40:47], v0
  ds_read_b128 v[80:83], v4 offset:23552
  v_mul_f32 v19, s18, v19
  v_smfmac_f32_16x16x64_bf16 v[20:23], v[112:115], a[80:87], v0
  v_cvt_pk_bf16_f32 v120, v16, v17
  v_smfmac_f32_16x16x64_bf16 v[20:23], v[84:87], a[88:95], v0
  v_cvt_pk_bf16_f32 v121, v18, v19
  v_smfmac_f32_16x16x64_bf16 v[20:23], v[88:91], a[128:135], v0
  ds_write_b64 v5, v[120:121] offset:24576
  v_smfmac_f32_16x16x64_bf16 v[20:23], v[100:103], a[136:143], v0
  s_waitcnt lgkmcnt(3)
  v_smfmac_f32_16x16x64_bf16 v[24:27], v[92:95], v[68:75], v0
  s_waitcnt lgkmcnt(1)
  v_mov_b64 v[92:93], 0
  v_smfmac_f32_16x16x64_bf16 v[24:27], v[96:99], v[76:83], v0
  s_nop 1
  v_cvt_pk_bf16_f32 v122, v20, v21
  v_cvt_pk_bf16_f32 v123, v22, v23
  v_smfmac_f32_16x16x64_bf16 v[24:27], v[116:119], v[208:215], v0
  ds_write_b64 v5, v[122:123] offset:26880
  v_mov_b64 v[94:95], 0
  v_smfmac_f32_16x16x64_bf16 v[24:27], v[124:127], v[216:223], v0
  s_waitcnt lgkmcnt(1)
  s_barrier
  ds_read_b64_tr_b16 v[68:69], v6 offset:24576
  v_smfmac_f32_16x16x64_bf16 v[24:27], v[104:107], a[48:55], v0
  s_add_u32 s27, s27, 8192
  ds_read_b64_tr_b16 v[70:71], v6 offset:24640
  ds_read_b64_tr_b16 v[72:73], v6 offset:24832
  v_smfmac_f32_16x16x64_bf16 v[24:27], v[108:111], a[56:63], v0
  s_add_u32 s28, s28, 8192
  ds_read_b64_tr_b16 v[74:75], v6 offset:24896
  ds_read_b64_tr_b16 v[76:77], v6 offset:25088
  v_smfmac_f32_16x16x64_bf16 v[24:27], v[112:115], a[96:103], v0
  s_nop 0
  ds_read_b64_tr_b16 v[78:79], v6 offset:25152
  ds_read_b64_tr_b16 v[80:81], v6 offset:25344
  v_smfmac_f32_16x16x64_bf16 v[24:27], v[84:87], a[104:111], v0
  ds_read_b64_tr_b16 v[82:83], v6 offset:25408
  v_mov_b64 v[96:97], 0
  v_smfmac_f32_16x16x64_bf16 v[24:27], v[88:91], a[144:151], v0
  s_waitcnt lgkmcnt(8)
  s_barrier
  ds_read_b64_tr_b16 v[116:117], v6 offset:26880
  v_smfmac_f32_16x16x64_bf16 v[24:27], v[100:103], a[152:159], v0
  s_waitcnt lgkmcnt(7)
  ds_read_b64_tr_b16 v[118:119], v6 offset:26944
  v_mfma_f32_16x16x32_bf16 v[16:19], v[36:39], v[68:71], 0
  s_waitcnt lgkmcnt(6)
  ds_read_b64_tr_b16 v[124:125], v6 offset:27136
  ds_read_b64_tr_b16 v[126:127], v6 offset:27200
  v_mfma_f32_16x16x32_bf16 v[16:19], v[40:43], v[72:75], v[16:19]
  s_waitcnt lgkmcnt(6)
  ds_read_b64_tr_b16 v[104:105], v6 offset:27392
  ds_read_b64_tr_b16 v[106:107], v6 offset:27456
  v_mfma_f32_16x16x32_bf16 v[16:19], v[44:47], v[76:79], v[16:19]
  s_waitcnt lgkmcnt(6)
  ds_read_b64_tr_b16 v[108:109], v6 offset:27648
  ds_read_b64_tr_b16 v[110:111], v6 offset:27712
  v_mfma_f32_16x16x32_bf16 v[16:19], v[48:51], v[80:83], v[16:19]
  s_waitcnt lgkmcnt(6)
  v_cvt_pk_bf16_f32 v120, v24, v25
  v_cvt_pk_bf16_f32 v121, v26, v27
  v_mfma_f32_16x16x32_bf16 v[112:115], v[116:119], v[68:71], 0
  s_waitcnt lgkmcnt(4)
  buffer_store_dwordx4 v[120:123], v2, s[4:7], s29 offen offset:0 sc1
  v_mov_b64 v[98:99], 0
  v_mfma_f32_16x16x32_bf16 v[112:115], v[124:127], v[72:75], v[112:115]
  s_waitcnt lgkmcnt(2)
  v_mov_b64 v[36:37], 0
  v_exp_f32 v100, v16
  v_mfma_f32_16x16x32_bf16 v[112:115], v[104:107], v[76:79], v[112:115]
  s_waitcnt lgkmcnt(0)
  v_exp_f32 v101, v17
  v_mfma_f32_16x16x32_bf16 v[112:115], v[108:111], v[80:83], v[112:115]
  v_exp_f32 v102, v18
  v_mfma_f32_16x16x32_bf16 v[20:23], v[52:55], v[68:71], 0
  s_cmp_eq_u32 s14, 63
  v_exp_f32 v103, v19
  v_mfma_f32_16x16x32_bf16 v[20:23], v[56:59], v[72:75], v[20:23]
  s_cbranch_scc1 M_tdone
  v_cvt_pk_bf16_f32 v44, v100, v101
  v_cvt_pk_bf16_f32 v45, v102, v103
  v_mfma_f32_16x16x32_bf16 v[20:23], v[60:63], v[76:79], v[20:23]
  s_add_u32 s29, s29, 131072
  v_exp_f32 v100, v112
  v_mfma_f32_16x16x32_bf16 v[20:23], v[64:67], v[80:83], v[20:23]
  v_exp_f32 v101, v113
  v_exp_f32 v102, v114
  v_exp_f32 v103, v115
  v_cvt_pk_bf16_f32 v84, v100, v101
  v_cvt_pk_bf16_f32 v85, v102, v103
  v_cndmask_b32 v48, v84, 0, s[16:17]
  v_cndmask_b32 v49, v85, 0, s[16:17]
  v_cndmask_b32 v50, 0, v84, s[16:17]
  v_cndmask_b32 v51, 0, v85, s[16:17]
  v_exp_f32 v100, v20
  v_mfma_f32_16x16x16_bf16 v[88:91], v[12:13], v[48:49], 0
  v_exp_f32 v101, v21
  v_mfma_f32_16x16x16_bf16 v[24:27], v[120:121], v[48:49], 0
  v_exp_f32 v102, v22
  v_mfma_f32_16x16x16_bf16 v[116:119], v[120:121], v[50:51], 0
  v_exp_f32 v103, v23
  v_cvt_pk_bf16_f32 v46, v100, v101
  v_cvt_pk_bf16_f32 v47, v102, v103
  v_mov_b64 v[38:39], 0
  s_nop 0
  v_mfma_f32_16x16x32_bf16 v[88:91], v[12:15], v[44:47], v[88:91]
  v_mov_b64 v[40:41], 0
  v_mov_b64 v[42:43], 0
  v_mfma_f32_16x16x32_bf16 v[24:27], v[28:31], v[44:47], v[24:27]
  ds_read_b128 v[52:55], v4 offset:24576
  ds_read_b128 v[56:59], v4 offset:25600
  v_mfma_f32_16x16x32_bf16 v[116:119], v[32:35], v[44:47], v[116:119]
  s_nop 1
  v_rcp_f32 v89, v88
  v_subrev_u32 v100, s54, v88
  v_cmp_le_u32 vcc, s55, v100
  v_mul_f32 v24, v89, v24
  v_mul_f32 v25, v89, v25
  s_cbranch_vccnz T_slow_81
T_back_82:
  v_cvt_pk_bf16_f32 v124, v24, v25
  v_pk_mul_f32 v[26:27], v[26:27], v[88:89] op_sel:[0,1] op_sel_hi:[1,1]
  v_pk_mul_f32 v[116:117], v[116:117], v[88:89] op_sel:[0,1] op_sel_hi:[1,1]
  v_pk_mul_f32 v[118:119], v[118:119], v[88:89] op_sel:[0,1] op_sel_hi:[1,1]
  v_cvt_pk_bf16_f32 v125, v26, v27
  v_cvt_pk_bf16_f32 v126, v116, v117
  v_cvt_pk_bf16_f32 v127, v118, v119
  ds_write_b128 v11, v[124:127] offset:29184
  s_nop 0
  v_smfmac_f32_16x16x64_bf16 v[92:95], v[124:127], a[160:167], v0
  v_smfmac_f32_16x16x64_bf16 v[96:99], v[124:127], a[168:175], v0
  v_smfmac_f32_16x16x64_bf16 v[36:39], v[124:127], a[176:183], v0
  v_smfmac_f32_16x16x64_bf16 v[40:43], v[124:127], a[184:191], v0
  s_waitcnt lgkmcnt(0)
  s_barrier
  ds_read_b128 v[104:107], v11 offset:29696
  ds_read_b128 v[108:111], v11 offset:30208
  ds_read_b128 v[68:71], v11 offset:30720
  s_waitcnt lgkmcnt(2)
  v_smfmac_f32_16x16x64_bf16 v[92:95], v[104:107], a[192:199], v0
  s_waitcnt lgkmcnt(1)
  ds_read_b128 v[76:79], v4 offset:28672
  v_smfmac_f32_16x16x64_bf16 v[92:95], v[108:111], a[224:231], v0
  s_waitcnt lgkmcnt(1)
  ds_read_b128 v[80:83], v4 offset:29696
  v_smfmac_f32_16x16x64_bf16 v[92:95], v[68:71], a[240:247], v0
  ds_read_b128 v[60:63], v4 offset:26624
  v_smfmac_f32_16x16x64_bf16 v[96:99], v[104:107], a[200:207], v0
  ds_read_b128 v[64:67], v4 offset:27648
  v_smfmac_f32_16x16x64_bf16 v[96:99], v[108:111], a[232:239], v0
  ds_read_b128 v[28:31], v4 offset:30720
  s_nop 0
  v_cvt_pk_bf16_f32 v16, v92, v93
  v_cvt_pk_bf16_f32 v17, v94, v95
  v_bfi_b32 v16, 1, s57, v16
  v_smfmac_f32_16x16x64_bf16 v[96:99], v[68:71], a[248:255], v0
  buffer_store_dwordx2 v[16:17], v7, s[4:7], s20 offen offset:0 sc1
  v_smfmac_f32_16x16x64_bf16 v[36:39], v[104:107], a[208:215], v0
  ds_read_b128 v[32:35], v4 offset:31744
  v_smfmac_f32_16x16x64_bf16 v[36:39], v[108:111], v[52:59], v0
  s_waitcnt lgkmcnt(4)
  s_nop 0
  v_cvt_pk_bf16_f32 v18, v96, v97
  v_cvt_pk_bf16_f32 v19, v98, v99
  v_bfi_b32 v18, 1, s57, v18
  v_smfmac_f32_16x16x64_bf16 v[36:39], v[68:71], v[76:83], v0
  buffer_store_dwordx2 v[18:19], v7, s[4:7], s20 offen offset:64 sc1
  v_smfmac_f32_16x16x64_bf16 v[40:43], v[104:107], a[216:223], v0
  s_waitcnt lgkmcnt(2)
  ds_read_b128 v[116:119], v2 offset:31232
  v_smfmac_f32_16x16x64_bf16 v[40:43], v[108:111], v[60:67], v0
  s_waitcnt lgkmcnt(1)
  s_nop 0
  v_cvt_pk_bf16_f32 v20, v36, v37
  v_cvt_pk_bf16_f32 v21, v38, v39
  v_bfi_b32 v20, 1, s57, v20
  v_smfmac_f32_16x16x64_bf16 v[40:43], v[68:71], v[28:35], v0
  buffer_store_dwordx2 v[20:21], v7, s[4:7], s21 offen offset:0 sc1
  s_nop 6
  v_cvt_pk_bf16_f32 v22, v40, v41
  v_cvt_pk_bf16_f32 v23, v42, v43
  v_bfi_b32 v22, 1, s57, v22
  buffer_store_dwordx2 v[22:23], v7, s[4:7], s21 offen offset:64 sc1
  ds_read_b128 v[68:71], v4 offset:0
  ds_read_b128 v[72:75], v4 offset:1024
  ds_read_b128 v[76:79], v4 offset:4096
  ds_read_b128 v[80:83], v4 offset:5120
  ds_read_b128 v[84:87], v4 offset:8192
  ds_read_b128 v[88:91], v4 offset:9216
  v_mov_b64 v[16:17], 0
  v_mov_b64 v[18:19], 0
  v_mov_b64 v[20:21], 0
  v_mov_b64 v[22:23], 0
  v_mov_b64 v[24:25], 0
  v_mov_b64 v[26:27], 0
  s_mov_b32 s19, 0
  v_mov_b32 v49, -1
  s_waitcnt vmcnt(2)
  buffer_load_dwordx4 v[52:55], v2, s[4:7], s22 offen offset:0 sc1
  buffer_load_dwordx4 v[56:59], v2, s[4:7], s22 offen offset:1024 sc1
  buffer_load_dwordx4 v[60:63], v2, s[4:7], s22 offen offset:2048 sc1
  buffer_load_dwordx4 v[64:67], v2, s[4:7], s22 offen offset:3072 sc1
  ds_read_b128 v[92:95], v4 offset:2048
  ds_read_b128 v[96:99], v4 offset:3072
  ds_read_b128 v[100:103], v4 offset:6144
  ds_read_b128 v[104:107], v4 offset:7168
  ds_read_b128 v[108:111], v4 offset:10240
  ds_read_b128 v[112:115], v4 offset:11264
  ds_read_b64 v[44:45], v2 offset:32256
  s_waitcnt lgkmcnt(0)
  v_readfirstlane_b32 s38, v44
  v_readfirstlane_b32 s37, v45
  s_nop 0
  s_lshl_b32 s38, s38, 1
  s_lshl1_add_u32 s37, s37, 1
  s_min_u32 s38, s38, s37
  s_cmp_ge_u32 s38, 64
  s_cselect_b32 s38, 100, s38
  s_sub_u32 s38, s38, 1
  s_max_i32 s30, s30, s38
  s_waitcnt lgkmcnt(12)
  s_waitcnt vmcnt(3)
  v_mfma_f32_16x16x32_bf16 v[120:123], v[116:119], v[52:55], 0
  v_xor_b32 v48, s57, v52
  v_bitop3_b32 v48, v48, v54, s57 bitop3:0xf6
  s_waitcnt vmcnt(2)
  v_mfma_f32_16x16x32_bf16 v[120:123], v[116:119], v[56:59], v[120:123]
  v_bitop3_b32 v48, v48, v56, s57 bitop3:0xf6
  v_bitop3_b32 v48, v48, v58, s57 bitop3:0xf6
  s_waitcnt vmcnt(1)
  v_mfma_f32_16x16x32_bf16 v[120:123], v[116:119], v[60:63], v[120:123]
  v_bitop3_b32 v48, v48, v60, s57 bitop3:0xf6
  v_bitop3_b32 v48, v48, v62, s57 bitop3:0xf6
  s_waitcnt vmcnt(0)
  v_mfma_f32_16x16x32_bf16 v[120:123], v[116:119], v[64:67], v[120:123]
  v_bitop3_b32 v48, v48, v64, s57 bitop3:0xf6
  v_bitop3_b32 v48, v48, v66, s57 bitop3:0xf6
  v_and_b32 v48, 1, v48
  v_cmp_ne_u32 vcc, 0, v48
  s_cbranch_vccnz T_p1re_84
T_p1ok_85:
  s_nop 2
  v_add_f32_dpp v120, v120, v120 row_ror:8 row_mask:0xf bank_mask:0xf
  v_add_f32_dpp v121, v121, v121 row_ror:8 row_mask:0xf bank_mask:0xf
  v_cvt_pk_bf16_f32 v48, v120, v121
  buffer_store_dword v48, v8, s[4:7], s35 offen sc1
  buffer_store_dword v49, v8, s[4:7], s26 offen sc1
  s_barrier
  ds_read_b128 v[28:31], v2 offset:16384
  ds_read_b128 v[32:35], v2 offset:20480
  ds_read_b128 v[36:39], v2 offset:8192
  ds_read_b128 v[40:43], v2 offset:9216
  ds_read_b128 v[44:47], v2 offset:10240
  ds_read_b128 v[48:51], v2 offset:11264
  buffer_load_dwordx4 v[124:127], v2, s[4:7], s24 offen offset:0 sc1
  buffer_load_dwordx4 v[116:119], v2, s[4:7], s25 offen offset:0 sc1
  ds_read_b128 v[52:55], v2 offset:12288
  ds_read_b128 v[56:59], v2 offset:13312
  ds_read_b128 v[60:63], v2 offset:14336
  ds_read_b128 v[64:67], v2 offset:15360
  buffer_load_dwordx4 v[124:127], v2, s[4:7], s24 offen offset:0 sc1
  buffer_load_dwordx4 v[116:119], v2, s[4:7], s25 offen offset:0 sc1
  s_mov_b32 s19, 0
  s_branch T_loop_74
T_p1re_84:
  s_mov_b64 exec, vcc
  buffer_load_dwordx4 v[52:55], v2, s[4:7], s22 offen offset:0 sc1
  buffer_load_dwordx4 v[56:59], v2, s[4:7], s22 offen offset:1024 sc1
  buffer_load_dwordx4 v[60:63], v2, s[4:7], s22 offen offset:2048 sc1
  buffer_load_dwordx4 v[64:67], v2, s[4:7], s22 offen offset:3072 sc1
  s_mov_b64 exec, -1
  s_add_u32 s19, s19, 1
  s_cmp_gt_u32 s19, 32768
  s_cbranch_scc1 M_exit
  s_waitcnt vmcnt(3)
  v_mfma_f32_16x16x32_bf16 v[120:123], v[116:119], v[52:55], 0
  v_xor_b32 v48, s57, v52
  v_bitop3_b32 v48, v48, v54, s57 bitop3:0xf6
  s_waitcnt vmcnt(2)
  v_mfma_f32_16x16x32_bf16 v[120:123], v[116:119], v[56:59], v[120:123]
  v_bitop3_b32 v48, v48, v56, s57 bitop3:0xf6
  v_bitop3_b32 v48, v48, v58, s57 bitop3:0xf6
  s_waitcnt vmcnt(1)
  v_mfma_f32_16x16x32_bf16 v[120:123], v[116:119], v[60:63], v[120:123]
  v_bitop3_b32 v48, v48, v60, s57 bitop3:0xf6
  v_bitop3_b32 v48, v48, v62, s57 bitop3:0xf6
  s_waitcnt vmcnt(0)
  v_mfma_f32_16x16x32_bf16 v[120:123], v[116:119], v[64:67], v[120:123]
  v_bitop3_b32 v48, v48, v64, s57 bitop3:0xf6
  v_bitop3_b32 v48, v48, v66, s57 bitop3:0xf6
  v_and_b32 v48, 1, v48
  v_cmp_ne_u32 vcc, 0, v48
  s_cbranch_vccnz T_p1re_84
  s_branch T_p1ok_85
T_kvw_78:
  s_mov_b32 s19, 0
  s_branch T_kvok_87
T_kv_86:
  s_sleep 4
  s_add_u32 s19, s19, 1
  s_cmp_gt_u32 s19, 32768
  s_cbranch_scc1 M_exit
T_kvok_87:
  s_add_u32 s39, s99, 128
  s_mov_b32 s38, 0
  s_mov_b32 s37, 0
  s_atomic_or s38, s[58:59], s99 glc
  s_atomic_or s37, s[58:59], s39 glc
  s_waitcnt lgkmcnt(0)
  s_lshl_b32 s38, s38, 1
  s_lshl1_add_u32 s37, s37, 1
  s_min_u32 s38, s38, s37
  s_cmp_ge_u32 s38, 64
  s_cselect_b32 s38, 100, s38
  s_sub_u32 s38, s38, 1
  s_max_i32 s30, s30, s38
  s_cmp_ge_i32 s14, s30
  s_cbranch_scc1 T_kv_86
  s_branch T_kvb_79
T_slow_81:
  s_nop 7
  v_max3_f32 v100, v16, v17, v18
  v_max3_f32 v100, v100, v19, v20
  v_max3_f32 v100, v100, v21, v22
  v_max3_f32 v100, v100, v23, v112
  v_max3_f32 v100, v100, v113, v114
  v_max_f32 v100, v100, v115
  v_mov_b32 v101, v100
  s_nop 1
  v_permlane32_swap_b32 v100, v101
  s_nop 1
  v_max_f32 v100, v100, v101
  v_mov_b32 v101, v100
  s_nop 1
  v_permlane16_swap_b32 v100, v101
  s_nop 1
  v_max_f32 v100, v100, v101
  v_sub_f32 v16, v16, v100
  v_sub_f32 v17, v17, v100
  v_sub_f32 v18, v18, v100
  v_sub_f32 v19, v19, v100
  v_exp_f32 v16, v16
  v_exp_f32 v17, v17
  v_exp_f32 v18, v18
  v_exp_f32 v19, v19
  v_sub_f32 v20, v20, v100
  v_sub_f32 v21, v21, v100
  v_sub_f32 v22, v22, v100
  v_sub_f32 v23, v23, v100
  v_exp_f32 v20, v20
  v_exp_f32 v21, v21
  v_exp_f32 v22, v22
  v_exp_f32 v23, v23
  v_sub_f32 v112, v112, v100
  v_sub_f32 v113, v113, v100
  v_sub_f32 v114, v114, v100
  v_sub_f32 v115, v115, v100
  v_exp_f32 v112, v112
  v_exp_f32 v113, v113
  v_exp_f32 v114, v114
  v_exp_f32 v115, v115
  s_nop 0
  v_cvt_pk_bf16_f32 v44, v16, v17
  v_cvt_pk_bf16_f32 v45, v18, v19
  v_cvt_pk_bf16_f32 v46, v20, v21
  v_cvt_pk_bf16_f32 v47, v22, v23
  v_cvt_pk_bf16_f32 v84, v112, v113
  v_cvt_pk_bf16_f32 v85, v114, v115
  v_cndmask_b32 v48, v84, 0, s[16:17]
  v_cndmask_b32 v49, v85, 0, s[16:17]
  v_cndmask_b32 v50, 0, v84, s[16:17]
  v_cndmask_b32 v51, 0, v85, s[16:17]
  s_nop 1
  v_mfma_f32_16x16x16_bf16 v[88:91], v[12:13], v[48:49], 0
  v_mfma_f32_16x16x16_bf16 v[24:27], v[120:121], v[48:49], 0
  v_mfma_f32_16x16x16_bf16 v[116:119], v[120:121], v[50:51], 0
  v_mfma_f32_16x16x32_bf16 v[88:91], v[12:15], v[44:47], v[88:91]
  v_mfma_f32_16x16x32_bf16 v[24:27], v[28:31], v[44:47], v[24:27]
  v_mfma_f32_16x16x32_bf16 v[116:119], v[32:35], v[44:47], v[116:119]
  s_nop 7
  s_nop 1
  v_rcp_f32 v89, v88
  s_nop 0
  v_mul_f32 v24, v89, v24
  v_mul_f32 v25, v89, v25
  s_branch T_back_82
T_w_71:
  s_mov_b32 s19, 0
  v_mov_b64 v[16:17], 0
  v_mov_b64 v[18:19], 0
  v_mov_b64 v[20:21], 0
  v_mov_b64 v[22:23], 0
  v_mov_b64 v[24:25], 0
  v_mov_b64 v[26:27], 0
  buffer_load_dwordx4 v[124:127], v2, s[4:7], s24 offen offset:1024 sc1
  buffer_load_dwordx4 v[116:119], v2, s[4:7], s25 offen offset:1024 sc1
  buffer_load_dwordx4 v[124:127], v2, s[4:7], s24 offen offset:1024 sc1
  buffer_load_dwordx4 v[116:119], v2, s[4:7], s25 offen offset:1024 sc1
  s_branch T_loop_88
.p2align 6
T_retry_89:
  s_mov_b64 exec, vcc
  buffer_load_dwordx4 v[124:127], v2, s[4:7], s24 offen offset:1024 sc1
  buffer_load_dwordx4 v[116:119], v2, s[4:7], s25 offen offset:1024 sc1
  s_mov_b64 exec, -1
  s_add_u32 s19, s19, 1
  s_cmp_gt_u32 s19, 32768
  s_cbranch_scc1 M_exit
T_loop_88:
  s_waitcnt vmcnt(3) lgkmcnt(0)
  v_max3_u32 v123, v124, v125, v126
  v_max_u32 v123, v123, v127
  v_mov_b32_dpp v120, v124 row_ror:8 row_mask:0xf bank_mask:0xf
  v_mov_b32_dpp v121, v125 row_ror:8 row_mask:0xf bank_mask:0xf
  s_waitcnt vmcnt(2)
  v_max3_u32 v123, v123, v116, v117
  v_max3_u32 v123, v123, v118, v119
  v_cmp_eq_u32 vcc, -1, v123
  s_cbranch_vccnz T_retry_89
  v_smfmac_f32_16x16x64_bf16 v[16:19], v[124:127], v[68:75], v0
  s_add_u32 s14, s14, 1
  ds_write_b128 v2, v[124:127] offset:1024
  v_mov_b32_dpp v122, v126 row_ror:8 row_mask:0xf bank_mask:0xf
  v_smfmac_f32_16x16x64_bf16 v[20:23], v[124:127], v[76:83], v0
  s_and_b32 s57, s14, 1
  v_mov_b32_dpp v123, v127 row_ror:8 row_mask:0xf bank_mask:0xf
  v_smfmac_f32_16x16x64_bf16 v[24:27], v[124:127], v[84:91], v0
  s_and_b32 s36, s14, 3
  ds_write_b128 v2, v[116:119] offset:5120
  v_smfmac_f32_16x16x64_bf16 v[16:19], v[120:123], v[92:99], v0
  s_lshl_b32 s36, s36, 13
  v_mov_b32_dpp v84, v116 row_ror:8 row_mask:0xf bank_mask:0xf
  v_smfmac_f32_16x16x64_bf16 v[20:23], v[120:123], v[100:107], v0
  s_add_u32 s26, s36, s23
  ds_read_b128 v[68:71], v4 offset:12288
  v_mov_b32_dpp v85, v117 row_ror:8 row_mask:0xf bank_mask:0xf
  v_smfmac_f32_16x16x64_bf16 v[24:27], v[120:123], v[108:115], v0
  s_add_u32 s36, s36, 8192
  ds_read_b128 v[72:75], v4 offset:13312
  v_mov_b32_dpp v86, v118 row_ror:8 row_mask:0xf bank_mask:0xf
  v_smfmac_f32_16x16x64_bf16 v[16:19], v[116:119], v[224:231], v0
  s_and_b32 s36, s36, 0x7fff
  ds_read_b128 v[76:79], v4 offset:14336
  v_mov_b32_dpp v87, v119 row_ror:8 row_mask:0xf bank_mask:0xf
  v_smfmac_f32_16x16x64_bf16 v[20:23], v[116:119], v[240:247], v0
  s_waitcnt lgkmcnt(3)
  s_barrier
  ds_read_b128 v[100:103], v2 offset:0
  v_smfmac_f32_16x16x64_bf16 v[24:27], v[116:119], a[0:7], v0
  s_mov_b32 m0, s31
  ds_read_b128 v[120:123], v1 offset:0
  v_smfmac_f32_16x16x64_bf16 v[16:19], v[84:87], v[232:239], v0
  s_cmp_ge_i32 s14, s30
  s_cbranch_scc1 T_kvw_92
T_kvb_93:
  v_smfmac_f32_16x16x64_bf16 v[20:23], v[84:87], v[248:255], v0
  ds_read_b128 v[80:83], v4 offset:15360
  v_smfmac_f32_16x16x64_bf16 v[24:27], v[84:87], a[8:15], v0
  s_waitcnt lgkmcnt(2)
  buffer_load_dwordx4 v9, s[4:7], s27 offen sc1 lds
  v_smfmac_f32_16x16x64_bf16 v[16:19], v[100:103], v[128:135], v0
  ds_read_b128 v[92:95], v2 offset:3072
  s_mov_b32 m0, s32
  v_smfmac_f32_16x16x64_bf16 v[20:23], v[100:103], v[144:151], v0
  ds_read_b128 v[96:99], v1 offset:3072
  v_smfmac_f32_16x16x64_bf16 v[24:27], v[100:103], v[68:75], v0
  s_waitcnt vmcnt(1) lgkmcnt(3)
  ds_read_b128 v[116:119], v2 offset:2048
  v_smfmac_f32_16x16x64_bf16 v[16:19], v[120:123], v[136:143], v0
  ds_read_b128 v[124:127], v1 offset:2048
  buffer_load_dwordx4 v9, s[4:7], s27 offen offset:128 sc1 lds
  v_smfmac_f32_16x16x64_bf16 v[20:23], v[120:123], v[152:159], v0
  s_waitcnt lgkmcnt(4)
  ds_read_b128 v[104:107], v2 offset:4096
  s_mov_b32 m0, s33
  v_smfmac_f32_16x16x64_bf16 v[24:27], v[120:123], v[76:83], v0
  s_waitcnt lgkmcnt(4)
  ds_read_b128 v[108:111], v1 offset:4096
  v_smfmac_f32_16x16x64_bf16 v[16:19], v[92:95], v[160:167], v0
  s_waitcnt lgkmcnt(4)
  ds_read_b128 v[112:115], v2 offset:7168
  v_smfmac_f32_16x16x64_bf16 v[16:19], v[96:99], v[168:175], v0
  s_waitcnt lgkmcnt(4)
  ds_read_b128 v[84:87], v1 offset:7168
  buffer_load_dwordx4 v10, s[4:7], s28 offen sc1 lds
  v_smfmac_f32_16x16x64_bf16 v[16:19], v[116:119], v[192:199], v0
  s_waitcnt lgkmcnt(4)
  ds_read_b128 v[88:91], v2 offset:6144
  s_mov_b32 m0, s34
  v_smfmac_f32_16x16x64_bf16 v[16:19], v[124:127], v[200:207], v0
  s_waitcnt lgkmcnt(4)
  ds_read_b128 v[100:103], v1 offset:6144
  v_smfmac_f32_16x16x64_bf16 v[16:19], v[104:107], a[16:23], v0
  s_waitcnt lgkmcnt(4)
  ds_read_b128 v[68:71], v4 offset:16384
  v_smfmac_f32_16x16x64_bf16 v[16:19], v[108:111], a[24:31], v0
  s_waitcnt lgkmcnt(4)
  ds_read_b128 v[72:75], v4 offset:17408
  buffer_load_dwordx4 v10, s[4:7], s28 offen offset:256 sc1 lds
  v_smfmac_f32_16x16x64_bf16 v[16:19], v[112:115], a[64:71], v0
  s_waitcnt lgkmcnt(4)
  ds_read_b128 v[76:79], v4 offset:18432
  v_smfmac_f32_16x16x64_bf16 v[16:19], v[84:87], a[72:79], v0
  s_waitcnt lgkmcnt(4)
  ds_read_b128 v[80:83], v4 offset:19456
  v_smfmac_f32_16x16x64_bf16 v[16:19], v[88:91], a[112:119], v0
  s_waitcnt lgkmcnt(4)
  v_smfmac_f32_16x16x64_bf16 v[16:19], v[100:103], a[120:127], v0
  s_add_u32 s24, s36, 145752064
  s_add_u32 s25, s36, 145756160
  v_smfmac_f32_16x16x64_bf16 v[20:23], v[92:95], v[176:183], v0
  s_add_u32 s35, s36, s23
  v_smfmac_f32_16x16x64_bf16 v[20:23], v[96:99], v[184:191], v0
  s_waitcnt lgkmcnt(2)
  v_smfmac_f32_16x16x64_bf16 v[20:23], v[116:119], v[68:75], v0
  s_waitcnt lgkmcnt(0)
  ds_read_b128 v[68:71], v4 offset:20480
  v_mul_f32 v16, s18, v16
  v_smfmac_f32_16x16x64_bf16 v[20:23], v[124:127], v[76:83], v0
  ds_read_b128 v[72:75], v4 offset:21504
  v_mul_f32 v17, s18, v17
  v_smfmac_f32_16x16x64_bf16 v[20:23], v[104:107], a[32:39], v0
  ds_read_b128 v[76:79], v4 offset:22528
  v_mul_f32 v18, s18, v18
  v_smfmac_f32_16x16x64_bf16 v[20:23], v[108:111], a[40:47], v0
  ds_read_b128 v[80:83], v4 offset:23552
  v_mul_f32 v19, s18, v19
  v_smfmac_f32_16x16x64_bf16 v[20:23], v[112:115], a[80:87], v0
  v_cvt_pk_bf16_f32 v120, v16, v17
  v_smfmac_f32_16x16x64_bf16 v[20:23], v[84:87], a[88:95], v0
  v_cvt_pk_bf16_f32 v121, v18, v19
  v_smfmac_f32_16x16x64_bf16 v[20:23], v[88:91], a[128:135], v0
  ds_write_b64 v5, v[120:121] offset:24576
  v_smfmac_f32_16x16x64_bf16 v[20:23], v[100:103], a[136:143], v0
  s_waitcnt lgkmcnt(3)
  v_smfmac_f32_16x16x64_bf16 v[24:27], v[92:95], v[68:75], v0
  s_waitcnt lgkmcnt(1)
  v_mov_b64 v[92:93], 0
  v_smfmac_f32_16x16x64_bf16 v[24:27], v[96:99], v[76:83], v0
  s_nop 1
  v_cvt_pk_bf16_f32 v122, v20, v21
  v_cvt_pk_bf16_f32 v123, v22, v23
  v_smfmac_f32_16x16x64_bf16 v[24:27], v[116:119], v[208:215], v0
  ds_write_b64 v5, v[122:123] offset:26880
  v_mov_b64 v[94:95], 0
  v_smfmac_f32_16x16x64_bf16 v[24:27], v[124:127], v[216:223], v0
  s_waitcnt lgkmcnt(1)
  s_barrier
  ds_read_b64_tr_b16 v[68:69], v6 offset:24576
  v_smfmac_f32_16x16x64_bf16 v[24:27], v[104:107], a[48:55], v0
  s_add_u32 s27, s27, 8192
  ds_read_b64_tr_b16 v[70:71], v6 offset:24640
  ds_read_b64_tr_b16 v[72:73], v6 offset:24832
  v_smfmac_f32_16x16x64_bf16 v[24:27], v[108:111], a[56:63], v0
  s_add_u32 s28, s28, 8192
  ds_read_b64_tr_b16 v[74:75], v6 offset:24896
  ds_read_b64_tr_b16 v[76:77], v6 offset:25088
  v_smfmac_f32_16x16x64_bf16 v[24:27], v[112:115], a[96:103], v0
  s_nop 0
  ds_read_b64_tr_b16 v[78:79], v6 offset:25152
  ds_read_b64_tr_b16 v[80:81], v6 offset:25344
  v_smfmac_f32_16x16x64_bf16 v[24:27], v[84:87], a[104:111], v0
  ds_read_b64_tr_b16 v[82:83], v6 offset:25408
  v_mov_b64 v[96:97], 0
  v_smfmac_f32_16x16x64_bf16 v[24:27], v[88:91], a[144:151], v0
  s_waitcnt lgkmcnt(8)
  s_barrier
  ds_read_b64_tr_b16 v[116:117], v6 offset:26880
  v_smfmac_f32_16x16x64_bf16 v[24:27], v[100:103], a[152:159], v0
  s_waitcnt lgkmcnt(7)
  ds_read_b64_tr_b16 v[118:119], v6 offset:26944
  v_mfma_f32_16x16x32_bf16 v[16:19], v[36:39], v[68:71], 0
  s_waitcnt lgkmcnt(6)
  ds_read_b64_tr_b16 v[124:125], v6 offset:27136
  ds_read_b64_tr_b16 v[126:127], v6 offset:27200
  v_mfma_f32_16x16x32_bf16 v[16:19], v[40:43], v[72:75], v[16:19]
  s_waitcnt lgkmcnt(6)
  ds_read_b64_tr_b16 v[104:105], v6 offset:27392
  ds_read_b64_tr_b16 v[106:107], v6 offset:27456
  v_mfma_f32_16x16x32_bf16 v[16:19], v[44:47], v[76:79], v[16:19]
  s_waitcnt lgkmcnt(6)
  ds_read_b64_tr_b16 v[108:109], v6 offset:27648
  ds_read_b64_tr_b16 v[110:111], v6 offset:27712
  v_mfma_f32_16x16x32_bf16 v[16:19], v[48:51], v[80:83], v[16:19]
  s_waitcnt lgkmcnt(6)
  v_cvt_pk_bf16_f32 v120, v24, v25
  v_cvt_pk_bf16_f32 v121, v26, v27
  v_mfma_f32_16x16x32_bf16 v[112:115], v[116:119], v[68:71], 0
  s_waitcnt lgkmcnt(4)
  v_mov_b64 v[98:99], 0
  v_mfma_f32_16x16x32_bf16 v[112:115], v[124:127], v[72:75], v[112:115]
  s_waitcnt lgkmcnt(2)
  buffer_store_dwordx4 v[120:123], v2, s[4:7], s29 offen offset:1024 sc1
  v_mov_b64 v[36:37], 0
  v_exp_f32 v100, v16
  v_mfma_f32_16x16x32_bf16 v[112:115], v[104:107], v[76:79], v[112:115]
  s_waitcnt lgkmcnt(0)
  v_exp_f32 v101, v17
  v_mfma_f32_16x16x32_bf16 v[112:115], v[108:111], v[80:83], v[112:115]
  v_exp_f32 v102, v18
  v_mfma_f32_16x16x32_bf16 v[20:23], v[52:55], v[68:71], 0
  s_cmp_eq_u32 s14, 63
  v_exp_f32 v103, v19
  v_mfma_f32_16x16x32_bf16 v[20:23], v[56:59], v[72:75], v[20:23]
  s_cbranch_scc1 M_tdone
  v_cvt_pk_bf16_f32 v44, v100, v101
  v_cvt_pk_bf16_f32 v45, v102, v103
  v_mfma_f32_16x16x32_bf16 v[20:23], v[60:63], v[76:79], v[20:23]
  s_add_u32 s29, s29, 131072
  v_exp_f32 v100, v112
  v_mfma_f32_16x16x32_bf16 v[20:23], v[64:67], v[80:83], v[20:23]
  v_exp_f32 v101, v113
  v_exp_f32 v102, v114
  v_exp_f32 v103, v115
  v_cvt_pk_bf16_f32 v84, v100, v101
  v_cvt_pk_bf16_f32 v85, v102, v103
  v_cndmask_b32 v48, v84, 0, s[16:17]
  v_cndmask_b32 v49, v85, 0, s[16:17]
  v_cndmask_b32 v50, 0, v84, s[16:17]
  v_cndmask_b32 v51, 0, v85, s[16:17]
  v_exp_f32 v100, v20
  v_mfma_f32_16x16x16_bf16 v[88:91], v[12:13], v[48:49], 0
  v_exp_f32 v101, v21
  v_mfma_f32_16x16x16_bf16 v[24:27], v[120:121], v[48:49], 0
  v_exp_f32 v102, v22
  v_mfma_f32_16x16x16_bf16 v[116:119], v[120:121], v[50:51], 0
  v_exp_f32 v103, v23
  v_cvt_pk_bf16_f32 v46, v100, v101
  v_cvt_pk_bf16_f32 v47, v102, v103
  v_mov_b64 v[38:39], 0
  s_nop 0
  v_mfma_f32_16x16x32_bf16 v[88:91], v[12:15], v[44:47], v[88:91]
  v_mov_b64 v[40:41], 0
  v_mov_b64 v[42:43], 0
  v_mfma_f32_16x16x32_bf16 v[24:27], v[28:31], v[44:47], v[24:27]
  ds_read_b128 v[52:55], v4 offset:24576
  ds_read_b128 v[56:59], v4 offset:25600
  v_mfma_f32_16x16x32_bf16 v[116:119], v[32:35], v[44:47], v[116:119]
  s_nop 1
  v_rcp_f32 v89, v88
  v_subrev_u32 v100, s54, v88
  v_cmp_le_u32 vcc, s55, v100
  v_mul_f32 v24, v89, v24
  v_mul_f32 v25, v89, v25
  s_cbranch_vccnz T_slow_95
T_back_96:
  v_cvt_pk_bf16_f32 v124, v24, v25
  v_pk_mul_f32 v[26:27], v[26:27], v[88:89] op_sel:[0,1] op_sel_hi:[1,1]
  v_pk_mul_f32 v[116:117], v[116:117], v[88:89] op_sel:[0,1] op_sel_hi:[1,1]
  v_pk_mul_f32 v[118:119], v[118:119], v[88:89] op_sel:[0,1] op_sel_hi:[1,1]
  v_cvt_pk_bf16_f32 v125, v26, v27
  v_cvt_pk_bf16_f32 v126, v116, v117
  v_cvt_pk_bf16_f32 v127, v118, v119
  ds_write_b128 v11, v[124:127] offset:29696
  s_nop 0
  v_smfmac_f32_16x16x64_bf16 v[92:95], v[124:127], a[160:167], v0
  v_smfmac_f32_16x16x64_bf16 v[96:99], v[124:127], a[168:175], v0
  v_smfmac_f32_16x16x64_bf16 v[36:39], v[124:127], a[176:183], v0
  v_smfmac_f32_16x16x64_bf16 v[40:43], v[124:127], a[184:191], v0
  s_waitcnt lgkmcnt(0)
  s_barrier
  ds_read_b128 v[104:107], v11 offset:29184
  ds_read_b128 v[108:111], v11 offset:30720
  ds_read_b128 v[68:71], v11 offset:30208
  s_waitcnt lgkmcnt(2)
  v_smfmac_f32_16x16x64_bf16 v[92:95], v[104:107], a[192:199], v0
  s_waitcnt lgkmcnt(1)
  ds_read_b128 v[76:79], v4 offset:28672
  v_smfmac_f32_16x16x64_bf16 v[92:95], v[108:111], a[224:231], v0
  s_waitcnt lgkmcnt(1)
  ds_read_b128 v[80:83], v4 offset:29696
  v_smfmac_f32_16x16x64_bf16 v[92:95], v[68:71], a[240:247], v0
  ds_read_b128 v[60:63], v4 offset:26624
  v_smfmac_f32_16x16x64_bf16 v[96:99], v[104:107], a[200:207], v0
  ds_read_b128 v[64:67], v4 offset:27648
  v_smfmac_f32_16x16x64_bf16 v[96:99], v[108:111], a[232:239], v0
  ds_read_b128 v[28:31], v4 offset:30720
  s_nop 0
  v_cvt_pk_bf16_f32 v16, v92, v93
  v_cvt_pk_bf16_f32 v17, v94, v95
  v_bfi_b32 v16, 1, s57, v16
  v_smfmac_f32_16x16x64_bf16 v[96:99], v[68:71], a[248:255], v0
  buffer_store_dwordx2 v[16:17], v7, s[4:7], s20 offen offset:0 sc1
  v_smfmac_f32_16x16x64_bf16 v[36:39], v[104:107], a[208:215], v0
  ds_read_b128 v[32:35], v4 offset:31744
  v_smfmac_f32_16x16x64_bf16 v[36:39], v[108:111], v[52:59], v0
  s_waitcnt lgkmcnt(4)
  s_nop 0
  v_cvt_pk_bf16_f32 v18, v96, v97
  v_cvt_pk_bf16_f32 v19, v98, v99
  v_bfi_b32 v18, 1, s57, v18
  v_smfmac_f32_16x16x64_bf16 v[36:39], v[68:71], v[76:83], v0
  buffer_store_dwordx2 v[18:19], v7, s[4:7], s20 offen offset:64 sc1
  v_smfmac_f32_16x16x64_bf16 v[40:43], v[104:107], a[216:223], v0
  s_waitcnt lgkmcnt(2)
  ds_read_b128 v[116:119], v2 offset:31232
  v_smfmac_f32_16x16x64_bf16 v[40:43], v[108:111], v[60:67], v0
  s_waitcnt lgkmcnt(1)
  s_nop 0
  v_cvt_pk_bf16_f32 v20, v36, v37
  v_cvt_pk_bf16_f32 v21, v38, v39
  v_bfi_b32 v20, 1, s57, v20
  v_smfmac_f32_16x16x64_bf16 v[40:43], v[68:71], v[28:35], v0
  buffer_store_dwordx2 v[20:21], v7, s[4:7], s21 offen offset:0 sc1
  s_nop 6
  v_cvt_pk_bf16_f32 v22, v40, v41
  v_cvt_pk_bf16_f32 v23, v42, v43
  v_bfi_b32 v22, 1, s57, v22
  buffer_store_dwordx2 v[22:23], v7, s[4:7], s21 offen offset:64 sc1
  ds_read_b128 v[68:71], v4 offset:0
  ds_read_b128 v[72:75], v4 offset:1024
  ds_read_b128 v[76:79], v4 offset:4096
  ds_read_b128 v[80:83], v4 offset:5120
  ds_read_b128 v[84:87], v4 offset:8192
  ds_read_b128 v[88:91], v4 offset:9216
  ds_read_b128 v[92:95], v4 offset:2048
  ds_read_b128 v[96:99], v4 offset:3072
  ds_read_b128 v[100:103], v4 offset:6144
  ds_read_b128 v[104:107], v4 offset:7168
  ds_read_b128 v[108:111], v4 offset:10240
  ds_read_b128 v[112:115], v4 offset:11264
  v_mov_b64 v[16:17], 0
  v_mov_b64 v[18:19], 0
  v_mov_b64 v[20:21], 0
  v_mov_b64 v[22:23], 0
  v_mov_b64 v[24:25], 0
  v_mov_b64 v[26:27], 0
  s_mov_b32 s19, 0
  v_mov_b32 v49, -1
  ds_read_b64 v[44:45], v2 offset:32256
  s_waitcnt lgkmcnt(0)
  v_readfirstlane_b32 s38, v44
  v_readfirstlane_b32 s37, v45
  s_nop 0
  s_lshl_b32 s38, s38, 1
  s_lshl1_add_u32 s37, s37, 1
  s_min_u32 s38, s38, s37
  s_cmp_ge_u32 s38, 64
  s_cselect_b32 s38, 100, s38
  s_sub_u32 s38, s38, 1
  s_max_i32 s30, s30, s38
  s_waitcnt vmcnt(0)
  buffer_load_dwordx4 v[52:55], v2, s[4:7], s22 offen offset:0 sc1
  buffer_load_dwordx4 v[56:59], v2, s[4:7], s22 offen offset:1024 sc1
  buffer_load_dwordx4 v[60:63], v2, s[4:7], s22 offen offset:2048 sc1
  buffer_load_dwordx4 v[64:67], v2, s[4:7], s22 offen offset:3072 sc1
  s_waitcnt lgkmcnt(12)
  s_waitcnt vmcnt(3)
  v_mfma_f32_16x16x32_bf16 v[120:123], v[116:119], v[52:55], 0
  v_xor_b32 v48, s57, v52
  v_bitop3_b32 v48, v48, v54, s57 bitop3:0xf6
  s_waitcnt vmcnt(2)
  v_mfma_f32_16x16x32_bf16 v[120:123], v[116:119], v[56:59], v[120:123]
  v_bitop3_b32 v48, v48, v56, s57 bitop3:0xf6
  v_bitop3_b32 v48, v48, v58, s57 bitop3:0xf6
  s_waitcnt vmcnt(1)
  v_mfma_f32_16x16x32_bf16 v[120:123], v[116:119], v[60:63], v[120:123]
  v_bitop3_b32 v48, v48, v60, s57 bitop3:0xf6
  v_bitop3_b32 v48, v48, v62, s57 bitop3:0xf6
  s_waitcnt vmcnt(0)
  v_mfma_f32_16x16x32_bf16 v[120:123], v[116:119], v[64:67], v[120:123]
  v_bitop3_b32 v48, v48, v64, s57 bitop3:0xf6
  v_bitop3_b32 v48, v48, v66, s57 bitop3:0xf6
  v_and_b32 v48, 1, v48
  v_cmp_ne_u32 vcc, 0, v48
  s_cbranch_vccnz T_p1re_98
T_p1ok_99:
  s_nop 2
  v_add_f32_dpp v120, v120, v120 row_ror:8 row_mask:0xf bank_mask:0xf
  v_add_f32_dpp v121, v121, v121 row_ror:8 row_mask:0xf bank_mask:0xf
  v_cvt_pk_bf16_f32 v48, v120, v121
  buffer_store_dword v48, v8, s[4:7], s35 offen sc1
  buffer_store_dword v49, v8, s[4:7], s26 offen sc1
  s_barrier
  ds_read_b128 v[28:31], v2 offset:17408
  ds_read_b128 v[32:35], v2 offset:21504
  ds_read_b128 v[36:39], v2 offset:8192
  ds_read_b128 v[40:43], v2 offset:9216
  ds_read_b128 v[44:47], v2 offset:10240
  ds_read_b128 v[48:51], v2 offset:11264
  buffer_load_dwordx4 v[124:127], v2, s[4:7], s24 offen offset:1024 sc1
  buffer_load_dwordx4 v[116:119], v2, s[4:7], s25 offen offset:1024 sc1
  ds_read_b128 v[52:55], v2 offset:12288
  ds_read_b128 v[56:59], v2 offset:13312
  ds_read_b128 v[60:63], v2 offset:14336
  ds_read_b128 v[64:67], v2 offset:15360
  buffer_load_dwordx4 v[124:127], v2, s[4:7], s24 offen offset:1024 sc1
  buffer_load_dwordx4 v[116:119], v2, s[4:7], s25 offen offset:1024 sc1
  s_mov_b32 s19, 0
  s_branch T_loop_88
T_p1re_98:
  s_mov_b64 exec, vcc
  buffer_load_dwordx4 v[52:55], v2, s[4:7], s22 offen offset:0 sc1
  buffer_load_dwordx4 v[56:59], v2, s[4:7], s22 offen offset:1024 sc1
  buffer_load_dwordx4 v[60:63], v2, s[4:7], s22 offen offset:2048 sc1
  buffer_load_dwordx4 v[64:67], v2, s[4:7], s22 offen offset:3072 sc1
  s_mov_b64 exec, -1
  s_add_u32 s19, s19, 1
  s_cmp_gt_u32 s19, 32768
  s_cbranch_scc1 M_exit
  s_waitcnt vmcnt(3)
  v_mfma_f32_16x16x32_bf16 v[120:123], v[116:119], v[52:55], 0
  v_xor_b32 v48, s57, v52
  v_bitop3_b32 v48, v48, v54, s57 bitop3:0xf6
  s_waitcnt vmcnt(2)
  v_mfma_f32_16x16x32_bf16 v[120:123], v[116:119], v[56:59], v[120:123]
  v_bitop3_b32 v48, v48, v56, s57 bitop3:0xf6
  v_bitop3_b32 v48, v48, v58, s57 bitop3:0xf6
  s_waitcnt vmcnt(1)
  v_mfma_f32_16x16x32_bf16 v[120:123], v[116:119], v[60:63], v[120:123]
  v_bitop3_b32 v48, v48, v60, s57 bitop3:0xf6
  v_bitop3_b32 v48, v48, v62, s57 bitop3:0xf6
  s_waitcnt vmcnt(0)
  v_mfma_f32_16x16x32_bf16 v[120:123], v[116:119], v[64:67], v[120:123]
  v_bitop3_b32 v48, v48, v64, s57 bitop3:0xf6
  v_bitop3_b32 v48, v48, v66, s57 bitop3:0xf6
  v_and_b32 v48, 1, v48
  v_cmp_ne_u32 vcc, 0, v48
  s_cbranch_vccnz T_p1re_98
  s_branch T_p1ok_99
T_kvw_92:
  s_mov_b32 s19, 0
  s_branch T_kvok_101
T_kv_100:
  s_sleep 4
  s_add_u32 s19, s19, 1
  s_cmp_gt_u32 s19, 32768
  s_cbranch_scc1 M_exit
T_kvok_101:
  s_add_u32 s39, s99, 128
  s_mov_b32 s38, 0
  s_mov_b32 s37, 0
  s_atomic_or s38, s[58:59], s99 glc
  s_atomic_or s37, s[58:59], s39 glc
  s_waitcnt lgkmcnt(0)
  s_lshl_b32 s38, s38, 1
  s_lshl1_add_u32 s37, s37, 1
  s_min_u32 s38, s38, s37
  s_cmp_ge_u32 s38, 64
  s_cselect_b32 s38, 100, s38
  s_sub_u32 s38, s38, 1
  s_max_i32 s30, s30, s38
  s_cmp_ge_i32 s14, s30
  s_cbranch_scc1 T_kv_100
  s_branch T_kvb_93
T_slow_95:
  s_nop 7
  v_max3_f32 v100, v16, v17, v18
  v_max3_f32 v100, v100, v19, v20
  v_max3_f32 v100, v100, v21, v22
  v_max3_f32 v100, v100, v23, v112
  v_max3_f32 v100, v100, v113, v114
  v_max_f32 v100, v100, v115
  v_mov_b32 v101, v100
  s_nop 1
  v_permlane32_swap_b32 v100, v101
  s_nop 1
  v_max_f32 v100, v100, v101
  v_mov_b32 v101, v100
  s_nop 1
  v_permlane16_swap_b32 v100, v101
  s_nop 1
  v_max_f32 v100, v100, v101
  v_sub_f32 v16, v16, v100
  v_sub_f32 v17, v17, v100
  v_sub_f32 v18, v18, v100
  v_sub_f32 v19, v19, v100
  v_exp_f32 v16, v16
  v_exp_f32 v17, v17
  v_exp_f32 v18, v18
  v_exp_f32 v19, v19
  v_sub_f32 v20, v20, v100
  v_sub_f32 v21, v21, v100
  v_sub_f32 v22, v22, v100
  v_sub_f32 v23, v23, v100
  v_exp_f32 v20, v20
  v_exp_f32 v21, v21
  v_exp_f32 v22, v22
  v_exp_f32 v23, v23
  v_sub_f32 v112, v112, v100
  v_sub_f32 v113, v113, v100
  v_sub_f32 v114, v114, v100
  v_sub_f32 v115, v115, v100
  v_exp_f32 v112, v112
  v_exp_f32 v113, v113
  v_exp_f32 v114, v114
  v_exp_f32 v115, v115
  s_nop 0
  v_cvt_pk_bf16_f32 v44, v16, v17
  v_cvt_pk_bf16_f32 v45, v18, v19
  v_cvt_pk_bf16_f32 v46, v20, v21
  v_cvt_pk_bf16_f32 v47, v22, v23
  v_cvt_pk_bf16_f32 v84, v112, v113
  v_cvt_pk_bf16_f32 v85, v114, v115
  v_cndmask_b32 v48, v84, 0, s[16:17]
  v_cndmask_b32 v49, v85, 0, s[16:17]
  v_cndmask_b32 v50, 0, v84, s[16:17]
  v_cndmask_b32 v51, 0, v85, s[16:17]
  s_nop 1
  v_mfma_f32_16x16x16_bf16 v[88:91], v[12:13], v[48:49], 0
  v_mfma_f32_16x16x16_bf16 v[24:27], v[120:121], v[48:49], 0
  v_mfma_f32_16x16x16_bf16 v[116:119], v[120:121], v[50:51], 0
  v_mfma_f32_16x16x32_bf16 v[88:91], v[12:15], v[44:47], v[88:91]
  v_mfma_f32_16x16x32_bf16 v[24:27], v[28:31], v[44:47], v[24:27]
  v_mfma_f32_16x16x32_bf16 v[116:119], v[32:35], v[44:47], v[116:119]
  s_nop 7
  s_nop 1
  v_rcp_f32 v89, v88
  s_nop 0
  v_mul_f32 v24, v89, v24
  v_mul_f32 v25, v89, v25
  s_branch T_back_96
T_w_72:
  s_mov_b32 s19, 0
  v_mov_b64 v[16:17], 0
  v_mov_b64 v[18:19], 0
  v_mov_b64 v[20:21], 0
  v_mov_b64 v[22:23], 0
  v_mov_b64 v[24:25], 0
  v_mov_b64 v[26:27], 0
  buffer_load_dwordx4 v[124:127], v2, s[4:7], s24 offen offset:2048 sc1
  buffer_load_dwordx4 v[116:119], v2, s[4:7], s25 offen offset:2048 sc1
  buffer_load_dwordx4 v[124:127], v2, s[4:7], s24 offen offset:2048 sc1
  buffer_load_dwordx4 v[116:119], v2, s[4:7], s25 offen offset:2048 sc1
  s_branch T_loop_102
.p2align 6
T_retry_103:
  s_mov_b64 exec, vcc
  buffer_load_dwordx4 v[124:127], v2, s[4:7], s24 offen offset:2048 sc1
  buffer_load_dwordx4 v[116:119], v2, s[4:7], s25 offen offset:2048 sc1
  s_mov_b64 exec, -1
  s_add_u32 s19, s19, 1
  s_cmp_gt_u32 s19, 32768
  s_cbranch_scc1 M_exit
T_loop_102:
  s_waitcnt vmcnt(3) lgkmcnt(0)
  v_max3_u32 v123, v124, v125, v126
  v_max_u32 v123, v123, v127
  v_mov_b32_dpp v120, v124 row_ror:8 row_mask:0xf bank_mask:0xf
  v_mov_b32_dpp v121, v125 row_ror:8 row_mask:0xf bank_mask:0xf
  s_waitcnt vmcnt(2)
  v_max3_u32 v123, v123, v116, v117
  v_max3_u32 v123, v123, v118, v119
  v_cmp_eq_u32 vcc, -1, v123
  s_cbranch_vccnz T_retry_103
  v_smfmac_f32_16x16x64_bf16 v[16:19], v[124:127], v[68:75], v0
  s_add_u32 s14, s14, 1
  ds_write_b128 v2, v[124:127] offset:2048
  v_mov_b32_dpp v122, v126 row_ror:8 row_mask:0xf bank_mask:0xf
  v_smfmac_f32_16x16x64_bf16 v[20:23], v[124:127], v[76:83], v0
  s_and_b32 s57, s14, 1
  v_mov_b32_dpp v123, v127 row_ror:8 row_mask:0xf bank_mask:0xf
  v_smfmac_f32_16x16x64_bf16 v[24:27], v[124:127], v[84:91], v0
  s_and_b32 s36, s14, 3
  ds_write_b128 v2, v[116:119] offset:6144
  v_smfmac_f32_16x16x64_bf16 v[16:19], v[120:123], v[92:99], v0
  s_lshl_b32 s36, s36, 13
  v_mov_b32_dpp v84, v116 row_ror:8 row_mask:0xf bank_mask:0xf
  v_smfmac_f32_16x16x64_bf16 v[20:23], v[120:123], v[100:107], v0
  s_add_u32 s26, s36, s23
  ds_read_b128 v[68:71], v4 offset:12288
  v_mov_b32_dpp v85, v117 row_ror:8 row_mask:0xf bank_mask:0xf
  v_smfmac_f32_16x16x64_bf16 v[24:27], v[120:123], v[108:115], v0
  s_add_u32 s36, s36, 8192
  ds_read_b128 v[72:75], v4 offset:13312
  v_mov_b32_dpp v86, v118 row_ror:8 row_mask:0xf bank_mask:0xf
  v_smfmac_f32_16x16x64_bf16 v[16:19], v[116:119], v[224:231], v0
  s_and_b32 s36, s36, 0x7fff
  ds_read_b128 v[76:79], v4 offset:14336
  v_mov_b32_dpp v87, v119 row_ror:8 row_mask:0xf bank_mask:0xf
  v_smfmac_f32_16x16x64_bf16 v[20:23], v[116:119], v[240:247], v0
  s_waitcnt lgkmcnt(3)
  s_barrier
  ds_read_b128 v[100:103], v2 offset:3072
  v_smfmac_f32_16x16x64_bf16 v[24:27], v[116:119], a[0:7], v0
  s_mov_b32 m0, s31
  ds_read_b128 v[120:123], v1 offset:3072
  v_smfmac_f32_16x16x64_bf16 v[16:19], v[84:87], v[232:239], v0
  s_cmp_ge_i32 s14, s30
  s_cbranch_scc1 T_kvw_106
T_kvb_107:
  v_smfmac_f32_16x16x64_bf16 v[20:23], v[84:87], v[248:255], v0
  ds_read_b128 v[80:83], v4 offset:15360
  v_smfmac_f32_16x16x64_bf16 v[24:27], v[84:87], a[8:15], v0
  s_waitcnt lgkmcnt(2)
  v_smfmac_f32_16x16x64_bf16 v[16:19], v[100:103], v[128:135], v0
  ds_read_b128 v[92:95], v2 offset:0
  buffer_load_dwordx4 v9, s[4:7], s27 offen sc1 lds
  v_smfmac_f32_16x16x64_bf16 v[20:23], v[100:103], v[144:151], v0
  ds_read_b128 v[96:99], v1 offset:0
  s_mov_b32 m0, s32
  v_smfmac_f32_16x16x64_bf16 v[24:27], v[100:103], v[68:75], v0
  s_waitcnt vmcnt(1) lgkmcnt(3)
  ds_read_b128 v[116:119], v2 offset:1024
  v_smfmac_f32_16x16x64_bf16 v[16:19], v[120:123], v[136:143], v0
  ds_read_b128 v[124:127], v1 offset:1024
  v_smfmac_f32_16x16x64_bf16 v[20:23], v[120:123], v[152:159], v0
  s_waitcnt lgkmcnt(4)
  ds_read_b128 v[104:107], v2 offset:7168
  buffer_load_dwordx4 v9, s[4:7], s27 offen offset:128 sc1 lds
  v_smfmac_f32_16x16x64_bf16 v[24:27], v[120:123], v[76:83], v0
  s_waitcnt lgkmcnt(4)
  ds_read_b128 v[108:111], v1 offset:7168
  s_mov_b32 m0, s33
  v_smfmac_f32_16x16x64_bf16 v[16:19], v[92:95], v[160:167], v0
  s_waitcnt lgkmcnt(4)
  ds_read_b128 v[112:115], v2 offset:4096
  v_mov_b32 v122, s98
  v_smfmac_f32_16x16x64_bf16 v[16:19], v[96:99], v[168:175], v0
  s_waitcnt lgkmcnt(4)
  ds_read_b128 v[84:87], v1 offset:4096
  v_smfmac_f32_16x16x64_bf16 v[16:19], v[116:119], v[192:199], v0
  s_waitcnt lgkmcnt(4)
  ds_read_b128 v[88:91], v2 offset:5120
  buffer_load_dwordx4 v10, s[4:7], s28 offen sc1 lds
  v_smfmac_f32_16x16x64_bf16 v[16:19], v[124:127], v[200:207], v0
  s_waitcnt lgkmcnt(4)
  ds_read_b128 v[100:103], v1 offset:5120
  s_mov_b32 m0, s34
  v_smfmac_f32_16x16x64_bf16 v[16:19], v[104:107], a[16:23], v0
  s_waitcnt lgkmcnt(4)
  ds_read_b128 v[68:71], v4 offset:16384
  v_smfmac_f32_16x16x64_bf16 v[16:19], v[108:111], a[24:31], v0
  s_waitcnt lgkmcnt(4)
  ds_read_b128 v[72:75], v4 offset:17408
  v_smfmac_f32_16x16x64_bf16 v[16:19], v[112:115], a[64:71], v0
  s_waitcnt lgkmcnt(4)
  ds_read_b128 v[76:79], v4 offset:18432
  buffer_load_dwordx4 v10, s[4:7], s28 offen offset:256 sc1 lds
  v_smfmac_f32_16x16x64_bf16 v[16:19], v[84:87], a[72:79], v0
  s_waitcnt lgkmcnt(4)
  ds_read_b128 v[80:83], v4 offset:19456
  v_smfmac_f32_16x16x64_bf16 v[16:19], v[88:91], a[112:119], v0
  s_waitcnt lgkmcnt(4)
  v_smfmac_f32_16x16x64_bf16 v[16:19], v[100:103], a[120:127], v0
  s_add_u32 s24, s36, 145752064
  s_add_u32 s25, s36, 145756160
  v_smfmac_f32_16x16x64_bf16 v[20:23], v[92:95], v[176:183], v0
  buffer_store_dword v122, v3, s[4:7], s15 offen sc1
  s_add_u32 s35, s36, s23
  v_smfmac_f32_16x16x64_bf16 v[20:23], v[96:99], v[184:191], v0
  s_waitcnt lgkmcnt(2)
  s_add_u32 s98, s14, 1
  v_smfmac_f32_16x16x64_bf16 v[20:23], v[116:119], v[68:75], v0
  s_waitcnt lgkmcnt(0)
  ds_read_b128 v[68:71], v4 offset:20480
  v_mul_f32 v16, s18, v16
  v_smfmac_f32_16x16x64_bf16 v[20:23], v[124:127], v[76:83], v0
  ds_read_b128 v[72:75], v4 offset:21504
  v_mul_f32 v17, s18, v17
  v_smfmac_f32_16x16x64_bf16 v[20:23], v[104:107], a[32:39], v0
  ds_read_b128 v[76:79], v4 offset:22528
  v_mul_f32 v18, s18, v18
  v_smfmac_f32_16x16x64_bf16 v[20:23], v[108:111], a[40:47], v0
  ds_read_b128 v[80:83], v4 offset:23552
  v_mul_f32 v19, s18, v19
  v_smfmac_f32_16x16x64_bf16 v[20:23], v[112:115], a[80:87], v0
  v_cvt_pk_bf16_f32 v120, v16, v17
  v_smfmac_f32_16x16x64_bf16 v[20:23], v[84:87], a[88:95], v0
  v_cvt_pk_bf16_f32 v121, v18, v19
  v_smfmac_f32_16x16x64_bf16 v[20:23], v[88:91], a[128:135], v0
  ds_write_b64 v5, v[120:121] offset:24576
  v_smfmac_f32_16x16x64_bf16 v[20:23], v[100:103], a[136:143], v0
  s_waitcnt lgkmcnt(3)
  v_smfmac_f32_16x16x64_bf16 v[24:27], v[92:95], v[68:75], v0
  s_waitcnt lgkmcnt(1)
  v_mov_b64 v[92:93], 0
  v_smfmac_f32_16x16x64_bf16 v[24:27], v[96:99], v[76:83], v0
  s_nop 1
  v_cvt_pk_bf16_f32 v122, v20, v21
  v_cvt_pk_bf16_f32 v123, v22, v23
  v_smfmac_f32_16x16x64_bf16 v[24:27], v[116:119], v[208:215], v0
  ds_write_b64 v5, v[122:123] offset:26880
  v_mov_b64 v[94:95], 0
  v_smfmac_f32_16x16x64_bf16 v[24:27], v[124:127], v[216:223], v0
  s_waitcnt lgkmcnt(1)
  s_barrier
  ds_read_b64_tr_b16 v[68:69], v6 offset:24576
  v_smfmac_f32_16x16x64_bf16 v[24:27], v[104:107], a[48:55], v0
  s_add_u32 s27, s27, 8192
  ds_read_b64_tr_b16 v[70:71], v6 offset:24640
  ds_read_b64_tr_b16 v[72:73], v6 offset:24832
  v_smfmac_f32_16x16x64_bf16 v[24:27], v[108:111], a[56:63], v0
  s_add_u32 s28, s28, 8192
  ds_read_b64_tr_b16 v[74:75], v6 offset:24896
  ds_read_b64_tr_b16 v[76:77], v6 offset:25088
  v_smfmac_f32_16x16x64_bf16 v[24:27], v[112:115], a[96:103], v0
  s_nop 0
  ds_read_b64_tr_b16 v[78:79], v6 offset:25152
  ds_read_b64_tr_b16 v[80:81], v6 offset:25344
  v_smfmac_f32_16x16x64_bf16 v[24:27], v[84:87], a[104:111], v0
  ds_read_b64_tr_b16 v[82:83], v6 offset:25408
  v_mov_b64 v[96:97], 0
  v_smfmac_f32_16x16x64_bf16 v[24:27], v[88:91], a[144:151], v0
  s_waitcnt lgkmcnt(8)
  s_barrier
  ds_read_b64_tr_b16 v[116:117], v6 offset:26880
  v_smfmac_f32_16x16x64_bf16 v[24:27], v[100:103], a[152:159], v0
  s_waitcnt lgkmcnt(7)
  ds_read_b64_tr_b16 v[118:119], v6 offset:26944
  v_mfma_f32_16x16x32_bf16 v[16:19], v[36:39], v[68:71], 0
  s_waitcnt lgkmcnt(6)
  ds_read_b64_tr_b16 v[124:125], v6 offset:27136
  ds_read_b64_tr_b16 v[126:127], v6 offset:27200
  v_mfma_f32_16x16x32_bf16 v[16:19], v[40:43], v[72:75], v[16:19]
  s_waitcnt lgkmcnt(6)
  ds_read_b64_tr_b16 v[104:105], v6 offset:27392
  ds_read_b64_tr_b16 v[106:107], v6 offset:27456
  v_mfma_f32_16x16x32_bf16 v[16:19], v[44:47], v[76:79], v[16:19]
  s_waitcnt lgkmcnt(6)
  ds_read_b64_tr_b16 v[108:109], v6 offset:27648
  ds_read_b64_tr_b16 v[110:111], v6 offset:27712
  v_mfma_f32_16x16x32_bf16 v[16:19], v[48:51], v[80:83], v[16:19]
  s_waitcnt lgkmcnt(6)
  v_cvt_pk_bf16_f32 v120, v24, v25
  v_cvt_pk_bf16_f32 v121, v26, v27
  v_mfma_f32_16x16x32_bf16 v[112:115], v[116:119], v[68:71], 0
  s_waitcnt lgkmcnt(4)
  v_mov_b64 v[98:99], 0
  v_mfma_f32_16x16x32_bf16 v[112:115], v[124:127], v[72:75], v[112:115]
  s_waitcnt lgkmcnt(2)
  v_mov_b64 v[36:37], 0
  v_exp_f32 v100, v16
  v_mfma_f32_16x16x32_bf16 v[112:115], v[104:107], v[76:79], v[112:115]
  s_waitcnt lgkmcnt(0)
  buffer_store_dwordx4 v[120:123], v2, s[4:7], s29 offen offset:2048 sc1
  v_exp_f32 v101, v17
  v_mfma_f32_16x16x32_bf16 v[112:115], v[108:111], v[80:83], v[112:115]
  v_exp_f32 v102, v18
  v_mfma_f32_16x16x32_bf16 v[20:23], v[52:55], v[68:71], 0
  s_cmp_eq_u32 s14, 63
  v_exp_f32 v103, v19
  v_mfma_f32_16x16x32_bf16 v[20:23], v[56:59], v[72:75], v[20:23]
  s_cbranch_scc1 M_tdone
  v_cvt_pk_bf16_f32 v44, v100, v101
  v_cvt_pk_bf16_f32 v45, v102, v103
  v_mfma_f32_16x16x32_bf16 v[20:23], v[60:63], v[76:79], v[20:23]
  s_add_u32 s29, s29, 131072
  v_exp_f32 v100, v112
  v_mfma_f32_16x16x32_bf16 v[20:23], v[64:67], v[80:83], v[20:23]
  v_exp_f32 v101, v113
  v_exp_f32 v102, v114
  v_exp_f32 v103, v115
  v_cvt_pk_bf16_f32 v84, v100, v101
  v_cvt_pk_bf16_f32 v85, v102, v103
  v_cndmask_b32 v48, v84, 0, s[16:17]
  v_cndmask_b32 v49, v85, 0, s[16:17]
  v_cndmask_b32 v50, 0, v84, s[16:17]
  v_cndmask_b32 v51, 0, v85, s[16:17]
  v_exp_f32 v100, v20
  v_mfma_f32_16x16x16_bf16 v[88:91], v[12:13], v[48:49], 0
  v_exp_f32 v101, v21
  v_mfma_f32_16x16x16_bf16 v[24:27], v[120:121], v[48:49], 0
  v_exp_f32 v102, v22
  v_mfma_f32_16x16x16_bf16 v[116:119], v[120:121], v[50:51], 0
  v_exp_f32 v103, v23
  v_cvt_pk_bf16_f32 v46, v100, v101
  v_cvt_pk_bf16_f32 v47, v102, v103
  v_mov_b64 v[38:39], 0
  s_nop 0
  v_mfma_f32_16x16x32_bf16 v[88:91], v[12:15], v[44:47], v[88:91]
  v_mov_b64 v[40:41], 0
  v_mov_b64 v[42:43], 0
  v_mfma_f32_16x16x32_bf16 v[24:27], v[28:31], v[44:47], v[24:27]
  ds_read_b128 v[52:55], v4 offset:24576
  ds_read_b128 v[56:59], v4 offset:25600
  v_mfma_f32_16x16x32_bf16 v[116:119], v[32:35], v[44:47], v[116:119]
  s_nop 1
  v_rcp_f32 v89, v88
  v_subrev_u32 v100, s54, v88
  v_cmp_le_u32 vcc, s55, v100
  v_mul_f32 v24, v89, v24
  v_mul_f32 v25, v89, v25
  s_cbranch_vccnz T_slow_109
T_back_110:
  v_cvt_pk_bf16_f32 v124, v24, v25
  v_pk_mul_f32 v[26:27], v[26:27], v[88:89] op_sel:[0,1] op_sel_hi:[1,1]
  v_pk_mul_f32 v[116:117], v[116:117], v[88:89] op_sel:[0,1] op_sel_hi:[1,1]
  v_pk_mul_f32 v[118:119], v[118:119], v[88:89] op_sel:[0,1] op_sel_hi:[1,1]
  v_cvt_pk_bf16_f32 v125, v26, v27
  v_cvt_pk_bf16_f32 v126, v116, v117
  v_cvt_pk_bf16_f32 v127, v118, v119
  ds_write_b128 v11, v[124:127] offset:30208
  s_nop 0
  v_smfmac_f32_16x16x64_bf16 v[92:95], v[124:127], a[160:167], v0
  v_smfmac_f32_16x16x64_bf16 v[96:99], v[124:127], a[168:175], v0
  v_smfmac_f32_16x16x64_bf16 v[36:39], v[124:127], a[176:183], v0
  v_smfmac_f32_16x16x64_bf16 v[40:43], v[124:127], a[184:191], v0
  s_waitcnt lgkmcnt(0)
  s_barrier
  ds_read_b128 v[104:107], v11 offset:30720
  ds_read_b128 v[108:111], v11 offset:29184
  ds_read_b128 v[68:71], v11 offset:29696
  s_waitcnt lgkmcnt(2)
  v_smfmac_f32_16x16x64_bf16 v[92:95], v[104:107], a[192:199], v0
  s_waitcnt lgkmcnt(1)
  ds_read_b128 v[76:79], v4 offset:28672
  v_smfmac_f32_16x16x64_bf16 v[92:95], v[108:111], a[224:231], v0
  s_waitcnt lgkmcnt(1)
  ds_read_b128 v[80:83], v4 offset:29696
  v_smfmac_f32_16x16x64_bf16 v[92:95], v[68:71], a[240:247], v0
  ds_read_b128 v[60:63], v4 offset:26624
  v_smfmac_f32_16x16x64_bf16 v[96:99], v[104:107], a[200:207], v0
  ds_read_b128 v[64:67], v4 offset:27648
  v_smfmac_f32_16x16x64_bf16 v[96:99], v[108:111], a[232:239], v0
  ds_read_b128 v[28:31], v4 offset:30720
  s_nop 0
  v_cvt_pk_bf16_f32 v16, v92, v93
  v_cvt_pk_bf16_f32 v17, v94, v95
  v_bfi_b32 v16, 1, s57, v16
  v_smfmac_f32_16x16x64_bf16 v[96:99], v[68:71], a[248:255], v0
  buffer_store_dwordx2 v[16:17], v7, s[4:7], s20 offen offset:0 sc1
  v_smfmac_f32_16x16x64_bf16 v[36:39], v[104:107], a[208:215], v0
  ds_read_b128 v[32:35], v4 offset:31744
  v_smfmac_f32_16x16x64_bf16 v[36:39], v[108:111], v[52:59], v0
  s_waitcnt lgkmcnt(4)
  s_nop 0
  v_cvt_pk_bf16_f32 v18, v96, v97
  v_cvt_pk_bf16_f32 v19, v98, v99
  v_bfi_b32 v18, 1, s57, v18
  v_smfmac_f32_16x16x64_bf16 v[36:39], v[68:71], v[76:83], v0
  buffer_store_dwordx2 v[18:19], v7, s[4:7], s20 offen offset:64 sc1
  v_smfmac_f32_16x16x64_bf16 v[40:43], v[104:107], a[216:223], v0
  s_waitcnt lgkmcnt(2)
  v_smfmac_f32_16x16x64_bf16 v[40:43], v[108:111], v[60:67], v0
  s_waitcnt lgkmcnt(0)
  s_nop 0
  v_cvt_pk_bf16_f32 v20, v36, v37
  v_cvt_pk_bf16_f32 v21, v38, v39
  v_bfi_b32 v20, 1, s57, v20
  v_smfmac_f32_16x16x64_bf16 v[40:43], v[68:71], v[28:35], v0
  buffer_store_dwordx2 v[20:21], v7, s[4:7], s21 offen offset:0 sc1
  s_nop 6
  v_cvt_pk_bf16_f32 v22, v40, v41
  v_cvt_pk_bf16_f32 v23, v42, v43
  v_bfi_b32 v22, 1, s57, v22
  buffer_store_dwordx2 v[22:23], v7, s[4:7], s21 offen offset:64 sc1
  ds_read_b128 v[68:71], v4 offset:0
  ds_read_b128 v[72:75], v4 offset:1024
  ds_read_b128 v[76:79], v4 offset:4096
  ds_read_b128 v[80:83], v4 offset:5120
  ds_read_b128 v[84:87], v4 offset:8192
  ds_read_b128 v[88:91], v4 offset:9216
  ds_read_b128 v[92:95], v4 offset:2048
  ds_read_b128 v[96:99], v4 offset:3072
  ds_read_b128 v[100:103], v4 offset:6144
  ds_read_b128 v[104:107], v4 offset:7168
  ds_read_b128 v[108:111], v4 offset:10240
  ds_read_b128 v[112:115], v4 offset:11264
  v_mov_b64 v[16:17], 0
  v_mov_b64 v[18:19], 0
  v_mov_b64 v[20:21], 0
  v_mov_b64 v[22:23], 0
  v_mov_b64 v[24:25], 0
  v_mov_b64 v[26:27], 0
  ds_read_b64 v[44:45], v2 offset:32256
  s_waitcnt lgkmcnt(0)
  v_readfirstlane_b32 s38, v44
  v_readfirstlane_b32 s37, v45
  s_nop 0
  s_lshl_b32 s38, s38, 1
  s_lshl1_add_u32 s37, s37, 1
  s_min_u32 s38, s38, s37
  s_cmp_ge_u32 s38, 64
  s_cselect_b32 s38, 100, s38
  s_sub_u32 s38, s38, 1
  s_max_i32 s30, s30, s38
  s_waitcnt vmcnt(4)
  s_barrier
  ds_read_b128 v[28:31], v2 offset:18432
  ds_read_b128 v[32:35], v2 offset:22528
  ds_read_b128 v[36:39], v2 offset:8192
  ds_read_b128 v[40:43], v2 offset:9216
  ds_read_b128 v[44:47], v2 offset:10240
  ds_read_b128 v[48:51], v2 offset:11264
  buffer_load_dwordx4 v[124:127], v2, s[4:7], s24 offen offset:2048 sc1
  buffer_load_dwordx4 v[116:119], v2, s[4:7], s25 offen offset:2048 sc1
  ds_read_b128 v[52:55], v2 offset:12288
  ds_read_b128 v[56:59], v2 offset:13312
  ds_read_b128 v[60:63], v2 offset:14336
  ds_read_b128 v[64:67], v2 offset:15360
  buffer_load_dwordx4 v[124:127], v2, s[4:7], s24 offen offset:2048 sc1
  buffer_load_dwordx4 v[116:119], v2, s[4:7], s25 offen offset:2048 sc1
  s_mov_b32 s19, 0
  s_branch T_loop_102
T_kvw_106:
  s_mov_b32 s19, 0
  s_branch T_kvok_115
T_kv_114:
  s_sleep 4
  s_add_u32 s19, s19, 1
  s_cmp_gt_u32 s19, 32768
  s_cbranch_scc1 M_exit
T_kvok_115:
  s_add_u32 s39, s99, 128
  s_mov_b32 s38, 0
  s_mov_b32 s37, 0
  s_atomic_or s38, s[58:59], s99 glc
  s_atomic_or s37, s[58:59], s39 glc
  s_waitcnt lgkmcnt(0)
  s_lshl_b32 s38, s38, 1
  s_lshl1_add_u32 s37, s37, 1
  s_min_u32 s38, s38, s37
  s_cmp_ge_u32 s38, 64
  s_cselect_b32 s38, 100, s38
  s_sub_u32 s38, s38, 1
  s_max_i32 s30, s30, s38
  s_cmp_ge_i32 s14, s30
  s_cbranch_scc1 T_kv_114
  s_branch T_kvb_107
T_slow_109:
  s_nop 7
  v_max3_f32 v100, v16, v17, v18
  v_max3_f32 v100, v100, v19, v20
  v_max3_f32 v100, v100, v21, v22
  v_max3_f32 v100, v100, v23, v112
  v_max3_f32 v100, v100, v113, v114
  v_max_f32 v100, v100, v115
  v_mov_b32 v101, v100
  s_nop 1
  v_permlane32_swap_b32 v100, v101
  s_nop 1
  v_max_f32 v100, v100, v101
  v_mov_b32 v101, v100
  s_nop 1
  v_permlane16_swap_b32 v100, v101
  s_nop 1
  v_max_f32 v100, v100, v101
  v_sub_f32 v16, v16, v100
  v_sub_f32 v17, v17, v100
  v_sub_f32 v18, v18, v100
  v_sub_f32 v19, v19, v100
  v_exp_f32 v16, v16
  v_exp_f32 v17, v17
  v_exp_f32 v18, v18
  v_exp_f32 v19, v19
  v_sub_f32 v20, v20, v100
  v_sub_f32 v21, v21, v100
  v_sub_f32 v22, v22, v100
  v_sub_f32 v23, v23, v100
  v_exp_f32 v20, v20
  v_exp_f32 v21, v21
  v_exp_f32 v22, v22
  v_exp_f32 v23, v23
  v_sub_f32 v112, v112, v100
  v_sub_f32 v113, v113, v100
  v_sub_f32 v114, v114, v100
  v_sub_f32 v115, v115, v100
  v_exp_f32 v112, v112
  v_exp_f32 v113, v113
  v_exp_f32 v114, v114
  v_exp_f32 v115, v115
  s_nop 0
  v_cvt_pk_bf16_f32 v44, v16, v17
  v_cvt_pk_bf16_f32 v45, v18, v19
  v_cvt_pk_bf16_f32 v46, v20, v21
  v_cvt_pk_bf16_f32 v47, v22, v23
  v_cvt_pk_bf16_f32 v84, v112, v113
  v_cvt_pk_bf16_f32 v85, v114, v115
  v_cndmask_b32 v48, v84, 0, s[16:17]
  v_cndmask_b32 v49, v85, 0, s[16:17]
  v_cndmask_b32 v50, 0, v84, s[16:17]
  v_cndmask_b32 v51, 0, v85, s[16:17]
  s_nop 1
  v_mfma_f32_16x16x16_bf16 v[88:91], v[12:13], v[48:49], 0
  v_mfma_f32_16x16x16_bf16 v[24:27], v[120:121], v[48:49], 0
  v_mfma_f32_16x16x16_bf16 v[116:119], v[120:121], v[50:51], 0
  v_mfma_f32_16x16x32_bf16 v[88:91], v[12:15], v[44:47], v[88:91]
  v_mfma_f32_16x16x32_bf16 v[24:27], v[28:31], v[44:47], v[24:27]
  v_mfma_f32_16x16x32_bf16 v[116:119], v[32:35], v[44:47], v[116:119]
  s_nop 7
  s_nop 1
  v_rcp_f32 v89, v88
  s_nop 0
  v_mul_f32 v24, v89, v24
  v_mul_f32 v25, v89, v25
  s_branch T_back_110
T_w_73:
  s_mov_b32 s19, 0
  v_mov_b64 v[16:17], 0
  v_mov_b64 v[18:19], 0
  v_mov_b64 v[20:21], 0
  v_mov_b64 v[22:23], 0
  v_mov_b64 v[24:25], 0
  v_mov_b64 v[26:27], 0
  buffer_load_dwordx4 v[124:127], v2, s[4:7], s24 offen offset:3072 sc1
  buffer_load_dwordx4 v[116:119], v2, s[4:7], s25 offen offset:3072 sc1
  buffer_load_dwordx4 v[124:127], v2, s[4:7], s24 offen offset:3072 sc1
  buffer_load_dwordx4 v[116:119], v2, s[4:7], s25 offen offset:3072 sc1
  s_branch T_loop_116
.p2align 6
T_retry_117:
  s_mov_b64 exec, vcc
  buffer_load_dwordx4 v[124:127], v2, s[4:7], s24 offen offset:3072 sc1
  buffer_load_dwordx4 v[116:119], v2, s[4:7], s25 offen offset:3072 sc1
  s_mov_b64 exec, -1
  s_add_u32 s19, s19, 1
  s_cmp_gt_u32 s19, 32768
  s_cbranch_scc1 M_exit
T_loop_116:
  s_waitcnt vmcnt(3) lgkmcnt(0)
  v_max3_u32 v123, v124, v125, v126
  v_max_u32 v123, v123, v127
  v_mov_b32_dpp v120, v124 row_ror:8 row_mask:0xf bank_mask:0xf
  v_mov_b32_dpp v121, v125 row_ror:8 row_mask:0xf bank_mask:0xf
  s_waitcnt vmcnt(2)
  v_max3_u32 v123, v123, v116, v117
  v_max3_u32 v123, v123, v118, v119
  v_cmp_eq_u32 vcc, -1, v123
  s_cbranch_vccnz T_retry_117
  v_smfmac_f32_16x16x64_bf16 v[16:19], v[124:127], v[68:75], v0
  s_add_u32 s14, s14, 1
  ds_write_b128 v2, v[124:127] offset:3072
  v_mov_b32_dpp v122, v126 row_ror:8 row_mask:0xf bank_mask:0xf
  v_smfmac_f32_16x16x64_bf16 v[20:23], v[124:127], v[76:83], v0
  s_and_b32 s57, s14, 1
  v_mov_b32_dpp v123, v127 row_ror:8 row_mask:0xf bank_mask:0xf
  v_smfmac_f32_16x16x64_bf16 v[24:27], v[124:127], v[84:91], v0
  s_and_b32 s36, s14, 3
  ds_write_b128 v2, v[116:119] offset:7168
  v_smfmac_f32_16x16x64_bf16 v[16:19], v[120:123], v[92:99], v0
  s_lshl_b32 s36, s36, 13
  v_mov_b32_dpp v84, v116 row_ror:8 row_mask:0xf bank_mask:0xf
  v_smfmac_f32_16x16x64_bf16 v[20:23], v[120:123], v[100:107], v0
  s_add_u32 s26, s36, s23
  ds_read_b128 v[68:71], v4 offset:12288
  v_mov_b32_dpp v85, v117 row_ror:8 row_mask:0xf bank_mask:0xf
  v_smfmac_f32_16x16x64_bf16 v[24:27], v[120:123], v[108:115], v0
  s_add_u32 s36, s36, 8192
  ds_read_b128 v[72:75], v4 offset:13312
  v_mov_b32_dpp v86, v118 row_ror:8 row_mask:0xf bank_mask:0xf
  v_smfmac_f32_16x16x64_bf16 v[16:19], v[116:119], v[224:231], v0
  s_and_b32 s36, s36, 0x7fff
  ds_read_b128 v[76:79], v4 offset:14336
  v_mov_b32_dpp v87, v119 row_ror:8 row_mask:0xf bank_mask:0xf
  v_smfmac_f32_16x16x64_bf16 v[20:23], v[116:119], v[240:247], v0
  s_waitcnt lgkmcnt(3)
  s_barrier
  ds_read_b128 v[100:103], v2 offset:2048
  v_smfmac_f32_16x16x64_bf16 v[24:27], v[116:119], a[0:7], v0
  s_mov_b32 m0, s31
  ds_read_b128 v[120:123], v1 offset:2048
  v_smfmac_f32_16x16x64_bf16 v[16:19], v[84:87], v[232:239], v0
  s_cmp_ge_i32 s14, s30
  s_cbranch_scc1 T_kvw_120
T_kvb_121:
  v_smfmac_f32_16x16x64_bf16 v[20:23], v[84:87], v[248:255], v0
  ds_read_b128 v[80:83], v4 offset:15360
  v_smfmac_f32_16x16x64_bf16 v[24:27], v[84:87], a[8:15], v0
  s_waitcnt lgkmcnt(2)
  v_smfmac_f32_16x16x64_bf16 v[16:19], v[100:103], v[128:135], v0
  ds_read_b128 v[92:95], v2 offset:1024
  v_smfmac_f32_16x16x64_bf16 v[20:23], v[100:103], v[144:151], v0
  ds_read_b128 v[96:99], v1 offset:1024
  buffer_load_dwordx4 v9, s[4:7], s27 offen sc1 lds
  v_smfmac_f32_16x16x64_bf16 v[24:27], v[100:103], v[68:75], v0
  s_waitcnt vmcnt(1) lgkmcnt(3)
  ds_read_b128 v[116:119], v2 offset:0
  s_mov_b32 m0, s32
  v_smfmac_f32_16x16x64_bf16 v[16:19], v[120:123], v[136:143], v0
  ds_read_b128 v[124:127], v1 offset:0
  v_smfmac_f32_16x16x64_bf16 v[20:23], v[120:123], v[152:159], v0
  s_waitcnt lgkmcnt(4)
  ds_read_b128 v[104:107], v2 offset:6144
  v_smfmac_f32_16x16x64_bf16 v[24:27], v[120:123], v[76:83], v0
  s_waitcnt lgkmcnt(4)
  ds_read_b128 v[108:111], v1 offset:6144
  buffer_load_dwordx4 v9, s[4:7], s27 offen offset:128 sc1 lds
  v_smfmac_f32_16x16x64_bf16 v[16:19], v[92:95], v[160:167], v0
  s_waitcnt lgkmcnt(4)
  ds_read_b128 v[112:115], v2 offset:5120
  s_mov_b32 m0, s33
  v_smfmac_f32_16x16x64_bf16 v[16:19], v[96:99], v[168:175], v0
  s_waitcnt lgkmcnt(4)
  ds_read_b128 v[84:87], v1 offset:5120
  v_smfmac_f32_16x16x64_bf16 v[16:19], v[116:119], v[192:199], v0
  s_waitcnt lgkmcnt(4)
  ds_read_b128 v[88:91], v2 offset:4096
  v_smfmac_f32_16x16x64_bf16 v[16:19], v[124:127], v[200:207], v0
  s_waitcnt lgkmcnt(4)
  ds_read_b128 v[100:103], v1 offset:4096
  buffer_load_dwordx4 v10, s[4:7], s28 offen sc1 lds
  v_smfmac_f32_16x16x64_bf16 v[16:19], v[104:107], a[16:23], v0
  s_waitcnt lgkmcnt(4)
  ds_read_b128 v[68:71], v4 offset:16384
  s_mov_b32 m0, s34
  v_smfmac_f32_16x16x64_bf16 v[16:19], v[108:111], a[24:31], v0
  s_waitcnt lgkmcnt(4)
  ds_read_b128 v[72:75], v4 offset:17408
  v_smfmac_f32_16x16x64_bf16 v[16:19], v[112:115], a[64:71], v0
  s_waitcnt lgkmcnt(4)
  ds_read_b128 v[76:79], v4 offset:18432
  v_smfmac_f32_16x16x64_bf16 v[16:19], v[84:87], a[72:79], v0
  s_waitcnt lgkmcnt(4)
  ds_read_b128 v[80:83], v4 offset:19456
  buffer_load_dwordx4 v10, s[4:7], s28 offen offset:256 sc1 lds
  v_smfmac_f32_16x16x64_bf16 v[16:19], v[88:91], a[112:119], v0
  s_waitcnt lgkmcnt(4)
  s_mov_b32 m0, 32256
  v_smfmac_f32_16x16x64_bf16 v[16:19], v[100:103], a[120:127], v0
  s_add_u32 s24, s36, 145752064
  s_add_u32 s25, s36, 145756160
  v_smfmac_f32_16x16x64_bf16 v[20:23], v[92:95], v[176:183], v0
  s_add_u32 s35, s36, s23
  v_smfmac_f32_16x16x64_bf16 v[20:23], v[96:99], v[184:191], v0
  s_waitcnt lgkmcnt(2)
  buffer_load_dword v3, s[4:7], s99 offen sc1 lds
  v_smfmac_f32_16x16x64_bf16 v[20:23], v[116:119], v[68:75], v0
  s_waitcnt lgkmcnt(0)
  ds_read_b128 v[68:71], v4 offset:20480
  v_mul_f32 v16, s18, v16
  v_smfmac_f32_16x16x64_bf16 v[20:23], v[124:127], v[76:83], v0
  ds_read_b128 v[72:75], v4 offset:21504
  v_mul_f32 v17, s18, v17
  v_smfmac_f32_16x16x64_bf16 v[20:23], v[104:107], a[32:39], v0
  ds_read_b128 v[76:79], v4 offset:22528
  v_mul_f32 v18, s18, v18
  v_smfmac_f32_16x16x64_bf16 v[20:23], v[108:111], a[40:47], v0
  ds_read_b128 v[80:83], v4 offset:23552
  v_mul_f32 v19, s18, v19
  v_smfmac_f32_16x16x64_bf16 v[20:23], v[112:115], a[80:87], v0
  v_cvt_pk_bf16_f32 v120, v16, v17
  v_smfmac_f32_16x16x64_bf16 v[20:23], v[84:87], a[88:95], v0
  v_cvt_pk_bf16_f32 v121, v18, v19
  v_smfmac_f32_16x16x64_bf16 v[20:23], v[88:91], a[128:135], v0
  ds_write_b64 v5, v[120:121] offset:24576
  v_smfmac_f32_16x16x64_bf16 v[20:23], v[100:103], a[136:143], v0
  s_waitcnt lgkmcnt(3)
  v_smfmac_f32_16x16x64_bf16 v[24:27], v[92:95], v[68:75], v0
  s_waitcnt lgkmcnt(1)
  v_mov_b64 v[92:93], 0
  v_smfmac_f32_16x16x64_bf16 v[24:27], v[96:99], v[76:83], v0
  s_nop 1
  v_cvt_pk_bf16_f32 v122, v20, v21
  v_cvt_pk_bf16_f32 v123, v22, v23
  v_smfmac_f32_16x16x64_bf16 v[24:27], v[116:119], v[208:215], v0
  ds_write_b64 v5, v[122:123] offset:26880
  v_mov_b64 v[94:95], 0
  v_smfmac_f32_16x16x64_bf16 v[24:27], v[124:127], v[216:223], v0
  s_waitcnt lgkmcnt(1)
  s_barrier
  ds_read_b64_tr_b16 v[68:69], v6 offset:24576
  v_smfmac_f32_16x16x64_bf16 v[24:27], v[104:107], a[48:55], v0
  s_add_u32 s27, s27, 8192
  ds_read_b64_tr_b16 v[70:71], v6 offset:24640
  ds_read_b64_tr_b16 v[72:73], v6 offset:24832
  v_smfmac_f32_16x16x64_bf16 v[24:27], v[108:111], a[56:63], v0
  s_add_u32 s28, s28, 8192
  ds_read_b64_tr_b16 v[74:75], v6 offset:24896
  ds_read_b64_tr_b16 v[76:77], v6 offset:25088
  v_smfmac_f32_16x16x64_bf16 v[24:27], v[112:115], a[96:103], v0
  s_nop 0
  ds_read_b64_tr_b16 v[78:79], v6 offset:25152
  ds_read_b64_tr_b16 v[80:81], v6 offset:25344
  v_smfmac_f32_16x16x64_bf16 v[24:27], v[84:87], a[104:111], v0
  ds_read_b64_tr_b16 v[82:83], v6 offset:25408
  v_mov_b64 v[96:97], 0
  v_smfmac_f32_16x16x64_bf16 v[24:27], v[88:91], a[144:151], v0
  s_waitcnt lgkmcnt(8)
  s_barrier
  ds_read_b64_tr_b16 v[116:117], v6 offset:26880
  v_smfmac_f32_16x16x64_bf16 v[24:27], v[100:103], a[152:159], v0
  s_waitcnt lgkmcnt(7)
  ds_read_b64_tr_b16 v[118:119], v6 offset:26944
  v_mfma_f32_16x16x32_bf16 v[16:19], v[36:39], v[68:71], 0
  s_waitcnt lgkmcnt(6)
  ds_read_b64_tr_b16 v[124:125], v6 offset:27136
  ds_read_b64_tr_b16 v[126:127], v6 offset:27200
  v_mfma_f32_16x16x32_bf16 v[16:19], v[40:43], v[72:75], v[16:19]
  s_waitcnt lgkmcnt(6)
  ds_read_b64_tr_b16 v[104:105], v6 offset:27392
  ds_read_b64_tr_b16 v[106:107], v6 offset:27456
  v_mfma_f32_16x16x32_bf16 v[16:19], v[44:47], v[76:79], v[16:19]
  s_waitcnt lgkmcnt(6)
  ds_read_b64_tr_b16 v[108:109], v6 offset:27648
  ds_read_b64_tr_b16 v[110:111], v6 offset:27712
  v_mfma_f32_16x16x32_bf16 v[16:19], v[48:51], v[80:83], v[16:19]
  s_waitcnt lgkmcnt(6)
  v_cvt_pk_bf16_f32 v120, v24, v25
  v_cvt_pk_bf16_f32 v121, v26, v27
  v_mfma_f32_16x16x32_bf16 v[112:115], v[116:119], v[68:71], 0
  s_waitcnt lgkmcnt(4)
  v_mov_b64 v[98:99], 0
  v_mfma_f32_16x16x32_bf16 v[112:115], v[124:127], v[72:75], v[112:115]
  s_waitcnt lgkmcnt(2)
  v_mov_b64 v[36:37], 0
  v_exp_f32 v100, v16
  v_mfma_f32_16x16x32_bf16 v[112:115], v[104:107], v[76:79], v[112:115]
  s_waitcnt lgkmcnt(0)
  v_exp_f32 v101, v17
  v_mfma_f32_16x16x32_bf16 v[112:115], v[108:111], v[80:83], v[112:115]
  buffer_store_dwordx4 v[120:123], v2, s[4:7], s29 offen offset:3072 sc1
  v_exp_f32 v102, v18
  v_mfma_f32_16x16x32_bf16 v[20:23], v[52:55], v[68:71], 0
  s_cmp_eq_u32 s14, 63
  v_exp_f32 v103, v19
  v_mfma_f32_16x16x32_bf16 v[20:23], v[56:59], v[72:75], v[20:23]
  s_cbranch_scc1 M_tdone
  v_cvt_pk_bf16_f32 v44, v100, v101
  v_cvt_pk_bf16_f32 v45, v102, v103
  v_mfma_f32_16x16x32_bf16 v[20:23], v[60:63], v[76:79], v[20:23]
  s_add_u32 s29, s29, 131072
  v_exp_f32 v100, v112
  v_mfma_f32_16x16x32_bf16 v[20:23], v[64:67], v[80:83], v[20:23]
  v_exp_f32 v101, v113
  v_exp_f32 v102, v114
  v_exp_f32 v103, v115
  v_cvt_pk_bf16_f32 v84, v100, v101
  v_cvt_pk_bf16_f32 v85, v102, v103
  v_cndmask_b32 v48, v84, 0, s[16:17]
  v_cndmask_b32 v49, v85, 0, s[16:17]
  v_cndmask_b32 v50, 0, v84, s[16:17]
  v_cndmask_b32 v51, 0, v85, s[16:17]
  v_exp_f32 v100, v20
  v_mfma_f32_16x16x16_bf16 v[88:91], v[12:13], v[48:49], 0
  v_exp_f32 v101, v21
  v_mfma_f32_16x16x16_bf16 v[24:27], v[120:121], v[48:49], 0
  v_exp_f32 v102, v22
  v_mfma_f32_16x16x16_bf16 v[116:119], v[120:121], v[50:51], 0
  v_exp_f32 v103, v23
  v_cvt_pk_bf16_f32 v46, v100, v101
  v_cvt_pk_bf16_f32 v47, v102, v103
  v_mov_b64 v[38:39], 0
  s_nop 0
  v_mfma_f32_16x16x32_bf16 v[88:91], v[12:15], v[44:47], v[88:91]
  v_mov_b64 v[40:41], 0
  v_mov_b64 v[42:43], 0
  v_mfma_f32_16x16x32_bf16 v[24:27], v[28:31], v[44:47], v[24:27]
  ds_read_b128 v[52:55], v4 offset:24576
  ds_read_b128 v[56:59], v4 offset:25600
  v_mfma_f32_16x16x32_bf16 v[116:119], v[32:35], v[44:47], v[116:119]
  s_nop 1
  v_rcp_f32 v89, v88
  v_subrev_u32 v100, s54, v88
  v_cmp_le_u32 vcc, s55, v100
  v_mul_f32 v24, v89, v24
  v_mul_f32 v25, v89, v25
  s_cbranch_vccnz T_slow_123
T_back_124:
  v_cvt_pk_bf16_f32 v124, v24, v25
  v_pk_mul_f32 v[26:27], v[26:27], v[88:89] op_sel:[0,1] op_sel_hi:[1,1]
  v_pk_mul_f32 v[116:117], v[116:117], v[88:89] op_sel:[0,1] op_sel_hi:[1,1]
  v_pk_mul_f32 v[118:119], v[118:119], v[88:89] op_sel:[0,1] op_sel_hi:[1,1]
  v_cvt_pk_bf16_f32 v125, v26, v27
  v_cvt_pk_bf16_f32 v126, v116, v117
  v_cvt_pk_bf16_f32 v127, v118, v119
  ds_write_b128 v11, v[124:127] offset:30720
  s_nop 0
  v_smfmac_f32_16x16x64_bf16 v[92:95], v[124:127], a[160:167], v0
  v_smfmac_f32_16x16x64_bf16 v[96:99], v[124:127], a[168:175], v0
  v_smfmac_f32_16x16x64_bf16 v[36:39], v[124:127], a[176:183], v0
  v_smfmac_f32_16x16x64_bf16 v[40:43], v[124:127], a[184:191], v0
  s_waitcnt lgkmcnt(0)
  s_barrier
  ds_read_b128 v[104:107], v11 offset:30208
  ds_read_b128 v[108:111], v11 offset:29696
  ds_read_b128 v[68:71], v11 offset:29184
  s_waitcnt lgkmcnt(2)
  v_smfmac_f32_16x16x64_bf16 v[92:95], v[104:107], a[192:199], v0
  s_waitcnt lgkmcnt(1)
  ds_read_b128 v[76:79], v4 offset:28672
  v_smfmac_f32_16x16x64_bf16 v[92:95], v[108:111], a[224:231], v0
  s_waitcnt lgkmcnt(1)
  ds_read_b128 v[80:83], v4 offset:29696
  v_smfmac_f32_16x16x64_bf16 v[92:95], v[68:71], a[240:247], v0
  ds_read_b128 v[60:63], v4 offset:26624
  v_smfmac_f32_16x16x64_bf16 v[96:99], v[104:107], a[200:207], v0
  ds_read_b128 v[64:67], v4 offset:27648
  v_smfmac_f32_16x16x64_bf16 v[96:99], v[108:111], a[232:239], v0
  ds_read_b128 v[28:31], v4 offset:30720
  s_nop 0
  v_cvt_pk_bf16_f32 v16, v92, v93
  v_cvt_pk_bf16_f32 v17, v94, v95
  v_bfi_b32 v16, 1, s57, v16
  v_smfmac_f32_16x16x64_bf16 v[96:99], v[68:71], a[248:255], v0
  buffer_store_dwordx2 v[16:17], v7, s[4:7], s20 offen offset:0 sc1
  v_smfmac_f32_16x16x64_bf16 v[36:39], v[104:107], a[208:215], v0
  ds_read_b128 v[32:35], v4 offset:31744
  v_smfmac_f32_16x16x64_bf16 v[36:39], v[108:111], v[52:59], v0
  s_waitcnt lgkmcnt(4)
  s_nop 0
  v_cvt_pk_bf16_f32 v18, v96, v97
  v_cvt_pk_bf16_f32 v19, v98, v99
  v_bfi_b32 v18, 1, s57, v18
  v_smfmac_f32_16x16x64_bf16 v[36:39], v[68:71], v[76:83], v0
  buffer_store_dwordx2 v[18:19], v7, s[4:7], s20 offen offset:64 sc1
  v_smfmac_f32_16x16x64_bf16 v[40:43], v[104:107], a[216:223], v0
  s_waitcnt lgkmcnt(2)
  v_smfmac_f32_16x16x64_bf16 v[40:43], v[108:111], v[60:67], v0
  s_waitcnt lgkmcnt(0)
  s_nop 0
  v_cvt_pk_bf16_f32 v20, v36, v37
  v_cvt_pk_bf16_f32 v21, v38, v39
  v_bfi_b32 v20, 1, s57, v20
  v_smfmac_f32_16x16x64_bf16 v[40:43], v[68:71], v[28:35], v0
  buffer_store_dwordx2 v[20:21], v7, s[4:7], s21 offen offset:0 sc1
  s_nop 6
  v_cvt_pk_bf16_f32 v22, v40, v41
  v_cvt_pk_bf16_f32 v23, v42, v43
  v_bfi_b32 v22, 1, s57, v22
  buffer_store_dwordx2 v[22:23], v7, s[4:7], s21 offen offset:64 sc1
  ds_read_b128 v[68:71], v4 offset:0
  ds_read_b128 v[72:75], v4 offset:1024
  ds_read_b128 v[76:79], v4 offset:4096
  ds_read_b128 v[80:83], v4 offset:5120
  ds_read_b128 v[84:87], v4 offset:8192
  ds_read_b128 v[88:91], v4 offset:9216
  ds_read_b128 v[92:95], v4 offset:2048
  ds_read_b128 v[96:99], v4 offset:3072
  ds_read_b128 v[100:103], v4 offset:6144
  ds_read_b128 v[104:107], v4 offset:7168
  ds_read_b128 v[108:111], v4 offset:10240
  ds_read_b128 v[112:115], v4 offset:11264
  v_mov_b64 v[16:17], 0
  v_mov_b64 v[18:19], 0
  v_mov_b64 v[20:21], 0
  v_mov_b64 v[22:23], 0
  v_mov_b64 v[24:25], 0
  v_mov_b64 v[26:27], 0
  ds_read_b64 v[44:45], v2 offset:32256
  s_waitcnt lgkmcnt(0)
  v_readfirstlane_b32 s38, v44
  v_readfirstlane_b32 s37, v45
  s_nop 0
  s_lshl_b32 s38, s38, 1
  s_lshl1_add_u32 s37, s37, 1
  s_min_u32 s38, s38, s37
  s_cmp_ge_u32 s38, 64
  s_cselect_b32 s38, 100, s38
  s_sub_u32 s38, s38, 1
  s_max_i32 s30, s30, s38
  s_waitcnt vmcnt(4)
  s_barrier
  ds_read_b128 v[28:31], v2 offset:19456
  ds_read_b128 v[32:35], v2 offset:23552
  ds_read_b128 v[36:39], v2 offset:8192
  ds_read_b128 v[40:43], v2 offset:9216
  ds_read_b128 v[44:47], v2 offset:10240
  ds_read_b128 v[48:51], v2 offset:11264
  buffer_load_dwordx4 v[124:127], v2, s[4:7], s24 offen offset:3072 sc1
  buffer_load_dwordx4 v[116:119], v2, s[4:7], s25 offen offset:3072 sc1
  ds_read_b128 v[52:55], v2 offset:12288
  ds_read_b128 v[56:59], v2 offset:13312
  ds_read_b128 v[60:63], v2 offset:14336
  ds_read_b128 v[64:67], v2 offset:15360
  buffer_load_dwordx4 v[124:127], v2, s[4:7], s24 offen offset:3072 sc1
  buffer_load_dwordx4 v[116:119], v2, s[4:7], s25 offen offset:3072 sc1
  s_mov_b32 s19, 0
  s_branch T_loop_116
T_kvw_120:
  s_mov_b32 s19, 0
  s_branch T_kvok_129
T_kv_128:
  s_sleep 4
  s_add_u32 s19, s19, 1
  s_cmp_gt_u32 s19, 32768
  s_cbranch_scc1 M_exit
T_kvok_129:
  s_add_u32 s39, s99, 128
  s_mov_b32 s38, 0
  s_mov_b32 s37, 0
  s_atomic_or s38, s[58:59], s99 glc
  s_atomic_or s37, s[58:59], s39 glc
  s_waitcnt lgkmcnt(0)
  s_lshl_b32 s38, s38, 1
  s_lshl1_add_u32 s37, s37, 1
  s_min_u32 s38, s38, s37
  s_cmp_ge_u32 s38, 64
  s_cselect_b32 s38, 100, s38
  s_sub_u32 s38, s38, 1
  s_max_i32 s30, s30, s38
  s_cmp_ge_i32 s14, s30
  s_cbranch_scc1 T_kv_128
  s_branch T_kvb_121
T_slow_123:
  s_nop 7
  v_max3_f32 v100, v16, v17, v18
  v_max3_f32 v100, v100, v19, v20
  v_max3_f32 v100, v100, v21, v22
  v_max3_f32 v100, v100, v23, v112
  v_max3_f32 v100, v100, v113, v114
  v_max_f32 v100, v100, v115
  v_mov_b32 v101, v100
  s_nop 1
  v_permlane32_swap_b32 v100, v101
  s_nop 1
  v_max_f32 v100, v100, v101
  v_mov_b32 v101, v100
  s_nop 1
  v_permlane16_swap_b32 v100, v101
  s_nop 1
  v_max_f32 v100, v100, v101
  v_sub_f32 v16, v16, v100
  v_sub_f32 v17, v17, v100
  v_sub_f32 v18, v18, v100
  v_sub_f32 v19, v19, v100
  v_exp_f32 v16, v16
  v_exp_f32 v17, v17
  v_exp_f32 v18, v18
  v_exp_f32 v19, v19
  v_sub_f32 v20, v20, v100
  v_sub_f32 v21, v21, v100
  v_sub_f32 v22, v22, v100
  v_sub_f32 v23, v23, v100
  v_exp_f32 v20, v20
  v_exp_f32 v21, v21
  v_exp_f32 v22, v22
  v_exp_f32 v23, v23
  v_sub_f32 v112, v112, v100
  v_sub_f32 v113, v113, v100
  v_sub_f32 v114, v114, v100
  v_sub_f32 v115, v115, v100
  v_exp_f32 v112, v112
  v_exp_f32 v113, v113
  v_exp_f32 v114, v114
  v_exp_f32 v115, v115
  s_nop 0
  v_cvt_pk_bf16_f32 v44, v16, v17
  v_cvt_pk_bf16_f32 v45, v18, v19
  v_cvt_pk_bf16_f32 v46, v20, v21
  v_cvt_pk_bf16_f32 v47, v22, v23
  v_cvt_pk_bf16_f32 v84, v112, v113
  v_cvt_pk_bf16_f32 v85, v114, v115
  v_cndmask_b32 v48, v84, 0, s[16:17]
  v_cndmask_b32 v49, v85, 0, s[16:17]
  v_cndmask_b32 v50, 0, v84, s[16:17]
  v_cndmask_b32 v51, 0, v85, s[16:17]
  s_nop 1
  v_mfma_f32_16x16x16_bf16 v[88:91], v[12:13], v[48:49], 0
  v_mfma_f32_16x16x16_bf16 v[24:27], v[120:121], v[48:49], 0
  v_mfma_f32_16x16x16_bf16 v[116:119], v[120:121], v[50:51], 0
  v_mfma_f32_16x16x32_bf16 v[88:91], v[12:15], v[44:47], v[88:91]
  v_mfma_f32_16x16x32_bf16 v[24:27], v[28:31], v[44:47], v[24:27]
  v_mfma_f32_16x16x32_bf16 v[116:119], v[32:35], v[44:47], v[116:119]
  s_nop 7
  s_nop 1
  v_rcp_f32 v89, v88
  s_nop 0
  v_mul_f32 v24, v89, v24
  v_mul_f32 v25, v89, v25
  s_branch T_back_124
M_tdone:
  v_mov_b32 v16, 64
  v_or_b32 v17, s13, v2
  v_min_u32 v17, 1, v17
  v_lshlrev_b32 v17, 30, v17
  s_waitcnt vmcnt(0)
  s_barrier
  buffer_store_dword v16, v17, s[4:7], s15 offen sc1
  s_branch M_done
M_worker:
  s_load_dwordx4 s[72:75], s[0:1], 120
  v_lshrrev_b32 v3, 6, v0
  v_and_b32 v1, 63, v0
  v_readfirstlane_b32 s16, v3
  v_lshlrev_b32 v2, 4, v1
  s_waitcnt lgkmcnt(0)
  s_mov_b64 s[4:5], s[74:75]
  s_mov_b64 s[74:75], s[72:73]
  s_mov_b64 s[72:73], s[4:5]
  s_and_b32 s5, s5, 0xffff
  s_mov_b32 s6, 268435456
  s_mov_b32 s7, 0x20000
  s_sub_u32 s66, s76, 1
  s_lshl_b32 s66, s66, 5
  s_add_u32 s66, s66, s77
  s_mul_i32 s64, s66, 9363
  s_lshr_b32 s64, s64, 16
  s_mul_i32 s67, s64, 7
  s_sub_u32 s65, s66, s67
  s_lshl_b32 s31, s66, 7
  s_add_u32 s31, s31, 148897792
  s_lshl_b32 s67, s67, 7
  s_add_u32 s67, s67, 148897792
  s_getpc_b64 s[76:77]
M_pc:
  s_add_u32 s76, s76, M_table-M_pc
  s_addc_u32 s77, s77, 0
  s_lshl_b32 s26, s65, 6
  s_load_dwordx16 s[48:63], s[76:77], s26
  s_waitcnt lgkmcnt(0)
  s_mov_b32 s23, s51
  s_cmp_lg_u32 s48, 1
  s_cbranch_scc1 M_nobpf
  s_load_dwordx8 s[36:43], s[0:1], 64
  s_mul_i32 s76, s64, 3
  s_add_u32 s76, s76, s57
  v_lshlrev_b32 v4, 7, v0
  s_mov_b32 s10, 4194304
  s_mov_b32 s11, 0x20000
  s_waitcnt lgkmcnt(0)
  s_mov_b32 s8, s42
  s_and_b32 s9, s43, 0xffff
  s_mul_i32 s77, s76, 43776
  s_add_u32 s77, s77, 0
  v_min_u32 v5, 32640, v4
  v_add_u32 v5, s77, v5
  s_add_u32 s77, s77, 32768
  buffer_load_dword v6, v5, s[8:11], 0 offen
  v_min_u32 v5, 10880, v4
  v_add_u32 v5, s77, v5
  s_add_u32 s77, s77, 32768
  buffer_load_dword v6, v5, s[8:11], 0 offen
  s_mov_b32 s8, s38
  s_and_b32 s9, s39, 0xffff
  s_mul_i32 s77, s76, 21888
  s_add_u32 s77, s77, 2097152
  v_min_u32 v5, 21760, v4
  v_add_u32 v5, s77, v5
  s_add_u32 s77, s77, 32768
  buffer_load_dword v6, v5, s[8:11], 0 offen
  s_mov_b32 s8, s40
  s_and_b32 s9, s41, 0xffff
  s_mul_i32 s77, s76, 21888
  s_add_u32 s77, s77, 2097152
  v_min_u32 v5, 21760, v4
  v_add_u32 v5, s77, v5
  s_add_u32 s77, s77, 32768
  buffer_load_dword v6, v5, s[8:11], 0 offen
  s_mov_b32 s8, s36
  s_and_b32 s9, s37, 0xffff
  s_mul_i32 s77, s76, 21888
  s_add_u32 s77, s77, 2097152
  v_min_u32 v5, 21760, v4
  v_add_u32 v5, s77, v5
  s_add_u32 s77, s77, 32768
  buffer_load_dword v6, v5, s[8:11], 0 offen
  s_waitcnt vmcnt(0)
M_nobpf:
  s_lshr_b32 s29, s16, 1
  s_cmp_eq_u32 s29, 0
  s_cselect_b32 s26, 2, 8
  s_cselect_b32 s27, 3, 4
  s_cselect_b32 s28, 9, 10
  s_cmp_eq_u32 s48, 1
  s_cselect_b32 s26, s27, s26
  s_cmp_eq_u32 s48, 2
  s_cselect_b32 s26, s28, s26
  s_lshl_b32 s26, s26, 3
  s_load_dwordx2 s[8:9], s[0:1], s26
  s_cmp_eq_u32 s48, 1
  s_cselect_b32 s26, 8, 0
  s_load_dwordx2 s[12:13], s[0:1], s26
  s_cmp_eq_u32 s29, 0
  s_cselect_b32 s21, 0, 3
  s_cselect_b32 s27, 1, 2
  s_cselect_b32 s28, 4, 5
  s_cmp_eq_u32 s48, 1
  s_cselect_b32 s21, s27, s21
  s_cmp_eq_u32 s48, 2
  s_cselect_b32 s21, s28, s21
  s_lshl_b32 s21, s21, 5
  s_add_u32 s21, s21, s64
  s_lshl_b32 s21, s21, 6
  s_add_u32 s21, s21, s49
  s_and_b32 s27, s16, 1
  s_lshl_b32 s21, s21, 1
  s_add_u32 s21, s21, s27
  s_lshl_b32 s21, s21, 12
  s_lshl_b32 s22, s50, 13
  s_lshl_b32 s19, s49, 15
  s_lshl_b32 s20, s50, 15
  s_lshl_b32 s17, s64, 1
  s_add_u32 s17, s17, s27
  s_lshl_b32 s17, s17, 7
  s_mov_b32 s18, 8192
  s_mov_b32 s24, 0x3e0293ee
  s_waitcnt lgkmcnt(0)
  s_and_b32 s9, s9, 0xffff
  s_mov_b32 s10, 4194304
  s_mov_b32 s11, 0x20000
  s_and_b32 s13, s13, 0xffff
  s_mov_b32 s14, 2097152
  s_mov_b32 s15, 0x20000
  s_cmp_eq_u32 s48, 0
  s_cselect_b32 s32, 0, s16
  s_lshr_b32 s32, s32, 1
  v_lshrrev_b32 v144, 4, v1
  v_and_b32 v56, 0xff, v2
  v_lshl_add_u32 v56, v144, 9, v56
  v_and_b32 v146, 15, v1
  v_and_b32 v144, 8, v1
  v_add_u32 v144, v144, v146
  s_cmp_lg_u32 s32, 0
  s_cselect_b64 vcc, -1, 0
  s_cselect_b32 s26, 8, 16
  v_cndmask_b32 v144, v146, v144, vcc
  v_lshrrev_b32 v145, 4, v1
  v_add_u32 v148, s26, v144
  v_xor_b32 v147, 0, v145
  v_xor_b32 v147, v147, v146
  v_lshlrev_b32 v147, 4, v147
  v_lshl_add_u32 v8, v144, 8, v147
  v_xor_b32 v147, 8, v145
  v_xor_b32 v147, v147, v146
  v_lshlrev_b32 v147, 4, v147
  v_lshl_add_u32 v9, v148, 8, v147
  v_xor_b32 v147, 4, v145
  v_xor_b32 v147, v147, v146
  v_lshlrev_b32 v147, 4, v147
  v_lshl_add_u32 v10, v144, 8, v147
  v_xor_b32 v147, 12, v145
  v_xor_b32 v147, v147, v146
  v_lshlrev_b32 v147, 4, v147
  v_lshl_add_u32 v11, v148, 8, v147
  v_xor_b32 v147, 8, v145
  v_xor_b32 v147, v147, v146
  v_lshlrev_b32 v147, 4, v147
  v_lshl_add_u32 v12, v144, 8, v147
  v_xor_b32 v147, 0, v145
  v_xor_b32 v147, v147, v146
  v_lshlrev_b32 v147, 4, v147
  v_lshl_add_u32 v13, v148, 8, v147
  v_xor_b32 v147, 12, v145
  v_xor_b32 v147, v147, v146
  v_lshlrev_b32 v147, 4, v147
  v_lshl_add_u32 v14, v144, 8, v147
  v_xor_b32 v147, 4, v145
  v_xor_b32 v147, v147, v146
  v_lshlrev_b32 v147, 4, v147
  v_lshl_add_u32 v15, v148, 8, v147
  v_lshrrev_b32 v144, 4, v1
  s_lshl_b32 s26, s16, 8
  v_add_u32 v145, 0, v144
  v_or_b32 v147, 0, v144
  v_xor_b32 v147, v147, v146
  v_lshlrev_b32 v147, 4, v147
  v_lshl_add_u32 v147, v145, 10, v147
  v_add_u32 v16, s26, v147
  v_add_u32 v145, 4, v144
  v_or_b32 v147, 4, v144
  v_xor_b32 v147, v147, v146
  v_lshlrev_b32 v147, 4, v147
  v_lshl_add_u32 v147, v145, 10, v147
  v_add_u32 v17, s26, v147
  v_add_u32 v145, 8, v144
  v_or_b32 v147, 8, v144
  v_xor_b32 v147, v147, v146
  v_lshlrev_b32 v147, 4, v147
  v_lshl_add_u32 v147, v145, 10, v147
  v_add_u32 v18, s26, v147
  v_add_u32 v145, 12, v144
  v_or_b32 v147, 12, v144
  v_xor_b32 v147, v147, v146
  v_lshlrev_b32 v147, 4, v147
  v_lshl_add_u32 v147, v145, 10, v147
  v_add_u32 v19, s26, v147
  v_add_u32 v145, 16, v144
  v_or_b32 v147, 8, v144
  v_xor_b32 v147, v147, v146
  v_lshlrev_b32 v147, 4, v147
  v_lshl_add_u32 v147, v145, 10, v147
  v_add_u32 v20, s26, v147
  v_add_u32 v145, 20, v144
  v_or_b32 v147, 12, v144
  v_xor_b32 v147, v147, v146
  v_lshlrev_b32 v147, 4, v147
  v_lshl_add_u32 v147, v145, 10, v147
  v_add_u32 v21, s26, v147
  v_add_u32 v145, 24, v144
  v_or_b32 v147, 0, v144
  v_xor_b32 v147, v147, v146
  v_lshlrev_b32 v147, 4, v147
  v_lshl_add_u32 v147, v145, 10, v147
  v_add_u32 v22, s26, v147
  v_add_u32 v145, 28, v144
  v_or_b32 v147, 4, v144
  v_xor_b32 v147, v147, v146
  v_lshlrev_b32 v147, 4, v147
  v_lshl_add_u32 v147, v145, 10, v147
  v_add_u32 v23, s26, v147
  v_lshrrev_b32 v144, 3, v1
  v_mul_lo_u32 v144, v144, s18
  v_and_b32 v145, 7, v1
  v_lshl_add_u32 v144, v145, 4, v144
  s_lshl_b32 s28, s16, 15
  s_add_u32 s28, s28, 32768
  s_lshl_b32 s29, s18, 3
  s_add_u32 m0, s28, 0
  s_nop 0
  buffer_load_dwordx4 v144, s[8:11], s17 offen lds
  s_add_u32 s17, s17, s29
  s_add_u32 m0, s28, 1024
  s_nop 0
  buffer_load_dwordx4 v144, s[8:11], s17 offen lds
  s_add_u32 s17, s17, s29
  s_add_u32 m0, s28, 2048
  s_nop 0
  buffer_load_dwordx4 v144, s[8:11], s17 offen lds
  s_add_u32 s17, s17, s29
  s_add_u32 m0, s28, 3072
  s_nop 0
  buffer_load_dwordx4 v144, s[8:11], s17 offen lds
  s_add_u32 s17, s17, s29
  s_add_u32 m0, s28, 4096
  s_nop 0
  buffer_load_dwordx4 v144, s[8:11], s17 offen lds
  s_add_u32 s17, s17, s29
  s_add_u32 m0, s28, 5120
  s_nop 0
  buffer_load_dwordx4 v144, s[8:11], s17 offen lds
  s_add_u32 s17, s17, s29
  s_add_u32 m0, s28, 6144
  s_nop 0
  buffer_load_dwordx4 v144, s[8:11], s17 offen lds
  s_add_u32 s17, s17, s29
  s_add_u32 m0, s28, 7168
  s_nop 0
  buffer_load_dwordx4 v144, s[8:11], s17 offen lds
  s_add_u32 s17, s17, s29
  s_add_u32 m0, s28, 8192
  s_nop 0
  buffer_load_dwordx4 v144, s[8:11], s17 offen lds
  s_add_u32 s17, s17, s29
  s_add_u32 m0, s28, 9216
  s_nop 0
  buffer_load_dwordx4 v144, s[8:11], s17 offen lds
  s_add_u32 s17, s17, s29
  s_add_u32 m0, s28, 10240
  s_nop 0
  buffer_load_dwordx4 v144, s[8:11], s17 offen lds
  s_add_u32 s17, s17, s29
  s_add_u32 m0, s28, 11264
  s_nop 0
  buffer_load_dwordx4 v144, s[8:11], s17 offen lds
  s_add_u32 s17, s17, s29
  s_add_u32 m0, s28, 12288
  s_nop 0
  buffer_load_dwordx4 v144, s[8:11], s17 offen lds
  s_add_u32 s17, s17, s29
  s_add_u32 m0, s28, 13312
  s_nop 0
  buffer_load_dwordx4 v144, s[8:11], s17 offen lds
  s_add_u32 s17, s17, s29
  s_add_u32 m0, s28, 14336
  s_nop 0
  buffer_load_dwordx4 v144, s[8:11], s17 offen lds
  s_add_u32 s17, s17, s29
  s_add_u32 m0, s28, 15360
  s_nop 0
  buffer_load_dwordx4 v144, s[8:11], s17 offen lds
  s_add_u32 s17, s17, s29
  s_add_u32 m0, s28, 16384
  s_nop 0
  buffer_load_dwordx4 v144, s[8:11], s17 offen lds
  s_add_u32 s17, s17, s29
  s_add_u32 m0, s28, 17408
  s_nop 0
  buffer_load_dwordx4 v144, s[8:11], s17 offen lds
  s_add_u32 s17, s17, s29
  s_add_u32 m0, s28, 18432
  s_nop 0
  buffer_load_dwordx4 v144, s[8:11], s17 offen lds
  s_add_u32 s17, s17, s29
  s_add_u32 m0, s28, 19456
  s_nop 0
  buffer_load_dwordx4 v144, s[8:11], s17 offen lds
  s_add_u32 s17, s17, s29
  s_add_u32 m0, s28, 20480
  s_nop 0
  buffer_load_dwordx4 v144, s[8:11], s17 offen lds
  s_add_u32 s17, s17, s29
  s_add_u32 m0, s28, 21504
  s_nop 0
  buffer_load_dwordx4 v144, s[8:11], s17 offen lds
  s_add_u32 s17, s17, s29
  s_add_u32 m0, s28, 22528
  s_nop 0
  buffer_load_dwordx4 v144, s[8:11], s17 offen lds
  s_add_u32 s17, s17, s29
  s_add_u32 m0, s28, 23552
  s_nop 0
  buffer_load_dwordx4 v144, s[8:11], s17 offen lds
  s_add_u32 s17, s17, s29
  s_add_u32 m0, s28, 24576
  s_nop 0
  buffer_load_dwordx4 v144, s[8:11], s17 offen lds
  s_add_u32 s17, s17, s29
  s_add_u32 m0, s28, 25600
  s_nop 0
  buffer_load_dwordx4 v144, s[8:11], s17 offen lds
  s_add_u32 s17, s17, s29
  s_add_u32 m0, s28, 26624
  s_nop 0
  buffer_load_dwordx4 v144, s[8:11], s17 offen lds
  s_add_u32 s17, s17, s29
  s_add_u32 m0, s28, 27648
  s_nop 0
  buffer_load_dwordx4 v144, s[8:11], s17 offen lds
  s_add_u32 s17, s17, s29
  s_add_u32 m0, s28, 28672
  s_nop 0
  buffer_load_dwordx4 v144, s[8:11], s17 offen lds
  s_add_u32 s17, s17, s29
  s_add_u32 m0, s28, 29696
  s_nop 0
  buffer_load_dwordx4 v144, s[8:11], s17 offen lds
  s_add_u32 s17, s17, s29
  s_add_u32 m0, s28, 30720
  s_nop 0
  buffer_load_dwordx4 v144, s[8:11], s17 offen lds
  s_add_u32 s17, s17, s29
  s_add_u32 m0, s28, 31744
  s_nop 0
  buffer_load_dwordx4 v144, s[8:11], s17 offen lds
  s_add_u32 s17, s17, s29
  s_lshl_b32 s25, s16, 13
  s_add_u32 m0, s25, 0
  s_nop 0
  buffer_load_dwordx4 v16, s[12:15], s19 offen lds
  s_add_u32 m0, s25, 1024
  s_nop 0
  buffer_load_dwordx4 v17, s[12:15], s19 offen lds
  s_add_u32 m0, s25, 2048
  s_nop 0
  buffer_load_dwordx4 v18, s[12:15], s19 offen lds
  s_add_u32 m0, s25, 3072
  s_nop 0
  buffer_load_dwordx4 v19, s[12:15], s19 offen lds
  s_add_u32 m0, s25, 4096
  s_nop 0
  buffer_load_dwordx4 v20, s[12:15], s19 offen lds
  s_add_u32 m0, s25, 5120
  s_nop 0
  buffer_load_dwordx4 v21, s[12:15], s19 offen lds
  s_add_u32 m0, s25, 6144
  s_nop 0
  buffer_load_dwordx4 v22, s[12:15], s19 offen lds
  s_add_u32 m0, s25, 7168
  s_nop 0
  buffer_load_dwordx4 v23, s[12:15], s19 offen lds
  s_cmp_gt_u32 s23, 1
  s_cselect_b32 s26, s20, 0
  s_add_u32 s19, s19, s26
  s_add_u32 s25, s25, 32768
  s_and_b32 s25, s25, 0x1ffff
  s_cmp_lg_u32 s16, 3
  s_cbranch_scc1 M_noinit
  s_mov_b32 s79, 0
  s_atomic_swap s79, s[72:73], s31 glc
  s_waitcnt lgkmcnt(0)
  s_mov_b32 s79, 1
  s_atomic_add s79, s[74:75], 128
M_noinit:
  s_cmp_lg_u32 s65, 3
  s_cbranch_scc1 M_noarm
  v_lshlrev_b32 v4, 4, v0
  v_mov_b64 v[60:61], -1
  v_mov_b64 v[62:63], -1
  s_mul_i32 s76, s64, 4096
  s_add_u32 s77, s76, 142868480
  buffer_store_dwordx4 v[60:63], v4, s[4:7], s77 offen sc1
  s_add_u32 s77, s76, 142999552
  buffer_store_dwordx4 v[60:63], v4, s[4:7], s77 offen sc1
  s_add_u32 s77, s76, 143130624
  buffer_store_dwordx4 v[60:63], v4, s[4:7], s77 offen sc1
  s_add_u32 s77, s76, 143261696
  buffer_store_dwordx4 v[60:63], v4, s[4:7], s77 offen sc1
  s_add_u32 s77, s76, 143392768
  buffer_store_dwordx4 v[60:63], v4, s[4:7], s77 offen sc1
  s_add_u32 s77, s76, 143523840
  buffer_store_dwordx4 v[60:63], v4, s[4:7], s77 offen sc1
M_noarm:
  s_mul_i32 s76, s64, 3
  s_add_u32 s76, s76, s57
  s_mul_i32 s76, s76, 24576
  v_lshlrev_b32 v4, 7, v0
  v_add_u32 v4, s76, v4
  buffer_load_dword v5, v4, s[12:15], 0 offen
  v_bfe_u32 v148, v1, 2, 2
  v_lshrrev_b32 v149, 5, v1
  v_lshl_add_u32 v148, v149, 4, v148
  v_bfe_u32 v149, v1, 4, 1
  v_lshl_add_u32 v148, v149, 3, v148
  v_and_b32 v149, 3, v1
  v_and_b32 v150, 2, v149
  v_add_u32 v150, v150, v149
  s_cmp_lg_u32 s32, 0
  s_cselect_b64 vcc, -1, 0
  s_cselect_b32 s26, 32, 16
  v_cndmask_b32 v149, v150, v149, vcc
  v_lshlrev_b32 v149, 3, v149
  v_lshl_add_u32 v148, v148, 7, v149
  v_add_u32 v152, s28, v148
  v_add_u32 v153, 512, v152
  v_add_u32 v154, s26, v152
  v_add_u32 v155, s26, v153
  s_waitcnt vmcnt(37)
  ds_read_b64_tr_b16 a[0:1], v152 offset:0
  ds_read_b64_tr_b16 a[2:3], v153 offset:0
  ds_read_b64_tr_b16 a[4:5], v154 offset:0
  ds_read_b64_tr_b16 a[6:7], v155 offset:0
  ds_read_b64_tr_b16 a[8:9], v152 offset:64
  ds_read_b64_tr_b16 a[10:11], v153 offset:64
  ds_read_b64_tr_b16 a[12:13], v154 offset:64
  ds_read_b64_tr_b16 a[14:15], v155 offset:64
  s_waitcnt lgkmcnt(0)
  s_add_u32 m0, s28, 0
  s_nop 0
  buffer_load_dwordx4 v144, s[8:11], s17 offen lds
  s_add_u32 s17, s17, s29
  s_add_u32 m0, s28, 1024
  s_nop 0
  buffer_load_dwordx4 v144, s[8:11], s17 offen lds
  s_add_u32 s17, s17, s29
  s_add_u32 m0, s28, 2048
  s_nop 0
  buffer_load_dwordx4 v144, s[8:11], s17 offen lds
  s_add_u32 s17, s17, s29
  s_add_u32 m0, s28, 3072
  s_nop 0
  buffer_load_dwordx4 v144, s[8:11], s17 offen lds
  s_add_u32 s17, s17, s29
  s_waitcnt vmcnt(37)
  ds_read_b64_tr_b16 a[16:17], v152 offset:4096
  ds_read_b64_tr_b16 a[18:19], v153 offset:4096
  ds_read_b64_tr_b16 a[20:21], v154 offset:4096
  ds_read_b64_tr_b16 a[22:23], v155 offset:4096
  ds_read_b64_tr_b16 a[24:25], v152 offset:4160
  ds_read_b64_tr_b16 a[26:27], v153 offset:4160
  ds_read_b64_tr_b16 a[28:29], v154 offset:4160
  ds_read_b64_tr_b16 a[30:31], v155 offset:4160
  s_waitcnt lgkmcnt(0)
  s_add_u32 m0, s28, 4096
  s_nop 0
  buffer_load_dwordx4 v144, s[8:11], s17 offen lds
  s_add_u32 s17, s17, s29
  s_add_u32 m0, s28, 5120
  s_nop 0
  buffer_load_dwordx4 v144, s[8:11], s17 offen lds
  s_add_u32 s17, s17, s29
  s_add_u32 m0, s28, 6144
  s_nop 0
  buffer_load_dwordx4 v144, s[8:11], s17 offen lds
  s_add_u32 s17, s17, s29
  s_add_u32 m0, s28, 7168
  s_nop 0
  buffer_load_dwordx4 v144, s[8:11], s17 offen lds
  s_add_u32 s17, s17, s29
  s_waitcnt vmcnt(37)
  ds_read_b64_tr_b16 a[32:33], v152 offset:8192
  ds_read_b64_tr_b16 a[34:35], v153 offset:8192
  ds_read_b64_tr_b16 a[36:37], v154 offset:8192
  ds_read_b64_tr_b16 a[38:39], v155 offset:8192
  ds_read_b64_tr_b16 a[40:41], v152 offset:8256
  ds_read_b64_tr_b16 a[42:43], v153 offset:8256
  ds_read_b64_tr_b16 a[44:45], v154 offset:8256
  ds_read_b64_tr_b16 a[46:47], v155 offset:8256
  s_waitcnt lgkmcnt(0)
  s_add_u32 m0, s28, 8192
  s_nop 0
  buffer_load_dwordx4 v144, s[8:11], s17 offen lds
  s_add_u32 s17, s17, s29
  s_add_u32 m0, s28, 9216
  s_nop 0
  buffer_load_dwordx4 v144, s[8:11], s17 offen lds
  s_add_u32 s17, s17, s29
  s_add_u32 m0, s28, 10240
  s_nop 0
  buffer_load_dwordx4 v144, s[8:11], s17 offen lds
  s_add_u32 s17, s17, s29
  s_add_u32 m0, s28, 11264
  s_nop 0
  buffer_load_dwordx4 v144, s[8:11], s17 offen lds
  s_add_u32 s17, s17, s29
  s_waitcnt vmcnt(37)
  ds_read_b64_tr_b16 a[48:49], v152 offset:12288
  ds_read_b64_tr_b16 a[50:51], v153 offset:12288
  ds_read_b64_tr_b16 a[52:53], v154 offset:12288
  ds_read_b64_tr_b16 a[54:55], v155 offset:12288
  ds_read_b64_tr_b16 a[56:57], v152 offset:12352
  ds_read_b64_tr_b16 a[58:59], v153 offset:12352
  ds_read_b64_tr_b16 a[60:61], v154 offset:12352
  ds_read_b64_tr_b16 a[62:63], v155 offset:12352
  s_waitcnt lgkmcnt(0)
  s_add_u32 m0, s28, 12288
  s_nop 0
  buffer_load_dwordx4 v144, s[8:11], s17 offen lds
  s_add_u32 s17, s17, s29
  s_add_u32 m0, s28, 13312
  s_nop 0
  buffer_load_dwordx4 v144, s[8:11], s17 offen lds
  s_add_u32 s17, s17, s29
  s_add_u32 m0, s28, 14336
  s_nop 0
  buffer_load_dwordx4 v144, s[8:11], s17 offen lds
  s_add_u32 s17, s17, s29
  s_add_u32 m0, s28, 15360
  s_nop 0
  buffer_load_dwordx4 v144, s[8:11], s17 offen lds
  s_add_u32 s17, s17, s29
  s_waitcnt vmcnt(37)
  ds_read_b64_tr_b16 a[64:65], v152 offset:16384
  ds_read_b64_tr_b16 a[66:67], v153 offset:16384
  ds_read_b64_tr_b16 a[68:69], v154 offset:16384
  ds_read_b64_tr_b16 a[70:71], v155 offset:16384
  ds_read_b64_tr_b16 a[72:73], v152 offset:16448
  ds_read_b64_tr_b16 a[74:75], v153 offset:16448
  ds_read_b64_tr_b16 a[76:77], v154 offset:16448
  ds_read_b64_tr_b16 a[78:79], v155 offset:16448
  s_waitcnt lgkmcnt(0)
  s_add_u32 m0, s28, 16384
  s_nop 0
  buffer_load_dwordx4 v144, s[8:11], s17 offen lds
  s_add_u32 s17, s17, s29
  s_add_u32 m0, s28, 17408
  s_nop 0
  buffer_load_dwordx4 v144, s[8:11], s17 offen lds
  s_add_u32 s17, s17, s29
  s_add_u32 m0, s28, 18432
  s_nop 0
  buffer_load_dwordx4 v144, s[8:11], s17 offen lds
  s_add_u32 s17, s17, s29
  s_add_u32 m0, s28, 19456
  s_nop 0
  buffer_load_dwordx4 v144, s[8:11], s17 offen lds
  s_add_u32 s17, s17, s29
  s_waitcnt vmcnt(37)
  ds_read_b64_tr_b16 a[80:81], v152 offset:20480
  ds_read_b64_tr_b16 a[82:83], v153 offset:20480
  ds_read_b64_tr_b16 a[84:85], v154 offset:20480
  ds_read_b64_tr_b16 a[86:87], v155 offset:20480
  ds_read_b64_tr_b16 a[88:89], v152 offset:20544
  ds_read_b64_tr_b16 a[90:91], v153 offset:20544
  ds_read_b64_tr_b16 a[92:93], v154 offset:20544
  ds_read_b64_tr_b16 a[94:95], v155 offset:20544
  s_waitcnt lgkmcnt(0)
  s_add_u32 m0, s28, 20480
  s_nop 0
  buffer_load_dwordx4 v144, s[8:11], s17 offen lds
  s_add_u32 s17, s17, s29
  s_add_u32 m0, s28, 21504
  s_nop 0
  buffer_load_dwordx4 v144, s[8:11], s17 offen lds
  s_add_u32 s17, s17, s29
  s_add_u32 m0, s28, 22528
  s_nop 0
  buffer_load_dwordx4 v144, s[8:11], s17 offen lds
  s_add_u32 s17, s17, s29
  s_add_u32 m0, s28, 23552
  s_nop 0
  buffer_load_dwordx4 v144, s[8:11], s17 offen lds
  s_add_u32 s17, s17, s29
  s_waitcnt vmcnt(37)
  ds_read_b64_tr_b16 a[96:97], v152 offset:24576
  ds_read_b64_tr_b16 a[98:99], v153 offset:24576
  ds_read_b64_tr_b16 a[100:101], v154 offset:24576
  ds_read_b64_tr_b16 a[102:103], v155 offset:24576
  ds_read_b64_tr_b16 a[104:105], v152 offset:24640
  ds_read_b64_tr_b16 a[106:107], v153 offset:24640
  ds_read_b64_tr_b16 a[108:109], v154 offset:24640
  ds_read_b64_tr_b16 a[110:111], v155 offset:24640
  s_waitcnt lgkmcnt(0)
  s_add_u32 m0, s28, 24576
  s_nop 0
  buffer_load_dwordx4 v144, s[8:11], s17 offen lds
  s_add_u32 s17, s17, s29
  s_add_u32 m0, s28, 25600
  s_nop 0
  buffer_load_dwordx4 v144, s[8:11], s17 offen lds
  s_add_u32 s17, s17, s29
  s_add_u32 m0, s28, 26624
  s_nop 0
  buffer_load_dwordx4 v144, s[8:11], s17 offen lds
  s_add_u32 s17, s17, s29
  s_add_u32 m0, s28, 27648
  s_nop 0
  buffer_load_dwordx4 v144, s[8:11], s17 offen lds
  s_add_u32 s17, s17, s29
  s_waitcnt vmcnt(37)
  ds_read_b64_tr_b16 a[112:113], v152 offset:28672
  ds_read_b64_tr_b16 a[114:115], v153 offset:28672
  ds_read_b64_tr_b16 a[116:117], v154 offset:28672
  ds_read_b64_tr_b16 a[118:119], v155 offset:28672
  ds_read_b64_tr_b16 a[120:121], v152 offset:28736
  ds_read_b64_tr_b16 a[122:123], v153 offset:28736
  ds_read_b64_tr_b16 a[124:125], v154 offset:28736
  ds_read_b64_tr_b16 a[126:127], v155 offset:28736
  s_waitcnt lgkmcnt(0)
  s_add_u32 m0, s28, 28672
  s_nop 0
  buffer_load_dwordx4 v144, s[8:11], s17 offen lds
  s_add_u32 s17, s17, s29
  s_add_u32 m0, s28, 29696
  s_nop 0
  buffer_load_dwordx4 v144, s[8:11], s17 offen lds
  s_add_u32 s17, s17, s29
  s_add_u32 m0, s28, 30720
  s_nop 0
  buffer_load_dwordx4 v144, s[8:11], s17 offen lds
  s_add_u32 s17, s17, s29
  s_add_u32 m0, s28, 31744
  s_nop 0
  buffer_load_dwordx4 v144, s[8:11], s17 offen lds
  s_add_u32 s17, s17, s29
  s_waitcnt vmcnt(28)
  ds_read_b64_tr_b16 a[128:129], v152 offset:0
  ds_read_b64_tr_b16 a[130:131], v153 offset:0
  ds_read_b64_tr_b16 a[132:133], v154 offset:0
  ds_read_b64_tr_b16 a[134:135], v155 offset:0
  ds_read_b64_tr_b16 a[136:137], v152 offset:64
  ds_read_b64_tr_b16 a[138:139], v153 offset:64
  ds_read_b64_tr_b16 a[140:141], v154 offset:64
  ds_read_b64_tr_b16 a[142:143], v155 offset:64
  s_waitcnt lgkmcnt(0)
  s_waitcnt vmcnt(24)
  ds_read_b64_tr_b16 a[144:145], v152 offset:4096
  ds_read_b64_tr_b16 a[146:147], v153 offset:4096
  ds_read_b64_tr_b16 a[148:149], v154 offset:4096
  ds_read_b64_tr_b16 a[150:151], v155 offset:4096
  ds_read_b64_tr_b16 a[152:153], v152 offset:4160
  ds_read_b64_tr_b16 a[154:155], v153 offset:4160
  ds_read_b64_tr_b16 a[156:157], v154 offset:4160
  ds_read_b64_tr_b16 a[158:159], v155 offset:4160
  s_waitcnt lgkmcnt(0)
  s_waitcnt vmcnt(20)
  ds_read_b64_tr_b16 a[160:161], v152 offset:8192
  ds_read_b64_tr_b16 a[162:163], v153 offset:8192
  ds_read_b64_tr_b16 a[164:165], v154 offset:8192
  ds_read_b64_tr_b16 a[166:167], v155 offset:8192
  ds_read_b64_tr_b16 a[168:169], v152 offset:8256
  ds_read_b64_tr_b16 a[170:171], v153 offset:8256
  ds_read_b64_tr_b16 a[172:173], v154 offset:8256
  ds_read_b64_tr_b16 a[174:175], v155 offset:8256
  s_waitcnt lgkmcnt(0)
  s_waitcnt vmcnt(16)
  ds_read_b64_tr_b16 a[176:177], v152 offset:12288
  ds_read_b64_tr_b16 a[178:179], v153 offset:12288
  ds_read_b64_tr_b16 a[180:181], v154 offset:12288
  ds_read_b64_tr_b16 a[182:183], v155 offset:12288
  ds_read_b64_tr_b16 a[184:185], v152 offset:12352
  ds_read_b64_tr_b16 a[186:187], v153 offset:12352
  ds_read_b64_tr_b16 a[188:189], v154 offset:12352
  ds_read_b64_tr_b16 a[190:191], v155 offset:12352
  s_waitcnt lgkmcnt(0)
  s_waitcnt vmcnt(12)
  ds_read_b64_tr_b16 a[192:193], v152 offset:16384
  ds_read_b64_tr_b16 a[194:195], v153 offset:16384
  ds_read_b64_tr_b16 a[196:197], v154 offset:16384
  ds_read_b64_tr_b16 a[198:199], v155 offset:16384
  ds_read_b64_tr_b16 a[200:201], v152 offset:16448
  ds_read_b64_tr_b16 a[202:203], v153 offset:16448
  ds_read_b64_tr_b16 a[204:205], v154 offset:16448
  ds_read_b64_tr_b16 a[206:207], v155 offset:16448
  s_waitcnt lgkmcnt(0)
  s_waitcnt vmcnt(8)
  ds_read_b64_tr_b16 a[208:209], v152 offset:20480
  ds_read_b64_tr_b16 a[210:211], v153 offset:20480
  ds_read_b64_tr_b16 a[212:213], v154 offset:20480
  ds_read_b64_tr_b16 a[214:215], v155 offset:20480
  ds_read_b64_tr_b16 a[216:217], v152 offset:20544
  ds_read_b64_tr_b16 a[218:219], v153 offset:20544
  ds_read_b64_tr_b16 a[220:221], v154 offset:20544
  ds_read_b64_tr_b16 a[222:223], v155 offset:20544
  s_waitcnt lgkmcnt(0)
  s_waitcnt vmcnt(4)
  ds_read_b64_tr_b16 a[224:225], v152 offset:24576
  ds_read_b64_tr_b16 a[226:227], v153 offset:24576
  ds_read_b64_tr_b16 a[228:229], v154 offset:24576
  ds_read_b64_tr_b16 a[230:231], v155 offset:24576
  ds_read_b64_tr_b16 a[232:233], v152 offset:24640
  ds_read_b64_tr_b16 a[234:235], v153 offset:24640
  ds_read_b64_tr_b16 a[236:237], v154 offset:24640
  ds_read_b64_tr_b16 a[238:239], v155 offset:24640
  s_waitcnt lgkmcnt(0)
  s_waitcnt vmcnt(0)
  ds_read_b64_tr_b16 a[240:241], v152 offset:28672
  ds_read_b64_tr_b16 a[242:243], v153 offset:28672
  ds_read_b64_tr_b16 a[244:245], v154 offset:28672
  ds_read_b64_tr_b16 a[246:247], v155 offset:28672
  ds_read_b64_tr_b16 a[248:249], v152 offset:28736
  ds_read_b64_tr_b16 a[250:251], v153 offset:28736
  ds_read_b64_tr_b16 a[252:253], v154 offset:28736
  ds_read_b64_tr_b16 a[254:255], v155 offset:28736
  s_waitcnt lgkmcnt(0)
  s_barrier
  s_add_u32 m0, s25, 0
  s_nop 0
  buffer_load_dwordx4 v16, s[12:15], s19 offen lds
  s_add_u32 m0, s25, 1024
  s_nop 0
  buffer_load_dwordx4 v17, s[12:15], s19 offen lds
  s_add_u32 m0, s25, 2048
  s_nop 0
  buffer_load_dwordx4 v18, s[12:15], s19 offen lds
  s_add_u32 m0, s25, 3072
  s_nop 0
  buffer_load_dwordx4 v19, s[12:15], s19 offen lds
  s_add_u32 m0, s25, 4096
  s_nop 0
  buffer_load_dwordx4 v20, s[12:15], s19 offen lds
  s_add_u32 m0, s25, 5120
  s_nop 0
  buffer_load_dwordx4 v21, s[12:15], s19 offen lds
  s_add_u32 m0, s25, 6144
  s_nop 0
  buffer_load_dwordx4 v22, s[12:15], s19 offen lds
  s_add_u32 m0, s25, 7168
  s_nop 0
  buffer_load_dwordx4 v23, s[12:15], s19 offen lds
  s_cmp_gt_u32 s23, 2
  s_cselect_b32 s26, s20, 0
  s_add_u32 s19, s19, s26
  s_add_u32 s25, s25, 32768
  s_and_b32 s25, s25, 0x1ffff
  s_waitcnt vmcnt(0)
  s_barrier
  s_load_dwordx2 s[8:9], s[0:1], 40
  s_mul_i32 s76, s66, 18816
  v_min_u32 v200, 146, v0
  v_lshl_add_u32 v200, v200, 7, s76
  s_waitcnt lgkmcnt(0)
  s_and_b32 s9, s9, 0xffff
  buffer_load_dword v201, v200, s[8:11], 0 offen
  s_cmp_lg_u32 s32, 0
  s_cbranch_scc1 P_v_130
  s_cmp_eq_u32 s48, 0
  s_cbranch_scc1 P_q_132
  s_mov_b32 s27, s21
  v_mov_b32 v7, 0x40000000
  s_mov_b32 s29, -2
  v_min_u32 v145, 1, v0
  v_lshlrev_b32 v145, 30, v145
  ds_read_b128 v[24:27], v8 offset:0
  ds_read_b128 v[28:31], v9 offset:0
  ds_read_b128 v[32:35], v10 offset:0
  ds_read_b128 v[36:39], v11 offset:0
  ds_read_b128 v[40:43], v12 offset:0
  ds_read_b128 v[44:47], v13 offset:0
.p2align 6
G_top_133:
  s_waitcnt lgkmcnt(5)
  v_mfma_f32_16x16x32_bf16 v[64:67], a[0:3], v[24:27], 0
  s_add_u32 m0, s25, 0
  ds_read_b128 v[48:51], v14 offset:0
  v_mfma_f32_16x16x32_bf16 v[68:71], a[4:7], v[24:27], 0
  v_mfma_f32_16x16x32_bf16 v[80:83], a[8:11], v[24:27], 0
  buffer_load_dwordx4 v16, s[12:15], s19 offen lds
  v_mfma_f32_16x16x32_bf16 v[84:87], a[12:15], v[24:27], 0
  s_waitcnt lgkmcnt(5)
  v_mfma_f32_16x16x32_bf16 v[72:75], a[0:3], v[28:31], 0
  ds_read_b128 v[52:55], v15 offset:0
  v_mfma_f32_16x16x32_bf16 v[76:79], a[4:7], v[28:31], 0
  v_cvt_pk_bf16_f32 v128, v96, v97
  v_cvt_pk_bf16_f32 v129, v98, v99
  v_mfma_f32_16x16x32_bf16 v[88:91], a[8:11], v[28:31], 0
  v_mfma_f32_16x16x32_bf16 v[92:95], a[12:15], v[28:31], 0
  s_waitcnt lgkmcnt(5)
  v_cvt_pk_bf16_f32 v130, v100, v101
  v_cvt_pk_bf16_f32 v131, v102, v103
  v_mfma_f32_16x16x32_bf16 v[64:67], a[16:19], v[32:35], v[64:67]
  s_add_u32 m0, s25, 1024
  ds_read_b128 v[24:27], v8 offset:8192
  v_mfma_f32_16x16x32_bf16 v[68:71], a[20:23], v[32:35], v[68:71]
  v_mfma_f32_16x16x32_bf16 v[80:83], a[24:27], v[32:35], v[80:83]
  buffer_load_dwordx4 v17, s[12:15], s19 offen lds
  v_mfma_f32_16x16x32_bf16 v[84:87], a[28:31], v[32:35], v[84:87]
  s_waitcnt lgkmcnt(5)
  v_mfma_f32_16x16x32_bf16 v[72:75], a[16:19], v[36:39], v[72:75]
  ds_read_b128 v[28:31], v9 offset:8192
  v_mfma_f32_16x16x32_bf16 v[76:79], a[20:23], v[36:39], v[76:79]
  v_mfma_f32_16x16x32_bf16 v[88:91], a[24:27], v[36:39], v[88:91]
  v_mfma_f32_16x16x32_bf16 v[92:95], a[28:31], v[36:39], v[92:95]
  s_waitcnt lgkmcnt(5)
  v_mfma_f32_16x16x32_bf16 v[64:67], a[32:35], v[40:43], v[64:67]
  s_add_u32 m0, s25, 2048
  ds_read_b128 v[32:35], v10 offset:8192
  v_mfma_f32_16x16x32_bf16 v[68:71], a[36:39], v[40:43], v[68:71]
  v_cvt_pk_bf16_f32 v132, v104, v105
  v_cvt_pk_bf16_f32 v133, v106, v107
  v_mfma_f32_16x16x32_bf16 v[80:83], a[40:43], v[40:43], v[80:83]
  buffer_load_dwordx4 v18, s[12:15], s19 offen lds
  v_mfma_f32_16x16x32_bf16 v[84:87], a[44:47], v[40:43], v[84:87]
  s_waitcnt lgkmcnt(5)
  v_cvt_pk_bf16_f32 v134, v108, v109
  v_cvt_pk_bf16_f32 v135, v110, v111
  v_mfma_f32_16x16x32_bf16 v[72:75], a[32:35], v[44:47], v[72:75]
  ds_read_b128 v[36:39], v11 offset:8192
  v_mfma_f32_16x16x32_bf16 v[76:79], a[36:39], v[44:47], v[76:79]
  v_mfma_f32_16x16x32_bf16 v[88:91], a[40:43], v[44:47], v[88:91]
  v_mfma_f32_16x16x32_bf16 v[92:95], a[44:47], v[44:47], v[92:95]
  s_waitcnt lgkmcnt(5)
  v_mfma_f32_16x16x32_bf16 v[64:67], a[48:51], v[48:51], v[64:67]
  s_add_u32 m0, s25, 3072
  ds_read_b128 v[40:43], v12 offset:8192
  v_mfma_f32_16x16x32_bf16 v[68:71], a[52:55], v[48:51], v[68:71]
  v_mfma_f32_16x16x32_bf16 v[80:83], a[56:59], v[48:51], v[80:83]
  buffer_load_dwordx4 v19, s[12:15], s19 offen lds
  v_mfma_f32_16x16x32_bf16 v[84:87], a[60:63], v[48:51], v[84:87]
  s_waitcnt lgkmcnt(5)
  v_mfma_f32_16x16x32_bf16 v[72:75], a[48:51], v[52:55], v[72:75]
  ds_read_b128 v[44:47], v13 offset:8192
  v_mfma_f32_16x16x32_bf16 v[76:79], a[52:55], v[52:55], v[76:79]
  v_cvt_pk_bf16_f32 v136, v112, v113
  v_cvt_pk_bf16_f32 v137, v114, v115
  v_mfma_f32_16x16x32_bf16 v[88:91], a[56:59], v[52:55], v[88:91]
  v_mfma_f32_16x16x32_bf16 v[92:95], a[60:63], v[52:55], v[92:95]
  s_waitcnt lgkmcnt(5)
  v_cvt_pk_bf16_f32 v138, v116, v117
  v_cvt_pk_bf16_f32 v139, v118, v119
  v_mfma_f32_16x16x32_bf16 v[64:67], a[64:67], v[24:27], v[64:67]
  s_add_u32 m0, s25, 4096
  ds_read_b128 v[48:51], v14 offset:8192
  v_mfma_f32_16x16x32_bf16 v[68:71], a[68:71], v[24:27], v[68:71]
  v_mfma_f32_16x16x32_bf16 v[80:83], a[72:75], v[24:27], v[80:83]
  buffer_load_dwordx4 v20, s[12:15], s19 offen lds
  v_mfma_f32_16x16x32_bf16 v[84:87], a[76:79], v[24:27], v[84:87]
  s_waitcnt lgkmcnt(5)
  v_mfma_f32_16x16x32_bf16 v[72:75], a[64:67], v[28:31], v[72:75]
  ds_read_b128 v[52:55], v15 offset:8192
  v_mfma_f32_16x16x32_bf16 v[76:79], a[68:71], v[28:31], v[76:79]
  v_mfma_f32_16x16x32_bf16 v[88:91], a[72:75], v[28:31], v[88:91]
  v_mfma_f32_16x16x32_bf16 v[92:95], a[76:79], v[28:31], v[92:95]
  s_waitcnt lgkmcnt(5)
  v_mfma_f32_16x16x32_bf16 v[64:67], a[80:83], v[32:35], v[64:67]
  s_add_u32 m0, s25, 5120
  ds_read_b128 v[24:27], v8 offset:16384
  v_mfma_f32_16x16x32_bf16 v[68:71], a[84:87], v[32:35], v[68:71]
  v_cvt_pk_bf16_f32 v140, v120, v121
  v_cvt_pk_bf16_f32 v141, v122, v123
  v_mfma_f32_16x16x32_bf16 v[80:83], a[88:91], v[32:35], v[80:83]
  buffer_load_dwordx4 v21, s[12:15], s19 offen lds
  v_mfma_f32_16x16x32_bf16 v[84:87], a[92:95], v[32:35], v[84:87]
  s_waitcnt lgkmcnt(5)
  v_cvt_pk_bf16_f32 v142, v124, v125
  v_cvt_pk_bf16_f32 v143, v126, v127
  v_mfma_f32_16x16x32_bf16 v[72:75], a[80:83], v[36:39], v[72:75]
  ds_read_b128 v[28:31], v9 offset:16384
  v_mfma_f32_16x16x32_bf16 v[76:79], a[84:87], v[36:39], v[76:79]
  v_mfma_f32_16x16x32_bf16 v[88:91], a[88:91], v[36:39], v[88:91]
  v_mfma_f32_16x16x32_bf16 v[92:95], a[92:95], v[36:39], v[92:95]
  s_waitcnt lgkmcnt(5)
  v_mfma_f32_16x16x32_bf16 v[64:67], a[96:99], v[40:43], v[64:67]
  s_add_u32 m0, s25, 6144
  ds_read_b128 v[32:35], v10 offset:16384
  v_mfma_f32_16x16x32_bf16 v[68:71], a[100:103], v[40:43], v[68:71]
  v_mfma_f32_16x16x32_bf16 v[80:83], a[104:107], v[40:43], v[80:83]
  buffer_load_dwordx4 v22, s[12:15], s19 offen lds
  v_mfma_f32_16x16x32_bf16 v[84:87], a[108:111], v[40:43], v[84:87]
  s_waitcnt lgkmcnt(5)
  v_mfma_f32_16x16x32_bf16 v[72:75], a[96:99], v[44:47], v[72:75]
  ds_read_b128 v[36:39], v11 offset:16384
  v_mfma_f32_16x16x32_bf16 v[76:79], a[100:103], v[44:47], v[76:79]
  v_mfma_f32_16x16x32_bf16 v[88:91], a[104:107], v[44:47], v[88:91]
  v_mfma_f32_16x16x32_bf16 v[92:95], a[108:111], v[44:47], v[92:95]
  s_waitcnt lgkmcnt(5)
  v_mfma_f32_16x16x32_bf16 v[64:67], a[112:115], v[48:51], v[64:67]
  s_add_u32 m0, s25, 7168
  ds_read_b128 v[40:43], v12 offset:16384
  v_mfma_f32_16x16x32_bf16 v[68:71], a[116:119], v[48:51], v[68:71]
  v_mfma_f32_16x16x32_bf16 v[80:83], a[120:123], v[48:51], v[80:83]
  buffer_load_dwordx4 v23, s[12:15], s19 offen lds
  v_mfma_f32_16x16x32_bf16 v[84:87], a[124:127], v[48:51], v[84:87]
  s_waitcnt lgkmcnt(5)
  v_mfma_f32_16x16x32_bf16 v[72:75], a[112:115], v[52:55], v[72:75]
  s_cmp_gt_u32 s23, 3
  ds_read_b128 v[44:47], v13 offset:16384
  v_mfma_f32_16x16x32_bf16 v[76:79], a[116:119], v[52:55], v[76:79]
  v_mfma_f32_16x16x32_bf16 v[88:91], a[120:123], v[52:55], v[88:91]
  s_cselect_b32 s26, s20, 0
  v_mfma_f32_16x16x32_bf16 v[92:95], a[124:127], v[52:55], v[92:95]
  s_waitcnt lgkmcnt(5)
  v_mfma_f32_16x16x32_bf16 v[64:67], a[128:131], v[24:27], v[64:67]
  s_add_u32 s19, s19, s26
  ds_read_b128 v[48:51], v14 offset:16384
  v_mfma_f32_16x16x32_bf16 v[68:71], a[132:135], v[24:27], v[68:71]
  v_mfma_f32_16x16x32_bf16 v[80:83], a[136:139], v[24:27], v[80:83]
  s_add_u32 s25, s25, 32768
  v_mfma_f32_16x16x32_bf16 v[84:87], a[140:143], v[24:27], v[84:87]
  s_waitcnt lgkmcnt(5)
  v_mfma_f32_16x16x32_bf16 v[72:75], a[128:131], v[28:31], v[72:75]
  s_and_b32 s25, s25, 0x1ffff
  ds_read_b128 v[52:55], v15 offset:16384
  v_mfma_f32_16x16x32_bf16 v[76:79], a[132:135], v[28:31], v[76:79]
  v_mfma_f32_16x16x32_bf16 v[88:91], a[136:139], v[28:31], v[88:91]
  buffer_store_dwordx4 v[128:131], v7, s[4:7], s21 offen offset:0 sc1
  v_mfma_f32_16x16x32_bf16 v[92:95], a[140:143], v[28:31], v[92:95]
  s_waitcnt lgkmcnt(5)
  v_mfma_f32_16x16x32_bf16 v[64:67], a[144:147], v[32:35], v[64:67]
  ds_read_b128 v[24:27], v8 offset:24576
  v_mfma_f32_16x16x32_bf16 v[68:71], a[148:151], v[32:35], v[68:71]
  v_mfma_f32_16x16x32_bf16 v[80:83], a[152:155], v[32:35], v[80:83]
  v_mfma_f32_16x16x32_bf16 v[84:87], a[156:159], v[32:35], v[84:87]
  s_waitcnt lgkmcnt(5)
  v_mfma_f32_16x16x32_bf16 v[72:75], a[144:147], v[36:39], v[72:75]
  ds_read_b128 v[28:31], v9 offset:24576
  v_mfma_f32_16x16x32_bf16 v[76:79], a[148:151], v[36:39], v[76:79]
  v_mfma_f32_16x16x32_bf16 v[88:91], a[152:155], v[36:39], v[88:91]
  buffer_store_dwordx4 v[132:135], v7, s[4:7], s21 offen offset:256 sc1
  v_mfma_f32_16x16x32_bf16 v[92:95], a[156:159], v[36:39], v[92:95]
  s_waitcnt lgkmcnt(5)
  v_mfma_f32_16x16x32_bf16 v[64:67], a[160:163], v[40:43], v[64:67]
  ds_read_b128 v[32:35], v10 offset:24576
  v_mfma_f32_16x16x32_bf16 v[68:71], a[164:167], v[40:43], v[68:71]
  v_mfma_f32_16x16x32_bf16 v[80:83], a[168:171], v[40:43], v[80:83]
  v_mfma_f32_16x16x32_bf16 v[84:87], a[172:175], v[40:43], v[84:87]
  s_waitcnt lgkmcnt(5)
  v_mfma_f32_16x16x32_bf16 v[72:75], a[160:163], v[44:47], v[72:75]
  ds_read_b128 v[36:39], v11 offset:24576
  v_mfma_f32_16x16x32_bf16 v[76:79], a[164:167], v[44:47], v[76:79]
  v_mfma_f32_16x16x32_bf16 v[88:91], a[168:171], v[44:47], v[88:91]
  buffer_store_dwordx4 v[136:139], v7, s[4:7], s21 offen offset:2048 sc1
  v_mfma_f32_16x16x32_bf16 v[92:95], a[172:175], v[44:47], v[92:95]
  s_waitcnt lgkmcnt(5)
  v_mfma_f32_16x16x32_bf16 v[64:67], a[176:179], v[48:51], v[64:67]
  ds_read_b128 v[40:43], v12 offset:24576
  v_mfma_f32_16x16x32_bf16 v[68:71], a[180:183], v[48:51], v[68:71]
  v_mfma_f32_16x16x32_bf16 v[80:83], a[184:187], v[48:51], v[80:83]
  v_mfma_f32_16x16x32_bf16 v[84:87], a[188:191], v[48:51], v[84:87]
  s_waitcnt lgkmcnt(5)
  v_mfma_f32_16x16x32_bf16 v[72:75], a[176:179], v[52:55], v[72:75]
  ds_read_b128 v[44:47], v13 offset:24576
  v_mfma_f32_16x16x32_bf16 v[76:79], a[180:183], v[52:55], v[76:79]
  v_mfma_f32_16x16x32_bf16 v[88:91], a[184:187], v[52:55], v[88:91]
  buffer_store_dwordx4 v[140:143], v7, s[4:7], s21 offen offset:2304 sc1
  v_mfma_f32_16x16x32_bf16 v[92:95], a[188:191], v[52:55], v[92:95]
  s_waitcnt lgkmcnt(5)
  v_mfma_f32_16x16x32_bf16 v[64:67], a[192:195], v[24:27], v[64:67]
  s_mov_b32 s21, s27
  ds_read_b128 v[48:51], v14 offset:24576
  v_mfma_f32_16x16x32_bf16 v[68:71], a[196:199], v[24:27], v[68:71]
  v_mov_b32 v7, v56
  v_mfma_f32_16x16x32_bf16 v[80:83], a[200:203], v[24:27], v[80:83]
  v_mfma_f32_16x16x32_bf16 v[84:87], a[204:207], v[24:27], v[84:87]
  s_waitcnt lgkmcnt(5)
  v_mfma_f32_16x16x32_bf16 v[72:75], a[192:195], v[28:31], v[72:75]
  s_add_u32 s27, s27, s22
  ds_read_b128 v[52:55], v15 offset:24576
  v_mfma_f32_16x16x32_bf16 v[76:79], a[196:199], v[28:31], v[76:79]
  v_mfma_f32_16x16x32_bf16 v[88:91], a[200:203], v[28:31], v[88:91]
  s_waitcnt vmcnt(13)
  s_barrier
  v_mfma_f32_16x16x32_bf16 v[92:95], a[204:207], v[28:31], v[92:95]
  s_waitcnt lgkmcnt(5)
  v_mfma_f32_16x16x32_bf16 v[64:67], a[208:211], v[32:35], v[64:67]
  ds_read_b128 v[24:27], v8 offset:32768
  v_mfma_f32_16x16x32_bf16 v[68:71], a[212:215], v[32:35], v[68:71]
  v_mfma_f32_16x16x32_bf16 v[80:83], a[216:219], v[32:35], v[80:83]
  v_mfma_f32_16x16x32_bf16 v[84:87], a[220:223], v[32:35], v[84:87]
  s_waitcnt lgkmcnt(5)
  v_mfma_f32_16x16x32_bf16 v[72:75], a[208:211], v[36:39], v[72:75]
  s_add_u32 s29, s29, 1
  ds_read_b128 v[28:31], v9 offset:32768
  v_mfma_f32_16x16x32_bf16 v[76:79], a[212:215], v[36:39], v[76:79]
  v_mfma_f32_16x16x32_bf16 v[88:91], a[216:219], v[36:39], v[88:91]
  s_max_i32 s30, s29, 0
  v_mfma_f32_16x16x32_bf16 v[92:95], a[220:223], v[36:39], v[92:95]
  s_waitcnt lgkmcnt(5)
  v_mov_b32 v144, s30
  v_mfma_f32_16x16x32_bf16 v[64:67], a[224:227], v[40:43], v[64:67]
  ds_read_b128 v[32:35], v10 offset:32768
  v_mfma_f32_16x16x32_bf16 v[68:71], a[228:231], v[40:43], v[68:71]
  v_mfma_f32_16x16x32_bf16 v[80:83], a[232:235], v[40:43], v[80:83]
  buffer_store_dword v144, v145, s[4:7], s31 offen sc1
  v_mfma_f32_16x16x32_bf16 v[84:87], a[236:239], v[40:43], v[84:87]
  s_waitcnt lgkmcnt(5)
  v_mfma_f32_16x16x32_bf16 v[72:75], a[224:227], v[44:47], v[72:75]
  ds_read_b128 v[36:39], v11 offset:32768
  v_mfma_f32_16x16x32_bf16 v[76:79], a[228:231], v[44:47], v[76:79]
  v_mfma_f32_16x16x32_bf16 v[88:91], a[232:235], v[44:47], v[88:91]
  v_mfma_f32_16x16x32_bf16 v[92:95], a[236:239], v[44:47], v[92:95]
  s_waitcnt lgkmcnt(5)
  v_mfma_f32_16x16x32_bf16 v[64:67], a[240:243], v[48:51], v[64:67]
  s_sub_u32 s23, s23, 1
  ds_read_b128 v[40:43], v12 offset:32768
  v_mfma_f32_16x16x32_bf16 v[68:71], a[244:247], v[48:51], v[68:71]
  v_mfma_f32_16x16x32_bf16 v[80:83], a[248:251], v[48:51], v[80:83]
  v_mfma_f32_16x16x32_bf16 v[84:87], a[252:255], v[48:51], v[84:87]
  s_waitcnt lgkmcnt(5)
  v_mfma_f32_16x16x32_bf16 v[72:75], a[240:243], v[52:55], v[72:75]
  s_cmp_eq_u32 s23, 0
  ds_read_b128 v[44:47], v13 offset:32768
  v_mfma_f32_16x16x32_bf16 v[76:79], a[244:247], v[52:55], v[76:79]
  v_mfma_f32_16x16x32_bf16 v[88:91], a[248:251], v[52:55], v[88:91]
  v_mfma_f32_16x16x32_bf16 v[92:95], a[252:255], v[52:55], v[92:95]
  s_cbranch_scc1 G_done0_134
  s_waitcnt lgkmcnt(5)
  v_mfma_f32_16x16x32_bf16 v[96:99], a[0:3], v[24:27], 0
  s_add_u32 m0, s25, 0
  ds_read_b128 v[48:51], v14 offset:32768
  v_mfma_f32_16x16x32_bf16 v[100:103], a[4:7], v[24:27], 0
  v_mfma_f32_16x16x32_bf16 v[112:115], a[8:11], v[24:27], 0
  buffer_load_dwordx4 v16, s[12:15], s19 offen lds
  v_mfma_f32_16x16x32_bf16 v[116:119], a[12:15], v[24:27], 0
  s_waitcnt lgkmcnt(5)
  v_mfma_f32_16x16x32_bf16 v[104:107], a[0:3], v[28:31], 0
  ds_read_b128 v[52:55], v15 offset:32768
  v_mfma_f32_16x16x32_bf16 v[108:111], a[4:7], v[28:31], 0
  v_cvt_pk_bf16_f32 v128, v64, v65
  v_cvt_pk_bf16_f32 v129, v66, v67
  v_mfma_f32_16x16x32_bf16 v[120:123], a[8:11], v[28:31], 0
  v_mfma_f32_16x16x32_bf16 v[124:127], a[12:15], v[28:31], 0
  s_waitcnt lgkmcnt(5)
  v_cvt_pk_bf16_f32 v130, v68, v69
  v_cvt_pk_bf16_f32 v131, v70, v71
  v_mfma_f32_16x16x32_bf16 v[96:99], a[16:19], v[32:35], v[96:99]
  s_add_u32 m0, s25, 1024
  ds_read_b128 v[24:27], v8 offset:40960
  v_mfma_f32_16x16x32_bf16 v[100:103], a[20:23], v[32:35], v[100:103]
  v_mfma_f32_16x16x32_bf16 v[112:115], a[24:27], v[32:35], v[112:115]
  buffer_load_dwordx4 v17, s[12:15], s19 offen lds
  v_mfma_f32_16x16x32_bf16 v[116:119], a[28:31], v[32:35], v[116:119]
  s_waitcnt lgkmcnt(5)
  v_mfma_f32_16x16x32_bf16 v[104:107], a[16:19], v[36:39], v[104:107]
  ds_read_b128 v[28:31], v9 offset:40960
  v_mfma_f32_16x16x32_bf16 v[108:111], a[20:23], v[36:39], v[108:111]
  v_mfma_f32_16x16x32_bf16 v[120:123], a[24:27], v[36:39], v[120:123]
  v_mfma_f32_16x16x32_bf16 v[124:127], a[28:31], v[36:39], v[124:127]
  s_waitcnt lgkmcnt(5)
  v_mfma_f32_16x16x32_bf16 v[96:99], a[32:35], v[40:43], v[96:99]
  s_add_u32 m0, s25, 2048
  ds_read_b128 v[32:35], v10 offset:40960
  v_mfma_f32_16x16x32_bf16 v[100:103], a[36:39], v[40:43], v[100:103]
  v_cvt_pk_bf16_f32 v132, v72, v73
  v_cvt_pk_bf16_f32 v133, v74, v75
  v_mfma_f32_16x16x32_bf16 v[112:115], a[40:43], v[40:43], v[112:115]
  buffer_load_dwordx4 v18, s[12:15], s19 offen lds
  v_mfma_f32_16x16x32_bf16 v[116:119], a[44:47], v[40:43], v[116:119]
  s_waitcnt lgkmcnt(5)
  v_cvt_pk_bf16_f32 v134, v76, v77
  v_cvt_pk_bf16_f32 v135, v78, v79
  v_mfma_f32_16x16x32_bf16 v[104:107], a[32:35], v[44:47], v[104:107]
  ds_read_b128 v[36:39], v11 offset:40960
  v_mfma_f32_16x16x32_bf16 v[108:111], a[36:39], v[44:47], v[108:111]
  v_mfma_f32_16x16x32_bf16 v[120:123], a[40:43], v[44:47], v[120:123]
  v_mfma_f32_16x16x32_bf16 v[124:127], a[44:47], v[44:47], v[124:127]
  s_waitcnt lgkmcnt(5)
  v_mfma_f32_16x16x32_bf16 v[96:99], a[48:51], v[48:51], v[96:99]
  s_add_u32 m0, s25, 3072
  ds_read_b128 v[40:43], v12 offset:40960
  v_mfma_f32_16x16x32_bf16 v[100:103], a[52:55], v[48:51], v[100:103]
  v_mfma_f32_16x16x32_bf16 v[112:115], a[56:59], v[48:51], v[112:115]
  buffer_load_dwordx4 v19, s[12:15], s19 offen lds
  v_mfma_f32_16x16x32_bf16 v[116:119], a[60:63], v[48:51], v[116:119]
  s_waitcnt lgkmcnt(5)
  v_mfma_f32_16x16x32_bf16 v[104:107], a[48:51], v[52:55], v[104:107]
  ds_read_b128 v[44:47], v13 offset:40960
  v_mfma_f32_16x16x32_bf16 v[108:111], a[52:55], v[52:55], v[108:111]
  v_cvt_pk_bf16_f32 v136, v80, v81
  v_cvt_pk_bf16_f32 v137, v82, v83
  v_mfma_f32_16x16x32_bf16 v[120:123], a[56:59], v[52:55], v[120:123]
  v_mfma_f32_16x16x32_bf16 v[124:127], a[60:63], v[52:55], v[124:127]
  s_waitcnt lgkmcnt(5)
  v_cvt_pk_bf16_f32 v138, v84, v85
  v_cvt_pk_bf16_f32 v139, v86, v87
  v_mfma_f32_16x16x32_bf16 v[96:99], a[64:67], v[24:27], v[96:99]
  s_add_u32 m0, s25, 4096
  ds_read_b128 v[48:51], v14 offset:40960
  v_mfma_f32_16x16x32_bf16 v[100:103], a[68:71], v[24:27], v[100:103]
  v_mfma_f32_16x16x32_bf16 v[112:115], a[72:75], v[24:27], v[112:115]
  buffer_load_dwordx4 v20, s[12:15], s19 offen lds
  v_mfma_f32_16x16x32_bf16 v[116:119], a[76:79], v[24:27], v[116:119]
  s_waitcnt lgkmcnt(5)
  v_mfma_f32_16x16x32_bf16 v[104:107], a[64:67], v[28:31], v[104:107]
  ds_read_b128 v[52:55], v15 offset:40960
  v_mfma_f32_16x16x32_bf16 v[108:111], a[68:71], v[28:31], v[108:111]
  v_mfma_f32_16x16x32_bf16 v[120:123], a[72:75], v[28:31], v[120:123]
  v_mfma_f32_16x16x32_bf16 v[124:127], a[76:79], v[28:31], v[124:127]
  s_waitcnt lgkmcnt(5)
  v_mfma_f32_16x16x32_bf16 v[96:99], a[80:83], v[32:35], v[96:99]
  s_add_u32 m0, s25, 5120
  ds_read_b128 v[24:27], v8 offset:49152
  v_mfma_f32_16x16x32_bf16 v[100:103], a[84:87], v[32:35], v[100:103]
  v_cvt_pk_bf16_f32 v140, v88, v89
  v_cvt_pk_bf16_f32 v141, v90, v91
  v_mfma_f32_16x16x32_bf16 v[112:115], a[88:91], v[32:35], v[112:115]
  buffer_load_dwordx4 v21, s[12:15], s19 offen lds
  v_mfma_f32_16x16x32_bf16 v[116:119], a[92:95], v[32:35], v[116:119]
  s_waitcnt lgkmcnt(5)
  v_cvt_pk_bf16_f32 v142, v92, v93
  v_cvt_pk_bf16_f32 v143, v94, v95
  v_mfma_f32_16x16x32_bf16 v[104:107], a[80:83], v[36:39], v[104:107]
  ds_read_b128 v[28:31], v9 offset:49152
  v_mfma_f32_16x16x32_bf16 v[108:111], a[84:87], v[36:39], v[108:111]
  v_mfma_f32_16x16x32_bf16 v[120:123], a[88:91], v[36:39], v[120:123]
  v_mfma_f32_16x16x32_bf16 v[124:127], a[92:95], v[36:39], v[124:127]
  s_waitcnt lgkmcnt(5)
  v_mfma_f32_16x16x32_bf16 v[96:99], a[96:99], v[40:43], v[96:99]
  s_add_u32 m0, s25, 6144
  ds_read_b128 v[32:35], v10 offset:49152
  v_mfma_f32_16x16x32_bf16 v[100:103], a[100:103], v[40:43], v[100:103]
  v_mfma_f32_16x16x32_bf16 v[112:115], a[104:107], v[40:43], v[112:115]
  buffer_load_dwordx4 v22, s[12:15], s19 offen lds
  v_mfma_f32_16x16x32_bf16 v[116:119], a[108:111], v[40:43], v[116:119]
  s_waitcnt lgkmcnt(5)
  v_mfma_f32_16x16x32_bf16 v[104:107], a[96:99], v[44:47], v[104:107]
  ds_read_b128 v[36:39], v11 offset:49152
  v_mfma_f32_16x16x32_bf16 v[108:111], a[100:103], v[44:47], v[108:111]
  v_mfma_f32_16x16x32_bf16 v[120:123], a[104:107], v[44:47], v[120:123]
  v_mfma_f32_16x16x32_bf16 v[124:127], a[108:111], v[44:47], v[124:127]
  s_waitcnt lgkmcnt(5)
  v_mfma_f32_16x16x32_bf16 v[96:99], a[112:115], v[48:51], v[96:99]
  s_add_u32 m0, s25, 7168
  ds_read_b128 v[40:43], v12 offset:49152
  v_mfma_f32_16x16x32_bf16 v[100:103], a[116:119], v[48:51], v[100:103]
  v_mfma_f32_16x16x32_bf16 v[112:115], a[120:123], v[48:51], v[112:115]
  buffer_load_dwordx4 v23, s[12:15], s19 offen lds
  v_mfma_f32_16x16x32_bf16 v[116:119], a[124:127], v[48:51], v[116:119]
  s_waitcnt lgkmcnt(5)
  v_mfma_f32_16x16x32_bf16 v[104:107], a[112:115], v[52:55], v[104:107]
  s_cmp_gt_u32 s23, 3
  ds_read_b128 v[44:47], v13 offset:49152
  v_mfma_f32_16x16x32_bf16 v[108:111], a[116:119], v[52:55], v[108:111]
  v_mfma_f32_16x16x32_bf16 v[120:123], a[120:123], v[52:55], v[120:123]
  s_cselect_b32 s26, s20, 0
  v_mfma_f32_16x16x32_bf16 v[124:127], a[124:127], v[52:55], v[124:127]
  s_waitcnt lgkmcnt(5)
  v_mfma_f32_16x16x32_bf16 v[96:99], a[128:131], v[24:27], v[96:99]
  s_add_u32 s19, s19, s26
  ds_read_b128 v[48:51], v14 offset:49152
  v_mfma_f32_16x16x32_bf16 v[100:103], a[132:135], v[24:27], v[100:103]
  v_mfma_f32_16x16x32_bf16 v[112:115], a[136:139], v[24:27], v[112:115]
  s_add_u32 s25, s25, 32768
  v_mfma_f32_16x16x32_bf16 v[116:119], a[140:143], v[24:27], v[116:119]
  s_waitcnt lgkmcnt(5)
  v_mfma_f32_16x16x32_bf16 v[104:107], a[128:131], v[28:31], v[104:107]
  s_and_b32 s25, s25, 0x1ffff
  ds_read_b128 v[52:55], v15 offset:49152
  v_mfma_f32_16x16x32_bf16 v[108:111], a[132:135], v[28:31], v[108:111]
  v_mfma_f32_16x16x32_bf16 v[120:123], a[136:139], v[28:31], v[120:123]
  buffer_store_dwordx4 v[128:131], v7, s[4:7], s21 offen offset:0 sc1
  v_mfma_f32_16x16x32_bf16 v[124:127], a[140:143], v[28:31], v[124:127]
  s_waitcnt lgkmcnt(5)
  v_mfma_f32_16x16x32_bf16 v[96:99], a[144:147], v[32:35], v[96:99]
  ds_read_b128 v[24:27], v8 offset:57344
  v_mfma_f32_16x16x32_bf16 v[100:103], a[148:151], v[32:35], v[100:103]
  v_mfma_f32_16x16x32_bf16 v[112:115], a[152:155], v[32:35], v[112:115]
  v_mfma_f32_16x16x32_bf16 v[116:119], a[156:159], v[32:35], v[116:119]
  s_waitcnt lgkmcnt(5)
  v_xor_b32 v8, 0x10000, v8
  v_mfma_f32_16x16x32_bf16 v[104:107], a[144:147], v[36:39], v[104:107]
  ds_read_b128 v[28:31], v9 offset:57344
  v_mfma_f32_16x16x32_bf16 v[108:111], a[148:151], v[36:39], v[108:111]
  v_mfma_f32_16x16x32_bf16 v[120:123], a[152:155], v[36:39], v[120:123]
  buffer_store_dwordx4 v[132:135], v7, s[4:7], s21 offen offset:256 sc1
  v_mfma_f32_16x16x32_bf16 v[124:127], a[156:159], v[36:39], v[124:127]
  s_waitcnt lgkmcnt(5)
  v_xor_b32 v9, 0x10000, v9
  v_mfma_f32_16x16x32_bf16 v[96:99], a[160:163], v[40:43], v[96:99]
  ds_read_b128 v[32:35], v10 offset:57344
  v_mfma_f32_16x16x32_bf16 v[100:103], a[164:167], v[40:43], v[100:103]
  v_mfma_f32_16x16x32_bf16 v[112:115], a[168:171], v[40:43], v[112:115]
  v_mfma_f32_16x16x32_bf16 v[116:119], a[172:175], v[40:43], v[116:119]
  s_waitcnt lgkmcnt(5)
  v_xor_b32 v10, 0x10000, v10
  v_mfma_f32_16x16x32_bf16 v[104:107], a[160:163], v[44:47], v[104:107]
  ds_read_b128 v[36:39], v11 offset:57344
  v_mfma_f32_16x16x32_bf16 v[108:111], a[164:167], v[44:47], v[108:111]
  v_mfma_f32_16x16x32_bf16 v[120:123], a[168:171], v[44:47], v[120:123]
  buffer_store_dwordx4 v[136:139], v7, s[4:7], s21 offen offset:2048 sc1
  v_mfma_f32_16x16x32_bf16 v[124:127], a[172:175], v[44:47], v[124:127]
  s_waitcnt lgkmcnt(5)
  v_xor_b32 v11, 0x10000, v11
  v_mfma_f32_16x16x32_bf16 v[96:99], a[176:179], v[48:51], v[96:99]
  ds_read_b128 v[40:43], v12 offset:57344
  v_mfma_f32_16x16x32_bf16 v[100:103], a[180:183], v[48:51], v[100:103]
  v_mfma_f32_16x16x32_bf16 v[112:115], a[184:187], v[48:51], v[112:115]
  v_mfma_f32_16x16x32_bf16 v[116:119], a[188:191], v[48:51], v[116:119]
  s_waitcnt lgkmcnt(5)
  v_xor_b32 v12, 0x10000, v12
  v_mfma_f32_16x16x32_bf16 v[104:107], a[176:179], v[52:55], v[104:107]
  ds_read_b128 v[44:47], v13 offset:57344
  v_mfma_f32_16x16x32_bf16 v[108:111], a[180:183], v[52:55], v[108:111]
  v_mfma_f32_16x16x32_bf16 v[120:123], a[184:187], v[52:55], v[120:123]
  buffer_store_dwordx4 v[140:143], v7, s[4:7], s21 offen offset:2304 sc1
  v_mfma_f32_16x16x32_bf16 v[124:127], a[188:191], v[52:55], v[124:127]
  s_waitcnt lgkmcnt(5)
  v_xor_b32 v13, 0x10000, v13
  v_mfma_f32_16x16x32_bf16 v[96:99], a[192:195], v[24:27], v[96:99]
  s_mov_b32 s21, s27
  ds_read_b128 v[48:51], v14 offset:57344
  v_mfma_f32_16x16x32_bf16 v[100:103], a[196:199], v[24:27], v[100:103]
  v_mov_b32 v7, v56
  v_mfma_f32_16x16x32_bf16 v[112:115], a[200:203], v[24:27], v[112:115]
  v_mfma_f32_16x16x32_bf16 v[116:119], a[204:207], v[24:27], v[116:119]
  s_waitcnt lgkmcnt(5)
  v_xor_b32 v14, 0x10000, v14
  v_mfma_f32_16x16x32_bf16 v[104:107], a[192:195], v[28:31], v[104:107]
  s_add_u32 s27, s27, s22
  ds_read_b128 v[52:55], v15 offset:57344
  v_mfma_f32_16x16x32_bf16 v[108:111], a[196:199], v[28:31], v[108:111]
  v_mfma_f32_16x16x32_bf16 v[120:123], a[200:203], v[28:31], v[120:123]
  s_waitcnt vmcnt(13)
  s_barrier
  v_mfma_f32_16x16x32_bf16 v[124:127], a[204:207], v[28:31], v[124:127]
  s_waitcnt lgkmcnt(5)
  v_xor_b32 v15, 0x10000, v15
  v_mfma_f32_16x16x32_bf16 v[96:99], a[208:211], v[32:35], v[96:99]
  ds_read_b128 v[24:27], v8 offset:0
  v_mfma_f32_16x16x32_bf16 v[100:103], a[212:215], v[32:35], v[100:103]
  v_mfma_f32_16x16x32_bf16 v[112:115], a[216:219], v[32:35], v[112:115]
  v_mfma_f32_16x16x32_bf16 v[116:119], a[220:223], v[32:35], v[116:119]
  s_waitcnt lgkmcnt(5)
  v_mfma_f32_16x16x32_bf16 v[104:107], a[208:211], v[36:39], v[104:107]
  s_add_u32 s29, s29, 1
  ds_read_b128 v[28:31], v9 offset:0
  v_mfma_f32_16x16x32_bf16 v[108:111], a[212:215], v[36:39], v[108:111]
  v_mfma_f32_16x16x32_bf16 v[120:123], a[216:219], v[36:39], v[120:123]
  s_max_i32 s30, s29, 0
  v_mfma_f32_16x16x32_bf16 v[124:127], a[220:223], v[36:39], v[124:127]
  s_waitcnt lgkmcnt(5)
  v_mov_b32 v144, s30
  v_mfma_f32_16x16x32_bf16 v[96:99], a[224:227], v[40:43], v[96:99]
  ds_read_b128 v[32:35], v10 offset:0
  v_mfma_f32_16x16x32_bf16 v[100:103], a[228:231], v[40:43], v[100:103]
  v_mfma_f32_16x16x32_bf16 v[112:115], a[232:235], v[40:43], v[112:115]
  buffer_store_dword v144, v145, s[4:7], s31 offen sc1
  v_mfma_f32_16x16x32_bf16 v[116:119], a[236:239], v[40:43], v[116:119]
  s_waitcnt lgkmcnt(5)
  v_mfma_f32_16x16x32_bf16 v[104:107], a[224:227], v[44:47], v[104:107]
  ds_read_b128 v[36:39], v11 offset:0
  v_mfma_f32_16x16x32_bf16 v[108:111], a[228:231], v[44:47], v[108:111]
  v_mfma_f32_16x16x32_bf16 v[120:123], a[232:235], v[44:47], v[120:123]
  v_mfma_f32_16x16x32_bf16 v[124:127], a[236:239], v[44:47], v[124:127]
  s_waitcnt lgkmcnt(5)
  v_mfma_f32_16x16x32_bf16 v[96:99], a[240:243], v[48:51], v[96:99]
  s_sub_u32 s23, s23, 1
  ds_read_b128 v[40:43], v12 offset:0
  v_mfma_f32_16x16x32_bf16 v[100:103], a[244:247], v[48:51], v[100:103]
  v_mfma_f32_16x16x32_bf16 v[112:115], a[248:251], v[48:51], v[112:115]
  v_mfma_f32_16x16x32_bf16 v[116:119], a[252:255], v[48:51], v[116:119]
  s_waitcnt lgkmcnt(5)
  v_mfma_f32_16x16x32_bf16 v[104:107], a[240:243], v[52:55], v[104:107]
  s_cmp_eq_u32 s23, 0
  ds_read_b128 v[44:47], v13 offset:0
  v_mfma_f32_16x16x32_bf16 v[108:111], a[244:247], v[52:55], v[108:111]
  v_mfma_f32_16x16x32_bf16 v[120:123], a[248:251], v[52:55], v[120:123]
  v_mfma_f32_16x16x32_bf16 v[124:127], a[252:255], v[52:55], v[124:127]
  s_cbranch_scc1 G_done1_135
  s_branch G_top_133
G_done0_134:
  s_nop 7
  s_nop 3
  v_cvt_pk_bf16_f32 v128, v64, v65
  v_cvt_pk_bf16_f32 v129, v66, v67
  v_cvt_pk_bf16_f32 v130, v68, v69
  v_cvt_pk_bf16_f32 v131, v70, v71
  buffer_store_dwordx4 v[128:131], v7, s[4:7], s21 offen offset:0 sc1
  v_cvt_pk_bf16_f32 v132, v72, v73
  v_cvt_pk_bf16_f32 v133, v74, v75
  v_cvt_pk_bf16_f32 v134, v76, v77
  v_cvt_pk_bf16_f32 v135, v78, v79
  buffer_store_dwordx4 v[132:135], v7, s[4:7], s21 offen offset:256 sc1
  v_cvt_pk_bf16_f32 v136, v80, v81
  v_cvt_pk_bf16_f32 v137, v82, v83
  v_cvt_pk_bf16_f32 v138, v84, v85
  v_cvt_pk_bf16_f32 v139, v86, v87
  buffer_store_dwordx4 v[136:139], v7, s[4:7], s21 offen offset:2048 sc1
  v_cvt_pk_bf16_f32 v140, v88, v89
  v_cvt_pk_bf16_f32 v141, v90, v91
  v_cvt_pk_bf16_f32 v142, v92, v93
  v_cvt_pk_bf16_f32 v143, v94, v95
  buffer_store_dwordx4 v[140:143], v7, s[4:7], s21 offen offset:2304 sc1
  s_branch G_fin_136
G_done1_135:
  s_nop 7
  s_nop 3
  v_cvt_pk_bf16_f32 v128, v96, v97
  v_cvt_pk_bf16_f32 v129, v98, v99
  v_cvt_pk_bf16_f32 v130, v100, v101
  v_cvt_pk_bf16_f32 v131, v102, v103
  buffer_store_dwordx4 v[128:131], v7, s[4:7], s21 offen offset:0 sc1
  v_cvt_pk_bf16_f32 v132, v104, v105
  v_cvt_pk_bf16_f32 v133, v106, v107
  v_cvt_pk_bf16_f32 v134, v108, v109
  v_cvt_pk_bf16_f32 v135, v110, v111
  buffer_store_dwordx4 v[132:135], v7, s[4:7], s21 offen offset:256 sc1
  v_cvt_pk_bf16_f32 v136, v112, v113
  v_cvt_pk_bf16_f32 v137, v114, v115
  v_cvt_pk_bf16_f32 v138, v116, v117
  v_cvt_pk_bf16_f32 v139, v118, v119
  buffer_store_dwordx4 v[136:139], v7, s[4:7], s21 offen offset:2048 sc1
  v_cvt_pk_bf16_f32 v140, v120, v121
  v_cvt_pk_bf16_f32 v141, v122, v123
  v_cvt_pk_bf16_f32 v142, v124, v125
  v_cvt_pk_bf16_f32 v143, v126, v127
  buffer_store_dwordx4 v[140:143], v7, s[4:7], s21 offen offset:2304 sc1
G_fin_136:
  s_waitcnt vmcnt(0) lgkmcnt(0)
  s_barrier
  s_add_u32 s30, s29, 2
  v_mov_b32 v144, s30
  v_min_u32 v145, 1, v0
  v_lshlrev_b32 v145, 30, v145
  buffer_store_dword v144, v145, s[4:7], s31 offen sc1
  s_branch P_end_131
P_q_132:
  s_mov_b32 s27, s21
  v_mov_b32 v7, 0x40000000
  s_mov_b32 s29, -2
  v_min_u32 v145, 1, v0
  v_lshlrev_b32 v145, 30, v145
  ds_read_b128 v[24:27], v8 offset:0
  ds_read_b128 v[28:31], v9 offset:0
  ds_read_b128 v[32:35], v10 offset:0
  ds_read_b128 v[36:39], v11 offset:0
  ds_read_b128 v[40:43], v12 offset:0
  ds_read_b128 v[44:47], v13 offset:0
.p2align 6
G_top_137:
  s_waitcnt lgkmcnt(5)
  v_mfma_f32_16x16x32_bf16 v[64:67], a[0:3], v[24:27], 0
  s_add_u32 m0, s25, 0
  ds_read_b128 v[48:51], v14 offset:0
  v_mfma_f32_16x16x32_bf16 v[68:71], a[4:7], v[24:27], 0
  v_mfma_f32_16x16x32_bf16 v[80:83], a[8:11], v[24:27], 0
  buffer_load_dwordx4 v16, s[12:15], s19 offen lds
  v_mfma_f32_16x16x32_bf16 v[84:87], a[12:15], v[24:27], 0
  s_waitcnt lgkmcnt(5)
  v_mfma_f32_16x16x32_bf16 v[72:75], a[0:3], v[28:31], 0
  ds_read_b128 v[52:55], v15 offset:0
  v_mfma_f32_16x16x32_bf16 v[76:79], a[4:7], v[28:31], 0
  v_mul_f32 v96, s24, v96
  v_mul_f32 v97, s24, v97
  v_mfma_f32_16x16x32_bf16 v[88:91], a[8:11], v[28:31], 0
  v_mfma_f32_16x16x32_bf16 v[92:95], a[12:15], v[28:31], 0
  s_waitcnt lgkmcnt(5)
  v_cvt_pk_bf16_f32 v128, v96, v97
  v_mul_f32 v98, s24, v98
  v_mfma_f32_16x16x32_bf16 v[64:67], a[16:19], v[32:35], v[64:67]
  s_add_u32 m0, s25, 1024
  ds_read_b128 v[24:27], v8 offset:8192
  v_mfma_f32_16x16x32_bf16 v[68:71], a[20:23], v[32:35], v[68:71]
  v_mul_f32 v99, s24, v99
  v_cvt_pk_bf16_f32 v129, v98, v99
  v_mfma_f32_16x16x32_bf16 v[80:83], a[24:27], v[32:35], v[80:83]
  buffer_load_dwordx4 v17, s[12:15], s19 offen lds
  v_mfma_f32_16x16x32_bf16 v[84:87], a[28:31], v[32:35], v[84:87]
  s_waitcnt lgkmcnt(5)
  v_mul_f32 v100, s24, v100
  v_mul_f32 v101, s24, v101
  v_mfma_f32_16x16x32_bf16 v[72:75], a[16:19], v[36:39], v[72:75]
  ds_read_b128 v[28:31], v9 offset:8192
  v_mfma_f32_16x16x32_bf16 v[76:79], a[20:23], v[36:39], v[76:79]
  v_cvt_pk_bf16_f32 v130, v100, v101
  v_mul_f32 v102, s24, v102
  v_mfma_f32_16x16x32_bf16 v[88:91], a[24:27], v[36:39], v[88:91]
  v_mfma_f32_16x16x32_bf16 v[92:95], a[28:31], v[36:39], v[92:95]
  s_waitcnt lgkmcnt(5)
  v_mul_f32 v103, s24, v103
  v_cvt_pk_bf16_f32 v131, v102, v103
  v_mfma_f32_16x16x32_bf16 v[64:67], a[32:35], v[40:43], v[64:67]
  s_add_u32 m0, s25, 2048
  ds_read_b128 v[32:35], v10 offset:8192
  v_mfma_f32_16x16x32_bf16 v[68:71], a[36:39], v[40:43], v[68:71]
  v_mul_f32 v104, s24, v104
  v_mul_f32 v105, s24, v105
  v_mfma_f32_16x16x32_bf16 v[80:83], a[40:43], v[40:43], v[80:83]
  buffer_load_dwordx4 v18, s[12:15], s19 offen lds
  v_mfma_f32_16x16x32_bf16 v[84:87], a[44:47], v[40:43], v[84:87]
  s_waitcnt lgkmcnt(5)
  v_cvt_pk_bf16_f32 v132, v104, v105
  v_mul_f32 v106, s24, v106
  v_mfma_f32_16x16x32_bf16 v[72:75], a[32:35], v[44:47], v[72:75]
  ds_read_b128 v[36:39], v11 offset:8192
  v_mfma_f32_16x16x32_bf16 v[76:79], a[36:39], v[44:47], v[76:79]
  v_mul_f32 v107, s24, v107
  v_cvt_pk_bf16_f32 v133, v106, v107
  v_mfma_f32_16x16x32_bf16 v[88:91], a[40:43], v[44:47], v[88:91]
  v_mfma_f32_16x16x32_bf16 v[92:95], a[44:47], v[44:47], v[92:95]
  s_waitcnt lgkmcnt(5)
  v_mul_f32 v108, s24, v108
  v_mul_f32 v109, s24, v109
  v_mfma_f32_16x16x32_bf16 v[64:67], a[48:51], v[48:51], v[64:67]
  s_add_u32 m0, s25, 3072
  ds_read_b128 v[40:43], v12 offset:8192
  v_mfma_f32_16x16x32_bf16 v[68:71], a[52:55], v[48:51], v[68:71]
  v_cvt_pk_bf16_f32 v134, v108, v109
  v_mul_f32 v110, s24, v110
  v_mfma_f32_16x16x32_bf16 v[80:83], a[56:59], v[48:51], v[80:83]
  buffer_load_dwordx4 v19, s[12:15], s19 offen lds
  v_mfma_f32_16x16x32_bf16 v[84:87], a[60:63], v[48:51], v[84:87]
  s_waitcnt lgkmcnt(5)
  v_mul_f32 v111, s24, v111
  v_cvt_pk_bf16_f32 v135, v110, v111
  v_mfma_f32_16x16x32_bf16 v[72:75], a[48:51], v[52:55], v[72:75]
  ds_read_b128 v[44:47], v13 offset:8192
  v_mfma_f32_16x16x32_bf16 v[76:79], a[52:55], v[52:55], v[76:79]
  v_mul_f32 v112, s24, v112
  v_mul_f32 v113, s24, v113
  v_mfma_f32_16x16x32_bf16 v[88:91], a[56:59], v[52:55], v[88:91]
  v_mfma_f32_16x16x32_bf16 v[92:95], a[60:63], v[52:55], v[92:95]
  s_waitcnt lgkmcnt(5)
  v_cvt_pk_bf16_f32 v136, v112, v113
  v_mul_f32 v114, s24, v114
  v_mfma_f32_16x16x32_bf16 v[64:67], a[64:67], v[24:27], v[64:67]
  s_add_u32 m0, s25, 4096
  ds_read_b128 v[48:51], v14 offset:8192
  v_mfma_f32_16x16x32_bf16 v[68:71], a[68:71], v[24:27], v[68:71]
  v_mul_f32 v115, s24, v115
  v_cvt_pk_bf16_f32 v137, v114, v115
  v_mfma_f32_16x16x32_bf16 v[80:83], a[72:75], v[24:27], v[80:83]
  buffer_load_dwordx4 v20, s[12:15], s19 offen lds
  v_mfma_f32_16x16x32_bf16 v[84:87], a[76:79], v[24:27], v[84:87]
  s_waitcnt lgkmcnt(5)
  v_mul_f32 v116, s24, v116
  v_mul_f32 v117, s24, v117
  v_mfma_f32_16x16x32_bf16 v[72:75], a[64:67], v[28:31], v[72:75]
  ds_read_b128 v[52:55], v15 offset:8192
  v_mfma_f32_16x16x32_bf16 v[76:79], a[68:71], v[28:31], v[76:79]
  v_cvt_pk_bf16_f32 v138, v116, v117
  v_mul_f32 v118, s24, v118
  v_mfma_f32_16x16x32_bf16 v[88:91], a[72:75], v[28:31], v[88:91]
  v_mfma_f32_16x16x32_bf16 v[92:95], a[76:79], v[28:31], v[92:95]
  s_waitcnt lgkmcnt(5)
  v_mul_f32 v119, s24, v119
  v_cvt_pk_bf16_f32 v139, v118, v119
  v_mfma_f32_16x16x32_bf16 v[64:67], a[80:83], v[32:35], v[64:67]
  s_add_u32 m0, s25, 5120
  ds_read_b128 v[24:27], v8 offset:16384
  v_mfma_f32_16x16x32_bf16 v[68:71], a[84:87], v[32:35], v[68:71]
  v_mul_f32 v120, s24, v120
  v_mul_f32 v121, s24, v121
  v_mfma_f32_16x16x32_bf16 v[80:83], a[88:91], v[32:35], v[80:83]
  buffer_load_dwordx4 v21, s[12:15], s19 offen lds
  v_mfma_f32_16x16x32_bf16 v[84:87], a[92:95], v[32:35], v[84:87]
  s_waitcnt lgkmcnt(5)
  v_cvt_pk_bf16_f32 v140, v120, v121
  v_mul_f32 v122, s24, v122
  v_mfma_f32_16x16x32_bf16 v[72:75], a[80:83], v[36:39], v[72:75]
  ds_read_b128 v[28:31], v9 offset:16384
  v_mfma_f32_16x16x32_bf16 v[76:79], a[84:87], v[36:39], v[76:79]
  v_mul_f32 v123, s24, v123
  v_cvt_pk_bf16_f32 v141, v122, v123
  v_mfma_f32_16x16x32_bf16 v[88:91], a[88:91], v[36:39], v[88:91]
  v_mfma_f32_16x16x32_bf16 v[92:95], a[92:95], v[36:39], v[92:95]
  s_waitcnt lgkmcnt(5)
  v_mul_f32 v124, s24, v124
  v_mul_f32 v125, s24, v125
  v_mfma_f32_16x16x32_bf16 v[64:67], a[96:99], v[40:43], v[64:67]
  s_add_u32 m0, s25, 6144
  ds_read_b128 v[32:35], v10 offset:16384
  v_mfma_f32_16x16x32_bf16 v[68:71], a[100:103], v[40:43], v[68:71]
  v_cvt_pk_bf16_f32 v142, v124, v125
  v_mul_f32 v126, s24, v126
  v_mfma_f32_16x16x32_bf16 v[80:83], a[104:107], v[40:43], v[80:83]
  buffer_load_dwordx4 v22, s[12:15], s19 offen lds
  v_mfma_f32_16x16x32_bf16 v[84:87], a[108:111], v[40:43], v[84:87]
  s_waitcnt lgkmcnt(5)
  v_mul_f32 v127, s24, v127
  v_cvt_pk_bf16_f32 v143, v126, v127
  v_mfma_f32_16x16x32_bf16 v[72:75], a[96:99], v[44:47], v[72:75]
  ds_read_b128 v[36:39], v11 offset:16384
  v_mfma_f32_16x16x32_bf16 v[76:79], a[100:103], v[44:47], v[76:79]
  v_mfma_f32_16x16x32_bf16 v[88:91], a[104:107], v[44:47], v[88:91]
  v_mfma_f32_16x16x32_bf16 v[92:95], a[108:111], v[44:47], v[92:95]
  s_waitcnt lgkmcnt(5)
  v_mfma_f32_16x16x32_bf16 v[64:67], a[112:115], v[48:51], v[64:67]
  s_add_u32 m0, s25, 7168
  ds_read_b128 v[40:43], v12 offset:16384
  v_mfma_f32_16x16x32_bf16 v[68:71], a[116:119], v[48:51], v[68:71]
  v_mfma_f32_16x16x32_bf16 v[80:83], a[120:123], v[48:51], v[80:83]
  buffer_load_dwordx4 v23, s[12:15], s19 offen lds
  v_mfma_f32_16x16x32_bf16 v[84:87], a[124:127], v[48:51], v[84:87]
  s_waitcnt lgkmcnt(5)
  v_mfma_f32_16x16x32_bf16 v[72:75], a[112:115], v[52:55], v[72:75]
  s_cmp_gt_u32 s23, 3
  ds_read_b128 v[44:47], v13 offset:16384
  v_mfma_f32_16x16x32_bf16 v[76:79], a[116:119], v[52:55], v[76:79]
  v_mfma_f32_16x16x32_bf16 v[88:91], a[120:123], v[52:55], v[88:91]
  s_cselect_b32 s26, s20, 0
  v_mfma_f32_16x16x32_bf16 v[92:95], a[124:127], v[52:55], v[92:95]
  s_waitcnt lgkmcnt(5)
  v_mfma_f32_16x16x32_bf16 v[64:67], a[128:131], v[24:27], v[64:67]
  s_add_u32 s19, s19, s26
  ds_read_b128 v[48:51], v14 offset:16384
  v_mfma_f32_16x16x32_bf16 v[68:71], a[132:135], v[24:27], v[68:71]
  v_mfma_f32_16x16x32_bf16 v[80:83], a[136:139], v[24:27], v[80:83]
  s_add_u32 s25, s25, 32768
  v_mfma_f32_16x16x32_bf16 v[84:87], a[140:143], v[24:27], v[84:87]
  s_waitcnt lgkmcnt(5)
  v_mfma_f32_16x16x32_bf16 v[72:75], a[128:131], v[28:31], v[72:75]
  s_and_b32 s25, s25, 0x1ffff
  ds_read_b128 v[52:55], v15 offset:16384
  v_mfma_f32_16x16x32_bf16 v[76:79], a[132:135], v[28:31], v[76:79]
  v_mfma_f32_16x16x32_bf16 v[88:91], a[136:139], v[28:31], v[88:91]
  buffer_store_dwordx4 v[128:131], v7, s[4:7], s21 offen offset:0 sc1
  v_mfma_f32_16x16x32_bf16 v[92:95], a[140:143], v[28:31], v[92:95]
  s_waitcnt lgkmcnt(5)
  v_mfma_f32_16x16x32_bf16 v[64:67], a[144:147], v[32:35], v[64:67]
  ds_read_b128 v[24:27], v8 offset:24576
  v_mfma_f32_16x16x32_bf16 v[68:71], a[148:151], v[32:35], v[68:71]
  v_mfma_f32_16x16x32_bf16 v[80:83], a[152:155], v[32:35], v[80:83]
  v_mfma_f32_16x16x32_bf16 v[84:87], a[156:159], v[32:35], v[84:87]
  s_waitcnt lgkmcnt(5)
  v_mfma_f32_16x16x32_bf16 v[72:75], a[144:147], v[36:39], v[72:75]
  ds_read_b128 v[28:31], v9 offset:24576
  v_mfma_f32_16x16x32_bf16 v[76:79], a[148:151], v[36:39], v[76:79]
  v_mfma_f32_16x16x32_bf16 v[88:91], a[152:155], v[36:39], v[88:91]
  buffer_store_dwordx4 v[132:135], v7, s[4:7], s21 offen offset:256 sc1
  v_mfma_f32_16x16x32_bf16 v[92:95], a[156:159], v[36:39], v[92:95]
  s_waitcnt lgkmcnt(5)
  v_mfma_f32_16x16x32_bf16 v[64:67], a[160:163], v[40:43], v[64:67]
  ds_read_b128 v[32:35], v10 offset:24576
  v_mfma_f32_16x16x32_bf16 v[68:71], a[164:167], v[40:43], v[68:71]
  v_mfma_f32_16x16x32_bf16 v[80:83], a[168:171], v[40:43], v[80:83]
  v_mfma_f32_16x16x32_bf16 v[84:87], a[172:175], v[40:43], v[84:87]
  s_waitcnt lgkmcnt(5)
  v_mfma_f32_16x16x32_bf16 v[72:75], a[160:163], v[44:47], v[72:75]
  ds_read_b128 v[36:39], v11 offset:24576
  v_mfma_f32_16x16x32_bf16 v[76:79], a[164:167], v[44:47], v[76:79]
  v_mfma_f32_16x16x32_bf16 v[88:91], a[168:171], v[44:47], v[88:91]
  buffer_store_dwordx4 v[136:139], v7, s[4:7], s21 offen offset:2048 sc1
  v_mfma_f32_16x16x32_bf16 v[92:95], a[172:175], v[44:47], v[92:95]
  s_waitcnt lgkmcnt(5)
  v_mfma_f32_16x16x32_bf16 v[64:67], a[176:179], v[48:51], v[64:67]
  ds_read_b128 v[40:43], v12 offset:24576
  v_mfma_f32_16x16x32_bf16 v[68:71], a[180:183], v[48:51], v[68:71]
  v_mfma_f32_16x16x32_bf16 v[80:83], a[184:187], v[48:51], v[80:83]
  v_mfma_f32_16x16x32_bf16 v[84:87], a[188:191], v[48:51], v[84:87]
  s_waitcnt lgkmcnt(5)
  v_mfma_f32_16x16x32_bf16 v[72:75], a[176:179], v[52:55], v[72:75]
  ds_read_b128 v[44:47], v13 offset:24576
  v_mfma_f32_16x16x32_bf16 v[76:79], a[180:183], v[52:55], v[76:79]
  v_mfma_f32_16x16x32_bf16 v[88:91], a[184:187], v[52:55], v[88:91]
  buffer_store_dwordx4 v[140:143], v7, s[4:7], s21 offen offset:2304 sc1
  v_mfma_f32_16x16x32_bf16 v[92:95], a[188:191], v[52:55], v[92:95]
  s_waitcnt lgkmcnt(5)
  v_mfma_f32_16x16x32_bf16 v[64:67], a[192:195], v[24:27], v[64:67]
  s_mov_b32 s21, s27
  ds_read_b128 v[48:51], v14 offset:24576
  v_mfma_f32_16x16x32_bf16 v[68:71], a[196:199], v[24:27], v[68:71]
  v_mov_b32 v7, v56
  v_mfma_f32_16x16x32_bf16 v[80:83], a[200:203], v[24:27], v[80:83]
  v_mfma_f32_16x16x32_bf16 v[84:87], a[204:207], v[24:27], v[84:87]
  s_waitcnt lgkmcnt(5)
  v_mfma_f32_16x16x32_bf16 v[72:75], a[192:195], v[28:31], v[72:75]
  s_add_u32 s27, s27, s22
  ds_read_b128 v[52:55], v15 offset:24576
  v_mfma_f32_16x16x32_bf16 v[76:79], a[196:199], v[28:31], v[76:79]
  v_mfma_f32_16x16x32_bf16 v[88:91], a[200:203], v[28:31], v[88:91]
  s_waitcnt vmcnt(13)
  s_barrier
  v_mfma_f32_16x16x32_bf16 v[92:95], a[204:207], v[28:31], v[92:95]
  s_waitcnt lgkmcnt(5)
  v_mfma_f32_16x16x32_bf16 v[64:67], a[208:211], v[32:35], v[64:67]
  ds_read_b128 v[24:27], v8 offset:32768
  v_mfma_f32_16x16x32_bf16 v[68:71], a[212:215], v[32:35], v[68:71]
  v_mfma_f32_16x16x32_bf16 v[80:83], a[216:219], v[32:35], v[80:83]
  v_mfma_f32_16x16x32_bf16 v[84:87], a[220:223], v[32:35], v[84:87]
  s_waitcnt lgkmcnt(5)
  v_mfma_f32_16x16x32_bf16 v[72:75], a[208:211], v[36:39], v[72:75]
  s_add_u32 s29, s29, 1
  ds_read_b128 v[28:31], v9 offset:32768
  v_mfma_f32_16x16x32_bf16 v[76:79], a[212:215], v[36:39], v[76:79]
  v_mfma_f32_16x16x32_bf16 v[88:91], a[216:219], v[36:39], v[88:91]
  s_max_i32 s30, s29, 0
  v_mfma_f32_16x16x32_bf16 v[92:95], a[220:223], v[36:39], v[92:95]
  s_waitcnt lgkmcnt(5)
  v_mov_b32 v144, s30
  v_mfma_f32_16x16x32_bf16 v[64:67], a[224:227], v[40:43], v[64:67]
  ds_read_b128 v[32:35], v10 offset:32768
  v_mfma_f32_16x16x32_bf16 v[68:71], a[228:231], v[40:43], v[68:71]
  v_mfma_f32_16x16x32_bf16 v[80:83], a[232:235], v[40:43], v[80:83]
  buffer_store_dword v144, v145, s[4:7], s31 offen sc1
  v_mfma_f32_16x16x32_bf16 v[84:87], a[236:239], v[40:43], v[84:87]
  s_waitcnt lgkmcnt(5)
  v_mfma_f32_16x16x32_bf16 v[72:75], a[224:227], v[44:47], v[72:75]
  ds_read_b128 v[36:39], v11 offset:32768
  v_mfma_f32_16x16x32_bf16 v[76:79], a[228:231], v[44:47], v[76:79]
  v_mfma_f32_16x16x32_bf16 v[88:91], a[232:235], v[44:47], v[88:91]
  v_mfma_f32_16x16x32_bf16 v[92:95], a[236:239], v[44:47], v[92:95]
  s_waitcnt lgkmcnt(5)
  v_mfma_f32_16x16x32_bf16 v[64:67], a[240:243], v[48:51], v[64:67]
  s_sub_u32 s23, s23, 1
  ds_read_b128 v[40:43], v12 offset:32768
  v_mfma_f32_16x16x32_bf16 v[68:71], a[244:247], v[48:51], v[68:71]
  v_mfma_f32_16x16x32_bf16 v[80:83], a[248:251], v[48:51], v[80:83]
  v_mfma_f32_16x16x32_bf16 v[84:87], a[252:255], v[48:51], v[84:87]
  s_waitcnt lgkmcnt(5)
  v_mfma_f32_16x16x32_bf16 v[72:75], a[240:243], v[52:55], v[72:75]
  s_cmp_eq_u32 s23, 0
  ds_read_b128 v[44:47], v13 offset:32768
  v_mfma_f32_16x16x32_bf16 v[76:79], a[244:247], v[52:55], v[76:79]
  v_mfma_f32_16x16x32_bf16 v[88:91], a[248:251], v[52:55], v[88:91]
  v_mfma_f32_16x16x32_bf16 v[92:95], a[252:255], v[52:55], v[92:95]
  s_cbranch_scc1 G_done0_138
  s_waitcnt lgkmcnt(5)
  v_mfma_f32_16x16x32_bf16 v[96:99], a[0:3], v[24:27], 0
  s_add_u32 m0, s25, 0
  ds_read_b128 v[48:51], v14 offset:32768
  v_mfma_f32_16x16x32_bf16 v[100:103], a[4:7], v[24:27], 0
  v_mfma_f32_16x16x32_bf16 v[112:115], a[8:11], v[24:27], 0
  buffer_load_dwordx4 v16, s[12:15], s19 offen lds
  v_mfma_f32_16x16x32_bf16 v[116:119], a[12:15], v[24:27], 0
  s_waitcnt lgkmcnt(5)
  v_mfma_f32_16x16x32_bf16 v[104:107], a[0:3], v[28:31], 0
  ds_read_b128 v[52:55], v15 offset:32768
  v_mfma_f32_16x16x32_bf16 v[108:111], a[4:7], v[28:31], 0
  v_mul_f32 v64, s24, v64
  v_mul_f32 v65, s24, v65
  v_mfma_f32_16x16x32_bf16 v[120:123], a[8:11], v[28:31], 0
  v_mfma_f32_16x16x32_bf16 v[124:127], a[12:15], v[28:31], 0
  s_waitcnt lgkmcnt(5)
  v_cvt_pk_bf16_f32 v128, v64, v65
  v_mul_f32 v66, s24, v66
  v_mfma_f32_16x16x32_bf16 v[96:99], a[16:19], v[32:35], v[96:99]
  s_add_u32 m0, s25, 1024
  ds_read_b128 v[24:27], v8 offset:40960
  v_mfma_f32_16x16x32_bf16 v[100:103], a[20:23], v[32:35], v[100:103]
  v_mul_f32 v67, s24, v67
  v_cvt_pk_bf16_f32 v129, v66, v67
  v_mfma_f32_16x16x32_bf16 v[112:115], a[24:27], v[32:35], v[112:115]
  buffer_load_dwordx4 v17, s[12:15], s19 offen lds
  v_mfma_f32_16x16x32_bf16 v[116:119], a[28:31], v[32:35], v[116:119]
  s_waitcnt lgkmcnt(5)
  v_mul_f32 v68, s24, v68
  v_mul_f32 v69, s24, v69
  v_mfma_f32_16x16x32_bf16 v[104:107], a[16:19], v[36:39], v[104:107]
  ds_read_b128 v[28:31], v9 offset:40960
  v_mfma_f32_16x16x32_bf16 v[108:111], a[20:23], v[36:39], v[108:111]
  v_cvt_pk_bf16_f32 v130, v68, v69
  v_mul_f32 v70, s24, v70
  v_mfma_f32_16x16x32_bf16 v[120:123], a[24:27], v[36:39], v[120:123]
  v_mfma_f32_16x16x32_bf16 v[124:127], a[28:31], v[36:39], v[124:127]
  s_waitcnt lgkmcnt(5)
  v_mul_f32 v71, s24, v71
  v_cvt_pk_bf16_f32 v131, v70, v71
  v_mfma_f32_16x16x32_bf16 v[96:99], a[32:35], v[40:43], v[96:99]
  s_add_u32 m0, s25, 2048
  ds_read_b128 v[32:35], v10 offset:40960
  v_mfma_f32_16x16x32_bf16 v[100:103], a[36:39], v[40:43], v[100:103]
  v_mul_f32 v72, s24, v72
  v_mul_f32 v73, s24, v73
  v_mfma_f32_16x16x32_bf16 v[112:115], a[40:43], v[40:43], v[112:115]
  buffer_load_dwordx4 v18, s[12:15], s19 offen lds
  v_mfma_f32_16x16x32_bf16 v[116:119], a[44:47], v[40:43], v[116:119]
  s_waitcnt lgkmcnt(5)
  v_cvt_pk_bf16_f32 v132, v72, v73
  v_mul_f32 v74, s24, v74
  v_mfma_f32_16x16x32_bf16 v[104:107], a[32:35], v[44:47], v[104:107]
  ds_read_b128 v[36:39], v11 offset:40960
  v_mfma_f32_16x16x32_bf16 v[108:111], a[36:39], v[44:47], v[108:111]
  v_mul_f32 v75, s24, v75
  v_cvt_pk_bf16_f32 v133, v74, v75
  v_mfma_f32_16x16x32_bf16 v[120:123], a[40:43], v[44:47], v[120:123]
  v_mfma_f32_16x16x32_bf16 v[124:127], a[44:47], v[44:47], v[124:127]
  s_waitcnt lgkmcnt(5)
  v_mul_f32 v76, s24, v76
  v_mul_f32 v77, s24, v77
  v_mfma_f32_16x16x32_bf16 v[96:99], a[48:51], v[48:51], v[96:99]
  s_add_u32 m0, s25, 3072
  ds_read_b128 v[40:43], v12 offset:40960
  v_mfma_f32_16x16x32_bf16 v[100:103], a[52:55], v[48:51], v[100:103]
  v_cvt_pk_bf16_f32 v134, v76, v77
  v_mul_f32 v78, s24, v78
  v_mfma_f32_16x16x32_bf16 v[112:115], a[56:59], v[48:51], v[112:115]
  buffer_load_dwordx4 v19, s[12:15], s19 offen lds
  v_mfma_f32_16x16x32_bf16 v[116:119], a[60:63], v[48:51], v[116:119]
  s_waitcnt lgkmcnt(5)
  v_mul_f32 v79, s24, v79
  v_cvt_pk_bf16_f32 v135, v78, v79
  v_mfma_f32_16x16x32_bf16 v[104:107], a[48:51], v[52:55], v[104:107]
  ds_read_b128 v[44:47], v13 offset:40960
  v_mfma_f32_16x16x32_bf16 v[108:111], a[52:55], v[52:55], v[108:111]
  v_mul_f32 v80, s24, v80
  v_mul_f32 v81, s24, v81
  v_mfma_f32_16x16x32_bf16 v[120:123], a[56:59], v[52:55], v[120:123]
  v_mfma_f32_16x16x32_bf16 v[124:127], a[60:63], v[52:55], v[124:127]
  s_waitcnt lgkmcnt(5)
  v_cvt_pk_bf16_f32 v136, v80, v81
  v_mul_f32 v82, s24, v82
  v_mfma_f32_16x16x32_bf16 v[96:99], a[64:67], v[24:27], v[96:99]
  s_add_u32 m0, s25, 4096
  ds_read_b128 v[48:51], v14 offset:40960
  v_mfma_f32_16x16x32_bf16 v[100:103], a[68:71], v[24:27], v[100:103]
  v_mul_f32 v83, s24, v83
  v_cvt_pk_bf16_f32 v137, v82, v83
  v_mfma_f32_16x16x32_bf16 v[112:115], a[72:75], v[24:27], v[112:115]
  buffer_load_dwordx4 v20, s[12:15], s19 offen lds
  v_mfma_f32_16x16x32_bf16 v[116:119], a[76:79], v[24:27], v[116:119]
  s_waitcnt lgkmcnt(5)
  v_mul_f32 v84, s24, v84
  v_mul_f32 v85, s24, v85
  v_mfma_f32_16x16x32_bf16 v[104:107], a[64:67], v[28:31], v[104:107]
  ds_read_b128 v[52:55], v15 offset:40960
  v_mfma_f32_16x16x32_bf16 v[108:111], a[68:71], v[28:31], v[108:111]
  v_cvt_pk_bf16_f32 v138, v84, v85
  v_mul_f32 v86, s24, v86
  v_mfma_f32_16x16x32_bf16 v[120:123], a[72:75], v[28:31], v[120:123]
  v_mfma_f32_16x16x32_bf16 v[124:127], a[76:79], v[28:31], v[124:127]
  s_waitcnt lgkmcnt(5)
  v_mul_f32 v87, s24, v87
  v_cvt_pk_bf16_f32 v139, v86, v87
  v_mfma_f32_16x16x32_bf16 v[96:99], a[80:83], v[32:35], v[96:99]
  s_add_u32 m0, s25, 5120
  ds_read_b128 v[24:27], v8 offset:49152
  v_mfma_f32_16x16x32_bf16 v[100:103], a[84:87], v[32:35], v[100:103]
  v_mul_f32 v88, s24, v88
  v_mul_f32 v89, s24, v89
  v_mfma_f32_16x16x32_bf16 v[112:115], a[88:91], v[32:35], v[112:115]
  buffer_load_dwordx4 v21, s[12:15], s19 offen lds
  v_mfma_f32_16x16x32_bf16 v[116:119], a[92:95], v[32:35], v[116:119]
  s_waitcnt lgkmcnt(5)
  v_cvt_pk_bf16_f32 v140, v88, v89
  v_mul_f32 v90, s24, v90
  v_mfma_f32_16x16x32_bf16 v[104:107], a[80:83], v[36:39], v[104:107]
  ds_read_b128 v[28:31], v9 offset:49152
  v_mfma_f32_16x16x32_bf16 v[108:111], a[84:87], v[36:39], v[108:111]
  v_mul_f32 v91, s24, v91
  v_cvt_pk_bf16_f32 v141, v90, v91
  v_mfma_f32_16x16x32_bf16 v[120:123], a[88:91], v[36:39], v[120:123]
  v_mfma_f32_16x16x32_bf16 v[124:127], a[92:95], v[36:39], v[124:127]
  s_waitcnt lgkmcnt(5)
  v_mul_f32 v92, s24, v92
  v_mul_f32 v93, s24, v93
  v_mfma_f32_16x16x32_bf16 v[96:99], a[96:99], v[40:43], v[96:99]
  s_add_u32 m0, s25, 6144
  ds_read_b128 v[32:35], v10 offset:49152
  v_mfma_f32_16x16x32_bf16 v[100:103], a[100:103], v[40:43], v[100:103]
  v_cvt_pk_bf16_f32 v142, v92, v93
  v_mul_f32 v94, s24, v94
  v_mfma_f32_16x16x32_bf16 v[112:115], a[104:107], v[40:43], v[112:115]
  buffer_load_dwordx4 v22, s[12:15], s19 offen lds
  v_mfma_f32_16x16x32_bf16 v[116:119], a[108:111], v[40:43], v[116:119]
  s_waitcnt lgkmcnt(5)
  v_mul_f32 v95, s24, v95
  v_cvt_pk_bf16_f32 v143, v94, v95
  v_mfma_f32_16x16x32_bf16 v[104:107], a[96:99], v[44:47], v[104:107]
  ds_read_b128 v[36:39], v11 offset:49152
  v_mfma_f32_16x16x32_bf16 v[108:111], a[100:103], v[44:47], v[108:111]
  v_mfma_f32_16x16x32_bf16 v[120:123], a[104:107], v[44:47], v[120:123]
  v_mfma_f32_16x16x32_bf16 v[124:127], a[108:111], v[44:47], v[124:127]
  s_waitcnt lgkmcnt(5)
  v_mfma_f32_16x16x32_bf16 v[96:99], a[112:115], v[48:51], v[96:99]
  s_add_u32 m0, s25, 7168
  ds_read_b128 v[40:43], v12 offset:49152
  v_mfma_f32_16x16x32_bf16 v[100:103], a[116:119], v[48:51], v[100:103]
  v_mfma_f32_16x16x32_bf16 v[112:115], a[120:123], v[48:51], v[112:115]
  buffer_load_dwordx4 v23, s[12:15], s19 offen lds
  v_mfma_f32_16x16x32_bf16 v[116:119], a[124:127], v[48:51], v[116:119]
  s_waitcnt lgkmcnt(5)
  v_mfma_f32_16x16x32_bf16 v[104:107], a[112:115], v[52:55], v[104:107]
  s_cmp_gt_u32 s23, 3
  ds_read_b128 v[44:47], v13 offset:49152
  v_mfma_f32_16x16x32_bf16 v[108:111], a[116:119], v[52:55], v[108:111]
  v_mfma_f32_16x16x32_bf16 v[120:123], a[120:123], v[52:55], v[120:123]
  s_cselect_b32 s26, s20, 0
  v_mfma_f32_16x16x32_bf16 v[124:127], a[124:127], v[52:55], v[124:127]
  s_waitcnt lgkmcnt(5)
  v_mfma_f32_16x16x32_bf16 v[96:99], a[128:131], v[24:27], v[96:99]
  s_add_u32 s19, s19, s26
  ds_read_b128 v[48:51], v14 offset:49152
  v_mfma_f32_16x16x32_bf16 v[100:103], a[132:135], v[24:27], v[100:103]
  v_mfma_f32_16x16x32_bf16 v[112:115], a[136:139], v[24:27], v[112:115]
  s_add_u32 s25, s25, 32768
  v_mfma_f32_16x16x32_bf16 v[116:119], a[140:143], v[24:27], v[116:119]
  s_waitcnt lgkmcnt(5)
  v_mfma_f32_16x16x32_bf16 v[104:107], a[128:131], v[28:31], v[104:107]
  s_and_b32 s25, s25, 0x1ffff
  ds_read_b128 v[52:55], v15 offset:49152
  v_mfma_f32_16x16x32_bf16 v[108:111], a[132:135], v[28:31], v[108:111]
  v_mfma_f32_16x16x32_bf16 v[120:123], a[136:139], v[28:31], v[120:123]
  buffer_store_dwordx4 v[128:131], v7, s[4:7], s21 offen offset:0 sc1
  v_mfma_f32_16x16x32_bf16 v[124:127], a[140:143], v[28:31], v[124:127]
  s_waitcnt lgkmcnt(5)
  v_mfma_f32_16x16x32_bf16 v[96:99], a[144:147], v[32:35], v[96:99]
  ds_read_b128 v[24:27], v8 offset:57344
  v_mfma_f32_16x16x32_bf16 v[100:103], a[148:151], v[32:35], v[100:103]
  v_mfma_f32_16x16x32_bf16 v[112:115], a[152:155], v[32:35], v[112:115]
  v_mfma_f32_16x16x32_bf16 v[116:119], a[156:159], v[32:35], v[116:119]
  s_waitcnt lgkmcnt(5)
  v_xor_b32 v8, 0x10000, v8
  v_mfma_f32_16x16x32_bf16 v[104:107], a[144:147], v[36:39], v[104:107]
  ds_read_b128 v[28:31], v9 offset:57344
  v_mfma_f32_16x16x32_bf16 v[108:111], a[148:151], v[36:39], v[108:111]
  v_mfma_f32_16x16x32_bf16 v[120:123], a[152:155], v[36:39], v[120:123]
  buffer_store_dwordx4 v[132:135], v7, s[4:7], s21 offen offset:256 sc1
  v_mfma_f32_16x16x32_bf16 v[124:127], a[156:159], v[36:39], v[124:127]
  s_waitcnt lgkmcnt(5)
  v_xor_b32 v9, 0x10000, v9
  v_mfma_f32_16x16x32_bf16 v[96:99], a[160:163], v[40:43], v[96:99]
  ds_read_b128 v[32:35], v10 offset:57344
  v_mfma_f32_16x16x32_bf16 v[100:103], a[164:167], v[40:43], v[100:103]
  v_mfma_f32_16x16x32_bf16 v[112:115], a[168:171], v[40:43], v[112:115]
  v_mfma_f32_16x16x32_bf16 v[116:119], a[172:175], v[40:43], v[116:119]
  s_waitcnt lgkmcnt(5)
  v_xor_b32 v10, 0x10000, v10
  v_mfma_f32_16x16x32_bf16 v[104:107], a[160:163], v[44:47], v[104:107]
  ds_read_b128 v[36:39], v11 offset:57344
  v_mfma_f32_16x16x32_bf16 v[108:111], a[164:167], v[44:47], v[108:111]
  v_mfma_f32_16x16x32_bf16 v[120:123], a[168:171], v[44:47], v[120:123]
  buffer_store_dwordx4 v[136:139], v7, s[4:7], s21 offen offset:2048 sc1
  v_mfma_f32_16x16x32_bf16 v[124:127], a[172:175], v[44:47], v[124:127]
  s_waitcnt lgkmcnt(5)
  v_xor_b32 v11, 0x10000, v11
  v_mfma_f32_16x16x32_bf16 v[96:99], a[176:179], v[48:51], v[96:99]
  ds_read_b128 v[40:43], v12 offset:57344
  v_mfma_f32_16x16x32_bf16 v[100:103], a[180:183], v[48:51], v[100:103]
  v_mfma_f32_16x16x32_bf16 v[112:115], a[184:187], v[48:51], v[112:115]
  v_mfma_f32_16x16x32_bf16 v[116:119], a[188:191], v[48:51], v[116:119]
  s_waitcnt lgkmcnt(5)
  v_xor_b32 v12, 0x10000, v12
  v_mfma_f32_16x16x32_bf16 v[104:107], a[176:179], v[52:55], v[104:107]
  ds_read_b128 v[44:47], v13 offset:57344
  v_mfma_f32_16x16x32_bf16 v[108:111], a[180:183], v[52:55], v[108:111]
  v_mfma_f32_16x16x32_bf16 v[120:123], a[184:187], v[52:55], v[120:123]
  buffer_store_dwordx4 v[140:143], v7, s[4:7], s21 offen offset:2304 sc1
  v_mfma_f32_16x16x32_bf16 v[124:127], a[188:191], v[52:55], v[124:127]
  s_waitcnt lgkmcnt(5)
  v_xor_b32 v13, 0x10000, v13
  v_mfma_f32_16x16x32_bf16 v[96:99], a[192:195], v[24:27], v[96:99]
  s_mov_b32 s21, s27
  ds_read_b128 v[48:51], v14 offset:57344
  v_mfma_f32_16x16x32_bf16 v[100:103], a[196:199], v[24:27], v[100:103]
  v_mov_b32 v7, v56
  v_mfma_f32_16x16x32_bf16 v[112:115], a[200:203], v[24:27], v[112:115]
  v_mfma_f32_16x16x32_bf16 v[116:119], a[204:207], v[24:27], v[116:119]
  s_waitcnt lgkmcnt(5)
  v_xor_b32 v14, 0x10000, v14
  v_mfma_f32_16x16x32_bf16 v[104:107], a[192:195], v[28:31], v[104:107]
  s_add_u32 s27, s27, s22
  ds_read_b128 v[52:55], v15 offset:57344
  v_mfma_f32_16x16x32_bf16 v[108:111], a[196:199], v[28:31], v[108:111]
  v_mfma_f32_16x16x32_bf16 v[120:123], a[200:203], v[28:31], v[120:123]
  s_waitcnt vmcnt(13)
  s_barrier
  v_mfma_f32_16x16x32_bf16 v[124:127], a[204:207], v[28:31], v[124:127]
  s_waitcnt lgkmcnt(5)
  v_xor_b32 v15, 0x10000, v15
  v_mfma_f32_16x16x32_bf16 v[96:99], a[208:211], v[32:35], v[96:99]
  ds_read_b128 v[24:27], v8 offset:0
  v_mfma_f32_16x16x32_bf16 v[100:103], a[212:215], v[32:35], v[100:103]
  v_mfma_f32_16x16x32_bf16 v[112:115], a[216:219], v[32:35], v[112:115]
  v_mfma_f32_16x16x32_bf16 v[116:119], a[220:223], v[32:35], v[116:119]
  s_waitcnt lgkmcnt(5)
  v_mfma_f32_16x16x32_bf16 v[104:107], a[208:211], v[36:39], v[104:107]
  s_add_u32 s29, s29, 1
  ds_read_b128 v[28:31], v9 offset:0
  v_mfma_f32_16x16x32_bf16 v[108:111], a[212:215], v[36:39], v[108:111]
  v_mfma_f32_16x16x32_bf16 v[120:123], a[216:219], v[36:39], v[120:123]
  s_max_i32 s30, s29, 0
  v_mfma_f32_16x16x32_bf16 v[124:127], a[220:223], v[36:39], v[124:127]
  s_waitcnt lgkmcnt(5)
  v_mov_b32 v144, s30
  v_mfma_f32_16x16x32_bf16 v[96:99], a[224:227], v[40:43], v[96:99]
  ds_read_b128 v[32:35], v10 offset:0
  v_mfma_f32_16x16x32_bf16 v[100:103], a[228:231], v[40:43], v[100:103]
  v_mfma_f32_16x16x32_bf16 v[112:115], a[232:235], v[40:43], v[112:115]
  buffer_store_dword v144, v145, s[4:7], s31 offen sc1
  v_mfma_f32_16x16x32_bf16 v[116:119], a[236:239], v[40:43], v[116:119]
  s_waitcnt lgkmcnt(5)
  v_mfma_f32_16x16x32_bf16 v[104:107], a[224:227], v[44:47], v[104:107]
  ds_read_b128 v[36:39], v11 offset:0
  v_mfma_f32_16x16x32_bf16 v[108:111], a[228:231], v[44:47], v[108:111]
  v_mfma_f32_16x16x32_bf16 v[120:123], a[232:235], v[44:47], v[120:123]
  v_mfma_f32_16x16x32_bf16 v[124:127], a[236:239], v[44:47], v[124:127]
  s_waitcnt lgkmcnt(5)
  v_mfma_f32_16x16x32_bf16 v[96:99], a[240:243], v[48:51], v[96:99]
  s_sub_u32 s23, s23, 1
  ds_read_b128 v[40:43], v12 offset:0
  v_mfma_f32_16x16x32_bf16 v[100:103], a[244:247], v[48:51], v[100:103]
  v_mfma_f32_16x16x32_bf16 v[112:115], a[248:251], v[48:51], v[112:115]
  v_mfma_f32_16x16x32_bf16 v[116:119], a[252:255], v[48:51], v[116:119]
  s_waitcnt lgkmcnt(5)
  v_mfma_f32_16x16x32_bf16 v[104:107], a[240:243], v[52:55], v[104:107]
  s_cmp_eq_u32 s23, 0
  ds_read_b128 v[44:47], v13 offset:0
  v_mfma_f32_16x16x32_bf16 v[108:111], a[244:247], v[52:55], v[108:111]
  v_mfma_f32_16x16x32_bf16 v[120:123], a[248:251], v[52:55], v[120:123]
  v_mfma_f32_16x16x32_bf16 v[124:127], a[252:255], v[52:55], v[124:127]
  s_cbranch_scc1 G_done1_139
  s_branch G_top_137
G_done0_138:
  s_nop 7
  s_nop 3
  v_mul_f32 v64, s24, v64
  v_mul_f32 v65, s24, v65
  v_cvt_pk_bf16_f32 v128, v64, v65
  v_mul_f32 v66, s24, v66
  v_mul_f32 v67, s24, v67
  v_cvt_pk_bf16_f32 v129, v66, v67
  v_mul_f32 v68, s24, v68
  v_mul_f32 v69, s24, v69
  v_cvt_pk_bf16_f32 v130, v68, v69
  v_mul_f32 v70, s24, v70
  v_mul_f32 v71, s24, v71
  v_cvt_pk_bf16_f32 v131, v70, v71
  buffer_store_dwordx4 v[128:131], v7, s[4:7], s21 offen offset:0 sc1
  v_mul_f32 v72, s24, v72
  v_mul_f32 v73, s24, v73
  v_cvt_pk_bf16_f32 v132, v72, v73
  v_mul_f32 v74, s24, v74
  v_mul_f32 v75, s24, v75
  v_cvt_pk_bf16_f32 v133, v74, v75
  v_mul_f32 v76, s24, v76
  v_mul_f32 v77, s24, v77
  v_cvt_pk_bf16_f32 v134, v76, v77
  v_mul_f32 v78, s24, v78
  v_mul_f32 v79, s24, v79
  v_cvt_pk_bf16_f32 v135, v78, v79
  buffer_store_dwordx4 v[132:135], v7, s[4:7], s21 offen offset:256 sc1
  v_mul_f32 v80, s24, v80
  v_mul_f32 v81, s24, v81
  v_cvt_pk_bf16_f32 v136, v80, v81
  v_mul_f32 v82, s24, v82
  v_mul_f32 v83, s24, v83
  v_cvt_pk_bf16_f32 v137, v82, v83
  v_mul_f32 v84, s24, v84
  v_mul_f32 v85, s24, v85
  v_cvt_pk_bf16_f32 v138, v84, v85
  v_mul_f32 v86, s24, v86
  v_mul_f32 v87, s24, v87
  v_cvt_pk_bf16_f32 v139, v86, v87
  buffer_store_dwordx4 v[136:139], v7, s[4:7], s21 offen offset:2048 sc1
  v_mul_f32 v88, s24, v88
  v_mul_f32 v89, s24, v89
  v_cvt_pk_bf16_f32 v140, v88, v89
  v_mul_f32 v90, s24, v90
  v_mul_f32 v91, s24, v91
  v_cvt_pk_bf16_f32 v141, v90, v91
  v_mul_f32 v92, s24, v92
  v_mul_f32 v93, s24, v93
  v_cvt_pk_bf16_f32 v142, v92, v93
  v_mul_f32 v94, s24, v94
  v_mul_f32 v95, s24, v95
  v_cvt_pk_bf16_f32 v143, v94, v95
  buffer_store_dwordx4 v[140:143], v7, s[4:7], s21 offen offset:2304 sc1
  s_branch G_fin_140
G_done1_139:
  s_nop 7
  s_nop 3
  v_mul_f32 v96, s24, v96
  v_mul_f32 v97, s24, v97
  v_cvt_pk_bf16_f32 v128, v96, v97
  v_mul_f32 v98, s24, v98
  v_mul_f32 v99, s24, v99
  v_cvt_pk_bf16_f32 v129, v98, v99
  v_mul_f32 v100, s24, v100
  v_mul_f32 v101, s24, v101
  v_cvt_pk_bf16_f32 v130, v100, v101
  v_mul_f32 v102, s24, v102
  v_mul_f32 v103, s24, v103
  v_cvt_pk_bf16_f32 v131, v102, v103
  buffer_store_dwordx4 v[128:131], v7, s[4:7], s21 offen offset:0 sc1
  v_mul_f32 v104, s24, v104
  v_mul_f32 v105, s24, v105
  v_cvt_pk_bf16_f32 v132, v104, v105
  v_mul_f32 v106, s24, v106
  v_mul_f32 v107, s24, v107
  v_cvt_pk_bf16_f32 v133, v106, v107
  v_mul_f32 v108, s24, v108
  v_mul_f32 v109, s24, v109
  v_cvt_pk_bf16_f32 v134, v108, v109
  v_mul_f32 v110, s24, v110
  v_mul_f32 v111, s24, v111
  v_cvt_pk_bf16_f32 v135, v110, v111
  buffer_store_dwordx4 v[132:135], v7, s[4:7], s21 offen offset:256 sc1
  v_mul_f32 v112, s24, v112
  v_mul_f32 v113, s24, v113
  v_cvt_pk_bf16_f32 v136, v112, v113
  v_mul_f32 v114, s24, v114
  v_mul_f32 v115, s24, v115
  v_cvt_pk_bf16_f32 v137, v114, v115
  v_mul_f32 v116, s24, v116
  v_mul_f32 v117, s24, v117
  v_cvt_pk_bf16_f32 v138, v116, v117
  v_mul_f32 v118, s24, v118
  v_mul_f32 v119, s24, v119
  v_cvt_pk_bf16_f32 v139, v118, v119
  buffer_store_dwordx4 v[136:139], v7, s[4:7], s21 offen offset:2048 sc1
  v_mul_f32 v120, s24, v120
  v_mul_f32 v121, s24, v121
  v_cvt_pk_bf16_f32 v140, v120, v121
  v_mul_f32 v122, s24, v122
  v_mul_f32 v123, s24, v123
  v_cvt_pk_bf16_f32 v141, v122, v123
  v_mul_f32 v124, s24, v124
  v_mul_f32 v125, s24, v125
  v_cvt_pk_bf16_f32 v142, v124, v125
  v_mul_f32 v126, s24, v126
  v_mul_f32 v127, s24, v127
  v_cvt_pk_bf16_f32 v143, v126, v127
  buffer_store_dwordx4 v[140:143], v7, s[4:7], s21 offen offset:2304 sc1
G_fin_140:
  s_waitcnt vmcnt(0) lgkmcnt(0)
  s_barrier
  s_add_u32 s30, s29, 2
  v_mov_b32 v144, s30
  v_min_u32 v145, 1, v0
  v_lshlrev_b32 v145, 30, v145
  buffer_store_dword v144, v145, s[4:7], s31 offen sc1
  s_branch P_end_131
P_v_130:
  s_mov_b32 s27, s21
  v_mov_b32 v7, 0x40000000
  s_mov_b32 s29, -2
  v_min_u32 v145, 1, v0
  v_lshlrev_b32 v145, 30, v145
  ds_read_b128 v[24:27], v8 offset:0
  ds_read_b128 v[28:31], v9 offset:0
  ds_read_b128 v[32:35], v10 offset:0
  ds_read_b128 v[36:39], v11 offset:0
  ds_read_b128 v[40:43], v12 offset:0
  ds_read_b128 v[44:47], v13 offset:0
.p2align 6
G_top_141:
  s_waitcnt lgkmcnt(5)
  v_mfma_f32_16x16x32_bf16 v[64:67], v[24:27], a[0:3], 0
  s_add_u32 m0, s25, 0
  ds_read_b128 v[48:51], v14 offset:0
  v_mfma_f32_16x16x32_bf16 v[72:75], v[24:27], a[4:7], 0
  v_mfma_f32_16x16x32_bf16 v[80:83], v[24:27], a[8:11], 0
  buffer_load_dwordx4 v16, s[12:15], s19 offen lds
  v_mfma_f32_16x16x32_bf16 v[88:91], v[24:27], a[12:15], 0
  s_waitcnt lgkmcnt(5)
  v_mfma_f32_16x16x32_bf16 v[68:71], v[28:31], a[0:3], 0
  ds_read_b128 v[52:55], v15 offset:0
  v_mfma_f32_16x16x32_bf16 v[76:79], v[28:31], a[4:7], 0
  v_cvt_pk_bf16_f32 v128, v96, v97
  v_cvt_pk_bf16_f32 v129, v98, v99
  v_mfma_f32_16x16x32_bf16 v[84:87], v[28:31], a[8:11], 0
  v_mfma_f32_16x16x32_bf16 v[92:95], v[28:31], a[12:15], 0
  s_waitcnt lgkmcnt(5)
  v_cvt_pk_bf16_f32 v130, v100, v101
  v_cvt_pk_bf16_f32 v131, v102, v103
  v_mfma_f32_16x16x32_bf16 v[64:67], v[32:35], a[16:19], v[64:67]
  s_add_u32 m0, s25, 1024
  ds_read_b128 v[24:27], v8 offset:8192
  v_mfma_f32_16x16x32_bf16 v[72:75], v[32:35], a[20:23], v[72:75]
  v_mfma_f32_16x16x32_bf16 v[80:83], v[32:35], a[24:27], v[80:83]
  buffer_load_dwordx4 v17, s[12:15], s19 offen lds
  v_mfma_f32_16x16x32_bf16 v[88:91], v[32:35], a[28:31], v[88:91]
  s_waitcnt lgkmcnt(5)
  v_mfma_f32_16x16x32_bf16 v[68:71], v[36:39], a[16:19], v[68:71]
  ds_read_b128 v[28:31], v9 offset:8192
  v_mfma_f32_16x16x32_bf16 v[76:79], v[36:39], a[20:23], v[76:79]
  v_mfma_f32_16x16x32_bf16 v[84:87], v[36:39], a[24:27], v[84:87]
  v_mfma_f32_16x16x32_bf16 v[92:95], v[36:39], a[28:31], v[92:95]
  s_waitcnt lgkmcnt(5)
  v_mfma_f32_16x16x32_bf16 v[64:67], v[40:43], a[32:35], v[64:67]
  s_add_u32 m0, s25, 2048
  ds_read_b128 v[32:35], v10 offset:8192
  v_mfma_f32_16x16x32_bf16 v[72:75], v[40:43], a[36:39], v[72:75]
  v_cvt_pk_bf16_f32 v132, v104, v105
  v_cvt_pk_bf16_f32 v133, v106, v107
  v_mfma_f32_16x16x32_bf16 v[80:83], v[40:43], a[40:43], v[80:83]
  buffer_load_dwordx4 v18, s[12:15], s19 offen lds
  v_mfma_f32_16x16x32_bf16 v[88:91], v[40:43], a[44:47], v[88:91]
  s_waitcnt lgkmcnt(5)
  v_cvt_pk_bf16_f32 v134, v108, v109
  v_cvt_pk_bf16_f32 v135, v110, v111
  v_mfma_f32_16x16x32_bf16 v[68:71], v[44:47], a[32:35], v[68:71]
  ds_read_b128 v[36:39], v11 offset:8192
  v_mfma_f32_16x16x32_bf16 v[76:79], v[44:47], a[36:39], v[76:79]
  v_mfma_f32_16x16x32_bf16 v[84:87], v[44:47], a[40:43], v[84:87]
  v_mfma_f32_16x16x32_bf16 v[92:95], v[44:47], a[44:47], v[92:95]
  s_waitcnt lgkmcnt(5)
  v_mfma_f32_16x16x32_bf16 v[64:67], v[48:51], a[48:51], v[64:67]
  s_add_u32 m0, s25, 3072
  ds_read_b128 v[40:43], v12 offset:8192
  v_mfma_f32_16x16x32_bf16 v[72:75], v[48:51], a[52:55], v[72:75]
  v_mfma_f32_16x16x32_bf16 v[80:83], v[48:51], a[56:59], v[80:83]
  buffer_load_dwordx4 v19, s[12:15], s19 offen lds
  v_mfma_f32_16x16x32_bf16 v[88:91], v[48:51], a[60:63], v[88:91]
  s_waitcnt lgkmcnt(5)
  v_mfma_f32_16x16x32_bf16 v[68:71], v[52:55], a[48:51], v[68:71]
  ds_read_b128 v[44:47], v13 offset:8192
  v_mfma_f32_16x16x32_bf16 v[76:79], v[52:55], a[52:55], v[76:79]
  v_cvt_pk_bf16_f32 v136, v112, v113
  v_cvt_pk_bf16_f32 v137, v114, v115
  v_mfma_f32_16x16x32_bf16 v[84:87], v[52:55], a[56:59], v[84:87]
  v_mfma_f32_16x16x32_bf16 v[92:95], v[52:55], a[60:63], v[92:95]
  s_waitcnt lgkmcnt(5)
  v_cvt_pk_bf16_f32 v138, v116, v117
  v_cvt_pk_bf16_f32 v139, v118, v119
  v_mfma_f32_16x16x32_bf16 v[64:67], v[24:27], a[64:67], v[64:67]
  s_add_u32 m0, s25, 4096
  ds_read_b128 v[48:51], v14 offset:8192
  v_mfma_f32_16x16x32_bf16 v[72:75], v[24:27], a[68:71], v[72:75]
  v_mfma_f32_16x16x32_bf16 v[80:83], v[24:27], a[72:75], v[80:83]
  buffer_load_dwordx4 v20, s[12:15], s19 offen lds
  v_mfma_f32_16x16x32_bf16 v[88:91], v[24:27], a[76:79], v[88:91]
  s_waitcnt lgkmcnt(5)
  v_mfma_f32_16x16x32_bf16 v[68:71], v[28:31], a[64:67], v[68:71]
  ds_read_b128 v[52:55], v15 offset:8192
  v_mfma_f32_16x16x32_bf16 v[76:79], v[28:31], a[68:71], v[76:79]
  v_mfma_f32_16x16x32_bf16 v[84:87], v[28:31], a[72:75], v[84:87]
  v_mfma_f32_16x16x32_bf16 v[92:95], v[28:31], a[76:79], v[92:95]
  s_waitcnt lgkmcnt(5)
  v_mfma_f32_16x16x32_bf16 v[64:67], v[32:35], a[80:83], v[64:67]
  s_add_u32 m0, s25, 5120
  ds_read_b128 v[24:27], v8 offset:16384
  v_mfma_f32_16x16x32_bf16 v[72:75], v[32:35], a[84:87], v[72:75]
  v_cvt_pk_bf16_f32 v140, v120, v121
  v_cvt_pk_bf16_f32 v141, v122, v123
  v_mfma_f32_16x16x32_bf16 v[80:83], v[32:35], a[88:91], v[80:83]
  buffer_load_dwordx4 v21, s[12:15], s19 offen lds
  v_mfma_f32_16x16x32_bf16 v[88:91], v[32:35], a[92:95], v[88:91]
  s_waitcnt lgkmcnt(5)
  v_cvt_pk_bf16_f32 v142, v124, v125
  v_cvt_pk_bf16_f32 v143, v126, v127
  v_mfma_f32_16x16x32_bf16 v[68:71], v[36:39], a[80:83], v[68:71]
  ds_read_b128 v[28:31], v9 offset:16384
  v_mfma_f32_16x16x32_bf16 v[76:79], v[36:39], a[84:87], v[76:79]
  v_mfma_f32_16x16x32_bf16 v[84:87], v[36:39], a[88:91], v[84:87]
  v_mfma_f32_16x16x32_bf16 v[92:95], v[36:39], a[92:95], v[92:95]
  s_waitcnt lgkmcnt(5)
  v_mfma_f32_16x16x32_bf16 v[64:67], v[40:43], a[96:99], v[64:67]
  s_add_u32 m0, s25, 6144
  ds_read_b128 v[32:35], v10 offset:16384
  v_mfma_f32_16x16x32_bf16 v[72:75], v[40:43], a[100:103], v[72:75]
  v_mfma_f32_16x16x32_bf16 v[80:83], v[40:43], a[104:107], v[80:83]
  buffer_load_dwordx4 v22, s[12:15], s19 offen lds
  v_mfma_f32_16x16x32_bf16 v[88:91], v[40:43], a[108:111], v[88:91]
  s_waitcnt lgkmcnt(5)
  v_mfma_f32_16x16x32_bf16 v[68:71], v[44:47], a[96:99], v[68:71]
  ds_read_b128 v[36:39], v11 offset:16384
  v_mfma_f32_16x16x32_bf16 v[76:79], v[44:47], a[100:103], v[76:79]
  v_mfma_f32_16x16x32_bf16 v[84:87], v[44:47], a[104:107], v[84:87]
  v_mfma_f32_16x16x32_bf16 v[92:95], v[44:47], a[108:111], v[92:95]
  s_waitcnt lgkmcnt(5)
  v_mfma_f32_16x16x32_bf16 v[64:67], v[48:51], a[112:115], v[64:67]
  s_add_u32 m0, s25, 7168
  ds_read_b128 v[40:43], v12 offset:16384
  v_mfma_f32_16x16x32_bf16 v[72:75], v[48:51], a[116:119], v[72:75]
  v_mfma_f32_16x16x32_bf16 v[80:83], v[48:51], a[120:123], v[80:83]
  buffer_load_dwordx4 v23, s[12:15], s19 offen lds
  v_mfma_f32_16x16x32_bf16 v[88:91], v[48:51], a[124:127], v[88:91]
  s_waitcnt lgkmcnt(5)
  v_mfma_f32_16x16x32_bf16 v[68:71], v[52:55], a[112:115], v[68:71]
  s_cmp_gt_u32 s23, 3
  ds_read_b128 v[44:47], v13 offset:16384
  v_mfma_f32_16x16x32_bf16 v[76:79], v[52:55], a[116:119], v[76:79]
  v_mfma_f32_16x16x32_bf16 v[84:87], v[52:55], a[120:123], v[84:87]
  s_cselect_b32 s26, s20, 0
  v_mfma_f32_16x16x32_bf16 v[92:95], v[52:55], a[124:127], v[92:95]
  s_waitcnt lgkmcnt(5)
  v_mfma_f32_16x16x32_bf16 v[64:67], v[24:27], a[128:131], v[64:67]
  s_add_u32 s19, s19, s26
  ds_read_b128 v[48:51], v14 offset:16384
  v_mfma_f32_16x16x32_bf16 v[72:75], v[24:27], a[132:135], v[72:75]
  v_mfma_f32_16x16x32_bf16 v[80:83], v[24:27], a[136:139], v[80:83]
  s_add_u32 s25, s25, 32768
  v_mfma_f32_16x16x32_bf16 v[88:91], v[24:27], a[140:143], v[88:91]
  s_waitcnt lgkmcnt(5)
  v_mfma_f32_16x16x32_bf16 v[68:71], v[28:31], a[128:131], v[68:71]
  s_and_b32 s25, s25, 0x1ffff
  ds_read_b128 v[52:55], v15 offset:16384
  v_mfma_f32_16x16x32_bf16 v[76:79], v[28:31], a[132:135], v[76:79]
  v_mfma_f32_16x16x32_bf16 v[84:87], v[28:31], a[136:139], v[84:87]
  buffer_store_dwordx4 v[128:131], v7, s[4:7], s21 offen offset:0 sc1
  v_mfma_f32_16x16x32_bf16 v[92:95], v[28:31], a[140:143], v[92:95]
  s_waitcnt lgkmcnt(5)
  v_mfma_f32_16x16x32_bf16 v[64:67], v[32:35], a[144:147], v[64:67]
  ds_read_b128 v[24:27], v8 offset:24576
  v_mfma_f32_16x16x32_bf16 v[72:75], v[32:35], a[148:151], v[72:75]
  v_mfma_f32_16x16x32_bf16 v[80:83], v[32:35], a[152:155], v[80:83]
  v_mfma_f32_16x16x32_bf16 v[88:91], v[32:35], a[156:159], v[88:91]
  s_waitcnt lgkmcnt(5)
  v_mfma_f32_16x16x32_bf16 v[68:71], v[36:39], a[144:147], v[68:71]
  ds_read_b128 v[28:31], v9 offset:24576
  v_mfma_f32_16x16x32_bf16 v[76:79], v[36:39], a[148:151], v[76:79]
  v_mfma_f32_16x16x32_bf16 v[84:87], v[36:39], a[152:155], v[84:87]
  buffer_store_dwordx4 v[132:135], v7, s[4:7], s21 offen offset:256 sc1
  v_mfma_f32_16x16x32_bf16 v[92:95], v[36:39], a[156:159], v[92:95]
  s_waitcnt lgkmcnt(5)
  v_mfma_f32_16x16x32_bf16 v[64:67], v[40:43], a[160:163], v[64:67]
  ds_read_b128 v[32:35], v10 offset:24576
  v_mfma_f32_16x16x32_bf16 v[72:75], v[40:43], a[164:167], v[72:75]
  v_mfma_f32_16x16x32_bf16 v[80:83], v[40:43], a[168:171], v[80:83]
  v_mfma_f32_16x16x32_bf16 v[88:91], v[40:43], a[172:175], v[88:91]
  s_waitcnt lgkmcnt(5)
  v_mfma_f32_16x16x32_bf16 v[68:71], v[44:47], a[160:163], v[68:71]
  ds_read_b128 v[36:39], v11 offset:24576
  v_mfma_f32_16x16x32_bf16 v[76:79], v[44:47], a[164:167], v[76:79]
  v_mfma_f32_16x16x32_bf16 v[84:87], v[44:47], a[168:171], v[84:87]
  buffer_store_dwordx4 v[136:139], v7, s[4:7], s21 offen offset:2048 sc1
  v_mfma_f32_16x16x32_bf16 v[92:95], v[44:47], a[172:175], v[92:95]
  s_waitcnt lgkmcnt(5)
  v_mfma_f32_16x16x32_bf16 v[64:67], v[48:51], a[176:179], v[64:67]
  ds_read_b128 v[40:43], v12 offset:24576
  v_mfma_f32_16x16x32_bf16 v[72:75], v[48:51], a[180:183], v[72:75]
  v_mfma_f32_16x16x32_bf16 v[80:83], v[48:51], a[184:187], v[80:83]
  v_mfma_f32_16x16x32_bf16 v[88:91], v[48:51], a[188:191], v[88:91]
  s_waitcnt lgkmcnt(5)
  v_mfma_f32_16x16x32_bf16 v[68:71], v[52:55], a[176:179], v[68:71]
  ds_read_b128 v[44:47], v13 offset:24576
  v_mfma_f32_16x16x32_bf16 v[76:79], v[52:55], a[180:183], v[76:79]
  v_mfma_f32_16x16x32_bf16 v[84:87], v[52:55], a[184:187], v[84:87]
  buffer_store_dwordx4 v[140:143], v7, s[4:7], s21 offen offset:2304 sc1
  v_mfma_f32_16x16x32_bf16 v[92:95], v[52:55], a[188:191], v[92:95]
  s_waitcnt lgkmcnt(5)
  v_mfma_f32_16x16x32_bf16 v[64:67], v[24:27], a[192:195], v[64:67]
  s_mov_b32 s21, s27
  ds_read_b128 v[48:51], v14 offset:24576
  v_mfma_f32_16x16x32_bf16 v[72:75], v[24:27], a[196:199], v[72:75]
  v_mov_b32 v7, v56
  v_mfma_f32_16x16x32_bf16 v[80:83], v[24:27], a[200:203], v[80:83]
  v_mfma_f32_16x16x32_bf16 v[88:91], v[24:27], a[204:207], v[88:91]
  s_waitcnt lgkmcnt(5)
  v_mfma_f32_16x16x32_bf16 v[68:71], v[28:31], a[192:195], v[68:71]
  s_add_u32 s27, s27, s22
  ds_read_b128 v[52:55], v15 offset:24576
  v_mfma_f32_16x16x32_bf16 v[76:79], v[28:31], a[196:199], v[76:79]
  v_mfma_f32_16x16x32_bf16 v[84:87], v[28:31], a[200:203], v[84:87]
  s_waitcnt vmcnt(13)
  s_barrier
  v_mfma_f32_16x16x32_bf16 v[92:95], v[28:31], a[204:207], v[92:95]
  s_waitcnt lgkmcnt(5)
  v_mfma_f32_16x16x32_bf16 v[64:67], v[32:35], a[208:211], v[64:67]
  ds_read_b128 v[24:27], v8 offset:32768
  v_mfma_f32_16x16x32_bf16 v[72:75], v[32:35], a[212:215], v[72:75]
  v_mfma_f32_16x16x32_bf16 v[80:83], v[32:35], a[216:219], v[80:83]
  v_mfma_f32_16x16x32_bf16 v[88:91], v[32:35], a[220:223], v[88:91]
  s_waitcnt lgkmcnt(5)
  v_mfma_f32_16x16x32_bf16 v[68:71], v[36:39], a[208:211], v[68:71]
  s_add_u32 s29, s29, 1
  ds_read_b128 v[28:31], v9 offset:32768
  v_mfma_f32_16x16x32_bf16 v[76:79], v[36:39], a[212:215], v[76:79]
  v_mfma_f32_16x16x32_bf16 v[84:87], v[36:39], a[216:219], v[84:87]
  s_max_i32 s30, s29, 0
  v_mfma_f32_16x16x32_bf16 v[92:95], v[36:39], a[220:223], v[92:95]
  s_waitcnt lgkmcnt(5)
  v_mov_b32 v144, s30
  v_mfma_f32_16x16x32_bf16 v[64:67], v[40:43], a[224:227], v[64:67]
  ds_read_b128 v[32:35], v10 offset:32768
  v_mfma_f32_16x16x32_bf16 v[72:75], v[40:43], a[228:231], v[72:75]
  v_mfma_f32_16x16x32_bf16 v[80:83], v[40:43], a[232:235], v[80:83]
  buffer_store_dword v144, v145, s[4:7], s31 offen sc1
  v_mfma_f32_16x16x32_bf16 v[88:91], v[40:43], a[236:239], v[88:91]
  s_waitcnt lgkmcnt(5)
  v_mfma_f32_16x16x32_bf16 v[68:71], v[44:47], a[224:227], v[68:71]
  ds_read_b128 v[36:39], v11 offset:32768
  v_mfma_f32_16x16x32_bf16 v[76:79], v[44:47], a[228:231], v[76:79]
  v_mfma_f32_16x16x32_bf16 v[84:87], v[44:47], a[232:235], v[84:87]
  v_mfma_f32_16x16x32_bf16 v[92:95], v[44:47], a[236:239], v[92:95]
  s_waitcnt lgkmcnt(5)
  v_mfma_f32_16x16x32_bf16 v[64:67], v[48:51], a[240:243], v[64:67]
  s_sub_u32 s23, s23, 1
  ds_read_b128 v[40:43], v12 offset:32768
  v_mfma_f32_16x16x32_bf16 v[72:75], v[48:51], a[244:247], v[72:75]
  v_mfma_f32_16x16x32_bf16 v[80:83], v[48:51], a[248:251], v[80:83]
  v_mfma_f32_16x16x32_bf16 v[88:91], v[48:51], a[252:255], v[88:91]
  s_waitcnt lgkmcnt(5)
  v_mfma_f32_16x16x32_bf16 v[68:71], v[52:55], a[240:243], v[68:71]
  s_cmp_eq_u32 s23, 0
  ds_read_b128 v[44:47], v13 offset:32768
  v_mfma_f32_16x16x32_bf16 v[76:79], v[52:55], a[244:247], v[76:79]
  v_mfma_f32_16x16x32_bf16 v[84:87], v[52:55], a[248:251], v[84:87]
  v_mfma_f32_16x16x32_bf16 v[92:95], v[52:55], a[252:255], v[92:95]
  s_cbranch_scc1 G_done0_142
  s_waitcnt lgkmcnt(5)
  v_mfma_f32_16x16x32_bf16 v[96:99], v[24:27], a[0:3], 0
  s_add_u32 m0, s25, 0
  ds_read_b128 v[48:51], v14 offset:32768
  v_mfma_f32_16x16x32_bf16 v[104:107], v[24:27], a[4:7], 0
  v_mfma_f32_16x16x32_bf16 v[112:115], v[24:27], a[8:11], 0
  buffer_load_dwordx4 v16, s[12:15], s19 offen lds
  v_mfma_f32_16x16x32_bf16 v[120:123], v[24:27], a[12:15], 0
  s_waitcnt lgkmcnt(5)
  v_mfma_f32_16x16x32_bf16 v[100:103], v[28:31], a[0:3], 0
  ds_read_b128 v[52:55], v15 offset:32768
  v_mfma_f32_16x16x32_bf16 v[108:111], v[28:31], a[4:7], 0
  v_cvt_pk_bf16_f32 v128, v64, v65
  v_cvt_pk_bf16_f32 v129, v66, v67
  v_mfma_f32_16x16x32_bf16 v[116:119], v[28:31], a[8:11], 0
  v_mfma_f32_16x16x32_bf16 v[124:127], v[28:31], a[12:15], 0
  s_waitcnt lgkmcnt(5)
  v_cvt_pk_bf16_f32 v130, v68, v69
  v_cvt_pk_bf16_f32 v131, v70, v71
  v_mfma_f32_16x16x32_bf16 v[96:99], v[32:35], a[16:19], v[96:99]
  s_add_u32 m0, s25, 1024
  ds_read_b128 v[24:27], v8 offset:40960
  v_mfma_f32_16x16x32_bf16 v[104:107], v[32:35], a[20:23], v[104:107]
  v_mfma_f32_16x16x32_bf16 v[112:115], v[32:35], a[24:27], v[112:115]
  buffer_load_dwordx4 v17, s[12:15], s19 offen lds
  v_mfma_f32_16x16x32_bf16 v[120:123], v[32:35], a[28:31], v[120:123]
  s_waitcnt lgkmcnt(5)
  v_mfma_f32_16x16x32_bf16 v[100:103], v[36:39], a[16:19], v[100:103]
  ds_read_b128 v[28:31], v9 offset:40960
  v_mfma_f32_16x16x32_bf16 v[108:111], v[36:39], a[20:23], v[108:111]
  v_mfma_f32_16x16x32_bf16 v[116:119], v[36:39], a[24:27], v[116:119]
  v_mfma_f32_16x16x32_bf16 v[124:127], v[36:39], a[28:31], v[124:127]
  s_waitcnt lgkmcnt(5)
  v_mfma_f32_16x16x32_bf16 v[96:99], v[40:43], a[32:35], v[96:99]
  s_add_u32 m0, s25, 2048
  ds_read_b128 v[32:35], v10 offset:40960
  v_mfma_f32_16x16x32_bf16 v[104:107], v[40:43], a[36:39], v[104:107]
  v_cvt_pk_bf16_f32 v132, v72, v73
  v_cvt_pk_bf16_f32 v133, v74, v75
  v_mfma_f32_16x16x32_bf16 v[112:115], v[40:43], a[40:43], v[112:115]
  buffer_load_dwordx4 v18, s[12:15], s19 offen lds
  v_mfma_f32_16x16x32_bf16 v[120:123], v[40:43], a[44:47], v[120:123]
  s_waitcnt lgkmcnt(5)
  v_cvt_pk_bf16_f32 v134, v76, v77
  v_cvt_pk_bf16_f32 v135, v78, v79
  v_mfma_f32_16x16x32_bf16 v[100:103], v[44:47], a[32:35], v[100:103]
  ds_read_b128 v[36:39], v11 offset:40960
  v_mfma_f32_16x16x32_bf16 v[108:111], v[44:47], a[36:39], v[108:111]
  v_mfma_f32_16x16x32_bf16 v[116:119], v[44:47], a[40:43], v[116:119]
  v_mfma_f32_16x16x32_bf16 v[124:127], v[44:47], a[44:47], v[124:127]
  s_waitcnt lgkmcnt(5)
  v_mfma_f32_16x16x32_bf16 v[96:99], v[48:51], a[48:51], v[96:99]
  s_add_u32 m0, s25, 3072
  ds_read_b128 v[40:43], v12 offset:40960
  v_mfma_f32_16x16x32_bf16 v[104:107], v[48:51], a[52:55], v[104:107]
  v_mfma_f32_16x16x32_bf16 v[112:115], v[48:51], a[56:59], v[112:115]
  buffer_load_dwordx4 v19, s[12:15], s19 offen lds
  v_mfma_f32_16x16x32_bf16 v[120:123], v[48:51], a[60:63], v[120:123]
  s_waitcnt lgkmcnt(5)
  v_mfma_f32_16x16x32_bf16 v[100:103], v[52:55], a[48:51], v[100:103]
  ds_read_b128 v[44:47], v13 offset:40960
  v_mfma_f32_16x16x32_bf16 v[108:111], v[52:55], a[52:55], v[108:111]
  v_cvt_pk_bf16_f32 v136, v80, v81
  v_cvt_pk_bf16_f32 v137, v82, v83
  v_mfma_f32_16x16x32_bf16 v[116:119], v[52:55], a[56:59], v[116:119]
  v_mfma_f32_16x16x32_bf16 v[124:127], v[52:55], a[60:63], v[124:127]
  s_waitcnt lgkmcnt(5)
  v_cvt_pk_bf16_f32 v138, v84, v85
  v_cvt_pk_bf16_f32 v139, v86, v87
  v_mfma_f32_16x16x32_bf16 v[96:99], v[24:27], a[64:67], v[96:99]
  s_add_u32 m0, s25, 4096
  ds_read_b128 v[48:51], v14 offset:40960
  v_mfma_f32_16x16x32_bf16 v[104:107], v[24:27], a[68:71], v[104:107]
  v_mfma_f32_16x16x32_bf16 v[112:115], v[24:27], a[72:75], v[112:115]
  buffer_load_dwordx4 v20, s[12:15], s19 offen lds
  v_mfma_f32_16x16x32_bf16 v[120:123], v[24:27], a[76:79], v[120:123]
  s_waitcnt lgkmcnt(5)
  v_mfma_f32_16x16x32_bf16 v[100:103], v[28:31], a[64:67], v[100:103]
  ds_read_b128 v[52:55], v15 offset:40960
  v_mfma_f32_16x16x32_bf16 v[108:111], v[28:31], a[68:71], v[108:111]
  v_mfma_f32_16x16x32_bf16 v[116:119], v[28:31], a[72:75], v[116:119]
  v_mfma_f32_16x16x32_bf16 v[124:127], v[28:31], a[76:79], v[124:127]
  s_waitcnt lgkmcnt(5)
  v_mfma_f32_16x16x32_bf16 v[96:99], v[32:35], a[80:83], v[96:99]
  s_add_u32 m0, s25, 5120
  ds_read_b128 v[24:27], v8 offset:49152
  v_mfma_f32_16x16x32_bf16 v[104:107], v[32:35], a[84:87], v[104:107]
  v_cvt_pk_bf16_f32 v140, v88, v89
  v_cvt_pk_bf16_f32 v141, v90, v91
  v_mfma_f32_16x16x32_bf16 v[112:115], v[32:35], a[88:91], v[112:115]
  buffer_load_dwordx4 v21, s[12:15], s19 offen lds
  v_mfma_f32_16x16x32_bf16 v[120:123], v[32:35], a[92:95], v[120:123]
  s_waitcnt lgkmcnt(5)
  v_cvt_pk_bf16_f32 v142, v92, v93
  v_cvt_pk_bf16_f32 v143, v94, v95
  v_mfma_f32_16x16x32_bf16 v[100:103], v[36:39], a[80:83], v[100:103]
  ds_read_b128 v[28:31], v9 offset:49152
  v_mfma_f32_16x16x32_bf16 v[108:111], v[36:39], a[84:87], v[108:111]
  v_mfma_f32_16x16x32_bf16 v[116:119], v[36:39], a[88:91], v[116:119]
  v_mfma_f32_16x16x32_bf16 v[124:127], v[36:39], a[92:95], v[124:127]
  s_waitcnt lgkmcnt(5)
  v_mfma_f32_16x16x32_bf16 v[96:99], v[40:43], a[96:99], v[96:99]
  s_add_u32 m0, s25, 6144
  ds_read_b128 v[32:35], v10 offset:49152
  v_mfma_f32_16x16x32_bf16 v[104:107], v[40:43], a[100:103], v[104:107]
  v_mfma_f32_16x16x32_bf16 v[112:115], v[40:43], a[104:107], v[112:115]
  buffer_load_dwordx4 v22, s[12:15], s19 offen lds
  v_mfma_f32_16x16x32_bf16 v[120:123], v[40:43], a[108:111], v[120:123]
  s_waitcnt lgkmcnt(5)
  v_mfma_f32_16x16x32_bf16 v[100:103], v[44:47], a[96:99], v[100:103]
  ds_read_b128 v[36:39], v11 offset:49152
  v_mfma_f32_16x16x32_bf16 v[108:111], v[44:47], a[100:103], v[108:111]
  v_mfma_f32_16x16x32_bf16 v[116:119], v[44:47], a[104:107], v[116:119]
  v_mfma_f32_16x16x32_bf16 v[124:127], v[44:47], a[108:111], v[124:127]
  s_waitcnt lgkmcnt(5)
  v_mfma_f32_16x16x32_bf16 v[96:99], v[48:51], a[112:115], v[96:99]
  s_add_u32 m0, s25, 7168
  ds_read_b128 v[40:43], v12 offset:49152
  v_mfma_f32_16x16x32_bf16 v[104:107], v[48:51], a[116:119], v[104:107]
  v_mfma_f32_16x16x32_bf16 v[112:115], v[48:51], a[120:123], v[112:115]
  buffer_load_dwordx4 v23, s[12:15], s19 offen lds
  v_mfma_f32_16x16x32_bf16 v[120:123], v[48:51], a[124:127], v[120:123]
  s_waitcnt lgkmcnt(5)
  v_mfma_f32_16x16x32_bf16 v[100:103], v[52:55], a[112:115], v[100:103]
  s_cmp_gt_u32 s23, 3
  ds_read_b128 v[44:47], v13 offset:49152
  v_mfma_f32_16x16x32_bf16 v[108:111], v[52:55], a[116:119], v[108:111]
  v_mfma_f32_16x16x32_bf16 v[116:119], v[52:55], a[120:123], v[116:119]
  s_cselect_b32 s26, s20, 0
  v_mfma_f32_16x16x32_bf16 v[124:127], v[52:55], a[124:127], v[124:127]
  s_waitcnt lgkmcnt(5)
  v_mfma_f32_16x16x32_bf16 v[96:99], v[24:27], a[128:131], v[96:99]
  s_add_u32 s19, s19, s26
  ds_read_b128 v[48:51], v14 offset:49152
  v_mfma_f32_16x16x32_bf16 v[104:107], v[24:27], a[132:135], v[104:107]
  v_mfma_f32_16x16x32_bf16 v[112:115], v[24:27], a[136:139], v[112:115]
  s_add_u32 s25, s25, 32768
  v_mfma_f32_16x16x32_bf16 v[120:123], v[24:27], a[140:143], v[120:123]
  s_waitcnt lgkmcnt(5)
  v_mfma_f32_16x16x32_bf16 v[100:103], v[28:31], a[128:131], v[100:103]
  s_and_b32 s25, s25, 0x1ffff
  ds_read_b128 v[52:55], v15 offset:49152
  v_mfma_f32_16x16x32_bf16 v[108:111], v[28:31], a[132:135], v[108:111]
  v_mfma_f32_16x16x32_bf16 v[116:119], v[28:31], a[136:139], v[116:119]
  buffer_store_dwordx4 v[128:131], v7, s[4:7], s21 offen offset:0 sc1
  v_mfma_f32_16x16x32_bf16 v[124:127], v[28:31], a[140:143], v[124:127]
  s_waitcnt lgkmcnt(5)
  v_mfma_f32_16x16x32_bf16 v[96:99], v[32:35], a[144:147], v[96:99]
  ds_read_b128 v[24:27], v8 offset:57344
  v_mfma_f32_16x16x32_bf16 v[104:107], v[32:35], a[148:151], v[104:107]
  v_mfma_f32_16x16x32_bf16 v[112:115], v[32:35], a[152:155], v[112:115]
  v_mfma_f32_16x16x32_bf16 v[120:123], v[32:35], a[156:159], v[120:123]
  s_waitcnt lgkmcnt(5)
  v_xor_b32 v8, 0x10000, v8
  v_mfma_f32_16x16x32_bf16 v[100:103], v[36:39], a[144:147], v[100:103]
  ds_read_b128 v[28:31], v9 offset:57344
  v_mfma_f32_16x16x32_bf16 v[108:111], v[36:39], a[148:151], v[108:111]
  v_mfma_f32_16x16x32_bf16 v[116:119], v[36:39], a[152:155], v[116:119]
  buffer_store_dwordx4 v[132:135], v7, s[4:7], s21 offen offset:256 sc1
  v_mfma_f32_16x16x32_bf16 v[124:127], v[36:39], a[156:159], v[124:127]
  s_waitcnt lgkmcnt(5)
  v_xor_b32 v9, 0x10000, v9
  v_mfma_f32_16x16x32_bf16 v[96:99], v[40:43], a[160:163], v[96:99]
  ds_read_b128 v[32:35], v10 offset:57344
  v_mfma_f32_16x16x32_bf16 v[104:107], v[40:43], a[164:167], v[104:107]
  v_mfma_f32_16x16x32_bf16 v[112:115], v[40:43], a[168:171], v[112:115]
  v_mfma_f32_16x16x32_bf16 v[120:123], v[40:43], a[172:175], v[120:123]
  s_waitcnt lgkmcnt(5)
  v_xor_b32 v10, 0x10000, v10
  v_mfma_f32_16x16x32_bf16 v[100:103], v[44:47], a[160:163], v[100:103]
  ds_read_b128 v[36:39], v11 offset:57344
  v_mfma_f32_16x16x32_bf16 v[108:111], v[44:47], a[164:167], v[108:111]
  v_mfma_f32_16x16x32_bf16 v[116:119], v[44:47], a[168:171], v[116:119]
  buffer_store_dwordx4 v[136:139], v7, s[4:7], s21 offen offset:2048 sc1
  v_mfma_f32_16x16x32_bf16 v[124:127], v[44:47], a[172:175], v[124:127]
  s_waitcnt lgkmcnt(5)
  v_xor_b32 v11, 0x10000, v11
  v_mfma_f32_16x16x32_bf16 v[96:99], v[48:51], a[176:179], v[96:99]
  ds_read_b128 v[40:43], v12 offset:57344
  v_mfma_f32_16x16x32_bf16 v[104:107], v[48:51], a[180:183], v[104:107]
  v_mfma_f32_16x16x32_bf16 v[112:115], v[48:51], a[184:187], v[112:115]
  v_mfma_f32_16x16x32_bf16 v[120:123], v[48:51], a[188:191], v[120:123]
  s_waitcnt lgkmcnt(5)
  v_xor_b32 v12, 0x10000, v12
  v_mfma_f32_16x16x32_bf16 v[100:103], v[52:55], a[176:179], v[100:103]
  ds_read_b128 v[44:47], v13 offset:57344
  v_mfma_f32_16x16x32_bf16 v[108:111], v[52:55], a[180:183], v[108:111]
  v_mfma_f32_16x16x32_bf16 v[116:119], v[52:55], a[184:187], v[116:119]
  buffer_store_dwordx4 v[140:143], v7, s[4:7], s21 offen offset:2304 sc1
  v_mfma_f32_16x16x32_bf16 v[124:127], v[52:55], a[188:191], v[124:127]
  s_waitcnt lgkmcnt(5)
  v_xor_b32 v13, 0x10000, v13
  v_mfma_f32_16x16x32_bf16 v[96:99], v[24:27], a[192:195], v[96:99]
  s_mov_b32 s21, s27
  ds_read_b128 v[48:51], v14 offset:57344
  v_mfma_f32_16x16x32_bf16 v[104:107], v[24:27], a[196:199], v[104:107]
  v_mov_b32 v7, v56
  v_mfma_f32_16x16x32_bf16 v[112:115], v[24:27], a[200:203], v[112:115]
  v_mfma_f32_16x16x32_bf16 v[120:123], v[24:27], a[204:207], v[120:123]
  s_waitcnt lgkmcnt(5)
  v_xor_b32 v14, 0x10000, v14
  v_mfma_f32_16x16x32_bf16 v[100:103], v[28:31], a[192:195], v[100:103]
  s_add_u32 s27, s27, s22
  ds_read_b128 v[52:55], v15 offset:57344
  v_mfma_f32_16x16x32_bf16 v[108:111], v[28:31], a[196:199], v[108:111]
  v_mfma_f32_16x16x32_bf16 v[116:119], v[28:31], a[200:203], v[116:119]
  s_waitcnt vmcnt(13)
  s_barrier
  v_mfma_f32_16x16x32_bf16 v[124:127], v[28:31], a[204:207], v[124:127]
  s_waitcnt lgkmcnt(5)
  v_xor_b32 v15, 0x10000, v15
  v_mfma_f32_16x16x32_bf16 v[96:99], v[32:35], a[208:211], v[96:99]
  ds_read_b128 v[24:27], v8 offset:0
  v_mfma_f32_16x16x32_bf16 v[104:107], v[32:35], a[212:215], v[104:107]
  v_mfma_f32_16x16x32_bf16 v[112:115], v[32:35], a[216:219], v[112:115]
  v_mfma_f32_16x16x32_bf16 v[120:123], v[32:35], a[220:223], v[120:123]
  s_waitcnt lgkmcnt(5)
  v_mfma_f32_16x16x32_bf16 v[100:103], v[36:39], a[208:211], v[100:103]
  s_add_u32 s29, s29, 1
  ds_read_b128 v[28:31], v9 offset:0
  v_mfma_f32_16x16x32_bf16 v[108:111], v[36:39], a[212:215], v[108:111]
  v_mfma_f32_16x16x32_bf16 v[116:119], v[36:39], a[216:219], v[116:119]
  s_max_i32 s30, s29, 0
  v_mfma_f32_16x16x32_bf16 v[124:127], v[36:39], a[220:223], v[124:127]
  s_waitcnt lgkmcnt(5)
  v_mov_b32 v144, s30
  v_mfma_f32_16x16x32_bf16 v[96:99], v[40:43], a[224:227], v[96:99]
  ds_read_b128 v[32:35], v10 offset:0
  v_mfma_f32_16x16x32_bf16 v[104:107], v[40:43], a[228:231], v[104:107]
  v_mfma_f32_16x16x32_bf16 v[112:115], v[40:43], a[232:235], v[112:115]
  buffer_store_dword v144, v145, s[4:7], s31 offen sc1
  v_mfma_f32_16x16x32_bf16 v[120:123], v[40:43], a[236:239], v[120:123]
  s_waitcnt lgkmcnt(5)
  v_mfma_f32_16x16x32_bf16 v[100:103], v[44:47], a[224:227], v[100:103]
  ds_read_b128 v[36:39], v11 offset:0
  v_mfma_f32_16x16x32_bf16 v[108:111], v[44:47], a[228:231], v[108:111]
  v_mfma_f32_16x16x32_bf16 v[116:119], v[44:47], a[232:235], v[116:119]
  v_mfma_f32_16x16x32_bf16 v[124:127], v[44:47], a[236:239], v[124:127]
  s_waitcnt lgkmcnt(5)
  v_mfma_f32_16x16x32_bf16 v[96:99], v[48:51], a[240:243], v[96:99]
  s_sub_u32 s23, s23, 1
  ds_read_b128 v[40:43], v12 offset:0
  v_mfma_f32_16x16x32_bf16 v[104:107], v[48:51], a[244:247], v[104:107]
  v_mfma_f32_16x16x32_bf16 v[112:115], v[48:51], a[248:251], v[112:115]
  v_mfma_f32_16x16x32_bf16 v[120:123], v[48:51], a[252:255], v[120:123]
  s_waitcnt lgkmcnt(5)
  v_mfma_f32_16x16x32_bf16 v[100:103], v[52:55], a[240:243], v[100:103]
  s_cmp_eq_u32 s23, 0
  ds_read_b128 v[44:47], v13 offset:0
  v_mfma_f32_16x16x32_bf16 v[108:111], v[52:55], a[244:247], v[108:111]
  v_mfma_f32_16x16x32_bf16 v[116:119], v[52:55], a[248:251], v[116:119]
  v_mfma_f32_16x16x32_bf16 v[124:127], v[52:55], a[252:255], v[124:127]
  s_cbranch_scc1 G_done1_143
  s_branch G_top_141
G_done0_142:
  s_nop 7
  s_nop 3
  v_cvt_pk_bf16_f32 v128, v64, v65
  v_cvt_pk_bf16_f32 v129, v66, v67
  v_cvt_pk_bf16_f32 v130, v68, v69
  v_cvt_pk_bf16_f32 v131, v70, v71
  buffer_store_dwordx4 v[128:131], v7, s[4:7], s21 offen offset:0 sc1
  v_cvt_pk_bf16_f32 v132, v72, v73
  v_cvt_pk_bf16_f32 v133, v74, v75
  v_cvt_pk_bf16_f32 v134, v76, v77
  v_cvt_pk_bf16_f32 v135, v78, v79
  buffer_store_dwordx4 v[132:135], v7, s[4:7], s21 offen offset:256 sc1
  v_cvt_pk_bf16_f32 v136, v80, v81
  v_cvt_pk_bf16_f32 v137, v82, v83
  v_cvt_pk_bf16_f32 v138, v84, v85
  v_cvt_pk_bf16_f32 v139, v86, v87
  buffer_store_dwordx4 v[136:139], v7, s[4:7], s21 offen offset:2048 sc1
  v_cvt_pk_bf16_f32 v140, v88, v89
  v_cvt_pk_bf16_f32 v141, v90, v91
  v_cvt_pk_bf16_f32 v142, v92, v93
  v_cvt_pk_bf16_f32 v143, v94, v95
  buffer_store_dwordx4 v[140:143], v7, s[4:7], s21 offen offset:2304 sc1
  s_branch G_fin_144
G_done1_143:
  s_nop 7
  s_nop 3
  v_cvt_pk_bf16_f32 v128, v96, v97
  v_cvt_pk_bf16_f32 v129, v98, v99
  v_cvt_pk_bf16_f32 v130, v100, v101
  v_cvt_pk_bf16_f32 v131, v102, v103
  buffer_store_dwordx4 v[128:131], v7, s[4:7], s21 offen offset:0 sc1
  v_cvt_pk_bf16_f32 v132, v104, v105
  v_cvt_pk_bf16_f32 v133, v106, v107
  v_cvt_pk_bf16_f32 v134, v108, v109
  v_cvt_pk_bf16_f32 v135, v110, v111
  buffer_store_dwordx4 v[132:135], v7, s[4:7], s21 offen offset:256 sc1
  v_cvt_pk_bf16_f32 v136, v112, v113
  v_cvt_pk_bf16_f32 v137, v114, v115
  v_cvt_pk_bf16_f32 v138, v116, v117
  v_cvt_pk_bf16_f32 v139, v118, v119
  buffer_store_dwordx4 v[136:139], v7, s[4:7], s21 offen offset:2048 sc1
  v_cvt_pk_bf16_f32 v140, v120, v121
  v_cvt_pk_bf16_f32 v141, v122, v123
  v_cvt_pk_bf16_f32 v142, v124, v125
  v_cvt_pk_bf16_f32 v143, v126, v127
  buffer_store_dwordx4 v[140:143], v7, s[4:7], s21 offen offset:2304 sc1
G_fin_144:
  s_waitcnt vmcnt(0) lgkmcnt(0)
  s_barrier
  s_add_u32 s30, s29, 2
  v_mov_b32 v144, s30
  v_min_u32 v145, 1, v0
  v_lshlrev_b32 v145, 30, v145
  buffer_store_dword v144, v145, s[4:7], s31 offen sc1
P_end_131:
  s_mov_b32 s71, 0
  s_branch M_sg_146
M_sw_145:
  s_sleep 8
  s_add_u32 s71, s71, 1
  s_cmp_gt_u32 s71, 262144
  s_cbranch_scc1 M_exit
M_sg_146:
  s_mov_b32 s79, 0
  s_atomic_or s79, s[74:75], 128 glc
  s_waitcnt lgkmcnt(0)
  s_cmp_lt_u32 s79, 256
  s_cbranch_scc1 M_sw_145
  s_cmp_eq_u32 s65, 6
  s_cbranch_scc1 M_follow
  s_mov_b32 s68, 0
  s_mov_b32 s36, -1
  s_mov_b32 s69, s53
  s_mov_b32 s70, s54
  s_load_dwordx2 s[8:9], s[0:1], 40
  s_mul_i32 s76, s64, 6
  s_add_u32 s76, s76, s65
  s_mul_i32 s76, s76, 21888
  v_min_u32 v200, 170, v0
  v_mul_u32_u24 v200, 128, v200
  v_add_u32 v200, s76, v200
  s_waitcnt lgkmcnt(0)
  s_and_b32 s9, s9, 0xffff
  s_mov_b32 s10, 4194304
  s_mov_b32 s11, 0x20000
M_att:
  s_mov_b32 s24, 0xf149f2ca
  s_mov_b32 s29, 0
  v_mov_b32 v6, 0
  v_mov_b32 v7, 0
  s_lshl_b32 s26, s16, 11
  v_add_u32 v3, s26, v2
  v_and_b32 v5, 31, v1
  v_lshrrev_b32 v12, 5, v1
  v_lshlrev_b32 v12, 2, v12
  v_sub_u32 v5, v5, v12
  s_lshl_b32 s26, s64, 19
  s_add_u32 s19, s26, 16777216
  s_add_u32 s20, s26, 33554432
  s_lshl_b32 s27, s69, 2
  s_add_u32 s27, s27, s16
  s_lshl_b32 s27, s27, 14
  s_add_u32 s25, s26, s27
  s_bfe_u32 s78, s70, 0x80000
  s_add_u32 s76, s67, 512
  s_mov_b32 s71, 0
  s_branch M_sg_148
M_sw_147:
  s_sleep 8
  s_add_u32 s71, s71, 1
  s_cmp_gt_u32 s71, 262144
  s_cbranch_scc1 M_exit
M_sg_148:
  s_mov_b32 s79, 0
  s_atomic_or s79, s[72:73], s76 glc
  s_waitcnt lgkmcnt(0)
  s_cmp_lt_u32 s79, s78
  s_cbranch_scc1 M_sw_147
  s_bfe_u32 s78, s70, 0x80008
  s_add_u32 s76, s67, 640
  s_mov_b32 s71, 0
  s_branch M_sg_150
M_sw_149:
  s_sleep 8
  s_add_u32 s71, s71, 1
  s_cmp_gt_u32 s71, 262144
  s_cbranch_scc1 M_exit
M_sg_150:
  s_mov_b32 s79, 0
  s_atomic_or s79, s[72:73], s76 glc
  s_waitcnt lgkmcnt(0)
  s_cmp_lt_u32 s79, s78
  s_cbranch_scc1 M_sw_149
  s_lshl_b32 s27, s69, 16
  s_add_u32 s27, s27, 16384
  s_add_u32 s17, s19, s27
M_kv_151:
  s_cmp_ge_u32 s17, s36
  s_cbranch_scc1 M_kvok_152
  s_mov_b32 s76, 0
  s_mov_b32 s78, 23
  s_mov_b32 s77, 335872
  s_cmp_eq_u32 s68, 1
  s_cmov_b32 s76, 128
  s_cmov_b32 s78, 27
  s_cmov_b32 s77, 114688
  s_cmp_eq_u32 s68, 2
  s_cmov_b32 s76, 768
  s_cmov_b32 s78, 14
  s_cmov_b32 s77, 0
  s_add_u32 s76, s76, s67
  s_mov_b32 s71, 0
  s_branch M_sg_154
M_sw_153:
  s_sleep 8
  s_add_u32 s71, s71, 1
  s_cmp_gt_u32 s71, 262144
  s_cbranch_scc1 M_exit
M_sg_154:
  s_mov_b32 s79, 0
  s_atomic_or s79, s[72:73], s76 glc
  s_waitcnt lgkmcnt(0)
  s_cmp_lt_u32 s79, s78
  s_cbranch_scc1 M_sw_153
  s_add_u32 s36, s77, s19
  s_add_u32 s68, s68, 1
  s_branch M_kv_151
M_kvok_152:
  s_add_u32 s28, s25, 0
  buffer_load_dwordx4 a[128:131], v2, s[4:7], s28 offen offset:0 sc1
  buffer_load_dwordx4 a[132:135], v2, s[4:7], s28 offen offset:1024 sc1
  buffer_load_dwordx4 a[136:139], v2, s[4:7], s28 offen offset:2048 sc1
  buffer_load_dwordx4 a[140:143], v2, s[4:7], s28 offen offset:3072 sc1
  s_add_u32 s28, s25, 4096
  buffer_load_dwordx4 a[144:147], v2, s[4:7], s28 offen offset:0 sc1
  buffer_load_dwordx4 a[148:151], v2, s[4:7], s28 offen offset:1024 sc1
  buffer_load_dwordx4 a[152:155], v2, s[4:7], s28 offen offset:2048 sc1
  buffer_load_dwordx4 a[156:159], v2, s[4:7], s28 offen offset:3072 sc1
  s_add_u32 s28, s25, 8192
  buffer_load_dwordx4 a[160:163], v2, s[4:7], s28 offen offset:0 sc1
  buffer_load_dwordx4 a[164:167], v2, s[4:7], s28 offen offset:1024 sc1
  buffer_load_dwordx4 a[168:171], v2, s[4:7], s28 offen offset:2048 sc1
  buffer_load_dwordx4 a[172:175], v2, s[4:7], s28 offen offset:3072 sc1
  s_add_u32 s28, s25, 12288
  buffer_load_dwordx4 a[176:179], v2, s[4:7], s28 offen offset:0 sc1
  buffer_load_dwordx4 a[180:183], v2, s[4:7], s28 offen offset:1024 sc1
  buffer_load_dwordx4 a[184:187], v2, s[4:7], s28 offen offset:2048 sc1
  buffer_load_dwordx4 a[188:191], v2, s[4:7], s28 offen offset:3072 sc1
A_again_155:
  s_lshl_b32 s27, s69, 16
  s_add_u32 s27, s27, 57344
  s_add_u32 s17, s19, s27
  s_add_u32 s18, s20, s27
  s_lshl_b32 s21, s16, 11
  s_mov_b32 m0, s21
  s_nop 0
  buffer_load_dwordx4 v3, s[4:7], s18 offen offset:0 sc1 lds
  buffer_load_dwordx4 v3, s[4:7], s18 offen offset:1024 sc1 lds
  s_add_u32 m0, s21, 8192
  s_nop 0
  buffer_load_dwordx4 v3, s[4:7], s17 offen offset:0 sc1 lds
  buffer_load_dwordx4 v3, s[4:7], s17 offen offset:1024 sc1 lds
  s_add_u32 s18, s18, 8192
  s_sub_u32 s18, s18, 8192
  s_max_i32 s18, s18, s20
  s_sub_u32 s17, s17, 8192
  s_max_i32 s17, s17, s19
  s_add_u32 s21, s21, 16384
  s_and_b32 s21, s21, 131071
  s_mov_b32 m0, s21
  s_nop 0
  buffer_load_dwordx4 v3, s[4:7], s18 offen offset:0 sc1 lds
  buffer_load_dwordx4 v3, s[4:7], s18 offen offset:1024 sc1 lds
  s_add_u32 m0, s21, 8192
  s_nop 0
  buffer_load_dwordx4 v3, s[4:7], s17 offen offset:0 sc1 lds
  buffer_load_dwordx4 v3, s[4:7], s17 offen offset:1024 sc1 lds
  s_sub_u32 s18, s18, 8192
  s_max_i32 s18, s18, s20
  s_sub_u32 s17, s17, 8192
  s_max_i32 s17, s17, s19
  s_add_u32 s21, s21, 16384
  s_and_b32 s21, s21, 131071
  s_mov_b32 m0, s21
  s_nop 0
  buffer_load_dwordx4 v3, s[4:7], s18 offen offset:0 sc1 lds
  buffer_load_dwordx4 v3, s[4:7], s18 offen offset:1024 sc1 lds
  s_add_u32 m0, s21, 8192
  s_nop 0
  buffer_load_dwordx4 v3, s[4:7], s17 offen offset:0 sc1 lds
  buffer_load_dwordx4 v3, s[4:7], s17 offen offset:1024 sc1 lds
  s_sub_u32 s18, s18, 8192
  s_max_i32 s18, s18, s20
  s_sub_u32 s17, s17, 8192
  s_max_i32 s17, s17, s19
  s_add_u32 s21, s21, 16384
  s_and_b32 s21, s21, 131071
  s_mov_b32 m0, s21
  s_nop 0
  buffer_load_dwordx4 v3, s[4:7], s18 offen offset:0 sc1 lds
  buffer_load_dwordx4 v3, s[4:7], s18 offen offset:1024 sc1 lds
  s_add_u32 m0, s21, 8192
  s_nop 0
  buffer_load_dwordx4 v3, s[4:7], s17 offen offset:0 sc1 lds
  buffer_load_dwordx4 v3, s[4:7], s17 offen offset:1024 sc1 lds
  s_sub_u32 s18, s18, 8192
  s_max_i32 s18, s18, s20
  s_sub_u32 s17, s17, 8192
  s_max_i32 s17, s17, s19
  s_add_u32 s21, s21, 16384
  s_and_b32 s21, s21, 131071
  s_mov_b32 m0, s21
  s_nop 0
  buffer_load_dwordx4 v3, s[4:7], s18 offen offset:0 sc1 lds
  buffer_load_dwordx4 v3, s[4:7], s18 offen offset:1024 sc1 lds
  s_add_u32 m0, s21, 8192
  s_nop 0
  buffer_load_dwordx4 v3, s[4:7], s17 offen offset:0 sc1 lds
  buffer_load_dwordx4 v3, s[4:7], s17 offen offset:1024 sc1 lds
  s_sub_u32 s18, s18, 8192
  s_max_i32 s18, s18, s20
  s_sub_u32 s17, s17, 8192
  s_max_i32 s17, s17, s19
  s_add_u32 s21, s21, 16384
  s_and_b32 s21, s21, 131071
  s_mov_b32 m0, s21
  s_nop 0
  buffer_load_dwordx4 v3, s[4:7], s18 offen offset:0 sc1 lds
  buffer_load_dwordx4 v3, s[4:7], s18 offen offset:1024 sc1 lds
  s_add_u32 m0, s21, 8192
  s_nop 0
  buffer_load_dwordx4 v3, s[4:7], s17 offen offset:0 sc1 lds
  buffer_load_dwordx4 v3, s[4:7], s17 offen offset:1024 sc1 lds
  v_accvgpr_write_b32 a0, 0
  v_accvgpr_write_b32 a1, 0
  v_accvgpr_write_b32 a2, 0
  v_accvgpr_write_b32 a3, 0
  v_accvgpr_write_b32 a4, 0
  v_accvgpr_write_b32 a5, 0
  v_accvgpr_write_b32 a6, 0
  v_accvgpr_write_b32 a7, 0
  v_accvgpr_write_b32 a8, 0
  v_accvgpr_write_b32 a9, 0
  v_accvgpr_write_b32 a10, 0
  v_accvgpr_write_b32 a11, 0
  v_accvgpr_write_b32 a12, 0
  v_accvgpr_write_b32 a13, 0
  v_accvgpr_write_b32 a14, 0
  v_accvgpr_write_b32 a15, 0
  v_accvgpr_write_b32 a16, 0
  v_accvgpr_write_b32 a17, 0
  v_accvgpr_write_b32 a18, 0
  v_accvgpr_write_b32 a19, 0
  v_accvgpr_write_b32 a20, 0
  v_accvgpr_write_b32 a21, 0
  v_accvgpr_write_b32 a22, 0
  v_accvgpr_write_b32 a23, 0
  v_accvgpr_write_b32 a24, 0
  v_accvgpr_write_b32 a25, 0
  v_accvgpr_write_b32 a26, 0
  v_accvgpr_write_b32 a27, 0
  v_accvgpr_write_b32 a28, 0
  v_accvgpr_write_b32 a29, 0
  v_accvgpr_write_b32 a30, 0
  v_accvgpr_write_b32 a31, 0
  v_accvgpr_write_b32 a32, 0
  v_accvgpr_write_b32 a33, 0
  v_accvgpr_write_b32 a34, 0
  v_accvgpr_write_b32 a35, 0
  v_accvgpr_write_b32 a36, 0
  v_accvgpr_write_b32 a37, 0
  v_accvgpr_write_b32 a38, 0
  v_accvgpr_write_b32 a39, 0
  v_accvgpr_write_b32 a40, 0
  v_accvgpr_write_b32 a41, 0
  v_accvgpr_write_b32 a42, 0
  v_accvgpr_write_b32 a43, 0
  v_accvgpr_write_b32 a44, 0
  v_accvgpr_write_b32 a45, 0
  v_accvgpr_write_b32 a46, 0
  v_accvgpr_write_b32 a47, 0
  v_accvgpr_write_b32 a48, 0
  v_accvgpr_write_b32 a49, 0
  v_accvgpr_write_b32 a50, 0
  v_accvgpr_write_b32 a51, 0
  v_accvgpr_write_b32 a52, 0
  v_accvgpr_write_b32 a53, 0
  v_accvgpr_write_b32 a54, 0
  v_accvgpr_write_b32 a55, 0
  v_accvgpr_write_b32 a56, 0
  v_accvgpr_write_b32 a57, 0
  v_accvgpr_write_b32 a58, 0
  v_accvgpr_write_b32 a59, 0
  v_accvgpr_write_b32 a60, 0
  v_accvgpr_write_b32 a61, 0
  v_accvgpr_write_b32 a62, 0
  v_accvgpr_write_b32 a63, 0
  v_accvgpr_write_b32 a64, 0
  v_accvgpr_write_b32 a65, 0
  v_accvgpr_write_b32 a66, 0
  v_accvgpr_write_b32 a67, 0
  v_accvgpr_write_b32 a68, 0
  v_accvgpr_write_b32 a69, 0
  v_accvgpr_write_b32 a70, 0
  v_accvgpr_write_b32 a71, 0
  v_accvgpr_write_b32 a72, 0
  v_accvgpr_write_b32 a73, 0
  v_accvgpr_write_b32 a74, 0
  v_accvgpr_write_b32 a75, 0
  v_accvgpr_write_b32 a76, 0
  v_accvgpr_write_b32 a77, 0
  v_accvgpr_write_b32 a78, 0
  v_accvgpr_write_b32 a79, 0
  v_accvgpr_write_b32 a80, 0
  v_accvgpr_write_b32 a81, 0
  v_accvgpr_write_b32 a82, 0
  v_accvgpr_write_b32 a83, 0
  v_accvgpr_write_b32 a84, 0
  v_accvgpr_write_b32 a85, 0
  v_accvgpr_write_b32 a86, 0
  v_accvgpr_write_b32 a87, 0
  v_accvgpr_write_b32 a88, 0
  v_accvgpr_write_b32 a89, 0
  v_accvgpr_write_b32 a90, 0
  v_accvgpr_write_b32 a91, 0
  v_accvgpr_write_b32 a92, 0
  v_accvgpr_write_b32 a93, 0
  v_accvgpr_write_b32 a94, 0
  v_accvgpr_write_b32 a95, 0
  v_accvgpr_write_b32 a96, 0
  v_accvgpr_write_b32 a97, 0
  v_accvgpr_write_b32 a98, 0
  v_accvgpr_write_b32 a99, 0
  v_accvgpr_write_b32 a100, 0
  v_accvgpr_write_b32 a101, 0
  v_accvgpr_write_b32 a102, 0
  v_accvgpr_write_b32 a103, 0
  v_accvgpr_write_b32 a104, 0
  v_accvgpr_write_b32 a105, 0
  v_accvgpr_write_b32 a106, 0
  v_accvgpr_write_b32 a107, 0
  v_accvgpr_write_b32 a108, 0
  v_accvgpr_write_b32 a109, 0
  v_accvgpr_write_b32 a110, 0
  v_accvgpr_write_b32 a111, 0
  v_accvgpr_write_b32 a112, 0
  v_accvgpr_write_b32 a113, 0
  v_accvgpr_write_b32 a114, 0
  v_accvgpr_write_b32 a115, 0
  v_accvgpr_write_b32 a116, 0
  v_accvgpr_write_b32 a117, 0
  v_accvgpr_write_b32 a118, 0
  v_accvgpr_write_b32 a119, 0
  v_accvgpr_write_b32 a120, 0
  v_accvgpr_write_b32 a121, 0
  v_accvgpr_write_b32 a122, 0
  v_accvgpr_write_b32 a123, 0
  v_accvgpr_write_b32 a124, 0
  v_accvgpr_write_b32 a125, 0
  v_accvgpr_write_b32 a126, 0
  v_accvgpr_write_b32 a127, 0
  v_mov_b32 v8, 0
  v_mov_b32 v9, 0
  v_mov_b32 v10, 0
  v_mov_b32 v11, 0
  v_mov_b32 v52, 0
  v_mov_b32 v53, 0
  v_mov_b32 v54, s24
  v_mov_b32 v55, s24
  v_mov_b32 v56, s24
  v_mov_b32 v57, s24
  v_mov_b32 v58, s24
  v_mov_b32 v59, s24
  v_mov_b32 v60, s24
  v_mov_b32 v61, s24
  v_mov_b32 v62, s24
  v_mov_b32 v63, s24
  v_mov_b32 v104, 0
  v_mov_b32 v105, 0
  v_mov_b32 v4, v2
  v_mov_b32 v64, s24
  v_mov_b32 v65, s24
  v_mov_b32 v66, s24
  v_mov_b32 v67, s24
  v_mov_b32 v68, s24
  v_mov_b32 v69, s24
  v_mov_b32 v70, s24
  v_mov_b32 v71, s24
  v_mov_b32 v72, s24
  v_mov_b32 v73, s24
  v_mov_b32 v74, s24
  v_mov_b32 v75, s24
  v_mov_b32 v76, s24
  v_mov_b32 v77, s24
  v_mov_b32 v78, s24
  v_mov_b32 v79, s24
  v_mov_b32 v12, s24
  v_cmp_le_i32 s[40:41], 0, v5
  v_cmp_le_i32 s[42:43], 1, v5
  v_cmp_le_i32 s[44:45], 2, v5
  v_cmp_le_i32 s[46:47], 3, v5
  v_cndmask_b32 v80, v12, v7, s[40:41]
  v_cndmask_b32 v81, v12, v7, s[42:43]
  v_cndmask_b32 v82, v12, v7, s[44:45]
  v_cndmask_b32 v83, v12, v7, s[46:47]
  v_cmp_le_i32 s[40:41], 8, v5
  v_cmp_le_i32 s[42:43], 9, v5
  v_cmp_le_i32 s[44:45], 10, v5
  v_cmp_le_i32 s[46:47], 11, v5
  v_cndmask_b32 v84, v12, v7, s[40:41]
  v_cndmask_b32 v85, v12, v7, s[42:43]
  v_cndmask_b32 v86, v12, v7, s[44:45]
  v_cndmask_b32 v87, v12, v7, s[46:47]
  v_cmp_le_i32 s[40:41], 16, v5
  v_cmp_le_i32 s[42:43], 17, v5
  v_cmp_le_i32 s[44:45], 18, v5
  v_cmp_le_i32 s[46:47], 19, v5
  v_cndmask_b32 v88, v12, v7, s[40:41]
  v_cndmask_b32 v89, v12, v7, s[42:43]
  v_cndmask_b32 v90, v12, v7, s[44:45]
  v_cndmask_b32 v91, v12, v7, s[46:47]
  v_cmp_le_i32 s[40:41], 24, v5
  v_cmp_le_i32 s[42:43], 25, v5
  v_cmp_le_i32 s[44:45], 26, v5
  v_cmp_le_i32 s[46:47], 27, v5
  v_cndmask_b32 v92, v12, v7, s[40:41]
  v_cndmask_b32 v93, v12, v7, s[42:43]
  v_cndmask_b32 v94, v12, v7, s[44:45]
  v_cndmask_b32 v95, v12, v7, s[46:47]
  s_lshl_b32 s22, s69, 3
  s_add_u32 s22, s22, 8
  s_lshl_b32 s26, s16, 1
  s_sub_u32 s23, 6, s26
  s_waitcnt vmcnt(20)
  s_barrier
  s_cmp_eq_u32 s23, 0
  s_cbranch_scc1 A_go_157
A_idle_156:
  s_waitcnt vmcnt(16)
  s_barrier
  s_sub_u32 s18, s18, 8192
  s_max_i32 s18, s18, s20
  s_sub_u32 s17, s17, 8192
  s_max_i32 s17, s17, s19
  s_add_u32 s21, s21, 16384
  s_and_b32 s21, s21, 131071
M_kv_158:
  s_cmp_ge_u32 s17, s36
  s_cbranch_scc1 M_kvok_159
  s_mov_b32 s76, 0
  s_mov_b32 s78, 23
  s_mov_b32 s77, 335872
  s_cmp_eq_u32 s68, 1
  s_cmov_b32 s76, 128
  s_cmov_b32 s78, 27
  s_cmov_b32 s77, 114688
  s_cmp_eq_u32 s68, 2
  s_cmov_b32 s76, 768
  s_cmov_b32 s78, 14
  s_cmov_b32 s77, 0
  s_add_u32 s76, s76, s67
  s_mov_b32 s71, 0
  s_branch M_sg_161
M_sw_160:
  s_sleep 8
  s_add_u32 s71, s71, 1
  s_cmp_gt_u32 s71, 262144
  s_cbranch_scc1 M_exit
M_sg_161:
  s_mov_b32 s79, 0
  s_atomic_or s79, s[72:73], s76 glc
  s_waitcnt lgkmcnt(0)
  s_cmp_lt_u32 s79, s78
  s_cbranch_scc1 M_sw_160
  s_add_u32 s36, s77, s19
  s_add_u32 s68, s68, 1
  s_branch M_kv_158
M_kvok_159:
  s_mov_b32 m0, s21
  s_nop 0
  buffer_load_dwordx4 v3, s[4:7], s18 offen offset:0 sc1 lds
  buffer_load_dwordx4 v3, s[4:7], s18 offen offset:1024 sc1 lds
  s_add_u32 m0, s21, 8192
  s_nop 0
  buffer_load_dwordx4 v3, s[4:7], s17 offen offset:0 sc1 lds
  buffer_load_dwordx4 v3, s[4:7], s17 offen offset:1024 sc1 lds
  v_add_u32 v4, 16384, v4
  v_and_b32 v4, 131071, v4
  s_sub_u32 s22, s22, 1
  s_sub_u32 s23, s23, 1
  s_cmp_lg_u32 s23, 0
  s_cbranch_scc1 A_idle_156
A_go_157:
  ds_read_b128 a[224:227], v4 offset:0
  ds_read_b128 a[228:231], v4 offset:2048
  ds_read_b128 a[232:235], v4 offset:4096
  ds_read_b128 a[236:239], v4 offset:6144
  ds_read_b128 a[240:243], v4 offset:1024
  ds_read_b128 a[244:247], v4 offset:3072
  ds_read_b128 a[248:251], v4 offset:5120
  ds_read_b128 a[252:255], v4 offset:7168
  ds_read_b128 a[192:195], v4 offset:8192
  ds_read_b128 a[196:199], v4 offset:9216
  ds_read_b128 a[200:203], v4 offset:10240
  ds_read_b128 a[204:207], v4 offset:11264
  ds_read_b128 a[208:211], v4 offset:12288
  ds_read_b128 a[212:215], v4 offset:13312
  ds_read_b128 a[216:219], v4 offset:14336
  ds_read_b128 a[220:223], v4 offset:15360
  v_add_u32 v4, 16384, v4
  v_and_b32 v4, 131071, v4
  s_waitcnt lgkmcnt(8)
.p2align 6
A_top_162:
  s_waitcnt lgkmcnt(7)
  v_mfma_f32_32x32x16_bf16 v[32:47], a[192:195], a[128:131], v[64:79]
  s_waitcnt lgkmcnt(6)
  v_exp_f32 v54, v54
  v_add_f32 v11, v11, v53
  v_cvt_pk_bf16_f32 v106, v52, v53
  v_mfma_f32_32x32x16_bf16 v[32:47], a[196:199], a[132:135], v[32:47]
  s_waitcnt lgkmcnt(4)
  v_exp_f32 v55, v55
  v_add_f32 v10, v10, v54
  v_mfma_f32_32x32x16_bf16 v[32:47], a[200:203], a[136:139], v[32:47]
  v_exp_f32 v56, v56
  v_add_f32 v11, v11, v55
  v_cvt_pk_bf16_f32 v107, v54, v55
  v_mfma_f32_32x32x16_bf16 v[32:47], a[204:207], a[140:143], v[32:47]
  s_waitcnt lgkmcnt(2)
  v_exp_f32 v57, v57
  v_add_f32 v10, v10, v56
  v_mfma_f32_32x32x16_bf16 v[32:47], a[208:211], a[144:147], v[32:47]
  v_exp_f32 v58, v58
  v_add_f32 v11, v11, v57
  v_cvt_pk_bf16_f32 v108, v56, v57
  v_mfma_f32_32x32x16_bf16 v[32:47], a[212:215], a[148:151], v[32:47]
  s_waitcnt lgkmcnt(0)
  v_exp_f32 v59, v59
  v_add_f32 v10, v10, v58
  v_mfma_f32_32x32x16_bf16 v[32:47], a[216:219], a[152:155], v[32:47]
  v_exp_f32 v60, v60
  v_add_f32 v11, v11, v59
  v_cvt_pk_bf16_f32 v109, v58, v59
  v_mfma_f32_32x32x16_bf16 v[32:47], a[220:223], a[156:159], v[32:47]
  s_waitcnt vmcnt(16)
  s_barrier
  v_exp_f32 v61, v61
  v_add_f32 v10, v10, v60
  v_mfma_f32_32x32x16_bf16 a[64:79], a[224:227], v[104:107], a[64:79]
  ds_read_b128 a[224:227], v4 offset:0
  v_exp_f32 v62, v62
  v_add_f32 v11, v11, v61
  v_cvt_pk_bf16_f32 v110, v60, v61
  v_mfma_f32_32x32x16_bf16 a[80:95], a[228:231], v[104:107], a[80:95]
  s_sub_u32 s18, s18, 8192
  ds_read_b128 a[228:231], v4 offset:2048
  v_exp_f32 v63, v63
  v_add_f32 v10, v10, v62
  v_mfma_f32_32x32x16_bf16 a[96:111], a[232:235], v[104:107], a[96:111]
  s_max_i32 s18, s18, s20
  ds_read_b128 a[232:235], v4 offset:4096
  v_exp_f32 v32, v32
  v_add_f32 v11, v11, v63
  v_cvt_pk_bf16_f32 v111, v62, v63
  v_mfma_f32_32x32x16_bf16 a[112:127], a[236:239], v[104:107], a[112:127]
  s_sub_u32 s17, s17, 8192
  ds_read_b128 a[236:239], v4 offset:6144
  v_exp_f32 v33, v33
  v_add_f32 v8, v8, v32
  v_mfma_f32_32x32x16_bf16 a[64:79], a[240:243], v[108:111], a[64:79]
  s_max_i32 s17, s17, s19
  ds_read_b128 a[240:243], v4 offset:1024
  v_exp_f32 v34, v34
  v_add_f32 v9, v9, v33
  v_cvt_pk_bf16_f32 v96, v32, v33
  v_mfma_f32_32x32x16_bf16 a[80:95], a[244:247], v[108:111], a[80:95]
  s_add_u32 s21, s21, 16384
  ds_read_b128 a[244:247], v4 offset:3072
  v_exp_f32 v35, v35
  v_add_f32 v8, v8, v34
  v_mfma_f32_32x32x16_bf16 a[96:111], a[248:251], v[108:111], a[96:111]
  s_and_b32 s21, s21, 131071
  ds_read_b128 a[248:251], v4 offset:5120
  v_exp_f32 v36, v36
  v_add_f32 v9, v9, v35
  v_cvt_pk_bf16_f32 v97, v34, v35
  v_mfma_f32_32x32x16_bf16 a[112:127], a[252:255], v[108:111], a[112:127]
  ds_read_b128 a[252:255], v4 offset:7168
  v_exp_f32 v37, v37
  v_add_f32 v8, v8, v36
  v_mfma_f32_32x32x16_bf16 v[48:63], a[192:195], a[160:163], v[80:95]
  s_add_u32 s23, s23, 1
  ds_read_b128 a[192:195], v4 offset:8192
  v_exp_f32 v38, v38
  v_add_f32 v9, v9, v37
  v_cvt_pk_bf16_f32 v98, v36, v37
  v_mfma_f32_32x32x16_bf16 v[48:63], a[196:199], a[164:167], v[48:63]
  s_sub_u32 s22, s22, 1
  ds_read_b128 a[196:199], v4 offset:9216
  v_exp_f32 v39, v39
  v_add_f32 v8, v8, v38
  v_mfma_f32_32x32x16_bf16 v[48:63], a[200:203], a[168:171], v[48:63]
  s_cmp_lt_u32 s23, 3
  ds_read_b128 a[200:203], v4 offset:10240
  v_exp_f32 v40, v40
  v_add_f32 v9, v9, v39
  v_cvt_pk_bf16_f32 v99, v38, v39
  v_mfma_f32_32x32x16_bf16 v[48:63], a[204:207], a[172:175], v[48:63]
  s_cbranch_scc1 A_upd_163
A_back_164:
  ds_read_b128 a[204:207], v4 offset:11264
  v_exp_f32 v41, v41
  v_add_f32 v8, v8, v40
  v_mfma_f32_32x32x16_bf16 v[48:63], a[208:211], a[176:179], v[48:63]
  s_cmp_lt_u32 s17, s36
  ds_read_b128 a[208:211], v4 offset:12288
  v_exp_f32 v42, v42
  v_add_f32 v9, v9, v41
  v_cvt_pk_bf16_f32 v100, v40, v41
  v_mfma_f32_32x32x16_bf16 v[48:63], a[212:215], a[180:183], v[48:63]
  s_cbranch_scc1 A_kvw_166
A_kvb_167:
  ds_read_b128 a[212:215], v4 offset:13312
  v_exp_f32 v43, v43
  v_add_f32 v8, v8, v42
  v_mfma_f32_32x32x16_bf16 v[48:63], a[216:219], a[184:187], v[48:63]
  s_mov_b32 m0, s21
  ds_read_b128 a[216:219], v4 offset:14336
  v_exp_f32 v44, v44
  v_add_f32 v9, v9, v43
  v_cvt_pk_bf16_f32 v101, v42, v43
  v_mfma_f32_32x32x16_bf16 v[48:63], a[220:223], a[188:191], v[48:63]
  s_waitcnt lgkmcnt(13)
  ds_read_b128 a[220:223], v4 offset:15360
  v_exp_f32 v45, v45
  v_add_f32 v8, v8, v44
  v_mfma_f32_32x32x16_bf16 a[0:15], a[224:227], v[96:99], a[0:15]
  buffer_load_dwordx4 v3, s[4:7], s18 offen offset:0 sc1 lds
  v_exp_f32 v46, v46
  v_add_f32 v9, v9, v45
  v_cvt_pk_bf16_f32 v102, v44, v45
  v_mfma_f32_32x32x16_bf16 a[16:31], a[228:231], v[96:99], a[16:31]
  s_waitcnt lgkmcnt(12)
  v_exp_f32 v47, v47
  v_add_f32 v8, v8, v46
  v_add_u32 v4, 16384, v4
  v_mfma_f32_32x32x16_bf16 a[32:47], a[232:235], v[96:99], a[32:47]
  buffer_load_dwordx4 v3, s[4:7], s18 offen offset:1024 sc1 lds
  v_exp_f32 v48, v48
  v_add_f32 v9, v9, v47
  v_cvt_pk_bf16_f32 v103, v46, v47
  v_mfma_f32_32x32x16_bf16 a[48:63], a[236:239], v[96:99], a[48:63]
  s_waitcnt lgkmcnt(10)
  s_add_u32 m0, s21, 8192
  v_exp_f32 v49, v49
  v_add_f32 v10, v10, v48
  v_and_b32 v4, 131071, v4
  v_mfma_f32_32x32x16_bf16 a[0:15], a[240:243], v[100:103], a[0:15]
  buffer_load_dwordx4 v3, s[4:7], s17 offen offset:0 sc1 lds
  v_exp_f32 v50, v50
  v_add_f32 v11, v11, v49
  v_cvt_pk_bf16_f32 v104, v48, v49
  v_mfma_f32_32x32x16_bf16 a[16:31], a[244:247], v[100:103], a[16:31]
  s_waitcnt lgkmcnt(8)
  s_cmp_lg_u32 s22, 0
  v_exp_f32 v51, v51
  v_add_f32 v10, v10, v50
  v_mfma_f32_32x32x16_bf16 a[32:47], a[248:251], v[100:103], a[32:47]
  buffer_load_dwordx4 v3, s[4:7], s17 offen offset:1024 sc1 lds
  v_exp_f32 v52, v52
  v_add_f32 v11, v11, v51
  v_cvt_pk_bf16_f32 v105, v50, v51
  v_mfma_f32_32x32x16_bf16 a[48:63], a[252:255], v[100:103], a[48:63]
  v_exp_f32 v53, v53
  v_add_f32 v10, v10, v52
  s_cbranch_scc1 A_top_162
  v_exp_f32 v54, v54
  v_add_f32 v11, v11, v53
  v_cvt_pk_bf16_f32 v106, v52, v53
  v_exp_f32 v55, v55
  v_add_f32 v10, v10, v54
  v_exp_f32 v56, v56
  v_add_f32 v11, v11, v55
  v_cvt_pk_bf16_f32 v107, v54, v55
  v_exp_f32 v57, v57
  v_add_f32 v10, v10, v56
  v_exp_f32 v58, v58
  v_add_f32 v11, v11, v57
  v_cvt_pk_bf16_f32 v108, v56, v57
  v_exp_f32 v59, v59
  v_add_f32 v10, v10, v58
  v_exp_f32 v60, v60
  v_add_f32 v11, v11, v59
  v_cvt_pk_bf16_f32 v109, v58, v59
  v_exp_f32 v61, v61
  v_add_f32 v10, v10, v60
  v_exp_f32 v62, v62
  v_add_f32 v11, v11, v61
  v_cvt_pk_bf16_f32 v110, v60, v61
  v_exp_f32 v63, v63
  v_add_f32 v10, v10, v62
  v_add_f32 v11, v11, v63
  v_cvt_pk_bf16_f32 v111, v62, v63
  s_nop 1
  v_mfma_f32_32x32x16_bf16 a[64:79], a[224:227], v[104:107], a[64:79]
  v_mfma_f32_32x32x16_bf16 a[80:95], a[228:231], v[104:107], a[80:95]
  v_mfma_f32_32x32x16_bf16 a[96:111], a[232:235], v[104:107], a[96:111]
  v_mfma_f32_32x32x16_bf16 a[112:127], a[236:239], v[104:107], a[112:127]
  v_mfma_f32_32x32x16_bf16 a[64:79], a[240:243], v[108:111], a[64:79]
  v_mfma_f32_32x32x16_bf16 a[80:95], a[244:247], v[108:111], a[80:95]
  v_mfma_f32_32x32x16_bf16 a[96:111], a[248:251], v[108:111], a[96:111]
  v_mfma_f32_32x32x16_bf16 a[112:127], a[252:255], v[108:111], a[112:127]
  v_add_f32 v8, v8, v9
  v_mov_b32 v9, v8
  s_nop 1
  v_permlane32_swap_b32 v8, v9
  s_nop 1
  v_add_f32 v8, v8, v9
  v_add_f32 v10, v10, v11
  v_mov_b32 v11, v10
  s_nop 1
  v_permlane32_swap_b32 v10, v11
  s_nop 1
  v_add_f32 v10, v10, v11
  v_subrev_u32 v12, 0x2f800000, v8
  v_subrev_u32 v13, 0x2f800000, v10
  v_max_u32 v12, v12, v13
  v_cmp_le_u32 vcc, 0x28000000, v12
  s_nop 1
  s_cmp_lg_u64 vcc, 0
  s_cselect_b32 s26, 1, 0
  v_mov_b32 v12, s26
  s_lshl_b32 s26, s16, 2
  s_add_u32 s26, s26, 131072
  v_mov_b32 v13, s26
  ds_write_b32 v13, v12
  v_mov_b32 v14, 131072
  s_waitcnt vmcnt(0) lgkmcnt(0)
  s_barrier
  ds_read_b128 v[16:19], v14
  v_rcp_f32 v8, v8
  v_rcp_f32 v10, v10
  s_waitcnt lgkmcnt(0)
  v_or3_b32 v12, v16, v17, v18
  v_or_b32 v12, v12, v19
  s_nop 0
  v_readfirstlane_b32 s26, v12
  s_nop 1
  s_cmp_gt_u32 s26, s29
  s_cbranch_scc1 A_slow_168
  s_add_u32 s28, s25, 100663296
  v_accvgpr_read_b32 v112, a0
  v_accvgpr_read_b32 v113, a1
  v_accvgpr_read_b32 v114, a2
  v_accvgpr_read_b32 v115, a3
  v_accvgpr_read_b32 v116, a4
  v_accvgpr_read_b32 v117, a5
  v_accvgpr_read_b32 v118, a6
  v_accvgpr_read_b32 v119, a7
  v_pk_mul_f32 v[112:113], v[112:113], v[8:9] op_sel_hi:[1,0]
  v_pk_mul_f32 v[114:115], v[114:115], v[8:9] op_sel_hi:[1,0]
  v_pk_mul_f32 v[116:117], v[116:117], v[8:9] op_sel_hi:[1,0]
  v_pk_mul_f32 v[118:119], v[118:119], v[8:9] op_sel_hi:[1,0]
  v_cvt_pk_bf16_f32 v120, v112, v113
  v_cvt_pk_bf16_f32 v121, v114, v115
  v_cvt_pk_bf16_f32 v122, v116, v117
  v_cvt_pk_bf16_f32 v123, v118, v119
  buffer_store_dwordx4 v[120:123], v2, s[4:7], s28 offen offset:0 sc1
  v_accvgpr_read_b32 v124, a8
  v_accvgpr_read_b32 v125, a9
  v_accvgpr_read_b32 v126, a10
  v_accvgpr_read_b32 v127, a11
  v_accvgpr_read_b32 v128, a12
  v_accvgpr_read_b32 v129, a13
  v_accvgpr_read_b32 v130, a14
  v_accvgpr_read_b32 v131, a15
  v_pk_mul_f32 v[124:125], v[124:125], v[8:9] op_sel_hi:[1,0]
  v_pk_mul_f32 v[126:127], v[126:127], v[8:9] op_sel_hi:[1,0]
  v_pk_mul_f32 v[128:129], v[128:129], v[8:9] op_sel_hi:[1,0]
  v_pk_mul_f32 v[130:131], v[130:131], v[8:9] op_sel_hi:[1,0]
  v_cvt_pk_bf16_f32 v132, v124, v125
  v_cvt_pk_bf16_f32 v133, v126, v127
  v_cvt_pk_bf16_f32 v134, v128, v129
  v_cvt_pk_bf16_f32 v135, v130, v131
  buffer_store_dwordx4 v[132:135], v2, s[4:7], s28 offen offset:1024 sc1
  v_accvgpr_read_b32 v136, a16
  v_accvgpr_read_b32 v137, a17
  v_accvgpr_read_b32 v138, a18
  v_accvgpr_read_b32 v139, a19
  v_accvgpr_read_b32 v140, a20
  v_accvgpr_read_b32 v141, a21
  v_accvgpr_read_b32 v142, a22
  v_accvgpr_read_b32 v143, a23
  v_pk_mul_f32 v[136:137], v[136:137], v[8:9] op_sel_hi:[1,0]
  v_pk_mul_f32 v[138:139], v[138:139], v[8:9] op_sel_hi:[1,0]
  v_pk_mul_f32 v[140:141], v[140:141], v[8:9] op_sel_hi:[1,0]
  v_pk_mul_f32 v[142:143], v[142:143], v[8:9] op_sel_hi:[1,0]
  v_cvt_pk_bf16_f32 v144, v136, v137
  v_cvt_pk_bf16_f32 v145, v138, v139
  v_cvt_pk_bf16_f32 v146, v140, v141
  v_cvt_pk_bf16_f32 v147, v142, v143
  buffer_store_dwordx4 v[144:147], v2, s[4:7], s28 offen offset:2048 sc1
  v_accvgpr_read_b32 v148, a24
  v_accvgpr_read_b32 v149, a25
  v_accvgpr_read_b32 v150, a26
  v_accvgpr_read_b32 v151, a27
  v_accvgpr_read_b32 v152, a28
  v_accvgpr_read_b32 v153, a29
  v_accvgpr_read_b32 v154, a30
  v_accvgpr_read_b32 v155, a31
  v_pk_mul_f32 v[148:149], v[148:149], v[8:9] op_sel_hi:[1,0]
  v_pk_mul_f32 v[150:151], v[150:151], v[8:9] op_sel_hi:[1,0]
  v_pk_mul_f32 v[152:153], v[152:153], v[8:9] op_sel_hi:[1,0]
  v_pk_mul_f32 v[154:155], v[154:155], v[8:9] op_sel_hi:[1,0]
  v_cvt_pk_bf16_f32 v156, v148, v149
  v_cvt_pk_bf16_f32 v157, v150, v151
  v_cvt_pk_bf16_f32 v158, v152, v153
  v_cvt_pk_bf16_f32 v159, v154, v155
  buffer_store_dwordx4 v[156:159], v2, s[4:7], s28 offen offset:3072 sc1
  s_add_u32 s28, s25, 100667392
  v_accvgpr_read_b32 v112, a32
  v_accvgpr_read_b32 v113, a33
  v_accvgpr_read_b32 v114, a34
  v_accvgpr_read_b32 v115, a35
  v_accvgpr_read_b32 v116, a36
  v_accvgpr_read_b32 v117, a37
  v_accvgpr_read_b32 v118, a38
  v_accvgpr_read_b32 v119, a39
  v_pk_mul_f32 v[112:113], v[112:113], v[8:9] op_sel_hi:[1,0]
  v_pk_mul_f32 v[114:115], v[114:115], v[8:9] op_sel_hi:[1,0]
  v_pk_mul_f32 v[116:117], v[116:117], v[8:9] op_sel_hi:[1,0]
  v_pk_mul_f32 v[118:119], v[118:119], v[8:9] op_sel_hi:[1,0]
  v_cvt_pk_bf16_f32 v120, v112, v113
  v_cvt_pk_bf16_f32 v121, v114, v115
  v_cvt_pk_bf16_f32 v122, v116, v117
  v_cvt_pk_bf16_f32 v123, v118, v119
  buffer_store_dwordx4 v[120:123], v2, s[4:7], s28 offen offset:0 sc1
  v_accvgpr_read_b32 v124, a40
  v_accvgpr_read_b32 v125, a41
  v_accvgpr_read_b32 v126, a42
  v_accvgpr_read_b32 v127, a43
  v_accvgpr_read_b32 v128, a44
  v_accvgpr_read_b32 v129, a45
  v_accvgpr_read_b32 v130, a46
  v_accvgpr_read_b32 v131, a47
  v_pk_mul_f32 v[124:125], v[124:125], v[8:9] op_sel_hi:[1,0]
  v_pk_mul_f32 v[126:127], v[126:127], v[8:9] op_sel_hi:[1,0]
  v_pk_mul_f32 v[128:129], v[128:129], v[8:9] op_sel_hi:[1,0]
  v_pk_mul_f32 v[130:131], v[130:131], v[8:9] op_sel_hi:[1,0]
  v_cvt_pk_bf16_f32 v132, v124, v125
  v_cvt_pk_bf16_f32 v133, v126, v127
  v_cvt_pk_bf16_f32 v134, v128, v129
  v_cvt_pk_bf16_f32 v135, v130, v131
  buffer_store_dwordx4 v[132:135], v2, s[4:7], s28 offen offset:1024 sc1
  v_accvgpr_read_b32 v136, a48
  v_accvgpr_read_b32 v137, a49
  v_accvgpr_read_b32 v138, a50
  v_accvgpr_read_b32 v139, a51
  v_accvgpr_read_b32 v140, a52
  v_accvgpr_read_b32 v141, a53
  v_accvgpr_read_b32 v142, a54
  v_accvgpr_read_b32 v143, a55
  v_pk_mul_f32 v[136:137], v[136:137], v[8:9] op_sel_hi:[1,0]
  v_pk_mul_f32 v[138:139], v[138:139], v[8:9] op_sel_hi:[1,0]
  v_pk_mul_f32 v[140:141], v[140:141], v[8:9] op_sel_hi:[1,0]
  v_pk_mul_f32 v[142:143], v[142:143], v[8:9] op_sel_hi:[1,0]
  v_cvt_pk_bf16_f32 v144, v136, v137
  v_cvt_pk_bf16_f32 v145, v138, v139
  v_cvt_pk_bf16_f32 v146, v140, v141
  v_cvt_pk_bf16_f32 v147, v142, v143
  buffer_store_dwordx4 v[144:147], v2, s[4:7], s28 offen offset:2048 sc1
  v_accvgpr_read_b32 v148, a56
  v_accvgpr_read_b32 v149, a57
  v_accvgpr_read_b32 v150, a58
  v_accvgpr_read_b32 v151, a59
  v_accvgpr_read_b32 v152, a60
  v_accvgpr_read_b32 v153, a61
  v_accvgpr_read_b32 v154, a62
  v_accvgpr_read_b32 v155, a63
  v_pk_mul_f32 v[148:149], v[148:149], v[8:9] op_sel_hi:[1,0]
  v_pk_mul_f32 v[150:151], v[150:151], v[8:9] op_sel_hi:[1,0]
  v_pk_mul_f32 v[152:153], v[152:153], v[8:9] op_sel_hi:[1,0]
  v_pk_mul_f32 v[154:155], v[154:155], v[8:9] op_sel_hi:[1,0]
  v_cvt_pk_bf16_f32 v156, v148, v149
  v_cvt_pk_bf16_f32 v157, v150, v151
  v_cvt_pk_bf16_f32 v158, v152, v153
  v_cvt_pk_bf16_f32 v159, v154, v155
  buffer_store_dwordx4 v[156:159], v2, s[4:7], s28 offen offset:3072 sc1
  s_add_u32 s28, s25, 100671488
  v_accvgpr_read_b32 v112, a64
  v_accvgpr_read_b32 v113, a65
  v_accvgpr_read_b32 v114, a66
  v_accvgpr_read_b32 v115, a67
  v_accvgpr_read_b32 v116, a68
  v_accvgpr_read_b32 v117, a69
  v_accvgpr_read_b32 v118, a70
  v_accvgpr_read_b32 v119, a71
  v_pk_mul_f32 v[112:113], v[112:113], v[10:11] op_sel_hi:[1,0]
  v_pk_mul_f32 v[114:115], v[114:115], v[10:11] op_sel_hi:[1,0]
  v_pk_mul_f32 v[116:117], v[116:117], v[10:11] op_sel_hi:[1,0]
  v_pk_mul_f32 v[118:119], v[118:119], v[10:11] op_sel_hi:[1,0]
  v_cvt_pk_bf16_f32 v120, v112, v113
  v_cvt_pk_bf16_f32 v121, v114, v115
  v_cvt_pk_bf16_f32 v122, v116, v117
  v_cvt_pk_bf16_f32 v123, v118, v119
  buffer_store_dwordx4 v[120:123], v2, s[4:7], s28 offen offset:0 sc1
  v_accvgpr_read_b32 v124, a72
  v_accvgpr_read_b32 v125, a73
  v_accvgpr_read_b32 v126, a74
  v_accvgpr_read_b32 v127, a75
  v_accvgpr_read_b32 v128, a76
  v_accvgpr_read_b32 v129, a77
  v_accvgpr_read_b32 v130, a78
  v_accvgpr_read_b32 v131, a79
  v_pk_mul_f32 v[124:125], v[124:125], v[10:11] op_sel_hi:[1,0]
  v_pk_mul_f32 v[126:127], v[126:127], v[10:11] op_sel_hi:[1,0]
  v_pk_mul_f32 v[128:129], v[128:129], v[10:11] op_sel_hi:[1,0]
  v_pk_mul_f32 v[130:131], v[130:131], v[10:11] op_sel_hi:[1,0]
  v_cvt_pk_bf16_f32 v132, v124, v125
  v_cvt_pk_bf16_f32 v133, v126, v127
  v_cvt_pk_bf16_f32 v134, v128, v129
  v_cvt_pk_bf16_f32 v135, v130, v131
  buffer_store_dwordx4 v[132:135], v2, s[4:7], s28 offen offset:1024 sc1
  v_accvgpr_read_b32 v136, a80
  v_accvgpr_read_b32 v137, a81
  v_accvgpr_read_b32 v138, a82
  v_accvgpr_read_b32 v139, a83
  v_accvgpr_read_b32 v140, a84
  v_accvgpr_read_b32 v141, a85
  v_accvgpr_read_b32 v142, a86
  v_accvgpr_read_b32 v143, a87
  v_pk_mul_f32 v[136:137], v[136:137], v[10:11] op_sel_hi:[1,0]
  v_pk_mul_f32 v[138:139], v[138:139], v[10:11] op_sel_hi:[1,0]
  v_pk_mul_f32 v[140:141], v[140:141], v[10:11] op_sel_hi:[1,0]
  v_pk_mul_f32 v[142:143], v[142:143], v[10:11] op_sel_hi:[1,0]
  v_cvt_pk_bf16_f32 v144, v136, v137
  v_cvt_pk_bf16_f32 v145, v138, v139
  v_cvt_pk_bf16_f32 v146, v140, v141
  v_cvt_pk_bf16_f32 v147, v142, v143
  buffer_store_dwordx4 v[144:147], v2, s[4:7], s28 offen offset:2048 sc1
  v_accvgpr_read_b32 v148, a88
  v_accvgpr_read_b32 v149, a89
  v_accvgpr_read_b32 v150, a90
  v_accvgpr_read_b32 v151, a91
  v_accvgpr_read_b32 v152, a92
  v_accvgpr_read_b32 v153, a93
  v_accvgpr_read_b32 v154, a94
  v_accvgpr_read_b32 v155, a95
  v_pk_mul_f32 v[148:149], v[148:149], v[10:11] op_sel_hi:[1,0]
  v_pk_mul_f32 v[150:151], v[150:151], v[10:11] op_sel_hi:[1,0]
  v_pk_mul_f32 v[152:153], v[152:153], v[10:11] op_sel_hi:[1,0]
  v_pk_mul_f32 v[154:155], v[154:155], v[10:11] op_sel_hi:[1,0]
  v_cvt_pk_bf16_f32 v156, v148, v149
  v_cvt_pk_bf16_f32 v157, v150, v151
  v_cvt_pk_bf16_f32 v158, v152, v153
  v_cvt_pk_bf16_f32 v159, v154, v155
  buffer_store_dwordx4 v[156:159], v2, s[4:7], s28 offen offset:3072 sc1
  s_add_u32 s28, s25, 100675584
  v_accvgpr_read_b32 v112, a96
  v_accvgpr_read_b32 v113, a97
  v_accvgpr_read_b32 v114, a98
  v_accvgpr_read_b32 v115, a99
  v_accvgpr_read_b32 v116, a100
  v_accvgpr_read_b32 v117, a101
  v_accvgpr_read_b32 v118, a102
  v_accvgpr_read_b32 v119, a103
  v_pk_mul_f32 v[112:113], v[112:113], v[10:11] op_sel_hi:[1,0]
  v_pk_mul_f32 v[114:115], v[114:115], v[10:11] op_sel_hi:[1,0]
  v_pk_mul_f32 v[116:117], v[116:117], v[10:11] op_sel_hi:[1,0]
  v_pk_mul_f32 v[118:119], v[118:119], v[10:11] op_sel_hi:[1,0]
  v_cvt_pk_bf16_f32 v120, v112, v113
  v_cvt_pk_bf16_f32 v121, v114, v115
  v_cvt_pk_bf16_f32 v122, v116, v117
  v_cvt_pk_bf16_f32 v123, v118, v119
  buffer_store_dwordx4 v[120:123], v2, s[4:7], s28 offen offset:0 sc1
  v_accvgpr_read_b32 v124, a104
  v_accvgpr_read_b32 v125, a105
  v_accvgpr_read_b32 v126, a106
  v_accvgpr_read_b32 v127, a107
  v_accvgpr_read_b32 v128, a108
  v_accvgpr_read_b32 v129, a109
  v_accvgpr_read_b32 v130, a110
  v_accvgpr_read_b32 v131, a111
  v_pk_mul_f32 v[124:125], v[124:125], v[10:11] op_sel_hi:[1,0]
  v_pk_mul_f32 v[126:127], v[126:127], v[10:11] op_sel_hi:[1,0]
  v_pk_mul_f32 v[128:129], v[128:129], v[10:11] op_sel_hi:[1,0]
  v_pk_mul_f32 v[130:131], v[130:131], v[10:11] op_sel_hi:[1,0]
  v_cvt_pk_bf16_f32 v132, v124, v125
  v_cvt_pk_bf16_f32 v133, v126, v127
  v_cvt_pk_bf16_f32 v134, v128, v129
  v_cvt_pk_bf16_f32 v135, v130, v131
  buffer_store_dwordx4 v[132:135], v2, s[4:7], s28 offen offset:1024 sc1
  v_accvgpr_read_b32 v136, a112
  v_accvgpr_read_b32 v137, a113
  v_accvgpr_read_b32 v138, a114
  v_accvgpr_read_b32 v139, a115
  v_accvgpr_read_b32 v140, a116
  v_accvgpr_read_b32 v141, a117
  v_accvgpr_read_b32 v142, a118
  v_accvgpr_read_b32 v143, a119
  v_pk_mul_f32 v[136:137], v[136:137], v[10:11] op_sel_hi:[1,0]
  v_pk_mul_f32 v[138:139], v[138:139], v[10:11] op_sel_hi:[1,0]
  v_pk_mul_f32 v[140:141], v[140:141], v[10:11] op_sel_hi:[1,0]
  v_pk_mul_f32 v[142:143], v[142:143], v[10:11] op_sel_hi:[1,0]
  v_cvt_pk_bf16_f32 v144, v136, v137
  v_cvt_pk_bf16_f32 v145, v138, v139
  v_cvt_pk_bf16_f32 v146, v140, v141
  v_cvt_pk_bf16_f32 v147, v142, v143
  buffer_store_dwordx4 v[144:147], v2, s[4:7], s28 offen offset:2048 sc1
  v_accvgpr_read_b32 v148, a120
  v_accvgpr_read_b32 v149, a121
  v_accvgpr_read_b32 v150, a122
  v_accvgpr_read_b32 v151, a123
  v_accvgpr_read_b32 v152, a124
  v_accvgpr_read_b32 v153, a125
  v_accvgpr_read_b32 v154, a126
  v_accvgpr_read_b32 v155, a127
  v_pk_mul_f32 v[148:149], v[148:149], v[10:11] op_sel_hi:[1,0]
  v_pk_mul_f32 v[150:151], v[150:151], v[10:11] op_sel_hi:[1,0]
  v_pk_mul_f32 v[152:153], v[152:153], v[10:11] op_sel_hi:[1,0]
  v_pk_mul_f32 v[154:155], v[154:155], v[10:11] op_sel_hi:[1,0]
  v_cvt_pk_bf16_f32 v156, v148, v149
  v_cvt_pk_bf16_f32 v157, v150, v151
  v_cvt_pk_bf16_f32 v158, v152, v153
  v_cvt_pk_bf16_f32 v159, v154, v155
  buffer_store_dwordx4 v[156:159], v2, s[4:7], s28 offen offset:3072 sc1
  s_branch A_out_165
A_kvw_166:
M_kv_169:
  s_cmp_ge_u32 s17, s36
  s_cbranch_scc1 M_kvok_170
  s_mov_b32 s76, 0
  s_mov_b32 s78, 23
  s_mov_b32 s77, 335872
  s_cmp_eq_u32 s68, 1
  s_cmov_b32 s76, 128
  s_cmov_b32 s78, 27
  s_cmov_b32 s77, 114688
  s_cmp_eq_u32 s68, 2
  s_cmov_b32 s76, 768
  s_cmov_b32 s78, 14
  s_cmov_b32 s77, 0
  s_add_u32 s76, s76, s67
  s_mov_b32 s71, 0
  s_branch M_sg_172
M_sw_171:
  s_sleep 8
  s_add_u32 s71, s71, 1
  s_cmp_gt_u32 s71, 262144
  s_cbranch_scc1 M_exit
M_sg_172:
  s_mov_b32 s79, 0
  s_atomic_or s79, s[72:73], s76 glc
  s_waitcnt lgkmcnt(0)
  s_cmp_lt_u32 s79, s78
  s_cbranch_scc1 M_sw_171
  s_add_u32 s36, s77, s19
  s_add_u32 s68, s68, 1
  s_branch M_kv_169
M_kvok_170:
  s_branch A_kvb_167
A_upd_163:
  s_cmp_eq_u32 s23, 2
  s_cbranch_scc1 A_upd2_173
  v_mov_b32 v12, s24
  v_cmp_le_i32 s[40:41], 0, v5
  v_cmp_le_i32 s[42:43], 1, v5
  v_cmp_le_i32 s[44:45], 2, v5
  v_cmp_le_i32 s[46:47], 3, v5
  v_cndmask_b32 v64, v12, v6, s[40:41]
  v_cndmask_b32 v65, v12, v6, s[42:43]
  v_cndmask_b32 v66, v12, v6, s[44:45]
  v_cndmask_b32 v67, v12, v6, s[46:47]
  v_cmp_le_i32 s[40:41], 8, v5
  v_cmp_le_i32 s[42:43], 9, v5
  v_cmp_le_i32 s[44:45], 10, v5
  v_cmp_le_i32 s[46:47], 11, v5
  v_cndmask_b32 v68, v12, v6, s[40:41]
  v_cndmask_b32 v69, v12, v6, s[42:43]
  v_cndmask_b32 v70, v12, v6, s[44:45]
  v_cndmask_b32 v71, v12, v6, s[46:47]
  v_cmp_le_i32 s[40:41], 16, v5
  v_cmp_le_i32 s[42:43], 17, v5
  v_cmp_le_i32 s[44:45], 18, v5
  v_cmp_le_i32 s[46:47], 19, v5
  v_cndmask_b32 v72, v12, v6, s[40:41]
  v_cndmask_b32 v73, v12, v6, s[42:43]
  v_cndmask_b32 v74, v12, v6, s[44:45]
  v_cndmask_b32 v75, v12, v6, s[46:47]
  v_cmp_le_i32 s[40:41], 24, v5
  v_cmp_le_i32 s[42:43], 25, v5
  v_cmp_le_i32 s[44:45], 26, v5
  v_cmp_le_i32 s[46:47], 27, v5
  v_cndmask_b32 v76, v12, v6, s[40:41]
  v_cndmask_b32 v77, v12, v6, s[42:43]
  v_cndmask_b32 v78, v12, v6, s[44:45]
  v_cndmask_b32 v79, v12, v6, s[46:47]
  v_mov_b32 v80, v7
  v_mov_b32 v81, v7
  v_mov_b32 v82, v7
  v_mov_b32 v83, v7
  v_mov_b32 v84, v7
  v_mov_b32 v85, v7
  v_mov_b32 v86, v7
  v_mov_b32 v87, v7
  v_mov_b32 v88, v7
  v_mov_b32 v89, v7
  v_mov_b32 v90, v7
  v_mov_b32 v91, v7
  v_mov_b32 v92, v7
  v_mov_b32 v93, v7
  v_mov_b32 v94, v7
  v_mov_b32 v95, v7
  s_branch A_back_164
A_upd2_173:
  v_mov_b32 v64, v6
  v_mov_b32 v65, v6
  v_mov_b32 v66, v6
  v_mov_b32 v67, v6
  v_mov_b32 v68, v6
  v_mov_b32 v69, v6
  v_mov_b32 v70, v6
  v_mov_b32 v71, v6
  v_mov_b32 v72, v6
  v_mov_b32 v73, v6
  v_mov_b32 v74, v6
  v_mov_b32 v75, v6
  v_mov_b32 v76, v6
  v_mov_b32 v77, v6
  v_mov_b32 v78, v6
  v_mov_b32 v79, v6
  s_branch A_back_164
A_slow_168:
  s_mov_b32 s29, 1
  v_mov_b32 v64, s24
  v_mov_b32 v65, s24
  v_mov_b32 v66, s24
  v_mov_b32 v67, s24
  v_mov_b32 v68, s24
  v_mov_b32 v69, s24
  v_mov_b32 v70, s24
  v_mov_b32 v71, s24
  v_mov_b32 v72, s24
  v_mov_b32 v73, s24
  v_mov_b32 v74, s24
  v_mov_b32 v75, s24
  v_mov_b32 v76, s24
  v_mov_b32 v77, s24
  v_mov_b32 v78, s24
  v_mov_b32 v79, s24
  v_mov_b32 v12, s24
  v_cmp_le_i32 s[40:41], 0, v5
  v_cmp_le_i32 s[42:43], 1, v5
  v_cmp_le_i32 s[44:45], 2, v5
  v_cmp_le_i32 s[46:47], 3, v5
  v_cndmask_b32 v80, v12, v7, s[40:41]
  v_cndmask_b32 v81, v12, v7, s[42:43]
  v_cndmask_b32 v82, v12, v7, s[44:45]
  v_cndmask_b32 v83, v12, v7, s[46:47]
  v_cmp_le_i32 s[40:41], 8, v5
  v_cmp_le_i32 s[42:43], 9, v5
  v_cmp_le_i32 s[44:45], 10, v5
  v_cmp_le_i32 s[46:47], 11, v5
  v_cndmask_b32 v84, v12, v7, s[40:41]
  v_cndmask_b32 v85, v12, v7, s[42:43]
  v_cndmask_b32 v86, v12, v7, s[44:45]
  v_cndmask_b32 v87, v12, v7, s[46:47]
  v_cmp_le_i32 s[40:41], 16, v5
  v_cmp_le_i32 s[42:43], 17, v5
  v_cmp_le_i32 s[44:45], 18, v5
  v_cmp_le_i32 s[46:47], 19, v5
  v_cndmask_b32 v88, v12, v7, s[40:41]
  v_cndmask_b32 v89, v12, v7, s[42:43]
  v_cndmask_b32 v90, v12, v7, s[44:45]
  v_cndmask_b32 v91, v12, v7, s[46:47]
  v_cmp_le_i32 s[40:41], 24, v5
  v_cmp_le_i32 s[42:43], 25, v5
  v_cmp_le_i32 s[44:45], 26, v5
  v_cmp_le_i32 s[46:47], 27, v5
  v_cndmask_b32 v92, v12, v7, s[40:41]
  v_cndmask_b32 v93, v12, v7, s[42:43]
  v_cndmask_b32 v94, v12, v7, s[44:45]
  v_cndmask_b32 v95, v12, v7, s[46:47]
  v_mov_b32 v8, s24
  v_mov_b32 v10, s24
  s_add_u32 s17, s25, 16785408
  s_mov_b32 s23, 0
A_ml_174:
  s_add_u32 s28, s17, 4096
  buffer_load_dwordx4 a[192:195], v2, s[4:7], s17 offen offset:0 sc1
  buffer_load_dwordx4 a[196:199], v2, s[4:7], s17 offen offset:1024 sc1
  buffer_load_dwordx4 a[200:203], v2, s[4:7], s17 offen offset:2048 sc1
  buffer_load_dwordx4 a[204:207], v2, s[4:7], s17 offen offset:3072 sc1
  buffer_load_dwordx4 a[208:211], v2, s[4:7], s28 offen offset:0 sc1
  buffer_load_dwordx4 a[212:215], v2, s[4:7], s28 offen offset:1024 sc1
  buffer_load_dwordx4 a[216:219], v2, s[4:7], s28 offen offset:2048 sc1
  buffer_load_dwordx4 a[220:223], v2, s[4:7], s28 offen offset:3072 sc1
  s_waitcnt vmcnt(0)
  v_mfma_f32_32x32x16_bf16 v[32:47], a[192:195], a[128:131], v[64:79]
  v_mfma_f32_32x32x16_bf16 v[32:47], a[196:199], a[132:135], v[32:47]
  v_mfma_f32_32x32x16_bf16 v[32:47], a[200:203], a[136:139], v[32:47]
  v_mfma_f32_32x32x16_bf16 v[32:47], a[204:207], a[140:143], v[32:47]
  v_mfma_f32_32x32x16_bf16 v[32:47], a[208:211], a[144:147], v[32:47]
  v_mfma_f32_32x32x16_bf16 v[32:47], a[212:215], a[148:151], v[32:47]
  v_mfma_f32_32x32x16_bf16 v[32:47], a[216:219], a[152:155], v[32:47]
  v_mfma_f32_32x32x16_bf16 v[32:47], a[220:223], a[156:159], v[32:47]
  v_mfma_f32_32x32x16_bf16 v[48:63], a[192:195], a[160:163], v[80:95]
  v_mfma_f32_32x32x16_bf16 v[48:63], a[196:199], a[164:167], v[48:63]
  v_mfma_f32_32x32x16_bf16 v[48:63], a[200:203], a[168:171], v[48:63]
  v_mfma_f32_32x32x16_bf16 v[48:63], a[204:207], a[172:175], v[48:63]
  v_mfma_f32_32x32x16_bf16 v[48:63], a[208:211], a[176:179], v[48:63]
  v_mfma_f32_32x32x16_bf16 v[48:63], a[212:215], a[180:183], v[48:63]
  v_mfma_f32_32x32x16_bf16 v[48:63], a[216:219], a[184:187], v[48:63]
  v_mfma_f32_32x32x16_bf16 v[48:63], a[220:223], a[188:191], v[48:63]
  s_nop 7
  s_nop 3
  v_max3_f32 v8, v8, v32, v33
  v_max3_f32 v8, v8, v34, v35
  v_max3_f32 v8, v8, v36, v37
  v_max3_f32 v8, v8, v38, v39
  v_max3_f32 v8, v8, v40, v41
  v_max3_f32 v8, v8, v42, v43
  v_max3_f32 v8, v8, v44, v45
  v_max3_f32 v8, v8, v46, v47
  v_max3_f32 v10, v10, v48, v49
  v_max3_f32 v10, v10, v50, v51
  v_max3_f32 v10, v10, v52, v53
  v_max3_f32 v10, v10, v54, v55
  v_max3_f32 v10, v10, v56, v57
  v_max3_f32 v10, v10, v58, v59
  v_max3_f32 v10, v10, v60, v61
  v_max3_f32 v10, v10, v62, v63
  s_add_u32 s23, s23, 1
  s_cmp_lg_u32 s23, 1
  s_cbranch_scc1 A_m2_175
  v_mov_b32 v12, s24
  v_cmp_le_i32 s[40:41], 0, v5
  v_cmp_le_i32 s[42:43], 1, v5
  v_cmp_le_i32 s[44:45], 2, v5
  v_cmp_le_i32 s[46:47], 3, v5
  v_cndmask_b32 v64, v12, v6, s[40:41]
  v_cndmask_b32 v65, v12, v6, s[42:43]
  v_cndmask_b32 v66, v12, v6, s[44:45]
  v_cndmask_b32 v67, v12, v6, s[46:47]
  v_cmp_le_i32 s[40:41], 8, v5
  v_cmp_le_i32 s[42:43], 9, v5
  v_cmp_le_i32 s[44:45], 10, v5
  v_cmp_le_i32 s[46:47], 11, v5
  v_cndmask_b32 v68, v12, v6, s[40:41]
  v_cndmask_b32 v69, v12, v6, s[42:43]
  v_cndmask_b32 v70, v12, v6, s[44:45]
  v_cndmask_b32 v71, v12, v6, s[46:47]
  v_cmp_le_i32 s[40:41], 16, v5
  v_cmp_le_i32 s[42:43], 17, v5
  v_cmp_le_i32 s[44:45], 18, v5
  v_cmp_le_i32 s[46:47], 19, v5
  v_cndmask_b32 v72, v12, v6, s[40:41]
  v_cndmask_b32 v73, v12, v6, s[42:43]
  v_cndmask_b32 v74, v12, v6, s[44:45]
  v_cndmask_b32 v75, v12, v6, s[46:47]
  v_cmp_le_i32 s[40:41], 24, v5
  v_cmp_le_i32 s[42:43], 25, v5
  v_cmp_le_i32 s[44:45], 26, v5
  v_cmp_le_i32 s[46:47], 27, v5
  v_cndmask_b32 v76, v12, v6, s[40:41]
  v_cndmask_b32 v77, v12, v6, s[42:43]
  v_cndmask_b32 v78, v12, v6, s[44:45]
  v_cndmask_b32 v79, v12, v6, s[46:47]
  v_mov_b32 v80, v7
  v_mov_b32 v81, v7
  v_mov_b32 v82, v7
  v_mov_b32 v83, v7
  v_mov_b32 v84, v7
  v_mov_b32 v85, v7
  v_mov_b32 v86, v7
  v_mov_b32 v87, v7
  v_mov_b32 v88, v7
  v_mov_b32 v89, v7
  v_mov_b32 v90, v7
  v_mov_b32 v91, v7
  v_mov_b32 v92, v7
  v_mov_b32 v93, v7
  v_mov_b32 v94, v7
  v_mov_b32 v95, v7
A_m2_175:
  s_cmp_lg_u32 s23, 2
  s_cbranch_scc1 A_m3_176
  v_mov_b32 v64, v6
  v_mov_b32 v65, v6
  v_mov_b32 v66, v6
  v_mov_b32 v67, v6
  v_mov_b32 v68, v6
  v_mov_b32 v69, v6
  v_mov_b32 v70, v6
  v_mov_b32 v71, v6
  v_mov_b32 v72, v6
  v_mov_b32 v73, v6
  v_mov_b32 v74, v6
  v_mov_b32 v75, v6
  v_mov_b32 v76, v6
  v_mov_b32 v77, v6
  v_mov_b32 v78, v6
  v_mov_b32 v79, v6
A_m3_176:
  s_sub_u32 s17, s17, 8192
  s_cmp_ge_i32 s17, s19
  s_cbranch_scc1 A_ml_174
  v_mov_b32 v9, v8
  s_nop 1
  v_permlane32_swap_b32 v8, v9
  s_nop 1
  v_max_f32 v8, v8, v9
  v_sub_f32 v6, 0, v8
  v_mov_b32 v11, v10
  s_nop 1
  v_permlane32_swap_b32 v10, v11
  s_nop 1
  v_max_f32 v10, v10, v11
  v_sub_f32 v7, 0, v10
  s_branch A_again_155
A_out_165:
  s_mov_b32 s69, s55
  s_mov_b32 s70, s56
  s_sub_u32 s52, s52, 1
  s_cmp_lg_u32 s52, 0
  s_cbranch_scc1 M_att
  s_waitcnt vmcnt(0)
  s_barrier
  s_mov_b32 s30, 512
  v_mov_b32 v144, s30
  v_min_u32 v145, 1, v0
  v_lshlrev_b32 v145, 30, v145
  buffer_store_dword v144, v145, s[4:7], s31 offen sc1
  s_lshr_b32 s48, s64, 2
  s_bfe_u32 s49, s64, 0x10001
  s_and_b32 s50, s64, 1
  s_mul_i32 s50, s50, 6
  s_add_u32 s50, s50, s65
  s_mov_b32 s51, 12
  s_cmp_lt_u32 s50, 4
  s_cselect_b32 s23, 6, 5
  s_load_dwordx2 s[8:9], s[0:1], 40
  s_lshl_b32 s17, s48, 19
  s_lshl_b32 s26, s49, 2
  s_add_u32 s26, s26, s16
  s_lshl_b32 s27, s26, 7
  s_add_u32 s17, s17, s27
  s_mov_b32 s18, 1024
  s_lshl_b32 s21, s48, 6
  s_add_u32 s21, s21, s50
  s_lshl_b32 s21, s21, 3
  s_add_u32 s21, s21, s26
  s_lshl_b32 s21, s21, 12
  s_add_u32 s21, s21, 150994944
  s_lshl_b32 s22, s51, 15
  s_mov_b32 s24, 1.0
  s_waitcnt lgkmcnt(0)
  s_and_b32 s9, s9, 0xffff
  s_mov_b32 s10, 4194304
  s_mov_b32 s11, 0x20000
  s_mov_b32 s12, s4
  s_mov_b32 s13, s5
  s_mov_b32 s14, 268435456
  s_mov_b32 s15, 0x20000
  s_lshl_b32 s19, s48, 8
  s_add_u32 s19, s19, s50
  s_lshl_b32 s19, s19, 13
  s_add_u32 s19, s19, 100663296
  s_lshl_b32 s20, s51, 13
  v_lshrrev_b32 v144, 4, v1
  v_and_b32 v56, 0xff, v2
  v_lshl_add_u32 v56, v144, 9, v56
  s_mul_i32 s26, s16, 524288
  v_add_u32 v8, 0, v56
  v_add_u32 v16, 0, v2
  v_add_u32 v16, s26, v16
  v_add_u32 v9, 256, v56
  v_add_u32 v17, 1024, v2
  v_add_u32 v17, s26, v17
  v_add_u32 v10, 2048, v56
  v_add_u32 v18, 2048, v2
  v_add_u32 v18, s26, v18
  v_add_u32 v11, 2304, v56
  v_add_u32 v19, 3072, v2
  v_add_u32 v19, s26, v19
  v_add_u32 v12, 4096, v56
  v_add_u32 v20, 4096, v2
  v_add_u32 v20, s26, v20
  v_add_u32 v13, 4352, v56
  v_add_u32 v21, 5120, v2
  v_add_u32 v21, s26, v21
  v_add_u32 v14, 6144, v56
  v_add_u32 v22, 6144, v2
  v_add_u32 v22, s26, v22
  v_add_u32 v15, 6400, v56
  v_add_u32 v23, 7168, v2
  v_add_u32 v23, s26, v23
  v_lshrrev_b32 v144, 3, v1
  v_mul_lo_u32 v144, v144, s18
  v_and_b32 v145, 7, v1
  v_lshl_add_u32 v144, v145, 4, v144
  s_lshl_b32 s28, s16, 15
  s_add_u32 s28, s28, 32768
  s_lshl_b32 s29, s18, 3
  s_add_u32 m0, s28, 0
  s_nop 0
  buffer_load_dwordx4 v144, s[8:11], s17 offen lds
  s_add_u32 s17, s17, s29
  s_add_u32 m0, s28, 1024
  s_nop 0
  buffer_load_dwordx4 v144, s[8:11], s17 offen lds
  s_add_u32 s17, s17, s29
  s_add_u32 m0, s28, 2048
  s_nop 0
  buffer_load_dwordx4 v144, s[8:11], s17 offen lds
  s_add_u32 s17, s17, s29
  s_add_u32 m0, s28, 3072
  s_nop 0
  buffer_load_dwordx4 v144, s[8:11], s17 offen lds
  s_add_u32 s17, s17, s29
  s_add_u32 m0, s28, 4096
  s_nop 0
  buffer_load_dwordx4 v144, s[8:11], s17 offen lds
  s_add_u32 s17, s17, s29
  s_add_u32 m0, s28, 5120
  s_nop 0
  buffer_load_dwordx4 v144, s[8:11], s17 offen lds
  s_add_u32 s17, s17, s29
  s_add_u32 m0, s28, 6144
  s_nop 0
  buffer_load_dwordx4 v144, s[8:11], s17 offen lds
  s_add_u32 s17, s17, s29
  s_add_u32 m0, s28, 7168
  s_nop 0
  buffer_load_dwordx4 v144, s[8:11], s17 offen lds
  s_add_u32 s17, s17, s29
  s_add_u32 m0, s28, 8192
  s_nop 0
  buffer_load_dwordx4 v144, s[8:11], s17 offen lds
  s_add_u32 s17, s17, s29
  s_add_u32 m0, s28, 9216
  s_nop 0
  buffer_load_dwordx4 v144, s[8:11], s17 offen lds
  s_add_u32 s17, s17, s29
  s_add_u32 m0, s28, 10240
  s_nop 0
  buffer_load_dwordx4 v144, s[8:11], s17 offen lds
  s_add_u32 s17, s17, s29
  s_add_u32 m0, s28, 11264
  s_nop 0
  buffer_load_dwordx4 v144, s[8:11], s17 offen lds
  s_add_u32 s17, s17, s29
  s_add_u32 m0, s28, 12288
  s_nop 0
  buffer_load_dwordx4 v144, s[8:11], s17 offen lds
  s_add_u32 s17, s17, s29
  s_add_u32 m0, s28, 13312
  s_nop 0
  buffer_load_dwordx4 v144, s[8:11], s17 offen lds
  s_add_u32 s17, s17, s29
  s_add_u32 m0, s28, 14336
  s_nop 0
  buffer_load_dwordx4 v144, s[8:11], s17 offen lds
  s_add_u32 s17, s17, s29
  s_add_u32 m0, s28, 15360
  s_nop 0
  buffer_load_dwordx4 v144, s[8:11], s17 offen lds
  s_add_u32 s17, s17, s29
  s_add_u32 m0, s28, 16384
  s_nop 0
  buffer_load_dwordx4 v144, s[8:11], s17 offen lds
  s_add_u32 s17, s17, s29
  s_add_u32 m0, s28, 17408
  s_nop 0
  buffer_load_dwordx4 v144, s[8:11], s17 offen lds
  s_add_u32 s17, s17, s29
  s_add_u32 m0, s28, 18432
  s_nop 0
  buffer_load_dwordx4 v144, s[8:11], s17 offen lds
  s_add_u32 s17, s17, s29
  s_add_u32 m0, s28, 19456
  s_nop 0
  buffer_load_dwordx4 v144, s[8:11], s17 offen lds
  s_add_u32 s17, s17, s29
  s_add_u32 m0, s28, 20480
  s_nop 0
  buffer_load_dwordx4 v144, s[8:11], s17 offen lds
  s_add_u32 s17, s17, s29
  s_add_u32 m0, s28, 21504
  s_nop 0
  buffer_load_dwordx4 v144, s[8:11], s17 offen lds
  s_add_u32 s17, s17, s29
  s_add_u32 m0, s28, 22528
  s_nop 0
  buffer_load_dwordx4 v144, s[8:11], s17 offen lds
  s_add_u32 s17, s17, s29
  s_add_u32 m0, s28, 23552
  s_nop 0
  buffer_load_dwordx4 v144, s[8:11], s17 offen lds
  s_add_u32 s17, s17, s29
  s_add_u32 m0, s28, 24576
  s_nop 0
  buffer_load_dwordx4 v144, s[8:11], s17 offen lds
  s_add_u32 s17, s17, s29
  s_add_u32 m0, s28, 25600
  s_nop 0
  buffer_load_dwordx4 v144, s[8:11], s17 offen lds
  s_add_u32 s17, s17, s29
  s_add_u32 m0, s28, 26624
  s_nop 0
  buffer_load_dwordx4 v144, s[8:11], s17 offen lds
  s_add_u32 s17, s17, s29
  s_add_u32 m0, s28, 27648
  s_nop 0
  buffer_load_dwordx4 v144, s[8:11], s17 offen lds
  s_add_u32 s17, s17, s29
  s_add_u32 m0, s28, 28672
  s_nop 0
  buffer_load_dwordx4 v144, s[8:11], s17 offen lds
  s_add_u32 s17, s17, s29
  s_add_u32 m0, s28, 29696
  s_nop 0
  buffer_load_dwordx4 v144, s[8:11], s17 offen lds
  s_add_u32 s17, s17, s29
  s_add_u32 m0, s28, 30720
  s_nop 0
  buffer_load_dwordx4 v144, s[8:11], s17 offen lds
  s_add_u32 s17, s17, s29
  s_add_u32 m0, s28, 31744
  s_nop 0
  buffer_load_dwordx4 v144, s[8:11], s17 offen lds
  s_add_u32 s17, s17, s29
  v_bfe_u32 v148, v1, 2, 2
  v_lshrrev_b32 v149, 5, v1
  v_lshl_add_u32 v148, v149, 4, v148
  v_bfe_u32 v149, v1, 4, 1
  v_lshl_add_u32 v148, v149, 2, v148
  v_and_b32 v149, 3, v1
  v_lshlrev_b32 v149, 4, v149
  s_mov_b32 s26, 8
  v_lshl_add_u32 v148, v148, 7, v149
  v_add_u32 v152, s28, v148
  v_add_u32 v153, 1024, v152
  v_add_u32 v154, s26, v152
  v_add_u32 v155, s26, v153
  s_waitcnt vmcnt(28)
  ds_read_b64_tr_b16 a[0:1], v152 offset:0
  ds_read_b64_tr_b16 a[2:3], v153 offset:0
  ds_read_b64_tr_b16 a[4:5], v154 offset:0
  ds_read_b64_tr_b16 a[6:7], v155 offset:0
  ds_read_b64_tr_b16 a[8:9], v152 offset:64
  ds_read_b64_tr_b16 a[10:11], v153 offset:64
  ds_read_b64_tr_b16 a[12:13], v154 offset:64
  ds_read_b64_tr_b16 a[14:15], v155 offset:64
  s_waitcnt lgkmcnt(0)
  s_add_u32 m0, s28, 0
  s_nop 0
  buffer_load_dwordx4 v144, s[8:11], s17 offen lds
  s_add_u32 s17, s17, s29
  s_add_u32 m0, s28, 1024
  s_nop 0
  buffer_load_dwordx4 v144, s[8:11], s17 offen lds
  s_add_u32 s17, s17, s29
  s_add_u32 m0, s28, 2048
  s_nop 0
  buffer_load_dwordx4 v144, s[8:11], s17 offen lds
  s_add_u32 s17, s17, s29
  s_add_u32 m0, s28, 3072
  s_nop 0
  buffer_load_dwordx4 v144, s[8:11], s17 offen lds
  s_add_u32 s17, s17, s29
  s_waitcnt vmcnt(28)
  ds_read_b64_tr_b16 a[16:17], v152 offset:4096
  ds_read_b64_tr_b16 a[18:19], v153 offset:4096
  ds_read_b64_tr_b16 a[20:21], v154 offset:4096
  ds_read_b64_tr_b16 a[22:23], v155 offset:4096
  ds_read_b64_tr_b16 a[24:25], v152 offset:4160
  ds_read_b64_tr_b16 a[26:27], v153 offset:4160
  ds_read_b64_tr_b16 a[28:29], v154 offset:4160
  ds_read_b64_tr_b16 a[30:31], v155 offset:4160
  s_waitcnt lgkmcnt(0)
  s_add_u32 m0, s28, 4096
  s_nop 0
  buffer_load_dwordx4 v144, s[8:11], s17 offen lds
  s_add_u32 s17, s17, s29
  s_add_u32 m0, s28, 5120
  s_nop 0
  buffer_load_dwordx4 v144, s[8:11], s17 offen lds
  s_add_u32 s17, s17, s29
  s_add_u32 m0, s28, 6144
  s_nop 0
  buffer_load_dwordx4 v144, s[8:11], s17 offen lds
  s_add_u32 s17, s17, s29
  s_add_u32 m0, s28, 7168
  s_nop 0
  buffer_load_dwordx4 v144, s[8:11], s17 offen lds
  s_add_u32 s17, s17, s29
  s_waitcnt vmcnt(28)
  ds_read_b64_tr_b16 a[32:33], v152 offset:8192
  ds_read_b64_tr_b16 a[34:35], v153 offset:8192
  ds_read_b64_tr_b16 a[36:37], v154 offset:8192
  ds_read_b64_tr_b16 a[38:39], v155 offset:8192
  ds_read_b64_tr_b16 a[40:41], v152 offset:8256
  ds_read_b64_tr_b16 a[42:43], v153 offset:8256
  ds_read_b64_tr_b16 a[44:45], v154 offset:8256
  ds_read_b64_tr_b16 a[46:47], v155 offset:8256
  s_waitcnt lgkmcnt(0)
  s_add_u32 m0, s28, 8192
  s_nop 0
  buffer_load_dwordx4 v144, s[8:11], s17 offen lds
  s_add_u32 s17, s17, s29
  s_add_u32 m0, s28, 9216
  s_nop 0
  buffer_load_dwordx4 v144, s[8:11], s17 offen lds
  s_add_u32 s17, s17, s29
  s_add_u32 m0, s28, 10240
  s_nop 0
  buffer_load_dwordx4 v144, s[8:11], s17 offen lds
  s_add_u32 s17, s17, s29
  s_add_u32 m0, s28, 11264
  s_nop 0
  buffer_load_dwordx4 v144, s[8:11], s17 offen lds
  s_add_u32 s17, s17, s29
  s_waitcnt vmcnt(28)
  ds_read_b64_tr_b16 a[48:49], v152 offset:12288
  ds_read_b64_tr_b16 a[50:51], v153 offset:12288
  ds_read_b64_tr_b16 a[52:53], v154 offset:12288
  ds_read_b64_tr_b16 a[54:55], v155 offset:12288
  ds_read_b64_tr_b16 a[56:57], v152 offset:12352
  ds_read_b64_tr_b16 a[58:59], v153 offset:12352
  ds_read_b64_tr_b16 a[60:61], v154 offset:12352
  ds_read_b64_tr_b16 a[62:63], v155 offset:12352
  s_waitcnt lgkmcnt(0)
  s_add_u32 m0, s28, 12288
  s_nop 0
  buffer_load_dwordx4 v144, s[8:11], s17 offen lds
  s_add_u32 s17, s17, s29
  s_add_u32 m0, s28, 13312
  s_nop 0
  buffer_load_dwordx4 v144, s[8:11], s17 offen lds
  s_add_u32 s17, s17, s29
  s_add_u32 m0, s28, 14336
  s_nop 0
  buffer_load_dwordx4 v144, s[8:11], s17 offen lds
  s_add_u32 s17, s17, s29
  s_add_u32 m0, s28, 15360
  s_nop 0
  buffer_load_dwordx4 v144, s[8:11], s17 offen lds
  s_add_u32 s17, s17, s29
  s_waitcnt vmcnt(28)
  ds_read_b64_tr_b16 a[64:65], v152 offset:16384
  ds_read_b64_tr_b16 a[66:67], v153 offset:16384
  ds_read_b64_tr_b16 a[68:69], v154 offset:16384
  ds_read_b64_tr_b16 a[70:71], v155 offset:16384
  ds_read_b64_tr_b16 a[72:73], v152 offset:16448
  ds_read_b64_tr_b16 a[74:75], v153 offset:16448
  ds_read_b64_tr_b16 a[76:77], v154 offset:16448
  ds_read_b64_tr_b16 a[78:79], v155 offset:16448
  s_waitcnt lgkmcnt(0)
  s_add_u32 m0, s28, 16384
  s_nop 0
  buffer_load_dwordx4 v144, s[8:11], s17 offen lds
  s_add_u32 s17, s17, s29
  s_add_u32 m0, s28, 17408
  s_nop 0
  buffer_load_dwordx4 v144, s[8:11], s17 offen lds
  s_add_u32 s17, s17, s29
  s_add_u32 m0, s28, 18432
  s_nop 0
  buffer_load_dwordx4 v144, s[8:11], s17 offen lds
  s_add_u32 s17, s17, s29
  s_add_u32 m0, s28, 19456
  s_nop 0
  buffer_load_dwordx4 v144, s[8:11], s17 offen lds
  s_add_u32 s17, s17, s29
  s_waitcnt vmcnt(28)
  ds_read_b64_tr_b16 a[80:81], v152 offset:20480
  ds_read_b64_tr_b16 a[82:83], v153 offset:20480
  ds_read_b64_tr_b16 a[84:85], v154 offset:20480
  ds_read_b64_tr_b16 a[86:87], v155 offset:20480
  ds_read_b64_tr_b16 a[88:89], v152 offset:20544
  ds_read_b64_tr_b16 a[90:91], v153 offset:20544
  ds_read_b64_tr_b16 a[92:93], v154 offset:20544
  ds_read_b64_tr_b16 a[94:95], v155 offset:20544
  s_waitcnt lgkmcnt(0)
  s_add_u32 m0, s28, 20480
  s_nop 0
  buffer_load_dwordx4 v144, s[8:11], s17 offen lds
  s_add_u32 s17, s17, s29
  s_add_u32 m0, s28, 21504
  s_nop 0
  buffer_load_dwordx4 v144, s[8:11], s17 offen lds
  s_add_u32 s17, s17, s29
  s_add_u32 m0, s28, 22528
  s_nop 0
  buffer_load_dwordx4 v144, s[8:11], s17 offen lds
  s_add_u32 s17, s17, s29
  s_add_u32 m0, s28, 23552
  s_nop 0
  buffer_load_dwordx4 v144, s[8:11], s17 offen lds
  s_add_u32 s17, s17, s29
  s_waitcnt vmcnt(28)
  ds_read_b64_tr_b16 a[96:97], v152 offset:24576
  ds_read_b64_tr_b16 a[98:99], v153 offset:24576
  ds_read_b64_tr_b16 a[100:101], v154 offset:24576
  ds_read_b64_tr_b16 a[102:103], v155 offset:24576
  ds_read_b64_tr_b16 a[104:105], v152 offset:24640
  ds_read_b64_tr_b16 a[106:107], v153 offset:24640
  ds_read_b64_tr_b16 a[108:109], v154 offset:24640
  ds_read_b64_tr_b16 a[110:111], v155 offset:24640
  s_waitcnt lgkmcnt(0)
  s_add_u32 m0, s28, 24576
  s_nop 0
  buffer_load_dwordx4 v144, s[8:11], s17 offen lds
  s_add_u32 s17, s17, s29
  s_add_u32 m0, s28, 25600
  s_nop 0
  buffer_load_dwordx4 v144, s[8:11], s17 offen lds
  s_add_u32 s17, s17, s29
  s_add_u32 m0, s28, 26624
  s_nop 0
  buffer_load_dwordx4 v144, s[8:11], s17 offen lds
  s_add_u32 s17, s17, s29
  s_add_u32 m0, s28, 27648
  s_nop 0
  buffer_load_dwordx4 v144, s[8:11], s17 offen lds
  s_add_u32 s17, s17, s29
  s_waitcnt vmcnt(28)
  ds_read_b64_tr_b16 a[112:113], v152 offset:28672
  ds_read_b64_tr_b16 a[114:115], v153 offset:28672
  ds_read_b64_tr_b16 a[116:117], v154 offset:28672
  ds_read_b64_tr_b16 a[118:119], v155 offset:28672
  ds_read_b64_tr_b16 a[120:121], v152 offset:28736
  ds_read_b64_tr_b16 a[122:123], v153 offset:28736
  ds_read_b64_tr_b16 a[124:125], v154 offset:28736
  ds_read_b64_tr_b16 a[126:127], v155 offset:28736
  s_waitcnt lgkmcnt(0)
  s_add_u32 m0, s28, 28672
  s_nop 0
  buffer_load_dwordx4 v144, s[8:11], s17 offen lds
  s_add_u32 s17, s17, s29
  s_add_u32 m0, s28, 29696
  s_nop 0
  buffer_load_dwordx4 v144, s[8:11], s17 offen lds
  s_add_u32 s17, s17, s29
  s_add_u32 m0, s28, 30720
  s_nop 0
  buffer_load_dwordx4 v144, s[8:11], s17 offen lds
  s_add_u32 s17, s17, s29
  s_add_u32 m0, s28, 31744
  s_nop 0
  buffer_load_dwordx4 v144, s[8:11], s17 offen lds
  s_add_u32 s17, s17, s29
  s_waitcnt vmcnt(28)
  ds_read_b64_tr_b16 a[128:129], v152 offset:0
  ds_read_b64_tr_b16 a[130:131], v153 offset:0
  ds_read_b64_tr_b16 a[132:133], v154 offset:0
  ds_read_b64_tr_b16 a[134:135], v155 offset:0
  ds_read_b64_tr_b16 a[136:137], v152 offset:64
  ds_read_b64_tr_b16 a[138:139], v153 offset:64
  ds_read_b64_tr_b16 a[140:141], v154 offset:64
  ds_read_b64_tr_b16 a[142:143], v155 offset:64
  s_waitcnt lgkmcnt(0)
  s_waitcnt vmcnt(24)
  ds_read_b64_tr_b16 a[144:145], v152 offset:4096
  ds_read_b64_tr_b16 a[146:147], v153 offset:4096
  ds_read_b64_tr_b16 a[148:149], v154 offset:4096
  ds_read_b64_tr_b16 a[150:151], v155 offset:4096
  ds_read_b64_tr_b16 a[152:153], v152 offset:4160
  ds_read_b64_tr_b16 a[154:155], v153 offset:4160
  ds_read_b64_tr_b16 a[156:157], v154 offset:4160
  ds_read_b64_tr_b16 a[158:159], v155 offset:4160
  s_waitcnt lgkmcnt(0)
  s_waitcnt vmcnt(20)
  ds_read_b64_tr_b16 a[160:161], v152 offset:8192
  ds_read_b64_tr_b16 a[162:163], v153 offset:8192
  ds_read_b64_tr_b16 a[164:165], v154 offset:8192
  ds_read_b64_tr_b16 a[166:167], v155 offset:8192
  ds_read_b64_tr_b16 a[168:169], v152 offset:8256
  ds_read_b64_tr_b16 a[170:171], v153 offset:8256
  ds_read_b64_tr_b16 a[172:173], v154 offset:8256
  ds_read_b64_tr_b16 a[174:175], v155 offset:8256
  s_waitcnt lgkmcnt(0)
  s_waitcnt vmcnt(16)
  ds_read_b64_tr_b16 a[176:177], v152 offset:12288
  ds_read_b64_tr_b16 a[178:179], v153 offset:12288
  ds_read_b64_tr_b16 a[180:181], v154 offset:12288
  ds_read_b64_tr_b16 a[182:183], v155 offset:12288
  ds_read_b64_tr_b16 a[184:185], v152 offset:12352
  ds_read_b64_tr_b16 a[186:187], v153 offset:12352
  ds_read_b64_tr_b16 a[188:189], v154 offset:12352
  ds_read_b64_tr_b16 a[190:191], v155 offset:12352
  s_waitcnt lgkmcnt(0)
  s_waitcnt vmcnt(12)
  ds_read_b64_tr_b16 a[192:193], v152 offset:16384
  ds_read_b64_tr_b16 a[194:195], v153 offset:16384
  ds_read_b64_tr_b16 a[196:197], v154 offset:16384
  ds_read_b64_tr_b16 a[198:199], v155 offset:16384
  ds_read_b64_tr_b16 a[200:201], v152 offset:16448
  ds_read_b64_tr_b16 a[202:203], v153 offset:16448
  ds_read_b64_tr_b16 a[204:205], v154 offset:16448
  ds_read_b64_tr_b16 a[206:207], v155 offset:16448
  s_waitcnt lgkmcnt(0)
  s_waitcnt vmcnt(8)
  ds_read_b64_tr_b16 a[208:209], v152 offset:20480
  ds_read_b64_tr_b16 a[210:211], v153 offset:20480
  ds_read_b64_tr_b16 a[212:213], v154 offset:20480
  ds_read_b64_tr_b16 a[214:215], v155 offset:20480
  ds_read_b64_tr_b16 a[216:217], v152 offset:20544
  ds_read_b64_tr_b16 a[218:219], v153 offset:20544
  ds_read_b64_tr_b16 a[220:221], v154 offset:20544
  ds_read_b64_tr_b16 a[222:223], v155 offset:20544
  s_waitcnt lgkmcnt(0)
  s_waitcnt vmcnt(4)
  ds_read_b64_tr_b16 a[224:225], v152 offset:24576
  ds_read_b64_tr_b16 a[226:227], v153 offset:24576
  ds_read_b64_tr_b16 a[228:229], v154 offset:24576
  ds_read_b64_tr_b16 a[230:231], v155 offset:24576
  ds_read_b64_tr_b16 a[232:233], v152 offset:24640
  ds_read_b64_tr_b16 a[234:235], v153 offset:24640
  ds_read_b64_tr_b16 a[236:237], v154 offset:24640
  ds_read_b64_tr_b16 a[238:239], v155 offset:24640
  s_waitcnt lgkmcnt(0)
  s_waitcnt vmcnt(0)
  ds_read_b64_tr_b16 a[240:241], v152 offset:28672
  ds_read_b64_tr_b16 a[242:243], v153 offset:28672
  ds_read_b64_tr_b16 a[244:245], v154 offset:28672
  ds_read_b64_tr_b16 a[246:247], v155 offset:28672
  ds_read_b64_tr_b16 a[248:249], v152 offset:28736
  ds_read_b64_tr_b16 a[250:251], v153 offset:28736
  ds_read_b64_tr_b16 a[252:253], v154 offset:28736
  ds_read_b64_tr_b16 a[254:255], v155 offset:28736
  s_waitcnt lgkmcnt(0)
  v_min_u32 v4, 27, v1
  v_mul_u32_u24 v5, 37, v4
  v_lshrrev_b32 v5, 8, v5
  v_mul_u32_u24 v5, 7, v5
  v_sub_u32 v5, v4, v5
  v_mov_b32 v6, 0x200
  v_cmp_ne_u32 vcc, 6, v5
  s_mul_i32 s76, s48, 3584
  s_add_u32 s76, s76, 148897792
  v_cndmask_b32 v5, 0, v6, vcc
  v_lshl_add_u32 v4, v4, 7, s76
  s_mov_b32 s71, 0
  s_branch M_vg_178
M_vw_177:
  s_sleep 2
  s_add_u32 s71, s71, 1
  s_cmp_gt_u32 s71, 262144
  s_cbranch_scc1 M_exit
M_vg_178:
  buffer_load_dword v6, v4, s[4:7], 0 offen sc1
  s_waitcnt vmcnt(0)
  v_cmp_lt_u32 vcc, v6, v5
  s_cbranch_vccnz M_vw_177
  s_barrier
  s_lshl_b32 s25, s16, 13
  s_add_u32 m0, s25, 0
  s_nop 0
  buffer_load_dwordx4 v16, s[12:15], s19 offen sc1 lds
  s_add_u32 m0, s25, 1024
  s_nop 0
  buffer_load_dwordx4 v17, s[12:15], s19 offen sc1 lds
  s_add_u32 m0, s25, 2048
  s_nop 0
  buffer_load_dwordx4 v18, s[12:15], s19 offen sc1 lds
  s_add_u32 m0, s25, 3072
  s_nop 0
  buffer_load_dwordx4 v19, s[12:15], s19 offen sc1 lds
  s_add_u32 m0, s25, 4096
  s_nop 0
  buffer_load_dwordx4 v20, s[12:15], s19 offen sc1 lds
  s_add_u32 m0, s25, 5120
  s_nop 0
  buffer_load_dwordx4 v21, s[12:15], s19 offen sc1 lds
  s_add_u32 m0, s25, 6144
  s_nop 0
  buffer_load_dwordx4 v22, s[12:15], s19 offen sc1 lds
  s_add_u32 m0, s25, 7168
  s_nop 0
  buffer_load_dwordx4 v23, s[12:15], s19 offen sc1 lds
  s_cmp_gt_u32 s23, 1
  s_cselect_b32 s26, s20, 0
  s_add_u32 s19, s19, s26
  s_add_u32 s25, s25, 32768
  s_and_b32 s25, s25, 0x1ffff
  s_add_u32 m0, s25, 0
  s_nop 0
  buffer_load_dwordx4 v16, s[12:15], s19 offen sc1 lds
  s_add_u32 m0, s25, 1024
  s_nop 0
  buffer_load_dwordx4 v17, s[12:15], s19 offen sc1 lds
  s_add_u32 m0, s25, 2048
  s_nop 0
  buffer_load_dwordx4 v18, s[12:15], s19 offen sc1 lds
  s_add_u32 m0, s25, 3072
  s_nop 0
  buffer_load_dwordx4 v19, s[12:15], s19 offen sc1 lds
  s_add_u32 m0, s25, 4096
  s_nop 0
  buffer_load_dwordx4 v20, s[12:15], s19 offen sc1 lds
  s_add_u32 m0, s25, 5120
  s_nop 0
  buffer_load_dwordx4 v21, s[12:15], s19 offen sc1 lds
  s_add_u32 m0, s25, 6144
  s_nop 0
  buffer_load_dwordx4 v22, s[12:15], s19 offen sc1 lds
  s_add_u32 m0, s25, 7168
  s_nop 0
  buffer_load_dwordx4 v23, s[12:15], s19 offen sc1 lds
  s_cmp_gt_u32 s23, 2
  s_cselect_b32 s26, s20, 0
  s_add_u32 s19, s19, s26
  s_add_u32 s25, s25, 32768
  s_and_b32 s25, s25, 0x1ffff
  s_waitcnt vmcnt(0)
  s_barrier
  s_mov_b32 s27, s21
  v_mov_b32 v7, 0x40000000
  ds_read_b128 v[24:27], v8 offset:0
  ds_read_b128 v[28:31], v9 offset:0
  ds_read_b128 v[32:35], v10 offset:0
  ds_read_b128 v[36:39], v11 offset:0
  ds_read_b128 v[40:43], v12 offset:0
  ds_read_b128 v[44:47], v13 offset:0
.p2align 6
G_top_179:
  s_waitcnt lgkmcnt(5)
  v_mfma_f32_16x16x32_bf16 v[64:67], a[0:3], v[24:27], 0
  s_add_u32 m0, s25, 0
  ds_read_b128 v[48:51], v14 offset:0
  v_mfma_f32_16x16x32_bf16 v[68:71], a[4:7], v[24:27], 0
  v_mfma_f32_16x16x32_bf16 v[80:83], a[8:11], v[24:27], 0
  buffer_load_dwordx4 v16, s[12:15], s19 offen sc1 lds
  v_mfma_f32_16x16x32_bf16 v[84:87], a[12:15], v[24:27], 0
  s_waitcnt lgkmcnt(5)
  v_mfma_f32_16x16x32_bf16 v[72:75], a[0:3], v[28:31], 0
  ds_read_b128 v[52:55], v15 offset:0
  v_mfma_f32_16x16x32_bf16 v[76:79], a[4:7], v[28:31], 0
  v_cvt_pk_bf16_f32 v128, v96, v97
  v_cvt_pk_bf16_f32 v129, v98, v99
  v_mfma_f32_16x16x32_bf16 v[88:91], a[8:11], v[28:31], 0
  v_mfma_f32_16x16x32_bf16 v[92:95], a[12:15], v[28:31], 0
  s_waitcnt lgkmcnt(5)
  v_cvt_pk_bf16_f32 v130, v100, v101
  v_cvt_pk_bf16_f32 v131, v102, v103
  v_mfma_f32_16x16x32_bf16 v[64:67], a[16:19], v[32:35], v[64:67]
  s_add_u32 m0, s25, 1024
  ds_read_b128 v[24:27], v8 offset:8192
  v_mfma_f32_16x16x32_bf16 v[68:71], a[20:23], v[32:35], v[68:71]
  v_mfma_f32_16x16x32_bf16 v[80:83], a[24:27], v[32:35], v[80:83]
  buffer_load_dwordx4 v17, s[12:15], s19 offen sc1 lds
  v_mfma_f32_16x16x32_bf16 v[84:87], a[28:31], v[32:35], v[84:87]
  s_waitcnt lgkmcnt(5)
  v_mfma_f32_16x16x32_bf16 v[72:75], a[16:19], v[36:39], v[72:75]
  ds_read_b128 v[28:31], v9 offset:8192
  v_mfma_f32_16x16x32_bf16 v[76:79], a[20:23], v[36:39], v[76:79]
  v_mfma_f32_16x16x32_bf16 v[88:91], a[24:27], v[36:39], v[88:91]
  v_mfma_f32_16x16x32_bf16 v[92:95], a[28:31], v[36:39], v[92:95]
  s_waitcnt lgkmcnt(5)
  v_mfma_f32_16x16x32_bf16 v[64:67], a[32:35], v[40:43], v[64:67]
  s_add_u32 m0, s25, 2048
  ds_read_b128 v[32:35], v10 offset:8192
  v_mfma_f32_16x16x32_bf16 v[68:71], a[36:39], v[40:43], v[68:71]
  v_cvt_pk_bf16_f32 v132, v104, v105
  v_cvt_pk_bf16_f32 v133, v106, v107
  v_mfma_f32_16x16x32_bf16 v[80:83], a[40:43], v[40:43], v[80:83]
  buffer_load_dwordx4 v18, s[12:15], s19 offen sc1 lds
  v_mfma_f32_16x16x32_bf16 v[84:87], a[44:47], v[40:43], v[84:87]
  s_waitcnt lgkmcnt(5)
  v_cvt_pk_bf16_f32 v134, v108, v109
  v_cvt_pk_bf16_f32 v135, v110, v111
  v_mfma_f32_16x16x32_bf16 v[72:75], a[32:35], v[44:47], v[72:75]
  ds_read_b128 v[36:39], v11 offset:8192
  v_mfma_f32_16x16x32_bf16 v[76:79], a[36:39], v[44:47], v[76:79]
  v_mfma_f32_16x16x32_bf16 v[88:91], a[40:43], v[44:47], v[88:91]
  v_mfma_f32_16x16x32_bf16 v[92:95], a[44:47], v[44:47], v[92:95]
  s_waitcnt lgkmcnt(5)
  v_mfma_f32_16x16x32_bf16 v[64:67], a[48:51], v[48:51], v[64:67]
  s_add_u32 m0, s25, 3072
  ds_read_b128 v[40:43], v12 offset:8192
  v_mfma_f32_16x16x32_bf16 v[68:71], a[52:55], v[48:51], v[68:71]
  v_mfma_f32_16x16x32_bf16 v[80:83], a[56:59], v[48:51], v[80:83]
  buffer_load_dwordx4 v19, s[12:15], s19 offen sc1 lds
  v_mfma_f32_16x16x32_bf16 v[84:87], a[60:63], v[48:51], v[84:87]
  s_waitcnt lgkmcnt(5)
  v_mfma_f32_16x16x32_bf16 v[72:75], a[48:51], v[52:55], v[72:75]
  ds_read_b128 v[44:47], v13 offset:8192
  v_mfma_f32_16x16x32_bf16 v[76:79], a[52:55], v[52:55], v[76:79]
  v_cvt_pk_bf16_f32 v136, v112, v113
  v_cvt_pk_bf16_f32 v137, v114, v115
  v_mfma_f32_16x16x32_bf16 v[88:91], a[56:59], v[52:55], v[88:91]
  v_mfma_f32_16x16x32_bf16 v[92:95], a[60:63], v[52:55], v[92:95]
  s_waitcnt lgkmcnt(5)
  v_cvt_pk_bf16_f32 v138, v116, v117
  v_cvt_pk_bf16_f32 v139, v118, v119
  v_mfma_f32_16x16x32_bf16 v[64:67], a[64:67], v[24:27], v[64:67]
  s_add_u32 m0, s25, 4096
  ds_read_b128 v[48:51], v14 offset:8192
  v_mfma_f32_16x16x32_bf16 v[68:71], a[68:71], v[24:27], v[68:71]
  v_mfma_f32_16x16x32_bf16 v[80:83], a[72:75], v[24:27], v[80:83]
  buffer_load_dwordx4 v20, s[12:15], s19 offen sc1 lds
  v_mfma_f32_16x16x32_bf16 v[84:87], a[76:79], v[24:27], v[84:87]
  s_waitcnt lgkmcnt(5)
  v_mfma_f32_16x16x32_bf16 v[72:75], a[64:67], v[28:31], v[72:75]
  ds_read_b128 v[52:55], v15 offset:8192
  v_mfma_f32_16x16x32_bf16 v[76:79], a[68:71], v[28:31], v[76:79]
  v_mfma_f32_16x16x32_bf16 v[88:91], a[72:75], v[28:31], v[88:91]
  v_mfma_f32_16x16x32_bf16 v[92:95], a[76:79], v[28:31], v[92:95]
  s_waitcnt lgkmcnt(5)
  v_mfma_f32_16x16x32_bf16 v[64:67], a[80:83], v[32:35], v[64:67]
  s_add_u32 m0, s25, 5120
  ds_read_b128 v[24:27], v8 offset:16384
  v_mfma_f32_16x16x32_bf16 v[68:71], a[84:87], v[32:35], v[68:71]
  v_cvt_pk_bf16_f32 v140, v120, v121
  v_cvt_pk_bf16_f32 v141, v122, v123
  v_mfma_f32_16x16x32_bf16 v[80:83], a[88:91], v[32:35], v[80:83]
  buffer_load_dwordx4 v21, s[12:15], s19 offen sc1 lds
  v_mfma_f32_16x16x32_bf16 v[84:87], a[92:95], v[32:35], v[84:87]
  s_waitcnt lgkmcnt(5)
  v_cvt_pk_bf16_f32 v142, v124, v125
  v_cvt_pk_bf16_f32 v143, v126, v127
  v_mfma_f32_16x16x32_bf16 v[72:75], a[80:83], v[36:39], v[72:75]
  ds_read_b128 v[28:31], v9 offset:16384
  v_mfma_f32_16x16x32_bf16 v[76:79], a[84:87], v[36:39], v[76:79]
  v_mfma_f32_16x16x32_bf16 v[88:91], a[88:91], v[36:39], v[88:91]
  v_mfma_f32_16x16x32_bf16 v[92:95], a[92:95], v[36:39], v[92:95]
  s_waitcnt lgkmcnt(5)
  v_mfma_f32_16x16x32_bf16 v[64:67], a[96:99], v[40:43], v[64:67]
  s_add_u32 m0, s25, 6144
  ds_read_b128 v[32:35], v10 offset:16384
  v_mfma_f32_16x16x32_bf16 v[68:71], a[100:103], v[40:43], v[68:71]
  v_mfma_f32_16x16x32_bf16 v[80:83], a[104:107], v[40:43], v[80:83]
  buffer_load_dwordx4 v22, s[12:15], s19 offen sc1 lds
  v_mfma_f32_16x16x32_bf16 v[84:87], a[108:111], v[40:43], v[84:87]
  s_waitcnt lgkmcnt(5)
  v_mfma_f32_16x16x32_bf16 v[72:75], a[96:99], v[44:47], v[72:75]
  ds_read_b128 v[36:39], v11 offset:16384
  v_mfma_f32_16x16x32_bf16 v[76:79], a[100:103], v[44:47], v[76:79]
  v_mfma_f32_16x16x32_bf16 v[88:91], a[104:107], v[44:47], v[88:91]
  v_mfma_f32_16x16x32_bf16 v[92:95], a[108:111], v[44:47], v[92:95]
  s_waitcnt lgkmcnt(5)
  v_mfma_f32_16x16x32_bf16 v[64:67], a[112:115], v[48:51], v[64:67]
  s_add_u32 m0, s25, 7168
  ds_read_b128 v[40:43], v12 offset:16384
  v_mfma_f32_16x16x32_bf16 v[68:71], a[116:119], v[48:51], v[68:71]
  v_mfma_f32_16x16x32_bf16 v[80:83], a[120:123], v[48:51], v[80:83]
  buffer_load_dwordx4 v23, s[12:15], s19 offen sc1 lds
  v_mfma_f32_16x16x32_bf16 v[84:87], a[124:127], v[48:51], v[84:87]
  s_waitcnt lgkmcnt(5)
  v_mfma_f32_16x16x32_bf16 v[72:75], a[112:115], v[52:55], v[72:75]
  s_cmp_gt_u32 s23, 3
  ds_read_b128 v[44:47], v13 offset:16384
  v_mfma_f32_16x16x32_bf16 v[76:79], a[116:119], v[52:55], v[76:79]
  v_mfma_f32_16x16x32_bf16 v[88:91], a[120:123], v[52:55], v[88:91]
  s_cselect_b32 s26, s20, 0
  v_mfma_f32_16x16x32_bf16 v[92:95], a[124:127], v[52:55], v[92:95]
  s_waitcnt lgkmcnt(5)
  v_mfma_f32_16x16x32_bf16 v[64:67], a[128:131], v[24:27], v[64:67]
  s_add_u32 s19, s19, s26
  ds_read_b128 v[48:51], v14 offset:16384
  v_mfma_f32_16x16x32_bf16 v[68:71], a[132:135], v[24:27], v[68:71]
  v_mfma_f32_16x16x32_bf16 v[80:83], a[136:139], v[24:27], v[80:83]
  s_add_u32 s25, s25, 32768
  v_mfma_f32_16x16x32_bf16 v[84:87], a[140:143], v[24:27], v[84:87]
  s_waitcnt lgkmcnt(5)
  v_mfma_f32_16x16x32_bf16 v[72:75], a[128:131], v[28:31], v[72:75]
  s_and_b32 s25, s25, 0x1ffff
  ds_read_b128 v[52:55], v15 offset:16384
  v_mfma_f32_16x16x32_bf16 v[76:79], a[132:135], v[28:31], v[76:79]
  v_mfma_f32_16x16x32_bf16 v[88:91], a[136:139], v[28:31], v[88:91]
  buffer_store_dwordx4 v[128:131], v7, s[4:7], s21 offen offset:0 sc1
  v_mfma_f32_16x16x32_bf16 v[92:95], a[140:143], v[28:31], v[92:95]
  s_waitcnt lgkmcnt(5)
  v_mfma_f32_16x16x32_bf16 v[64:67], a[144:147], v[32:35], v[64:67]
  ds_read_b128 v[24:27], v8 offset:24576
  v_mfma_f32_16x16x32_bf16 v[68:71], a[148:151], v[32:35], v[68:71]
  v_mfma_f32_16x16x32_bf16 v[80:83], a[152:155], v[32:35], v[80:83]
  v_mfma_f32_16x16x32_bf16 v[84:87], a[156:159], v[32:35], v[84:87]
  s_waitcnt lgkmcnt(5)
  v_mfma_f32_16x16x32_bf16 v[72:75], a[144:147], v[36:39], v[72:75]
  ds_read_b128 v[28:31], v9 offset:24576
  v_mfma_f32_16x16x32_bf16 v[76:79], a[148:151], v[36:39], v[76:79]
  v_mfma_f32_16x16x32_bf16 v[88:91], a[152:155], v[36:39], v[88:91]
  buffer_store_dwordx4 v[132:135], v7, s[4:7], s21 offen offset:256 sc1
  v_mfma_f32_16x16x32_bf16 v[92:95], a[156:159], v[36:39], v[92:95]
  s_waitcnt lgkmcnt(5)
  v_mfma_f32_16x16x32_bf16 v[64:67], a[160:163], v[40:43], v[64:67]
  ds_read_b128 v[32:35], v10 offset:24576
  v_mfma_f32_16x16x32_bf16 v[68:71], a[164:167], v[40:43], v[68:71]
  v_mfma_f32_16x16x32_bf16 v[80:83], a[168:171], v[40:43], v[80:83]
  v_mfma_f32_16x16x32_bf16 v[84:87], a[172:175], v[40:43], v[84:87]
  s_waitcnt lgkmcnt(5)
  v_mfma_f32_16x16x32_bf16 v[72:75], a[160:163], v[44:47], v[72:75]
  ds_read_b128 v[36:39], v11 offset:24576
  v_mfma_f32_16x16x32_bf16 v[76:79], a[164:167], v[44:47], v[76:79]
  v_mfma_f32_16x16x32_bf16 v[88:91], a[168:171], v[44:47], v[88:91]
  buffer_store_dwordx4 v[136:139], v7, s[4:7], s21 offen offset:2048 sc1
  v_mfma_f32_16x16x32_bf16 v[92:95], a[172:175], v[44:47], v[92:95]
  s_waitcnt lgkmcnt(5)
  v_mfma_f32_16x16x32_bf16 v[64:67], a[176:179], v[48:51], v[64:67]
  ds_read_b128 v[40:43], v12 offset:24576
  v_mfma_f32_16x16x32_bf16 v[68:71], a[180:183], v[48:51], v[68:71]
  v_mfma_f32_16x16x32_bf16 v[80:83], a[184:187], v[48:51], v[80:83]
  v_mfma_f32_16x16x32_bf16 v[84:87], a[188:191], v[48:51], v[84:87]
  s_waitcnt lgkmcnt(5)
  v_mfma_f32_16x16x32_bf16 v[72:75], a[176:179], v[52:55], v[72:75]
  ds_read_b128 v[44:47], v13 offset:24576
  v_mfma_f32_16x16x32_bf16 v[76:79], a[180:183], v[52:55], v[76:79]
  v_mfma_f32_16x16x32_bf16 v[88:91], a[184:187], v[52:55], v[88:91]
  buffer_store_dwordx4 v[140:143], v7, s[4:7], s21 offen offset:2304 sc1
  v_mfma_f32_16x16x32_bf16 v[92:95], a[188:191], v[52:55], v[92:95]
  s_waitcnt lgkmcnt(5)
  v_mfma_f32_16x16x32_bf16 v[64:67], a[192:195], v[24:27], v[64:67]
  s_mov_b32 s21, s27
  ds_read_b128 v[48:51], v14 offset:24576
  v_mfma_f32_16x16x32_bf16 v[68:71], a[196:199], v[24:27], v[68:71]
  v_mov_b32 v7, v56
  v_mfma_f32_16x16x32_bf16 v[80:83], a[200:203], v[24:27], v[80:83]
  v_mfma_f32_16x16x32_bf16 v[84:87], a[204:207], v[24:27], v[84:87]
  s_waitcnt lgkmcnt(5)
  v_mfma_f32_16x16x32_bf16 v[72:75], a[192:195], v[28:31], v[72:75]
  s_add_u32 s27, s27, s22
  ds_read_b128 v[52:55], v15 offset:24576
  v_mfma_f32_16x16x32_bf16 v[76:79], a[196:199], v[28:31], v[76:79]
  v_mfma_f32_16x16x32_bf16 v[88:91], a[200:203], v[28:31], v[88:91]
  s_waitcnt vmcnt(16)
  s_barrier
  v_mfma_f32_16x16x32_bf16 v[92:95], a[204:207], v[28:31], v[92:95]
  s_waitcnt lgkmcnt(5)
  v_mfma_f32_16x16x32_bf16 v[64:67], a[208:211], v[32:35], v[64:67]
  ds_read_b128 v[24:27], v8 offset:32768
  v_mfma_f32_16x16x32_bf16 v[68:71], a[212:215], v[32:35], v[68:71]
  v_mfma_f32_16x16x32_bf16 v[80:83], a[216:219], v[32:35], v[80:83]
  v_mfma_f32_16x16x32_bf16 v[84:87], a[220:223], v[32:35], v[84:87]
  s_waitcnt lgkmcnt(5)
  v_mfma_f32_16x16x32_bf16 v[72:75], a[208:211], v[36:39], v[72:75]
  ds_read_b128 v[28:31], v9 offset:32768
  v_mfma_f32_16x16x32_bf16 v[76:79], a[212:215], v[36:39], v[76:79]
  v_mfma_f32_16x16x32_bf16 v[88:91], a[216:219], v[36:39], v[88:91]
  v_mfma_f32_16x16x32_bf16 v[92:95], a[220:223], v[36:39], v[92:95]
  s_waitcnt lgkmcnt(5)
  v_mfma_f32_16x16x32_bf16 v[64:67], a[224:227], v[40:43], v[64:67]
  ds_read_b128 v[32:35], v10 offset:32768
  v_mfma_f32_16x16x32_bf16 v[68:71], a[228:231], v[40:43], v[68:71]
  v_mfma_f32_16x16x32_bf16 v[80:83], a[232:235], v[40:43], v[80:83]
  v_mfma_f32_16x16x32_bf16 v[84:87], a[236:239], v[40:43], v[84:87]
  s_waitcnt lgkmcnt(5)
  v_mfma_f32_16x16x32_bf16 v[72:75], a[224:227], v[44:47], v[72:75]
  ds_read_b128 v[36:39], v11 offset:32768
  v_mfma_f32_16x16x32_bf16 v[76:79], a[228:231], v[44:47], v[76:79]
  v_mfma_f32_16x16x32_bf16 v[88:91], a[232:235], v[44:47], v[88:91]
  v_mfma_f32_16x16x32_bf16 v[92:95], a[236:239], v[44:47], v[92:95]
  s_waitcnt lgkmcnt(5)
  v_mfma_f32_16x16x32_bf16 v[64:67], a[240:243], v[48:51], v[64:67]
  s_sub_u32 s23, s23, 1
  ds_read_b128 v[40:43], v12 offset:32768
  v_mfma_f32_16x16x32_bf16 v[68:71], a[244:247], v[48:51], v[68:71]
  v_mfma_f32_16x16x32_bf16 v[80:83], a[248:251], v[48:51], v[80:83]
  v_mfma_f32_16x16x32_bf16 v[84:87], a[252:255], v[48:51], v[84:87]
  s_waitcnt lgkmcnt(5)
  v_mfma_f32_16x16x32_bf16 v[72:75], a[240:243], v[52:55], v[72:75]
  s_cmp_eq_u32 s23, 0
  ds_read_b128 v[44:47], v13 offset:32768
  v_mfma_f32_16x16x32_bf16 v[76:79], a[244:247], v[52:55], v[76:79]
  v_mfma_f32_16x16x32_bf16 v[88:91], a[248:251], v[52:55], v[88:91]
  v_mfma_f32_16x16x32_bf16 v[92:95], a[252:255], v[52:55], v[92:95]
  s_cbranch_scc1 G_done0_180
  s_waitcnt lgkmcnt(5)
  v_mfma_f32_16x16x32_bf16 v[96:99], a[0:3], v[24:27], 0
  s_add_u32 m0, s25, 0
  ds_read_b128 v[48:51], v14 offset:32768
  v_mfma_f32_16x16x32_bf16 v[100:103], a[4:7], v[24:27], 0
  v_mfma_f32_16x16x32_bf16 v[112:115], a[8:11], v[24:27], 0
  buffer_load_dwordx4 v16, s[12:15], s19 offen sc1 lds
  v_mfma_f32_16x16x32_bf16 v[116:119], a[12:15], v[24:27], 0
  s_waitcnt lgkmcnt(5)
  v_mfma_f32_16x16x32_bf16 v[104:107], a[0:3], v[28:31], 0
  ds_read_b128 v[52:55], v15 offset:32768
  v_mfma_f32_16x16x32_bf16 v[108:111], a[4:7], v[28:31], 0
  v_cvt_pk_bf16_f32 v128, v64, v65
  v_cvt_pk_bf16_f32 v129, v66, v67
  v_mfma_f32_16x16x32_bf16 v[120:123], a[8:11], v[28:31], 0
  v_mfma_f32_16x16x32_bf16 v[124:127], a[12:15], v[28:31], 0
  s_waitcnt lgkmcnt(5)
  v_cvt_pk_bf16_f32 v130, v68, v69
  v_cvt_pk_bf16_f32 v131, v70, v71
  v_mfma_f32_16x16x32_bf16 v[96:99], a[16:19], v[32:35], v[96:99]
  s_add_u32 m0, s25, 1024
  ds_read_b128 v[24:27], v8 offset:40960
  v_mfma_f32_16x16x32_bf16 v[100:103], a[20:23], v[32:35], v[100:103]
  v_mfma_f32_16x16x32_bf16 v[112:115], a[24:27], v[32:35], v[112:115]
  buffer_load_dwordx4 v17, s[12:15], s19 offen sc1 lds
  v_mfma_f32_16x16x32_bf16 v[116:119], a[28:31], v[32:35], v[116:119]
  s_waitcnt lgkmcnt(5)
  v_mfma_f32_16x16x32_bf16 v[104:107], a[16:19], v[36:39], v[104:107]
  ds_read_b128 v[28:31], v9 offset:40960
  v_mfma_f32_16x16x32_bf16 v[108:111], a[20:23], v[36:39], v[108:111]
  v_mfma_f32_16x16x32_bf16 v[120:123], a[24:27], v[36:39], v[120:123]
  v_mfma_f32_16x16x32_bf16 v[124:127], a[28:31], v[36:39], v[124:127]
  s_waitcnt lgkmcnt(5)
  v_mfma_f32_16x16x32_bf16 v[96:99], a[32:35], v[40:43], v[96:99]
  s_add_u32 m0, s25, 2048
  ds_read_b128 v[32:35], v10 offset:40960
  v_mfma_f32_16x16x32_bf16 v[100:103], a[36:39], v[40:43], v[100:103]
  v_cvt_pk_bf16_f32 v132, v72, v73
  v_cvt_pk_bf16_f32 v133, v74, v75
  v_mfma_f32_16x16x32_bf16 v[112:115], a[40:43], v[40:43], v[112:115]
  buffer_load_dwordx4 v18, s[12:15], s19 offen sc1 lds
  v_mfma_f32_16x16x32_bf16 v[116:119], a[44:47], v[40:43], v[116:119]
  s_waitcnt lgkmcnt(5)
  v_cvt_pk_bf16_f32 v134, v76, v77
  v_cvt_pk_bf16_f32 v135, v78, v79
  v_mfma_f32_16x16x32_bf16 v[104:107], a[32:35], v[44:47], v[104:107]
  ds_read_b128 v[36:39], v11 offset:40960
  v_mfma_f32_16x16x32_bf16 v[108:111], a[36:39], v[44:47], v[108:111]
  v_mfma_f32_16x16x32_bf16 v[120:123], a[40:43], v[44:47], v[120:123]
  v_mfma_f32_16x16x32_bf16 v[124:127], a[44:47], v[44:47], v[124:127]
  s_waitcnt lgkmcnt(5)
  v_mfma_f32_16x16x32_bf16 v[96:99], a[48:51], v[48:51], v[96:99]
  s_add_u32 m0, s25, 3072
  ds_read_b128 v[40:43], v12 offset:40960
  v_mfma_f32_16x16x32_bf16 v[100:103], a[52:55], v[48:51], v[100:103]
  v_mfma_f32_16x16x32_bf16 v[112:115], a[56:59], v[48:51], v[112:115]
  buffer_load_dwordx4 v19, s[12:15], s19 offen sc1 lds
  v_mfma_f32_16x16x32_bf16 v[116:119], a[60:63], v[48:51], v[116:119]
  s_waitcnt lgkmcnt(5)
  v_mfma_f32_16x16x32_bf16 v[104:107], a[48:51], v[52:55], v[104:107]
  ds_read_b128 v[44:47], v13 offset:40960
  v_mfma_f32_16x16x32_bf16 v[108:111], a[52:55], v[52:55], v[108:111]
  v_cvt_pk_bf16_f32 v136, v80, v81
  v_cvt_pk_bf16_f32 v137, v82, v83
  v_mfma_f32_16x16x32_bf16 v[120:123], a[56:59], v[52:55], v[120:123]
  v_mfma_f32_16x16x32_bf16 v[124:127], a[60:63], v[52:55], v[124:127]
  s_waitcnt lgkmcnt(5)
  v_cvt_pk_bf16_f32 v138, v84, v85
  v_cvt_pk_bf16_f32 v139, v86, v87
  v_mfma_f32_16x16x32_bf16 v[96:99], a[64:67], v[24:27], v[96:99]
  s_add_u32 m0, s25, 4096
  ds_read_b128 v[48:51], v14 offset:40960
  v_mfma_f32_16x16x32_bf16 v[100:103], a[68:71], v[24:27], v[100:103]
  v_mfma_f32_16x16x32_bf16 v[112:115], a[72:75], v[24:27], v[112:115]
  buffer_load_dwordx4 v20, s[12:15], s19 offen sc1 lds
  v_mfma_f32_16x16x32_bf16 v[116:119], a[76:79], v[24:27], v[116:119]
  s_waitcnt lgkmcnt(5)
  v_mfma_f32_16x16x32_bf16 v[104:107], a[64:67], v[28:31], v[104:107]
  ds_read_b128 v[52:55], v15 offset:40960
  v_mfma_f32_16x16x32_bf16 v[108:111], a[68:71], v[28:31], v[108:111]
  v_mfma_f32_16x16x32_bf16 v[120:123], a[72:75], v[28:31], v[120:123]
  v_mfma_f32_16x16x32_bf16 v[124:127], a[76:79], v[28:31], v[124:127]
  s_waitcnt lgkmcnt(5)
  v_mfma_f32_16x16x32_bf16 v[96:99], a[80:83], v[32:35], v[96:99]
  s_add_u32 m0, s25, 5120
  ds_read_b128 v[24:27], v8 offset:49152
  v_mfma_f32_16x16x32_bf16 v[100:103], a[84:87], v[32:35], v[100:103]
  v_cvt_pk_bf16_f32 v140, v88, v89
  v_cvt_pk_bf16_f32 v141, v90, v91
  v_mfma_f32_16x16x32_bf16 v[112:115], a[88:91], v[32:35], v[112:115]
  buffer_load_dwordx4 v21, s[12:15], s19 offen sc1 lds
  v_mfma_f32_16x16x32_bf16 v[116:119], a[92:95], v[32:35], v[116:119]
  s_waitcnt lgkmcnt(5)
  v_cvt_pk_bf16_f32 v142, v92, v93
  v_cvt_pk_bf16_f32 v143, v94, v95
  v_mfma_f32_16x16x32_bf16 v[104:107], a[80:83], v[36:39], v[104:107]
  ds_read_b128 v[28:31], v9 offset:49152
  v_mfma_f32_16x16x32_bf16 v[108:111], a[84:87], v[36:39], v[108:111]
  v_mfma_f32_16x16x32_bf16 v[120:123], a[88:91], v[36:39], v[120:123]
  v_mfma_f32_16x16x32_bf16 v[124:127], a[92:95], v[36:39], v[124:127]
  s_waitcnt lgkmcnt(5)
  v_mfma_f32_16x16x32_bf16 v[96:99], a[96:99], v[40:43], v[96:99]
  s_add_u32 m0, s25, 6144
  ds_read_b128 v[32:35], v10 offset:49152
  v_mfma_f32_16x16x32_bf16 v[100:103], a[100:103], v[40:43], v[100:103]
  v_mfma_f32_16x16x32_bf16 v[112:115], a[104:107], v[40:43], v[112:115]
  buffer_load_dwordx4 v22, s[12:15], s19 offen sc1 lds
  v_mfma_f32_16x16x32_bf16 v[116:119], a[108:111], v[40:43], v[116:119]
  s_waitcnt lgkmcnt(5)
  v_mfma_f32_16x16x32_bf16 v[104:107], a[96:99], v[44:47], v[104:107]
  ds_read_b128 v[36:39], v11 offset:49152
  v_mfma_f32_16x16x32_bf16 v[108:111], a[100:103], v[44:47], v[108:111]
  v_mfma_f32_16x16x32_bf16 v[120:123], a[104:107], v[44:47], v[120:123]
  v_mfma_f32_16x16x32_bf16 v[124:127], a[108:111], v[44:47], v[124:127]
  s_waitcnt lgkmcnt(5)
  v_mfma_f32_16x16x32_bf16 v[96:99], a[112:115], v[48:51], v[96:99]
  s_add_u32 m0, s25, 7168
  ds_read_b128 v[40:43], v12 offset:49152
  v_mfma_f32_16x16x32_bf16 v[100:103], a[116:119], v[48:51], v[100:103]
  v_mfma_f32_16x16x32_bf16 v[112:115], a[120:123], v[48:51], v[112:115]
  buffer_load_dwordx4 v23, s[12:15], s19 offen sc1 lds
  v_mfma_f32_16x16x32_bf16 v[116:119], a[124:127], v[48:51], v[116:119]
  s_waitcnt lgkmcnt(5)
  v_mfma_f32_16x16x32_bf16 v[104:107], a[112:115], v[52:55], v[104:107]
  s_cmp_gt_u32 s23, 3
  ds_read_b128 v[44:47], v13 offset:49152
  v_mfma_f32_16x16x32_bf16 v[108:111], a[116:119], v[52:55], v[108:111]
  v_mfma_f32_16x16x32_bf16 v[120:123], a[120:123], v[52:55], v[120:123]
  s_cselect_b32 s26, s20, 0
  v_mfma_f32_16x16x32_bf16 v[124:127], a[124:127], v[52:55], v[124:127]
  s_waitcnt lgkmcnt(5)
  v_mfma_f32_16x16x32_bf16 v[96:99], a[128:131], v[24:27], v[96:99]
  s_add_u32 s19, s19, s26
  ds_read_b128 v[48:51], v14 offset:49152
  v_mfma_f32_16x16x32_bf16 v[100:103], a[132:135], v[24:27], v[100:103]
  v_mfma_f32_16x16x32_bf16 v[112:115], a[136:139], v[24:27], v[112:115]
  s_add_u32 s25, s25, 32768
  v_mfma_f32_16x16x32_bf16 v[116:119], a[140:143], v[24:27], v[116:119]
  s_waitcnt lgkmcnt(5)
  v_mfma_f32_16x16x32_bf16 v[104:107], a[128:131], v[28:31], v[104:107]
  s_and_b32 s25, s25, 0x1ffff
  ds_read_b128 v[52:55], v15 offset:49152
  v_mfma_f32_16x16x32_bf16 v[108:111], a[132:135], v[28:31], v[108:111]
  v_mfma_f32_16x16x32_bf16 v[120:123], a[136:139], v[28:31], v[120:123]
  buffer_store_dwordx4 v[128:131], v7, s[4:7], s21 offen offset:0 sc1
  v_mfma_f32_16x16x32_bf16 v[124:127], a[140:143], v[28:31], v[124:127]
  s_waitcnt lgkmcnt(5)
  v_mfma_f32_16x16x32_bf16 v[96:99], a[144:147], v[32:35], v[96:99]
  ds_read_b128 v[24:27], v8 offset:57344
  v_mfma_f32_16x16x32_bf16 v[100:103], a[148:151], v[32:35], v[100:103]
  v_mfma_f32_16x16x32_bf16 v[112:115], a[152:155], v[32:35], v[112:115]
  v_mfma_f32_16x16x32_bf16 v[116:119], a[156:159], v[32:35], v[116:119]
  s_waitcnt lgkmcnt(5)
  v_xor_b32 v8, 0x10000, v8
  v_mfma_f32_16x16x32_bf16 v[104:107], a[144:147], v[36:39], v[104:107]
  ds_read_b128 v[28:31], v9 offset:57344
  v_mfma_f32_16x16x32_bf16 v[108:111], a[148:151], v[36:39], v[108:111]
  v_mfma_f32_16x16x32_bf16 v[120:123], a[152:155], v[36:39], v[120:123]
  buffer_store_dwordx4 v[132:135], v7, s[4:7], s21 offen offset:256 sc1
  v_mfma_f32_16x16x32_bf16 v[124:127], a[156:159], v[36:39], v[124:127]
  s_waitcnt lgkmcnt(5)
  v_xor_b32 v9, 0x10000, v9
  v_mfma_f32_16x16x32_bf16 v[96:99], a[160:163], v[40:43], v[96:99]
  ds_read_b128 v[32:35], v10 offset:57344
  v_mfma_f32_16x16x32_bf16 v[100:103], a[164:167], v[40:43], v[100:103]
  v_mfma_f32_16x16x32_bf16 v[112:115], a[168:171], v[40:43], v[112:115]
  v_mfma_f32_16x16x32_bf16 v[116:119], a[172:175], v[40:43], v[116:119]
  s_waitcnt lgkmcnt(5)
  v_xor_b32 v10, 0x10000, v10
  v_mfma_f32_16x16x32_bf16 v[104:107], a[160:163], v[44:47], v[104:107]
  ds_read_b128 v[36:39], v11 offset:57344
  v_mfma_f32_16x16x32_bf16 v[108:111], a[164:167], v[44:47], v[108:111]
  v_mfma_f32_16x16x32_bf16 v[120:123], a[168:171], v[44:47], v[120:123]
  buffer_store_dwordx4 v[136:139], v7, s[4:7], s21 offen offset:2048 sc1
  v_mfma_f32_16x16x32_bf16 v[124:127], a[172:175], v[44:47], v[124:127]
  s_waitcnt lgkmcnt(5)
  v_xor_b32 v11, 0x10000, v11
  v_mfma_f32_16x16x32_bf16 v[96:99], a[176:179], v[48:51], v[96:99]
  ds_read_b128 v[40:43], v12 offset:57344
  v_mfma_f32_16x16x32_bf16 v[100:103], a[180:183], v[48:51], v[100:103]
  v_mfma_f32_16x16x32_bf16 v[112:115], a[184:187], v[48:51], v[112:115]
  v_mfma_f32_16x16x32_bf16 v[116:119], a[188:191], v[48:51], v[116:119]
  s_waitcnt lgkmcnt(5)
  v_xor_b32 v12, 0x10000, v12
  v_mfma_f32_16x16x32_bf16 v[104:107], a[176:179], v[52:55], v[104:107]
  ds_read_b128 v[44:47], v13 offset:57344
  v_mfma_f32_16x16x32_bf16 v[108:111], a[180:183], v[52:55], v[108:111]
  v_mfma_f32_16x16x32_bf16 v[120:123], a[184:187], v[52:55], v[120:123]
  buffer_store_dwordx4 v[140:143], v7, s[4:7], s21 offen offset:2304 sc1
  v_mfma_f32_16x16x32_bf16 v[124:127], a[188:191], v[52:55], v[124:127]
  s_waitcnt lgkmcnt(5)
  v_xor_b32 v13, 0x10000, v13
  v_mfma_f32_16x16x32_bf16 v[96:99], a[192:195], v[24:27], v[96:99]
  s_mov_b32 s21, s27
  ds_read_b128 v[48:51], v14 offset:57344
  v_mfma_f32_16x16x32_bf16 v[100:103], a[196:199], v[24:27], v[100:103]
  v_mov_b32 v7, v56
  v_mfma_f32_16x16x32_bf16 v[112:115], a[200:203], v[24:27], v[112:115]
  v_mfma_f32_16x16x32_bf16 v[116:119], a[204:207], v[24:27], v[116:119]
  s_waitcnt lgkmcnt(5)
  v_xor_b32 v14, 0x10000, v14
  v_mfma_f32_16x16x32_bf16 v[104:107], a[192:195], v[28:31], v[104:107]
  s_add_u32 s27, s27, s22
  ds_read_b128 v[52:55], v15 offset:57344
  v_mfma_f32_16x16x32_bf16 v[108:111], a[196:199], v[28:31], v[108:111]
  v_mfma_f32_16x16x32_bf16 v[120:123], a[200:203], v[28:31], v[120:123]
  s_waitcnt vmcnt(16)
  s_barrier
  v_mfma_f32_16x16x32_bf16 v[124:127], a[204:207], v[28:31], v[124:127]
  s_waitcnt lgkmcnt(5)
  v_xor_b32 v15, 0x10000, v15
  v_mfma_f32_16x16x32_bf16 v[96:99], a[208:211], v[32:35], v[96:99]
  ds_read_b128 v[24:27], v8 offset:0
  v_mfma_f32_16x16x32_bf16 v[100:103], a[212:215], v[32:35], v[100:103]
  v_mfma_f32_16x16x32_bf16 v[112:115], a[216:219], v[32:35], v[112:115]
  v_mfma_f32_16x16x32_bf16 v[116:119], a[220:223], v[32:35], v[116:119]
  s_waitcnt lgkmcnt(5)
  v_mfma_f32_16x16x32_bf16 v[104:107], a[208:211], v[36:39], v[104:107]
  ds_read_b128 v[28:31], v9 offset:0
  v_mfma_f32_16x16x32_bf16 v[108:111], a[212:215], v[36:39], v[108:111]
  v_mfma_f32_16x16x32_bf16 v[120:123], a[216:219], v[36:39], v[120:123]
  v_mfma_f32_16x16x32_bf16 v[124:127], a[220:223], v[36:39], v[124:127]
  s_waitcnt lgkmcnt(5)
  v_mfma_f32_16x16x32_bf16 v[96:99], a[224:227], v[40:43], v[96:99]
  ds_read_b128 v[32:35], v10 offset:0
  v_mfma_f32_16x16x32_bf16 v[100:103], a[228:231], v[40:43], v[100:103]
  v_mfma_f32_16x16x32_bf16 v[112:115], a[232:235], v[40:43], v[112:115]
  v_mfma_f32_16x16x32_bf16 v[116:119], a[236:239], v[40:43], v[116:119]
  s_waitcnt lgkmcnt(5)
  v_mfma_f32_16x16x32_bf16 v[104:107], a[224:227], v[44:47], v[104:107]
  ds_read_b128 v[36:39], v11 offset:0
  v_mfma_f32_16x16x32_bf16 v[108:111], a[228:231], v[44:47], v[108:111]
  v_mfma_f32_16x16x32_bf16 v[120:123], a[232:235], v[44:47], v[120:123]
  v_mfma_f32_16x16x32_bf16 v[124:127], a[236:239], v[44:47], v[124:127]
  s_waitcnt lgkmcnt(5)
  v_mfma_f32_16x16x32_bf16 v[96:99], a[240:243], v[48:51], v[96:99]
  s_sub_u32 s23, s23, 1
  ds_read_b128 v[40:43], v12 offset:0
  v_mfma_f32_16x16x32_bf16 v[100:103], a[244:247], v[48:51], v[100:103]
  v_mfma_f32_16x16x32_bf16 v[112:115], a[248:251], v[48:51], v[112:115]
  v_mfma_f32_16x16x32_bf16 v[116:119], a[252:255], v[48:51], v[116:119]
  s_waitcnt lgkmcnt(5)
  v_mfma_f32_16x16x32_bf16 v[104:107], a[240:243], v[52:55], v[104:107]
  s_cmp_eq_u32 s23, 0
  ds_read_b128 v[44:47], v13 offset:0
  v_mfma_f32_16x16x32_bf16 v[108:111], a[244:247], v[52:55], v[108:111]
  v_mfma_f32_16x16x32_bf16 v[120:123], a[248:251], v[52:55], v[120:123]
  v_mfma_f32_16x16x32_bf16 v[124:127], a[252:255], v[52:55], v[124:127]
  s_cbranch_scc1 G_done1_181
  s_branch G_top_179
G_done0_180:
  s_nop 7
  s_nop 3
  v_cvt_pk_bf16_f32 v128, v64, v65
  v_cvt_pk_bf16_f32 v129, v66, v67
  v_cvt_pk_bf16_f32 v130, v68, v69
  v_cvt_pk_bf16_f32 v131, v70, v71
  buffer_store_dwordx4 v[128:131], v7, s[4:7], s21 offen offset:0 sc1
  v_cvt_pk_bf16_f32 v132, v72, v73
  v_cvt_pk_bf16_f32 v133, v74, v75
  v_cvt_pk_bf16_f32 v134, v76, v77
  v_cvt_pk_bf16_f32 v135, v78, v79
  buffer_store_dwordx4 v[132:135], v7, s[4:7], s21 offen offset:256 sc1
  v_cvt_pk_bf16_f32 v136, v80, v81
  v_cvt_pk_bf16_f32 v137, v82, v83
  v_cvt_pk_bf16_f32 v138, v84, v85
  v_cvt_pk_bf16_f32 v139, v86, v87
  buffer_store_dwordx4 v[136:139], v7, s[4:7], s21 offen offset:2048 sc1
  v_cvt_pk_bf16_f32 v140, v88, v89
  v_cvt_pk_bf16_f32 v141, v90, v91
  v_cvt_pk_bf16_f32 v142, v92, v93
  v_cvt_pk_bf16_f32 v143, v94, v95
  buffer_store_dwordx4 v[140:143], v7, s[4:7], s21 offen offset:2304 sc1
  s_branch G_fin_182
G_done1_181:
  s_nop 7
  s_nop 3
  v_cvt_pk_bf16_f32 v128, v96, v97
  v_cvt_pk_bf16_f32 v129, v98, v99
  v_cvt_pk_bf16_f32 v130, v100, v101
  v_cvt_pk_bf16_f32 v131, v102, v103
  buffer_store_dwordx4 v[128:131], v7, s[4:7], s21 offen offset:0 sc1
  v_cvt_pk_bf16_f32 v132, v104, v105
  v_cvt_pk_bf16_f32 v133, v106, v107
  v_cvt_pk_bf16_f32 v134, v108, v109
  v_cvt_pk_bf16_f32 v135, v110, v111
  buffer_store_dwordx4 v[132:135], v7, s[4:7], s21 offen offset:256 sc1
  v_cvt_pk_bf16_f32 v136, v112, v113
  v_cvt_pk_bf16_f32 v137, v114, v115
  v_cvt_pk_bf16_f32 v138, v116, v117
  v_cvt_pk_bf16_f32 v139, v118, v119
  buffer_store_dwordx4 v[136:139], v7, s[4:7], s21 offen offset:2048 sc1
  v_cvt_pk_bf16_f32 v140, v120, v121
  v_cvt_pk_bf16_f32 v141, v122, v123
  v_cvt_pk_bf16_f32 v142, v124, v125
  v_cvt_pk_bf16_f32 v143, v126, v127
  buffer_store_dwordx4 v[140:143], v7, s[4:7], s21 offen offset:2304 sc1
G_fin_182:
  s_waitcnt vmcnt(0) lgkmcnt(0)
  s_barrier
  s_waitcnt vmcnt(0)
  s_barrier
  s_mov_b32 s30, 768
  v_mov_b32 v144, s30
  v_min_u32 v145, 1, v0
  v_lshlrev_b32 v145, 30, v145
  buffer_store_dword v144, v145, s[4:7], s31 offen sc1
  s_mul_i32 s50, s64, 6
  s_add_u32 s50, s50, s65
  s_mul_i32 s76, s50, 21846
  s_lshr_b32 s76, s76, 16
  s_mul_i32 s77, s76, 3
  s_add_u32 s51, s50, 64
  s_cmp_eq_u32 s77, s50
  s_cselect_b32 s50, s76, s51
M_fin:
  s_lshr_b32 s48, s50, 2
  s_and_b32 s49, s50, 3
  s_load_dwordx2 s[8:9], s[0:1], 0
  s_load_dwordx2 s[12:13], s[0:1], 104
  s_load_dwordx2 s[32:33], s[0:1], 112
  v_and_b32 v4, 31, v1
  v_lshrrev_b32 v5, 5, v1
  v_lshlrev_b32 v5, 4, v5
  v_lshl_add_u32 v6, v4, 10, v5
  s_lshl_b32 s26, s16, 8
  s_lshl_b32 s27, s48, 15
  s_add_u32 s27, s27, s26
  s_waitcnt lgkmcnt(0)
  s_and_b32 s9, s9, 0xffff
  s_mov_b32 s10, 2097152
  s_mov_b32 s11, 0x20000
  s_and_b32 s13, s13, 0xffff
  s_mov_b32 s14, 1024
  s_mov_b32 s15, 0x20000
  s_and_b32 s33, s33, 0xffff
  s_mov_b32 s34, 2097152
  s_mov_b32 s35, 0x20000
  buffer_load_dwordx4 v[16:19], v6, s[8:11], s27 offen offset:0
  buffer_load_dwordx4 v[48:51], v5, s[12:15], s26 offen offset:0
  buffer_load_dwordx4 v[20:23], v6, s[8:11], s27 offen offset:32
  buffer_load_dwordx4 v[52:55], v5, s[12:15], s26 offen offset:32
  buffer_load_dwordx4 v[24:27], v6, s[8:11], s27 offen offset:64
  buffer_load_dwordx4 v[56:59], v5, s[12:15], s26 offen offset:64
  buffer_load_dwordx4 v[28:31], v6, s[8:11], s27 offen offset:96
  buffer_load_dwordx4 v[60:63], v5, s[12:15], s26 offen offset:96
  buffer_load_dwordx4 v[32:35], v6, s[8:11], s27 offen offset:128
  buffer_load_dwordx4 v[64:67], v5, s[12:15], s26 offen offset:128
  buffer_load_dwordx4 v[36:39], v6, s[8:11], s27 offen offset:160
  buffer_load_dwordx4 v[68:71], v5, s[12:15], s26 offen offset:160
  buffer_load_dwordx4 v[40:43], v6, s[8:11], s27 offen offset:192
  buffer_load_dwordx4 v[72:75], v5, s[12:15], s26 offen offset:192
  buffer_load_dwordx4 v[44:47], v6, s[8:11], s27 offen offset:224
  buffer_load_dwordx4 v[76:79], v5, s[12:15], s26 offen offset:224
  s_lshl_b32 s28, s48, 2
  s_add_u32 s28, s28, s49
  s_lshl_b32 s28, s28, 2
  s_add_u32 s28, s28, s16
  s_lshl_b32 s28, s28, 11
  s_waitcnt vmcnt(14)
  v_mfma_f32_32x32x16_bf16 v[80:95], v[48:51], v[16:19], 0
  s_waitcnt vmcnt(12)
  v_mfma_f32_32x32x16_bf16 v[80:95], v[52:55], v[20:23], v[80:95]
  s_waitcnt vmcnt(10)
  v_mfma_f32_32x32x16_bf16 v[80:95], v[56:59], v[24:27], v[80:95]
  s_waitcnt vmcnt(8)
  v_mfma_f32_32x32x16_bf16 v[80:95], v[60:63], v[28:31], v[80:95]
  s_waitcnt vmcnt(6)
  v_mfma_f32_32x32x16_bf16 v[80:95], v[64:67], v[32:35], v[80:95]
  s_waitcnt vmcnt(4)
  v_mfma_f32_32x32x16_bf16 v[80:95], v[68:71], v[36:39], v[80:95]
  s_waitcnt vmcnt(2)
  v_mfma_f32_32x32x16_bf16 v[80:95], v[72:75], v[40:43], v[80:95]
  s_waitcnt vmcnt(0)
  v_mfma_f32_32x32x16_bf16 v[80:95], v[76:79], v[44:47], v[80:95]
  s_mul_i32 s76, s48, 43
  s_lshr_b32 s76, s76, 9
  s_mul_i32 s76, s76, 12
  s_sub_u32 s76, s48, s76
  s_cmp_ge_u32 s76, 6
  s_addc_u32 s76, s76, 0
  s_and_b32 s77, s49, 2
  s_mul_i32 s77, s77, 7
  s_add_u32 s76, s76, s77
  v_mov_b32 v193, 0x300
  s_lshl_b32 s76, s76, 7
  s_add_u32 s76, s76, 148897792
  v_and_b32 v192, 7, v1
  v_mul_u32_u24 v192, 3584, v192
  v_add_u32 v192, s76, v192
  s_mov_b32 s71, 0
  s_branch M_vg_184
M_vw_183:
  s_sleep 2
  s_add_u32 s71, s71, 1
  s_cmp_gt_u32 s71, 262144
  s_cbranch_scc1 M_exit
M_vg_184:
  buffer_load_dword v194, v192, s[4:7], 0 offen sc1
  s_waitcnt vmcnt(0)
  v_cmp_lt_u32 vcc, v194, v193
  s_cbranch_vccnz M_vw_183
  s_add_u32 s29, s28, 150994944
  buffer_load_dwordx4 v[96:99], v2, s[4:7], s29 offen offset:0 sc1
  buffer_load_dwordx4 v[100:103], v2, s[4:7], s29 offen offset:1024 sc1
  s_add_u32 s29, s28, 153092096
  buffer_load_dwordx4 v[104:107], v2, s[4:7], s29 offen offset:0 sc1
  buffer_load_dwordx4 v[108:111], v2, s[4:7], s29 offen offset:1024 sc1
  s_add_u32 s29, s28, 155189248
  buffer_load_dwordx4 v[112:115], v2, s[4:7], s29 offen offset:0 sc1
  buffer_load_dwordx4 v[116:119], v2, s[4:7], s29 offen offset:1024 sc1
  s_add_u32 s29, s28, 157286400
  buffer_load_dwordx4 v[120:123], v2, s[4:7], s29 offen offset:0 sc1
  buffer_load_dwordx4 v[124:127], v2, s[4:7], s29 offen offset:1024 sc1
  s_add_u32 s29, s28, 159383552
  buffer_load_dwordx4 v[128:131], v2, s[4:7], s29 offen offset:0 sc1
  buffer_load_dwordx4 v[132:135], v2, s[4:7], s29 offen offset:1024 sc1
  s_add_u32 s29, s28, 161480704
  buffer_load_dwordx4 v[136:139], v2, s[4:7], s29 offen offset:0 sc1
  buffer_load_dwordx4 v[140:143], v2, s[4:7], s29 offen offset:1024 sc1
  s_add_u32 s29, s28, 163577856
  buffer_load_dwordx4 v[144:147], v2, s[4:7], s29 offen offset:0 sc1
  buffer_load_dwordx4 v[148:151], v2, s[4:7], s29 offen offset:1024 sc1
  s_add_u32 s29, s28, 165675008
  buffer_load_dwordx4 v[152:155], v2, s[4:7], s29 offen offset:0 sc1
  buffer_load_dwordx4 v[156:159], v2, s[4:7], s29 offen offset:1024 sc1
  v_lshlrev_b32 v7, 4, v4
  s_lshl_b32 s26, s16, 2
  v_add_u32 v4, s26, v7
  s_barrier
  ds_write_b32 v4, v80
  s_waitcnt lgkmcnt(0)
  s_barrier
  ds_read_b128 v[84:87], v7
  s_waitcnt lgkmcnt(0)
  v_add_f32 v80, v84, v85
  v_add_f32 v81, v86, v87
  v_add_f32 v80, v80, v81
  v_mul_f32 v80, 0xbfb8aa3b, v80
  v_exp_f32 v80, v80
  s_nop 0
  v_add_f32 v80, 1.0, v80
  v_rcp_f32 v80, v80
  s_nop 0
  v_sub_f32 v82, 1.0, v80
  s_waitcnt vmcnt(14)
  v_lshlrev_b32 v160, 16, v96
  v_and_b32 v161, 0xffff0000, v96
  v_lshlrev_b32 v162, 16, v97
  v_and_b32 v163, 0xffff0000, v97
  v_lshlrev_b32 v164, 16, v98
  v_and_b32 v165, 0xffff0000, v98
  v_lshlrev_b32 v166, 16, v99
  v_and_b32 v167, 0xffff0000, v99
  v_lshlrev_b32 v168, 16, v100
  v_and_b32 v169, 0xffff0000, v100
  v_lshlrev_b32 v170, 16, v101
  v_and_b32 v171, 0xffff0000, v101
  v_lshlrev_b32 v172, 16, v102
  v_and_b32 v173, 0xffff0000, v102
  v_lshlrev_b32 v174, 16, v103
  v_and_b32 v175, 0xffff0000, v103
  s_waitcnt vmcnt(12)
  v_lshlrev_b32 v8, 16, v104
  v_and_b32 v9, 0xffff0000, v104
  v_pk_add_f32 v[160:161], v[160:161], v[8:9]
  v_lshlrev_b32 v10, 16, v105
  v_and_b32 v11, 0xffff0000, v105
  v_pk_add_f32 v[162:163], v[162:163], v[10:11]
  v_lshlrev_b32 v12, 16, v106
  v_and_b32 v13, 0xffff0000, v106
  v_pk_add_f32 v[164:165], v[164:165], v[12:13]
  v_lshlrev_b32 v14, 16, v107
  v_and_b32 v15, 0xffff0000, v107
  v_pk_add_f32 v[166:167], v[166:167], v[14:15]
  v_lshlrev_b32 v8, 16, v108
  v_and_b32 v9, 0xffff0000, v108
  v_pk_add_f32 v[168:169], v[168:169], v[8:9]
  v_lshlrev_b32 v10, 16, v109
  v_and_b32 v11, 0xffff0000, v109
  v_pk_add_f32 v[170:171], v[170:171], v[10:11]
  v_lshlrev_b32 v12, 16, v110
  v_and_b32 v13, 0xffff0000, v110
  v_pk_add_f32 v[172:173], v[172:173], v[12:13]
  v_lshlrev_b32 v14, 16, v111
  v_and_b32 v15, 0xffff0000, v111
  v_pk_add_f32 v[174:175], v[174:175], v[14:15]
  s_waitcnt vmcnt(10)
  v_lshlrev_b32 v8, 16, v112
  v_and_b32 v9, 0xffff0000, v112
  v_pk_add_f32 v[160:161], v[160:161], v[8:9]
  v_lshlrev_b32 v10, 16, v113
  v_and_b32 v11, 0xffff0000, v113
  v_pk_add_f32 v[162:163], v[162:163], v[10:11]
  v_lshlrev_b32 v12, 16, v114
  v_and_b32 v13, 0xffff0000, v114
  v_pk_add_f32 v[164:165], v[164:165], v[12:13]
  v_lshlrev_b32 v14, 16, v115
  v_and_b32 v15, 0xffff0000, v115
  v_pk_add_f32 v[166:167], v[166:167], v[14:15]
  v_lshlrev_b32 v8, 16, v116
  v_and_b32 v9, 0xffff0000, v116
  v_pk_add_f32 v[168:169], v[168:169], v[8:9]
  v_lshlrev_b32 v10, 16, v117
  v_and_b32 v11, 0xffff0000, v117
  v_pk_add_f32 v[170:171], v[170:171], v[10:11]
  v_lshlrev_b32 v12, 16, v118
  v_and_b32 v13, 0xffff0000, v118
  v_pk_add_f32 v[172:173], v[172:173], v[12:13]
  v_lshlrev_b32 v14, 16, v119
  v_and_b32 v15, 0xffff0000, v119
  v_pk_add_f32 v[174:175], v[174:175], v[14:15]
  s_waitcnt vmcnt(8)
  v_lshlrev_b32 v8, 16, v120
  v_and_b32 v9, 0xffff0000, v120
  v_pk_add_f32 v[160:161], v[160:161], v[8:9]
  v_lshlrev_b32 v10, 16, v121
  v_and_b32 v11, 0xffff0000, v121
  v_pk_add_f32 v[162:163], v[162:163], v[10:11]
  v_lshlrev_b32 v12, 16, v122
  v_and_b32 v13, 0xffff0000, v122
  v_pk_add_f32 v[164:165], v[164:165], v[12:13]
  v_lshlrev_b32 v14, 16, v123
  v_and_b32 v15, 0xffff0000, v123
  v_pk_add_f32 v[166:167], v[166:167], v[14:15]
  v_lshlrev_b32 v8, 16, v124
  v_and_b32 v9, 0xffff0000, v124
  v_pk_add_f32 v[168:169], v[168:169], v[8:9]
  v_lshlrev_b32 v10, 16, v125
  v_and_b32 v11, 0xffff0000, v125
  v_pk_add_f32 v[170:171], v[170:171], v[10:11]
  v_lshlrev_b32 v12, 16, v126
  v_and_b32 v13, 0xffff0000, v126
  v_pk_add_f32 v[172:173], v[172:173], v[12:13]
  v_lshlrev_b32 v14, 16, v127
  v_and_b32 v15, 0xffff0000, v127
  v_pk_add_f32 v[174:175], v[174:175], v[14:15]
  s_waitcnt vmcnt(6)
  v_lshlrev_b32 v8, 16, v128
  v_and_b32 v9, 0xffff0000, v128
  v_pk_add_f32 v[160:161], v[160:161], v[8:9]
  v_lshlrev_b32 v10, 16, v129
  v_and_b32 v11, 0xffff0000, v129
  v_pk_add_f32 v[162:163], v[162:163], v[10:11]
  v_lshlrev_b32 v12, 16, v130
  v_and_b32 v13, 0xffff0000, v130
  v_pk_add_f32 v[164:165], v[164:165], v[12:13]
  v_lshlrev_b32 v14, 16, v131
  v_and_b32 v15, 0xffff0000, v131
  v_pk_add_f32 v[166:167], v[166:167], v[14:15]
  v_lshlrev_b32 v8, 16, v132
  v_and_b32 v9, 0xffff0000, v132
  v_pk_add_f32 v[168:169], v[168:169], v[8:9]
  v_lshlrev_b32 v10, 16, v133
  v_and_b32 v11, 0xffff0000, v133
  v_pk_add_f32 v[170:171], v[170:171], v[10:11]
  v_lshlrev_b32 v12, 16, v134
  v_and_b32 v13, 0xffff0000, v134
  v_pk_add_f32 v[172:173], v[172:173], v[12:13]
  v_lshlrev_b32 v14, 16, v135
  v_and_b32 v15, 0xffff0000, v135
  v_pk_add_f32 v[174:175], v[174:175], v[14:15]
  s_waitcnt vmcnt(4)
  v_lshlrev_b32 v8, 16, v136
  v_and_b32 v9, 0xffff0000, v136
  v_pk_add_f32 v[160:161], v[160:161], v[8:9]
  v_lshlrev_b32 v10, 16, v137
  v_and_b32 v11, 0xffff0000, v137
  v_pk_add_f32 v[162:163], v[162:163], v[10:11]
  v_lshlrev_b32 v12, 16, v138
  v_and_b32 v13, 0xffff0000, v138
  v_pk_add_f32 v[164:165], v[164:165], v[12:13]
  v_lshlrev_b32 v14, 16, v139
  v_and_b32 v15, 0xffff0000, v139
  v_pk_add_f32 v[166:167], v[166:167], v[14:15]
  v_lshlrev_b32 v8, 16, v140
  v_and_b32 v9, 0xffff0000, v140
  v_pk_add_f32 v[168:169], v[168:169], v[8:9]
  v_lshlrev_b32 v10, 16, v141
  v_and_b32 v11, 0xffff0000, v141
  v_pk_add_f32 v[170:171], v[170:171], v[10:11]
  v_lshlrev_b32 v12, 16, v142
  v_and_b32 v13, 0xffff0000, v142
  v_pk_add_f32 v[172:173], v[172:173], v[12:13]
  v_lshlrev_b32 v14, 16, v143
  v_and_b32 v15, 0xffff0000, v143
  v_pk_add_f32 v[174:175], v[174:175], v[14:15]
  s_waitcnt vmcnt(2)
  v_lshlrev_b32 v8, 16, v144
  v_and_b32 v9, 0xffff0000, v144
  v_pk_add_f32 v[160:161], v[160:161], v[8:9]
  v_lshlrev_b32 v10, 16, v145
  v_and_b32 v11, 0xffff0000, v145
  v_pk_add_f32 v[162:163], v[162:163], v[10:11]
  v_lshlrev_b32 v12, 16, v146
  v_and_b32 v13, 0xffff0000, v146
  v_pk_add_f32 v[164:165], v[164:165], v[12:13]
  v_lshlrev_b32 v14, 16, v147
  v_and_b32 v15, 0xffff0000, v147
  v_pk_add_f32 v[166:167], v[166:167], v[14:15]
  v_lshlrev_b32 v8, 16, v148
  v_and_b32 v9, 0xffff0000, v148
  v_pk_add_f32 v[168:169], v[168:169], v[8:9]
  v_lshlrev_b32 v10, 16, v149
  v_and_b32 v11, 0xffff0000, v149
  v_pk_add_f32 v[170:171], v[170:171], v[10:11]
  v_lshlrev_b32 v12, 16, v150
  v_and_b32 v13, 0xffff0000, v150
  v_pk_add_f32 v[172:173], v[172:173], v[12:13]
  v_lshlrev_b32 v14, 16, v151
  v_and_b32 v15, 0xffff0000, v151
  v_pk_add_f32 v[174:175], v[174:175], v[14:15]
  s_waitcnt vmcnt(0)
  v_lshlrev_b32 v8, 16, v152
  v_and_b32 v9, 0xffff0000, v152
  v_pk_add_f32 v[160:161], v[160:161], v[8:9]
  v_lshlrev_b32 v10, 16, v153
  v_and_b32 v11, 0xffff0000, v153
  v_pk_add_f32 v[162:163], v[162:163], v[10:11]
  v_lshlrev_b32 v12, 16, v154
  v_and_b32 v13, 0xffff0000, v154
  v_pk_add_f32 v[164:165], v[164:165], v[12:13]
  v_lshlrev_b32 v14, 16, v155
  v_and_b32 v15, 0xffff0000, v155
  v_pk_add_f32 v[166:167], v[166:167], v[14:15]
  v_lshlrev_b32 v8, 16, v156
  v_and_b32 v9, 0xffff0000, v156
  v_pk_add_f32 v[168:169], v[168:169], v[8:9]
  v_lshlrev_b32 v10, 16, v157
  v_and_b32 v11, 0xffff0000, v157
  v_pk_add_f32 v[170:171], v[170:171], v[10:11]
  v_lshlrev_b32 v12, 16, v158
  v_and_b32 v13, 0xffff0000, v158
  v_pk_add_f32 v[172:173], v[172:173], v[12:13]
  v_lshlrev_b32 v14, 16, v159
  v_and_b32 v15, 0xffff0000, v159
  v_pk_add_f32 v[174:175], v[174:175], v[14:15]
  s_and_b32 s76, s48, 1
  s_lshl_b32 s76, s76, 1
  s_lshr_b32 s77, s49, 1
  s_add_u32 s76, s76, s77
  s_mul_i32 s76, s76, 7
  s_add_u32 s76, s76, 6
  s_lshr_b32 s77, s48, 1
  s_add_u32 s77, s77, 0x201
  v_mov_b32 v193, s77
  s_lshl_b32 s76, s76, 7
  s_add_u32 s76, s76, 148897792
  v_and_b32 v192, 7, v1
  v_mul_u32_u24 v192, 3584, v192
  v_add_u32 v192, s76, v192
  s_mov_b32 s71, 0
  s_branch M_vg_186
M_vw_185:
  s_sleep 2
  s_add_u32 s71, s71, 1
  s_cmp_gt_u32 s71, 262144
  s_cbranch_scc1 M_exit
M_vg_186:
  buffer_load_dword v194, v192, s[4:7], 0 offen sc1
  s_waitcnt vmcnt(0)
  v_cmp_lt_u32 vcc, v194, v193
  s_cbranch_vccnz M_vw_185
  s_add_u32 s29, s28, 167772160
  buffer_load_dwordx4 v[96:99], v2, s[4:7], s29 offen offset:0 sc1
  buffer_load_dwordx4 v[100:103], v2, s[4:7], s29 offen offset:1024 sc1
  s_add_u32 s29, s28, 169869312
  buffer_load_dwordx4 v[104:107], v2, s[4:7], s29 offen offset:0 sc1
  buffer_load_dwordx4 v[108:111], v2, s[4:7], s29 offen offset:1024 sc1
  s_add_u32 s29, s28, 171966464
  buffer_load_dwordx4 v[112:115], v2, s[4:7], s29 offen offset:0 sc1
  buffer_load_dwordx4 v[116:119], v2, s[4:7], s29 offen offset:1024 sc1
  s_add_u32 s29, s28, 174063616
  buffer_load_dwordx4 v[120:123], v2, s[4:7], s29 offen offset:0 sc1
  buffer_load_dwordx4 v[124:127], v2, s[4:7], s29 offen offset:1024 sc1
  s_add_u32 s29, s28, 176160768
  buffer_load_dwordx4 v[128:131], v2, s[4:7], s29 offen offset:0 sc1
  buffer_load_dwordx4 v[132:135], v2, s[4:7], s29 offen offset:1024 sc1
  s_add_u32 s29, s28, 178257920
  buffer_load_dwordx4 v[136:139], v2, s[4:7], s29 offen offset:0 sc1
  buffer_load_dwordx4 v[140:143], v2, s[4:7], s29 offen offset:1024 sc1
  s_add_u32 s29, s28, 180355072
  buffer_load_dwordx4 v[144:147], v2, s[4:7], s29 offen offset:0 sc1
  buffer_load_dwordx4 v[148:151], v2, s[4:7], s29 offen offset:1024 sc1
  s_add_u32 s29, s28, 182452224
  buffer_load_dwordx4 v[152:155], v2, s[4:7], s29 offen offset:0 sc1
  buffer_load_dwordx4 v[156:159], v2, s[4:7], s29 offen offset:1024 sc1
  v_pk_mul_f32 v[160:161], v[160:161], v[80:81] op_sel_hi:[1,0]
  v_pk_mul_f32 v[162:163], v[162:163], v[80:81] op_sel_hi:[1,0]
  v_pk_mul_f32 v[164:165], v[164:165], v[80:81] op_sel_hi:[1,0]
  v_pk_mul_f32 v[166:167], v[166:167], v[80:81] op_sel_hi:[1,0]
  v_pk_mul_f32 v[168:169], v[168:169], v[80:81] op_sel_hi:[1,0]
  v_pk_mul_f32 v[170:171], v[170:171], v[80:81] op_sel_hi:[1,0]
  v_pk_mul_f32 v[172:173], v[172:173], v[80:81] op_sel_hi:[1,0]
  v_pk_mul_f32 v[174:175], v[174:175], v[80:81] op_sel_hi:[1,0]
  s_waitcnt vmcnt(14)
  v_lshlrev_b32 v176, 16, v96
  v_and_b32 v177, 0xffff0000, v96
  v_lshlrev_b32 v178, 16, v97
  v_and_b32 v179, 0xffff0000, v97
  v_lshlrev_b32 v180, 16, v98
  v_and_b32 v181, 0xffff0000, v98
  v_lshlrev_b32 v182, 16, v99
  v_and_b32 v183, 0xffff0000, v99
  v_lshlrev_b32 v184, 16, v100
  v_and_b32 v185, 0xffff0000, v100
  v_lshlrev_b32 v186, 16, v101
  v_and_b32 v187, 0xffff0000, v101
  v_lshlrev_b32 v188, 16, v102
  v_and_b32 v189, 0xffff0000, v102
  v_lshlrev_b32 v190, 16, v103
  v_and_b32 v191, 0xffff0000, v103
  s_waitcnt vmcnt(12)
  v_lshlrev_b32 v8, 16, v104
  v_and_b32 v9, 0xffff0000, v104
  v_pk_add_f32 v[176:177], v[176:177], v[8:9]
  v_lshlrev_b32 v10, 16, v105
  v_and_b32 v11, 0xffff0000, v105
  v_pk_add_f32 v[178:179], v[178:179], v[10:11]
  v_lshlrev_b32 v12, 16, v106
  v_and_b32 v13, 0xffff0000, v106
  v_pk_add_f32 v[180:181], v[180:181], v[12:13]
  v_lshlrev_b32 v14, 16, v107
  v_and_b32 v15, 0xffff0000, v107
  v_pk_add_f32 v[182:183], v[182:183], v[14:15]
  v_lshlrev_b32 v8, 16, v108
  v_and_b32 v9, 0xffff0000, v108
  v_pk_add_f32 v[184:185], v[184:185], v[8:9]
  v_lshlrev_b32 v10, 16, v109
  v_and_b32 v11, 0xffff0000, v109
  v_pk_add_f32 v[186:187], v[186:187], v[10:11]
  v_lshlrev_b32 v12, 16, v110
  v_and_b32 v13, 0xffff0000, v110
  v_pk_add_f32 v[188:189], v[188:189], v[12:13]
  v_lshlrev_b32 v14, 16, v111
  v_and_b32 v15, 0xffff0000, v111
  v_pk_add_f32 v[190:191], v[190:191], v[14:15]
  s_waitcnt vmcnt(10)
  v_lshlrev_b32 v8, 16, v112
  v_and_b32 v9, 0xffff0000, v112
  v_pk_add_f32 v[176:177], v[176:177], v[8:9]
  v_lshlrev_b32 v10, 16, v113
  v_and_b32 v11, 0xffff0000, v113
  v_pk_add_f32 v[178:179], v[178:179], v[10:11]
  v_lshlrev_b32 v12, 16, v114
  v_and_b32 v13, 0xffff0000, v114
  v_pk_add_f32 v[180:181], v[180:181], v[12:13]
  v_lshlrev_b32 v14, 16, v115
  v_and_b32 v15, 0xffff0000, v115
  v_pk_add_f32 v[182:183], v[182:183], v[14:15]
  v_lshlrev_b32 v8, 16, v116
  v_and_b32 v9, 0xffff0000, v116
  v_pk_add_f32 v[184:185], v[184:185], v[8:9]
  v_lshlrev_b32 v10, 16, v117
  v_and_b32 v11, 0xffff0000, v117
  v_pk_add_f32 v[186:187], v[186:187], v[10:11]
  v_lshlrev_b32 v12, 16, v118
  v_and_b32 v13, 0xffff0000, v118
  v_pk_add_f32 v[188:189], v[188:189], v[12:13]
  v_lshlrev_b32 v14, 16, v119
  v_and_b32 v15, 0xffff0000, v119
  v_pk_add_f32 v[190:191], v[190:191], v[14:15]
  s_waitcnt vmcnt(8)
  v_lshlrev_b32 v8, 16, v120
  v_and_b32 v9, 0xffff0000, v120
  v_pk_add_f32 v[176:177], v[176:177], v[8:9]
  v_lshlrev_b32 v10, 16, v121
  v_and_b32 v11, 0xffff0000, v121
  v_pk_add_f32 v[178:179], v[178:179], v[10:11]
  v_lshlrev_b32 v12, 16, v122
  v_and_b32 v13, 0xffff0000, v122
  v_pk_add_f32 v[180:181], v[180:181], v[12:13]
  v_lshlrev_b32 v14, 16, v123
  v_and_b32 v15, 0xffff0000, v123
  v_pk_add_f32 v[182:183], v[182:183], v[14:15]
  v_lshlrev_b32 v8, 16, v124
  v_and_b32 v9, 0xffff0000, v124
  v_pk_add_f32 v[184:185], v[184:185], v[8:9]
  v_lshlrev_b32 v10, 16, v125
  v_and_b32 v11, 0xffff0000, v125
  v_pk_add_f32 v[186:187], v[186:187], v[10:11]
  v_lshlrev_b32 v12, 16, v126
  v_and_b32 v13, 0xffff0000, v126
  v_pk_add_f32 v[188:189], v[188:189], v[12:13]
  v_lshlrev_b32 v14, 16, v127
  v_and_b32 v15, 0xffff0000, v127
  v_pk_add_f32 v[190:191], v[190:191], v[14:15]
  s_waitcnt vmcnt(6)
  v_lshlrev_b32 v8, 16, v128
  v_and_b32 v9, 0xffff0000, v128
  v_pk_add_f32 v[176:177], v[176:177], v[8:9]
  v_lshlrev_b32 v10, 16, v129
  v_and_b32 v11, 0xffff0000, v129
  v_pk_add_f32 v[178:179], v[178:179], v[10:11]
  v_lshlrev_b32 v12, 16, v130
  v_and_b32 v13, 0xffff0000, v130
  v_pk_add_f32 v[180:181], v[180:181], v[12:13]
  v_lshlrev_b32 v14, 16, v131
  v_and_b32 v15, 0xffff0000, v131
  v_pk_add_f32 v[182:183], v[182:183], v[14:15]
  v_lshlrev_b32 v8, 16, v132
  v_and_b32 v9, 0xffff0000, v132
  v_pk_add_f32 v[184:185], v[184:185], v[8:9]
  v_lshlrev_b32 v10, 16, v133
  v_and_b32 v11, 0xffff0000, v133
  v_pk_add_f32 v[186:187], v[186:187], v[10:11]
  v_lshlrev_b32 v12, 16, v134
  v_and_b32 v13, 0xffff0000, v134
  v_pk_add_f32 v[188:189], v[188:189], v[12:13]
  v_lshlrev_b32 v14, 16, v135
  v_and_b32 v15, 0xffff0000, v135
  v_pk_add_f32 v[190:191], v[190:191], v[14:15]
  s_waitcnt vmcnt(4)
  v_lshlrev_b32 v8, 16, v136
  v_and_b32 v9, 0xffff0000, v136
  v_pk_add_f32 v[176:177], v[176:177], v[8:9]
  v_lshlrev_b32 v10, 16, v137
  v_and_b32 v11, 0xffff0000, v137
  v_pk_add_f32 v[178:179], v[178:179], v[10:11]
  v_lshlrev_b32 v12, 16, v138
  v_and_b32 v13, 0xffff0000, v138
  v_pk_add_f32 v[180:181], v[180:181], v[12:13]
  v_lshlrev_b32 v14, 16, v139
  v_and_b32 v15, 0xffff0000, v139
  v_pk_add_f32 v[182:183], v[182:183], v[14:15]
  v_lshlrev_b32 v8, 16, v140
  v_and_b32 v9, 0xffff0000, v140
  v_pk_add_f32 v[184:185], v[184:185], v[8:9]
  v_lshlrev_b32 v10, 16, v141
  v_and_b32 v11, 0xffff0000, v141
  v_pk_add_f32 v[186:187], v[186:187], v[10:11]
  v_lshlrev_b32 v12, 16, v142
  v_and_b32 v13, 0xffff0000, v142
  v_pk_add_f32 v[188:189], v[188:189], v[12:13]
  v_lshlrev_b32 v14, 16, v143
  v_and_b32 v15, 0xffff0000, v143
  v_pk_add_f32 v[190:191], v[190:191], v[14:15]
  s_waitcnt vmcnt(2)
  v_lshlrev_b32 v8, 16, v144
  v_and_b32 v9, 0xffff0000, v144
  v_pk_add_f32 v[176:177], v[176:177], v[8:9]
  v_lshlrev_b32 v10, 16, v145
  v_and_b32 v11, 0xffff0000, v145
  v_pk_add_f32 v[178:179], v[178:179], v[10:11]
  v_lshlrev_b32 v12, 16, v146
  v_and_b32 v13, 0xffff0000, v146
  v_pk_add_f32 v[180:181], v[180:181], v[12:13]
  v_lshlrev_b32 v14, 16, v147
  v_and_b32 v15, 0xffff0000, v147
  v_pk_add_f32 v[182:183], v[182:183], v[14:15]
  v_lshlrev_b32 v8, 16, v148
  v_and_b32 v9, 0xffff0000, v148
  v_pk_add_f32 v[184:185], v[184:185], v[8:9]
  v_lshlrev_b32 v10, 16, v149
  v_and_b32 v11, 0xffff0000, v149
  v_pk_add_f32 v[186:187], v[186:187], v[10:11]
  v_lshlrev_b32 v12, 16, v150
  v_and_b32 v13, 0xffff0000, v150
  v_pk_add_f32 v[188:189], v[188:189], v[12:13]
  v_lshlrev_b32 v14, 16, v151
  v_and_b32 v15, 0xffff0000, v151
  v_pk_add_f32 v[190:191], v[190:191], v[14:15]
  s_waitcnt vmcnt(0)
  v_lshlrev_b32 v8, 16, v152
  v_and_b32 v9, 0xffff0000, v152
  v_pk_add_f32 v[176:177], v[176:177], v[8:9]
  v_lshlrev_b32 v10, 16, v153
  v_and_b32 v11, 0xffff0000, v153
  v_pk_add_f32 v[178:179], v[178:179], v[10:11]
  v_lshlrev_b32 v12, 16, v154
  v_and_b32 v13, 0xffff0000, v154
  v_pk_add_f32 v[180:181], v[180:181], v[12:13]
  v_lshlrev_b32 v14, 16, v155
  v_and_b32 v15, 0xffff0000, v155
  v_pk_add_f32 v[182:183], v[182:183], v[14:15]
  v_lshlrev_b32 v8, 16, v156
  v_and_b32 v9, 0xffff0000, v156
  v_pk_add_f32 v[184:185], v[184:185], v[8:9]
  v_lshlrev_b32 v10, 16, v157
  v_and_b32 v11, 0xffff0000, v157
  v_pk_add_f32 v[186:187], v[186:187], v[10:11]
  v_lshlrev_b32 v12, 16, v158
  v_and_b32 v13, 0xffff0000, v158
  v_pk_add_f32 v[188:189], v[188:189], v[12:13]
  v_lshlrev_b32 v14, 16, v159
  v_and_b32 v15, 0xffff0000, v159
  v_pk_add_f32 v[190:191], v[190:191], v[14:15]
  v_pk_fma_f32 v[160:161], v[176:177], v[82:83], v[160:161] op_sel_hi:[1,0,1]
  v_cvt_pk_bf16_f32 v16, v160, v161
  v_pk_fma_f32 v[162:163], v[178:179], v[82:83], v[162:163] op_sel_hi:[1,0,1]
  v_cvt_pk_bf16_f32 v17, v162, v163
  v_pk_fma_f32 v[164:165], v[180:181], v[82:83], v[164:165] op_sel_hi:[1,0,1]
  v_cvt_pk_bf16_f32 v18, v164, v165
  v_pk_fma_f32 v[166:167], v[182:183], v[82:83], v[166:167] op_sel_hi:[1,0,1]
  v_cvt_pk_bf16_f32 v19, v166, v167
  v_pk_fma_f32 v[168:169], v[184:185], v[82:83], v[168:169] op_sel_hi:[1,0,1]
  v_cvt_pk_bf16_f32 v20, v168, v169
  v_pk_fma_f32 v[170:171], v[186:187], v[82:83], v[170:171] op_sel_hi:[1,0,1]
  v_cvt_pk_bf16_f32 v21, v170, v171
  v_pk_fma_f32 v[172:173], v[188:189], v[82:83], v[172:173] op_sel_hi:[1,0,1]
  v_cvt_pk_bf16_f32 v22, v172, v173
  v_pk_fma_f32 v[174:175], v[190:191], v[82:83], v[174:175] op_sel_hi:[1,0,1]
  v_cvt_pk_bf16_f32 v23, v174, v175
  s_lshl_b32 s26, s49, 2
  s_add_u32 s26, s26, s16
  s_lshl_b32 s26, s26, 6
  s_lshl_b32 s27, s48, 15
  s_add_u32 s26, s26, s27
  buffer_store_dwordx4 v[16:19], v6, s[32:35], s26 offen offset:0
  buffer_store_dwordx4 v[20:23], v6, s[32:35], s26 offen offset:32
  s_cmp_lt_u32 s50, 64
  s_mov_b32 s50, s51
  s_cbranch_scc1 M_fin
  s_branch M_done
M_follow:
  s_lshr_b32 s48, s64, 2
  s_and_b32 s49, s64, 1
  s_bfe_u32 s50, s64, 0x10001
  s_mov_b32 s51, 2
  s_mov_b32 s23, 32
  s_load_dwordx2 s[8:9], s[0:1], 88
  s_lshl_b32 s17, s48, 19
  s_lshl_b32 s26, s49, 2
  s_add_u32 s26, s26, s16
  s_lshl_b32 s27, s26, 7
  s_add_u32 s17, s17, s27
  s_mov_b32 s18, 1024
  s_lshl_b32 s21, s48, 6
  s_add_u32 s21, s21, s50
  s_lshl_b32 s21, s21, 3
  s_add_u32 s21, s21, s26
  s_lshl_b32 s21, s21, 12
  s_add_u32 s21, s21, 167772160
  s_lshl_b32 s22, s51, 15
  s_mov_b32 s24, 1.0
  s_waitcnt lgkmcnt(0)
  s_and_b32 s9, s9, 0xffff
  s_mov_b32 s10, 4194304
  s_mov_b32 s11, 0x20000
  v_lshrrev_b32 v144, 4, v1
  v_and_b32 v56, 0xff, v2
  v_lshl_add_u32 v56, v144, 9, v56
  s_mul_i32 s26, s16, 0
  v_add_u32 v8, 0, v56
  v_add_u32 v16, 0, v2
  v_add_u32 v16, s26, v16
  v_add_u32 v9, 256, v56
  v_add_u32 v17, 1024, v2
  v_add_u32 v17, s26, v17
  v_add_u32 v10, 2048, v56
  v_add_u32 v18, 2048, v2
  v_add_u32 v18, s26, v18
  v_add_u32 v11, 2304, v56
  v_add_u32 v19, 3072, v2
  v_add_u32 v19, s26, v19
  v_add_u32 v12, 4096, v56
  v_add_u32 v20, 4096, v2
  v_add_u32 v20, s26, v20
  v_add_u32 v13, 4352, v56
  v_add_u32 v21, 5120, v2
  v_add_u32 v21, s26, v21
  v_add_u32 v14, 6144, v56
  v_add_u32 v22, 6144, v2
  v_add_u32 v22, s26, v22
  v_add_u32 v15, 6400, v56
  v_add_u32 v23, 7168, v2
  v_add_u32 v23, s26, v23
  v_mov_b32 v20, v56
  v_lshrrev_b32 v144, 3, v1
  v_mul_lo_u32 v144, v144, s18
  v_and_b32 v145, 7, v1
  v_lshl_add_u32 v144, v145, 4, v144
  s_lshl_b32 s28, s16, 15
  s_add_u32 s28, s28, 32768
  s_lshl_b32 s29, s18, 3
  s_add_u32 m0, s28, 0
  s_nop 0
  buffer_load_dwordx4 v144, s[8:11], s17 offen lds
  s_add_u32 s17, s17, s29
  s_add_u32 m0, s28, 1024
  s_nop 0
  buffer_load_dwordx4 v144, s[8:11], s17 offen lds
  s_add_u32 s17, s17, s29
  s_add_u32 m0, s28, 2048
  s_nop 0
  buffer_load_dwordx4 v144, s[8:11], s17 offen lds
  s_add_u32 s17, s17, s29
  s_add_u32 m0, s28, 3072
  s_nop 0
  buffer_load_dwordx4 v144, s[8:11], s17 offen lds
  s_add_u32 s17, s17, s29
  s_add_u32 m0, s28, 4096
  s_nop 0
  buffer_load_dwordx4 v144, s[8:11], s17 offen lds
  s_add_u32 s17, s17, s29
  s_add_u32 m0, s28, 5120
  s_nop 0
  buffer_load_dwordx4 v144, s[8:11], s17 offen lds
  s_add_u32 s17, s17, s29
  s_add_u32 m0, s28, 6144
  s_nop 0
  buffer_load_dwordx4 v144, s[8:11], s17 offen lds
  s_add_u32 s17, s17, s29
  s_add_u32 m0, s28, 7168
  s_nop 0
  buffer_load_dwordx4 v144, s[8:11], s17 offen lds
  s_add_u32 s17, s17, s29
  s_add_u32 m0, s28, 8192
  s_nop 0
  buffer_load_dwordx4 v144, s[8:11], s17 offen lds
  s_add_u32 s17, s17, s29
  s_add_u32 m0, s28, 9216
  s_nop 0
  buffer_load_dwordx4 v144, s[8:11], s17 offen lds
  s_add_u32 s17, s17, s29
  s_add_u32 m0, s28, 10240
  s_nop 0
  buffer_load_dwordx4 v144, s[8:11], s17 offen lds
  s_add_u32 s17, s17, s29
  s_add_u32 m0, s28, 11264
  s_nop 0
  buffer_load_dwordx4 v144, s[8:11], s17 offen lds
  s_add_u32 s17, s17, s29
  s_add_u32 m0, s28, 12288
  s_nop 0
  buffer_load_dwordx4 v144, s[8:11], s17 offen lds
  s_add_u32 s17, s17, s29
  s_add_u32 m0, s28, 13312
  s_nop 0
  buffer_load_dwordx4 v144, s[8:11], s17 offen lds
  s_add_u32 s17, s17, s29
  s_add_u32 m0, s28, 14336
  s_nop 0
  buffer_load_dwordx4 v144, s[8:11], s17 offen lds
  s_add_u32 s17, s17, s29
  s_add_u32 m0, s28, 15360
  s_nop 0
  buffer_load_dwordx4 v144, s[8:11], s17 offen lds
  s_add_u32 s17, s17, s29
  s_add_u32 m0, s28, 16384
  s_nop 0
  buffer_load_dwordx4 v144, s[8:11], s17 offen lds
  s_add_u32 s17, s17, s29
  s_add_u32 m0, s28, 17408
  s_nop 0
  buffer_load_dwordx4 v144, s[8:11], s17 offen lds
  s_add_u32 s17, s17, s29
  s_add_u32 m0, s28, 18432
  s_nop 0
  buffer_load_dwordx4 v144, s[8:11], s17 offen lds
  s_add_u32 s17, s17, s29
  s_add_u32 m0, s28, 19456
  s_nop 0
  buffer_load_dwordx4 v144, s[8:11], s17 offen lds
  s_add_u32 s17, s17, s29
  s_add_u32 m0, s28, 20480
  s_nop 0
  buffer_load_dwordx4 v144, s[8:11], s17 offen lds
  s_add_u32 s17, s17, s29
  s_add_u32 m0, s28, 21504
  s_nop 0
  buffer_load_dwordx4 v144, s[8:11], s17 offen lds
  s_add_u32 s17, s17, s29
  s_add_u32 m0, s28, 22528
  s_nop 0
  buffer_load_dwordx4 v144, s[8:11], s17 offen lds
  s_add_u32 s17, s17, s29
  s_add_u32 m0, s28, 23552
  s_nop 0
  buffer_load_dwordx4 v144, s[8:11], s17 offen lds
  s_add_u32 s17, s17, s29
  s_add_u32 m0, s28, 24576
  s_nop 0
  buffer_load_dwordx4 v144, s[8:11], s17 offen lds
  s_add_u32 s17, s17, s29
  s_add_u32 m0, s28, 25600
  s_nop 0
  buffer_load_dwordx4 v144, s[8:11], s17 offen lds
  s_add_u32 s17, s17, s29
  s_add_u32 m0, s28, 26624
  s_nop 0
  buffer_load_dwordx4 v144, s[8:11], s17 offen lds
  s_add_u32 s17, s17, s29
  s_add_u32 m0, s28, 27648
  s_nop 0
  buffer_load_dwordx4 v144, s[8:11], s17 offen lds
  s_add_u32 s17, s17, s29
  s_add_u32 m0, s28, 28672
  s_nop 0
  buffer_load_dwordx4 v144, s[8:11], s17 offen lds
  s_add_u32 s17, s17, s29
  s_add_u32 m0, s28, 29696
  s_nop 0
  buffer_load_dwordx4 v144, s[8:11], s17 offen lds
  s_add_u32 s17, s17, s29
  s_add_u32 m0, s28, 30720
  s_nop 0
  buffer_load_dwordx4 v144, s[8:11], s17 offen lds
  s_add_u32 s17, s17, s29
  s_add_u32 m0, s28, 31744
  s_nop 0
  buffer_load_dwordx4 v144, s[8:11], s17 offen lds
  s_add_u32 s17, s17, s29
  v_bfe_u32 v148, v1, 2, 2
  v_lshrrev_b32 v149, 5, v1
  v_lshl_add_u32 v148, v149, 4, v148
  v_bfe_u32 v149, v1, 4, 1
  v_lshl_add_u32 v148, v149, 2, v148
  v_and_b32 v149, 3, v1
  v_lshlrev_b32 v149, 4, v149
  s_mov_b32 s26, 8
  v_lshl_add_u32 v148, v148, 7, v149
  v_add_u32 v152, s28, v148
  v_add_u32 v153, 1024, v152
  v_add_u32 v154, s26, v152
  v_add_u32 v155, s26, v153
  s_waitcnt vmcnt(28)
  ds_read_b64_tr_b16 a[0:1], v152 offset:0
  ds_read_b64_tr_b16 a[2:3], v153 offset:0
  ds_read_b64_tr_b16 a[4:5], v154 offset:0
  ds_read_b64_tr_b16 a[6:7], v155 offset:0
  ds_read_b64_tr_b16 a[8:9], v152 offset:64
  ds_read_b64_tr_b16 a[10:11], v153 offset:64
  ds_read_b64_tr_b16 a[12:13], v154 offset:64
  ds_read_b64_tr_b16 a[14:15], v155 offset:64
  s_waitcnt lgkmcnt(0)
  s_add_u32 m0, s28, 0
  s_nop 0
  buffer_load_dwordx4 v144, s[8:11], s17 offen lds
  s_add_u32 s17, s17, s29
  s_add_u32 m0, s28, 1024
  s_nop 0
  buffer_load_dwordx4 v144, s[8:11], s17 offen lds
  s_add_u32 s17, s17, s29
  s_add_u32 m0, s28, 2048
  s_nop 0
  buffer_load_dwordx4 v144, s[8:11], s17 offen lds
  s_add_u32 s17, s17, s29
  s_add_u32 m0, s28, 3072
  s_nop 0
  buffer_load_dwordx4 v144, s[8:11], s17 offen lds
  s_add_u32 s17, s17, s29
  s_waitcnt vmcnt(28)
  ds_read_b64_tr_b16 a[16:17], v152 offset:4096
  ds_read_b64_tr_b16 a[18:19], v153 offset:4096
  ds_read_b64_tr_b16 a[20:21], v154 offset:4096
  ds_read_b64_tr_b16 a[22:23], v155 offset:4096
  ds_read_b64_tr_b16 a[24:25], v152 offset:4160
  ds_read_b64_tr_b16 a[26:27], v153 offset:4160
  ds_read_b64_tr_b16 a[28:29], v154 offset:4160
  ds_read_b64_tr_b16 a[30:31], v155 offset:4160
  s_waitcnt lgkmcnt(0)
  s_add_u32 m0, s28, 4096
  s_nop 0
  buffer_load_dwordx4 v144, s[8:11], s17 offen lds
  s_add_u32 s17, s17, s29
  s_add_u32 m0, s28, 5120
  s_nop 0
  buffer_load_dwordx4 v144, s[8:11], s17 offen lds
  s_add_u32 s17, s17, s29
  s_add_u32 m0, s28, 6144
  s_nop 0
  buffer_load_dwordx4 v144, s[8:11], s17 offen lds
  s_add_u32 s17, s17, s29
  s_add_u32 m0, s28, 7168
  s_nop 0
  buffer_load_dwordx4 v144, s[8:11], s17 offen lds
  s_add_u32 s17, s17, s29
  s_waitcnt vmcnt(28)
  ds_read_b64_tr_b16 a[32:33], v152 offset:8192
  ds_read_b64_tr_b16 a[34:35], v153 offset:8192
  ds_read_b64_tr_b16 a[36:37], v154 offset:8192
  ds_read_b64_tr_b16 a[38:39], v155 offset:8192
  ds_read_b64_tr_b16 a[40:41], v152 offset:8256
  ds_read_b64_tr_b16 a[42:43], v153 offset:8256
  ds_read_b64_tr_b16 a[44:45], v154 offset:8256
  ds_read_b64_tr_b16 a[46:47], v155 offset:8256
  s_waitcnt lgkmcnt(0)
  s_add_u32 m0, s28, 8192
  s_nop 0
  buffer_load_dwordx4 v144, s[8:11], s17 offen lds
  s_add_u32 s17, s17, s29
  s_add_u32 m0, s28, 9216
  s_nop 0
  buffer_load_dwordx4 v144, s[8:11], s17 offen lds
  s_add_u32 s17, s17, s29
  s_add_u32 m0, s28, 10240
  s_nop 0
  buffer_load_dwordx4 v144, s[8:11], s17 offen lds
  s_add_u32 s17, s17, s29
  s_add_u32 m0, s28, 11264
  s_nop 0
  buffer_load_dwordx4 v144, s[8:11], s17 offen lds
  s_add_u32 s17, s17, s29
  s_waitcnt vmcnt(28)
  ds_read_b64_tr_b16 a[48:49], v152 offset:12288
  ds_read_b64_tr_b16 a[50:51], v153 offset:12288
  ds_read_b64_tr_b16 a[52:53], v154 offset:12288
  ds_read_b64_tr_b16 a[54:55], v155 offset:12288
  ds_read_b64_tr_b16 a[56:57], v152 offset:12352
  ds_read_b64_tr_b16 a[58:59], v153 offset:12352
  ds_read_b64_tr_b16 a[60:61], v154 offset:12352
  ds_read_b64_tr_b16 a[62:63], v155 offset:12352
  s_waitcnt lgkmcnt(0)
  s_add_u32 m0, s28, 12288
  s_nop 0
  buffer_load_dwordx4 v144, s[8:11], s17 offen lds
  s_add_u32 s17, s17, s29
  s_add_u32 m0, s28, 13312
  s_nop 0
  buffer_load_dwordx4 v144, s[8:11], s17 offen lds
  s_add_u32 s17, s17, s29
  s_add_u32 m0, s28, 14336
  s_nop 0
  buffer_load_dwordx4 v144, s[8:11], s17 offen lds
  s_add_u32 s17, s17, s29
  s_add_u32 m0, s28, 15360
  s_nop 0
  buffer_load_dwordx4 v144, s[8:11], s17 offen lds
  s_add_u32 s17, s17, s29
  s_waitcnt vmcnt(28)
  ds_read_b64_tr_b16 a[64:65], v152 offset:16384
  ds_read_b64_tr_b16 a[66:67], v153 offset:16384
  ds_read_b64_tr_b16 a[68:69], v154 offset:16384
  ds_read_b64_tr_b16 a[70:71], v155 offset:16384
  ds_read_b64_tr_b16 a[72:73], v152 offset:16448
  ds_read_b64_tr_b16 a[74:75], v153 offset:16448
  ds_read_b64_tr_b16 a[76:77], v154 offset:16448
  ds_read_b64_tr_b16 a[78:79], v155 offset:16448
  s_waitcnt lgkmcnt(0)
  s_add_u32 m0, s28, 16384
  s_nop 0
  buffer_load_dwordx4 v144, s[8:11], s17 offen lds
  s_add_u32 s17, s17, s29
  s_add_u32 m0, s28, 17408
  s_nop 0
  buffer_load_dwordx4 v144, s[8:11], s17 offen lds
  s_add_u32 s17, s17, s29
  s_add_u32 m0, s28, 18432
  s_nop 0
  buffer_load_dwordx4 v144, s[8:11], s17 offen lds
  s_add_u32 s17, s17, s29
  s_add_u32 m0, s28, 19456
  s_nop 0
  buffer_load_dwordx4 v144, s[8:11], s17 offen lds
  s_add_u32 s17, s17, s29
  s_waitcnt vmcnt(28)
  ds_read_b64_tr_b16 a[80:81], v152 offset:20480
  ds_read_b64_tr_b16 a[82:83], v153 offset:20480
  ds_read_b64_tr_b16 a[84:85], v154 offset:20480
  ds_read_b64_tr_b16 a[86:87], v155 offset:20480
  ds_read_b64_tr_b16 a[88:89], v152 offset:20544
  ds_read_b64_tr_b16 a[90:91], v153 offset:20544
  ds_read_b64_tr_b16 a[92:93], v154 offset:20544
  ds_read_b64_tr_b16 a[94:95], v155 offset:20544
  s_waitcnt lgkmcnt(0)
  s_add_u32 m0, s28, 20480
  s_nop 0
  buffer_load_dwordx4 v144, s[8:11], s17 offen lds
  s_add_u32 s17, s17, s29
  s_add_u32 m0, s28, 21504
  s_nop 0
  buffer_load_dwordx4 v144, s[8:11], s17 offen lds
  s_add_u32 s17, s17, s29
  s_add_u32 m0, s28, 22528
  s_nop 0
  buffer_load_dwordx4 v144, s[8:11], s17 offen lds
  s_add_u32 s17, s17, s29
  s_add_u32 m0, s28, 23552
  s_nop 0
  buffer_load_dwordx4 v144, s[8:11], s17 offen lds
  s_add_u32 s17, s17, s29
  s_waitcnt vmcnt(28)
  ds_read_b64_tr_b16 a[96:97], v152 offset:24576
  ds_read_b64_tr_b16 a[98:99], v153 offset:24576
  ds_read_b64_tr_b16 a[100:101], v154 offset:24576
  ds_read_b64_tr_b16 a[102:103], v155 offset:24576
  ds_read_b64_tr_b16 a[104:105], v152 offset:24640
  ds_read_b64_tr_b16 a[106:107], v153 offset:24640
  ds_read_b64_tr_b16 a[108:109], v154 offset:24640
  ds_read_b64_tr_b16 a[110:111], v155 offset:24640
  s_waitcnt lgkmcnt(0)
  s_add_u32 m0, s28, 24576
  s_nop 0
  buffer_load_dwordx4 v144, s[8:11], s17 offen lds
  s_add_u32 s17, s17, s29
  s_add_u32 m0, s28, 25600
  s_nop 0
  buffer_load_dwordx4 v144, s[8:11], s17 offen lds
  s_add_u32 s17, s17, s29
  s_add_u32 m0, s28, 26624
  s_nop 0
  buffer_load_dwordx4 v144, s[8:11], s17 offen lds
  s_add_u32 s17, s17, s29
  s_add_u32 m0, s28, 27648
  s_nop 0
  buffer_load_dwordx4 v144, s[8:11], s17 offen lds
  s_add_u32 s17, s17, s29
  s_waitcnt vmcnt(28)
  ds_read_b64_tr_b16 a[112:113], v152 offset:28672
  ds_read_b64_tr_b16 a[114:115], v153 offset:28672
  ds_read_b64_tr_b16 a[116:117], v154 offset:28672
  ds_read_b64_tr_b16 a[118:119], v155 offset:28672
  ds_read_b64_tr_b16 a[120:121], v152 offset:28736
  ds_read_b64_tr_b16 a[122:123], v153 offset:28736
  ds_read_b64_tr_b16 a[124:125], v154 offset:28736
  ds_read_b64_tr_b16 a[126:127], v155 offset:28736
  s_waitcnt lgkmcnt(0)
  s_add_u32 m0, s28, 28672
  s_nop 0
  buffer_load_dwordx4 v144, s[8:11], s17 offen lds
  s_add_u32 s17, s17, s29
  s_add_u32 m0, s28, 29696
  s_nop 0
  buffer_load_dwordx4 v144, s[8:11], s17 offen lds
  s_add_u32 s17, s17, s29
  s_add_u32 m0, s28, 30720
  s_nop 0
  buffer_load_dwordx4 v144, s[8:11], s17 offen lds
  s_add_u32 s17, s17, s29
  s_add_u32 m0, s28, 31744
  s_nop 0
  buffer_load_dwordx4 v144, s[8:11], s17 offen lds
  s_add_u32 s17, s17, s29
  s_waitcnt vmcnt(28)
  ds_read_b64_tr_b16 a[128:129], v152 offset:0
  ds_read_b64_tr_b16 a[130:131], v153 offset:0
  ds_read_b64_tr_b16 a[132:133], v154 offset:0
  ds_read_b64_tr_b16 a[134:135], v155 offset:0
  ds_read_b64_tr_b16 a[136:137], v152 offset:64
  ds_read_b64_tr_b16 a[138:139], v153 offset:64
  ds_read_b64_tr_b16 a[140:141], v154 offset:64
  ds_read_b64_tr_b16 a[142:143], v155 offset:64
  s_waitcnt lgkmcnt(0)
  s_waitcnt vmcnt(24)
  ds_read_b64_tr_b16 a[144:145], v152 offset:4096
  ds_read_b64_tr_b16 a[146:147], v153 offset:4096
  ds_read_b64_tr_b16 a[148:149], v154 offset:4096
  ds_read_b64_tr_b16 a[150:151], v155 offset:4096
  ds_read_b64_tr_b16 a[152:153], v152 offset:4160
  ds_read_b64_tr_b16 a[154:155], v153 offset:4160
  ds_read_b64_tr_b16 a[156:157], v154 offset:4160
  ds_read_b64_tr_b16 a[158:159], v155 offset:4160
  s_waitcnt lgkmcnt(0)
  s_waitcnt vmcnt(20)
  ds_read_b64_tr_b16 a[160:161], v152 offset:8192
  ds_read_b64_tr_b16 a[162:163], v153 offset:8192
  ds_read_b64_tr_b16 a[164:165], v154 offset:8192
  ds_read_b64_tr_b16 a[166:167], v155 offset:8192
  ds_read_b64_tr_b16 a[168:169], v152 offset:8256
  ds_read_b64_tr_b16 a[170:171], v153 offset:8256
  ds_read_b64_tr_b16 a[172:173], v154 offset:8256
  ds_read_b64_tr_b16 a[174:175], v155 offset:8256
  s_waitcnt lgkmcnt(0)
  s_waitcnt vmcnt(16)
  ds_read_b64_tr_b16 a[176:177], v152 offset:12288
  ds_read_b64_tr_b16 a[178:179], v153 offset:12288
  ds_read_b64_tr_b16 a[180:181], v154 offset:12288
  ds_read_b64_tr_b16 a[182:183], v155 offset:12288
  ds_read_b64_tr_b16 a[184:185], v152 offset:12352
  ds_read_b64_tr_b16 a[186:187], v153 offset:12352
  ds_read_b64_tr_b16 a[188:189], v154 offset:12352
  ds_read_b64_tr_b16 a[190:191], v155 offset:12352
  s_waitcnt lgkmcnt(0)
  s_waitcnt vmcnt(12)
  ds_read_b64_tr_b16 a[192:193], v152 offset:16384
  ds_read_b64_tr_b16 a[194:195], v153 offset:16384
  ds_read_b64_tr_b16 a[196:197], v154 offset:16384
  ds_read_b64_tr_b16 a[198:199], v155 offset:16384
  ds_read_b64_tr_b16 a[200:201], v152 offset:16448
  ds_read_b64_tr_b16 a[202:203], v153 offset:16448
  ds_read_b64_tr_b16 a[204:205], v154 offset:16448
  ds_read_b64_tr_b16 a[206:207], v155 offset:16448
  s_waitcnt lgkmcnt(0)
  s_waitcnt vmcnt(8)
  ds_read_b64_tr_b16 a[208:209], v152 offset:20480
  ds_read_b64_tr_b16 a[210:211], v153 offset:20480
  ds_read_b64_tr_b16 a[212:213], v154 offset:20480
  ds_read_b64_tr_b16 a[214:215], v155 offset:20480
  ds_read_b64_tr_b16 a[216:217], v152 offset:20544
  ds_read_b64_tr_b16 a[218:219], v153 offset:20544
  ds_read_b64_tr_b16 a[220:221], v154 offset:20544
  ds_read_b64_tr_b16 a[222:223], v155 offset:20544
  s_waitcnt lgkmcnt(0)
  s_waitcnt vmcnt(4)
  ds_read_b64_tr_b16 a[224:225], v152 offset:24576
  ds_read_b64_tr_b16 a[226:227], v153 offset:24576
  ds_read_b64_tr_b16 a[228:229], v154 offset:24576
  ds_read_b64_tr_b16 a[230:231], v155 offset:24576
  ds_read_b64_tr_b16 a[232:233], v152 offset:24640
  ds_read_b64_tr_b16 a[234:235], v153 offset:24640
  ds_read_b64_tr_b16 a[236:237], v154 offset:24640
  ds_read_b64_tr_b16 a[238:239], v155 offset:24640
  s_waitcnt lgkmcnt(0)
  s_waitcnt vmcnt(0)
  ds_read_b64_tr_b16 a[240:241], v152 offset:28672
  ds_read_b64_tr_b16 a[242:243], v153 offset:28672
  ds_read_b64_tr_b16 a[244:245], v154 offset:28672
  ds_read_b64_tr_b16 a[246:247], v155 offset:28672
  ds_read_b64_tr_b16 a[248:249], v152 offset:28736
  ds_read_b64_tr_b16 a[250:251], v153 offset:28736
  ds_read_b64_tr_b16 a[252:253], v154 offset:28736
  ds_read_b64_tr_b16 a[254:255], v155 offset:28736
  s_waitcnt lgkmcnt(0)
  s_lshl_b32 s26, s48, 2
  s_add_u32 s26, s26, s16
  s_lshl_b32 s27, s26, 6
  s_add_u32 s27, s27, s50
  s_lshl_b32 s19, s27, 13
  s_lshl_b32 s27, s50, 5
  s_add_u32 s27, s27, s26
  s_mul_i32 s27, s27, 4096
  s_add_u32 s20, s27, 135266304
  s_lshl_b32 s25, s16, 12
  s_add_u32 s25, s25, 65536
  s_lshl_b32 s26, s16, 13
  v_add_u32 v3, s26, v2
  v_lshrrev_b32 v16, 5, v1
  v_and_b32 v17, 31, v1
  v_bfe_u32 v18, v1, 4, 1
  v_lshl_add_u32 v18, v18, 1, v16
  v_and_b32 v19, 15, v1
  v_lshl_add_u32 v18, v18, 4, v19
  v_lshl_add_u32 v5, v18, 4, s25
  v_bfe_u32 v18, v1, 2, 2
  v_lshl_add_u32 v18, v16, 2, v18
  v_and_b32 v19, 1, v1
  v_lshl_add_u32 v18, v19, 4, v18
  v_lshl_add_u32 v4, v18, 4, s25
  v_lshlrev_b32 v16, 2, v16
  v_sub_u32 v17, v17, v16
  v_mov_b32 v18, 0xf149f2ca
  v_cmp_le_i32 vcc, 0, v17
  s_nop 1
  v_cndmask_b32 v240, v18, 0, vcc
  v_cmp_le_i32 vcc, 1, v17
  s_nop 1
  v_cndmask_b32 v241, v18, 0, vcc
  v_cmp_le_i32 vcc, 2, v17
  s_nop 1
  v_cndmask_b32 v242, v18, 0, vcc
  v_cmp_le_i32 vcc, 3, v17
  s_nop 1
  v_cndmask_b32 v243, v18, 0, vcc
  v_cmp_le_i32 vcc, 8, v17
  s_nop 1
  v_cndmask_b32 v244, v18, 0, vcc
  v_cmp_le_i32 vcc, 9, v17
  s_nop 1
  v_cndmask_b32 v245, v18, 0, vcc
  v_cmp_le_i32 vcc, 10, v17
  s_nop 1
  v_cndmask_b32 v246, v18, 0, vcc
  v_cmp_le_i32 vcc, 11, v17
  s_nop 1
  v_cndmask_b32 v247, v18, 0, vcc
  v_cmp_le_i32 vcc, 16, v17
  s_nop 1
  v_cndmask_b32 v248, v18, 0, vcc
  v_cmp_le_i32 vcc, 17, v17
  s_nop 1
  v_cndmask_b32 v249, v18, 0, vcc
  v_cmp_le_i32 vcc, 18, v17
  s_nop 1
  v_cndmask_b32 v250, v18, 0, vcc
  v_cmp_le_i32 vcc, 19, v17
  s_nop 1
  v_cndmask_b32 v251, v18, 0, vcc
  v_cmp_le_i32 vcc, 24, v17
  s_nop 1
  v_cndmask_b32 v252, v18, 0, vcc
  v_cmp_le_i32 vcc, 25, v17
  s_nop 1
  v_cndmask_b32 v253, v18, 0, vcc
  v_cmp_le_i32 vcc, 26, v17
  s_nop 1
  v_cndmask_b32 v254, v18, 0, vcc
  v_cmp_le_i32 vcc, 27, v17
  s_nop 1
  v_cndmask_b32 v255, v18, 0, vcc
  v_mov_b32 v21, v2
  s_barrier
  s_lshl_b32 s77, s48, 2
  s_add_u32 s77, s77, s16
  s_mul_i32 s78, s77, 896
  s_add_u32 s76, s78, 148898304
  s_mov_b32 s71, 0
  s_branch M_sg_189
M_sw_188:
  s_sleep 8
  s_add_u32 s71, s71, 1
  s_cmp_gt_u32 s71, 262144
  s_cbranch_scc1 M_exit
M_sg_189:
  s_mov_b32 s79, 0
  s_atomic_or s79, s[72:73], s76 glc
  s_waitcnt lgkmcnt(0)
  s_cmp_lt_u32 s79, 16
  s_cbranch_scc1 M_sw_188
  s_add_u32 s76, s78, 148898048
  s_mov_b32 s71, 0
  s_branch M_sg_191
M_sw_190:
  s_sleep 8
  s_add_u32 s71, s71, 1
  s_cmp_gt_u32 s71, 262144
  s_cbranch_scc1 M_exit
M_sg_191:
  s_mov_b32 s79, 0
  s_atomic_or s79, s[72:73], s76 glc
  s_waitcnt lgkmcnt(0)
  s_cmp_lt_u32 s79, 8
  s_cbranch_scc1 M_sw_190
  s_add_u32 s76, s78, 148898176
  s_mov_b32 s71, 0
  s_branch M_sg_193
M_sw_192:
  s_sleep 8
  s_add_u32 s71, s71, 1
  s_cmp_gt_u32 s71, 262144
  s_cbranch_scc1 M_exit
M_sg_193:
  s_mov_b32 s79, 0
  s_atomic_or s79, s[72:73], s76 glc
  s_waitcnt lgkmcnt(0)
  s_cmp_lt_u32 s79, 8
  s_cbranch_scc1 M_sw_192
M_xok_187:
  s_lshl_b32 s77, s77, 7
  s_add_u32 s54, s77, 148926464
  s_add_u32 s52, s50, 1
  s_mov_b32 s53, 0
  s_mov_b32 s30, 0x200
  s_add_u32 s28, s19, 50331648
  buffer_load_dwordx4 v[144:147], v21, s[4:7], s28 offen offset:0 sc1
  buffer_load_dwordx4 v[148:151], v21, s[4:7], s28 offen offset:1024 sc1
  buffer_load_dwordx4 v[152:155], v21, s[4:7], s28 offen offset:2048 sc1
  buffer_load_dwordx4 v[156:159], v21, s[4:7], s28 offen offset:3072 sc1
  s_add_u32 s29, s19, 50335744
  buffer_load_dwordx4 v[160:163], v21, s[4:7], s29 offen offset:0 sc1
  buffer_load_dwordx4 v[164:167], v21, s[4:7], s29 offen offset:1024 sc1
  buffer_load_dwordx4 v[168:171], v21, s[4:7], s29 offen offset:2048 sc1
  buffer_load_dwordx4 v[172:175], v21, s[4:7], s29 offen offset:3072 sc1
  s_add_u32 s28, s19, 67108864
  buffer_load_dwordx4 v[176:179], v21, s[4:7], s28 offen offset:0 sc1
  buffer_load_dwordx4 v[180:183], v21, s[4:7], s28 offen offset:1024 sc1
  buffer_load_dwordx4 v[184:187], v21, s[4:7], s28 offen offset:2048 sc1
  buffer_load_dwordx4 v[188:191], v21, s[4:7], s28 offen offset:3072 sc1
  s_add_u32 s29, s19, 67112960
  buffer_load_dwordx4 v[192:195], v21, s[4:7], s29 offen offset:0 sc1
  buffer_load_dwordx4 v[196:199], v21, s[4:7], s29 offen offset:1024 sc1
  buffer_load_dwordx4 v[200:203], v21, s[4:7], s29 offen offset:2048 sc1
  buffer_load_dwordx4 v[204:207], v21, s[4:7], s29 offen offset:3072 sc1
  s_add_u32 s28, s19, 83886080
  buffer_load_dwordx4 v[208:211], v21, s[4:7], s28 offen offset:0 sc1
  buffer_load_dwordx4 v[212:215], v21, s[4:7], s28 offen offset:1024 sc1
  buffer_load_dwordx4 v[216:219], v21, s[4:7], s28 offen offset:2048 sc1
  buffer_load_dwordx4 v[220:223], v21, s[4:7], s28 offen offset:3072 sc1
  s_add_u32 s29, s19, 83890176
  buffer_load_dwordx4 v[224:227], v21, s[4:7], s29 offen offset:0 sc1
  buffer_load_dwordx4 v[228:231], v21, s[4:7], s29 offen offset:1024 sc1
  buffer_load_dwordx4 v[232:235], v21, s[4:7], s29 offen offset:2048 sc1
  buffer_load_dwordx4 v[236:239], v21, s[4:7], s29 offen offset:3072 sc1
  s_mov_b32 s24, 0
  v_mov_b32 v22, 0x40000000
  s_sub_u32 s21, s21, s22
F_top_194:
  s_waitcnt vmcnt(8)
  v_mfma_f32_32x32x16_bf16 v[24:39], v[176:179], v[144:147], v[240:255]
  s_nop 1
  v_cvt_pk_bf16_f32 v128, v64, v65
  v_cvt_pk_bf16_f32 v129, v66, v67
  v_cvt_pk_bf16_f32 v130, v68, v69
  v_cvt_pk_bf16_f32 v131, v70, v71
  v_mfma_f32_32x32x16_bf16 v[24:39], v[180:183], v[148:151], v[24:39]
  buffer_store_dwordx4 v[128:131], v22, s[4:7], s21 offen offset:0 sc1
  v_mfma_f32_32x32x16_bf16 v[24:39], v[184:187], v[152:155], v[24:39]
  v_cvt_pk_bf16_f32 v132, v72, v73
  v_cvt_pk_bf16_f32 v133, v74, v75
  v_cvt_pk_bf16_f32 v134, v76, v77
  v_cvt_pk_bf16_f32 v135, v78, v79
  v_mfma_f32_32x32x16_bf16 v[24:39], v[188:191], v[156:159], v[24:39]
  buffer_store_dwordx4 v[132:135], v22, s[4:7], s21 offen offset:256 sc1
  v_mfma_f32_32x32x16_bf16 v[24:39], v[192:195], v[160:163], v[24:39]
  v_cvt_pk_bf16_f32 v136, v80, v81
  v_cvt_pk_bf16_f32 v137, v82, v83
  v_cvt_pk_bf16_f32 v138, v84, v85
  v_cvt_pk_bf16_f32 v139, v86, v87
  v_mfma_f32_32x32x16_bf16 v[24:39], v[196:199], v[164:167], v[24:39]
  buffer_store_dwordx4 v[136:139], v22, s[4:7], s21 offen offset:2048 sc1
  v_mfma_f32_32x32x16_bf16 v[24:39], v[200:203], v[168:171], v[24:39]
  v_cvt_pk_bf16_f32 v140, v88, v89
  v_cvt_pk_bf16_f32 v141, v90, v91
  v_cvt_pk_bf16_f32 v142, v92, v93
  v_cvt_pk_bf16_f32 v143, v94, v95
  v_mfma_f32_32x32x16_bf16 v[24:39], v[204:207], v[172:175], v[24:39]
  buffer_store_dwordx4 v[140:143], v22, s[4:7], s21 offen offset:2304 sc1
  s_add_u32 s21, s21, s22
  v_mov_b32 v22, v20
  s_cmp_lg_u32 s24, 0
  s_cbranch_scc1 F_have_195
  s_cmp_le_u32 s52, 58
  s_cbranch_scc1 M_dp_196
  s_mov_b32 s71, 0
  v_add_u32 v16, s25, v2
  s_branch M_dp_198
M_dp_197:
  s_sleep 1
  s_add_u32 s71, s71, 1
  s_cmp_gt_u32 s71, 262144
  s_cbranch_scc1 M_exit
M_dp_198:
  buffer_load_dword v23, off, s[4:7], s54 sc1
  buffer_load_dwordx4 v[96:99], v2, s[4:7], s20 offen offset:0 sc1
  buffer_load_dwordx4 v[100:103], v2, s[4:7], s20 offen offset:1024 sc1
  buffer_load_dwordx4 v[104:107], v2, s[4:7], s20 offen offset:2048 sc1
  buffer_load_dwordx4 v[108:111], v2, s[4:7], s20 offen offset:3072 sc1
  s_waitcnt vmcnt(3)
  v_max_u32 v17, v96, v97
  v_max3_u32 v17, v17, v98, v99
  s_waitcnt vmcnt(2)
  v_max3_u32 v17, v17, v100, v101
  v_max3_u32 v17, v17, v102, v103
  s_waitcnt vmcnt(1)
  v_max3_u32 v17, v17, v104, v105
  v_max3_u32 v17, v17, v106, v107
  s_waitcnt vmcnt(0)
  v_max3_u32 v17, v17, v108, v109
  v_max3_u32 v17, v17, v110, v111
  v_cmp_eq_u32 vcc, -1, v17
  s_cbranch_vccz M_dp_199
  v_cmp_gt_u32 vcc, s52, v23
  s_cbranch_vccnz M_dp_197
  s_branch M_dp_196
M_dp_199:
  ds_write_b128 v16, v[96:99] offset:0
  ds_write_b128 v16, v[100:103] offset:1024
  ds_write_b128 v16, v[104:107] offset:2048
  ds_write_b128 v16, v[108:111] offset:3072
  s_branch F_have_195
M_dp_196:
  v_mov_b32 v16, s54
  v_mov_b32 v17, s52
  s_mov_b32 s71, 0
  s_branch M_vg_201
M_vw_200:
  s_sleep 2
  s_add_u32 s71, s71, 1
  s_cmp_gt_u32 s71, 262144
  s_cbranch_scc1 M_exit
M_vg_201:
  buffer_load_dword v23, v16, s[4:7], 0 offen sc1
  s_waitcnt vmcnt(0)
  v_cmp_lt_u32 vcc, v23, v17
  s_cbranch_vccnz M_vw_200
  s_mov_b32 m0, s25
  s_nop 0
  buffer_load_dwordx4 v2, s[4:7], s20 offen offset:0 sc1 lds
  buffer_load_dwordx4 v2, s[4:7], s20 offen offset:1024 sc1 lds
  buffer_load_dwordx4 v2, s[4:7], s20 offen offset:2048 sc1 lds
  buffer_load_dwordx4 v2, s[4:7], s20 offen offset:3072 sc1 lds
  s_waitcnt vmcnt(0)
F_have_195:
  ds_read_b64_tr_b16 v[176:177], v4 offset:8
  ds_read_b64_tr_b16 v[178:179], v4 offset:136
  ds_read_b64_tr_b16 v[180:181], v4 offset:520
  ds_read_b64_tr_b16 v[182:183], v4 offset:648
  ds_read_b64_tr_b16 v[184:185], v4 offset:1032
  ds_read_b64_tr_b16 v[186:187], v4 offset:1160
  ds_read_b64_tr_b16 v[188:189], v4 offset:1544
  ds_read_b64_tr_b16 v[190:191], v4 offset:1672
  ds_read_b64_tr_b16 v[192:193], v4 offset:2056
  ds_read_b64_tr_b16 v[194:195], v4 offset:2184
  ds_read_b64_tr_b16 v[196:197], v4 offset:2568
  ds_read_b64_tr_b16 v[198:199], v4 offset:2696
  s_sub_u32 s23, s23, 1
  s_cmp_gt_u32 s23, 0
  s_cselect_b32 s26, s51, 0
  s_cselect_b32 s27, 0, 0x40000000
  v_or_b32 v21, s27, v21
  s_lshl_b32 s27, s26, 13
  s_add_u32 s19, s19, s27
  s_mul_i32 s27, s26, 131072
  s_add_u32 s20, s20, s27
  s_cmp_lg_u32 s23, 24
  s_cbranch_scc1 M_xok_202
  s_lshl_b32 s77, s48, 2
  s_add_u32 s77, s77, s16
  s_mul_i32 s78, s77, 896
  s_add_u32 s76, s78, 148898304
  s_mov_b32 s71, 0
  s_branch M_sg_204
M_sw_203:
  s_sleep 8
  s_add_u32 s71, s71, 1
  s_cmp_gt_u32 s71, 262144
  s_cbranch_scc1 M_exit
M_sg_204:
  s_mov_b32 s79, 0
  s_atomic_or s79, s[72:73], s76 glc
  s_waitcnt lgkmcnt(0)
  s_cmp_lt_u32 s79, 32
  s_cbranch_scc1 M_sw_203
  s_add_u32 s76, s78, 148898432
  s_mov_b32 s71, 0
  s_branch M_sg_206
M_sw_205:
  s_sleep 8
  s_add_u32 s71, s71, 1
  s_cmp_gt_u32 s71, 262144
  s_cbranch_scc1 M_exit
M_sg_206:
  s_mov_b32 s79, 0
  s_atomic_or s79, s[72:73], s76 glc
  s_waitcnt lgkmcnt(0)
  s_cmp_lt_u32 s79, 32
  s_cbranch_scc1 M_sw_205
  s_add_u32 s76, s78, 148898048
  s_mov_b32 s71, 0
  s_branch M_sg_208
M_sw_207:
  s_sleep 8
  s_add_u32 s71, s71, 1
  s_cmp_gt_u32 s71, 262144
  s_cbranch_scc1 M_exit
M_sg_208:
  s_mov_b32 s79, 0
  s_atomic_or s79, s[72:73], s76 glc
  s_waitcnt lgkmcnt(0)
  s_cmp_lt_u32 s79, 32
  s_cbranch_scc1 M_sw_207
  s_add_u32 s76, s78, 148898176
  s_mov_b32 s71, 0
  s_branch M_sg_210
M_sw_209:
  s_sleep 8
  s_add_u32 s71, s71, 1
  s_cmp_gt_u32 s71, 262144
  s_cbranch_scc1 M_exit
M_sg_210:
  s_mov_b32 s79, 0
  s_atomic_or s79, s[72:73], s76 glc
  s_waitcnt lgkmcnt(0)
  s_cmp_lt_u32 s79, 32
  s_cbranch_scc1 M_sw_209
M_xok_202:
  s_waitcnt lgkmcnt(10)
  v_mfma_f32_32x32x16_bf16 v[40:55], v[176:179], v[144:147], 0
  ds_read_b64_tr_b16 v[200:201], v4 offset:3080
  ds_read_b64_tr_b16 v[202:203], v4 offset:3208
  v_max_f32 v6, v24, v25
  s_waitcnt lgkmcnt(10)
  v_mfma_f32_32x32x16_bf16 v[40:55], v[180:183], v[148:151], v[40:55]
  ds_read_b64_tr_b16 v[204:205], v4 offset:3592
  ds_read_b64_tr_b16 v[206:207], v4 offset:3720
  v_max3_f32 v6, v6, v26, v27
  s_waitcnt lgkmcnt(10)
  v_mfma_f32_32x32x16_bf16 v[40:55], v[184:187], v[152:155], v[40:55]
  ds_read_b64 v[56:57], v5 offset:0
  ds_read_b64 v[58:59], v5 offset:1024
  v_max3_f32 v6, v6, v28, v29
  s_waitcnt lgkmcnt(10)
  v_mfma_f32_32x32x16_bf16 v[40:55], v[188:191], v[156:159], v[40:55]
  ds_read_b64 v[60:61], v5 offset:2048
  ds_read_b64 v[62:63], v5 offset:3072
  v_max3_f32 v6, v6, v30, v31
  s_waitcnt lgkmcnt(10)
  v_mfma_f32_32x32x16_bf16 v[40:55], v[192:195], v[160:163], v[40:55]
  v_max3_f32 v6, v6, v32, v33
  s_waitcnt lgkmcnt(8)
  v_mfma_f32_32x32x16_bf16 v[40:55], v[196:199], v[164:167], v[40:55]
  v_max3_f32 v6, v6, v34, v35
  s_waitcnt lgkmcnt(6)
  v_mfma_f32_32x32x16_bf16 v[40:55], v[200:203], v[168:171], v[40:55]
  v_max3_f32 v6, v6, v36, v37
  s_waitcnt lgkmcnt(4)
  v_mfma_f32_32x32x16_bf16 v[40:55], v[204:207], v[172:175], v[40:55]
  v_max3_f32 v6, v6, v38, v39
  s_add_u32 s28, s19, 50331648
  buffer_load_dwordx4 v[144:147], v21, s[4:7], s28 offen offset:0 sc1
  buffer_load_dwordx4 v[148:151], v21, s[4:7], s28 offen offset:1024 sc1
  s_nop 7
  v_max3_f32 v6, v6, v40, v41
  v_max3_f32 v6, v6, v42, v43
  v_mov_b32 v16, v6
  s_nop 1
  v_permlane32_swap_b32 v6, v16
  s_nop 1
  v_max_f32 v6, v6, v16
  v_pk_add_f32 v[24:25], v[24:25], v[6:7] op_sel_hi:[1,0] neg_lo:[0,1] neg_hi:[0,1]
  v_pk_add_f32 v[26:27], v[26:27], v[6:7] op_sel_hi:[1,0] neg_lo:[0,1] neg_hi:[0,1]
  v_pk_add_f32 v[28:29], v[28:29], v[6:7] op_sel_hi:[1,0] neg_lo:[0,1] neg_hi:[0,1]
  v_pk_add_f32 v[30:31], v[30:31], v[6:7] op_sel_hi:[1,0] neg_lo:[0,1] neg_hi:[0,1]
  v_pk_add_f32 v[32:33], v[32:33], v[6:7] op_sel_hi:[1,0] neg_lo:[0,1] neg_hi:[0,1]
  v_pk_add_f32 v[34:35], v[34:35], v[6:7] op_sel_hi:[1,0] neg_lo:[0,1] neg_hi:[0,1]
  v_pk_add_f32 v[36:37], v[36:37], v[6:7] op_sel_hi:[1,0] neg_lo:[0,1] neg_hi:[0,1]
  v_pk_add_f32 v[38:39], v[38:39], v[6:7] op_sel_hi:[1,0] neg_lo:[0,1] neg_hi:[0,1]
  v_pk_add_f32 v[40:41], v[40:41], v[6:7] op_sel_hi:[1,0] neg_lo:[0,1] neg_hi:[0,1]
  v_pk_add_f32 v[42:43], v[42:43], v[6:7] op_sel_hi:[1,0] neg_lo:[0,1] neg_hi:[0,1]
  v_exp_f32 v24, v24
  v_exp_f32 v25, v25
  v_exp_f32 v26, v26
  v_exp_f32 v27, v27
  v_exp_f32 v28, v28
  v_exp_f32 v29, v29
  v_exp_f32 v30, v30
  v_exp_f32 v31, v31
  v_exp_f32 v32, v32
  v_exp_f32 v33, v33
  buffer_load_dwordx4 v[152:155], v21, s[4:7], s28 offen offset:2048 sc1
  v_exp_f32 v34, v34
  v_exp_f32 v35, v35
  v_exp_f32 v36, v36
  v_exp_f32 v37, v37
  v_exp_f32 v38, v38
  v_exp_f32 v39, v39
  v_exp_f32 v40, v40
  v_exp_f32 v41, v41
  v_exp_f32 v42, v42
  v_exp_f32 v43, v43
  v_pk_add_f32 v[16:17], v[24:25], v[26:27]
  v_pk_add_f32 v[16:17], v[16:17], v[28:29]
  v_pk_add_f32 v[16:17], v[16:17], v[30:31]
  v_pk_add_f32 v[16:17], v[16:17], v[32:33]
  v_pk_add_f32 v[16:17], v[16:17], v[34:35]
  v_pk_add_f32 v[16:17], v[16:17], v[36:37]
  v_pk_add_f32 v[16:17], v[16:17], v[38:39]
  v_pk_add_f32 v[16:17], v[16:17], v[40:41]
  v_pk_add_f32 v[16:17], v[16:17], v[42:43]
  v_add_f32 v16, v16, v17
  v_mov_b32 v17, v16
  buffer_load_dwordx4 v[156:159], v21, s[4:7], s28 offen offset:3072 sc1
  s_nop 0
  v_permlane32_swap_b32 v16, v17
  s_nop 1
  v_add_f32 v16, v16, v17
  v_rcp_f32 v6, v16
  s_nop 0
  v_pk_mul_f32 v[24:25], v[24:25], v[6:7] op_sel_hi:[1,0]
  v_pk_mul_f32 v[26:27], v[26:27], v[6:7] op_sel_hi:[1,0]
  v_pk_mul_f32 v[28:29], v[28:29], v[6:7] op_sel_hi:[1,0]
  v_pk_mul_f32 v[30:31], v[30:31], v[6:7] op_sel_hi:[1,0]
  v_pk_mul_f32 v[32:33], v[32:33], v[6:7] op_sel_hi:[1,0]
  v_pk_mul_f32 v[34:35], v[34:35], v[6:7] op_sel_hi:[1,0]
  v_pk_mul_f32 v[36:37], v[36:37], v[6:7] op_sel_hi:[1,0]
  v_pk_mul_f32 v[38:39], v[38:39], v[6:7] op_sel_hi:[1,0]
  v_pk_mul_f32 v[40:41], v[40:41], v[6:7] op_sel_hi:[1,0]
  v_pk_mul_f32 v[42:43], v[42:43], v[6:7] op_sel_hi:[1,0]
  v_cvt_pk_bf16_f32 v128, v24, v25
  v_cvt_pk_bf16_f32 v129, v26, v27
  v_cvt_pk_bf16_f32 v130, v28, v29
  v_cvt_pk_bf16_f32 v131, v30, v31
  v_cvt_pk_bf16_f32 v132, v32, v33
  v_cvt_pk_bf16_f32 v133, v34, v35
  v_cvt_pk_bf16_f32 v134, v36, v37
  v_cvt_pk_bf16_f32 v135, v38, v39
  v_cvt_pk_bf16_f32 v136, v40, v41
  v_cvt_pk_bf16_f32 v137, v42, v43
  s_waitcnt vmcnt(8) lgkmcnt(0)
  v_mfma_f32_32x32x16_bf16 v[64:79], v[208:211], v[128:131], 0
  s_add_u32 s29, s19, 50335744
  buffer_load_dwordx4 v[160:163], v21, s[4:7], s29 offen offset:0 sc1
  v_mfma_f32_32x32x16_bf16 v[64:79], v[212:215], v[132:135], v[64:79]
  v_mfma_f32_32x32x8_bf16 v[64:79], v[56:57], v[136:137], v[64:79]
  v_mfma_f32_32x32x16_bf16 v[80:95], v[216:219], v[128:131], 0
  buffer_load_dwordx4 v[164:167], v21, s[4:7], s29 offen offset:1024 sc1
  v_mfma_f32_32x32x16_bf16 v[80:95], v[220:223], v[132:135], v[80:95]
  v_cvt_pk_bf16_f32 v24, v64, v65
  v_cvt_pk_bf16_f32 v25, v66, v67
  v_cvt_pk_bf16_f32 v26, v68, v69
  v_cvt_pk_bf16_f32 v27, v70, v71
  v_mfma_f32_32x32x8_bf16 v[80:95], v[58:59], v[136:137], v[80:95]
  ds_write_b128 v3, v[24:27] offset:0
  v_cvt_pk_bf16_f32 v28, v72, v73
  v_cvt_pk_bf16_f32 v29, v74, v75
  v_cvt_pk_bf16_f32 v30, v76, v77
  v_cvt_pk_bf16_f32 v31, v78, v79
  v_mfma_f32_32x32x16_bf16 v[96:111], v[224:227], v[128:131], 0
  ds_write_b128 v3, v[28:31] offset:1024
  buffer_load_dwordx4 v[168:171], v21, s[4:7], s29 offen offset:2048 sc1
  v_mfma_f32_32x32x16_bf16 v[96:111], v[228:231], v[132:135], v[96:111]
  v_cvt_pk_bf16_f32 v32, v80, v81
  v_cvt_pk_bf16_f32 v33, v82, v83
  v_cvt_pk_bf16_f32 v34, v84, v85
  v_cvt_pk_bf16_f32 v35, v86, v87
  v_mfma_f32_32x32x8_bf16 v[96:111], v[60:61], v[136:137], v[96:111]
  ds_write_b128 v3, v[32:35] offset:2048
  v_cvt_pk_bf16_f32 v36, v88, v89
  v_cvt_pk_bf16_f32 v37, v90, v91
  v_cvt_pk_bf16_f32 v38, v92, v93
  v_cvt_pk_bf16_f32 v39, v94, v95
  v_mfma_f32_32x32x16_bf16 v[112:127], v[232:235], v[128:131], 0
  ds_write_b128 v3, v[36:39] offset:3072
  buffer_load_dwordx4 v[172:175], v21, s[4:7], s29 offen offset:3072 sc1
  v_mfma_f32_32x32x16_bf16 v[112:127], v[236:239], v[132:135], v[112:127]
  v_cvt_pk_bf16_f32 v40, v96, v97
  v_cvt_pk_bf16_f32 v41, v98, v99
  v_cvt_pk_bf16_f32 v42, v100, v101
  v_cvt_pk_bf16_f32 v43, v102, v103
  v_mfma_f32_32x32x8_bf16 v[112:127], v[62:63], v[136:137], v[112:127]
  ds_write_b128 v3, v[40:43] offset:4096
  v_cvt_pk_bf16_f32 v44, v104, v105
  v_cvt_pk_bf16_f32 v45, v106, v107
  v_cvt_pk_bf16_f32 v46, v108, v109
  v_cvt_pk_bf16_f32 v47, v110, v111
  ds_write_b128 v3, v[44:47] offset:5120
  s_nop 5
  v_cvt_pk_bf16_f32 v48, v112, v113
  v_cvt_pk_bf16_f32 v49, v114, v115
  v_cvt_pk_bf16_f32 v50, v116, v117
  v_cvt_pk_bf16_f32 v51, v118, v119
  ds_write_b128 v3, v[48:51] offset:6144
  v_cvt_pk_bf16_f32 v52, v120, v121
  v_cvt_pk_bf16_f32 v53, v122, v123
  v_cvt_pk_bf16_f32 v54, v124, v125
  v_cvt_pk_bf16_f32 v55, v126, v127
  ds_write_b128 v3, v[52:55] offset:7168
  s_waitcnt vmcnt(8)
  s_waitcnt lgkmcnt(0)
  s_barrier
  ds_read_b128 v[24:27], v8 offset:0
  ds_read_b128 v[28:31], v9 offset:0
  ds_read_b128 v[32:35], v10 offset:0
  ds_read_b128 v[36:39], v11 offset:0
  ds_read_b128 v[40:43], v12 offset:0
  ds_read_b128 v[44:47], v13 offset:0
  buffer_load_dword v23, off, s[4:7], s54 sc1
  v_mov_b32 v16, s30
  v_min_u32 v17, 1, v0
  v_lshlrev_b32 v17, 30, v17
  buffer_store_dword v16, v17, s[4:7], s31 offen sc1
  s_add_u32 s30, s30, 1
  s_add_u32 s52, s52, 2
  s_waitcnt lgkmcnt(5)
  v_mfma_f32_16x16x32_bf16 v[64:67], a[0:3], v[24:27], 0
  s_add_u32 s28, s19, 67108864
  ds_read_b128 v[48:51], v14 offset:0
  v_mfma_f32_16x16x32_bf16 v[68:71], a[4:7], v[24:27], 0
  v_mfma_f32_16x16x32_bf16 v[80:83], a[8:11], v[24:27], 0
  v_mfma_f32_16x16x32_bf16 v[84:87], a[12:15], v[24:27], 0
  s_waitcnt lgkmcnt(5)
  v_mfma_f32_16x16x32_bf16 v[72:75], a[0:3], v[28:31], 0
  ds_read_b128 v[52:55], v15 offset:0
  v_mfma_f32_16x16x32_bf16 v[76:79], a[4:7], v[28:31], 0
  v_mfma_f32_16x16x32_bf16 v[88:91], a[8:11], v[28:31], 0
  buffer_load_dwordx4 v[176:179], v21, s[4:7], s28 offen offset:0 sc1
  v_mfma_f32_16x16x32_bf16 v[92:95], a[12:15], v[28:31], 0
  s_waitcnt lgkmcnt(5)
  v_mfma_f32_16x16x32_bf16 v[64:67], a[16:19], v[32:35], v[64:67]
  ds_read_b128 v[24:27], v8 offset:8192
  v_mfma_f32_16x16x32_bf16 v[68:71], a[20:23], v[32:35], v[68:71]
  v_mfma_f32_16x16x32_bf16 v[80:83], a[24:27], v[32:35], v[80:83]
  v_mfma_f32_16x16x32_bf16 v[84:87], a[28:31], v[32:35], v[84:87]
  s_waitcnt lgkmcnt(5)
  v_mfma_f32_16x16x32_bf16 v[72:75], a[16:19], v[36:39], v[72:75]
  ds_read_b128 v[28:31], v9 offset:8192
  v_mfma_f32_16x16x32_bf16 v[76:79], a[20:23], v[36:39], v[76:79]
  v_mfma_f32_16x16x32_bf16 v[88:91], a[24:27], v[36:39], v[88:91]
  buffer_load_dwordx4 v[180:183], v21, s[4:7], s28 offen offset:1024 sc1
  v_mfma_f32_16x16x32_bf16 v[92:95], a[28:31], v[36:39], v[92:95]
  s_waitcnt lgkmcnt(5)
  v_mfma_f32_16x16x32_bf16 v[64:67], a[32:35], v[40:43], v[64:67]
  ds_read_b128 v[32:35], v10 offset:8192
  v_mfma_f32_16x16x32_bf16 v[68:71], a[36:39], v[40:43], v[68:71]
  v_mfma_f32_16x16x32_bf16 v[80:83], a[40:43], v[40:43], v[80:83]
  v_mfma_f32_16x16x32_bf16 v[84:87], a[44:47], v[40:43], v[84:87]
  s_waitcnt lgkmcnt(5)
  v_mfma_f32_16x16x32_bf16 v[72:75], a[32:35], v[44:47], v[72:75]
  ds_read_b128 v[36:39], v11 offset:8192
  v_mfma_f32_16x16x32_bf16 v[76:79], a[36:39], v[44:47], v[76:79]
  v_mfma_f32_16x16x32_bf16 v[88:91], a[40:43], v[44:47], v[88:91]
  buffer_load_dwordx4 v[184:187], v21, s[4:7], s28 offen offset:2048 sc1
  v_mfma_f32_16x16x32_bf16 v[92:95], a[44:47], v[44:47], v[92:95]
  s_waitcnt lgkmcnt(5)
  v_mfma_f32_16x16x32_bf16 v[64:67], a[48:51], v[48:51], v[64:67]
  ds_read_b128 v[40:43], v12 offset:8192
  v_mfma_f32_16x16x32_bf16 v[68:71], a[52:55], v[48:51], v[68:71]
  v_mfma_f32_16x16x32_bf16 v[80:83], a[56:59], v[48:51], v[80:83]
  v_mfma_f32_16x16x32_bf16 v[84:87], a[60:63], v[48:51], v[84:87]
  s_waitcnt lgkmcnt(5)
  v_mfma_f32_16x16x32_bf16 v[72:75], a[48:51], v[52:55], v[72:75]
  ds_read_b128 v[44:47], v13 offset:8192
  v_mfma_f32_16x16x32_bf16 v[76:79], a[52:55], v[52:55], v[76:79]
  v_mfma_f32_16x16x32_bf16 v[88:91], a[56:59], v[52:55], v[88:91]
  buffer_load_dwordx4 v[188:191], v21, s[4:7], s28 offen offset:3072 sc1
  v_mfma_f32_16x16x32_bf16 v[92:95], a[60:63], v[52:55], v[92:95]
  s_waitcnt lgkmcnt(5)
  v_mfma_f32_16x16x32_bf16 v[64:67], a[64:67], v[24:27], v[64:67]
  s_add_u32 s29, s19, 67112960
  ds_read_b128 v[48:51], v14 offset:8192
  v_mfma_f32_16x16x32_bf16 v[68:71], a[68:71], v[24:27], v[68:71]
  v_mfma_f32_16x16x32_bf16 v[80:83], a[72:75], v[24:27], v[80:83]
  v_mfma_f32_16x16x32_bf16 v[84:87], a[76:79], v[24:27], v[84:87]
  s_waitcnt lgkmcnt(5)
  v_mfma_f32_16x16x32_bf16 v[72:75], a[64:67], v[28:31], v[72:75]
  ds_read_b128 v[52:55], v15 offset:8192
  v_mfma_f32_16x16x32_bf16 v[76:79], a[68:71], v[28:31], v[76:79]
  v_mfma_f32_16x16x32_bf16 v[88:91], a[72:75], v[28:31], v[88:91]
  buffer_load_dwordx4 v[192:195], v21, s[4:7], s29 offen offset:0 sc1
  v_mfma_f32_16x16x32_bf16 v[92:95], a[76:79], v[28:31], v[92:95]
  s_waitcnt lgkmcnt(5)
  v_mfma_f32_16x16x32_bf16 v[64:67], a[80:83], v[32:35], v[64:67]
  ds_read_b128 v[24:27], v8 offset:16384
  v_mfma_f32_16x16x32_bf16 v[68:71], a[84:87], v[32:35], v[68:71]
  v_mfma_f32_16x16x32_bf16 v[80:83], a[88:91], v[32:35], v[80:83]
  v_mfma_f32_16x16x32_bf16 v[84:87], a[92:95], v[32:35], v[84:87]
  s_waitcnt lgkmcnt(5)
  v_mfma_f32_16x16x32_bf16 v[72:75], a[80:83], v[36:39], v[72:75]
  ds_read_b128 v[28:31], v9 offset:16384
  v_mfma_f32_16x16x32_bf16 v[76:79], a[84:87], v[36:39], v[76:79]
  v_mfma_f32_16x16x32_bf16 v[88:91], a[88:91], v[36:39], v[88:91]
  buffer_load_dwordx4 v[196:199], v21, s[4:7], s29 offen offset:1024 sc1
  v_mfma_f32_16x16x32_bf16 v[92:95], a[92:95], v[36:39], v[92:95]
  s_waitcnt lgkmcnt(5)
  v_mfma_f32_16x16x32_bf16 v[64:67], a[96:99], v[40:43], v[64:67]
  ds_read_b128 v[32:35], v10 offset:16384
  v_mfma_f32_16x16x32_bf16 v[68:71], a[100:103], v[40:43], v[68:71]
  v_mfma_f32_16x16x32_bf16 v[80:83], a[104:107], v[40:43], v[80:83]
  v_mfma_f32_16x16x32_bf16 v[84:87], a[108:111], v[40:43], v[84:87]
  s_waitcnt lgkmcnt(5)
  s_waitcnt vmcnt(7)
  v_readfirstlane_b32 s53, v23
  s_nop 0
  s_cmp_ge_u32 s53, s52
  s_cselect_b32 s24, 1, 0
  s_cbranch_scc0 F_nopre_211
  s_mov_b32 m0, s25
  s_nop 0
  buffer_load_dwordx4 v2, s[4:7], s20 offen offset:0 sc1 lds
  buffer_load_dwordx4 v2, s[4:7], s20 offen offset:1024 sc1 lds
  buffer_load_dwordx4 v2, s[4:7], s20 offen offset:2048 sc1 lds
  buffer_load_dwordx4 v2, s[4:7], s20 offen offset:3072 sc1 lds
F_nopre_211:
  v_mfma_f32_16x16x32_bf16 v[72:75], a[96:99], v[44:47], v[72:75]
  ds_read_b128 v[36:39], v11 offset:16384
  v_mfma_f32_16x16x32_bf16 v[76:79], a[100:103], v[44:47], v[76:79]
  v_mfma_f32_16x16x32_bf16 v[88:91], a[104:107], v[44:47], v[88:91]
  buffer_load_dwordx4 v[200:203], v21, s[4:7], s29 offen offset:2048 sc1
  v_mfma_f32_16x16x32_bf16 v[92:95], a[108:111], v[44:47], v[92:95]
  s_waitcnt lgkmcnt(5)
  v_mfma_f32_16x16x32_bf16 v[64:67], a[112:115], v[48:51], v[64:67]
  ds_read_b128 v[40:43], v12 offset:16384
  v_mfma_f32_16x16x32_bf16 v[68:71], a[116:119], v[48:51], v[68:71]
  v_mfma_f32_16x16x32_bf16 v[80:83], a[120:123], v[48:51], v[80:83]
  v_mfma_f32_16x16x32_bf16 v[84:87], a[124:127], v[48:51], v[84:87]
  s_waitcnt lgkmcnt(5)
  v_mfma_f32_16x16x32_bf16 v[72:75], a[112:115], v[52:55], v[72:75]
  ds_read_b128 v[44:47], v13 offset:16384
  v_mfma_f32_16x16x32_bf16 v[76:79], a[116:119], v[52:55], v[76:79]
  v_mfma_f32_16x16x32_bf16 v[88:91], a[120:123], v[52:55], v[88:91]
  buffer_load_dwordx4 v[204:207], v21, s[4:7], s29 offen offset:3072 sc1
  v_mfma_f32_16x16x32_bf16 v[92:95], a[124:127], v[52:55], v[92:95]
  s_waitcnt lgkmcnt(5)
  v_mfma_f32_16x16x32_bf16 v[64:67], a[128:131], v[24:27], v[64:67]
  s_add_u32 s28, s19, 83886080
  ds_read_b128 v[48:51], v14 offset:16384
  v_mfma_f32_16x16x32_bf16 v[68:71], a[132:135], v[24:27], v[68:71]
  v_mfma_f32_16x16x32_bf16 v[80:83], a[136:139], v[24:27], v[80:83]
  v_mfma_f32_16x16x32_bf16 v[84:87], a[140:143], v[24:27], v[84:87]
  s_waitcnt lgkmcnt(5)
  v_mfma_f32_16x16x32_bf16 v[72:75], a[128:131], v[28:31], v[72:75]
  ds_read_b128 v[52:55], v15 offset:16384
  v_mfma_f32_16x16x32_bf16 v[76:79], a[132:135], v[28:31], v[76:79]
  v_mfma_f32_16x16x32_bf16 v[88:91], a[136:139], v[28:31], v[88:91]
  buffer_load_dwordx4 v[208:211], v21, s[4:7], s28 offen offset:0 sc1
  v_mfma_f32_16x16x32_bf16 v[92:95], a[140:143], v[28:31], v[92:95]
  s_waitcnt lgkmcnt(5)
  v_mfma_f32_16x16x32_bf16 v[64:67], a[144:147], v[32:35], v[64:67]
  ds_read_b128 v[24:27], v8 offset:24576
  v_mfma_f32_16x16x32_bf16 v[68:71], a[148:151], v[32:35], v[68:71]
  v_mfma_f32_16x16x32_bf16 v[80:83], a[152:155], v[32:35], v[80:83]
  v_mfma_f32_16x16x32_bf16 v[84:87], a[156:159], v[32:35], v[84:87]
  s_waitcnt lgkmcnt(5)
  v_mfma_f32_16x16x32_bf16 v[72:75], a[144:147], v[36:39], v[72:75]
  ds_read_b128 v[28:31], v9 offset:24576
  v_mfma_f32_16x16x32_bf16 v[76:79], a[148:151], v[36:39], v[76:79]
  v_mfma_f32_16x16x32_bf16 v[88:91], a[152:155], v[36:39], v[88:91]
  buffer_load_dwordx4 v[212:215], v21, s[4:7], s28 offen offset:1024 sc1
  v_mfma_f32_16x16x32_bf16 v[92:95], a[156:159], v[36:39], v[92:95]
  s_waitcnt lgkmcnt(5)
  v_mfma_f32_16x16x32_bf16 v[64:67], a[160:163], v[40:43], v[64:67]
  ds_read_b128 v[32:35], v10 offset:24576
  v_mfma_f32_16x16x32_bf16 v[68:71], a[164:167], v[40:43], v[68:71]
  v_mfma_f32_16x16x32_bf16 v[80:83], a[168:171], v[40:43], v[80:83]
  v_mfma_f32_16x16x32_bf16 v[84:87], a[172:175], v[40:43], v[84:87]
  s_waitcnt lgkmcnt(5)
  v_mfma_f32_16x16x32_bf16 v[72:75], a[160:163], v[44:47], v[72:75]
  ds_read_b128 v[36:39], v11 offset:24576
  v_mfma_f32_16x16x32_bf16 v[76:79], a[164:167], v[44:47], v[76:79]
  v_mfma_f32_16x16x32_bf16 v[88:91], a[168:171], v[44:47], v[88:91]
  buffer_load_dwordx4 v[216:219], v21, s[4:7], s28 offen offset:2048 sc1
  v_mfma_f32_16x16x32_bf16 v[92:95], a[172:175], v[44:47], v[92:95]
  s_waitcnt lgkmcnt(5)
  v_mfma_f32_16x16x32_bf16 v[64:67], a[176:179], v[48:51], v[64:67]
  ds_read_b128 v[40:43], v12 offset:24576
  v_mfma_f32_16x16x32_bf16 v[68:71], a[180:183], v[48:51], v[68:71]
  v_mfma_f32_16x16x32_bf16 v[80:83], a[184:187], v[48:51], v[80:83]
  v_mfma_f32_16x16x32_bf16 v[84:87], a[188:191], v[48:51], v[84:87]
  s_waitcnt lgkmcnt(5)
  v_mfma_f32_16x16x32_bf16 v[72:75], a[176:179], v[52:55], v[72:75]
  ds_read_b128 v[44:47], v13 offset:24576
  v_mfma_f32_16x16x32_bf16 v[76:79], a[180:183], v[52:55], v[76:79]
  v_mfma_f32_16x16x32_bf16 v[88:91], a[184:187], v[52:55], v[88:91]
  buffer_load_dwordx4 v[220:223], v21, s[4:7], s28 offen offset:3072 sc1
  v_mfma_f32_16x16x32_bf16 v[92:95], a[188:191], v[52:55], v[92:95]
  s_waitcnt lgkmcnt(5)
  v_mfma_f32_16x16x32_bf16 v[64:67], a[192:195], v[24:27], v[64:67]
  s_add_u32 s29, s19, 83890176
  ds_read_b128 v[48:51], v14 offset:24576
  v_mfma_f32_16x16x32_bf16 v[68:71], a[196:199], v[24:27], v[68:71]
  v_mfma_f32_16x16x32_bf16 v[80:83], a[200:203], v[24:27], v[80:83]
  v_mfma_f32_16x16x32_bf16 v[84:87], a[204:207], v[24:27], v[84:87]
  s_waitcnt lgkmcnt(5)
  v_mfma_f32_16x16x32_bf16 v[72:75], a[192:195], v[28:31], v[72:75]
  ds_read_b128 v[52:55], v15 offset:24576
  v_mfma_f32_16x16x32_bf16 v[76:79], a[196:199], v[28:31], v[76:79]
  v_mfma_f32_16x16x32_bf16 v[88:91], a[200:203], v[28:31], v[88:91]
  buffer_load_dwordx4 v[224:227], v21, s[4:7], s29 offen offset:0 sc1
  v_mfma_f32_16x16x32_bf16 v[92:95], a[204:207], v[28:31], v[92:95]
  s_waitcnt lgkmcnt(5)
  v_mfma_f32_16x16x32_bf16 v[64:67], a[208:211], v[32:35], v[64:67]
  v_mfma_f32_16x16x32_bf16 v[68:71], a[212:215], v[32:35], v[68:71]
  v_mfma_f32_16x16x32_bf16 v[80:83], a[216:219], v[32:35], v[80:83]
  v_mfma_f32_16x16x32_bf16 v[84:87], a[220:223], v[32:35], v[84:87]
  s_waitcnt lgkmcnt(4)
  v_mfma_f32_16x16x32_bf16 v[72:75], a[208:211], v[36:39], v[72:75]
  v_mfma_f32_16x16x32_bf16 v[76:79], a[212:215], v[36:39], v[76:79]
  v_xor_b32 v8, 0x8000, v8
  v_mfma_f32_16x16x32_bf16 v[88:91], a[216:219], v[36:39], v[88:91]
  buffer_load_dwordx4 v[228:231], v21, s[4:7], s29 offen offset:1024 sc1
  v_mfma_f32_16x16x32_bf16 v[92:95], a[220:223], v[36:39], v[92:95]
  s_waitcnt lgkmcnt(3)
  v_xor_b32 v9, 0x8000, v9
  v_mfma_f32_16x16x32_bf16 v[64:67], a[224:227], v[40:43], v[64:67]
  v_mfma_f32_16x16x32_bf16 v[68:71], a[228:231], v[40:43], v[68:71]
  v_xor_b32 v10, 0x8000, v10
  v_mfma_f32_16x16x32_bf16 v[80:83], a[232:235], v[40:43], v[80:83]
  v_mfma_f32_16x16x32_bf16 v[84:87], a[236:239], v[40:43], v[84:87]
  s_waitcnt lgkmcnt(2)
  v_xor_b32 v11, 0x8000, v11
  v_mfma_f32_16x16x32_bf16 v[72:75], a[224:227], v[44:47], v[72:75]
  v_mfma_f32_16x16x32_bf16 v[76:79], a[228:231], v[44:47], v[76:79]
  v_xor_b32 v12, 0x8000, v12
  v_mfma_f32_16x16x32_bf16 v[88:91], a[232:235], v[44:47], v[88:91]
  buffer_load_dwordx4 v[232:235], v21, s[4:7], s29 offen offset:2048 sc1
  v_mfma_f32_16x16x32_bf16 v[92:95], a[236:239], v[44:47], v[92:95]
  s_waitcnt lgkmcnt(1)
  v_xor_b32 v13, 0x8000, v13
  v_mfma_f32_16x16x32_bf16 v[64:67], a[240:243], v[48:51], v[64:67]
  v_mfma_f32_16x16x32_bf16 v[68:71], a[244:247], v[48:51], v[68:71]
  v_xor_b32 v14, 0x8000, v14
  v_mfma_f32_16x16x32_bf16 v[80:83], a[248:251], v[48:51], v[80:83]
  v_mfma_f32_16x16x32_bf16 v[84:87], a[252:255], v[48:51], v[84:87]
  s_waitcnt lgkmcnt(0)
  v_xor_b32 v15, 0x8000, v15
  v_mfma_f32_16x16x32_bf16 v[72:75], a[240:243], v[52:55], v[72:75]
  v_mfma_f32_16x16x32_bf16 v[76:79], a[244:247], v[52:55], v[76:79]
  v_xor_b32 v3, 0x8000, v3
  v_mfma_f32_16x16x32_bf16 v[88:91], a[248:251], v[52:55], v[88:91]
  buffer_load_dwordx4 v[236:239], v21, s[4:7], s29 offen offset:3072 sc1
  v_mfma_f32_16x16x32_bf16 v[92:95], a[252:255], v[52:55], v[92:95]
  s_cmp_gt_u32 s23, 0
  s_cbranch_scc1 F_top_194
  s_nop 2
  v_cvt_pk_bf16_f32 v128, v64, v65
  v_cvt_pk_bf16_f32 v129, v66, v67
  v_cvt_pk_bf16_f32 v130, v68, v69
  v_cvt_pk_bf16_f32 v131, v70, v71
  buffer_store_dwordx4 v[128:131], v22, s[4:7], s21 offen offset:0 sc1
  v_cvt_pk_bf16_f32 v132, v72, v73
  v_cvt_pk_bf16_f32 v133, v74, v75
  v_cvt_pk_bf16_f32 v134, v76, v77
  v_cvt_pk_bf16_f32 v135, v78, v79
  buffer_store_dwordx4 v[132:135], v22, s[4:7], s21 offen offset:256 sc1
  v_cvt_pk_bf16_f32 v136, v80, v81
  v_cvt_pk_bf16_f32 v137, v82, v83
  v_cvt_pk_bf16_f32 v138, v84, v85
  v_cvt_pk_bf16_f32 v139, v86, v87
  buffer_store_dwordx4 v[136:139], v22, s[4:7], s21 offen offset:2048 sc1
  v_cvt_pk_bf16_f32 v140, v88, v89
  v_cvt_pk_bf16_f32 v141, v90, v91
  v_cvt_pk_bf16_f32 v142, v92, v93
  v_cvt_pk_bf16_f32 v143, v94, v95
  buffer_store_dwordx4 v[140:143], v22, s[4:7], s21 offen offset:2304 sc1
  s_waitcnt vmcnt(0) lgkmcnt(0)
  s_barrier
  v_mov_b32 v144, s30
  v_min_u32 v145, 1, v0
  v_lshlrev_b32 v145, 30, v145
  buffer_store_dword v144, v145, s[4:7], s31 offen sc1
M_done:
M_exit:
  s_endpgm
.p2align 6
.type M_table,@object
M_table:
.long 0x1, 0x3f, 0xffffffff, 0x17, 0x1, 0x7, 0x800, 0x0, 0x8, 0x0, 0x0, 0x0, 0x0, 0x0, 0x0, 0x0
.long 0x1, 0x28, 0xffffffff, 0x1b, 0x1, 0x6, 0x1000, 0x0, 0x8, 0x1, 0x0, 0x0, 0x0, 0x0, 0x0, 0x0
.long 0x2, 0x0, 0x2, 0x20, 0x1, 0x5, 0x1800, 0x0, 0x8, 0x0, 0x0, 0x0, 0x0, 0x0, 0x0, 0x0
.long 0x2, 0x1, 0x2, 0x20, 0x1, 0x4, 0x2000, 0x0, 0x8, 0x1, 0x0, 0x0, 0x0, 0x0, 0x0, 0x0
.long 0x0, 0x0, 0x1, 0x20, 0x2, 0x3, 0x20, 0x0, 0x8, 0x2, 0x0, 0x0, 0x0, 0x0, 0x0, 0x0
.long 0x0, 0x3f, 0xffffffff, 0x20, 0x2, 0x2, 0x18, 0x1, 0x10, 0x0, 0x0, 0x0, 0x0, 0x0, 0x0, 0x0
.long 0x1, 0xd, 0xffffffff, 0xe, 0x0, 0x0, 0x8, 0x0, 0x8, 0x2, 0x0, 0x0, 0x0, 0x0, 0x0, 0x0
.size M_table, 448
.section .rodata,"a"
.p2align 6
.amdhsa_kernel gated_mix__compressed_kv_cla__memory_aug_recurrent_mem_tr__prompt_kernel
.amdhsa_next_free_vgpr 512
.amdhsa_next_free_sgpr 102
.amdhsa_accum_offset 256
.amdhsa_group_segment_fixed_size 0
.amdhsa_kernarg_size 136
.amdhsa_user_sgpr_count 2
.amdhsa_user_sgpr_kernarg_segment_ptr 1
.amdhsa_system_sgpr_workgroup_id_x 1
.end_amdhsa_kernel
```

```asm
; @launch grid=(256,1,1) block=(256,1,1) lds=163840
.amdgcn_target "amdgcn-amd-amdhsa--gfx950"
.text
.globl gated_mix__compressed_kv_cla__memory_aug_recurrent_mem_tr__prompt_kernel
.p2align 8
.type gated_mix__compressed_kv_cla__memory_aug_recurrent_mem_tr__prompt_kernel,@function
gated_mix__compressed_kv_cla__memory_aug_recurrent_mem_tr__prompt_kernel:
  s_cmp_ge_u32 s2, 256
  s_cbranch_scc1 M_exit
  s_getpc_b64 s[60:61]
M_pc0:
  s_lshr_b32 s62, s2, 3
  s_and_b32 s62, s62, 3
  s_lshl_b32 s62, s62, 15
  v_lshl_add_u32 v104, v0, 7, s62
  v_min_u32 v104, M_table-M_pc0, v104
  global_load_dword v105, v104, s[60:61]
  s_lshr_b32 s77, s2, 3
  s_and_b32 s76, s2, 7
  s_cbranch_scc1 M_worker
  s_mov_b32 s12, s77
  s_load_dwordx4 s[60:63], s[0:1], 64
  s_load_dwordx4 s[64:67], s[0:1], 80
  s_load_dwordx4 s[68:71], s[0:1], 120
  s_load_dwordx2 s[72:73], s[0:1], 56
  v_lshrrev_b32 v1, 6, v0
  v_and_b32 v20, 63, v0
  v_readfirstlane_b32 s13, v1
  v_lshrrev_b32 v26, 3, v20
  v_lshlrev_b32 v26, 10, v26
  v_and_b32 v1, 7, v20
  v_lshl_add_u32 v26, v1, 4, v26
  s_lshl_b32 s36, s13, 7
  s_lshl_b32 s38, s12, 17
  s_add_u32 s36, s36, s38
  v_add_u32 v26, s36, v26
  s_lshl_b32 s39, s13, 15
  s_add_u32 s39, s39, 32768
  s_waitcnt lgkmcnt(0)
  s_mov_b32 s48, s66
  s_and_b32 s49, s67, 0xffff
  s_mov_b32 s50, 0x400000
  s_mov_b32 s51, 0x20000
  s_xor_b32 s36, s13, 0
  s_lshl_b32 s36, s36, 15
  s_add_u32 m0, s39, 28672
  s_add_u32 s37, s36, 0
  buffer_load_dwordx4 v26, s[48:51], s37 offen lds
  s_add_u32 m0, s39, 29696
  s_add_u32 s37, s36, 8192
  buffer_load_dwordx4 v26, s[48:51], s37 offen lds
  s_add_u32 m0, s39, 30720
  s_add_u32 s37, s36, 16384
  buffer_load_dwordx4 v26, s[48:51], s37 offen lds
  s_add_u32 m0, s39, 31744
  s_add_u32 s37, s36, 24576
  buffer_load_dwordx4 v26, s[48:51], s37 offen lds
  s_xor_b32 s36, s13, 0
  s_lshl_b32 s36, s36, 15
  s_add_u32 m0, s39, 24576
  s_add_u32 s37, s36, 512
  buffer_load_dwordx4 v26, s[48:51], s37 offen lds
  s_add_u32 m0, s39, 25600
  s_add_u32 s37, s36, 8704
  buffer_load_dwordx4 v26, s[48:51], s37 offen lds
  s_add_u32 m0, s39, 26624
  s_add_u32 s37, s36, 16896
  buffer_load_dwordx4 v26, s[48:51], s37 offen lds
  s_add_u32 m0, s39, 27648
  s_add_u32 s37, s36, 25088
  buffer_load_dwordx4 v26, s[48:51], s37 offen lds
  s_xor_b32 s36, s13, 1
  s_lshl_b32 s36, s36, 15
  s_add_u32 m0, s39, 12288
  s_add_u32 s37, s36, 0
  buffer_load_dwordx4 v26, s[48:51], s37 offen lds
  s_add_u32 m0, s39, 13312
  s_add_u32 s37, s36, 8192
  buffer_load_dwordx4 v26, s[48:51], s37 offen lds
  s_add_u32 m0, s39, 14336
  s_add_u32 s37, s36, 16384
  buffer_load_dwordx4 v26, s[48:51], s37 offen lds
  s_add_u32 m0, s39, 15360
  s_add_u32 s37, s36, 24576
  buffer_load_dwordx4 v26, s[48:51], s37 offen lds
  s_xor_b32 s36, s13, 1
  s_lshl_b32 s36, s36, 15
  s_add_u32 m0, s39, 8192
  s_add_u32 s37, s36, 512
  buffer_load_dwordx4 v26, s[48:51], s37 offen lds
  s_add_u32 m0, s39, 9216
  s_add_u32 s37, s36, 8704
  buffer_load_dwordx4 v26, s[48:51], s37 offen lds
  s_add_u32 m0, s39, 10240
  s_add_u32 s37, s36, 16896
  buffer_load_dwordx4 v26, s[48:51], s37 offen lds
  s_add_u32 m0, s39, 11264
  s_add_u32 s37, s36, 25088
  buffer_load_dwordx4 v26, s[48:51], s37 offen lds
  s_mov_b32 s8, s60
  s_and_b32 s9, s61, 0xffff
  s_mov_b32 s10, 0x400000
  s_mov_b32 s11, 0x20000
  s_mov_b32 s40, s62
  s_and_b32 s41, s63, 0xffff
  s_mov_b32 s42, 0x400000
  s_mov_b32 s43, 0x20000
  s_mov_b32 s44, s64
  s_and_b32 s45, s65, 0xffff
  s_mov_b32 s46, 0x400000
  s_mov_b32 s47, 0x20000
  s_mov_b32 s4, s70
  s_and_b32 s5, s71, 0xffff
  s_mov_b32 s6, 0x10000000
  s_mov_b32 s7, 0x20000
  s_mov_b32 s76, s72
  s_and_b32 s77, s73, 0xffff
  s_mov_b32 s78, 0x2000
  s_mov_b32 s79, 0x20000
  s_mov_b32 s72, s68
  s_and_b32 s73, s69, 0xffff
  s_mov_b32 s74, 0x100
  s_mov_b32 s75, 0x20000
  s_mov_b64 s[52:53], s[68:69]
  s_mov_b64 s[58:59], s[70:71]
  s_mul_i32 s99, s12, 896
  s_add_u32 s99, s99, 148898048
  s_lshl_b32 s15, s12, 7
  s_add_u32 s15, s15, 148926464
  v_lshrrev_b32 v21, 4, v20
  v_and_b32 v22, 15, v20
  v_and_b32 v23, 1, v21
  v_lshrrev_b32 v24, 1, v21
  v_lshlrev_b32 v2, 4, v20
  s_lshl_b32 s36, s13, 10
  v_add_u32 v59, s36, v2
  s_mov_b32 s37, s39
  v_add_u32 v4, s37, v2
  v_lshrrev_b32 v25, 2, v20
  v_lshlrev_b32 v25, 13, v25
  v_and_b32 v1, 3, v20
  v_lshl_add_u32 v25, v1, 4, v25
  s_lshl_b32 s36, s13, 6
  s_lshl_b32 s38, s12, 8
  s_add_u32 s36, s36, s38
  v_add_u32 v25, s36, v25
  v_bfe_u32 v29, v20, 2, 1
  v_bfe_u32 v30, v20, 3, 1
  v_and_b32 v31, 3, v20
  v_lshl_add_u32 v27, v21, 2, v29
  v_lshlrev_b32 v27, 6, v27
  v_lshl_add_u32 v27, v30, 5, v27
  v_lshl_add_u32 v27, v31, 3, v27
  v_add_u32 v27, s37, v27
  v_xor_b32 v36, 1, v30
  v_lshl_add_u32 v36, v36, 11, v27
  v_lshl_add_u32 v27, v30, 11, v27
  v_lshl_add_u32 v28, v23, 2, v24
  v_lshl_add_u32 v28, v28, 2, v29
  v_lshlrev_b32 v28, 7, v28
  v_lshl_add_u32 v28, v30, 6, v28
  v_lshl_add_u32 v28, v31, 4, v28
  v_add_u32 v28, s37, v28
  v_lshrrev_b32 v25, 3, v20
  v_lshlrev_b32 v25, 13, v25
  v_and_b32 v1, 7, v20
  v_lshl_add_u32 v25, v1, 4, v25
  s_lshr_b32 s36, s13, 1
  s_lshl1_add_u32 s36, s12, s36
  s_lshl_b32 s36, s36, 7
  v_add_u32 v25, s36, v25
  v_lshl_add_u32 v27, v21, 2, v29
  v_lshlrev_b32 v27, 7, v27
  v_lshl_add_u32 v27, v30, 5, v27
  v_lshl_add_u32 v27, v31, 3, v27
  s_and_b32 s36, s13, 1
  s_lshl_b32 s36, s36, 6
  s_xor_b32 s37, s13, 1
  s_lshl_b32 s37, s37, 15
  s_add_u32 s37, s37, s36
  s_add_u32 s37, s37, 32768
  s_add_u32 s36, s36, s39
  v_add_u32 v36, s37, v27
  v_add_u32 v27, s36, v27
  v_lshlrev_b32 v101, 12, v30
  v_xor_b32 v100, 0x1000, v101
  v_mov_b32 v0, 0x4444
  v_mov_b32 v1, 0xeeee
  v_cmp_lt_u32 vcc, 7, v22
  s_nop 1
  v_cndmask_b32 v32, v0, v1, vcc
  v_mov_b32 v0, v32
  v_and_b32 v32, 7, v20
  v_lshlrev_b32 v32, 4, v32
  v_lshl_add_u32 v11, v21, 7, v32
  v_xor_b32 v1, 128, v2
  v_lshl_add_u32 v33, v24, 4, v22
  s_lshl_b32 s36, s13, 5
  v_add_u32 v33, s36, v33
  v_lshlrev_b32 v33, 3, v33
  v_mul_u32_u24 v34, 1152, v23
  v_add_u32 v5, v33, v34
  v_bfe_u32 v33, v20, 2, 2
  v_lshl_add_u32 v33, v23, 2, v33
  v_lshl_add_u32 v33, v24, 4, v33
  v_lshlrev_b32 v33, 3, v33
  v_and_b32 v34, 1, v20
  v_mul_u32_u24 v34, 1152, v34
  v_add_u32 v6, v33, v34
  s_lshl_b32 s36, s13, 3
  v_lshrrev_b32 v33, 3, v20
  v_add_u32 v33, s36, v33
  v_mul_u32_u24 v34, 0, v33
  v_add_u32 v34, s12, v34
  v_and_b32 v34, 31, v34
  v_lshrrev_b32 v37, 1, v32
  v_lshl_add_u32 v33, v33, 13, v37
  v_lshl_add_u32 v7, v34, 7, v33
  v_and_b32 v37, 1, v20
  v_bfe_u32 v38, v20, 1, 1
  v_lshl_add_u32 v37, v29, 1, v37
  s_lshr_b32 s36, s12, 3
  s_lshl_b32 s36, s36, 10
  s_and_b32 s37, s12, 1
  s_lshl_b32 s37, s37, 9
  s_add_u32 s36, s36, s37
  s_and_b32 s37, s12, 6
  s_lshl_b32 s37, s37, 5
  s_add_u32 s36, s36, s37
  v_lshlrev_b32 v33, 4, v21
  v_lshl_add_u32 v33, v37, 2, v33
  v_lshl_add_u32 v33, v38, 8, v33
  v_lshl_add_u32 v33, v30, 30, v33
  v_add_u32 v8, s36, v33
  v_mov_b32 v39, v21
  s_lshr_b32 s36, s12, 2
  s_lshl_b32 s36, s36, 6
  s_and_b32 s37, s12, 1
  s_lshl_b32 s37, s37, 5
  s_add_u32 s36, s36, s37
  s_and_b32 s37, s12, 2
  s_lshl_b32 s37, s37, 11
  s_add_u32 s36, s36, s37
  v_lshlrev_b32 v35, 10, v39
  v_lshl_add_u32 v35, v37, 2, v35
  v_lshl_add_u32 v35, v38, 4, v35
  v_add_u32 v35, s36, v35
  buffer_load_ushort v44, v35, s[76:79], 0 offen offset:0
  buffer_load_ushort v45, v35, s[76:79], 0 offen offset:2
  buffer_load_ushort v46, v35, s[76:79], 0 offen offset:512
  buffer_load_ushort v47, v35, s[76:79], 0 offen offset:514
  v_lshlrev_b32 v33, 4, v29
  v_mov_b32 v34, 0x3f80
  v_lshlrev_b32 v33, v33, v34
  v_and_b32 v34, 1, v20
  v_lshl_add_u32 v34, v34, 1, v30
  v_cmp_eq_u32 vcc, 0, v34
  s_nop 1
  v_cndmask_b32 v48, 0, v33, vcc
  v_cmp_eq_u32 vcc, 1, v34
  s_nop 1
  v_cndmask_b32 v49, 0, v33, vcc
  v_cmp_eq_u32 vcc, 2, v34
  s_nop 1
  v_cndmask_b32 v50, 0, v33, vcc
  v_cmp_eq_u32 vcc, 3, v34
  s_nop 1
  v_cndmask_b32 v51, 0, v33, vcc
  ds_write_b128 v2, v[48:51] offset:31232
  v_lshlrev_b32 v33, 9, v21
  s_lshl_b32 s36, s13, 11
  v_add_u32 v33, s36, v33
  v_lshl_add_u32 v10, v22, 4, v33
  v_lshl_add_u32 v33, v30, 8, v33
  v_add_u32 v9, v33, v32
  v_mov_b32 v12, 0x3f803f80
  v_mov_b32 v13, 0x3f803f80
  v_mov_b32 v14, 0x3f803f80
  v_mov_b32 v15, 0x3f803f80
  s_mov_b32 s2, 0x3f803f80
  s_mov_b32 s3, 0x3f803f80
  s_mov_b32 s98, 0
  v_and_b32 v33, 1, v20
  v_mul_u32_u24 v33, 128, v33
  v_min_u32 v34, 1, v20
  v_lshlrev_b32 v34, 30, v34
  s_cmp_eq_u32 s13, 3
  s_cselect_b64 vcc, -1, 0
  v_cndmask_b32 v19, v34, v33, vcc
  v_mov_b64 v[60:61], 0
  v_mov_b32 v62, 32256
  ds_write_b64 v62, v[60:61]
  s_mov_b32 s16, 0
  s_mov_b32 s17, -1
  s_mov_b32 s18, 0x3e0293ee
  s_mov_b32 s54, 0x2f800000
  s_mov_b32 s55, 0x28000000
  s_lshl_b32 s36, s13, 10
  s_add_u32 s31, s36, 8192
  s_add_u32 s32, s36, 12160
  s_add_u32 s33, s36, 16384
  s_add_u32 s34, s36, 20224
  s_lshl_b32 s36, s12, 19
  s_add_u32 s27, s36, 67108864
  s_add_u32 s28, s36, 83886080
  s_mul_i32 s36, s12, 4096
  s_add_u32 s29, s36, 135266304
  s_lshl_b32 s36, s12, 13
  s_add_u32 s22, s36, 144703488
  s_add_u32 s23, s36, 144707584
  s_mov_b32 s20, 144703488
  s_mov_b32 s21, 144707584
  v_mov_b32 v40, -1
  v_mov_b32 v41, -1
  v_mov_b32 v42, -1
  v_mov_b32 v43, -1
  s_lshl_b32 s36, s13, 13
  s_add_u32 s36, s36, 145752064
  s_add_u32 s37, s36, 4096
  buffer_store_dwordx4 v[40:43], v59, s[4:7], s22 offen sc1
  buffer_store_dwordx4 v[40:43], v59, s[4:7], s23 offen sc1
  buffer_store_dword v40, v8, s[4:7], s36 offen sc1
  buffer_store_dword v40, v8, s[4:7], s37 offen sc1
  v_mov_b32 v52, 0
  v_min_u32 v53, 1, v59
  v_lshlrev_b32 v53, 30, v53
  buffer_store_dword v52, v53, s[4:7], s15 offen sc1
  s_waitcnt vmcnt(21)
  ds_read_b64_tr_b16 a[160:161], v28 offset:28672
  ds_read_b64_tr_b16 a[162:163], v28 offset:28928
  ds_read_b64_tr_b16 a[164:165], v28 offset:29696
  ds_read_b64_tr_b16 a[166:167], v28 offset:29952
  ds_read_b64_tr_b16 a[168:169], v28 offset:28680
  ds_read_b64_tr_b16 a[170:171], v28 offset:28936
  ds_read_b64_tr_b16 a[172:173], v28 offset:29704
  ds_read_b64_tr_b16 a[174:175], v28 offset:29960
  s_waitcnt lgkmcnt(0)
  s_waitcnt vmcnt(17)
  ds_read_b64_tr_b16 a[176:177], v28 offset:24576
  ds_read_b64_tr_b16 a[178:179], v28 offset:24832
  ds_read_b64_tr_b16 a[180:181], v28 offset:25600
  ds_read_b64_tr_b16 a[182:183], v28 offset:25856
  ds_read_b64_tr_b16 a[184:185], v28 offset:24584
  ds_read_b64_tr_b16 a[186:187], v28 offset:24840
  ds_read_b64_tr_b16 a[188:189], v28 offset:25608
  ds_read_b64_tr_b16 a[190:191], v28 offset:25864
  s_waitcnt lgkmcnt(0)
  s_xor_b32 s36, s13, 2
  s_lshl_b32 s36, s36, 15
  s_add_u32 m0, s39, 28672
  s_add_u32 s37, s36, 0
  buffer_load_dwordx4 v26, s[48:51], s37 offen lds
  s_add_u32 m0, s39, 29696
  s_add_u32 s37, s36, 8192
  buffer_load_dwordx4 v26, s[48:51], s37 offen lds
  s_add_u32 m0, s39, 30720
  s_add_u32 s37, s36, 16384
  buffer_load_dwordx4 v26, s[48:51], s37 offen lds
  s_add_u32 m0, s39, 31744
  s_add_u32 s37, s36, 24576
  buffer_load_dwordx4 v26, s[48:51], s37 offen lds
  s_xor_b32 s36, s13, 3
  s_lshl_b32 s36, s36, 15
  s_add_u32 m0, s39, 24576
  s_add_u32 s37, s36, 0
  buffer_load_dwordx4 v26, s[48:51], s37 offen lds
  s_add_u32 m0, s39, 25600
  s_add_u32 s37, s36, 8192
  buffer_load_dwordx4 v26, s[48:51], s37 offen lds
  s_add_u32 m0, s39, 26624
  s_add_u32 s37, s36, 16384
  buffer_load_dwordx4 v26, s[48:51], s37 offen lds
  s_add_u32 m0, s39, 27648
  s_add_u32 s37, s36, 24576
  buffer_load_dwordx4 v26, s[48:51], s37 offen lds
  s_waitcnt vmcnt(21)
  ds_read_b64_tr_b16 a[192:193], v28 offset:12288
  ds_read_b64_tr_b16 a[194:195], v28 offset:12544
  ds_read_b64_tr_b16 a[196:197], v28 offset:13312
  ds_read_b64_tr_b16 a[198:199], v28 offset:13568
  ds_read_b64_tr_b16 a[200:201], v28 offset:12296
  ds_read_b64_tr_b16 a[202:203], v28 offset:12552
  ds_read_b64_tr_b16 a[204:205], v28 offset:13320
  ds_read_b64_tr_b16 a[206:207], v28 offset:13576
  s_waitcnt lgkmcnt(0)
  s_waitcnt vmcnt(17)
  ds_read_b64_tr_b16 a[208:209], v28 offset:8192
  ds_read_b64_tr_b16 a[210:211], v28 offset:8448
  ds_read_b64_tr_b16 a[212:213], v28 offset:9216
  ds_read_b64_tr_b16 a[214:215], v28 offset:9472
  ds_read_b64_tr_b16 a[216:217], v28 offset:8200
  ds_read_b64_tr_b16 a[218:219], v28 offset:8456
  ds_read_b64_tr_b16 a[220:221], v28 offset:9224
  ds_read_b64_tr_b16 a[222:223], v28 offset:9480
  s_waitcnt lgkmcnt(0)
  s_xor_b32 s36, s13, 2
  s_lshl_b32 s36, s36, 19
  s_add_u32 m0, s39, 12288
  s_add_u32 s37, s36, 0
  buffer_load_dwordx4 v25, s[8:11], s37 offen lds
  s_add_u32 m0, s39, 13312
  s_add_u32 s37, s36, 65536
  buffer_load_dwordx4 v25, s[8:11], s37 offen lds
  s_add_u32 m0, s39, 14336
  s_add_u32 s37, s36, 131072
  buffer_load_dwordx4 v25, s[8:11], s37 offen lds
  s_add_u32 m0, s39, 15360
  s_add_u32 s37, s36, 196608
  buffer_load_dwordx4 v25, s[8:11], s37 offen lds
  s_xor_b32 s36, s13, 2
  s_lshl_b32 s36, s36, 19
  s_add_u32 m0, s39, 8192
  s_add_u32 s37, s36, 262144
  buffer_load_dwordx4 v25, s[8:11], s37 offen lds
  s_add_u32 m0, s39, 9216
  s_add_u32 s37, s36, 327680
  buffer_load_dwordx4 v25, s[8:11], s37 offen lds
  s_add_u32 m0, s39, 10240
  s_add_u32 s37, s36, 393216
  buffer_load_dwordx4 v25, s[8:11], s37 offen lds
  s_add_u32 m0, s39, 11264
  s_add_u32 s37, s36, 458752
  buffer_load_dwordx4 v25, s[8:11], s37 offen lds
  s_waitcnt vmcnt(12)
  ds_read_b64_tr_b16 a[224:225], v28 offset:28672
  ds_read_b64_tr_b16 a[226:227], v28 offset:28928
  ds_read_b64_tr_b16 a[228:229], v28 offset:29696
  ds_read_b64_tr_b16 a[230:231], v28 offset:29952
  ds_read_b64_tr_b16 a[232:233], v28 offset:28680
  ds_read_b64_tr_b16 a[234:235], v28 offset:28936
  ds_read_b64_tr_b16 a[236:237], v28 offset:29704
  ds_read_b64_tr_b16 a[238:239], v28 offset:29960
  s_waitcnt lgkmcnt(0)
  s_waitcnt vmcnt(8)
  ds_read_b64_tr_b16 a[240:241], v28 offset:24576
  ds_read_b64_tr_b16 a[242:243], v28 offset:24832
  ds_read_b64_tr_b16 a[244:245], v28 offset:25600
  ds_read_b64_tr_b16 a[246:247], v28 offset:25856
  ds_read_b64_tr_b16 a[248:249], v28 offset:24584
  ds_read_b64_tr_b16 a[250:251], v28 offset:24840
  ds_read_b64_tr_b16 a[252:253], v28 offset:25608
  ds_read_b64_tr_b16 a[254:255], v28 offset:25864
  s_waitcnt lgkmcnt(0)
  s_xor_b32 s36, s13, 4
  s_lshl_b32 s36, s36, 19
  s_add_u32 m0, s39, 28672
  s_add_u32 s37, s36, 0
  buffer_load_dwordx4 v25, s[8:11], s37 offen lds
  s_add_u32 m0, s39, 29696
  s_add_u32 s37, s36, 65536
  buffer_load_dwordx4 v25, s[8:11], s37 offen lds
  s_add_u32 m0, s39, 30720
  s_add_u32 s37, s36, 131072
  buffer_load_dwordx4 v25, s[8:11], s37 offen lds
  s_add_u32 m0, s39, 31744
  s_add_u32 s37, s36, 196608
  buffer_load_dwordx4 v25, s[8:11], s37 offen lds
  s_xor_b32 s36, s13, 4
  s_lshl_b32 s36, s36, 19
  s_add_u32 m0, s39, 24576
  s_add_u32 s37, s36, 262144
  buffer_load_dwordx4 v25, s[8:11], s37 offen lds
  s_add_u32 m0, s39, 25600
  s_add_u32 s37, s36, 327680
  buffer_load_dwordx4 v25, s[8:11], s37 offen lds
  s_add_u32 m0, s39, 26624
  s_add_u32 s37, s36, 393216
  buffer_load_dwordx4 v25, s[8:11], s37 offen lds
  s_add_u32 m0, s39, 27648
  s_add_u32 s37, s36, 458752
  buffer_load_dwordx4 v25, s[8:11], s37 offen lds
  s_barrier
  s_cmp_lg_u32 s13, 0
  s_cbranch_scc1 T_arm_1
  s_getreg_b32 s36, hwreg(HW_REG_XCC_ID, 0, 3)
  s_lshl_b32 s36, s36, 3
  s_lshl_b64 s[60:61], 1, s36
  s_mov_b32 s62, 1
  s_atomic_add_x2 s[60:61], s[52:53], 0
  s_atomic_add s62, s[52:53], 128
  v_lshl_or_b32 v44, v45, 16, v44
  v_lshl_or_b32 v46, v47, 16, v46
  v_min_u32 v44, -2, v44
  v_min_u32 v46, -2, v46
  s_mov_b32 s36, 145752064
  s_mov_b32 s37, 145756160
  buffer_store_dword v44, v8, s[4:7], s36 offen sc1
  buffer_store_dword v46, v8, s[4:7], s37 offen sc1
T_arm_1:
  v_mad_u32_u24 v96, v100, 1, v27
  v_mad_u32_u24 v97, v101, 1, v27
  v_mad_u32_u24 v98, v100, 1, v36
  v_mad_u32_u24 v99, v101, 1, v36
  s_waitcnt vmcnt(8)
  s_barrier
  ds_read_b64_tr_b16 v[160:161], v96 offset:8192
  ds_read_b64_tr_b16 v[162:163], v96 offset:8448
  ds_read_b64_tr_b16 v[164:165], v96 offset:10240
  ds_read_b64_tr_b16 v[166:167], v96 offset:10496
  ds_read_b64_tr_b16 v[168:169], v97 offset:8192
  ds_read_b64_tr_b16 v[170:171], v97 offset:8448
  ds_read_b64_tr_b16 v[172:173], v97 offset:10240
  ds_read_b64_tr_b16 v[174:175], v97 offset:10496
  ds_read_b64_tr_b16 v[192:193], v98 offset:8192
  ds_read_b64_tr_b16 v[194:195], v98 offset:8448
  ds_read_b64_tr_b16 v[196:197], v98 offset:10240
  ds_read_b64_tr_b16 v[198:199], v98 offset:10496
  ds_read_b64_tr_b16 v[200:201], v99 offset:8192
  ds_read_b64_tr_b16 v[202:203], v99 offset:8448
  ds_read_b64_tr_b16 v[204:205], v99 offset:10240
  ds_read_b64_tr_b16 v[206:207], v99 offset:10496
  s_waitcnt lgkmcnt(0)
  s_barrier
  s_xor_b32 s36, s13, 4
  s_lshl_b32 s36, s36, 19
  s_add_u32 m0, s39, 12288
  s_add_u32 s37, s36, 0
  buffer_load_dwordx4 v25, s[40:43], s37 offen lds
  s_add_u32 m0, s39, 13312
  s_add_u32 s37, s36, 65536
  buffer_load_dwordx4 v25, s[40:43], s37 offen lds
  s_add_u32 m0, s39, 14336
  s_add_u32 s37, s36, 131072
  buffer_load_dwordx4 v25, s[40:43], s37 offen lds
  s_add_u32 m0, s39, 15360
  s_add_u32 s37, s36, 196608
  buffer_load_dwordx4 v25, s[40:43], s37 offen lds
  s_xor_b32 s36, s13, 4
  s_lshl_b32 s36, s36, 19
  s_add_u32 m0, s39, 8192
  s_add_u32 s37, s36, 262144
  buffer_load_dwordx4 v25, s[40:43], s37 offen lds
  s_add_u32 m0, s39, 9216
  s_add_u32 s37, s36, 327680
  buffer_load_dwordx4 v25, s[40:43], s37 offen lds
  s_add_u32 m0, s39, 10240
  s_add_u32 s37, s36, 393216
  buffer_load_dwordx4 v25, s[40:43], s37 offen lds
  s_add_u32 m0, s39, 11264
  s_add_u32 s37, s36, 458752
  buffer_load_dwordx4 v25, s[40:43], s37 offen lds
  v_mad_u32_u24 v96, v100, 1, v27
  v_mad_u32_u24 v97, v101, 1, v27
  v_mad_u32_u24 v98, v100, 1, v36
  v_mad_u32_u24 v99, v101, 1, v36
  s_waitcnt vmcnt(8)
  s_barrier
  ds_read_b64_tr_b16 v[224:225], v96 offset:24576
  ds_read_b64_tr_b16 v[226:227], v96 offset:24832
  ds_read_b64_tr_b16 v[228:229], v96 offset:26624
  ds_read_b64_tr_b16 v[230:231], v96 offset:26880
  ds_read_b64_tr_b16 v[232:233], v97 offset:24576
  ds_read_b64_tr_b16 v[234:235], v97 offset:24832
  ds_read_b64_tr_b16 v[236:237], v97 offset:26624
  ds_read_b64_tr_b16 v[238:239], v97 offset:26880
  ds_read_b64_tr_b16 a[16:17], v98 offset:24576
  ds_read_b64_tr_b16 a[18:19], v98 offset:24832
  ds_read_b64_tr_b16 a[20:21], v98 offset:26624
  ds_read_b64_tr_b16 a[22:23], v98 offset:26880
  ds_read_b64_tr_b16 a[24:25], v99 offset:24576
  ds_read_b64_tr_b16 a[26:27], v99 offset:24832
  ds_read_b64_tr_b16 a[28:29], v99 offset:26624
  ds_read_b64_tr_b16 a[30:31], v99 offset:26880
  s_waitcnt lgkmcnt(0)
  s_barrier
  s_xor_b32 s36, s13, 4
  s_lshl_b32 s36, s36, 19
  s_add_u32 m0, s39, 28672
  s_add_u32 s37, s36, 0
  buffer_load_dwordx4 v25, s[44:47], s37 offen lds
  s_add_u32 m0, s39, 29696
  s_add_u32 s37, s36, 65536
  buffer_load_dwordx4 v25, s[44:47], s37 offen lds
  s_add_u32 m0, s39, 30720
  s_add_u32 s37, s36, 131072
  buffer_load_dwordx4 v25, s[44:47], s37 offen lds
  s_add_u32 m0, s39, 31744
  s_add_u32 s37, s36, 196608
  buffer_load_dwordx4 v25, s[44:47], s37 offen lds
  s_xor_b32 s36, s13, 4
  s_lshl_b32 s36, s36, 19
  s_add_u32 m0, s39, 24576
  s_add_u32 s37, s36, 262144
  buffer_load_dwordx4 v25, s[44:47], s37 offen lds
  s_add_u32 m0, s39, 25600
  s_add_u32 s37, s36, 327680
  buffer_load_dwordx4 v25, s[44:47], s37 offen lds
  s_add_u32 m0, s39, 26624
  s_add_u32 s37, s36, 393216
  buffer_load_dwordx4 v25, s[44:47], s37 offen lds
  s_add_u32 m0, s39, 27648
  s_add_u32 s37, s36, 458752
  buffer_load_dwordx4 v25, s[44:47], s37 offen lds
  v_mad_u32_u24 v96, v100, 1, v27
  v_mad_u32_u24 v97, v101, 1, v27
  v_mad_u32_u24 v98, v100, 1, v36
  v_mad_u32_u24 v99, v101, 1, v36
  s_waitcnt vmcnt(8)
  s_barrier
  ds_read_b64_tr_b16 v[240:241], v96 offset:8192
  ds_read_b64_tr_b16 v[242:243], v96 offset:8448
  ds_read_b64_tr_b16 v[244:245], v96 offset:10240
  ds_read_b64_tr_b16 v[246:247], v96 offset:10496
  ds_read_b64_tr_b16 v[248:249], v97 offset:8192
  ds_read_b64_tr_b16 v[250:251], v97 offset:8448
  ds_read_b64_tr_b16 v[252:253], v97 offset:10240
  ds_read_b64_tr_b16 v[254:255], v97 offset:10496
  ds_read_b64_tr_b16 a[32:33], v98 offset:8192
  ds_read_b64_tr_b16 a[34:35], v98 offset:8448
  ds_read_b64_tr_b16 a[36:37], v98 offset:10240
  ds_read_b64_tr_b16 a[38:39], v98 offset:10496
  ds_read_b64_tr_b16 a[40:41], v99 offset:8192
  ds_read_b64_tr_b16 a[42:43], v99 offset:8448
  ds_read_b64_tr_b16 a[44:45], v99 offset:10240
  ds_read_b64_tr_b16 a[46:47], v99 offset:10496
  s_waitcnt lgkmcnt(0)
  s_barrier
  s_xor_b32 s36, s13, 6
  s_lshl_b32 s36, s36, 19
  s_add_u32 m0, s39, 12288
  s_add_u32 s37, s36, 0
  buffer_load_dwordx4 v25, s[8:11], s37 offen lds
  s_add_u32 m0, s39, 13312
  s_add_u32 s37, s36, 65536
  buffer_load_dwordx4 v25, s[8:11], s37 offen lds
  s_add_u32 m0, s39, 14336
  s_add_u32 s37, s36, 131072
  buffer_load_dwordx4 v25, s[8:11], s37 offen lds
  s_add_u32 m0, s39, 15360
  s_add_u32 s37, s36, 196608
  buffer_load_dwordx4 v25, s[8:11], s37 offen lds
  s_xor_b32 s36, s13, 6
  s_lshl_b32 s36, s36, 19
  s_add_u32 m0, s39, 8192
  s_add_u32 s37, s36, 262144
  buffer_load_dwordx4 v25, s[8:11], s37 offen lds
  s_add_u32 m0, s39, 9216
  s_add_u32 s37, s36, 327680
  buffer_load_dwordx4 v25, s[8:11], s37 offen lds
  s_add_u32 m0, s39, 10240
  s_add_u32 s37, s36, 393216
  buffer_load_dwordx4 v25, s[8:11], s37 offen lds
  s_add_u32 m0, s39, 11264
  s_add_u32 s37, s36, 458752
  buffer_load_dwordx4 v25, s[8:11], s37 offen lds
  v_mad_u32_u24 v96, v100, 1, v27
  v_mad_u32_u24 v97, v101, 1, v27
  v_mad_u32_u24 v98, v100, 1, v36
  v_mad_u32_u24 v99, v101, 1, v36
  s_waitcnt vmcnt(8)
  s_barrier
  ds_read_b64_tr_b16 a[0:1], v96 offset:24576
  ds_read_b64_tr_b16 a[2:3], v96 offset:24832
  ds_read_b64_tr_b16 a[4:5], v96 offset:26624
  ds_read_b64_tr_b16 a[6:7], v96 offset:26880
  ds_read_b64_tr_b16 a[8:9], v97 offset:24576
  ds_read_b64_tr_b16 a[10:11], v97 offset:24832
  ds_read_b64_tr_b16 a[12:13], v97 offset:26624
  ds_read_b64_tr_b16 a[14:15], v97 offset:26880
  ds_read_b64_tr_b16 a[48:49], v98 offset:24576
  ds_read_b64_tr_b16 a[50:51], v98 offset:24832
  ds_read_b64_tr_b16 a[52:53], v98 offset:26624
  ds_read_b64_tr_b16 a[54:55], v98 offset:26880
  ds_read_b64_tr_b16 a[56:57], v99 offset:24576
  ds_read_b64_tr_b16 a[58:59], v99 offset:24832
  ds_read_b64_tr_b16 a[60:61], v99 offset:26624
  ds_read_b64_tr_b16 a[62:63], v99 offset:26880
  s_waitcnt lgkmcnt(0)
  s_barrier
  s_xor_b32 s36, s13, 6
  s_lshl_b32 s36, s36, 19
  s_add_u32 m0, s39, 28672
  s_add_u32 s37, s36, 0
  buffer_load_dwordx4 v25, s[40:43], s37 offen lds
  s_add_u32 m0, s39, 29696
  s_add_u32 s37, s36, 65536
  buffer_load_dwordx4 v25, s[40:43], s37 offen lds
  s_add_u32 m0, s39, 30720
  s_add_u32 s37, s36, 131072
  buffer_load_dwordx4 v25, s[40:43], s37 offen lds
  s_add_u32 m0, s39, 31744
  s_add_u32 s37, s36, 196608
  buffer_load_dwordx4 v25, s[40:43], s37 offen lds
  s_xor_b32 s36, s13, 6
  s_lshl_b32 s36, s36, 19
  s_add_u32 m0, s39, 24576
  s_add_u32 s37, s36, 262144
  buffer_load_dwordx4 v25, s[40:43], s37 offen lds
  s_add_u32 m0, s39, 25600
  s_add_u32 s37, s36, 327680
  buffer_load_dwordx4 v25, s[40:43], s37 offen lds
  s_add_u32 m0, s39, 26624
  s_add_u32 s37, s36, 393216
  buffer_load_dwordx4 v25, s[40:43], s37 offen lds
  s_add_u32 m0, s39, 27648
  s_add_u32 s37, s36, 458752
  buffer_load_dwordx4 v25, s[40:43], s37 offen lds
  v_mad_u32_u24 v96, v100, 1, v27
  v_mad_u32_u24 v97, v101, 1, v27
  v_mad_u32_u24 v98, v100, 1, v36
  v_mad_u32_u24 v99, v101, 1, v36
  s_waitcnt vmcnt(8)
  s_barrier
  ds_read_b64_tr_b16 a[64:65], v96 offset:8192
  ds_read_b64_tr_b16 a[66:67], v96 offset:8448
  ds_read_b64_tr_b16 a[68:69], v96 offset:10240
  ds_read_b64_tr_b16 a[70:71], v96 offset:10496
  ds_read_b64_tr_b16 a[72:73], v97 offset:8192
  ds_read_b64_tr_b16 a[74:75], v97 offset:8448
  ds_read_b64_tr_b16 a[76:77], v97 offset:10240
  ds_read_b64_tr_b16 a[78:79], v97 offset:10496
  ds_read_b64_tr_b16 a[112:113], v98 offset:8192
  ds_read_b64_tr_b16 a[114:115], v98 offset:8448
  ds_read_b64_tr_b16 a[116:117], v98 offset:10240
  ds_read_b64_tr_b16 a[118:119], v98 offset:10496
  ds_read_b64_tr_b16 a[120:121], v99 offset:8192
  ds_read_b64_tr_b16 a[122:123], v99 offset:8448
  ds_read_b64_tr_b16 a[124:125], v99 offset:10240
  ds_read_b64_tr_b16 a[126:127], v99 offset:10496
  s_waitcnt lgkmcnt(0)
  s_barrier
  s_xor_b32 s36, s13, 6
  s_lshl_b32 s36, s36, 19
  s_add_u32 m0, s39, 12288
  s_add_u32 s37, s36, 0
  buffer_load_dwordx4 v25, s[44:47], s37 offen lds
  s_add_u32 m0, s39, 13312
  s_add_u32 s37, s36, 65536
  buffer_load_dwordx4 v25, s[44:47], s37 offen lds
  s_add_u32 m0, s39, 14336
  s_add_u32 s37, s36, 131072
  buffer_load_dwordx4 v25, s[44:47], s37 offen lds
  s_add_u32 m0, s39, 15360
  s_add_u32 s37, s36, 196608
  buffer_load_dwordx4 v25, s[44:47], s37 offen lds
  s_xor_b32 s36, s13, 6
  s_lshl_b32 s36, s36, 19
  s_add_u32 m0, s39, 8192
  s_add_u32 s37, s36, 262144
  buffer_load_dwordx4 v25, s[44:47], s37 offen lds
  s_add_u32 m0, s39, 9216
  s_add_u32 s37, s36, 327680
  buffer_load_dwordx4 v25, s[44:47], s37 offen lds
  s_add_u32 m0, s39, 10240
  s_add_u32 s37, s36, 393216
  buffer_load_dwordx4 v25, s[44:47], s37 offen lds
  s_add_u32 m0, s39, 11264
  s_add_u32 s37, s36, 458752
  buffer_load_dwordx4 v25, s[44:47], s37 offen lds
  v_mad_u32_u24 v96, v100, 1, v27
  v_mad_u32_u24 v97, v101, 1, v27
  v_mad_u32_u24 v98, v100, 1, v36
  v_mad_u32_u24 v99, v101, 1, v36
  s_waitcnt vmcnt(8)
  s_barrier
  ds_read_b64_tr_b16 a[80:81], v96 offset:24576
  ds_read_b64_tr_b16 a[82:83], v96 offset:24832
  ds_read_b64_tr_b16 a[84:85], v96 offset:26624
  ds_read_b64_tr_b16 a[86:87], v96 offset:26880
  ds_read_b64_tr_b16 a[88:89], v97 offset:24576
  ds_read_b64_tr_b16 a[90:91], v97 offset:24832
  ds_read_b64_tr_b16 a[92:93], v97 offset:26624
  ds_read_b64_tr_b16 a[94:95], v97 offset:26880
  ds_read_b64_tr_b16 a[128:129], v98 offset:24576
  ds_read_b64_tr_b16 a[130:131], v98 offset:24832
  ds_read_b64_tr_b16 a[132:133], v98 offset:26624
  ds_read_b64_tr_b16 a[134:135], v98 offset:26880
  ds_read_b64_tr_b16 a[136:137], v99 offset:24576
  ds_read_b64_tr_b16 a[138:139], v99 offset:24832
  ds_read_b64_tr_b16 a[140:141], v99 offset:26624
  ds_read_b64_tr_b16 a[142:143], v99 offset:26880
  s_waitcnt lgkmcnt(0)
  s_barrier
  s_xor_b32 s36, s13, 0
  s_lshl_b32 s36, s36, 19
  s_add_u32 m0, s39, 28672
  s_add_u32 s37, s36, 0
  buffer_load_dwordx4 v25, s[8:11], s37 offen lds
  s_add_u32 m0, s39, 29696
  s_add_u32 s37, s36, 65536
  buffer_load_dwordx4 v25, s[8:11], s37 offen lds
  s_add_u32 m0, s39, 30720
  s_add_u32 s37, s36, 131072
  buffer_load_dwordx4 v25, s[8:11], s37 offen lds
  s_add_u32 m0, s39, 31744
  s_add_u32 s37, s36, 196608
  buffer_load_dwordx4 v25, s[8:11], s37 offen lds
  s_xor_b32 s36, s13, 0
  s_lshl_b32 s36, s36, 19
  s_add_u32 m0, s39, 0
  s_add_u32 s37, s36, 262144
  buffer_load_dwordx4 v25, s[8:11], s37 offen lds
  s_add_u32 m0, s39, 1024
  s_add_u32 s37, s36, 327680
  buffer_load_dwordx4 v25, s[8:11], s37 offen lds
  s_add_u32 m0, s39, 2048
  s_add_u32 s37, s36, 393216
  buffer_load_dwordx4 v25, s[8:11], s37 offen lds
  s_add_u32 m0, s39, 3072
  s_add_u32 s37, s36, 458752
  buffer_load_dwordx4 v25, s[8:11], s37 offen lds
  v_mad_u32_u24 v96, v100, 1, v27
  v_mad_u32_u24 v97, v101, 1, v27
  v_mad_u32_u24 v98, v100, 1, v36
  v_mad_u32_u24 v99, v101, 1, v36
  s_waitcnt vmcnt(8)
  s_barrier
  ds_read_b64_tr_b16 a[96:97], v96 offset:8192
  ds_read_b64_tr_b16 a[98:99], v96 offset:8448
  ds_read_b64_tr_b16 a[100:101], v96 offset:10240
  ds_read_b64_tr_b16 a[102:103], v96 offset:10496
  ds_read_b64_tr_b16 a[104:105], v97 offset:8192
  ds_read_b64_tr_b16 a[106:107], v97 offset:8448
  ds_read_b64_tr_b16 a[108:109], v97 offset:10240
  ds_read_b64_tr_b16 a[110:111], v97 offset:10496
  ds_read_b64_tr_b16 a[144:145], v98 offset:8192
  ds_read_b64_tr_b16 a[146:147], v98 offset:8448
  ds_read_b64_tr_b16 a[148:149], v98 offset:10240
  ds_read_b64_tr_b16 a[150:151], v98 offset:10496
  ds_read_b64_tr_b16 a[152:153], v99 offset:8192
  ds_read_b64_tr_b16 a[154:155], v99 offset:8448
  ds_read_b64_tr_b16 a[156:157], v99 offset:10240
  ds_read_b64_tr_b16 a[158:159], v99 offset:10496
  s_waitcnt lgkmcnt(0)
  s_barrier
  s_xor_b32 s36, s13, 0
  s_lshl_b32 s36, s36, 19
  s_add_u32 m0, s39, 24576
  s_add_u32 s37, s36, 0
  buffer_load_dwordx4 v25, s[40:43], s37 offen lds
  s_add_u32 m0, s39, 25600
  s_add_u32 s37, s36, 65536
  buffer_load_dwordx4 v25, s[40:43], s37 offen lds
  s_add_u32 m0, s39, 26624
  s_add_u32 s37, s36, 131072
  buffer_load_dwordx4 v25, s[40:43], s37 offen lds
  s_add_u32 m0, s39, 27648
  s_add_u32 s37, s36, 196608
  buffer_load_dwordx4 v25, s[40:43], s37 offen lds
  s_xor_b32 s36, s13, 0
  s_lshl_b32 s36, s36, 19
  s_add_u32 m0, s39, 4096
  s_add_u32 s37, s36, 262144
  buffer_load_dwordx4 v25, s[40:43], s37 offen lds
  s_add_u32 m0, s39, 5120
  s_add_u32 s37, s36, 327680
  buffer_load_dwordx4 v25, s[40:43], s37 offen lds
  s_add_u32 m0, s39, 6144
  s_add_u32 s37, s36, 393216
  buffer_load_dwordx4 v25, s[40:43], s37 offen lds
  s_add_u32 m0, s39, 7168
  s_add_u32 s37, s36, 458752
  buffer_load_dwordx4 v25, s[40:43], s37 offen lds
  v_mad_u32_u24 v96, v100, 7, v27
  v_mad_u32_u24 v97, v101, 7, v27
  v_mad_u32_u24 v98, v100, 7, v36
  v_mad_u32_u24 v99, v101, 7, v36
  s_waitcnt vmcnt(8)
  s_barrier
  ds_read_b64_tr_b16 v[128:129], v98 offset:0
  ds_read_b64_tr_b16 v[130:131], v98 offset:256
  ds_read_b64_tr_b16 v[132:133], v98 offset:2048
  ds_read_b64_tr_b16 v[134:135], v98 offset:2304
  ds_read_b64_tr_b16 v[136:137], v99 offset:0
  ds_read_b64_tr_b16 v[138:139], v99 offset:256
  ds_read_b64_tr_b16 v[140:141], v99 offset:2048
  ds_read_b64_tr_b16 v[142:143], v99 offset:2304
  ds_read_b64_tr_b16 v[64:65], v96 offset:0
  ds_read_b64_tr_b16 v[66:67], v96 offset:256
  ds_read_b64_tr_b16 v[68:69], v96 offset:2048
  ds_read_b64_tr_b16 v[70:71], v96 offset:2304
  ds_read_b64_tr_b16 v[72:73], v97 offset:0
  ds_read_b64_tr_b16 v[74:75], v97 offset:256
  ds_read_b64_tr_b16 v[76:77], v97 offset:2048
  ds_read_b64_tr_b16 v[78:79], v97 offset:2304
  s_waitcnt lgkmcnt(0)
  s_barrier
  ds_write_b128 v4, v[64:67] offset:0
  ds_write_b128 v4, v[68:71] offset:1024
  ds_write_b128 v4, v[72:75] offset:2048
  ds_write_b128 v4, v[76:79] offset:3072
  s_xor_b32 s36, s13, 2
  s_lshl_b32 s36, s36, 19
  s_add_u32 m0, s39, 28672
  s_add_u32 s37, s36, 0
  buffer_load_dwordx4 v25, s[40:43], s37 offen lds
  s_add_u32 m0, s39, 29696
  s_add_u32 s37, s36, 65536
  buffer_load_dwordx4 v25, s[40:43], s37 offen lds
  s_add_u32 m0, s39, 30720
  s_add_u32 s37, s36, 131072
  buffer_load_dwordx4 v25, s[40:43], s37 offen lds
  s_add_u32 m0, s39, 31744
  s_add_u32 s37, s36, 196608
  buffer_load_dwordx4 v25, s[40:43], s37 offen lds
  s_xor_b32 s36, s13, 2
  s_lshl_b32 s36, s36, 19
  s_add_u32 m0, s39, 16384
  s_add_u32 s37, s36, 262144
  buffer_load_dwordx4 v25, s[40:43], s37 offen lds
  s_add_u32 m0, s39, 17408
  s_add_u32 s37, s36, 327680
  buffer_load_dwordx4 v25, s[40:43], s37 offen lds
  s_add_u32 m0, s39, 18432
  s_add_u32 s37, s36, 393216
  buffer_load_dwordx4 v25, s[40:43], s37 offen lds
  s_add_u32 m0, s39, 19456
  s_add_u32 s37, s36, 458752
  buffer_load_dwordx4 v25, s[40:43], s37 offen lds
  s_getpc_b64 s[60:61]
T_pc_2:
  s_add_u32 s60, s60, T_code-T_pc_2
  s_addc_u32 s61, s61, 0
  v_lshlrev_b32 v102, 3, v59
  v_min_u32 v102, 12416, v102
  global_load_dword v103, v102, s[60:61]
  buffer_load_dwordx2 v[54:55], off, s[72:75], 0 sc1
  buffer_load_dword v56, off, s[72:75], 0 offset:128 sc1
  v_mad_u32_u24 v96, v100, 5, v27
  v_mad_u32_u24 v97, v101, 5, v27
  v_mad_u32_u24 v98, v100, 5, v36
  v_mad_u32_u24 v99, v101, 5, v36
  s_waitcnt vmcnt(11)
  s_barrier
  ds_read_b64_tr_b16 v[144:145], v98 offset:4096
  ds_read_b64_tr_b16 v[146:147], v98 offset:4352
  ds_read_b64_tr_b16 v[148:149], v98 offset:6144
  ds_read_b64_tr_b16 v[150:151], v98 offset:6400
  ds_read_b64_tr_b16 v[152:153], v99 offset:4096
  ds_read_b64_tr_b16 v[154:155], v99 offset:4352
  ds_read_b64_tr_b16 v[156:157], v99 offset:6144
  ds_read_b64_tr_b16 v[158:159], v99 offset:6400
  ds_read_b64_tr_b16 v[64:65], v96 offset:4096
  ds_read_b64_tr_b16 v[66:67], v96 offset:4352
  ds_read_b64_tr_b16 v[68:69], v96 offset:6144
  ds_read_b64_tr_b16 v[70:71], v96 offset:6400
  ds_read_b64_tr_b16 v[72:73], v97 offset:4096
  ds_read_b64_tr_b16 v[74:75], v97 offset:4352
  ds_read_b64_tr_b16 v[76:77], v97 offset:6144
  ds_read_b64_tr_b16 v[78:79], v97 offset:6400
  s_waitcnt lgkmcnt(0)
  s_barrier
  ds_write_b128 v4, v[64:67] offset:4096
  ds_write_b128 v4, v[68:71] offset:5120
  ds_write_b128 v4, v[72:75] offset:6144
  ds_write_b128 v4, v[76:79] offset:7168
  s_xor_b32 s36, s13, 2
  s_lshl_b32 s36, s36, 19
  s_add_u32 m0, s39, 24576
  s_add_u32 s37, s36, 0
  buffer_load_dwordx4 v25, s[44:47], s37 offen lds
  s_add_u32 m0, s39, 25600
  s_add_u32 s37, s36, 65536
  buffer_load_dwordx4 v25, s[44:47], s37 offen lds
  s_add_u32 m0, s39, 26624
  s_add_u32 s37, s36, 131072
  buffer_load_dwordx4 v25, s[44:47], s37 offen lds
  s_add_u32 m0, s39, 27648
  s_add_u32 s37, s36, 196608
  buffer_load_dwordx4 v25, s[44:47], s37 offen lds
  s_xor_b32 s36, s13, 2
  s_lshl_b32 s36, s36, 19
  s_add_u32 m0, s39, 20480
  s_add_u32 s37, s36, 262144
  buffer_load_dwordx4 v25, s[44:47], s37 offen lds
  s_add_u32 m0, s39, 21504
  s_add_u32 s37, s36, 327680
  buffer_load_dwordx4 v25, s[44:47], s37 offen lds
  s_add_u32 m0, s39, 22528
  s_add_u32 s37, s36, 393216
  buffer_load_dwordx4 v25, s[44:47], s37 offen lds
  s_add_u32 m0, s39, 23552
  s_add_u32 s37, s36, 458752
  buffer_load_dwordx4 v25, s[44:47], s37 offen lds
  v_mad_u32_u24 v96, v100, 3, v27
  v_mad_u32_u24 v97, v101, 3, v27
  v_mad_u32_u24 v98, v100, 3, v36
  v_mad_u32_u24 v99, v101, 3, v36
  s_waitcnt vmcnt(11)
  s_barrier
  ds_read_b64_tr_b16 v[176:177], v96 offset:16384
  ds_read_b64_tr_b16 v[178:179], v96 offset:16640
  ds_read_b64_tr_b16 v[180:181], v96 offset:18432
  ds_read_b64_tr_b16 v[182:183], v96 offset:18688
  ds_read_b64_tr_b16 v[184:185], v97 offset:16384
  ds_read_b64_tr_b16 v[186:187], v97 offset:16640
  ds_read_b64_tr_b16 v[188:189], v97 offset:18432
  ds_read_b64_tr_b16 v[190:191], v97 offset:18688
  ds_read_b64_tr_b16 v[64:65], v98 offset:16384
  ds_read_b64_tr_b16 v[66:67], v98 offset:16640
  ds_read_b64_tr_b16 v[68:69], v98 offset:18432
  ds_read_b64_tr_b16 v[70:71], v98 offset:18688
  ds_read_b64_tr_b16 v[72:73], v99 offset:16384
  ds_read_b64_tr_b16 v[74:75], v99 offset:16640
  ds_read_b64_tr_b16 v[76:77], v99 offset:18432
  ds_read_b64_tr_b16 v[78:79], v99 offset:18688
  s_waitcnt lgkmcnt(0)
  s_barrier
  ds_write_b128 v4, v[64:67] offset:16384
  ds_write_b128 v4, v[68:71] offset:17408
  ds_write_b128 v4, v[72:75] offset:18432
  ds_write_b128 v4, v[76:79] offset:19456
  s_xor_b32 s36, s13, 0
  s_lshl_b32 s36, s36, 19
  s_add_u32 m0, s39, 8192
  s_add_u32 s37, s36, 0
  buffer_load_dwordx4 v25, s[44:47], s37 offen lds
  s_add_u32 m0, s39, 9216
  s_add_u32 s37, s36, 65536
  buffer_load_dwordx4 v25, s[44:47], s37 offen lds
  s_add_u32 m0, s39, 10240
  s_add_u32 s37, s36, 131072
  buffer_load_dwordx4 v25, s[44:47], s37 offen lds
  s_add_u32 m0, s39, 11264
  s_add_u32 s37, s36, 196608
  buffer_load_dwordx4 v25, s[44:47], s37 offen lds
  s_xor_b32 s36, s13, 0
  s_lshl_b32 s36, s36, 19
  s_add_u32 m0, s39, 12288
  s_add_u32 s37, s36, 262144
  buffer_load_dwordx4 v25, s[44:47], s37 offen lds
  s_add_u32 m0, s39, 13312
  s_add_u32 s37, s36, 327680
  buffer_load_dwordx4 v25, s[44:47], s37 offen lds
  s_add_u32 m0, s39, 14336
  s_add_u32 s37, s36, 393216
  buffer_load_dwordx4 v25, s[44:47], s37 offen lds
  s_add_u32 m0, s39, 15360
  s_add_u32 s37, s36, 458752
  buffer_load_dwordx4 v25, s[44:47], s37 offen lds
  v_mad_u32_u24 v96, v100, 1, v27
  v_mad_u32_u24 v97, v101, 1, v27
  v_mad_u32_u24 v98, v100, 1, v36
  v_mad_u32_u24 v99, v101, 1, v36
  s_waitcnt vmcnt(8)
  s_barrier
  ds_read_b64_tr_b16 v[208:209], v98 offset:20480
  ds_read_b64_tr_b16 v[210:211], v98 offset:20736
  ds_read_b64_tr_b16 v[212:213], v98 offset:22528
  ds_read_b64_tr_b16 v[214:215], v98 offset:22784
  ds_read_b64_tr_b16 v[216:217], v99 offset:20480
  ds_read_b64_tr_b16 v[218:219], v99 offset:20736
  ds_read_b64_tr_b16 v[220:221], v99 offset:22528
  ds_read_b64_tr_b16 v[222:223], v99 offset:22784
  ds_read_b64_tr_b16 v[64:65], v96 offset:20480
  ds_read_b64_tr_b16 v[66:67], v96 offset:20736
  ds_read_b64_tr_b16 v[68:69], v96 offset:22528
  ds_read_b64_tr_b16 v[70:71], v96 offset:22784
  ds_read_b64_tr_b16 v[72:73], v97 offset:20480
  ds_read_b64_tr_b16 v[74:75], v97 offset:20736
  ds_read_b64_tr_b16 v[76:77], v97 offset:22528
  ds_read_b64_tr_b16 v[78:79], v97 offset:22784
  s_waitcnt lgkmcnt(0)
  s_barrier
  ds_write_b128 v4, v[64:67] offset:20480
  ds_write_b128 v4, v[68:71] offset:21504
  ds_write_b128 v4, v[72:75] offset:22528
  ds_write_b128 v4, v[76:79] offset:23552
  s_xor_b32 s36, s13, 2
  s_lshl_b32 s36, s36, 15
  s_add_u32 m0, s39, 24576
  s_add_u32 s37, s36, 512
  buffer_load_dwordx4 v26, s[48:51], s37 offen lds
  s_add_u32 m0, s39, 25600
  s_add_u32 s37, s36, 8704
  buffer_load_dwordx4 v26, s[48:51], s37 offen lds
  s_add_u32 m0, s39, 26624
  s_add_u32 s37, s36, 16896
  buffer_load_dwordx4 v26, s[48:51], s37 offen lds
  s_add_u32 m0, s39, 27648
  s_add_u32 s37, s36, 25088
  buffer_load_dwordx4 v26, s[48:51], s37 offen lds
  s_xor_b32 s36, s13, 3
  s_lshl_b32 s36, s36, 15
  s_add_u32 m0, s39, 28672
  s_add_u32 s37, s36, 512
  buffer_load_dwordx4 v26, s[48:51], s37 offen lds
  s_add_u32 m0, s39, 29696
  s_add_u32 s37, s36, 8704
  buffer_load_dwordx4 v26, s[48:51], s37 offen lds
  s_add_u32 m0, s39, 30720
  s_add_u32 s37, s36, 16896
  buffer_load_dwordx4 v26, s[48:51], s37 offen lds
  s_add_u32 m0, s39, 31744
  s_add_u32 s37, s36, 25088
  buffer_load_dwordx4 v26, s[48:51], s37 offen lds
  s_mov_b32 s19, 0
  s_branch T_arrgo_4
T_arr_3:
  s_add_u32 s19, s19, 1
  s_cmp_gt_u32 s19, 32768
  s_cbranch_scc1 M_exit
  buffer_load_dwordx2 v[54:55], off, s[72:75], 0 sc1
  buffer_load_dword v56, off, s[72:75], 0 offset:128 sc1
  s_waitcnt vmcnt(0)
T_arrgo_4:
  v_sad_u8 v57, v54, 0, 0
  v_sad_u8 v57, v55, 0, v57
  v_or_b32 v58, v54, v55
  v_cmp_gt_u32 vcc, 32, v57
  s_cbranch_vccnz T_arr_3
  v_cmp_gt_u32 vcc, 0x100, v56
  s_cbranch_vccnz T_arr_3
  v_readfirstlane_b32 s36, v58
  s_nop 0
  s_and_b32 s36, s36, 0x20202020
  s_cselect_b32 s56, 0, 1
  s_mov_b32 s14, -1
  s_mov_b32 s30, -1
  s_mov_b32 s19, 0
  s_branch T_kvok_6
T_kv_5:
  s_sleep 4
  s_add_u32 s19, s19, 1
  s_cmp_gt_u32 s19, 32768
  s_cbranch_scc1 M_exit
T_kvok_6:
  s_add_u32 s39, s99, 128
  s_mov_b32 s38, 0
  s_mov_b32 s37, 0
  s_atomic_or s38, s[58:59], s99 glc
  s_atomic_or s37, s[58:59], s39 glc
  s_waitcnt lgkmcnt(0)
  s_lshl_b32 s38, s38, 1
  s_lshl1_add_u32 s37, s37, 1
  s_min_u32 s38, s38, s37
  s_cmp_ge_u32 s38, 64
  s_cselect_b32 s38, 100, s38
  s_sub_u32 s38, s38, 1
  s_max_i32 s30, s30, s38
  s_cmp_ge_i32 s14, s30
  s_cbranch_scc1 T_kv_5
  s_mov_b32 m0, s31
  s_nop 0
  buffer_load_dwordx4 v9, s[4:7], s27 offen sc1 lds
  s_mov_b32 m0, s32
  s_nop 0
  buffer_load_dwordx4 v9, s[4:7], s27 offen offset:128 sc1 lds
  s_mov_b32 m0, s33
  s_nop 0
  buffer_load_dwordx4 v10, s[4:7], s28 offen sc1 lds
  s_mov_b32 m0, s34
  s_nop 0
  buffer_load_dwordx4 v10, s[4:7], s28 offen offset:256 sc1 lds
  s_add_u32 s27, s27, 8192
  s_add_u32 s28, s28, 8192
  s_lshl_b32 s36, s12, 10
  s_add_u32 s36, s36, 145752064
  buffer_load_dwordx4 v[40:43], v2, s[4:7], s36 offen sc1
  v_mad_u32_u24 v96, v101, 1, v27
  v_mad_u32_u24 v97, v100, 1, v27
  v_mad_u32_u24 v98, v101, 1, v36
  v_mad_u32_u24 v99, v100, 1, v36
  s_waitcnt vmcnt(13)
  s_barrier
  ds_read_b64_tr_b16 v[64:65], v96 offset:8192
  ds_read_b64_tr_b16 v[66:67], v96 offset:8448
  ds_read_b64_tr_b16 v[68:69], v96 offset:10240
  ds_read_b64_tr_b16 v[70:71], v96 offset:10496
  ds_read_b64_tr_b16 v[72:73], v97 offset:8192
  ds_read_b64_tr_b16 v[74:75], v97 offset:8448
  ds_read_b64_tr_b16 v[76:77], v97 offset:10240
  ds_read_b64_tr_b16 v[78:79], v97 offset:10496
  ds_read_b64_tr_b16 v[80:81], v98 offset:8192
  ds_read_b64_tr_b16 v[82:83], v98 offset:8448
  ds_read_b64_tr_b16 v[84:85], v98 offset:10240
  ds_read_b64_tr_b16 v[86:87], v98 offset:10496
  ds_read_b64_tr_b16 v[88:89], v99 offset:8192
  ds_read_b64_tr_b16 v[90:91], v99 offset:8448
  ds_read_b64_tr_b16 v[92:93], v99 offset:10240
  ds_read_b64_tr_b16 v[94:95], v99 offset:10496
  s_waitcnt lgkmcnt(0)
  s_barrier
  ds_write_b128 v4, v[64:67] offset:8192
  ds_write_b128 v4, v[68:71] offset:9216
  ds_write_b128 v4, v[72:75] offset:10240
  ds_write_b128 v4, v[76:79] offset:11264
  ds_write_b128 v4, v[80:83] offset:12288
  ds_write_b128 v4, v[84:87] offset:13312
  ds_write_b128 v4, v[88:91] offset:14336
  ds_write_b128 v4, v[92:95] offset:15360
  s_waitcnt vmcnt(9)
  ds_read_b64_tr_b16 v[64:65], v28 offset:24576
  ds_read_b64_tr_b16 v[66:67], v28 offset:24832
  ds_read_b64_tr_b16 v[68:69], v28 offset:25600
  ds_read_b64_tr_b16 v[70:71], v28 offset:25856
  ds_read_b64_tr_b16 v[72:73], v28 offset:24584
  ds_read_b64_tr_b16 v[74:75], v28 offset:24840
  ds_read_b64_tr_b16 v[76:77], v28 offset:25608
  ds_read_b64_tr_b16 v[78:79], v28 offset:25864
  s_waitcnt lgkmcnt(0)
  ds_write_b128 v4, v[64:67] offset:24576
  ds_write_b128 v4, v[68:71] offset:25600
  ds_write_b128 v4, v[72:75] offset:26624
  ds_write_b128 v4, v[76:79] offset:27648
  s_waitcnt lgkmcnt(0)
  s_waitcnt vmcnt(5)
  ds_read_b64_tr_b16 v[64:65], v28 offset:28672
  ds_read_b64_tr_b16 v[66:67], v28 offset:28928
  ds_read_b64_tr_b16 v[68:69], v28 offset:29696
  ds_read_b64_tr_b16 v[70:71], v28 offset:29952
  ds_read_b64_tr_b16 v[72:73], v28 offset:28680
  ds_read_b64_tr_b16 v[74:75], v28 offset:28936
  ds_read_b64_tr_b16 v[76:77], v28 offset:29704
  ds_read_b64_tr_b16 v[78:79], v28 offset:29960
  s_waitcnt lgkmcnt(0)
  ds_write_b128 v4, v[64:67] offset:28672
  ds_write_b128 v4, v[68:71] offset:29696
  ds_write_b128 v4, v[72:75] offset:30720
  ds_write_b128 v4, v[76:79] offset:31744
  s_waitcnt lgkmcnt(0)
  s_mov_b32 s14, 1
  s_cmp_lt_i32 s14, s30
  s_cbranch_scc1 T_kv2_7
  s_mov_b32 s19, 0
  s_branch T_kvok_9
T_kv_8:
  s_sleep 4
  s_add_u32 s19, s19, 1
  s_cmp_gt_u32 s19, 32768
  s_cbranch_scc1 M_exit
T_kvok_9:
  s_add_u32 s39, s99, 128
  s_mov_b32 s38, 0
  s_mov_b32 s37, 0
  s_atomic_or s38, s[58:59], s99 glc
  s_atomic_or s37, s[58:59], s39 glc
  s_waitcnt lgkmcnt(0)
  s_lshl_b32 s38, s38, 1
  s_lshl1_add_u32 s37, s37, 1
  s_min_u32 s38, s38, s37
  s_cmp_ge_u32 s38, 64
  s_cselect_b32 s38, 100, s38
  s_sub_u32 s38, s38, 1
  s_max_i32 s30, s30, s38
  s_cmp_ge_i32 s14, s30
  s_cbranch_scc1 T_kv_8
T_kv2_7:
  s_waitcnt vmcnt(0) lgkmcnt(0)
  s_barrier
  s_cmp_ge_u32 s13, 2
  s_cselect_b64 vcc, -1, 0
  v_cndmask_b32 v3, v8, v19, vcc
  ds_read_b128 v[68:71], v4 offset:0
  ds_read_b128 v[72:75], v4 offset:1024
  ds_read_b128 v[76:79], v4 offset:4096
  ds_read_b128 v[80:83], v4 offset:5120
  ds_read_b128 v[84:87], v4 offset:8192
  ds_read_b128 v[88:91], v4 offset:9216
  ds_read_b128 v[92:95], v4 offset:2048
  ds_read_b128 v[96:99], v4 offset:3072
  ds_read_b128 v[100:103], v4 offset:6144
  ds_read_b128 v[104:107], v4 offset:7168
  ds_read_b128 v[108:111], v4 offset:10240
  ds_read_b128 v[112:115], v4 offset:11264
  ds_read_b128 v[28:31], v59 offset:16384
  ds_read_b128 v[32:35], v59 offset:20480
  ds_read_b128 v[36:39], v2 offset:8192
  ds_read_b128 v[40:43], v2 offset:9216
  ds_read_b128 v[44:47], v2 offset:10240
  ds_read_b128 v[48:51], v2 offset:11264
  ds_read_b128 v[52:55], v2 offset:12288
  ds_read_b128 v[56:59], v2 offset:13312
  ds_read_b128 v[60:63], v2 offset:14336
  ds_read_b128 v[64:67], v2 offset:15360
  s_and_b32 s36, s13, 1
  s_lshl_b32 s36, s36, 12
  s_add_u32 s22, s22, s36
  s_add_u32 s23, s36, 145752064
  s_mov_b32 s14, -1
  s_and_b32 s57, s14, 1
  s_and_b32 s36, s14, 3
  s_lshl_b32 s36, s36, 13
  s_add_u32 s26, s36, s23
  s_add_u32 s36, s36, 8192
  s_and_b32 s36, s36, 0x7fff
  s_add_u32 s24, s36, 145752064
  s_add_u32 s25, s36, 145756160
  s_add_u32 s35, s36, s23
  s_waitcnt lgkmcnt(0)
  s_cmp_lg_u32 s56, 0
  s_cbranch_scc1 M_global
T_code:
  s_cmp_eq_u32 s13, 1
  s_cbranch_scc1 T_w_11
  s_cmp_eq_u32 s13, 2
  s_cbranch_scc1 T_w_12
  s_cmp_eq_u32 s13, 3
  s_cbranch_scc1 T_w_13
T_w_10:
  s_mov_b32 s19, 0
  v_mov_b64 v[16:17], 0
  v_mov_b64 v[18:19], 0
  v_mov_b64 v[20:21], 0
  v_mov_b64 v[22:23], 0
  v_mov_b64 v[24:25], 0
  v_mov_b64 v[26:27], 0
  buffer_load_dwordx4 v[124:127], v2, s[4:7], s24 offen offset:0 sc1
  buffer_load_dwordx4 v[116:119], v2, s[4:7], s25 offen offset:0 sc1
  buffer_load_dwordx4 v[124:127], v2, s[4:7], s24 offen offset:0 sc1
  buffer_load_dwordx4 v[116:119], v2, s[4:7], s25 offen offset:0 sc1
  s_branch T_loop_14
.p2align 6
T_retry_15:
  s_mov_b64 exec, vcc
  buffer_load_dwordx4 v[124:127], v2, s[4:7], s24 offen offset:0 sc1
  buffer_load_dwordx4 v[116:119], v2, s[4:7], s25 offen offset:0 sc1
  s_mov_b64 exec, -1
  s_add_u32 s19, s19, 1
  s_cmp_gt_u32 s19, 32768
  s_cbranch_scc1 M_exit
T_loop_14:
  s_waitcnt vmcnt(3) lgkmcnt(0)
  v_max3_u32 v123, v124, v125, v126
  v_max_u32 v123, v123, v127
  v_mov_b32_dpp v120, v124 row_ror:8 row_mask:0xf bank_mask:0xf
  v_mov_b32_dpp v121, v125 row_ror:8 row_mask:0xf bank_mask:0xf
  s_waitcnt vmcnt(2)
  v_max3_u32 v123, v123, v116, v117
  v_max3_u32 v123, v123, v118, v119
  v_cmp_eq_u32 vcc, -1, v123
  s_cbranch_vccnz T_retry_15
  v_smfmac_f32_16x16x64_bf16 v[16:19], v[124:127], v[68:75], v0
  s_add_u32 s14, s14, 1
  ds_write_b128 v2, v[124:127] offset:0
  v_mov_b32_dpp v122, v126 row_ror:8 row_mask:0xf bank_mask:0xf
  v_smfmac_f32_16x16x64_bf16 v[20:23], v[124:127], v[76:83], v0
  s_and_b32 s57, s14, 1
  v_mov_b32_dpp v123, v127 row_ror:8 row_mask:0xf bank_mask:0xf
  v_smfmac_f32_16x16x64_bf16 v[24:27], v[124:127], v[84:91], v0
  s_and_b32 s36, s14, 3
  ds_write_b128 v2, v[116:119] offset:4096
  v_smfmac_f32_16x16x64_bf16 v[16:19], v[120:123], v[92:99], v0
  s_lshl_b32 s36, s36, 13
  v_mov_b32_dpp v84, v116 row_ror:8 row_mask:0xf bank_mask:0xf
  v_smfmac_f32_16x16x64_bf16 v[20:23], v[120:123], v[100:107], v0
  s_add_u32 s26, s36, s23
  ds_read_b128 v[68:71], v4 offset:12288
  v_mov_b32_dpp v85, v117 row_ror:8 row_mask:0xf bank_mask:0xf
  v_smfmac_f32_16x16x64_bf16 v[24:27], v[120:123], v[108:115], v0
  s_add_u32 s36, s36, 8192
  ds_read_b128 v[72:75], v4 offset:13312
  v_mov_b32_dpp v86, v118 row_ror:8 row_mask:0xf bank_mask:0xf
  v_smfmac_f32_16x16x64_bf16 v[16:19], v[116:119], v[224:231], v0
  s_and_b32 s36, s36, 0x7fff
  ds_read_b128 v[76:79], v4 offset:14336
  v_mov_b32_dpp v87, v119 row_ror:8 row_mask:0xf bank_mask:0xf
  v_smfmac_f32_16x16x64_bf16 v[20:23], v[116:119], v[240:247], v0
  s_waitcnt lgkmcnt(3)
  s_barrier
  ds_read_b128 v[100:103], v2 offset:1024
  v_smfmac_f32_16x16x64_bf16 v[24:27], v[116:119], a[0:7], v0
  s_mov_b32 m0, s31
  ds_read_b128 v[120:123], v1 offset:1024
  v_smfmac_f32_16x16x64_bf16 v[16:19], v[84:87], v[232:239], v0
  s_cmp_ge_i32 s14, s30
  s_cbranch_scc1 T_kvw_18
T_kvb_19:
  v_smfmac_f32_16x16x64_bf16 v[20:23], v[84:87], v[248:255], v0
  ds_read_b128 v[80:83], v4 offset:15360
  buffer_load_dwordx4 v9, s[4:7], s27 offen sc1 lds
  v_smfmac_f32_16x16x64_bf16 v[24:27], v[84:87], a[8:15], v0
  s_waitcnt lgkmcnt(2)
  s_mov_b32 m0, s32
  v_smfmac_f32_16x16x64_bf16 v[16:19], v[100:103], v[128:135], v0
  ds_read_b128 v[92:95], v2 offset:2048
  v_smfmac_f32_16x16x64_bf16 v[20:23], v[100:103], v[144:151], v0
  ds_read_b128 v[96:99], v1 offset:2048
  v_smfmac_f32_16x16x64_bf16 v[24:27], v[100:103], v[68:75], v0
  s_waitcnt vmcnt(1) lgkmcnt(3)
  ds_read_b128 v[116:119], v2 offset:3072
  buffer_load_dwordx4 v9, s[4:7], s27 offen offset:128 sc1 lds
  v_smfmac_f32_16x16x64_bf16 v[16:19], v[120:123], v[136:143], v0
  ds_read_b128 v[124:127], v1 offset:3072
  s_mov_b32 m0, s33
  v_smfmac_f32_16x16x64_bf16 v[20:23], v[120:123], v[152:159], v0
  s_waitcnt lgkmcnt(4)
  ds_read_b128 v[104:107], v2 offset:5120
  v_smfmac_f32_16x16x64_bf16 v[24:27], v[120:123], v[76:83], v0
  s_waitcnt lgkmcnt(4)
  ds_read_b128 v[108:111], v1 offset:5120
  v_smfmac_f32_16x16x64_bf16 v[16:19], v[92:95], v[160:167], v0
  s_waitcnt lgkmcnt(4)
  ds_read_b128 v[112:115], v2 offset:6144
  buffer_load_dwordx4 v10, s[4:7], s28 offen sc1 lds
  v_smfmac_f32_16x16x64_bf16 v[16:19], v[96:99], v[168:175], v0
  s_waitcnt lgkmcnt(4)
  ds_read_b128 v[84:87], v1 offset:6144
  s_mov_b32 m0, s34
  v_smfmac_f32_16x16x64_bf16 v[16:19], v[116:119], v[192:199], v0
  s_waitcnt lgkmcnt(4)
  ds_read_b128 v[88:91], v2 offset:7168
  v_smfmac_f32_16x16x64_bf16 v[16:19], v[124:127], v[200:207], v0
  s_waitcnt lgkmcnt(4)
  ds_read_b128 v[100:103], v1 offset:7168
  v_smfmac_f32_16x16x64_bf16 v[16:19], v[104:107], a[16:23], v0
  s_waitcnt lgkmcnt(4)
  ds_read_b128 v[68:71], v4 offset:16384
  buffer_load_dwordx4 v10, s[4:7], s28 offen offset:256 sc1 lds
  v_smfmac_f32_16x16x64_bf16 v[16:19], v[108:111], a[24:31], v0
  s_waitcnt lgkmcnt(4)
  ds_read_b128 v[72:75], v4 offset:17408
  v_smfmac_f32_16x16x64_bf16 v[16:19], v[112:115], a[64:71], v0
  s_waitcnt lgkmcnt(4)
  ds_read_b128 v[76:79], v4 offset:18432
  v_smfmac_f32_16x16x64_bf16 v[16:19], v[84:87], a[72:79], v0
  s_waitcnt lgkmcnt(4)
  ds_read_b128 v[80:83], v4 offset:19456
  v_smfmac_f32_16x16x64_bf16 v[16:19], v[88:91], a[112:119], v0
  s_waitcnt lgkmcnt(4)
  v_smfmac_f32_16x16x64_bf16 v[16:19], v[100:103], a[120:127], v0
  s_add_u32 s24, s36, 145752064
  s_add_u32 s25, s36, 145756160
  v_smfmac_f32_16x16x64_bf16 v[20:23], v[92:95], v[176:183], v0
  s_add_u32 s35, s36, s23
  v_smfmac_f32_16x16x64_bf16 v[20:23], v[96:99], v[184:191], v0
  s_waitcnt lgkmcnt(2)
  v_smfmac_f32_16x16x64_bf16 v[20:23], v[116:119], v[68:75], v0
  s_waitcnt lgkmcnt(0)
  ds_read_b128 v[68:71], v4 offset:20480
  v_mul_f32 v16, s18, v16
  v_smfmac_f32_16x16x64_bf16 v[20:23], v[124:127], v[76:83], v0
  ds_read_b128 v[72:75], v4 offset:21504
  v_mul_f32 v17, s18, v17
  v_smfmac_f32_16x16x64_bf16 v[20:23], v[104:107], a[32:39], v0
  ds_read_b128 v[76:79], v4 offset:22528
  v_mul_f32 v18, s18, v18
  v_smfmac_f32_16x16x64_bf16 v[20:23], v[108:111], a[40:47], v0
  ds_read_b128 v[80:83], v4 offset:23552
  v_mul_f32 v19, s18, v19
  v_smfmac_f32_16x16x64_bf16 v[20:23], v[112:115], a[80:87], v0
  v_cvt_pk_bf16_f32 v120, v16, v17
  v_smfmac_f32_16x16x64_bf16 v[20:23], v[84:87], a[88:95], v0
  v_cvt_pk_bf16_f32 v121, v18, v19
  v_smfmac_f32_16x16x64_bf16 v[20:23], v[88:91], a[128:135], v0
  ds_write_b64 v5, v[120:121] offset:24576
  v_smfmac_f32_16x16x64_bf16 v[20:23], v[100:103], a[136:143], v0
  s_waitcnt lgkmcnt(3)
  v_smfmac_f32_16x16x64_bf16 v[24:27], v[92:95], v[68:75], v0
  s_waitcnt lgkmcnt(1)
  v_mov_b64 v[92:93], 0
  v_smfmac_f32_16x16x64_bf16 v[24:27], v[96:99], v[76:83], v0
  s_nop 1
  v_cvt_pk_bf16_f32 v122, v20, v21
  v_cvt_pk_bf16_f32 v123, v22, v23
  v_smfmac_f32_16x16x64_bf16 v[24:27], v[116:119], v[208:215], v0
  ds_write_b64 v5, v[122:123] offset:26880
  v_mov_b64 v[94:95], 0
  v_smfmac_f32_16x16x64_bf16 v[24:27], v[124:127], v[216:223], v0
  s_waitcnt lgkmcnt(1)
  s_barrier
  ds_read_b64_tr_b16 v[68:69], v6 offset:24576
  v_smfmac_f32_16x16x64_bf16 v[24:27], v[104:107], a[48:55], v0
  s_add_u32 s27, s27, 8192
  ds_read_b64_tr_b16 v[70:71], v6 offset:24640
  ds_read_b64_tr_b16 v[72:73], v6 offset:24832
  v_smfmac_f32_16x16x64_bf16 v[24:27], v[108:111], a[56:63], v0
  s_add_u32 s28, s28, 8192
  ds_read_b64_tr_b16 v[74:75], v6 offset:24896
  ds_read_b64_tr_b16 v[76:77], v6 offset:25088
  v_smfmac_f32_16x16x64_bf16 v[24:27], v[112:115], a[96:103], v0
  s_nop 0
  ds_read_b64_tr_b16 v[78:79], v6 offset:25152
  ds_read_b64_tr_b16 v[80:81], v6 offset:25344
  v_smfmac_f32_16x16x64_bf16 v[24:27], v[84:87], a[104:111], v0
  ds_read_b64_tr_b16 v[82:83], v6 offset:25408
  v_mov_b64 v[96:97], 0
  v_smfmac_f32_16x16x64_bf16 v[24:27], v[88:91], a[144:151], v0
  s_waitcnt lgkmcnt(8)
  s_barrier
  ds_read_b64_tr_b16 v[116:117], v6 offset:26880
  v_smfmac_f32_16x16x64_bf16 v[24:27], v[100:103], a[152:159], v0
  s_waitcnt lgkmcnt(7)
  ds_read_b64_tr_b16 v[118:119], v6 offset:26944
  v_mfma_f32_16x16x32_bf16 v[16:19], v[36:39], v[68:71], 0
  s_waitcnt lgkmcnt(6)
  ds_read_b64_tr_b16 v[124:125], v6 offset:27136
  ds_read_b64_tr_b16 v[126:127], v6 offset:27200
  v_mfma_f32_16x16x32_bf16 v[16:19], v[40:43], v[72:75], v[16:19]
  s_waitcnt lgkmcnt(6)
  ds_read_b64_tr_b16 v[104:105], v6 offset:27392
  ds_read_b64_tr_b16 v[106:107], v6 offset:27456
  v_mfma_f32_16x16x32_bf16 v[16:19], v[44:47], v[76:79], v[16:19]
  s_waitcnt lgkmcnt(6)
  ds_read_b64_tr_b16 v[108:109], v6 offset:27648
  ds_read_b64_tr_b16 v[110:111], v6 offset:27712
  v_mfma_f32_16x16x32_bf16 v[16:19], v[48:51], v[80:83], v[16:19]
  s_waitcnt lgkmcnt(6)
  v_cvt_pk_bf16_f32 v120, v24, v25
  v_cvt_pk_bf16_f32 v121, v26, v27
  v_mfma_f32_16x16x32_bf16 v[112:115], v[116:119], v[68:71], 0
  s_waitcnt lgkmcnt(4)
  buffer_store_dwordx4 v[120:123], v2, s[4:7], s29 offen offset:0 sc1
  v_mov_b64 v[98:99], 0
  v_mfma_f32_16x16x32_bf16 v[112:115], v[124:127], v[72:75], v[112:115]
  s_waitcnt lgkmcnt(2)
  v_mov_b64 v[36:37], 0
  v_exp_f32 v100, v16
  v_mfma_f32_16x16x32_bf16 v[112:115], v[104:107], v[76:79], v[112:115]
  s_waitcnt lgkmcnt(0)
  v_exp_f32 v101, v17
  v_mfma_f32_16x16x32_bf16 v[112:115], v[108:111], v[80:83], v[112:115]
  v_exp_f32 v102, v18
  v_mfma_f32_16x16x32_bf16 v[20:23], v[52:55], v[68:71], 0
  s_cmp_eq_u32 s14, 63
  v_exp_f32 v103, v19
  v_mfma_f32_16x16x32_bf16 v[20:23], v[56:59], v[72:75], v[20:23]
  s_cbranch_scc1 M_tdone
  v_cvt_pk_bf16_f32 v44, v100, v101
  v_cvt_pk_bf16_f32 v45, v102, v103
  v_mfma_f32_16x16x32_bf16 v[20:23], v[60:63], v[76:79], v[20:23]
  s_add_u32 s29, s29, 131072
  v_exp_f32 v100, v112
  v_mfma_f32_16x16x32_bf16 v[20:23], v[64:67], v[80:83], v[20:23]
  v_exp_f32 v101, v113
  v_exp_f32 v102, v114
  v_exp_f32 v103, v115
  v_cvt_pk_bf16_f32 v84, v100, v101
  v_cvt_pk_bf16_f32 v85, v102, v103
  v_cndmask_b32 v48, v84, 0, s[16:17]
  v_cndmask_b32 v49, v85, 0, s[16:17]
  v_cndmask_b32 v50, 0, v84, s[16:17]
  v_cndmask_b32 v51, 0, v85, s[16:17]
  v_exp_f32 v100, v20
  v_mfma_f32_16x16x16_bf16 v[88:91], v[12:13], v[48:49], 0
  v_exp_f32 v101, v21
  v_mfma_f32_16x16x16_bf16 v[24:27], v[120:121], v[48:49], 0
  v_exp_f32 v102, v22
  v_mfma_f32_16x16x16_bf16 v[116:119], v[120:121], v[50:51], 0
  v_exp_f32 v103, v23
  v_cvt_pk_bf16_f32 v46, v100, v101
  v_cvt_pk_bf16_f32 v47, v102, v103
  v_mov_b64 v[38:39], 0
  s_nop 0
  v_mfma_f32_16x16x32_bf16 v[88:91], v[12:15], v[44:47], v[88:91]
  v_mov_b64 v[40:41], 0
  v_mov_b64 v[42:43], 0
  v_mfma_f32_16x16x32_bf16 v[24:27], v[28:31], v[44:47], v[24:27]
  ds_read_b128 v[52:55], v4 offset:24576
  ds_read_b128 v[56:59], v4 offset:25600
  v_mfma_f32_16x16x32_bf16 v[116:119], v[32:35], v[44:47], v[116:119]
  s_nop 1
  v_rcp_f32 v89, v88
  v_subrev_u32 v100, s54, v88
  v_cmp_le_u32 vcc, s55, v100
  v_mul_f32 v24, v89, v24
  v_mul_f32 v25, v89, v25
  s_cbranch_vccnz T_slow_21
T_back_22:
  v_cvt_pk_bf16_f32 v124, v24, v25
  v_pk_mul_f32 v[26:27], v[26:27], v[88:89] op_sel:[0,1] op_sel_hi:[1,1]
  v_pk_mul_f32 v[116:117], v[116:117], v[88:89] op_sel:[0,1] op_sel_hi:[1,1]
  v_pk_mul_f32 v[118:119], v[118:119], v[88:89] op_sel:[0,1] op_sel_hi:[1,1]
  v_cvt_pk_bf16_f32 v125, v26, v27
  v_cvt_pk_bf16_f32 v126, v116, v117
  v_cvt_pk_bf16_f32 v127, v118, v119
  ds_write_b128 v11, v[124:127] offset:29184
  s_nop 0
  v_smfmac_f32_16x16x64_bf16 v[92:95], v[124:127], a[160:167], v0
  v_smfmac_f32_16x16x64_bf16 v[96:99], v[124:127], a[168:175], v0
  v_smfmac_f32_16x16x64_bf16 v[36:39], v[124:127], a[176:183], v0
  v_smfmac_f32_16x16x64_bf16 v[40:43], v[124:127], a[184:191], v0
  s_waitcnt lgkmcnt(0)
  s_barrier
  ds_read_b128 v[104:107], v11 offset:29696
  ds_read_b128 v[108:111], v11 offset:30208
  ds_read_b128 v[68:71], v11 offset:30720
  s_waitcnt lgkmcnt(2)
  v_smfmac_f32_16x16x64_bf16 v[92:95], v[104:107], a[192:199], v0
  s_waitcnt lgkmcnt(1)
  ds_read_b128 v[76:79], v4 offset:28672
  v_smfmac_f32_16x16x64_bf16 v[92:95], v[108:111], a[224:231], v0
  s_waitcnt lgkmcnt(1)
  ds_read_b128 v[80:83], v4 offset:29696
  v_smfmac_f32_16x16x64_bf16 v[92:95], v[68:71], a[240:247], v0
  ds_read_b128 v[60:63], v4 offset:26624
  v_smfmac_f32_16x16x64_bf16 v[96:99], v[104:107], a[200:207], v0
  ds_read_b128 v[64:67], v4 offset:27648
  v_smfmac_f32_16x16x64_bf16 v[96:99], v[108:111], a[232:239], v0
  ds_read_b128 v[28:31], v4 offset:30720
  s_nop 0
  v_cvt_pk_bf16_f32 v16, v92, v93
  v_cvt_pk_bf16_f32 v17, v94, v95
  v_bfi_b32 v16, 1, s57, v16
  v_smfmac_f32_16x16x64_bf16 v[96:99], v[68:71], a[248:255], v0
  buffer_store_dwordx2 v[16:17], v7, s[4:7], s20 offen offset:0
  v_smfmac_f32_16x16x64_bf16 v[36:39], v[104:107], a[208:215], v0
  ds_read_b128 v[32:35], v4 offset:31744
  v_smfmac_f32_16x16x64_bf16 v[36:39], v[108:111], v[52:59], v0
  s_waitcnt lgkmcnt(4)
  s_nop 0
  v_cvt_pk_bf16_f32 v18, v96, v97
  v_cvt_pk_bf16_f32 v19, v98, v99
  v_bfi_b32 v18, 1, s57, v18
  v_smfmac_f32_16x16x64_bf16 v[36:39], v[68:71], v[76:83], v0
  buffer_store_dwordx2 v[18:19], v7, s[4:7], s20 offen offset:64
  v_smfmac_f32_16x16x64_bf16 v[40:43], v[104:107], a[216:223], v0
  s_waitcnt lgkmcnt(2)
  ds_read_b128 v[116:119], v2 offset:31232
  v_smfmac_f32_16x16x64_bf16 v[40:43], v[108:111], v[60:67], v0
  s_waitcnt lgkmcnt(1)
  s_nop 0
  v_cvt_pk_bf16_f32 v20, v36, v37
  v_cvt_pk_bf16_f32 v21, v38, v39
  v_bfi_b32 v20, 1, s57, v20
  v_smfmac_f32_16x16x64_bf16 v[40:43], v[68:71], v[28:35], v0
  buffer_store_dwordx2 v[20:21], v7, s[4:7], s21 offen offset:0
  s_nop 6
  v_cvt_pk_bf16_f32 v22, v40, v41
  v_cvt_pk_bf16_f32 v23, v42, v43
  v_bfi_b32 v22, 1, s57, v22
  buffer_store_dwordx2 v[22:23], v7, s[4:7], s21 offen offset:64
  ds_read_b128 v[68:71], v4 offset:0
  ds_read_b128 v[72:75], v4 offset:1024
  ds_read_b128 v[76:79], v4 offset:4096
  ds_read_b128 v[80:83], v4 offset:5120
  ds_read_b128 v[84:87], v4 offset:8192
  ds_read_b128 v[88:91], v4 offset:9216
  v_mov_b64 v[16:17], 0
  v_mov_b64 v[18:19], 0
  v_mov_b64 v[20:21], 0
  v_mov_b64 v[22:23], 0
  v_mov_b64 v[24:25], 0
  v_mov_b64 v[26:27], 0
  s_mov_b32 s19, 0
  v_mov_b32 v49, -1
  s_waitcnt vmcnt(2)
  buffer_load_dwordx4 v[52:55], v2, s[4:7], s22 offen offset:0 sc1
  buffer_load_dwordx4 v[56:59], v2, s[4:7], s22 offen offset:1024 sc1
  buffer_load_dwordx4 v[60:63], v2, s[4:7], s22 offen offset:2048 sc1
  buffer_load_dwordx4 v[64:67], v2, s[4:7], s22 offen offset:3072 sc1
  ds_read_b128 v[92:95], v4 offset:2048
  ds_read_b128 v[96:99], v4 offset:3072
  ds_read_b128 v[100:103], v4 offset:6144
  ds_read_b128 v[104:107], v4 offset:7168
  ds_read_b128 v[108:111], v4 offset:10240
  ds_read_b128 v[112:115], v4 offset:11264
  ds_read_b64 v[44:45], v2 offset:32256
  s_waitcnt lgkmcnt(0)
  v_readfirstlane_b32 s38, v44
  v_readfirstlane_b32 s37, v45
  s_nop 0
  s_lshl_b32 s38, s38, 1
  s_lshl1_add_u32 s37, s37, 1
  s_min_u32 s38, s38, s37
  s_cmp_ge_u32 s38, 64
  s_cselect_b32 s38, 100, s38
  s_sub_u32 s38, s38, 1
  s_max_i32 s30, s30, s38
  s_waitcnt lgkmcnt(12)
  s_waitcnt vmcnt(3)
  v_mfma_f32_16x16x32_bf16 v[120:123], v[116:119], v[52:55], 0
  v_xor_b32 v48, s57, v52
  v_bitop3_b32 v48, v48, v54, s57 bitop3:0xf6
  s_waitcnt vmcnt(2)
  v_mfma_f32_16x16x32_bf16 v[120:123], v[116:119], v[56:59], v[120:123]
  v_bitop3_b32 v48, v48, v56, s57 bitop3:0xf6
  v_bitop3_b32 v48, v48, v58, s57 bitop3:0xf6
  s_waitcnt vmcnt(1)
  v_mfma_f32_16x16x32_bf16 v[120:123], v[116:119], v[60:63], v[120:123]
  v_bitop3_b32 v48, v48, v60, s57 bitop3:0xf6
  v_bitop3_b32 v48, v48, v62, s57 bitop3:0xf6
  s_waitcnt vmcnt(0)
  v_mfma_f32_16x16x32_bf16 v[120:123], v[116:119], v[64:67], v[120:123]
  v_bitop3_b32 v48, v48, v64, s57 bitop3:0xf6
  v_bitop3_b32 v48, v48, v66, s57 bitop3:0xf6
  v_and_b32 v48, 1, v48
  v_cmp_ne_u32 vcc, 0, v48
  s_cbranch_vccnz T_p1re_24
T_p1ok_25:
  s_nop 2
  v_add_f32_dpp v120, v120, v120 row_ror:8 row_mask:0xf bank_mask:0xf
  v_add_f32_dpp v121, v121, v121 row_ror:8 row_mask:0xf bank_mask:0xf
  v_cvt_pk_bf16_f32 v48, v120, v121
  buffer_store_dword v48, v8, s[4:7], s35 offen
  buffer_store_dword v49, v8, s[4:7], s26 offen
  s_barrier
  ds_read_b128 v[28:31], v2 offset:16384
  ds_read_b128 v[32:35], v2 offset:20480
  ds_read_b128 v[36:39], v2 offset:8192
  ds_read_b128 v[40:43], v2 offset:9216
  ds_read_b128 v[44:47], v2 offset:10240
  ds_read_b128 v[48:51], v2 offset:11264
  buffer_load_dwordx4 v[124:127], v2, s[4:7], s24 offen offset:0 sc1
  buffer_load_dwordx4 v[116:119], v2, s[4:7], s25 offen offset:0 sc1
  ds_read_b128 v[52:55], v2 offset:12288
  ds_read_b128 v[56:59], v2 offset:13312
  ds_read_b128 v[60:63], v2 offset:14336
  ds_read_b128 v[64:67], v2 offset:15360
  buffer_load_dwordx4 v[124:127], v2, s[4:7], s24 offen offset:0 sc1
  buffer_load_dwordx4 v[116:119], v2, s[4:7], s25 offen offset:0 sc1
  s_mov_b32 s19, 0
  s_branch T_loop_14
T_p1re_24:
  s_mov_b64 exec, vcc
  buffer_load_dwordx4 v[52:55], v2, s[4:7], s22 offen offset:0 sc1
  buffer_load_dwordx4 v[56:59], v2, s[4:7], s22 offen offset:1024 sc1
  buffer_load_dwordx4 v[60:63], v2, s[4:7], s22 offen offset:2048 sc1
  buffer_load_dwordx4 v[64:67], v2, s[4:7], s22 offen offset:3072 sc1
  s_mov_b64 exec, -1
  s_add_u32 s19, s19, 1
  s_cmp_gt_u32 s19, 32768
  s_cbranch_scc1 M_exit
  s_waitcnt vmcnt(3)
  v_mfma_f32_16x16x32_bf16 v[120:123], v[116:119], v[52:55], 0
  v_xor_b32 v48, s57, v52
  v_bitop3_b32 v48, v48, v54, s57 bitop3:0xf6
  s_waitcnt vmcnt(2)
  v_mfma_f32_16x16x32_bf16 v[120:123], v[116:119], v[56:59], v[120:123]
  v_bitop3_b32 v48, v48, v56, s57 bitop3:0xf6
  v_bitop3_b32 v48, v48, v58, s57 bitop3:0xf6
  s_waitcnt vmcnt(1)
  v_mfma_f32_16x16x32_bf16 v[120:123], v[116:119], v[60:63], v[120:123]
  v_bitop3_b32 v48, v48, v60, s57 bitop3:0xf6
  v_bitop3_b32 v48, v48, v62, s57 bitop3:0xf6
  s_waitcnt vmcnt(0)
  v_mfma_f32_16x16x32_bf16 v[120:123], v[116:119], v[64:67], v[120:123]
  v_bitop3_b32 v48, v48, v64, s57 bitop3:0xf6
  v_bitop3_b32 v48, v48, v66, s57 bitop3:0xf6
  v_and_b32 v48, 1, v48
  v_cmp_ne_u32 vcc, 0, v48
  s_cbranch_vccnz T_p1re_24
  s_branch T_p1ok_25
T_kvw_18:
  s_mov_b32 s19, 0
  s_branch T_kvok_27
T_kv_26:
  s_sleep 4
  s_add_u32 s19, s19, 1
  s_cmp_gt_u32 s19, 32768
  s_cbranch_scc1 M_exit
T_kvok_27:
  s_add_u32 s39, s99, 128
  s_mov_b32 s38, 0
  s_mov_b32 s37, 0
  s_atomic_or s38, s[58:59], s99 glc
  s_atomic_or s37, s[58:59], s39 glc
  s_waitcnt lgkmcnt(0)
  s_lshl_b32 s38, s38, 1
  s_lshl1_add_u32 s37, s37, 1
  s_min_u32 s38, s38, s37
  s_cmp_ge_u32 s38, 64
  s_cselect_b32 s38, 100, s38
  s_sub_u32 s38, s38, 1
  s_max_i32 s30, s30, s38
  s_cmp_ge_i32 s14, s30
  s_cbranch_scc1 T_kv_26
  s_branch T_kvb_19
T_slow_21:
  s_nop 7
  v_max3_f32 v100, v16, v17, v18
  v_max3_f32 v100, v100, v19, v20
  v_max3_f32 v100, v100, v21, v22
  v_max3_f32 v100, v100, v23, v112
  v_max3_f32 v100, v100, v113, v114
  v_max_f32 v100, v100, v115
  v_mov_b32 v101, v100
  s_nop 1
  v_permlane32_swap_b32 v100, v101
  s_nop 1
  v_max_f32 v100, v100, v101
  v_mov_b32 v101, v100
  s_nop 1
  v_permlane16_swap_b32 v100, v101
  s_nop 1
  v_max_f32 v100, v100, v101
  v_sub_f32 v16, v16, v100
  v_sub_f32 v17, v17, v100
  v_sub_f32 v18, v18, v100
  v_sub_f32 v19, v19, v100
  v_exp_f32 v16, v16
  v_exp_f32 v17, v17
  v_exp_f32 v18, v18
  v_exp_f32 v19, v19
  v_sub_f32 v20, v20, v100
  v_sub_f32 v21, v21, v100
  v_sub_f32 v22, v22, v100
  v_sub_f32 v23, v23, v100
  v_exp_f32 v20, v20
  v_exp_f32 v21, v21
  v_exp_f32 v22, v22
  v_exp_f32 v23, v23
  v_sub_f32 v112, v112, v100
  v_sub_f32 v113, v113, v100
  v_sub_f32 v114, v114, v100
  v_sub_f32 v115, v115, v100
  v_exp_f32 v112, v112
  v_exp_f32 v113, v113
  v_exp_f32 v114, v114
  v_exp_f32 v115, v115
  s_nop 0
  v_cvt_pk_bf16_f32 v44, v16, v17
  v_cvt_pk_bf16_f32 v45, v18, v19
  v_cvt_pk_bf16_f32 v46, v20, v21
  v_cvt_pk_bf16_f32 v47, v22, v23
  v_cvt_pk_bf16_f32 v84, v112, v113
  v_cvt_pk_bf16_f32 v85, v114, v115
  v_cndmask_b32 v48, v84, 0, s[16:17]
  v_cndmask_b32 v49, v85, 0, s[16:17]
  v_cndmask_b32 v50, 0, v84, s[16:17]
  v_cndmask_b32 v51, 0, v85, s[16:17]
  s_nop 1
  v_mfma_f32_16x16x16_bf16 v[88:91], v[12:13], v[48:49], 0
  v_mfma_f32_16x16x16_bf16 v[24:27], v[120:121], v[48:49], 0
  v_mfma_f32_16x16x16_bf16 v[116:119], v[120:121], v[50:51], 0
  v_mfma_f32_16x16x32_bf16 v[88:91], v[12:15], v[44:47], v[88:91]
  v_mfma_f32_16x16x32_bf16 v[24:27], v[28:31], v[44:47], v[24:27]
  v_mfma_f32_16x16x32_bf16 v[116:119], v[32:35], v[44:47], v[116:119]
  s_nop 7
  s_nop 1
  v_rcp_f32 v89, v88
  s_nop 0
  v_mul_f32 v24, v89, v24
  v_mul_f32 v25, v89, v25
  s_branch T_back_22
T_w_11:
  s_mov_b32 s19, 0
  v_mov_b64 v[16:17], 0
  v_mov_b64 v[18:19], 0
  v_mov_b64 v[20:21], 0
  v_mov_b64 v[22:23], 0
  v_mov_b64 v[24:25], 0
  v_mov_b64 v[26:27], 0
  buffer_load_dwordx4 v[124:127], v2, s[4:7], s24 offen offset:1024 sc1
  buffer_load_dwordx4 v[116:119], v2, s[4:7], s25 offen offset:1024 sc1
  buffer_load_dwordx4 v[124:127], v2, s[4:7], s24 offen offset:1024 sc1
  buffer_load_dwordx4 v[116:119], v2, s[4:7], s25 offen offset:1024 sc1
  s_branch T_loop_28
.p2align 6
T_retry_29:
  s_mov_b64 exec, vcc
  buffer_load_dwordx4 v[124:127], v2, s[4:7], s24 offen offset:1024 sc1
  buffer_load_dwordx4 v[116:119], v2, s[4:7], s25 offen offset:1024 sc1
  s_mov_b64 exec, -1
  s_add_u32 s19, s19, 1
  s_cmp_gt_u32 s19, 32768
  s_cbranch_scc1 M_exit
T_loop_28:
  s_waitcnt vmcnt(3) lgkmcnt(0)
  v_max3_u32 v123, v124, v125, v126
  v_max_u32 v123, v123, v127
  v_mov_b32_dpp v120, v124 row_ror:8 row_mask:0xf bank_mask:0xf
  v_mov_b32_dpp v121, v125 row_ror:8 row_mask:0xf bank_mask:0xf
  s_waitcnt vmcnt(2)
  v_max3_u32 v123, v123, v116, v117
  v_max3_u32 v123, v123, v118, v119
  v_cmp_eq_u32 vcc, -1, v123
  s_cbranch_vccnz T_retry_29
  v_smfmac_f32_16x16x64_bf16 v[16:19], v[124:127], v[68:75], v0
  s_add_u32 s14, s14, 1
  ds_write_b128 v2, v[124:127] offset:1024
  v_mov_b32_dpp v122, v126 row_ror:8 row_mask:0xf bank_mask:0xf
  v_smfmac_f32_16x16x64_bf16 v[20:23], v[124:127], v[76:83], v0
  s_and_b32 s57, s14, 1
  v_mov_b32_dpp v123, v127 row_ror:8 row_mask:0xf bank_mask:0xf
  v_smfmac_f32_16x16x64_bf16 v[24:27], v[124:127], v[84:91], v0
  s_and_b32 s36, s14, 3
  ds_write_b128 v2, v[116:119] offset:5120
  v_smfmac_f32_16x16x64_bf16 v[16:19], v[120:123], v[92:99], v0
  s_lshl_b32 s36, s36, 13
  v_mov_b32_dpp v84, v116 row_ror:8 row_mask:0xf bank_mask:0xf
  v_smfmac_f32_16x16x64_bf16 v[20:23], v[120:123], v[100:107], v0
  s_add_u32 s26, s36, s23
  ds_read_b128 v[68:71], v4 offset:12288
  v_mov_b32_dpp v85, v117 row_ror:8 row_mask:0xf bank_mask:0xf
  v_smfmac_f32_16x16x64_bf16 v[24:27], v[120:123], v[108:115], v0
  s_add_u32 s36, s36, 8192
  ds_read_b128 v[72:75], v4 offset:13312
  v_mov_b32_dpp v86, v118 row_ror:8 row_mask:0xf bank_mask:0xf
  v_smfmac_f32_16x16x64_bf16 v[16:19], v[116:119], v[224:231], v0
  s_and_b32 s36, s36, 0x7fff
  ds_read_b128 v[76:79], v4 offset:14336
  v_mov_b32_dpp v87, v119 row_ror:8 row_mask:0xf bank_mask:0xf
  v_smfmac_f32_16x16x64_bf16 v[20:23], v[116:119], v[240:247], v0
  s_waitcnt lgkmcnt(3)
  s_barrier
  ds_read_b128 v[100:103], v2 offset:0
  v_smfmac_f32_16x16x64_bf16 v[24:27], v[116:119], a[0:7], v0
  s_mov_b32 m0, s31
  ds_read_b128 v[120:123], v1 offset:0
  v_smfmac_f32_16x16x64_bf16 v[16:19], v[84:87], v[232:239], v0
  s_cmp_ge_i32 s14, s30
  s_cbranch_scc1 T_kvw_32
T_kvb_33:
  v_smfmac_f32_16x16x64_bf16 v[20:23], v[84:87], v[248:255], v0
  ds_read_b128 v[80:83], v4 offset:15360
  v_smfmac_f32_16x16x64_bf16 v[24:27], v[84:87], a[8:15], v0
  s_waitcnt lgkmcnt(2)
  buffer_load_dwordx4 v9, s[4:7], s27 offen sc1 lds
  v_smfmac_f32_16x16x64_bf16 v[16:19], v[100:103], v[128:135], v0
  ds_read_b128 v[92:95], v2 offset:3072
  s_mov_b32 m0, s32
  v_smfmac_f32_16x16x64_bf16 v[20:23], v[100:103], v[144:151], v0
  ds_read_b128 v[96:99], v1 offset:3072
  v_smfmac_f32_16x16x64_bf16 v[24:27], v[100:103], v[68:75], v0
  s_waitcnt vmcnt(1) lgkmcnt(3)
  ds_read_b128 v[116:119], v2 offset:2048
  v_smfmac_f32_16x16x64_bf16 v[16:19], v[120:123], v[136:143], v0
  ds_read_b128 v[124:127], v1 offset:2048
  buffer_load_dwordx4 v9, s[4:7], s27 offen offset:128 sc1 lds
  v_smfmac_f32_16x16x64_bf16 v[20:23], v[120:123], v[152:159], v0
  s_waitcnt lgkmcnt(4)
  ds_read_b128 v[104:107], v2 offset:4096
  s_mov_b32 m0, s33
  v_smfmac_f32_16x16x64_bf16 v[24:27], v[120:123], v[76:83], v0
  s_waitcnt lgkmcnt(4)
  ds_read_b128 v[108:111], v1 offset:4096
  v_smfmac_f32_16x16x64_bf16 v[16:19], v[92:95], v[160:167], v0
  s_waitcnt lgkmcnt(4)
  ds_read_b128 v[112:115], v2 offset:7168
  v_smfmac_f32_16x16x64_bf16 v[16:19], v[96:99], v[168:175], v0
  s_waitcnt lgkmcnt(4)
  ds_read_b128 v[84:87], v1 offset:7168
  buffer_load_dwordx4 v10, s[4:7], s28 offen sc1 lds
  v_smfmac_f32_16x16x64_bf16 v[16:19], v[116:119], v[192:199], v0
  s_waitcnt lgkmcnt(4)
  ds_read_b128 v[88:91], v2 offset:6144
  s_mov_b32 m0, s34
  v_smfmac_f32_16x16x64_bf16 v[16:19], v[124:127], v[200:207], v0
  s_waitcnt lgkmcnt(4)
  ds_read_b128 v[100:103], v1 offset:6144
  v_smfmac_f32_16x16x64_bf16 v[16:19], v[104:107], a[16:23], v0
  s_waitcnt lgkmcnt(4)
  ds_read_b128 v[68:71], v4 offset:16384
  v_smfmac_f32_16x16x64_bf16 v[16:19], v[108:111], a[24:31], v0
  s_waitcnt lgkmcnt(4)
  ds_read_b128 v[72:75], v4 offset:17408
  buffer_load_dwordx4 v10, s[4:7], s28 offen offset:256 sc1 lds
  v_smfmac_f32_16x16x64_bf16 v[16:19], v[112:115], a[64:71], v0
  s_waitcnt lgkmcnt(4)
  ds_read_b128 v[76:79], v4 offset:18432
  v_smfmac_f32_16x16x64_bf16 v[16:19], v[84:87], a[72:79], v0
  s_waitcnt lgkmcnt(4)
  ds_read_b128 v[80:83], v4 offset:19456
  v_smfmac_f32_16x16x64_bf16 v[16:19], v[88:91], a[112:119], v0
  s_waitcnt lgkmcnt(4)
  v_smfmac_f32_16x16x64_bf16 v[16:19], v[100:103], a[120:127], v0
  s_add_u32 s24, s36, 145752064
  s_add_u32 s25, s36, 145756160
  v_smfmac_f32_16x16x64_bf16 v[20:23], v[92:95], v[176:183], v0
  s_add_u32 s35, s36, s23
  v_smfmac_f32_16x16x64_bf16 v[20:23], v[96:99], v[184:191], v0
  s_waitcnt lgkmcnt(2)
  v_smfmac_f32_16x16x64_bf16 v[20:23], v[116:119], v[68:75], v0
  s_waitcnt lgkmcnt(0)
  ds_read_b128 v[68:71], v4 offset:20480
  v_mul_f32 v16, s18, v16
  v_smfmac_f32_16x16x64_bf16 v[20:23], v[124:127], v[76:83], v0
  ds_read_b128 v[72:75], v4 offset:21504
  v_mul_f32 v17, s18, v17
  v_smfmac_f32_16x16x64_bf16 v[20:23], v[104:107], a[32:39], v0
  ds_read_b128 v[76:79], v4 offset:22528
  v_mul_f32 v18, s18, v18
  v_smfmac_f32_16x16x64_bf16 v[20:23], v[108:111], a[40:47], v0
  ds_read_b128 v[80:83], v4 offset:23552
  v_mul_f32 v19, s18, v19
  v_smfmac_f32_16x16x64_bf16 v[20:23], v[112:115], a[80:87], v0
  v_cvt_pk_bf16_f32 v120, v16, v17
  v_smfmac_f32_16x16x64_bf16 v[20:23], v[84:87], a[88:95], v0
  v_cvt_pk_bf16_f32 v121, v18, v19
  v_smfmac_f32_16x16x64_bf16 v[20:23], v[88:91], a[128:135], v0
  ds_write_b64 v5, v[120:121] offset:24576
  v_smfmac_f32_16x16x64_bf16 v[20:23], v[100:103], a[136:143], v0
  s_waitcnt lgkmcnt(3)
  v_smfmac_f32_16x16x64_bf16 v[24:27], v[92:95], v[68:75], v0
  s_waitcnt lgkmcnt(1)
  v_mov_b64 v[92:93], 0
  v_smfmac_f32_16x16x64_bf16 v[24:27], v[96:99], v[76:83], v0
  s_nop 1
  v_cvt_pk_bf16_f32 v122, v20, v21
  v_cvt_pk_bf16_f32 v123, v22, v23
  v_smfmac_f32_16x16x64_bf16 v[24:27], v[116:119], v[208:215], v0
  ds_write_b64 v5, v[122:123] offset:26880
  v_mov_b64 v[94:95], 0
  v_smfmac_f32_16x16x64_bf16 v[24:27], v[124:127], v[216:223], v0
  s_waitcnt lgkmcnt(1)
  s_barrier
  ds_read_b64_tr_b16 v[68:69], v6 offset:24576
  v_smfmac_f32_16x16x64_bf16 v[24:27], v[104:107], a[48:55], v0
  s_add_u32 s27, s27, 8192
  ds_read_b64_tr_b16 v[70:71], v6 offset:24640
  ds_read_b64_tr_b16 v[72:73], v6 offset:24832
  v_smfmac_f32_16x16x64_bf16 v[24:27], v[108:111], a[56:63], v0
  s_add_u32 s28, s28, 8192
  ds_read_b64_tr_b16 v[74:75], v6 offset:24896
  ds_read_b64_tr_b16 v[76:77], v6 offset:25088
  v_smfmac_f32_16x16x64_bf16 v[24:27], v[112:115], a[96:103], v0
  s_nop 0
  ds_read_b64_tr_b16 v[78:79], v6 offset:25152
  ds_read_b64_tr_b16 v[80:81], v6 offset:25344
  v_smfmac_f32_16x16x64_bf16 v[24:27], v[84:87], a[104:111], v0
  ds_read_b64_tr_b16 v[82:83], v6 offset:25408
  v_mov_b64 v[96:97], 0
  v_smfmac_f32_16x16x64_bf16 v[24:27], v[88:91], a[144:151], v0
  s_waitcnt lgkmcnt(8)
  s_barrier
  ds_read_b64_tr_b16 v[116:117], v6 offset:26880
  v_smfmac_f32_16x16x64_bf16 v[24:27], v[100:103], a[152:159], v0
  s_waitcnt lgkmcnt(7)
  ds_read_b64_tr_b16 v[118:119], v6 offset:26944
  v_mfma_f32_16x16x32_bf16 v[16:19], v[36:39], v[68:71], 0
  s_waitcnt lgkmcnt(6)
  ds_read_b64_tr_b16 v[124:125], v6 offset:27136
  ds_read_b64_tr_b16 v[126:127], v6 offset:27200
  v_mfma_f32_16x16x32_bf16 v[16:19], v[40:43], v[72:75], v[16:19]
  s_waitcnt lgkmcnt(6)
  ds_read_b64_tr_b16 v[104:105], v6 offset:27392
  ds_read_b64_tr_b16 v[106:107], v6 offset:27456
  v_mfma_f32_16x16x32_bf16 v[16:19], v[44:47], v[76:79], v[16:19]
  s_waitcnt lgkmcnt(6)
  ds_read_b64_tr_b16 v[108:109], v6 offset:27648
  ds_read_b64_tr_b16 v[110:111], v6 offset:27712
  v_mfma_f32_16x16x32_bf16 v[16:19], v[48:51], v[80:83], v[16:19]
  s_waitcnt lgkmcnt(6)
  v_cvt_pk_bf16_f32 v120, v24, v25
  v_cvt_pk_bf16_f32 v121, v26, v27
  v_mfma_f32_16x16x32_bf16 v[112:115], v[116:119], v[68:71], 0
  s_waitcnt lgkmcnt(4)
  v_mov_b64 v[98:99], 0
  v_mfma_f32_16x16x32_bf16 v[112:115], v[124:127], v[72:75], v[112:115]
  s_waitcnt lgkmcnt(2)
  buffer_store_dwordx4 v[120:123], v2, s[4:7], s29 offen offset:1024 sc1
  v_mov_b64 v[36:37], 0
  v_exp_f32 v100, v16
  v_mfma_f32_16x16x32_bf16 v[112:115], v[104:107], v[76:79], v[112:115]
  s_waitcnt lgkmcnt(0)
  v_exp_f32 v101, v17
  v_mfma_f32_16x16x32_bf16 v[112:115], v[108:111], v[80:83], v[112:115]
  v_exp_f32 v102, v18
  v_mfma_f32_16x16x32_bf16 v[20:23], v[52:55], v[68:71], 0
  s_cmp_eq_u32 s14, 63
  v_exp_f32 v103, v19
  v_mfma_f32_16x16x32_bf16 v[20:23], v[56:59], v[72:75], v[20:23]
  s_cbranch_scc1 M_tdone
  v_cvt_pk_bf16_f32 v44, v100, v101
  v_cvt_pk_bf16_f32 v45, v102, v103
  v_mfma_f32_16x16x32_bf16 v[20:23], v[60:63], v[76:79], v[20:23]
  s_add_u32 s29, s29, 131072
  v_exp_f32 v100, v112
  v_mfma_f32_16x16x32_bf16 v[20:23], v[64:67], v[80:83], v[20:23]
  v_exp_f32 v101, v113
  v_exp_f32 v102, v114
  v_exp_f32 v103, v115
  v_cvt_pk_bf16_f32 v84, v100, v101
  v_cvt_pk_bf16_f32 v85, v102, v103
  v_cndmask_b32 v48, v84, 0, s[16:17]
  v_cndmask_b32 v49, v85, 0, s[16:17]
  v_cndmask_b32 v50, 0, v84, s[16:17]
  v_cndmask_b32 v51, 0, v85, s[16:17]
  v_exp_f32 v100, v20
  v_mfma_f32_16x16x16_bf16 v[88:91], v[12:13], v[48:49], 0
  v_exp_f32 v101, v21
  v_mfma_f32_16x16x16_bf16 v[24:27], v[120:121], v[48:49], 0
  v_exp_f32 v102, v22
  v_mfma_f32_16x16x16_bf16 v[116:119], v[120:121], v[50:51], 0
  v_exp_f32 v103, v23
  v_cvt_pk_bf16_f32 v46, v100, v101
  v_cvt_pk_bf16_f32 v47, v102, v103
  v_mov_b64 v[38:39], 0
  s_nop 0
  v_mfma_f32_16x16x32_bf16 v[88:91], v[12:15], v[44:47], v[88:91]
  v_mov_b64 v[40:41], 0
  v_mov_b64 v[42:43], 0
  v_mfma_f32_16x16x32_bf16 v[24:27], v[28:31], v[44:47], v[24:27]
  ds_read_b128 v[52:55], v4 offset:24576
  ds_read_b128 v[56:59], v4 offset:25600
  v_mfma_f32_16x16x32_bf16 v[116:119], v[32:35], v[44:47], v[116:119]
  s_nop 1
  v_rcp_f32 v89, v88
  v_subrev_u32 v100, s54, v88
  v_cmp_le_u32 vcc, s55, v100
  v_mul_f32 v24, v89, v24
  v_mul_f32 v25, v89, v25
  s_cbranch_vccnz T_slow_35
T_back_36:
  v_cvt_pk_bf16_f32 v124, v24, v25
  v_pk_mul_f32 v[26:27], v[26:27], v[88:89] op_sel:[0,1] op_sel_hi:[1,1]
  v_pk_mul_f32 v[116:117], v[116:117], v[88:89] op_sel:[0,1] op_sel_hi:[1,1]
  v_pk_mul_f32 v[118:119], v[118:119], v[88:89] op_sel:[0,1] op_sel_hi:[1,1]
  v_cvt_pk_bf16_f32 v125, v26, v27
  v_cvt_pk_bf16_f32 v126, v116, v117
  v_cvt_pk_bf16_f32 v127, v118, v119
  ds_write_b128 v11, v[124:127] offset:29696
  s_nop 0
  v_smfmac_f32_16x16x64_bf16 v[92:95], v[124:127], a[160:167], v0
  v_smfmac_f32_16x16x64_bf16 v[96:99], v[124:127], a[168:175], v0
  v_smfmac_f32_16x16x64_bf16 v[36:39], v[124:127], a[176:183], v0
  v_smfmac_f32_16x16x64_bf16 v[40:43], v[124:127], a[184:191], v0
  s_waitcnt lgkmcnt(0)
  s_barrier
  ds_read_b128 v[104:107], v11 offset:29184
  ds_read_b128 v[108:111], v11 offset:30720
  ds_read_b128 v[68:71], v11 offset:30208
  s_waitcnt lgkmcnt(2)
  v_smfmac_f32_16x16x64_bf16 v[92:95], v[104:107], a[192:199], v0
  s_waitcnt lgkmcnt(1)
  ds_read_b128 v[76:79], v4 offset:28672
  v_smfmac_f32_16x16x64_bf16 v[92:95], v[108:111], a[224:231], v0
  s_waitcnt lgkmcnt(1)
  ds_read_b128 v[80:83], v4 offset:29696
  v_smfmac_f32_16x16x64_bf16 v[92:95], v[68:71], a[240:247], v0
  ds_read_b128 v[60:63], v4 offset:26624
  v_smfmac_f32_16x16x64_bf16 v[96:99], v[104:107], a[200:207], v0
  ds_read_b128 v[64:67], v4 offset:27648
  v_smfmac_f32_16x16x64_bf16 v[96:99], v[108:111], a[232:239], v0
  ds_read_b128 v[28:31], v4 offset:30720
  s_nop 0
  v_cvt_pk_bf16_f32 v16, v92, v93
  v_cvt_pk_bf16_f32 v17, v94, v95
  v_bfi_b32 v16, 1, s57, v16
  v_smfmac_f32_16x16x64_bf16 v[96:99], v[68:71], a[248:255], v0
  buffer_store_dwordx2 v[16:17], v7, s[4:7], s20 offen offset:0
  v_smfmac_f32_16x16x64_bf16 v[36:39], v[104:107], a[208:215], v0
  ds_read_b128 v[32:35], v4 offset:31744
  v_smfmac_f32_16x16x64_bf16 v[36:39], v[108:111], v[52:59], v0
  s_waitcnt lgkmcnt(4)
  s_nop 0
  v_cvt_pk_bf16_f32 v18, v96, v97
  v_cvt_pk_bf16_f32 v19, v98, v99
  v_bfi_b32 v18, 1, s57, v18
  v_smfmac_f32_16x16x64_bf16 v[36:39], v[68:71], v[76:83], v0
  buffer_store_dwordx2 v[18:19], v7, s[4:7], s20 offen offset:64
  v_smfmac_f32_16x16x64_bf16 v[40:43], v[104:107], a[216:223], v0
  s_waitcnt lgkmcnt(2)
  ds_read_b128 v[116:119], v2 offset:31232
  v_smfmac_f32_16x16x64_bf16 v[40:43], v[108:111], v[60:67], v0
  s_waitcnt lgkmcnt(1)
  s_nop 0
  v_cvt_pk_bf16_f32 v20, v36, v37
  v_cvt_pk_bf16_f32 v21, v38, v39
  v_bfi_b32 v20, 1, s57, v20
  v_smfmac_f32_16x16x64_bf16 v[40:43], v[68:71], v[28:35], v0
  buffer_store_dwordx2 v[20:21], v7, s[4:7], s21 offen offset:0
  s_nop 6
  v_cvt_pk_bf16_f32 v22, v40, v41
  v_cvt_pk_bf16_f32 v23, v42, v43
  v_bfi_b32 v22, 1, s57, v22
  buffer_store_dwordx2 v[22:23], v7, s[4:7], s21 offen offset:64
  ds_read_b128 v[68:71], v4 offset:0
  ds_read_b128 v[72:75], v4 offset:1024
  ds_read_b128 v[76:79], v4 offset:4096
  ds_read_b128 v[80:83], v4 offset:5120
  ds_read_b128 v[84:87], v4 offset:8192
  ds_read_b128 v[88:91], v4 offset:9216
  ds_read_b128 v[92:95], v4 offset:2048
  ds_read_b128 v[96:99], v4 offset:3072
  ds_read_b128 v[100:103], v4 offset:6144
  ds_read_b128 v[104:107], v4 offset:7168
  ds_read_b128 v[108:111], v4 offset:10240
  ds_read_b128 v[112:115], v4 offset:11264
  v_mov_b64 v[16:17], 0
  v_mov_b64 v[18:19], 0
  v_mov_b64 v[20:21], 0
  v_mov_b64 v[22:23], 0
  v_mov_b64 v[24:25], 0
  v_mov_b64 v[26:27], 0
  s_mov_b32 s19, 0
  v_mov_b32 v49, -1
  ds_read_b64 v[44:45], v2 offset:32256
  s_waitcnt lgkmcnt(0)
  v_readfirstlane_b32 s38, v44
  v_readfirstlane_b32 s37, v45
  s_nop 0
  s_lshl_b32 s38, s38, 1
  s_lshl1_add_u32 s37, s37, 1
  s_min_u32 s38, s38, s37
  s_cmp_ge_u32 s38, 64
  s_cselect_b32 s38, 100, s38
  s_sub_u32 s38, s38, 1
  s_max_i32 s30, s30, s38
  s_waitcnt vmcnt(0)
  buffer_load_dwordx4 v[52:55], v2, s[4:7], s22 offen offset:0 sc1
  buffer_load_dwordx4 v[56:59], v2, s[4:7], s22 offen offset:1024 sc1
  buffer_load_dwordx4 v[60:63], v2, s[4:7], s22 offen offset:2048 sc1
  buffer_load_dwordx4 v[64:67], v2, s[4:7], s22 offen offset:3072 sc1
  s_waitcnt lgkmcnt(12)
  s_waitcnt vmcnt(3)
  v_mfma_f32_16x16x32_bf16 v[120:123], v[116:119], v[52:55], 0
  v_xor_b32 v48, s57, v52
  v_bitop3_b32 v48, v48, v54, s57 bitop3:0xf6
  s_waitcnt vmcnt(2)
  v_mfma_f32_16x16x32_bf16 v[120:123], v[116:119], v[56:59], v[120:123]
  v_bitop3_b32 v48, v48, v56, s57 bitop3:0xf6
  v_bitop3_b32 v48, v48, v58, s57 bitop3:0xf6
  s_waitcnt vmcnt(1)
  v_mfma_f32_16x16x32_bf16 v[120:123], v[116:119], v[60:63], v[120:123]
  v_bitop3_b32 v48, v48, v60, s57 bitop3:0xf6
  v_bitop3_b32 v48, v48, v62, s57 bitop3:0xf6
  s_waitcnt vmcnt(0)
  v_mfma_f32_16x16x32_bf16 v[120:123], v[116:119], v[64:67], v[120:123]
  v_bitop3_b32 v48, v48, v64, s57 bitop3:0xf6
  v_bitop3_b32 v48, v48, v66, s57 bitop3:0xf6
  v_and_b32 v48, 1, v48
  v_cmp_ne_u32 vcc, 0, v48
  s_cbranch_vccnz T_p1re_38
T_p1ok_39:
  s_nop 2
  v_add_f32_dpp v120, v120, v120 row_ror:8 row_mask:0xf bank_mask:0xf
  v_add_f32_dpp v121, v121, v121 row_ror:8 row_mask:0xf bank_mask:0xf
  v_cvt_pk_bf16_f32 v48, v120, v121
  buffer_store_dword v48, v8, s[4:7], s35 offen
  buffer_store_dword v49, v8, s[4:7], s26 offen
  s_barrier
  ds_read_b128 v[28:31], v2 offset:17408
  ds_read_b128 v[32:35], v2 offset:21504
  ds_read_b128 v[36:39], v2 offset:8192
  ds_read_b128 v[40:43], v2 offset:9216
  ds_read_b128 v[44:47], v2 offset:10240
  ds_read_b128 v[48:51], v2 offset:11264
  buffer_load_dwordx4 v[124:127], v2, s[4:7], s24 offen offset:1024 sc1
  buffer_load_dwordx4 v[116:119], v2, s[4:7], s25 offen offset:1024 sc1
  ds_read_b128 v[52:55], v2 offset:12288
  ds_read_b128 v[56:59], v2 offset:13312
  ds_read_b128 v[60:63], v2 offset:14336
  ds_read_b128 v[64:67], v2 offset:15360
  buffer_load_dwordx4 v[124:127], v2, s[4:7], s24 offen offset:1024 sc1
  buffer_load_dwordx4 v[116:119], v2, s[4:7], s25 offen offset:1024 sc1
  s_mov_b32 s19, 0
  s_branch T_loop_28
T_p1re_38:
  s_mov_b64 exec, vcc
  buffer_load_dwordx4 v[52:55], v2, s[4:7], s22 offen offset:0 sc1
  buffer_load_dwordx4 v[56:59], v2, s[4:7], s22 offen offset:1024 sc1
  buffer_load_dwordx4 v[60:63], v2, s[4:7], s22 offen offset:2048 sc1
  buffer_load_dwordx4 v[64:67], v2, s[4:7], s22 offen offset:3072 sc1
  s_mov_b64 exec, -1
  s_add_u32 s19, s19, 1
  s_cmp_gt_u32 s19, 32768
  s_cbranch_scc1 M_exit
  s_waitcnt vmcnt(3)
  v_mfma_f32_16x16x32_bf16 v[120:123], v[116:119], v[52:55], 0
  v_xor_b32 v48, s57, v52
  v_bitop3_b32 v48, v48, v54, s57 bitop3:0xf6
  s_waitcnt vmcnt(2)
  v_mfma_f32_16x16x32_bf16 v[120:123], v[116:119], v[56:59], v[120:123]
  v_bitop3_b32 v48, v48, v56, s57 bitop3:0xf6
  v_bitop3_b32 v48, v48, v58, s57 bitop3:0xf6
  s_waitcnt vmcnt(1)
  v_mfma_f32_16x16x32_bf16 v[120:123], v[116:119], v[60:63], v[120:123]
  v_bitop3_b32 v48, v48, v60, s57 bitop3:0xf6
  v_bitop3_b32 v48, v48, v62, s57 bitop3:0xf6
  s_waitcnt vmcnt(0)
  v_mfma_f32_16x16x32_bf16 v[120:123], v[116:119], v[64:67], v[120:123]
  v_bitop3_b32 v48, v48, v64, s57 bitop3:0xf6
  v_bitop3_b32 v48, v48, v66, s57 bitop3:0xf6
  v_and_b32 v48, 1, v48
  v_cmp_ne_u32 vcc, 0, v48
  s_cbranch_vccnz T_p1re_38
  s_branch T_p1ok_39
T_kvw_32:
  s_mov_b32 s19, 0
  s_branch T_kvok_41
T_kv_40:
  s_sleep 4
  s_add_u32 s19, s19, 1
  s_cmp_gt_u32 s19, 32768
  s_cbranch_scc1 M_exit
T_kvok_41:
  s_add_u32 s39, s99, 128
  s_mov_b32 s38, 0
  s_mov_b32 s37, 0
  s_atomic_or s38, s[58:59], s99 glc
  s_atomic_or s37, s[58:59], s39 glc
  s_waitcnt lgkmcnt(0)
  s_lshl_b32 s38, s38, 1
  s_lshl1_add_u32 s37, s37, 1
  s_min_u32 s38, s38, s37
  s_cmp_ge_u32 s38, 64
  s_cselect_b32 s38, 100, s38
  s_sub_u32 s38, s38, 1
  s_max_i32 s30, s30, s38
  s_cmp_ge_i32 s14, s30
  s_cbranch_scc1 T_kv_40
  s_branch T_kvb_33
T_slow_35:
  s_nop 7
  v_max3_f32 v100, v16, v17, v18
  v_max3_f32 v100, v100, v19, v20
  v_max3_f32 v100, v100, v21, v22
  v_max3_f32 v100, v100, v23, v112
  v_max3_f32 v100, v100, v113, v114
  v_max_f32 v100, v100, v115
  v_mov_b32 v101, v100
  s_nop 1
  v_permlane32_swap_b32 v100, v101
  s_nop 1
  v_max_f32 v100, v100, v101
  v_mov_b32 v101, v100
  s_nop 1
  v_permlane16_swap_b32 v100, v101
  s_nop 1
  v_max_f32 v100, v100, v101
  v_sub_f32 v16, v16, v100
  v_sub_f32 v17, v17, v100
  v_sub_f32 v18, v18, v100
  v_sub_f32 v19, v19, v100
  v_exp_f32 v16, v16
  v_exp_f32 v17, v17
  v_exp_f32 v18, v18
  v_exp_f32 v19, v19
  v_sub_f32 v20, v20, v100
  v_sub_f32 v21, v21, v100
  v_sub_f32 v22, v22, v100
  v_sub_f32 v23, v23, v100
  v_exp_f32 v20, v20
  v_exp_f32 v21, v21
  v_exp_f32 v22, v22
  v_exp_f32 v23, v23
  v_sub_f32 v112, v112, v100
  v_sub_f32 v113, v113, v100
  v_sub_f32 v114, v114, v100
  v_sub_f32 v115, v115, v100
  v_exp_f32 v112, v112
  v_exp_f32 v113, v113
  v_exp_f32 v114, v114
  v_exp_f32 v115, v115
  s_nop 0
  v_cvt_pk_bf16_f32 v44, v16, v17
  v_cvt_pk_bf16_f32 v45, v18, v19
  v_cvt_pk_bf16_f32 v46, v20, v21
  v_cvt_pk_bf16_f32 v47, v22, v23
  v_cvt_pk_bf16_f32 v84, v112, v113
  v_cvt_pk_bf16_f32 v85, v114, v115
  v_cndmask_b32 v48, v84, 0, s[16:17]
  v_cndmask_b32 v49, v85, 0, s[16:17]
  v_cndmask_b32 v50, 0, v84, s[16:17]
  v_cndmask_b32 v51, 0, v85, s[16:17]
  s_nop 1
  v_mfma_f32_16x16x16_bf16 v[88:91], v[12:13], v[48:49], 0
  v_mfma_f32_16x16x16_bf16 v[24:27], v[120:121], v[48:49], 0
  v_mfma_f32_16x16x16_bf16 v[116:119], v[120:121], v[50:51], 0
  v_mfma_f32_16x16x32_bf16 v[88:91], v[12:15], v[44:47], v[88:91]
  v_mfma_f32_16x16x32_bf16 v[24:27], v[28:31], v[44:47], v[24:27]
  v_mfma_f32_16x16x32_bf16 v[116:119], v[32:35], v[44:47], v[116:119]
  s_nop 7
  s_nop 1
  v_rcp_f32 v89, v88
  s_nop 0
  v_mul_f32 v24, v89, v24
  v_mul_f32 v25, v89, v25
  s_branch T_back_36
T_w_12:
  s_mov_b32 s19, 0
  v_mov_b64 v[16:17], 0
  v_mov_b64 v[18:19], 0
  v_mov_b64 v[20:21], 0
  v_mov_b64 v[22:23], 0
  v_mov_b64 v[24:25], 0
  v_mov_b64 v[26:27], 0
  buffer_load_dwordx4 v[124:127], v2, s[4:7], s24 offen offset:2048 sc1
  buffer_load_dwordx4 v[116:119], v2, s[4:7], s25 offen offset:2048 sc1
  buffer_load_dwordx4 v[124:127], v2, s[4:7], s24 offen offset:2048 sc1
  buffer_load_dwordx4 v[116:119], v2, s[4:7], s25 offen offset:2048 sc1
  s_branch T_loop_42
.p2align 6
T_retry_43:
  s_mov_b64 exec, vcc
  buffer_load_dwordx4 v[124:127], v2, s[4:7], s24 offen offset:2048 sc1
  buffer_load_dwordx4 v[116:119], v2, s[4:7], s25 offen offset:2048 sc1
  s_mov_b64 exec, -1
  s_add_u32 s19, s19, 1
  s_cmp_gt_u32 s19, 32768
  s_cbranch_scc1 M_exit
T_loop_42:
  s_waitcnt vmcnt(3) lgkmcnt(0)
  v_max3_u32 v123, v124, v125, v126
  v_max_u32 v123, v123, v127
  v_mov_b32_dpp v120, v124 row_ror:8 row_mask:0xf bank_mask:0xf
  v_mov_b32_dpp v121, v125 row_ror:8 row_mask:0xf bank_mask:0xf
  s_waitcnt vmcnt(2)
  v_max3_u32 v123, v123, v116, v117
  v_max3_u32 v123, v123, v118, v119
  v_cmp_eq_u32 vcc, -1, v123
  s_cbranch_vccnz T_retry_43
  v_smfmac_f32_16x16x64_bf16 v[16:19], v[124:127], v[68:75], v0
  s_add_u32 s14, s14, 1
  ds_write_b128 v2, v[124:127] offset:2048
  v_mov_b32_dpp v122, v126 row_ror:8 row_mask:0xf bank_mask:0xf
  v_smfmac_f32_16x16x64_bf16 v[20:23], v[124:127], v[76:83], v0
  s_and_b32 s57, s14, 1
  v_mov_b32_dpp v123, v127 row_ror:8 row_mask:0xf bank_mask:0xf
  v_smfmac_f32_16x16x64_bf16 v[24:27], v[124:127], v[84:91], v0
  s_and_b32 s36, s14, 3
  ds_write_b128 v2, v[116:119] offset:6144
  v_smfmac_f32_16x16x64_bf16 v[16:19], v[120:123], v[92:99], v0
  s_lshl_b32 s36, s36, 13
  v_mov_b32_dpp v84, v116 row_ror:8 row_mask:0xf bank_mask:0xf
  v_smfmac_f32_16x16x64_bf16 v[20:23], v[120:123], v[100:107], v0
  s_add_u32 s26, s36, s23
  ds_read_b128 v[68:71], v4 offset:12288
  v_mov_b32_dpp v85, v117 row_ror:8 row_mask:0xf bank_mask:0xf
  v_smfmac_f32_16x16x64_bf16 v[24:27], v[120:123], v[108:115], v0
  s_add_u32 s36, s36, 8192
  ds_read_b128 v[72:75], v4 offset:13312
  v_mov_b32_dpp v86, v118 row_ror:8 row_mask:0xf bank_mask:0xf
  v_smfmac_f32_16x16x64_bf16 v[16:19], v[116:119], v[224:231], v0
  s_and_b32 s36, s36, 0x7fff
  ds_read_b128 v[76:79], v4 offset:14336
  v_mov_b32_dpp v87, v119 row_ror:8 row_mask:0xf bank_mask:0xf
  v_smfmac_f32_16x16x64_bf16 v[20:23], v[116:119], v[240:247], v0
  s_waitcnt lgkmcnt(3)
  s_barrier
  ds_read_b128 v[100:103], v2 offset:3072
  v_smfmac_f32_16x16x64_bf16 v[24:27], v[116:119], a[0:7], v0
  s_mov_b32 m0, s31
  ds_read_b128 v[120:123], v1 offset:3072
  v_smfmac_f32_16x16x64_bf16 v[16:19], v[84:87], v[232:239], v0
  s_cmp_ge_i32 s14, s30
  s_cbranch_scc1 T_kvw_46
T_kvb_47:
  v_smfmac_f32_16x16x64_bf16 v[20:23], v[84:87], v[248:255], v0
  ds_read_b128 v[80:83], v4 offset:15360
  v_smfmac_f32_16x16x64_bf16 v[24:27], v[84:87], a[8:15], v0
  s_waitcnt lgkmcnt(2)
  v_smfmac_f32_16x16x64_bf16 v[16:19], v[100:103], v[128:135], v0
  ds_read_b128 v[92:95], v2 offset:0
  buffer_load_dwordx4 v9, s[4:7], s27 offen sc1 lds
  v_smfmac_f32_16x16x64_bf16 v[20:23], v[100:103], v[144:151], v0
  ds_read_b128 v[96:99], v1 offset:0
  s_mov_b32 m0, s32
  v_smfmac_f32_16x16x64_bf16 v[24:27], v[100:103], v[68:75], v0
  s_waitcnt vmcnt(1) lgkmcnt(3)
  ds_read_b128 v[116:119], v2 offset:1024
  v_smfmac_f32_16x16x64_bf16 v[16:19], v[120:123], v[136:143], v0
  ds_read_b128 v[124:127], v1 offset:1024
  v_smfmac_f32_16x16x64_bf16 v[20:23], v[120:123], v[152:159], v0
  s_waitcnt lgkmcnt(4)
  ds_read_b128 v[104:107], v2 offset:7168
  buffer_load_dwordx4 v9, s[4:7], s27 offen offset:128 sc1 lds
  v_smfmac_f32_16x16x64_bf16 v[24:27], v[120:123], v[76:83], v0
  s_waitcnt lgkmcnt(4)
  ds_read_b128 v[108:111], v1 offset:7168
  s_mov_b32 m0, s33
  v_smfmac_f32_16x16x64_bf16 v[16:19], v[92:95], v[160:167], v0
  s_waitcnt lgkmcnt(4)
  ds_read_b128 v[112:115], v2 offset:4096
  v_mov_b32 v122, s98
  v_smfmac_f32_16x16x64_bf16 v[16:19], v[96:99], v[168:175], v0
  s_waitcnt lgkmcnt(4)
  ds_read_b128 v[84:87], v1 offset:4096
  v_smfmac_f32_16x16x64_bf16 v[16:19], v[116:119], v[192:199], v0
  s_waitcnt lgkmcnt(4)
  ds_read_b128 v[88:91], v2 offset:5120
  buffer_load_dwordx4 v10, s[4:7], s28 offen sc1 lds
  v_smfmac_f32_16x16x64_bf16 v[16:19], v[124:127], v[200:207], v0
  s_waitcnt lgkmcnt(4)
  ds_read_b128 v[100:103], v1 offset:5120
  s_mov_b32 m0, s34
  v_smfmac_f32_16x16x64_bf16 v[16:19], v[104:107], a[16:23], v0
  s_waitcnt lgkmcnt(4)
  ds_read_b128 v[68:71], v4 offset:16384
  v_smfmac_f32_16x16x64_bf16 v[16:19], v[108:111], a[24:31], v0
  s_waitcnt lgkmcnt(4)
  ds_read_b128 v[72:75], v4 offset:17408
  v_smfmac_f32_16x16x64_bf16 v[16:19], v[112:115], a[64:71], v0
  s_waitcnt lgkmcnt(4)
  ds_read_b128 v[76:79], v4 offset:18432
  buffer_load_dwordx4 v10, s[4:7], s28 offen offset:256 sc1 lds
  v_smfmac_f32_16x16x64_bf16 v[16:19], v[84:87], a[72:79], v0
  s_waitcnt lgkmcnt(4)
  ds_read_b128 v[80:83], v4 offset:19456
  v_smfmac_f32_16x16x64_bf16 v[16:19], v[88:91], a[112:119], v0
  s_waitcnt lgkmcnt(4)
  v_smfmac_f32_16x16x64_bf16 v[16:19], v[100:103], a[120:127], v0
  s_add_u32 s24, s36, 145752064
  s_add_u32 s25, s36, 145756160
  v_smfmac_f32_16x16x64_bf16 v[20:23], v[92:95], v[176:183], v0
  buffer_store_dword v122, v3, s[4:7], s15 offen sc1
  s_add_u32 s35, s36, s23
  v_smfmac_f32_16x16x64_bf16 v[20:23], v[96:99], v[184:191], v0
  s_waitcnt lgkmcnt(2)
  s_add_u32 s98, s14, 1
  v_smfmac_f32_16x16x64_bf16 v[20:23], v[116:119], v[68:75], v0
  s_waitcnt lgkmcnt(0)
  ds_read_b128 v[68:71], v4 offset:20480
  v_mul_f32 v16, s18, v16
  v_smfmac_f32_16x16x64_bf16 v[20:23], v[124:127], v[76:83], v0
  ds_read_b128 v[72:75], v4 offset:21504
  v_mul_f32 v17, s18, v17
  v_smfmac_f32_16x16x64_bf16 v[20:23], v[104:107], a[32:39], v0
  ds_read_b128 v[76:79], v4 offset:22528
  v_mul_f32 v18, s18, v18
  v_smfmac_f32_16x16x64_bf16 v[20:23], v[108:111], a[40:47], v0
  ds_read_b128 v[80:83], v4 offset:23552
  v_mul_f32 v19, s18, v19
  v_smfmac_f32_16x16x64_bf16 v[20:23], v[112:115], a[80:87], v0
  v_cvt_pk_bf16_f32 v120, v16, v17
  v_smfmac_f32_16x16x64_bf16 v[20:23], v[84:87], a[88:95], v0
  v_cvt_pk_bf16_f32 v121, v18, v19
  v_smfmac_f32_16x16x64_bf16 v[20:23], v[88:91], a[128:135], v0
  ds_write_b64 v5, v[120:121] offset:24576
  v_smfmac_f32_16x16x64_bf16 v[20:23], v[100:103], a[136:143], v0
  s_waitcnt lgkmcnt(3)
  v_smfmac_f32_16x16x64_bf16 v[24:27], v[92:95], v[68:75], v0
  s_waitcnt lgkmcnt(1)
  v_mov_b64 v[92:93], 0
  v_smfmac_f32_16x16x64_bf16 v[24:27], v[96:99], v[76:83], v0
  s_nop 1
  v_cvt_pk_bf16_f32 v122, v20, v21
  v_cvt_pk_bf16_f32 v123, v22, v23
  v_smfmac_f32_16x16x64_bf16 v[24:27], v[116:119], v[208:215], v0
  ds_write_b64 v5, v[122:123] offset:26880
  v_mov_b64 v[94:95], 0
  v_smfmac_f32_16x16x64_bf16 v[24:27], v[124:127], v[216:223], v0
  s_waitcnt lgkmcnt(1)
  s_barrier
  ds_read_b64_tr_b16 v[68:69], v6 offset:24576
  v_smfmac_f32_16x16x64_bf16 v[24:27], v[104:107], a[48:55], v0
  s_add_u32 s27, s27, 8192
  ds_read_b64_tr_b16 v[70:71], v6 offset:24640
  ds_read_b64_tr_b16 v[72:73], v6 offset:24832
  v_smfmac_f32_16x16x64_bf16 v[24:27], v[108:111], a[56:63], v0
  s_add_u32 s28, s28, 8192
  ds_read_b64_tr_b16 v[74:75], v6 offset:24896
  ds_read_b64_tr_b16 v[76:77], v6 offset:25088
  v_smfmac_f32_16x16x64_bf16 v[24:27], v[112:115], a[96:103], v0
  s_nop 0
  ds_read_b64_tr_b16 v[78:79], v6 offset:25152
  ds_read_b64_tr_b16 v[80:81], v6 offset:25344
  v_smfmac_f32_16x16x64_bf16 v[24:27], v[84:87], a[104:111], v0
  ds_read_b64_tr_b16 v[82:83], v6 offset:25408
  v_mov_b64 v[96:97], 0
  v_smfmac_f32_16x16x64_bf16 v[24:27], v[88:91], a[144:151], v0
  s_waitcnt lgkmcnt(8)
  s_barrier
  ds_read_b64_tr_b16 v[116:117], v6 offset:26880
  v_smfmac_f32_16x16x64_bf16 v[24:27], v[100:103], a[152:159], v0
  s_waitcnt lgkmcnt(7)
  ds_read_b64_tr_b16 v[118:119], v6 offset:26944
  v_mfma_f32_16x16x32_bf16 v[16:19], v[36:39], v[68:71], 0
  s_waitcnt lgkmcnt(6)
  ds_read_b64_tr_b16 v[124:125], v6 offset:27136
  ds_read_b64_tr_b16 v[126:127], v6 offset:27200
  v_mfma_f32_16x16x32_bf16 v[16:19], v[40:43], v[72:75], v[16:19]
  s_waitcnt lgkmcnt(6)
  ds_read_b64_tr_b16 v[104:105], v6 offset:27392
  ds_read_b64_tr_b16 v[106:107], v6 offset:27456
  v_mfma_f32_16x16x32_bf16 v[16:19], v[44:47], v[76:79], v[16:19]
  s_waitcnt lgkmcnt(6)
  ds_read_b64_tr_b16 v[108:109], v6 offset:27648
  ds_read_b64_tr_b16 v[110:111], v6 offset:27712
  v_mfma_f32_16x16x32_bf16 v[16:19], v[48:51], v[80:83], v[16:19]
  s_waitcnt lgkmcnt(6)
  v_cvt_pk_bf16_f32 v120, v24, v25
  v_cvt_pk_bf16_f32 v121, v26, v27
  v_mfma_f32_16x16x32_bf16 v[112:115], v[116:119], v[68:71], 0
  s_waitcnt lgkmcnt(4)
  v_mov_b64 v[98:99], 0
  v_mfma_f32_16x16x32_bf16 v[112:115], v[124:127], v[72:75], v[112:115]
  s_waitcnt lgkmcnt(2)
  v_mov_b64 v[36:37], 0
  v_exp_f32 v100, v16
  v_mfma_f32_16x16x32_bf16 v[112:115], v[104:107], v[76:79], v[112:115]
  s_waitcnt lgkmcnt(0)
  buffer_store_dwordx4 v[120:123], v2, s[4:7], s29 offen offset:2048 sc1
  v_exp_f32 v101, v17
  v_mfma_f32_16x16x32_bf16 v[112:115], v[108:111], v[80:83], v[112:115]
  v_exp_f32 v102, v18
  v_mfma_f32_16x16x32_bf16 v[20:23], v[52:55], v[68:71], 0
  s_cmp_eq_u32 s14, 63
  v_exp_f32 v103, v19
  v_mfma_f32_16x16x32_bf16 v[20:23], v[56:59], v[72:75], v[20:23]
  s_cbranch_scc1 M_tdone
  v_cvt_pk_bf16_f32 v44, v100, v101
  v_cvt_pk_bf16_f32 v45, v102, v103
  v_mfma_f32_16x16x32_bf16 v[20:23], v[60:63], v[76:79], v[20:23]
  s_add_u32 s29, s29, 131072
  v_exp_f32 v100, v112
  v_mfma_f32_16x16x32_bf16 v[20:23], v[64:67], v[80:83], v[20:23]
  v_exp_f32 v101, v113
  v_exp_f32 v102, v114
  v_exp_f32 v103, v115
  v_cvt_pk_bf16_f32 v84, v100, v101
  v_cvt_pk_bf16_f32 v85, v102, v103
  v_cndmask_b32 v48, v84, 0, s[16:17]
  v_cndmask_b32 v49, v85, 0, s[16:17]
  v_cndmask_b32 v50, 0, v84, s[16:17]
  v_cndmask_b32 v51, 0, v85, s[16:17]
  v_exp_f32 v100, v20
  v_mfma_f32_16x16x16_bf16 v[88:91], v[12:13], v[48:49], 0
  v_exp_f32 v101, v21
  v_mfma_f32_16x16x16_bf16 v[24:27], v[120:121], v[48:49], 0
  v_exp_f32 v102, v22
  v_mfma_f32_16x16x16_bf16 v[116:119], v[120:121], v[50:51], 0
  v_exp_f32 v103, v23
  v_cvt_pk_bf16_f32 v46, v100, v101
  v_cvt_pk_bf16_f32 v47, v102, v103
  v_mov_b64 v[38:39], 0
  s_nop 0
  v_mfma_f32_16x16x32_bf16 v[88:91], v[12:15], v[44:47], v[88:91]
  v_mov_b64 v[40:41], 0
  v_mov_b64 v[42:43], 0
  v_mfma_f32_16x16x32_bf16 v[24:27], v[28:31], v[44:47], v[24:27]
  ds_read_b128 v[52:55], v4 offset:24576
  ds_read_b128 v[56:59], v4 offset:25600
  v_mfma_f32_16x16x32_bf16 v[116:119], v[32:35], v[44:47], v[116:119]
  s_nop 1
  v_rcp_f32 v89, v88
  v_subrev_u32 v100, s54, v88
  v_cmp_le_u32 vcc, s55, v100
  v_mul_f32 v24, v89, v24
  v_mul_f32 v25, v89, v25
  s_cbranch_vccnz T_slow_49
T_back_50:
  v_cvt_pk_bf16_f32 v124, v24, v25
  v_pk_mul_f32 v[26:27], v[26:27], v[88:89] op_sel:[0,1] op_sel_hi:[1,1]
  v_pk_mul_f32 v[116:117], v[116:117], v[88:89] op_sel:[0,1] op_sel_hi:[1,1]
  v_pk_mul_f32 v[118:119], v[118:119], v[88:89] op_sel:[0,1] op_sel_hi:[1,1]
  v_cvt_pk_bf16_f32 v125, v26, v27
  v_cvt_pk_bf16_f32 v126, v116, v117
  v_cvt_pk_bf16_f32 v127, v118, v119
  ds_write_b128 v11, v[124:127] offset:30208
  s_nop 0
  v_smfmac_f32_16x16x64_bf16 v[92:95], v[124:127], a[160:167], v0
  v_smfmac_f32_16x16x64_bf16 v[96:99], v[124:127], a[168:175], v0
  v_smfmac_f32_16x16x64_bf16 v[36:39], v[124:127], a[176:183], v0
  v_smfmac_f32_16x16x64_bf16 v[40:43], v[124:127], a[184:191], v0
  s_waitcnt lgkmcnt(0)
  s_barrier
  ds_read_b128 v[104:107], v11 offset:30720
  ds_read_b128 v[108:111], v11 offset:29184
  ds_read_b128 v[68:71], v11 offset:29696
  s_waitcnt lgkmcnt(2)
  v_smfmac_f32_16x16x64_bf16 v[92:95], v[104:107], a[192:199], v0
  s_waitcnt lgkmcnt(1)
  ds_read_b128 v[76:79], v4 offset:28672
  v_smfmac_f32_16x16x64_bf16 v[92:95], v[108:111], a[224:231], v0
  s_waitcnt lgkmcnt(1)
  ds_read_b128 v[80:83], v4 offset:29696
  v_smfmac_f32_16x16x64_bf16 v[92:95], v[68:71], a[240:247], v0
  ds_read_b128 v[60:63], v4 offset:26624
  v_smfmac_f32_16x16x64_bf16 v[96:99], v[104:107], a[200:207], v0
  ds_read_b128 v[64:67], v4 offset:27648
  v_smfmac_f32_16x16x64_bf16 v[96:99], v[108:111], a[232:239], v0
  ds_read_b128 v[28:31], v4 offset:30720
  s_nop 0
  v_cvt_pk_bf16_f32 v16, v92, v93
  v_cvt_pk_bf16_f32 v17, v94, v95
  v_bfi_b32 v16, 1, s57, v16
  v_smfmac_f32_16x16x64_bf16 v[96:99], v[68:71], a[248:255], v0
  buffer_store_dwordx2 v[16:17], v7, s[4:7], s20 offen offset:0
  v_smfmac_f32_16x16x64_bf16 v[36:39], v[104:107], a[208:215], v0
  ds_read_b128 v[32:35], v4 offset:31744
  v_smfmac_f32_16x16x64_bf16 v[36:39], v[108:111], v[52:59], v0
  s_waitcnt lgkmcnt(4)
  s_nop 0
  v_cvt_pk_bf16_f32 v18, v96, v97
  v_cvt_pk_bf16_f32 v19, v98, v99
  v_bfi_b32 v18, 1, s57, v18
  v_smfmac_f32_16x16x64_bf16 v[36:39], v[68:71], v[76:83], v0
  buffer_store_dwordx2 v[18:19], v7, s[4:7], s20 offen offset:64
  v_smfmac_f32_16x16x64_bf16 v[40:43], v[104:107], a[216:223], v0
  s_waitcnt lgkmcnt(2)
  v_smfmac_f32_16x16x64_bf16 v[40:43], v[108:111], v[60:67], v0
  s_waitcnt lgkmcnt(0)
  s_nop 0
  v_cvt_pk_bf16_f32 v20, v36, v37
  v_cvt_pk_bf16_f32 v21, v38, v39
  v_bfi_b32 v20, 1, s57, v20
  v_smfmac_f32_16x16x64_bf16 v[40:43], v[68:71], v[28:35], v0
  buffer_store_dwordx2 v[20:21], v7, s[4:7], s21 offen offset:0
  s_nop 6
  v_cvt_pk_bf16_f32 v22, v40, v41
  v_cvt_pk_bf16_f32 v23, v42, v43
  v_bfi_b32 v22, 1, s57, v22
  buffer_store_dwordx2 v[22:23], v7, s[4:7], s21 offen offset:64
  ds_read_b128 v[68:71], v4 offset:0
  ds_read_b128 v[72:75], v4 offset:1024
  ds_read_b128 v[76:79], v4 offset:4096
  ds_read_b128 v[80:83], v4 offset:5120
  ds_read_b128 v[84:87], v4 offset:8192
  ds_read_b128 v[88:91], v4 offset:9216
  ds_read_b128 v[92:95], v4 offset:2048
  ds_read_b128 v[96:99], v4 offset:3072
  ds_read_b128 v[100:103], v4 offset:6144
  ds_read_b128 v[104:107], v4 offset:7168
  ds_read_b128 v[108:111], v4 offset:10240
  ds_read_b128 v[112:115], v4 offset:11264
  v_mov_b64 v[16:17], 0
  v_mov_b64 v[18:19], 0
  v_mov_b64 v[20:21], 0
  v_mov_b64 v[22:23], 0
  v_mov_b64 v[24:25], 0
  v_mov_b64 v[26:27], 0
  ds_read_b64 v[44:45], v2 offset:32256
  s_waitcnt lgkmcnt(0)
  v_readfirstlane_b32 s38, v44
  v_readfirstlane_b32 s37, v45
  s_nop 0
  s_lshl_b32 s38, s38, 1
  s_lshl1_add_u32 s37, s37, 1
  s_min_u32 s38, s38, s37
  s_cmp_ge_u32 s38, 64
  s_cselect_b32 s38, 100, s38
  s_sub_u32 s38, s38, 1
  s_max_i32 s30, s30, s38
  s_waitcnt vmcnt(4)
  s_barrier
  ds_read_b128 v[28:31], v2 offset:18432
  ds_read_b128 v[32:35], v2 offset:22528
  ds_read_b128 v[36:39], v2 offset:8192
  ds_read_b128 v[40:43], v2 offset:9216
  ds_read_b128 v[44:47], v2 offset:10240
  ds_read_b128 v[48:51], v2 offset:11264
  buffer_load_dwordx4 v[124:127], v2, s[4:7], s24 offen offset:2048 sc1
  buffer_load_dwordx4 v[116:119], v2, s[4:7], s25 offen offset:2048 sc1
  ds_read_b128 v[52:55], v2 offset:12288
  ds_read_b128 v[56:59], v2 offset:13312
  ds_read_b128 v[60:63], v2 offset:14336
  ds_read_b128 v[64:67], v2 offset:15360
  buffer_load_dwordx4 v[124:127], v2, s[4:7], s24 offen offset:2048 sc1
  buffer_load_dwordx4 v[116:119], v2, s[4:7], s25 offen offset:2048 sc1
  s_mov_b32 s19, 0
  s_branch T_loop_42
T_kvw_46:
  s_mov_b32 s19, 0
  s_branch T_kvok_55
T_kv_54:
  s_sleep 4
  s_add_u32 s19, s19, 1
  s_cmp_gt_u32 s19, 32768
  s_cbranch_scc1 M_exit
T_kvok_55:
  s_add_u32 s39, s99, 128
  s_mov_b32 s38, 0
  s_mov_b32 s37, 0
  s_atomic_or s38, s[58:59], s99 glc
  s_atomic_or s37, s[58:59], s39 glc
  s_waitcnt lgkmcnt(0)
  s_lshl_b32 s38, s38, 1
  s_lshl1_add_u32 s37, s37, 1
  s_min_u32 s38, s38, s37
  s_cmp_ge_u32 s38, 64
  s_cselect_b32 s38, 100, s38
  s_sub_u32 s38, s38, 1
  s_max_i32 s30, s30, s38
  s_cmp_ge_i32 s14, s30
  s_cbranch_scc1 T_kv_54
  s_branch T_kvb_47
T_slow_49:
  s_nop 7
  v_max3_f32 v100, v16, v17, v18
  v_max3_f32 v100, v100, v19, v20
  v_max3_f32 v100, v100, v21, v22
  v_max3_f32 v100, v100, v23, v112
  v_max3_f32 v100, v100, v113, v114
  v_max_f32 v100, v100, v115
  v_mov_b32 v101, v100
  s_nop 1
  v_permlane32_swap_b32 v100, v101
  s_nop 1
  v_max_f32 v100, v100, v101
  v_mov_b32 v101, v100
  s_nop 1
  v_permlane16_swap_b32 v100, v101
  s_nop 1
  v_max_f32 v100, v100, v101
  v_sub_f32 v16, v16, v100
  v_sub_f32 v17, v17, v100
  v_sub_f32 v18, v18, v100
  v_sub_f32 v19, v19, v100
  v_exp_f32 v16, v16
  v_exp_f32 v17, v17
  v_exp_f32 v18, v18
  v_exp_f32 v19, v19
  v_sub_f32 v20, v20, v100
  v_sub_f32 v21, v21, v100
  v_sub_f32 v22, v22, v100
  v_sub_f32 v23, v23, v100
  v_exp_f32 v20, v20
  v_exp_f32 v21, v21
  v_exp_f32 v22, v22
  v_exp_f32 v23, v23
  v_sub_f32 v112, v112, v100
  v_sub_f32 v113, v113, v100
  v_sub_f32 v114, v114, v100
  v_sub_f32 v115, v115, v100
  v_exp_f32 v112, v112
  v_exp_f32 v113, v113
  v_exp_f32 v114, v114
  v_exp_f32 v115, v115
  s_nop 0
  v_cvt_pk_bf16_f32 v44, v16, v17
  v_cvt_pk_bf16_f32 v45, v18, v19
  v_cvt_pk_bf16_f32 v46, v20, v21
  v_cvt_pk_bf16_f32 v47, v22, v23
  v_cvt_pk_bf16_f32 v84, v112, v113
  v_cvt_pk_bf16_f32 v85, v114, v115
  v_cndmask_b32 v48, v84, 0, s[16:17]
  v_cndmask_b32 v49, v85, 0, s[16:17]
  v_cndmask_b32 v50, 0, v84, s[16:17]
  v_cndmask_b32 v51, 0, v85, s[16:17]
  s_nop 1
  v_mfma_f32_16x16x16_bf16 v[88:91], v[12:13], v[48:49], 0
  v_mfma_f32_16x16x16_bf16 v[24:27], v[120:121], v[48:49], 0
  v_mfma_f32_16x16x16_bf16 v[116:119], v[120:121], v[50:51], 0
  v_mfma_f32_16x16x32_bf16 v[88:91], v[12:15], v[44:47], v[88:91]
  v_mfma_f32_16x16x32_bf16 v[24:27], v[28:31], v[44:47], v[24:27]
  v_mfma_f32_16x16x32_bf16 v[116:119], v[32:35], v[44:47], v[116:119]
  s_nop 7
  s_nop 1
  v_rcp_f32 v89, v88
  s_nop 0
  v_mul_f32 v24, v89, v24
  v_mul_f32 v25, v89, v25
  s_branch T_back_50
T_w_13:
  s_mov_b32 s19, 0
  v_mov_b64 v[16:17], 0
  v_mov_b64 v[18:19], 0
  v_mov_b64 v[20:21], 0
  v_mov_b64 v[22:23], 0
  v_mov_b64 v[24:25], 0
  v_mov_b64 v[26:27], 0
  buffer_load_dwordx4 v[124:127], v2, s[4:7], s24 offen offset:3072 sc1
  buffer_load_dwordx4 v[116:119], v2, s[4:7], s25 offen offset:3072 sc1
  buffer_load_dwordx4 v[124:127], v2, s[4:7], s24 offen offset:3072 sc1
  buffer_load_dwordx4 v[116:119], v2, s[4:7], s25 offen offset:3072 sc1
  s_branch T_loop_56
.p2align 6
T_retry_57:
  s_mov_b64 exec, vcc
  buffer_load_dwordx4 v[124:127], v2, s[4:7], s24 offen offset:3072 sc1
  buffer_load_dwordx4 v[116:119], v2, s[4:7], s25 offen offset:3072 sc1
  s_mov_b64 exec, -1
  s_add_u32 s19, s19, 1
  s_cmp_gt_u32 s19, 32768
  s_cbranch_scc1 M_exit
T_loop_56:
  s_waitcnt vmcnt(3) lgkmcnt(0)
  v_max3_u32 v123, v124, v125, v126
  v_max_u32 v123, v123, v127
  v_mov_b32_dpp v120, v124 row_ror:8 row_mask:0xf bank_mask:0xf
  v_mov_b32_dpp v121, v125 row_ror:8 row_mask:0xf bank_mask:0xf
  s_waitcnt vmcnt(2)
  v_max3_u32 v123, v123, v116, v117
  v_max3_u32 v123, v123, v118, v119
  v_cmp_eq_u32 vcc, -1, v123
  s_cbranch_vccnz T_retry_57
  v_smfmac_f32_16x16x64_bf16 v[16:19], v[124:127], v[68:75], v0
  s_add_u32 s14, s14, 1
  ds_write_b128 v2, v[124:127] offset:3072
  v_mov_b32_dpp v122, v126 row_ror:8 row_mask:0xf bank_mask:0xf
  v_smfmac_f32_16x16x64_bf16 v[20:23], v[124:127], v[76:83], v0
  s_and_b32 s57, s14, 1
  v_mov_b32_dpp v123, v127 row_ror:8 row_mask:0xf bank_mask:0xf
  v_smfmac_f32_16x16x64_bf16 v[24:27], v[124:127], v[84:91], v0
  s_and_b32 s36, s14, 3
  ds_write_b128 v2, v[116:119] offset:7168
  v_smfmac_f32_16x16x64_bf16 v[16:19], v[120:123], v[92:99], v0
  s_lshl_b32 s36, s36, 13
  v_mov_b32_dpp v84, v116 row_ror:8 row_mask:0xf bank_mask:0xf
  v_smfmac_f32_16x16x64_bf16 v[20:23], v[120:123], v[100:107], v0
  s_add_u32 s26, s36, s23
  ds_read_b128 v[68:71], v4 offset:12288
  v_mov_b32_dpp v85, v117 row_ror:8 row_mask:0xf bank_mask:0xf
  v_smfmac_f32_16x16x64_bf16 v[24:27], v[120:123], v[108:115], v0
  s_add_u32 s36, s36, 8192
  ds_read_b128 v[72:75], v4 offset:13312
  v_mov_b32_dpp v86, v118 row_ror:8 row_mask:0xf bank_mask:0xf
  v_smfmac_f32_16x16x64_bf16 v[16:19], v[116:119], v[224:231], v0
  s_and_b32 s36, s36, 0x7fff
  ds_read_b128 v[76:79], v4 offset:14336
  v_mov_b32_dpp v87, v119 row_ror:8 row_mask:0xf bank_mask:0xf
  v_smfmac_f32_16x16x64_bf16 v[20:23], v[116:119], v[240:247], v0
  s_waitcnt lgkmcnt(3)
  s_barrier
  ds_read_b128 v[100:103], v2 offset:2048
  v_smfmac_f32_16x16x64_bf16 v[24:27], v[116:119], a[0:7], v0
  s_mov_b32 m0, s31
  ds_read_b128 v[120:123], v1 offset:2048
  v_smfmac_f32_16x16x64_bf16 v[16:19], v[84:87], v[232:239], v0
  s_cmp_ge_i32 s14, s30
  s_cbranch_scc1 T_kvw_60
T_kvb_61:
  v_smfmac_f32_16x16x64_bf16 v[20:23], v[84:87], v[248:255], v0
  ds_read_b128 v[80:83], v4 offset:15360
  v_smfmac_f32_16x16x64_bf16 v[24:27], v[84:87], a[8:15], v0
  s_waitcnt lgkmcnt(2)
  v_smfmac_f32_16x16x64_bf16 v[16:19], v[100:103], v[128:135], v0
  ds_read_b128 v[92:95], v2 offset:1024
  v_smfmac_f32_16x16x64_bf16 v[20:23], v[100:103], v[144:151], v0
  ds_read_b128 v[96:99], v1 offset:1024
  buffer_load_dwordx4 v9, s[4:7], s27 offen sc1 lds
  v_smfmac_f32_16x16x64_bf16 v[24:27], v[100:103], v[68:75], v0
  s_waitcnt vmcnt(1) lgkmcnt(3)
  ds_read_b128 v[116:119], v2 offset:0
  s_mov_b32 m0, s32
  v_smfmac_f32_16x16x64_bf16 v[16:19], v[120:123], v[136:143], v0
  ds_read_b128 v[124:127], v1 offset:0
  v_smfmac_f32_16x16x64_bf16 v[20:23], v[120:123], v[152:159], v0
  s_waitcnt lgkmcnt(4)
  ds_read_b128 v[104:107], v2 offset:6144
  v_smfmac_f32_16x16x64_bf16 v[24:27], v[120:123], v[76:83], v0
  s_waitcnt lgkmcnt(4)
  ds_read_b128 v[108:111], v1 offset:6144
  buffer_load_dwordx4 v9, s[4:7], s27 offen offset:128 sc1 lds
  v_smfmac_f32_16x16x64_bf16 v[16:19], v[92:95], v[160:167], v0
  s_waitcnt lgkmcnt(4)
  ds_read_b128 v[112:115], v2 offset:5120
  s_mov_b32 m0, s33
  v_smfmac_f32_16x16x64_bf16 v[16:19], v[96:99], v[168:175], v0
  s_waitcnt lgkmcnt(4)
  ds_read_b128 v[84:87], v1 offset:5120
  v_smfmac_f32_16x16x64_bf16 v[16:19], v[116:119], v[192:199], v0
  s_waitcnt lgkmcnt(4)
  ds_read_b128 v[88:91], v2 offset:4096
  v_smfmac_f32_16x16x64_bf16 v[16:19], v[124:127], v[200:207], v0
  s_waitcnt lgkmcnt(4)
  ds_read_b128 v[100:103], v1 offset:4096
  buffer_load_dwordx4 v10, s[4:7], s28 offen sc1 lds
  v_smfmac_f32_16x16x64_bf16 v[16:19], v[104:107], a[16:23], v0
  s_waitcnt lgkmcnt(4)
  ds_read_b128 v[68:71], v4 offset:16384
  s_mov_b32 m0, s34
  v_smfmac_f32_16x16x64_bf16 v[16:19], v[108:111], a[24:31], v0
  s_waitcnt lgkmcnt(4)
  ds_read_b128 v[72:75], v4 offset:17408
  v_smfmac_f32_16x16x64_bf16 v[16:19], v[112:115], a[64:71], v0
  s_waitcnt lgkmcnt(4)
  ds_read_b128 v[76:79], v4 offset:18432
  v_smfmac_f32_16x16x64_bf16 v[16:19], v[84:87], a[72:79], v0
  s_waitcnt lgkmcnt(4)
  ds_read_b128 v[80:83], v4 offset:19456
  buffer_load_dwordx4 v10, s[4:7], s28 offen offset:256 sc1 lds
  v_smfmac_f32_16x16x64_bf16 v[16:19], v[88:91], a[112:119], v0
  s_waitcnt lgkmcnt(4)
  s_mov_b32 m0, 32256
  v_smfmac_f32_16x16x64_bf16 v[16:19], v[100:103], a[120:127], v0
  s_add_u32 s24, s36, 145752064
  s_add_u32 s25, s36, 145756160
  v_smfmac_f32_16x16x64_bf16 v[20:23], v[92:95], v[176:183], v0
  s_add_u32 s35, s36, s23
  v_smfmac_f32_16x16x64_bf16 v[20:23], v[96:99], v[184:191], v0
  s_waitcnt lgkmcnt(2)
  buffer_load_dword v3, s[4:7], s99 offen sc1 lds
  v_smfmac_f32_16x16x64_bf16 v[20:23], v[116:119], v[68:75], v0
  s_waitcnt lgkmcnt(0)
  ds_read_b128 v[68:71], v4 offset:20480
  v_mul_f32 v16, s18, v16
  v_smfmac_f32_16x16x64_bf16 v[20:23], v[124:127], v[76:83], v0
  ds_read_b128 v[72:75], v4 offset:21504
  v_mul_f32 v17, s18, v17
  v_smfmac_f32_16x16x64_bf16 v[20:23], v[104:107], a[32:39], v0
  ds_read_b128 v[76:79], v4 offset:22528
  v_mul_f32 v18, s18, v18
  v_smfmac_f32_16x16x64_bf16 v[20:23], v[108:111], a[40:47], v0
  ds_read_b128 v[80:83], v4 offset:23552
  v_mul_f32 v19, s18, v19
  v_smfmac_f32_16x16x64_bf16 v[20:23], v[112:115], a[80:87], v0
  v_cvt_pk_bf16_f32 v120, v16, v17
  v_smfmac_f32_16x16x64_bf16 v[20:23], v[84:87], a[88:95], v0
  v_cvt_pk_bf16_f32 v121, v18, v19
  v_smfmac_f32_16x16x64_bf16 v[20:23], v[88:91], a[128:135], v0
  ds_write_b64 v5, v[120:121] offset:24576
  v_smfmac_f32_16x16x64_bf16 v[20:23], v[100:103], a[136:143], v0
  s_waitcnt lgkmcnt(3)
  v_smfmac_f32_16x16x64_bf16 v[24:27], v[92:95], v[68:75], v0
  s_waitcnt lgkmcnt(1)
  v_mov_b64 v[92:93], 0
  v_smfmac_f32_16x16x64_bf16 v[24:27], v[96:99], v[76:83], v0
  s_nop 1
  v_cvt_pk_bf16_f32 v122, v20, v21
  v_cvt_pk_bf16_f32 v123, v22, v23
  v_smfmac_f32_16x16x64_bf16 v[24:27], v[116:119], v[208:215], v0
  ds_write_b64 v5, v[122:123] offset:26880
  v_mov_b64 v[94:95], 0
  v_smfmac_f32_16x16x64_bf16 v[24:27], v[124:127], v[216:223], v0
  s_waitcnt lgkmcnt(1)
  s_barrier
  ds_read_b64_tr_b16 v[68:69], v6 offset:24576
  v_smfmac_f32_16x16x64_bf16 v[24:27], v[104:107], a[48:55], v0
  s_add_u32 s27, s27, 8192
  ds_read_b64_tr_b16 v[70:71], v6 offset:24640
  ds_read_b64_tr_b16 v[72:73], v6 offset:24832
  v_smfmac_f32_16x16x64_bf16 v[24:27], v[108:111], a[56:63], v0
  s_add_u32 s28, s28, 8192
  ds_read_b64_tr_b16 v[74:75], v6 offset:24896
  ds_read_b64_tr_b16 v[76:77], v6 offset:25088
  v_smfmac_f32_16x16x64_bf16 v[24:27], v[112:115], a[96:103], v0
  s_nop 0
  ds_read_b64_tr_b16 v[78:79], v6 offset:25152
  ds_read_b64_tr_b16 v[80:81], v6 offset:25344
  v_smfmac_f32_16x16x64_bf16 v[24:27], v[84:87], a[104:111], v0
  ds_read_b64_tr_b16 v[82:83], v6 offset:25408
  v_mov_b64 v[96:97], 0
  v_smfmac_f32_16x16x64_bf16 v[24:27], v[88:91], a[144:151], v0
  s_waitcnt lgkmcnt(8)
  s_barrier
  ds_read_b64_tr_b16 v[116:117], v6 offset:26880
  v_smfmac_f32_16x16x64_bf16 v[24:27], v[100:103], a[152:159], v0
  s_waitcnt lgkmcnt(7)
  ds_read_b64_tr_b16 v[118:119], v6 offset:26944
  v_mfma_f32_16x16x32_bf16 v[16:19], v[36:39], v[68:71], 0
  s_waitcnt lgkmcnt(6)
  ds_read_b64_tr_b16 v[124:125], v6 offset:27136
  ds_read_b64_tr_b16 v[126:127], v6 offset:27200
  v_mfma_f32_16x16x32_bf16 v[16:19], v[40:43], v[72:75], v[16:19]
  s_waitcnt lgkmcnt(6)
  ds_read_b64_tr_b16 v[104:105], v6 offset:27392
  ds_read_b64_tr_b16 v[106:107], v6 offset:27456
  v_mfma_f32_16x16x32_bf16 v[16:19], v[44:47], v[76:79], v[16:19]
  s_waitcnt lgkmcnt(6)
  ds_read_b64_tr_b16 v[108:109], v6 offset:27648
  ds_read_b64_tr_b16 v[110:111], v6 offset:27712
  v_mfma_f32_16x16x32_bf16 v[16:19], v[48:51], v[80:83], v[16:19]
  s_waitcnt lgkmcnt(6)
  v_cvt_pk_bf16_f32 v120, v24, v25
  v_cvt_pk_bf16_f32 v121, v26, v27
  v_mfma_f32_16x16x32_bf16 v[112:115], v[116:119], v[68:71], 0
  s_waitcnt lgkmcnt(4)
  v_mov_b64 v[98:99], 0
  v_mfma_f32_16x16x32_bf16 v[112:115], v[124:127], v[72:75], v[112:115]
  s_waitcnt lgkmcnt(2)
  v_mov_b64 v[36:37], 0
  v_exp_f32 v100, v16
  v_mfma_f32_16x16x32_bf16 v[112:115], v[104:107], v[76:79], v[112:115]
  s_waitcnt lgkmcnt(0)
  v_exp_f32 v101, v17
  v_mfma_f32_16x16x32_bf16 v[112:115], v[108:111], v[80:83], v[112:115]
  buffer_store_dwordx4 v[120:123], v2, s[4:7], s29 offen offset:3072 sc1
  v_exp_f32 v102, v18
  v_mfma_f32_16x16x32_bf16 v[20:23], v[52:55], v[68:71], 0
  s_cmp_eq_u32 s14, 63
  v_exp_f32 v103, v19
  v_mfma_f32_16x16x32_bf16 v[20:23], v[56:59], v[72:75], v[20:23]
  s_cbranch_scc1 M_tdone
  v_cvt_pk_bf16_f32 v44, v100, v101
  v_cvt_pk_bf16_f32 v45, v102, v103
  v_mfma_f32_16x16x32_bf16 v[20:23], v[60:63], v[76:79], v[20:23]
  s_add_u32 s29, s29, 131072
  v_exp_f32 v100, v112
  v_mfma_f32_16x16x32_bf16 v[20:23], v[64:67], v[80:83], v[20:23]
  v_exp_f32 v101, v113
  v_exp_f32 v102, v114
  v_exp_f32 v103, v115
  v_cvt_pk_bf16_f32 v84, v100, v101
  v_cvt_pk_bf16_f32 v85, v102, v103
  v_cndmask_b32 v48, v84, 0, s[16:17]
  v_cndmask_b32 v49, v85, 0, s[16:17]
  v_cndmask_b32 v50, 0, v84, s[16:17]
  v_cndmask_b32 v51, 0, v85, s[16:17]
  v_exp_f32 v100, v20
  v_mfma_f32_16x16x16_bf16 v[88:91], v[12:13], v[48:49], 0
  v_exp_f32 v101, v21
  v_mfma_f32_16x16x16_bf16 v[24:27], v[120:121], v[48:49], 0
  v_exp_f32 v102, v22
  v_mfma_f32_16x16x16_bf16 v[116:119], v[120:121], v[50:51], 0
  v_exp_f32 v103, v23
  v_cvt_pk_bf16_f32 v46, v100, v101
  v_cvt_pk_bf16_f32 v47, v102, v103
  v_mov_b64 v[38:39], 0
  s_nop 0
  v_mfma_f32_16x16x32_bf16 v[88:91], v[12:15], v[44:47], v[88:91]
  v_mov_b64 v[40:41], 0
  v_mov_b64 v[42:43], 0
  v_mfma_f32_16x16x32_bf16 v[24:27], v[28:31], v[44:47], v[24:27]
  ds_read_b128 v[52:55], v4 offset:24576
  ds_read_b128 v[56:59], v4 offset:25600
  v_mfma_f32_16x16x32_bf16 v[116:119], v[32:35], v[44:47], v[116:119]
  s_nop 1
  v_rcp_f32 v89, v88
  v_subrev_u32 v100, s54, v88
  v_cmp_le_u32 vcc, s55, v100
  v_mul_f32 v24, v89, v24
  v_mul_f32 v25, v89, v25
  s_cbranch_vccnz T_slow_63
T_back_64:
  v_cvt_pk_bf16_f32 v124, v24, v25
  v_pk_mul_f32 v[26:27], v[26:27], v[88:89] op_sel:[0,1] op_sel_hi:[1,1]
  v_pk_mul_f32 v[116:117], v[116:117], v[88:89] op_sel:[0,1] op_sel_hi:[1,1]
  v_pk_mul_f32 v[118:119], v[118:119], v[88:89] op_sel:[0,1] op_sel_hi:[1,1]
  v_cvt_pk_bf16_f32 v125, v26, v27
  v_cvt_pk_bf16_f32 v126, v116, v117
  v_cvt_pk_bf16_f32 v127, v118, v119
  ds_write_b128 v11, v[124:127] offset:30720
  s_nop 0
  v_smfmac_f32_16x16x64_bf16 v[92:95], v[124:127], a[160:167], v0
  v_smfmac_f32_16x16x64_bf16 v[96:99], v[124:127], a[168:175], v0
  v_smfmac_f32_16x16x64_bf16 v[36:39], v[124:127], a[176:183], v0
  v_smfmac_f32_16x16x64_bf16 v[40:43], v[124:127], a[184:191], v0
  s_waitcnt lgkmcnt(0)
  s_barrier
  ds_read_b128 v[104:107], v11 offset:30208
  ds_read_b128 v[108:111], v11 offset:29696
  ds_read_b128 v[68:71], v11 offset:29184
  s_waitcnt lgkmcnt(2)
  v_smfmac_f32_16x16x64_bf16 v[92:95], v[104:107], a[192:199], v0
  s_waitcnt lgkmcnt(1)
  ds_read_b128 v[76:79], v4 offset:28672
  v_smfmac_f32_16x16x64_bf16 v[92:95], v[108:111], a[224:231], v0
  s_waitcnt lgkmcnt(1)
  ds_read_b128 v[80:83], v4 offset:29696
  v_smfmac_f32_16x16x64_bf16 v[92:95], v[68:71], a[240:247], v0
  ds_read_b128 v[60:63], v4 offset:26624
  v_smfmac_f32_16x16x64_bf16 v[96:99], v[104:107], a[200:207], v0
  ds_read_b128 v[64:67], v4 offset:27648
  v_smfmac_f32_16x16x64_bf16 v[96:99], v[108:111], a[232:239], v0
  ds_read_b128 v[28:31], v4 offset:30720
  s_nop 0
  v_cvt_pk_bf16_f32 v16, v92, v93
  v_cvt_pk_bf16_f32 v17, v94, v95
  v_bfi_b32 v16, 1, s57, v16
  v_smfmac_f32_16x16x64_bf16 v[96:99], v[68:71], a[248:255], v0
  buffer_store_dwordx2 v[16:17], v7, s[4:7], s20 offen offset:0
  v_smfmac_f32_16x16x64_bf16 v[36:39], v[104:107], a[208:215], v0
  ds_read_b128 v[32:35], v4 offset:31744
  v_smfmac_f32_16x16x64_bf16 v[36:39], v[108:111], v[52:59], v0
  s_waitcnt lgkmcnt(4)
  s_nop 0
  v_cvt_pk_bf16_f32 v18, v96, v97
  v_cvt_pk_bf16_f32 v19, v98, v99
  v_bfi_b32 v18, 1, s57, v18
  v_smfmac_f32_16x16x64_bf16 v[36:39], v[68:71], v[76:83], v0
  buffer_store_dwordx2 v[18:19], v7, s[4:7], s20 offen offset:64
  v_smfmac_f32_16x16x64_bf16 v[40:43], v[104:107], a[216:223], v0
  s_waitcnt lgkmcnt(2)
  v_smfmac_f32_16x16x64_bf16 v[40:43], v[108:111], v[60:67], v0
  s_waitcnt lgkmcnt(0)
  s_nop 0
  v_cvt_pk_bf16_f32 v20, v36, v37
  v_cvt_pk_bf16_f32 v21, v38, v39
  v_bfi_b32 v20, 1, s57, v20
  v_smfmac_f32_16x16x64_bf16 v[40:43], v[68:71], v[28:35], v0
  buffer_store_dwordx2 v[20:21], v7, s[4:7], s21 offen offset:0
  s_nop 6
  v_cvt_pk_bf16_f32 v22, v40, v41
  v_cvt_pk_bf16_f32 v23, v42, v43
  v_bfi_b32 v22, 1, s57, v22
  buffer_store_dwordx2 v[22:23], v7, s[4:7], s21 offen offset:64
  ds_read_b128 v[68:71], v4 offset:0
  ds_read_b128 v[72:75], v4 offset:1024
  ds_read_b128 v[76:79], v4 offset:4096
  ds_read_b128 v[80:83], v4 offset:5120
  ds_read_b128 v[84:87], v4 offset:8192
  ds_read_b128 v[88:91], v4 offset:9216
  ds_read_b128 v[92:95], v4 offset:2048
  ds_read_b128 v[96:99], v4 offset:3072
  ds_read_b128 v[100:103], v4 offset:6144
  ds_read_b128 v[104:107], v4 offset:7168
  ds_read_b128 v[108:111], v4 offset:10240
  ds_read_b128 v[112:115], v4 offset:11264
  v_mov_b64 v[16:17], 0
  v_mov_b64 v[18:19], 0
  v_mov_b64 v[20:21], 0
  v_mov_b64 v[22:23], 0
  v_mov_b64 v[24:25], 0
  v_mov_b64 v[26:27], 0
  ds_read_b64 v[44:45], v2 offset:32256
  s_waitcnt lgkmcnt(0)
  v_readfirstlane_b32 s38, v44
  v_readfirstlane_b32 s37, v45
  s_nop 0
  s_lshl_b32 s38, s38, 1
  s_lshl1_add_u32 s37, s37, 1
  s_min_u32 s38, s38, s37
  s_cmp_ge_u32 s38, 64
  s_cselect_b32 s38, 100, s38
  s_sub_u32 s38, s38, 1
  s_max_i32 s30, s30, s38
  s_waitcnt vmcnt(4)
  s_barrier
  ds_read_b128 v[28:31], v2 offset:19456
  ds_read_b128 v[32:35], v2 offset:23552
  ds_read_b128 v[36:39], v2 offset:8192
  ds_read_b128 v[40:43], v2 offset:9216
  ds_read_b128 v[44:47], v2 offset:10240
  ds_read_b128 v[48:51], v2 offset:11264
  buffer_load_dwordx4 v[124:127], v2, s[4:7], s24 offen offset:3072 sc1
  buffer_load_dwordx4 v[116:119], v2, s[4:7], s25 offen offset:3072 sc1
  ds_read_b128 v[52:55], v2 offset:12288
  ds_read_b128 v[56:59], v2 offset:13312
  ds_read_b128 v[60:63], v2 offset:14336
  ds_read_b128 v[64:67], v2 offset:15360
  buffer_load_dwordx4 v[124:127], v2, s[4:7], s24 offen offset:3072 sc1
  buffer_load_dwordx4 v[116:119], v2, s[4:7], s25 offen offset:3072 sc1
  s_mov_b32 s19, 0
  s_branch T_loop_56
T_kvw_60:
  s_mov_b32 s19, 0
  s_branch T_kvok_69
T_kv_68:
  s_sleep 4
  s_add_u32 s19, s19, 1
  s_cmp_gt_u32 s19, 32768
  s_cbranch_scc1 M_exit
T_kvok_69:
  s_add_u32 s39, s99, 128
  s_mov_b32 s38, 0
  s_mov_b32 s37, 0
  s_atomic_or s38, s[58:59], s99 glc
  s_atomic_or s37, s[58:59], s39 glc
  s_waitcnt lgkmcnt(0)
  s_lshl_b32 s38, s38, 1
  s_lshl1_add_u32 s37, s37, 1
  s_min_u32 s38, s38, s37
  s_cmp_ge_u32 s38, 64
  s_cselect_b32 s38, 100, s38
  s_sub_u32 s38, s38, 1
  s_max_i32 s30, s30, s38
  s_cmp_ge_i32 s14, s30
  s_cbranch_scc1 T_kv_68
  s_branch T_kvb_61
T_slow_63:
  s_nop 7
  v_max3_f32 v100, v16, v17, v18
  v_max3_f32 v100, v100, v19, v20
  v_max3_f32 v100, v100, v21, v22
  v_max3_f32 v100, v100, v23, v112
  v_max3_f32 v100, v100, v113, v114
  v_max_f32 v100, v100, v115
  v_mov_b32 v101, v100
  s_nop 1
  v_permlane32_swap_b32 v100, v101
  s_nop 1
  v_max_f32 v100, v100, v101
  v_mov_b32 v101, v100
  s_nop 1
  v_permlane16_swap_b32 v100, v101
  s_nop 1
  v_max_f32 v100, v100, v101
  v_sub_f32 v16, v16, v100
  v_sub_f32 v17, v17, v100
  v_sub_f32 v18, v18, v100
  v_sub_f32 v19, v19, v100
  v_exp_f32 v16, v16
  v_exp_f32 v17, v17
  v_exp_f32 v18, v18
  v_exp_f32 v19, v19
  v_sub_f32 v20, v20, v100
  v_sub_f32 v21, v21, v100
  v_sub_f32 v22, v22, v100
  v_sub_f32 v23, v23, v100
  v_exp_f32 v20, v20
  v_exp_f32 v21, v21
  v_exp_f32 v22, v22
  v_exp_f32 v23, v23
  v_sub_f32 v112, v112, v100
  v_sub_f32 v113, v113, v100
  v_sub_f32 v114, v114, v100
  v_sub_f32 v115, v115, v100
  v_exp_f32 v112, v112
  v_exp_f32 v113, v113
  v_exp_f32 v114, v114
  v_exp_f32 v115, v115
  s_nop 0
  v_cvt_pk_bf16_f32 v44, v16, v17
  v_cvt_pk_bf16_f32 v45, v18, v19
  v_cvt_pk_bf16_f32 v46, v20, v21
  v_cvt_pk_bf16_f32 v47, v22, v23
  v_cvt_pk_bf16_f32 v84, v112, v113
  v_cvt_pk_bf16_f32 v85, v114, v115
  v_cndmask_b32 v48, v84, 0, s[16:17]
  v_cndmask_b32 v49, v85, 0, s[16:17]
  v_cndmask_b32 v50, 0, v84, s[16:17]
  v_cndmask_b32 v51, 0, v85, s[16:17]
  s_nop 1
  v_mfma_f32_16x16x16_bf16 v[88:91], v[12:13], v[48:49], 0
  v_mfma_f32_16x16x16_bf16 v[24:27], v[120:121], v[48:49], 0
  v_mfma_f32_16x16x16_bf16 v[116:119], v[120:121], v[50:51], 0
  v_mfma_f32_16x16x32_bf16 v[88:91], v[12:15], v[44:47], v[88:91]
  v_mfma_f32_16x16x32_bf16 v[24:27], v[28:31], v[44:47], v[24:27]
  v_mfma_f32_16x16x32_bf16 v[116:119], v[32:35], v[44:47], v[116:119]
  s_nop 7
  s_nop 1
  v_rcp_f32 v89, v88
  s_nop 0
  v_mul_f32 v24, v89, v24
  v_mul_f32 v25, v89, v25
  s_branch T_back_64
M_global:
  s_cmp_eq_u32 s13, 1
  s_cbranch_scc1 T_w_71
  s_cmp_eq_u32 s13, 2
  s_cbranch_scc1 T_w_72
  s_cmp_eq_u32 s13, 3
  s_cbranch_scc1 T_w_73
T_w_70:
  s_mov_b32 s19, 0
  v_mov_b64 v[16:17], 0
  v_mov_b64 v[18:19], 0
  v_mov_b64 v[20:21], 0
  v_mov_b64 v[22:23], 0
  v_mov_b64 v[24:25], 0
  v_mov_b64 v[26:27], 0
  buffer_load_dwordx4 v[124:127], v2, s[4:7], s24 offen offset:0 sc1
  buffer_load_dwordx4 v[116:119], v2, s[4:7], s25 offen offset:0 sc1
  buffer_load_dwordx4 v[124:127], v2, s[4:7], s24 offen offset:0 sc1
  buffer_load_dwordx4 v[116:119], v2, s[4:7], s25 offen offset:0 sc1
  s_branch T_loop_74
.p2align 6
T_retry_75:
  s_mov_b64 exec, vcc
  buffer_load_dwordx4 v[124:127], v2, s[4:7], s24 offen offset:0 sc1
  buffer_load_dwordx4 v[116:119], v2, s[4:7], s25 offen offset:0 sc1
  s_mov_b64 exec, -1
  s_add_u32 s19, s19, 1
  s_cmp_gt_u32 s19, 32768
  s_cbranch_scc1 M_exit
T_loop_74:
  s_waitcnt vmcnt(3) lgkmcnt(0)
  v_max3_u32 v123, v124, v125, v126
  v_max_u32 v123, v123, v127
  v_mov_b32_dpp v120, v124 row_ror:8 row_mask:0xf bank_mask:0xf
  v_mov_b32_dpp v121, v125 row_ror:8 row_mask:0xf bank_mask:0xf
  s_waitcnt vmcnt(2)
  v_max3_u32 v123, v123, v116, v117
  v_max3_u32 v123, v123, v118, v119
  v_cmp_eq_u32 vcc, -1, v123
  s_cbranch_vccnz T_retry_75
  v_smfmac_f32_16x16x64_bf16 v[16:19], v[124:127], v[68:75], v0
  s_add_u32 s14, s14, 1
  ds_write_b128 v2, v[124:127] offset:0
  v_mov_b32_dpp v122, v126 row_ror:8 row_mask:0xf bank_mask:0xf
  v_smfmac_f32_16x16x64_bf16 v[20:23], v[124:127], v[76:83], v0
  s_and_b32 s57, s14, 1
  v_mov_b32_dpp v123, v127 row_ror:8 row_mask:0xf bank_mask:0xf
  v_smfmac_f32_16x16x64_bf16 v[24:27], v[124:127], v[84:91], v0
  s_and_b32 s36, s14, 3
  ds_write_b128 v2, v[116:119] offset:4096
  v_smfmac_f32_16x16x64_bf16 v[16:19], v[120:123], v[92:99], v0
  s_lshl_b32 s36, s36, 13
  v_mov_b32_dpp v84, v116 row_ror:8 row_mask:0xf bank_mask:0xf
  v_smfmac_f32_16x16x64_bf16 v[20:23], v[120:123], v[100:107], v0
  s_add_u32 s26, s36, s23
  ds_read_b128 v[68:71], v4 offset:12288
  v_mov_b32_dpp v85, v117 row_ror:8 row_mask:0xf bank_mask:0xf
  v_smfmac_f32_16x16x64_bf16 v[24:27], v[120:123], v[108:115], v0
  s_add_u32 s36, s36, 8192
  ds_read_b128 v[72:75], v4 offset:13312
  v_mov_b32_dpp v86, v118 row_ror:8 row_mask:0xf bank_mask:0xf
  v_smfmac_f32_16x16x64_bf16 v[16:19], v[116:119], v[224:231], v0
  s_and_b32 s36, s36, 0x7fff
  ds_read_b128 v[76:79], v4 offset:14336
  v_mov_b32_dpp v87, v119 row_ror:8 row_mask:0xf bank_mask:0xf
  v_smfmac_f32_16x16x64_bf16 v[20:23], v[116:119], v[240:247], v0
  s_waitcnt lgkmcnt(3)
  s_barrier
  ds_read_b128 v[100:103], v2 offset:1024
  v_smfmac_f32_16x16x64_bf16 v[24:27], v[116:119], a[0:7], v0
  s_mov_b32 m0, s31
  ds_read_b128 v[120:123], v1 offset:1024
  v_smfmac_f32_16x16x64_bf16 v[16:19], v[84:87], v[232:239], v0
  s_cmp_ge_i32 s14, s30
  s_cbranch_scc1 T_kvw_78
T_kvb_79:
  v_smfmac_f32_16x16x64_bf16 v[20:23], v[84:87], v[248:255], v0
  ds_read_b128 v[80:83], v4 offset:15360
  buffer_load_dwordx4 v9, s[4:7], s27 offen sc1 lds
  v_smfmac_f32_16x16x64_bf16 v[24:27], v[84:87], a[8:15], v0
  s_waitcnt lgkmcnt(2)
  s_mov_b32 m0, s32
  v_smfmac_f32_16x16x64_bf16 v[16:19], v[100:103], v[128:135], v0
  ds_read_b128 v[92:95], v2 offset:2048
  v_smfmac_f32_16x16x64_bf16 v[20:23], v[100:103], v[144:151], v0
  ds_read_b128 v[96:99], v1 offset:2048
  v_smfmac_f32_16x16x64_bf16 v[24:27], v[100:103], v[68:75], v0
  s_waitcnt vmcnt(1) lgkmcnt(3)
  ds_read_b128 v[116:119], v2 offset:3072
  buffer_load_dwordx4 v9, s[4:7], s27 offen offset:128 sc1 lds
  v_smfmac_f32_16x16x64_bf16 v[16:19], v[120:123], v[136:143], v0
  ds_read_b128 v[124:127], v1 offset:3072
  s_mov_b32 m0, s33
  v_smfmac_f32_16x16x64_bf16 v[20:23], v[120:123], v[152:159], v0
  s_waitcnt lgkmcnt(4)
  ds_read_b128 v[104:107], v2 offset:5120
  v_smfmac_f32_16x16x64_bf16 v[24:27], v[120:123], v[76:83], v0
  s_waitcnt lgkmcnt(4)
  ds_read_b128 v[108:111], v1 offset:5120
  v_smfmac_f32_16x16x64_bf16 v[16:19], v[92:95], v[160:167], v0
  s_waitcnt lgkmcnt(4)
  ds_read_b128 v[112:115], v2 offset:6144
  buffer_load_dwordx4 v10, s[4:7], s28 offen sc1 lds
  v_smfmac_f32_16x16x64_bf16 v[16:19], v[96:99], v[168:175], v0
  s_waitcnt lgkmcnt(4)
  ds_read_b128 v[84:87], v1 offset:6144
  s_mov_b32 m0, s34
  v_smfmac_f32_16x16x64_bf16 v[16:19], v[116:119], v[192:199], v0
  s_waitcnt lgkmcnt(4)
  ds_read_b128 v[88:91], v2 offset:7168
  v_smfmac_f32_16x16x64_bf16 v[16:19], v[124:127], v[200:207], v0
  s_waitcnt lgkmcnt(4)
  ds_read_b128 v[100:103], v1 offset:7168
  v_smfmac_f32_16x16x64_bf16 v[16:19], v[104:107], a[16:23], v0
  s_waitcnt lgkmcnt(4)
  ds_read_b128 v[68:71], v4 offset:16384
  buffer_load_dwordx4 v10, s[4:7], s28 offen offset:256 sc1 lds
  v_smfmac_f32_16x16x64_bf16 v[16:19], v[108:111], a[24:31], v0
  s_waitcnt lgkmcnt(4)
  ds_read_b128 v[72:75], v4 offset:17408
  v_smfmac_f32_16x16x64_bf16 v[16:19], v[112:115], a[64:71], v0
  s_waitcnt lgkmcnt(4)
  ds_read_b128 v[76:79], v4 offset:18432
  v_smfmac_f32_16x16x64_bf16 v[16:19], v[84:87], a[72:79], v0
  s_waitcnt lgkmcnt(4)
  ds_read_b128 v[80:83], v4 offset:19456
  v_smfmac_f32_16x16x64_bf16 v[16:19], v[88:91], a[112:119], v0
  s_waitcnt lgkmcnt(4)
  v_smfmac_f32_16x16x64_bf16 v[16:19], v[100:103], a[120:127], v0
  s_add_u32 s24, s36, 145752064
  s_add_u32 s25, s36, 145756160
  v_smfmac_f32_16x16x64_bf16 v[20:23], v[92:95], v[176:183], v0
  s_add_u32 s35, s36, s23
  v_smfmac_f32_16x16x64_bf16 v[20:23], v[96:99], v[184:191], v0
  s_waitcnt lgkmcnt(2)
  v_smfmac_f32_16x16x64_bf16 v[20:23], v[116:119], v[68:75], v0
  s_waitcnt lgkmcnt(0)
  ds_read_b128 v[68:71], v4 offset:20480
  v_mul_f32 v16, s18, v16
  v_smfmac_f32_16x16x64_bf16 v[20:23], v[124:127], v[76:83], v0
  ds_read_b128 v[72:75], v4 offset:21504
  v_mul_f32 v17, s18, v17
  v_smfmac_f32_16x16x64_bf16 v[20:23], v[104:107], a[32:39], v0
  ds_read_b128 v[76:79], v4 offset:22528
  v_mul_f32 v18, s18, v18
  v_smfmac_f32_16x16x64_bf16 v[20:23], v[108:111], a[40:47], v0
  ds_read_b128 v[80:83], v4 offset:23552
  v_mul_f32 v19, s18, v19
  v_smfmac_f32_16x16x64_bf16 v[20:23], v[112:115], a[80:87], v0
  v_cvt_pk_bf16_f32 v120, v16, v17
  v_smfmac_f32_16x16x64_bf16 v[20:23], v[84:87], a[88:95], v0
  v_cvt_pk_bf16_f32 v121, v18, v19
  v_smfmac_f32_16x16x64_bf16 v[20:23], v[88:91], a[128:135], v0
  ds_write_b64 v5, v[120:121] offset:24576
  v_smfmac_f32_16x16x64_bf16 v[20:23], v[100:103], a[136:143], v0
  s_waitcnt lgkmcnt(3)
  v_smfmac_f32_16x16x64_bf16 v[24:27], v[92:95], v[68:75], v0
  s_waitcnt lgkmcnt(1)
  v_mov_b64 v[92:93], 0
  v_smfmac_f32_16x16x64_bf16 v[24:27], v[96:99], v[76:83], v0
  s_nop 1
  v_cvt_pk_bf16_f32 v122, v20, v21
  v_cvt_pk_bf16_f32 v123, v22, v23
  v_smfmac_f32_16x16x64_bf16 v[24:27], v[116:119], v[208:215], v0
  ds_write_b64 v5, v[122:123] offset:26880
  v_mov_b64 v[94:95], 0
  v_smfmac_f32_16x16x64_bf16 v[24:27], v[124:127], v[216:223], v0
  s_waitcnt lgkmcnt(1)
  s_barrier
  ds_read_b64_tr_b16 v[68:69], v6 offset:24576
  v_smfmac_f32_16x16x64_bf16 v[24:27], v[104:107], a[48:55], v0
  s_add_u32 s27, s27, 8192
  ds_read_b64_tr_b16 v[70:71], v6 offset:24640
  ds_read_b64_tr_b16 v[72:73], v6 offset:24832
  v_smfmac_f32_16x16x64_bf16 v[24:27], v[108:111], a[56:63], v0
  s_add_u32 s28, s28, 8192
  ds_read_b64_tr_b16 v[74:75], v6 offset:24896
  ds_read_b64_tr_b16 v[76:77], v6 offset:25088
  v_smfmac_f32_16x16x64_bf16 v[24:27], v[112:115], a[96:103], v0
  s_nop 0
  ds_read_b64_tr_b16 v[78:79], v6 offset:25152
  ds_read_b64_tr_b16 v[80:81], v6 offset:25344
  v_smfmac_f32_16x16x64_bf16 v[24:27], v[84:87], a[104:111], v0
  ds_read_b64_tr_b16 v[82:83], v6 offset:25408
  v_mov_b64 v[96:97], 0
  v_smfmac_f32_16x16x64_bf16 v[24:27], v[88:91], a[144:151], v0
  s_waitcnt lgkmcnt(8)
  s_barrier
  ds_read_b64_tr_b16 v[116:117], v6 offset:26880
  v_smfmac_f32_16x16x64_bf16 v[24:27], v[100:103], a[152:159], v0
  s_waitcnt lgkmcnt(7)
  ds_read_b64_tr_b16 v[118:119], v6 offset:26944
  v_mfma_f32_16x16x32_bf16 v[16:19], v[36:39], v[68:71], 0
  s_waitcnt lgkmcnt(6)
  ds_read_b64_tr_b16 v[124:125], v6 offset:27136
  ds_read_b64_tr_b16 v[126:127], v6 offset:27200
  v_mfma_f32_16x16x32_bf16 v[16:19], v[40:43], v[72:75], v[16:19]
  s_waitcnt lgkmcnt(6)
  ds_read_b64_tr_b16 v[104:105], v6 offset:27392
  ds_read_b64_tr_b16 v[106:107], v6 offset:27456
  v_mfma_f32_16x16x32_bf16 v[16:19], v[44:47], v[76:79], v[16:19]
  s_waitcnt lgkmcnt(6)
  ds_read_b64_tr_b16 v[108:109], v6 offset:27648
  ds_read_b64_tr_b16 v[110:111], v6 offset:27712
  v_mfma_f32_16x16x32_bf16 v[16:19], v[48:51], v[80:83], v[16:19]
  s_waitcnt lgkmcnt(6)
  v_cvt_pk_bf16_f32 v120, v24, v25
  v_cvt_pk_bf16_f32 v121, v26, v27
  v_mfma_f32_16x16x32_bf16 v[112:115], v[116:119], v[68:71], 0
  s_waitcnt lgkmcnt(4)
  buffer_store_dwordx4 v[120:123], v2, s[4:7], s29 offen offset:0 sc1
  v_mov_b64 v[98:99], 0
  v_mfma_f32_16x16x32_bf16 v[112:115], v[124:127], v[72:75], v[112:115]
  s_waitcnt lgkmcnt(2)
  v_mov_b64 v[36:37], 0
  v_exp_f32 v100, v16
  v_mfma_f32_16x16x32_bf16 v[112:115], v[104:107], v[76:79], v[112:115]
  s_waitcnt lgkmcnt(0)
  v_exp_f32 v101, v17
  v_mfma_f32_16x16x32_bf16 v[112:115], v[108:111], v[80:83], v[112:115]
  v_exp_f32 v102, v18
  v_mfma_f32_16x16x32_bf16 v[20:23], v[52:55], v[68:71], 0
  s_cmp_eq_u32 s14, 63
  v_exp_f32 v103, v19
  v_mfma_f32_16x16x32_bf16 v[20:23], v[56:59], v[72:75], v[20:23]
  s_cbranch_scc1 M_tdone
  v_cvt_pk_bf16_f32 v44, v100, v101
  v_cvt_pk_bf16_f32 v45, v102, v103
  v_mfma_f32_16x16x32_bf16 v[20:23], v[60:63], v[76:79], v[20:23]
  s_add_u32 s29, s29, 131072
  v_exp_f32 v100, v112
  v_mfma_f32_16x16x32_bf16 v[20:23], v[64:67], v[80:83], v[20:23]
  v_exp_f32 v101, v113
  v_exp_f32 v102, v114
  v_exp_f32 v103, v115
  v_cvt_pk_bf16_f32 v84, v100, v101
  v_cvt_pk_bf16_f32 v85, v102, v103
  v_cndmask_b32 v48, v84, 0, s[16:17]
  v_cndmask_b32 v49, v85, 0, s[16:17]
  v_cndmask_b32 v50, 0, v84, s[16:17]
  v_cndmask_b32 v51, 0, v85, s[16:17]
  v_exp_f32 v100, v20
  v_mfma_f32_16x16x16_bf16 v[88:91], v[12:13], v[48:49], 0
  v_exp_f32 v101, v21
  v_mfma_f32_16x16x16_bf16 v[24:27], v[120:121], v[48:49], 0
  v_exp_f32 v102, v22
  v_mfma_f32_16x16x16_bf16 v[116:119], v[120:121], v[50:51], 0
  v_exp_f32 v103, v23
  v_cvt_pk_bf16_f32 v46, v100, v101
  v_cvt_pk_bf16_f32 v47, v102, v103
  v_mov_b64 v[38:39], 0
  s_nop 0
  v_mfma_f32_16x16x32_bf16 v[88:91], v[12:15], v[44:47], v[88:91]
  v_mov_b64 v[40:41], 0
  v_mov_b64 v[42:43], 0
  v_mfma_f32_16x16x32_bf16 v[24:27], v[28:31], v[44:47], v[24:27]
  ds_read_b128 v[52:55], v4 offset:24576
  ds_read_b128 v[56:59], v4 offset:25600
  v_mfma_f32_16x16x32_bf16 v[116:119], v[32:35], v[44:47], v[116:119]
  s_nop 1
  v_rcp_f32 v89, v88
  v_subrev_u32 v100, s54, v88
  v_cmp_le_u32 vcc, s55, v100
  v_mul_f32 v24, v89, v24
  v_mul_f32 v25, v89, v25
  s_cbranch_vccnz T_slow_81
T_back_82:
  v_cvt_pk_bf16_f32 v124, v24, v25
  v_pk_mul_f32 v[26:27], v[26:27], v[88:89] op_sel:[0,1] op_sel_hi:[1,1]
  v_pk_mul_f32 v[116:117], v[116:117], v[88:89] op_sel:[0,1] op_sel_hi:[1,1]
  v_pk_mul_f32 v[118:119], v[118:119], v[88:89] op_sel:[0,1] op_sel_hi:[1,1]
  v_cvt_pk_bf16_f32 v125, v26, v27
  v_cvt_pk_bf16_f32 v126, v116, v117
  v_cvt_pk_bf16_f32 v127, v118, v119
  ds_write_b128 v11, v[124:127] offset:29184
  s_nop 0
  v_smfmac_f32_16x16x64_bf16 v[92:95], v[124:127], a[160:167], v0
  v_smfmac_f32_16x16x64_bf16 v[96:99], v[124:127], a[168:175], v0
  v_smfmac_f32_16x16x64_bf16 v[36:39], v[124:127], a[176:183], v0
  v_smfmac_f32_16x16x64_bf16 v[40:43], v[124:127], a[184:191], v0
  s_waitcnt lgkmcnt(0)
  s_barrier
  ds_read_b128 v[104:107], v11 offset:29696
  ds_read_b128 v[108:111], v11 offset:30208
  ds_read_b128 v[68:71], v11 offset:30720
  s_waitcnt lgkmcnt(2)
  v_smfmac_f32_16x16x64_bf16 v[92:95], v[104:107], a[192:199], v0
  s_waitcnt lgkmcnt(1)
  ds_read_b128 v[76:79], v4 offset:28672
  v_smfmac_f32_16x16x64_bf16 v[92:95], v[108:111], a[224:231], v0
  s_waitcnt lgkmcnt(1)
  ds_read_b128 v[80:83], v4 offset:29696
  v_smfmac_f32_16x16x64_bf16 v[92:95], v[68:71], a[240:247], v0
  ds_read_b128 v[60:63], v4 offset:26624
  v_smfmac_f32_16x16x64_bf16 v[96:99], v[104:107], a[200:207], v0
  ds_read_b128 v[64:67], v4 offset:27648
  v_smfmac_f32_16x16x64_bf16 v[96:99], v[108:111], a[232:239], v0
  ds_read_b128 v[28:31], v4 offset:30720
  s_nop 0
  v_cvt_pk_bf16_f32 v16, v92, v93
  v_cvt_pk_bf16_f32 v17, v94, v95
  v_bfi_b32 v16, 1, s57, v16
  v_smfmac_f32_16x16x64_bf16 v[96:99], v[68:71], a[248:255], v0
  buffer_store_dwordx2 v[16:17], v7, s[4:7], s20 offen offset:0 sc1
  v_smfmac_f32_16x16x64_bf16 v[36:39], v[104:107], a[208:215], v0
  ds_read_b128 v[32:35], v4 offset:31744
  v_smfmac_f32_16x16x64_bf16 v[36:39], v[108:111], v[52:59], v0
  s_waitcnt lgkmcnt(4)
  s_nop 0
  v_cvt_pk_bf16_f32 v18, v96, v97
  v_cvt_pk_bf16_f32 v19, v98, v99
  v_bfi_b32 v18, 1, s57, v18
  v_smfmac_f32_16x16x64_bf16 v[36:39], v[68:71], v[76:83], v0
  buffer_store_dwordx2 v[18:19], v7, s[4:7], s20 offen offset:64 sc1
  v_smfmac_f32_16x16x64_bf16 v[40:43], v[104:107], a[216:223], v0
  s_waitcnt lgkmcnt(2)
  ds_read_b128 v[116:119], v2 offset:31232
  v_smfmac_f32_16x16x64_bf16 v[40:43], v[108:111], v[60:67], v0
  s_waitcnt lgkmcnt(1)
  s_nop 0
  v_cvt_pk_bf16_f32 v20, v36, v37
  v_cvt_pk_bf16_f32 v21, v38, v39
  v_bfi_b32 v20, 1, s57, v20
  v_smfmac_f32_16x16x64_bf16 v[40:43], v[68:71], v[28:35], v0
  buffer_store_dwordx2 v[20:21], v7, s[4:7], s21 offen offset:0 sc1
  s_nop 6
  v_cvt_pk_bf16_f32 v22, v40, v41
  v_cvt_pk_bf16_f32 v23, v42, v43
  v_bfi_b32 v22, 1, s57, v22
  buffer_store_dwordx2 v[22:23], v7, s[4:7], s21 offen offset:64 sc1
  ds_read_b128 v[68:71], v4 offset:0
  ds_read_b128 v[72:75], v4 offset:1024
  ds_read_b128 v[76:79], v4 offset:4096
  ds_read_b128 v[80:83], v4 offset:5120
  ds_read_b128 v[84:87], v4 offset:8192
  ds_read_b128 v[88:91], v4 offset:9216
  v_mov_b64 v[16:17], 0
  v_mov_b64 v[18:19], 0
  v_mov_b64 v[20:21], 0
  v_mov_b64 v[22:23], 0
  v_mov_b64 v[24:25], 0
  v_mov_b64 v[26:27], 0
  s_mov_b32 s19, 0
  v_mov_b32 v49, -1
  s_waitcnt vmcnt(2)
  buffer_load_dwordx4 v[52:55], v2, s[4:7], s22 offen offset:0 sc1
  buffer_load_dwordx4 v[56:59], v2, s[4:7], s22 offen offset:1024 sc1
  buffer_load_dwordx4 v[60:63], v2, s[4:7], s22 offen offset:2048 sc1
  buffer_load_dwordx4 v[64:67], v2, s[4:7], s22 offen offset:3072 sc1
  ds_read_b128 v[92:95], v4 offset:2048
  ds_read_b128 v[96:99], v4 offset:3072
  ds_read_b128 v[100:103], v4 offset:6144
  ds_read_b128 v[104:107], v4 offset:7168
  ds_read_b128 v[108:111], v4 offset:10240
  ds_read_b128 v[112:115], v4 offset:11264
  ds_read_b64 v[44:45], v2 offset:32256
  s_waitcnt lgkmcnt(0)
  v_readfirstlane_b32 s38, v44
  v_readfirstlane_b32 s37, v45
  s_nop 0
  s_lshl_b32 s38, s38, 1
  s_lshl1_add_u32 s37, s37, 1
  s_min_u32 s38, s38, s37
  s_cmp_ge_u32 s38, 64
  s_cselect_b32 s38, 100, s38
  s_sub_u32 s38, s38, 1
  s_max_i32 s30, s30, s38
  s_waitcnt lgkmcnt(12)
  s_waitcnt vmcnt(3)
  v_mfma_f32_16x16x32_bf16 v[120:123], v[116:119], v[52:55], 0
  v_xor_b32 v48, s57, v52
  v_bitop3_b32 v48, v48, v54, s57 bitop3:0xf6
  s_waitcnt vmcnt(2)
  v_mfma_f32_16x16x32_bf16 v[120:123], v[116:119], v[56:59], v[120:123]
  v_bitop3_b32 v48, v48, v56, s57 bitop3:0xf6
  v_bitop3_b32 v48, v48, v58, s57 bitop3:0xf6
  s_waitcnt vmcnt(1)
  v_mfma_f32_16x16x32_bf16 v[120:123], v[116:119], v[60:63], v[120:123]
  v_bitop3_b32 v48, v48, v60, s57 bitop3:0xf6
  v_bitop3_b32 v48, v48, v62, s57 bitop3:0xf6
  s_waitcnt vmcnt(0)
  v_mfma_f32_16x16x32_bf16 v[120:123], v[116:119], v[64:67], v[120:123]
  v_bitop3_b32 v48, v48, v64, s57 bitop3:0xf6
  v_bitop3_b32 v48, v48, v66, s57 bitop3:0xf6
  v_and_b32 v48, 1, v48
  v_cmp_ne_u32 vcc, 0, v48
  s_cbranch_vccnz T_p1re_84
T_p1ok_85:
  s_nop 2
  v_add_f32_dpp v120, v120, v120 row_ror:8 row_mask:0xf bank_mask:0xf
  v_add_f32_dpp v121, v121, v121 row_ror:8 row_mask:0xf bank_mask:0xf
  v_cvt_pk_bf16_f32 v48, v120, v121
  buffer_store_dword v48, v8, s[4:7], s35 offen sc1
  buffer_store_dword v49, v8, s[4:7], s26 offen sc1
  s_barrier
  ds_read_b128 v[28:31], v2 offset:16384
  ds_read_b128 v[32:35], v2 offset:20480
  ds_read_b128 v[36:39], v2 offset:8192
  ds_read_b128 v[40:43], v2 offset:9216
  ds_read_b128 v[44:47], v2 offset:10240
  ds_read_b128 v[48:51], v2 offset:11264
  buffer_load_dwordx4 v[124:127], v2, s[4:7], s24 offen offset:0 sc1
  buffer_load_dwordx4 v[116:119], v2, s[4:7], s25 offen offset:0 sc1
  ds_read_b128 v[52:55], v2 offset:12288
  ds_read_b128 v[56:59], v2 offset:13312
  ds_read_b128 v[60:63], v2 offset:14336
  ds_read_b128 v[64:67], v2 offset:15360
  buffer_load_dwordx4 v[124:127], v2, s[4:7], s24 offen offset:0 sc1
  buffer_load_dwordx4 v[116:119], v2, s[4:7], s25 offen offset:0 sc1
  s_mov_b32 s19, 0
  s_branch T_loop_74
T_p1re_84:
  s_mov_b64 exec, vcc
  buffer_load_dwordx4 v[52:55], v2, s[4:7], s22 offen offset:0 sc1
  buffer_load_dwordx4 v[56:59], v2, s[4:7], s22 offen offset:1024 sc1
  buffer_load_dwordx4 v[60:63], v2, s[4:7], s22 offen offset:2048 sc1
  buffer_load_dwordx4 v[64:67], v2, s[4:7], s22 offen offset:3072 sc1
  s_mov_b64 exec, -1
  s_add_u32 s19, s19, 1
  s_cmp_gt_u32 s19, 32768
  s_cbranch_scc1 M_exit
  s_waitcnt vmcnt(3)
  v_mfma_f32_16x16x32_bf16 v[120:123], v[116:119], v[52:55], 0
  v_xor_b32 v48, s57, v52
  v_bitop3_b32 v48, v48, v54, s57 bitop3:0xf6
  s_waitcnt vmcnt(2)
  v_mfma_f32_16x16x32_bf16 v[120:123], v[116:119], v[56:59], v[120:123]
  v_bitop3_b32 v48, v48, v56, s57 bitop3:0xf6
  v_bitop3_b32 v48, v48, v58, s57 bitop3:0xf6
  s_waitcnt vmcnt(1)
  v_mfma_f32_16x16x32_bf16 v[120:123], v[116:119], v[60:63], v[120:123]
  v_bitop3_b32 v48, v48, v60, s57 bitop3:0xf6
  v_bitop3_b32 v48, v48, v62, s57 bitop3:0xf6
  s_waitcnt vmcnt(0)
  v_mfma_f32_16x16x32_bf16 v[120:123], v[116:119], v[64:67], v[120:123]
  v_bitop3_b32 v48, v48, v64, s57 bitop3:0xf6
  v_bitop3_b32 v48, v48, v66, s57 bitop3:0xf6
  v_and_b32 v48, 1, v48
  v_cmp_ne_u32 vcc, 0, v48
  s_cbranch_vccnz T_p1re_84
  s_branch T_p1ok_85
T_kvw_78:
  s_mov_b32 s19, 0
  s_branch T_kvok_87
T_kv_86:
  s_sleep 4
  s_add_u32 s19, s19, 1
  s_cmp_gt_u32 s19, 32768
  s_cbranch_scc1 M_exit
T_kvok_87:
  s_add_u32 s39, s99, 128
  s_mov_b32 s38, 0
  s_mov_b32 s37, 0
  s_atomic_or s38, s[58:59], s99 glc
  s_atomic_or s37, s[58:59], s39 glc
  s_waitcnt lgkmcnt(0)
  s_lshl_b32 s38, s38, 1
  s_lshl1_add_u32 s37, s37, 1
  s_min_u32 s38, s38, s37
  s_cmp_ge_u32 s38, 64
  s_cselect_b32 s38, 100, s38
  s_sub_u32 s38, s38, 1
  s_max_i32 s30, s30, s38
  s_cmp_ge_i32 s14, s30
  s_cbranch_scc1 T_kv_86
  s_branch T_kvb_79
T_slow_81:
  s_nop 7
  v_max3_f32 v100, v16, v17, v18
  v_max3_f32 v100, v100, v19, v20
  v_max3_f32 v100, v100, v21, v22
  v_max3_f32 v100, v100, v23, v112
  v_max3_f32 v100, v100, v113, v114
  v_max_f32 v100, v100, v115
  v_mov_b32 v101, v100
  s_nop 1
  v_permlane32_swap_b32 v100, v101
  s_nop 1
  v_max_f32 v100, v100, v101
  v_mov_b32 v101, v100
  s_nop 1
  v_permlane16_swap_b32 v100, v101
  s_nop 1
  v_max_f32 v100, v100, v101
  v_sub_f32 v16, v16, v100
  v_sub_f32 v17, v17, v100
  v_sub_f32 v18, v18, v100
  v_sub_f32 v19, v19, v100
  v_exp_f32 v16, v16
  v_exp_f32 v17, v17
  v_exp_f32 v18, v18
  v_exp_f32 v19, v19
  v_sub_f32 v20, v20, v100
  v_sub_f32 v21, v21, v100
  v_sub_f32 v22, v22, v100
  v_sub_f32 v23, v23, v100
  v_exp_f32 v20, v20
  v_exp_f32 v21, v21
  v_exp_f32 v22, v22
  v_exp_f32 v23, v23
  v_sub_f32 v112, v112, v100
  v_sub_f32 v113, v113, v100
  v_sub_f32 v114, v114, v100
  v_sub_f32 v115, v115, v100
  v_exp_f32 v112, v112
  v_exp_f32 v113, v113
  v_exp_f32 v114, v114
  v_exp_f32 v115, v115
  s_nop 0
  v_cvt_pk_bf16_f32 v44, v16, v17
  v_cvt_pk_bf16_f32 v45, v18, v19
  v_cvt_pk_bf16_f32 v46, v20, v21
  v_cvt_pk_bf16_f32 v47, v22, v23
  v_cvt_pk_bf16_f32 v84, v112, v113
  v_cvt_pk_bf16_f32 v85, v114, v115
  v_cndmask_b32 v48, v84, 0, s[16:17]
  v_cndmask_b32 v49, v85, 0, s[16:17]
  v_cndmask_b32 v50, 0, v84, s[16:17]
  v_cndmask_b32 v51, 0, v85, s[16:17]
  s_nop 1
  v_mfma_f32_16x16x16_bf16 v[88:91], v[12:13], v[48:49], 0
  v_mfma_f32_16x16x16_bf16 v[24:27], v[120:121], v[48:49], 0
  v_mfma_f32_16x16x16_bf16 v[116:119], v[120:121], v[50:51], 0
  v_mfma_f32_16x16x32_bf16 v[88:91], v[12:15], v[44:47], v[88:91]
  v_mfma_f32_16x16x32_bf16 v[24:27], v[28:31], v[44:47], v[24:27]
  v_mfma_f32_16x16x32_bf16 v[116:119], v[32:35], v[44:47], v[116:119]
  s_nop 7
  s_nop 1
  v_rcp_f32 v89, v88
  s_nop 0
  v_mul_f32 v24, v89, v24
  v_mul_f32 v25, v89, v25
  s_branch T_back_82
T_w_71:
  s_mov_b32 s19, 0
  v_mov_b64 v[16:17], 0
  v_mov_b64 v[18:19], 0
  v_mov_b64 v[20:21], 0
  v_mov_b64 v[22:23], 0
  v_mov_b64 v[24:25], 0
  v_mov_b64 v[26:27], 0
  buffer_load_dwordx4 v[124:127], v2, s[4:7], s24 offen offset:1024 sc1
  buffer_load_dwordx4 v[116:119], v2, s[4:7], s25 offen offset:1024 sc1
  buffer_load_dwordx4 v[124:127], v2, s[4:7], s24 offen offset:1024 sc1
  buffer_load_dwordx4 v[116:119], v2, s[4:7], s25 offen offset:1024 sc1
  s_branch T_loop_88
.p2align 6
T_retry_89:
  s_mov_b64 exec, vcc
  buffer_load_dwordx4 v[124:127], v2, s[4:7], s24 offen offset:1024 sc1
  buffer_load_dwordx4 v[116:119], v2, s[4:7], s25 offen offset:1024 sc1
  s_mov_b64 exec, -1
  s_add_u32 s19, s19, 1
  s_cmp_gt_u32 s19, 32768
  s_cbranch_scc1 M_exit
T_loop_88:
  s_waitcnt vmcnt(3) lgkmcnt(0)
  v_max3_u32 v123, v124, v125, v126
  v_max_u32 v123, v123, v127
  v_mov_b32_dpp v120, v124 row_ror:8 row_mask:0xf bank_mask:0xf
  v_mov_b32_dpp v121, v125 row_ror:8 row_mask:0xf bank_mask:0xf
  s_waitcnt vmcnt(2)
  v_max3_u32 v123, v123, v116, v117
  v_max3_u32 v123, v123, v118, v119
  v_cmp_eq_u32 vcc, -1, v123
  s_cbranch_vccnz T_retry_89
  v_smfmac_f32_16x16x64_bf16 v[16:19], v[124:127], v[68:75], v0
  s_add_u32 s14, s14, 1
  ds_write_b128 v2, v[124:127] offset:1024
  v_mov_b32_dpp v122, v126 row_ror:8 row_mask:0xf bank_mask:0xf
  v_smfmac_f32_16x16x64_bf16 v[20:23], v[124:127], v[76:83], v0
  s_and_b32 s57, s14, 1
  v_mov_b32_dpp v123, v127 row_ror:8 row_mask:0xf bank_mask:0xf
  v_smfmac_f32_16x16x64_bf16 v[24:27], v[124:127], v[84:91], v0
  s_and_b32 s36, s14, 3
  ds_write_b128 v2, v[116:119] offset:5120
  v_smfmac_f32_16x16x64_bf16 v[16:19], v[120:123], v[92:99], v0
  s_lshl_b32 s36, s36, 13
  v_mov_b32_dpp v84, v116 row_ror:8 row_mask:0xf bank_mask:0xf
  v_smfmac_f32_16x16x64_bf16 v[20:23], v[120:123], v[100:107], v0
  s_add_u32 s26, s36, s23
  ds_read_b128 v[68:71], v4 offset:12288
  v_mov_b32_dpp v85, v117 row_ror:8 row_mask:0xf bank_mask:0xf
  v_smfmac_f32_16x16x64_bf16 v[24:27], v[120:123], v[108:115], v0
  s_add_u32 s36, s36, 8192
  ds_read_b128 v[72:75], v4 offset:13312
  v_mov_b32_dpp v86, v118 row_ror:8 row_mask:0xf bank_mask:0xf
  v_smfmac_f32_16x16x64_bf16 v[16:19], v[116:119], v[224:231], v0
  s_and_b32 s36, s36, 0x7fff
  ds_read_b128 v[76:79], v4 offset:14336
  v_mov_b32_dpp v87, v119 row_ror:8 row_mask:0xf bank_mask:0xf
  v_smfmac_f32_16x16x64_bf16 v[20:23], v[116:119], v[240:247], v0
  s_waitcnt lgkmcnt(3)
  s_barrier
  ds_read_b128 v[100:103], v2 offset:0
  v_smfmac_f32_16x16x64_bf16 v[24:27], v[116:119], a[0:7], v0
  s_mov_b32 m0, s31
  ds_read_b128 v[120:123], v1 offset:0
  v_smfmac_f32_16x16x64_bf16 v[16:19], v[84:87], v[232:239], v0
  s_cmp_ge_i32 s14, s30
  s_cbranch_scc1 T_kvw_92
T_kvb_93:
  v_smfmac_f32_16x16x64_bf16 v[20:23], v[84:87], v[248:255], v0
  ds_read_b128 v[80:83], v4 offset:15360
  v_smfmac_f32_16x16x64_bf16 v[24:27], v[84:87], a[8:15], v0
  s_waitcnt lgkmcnt(2)
  buffer_load_dwordx4 v9, s[4:7], s27 offen sc1 lds
  v_smfmac_f32_16x16x64_bf16 v[16:19], v[100:103], v[128:135], v0
  ds_read_b128 v[92:95], v2 offset:3072
  s_mov_b32 m0, s32
  v_smfmac_f32_16x16x64_bf16 v[20:23], v[100:103], v[144:151], v0
  ds_read_b128 v[96:99], v1 offset:3072
  v_smfmac_f32_16x16x64_bf16 v[24:27], v[100:103], v[68:75], v0
  s_waitcnt vmcnt(1) lgkmcnt(3)
  ds_read_b128 v[116:119], v2 offset:2048
  v_smfmac_f32_16x16x64_bf16 v[16:19], v[120:123], v[136:143], v0
  ds_read_b128 v[124:127], v1 offset:2048
  buffer_load_dwordx4 v9, s[4:7], s27 offen offset:128 sc1 lds
  v_smfmac_f32_16x16x64_bf16 v[20:23], v[120:123], v[152:159], v0
  s_waitcnt lgkmcnt(4)
  ds_read_b128 v[104:107], v2 offset:4096
  s_mov_b32 m0, s33
  v_smfmac_f32_16x16x64_bf16 v[24:27], v[120:123], v[76:83], v0
  s_waitcnt lgkmcnt(4)
  ds_read_b128 v[108:111], v1 offset:4096
  v_smfmac_f32_16x16x64_bf16 v[16:19], v[92:95], v[160:167], v0
  s_waitcnt lgkmcnt(4)
  ds_read_b128 v[112:115], v2 offset:7168
  v_smfmac_f32_16x16x64_bf16 v[16:19], v[96:99], v[168:175], v0
  s_waitcnt lgkmcnt(4)
  ds_read_b128 v[84:87], v1 offset:7168
  buffer_load_dwordx4 v10, s[4:7], s28 offen sc1 lds
  v_smfmac_f32_16x16x64_bf16 v[16:19], v[116:119], v[192:199], v0
  s_waitcnt lgkmcnt(4)
  ds_read_b128 v[88:91], v2 offset:6144
  s_mov_b32 m0, s34
  v_smfmac_f32_16x16x64_bf16 v[16:19], v[124:127], v[200:207], v0
  s_waitcnt lgkmcnt(4)
  ds_read_b128 v[100:103], v1 offset:6144
  v_smfmac_f32_16x16x64_bf16 v[16:19], v[104:107], a[16:23], v0
  s_waitcnt lgkmcnt(4)
  ds_read_b128 v[68:71], v4 offset:16384
  v_smfmac_f32_16x16x64_bf16 v[16:19], v[108:111], a[24:31], v0
  s_waitcnt lgkmcnt(4)
  ds_read_b128 v[72:75], v4 offset:17408
  buffer_load_dwordx4 v10, s[4:7], s28 offen offset:256 sc1 lds
  v_smfmac_f32_16x16x64_bf16 v[16:19], v[112:115], a[64:71], v0
  s_waitcnt lgkmcnt(4)
  ds_read_b128 v[76:79], v4 offset:18432
  v_smfmac_f32_16x16x64_bf16 v[16:19], v[84:87], a[72:79], v0
  s_waitcnt lgkmcnt(4)
  ds_read_b128 v[80:83], v4 offset:19456
  v_smfmac_f32_16x16x64_bf16 v[16:19], v[88:91], a[112:119], v0
  s_waitcnt lgkmcnt(4)
  v_smfmac_f32_16x16x64_bf16 v[16:19], v[100:103], a[120:127], v0
  s_add_u32 s24, s36, 145752064
  s_add_u32 s25, s36, 145756160
  v_smfmac_f32_16x16x64_bf16 v[20:23], v[92:95], v[176:183], v0
  s_add_u32 s35, s36, s23
  v_smfmac_f32_16x16x64_bf16 v[20:23], v[96:99], v[184:191], v0
  s_waitcnt lgkmcnt(2)
  v_smfmac_f32_16x16x64_bf16 v[20:23], v[116:119], v[68:75], v0
  s_waitcnt lgkmcnt(0)
  ds_read_b128 v[68:71], v4 offset:20480
  v_mul_f32 v16, s18, v16
  v_smfmac_f32_16x16x64_bf16 v[20:23], v[124:127], v[76:83], v0
  ds_read_b128 v[72:75], v4 offset:21504
  v_mul_f32 v17, s18, v17
  v_smfmac_f32_16x16x64_bf16 v[20:23], v[104:107], a[32:39], v0
  ds_read_b128 v[76:79], v4 offset:22528
  v_mul_f32 v18, s18, v18
  v_smfmac_f32_16x16x64_bf16 v[20:23], v[108:111], a[40:47], v0
  ds_read_b128 v[80:83], v4 offset:23552
  v_mul_f32 v19, s18, v19
  v_smfmac_f32_16x16x64_bf16 v[20:23], v[112:115], a[80:87], v0
  v_cvt_pk_bf16_f32 v120, v16, v17
  v_smfmac_f32_16x16x64_bf16 v[20:23], v[84:87], a[88:95], v0
  v_cvt_pk_bf16_f32 v121, v18, v19
  v_smfmac_f32_16x16x64_bf16 v[20:23], v[88:91], a[128:135], v0
  ds_write_b64 v5, v[120:121] offset:24576
  v_smfmac_f32_16x16x64_bf16 v[20:23], v[100:103], a[136:143], v0
  s_waitcnt lgkmcnt(3)
  v_smfmac_f32_16x16x64_bf16 v[24:27], v[92:95], v[68:75], v0
  s_waitcnt lgkmcnt(1)
  v_mov_b64 v[92:93], 0
  v_smfmac_f32_16x16x64_bf16 v[24:27], v[96:99], v[76:83], v0
  s_nop 1
  v_cvt_pk_bf16_f32 v122, v20, v21
  v_cvt_pk_bf16_f32 v123, v22, v23
  v_smfmac_f32_16x16x64_bf16 v[24:27], v[116:119], v[208:215], v0
  ds_write_b64 v5, v[122:123] offset:26880
  v_mov_b64 v[94:95], 0
  v_smfmac_f32_16x16x64_bf16 v[24:27], v[124:127], v[216:223], v0
  s_waitcnt lgkmcnt(1)
  s_barrier
  ds_read_b64_tr_b16 v[68:69], v6 offset:24576
  v_smfmac_f32_16x16x64_bf16 v[24:27], v[104:107], a[48:55], v0
  s_add_u32 s27, s27, 8192
  ds_read_b64_tr_b16 v[70:71], v6 offset:24640
  ds_read_b64_tr_b16 v[72:73], v6 offset:24832
  v_smfmac_f32_16x16x64_bf16 v[24:27], v[108:111], a[56:63], v0
  s_add_u32 s28, s28, 8192
  ds_read_b64_tr_b16 v[74:75], v6 offset:24896
  ds_read_b64_tr_b16 v[76:77], v6 offset:25088
  v_smfmac_f32_16x16x64_bf16 v[24:27], v[112:115], a[96:103], v0
  s_nop 0
  ds_read_b64_tr_b16 v[78:79], v6 offset:25152
  ds_read_b64_tr_b16 v[80:81], v6 offset:25344
  v_smfmac_f32_16x16x64_bf16 v[24:27], v[84:87], a[104:111], v0
  ds_read_b64_tr_b16 v[82:83], v6 offset:25408
  v_mov_b64 v[96:97], 0
  v_smfmac_f32_16x16x64_bf16 v[24:27], v[88:91], a[144:151], v0
  s_waitcnt lgkmcnt(8)
  s_barrier
  ds_read_b64_tr_b16 v[116:117], v6 offset:26880
  v_smfmac_f32_16x16x64_bf16 v[24:27], v[100:103], a[152:159], v0
  s_waitcnt lgkmcnt(7)
  ds_read_b64_tr_b16 v[118:119], v6 offset:26944
  v_mfma_f32_16x16x32_bf16 v[16:19], v[36:39], v[68:71], 0
  s_waitcnt lgkmcnt(6)
  ds_read_b64_tr_b16 v[124:125], v6 offset:27136
  ds_read_b64_tr_b16 v[126:127], v6 offset:27200
  v_mfma_f32_16x16x32_bf16 v[16:19], v[40:43], v[72:75], v[16:19]
  s_waitcnt lgkmcnt(6)
  ds_read_b64_tr_b16 v[104:105], v6 offset:27392
  ds_read_b64_tr_b16 v[106:107], v6 offset:27456
  v_mfma_f32_16x16x32_bf16 v[16:19], v[44:47], v[76:79], v[16:19]
  s_waitcnt lgkmcnt(6)
  ds_read_b64_tr_b16 v[108:109], v6 offset:27648
  ds_read_b64_tr_b16 v[110:111], v6 offset:27712
  v_mfma_f32_16x16x32_bf16 v[16:19], v[48:51], v[80:83], v[16:19]
  s_waitcnt lgkmcnt(6)
  v_cvt_pk_bf16_f32 v120, v24, v25
  v_cvt_pk_bf16_f32 v121, v26, v27
  v_mfma_f32_16x16x32_bf16 v[112:115], v[116:119], v[68:71], 0
  s_waitcnt lgkmcnt(4)
  v_mov_b64 v[98:99], 0
  v_mfma_f32_16x16x32_bf16 v[112:115], v[124:127], v[72:75], v[112:115]
  s_waitcnt lgkmcnt(2)
  buffer_store_dwordx4 v[120:123], v2, s[4:7], s29 offen offset:1024 sc1
  v_mov_b64 v[36:37], 0
  v_exp_f32 v100, v16
  v_mfma_f32_16x16x32_bf16 v[112:115], v[104:107], v[76:79], v[112:115]
  s_waitcnt lgkmcnt(0)
  v_exp_f32 v101, v17
  v_mfma_f32_16x16x32_bf16 v[112:115], v[108:111], v[80:83], v[112:115]
  v_exp_f32 v102, v18
  v_mfma_f32_16x16x32_bf16 v[20:23], v[52:55], v[68:71], 0
  s_cmp_eq_u32 s14, 63
  v_exp_f32 v103, v19
  v_mfma_f32_16x16x32_bf16 v[20:23], v[56:59], v[72:75], v[20:23]
  s_cbranch_scc1 M_tdone
  v_cvt_pk_bf16_f32 v44, v100, v101
  v_cvt_pk_bf16_f32 v45, v102, v103
  v_mfma_f32_16x16x32_bf16 v[20:23], v[60:63], v[76:79], v[20:23]
  s_add_u32 s29, s29, 131072
  v_exp_f32 v100, v112
  v_mfma_f32_16x16x32_bf16 v[20:23], v[64:67], v[80:83], v[20:23]
  v_exp_f32 v101, v113
  v_exp_f32 v102, v114
  v_exp_f32 v103, v115
  v_cvt_pk_bf16_f32 v84, v100, v101
  v_cvt_pk_bf16_f32 v85, v102, v103
  v_cndmask_b32 v48, v84, 0, s[16:17]
  v_cndmask_b32 v49, v85, 0, s[16:17]
  v_cndmask_b32 v50, 0, v84, s[16:17]
  v_cndmask_b32 v51, 0, v85, s[16:17]
  v_exp_f32 v100, v20
  v_mfma_f32_16x16x16_bf16 v[88:91], v[12:13], v[48:49], 0
  v_exp_f32 v101, v21
  v_mfma_f32_16x16x16_bf16 v[24:27], v[120:121], v[48:49], 0
  v_exp_f32 v102, v22
  v_mfma_f32_16x16x16_bf16 v[116:119], v[120:121], v[50:51], 0
  v_exp_f32 v103, v23
  v_cvt_pk_bf16_f32 v46, v100, v101
  v_cvt_pk_bf16_f32 v47, v102, v103
  v_mov_b64 v[38:39], 0
  s_nop 0
  v_mfma_f32_16x16x32_bf16 v[88:91], v[12:15], v[44:47], v[88:91]
  v_mov_b64 v[40:41], 0
  v_mov_b64 v[42:43], 0
  v_mfma_f32_16x16x32_bf16 v[24:27], v[28:31], v[44:47], v[24:27]
  ds_read_b128 v[52:55], v4 offset:24576
  ds_read_b128 v[56:59], v4 offset:25600
  v_mfma_f32_16x16x32_bf16 v[116:119], v[32:35], v[44:47], v[116:119]
  s_nop 1
  v_rcp_f32 v89, v88
  v_subrev_u32 v100, s54, v88
  v_cmp_le_u32 vcc, s55, v100
  v_mul_f32 v24, v89, v24
  v_mul_f32 v25, v89, v25
  s_cbranch_vccnz T_slow_95
T_back_96:
  v_cvt_pk_bf16_f32 v124, v24, v25
  v_pk_mul_f32 v[26:27], v[26:27], v[88:89] op_sel:[0,1] op_sel_hi:[1,1]
  v_pk_mul_f32 v[116:117], v[116:117], v[88:89] op_sel:[0,1] op_sel_hi:[1,1]
  v_pk_mul_f32 v[118:119], v[118:119], v[88:89] op_sel:[0,1] op_sel_hi:[1,1]
  v_cvt_pk_bf16_f32 v125, v26, v27
  v_cvt_pk_bf16_f32 v126, v116, v117
  v_cvt_pk_bf16_f32 v127, v118, v119
  ds_write_b128 v11, v[124:127] offset:29696
  s_nop 0
  v_smfmac_f32_16x16x64_bf16 v[92:95], v[124:127], a[160:167], v0
  v_smfmac_f32_16x16x64_bf16 v[96:99], v[124:127], a[168:175], v0
  v_smfmac_f32_16x16x64_bf16 v[36:39], v[124:127], a[176:183], v0
  v_smfmac_f32_16x16x64_bf16 v[40:43], v[124:127], a[184:191], v0
  s_waitcnt lgkmcnt(0)
  s_barrier
  ds_read_b128 v[104:107], v11 offset:29184
  ds_read_b128 v[108:111], v11 offset:30720
  ds_read_b128 v[68:71], v11 offset:30208
  s_waitcnt lgkmcnt(2)
  v_smfmac_f32_16x16x64_bf16 v[92:95], v[104:107], a[192:199], v0
  s_waitcnt lgkmcnt(1)
  ds_read_b128 v[76:79], v4 offset:28672
  v_smfmac_f32_16x16x64_bf16 v[92:95], v[108:111], a[224:231], v0
  s_waitcnt lgkmcnt(1)
  ds_read_b128 v[80:83], v4 offset:29696
  v_smfmac_f32_16x16x64_bf16 v[92:95], v[68:71], a[240:247], v0
  ds_read_b128 v[60:63], v4 offset:26624
  v_smfmac_f32_16x16x64_bf16 v[96:99], v[104:107], a[200:207], v0
  ds_read_b128 v[64:67], v4 offset:27648
  v_smfmac_f32_16x16x64_bf16 v[96:99], v[108:111], a[232:239], v0
  ds_read_b128 v[28:31], v4 offset:30720
  s_nop 0
  v_cvt_pk_bf16_f32 v16, v92, v93
  v_cvt_pk_bf16_f32 v17, v94, v95
  v_bfi_b32 v16, 1, s57, v16
  v_smfmac_f32_16x16x64_bf16 v[96:99], v[68:71], a[248:255], v0
  buffer_store_dwordx2 v[16:17], v7, s[4:7], s20 offen offset:0 sc1
  v_smfmac_f32_16x16x64_bf16 v[36:39], v[104:107], a[208:215], v0
  ds_read_b128 v[32:35], v4 offset:31744
  v_smfmac_f32_16x16x64_bf16 v[36:39], v[108:111], v[52:59], v0
  s_waitcnt lgkmcnt(4)
  s_nop 0
  v_cvt_pk_bf16_f32 v18, v96, v97
  v_cvt_pk_bf16_f32 v19, v98, v99
  v_bfi_b32 v18, 1, s57, v18
  v_smfmac_f32_16x16x64_bf16 v[36:39], v[68:71], v[76:83], v0
  buffer_store_dwordx2 v[18:19], v7, s[4:7], s20 offen offset:64 sc1
  v_smfmac_f32_16x16x64_bf16 v[40:43], v[104:107], a[216:223], v0
  s_waitcnt lgkmcnt(2)
  ds_read_b128 v[116:119], v2 offset:31232
  v_smfmac_f32_16x16x64_bf16 v[40:43], v[108:111], v[60:67], v0
  s_waitcnt lgkmcnt(1)
  s_nop 0
  v_cvt_pk_bf16_f32 v20, v36, v37
  v_cvt_pk_bf16_f32 v21, v38, v39
  v_bfi_b32 v20, 1, s57, v20
  v_smfmac_f32_16x16x64_bf16 v[40:43], v[68:71], v[28:35], v0
  buffer_store_dwordx2 v[20:21], v7, s[4:7], s21 offen offset:0 sc1
  s_nop 6
  v_cvt_pk_bf16_f32 v22, v40, v41
  v_cvt_pk_bf16_f32 v23, v42, v43
  v_bfi_b32 v22, 1, s57, v22
  buffer_store_dwordx2 v[22:23], v7, s[4:7], s21 offen offset:64 sc1
  ds_read_b128 v[68:71], v4 offset:0
  ds_read_b128 v[72:75], v4 offset:1024
  ds_read_b128 v[76:79], v4 offset:4096
  ds_read_b128 v[80:83], v4 offset:5120
  ds_read_b128 v[84:87], v4 offset:8192
  ds_read_b128 v[88:91], v4 offset:9216
  ds_read_b128 v[92:95], v4 offset:2048
  ds_read_b128 v[96:99], v4 offset:3072
  ds_read_b128 v[100:103], v4 offset:6144
  ds_read_b128 v[104:107], v4 offset:7168
  ds_read_b128 v[108:111], v4 offset:10240
  ds_read_b128 v[112:115], v4 offset:11264
  v_mov_b64 v[16:17], 0
  v_mov_b64 v[18:19], 0
  v_mov_b64 v[20:21], 0
  v_mov_b64 v[22:23], 0
  v_mov_b64 v[24:25], 0
  v_mov_b64 v[26:27], 0
  s_mov_b32 s19, 0
  v_mov_b32 v49, -1
  ds_read_b64 v[44:45], v2 offset:32256
  s_waitcnt lgkmcnt(0)
  v_readfirstlane_b32 s38, v44
  v_readfirstlane_b32 s37, v45
  s_nop 0
  s_lshl_b32 s38, s38, 1
  s_lshl1_add_u32 s37, s37, 1
  s_min_u32 s38, s38, s37
  s_cmp_ge_u32 s38, 64
  s_cselect_b32 s38, 100, s38
  s_sub_u32 s38, s38, 1
  s_max_i32 s30, s30, s38
  s_waitcnt vmcnt(0)
  buffer_load_dwordx4 v[52:55], v2, s[4:7], s22 offen offset:0 sc1
  buffer_load_dwordx4 v[56:59], v2, s[4:7], s22 offen offset:1024 sc1
  buffer_load_dwordx4 v[60:63], v2, s[4:7], s22 offen offset:2048 sc1
  buffer_load_dwordx4 v[64:67], v2, s[4:7], s22 offen offset:3072 sc1
  s_waitcnt lgkmcnt(12)
  s_waitcnt vmcnt(3)
  v_mfma_f32_16x16x32_bf16 v[120:123], v[116:119], v[52:55], 0
  v_xor_b32 v48, s57, v52
  v_bitop3_b32 v48, v48, v54, s57 bitop3:0xf6
  s_waitcnt vmcnt(2)
  v_mfma_f32_16x16x32_bf16 v[120:123], v[116:119], v[56:59], v[120:123]
  v_bitop3_b32 v48, v48, v56, s57 bitop3:0xf6
  v_bitop3_b32 v48, v48, v58, s57 bitop3:0xf6
  s_waitcnt vmcnt(1)
  v_mfma_f32_16x16x32_bf16 v[120:123], v[116:119], v[60:63], v[120:123]
  v_bitop3_b32 v48, v48, v60, s57 bitop3:0xf6
  v_bitop3_b32 v48, v48, v62, s57 bitop3:0xf6
  s_waitcnt vmcnt(0)
  v_mfma_f32_16x16x32_bf16 v[120:123], v[116:119], v[64:67], v[120:123]
  v_bitop3_b32 v48, v48, v64, s57 bitop3:0xf6
  v_bitop3_b32 v48, v48, v66, s57 bitop3:0xf6
  v_and_b32 v48, 1, v48
  v_cmp_ne_u32 vcc, 0, v48
  s_cbranch_vccnz T_p1re_98
T_p1ok_99:
  s_nop 2
  v_add_f32_dpp v120, v120, v120 row_ror:8 row_mask:0xf bank_mask:0xf
  v_add_f32_dpp v121, v121, v121 row_ror:8 row_mask:0xf bank_mask:0xf
  v_cvt_pk_bf16_f32 v48, v120, v121
  buffer_store_dword v48, v8, s[4:7], s35 offen sc1
  buffer_store_dword v49, v8, s[4:7], s26 offen sc1
  s_barrier
  ds_read_b128 v[28:31], v2 offset:17408
  ds_read_b128 v[32:35], v2 offset:21504
  ds_read_b128 v[36:39], v2 offset:8192
  ds_read_b128 v[40:43], v2 offset:9216
  ds_read_b128 v[44:47], v2 offset:10240
  ds_read_b128 v[48:51], v2 offset:11264
  buffer_load_dwordx4 v[124:127], v2, s[4:7], s24 offen offset:1024 sc1
  buffer_load_dwordx4 v[116:119], v2, s[4:7], s25 offen offset:1024 sc1
  ds_read_b128 v[52:55], v2 offset:12288
  ds_read_b128 v[56:59], v2 offset:13312
  ds_read_b128 v[60:63], v2 offset:14336
  ds_read_b128 v[64:67], v2 offset:15360
  buffer_load_dwordx4 v[124:127], v2, s[4:7], s24 offen offset:1024 sc1
  buffer_load_dwordx4 v[116:119], v2, s[4:7], s25 offen offset:1024 sc1
  s_mov_b32 s19, 0
  s_branch T_loop_88
T_p1re_98:
  s_mov_b64 exec, vcc
  buffer_load_dwordx4 v[52:55], v2, s[4:7], s22 offen offset:0 sc1
  buffer_load_dwordx4 v[56:59], v2, s[4:7], s22 offen offset:1024 sc1
  buffer_load_dwordx4 v[60:63], v2, s[4:7], s22 offen offset:2048 sc1
  buffer_load_dwordx4 v[64:67], v2, s[4:7], s22 offen offset:3072 sc1
  s_mov_b64 exec, -1
  s_add_u32 s19, s19, 1
  s_cmp_gt_u32 s19, 32768
  s_cbranch_scc1 M_exit
  s_waitcnt vmcnt(3)
  v_mfma_f32_16x16x32_bf16 v[120:123], v[116:119], v[52:55], 0
  v_xor_b32 v48, s57, v52
  v_bitop3_b32 v48, v48, v54, s57 bitop3:0xf6
  s_waitcnt vmcnt(2)
  v_mfma_f32_16x16x32_bf16 v[120:123], v[116:119], v[56:59], v[120:123]
  v_bitop3_b32 v48, v48, v56, s57 bitop3:0xf6
  v_bitop3_b32 v48, v48, v58, s57 bitop3:0xf6
  s_waitcnt vmcnt(1)
  v_mfma_f32_16x16x32_bf16 v[120:123], v[116:119], v[60:63], v[120:123]
  v_bitop3_b32 v48, v48, v60, s57 bitop3:0xf6
  v_bitop3_b32 v48, v48, v62, s57 bitop3:0xf6
  s_waitcnt vmcnt(0)
  v_mfma_f32_16x16x32_bf16 v[120:123], v[116:119], v[64:67], v[120:123]
  v_bitop3_b32 v48, v48, v64, s57 bitop3:0xf6
  v_bitop3_b32 v48, v48, v66, s57 bitop3:0xf6
  v_and_b32 v48, 1, v48
  v_cmp_ne_u32 vcc, 0, v48
  s_cbranch_vccnz T_p1re_98
  s_branch T_p1ok_99
T_kvw_92:
  s_mov_b32 s19, 0
  s_branch T_kvok_101
T_kv_100:
  s_sleep 4
  s_add_u32 s19, s19, 1
  s_cmp_gt_u32 s19, 32768
  s_cbranch_scc1 M_exit
T_kvok_101:
  s_add_u32 s39, s99, 128
  s_mov_b32 s38, 0
  s_mov_b32 s37, 0
  s_atomic_or s38, s[58:59], s99 glc
  s_atomic_or s37, s[58:59], s39 glc
  s_waitcnt lgkmcnt(0)
  s_lshl_b32 s38, s38, 1
  s_lshl1_add_u32 s37, s37, 1
  s_min_u32 s38, s38, s37
  s_cmp_ge_u32 s38, 64
  s_cselect_b32 s38, 100, s38
  s_sub_u32 s38, s38, 1
  s_max_i32 s30, s30, s38
  s_cmp_ge_i32 s14, s30
  s_cbranch_scc1 T_kv_100
  s_branch T_kvb_93
T_slow_95:
  s_nop 7
  v_max3_f32 v100, v16, v17, v18
  v_max3_f32 v100, v100, v19, v20
  v_max3_f32 v100, v100, v21, v22
  v_max3_f32 v100, v100, v23, v112
  v_max3_f32 v100, v100, v113, v114
  v_max_f32 v100, v100, v115
  v_mov_b32 v101, v100
  s_nop 1
  v_permlane32_swap_b32 v100, v101
  s_nop 1
  v_max_f32 v100, v100, v101
  v_mov_b32 v101, v100
  s_nop 1
  v_permlane16_swap_b32 v100, v101
  s_nop 1
  v_max_f32 v100, v100, v101
  v_sub_f32 v16, v16, v100
  v_sub_f32 v17, v17, v100
  v_sub_f32 v18, v18, v100
  v_sub_f32 v19, v19, v100
  v_exp_f32 v16, v16
  v_exp_f32 v17, v17
  v_exp_f32 v18, v18
  v_exp_f32 v19, v19
  v_sub_f32 v20, v20, v100
  v_sub_f32 v21, v21, v100
  v_sub_f32 v22, v22, v100
  v_sub_f32 v23, v23, v100
  v_exp_f32 v20, v20
  v_exp_f32 v21, v21
  v_exp_f32 v22, v22
  v_exp_f32 v23, v23
  v_sub_f32 v112, v112, v100
  v_sub_f32 v113, v113, v100
  v_sub_f32 v114, v114, v100
  v_sub_f32 v115, v115, v100
  v_exp_f32 v112, v112
  v_exp_f32 v113, v113
  v_exp_f32 v114, v114
  v_exp_f32 v115, v115
  s_nop 0
  v_cvt_pk_bf16_f32 v44, v16, v17
  v_cvt_pk_bf16_f32 v45, v18, v19
  v_cvt_pk_bf16_f32 v46, v20, v21
  v_cvt_pk_bf16_f32 v47, v22, v23
  v_cvt_pk_bf16_f32 v84, v112, v113
  v_cvt_pk_bf16_f32 v85, v114, v115
  v_cndmask_b32 v48, v84, 0, s[16:17]
  v_cndmask_b32 v49, v85, 0, s[16:17]
  v_cndmask_b32 v50, 0, v84, s[16:17]
  v_cndmask_b32 v51, 0, v85, s[16:17]
  s_nop 1
  v_mfma_f32_16x16x16_bf16 v[88:91], v[12:13], v[48:49], 0
  v_mfma_f32_16x16x16_bf16 v[24:27], v[120:121], v[48:49], 0
  v_mfma_f32_16x16x16_bf16 v[116:119], v[120:121], v[50:51], 0
  v_mfma_f32_16x16x32_bf16 v[88:91], v[12:15], v[44:47], v[88:91]
  v_mfma_f32_16x16x32_bf16 v[24:27], v[28:31], v[44:47], v[24:27]
  v_mfma_f32_16x16x32_bf16 v[116:119], v[32:35], v[44:47], v[116:119]
  s_nop 7
  s_nop 1
  v_rcp_f32 v89, v88
  s_nop 0
  v_mul_f32 v24, v89, v24
  v_mul_f32 v25, v89, v25
  s_branch T_back_96
T_w_72:
  s_mov_b32 s19, 0
  v_mov_b64 v[16:17], 0
  v_mov_b64 v[18:19], 0
  v_mov_b64 v[20:21], 0
  v_mov_b64 v[22:23], 0
  v_mov_b64 v[24:25], 0
  v_mov_b64 v[26:27], 0
  buffer_load_dwordx4 v[124:127], v2, s[4:7], s24 offen offset:2048 sc1
  buffer_load_dwordx4 v[116:119], v2, s[4:7], s25 offen offset:2048 sc1
  buffer_load_dwordx4 v[124:127], v2, s[4:7], s24 offen offset:2048 sc1
  buffer_load_dwordx4 v[116:119], v2, s[4:7], s25 offen offset:2048 sc1
  s_branch T_loop_102
.p2align 6
T_retry_103:
  s_mov_b64 exec, vcc
  buffer_load_dwordx4 v[124:127], v2, s[4:7], s24 offen offset:2048 sc1
  buffer_load_dwordx4 v[116:119], v2, s[4:7], s25 offen offset:2048 sc1
  s_mov_b64 exec, -1
  s_add_u32 s19, s19, 1
  s_cmp_gt_u32 s19, 32768
  s_cbranch_scc1 M_exit
T_loop_102:
  s_waitcnt vmcnt(3) lgkmcnt(0)
  v_max3_u32 v123, v124, v125, v126
  v_max_u32 v123, v123, v127
  v_mov_b32_dpp v120, v124 row_ror:8 row_mask:0xf bank_mask:0xf
  v_mov_b32_dpp v121, v125 row_ror:8 row_mask:0xf bank_mask:0xf
  s_waitcnt vmcnt(2)
  v_max3_u32 v123, v123, v116, v117
  v_max3_u32 v123, v123, v118, v119
  v_cmp_eq_u32 vcc, -1, v123
  s_cbranch_vccnz T_retry_103
  v_smfmac_f32_16x16x64_bf16 v[16:19], v[124:127], v[68:75], v0
  s_add_u32 s14, s14, 1
  ds_write_b128 v2, v[124:127] offset:2048
  v_mov_b32_dpp v122, v126 row_ror:8 row_mask:0xf bank_mask:0xf
  v_smfmac_f32_16x16x64_bf16 v[20:23], v[124:127], v[76:83], v0
  s_and_b32 s57, s14, 1
  v_mov_b32_dpp v123, v127 row_ror:8 row_mask:0xf bank_mask:0xf
  v_smfmac_f32_16x16x64_bf16 v[24:27], v[124:127], v[84:91], v0
  s_and_b32 s36, s14, 3
  ds_write_b128 v2, v[116:119] offset:6144
  v_smfmac_f32_16x16x64_bf16 v[16:19], v[120:123], v[92:99], v0
  s_lshl_b32 s36, s36, 13
  v_mov_b32_dpp v84, v116 row_ror:8 row_mask:0xf bank_mask:0xf
  v_smfmac_f32_16x16x64_bf16 v[20:23], v[120:123], v[100:107], v0
  s_add_u32 s26, s36, s23
  ds_read_b128 v[68:71], v4 offset:12288
  v_mov_b32_dpp v85, v117 row_ror:8 row_mask:0xf bank_mask:0xf
  v_smfmac_f32_16x16x64_bf16 v[24:27], v[120:123], v[108:115], v0
  s_add_u32 s36, s36, 8192
  ds_read_b128 v[72:75], v4 offset:13312
  v_mov_b32_dpp v86, v118 row_ror:8 row_mask:0xf bank_mask:0xf
  v_smfmac_f32_16x16x64_bf16 v[16:19], v[116:119], v[224:231], v0
  s_and_b32 s36, s36, 0x7fff
  ds_read_b128 v[76:79], v4 offset:14336
  v_mov_b32_dpp v87, v119 row_ror:8 row_mask:0xf bank_mask:0xf
  v_smfmac_f32_16x16x64_bf16 v[20:23], v[116:119], v[240:247], v0
  s_waitcnt lgkmcnt(3)
  s_barrier
  ds_read_b128 v[100:103], v2 offset:3072
  v_smfmac_f32_16x16x64_bf16 v[24:27], v[116:119], a[0:7], v0
  s_mov_b32 m0, s31
  ds_read_b128 v[120:123], v1 offset:3072
  v_smfmac_f32_16x16x64_bf16 v[16:19], v[84:87], v[232:239], v0
  s_cmp_ge_i32 s14, s30
  s_cbranch_scc1 T_kvw_106
T_kvb_107:
  v_smfmac_f32_16x16x64_bf16 v[20:23], v[84:87], v[248:255], v0
  ds_read_b128 v[80:83], v4 offset:15360
  v_smfmac_f32_16x16x64_bf16 v[24:27], v[84:87], a[8:15], v0
  s_waitcnt lgkmcnt(2)
  v_smfmac_f32_16x16x64_bf16 v[16:19], v[100:103], v[128:135], v0
  ds_read_b128 v[92:95], v2 offset:0
  buffer_load_dwordx4 v9, s[4:7], s27 offen sc1 lds
  v_smfmac_f32_16x16x64_bf16 v[20:23], v[100:103], v[144:151], v0
  ds_read_b128 v[96:99], v1 offset:0
  s_mov_b32 m0, s32
  v_smfmac_f32_16x16x64_bf16 v[24:27], v[100:103], v[68:75], v0
  s_waitcnt vmcnt(1) lgkmcnt(3)
  ds_read_b128 v[116:119], v2 offset:1024
  v_smfmac_f32_16x16x64_bf16 v[16:19], v[120:123], v[136:143], v0
  ds_read_b128 v[124:127], v1 offset:1024
  v_smfmac_f32_16x16x64_bf16 v[20:23], v[120:123], v[152:159], v0
  s_waitcnt lgkmcnt(4)
  ds_read_b128 v[104:107], v2 offset:7168
  buffer_load_dwordx4 v9, s[4:7], s27 offen offset:128 sc1 lds
  v_smfmac_f32_16x16x64_bf16 v[24:27], v[120:123], v[76:83], v0
  s_waitcnt lgkmcnt(4)
  ds_read_b128 v[108:111], v1 offset:7168
  s_mov_b32 m0, s33
  v_smfmac_f32_16x16x64_bf16 v[16:19], v[92:95], v[160:167], v0
  s_waitcnt lgkmcnt(4)
  ds_read_b128 v[112:115], v2 offset:4096
  v_mov_b32 v122, s98
  v_smfmac_f32_16x16x64_bf16 v[16:19], v[96:99], v[168:175], v0
  s_waitcnt lgkmcnt(4)
  ds_read_b128 v[84:87], v1 offset:4096
  v_smfmac_f32_16x16x64_bf16 v[16:19], v[116:119], v[192:199], v0
  s_waitcnt lgkmcnt(4)
  ds_read_b128 v[88:91], v2 offset:5120
  buffer_load_dwordx4 v10, s[4:7], s28 offen sc1 lds
  v_smfmac_f32_16x16x64_bf16 v[16:19], v[124:127], v[200:207], v0
  s_waitcnt lgkmcnt(4)
  ds_read_b128 v[100:103], v1 offset:5120
  s_mov_b32 m0, s34
  v_smfmac_f32_16x16x64_bf16 v[16:19], v[104:107], a[16:23], v0
  s_waitcnt lgkmcnt(4)
  ds_read_b128 v[68:71], v4 offset:16384
  v_smfmac_f32_16x16x64_bf16 v[16:19], v[108:111], a[24:31], v0
  s_waitcnt lgkmcnt(4)
  ds_read_b128 v[72:75], v4 offset:17408
  v_smfmac_f32_16x16x64_bf16 v[16:19], v[112:115], a[64:71], v0
  s_waitcnt lgkmcnt(4)
  ds_read_b128 v[76:79], v4 offset:18432
  buffer_load_dwordx4 v10, s[4:7], s28 offen offset:256 sc1 lds
  v_smfmac_f32_16x16x64_bf16 v[16:19], v[84:87], a[72:79], v0
  s_waitcnt lgkmcnt(4)
  ds_read_b128 v[80:83], v4 offset:19456
  v_smfmac_f32_16x16x64_bf16 v[16:19], v[88:91], a[112:119], v0
  s_waitcnt lgkmcnt(4)
  v_smfmac_f32_16x16x64_bf16 v[16:19], v[100:103], a[120:127], v0
  s_add_u32 s24, s36, 145752064
  s_add_u32 s25, s36, 145756160
  v_smfmac_f32_16x16x64_bf16 v[20:23], v[92:95], v[176:183], v0
  buffer_store_dword v122, v3, s[4:7], s15 offen sc1
  s_add_u32 s35, s36, s23
  v_smfmac_f32_16x16x64_bf16 v[20:23], v[96:99], v[184:191], v0
  s_waitcnt lgkmcnt(2)
  s_add_u32 s98, s14, 1
  v_smfmac_f32_16x16x64_bf16 v[20:23], v[116:119], v[68:75], v0
  s_waitcnt lgkmcnt(0)
  ds_read_b128 v[68:71], v4 offset:20480
  v_mul_f32 v16, s18, v16
  v_smfmac_f32_16x16x64_bf16 v[20:23], v[124:127], v[76:83], v0
  ds_read_b128 v[72:75], v4 offset:21504
  v_mul_f32 v17, s18, v17
  v_smfmac_f32_16x16x64_bf16 v[20:23], v[104:107], a[32:39], v0
  ds_read_b128 v[76:79], v4 offset:22528
  v_mul_f32 v18, s18, v18
  v_smfmac_f32_16x16x64_bf16 v[20:23], v[108:111], a[40:47], v0
  ds_read_b128 v[80:83], v4 offset:23552
  v_mul_f32 v19, s18, v19
  v_smfmac_f32_16x16x64_bf16 v[20:23], v[112:115], a[80:87], v0
  v_cvt_pk_bf16_f32 v120, v16, v17
  v_smfmac_f32_16x16x64_bf16 v[20:23], v[84:87], a[88:95], v0
  v_cvt_pk_bf16_f32 v121, v18, v19
  v_smfmac_f32_16x16x64_bf16 v[20:23], v[88:91], a[128:135], v0
  ds_write_b64 v5, v[120:121] offset:24576
  v_smfmac_f32_16x16x64_bf16 v[20:23], v[100:103], a[136:143], v0
  s_waitcnt lgkmcnt(3)
  v_smfmac_f32_16x16x64_bf16 v[24:27], v[92:95], v[68:75], v0
  s_waitcnt lgkmcnt(1)
  v_mov_b64 v[92:93], 0
  v_smfmac_f32_16x16x64_bf16 v[24:27], v[96:99], v[76:83], v0
  s_nop 1
  v_cvt_pk_bf16_f32 v122, v20, v21
  v_cvt_pk_bf16_f32 v123, v22, v23
  v_smfmac_f32_16x16x64_bf16 v[24:27], v[116:119], v[208:215], v0
  ds_write_b64 v5, v[122:123] offset:26880
  v_mov_b64 v[94:95], 0
  v_smfmac_f32_16x16x64_bf16 v[24:27], v[124:127], v[216:223], v0
  s_waitcnt lgkmcnt(1)
  s_barrier
  ds_read_b64_tr_b16 v[68:69], v6 offset:24576
  v_smfmac_f32_16x16x64_bf16 v[24:27], v[104:107], a[48:55], v0
  s_add_u32 s27, s27, 8192
  ds_read_b64_tr_b16 v[70:71], v6 offset:24640
  ds_read_b64_tr_b16 v[72:73], v6 offset:24832
  v_smfmac_f32_16x16x64_bf16 v[24:27], v[108:111], a[56:63], v0
  s_add_u32 s28, s28, 8192
  ds_read_b64_tr_b16 v[74:75], v6 offset:24896
  ds_read_b64_tr_b16 v[76:77], v6 offset:25088
  v_smfmac_f32_16x16x64_bf16 v[24:27], v[112:115], a[96:103], v0
  s_nop 0
  ds_read_b64_tr_b16 v[78:79], v6 offset:25152
  ds_read_b64_tr_b16 v[80:81], v6 offset:25344
  v_smfmac_f32_16x16x64_bf16 v[24:27], v[84:87], a[104:111], v0
  ds_read_b64_tr_b16 v[82:83], v6 offset:25408
  v_mov_b64 v[96:97], 0
  v_smfmac_f32_16x16x64_bf16 v[24:27], v[88:91], a[144:151], v0
  s_waitcnt lgkmcnt(8)
  s_barrier
  ds_read_b64_tr_b16 v[116:117], v6 offset:26880
  v_smfmac_f32_16x16x64_bf16 v[24:27], v[100:103], a[152:159], v0
  s_waitcnt lgkmcnt(7)
  ds_read_b64_tr_b16 v[118:119], v6 offset:26944
  v_mfma_f32_16x16x32_bf16 v[16:19], v[36:39], v[68:71], 0
  s_waitcnt lgkmcnt(6)
  ds_read_b64_tr_b16 v[124:125], v6 offset:27136
  ds_read_b64_tr_b16 v[126:127], v6 offset:27200
  v_mfma_f32_16x16x32_bf16 v[16:19], v[40:43], v[72:75], v[16:19]
  s_waitcnt lgkmcnt(6)
  ds_read_b64_tr_b16 v[104:105], v6 offset:27392
  ds_read_b64_tr_b16 v[106:107], v6 offset:27456
  v_mfma_f32_16x16x32_bf16 v[16:19], v[44:47], v[76:79], v[16:19]
  s_waitcnt lgkmcnt(6)
  ds_read_b64_tr_b16 v[108:109], v6 offset:27648
  ds_read_b64_tr_b16 v[110:111], v6 offset:27712
  v_mfma_f32_16x16x32_bf16 v[16:19], v[48:51], v[80:83], v[16:19]
  s_waitcnt lgkmcnt(6)
  v_cvt_pk_bf16_f32 v120, v24, v25
  v_cvt_pk_bf16_f32 v121, v26, v27
  v_mfma_f32_16x16x32_bf16 v[112:115], v[116:119], v[68:71], 0
  s_waitcnt lgkmcnt(4)
  v_mov_b64 v[98:99], 0
  v_mfma_f32_16x16x32_bf16 v[112:115], v[124:127], v[72:75], v[112:115]
  s_waitcnt lgkmcnt(2)
  v_mov_b64 v[36:37], 0
  v_exp_f32 v100, v16
  v_mfma_f32_16x16x32_bf16 v[112:115], v[104:107], v[76:79], v[112:115]
  s_waitcnt lgkmcnt(0)
  buffer_store_dwordx4 v[120:123], v2, s[4:7], s29 offen offset:2048 sc1
  v_exp_f32 v101, v17
  v_mfma_f32_16x16x32_bf16 v[112:115], v[108:111], v[80:83], v[112:115]
  v_exp_f32 v102, v18
  v_mfma_f32_16x16x32_bf16 v[20:23], v[52:55], v[68:71], 0
  s_cmp_eq_u32 s14, 63
  v_exp_f32 v103, v19
  v_mfma_f32_16x16x32_bf16 v[20:23], v[56:59], v[72:75], v[20:23]
  s_cbranch_scc1 M_tdone
  v_cvt_pk_bf16_f32 v44, v100, v101
  v_cvt_pk_bf16_f32 v45, v102, v103
  v_mfma_f32_16x16x32_bf16 v[20:23], v[60:63], v[76:79], v[20:23]
  s_add_u32 s29, s29, 131072
  v_exp_f32 v100, v112
  v_mfma_f32_16x16x32_bf16 v[20:23], v[64:67], v[80:83], v[20:23]
  v_exp_f32 v101, v113
  v_exp_f32 v102, v114
  v_exp_f32 v103, v115
  v_cvt_pk_bf16_f32 v84, v100, v101
  v_cvt_pk_bf16_f32 v85, v102, v103
  v_cndmask_b32 v48, v84, 0, s[16:17]
  v_cndmask_b32 v49, v85, 0, s[16:17]
  v_cndmask_b32 v50, 0, v84, s[16:17]
  v_cndmask_b32 v51, 0, v85, s[16:17]
  v_exp_f32 v100, v20
  v_mfma_f32_16x16x16_bf16 v[88:91], v[12:13], v[48:49], 0
  v_exp_f32 v101, v21
  v_mfma_f32_16x16x16_bf16 v[24:27], v[120:121], v[48:49], 0
  v_exp_f32 v102, v22
  v_mfma_f32_16x16x16_bf16 v[116:119], v[120:121], v[50:51], 0
  v_exp_f32 v103, v23
  v_cvt_pk_bf16_f32 v46, v100, v101
  v_cvt_pk_bf16_f32 v47, v102, v103
  v_mov_b64 v[38:39], 0
  s_nop 0
  v_mfma_f32_16x16x32_bf16 v[88:91], v[12:15], v[44:47], v[88:91]
  v_mov_b64 v[40:41], 0
  v_mov_b64 v[42:43], 0
  v_mfma_f32_16x16x32_bf16 v[24:27], v[28:31], v[44:47], v[24:27]
  ds_read_b128 v[52:55], v4 offset:24576
  ds_read_b128 v[56:59], v4 offset:25600
  v_mfma_f32_16x16x32_bf16 v[116:119], v[32:35], v[44:47], v[116:119]
  s_nop 1
  v_rcp_f32 v89, v88
  v_subrev_u32 v100, s54, v88
  v_cmp_le_u32 vcc, s55, v100
  v_mul_f32 v24, v89, v24
  v_mul_f32 v25, v89, v25
  s_cbranch_vccnz T_slow_109
T_back_110:
  v_cvt_pk_bf16_f32 v124, v24, v25
  v_pk_mul_f32 v[26:27], v[26:27], v[88:89] op_sel:[0,1] op_sel_hi:[1,1]
  v_pk_mul_f32 v[116:117], v[116:117], v[88:89] op_sel:[0,1] op_sel_hi:[1,1]
  v_pk_mul_f32 v[118:119], v[118:119], v[88:89] op_sel:[0,1] op_sel_hi:[1,1]
  v_cvt_pk_bf16_f32 v125, v26, v27
  v_cvt_pk_bf16_f32 v126, v116, v117
  v_cvt_pk_bf16_f32 v127, v118, v119
  ds_write_b128 v11, v[124:127] offset:30208
  s_nop 0
  v_smfmac_f32_16x16x64_bf16 v[92:95], v[124:127], a[160:167], v0
  v_smfmac_f32_16x16x64_bf16 v[96:99], v[124:127], a[168:175], v0
  v_smfmac_f32_16x16x64_bf16 v[36:39], v[124:127], a[176:183], v0
  v_smfmac_f32_16x16x64_bf16 v[40:43], v[124:127], a[184:191], v0
  s_waitcnt lgkmcnt(0)
  s_barrier
  ds_read_b128 v[104:107], v11 offset:30720
  ds_read_b128 v[108:111], v11 offset:29184
  ds_read_b128 v[68:71], v11 offset:29696
  s_waitcnt lgkmcnt(2)
  v_smfmac_f32_16x16x64_bf16 v[92:95], v[104:107], a[192:199], v0
  s_waitcnt lgkmcnt(1)
  ds_read_b128 v[76:79], v4 offset:28672
  v_smfmac_f32_16x16x64_bf16 v[92:95], v[108:111], a[224:231], v0
  s_waitcnt lgkmcnt(1)
  ds_read_b128 v[80:83], v4 offset:29696
  v_smfmac_f32_16x16x64_bf16 v[92:95], v[68:71], a[240:247], v0
  ds_read_b128 v[60:63], v4 offset:26624
  v_smfmac_f32_16x16x64_bf16 v[96:99], v[104:107], a[200:207], v0
  ds_read_b128 v[64:67], v4 offset:27648
  v_smfmac_f32_16x16x64_bf16 v[96:99], v[108:111], a[232:239], v0
  ds_read_b128 v[28:31], v4 offset:30720
  s_nop 0
  v_cvt_pk_bf16_f32 v16, v92, v93
  v_cvt_pk_bf16_f32 v17, v94, v95
  v_bfi_b32 v16, 1, s57, v16
  v_smfmac_f32_16x16x64_bf16 v[96:99], v[68:71], a[248:255], v0
  buffer_store_dwordx2 v[16:17], v7, s[4:7], s20 offen offset:0 sc1
  v_smfmac_f32_16x16x64_bf16 v[36:39], v[104:107], a[208:215], v0
  ds_read_b128 v[32:35], v4 offset:31744
  v_smfmac_f32_16x16x64_bf16 v[36:39], v[108:111], v[52:59], v0
  s_waitcnt lgkmcnt(4)
  s_nop 0
  v_cvt_pk_bf16_f32 v18, v96, v97
  v_cvt_pk_bf16_f32 v19, v98, v99
  v_bfi_b32 v18, 1, s57, v18
  v_smfmac_f32_16x16x64_bf16 v[36:39], v[68:71], v[76:83], v0
  buffer_store_dwordx2 v[18:19], v7, s[4:7], s20 offen offset:64 sc1
  v_smfmac_f32_16x16x64_bf16 v[40:43], v[104:107], a[216:223], v0
  s_waitcnt lgkmcnt(2)
  v_smfmac_f32_16x16x64_bf16 v[40:43], v[108:111], v[60:67], v0
  s_waitcnt lgkmcnt(0)
  s_nop 0
  v_cvt_pk_bf16_f32 v20, v36, v37
  v_cvt_pk_bf16_f32 v21, v38, v39
  v_bfi_b32 v20, 1, s57, v20
  v_smfmac_f32_16x16x64_bf16 v[40:43], v[68:71], v[28:35], v0
  buffer_store_dwordx2 v[20:21], v7, s[4:7], s21 offen offset:0 sc1
  s_nop 6
  v_cvt_pk_bf16_f32 v22, v40, v41
  v_cvt_pk_bf16_f32 v23, v42, v43
  v_bfi_b32 v22, 1, s57, v22
  buffer_store_dwordx2 v[22:23], v7, s[4:7], s21 offen offset:64 sc1
  ds_read_b128 v[68:71], v4 offset:0
  ds_read_b128 v[72:75], v4 offset:1024
  ds_read_b128 v[76:79], v4 offset:4096
  ds_read_b128 v[80:83], v4 offset:5120
  ds_read_b128 v[84:87], v4 offset:8192
  ds_read_b128 v[88:91], v4 offset:9216
  ds_read_b128 v[92:95], v4 offset:2048
  ds_read_b128 v[96:99], v4 offset:3072
  ds_read_b128 v[100:103], v4 offset:6144
  ds_read_b128 v[104:107], v4 offset:7168
  ds_read_b128 v[108:111], v4 offset:10240
  ds_read_b128 v[112:115], v4 offset:11264
  v_mov_b64 v[16:17], 0
  v_mov_b64 v[18:19], 0
  v_mov_b64 v[20:21], 0
  v_mov_b64 v[22:23], 0
  v_mov_b64 v[24:25], 0
  v_mov_b64 v[26:27], 0
  ds_read_b64 v[44:45], v2 offset:32256
  s_waitcnt lgkmcnt(0)
  v_readfirstlane_b32 s38, v44
  v_readfirstlane_b32 s37, v45
  s_nop 0
  s_lshl_b32 s38, s38, 1
  s_lshl1_add_u32 s37, s37, 1
  s_min_u32 s38, s38, s37
  s_cmp_ge_u32 s38, 64
  s_cselect_b32 s38, 100, s38
  s_sub_u32 s38, s38, 1
  s_max_i32 s30, s30, s38
  s_waitcnt vmcnt(4)
  s_barrier
  ds_read_b128 v[28:31], v2 offset:18432
  ds_read_b128 v[32:35], v2 offset:22528
  ds_read_b128 v[36:39], v2 offset:8192
  ds_read_b128 v[40:43], v2 offset:9216
  ds_read_b128 v[44:47], v2 offset:10240
  ds_read_b128 v[48:51], v2 offset:11264
  buffer_load_dwordx4 v[124:127], v2, s[4:7], s24 offen offset:2048 sc1
  buffer_load_dwordx4 v[116:119], v2, s[4:7], s25 offen offset:2048 sc1
  ds_read_b128 v[52:55], v2 offset:12288
  ds_read_b128 v[56:59], v2 offset:13312
  ds_read_b128 v[60:63], v2 offset:14336
  ds_read_b128 v[64:67], v2 offset:15360
  buffer_load_dwordx4 v[124:127], v2, s[4:7], s24 offen offset:2048 sc1
  buffer_load_dwordx4 v[116:119], v2, s[4:7], s25 offen offset:2048 sc1
  s_mov_b32 s19, 0
  s_branch T_loop_102
T_kvw_106:
  s_mov_b32 s19, 0
  s_branch T_kvok_115
T_kv_114:
  s_sleep 4
  s_add_u32 s19, s19, 1
  s_cmp_gt_u32 s19, 32768
  s_cbranch_scc1 M_exit
T_kvok_115:
  s_add_u32 s39, s99, 128
  s_mov_b32 s38, 0
  s_mov_b32 s37, 0
  s_atomic_or s38, s[58:59], s99 glc
  s_atomic_or s37, s[58:59], s39 glc
  s_waitcnt lgkmcnt(0)
  s_lshl_b32 s38, s38, 1
  s_lshl1_add_u32 s37, s37, 1
  s_min_u32 s38, s38, s37
  s_cmp_ge_u32 s38, 64
  s_cselect_b32 s38, 100, s38
  s_sub_u32 s38, s38, 1
  s_max_i32 s30, s30, s38
  s_cmp_ge_i32 s14, s30
  s_cbranch_scc1 T_kv_114
  s_branch T_kvb_107
T_slow_109:
  s_nop 7
  v_max3_f32 v100, v16, v17, v18
  v_max3_f32 v100, v100, v19, v20
  v_max3_f32 v100, v100, v21, v22
  v_max3_f32 v100, v100, v23, v112
  v_max3_f32 v100, v100, v113, v114
  v_max_f32 v100, v100, v115
  v_mov_b32 v101, v100
  s_nop 1
  v_permlane32_swap_b32 v100, v101
  s_nop 1
  v_max_f32 v100, v100, v101
  v_mov_b32 v101, v100
  s_nop 1
  v_permlane16_swap_b32 v100, v101
  s_nop 1
  v_max_f32 v100, v100, v101
  v_sub_f32 v16, v16, v100
  v_sub_f32 v17, v17, v100
  v_sub_f32 v18, v18, v100
  v_sub_f32 v19, v19, v100
  v_exp_f32 v16, v16
  v_exp_f32 v17, v17
  v_exp_f32 v18, v18
  v_exp_f32 v19, v19
  v_sub_f32 v20, v20, v100
  v_sub_f32 v21, v21, v100
  v_sub_f32 v22, v22, v100
  v_sub_f32 v23, v23, v100
  v_exp_f32 v20, v20
  v_exp_f32 v21, v21
  v_exp_f32 v22, v22
  v_exp_f32 v23, v23
  v_sub_f32 v112, v112, v100
  v_sub_f32 v113, v113, v100
  v_sub_f32 v114, v114, v100
  v_sub_f32 v115, v115, v100
  v_exp_f32 v112, v112
  v_exp_f32 v113, v113
  v_exp_f32 v114, v114
  v_exp_f32 v115, v115
  s_nop 0
  v_cvt_pk_bf16_f32 v44, v16, v17
  v_cvt_pk_bf16_f32 v45, v18, v19
  v_cvt_pk_bf16_f32 v46, v20, v21
  v_cvt_pk_bf16_f32 v47, v22, v23
  v_cvt_pk_bf16_f32 v84, v112, v113
  v_cvt_pk_bf16_f32 v85, v114, v115
  v_cndmask_b32 v48, v84, 0, s[16:17]
  v_cndmask_b32 v49, v85, 0, s[16:17]
  v_cndmask_b32 v50, 0, v84, s[16:17]
  v_cndmask_b32 v51, 0, v85, s[16:17]
  s_nop 1
  v_mfma_f32_16x16x16_bf16 v[88:91], v[12:13], v[48:49], 0
  v_mfma_f32_16x16x16_bf16 v[24:27], v[120:121], v[48:49], 0
  v_mfma_f32_16x16x16_bf16 v[116:119], v[120:121], v[50:51], 0
  v_mfma_f32_16x16x32_bf16 v[88:91], v[12:15], v[44:47], v[88:91]
  v_mfma_f32_16x16x32_bf16 v[24:27], v[28:31], v[44:47], v[24:27]
  v_mfma_f32_16x16x32_bf16 v[116:119], v[32:35], v[44:47], v[116:119]
  s_nop 7
  s_nop 1
  v_rcp_f32 v89, v88
  s_nop 0
  v_mul_f32 v24, v89, v24
  v_mul_f32 v25, v89, v25
  s_branch T_back_110
T_w_73:
  s_mov_b32 s19, 0
  v_mov_b64 v[16:17], 0
  v_mov_b64 v[18:19], 0
  v_mov_b64 v[20:21], 0
  v_mov_b64 v[22:23], 0
  v_mov_b64 v[24:25], 0
  v_mov_b64 v[26:27], 0
  buffer_load_dwordx4 v[124:127], v2, s[4:7], s24 offen offset:3072 sc1
  buffer_load_dwordx4 v[116:119], v2, s[4:7], s25 offen offset:3072 sc1
  buffer_load_dwordx4 v[124:127], v2, s[4:7], s24 offen offset:3072 sc1
  buffer_load_dwordx4 v[116:119], v2, s[4:7], s25 offen offset:3072 sc1
  s_branch T_loop_116
.p2align 6
T_retry_117:
  s_mov_b64 exec, vcc
  buffer_load_dwordx4 v[124:127], v2, s[4:7], s24 offen offset:3072 sc1
  buffer_load_dwordx4 v[116:119], v2, s[4:7], s25 offen offset:3072 sc1
  s_mov_b64 exec, -1
  s_add_u32 s19, s19, 1
  s_cmp_gt_u32 s19, 32768
  s_cbranch_scc1 M_exit
T_loop_116:
  s_waitcnt vmcnt(3) lgkmcnt(0)
  v_max3_u32 v123, v124, v125, v126
  v_max_u32 v123, v123, v127
  v_mov_b32_dpp v120, v124 row_ror:8 row_mask:0xf bank_mask:0xf
  v_mov_b32_dpp v121, v125 row_ror:8 row_mask:0xf bank_mask:0xf
  s_waitcnt vmcnt(2)
  v_max3_u32 v123, v123, v116, v117
  v_max3_u32 v123, v123, v118, v119
  v_cmp_eq_u32 vcc, -1, v123
  s_cbranch_vccnz T_retry_117
  v_smfmac_f32_16x16x64_bf16 v[16:19], v[124:127], v[68:75], v0
  s_add_u32 s14, s14, 1
  ds_write_b128 v2, v[124:127] offset:3072
  v_mov_b32_dpp v122, v126 row_ror:8 row_mask:0xf bank_mask:0xf
  v_smfmac_f32_16x16x64_bf16 v[20:23], v[124:127], v[76:83], v0
  s_and_b32 s57, s14, 1
  v_mov_b32_dpp v123, v127 row_ror:8 row_mask:0xf bank_mask:0xf
  v_smfmac_f32_16x16x64_bf16 v[24:27], v[124:127], v[84:91], v0
  s_and_b32 s36, s14, 3
  ds_write_b128 v2, v[116:119] offset:7168
  v_smfmac_f32_16x16x64_bf16 v[16:19], v[120:123], v[92:99], v0
  s_lshl_b32 s36, s36, 13
  v_mov_b32_dpp v84, v116 row_ror:8 row_mask:0xf bank_mask:0xf
  v_smfmac_f32_16x16x64_bf16 v[20:23], v[120:123], v[100:107], v0
  s_add_u32 s26, s36, s23
  ds_read_b128 v[68:71], v4 offset:12288
  v_mov_b32_dpp v85, v117 row_ror:8 row_mask:0xf bank_mask:0xf
  v_smfmac_f32_16x16x64_bf16 v[24:27], v[120:123], v[108:115], v0
  s_add_u32 s36, s36, 8192
  ds_read_b128 v[72:75], v4 offset:13312
  v_mov_b32_dpp v86, v118 row_ror:8 row_mask:0xf bank_mask:0xf
  v_smfmac_f32_16x16x64_bf16 v[16:19], v[116:119], v[224:231], v0
  s_and_b32 s36, s36, 0x7fff
  ds_read_b128 v[76:79], v4 offset:14336
  v_mov_b32_dpp v87, v119 row_ror:8 row_mask:0xf bank_mask:0xf
  v_smfmac_f32_16x16x64_bf16 v[20:23], v[116:119], v[240:247], v0
  s_waitcnt lgkmcnt(3)
  s_barrier
  ds_read_b128 v[100:103], v2 offset:2048
  v_smfmac_f32_16x16x64_bf16 v[24:27], v[116:119], a[0:7], v0
  s_mov_b32 m0, s31
  ds_read_b128 v[120:123], v1 offset:2048
  v_smfmac_f32_16x16x64_bf16 v[16:19], v[84:87], v[232:239], v0
  s_cmp_ge_i32 s14, s30
  s_cbranch_scc1 T_kvw_120
T_kvb_121:
  v_smfmac_f32_16x16x64_bf16 v[20:23], v[84:87], v[248:255], v0
  ds_read_b128 v[80:83], v4 offset:15360
  v_smfmac_f32_16x16x64_bf16 v[24:27], v[84:87], a[8:15], v0
  s_waitcnt lgkmcnt(2)
  v_smfmac_f32_16x16x64_bf16 v[16:19], v[100:103], v[128:135], v0
  ds_read_b128 v[92:95], v2 offset:1024
  v_smfmac_f32_16x16x64_bf16 v[20:23], v[100:103], v[144:151], v0
  ds_read_b128 v[96:99], v1 offset:1024
  buffer_load_dwordx4 v9, s[4:7], s27 offen sc1 lds
  v_smfmac_f32_16x16x64_bf16 v[24:27], v[100:103], v[68:75], v0
  s_waitcnt vmcnt(1) lgkmcnt(3)
  ds_read_b128 v[116:119], v2 offset:0
  s_mov_b32 m0, s32
  v_smfmac_f32_16x16x64_bf16 v[16:19], v[120:123], v[136:143], v0
  ds_read_b128 v[124:127], v1 offset:0
  v_smfmac_f32_16x16x64_bf16 v[20:23], v[120:123], v[152:159], v0
  s_waitcnt lgkmcnt(4)
  ds_read_b128 v[104:107], v2 offset:6144
  v_smfmac_f32_16x16x64_bf16 v[24:27], v[120:123], v[76:83], v0
  s_waitcnt lgkmcnt(4)
  ds_read_b128 v[108:111], v1 offset:6144
  buffer_load_dwordx4 v9, s[4:7], s27 offen offset:128 sc1 lds
  v_smfmac_f32_16x16x64_bf16 v[16:19], v[92:95], v[160:167], v0
  s_waitcnt lgkmcnt(4)
  ds_read_b128 v[112:115], v2 offset:5120
  s_mov_b32 m0, s33
  v_smfmac_f32_16x16x64_bf16 v[16:19], v[96:99], v[168:175], v0
  s_waitcnt lgkmcnt(4)
  ds_read_b128 v[84:87], v1 offset:5120
  v_smfmac_f32_16x16x64_bf16 v[16:19], v[116:119], v[192:199], v0
  s_waitcnt lgkmcnt(4)
  ds_read_b128 v[88:91], v2 offset:4096
  v_smfmac_f32_16x16x64_bf16 v[16:19], v[124:127], v[200:207], v0
  s_waitcnt lgkmcnt(4)
  ds_read_b128 v[100:103], v1 offset:4096
  buffer_load_dwordx4 v10, s[4:7], s28 offen sc1 lds
  v_smfmac_f32_16x16x64_bf16 v[16:19], v[104:107], a[16:23], v0
  s_waitcnt lgkmcnt(4)
  ds_read_b128 v[68:71], v4 offset:16384
  s_mov_b32 m0, s34
  v_smfmac_f32_16x16x64_bf16 v[16:19], v[108:111], a[24:31], v0
  s_waitcnt lgkmcnt(4)
  ds_read_b128 v[72:75], v4 offset:17408
  v_smfmac_f32_16x16x64_bf16 v[16:19], v[112:115], a[64:71], v0
  s_waitcnt lgkmcnt(4)
  ds_read_b128 v[76:79], v4 offset:18432
  v_smfmac_f32_16x16x64_bf16 v[16:19], v[84:87], a[72:79], v0
  s_waitcnt lgkmcnt(4)
  ds_read_b128 v[80:83], v4 offset:19456
  buffer_load_dwordx4 v10, s[4:7], s28 offen offset:256 sc1 lds
  v_smfmac_f32_16x16x64_bf16 v[16:19], v[88:91], a[112:119], v0
  s_waitcnt lgkmcnt(4)
  s_mov_b32 m0, 32256
  v_smfmac_f32_16x16x64_bf16 v[16:19], v[100:103], a[120:127], v0
  s_add_u32 s24, s36, 145752064
  s_add_u32 s25, s36, 145756160
  v_smfmac_f32_16x16x64_bf16 v[20:23], v[92:95], v[176:183], v0
  s_add_u32 s35, s36, s23
  v_smfmac_f32_16x16x64_bf16 v[20:23], v[96:99], v[184:191], v0
  s_waitcnt lgkmcnt(2)
  buffer_load_dword v3, s[4:7], s99 offen sc1 lds
  v_smfmac_f32_16x16x64_bf16 v[20:23], v[116:119], v[68:75], v0
  s_waitcnt lgkmcnt(0)
  ds_read_b128 v[68:71], v4 offset:20480
  v_mul_f32 v16, s18, v16
  v_smfmac_f32_16x16x64_bf16 v[20:23], v[124:127], v[76:83], v0
  ds_read_b128 v[72:75], v4 offset:21504
  v_mul_f32 v17, s18, v17
  v_smfmac_f32_16x16x64_bf16 v[20:23], v[104:107], a[32:39], v0
  ds_read_b128 v[76:79], v4 offset:22528
  v_mul_f32 v18, s18, v18
  v_smfmac_f32_16x16x64_bf16 v[20:23], v[108:111], a[40:47], v0
  ds_read_b128 v[80:83], v4 offset:23552
  v_mul_f32 v19, s18, v19
  v_smfmac_f32_16x16x64_bf16 v[20:23], v[112:115], a[80:87], v0
  v_cvt_pk_bf16_f32 v120, v16, v17
  v_smfmac_f32_16x16x64_bf16 v[20:23], v[84:87], a[88:95], v0
  v_cvt_pk_bf16_f32 v121, v18, v19
  v_smfmac_f32_16x16x64_bf16 v[20:23], v[88:91], a[128:135], v0
  ds_write_b64 v5, v[120:121] offset:24576
  v_smfmac_f32_16x16x64_bf16 v[20:23], v[100:103], a[136:143], v0
  s_waitcnt lgkmcnt(3)
  v_smfmac_f32_16x16x64_bf16 v[24:27], v[92:95], v[68:75], v0
  s_waitcnt lgkmcnt(1)
  v_mov_b64 v[92:93], 0
  v_smfmac_f32_16x16x64_bf16 v[24:27], v[96:99], v[76:83], v0
  s_nop 1
  v_cvt_pk_bf16_f32 v122, v20, v21
  v_cvt_pk_bf16_f32 v123, v22, v23
  v_smfmac_f32_16x16x64_bf16 v[24:27], v[116:119], v[208:215], v0
  ds_write_b64 v5, v[122:123] offset:26880
  v_mov_b64 v[94:95], 0
  v_smfmac_f32_16x16x64_bf16 v[24:27], v[124:127], v[216:223], v0
  s_waitcnt lgkmcnt(1)
  s_barrier
  ds_read_b64_tr_b16 v[68:69], v6 offset:24576
  v_smfmac_f32_16x16x64_bf16 v[24:27], v[104:107], a[48:55], v0
  s_add_u32 s27, s27, 8192
  ds_read_b64_tr_b16 v[70:71], v6 offset:24640
  ds_read_b64_tr_b16 v[72:73], v6 offset:24832
  v_smfmac_f32_16x16x64_bf16 v[24:27], v[108:111], a[56:63], v0
  s_add_u32 s28, s28, 8192
  ds_read_b64_tr_b16 v[74:75], v6 offset:24896
  ds_read_b64_tr_b16 v[76:77], v6 offset:25088
  v_smfmac_f32_16x16x64_bf16 v[24:27], v[112:115], a[96:103], v0
  s_nop 0
  ds_read_b64_tr_b16 v[78:79], v6 offset:25152
  ds_read_b64_tr_b16 v[80:81], v6 offset:25344
  v_smfmac_f32_16x16x64_bf16 v[24:27], v[84:87], a[104:111], v0
  ds_read_b64_tr_b16 v[82:83], v6 offset:25408
  v_mov_b64 v[96:97], 0
  v_smfmac_f32_16x16x64_bf16 v[24:27], v[88:91], a[144:151], v0
  s_waitcnt lgkmcnt(8)
  s_barrier
  ds_read_b64_tr_b16 v[116:117], v6 offset:26880
  v_smfmac_f32_16x16x64_bf16 v[24:27], v[100:103], a[152:159], v0
  s_waitcnt lgkmcnt(7)
  ds_read_b64_tr_b16 v[118:119], v6 offset:26944
  v_mfma_f32_16x16x32_bf16 v[16:19], v[36:39], v[68:71], 0
  s_waitcnt lgkmcnt(6)
  ds_read_b64_tr_b16 v[124:125], v6 offset:27136
  ds_read_b64_tr_b16 v[126:127], v6 offset:27200
  v_mfma_f32_16x16x32_bf16 v[16:19], v[40:43], v[72:75], v[16:19]
  s_waitcnt lgkmcnt(6)
  ds_read_b64_tr_b16 v[104:105], v6 offset:27392
  ds_read_b64_tr_b16 v[106:107], v6 offset:27456
  v_mfma_f32_16x16x32_bf16 v[16:19], v[44:47], v[76:79], v[16:19]
  s_waitcnt lgkmcnt(6)
  ds_read_b64_tr_b16 v[108:109], v6 offset:27648
  ds_read_b64_tr_b16 v[110:111], v6 offset:27712
  v_mfma_f32_16x16x32_bf16 v[16:19], v[48:51], v[80:83], v[16:19]
  s_waitcnt lgkmcnt(6)
  v_cvt_pk_bf16_f32 v120, v24, v25
  v_cvt_pk_bf16_f32 v121, v26, v27
  v_mfma_f32_16x16x32_bf16 v[112:115], v[116:119], v[68:71], 0
  s_waitcnt lgkmcnt(4)
  v_mov_b64 v[98:99], 0
  v_mfma_f32_16x16x32_bf16 v[112:115], v[124:127], v[72:75], v[112:115]
  s_waitcnt lgkmcnt(2)
  v_mov_b64 v[36:37], 0
  v_exp_f32 v100, v16
  v_mfma_f32_16x16x32_bf16 v[112:115], v[104:107], v[76:79], v[112:115]
  s_waitcnt lgkmcnt(0)
  v_exp_f32 v101, v17
  v_mfma_f32_16x16x32_bf16 v[112:115], v[108:111], v[80:83], v[112:115]
  buffer_store_dwordx4 v[120:123], v2, s[4:7], s29 offen offset:3072 sc1
  v_exp_f32 v102, v18
  v_mfma_f32_16x16x32_bf16 v[20:23], v[52:55], v[68:71], 0
  s_cmp_eq_u32 s14, 63
  v_exp_f32 v103, v19
  v_mfma_f32_16x16x32_bf16 v[20:23], v[56:59], v[72:75], v[20:23]
  s_cbranch_scc1 M_tdone
  v_cvt_pk_bf16_f32 v44, v100, v101
  v_cvt_pk_bf16_f32 v45, v102, v103
  v_mfma_f32_16x16x32_bf16 v[20:23], v[60:63], v[76:79], v[20:23]
  s_add_u32 s29, s29, 131072
  v_exp_f32 v100, v112
  v_mfma_f32_16x16x32_bf16 v[20:23], v[64:67], v[80:83], v[20:23]
  v_exp_f32 v101, v113
  v_exp_f32 v102, v114
  v_exp_f32 v103, v115
  v_cvt_pk_bf16_f32 v84, v100, v101
  v_cvt_pk_bf16_f32 v85, v102, v103
  v_cndmask_b32 v48, v84, 0, s[16:17]
  v_cndmask_b32 v49, v85, 0, s[16:17]
  v_cndmask_b32 v50, 0, v84, s[16:17]
  v_cndmask_b32 v51, 0, v85, s[16:17]
  v_exp_f32 v100, v20
  v_mfma_f32_16x16x16_bf16 v[88:91], v[12:13], v[48:49], 0
  v_exp_f32 v101, v21
  v_mfma_f32_16x16x16_bf16 v[24:27], v[120:121], v[48:49], 0
  v_exp_f32 v102, v22
  v_mfma_f32_16x16x16_bf16 v[116:119], v[120:121], v[50:51], 0
  v_exp_f32 v103, v23
  v_cvt_pk_bf16_f32 v46, v100, v101
  v_cvt_pk_bf16_f32 v47, v102, v103
  v_mov_b64 v[38:39], 0
  s_nop 0
  v_mfma_f32_16x16x32_bf16 v[88:91], v[12:15], v[44:47], v[88:91]
  v_mov_b64 v[40:41], 0
  v_mov_b64 v[42:43], 0
  v_mfma_f32_16x16x32_bf16 v[24:27], v[28:31], v[44:47], v[24:27]
  ds_read_b128 v[52:55], v4 offset:24576
  ds_read_b128 v[56:59], v4 offset:25600
  v_mfma_f32_16x16x32_bf16 v[116:119], v[32:35], v[44:47], v[116:119]
  s_nop 1
  v_rcp_f32 v89, v88
  v_subrev_u32 v100, s54, v88
  v_cmp_le_u32 vcc, s55, v100
  v_mul_f32 v24, v89, v24
  v_mul_f32 v25, v89, v25
  s_cbranch_vccnz T_slow_123
T_back_124:
  v_cvt_pk_bf16_f32 v124, v24, v25
  v_pk_mul_f32 v[26:27], v[26:27], v[88:89] op_sel:[0,1] op_sel_hi:[1,1]
  v_pk_mul_f32 v[116:117], v[116:117], v[88:89] op_sel:[0,1] op_sel_hi:[1,1]
  v_pk_mul_f32 v[118:119], v[118:119], v[88:89] op_sel:[0,1] op_sel_hi:[1,1]
  v_cvt_pk_bf16_f32 v125, v26, v27
  v_cvt_pk_bf16_f32 v126, v116, v117
  v_cvt_pk_bf16_f32 v127, v118, v119
  ds_write_b128 v11, v[124:127] offset:30720
  s_nop 0
  v_smfmac_f32_16x16x64_bf16 v[92:95], v[124:127], a[160:167], v0
  v_smfmac_f32_16x16x64_bf16 v[96:99], v[124:127], a[168:175], v0
  v_smfmac_f32_16x16x64_bf16 v[36:39], v[124:127], a[176:183], v0
  v_smfmac_f32_16x16x64_bf16 v[40:43], v[124:127], a[184:191], v0
  s_waitcnt lgkmcnt(0)
  s_barrier
  ds_read_b128 v[104:107], v11 offset:30208
  ds_read_b128 v[108:111], v11 offset:29696
  ds_read_b128 v[68:71], v11 offset:29184
  s_waitcnt lgkmcnt(2)
  v_smfmac_f32_16x16x64_bf16 v[92:95], v[104:107], a[192:199], v0
  s_waitcnt lgkmcnt(1)
  ds_read_b128 v[76:79], v4 offset:28672
  v_smfmac_f32_16x16x64_bf16 v[92:95], v[108:111], a[224:231], v0
  s_waitcnt lgkmcnt(1)
  ds_read_b128 v[80:83], v4 offset:29696
  v_smfmac_f32_16x16x64_bf16 v[92:95], v[68:71], a[240:247], v0
  ds_read_b128 v[60:63], v4 offset:26624
  v_smfmac_f32_16x16x64_bf16 v[96:99], v[104:107], a[200:207], v0
  ds_read_b128 v[64:67], v4 offset:27648
  v_smfmac_f32_16x16x64_bf16 v[96:99], v[108:111], a[232:239], v0
  ds_read_b128 v[28:31], v4 offset:30720
  s_nop 0
  v_cvt_pk_bf16_f32 v16, v92, v93
  v_cvt_pk_bf16_f32 v17, v94, v95
  v_bfi_b32 v16, 1, s57, v16
  v_smfmac_f32_16x16x64_bf16 v[96:99], v[68:71], a[248:255], v0
  buffer_store_dwordx2 v[16:17], v7, s[4:7], s20 offen offset:0 sc1
  v_smfmac_f32_16x16x64_bf16 v[36:39], v[104:107], a[208:215], v0
  ds_read_b128 v[32:35], v4 offset:31744
  v_smfmac_f32_16x16x64_bf16 v[36:39], v[108:111], v[52:59], v0
  s_waitcnt lgkmcnt(4)
  s_nop 0
  v_cvt_pk_bf16_f32 v18, v96, v97
  v_cvt_pk_bf16_f32 v19, v98, v99
  v_bfi_b32 v18, 1, s57, v18
  v_smfmac_f32_16x16x64_bf16 v[36:39], v[68:71], v[76:83], v0
  buffer_store_dwordx2 v[18:19], v7, s[4:7], s20 offen offset:64 sc1
  v_smfmac_f32_16x16x64_bf16 v[40:43], v[104:107], a[216:223], v0
  s_waitcnt lgkmcnt(2)
  v_smfmac_f32_16x16x64_bf16 v[40:43], v[108:111], v[60:67], v0
  s_waitcnt lgkmcnt(0)
  s_nop 0
  v_cvt_pk_bf16_f32 v20, v36, v37
  v_cvt_pk_bf16_f32 v21, v38, v39
  v_bfi_b32 v20, 1, s57, v20
  v_smfmac_f32_16x16x64_bf16 v[40:43], v[68:71], v[28:35], v0
  buffer_store_dwordx2 v[20:21], v7, s[4:7], s21 offen offset:0 sc1
  s_nop 6
  v_cvt_pk_bf16_f32 v22, v40, v41
  v_cvt_pk_bf16_f32 v23, v42, v43
  v_bfi_b32 v22, 1, s57, v22
  buffer_store_dwordx2 v[22:23], v7, s[4:7], s21 offen offset:64 sc1
  ds_read_b128 v[68:71], v4 offset:0
  ds_read_b128 v[72:75], v4 offset:1024
  ds_read_b128 v[76:79], v4 offset:4096
  ds_read_b128 v[80:83], v4 offset:5120
  ds_read_b128 v[84:87], v4 offset:8192
  ds_read_b128 v[88:91], v4 offset:9216
  ds_read_b128 v[92:95], v4 offset:2048
  ds_read_b128 v[96:99], v4 offset:3072
  ds_read_b128 v[100:103], v4 offset:6144
  ds_read_b128 v[104:107], v4 offset:7168
  ds_read_b128 v[108:111], v4 offset:10240
  ds_read_b128 v[112:115], v4 offset:11264
  v_mov_b64 v[16:17], 0
  v_mov_b64 v[18:19], 0
  v_mov_b64 v[20:21], 0
  v_mov_b64 v[22:23], 0
  v_mov_b64 v[24:25], 0
  v_mov_b64 v[26:27], 0
  ds_read_b64 v[44:45], v2 offset:32256
  s_waitcnt lgkmcnt(0)
  v_readfirstlane_b32 s38, v44
  v_readfirstlane_b32 s37, v45
  s_nop 0
  s_lshl_b32 s38, s38, 1
  s_lshl1_add_u32 s37, s37, 1
  s_min_u32 s38, s38, s37
  s_cmp_ge_u32 s38, 64
  s_cselect_b32 s38, 100, s38
  s_sub_u32 s38, s38, 1
  s_max_i32 s30, s30, s38
  s_waitcnt vmcnt(4)
  s_barrier
  ds_read_b128 v[28:31], v2 offset:19456
  ds_read_b128 v[32:35], v2 offset:23552
  ds_read_b128 v[36:39], v2 offset:8192
  ds_read_b128 v[40:43], v2 offset:9216
  ds_read_b128 v[44:47], v2 offset:10240
  ds_read_b128 v[48:51], v2 offset:11264
  buffer_load_dwordx4 v[124:127], v2, s[4:7], s24 offen offset:3072 sc1
  buffer_load_dwordx4 v[116:119], v2, s[4:7], s25 offen offset:3072 sc1
  ds_read_b128 v[52:55], v2 offset:12288
  ds_read_b128 v[56:59], v2 offset:13312
  ds_read_b128 v[60:63], v2 offset:14336
  ds_read_b128 v[64:67], v2 offset:15360
  buffer_load_dwordx4 v[124:127], v2, s[4:7], s24 offen offset:3072 sc1
  buffer_load_dwordx4 v[116:119], v2, s[4:7], s25 offen offset:3072 sc1
  s_mov_b32 s19, 0
  s_branch T_loop_116
T_kvw_120:
  s_mov_b32 s19, 0
  s_branch T_kvok_129
T_kv_128:
  s_sleep 4
  s_add_u32 s19, s19, 1
  s_cmp_gt_u32 s19, 32768
  s_cbranch_scc1 M_exit
T_kvok_129:
  s_add_u32 s39, s99, 128
  s_mov_b32 s38, 0
  s_mov_b32 s37, 0
  s_atomic_or s38, s[58:59], s99 glc
  s_atomic_or s37, s[58:59], s39 glc
  s_waitcnt lgkmcnt(0)
  s_lshl_b32 s38, s38, 1
  s_lshl1_add_u32 s37, s37, 1
  s_min_u32 s38, s38, s37
  s_cmp_ge_u32 s38, 64
  s_cselect_b32 s38, 100, s38
  s_sub_u32 s38, s38, 1
  s_max_i32 s30, s30, s38
  s_cmp_ge_i32 s14, s30
  s_cbranch_scc1 T_kv_128
  s_branch T_kvb_121
T_slow_123:
  s_nop 7
  v_max3_f32 v100, v16, v17, v18
  v_max3_f32 v100, v100, v19, v20
  v_max3_f32 v100, v100, v21, v22
  v_max3_f32 v100, v100, v23, v112
  v_max3_f32 v100, v100, v113, v114
  v_max_f32 v100, v100, v115
  v_mov_b32 v101, v100
  s_nop 1
  v_permlane32_swap_b32 v100, v101
  s_nop 1
  v_max_f32 v100, v100, v101
  v_mov_b32 v101, v100
  s_nop 1
  v_permlane16_swap_b32 v100, v101
  s_nop 1
  v_max_f32 v100, v100, v101
  v_sub_f32 v16, v16, v100
  v_sub_f32 v17, v17, v100
  v_sub_f32 v18, v18, v100
  v_sub_f32 v19, v19, v100
  v_exp_f32 v16, v16
  v_exp_f32 v17, v17
  v_exp_f32 v18, v18
  v_exp_f32 v19, v19
  v_sub_f32 v20, v20, v100
  v_sub_f32 v21, v21, v100
  v_sub_f32 v22, v22, v100
  v_sub_f32 v23, v23, v100
  v_exp_f32 v20, v20
  v_exp_f32 v21, v21
  v_exp_f32 v22, v22
  v_exp_f32 v23, v23
  v_sub_f32 v112, v112, v100
  v_sub_f32 v113, v113, v100
  v_sub_f32 v114, v114, v100
  v_sub_f32 v115, v115, v100
  v_exp_f32 v112, v112
  v_exp_f32 v113, v113
  v_exp_f32 v114, v114
  v_exp_f32 v115, v115
  s_nop 0
  v_cvt_pk_bf16_f32 v44, v16, v17
  v_cvt_pk_bf16_f32 v45, v18, v19
  v_cvt_pk_bf16_f32 v46, v20, v21
  v_cvt_pk_bf16_f32 v47, v22, v23
  v_cvt_pk_bf16_f32 v84, v112, v113
  v_cvt_pk_bf16_f32 v85, v114, v115
  v_cndmask_b32 v48, v84, 0, s[16:17]
  v_cndmask_b32 v49, v85, 0, s[16:17]
  v_cndmask_b32 v50, 0, v84, s[16:17]
  v_cndmask_b32 v51, 0, v85, s[16:17]
  s_nop 1
  v_mfma_f32_16x16x16_bf16 v[88:91], v[12:13], v[48:49], 0
  v_mfma_f32_16x16x16_bf16 v[24:27], v[120:121], v[48:49], 0
  v_mfma_f32_16x16x16_bf16 v[116:119], v[120:121], v[50:51], 0
  v_mfma_f32_16x16x32_bf16 v[88:91], v[12:15], v[44:47], v[88:91]
  v_mfma_f32_16x16x32_bf16 v[24:27], v[28:31], v[44:47], v[24:27]
  v_mfma_f32_16x16x32_bf16 v[116:119], v[32:35], v[44:47], v[116:119]
  s_nop 7
  s_nop 1
  v_rcp_f32 v89, v88
  s_nop 0
  v_mul_f32 v24, v89, v24
  v_mul_f32 v25, v89, v25
  s_branch T_back_124
M_tdone:
  v_mov_b32 v16, 64
  v_or_b32 v17, s13, v2
  v_min_u32 v17, 1, v17
  v_lshlrev_b32 v17, 30, v17
  s_waitcnt vmcnt(0)
  s_barrier
  buffer_store_dword v16, v17, s[4:7], s15 offen sc1
  s_branch M_done
M_worker:
  s_load_dwordx4 s[72:75], s[0:1], 120
  v_lshrrev_b32 v3, 6, v0
  v_and_b32 v1, 63, v0
  v_readfirstlane_b32 s16, v3
  v_lshlrev_b32 v2, 4, v1
  s_waitcnt lgkmcnt(0)
  s_mov_b64 s[4:5], s[74:75]
  s_mov_b64 s[74:75], s[72:73]
  s_mov_b64 s[72:73], s[4:5]
  s_and_b32 s5, s5, 0xffff
  s_mov_b32 s6, 268435456
  s_mov_b32 s7, 0x20000
  s_sub_u32 s66, s76, 1
  s_lshl_b32 s66, s66, 5
  s_add_u32 s66, s66, s77
  s_mul_i32 s64, s66, 9363
  s_lshr_b32 s64, s64, 16
  s_mul_i32 s67, s64, 7
  s_sub_u32 s65, s66, s67
  s_lshl_b32 s31, s66, 7
  s_add_u32 s31, s31, 148897792
  s_lshl_b32 s67, s67, 7
  s_add_u32 s67, s67, 148897792
  s_getpc_b64 s[76:77]
M_pc:
  s_add_u32 s76, s76, M_table-M_pc
  s_addc_u32 s77, s77, 0
  s_lshl_b32 s26, s65, 6
  s_load_dwordx16 s[48:63], s[76:77], s26
  s_waitcnt lgkmcnt(0)
  s_mov_b32 s23, s51
  s_cmp_lg_u32 s48, 1
  s_cbranch_scc1 M_nobpf
  s_load_dwordx8 s[36:43], s[0:1], 64
  s_mul_i32 s76, s64, 3
  s_add_u32 s76, s76, s57
  v_lshlrev_b32 v4, 7, v0
  s_mov_b32 s10, 4194304
  s_mov_b32 s11, 0x20000
  s_waitcnt lgkmcnt(0)
  s_mov_b32 s8, s42
  s_and_b32 s9, s43, 0xffff
  s_mul_i32 s77, s76, 43776
  s_add_u32 s77, s77, 0
  v_min_u32 v5, 32640, v4
  v_add_u32 v5, s77, v5
  s_add_u32 s77, s77, 32768
  buffer_load_dword v6, v5, s[8:11], 0 offen
  v_min_u32 v5, 10880, v4
  v_add_u32 v5, s77, v5
  s_add_u32 s77, s77, 32768
  buffer_load_dword v6, v5, s[8:11], 0 offen
  s_mov_b32 s8, s38
  s_and_b32 s9, s39, 0xffff
  s_mul_i32 s77, s76, 21888
  s_add_u32 s77, s77, 2097152
  v_min_u32 v5, 21760, v4
  v_add_u32 v5, s77, v5
  s_add_u32 s77, s77, 32768
  buffer_load_dword v6, v5, s[8:11], 0 offen
  s_mov_b32 s8, s40
  s_and_b32 s9, s41, 0xffff
  s_mul_i32 s77, s76, 21888
  s_add_u32 s77, s77, 2097152
  v_min_u32 v5, 21760, v4
  v_add_u32 v5, s77, v5
  s_add_u32 s77, s77, 32768
  buffer_load_dword v6, v5, s[8:11], 0 offen
  s_mov_b32 s8, s36
  s_and_b32 s9, s37, 0xffff
  s_mul_i32 s77, s76, 21888
  s_add_u32 s77, s77, 2097152
  v_min_u32 v5, 21760, v4
  v_add_u32 v5, s77, v5
  s_add_u32 s77, s77, 32768
  buffer_load_dword v6, v5, s[8:11], 0 offen
  s_waitcnt vmcnt(0)
M_nobpf:
  s_lshr_b32 s29, s16, 1
  s_cmp_eq_u32 s29, 0
  s_cselect_b32 s26, 2, 8
  s_cselect_b32 s27, 3, 4
  s_cselect_b32 s28, 9, 10
  s_cmp_eq_u32 s48, 1
  s_cselect_b32 s26, s27, s26
  s_cmp_eq_u32 s48, 2
  s_cselect_b32 s26, s28, s26
  s_lshl_b32 s26, s26, 3
  s_load_dwordx2 s[8:9], s[0:1], s26
  s_cmp_eq_u32 s48, 1
  s_cselect_b32 s26, 8, 0
  s_load_dwordx2 s[12:13], s[0:1], s26
  s_cmp_eq_u32 s29, 0
  s_cselect_b32 s21, 0, 3
  s_cselect_b32 s27, 1, 2
  s_cselect_b32 s28, 4, 5
  s_cmp_eq_u32 s48, 1
  s_cselect_b32 s21, s27, s21
  s_cmp_eq_u32 s48, 2
  s_cselect_b32 s21, s28, s21
  s_lshl_b32 s21, s21, 5
  s_add_u32 s21, s21, s64
  s_lshl_b32 s21, s21, 6
  s_add_u32 s21, s21, s49
  s_and_b32 s27, s16, 1
  s_lshl_b32 s21, s21, 1
  s_add_u32 s21, s21, s27
  s_lshl_b32 s21, s21, 12
  s_lshl_b32 s22, s50, 13
  s_lshl_b32 s19, s49, 15
  s_lshl_b32 s20, s50, 15
  s_lshl_b32 s17, s64, 1
  s_add_u32 s17, s17, s27
  s_lshl_b32 s17, s17, 7
  s_mov_b32 s18, 8192
  s_mov_b32 s24, 0x3e0293ee
  s_waitcnt lgkmcnt(0)
  s_and_b32 s9, s9, 0xffff
  s_mov_b32 s10, 4194304
  s_mov_b32 s11, 0x20000
  s_and_b32 s13, s13, 0xffff
  s_mov_b32 s14, 2097152
  s_mov_b32 s15, 0x20000
  s_cmp_eq_u32 s48, 0
  s_cselect_b32 s32, 0, s16
  s_lshr_b32 s32, s32, 1
  v_lshrrev_b32 v144, 4, v1
  v_and_b32 v56, 0xff, v2
  v_lshl_add_u32 v56, v144, 9, v56
  v_and_b32 v146, 15, v1
  v_and_b32 v144, 8, v1
  v_add_u32 v144, v144, v146
  s_cmp_lg_u32 s32, 0
  s_cselect_b64 vcc, -1, 0
  s_cselect_b32 s26, 8, 16
  v_cndmask_b32 v144, v146, v144, vcc
  v_lshrrev_b32 v145, 4, v1
  v_add_u32 v148, s26, v144
  v_xor_b32 v147, 0, v145
  v_xor_b32 v147, v147, v146
  v_lshlrev_b32 v147, 4, v147
  v_lshl_add_u32 v8, v144, 8, v147
  v_xor_b32 v147, 8, v145
  v_xor_b32 v147, v147, v146
  v_lshlrev_b32 v147, 4, v147
  v_lshl_add_u32 v9, v148, 8, v147
  v_xor_b32 v147, 4, v145
  v_xor_b32 v147, v147, v146
  v_lshlrev_b32 v147, 4, v147
  v_lshl_add_u32 v10, v144, 8, v147
  v_xor_b32 v147, 12, v145
  v_xor_b32 v147, v147, v146
  v_lshlrev_b32 v147, 4, v147
  v_lshl_add_u32 v11, v148, 8, v147
  v_xor_b32 v147, 8, v145
  v_xor_b32 v147, v147, v146
  v_lshlrev_b32 v147, 4, v147
  v_lshl_add_u32 v12, v144, 8, v147
  v_xor_b32 v147, 0, v145
  v_xor_b32 v147, v147, v146
  v_lshlrev_b32 v147, 4, v147
  v_lshl_add_u32 v13, v148, 8, v147
  v_xor_b32 v147, 12, v145
  v_xor_b32 v147, v147, v146
  v_lshlrev_b32 v147, 4, v147
  v_lshl_add_u32 v14, v144, 8, v147
  v_xor_b32 v147, 4, v145
  v_xor_b32 v147, v147, v146
  v_lshlrev_b32 v147, 4, v147
  v_lshl_add_u32 v15, v148, 8, v147
  v_lshrrev_b32 v144, 4, v1
  s_lshl_b32 s26, s16, 8
  v_add_u32 v145, 0, v144
  v_or_b32 v147, 0, v144
  v_xor_b32 v147, v147, v146
  v_lshlrev_b32 v147, 4, v147
  v_lshl_add_u32 v147, v145, 10, v147
  v_add_u32 v16, s26, v147
  v_add_u32 v145, 4, v144
  v_or_b32 v147, 4, v144
  v_xor_b32 v147, v147, v146
  v_lshlrev_b32 v147, 4, v147
  v_lshl_add_u32 v147, v145, 10, v147
  v_add_u32 v17, s26, v147
  v_add_u32 v145, 8, v144
  v_or_b32 v147, 8, v144
  v_xor_b32 v147, v147, v146
  v_lshlrev_b32 v147, 4, v147
  v_lshl_add_u32 v147, v145, 10, v147
  v_add_u32 v18, s26, v147
  v_add_u32 v145, 12, v144
  v_or_b32 v147, 12, v144
  v_xor_b32 v147, v147, v146
  v_lshlrev_b32 v147, 4, v147
  v_lshl_add_u32 v147, v145, 10, v147
  v_add_u32 v19, s26, v147
  v_add_u32 v145, 16, v144
  v_or_b32 v147, 8, v144
  v_xor_b32 v147, v147, v146
  v_lshlrev_b32 v147, 4, v147
  v_lshl_add_u32 v147, v145, 10, v147
  v_add_u32 v20, s26, v147
  v_add_u32 v145, 20, v144
  v_or_b32 v147, 12, v144
  v_xor_b32 v147, v147, v146
  v_lshlrev_b32 v147, 4, v147
  v_lshl_add_u32 v147, v145, 10, v147
  v_add_u32 v21, s26, v147
  v_add_u32 v145, 24, v144
  v_or_b32 v147, 0, v144
  v_xor_b32 v147, v147, v146
  v_lshlrev_b32 v147, 4, v147
  v_lshl_add_u32 v147, v145, 10, v147
  v_add_u32 v22, s26, v147
  v_add_u32 v145, 28, v144
  v_or_b32 v147, 4, v144
  v_xor_b32 v147, v147, v146
  v_lshlrev_b32 v147, 4, v147
  v_lshl_add_u32 v147, v145, 10, v147
  v_add_u32 v23, s26, v147
  v_lshrrev_b32 v144, 3, v1
  v_mul_lo_u32 v144, v144, s18
  v_and_b32 v145, 7, v1
  v_lshl_add_u32 v144, v145, 4, v144
  s_lshl_b32 s28, s16, 15
  s_add_u32 s28, s28, 32768
  s_lshl_b32 s29, s18, 3
  s_add_u32 m0, s28, 0
  s_nop 0
  buffer_load_dwordx4 v144, s[8:11], s17 offen lds
  s_add_u32 s17, s17, s29
  s_add_u32 m0, s28, 1024
  s_nop 0
  buffer_load_dwordx4 v144, s[8:11], s17 offen lds
  s_add_u32 s17, s17, s29
  s_add_u32 m0, s28, 2048
  s_nop 0
  buffer_load_dwordx4 v144, s[8:11], s17 offen lds
  s_add_u32 s17, s17, s29
  s_add_u32 m0, s28, 3072
  s_nop 0
  buffer_load_dwordx4 v144, s[8:11], s17 offen lds
  s_add_u32 s17, s17, s29
  s_add_u32 m0, s28, 4096
  s_nop 0
  buffer_load_dwordx4 v144, s[8:11], s17 offen lds
  s_add_u32 s17, s17, s29
  s_add_u32 m0, s28, 5120
  s_nop 0
  buffer_load_dwordx4 v144, s[8:11], s17 offen lds
  s_add_u32 s17, s17, s29
  s_add_u32 m0, s28, 6144
  s_nop 0
  buffer_load_dwordx4 v144, s[8:11], s17 offen lds
  s_add_u32 s17, s17, s29
  s_add_u32 m0, s28, 7168
  s_nop 0
  buffer_load_dwordx4 v144, s[8:11], s17 offen lds
  s_add_u32 s17, s17, s29
  s_add_u32 m0, s28, 8192
  s_nop 0
  buffer_load_dwordx4 v144, s[8:11], s17 offen lds
  s_add_u32 s17, s17, s29
  s_add_u32 m0, s28, 9216
  s_nop 0
  buffer_load_dwordx4 v144, s[8:11], s17 offen lds
  s_add_u32 s17, s17, s29
  s_add_u32 m0, s28, 10240
  s_nop 0
  buffer_load_dwordx4 v144, s[8:11], s17 offen lds
  s_add_u32 s17, s17, s29
  s_add_u32 m0, s28, 11264
  s_nop 0
  buffer_load_dwordx4 v144, s[8:11], s17 offen lds
  s_add_u32 s17, s17, s29
  s_add_u32 m0, s28, 12288
  s_nop 0
  buffer_load_dwordx4 v144, s[8:11], s17 offen lds
  s_add_u32 s17, s17, s29
  s_add_u32 m0, s28, 13312
  s_nop 0
  buffer_load_dwordx4 v144, s[8:11], s17 offen lds
  s_add_u32 s17, s17, s29
  s_add_u32 m0, s28, 14336
  s_nop 0
  buffer_load_dwordx4 v144, s[8:11], s17 offen lds
  s_add_u32 s17, s17, s29
  s_add_u32 m0, s28, 15360
  s_nop 0
  buffer_load_dwordx4 v144, s[8:11], s17 offen lds
  s_add_u32 s17, s17, s29
  s_add_u32 m0, s28, 16384
  s_nop 0
  buffer_load_dwordx4 v144, s[8:11], s17 offen lds
  s_add_u32 s17, s17, s29
  s_add_u32 m0, s28, 17408
  s_nop 0
  buffer_load_dwordx4 v144, s[8:11], s17 offen lds
  s_add_u32 s17, s17, s29
  s_add_u32 m0, s28, 18432
  s_nop 0
  buffer_load_dwordx4 v144, s[8:11], s17 offen lds
  s_add_u32 s17, s17, s29
  s_add_u32 m0, s28, 19456
  s_nop 0
  buffer_load_dwordx4 v144, s[8:11], s17 offen lds
  s_add_u32 s17, s17, s29
  s_add_u32 m0, s28, 20480
  s_nop 0
  buffer_load_dwordx4 v144, s[8:11], s17 offen lds
  s_add_u32 s17, s17, s29
  s_add_u32 m0, s28, 21504
  s_nop 0
  buffer_load_dwordx4 v144, s[8:11], s17 offen lds
  s_add_u32 s17, s17, s29
  s_add_u32 m0, s28, 22528
  s_nop 0
  buffer_load_dwordx4 v144, s[8:11], s17 offen lds
  s_add_u32 s17, s17, s29
  s_add_u32 m0, s28, 23552
  s_nop 0
  buffer_load_dwordx4 v144, s[8:11], s17 offen lds
  s_add_u32 s17, s17, s29
  s_add_u32 m0, s28, 24576
  s_nop 0
  buffer_load_dwordx4 v144, s[8:11], s17 offen lds
  s_add_u32 s17, s17, s29
  s_add_u32 m0, s28, 25600
  s_nop 0
  buffer_load_dwordx4 v144, s[8:11], s17 offen lds
  s_add_u32 s17, s17, s29
  s_add_u32 m0, s28, 26624
  s_nop 0
  buffer_load_dwordx4 v144, s[8:11], s17 offen lds
  s_add_u32 s17, s17, s29
  s_add_u32 m0, s28, 27648
  s_nop 0
  buffer_load_dwordx4 v144, s[8:11], s17 offen lds
  s_add_u32 s17, s17, s29
  s_add_u32 m0, s28, 28672
  s_nop 0
  buffer_load_dwordx4 v144, s[8:11], s17 offen lds
  s_add_u32 s17, s17, s29
  s_add_u32 m0, s28, 29696
  s_nop 0
  buffer_load_dwordx4 v144, s[8:11], s17 offen lds
  s_add_u32 s17, s17, s29
  s_add_u32 m0, s28, 30720
  s_nop 0
  buffer_load_dwordx4 v144, s[8:11], s17 offen lds
  s_add_u32 s17, s17, s29
  s_add_u32 m0, s28, 31744
  s_nop 0
  buffer_load_dwordx4 v144, s[8:11], s17 offen lds
  s_add_u32 s17, s17, s29
  s_lshl_b32 s25, s16, 13
  s_add_u32 m0, s25, 0
  s_nop 0
  buffer_load_dwordx4 v16, s[12:15], s19 offen lds
  s_add_u32 m0, s25, 1024
  s_nop 0
  buffer_load_dwordx4 v17, s[12:15], s19 offen lds
  s_add_u32 m0, s25, 2048
  s_nop 0
  buffer_load_dwordx4 v18, s[12:15], s19 offen lds
  s_add_u32 m0, s25, 3072
  s_nop 0
  buffer_load_dwordx4 v19, s[12:15], s19 offen lds
  s_add_u32 m0, s25, 4096
  s_nop 0
  buffer_load_dwordx4 v20, s[12:15], s19 offen lds
  s_add_u32 m0, s25, 5120
  s_nop 0
  buffer_load_dwordx4 v21, s[12:15], s19 offen lds
  s_add_u32 m0, s25, 6144
  s_nop 0
  buffer_load_dwordx4 v22, s[12:15], s19 offen lds
  s_add_u32 m0, s25, 7168
  s_nop 0
  buffer_load_dwordx4 v23, s[12:15], s19 offen lds
  s_cmp_gt_u32 s23, 1
  s_cselect_b32 s26, s20, 0
  s_add_u32 s19, s19, s26
  s_add_u32 s25, s25, 32768
  s_and_b32 s25, s25, 0x1ffff
  s_cmp_lg_u32 s16, 3
  s_cbranch_scc1 M_noinit
  s_mov_b32 s79, 0
  s_atomic_swap s79, s[72:73], s31 glc
  s_waitcnt lgkmcnt(0)
  s_mov_b32 s79, 1
  s_atomic_add s79, s[74:75], 128
M_noinit:
  s_cmp_lg_u32 s65, 3
  s_cbranch_scc1 M_noarm
  v_lshlrev_b32 v4, 4, v0
  v_mov_b64 v[60:61], -1
  v_mov_b64 v[62:63], -1
  s_mul_i32 s76, s64, 4096
  s_add_u32 s77, s76, 142868480
  buffer_store_dwordx4 v[60:63], v4, s[4:7], s77 offen sc1
  s_add_u32 s77, s76, 142999552
  buffer_store_dwordx4 v[60:63], v4, s[4:7], s77 offen sc1
  s_add_u32 s77, s76, 143130624
  buffer_store_dwordx4 v[60:63], v4, s[4:7], s77 offen sc1
  s_add_u32 s77, s76, 143261696
  buffer_store_dwordx4 v[60:63], v4, s[4:7], s77 offen sc1
  s_add_u32 s77, s76, 143392768
  buffer_store_dwordx4 v[60:63], v4, s[4:7], s77 offen sc1
  s_add_u32 s77, s76, 143523840
  buffer_store_dwordx4 v[60:63], v4, s[4:7], s77 offen sc1
M_noarm:
  s_mul_i32 s76, s64, 3
  s_add_u32 s76, s76, s57
  s_mul_i32 s76, s76, 24576
  v_lshlrev_b32 v4, 7, v0
  v_add_u32 v4, s76, v4
  buffer_load_dword v5, v4, s[12:15], 0 offen
  v_bfe_u32 v148, v1, 2, 2
  v_lshrrev_b32 v149, 5, v1
  v_lshl_add_u32 v148, v149, 4, v148
  v_bfe_u32 v149, v1, 4, 1
  v_lshl_add_u32 v148, v149, 3, v148
  v_and_b32 v149, 3, v1
  v_and_b32 v150, 2, v149
  v_add_u32 v150, v150, v149
  s_cmp_lg_u32 s32, 0
  s_cselect_b64 vcc, -1, 0
  s_cselect_b32 s26, 32, 16
  v_cndmask_b32 v149, v150, v149, vcc
  v_lshlrev_b32 v149, 3, v149
  v_lshl_add_u32 v148, v148, 7, v149
  v_add_u32 v152, s28, v148
  v_add_u32 v153, 512, v152
  v_add_u32 v154, s26, v152
  v_add_u32 v155, s26, v153
  s_waitcnt vmcnt(37)
  ds_read_b64_tr_b16 a[0:1], v152 offset:0
  ds_read_b64_tr_b16 a[2:3], v153 offset:0
  ds_read_b64_tr_b16 a[4:5], v154 offset:0
  ds_read_b64_tr_b16 a[6:7], v155 offset:0
  ds_read_b64_tr_b16 a[8:9], v152 offset:64
  ds_read_b64_tr_b16 a[10:11], v153 offset:64
  ds_read_b64_tr_b16 a[12:13], v154 offset:64
  ds_read_b64_tr_b16 a[14:15], v155 offset:64
  s_waitcnt lgkmcnt(0)
  s_add_u32 m0, s28, 0
  s_nop 0
  buffer_load_dwordx4 v144, s[8:11], s17 offen lds
  s_add_u32 s17, s17, s29
  s_add_u32 m0, s28, 1024
  s_nop 0
  buffer_load_dwordx4 v144, s[8:11], s17 offen lds
  s_add_u32 s17, s17, s29
  s_add_u32 m0, s28, 2048
  s_nop 0
  buffer_load_dwordx4 v144, s[8:11], s17 offen lds
  s_add_u32 s17, s17, s29
  s_add_u32 m0, s28, 3072
  s_nop 0
  buffer_load_dwordx4 v144, s[8:11], s17 offen lds
  s_add_u32 s17, s17, s29
  s_waitcnt vmcnt(37)
  ds_read_b64_tr_b16 a[16:17], v152 offset:4096
  ds_read_b64_tr_b16 a[18:19], v153 offset:4096
  ds_read_b64_tr_b16 a[20:21], v154 offset:4096
  ds_read_b64_tr_b16 a[22:23], v155 offset:4096
  ds_read_b64_tr_b16 a[24:25], v152 offset:4160
  ds_read_b64_tr_b16 a[26:27], v153 offset:4160
  ds_read_b64_tr_b16 a[28:29], v154 offset:4160
  ds_read_b64_tr_b16 a[30:31], v155 offset:4160
  s_waitcnt lgkmcnt(0)
  s_add_u32 m0, s28, 4096
  s_nop 0
  buffer_load_dwordx4 v144, s[8:11], s17 offen lds
  s_add_u32 s17, s17, s29
  s_add_u32 m0, s28, 5120
  s_nop 0
  buffer_load_dwordx4 v144, s[8:11], s17 offen lds
  s_add_u32 s17, s17, s29
  s_add_u32 m0, s28, 6144
  s_nop 0
  buffer_load_dwordx4 v144, s[8:11], s17 offen lds
  s_add_u32 s17, s17, s29
  s_add_u32 m0, s28, 7168
  s_nop 0
  buffer_load_dwordx4 v144, s[8:11], s17 offen lds
  s_add_u32 s17, s17, s29
  s_waitcnt vmcnt(37)
  ds_read_b64_tr_b16 a[32:33], v152 offset:8192
  ds_read_b64_tr_b16 a[34:35], v153 offset:8192
  ds_read_b64_tr_b16 a[36:37], v154 offset:8192
  ds_read_b64_tr_b16 a[38:39], v155 offset:8192
  ds_read_b64_tr_b16 a[40:41], v152 offset:8256
  ds_read_b64_tr_b16 a[42:43], v153 offset:8256
  ds_read_b64_tr_b16 a[44:45], v154 offset:8256
  ds_read_b64_tr_b16 a[46:47], v155 offset:8256
  s_waitcnt lgkmcnt(0)
  s_add_u32 m0, s28, 8192
  s_nop 0
  buffer_load_dwordx4 v144, s[8:11], s17 offen lds
  s_add_u32 s17, s17, s29
  s_add_u32 m0, s28, 9216
  s_nop 0
  buffer_load_dwordx4 v144, s[8:11], s17 offen lds
  s_add_u32 s17, s17, s29
  s_add_u32 m0, s28, 10240
  s_nop 0
  buffer_load_dwordx4 v144, s[8:11], s17 offen lds
  s_add_u32 s17, s17, s29
  s_add_u32 m0, s28, 11264
  s_nop 0
  buffer_load_dwordx4 v144, s[8:11], s17 offen lds
  s_add_u32 s17, s17, s29
  s_waitcnt vmcnt(37)
  ds_read_b64_tr_b16 a[48:49], v152 offset:12288
  ds_read_b64_tr_b16 a[50:51], v153 offset:12288
  ds_read_b64_tr_b16 a[52:53], v154 offset:12288
  ds_read_b64_tr_b16 a[54:55], v155 offset:12288
  ds_read_b64_tr_b16 a[56:57], v152 offset:12352
  ds_read_b64_tr_b16 a[58:59], v153 offset:12352
  ds_read_b64_tr_b16 a[60:61], v154 offset:12352
  ds_read_b64_tr_b16 a[62:63], v155 offset:12352
  s_waitcnt lgkmcnt(0)
  s_add_u32 m0, s28, 12288
  s_nop 0
  buffer_load_dwordx4 v144, s[8:11], s17 offen lds
  s_add_u32 s17, s17, s29
  s_add_u32 m0, s28, 13312
  s_nop 0
  buffer_load_dwordx4 v144, s[8:11], s17 offen lds
  s_add_u32 s17, s17, s29
  s_add_u32 m0, s28, 14336
  s_nop 0
  buffer_load_dwordx4 v144, s[8:11], s17 offen lds
  s_add_u32 s17, s17, s29
  s_add_u32 m0, s28, 15360
  s_nop 0
  buffer_load_dwordx4 v144, s[8:11], s17 offen lds
  s_add_u32 s17, s17, s29
  s_waitcnt vmcnt(37)
  ds_read_b64_tr_b16 a[64:65], v152 offset:16384
  ds_read_b64_tr_b16 a[66:67], v153 offset:16384
  ds_read_b64_tr_b16 a[68:69], v154 offset:16384
  ds_read_b64_tr_b16 a[70:71], v155 offset:16384
  ds_read_b64_tr_b16 a[72:73], v152 offset:16448
  ds_read_b64_tr_b16 a[74:75], v153 offset:16448
  ds_read_b64_tr_b16 a[76:77], v154 offset:16448
  ds_read_b64_tr_b16 a[78:79], v155 offset:16448
  s_waitcnt lgkmcnt(0)
  s_add_u32 m0, s28, 16384
  s_nop 0
  buffer_load_dwordx4 v144, s[8:11], s17 offen lds
  s_add_u32 s17, s17, s29
  s_add_u32 m0, s28, 17408
  s_nop 0
  buffer_load_dwordx4 v144, s[8:11], s17 offen lds
  s_add_u32 s17, s17, s29
  s_add_u32 m0, s28, 18432
  s_nop 0
  buffer_load_dwordx4 v144, s[8:11], s17 offen lds
  s_add_u32 s17, s17, s29
  s_add_u32 m0, s28, 19456
  s_nop 0
  buffer_load_dwordx4 v144, s[8:11], s17 offen lds
  s_add_u32 s17, s17, s29
  s_waitcnt vmcnt(37)
  ds_read_b64_tr_b16 a[80:81], v152 offset:20480
  ds_read_b64_tr_b16 a[82:83], v153 offset:20480
  ds_read_b64_tr_b16 a[84:85], v154 offset:20480
  ds_read_b64_tr_b16 a[86:87], v155 offset:20480
  ds_read_b64_tr_b16 a[88:89], v152 offset:20544
  ds_read_b64_tr_b16 a[90:91], v153 offset:20544
  ds_read_b64_tr_b16 a[92:93], v154 offset:20544
  ds_read_b64_tr_b16 a[94:95], v155 offset:20544
  s_waitcnt lgkmcnt(0)
  s_add_u32 m0, s28, 20480
  s_nop 0
  buffer_load_dwordx4 v144, s[8:11], s17 offen lds
  s_add_u32 s17, s17, s29
  s_add_u32 m0, s28, 21504
  s_nop 0
  buffer_load_dwordx4 v144, s[8:11], s17 offen lds
  s_add_u32 s17, s17, s29
  s_add_u32 m0, s28, 22528
  s_nop 0
  buffer_load_dwordx4 v144, s[8:11], s17 offen lds
  s_add_u32 s17, s17, s29
  s_add_u32 m0, s28, 23552
  s_nop 0
  buffer_load_dwordx4 v144, s[8:11], s17 offen lds
  s_add_u32 s17, s17, s29
  s_waitcnt vmcnt(37)
  ds_read_b64_tr_b16 a[96:97], v152 offset:24576
  ds_read_b64_tr_b16 a[98:99], v153 offset:24576
  ds_read_b64_tr_b16 a[100:101], v154 offset:24576
  ds_read_b64_tr_b16 a[102:103], v155 offset:24576
  ds_read_b64_tr_b16 a[104:105], v152 offset:24640
  ds_read_b64_tr_b16 a[106:107], v153 offset:24640
  ds_read_b64_tr_b16 a[108:109], v154 offset:24640
  ds_read_b64_tr_b16 a[110:111], v155 offset:24640
  s_waitcnt lgkmcnt(0)
  s_add_u32 m0, s28, 24576
  s_nop 0
  buffer_load_dwordx4 v144, s[8:11], s17 offen lds
  s_add_u32 s17, s17, s29
  s_add_u32 m0, s28, 25600
  s_nop 0
  buffer_load_dwordx4 v144, s[8:11], s17 offen lds
  s_add_u32 s17, s17, s29
  s_add_u32 m0, s28, 26624
  s_nop 0
  buffer_load_dwordx4 v144, s[8:11], s17 offen lds
  s_add_u32 s17, s17, s29
  s_add_u32 m0, s28, 27648
  s_nop 0
  buffer_load_dwordx4 v144, s[8:11], s17 offen lds
  s_add_u32 s17, s17, s29
  s_waitcnt vmcnt(37)
  ds_read_b64_tr_b16 a[112:113], v152 offset:28672
  ds_read_b64_tr_b16 a[114:115], v153 offset:28672
  ds_read_b64_tr_b16 a[116:117], v154 offset:28672
  ds_read_b64_tr_b16 a[118:119], v155 offset:28672
  ds_read_b64_tr_b16 a[120:121], v152 offset:28736
  ds_read_b64_tr_b16 a[122:123], v153 offset:28736
  ds_read_b64_tr_b16 a[124:125], v154 offset:28736
  ds_read_b64_tr_b16 a[126:127], v155 offset:28736
  s_waitcnt lgkmcnt(0)
  s_add_u32 m0, s28, 28672
  s_nop 0
  buffer_load_dwordx4 v144, s[8:11], s17 offen lds
  s_add_u32 s17, s17, s29
  s_add_u32 m0, s28, 29696
  s_nop 0
  buffer_load_dwordx4 v144, s[8:11], s17 offen lds
  s_add_u32 s17, s17, s29
  s_add_u32 m0, s28, 30720
  s_nop 0
  buffer_load_dwordx4 v144, s[8:11], s17 offen lds
  s_add_u32 s17, s17, s29
  s_add_u32 m0, s28, 31744
  s_nop 0
  buffer_load_dwordx4 v144, s[8:11], s17 offen lds
  s_add_u32 s17, s17, s29
  s_waitcnt vmcnt(28)
  ds_read_b64_tr_b16 a[128:129], v152 offset:0
  ds_read_b64_tr_b16 a[130:131], v153 offset:0
  ds_read_b64_tr_b16 a[132:133], v154 offset:0
  ds_read_b64_tr_b16 a[134:135], v155 offset:0
  ds_read_b64_tr_b16 a[136:137], v152 offset:64
  ds_read_b64_tr_b16 a[138:139], v153 offset:64
  ds_read_b64_tr_b16 a[140:141], v154 offset:64
  ds_read_b64_tr_b16 a[142:143], v155 offset:64
  s_waitcnt lgkmcnt(0)
  s_waitcnt vmcnt(24)
  ds_read_b64_tr_b16 a[144:145], v152 offset:4096
  ds_read_b64_tr_b16 a[146:147], v153 offset:4096
  ds_read_b64_tr_b16 a[148:149], v154 offset:4096
  ds_read_b64_tr_b16 a[150:151], v155 offset:4096
  ds_read_b64_tr_b16 a[152:153], v152 offset:4160
  ds_read_b64_tr_b16 a[154:155], v153 offset:4160
  ds_read_b64_tr_b16 a[156:157], v154 offset:4160
  ds_read_b64_tr_b16 a[158:159], v155 offset:4160
  s_waitcnt lgkmcnt(0)
  s_waitcnt vmcnt(20)
  ds_read_b64_tr_b16 a[160:161], v152 offset:8192
  ds_read_b64_tr_b16 a[162:163], v153 offset:8192
  ds_read_b64_tr_b16 a[164:165], v154 offset:8192
  ds_read_b64_tr_b16 a[166:167], v155 offset:8192
  ds_read_b64_tr_b16 a[168:169], v152 offset:8256
  ds_read_b64_tr_b16 a[170:171], v153 offset:8256
  ds_read_b64_tr_b16 a[172:173], v154 offset:8256
  ds_read_b64_tr_b16 a[174:175], v155 offset:8256
  s_waitcnt lgkmcnt(0)
  s_waitcnt vmcnt(16)
  ds_read_b64_tr_b16 a[176:177], v152 offset:12288
  ds_read_b64_tr_b16 a[178:179], v153 offset:12288
  ds_read_b64_tr_b16 a[180:181], v154 offset:12288
  ds_read_b64_tr_b16 a[182:183], v155 offset:12288
  ds_read_b64_tr_b16 a[184:185], v152 offset:12352
  ds_read_b64_tr_b16 a[186:187], v153 offset:12352
  ds_read_b64_tr_b16 a[188:189], v154 offset:12352
  ds_read_b64_tr_b16 a[190:191], v155 offset:12352
  s_waitcnt lgkmcnt(0)
  s_waitcnt vmcnt(12)
  ds_read_b64_tr_b16 a[192:193], v152 offset:16384
  ds_read_b64_tr_b16 a[194:195], v153 offset:16384
  ds_read_b64_tr_b16 a[196:197], v154 offset:16384
  ds_read_b64_tr_b16 a[198:199], v155 offset:16384
  ds_read_b64_tr_b16 a[200:201], v152 offset:16448
  ds_read_b64_tr_b16 a[202:203], v153 offset:16448
  ds_read_b64_tr_b16 a[204:205], v154 offset:16448
  ds_read_b64_tr_b16 a[206:207], v155 offset:16448
  s_waitcnt lgkmcnt(0)
  s_waitcnt vmcnt(8)
  ds_read_b64_tr_b16 a[208:209], v152 offset:20480
  ds_read_b64_tr_b16 a[210:211], v153 offset:20480
  ds_read_b64_tr_b16 a[212:213], v154 offset:20480
  ds_read_b64_tr_b16 a[214:215], v155 offset:20480
  ds_read_b64_tr_b16 a[216:217], v152 offset:20544
  ds_read_b64_tr_b16 a[218:219], v153 offset:20544
  ds_read_b64_tr_b16 a[220:221], v154 offset:20544
  ds_read_b64_tr_b16 a[222:223], v155 offset:20544
  s_waitcnt lgkmcnt(0)
  s_waitcnt vmcnt(4)
  ds_read_b64_tr_b16 a[224:225], v152 offset:24576
  ds_read_b64_tr_b16 a[226:227], v153 offset:24576
  ds_read_b64_tr_b16 a[228:229], v154 offset:24576
  ds_read_b64_tr_b16 a[230:231], v155 offset:24576
  ds_read_b64_tr_b16 a[232:233], v152 offset:24640
  ds_read_b64_tr_b16 a[234:235], v153 offset:24640
  ds_read_b64_tr_b16 a[236:237], v154 offset:24640
  ds_read_b64_tr_b16 a[238:239], v155 offset:24640
  s_waitcnt lgkmcnt(0)
  s_waitcnt vmcnt(0)
  ds_read_b64_tr_b16 a[240:241], v152 offset:28672
  ds_read_b64_tr_b16 a[242:243], v153 offset:28672
  ds_read_b64_tr_b16 a[244:245], v154 offset:28672
  ds_read_b64_tr_b16 a[246:247], v155 offset:28672
  ds_read_b64_tr_b16 a[248:249], v152 offset:28736
  ds_read_b64_tr_b16 a[250:251], v153 offset:28736
  ds_read_b64_tr_b16 a[252:253], v154 offset:28736
  ds_read_b64_tr_b16 a[254:255], v155 offset:28736
  s_waitcnt lgkmcnt(0)
  s_barrier
  s_add_u32 m0, s25, 0
  s_nop 0
  buffer_load_dwordx4 v16, s[12:15], s19 offen lds
  s_add_u32 m0, s25, 1024
  s_nop 0
  buffer_load_dwordx4 v17, s[12:15], s19 offen lds
  s_add_u32 m0, s25, 2048
  s_nop 0
  buffer_load_dwordx4 v18, s[12:15], s19 offen lds
  s_add_u32 m0, s25, 3072
  s_nop 0
  buffer_load_dwordx4 v19, s[12:15], s19 offen lds
  s_add_u32 m0, s25, 4096
  s_nop 0
  buffer_load_dwordx4 v20, s[12:15], s19 offen lds
  s_add_u32 m0, s25, 5120
  s_nop 0
  buffer_load_dwordx4 v21, s[12:15], s19 offen lds
  s_add_u32 m0, s25, 6144
  s_nop 0
  buffer_load_dwordx4 v22, s[12:15], s19 offen lds
  s_add_u32 m0, s25, 7168
  s_nop 0
  buffer_load_dwordx4 v23, s[12:15], s19 offen lds
  s_cmp_gt_u32 s23, 2
  s_cselect_b32 s26, s20, 0
  s_add_u32 s19, s19, s26
  s_add_u32 s25, s25, 32768
  s_and_b32 s25, s25, 0x1ffff
  s_waitcnt vmcnt(0)
  s_barrier
  s_load_dwordx2 s[8:9], s[0:1], 40
  s_mul_i32 s76, s66, 18816
  v_min_u32 v200, 146, v0
  v_lshl_add_u32 v200, v200, 7, s76
  s_waitcnt lgkmcnt(0)
  s_and_b32 s9, s9, 0xffff
  buffer_load_dword v201, v200, s[8:11], 0 offen
  s_cmp_lg_u32 s32, 0
  s_cbranch_scc1 P_v_130
  s_cmp_eq_u32 s48, 0
  s_cbranch_scc1 P_q_132
  s_mov_b32 s27, s21
  v_mov_b32 v7, 0x40000000
  s_mov_b32 s29, -2
  v_min_u32 v145, 1, v0
  v_lshlrev_b32 v145, 30, v145
  ds_read_b128 v[24:27], v8 offset:0
  ds_read_b128 v[28:31], v9 offset:0
  ds_read_b128 v[32:35], v10 offset:0
  ds_read_b128 v[36:39], v11 offset:0
  ds_read_b128 v[40:43], v12 offset:0
  ds_read_b128 v[44:47], v13 offset:0
.p2align 6
G_top_133:
  s_waitcnt lgkmcnt(5)
  v_mfma_f32_16x16x32_bf16 v[64:67], a[0:3], v[24:27], 0
  s_add_u32 m0, s25, 0
  ds_read_b128 v[48:51], v14 offset:0
  v_mfma_f32_16x16x32_bf16 v[68:71], a[4:7], v[24:27], 0
  v_mfma_f32_16x16x32_bf16 v[80:83], a[8:11], v[24:27], 0
  buffer_load_dwordx4 v16, s[12:15], s19 offen lds
  v_mfma_f32_16x16x32_bf16 v[84:87], a[12:15], v[24:27], 0
  s_waitcnt lgkmcnt(5)
  v_mfma_f32_16x16x32_bf16 v[72:75], a[0:3], v[28:31], 0
  ds_read_b128 v[52:55], v15 offset:0
  v_mfma_f32_16x16x32_bf16 v[76:79], a[4:7], v[28:31], 0
  v_cvt_pk_bf16_f32 v128, v96, v97
  v_cvt_pk_bf16_f32 v129, v98, v99
  v_mfma_f32_16x16x32_bf16 v[88:91], a[8:11], v[28:31], 0
  v_mfma_f32_16x16x32_bf16 v[92:95], a[12:15], v[28:31], 0
  s_waitcnt lgkmcnt(5)
  v_cvt_pk_bf16_f32 v130, v100, v101
  v_cvt_pk_bf16_f32 v131, v102, v103
  v_mfma_f32_16x16x32_bf16 v[64:67], a[16:19], v[32:35], v[64:67]
  s_add_u32 m0, s25, 1024
  ds_read_b128 v[24:27], v8 offset:8192
  v_mfma_f32_16x16x32_bf16 v[68:71], a[20:23], v[32:35], v[68:71]
  v_mfma_f32_16x16x32_bf16 v[80:83], a[24:27], v[32:35], v[80:83]
  buffer_load_dwordx4 v17, s[12:15], s19 offen lds
  v_mfma_f32_16x16x32_bf16 v[84:87], a[28:31], v[32:35], v[84:87]
  s_waitcnt lgkmcnt(5)
  v_mfma_f32_16x16x32_bf16 v[72:75], a[16:19], v[36:39], v[72:75]
  ds_read_b128 v[28:31], v9 offset:8192
  v_mfma_f32_16x16x32_bf16 v[76:79], a[20:23], v[36:39], v[76:79]
  v_mfma_f32_16x16x32_bf16 v[88:91], a[24:27], v[36:39], v[88:91]
  v_mfma_f32_16x16x32_bf16 v[92:95], a[28:31], v[36:39], v[92:95]
  s_waitcnt lgkmcnt(5)
  v_mfma_f32_16x16x32_bf16 v[64:67], a[32:35], v[40:43], v[64:67]
  s_add_u32 m0, s25, 2048
  ds_read_b128 v[32:35], v10 offset:8192
  v_mfma_f32_16x16x32_bf16 v[68:71], a[36:39], v[40:43], v[68:71]
  v_cvt_pk_bf16_f32 v132, v104, v105
  v_cvt_pk_bf16_f32 v133, v106, v107
  v_mfma_f32_16x16x32_bf16 v[80:83], a[40:43], v[40:43], v[80:83]
  buffer_load_dwordx4 v18, s[12:15], s19 offen lds
  v_mfma_f32_16x16x32_bf16 v[84:87], a[44:47], v[40:43], v[84:87]
  s_waitcnt lgkmcnt(5)
  v_cvt_pk_bf16_f32 v134, v108, v109
  v_cvt_pk_bf16_f32 v135, v110, v111
  v_mfma_f32_16x16x32_bf16 v[72:75], a[32:35], v[44:47], v[72:75]
  ds_read_b128 v[36:39], v11 offset:8192
  v_mfma_f32_16x16x32_bf16 v[76:79], a[36:39], v[44:47], v[76:79]
  v_mfma_f32_16x16x32_bf16 v[88:91], a[40:43], v[44:47], v[88:91]
  v_mfma_f32_16x16x32_bf16 v[92:95], a[44:47], v[44:47], v[92:95]
  s_waitcnt lgkmcnt(5)
  v_mfma_f32_16x16x32_bf16 v[64:67], a[48:51], v[48:51], v[64:67]
  s_add_u32 m0, s25, 3072
  ds_read_b128 v[40:43], v12 offset:8192
  v_mfma_f32_16x16x32_bf16 v[68:71], a[52:55], v[48:51], v[68:71]
  v_mfma_f32_16x16x32_bf16 v[80:83], a[56:59], v[48:51], v[80:83]
  buffer_load_dwordx4 v19, s[12:15], s19 offen lds
  v_mfma_f32_16x16x32_bf16 v[84:87], a[60:63], v[48:51], v[84:87]
  s_waitcnt lgkmcnt(5)
  v_mfma_f32_16x16x32_bf16 v[72:75], a[48:51], v[52:55], v[72:75]
  ds_read_b128 v[44:47], v13 offset:8192
  v_mfma_f32_16x16x32_bf16 v[76:79], a[52:55], v[52:55], v[76:79]
  v_cvt_pk_bf16_f32 v136, v112, v113
  v_cvt_pk_bf16_f32 v137, v114, v115
  v_mfma_f32_16x16x32_bf16 v[88:91], a[56:59], v[52:55], v[88:91]
  v_mfma_f32_16x16x32_bf16 v[92:95], a[60:63], v[52:55], v[92:95]
  s_waitcnt lgkmcnt(5)
  v_cvt_pk_bf16_f32 v138, v116, v117
  v_cvt_pk_bf16_f32 v139, v118, v119
  v_mfma_f32_16x16x32_bf16 v[64:67], a[64:67], v[24:27], v[64:67]
  s_add_u32 m0, s25, 4096
  ds_read_b128 v[48:51], v14 offset:8192
  v_mfma_f32_16x16x32_bf16 v[68:71], a[68:71], v[24:27], v[68:71]
  v_mfma_f32_16x16x32_bf16 v[80:83], a[72:75], v[24:27], v[80:83]
  buffer_load_dwordx4 v20, s[12:15], s19 offen lds
  v_mfma_f32_16x16x32_bf16 v[84:87], a[76:79], v[24:27], v[84:87]
  s_waitcnt lgkmcnt(5)
  v_mfma_f32_16x16x32_bf16 v[72:75], a[64:67], v[28:31], v[72:75]
  ds_read_b128 v[52:55], v15 offset:8192
  v_mfma_f32_16x16x32_bf16 v[76:79], a[68:71], v[28:31], v[76:79]
  v_mfma_f32_16x16x32_bf16 v[88:91], a[72:75], v[28:31], v[88:91]
  v_mfma_f32_16x16x32_bf16 v[92:95], a[76:79], v[28:31], v[92:95]
  s_waitcnt lgkmcnt(5)
  v_mfma_f32_16x16x32_bf16 v[64:67], a[80:83], v[32:35], v[64:67]
  s_add_u32 m0, s25, 5120
  ds_read_b128 v[24:27], v8 offset:16384
  v_mfma_f32_16x16x32_bf16 v[68:71], a[84:87], v[32:35], v[68:71]
  v_cvt_pk_bf16_f32 v140, v120, v121
  v_cvt_pk_bf16_f32 v141, v122, v123
  v_mfma_f32_16x16x32_bf16 v[80:83], a[88:91], v[32:35], v[80:83]
  buffer_load_dwordx4 v21, s[12:15], s19 offen lds
  v_mfma_f32_16x16x32_bf16 v[84:87], a[92:95], v[32:35], v[84:87]
  s_waitcnt lgkmcnt(5)
  v_cvt_pk_bf16_f32 v142, v124, v125
  v_cvt_pk_bf16_f32 v143, v126, v127
  v_mfma_f32_16x16x32_bf16 v[72:75], a[80:83], v[36:39], v[72:75]
  ds_read_b128 v[28:31], v9 offset:16384
  v_mfma_f32_16x16x32_bf16 v[76:79], a[84:87], v[36:39], v[76:79]
  v_mfma_f32_16x16x32_bf16 v[88:91], a[88:91], v[36:39], v[88:91]
  v_mfma_f32_16x16x32_bf16 v[92:95], a[92:95], v[36:39], v[92:95]
  s_waitcnt lgkmcnt(5)
  v_mfma_f32_16x16x32_bf16 v[64:67], a[96:99], v[40:43], v[64:67]
  s_add_u32 m0, s25, 6144
  ds_read_b128 v[32:35], v10 offset:16384
  v_mfma_f32_16x16x32_bf16 v[68:71], a[100:103], v[40:43], v[68:71]
  v_mfma_f32_16x16x32_bf16 v[80:83], a[104:107], v[40:43], v[80:83]
  buffer_load_dwordx4 v22, s[12:15], s19 offen lds
  v_mfma_f32_16x16x32_bf16 v[84:87], a[108:111], v[40:43], v[84:87]
  s_waitcnt lgkmcnt(5)
  v_mfma_f32_16x16x32_bf16 v[72:75], a[96:99], v[44:47], v[72:75]
  ds_read_b128 v[36:39], v11 offset:16384
  v_mfma_f32_16x16x32_bf16 v[76:79], a[100:103], v[44:47], v[76:79]
  v_mfma_f32_16x16x32_bf16 v[88:91], a[104:107], v[44:47], v[88:91]
  v_mfma_f32_16x16x32_bf16 v[92:95], a[108:111], v[44:47], v[92:95]
  s_waitcnt lgkmcnt(5)
  v_mfma_f32_16x16x32_bf16 v[64:67], a[112:115], v[48:51], v[64:67]
  s_add_u32 m0, s25, 7168
  ds_read_b128 v[40:43], v12 offset:16384
  v_mfma_f32_16x16x32_bf16 v[68:71], a[116:119], v[48:51], v[68:71]
  v_mfma_f32_16x16x32_bf16 v[80:83], a[120:123], v[48:51], v[80:83]
  buffer_load_dwordx4 v23, s[12:15], s19 offen lds
  v_mfma_f32_16x16x32_bf16 v[84:87], a[124:127], v[48:51], v[84:87]
  s_waitcnt lgkmcnt(5)
  v_mfma_f32_16x16x32_bf16 v[72:75], a[112:115], v[52:55], v[72:75]
  s_cmp_gt_u32 s23, 3
  ds_read_b128 v[44:47], v13 offset:16384
  v_mfma_f32_16x16x32_bf16 v[76:79], a[116:119], v[52:55], v[76:79]
  v_mfma_f32_16x16x32_bf16 v[88:91], a[120:123], v[52:55], v[88:91]
  s_cselect_b32 s26, s20, 0
  v_mfma_f32_16x16x32_bf16 v[92:95], a[124:127], v[52:55], v[92:95]
  s_waitcnt lgkmcnt(5)
  v_mfma_f32_16x16x32_bf16 v[64:67], a[128:131], v[24:27], v[64:67]
  s_add_u32 s19, s19, s26
  ds_read_b128 v[48:51], v14 offset:16384
  v_mfma_f32_16x16x32_bf16 v[68:71], a[132:135], v[24:27], v[68:71]
  v_mfma_f32_16x16x32_bf16 v[80:83], a[136:139], v[24:27], v[80:83]
  s_add_u32 s25, s25, 32768
  v_mfma_f32_16x16x32_bf16 v[84:87], a[140:143], v[24:27], v[84:87]
  s_waitcnt lgkmcnt(5)
  v_mfma_f32_16x16x32_bf16 v[72:75], a[128:131], v[28:31], v[72:75]
  s_and_b32 s25, s25, 0x1ffff
  ds_read_b128 v[52:55], v15 offset:16384
  v_mfma_f32_16x16x32_bf16 v[76:79], a[132:135], v[28:31], v[76:79]
  v_mfma_f32_16x16x32_bf16 v[88:91], a[136:139], v[28:31], v[88:91]
  buffer_store_dwordx4 v[128:131], v7, s[4:7], s21 offen offset:0 sc1
  v_mfma_f32_16x16x32_bf16 v[92:95], a[140:143], v[28:31], v[92:95]
  s_waitcnt lgkmcnt(5)
  v_mfma_f32_16x16x32_bf16 v[64:67], a[144:147], v[32:35], v[64:67]
  ds_read_b128 v[24:27], v8 offset:24576
  v_mfma_f32_16x16x32_bf16 v[68:71], a[148:151], v[32:35], v[68:71]
  v_mfma_f32_16x16x32_bf16 v[80:83], a[152:155], v[32:35], v[80:83]
  v_mfma_f32_16x16x32_bf16 v[84:87], a[156:159], v[32:35], v[84:87]
  s_waitcnt lgkmcnt(5)
  v_mfma_f32_16x16x32_bf16 v[72:75], a[144:147], v[36:39], v[72:75]
  ds_read_b128 v[28:31], v9 offset:24576
  v_mfma_f32_16x16x32_bf16 v[76:79], a[148:151], v[36:39], v[76:79]
  v_mfma_f32_16x16x32_bf16 v[88:91], a[152:155], v[36:39], v[88:91]
  buffer_store_dwordx4 v[132:135], v7, s[4:7], s21 offen offset:256 sc1
  v_mfma_f32_16x16x32_bf16 v[92:95], a[156:159], v[36:39], v[92:95]
  s_waitcnt lgkmcnt(5)
  v_mfma_f32_16x16x32_bf16 v[64:67], a[160:163], v[40:43], v[64:67]
  ds_read_b128 v[32:35], v10 offset:24576
  v_mfma_f32_16x16x32_bf16 v[68:71], a[164:167], v[40:43], v[68:71]
  v_mfma_f32_16x16x32_bf16 v[80:83], a[168:171], v[40:43], v[80:83]
  v_mfma_f32_16x16x32_bf16 v[84:87], a[172:175], v[40:43], v[84:87]
  s_waitcnt lgkmcnt(5)
  v_mfma_f32_16x16x32_bf16 v[72:75], a[160:163], v[44:47], v[72:75]
  ds_read_b128 v[36:39], v11 offset:24576
  v_mfma_f32_16x16x32_bf16 v[76:79], a[164:167], v[44:47], v[76:79]
  v_mfma_f32_16x16x32_bf16 v[88:91], a[168:171], v[44:47], v[88:91]
  buffer_store_dwordx4 v[136:139], v7, s[4:7], s21 offen offset:2048 sc1
  v_mfma_f32_16x16x32_bf16 v[92:95], a[172:175], v[44:47], v[92:95]
  s_waitcnt lgkmcnt(5)
  v_mfma_f32_16x16x32_bf16 v[64:67], a[176:179], v[48:51], v[64:67]
  ds_read_b128 v[40:43], v12 offset:24576
  v_mfma_f32_16x16x32_bf16 v[68:71], a[180:183], v[48:51], v[68:71]
  v_mfma_f32_16x16x32_bf16 v[80:83], a[184:187], v[48:51], v[80:83]
  v_mfma_f32_16x16x32_bf16 v[84:87], a[188:191], v[48:51], v[84:87]
  s_waitcnt lgkmcnt(5)
  v_mfma_f32_16x16x32_bf16 v[72:75], a[176:179], v[52:55], v[72:75]
  ds_read_b128 v[44:47], v13 offset:24576
  v_mfma_f32_16x16x32_bf16 v[76:79], a[180:183], v[52:55], v[76:79]
  v_mfma_f32_16x16x32_bf16 v[88:91], a[184:187], v[52:55], v[88:91]
  buffer_store_dwordx4 v[140:143], v7, s[4:7], s21 offen offset:2304 sc1
  v_mfma_f32_16x16x32_bf16 v[92:95], a[188:191], v[52:55], v[92:95]
  s_waitcnt lgkmcnt(5)
  v_mfma_f32_16x16x32_bf16 v[64:67], a[192:195], v[24:27], v[64:67]
  s_mov_b32 s21, s27
  ds_read_b128 v[48:51], v14 offset:24576
  v_mfma_f32_16x16x32_bf16 v[68:71], a[196:199], v[24:27], v[68:71]
  v_mov_b32 v7, v56
  v_mfma_f32_16x16x32_bf16 v[80:83], a[200:203], v[24:27], v[80:83]
  v_mfma_f32_16x16x32_bf16 v[84:87], a[204:207], v[24:27], v[84:87]
  s_waitcnt lgkmcnt(5)
  v_mfma_f32_16x16x32_bf16 v[72:75], a[192:195], v[28:31], v[72:75]
  s_add_u32 s27, s27, s22
  ds_read_b128 v[52:55], v15 offset:24576
  v_mfma_f32_16x16x32_bf16 v[76:79], a[196:199], v[28:31], v[76:79]
  v_mfma_f32_16x16x32_bf16 v[88:91], a[200:203], v[28:31], v[88:91]
  s_waitcnt vmcnt(13)
  s_barrier
  v_mfma_f32_16x16x32_bf16 v[92:95], a[204:207], v[28:31], v[92:95]
  s_waitcnt lgkmcnt(5)
  v_mfma_f32_16x16x32_bf16 v[64:67], a[208:211], v[32:35], v[64:67]
  ds_read_b128 v[24:27], v8 offset:32768
  v_mfma_f32_16x16x32_bf16 v[68:71], a[212:215], v[32:35], v[68:71]
  v_mfma_f32_16x16x32_bf16 v[80:83], a[216:219], v[32:35], v[80:83]
  v_mfma_f32_16x16x32_bf16 v[84:87], a[220:223], v[32:35], v[84:87]
  s_waitcnt lgkmcnt(5)
  v_mfma_f32_16x16x32_bf16 v[72:75], a[208:211], v[36:39], v[72:75]
  s_add_u32 s29, s29, 1
  ds_read_b128 v[28:31], v9 offset:32768
  v_mfma_f32_16x16x32_bf16 v[76:79], a[212:215], v[36:39], v[76:79]
  v_mfma_f32_16x16x32_bf16 v[88:91], a[216:219], v[36:39], v[88:91]
  s_max_i32 s30, s29, 0
  v_mfma_f32_16x16x32_bf16 v[92:95], a[220:223], v[36:39], v[92:95]
  s_waitcnt lgkmcnt(5)
  v_mov_b32 v144, s30
  v_mfma_f32_16x16x32_bf16 v[64:67], a[224:227], v[40:43], v[64:67]
  ds_read_b128 v[32:35], v10 offset:32768
  v_mfma_f32_16x16x32_bf16 v[68:71], a[228:231], v[40:43], v[68:71]
  v_mfma_f32_16x16x32_bf16 v[80:83], a[232:235], v[40:43], v[80:83]
  buffer_store_dword v144, v145, s[4:7], s31 offen sc1
  v_mfma_f32_16x16x32_bf16 v[84:87], a[236:239], v[40:43], v[84:87]
  s_waitcnt lgkmcnt(5)
  v_mfma_f32_16x16x32_bf16 v[72:75], a[224:227], v[44:47], v[72:75]
  ds_read_b128 v[36:39], v11 offset:32768
  v_mfma_f32_16x16x32_bf16 v[76:79], a[228:231], v[44:47], v[76:79]
  v_mfma_f32_16x16x32_bf16 v[88:91], a[232:235], v[44:47], v[88:91]
  v_mfma_f32_16x16x32_bf16 v[92:95], a[236:239], v[44:47], v[92:95]
  s_waitcnt lgkmcnt(5)
  v_mfma_f32_16x16x32_bf16 v[64:67], a[240:243], v[48:51], v[64:67]
  s_sub_u32 s23, s23, 1
  ds_read_b128 v[40:43], v12 offset:32768
  v_mfma_f32_16x16x32_bf16 v[68:71], a[244:247], v[48:51], v[68:71]
  v_mfma_f32_16x16x32_bf16 v[80:83], a[248:251], v[48:51], v[80:83]
  v_mfma_f32_16x16x32_bf16 v[84:87], a[252:255], v[48:51], v[84:87]
  s_waitcnt lgkmcnt(5)
  v_mfma_f32_16x16x32_bf16 v[72:75], a[240:243], v[52:55], v[72:75]
  s_cmp_eq_u32 s23, 0
  ds_read_b128 v[44:47], v13 offset:32768
  v_mfma_f32_16x16x32_bf16 v[76:79], a[244:247], v[52:55], v[76:79]
  v_mfma_f32_16x16x32_bf16 v[88:91], a[248:251], v[52:55], v[88:91]
  v_mfma_f32_16x16x32_bf16 v[92:95], a[252:255], v[52:55], v[92:95]
  s_cbranch_scc1 G_done0_134
  s_waitcnt lgkmcnt(5)
  v_mfma_f32_16x16x32_bf16 v[96:99], a[0:3], v[24:27], 0
  s_add_u32 m0, s25, 0
  ds_read_b128 v[48:51], v14 offset:32768
  v_mfma_f32_16x16x32_bf16 v[100:103], a[4:7], v[24:27], 0
  v_mfma_f32_16x16x32_bf16 v[112:115], a[8:11], v[24:27], 0
  buffer_load_dwordx4 v16, s[12:15], s19 offen lds
  v_mfma_f32_16x16x32_bf16 v[116:119], a[12:15], v[24:27], 0
  s_waitcnt lgkmcnt(5)
  v_mfma_f32_16x16x32_bf16 v[104:107], a[0:3], v[28:31], 0
  ds_read_b128 v[52:55], v15 offset:32768
  v_mfma_f32_16x16x32_bf16 v[108:111], a[4:7], v[28:31], 0
  v_cvt_pk_bf16_f32 v128, v64, v65
  v_cvt_pk_bf16_f32 v129, v66, v67
  v_mfma_f32_16x16x32_bf16 v[120:123], a[8:11], v[28:31], 0
  v_mfma_f32_16x16x32_bf16 v[124:127], a[12:15], v[28:31], 0
  s_waitcnt lgkmcnt(5)
  v_cvt_pk_bf16_f32 v130, v68, v69
  v_cvt_pk_bf16_f32 v131, v70, v71
  v_mfma_f32_16x16x32_bf16 v[96:99], a[16:19], v[32:35], v[96:99]
  s_add_u32 m0, s25, 1024
  ds_read_b128 v[24:27], v8 offset:40960
  v_mfma_f32_16x16x32_bf16 v[100:103], a[20:23], v[32:35], v[100:103]
  v_mfma_f32_16x16x32_bf16 v[112:115], a[24:27], v[32:35], v[112:115]
  buffer_load_dwordx4 v17, s[12:15], s19 offen lds
  v_mfma_f32_16x16x32_bf16 v[116:119], a[28:31], v[32:35], v[116:119]
  s_waitcnt lgkmcnt(5)
  v_mfma_f32_16x16x32_bf16 v[104:107], a[16:19], v[36:39], v[104:107]
  ds_read_b128 v[28:31], v9 offset:40960
  v_mfma_f32_16x16x32_bf16 v[108:111], a[20:23], v[36:39], v[108:111]
  v_mfma_f32_16x16x32_bf16 v[120:123], a[24:27], v[36:39], v[120:123]
  v_mfma_f32_16x16x32_bf16 v[124:127], a[28:31], v[36:39], v[124:127]
  s_waitcnt lgkmcnt(5)
  v_mfma_f32_16x16x32_bf16 v[96:99], a[32:35], v[40:43], v[96:99]
  s_add_u32 m0, s25, 2048
  ds_read_b128 v[32:35], v10 offset:40960
  v_mfma_f32_16x16x32_bf16 v[100:103], a[36:39], v[40:43], v[100:103]
  v_cvt_pk_bf16_f32 v132, v72, v73
  v_cvt_pk_bf16_f32 v133, v74, v75
  v_mfma_f32_16x16x32_bf16 v[112:115], a[40:43], v[40:43], v[112:115]
  buffer_load_dwordx4 v18, s[12:15], s19 offen lds
  v_mfma_f32_16x16x32_bf16 v[116:119], a[44:47], v[40:43], v[116:119]
  s_waitcnt lgkmcnt(5)
  v_cvt_pk_bf16_f32 v134, v76, v77
  v_cvt_pk_bf16_f32 v135, v78, v79
  v_mfma_f32_16x16x32_bf16 v[104:107], a[32:35], v[44:47], v[104:107]
  ds_read_b128 v[36:39], v11 offset:40960
  v_mfma_f32_16x16x32_bf16 v[108:111], a[36:39], v[44:47], v[108:111]
  v_mfma_f32_16x16x32_bf16 v[120:123], a[40:43], v[44:47], v[120:123]
  v_mfma_f32_16x16x32_bf16 v[124:127], a[44:47], v[44:47], v[124:127]
  s_waitcnt lgkmcnt(5)
  v_mfma_f32_16x16x32_bf16 v[96:99], a[48:51], v[48:51], v[96:99]
  s_add_u32 m0, s25, 3072
  ds_read_b128 v[40:43], v12 offset:40960
  v_mfma_f32_16x16x32_bf16 v[100:103], a[52:55], v[48:51], v[100:103]
  v_mfma_f32_16x16x32_bf16 v[112:115], a[56:59], v[48:51], v[112:115]
  buffer_load_dwordx4 v19, s[12:15], s19 offen lds
  v_mfma_f32_16x16x32_bf16 v[116:119], a[60:63], v[48:51], v[116:119]
  s_waitcnt lgkmcnt(5)
  v_mfma_f32_16x16x32_bf16 v[104:107], a[48:51], v[52:55], v[104:107]
  ds_read_b128 v[44:47], v13 offset:40960
  v_mfma_f32_16x16x32_bf16 v[108:111], a[52:55], v[52:55], v[108:111]
  v_cvt_pk_bf16_f32 v136, v80, v81
  v_cvt_pk_bf16_f32 v137, v82, v83
  v_mfma_f32_16x16x32_bf16 v[120:123], a[56:59], v[52:55], v[120:123]
  v_mfma_f32_16x16x32_bf16 v[124:127], a[60:63], v[52:55], v[124:127]
  s_waitcnt lgkmcnt(5)
  v_cvt_pk_bf16_f32 v138, v84, v85
  v_cvt_pk_bf16_f32 v139, v86, v87
  v_mfma_f32_16x16x32_bf16 v[96:99], a[64:67], v[24:27], v[96:99]
  s_add_u32 m0, s25, 4096
  ds_read_b128 v[48:51], v14 offset:40960
  v_mfma_f32_16x16x32_bf16 v[100:103], a[68:71], v[24:27], v[100:103]
  v_mfma_f32_16x16x32_bf16 v[112:115], a[72:75], v[24:27], v[112:115]
  buffer_load_dwordx4 v20, s[12:15], s19 offen lds
  v_mfma_f32_16x16x32_bf16 v[116:119], a[76:79], v[24:27], v[116:119]
  s_waitcnt lgkmcnt(5)
  v_mfma_f32_16x16x32_bf16 v[104:107], a[64:67], v[28:31], v[104:107]
  ds_read_b128 v[52:55], v15 offset:40960
  v_mfma_f32_16x16x32_bf16 v[108:111], a[68:71], v[28:31], v[108:111]
  v_mfma_f32_16x16x32_bf16 v[120:123], a[72:75], v[28:31], v[120:123]
  v_mfma_f32_16x16x32_bf16 v[124:127], a[76:79], v[28:31], v[124:127]
  s_waitcnt lgkmcnt(5)
  v_mfma_f32_16x16x32_bf16 v[96:99], a[80:83], v[32:35], v[96:99]
  s_add_u32 m0, s25, 5120
  ds_read_b128 v[24:27], v8 offset:49152
  v_mfma_f32_16x16x32_bf16 v[100:103], a[84:87], v[32:35], v[100:103]
  v_cvt_pk_bf16_f32 v140, v88, v89
  v_cvt_pk_bf16_f32 v141, v90, v91
  v_mfma_f32_16x16x32_bf16 v[112:115], a[88:91], v[32:35], v[112:115]
  buffer_load_dwordx4 v21, s[12:15], s19 offen lds
  v_mfma_f32_16x16x32_bf16 v[116:119], a[92:95], v[32:35], v[116:119]
  s_waitcnt lgkmcnt(5)
  v_cvt_pk_bf16_f32 v142, v92, v93
  v_cvt_pk_bf16_f32 v143, v94, v95
  v_mfma_f32_16x16x32_bf16 v[104:107], a[80:83], v[36:39], v[104:107]
  ds_read_b128 v[28:31], v9 offset:49152
  v_mfma_f32_16x16x32_bf16 v[108:111], a[84:87], v[36:39], v[108:111]
  v_mfma_f32_16x16x32_bf16 v[120:123], a[88:91], v[36:39], v[120:123]
  v_mfma_f32_16x16x32_bf16 v[124:127], a[92:95], v[36:39], v[124:127]
  s_waitcnt lgkmcnt(5)
  v_mfma_f32_16x16x32_bf16 v[96:99], a[96:99], v[40:43], v[96:99]
  s_add_u32 m0, s25, 6144
  ds_read_b128 v[32:35], v10 offset:49152
  v_mfma_f32_16x16x32_bf16 v[100:103], a[100:103], v[40:43], v[100:103]
  v_mfma_f32_16x16x32_bf16 v[112:115], a[104:107], v[40:43], v[112:115]
  buffer_load_dwordx4 v22, s[12:15], s19 offen lds
  v_mfma_f32_16x16x32_bf16 v[116:119], a[108:111], v[40:43], v[116:119]
  s_waitcnt lgkmcnt(5)
  v_mfma_f32_16x16x32_bf16 v[104:107], a[96:99], v[44:47], v[104:107]
  ds_read_b128 v[36:39], v11 offset:49152
  v_mfma_f32_16x16x32_bf16 v[108:111], a[100:103], v[44:47], v[108:111]
  v_mfma_f32_16x16x32_bf16 v[120:123], a[104:107], v[44:47], v[120:123]
  v_mfma_f32_16x16x32_bf16 v[124:127], a[108:111], v[44:47], v[124:127]
  s_waitcnt lgkmcnt(5)
  v_mfma_f32_16x16x32_bf16 v[96:99], a[112:115], v[48:51], v[96:99]
  s_add_u32 m0, s25, 7168
  ds_read_b128 v[40:43], v12 offset:49152
  v_mfma_f32_16x16x32_bf16 v[100:103], a[116:119], v[48:51], v[100:103]
  v_mfma_f32_16x16x32_bf16 v[112:115], a[120:123], v[48:51], v[112:115]
  buffer_load_dwordx4 v23, s[12:15], s19 offen lds
  v_mfma_f32_16x16x32_bf16 v[116:119], a[124:127], v[48:51], v[116:119]
  s_waitcnt lgkmcnt(5)
  v_mfma_f32_16x16x32_bf16 v[104:107], a[112:115], v[52:55], v[104:107]
  s_cmp_gt_u32 s23, 3
  ds_read_b128 v[44:47], v13 offset:49152
  v_mfma_f32_16x16x32_bf16 v[108:111], a[116:119], v[52:55], v[108:111]
  v_mfma_f32_16x16x32_bf16 v[120:123], a[120:123], v[52:55], v[120:123]
  s_cselect_b32 s26, s20, 0
  v_mfma_f32_16x16x32_bf16 v[124:127], a[124:127], v[52:55], v[124:127]
  s_waitcnt lgkmcnt(5)
  v_mfma_f32_16x16x32_bf16 v[96:99], a[128:131], v[24:27], v[96:99]
  s_add_u32 s19, s19, s26
  ds_read_b128 v[48:51], v14 offset:49152
  v_mfma_f32_16x16x32_bf16 v[100:103], a[132:135], v[24:27], v[100:103]
  v_mfma_f32_16x16x32_bf16 v[112:115], a[136:139], v[24:27], v[112:115]
  s_add_u32 s25, s25, 32768
  v_mfma_f32_16x16x32_bf16 v[116:119], a[140:143], v[24:27], v[116:119]
  s_waitcnt lgkmcnt(5)
  v_mfma_f32_16x16x32_bf16 v[104:107], a[128:131], v[28:31], v[104:107]
  s_and_b32 s25, s25, 0x1ffff
  ds_read_b128 v[52:55], v15 offset:49152
  v_mfma_f32_16x16x32_bf16 v[108:111], a[132:135], v[28:31], v[108:111]
  v_mfma_f32_16x16x32_bf16 v[120:123], a[136:139], v[28:31], v[120:123]
  buffer_store_dwordx4 v[128:131], v7, s[4:7], s21 offen offset:0 sc1
  v_mfma_f32_16x16x32_bf16 v[124:127], a[140:143], v[28:31], v[124:127]
  s_waitcnt lgkmcnt(5)
  v_mfma_f32_16x16x32_bf16 v[96:99], a[144:147], v[32:35], v[96:99]
  ds_read_b128 v[24:27], v8 offset:57344
  v_mfma_f32_16x16x32_bf16 v[100:103], a[148:151], v[32:35], v[100:103]
  v_mfma_f32_16x16x32_bf16 v[112:115], a[152:155], v[32:35], v[112:115]
  v_mfma_f32_16x16x32_bf16 v[116:119], a[156:159], v[32:35], v[116:119]
  s_waitcnt lgkmcnt(5)
  v_xor_b32 v8, 0x10000, v8
  v_mfma_f32_16x16x32_bf16 v[104:107], a[144:147], v[36:39], v[104:107]
  ds_read_b128 v[28:31], v9 offset:57344
  v_mfma_f32_16x16x32_bf16 v[108:111], a[148:151], v[36:39], v[108:111]
  v_mfma_f32_16x16x32_bf16 v[120:123], a[152:155], v[36:39], v[120:123]
  buffer_store_dwordx4 v[132:135], v7, s[4:7], s21 offen offset:256 sc1
  v_mfma_f32_16x16x32_bf16 v[124:127], a[156:159], v[36:39], v[124:127]
  s_waitcnt lgkmcnt(5)
  v_xor_b32 v9, 0x10000, v9
  v_mfma_f32_16x16x32_bf16 v[96:99], a[160:163], v[40:43], v[96:99]
  ds_read_b128 v[32:35], v10 offset:57344
  v_mfma_f32_16x16x32_bf16 v[100:103], a[164:167], v[40:43], v[100:103]
  v_mfma_f32_16x16x32_bf16 v[112:115], a[168:171], v[40:43], v[112:115]
  v_mfma_f32_16x16x32_bf16 v[116:119], a[172:175], v[40:43], v[116:119]
  s_waitcnt lgkmcnt(5)
  v_xor_b32 v10, 0x10000, v10
  v_mfma_f32_16x16x32_bf16 v[104:107], a[160:163], v[44:47], v[104:107]
  ds_read_b128 v[36:39], v11 offset:57344
  v_mfma_f32_16x16x32_bf16 v[108:111], a[164:167], v[44:47], v[108:111]
  v_mfma_f32_16x16x32_bf16 v[120:123], a[168:171], v[44:47], v[120:123]
  buffer_store_dwordx4 v[136:139], v7, s[4:7], s21 offen offset:2048 sc1
  v_mfma_f32_16x16x32_bf16 v[124:127], a[172:175], v[44:47], v[124:127]
  s_waitcnt lgkmcnt(5)
  v_xor_b32 v11, 0x10000, v11
  v_mfma_f32_16x16x32_bf16 v[96:99], a[176:179], v[48:51], v[96:99]
  ds_read_b128 v[40:43], v12 offset:57344
  v_mfma_f32_16x16x32_bf16 v[100:103], a[180:183], v[48:51], v[100:103]
  v_mfma_f32_16x16x32_bf16 v[112:115], a[184:187], v[48:51], v[112:115]
  v_mfma_f32_16x16x32_bf16 v[116:119], a[188:191], v[48:51], v[116:119]
  s_waitcnt lgkmcnt(5)
  v_xor_b32 v12, 0x10000, v12
  v_mfma_f32_16x16x32_bf16 v[104:107], a[176:179], v[52:55], v[104:107]
  ds_read_b128 v[44:47], v13 offset:57344
  v_mfma_f32_16x16x32_bf16 v[108:111], a[180:183], v[52:55], v[108:111]
  v_mfma_f32_16x16x32_bf16 v[120:123], a[184:187], v[52:55], v[120:123]
  buffer_store_dwordx4 v[140:143], v7, s[4:7], s21 offen offset:2304 sc1
  v_mfma_f32_16x16x32_bf16 v[124:127], a[188:191], v[52:55], v[124:127]
  s_waitcnt lgkmcnt(5)
  v_xor_b32 v13, 0x10000, v13
  v_mfma_f32_16x16x32_bf16 v[96:99], a[192:195], v[24:27], v[96:99]
  s_mov_b32 s21, s27
  ds_read_b128 v[48:51], v14 offset:57344
  v_mfma_f32_16x16x32_bf16 v[100:103], a[196:199], v[24:27], v[100:103]
  v_mov_b32 v7, v56
  v_mfma_f32_16x16x32_bf16 v[112:115], a[200:203], v[24:27], v[112:115]
  v_mfma_f32_16x16x32_bf16 v[116:119], a[204:207], v[24:27], v[116:119]
  s_waitcnt lgkmcnt(5)
  v_xor_b32 v14, 0x10000, v14
  v_mfma_f32_16x16x32_bf16 v[104:107], a[192:195], v[28:31], v[104:107]
  s_add_u32 s27, s27, s22
  ds_read_b128 v[52:55], v15 offset:57344
  v_mfma_f32_16x16x32_bf16 v[108:111], a[196:199], v[28:31], v[108:111]
  v_mfma_f32_16x16x32_bf16 v[120:123], a[200:203], v[28:31], v[120:123]
  s_waitcnt vmcnt(13)
  s_barrier
  v_mfma_f32_16x16x32_bf16 v[124:127], a[204:207], v[28:31], v[124:127]
  s_waitcnt lgkmcnt(5)
  v_xor_b32 v15, 0x10000, v15
  v_mfma_f32_16x16x32_bf16 v[96:99], a[208:211], v[32:35], v[96:99]
  ds_read_b128 v[24:27], v8 offset:0
  v_mfma_f32_16x16x32_bf16 v[100:103], a[212:215], v[32:35], v[100:103]
  v_mfma_f32_16x16x32_bf16 v[112:115], a[216:219], v[32:35], v[112:115]
  v_mfma_f32_16x16x32_bf16 v[116:119], a[220:223], v[32:35], v[116:119]
  s_waitcnt lgkmcnt(5)
  v_mfma_f32_16x16x32_bf16 v[104:107], a[208:211], v[36:39], v[104:107]
  s_add_u32 s29, s29, 1
  ds_read_b128 v[28:31], v9 offset:0
  v_mfma_f32_16x16x32_bf16 v[108:111], a[212:215], v[36:39], v[108:111]
  v_mfma_f32_16x16x32_bf16 v[120:123], a[216:219], v[36:39], v[120:123]
  s_max_i32 s30, s29, 0
  v_mfma_f32_16x16x32_bf16 v[124:127], a[220:223], v[36:39], v[124:127]
  s_waitcnt lgkmcnt(5)
  v_mov_b32 v144, s30
  v_mfma_f32_16x16x32_bf16 v[96:99], a[224:227], v[40:43], v[96:99]
  ds_read_b128 v[32:35], v10 offset:0
  v_mfma_f32_16x16x32_bf16 v[100:103], a[228:231], v[40:43], v[100:103]
  v_mfma_f32_16x16x32_bf16 v[112:115], a[232:235], v[40:43], v[112:115]
  buffer_store_dword v144, v145, s[4:7], s31 offen sc1
  v_mfma_f32_16x16x32_bf16 v[116:119], a[236:239], v[40:43], v[116:119]
  s_waitcnt lgkmcnt(5)
  v_mfma_f32_16x16x32_bf16 v[104:107], a[224:227], v[44:47], v[104:107]
  ds_read_b128 v[36:39], v11 offset:0
  v_mfma_f32_16x16x32_bf16 v[108:111], a[228:231], v[44:47], v[108:111]
  v_mfma_f32_16x16x32_bf16 v[120:123], a[232:235], v[44:47], v[120:123]
  v_mfma_f32_16x16x32_bf16 v[124:127], a[236:239], v[44:47], v[124:127]
  s_waitcnt lgkmcnt(5)
  v_mfma_f32_16x16x32_bf16 v[96:99], a[240:243], v[48:51], v[96:99]
  s_sub_u32 s23, s23, 1
  ds_read_b128 v[40:43], v12 offset:0
  v_mfma_f32_16x16x32_bf16 v[100:103], a[244:247], v[48:51], v[100:103]
  v_mfma_f32_16x16x32_bf16 v[112:115], a[248:251], v[48:51], v[112:115]
  v_mfma_f32_16x16x32_bf16 v[116:119], a[252:255], v[48:51], v[116:119]
  s_waitcnt lgkmcnt(5)
  v_mfma_f32_16x16x32_bf16 v[104:107], a[240:243], v[52:55], v[104:107]
  s_cmp_eq_u32 s23, 0
  ds_read_b128 v[44:47], v13 offset:0
  v_mfma_f32_16x16x32_bf16 v[108:111], a[244:247], v[52:55], v[108:111]
  v_mfma_f32_16x16x32_bf16 v[120:123], a[248:251], v[52:55], v[120:123]
  v_mfma_f32_16x16x32_bf16 v[124:127], a[252:255], v[52:55], v[124:127]
  s_cbranch_scc1 G_done1_135
  s_branch G_top_133
G_done0_134:
  s_nop 7
  s_nop 3
  v_cvt_pk_bf16_f32 v128, v64, v65
  v_cvt_pk_bf16_f32 v129, v66, v67
  v_cvt_pk_bf16_f32 v130, v68, v69
  v_cvt_pk_bf16_f32 v131, v70, v71
  buffer_store_dwordx4 v[128:131], v7, s[4:7], s21 offen offset:0 sc1
  v_cvt_pk_bf16_f32 v132, v72, v73
  v_cvt_pk_bf16_f32 v133, v74, v75
  v_cvt_pk_bf16_f32 v134, v76, v77
  v_cvt_pk_bf16_f32 v135, v78, v79
  buffer_store_dwordx4 v[132:135], v7, s[4:7], s21 offen offset:256 sc1
  v_cvt_pk_bf16_f32 v136, v80, v81
  v_cvt_pk_bf16_f32 v137, v82, v83
  v_cvt_pk_bf16_f32 v138, v84, v85
  v_cvt_pk_bf16_f32 v139, v86, v87
  buffer_store_dwordx4 v[136:139], v7, s[4:7], s21 offen offset:2048 sc1
  v_cvt_pk_bf16_f32 v140, v88, v89
  v_cvt_pk_bf16_f32 v141, v90, v91
  v_cvt_pk_bf16_f32 v142, v92, v93
  v_cvt_pk_bf16_f32 v143, v94, v95
  buffer_store_dwordx4 v[140:143], v7, s[4:7], s21 offen offset:2304 sc1
  s_branch G_fin_136
G_done1_135:
  s_nop 7
  s_nop 3
  v_cvt_pk_bf16_f32 v128, v96, v97
  v_cvt_pk_bf16_f32 v129, v98, v99
  v_cvt_pk_bf16_f32 v130, v100, v101
  v_cvt_pk_bf16_f32 v131, v102, v103
  buffer_store_dwordx4 v[128:131], v7, s[4:7], s21 offen offset:0 sc1
  v_cvt_pk_bf16_f32 v132, v104, v105
  v_cvt_pk_bf16_f32 v133, v106, v107
  v_cvt_pk_bf16_f32 v134, v108, v109
  v_cvt_pk_bf16_f32 v135, v110, v111
  buffer_store_dwordx4 v[132:135], v7, s[4:7], s21 offen offset:256 sc1
  v_cvt_pk_bf16_f32 v136, v112, v113
  v_cvt_pk_bf16_f32 v137, v114, v115
  v_cvt_pk_bf16_f32 v138, v116, v117
  v_cvt_pk_bf16_f32 v139, v118, v119
  buffer_store_dwordx4 v[136:139], v7, s[4:7], s21 offen offset:2048 sc1
  v_cvt_pk_bf16_f32 v140, v120, v121
  v_cvt_pk_bf16_f32 v141, v122, v123
  v_cvt_pk_bf16_f32 v142, v124, v125
  v_cvt_pk_bf16_f32 v143, v126, v127
  buffer_store_dwordx4 v[140:143], v7, s[4:7], s21 offen offset:2304 sc1
G_fin_136:
  s_waitcnt vmcnt(0) lgkmcnt(0)
  s_barrier
  s_add_u32 s30, s29, 2
  v_mov_b32 v144, s30
  v_min_u32 v145, 1, v0
  v_lshlrev_b32 v145, 30, v145
  buffer_store_dword v144, v145, s[4:7], s31 offen sc1
  s_branch P_end_131
P_q_132:
  s_mov_b32 s27, s21
  v_mov_b32 v7, 0x40000000
  s_mov_b32 s29, -2
  v_min_u32 v145, 1, v0
  v_lshlrev_b32 v145, 30, v145
  ds_read_b128 v[24:27], v8 offset:0
  ds_read_b128 v[28:31], v9 offset:0
  ds_read_b128 v[32:35], v10 offset:0
  ds_read_b128 v[36:39], v11 offset:0
  ds_read_b128 v[40:43], v12 offset:0
  ds_read_b128 v[44:47], v13 offset:0
.p2align 6
G_top_137:
  s_waitcnt lgkmcnt(5)
  v_mfma_f32_16x16x32_bf16 v[64:67], a[0:3], v[24:27], 0
  s_add_u32 m0, s25, 0
  ds_read_b128 v[48:51], v14 offset:0
  v_mfma_f32_16x16x32_bf16 v[68:71], a[4:7], v[24:27], 0
  v_mfma_f32_16x16x32_bf16 v[80:83], a[8:11], v[24:27], 0
  buffer_load_dwordx4 v16, s[12:15], s19 offen lds
  v_mfma_f32_16x16x32_bf16 v[84:87], a[12:15], v[24:27], 0
  s_waitcnt lgkmcnt(5)
  v_mfma_f32_16x16x32_bf16 v[72:75], a[0:3], v[28:31], 0
  ds_read_b128 v[52:55], v15 offset:0
  v_mfma_f32_16x16x32_bf16 v[76:79], a[4:7], v[28:31], 0
  v_mul_f32 v96, s24, v96
  v_mul_f32 v97, s24, v97
  v_mfma_f32_16x16x32_bf16 v[88:91], a[8:11], v[28:31], 0
  v_mfma_f32_16x16x32_bf16 v[92:95], a[12:15], v[28:31], 0
  s_waitcnt lgkmcnt(5)
  v_cvt_pk_bf16_f32 v128, v96, v97
  v_mul_f32 v98, s24, v98
  v_mfma_f32_16x16x32_bf16 v[64:67], a[16:19], v[32:35], v[64:67]
  s_add_u32 m0, s25, 1024
  ds_read_b128 v[24:27], v8 offset:8192
  v_mfma_f32_16x16x32_bf16 v[68:71], a[20:23], v[32:35], v[68:71]
  v_mul_f32 v99, s24, v99
  v_cvt_pk_bf16_f32 v129, v98, v99
  v_mfma_f32_16x16x32_bf16 v[80:83], a[24:27], v[32:35], v[80:83]
  buffer_load_dwordx4 v17, s[12:15], s19 offen lds
  v_mfma_f32_16x16x32_bf16 v[84:87], a[28:31], v[32:35], v[84:87]
  s_waitcnt lgkmcnt(5)
  v_mul_f32 v100, s24, v100
  v_mul_f32 v101, s24, v101
  v_mfma_f32_16x16x32_bf16 v[72:75], a[16:19], v[36:39], v[72:75]
  ds_read_b128 v[28:31], v9 offset:8192
  v_mfma_f32_16x16x32_bf16 v[76:79], a[20:23], v[36:39], v[76:79]
  v_cvt_pk_bf16_f32 v130, v100, v101
  v_mul_f32 v102, s24, v102
  v_mfma_f32_16x16x32_bf16 v[88:91], a[24:27], v[36:39], v[88:91]
  v_mfma_f32_16x16x32_bf16 v[92:95], a[28:31], v[36:39], v[92:95]
  s_waitcnt lgkmcnt(5)
  v_mul_f32 v103, s24, v103
  v_cvt_pk_bf16_f32 v131, v102, v103
  v_mfma_f32_16x16x32_bf16 v[64:67], a[32:35], v[40:43], v[64:67]
  s_add_u32 m0, s25, 2048
  ds_read_b128 v[32:35], v10 offset:8192
  v_mfma_f32_16x16x32_bf16 v[68:71], a[36:39], v[40:43], v[68:71]
  v_mul_f32 v104, s24, v104
  v_mul_f32 v105, s24, v105
  v_mfma_f32_16x16x32_bf16 v[80:83], a[40:43], v[40:43], v[80:83]
  buffer_load_dwordx4 v18, s[12:15], s19 offen lds
  v_mfma_f32_16x16x32_bf16 v[84:87], a[44:47], v[40:43], v[84:87]
  s_waitcnt lgkmcnt(5)
  v_cvt_pk_bf16_f32 v132, v104, v105
  v_mul_f32 v106, s24, v106
  v_mfma_f32_16x16x32_bf16 v[72:75], a[32:35], v[44:47], v[72:75]
  ds_read_b128 v[36:39], v11 offset:8192
  v_mfma_f32_16x16x32_bf16 v[76:79], a[36:39], v[44:47], v[76:79]
  v_mul_f32 v107, s24, v107
  v_cvt_pk_bf16_f32 v133, v106, v107
  v_mfma_f32_16x16x32_bf16 v[88:91], a[40:43], v[44:47], v[88:91]
  v_mfma_f32_16x16x32_bf16 v[92:95], a[44:47], v[44:47], v[92:95]
  s_waitcnt lgkmcnt(5)
  v_mul_f32 v108, s24, v108
  v_mul_f32 v109, s24, v109
  v_mfma_f32_16x16x32_bf16 v[64:67], a[48:51], v[48:51], v[64:67]
  s_add_u32 m0, s25, 3072
  ds_read_b128 v[40:43], v12 offset:8192
  v_mfma_f32_16x16x32_bf16 v[68:71], a[52:55], v[48:51], v[68:71]
  v_cvt_pk_bf16_f32 v134, v108, v109
  v_mul_f32 v110, s24, v110
  v_mfma_f32_16x16x32_bf16 v[80:83], a[56:59], v[48:51], v[80:83]
  buffer_load_dwordx4 v19, s[12:15], s19 offen lds
  v_mfma_f32_16x16x32_bf16 v[84:87], a[60:63], v[48:51], v[84:87]
  s_waitcnt lgkmcnt(5)
  v_mul_f32 v111, s24, v111
  v_cvt_pk_bf16_f32 v135, v110, v111
  v_mfma_f32_16x16x32_bf16 v[72:75], a[48:51], v[52:55], v[72:75]
  ds_read_b128 v[44:47], v13 offset:8192
  v_mfma_f32_16x16x32_bf16 v[76:79], a[52:55], v[52:55], v[76:79]
  v_mul_f32 v112, s24, v112
  v_mul_f32 v113, s24, v113
  v_mfma_f32_16x16x32_bf16 v[88:91], a[56:59], v[52:55], v[88:91]
  v_mfma_f32_16x16x32_bf16 v[92:95], a[60:63], v[52:55], v[92:95]
  s_waitcnt lgkmcnt(5)
  v_cvt_pk_bf16_f32 v136, v112, v113
  v_mul_f32 v114, s24, v114
  v_mfma_f32_16x16x32_bf16 v[64:67], a[64:67], v[24:27], v[64:67]
  s_add_u32 m0, s25, 4096
  ds_read_b128 v[48:51], v14 offset:8192
  v_mfma_f32_16x16x32_bf16 v[68:71], a[68:71], v[24:27], v[68:71]
  v_mul_f32 v115, s24, v115
  v_cvt_pk_bf16_f32 v137, v114, v115
  v_mfma_f32_16x16x32_bf16 v[80:83], a[72:75], v[24:27], v[80:83]
  buffer_load_dwordx4 v20, s[12:15], s19 offen lds
  v_mfma_f32_16x16x32_bf16 v[84:87], a[76:79], v[24:27], v[84:87]
  s_waitcnt lgkmcnt(5)
  v_mul_f32 v116, s24, v116
  v_mul_f32 v117, s24, v117
  v_mfma_f32_16x16x32_bf16 v[72:75], a[64:67], v[28:31], v[72:75]
  ds_read_b128 v[52:55], v15 offset:8192
  v_mfma_f32_16x16x32_bf16 v[76:79], a[68:71], v[28:31], v[76:79]
  v_cvt_pk_bf16_f32 v138, v116, v117
  v_mul_f32 v118, s24, v118
  v_mfma_f32_16x16x32_bf16 v[88:91], a[72:75], v[28:31], v[88:91]
  v_mfma_f32_16x16x32_bf16 v[92:95], a[76:79], v[28:31], v[92:95]
  s_waitcnt lgkmcnt(5)
  v_mul_f32 v119, s24, v119
  v_cvt_pk_bf16_f32 v139, v118, v119
  v_mfma_f32_16x16x32_bf16 v[64:67], a[80:83], v[32:35], v[64:67]
  s_add_u32 m0, s25, 5120
  ds_read_b128 v[24:27], v8 offset:16384
  v_mfma_f32_16x16x32_bf16 v[68:71], a[84:87], v[32:35], v[68:71]
  v_mul_f32 v120, s24, v120
  v_mul_f32 v121, s24, v121
  v_mfma_f32_16x16x32_bf16 v[80:83], a[88:91], v[32:35], v[80:83]
  buffer_load_dwordx4 v21, s[12:15], s19 offen lds
  v_mfma_f32_16x16x32_bf16 v[84:87], a[92:95], v[32:35], v[84:87]
  s_waitcnt lgkmcnt(5)
  v_cvt_pk_bf16_f32 v140, v120, v121
  v_mul_f32 v122, s24, v122
  v_mfma_f32_16x16x32_bf16 v[72:75], a[80:83], v[36:39], v[72:75]
  ds_read_b128 v[28:31], v9 offset:16384
  v_mfma_f32_16x16x32_bf16 v[76:79], a[84:87], v[36:39], v[76:79]
  v_mul_f32 v123, s24, v123
  v_cvt_pk_bf16_f32 v141, v122, v123
  v_mfma_f32_16x16x32_bf16 v[88:91], a[88:91], v[36:39], v[88:91]
  v_mfma_f32_16x16x32_bf16 v[92:95], a[92:95], v[36:39], v[92:95]
  s_waitcnt lgkmcnt(5)
  v_mul_f32 v124, s24, v124
  v_mul_f32 v125, s24, v125
  v_mfma_f32_16x16x32_bf16 v[64:67], a[96:99], v[40:43], v[64:67]
  s_add_u32 m0, s25, 6144
  ds_read_b128 v[32:35], v10 offset:16384
  v_mfma_f32_16x16x32_bf16 v[68:71], a[100:103], v[40:43], v[68:71]
  v_cvt_pk_bf16_f32 v142, v124, v125
  v_mul_f32 v126, s24, v126
  v_mfma_f32_16x16x32_bf16 v[80:83], a[104:107], v[40:43], v[80:83]
  buffer_load_dwordx4 v22, s[12:15], s19 offen lds
  v_mfma_f32_16x16x32_bf16 v[84:87], a[108:111], v[40:43], v[84:87]
  s_waitcnt lgkmcnt(5)
  v_mul_f32 v127, s24, v127
  v_cvt_pk_bf16_f32 v143, v126, v127
  v_mfma_f32_16x16x32_bf16 v[72:75], a[96:99], v[44:47], v[72:75]
  ds_read_b128 v[36:39], v11 offset:16384
  v_mfma_f32_16x16x32_bf16 v[76:79], a[100:103], v[44:47], v[76:79]
  v_mfma_f32_16x16x32_bf16 v[88:91], a[104:107], v[44:47], v[88:91]
  v_mfma_f32_16x16x32_bf16 v[92:95], a[108:111], v[44:47], v[92:95]
  s_waitcnt lgkmcnt(5)
  v_mfma_f32_16x16x32_bf16 v[64:67], a[112:115], v[48:51], v[64:67]
  s_add_u32 m0, s25, 7168
  ds_read_b128 v[40:43], v12 offset:16384
  v_mfma_f32_16x16x32_bf16 v[68:71], a[116:119], v[48:51], v[68:71]
  v_mfma_f32_16x16x32_bf16 v[80:83], a[120:123], v[48:51], v[80:83]
  buffer_load_dwordx4 v23, s[12:15], s19 offen lds
  v_mfma_f32_16x16x32_bf16 v[84:87], a[124:127], v[48:51], v[84:87]
  s_waitcnt lgkmcnt(5)
  v_mfma_f32_16x16x32_bf16 v[72:75], a[112:115], v[52:55], v[72:75]
  s_cmp_gt_u32 s23, 3
  ds_read_b128 v[44:47], v13 offset:16384
  v_mfma_f32_16x16x32_bf16 v[76:79], a[116:119], v[52:55], v[76:79]
  v_mfma_f32_16x16x32_bf16 v[88:91], a[120:123], v[52:55], v[88:91]
  s_cselect_b32 s26, s20, 0
  v_mfma_f32_16x16x32_bf16 v[92:95], a[124:127], v[52:55], v[92:95]
  s_waitcnt lgkmcnt(5)
  v_mfma_f32_16x16x32_bf16 v[64:67], a[128:131], v[24:27], v[64:67]
  s_add_u32 s19, s19, s26
  ds_read_b128 v[48:51], v14 offset:16384
  v_mfma_f32_16x16x32_bf16 v[68:71], a[132:135], v[24:27], v[68:71]
  v_mfma_f32_16x16x32_bf16 v[80:83], a[136:139], v[24:27], v[80:83]
  s_add_u32 s25, s25, 32768
  v_mfma_f32_16x16x32_bf16 v[84:87], a[140:143], v[24:27], v[84:87]
  s_waitcnt lgkmcnt(5)
  v_mfma_f32_16x16x32_bf16 v[72:75], a[128:131], v[28:31], v[72:75]
  s_and_b32 s25, s25, 0x1ffff
  ds_read_b128 v[52:55], v15 offset:16384
  v_mfma_f32_16x16x32_bf16 v[76:79], a[132:135], v[28:31], v[76:79]
  v_mfma_f32_16x16x32_bf16 v[88:91], a[136:139], v[28:31], v[88:91]
  buffer_store_dwordx4 v[128:131], v7, s[4:7], s21 offen offset:0 sc1
  v_mfma_f32_16x16x32_bf16 v[92:95], a[140:143], v[28:31], v[92:95]
  s_waitcnt lgkmcnt(5)
  v_mfma_f32_16x16x32_bf16 v[64:67], a[144:147], v[32:35], v[64:67]
  ds_read_b128 v[24:27], v8 offset:24576
  v_mfma_f32_16x16x32_bf16 v[68:71], a[148:151], v[32:35], v[68:71]
  v_mfma_f32_16x16x32_bf16 v[80:83], a[152:155], v[32:35], v[80:83]
  v_mfma_f32_16x16x32_bf16 v[84:87], a[156:159], v[32:35], v[84:87]
  s_waitcnt lgkmcnt(5)
  v_mfma_f32_16x16x32_bf16 v[72:75], a[144:147], v[36:39], v[72:75]
  ds_read_b128 v[28:31], v9 offset:24576
  v_mfma_f32_16x16x32_bf16 v[76:79], a[148:151], v[36:39], v[76:79]
  v_mfma_f32_16x16x32_bf16 v[88:91], a[152:155], v[36:39], v[88:91]
  buffer_store_dwordx4 v[132:135], v7, s[4:7], s21 offen offset:256 sc1
  v_mfma_f32_16x16x32_bf16 v[92:95], a[156:159], v[36:39], v[92:95]
  s_waitcnt lgkmcnt(5)
  v_mfma_f32_16x16x32_bf16 v[64:67], a[160:163], v[40:43], v[64:67]
  ds_read_b128 v[32:35], v10 offset:24576
  v_mfma_f32_16x16x32_bf16 v[68:71], a[164:167], v[40:43], v[68:71]
  v_mfma_f32_16x16x32_bf16 v[80:83], a[168:171], v[40:43], v[80:83]
  v_mfma_f32_16x16x32_bf16 v[84:87], a[172:175], v[40:43], v[84:87]
  s_waitcnt lgkmcnt(5)
  v_mfma_f32_16x16x32_bf16 v[72:75], a[160:163], v[44:47], v[72:75]
  ds_read_b128 v[36:39], v11 offset:24576
  v_mfma_f32_16x16x32_bf16 v[76:79], a[164:167], v[44:47], v[76:79]
  v_mfma_f32_16x16x32_bf16 v[88:91], a[168:171], v[44:47], v[88:91]
  buffer_store_dwordx4 v[136:139], v7, s[4:7], s21 offen offset:2048 sc1
  v_mfma_f32_16x16x32_bf16 v[92:95], a[172:175], v[44:47], v[92:95]
  s_waitcnt lgkmcnt(5)
  v_mfma_f32_16x16x32_bf16 v[64:67], a[176:179], v[48:51], v[64:67]
  ds_read_b128 v[40:43], v12 offset:24576
  v_mfma_f32_16x16x32_bf16 v[68:71], a[180:183], v[48:51], v[68:71]
  v_mfma_f32_16x16x32_bf16 v[80:83], a[184:187], v[48:51], v[80:83]
  v_mfma_f32_16x16x32_bf16 v[84:87], a[188:191], v[48:51], v[84:87]
  s_waitcnt lgkmcnt(5)
  v_mfma_f32_16x16x32_bf16 v[72:75], a[176:179], v[52:55], v[72:75]
  ds_read_b128 v[44:47], v13 offset:24576
  v_mfma_f32_16x16x32_bf16 v[76:79], a[180:183], v[52:55], v[76:79]
  v_mfma_f32_16x16x32_bf16 v[88:91], a[184:187], v[52:55], v[88:91]
  buffer_store_dwordx4 v[140:143], v7, s[4:7], s21 offen offset:2304 sc1
  v_mfma_f32_16x16x32_bf16 v[92:95], a[188:191], v[52:55], v[92:95]
  s_waitcnt lgkmcnt(5)
  v_mfma_f32_16x16x32_bf16 v[64:67], a[192:195], v[24:27], v[64:67]
  s_mov_b32 s21, s27
  ds_read_b128 v[48:51], v14 offset:24576
  v_mfma_f32_16x16x32_bf16 v[68:71], a[196:199], v[24:27], v[68:71]
  v_mov_b32 v7, v56
  v_mfma_f32_16x16x32_bf16 v[80:83], a[200:203], v[24:27], v[80:83]
  v_mfma_f32_16x16x32_bf16 v[84:87], a[204:207], v[24:27], v[84:87]
  s_waitcnt lgkmcnt(5)
  v_mfma_f32_16x16x32_bf16 v[72:75], a[192:195], v[28:31], v[72:75]
  s_add_u32 s27, s27, s22
  ds_read_b128 v[52:55], v15 offset:24576
  v_mfma_f32_16x16x32_bf16 v[76:79], a[196:199], v[28:31], v[76:79]
  v_mfma_f32_16x16x32_bf16 v[88:91], a[200:203], v[28:31], v[88:91]
  s_waitcnt vmcnt(13)
  s_barrier
  v_mfma_f32_16x16x32_bf16 v[92:95], a[204:207], v[28:31], v[92:95]
  s_waitcnt lgkmcnt(5)
  v_mfma_f32_16x16x32_bf16 v[64:67], a[208:211], v[32:35], v[64:67]
  ds_read_b128 v[24:27], v8 offset:32768
  v_mfma_f32_16x16x32_bf16 v[68:71], a[212:215], v[32:35], v[68:71]
  v_mfma_f32_16x16x32_bf16 v[80:83], a[216:219], v[32:35], v[80:83]
  v_mfma_f32_16x16x32_bf16 v[84:87], a[220:223], v[32:35], v[84:87]
  s_waitcnt lgkmcnt(5)
  v_mfma_f32_16x16x32_bf16 v[72:75], a[208:211], v[36:39], v[72:75]
  s_add_u32 s29, s29, 1
  ds_read_b128 v[28:31], v9 offset:32768
  v_mfma_f32_16x16x32_bf16 v[76:79], a[212:215], v[36:39], v[76:79]
  v_mfma_f32_16x16x32_bf16 v[88:91], a[216:219], v[36:39], v[88:91]
  s_max_i32 s30, s29, 0
  v_mfma_f32_16x16x32_bf16 v[92:95], a[220:223], v[36:39], v[92:95]
  s_waitcnt lgkmcnt(5)
  v_mov_b32 v144, s30
  v_mfma_f32_16x16x32_bf16 v[64:67], a[224:227], v[40:43], v[64:67]
  ds_read_b128 v[32:35], v10 offset:32768
  v_mfma_f32_16x16x32_bf16 v[68:71], a[228:231], v[40:43], v[68:71]
  v_mfma_f32_16x16x32_bf16 v[80:83], a[232:235], v[40:43], v[80:83]
  buffer_store_dword v144, v145, s[4:7], s31 offen sc1
  v_mfma_f32_16x16x32_bf16 v[84:87], a[236:239], v[40:43], v[84:87]
  s_waitcnt lgkmcnt(5)
  v_mfma_f32_16x16x32_bf16 v[72:75], a[224:227], v[44:47], v[72:75]
  ds_read_b128 v[36:39], v11 offset:32768
  v_mfma_f32_16x16x32_bf16 v[76:79], a[228:231], v[44:47], v[76:79]
  v_mfma_f32_16x16x32_bf16 v[88:91], a[232:235], v[44:47], v[88:91]
  v_mfma_f32_16x16x32_bf16 v[92:95], a[236:239], v[44:47], v[92:95]
  s_waitcnt lgkmcnt(5)
  v_mfma_f32_16x16x32_bf16 v[64:67], a[240:243], v[48:51], v[64:67]
  s_sub_u32 s23, s23, 1
  ds_read_b128 v[40:43], v12 offset:32768
  v_mfma_f32_16x16x32_bf16 v[68:71], a[244:247], v[48:51], v[68:71]
  v_mfma_f32_16x16x32_bf16 v[80:83], a[248:251], v[48:51], v[80:83]
  v_mfma_f32_16x16x32_bf16 v[84:87], a[252:255], v[48:51], v[84:87]
  s_waitcnt lgkmcnt(5)
  v_mfma_f32_16x16x32_bf16 v[72:75], a[240:243], v[52:55], v[72:75]
  s_cmp_eq_u32 s23, 0
  ds_read_b128 v[44:47], v13 offset:32768
  v_mfma_f32_16x16x32_bf16 v[76:79], a[244:247], v[52:55], v[76:79]
  v_mfma_f32_16x16x32_bf16 v[88:91], a[248:251], v[52:55], v[88:91]
  v_mfma_f32_16x16x32_bf16 v[92:95], a[252:255], v[52:55], v[92:95]
  s_cbranch_scc1 G_done0_138
  s_waitcnt lgkmcnt(5)
  v_mfma_f32_16x16x32_bf16 v[96:99], a[0:3], v[24:27], 0
  s_add_u32 m0, s25, 0
  ds_read_b128 v[48:51], v14 offset:32768
  v_mfma_f32_16x16x32_bf16 v[100:103], a[4:7], v[24:27], 0
  v_mfma_f32_16x16x32_bf16 v[112:115], a[8:11], v[24:27], 0
  buffer_load_dwordx4 v16, s[12:15], s19 offen lds
  v_mfma_f32_16x16x32_bf16 v[116:119], a[12:15], v[24:27], 0
  s_waitcnt lgkmcnt(5)
  v_mfma_f32_16x16x32_bf16 v[104:107], a[0:3], v[28:31], 0
  ds_read_b128 v[52:55], v15 offset:32768
  v_mfma_f32_16x16x32_bf16 v[108:111], a[4:7], v[28:31], 0
  v_mul_f32 v64, s24, v64
  v_mul_f32 v65, s24, v65
  v_mfma_f32_16x16x32_bf16 v[120:123], a[8:11], v[28:31], 0
  v_mfma_f32_16x16x32_bf16 v[124:127], a[12:15], v[28:31], 0
  s_waitcnt lgkmcnt(5)
  v_cvt_pk_bf16_f32 v128, v64, v65
  v_mul_f32 v66, s24, v66
  v_mfma_f32_16x16x32_bf16 v[96:99], a[16:19], v[32:35], v[96:99]
  s_add_u32 m0, s25, 1024
  ds_read_b128 v[24:27], v8 offset:40960
  v_mfma_f32_16x16x32_bf16 v[100:103], a[20:23], v[32:35], v[100:103]
  v_mul_f32 v67, s24, v67
  v_cvt_pk_bf16_f32 v129, v66, v67
  v_mfma_f32_16x16x32_bf16 v[112:115], a[24:27], v[32:35], v[112:115]
  buffer_load_dwordx4 v17, s[12:15], s19 offen lds
  v_mfma_f32_16x16x32_bf16 v[116:119], a[28:31], v[32:35], v[116:119]
  s_waitcnt lgkmcnt(5)
  v_mul_f32 v68, s24, v68
  v_mul_f32 v69, s24, v69
  v_mfma_f32_16x16x32_bf16 v[104:107], a[16:19], v[36:39], v[104:107]
  ds_read_b128 v[28:31], v9 offset:40960
  v_mfma_f32_16x16x32_bf16 v[108:111], a[20:23], v[36:39], v[108:111]
  v_cvt_pk_bf16_f32 v130, v68, v69
  v_mul_f32 v70, s24, v70
  v_mfma_f32_16x16x32_bf16 v[120:123], a[24:27], v[36:39], v[120:123]
  v_mfma_f32_16x16x32_bf16 v[124:127], a[28:31], v[36:39], v[124:127]
  s_waitcnt lgkmcnt(5)
  v_mul_f32 v71, s24, v71
  v_cvt_pk_bf16_f32 v131, v70, v71
  v_mfma_f32_16x16x32_bf16 v[96:99], a[32:35], v[40:43], v[96:99]
  s_add_u32 m0, s25, 2048
  ds_read_b128 v[32:35], v10 offset:40960
  v_mfma_f32_16x16x32_bf16 v[100:103], a[36:39], v[40:43], v[100:103]
  v_mul_f32 v72, s24, v72
  v_mul_f32 v73, s24, v73
  v_mfma_f32_16x16x32_bf16 v[112:115], a[40:43], v[40:43], v[112:115]
  buffer_load_dwordx4 v18, s[12:15], s19 offen lds
  v_mfma_f32_16x16x32_bf16 v[116:119], a[44:47], v[40:43], v[116:119]
  s_waitcnt lgkmcnt(5)
  v_cvt_pk_bf16_f32 v132, v72, v73
  v_mul_f32 v74, s24, v74
  v_mfma_f32_16x16x32_bf16 v[104:107], a[32:35], v[44:47], v[104:107]
  ds_read_b128 v[36:39], v11 offset:40960
  v_mfma_f32_16x16x32_bf16 v[108:111], a[36:39], v[44:47], v[108:111]
  v_mul_f32 v75, s24, v75
  v_cvt_pk_bf16_f32 v133, v74, v75
  v_mfma_f32_16x16x32_bf16 v[120:123], a[40:43], v[44:47], v[120:123]
  v_mfma_f32_16x16x32_bf16 v[124:127], a[44:47], v[44:47], v[124:127]
  s_waitcnt lgkmcnt(5)
  v_mul_f32 v76, s24, v76
  v_mul_f32 v77, s24, v77
  v_mfma_f32_16x16x32_bf16 v[96:99], a[48:51], v[48:51], v[96:99]
  s_add_u32 m0, s25, 3072
  ds_read_b128 v[40:43], v12 offset:40960
  v_mfma_f32_16x16x32_bf16 v[100:103], a[52:55], v[48:51], v[100:103]
  v_cvt_pk_bf16_f32 v134, v76, v77
  v_mul_f32 v78, s24, v78
  v_mfma_f32_16x16x32_bf16 v[112:115], a[56:59], v[48:51], v[112:115]
  buffer_load_dwordx4 v19, s[12:15], s19 offen lds
  v_mfma_f32_16x16x32_bf16 v[116:119], a[60:63], v[48:51], v[116:119]
  s_waitcnt lgkmcnt(5)
  v_mul_f32 v79, s24, v79
  v_cvt_pk_bf16_f32 v135, v78, v79
  v_mfma_f32_16x16x32_bf16 v[104:107], a[48:51], v[52:55], v[104:107]
  ds_read_b128 v[44:47], v13 offset:40960
  v_mfma_f32_16x16x32_bf16 v[108:111], a[52:55], v[52:55], v[108:111]
  v_mul_f32 v80, s24, v80
  v_mul_f32 v81, s24, v81
  v_mfma_f32_16x16x32_bf16 v[120:123], a[56:59], v[52:55], v[120:123]
  v_mfma_f32_16x16x32_bf16 v[124:127], a[60:63], v[52:55], v[124:127]
  s_waitcnt lgkmcnt(5)
  v_cvt_pk_bf16_f32 v136, v80, v81
  v_mul_f32 v82, s24, v82
  v_mfma_f32_16x16x32_bf16 v[96:99], a[64:67], v[24:27], v[96:99]
  s_add_u32 m0, s25, 4096
  ds_read_b128 v[48:51], v14 offset:40960
  v_mfma_f32_16x16x32_bf16 v[100:103], a[68:71], v[24:27], v[100:103]
  v_mul_f32 v83, s24, v83
  v_cvt_pk_bf16_f32 v137, v82, v83
  v_mfma_f32_16x16x32_bf16 v[112:115], a[72:75], v[24:27], v[112:115]
  buffer_load_dwordx4 v20, s[12:15], s19 offen lds
  v_mfma_f32_16x16x32_bf16 v[116:119], a[76:79], v[24:27], v[116:119]
  s_waitcnt lgkmcnt(5)
  v_mul_f32 v84, s24, v84
  v_mul_f32 v85, s24, v85
  v_mfma_f32_16x16x32_bf16 v[104:107], a[64:67], v[28:31], v[104:107]
  ds_read_b128 v[52:55], v15 offset:40960
  v_mfma_f32_16x16x32_bf16 v[108:111], a[68:71], v[28:31], v[108:111]
  v_cvt_pk_bf16_f32 v138, v84, v85
  v_mul_f32 v86, s24, v86
  v_mfma_f32_16x16x32_bf16 v[120:123], a[72:75], v[28:31], v[120:123]
  v_mfma_f32_16x16x32_bf16 v[124:127], a[76:79], v[28:31], v[124:127]
  s_waitcnt lgkmcnt(5)
  v_mul_f32 v87, s24, v87
  v_cvt_pk_bf16_f32 v139, v86, v87
  v_mfma_f32_16x16x32_bf16 v[96:99], a[80:83], v[32:35], v[96:99]
  s_add_u32 m0, s25, 5120
  ds_read_b128 v[24:27], v8 offset:49152
  v_mfma_f32_16x16x32_bf16 v[100:103], a[84:87], v[32:35], v[100:103]
  v_mul_f32 v88, s24, v88
  v_mul_f32 v89, s24, v89
  v_mfma_f32_16x16x32_bf16 v[112:115], a[88:91], v[32:35], v[112:115]
  buffer_load_dwordx4 v21, s[12:15], s19 offen lds
  v_mfma_f32_16x16x32_bf16 v[116:119], a[92:95], v[32:35], v[116:119]
  s_waitcnt lgkmcnt(5)
  v_cvt_pk_bf16_f32 v140, v88, v89
  v_mul_f32 v90, s24, v90
  v_mfma_f32_16x16x32_bf16 v[104:107], a[80:83], v[36:39], v[104:107]
  ds_read_b128 v[28:31], v9 offset:49152
  v_mfma_f32_16x16x32_bf16 v[108:111], a[84:87], v[36:39], v[108:111]
  v_mul_f32 v91, s24, v91
  v_cvt_pk_bf16_f32 v141, v90, v91
  v_mfma_f32_16x16x32_bf16 v[120:123], a[88:91], v[36:39], v[120:123]
  v_mfma_f32_16x16x32_bf16 v[124:127], a[92:95], v[36:39], v[124:127]
  s_waitcnt lgkmcnt(5)
  v_mul_f32 v92, s24, v92
  v_mul_f32 v93, s24, v93
  v_mfma_f32_16x16x32_bf16 v[96:99], a[96:99], v[40:43], v[96:99]
  s_add_u32 m0, s25, 6144
  ds_read_b128 v[32:35], v10 offset:49152
  v_mfma_f32_16x16x32_bf16 v[100:103], a[100:103], v[40:43], v[100:103]
  v_cvt_pk_bf16_f32 v142, v92, v93
  v_mul_f32 v94, s24, v94
  v_mfma_f32_16x16x32_bf16 v[112:115], a[104:107], v[40:43], v[112:115]
  buffer_load_dwordx4 v22, s[12:15], s19 offen lds
  v_mfma_f32_16x16x32_bf16 v[116:119], a[108:111], v[40:43], v[116:119]
  s_waitcnt lgkmcnt(5)
  v_mul_f32 v95, s24, v95
  v_cvt_pk_bf16_f32 v143, v94, v95
  v_mfma_f32_16x16x32_bf16 v[104:107], a[96:99], v[44:47], v[104:107]
  ds_read_b128 v[36:39], v11 offset:49152
  v_mfma_f32_16x16x32_bf16 v[108:111], a[100:103], v[44:47], v[108:111]
  v_mfma_f32_16x16x32_bf16 v[120:123], a[104:107], v[44:47], v[120:123]
  v_mfma_f32_16x16x32_bf16 v[124:127], a[108:111], v[44:47], v[124:127]
  s_waitcnt lgkmcnt(5)
  v_mfma_f32_16x16x32_bf16 v[96:99], a[112:115], v[48:51], v[96:99]
  s_add_u32 m0, s25, 7168
  ds_read_b128 v[40:43], v12 offset:49152
  v_mfma_f32_16x16x32_bf16 v[100:103], a[116:119], v[48:51], v[100:103]
  v_mfma_f32_16x16x32_bf16 v[112:115], a[120:123], v[48:51], v[112:115]
  buffer_load_dwordx4 v23, s[12:15], s19 offen lds
  v_mfma_f32_16x16x32_bf16 v[116:119], a[124:127], v[48:51], v[116:119]
  s_waitcnt lgkmcnt(5)
  v_mfma_f32_16x16x32_bf16 v[104:107], a[112:115], v[52:55], v[104:107]
  s_cmp_gt_u32 s23, 3
  ds_read_b128 v[44:47], v13 offset:49152
  v_mfma_f32_16x16x32_bf16 v[108:111], a[116:119], v[52:55], v[108:111]
  v_mfma_f32_16x16x32_bf16 v[120:123], a[120:123], v[52:55], v[120:123]
  s_cselect_b32 s26, s20, 0
  v_mfma_f32_16x16x32_bf16 v[124:127], a[124:127], v[52:55], v[124:127]
  s_waitcnt lgkmcnt(5)
  v_mfma_f32_16x16x32_bf16 v[96:99], a[128:131], v[24:27], v[96:99]
  s_add_u32 s19, s19, s26
  ds_read_b128 v[48:51], v14 offset:49152
  v_mfma_f32_16x16x32_bf16 v[100:103], a[132:135], v[24:27], v[100:103]
  v_mfma_f32_16x16x32_bf16 v[112:115], a[136:139], v[24:27], v[112:115]
  s_add_u32 s25, s25, 32768
  v_mfma_f32_16x16x32_bf16 v[116:119], a[140:143], v[24:27], v[116:119]
  s_waitcnt lgkmcnt(5)
  v_mfma_f32_16x16x32_bf16 v[104:107], a[128:131], v[28:31], v[104:107]
  s_and_b32 s25, s25, 0x1ffff
  ds_read_b128 v[52:55], v15 offset:49152
  v_mfma_f32_16x16x32_bf16 v[108:111], a[132:135], v[28:31], v[108:111]
  v_mfma_f32_16x16x32_bf16 v[120:123], a[136:139], v[28:31], v[120:123]
  buffer_store_dwordx4 v[128:131], v7, s[4:7], s21 offen offset:0 sc1
  v_mfma_f32_16x16x32_bf16 v[124:127], a[140:143], v[28:31], v[124:127]
  s_waitcnt lgkmcnt(5)
  v_mfma_f32_16x16x32_bf16 v[96:99], a[144:147], v[32:35], v[96:99]
  ds_read_b128 v[24:27], v8 offset:57344
  v_mfma_f32_16x16x32_bf16 v[100:103], a[148:151], v[32:35], v[100:103]
  v_mfma_f32_16x16x32_bf16 v[112:115], a[152:155], v[32:35], v[112:115]
  v_mfma_f32_16x16x32_bf16 v[116:119], a[156:159], v[32:35], v[116:119]
  s_waitcnt lgkmcnt(5)
  v_xor_b32 v8, 0x10000, v8
  v_mfma_f32_16x16x32_bf16 v[104:107], a[144:147], v[36:39], v[104:107]
  ds_read_b128 v[28:31], v9 offset:57344
  v_mfma_f32_16x16x32_bf16 v[108:111], a[148:151], v[36:39], v[108:111]
  v_mfma_f32_16x16x32_bf16 v[120:123], a[152:155], v[36:39], v[120:123]
  buffer_store_dwordx4 v[132:135], v7, s[4:7], s21 offen offset:256 sc1
  v_mfma_f32_16x16x32_bf16 v[124:127], a[156:159], v[36:39], v[124:127]
  s_waitcnt lgkmcnt(5)
  v_xor_b32 v9, 0x10000, v9
  v_mfma_f32_16x16x32_bf16 v[96:99], a[160:163], v[40:43], v[96:99]
  ds_read_b128 v[32:35], v10 offset:57344
  v_mfma_f32_16x16x32_bf16 v[100:103], a[164:167], v[40:43], v[100:103]
  v_mfma_f32_16x16x32_bf16 v[112:115], a[168:171], v[40:43], v[112:115]
  v_mfma_f32_16x16x32_bf16 v[116:119], a[172:175], v[40:43], v[116:119]
  s_waitcnt lgkmcnt(5)
  v_xor_b32 v10, 0x10000, v10
  v_mfma_f32_16x16x32_bf16 v[104:107], a[160:163], v[44:47], v[104:107]
  ds_read_b128 v[36:39], v11 offset:57344
  v_mfma_f32_16x16x32_bf16 v[108:111], a[164:167], v[44:47], v[108:111]
  v_mfma_f32_16x16x32_bf16 v[120:123], a[168:171], v[44:47], v[120:123]
  buffer_store_dwordx4 v[136:139], v7, s[4:7], s21 offen offset:2048 sc1
  v_mfma_f32_16x16x32_bf16 v[124:127], a[172:175], v[44:47], v[124:127]
  s_waitcnt lgkmcnt(5)
  v_xor_b32 v11, 0x10000, v11
  v_mfma_f32_16x16x32_bf16 v[96:99], a[176:179], v[48:51], v[96:99]
  ds_read_b128 v[40:43], v12 offset:57344
  v_mfma_f32_16x16x32_bf16 v[100:103], a[180:183], v[48:51], v[100:103]
  v_mfma_f32_16x16x32_bf16 v[112:115], a[184:187], v[48:51], v[112:115]
  v_mfma_f32_16x16x32_bf16 v[116:119], a[188:191], v[48:51], v[116:119]
  s_waitcnt lgkmcnt(5)
  v_xor_b32 v12, 0x10000, v12
  v_mfma_f32_16x16x32_bf16 v[104:107], a[176:179], v[52:55], v[104:107]
  ds_read_b128 v[44:47], v13 offset:57344
  v_mfma_f32_16x16x32_bf16 v[108:111], a[180:183], v[52:55], v[108:111]
  v_mfma_f32_16x16x32_bf16 v[120:123], a[184:187], v[52:55], v[120:123]
  buffer_store_dwordx4 v[140:143], v7, s[4:7], s21 offen offset:2304 sc1
  v_mfma_f32_16x16x32_bf16 v[124:127], a[188:191], v[52:55], v[124:127]
  s_waitcnt lgkmcnt(5)
  v_xor_b32 v13, 0x10000, v13
  v_mfma_f32_16x16x32_bf16 v[96:99], a[192:195], v[24:27], v[96:99]
  s_mov_b32 s21, s27
  ds_read_b128 v[48:51], v14 offset:57344
  v_mfma_f32_16x16x32_bf16 v[100:103], a[196:199], v[24:27], v[100:103]
  v_mov_b32 v7, v56
  v_mfma_f32_16x16x32_bf16 v[112:115], a[200:203], v[24:27], v[112:115]
  v_mfma_f32_16x16x32_bf16 v[116:119], a[204:207], v[24:27], v[116:119]
  s_waitcnt lgkmcnt(5)
  v_xor_b32 v14, 0x10000, v14
  v_mfma_f32_16x16x32_bf16 v[104:107], a[192:195], v[28:31], v[104:107]
  s_add_u32 s27, s27, s22
  ds_read_b128 v[52:55], v15 offset:57344
  v_mfma_f32_16x16x32_bf16 v[108:111], a[196:199], v[28:31], v[108:111]
  v_mfma_f32_16x16x32_bf16 v[120:123], a[200:203], v[28:31], v[120:123]
  s_waitcnt vmcnt(13)
  s_barrier
  v_mfma_f32_16x16x32_bf16 v[124:127], a[204:207], v[28:31], v[124:127]
  s_waitcnt lgkmcnt(5)
  v_xor_b32 v15, 0x10000, v15
  v_mfma_f32_16x16x32_bf16 v[96:99], a[208:211], v[32:35], v[96:99]
  ds_read_b128 v[24:27], v8 offset:0
  v_mfma_f32_16x16x32_bf16 v[100:103], a[212:215], v[32:35], v[100:103]
  v_mfma_f32_16x16x32_bf16 v[112:115], a[216:219], v[32:35], v[112:115]
  v_mfma_f32_16x16x32_bf16 v[116:119], a[220:223], v[32:35], v[116:119]
  s_waitcnt lgkmcnt(5)
  v_mfma_f32_16x16x32_bf16 v[104:107], a[208:211], v[36:39], v[104:107]
  s_add_u32 s29, s29, 1
  ds_read_b128 v[28:31], v9 offset:0
  v_mfma_f32_16x16x32_bf16 v[108:111], a[212:215], v[36:39], v[108:111]
  v_mfma_f32_16x16x32_bf16 v[120:123], a[216:219], v[36:39], v[120:123]
  s_max_i32 s30, s29, 0
  v_mfma_f32_16x16x32_bf16 v[124:127], a[220:223], v[36:39], v[124:127]
  s_waitcnt lgkmcnt(5)
  v_mov_b32 v144, s30
  v_mfma_f32_16x16x32_bf16 v[96:99], a[224:227], v[40:43], v[96:99]
  ds_read_b128 v[32:35], v10 offset:0
  v_mfma_f32_16x16x32_bf16 v[100:103], a[228:231], v[40:43], v[100:103]
  v_mfma_f32_16x16x32_bf16 v[112:115], a[232:235], v[40:43], v[112:115]
  buffer_store_dword v144, v145, s[4:7], s31 offen sc1
  v_mfma_f32_16x16x32_bf16 v[116:119], a[236:239], v[40:43], v[116:119]
  s_waitcnt lgkmcnt(5)
  v_mfma_f32_16x16x32_bf16 v[104:107], a[224:227], v[44:47], v[104:107]
  ds_read_b128 v[36:39], v11 offset:0
  v_mfma_f32_16x16x32_bf16 v[108:111], a[228:231], v[44:47], v[108:111]
  v_mfma_f32_16x16x32_bf16 v[120:123], a[232:235], v[44:47], v[120:123]
  v_mfma_f32_16x16x32_bf16 v[124:127], a[236:239], v[44:47], v[124:127]
  s_waitcnt lgkmcnt(5)
  v_mfma_f32_16x16x32_bf16 v[96:99], a[240:243], v[48:51], v[96:99]
  s_sub_u32 s23, s23, 1
  ds_read_b128 v[40:43], v12 offset:0
  v_mfma_f32_16x16x32_bf16 v[100:103], a[244:247], v[48:51], v[100:103]
  v_mfma_f32_16x16x32_bf16 v[112:115], a[248:251], v[48:51], v[112:115]
  v_mfma_f32_16x16x32_bf16 v[116:119], a[252:255], v[48:51], v[116:119]
  s_waitcnt lgkmcnt(5)
  v_mfma_f32_16x16x32_bf16 v[104:107], a[240:243], v[52:55], v[104:107]
  s_cmp_eq_u32 s23, 0
  ds_read_b128 v[44:47], v13 offset:0
  v_mfma_f32_16x16x32_bf16 v[108:111], a[244:247], v[52:55], v[108:111]
  v_mfma_f32_16x16x32_bf16 v[120:123], a[248:251], v[52:55], v[120:123]
  v_mfma_f32_16x16x32_bf16 v[124:127], a[252:255], v[52:55], v[124:127]
  s_cbranch_scc1 G_done1_139
  s_branch G_top_137
G_done0_138:
  s_nop 7
  s_nop 3
  v_mul_f32 v64, s24, v64
  v_mul_f32 v65, s24, v65
  v_cvt_pk_bf16_f32 v128, v64, v65
  v_mul_f32 v66, s24, v66
  v_mul_f32 v67, s24, v67
  v_cvt_pk_bf16_f32 v129, v66, v67
  v_mul_f32 v68, s24, v68
  v_mul_f32 v69, s24, v69
  v_cvt_pk_bf16_f32 v130, v68, v69
  v_mul_f32 v70, s24, v70
  v_mul_f32 v71, s24, v71
  v_cvt_pk_bf16_f32 v131, v70, v71
  buffer_store_dwordx4 v[128:131], v7, s[4:7], s21 offen offset:0 sc1
  v_mul_f32 v72, s24, v72
  v_mul_f32 v73, s24, v73
  v_cvt_pk_bf16_f32 v132, v72, v73
  v_mul_f32 v74, s24, v74
  v_mul_f32 v75, s24, v75
  v_cvt_pk_bf16_f32 v133, v74, v75
  v_mul_f32 v76, s24, v76
  v_mul_f32 v77, s24, v77
  v_cvt_pk_bf16_f32 v134, v76, v77
  v_mul_f32 v78, s24, v78
  v_mul_f32 v79, s24, v79
  v_cvt_pk_bf16_f32 v135, v78, v79
  buffer_store_dwordx4 v[132:135], v7, s[4:7], s21 offen offset:256 sc1
  v_mul_f32 v80, s24, v80
  v_mul_f32 v81, s24, v81
  v_cvt_pk_bf16_f32 v136, v80, v81
  v_mul_f32 v82, s24, v82
  v_mul_f32 v83, s24, v83
  v_cvt_pk_bf16_f32 v137, v82, v83
  v_mul_f32 v84, s24, v84
  v_mul_f32 v85, s24, v85
  v_cvt_pk_bf16_f32 v138, v84, v85
  v_mul_f32 v86, s24, v86
  v_mul_f32 v87, s24, v87
  v_cvt_pk_bf16_f32 v139, v86, v87
  buffer_store_dwordx4 v[136:139], v7, s[4:7], s21 offen offset:2048 sc1
  v_mul_f32 v88, s24, v88
  v_mul_f32 v89, s24, v89
  v_cvt_pk_bf16_f32 v140, v88, v89
  v_mul_f32 v90, s24, v90
  v_mul_f32 v91, s24, v91
  v_cvt_pk_bf16_f32 v141, v90, v91
  v_mul_f32 v92, s24, v92
  v_mul_f32 v93, s24, v93
  v_cvt_pk_bf16_f32 v142, v92, v93
  v_mul_f32 v94, s24, v94
  v_mul_f32 v95, s24, v95
  v_cvt_pk_bf16_f32 v143, v94, v95
  buffer_store_dwordx4 v[140:143], v7, s[4:7], s21 offen offset:2304 sc1
  s_branch G_fin_140
G_done1_139:
  s_nop 7
  s_nop 3
  v_mul_f32 v96, s24, v96
  v_mul_f32 v97, s24, v97
  v_cvt_pk_bf16_f32 v128, v96, v97
  v_mul_f32 v98, s24, v98
  v_mul_f32 v99, s24, v99
  v_cvt_pk_bf16_f32 v129, v98, v99
  v_mul_f32 v100, s24, v100
  v_mul_f32 v101, s24, v101
  v_cvt_pk_bf16_f32 v130, v100, v101
  v_mul_f32 v102, s24, v102
  v_mul_f32 v103, s24, v103
  v_cvt_pk_bf16_f32 v131, v102, v103
  buffer_store_dwordx4 v[128:131], v7, s[4:7], s21 offen offset:0 sc1
  v_mul_f32 v104, s24, v104
  v_mul_f32 v105, s24, v105
  v_cvt_pk_bf16_f32 v132, v104, v105
  v_mul_f32 v106, s24, v106
  v_mul_f32 v107, s24, v107
  v_cvt_pk_bf16_f32 v133, v106, v107
  v_mul_f32 v108, s24, v108
  v_mul_f32 v109, s24, v109
  v_cvt_pk_bf16_f32 v134, v108, v109
  v_mul_f32 v110, s24, v110
  v_mul_f32 v111, s24, v111
  v_cvt_pk_bf16_f32 v135, v110, v111
  buffer_store_dwordx4 v[132:135], v7, s[4:7], s21 offen offset:256 sc1
  v_mul_f32 v112, s24, v112
  v_mul_f32 v113, s24, v113
  v_cvt_pk_bf16_f32 v136, v112, v113
  v_mul_f32 v114, s24, v114
  v_mul_f32 v115, s24, v115
  v_cvt_pk_bf16_f32 v137, v114, v115
  v_mul_f32 v116, s24, v116
  v_mul_f32 v117, s24, v117
  v_cvt_pk_bf16_f32 v138, v116, v117
  v_mul_f32 v118, s24, v118
  v_mul_f32 v119, s24, v119
  v_cvt_pk_bf16_f32 v139, v118, v119
  buffer_store_dwordx4 v[136:139], v7, s[4:7], s21 offen offset:2048 sc1
  v_mul_f32 v120, s24, v120
  v_mul_f32 v121, s24, v121
  v_cvt_pk_bf16_f32 v140, v120, v121
  v_mul_f32 v122, s24, v122
  v_mul_f32 v123, s24, v123
  v_cvt_pk_bf16_f32 v141, v122, v123
  v_mul_f32 v124, s24, v124
  v_mul_f32 v125, s24, v125
  v_cvt_pk_bf16_f32 v142, v124, v125
  v_mul_f32 v126, s24, v126
  v_mul_f32 v127, s24, v127
  v_cvt_pk_bf16_f32 v143, v126, v127
  buffer_store_dwordx4 v[140:143], v7, s[4:7], s21 offen offset:2304 sc1
G_fin_140:
  s_waitcnt vmcnt(0) lgkmcnt(0)
  s_barrier
  s_add_u32 s30, s29, 2
  v_mov_b32 v144, s30
  v_min_u32 v145, 1, v0
  v_lshlrev_b32 v145, 30, v145
  buffer_store_dword v144, v145, s[4:7], s31 offen sc1
  s_branch P_end_131
P_v_130:
  s_mov_b32 s27, s21
  v_mov_b32 v7, 0x40000000
  s_mov_b32 s29, -2
  v_min_u32 v145, 1, v0
  v_lshlrev_b32 v145, 30, v145
  ds_read_b128 v[24:27], v8 offset:0
  ds_read_b128 v[28:31], v9 offset:0
  ds_read_b128 v[32:35], v10 offset:0
  ds_read_b128 v[36:39], v11 offset:0
  ds_read_b128 v[40:43], v12 offset:0
  ds_read_b128 v[44:47], v13 offset:0
.p2align 6
G_top_141:
  s_waitcnt lgkmcnt(5)
  v_mfma_f32_16x16x32_bf16 v[64:67], v[24:27], a[0:3], 0
  s_add_u32 m0, s25, 0
  ds_read_b128 v[48:51], v14 offset:0
  v_mfma_f32_16x16x32_bf16 v[72:75], v[24:27], a[4:7], 0
  v_mfma_f32_16x16x32_bf16 v[80:83], v[24:27], a[8:11], 0
  buffer_load_dwordx4 v16, s[12:15], s19 offen lds
  v_mfma_f32_16x16x32_bf16 v[88:91], v[24:27], a[12:15], 0
  s_waitcnt lgkmcnt(5)
  v_mfma_f32_16x16x32_bf16 v[68:71], v[28:31], a[0:3], 0
  ds_read_b128 v[52:55], v15 offset:0
  v_mfma_f32_16x16x32_bf16 v[76:79], v[28:31], a[4:7], 0
  v_cvt_pk_bf16_f32 v128, v96, v97
  v_cvt_pk_bf16_f32 v129, v98, v99
  v_mfma_f32_16x16x32_bf16 v[84:87], v[28:31], a[8:11], 0
  v_mfma_f32_16x16x32_bf16 v[92:95], v[28:31], a[12:15], 0
  s_waitcnt lgkmcnt(5)
  v_cvt_pk_bf16_f32 v130, v100, v101
  v_cvt_pk_bf16_f32 v131, v102, v103
  v_mfma_f32_16x16x32_bf16 v[64:67], v[32:35], a[16:19], v[64:67]
  s_add_u32 m0, s25, 1024
  ds_read_b128 v[24:27], v8 offset:8192
  v_mfma_f32_16x16x32_bf16 v[72:75], v[32:35], a[20:23], v[72:75]
  v_mfma_f32_16x16x32_bf16 v[80:83], v[32:35], a[24:27], v[80:83]
  buffer_load_dwordx4 v17, s[12:15], s19 offen lds
  v_mfma_f32_16x16x32_bf16 v[88:91], v[32:35], a[28:31], v[88:91]
  s_waitcnt lgkmcnt(5)
  v_mfma_f32_16x16x32_bf16 v[68:71], v[36:39], a[16:19], v[68:71]
  ds_read_b128 v[28:31], v9 offset:8192
  v_mfma_f32_16x16x32_bf16 v[76:79], v[36:39], a[20:23], v[76:79]
  v_mfma_f32_16x16x32_bf16 v[84:87], v[36:39], a[24:27], v[84:87]
  v_mfma_f32_16x16x32_bf16 v[92:95], v[36:39], a[28:31], v[92:95]
  s_waitcnt lgkmcnt(5)
  v_mfma_f32_16x16x32_bf16 v[64:67], v[40:43], a[32:35], v[64:67]
  s_add_u32 m0, s25, 2048
  ds_read_b128 v[32:35], v10 offset:8192
  v_mfma_f32_16x16x32_bf16 v[72:75], v[40:43], a[36:39], v[72:75]
  v_cvt_pk_bf16_f32 v132, v104, v105
  v_cvt_pk_bf16_f32 v133, v106, v107
  v_mfma_f32_16x16x32_bf16 v[80:83], v[40:43], a[40:43], v[80:83]
  buffer_load_dwordx4 v18, s[12:15], s19 offen lds
  v_mfma_f32_16x16x32_bf16 v[88:91], v[40:43], a[44:47], v[88:91]
  s_waitcnt lgkmcnt(5)
  v_cvt_pk_bf16_f32 v134, v108, v109
  v_cvt_pk_bf16_f32 v135, v110, v111
  v_mfma_f32_16x16x32_bf16 v[68:71], v[44:47], a[32:35], v[68:71]
  ds_read_b128 v[36:39], v11 offset:8192
  v_mfma_f32_16x16x32_bf16 v[76:79], v[44:47], a[36:39], v[76:79]
  v_mfma_f32_16x16x32_bf16 v[84:87], v[44:47], a[40:43], v[84:87]
  v_mfma_f32_16x16x32_bf16 v[92:95], v[44:47], a[44:47], v[92:95]
  s_waitcnt lgkmcnt(5)
  v_mfma_f32_16x16x32_bf16 v[64:67], v[48:51], a[48:51], v[64:67]
  s_add_u32 m0, s25, 3072
  ds_read_b128 v[40:43], v12 offset:8192
  v_mfma_f32_16x16x32_bf16 v[72:75], v[48:51], a[52:55], v[72:75]
  v_mfma_f32_16x16x32_bf16 v[80:83], v[48:51], a[56:59], v[80:83]
  buffer_load_dwordx4 v19, s[12:15], s19 offen lds
  v_mfma_f32_16x16x32_bf16 v[88:91], v[48:51], a[60:63], v[88:91]
  s_waitcnt lgkmcnt(5)
  v_mfma_f32_16x16x32_bf16 v[68:71], v[52:55], a[48:51], v[68:71]
  ds_read_b128 v[44:47], v13 offset:8192
  v_mfma_f32_16x16x32_bf16 v[76:79], v[52:55], a[52:55], v[76:79]
  v_cvt_pk_bf16_f32 v136, v112, v113
  v_cvt_pk_bf16_f32 v137, v114, v115
  v_mfma_f32_16x16x32_bf16 v[84:87], v[52:55], a[56:59], v[84:87]
  v_mfma_f32_16x16x32_bf16 v[92:95], v[52:55], a[60:63], v[92:95]
  s_waitcnt lgkmcnt(5)
  v_cvt_pk_bf16_f32 v138, v116, v117
  v_cvt_pk_bf16_f32 v139, v118, v119
  v_mfma_f32_16x16x32_bf16 v[64:67], v[24:27], a[64:67], v[64:67]
  s_add_u32 m0, s25, 4096
  ds_read_b128 v[48:51], v14 offset:8192
  v_mfma_f32_16x16x32_bf16 v[72:75], v[24:27], a[68:71], v[72:75]
  v_mfma_f32_16x16x32_bf16 v[80:83], v[24:27], a[72:75], v[80:83]
  buffer_load_dwordx4 v20, s[12:15], s19 offen lds
  v_mfma_f32_16x16x32_bf16 v[88:91], v[24:27], a[76:79], v[88:91]
  s_waitcnt lgkmcnt(5)
  v_mfma_f32_16x16x32_bf16 v[68:71], v[28:31], a[64:67], v[68:71]
  ds_read_b128 v[52:55], v15 offset:8192
  v_mfma_f32_16x16x32_bf16 v[76:79], v[28:31], a[68:71], v[76:79]
  v_mfma_f32_16x16x32_bf16 v[84:87], v[28:31], a[72:75], v[84:87]
  v_mfma_f32_16x16x32_bf16 v[92:95], v[28:31], a[76:79], v[92:95]
  s_waitcnt lgkmcnt(5)
  v_mfma_f32_16x16x32_bf16 v[64:67], v[32:35], a[80:83], v[64:67]
  s_add_u32 m0, s25, 5120
  ds_read_b128 v[24:27], v8 offset:16384
  v_mfma_f32_16x16x32_bf16 v[72:75], v[32:35], a[84:87], v[72:75]
  v_cvt_pk_bf16_f32 v140, v120, v121
  v_cvt_pk_bf16_f32 v141, v122, v123
  v_mfma_f32_16x16x32_bf16 v[80:83], v[32:35], a[88:91], v[80:83]
  buffer_load_dwordx4 v21, s[12:15], s19 offen lds
  v_mfma_f32_16x16x32_bf16 v[88:91], v[32:35], a[92:95], v[88:91]
  s_waitcnt lgkmcnt(5)
  v_cvt_pk_bf16_f32 v142, v124, v125
  v_cvt_pk_bf16_f32 v143, v126, v127
  v_mfma_f32_16x16x32_bf16 v[68:71], v[36:39], a[80:83], v[68:71]
  ds_read_b128 v[28:31], v9 offset:16384
  v_mfma_f32_16x16x32_bf16 v[76:79], v[36:39], a[84:87], v[76:79]
  v_mfma_f32_16x16x32_bf16 v[84:87], v[36:39], a[88:91], v[84:87]
  v_mfma_f32_16x16x32_bf16 v[92:95], v[36:39], a[92:95], v[92:95]
  s_waitcnt lgkmcnt(5)
  v_mfma_f32_16x16x32_bf16 v[64:67], v[40:43], a[96:99], v[64:67]
  s_add_u32 m0, s25, 6144
  ds_read_b128 v[32:35], v10 offset:16384
  v_mfma_f32_16x16x32_bf16 v[72:75], v[40:43], a[100:103], v[72:75]
  v_mfma_f32_16x16x32_bf16 v[80:83], v[40:43], a[104:107], v[80:83]
  buffer_load_dwordx4 v22, s[12:15], s19 offen lds
  v_mfma_f32_16x16x32_bf16 v[88:91], v[40:43], a[108:111], v[88:91]
  s_waitcnt lgkmcnt(5)
  v_mfma_f32_16x16x32_bf16 v[68:71], v[44:47], a[96:99], v[68:71]
  ds_read_b128 v[36:39], v11 offset:16384
  v_mfma_f32_16x16x32_bf16 v[76:79], v[44:47], a[100:103], v[76:79]
  v_mfma_f32_16x16x32_bf16 v[84:87], v[44:47], a[104:107], v[84:87]
  v_mfma_f32_16x16x32_bf16 v[92:95], v[44:47], a[108:111], v[92:95]
  s_waitcnt lgkmcnt(5)
  v_mfma_f32_16x16x32_bf16 v[64:67], v[48:51], a[112:115], v[64:67]
  s_add_u32 m0, s25, 7168
  ds_read_b128 v[40:43], v12 offset:16384
  v_mfma_f32_16x16x32_bf16 v[72:75], v[48:51], a[116:119], v[72:75]
  v_mfma_f32_16x16x32_bf16 v[80:83], v[48:51], a[120:123], v[80:83]
  buffer_load_dwordx4 v23, s[12:15], s19 offen lds
  v_mfma_f32_16x16x32_bf16 v[88:91], v[48:51], a[124:127], v[88:91]
  s_waitcnt lgkmcnt(5)
  v_mfma_f32_16x16x32_bf16 v[68:71], v[52:55], a[112:115], v[68:71]
  s_cmp_gt_u32 s23, 3
  ds_read_b128 v[44:47], v13 offset:16384
  v_mfma_f32_16x16x32_bf16 v[76:79], v[52:55], a[116:119], v[76:79]
  v_mfma_f32_16x16x32_bf16 v[84:87], v[52:55], a[120:123], v[84:87]
  s_cselect_b32 s26, s20, 0
  v_mfma_f32_16x16x32_bf16 v[92:95], v[52:55], a[124:127], v[92:95]
  s_waitcnt lgkmcnt(5)
  v_mfma_f32_16x16x32_bf16 v[64:67], v[24:27], a[128:131], v[64:67]
  s_add_u32 s19, s19, s26
  ds_read_b128 v[48:51], v14 offset:16384
  v_mfma_f32_16x16x32_bf16 v[72:75], v[24:27], a[132:135], v[72:75]
  v_mfma_f32_16x16x32_bf16 v[80:83], v[24:27], a[136:139], v[80:83]
  s_add_u32 s25, s25, 32768
  v_mfma_f32_16x16x32_bf16 v[88:91], v[24:27], a[140:143], v[88:91]
  s_waitcnt lgkmcnt(5)
  v_mfma_f32_16x16x32_bf16 v[68:71], v[28:31], a[128:131], v[68:71]
  s_and_b32 s25, s25, 0x1ffff
  ds_read_b128 v[52:55], v15 offset:16384
  v_mfma_f32_16x16x32_bf16 v[76:79], v[28:31], a[132:135], v[76:79]
  v_mfma_f32_16x16x32_bf16 v[84:87], v[28:31], a[136:139], v[84:87]
  buffer_store_dwordx4 v[128:131], v7, s[4:7], s21 offen offset:0 sc1
  v_mfma_f32_16x16x32_bf16 v[92:95], v[28:31], a[140:143], v[92:95]
  s_waitcnt lgkmcnt(5)
  v_mfma_f32_16x16x32_bf16 v[64:67], v[32:35], a[144:147], v[64:67]
  ds_read_b128 v[24:27], v8 offset:24576
  v_mfma_f32_16x16x32_bf16 v[72:75], v[32:35], a[148:151], v[72:75]
  v_mfma_f32_16x16x32_bf16 v[80:83], v[32:35], a[152:155], v[80:83]
  v_mfma_f32_16x16x32_bf16 v[88:91], v[32:35], a[156:159], v[88:91]
  s_waitcnt lgkmcnt(5)
  v_mfma_f32_16x16x32_bf16 v[68:71], v[36:39], a[144:147], v[68:71]
  ds_read_b128 v[28:31], v9 offset:24576
  v_mfma_f32_16x16x32_bf16 v[76:79], v[36:39], a[148:151], v[76:79]
  v_mfma_f32_16x16x32_bf16 v[84:87], v[36:39], a[152:155], v[84:87]
  buffer_store_dwordx4 v[132:135], v7, s[4:7], s21 offen offset:256 sc1
  v_mfma_f32_16x16x32_bf16 v[92:95], v[36:39], a[156:159], v[92:95]
  s_waitcnt lgkmcnt(5)
  v_mfma_f32_16x16x32_bf16 v[64:67], v[40:43], a[160:163], v[64:67]
  ds_read_b128 v[32:35], v10 offset:24576
  v_mfma_f32_16x16x32_bf16 v[72:75], v[40:43], a[164:167], v[72:75]
  v_mfma_f32_16x16x32_bf16 v[80:83], v[40:43], a[168:171], v[80:83]
  v_mfma_f32_16x16x32_bf16 v[88:91], v[40:43], a[172:175], v[88:91]
  s_waitcnt lgkmcnt(5)
  v_mfma_f32_16x16x32_bf16 v[68:71], v[44:47], a[160:163], v[68:71]
  ds_read_b128 v[36:39], v11 offset:24576
  v_mfma_f32_16x16x32_bf16 v[76:79], v[44:47], a[164:167], v[76:79]
  v_mfma_f32_16x16x32_bf16 v[84:87], v[44:47], a[168:171], v[84:87]
  buffer_store_dwordx4 v[136:139], v7, s[4:7], s21 offen offset:2048 sc1
  v_mfma_f32_16x16x32_bf16 v[92:95], v[44:47], a[172:175], v[92:95]
  s_waitcnt lgkmcnt(5)
  v_mfma_f32_16x16x32_bf16 v[64:67], v[48:51], a[176:179], v[64:67]
  ds_read_b128 v[40:43], v12 offset:24576
  v_mfma_f32_16x16x32_bf16 v[72:75], v[48:51], a[180:183], v[72:75]
  v_mfma_f32_16x16x32_bf16 v[80:83], v[48:51], a[184:187], v[80:83]
  v_mfma_f32_16x16x32_bf16 v[88:91], v[48:51], a[188:191], v[88:91]
  s_waitcnt lgkmcnt(5)
  v_mfma_f32_16x16x32_bf16 v[68:71], v[52:55], a[176:179], v[68:71]
  ds_read_b128 v[44:47], v13 offset:24576
  v_mfma_f32_16x16x32_bf16 v[76:79], v[52:55], a[180:183], v[76:79]
  v_mfma_f32_16x16x32_bf16 v[84:87], v[52:55], a[184:187], v[84:87]
  buffer_store_dwordx4 v[140:143], v7, s[4:7], s21 offen offset:2304 sc1
  v_mfma_f32_16x16x32_bf16 v[92:95], v[52:55], a[188:191], v[92:95]
  s_waitcnt lgkmcnt(5)
  v_mfma_f32_16x16x32_bf16 v[64:67], v[24:27], a[192:195], v[64:67]
  s_mov_b32 s21, s27
  ds_read_b128 v[48:51], v14 offset:24576
  v_mfma_f32_16x16x32_bf16 v[72:75], v[24:27], a[196:199], v[72:75]
  v_mov_b32 v7, v56
  v_mfma_f32_16x16x32_bf16 v[80:83], v[24:27], a[200:203], v[80:83]
  v_mfma_f32_16x16x32_bf16 v[88:91], v[24:27], a[204:207], v[88:91]
  s_waitcnt lgkmcnt(5)
  v_mfma_f32_16x16x32_bf16 v[68:71], v[28:31], a[192:195], v[68:71]
  s_add_u32 s27, s27, s22
  ds_read_b128 v[52:55], v15 offset:24576
  v_mfma_f32_16x16x32_bf16 v[76:79], v[28:31], a[196:199], v[76:79]
  v_mfma_f32_16x16x32_bf16 v[84:87], v[28:31], a[200:203], v[84:87]
  s_waitcnt vmcnt(13)
  s_barrier
  v_mfma_f32_16x16x32_bf16 v[92:95], v[28:31], a[204:207], v[92:95]
  s_waitcnt lgkmcnt(5)
  v_mfma_f32_16x16x32_bf16 v[64:67], v[32:35], a[208:211], v[64:67]
  ds_read_b128 v[24:27], v8 offset:32768
  v_mfma_f32_16x16x32_bf16 v[72:75], v[32:35], a[212:215], v[72:75]
  v_mfma_f32_16x16x32_bf16 v[80:83], v[32:35], a[216:219], v[80:83]
  v_mfma_f32_16x16x32_bf16 v[88:91], v[32:35], a[220:223], v[88:91]
  s_waitcnt lgkmcnt(5)
  v_mfma_f32_16x16x32_bf16 v[68:71], v[36:39], a[208:211], v[68:71]
  s_add_u32 s29, s29, 1
  ds_read_b128 v[28:31], v9 offset:32768
  v_mfma_f32_16x16x32_bf16 v[76:79], v[36:39], a[212:215], v[76:79]
  v_mfma_f32_16x16x32_bf16 v[84:87], v[36:39], a[216:219], v[84:87]
  s_max_i32 s30, s29, 0
  v_mfma_f32_16x16x32_bf16 v[92:95], v[36:39], a[220:223], v[92:95]
  s_waitcnt lgkmcnt(5)
  v_mov_b32 v144, s30
  v_mfma_f32_16x16x32_bf16 v[64:67], v[40:43], a[224:227], v[64:67]
  ds_read_b128 v[32:35], v10 offset:32768
  v_mfma_f32_16x16x32_bf16 v[72:75], v[40:43], a[228:231], v[72:75]
  v_mfma_f32_16x16x32_bf16 v[80:83], v[40:43], a[232:235], v[80:83]
  buffer_store_dword v144, v145, s[4:7], s31 offen sc1
  v_mfma_f32_16x16x32_bf16 v[88:91], v[40:43], a[236:239], v[88:91]
  s_waitcnt lgkmcnt(5)
  v_mfma_f32_16x16x32_bf16 v[68:71], v[44:47], a[224:227], v[68:71]
  ds_read_b128 v[36:39], v11 offset:32768
  v_mfma_f32_16x16x32_bf16 v[76:79], v[44:47], a[228:231], v[76:79]
  v_mfma_f32_16x16x32_bf16 v[84:87], v[44:47], a[232:235], v[84:87]
  v_mfma_f32_16x16x32_bf16 v[92:95], v[44:47], a[236:239], v[92:95]
  s_waitcnt lgkmcnt(5)
  v_mfma_f32_16x16x32_bf16 v[64:67], v[48:51], a[240:243], v[64:67]
  s_sub_u32 s23, s23, 1
  ds_read_b128 v[40:43], v12 offset:32768
  v_mfma_f32_16x16x32_bf16 v[72:75], v[48:51], a[244:247], v[72:75]
  v_mfma_f32_16x16x32_bf16 v[80:83], v[48:51], a[248:251], v[80:83]
  v_mfma_f32_16x16x32_bf16 v[88:91], v[48:51], a[252:255], v[88:91]
  s_waitcnt lgkmcnt(5)
  v_mfma_f32_16x16x32_bf16 v[68:71], v[52:55], a[240:243], v[68:71]
  s_cmp_eq_u32 s23, 0
  ds_read_b128 v[44:47], v13 offset:32768
  v_mfma_f32_16x16x32_bf16 v[76:79], v[52:55], a[244:247], v[76:79]
  v_mfma_f32_16x16x32_bf16 v[84:87], v[52:55], a[248:251], v[84:87]
  v_mfma_f32_16x16x32_bf16 v[92:95], v[52:55], a[252:255], v[92:95]
  s_cbranch_scc1 G_done0_142
  s_waitcnt lgkmcnt(5)
  v_mfma_f32_16x16x32_bf16 v[96:99], v[24:27], a[0:3], 0
  s_add_u32 m0, s25, 0
  ds_read_b128 v[48:51], v14 offset:32768
  v_mfma_f32_16x16x32_bf16 v[104:107], v[24:27], a[4:7], 0
  v_mfma_f32_16x16x32_bf16 v[112:115], v[24:27], a[8:11], 0
  buffer_load_dwordx4 v16, s[12:15], s19 offen lds
  v_mfma_f32_16x16x32_bf16 v[120:123], v[24:27], a[12:15], 0
  s_waitcnt lgkmcnt(5)
  v_mfma_f32_16x16x32_bf16 v[100:103], v[28:31], a[0:3], 0
  ds_read_b128 v[52:55], v15 offset:32768
  v_mfma_f32_16x16x32_bf16 v[108:111], v[28:31], a[4:7], 0
  v_cvt_pk_bf16_f32 v128, v64, v65
  v_cvt_pk_bf16_f32 v129, v66, v67
  v_mfma_f32_16x16x32_bf16 v[116:119], v[28:31], a[8:11], 0
  v_mfma_f32_16x16x32_bf16 v[124:127], v[28:31], a[12:15], 0
  s_waitcnt lgkmcnt(5)
  v_cvt_pk_bf16_f32 v130, v68, v69
  v_cvt_pk_bf16_f32 v131, v70, v71
  v_mfma_f32_16x16x32_bf16 v[96:99], v[32:35], a[16:19], v[96:99]
  s_add_u32 m0, s25, 1024
  ds_read_b128 v[24:27], v8 offset:40960
  v_mfma_f32_16x16x32_bf16 v[104:107], v[32:35], a[20:23], v[104:107]
  v_mfma_f32_16x16x32_bf16 v[112:115], v[32:35], a[24:27], v[112:115]
  buffer_load_dwordx4 v17, s[12:15], s19 offen lds
  v_mfma_f32_16x16x32_bf16 v[120:123], v[32:35], a[28:31], v[120:123]
  s_waitcnt lgkmcnt(5)
  v_mfma_f32_16x16x32_bf16 v[100:103], v[36:39], a[16:19], v[100:103]
  ds_read_b128 v[28:31], v9 offset:40960
  v_mfma_f32_16x16x32_bf16 v[108:111], v[36:39], a[20:23], v[108:111]
  v_mfma_f32_16x16x32_bf16 v[116:119], v[36:39], a[24:27], v[116:119]
  v_mfma_f32_16x16x32_bf16 v[124:127], v[36:39], a[28:31], v[124:127]
  s_waitcnt lgkmcnt(5)
  v_mfma_f32_16x16x32_bf16 v[96:99], v[40:43], a[32:35], v[96:99]
  s_add_u32 m0, s25, 2048
  ds_read_b128 v[32:35], v10 offset:40960
  v_mfma_f32_16x16x32_bf16 v[104:107], v[40:43], a[36:39], v[104:107]
  v_cvt_pk_bf16_f32 v132, v72, v73
  v_cvt_pk_bf16_f32 v133, v74, v75
  v_mfma_f32_16x16x32_bf16 v[112:115], v[40:43], a[40:43], v[112:115]
  buffer_load_dwordx4 v18, s[12:15], s19 offen lds
  v_mfma_f32_16x16x32_bf16 v[120:123], v[40:43], a[44:47], v[120:123]
  s_waitcnt lgkmcnt(5)
  v_cvt_pk_bf16_f32 v134, v76, v77
  v_cvt_pk_bf16_f32 v135, v78, v79
  v_mfma_f32_16x16x32_bf16 v[100:103], v[44:47], a[32:35], v[100:103]
  ds_read_b128 v[36:39], v11 offset:40960
  v_mfma_f32_16x16x32_bf16 v[108:111], v[44:47], a[36:39], v[108:111]
  v_mfma_f32_16x16x32_bf16 v[116:119], v[44:47], a[40:43], v[116:119]
  v_mfma_f32_16x16x32_bf16 v[124:127], v[44:47], a[44:47], v[124:127]
  s_waitcnt lgkmcnt(5)
  v_mfma_f32_16x16x32_bf16 v[96:99], v[48:51], a[48:51], v[96:99]
  s_add_u32 m0, s25, 3072
  ds_read_b128 v[40:43], v12 offset:40960
  v_mfma_f32_16x16x32_bf16 v[104:107], v[48:51], a[52:55], v[104:107]
  v_mfma_f32_16x16x32_bf16 v[112:115], v[48:51], a[56:59], v[112:115]
  buffer_load_dwordx4 v19, s[12:15], s19 offen lds
  v_mfma_f32_16x16x32_bf16 v[120:123], v[48:51], a[60:63], v[120:123]
  s_waitcnt lgkmcnt(5)
  v_mfma_f32_16x16x32_bf16 v[100:103], v[52:55], a[48:51], v[100:103]
  ds_read_b128 v[44:47], v13 offset:40960
  v_mfma_f32_16x16x32_bf16 v[108:111], v[52:55], a[52:55], v[108:111]
  v_cvt_pk_bf16_f32 v136, v80, v81
  v_cvt_pk_bf16_f32 v137, v82, v83
  v_mfma_f32_16x16x32_bf16 v[116:119], v[52:55], a[56:59], v[116:119]
  v_mfma_f32_16x16x32_bf16 v[124:127], v[52:55], a[60:63], v[124:127]
  s_waitcnt lgkmcnt(5)
  v_cvt_pk_bf16_f32 v138, v84, v85
  v_cvt_pk_bf16_f32 v139, v86, v87
  v_mfma_f32_16x16x32_bf16 v[96:99], v[24:27], a[64:67], v[96:99]
  s_add_u32 m0, s25, 4096
  ds_read_b128 v[48:51], v14 offset:40960
  v_mfma_f32_16x16x32_bf16 v[104:107], v[24:27], a[68:71], v[104:107]
  v_mfma_f32_16x16x32_bf16 v[112:115], v[24:27], a[72:75], v[112:115]
  buffer_load_dwordx4 v20, s[12:15], s19 offen lds
  v_mfma_f32_16x16x32_bf16 v[120:123], v[24:27], a[76:79], v[120:123]
  s_waitcnt lgkmcnt(5)
  v_mfma_f32_16x16x32_bf16 v[100:103], v[28:31], a[64:67], v[100:103]
  ds_read_b128 v[52:55], v15 offset:40960
  v_mfma_f32_16x16x32_bf16 v[108:111], v[28:31], a[68:71], v[108:111]
  v_mfma_f32_16x16x32_bf16 v[116:119], v[28:31], a[72:75], v[116:119]
  v_mfma_f32_16x16x32_bf16 v[124:127], v[28:31], a[76:79], v[124:127]
  s_waitcnt lgkmcnt(5)
  v_mfma_f32_16x16x32_bf16 v[96:99], v[32:35], a[80:83], v[96:99]
  s_add_u32 m0, s25, 5120
  ds_read_b128 v[24:27], v8 offset:49152
  v_mfma_f32_16x16x32_bf16 v[104:107], v[32:35], a[84:87], v[104:107]
  v_cvt_pk_bf16_f32 v140, v88, v89
  v_cvt_pk_bf16_f32 v141, v90, v91
  v_mfma_f32_16x16x32_bf16 v[112:115], v[32:35], a[88:91], v[112:115]
  buffer_load_dwordx4 v21, s[12:15], s19 offen lds
  v_mfma_f32_16x16x32_bf16 v[120:123], v[32:35], a[92:95], v[120:123]
  s_waitcnt lgkmcnt(5)
  v_cvt_pk_bf16_f32 v142, v92, v93
  v_cvt_pk_bf16_f32 v143, v94, v95
  v_mfma_f32_16x16x32_bf16 v[100:103], v[36:39], a[80:83], v[100:103]
  ds_read_b128 v[28:31], v9 offset:49152
  v_mfma_f32_16x16x32_bf16 v[108:111], v[36:39], a[84:87], v[108:111]
  v_mfma_f32_16x16x32_bf16 v[116:119], v[36:39], a[88:91], v[116:119]
  v_mfma_f32_16x16x32_bf16 v[124:127], v[36:39], a[92:95], v[124:127]
  s_waitcnt lgkmcnt(5)
  v_mfma_f32_16x16x32_bf16 v[96:99], v[40:43], a[96:99], v[96:99]
  s_add_u32 m0, s25, 6144
  ds_read_b128 v[32:35], v10 offset:49152
  v_mfma_f32_16x16x32_bf16 v[104:107], v[40:43], a[100:103], v[104:107]
  v_mfma_f32_16x16x32_bf16 v[112:115], v[40:43], a[104:107], v[112:115]
  buffer_load_dwordx4 v22, s[12:15], s19 offen lds
  v_mfma_f32_16x16x32_bf16 v[120:123], v[40:43], a[108:111], v[120:123]
  s_waitcnt lgkmcnt(5)
  v_mfma_f32_16x16x32_bf16 v[100:103], v[44:47], a[96:99], v[100:103]
  ds_read_b128 v[36:39], v11 offset:49152
  v_mfma_f32_16x16x32_bf16 v[108:111], v[44:47], a[100:103], v[108:111]
  v_mfma_f32_16x16x32_bf16 v[116:119], v[44:47], a[104:107], v[116:119]
  v_mfma_f32_16x16x32_bf16 v[124:127], v[44:47], a[108:111], v[124:127]
  s_waitcnt lgkmcnt(5)
  v_mfma_f32_16x16x32_bf16 v[96:99], v[48:51], a[112:115], v[96:99]
  s_add_u32 m0, s25, 7168
  ds_read_b128 v[40:43], v12 offset:49152
  v_mfma_f32_16x16x32_bf16 v[104:107], v[48:51], a[116:119], v[104:107]
  v_mfma_f32_16x16x32_bf16 v[112:115], v[48:51], a[120:123], v[112:115]
  buffer_load_dwordx4 v23, s[12:15], s19 offen lds
  v_mfma_f32_16x16x32_bf16 v[120:123], v[48:51], a[124:127], v[120:123]
  s_waitcnt lgkmcnt(5)
  v_mfma_f32_16x16x32_bf16 v[100:103], v[52:55], a[112:115], v[100:103]
  s_cmp_gt_u32 s23, 3
  ds_read_b128 v[44:47], v13 offset:49152
  v_mfma_f32_16x16x32_bf16 v[108:111], v[52:55], a[116:119], v[108:111]
  v_mfma_f32_16x16x32_bf16 v[116:119], v[52:55], a[120:123], v[116:119]
  s_cselect_b32 s26, s20, 0
  v_mfma_f32_16x16x32_bf16 v[124:127], v[52:55], a[124:127], v[124:127]
  s_waitcnt lgkmcnt(5)
  v_mfma_f32_16x16x32_bf16 v[96:99], v[24:27], a[128:131], v[96:99]
  s_add_u32 s19, s19, s26
  ds_read_b128 v[48:51], v14 offset:49152
  v_mfma_f32_16x16x32_bf16 v[104:107], v[24:27], a[132:135], v[104:107]
  v_mfma_f32_16x16x32_bf16 v[112:115], v[24:27], a[136:139], v[112:115]
  s_add_u32 s25, s25, 32768
  v_mfma_f32_16x16x32_bf16 v[120:123], v[24:27], a[140:143], v[120:123]
  s_waitcnt lgkmcnt(5)
  v_mfma_f32_16x16x32_bf16 v[100:103], v[28:31], a[128:131], v[100:103]
  s_and_b32 s25, s25, 0x1ffff
  ds_read_b128 v[52:55], v15 offset:49152
  v_mfma_f32_16x16x32_bf16 v[108:111], v[28:31], a[132:135], v[108:111]
  v_mfma_f32_16x16x32_bf16 v[116:119], v[28:31], a[136:139], v[116:119]
  buffer_store_dwordx4 v[128:131], v7, s[4:7], s21 offen offset:0 sc1
  v_mfma_f32_16x16x32_bf16 v[124:127], v[28:31], a[140:143], v[124:127]
  s_waitcnt lgkmcnt(5)
  v_mfma_f32_16x16x32_bf16 v[96:99], v[32:35], a[144:147], v[96:99]
  ds_read_b128 v[24:27], v8 offset:57344
  v_mfma_f32_16x16x32_bf16 v[104:107], v[32:35], a[148:151], v[104:107]
  v_mfma_f32_16x16x32_bf16 v[112:115], v[32:35], a[152:155], v[112:115]
  v_mfma_f32_16x16x32_bf16 v[120:123], v[32:35], a[156:159], v[120:123]
  s_waitcnt lgkmcnt(5)
  v_xor_b32 v8, 0x10000, v8
  v_mfma_f32_16x16x32_bf16 v[100:103], v[36:39], a[144:147], v[100:103]
  ds_read_b128 v[28:31], v9 offset:57344
  v_mfma_f32_16x16x32_bf16 v[108:111], v[36:39], a[148:151], v[108:111]
  v_mfma_f32_16x16x32_bf16 v[116:119], v[36:39], a[152:155], v[116:119]
  buffer_store_dwordx4 v[132:135], v7, s[4:7], s21 offen offset:256 sc1
  v_mfma_f32_16x16x32_bf16 v[124:127], v[36:39], a[156:159], v[124:127]
  s_waitcnt lgkmcnt(5)
  v_xor_b32 v9, 0x10000, v9
  v_mfma_f32_16x16x32_bf16 v[96:99], v[40:43], a[160:163], v[96:99]
  ds_read_b128 v[32:35], v10 offset:57344
  v_mfma_f32_16x16x32_bf16 v[104:107], v[40:43], a[164:167], v[104:107]
  v_mfma_f32_16x16x32_bf16 v[112:115], v[40:43], a[168:171], v[112:115]
  v_mfma_f32_16x16x32_bf16 v[120:123], v[40:43], a[172:175], v[120:123]
  s_waitcnt lgkmcnt(5)
  v_xor_b32 v10, 0x10000, v10
  v_mfma_f32_16x16x32_bf16 v[100:103], v[44:47], a[160:163], v[100:103]
  ds_read_b128 v[36:39], v11 offset:57344
  v_mfma_f32_16x16x32_bf16 v[108:111], v[44:47], a[164:167], v[108:111]
  v_mfma_f32_16x16x32_bf16 v[116:119], v[44:47], a[168:171], v[116:119]
  buffer_store_dwordx4 v[136:139], v7, s[4:7], s21 offen offset:2048 sc1
  v_mfma_f32_16x16x32_bf16 v[124:127], v[44:47], a[172:175], v[124:127]
  s_waitcnt lgkmcnt(5)
  v_xor_b32 v11, 0x10000, v11
  v_mfma_f32_16x16x32_bf16 v[96:99], v[48:51], a[176:179], v[96:99]
  ds_read_b128 v[40:43], v12 offset:57344
  v_mfma_f32_16x16x32_bf16 v[104:107], v[48:51], a[180:183], v[104:107]
  v_mfma_f32_16x16x32_bf16 v[112:115], v[48:51], a[184:187], v[112:115]
  v_mfma_f32_16x16x32_bf16 v[120:123], v[48:51], a[188:191], v[120:123]
  s_waitcnt lgkmcnt(5)
  v_xor_b32 v12, 0x10000, v12
  v_mfma_f32_16x16x32_bf16 v[100:103], v[52:55], a[176:179], v[100:103]
  ds_read_b128 v[44:47], v13 offset:57344
  v_mfma_f32_16x16x32_bf16 v[108:111], v[52:55], a[180:183], v[108:111]
  v_mfma_f32_16x16x32_bf16 v[116:119], v[52:55], a[184:187], v[116:119]
  buffer_store_dwordx4 v[140:143], v7, s[4:7], s21 offen offset:2304 sc1
  v_mfma_f32_16x16x32_bf16 v[124:127], v[52:55], a[188:191], v[124:127]
  s_waitcnt lgkmcnt(5)
  v_xor_b32 v13, 0x10000, v13
  v_mfma_f32_16x16x32_bf16 v[96:99], v[24:27], a[192:195], v[96:99]
  s_mov_b32 s21, s27
  ds_read_b128 v[48:51], v14 offset:57344
  v_mfma_f32_16x16x32_bf16 v[104:107], v[24:27], a[196:199], v[104:107]
  v_mov_b32 v7, v56
  v_mfma_f32_16x16x32_bf16 v[112:115], v[24:27], a[200:203], v[112:115]
  v_mfma_f32_16x16x32_bf16 v[120:123], v[24:27], a[204:207], v[120:123]
  s_waitcnt lgkmcnt(5)
  v_xor_b32 v14, 0x10000, v14
  v_mfma_f32_16x16x32_bf16 v[100:103], v[28:31], a[192:195], v[100:103]
  s_add_u32 s27, s27, s22
  ds_read_b128 v[52:55], v15 offset:57344
  v_mfma_f32_16x16x32_bf16 v[108:111], v[28:31], a[196:199], v[108:111]
  v_mfma_f32_16x16x32_bf16 v[116:119], v[28:31], a[200:203], v[116:119]
  s_waitcnt vmcnt(13)
  s_barrier
  v_mfma_f32_16x16x32_bf16 v[124:127], v[28:31], a[204:207], v[124:127]
  s_waitcnt lgkmcnt(5)
  v_xor_b32 v15, 0x10000, v15
  v_mfma_f32_16x16x32_bf16 v[96:99], v[32:35], a[208:211], v[96:99]
  ds_read_b128 v[24:27], v8 offset:0
  v_mfma_f32_16x16x32_bf16 v[104:107], v[32:35], a[212:215], v[104:107]
  v_mfma_f32_16x16x32_bf16 v[112:115], v[32:35], a[216:219], v[112:115]
  v_mfma_f32_16x16x32_bf16 v[120:123], v[32:35], a[220:223], v[120:123]
  s_waitcnt lgkmcnt(5)
  v_mfma_f32_16x16x32_bf16 v[100:103], v[36:39], a[208:211], v[100:103]
  s_add_u32 s29, s29, 1
  ds_read_b128 v[28:31], v9 offset:0
  v_mfma_f32_16x16x32_bf16 v[108:111], v[36:39], a[212:215], v[108:111]
  v_mfma_f32_16x16x32_bf16 v[116:119], v[36:39], a[216:219], v[116:119]
  s_max_i32 s30, s29, 0
  v_mfma_f32_16x16x32_bf16 v[124:127], v[36:39], a[220:223], v[124:127]
  s_waitcnt lgkmcnt(5)
  v_mov_b32 v144, s30
  v_mfma_f32_16x16x32_bf16 v[96:99], v[40:43], a[224:227], v[96:99]
  ds_read_b128 v[32:35], v10 offset:0
  v_mfma_f32_16x16x32_bf16 v[104:107], v[40:43], a[228:231], v[104:107]
  v_mfma_f32_16x16x32_bf16 v[112:115], v[40:43], a[232:235], v[112:115]
  buffer_store_dword v144, v145, s[4:7], s31 offen sc1
  v_mfma_f32_16x16x32_bf16 v[120:123], v[40:43], a[236:239], v[120:123]
  s_waitcnt lgkmcnt(5)
  v_mfma_f32_16x16x32_bf16 v[100:103], v[44:47], a[224:227], v[100:103]
  ds_read_b128 v[36:39], v11 offset:0
  v_mfma_f32_16x16x32_bf16 v[108:111], v[44:47], a[228:231], v[108:111]
  v_mfma_f32_16x16x32_bf16 v[116:119], v[44:47], a[232:235], v[116:119]
  v_mfma_f32_16x16x32_bf16 v[124:127], v[44:47], a[236:239], v[124:127]
  s_waitcnt lgkmcnt(5)
  v_mfma_f32_16x16x32_bf16 v[96:99], v[48:51], a[240:243], v[96:99]
  s_sub_u32 s23, s23, 1
  ds_read_b128 v[40:43], v12 offset:0
  v_mfma_f32_16x16x32_bf16 v[104:107], v[48:51], a[244:247], v[104:107]
  v_mfma_f32_16x16x32_bf16 v[112:115], v[48:51], a[248:251], v[112:115]
  v_mfma_f32_16x16x32_bf16 v[120:123], v[48:51], a[252:255], v[120:123]
  s_waitcnt lgkmcnt(5)
  v_mfma_f32_16x16x32_bf16 v[100:103], v[52:55], a[240:243], v[100:103]
  s_cmp_eq_u32 s23, 0
  ds_read_b128 v[44:47], v13 offset:0
  v_mfma_f32_16x16x32_bf16 v[108:111], v[52:55], a[244:247], v[108:111]
  v_mfma_f32_16x16x32_bf16 v[116:119], v[52:55], a[248:251], v[116:119]
  v_mfma_f32_16x16x32_bf16 v[124:127], v[52:55], a[252:255], v[124:127]
  s_cbranch_scc1 G_done1_143
  s_branch G_top_141
G_done0_142:
  s_nop 7
  s_nop 3
  v_cvt_pk_bf16_f32 v128, v64, v65
  v_cvt_pk_bf16_f32 v129, v66, v67
  v_cvt_pk_bf16_f32 v130, v68, v69
  v_cvt_pk_bf16_f32 v131, v70, v71
  buffer_store_dwordx4 v[128:131], v7, s[4:7], s21 offen offset:0 sc1
  v_cvt_pk_bf16_f32 v132, v72, v73
  v_cvt_pk_bf16_f32 v133, v74, v75
  v_cvt_pk_bf16_f32 v134, v76, v77
  v_cvt_pk_bf16_f32 v135, v78, v79
  buffer_store_dwordx4 v[132:135], v7, s[4:7], s21 offen offset:256 sc1
  v_cvt_pk_bf16_f32 v136, v80, v81
  v_cvt_pk_bf16_f32 v137, v82, v83
  v_cvt_pk_bf16_f32 v138, v84, v85
  v_cvt_pk_bf16_f32 v139, v86, v87
  buffer_store_dwordx4 v[136:139], v7, s[4:7], s21 offen offset:2048 sc1
  v_cvt_pk_bf16_f32 v140, v88, v89
  v_cvt_pk_bf16_f32 v141, v90, v91
  v_cvt_pk_bf16_f32 v142, v92, v93
  v_cvt_pk_bf16_f32 v143, v94, v95
  buffer_store_dwordx4 v[140:143], v7, s[4:7], s21 offen offset:2304 sc1
  s_branch G_fin_144
G_done1_143:
  s_nop 7
  s_nop 3
  v_cvt_pk_bf16_f32 v128, v96, v97
  v_cvt_pk_bf16_f32 v129, v98, v99
  v_cvt_pk_bf16_f32 v130, v100, v101
  v_cvt_pk_bf16_f32 v131, v102, v103
  buffer_store_dwordx4 v[128:131], v7, s[4:7], s21 offen offset:0 sc1
  v_cvt_pk_bf16_f32 v132, v104, v105
  v_cvt_pk_bf16_f32 v133, v106, v107
  v_cvt_pk_bf16_f32 v134, v108, v109
  v_cvt_pk_bf16_f32 v135, v110, v111
  buffer_store_dwordx4 v[132:135], v7, s[4:7], s21 offen offset:256 sc1
  v_cvt_pk_bf16_f32 v136, v112, v113
  v_cvt_pk_bf16_f32 v137, v114, v115
  v_cvt_pk_bf16_f32 v138, v116, v117
  v_cvt_pk_bf16_f32 v139, v118, v119
  buffer_store_dwordx4 v[136:139], v7, s[4:7], s21 offen offset:2048 sc1
  v_cvt_pk_bf16_f32 v140, v120, v121
  v_cvt_pk_bf16_f32 v141, v122, v123
  v_cvt_pk_bf16_f32 v142, v124, v125
  v_cvt_pk_bf16_f32 v143, v126, v127
  buffer_store_dwordx4 v[140:143], v7, s[4:7], s21 offen offset:2304 sc1
G_fin_144:
  s_waitcnt vmcnt(0) lgkmcnt(0)
  s_barrier
  s_add_u32 s30, s29, 2
  v_mov_b32 v144, s30
  v_min_u32 v145, 1, v0
  v_lshlrev_b32 v145, 30, v145
  buffer_store_dword v144, v145, s[4:7], s31 offen sc1
P_end_131:
  s_mov_b32 s71, 0
  s_branch M_sg_146
M_sw_145:
  s_sleep 8
  s_add_u32 s71, s71, 1
  s_cmp_gt_u32 s71, 262144
  s_cbranch_scc1 M_exit
M_sg_146:
  s_mov_b32 s79, 0
  s_atomic_or s79, s[74:75], 128 glc
  s_waitcnt lgkmcnt(0)
  s_cmp_lt_u32 s79, 256
  s_cbranch_scc1 M_sw_145
  s_cmp_eq_u32 s65, 6
  s_cbranch_scc1 M_follow
  s_mov_b32 s68, 0
  s_mov_b32 s36, -1
  s_mov_b32 s69, s53
  s_mov_b32 s70, s54
  s_load_dwordx2 s[8:9], s[0:1], 40
  s_mul_i32 s76, s64, 6
  s_add_u32 s76, s76, s65
  s_mul_i32 s76, s76, 21888
  v_min_u32 v200, 170, v0
  v_mul_u32_u24 v200, 128, v200
  v_add_u32 v200, s76, v200
  s_waitcnt lgkmcnt(0)
  s_and_b32 s9, s9, 0xffff
  s_mov_b32 s10, 4194304
  s_mov_b32 s11, 0x20000
M_att:
  s_mov_b32 s24, 0xf149f2ca
  s_mov_b32 s29, 0
  v_mov_b32 v6, 0
  v_mov_b32 v7, 0
  s_lshl_b32 s26, s16, 11
  v_add_u32 v3, s26, v2
  v_and_b32 v5, 31, v1
  v_lshrrev_b32 v12, 5, v1
  v_lshlrev_b32 v12, 2, v12
  v_sub_u32 v5, v5, v12
  s_lshl_b32 s26, s64, 19
  s_add_u32 s19, s26, 16777216
  s_add_u32 s20, s26, 33554432
  s_lshl_b32 s27, s69, 2
  s_add_u32 s27, s27, s16
  s_lshl_b32 s27, s27, 14
  s_add_u32 s25, s26, s27
  s_bfe_u32 s78, s70, 0x80000
  s_add_u32 s76, s67, 512
  s_mov_b32 s71, 0
  s_branch M_sg_148
M_sw_147:
  s_sleep 8
  s_add_u32 s71, s71, 1
  s_cmp_gt_u32 s71, 262144
  s_cbranch_scc1 M_exit
M_sg_148:
  s_mov_b32 s79, 0
  s_atomic_or s79, s[72:73], s76 glc
  s_waitcnt lgkmcnt(0)
  s_cmp_lt_u32 s79, s78
  s_cbranch_scc1 M_sw_147
  s_bfe_u32 s78, s70, 0x80008
  s_add_u32 s76, s67, 640
  s_mov_b32 s71, 0
  s_branch M_sg_150
M_sw_149:
  s_sleep 8
  s_add_u32 s71, s71, 1
  s_cmp_gt_u32 s71, 262144
  s_cbranch_scc1 M_exit
M_sg_150:
  s_mov_b32 s79, 0
  s_atomic_or s79, s[72:73], s76 glc
  s_waitcnt lgkmcnt(0)
  s_cmp_lt_u32 s79, s78
  s_cbranch_scc1 M_sw_149
  s_lshl_b32 s27, s69, 16
  s_add_u32 s27, s27, 16384
  s_add_u32 s17, s19, s27
M_kv_151:
  s_cmp_ge_u32 s17, s36
  s_cbranch_scc1 M_kvok_152
  s_mov_b32 s76, 0
  s_mov_b32 s78, 23
  s_mov_b32 s77, 335872
  s_cmp_eq_u32 s68, 1
  s_cmov_b32 s76, 128
  s_cmov_b32 s78, 27
  s_cmov_b32 s77, 114688
  s_cmp_eq_u32 s68, 2
  s_cmov_b32 s76, 768
  s_cmov_b32 s78, 14
  s_cmov_b32 s77, 0
  s_add_u32 s76, s76, s67
  s_mov_b32 s71, 0
  s_branch M_sg_154
M_sw_153:
  s_sleep 8
  s_add_u32 s71, s71, 1
  s_cmp_gt_u32 s71, 262144
  s_cbranch_scc1 M_exit
M_sg_154:
  s_mov_b32 s79, 0
  s_atomic_or s79, s[72:73], s76 glc
  s_waitcnt lgkmcnt(0)
  s_cmp_lt_u32 s79, s78
  s_cbranch_scc1 M_sw_153
  s_add_u32 s36, s77, s19
  s_add_u32 s68, s68, 1
  s_branch M_kv_151
M_kvok_152:
  s_add_u32 s28, s25, 0
  buffer_load_dwordx4 a[128:131], v2, s[4:7], s28 offen offset:0 sc1
  buffer_load_dwordx4 a[132:135], v2, s[4:7], s28 offen offset:1024 sc1
  buffer_load_dwordx4 a[136:139], v2, s[4:7], s28 offen offset:2048 sc1
  buffer_load_dwordx4 a[140:143], v2, s[4:7], s28 offen offset:3072 sc1
  s_add_u32 s28, s25, 4096
  buffer_load_dwordx4 a[144:147], v2, s[4:7], s28 offen offset:0 sc1
  buffer_load_dwordx4 a[148:151], v2, s[4:7], s28 offen offset:1024 sc1
  buffer_load_dwordx4 a[152:155], v2, s[4:7], s28 offen offset:2048 sc1
  buffer_load_dwordx4 a[156:159], v2, s[4:7], s28 offen offset:3072 sc1
  s_add_u32 s28, s25, 8192
  buffer_load_dwordx4 a[160:163], v2, s[4:7], s28 offen offset:0 sc1
  buffer_load_dwordx4 a[164:167], v2, s[4:7], s28 offen offset:1024 sc1
  buffer_load_dwordx4 a[168:171], v2, s[4:7], s28 offen offset:2048 sc1
  buffer_load_dwordx4 a[172:175], v2, s[4:7], s28 offen offset:3072 sc1
  s_add_u32 s28, s25, 12288
  buffer_load_dwordx4 a[176:179], v2, s[4:7], s28 offen offset:0 sc1
  buffer_load_dwordx4 a[180:183], v2, s[4:7], s28 offen offset:1024 sc1
  buffer_load_dwordx4 a[184:187], v2, s[4:7], s28 offen offset:2048 sc1
  buffer_load_dwordx4 a[188:191], v2, s[4:7], s28 offen offset:3072 sc1
A_again_155:
  s_lshl_b32 s27, s69, 16
  s_add_u32 s27, s27, 57344
  s_add_u32 s17, s19, s27
  s_add_u32 s18, s20, s27
  s_lshl_b32 s21, s16, 11
  s_mov_b32 m0, s21
  s_nop 0
  buffer_load_dwordx4 v3, s[4:7], s18 offen offset:0 sc1 lds
  buffer_load_dwordx4 v3, s[4:7], s18 offen offset:1024 sc1 lds
  s_add_u32 m0, s21, 8192
  s_nop 0
  buffer_load_dwordx4 v3, s[4:7], s17 offen offset:0 sc1 lds
  buffer_load_dwordx4 v3, s[4:7], s17 offen offset:1024 sc1 lds
  s_add_u32 s18, s18, 8192
  s_sub_u32 s18, s18, 8192
  s_max_i32 s18, s18, s20
  s_sub_u32 s17, s17, 8192
  s_max_i32 s17, s17, s19
  s_add_u32 s21, s21, 16384
  s_and_b32 s21, s21, 131071
  s_mov_b32 m0, s21
  s_nop 0
  buffer_load_dwordx4 v3, s[4:7], s18 offen offset:0 sc1 lds
  buffer_load_dwordx4 v3, s[4:7], s18 offen offset:1024 sc1 lds
  s_add_u32 m0, s21, 8192
  s_nop 0
  buffer_load_dwordx4 v3, s[4:7], s17 offen offset:0 sc1 lds
  buffer_load_dwordx4 v3, s[4:7], s17 offen offset:1024 sc1 lds
  s_sub_u32 s18, s18, 8192
  s_max_i32 s18, s18, s20
  s_sub_u32 s17, s17, 8192
  s_max_i32 s17, s17, s19
  s_add_u32 s21, s21, 16384
  s_and_b32 s21, s21, 131071
  s_mov_b32 m0, s21
  s_nop 0
  buffer_load_dwordx4 v3, s[4:7], s18 offen offset:0 sc1 lds
  buffer_load_dwordx4 v3, s[4:7], s18 offen offset:1024 sc1 lds
  s_add_u32 m0, s21, 8192
  s_nop 0
  buffer_load_dwordx4 v3, s[4:7], s17 offen offset:0 sc1 lds
  buffer_load_dwordx4 v3, s[4:7], s17 offen offset:1024 sc1 lds
  s_sub_u32 s18, s18, 8192
  s_max_i32 s18, s18, s20
  s_sub_u32 s17, s17, 8192
  s_max_i32 s17, s17, s19
  s_add_u32 s21, s21, 16384
  s_and_b32 s21, s21, 131071
  s_mov_b32 m0, s21
  s_nop 0
  buffer_load_dwordx4 v3, s[4:7], s18 offen offset:0 sc1 lds
  buffer_load_dwordx4 v3, s[4:7], s18 offen offset:1024 sc1 lds
  s_add_u32 m0, s21, 8192
  s_nop 0
  buffer_load_dwordx4 v3, s[4:7], s17 offen offset:0 sc1 lds
  buffer_load_dwordx4 v3, s[4:7], s17 offen offset:1024 sc1 lds
  s_sub_u32 s18, s18, 8192
  s_max_i32 s18, s18, s20
  s_sub_u32 s17, s17, 8192
  s_max_i32 s17, s17, s19
  s_add_u32 s21, s21, 16384
  s_and_b32 s21, s21, 131071
  s_mov_b32 m0, s21
  s_nop 0
  buffer_load_dwordx4 v3, s[4:7], s18 offen offset:0 sc1 lds
  buffer_load_dwordx4 v3, s[4:7], s18 offen offset:1024 sc1 lds
  s_add_u32 m0, s21, 8192
  s_nop 0
  buffer_load_dwordx4 v3, s[4:7], s17 offen offset:0 sc1 lds
  buffer_load_dwordx4 v3, s[4:7], s17 offen offset:1024 sc1 lds
  s_sub_u32 s18, s18, 8192
  s_max_i32 s18, s18, s20
  s_sub_u32 s17, s17, 8192
  s_max_i32 s17, s17, s19
  s_add_u32 s21, s21, 16384
  s_and_b32 s21, s21, 131071
  s_mov_b32 m0, s21
  s_nop 0
  buffer_load_dwordx4 v3, s[4:7], s18 offen offset:0 sc1 lds
  buffer_load_dwordx4 v3, s[4:7], s18 offen offset:1024 sc1 lds
  s_add_u32 m0, s21, 8192
  s_nop 0
  buffer_load_dwordx4 v3, s[4:7], s17 offen offset:0 sc1 lds
  buffer_load_dwordx4 v3, s[4:7], s17 offen offset:1024 sc1 lds
  v_accvgpr_write_b32 a0, 0
  v_accvgpr_write_b32 a1, 0
  v_accvgpr_write_b32 a2, 0
  v_accvgpr_write_b32 a3, 0
  v_accvgpr_write_b32 a4, 0
  v_accvgpr_write_b32 a5, 0
  v_accvgpr_write_b32 a6, 0
  v_accvgpr_write_b32 a7, 0
  v_accvgpr_write_b32 a8, 0
  v_accvgpr_write_b32 a9, 0
  v_accvgpr_write_b32 a10, 0
  v_accvgpr_write_b32 a11, 0
  v_accvgpr_write_b32 a12, 0
  v_accvgpr_write_b32 a13, 0
  v_accvgpr_write_b32 a14, 0
  v_accvgpr_write_b32 a15, 0
  v_accvgpr_write_b32 a16, 0
  v_accvgpr_write_b32 a17, 0
  v_accvgpr_write_b32 a18, 0
  v_accvgpr_write_b32 a19, 0
  v_accvgpr_write_b32 a20, 0
  v_accvgpr_write_b32 a21, 0
  v_accvgpr_write_b32 a22, 0
  v_accvgpr_write_b32 a23, 0
  v_accvgpr_write_b32 a24, 0
  v_accvgpr_write_b32 a25, 0
  v_accvgpr_write_b32 a26, 0
  v_accvgpr_write_b32 a27, 0
  v_accvgpr_write_b32 a28, 0
  v_accvgpr_write_b32 a29, 0
  v_accvgpr_write_b32 a30, 0
  v_accvgpr_write_b32 a31, 0
  v_accvgpr_write_b32 a32, 0
  v_accvgpr_write_b32 a33, 0
  v_accvgpr_write_b32 a34, 0
  v_accvgpr_write_b32 a35, 0
  v_accvgpr_write_b32 a36, 0
  v_accvgpr_write_b32 a37, 0
  v_accvgpr_write_b32 a38, 0
  v_accvgpr_write_b32 a39, 0
  v_accvgpr_write_b32 a40, 0
  v_accvgpr_write_b32 a41, 0
  v_accvgpr_write_b32 a42, 0
  v_accvgpr_write_b32 a43, 0
  v_accvgpr_write_b32 a44, 0
  v_accvgpr_write_b32 a45, 0
  v_accvgpr_write_b32 a46, 0
  v_accvgpr_write_b32 a47, 0
  v_accvgpr_write_b32 a48, 0
  v_accvgpr_write_b32 a49, 0
  v_accvgpr_write_b32 a50, 0
  v_accvgpr_write_b32 a51, 0
  v_accvgpr_write_b32 a52, 0
  v_accvgpr_write_b32 a53, 0
  v_accvgpr_write_b32 a54, 0
  v_accvgpr_write_b32 a55, 0
  v_accvgpr_write_b32 a56, 0
  v_accvgpr_write_b32 a57, 0
  v_accvgpr_write_b32 a58, 0
  v_accvgpr_write_b32 a59, 0
  v_accvgpr_write_b32 a60, 0
  v_accvgpr_write_b32 a61, 0
  v_accvgpr_write_b32 a62, 0
  v_accvgpr_write_b32 a63, 0
  v_accvgpr_write_b32 a64, 0
  v_accvgpr_write_b32 a65, 0
  v_accvgpr_write_b32 a66, 0
  v_accvgpr_write_b32 a67, 0
  v_accvgpr_write_b32 a68, 0
  v_accvgpr_write_b32 a69, 0
  v_accvgpr_write_b32 a70, 0
  v_accvgpr_write_b32 a71, 0
  v_accvgpr_write_b32 a72, 0
  v_accvgpr_write_b32 a73, 0
  v_accvgpr_write_b32 a74, 0
  v_accvgpr_write_b32 a75, 0
  v_accvgpr_write_b32 a76, 0
  v_accvgpr_write_b32 a77, 0
  v_accvgpr_write_b32 a78, 0
  v_accvgpr_write_b32 a79, 0
  v_accvgpr_write_b32 a80, 0
  v_accvgpr_write_b32 a81, 0
  v_accvgpr_write_b32 a82, 0
  v_accvgpr_write_b32 a83, 0
  v_accvgpr_write_b32 a84, 0
  v_accvgpr_write_b32 a85, 0
  v_accvgpr_write_b32 a86, 0
  v_accvgpr_write_b32 a87, 0
  v_accvgpr_write_b32 a88, 0
  v_accvgpr_write_b32 a89, 0
  v_accvgpr_write_b32 a90, 0
  v_accvgpr_write_b32 a91, 0
  v_accvgpr_write_b32 a92, 0
  v_accvgpr_write_b32 a93, 0
  v_accvgpr_write_b32 a94, 0
  v_accvgpr_write_b32 a95, 0
  v_accvgpr_write_b32 a96, 0
  v_accvgpr_write_b32 a97, 0
  v_accvgpr_write_b32 a98, 0
  v_accvgpr_write_b32 a99, 0
  v_accvgpr_write_b32 a100, 0
  v_accvgpr_write_b32 a101, 0
  v_accvgpr_write_b32 a102, 0
  v_accvgpr_write_b32 a103, 0
  v_accvgpr_write_b32 a104, 0
  v_accvgpr_write_b32 a105, 0
  v_accvgpr_write_b32 a106, 0
  v_accvgpr_write_b32 a107, 0
  v_accvgpr_write_b32 a108, 0
  v_accvgpr_write_b32 a109, 0
  v_accvgpr_write_b32 a110, 0
  v_accvgpr_write_b32 a111, 0
  v_accvgpr_write_b32 a112, 0
  v_accvgpr_write_b32 a113, 0
  v_accvgpr_write_b32 a114, 0
  v_accvgpr_write_b32 a115, 0
  v_accvgpr_write_b32 a116, 0
  v_accvgpr_write_b32 a117, 0
  v_accvgpr_write_b32 a118, 0
  v_accvgpr_write_b32 a119, 0
  v_accvgpr_write_b32 a120, 0
  v_accvgpr_write_b32 a121, 0
  v_accvgpr_write_b32 a122, 0
  v_accvgpr_write_b32 a123, 0
  v_accvgpr_write_b32 a124, 0
  v_accvgpr_write_b32 a125, 0
  v_accvgpr_write_b32 a126, 0
  v_accvgpr_write_b32 a127, 0
  v_mov_b32 v8, 0
  v_mov_b32 v9, 0
  v_mov_b32 v10, 0
  v_mov_b32 v11, 0
  v_mov_b32 v52, 0
  v_mov_b32 v53, 0
  v_mov_b32 v54, s24
  v_mov_b32 v55, s24
  v_mov_b32 v56, s24
  v_mov_b32 v57, s24
  v_mov_b32 v58, s24
  v_mov_b32 v59, s24
  v_mov_b32 v60, s24
  v_mov_b32 v61, s24
  v_mov_b32 v62, s24
  v_mov_b32 v63, s24
  v_mov_b32 v104, 0
  v_mov_b32 v105, 0
  v_mov_b32 v4, v2
  v_mov_b32 v64, s24
  v_mov_b32 v65, s24
  v_mov_b32 v66, s24
  v_mov_b32 v67, s24
  v_mov_b32 v68, s24
  v_mov_b32 v69, s24
  v_mov_b32 v70, s24
  v_mov_b32 v71, s24
  v_mov_b32 v72, s24
  v_mov_b32 v73, s24
  v_mov_b32 v74, s24
  v_mov_b32 v75, s24
  v_mov_b32 v76, s24
  v_mov_b32 v77, s24
  v_mov_b32 v78, s24
  v_mov_b32 v79, s24
  v_mov_b32 v12, s24
  v_cmp_le_i32 s[40:41], 0, v5
  v_cmp_le_i32 s[42:43], 1, v5
  v_cmp_le_i32 s[44:45], 2, v5
  v_cmp_le_i32 s[46:47], 3, v5
  v_cndmask_b32 v80, v12, v7, s[40:41]
  v_cndmask_b32 v81, v12, v7, s[42:43]
  v_cndmask_b32 v82, v12, v7, s[44:45]
  v_cndmask_b32 v83, v12, v7, s[46:47]
  v_cmp_le_i32 s[40:41], 8, v5
  v_cmp_le_i32 s[42:43], 9, v5
  v_cmp_le_i32 s[44:45], 10, v5
  v_cmp_le_i32 s[46:47], 11, v5
  v_cndmask_b32 v84, v12, v7, s[40:41]
  v_cndmask_b32 v85, v12, v7, s[42:43]
  v_cndmask_b32 v86, v12, v7, s[44:45]
  v_cndmask_b32 v87, v12, v7, s[46:47]
  v_cmp_le_i32 s[40:41], 16, v5
  v_cmp_le_i32 s[42:43], 17, v5
  v_cmp_le_i32 s[44:45], 18, v5
  v_cmp_le_i32 s[46:47], 19, v5
  v_cndmask_b32 v88, v12, v7, s[40:41]
  v_cndmask_b32 v89, v12, v7, s[42:43]
  v_cndmask_b32 v90, v12, v7, s[44:45]
  v_cndmask_b32 v91, v12, v7, s[46:47]
  v_cmp_le_i32 s[40:41], 24, v5
  v_cmp_le_i32 s[42:43], 25, v5
  v_cmp_le_i32 s[44:45], 26, v5
  v_cmp_le_i32 s[46:47], 27, v5
  v_cndmask_b32 v92, v12, v7, s[40:41]
  v_cndmask_b32 v93, v12, v7, s[42:43]
  v_cndmask_b32 v94, v12, v7, s[44:45]
  v_cndmask_b32 v95, v12, v7, s[46:47]
  s_lshl_b32 s22, s69, 3
  s_add_u32 s22, s22, 8
  s_lshl_b32 s26, s16, 1
  s_sub_u32 s23, 6, s26
  s_waitcnt vmcnt(20)
  s_barrier
  s_cmp_eq_u32 s23, 0
  s_cbranch_scc1 A_go_157
A_idle_156:
  s_waitcnt vmcnt(16)
  s_barrier
  s_sub_u32 s18, s18, 8192
  s_max_i32 s18, s18, s20
  s_sub_u32 s17, s17, 8192
  s_max_i32 s17, s17, s19
  s_add_u32 s21, s21, 16384
  s_and_b32 s21, s21, 131071
M_kv_158:
  s_cmp_ge_u32 s17, s36
  s_cbranch_scc1 M_kvok_159
  s_mov_b32 s76, 0
  s_mov_b32 s78, 23
  s_mov_b32 s77, 335872
  s_cmp_eq_u32 s68, 1
  s_cmov_b32 s76, 128
  s_cmov_b32 s78, 27
  s_cmov_b32 s77, 114688
  s_cmp_eq_u32 s68, 2
  s_cmov_b32 s76, 768
  s_cmov_b32 s78, 14
  s_cmov_b32 s77, 0
  s_add_u32 s76, s76, s67
  s_mov_b32 s71, 0
  s_branch M_sg_161
M_sw_160:
  s_sleep 8
  s_add_u32 s71, s71, 1
  s_cmp_gt_u32 s71, 262144
  s_cbranch_scc1 M_exit
M_sg_161:
  s_mov_b32 s79, 0
  s_atomic_or s79, s[72:73], s76 glc
  s_waitcnt lgkmcnt(0)
  s_cmp_lt_u32 s79, s78
  s_cbranch_scc1 M_sw_160
  s_add_u32 s36, s77, s19
  s_add_u32 s68, s68, 1
  s_branch M_kv_158
M_kvok_159:
  s_mov_b32 m0, s21
  s_nop 0
  buffer_load_dwordx4 v3, s[4:7], s18 offen offset:0 sc1 lds
  buffer_load_dwordx4 v3, s[4:7], s18 offen offset:1024 sc1 lds
  s_add_u32 m0, s21, 8192
  s_nop 0
  buffer_load_dwordx4 v3, s[4:7], s17 offen offset:0 sc1 lds
  buffer_load_dwordx4 v3, s[4:7], s17 offen offset:1024 sc1 lds
  v_add_u32 v4, 16384, v4
  v_and_b32 v4, 131071, v4
  s_sub_u32 s22, s22, 1
  s_sub_u32 s23, s23, 1
  s_cmp_lg_u32 s23, 0
  s_cbranch_scc1 A_idle_156
A_go_157:
  ds_read_b128 a[224:227], v4 offset:0
  ds_read_b128 a[228:231], v4 offset:2048
  ds_read_b128 a[232:235], v4 offset:4096
  ds_read_b128 a[236:239], v4 offset:6144
  ds_read_b128 a[240:243], v4 offset:1024
  ds_read_b128 a[244:247], v4 offset:3072
  ds_read_b128 a[248:251], v4 offset:5120
  ds_read_b128 a[252:255], v4 offset:7168
  ds_read_b128 a[192:195], v4 offset:8192
  ds_read_b128 a[196:199], v4 offset:9216
  ds_read_b128 a[200:203], v4 offset:10240
  ds_read_b128 a[204:207], v4 offset:11264
  ds_read_b128 a[208:211], v4 offset:12288
  ds_read_b128 a[212:215], v4 offset:13312
  ds_read_b128 a[216:219], v4 offset:14336
  ds_read_b128 a[220:223], v4 offset:15360
  v_add_u32 v4, 16384, v4
  v_and_b32 v4, 131071, v4
  s_waitcnt lgkmcnt(8)
.p2align 6
A_top_162:
  s_waitcnt lgkmcnt(7)
  v_mfma_f32_32x32x16_bf16 v[32:47], a[192:195], a[128:131], v[64:79]
  s_waitcnt lgkmcnt(6)
  v_exp_f32 v54, v54
  v_add_f32 v11, v11, v53
  v_cvt_pk_bf16_f32 v106, v52, v53
  v_mfma_f32_32x32x16_bf16 v[32:47], a[196:199], a[132:135], v[32:47]
  s_waitcnt lgkmcnt(4)
  v_exp_f32 v55, v55
  v_add_f32 v10, v10, v54
  v_mfma_f32_32x32x16_bf16 v[32:47], a[200:203], a[136:139], v[32:47]
  v_exp_f32 v56, v56
  v_add_f32 v11, v11, v55
  v_cvt_pk_bf16_f32 v107, v54, v55
  v_mfma_f32_32x32x16_bf16 v[32:47], a[204:207], a[140:143], v[32:47]
  s_waitcnt lgkmcnt(2)
  v_exp_f32 v57, v57
  v_add_f32 v10, v10, v56
  v_mfma_f32_32x32x16_bf16 v[32:47], a[208:211], a[144:147], v[32:47]
  v_exp_f32 v58, v58
  v_add_f32 v11, v11, v57
  v_cvt_pk_bf16_f32 v108, v56, v57
  v_mfma_f32_32x32x16_bf16 v[32:47], a[212:215], a[148:151], v[32:47]
  s_waitcnt lgkmcnt(0)
  v_exp_f32 v59, v59
  v_add_f32 v10, v10, v58
  v_mfma_f32_32x32x16_bf16 v[32:47], a[216:219], a[152:155], v[32:47]
  v_exp_f32 v60, v60
  v_add_f32 v11, v11, v59
  v_cvt_pk_bf16_f32 v109, v58, v59
  v_mfma_f32_32x32x16_bf16 v[32:47], a[220:223], a[156:159], v[32:47]
  s_waitcnt vmcnt(16)
  s_barrier
  v_exp_f32 v61, v61
  v_add_f32 v10, v10, v60
  v_mfma_f32_32x32x16_bf16 a[64:79], a[224:227], v[104:107], a[64:79]
  ds_read_b128 a[224:227], v4 offset:0
  v_exp_f32 v62, v62
  v_add_f32 v11, v11, v61
  v_cvt_pk_bf16_f32 v110, v60, v61
  v_mfma_f32_32x32x16_bf16 a[80:95], a[228:231], v[104:107], a[80:95]
  s_sub_u32 s18, s18, 8192
  ds_read_b128 a[228:231], v4 offset:2048
  v_exp_f32 v63, v63
  v_add_f32 v10, v10, v62
  v_mfma_f32_32x32x16_bf16 a[96:111], a[232:235], v[104:107], a[96:111]
  s_max_i32 s18, s18, s20
  ds_read_b128 a[232:235], v4 offset:4096
  v_exp_f32 v32, v32
  v_add_f32 v11, v11, v63
  v_cvt_pk_bf16_f32 v111, v62, v63
  v_mfma_f32_32x32x16_bf16 a[112:127], a[236:239], v[104:107], a[112:127]
  s_sub_u32 s17, s17, 8192
  ds_read_b128 a[236:239], v4 offset:6144
  v_exp_f32 v33, v33
  v_add_f32 v8, v8, v32
  v_mfma_f32_32x32x16_bf16 a[64:79], a[240:243], v[108:111], a[64:79]
  s_max_i32 s17, s17, s19
  ds_read_b128 a[240:243], v4 offset:1024
  v_exp_f32 v34, v34
  v_add_f32 v9, v9, v33
  v_cvt_pk_bf16_f32 v96, v32, v33
  v_mfma_f32_32x32x16_bf16 a[80:95], a[244:247], v[108:111], a[80:95]
  s_add_u32 s21, s21, 16384
  ds_read_b128 a[244:247], v4 offset:3072
  v_exp_f32 v35, v35
  v_add_f32 v8, v8, v34
  v_mfma_f32_32x32x16_bf16 a[96:111], a[248:251], v[108:111], a[96:111]
  s_and_b32 s21, s21, 131071
  ds_read_b128 a[248:251], v4 offset:5120
  v_exp_f32 v36, v36
  v_add_f32 v9, v9, v35
  v_cvt_pk_bf16_f32 v97, v34, v35
  v_mfma_f32_32x32x16_bf16 a[112:127], a[252:255], v[108:111], a[112:127]
  ds_read_b128 a[252:255], v4 offset:7168
  v_exp_f32 v37, v37
  v_add_f32 v8, v8, v36
  v_mfma_f32_32x32x16_bf16 v[48:63], a[192:195], a[160:163], v[80:95]
  s_add_u32 s23, s23, 1
  ds_read_b128 a[192:195], v4 offset:8192
  v_exp_f32 v38, v38
  v_add_f32 v9, v9, v37
  v_cvt_pk_bf16_f32 v98, v36, v37
  v_mfma_f32_32x32x16_bf16 v[48:63], a[196:199], a[164:167], v[48:63]
  s_sub_u32 s22, s22, 1
  ds_read_b128 a[196:199], v4 offset:9216
  v_exp_f32 v39, v39
  v_add_f32 v8, v8, v38
  v_mfma_f32_32x32x16_bf16 v[48:63], a[200:203], a[168:171], v[48:63]
  s_cmp_lt_u32 s23, 3
  ds_read_b128 a[200:203], v4 offset:10240
  v_exp_f32 v40, v40
  v_add_f32 v9, v9, v39
  v_cvt_pk_bf16_f32 v99, v38, v39
  v_mfma_f32_32x32x16_bf16 v[48:63], a[204:207], a[172:175], v[48:63]
  s_cbranch_scc1 A_upd_163
A_back_164:
  ds_read_b128 a[204:207], v4 offset:11264
  v_exp_f32 v41, v41
  v_add_f32 v8, v8, v40
  v_mfma_f32_32x32x16_bf16 v[48:63], a[208:211], a[176:179], v[48:63]
  s_cmp_lt_u32 s17, s36
  ds_read_b128 a[208:211], v4 offset:12288
  v_exp_f32 v42, v42
  v_add_f32 v9, v9, v41
  v_cvt_pk_bf16_f32 v100, v40, v41
  v_mfma_f32_32x32x16_bf16 v[48:63], a[212:215], a[180:183], v[48:63]
  s_cbranch_scc1 A_kvw_166
A_kvb_167:
  ds_read_b128 a[212:215], v4 offset:13312
  v_exp_f32 v43, v43
  v_add_f32 v8, v8, v42
  v_mfma_f32_32x32x16_bf16 v[48:63], a[216:219], a[184:187], v[48:63]
  s_mov_b32 m0, s21
  ds_read_b128 a[216:219], v4 offset:14336
  v_exp_f32 v44, v44
  v_add_f32 v9, v9, v43
  v_cvt_pk_bf16_f32 v101, v42, v43
  v_mfma_f32_32x32x16_bf16 v[48:63], a[220:223], a[188:191], v[48:63]
  s_waitcnt lgkmcnt(13)
  ds_read_b128 a[220:223], v4 offset:15360
  v_exp_f32 v45, v45
  v_add_f32 v8, v8, v44
  v_mfma_f32_32x32x16_bf16 a[0:15], a[224:227], v[96:99], a[0:15]
  buffer_load_dwordx4 v3, s[4:7], s18 offen offset:0 sc1 lds
  v_exp_f32 v46, v46
  v_add_f32 v9, v9, v45
  v_cvt_pk_bf16_f32 v102, v44, v45
  v_mfma_f32_32x32x16_bf16 a[16:31], a[228:231], v[96:99], a[16:31]
  s_waitcnt lgkmcnt(12)
  v_exp_f32 v47, v47
  v_add_f32 v8, v8, v46
  v_add_u32 v4, 16384, v4
  v_mfma_f32_32x32x16_bf16 a[32:47], a[232:235], v[96:99], a[32:47]
  buffer_load_dwordx4 v3, s[4:7], s18 offen offset:1024 sc1 lds
  v_exp_f32 v48, v48
  v_add_f32 v9, v9, v47
  v_cvt_pk_bf16_f32 v103, v46, v47
  v_mfma_f32_32x32x16_bf16 a[48:63], a[236:239], v[96:99], a[48:63]
  s_waitcnt lgkmcnt(10)
  s_add_u32 m0, s21, 8192
  v_exp_f32 v49, v49
  v_add_f32 v10, v10, v48
  v_and_b32 v4, 131071, v4
  v_mfma_f32_32x32x16_bf16 a[0:15], a[240:243], v[100:103], a[0:15]
  buffer_load_dwordx4 v3, s[4:7], s17 offen offset:0 sc1 lds
  v_exp_f32 v50, v50
  v_add_f32 v11, v11, v49
  v_cvt_pk_bf16_f32 v104, v48, v49
  v_mfma_f32_32x32x16_bf16 a[16:31], a[244:247], v[100:103], a[16:31]
  s_waitcnt lgkmcnt(8)
  s_cmp_lg_u32 s22, 0
  v_exp_f32 v51, v51
  v_add_f32 v10, v10, v50
  v_mfma_f32_32x32x16_bf16 a[32:47], a[248:251], v[100:103], a[32:47]
  buffer_load_dwordx4 v3, s[4:7], s17 offen offset:1024 sc1 lds
  v_exp_f32 v52, v52
  v_add_f32 v11, v11, v51
  v_cvt_pk_bf16_f32 v105, v50, v51
  v_mfma_f32_32x32x16_bf16 a[48:63], a[252:255], v[100:103], a[48:63]
  v_exp_f32 v53, v53
  v_add_f32 v10, v10, v52
  s_cbranch_scc1 A_top_162
  v_exp_f32 v54, v54
  v_add_f32 v11, v11, v53
  v_cvt_pk_bf16_f32 v106, v52, v53
  v_exp_f32 v55, v55
  v_add_f32 v10, v10, v54
  v_exp_f32 v56, v56
  v_add_f32 v11, v11, v55
  v_cvt_pk_bf16_f32 v107, v54, v55
  v_exp_f32 v57, v57
  v_add_f32 v10, v10, v56
  v_exp_f32 v58, v58
  v_add_f32 v11, v11, v57
  v_cvt_pk_bf16_f32 v108, v56, v57
  v_exp_f32 v59, v59
  v_add_f32 v10, v10, v58
  v_exp_f32 v60, v60
  v_add_f32 v11, v11, v59
  v_cvt_pk_bf16_f32 v109, v58, v59
  v_exp_f32 v61, v61
  v_add_f32 v10, v10, v60
  v_exp_f32 v62, v62
  v_add_f32 v11, v11, v61
  v_cvt_pk_bf16_f32 v110, v60, v61
  v_exp_f32 v63, v63
  v_add_f32 v10, v10, v62
  v_add_f32 v11, v11, v63
  v_cvt_pk_bf16_f32 v111, v62, v63
  s_nop 1
  v_mfma_f32_32x32x16_bf16 a[64:79], a[224:227], v[104:107], a[64:79]
  v_mfma_f32_32x32x16_bf16 a[80:95], a[228:231], v[104:107], a[80:95]
  v_mfma_f32_32x32x16_bf16 a[96:111], a[232:235], v[104:107], a[96:111]
  v_mfma_f32_32x32x16_bf16 a[112:127], a[236:239], v[104:107], a[112:127]
  v_mfma_f32_32x32x16_bf16 a[64:79], a[240:243], v[108:111], a[64:79]
  v_mfma_f32_32x32x16_bf16 a[80:95], a[244:247], v[108:111], a[80:95]
  v_mfma_f32_32x32x16_bf16 a[96:111], a[248:251], v[108:111], a[96:111]
  v_mfma_f32_32x32x16_bf16 a[112:127], a[252:255], v[108:111], a[112:127]
  v_add_f32 v8, v8, v9
  v_mov_b32 v9, v8
  s_nop 1
  v_permlane32_swap_b32 v8, v9
  s_nop 1
  v_add_f32 v8, v8, v9
  v_add_f32 v10, v10, v11
  v_mov_b32 v11, v10
  s_nop 1
  v_permlane32_swap_b32 v10, v11
  s_nop 1
  v_add_f32 v10, v10, v11
  v_subrev_u32 v12, 0x2f800000, v8
  v_subrev_u32 v13, 0x2f800000, v10
  v_max_u32 v12, v12, v13
  v_cmp_le_u32 vcc, 0x28000000, v12
  s_nop 1
  s_cmp_lg_u64 vcc, 0
  s_cselect_b32 s26, 1, 0
  v_mov_b32 v12, s26
  s_lshl_b32 s26, s16, 2
  s_add_u32 s26, s26, 131072
  v_mov_b32 v13, s26
  ds_write_b32 v13, v12
  v_mov_b32 v14, 131072
  s_waitcnt vmcnt(0) lgkmcnt(0)
  s_barrier
  ds_read_b128 v[16:19], v14
  v_rcp_f32 v8, v8
  v_rcp_f32 v10, v10
  s_waitcnt lgkmcnt(0)
  v_or3_b32 v12, v16, v17, v18
  v_or_b32 v12, v12, v19
  s_nop 0
  v_readfirstlane_b32 s26, v12
  s_nop 1
  s_cmp_gt_u32 s26, s29
  s_cbranch_scc1 A_slow_168
  s_add_u32 s28, s25, 100663296
  v_accvgpr_read_b32 v112, a0
  v_accvgpr_read_b32 v113, a1
  v_accvgpr_read_b32 v114, a2
  v_accvgpr_read_b32 v115, a3
  v_accvgpr_read_b32 v116, a4
  v_accvgpr_read_b32 v117, a5
  v_accvgpr_read_b32 v118, a6
  v_accvgpr_read_b32 v119, a7
  v_pk_mul_f32 v[112:113], v[112:113], v[8:9] op_sel_hi:[1,0]
  v_pk_mul_f32 v[114:115], v[114:115], v[8:9] op_sel_hi:[1,0]
  v_pk_mul_f32 v[116:117], v[116:117], v[8:9] op_sel_hi:[1,0]
  v_pk_mul_f32 v[118:119], v[118:119], v[8:9] op_sel_hi:[1,0]
  v_cvt_pk_bf16_f32 v120, v112, v113
  v_cvt_pk_bf16_f32 v121, v114, v115
  v_cvt_pk_bf16_f32 v122, v116, v117
  v_cvt_pk_bf16_f32 v123, v118, v119
  buffer_store_dwordx4 v[120:123], v2, s[4:7], s28 offen offset:0 sc1
  v_accvgpr_read_b32 v124, a8
  v_accvgpr_read_b32 v125, a9
  v_accvgpr_read_b32 v126, a10
  v_accvgpr_read_b32 v127, a11
  v_accvgpr_read_b32 v128, a12
  v_accvgpr_read_b32 v129, a13
  v_accvgpr_read_b32 v130, a14
  v_accvgpr_read_b32 v131, a15
  v_pk_mul_f32 v[124:125], v[124:125], v[8:9] op_sel_hi:[1,0]
  v_pk_mul_f32 v[126:127], v[126:127], v[8:9] op_sel_hi:[1,0]
  v_pk_mul_f32 v[128:129], v[128:129], v[8:9] op_sel_hi:[1,0]
  v_pk_mul_f32 v[130:131], v[130:131], v[8:9] op_sel_hi:[1,0]
  v_cvt_pk_bf16_f32 v132, v124, v125
  v_cvt_pk_bf16_f32 v133, v126, v127
  v_cvt_pk_bf16_f32 v134, v128, v129
  v_cvt_pk_bf16_f32 v135, v130, v131
  buffer_store_dwordx4 v[132:135], v2, s[4:7], s28 offen offset:1024 sc1
  v_accvgpr_read_b32 v136, a16
  v_accvgpr_read_b32 v137, a17
  v_accvgpr_read_b32 v138, a18
  v_accvgpr_read_b32 v139, a19
  v_accvgpr_read_b32 v140, a20
  v_accvgpr_read_b32 v141, a21
  v_accvgpr_read_b32 v142, a22
  v_accvgpr_read_b32 v143, a23
  v_pk_mul_f32 v[136:137], v[136:137], v[8:9] op_sel_hi:[1,0]
  v_pk_mul_f32 v[138:139], v[138:139], v[8:9] op_sel_hi:[1,0]
  v_pk_mul_f32 v[140:141], v[140:141], v[8:9] op_sel_hi:[1,0]
  v_pk_mul_f32 v[142:143], v[142:143], v[8:9] op_sel_hi:[1,0]
  v_cvt_pk_bf16_f32 v144, v136, v137
  v_cvt_pk_bf16_f32 v145, v138, v139
  v_cvt_pk_bf16_f32 v146, v140, v141
  v_cvt_pk_bf16_f32 v147, v142, v143
  buffer_store_dwordx4 v[144:147], v2, s[4:7], s28 offen offset:2048 sc1
  v_accvgpr_read_b32 v148, a24
  v_accvgpr_read_b32 v149, a25
  v_accvgpr_read_b32 v150, a26
  v_accvgpr_read_b32 v151, a27
  v_accvgpr_read_b32 v152, a28
  v_accvgpr_read_b32 v153, a29
  v_accvgpr_read_b32 v154, a30
  v_accvgpr_read_b32 v155, a31
  v_pk_mul_f32 v[148:149], v[148:149], v[8:9] op_sel_hi:[1,0]
  v_pk_mul_f32 v[150:151], v[150:151], v[8:9] op_sel_hi:[1,0]
  v_pk_mul_f32 v[152:153], v[152:153], v[8:9] op_sel_hi:[1,0]
  v_pk_mul_f32 v[154:155], v[154:155], v[8:9] op_sel_hi:[1,0]
  v_cvt_pk_bf16_f32 v156, v148, v149
  v_cvt_pk_bf16_f32 v157, v150, v151
  v_cvt_pk_bf16_f32 v158, v152, v153
  v_cvt_pk_bf16_f32 v159, v154, v155
  buffer_store_dwordx4 v[156:159], v2, s[4:7], s28 offen offset:3072 sc1
  s_add_u32 s28, s25, 100667392
  v_accvgpr_read_b32 v112, a32
  v_accvgpr_read_b32 v113, a33
  v_accvgpr_read_b32 v114, a34
  v_accvgpr_read_b32 v115, a35
  v_accvgpr_read_b32 v116, a36
  v_accvgpr_read_b32 v117, a37
  v_accvgpr_read_b32 v118, a38
  v_accvgpr_read_b32 v119, a39
  v_pk_mul_f32 v[112:113], v[112:113], v[8:9] op_sel_hi:[1,0]
  v_pk_mul_f32 v[114:115], v[114:115], v[8:9] op_sel_hi:[1,0]
  v_pk_mul_f32 v[116:117], v[116:117], v[8:9] op_sel_hi:[1,0]
  v_pk_mul_f32 v[118:119], v[118:119], v[8:9] op_sel_hi:[1,0]
  v_cvt_pk_bf16_f32 v120, v112, v113
  v_cvt_pk_bf16_f32 v121, v114, v115
  v_cvt_pk_bf16_f32 v122, v116, v117
  v_cvt_pk_bf16_f32 v123, v118, v119
  buffer_store_dwordx4 v[120:123], v2, s[4:7], s28 offen offset:0 sc1
  v_accvgpr_read_b32 v124, a40
  v_accvgpr_read_b32 v125, a41
  v_accvgpr_read_b32 v126, a42
  v_accvgpr_read_b32 v127, a43
  v_accvgpr_read_b32 v128, a44
  v_accvgpr_read_b32 v129, a45
  v_accvgpr_read_b32 v130, a46
  v_accvgpr_read_b32 v131, a47
  v_pk_mul_f32 v[124:125], v[124:125], v[8:9] op_sel_hi:[1,0]
  v_pk_mul_f32 v[126:127], v[126:127], v[8:9] op_sel_hi:[1,0]
  v_pk_mul_f32 v[128:129], v[128:129], v[8:9] op_sel_hi:[1,0]
  v_pk_mul_f32 v[130:131], v[130:131], v[8:9] op_sel_hi:[1,0]
  v_cvt_pk_bf16_f32 v132, v124, v125
  v_cvt_pk_bf16_f32 v133, v126, v127
  v_cvt_pk_bf16_f32 v134, v128, v129
  v_cvt_pk_bf16_f32 v135, v130, v131
  buffer_store_dwordx4 v[132:135], v2, s[4:7], s28 offen offset:1024 sc1
  v_accvgpr_read_b32 v136, a48
  v_accvgpr_read_b32 v137, a49
  v_accvgpr_read_b32 v138, a50
  v_accvgpr_read_b32 v139, a51
  v_accvgpr_read_b32 v140, a52
  v_accvgpr_read_b32 v141, a53
  v_accvgpr_read_b32 v142, a54
  v_accvgpr_read_b32 v143, a55
  v_pk_mul_f32 v[136:137], v[136:137], v[8:9] op_sel_hi:[1,0]
  v_pk_mul_f32 v[138:139], v[138:139], v[8:9] op_sel_hi:[1,0]
  v_pk_mul_f32 v[140:141], v[140:141], v[8:9] op_sel_hi:[1,0]
  v_pk_mul_f32 v[142:143], v[142:143], v[8:9] op_sel_hi:[1,0]
  v_cvt_pk_bf16_f32 v144, v136, v137
  v_cvt_pk_bf16_f32 v145, v138, v139
  v_cvt_pk_bf16_f32 v146, v140, v141
  v_cvt_pk_bf16_f32 v147, v142, v143
  buffer_store_dwordx4 v[144:147], v2, s[4:7], s28 offen offset:2048 sc1
  v_accvgpr_read_b32 v148, a56
  v_accvgpr_read_b32 v149, a57
  v_accvgpr_read_b32 v150, a58
  v_accvgpr_read_b32 v151, a59
  v_accvgpr_read_b32 v152, a60
  v_accvgpr_read_b32 v153, a61
  v_accvgpr_read_b32 v154, a62
  v_accvgpr_read_b32 v155, a63
  v_pk_mul_f32 v[148:149], v[148:149], v[8:9] op_sel_hi:[1,0]
  v_pk_mul_f32 v[150:151], v[150:151], v[8:9] op_sel_hi:[1,0]
  v_pk_mul_f32 v[152:153], v[152:153], v[8:9] op_sel_hi:[1,0]
  v_pk_mul_f32 v[154:155], v[154:155], v[8:9] op_sel_hi:[1,0]
  v_cvt_pk_bf16_f32 v156, v148, v149
  v_cvt_pk_bf16_f32 v157, v150, v151
  v_cvt_pk_bf16_f32 v158, v152, v153
  v_cvt_pk_bf16_f32 v159, v154, v155
  buffer_store_dwordx4 v[156:159], v2, s[4:7], s28 offen offset:3072 sc1
  s_add_u32 s28, s25, 100671488
  v_accvgpr_read_b32 v112, a64
  v_accvgpr_read_b32 v113, a65
  v_accvgpr_read_b32 v114, a66
  v_accvgpr_read_b32 v115, a67
  v_accvgpr_read_b32 v116, a68
  v_accvgpr_read_b32 v117, a69
  v_accvgpr_read_b32 v118, a70
  v_accvgpr_read_b32 v119, a71
  v_pk_mul_f32 v[112:113], v[112:113], v[10:11] op_sel_hi:[1,0]
  v_pk_mul_f32 v[114:115], v[114:115], v[10:11] op_sel_hi:[1,0]
  v_pk_mul_f32 v[116:117], v[116:117], v[10:11] op_sel_hi:[1,0]
  v_pk_mul_f32 v[118:119], v[118:119], v[10:11] op_sel_hi:[1,0]
  v_cvt_pk_bf16_f32 v120, v112, v113
  v_cvt_pk_bf16_f32 v121, v114, v115
  v_cvt_pk_bf16_f32 v122, v116, v117
  v_cvt_pk_bf16_f32 v123, v118, v119
  buffer_store_dwordx4 v[120:123], v2, s[4:7], s28 offen offset:0 sc1
  v_accvgpr_read_b32 v124, a72
  v_accvgpr_read_b32 v125, a73
  v_accvgpr_read_b32 v126, a74
  v_accvgpr_read_b32 v127, a75
  v_accvgpr_read_b32 v128, a76
  v_accvgpr_read_b32 v129, a77
  v_accvgpr_read_b32 v130, a78
  v_accvgpr_read_b32 v131, a79
  v_pk_mul_f32 v[124:125], v[124:125], v[10:11] op_sel_hi:[1,0]
  v_pk_mul_f32 v[126:127], v[126:127], v[10:11] op_sel_hi:[1,0]
  v_pk_mul_f32 v[128:129], v[128:129], v[10:11] op_sel_hi:[1,0]
  v_pk_mul_f32 v[130:131], v[130:131], v[10:11] op_sel_hi:[1,0]
  v_cvt_pk_bf16_f32 v132, v124, v125
  v_cvt_pk_bf16_f32 v133, v126, v127
  v_cvt_pk_bf16_f32 v134, v128, v129
  v_cvt_pk_bf16_f32 v135, v130, v131
  buffer_store_dwordx4 v[132:135], v2, s[4:7], s28 offen offset:1024 sc1
  v_accvgpr_read_b32 v136, a80
  v_accvgpr_read_b32 v137, a81
  v_accvgpr_read_b32 v138, a82
  v_accvgpr_read_b32 v139, a83
  v_accvgpr_read_b32 v140, a84
  v_accvgpr_read_b32 v141, a85
  v_accvgpr_read_b32 v142, a86
  v_accvgpr_read_b32 v143, a87
  v_pk_mul_f32 v[136:137], v[136:137], v[10:11] op_sel_hi:[1,0]
  v_pk_mul_f32 v[138:139], v[138:139], v[10:11] op_sel_hi:[1,0]
  v_pk_mul_f32 v[140:141], v[140:141], v[10:11] op_sel_hi:[1,0]
  v_pk_mul_f32 v[142:143], v[142:143], v[10:11] op_sel_hi:[1,0]
  v_cvt_pk_bf16_f32 v144, v136, v137
  v_cvt_pk_bf16_f32 v145, v138, v139
  v_cvt_pk_bf16_f32 v146, v140, v141
  v_cvt_pk_bf16_f32 v147, v142, v143
  buffer_store_dwordx4 v[144:147], v2, s[4:7], s28 offen offset:2048 sc1
  v_accvgpr_read_b32 v148, a88
  v_accvgpr_read_b32 v149, a89
  v_accvgpr_read_b32 v150, a90
  v_accvgpr_read_b32 v151, a91
  v_accvgpr_read_b32 v152, a92
  v_accvgpr_read_b32 v153, a93
  v_accvgpr_read_b32 v154, a94
  v_accvgpr_read_b32 v155, a95
  v_pk_mul_f32 v[148:149], v[148:149], v[10:11] op_sel_hi:[1,0]
  v_pk_mul_f32 v[150:151], v[150:151], v[10:11] op_sel_hi:[1,0]
  v_pk_mul_f32 v[152:153], v[152:153], v[10:11] op_sel_hi:[1,0]
  v_pk_mul_f32 v[154:155], v[154:155], v[10:11] op_sel_hi:[1,0]
  v_cvt_pk_bf16_f32 v156, v148, v149
  v_cvt_pk_bf16_f32 v157, v150, v151
  v_cvt_pk_bf16_f32 v158, v152, v153
  v_cvt_pk_bf16_f32 v159, v154, v155
  buffer_store_dwordx4 v[156:159], v2, s[4:7], s28 offen offset:3072 sc1
  s_add_u32 s28, s25, 100675584
  v_accvgpr_read_b32 v112, a96
  v_accvgpr_read_b32 v113, a97
  v_accvgpr_read_b32 v114, a98
  v_accvgpr_read_b32 v115, a99
  v_accvgpr_read_b32 v116, a100
  v_accvgpr_read_b32 v117, a101
  v_accvgpr_read_b32 v118, a102
  v_accvgpr_read_b32 v119, a103
  v_pk_mul_f32 v[112:113], v[112:113], v[10:11] op_sel_hi:[1,0]
  v_pk_mul_f32 v[114:115], v[114:115], v[10:11] op_sel_hi:[1,0]
  v_pk_mul_f32 v[116:117], v[116:117], v[10:11] op_sel_hi:[1,0]
  v_pk_mul_f32 v[118:119], v[118:119], v[10:11] op_sel_hi:[1,0]
  v_cvt_pk_bf16_f32 v120, v112, v113
  v_cvt_pk_bf16_f32 v121, v114, v115
  v_cvt_pk_bf16_f32 v122, v116, v117
  v_cvt_pk_bf16_f32 v123, v118, v119
  buffer_store_dwordx4 v[120:123], v2, s[4:7], s28 offen offset:0 sc1
  v_accvgpr_read_b32 v124, a104
  v_accvgpr_read_b32 v125, a105
  v_accvgpr_read_b32 v126, a106
  v_accvgpr_read_b32 v127, a107
  v_accvgpr_read_b32 v128, a108
  v_accvgpr_read_b32 v129, a109
  v_accvgpr_read_b32 v130, a110
  v_accvgpr_read_b32 v131, a111
  v_pk_mul_f32 v[124:125], v[124:125], v[10:11] op_sel_hi:[1,0]
  v_pk_mul_f32 v[126:127], v[126:127], v[10:11] op_sel_hi:[1,0]
  v_pk_mul_f32 v[128:129], v[128:129], v[10:11] op_sel_hi:[1,0]
  v_pk_mul_f32 v[130:131], v[130:131], v[10:11] op_sel_hi:[1,0]
  v_cvt_pk_bf16_f32 v132, v124, v125
  v_cvt_pk_bf16_f32 v133, v126, v127
  v_cvt_pk_bf16_f32 v134, v128, v129
  v_cvt_pk_bf16_f32 v135, v130, v131
  buffer_store_dwordx4 v[132:135], v2, s[4:7], s28 offen offset:1024 sc1
  v_accvgpr_read_b32 v136, a112
  v_accvgpr_read_b32 v137, a113
  v_accvgpr_read_b32 v138, a114
  v_accvgpr_read_b32 v139, a115
  v_accvgpr_read_b32 v140, a116
  v_accvgpr_read_b32 v141, a117
  v_accvgpr_read_b32 v142, a118
  v_accvgpr_read_b32 v143, a119
  v_pk_mul_f32 v[136:137], v[136:137], v[10:11] op_sel_hi:[1,0]
  v_pk_mul_f32 v[138:139], v[138:139], v[10:11] op_sel_hi:[1,0]
  v_pk_mul_f32 v[140:141], v[140:141], v[10:11] op_sel_hi:[1,0]
  v_pk_mul_f32 v[142:143], v[142:143], v[10:11] op_sel_hi:[1,0]
  v_cvt_pk_bf16_f32 v144, v136, v137
  v_cvt_pk_bf16_f32 v145, v138, v139
  v_cvt_pk_bf16_f32 v146, v140, v141
  v_cvt_pk_bf16_f32 v147, v142, v143
  buffer_store_dwordx4 v[144:147], v2, s[4:7], s28 offen offset:2048 sc1
  v_accvgpr_read_b32 v148, a120
  v_accvgpr_read_b32 v149, a121
  v_accvgpr_read_b32 v150, a122
  v_accvgpr_read_b32 v151, a123
  v_accvgpr_read_b32 v152, a124
  v_accvgpr_read_b32 v153, a125
  v_accvgpr_read_b32 v154, a126
  v_accvgpr_read_b32 v155, a127
  v_pk_mul_f32 v[148:149], v[148:149], v[10:11] op_sel_hi:[1,0]
  v_pk_mul_f32 v[150:151], v[150:151], v[10:11] op_sel_hi:[1,0]
  v_pk_mul_f32 v[152:153], v[152:153], v[10:11] op_sel_hi:[1,0]
  v_pk_mul_f32 v[154:155], v[154:155], v[10:11] op_sel_hi:[1,0]
  v_cvt_pk_bf16_f32 v156, v148, v149
  v_cvt_pk_bf16_f32 v157, v150, v151
  v_cvt_pk_bf16_f32 v158, v152, v153
  v_cvt_pk_bf16_f32 v159, v154, v155
  buffer_store_dwordx4 v[156:159], v2, s[4:7], s28 offen offset:3072 sc1
  s_branch A_out_165
A_kvw_166:
M_kv_169:
  s_cmp_ge_u32 s17, s36
  s_cbranch_scc1 M_kvok_170
  s_mov_b32 s76, 0
  s_mov_b32 s78, 23
  s_mov_b32 s77, 335872
  s_cmp_eq_u32 s68, 1
  s_cmov_b32 s76, 128
  s_cmov_b32 s78, 27
  s_cmov_b32 s77, 114688
  s_cmp_eq_u32 s68, 2
  s_cmov_b32 s76, 768
  s_cmov_b32 s78, 14
  s_cmov_b32 s77, 0
  s_add_u32 s76, s76, s67
  s_mov_b32 s71, 0
  s_branch M_sg_172
M_sw_171:
  s_sleep 8
  s_add_u32 s71, s71, 1
  s_cmp_gt_u32 s71, 262144
  s_cbranch_scc1 M_exit
M_sg_172:
  s_mov_b32 s79, 0
  s_atomic_or s79, s[72:73], s76 glc
  s_waitcnt lgkmcnt(0)
  s_cmp_lt_u32 s79, s78
  s_cbranch_scc1 M_sw_171
  s_add_u32 s36, s77, s19
  s_add_u32 s68, s68, 1
  s_branch M_kv_169
M_kvok_170:
  s_branch A_kvb_167
A_upd_163:
  s_cmp_eq_u32 s23, 2
  s_cbranch_scc1 A_upd2_173
  v_mov_b32 v12, s24
  v_cmp_le_i32 s[40:41], 0, v5
  v_cmp_le_i32 s[42:43], 1, v5
  v_cmp_le_i32 s[44:45], 2, v5
  v_cmp_le_i32 s[46:47], 3, v5
  v_cndmask_b32 v64, v12, v6, s[40:41]
  v_cndmask_b32 v65, v12, v6, s[42:43]
  v_cndmask_b32 v66, v12, v6, s[44:45]
  v_cndmask_b32 v67, v12, v6, s[46:47]
  v_cmp_le_i32 s[40:41], 8, v5
  v_cmp_le_i32 s[42:43], 9, v5
  v_cmp_le_i32 s[44:45], 10, v5
  v_cmp_le_i32 s[46:47], 11, v5
  v_cndmask_b32 v68, v12, v6, s[40:41]
  v_cndmask_b32 v69, v12, v6, s[42:43]
  v_cndmask_b32 v70, v12, v6, s[44:45]
  v_cndmask_b32 v71, v12, v6, s[46:47]
  v_cmp_le_i32 s[40:41], 16, v5
  v_cmp_le_i32 s[42:43], 17, v5
  v_cmp_le_i32 s[44:45], 18, v5
  v_cmp_le_i32 s[46:47], 19, v5
  v_cndmask_b32 v72, v12, v6, s[40:41]
  v_cndmask_b32 v73, v12, v6, s[42:43]
  v_cndmask_b32 v74, v12, v6, s[44:45]
  v_cndmask_b32 v75, v12, v6, s[46:47]
  v_cmp_le_i32 s[40:41], 24, v5
  v_cmp_le_i32 s[42:43], 25, v5
  v_cmp_le_i32 s[44:45], 26, v5
  v_cmp_le_i32 s[46:47], 27, v5
  v_cndmask_b32 v76, v12, v6, s[40:41]
  v_cndmask_b32 v77, v12, v6, s[42:43]
  v_cndmask_b32 v78, v12, v6, s[44:45]
  v_cndmask_b32 v79, v12, v6, s[46:47]
  v_mov_b32 v80, v7
  v_mov_b32 v81, v7
  v_mov_b32 v82, v7
  v_mov_b32 v83, v7
  v_mov_b32 v84, v7
  v_mov_b32 v85, v7
  v_mov_b32 v86, v7
  v_mov_b32 v87, v7
  v_mov_b32 v88, v7
  v_mov_b32 v89, v7
  v_mov_b32 v90, v7
  v_mov_b32 v91, v7
  v_mov_b32 v92, v7
  v_mov_b32 v93, v7
  v_mov_b32 v94, v7
  v_mov_b32 v95, v7
  s_branch A_back_164
A_upd2_173:
  v_mov_b32 v64, v6
  v_mov_b32 v65, v6
  v_mov_b32 v66, v6
  v_mov_b32 v67, v6
  v_mov_b32 v68, v6
  v_mov_b32 v69, v6
  v_mov_b32 v70, v6
  v_mov_b32 v71, v6
  v_mov_b32 v72, v6
  v_mov_b32 v73, v6
  v_mov_b32 v74, v6
  v_mov_b32 v75, v6
  v_mov_b32 v76, v6
  v_mov_b32 v77, v6
  v_mov_b32 v78, v6
  v_mov_b32 v79, v6
  s_branch A_back_164
A_slow_168:
  s_mov_b32 s29, 1
  v_mov_b32 v64, s24
  v_mov_b32 v65, s24
  v_mov_b32 v66, s24
  v_mov_b32 v67, s24
  v_mov_b32 v68, s24
  v_mov_b32 v69, s24
  v_mov_b32 v70, s24
  v_mov_b32 v71, s24
  v_mov_b32 v72, s24
  v_mov_b32 v73, s24
  v_mov_b32 v74, s24
  v_mov_b32 v75, s24
  v_mov_b32 v76, s24
  v_mov_b32 v77, s24
  v_mov_b32 v78, s24
  v_mov_b32 v79, s24
  v_mov_b32 v12, s24
  v_cmp_le_i32 s[40:41], 0, v5
  v_cmp_le_i32 s[42:43], 1, v5
  v_cmp_le_i32 s[44:45], 2, v5
  v_cmp_le_i32 s[46:47], 3, v5
  v_cndmask_b32 v80, v12, v7, s[40:41]
  v_cndmask_b32 v81, v12, v7, s[42:43]
  v_cndmask_b32 v82, v12, v7, s[44:45]
  v_cndmask_b32 v83, v12, v7, s[46:47]
  v_cmp_le_i32 s[40:41], 8, v5
  v_cmp_le_i32 s[42:43], 9, v5
  v_cmp_le_i32 s[44:45], 10, v5
  v_cmp_le_i32 s[46:47], 11, v5
  v_cndmask_b32 v84, v12, v7, s[40:41]
  v_cndmask_b32 v85, v12, v7, s[42:43]
  v_cndmask_b32 v86, v12, v7, s[44:45]
  v_cndmask_b32 v87, v12, v7, s[46:47]
  v_cmp_le_i32 s[40:41], 16, v5
  v_cmp_le_i32 s[42:43], 17, v5
  v_cmp_le_i32 s[44:45], 18, v5
  v_cmp_le_i32 s[46:47], 19, v5
  v_cndmask_b32 v88, v12, v7, s[40:41]
  v_cndmask_b32 v89, v12, v7, s[42:43]
  v_cndmask_b32 v90, v12, v7, s[44:45]
  v_cndmask_b32 v91, v12, v7, s[46:47]
  v_cmp_le_i32 s[40:41], 24, v5
  v_cmp_le_i32 s[42:43], 25, v5
  v_cmp_le_i32 s[44:45], 26, v5
  v_cmp_le_i32 s[46:47], 27, v5
  v_cndmask_b32 v92, v12, v7, s[40:41]
  v_cndmask_b32 v93, v12, v7, s[42:43]
  v_cndmask_b32 v94, v12, v7, s[44:45]
  v_cndmask_b32 v95, v12, v7, s[46:47]
  v_mov_b32 v8, s24
  v_mov_b32 v10, s24
  s_add_u32 s17, s25, 16785408
  s_mov_b32 s23, 0
A_ml_174:
  s_add_u32 s28, s17, 4096
  buffer_load_dwordx4 a[192:195], v2, s[4:7], s17 offen offset:0 sc1
  buffer_load_dwordx4 a[196:199], v2, s[4:7], s17 offen offset:1024 sc1
  buffer_load_dwordx4 a[200:203], v2, s[4:7], s17 offen offset:2048 sc1
  buffer_load_dwordx4 a[204:207], v2, s[4:7], s17 offen offset:3072 sc1
  buffer_load_dwordx4 a[208:211], v2, s[4:7], s28 offen offset:0 sc1
  buffer_load_dwordx4 a[212:215], v2, s[4:7], s28 offen offset:1024 sc1
  buffer_load_dwordx4 a[216:219], v2, s[4:7], s28 offen offset:2048 sc1
  buffer_load_dwordx4 a[220:223], v2, s[4:7], s28 offen offset:3072 sc1
  s_waitcnt vmcnt(0)
  v_mfma_f32_32x32x16_bf16 v[32:47], a[192:195], a[128:131], v[64:79]
  v_mfma_f32_32x32x16_bf16 v[32:47], a[196:199], a[132:135], v[32:47]
  v_mfma_f32_32x32x16_bf16 v[32:47], a[200:203], a[136:139], v[32:47]
  v_mfma_f32_32x32x16_bf16 v[32:47], a[204:207], a[140:143], v[32:47]
  v_mfma_f32_32x32x16_bf16 v[32:47], a[208:211], a[144:147], v[32:47]
  v_mfma_f32_32x32x16_bf16 v[32:47], a[212:215], a[148:151], v[32:47]
  v_mfma_f32_32x32x16_bf16 v[32:47], a[216:219], a[152:155], v[32:47]
  v_mfma_f32_32x32x16_bf16 v[32:47], a[220:223], a[156:159], v[32:47]
  v_mfma_f32_32x32x16_bf16 v[48:63], a[192:195], a[160:163], v[80:95]
  v_mfma_f32_32x32x16_bf16 v[48:63], a[196:199], a[164:167], v[48:63]
  v_mfma_f32_32x32x16_bf16 v[48:63], a[200:203], a[168:171], v[48:63]
  v_mfma_f32_32x32x16_bf16 v[48:63], a[204:207], a[172:175], v[48:63]
  v_mfma_f32_32x32x16_bf16 v[48:63], a[208:211], a[176:179], v[48:63]
  v_mfma_f32_32x32x16_bf16 v[48:63], a[212:215], a[180:183], v[48:63]
  v_mfma_f32_32x32x16_bf16 v[48:63], a[216:219], a[184:187], v[48:63]
  v_mfma_f32_32x32x16_bf16 v[48:63], a[220:223], a[188:191], v[48:63]
  s_nop 7
  s_nop 3
  v_max3_f32 v8, v8, v32, v33
  v_max3_f32 v8, v8, v34, v35
  v_max3_f32 v8, v8, v36, v37
  v_max3_f32 v8, v8, v38, v39
  v_max3_f32 v8, v8, v40, v41
  v_max3_f32 v8, v8, v42, v43
  v_max3_f32 v8, v8, v44, v45
  v_max3_f32 v8, v8, v46, v47
  v_max3_f32 v10, v10, v48, v49
  v_max3_f32 v10, v10, v50, v51
  v_max3_f32 v10, v10, v52, v53
  v_max3_f32 v10, v10, v54, v55
  v_max3_f32 v10, v10, v56, v57
  v_max3_f32 v10, v10, v58, v59
  v_max3_f32 v10, v10, v60, v61
  v_max3_f32 v10, v10, v62, v63
  s_add_u32 s23, s23, 1
  s_cmp_lg_u32 s23, 1
  s_cbranch_scc1 A_m2_175
  v_mov_b32 v12, s24
  v_cmp_le_i32 s[40:41], 0, v5
  v_cmp_le_i32 s[42:43], 1, v5
  v_cmp_le_i32 s[44:45], 2, v5
  v_cmp_le_i32 s[46:47], 3, v5
  v_cndmask_b32 v64, v12, v6, s[40:41]
  v_cndmask_b32 v65, v12, v6, s[42:43]
  v_cndmask_b32 v66, v12, v6, s[44:45]
  v_cndmask_b32 v67, v12, v6, s[46:47]
  v_cmp_le_i32 s[40:41], 8, v5
  v_cmp_le_i32 s[42:43], 9, v5
  v_cmp_le_i32 s[44:45], 10, v5
  v_cmp_le_i32 s[46:47], 11, v5
  v_cndmask_b32 v68, v12, v6, s[40:41]
  v_cndmask_b32 v69, v12, v6, s[42:43]
  v_cndmask_b32 v70, v12, v6, s[44:45]
  v_cndmask_b32 v71, v12, v6, s[46:47]
  v_cmp_le_i32 s[40:41], 16, v5
  v_cmp_le_i32 s[42:43], 17, v5
  v_cmp_le_i32 s[44:45], 18, v5
  v_cmp_le_i32 s[46:47], 19, v5
  v_cndmask_b32 v72, v12, v6, s[40:41]
  v_cndmask_b32 v73, v12, v6, s[42:43]
  v_cndmask_b32 v74, v12, v6, s[44:45]
  v_cndmask_b32 v75, v12, v6, s[46:47]
  v_cmp_le_i32 s[40:41], 24, v5
  v_cmp_le_i32 s[42:43], 25, v5
  v_cmp_le_i32 s[44:45], 26, v5
  v_cmp_le_i32 s[46:47], 27, v5
  v_cndmask_b32 v76, v12, v6, s[40:41]
  v_cndmask_b32 v77, v12, v6, s[42:43]
  v_cndmask_b32 v78, v12, v6, s[44:45]
  v_cndmask_b32 v79, v12, v6, s[46:47]
  v_mov_b32 v80, v7
  v_mov_b32 v81, v7
  v_mov_b32 v82, v7
  v_mov_b32 v83, v7
  v_mov_b32 v84, v7
  v_mov_b32 v85, v7
  v_mov_b32 v86, v7
  v_mov_b32 v87, v7
  v_mov_b32 v88, v7
  v_mov_b32 v89, v7
  v_mov_b32 v90, v7
  v_mov_b32 v91, v7
  v_mov_b32 v92, v7
  v_mov_b32 v93, v7
  v_mov_b32 v94, v7
  v_mov_b32 v95, v7
A_m2_175:
  s_cmp_lg_u32 s23, 2
  s_cbranch_scc1 A_m3_176
  v_mov_b32 v64, v6
  v_mov_b32 v65, v6
  v_mov_b32 v66, v6
  v_mov_b32 v67, v6
  v_mov_b32 v68, v6
  v_mov_b32 v69, v6
  v_mov_b32 v70, v6
  v_mov_b32 v71, v6
  v_mov_b32 v72, v6
  v_mov_b32 v73, v6
  v_mov_b32 v74, v6
  v_mov_b32 v75, v6
  v_mov_b32 v76, v6
  v_mov_b32 v77, v6
  v_mov_b32 v78, v6
  v_mov_b32 v79, v6
A_m3_176:
  s_sub_u32 s17, s17, 8192
  s_cmp_ge_i32 s17, s19
  s_cbranch_scc1 A_ml_174
  v_mov_b32 v9, v8
  s_nop 1
  v_permlane32_swap_b32 v8, v9
  s_nop 1
  v_max_f32 v8, v8, v9
  v_sub_f32 v6, 0, v8
  v_mov_b32 v11, v10
  s_nop 1
  v_permlane32_swap_b32 v10, v11
  s_nop 1
  v_max_f32 v10, v10, v11
  v_sub_f32 v7, 0, v10
  s_branch A_again_155
A_out_165:
  s_mov_b32 s69, s55
  s_mov_b32 s70, s56
  s_sub_u32 s52, s52, 1
  s_cmp_lg_u32 s52, 0
  s_cbranch_scc1 M_att
  s_waitcnt vmcnt(0)
  s_barrier
  s_mov_b32 s30, 512
  v_mov_b32 v144, s30
  v_min_u32 v145, 1, v0
  v_lshlrev_b32 v145, 30, v145
  buffer_store_dword v144, v145, s[4:7], s31 offen sc1
  s_lshr_b32 s48, s64, 2
  s_bfe_u32 s49, s64, 0x10001
  s_and_b32 s50, s64, 1
  s_mul_i32 s50, s50, 6
  s_add_u32 s50, s50, s65
  s_mov_b32 s51, 12
  s_cmp_lt_u32 s50, 4
  s_cselect_b32 s23, 6, 5
  s_load_dwordx2 s[8:9], s[0:1], 40
  s_lshl_b32 s17, s48, 19
  s_lshl_b32 s26, s49, 2
  s_add_u32 s26, s26, s16
  s_lshl_b32 s27, s26, 7
  s_add_u32 s17, s17, s27
  s_mov_b32 s18, 1024
  s_lshl_b32 s21, s48, 6
  s_add_u32 s21, s21, s50
  s_lshl_b32 s21, s21, 3
  s_add_u32 s21, s21, s26
  s_lshl_b32 s21, s21, 12
  s_add_u32 s21, s21, 150994944
  s_lshl_b32 s22, s51, 15
  s_mov_b32 s24, 1.0
  s_waitcnt lgkmcnt(0)
  s_and_b32 s9, s9, 0xffff
  s_mov_b32 s10, 4194304
  s_mov_b32 s11, 0x20000
  s_mov_b32 s12, s4
  s_mov_b32 s13, s5
  s_mov_b32 s14, 268435456
  s_mov_b32 s15, 0x20000
  s_lshl_b32 s19, s48, 8
  s_add_u32 s19, s19, s50
  s_lshl_b32 s19, s19, 13
  s_add_u32 s19, s19, 100663296
  s_lshl_b32 s20, s51, 13
  v_lshrrev_b32 v144, 4, v1
  v_and_b32 v56, 0xff, v2
  v_lshl_add_u32 v56, v144, 9, v56
  s_mul_i32 s26, s16, 524288
  v_add_u32 v8, 0, v56
  v_add_u32 v16, 0, v2
  v_add_u32 v16, s26, v16
  v_add_u32 v9, 256, v56
  v_add_u32 v17, 1024, v2
  v_add_u32 v17, s26, v17
  v_add_u32 v10, 2048, v56
  v_add_u32 v18, 2048, v2
  v_add_u32 v18, s26, v18
  v_add_u32 v11, 2304, v56
  v_add_u32 v19, 3072, v2
  v_add_u32 v19, s26, v19
  v_add_u32 v12, 4096, v56
  v_add_u32 v20, 4096, v2
  v_add_u32 v20, s26, v20
  v_add_u32 v13, 4352, v56
  v_add_u32 v21, 5120, v2
  v_add_u32 v21, s26, v21
  v_add_u32 v14, 6144, v56
  v_add_u32 v22, 6144, v2
  v_add_u32 v22, s26, v22
  v_add_u32 v15, 6400, v56
  v_add_u32 v23, 7168, v2
  v_add_u32 v23, s26, v23
  v_lshrrev_b32 v144, 3, v1
  v_mul_lo_u32 v144, v144, s18
  v_and_b32 v145, 7, v1
  v_lshl_add_u32 v144, v145, 4, v144
  s_lshl_b32 s28, s16, 15
  s_add_u32 s28, s28, 32768
  s_lshl_b32 s29, s18, 3
  s_add_u32 m0, s28, 0
  s_nop 0
  buffer_load_dwordx4 v144, s[8:11], s17 offen lds
  s_add_u32 s17, s17, s29
  s_add_u32 m0, s28, 1024
  s_nop 0
  buffer_load_dwordx4 v144, s[8:11], s17 offen lds
  s_add_u32 s17, s17, s29
  s_add_u32 m0, s28, 2048
  s_nop 0
  buffer_load_dwordx4 v144, s[8:11], s17 offen lds
  s_add_u32 s17, s17, s29
  s_add_u32 m0, s28, 3072
  s_nop 0
  buffer_load_dwordx4 v144, s[8:11], s17 offen lds
  s_add_u32 s17, s17, s29
  s_add_u32 m0, s28, 4096
  s_nop 0
  buffer_load_dwordx4 v144, s[8:11], s17 offen lds
  s_add_u32 s17, s17, s29
  s_add_u32 m0, s28, 5120
  s_nop 0
  buffer_load_dwordx4 v144, s[8:11], s17 offen lds
  s_add_u32 s17, s17, s29
  s_add_u32 m0, s28, 6144
  s_nop 0
  buffer_load_dwordx4 v144, s[8:11], s17 offen lds
  s_add_u32 s17, s17, s29
  s_add_u32 m0, s28, 7168
  s_nop 0
  buffer_load_dwordx4 v144, s[8:11], s17 offen lds
  s_add_u32 s17, s17, s29
  s_add_u32 m0, s28, 8192
  s_nop 0
  buffer_load_dwordx4 v144, s[8:11], s17 offen lds
  s_add_u32 s17, s17, s29
  s_add_u32 m0, s28, 9216
  s_nop 0
  buffer_load_dwordx4 v144, s[8:11], s17 offen lds
  s_add_u32 s17, s17, s29
  s_add_u32 m0, s28, 10240
  s_nop 0
  buffer_load_dwordx4 v144, s[8:11], s17 offen lds
  s_add_u32 s17, s17, s29
  s_add_u32 m0, s28, 11264
  s_nop 0
  buffer_load_dwordx4 v144, s[8:11], s17 offen lds
  s_add_u32 s17, s17, s29
  s_add_u32 m0, s28, 12288
  s_nop 0
  buffer_load_dwordx4 v144, s[8:11], s17 offen lds
  s_add_u32 s17, s17, s29
  s_add_u32 m0, s28, 13312
  s_nop 0
  buffer_load_dwordx4 v144, s[8:11], s17 offen lds
  s_add_u32 s17, s17, s29
  s_add_u32 m0, s28, 14336
  s_nop 0
  buffer_load_dwordx4 v144, s[8:11], s17 offen lds
  s_add_u32 s17, s17, s29
  s_add_u32 m0, s28, 15360
  s_nop 0
  buffer_load_dwordx4 v144, s[8:11], s17 offen lds
  s_add_u32 s17, s17, s29
  s_add_u32 m0, s28, 16384
  s_nop 0
  buffer_load_dwordx4 v144, s[8:11], s17 offen lds
  s_add_u32 s17, s17, s29
  s_add_u32 m0, s28, 17408
  s_nop 0
  buffer_load_dwordx4 v144, s[8:11], s17 offen lds
  s_add_u32 s17, s17, s29
  s_add_u32 m0, s28, 18432
  s_nop 0
  buffer_load_dwordx4 v144, s[8:11], s17 offen lds
  s_add_u32 s17, s17, s29
  s_add_u32 m0, s28, 19456
  s_nop 0
  buffer_load_dwordx4 v144, s[8:11], s17 offen lds
  s_add_u32 s17, s17, s29
  s_add_u32 m0, s28, 20480
  s_nop 0
  buffer_load_dwordx4 v144, s[8:11], s17 offen lds
  s_add_u32 s17, s17, s29
  s_add_u32 m0, s28, 21504
  s_nop 0
  buffer_load_dwordx4 v144, s[8:11], s17 offen lds
  s_add_u32 s17, s17, s29
  s_add_u32 m0, s28, 22528
  s_nop 0
  buffer_load_dwordx4 v144, s[8:11], s17 offen lds
  s_add_u32 s17, s17, s29
  s_add_u32 m0, s28, 23552
  s_nop 0
  buffer_load_dwordx4 v144, s[8:11], s17 offen lds
  s_add_u32 s17, s17, s29
  s_add_u32 m0, s28, 24576
  s_nop 0
  buffer_load_dwordx4 v144, s[8:11], s17 offen lds
  s_add_u32 s17, s17, s29
  s_add_u32 m0, s28, 25600
  s_nop 0
  buffer_load_dwordx4 v144, s[8:11], s17 offen lds
  s_add_u32 s17, s17, s29
  s_add_u32 m0, s28, 26624
  s_nop 0
  buffer_load_dwordx4 v144, s[8:11], s17 offen lds
  s_add_u32 s17, s17, s29
  s_add_u32 m0, s28, 27648
  s_nop 0
  buffer_load_dwordx4 v144, s[8:11], s17 offen lds
  s_add_u32 s17, s17, s29
  s_add_u32 m0, s28, 28672
  s_nop 0
  buffer_load_dwordx4 v144, s[8:11], s17 offen lds
  s_add_u32 s17, s17, s29
  s_add_u32 m0, s28, 29696
  s_nop 0
  buffer_load_dwordx4 v144, s[8:11], s17 offen lds
  s_add_u32 s17, s17, s29
  s_add_u32 m0, s28, 30720
  s_nop 0
  buffer_load_dwordx4 v144, s[8:11], s17 offen lds
  s_add_u32 s17, s17, s29
  s_add_u32 m0, s28, 31744
  s_nop 0
  buffer_load_dwordx4 v144, s[8:11], s17 offen lds
  s_add_u32 s17, s17, s29
  v_bfe_u32 v148, v1, 2, 2
  v_lshrrev_b32 v149, 5, v1
  v_lshl_add_u32 v148, v149, 4, v148
  v_bfe_u32 v149, v1, 4, 1
  v_lshl_add_u32 v148, v149, 2, v148
  v_and_b32 v149, 3, v1
  v_lshlrev_b32 v149, 4, v149
  s_mov_b32 s26, 8
  v_lshl_add_u32 v148, v148, 7, v149
  v_add_u32 v152, s28, v148
  v_add_u32 v153, 1024, v152
  v_add_u32 v154, s26, v152
  v_add_u32 v155, s26, v153
  s_waitcnt vmcnt(28)
  ds_read_b64_tr_b16 a[0:1], v152 offset:0
  ds_read_b64_tr_b16 a[2:3], v153 offset:0
  ds_read_b64_tr_b16 a[4:5], v154 offset:0
  ds_read_b64_tr_b16 a[6:7], v155 offset:0
  ds_read_b64_tr_b16 a[8:9], v152 offset:64
  ds_read_b64_tr_b16 a[10:11], v153 offset:64
  ds_read_b64_tr_b16 a[12:13], v154 offset:64
  ds_read_b64_tr_b16 a[14:15], v155 offset:64
  s_waitcnt lgkmcnt(0)
  s_add_u32 m0, s28, 0
  s_nop 0
  buffer_load_dwordx4 v144, s[8:11], s17 offen lds
  s_add_u32 s17, s17, s29
  s_add_u32 m0, s28, 1024
  s_nop 0
  buffer_load_dwordx4 v144, s[8:11], s17 offen lds
  s_add_u32 s17, s17, s29
  s_add_u32 m0, s28, 2048
  s_nop 0
  buffer_load_dwordx4 v144, s[8:11], s17 offen lds
  s_add_u32 s17, s17, s29
  s_add_u32 m0, s28, 3072
  s_nop 0
  buffer_load_dwordx4 v144, s[8:11], s17 offen lds
  s_add_u32 s17, s17, s29
  s_waitcnt vmcnt(28)
  ds_read_b64_tr_b16 a[16:17], v152 offset:4096
  ds_read_b64_tr_b16 a[18:19], v153 offset:4096
  ds_read_b64_tr_b16 a[20:21], v154 offset:4096
  ds_read_b64_tr_b16 a[22:23], v155 offset:4096
  ds_read_b64_tr_b16 a[24:25], v152 offset:4160
  ds_read_b64_tr_b16 a[26:27], v153 offset:4160
  ds_read_b64_tr_b16 a[28:29], v154 offset:4160
  ds_read_b64_tr_b16 a[30:31], v155 offset:4160
  s_waitcnt lgkmcnt(0)
  s_add_u32 m0, s28, 4096
  s_nop 0
  buffer_load_dwordx4 v144, s[8:11], s17 offen lds
  s_add_u32 s17, s17, s29
  s_add_u32 m0, s28, 5120
  s_nop 0
  buffer_load_dwordx4 v144, s[8:11], s17 offen lds
  s_add_u32 s17, s17, s29
  s_add_u32 m0, s28, 6144
  s_nop 0
  buffer_load_dwordx4 v144, s[8:11], s17 offen lds
  s_add_u32 s17, s17, s29
  s_add_u32 m0, s28, 7168
  s_nop 0
  buffer_load_dwordx4 v144, s[8:11], s17 offen lds
  s_add_u32 s17, s17, s29
  s_waitcnt vmcnt(28)
  ds_read_b64_tr_b16 a[32:33], v152 offset:8192
  ds_read_b64_tr_b16 a[34:35], v153 offset:8192
  ds_read_b64_tr_b16 a[36:37], v154 offset:8192
  ds_read_b64_tr_b16 a[38:39], v155 offset:8192
  ds_read_b64_tr_b16 a[40:41], v152 offset:8256
  ds_read_b64_tr_b16 a[42:43], v153 offset:8256
  ds_read_b64_tr_b16 a[44:45], v154 offset:8256
  ds_read_b64_tr_b16 a[46:47], v155 offset:8256
  s_waitcnt lgkmcnt(0)
  s_add_u32 m0, s28, 8192
  s_nop 0
  buffer_load_dwordx4 v144, s[8:11], s17 offen lds
  s_add_u32 s17, s17, s29
  s_add_u32 m0, s28, 9216
  s_nop 0
  buffer_load_dwordx4 v144, s[8:11], s17 offen lds
  s_add_u32 s17, s17, s29
  s_add_u32 m0, s28, 10240
  s_nop 0
  buffer_load_dwordx4 v144, s[8:11], s17 offen lds
  s_add_u32 s17, s17, s29
  s_add_u32 m0, s28, 11264
  s_nop 0
  buffer_load_dwordx4 v144, s[8:11], s17 offen lds
  s_add_u32 s17, s17, s29
  s_waitcnt vmcnt(28)
  ds_read_b64_tr_b16 a[48:49], v152 offset:12288
  ds_read_b64_tr_b16 a[50:51], v153 offset:12288
  ds_read_b64_tr_b16 a[52:53], v154 offset:12288
  ds_read_b64_tr_b16 a[54:55], v155 offset:12288
  ds_read_b64_tr_b16 a[56:57], v152 offset:12352
  ds_read_b64_tr_b16 a[58:59], v153 offset:12352
  ds_read_b64_tr_b16 a[60:61], v154 offset:12352
  ds_read_b64_tr_b16 a[62:63], v155 offset:12352
  s_waitcnt lgkmcnt(0)
  s_add_u32 m0, s28, 12288
  s_nop 0
  buffer_load_dwordx4 v144, s[8:11], s17 offen lds
  s_add_u32 s17, s17, s29
  s_add_u32 m0, s28, 13312
  s_nop 0
  buffer_load_dwordx4 v144, s[8:11], s17 offen lds
  s_add_u32 s17, s17, s29
  s_add_u32 m0, s28, 14336
  s_nop 0
  buffer_load_dwordx4 v144, s[8:11], s17 offen lds
  s_add_u32 s17, s17, s29
  s_add_u32 m0, s28, 15360
  s_nop 0
  buffer_load_dwordx4 v144, s[8:11], s17 offen lds
  s_add_u32 s17, s17, s29
  s_waitcnt vmcnt(28)
  ds_read_b64_tr_b16 a[64:65], v152 offset:16384
  ds_read_b64_tr_b16 a[66:67], v153 offset:16384
  ds_read_b64_tr_b16 a[68:69], v154 offset:16384
  ds_read_b64_tr_b16 a[70:71], v155 offset:16384
  ds_read_b64_tr_b16 a[72:73], v152 offset:16448
  ds_read_b64_tr_b16 a[74:75], v153 offset:16448
  ds_read_b64_tr_b16 a[76:77], v154 offset:16448
  ds_read_b64_tr_b16 a[78:79], v155 offset:16448
  s_waitcnt lgkmcnt(0)
  s_add_u32 m0, s28, 16384
  s_nop 0
  buffer_load_dwordx4 v144, s[8:11], s17 offen lds
  s_add_u32 s17, s17, s29
  s_add_u32 m0, s28, 17408
  s_nop 0
  buffer_load_dwordx4 v144, s[8:11], s17 offen lds
  s_add_u32 s17, s17, s29
  s_add_u32 m0, s28, 18432
  s_nop 0
  buffer_load_dwordx4 v144, s[8:11], s17 offen lds
  s_add_u32 s17, s17, s29
  s_add_u32 m0, s28, 19456
  s_nop 0
  buffer_load_dwordx4 v144, s[8:11], s17 offen lds
  s_add_u32 s17, s17, s29
  s_waitcnt vmcnt(28)
  ds_read_b64_tr_b16 a[80:81], v152 offset:20480
  ds_read_b64_tr_b16 a[82:83], v153 offset:20480
  ds_read_b64_tr_b16 a[84:85], v154 offset:20480
  ds_read_b64_tr_b16 a[86:87], v155 offset:20480
  ds_read_b64_tr_b16 a[88:89], v152 offset:20544
  ds_read_b64_tr_b16 a[90:91], v153 offset:20544
  ds_read_b64_tr_b16 a[92:93], v154 offset:20544
  ds_read_b64_tr_b16 a[94:95], v155 offset:20544
  s_waitcnt lgkmcnt(0)
  s_add_u32 m0, s28, 20480
  s_nop 0
  buffer_load_dwordx4 v144, s[8:11], s17 offen lds
  s_add_u32 s17, s17, s29
  s_add_u32 m0, s28, 21504
  s_nop 0
  buffer_load_dwordx4 v144, s[8:11], s17 offen lds
  s_add_u32 s17, s17, s29
  s_add_u32 m0, s28, 22528
  s_nop 0
  buffer_load_dwordx4 v144, s[8:11], s17 offen lds
  s_add_u32 s17, s17, s29
  s_add_u32 m0, s28, 23552
  s_nop 0
  buffer_load_dwordx4 v144, s[8:11], s17 offen lds
  s_add_u32 s17, s17, s29
  s_waitcnt vmcnt(28)
  ds_read_b64_tr_b16 a[96:97], v152 offset:24576
  ds_read_b64_tr_b16 a[98:99], v153 offset:24576
  ds_read_b64_tr_b16 a[100:101], v154 offset:24576
  ds_read_b64_tr_b16 a[102:103], v155 offset:24576
  ds_read_b64_tr_b16 a[104:105], v152 offset:24640
  ds_read_b64_tr_b16 a[106:107], v153 offset:24640
  ds_read_b64_tr_b16 a[108:109], v154 offset:24640
  ds_read_b64_tr_b16 a[110:111], v155 offset:24640
  s_waitcnt lgkmcnt(0)
  s_add_u32 m0, s28, 24576
  s_nop 0
  buffer_load_dwordx4 v144, s[8:11], s17 offen lds
  s_add_u32 s17, s17, s29
  s_add_u32 m0, s28, 25600
  s_nop 0
  buffer_load_dwordx4 v144, s[8:11], s17 offen lds
  s_add_u32 s17, s17, s29
  s_add_u32 m0, s28, 26624
  s_nop 0
  buffer_load_dwordx4 v144, s[8:11], s17 offen lds
  s_add_u32 s17, s17, s29
  s_add_u32 m0, s28, 27648
  s_nop 0
  buffer_load_dwordx4 v144, s[8:11], s17 offen lds
  s_add_u32 s17, s17, s29
  s_waitcnt vmcnt(28)
  ds_read_b64_tr_b16 a[112:113], v152 offset:28672
  ds_read_b64_tr_b16 a[114:115], v153 offset:28672
  ds_read_b64_tr_b16 a[116:117], v154 offset:28672
  ds_read_b64_tr_b16 a[118:119], v155 offset:28672
  ds_read_b64_tr_b16 a[120:121], v152 offset:28736
  ds_read_b64_tr_b16 a[122:123], v153 offset:28736
  ds_read_b64_tr_b16 a[124:125], v154 offset:28736
  ds_read_b64_tr_b16 a[126:127], v155 offset:28736
  s_waitcnt lgkmcnt(0)
  s_add_u32 m0, s28, 28672
  s_nop 0
  buffer_load_dwordx4 v144, s[8:11], s17 offen lds
  s_add_u32 s17, s17, s29
  s_add_u32 m0, s28, 29696
  s_nop 0
  buffer_load_dwordx4 v144, s[8:11], s17 offen lds
  s_add_u32 s17, s17, s29
  s_add_u32 m0, s28, 30720
  s_nop 0
  buffer_load_dwordx4 v144, s[8:11], s17 offen lds
  s_add_u32 s17, s17, s29
  s_add_u32 m0, s28, 31744
  s_nop 0
  buffer_load_dwordx4 v144, s[8:11], s17 offen lds
  s_add_u32 s17, s17, s29
  s_waitcnt vmcnt(28)
  ds_read_b64_tr_b16 a[128:129], v152 offset:0
  ds_read_b64_tr_b16 a[130:131], v153 offset:0
  ds_read_b64_tr_b16 a[132:133], v154 offset:0
  ds_read_b64_tr_b16 a[134:135], v155 offset:0
  ds_read_b64_tr_b16 a[136:137], v152 offset:64
  ds_read_b64_tr_b16 a[138:139], v153 offset:64
  ds_read_b64_tr_b16 a[140:141], v154 offset:64
  ds_read_b64_tr_b16 a[142:143], v155 offset:64
  s_waitcnt lgkmcnt(0)
  s_waitcnt vmcnt(24)
  ds_read_b64_tr_b16 a[144:145], v152 offset:4096
  ds_read_b64_tr_b16 a[146:147], v153 offset:4096
  ds_read_b64_tr_b16 a[148:149], v154 offset:4096
  ds_read_b64_tr_b16 a[150:151], v155 offset:4096
  ds_read_b64_tr_b16 a[152:153], v152 offset:4160
  ds_read_b64_tr_b16 a[154:155], v153 offset:4160
  ds_read_b64_tr_b16 a[156:157], v154 offset:4160
  ds_read_b64_tr_b16 a[158:159], v155 offset:4160
  s_waitcnt lgkmcnt(0)
  s_waitcnt vmcnt(20)
  ds_read_b64_tr_b16 a[160:161], v152 offset:8192
  ds_read_b64_tr_b16 a[162:163], v153 offset:8192
  ds_read_b64_tr_b16 a[164:165], v154 offset:8192
  ds_read_b64_tr_b16 a[166:167], v155 offset:8192
  ds_read_b64_tr_b16 a[168:169], v152 offset:8256
  ds_read_b64_tr_b16 a[170:171], v153 offset:8256
  ds_read_b64_tr_b16 a[172:173], v154 offset:8256
  ds_read_b64_tr_b16 a[174:175], v155 offset:8256
  s_waitcnt lgkmcnt(0)
  s_waitcnt vmcnt(16)
  ds_read_b64_tr_b16 a[176:177], v152 offset:12288
  ds_read_b64_tr_b16 a[178:179], v153 offset:12288
  ds_read_b64_tr_b16 a[180:181], v154 offset:12288
  ds_read_b64_tr_b16 a[182:183], v155 offset:12288
  ds_read_b64_tr_b16 a[184:185], v152 offset:12352
  ds_read_b64_tr_b16 a[186:187], v153 offset:12352
  ds_read_b64_tr_b16 a[188:189], v154 offset:12352
  ds_read_b64_tr_b16 a[190:191], v155 offset:12352
  s_waitcnt lgkmcnt(0)
  s_waitcnt vmcnt(12)
  ds_read_b64_tr_b16 a[192:193], v152 offset:16384
  ds_read_b64_tr_b16 a[194:195], v153 offset:16384
  ds_read_b64_tr_b16 a[196:197], v154 offset:16384
  ds_read_b64_tr_b16 a[198:199], v155 offset:16384
  ds_read_b64_tr_b16 a[200:201], v152 offset:16448
  ds_read_b64_tr_b16 a[202:203], v153 offset:16448
  ds_read_b64_tr_b16 a[204:205], v154 offset:16448
  ds_read_b64_tr_b16 a[206:207], v155 offset:16448
  s_waitcnt lgkmcnt(0)
  s_waitcnt vmcnt(8)
  ds_read_b64_tr_b16 a[208:209], v152 offset:20480
  ds_read_b64_tr_b16 a[210:211], v153 offset:20480
  ds_read_b64_tr_b16 a[212:213], v154 offset:20480
  ds_read_b64_tr_b16 a[214:215], v155 offset:20480
  ds_read_b64_tr_b16 a[216:217], v152 offset:20544
  ds_read_b64_tr_b16 a[218:219], v153 offset:20544
  ds_read_b64_tr_b16 a[220:221], v154 offset:20544
  ds_read_b64_tr_b16 a[222:223], v155 offset:20544
  s_waitcnt lgkmcnt(0)
  s_waitcnt vmcnt(4)
  ds_read_b64_tr_b16 a[224:225], v152 offset:24576
  ds_read_b64_tr_b16 a[226:227], v153 offset:24576
  ds_read_b64_tr_b16 a[228:229], v154 offset:24576
  ds_read_b64_tr_b16 a[230:231], v155 offset:24576
  ds_read_b64_tr_b16 a[232:233], v152 offset:24640
  ds_read_b64_tr_b16 a[234:235], v153 offset:24640
  ds_read_b64_tr_b16 a[236:237], v154 offset:24640
  ds_read_b64_tr_b16 a[238:239], v155 offset:24640
  s_waitcnt lgkmcnt(0)
  s_waitcnt vmcnt(0)
  ds_read_b64_tr_b16 a[240:241], v152 offset:28672
  ds_read_b64_tr_b16 a[242:243], v153 offset:28672
  ds_read_b64_tr_b16 a[244:245], v154 offset:28672
  ds_read_b64_tr_b16 a[246:247], v155 offset:28672
  ds_read_b64_tr_b16 a[248:249], v152 offset:28736
  ds_read_b64_tr_b16 a[250:251], v153 offset:28736
  ds_read_b64_tr_b16 a[252:253], v154 offset:28736
  ds_read_b64_tr_b16 a[254:255], v155 offset:28736
  s_waitcnt lgkmcnt(0)
  v_min_u32 v4, 27, v1
  v_mul_u32_u24 v5, 37, v4
  v_lshrrev_b32 v5, 8, v5
  v_mul_u32_u24 v5, 7, v5
  v_sub_u32 v5, v4, v5
  v_mov_b32 v6, 0x200
  v_cmp_ne_u32 vcc, 6, v5
  s_mul_i32 s76, s48, 3584
  s_add_u32 s76, s76, 148897792
  v_cndmask_b32 v5, 0, v6, vcc
  v_lshl_add_u32 v4, v4, 7, s76
  s_mov_b32 s71, 0
  s_branch M_vg_178
M_vw_177:
  s_sleep 2
  s_add_u32 s71, s71, 1
  s_cmp_gt_u32 s71, 262144
  s_cbranch_scc1 M_exit
M_vg_178:
  buffer_load_dword v6, v4, s[4:7], 0 offen sc1
  s_waitcnt vmcnt(0)
  v_cmp_lt_u32 vcc, v6, v5
  s_cbranch_vccnz M_vw_177
  s_barrier
  s_lshl_b32 s25, s16, 13
  s_add_u32 m0, s25, 0
  s_nop 0
  buffer_load_dwordx4 v16, s[12:15], s19 offen sc1 lds
  s_add_u32 m0, s25, 1024
  s_nop 0
  buffer_load_dwordx4 v17, s[12:15], s19 offen sc1 lds
  s_add_u32 m0, s25, 2048
  s_nop 0
  buffer_load_dwordx4 v18, s[12:15], s19 offen sc1 lds
  s_add_u32 m0, s25, 3072
  s_nop 0
  buffer_load_dwordx4 v19, s[12:15], s19 offen sc1 lds
  s_add_u32 m0, s25, 4096
  s_nop 0
  buffer_load_dwordx4 v20, s[12:15], s19 offen sc1 lds
  s_add_u32 m0, s25, 5120
  s_nop 0
  buffer_load_dwordx4 v21, s[12:15], s19 offen sc1 lds
  s_add_u32 m0, s25, 6144
  s_nop 0
  buffer_load_dwordx4 v22, s[12:15], s19 offen sc1 lds
  s_add_u32 m0, s25, 7168
  s_nop 0
  buffer_load_dwordx4 v23, s[12:15], s19 offen sc1 lds
  s_cmp_gt_u32 s23, 1
  s_cselect_b32 s26, s20, 0
  s_add_u32 s19, s19, s26
  s_add_u32 s25, s25, 32768
  s_and_b32 s25, s25, 0x1ffff
  s_add_u32 m0, s25, 0
  s_nop 0
  buffer_load_dwordx4 v16, s[12:15], s19 offen sc1 lds
  s_add_u32 m0, s25, 1024
  s_nop 0
  buffer_load_dwordx4 v17, s[12:15], s19 offen sc1 lds
  s_add_u32 m0, s25, 2048
  s_nop 0
  buffer_load_dwordx4 v18, s[12:15], s19 offen sc1 lds
  s_add_u32 m0, s25, 3072
  s_nop 0
  buffer_load_dwordx4 v19, s[12:15], s19 offen sc1 lds
  s_add_u32 m0, s25, 4096
  s_nop 0
  buffer_load_dwordx4 v20, s[12:15], s19 offen sc1 lds
  s_add_u32 m0, s25, 5120
  s_nop 0
  buffer_load_dwordx4 v21, s[12:15], s19 offen sc1 lds
  s_add_u32 m0, s25, 6144
  s_nop 0
  buffer_load_dwordx4 v22, s[12:15], s19 offen sc1 lds
  s_add_u32 m0, s25, 7168
  s_nop 0
  buffer_load_dwordx4 v23, s[12:15], s19 offen sc1 lds
  s_cmp_gt_u32 s23, 2
  s_cselect_b32 s26, s20, 0
  s_add_u32 s19, s19, s26
  s_add_u32 s25, s25, 32768
  s_and_b32 s25, s25, 0x1ffff
  s_waitcnt vmcnt(0)
  s_barrier
  s_mov_b32 s27, s21
  v_mov_b32 v7, 0x40000000
  ds_read_b128 v[24:27], v8 offset:0
  ds_read_b128 v[28:31], v9 offset:0
  ds_read_b128 v[32:35], v10 offset:0
  ds_read_b128 v[36:39], v11 offset:0
  ds_read_b128 v[40:43], v12 offset:0
  ds_read_b128 v[44:47], v13 offset:0
.p2align 6
G_top_179:
  s_waitcnt lgkmcnt(5)
  v_mfma_f32_16x16x32_bf16 v[64:67], a[0:3], v[24:27], 0
  s_add_u32 m0, s25, 0
  ds_read_b128 v[48:51], v14 offset:0
  v_mfma_f32_16x16x32_bf16 v[68:71], a[4:7], v[24:27], 0
  v_mfma_f32_16x16x32_bf16 v[80:83], a[8:11], v[24:27], 0
  buffer_load_dwordx4 v16, s[12:15], s19 offen sc1 lds
  v_mfma_f32_16x16x32_bf16 v[84:87], a[12:15], v[24:27], 0
  s_waitcnt lgkmcnt(5)
  v_mfma_f32_16x16x32_bf16 v[72:75], a[0:3], v[28:31], 0
  ds_read_b128 v[52:55], v15 offset:0
  v_mfma_f32_16x16x32_bf16 v[76:79], a[4:7], v[28:31], 0
  v_cvt_pk_bf16_f32 v128, v96, v97
  v_cvt_pk_bf16_f32 v129, v98, v99
  v_mfma_f32_16x16x32_bf16 v[88:91], a[8:11], v[28:31], 0
  v_mfma_f32_16x16x32_bf16 v[92:95], a[12:15], v[28:31], 0
  s_waitcnt lgkmcnt(5)
  v_cvt_pk_bf16_f32 v130, v100, v101
  v_cvt_pk_bf16_f32 v131, v102, v103
  v_mfma_f32_16x16x32_bf16 v[64:67], a[16:19], v[32:35], v[64:67]
  s_add_u32 m0, s25, 1024
  ds_read_b128 v[24:27], v8 offset:8192
  v_mfma_f32_16x16x32_bf16 v[68:71], a[20:23], v[32:35], v[68:71]
  v_mfma_f32_16x16x32_bf16 v[80:83], a[24:27], v[32:35], v[80:83]
  buffer_load_dwordx4 v17, s[12:15], s19 offen sc1 lds
  v_mfma_f32_16x16x32_bf16 v[84:87], a[28:31], v[32:35], v[84:87]
  s_waitcnt lgkmcnt(5)
  v_mfma_f32_16x16x32_bf16 v[72:75], a[16:19], v[36:39], v[72:75]
  ds_read_b128 v[28:31], v9 offset:8192
  v_mfma_f32_16x16x32_bf16 v[76:79], a[20:23], v[36:39], v[76:79]
  v_mfma_f32_16x16x32_bf16 v[88:91], a[24:27], v[36:39], v[88:91]
  v_mfma_f32_16x16x32_bf16 v[92:95], a[28:31], v[36:39], v[92:95]
  s_waitcnt lgkmcnt(5)
  v_mfma_f32_16x16x32_bf16 v[64:67], a[32:35], v[40:43], v[64:67]
  s_add_u32 m0, s25, 2048
  ds_read_b128 v[32:35], v10 offset:8192
  v_mfma_f32_16x16x32_bf16 v[68:71], a[36:39], v[40:43], v[68:71]
  v_cvt_pk_bf16_f32 v132, v104, v105
  v_cvt_pk_bf16_f32 v133, v106, v107
  v_mfma_f32_16x16x32_bf16 v[80:83], a[40:43], v[40:43], v[80:83]
  buffer_load_dwordx4 v18, s[12:15], s19 offen sc1 lds
  v_mfma_f32_16x16x32_bf16 v[84:87], a[44:47], v[40:43], v[84:87]
  s_waitcnt lgkmcnt(5)
  v_cvt_pk_bf16_f32 v134, v108, v109
  v_cvt_pk_bf16_f32 v135, v110, v111
  v_mfma_f32_16x16x32_bf16 v[72:75], a[32:35], v[44:47], v[72:75]
  ds_read_b128 v[36:39], v11 offset:8192
  v_mfma_f32_16x16x32_bf16 v[76:79], a[36:39], v[44:47], v[76:79]
  v_mfma_f32_16x16x32_bf16 v[88:91], a[40:43], v[44:47], v[88:91]
  v_mfma_f32_16x16x32_bf16 v[92:95], a[44:47], v[44:47], v[92:95]
  s_waitcnt lgkmcnt(5)
  v_mfma_f32_16x16x32_bf16 v[64:67], a[48:51], v[48:51], v[64:67]
  s_add_u32 m0, s25, 3072
  ds_read_b128 v[40:43], v12 offset:8192
  v_mfma_f32_16x16x32_bf16 v[68:71], a[52:55], v[48:51], v[68:71]
  v_mfma_f32_16x16x32_bf16 v[80:83], a[56:59], v[48:51], v[80:83]
  buffer_load_dwordx4 v19, s[12:15], s19 offen sc1 lds
  v_mfma_f32_16x16x32_bf16 v[84:87], a[60:63], v[48:51], v[84:87]
  s_waitcnt lgkmcnt(5)
  v_mfma_f32_16x16x32_bf16 v[72:75], a[48:51], v[52:55], v[72:75]
  ds_read_b128 v[44:47], v13 offset:8192
  v_mfma_f32_16x16x32_bf16 v[76:79], a[52:55], v[52:55], v[76:79]
  v_cvt_pk_bf16_f32 v136, v112, v113
  v_cvt_pk_bf16_f32 v137, v114, v115
  v_mfma_f32_16x16x32_bf16 v[88:91], a[56:59], v[52:55], v[88:91]
  v_mfma_f32_16x16x32_bf16 v[92:95], a[60:63], v[52:55], v[92:95]
  s_waitcnt lgkmcnt(5)
  v_cvt_pk_bf16_f32 v138, v116, v117
  v_cvt_pk_bf16_f32 v139, v118, v119
  v_mfma_f32_16x16x32_bf16 v[64:67], a[64:67], v[24:27], v[64:67]
  s_add_u32 m0, s25, 4096
  ds_read_b128 v[48:51], v14 offset:8192
  v_mfma_f32_16x16x32_bf16 v[68:71], a[68:71], v[24:27], v[68:71]
  v_mfma_f32_16x16x32_bf16 v[80:83], a[72:75], v[24:27], v[80:83]
  buffer_load_dwordx4 v20, s[12:15], s19 offen sc1 lds
  v_mfma_f32_16x16x32_bf16 v[84:87], a[76:79], v[24:27], v[84:87]
  s_waitcnt lgkmcnt(5)
  v_mfma_f32_16x16x32_bf16 v[72:75], a[64:67], v[28:31], v[72:75]
  ds_read_b128 v[52:55], v15 offset:8192
  v_mfma_f32_16x16x32_bf16 v[76:79], a[68:71], v[28:31], v[76:79]
  v_mfma_f32_16x16x32_bf16 v[88:91], a[72:75], v[28:31], v[88:91]
  v_mfma_f32_16x16x32_bf16 v[92:95], a[76:79], v[28:31], v[92:95]
  s_waitcnt lgkmcnt(5)
  v_mfma_f32_16x16x32_bf16 v[64:67], a[80:83], v[32:35], v[64:67]
  s_add_u32 m0, s25, 5120
  ds_read_b128 v[24:27], v8 offset:16384
  v_mfma_f32_16x16x32_bf16 v[68:71], a[84:87], v[32:35], v[68:71]
  v_cvt_pk_bf16_f32 v140, v120, v121
  v_cvt_pk_bf16_f32 v141, v122, v123
  v_mfma_f32_16x16x32_bf16 v[80:83], a[88:91], v[32:35], v[80:83]
  buffer_load_dwordx4 v21, s[12:15], s19 offen sc1 lds
  v_mfma_f32_16x16x32_bf16 v[84:87], a[92:95], v[32:35], v[84:87]
  s_waitcnt lgkmcnt(5)
  v_cvt_pk_bf16_f32 v142, v124, v125
  v_cvt_pk_bf16_f32 v143, v126, v127
  v_mfma_f32_16x16x32_bf16 v[72:75], a[80:83], v[36:39], v[72:75]
  ds_read_b128 v[28:31], v9 offset:16384
  v_mfma_f32_16x16x32_bf16 v[76:79], a[84:87], v[36:39], v[76:79]
  v_mfma_f32_16x16x32_bf16 v[88:91], a[88:91], v[36:39], v[88:91]
  v_mfma_f32_16x16x32_bf16 v[92:95], a[92:95], v[36:39], v[92:95]
  s_waitcnt lgkmcnt(5)
  v_mfma_f32_16x16x32_bf16 v[64:67], a[96:99], v[40:43], v[64:67]
  s_add_u32 m0, s25, 6144
  ds_read_b128 v[32:35], v10 offset:16384
  v_mfma_f32_16x16x32_bf16 v[68:71], a[100:103], v[40:43], v[68:71]
  v_mfma_f32_16x16x32_bf16 v[80:83], a[104:107], v[40:43], v[80:83]
  buffer_load_dwordx4 v22, s[12:15], s19 offen sc1 lds
  v_mfma_f32_16x16x32_bf16 v[84:87], a[108:111], v[40:43], v[84:87]
  s_waitcnt lgkmcnt(5)
  v_mfma_f32_16x16x32_bf16 v[72:75], a[96:99], v[44:47], v[72:75]
  ds_read_b128 v[36:39], v11 offset:16384
  v_mfma_f32_16x16x32_bf16 v[76:79], a[100:103], v[44:47], v[76:79]
  v_mfma_f32_16x16x32_bf16 v[88:91], a[104:107], v[44:47], v[88:91]
  v_mfma_f32_16x16x32_bf16 v[92:95], a[108:111], v[44:47], v[92:95]
  s_waitcnt lgkmcnt(5)
  v_mfma_f32_16x16x32_bf16 v[64:67], a[112:115], v[48:51], v[64:67]
  s_add_u32 m0, s25, 7168
  ds_read_b128 v[40:43], v12 offset:16384
  v_mfma_f32_16x16x32_bf16 v[68:71], a[116:119], v[48:51], v[68:71]
  v_mfma_f32_16x16x32_bf16 v[80:83], a[120:123], v[48:51], v[80:83]
  buffer_load_dwordx4 v23, s[12:15], s19 offen sc1 lds
  v_mfma_f32_16x16x32_bf16 v[84:87], a[124:127], v[48:51], v[84:87]
  s_waitcnt lgkmcnt(5)
  v_mfma_f32_16x16x32_bf16 v[72:75], a[112:115], v[52:55], v[72:75]
  s_cmp_gt_u32 s23, 3
  ds_read_b128 v[44:47], v13 offset:16384
  v_mfma_f32_16x16x32_bf16 v[76:79], a[116:119], v[52:55], v[76:79]
  v_mfma_f32_16x16x32_bf16 v[88:91], a[120:123], v[52:55], v[88:91]
  s_cselect_b32 s26, s20, 0
  v_mfma_f32_16x16x32_bf16 v[92:95], a[124:127], v[52:55], v[92:95]
  s_waitcnt lgkmcnt(5)
  v_mfma_f32_16x16x32_bf16 v[64:67], a[128:131], v[24:27], v[64:67]
  s_add_u32 s19, s19, s26
  ds_read_b128 v[48:51], v14 offset:16384
  v_mfma_f32_16x16x32_bf16 v[68:71], a[132:135], v[24:27], v[68:71]
  v_mfma_f32_16x16x32_bf16 v[80:83], a[136:139], v[24:27], v[80:83]
  s_add_u32 s25, s25, 32768
  v_mfma_f32_16x16x32_bf16 v[84:87], a[140:143], v[24:27], v[84:87]
  s_waitcnt lgkmcnt(5)
  v_mfma_f32_16x16x32_bf16 v[72:75], a[128:131], v[28:31], v[72:75]
  s_and_b32 s25, s25, 0x1ffff
  ds_read_b128 v[52:55], v15 offset:16384
  v_mfma_f32_16x16x32_bf16 v[76:79], a[132:135], v[28:31], v[76:79]
  v_mfma_f32_16x16x32_bf16 v[88:91], a[136:139], v[28:31], v[88:91]
  buffer_store_dwordx4 v[128:131], v7, s[4:7], s21 offen offset:0 sc1
  v_mfma_f32_16x16x32_bf16 v[92:95], a[140:143], v[28:31], v[92:95]
  s_waitcnt lgkmcnt(5)
  v_mfma_f32_16x16x32_bf16 v[64:67], a[144:147], v[32:35], v[64:67]
  ds_read_b128 v[24:27], v8 offset:24576
  v_mfma_f32_16x16x32_bf16 v[68:71], a[148:151], v[32:35], v[68:71]
  v_mfma_f32_16x16x32_bf16 v[80:83], a[152:155], v[32:35], v[80:83]
  v_mfma_f32_16x16x32_bf16 v[84:87], a[156:159], v[32:35], v[84:87]
  s_waitcnt lgkmcnt(5)
  v_mfma_f32_16x16x32_bf16 v[72:75], a[144:147], v[36:39], v[72:75]
  ds_read_b128 v[28:31], v9 offset:24576
  v_mfma_f32_16x16x32_bf16 v[76:79], a[148:151], v[36:39], v[76:79]
  v_mfma_f32_16x16x32_bf16 v[88:91], a[152:155], v[36:39], v[88:91]
  buffer_store_dwordx4 v[132:135], v7, s[4:7], s21 offen offset:256 sc1
  v_mfma_f32_16x16x32_bf16 v[92:95], a[156:159], v[36:39], v[92:95]
  s_waitcnt lgkmcnt(5)
  v_mfma_f32_16x16x32_bf16 v[64:67], a[160:163], v[40:43], v[64:67]
  ds_read_b128 v[32:35], v10 offset:24576
  v_mfma_f32_16x16x32_bf16 v[68:71], a[164:167], v[40:43], v[68:71]
  v_mfma_f32_16x16x32_bf16 v[80:83], a[168:171], v[40:43], v[80:83]
  v_mfma_f32_16x16x32_bf16 v[84:87], a[172:175], v[40:43], v[84:87]
  s_waitcnt lgkmcnt(5)
  v_mfma_f32_16x16x32_bf16 v[72:75], a[160:163], v[44:47], v[72:75]
  ds_read_b128 v[36:39], v11 offset:24576
  v_mfma_f32_16x16x32_bf16 v[76:79], a[164:167], v[44:47], v[76:79]
  v_mfma_f32_16x16x32_bf16 v[88:91], a[168:171], v[44:47], v[88:91]
  buffer_store_dwordx4 v[136:139], v7, s[4:7], s21 offen offset:2048 sc1
  v_mfma_f32_16x16x32_bf16 v[92:95], a[172:175], v[44:47], v[92:95]
  s_waitcnt lgkmcnt(5)
  v_mfma_f32_16x16x32_bf16 v[64:67], a[176:179], v[48:51], v[64:67]
  ds_read_b128 v[40:43], v12 offset:24576
  v_mfma_f32_16x16x32_bf16 v[68:71], a[180:183], v[48:51], v[68:71]
  v_mfma_f32_16x16x32_bf16 v[80:83], a[184:187], v[48:51], v[80:83]
  v_mfma_f32_16x16x32_bf16 v[84:87], a[188:191], v[48:51], v[84:87]
  s_waitcnt lgkmcnt(5)
  v_mfma_f32_16x16x32_bf16 v[72:75], a[176:179], v[52:55], v[72:75]
  ds_read_b128 v[44:47], v13 offset:24576
  v_mfma_f32_16x16x32_bf16 v[76:79], a[180:183], v[52:55], v[76:79]
  v_mfma_f32_16x16x32_bf16 v[88:91], a[184:187], v[52:55], v[88:91]
  buffer_store_dwordx4 v[140:143], v7, s[4:7], s21 offen offset:2304 sc1
  v_mfma_f32_16x16x32_bf16 v[92:95], a[188:191], v[52:55], v[92:95]
  s_waitcnt lgkmcnt(5)
  v_mfma_f32_16x16x32_bf16 v[64:67], a[192:195], v[24:27], v[64:67]
  s_mov_b32 s21, s27
  ds_read_b128 v[48:51], v14 offset:24576
  v_mfma_f32_16x16x32_bf16 v[68:71], a[196:199], v[24:27], v[68:71]
  v_mov_b32 v7, v56
  v_mfma_f32_16x16x32_bf16 v[80:83], a[200:203], v[24:27], v[80:83]
  v_mfma_f32_16x16x32_bf16 v[84:87], a[204:207], v[24:27], v[84:87]
  s_waitcnt lgkmcnt(5)
  v_mfma_f32_16x16x32_bf16 v[72:75], a[192:195], v[28:31], v[72:75]
  s_add_u32 s27, s27, s22
  ds_read_b128 v[52:55], v15 offset:24576
  v_mfma_f32_16x16x32_bf16 v[76:79], a[196:199], v[28:31], v[76:79]
  v_mfma_f32_16x16x32_bf16 v[88:91], a[200:203], v[28:31], v[88:91]
  s_waitcnt vmcnt(16)
  s_barrier
  v_mfma_f32_16x16x32_bf16 v[92:95], a[204:207], v[28:31], v[92:95]
  s_waitcnt lgkmcnt(5)
  v_mfma_f32_16x16x32_bf16 v[64:67], a[208:211], v[32:35], v[64:67]
  ds_read_b128 v[24:27], v8 offset:32768
  v_mfma_f32_16x16x32_bf16 v[68:71], a[212:215], v[32:35], v[68:71]
  v_mfma_f32_16x16x32_bf16 v[80:83], a[216:219], v[32:35], v[80:83]
  v_mfma_f32_16x16x32_bf16 v[84:87], a[220:223], v[32:35], v[84:87]
  s_waitcnt lgkmcnt(5)
  v_mfma_f32_16x16x32_bf16 v[72:75], a[208:211], v[36:39], v[72:75]
  ds_read_b128 v[28:31], v9 offset:32768
  v_mfma_f32_16x16x32_bf16 v[76:79], a[212:215], v[36:39], v[76:79]
  v_mfma_f32_16x16x32_bf16 v[88:91], a[216:219], v[36:39], v[88:91]
  v_mfma_f32_16x16x32_bf16 v[92:95], a[220:223], v[36:39], v[92:95]
  s_waitcnt lgkmcnt(5)
  v_mfma_f32_16x16x32_bf16 v[64:67], a[224:227], v[40:43], v[64:67]
  ds_read_b128 v[32:35], v10 offset:32768
  v_mfma_f32_16x16x32_bf16 v[68:71], a[228:231], v[40:43], v[68:71]
  v_mfma_f32_16x16x32_bf16 v[80:83], a[232:235], v[40:43], v[80:83]
  v_mfma_f32_16x16x32_bf16 v[84:87], a[236:239], v[40:43], v[84:87]
  s_waitcnt lgkmcnt(5)
  v_mfma_f32_16x16x32_bf16 v[72:75], a[224:227], v[44:47], v[72:75]
  ds_read_b128 v[36:39], v11 offset:32768
  v_mfma_f32_16x16x32_bf16 v[76:79], a[228:231], v[44:47], v[76:79]
  v_mfma_f32_16x16x32_bf16 v[88:91], a[232:235], v[44:47], v[88:91]
  v_mfma_f32_16x16x32_bf16 v[92:95], a[236:239], v[44:47], v[92:95]
  s_waitcnt lgkmcnt(5)
  v_mfma_f32_16x16x32_bf16 v[64:67], a[240:243], v[48:51], v[64:67]
  s_sub_u32 s23, s23, 1
  ds_read_b128 v[40:43], v12 offset:32768
  v_mfma_f32_16x16x32_bf16 v[68:71], a[244:247], v[48:51], v[68:71]
  v_mfma_f32_16x16x32_bf16 v[80:83], a[248:251], v[48:51], v[80:83]
  v_mfma_f32_16x16x32_bf16 v[84:87], a[252:255], v[48:51], v[84:87]
  s_waitcnt lgkmcnt(5)
  v_mfma_f32_16x16x32_bf16 v[72:75], a[240:243], v[52:55], v[72:75]
  s_cmp_eq_u32 s23, 0
  ds_read_b128 v[44:47], v13 offset:32768
  v_mfma_f32_16x16x32_bf16 v[76:79], a[244:247], v[52:55], v[76:79]
  v_mfma_f32_16x16x32_bf16 v[88:91], a[248:251], v[52:55], v[88:91]
  v_mfma_f32_16x16x32_bf16 v[92:95], a[252:255], v[52:55], v[92:95]
  s_cbranch_scc1 G_done0_180
  s_waitcnt lgkmcnt(5)
  v_mfma_f32_16x16x32_bf16 v[96:99], a[0:3], v[24:27], 0
  s_add_u32 m0, s25, 0
  ds_read_b128 v[48:51], v14 offset:32768
  v_mfma_f32_16x16x32_bf16 v[100:103], a[4:7], v[24:27], 0
  v_mfma_f32_16x16x32_bf16 v[112:115], a[8:11], v[24:27], 0
  buffer_load_dwordx4 v16, s[12:15], s19 offen sc1 lds
  v_mfma_f32_16x16x32_bf16 v[116:119], a[12:15], v[24:27], 0
  s_waitcnt lgkmcnt(5)
  v_mfma_f32_16x16x32_bf16 v[104:107], a[0:3], v[28:31], 0
  ds_read_b128 v[52:55], v15 offset:32768
  v_mfma_f32_16x16x32_bf16 v[108:111], a[4:7], v[28:31], 0
  v_cvt_pk_bf16_f32 v128, v64, v65
  v_cvt_pk_bf16_f32 v129, v66, v67
  v_mfma_f32_16x16x32_bf16 v[120:123], a[8:11], v[28:31], 0
  v_mfma_f32_16x16x32_bf16 v[124:127], a[12:15], v[28:31], 0
  s_waitcnt lgkmcnt(5)
  v_cvt_pk_bf16_f32 v130, v68, v69
  v_cvt_pk_bf16_f32 v131, v70, v71
  v_mfma_f32_16x16x32_bf16 v[96:99], a[16:19], v[32:35], v[96:99]
  s_add_u32 m0, s25, 1024
  ds_read_b128 v[24:27], v8 offset:40960
  v_mfma_f32_16x16x32_bf16 v[100:103], a[20:23], v[32:35], v[100:103]
  v_mfma_f32_16x16x32_bf16 v[112:115], a[24:27], v[32:35], v[112:115]
  buffer_load_dwordx4 v17, s[12:15], s19 offen sc1 lds
  v_mfma_f32_16x16x32_bf16 v[116:119], a[28:31], v[32:35], v[116:119]
  s_waitcnt lgkmcnt(5)
  v_mfma_f32_16x16x32_bf16 v[104:107], a[16:19], v[36:39], v[104:107]
  ds_read_b128 v[28:31], v9 offset:40960
  v_mfma_f32_16x16x32_bf16 v[108:111], a[20:23], v[36:39], v[108:111]
  v_mfma_f32_16x16x32_bf16 v[120:123], a[24:27], v[36:39], v[120:123]
  v_mfma_f32_16x16x32_bf16 v[124:127], a[28:31], v[36:39], v[124:127]
  s_waitcnt lgkmcnt(5)
  v_mfma_f32_16x16x32_bf16 v[96:99], a[32:35], v[40:43], v[96:99]
  s_add_u32 m0, s25, 2048
  ds_read_b128 v[32:35], v10 offset:40960
  v_mfma_f32_16x16x32_bf16 v[100:103], a[36:39], v[40:43], v[100:103]
  v_cvt_pk_bf16_f32 v132, v72, v73
  v_cvt_pk_bf16_f32 v133, v74, v75
  v_mfma_f32_16x16x32_bf16 v[112:115], a[40:43], v[40:43], v[112:115]
  buffer_load_dwordx4 v18, s[12:15], s19 offen sc1 lds
  v_mfma_f32_16x16x32_bf16 v[116:119], a[44:47], v[40:43], v[116:119]
  s_waitcnt lgkmcnt(5)
  v_cvt_pk_bf16_f32 v134, v76, v77
  v_cvt_pk_bf16_f32 v135, v78, v79
  v_mfma_f32_16x16x32_bf16 v[104:107], a[32:35], v[44:47], v[104:107]
  ds_read_b128 v[36:39], v11 offset:40960
  v_mfma_f32_16x16x32_bf16 v[108:111], a[36:39], v[44:47], v[108:111]
  v_mfma_f32_16x16x32_bf16 v[120:123], a[40:43], v[44:47], v[120:123]
  v_mfma_f32_16x16x32_bf16 v[124:127], a[44:47], v[44:47], v[124:127]
  s_waitcnt lgkmcnt(5)
  v_mfma_f32_16x16x32_bf16 v[96:99], a[48:51], v[48:51], v[96:99]
  s_add_u32 m0, s25, 3072
  ds_read_b128 v[40:43], v12 offset:40960
  v_mfma_f32_16x16x32_bf16 v[100:103], a[52:55], v[48:51], v[100:103]
  v_mfma_f32_16x16x32_bf16 v[112:115], a[56:59], v[48:51], v[112:115]
  buffer_load_dwordx4 v19, s[12:15], s19 offen sc1 lds
  v_mfma_f32_16x16x32_bf16 v[116:119], a[60:63], v[48:51], v[116:119]
  s_waitcnt lgkmcnt(5)
  v_mfma_f32_16x16x32_bf16 v[104:107], a[48:51], v[52:55], v[104:107]
  ds_read_b128 v[44:47], v13 offset:40960
  v_mfma_f32_16x16x32_bf16 v[108:111], a[52:55], v[52:55], v[108:111]
  v_cvt_pk_bf16_f32 v136, v80, v81
  v_cvt_pk_bf16_f32 v137, v82, v83
  v_mfma_f32_16x16x32_bf16 v[120:123], a[56:59], v[52:55], v[120:123]
  v_mfma_f32_16x16x32_bf16 v[124:127], a[60:63], v[52:55], v[124:127]
  s_waitcnt lgkmcnt(5)
  v_cvt_pk_bf16_f32 v138, v84, v85
  v_cvt_pk_bf16_f32 v139, v86, v87
  v_mfma_f32_16x16x32_bf16 v[96:99], a[64:67], v[24:27], v[96:99]
  s_add_u32 m0, s25, 4096
  ds_read_b128 v[48:51], v14 offset:40960
  v_mfma_f32_16x16x32_bf16 v[100:103], a[68:71], v[24:27], v[100:103]
  v_mfma_f32_16x16x32_bf16 v[112:115], a[72:75], v[24:27], v[112:115]
  buffer_load_dwordx4 v20, s[12:15], s19 offen sc1 lds
  v_mfma_f32_16x16x32_bf16 v[116:119], a[76:79], v[24:27], v[116:119]
  s_waitcnt lgkmcnt(5)
  v_mfma_f32_16x16x32_bf16 v[104:107], a[64:67], v[28:31], v[104:107]
  ds_read_b128 v[52:55], v15 offset:40960
  v_mfma_f32_16x16x32_bf16 v[108:111], a[68:71], v[28:31], v[108:111]
  v_mfma_f32_16x16x32_bf16 v[120:123], a[72:75], v[28:31], v[120:123]
  v_mfma_f32_16x16x32_bf16 v[124:127], a[76:79], v[28:31], v[124:127]
  s_waitcnt lgkmcnt(5)
  v_mfma_f32_16x16x32_bf16 v[96:99], a[80:83], v[32:35], v[96:99]
  s_add_u32 m0, s25, 5120
  ds_read_b128 v[24:27], v8 offset:49152
  v_mfma_f32_16x16x32_bf16 v[100:103], a[84:87], v[32:35], v[100:103]
  v_cvt_pk_bf16_f32 v140, v88, v89
  v_cvt_pk_bf16_f32 v141, v90, v91
  v_mfma_f32_16x16x32_bf16 v[112:115], a[88:91], v[32:35], v[112:115]
  buffer_load_dwordx4 v21, s[12:15], s19 offen sc1 lds
  v_mfma_f32_16x16x32_bf16 v[116:119], a[92:95], v[32:35], v[116:119]
  s_waitcnt lgkmcnt(5)
  v_cvt_pk_bf16_f32 v142, v92, v93
  v_cvt_pk_bf16_f32 v143, v94, v95
  v_mfma_f32_16x16x32_bf16 v[104:107], a[80:83], v[36:39], v[104:107]
  ds_read_b128 v[28:31], v9 offset:49152
  v_mfma_f32_16x16x32_bf16 v[108:111], a[84:87], v[36:39], v[108:111]
  v_mfma_f32_16x16x32_bf16 v[120:123], a[88:91], v[36:39], v[120:123]
  v_mfma_f32_16x16x32_bf16 v[124:127], a[92:95], v[36:39], v[124:127]
  s_waitcnt lgkmcnt(5)
  v_mfma_f32_16x16x32_bf16 v[96:99], a[96:99], v[40:43], v[96:99]
  s_add_u32 m0, s25, 6144
  ds_read_b128 v[32:35], v10 offset:49152
  v_mfma_f32_16x16x32_bf16 v[100:103], a[100:103], v[40:43], v[100:103]
  v_mfma_f32_16x16x32_bf16 v[112:115], a[104:107], v[40:43], v[112:115]
  buffer_load_dwordx4 v22, s[12:15], s19 offen sc1 lds
  v_mfma_f32_16x16x32_bf16 v[116:119], a[108:111], v[40:43], v[116:119]
  s_waitcnt lgkmcnt(5)
  v_mfma_f32_16x16x32_bf16 v[104:107], a[96:99], v[44:47], v[104:107]
  ds_read_b128 v[36:39], v11 offset:49152
  v_mfma_f32_16x16x32_bf16 v[108:111], a[100:103], v[44:47], v[108:111]
  v_mfma_f32_16x16x32_bf16 v[120:123], a[104:107], v[44:47], v[120:123]
  v_mfma_f32_16x16x32_bf16 v[124:127], a[108:111], v[44:47], v[124:127]
  s_waitcnt lgkmcnt(5)
  v_mfma_f32_16x16x32_bf16 v[96:99], a[112:115], v[48:51], v[96:99]
  s_add_u32 m0, s25, 7168
  ds_read_b128 v[40:43], v12 offset:49152
  v_mfma_f32_16x16x32_bf16 v[100:103], a[116:119], v[48:51], v[100:103]
  v_mfma_f32_16x16x32_bf16 v[112:115], a[120:123], v[48:51], v[112:115]
  buffer_load_dwordx4 v23, s[12:15], s19 offen sc1 lds
  v_mfma_f32_16x16x32_bf16 v[116:119], a[124:127], v[48:51], v[116:119]
  s_waitcnt lgkmcnt(5)
  v_mfma_f32_16x16x32_bf16 v[104:107], a[112:115], v[52:55], v[104:107]
  s_cmp_gt_u32 s23, 3
  ds_read_b128 v[44:47], v13 offset:49152
  v_mfma_f32_16x16x32_bf16 v[108:111], a[116:119], v[52:55], v[108:111]
  v_mfma_f32_16x16x32_bf16 v[120:123], a[120:123], v[52:55], v[120:123]
  s_cselect_b32 s26, s20, 0
  v_mfma_f32_16x16x32_bf16 v[124:127], a[124:127], v[52:55], v[124:127]
  s_waitcnt lgkmcnt(5)
  v_mfma_f32_16x16x32_bf16 v[96:99], a[128:131], v[24:27], v[96:99]
  s_add_u32 s19, s19, s26
  ds_read_b128 v[48:51], v14 offset:49152
  v_mfma_f32_16x16x32_bf16 v[100:103], a[132:135], v[24:27], v[100:103]
  v_mfma_f32_16x16x32_bf16 v[112:115], a[136:139], v[24:27], v[112:115]
  s_add_u32 s25, s25, 32768
  v_mfma_f32_16x16x32_bf16 v[116:119], a[140:143], v[24:27], v[116:119]
  s_waitcnt lgkmcnt(5)
  v_mfma_f32_16x16x32_bf16 v[104:107], a[128:131], v[28:31], v[104:107]
  s_and_b32 s25, s25, 0x1ffff
  ds_read_b128 v[52:55], v15 offset:49152
  v_mfma_f32_16x16x32_bf16 v[108:111], a[132:135], v[28:31], v[108:111]
  v_mfma_f32_16x16x32_bf16 v[120:123], a[136:139], v[28:31], v[120:123]
  buffer_store_dwordx4 v[128:131], v7, s[4:7], s21 offen offset:0 sc1
  v_mfma_f32_16x16x32_bf16 v[124:127], a[140:143], v[28:31], v[124:127]
  s_waitcnt lgkmcnt(5)
  v_mfma_f32_16x16x32_bf16 v[96:99], a[144:147], v[32:35], v[96:99]
  ds_read_b128 v[24:27], v8 offset:57344
  v_mfma_f32_16x16x32_bf16 v[100:103], a[148:151], v[32:35], v[100:103]
  v_mfma_f32_16x16x32_bf16 v[112:115], a[152:155], v[32:35], v[112:115]
  v_mfma_f32_16x16x32_bf16 v[116:119], a[156:159], v[32:35], v[116:119]
  s_waitcnt lgkmcnt(5)
  v_xor_b32 v8, 0x10000, v8
  v_mfma_f32_16x16x32_bf16 v[104:107], a[144:147], v[36:39], v[104:107]
  ds_read_b128 v[28:31], v9 offset:57344
  v_mfma_f32_16x16x32_bf16 v[108:111], a[148:151], v[36:39], v[108:111]
  v_mfma_f32_16x16x32_bf16 v[120:123], a[152:155], v[36:39], v[120:123]
  buffer_store_dwordx4 v[132:135], v7, s[4:7], s21 offen offset:256 sc1
  v_mfma_f32_16x16x32_bf16 v[124:127], a[156:159], v[36:39], v[124:127]
  s_waitcnt lgkmcnt(5)
  v_xor_b32 v9, 0x10000, v9
  v_mfma_f32_16x16x32_bf16 v[96:99], a[160:163], v[40:43], v[96:99]
  ds_read_b128 v[32:35], v10 offset:57344
  v_mfma_f32_16x16x32_bf16 v[100:103], a[164:167], v[40:43], v[100:103]
  v_mfma_f32_16x16x32_bf16 v[112:115], a[168:171], v[40:43], v[112:115]
  v_mfma_f32_16x16x32_bf16 v[116:119], a[172:175], v[40:43], v[116:119]
  s_waitcnt lgkmcnt(5)
  v_xor_b32 v10, 0x10000, v10
  v_mfma_f32_16x16x32_bf16 v[104:107], a[160:163], v[44:47], v[104:107]
  ds_read_b128 v[36:39], v11 offset:57344
  v_mfma_f32_16x16x32_bf16 v[108:111], a[164:167], v[44:47], v[108:111]
  v_mfma_f32_16x16x32_bf16 v[120:123], a[168:171], v[44:47], v[120:123]
  buffer_store_dwordx4 v[136:139], v7, s[4:7], s21 offen offset:2048 sc1
  v_mfma_f32_16x16x32_bf16 v[124:127], a[172:175], v[44:47], v[124:127]
  s_waitcnt lgkmcnt(5)
  v_xor_b32 v11, 0x10000, v11
  v_mfma_f32_16x16x32_bf16 v[96:99], a[176:179], v[48:51], v[96:99]
  ds_read_b128 v[40:43], v12 offset:57344
  v_mfma_f32_16x16x32_bf16 v[100:103], a[180:183], v[48:51], v[100:103]
  v_mfma_f32_16x16x32_bf16 v[112:115], a[184:187], v[48:51], v[112:115]
  v_mfma_f32_16x16x32_bf16 v[116:119], a[188:191], v[48:51], v[116:119]
  s_waitcnt lgkmcnt(5)
  v_xor_b32 v12, 0x10000, v12
  v_mfma_f32_16x16x32_bf16 v[104:107], a[176:179], v[52:55], v[104:107]
  ds_read_b128 v[44:47], v13 offset:57344
  v_mfma_f32_16x16x32_bf16 v[108:111], a[180:183], v[52:55], v[108:111]
  v_mfma_f32_16x16x32_bf16 v[120:123], a[184:187], v[52:55], v[120:123]
  buffer_store_dwordx4 v[140:143], v7, s[4:7], s21 offen offset:2304 sc1
  v_mfma_f32_16x16x32_bf16 v[124:127], a[188:191], v[52:55], v[124:127]
  s_waitcnt lgkmcnt(5)
  v_xor_b32 v13, 0x10000, v13
  v_mfma_f32_16x16x32_bf16 v[96:99], a[192:195], v[24:27], v[96:99]
  s_mov_b32 s21, s27
  ds_read_b128 v[48:51], v14 offset:57344
  v_mfma_f32_16x16x32_bf16 v[100:103], a[196:199], v[24:27], v[100:103]
  v_mov_b32 v7, v56
  v_mfma_f32_16x16x32_bf16 v[112:115], a[200:203], v[24:27], v[112:115]
  v_mfma_f32_16x16x32_bf16 v[116:119], a[204:207], v[24:27], v[116:119]
  s_waitcnt lgkmcnt(5)
  v_xor_b32 v14, 0x10000, v14
  v_mfma_f32_16x16x32_bf16 v[104:107], a[192:195], v[28:31], v[104:107]
  s_add_u32 s27, s27, s22
  ds_read_b128 v[52:55], v15 offset:57344
  v_mfma_f32_16x16x32_bf16 v[108:111], a[196:199], v[28:31], v[108:111]
  v_mfma_f32_16x16x32_bf16 v[120:123], a[200:203], v[28:31], v[120:123]
  s_waitcnt vmcnt(16)
  s_barrier
  v_mfma_f32_16x16x32_bf16 v[124:127], a[204:207], v[28:31], v[124:127]
  s_waitcnt lgkmcnt(5)
  v_xor_b32 v15, 0x10000, v15
  v_mfma_f32_16x16x32_bf16 v[96:99], a[208:211], v[32:35], v[96:99]
  ds_read_b128 v[24:27], v8 offset:0
  v_mfma_f32_16x16x32_bf16 v[100:103], a[212:215], v[32:35], v[100:103]
  v_mfma_f32_16x16x32_bf16 v[112:115], a[216:219], v[32:35], v[112:115]
  v_mfma_f32_16x16x32_bf16 v[116:119], a[220:223], v[32:35], v[116:119]
  s_waitcnt lgkmcnt(5)
  v_mfma_f32_16x16x32_bf16 v[104:107], a[208:211], v[36:39], v[104:107]
  ds_read_b128 v[28:31], v9 offset:0
  v_mfma_f32_16x16x32_bf16 v[108:111], a[212:215], v[36:39], v[108:111]
  v_mfma_f32_16x16x32_bf16 v[120:123], a[216:219], v[36:39], v[120:123]
  v_mfma_f32_16x16x32_bf16 v[124:127], a[220:223], v[36:39], v[124:127]
  s_waitcnt lgkmcnt(5)
  v_mfma_f32_16x16x32_bf16 v[96:99], a[224:227], v[40:43], v[96:99]
  ds_read_b128 v[32:35], v10 offset:0
  v_mfma_f32_16x16x32_bf16 v[100:103], a[228:231], v[40:43], v[100:103]
  v_mfma_f32_16x16x32_bf16 v[112:115], a[232:235], v[40:43], v[112:115]
  v_mfma_f32_16x16x32_bf16 v[116:119], a[236:239], v[40:43], v[116:119]
  s_waitcnt lgkmcnt(5)
  v_mfma_f32_16x16x32_bf16 v[104:107], a[224:227], v[44:47], v[104:107]
  ds_read_b128 v[36:39], v11 offset:0
  v_mfma_f32_16x16x32_bf16 v[108:111], a[228:231], v[44:47], v[108:111]
  v_mfma_f32_16x16x32_bf16 v[120:123], a[232:235], v[44:47], v[120:123]
  v_mfma_f32_16x16x32_bf16 v[124:127], a[236:239], v[44:47], v[124:127]
  s_waitcnt lgkmcnt(5)
  v_mfma_f32_16x16x32_bf16 v[96:99], a[240:243], v[48:51], v[96:99]
  s_sub_u32 s23, s23, 1
  ds_read_b128 v[40:43], v12 offset:0
  v_mfma_f32_16x16x32_bf16 v[100:103], a[244:247], v[48:51], v[100:103]
  v_mfma_f32_16x16x32_bf16 v[112:115], a[248:251], v[48:51], v[112:115]
  v_mfma_f32_16x16x32_bf16 v[116:119], a[252:255], v[48:51], v[116:119]
  s_waitcnt lgkmcnt(5)
  v_mfma_f32_16x16x32_bf16 v[104:107], a[240:243], v[52:55], v[104:107]
  s_cmp_eq_u32 s23, 0
  ds_read_b128 v[44:47], v13 offset:0
  v_mfma_f32_16x16x32_bf16 v[108:111], a[244:247], v[52:55], v[108:111]
  v_mfma_f32_16x16x32_bf16 v[120:123], a[248:251], v[52:55], v[120:123]
  v_mfma_f32_16x16x32_bf16 v[124:127], a[252:255], v[52:55], v[124:127]
  s_cbranch_scc1 G_done1_181
  s_branch G_top_179
G_done0_180:
  s_nop 7
  s_nop 3
  v_cvt_pk_bf16_f32 v128, v64, v65
  v_cvt_pk_bf16_f32 v129, v66, v67
  v_cvt_pk_bf16_f32 v130, v68, v69
  v_cvt_pk_bf16_f32 v131, v70, v71
  buffer_store_dwordx4 v[128:131], v7, s[4:7], s21 offen offset:0 sc1
  v_cvt_pk_bf16_f32 v132, v72, v73
  v_cvt_pk_bf16_f32 v133, v74, v75
  v_cvt_pk_bf16_f32 v134, v76, v77
  v_cvt_pk_bf16_f32 v135, v78, v79
  buffer_store_dwordx4 v[132:135], v7, s[4:7], s21 offen offset:256 sc1
  v_cvt_pk_bf16_f32 v136, v80, v81
  v_cvt_pk_bf16_f32 v137, v82, v83
  v_cvt_pk_bf16_f32 v138, v84, v85
  v_cvt_pk_bf16_f32 v139, v86, v87
  buffer_store_dwordx4 v[136:139], v7, s[4:7], s21 offen offset:2048 sc1
  v_cvt_pk_bf16_f32 v140, v88, v89
  v_cvt_pk_bf16_f32 v141, v90, v91
  v_cvt_pk_bf16_f32 v142, v92, v93
  v_cvt_pk_bf16_f32 v143, v94, v95
  buffer_store_dwordx4 v[140:143], v7, s[4:7], s21 offen offset:2304 sc1
  s_branch G_fin_182
G_done1_181:
  s_nop 7
  s_nop 3
  v_cvt_pk_bf16_f32 v128, v96, v97
  v_cvt_pk_bf16_f32 v129, v98, v99
  v_cvt_pk_bf16_f32 v130, v100, v101
  v_cvt_pk_bf16_f32 v131, v102, v103
  buffer_store_dwordx4 v[128:131], v7, s[4:7], s21 offen offset:0 sc1
  v_cvt_pk_bf16_f32 v132, v104, v105
  v_cvt_pk_bf16_f32 v133, v106, v107
  v_cvt_pk_bf16_f32 v134, v108, v109
  v_cvt_pk_bf16_f32 v135, v110, v111
  buffer_store_dwordx4 v[132:135], v7, s[4:7], s21 offen offset:256 sc1
  v_cvt_pk_bf16_f32 v136, v112, v113
  v_cvt_pk_bf16_f32 v137, v114, v115
  v_cvt_pk_bf16_f32 v138, v116, v117
  v_cvt_pk_bf16_f32 v139, v118, v119
  buffer_store_dwordx4 v[136:139], v7, s[4:7], s21 offen offset:2048 sc1
  v_cvt_pk_bf16_f32 v140, v120, v121
  v_cvt_pk_bf16_f32 v141, v122, v123
  v_cvt_pk_bf16_f32 v142, v124, v125
  v_cvt_pk_bf16_f32 v143, v126, v127
  buffer_store_dwordx4 v[140:143], v7, s[4:7], s21 offen offset:2304 sc1
G_fin_182:
  s_waitcnt vmcnt(0) lgkmcnt(0)
  s_barrier
  s_waitcnt vmcnt(0)
  s_barrier
  s_mov_b32 s30, 768
  v_mov_b32 v144, s30
  v_min_u32 v145, 1, v0
  v_lshlrev_b32 v145, 30, v145
  buffer_store_dword v144, v145, s[4:7], s31 offen sc1
  s_mul_i32 s50, s64, 6
  s_add_u32 s50, s50, s65
  s_mul_i32 s76, s50, 21846
  s_lshr_b32 s76, s76, 16
  s_mul_i32 s77, s76, 3
  s_add_u32 s51, s50, 64
  s_cmp_eq_u32 s77, s50
  s_cselect_b32 s50, s76, s51
M_fin:
  s_lshr_b32 s48, s50, 2
  s_and_b32 s49, s50, 3
  s_load_dwordx2 s[8:9], s[0:1], 0
  s_load_dwordx2 s[12:13], s[0:1], 104
  s_load_dwordx2 s[32:33], s[0:1], 112
  v_and_b32 v4, 31, v1
  v_lshrrev_b32 v5, 5, v1
  v_lshlrev_b32 v5, 4, v5
  v_lshl_add_u32 v6, v4, 10, v5
  s_lshl_b32 s26, s16, 8
  s_lshl_b32 s27, s48, 15
  s_add_u32 s27, s27, s26
  s_waitcnt lgkmcnt(0)
  s_and_b32 s9, s9, 0xffff
  s_mov_b32 s10, 2097152
  s_mov_b32 s11, 0x20000
  s_and_b32 s13, s13, 0xffff
  s_mov_b32 s14, 1024
  s_mov_b32 s15, 0x20000
  s_and_b32 s33, s33, 0xffff
  s_mov_b32 s34, 2097152
  s_mov_b32 s35, 0x20000
  buffer_load_dwordx4 v[16:19], v6, s[8:11], s27 offen offset:0
  buffer_load_dwordx4 v[48:51], v5, s[12:15], s26 offen offset:0
  buffer_load_dwordx4 v[20:23], v6, s[8:11], s27 offen offset:32
  buffer_load_dwordx4 v[52:55], v5, s[12:15], s26 offen offset:32
  buffer_load_dwordx4 v[24:27], v6, s[8:11], s27 offen offset:64
  buffer_load_dwordx4 v[56:59], v5, s[12:15], s26 offen offset:64
  buffer_load_dwordx4 v[28:31], v6, s[8:11], s27 offen offset:96
  buffer_load_dwordx4 v[60:63], v5, s[12:15], s26 offen offset:96
  buffer_load_dwordx4 v[32:35], v6, s[8:11], s27 offen offset:128
  buffer_load_dwordx4 v[64:67], v5, s[12:15], s26 offen offset:128
  buffer_load_dwordx4 v[36:39], v6, s[8:11], s27 offen offset:160
  buffer_load_dwordx4 v[68:71], v5, s[12:15], s26 offen offset:160
  buffer_load_dwordx4 v[40:43], v6, s[8:11], s27 offen offset:192
  buffer_load_dwordx4 v[72:75], v5, s[12:15], s26 offen offset:192
  buffer_load_dwordx4 v[44:47], v6, s[8:11], s27 offen offset:224
  buffer_load_dwordx4 v[76:79], v5, s[12:15], s26 offen offset:224
  s_lshl_b32 s28, s48, 2
  s_add_u32 s28, s28, s49
  s_lshl_b32 s28, s28, 2
  s_add_u32 s28, s28, s16
  s_lshl_b32 s28, s28, 11
  s_waitcnt vmcnt(14)
  v_mfma_f32_32x32x16_bf16 v[80:95], v[48:51], v[16:19], 0
  s_waitcnt vmcnt(12)
  v_mfma_f32_32x32x16_bf16 v[80:95], v[52:55], v[20:23], v[80:95]
  s_waitcnt vmcnt(10)
  v_mfma_f32_32x32x16_bf16 v[80:95], v[56:59], v[24:27], v[80:95]
  s_waitcnt vmcnt(8)
  v_mfma_f32_32x32x16_bf16 v[80:95], v[60:63], v[28:31], v[80:95]
  s_waitcnt vmcnt(6)
  v_mfma_f32_32x32x16_bf16 v[80:95], v[64:67], v[32:35], v[80:95]
  s_waitcnt vmcnt(4)
  v_mfma_f32_32x32x16_bf16 v[80:95], v[68:71], v[36:39], v[80:95]
  s_waitcnt vmcnt(2)
  v_mfma_f32_32x32x16_bf16 v[80:95], v[72:75], v[40:43], v[80:95]
  s_waitcnt vmcnt(0)
  v_mfma_f32_32x32x16_bf16 v[80:95], v[76:79], v[44:47], v[80:95]
  s_mul_i32 s76, s48, 43
  s_lshr_b32 s76, s76, 9
  s_mul_i32 s76, s76, 12
  s_sub_u32 s76, s48, s76
  s_cmp_ge_u32 s76, 6
  s_addc_u32 s76, s76, 0
  s_and_b32 s77, s49, 2
  s_mul_i32 s77, s77, 7
  s_add_u32 s76, s76, s77
  v_mov_b32 v193, 0x300
  s_lshl_b32 s76, s76, 7
  s_add_u32 s76, s76, 148897792
  v_and_b32 v192, 7, v1
  v_mul_u32_u24 v192, 3584, v192
  v_add_u32 v192, s76, v192
  s_mov_b32 s71, 0
  s_branch M_vg_184
M_vw_183:
  s_sleep 2
  s_add_u32 s71, s71, 1
  s_cmp_gt_u32 s71, 262144
  s_cbranch_scc1 M_exit
M_vg_184:
  buffer_load_dword v194, v192, s[4:7], 0 offen sc1
  s_waitcnt vmcnt(0)
  v_cmp_lt_u32 vcc, v194, v193
  s_cbranch_vccnz M_vw_183
  s_add_u32 s29, s28, 150994944
  buffer_load_dwordx4 v[96:99], v2, s[4:7], s29 offen offset:0 sc1
  buffer_load_dwordx4 v[100:103], v2, s[4:7], s29 offen offset:1024 sc1
  s_add_u32 s29, s28, 153092096
  buffer_load_dwordx4 v[104:107], v2, s[4:7], s29 offen offset:0 sc1
  buffer_load_dwordx4 v[108:111], v2, s[4:7], s29 offen offset:1024 sc1
  s_add_u32 s29, s28, 155189248
  buffer_load_dwordx4 v[112:115], v2, s[4:7], s29 offen offset:0 sc1
  buffer_load_dwordx4 v[116:119], v2, s[4:7], s29 offen offset:1024 sc1
  s_add_u32 s29, s28, 157286400
  buffer_load_dwordx4 v[120:123], v2, s[4:7], s29 offen offset:0 sc1
  buffer_load_dwordx4 v[124:127], v2, s[4:7], s29 offen offset:1024 sc1
  s_add_u32 s29, s28, 159383552
  buffer_load_dwordx4 v[128:131], v2, s[4:7], s29 offen offset:0 sc1
  buffer_load_dwordx4 v[132:135], v2, s[4:7], s29 offen offset:1024 sc1
  s_add_u32 s29, s28, 161480704
  buffer_load_dwordx4 v[136:139], v2, s[4:7], s29 offen offset:0 sc1
  buffer_load_dwordx4 v[140:143], v2, s[4:7], s29 offen offset:1024 sc1
  s_add_u32 s29, s28, 163577856
  buffer_load_dwordx4 v[144:147], v2, s[4:7], s29 offen offset:0 sc1
  buffer_load_dwordx4 v[148:151], v2, s[4:7], s29 offen offset:1024 sc1
  s_add_u32 s29, s28, 165675008
  buffer_load_dwordx4 v[152:155], v2, s[4:7], s29 offen offset:0 sc1
  buffer_load_dwordx4 v[156:159], v2, s[4:7], s29 offen offset:1024 sc1
  v_lshlrev_b32 v7, 4, v4
  s_lshl_b32 s26, s16, 2
  v_add_u32 v4, s26, v7
  s_barrier
  ds_write_b32 v4, v80
  s_waitcnt lgkmcnt(0)
  s_barrier
  ds_read_b128 v[84:87], v7
  s_waitcnt lgkmcnt(0)
  v_add_f32 v80, v84, v85
  v_add_f32 v81, v86, v87
  v_add_f32 v80, v80, v81
  v_mul_f32 v80, 0xbfb8aa3b, v80
  v_exp_f32 v80, v80
  s_nop 0
  v_add_f32 v80, 1.0, v80
  v_rcp_f32 v80, v80
  s_nop 0
  v_sub_f32 v82, 1.0, v80
  s_waitcnt vmcnt(14)
  v_lshlrev_b32 v160, 16, v96
  v_and_b32 v161, 0xffff0000, v96
  v_lshlrev_b32 v162, 16, v97
  v_and_b32 v163, 0xffff0000, v97
  v_lshlrev_b32 v164, 16, v98
  v_and_b32 v165, 0xffff0000, v98
  v_lshlrev_b32 v166, 16, v99
  v_and_b32 v167, 0xffff0000, v99
  v_lshlrev_b32 v168, 16, v100
  v_and_b32 v169, 0xffff0000, v100
  v_lshlrev_b32 v170, 16, v101
  v_and_b32 v171, 0xffff0000, v101
  v_lshlrev_b32 v172, 16, v102
  v_and_b32 v173, 0xffff0000, v102
  v_lshlrev_b32 v174, 16, v103
  v_and_b32 v175, 0xffff0000, v103
  s_waitcnt vmcnt(12)
  v_lshlrev_b32 v8, 16, v104
  v_and_b32 v9, 0xffff0000, v104
  v_pk_add_f32 v[160:161], v[160:161], v[8:9]
  v_lshlrev_b32 v10, 16, v105
  v_and_b32 v11, 0xffff0000, v105
  v_pk_add_f32 v[162:163], v[162:163], v[10:11]
  v_lshlrev_b32 v12, 16, v106
  v_and_b32 v13, 0xffff0000, v106
  v_pk_add_f32 v[164:165], v[164:165], v[12:13]
  v_lshlrev_b32 v14, 16, v107
  v_and_b32 v15, 0xffff0000, v107
  v_pk_add_f32 v[166:167], v[166:167], v[14:15]
  v_lshlrev_b32 v8, 16, v108
  v_and_b32 v9, 0xffff0000, v108
  v_pk_add_f32 v[168:169], v[168:169], v[8:9]
  v_lshlrev_b32 v10, 16, v109
  v_and_b32 v11, 0xffff0000, v109
  v_pk_add_f32 v[170:171], v[170:171], v[10:11]
  v_lshlrev_b32 v12, 16, v110
  v_and_b32 v13, 0xffff0000, v110
  v_pk_add_f32 v[172:173], v[172:173], v[12:13]
  v_lshlrev_b32 v14, 16, v111
  v_and_b32 v15, 0xffff0000, v111
  v_pk_add_f32 v[174:175], v[174:175], v[14:15]
  s_waitcnt vmcnt(10)
  v_lshlrev_b32 v8, 16, v112
  v_and_b32 v9, 0xffff0000, v112
  v_pk_add_f32 v[160:161], v[160:161], v[8:9]
  v_lshlrev_b32 v10, 16, v113
  v_and_b32 v11, 0xffff0000, v113
  v_pk_add_f32 v[162:163], v[162:163], v[10:11]
  v_lshlrev_b32 v12, 16, v114
  v_and_b32 v13, 0xffff0000, v114
  v_pk_add_f32 v[164:165], v[164:165], v[12:13]
  v_lshlrev_b32 v14, 16, v115
  v_and_b32 v15, 0xffff0000, v115
  v_pk_add_f32 v[166:167], v[166:167], v[14:15]
  v_lshlrev_b32 v8, 16, v116
  v_and_b32 v9, 0xffff0000, v116
  v_pk_add_f32 v[168:169], v[168:169], v[8:9]
  v_lshlrev_b32 v10, 16, v117
  v_and_b32 v11, 0xffff0000, v117
  v_pk_add_f32 v[170:171], v[170:171], v[10:11]
  v_lshlrev_b32 v12, 16, v118
  v_and_b32 v13, 0xffff0000, v118
  v_pk_add_f32 v[172:173], v[172:173], v[12:13]
  v_lshlrev_b32 v14, 16, v119
  v_and_b32 v15, 0xffff0000, v119
  v_pk_add_f32 v[174:175], v[174:175], v[14:15]
  s_waitcnt vmcnt(8)
  v_lshlrev_b32 v8, 16, v120
  v_and_b32 v9, 0xffff0000, v120
  v_pk_add_f32 v[160:161], v[160:161], v[8:9]
  v_lshlrev_b32 v10, 16, v121
  v_and_b32 v11, 0xffff0000, v121
  v_pk_add_f32 v[162:163], v[162:163], v[10:11]
  v_lshlrev_b32 v12, 16, v122
  v_and_b32 v13, 0xffff0000, v122
  v_pk_add_f32 v[164:165], v[164:165], v[12:13]
  v_lshlrev_b32 v14, 16, v123
  v_and_b32 v15, 0xffff0000, v123
  v_pk_add_f32 v[166:167], v[166:167], v[14:15]
  v_lshlrev_b32 v8, 16, v124
  v_and_b32 v9, 0xffff0000, v124
  v_pk_add_f32 v[168:169], v[168:169], v[8:9]
  v_lshlrev_b32 v10, 16, v125
  v_and_b32 v11, 0xffff0000, v125
  v_pk_add_f32 v[170:171], v[170:171], v[10:11]
  v_lshlrev_b32 v12, 16, v126
  v_and_b32 v13, 0xffff0000, v126
  v_pk_add_f32 v[172:173], v[172:173], v[12:13]
  v_lshlrev_b32 v14, 16, v127
  v_and_b32 v15, 0xffff0000, v127
  v_pk_add_f32 v[174:175], v[174:175], v[14:15]
  s_waitcnt vmcnt(6)
  v_lshlrev_b32 v8, 16, v128
  v_and_b32 v9, 0xffff0000, v128
  v_pk_add_f32 v[160:161], v[160:161], v[8:9]
  v_lshlrev_b32 v10, 16, v129
  v_and_b32 v11, 0xffff0000, v129
  v_pk_add_f32 v[162:163], v[162:163], v[10:11]
  v_lshlrev_b32 v12, 16, v130
  v_and_b32 v13, 0xffff0000, v130
  v_pk_add_f32 v[164:165], v[164:165], v[12:13]
  v_lshlrev_b32 v14, 16, v131
  v_and_b32 v15, 0xffff0000, v131
  v_pk_add_f32 v[166:167], v[166:167], v[14:15]
  v_lshlrev_b32 v8, 16, v132
  v_and_b32 v9, 0xffff0000, v132
  v_pk_add_f32 v[168:169], v[168:169], v[8:9]
  v_lshlrev_b32 v10, 16, v133
  v_and_b32 v11, 0xffff0000, v133
  v_pk_add_f32 v[170:171], v[170:171], v[10:11]
  v_lshlrev_b32 v12, 16, v134
  v_and_b32 v13, 0xffff0000, v134
  v_pk_add_f32 v[172:173], v[172:173], v[12:13]
  v_lshlrev_b32 v14, 16, v135
  v_and_b32 v15, 0xffff0000, v135
  v_pk_add_f32 v[174:175], v[174:175], v[14:15]
  s_waitcnt vmcnt(4)
  v_lshlrev_b32 v8, 16, v136
  v_and_b32 v9, 0xffff0000, v136
  v_pk_add_f32 v[160:161], v[160:161], v[8:9]
  v_lshlrev_b32 v10, 16, v137
  v_and_b32 v11, 0xffff0000, v137
  v_pk_add_f32 v[162:163], v[162:163], v[10:11]
  v_lshlrev_b32 v12, 16, v138
  v_and_b32 v13, 0xffff0000, v138
  v_pk_add_f32 v[164:165], v[164:165], v[12:13]
  v_lshlrev_b32 v14, 16, v139
  v_and_b32 v15, 0xffff0000, v139
  v_pk_add_f32 v[166:167], v[166:167], v[14:15]
  v_lshlrev_b32 v8, 16, v140
  v_and_b32 v9, 0xffff0000, v140
  v_pk_add_f32 v[168:169], v[168:169], v[8:9]
  v_lshlrev_b32 v10, 16, v141
  v_and_b32 v11, 0xffff0000, v141
  v_pk_add_f32 v[170:171], v[170:171], v[10:11]
  v_lshlrev_b32 v12, 16, v142
  v_and_b32 v13, 0xffff0000, v142
  v_pk_add_f32 v[172:173], v[172:173], v[12:13]
  v_lshlrev_b32 v14, 16, v143
  v_and_b32 v15, 0xffff0000, v143
  v_pk_add_f32 v[174:175], v[174:175], v[14:15]
  s_waitcnt vmcnt(2)
  v_lshlrev_b32 v8, 16, v144
  v_and_b32 v9, 0xffff0000, v144
  v_pk_add_f32 v[160:161], v[160:161], v[8:9]
  v_lshlrev_b32 v10, 16, v145
  v_and_b32 v11, 0xffff0000, v145
  v_pk_add_f32 v[162:163], v[162:163], v[10:11]
  v_lshlrev_b32 v12, 16, v146
  v_and_b32 v13, 0xffff0000, v146
  v_pk_add_f32 v[164:165], v[164:165], v[12:13]
  v_lshlrev_b32 v14, 16, v147
  v_and_b32 v15, 0xffff0000, v147
  v_pk_add_f32 v[166:167], v[166:167], v[14:15]
  v_lshlrev_b32 v8, 16, v148
  v_and_b32 v9, 0xffff0000, v148
  v_pk_add_f32 v[168:169], v[168:169], v[8:9]
  v_lshlrev_b32 v10, 16, v149
  v_and_b32 v11, 0xffff0000, v149
  v_pk_add_f32 v[170:171], v[170:171], v[10:11]
  v_lshlrev_b32 v12, 16, v150
  v_and_b32 v13, 0xffff0000, v150
  v_pk_add_f32 v[172:173], v[172:173], v[12:13]
  v_lshlrev_b32 v14, 16, v151
  v_and_b32 v15, 0xffff0000, v151
  v_pk_add_f32 v[174:175], v[174:175], v[14:15]
  s_waitcnt vmcnt(0)
  v_lshlrev_b32 v8, 16, v152
  v_and_b32 v9, 0xffff0000, v152
  v_pk_add_f32 v[160:161], v[160:161], v[8:9]
  v_lshlrev_b32 v10, 16, v153
  v_and_b32 v11, 0xffff0000, v153
  v_pk_add_f32 v[162:163], v[162:163], v[10:11]
  v_lshlrev_b32 v12, 16, v154
  v_and_b32 v13, 0xffff0000, v154
  v_pk_add_f32 v[164:165], v[164:165], v[12:13]
  v_lshlrev_b32 v14, 16, v155
  v_and_b32 v15, 0xffff0000, v155
  v_pk_add_f32 v[166:167], v[166:167], v[14:15]
  v_lshlrev_b32 v8, 16, v156
  v_and_b32 v9, 0xffff0000, v156
  v_pk_add_f32 v[168:169], v[168:169], v[8:9]
  v_lshlrev_b32 v10, 16, v157
  v_and_b32 v11, 0xffff0000, v157
  v_pk_add_f32 v[170:171], v[170:171], v[10:11]
  v_lshlrev_b32 v12, 16, v158
  v_and_b32 v13, 0xffff0000, v158
  v_pk_add_f32 v[172:173], v[172:173], v[12:13]
  v_lshlrev_b32 v14, 16, v159
  v_and_b32 v15, 0xffff0000, v159
  v_pk_add_f32 v[174:175], v[174:175], v[14:15]
  s_and_b32 s76, s48, 1
  s_lshl_b32 s76, s76, 1
  s_lshr_b32 s77, s49, 1
  s_add_u32 s76, s76, s77
  s_mul_i32 s76, s76, 7
  s_add_u32 s76, s76, 6
  s_lshr_b32 s77, s48, 1
  s_add_u32 s77, s77, 0x201
  v_mov_b32 v193, s77
  s_lshl_b32 s76, s76, 7
  s_add_u32 s76, s76, 148897792
  v_and_b32 v192, 7, v1
  v_mul_u32_u24 v192, 3584, v192
  v_add_u32 v192, s76, v192
  s_mov_b32 s71, 0
  s_branch M_vg_186
M_vw_185:
  s_sleep 2
  s_add_u32 s71, s71, 1
  s_cmp_gt_u32 s71, 262144
  s_cbranch_scc1 M_exit
M_vg_186:
  buffer_load_dword v194, v192, s[4:7], 0 offen sc1
  s_waitcnt vmcnt(0)
  v_cmp_lt_u32 vcc, v194, v193
  s_cbranch_vccnz M_vw_185
  s_add_u32 s29, s28, 167772160
  buffer_load_dwordx4 v[96:99], v2, s[4:7], s29 offen offset:0 sc1
  buffer_load_dwordx4 v[100:103], v2, s[4:7], s29 offen offset:1024 sc1
  s_add_u32 s29, s28, 169869312
  buffer_load_dwordx4 v[104:107], v2, s[4:7], s29 offen offset:0 sc1
  buffer_load_dwordx4 v[108:111], v2, s[4:7], s29 offen offset:1024 sc1
  s_add_u32 s29, s28, 171966464
  buffer_load_dwordx4 v[112:115], v2, s[4:7], s29 offen offset:0 sc1
  buffer_load_dwordx4 v[116:119], v2, s[4:7], s29 offen offset:1024 sc1
  s_add_u32 s29, s28, 174063616
  buffer_load_dwordx4 v[120:123], v2, s[4:7], s29 offen offset:0 sc1
  buffer_load_dwordx4 v[124:127], v2, s[4:7], s29 offen offset:1024 sc1
  s_add_u32 s29, s28, 176160768
  buffer_load_dwordx4 v[128:131], v2, s[4:7], s29 offen offset:0 sc1
  buffer_load_dwordx4 v[132:135], v2, s[4:7], s29 offen offset:1024 sc1
  s_add_u32 s29, s28, 178257920
  buffer_load_dwordx4 v[136:139], v2, s[4:7], s29 offen offset:0 sc1
  buffer_load_dwordx4 v[140:143], v2, s[4:7], s29 offen offset:1024 sc1
  s_add_u32 s29, s28, 180355072
  buffer_load_dwordx4 v[144:147], v2, s[4:7], s29 offen offset:0 sc1
  buffer_load_dwordx4 v[148:151], v2, s[4:7], s29 offen offset:1024 sc1
  s_add_u32 s29, s28, 182452224
  buffer_load_dwordx4 v[152:155], v2, s[4:7], s29 offen offset:0 sc1
  buffer_load_dwordx4 v[156:159], v2, s[4:7], s29 offen offset:1024 sc1
  v_pk_mul_f32 v[160:161], v[160:161], v[80:81] op_sel_hi:[1,0]
  v_pk_mul_f32 v[162:163], v[162:163], v[80:81] op_sel_hi:[1,0]
  v_pk_mul_f32 v[164:165], v[164:165], v[80:81] op_sel_hi:[1,0]
  v_pk_mul_f32 v[166:167], v[166:167], v[80:81] op_sel_hi:[1,0]
  v_pk_mul_f32 v[168:169], v[168:169], v[80:81] op_sel_hi:[1,0]
  v_pk_mul_f32 v[170:171], v[170:171], v[80:81] op_sel_hi:[1,0]
  v_pk_mul_f32 v[172:173], v[172:173], v[80:81] op_sel_hi:[1,0]
  v_pk_mul_f32 v[174:175], v[174:175], v[80:81] op_sel_hi:[1,0]
  s_waitcnt vmcnt(14)
  v_lshlrev_b32 v176, 16, v96
  v_and_b32 v177, 0xffff0000, v96
  v_lshlrev_b32 v178, 16, v97
  v_and_b32 v179, 0xffff0000, v97
  v_lshlrev_b32 v180, 16, v98
  v_and_b32 v181, 0xffff0000, v98
  v_lshlrev_b32 v182, 16, v99
  v_and_b32 v183, 0xffff0000, v99
  v_lshlrev_b32 v184, 16, v100
  v_and_b32 v185, 0xffff0000, v100
  v_lshlrev_b32 v186, 16, v101
  v_and_b32 v187, 0xffff0000, v101
  v_lshlrev_b32 v188, 16, v102
  v_and_b32 v189, 0xffff0000, v102
  v_lshlrev_b32 v190, 16, v103
  v_and_b32 v191, 0xffff0000, v103
  s_waitcnt vmcnt(12)
  v_lshlrev_b32 v8, 16, v104
  v_and_b32 v9, 0xffff0000, v104
  v_pk_add_f32 v[176:177], v[176:177], v[8:9]
  v_lshlrev_b32 v10, 16, v105
  v_and_b32 v11, 0xffff0000, v105
  v_pk_add_f32 v[178:179], v[178:179], v[10:11]
  v_lshlrev_b32 v12, 16, v106
  v_and_b32 v13, 0xffff0000, v106
  v_pk_add_f32 v[180:181], v[180:181], v[12:13]
  v_lshlrev_b32 v14, 16, v107
  v_and_b32 v15, 0xffff0000, v107
  v_pk_add_f32 v[182:183], v[182:183], v[14:15]
  v_lshlrev_b32 v8, 16, v108
  v_and_b32 v9, 0xffff0000, v108
  v_pk_add_f32 v[184:185], v[184:185], v[8:9]
  v_lshlrev_b32 v10, 16, v109
  v_and_b32 v11, 0xffff0000, v109
  v_pk_add_f32 v[186:187], v[186:187], v[10:11]
  v_lshlrev_b32 v12, 16, v110
  v_and_b32 v13, 0xffff0000, v110
  v_pk_add_f32 v[188:189], v[188:189], v[12:13]
  v_lshlrev_b32 v14, 16, v111
  v_and_b32 v15, 0xffff0000, v111
  v_pk_add_f32 v[190:191], v[190:191], v[14:15]
  s_waitcnt vmcnt(10)
  v_lshlrev_b32 v8, 16, v112
  v_and_b32 v9, 0xffff0000, v112
  v_pk_add_f32 v[176:177], v[176:177], v[8:9]
  v_lshlrev_b32 v10, 16, v113
  v_and_b32 v11, 0xffff0000, v113
  v_pk_add_f32 v[178:179], v[178:179], v[10:11]
  v_lshlrev_b32 v12, 16, v114
  v_and_b32 v13, 0xffff0000, v114
  v_pk_add_f32 v[180:181], v[180:181], v[12:13]
  v_lshlrev_b32 v14, 16, v115
  v_and_b32 v15, 0xffff0000, v115
  v_pk_add_f32 v[182:183], v[182:183], v[14:15]
  v_lshlrev_b32 v8, 16, v116
  v_and_b32 v9, 0xffff0000, v116
  v_pk_add_f32 v[184:185], v[184:185], v[8:9]
  v_lshlrev_b32 v10, 16, v117
  v_and_b32 v11, 0xffff0000, v117
  v_pk_add_f32 v[186:187], v[186:187], v[10:11]
  v_lshlrev_b32 v12, 16, v118
  v_and_b32 v13, 0xffff0000, v118
  v_pk_add_f32 v[188:189], v[188:189], v[12:13]
  v_lshlrev_b32 v14, 16, v119
  v_and_b32 v15, 0xffff0000, v119
  v_pk_add_f32 v[190:191], v[190:191], v[14:15]
  s_waitcnt vmcnt(8)
  v_lshlrev_b32 v8, 16, v120
  v_and_b32 v9, 0xffff0000, v120
  v_pk_add_f32 v[176:177], v[176:177], v[8:9]
  v_lshlrev_b32 v10, 16, v121
  v_and_b32 v11, 0xffff0000, v121
  v_pk_add_f32 v[178:179], v[178:179], v[10:11]
  v_lshlrev_b32 v12, 16, v122
  v_and_b32 v13, 0xffff0000, v122
  v_pk_add_f32 v[180:181], v[180:181], v[12:13]
  v_lshlrev_b32 v14, 16, v123
  v_and_b32 v15, 0xffff0000, v123
  v_pk_add_f32 v[182:183], v[182:183], v[14:15]
  v_lshlrev_b32 v8, 16, v124
  v_and_b32 v9, 0xffff0000, v124
  v_pk_add_f32 v[184:185], v[184:185], v[8:9]
  v_lshlrev_b32 v10, 16, v125
  v_and_b32 v11, 0xffff0000, v125
  v_pk_add_f32 v[186:187], v[186:187], v[10:11]
  v_lshlrev_b32 v12, 16, v126
  v_and_b32 v13, 0xffff0000, v126
  v_pk_add_f32 v[188:189], v[188:189], v[12:13]
  v_lshlrev_b32 v14, 16, v127
  v_and_b32 v15, 0xffff0000, v127
  v_pk_add_f32 v[190:191], v[190:191], v[14:15]
  s_waitcnt vmcnt(6)
  v_lshlrev_b32 v8, 16, v128
  v_and_b32 v9, 0xffff0000, v128
  v_pk_add_f32 v[176:177], v[176:177], v[8:9]
  v_lshlrev_b32 v10, 16, v129
  v_and_b32 v11, 0xffff0000, v129
  v_pk_add_f32 v[178:179], v[178:179], v[10:11]
  v_lshlrev_b32 v12, 16, v130
  v_and_b32 v13, 0xffff0000, v130
  v_pk_add_f32 v[180:181], v[180:181], v[12:13]
  v_lshlrev_b32 v14, 16, v131
  v_and_b32 v15, 0xffff0000, v131
  v_pk_add_f32 v[182:183], v[182:183], v[14:15]
  v_lshlrev_b32 v8, 16, v132
  v_and_b32 v9, 0xffff0000, v132
  v_pk_add_f32 v[184:185], v[184:185], v[8:9]
  v_lshlrev_b32 v10, 16, v133
  v_and_b32 v11, 0xffff0000, v133
  v_pk_add_f32 v[186:187], v[186:187], v[10:11]
  v_lshlrev_b32 v12, 16, v134
  v_and_b32 v13, 0xffff0000, v134
  v_pk_add_f32 v[188:189], v[188:189], v[12:13]
  v_lshlrev_b32 v14, 16, v135
  v_and_b32 v15, 0xffff0000, v135
  v_pk_add_f32 v[190:191], v[190:191], v[14:15]
  s_waitcnt vmcnt(4)
  v_lshlrev_b32 v8, 16, v136
  v_and_b32 v9, 0xffff0000, v136
  v_pk_add_f32 v[176:177], v[176:177], v[8:9]
  v_lshlrev_b32 v10, 16, v137
  v_and_b32 v11, 0xffff0000, v137
  v_pk_add_f32 v[178:179], v[178:179], v[10:11]
  v_lshlrev_b32 v12, 16, v138
  v_and_b32 v13, 0xffff0000, v138
  v_pk_add_f32 v[180:181], v[180:181], v[12:13]
  v_lshlrev_b32 v14, 16, v139
  v_and_b32 v15, 0xffff0000, v139
  v_pk_add_f32 v[182:183], v[182:183], v[14:15]
  v_lshlrev_b32 v8, 16, v140
  v_and_b32 v9, 0xffff0000, v140
  v_pk_add_f32 v[184:185], v[184:185], v[8:9]
  v_lshlrev_b32 v10, 16, v141
  v_and_b32 v11, 0xffff0000, v141
  v_pk_add_f32 v[186:187], v[186:187], v[10:11]
  v_lshlrev_b32 v12, 16, v142
  v_and_b32 v13, 0xffff0000, v142
  v_pk_add_f32 v[188:189], v[188:189], v[12:13]
  v_lshlrev_b32 v14, 16, v143
  v_and_b32 v15, 0xffff0000, v143
  v_pk_add_f32 v[190:191], v[190:191], v[14:15]
  s_waitcnt vmcnt(2)
  v_lshlrev_b32 v8, 16, v144
  v_and_b32 v9, 0xffff0000, v144
  v_pk_add_f32 v[176:177], v[176:177], v[8:9]
  v_lshlrev_b32 v10, 16, v145
  v_and_b32 v11, 0xffff0000, v145
  v_pk_add_f32 v[178:179], v[178:179], v[10:11]
  v_lshlrev_b32 v12, 16, v146
  v_and_b32 v13, 0xffff0000, v146
  v_pk_add_f32 v[180:181], v[180:181], v[12:13]
  v_lshlrev_b32 v14, 16, v147
  v_and_b32 v15, 0xffff0000, v147
  v_pk_add_f32 v[182:183], v[182:183], v[14:15]
  v_lshlrev_b32 v8, 16, v148
  v_and_b32 v9, 0xffff0000, v148
  v_pk_add_f32 v[184:185], v[184:185], v[8:9]
  v_lshlrev_b32 v10, 16, v149
  v_and_b32 v11, 0xffff0000, v149
  v_pk_add_f32 v[186:187], v[186:187], v[10:11]
  v_lshlrev_b32 v12, 16, v150
  v_and_b32 v13, 0xffff0000, v150
  v_pk_add_f32 v[188:189], v[188:189], v[12:13]
  v_lshlrev_b32 v14, 16, v151
  v_and_b32 v15, 0xffff0000, v151
  v_pk_add_f32 v[190:191], v[190:191], v[14:15]
  s_waitcnt vmcnt(0)
  v_lshlrev_b32 v8, 16, v152
  v_and_b32 v9, 0xffff0000, v152
  v_pk_add_f32 v[176:177], v[176:177], v[8:9]
  v_lshlrev_b32 v10, 16, v153
  v_and_b32 v11, 0xffff0000, v153
  v_pk_add_f32 v[178:179], v[178:179], v[10:11]
  v_lshlrev_b32 v12, 16, v154
  v_and_b32 v13, 0xffff0000, v154
  v_pk_add_f32 v[180:181], v[180:181], v[12:13]
  v_lshlrev_b32 v14, 16, v155
  v_and_b32 v15, 0xffff0000, v155
  v_pk_add_f32 v[182:183], v[182:183], v[14:15]
  v_lshlrev_b32 v8, 16, v156
  v_and_b32 v9, 0xffff0000, v156
  v_pk_add_f32 v[184:185], v[184:185], v[8:9]
  v_lshlrev_b32 v10, 16, v157
  v_and_b32 v11, 0xffff0000, v157
  v_pk_add_f32 v[186:187], v[186:187], v[10:11]
  v_lshlrev_b32 v12, 16, v158
  v_and_b32 v13, 0xffff0000, v158
  v_pk_add_f32 v[188:189], v[188:189], v[12:13]
  v_lshlrev_b32 v14, 16, v159
  v_and_b32 v15, 0xffff0000, v159
  v_pk_add_f32 v[190:191], v[190:191], v[14:15]
  v_pk_fma_f32 v[160:161], v[176:177], v[82:83], v[160:161] op_sel_hi:[1,0,1]
  v_cvt_pk_bf16_f32 v16, v160, v161
  v_pk_fma_f32 v[162:163], v[178:179], v[82:83], v[162:163] op_sel_hi:[1,0,1]
  v_cvt_pk_bf16_f32 v17, v162, v163
  v_pk_fma_f32 v[164:165], v[180:181], v[82:83], v[164:165] op_sel_hi:[1,0,1]
  v_cvt_pk_bf16_f32 v18, v164, v165
  v_pk_fma_f32 v[166:167], v[182:183], v[82:83], v[166:167] op_sel_hi:[1,0,1]
  v_cvt_pk_bf16_f32 v19, v166, v167
  v_pk_fma_f32 v[168:169], v[184:185], v[82:83], v[168:169] op_sel_hi:[1,0,1]
  v_cvt_pk_bf16_f32 v20, v168, v169
  v_pk_fma_f32 v[170:171], v[186:187], v[82:83], v[170:171] op_sel_hi:[1,0,1]
  v_cvt_pk_bf16_f32 v21, v170, v171
  v_pk_fma_f32 v[172:173], v[188:189], v[82:83], v[172:173] op_sel_hi:[1,0,1]
  v_cvt_pk_bf16_f32 v22, v172, v173
  v_pk_fma_f32 v[174:175], v[190:191], v[82:83], v[174:175] op_sel_hi:[1,0,1]
  v_cvt_pk_bf16_f32 v23, v174, v175
  s_lshl_b32 s26, s49, 2
  s_add_u32 s26, s26, s16
  s_lshl_b32 s26, s26, 6
  s_lshl_b32 s27, s48, 15
  s_add_u32 s26, s26, s27
  buffer_store_dwordx4 v[16:19], v6, s[32:35], s26 offen offset:0
  buffer_store_dwordx4 v[20:23], v6, s[32:35], s26 offen offset:32
  s_cmp_lt_u32 s50, 64
  s_mov_b32 s50, s51
  s_cbranch_scc1 M_fin
  s_branch M_done
M_follow:
  s_lshr_b32 s48, s64, 2
  s_and_b32 s49, s64, 1
  s_bfe_u32 s50, s64, 0x10001
  s_mov_b32 s51, 2
  s_mov_b32 s23, 32
  s_load_dwordx2 s[8:9], s[0:1], 88
  s_lshl_b32 s17, s48, 19
  s_lshl_b32 s26, s49, 2
  s_add_u32 s26, s26, s16
  s_lshl_b32 s27, s26, 7
  s_add_u32 s17, s17, s27
  s_mov_b32 s18, 1024
  s_lshl_b32 s21, s48, 6
  s_add_u32 s21, s21, s50
  s_lshl_b32 s21, s21, 3
  s_add_u32 s21, s21, s26
  s_lshl_b32 s21, s21, 12
  s_add_u32 s21, s21, 167772160
  s_lshl_b32 s22, s51, 15
  s_mov_b32 s24, 1.0
  s_waitcnt lgkmcnt(0)
  s_and_b32 s9, s9, 0xffff
  s_mov_b32 s10, 4194304
  s_mov_b32 s11, 0x20000
  v_lshrrev_b32 v144, 4, v1
  v_and_b32 v56, 0xff, v2
  v_lshl_add_u32 v56, v144, 9, v56
  s_mul_i32 s26, s16, 0
  v_add_u32 v8, 0, v56
  v_add_u32 v16, 0, v2
  v_add_u32 v16, s26, v16
  v_add_u32 v9, 256, v56
  v_add_u32 v17, 1024, v2
  v_add_u32 v17, s26, v17
  v_add_u32 v10, 2048, v56
  v_add_u32 v18, 2048, v2
  v_add_u32 v18, s26, v18
  v_add_u32 v11, 2304, v56
  v_add_u32 v19, 3072, v2
  v_add_u32 v19, s26, v19
  v_add_u32 v12, 4096, v56
  v_add_u32 v20, 4096, v2
  v_add_u32 v20, s26, v20
  v_add_u32 v13, 4352, v56
  v_add_u32 v21, 5120, v2
  v_add_u32 v21, s26, v21
  v_add_u32 v14, 6144, v56
  v_add_u32 v22, 6144, v2
  v_add_u32 v22, s26, v22
  v_add_u32 v15, 6400, v56
  v_add_u32 v23, 7168, v2
  v_add_u32 v23, s26, v23
  v_mov_b32 v20, v56
  v_lshrrev_b32 v144, 3, v1
  v_mul_lo_u32 v144, v144, s18
  v_and_b32 v145, 7, v1
  v_lshl_add_u32 v144, v145, 4, v144
  s_lshl_b32 s28, s16, 15
  s_add_u32 s28, s28, 32768
  s_lshl_b32 s29, s18, 3
  s_add_u32 m0, s28, 0
  s_nop 0
  buffer_load_dwordx4 v144, s[8:11], s17 offen lds
  s_add_u32 s17, s17, s29
  s_add_u32 m0, s28, 1024
  s_nop 0
  buffer_load_dwordx4 v144, s[8:11], s17 offen lds
  s_add_u32 s17, s17, s29
  s_add_u32 m0, s28, 2048
  s_nop 0
  buffer_load_dwordx4 v144, s[8:11], s17 offen lds
  s_add_u32 s17, s17, s29
  s_add_u32 m0, s28, 3072
  s_nop 0
  buffer_load_dwordx4 v144, s[8:11], s17 offen lds
  s_add_u32 s17, s17, s29
  s_add_u32 m0, s28, 4096
  s_nop 0
  buffer_load_dwordx4 v144, s[8:11], s17 offen lds
  s_add_u32 s17, s17, s29
  s_add_u32 m0, s28, 5120
  s_nop 0
  buffer_load_dwordx4 v144, s[8:11], s17 offen lds
  s_add_u32 s17, s17, s29
  s_add_u32 m0, s28, 6144
  s_nop 0
  buffer_load_dwordx4 v144, s[8:11], s17 offen lds
  s_add_u32 s17, s17, s29
  s_add_u32 m0, s28, 7168
  s_nop 0
  buffer_load_dwordx4 v144, s[8:11], s17 offen lds
  s_add_u32 s17, s17, s29
  s_add_u32 m0, s28, 8192
  s_nop 0
  buffer_load_dwordx4 v144, s[8:11], s17 offen lds
  s_add_u32 s17, s17, s29
  s_add_u32 m0, s28, 9216
  s_nop 0
  buffer_load_dwordx4 v144, s[8:11], s17 offen lds
  s_add_u32 s17, s17, s29
  s_add_u32 m0, s28, 10240
  s_nop 0
  buffer_load_dwordx4 v144, s[8:11], s17 offen lds
  s_add_u32 s17, s17, s29
  s_add_u32 m0, s28, 11264
  s_nop 0
  buffer_load_dwordx4 v144, s[8:11], s17 offen lds
  s_add_u32 s17, s17, s29
  s_add_u32 m0, s28, 12288
  s_nop 0
  buffer_load_dwordx4 v144, s[8:11], s17 offen lds
  s_add_u32 s17, s17, s29
  s_add_u32 m0, s28, 13312
  s_nop 0
  buffer_load_dwordx4 v144, s[8:11], s17 offen lds
  s_add_u32 s17, s17, s29
  s_add_u32 m0, s28, 14336
  s_nop 0
  buffer_load_dwordx4 v144, s[8:11], s17 offen lds
  s_add_u32 s17, s17, s29
  s_add_u32 m0, s28, 15360
  s_nop 0
  buffer_load_dwordx4 v144, s[8:11], s17 offen lds
  s_add_u32 s17, s17, s29
  s_add_u32 m0, s28, 16384
  s_nop 0
  buffer_load_dwordx4 v144, s[8:11], s17 offen lds
  s_add_u32 s17, s17, s29
  s_add_u32 m0, s28, 17408
  s_nop 0
  buffer_load_dwordx4 v144, s[8:11], s17 offen lds
  s_add_u32 s17, s17, s29
  s_add_u32 m0, s28, 18432
  s_nop 0
  buffer_load_dwordx4 v144, s[8:11], s17 offen lds
  s_add_u32 s17, s17, s29
  s_add_u32 m0, s28, 19456
  s_nop 0
  buffer_load_dwordx4 v144, s[8:11], s17 offen lds
  s_add_u32 s17, s17, s29
  s_add_u32 m0, s28, 20480
  s_nop 0
  buffer_load_dwordx4 v144, s[8:11], s17 offen lds
  s_add_u32 s17, s17, s29
  s_add_u32 m0, s28, 21504
  s_nop 0
  buffer_load_dwordx4 v144, s[8:11], s17 offen lds
  s_add_u32 s17, s17, s29
  s_add_u32 m0, s28, 22528
  s_nop 0
  buffer_load_dwordx4 v144, s[8:11], s17 offen lds
  s_add_u32 s17, s17, s29
  s_add_u32 m0, s28, 23552
  s_nop 0
  buffer_load_dwordx4 v144, s[8:11], s17 offen lds
  s_add_u32 s17, s17, s29
  s_add_u32 m0, s28, 24576
  s_nop 0
  buffer_load_dwordx4 v144, s[8:11], s17 offen lds
  s_add_u32 s17, s17, s29
  s_add_u32 m0, s28, 25600
  s_nop 0
  buffer_load_dwordx4 v144, s[8:11], s17 offen lds
  s_add_u32 s17, s17, s29
  s_add_u32 m0, s28, 26624
  s_nop 0
  buffer_load_dwordx4 v144, s[8:11], s17 offen lds
  s_add_u32 s17, s17, s29
  s_add_u32 m0, s28, 27648
  s_nop 0
  buffer_load_dwordx4 v144, s[8:11], s17 offen lds
  s_add_u32 s17, s17, s29
  s_add_u32 m0, s28, 28672
  s_nop 0
  buffer_load_dwordx4 v144, s[8:11], s17 offen lds
  s_add_u32 s17, s17, s29
  s_add_u32 m0, s28, 29696
  s_nop 0
  buffer_load_dwordx4 v144, s[8:11], s17 offen lds
  s_add_u32 s17, s17, s29
  s_add_u32 m0, s28, 30720
  s_nop 0
  buffer_load_dwordx4 v144, s[8:11], s17 offen lds
  s_add_u32 s17, s17, s29
  s_add_u32 m0, s28, 31744
  s_nop 0
  buffer_load_dwordx4 v144, s[8:11], s17 offen lds
  s_add_u32 s17, s17, s29
  v_bfe_u32 v148, v1, 2, 2
  v_lshrrev_b32 v149, 5, v1
  v_lshl_add_u32 v148, v149, 4, v148
  v_bfe_u32 v149, v1, 4, 1
  v_lshl_add_u32 v148, v149, 2, v148
  v_and_b32 v149, 3, v1
  v_lshlrev_b32 v149, 4, v149
  s_mov_b32 s26, 8
  v_lshl_add_u32 v148, v148, 7, v149
  v_add_u32 v152, s28, v148
  v_add_u32 v153, 1024, v152
  v_add_u32 v154, s26, v152
  v_add_u32 v155, s26, v153
  s_waitcnt vmcnt(28)
  ds_read_b64_tr_b16 a[0:1], v152 offset:0
  ds_read_b64_tr_b16 a[2:3], v153 offset:0
  ds_read_b64_tr_b16 a[4:5], v154 offset:0
  ds_read_b64_tr_b16 a[6:7], v155 offset:0
  ds_read_b64_tr_b16 a[8:9], v152 offset:64
  ds_read_b64_tr_b16 a[10:11], v153 offset:64
  ds_read_b64_tr_b16 a[12:13], v154 offset:64
  ds_read_b64_tr_b16 a[14:15], v155 offset:64
  s_waitcnt lgkmcnt(0)
  s_add_u32 m0, s28, 0
  s_nop 0
  buffer_load_dwordx4 v144, s[8:11], s17 offen lds
  s_add_u32 s17, s17, s29
  s_add_u32 m0, s28, 1024
  s_nop 0
  buffer_load_dwordx4 v144, s[8:11], s17 offen lds
  s_add_u32 s17, s17, s29
  s_add_u32 m0, s28, 2048
  s_nop 0
  buffer_load_dwordx4 v144, s[8:11], s17 offen lds
  s_add_u32 s17, s17, s29
  s_add_u32 m0, s28, 3072
  s_nop 0
  buffer_load_dwordx4 v144, s[8:11], s17 offen lds
  s_add_u32 s17, s17, s29
  s_waitcnt vmcnt(28)
  ds_read_b64_tr_b16 a[16:17], v152 offset:4096
  ds_read_b64_tr_b16 a[18:19], v153 offset:4096
  ds_read_b64_tr_b16 a[20:21], v154 offset:4096
  ds_read_b64_tr_b16 a[22:23], v155 offset:4096
  ds_read_b64_tr_b16 a[24:25], v152 offset:4160
  ds_read_b64_tr_b16 a[26:27], v153 offset:4160
  ds_read_b64_tr_b16 a[28:29], v154 offset:4160
  ds_read_b64_tr_b16 a[30:31], v155 offset:4160
  s_waitcnt lgkmcnt(0)
  s_add_u32 m0, s28, 4096
  s_nop 0
  buffer_load_dwordx4 v144, s[8:11], s17 offen lds
  s_add_u32 s17, s17, s29
  s_add_u32 m0, s28, 5120
  s_nop 0
  buffer_load_dwordx4 v144, s[8:11], s17 offen lds
  s_add_u32 s17, s17, s29
  s_add_u32 m0, s28, 6144
  s_nop 0
  buffer_load_dwordx4 v144, s[8:11], s17 offen lds
  s_add_u32 s17, s17, s29
  s_add_u32 m0, s28, 7168
  s_nop 0
  buffer_load_dwordx4 v144, s[8:11], s17 offen lds
  s_add_u32 s17, s17, s29
  s_waitcnt vmcnt(28)
  ds_read_b64_tr_b16 a[32:33], v152 offset:8192
  ds_read_b64_tr_b16 a[34:35], v153 offset:8192
  ds_read_b64_tr_b16 a[36:37], v154 offset:8192
  ds_read_b64_tr_b16 a[38:39], v155 offset:8192
  ds_read_b64_tr_b16 a[40:41], v152 offset:8256
  ds_read_b64_tr_b16 a[42:43], v153 offset:8256
  ds_read_b64_tr_b16 a[44:45], v154 offset:8256
  ds_read_b64_tr_b16 a[46:47], v155 offset:8256
  s_waitcnt lgkmcnt(0)
  s_add_u32 m0, s28, 8192
  s_nop 0
  buffer_load_dwordx4 v144, s[8:11], s17 offen lds
  s_add_u32 s17, s17, s29
  s_add_u32 m0, s28, 9216
  s_nop 0
  buffer_load_dwordx4 v144, s[8:11], s17 offen lds
  s_add_u32 s17, s17, s29
  s_add_u32 m0, s28, 10240
  s_nop 0
  buffer_load_dwordx4 v144, s[8:11], s17 offen lds
  s_add_u32 s17, s17, s29
  s_add_u32 m0, s28, 11264
  s_nop 0
  buffer_load_dwordx4 v144, s[8:11], s17 offen lds
  s_add_u32 s17, s17, s29
  s_waitcnt vmcnt(28)
  ds_read_b64_tr_b16 a[48:49], v152 offset:12288
  ds_read_b64_tr_b16 a[50:51], v153 offset:12288
  ds_read_b64_tr_b16 a[52:53], v154 offset:12288
  ds_read_b64_tr_b16 a[54:55], v155 offset:12288
  ds_read_b64_tr_b16 a[56:57], v152 offset:12352
  ds_read_b64_tr_b16 a[58:59], v153 offset:12352
  ds_read_b64_tr_b16 a[60:61], v154 offset:12352
  ds_read_b64_tr_b16 a[62:63], v155 offset:12352
  s_waitcnt lgkmcnt(0)
  s_add_u32 m0, s28, 12288
  s_nop 0
  buffer_load_dwordx4 v144, s[8:11], s17 offen lds
  s_add_u32 s17, s17, s29
  s_add_u32 m0, s28, 13312
  s_nop 0
  buffer_load_dwordx4 v144, s[8:11], s17 offen lds
  s_add_u32 s17, s17, s29
  s_add_u32 m0, s28, 14336
  s_nop 0
  buffer_load_dwordx4 v144, s[8:11], s17 offen lds
  s_add_u32 s17, s17, s29
  s_add_u32 m0, s28, 15360
  s_nop 0
  buffer_load_dwordx4 v144, s[8:11], s17 offen lds
  s_add_u32 s17, s17, s29
  s_waitcnt vmcnt(28)
  ds_read_b64_tr_b16 a[64:65], v152 offset:16384
  ds_read_b64_tr_b16 a[66:67], v153 offset:16384
  ds_read_b64_tr_b16 a[68:69], v154 offset:16384
  ds_read_b64_tr_b16 a[70:71], v155 offset:16384
  ds_read_b64_tr_b16 a[72:73], v152 offset:16448
  ds_read_b64_tr_b16 a[74:75], v153 offset:16448
  ds_read_b64_tr_b16 a[76:77], v154 offset:16448
  ds_read_b64_tr_b16 a[78:79], v155 offset:16448
  s_waitcnt lgkmcnt(0)
  s_add_u32 m0, s28, 16384
  s_nop 0
  buffer_load_dwordx4 v144, s[8:11], s17 offen lds
  s_add_u32 s17, s17, s29
  s_add_u32 m0, s28, 17408
  s_nop 0
  buffer_load_dwordx4 v144, s[8:11], s17 offen lds
  s_add_u32 s17, s17, s29
  s_add_u32 m0, s28, 18432
  s_nop 0
  buffer_load_dwordx4 v144, s[8:11], s17 offen lds
  s_add_u32 s17, s17, s29
  s_add_u32 m0, s28, 19456
  s_nop 0
  buffer_load_dwordx4 v144, s[8:11], s17 offen lds
  s_add_u32 s17, s17, s29
  s_waitcnt vmcnt(28)
  ds_read_b64_tr_b16 a[80:81], v152 offset:20480
  ds_read_b64_tr_b16 a[82:83], v153 offset:20480
  ds_read_b64_tr_b16 a[84:85], v154 offset:20480
  ds_read_b64_tr_b16 a[86:87], v155 offset:20480
  ds_read_b64_tr_b16 a[88:89], v152 offset:20544
  ds_read_b64_tr_b16 a[90:91], v153 offset:20544
  ds_read_b64_tr_b16 a[92:93], v154 offset:20544
  ds_read_b64_tr_b16 a[94:95], v155 offset:20544
  s_waitcnt lgkmcnt(0)
  s_add_u32 m0, s28, 20480
  s_nop 0
  buffer_load_dwordx4 v144, s[8:11], s17 offen lds
  s_add_u32 s17, s17, s29
  s_add_u32 m0, s28, 21504
  s_nop 0
  buffer_load_dwordx4 v144, s[8:11], s17 offen lds
  s_add_u32 s17, s17, s29
  s_add_u32 m0, s28, 22528
  s_nop 0
  buffer_load_dwordx4 v144, s[8:11], s17 offen lds
  s_add_u32 s17, s17, s29
  s_add_u32 m0, s28, 23552
  s_nop 0
  buffer_load_dwordx4 v144, s[8:11], s17 offen lds
  s_add_u32 s17, s17, s29
  s_waitcnt vmcnt(28)
  ds_read_b64_tr_b16 a[96:97], v152 offset:24576
  ds_read_b64_tr_b16 a[98:99], v153 offset:24576
  ds_read_b64_tr_b16 a[100:101], v154 offset:24576
  ds_read_b64_tr_b16 a[102:103], v155 offset:24576
  ds_read_b64_tr_b16 a[104:105], v152 offset:24640
  ds_read_b64_tr_b16 a[106:107], v153 offset:24640
  ds_read_b64_tr_b16 a[108:109], v154 offset:24640
  ds_read_b64_tr_b16 a[110:111], v155 offset:24640
  s_waitcnt lgkmcnt(0)
  s_add_u32 m0, s28, 24576
  s_nop 0
  buffer_load_dwordx4 v144, s[8:11], s17 offen lds
  s_add_u32 s17, s17, s29
  s_add_u32 m0, s28, 25600
  s_nop 0
  buffer_load_dwordx4 v144, s[8:11], s17 offen lds
  s_add_u32 s17, s17, s29
  s_add_u32 m0, s28, 26624
  s_nop 0
  buffer_load_dwordx4 v144, s[8:11], s17 offen lds
  s_add_u32 s17, s17, s29
  s_add_u32 m0, s28, 27648
  s_nop 0
  buffer_load_dwordx4 v144, s[8:11], s17 offen lds
  s_add_u32 s17, s17, s29
  s_waitcnt vmcnt(28)
  ds_read_b64_tr_b16 a[112:113], v152 offset:28672
  ds_read_b64_tr_b16 a[114:115], v153 offset:28672
  ds_read_b64_tr_b16 a[116:117], v154 offset:28672
  ds_read_b64_tr_b16 a[118:119], v155 offset:28672
  ds_read_b64_tr_b16 a[120:121], v152 offset:28736
  ds_read_b64_tr_b16 a[122:123], v153 offset:28736
  ds_read_b64_tr_b16 a[124:125], v154 offset:28736
  ds_read_b64_tr_b16 a[126:127], v155 offset:28736
  s_waitcnt lgkmcnt(0)
  s_add_u32 m0, s28, 28672
  s_nop 0
  buffer_load_dwordx4 v144, s[8:11], s17 offen lds
  s_add_u32 s17, s17, s29
  s_add_u32 m0, s28, 29696
  s_nop 0
  buffer_load_dwordx4 v144, s[8:11], s17 offen lds
  s_add_u32 s17, s17, s29
  s_add_u32 m0, s28, 30720
  s_nop 0
  buffer_load_dwordx4 v144, s[8:11], s17 offen lds
  s_add_u32 s17, s17, s29
  s_add_u32 m0, s28, 31744
  s_nop 0
  buffer_load_dwordx4 v144, s[8:11], s17 offen lds
  s_add_u32 s17, s17, s29
  s_waitcnt vmcnt(28)
  ds_read_b64_tr_b16 a[128:129], v152 offset:0
  ds_read_b64_tr_b16 a[130:131], v153 offset:0
  ds_read_b64_tr_b16 a[132:133], v154 offset:0
  ds_read_b64_tr_b16 a[134:135], v155 offset:0
  ds_read_b64_tr_b16 a[136:137], v152 offset:64
  ds_read_b64_tr_b16 a[138:139], v153 offset:64
  ds_read_b64_tr_b16 a[140:141], v154 offset:64
  ds_read_b64_tr_b16 a[142:143], v155 offset:64
  s_waitcnt lgkmcnt(0)
  s_waitcnt vmcnt(24)
  ds_read_b64_tr_b16 a[144:145], v152 offset:4096
  ds_read_b64_tr_b16 a[146:147], v153 offset:4096
  ds_read_b64_tr_b16 a[148:149], v154 offset:4096
  ds_read_b64_tr_b16 a[150:151], v155 offset:4096
  ds_read_b64_tr_b16 a[152:153], v152 offset:4160
  ds_read_b64_tr_b16 a[154:155], v153 offset:4160
  ds_read_b64_tr_b16 a[156:157], v154 offset:4160
  ds_read_b64_tr_b16 a[158:159], v155 offset:4160
  s_waitcnt lgkmcnt(0)
  s_waitcnt vmcnt(20)
  ds_read_b64_tr_b16 a[160:161], v152 offset:8192
  ds_read_b64_tr_b16 a[162:163], v153 offset:8192
  ds_read_b64_tr_b16 a[164:165], v154 offset:8192
  ds_read_b64_tr_b16 a[166:167], v155 offset:8192
  ds_read_b64_tr_b16 a[168:169], v152 offset:8256
  ds_read_b64_tr_b16 a[170:171], v153 offset:8256
  ds_read_b64_tr_b16 a[172:173], v154 offset:8256
  ds_read_b64_tr_b16 a[174:175], v155 offset:8256
  s_waitcnt lgkmcnt(0)
  s_waitcnt vmcnt(16)
  ds_read_b64_tr_b16 a[176:177], v152 offset:12288
  ds_read_b64_tr_b16 a[178:179], v153 offset:12288
  ds_read_b64_tr_b16 a[180:181], v154 offset:12288
  ds_read_b64_tr_b16 a[182:183], v155 offset:12288
  ds_read_b64_tr_b16 a[184:185], v152 offset:12352
  ds_read_b64_tr_b16 a[186:187], v153 offset:12352
  ds_read_b64_tr_b16 a[188:189], v154 offset:12352
  ds_read_b64_tr_b16 a[190:191], v155 offset:12352
  s_waitcnt lgkmcnt(0)
  s_waitcnt vmcnt(12)
  ds_read_b64_tr_b16 a[192:193], v152 offset:16384
  ds_read_b64_tr_b16 a[194:195], v153 offset:16384
  ds_read_b64_tr_b16 a[196:197], v154 offset:16384
  ds_read_b64_tr_b16 a[198:199], v155 offset:16384
  ds_read_b64_tr_b16 a[200:201], v152 offset:16448
  ds_read_b64_tr_b16 a[202:203], v153 offset:16448
  ds_read_b64_tr_b16 a[204:205], v154 offset:16448
  ds_read_b64_tr_b16 a[206:207], v155 offset:16448
  s_waitcnt lgkmcnt(0)
  s_waitcnt vmcnt(8)
  ds_read_b64_tr_b16 a[208:209], v152 offset:20480
  ds_read_b64_tr_b16 a[210:211], v153 offset:20480
  ds_read_b64_tr_b16 a[212:213], v154 offset:20480
  ds_read_b64_tr_b16 a[214:215], v155 offset:20480
  ds_read_b64_tr_b16 a[216:217], v152 offset:20544
  ds_read_b64_tr_b16 a[218:219], v153 offset:20544
  ds_read_b64_tr_b16 a[220:221], v154 offset:20544
  ds_read_b64_tr_b16 a[222:223], v155 offset:20544
  s_waitcnt lgkmcnt(0)
  s_waitcnt vmcnt(4)
  ds_read_b64_tr_b16 a[224:225], v152 offset:24576
  ds_read_b64_tr_b16 a[226:227], v153 offset:24576
  ds_read_b64_tr_b16 a[228:229], v154 offset:24576
  ds_read_b64_tr_b16 a[230:231], v155 offset:24576
  ds_read_b64_tr_b16 a[232:233], v152 offset:24640
  ds_read_b64_tr_b16 a[234:235], v153 offset:24640
  ds_read_b64_tr_b16 a[236:237], v154 offset:24640
  ds_read_b64_tr_b16 a[238:239], v155 offset:24640
  s_waitcnt lgkmcnt(0)
  s_waitcnt vmcnt(0)
  ds_read_b64_tr_b16 a[240:241], v152 offset:28672
  ds_read_b64_tr_b16 a[242:243], v153 offset:28672
  ds_read_b64_tr_b16 a[244:245], v154 offset:28672
  ds_read_b64_tr_b16 a[246:247], v155 offset:28672
  ds_read_b64_tr_b16 a[248:249], v152 offset:28736
  ds_read_b64_tr_b16 a[250:251], v153 offset:28736
  ds_read_b64_tr_b16 a[252:253], v154 offset:28736
  ds_read_b64_tr_b16 a[254:255], v155 offset:28736
  s_waitcnt lgkmcnt(0)
  s_lshl_b32 s26, s48, 2
  s_add_u32 s26, s26, s16
  s_lshl_b32 s27, s26, 6
  s_add_u32 s27, s27, s50
  s_lshl_b32 s19, s27, 13
  s_lshl_b32 s27, s50, 5
  s_add_u32 s27, s27, s26
  s_mul_i32 s27, s27, 4096
  s_add_u32 s20, s27, 135266304
  s_lshl_b32 s25, s16, 12
  s_add_u32 s25, s25, 65536
  s_lshl_b32 s26, s16, 13
  v_add_u32 v3, s26, v2
  v_lshrrev_b32 v16, 5, v1
  v_and_b32 v17, 31, v1
  v_bfe_u32 v18, v1, 4, 1
  v_lshl_add_u32 v18, v18, 1, v16
  v_and_b32 v19, 15, v1
  v_lshl_add_u32 v18, v18, 4, v19
  v_lshl_add_u32 v5, v18, 4, s25
  v_bfe_u32 v18, v1, 2, 2
  v_lshl_add_u32 v18, v16, 2, v18
  v_and_b32 v19, 1, v1
  v_lshl_add_u32 v18, v19, 4, v18
  v_lshl_add_u32 v4, v18, 4, s25
  v_lshlrev_b32 v16, 2, v16
  v_sub_u32 v17, v17, v16
  v_mov_b32 v18, 0xf149f2ca
  v_cmp_le_i32 vcc, 0, v17
  s_nop 1
  v_cndmask_b32 v240, v18, 0, vcc
  v_cmp_le_i32 vcc, 1, v17
  s_nop 1
  v_cndmask_b32 v241, v18, 0, vcc
  v_cmp_le_i32 vcc, 2, v17
  s_nop 1
  v_cndmask_b32 v242, v18, 0, vcc
  v_cmp_le_i32 vcc, 3, v17
  s_nop 1
  v_cndmask_b32 v243, v18, 0, vcc
  v_cmp_le_i32 vcc, 8, v17
  s_nop 1
  v_cndmask_b32 v244, v18, 0, vcc
  v_cmp_le_i32 vcc, 9, v17
  s_nop 1
  v_cndmask_b32 v245, v18, 0, vcc
  v_cmp_le_i32 vcc, 10, v17
  s_nop 1
  v_cndmask_b32 v246, v18, 0, vcc
  v_cmp_le_i32 vcc, 11, v17
  s_nop 1
  v_cndmask_b32 v247, v18, 0, vcc
  v_cmp_le_i32 vcc, 16, v17
  s_nop 1
  v_cndmask_b32 v248, v18, 0, vcc
  v_cmp_le_i32 vcc, 17, v17
  s_nop 1
  v_cndmask_b32 v249, v18, 0, vcc
  v_cmp_le_i32 vcc, 18, v17
  s_nop 1
  v_cndmask_b32 v250, v18, 0, vcc
  v_cmp_le_i32 vcc, 19, v17
  s_nop 1
  v_cndmask_b32 v251, v18, 0, vcc
  v_cmp_le_i32 vcc, 24, v17
  s_nop 1
  v_cndmask_b32 v252, v18, 0, vcc
  v_cmp_le_i32 vcc, 25, v17
  s_nop 1
  v_cndmask_b32 v253, v18, 0, vcc
  v_cmp_le_i32 vcc, 26, v17
  s_nop 1
  v_cndmask_b32 v254, v18, 0, vcc
  v_cmp_le_i32 vcc, 27, v17
  s_nop 1
  v_cndmask_b32 v255, v18, 0, vcc
  v_mov_b32 v21, v2
  s_barrier
  s_lshl_b32 s77, s48, 2
  s_add_u32 s77, s77, s16
  s_mul_i32 s78, s77, 896
  s_add_u32 s76, s78, 148898304
  s_mov_b32 s71, 0
  s_branch M_sg_189
M_sw_188:
  s_sleep 8
  s_add_u32 s71, s71, 1
  s_cmp_gt_u32 s71, 262144
  s_cbranch_scc1 M_exit
M_sg_189:
  s_mov_b32 s79, 0
  s_atomic_or s79, s[72:73], s76 glc
  s_waitcnt lgkmcnt(0)
  s_cmp_lt_u32 s79, 16
  s_cbranch_scc1 M_sw_188
  s_add_u32 s76, s78, 148898048
  s_mov_b32 s71, 0
  s_branch M_sg_191
M_sw_190:
  s_sleep 8
  s_add_u32 s71, s71, 1
  s_cmp_gt_u32 s71, 262144
  s_cbranch_scc1 M_exit
M_sg_191:
  s_mov_b32 s79, 0
  s_atomic_or s79, s[72:73], s76 glc
  s_waitcnt lgkmcnt(0)
  s_cmp_lt_u32 s79, 8
  s_cbranch_scc1 M_sw_190
  s_add_u32 s76, s78, 148898176
  s_mov_b32 s71, 0
  s_branch M_sg_193
M_sw_192:
  s_sleep 8
  s_add_u32 s71, s71, 1
  s_cmp_gt_u32 s71, 262144
  s_cbranch_scc1 M_exit
M_sg_193:
  s_mov_b32 s79, 0
  s_atomic_or s79, s[72:73], s76 glc
  s_waitcnt lgkmcnt(0)
  s_cmp_lt_u32 s79, 8
  s_cbranch_scc1 M_sw_192
M_xok_187:
  s_lshl_b32 s77, s77, 7
  s_add_u32 s54, s77, 148926464
  s_add_u32 s52, s50, 1
  s_mov_b32 s53, 0
  s_mov_b32 s30, 0x200
  s_add_u32 s28, s19, 50331648
  buffer_load_dwordx4 v[144:147], v21, s[4:7], s28 offen offset:0 sc1
  buffer_load_dwordx4 v[148:151], v21, s[4:7], s28 offen offset:1024 sc1
  buffer_load_dwordx4 v[152:155], v21, s[4:7], s28 offen offset:2048 sc1
  buffer_load_dwordx4 v[156:159], v21, s[4:7], s28 offen offset:3072 sc1
  s_add_u32 s29, s19, 50335744
  buffer_load_dwordx4 v[160:163], v21, s[4:7], s29 offen offset:0 sc1
  buffer_load_dwordx4 v[164:167], v21, s[4:7], s29 offen offset:1024 sc1
  buffer_load_dwordx4 v[168:171], v21, s[4:7], s29 offen offset:2048 sc1
  buffer_load_dwordx4 v[172:175], v21, s[4:7], s29 offen offset:3072 sc1
  s_add_u32 s28, s19, 67108864
  buffer_load_dwordx4 v[176:179], v21, s[4:7], s28 offen offset:0 sc1
  buffer_load_dwordx4 v[180:183], v21, s[4:7], s28 offen offset:1024 sc1
  buffer_load_dwordx4 v[184:187], v21, s[4:7], s28 offen offset:2048 sc1
  buffer_load_dwordx4 v[188:191], v21, s[4:7], s28 offen offset:3072 sc1
  s_add_u32 s29, s19, 67112960
  buffer_load_dwordx4 v[192:195], v21, s[4:7], s29 offen offset:0 sc1
  buffer_load_dwordx4 v[196:199], v21, s[4:7], s29 offen offset:1024 sc1
  buffer_load_dwordx4 v[200:203], v21, s[4:7], s29 offen offset:2048 sc1
  buffer_load_dwordx4 v[204:207], v21, s[4:7], s29 offen offset:3072 sc1
  s_add_u32 s28, s19, 83886080
  buffer_load_dwordx4 v[208:211], v21, s[4:7], s28 offen offset:0 sc1
  buffer_load_dwordx4 v[212:215], v21, s[4:7], s28 offen offset:1024 sc1
  buffer_load_dwordx4 v[216:219], v21, s[4:7], s28 offen offset:2048 sc1
  buffer_load_dwordx4 v[220:223], v21, s[4:7], s28 offen offset:3072 sc1
  s_add_u32 s29, s19, 83890176
  buffer_load_dwordx4 v[224:227], v21, s[4:7], s29 offen offset:0 sc1
  buffer_load_dwordx4 v[228:231], v21, s[4:7], s29 offen offset:1024 sc1
  buffer_load_dwordx4 v[232:235], v21, s[4:7], s29 offen offset:2048 sc1
  buffer_load_dwordx4 v[236:239], v21, s[4:7], s29 offen offset:3072 sc1
  s_mov_b32 s24, 0
  v_mov_b32 v22, 0x40000000
  s_sub_u32 s21, s21, s22
F_top_194:
  s_waitcnt vmcnt(8)
  v_mfma_f32_32x32x16_bf16 v[24:39], v[176:179], v[144:147], v[240:255]
  s_nop 1
  v_cvt_pk_bf16_f32 v128, v64, v65
  v_cvt_pk_bf16_f32 v129, v66, v67
  v_cvt_pk_bf16_f32 v130, v68, v69
  v_cvt_pk_bf16_f32 v131, v70, v71
  v_mfma_f32_32x32x16_bf16 v[24:39], v[180:183], v[148:151], v[24:39]
  buffer_store_dwordx4 v[128:131], v22, s[4:7], s21 offen offset:0 sc1
  v_mfma_f32_32x32x16_bf16 v[24:39], v[184:187], v[152:155], v[24:39]
  v_cvt_pk_bf16_f32 v132, v72, v73
  v_cvt_pk_bf16_f32 v133, v74, v75
  v_cvt_pk_bf16_f32 v134, v76, v77
  v_cvt_pk_bf16_f32 v135, v78, v79
  v_mfma_f32_32x32x16_bf16 v[24:39], v[188:191], v[156:159], v[24:39]
  buffer_store_dwordx4 v[132:135], v22, s[4:7], s21 offen offset:256 sc1
  v_mfma_f32_32x32x16_bf16 v[24:39], v[192:195], v[160:163], v[24:39]
  v_cvt_pk_bf16_f32 v136, v80, v81
  v_cvt_pk_bf16_f32 v137, v82, v83
  v_cvt_pk_bf16_f32 v138, v84, v85
  v_cvt_pk_bf16_f32 v139, v86, v87
  v_mfma_f32_32x32x16_bf16 v[24:39], v[196:199], v[164:167], v[24:39]
  buffer_store_dwordx4 v[136:139], v22, s[4:7], s21 offen offset:2048 sc1
  v_mfma_f32_32x32x16_bf16 v[24:39], v[200:203], v[168:171], v[24:39]
  v_cvt_pk_bf16_f32 v140, v88, v89
  v_cvt_pk_bf16_f32 v141, v90, v91
  v_cvt_pk_bf16_f32 v142, v92, v93
  v_cvt_pk_bf16_f32 v143, v94, v95
  v_mfma_f32_32x32x16_bf16 v[24:39], v[204:207], v[172:175], v[24:39]
  buffer_store_dwordx4 v[140:143], v22, s[4:7], s21 offen offset:2304 sc1
  s_add_u32 s21, s21, s22
  v_mov_b32 v22, v20
  s_cmp_lg_u32 s24, 0
  s_cbranch_scc1 F_have_195
  s_cmp_le_u32 s52, 58
  s_cbranch_scc1 M_dp_196
  s_mov_b32 s71, 0
  v_add_u32 v16, s25, v2
  s_branch M_dp_198
M_dp_197:
  s_sleep 1
  s_add_u32 s71, s71, 1
  s_cmp_gt_u32 s71, 262144
  s_cbranch_scc1 M_exit
M_dp_198:
  buffer_load_dword v23, off, s[4:7], s54 sc1
  buffer_load_dwordx4 v[96:99], v2, s[4:7], s20 offen offset:0 sc1
  buffer_load_dwordx4 v[100:103], v2, s[4:7], s20 offen offset:1024 sc1
  buffer_load_dwordx4 v[104:107], v2, s[4:7], s20 offen offset:2048 sc1
  buffer_load_dwordx4 v[108:111], v2, s[4:7], s20 offen offset:3072 sc1
  s_waitcnt vmcnt(3)
  v_max_u32 v17, v96, v97
  v_max3_u32 v17, v17, v98, v99
  s_waitcnt vmcnt(2)
  v_max3_u32 v17, v17, v100, v101
  v_max3_u32 v17, v17, v102, v103
  s_waitcnt vmcnt(1)
  v_max3_u32 v17, v17, v104, v105
  v_max3_u32 v17, v17, v106, v107
  s_waitcnt vmcnt(0)
  v_max3_u32 v17, v17, v108, v109
  v_max3_u32 v17, v17, v110, v111
  v_cmp_eq_u32 vcc, -1, v17
  s_cbranch_vccz M_dp_199
  v_cmp_gt_u32 vcc, s52, v23
  s_cbranch_vccnz M_dp_197
  s_branch M_dp_196
M_dp_199:
  ds_write_b128 v16, v[96:99] offset:0
  ds_write_b128 v16, v[100:103] offset:1024
  ds_write_b128 v16, v[104:107] offset:2048
  ds_write_b128 v16, v[108:111] offset:3072
  s_branch F_have_195
M_dp_196:
  v_mov_b32 v16, s54
  v_mov_b32 v17, s52
  s_mov_b32 s71, 0
  s_branch M_vg_201
M_vw_200:
  s_sleep 2
  s_add_u32 s71, s71, 1
  s_cmp_gt_u32 s71, 262144
  s_cbranch_scc1 M_exit
M_vg_201:
  buffer_load_dword v23, v16, s[4:7], 0 offen sc1
  s_waitcnt vmcnt(0)
  v_cmp_lt_u32 vcc, v23, v17
  s_cbranch_vccnz M_vw_200
  s_mov_b32 m0, s25
  s_nop 0
  buffer_load_dwordx4 v2, s[4:7], s20 offen offset:0 sc1 lds
  buffer_load_dwordx4 v2, s[4:7], s20 offen offset:1024 sc1 lds
  buffer_load_dwordx4 v2, s[4:7], s20 offen offset:2048 sc1 lds
  buffer_load_dwordx4 v2, s[4:7], s20 offen offset:3072 sc1 lds
  s_waitcnt vmcnt(0)
F_have_195:
  ds_read_b64_tr_b16 v[176:177], v4 offset:8
  ds_read_b64_tr_b16 v[178:179], v4 offset:136
  ds_read_b64_tr_b16 v[180:181], v4 offset:520
  ds_read_b64_tr_b16 v[182:183], v4 offset:648
  ds_read_b64_tr_b16 v[184:185], v4 offset:1032
  ds_read_b64_tr_b16 v[186:187], v4 offset:1160
  ds_read_b64_tr_b16 v[188:189], v4 offset:1544
  ds_read_b64_tr_b16 v[190:191], v4 offset:1672
  ds_read_b64_tr_b16 v[192:193], v4 offset:2056
  ds_read_b64_tr_b16 v[194:195], v4 offset:2184
  ds_read_b64_tr_b16 v[196:197], v4 offset:2568
  ds_read_b64_tr_b16 v[198:199], v4 offset:2696
  s_sub_u32 s23, s23, 1
  s_cmp_gt_u32 s23, 0
  s_cselect_b32 s26, s51, 0
  s_cselect_b32 s27, 0, 0x40000000
  v_or_b32 v21, s27, v21
  s_lshl_b32 s27, s26, 13
  s_add_u32 s19, s19, s27
  s_mul_i32 s27, s26, 131072
  s_add_u32 s20, s20, s27
  s_cmp_lg_u32 s23, 24
  s_cbranch_scc1 M_xok_202
  s_lshl_b32 s77, s48, 2
  s_add_u32 s77, s77, s16
  s_mul_i32 s78, s77, 896
  s_add_u32 s76, s78, 148898304
  s_mov_b32 s71, 0
  s_branch M_sg_204
M_sw_203:
  s_sleep 8
  s_add_u32 s71, s71, 1
  s_cmp_gt_u32 s71, 262144
  s_cbranch_scc1 M_exit
M_sg_204:
  s_mov_b32 s79, 0
  s_atomic_or s79, s[72:73], s76 glc
  s_waitcnt lgkmcnt(0)
  s_cmp_lt_u32 s79, 32
  s_cbranch_scc1 M_sw_203
  s_add_u32 s76, s78, 148898432
  s_mov_b32 s71, 0
  s_branch M_sg_206
M_sw_205:
  s_sleep 8
  s_add_u32 s71, s71, 1
  s_cmp_gt_u32 s71, 262144
  s_cbranch_scc1 M_exit
M_sg_206:
  s_mov_b32 s79, 0
  s_atomic_or s79, s[72:73], s76 glc
  s_waitcnt lgkmcnt(0)
  s_cmp_lt_u32 s79, 32
  s_cbranch_scc1 M_sw_205
  s_add_u32 s76, s78, 148898048
  s_mov_b32 s71, 0
  s_branch M_sg_208
M_sw_207:
  s_sleep 8
  s_add_u32 s71, s71, 1
  s_cmp_gt_u32 s71, 262144
  s_cbranch_scc1 M_exit
M_sg_208:
  s_mov_b32 s79, 0
  s_atomic_or s79, s[72:73], s76 glc
  s_waitcnt lgkmcnt(0)
  s_cmp_lt_u32 s79, 32
  s_cbranch_scc1 M_sw_207
  s_add_u32 s76, s78, 148898176
  s_mov_b32 s71, 0
  s_branch M_sg_210
M_sw_209:
  s_sleep 8
  s_add_u32 s71, s71, 1
  s_cmp_gt_u32 s71, 262144
  s_cbranch_scc1 M_exit
M_sg_210:
  s_mov_b32 s79, 0
  s_atomic_or s79, s[72:73], s76 glc
  s_waitcnt lgkmcnt(0)
  s_cmp_lt_u32 s79, 32
  s_cbranch_scc1 M_sw_209
M_xok_202:
  s_waitcnt lgkmcnt(10)
  v_mfma_f32_32x32x16_bf16 v[40:55], v[176:179], v[144:147], 0
  ds_read_b64_tr_b16 v[200:201], v4 offset:3080
  ds_read_b64_tr_b16 v[202:203], v4 offset:3208
  v_max_f32 v6, v24, v25
  s_waitcnt lgkmcnt(10)
  v_mfma_f32_32x32x16_bf16 v[40:55], v[180:183], v[148:151], v[40:55]
  ds_read_b64_tr_b16 v[204:205], v4 offset:3592
  ds_read_b64_tr_b16 v[206:207], v4 offset:3720
  v_max3_f32 v6, v6, v26, v27
  s_waitcnt lgkmcnt(10)
  v_mfma_f32_32x32x16_bf16 v[40:55], v[184:187], v[152:155], v[40:55]
  ds_read_b64 v[56:57], v5 offset:0
  ds_read_b64 v[58:59], v5 offset:1024
  v_max3_f32 v6, v6, v28, v29
  s_waitcnt lgkmcnt(10)
  v_mfma_f32_32x32x16_bf16 v[40:55], v[188:191], v[156:159], v[40:55]
  ds_read_b64 v[60:61], v5 offset:2048
  ds_read_b64 v[62:63], v5 offset:3072
  v_max3_f32 v6, v6, v30, v31
  s_waitcnt lgkmcnt(10)
  v_mfma_f32_32x32x16_bf16 v[40:55], v[192:195], v[160:163], v[40:55]
  v_max3_f32 v6, v6, v32, v33
  s_waitcnt lgkmcnt(8)
  v_mfma_f32_32x32x16_bf16 v[40:55], v[196:199], v[164:167], v[40:55]
  v_max3_f32 v6, v6, v34, v35
  s_waitcnt lgkmcnt(6)
  v_mfma_f32_32x32x16_bf16 v[40:55], v[200:203], v[168:171], v[40:55]
  v_max3_f32 v6, v6, v36, v37
  s_waitcnt lgkmcnt(4)
  v_mfma_f32_32x32x16_bf16 v[40:55], v[204:207], v[172:175], v[40:55]
  v_max3_f32 v6, v6, v38, v39
  s_add_u32 s28, s19, 50331648
  buffer_load_dwordx4 v[144:147], v21, s[4:7], s28 offen offset:0 sc1
  buffer_load_dwordx4 v[148:151], v21, s[4:7], s28 offen offset:1024 sc1
  s_nop 7
  v_max3_f32 v6, v6, v40, v41
  v_max3_f32 v6, v6, v42, v43
  v_mov_b32 v16, v6
  s_nop 1
  v_permlane32_swap_b32 v6, v16
  s_nop 1
  v_max_f32 v6, v6, v16
  v_pk_add_f32 v[24:25], v[24:25], v[6:7] op_sel_hi:[1,0] neg_lo:[0,1] neg_hi:[0,1]
  v_pk_add_f32 v[26:27], v[26:27], v[6:7] op_sel_hi:[1,0] neg_lo:[0,1] neg_hi:[0,1]
  v_pk_add_f32 v[28:29], v[28:29], v[6:7] op_sel_hi:[1,0] neg_lo:[0,1] neg_hi:[0,1]
  v_pk_add_f32 v[30:31], v[30:31], v[6:7] op_sel_hi:[1,0] neg_lo:[0,1] neg_hi:[0,1]
  v_pk_add_f32 v[32:33], v[32:33], v[6:7] op_sel_hi:[1,0] neg_lo:[0,1] neg_hi:[0,1]
  v_pk_add_f32 v[34:35], v[34:35], v[6:7] op_sel_hi:[1,0] neg_lo:[0,1] neg_hi:[0,1]
  v_pk_add_f32 v[36:37], v[36:37], v[6:7] op_sel_hi:[1,0] neg_lo:[0,1] neg_hi:[0,1]
  v_pk_add_f32 v[38:39], v[38:39], v[6:7] op_sel_hi:[1,0] neg_lo:[0,1] neg_hi:[0,1]
  v_pk_add_f32 v[40:41], v[40:41], v[6:7] op_sel_hi:[1,0] neg_lo:[0,1] neg_hi:[0,1]
  v_pk_add_f32 v[42:43], v[42:43], v[6:7] op_sel_hi:[1,0] neg_lo:[0,1] neg_hi:[0,1]
  v_exp_f32 v24, v24
  v_exp_f32 v25, v25
  v_exp_f32 v26, v26
  v_exp_f32 v27, v27
  v_exp_f32 v28, v28
  v_exp_f32 v29, v29
  v_exp_f32 v30, v30
  v_exp_f32 v31, v31
  v_exp_f32 v32, v32
  v_exp_f32 v33, v33
  buffer_load_dwordx4 v[152:155], v21, s[4:7], s28 offen offset:2048 sc1
  v_exp_f32 v34, v34
  v_exp_f32 v35, v35
  v_exp_f32 v36, v36
  v_exp_f32 v37, v37
  v_exp_f32 v38, v38
  v_exp_f32 v39, v39
  v_exp_f32 v40, v40
  v_exp_f32 v41, v41
  v_exp_f32 v42, v42
  v_exp_f32 v43, v43
  v_pk_add_f32 v[16:17], v[24:25], v[26:27]
  v_pk_add_f32 v[16:17], v[16:17], v[28:29]
  v_pk_add_f32 v[16:17], v[16:17], v[30:31]
  v_pk_add_f32 v[16:17], v[16:17], v[32:33]
  v_pk_add_f32 v[16:17], v[16:17], v[34:35]
  v_pk_add_f32 v[16:17], v[16:17], v[36:37]
  v_pk_add_f32 v[16:17], v[16:17], v[38:39]
  v_pk_add_f32 v[16:17], v[16:17], v[40:41]
  v_pk_add_f32 v[16:17], v[16:17], v[42:43]
  v_add_f32 v16, v16, v17
  v_mov_b32 v17, v16
  buffer_load_dwordx4 v[156:159], v21, s[4:7], s28 offen offset:3072 sc1
  s_nop 0
  v_permlane32_swap_b32 v16, v17
  s_nop 1
  v_add_f32 v16, v16, v17
  v_rcp_f32 v6, v16
  s_nop 0
  v_pk_mul_f32 v[24:25], v[24:25], v[6:7] op_sel_hi:[1,0]
  v_pk_mul_f32 v[26:27], v[26:27], v[6:7] op_sel_hi:[1,0]
  v_pk_mul_f32 v[28:29], v[28:29], v[6:7] op_sel_hi:[1,0]
  v_pk_mul_f32 v[30:31], v[30:31], v[6:7] op_sel_hi:[1,0]
  v_pk_mul_f32 v[32:33], v[32:33], v[6:7] op_sel_hi:[1,0]
  v_pk_mul_f32 v[34:35], v[34:35], v[6:7] op_sel_hi:[1,0]
  v_pk_mul_f32 v[36:37], v[36:37], v[6:7] op_sel_hi:[1,0]
  v_pk_mul_f32 v[38:39], v[38:39], v[6:7] op_sel_hi:[1,0]
  v_pk_mul_f32 v[40:41], v[40:41], v[6:7] op_sel_hi:[1,0]
  v_pk_mul_f32 v[42:43], v[42:43], v[6:7] op_sel_hi:[1,0]
  v_cvt_pk_bf16_f32 v128, v24, v25
  v_cvt_pk_bf16_f32 v129, v26, v27
  v_cvt_pk_bf16_f32 v130, v28, v29
  v_cvt_pk_bf16_f32 v131, v30, v31
  v_cvt_pk_bf16_f32 v132, v32, v33
  v_cvt_pk_bf16_f32 v133, v34, v35
  v_cvt_pk_bf16_f32 v134, v36, v37
  v_cvt_pk_bf16_f32 v135, v38, v39
  v_cvt_pk_bf16_f32 v136, v40, v41
  v_cvt_pk_bf16_f32 v137, v42, v43
  s_waitcnt vmcnt(8) lgkmcnt(0)
  v_mfma_f32_32x32x16_bf16 v[64:79], v[208:211], v[128:131], 0
  s_add_u32 s29, s19, 50335744
  buffer_load_dwordx4 v[160:163], v21, s[4:7], s29 offen offset:0 sc1
  v_mfma_f32_32x32x16_bf16 v[64:79], v[212:215], v[132:135], v[64:79]
  v_mfma_f32_32x32x8_bf16 v[64:79], v[56:57], v[136:137], v[64:79]
  v_mfma_f32_32x32x16_bf16 v[80:95], v[216:219], v[128:131], 0
  buffer_load_dwordx4 v[164:167], v21, s[4:7], s29 offen offset:1024 sc1
  v_mfma_f32_32x32x16_bf16 v[80:95], v[220:223], v[132:135], v[80:95]
  v_cvt_pk_bf16_f32 v24, v64, v65
  v_cvt_pk_bf16_f32 v25, v66, v67
  v_cvt_pk_bf16_f32 v26, v68, v69
  v_cvt_pk_bf16_f32 v27, v70, v71
  v_mfma_f32_32x32x8_bf16 v[80:95], v[58:59], v[136:137], v[80:95]
  ds_write_b128 v3, v[24:27] offset:0
  v_cvt_pk_bf16_f32 v28, v72, v73
  v_cvt_pk_bf16_f32 v29, v74, v75
  v_cvt_pk_bf16_f32 v30, v76, v77
  v_cvt_pk_bf16_f32 v31, v78, v79
  v_mfma_f32_32x32x16_bf16 v[96:111], v[224:227], v[128:131], 0
  ds_write_b128 v3, v[28:31] offset:1024
  buffer_load_dwordx4 v[168:171], v21, s[4:7], s29 offen offset:2048 sc1
  v_mfma_f32_32x32x16_bf16 v[96:111], v[228:231], v[132:135], v[96:111]
  v_cvt_pk_bf16_f32 v32, v80, v81
  v_cvt_pk_bf16_f32 v33, v82, v83
  v_cvt_pk_bf16_f32 v34, v84, v85
  v_cvt_pk_bf16_f32 v35, v86, v87
  v_mfma_f32_32x32x8_bf16 v[96:111], v[60:61], v[136:137], v[96:111]
  ds_write_b128 v3, v[32:35] offset:2048
  v_cvt_pk_bf16_f32 v36, v88, v89
  v_cvt_pk_bf16_f32 v37, v90, v91
  v_cvt_pk_bf16_f32 v38, v92, v93
  v_cvt_pk_bf16_f32 v39, v94, v95
  v_mfma_f32_32x32x16_bf16 v[112:127], v[232:235], v[128:131], 0
  ds_write_b128 v3, v[36:39] offset:3072
  buffer_load_dwordx4 v[172:175], v21, s[4:7], s29 offen offset:3072 sc1
  v_mfma_f32_32x32x16_bf16 v[112:127], v[236:239], v[132:135], v[112:127]
  v_cvt_pk_bf16_f32 v40, v96, v97
  v_cvt_pk_bf16_f32 v41, v98, v99
  v_cvt_pk_bf16_f32 v42, v100, v101
  v_cvt_pk_bf16_f32 v43, v102, v103
  v_mfma_f32_32x32x8_bf16 v[112:127], v[62:63], v[136:137], v[112:127]
  ds_write_b128 v3, v[40:43] offset:4096
  v_cvt_pk_bf16_f32 v44, v104, v105
  v_cvt_pk_bf16_f32 v45, v106, v107
  v_cvt_pk_bf16_f32 v46, v108, v109
  v_cvt_pk_bf16_f32 v47, v110, v111
  ds_write_b128 v3, v[44:47] offset:5120
  s_nop 5
  v_cvt_pk_bf16_f32 v48, v112, v113
  v_cvt_pk_bf16_f32 v49, v114, v115
  v_cvt_pk_bf16_f32 v50, v116, v117
  v_cvt_pk_bf16_f32 v51, v118, v119
  ds_write_b128 v3, v[48:51] offset:6144
  v_cvt_pk_bf16_f32 v52, v120, v121
  v_cvt_pk_bf16_f32 v53, v122, v123
  v_cvt_pk_bf16_f32 v54, v124, v125
  v_cvt_pk_bf16_f32 v55, v126, v127
  ds_write_b128 v3, v[52:55] offset:7168
  s_waitcnt vmcnt(8)
  s_waitcnt lgkmcnt(0)
  s_barrier
  ds_read_b128 v[24:27], v8 offset:0
  ds_read_b128 v[28:31], v9 offset:0
  ds_read_b128 v[32:35], v10 offset:0
  ds_read_b128 v[36:39], v11 offset:0
  ds_read_b128 v[40:43], v12 offset:0
  ds_read_b128 v[44:47], v13 offset:0
  buffer_load_dword v23, off, s[4:7], s54 sc1
  v_mov_b32 v16, s30
  v_min_u32 v17, 1, v0
  v_lshlrev_b32 v17, 30, v17
  buffer_store_dword v16, v17, s[4:7], s31 offen sc1
  s_add_u32 s30, s30, 1
  s_add_u32 s52, s52, 2
  s_waitcnt lgkmcnt(5)
  v_mfma_f32_16x16x32_bf16 v[64:67], a[0:3], v[24:27], 0
  s_add_u32 s28, s19, 67108864
  ds_read_b128 v[48:51], v14 offset:0
  v_mfma_f32_16x16x32_bf16 v[68:71], a[4:7], v[24:27], 0
  v_mfma_f32_16x16x32_bf16 v[80:83], a[8:11], v[24:27], 0
  v_mfma_f32_16x16x32_bf16 v[84:87], a[12:15], v[24:27], 0
  s_waitcnt lgkmcnt(5)
  v_mfma_f32_16x16x32_bf16 v[72:75], a[0:3], v[28:31], 0
  ds_read_b128 v[52:55], v15 offset:0
  v_mfma_f32_16x16x32_bf16 v[76:79], a[4:7], v[28:31], 0
  v_mfma_f32_16x16x32_bf16 v[88:91], a[8:11], v[28:31], 0
  buffer_load_dwordx4 v[176:179], v21, s[4:7], s28 offen offset:0 sc1
  v_mfma_f32_16x16x32_bf16 v[92:95], a[12:15], v[28:31], 0
  s_waitcnt lgkmcnt(5)
  v_mfma_f32_16x16x32_bf16 v[64:67], a[16:19], v[32:35], v[64:67]
  ds_read_b128 v[24:27], v8 offset:8192
  v_mfma_f32_16x16x32_bf16 v[68:71], a[20:23], v[32:35], v[68:71]
  v_mfma_f32_16x16x32_bf16 v[80:83], a[24:27], v[32:35], v[80:83]
  v_mfma_f32_16x16x32_bf16 v[84:87], a[28:31], v[32:35], v[84:87]
  s_waitcnt lgkmcnt(5)
  v_mfma_f32_16x16x32_bf16 v[72:75], a[16:19], v[36:39], v[72:75]
  ds_read_b128 v[28:31], v9 offset:8192
  v_mfma_f32_16x16x32_bf16 v[76:79], a[20:23], v[36:39], v[76:79]
  v_mfma_f32_16x16x32_bf16 v[88:91], a[24:27], v[36:39], v[88:91]
  buffer_load_dwordx4 v[180:183], v21, s[4:7], s28 offen offset:1024 sc1
  v_mfma_f32_16x16x32_bf16 v[92:95], a[28:31], v[36:39], v[92:95]
  s_waitcnt lgkmcnt(5)
  v_mfma_f32_16x16x32_bf16 v[64:67], a[32:35], v[40:43], v[64:67]
  ds_read_b128 v[32:35], v10 offset:8192
  v_mfma_f32_16x16x32_bf16 v[68:71], a[36:39], v[40:43], v[68:71]
  v_mfma_f32_16x16x32_bf16 v[80:83], a[40:43], v[40:43], v[80:83]
  v_mfma_f32_16x16x32_bf16 v[84:87], a[44:47], v[40:43], v[84:87]
  s_waitcnt lgkmcnt(5)
  v_mfma_f32_16x16x32_bf16 v[72:75], a[32:35], v[44:47], v[72:75]
  ds_read_b128 v[36:39], v11 offset:8192
  v_mfma_f32_16x16x32_bf16 v[76:79], a[36:39], v[44:47], v[76:79]
  v_mfma_f32_16x16x32_bf16 v[88:91], a[40:43], v[44:47], v[88:91]
  buffer_load_dwordx4 v[184:187], v21, s[4:7], s28 offen offset:2048 sc1
  v_mfma_f32_16x16x32_bf16 v[92:95], a[44:47], v[44:47], v[92:95]
  s_waitcnt lgkmcnt(5)
  v_mfma_f32_16x16x32_bf16 v[64:67], a[48:51], v[48:51], v[64:67]
  ds_read_b128 v[40:43], v12 offset:8192
  v_mfma_f32_16x16x32_bf16 v[68:71], a[52:55], v[48:51], v[68:71]
  v_mfma_f32_16x16x32_bf16 v[80:83], a[56:59], v[48:51], v[80:83]
  v_mfma_f32_16x16x32_bf16 v[84:87], a[60:63], v[48:51], v[84:87]
  s_waitcnt lgkmcnt(5)
  v_mfma_f32_16x16x32_bf16 v[72:75], a[48:51], v[52:55], v[72:75]
  ds_read_b128 v[44:47], v13 offset:8192
  v_mfma_f32_16x16x32_bf16 v[76:79], a[52:55], v[52:55], v[76:79]
  v_mfma_f32_16x16x32_bf16 v[88:91], a[56:59], v[52:55], v[88:91]
  buffer_load_dwordx4 v[188:191], v21, s[4:7], s28 offen offset:3072 sc1
  v_mfma_f32_16x16x32_bf16 v[92:95], a[60:63], v[52:55], v[92:95]
  s_waitcnt lgkmcnt(5)
  v_mfma_f32_16x16x32_bf16 v[64:67], a[64:67], v[24:27], v[64:67]
  s_add_u32 s29, s19, 67112960
  ds_read_b128 v[48:51], v14 offset:8192
  v_mfma_f32_16x16x32_bf16 v[68:71], a[68:71], v[24:27], v[68:71]
  v_mfma_f32_16x16x32_bf16 v[80:83], a[72:75], v[24:27], v[80:83]
  v_mfma_f32_16x16x32_bf16 v[84:87], a[76:79], v[24:27], v[84:87]
  s_waitcnt lgkmcnt(5)
  v_mfma_f32_16x16x32_bf16 v[72:75], a[64:67], v[28:31], v[72:75]
  ds_read_b128 v[52:55], v15 offset:8192
  v_mfma_f32_16x16x32_bf16 v[76:79], a[68:71], v[28:31], v[76:79]
  v_mfma_f32_16x16x32_bf16 v[88:91], a[72:75], v[28:31], v[88:91]
  buffer_load_dwordx4 v[192:195], v21, s[4:7], s29 offen offset:0 sc1
  v_mfma_f32_16x16x32_bf16 v[92:95], a[76:79], v[28:31], v[92:95]
  s_waitcnt lgkmcnt(5)
  v_mfma_f32_16x16x32_bf16 v[64:67], a[80:83], v[32:35], v[64:67]
  ds_read_b128 v[24:27], v8 offset:16384
  v_mfma_f32_16x16x32_bf16 v[68:71], a[84:87], v[32:35], v[68:71]
  v_mfma_f32_16x16x32_bf16 v[80:83], a[88:91], v[32:35], v[80:83]
  v_mfma_f32_16x16x32_bf16 v[84:87], a[92:95], v[32:35], v[84:87]
  s_waitcnt lgkmcnt(5)
  v_mfma_f32_16x16x32_bf16 v[72:75], a[80:83], v[36:39], v[72:75]
  ds_read_b128 v[28:31], v9 offset:16384
  v_mfma_f32_16x16x32_bf16 v[76:79], a[84:87], v[36:39], v[76:79]
  v_mfma_f32_16x16x32_bf16 v[88:91], a[88:91], v[36:39], v[88:91]
  buffer_load_dwordx4 v[196:199], v21, s[4:7], s29 offen offset:1024 sc1
  v_mfma_f32_16x16x32_bf16 v[92:95], a[92:95], v[36:39], v[92:95]
  s_waitcnt lgkmcnt(5)
  v_mfma_f32_16x16x32_bf16 v[64:67], a[96:99], v[40:43], v[64:67]
  ds_read_b128 v[32:35], v10 offset:16384
  v_mfma_f32_16x16x32_bf16 v[68:71], a[100:103], v[40:43], v[68:71]
  v_mfma_f32_16x16x32_bf16 v[80:83], a[104:107], v[40:43], v[80:83]
  v_mfma_f32_16x16x32_bf16 v[84:87], a[108:111], v[40:43], v[84:87]
  s_waitcnt lgkmcnt(5)
  s_waitcnt vmcnt(7)
  v_readfirstlane_b32 s53, v23
  s_nop 0
  s_cmp_ge_u32 s53, s52
  s_cselect_b32 s24, 1, 0
  s_cbranch_scc0 F_nopre_211
  s_mov_b32 m0, s25
  s_nop 0
  buffer_load_dwordx4 v2, s[4:7], s20 offen offset:0 sc1 lds
  buffer_load_dwordx4 v2, s[4:7], s20 offen offset:1024 sc1 lds
  buffer_load_dwordx4 v2, s[4:7], s20 offen offset:2048 sc1 lds
  buffer_load_dwordx4 v2, s[4:7], s20 offen offset:3072 sc1 lds
F_nopre_211:
  v_mfma_f32_16x16x32_bf16 v[72:75], a[96:99], v[44:47], v[72:75]
  ds_read_b128 v[36:39], v11 offset:16384
  v_mfma_f32_16x16x32_bf16 v[76:79], a[100:103], v[44:47], v[76:79]
  v_mfma_f32_16x16x32_bf16 v[88:91], a[104:107], v[44:47], v[88:91]
  buffer_load_dwordx4 v[200:203], v21, s[4:7], s29 offen offset:2048 sc1
  v_mfma_f32_16x16x32_bf16 v[92:95], a[108:111], v[44:47], v[92:95]
  s_waitcnt lgkmcnt(5)
  v_mfma_f32_16x16x32_bf16 v[64:67], a[112:115], v[48:51], v[64:67]
  ds_read_b128 v[40:43], v12 offset:16384
  v_mfma_f32_16x16x32_bf16 v[68:71], a[116:119], v[48:51], v[68:71]
  v_mfma_f32_16x16x32_bf16 v[80:83], a[120:123], v[48:51], v[80:83]
  v_mfma_f32_16x16x32_bf16 v[84:87], a[124:127], v[48:51], v[84:87]
  s_waitcnt lgkmcnt(5)
  v_mfma_f32_16x16x32_bf16 v[72:75], a[112:115], v[52:55], v[72:75]
  ds_read_b128 v[44:47], v13 offset:16384
  v_mfma_f32_16x16x32_bf16 v[76:79], a[116:119], v[52:55], v[76:79]
  v_mfma_f32_16x16x32_bf16 v[88:91], a[120:123], v[52:55], v[88:91]
  buffer_load_dwordx4 v[204:207], v21, s[4:7], s29 offen offset:3072 sc1
  v_mfma_f32_16x16x32_bf16 v[92:95], a[124:127], v[52:55], v[92:95]
  s_waitcnt lgkmcnt(5)
  v_mfma_f32_16x16x32_bf16 v[64:67], a[128:131], v[24:27], v[64:67]
  s_add_u32 s28, s19, 83886080
  ds_read_b128 v[48:51], v14 offset:16384
  v_mfma_f32_16x16x32_bf16 v[68:71], a[132:135], v[24:27], v[68:71]
  v_mfma_f32_16x16x32_bf16 v[80:83], a[136:139], v[24:27], v[80:83]
  v_mfma_f32_16x16x32_bf16 v[84:87], a[140:143], v[24:27], v[84:87]
  s_waitcnt lgkmcnt(5)
  v_mfma_f32_16x16x32_bf16 v[72:75], a[128:131], v[28:31], v[72:75]
  ds_read_b128 v[52:55], v15 offset:16384
  v_mfma_f32_16x16x32_bf16 v[76:79], a[132:135], v[28:31], v[76:79]
  v_mfma_f32_16x16x32_bf16 v[88:91], a[136:139], v[28:31], v[88:91]
  buffer_load_dwordx4 v[208:211], v21, s[4:7], s28 offen offset:0 sc1
  v_mfma_f32_16x16x32_bf16 v[92:95], a[140:143], v[28:31], v[92:95]
  s_waitcnt lgkmcnt(5)
  v_mfma_f32_16x16x32_bf16 v[64:67], a[144:147], v[32:35], v[64:67]
  ds_read_b128 v[24:27], v8 offset:24576
  v_mfma_f32_16x16x32_bf16 v[68:71], a[148:151], v[32:35], v[68:71]
  v_mfma_f32_16x16x32_bf16 v[80:83], a[152:155], v[32:35], v[80:83]
  v_mfma_f32_16x16x32_bf16 v[84:87], a[156:159], v[32:35], v[84:87]
  s_waitcnt lgkmcnt(5)
  v_mfma_f32_16x16x32_bf16 v[72:75], a[144:147], v[36:39], v[72:75]
  ds_read_b128 v[28:31], v9 offset:24576
  v_mfma_f32_16x16x32_bf16 v[76:79], a[148:151], v[36:39], v[76:79]
  v_mfma_f32_16x16x32_bf16 v[88:91], a[152:155], v[36:39], v[88:91]
  buffer_load_dwordx4 v[212:215], v21, s[4:7], s28 offen offset:1024 sc1
  v_mfma_f32_16x16x32_bf16 v[92:95], a[156:159], v[36:39], v[92:95]
  s_waitcnt lgkmcnt(5)
  v_mfma_f32_16x16x32_bf16 v[64:67], a[160:163], v[40:43], v[64:67]
  ds_read_b128 v[32:35], v10 offset:24576
  v_mfma_f32_16x16x32_bf16 v[68:71], a[164:167], v[40:43], v[68:71]
  v_mfma_f32_16x16x32_bf16 v[80:83], a[168:171], v[40:43], v[80:83]
  v_mfma_f32_16x16x32_bf16 v[84:87], a[172:175], v[40:43], v[84:87]
  s_waitcnt lgkmcnt(5)
  v_mfma_f32_16x16x32_bf16 v[72:75], a[160:163], v[44:47], v[72:75]
  ds_read_b128 v[36:39], v11 offset:24576
  v_mfma_f32_16x16x32_bf16 v[76:79], a[164:167], v[44:47], v[76:79]
  v_mfma_f32_16x16x32_bf16 v[88:91], a[168:171], v[44:47], v[88:91]
  buffer_load_dwordx4 v[216:219], v21, s[4:7], s28 offen offset:2048 sc1
  v_mfma_f32_16x16x32_bf16 v[92:95], a[172:175], v[44:47], v[92:95]
  s_waitcnt lgkmcnt(5)
  v_mfma_f32_16x16x32_bf16 v[64:67], a[176:179], v[48:51], v[64:67]
  ds_read_b128 v[40:43], v12 offset:24576
  v_mfma_f32_16x16x32_bf16 v[68:71], a[180:183], v[48:51], v[68:71]
  v_mfma_f32_16x16x32_bf16 v[80:83], a[184:187], v[48:51], v[80:83]
  v_mfma_f32_16x16x32_bf16 v[84:87], a[188:191], v[48:51], v[84:87]
  s_waitcnt lgkmcnt(5)
  v_mfma_f32_16x16x32_bf16 v[72:75], a[176:179], v[52:55], v[72:75]
  ds_read_b128 v[44:47], v13 offset:24576
  v_mfma_f32_16x16x32_bf16 v[76:79], a[180:183], v[52:55], v[76:79]
  v_mfma_f32_16x16x32_bf16 v[88:91], a[184:187], v[52:55], v[88:91]
  buffer_load_dwordx4 v[220:223], v21, s[4:7], s28 offen offset:3072 sc1
  v_mfma_f32_16x16x32_bf16 v[92:95], a[188:191], v[52:55], v[92:95]
  s_waitcnt lgkmcnt(5)
  v_mfma_f32_16x16x32_bf16 v[64:67], a[192:195], v[24:27], v[64:67]
  s_add_u32 s29, s19, 83890176
  ds_read_b128 v[48:51], v14 offset:24576
  v_mfma_f32_16x16x32_bf16 v[68:71], a[196:199], v[24:27], v[68:71]
  v_mfma_f32_16x16x32_bf16 v[80:83], a[200:203], v[24:27], v[80:83]
  v_mfma_f32_16x16x32_bf16 v[84:87], a[204:207], v[24:27], v[84:87]
  s_waitcnt lgkmcnt(5)
  v_mfma_f32_16x16x32_bf16 v[72:75], a[192:195], v[28:31], v[72:75]
  ds_read_b128 v[52:55], v15 offset:24576
  v_mfma_f32_16x16x32_bf16 v[76:79], a[196:199], v[28:31], v[76:79]
  v_mfma_f32_16x16x32_bf16 v[88:91], a[200:203], v[28:31], v[88:91]
  buffer_load_dwordx4 v[224:227], v21, s[4:7], s29 offen offset:0 sc1
  v_mfma_f32_16x16x32_bf16 v[92:95], a[204:207], v[28:31], v[92:95]
  s_waitcnt lgkmcnt(5)
  v_mfma_f32_16x16x32_bf16 v[64:67], a[208:211], v[32:35], v[64:67]
  v_mfma_f32_16x16x32_bf16 v[68:71], a[212:215], v[32:35], v[68:71]
  v_mfma_f32_16x16x32_bf16 v[80:83], a[216:219], v[32:35], v[80:83]
  v_mfma_f32_16x16x32_bf16 v[84:87], a[220:223], v[32:35], v[84:87]
  s_waitcnt lgkmcnt(4)
  v_mfma_f32_16x16x32_bf16 v[72:75], a[208:211], v[36:39], v[72:75]
  v_mfma_f32_16x16x32_bf16 v[76:79], a[212:215], v[36:39], v[76:79]
  v_xor_b32 v8, 0x8000, v8
  v_mfma_f32_16x16x32_bf16 v[88:91], a[216:219], v[36:39], v[88:91]
  buffer_load_dwordx4 v[228:231], v21, s[4:7], s29 offen offset:1024 sc1
  v_mfma_f32_16x16x32_bf16 v[92:95], a[220:223], v[36:39], v[92:95]
  s_waitcnt lgkmcnt(3)
  v_xor_b32 v9, 0x8000, v9
  v_mfma_f32_16x16x32_bf16 v[64:67], a[224:227], v[40:43], v[64:67]
  v_mfma_f32_16x16x32_bf16 v[68:71], a[228:231], v[40:43], v[68:71]
  v_xor_b32 v10, 0x8000, v10
  v_mfma_f32_16x16x32_bf16 v[80:83], a[232:235], v[40:43], v[80:83]
  v_mfma_f32_16x16x32_bf16 v[84:87], a[236:239], v[40:43], v[84:87]
  s_waitcnt lgkmcnt(2)
  v_xor_b32 v11, 0x8000, v11
  v_mfma_f32_16x16x32_bf16 v[72:75], a[224:227], v[44:47], v[72:75]
  v_mfma_f32_16x16x32_bf16 v[76:79], a[228:231], v[44:47], v[76:79]
  v_xor_b32 v12, 0x8000, v12
  v_mfma_f32_16x16x32_bf16 v[88:91], a[232:235], v[44:47], v[88:91]
  buffer_load_dwordx4 v[232:235], v21, s[4:7], s29 offen offset:2048 sc1
  v_mfma_f32_16x16x32_bf16 v[92:95], a[236:239], v[44:47], v[92:95]
  s_waitcnt lgkmcnt(1)
  v_xor_b32 v13, 0x8000, v13
  v_mfma_f32_16x16x32_bf16 v[64:67], a[240:243], v[48:51], v[64:67]
  v_mfma_f32_16x16x32_bf16 v[68:71], a[244:247], v[48:51], v[68:71]
  v_xor_b32 v14, 0x8000, v14
  v_mfma_f32_16x16x32_bf16 v[80:83], a[248:251], v[48:51], v[80:83]
  v_mfma_f32_16x16x32_bf16 v[84:87], a[252:255], v[48:51], v[84:87]
  s_waitcnt lgkmcnt(0)
  v_xor_b32 v15, 0x8000, v15
  v_mfma_f32_16x16x32_bf16 v[72:75], a[240:243], v[52:55], v[72:75]
  v_mfma_f32_16x16x32_bf16 v[76:79], a[244:247], v[52:55], v[76:79]
  v_xor_b32 v3, 0x8000, v3
  v_mfma_f32_16x16x32_bf16 v[88:91], a[248:251], v[52:55], v[88:91]
  buffer_load_dwordx4 v[236:239], v21, s[4:7], s29 offen offset:3072 sc1
  v_mfma_f32_16x16x32_bf16 v[92:95], a[252:255], v[52:55], v[92:95]
  s_cmp_gt_u32 s23, 0
  s_cbranch_scc1 F_top_194
  s_nop 2
  v_cvt_pk_bf16_f32 v128, v64, v65
  v_cvt_pk_bf16_f32 v129, v66, v67
  v_cvt_pk_bf16_f32 v130, v68, v69
  v_cvt_pk_bf16_f32 v131, v70, v71
  buffer_store_dwordx4 v[128:131], v22, s[4:7], s21 offen offset:0 sc1
  v_cvt_pk_bf16_f32 v132, v72, v73
  v_cvt_pk_bf16_f32 v133, v74, v75
  v_cvt_pk_bf16_f32 v134, v76, v77
  v_cvt_pk_bf16_f32 v135, v78, v79
  buffer_store_dwordx4 v[132:135], v22, s[4:7], s21 offen offset:256 sc1
  v_cvt_pk_bf16_f32 v136, v80, v81
  v_cvt_pk_bf16_f32 v137, v82, v83
  v_cvt_pk_bf16_f32 v138, v84, v85
  v_cvt_pk_bf16_f32 v139, v86, v87
  buffer_store_dwordx4 v[136:139], v22, s[4:7], s21 offen offset:2048 sc1
  v_cvt_pk_bf16_f32 v140, v88, v89
  v_cvt_pk_bf16_f32 v141, v90, v91
  v_cvt_pk_bf16_f32 v142, v92, v93
  v_cvt_pk_bf16_f32 v143, v94, v95
  buffer_store_dwordx4 v[140:143], v22, s[4:7], s21 offen offset:2304 sc1
  s_waitcnt vmcnt(0) lgkmcnt(0)
  s_barrier
  v_mov_b32 v144, s30
  v_min_u32 v145, 1, v0
  v_lshlrev_b32 v145, 30, v145
  buffer_store_dword v144, v145, s[4:7], s31 offen sc1
M_done:
M_exit:
  s_endpgm
.p2align 6
.type M_table,@object
M_table:
.long 0x1, 0x3f, 0xffffffff, 0x17, 0x1, 0x7, 0x800, 0x0, 0x8, 0x0, 0x0, 0x0, 0x0, 0x0, 0x0, 0x0
.long 0x1, 0x28, 0xffffffff, 0x1b, 0x1, 0x6, 0x1000, 0x0, 0x8, 0x1, 0x0, 0x0, 0x0, 0x0, 0x0, 0x0
.long 0x2, 0x0, 0x2, 0x20, 0x1, 0x5, 0x1800, 0x0, 0x8, 0x0, 0x0, 0x0, 0x0, 0x0, 0x0, 0x0
.long 0x2, 0x1, 0x2, 0x20, 0x1, 0x4, 0x2000, 0x0, 0x8, 0x1, 0x0, 0x0, 0x0, 0x0, 0x0, 0x0
.long 0x0, 0x0, 0x1, 0x20, 0x2, 0x3, 0x20, 0x0, 0x8, 0x2, 0x0, 0x0, 0x0, 0x0, 0x0, 0x0
.long 0x0, 0x3f, 0xffffffff, 0x20, 0x2, 0x2, 0x18, 0x1, 0x10, 0x0, 0x0, 0x0, 0x0, 0x0, 0x0, 0x0
.long 0x1, 0xd, 0xffffffff, 0xe, 0x0, 0x0, 0x8, 0x0, 0x8, 0x2, 0x0, 0x0, 0x0, 0x0, 0x0, 0x0
.size M_table, 448
.section .rodata,"a"
.p2align 6
.amdhsa_kernel gated_mix__compressed_kv_cla__memory_aug_recurrent_mem_tr__prompt_kernel
.amdhsa_next_free_vgpr 512
.amdhsa_next_free_sgpr 102
.amdhsa_accum_offset 256
.amdhsa_group_segment_fixed_size 0
.amdhsa_kernarg_size 136
.amdhsa_user_sgpr_count 2
.amdhsa_user_sgpr_kernarg_segment_ptr 1
.amdhsa_system_sgpr_workgroup_id_x 1
.end_amdhsa_kernel
```

```asm
; @launch grid=(256,1,1) block=(256,1,1) lds=163840
.amdgcn_target "amdgcn-amd-amdhsa--gfx950"
.text
.globl gated_mix__compressed_kv_cla__memory_aug_recurrent_mem_tr__prompt_kernel
.p2align 8
.type gated_mix__compressed_kv_cla__memory_aug_recurrent_mem_tr__prompt_kernel,@function
gated_mix__compressed_kv_cla__memory_aug_recurrent_mem_tr__prompt_kernel:
  s_cmp_ge_u32 s2, 256
  s_cbranch_scc1 M_exit
  s_getpc_b64 s[60:61]
M_pc0:
  s_lshr_b32 s62, s2, 3
  s_and_b32 s62, s62, 3
  s_lshl_b32 s62, s62, 15
  v_lshl_add_u32 v104, v0, 7, s62
  v_min_u32 v104, M_table-M_pc0, v104
  global_load_dword v105, v104, s[60:61]
  s_lshr_b32 s77, s2, 3
  s_and_b32 s76, s2, 7
  s_cbranch_scc1 M_worker
  s_mov_b32 s12, s77
  s_load_dwordx4 s[60:63], s[0:1], 64
  s_load_dwordx4 s[64:67], s[0:1], 80
  s_load_dwordx4 s[68:71], s[0:1], 120
  s_load_dwordx2 s[72:73], s[0:1], 56
  v_lshrrev_b32 v1, 6, v0
  v_and_b32 v20, 63, v0
  v_readfirstlane_b32 s13, v1
  v_lshrrev_b32 v26, 3, v20
  v_lshlrev_b32 v26, 10, v26
  v_and_b32 v1, 7, v20
  v_lshl_add_u32 v26, v1, 4, v26
  s_lshl_b32 s36, s13, 7
  s_lshl_b32 s38, s12, 17
  s_add_u32 s36, s36, s38
  v_add_u32 v26, s36, v26
  s_lshl_b32 s39, s13, 15
  s_add_u32 s39, s39, 32768
  s_waitcnt lgkmcnt(0)
  s_mov_b32 s48, s66
  s_and_b32 s49, s67, 0xffff
  s_mov_b32 s50, 0x400000
  s_mov_b32 s51, 0x20000
  s_xor_b32 s36, s13, 0
  s_lshl_b32 s36, s36, 15
  s_add_u32 m0, s39, 28672
  s_add_u32 s37, s36, 0
  buffer_load_dwordx4 v26, s[48:51], s37 offen lds
  s_add_u32 m0, s39, 29696
  s_add_u32 s37, s36, 8192
  buffer_load_dwordx4 v26, s[48:51], s37 offen lds
  s_add_u32 m0, s39, 30720
  s_add_u32 s37, s36, 16384
  buffer_load_dwordx4 v26, s[48:51], s37 offen lds
  s_add_u32 m0, s39, 31744
  s_add_u32 s37, s36, 24576
  buffer_load_dwordx4 v26, s[48:51], s37 offen lds
  s_xor_b32 s36, s13, 0
  s_lshl_b32 s36, s36, 15
  s_add_u32 m0, s39, 24576
  s_add_u32 s37, s36, 512
  buffer_load_dwordx4 v26, s[48:51], s37 offen lds
  s_add_u32 m0, s39, 25600
  s_add_u32 s37, s36, 8704
  buffer_load_dwordx4 v26, s[48:51], s37 offen lds
  s_add_u32 m0, s39, 26624
  s_add_u32 s37, s36, 16896
  buffer_load_dwordx4 v26, s[48:51], s37 offen lds
  s_add_u32 m0, s39, 27648
  s_add_u32 s37, s36, 25088
  buffer_load_dwordx4 v26, s[48:51], s37 offen lds
  s_xor_b32 s36, s13, 1
  s_lshl_b32 s36, s36, 15
  s_add_u32 m0, s39, 12288
  s_add_u32 s37, s36, 0
  buffer_load_dwordx4 v26, s[48:51], s37 offen lds
  s_add_u32 m0, s39, 13312
  s_add_u32 s37, s36, 8192
  buffer_load_dwordx4 v26, s[48:51], s37 offen lds
  s_add_u32 m0, s39, 14336
  s_add_u32 s37, s36, 16384
  buffer_load_dwordx4 v26, s[48:51], s37 offen lds
  s_add_u32 m0, s39, 15360
  s_add_u32 s37, s36, 24576
  buffer_load_dwordx4 v26, s[48:51], s37 offen lds
  s_xor_b32 s36, s13, 1
  s_lshl_b32 s36, s36, 15
  s_add_u32 m0, s39, 8192
  s_add_u32 s37, s36, 512
  buffer_load_dwordx4 v26, s[48:51], s37 offen lds
  s_add_u32 m0, s39, 9216
  s_add_u32 s37, s36, 8704
  buffer_load_dwordx4 v26, s[48:51], s37 offen lds
  s_add_u32 m0, s39, 10240
  s_add_u32 s37, s36, 16896
  buffer_load_dwordx4 v26, s[48:51], s37 offen lds
  s_add_u32 m0, s39, 11264
  s_add_u32 s37, s36, 25088
  buffer_load_dwordx4 v26, s[48:51], s37 offen lds
  s_mov_b32 s8, s60
  s_and_b32 s9, s61, 0xffff
  s_mov_b32 s10, 0x400000
  s_mov_b32 s11, 0x20000
  s_mov_b32 s40, s62
  s_and_b32 s41, s63, 0xffff
  s_mov_b32 s42, 0x400000
  s_mov_b32 s43, 0x20000
  s_mov_b32 s44, s64
  s_and_b32 s45, s65, 0xffff
  s_mov_b32 s46, 0x400000
  s_mov_b32 s47, 0x20000
  s_mov_b32 s4, s70
  s_and_b32 s5, s71, 0xffff
  s_mov_b32 s6, 0x10000000
  s_mov_b32 s7, 0x20000
  s_mov_b32 s76, s72
  s_and_b32 s77, s73, 0xffff
  s_mov_b32 s78, 0x2000
  s_mov_b32 s79, 0x20000
  s_mov_b32 s72, s68
  s_and_b32 s73, s69, 0xffff
  s_mov_b32 s74, 0x100
  s_mov_b32 s75, 0x20000
  s_mov_b64 s[52:53], s[68:69]
  s_mov_b64 s[58:59], s[70:71]
  s_mul_i32 s99, s12, 896
  s_add_u32 s99, s99, 148898048
  s_lshl_b32 s15, s12, 7
  s_add_u32 s15, s15, 148926464
  v_lshrrev_b32 v21, 4, v20
  v_and_b32 v22, 15, v20
  v_and_b32 v23, 1, v21
  v_lshrrev_b32 v24, 1, v21
  v_lshlrev_b32 v2, 4, v20
  s_lshl_b32 s36, s13, 10
  v_add_u32 v59, s36, v2
  s_mov_b32 s37, s39
  v_add_u32 v4, s37, v2
  v_lshrrev_b32 v25, 2, v20
  v_lshlrev_b32 v25, 13, v25
  v_and_b32 v1, 3, v20
  v_lshl_add_u32 v25, v1, 4, v25
  s_lshl_b32 s36, s13, 6
  s_lshl_b32 s38, s12, 8
  s_add_u32 s36, s36, s38
  v_add_u32 v25, s36, v25
  v_bfe_u32 v29, v20, 2, 1
  v_bfe_u32 v30, v20, 3, 1
  v_and_b32 v31, 3, v20
  v_lshl_add_u32 v27, v21, 2, v29
  v_lshlrev_b32 v27, 6, v27
  v_lshl_add_u32 v27, v30, 5, v27
  v_lshl_add_u32 v27, v31, 3, v27
  v_add_u32 v27, s37, v27
  v_xor_b32 v36, 1, v30
  v_lshl_add_u32 v36, v36, 11, v27
  v_lshl_add_u32 v27, v30, 11, v27
  v_lshl_add_u32 v28, v23, 2, v24
  v_lshl_add_u32 v28, v28, 2, v29
  v_lshlrev_b32 v28, 7, v28
  v_lshl_add_u32 v28, v30, 6, v28
  v_lshl_add_u32 v28, v31, 4, v28
  v_add_u32 v28, s37, v28
  v_lshrrev_b32 v25, 3, v20
  v_lshlrev_b32 v25, 13, v25
  v_and_b32 v1, 7, v20
  v_lshl_add_u32 v25, v1, 4, v25
  s_lshr_b32 s36, s13, 1
  s_lshl1_add_u32 s36, s12, s36
  s_lshl_b32 s36, s36, 7
  v_add_u32 v25, s36, v25
  v_lshl_add_u32 v27, v21, 2, v29
  v_lshlrev_b32 v27, 7, v27
  v_lshl_add_u32 v27, v30, 5, v27
  v_lshl_add_u32 v27, v31, 3, v27
  s_and_b32 s36, s13, 1
  s_lshl_b32 s36, s36, 6
  s_xor_b32 s37, s13, 1
  s_lshl_b32 s37, s37, 15
  s_add_u32 s37, s37, s36
  s_add_u32 s37, s37, 32768
  s_add_u32 s36, s36, s39
  v_add_u32 v36, s37, v27
  v_add_u32 v27, s36, v27
  v_lshlrev_b32 v101, 12, v30
  v_xor_b32 v100, 0x1000, v101
  v_mov_b32 v0, 0x4444
  v_mov_b32 v1, 0xeeee
  v_cmp_lt_u32 vcc, 7, v22
  s_nop 1
  v_cndmask_b32 v32, v0, v1, vcc
  v_mov_b32 v0, v32
  v_and_b32 v32, 7, v20
  v_lshlrev_b32 v32, 4, v32
  v_lshl_add_u32 v11, v21, 7, v32
  v_xor_b32 v1, 128, v2
  v_lshl_add_u32 v33, v24, 4, v22
  s_lshl_b32 s36, s13, 5
  v_add_u32 v33, s36, v33
  v_lshlrev_b32 v33, 3, v33
  v_mul_u32_u24 v34, 1152, v23
  v_add_u32 v5, v33, v34
  v_bfe_u32 v33, v20, 2, 2
  v_lshl_add_u32 v33, v23, 2, v33
  v_lshl_add_u32 v33, v24, 4, v33
  v_lshlrev_b32 v33, 3, v33
  v_and_b32 v34, 1, v20
  v_mul_u32_u24 v34, 1152, v34
  v_add_u32 v6, v33, v34
  s_lshl_b32 s36, s13, 3
  v_lshrrev_b32 v33, 3, v20
  v_add_u32 v33, s36, v33
  v_mul_u32_u24 v34, 0, v33
  v_add_u32 v34, s12, v34
  v_and_b32 v34, 31, v34
  v_lshrrev_b32 v37, 1, v32
  v_lshl_add_u32 v33, v33, 13, v37
  v_lshl_add_u32 v7, v34, 7, v33
  v_and_b32 v37, 1, v20
  v_bfe_u32 v38, v20, 1, 1
  v_lshl_add_u32 v37, v29, 1, v37
  s_lshr_b32 s36, s12, 3
  s_lshl_b32 s36, s36, 10
  s_and_b32 s37, s12, 1
  s_lshl_b32 s37, s37, 9
  s_add_u32 s36, s36, s37
  s_and_b32 s37, s12, 6
  s_lshl_b32 s37, s37, 5
  s_add_u32 s36, s36, s37
  v_lshlrev_b32 v33, 4, v21
  v_lshl_add_u32 v33, v37, 2, v33
  v_lshl_add_u32 v33, v38, 8, v33
  v_lshl_add_u32 v33, v30, 30, v33
  v_add_u32 v8, s36, v33
  v_mov_b32 v39, v21
  s_lshr_b32 s36, s12, 2
  s_lshl_b32 s36, s36, 6
  s_and_b32 s37, s12, 1
  s_lshl_b32 s37, s37, 5
  s_add_u32 s36, s36, s37
  s_and_b32 s37, s12, 2
  s_lshl_b32 s37, s37, 11
  s_add_u32 s36, s36, s37
  v_lshlrev_b32 v35, 10, v39
  v_lshl_add_u32 v35, v37, 2, v35
  v_lshl_add_u32 v35, v38, 4, v35
  v_add_u32 v35, s36, v35
  buffer_load_ushort v44, v35, s[76:79], 0 offen offset:0
  buffer_load_ushort v45, v35, s[76:79], 0 offen offset:2
  buffer_load_ushort v46, v35, s[76:79], 0 offen offset:512
  buffer_load_ushort v47, v35, s[76:79], 0 offen offset:514
  v_lshlrev_b32 v33, 4, v29
  v_mov_b32 v34, 0x3f80
  v_lshlrev_b32 v33, v33, v34
  v_and_b32 v34, 1, v20
  v_lshl_add_u32 v34, v34, 1, v30
  v_cmp_eq_u32 vcc, 0, v34
  s_nop 1
  v_cndmask_b32 v48, 0, v33, vcc
  v_cmp_eq_u32 vcc, 1, v34
  s_nop 1
  v_cndmask_b32 v49, 0, v33, vcc
  v_cmp_eq_u32 vcc, 2, v34
  s_nop 1
  v_cndmask_b32 v50, 0, v33, vcc
  v_cmp_eq_u32 vcc, 3, v34
  s_nop 1
  v_cndmask_b32 v51, 0, v33, vcc
  ds_write_b128 v2, v[48:51] offset:31232
  v_lshlrev_b32 v33, 9, v21
  s_lshl_b32 s36, s13, 11
  v_add_u32 v33, s36, v33
  v_lshl_add_u32 v10, v22, 4, v33
  v_lshl_add_u32 v33, v30, 8, v33
  v_add_u32 v9, v33, v32
  v_mov_b32 v12, 0x3f803f80
  v_mov_b32 v13, 0x3f803f80
  v_mov_b32 v14, 0x3f803f80
  v_mov_b32 v15, 0x3f803f80
  s_mov_b32 s2, 0x3f803f80
  s_mov_b32 s3, 0x3f803f80
  s_mov_b32 s98, 0
  v_and_b32 v33, 1, v20
  v_mul_u32_u24 v33, 128, v33
  v_min_u32 v34, 1, v20
  v_lshlrev_b32 v34, 30, v34
  s_cmp_eq_u32 s13, 3
  s_cselect_b64 vcc, -1, 0
  v_cndmask_b32 v19, v34, v33, vcc
  v_mov_b64 v[60:61], 0
  v_mov_b32 v62, 32256
  ds_write_b64 v62, v[60:61]
  s_mov_b32 s16, 0
  s_mov_b32 s17, -1
  s_mov_b32 s18, 0x3e0293ee
  s_mov_b32 s54, 0x2f800000
  s_mov_b32 s55, 0x28000000
  s_mov_b32 s96, s55
  s_lshl_b32 s36, s13, 10
  s_add_u32 s31, s36, 8192
  s_add_u32 s32, s36, 12160
  s_add_u32 s33, s36, 16384
  s_add_u32 s34, s36, 20224
  s_lshl_b32 s36, s12, 19
  s_add_u32 s27, s36, 67108864
  s_add_u32 s28, s36, 83886080
  s_mul_i32 s36, s12, 4096
  s_add_u32 s29, s36, 135266304
  s_lshl_b32 s36, s12, 13
  s_add_u32 s22, s36, 144703488
  s_add_u32 s23, s36, 144707584
  s_mov_b32 s20, 144703488
  s_mov_b32 s21, 144707584
  v_mov_b32 v40, -1
  v_mov_b32 v41, -1
  v_mov_b32 v42, -1
  v_mov_b32 v43, -1
  s_lshl_b32 s36, s13, 13
  s_add_u32 s36, s36, 145752064
  s_add_u32 s37, s36, 4096
  buffer_store_dwordx4 v[40:43], v59, s[4:7], s22 offen sc1
  buffer_store_dwordx4 v[40:43], v59, s[4:7], s23 offen sc1
  buffer_store_dword v40, v8, s[4:7], s36 offen sc1
  buffer_store_dword v40, v8, s[4:7], s37 offen sc1
  v_mov_b32 v52, 0
  v_min_u32 v53, 1, v59
  v_lshlrev_b32 v53, 30, v53
  buffer_store_dword v52, v53, s[4:7], s15 offen sc1
  s_waitcnt vmcnt(21)
  ds_read_b64_tr_b16 a[160:161], v28 offset:28672
  ds_read_b64_tr_b16 a[162:163], v28 offset:28928
  ds_read_b64_tr_b16 a[164:165], v28 offset:29696
  ds_read_b64_tr_b16 a[166:167], v28 offset:29952
  ds_read_b64_tr_b16 a[168:169], v28 offset:28680
  ds_read_b64_tr_b16 a[170:171], v28 offset:28936
  ds_read_b64_tr_b16 a[172:173], v28 offset:29704
  ds_read_b64_tr_b16 a[174:175], v28 offset:29960
  s_waitcnt lgkmcnt(0)
  s_waitcnt vmcnt(17)
  ds_read_b64_tr_b16 a[176:177], v28 offset:24576
  ds_read_b64_tr_b16 a[178:179], v28 offset:24832
  ds_read_b64_tr_b16 a[180:181], v28 offset:25600
  ds_read_b64_tr_b16 a[182:183], v28 offset:25856
  ds_read_b64_tr_b16 a[184:185], v28 offset:24584
  ds_read_b64_tr_b16 a[186:187], v28 offset:24840
  ds_read_b64_tr_b16 a[188:189], v28 offset:25608
  ds_read_b64_tr_b16 a[190:191], v28 offset:25864
  s_waitcnt lgkmcnt(0)
  s_xor_b32 s36, s13, 2
  s_lshl_b32 s36, s36, 15
  s_add_u32 m0, s39, 28672
  s_add_u32 s37, s36, 0
  buffer_load_dwordx4 v26, s[48:51], s37 offen lds
  s_add_u32 m0, s39, 29696
  s_add_u32 s37, s36, 8192
  buffer_load_dwordx4 v26, s[48:51], s37 offen lds
  s_add_u32 m0, s39, 30720
  s_add_u32 s37, s36, 16384
  buffer_load_dwordx4 v26, s[48:51], s37 offen lds
  s_add_u32 m0, s39, 31744
  s_add_u32 s37, s36, 24576
  buffer_load_dwordx4 v26, s[48:51], s37 offen lds
  s_xor_b32 s36, s13, 3
  s_lshl_b32 s36, s36, 15
  s_add_u32 m0, s39, 24576
  s_add_u32 s37, s36, 0
  buffer_load_dwordx4 v26, s[48:51], s37 offen lds
  s_add_u32 m0, s39, 25600
  s_add_u32 s37, s36, 8192
  buffer_load_dwordx4 v26, s[48:51], s37 offen lds
  s_add_u32 m0, s39, 26624
  s_add_u32 s37, s36, 16384
  buffer_load_dwordx4 v26, s[48:51], s37 offen lds
  s_add_u32 m0, s39, 27648
  s_add_u32 s37, s36, 24576
  buffer_load_dwordx4 v26, s[48:51], s37 offen lds
  s_waitcnt vmcnt(21)
  ds_read_b64_tr_b16 a[192:193], v28 offset:12288
  ds_read_b64_tr_b16 a[194:195], v28 offset:12544
  ds_read_b64_tr_b16 a[196:197], v28 offset:13312
  ds_read_b64_tr_b16 a[198:199], v28 offset:13568
  ds_read_b64_tr_b16 a[200:201], v28 offset:12296
  ds_read_b64_tr_b16 a[202:203], v28 offset:12552
  ds_read_b64_tr_b16 a[204:205], v28 offset:13320
  ds_read_b64_tr_b16 a[206:207], v28 offset:13576
  s_waitcnt lgkmcnt(0)
  s_waitcnt vmcnt(17)
  ds_read_b64_tr_b16 a[208:209], v28 offset:8192
  ds_read_b64_tr_b16 a[210:211], v28 offset:8448
  ds_read_b64_tr_b16 a[212:213], v28 offset:9216
  ds_read_b64_tr_b16 a[214:215], v28 offset:9472
  ds_read_b64_tr_b16 a[216:217], v28 offset:8200
  ds_read_b64_tr_b16 a[218:219], v28 offset:8456
  ds_read_b64_tr_b16 a[220:221], v28 offset:9224
  ds_read_b64_tr_b16 a[222:223], v28 offset:9480
  s_waitcnt lgkmcnt(0)
  s_xor_b32 s36, s13, 2
  s_lshl_b32 s36, s36, 19
  s_add_u32 m0, s39, 12288
  s_add_u32 s37, s36, 0
  buffer_load_dwordx4 v25, s[8:11], s37 offen lds
  s_add_u32 m0, s39, 13312
  s_add_u32 s37, s36, 65536
  buffer_load_dwordx4 v25, s[8:11], s37 offen lds
  s_add_u32 m0, s39, 14336
  s_add_u32 s37, s36, 131072
  buffer_load_dwordx4 v25, s[8:11], s37 offen lds
  s_add_u32 m0, s39, 15360
  s_add_u32 s37, s36, 196608
  buffer_load_dwordx4 v25, s[8:11], s37 offen lds
  s_xor_b32 s36, s13, 2
  s_lshl_b32 s36, s36, 19
  s_add_u32 m0, s39, 8192
  s_add_u32 s37, s36, 262144
  buffer_load_dwordx4 v25, s[8:11], s37 offen lds
  s_add_u32 m0, s39, 9216
  s_add_u32 s37, s36, 327680
  buffer_load_dwordx4 v25, s[8:11], s37 offen lds
  s_add_u32 m0, s39, 10240
  s_add_u32 s37, s36, 393216
  buffer_load_dwordx4 v25, s[8:11], s37 offen lds
  s_add_u32 m0, s39, 11264
  s_add_u32 s37, s36, 458752
  buffer_load_dwordx4 v25, s[8:11], s37 offen lds
  s_waitcnt vmcnt(12)
  ds_read_b64_tr_b16 a[224:225], v28 offset:28672
  ds_read_b64_tr_b16 a[226:227], v28 offset:28928
  ds_read_b64_tr_b16 a[228:229], v28 offset:29696
  ds_read_b64_tr_b16 a[230:231], v28 offset:29952
  ds_read_b64_tr_b16 a[232:233], v28 offset:28680
  ds_read_b64_tr_b16 a[234:235], v28 offset:28936
  ds_read_b64_tr_b16 a[236:237], v28 offset:29704
  ds_read_b64_tr_b16 a[238:239], v28 offset:29960
  s_waitcnt lgkmcnt(0)
  s_waitcnt vmcnt(8)
  ds_read_b64_tr_b16 a[240:241], v28 offset:24576
  ds_read_b64_tr_b16 a[242:243], v28 offset:24832
  ds_read_b64_tr_b16 a[244:245], v28 offset:25600
  ds_read_b64_tr_b16 a[246:247], v28 offset:25856
  ds_read_b64_tr_b16 a[248:249], v28 offset:24584
  ds_read_b64_tr_b16 a[250:251], v28 offset:24840
  ds_read_b64_tr_b16 a[252:253], v28 offset:25608
  ds_read_b64_tr_b16 a[254:255], v28 offset:25864
  s_waitcnt lgkmcnt(0)
  s_xor_b32 s36, s13, 4
  s_lshl_b32 s36, s36, 19
  s_add_u32 m0, s39, 28672
  s_add_u32 s37, s36, 0
  buffer_load_dwordx4 v25, s[8:11], s37 offen lds
  s_add_u32 m0, s39, 29696
  s_add_u32 s37, s36, 65536
  buffer_load_dwordx4 v25, s[8:11], s37 offen lds
  s_add_u32 m0, s39, 30720
  s_add_u32 s37, s36, 131072
  buffer_load_dwordx4 v25, s[8:11], s37 offen lds
  s_add_u32 m0, s39, 31744
  s_add_u32 s37, s36, 196608
  buffer_load_dwordx4 v25, s[8:11], s37 offen lds
  s_xor_b32 s36, s13, 4
  s_lshl_b32 s36, s36, 19
  s_add_u32 m0, s39, 24576
  s_add_u32 s37, s36, 262144
  buffer_load_dwordx4 v25, s[8:11], s37 offen lds
  s_add_u32 m0, s39, 25600
  s_add_u32 s37, s36, 327680
  buffer_load_dwordx4 v25, s[8:11], s37 offen lds
  s_add_u32 m0, s39, 26624
  s_add_u32 s37, s36, 393216
  buffer_load_dwordx4 v25, s[8:11], s37 offen lds
  s_add_u32 m0, s39, 27648
  s_add_u32 s37, s36, 458752
  buffer_load_dwordx4 v25, s[8:11], s37 offen lds
  s_barrier
  s_cmp_lg_u32 s13, 0
  s_cbranch_scc1 T_arm_1
  s_getreg_b32 s36, hwreg(HW_REG_XCC_ID, 0, 3)
  s_lshl_b32 s36, s36, 3
  s_lshl_b64 s[60:61], 1, s36
  s_mov_b32 s62, 1
  s_atomic_add_x2 s[60:61], s[52:53], 0
  s_atomic_add s62, s[52:53], 128
  v_lshl_or_b32 v44, v45, 16, v44
  v_lshl_or_b32 v46, v47, 16, v46
  v_min_u32 v44, -2, v44
  v_min_u32 v46, -2, v46
  s_mov_b32 s36, 145752064
  s_mov_b32 s37, 145756160
  buffer_store_dword v44, v8, s[4:7], s36 offen sc1
  buffer_store_dword v46, v8, s[4:7], s37 offen sc1
T_arm_1:
  v_mad_u32_u24 v96, v100, 1, v27
  v_mad_u32_u24 v97, v101, 1, v27
  v_mad_u32_u24 v98, v100, 1, v36
  v_mad_u32_u24 v99, v101, 1, v36
  s_waitcnt vmcnt(8)
  s_barrier
  ds_read_b64_tr_b16 v[160:161], v96 offset:8192
  ds_read_b64_tr_b16 v[162:163], v96 offset:8448
  ds_read_b64_tr_b16 v[164:165], v96 offset:10240
  ds_read_b64_tr_b16 v[166:167], v96 offset:10496
  ds_read_b64_tr_b16 v[168:169], v97 offset:8192
  ds_read_b64_tr_b16 v[170:171], v97 offset:8448
  ds_read_b64_tr_b16 v[172:173], v97 offset:10240
  ds_read_b64_tr_b16 v[174:175], v97 offset:10496
  ds_read_b64_tr_b16 v[192:193], v98 offset:8192
  ds_read_b64_tr_b16 v[194:195], v98 offset:8448
  ds_read_b64_tr_b16 v[196:197], v98 offset:10240
  ds_read_b64_tr_b16 v[198:199], v98 offset:10496
  ds_read_b64_tr_b16 v[200:201], v99 offset:8192
  ds_read_b64_tr_b16 v[202:203], v99 offset:8448
  ds_read_b64_tr_b16 v[204:205], v99 offset:10240
  ds_read_b64_tr_b16 v[206:207], v99 offset:10496
  s_waitcnt lgkmcnt(0)
  s_barrier
  s_xor_b32 s36, s13, 4
  s_lshl_b32 s36, s36, 19
  s_add_u32 m0, s39, 12288
  s_add_u32 s37, s36, 0
  buffer_load_dwordx4 v25, s[40:43], s37 offen lds
  s_add_u32 m0, s39, 13312
  s_add_u32 s37, s36, 65536
  buffer_load_dwordx4 v25, s[40:43], s37 offen lds
  s_add_u32 m0, s39, 14336
  s_add_u32 s37, s36, 131072
  buffer_load_dwordx4 v25, s[40:43], s37 offen lds
  s_add_u32 m0, s39, 15360
  s_add_u32 s37, s36, 196608
  buffer_load_dwordx4 v25, s[40:43], s37 offen lds
  s_xor_b32 s36, s13, 4
  s_lshl_b32 s36, s36, 19
  s_add_u32 m0, s39, 8192
  s_add_u32 s37, s36, 262144
  buffer_load_dwordx4 v25, s[40:43], s37 offen lds
  s_add_u32 m0, s39, 9216
  s_add_u32 s37, s36, 327680
  buffer_load_dwordx4 v25, s[40:43], s37 offen lds
  s_add_u32 m0, s39, 10240
  s_add_u32 s37, s36, 393216
  buffer_load_dwordx4 v25, s[40:43], s37 offen lds
  s_add_u32 m0, s39, 11264
  s_add_u32 s37, s36, 458752
  buffer_load_dwordx4 v25, s[40:43], s37 offen lds
  v_mad_u32_u24 v96, v100, 1, v27
  v_mad_u32_u24 v97, v101, 1, v27
  v_mad_u32_u24 v98, v100, 1, v36
  v_mad_u32_u24 v99, v101, 1, v36
  s_waitcnt vmcnt(8)
  s_barrier
  ds_read_b64_tr_b16 v[224:225], v96 offset:24576
  ds_read_b64_tr_b16 v[226:227], v96 offset:24832
  ds_read_b64_tr_b16 v[228:229], v96 offset:26624
  ds_read_b64_tr_b16 v[230:231], v96 offset:26880
  ds_read_b64_tr_b16 v[232:233], v97 offset:24576
  ds_read_b64_tr_b16 v[234:235], v97 offset:24832
  ds_read_b64_tr_b16 v[236:237], v97 offset:26624
  ds_read_b64_tr_b16 v[238:239], v97 offset:26880
  ds_read_b64_tr_b16 a[16:17], v98 offset:24576
  ds_read_b64_tr_b16 a[18:19], v98 offset:24832
  ds_read_b64_tr_b16 a[20:21], v98 offset:26624
  ds_read_b64_tr_b16 a[22:23], v98 offset:26880
  ds_read_b64_tr_b16 a[24:25], v99 offset:24576
  ds_read_b64_tr_b16 a[26:27], v99 offset:24832
  ds_read_b64_tr_b16 a[28:29], v99 offset:26624
  ds_read_b64_tr_b16 a[30:31], v99 offset:26880
  s_waitcnt lgkmcnt(0)
  s_barrier
  s_xor_b32 s36, s13, 4
  s_lshl_b32 s36, s36, 19
  s_add_u32 m0, s39, 28672
  s_add_u32 s37, s36, 0
  buffer_load_dwordx4 v25, s[44:47], s37 offen lds
  s_add_u32 m0, s39, 29696
  s_add_u32 s37, s36, 65536
  buffer_load_dwordx4 v25, s[44:47], s37 offen lds
  s_add_u32 m0, s39, 30720
  s_add_u32 s37, s36, 131072
  buffer_load_dwordx4 v25, s[44:47], s37 offen lds
  s_add_u32 m0, s39, 31744
  s_add_u32 s37, s36, 196608
  buffer_load_dwordx4 v25, s[44:47], s37 offen lds
  s_xor_b32 s36, s13, 4
  s_lshl_b32 s36, s36, 19
  s_add_u32 m0, s39, 24576
  s_add_u32 s37, s36, 262144
  buffer_load_dwordx4 v25, s[44:47], s37 offen lds
  s_add_u32 m0, s39, 25600
  s_add_u32 s37, s36, 327680
  buffer_load_dwordx4 v25, s[44:47], s37 offen lds
  s_add_u32 m0, s39, 26624
  s_add_u32 s37, s36, 393216
  buffer_load_dwordx4 v25, s[44:47], s37 offen lds
  s_add_u32 m0, s39, 27648
  s_add_u32 s37, s36, 458752
  buffer_load_dwordx4 v25, s[44:47], s37 offen lds
  v_mad_u32_u24 v96, v100, 1, v27
  v_mad_u32_u24 v97, v101, 1, v27
  v_mad_u32_u24 v98, v100, 1, v36
  v_mad_u32_u24 v99, v101, 1, v36
  s_waitcnt vmcnt(8)
  s_barrier
  ds_read_b64_tr_b16 v[240:241], v96 offset:8192
  ds_read_b64_tr_b16 v[242:243], v96 offset:8448
  ds_read_b64_tr_b16 v[244:245], v96 offset:10240
  ds_read_b64_tr_b16 v[246:247], v96 offset:10496
  ds_read_b64_tr_b16 v[248:249], v97 offset:8192
  ds_read_b64_tr_b16 v[250:251], v97 offset:8448
  ds_read_b64_tr_b16 v[252:253], v97 offset:10240
  ds_read_b64_tr_b16 v[254:255], v97 offset:10496
  ds_read_b64_tr_b16 a[32:33], v98 offset:8192
  ds_read_b64_tr_b16 a[34:35], v98 offset:8448
  ds_read_b64_tr_b16 a[36:37], v98 offset:10240
  ds_read_b64_tr_b16 a[38:39], v98 offset:10496
  ds_read_b64_tr_b16 a[40:41], v99 offset:8192
  ds_read_b64_tr_b16 a[42:43], v99 offset:8448
  ds_read_b64_tr_b16 a[44:45], v99 offset:10240
  ds_read_b64_tr_b16 a[46:47], v99 offset:10496
  s_waitcnt lgkmcnt(0)
  s_barrier
  s_xor_b32 s36, s13, 6
  s_lshl_b32 s36, s36, 19
  s_add_u32 m0, s39, 12288
  s_add_u32 s37, s36, 0
  buffer_load_dwordx4 v25, s[8:11], s37 offen lds
  s_add_u32 m0, s39, 13312
  s_add_u32 s37, s36, 65536
  buffer_load_dwordx4 v25, s[8:11], s37 offen lds
  s_add_u32 m0, s39, 14336
  s_add_u32 s37, s36, 131072
  buffer_load_dwordx4 v25, s[8:11], s37 offen lds
  s_add_u32 m0, s39, 15360
  s_add_u32 s37, s36, 196608
  buffer_load_dwordx4 v25, s[8:11], s37 offen lds
  s_xor_b32 s36, s13, 6
  s_lshl_b32 s36, s36, 19
  s_add_u32 m0, s39, 8192
  s_add_u32 s37, s36, 262144
  buffer_load_dwordx4 v25, s[8:11], s37 offen lds
  s_add_u32 m0, s39, 9216
  s_add_u32 s37, s36, 327680
  buffer_load_dwordx4 v25, s[8:11], s37 offen lds
  s_add_u32 m0, s39, 10240
  s_add_u32 s37, s36, 393216
  buffer_load_dwordx4 v25, s[8:11], s37 offen lds
  s_add_u32 m0, s39, 11264
  s_add_u32 s37, s36, 458752
  buffer_load_dwordx4 v25, s[8:11], s37 offen lds
  v_mad_u32_u24 v96, v100, 1, v27
  v_mad_u32_u24 v97, v101, 1, v27
  v_mad_u32_u24 v98, v100, 1, v36
  v_mad_u32_u24 v99, v101, 1, v36
  s_waitcnt vmcnt(8)
  s_barrier
  ds_read_b64_tr_b16 a[0:1], v96 offset:24576
  ds_read_b64_tr_b16 a[2:3], v96 offset:24832
  ds_read_b64_tr_b16 a[4:5], v96 offset:26624
  ds_read_b64_tr_b16 a[6:7], v96 offset:26880
  ds_read_b64_tr_b16 a[8:9], v97 offset:24576
  ds_read_b64_tr_b16 a[10:11], v97 offset:24832
  ds_read_b64_tr_b16 a[12:13], v97 offset:26624
  ds_read_b64_tr_b16 a[14:15], v97 offset:26880
  ds_read_b64_tr_b16 a[48:49], v98 offset:24576
  ds_read_b64_tr_b16 a[50:51], v98 offset:24832
  ds_read_b64_tr_b16 a[52:53], v98 offset:26624
  ds_read_b64_tr_b16 a[54:55], v98 offset:26880
  ds_read_b64_tr_b16 a[56:57], v99 offset:24576
  ds_read_b64_tr_b16 a[58:59], v99 offset:24832
  ds_read_b64_tr_b16 a[60:61], v99 offset:26624
  ds_read_b64_tr_b16 a[62:63], v99 offset:26880
  s_waitcnt lgkmcnt(0)
  s_barrier
  s_xor_b32 s36, s13, 6
  s_lshl_b32 s36, s36, 19
  s_add_u32 m0, s39, 28672
  s_add_u32 s37, s36, 0
  buffer_load_dwordx4 v25, s[40:43], s37 offen lds
  s_add_u32 m0, s39, 29696
  s_add_u32 s37, s36, 65536
  buffer_load_dwordx4 v25, s[40:43], s37 offen lds
  s_add_u32 m0, s39, 30720
  s_add_u32 s37, s36, 131072
  buffer_load_dwordx4 v25, s[40:43], s37 offen lds
  s_add_u32 m0, s39, 31744
  s_add_u32 s37, s36, 196608
  buffer_load_dwordx4 v25, s[40:43], s37 offen lds
  s_xor_b32 s36, s13, 6
  s_lshl_b32 s36, s36, 19
  s_add_u32 m0, s39, 24576
  s_add_u32 s37, s36, 262144
  buffer_load_dwordx4 v25, s[40:43], s37 offen lds
  s_add_u32 m0, s39, 25600
  s_add_u32 s37, s36, 327680
  buffer_load_dwordx4 v25, s[40:43], s37 offen lds
  s_add_u32 m0, s39, 26624
  s_add_u32 s37, s36, 393216
  buffer_load_dwordx4 v25, s[40:43], s37 offen lds
  s_add_u32 m0, s39, 27648
  s_add_u32 s37, s36, 458752
  buffer_load_dwordx4 v25, s[40:43], s37 offen lds
  v_mad_u32_u24 v96, v100, 1, v27
  v_mad_u32_u24 v97, v101, 1, v27
  v_mad_u32_u24 v98, v100, 1, v36
  v_mad_u32_u24 v99, v101, 1, v36
  s_waitcnt vmcnt(8)
  s_barrier
  ds_read_b64_tr_b16 a[64:65], v96 offset:8192
  ds_read_b64_tr_b16 a[66:67], v96 offset:8448
  ds_read_b64_tr_b16 a[68:69], v96 offset:10240
  ds_read_b64_tr_b16 a[70:71], v96 offset:10496
  ds_read_b64_tr_b16 a[72:73], v97 offset:8192
  ds_read_b64_tr_b16 a[74:75], v97 offset:8448
  ds_read_b64_tr_b16 a[76:77], v97 offset:10240
  ds_read_b64_tr_b16 a[78:79], v97 offset:10496
  ds_read_b64_tr_b16 a[112:113], v98 offset:8192
  ds_read_b64_tr_b16 a[114:115], v98 offset:8448
  ds_read_b64_tr_b16 a[116:117], v98 offset:10240
  ds_read_b64_tr_b16 a[118:119], v98 offset:10496
  ds_read_b64_tr_b16 a[120:121], v99 offset:8192
  ds_read_b64_tr_b16 a[122:123], v99 offset:8448
  ds_read_b64_tr_b16 a[124:125], v99 offset:10240
  ds_read_b64_tr_b16 a[126:127], v99 offset:10496
  s_waitcnt lgkmcnt(0)
  s_barrier
  s_xor_b32 s36, s13, 6
  s_lshl_b32 s36, s36, 19
  s_add_u32 m0, s39, 12288
  s_add_u32 s37, s36, 0
  buffer_load_dwordx4 v25, s[44:47], s37 offen lds
  s_add_u32 m0, s39, 13312
  s_add_u32 s37, s36, 65536
  buffer_load_dwordx4 v25, s[44:47], s37 offen lds
  s_add_u32 m0, s39, 14336
  s_add_u32 s37, s36, 131072
  buffer_load_dwordx4 v25, s[44:47], s37 offen lds
  s_add_u32 m0, s39, 15360
  s_add_u32 s37, s36, 196608
  buffer_load_dwordx4 v25, s[44:47], s37 offen lds
  s_xor_b32 s36, s13, 6
  s_lshl_b32 s36, s36, 19
  s_add_u32 m0, s39, 8192
  s_add_u32 s37, s36, 262144
  buffer_load_dwordx4 v25, s[44:47], s37 offen lds
  s_add_u32 m0, s39, 9216
  s_add_u32 s37, s36, 327680
  buffer_load_dwordx4 v25, s[44:47], s37 offen lds
  s_add_u32 m0, s39, 10240
  s_add_u32 s37, s36, 393216
  buffer_load_dwordx4 v25, s[44:47], s37 offen lds
  s_add_u32 m0, s39, 11264
  s_add_u32 s37, s36, 458752
  buffer_load_dwordx4 v25, s[44:47], s37 offen lds
  v_mad_u32_u24 v96, v100, 1, v27
  v_mad_u32_u24 v97, v101, 1, v27
  v_mad_u32_u24 v98, v100, 1, v36
  v_mad_u32_u24 v99, v101, 1, v36
  s_waitcnt vmcnt(8)
  s_barrier
  ds_read_b64_tr_b16 a[80:81], v96 offset:24576
  ds_read_b64_tr_b16 a[82:83], v96 offset:24832
  ds_read_b64_tr_b16 a[84:85], v96 offset:26624
  ds_read_b64_tr_b16 a[86:87], v96 offset:26880
  ds_read_b64_tr_b16 a[88:89], v97 offset:24576
  ds_read_b64_tr_b16 a[90:91], v97 offset:24832
  ds_read_b64_tr_b16 a[92:93], v97 offset:26624
  ds_read_b64_tr_b16 a[94:95], v97 offset:26880
  ds_read_b64_tr_b16 a[128:129], v98 offset:24576
  ds_read_b64_tr_b16 a[130:131], v98 offset:24832
  ds_read_b64_tr_b16 a[132:133], v98 offset:26624
  ds_read_b64_tr_b16 a[134:135], v98 offset:26880
  ds_read_b64_tr_b16 a[136:137], v99 offset:24576
  ds_read_b64_tr_b16 a[138:139], v99 offset:24832
  ds_read_b64_tr_b16 a[140:141], v99 offset:26624
  ds_read_b64_tr_b16 a[142:143], v99 offset:26880
  s_waitcnt lgkmcnt(0)
  s_barrier
  s_xor_b32 s36, s13, 0
  s_lshl_b32 s36, s36, 19
  s_add_u32 m0, s39, 28672
  s_add_u32 s37, s36, 0
  buffer_load_dwordx4 v25, s[8:11], s37 offen lds
  s_add_u32 m0, s39, 29696
  s_add_u32 s37, s36, 65536
  buffer_load_dwordx4 v25, s[8:11], s37 offen lds
  s_add_u32 m0, s39, 30720
  s_add_u32 s37, s36, 131072
  buffer_load_dwordx4 v25, s[8:11], s37 offen lds
  s_add_u32 m0, s39, 31744
  s_add_u32 s37, s36, 196608
  buffer_load_dwordx4 v25, s[8:11], s37 offen lds
  s_xor_b32 s36, s13, 0
  s_lshl_b32 s36, s36, 19
  s_add_u32 m0, s39, 0
  s_add_u32 s37, s36, 262144
  buffer_load_dwordx4 v25, s[8:11], s37 offen lds
  s_add_u32 m0, s39, 1024
  s_add_u32 s37, s36, 327680
  buffer_load_dwordx4 v25, s[8:11], s37 offen lds
  s_add_u32 m0, s39, 2048
  s_add_u32 s37, s36, 393216
  buffer_load_dwordx4 v25, s[8:11], s37 offen lds
  s_add_u32 m0, s39, 3072
  s_add_u32 s37, s36, 458752
  buffer_load_dwordx4 v25, s[8:11], s37 offen lds
  v_mad_u32_u24 v96, v100, 1, v27
  v_mad_u32_u24 v97, v101, 1, v27
  v_mad_u32_u24 v98, v100, 1, v36
  v_mad_u32_u24 v99, v101, 1, v36
  s_waitcnt vmcnt(8)
  s_barrier
  ds_read_b64_tr_b16 a[96:97], v96 offset:8192
  ds_read_b64_tr_b16 a[98:99], v96 offset:8448
  ds_read_b64_tr_b16 a[100:101], v96 offset:10240
  ds_read_b64_tr_b16 a[102:103], v96 offset:10496
  ds_read_b64_tr_b16 a[104:105], v97 offset:8192
  ds_read_b64_tr_b16 a[106:107], v97 offset:8448
  ds_read_b64_tr_b16 a[108:109], v97 offset:10240
  ds_read_b64_tr_b16 a[110:111], v97 offset:10496
  ds_read_b64_tr_b16 a[144:145], v98 offset:8192
  ds_read_b64_tr_b16 a[146:147], v98 offset:8448
  ds_read_b64_tr_b16 a[148:149], v98 offset:10240
  ds_read_b64_tr_b16 a[150:151], v98 offset:10496
  ds_read_b64_tr_b16 a[152:153], v99 offset:8192
  ds_read_b64_tr_b16 a[154:155], v99 offset:8448
  ds_read_b64_tr_b16 a[156:157], v99 offset:10240
  ds_read_b64_tr_b16 a[158:159], v99 offset:10496
  s_waitcnt lgkmcnt(0)
  s_barrier
  s_xor_b32 s36, s13, 0
  s_lshl_b32 s36, s36, 19
  s_add_u32 m0, s39, 24576
  s_add_u32 s37, s36, 0
  buffer_load_dwordx4 v25, s[40:43], s37 offen lds
  s_add_u32 m0, s39, 25600
  s_add_u32 s37, s36, 65536
  buffer_load_dwordx4 v25, s[40:43], s37 offen lds
  s_add_u32 m0, s39, 26624
  s_add_u32 s37, s36, 131072
  buffer_load_dwordx4 v25, s[40:43], s37 offen lds
  s_add_u32 m0, s39, 27648
  s_add_u32 s37, s36, 196608
  buffer_load_dwordx4 v25, s[40:43], s37 offen lds
  s_xor_b32 s36, s13, 0
  s_lshl_b32 s36, s36, 19
  s_add_u32 m0, s39, 4096
  s_add_u32 s37, s36, 262144
  buffer_load_dwordx4 v25, s[40:43], s37 offen lds
  s_add_u32 m0, s39, 5120
  s_add_u32 s37, s36, 327680
  buffer_load_dwordx4 v25, s[40:43], s37 offen lds
  s_add_u32 m0, s39, 6144
  s_add_u32 s37, s36, 393216
  buffer_load_dwordx4 v25, s[40:43], s37 offen lds
  s_add_u32 m0, s39, 7168
  s_add_u32 s37, s36, 458752
  buffer_load_dwordx4 v25, s[40:43], s37 offen lds
  v_mad_u32_u24 v96, v100, 7, v27
  v_mad_u32_u24 v97, v101, 7, v27
  v_mad_u32_u24 v98, v100, 7, v36
  v_mad_u32_u24 v99, v101, 7, v36
  s_waitcnt vmcnt(8)
  s_barrier
  ds_read_b64_tr_b16 v[128:129], v98 offset:0
  ds_read_b64_tr_b16 v[130:131], v98 offset:256
  ds_read_b64_tr_b16 v[132:133], v98 offset:2048
  ds_read_b64_tr_b16 v[134:135], v98 offset:2304
  ds_read_b64_tr_b16 v[136:137], v99 offset:0
  ds_read_b64_tr_b16 v[138:139], v99 offset:256
  ds_read_b64_tr_b16 v[140:141], v99 offset:2048
  ds_read_b64_tr_b16 v[142:143], v99 offset:2304
  ds_read_b64_tr_b16 v[64:65], v96 offset:0
  ds_read_b64_tr_b16 v[66:67], v96 offset:256
  ds_read_b64_tr_b16 v[68:69], v96 offset:2048
  ds_read_b64_tr_b16 v[70:71], v96 offset:2304
  ds_read_b64_tr_b16 v[72:73], v97 offset:0
  ds_read_b64_tr_b16 v[74:75], v97 offset:256
  ds_read_b64_tr_b16 v[76:77], v97 offset:2048
  ds_read_b64_tr_b16 v[78:79], v97 offset:2304
  s_waitcnt lgkmcnt(0)
  s_barrier
  ds_write_b128 v4, v[64:67] offset:0
  ds_write_b128 v4, v[68:71] offset:1024
  ds_write_b128 v4, v[72:75] offset:2048
  ds_write_b128 v4, v[76:79] offset:3072
  s_xor_b32 s36, s13, 2
  s_lshl_b32 s36, s36, 19
  s_add_u32 m0, s39, 28672
  s_add_u32 s37, s36, 0
  buffer_load_dwordx4 v25, s[40:43], s37 offen lds
  s_add_u32 m0, s39, 29696
  s_add_u32 s37, s36, 65536
  buffer_load_dwordx4 v25, s[40:43], s37 offen lds
  s_add_u32 m0, s39, 30720
  s_add_u32 s37, s36, 131072
  buffer_load_dwordx4 v25, s[40:43], s37 offen lds
  s_add_u32 m0, s39, 31744
  s_add_u32 s37, s36, 196608
  buffer_load_dwordx4 v25, s[40:43], s37 offen lds
  s_xor_b32 s36, s13, 2
  s_lshl_b32 s36, s36, 19
  s_add_u32 m0, s39, 16384
  s_add_u32 s37, s36, 262144
  buffer_load_dwordx4 v25, s[40:43], s37 offen lds
  s_add_u32 m0, s39, 17408
  s_add_u32 s37, s36, 327680
  buffer_load_dwordx4 v25, s[40:43], s37 offen lds
  s_add_u32 m0, s39, 18432
  s_add_u32 s37, s36, 393216
  buffer_load_dwordx4 v25, s[40:43], s37 offen lds
  s_add_u32 m0, s39, 19456
  s_add_u32 s37, s36, 458752
  buffer_load_dwordx4 v25, s[40:43], s37 offen lds
  s_getpc_b64 s[60:61]
T_pc_2:
  s_add_u32 s60, s60, T_code-T_pc_2
  s_addc_u32 s61, s61, 0
  v_lshlrev_b32 v102, 3, v59
  v_min_u32 v102, 12416, v102
  global_load_dword v103, v102, s[60:61]
  buffer_load_dwordx2 v[54:55], off, s[72:75], 0 sc1
  buffer_load_dword v56, off, s[72:75], 0 offset:128 sc1
  v_mad_u32_u24 v96, v100, 5, v27
  v_mad_u32_u24 v97, v101, 5, v27
  v_mad_u32_u24 v98, v100, 5, v36
  v_mad_u32_u24 v99, v101, 5, v36
  s_waitcnt vmcnt(11)
  s_barrier
  ds_read_b64_tr_b16 v[144:145], v98 offset:4096
  ds_read_b64_tr_b16 v[146:147], v98 offset:4352
  ds_read_b64_tr_b16 v[148:149], v98 offset:6144
  ds_read_b64_tr_b16 v[150:151], v98 offset:6400
  ds_read_b64_tr_b16 v[152:153], v99 offset:4096
  ds_read_b64_tr_b16 v[154:155], v99 offset:4352
  ds_read_b64_tr_b16 v[156:157], v99 offset:6144
  ds_read_b64_tr_b16 v[158:159], v99 offset:6400
  ds_read_b64_tr_b16 v[64:65], v96 offset:4096
  ds_read_b64_tr_b16 v[66:67], v96 offset:4352
  ds_read_b64_tr_b16 v[68:69], v96 offset:6144
  ds_read_b64_tr_b16 v[70:71], v96 offset:6400
  ds_read_b64_tr_b16 v[72:73], v97 offset:4096
  ds_read_b64_tr_b16 v[74:75], v97 offset:4352
  ds_read_b64_tr_b16 v[76:77], v97 offset:6144
  ds_read_b64_tr_b16 v[78:79], v97 offset:6400
  s_waitcnt lgkmcnt(0)
  s_barrier
  ds_write_b128 v4, v[64:67] offset:4096
  ds_write_b128 v4, v[68:71] offset:5120
  ds_write_b128 v4, v[72:75] offset:6144
  ds_write_b128 v4, v[76:79] offset:7168
  s_xor_b32 s36, s13, 2
  s_lshl_b32 s36, s36, 19
  s_add_u32 m0, s39, 24576
  s_add_u32 s37, s36, 0
  buffer_load_dwordx4 v25, s[44:47], s37 offen lds
  s_add_u32 m0, s39, 25600
  s_add_u32 s37, s36, 65536
  buffer_load_dwordx4 v25, s[44:47], s37 offen lds
  s_add_u32 m0, s39, 26624
  s_add_u32 s37, s36, 131072
  buffer_load_dwordx4 v25, s[44:47], s37 offen lds
  s_add_u32 m0, s39, 27648
  s_add_u32 s37, s36, 196608
  buffer_load_dwordx4 v25, s[44:47], s37 offen lds
  s_xor_b32 s36, s13, 2
  s_lshl_b32 s36, s36, 19
  s_add_u32 m0, s39, 20480
  s_add_u32 s37, s36, 262144
  buffer_load_dwordx4 v25, s[44:47], s37 offen lds
  s_add_u32 m0, s39, 21504
  s_add_u32 s37, s36, 327680
  buffer_load_dwordx4 v25, s[44:47], s37 offen lds
  s_add_u32 m0, s39, 22528
  s_add_u32 s37, s36, 393216
  buffer_load_dwordx4 v25, s[44:47], s37 offen lds
  s_add_u32 m0, s39, 23552
  s_add_u32 s37, s36, 458752
  buffer_load_dwordx4 v25, s[44:47], s37 offen lds
  v_mad_u32_u24 v96, v100, 3, v27
  v_mad_u32_u24 v97, v101, 3, v27
  v_mad_u32_u24 v98, v100, 3, v36
  v_mad_u32_u24 v99, v101, 3, v36
  s_waitcnt vmcnt(11)
  s_barrier
  ds_read_b64_tr_b16 v[176:177], v96 offset:16384
  ds_read_b64_tr_b16 v[178:179], v96 offset:16640
  ds_read_b64_tr_b16 v[180:181], v96 offset:18432
  ds_read_b64_tr_b16 v[182:183], v96 offset:18688
  ds_read_b64_tr_b16 v[184:185], v97 offset:16384
  ds_read_b64_tr_b16 v[186:187], v97 offset:16640
  ds_read_b64_tr_b16 v[188:189], v97 offset:18432
  ds_read_b64_tr_b16 v[190:191], v97 offset:18688
  ds_read_b64_tr_b16 v[64:65], v98 offset:16384
  ds_read_b64_tr_b16 v[66:67], v98 offset:16640
  ds_read_b64_tr_b16 v[68:69], v98 offset:18432
  ds_read_b64_tr_b16 v[70:71], v98 offset:18688
  ds_read_b64_tr_b16 v[72:73], v99 offset:16384
  ds_read_b64_tr_b16 v[74:75], v99 offset:16640
  ds_read_b64_tr_b16 v[76:77], v99 offset:18432
  ds_read_b64_tr_b16 v[78:79], v99 offset:18688
  s_waitcnt lgkmcnt(0)
  s_barrier
  ds_write_b128 v4, v[64:67] offset:16384
  ds_write_b128 v4, v[68:71] offset:17408
  ds_write_b128 v4, v[72:75] offset:18432
  ds_write_b128 v4, v[76:79] offset:19456
  s_xor_b32 s36, s13, 0
  s_lshl_b32 s36, s36, 19
  s_add_u32 m0, s39, 8192
  s_add_u32 s37, s36, 0
  buffer_load_dwordx4 v25, s[44:47], s37 offen lds
  s_add_u32 m0, s39, 9216
  s_add_u32 s37, s36, 65536
  buffer_load_dwordx4 v25, s[44:47], s37 offen lds
  s_add_u32 m0, s39, 10240
  s_add_u32 s37, s36, 131072
  buffer_load_dwordx4 v25, s[44:47], s37 offen lds
  s_add_u32 m0, s39, 11264
  s_add_u32 s37, s36, 196608
  buffer_load_dwordx4 v25, s[44:47], s37 offen lds
  s_xor_b32 s36, s13, 0
  s_lshl_b32 s36, s36, 19
  s_add_u32 m0, s39, 12288
  s_add_u32 s37, s36, 262144
  buffer_load_dwordx4 v25, s[44:47], s37 offen lds
  s_add_u32 m0, s39, 13312
  s_add_u32 s37, s36, 327680
  buffer_load_dwordx4 v25, s[44:47], s37 offen lds
  s_add_u32 m0, s39, 14336
  s_add_u32 s37, s36, 393216
  buffer_load_dwordx4 v25, s[44:47], s37 offen lds
  s_add_u32 m0, s39, 15360
  s_add_u32 s37, s36, 458752
  buffer_load_dwordx4 v25, s[44:47], s37 offen lds
  v_mad_u32_u24 v96, v100, 1, v27
  v_mad_u32_u24 v97, v101, 1, v27
  v_mad_u32_u24 v98, v100, 1, v36
  v_mad_u32_u24 v99, v101, 1, v36
  s_waitcnt vmcnt(8)
  s_barrier
  ds_read_b64_tr_b16 v[208:209], v98 offset:20480
  ds_read_b64_tr_b16 v[210:211], v98 offset:20736
  ds_read_b64_tr_b16 v[212:213], v98 offset:22528
  ds_read_b64_tr_b16 v[214:215], v98 offset:22784
  ds_read_b64_tr_b16 v[216:217], v99 offset:20480
  ds_read_b64_tr_b16 v[218:219], v99 offset:20736
  ds_read_b64_tr_b16 v[220:221], v99 offset:22528
  ds_read_b64_tr_b16 v[222:223], v99 offset:22784
  ds_read_b64_tr_b16 v[64:65], v96 offset:20480
  ds_read_b64_tr_b16 v[66:67], v96 offset:20736
  ds_read_b64_tr_b16 v[68:69], v96 offset:22528
  ds_read_b64_tr_b16 v[70:71], v96 offset:22784
  ds_read_b64_tr_b16 v[72:73], v97 offset:20480
  ds_read_b64_tr_b16 v[74:75], v97 offset:20736
  ds_read_b64_tr_b16 v[76:77], v97 offset:22528
  ds_read_b64_tr_b16 v[78:79], v97 offset:22784
  s_waitcnt lgkmcnt(0)
  s_barrier
  ds_write_b128 v4, v[64:67] offset:20480
  ds_write_b128 v4, v[68:71] offset:21504
  ds_write_b128 v4, v[72:75] offset:22528
  ds_write_b128 v4, v[76:79] offset:23552
  s_xor_b32 s36, s13, 2
  s_lshl_b32 s36, s36, 15
  s_add_u32 m0, s39, 24576
  s_add_u32 s37, s36, 512
  buffer_load_dwordx4 v26, s[48:51], s37 offen lds
  s_add_u32 m0, s39, 25600
  s_add_u32 s37, s36, 8704
  buffer_load_dwordx4 v26, s[48:51], s37 offen lds
  s_add_u32 m0, s39, 26624
  s_add_u32 s37, s36, 16896
  buffer_load_dwordx4 v26, s[48:51], s37 offen lds
  s_add_u32 m0, s39, 27648
  s_add_u32 s37, s36, 25088
  buffer_load_dwordx4 v26, s[48:51], s37 offen lds
  s_xor_b32 s36, s13, 3
  s_lshl_b32 s36, s36, 15
  s_add_u32 m0, s39, 28672
  s_add_u32 s37, s36, 512
  buffer_load_dwordx4 v26, s[48:51], s37 offen lds
  s_add_u32 m0, s39, 29696
  s_add_u32 s37, s36, 8704
  buffer_load_dwordx4 v26, s[48:51], s37 offen lds
  s_add_u32 m0, s39, 30720
  s_add_u32 s37, s36, 16896
  buffer_load_dwordx4 v26, s[48:51], s37 offen lds
  s_add_u32 m0, s39, 31744
  s_add_u32 s37, s36, 25088
  buffer_load_dwordx4 v26, s[48:51], s37 offen lds
  s_mov_b32 s19, 0
  s_branch T_arrgo_4
T_arr_3:
  s_add_u32 s19, s19, 1
  s_cmp_gt_u32 s19, 32768
  s_cbranch_scc1 M_exit
  buffer_load_dwordx2 v[54:55], off, s[72:75], 0 sc1
  buffer_load_dword v56, off, s[72:75], 0 offset:128 sc1
  s_waitcnt vmcnt(0)
T_arrgo_4:
  v_sad_u8 v57, v54, 0, 0
  v_sad_u8 v57, v55, 0, v57
  v_or_b32 v58, v54, v55
  v_cmp_gt_u32 vcc, 32, v57
  s_cbranch_vccnz T_arr_3
  v_cmp_gt_u32 vcc, 0x100, v56
  s_cbranch_vccnz T_arr_3
  v_readfirstlane_b32 s36, v58
  s_nop 0
  s_and_b32 s36, s36, 0x20202020
  s_cselect_b32 s56, 0, 1
  s_mov_b32 s14, -1
  s_mov_b32 s30, -1
  s_mov_b32 s19, 0
  s_branch T_kvok_6
T_kv_5:
  s_sleep 4
  s_add_u32 s19, s19, 1
  s_cmp_gt_u32 s19, 32768
  s_cbranch_scc1 M_exit
T_kvok_6:
  s_add_u32 s39, s99, 128
  s_mov_b32 s38, 0
  s_mov_b32 s37, 0
  s_atomic_or s38, s[58:59], s99 glc
  s_atomic_or s37, s[58:59], s39 glc
  s_waitcnt lgkmcnt(0)
  s_lshl_b32 s38, s38, 1
  s_lshl1_add_u32 s37, s37, 1
  s_min_u32 s38, s38, s37
  s_cmp_ge_u32 s38, 64
  s_cselect_b32 s38, 100, s38
  s_sub_u32 s38, s38, 1
  s_max_i32 s30, s30, s38
  s_cmp_ge_i32 s14, s30
  s_cbranch_scc1 T_kv_5
  s_mov_b32 m0, s31
  s_nop 0
  buffer_load_dwordx4 v9, s[4:7], s27 offen sc1 lds
  s_mov_b32 m0, s32
  s_nop 0
  buffer_load_dwordx4 v9, s[4:7], s27 offen offset:128 sc1 lds
  s_mov_b32 m0, s33
  s_nop 0
  buffer_load_dwordx4 v10, s[4:7], s28 offen sc1 lds
  s_mov_b32 m0, s34
  s_nop 0
  buffer_load_dwordx4 v10, s[4:7], s28 offen offset:256 sc1 lds
  s_add_u32 s27, s27, 8192
  s_add_u32 s28, s28, 8192
  s_lshl_b32 s36, s12, 10
  s_add_u32 s36, s36, 145752064
  buffer_load_dwordx4 v[40:43], v2, s[4:7], s36 offen sc1
  v_mad_u32_u24 v96, v101, 1, v27
  v_mad_u32_u24 v97, v100, 1, v27
  v_mad_u32_u24 v98, v101, 1, v36
  v_mad_u32_u24 v99, v100, 1, v36
  s_waitcnt vmcnt(13)
  s_barrier
  ds_read_b64_tr_b16 v[64:65], v96 offset:8192
  ds_read_b64_tr_b16 v[66:67], v96 offset:8448
  ds_read_b64_tr_b16 v[68:69], v96 offset:10240
  ds_read_b64_tr_b16 v[70:71], v96 offset:10496
  ds_read_b64_tr_b16 v[72:73], v97 offset:8192
  ds_read_b64_tr_b16 v[74:75], v97 offset:8448
  ds_read_b64_tr_b16 v[76:77], v97 offset:10240
  ds_read_b64_tr_b16 v[78:79], v97 offset:10496
  ds_read_b64_tr_b16 v[80:81], v98 offset:8192
  ds_read_b64_tr_b16 v[82:83], v98 offset:8448
  ds_read_b64_tr_b16 v[84:85], v98 offset:10240
  ds_read_b64_tr_b16 v[86:87], v98 offset:10496
  ds_read_b64_tr_b16 v[88:89], v99 offset:8192
  ds_read_b64_tr_b16 v[90:91], v99 offset:8448
  ds_read_b64_tr_b16 v[92:93], v99 offset:10240
  ds_read_b64_tr_b16 v[94:95], v99 offset:10496
  s_waitcnt lgkmcnt(0)
  s_barrier
  ds_write_b128 v4, v[64:67] offset:8192
  ds_write_b128 v4, v[68:71] offset:9216
  ds_write_b128 v4, v[72:75] offset:10240
  ds_write_b128 v4, v[76:79] offset:11264
  ds_write_b128 v4, v[80:83] offset:12288
  ds_write_b128 v4, v[84:87] offset:13312
  ds_write_b128 v4, v[88:91] offset:14336
  ds_write_b128 v4, v[92:95] offset:15360
  s_waitcnt vmcnt(9)
  ds_read_b64_tr_b16 v[64:65], v28 offset:24576
  ds_read_b64_tr_b16 v[66:67], v28 offset:24832
  ds_read_b64_tr_b16 v[68:69], v28 offset:25600
  ds_read_b64_tr_b16 v[70:71], v28 offset:25856
  ds_read_b64_tr_b16 v[72:73], v28 offset:24584
  ds_read_b64_tr_b16 v[74:75], v28 offset:24840
  ds_read_b64_tr_b16 v[76:77], v28 offset:25608
  ds_read_b64_tr_b16 v[78:79], v28 offset:25864
  s_waitcnt lgkmcnt(0)
  ds_write_b128 v4, v[64:67] offset:24576
  ds_write_b128 v4, v[68:71] offset:25600
  ds_write_b128 v4, v[72:75] offset:26624
  ds_write_b128 v4, v[76:79] offset:27648
  s_waitcnt lgkmcnt(0)
  s_waitcnt vmcnt(5)
  ds_read_b64_tr_b16 v[64:65], v28 offset:28672
  ds_read_b64_tr_b16 v[66:67], v28 offset:28928
  ds_read_b64_tr_b16 v[68:69], v28 offset:29696
  ds_read_b64_tr_b16 v[70:71], v28 offset:29952
  ds_read_b64_tr_b16 v[72:73], v28 offset:28680
  ds_read_b64_tr_b16 v[74:75], v28 offset:28936
  ds_read_b64_tr_b16 v[76:77], v28 offset:29704
  ds_read_b64_tr_b16 v[78:79], v28 offset:29960
  s_waitcnt lgkmcnt(0)
  ds_write_b128 v4, v[64:67] offset:28672
  ds_write_b128 v4, v[68:71] offset:29696
  ds_write_b128 v4, v[72:75] offset:30720
  ds_write_b128 v4, v[76:79] offset:31744
  s_waitcnt lgkmcnt(0)
  s_mov_b32 s14, 1
  s_cmp_lt_i32 s14, s30
  s_cbranch_scc1 T_kv2_7
  s_mov_b32 s19, 0
  s_branch T_kvok_9
T_kv_8:
  s_sleep 4
  s_add_u32 s19, s19, 1
  s_cmp_gt_u32 s19, 32768
  s_cbranch_scc1 M_exit
T_kvok_9:
  s_add_u32 s39, s99, 128
  s_mov_b32 s38, 0
  s_mov_b32 s37, 0
  s_atomic_or s38, s[58:59], s99 glc
  s_atomic_or s37, s[58:59], s39 glc
  s_waitcnt lgkmcnt(0)
  s_lshl_b32 s38, s38, 1
  s_lshl1_add_u32 s37, s37, 1
  s_min_u32 s38, s38, s37
  s_cmp_ge_u32 s38, 64
  s_cselect_b32 s38, 100, s38
  s_sub_u32 s38, s38, 1
  s_max_i32 s30, s30, s38
  s_cmp_ge_i32 s14, s30
  s_cbranch_scc1 T_kv_8
T_kv2_7:
  s_waitcnt vmcnt(0) lgkmcnt(0)
  s_barrier
  s_cmp_ge_u32 s13, 2
  s_cselect_b64 vcc, -1, 0
  v_cndmask_b32 v3, v8, v19, vcc
  ds_read_b128 v[68:71], v4 offset:0
  ds_read_b128 v[72:75], v4 offset:1024
  ds_read_b128 v[76:79], v4 offset:4096
  ds_read_b128 v[80:83], v4 offset:5120
  ds_read_b128 v[84:87], v4 offset:8192
  ds_read_b128 v[88:91], v4 offset:9216
  ds_read_b128 v[92:95], v4 offset:2048
  ds_read_b128 v[96:99], v4 offset:3072
  ds_read_b128 v[100:103], v4 offset:6144
  ds_read_b128 v[104:107], v4 offset:7168
  ds_read_b128 v[108:111], v4 offset:10240
  ds_read_b128 v[112:115], v4 offset:11264
  ds_read_b128 v[28:31], v59 offset:16384
  ds_read_b128 v[32:35], v59 offset:20480
  ds_read_b128 v[36:39], v2 offset:8192
  ds_read_b128 v[40:43], v2 offset:9216
  ds_read_b128 v[44:47], v2 offset:10240
  ds_read_b128 v[48:51], v2 offset:11264
  ds_read_b128 v[52:55], v2 offset:12288
  ds_read_b128 v[56:59], v2 offset:13312
  ds_read_b128 v[60:63], v2 offset:14336
  ds_read_b128 v[64:67], v2 offset:15360
  s_and_b32 s36, s13, 1
  s_lshl_b32 s36, s36, 12
  s_add_u32 s22, s22, s36
  s_add_u32 s23, s36, 145752064
  s_mov_b32 s14, -1
  s_and_b32 s57, s14, 1
  s_and_b32 s36, s14, 3
  s_lshl_b32 s36, s36, 13
  s_add_u32 s26, s36, s23
  s_add_u32 s36, s36, 8192
  s_and_b32 s36, s36, 0x7fff
  s_add_u32 s24, s36, 145752064
  s_add_u32 s25, s36, 145756160
  s_add_u32 s35, s36, s23
  s_waitcnt lgkmcnt(0)
  s_cmp_lg_u32 s56, 0
  s_cbranch_scc1 M_global
T_code:
  s_cmp_eq_u32 s13, 1
  s_cbranch_scc1 T_w_11
  s_cmp_eq_u32 s13, 2
  s_cbranch_scc1 T_w_12
  s_cmp_eq_u32 s13, 3
  s_cbranch_scc1 T_w_13
T_w_10:
  s_mov_b32 s19, 0
  s_add_u32 s14, s14, 1
  v_mov_b64 v[16:17], 0
  v_mov_b64 v[18:19], 0
  v_mov_b64 v[20:21], 0
  v_mov_b64 v[22:23], 0
  v_mov_b64 v[24:25], 0
  v_mov_b64 v[26:27], 0
  buffer_load_dwordx4 v[124:127], v2, s[4:7], s24 offen offset:0 sc1
  buffer_load_dwordx4 v[116:119], v2, s[4:7], s25 offen offset:0 sc1
  buffer_load_dwordx4 v[124:127], v2, s[4:7], s24 offen offset:0 sc1
  buffer_load_dwordx4 v[116:119], v2, s[4:7], s25 offen offset:0 sc1
  s_branch T_loop_14
.p2align 6
T_retry_15:
  s_mov_b64 exec, vcc
  buffer_load_dwordx4 v[124:127], v2, s[4:7], s24 offen offset:0 sc1
  buffer_load_dwordx4 v[116:119], v2, s[4:7], s25 offen offset:0 sc1
  s_mov_b64 exec, -1
  s_add_u32 s19, s19, 1
  s_cmp_gt_u32 s19, 32768
  s_cbranch_scc1 M_exit
  s_nop 0
  v_mov_b64 v[16:17], 0
  v_mov_b64 v[18:19], 0
T_loop_14:
  s_waitcnt vmcnt(3) lgkmcnt(0)
  v_max3_u32 v123, v124, v125, v126
  v_max_u32 v123, v123, v127
  v_mov_b32_dpp v120, v124 row_ror:8 row_mask:0xf bank_mask:0xf
  v_mov_b32_dpp v121, v125 row_ror:8 row_mask:0xf bank_mask:0xf
  s_waitcnt vmcnt(2)
  v_max3_u32 v123, v123, v116, v117
  v_max3_u32 v123, v123, v118, v119
  v_cmp_eq_u32 vcc, -1, v123
  v_smfmac_f32_16x16x64_bf16 v[16:19], v[124:127], v[68:75], v0
  s_cbranch_vccnz T_retry_15
  ds_write_b128 v2, v[124:127] offset:0
  v_mov_b32_dpp v122, v126 row_ror:8 row_mask:0xf bank_mask:0xf
  v_smfmac_f32_16x16x64_bf16 v[20:23], v[124:127], v[76:83], v0
  s_and_b32 s57, s14, 1
  v_mov_b32_dpp v123, v127 row_ror:8 row_mask:0xf bank_mask:0xf
  v_smfmac_f32_16x16x64_bf16 v[24:27], v[124:127], v[84:91], v0
  s_and_b32 s36, s14, 3
  ds_write_b128 v2, v[116:119] offset:4096
  v_smfmac_f32_16x16x64_bf16 v[16:19], v[120:123], v[92:99], v0
  s_lshl_b32 s36, s36, 13
  v_mov_b32_dpp v84, v116 row_ror:8 row_mask:0xf bank_mask:0xf
  v_smfmac_f32_16x16x64_bf16 v[20:23], v[120:123], v[100:107], v0
  s_add_u32 s26, s36, s23
  ds_read_b128 v[68:71], v4 offset:12288
  v_mov_b32_dpp v85, v117 row_ror:8 row_mask:0xf bank_mask:0xf
  v_smfmac_f32_16x16x64_bf16 v[24:27], v[120:123], v[108:115], v0
  s_add_u32 s36, s36, 8192
  ds_read_b128 v[72:75], v4 offset:13312
  v_mov_b32_dpp v86, v118 row_ror:8 row_mask:0xf bank_mask:0xf
  v_smfmac_f32_16x16x64_bf16 v[16:19], v[116:119], v[224:231], v0
  s_and_b32 s36, s36, 0x7fff
  ds_read_b128 v[76:79], v4 offset:14336
  v_mov_b32_dpp v87, v119 row_ror:8 row_mask:0xf bank_mask:0xf
  v_smfmac_f32_16x16x64_bf16 v[20:23], v[116:119], v[240:247], v0
  s_waitcnt lgkmcnt(3)
  s_barrier
  ds_read_b128 v[100:103], v2 offset:1024
  v_smfmac_f32_16x16x64_bf16 v[24:27], v[116:119], a[0:7], v0
  s_mov_b32 m0, s31
  ds_read_b128 v[120:123], v1 offset:1024
  v_smfmac_f32_16x16x64_bf16 v[16:19], v[84:87], v[232:239], v0
  v_smfmac_f32_16x16x64_bf16 v[20:23], v[84:87], v[248:255], v0
  ds_read_b128 v[80:83], v4 offset:15360
  buffer_load_dwordx4 v9, s[4:7], s27 offen sc1 lds
  v_smfmac_f32_16x16x64_bf16 v[24:27], v[84:87], a[8:15], v0
  s_waitcnt lgkmcnt(2)
  s_mov_b32 m0, s32
  v_smfmac_f32_16x16x64_bf16 v[16:19], v[100:103], v[128:135], v0
  ds_read_b128 v[92:95], v2 offset:2048
  v_smfmac_f32_16x16x64_bf16 v[20:23], v[100:103], v[144:151], v0
  ds_read_b128 v[96:99], v1 offset:2048
  v_smfmac_f32_16x16x64_bf16 v[24:27], v[100:103], v[68:75], v0
  s_waitcnt vmcnt(1) lgkmcnt(3)
  ds_read_b128 v[116:119], v2 offset:3072
  buffer_load_dwordx4 v9, s[4:7], s27 offen offset:128 sc1 lds
  v_smfmac_f32_16x16x64_bf16 v[16:19], v[120:123], v[136:143], v0
  ds_read_b128 v[124:127], v1 offset:3072
  s_mov_b32 m0, s33
  v_smfmac_f32_16x16x64_bf16 v[20:23], v[120:123], v[152:159], v0
  s_waitcnt lgkmcnt(4)
  ds_read_b128 v[104:107], v2 offset:5120
  v_smfmac_f32_16x16x64_bf16 v[24:27], v[120:123], v[76:83], v0
  s_waitcnt lgkmcnt(4)
  ds_read_b128 v[108:111], v1 offset:5120
  v_smfmac_f32_16x16x64_bf16 v[16:19], v[92:95], v[160:167], v0
  s_waitcnt lgkmcnt(4)
  ds_read_b128 v[112:115], v2 offset:6144
  buffer_load_dwordx4 v10, s[4:7], s28 offen sc1 lds
  v_smfmac_f32_16x16x64_bf16 v[16:19], v[96:99], v[168:175], v0
  s_waitcnt lgkmcnt(4)
  ds_read_b128 v[84:87], v1 offset:6144
  s_mov_b32 m0, s34
  v_smfmac_f32_16x16x64_bf16 v[16:19], v[116:119], v[192:199], v0
  s_waitcnt lgkmcnt(4)
  ds_read_b128 v[88:91], v2 offset:7168
  v_smfmac_f32_16x16x64_bf16 v[16:19], v[124:127], v[200:207], v0
  s_waitcnt lgkmcnt(4)
  ds_read_b128 v[100:103], v1 offset:7168
  v_smfmac_f32_16x16x64_bf16 v[16:19], v[104:107], a[16:23], v0
  s_waitcnt lgkmcnt(4)
  ds_read_b128 v[68:71], v4 offset:16384
  buffer_load_dwordx4 v10, s[4:7], s28 offen offset:256 sc1 lds
  v_smfmac_f32_16x16x64_bf16 v[16:19], v[108:111], a[24:31], v0
  s_waitcnt lgkmcnt(4)
  ds_read_b128 v[72:75], v4 offset:17408
  v_smfmac_f32_16x16x64_bf16 v[16:19], v[112:115], a[64:71], v0
  s_waitcnt lgkmcnt(4)
  ds_read_b128 v[76:79], v4 offset:18432
  v_smfmac_f32_16x16x64_bf16 v[16:19], v[84:87], a[72:79], v0
  s_waitcnt lgkmcnt(4)
  ds_read_b128 v[80:83], v4 offset:19456
  v_smfmac_f32_16x16x64_bf16 v[16:19], v[88:91], a[112:119], v0
  s_waitcnt lgkmcnt(4)
  v_smfmac_f32_16x16x64_bf16 v[16:19], v[100:103], a[120:127], v0
  s_add_u32 s24, s36, 145752064
  s_add_u32 s25, s36, 145756160
  v_smfmac_f32_16x16x64_bf16 v[20:23], v[92:95], v[176:183], v0
  s_add_u32 s35, s36, s23
  v_smfmac_f32_16x16x64_bf16 v[20:23], v[96:99], v[184:191], v0
  s_waitcnt lgkmcnt(2)
  v_smfmac_f32_16x16x64_bf16 v[20:23], v[116:119], v[68:75], v0
  s_waitcnt lgkmcnt(0)
  ds_read_b128 v[68:71], v4 offset:20480
  v_mul_f32 v16, s18, v16
  v_smfmac_f32_16x16x64_bf16 v[20:23], v[124:127], v[76:83], v0
  ds_read_b128 v[72:75], v4 offset:21504
  v_mul_f32 v17, s18, v17
  v_smfmac_f32_16x16x64_bf16 v[20:23], v[104:107], a[32:39], v0
  ds_read_b128 v[76:79], v4 offset:22528
  v_mul_f32 v18, s18, v18
  v_smfmac_f32_16x16x64_bf16 v[20:23], v[108:111], a[40:47], v0
  ds_read_b128 v[80:83], v4 offset:23552
  v_mul_f32 v19, s18, v19
  v_smfmac_f32_16x16x64_bf16 v[20:23], v[112:115], a[80:87], v0
  v_cvt_pk_bf16_f32 v120, v16, v17
  v_smfmac_f32_16x16x64_bf16 v[20:23], v[84:87], a[88:95], v0
  v_cvt_pk_bf16_f32 v121, v18, v19
  v_smfmac_f32_16x16x64_bf16 v[20:23], v[88:91], a[128:135], v0
  ds_write_b64 v5, v[120:121] offset:24576
  v_smfmac_f32_16x16x64_bf16 v[20:23], v[100:103], a[136:143], v0
  s_waitcnt lgkmcnt(3)
  v_smfmac_f32_16x16x64_bf16 v[24:27], v[92:95], v[68:75], v0
  s_waitcnt lgkmcnt(1)
  v_mov_b64 v[92:93], 0
  v_smfmac_f32_16x16x64_bf16 v[24:27], v[96:99], v[76:83], v0
  s_nop 1
  v_cvt_pk_bf16_f32 v122, v20, v21
  v_cvt_pk_bf16_f32 v123, v22, v23
  v_smfmac_f32_16x16x64_bf16 v[24:27], v[116:119], v[208:215], v0
  ds_write_b64 v5, v[122:123] offset:26880
  v_mov_b64 v[94:95], 0
  v_smfmac_f32_16x16x64_bf16 v[24:27], v[124:127], v[216:223], v0
  s_waitcnt lgkmcnt(1)
  s_barrier
  ds_read_b64_tr_b16 v[68:69], v6 offset:24576
  v_smfmac_f32_16x16x64_bf16 v[24:27], v[104:107], a[48:55], v0
  s_add_u32 s27, s27, 8192
  ds_read_b64_tr_b16 v[70:71], v6 offset:24640
  ds_read_b64_tr_b16 v[72:73], v6 offset:24832
  v_smfmac_f32_16x16x64_bf16 v[24:27], v[108:111], a[56:63], v0
  s_add_u32 s28, s28, 8192
  ds_read_b64_tr_b16 v[74:75], v6 offset:24896
  ds_read_b64_tr_b16 v[76:77], v6 offset:25088
  v_smfmac_f32_16x16x64_bf16 v[24:27], v[112:115], a[96:103], v0
  s_nop 0
  ds_read_b64_tr_b16 v[78:79], v6 offset:25152
  ds_read_b64_tr_b16 v[80:81], v6 offset:25344
  v_smfmac_f32_16x16x64_bf16 v[24:27], v[84:87], a[104:111], v0
  ds_read_b64_tr_b16 v[82:83], v6 offset:25408
  v_mov_b64 v[96:97], 0
  v_smfmac_f32_16x16x64_bf16 v[24:27], v[88:91], a[144:151], v0
  s_waitcnt lgkmcnt(8)
  s_barrier
  ds_read_b64_tr_b16 v[116:117], v6 offset:26880
  v_smfmac_f32_16x16x64_bf16 v[24:27], v[100:103], a[152:159], v0
  s_waitcnt lgkmcnt(7)
  ds_read_b64_tr_b16 v[118:119], v6 offset:26944
  v_mfma_f32_16x16x32_bf16 v[16:19], v[36:39], v[68:71], 0
  s_waitcnt lgkmcnt(6)
  ds_read_b64_tr_b16 v[124:125], v6 offset:27136
  ds_read_b64_tr_b16 v[126:127], v6 offset:27200
  v_mfma_f32_16x16x32_bf16 v[16:19], v[40:43], v[72:75], v[16:19]
  s_waitcnt lgkmcnt(6)
  ds_read_b64_tr_b16 v[104:105], v6 offset:27392
  ds_read_b64_tr_b16 v[106:107], v6 offset:27456
  v_mfma_f32_16x16x32_bf16 v[16:19], v[44:47], v[76:79], v[16:19]
  s_waitcnt lgkmcnt(6)
  ds_read_b64_tr_b16 v[108:109], v6 offset:27648
  ds_read_b64_tr_b16 v[110:111], v6 offset:27712
  v_mfma_f32_16x16x32_bf16 v[16:19], v[48:51], v[80:83], v[16:19]
  s_waitcnt lgkmcnt(6)
  v_cvt_pk_bf16_f32 v120, v24, v25
  v_cvt_pk_bf16_f32 v121, v26, v27
  v_mfma_f32_16x16x32_bf16 v[112:115], v[116:119], v[68:71], 0
  s_waitcnt lgkmcnt(4)
  buffer_store_dwordx4 v[120:123], v2, s[4:7], s29 offen offset:0 sc1
  v_mov_b64 v[98:99], 0
  v_mfma_f32_16x16x32_bf16 v[112:115], v[124:127], v[72:75], v[112:115]
  s_waitcnt lgkmcnt(2)
  v_mov_b64 v[36:37], 0
  v_exp_f32 v100, v16
  v_mfma_f32_16x16x32_bf16 v[112:115], v[104:107], v[76:79], v[112:115]
  s_waitcnt lgkmcnt(0)
  v_exp_f32 v101, v17
  v_mfma_f32_16x16x32_bf16 v[112:115], v[108:111], v[80:83], v[112:115]
  v_exp_f32 v102, v18
  v_mfma_f32_16x16x32_bf16 v[20:23], v[52:55], v[68:71], 0
  v_exp_f32 v103, v19
  v_mfma_f32_16x16x32_bf16 v[20:23], v[56:59], v[72:75], v[20:23]
  v_cvt_pk_bf16_f32 v44, v100, v101
  v_cvt_pk_bf16_f32 v45, v102, v103
  v_mfma_f32_16x16x32_bf16 v[20:23], v[60:63], v[76:79], v[20:23]
  s_add_u32 s29, s29, 131072
  v_exp_f32 v100, v112
  v_mfma_f32_16x16x32_bf16 v[20:23], v[64:67], v[80:83], v[20:23]
  v_exp_f32 v101, v113
  v_exp_f32 v102, v114
  v_exp_f32 v103, v115
  v_cvt_pk_bf16_f32 v84, v100, v101
  v_cvt_pk_bf16_f32 v85, v102, v103
  v_cndmask_b32 v48, v84, 0, s[16:17]
  v_cndmask_b32 v49, v85, 0, s[16:17]
  v_cndmask_b32 v50, 0, v84, s[16:17]
  v_cndmask_b32 v51, 0, v85, s[16:17]
  v_exp_f32 v100, v20
  v_mfma_f32_16x16x16_bf16 v[88:91], v[12:13], v[48:49], 0
  v_exp_f32 v101, v21
  v_mfma_f32_16x16x16_bf16 v[24:27], v[120:121], v[48:49], 0
  v_exp_f32 v102, v22
  v_mfma_f32_16x16x16_bf16 v[116:119], v[120:121], v[50:51], 0
  v_exp_f32 v103, v23
  v_cvt_pk_bf16_f32 v46, v100, v101
  v_cvt_pk_bf16_f32 v47, v102, v103
  v_mov_b64 v[38:39], 0
  s_nop 0
  v_mfma_f32_16x16x32_bf16 v[88:91], v[12:15], v[44:47], v[88:91]
  v_mov_b64 v[40:41], 0
  v_mov_b64 v[42:43], 0
  v_mfma_f32_16x16x32_bf16 v[24:27], v[28:31], v[44:47], v[24:27]
  ds_read_b128 v[52:55], v4 offset:24576
  ds_read_b128 v[56:59], v4 offset:25600
  v_mfma_f32_16x16x32_bf16 v[116:119], v[32:35], v[44:47], v[116:119]
  s_nop 1
T_back_22:
  v_rcp_f32 v89, v88
  v_subrev_u32 v100, s54, v88
  v_cmp_le_u32 vcc, s96, v100
  v_mul_f32 v24, v89, v24
  v_mul_f32 v25, v89, v25
  v_cvt_pk_bf16_f32 v124, v24, v25
  v_pk_mul_f32 v[26:27], v[26:27], v[88:89] op_sel:[0,1] op_sel_hi:[1,1]
  v_cvt_pk_bf16_f32 v125, v26, v27
  ds_write_b64 v11, v[124:125] offset:29184
  v_pk_mul_f32 v[116:117], v[116:117], v[88:89] op_sel:[0,1] op_sel_hi:[1,1]
  v_pk_mul_f32 v[118:119], v[118:119], v[88:89] op_sel:[0,1] op_sel_hi:[1,1]
  v_cvt_pk_bf16_f32 v126, v116, v117
  v_cvt_pk_bf16_f32 v127, v118, v119
  ds_write_b64 v11, v[126:127] offset:29192
  s_cbranch_vccnz T_slow_21
  v_smfmac_f32_16x16x64_bf16 v[92:95], v[124:127], a[160:167], v0
  s_mov_b32 s96, s55
  v_smfmac_f32_16x16x64_bf16 v[96:99], v[124:127], a[168:175], v0
  s_cmp_eq_u32 s14, 63
  v_smfmac_f32_16x16x64_bf16 v[36:39], v[124:127], a[176:183], v0
  s_waitcnt lgkmcnt(0)
  s_barrier
  ds_read_b128 v[104:107], v11 offset:29696
  ds_read_b128 v[108:111], v11 offset:30208
  ds_read_b128 v[68:71], v11 offset:30720
  s_cbranch_scc1 M_tdone
  v_smfmac_f32_16x16x64_bf16 v[40:43], v[124:127], a[184:191], v0
  s_waitcnt lgkmcnt(2)
  v_smfmac_f32_16x16x64_bf16 v[92:95], v[104:107], a[192:199], v0
  s_waitcnt lgkmcnt(1)
  ds_read_b128 v[76:79], v4 offset:28672
  v_smfmac_f32_16x16x64_bf16 v[92:95], v[108:111], a[224:231], v0
  s_waitcnt lgkmcnt(1)
  ds_read_b128 v[80:83], v4 offset:29696
  v_smfmac_f32_16x16x64_bf16 v[92:95], v[68:71], a[240:247], v0
  ds_read_b128 v[60:63], v4 offset:26624
  v_smfmac_f32_16x16x64_bf16 v[96:99], v[104:107], a[200:207], v0
  ds_read_b128 v[64:67], v4 offset:27648
  v_smfmac_f32_16x16x64_bf16 v[96:99], v[108:111], a[232:239], v0
  ds_read_b128 v[28:31], v4 offset:30720
  s_nop 0
  v_cvt_pk_bf16_f32 v16, v92, v93
  v_cvt_pk_bf16_f32 v17, v94, v95
  v_bfi_b32 v16, 1, s57, v16
  v_smfmac_f32_16x16x64_bf16 v[96:99], v[68:71], a[248:255], v0
  buffer_store_dwordx2 v[16:17], v7, s[4:7], s20 offen offset:0
  v_smfmac_f32_16x16x64_bf16 v[36:39], v[104:107], a[208:215], v0
  ds_read_b128 v[32:35], v4 offset:31744
  v_smfmac_f32_16x16x64_bf16 v[36:39], v[108:111], v[52:59], v0
  s_waitcnt lgkmcnt(4)
  s_nop 0
  v_cvt_pk_bf16_f32 v18, v96, v97
  v_cvt_pk_bf16_f32 v19, v98, v99
  v_bfi_b32 v18, 1, s57, v18
  v_smfmac_f32_16x16x64_bf16 v[36:39], v[68:71], v[76:83], v0
  buffer_store_dwordx2 v[18:19], v7, s[4:7], s20 offen offset:64
  v_smfmac_f32_16x16x64_bf16 v[40:43], v[104:107], a[216:223], v0
  s_waitcnt lgkmcnt(2)
  ds_read_b128 v[116:119], v2 offset:31232
  v_smfmac_f32_16x16x64_bf16 v[40:43], v[108:111], v[60:67], v0
  s_waitcnt lgkmcnt(1)
  s_nop 0
  v_cvt_pk_bf16_f32 v20, v36, v37
  v_cvt_pk_bf16_f32 v21, v38, v39
  v_bfi_b32 v20, 1, s57, v20
  v_smfmac_f32_16x16x64_bf16 v[40:43], v[68:71], v[28:35], v0
  buffer_store_dwordx2 v[20:21], v7, s[4:7], s21 offen offset:0
  s_nop 6
  v_cvt_pk_bf16_f32 v22, v40, v41
  v_cvt_pk_bf16_f32 v23, v42, v43
  v_bfi_b32 v22, 1, s57, v22
  buffer_store_dwordx2 v[22:23], v7, s[4:7], s21 offen offset:64
  ds_read_b128 v[68:71], v4 offset:0
  ds_read_b128 v[72:75], v4 offset:1024
  ds_read_b128 v[76:79], v4 offset:4096
  ds_read_b128 v[80:83], v4 offset:5120
  ds_read_b128 v[84:87], v4 offset:8192
  ds_read_b128 v[88:91], v4 offset:9216
  v_mov_b64 v[16:17], 0
  v_mov_b64 v[18:19], 0
  v_mov_b64 v[20:21], 0
  v_mov_b64 v[22:23], 0
  v_mov_b64 v[24:25], 0
  v_mov_b64 v[26:27], 0
  s_mov_b32 s19, 0
  v_mov_b32 v49, -1
  s_waitcnt vmcnt(2)
  buffer_load_dwordx4 v[52:55], v2, s[4:7], s22 offen offset:0 sc1
  buffer_load_dwordx4 v[56:59], v2, s[4:7], s22 offen offset:1024 sc1
  buffer_load_dwordx4 v[60:63], v2, s[4:7], s22 offen offset:2048 sc1
  buffer_load_dwordx4 v[64:67], v2, s[4:7], s22 offen offset:3072 sc1
  ds_read_b128 v[92:95], v4 offset:2048
  ds_read_b128 v[96:99], v4 offset:3072
  ds_read_b128 v[100:103], v4 offset:6144
  ds_read_b128 v[104:107], v4 offset:7168
  ds_read_b128 v[108:111], v4 offset:10240
  ds_read_b128 v[112:115], v4 offset:11264
  ds_read_b64 v[44:45], v2 offset:32256
  s_waitcnt lgkmcnt(0)
  v_readfirstlane_b32 s38, v44
  v_readfirstlane_b32 s37, v45
  s_nop 0
  s_lshl_b32 s38, s38, 1
  s_lshl1_add_u32 s37, s37, 1
  s_min_u32 s38, s38, s37
  s_cmp_ge_u32 s38, 64
  s_cselect_b32 s38, 100, s38
  s_sub_u32 s38, s38, 1
  s_max_i32 s30, s30, s38
  s_waitcnt lgkmcnt(12)
  s_waitcnt vmcnt(3)
  v_mfma_f32_16x16x32_bf16 v[120:123], v[116:119], v[52:55], 0
  v_xor_b32 v48, s57, v52
  v_bitop3_b32 v48, v48, v54, s57 bitop3:0xf6
  s_waitcnt vmcnt(2)
  v_mfma_f32_16x16x32_bf16 v[120:123], v[116:119], v[56:59], v[120:123]
  v_bitop3_b32 v48, v48, v56, s57 bitop3:0xf6
  v_bitop3_b32 v48, v48, v58, s57 bitop3:0xf6
  s_waitcnt vmcnt(1)
  v_mfma_f32_16x16x32_bf16 v[120:123], v[116:119], v[60:63], v[120:123]
  v_bitop3_b32 v48, v48, v60, s57 bitop3:0xf6
  v_bitop3_b32 v48, v48, v62, s57 bitop3:0xf6
  s_waitcnt vmcnt(0)
  v_mfma_f32_16x16x32_bf16 v[120:123], v[116:119], v[64:67], v[120:123]
  v_bitop3_b32 v48, v48, v64, s57 bitop3:0xf6
  v_bitop3_b32 v48, v48, v66, s57 bitop3:0xf6
  v_and_b32 v48, 1, v48
  v_cmp_ne_u32 vcc, 0, v48
  s_cbranch_vccnz T_p1re_24
T_p1ok_25:
  s_nop 2
  v_add_f32_dpp v120, v120, v120 row_ror:8 row_mask:0xf bank_mask:0xf
  v_add_f32_dpp v121, v121, v121 row_ror:8 row_mask:0xf bank_mask:0xf
  v_cvt_pk_bf16_f32 v48, v120, v121
  buffer_store_dword v48, v8, s[4:7], s35 offen
  buffer_store_dword v49, v8, s[4:7], s26 offen
  s_barrier
  ds_read_b128 v[28:31], v2 offset:16384
  ds_read_b128 v[32:35], v2 offset:20480
  ds_read_b128 v[36:39], v2 offset:8192
  ds_read_b128 v[40:43], v2 offset:9216
  ds_read_b128 v[44:47], v2 offset:10240
  ds_read_b128 v[48:51], v2 offset:11264
  buffer_load_dwordx4 v[124:127], v2, s[4:7], s24 offen offset:0 sc1
  buffer_load_dwordx4 v[116:119], v2, s[4:7], s25 offen offset:0 sc1
  ds_read_b128 v[52:55], v2 offset:12288
  ds_read_b128 v[56:59], v2 offset:13312
  ds_read_b128 v[60:63], v2 offset:14336
  ds_read_b128 v[64:67], v2 offset:15360
  buffer_load_dwordx4 v[124:127], v2, s[4:7], s24 offen offset:0 sc1
  buffer_load_dwordx4 v[116:119], v2, s[4:7], s25 offen offset:0 sc1
  s_add_u32 s14, s14, 1
  s_cmp_ge_i32 s14, s30
  s_cbranch_scc1 T_kvw_18
T_kvb_19:
  s_mov_b32 s19, 0
  s_branch T_loop_14
T_p1re_24:
  s_mov_b64 exec, vcc
  buffer_load_dwordx4 v[52:55], v2, s[4:7], s22 offen offset:0 sc1
  buffer_load_dwordx4 v[56:59], v2, s[4:7], s22 offen offset:1024 sc1
  buffer_load_dwordx4 v[60:63], v2, s[4:7], s22 offen offset:2048 sc1
  buffer_load_dwordx4 v[64:67], v2, s[4:7], s22 offen offset:3072 sc1
  s_mov_b64 exec, -1
  s_add_u32 s19, s19, 1
  s_cmp_gt_u32 s19, 32768
  s_cbranch_scc1 M_exit
  s_waitcnt vmcnt(3)
  v_mfma_f32_16x16x32_bf16 v[120:123], v[116:119], v[52:55], 0
  v_xor_b32 v48, s57, v52
  v_bitop3_b32 v48, v48, v54, s57 bitop3:0xf6
  s_waitcnt vmcnt(2)
  v_mfma_f32_16x16x32_bf16 v[120:123], v[116:119], v[56:59], v[120:123]
  v_bitop3_b32 v48, v48, v56, s57 bitop3:0xf6
  v_bitop3_b32 v48, v48, v58, s57 bitop3:0xf6
  s_waitcnt vmcnt(1)
  v_mfma_f32_16x16x32_bf16 v[120:123], v[116:119], v[60:63], v[120:123]
  v_bitop3_b32 v48, v48, v60, s57 bitop3:0xf6
  v_bitop3_b32 v48, v48, v62, s57 bitop3:0xf6
  s_waitcnt vmcnt(0)
  v_mfma_f32_16x16x32_bf16 v[120:123], v[116:119], v[64:67], v[120:123]
  v_bitop3_b32 v48, v48, v64, s57 bitop3:0xf6
  v_bitop3_b32 v48, v48, v66, s57 bitop3:0xf6
  v_and_b32 v48, 1, v48
  v_cmp_ne_u32 vcc, 0, v48
  s_cbranch_vccnz T_p1re_24
  s_branch T_p1ok_25
T_kvw_18:
  s_mov_b32 s19, 0
  s_branch T_kvok_27
T_kv_26:
  s_sleep 4
  s_add_u32 s19, s19, 1
  s_cmp_gt_u32 s19, 32768
  s_cbranch_scc1 M_exit
T_kvok_27:
  s_add_u32 s39, s99, 128
  s_mov_b32 s38, 0
  s_mov_b32 s37, 0
  s_atomic_or s38, s[58:59], s99 glc
  s_atomic_or s37, s[58:59], s39 glc
  s_waitcnt lgkmcnt(0)
  s_lshl_b32 s38, s38, 1
  s_lshl1_add_u32 s37, s37, 1
  s_min_u32 s38, s38, s37
  s_cmp_ge_u32 s38, 64
  s_cselect_b32 s38, 100, s38
  s_sub_u32 s38, s38, 1
  s_max_i32 s30, s30, s38
  s_cmp_ge_i32 s14, s30
  s_cbranch_scc1 T_kv_26
  s_branch T_kvb_19
T_slow_21:
  s_nop 7
  v_max3_f32 v100, v16, v17, v18
  v_max3_f32 v100, v100, v19, v20
  v_max3_f32 v100, v100, v21, v22
  v_max3_f32 v100, v100, v23, v112
  v_max3_f32 v100, v100, v113, v114
  v_max_f32 v100, v100, v115
  v_mov_b32 v101, v100
  s_nop 1
  v_permlane32_swap_b32 v100, v101
  s_nop 1
  v_max_f32 v100, v100, v101
  v_mov_b32 v101, v100
  s_nop 1
  v_permlane16_swap_b32 v100, v101
  s_nop 1
  v_max_f32 v100, v100, v101
  v_sub_f32 v16, v16, v100
  v_sub_f32 v17, v17, v100
  v_sub_f32 v18, v18, v100
  v_sub_f32 v19, v19, v100
  v_exp_f32 v16, v16
  v_exp_f32 v17, v17
  v_exp_f32 v18, v18
  v_exp_f32 v19, v19
  v_sub_f32 v20, v20, v100
  v_sub_f32 v21, v21, v100
  v_sub_f32 v22, v22, v100
  v_sub_f32 v23, v23, v100
  v_exp_f32 v20, v20
  v_exp_f32 v21, v21
  v_exp_f32 v22, v22
  v_exp_f32 v23, v23
  v_sub_f32 v112, v112, v100
  v_sub_f32 v113, v113, v100
  v_sub_f32 v114, v114, v100
  v_sub_f32 v115, v115, v100
  v_exp_f32 v112, v112
  v_exp_f32 v113, v113
  v_exp_f32 v114, v114
  v_exp_f32 v115, v115
  s_nop 0
  v_cvt_pk_bf16_f32 v44, v16, v17
  v_cvt_pk_bf16_f32 v45, v18, v19
  v_cvt_pk_bf16_f32 v46, v20, v21
  v_cvt_pk_bf16_f32 v47, v22, v23
  v_cvt_pk_bf16_f32 v84, v112, v113
  v_cvt_pk_bf16_f32 v85, v114, v115
  v_cndmask_b32 v48, v84, 0, s[16:17]
  v_cndmask_b32 v49, v85, 0, s[16:17]
  v_cndmask_b32 v50, 0, v84, s[16:17]
  v_cndmask_b32 v51, 0, v85, s[16:17]
  s_nop 1
  v_mfma_f32_16x16x16_bf16 v[88:91], v[12:13], v[48:49], 0
  v_mfma_f32_16x16x16_bf16 v[24:27], v[120:121], v[48:49], 0
  v_mfma_f32_16x16x16_bf16 v[116:119], v[120:121], v[50:51], 0
  v_mfma_f32_16x16x32_bf16 v[88:91], v[12:15], v[44:47], v[88:91]
  v_mfma_f32_16x16x32_bf16 v[24:27], v[28:31], v[44:47], v[24:27]
  v_mfma_f32_16x16x32_bf16 v[116:119], v[32:35], v[44:47], v[116:119]
  s_nop 7
  s_nop 1
  s_mov_b32 s96, -1
  s_branch T_back_22
T_w_11:
  s_mov_b32 s19, 0
  s_add_u32 s14, s14, 1
  v_mov_b64 v[16:17], 0
  v_mov_b64 v[18:19], 0
  v_mov_b64 v[20:21], 0
  v_mov_b64 v[22:23], 0
  v_mov_b64 v[24:25], 0
  v_mov_b64 v[26:27], 0
  buffer_load_dwordx4 v[124:127], v2, s[4:7], s24 offen offset:1024 sc1
  buffer_load_dwordx4 v[116:119], v2, s[4:7], s25 offen offset:1024 sc1
  buffer_load_dwordx4 v[124:127], v2, s[4:7], s24 offen offset:1024 sc1
  buffer_load_dwordx4 v[116:119], v2, s[4:7], s25 offen offset:1024 sc1
  s_branch T_loop_28
.p2align 6
T_retry_29:
  s_mov_b64 exec, vcc
  buffer_load_dwordx4 v[124:127], v2, s[4:7], s24 offen offset:1024 sc1
  buffer_load_dwordx4 v[116:119], v2, s[4:7], s25 offen offset:1024 sc1
  s_mov_b64 exec, -1
  s_add_u32 s19, s19, 1
  s_cmp_gt_u32 s19, 32768
  s_cbranch_scc1 M_exit
  s_nop 0
  v_mov_b64 v[16:17], 0
  v_mov_b64 v[18:19], 0
T_loop_28:
  s_waitcnt vmcnt(3) lgkmcnt(0)
  v_max3_u32 v123, v124, v125, v126
  v_max_u32 v123, v123, v127
  v_mov_b32_dpp v120, v124 row_ror:8 row_mask:0xf bank_mask:0xf
  v_mov_b32_dpp v121, v125 row_ror:8 row_mask:0xf bank_mask:0xf
  s_waitcnt vmcnt(2)
  v_max3_u32 v123, v123, v116, v117
  v_max3_u32 v123, v123, v118, v119
  v_cmp_eq_u32 vcc, -1, v123
  v_smfmac_f32_16x16x64_bf16 v[16:19], v[124:127], v[68:75], v0
  s_cbranch_vccnz T_retry_29
  ds_write_b128 v2, v[124:127] offset:1024
  v_mov_b32_dpp v122, v126 row_ror:8 row_mask:0xf bank_mask:0xf
  v_smfmac_f32_16x16x64_bf16 v[20:23], v[124:127], v[76:83], v0
  s_and_b32 s57, s14, 1
  v_mov_b32_dpp v123, v127 row_ror:8 row_mask:0xf bank_mask:0xf
  v_smfmac_f32_16x16x64_bf16 v[24:27], v[124:127], v[84:91], v0
  s_and_b32 s36, s14, 3
  ds_write_b128 v2, v[116:119] offset:5120
  v_smfmac_f32_16x16x64_bf16 v[16:19], v[120:123], v[92:99], v0
  s_lshl_b32 s36, s36, 13
  v_mov_b32_dpp v84, v116 row_ror:8 row_mask:0xf bank_mask:0xf
  v_smfmac_f32_16x16x64_bf16 v[20:23], v[120:123], v[100:107], v0
  s_add_u32 s26, s36, s23
  ds_read_b128 v[68:71], v4 offset:12288
  v_mov_b32_dpp v85, v117 row_ror:8 row_mask:0xf bank_mask:0xf
  v_smfmac_f32_16x16x64_bf16 v[24:27], v[120:123], v[108:115], v0
  s_add_u32 s36, s36, 8192
  ds_read_b128 v[72:75], v4 offset:13312
  v_mov_b32_dpp v86, v118 row_ror:8 row_mask:0xf bank_mask:0xf
  v_smfmac_f32_16x16x64_bf16 v[16:19], v[116:119], v[224:231], v0
  s_and_b32 s36, s36, 0x7fff
  ds_read_b128 v[76:79], v4 offset:14336
  v_mov_b32_dpp v87, v119 row_ror:8 row_mask:0xf bank_mask:0xf
  v_smfmac_f32_16x16x64_bf16 v[20:23], v[116:119], v[240:247], v0
  s_waitcnt lgkmcnt(3)
  s_barrier
  ds_read_b128 v[100:103], v2 offset:0
  v_smfmac_f32_16x16x64_bf16 v[24:27], v[116:119], a[0:7], v0
  s_mov_b32 m0, s31
  ds_read_b128 v[120:123], v1 offset:0
  v_smfmac_f32_16x16x64_bf16 v[16:19], v[84:87], v[232:239], v0
  v_smfmac_f32_16x16x64_bf16 v[20:23], v[84:87], v[248:255], v0
  ds_read_b128 v[80:83], v4 offset:15360
  v_smfmac_f32_16x16x64_bf16 v[24:27], v[84:87], a[8:15], v0
  s_waitcnt lgkmcnt(2)
  buffer_load_dwordx4 v9, s[4:7], s27 offen sc1 lds
  v_smfmac_f32_16x16x64_bf16 v[16:19], v[100:103], v[128:135], v0
  ds_read_b128 v[92:95], v2 offset:3072
  s_mov_b32 m0, s32
  v_smfmac_f32_16x16x64_bf16 v[20:23], v[100:103], v[144:151], v0
  ds_read_b128 v[96:99], v1 offset:3072
  v_smfmac_f32_16x16x64_bf16 v[24:27], v[100:103], v[68:75], v0
  s_waitcnt vmcnt(1) lgkmcnt(3)
  ds_read_b128 v[116:119], v2 offset:2048
  v_smfmac_f32_16x16x64_bf16 v[16:19], v[120:123], v[136:143], v0
  ds_read_b128 v[124:127], v1 offset:2048
  buffer_load_dwordx4 v9, s[4:7], s27 offen offset:128 sc1 lds
  v_smfmac_f32_16x16x64_bf16 v[20:23], v[120:123], v[152:159], v0
  s_waitcnt lgkmcnt(4)
  ds_read_b128 v[104:107], v2 offset:4096
  s_mov_b32 m0, s33
  v_smfmac_f32_16x16x64_bf16 v[24:27], v[120:123], v[76:83], v0
  s_waitcnt lgkmcnt(4)
  ds_read_b128 v[108:111], v1 offset:4096
  v_smfmac_f32_16x16x64_bf16 v[16:19], v[92:95], v[160:167], v0
  s_waitcnt lgkmcnt(4)
  ds_read_b128 v[112:115], v2 offset:7168
  v_smfmac_f32_16x16x64_bf16 v[16:19], v[96:99], v[168:175], v0
  s_waitcnt lgkmcnt(4)
  ds_read_b128 v[84:87], v1 offset:7168
  buffer_load_dwordx4 v10, s[4:7], s28 offen sc1 lds
  v_smfmac_f32_16x16x64_bf16 v[16:19], v[116:119], v[192:199], v0
  s_waitcnt lgkmcnt(4)
  ds_read_b128 v[88:91], v2 offset:6144
  s_mov_b32 m0, s34
  v_smfmac_f32_16x16x64_bf16 v[16:19], v[124:127], v[200:207], v0
  s_waitcnt lgkmcnt(4)
  ds_read_b128 v[100:103], v1 offset:6144
  v_smfmac_f32_16x16x64_bf16 v[16:19], v[104:107], a[16:23], v0
  s_waitcnt lgkmcnt(4)
  ds_read_b128 v[68:71], v4 offset:16384
  v_smfmac_f32_16x16x64_bf16 v[16:19], v[108:111], a[24:31], v0
  s_waitcnt lgkmcnt(4)
  ds_read_b128 v[72:75], v4 offset:17408
  buffer_load_dwordx4 v10, s[4:7], s28 offen offset:256 sc1 lds
  v_smfmac_f32_16x16x64_bf16 v[16:19], v[112:115], a[64:71], v0
  s_waitcnt lgkmcnt(4)
  ds_read_b128 v[76:79], v4 offset:18432
  v_smfmac_f32_16x16x64_bf16 v[16:19], v[84:87], a[72:79], v0
  s_waitcnt lgkmcnt(4)
  ds_read_b128 v[80:83], v4 offset:19456
  v_smfmac_f32_16x16x64_bf16 v[16:19], v[88:91], a[112:119], v0
  s_waitcnt lgkmcnt(4)
  v_smfmac_f32_16x16x64_bf16 v[16:19], v[100:103], a[120:127], v0
  s_add_u32 s24, s36, 145752064
  s_add_u32 s25, s36, 145756160
  v_smfmac_f32_16x16x64_bf16 v[20:23], v[92:95], v[176:183], v0
  s_add_u32 s35, s36, s23
  v_smfmac_f32_16x16x64_bf16 v[20:23], v[96:99], v[184:191], v0
  s_waitcnt lgkmcnt(2)
  v_smfmac_f32_16x16x64_bf16 v[20:23], v[116:119], v[68:75], v0
  s_waitcnt lgkmcnt(0)
  ds_read_b128 v[68:71], v4 offset:20480
  v_mul_f32 v16, s18, v16
  v_smfmac_f32_16x16x64_bf16 v[20:23], v[124:127], v[76:83], v0
  ds_read_b128 v[72:75], v4 offset:21504
  v_mul_f32 v17, s18, v17
  v_smfmac_f32_16x16x64_bf16 v[20:23], v[104:107], a[32:39], v0
  ds_read_b128 v[76:79], v4 offset:22528
  v_mul_f32 v18, s18, v18
  v_smfmac_f32_16x16x64_bf16 v[20:23], v[108:111], a[40:47], v0
  ds_read_b128 v[80:83], v4 offset:23552
  v_mul_f32 v19, s18, v19
  v_smfmac_f32_16x16x64_bf16 v[20:23], v[112:115], a[80:87], v0
  v_cvt_pk_bf16_f32 v120, v16, v17
  v_smfmac_f32_16x16x64_bf16 v[20:23], v[84:87], a[88:95], v0
  v_cvt_pk_bf16_f32 v121, v18, v19
  v_smfmac_f32_16x16x64_bf16 v[20:23], v[88:91], a[128:135], v0
  ds_write_b64 v5, v[120:121] offset:24576
  v_smfmac_f32_16x16x64_bf16 v[20:23], v[100:103], a[136:143], v0
  s_waitcnt lgkmcnt(3)
  v_smfmac_f32_16x16x64_bf16 v[24:27], v[92:95], v[68:75], v0
  s_waitcnt lgkmcnt(1)
  v_mov_b64 v[92:93], 0
  v_smfmac_f32_16x16x64_bf16 v[24:27], v[96:99], v[76:83], v0
  s_nop 1
  v_cvt_pk_bf16_f32 v122, v20, v21
  v_cvt_pk_bf16_f32 v123, v22, v23
  v_smfmac_f32_16x16x64_bf16 v[24:27], v[116:119], v[208:215], v0
  ds_write_b64 v5, v[122:123] offset:26880
  v_mov_b64 v[94:95], 0
  v_smfmac_f32_16x16x64_bf16 v[24:27], v[124:127], v[216:223], v0
  s_waitcnt lgkmcnt(1)
  s_barrier
  ds_read_b64_tr_b16 v[68:69], v6 offset:24576
  v_smfmac_f32_16x16x64_bf16 v[24:27], v[104:107], a[48:55], v0
  s_add_u32 s27, s27, 8192
  ds_read_b64_tr_b16 v[70:71], v6 offset:24640
  ds_read_b64_tr_b16 v[72:73], v6 offset:24832
  v_smfmac_f32_16x16x64_bf16 v[24:27], v[108:111], a[56:63], v0
  s_add_u32 s28, s28, 8192
  ds_read_b64_tr_b16 v[74:75], v6 offset:24896
  ds_read_b64_tr_b16 v[76:77], v6 offset:25088
  v_smfmac_f32_16x16x64_bf16 v[24:27], v[112:115], a[96:103], v0
  s_nop 0
  ds_read_b64_tr_b16 v[78:79], v6 offset:25152
  ds_read_b64_tr_b16 v[80:81], v6 offset:25344
  v_smfmac_f32_16x16x64_bf16 v[24:27], v[84:87], a[104:111], v0
  ds_read_b64_tr_b16 v[82:83], v6 offset:25408
  v_mov_b64 v[96:97], 0
  v_smfmac_f32_16x16x64_bf16 v[24:27], v[88:91], a[144:151], v0
  s_waitcnt lgkmcnt(8)
  s_barrier
  ds_read_b64_tr_b16 v[116:117], v6 offset:26880
  v_smfmac_f32_16x16x64_bf16 v[24:27], v[100:103], a[152:159], v0
  s_waitcnt lgkmcnt(7)
  ds_read_b64_tr_b16 v[118:119], v6 offset:26944
  v_mfma_f32_16x16x32_bf16 v[16:19], v[36:39], v[68:71], 0
  s_waitcnt lgkmcnt(6)
  ds_read_b64_tr_b16 v[124:125], v6 offset:27136
  ds_read_b64_tr_b16 v[126:127], v6 offset:27200
  v_mfma_f32_16x16x32_bf16 v[16:19], v[40:43], v[72:75], v[16:19]
  s_waitcnt lgkmcnt(6)
  ds_read_b64_tr_b16 v[104:105], v6 offset:27392
  ds_read_b64_tr_b16 v[106:107], v6 offset:27456
  v_mfma_f32_16x16x32_bf16 v[16:19], v[44:47], v[76:79], v[16:19]
  s_waitcnt lgkmcnt(6)
  ds_read_b64_tr_b16 v[108:109], v6 offset:27648
  ds_read_b64_tr_b16 v[110:111], v6 offset:27712
  v_mfma_f32_16x16x32_bf16 v[16:19], v[48:51], v[80:83], v[16:19]
  s_waitcnt lgkmcnt(6)
  v_cvt_pk_bf16_f32 v120, v24, v25
  v_cvt_pk_bf16_f32 v121, v26, v27
  v_mfma_f32_16x16x32_bf16 v[112:115], v[116:119], v[68:71], 0
  s_waitcnt lgkmcnt(4)
  v_mov_b64 v[98:99], 0
  v_mfma_f32_16x16x32_bf16 v[112:115], v[124:127], v[72:75], v[112:115]
  s_waitcnt lgkmcnt(2)
  buffer_store_dwordx4 v[120:123], v2, s[4:7], s29 offen offset:1024 sc1
  v_mov_b64 v[36:37], 0
  v_exp_f32 v100, v16
  v_mfma_f32_16x16x32_bf16 v[112:115], v[104:107], v[76:79], v[112:115]
  s_waitcnt lgkmcnt(0)
  v_exp_f32 v101, v17
  v_mfma_f32_16x16x32_bf16 v[112:115], v[108:111], v[80:83], v[112:115]
  v_exp_f32 v102, v18
  v_mfma_f32_16x16x32_bf16 v[20:23], v[52:55], v[68:71], 0
  v_exp_f32 v103, v19
  v_mfma_f32_16x16x32_bf16 v[20:23], v[56:59], v[72:75], v[20:23]
  v_cvt_pk_bf16_f32 v44, v100, v101
  v_cvt_pk_bf16_f32 v45, v102, v103
  v_mfma_f32_16x16x32_bf16 v[20:23], v[60:63], v[76:79], v[20:23]
  s_add_u32 s29, s29, 131072
  v_exp_f32 v100, v112
  v_mfma_f32_16x16x32_bf16 v[20:23], v[64:67], v[80:83], v[20:23]
  v_exp_f32 v101, v113
  v_exp_f32 v102, v114
  v_exp_f32 v103, v115
  v_cvt_pk_bf16_f32 v84, v100, v101
  v_cvt_pk_bf16_f32 v85, v102, v103
  v_cndmask_b32 v48, v84, 0, s[16:17]
  v_cndmask_b32 v49, v85, 0, s[16:17]
  v_cndmask_b32 v50, 0, v84, s[16:17]
  v_cndmask_b32 v51, 0, v85, s[16:17]
  v_exp_f32 v100, v20
  v_mfma_f32_16x16x16_bf16 v[88:91], v[12:13], v[48:49], 0
  v_exp_f32 v101, v21
  v_mfma_f32_16x16x16_bf16 v[24:27], v[120:121], v[48:49], 0
  v_exp_f32 v102, v22
  v_mfma_f32_16x16x16_bf16 v[116:119], v[120:121], v[50:51], 0
  v_exp_f32 v103, v23
  v_cvt_pk_bf16_f32 v46, v100, v101
  v_cvt_pk_bf16_f32 v47, v102, v103
  v_mov_b64 v[38:39], 0
  s_nop 0
  v_mfma_f32_16x16x32_bf16 v[88:91], v[12:15], v[44:47], v[88:91]
  v_mov_b64 v[40:41], 0
  v_mov_b64 v[42:43], 0
  v_mfma_f32_16x16x32_bf16 v[24:27], v[28:31], v[44:47], v[24:27]
  ds_read_b128 v[52:55], v4 offset:24576
  ds_read_b128 v[56:59], v4 offset:25600
  v_mfma_f32_16x16x32_bf16 v[116:119], v[32:35], v[44:47], v[116:119]
  s_nop 1
T_back_36:
  v_rcp_f32 v89, v88
  v_subrev_u32 v100, s54, v88
  v_cmp_le_u32 vcc, s96, v100
  v_mul_f32 v24, v89, v24
  v_mul_f32 v25, v89, v25
  v_cvt_pk_bf16_f32 v124, v24, v25
  v_pk_mul_f32 v[26:27], v[26:27], v[88:89] op_sel:[0,1] op_sel_hi:[1,1]
  v_cvt_pk_bf16_f32 v125, v26, v27
  ds_write_b64 v11, v[124:125] offset:29696
  v_pk_mul_f32 v[116:117], v[116:117], v[88:89] op_sel:[0,1] op_sel_hi:[1,1]
  v_pk_mul_f32 v[118:119], v[118:119], v[88:89] op_sel:[0,1] op_sel_hi:[1,1]
  v_cvt_pk_bf16_f32 v126, v116, v117
  v_cvt_pk_bf16_f32 v127, v118, v119
  ds_write_b64 v11, v[126:127] offset:29704
  s_cbranch_vccnz T_slow_35
  v_smfmac_f32_16x16x64_bf16 v[92:95], v[124:127], a[160:167], v0
  s_mov_b32 s96, s55
  v_smfmac_f32_16x16x64_bf16 v[96:99], v[124:127], a[168:175], v0
  s_cmp_eq_u32 s14, 63
  v_smfmac_f32_16x16x64_bf16 v[36:39], v[124:127], a[176:183], v0
  s_waitcnt lgkmcnt(0)
  s_barrier
  ds_read_b128 v[104:107], v11 offset:29184
  ds_read_b128 v[108:111], v11 offset:30720
  ds_read_b128 v[68:71], v11 offset:30208
  s_cbranch_scc1 M_tdone
  v_smfmac_f32_16x16x64_bf16 v[40:43], v[124:127], a[184:191], v0
  s_waitcnt lgkmcnt(2)
  v_smfmac_f32_16x16x64_bf16 v[92:95], v[104:107], a[192:199], v0
  s_waitcnt lgkmcnt(1)
  ds_read_b128 v[76:79], v4 offset:28672
  v_smfmac_f32_16x16x64_bf16 v[92:95], v[108:111], a[224:231], v0
  s_waitcnt lgkmcnt(1)
  ds_read_b128 v[80:83], v4 offset:29696
  v_smfmac_f32_16x16x64_bf16 v[92:95], v[68:71], a[240:247], v0
  ds_read_b128 v[60:63], v4 offset:26624
  v_smfmac_f32_16x16x64_bf16 v[96:99], v[104:107], a[200:207], v0
  ds_read_b128 v[64:67], v4 offset:27648
  v_smfmac_f32_16x16x64_bf16 v[96:99], v[108:111], a[232:239], v0
  ds_read_b128 v[28:31], v4 offset:30720
  s_nop 0
  v_cvt_pk_bf16_f32 v16, v92, v93
  v_cvt_pk_bf16_f32 v17, v94, v95
  v_bfi_b32 v16, 1, s57, v16
  v_smfmac_f32_16x16x64_bf16 v[96:99], v[68:71], a[248:255], v0
  buffer_store_dwordx2 v[16:17], v7, s[4:7], s20 offen offset:0
  v_smfmac_f32_16x16x64_bf16 v[36:39], v[104:107], a[208:215], v0
  ds_read_b128 v[32:35], v4 offset:31744
  v_smfmac_f32_16x16x64_bf16 v[36:39], v[108:111], v[52:59], v0
  s_waitcnt lgkmcnt(4)
  s_nop 0
  v_cvt_pk_bf16_f32 v18, v96, v97
  v_cvt_pk_bf16_f32 v19, v98, v99
  v_bfi_b32 v18, 1, s57, v18
  v_smfmac_f32_16x16x64_bf16 v[36:39], v[68:71], v[76:83], v0
  buffer_store_dwordx2 v[18:19], v7, s[4:7], s20 offen offset:64
  v_smfmac_f32_16x16x64_bf16 v[40:43], v[104:107], a[216:223], v0
  s_waitcnt lgkmcnt(2)
  ds_read_b128 v[116:119], v2 offset:31232
  v_smfmac_f32_16x16x64_bf16 v[40:43], v[108:111], v[60:67], v0
  s_waitcnt lgkmcnt(1)
  s_nop 0
  v_cvt_pk_bf16_f32 v20, v36, v37
  v_cvt_pk_bf16_f32 v21, v38, v39
  v_bfi_b32 v20, 1, s57, v20
  v_smfmac_f32_16x16x64_bf16 v[40:43], v[68:71], v[28:35], v0
  buffer_store_dwordx2 v[20:21], v7, s[4:7], s21 offen offset:0
  s_nop 6
  v_cvt_pk_bf16_f32 v22, v40, v41
  v_cvt_pk_bf16_f32 v23, v42, v43
  v_bfi_b32 v22, 1, s57, v22
  buffer_store_dwordx2 v[22:23], v7, s[4:7], s21 offen offset:64
  ds_read_b128 v[68:71], v4 offset:0
  ds_read_b128 v[72:75], v4 offset:1024
  ds_read_b128 v[76:79], v4 offset:4096
  ds_read_b128 v[80:83], v4 offset:5120
  ds_read_b128 v[84:87], v4 offset:8192
  ds_read_b128 v[88:91], v4 offset:9216
  ds_read_b128 v[92:95], v4 offset:2048
  ds_read_b128 v[96:99], v4 offset:3072
  ds_read_b128 v[100:103], v4 offset:6144
  ds_read_b128 v[104:107], v4 offset:7168
  ds_read_b128 v[108:111], v4 offset:10240
  ds_read_b128 v[112:115], v4 offset:11264
  v_mov_b64 v[16:17], 0
  v_mov_b64 v[18:19], 0
  v_mov_b64 v[20:21], 0
  v_mov_b64 v[22:23], 0
  v_mov_b64 v[24:25], 0
  v_mov_b64 v[26:27], 0
  s_mov_b32 s19, 0
  v_mov_b32 v49, -1
  ds_read_b64 v[44:45], v2 offset:32256
  s_waitcnt lgkmcnt(0)
  v_readfirstlane_b32 s38, v44
  v_readfirstlane_b32 s37, v45
  s_nop 0
  s_lshl_b32 s38, s38, 1
  s_lshl1_add_u32 s37, s37, 1
  s_min_u32 s38, s38, s37
  s_cmp_ge_u32 s38, 64
  s_cselect_b32 s38, 100, s38
  s_sub_u32 s38, s38, 1
  s_max_i32 s30, s30, s38
  s_waitcnt vmcnt(0)
  buffer_load_dwordx4 v[52:55], v2, s[4:7], s22 offen offset:0 sc1
  buffer_load_dwordx4 v[56:59], v2, s[4:7], s22 offen offset:1024 sc1
  buffer_load_dwordx4 v[60:63], v2, s[4:7], s22 offen offset:2048 sc1
  buffer_load_dwordx4 v[64:67], v2, s[4:7], s22 offen offset:3072 sc1
  s_waitcnt lgkmcnt(12)
  s_waitcnt vmcnt(3)
  v_mfma_f32_16x16x32_bf16 v[120:123], v[116:119], v[52:55], 0
  v_xor_b32 v48, s57, v52
  v_bitop3_b32 v48, v48, v54, s57 bitop3:0xf6
  s_waitcnt vmcnt(2)
  v_mfma_f32_16x16x32_bf16 v[120:123], v[116:119], v[56:59], v[120:123]
  v_bitop3_b32 v48, v48, v56, s57 bitop3:0xf6
  v_bitop3_b32 v48, v48, v58, s57 bitop3:0xf6
  s_waitcnt vmcnt(1)
  v_mfma_f32_16x16x32_bf16 v[120:123], v[116:119], v[60:63], v[120:123]
  v_bitop3_b32 v48, v48, v60, s57 bitop3:0xf6
  v_bitop3_b32 v48, v48, v62, s57 bitop3:0xf6
  s_waitcnt vmcnt(0)
  v_mfma_f32_16x16x32_bf16 v[120:123], v[116:119], v[64:67], v[120:123]
  v_bitop3_b32 v48, v48, v64, s57 bitop3:0xf6
  v_bitop3_b32 v48, v48, v66, s57 bitop3:0xf6
  v_and_b32 v48, 1, v48
  v_cmp_ne_u32 vcc, 0, v48
  s_cbranch_vccnz T_p1re_38
T_p1ok_39:
  s_nop 2
  v_add_f32_dpp v120, v120, v120 row_ror:8 row_mask:0xf bank_mask:0xf
  v_add_f32_dpp v121, v121, v121 row_ror:8 row_mask:0xf bank_mask:0xf
  v_cvt_pk_bf16_f32 v48, v120, v121
  buffer_store_dword v48, v8, s[4:7], s35 offen
  buffer_store_dword v49, v8, s[4:7], s26 offen
  s_barrier
  ds_read_b128 v[28:31], v2 offset:17408
  ds_read_b128 v[32:35], v2 offset:21504
  ds_read_b128 v[36:39], v2 offset:8192
  ds_read_b128 v[40:43], v2 offset:9216
  ds_read_b128 v[44:47], v2 offset:10240
  ds_read_b128 v[48:51], v2 offset:11264
  buffer_load_dwordx4 v[124:127], v2, s[4:7], s24 offen offset:1024 sc1
  buffer_load_dwordx4 v[116:119], v2, s[4:7], s25 offen offset:1024 sc1
  ds_read_b128 v[52:55], v2 offset:12288
  ds_read_b128 v[56:59], v2 offset:13312
  ds_read_b128 v[60:63], v2 offset:14336
  ds_read_b128 v[64:67], v2 offset:15360
  buffer_load_dwordx4 v[124:127], v2, s[4:7], s24 offen offset:1024 sc1
  buffer_load_dwordx4 v[116:119], v2, s[4:7], s25 offen offset:1024 sc1
  s_add_u32 s14, s14, 1
  s_cmp_ge_i32 s14, s30
  s_cbranch_scc1 T_kvw_32
T_kvb_33:
  s_mov_b32 s19, 0
  s_branch T_loop_28
T_p1re_38:
  s_mov_b64 exec, vcc
  buffer_load_dwordx4 v[52:55], v2, s[4:7], s22 offen offset:0 sc1
  buffer_load_dwordx4 v[56:59], v2, s[4:7], s22 offen offset:1024 sc1
  buffer_load_dwordx4 v[60:63], v2, s[4:7], s22 offen offset:2048 sc1
  buffer_load_dwordx4 v[64:67], v2, s[4:7], s22 offen offset:3072 sc1
  s_mov_b64 exec, -1
  s_add_u32 s19, s19, 1
  s_cmp_gt_u32 s19, 32768
  s_cbranch_scc1 M_exit
  s_waitcnt vmcnt(3)
  v_mfma_f32_16x16x32_bf16 v[120:123], v[116:119], v[52:55], 0
  v_xor_b32 v48, s57, v52
  v_bitop3_b32 v48, v48, v54, s57 bitop3:0xf6
  s_waitcnt vmcnt(2)
  v_mfma_f32_16x16x32_bf16 v[120:123], v[116:119], v[56:59], v[120:123]
  v_bitop3_b32 v48, v48, v56, s57 bitop3:0xf6
  v_bitop3_b32 v48, v48, v58, s57 bitop3:0xf6
  s_waitcnt vmcnt(1)
  v_mfma_f32_16x16x32_bf16 v[120:123], v[116:119], v[60:63], v[120:123]
  v_bitop3_b32 v48, v48, v60, s57 bitop3:0xf6
  v_bitop3_b32 v48, v48, v62, s57 bitop3:0xf6
  s_waitcnt vmcnt(0)
  v_mfma_f32_16x16x32_bf16 v[120:123], v[116:119], v[64:67], v[120:123]
  v_bitop3_b32 v48, v48, v64, s57 bitop3:0xf6
  v_bitop3_b32 v48, v48, v66, s57 bitop3:0xf6
  v_and_b32 v48, 1, v48
  v_cmp_ne_u32 vcc, 0, v48
  s_cbranch_vccnz T_p1re_38
  s_branch T_p1ok_39
T_kvw_32:
  s_mov_b32 s19, 0
  s_branch T_kvok_41
T_kv_40:
  s_sleep 4
  s_add_u32 s19, s19, 1
  s_cmp_gt_u32 s19, 32768
  s_cbranch_scc1 M_exit
T_kvok_41:
  s_add_u32 s39, s99, 128
  s_mov_b32 s38, 0
  s_mov_b32 s37, 0
  s_atomic_or s38, s[58:59], s99 glc
  s_atomic_or s37, s[58:59], s39 glc
  s_waitcnt lgkmcnt(0)
  s_lshl_b32 s38, s38, 1
  s_lshl1_add_u32 s37, s37, 1
  s_min_u32 s38, s38, s37
  s_cmp_ge_u32 s38, 64
  s_cselect_b32 s38, 100, s38
  s_sub_u32 s38, s38, 1
  s_max_i32 s30, s30, s38
  s_cmp_ge_i32 s14, s30
  s_cbranch_scc1 T_kv_40
  s_branch T_kvb_33
T_slow_35:
  s_nop 7
  v_max3_f32 v100, v16, v17, v18
  v_max3_f32 v100, v100, v19, v20
  v_max3_f32 v100, v100, v21, v22
  v_max3_f32 v100, v100, v23, v112
  v_max3_f32 v100, v100, v113, v114
  v_max_f32 v100, v100, v115
  v_mov_b32 v101, v100
  s_nop 1
  v_permlane32_swap_b32 v100, v101
  s_nop 1
  v_max_f32 v100, v100, v101
  v_mov_b32 v101, v100
  s_nop 1
  v_permlane16_swap_b32 v100, v101
  s_nop 1
  v_max_f32 v100, v100, v101
  v_sub_f32 v16, v16, v100
  v_sub_f32 v17, v17, v100
  v_sub_f32 v18, v18, v100
  v_sub_f32 v19, v19, v100
  v_exp_f32 v16, v16
  v_exp_f32 v17, v17
  v_exp_f32 v18, v18
  v_exp_f32 v19, v19
  v_sub_f32 v20, v20, v100
  v_sub_f32 v21, v21, v100
  v_sub_f32 v22, v22, v100
  v_sub_f32 v23, v23, v100
  v_exp_f32 v20, v20
  v_exp_f32 v21, v21
  v_exp_f32 v22, v22
  v_exp_f32 v23, v23
  v_sub_f32 v112, v112, v100
  v_sub_f32 v113, v113, v100
  v_sub_f32 v114, v114, v100
  v_sub_f32 v115, v115, v100
  v_exp_f32 v112, v112
  v_exp_f32 v113, v113
  v_exp_f32 v114, v114
  v_exp_f32 v115, v115
  s_nop 0
  v_cvt_pk_bf16_f32 v44, v16, v17
  v_cvt_pk_bf16_f32 v45, v18, v19
  v_cvt_pk_bf16_f32 v46, v20, v21
  v_cvt_pk_bf16_f32 v47, v22, v23
  v_cvt_pk_bf16_f32 v84, v112, v113
  v_cvt_pk_bf16_f32 v85, v114, v115
  v_cndmask_b32 v48, v84, 0, s[16:17]
  v_cndmask_b32 v49, v85, 0, s[16:17]
  v_cndmask_b32 v50, 0, v84, s[16:17]
  v_cndmask_b32 v51, 0, v85, s[16:17]
  s_nop 1
  v_mfma_f32_16x16x16_bf16 v[88:91], v[12:13], v[48:49], 0
  v_mfma_f32_16x16x16_bf16 v[24:27], v[120:121], v[48:49], 0
  v_mfma_f32_16x16x16_bf16 v[116:119], v[120:121], v[50:51], 0
  v_mfma_f32_16x16x32_bf16 v[88:91], v[12:15], v[44:47], v[88:91]
  v_mfma_f32_16x16x32_bf16 v[24:27], v[28:31], v[44:47], v[24:27]
  v_mfma_f32_16x16x32_bf16 v[116:119], v[32:35], v[44:47], v[116:119]
  s_nop 7
  s_nop 1
  s_mov_b32 s96, -1
  s_branch T_back_36
T_w_12:
  s_mov_b32 s19, 0
  s_add_u32 s14, s14, 1
  v_mov_b64 v[16:17], 0
  v_mov_b64 v[18:19], 0
  v_mov_b64 v[20:21], 0
  v_mov_b64 v[22:23], 0
  v_mov_b64 v[24:25], 0
  v_mov_b64 v[26:27], 0
  buffer_load_dwordx4 v[124:127], v2, s[4:7], s24 offen offset:2048 sc1
  buffer_load_dwordx4 v[116:119], v2, s[4:7], s25 offen offset:2048 sc1
  buffer_load_dwordx4 v[124:127], v2, s[4:7], s24 offen offset:2048 sc1
  buffer_load_dwordx4 v[116:119], v2, s[4:7], s25 offen offset:2048 sc1
  s_branch T_loop_42
.p2align 6
T_retry_43:
  s_mov_b64 exec, vcc
  buffer_load_dwordx4 v[124:127], v2, s[4:7], s24 offen offset:2048 sc1
  buffer_load_dwordx4 v[116:119], v2, s[4:7], s25 offen offset:2048 sc1
  s_mov_b64 exec, -1
  s_add_u32 s19, s19, 1
  s_cmp_gt_u32 s19, 32768
  s_cbranch_scc1 M_exit
  s_nop 0
  v_mov_b64 v[16:17], 0
  v_mov_b64 v[18:19], 0
T_loop_42:
  s_waitcnt vmcnt(3) lgkmcnt(0)
  v_max3_u32 v123, v124, v125, v126
  v_max_u32 v123, v123, v127
  v_mov_b32_dpp v120, v124 row_ror:8 row_mask:0xf bank_mask:0xf
  v_mov_b32_dpp v121, v125 row_ror:8 row_mask:0xf bank_mask:0xf
  s_waitcnt vmcnt(2)
  v_max3_u32 v123, v123, v116, v117
  v_max3_u32 v123, v123, v118, v119
  v_cmp_eq_u32 vcc, -1, v123
  v_smfmac_f32_16x16x64_bf16 v[16:19], v[124:127], v[68:75], v0
  s_cbranch_vccnz T_retry_43
  ds_write_b128 v2, v[124:127] offset:2048
  v_mov_b32_dpp v122, v126 row_ror:8 row_mask:0xf bank_mask:0xf
  v_smfmac_f32_16x16x64_bf16 v[20:23], v[124:127], v[76:83], v0
  s_and_b32 s57, s14, 1
  v_mov_b32_dpp v123, v127 row_ror:8 row_mask:0xf bank_mask:0xf
  v_smfmac_f32_16x16x64_bf16 v[24:27], v[124:127], v[84:91], v0
  s_and_b32 s36, s14, 3
  ds_write_b128 v2, v[116:119] offset:6144
  v_smfmac_f32_16x16x64_bf16 v[16:19], v[120:123], v[92:99], v0
  s_lshl_b32 s36, s36, 13
  v_mov_b32_dpp v84, v116 row_ror:8 row_mask:0xf bank_mask:0xf
  v_smfmac_f32_16x16x64_bf16 v[20:23], v[120:123], v[100:107], v0
  s_add_u32 s26, s36, s23
  ds_read_b128 v[68:71], v4 offset:12288
  v_mov_b32_dpp v85, v117 row_ror:8 row_mask:0xf bank_mask:0xf
  v_smfmac_f32_16x16x64_bf16 v[24:27], v[120:123], v[108:115], v0
  s_add_u32 s36, s36, 8192
  ds_read_b128 v[72:75], v4 offset:13312
  v_mov_b32_dpp v86, v118 row_ror:8 row_mask:0xf bank_mask:0xf
  v_smfmac_f32_16x16x64_bf16 v[16:19], v[116:119], v[224:231], v0
  s_and_b32 s36, s36, 0x7fff
  ds_read_b128 v[76:79], v4 offset:14336
  v_mov_b32_dpp v87, v119 row_ror:8 row_mask:0xf bank_mask:0xf
  v_smfmac_f32_16x16x64_bf16 v[20:23], v[116:119], v[240:247], v0
  s_waitcnt lgkmcnt(3)
  s_barrier
  ds_read_b128 v[100:103], v2 offset:3072
  v_smfmac_f32_16x16x64_bf16 v[24:27], v[116:119], a[0:7], v0
  s_mov_b32 m0, s31
  ds_read_b128 v[120:123], v1 offset:3072
  v_smfmac_f32_16x16x64_bf16 v[16:19], v[84:87], v[232:239], v0
  v_smfmac_f32_16x16x64_bf16 v[20:23], v[84:87], v[248:255], v0
  ds_read_b128 v[80:83], v4 offset:15360
  v_smfmac_f32_16x16x64_bf16 v[24:27], v[84:87], a[8:15], v0
  s_waitcnt lgkmcnt(2)
  v_smfmac_f32_16x16x64_bf16 v[16:19], v[100:103], v[128:135], v0
  ds_read_b128 v[92:95], v2 offset:0
  buffer_load_dwordx4 v9, s[4:7], s27 offen sc1 lds
  v_smfmac_f32_16x16x64_bf16 v[20:23], v[100:103], v[144:151], v0
  ds_read_b128 v[96:99], v1 offset:0
  s_mov_b32 m0, s32
  v_smfmac_f32_16x16x64_bf16 v[24:27], v[100:103], v[68:75], v0
  s_waitcnt vmcnt(1) lgkmcnt(3)
  ds_read_b128 v[116:119], v2 offset:1024
  v_smfmac_f32_16x16x64_bf16 v[16:19], v[120:123], v[136:143], v0
  ds_read_b128 v[124:127], v1 offset:1024
  v_smfmac_f32_16x16x64_bf16 v[20:23], v[120:123], v[152:159], v0
  s_waitcnt lgkmcnt(4)
  ds_read_b128 v[104:107], v2 offset:7168
  buffer_load_dwordx4 v9, s[4:7], s27 offen offset:128 sc1 lds
  v_smfmac_f32_16x16x64_bf16 v[24:27], v[120:123], v[76:83], v0
  s_waitcnt lgkmcnt(4)
  ds_read_b128 v[108:111], v1 offset:7168
  s_mov_b32 m0, s33
  v_smfmac_f32_16x16x64_bf16 v[16:19], v[92:95], v[160:167], v0
  s_waitcnt lgkmcnt(4)
  ds_read_b128 v[112:115], v2 offset:4096
  v_mov_b32 v122, s98
  v_smfmac_f32_16x16x64_bf16 v[16:19], v[96:99], v[168:175], v0
  s_waitcnt lgkmcnt(4)
  ds_read_b128 v[84:87], v1 offset:4096
  v_smfmac_f32_16x16x64_bf16 v[16:19], v[116:119], v[192:199], v0
  s_waitcnt lgkmcnt(4)
  ds_read_b128 v[88:91], v2 offset:5120
  buffer_load_dwordx4 v10, s[4:7], s28 offen sc1 lds
  v_smfmac_f32_16x16x64_bf16 v[16:19], v[124:127], v[200:207], v0
  s_waitcnt lgkmcnt(4)
  ds_read_b128 v[100:103], v1 offset:5120
  s_mov_b32 m0, s34
  v_smfmac_f32_16x16x64_bf16 v[16:19], v[104:107], a[16:23], v0
  s_waitcnt lgkmcnt(4)
  ds_read_b128 v[68:71], v4 offset:16384
  v_smfmac_f32_16x16x64_bf16 v[16:19], v[108:111], a[24:31], v0
  s_waitcnt lgkmcnt(4)
  ds_read_b128 v[72:75], v4 offset:17408
  v_smfmac_f32_16x16x64_bf16 v[16:19], v[112:115], a[64:71], v0
  s_waitcnt lgkmcnt(4)
  ds_read_b128 v[76:79], v4 offset:18432
  buffer_load_dwordx4 v10, s[4:7], s28 offen offset:256 sc1 lds
  v_smfmac_f32_16x16x64_bf16 v[16:19], v[84:87], a[72:79], v0
  s_waitcnt lgkmcnt(4)
  ds_read_b128 v[80:83], v4 offset:19456
  v_smfmac_f32_16x16x64_bf16 v[16:19], v[88:91], a[112:119], v0
  s_waitcnt lgkmcnt(4)
  v_smfmac_f32_16x16x64_bf16 v[16:19], v[100:103], a[120:127], v0
  s_add_u32 s24, s36, 145752064
  s_add_u32 s25, s36, 145756160
  v_smfmac_f32_16x16x64_bf16 v[20:23], v[92:95], v[176:183], v0
  buffer_store_dword v122, v3, s[4:7], s15 offen sc1
  s_add_u32 s35, s36, s23
  v_smfmac_f32_16x16x64_bf16 v[20:23], v[96:99], v[184:191], v0
  s_waitcnt lgkmcnt(2)
  s_add_u32 s98, s14, 1
  v_smfmac_f32_16x16x64_bf16 v[20:23], v[116:119], v[68:75], v0
  s_waitcnt lgkmcnt(0)
  ds_read_b128 v[68:71], v4 offset:20480
  v_mul_f32 v16, s18, v16
  v_smfmac_f32_16x16x64_bf16 v[20:23], v[124:127], v[76:83], v0
  ds_read_b128 v[72:75], v4 offset:21504
  v_mul_f32 v17, s18, v17
  v_smfmac_f32_16x16x64_bf16 v[20:23], v[104:107], a[32:39], v0
  ds_read_b128 v[76:79], v4 offset:22528
  v_mul_f32 v18, s18, v18
  v_smfmac_f32_16x16x64_bf16 v[20:23], v[108:111], a[40:47], v0
  ds_read_b128 v[80:83], v4 offset:23552
  v_mul_f32 v19, s18, v19
  v_smfmac_f32_16x16x64_bf16 v[20:23], v[112:115], a[80:87], v0
  v_cvt_pk_bf16_f32 v120, v16, v17
  v_smfmac_f32_16x16x64_bf16 v[20:23], v[84:87], a[88:95], v0
  v_cvt_pk_bf16_f32 v121, v18, v19
  v_smfmac_f32_16x16x64_bf16 v[20:23], v[88:91], a[128:135], v0
  ds_write_b64 v5, v[120:121] offset:24576
  v_smfmac_f32_16x16x64_bf16 v[20:23], v[100:103], a[136:143], v0
  s_waitcnt lgkmcnt(3)
  v_smfmac_f32_16x16x64_bf16 v[24:27], v[92:95], v[68:75], v0
  s_waitcnt lgkmcnt(1)
  v_mov_b64 v[92:93], 0
  v_smfmac_f32_16x16x64_bf16 v[24:27], v[96:99], v[76:83], v0
  s_nop 1
  v_cvt_pk_bf16_f32 v122, v20, v21
  v_cvt_pk_bf16_f32 v123, v22, v23
  v_smfmac_f32_16x16x64_bf16 v[24:27], v[116:119], v[208:215], v0
  ds_write_b64 v5, v[122:123] offset:26880
  v_mov_b64 v[94:95], 0
  v_smfmac_f32_16x16x64_bf16 v[24:27], v[124:127], v[216:223], v0
  s_waitcnt lgkmcnt(1)
  s_barrier
  ds_read_b64_tr_b16 v[68:69], v6 offset:24576
  v_smfmac_f32_16x16x64_bf16 v[24:27], v[104:107], a[48:55], v0
  s_add_u32 s27, s27, 8192
  ds_read_b64_tr_b16 v[70:71], v6 offset:24640
  ds_read_b64_tr_b16 v[72:73], v6 offset:24832
  v_smfmac_f32_16x16x64_bf16 v[24:27], v[108:111], a[56:63], v0
  s_add_u32 s28, s28, 8192
  ds_read_b64_tr_b16 v[74:75], v6 offset:24896
  ds_read_b64_tr_b16 v[76:77], v6 offset:25088
  v_smfmac_f32_16x16x64_bf16 v[24:27], v[112:115], a[96:103], v0
  s_nop 0
  ds_read_b64_tr_b16 v[78:79], v6 offset:25152
  ds_read_b64_tr_b16 v[80:81], v6 offset:25344
  v_smfmac_f32_16x16x64_bf16 v[24:27], v[84:87], a[104:111], v0
  ds_read_b64_tr_b16 v[82:83], v6 offset:25408
  v_mov_b64 v[96:97], 0
  v_smfmac_f32_16x16x64_bf16 v[24:27], v[88:91], a[144:151], v0
  s_waitcnt lgkmcnt(8)
  s_barrier
  ds_read_b64_tr_b16 v[116:117], v6 offset:26880
  v_smfmac_f32_16x16x64_bf16 v[24:27], v[100:103], a[152:159], v0
  s_waitcnt lgkmcnt(7)
  ds_read_b64_tr_b16 v[118:119], v6 offset:26944
  v_mfma_f32_16x16x32_bf16 v[16:19], v[36:39], v[68:71], 0
  s_waitcnt lgkmcnt(6)
  ds_read_b64_tr_b16 v[124:125], v6 offset:27136
  ds_read_b64_tr_b16 v[126:127], v6 offset:27200
  v_mfma_f32_16x16x32_bf16 v[16:19], v[40:43], v[72:75], v[16:19]
  s_waitcnt lgkmcnt(6)
  ds_read_b64_tr_b16 v[104:105], v6 offset:27392
  ds_read_b64_tr_b16 v[106:107], v6 offset:27456
  v_mfma_f32_16x16x32_bf16 v[16:19], v[44:47], v[76:79], v[16:19]
  s_waitcnt lgkmcnt(6)
  ds_read_b64_tr_b16 v[108:109], v6 offset:27648
  ds_read_b64_tr_b16 v[110:111], v6 offset:27712
  v_mfma_f32_16x16x32_bf16 v[16:19], v[48:51], v[80:83], v[16:19]
  s_waitcnt lgkmcnt(6)
  v_cvt_pk_bf16_f32 v120, v24, v25
  v_cvt_pk_bf16_f32 v121, v26, v27
  v_mfma_f32_16x16x32_bf16 v[112:115], v[116:119], v[68:71], 0
  s_waitcnt lgkmcnt(4)
  v_mov_b64 v[98:99], 0
  v_mfma_f32_16x16x32_bf16 v[112:115], v[124:127], v[72:75], v[112:115]
  s_waitcnt lgkmcnt(2)
  v_mov_b64 v[36:37], 0
  v_exp_f32 v100, v16
  v_mfma_f32_16x16x32_bf16 v[112:115], v[104:107], v[76:79], v[112:115]
  s_waitcnt lgkmcnt(0)
  buffer_store_dwordx4 v[120:123], v2, s[4:7], s29 offen offset:2048 sc1
  v_exp_f32 v101, v17
  v_mfma_f32_16x16x32_bf16 v[112:115], v[108:111], v[80:83], v[112:115]
  v_exp_f32 v102, v18
  v_mfma_f32_16x16x32_bf16 v[20:23], v[52:55], v[68:71], 0
  v_exp_f32 v103, v19
  v_mfma_f32_16x16x32_bf16 v[20:23], v[56:59], v[72:75], v[20:23]
  v_cvt_pk_bf16_f32 v44, v100, v101
  v_cvt_pk_bf16_f32 v45, v102, v103
  v_mfma_f32_16x16x32_bf16 v[20:23], v[60:63], v[76:79], v[20:23]
  s_add_u32 s29, s29, 131072
  v_exp_f32 v100, v112
  v_mfma_f32_16x16x32_bf16 v[20:23], v[64:67], v[80:83], v[20:23]
  v_exp_f32 v101, v113
  v_exp_f32 v102, v114
  v_exp_f32 v103, v115
  v_cvt_pk_bf16_f32 v84, v100, v101
  v_cvt_pk_bf16_f32 v85, v102, v103
  v_cndmask_b32 v48, v84, 0, s[16:17]
  v_cndmask_b32 v49, v85, 0, s[16:17]
  v_cndmask_b32 v50, 0, v84, s[16:17]
  v_cndmask_b32 v51, 0, v85, s[16:17]
  v_exp_f32 v100, v20
  v_mfma_f32_16x16x16_bf16 v[88:91], v[12:13], v[48:49], 0
  v_exp_f32 v101, v21
  v_mfma_f32_16x16x16_bf16 v[24:27], v[120:121], v[48:49], 0
  v_exp_f32 v102, v22
  v_mfma_f32_16x16x16_bf16 v[116:119], v[120:121], v[50:51], 0
  v_exp_f32 v103, v23
  v_cvt_pk_bf16_f32 v46, v100, v101
  v_cvt_pk_bf16_f32 v47, v102, v103
  v_mov_b64 v[38:39], 0
  s_nop 0
  v_mfma_f32_16x16x32_bf16 v[88:91], v[12:15], v[44:47], v[88:91]
  v_mov_b64 v[40:41], 0
  v_mov_b64 v[42:43], 0
  v_mfma_f32_16x16x32_bf16 v[24:27], v[28:31], v[44:47], v[24:27]
  ds_read_b128 v[52:55], v4 offset:24576
  ds_read_b128 v[56:59], v4 offset:25600
  v_mfma_f32_16x16x32_bf16 v[116:119], v[32:35], v[44:47], v[116:119]
  s_nop 1
T_back_50:
  v_rcp_f32 v89, v88
  v_subrev_u32 v100, s54, v88
  v_cmp_le_u32 vcc, s96, v100
  v_mul_f32 v24, v89, v24
  v_mul_f32 v25, v89, v25
  v_cvt_pk_bf16_f32 v124, v24, v25
  v_pk_mul_f32 v[26:27], v[26:27], v[88:89] op_sel:[0,1] op_sel_hi:[1,1]
  v_cvt_pk_bf16_f32 v125, v26, v27
  ds_write_b64 v11, v[124:125] offset:30208
  v_pk_mul_f32 v[116:117], v[116:117], v[88:89] op_sel:[0,1] op_sel_hi:[1,1]
  v_pk_mul_f32 v[118:119], v[118:119], v[88:89] op_sel:[0,1] op_sel_hi:[1,1]
  v_cvt_pk_bf16_f32 v126, v116, v117
  v_cvt_pk_bf16_f32 v127, v118, v119
  ds_write_b64 v11, v[126:127] offset:30216
  s_cbranch_vccnz T_slow_49
  v_smfmac_f32_16x16x64_bf16 v[92:95], v[124:127], a[160:167], v0
  s_mov_b32 s96, s55
  v_smfmac_f32_16x16x64_bf16 v[96:99], v[124:127], a[168:175], v0
  s_cmp_eq_u32 s14, 63
  v_smfmac_f32_16x16x64_bf16 v[36:39], v[124:127], a[176:183], v0
  s_waitcnt lgkmcnt(0)
  s_barrier
  ds_read_b128 v[104:107], v11 offset:30720
  ds_read_b128 v[108:111], v11 offset:29184
  ds_read_b128 v[68:71], v11 offset:29696
  s_cbranch_scc1 M_tdone
  v_smfmac_f32_16x16x64_bf16 v[40:43], v[124:127], a[184:191], v0
  s_waitcnt lgkmcnt(2)
  v_smfmac_f32_16x16x64_bf16 v[92:95], v[104:107], a[192:199], v0
  s_waitcnt lgkmcnt(1)
  ds_read_b128 v[76:79], v4 offset:28672
  v_smfmac_f32_16x16x64_bf16 v[92:95], v[108:111], a[224:231], v0
  s_waitcnt lgkmcnt(1)
  ds_read_b128 v[80:83], v4 offset:29696
  v_smfmac_f32_16x16x64_bf16 v[92:95], v[68:71], a[240:247], v0
  ds_read_b128 v[60:63], v4 offset:26624
  v_smfmac_f32_16x16x64_bf16 v[96:99], v[104:107], a[200:207], v0
  ds_read_b128 v[64:67], v4 offset:27648
  v_smfmac_f32_16x16x64_bf16 v[96:99], v[108:111], a[232:239], v0
  ds_read_b128 v[28:31], v4 offset:30720
  s_nop 0
  v_cvt_pk_bf16_f32 v16, v92, v93
  v_cvt_pk_bf16_f32 v17, v94, v95
  v_bfi_b32 v16, 1, s57, v16
  v_smfmac_f32_16x16x64_bf16 v[96:99], v[68:71], a[248:255], v0
  buffer_store_dwordx2 v[16:17], v7, s[4:7], s20 offen offset:0
  v_smfmac_f32_16x16x64_bf16 v[36:39], v[104:107], a[208:215], v0
  ds_read_b128 v[32:35], v4 offset:31744
  v_smfmac_f32_16x16x64_bf16 v[36:39], v[108:111], v[52:59], v0
  s_waitcnt lgkmcnt(4)
  s_nop 0
  v_cvt_pk_bf16_f32 v18, v96, v97
  v_cvt_pk_bf16_f32 v19, v98, v99
  v_bfi_b32 v18, 1, s57, v18
  v_smfmac_f32_16x16x64_bf16 v[36:39], v[68:71], v[76:83], v0
  buffer_store_dwordx2 v[18:19], v7, s[4:7], s20 offen offset:64
  v_smfmac_f32_16x16x64_bf16 v[40:43], v[104:107], a[216:223], v0
  s_waitcnt lgkmcnt(2)
  v_smfmac_f32_16x16x64_bf16 v[40:43], v[108:111], v[60:67], v0
  s_waitcnt lgkmcnt(0)
  s_nop 0
  v_cvt_pk_bf16_f32 v20, v36, v37
  v_cvt_pk_bf16_f32 v21, v38, v39
  v_bfi_b32 v20, 1, s57, v20
  v_smfmac_f32_16x16x64_bf16 v[40:43], v[68:71], v[28:35], v0
  buffer_store_dwordx2 v[20:21], v7, s[4:7], s21 offen offset:0
  s_nop 6
  v_cvt_pk_bf16_f32 v22, v40, v41
  v_cvt_pk_bf16_f32 v23, v42, v43
  v_bfi_b32 v22, 1, s57, v22
  buffer_store_dwordx2 v[22:23], v7, s[4:7], s21 offen offset:64
  ds_read_b128 v[68:71], v4 offset:0
  ds_read_b128 v[72:75], v4 offset:1024
  ds_read_b128 v[76:79], v4 offset:4096
  ds_read_b128 v[80:83], v4 offset:5120
  ds_read_b128 v[84:87], v4 offset:8192
  ds_read_b128 v[88:91], v4 offset:9216
  ds_read_b128 v[92:95], v4 offset:2048
  ds_read_b128 v[96:99], v4 offset:3072
  ds_read_b128 v[100:103], v4 offset:6144
  ds_read_b128 v[104:107], v4 offset:7168
  ds_read_b128 v[108:111], v4 offset:10240
  ds_read_b128 v[112:115], v4 offset:11264
  v_mov_b64 v[16:17], 0
  v_mov_b64 v[18:19], 0
  v_mov_b64 v[20:21], 0
  v_mov_b64 v[22:23], 0
  v_mov_b64 v[24:25], 0
  v_mov_b64 v[26:27], 0
  ds_read_b64 v[44:45], v2 offset:32256
  s_waitcnt lgkmcnt(0)
  v_readfirstlane_b32 s38, v44
  v_readfirstlane_b32 s37, v45
  s_nop 0
  s_lshl_b32 s38, s38, 1
  s_lshl1_add_u32 s37, s37, 1
  s_min_u32 s38, s38, s37
  s_cmp_ge_u32 s38, 64
  s_cselect_b32 s38, 100, s38
  s_sub_u32 s38, s38, 1
  s_max_i32 s30, s30, s38
  s_waitcnt vmcnt(4)
  s_barrier
  ds_read_b128 v[28:31], v2 offset:18432
  ds_read_b128 v[32:35], v2 offset:22528
  ds_read_b128 v[36:39], v2 offset:8192
  ds_read_b128 v[40:43], v2 offset:9216
  ds_read_b128 v[44:47], v2 offset:10240
  ds_read_b128 v[48:51], v2 offset:11264
  buffer_load_dwordx4 v[124:127], v2, s[4:7], s24 offen offset:2048 sc1
  buffer_load_dwordx4 v[116:119], v2, s[4:7], s25 offen offset:2048 sc1
  ds_read_b128 v[52:55], v2 offset:12288
  ds_read_b128 v[56:59], v2 offset:13312
  ds_read_b128 v[60:63], v2 offset:14336
  ds_read_b128 v[64:67], v2 offset:15360
  buffer_load_dwordx4 v[124:127], v2, s[4:7], s24 offen offset:2048 sc1
  buffer_load_dwordx4 v[116:119], v2, s[4:7], s25 offen offset:2048 sc1
  s_add_u32 s14, s14, 1
  s_cmp_ge_i32 s14, s30
  s_cbranch_scc1 T_kvw_46
T_kvb_47:
  s_mov_b32 s19, 0
  s_branch T_loop_42
T_kvw_46:
  s_mov_b32 s19, 0
  s_branch T_kvok_55
T_kv_54:
  s_sleep 4
  s_add_u32 s19, s19, 1
  s_cmp_gt_u32 s19, 32768
  s_cbranch_scc1 M_exit
T_kvok_55:
  s_add_u32 s39, s99, 128
  s_mov_b32 s38, 0
  s_mov_b32 s37, 0
  s_atomic_or s38, s[58:59], s99 glc
  s_atomic_or s37, s[58:59], s39 glc
  s_waitcnt lgkmcnt(0)
  s_lshl_b32 s38, s38, 1
  s_lshl1_add_u32 s37, s37, 1
  s_min_u32 s38, s38, s37
  s_cmp_ge_u32 s38, 64
  s_cselect_b32 s38, 100, s38
  s_sub_u32 s38, s38, 1
  s_max_i32 s30, s30, s38
  s_cmp_ge_i32 s14, s30
  s_cbranch_scc1 T_kv_54
  s_branch T_kvb_47
T_slow_49:
  s_nop 7
  v_max3_f32 v100, v16, v17, v18
  v_max3_f32 v100, v100, v19, v20
  v_max3_f32 v100, v100, v21, v22
  v_max3_f32 v100, v100, v23, v112
  v_max3_f32 v100, v100, v113, v114
  v_max_f32 v100, v100, v115
  v_mov_b32 v101, v100
  s_nop 1
  v_permlane32_swap_b32 v100, v101
  s_nop 1
  v_max_f32 v100, v100, v101
  v_mov_b32 v101, v100
  s_nop 1
  v_permlane16_swap_b32 v100, v101
  s_nop 1
  v_max_f32 v100, v100, v101
  v_sub_f32 v16, v16, v100
  v_sub_f32 v17, v17, v100
  v_sub_f32 v18, v18, v100
  v_sub_f32 v19, v19, v100
  v_exp_f32 v16, v16
  v_exp_f32 v17, v17
  v_exp_f32 v18, v18
  v_exp_f32 v19, v19
  v_sub_f32 v20, v20, v100
  v_sub_f32 v21, v21, v100
  v_sub_f32 v22, v22, v100
  v_sub_f32 v23, v23, v100
  v_exp_f32 v20, v20
  v_exp_f32 v21, v21
  v_exp_f32 v22, v22
  v_exp_f32 v23, v23
  v_sub_f32 v112, v112, v100
  v_sub_f32 v113, v113, v100
  v_sub_f32 v114, v114, v100
  v_sub_f32 v115, v115, v100
  v_exp_f32 v112, v112
  v_exp_f32 v113, v113
  v_exp_f32 v114, v114
  v_exp_f32 v115, v115
  s_nop 0
  v_cvt_pk_bf16_f32 v44, v16, v17
  v_cvt_pk_bf16_f32 v45, v18, v19
  v_cvt_pk_bf16_f32 v46, v20, v21
  v_cvt_pk_bf16_f32 v47, v22, v23
  v_cvt_pk_bf16_f32 v84, v112, v113
  v_cvt_pk_bf16_f32 v85, v114, v115
  v_cndmask_b32 v48, v84, 0, s[16:17]
  v_cndmask_b32 v49, v85, 0, s[16:17]
  v_cndmask_b32 v50, 0, v84, s[16:17]
  v_cndmask_b32 v51, 0, v85, s[16:17]
  s_nop 1
  v_mfma_f32_16x16x16_bf16 v[88:91], v[12:13], v[48:49], 0
  v_mfma_f32_16x16x16_bf16 v[24:27], v[120:121], v[48:49], 0
  v_mfma_f32_16x16x16_bf16 v[116:119], v[120:121], v[50:51], 0
  v_mfma_f32_16x16x32_bf16 v[88:91], v[12:15], v[44:47], v[88:91]
  v_mfma_f32_16x16x32_bf16 v[24:27], v[28:31], v[44:47], v[24:27]
  v_mfma_f32_16x16x32_bf16 v[116:119], v[32:35], v[44:47], v[116:119]
  s_nop 7
  s_nop 1
  s_mov_b32 s96, -1
  s_branch T_back_50
T_w_13:
  s_mov_b32 s19, 0
  s_add_u32 s14, s14, 1
  v_mov_b64 v[16:17], 0
  v_mov_b64 v[18:19], 0
  v_mov_b64 v[20:21], 0
  v_mov_b64 v[22:23], 0
  v_mov_b64 v[24:25], 0
  v_mov_b64 v[26:27], 0
  buffer_load_dwordx4 v[124:127], v2, s[4:7], s24 offen offset:3072 sc1
  buffer_load_dwordx4 v[116:119], v2, s[4:7], s25 offen offset:3072 sc1
  buffer_load_dwordx4 v[124:127], v2, s[4:7], s24 offen offset:3072 sc1
  buffer_load_dwordx4 v[116:119], v2, s[4:7], s25 offen offset:3072 sc1
  s_branch T_loop_56
.p2align 6
T_retry_57:
  s_mov_b64 exec, vcc
  buffer_load_dwordx4 v[124:127], v2, s[4:7], s24 offen offset:3072 sc1
  buffer_load_dwordx4 v[116:119], v2, s[4:7], s25 offen offset:3072 sc1
  s_mov_b64 exec, -1
  s_add_u32 s19, s19, 1
  s_cmp_gt_u32 s19, 32768
  s_cbranch_scc1 M_exit
  s_nop 0
  v_mov_b64 v[16:17], 0
  v_mov_b64 v[18:19], 0
T_loop_56:
  s_waitcnt vmcnt(3) lgkmcnt(0)
  v_max3_u32 v123, v124, v125, v126
  v_max_u32 v123, v123, v127
  v_mov_b32_dpp v120, v124 row_ror:8 row_mask:0xf bank_mask:0xf
  v_mov_b32_dpp v121, v125 row_ror:8 row_mask:0xf bank_mask:0xf
  s_waitcnt vmcnt(2)
  v_max3_u32 v123, v123, v116, v117
  v_max3_u32 v123, v123, v118, v119
  v_cmp_eq_u32 vcc, -1, v123
  v_smfmac_f32_16x16x64_bf16 v[16:19], v[124:127], v[68:75], v0
  s_cbranch_vccnz T_retry_57
  ds_write_b128 v2, v[124:127] offset:3072
  v_mov_b32_dpp v122, v126 row_ror:8 row_mask:0xf bank_mask:0xf
  v_smfmac_f32_16x16x64_bf16 v[20:23], v[124:127], v[76:83], v0
  s_and_b32 s57, s14, 1
  v_mov_b32_dpp v123, v127 row_ror:8 row_mask:0xf bank_mask:0xf
  v_smfmac_f32_16x16x64_bf16 v[24:27], v[124:127], v[84:91], v0
  s_and_b32 s36, s14, 3
  ds_write_b128 v2, v[116:119] offset:7168
  v_smfmac_f32_16x16x64_bf16 v[16:19], v[120:123], v[92:99], v0
  s_lshl_b32 s36, s36, 13
  v_mov_b32_dpp v84, v116 row_ror:8 row_mask:0xf bank_mask:0xf
  v_smfmac_f32_16x16x64_bf16 v[20:23], v[120:123], v[100:107], v0
  s_add_u32 s26, s36, s23
  ds_read_b128 v[68:71], v4 offset:12288
  v_mov_b32_dpp v85, v117 row_ror:8 row_mask:0xf bank_mask:0xf
  v_smfmac_f32_16x16x64_bf16 v[24:27], v[120:123], v[108:115], v0
  s_add_u32 s36, s36, 8192
  ds_read_b128 v[72:75], v4 offset:13312
  v_mov_b32_dpp v86, v118 row_ror:8 row_mask:0xf bank_mask:0xf
  v_smfmac_f32_16x16x64_bf16 v[16:19], v[116:119], v[224:231], v0
  s_and_b32 s36, s36, 0x7fff
  ds_read_b128 v[76:79], v4 offset:14336
  v_mov_b32_dpp v87, v119 row_ror:8 row_mask:0xf bank_mask:0xf
  v_smfmac_f32_16x16x64_bf16 v[20:23], v[116:119], v[240:247], v0
  s_waitcnt lgkmcnt(3)
  s_barrier
  ds_read_b128 v[100:103], v2 offset:2048
  v_smfmac_f32_16x16x64_bf16 v[24:27], v[116:119], a[0:7], v0
  s_mov_b32 m0, s31
  ds_read_b128 v[120:123], v1 offset:2048
  v_smfmac_f32_16x16x64_bf16 v[16:19], v[84:87], v[232:239], v0
  v_smfmac_f32_16x16x64_bf16 v[20:23], v[84:87], v[248:255], v0
  ds_read_b128 v[80:83], v4 offset:15360
  v_smfmac_f32_16x16x64_bf16 v[24:27], v[84:87], a[8:15], v0
  s_waitcnt lgkmcnt(2)
  v_smfmac_f32_16x16x64_bf16 v[16:19], v[100:103], v[128:135], v0
  ds_read_b128 v[92:95], v2 offset:1024
  v_smfmac_f32_16x16x64_bf16 v[20:23], v[100:103], v[144:151], v0
  ds_read_b128 v[96:99], v1 offset:1024
  buffer_load_dwordx4 v9, s[4:7], s27 offen sc1 lds
  v_smfmac_f32_16x16x64_bf16 v[24:27], v[100:103], v[68:75], v0
  s_waitcnt vmcnt(1) lgkmcnt(3)
  ds_read_b128 v[116:119], v2 offset:0
  s_mov_b32 m0, s32
  v_smfmac_f32_16x16x64_bf16 v[16:19], v[120:123], v[136:143], v0
  ds_read_b128 v[124:127], v1 offset:0
  v_smfmac_f32_16x16x64_bf16 v[20:23], v[120:123], v[152:159], v0
  s_waitcnt lgkmcnt(4)
  ds_read_b128 v[104:107], v2 offset:6144
  v_smfmac_f32_16x16x64_bf16 v[24:27], v[120:123], v[76:83], v0
  s_waitcnt lgkmcnt(4)
  ds_read_b128 v[108:111], v1 offset:6144
  buffer_load_dwordx4 v9, s[4:7], s27 offen offset:128 sc1 lds
  v_smfmac_f32_16x16x64_bf16 v[16:19], v[92:95], v[160:167], v0
  s_waitcnt lgkmcnt(4)
  ds_read_b128 v[112:115], v2 offset:5120
  s_mov_b32 m0, s33
  v_smfmac_f32_16x16x64_bf16 v[16:19], v[96:99], v[168:175], v0
  s_waitcnt lgkmcnt(4)
  ds_read_b128 v[84:87], v1 offset:5120
  v_smfmac_f32_16x16x64_bf16 v[16:19], v[116:119], v[192:199], v0
  s_waitcnt lgkmcnt(4)
  ds_read_b128 v[88:91], v2 offset:4096
  v_smfmac_f32_16x16x64_bf16 v[16:19], v[124:127], v[200:207], v0
  s_waitcnt lgkmcnt(4)
  ds_read_b128 v[100:103], v1 offset:4096
  buffer_load_dwordx4 v10, s[4:7], s28 offen sc1 lds
  v_smfmac_f32_16x16x64_bf16 v[16:19], v[104:107], a[16:23], v0
  s_waitcnt lgkmcnt(4)
  ds_read_b128 v[68:71], v4 offset:16384
  s_mov_b32 m0, s34
  v_smfmac_f32_16x16x64_bf16 v[16:19], v[108:111], a[24:31], v0
  s_waitcnt lgkmcnt(4)
  ds_read_b128 v[72:75], v4 offset:17408
  v_smfmac_f32_16x16x64_bf16 v[16:19], v[112:115], a[64:71], v0
  s_waitcnt lgkmcnt(4)
  ds_read_b128 v[76:79], v4 offset:18432
  v_smfmac_f32_16x16x64_bf16 v[16:19], v[84:87], a[72:79], v0
  s_waitcnt lgkmcnt(4)
  ds_read_b128 v[80:83], v4 offset:19456
  buffer_load_dwordx4 v10, s[4:7], s28 offen offset:256 sc1 lds
  v_smfmac_f32_16x16x64_bf16 v[16:19], v[88:91], a[112:119], v0
  s_waitcnt lgkmcnt(4)
  s_mov_b32 m0, 32256
  v_smfmac_f32_16x16x64_bf16 v[16:19], v[100:103], a[120:127], v0
  s_add_u32 s24, s36, 145752064
  s_add_u32 s25, s36, 145756160
  v_smfmac_f32_16x16x64_bf16 v[20:23], v[92:95], v[176:183], v0
  s_add_u32 s35, s36, s23
  v_smfmac_f32_16x16x64_bf16 v[20:23], v[96:99], v[184:191], v0
  s_waitcnt lgkmcnt(2)
  buffer_load_dword v3, s[4:7], s99 offen sc1 lds
  v_smfmac_f32_16x16x64_bf16 v[20:23], v[116:119], v[68:75], v0
  s_waitcnt lgkmcnt(0)
  ds_read_b128 v[68:71], v4 offset:20480
  v_mul_f32 v16, s18, v16
  v_smfmac_f32_16x16x64_bf16 v[20:23], v[124:127], v[76:83], v0
  ds_read_b128 v[72:75], v4 offset:21504
  v_mul_f32 v17, s18, v17
  v_smfmac_f32_16x16x64_bf16 v[20:23], v[104:107], a[32:39], v0
  ds_read_b128 v[76:79], v4 offset:22528
  v_mul_f32 v18, s18, v18
  v_smfmac_f32_16x16x64_bf16 v[20:23], v[108:111], a[40:47], v0
  ds_read_b128 v[80:83], v4 offset:23552
  v_mul_f32 v19, s18, v19
  v_smfmac_f32_16x16x64_bf16 v[20:23], v[112:115], a[80:87], v0
  v_cvt_pk_bf16_f32 v120, v16, v17
  v_smfmac_f32_16x16x64_bf16 v[20:23], v[84:87], a[88:95], v0
  v_cvt_pk_bf16_f32 v121, v18, v19
  v_smfmac_f32_16x16x64_bf16 v[20:23], v[88:91], a[128:135], v0
  ds_write_b64 v5, v[120:121] offset:24576
  v_smfmac_f32_16x16x64_bf16 v[20:23], v[100:103], a[136:143], v0
  s_waitcnt lgkmcnt(3)
  v_smfmac_f32_16x16x64_bf16 v[24:27], v[92:95], v[68:75], v0
  s_waitcnt lgkmcnt(1)
  v_mov_b64 v[92:93], 0
  v_smfmac_f32_16x16x64_bf16 v[24:27], v[96:99], v[76:83], v0
  s_nop 1
  v_cvt_pk_bf16_f32 v122, v20, v21
  v_cvt_pk_bf16_f32 v123, v22, v23
  v_smfmac_f32_16x16x64_bf16 v[24:27], v[116:119], v[208:215], v0
  ds_write_b64 v5, v[122:123] offset:26880
  v_mov_b64 v[94:95], 0
  v_smfmac_f32_16x16x64_bf16 v[24:27], v[124:127], v[216:223], v0
  s_waitcnt lgkmcnt(1)
  s_barrier
  ds_read_b64_tr_b16 v[68:69], v6 offset:24576
  v_smfmac_f32_16x16x64_bf16 v[24:27], v[104:107], a[48:55], v0
  s_add_u32 s27, s27, 8192
  ds_read_b64_tr_b16 v[70:71], v6 offset:24640
  ds_read_b64_tr_b16 v[72:73], v6 offset:24832
  v_smfmac_f32_16x16x64_bf16 v[24:27], v[108:111], a[56:63], v0
  s_add_u32 s28, s28, 8192
  ds_read_b64_tr_b16 v[74:75], v6 offset:24896
  ds_read_b64_tr_b16 v[76:77], v6 offset:25088
  v_smfmac_f32_16x16x64_bf16 v[24:27], v[112:115], a[96:103], v0
  s_nop 0
  ds_read_b64_tr_b16 v[78:79], v6 offset:25152
  ds_read_b64_tr_b16 v[80:81], v6 offset:25344
  v_smfmac_f32_16x16x64_bf16 v[24:27], v[84:87], a[104:111], v0
  ds_read_b64_tr_b16 v[82:83], v6 offset:25408
  v_mov_b64 v[96:97], 0
  v_smfmac_f32_16x16x64_bf16 v[24:27], v[88:91], a[144:151], v0
  s_waitcnt lgkmcnt(8)
  s_barrier
  ds_read_b64_tr_b16 v[116:117], v6 offset:26880
  v_smfmac_f32_16x16x64_bf16 v[24:27], v[100:103], a[152:159], v0
  s_waitcnt lgkmcnt(7)
  ds_read_b64_tr_b16 v[118:119], v6 offset:26944
  v_mfma_f32_16x16x32_bf16 v[16:19], v[36:39], v[68:71], 0
  s_waitcnt lgkmcnt(6)
  ds_read_b64_tr_b16 v[124:125], v6 offset:27136
  ds_read_b64_tr_b16 v[126:127], v6 offset:27200
  v_mfma_f32_16x16x32_bf16 v[16:19], v[40:43], v[72:75], v[16:19]
  s_waitcnt lgkmcnt(6)
  ds_read_b64_tr_b16 v[104:105], v6 offset:27392
  ds_read_b64_tr_b16 v[106:107], v6 offset:27456
  v_mfma_f32_16x16x32_bf16 v[16:19], v[44:47], v[76:79], v[16:19]
  s_waitcnt lgkmcnt(6)
  ds_read_b64_tr_b16 v[108:109], v6 offset:27648
  ds_read_b64_tr_b16 v[110:111], v6 offset:27712
  v_mfma_f32_16x16x32_bf16 v[16:19], v[48:51], v[80:83], v[16:19]
  s_waitcnt lgkmcnt(6)
  v_cvt_pk_bf16_f32 v120, v24, v25
  v_cvt_pk_bf16_f32 v121, v26, v27
  v_mfma_f32_16x16x32_bf16 v[112:115], v[116:119], v[68:71], 0
  s_waitcnt lgkmcnt(4)
  v_mov_b64 v[98:99], 0
  v_mfma_f32_16x16x32_bf16 v[112:115], v[124:127], v[72:75], v[112:115]
  s_waitcnt lgkmcnt(2)
  v_mov_b64 v[36:37], 0
  v_exp_f32 v100, v16
  v_mfma_f32_16x16x32_bf16 v[112:115], v[104:107], v[76:79], v[112:115]
  s_waitcnt lgkmcnt(0)
  v_exp_f32 v101, v17
  v_mfma_f32_16x16x32_bf16 v[112:115], v[108:111], v[80:83], v[112:115]
  buffer_store_dwordx4 v[120:123], v2, s[4:7], s29 offen offset:3072 sc1
  v_exp_f32 v102, v18
  v_mfma_f32_16x16x32_bf16 v[20:23], v[52:55], v[68:71], 0
  v_exp_f32 v103, v19
  v_mfma_f32_16x16x32_bf16 v[20:23], v[56:59], v[72:75], v[20:23]
  v_cvt_pk_bf16_f32 v44, v100, v101
  v_cvt_pk_bf16_f32 v45, v102, v103
  v_mfma_f32_16x16x32_bf16 v[20:23], v[60:63], v[76:79], v[20:23]
  s_add_u32 s29, s29, 131072
  v_exp_f32 v100, v112
  v_mfma_f32_16x16x32_bf16 v[20:23], v[64:67], v[80:83], v[20:23]
  v_exp_f32 v101, v113
  v_exp_f32 v102, v114
  v_exp_f32 v103, v115
  v_cvt_pk_bf16_f32 v84, v100, v101
  v_cvt_pk_bf16_f32 v85, v102, v103
  v_cndmask_b32 v48, v84, 0, s[16:17]
  v_cndmask_b32 v49, v85, 0, s[16:17]
  v_cndmask_b32 v50, 0, v84, s[16:17]
  v_cndmask_b32 v51, 0, v85, s[16:17]
  v_exp_f32 v100, v20
  v_mfma_f32_16x16x16_bf16 v[88:91], v[12:13], v[48:49], 0
  v_exp_f32 v101, v21
  v_mfma_f32_16x16x16_bf16 v[24:27], v[120:121], v[48:49], 0
  v_exp_f32 v102, v22
  v_mfma_f32_16x16x16_bf16 v[116:119], v[120:121], v[50:51], 0
  v_exp_f32 v103, v23
  v_cvt_pk_bf16_f32 v46, v100, v101
  v_cvt_pk_bf16_f32 v47, v102, v103
  v_mov_b64 v[38:39], 0
  s_nop 0
  v_mfma_f32_16x16x32_bf16 v[88:91], v[12:15], v[44:47], v[88:91]
  v_mov_b64 v[40:41], 0
  v_mov_b64 v[42:43], 0
  v_mfma_f32_16x16x32_bf16 v[24:27], v[28:31], v[44:47], v[24:27]
  ds_read_b128 v[52:55], v4 offset:24576
  ds_read_b128 v[56:59], v4 offset:25600
  v_mfma_f32_16x16x32_bf16 v[116:119], v[32:35], v[44:47], v[116:119]
  s_nop 1
T_back_64:
  v_rcp_f32 v89, v88
  v_subrev_u32 v100, s54, v88
  v_cmp_le_u32 vcc, s96, v100
  v_mul_f32 v24, v89, v24
  v_mul_f32 v25, v89, v25
  v_cvt_pk_bf16_f32 v124, v24, v25
  v_pk_mul_f32 v[26:27], v[26:27], v[88:89] op_sel:[0,1] op_sel_hi:[1,1]
  v_cvt_pk_bf16_f32 v125, v26, v27
  ds_write_b64 v11, v[124:125] offset:30720
  v_pk_mul_f32 v[116:117], v[116:117], v[88:89] op_sel:[0,1] op_sel_hi:[1,1]
  v_pk_mul_f32 v[118:119], v[118:119], v[88:89] op_sel:[0,1] op_sel_hi:[1,1]
  v_cvt_pk_bf16_f32 v126, v116, v117
  v_cvt_pk_bf16_f32 v127, v118, v119
  ds_write_b64 v11, v[126:127] offset:30728
  s_cbranch_vccnz T_slow_63
  v_smfmac_f32_16x16x64_bf16 v[92:95], v[124:127], a[160:167], v0
  s_mov_b32 s96, s55
  v_smfmac_f32_16x16x64_bf16 v[96:99], v[124:127], a[168:175], v0
  s_cmp_eq_u32 s14, 63
  v_smfmac_f32_16x16x64_bf16 v[36:39], v[124:127], a[176:183], v0
  s_waitcnt lgkmcnt(0)
  s_barrier
  ds_read_b128 v[104:107], v11 offset:30208
  ds_read_b128 v[108:111], v11 offset:29696
  ds_read_b128 v[68:71], v11 offset:29184
  s_cbranch_scc1 M_tdone
  v_smfmac_f32_16x16x64_bf16 v[40:43], v[124:127], a[184:191], v0
  s_waitcnt lgkmcnt(2)
  v_smfmac_f32_16x16x64_bf16 v[92:95], v[104:107], a[192:199], v0
  s_waitcnt lgkmcnt(1)
  ds_read_b128 v[76:79], v4 offset:28672
  v_smfmac_f32_16x16x64_bf16 v[92:95], v[108:111], a[224:231], v0
  s_waitcnt lgkmcnt(1)
  ds_read_b128 v[80:83], v4 offset:29696
  v_smfmac_f32_16x16x64_bf16 v[92:95], v[68:71], a[240:247], v0
  ds_read_b128 v[60:63], v4 offset:26624
  v_smfmac_f32_16x16x64_bf16 v[96:99], v[104:107], a[200:207], v0
  ds_read_b128 v[64:67], v4 offset:27648
  v_smfmac_f32_16x16x64_bf16 v[96:99], v[108:111], a[232:239], v0
  ds_read_b128 v[28:31], v4 offset:30720
  s_nop 0
  v_cvt_pk_bf16_f32 v16, v92, v93
  v_cvt_pk_bf16_f32 v17, v94, v95
  v_bfi_b32 v16, 1, s57, v16
  v_smfmac_f32_16x16x64_bf16 v[96:99], v[68:71], a[248:255], v0
  buffer_store_dwordx2 v[16:17], v7, s[4:7], s20 offen offset:0
  v_smfmac_f32_16x16x64_bf16 v[36:39], v[104:107], a[208:215], v0
  ds_read_b128 v[32:35], v4 offset:31744
  v_smfmac_f32_16x16x64_bf16 v[36:39], v[108:111], v[52:59], v0
  s_waitcnt lgkmcnt(4)
  s_nop 0
  v_cvt_pk_bf16_f32 v18, v96, v97
  v_cvt_pk_bf16_f32 v19, v98, v99
  v_bfi_b32 v18, 1, s57, v18
  v_smfmac_f32_16x16x64_bf16 v[36:39], v[68:71], v[76:83], v0
  buffer_store_dwordx2 v[18:19], v7, s[4:7], s20 offen offset:64
  v_smfmac_f32_16x16x64_bf16 v[40:43], v[104:107], a[216:223], v0
  s_waitcnt lgkmcnt(2)
  v_smfmac_f32_16x16x64_bf16 v[40:43], v[108:111], v[60:67], v0
  s_waitcnt lgkmcnt(0)
  s_nop 0
  v_cvt_pk_bf16_f32 v20, v36, v37
  v_cvt_pk_bf16_f32 v21, v38, v39
  v_bfi_b32 v20, 1, s57, v20
  v_smfmac_f32_16x16x64_bf16 v[40:43], v[68:71], v[28:35], v0
  buffer_store_dwordx2 v[20:21], v7, s[4:7], s21 offen offset:0
  s_nop 6
  v_cvt_pk_bf16_f32 v22, v40, v41
  v_cvt_pk_bf16_f32 v23, v42, v43
  v_bfi_b32 v22, 1, s57, v22
  buffer_store_dwordx2 v[22:23], v7, s[4:7], s21 offen offset:64
  ds_read_b128 v[68:71], v4 offset:0
  ds_read_b128 v[72:75], v4 offset:1024
  ds_read_b128 v[76:79], v4 offset:4096
  ds_read_b128 v[80:83], v4 offset:5120
  ds_read_b128 v[84:87], v4 offset:8192
  ds_read_b128 v[88:91], v4 offset:9216
  ds_read_b128 v[92:95], v4 offset:2048
  ds_read_b128 v[96:99], v4 offset:3072
  ds_read_b128 v[100:103], v4 offset:6144
  ds_read_b128 v[104:107], v4 offset:7168
  ds_read_b128 v[108:111], v4 offset:10240
  ds_read_b128 v[112:115], v4 offset:11264
  v_mov_b64 v[16:17], 0
  v_mov_b64 v[18:19], 0
  v_mov_b64 v[20:21], 0
  v_mov_b64 v[22:23], 0
  v_mov_b64 v[24:25], 0
  v_mov_b64 v[26:27], 0
  ds_read_b64 v[44:45], v2 offset:32256
  s_waitcnt lgkmcnt(0)
  v_readfirstlane_b32 s38, v44
  v_readfirstlane_b32 s37, v45
  s_nop 0
  s_lshl_b32 s38, s38, 1
  s_lshl1_add_u32 s37, s37, 1
  s_min_u32 s38, s38, s37
  s_cmp_ge_u32 s38, 64
  s_cselect_b32 s38, 100, s38
  s_sub_u32 s38, s38, 1
  s_max_i32 s30, s30, s38
  s_waitcnt vmcnt(4)
  s_barrier
  ds_read_b128 v[28:31], v2 offset:19456
  ds_read_b128 v[32:35], v2 offset:23552
  ds_read_b128 v[36:39], v2 offset:8192
  ds_read_b128 v[40:43], v2 offset:9216
  ds_read_b128 v[44:47], v2 offset:10240
  ds_read_b128 v[48:51], v2 offset:11264
  buffer_load_dwordx4 v[124:127], v2, s[4:7], s24 offen offset:3072 sc1
  buffer_load_dwordx4 v[116:119], v2, s[4:7], s25 offen offset:3072 sc1
  ds_read_b128 v[52:55], v2 offset:12288
  ds_read_b128 v[56:59], v2 offset:13312
  ds_read_b128 v[60:63], v2 offset:14336
  ds_read_b128 v[64:67], v2 offset:15360
  buffer_load_dwordx4 v[124:127], v2, s[4:7], s24 offen offset:3072 sc1
  buffer_load_dwordx4 v[116:119], v2, s[4:7], s25 offen offset:3072 sc1
  s_add_u32 s14, s14, 1
  s_cmp_ge_i32 s14, s30
  s_cbranch_scc1 T_kvw_60
T_kvb_61:
  s_mov_b32 s19, 0
  s_branch T_loop_56
T_kvw_60:
  s_mov_b32 s19, 0
  s_branch T_kvok_69
T_kv_68:
  s_sleep 4
  s_add_u32 s19, s19, 1
  s_cmp_gt_u32 s19, 32768
  s_cbranch_scc1 M_exit
T_kvok_69:
  s_add_u32 s39, s99, 128
  s_mov_b32 s38, 0
  s_mov_b32 s37, 0
  s_atomic_or s38, s[58:59], s99 glc
  s_atomic_or s37, s[58:59], s39 glc
  s_waitcnt lgkmcnt(0)
  s_lshl_b32 s38, s38, 1
  s_lshl1_add_u32 s37, s37, 1
  s_min_u32 s38, s38, s37
  s_cmp_ge_u32 s38, 64
  s_cselect_b32 s38, 100, s38
  s_sub_u32 s38, s38, 1
  s_max_i32 s30, s30, s38
  s_cmp_ge_i32 s14, s30
  s_cbranch_scc1 T_kv_68
  s_branch T_kvb_61
T_slow_63:
  s_nop 7
  v_max3_f32 v100, v16, v17, v18
  v_max3_f32 v100, v100, v19, v20
  v_max3_f32 v100, v100, v21, v22
  v_max3_f32 v100, v100, v23, v112
  v_max3_f32 v100, v100, v113, v114
  v_max_f32 v100, v100, v115
  v_mov_b32 v101, v100
  s_nop 1
  v_permlane32_swap_b32 v100, v101
  s_nop 1
  v_max_f32 v100, v100, v101
  v_mov_b32 v101, v100
  s_nop 1
  v_permlane16_swap_b32 v100, v101
  s_nop 1
  v_max_f32 v100, v100, v101
  v_sub_f32 v16, v16, v100
  v_sub_f32 v17, v17, v100
  v_sub_f32 v18, v18, v100
  v_sub_f32 v19, v19, v100
  v_exp_f32 v16, v16
  v_exp_f32 v17, v17
  v_exp_f32 v18, v18
  v_exp_f32 v19, v19
  v_sub_f32 v20, v20, v100
  v_sub_f32 v21, v21, v100
  v_sub_f32 v22, v22, v100
  v_sub_f32 v23, v23, v100
  v_exp_f32 v20, v20
  v_exp_f32 v21, v21
  v_exp_f32 v22, v22
  v_exp_f32 v23, v23
  v_sub_f32 v112, v112, v100
  v_sub_f32 v113, v113, v100
  v_sub_f32 v114, v114, v100
  v_sub_f32 v115, v115, v100
  v_exp_f32 v112, v112
  v_exp_f32 v113, v113
  v_exp_f32 v114, v114
  v_exp_f32 v115, v115
  s_nop 0
  v_cvt_pk_bf16_f32 v44, v16, v17
  v_cvt_pk_bf16_f32 v45, v18, v19
  v_cvt_pk_bf16_f32 v46, v20, v21
  v_cvt_pk_bf16_f32 v47, v22, v23
  v_cvt_pk_bf16_f32 v84, v112, v113
  v_cvt_pk_bf16_f32 v85, v114, v115
  v_cndmask_b32 v48, v84, 0, s[16:17]
  v_cndmask_b32 v49, v85, 0, s[16:17]
  v_cndmask_b32 v50, 0, v84, s[16:17]
  v_cndmask_b32 v51, 0, v85, s[16:17]
  s_nop 1
  v_mfma_f32_16x16x16_bf16 v[88:91], v[12:13], v[48:49], 0
  v_mfma_f32_16x16x16_bf16 v[24:27], v[120:121], v[48:49], 0
  v_mfma_f32_16x16x16_bf16 v[116:119], v[120:121], v[50:51], 0
  v_mfma_f32_16x16x32_bf16 v[88:91], v[12:15], v[44:47], v[88:91]
  v_mfma_f32_16x16x32_bf16 v[24:27], v[28:31], v[44:47], v[24:27]
  v_mfma_f32_16x16x32_bf16 v[116:119], v[32:35], v[44:47], v[116:119]
  s_nop 7
  s_nop 1
  s_mov_b32 s96, -1
  s_branch T_back_64
M_global:
  s_cmp_eq_u32 s13, 1
  s_cbranch_scc1 T_w_71
  s_cmp_eq_u32 s13, 2
  s_cbranch_scc1 T_w_72
  s_cmp_eq_u32 s13, 3
  s_cbranch_scc1 T_w_73
T_w_70:
  s_mov_b32 s19, 0
  s_add_u32 s14, s14, 1
  v_mov_b64 v[16:17], 0
  v_mov_b64 v[18:19], 0
  v_mov_b64 v[20:21], 0
  v_mov_b64 v[22:23], 0
  v_mov_b64 v[24:25], 0
  v_mov_b64 v[26:27], 0
  buffer_load_dwordx4 v[124:127], v2, s[4:7], s24 offen offset:0 sc1
  buffer_load_dwordx4 v[116:119], v2, s[4:7], s25 offen offset:0 sc1
  buffer_load_dwordx4 v[124:127], v2, s[4:7], s24 offen offset:0 sc1
  buffer_load_dwordx4 v[116:119], v2, s[4:7], s25 offen offset:0 sc1
  s_branch T_loop_74
.p2align 6
T_retry_75:
  s_mov_b64 exec, vcc
  buffer_load_dwordx4 v[124:127], v2, s[4:7], s24 offen offset:0 sc1
  buffer_load_dwordx4 v[116:119], v2, s[4:7], s25 offen offset:0 sc1
  s_mov_b64 exec, -1
  s_add_u32 s19, s19, 1
  s_cmp_gt_u32 s19, 32768
  s_cbranch_scc1 M_exit
  s_nop 0
  v_mov_b64 v[16:17], 0
  v_mov_b64 v[18:19], 0
T_loop_74:
  s_waitcnt vmcnt(3) lgkmcnt(0)
  v_max3_u32 v123, v124, v125, v126
  v_max_u32 v123, v123, v127
  v_mov_b32_dpp v120, v124 row_ror:8 row_mask:0xf bank_mask:0xf
  v_mov_b32_dpp v121, v125 row_ror:8 row_mask:0xf bank_mask:0xf
  s_waitcnt vmcnt(2)
  v_max3_u32 v123, v123, v116, v117
  v_max3_u32 v123, v123, v118, v119
  v_cmp_eq_u32 vcc, -1, v123
  v_smfmac_f32_16x16x64_bf16 v[16:19], v[124:127], v[68:75], v0
  s_cbranch_vccnz T_retry_75
  ds_write_b128 v2, v[124:127] offset:0
  v_mov_b32_dpp v122, v126 row_ror:8 row_mask:0xf bank_mask:0xf
  v_smfmac_f32_16x16x64_bf16 v[20:23], v[124:127], v[76:83], v0
  s_and_b32 s57, s14, 1
  v_mov_b32_dpp v123, v127 row_ror:8 row_mask:0xf bank_mask:0xf
  v_smfmac_f32_16x16x64_bf16 v[24:27], v[124:127], v[84:91], v0
  s_and_b32 s36, s14, 3
  ds_write_b128 v2, v[116:119] offset:4096
  v_smfmac_f32_16x16x64_bf16 v[16:19], v[120:123], v[92:99], v0
  s_lshl_b32 s36, s36, 13
  v_mov_b32_dpp v84, v116 row_ror:8 row_mask:0xf bank_mask:0xf
  v_smfmac_f32_16x16x64_bf16 v[20:23], v[120:123], v[100:107], v0
  s_add_u32 s26, s36, s23
  ds_read_b128 v[68:71], v4 offset:12288
  v_mov_b32_dpp v85, v117 row_ror:8 row_mask:0xf bank_mask:0xf
  v_smfmac_f32_16x16x64_bf16 v[24:27], v[120:123], v[108:115], v0
  s_add_u32 s36, s36, 8192
  ds_read_b128 v[72:75], v4 offset:13312
  v_mov_b32_dpp v86, v118 row_ror:8 row_mask:0xf bank_mask:0xf
  v_smfmac_f32_16x16x64_bf16 v[16:19], v[116:119], v[224:231], v0
  s_and_b32 s36, s36, 0x7fff
  ds_read_b128 v[76:79], v4 offset:14336
  v_mov_b32_dpp v87, v119 row_ror:8 row_mask:0xf bank_mask:0xf
  v_smfmac_f32_16x16x64_bf16 v[20:23], v[116:119], v[240:247], v0
  s_waitcnt lgkmcnt(3)
  s_barrier
  ds_read_b128 v[100:103], v2 offset:1024
  v_smfmac_f32_16x16x64_bf16 v[24:27], v[116:119], a[0:7], v0
  s_mov_b32 m0, s31
  ds_read_b128 v[120:123], v1 offset:1024
  v_smfmac_f32_16x16x64_bf16 v[16:19], v[84:87], v[232:239], v0
  v_smfmac_f32_16x16x64_bf16 v[20:23], v[84:87], v[248:255], v0
  ds_read_b128 v[80:83], v4 offset:15360
  buffer_load_dwordx4 v9, s[4:7], s27 offen sc1 lds
  v_smfmac_f32_16x16x64_bf16 v[24:27], v[84:87], a[8:15], v0
  s_waitcnt lgkmcnt(2)
  s_mov_b32 m0, s32
  v_smfmac_f32_16x16x64_bf16 v[16:19], v[100:103], v[128:135], v0
  ds_read_b128 v[92:95], v2 offset:2048
  v_smfmac_f32_16x16x64_bf16 v[20:23], v[100:103], v[144:151], v0
  ds_read_b128 v[96:99], v1 offset:2048
  v_smfmac_f32_16x16x64_bf16 v[24:27], v[100:103], v[68:75], v0
  s_waitcnt vmcnt(1) lgkmcnt(3)
  ds_read_b128 v[116:119], v2 offset:3072
  buffer_load_dwordx4 v9, s[4:7], s27 offen offset:128 sc1 lds
  v_smfmac_f32_16x16x64_bf16 v[16:19], v[120:123], v[136:143], v0
  ds_read_b128 v[124:127], v1 offset:3072
  s_mov_b32 m0, s33
  v_smfmac_f32_16x16x64_bf16 v[20:23], v[120:123], v[152:159], v0
  s_waitcnt lgkmcnt(4)
  ds_read_b128 v[104:107], v2 offset:5120
  v_smfmac_f32_16x16x64_bf16 v[24:27], v[120:123], v[76:83], v0
  s_waitcnt lgkmcnt(4)
  ds_read_b128 v[108:111], v1 offset:5120
  v_smfmac_f32_16x16x64_bf16 v[16:19], v[92:95], v[160:167], v0
  s_waitcnt lgkmcnt(4)
  ds_read_b128 v[112:115], v2 offset:6144
  buffer_load_dwordx4 v10, s[4:7], s28 offen sc1 lds
  v_smfmac_f32_16x16x64_bf16 v[16:19], v[96:99], v[168:175], v0
  s_waitcnt lgkmcnt(4)
  ds_read_b128 v[84:87], v1 offset:6144
  s_mov_b32 m0, s34
  v_smfmac_f32_16x16x64_bf16 v[16:19], v[116:119], v[192:199], v0
  s_waitcnt lgkmcnt(4)
  ds_read_b128 v[88:91], v2 offset:7168
  v_smfmac_f32_16x16x64_bf16 v[16:19], v[124:127], v[200:207], v0
  s_waitcnt lgkmcnt(4)
  ds_read_b128 v[100:103], v1 offset:7168
  v_smfmac_f32_16x16x64_bf16 v[16:19], v[104:107], a[16:23], v0
  s_waitcnt lgkmcnt(4)
  ds_read_b128 v[68:71], v4 offset:16384
  buffer_load_dwordx4 v10, s[4:7], s28 offen offset:256 sc1 lds
  v_smfmac_f32_16x16x64_bf16 v[16:19], v[108:111], a[24:31], v0
  s_waitcnt lgkmcnt(4)
  ds_read_b128 v[72:75], v4 offset:17408
  v_smfmac_f32_16x16x64_bf16 v[16:19], v[112:115], a[64:71], v0
  s_waitcnt lgkmcnt(4)
  ds_read_b128 v[76:79], v4 offset:18432
  v_smfmac_f32_16x16x64_bf16 v[16:19], v[84:87], a[72:79], v0
  s_waitcnt lgkmcnt(4)
  ds_read_b128 v[80:83], v4 offset:19456
  v_smfmac_f32_16x16x64_bf16 v[16:19], v[88:91], a[112:119], v0
  s_waitcnt lgkmcnt(4)
  v_smfmac_f32_16x16x64_bf16 v[16:19], v[100:103], a[120:127], v0
  s_add_u32 s24, s36, 145752064
  s_add_u32 s25, s36, 145756160
  v_smfmac_f32_16x16x64_bf16 v[20:23], v[92:95], v[176:183], v0
  s_add_u32 s35, s36, s23
  v_smfmac_f32_16x16x64_bf16 v[20:23], v[96:99], v[184:191], v0
  s_waitcnt lgkmcnt(2)
  v_smfmac_f32_16x16x64_bf16 v[20:23], v[116:119], v[68:75], v0
  s_waitcnt lgkmcnt(0)
  ds_read_b128 v[68:71], v4 offset:20480
  v_mul_f32 v16, s18, v16
  v_smfmac_f32_16x16x64_bf16 v[20:23], v[124:127], v[76:83], v0
  ds_read_b128 v[72:75], v4 offset:21504
  v_mul_f32 v17, s18, v17
  v_smfmac_f32_16x16x64_bf16 v[20:23], v[104:107], a[32:39], v0
  ds_read_b128 v[76:79], v4 offset:22528
  v_mul_f32 v18, s18, v18
  v_smfmac_f32_16x16x64_bf16 v[20:23], v[108:111], a[40:47], v0
  ds_read_b128 v[80:83], v4 offset:23552
  v_mul_f32 v19, s18, v19
  v_smfmac_f32_16x16x64_bf16 v[20:23], v[112:115], a[80:87], v0
  v_cvt_pk_bf16_f32 v120, v16, v17
  v_smfmac_f32_16x16x64_bf16 v[20:23], v[84:87], a[88:95], v0
  v_cvt_pk_bf16_f32 v121, v18, v19
  v_smfmac_f32_16x16x64_bf16 v[20:23], v[88:91], a[128:135], v0
  ds_write_b64 v5, v[120:121] offset:24576
  v_smfmac_f32_16x16x64_bf16 v[20:23], v[100:103], a[136:143], v0
  s_waitcnt lgkmcnt(3)
  v_smfmac_f32_16x16x64_bf16 v[24:27], v[92:95], v[68:75], v0
  s_waitcnt lgkmcnt(1)
  v_mov_b64 v[92:93], 0
  v_smfmac_f32_16x16x64_bf16 v[24:27], v[96:99], v[76:83], v0
  s_nop 1
  v_cvt_pk_bf16_f32 v122, v20, v21
  v_cvt_pk_bf16_f32 v123, v22, v23
  v_smfmac_f32_16x16x64_bf16 v[24:27], v[116:119], v[208:215], v0
  ds_write_b64 v5, v[122:123] offset:26880
  v_mov_b64 v[94:95], 0
  v_smfmac_f32_16x16x64_bf16 v[24:27], v[124:127], v[216:223], v0
  s_waitcnt lgkmcnt(1)
  s_barrier
  ds_read_b64_tr_b16 v[68:69], v6 offset:24576
  v_smfmac_f32_16x16x64_bf16 v[24:27], v[104:107], a[48:55], v0
  s_add_u32 s27, s27, 8192
  ds_read_b64_tr_b16 v[70:71], v6 offset:24640
  ds_read_b64_tr_b16 v[72:73], v6 offset:24832
  v_smfmac_f32_16x16x64_bf16 v[24:27], v[108:111], a[56:63], v0
  s_add_u32 s28, s28, 8192
  ds_read_b64_tr_b16 v[74:75], v6 offset:24896
  ds_read_b64_tr_b16 v[76:77], v6 offset:25088
  v_smfmac_f32_16x16x64_bf16 v[24:27], v[112:115], a[96:103], v0
  s_nop 0
  ds_read_b64_tr_b16 v[78:79], v6 offset:25152
  ds_read_b64_tr_b16 v[80:81], v6 offset:25344
  v_smfmac_f32_16x16x64_bf16 v[24:27], v[84:87], a[104:111], v0
  ds_read_b64_tr_b16 v[82:83], v6 offset:25408
  v_mov_b64 v[96:97], 0
  v_smfmac_f32_16x16x64_bf16 v[24:27], v[88:91], a[144:151], v0
  s_waitcnt lgkmcnt(8)
  s_barrier
  ds_read_b64_tr_b16 v[116:117], v6 offset:26880
  v_smfmac_f32_16x16x64_bf16 v[24:27], v[100:103], a[152:159], v0
  s_waitcnt lgkmcnt(7)
  ds_read_b64_tr_b16 v[118:119], v6 offset:26944
  v_mfma_f32_16x16x32_bf16 v[16:19], v[36:39], v[68:71], 0
  s_waitcnt lgkmcnt(6)
  ds_read_b64_tr_b16 v[124:125], v6 offset:27136
  ds_read_b64_tr_b16 v[126:127], v6 offset:27200
  v_mfma_f32_16x16x32_bf16 v[16:19], v[40:43], v[72:75], v[16:19]
  s_waitcnt lgkmcnt(6)
  ds_read_b64_tr_b16 v[104:105], v6 offset:27392
  ds_read_b64_tr_b16 v[106:107], v6 offset:27456
  v_mfma_f32_16x16x32_bf16 v[16:19], v[44:47], v[76:79], v[16:19]
  s_waitcnt lgkmcnt(6)
  ds_read_b64_tr_b16 v[108:109], v6 offset:27648
  ds_read_b64_tr_b16 v[110:111], v6 offset:27712
  v_mfma_f32_16x16x32_bf16 v[16:19], v[48:51], v[80:83], v[16:19]
  s_waitcnt lgkmcnt(6)
  v_cvt_pk_bf16_f32 v120, v24, v25
  v_cvt_pk_bf16_f32 v121, v26, v27
  v_mfma_f32_16x16x32_bf16 v[112:115], v[116:119], v[68:71], 0
  s_waitcnt lgkmcnt(4)
  buffer_store_dwordx4 v[120:123], v2, s[4:7], s29 offen offset:0 sc1
  v_mov_b64 v[98:99], 0
  v_mfma_f32_16x16x32_bf16 v[112:115], v[124:127], v[72:75], v[112:115]
  s_waitcnt lgkmcnt(2)
  v_mov_b64 v[36:37], 0
  v_exp_f32 v100, v16
  v_mfma_f32_16x16x32_bf16 v[112:115], v[104:107], v[76:79], v[112:115]
  s_waitcnt lgkmcnt(0)
  v_exp_f32 v101, v17
  v_mfma_f32_16x16x32_bf16 v[112:115], v[108:111], v[80:83], v[112:115]
  v_exp_f32 v102, v18
  v_mfma_f32_16x16x32_bf16 v[20:23], v[52:55], v[68:71], 0
  v_exp_f32 v103, v19
  v_mfma_f32_16x16x32_bf16 v[20:23], v[56:59], v[72:75], v[20:23]
  v_cvt_pk_bf16_f32 v44, v100, v101
  v_cvt_pk_bf16_f32 v45, v102, v103
  v_mfma_f32_16x16x32_bf16 v[20:23], v[60:63], v[76:79], v[20:23]
  s_add_u32 s29, s29, 131072
  v_exp_f32 v100, v112
  v_mfma_f32_16x16x32_bf16 v[20:23], v[64:67], v[80:83], v[20:23]
  v_exp_f32 v101, v113
  v_exp_f32 v102, v114
  v_exp_f32 v103, v115
  v_cvt_pk_bf16_f32 v84, v100, v101
  v_cvt_pk_bf16_f32 v85, v102, v103
  v_cndmask_b32 v48, v84, 0, s[16:17]
  v_cndmask_b32 v49, v85, 0, s[16:17]
  v_cndmask_b32 v50, 0, v84, s[16:17]
  v_cndmask_b32 v51, 0, v85, s[16:17]
  v_exp_f32 v100, v20
  v_mfma_f32_16x16x16_bf16 v[88:91], v[12:13], v[48:49], 0
  v_exp_f32 v101, v21
  v_mfma_f32_16x16x16_bf16 v[24:27], v[120:121], v[48:49], 0
  v_exp_f32 v102, v22
  v_mfma_f32_16x16x16_bf16 v[116:119], v[120:121], v[50:51], 0
  v_exp_f32 v103, v23
  v_cvt_pk_bf16_f32 v46, v100, v101
  v_cvt_pk_bf16_f32 v47, v102, v103
  v_mov_b64 v[38:39], 0
  s_nop 0
  v_mfma_f32_16x16x32_bf16 v[88:91], v[12:15], v[44:47], v[88:91]
  v_mov_b64 v[40:41], 0
  v_mov_b64 v[42:43], 0
  v_mfma_f32_16x16x32_bf16 v[24:27], v[28:31], v[44:47], v[24:27]
  ds_read_b128 v[52:55], v4 offset:24576
  ds_read_b128 v[56:59], v4 offset:25600
  v_mfma_f32_16x16x32_bf16 v[116:119], v[32:35], v[44:47], v[116:119]
  s_nop 1
T_back_82:
  v_rcp_f32 v89, v88
  v_subrev_u32 v100, s54, v88
  v_cmp_le_u32 vcc, s96, v100
  v_mul_f32 v24, v89, v24
  v_mul_f32 v25, v89, v25
  v_cvt_pk_bf16_f32 v124, v24, v25
  v_pk_mul_f32 v[26:27], v[26:27], v[88:89] op_sel:[0,1] op_sel_hi:[1,1]
  v_cvt_pk_bf16_f32 v125, v26, v27
  ds_write_b64 v11, v[124:125] offset:29184
  v_pk_mul_f32 v[116:117], v[116:117], v[88:89] op_sel:[0,1] op_sel_hi:[1,1]
  v_pk_mul_f32 v[118:119], v[118:119], v[88:89] op_sel:[0,1] op_sel_hi:[1,1]
  v_cvt_pk_bf16_f32 v126, v116, v117
  v_cvt_pk_bf16_f32 v127, v118, v119
  ds_write_b64 v11, v[126:127] offset:29192
  s_cbranch_vccnz T_slow_81
  v_smfmac_f32_16x16x64_bf16 v[92:95], v[124:127], a[160:167], v0
  s_mov_b32 s96, s55
  v_smfmac_f32_16x16x64_bf16 v[96:99], v[124:127], a[168:175], v0
  s_cmp_eq_u32 s14, 63
  v_smfmac_f32_16x16x64_bf16 v[36:39], v[124:127], a[176:183], v0
  s_waitcnt lgkmcnt(0)
  s_barrier
  ds_read_b128 v[104:107], v11 offset:29696
  ds_read_b128 v[108:111], v11 offset:30208
  ds_read_b128 v[68:71], v11 offset:30720
  s_cbranch_scc1 M_tdone
  v_smfmac_f32_16x16x64_bf16 v[40:43], v[124:127], a[184:191], v0
  s_waitcnt lgkmcnt(2)
  v_smfmac_f32_16x16x64_bf16 v[92:95], v[104:107], a[192:199], v0
  s_waitcnt lgkmcnt(1)
  ds_read_b128 v[76:79], v4 offset:28672
  v_smfmac_f32_16x16x64_bf16 v[92:95], v[108:111], a[224:231], v0
  s_waitcnt lgkmcnt(1)
  ds_read_b128 v[80:83], v4 offset:29696
  v_smfmac_f32_16x16x64_bf16 v[92:95], v[68:71], a[240:247], v0
  ds_read_b128 v[60:63], v4 offset:26624
  v_smfmac_f32_16x16x64_bf16 v[96:99], v[104:107], a[200:207], v0
  ds_read_b128 v[64:67], v4 offset:27648
  v_smfmac_f32_16x16x64_bf16 v[96:99], v[108:111], a[232:239], v0
  ds_read_b128 v[28:31], v4 offset:30720
  s_nop 0
  v_cvt_pk_bf16_f32 v16, v92, v93
  v_cvt_pk_bf16_f32 v17, v94, v95
  v_bfi_b32 v16, 1, s57, v16
  v_smfmac_f32_16x16x64_bf16 v[96:99], v[68:71], a[248:255], v0
  buffer_store_dwordx2 v[16:17], v7, s[4:7], s20 offen offset:0 sc1
  v_smfmac_f32_16x16x64_bf16 v[36:39], v[104:107], a[208:215], v0
  ds_read_b128 v[32:35], v4 offset:31744
  v_smfmac_f32_16x16x64_bf16 v[36:39], v[108:111], v[52:59], v0
  s_waitcnt lgkmcnt(4)
  s_nop 0
  v_cvt_pk_bf16_f32 v18, v96, v97
  v_cvt_pk_bf16_f32 v19, v98, v99
  v_bfi_b32 v18, 1, s57, v18
  v_smfmac_f32_16x16x64_bf16 v[36:39], v[68:71], v[76:83], v0
  buffer_store_dwordx2 v[18:19], v7, s[4:7], s20 offen offset:64 sc1
  v_smfmac_f32_16x16x64_bf16 v[40:43], v[104:107], a[216:223], v0
  s_waitcnt lgkmcnt(2)
  ds_read_b128 v[116:119], v2 offset:31232
  v_smfmac_f32_16x16x64_bf16 v[40:43], v[108:111], v[60:67], v0
  s_waitcnt lgkmcnt(1)
  s_nop 0
  v_cvt_pk_bf16_f32 v20, v36, v37
  v_cvt_pk_bf16_f32 v21, v38, v39
  v_bfi_b32 v20, 1, s57, v20
  v_smfmac_f32_16x16x64_bf16 v[40:43], v[68:71], v[28:35], v0
  buffer_store_dwordx2 v[20:21], v7, s[4:7], s21 offen offset:0 sc1
  s_nop 6
  v_cvt_pk_bf16_f32 v22, v40, v41
  v_cvt_pk_bf16_f32 v23, v42, v43
  v_bfi_b32 v22, 1, s57, v22
  buffer_store_dwordx2 v[22:23], v7, s[4:7], s21 offen offset:64 sc1
  ds_read_b128 v[68:71], v4 offset:0
  ds_read_b128 v[72:75], v4 offset:1024
  ds_read_b128 v[76:79], v4 offset:4096
  ds_read_b128 v[80:83], v4 offset:5120
  ds_read_b128 v[84:87], v4 offset:8192
  ds_read_b128 v[88:91], v4 offset:9216
  v_mov_b64 v[16:17], 0
  v_mov_b64 v[18:19], 0
  v_mov_b64 v[20:21], 0
  v_mov_b64 v[22:23], 0
  v_mov_b64 v[24:25], 0
  v_mov_b64 v[26:27], 0
  s_mov_b32 s19, 0
  v_mov_b32 v49, -1
  s_waitcnt vmcnt(2)
  buffer_load_dwordx4 v[52:55], v2, s[4:7], s22 offen offset:0 sc1
  buffer_load_dwordx4 v[56:59], v2, s[4:7], s22 offen offset:1024 sc1
  buffer_load_dwordx4 v[60:63], v2, s[4:7], s22 offen offset:2048 sc1
  buffer_load_dwordx4 v[64:67], v2, s[4:7], s22 offen offset:3072 sc1
  ds_read_b128 v[92:95], v4 offset:2048
  ds_read_b128 v[96:99], v4 offset:3072
  ds_read_b128 v[100:103], v4 offset:6144
  ds_read_b128 v[104:107], v4 offset:7168
  ds_read_b128 v[108:111], v4 offset:10240
  ds_read_b128 v[112:115], v4 offset:11264
  ds_read_b64 v[44:45], v2 offset:32256
  s_waitcnt lgkmcnt(0)
  v_readfirstlane_b32 s38, v44
  v_readfirstlane_b32 s37, v45
  s_nop 0
  s_lshl_b32 s38, s38, 1
  s_lshl1_add_u32 s37, s37, 1
  s_min_u32 s38, s38, s37
  s_cmp_ge_u32 s38, 64
  s_cselect_b32 s38, 100, s38
  s_sub_u32 s38, s38, 1
  s_max_i32 s30, s30, s38
  s_waitcnt lgkmcnt(12)
  s_waitcnt vmcnt(3)
  v_mfma_f32_16x16x32_bf16 v[120:123], v[116:119], v[52:55], 0
  v_xor_b32 v48, s57, v52
  v_bitop3_b32 v48, v48, v54, s57 bitop3:0xf6
  s_waitcnt vmcnt(2)
  v_mfma_f32_16x16x32_bf16 v[120:123], v[116:119], v[56:59], v[120:123]
  v_bitop3_b32 v48, v48, v56, s57 bitop3:0xf6
  v_bitop3_b32 v48, v48, v58, s57 bitop3:0xf6
  s_waitcnt vmcnt(1)
  v_mfma_f32_16x16x32_bf16 v[120:123], v[116:119], v[60:63], v[120:123]
  v_bitop3_b32 v48, v48, v60, s57 bitop3:0xf6
  v_bitop3_b32 v48, v48, v62, s57 bitop3:0xf6
  s_waitcnt vmcnt(0)
  v_mfma_f32_16x16x32_bf16 v[120:123], v[116:119], v[64:67], v[120:123]
  v_bitop3_b32 v48, v48, v64, s57 bitop3:0xf6
  v_bitop3_b32 v48, v48, v66, s57 bitop3:0xf6
  v_and_b32 v48, 1, v48
  v_cmp_ne_u32 vcc, 0, v48
  s_cbranch_vccnz T_p1re_84
T_p1ok_85:
  s_nop 2
  v_add_f32_dpp v120, v120, v120 row_ror:8 row_mask:0xf bank_mask:0xf
  v_add_f32_dpp v121, v121, v121 row_ror:8 row_mask:0xf bank_mask:0xf
  v_cvt_pk_bf16_f32 v48, v120, v121
  buffer_store_dword v48, v8, s[4:7], s35 offen sc1
  buffer_store_dword v49, v8, s[4:7], s26 offen sc1
  s_barrier
  ds_read_b128 v[28:31], v2 offset:16384
  ds_read_b128 v[32:35], v2 offset:20480
  ds_read_b128 v[36:39], v2 offset:8192
  ds_read_b128 v[40:43], v2 offset:9216
  ds_read_b128 v[44:47], v2 offset:10240
  ds_read_b128 v[48:51], v2 offset:11264
  buffer_load_dwordx4 v[124:127], v2, s[4:7], s24 offen offset:0 sc1
  buffer_load_dwordx4 v[116:119], v2, s[4:7], s25 offen offset:0 sc1
  ds_read_b128 v[52:55], v2 offset:12288
  ds_read_b128 v[56:59], v2 offset:13312
  ds_read_b128 v[60:63], v2 offset:14336
  ds_read_b128 v[64:67], v2 offset:15360
  buffer_load_dwordx4 v[124:127], v2, s[4:7], s24 offen offset:0 sc1
  buffer_load_dwordx4 v[116:119], v2, s[4:7], s25 offen offset:0 sc1
  s_add_u32 s14, s14, 1
  s_cmp_ge_i32 s14, s30
  s_cbranch_scc1 T_kvw_78
T_kvb_79:
  s_mov_b32 s19, 0
  s_branch T_loop_74
T_p1re_84:
  s_mov_b64 exec, vcc
  buffer_load_dwordx4 v[52:55], v2, s[4:7], s22 offen offset:0 sc1
  buffer_load_dwordx4 v[56:59], v2, s[4:7], s22 offen offset:1024 sc1
  buffer_load_dwordx4 v[60:63], v2, s[4:7], s22 offen offset:2048 sc1
  buffer_load_dwordx4 v[64:67], v2, s[4:7], s22 offen offset:3072 sc1
  s_mov_b64 exec, -1
  s_add_u32 s19, s19, 1
  s_cmp_gt_u32 s19, 32768
  s_cbranch_scc1 M_exit
  s_waitcnt vmcnt(3)
  v_mfma_f32_16x16x32_bf16 v[120:123], v[116:119], v[52:55], 0
  v_xor_b32 v48, s57, v52
  v_bitop3_b32 v48, v48, v54, s57 bitop3:0xf6
  s_waitcnt vmcnt(2)
  v_mfma_f32_16x16x32_bf16 v[120:123], v[116:119], v[56:59], v[120:123]
  v_bitop3_b32 v48, v48, v56, s57 bitop3:0xf6
  v_bitop3_b32 v48, v48, v58, s57 bitop3:0xf6
  s_waitcnt vmcnt(1)
  v_mfma_f32_16x16x32_bf16 v[120:123], v[116:119], v[60:63], v[120:123]
  v_bitop3_b32 v48, v48, v60, s57 bitop3:0xf6
  v_bitop3_b32 v48, v48, v62, s57 bitop3:0xf6
  s_waitcnt vmcnt(0)
  v_mfma_f32_16x16x32_bf16 v[120:123], v[116:119], v[64:67], v[120:123]
  v_bitop3_b32 v48, v48, v64, s57 bitop3:0xf6
  v_bitop3_b32 v48, v48, v66, s57 bitop3:0xf6
  v_and_b32 v48, 1, v48
  v_cmp_ne_u32 vcc, 0, v48
  s_cbranch_vccnz T_p1re_84
  s_branch T_p1ok_85
T_kvw_78:
  s_mov_b32 s19, 0
  s_branch T_kvok_87
T_kv_86:
  s_sleep 4
  s_add_u32 s19, s19, 1
  s_cmp_gt_u32 s19, 32768
  s_cbranch_scc1 M_exit
T_kvok_87:
  s_add_u32 s39, s99, 128
  s_mov_b32 s38, 0
  s_mov_b32 s37, 0
  s_atomic_or s38, s[58:59], s99 glc
  s_atomic_or s37, s[58:59], s39 glc
  s_waitcnt lgkmcnt(0)
  s_lshl_b32 s38, s38, 1
  s_lshl1_add_u32 s37, s37, 1
  s_min_u32 s38, s38, s37
  s_cmp_ge_u32 s38, 64
  s_cselect_b32 s38, 100, s38
  s_sub_u32 s38, s38, 1
  s_max_i32 s30, s30, s38
  s_cmp_ge_i32 s14, s30
  s_cbranch_scc1 T_kv_86
  s_branch T_kvb_79
T_slow_81:
  s_nop 7
  v_max3_f32 v100, v16, v17, v18
  v_max3_f32 v100, v100, v19, v20
  v_max3_f32 v100, v100, v21, v22
  v_max3_f32 v100, v100, v23, v112
  v_max3_f32 v100, v100, v113, v114
  v_max_f32 v100, v100, v115
  v_mov_b32 v101, v100
  s_nop 1
  v_permlane32_swap_b32 v100, v101
  s_nop 1
  v_max_f32 v100, v100, v101
  v_mov_b32 v101, v100
  s_nop 1
  v_permlane16_swap_b32 v100, v101
  s_nop 1
  v_max_f32 v100, v100, v101
  v_sub_f32 v16, v16, v100
  v_sub_f32 v17, v17, v100
  v_sub_f32 v18, v18, v100
  v_sub_f32 v19, v19, v100
  v_exp_f32 v16, v16
  v_exp_f32 v17, v17
  v_exp_f32 v18, v18
  v_exp_f32 v19, v19
  v_sub_f32 v20, v20, v100
  v_sub_f32 v21, v21, v100
  v_sub_f32 v22, v22, v100
  v_sub_f32 v23, v23, v100
  v_exp_f32 v20, v20
  v_exp_f32 v21, v21
  v_exp_f32 v22, v22
  v_exp_f32 v23, v23
  v_sub_f32 v112, v112, v100
  v_sub_f32 v113, v113, v100
  v_sub_f32 v114, v114, v100
  v_sub_f32 v115, v115, v100
  v_exp_f32 v112, v112
  v_exp_f32 v113, v113
  v_exp_f32 v114, v114
  v_exp_f32 v115, v115
  s_nop 0
  v_cvt_pk_bf16_f32 v44, v16, v17
  v_cvt_pk_bf16_f32 v45, v18, v19
  v_cvt_pk_bf16_f32 v46, v20, v21
  v_cvt_pk_bf16_f32 v47, v22, v23
  v_cvt_pk_bf16_f32 v84, v112, v113
  v_cvt_pk_bf16_f32 v85, v114, v115
  v_cndmask_b32 v48, v84, 0, s[16:17]
  v_cndmask_b32 v49, v85, 0, s[16:17]
  v_cndmask_b32 v50, 0, v84, s[16:17]
  v_cndmask_b32 v51, 0, v85, s[16:17]
  s_nop 1
  v_mfma_f32_16x16x16_bf16 v[88:91], v[12:13], v[48:49], 0
  v_mfma_f32_16x16x16_bf16 v[24:27], v[120:121], v[48:49], 0
  v_mfma_f32_16x16x16_bf16 v[116:119], v[120:121], v[50:51], 0
  v_mfma_f32_16x16x32_bf16 v[88:91], v[12:15], v[44:47], v[88:91]
  v_mfma_f32_16x16x32_bf16 v[24:27], v[28:31], v[44:47], v[24:27]
  v_mfma_f32_16x16x32_bf16 v[116:119], v[32:35], v[44:47], v[116:119]
  s_nop 7
  s_nop 1
  s_mov_b32 s96, -1
  s_branch T_back_82
T_w_71:
  s_mov_b32 s19, 0
  s_add_u32 s14, s14, 1
  v_mov_b64 v[16:17], 0
  v_mov_b64 v[18:19], 0
  v_mov_b64 v[20:21], 0
  v_mov_b64 v[22:23], 0
  v_mov_b64 v[24:25], 0
  v_mov_b64 v[26:27], 0
  buffer_load_dwordx4 v[124:127], v2, s[4:7], s24 offen offset:1024 sc1
  buffer_load_dwordx4 v[116:119], v2, s[4:7], s25 offen offset:1024 sc1
  buffer_load_dwordx4 v[124:127], v2, s[4:7], s24 offen offset:1024 sc1
  buffer_load_dwordx4 v[116:119], v2, s[4:7], s25 offen offset:1024 sc1
  s_branch T_loop_88
.p2align 6
T_retry_89:
  s_mov_b64 exec, vcc
  buffer_load_dwordx4 v[124:127], v2, s[4:7], s24 offen offset:1024 sc1
  buffer_load_dwordx4 v[116:119], v2, s[4:7], s25 offen offset:1024 sc1
  s_mov_b64 exec, -1
  s_add_u32 s19, s19, 1
  s_cmp_gt_u32 s19, 32768
  s_cbranch_scc1 M_exit
  s_nop 0
  v_mov_b64 v[16:17], 0
  v_mov_b64 v[18:19], 0
T_loop_88:
  s_waitcnt vmcnt(3) lgkmcnt(0)
  v_max3_u32 v123, v124, v125, v126
  v_max_u32 v123, v123, v127
  v_mov_b32_dpp v120, v124 row_ror:8 row_mask:0xf bank_mask:0xf
  v_mov_b32_dpp v121, v125 row_ror:8 row_mask:0xf bank_mask:0xf
  s_waitcnt vmcnt(2)
  v_max3_u32 v123, v123, v116, v117
  v_max3_u32 v123, v123, v118, v119
  v_cmp_eq_u32 vcc, -1, v123
  v_smfmac_f32_16x16x64_bf16 v[16:19], v[124:127], v[68:75], v0
  s_cbranch_vccnz T_retry_89
  ds_write_b128 v2, v[124:127] offset:1024
  v_mov_b32_dpp v122, v126 row_ror:8 row_mask:0xf bank_mask:0xf
  v_smfmac_f32_16x16x64_bf16 v[20:23], v[124:127], v[76:83], v0
  s_and_b32 s57, s14, 1
  v_mov_b32_dpp v123, v127 row_ror:8 row_mask:0xf bank_mask:0xf
  v_smfmac_f32_16x16x64_bf16 v[24:27], v[124:127], v[84:91], v0
  s_and_b32 s36, s14, 3
  ds_write_b128 v2, v[116:119] offset:5120
  v_smfmac_f32_16x16x64_bf16 v[16:19], v[120:123], v[92:99], v0
  s_lshl_b32 s36, s36, 13
  v_mov_b32_dpp v84, v116 row_ror:8 row_mask:0xf bank_mask:0xf
  v_smfmac_f32_16x16x64_bf16 v[20:23], v[120:123], v[100:107], v0
  s_add_u32 s26, s36, s23
  ds_read_b128 v[68:71], v4 offset:12288
  v_mov_b32_dpp v85, v117 row_ror:8 row_mask:0xf bank_mask:0xf
  v_smfmac_f32_16x16x64_bf16 v[24:27], v[120:123], v[108:115], v0
  s_add_u32 s36, s36, 8192
  ds_read_b128 v[72:75], v4 offset:13312
  v_mov_b32_dpp v86, v118 row_ror:8 row_mask:0xf bank_mask:0xf
  v_smfmac_f32_16x16x64_bf16 v[16:19], v[116:119], v[224:231], v0
  s_and_b32 s36, s36, 0x7fff
  ds_read_b128 v[76:79], v4 offset:14336
  v_mov_b32_dpp v87, v119 row_ror:8 row_mask:0xf bank_mask:0xf
  v_smfmac_f32_16x16x64_bf16 v[20:23], v[116:119], v[240:247], v0
  s_waitcnt lgkmcnt(3)
  s_barrier
  ds_read_b128 v[100:103], v2 offset:0
  v_smfmac_f32_16x16x64_bf16 v[24:27], v[116:119], a[0:7], v0
  s_mov_b32 m0, s31
  ds_read_b128 v[120:123], v1 offset:0
  v_smfmac_f32_16x16x64_bf16 v[16:19], v[84:87], v[232:239], v0
  v_smfmac_f32_16x16x64_bf16 v[20:23], v[84:87], v[248:255], v0
  ds_read_b128 v[80:83], v4 offset:15360
  v_smfmac_f32_16x16x64_bf16 v[24:27], v[84:87], a[8:15], v0
  s_waitcnt lgkmcnt(2)
  buffer_load_dwordx4 v9, s[4:7], s27 offen sc1 lds
  v_smfmac_f32_16x16x64_bf16 v[16:19], v[100:103], v[128:135], v0
  ds_read_b128 v[92:95], v2 offset:3072
  s_mov_b32 m0, s32
  v_smfmac_f32_16x16x64_bf16 v[20:23], v[100:103], v[144:151], v0
  ds_read_b128 v[96:99], v1 offset:3072
  v_smfmac_f32_16x16x64_bf16 v[24:27], v[100:103], v[68:75], v0
  s_waitcnt vmcnt(1) lgkmcnt(3)
  ds_read_b128 v[116:119], v2 offset:2048
  v_smfmac_f32_16x16x64_bf16 v[16:19], v[120:123], v[136:143], v0
  ds_read_b128 v[124:127], v1 offset:2048
  buffer_load_dwordx4 v9, s[4:7], s27 offen offset:128 sc1 lds
  v_smfmac_f32_16x16x64_bf16 v[20:23], v[120:123], v[152:159], v0
  s_waitcnt lgkmcnt(4)
  ds_read_b128 v[104:107], v2 offset:4096
  s_mov_b32 m0, s33
  v_smfmac_f32_16x16x64_bf16 v[24:27], v[120:123], v[76:83], v0
  s_waitcnt lgkmcnt(4)
  ds_read_b128 v[108:111], v1 offset:4096
  v_smfmac_f32_16x16x64_bf16 v[16:19], v[92:95], v[160:167], v0
  s_waitcnt lgkmcnt(4)
  ds_read_b128 v[112:115], v2 offset:7168
  v_smfmac_f32_16x16x64_bf16 v[16:19], v[96:99], v[168:175], v0
  s_waitcnt lgkmcnt(4)
  ds_read_b128 v[84:87], v1 offset:7168
  buffer_load_dwordx4 v10, s[4:7], s28 offen sc1 lds
  v_smfmac_f32_16x16x64_bf16 v[16:19], v[116:119], v[192:199], v0
  s_waitcnt lgkmcnt(4)
  ds_read_b128 v[88:91], v2 offset:6144
  s_mov_b32 m0, s34
  v_smfmac_f32_16x16x64_bf16 v[16:19], v[124:127], v[200:207], v0
  s_waitcnt lgkmcnt(4)
  ds_read_b128 v[100:103], v1 offset:6144
  v_smfmac_f32_16x16x64_bf16 v[16:19], v[104:107], a[16:23], v0
  s_waitcnt lgkmcnt(4)
  ds_read_b128 v[68:71], v4 offset:16384
  v_smfmac_f32_16x16x64_bf16 v[16:19], v[108:111], a[24:31], v0
  s_waitcnt lgkmcnt(4)
  ds_read_b128 v[72:75], v4 offset:17408
  buffer_load_dwordx4 v10, s[4:7], s28 offen offset:256 sc1 lds
  v_smfmac_f32_16x16x64_bf16 v[16:19], v[112:115], a[64:71], v0
  s_waitcnt lgkmcnt(4)
  ds_read_b128 v[76:79], v4 offset:18432
  v_smfmac_f32_16x16x64_bf16 v[16:19], v[84:87], a[72:79], v0
  s_waitcnt lgkmcnt(4)
  ds_read_b128 v[80:83], v4 offset:19456
  v_smfmac_f32_16x16x64_bf16 v[16:19], v[88:91], a[112:119], v0
  s_waitcnt lgkmcnt(4)
  v_smfmac_f32_16x16x64_bf16 v[16:19], v[100:103], a[120:127], v0
  s_add_u32 s24, s36, 145752064
  s_add_u32 s25, s36, 145756160
  v_smfmac_f32_16x16x64_bf16 v[20:23], v[92:95], v[176:183], v0
  s_add_u32 s35, s36, s23
  v_smfmac_f32_16x16x64_bf16 v[20:23], v[96:99], v[184:191], v0
  s_waitcnt lgkmcnt(2)
  v_smfmac_f32_16x16x64_bf16 v[20:23], v[116:119], v[68:75], v0
  s_waitcnt lgkmcnt(0)
  ds_read_b128 v[68:71], v4 offset:20480
  v_mul_f32 v16, s18, v16
  v_smfmac_f32_16x16x64_bf16 v[20:23], v[124:127], v[76:83], v0
  ds_read_b128 v[72:75], v4 offset:21504
  v_mul_f32 v17, s18, v17
  v_smfmac_f32_16x16x64_bf16 v[20:23], v[104:107], a[32:39], v0
  ds_read_b128 v[76:79], v4 offset:22528
  v_mul_f32 v18, s18, v18
  v_smfmac_f32_16x16x64_bf16 v[20:23], v[108:111], a[40:47], v0
  ds_read_b128 v[80:83], v4 offset:23552
  v_mul_f32 v19, s18, v19
  v_smfmac_f32_16x16x64_bf16 v[20:23], v[112:115], a[80:87], v0
  v_cvt_pk_bf16_f32 v120, v16, v17
  v_smfmac_f32_16x16x64_bf16 v[20:23], v[84:87], a[88:95], v0
  v_cvt_pk_bf16_f32 v121, v18, v19
  v_smfmac_f32_16x16x64_bf16 v[20:23], v[88:91], a[128:135], v0
  ds_write_b64 v5, v[120:121] offset:24576
  v_smfmac_f32_16x16x64_bf16 v[20:23], v[100:103], a[136:143], v0
  s_waitcnt lgkmcnt(3)
  v_smfmac_f32_16x16x64_bf16 v[24:27], v[92:95], v[68:75], v0
  s_waitcnt lgkmcnt(1)
  v_mov_b64 v[92:93], 0
  v_smfmac_f32_16x16x64_bf16 v[24:27], v[96:99], v[76:83], v0
  s_nop 1
  v_cvt_pk_bf16_f32 v122, v20, v21
  v_cvt_pk_bf16_f32 v123, v22, v23
  v_smfmac_f32_16x16x64_bf16 v[24:27], v[116:119], v[208:215], v0
  ds_write_b64 v5, v[122:123] offset:26880
  v_mov_b64 v[94:95], 0
  v_smfmac_f32_16x16x64_bf16 v[24:27], v[124:127], v[216:223], v0
  s_waitcnt lgkmcnt(1)
  s_barrier
  ds_read_b64_tr_b16 v[68:69], v6 offset:24576
  v_smfmac_f32_16x16x64_bf16 v[24:27], v[104:107], a[48:55], v0
  s_add_u32 s27, s27, 8192
  ds_read_b64_tr_b16 v[70:71], v6 offset:24640
  ds_read_b64_tr_b16 v[72:73], v6 offset:24832
  v_smfmac_f32_16x16x64_bf16 v[24:27], v[108:111], a[56:63], v0
  s_add_u32 s28, s28, 8192
  ds_read_b64_tr_b16 v[74:75], v6 offset:24896
  ds_read_b64_tr_b16 v[76:77], v6 offset:25088
  v_smfmac_f32_16x16x64_bf16 v[24:27], v[112:115], a[96:103], v0
  s_nop 0
  ds_read_b64_tr_b16 v[78:79], v6 offset:25152
  ds_read_b64_tr_b16 v[80:81], v6 offset:25344
  v_smfmac_f32_16x16x64_bf16 v[24:27], v[84:87], a[104:111], v0
  ds_read_b64_tr_b16 v[82:83], v6 offset:25408
  v_mov_b64 v[96:97], 0
  v_smfmac_f32_16x16x64_bf16 v[24:27], v[88:91], a[144:151], v0
  s_waitcnt lgkmcnt(8)
  s_barrier
  ds_read_b64_tr_b16 v[116:117], v6 offset:26880
  v_smfmac_f32_16x16x64_bf16 v[24:27], v[100:103], a[152:159], v0
  s_waitcnt lgkmcnt(7)
  ds_read_b64_tr_b16 v[118:119], v6 offset:26944
  v_mfma_f32_16x16x32_bf16 v[16:19], v[36:39], v[68:71], 0
  s_waitcnt lgkmcnt(6)
  ds_read_b64_tr_b16 v[124:125], v6 offset:27136
  ds_read_b64_tr_b16 v[126:127], v6 offset:27200
  v_mfma_f32_16x16x32_bf16 v[16:19], v[40:43], v[72:75], v[16:19]
  s_waitcnt lgkmcnt(6)
  ds_read_b64_tr_b16 v[104:105], v6 offset:27392
  ds_read_b64_tr_b16 v[106:107], v6 offset:27456
  v_mfma_f32_16x16x32_bf16 v[16:19], v[44:47], v[76:79], v[16:19]
  s_waitcnt lgkmcnt(6)
  ds_read_b64_tr_b16 v[108:109], v6 offset:27648
  ds_read_b64_tr_b16 v[110:111], v6 offset:27712
  v_mfma_f32_16x16x32_bf16 v[16:19], v[48:51], v[80:83], v[16:19]
  s_waitcnt lgkmcnt(6)
  v_cvt_pk_bf16_f32 v120, v24, v25
  v_cvt_pk_bf16_f32 v121, v26, v27
  v_mfma_f32_16x16x32_bf16 v[112:115], v[116:119], v[68:71], 0
  s_waitcnt lgkmcnt(4)
  v_mov_b64 v[98:99], 0
  v_mfma_f32_16x16x32_bf16 v[112:115], v[124:127], v[72:75], v[112:115]
  s_waitcnt lgkmcnt(2)
  buffer_store_dwordx4 v[120:123], v2, s[4:7], s29 offen offset:1024 sc1
  v_mov_b64 v[36:37], 0
  v_exp_f32 v100, v16
  v_mfma_f32_16x16x32_bf16 v[112:115], v[104:107], v[76:79], v[112:115]
  s_waitcnt lgkmcnt(0)
  v_exp_f32 v101, v17
  v_mfma_f32_16x16x32_bf16 v[112:115], v[108:111], v[80:83], v[112:115]
  v_exp_f32 v102, v18
  v_mfma_f32_16x16x32_bf16 v[20:23], v[52:55], v[68:71], 0
  v_exp_f32 v103, v19
  v_mfma_f32_16x16x32_bf16 v[20:23], v[56:59], v[72:75], v[20:23]
  v_cvt_pk_bf16_f32 v44, v100, v101
  v_cvt_pk_bf16_f32 v45, v102, v103
  v_mfma_f32_16x16x32_bf16 v[20:23], v[60:63], v[76:79], v[20:23]
  s_add_u32 s29, s29, 131072
  v_exp_f32 v100, v112
  v_mfma_f32_16x16x32_bf16 v[20:23], v[64:67], v[80:83], v[20:23]
  v_exp_f32 v101, v113
  v_exp_f32 v102, v114
  v_exp_f32 v103, v115
  v_cvt_pk_bf16_f32 v84, v100, v101
  v_cvt_pk_bf16_f32 v85, v102, v103
  v_cndmask_b32 v48, v84, 0, s[16:17]
  v_cndmask_b32 v49, v85, 0, s[16:17]
  v_cndmask_b32 v50, 0, v84, s[16:17]
  v_cndmask_b32 v51, 0, v85, s[16:17]
  v_exp_f32 v100, v20
  v_mfma_f32_16x16x16_bf16 v[88:91], v[12:13], v[48:49], 0
  v_exp_f32 v101, v21
  v_mfma_f32_16x16x16_bf16 v[24:27], v[120:121], v[48:49], 0
  v_exp_f32 v102, v22
  v_mfma_f32_16x16x16_bf16 v[116:119], v[120:121], v[50:51], 0
  v_exp_f32 v103, v23
  v_cvt_pk_bf16_f32 v46, v100, v101
  v_cvt_pk_bf16_f32 v47, v102, v103
  v_mov_b64 v[38:39], 0
  s_nop 0
  v_mfma_f32_16x16x32_bf16 v[88:91], v[12:15], v[44:47], v[88:91]
  v_mov_b64 v[40:41], 0
  v_mov_b64 v[42:43], 0
  v_mfma_f32_16x16x32_bf16 v[24:27], v[28:31], v[44:47], v[24:27]
  ds_read_b128 v[52:55], v4 offset:24576
  ds_read_b128 v[56:59], v4 offset:25600
  v_mfma_f32_16x16x32_bf16 v[116:119], v[32:35], v[44:47], v[116:119]
  s_nop 1
T_back_96:
  v_rcp_f32 v89, v88
  v_subrev_u32 v100, s54, v88
  v_cmp_le_u32 vcc, s96, v100
  v_mul_f32 v24, v89, v24
  v_mul_f32 v25, v89, v25
  v_cvt_pk_bf16_f32 v124, v24, v25
  v_pk_mul_f32 v[26:27], v[26:27], v[88:89] op_sel:[0,1] op_sel_hi:[1,1]
  v_cvt_pk_bf16_f32 v125, v26, v27
  ds_write_b64 v11, v[124:125] offset:29696
  v_pk_mul_f32 v[116:117], v[116:117], v[88:89] op_sel:[0,1] op_sel_hi:[1,1]
  v_pk_mul_f32 v[118:119], v[118:119], v[88:89] op_sel:[0,1] op_sel_hi:[1,1]
  v_cvt_pk_bf16_f32 v126, v116, v117
  v_cvt_pk_bf16_f32 v127, v118, v119
  ds_write_b64 v11, v[126:127] offset:29704
  s_cbranch_vccnz T_slow_95
  v_smfmac_f32_16x16x64_bf16 v[92:95], v[124:127], a[160:167], v0
  s_mov_b32 s96, s55
  v_smfmac_f32_16x16x64_bf16 v[96:99], v[124:127], a[168:175], v0
  s_cmp_eq_u32 s14, 63
  v_smfmac_f32_16x16x64_bf16 v[36:39], v[124:127], a[176:183], v0
  s_waitcnt lgkmcnt(0)
  s_barrier
  ds_read_b128 v[104:107], v11 offset:29184
  ds_read_b128 v[108:111], v11 offset:30720
  ds_read_b128 v[68:71], v11 offset:30208
  s_cbranch_scc1 M_tdone
  v_smfmac_f32_16x16x64_bf16 v[40:43], v[124:127], a[184:191], v0
  s_waitcnt lgkmcnt(2)
  v_smfmac_f32_16x16x64_bf16 v[92:95], v[104:107], a[192:199], v0
  s_waitcnt lgkmcnt(1)
  ds_read_b128 v[76:79], v4 offset:28672
  v_smfmac_f32_16x16x64_bf16 v[92:95], v[108:111], a[224:231], v0
  s_waitcnt lgkmcnt(1)
  ds_read_b128 v[80:83], v4 offset:29696
  v_smfmac_f32_16x16x64_bf16 v[92:95], v[68:71], a[240:247], v0
  ds_read_b128 v[60:63], v4 offset:26624
  v_smfmac_f32_16x16x64_bf16 v[96:99], v[104:107], a[200:207], v0
  ds_read_b128 v[64:67], v4 offset:27648
  v_smfmac_f32_16x16x64_bf16 v[96:99], v[108:111], a[232:239], v0
  ds_read_b128 v[28:31], v4 offset:30720
  s_nop 0
  v_cvt_pk_bf16_f32 v16, v92, v93
  v_cvt_pk_bf16_f32 v17, v94, v95
  v_bfi_b32 v16, 1, s57, v16
  v_smfmac_f32_16x16x64_bf16 v[96:99], v[68:71], a[248:255], v0
  buffer_store_dwordx2 v[16:17], v7, s[4:7], s20 offen offset:0 sc1
  v_smfmac_f32_16x16x64_bf16 v[36:39], v[104:107], a[208:215], v0
  ds_read_b128 v[32:35], v4 offset:31744
  v_smfmac_f32_16x16x64_bf16 v[36:39], v[108:111], v[52:59], v0
  s_waitcnt lgkmcnt(4)
  s_nop 0
  v_cvt_pk_bf16_f32 v18, v96, v97
  v_cvt_pk_bf16_f32 v19, v98, v99
  v_bfi_b32 v18, 1, s57, v18
  v_smfmac_f32_16x16x64_bf16 v[36:39], v[68:71], v[76:83], v0
  buffer_store_dwordx2 v[18:19], v7, s[4:7], s20 offen offset:64 sc1
  v_smfmac_f32_16x16x64_bf16 v[40:43], v[104:107], a[216:223], v0
  s_waitcnt lgkmcnt(2)
  ds_read_b128 v[116:119], v2 offset:31232
  v_smfmac_f32_16x16x64_bf16 v[40:43], v[108:111], v[60:67], v0
  s_waitcnt lgkmcnt(1)
  s_nop 0
  v_cvt_pk_bf16_f32 v20, v36, v37
  v_cvt_pk_bf16_f32 v21, v38, v39
  v_bfi_b32 v20, 1, s57, v20
  v_smfmac_f32_16x16x64_bf16 v[40:43], v[68:71], v[28:35], v0
  buffer_store_dwordx2 v[20:21], v7, s[4:7], s21 offen offset:0 sc1
  s_nop 6
  v_cvt_pk_bf16_f32 v22, v40, v41
  v_cvt_pk_bf16_f32 v23, v42, v43
  v_bfi_b32 v22, 1, s57, v22
  buffer_store_dwordx2 v[22:23], v7, s[4:7], s21 offen offset:64 sc1
  ds_read_b128 v[68:71], v4 offset:0
  ds_read_b128 v[72:75], v4 offset:1024
  ds_read_b128 v[76:79], v4 offset:4096
  ds_read_b128 v[80:83], v4 offset:5120
  ds_read_b128 v[84:87], v4 offset:8192
  ds_read_b128 v[88:91], v4 offset:9216
  ds_read_b128 v[92:95], v4 offset:2048
  ds_read_b128 v[96:99], v4 offset:3072
  ds_read_b128 v[100:103], v4 offset:6144
  ds_read_b128 v[104:107], v4 offset:7168
  ds_read_b128 v[108:111], v4 offset:10240
  ds_read_b128 v[112:115], v4 offset:11264
  v_mov_b64 v[16:17], 0
  v_mov_b64 v[18:19], 0
  v_mov_b64 v[20:21], 0
  v_mov_b64 v[22:23], 0
  v_mov_b64 v[24:25], 0
  v_mov_b64 v[26:27], 0
  s_mov_b32 s19, 0
  v_mov_b32 v49, -1
  ds_read_b64 v[44:45], v2 offset:32256
  s_waitcnt lgkmcnt(0)
  v_readfirstlane_b32 s38, v44
  v_readfirstlane_b32 s37, v45
  s_nop 0
  s_lshl_b32 s38, s38, 1
  s_lshl1_add_u32 s37, s37, 1
  s_min_u32 s38, s38, s37
  s_cmp_ge_u32 s38, 64
  s_cselect_b32 s38, 100, s38
  s_sub_u32 s38, s38, 1
  s_max_i32 s30, s30, s38
  s_waitcnt vmcnt(0)
  buffer_load_dwordx4 v[52:55], v2, s[4:7], s22 offen offset:0 sc1
  buffer_load_dwordx4 v[56:59], v2, s[4:7], s22 offen offset:1024 sc1
  buffer_load_dwordx4 v[60:63], v2, s[4:7], s22 offen offset:2048 sc1
  buffer_load_dwordx4 v[64:67], v2, s[4:7], s22 offen offset:3072 sc1
  s_waitcnt lgkmcnt(12)
  s_waitcnt vmcnt(3)
  v_mfma_f32_16x16x32_bf16 v[120:123], v[116:119], v[52:55], 0
  v_xor_b32 v48, s57, v52
  v_bitop3_b32 v48, v48, v54, s57 bitop3:0xf6
  s_waitcnt vmcnt(2)
  v_mfma_f32_16x16x32_bf16 v[120:123], v[116:119], v[56:59], v[120:123]
  v_bitop3_b32 v48, v48, v56, s57 bitop3:0xf6
  v_bitop3_b32 v48, v48, v58, s57 bitop3:0xf6
  s_waitcnt vmcnt(1)
  v_mfma_f32_16x16x32_bf16 v[120:123], v[116:119], v[60:63], v[120:123]
  v_bitop3_b32 v48, v48, v60, s57 bitop3:0xf6
  v_bitop3_b32 v48, v48, v62, s57 bitop3:0xf6
  s_waitcnt vmcnt(0)
  v_mfma_f32_16x16x32_bf16 v[120:123], v[116:119], v[64:67], v[120:123]
  v_bitop3_b32 v48, v48, v64, s57 bitop3:0xf6
  v_bitop3_b32 v48, v48, v66, s57 bitop3:0xf6
  v_and_b32 v48, 1, v48
  v_cmp_ne_u32 vcc, 0, v48
  s_cbranch_vccnz T_p1re_98
T_p1ok_99:
  s_nop 2
  v_add_f32_dpp v120, v120, v120 row_ror:8 row_mask:0xf bank_mask:0xf
  v_add_f32_dpp v121, v121, v121 row_ror:8 row_mask:0xf bank_mask:0xf
  v_cvt_pk_bf16_f32 v48, v120, v121
  buffer_store_dword v48, v8, s[4:7], s35 offen sc1
  buffer_store_dword v49, v8, s[4:7], s26 offen sc1
  s_barrier
  ds_read_b128 v[28:31], v2 offset:17408
  ds_read_b128 v[32:35], v2 offset:21504
  ds_read_b128 v[36:39], v2 offset:8192
  ds_read_b128 v[40:43], v2 offset:9216
  ds_read_b128 v[44:47], v2 offset:10240
  ds_read_b128 v[48:51], v2 offset:11264
  buffer_load_dwordx4 v[124:127], v2, s[4:7], s24 offen offset:1024 sc1
  buffer_load_dwordx4 v[116:119], v2, s[4:7], s25 offen offset:1024 sc1
  ds_read_b128 v[52:55], v2 offset:12288
  ds_read_b128 v[56:59], v2 offset:13312
  ds_read_b128 v[60:63], v2 offset:14336
  ds_read_b128 v[64:67], v2 offset:15360
  buffer_load_dwordx4 v[124:127], v2, s[4:7], s24 offen offset:1024 sc1
  buffer_load_dwordx4 v[116:119], v2, s[4:7], s25 offen offset:1024 sc1
  s_add_u32 s14, s14, 1
  s_cmp_ge_i32 s14, s30
  s_cbranch_scc1 T_kvw_92
T_kvb_93:
  s_mov_b32 s19, 0
  s_branch T_loop_88
T_p1re_98:
  s_mov_b64 exec, vcc
  buffer_load_dwordx4 v[52:55], v2, s[4:7], s22 offen offset:0 sc1
  buffer_load_dwordx4 v[56:59], v2, s[4:7], s22 offen offset:1024 sc1
  buffer_load_dwordx4 v[60:63], v2, s[4:7], s22 offen offset:2048 sc1
  buffer_load_dwordx4 v[64:67], v2, s[4:7], s22 offen offset:3072 sc1
  s_mov_b64 exec, -1
  s_add_u32 s19, s19, 1
  s_cmp_gt_u32 s19, 32768
  s_cbranch_scc1 M_exit
  s_waitcnt vmcnt(3)
  v_mfma_f32_16x16x32_bf16 v[120:123], v[116:119], v[52:55], 0
  v_xor_b32 v48, s57, v52
  v_bitop3_b32 v48, v48, v54, s57 bitop3:0xf6
  s_waitcnt vmcnt(2)
  v_mfma_f32_16x16x32_bf16 v[120:123], v[116:119], v[56:59], v[120:123]
  v_bitop3_b32 v48, v48, v56, s57 bitop3:0xf6
  v_bitop3_b32 v48, v48, v58, s57 bitop3:0xf6
  s_waitcnt vmcnt(1)
  v_mfma_f32_16x16x32_bf16 v[120:123], v[116:119], v[60:63], v[120:123]
  v_bitop3_b32 v48, v48, v60, s57 bitop3:0xf6
  v_bitop3_b32 v48, v48, v62, s57 bitop3:0xf6
  s_waitcnt vmcnt(0)
  v_mfma_f32_16x16x32_bf16 v[120:123], v[116:119], v[64:67], v[120:123]
  v_bitop3_b32 v48, v48, v64, s57 bitop3:0xf6
  v_bitop3_b32 v48, v48, v66, s57 bitop3:0xf6
  v_and_b32 v48, 1, v48
  v_cmp_ne_u32 vcc, 0, v48
  s_cbranch_vccnz T_p1re_98
  s_branch T_p1ok_99
T_kvw_92:
  s_mov_b32 s19, 0
  s_branch T_kvok_101
T_kv_100:
  s_sleep 4
  s_add_u32 s19, s19, 1
  s_cmp_gt_u32 s19, 32768
  s_cbranch_scc1 M_exit
T_kvok_101:
  s_add_u32 s39, s99, 128
  s_mov_b32 s38, 0
  s_mov_b32 s37, 0
  s_atomic_or s38, s[58:59], s99 glc
  s_atomic_or s37, s[58:59], s39 glc
  s_waitcnt lgkmcnt(0)
  s_lshl_b32 s38, s38, 1
  s_lshl1_add_u32 s37, s37, 1
  s_min_u32 s38, s38, s37
  s_cmp_ge_u32 s38, 64
  s_cselect_b32 s38, 100, s38
  s_sub_u32 s38, s38, 1
  s_max_i32 s30, s30, s38
  s_cmp_ge_i32 s14, s30
  s_cbranch_scc1 T_kv_100
  s_branch T_kvb_93
T_slow_95:
  s_nop 7
  v_max3_f32 v100, v16, v17, v18
  v_max3_f32 v100, v100, v19, v20
  v_max3_f32 v100, v100, v21, v22
  v_max3_f32 v100, v100, v23, v112
  v_max3_f32 v100, v100, v113, v114
  v_max_f32 v100, v100, v115
  v_mov_b32 v101, v100
  s_nop 1
  v_permlane32_swap_b32 v100, v101
  s_nop 1
  v_max_f32 v100, v100, v101
  v_mov_b32 v101, v100
  s_nop 1
  v_permlane16_swap_b32 v100, v101
  s_nop 1
  v_max_f32 v100, v100, v101
  v_sub_f32 v16, v16, v100
  v_sub_f32 v17, v17, v100
  v_sub_f32 v18, v18, v100
  v_sub_f32 v19, v19, v100
  v_exp_f32 v16, v16
  v_exp_f32 v17, v17
  v_exp_f32 v18, v18
  v_exp_f32 v19, v19
  v_sub_f32 v20, v20, v100
  v_sub_f32 v21, v21, v100
  v_sub_f32 v22, v22, v100
  v_sub_f32 v23, v23, v100
  v_exp_f32 v20, v20
  v_exp_f32 v21, v21
  v_exp_f32 v22, v22
  v_exp_f32 v23, v23
  v_sub_f32 v112, v112, v100
  v_sub_f32 v113, v113, v100
  v_sub_f32 v114, v114, v100
  v_sub_f32 v115, v115, v100
  v_exp_f32 v112, v112
  v_exp_f32 v113, v113
  v_exp_f32 v114, v114
  v_exp_f32 v115, v115
  s_nop 0
  v_cvt_pk_bf16_f32 v44, v16, v17
  v_cvt_pk_bf16_f32 v45, v18, v19
  v_cvt_pk_bf16_f32 v46, v20, v21
  v_cvt_pk_bf16_f32 v47, v22, v23
  v_cvt_pk_bf16_f32 v84, v112, v113
  v_cvt_pk_bf16_f32 v85, v114, v115
  v_cndmask_b32 v48, v84, 0, s[16:17]
  v_cndmask_b32 v49, v85, 0, s[16:17]
  v_cndmask_b32 v50, 0, v84, s[16:17]
  v_cndmask_b32 v51, 0, v85, s[16:17]
  s_nop 1
  v_mfma_f32_16x16x16_bf16 v[88:91], v[12:13], v[48:49], 0
  v_mfma_f32_16x16x16_bf16 v[24:27], v[120:121], v[48:49], 0
  v_mfma_f32_16x16x16_bf16 v[116:119], v[120:121], v[50:51], 0
  v_mfma_f32_16x16x32_bf16 v[88:91], v[12:15], v[44:47], v[88:91]
  v_mfma_f32_16x16x32_bf16 v[24:27], v[28:31], v[44:47], v[24:27]
  v_mfma_f32_16x16x32_bf16 v[116:119], v[32:35], v[44:47], v[116:119]
  s_nop 7
  s_nop 1
  s_mov_b32 s96, -1
  s_branch T_back_96
T_w_72:
  s_mov_b32 s19, 0
  s_add_u32 s14, s14, 1
  v_mov_b64 v[16:17], 0
  v_mov_b64 v[18:19], 0
  v_mov_b64 v[20:21], 0
  v_mov_b64 v[22:23], 0
  v_mov_b64 v[24:25], 0
  v_mov_b64 v[26:27], 0
  buffer_load_dwordx4 v[124:127], v2, s[4:7], s24 offen offset:2048 sc1
  buffer_load_dwordx4 v[116:119], v2, s[4:7], s25 offen offset:2048 sc1
  buffer_load_dwordx4 v[124:127], v2, s[4:7], s24 offen offset:2048 sc1
  buffer_load_dwordx4 v[116:119], v2, s[4:7], s25 offen offset:2048 sc1
  s_branch T_loop_102
.p2align 6
T_retry_103:
  s_mov_b64 exec, vcc
  buffer_load_dwordx4 v[124:127], v2, s[4:7], s24 offen offset:2048 sc1
  buffer_load_dwordx4 v[116:119], v2, s[4:7], s25 offen offset:2048 sc1
  s_mov_b64 exec, -1
  s_add_u32 s19, s19, 1
  s_cmp_gt_u32 s19, 32768
  s_cbranch_scc1 M_exit
  s_nop 0
  v_mov_b64 v[16:17], 0
  v_mov_b64 v[18:19], 0
T_loop_102:
  s_waitcnt vmcnt(3) lgkmcnt(0)
  v_max3_u32 v123, v124, v125, v126
  v_max_u32 v123, v123, v127
  v_mov_b32_dpp v120, v124 row_ror:8 row_mask:0xf bank_mask:0xf
  v_mov_b32_dpp v121, v125 row_ror:8 row_mask:0xf bank_mask:0xf
  s_waitcnt vmcnt(2)
  v_max3_u32 v123, v123, v116, v117
  v_max3_u32 v123, v123, v118, v119
  v_cmp_eq_u32 vcc, -1, v123
  v_smfmac_f32_16x16x64_bf16 v[16:19], v[124:127], v[68:75], v0
  s_cbranch_vccnz T_retry_103
  ds_write_b128 v2, v[124:127] offset:2048
  v_mov_b32_dpp v122, v126 row_ror:8 row_mask:0xf bank_mask:0xf
  v_smfmac_f32_16x16x64_bf16 v[20:23], v[124:127], v[76:83], v0
  s_and_b32 s57, s14, 1
  v_mov_b32_dpp v123, v127 row_ror:8 row_mask:0xf bank_mask:0xf
  v_smfmac_f32_16x16x64_bf16 v[24:27], v[124:127], v[84:91], v0
  s_and_b32 s36, s14, 3
  ds_write_b128 v2, v[116:119] offset:6144
  v_smfmac_f32_16x16x64_bf16 v[16:19], v[120:123], v[92:99], v0
  s_lshl_b32 s36, s36, 13
  v_mov_b32_dpp v84, v116 row_ror:8 row_mask:0xf bank_mask:0xf
  v_smfmac_f32_16x16x64_bf16 v[20:23], v[120:123], v[100:107], v0
  s_add_u32 s26, s36, s23
  ds_read_b128 v[68:71], v4 offset:12288
  v_mov_b32_dpp v85, v117 row_ror:8 row_mask:0xf bank_mask:0xf
  v_smfmac_f32_16x16x64_bf16 v[24:27], v[120:123], v[108:115], v0
  s_add_u32 s36, s36, 8192
  ds_read_b128 v[72:75], v4 offset:13312
  v_mov_b32_dpp v86, v118 row_ror:8 row_mask:0xf bank_mask:0xf
  v_smfmac_f32_16x16x64_bf16 v[16:19], v[116:119], v[224:231], v0
  s_and_b32 s36, s36, 0x7fff
  ds_read_b128 v[76:79], v4 offset:14336
  v_mov_b32_dpp v87, v119 row_ror:8 row_mask:0xf bank_mask:0xf
  v_smfmac_f32_16x16x64_bf16 v[20:23], v[116:119], v[240:247], v0
  s_waitcnt lgkmcnt(3)
  s_barrier
  ds_read_b128 v[100:103], v2 offset:3072
  v_smfmac_f32_16x16x64_bf16 v[24:27], v[116:119], a[0:7], v0
  s_mov_b32 m0, s31
  ds_read_b128 v[120:123], v1 offset:3072
  v_smfmac_f32_16x16x64_bf16 v[16:19], v[84:87], v[232:239], v0
  v_smfmac_f32_16x16x64_bf16 v[20:23], v[84:87], v[248:255], v0
  ds_read_b128 v[80:83], v4 offset:15360
  v_smfmac_f32_16x16x64_bf16 v[24:27], v[84:87], a[8:15], v0
  s_waitcnt lgkmcnt(2)
  v_smfmac_f32_16x16x64_bf16 v[16:19], v[100:103], v[128:135], v0
  ds_read_b128 v[92:95], v2 offset:0
  buffer_load_dwordx4 v9, s[4:7], s27 offen sc1 lds
  v_smfmac_f32_16x16x64_bf16 v[20:23], v[100:103], v[144:151], v0
  ds_read_b128 v[96:99], v1 offset:0
  s_mov_b32 m0, s32
  v_smfmac_f32_16x16x64_bf16 v[24:27], v[100:103], v[68:75], v0
  s_waitcnt vmcnt(1) lgkmcnt(3)
  ds_read_b128 v[116:119], v2 offset:1024
  v_smfmac_f32_16x16x64_bf16 v[16:19], v[120:123], v[136:143], v0
  ds_read_b128 v[124:127], v1 offset:1024
  v_smfmac_f32_16x16x64_bf16 v[20:23], v[120:123], v[152:159], v0
  s_waitcnt lgkmcnt(4)
  ds_read_b128 v[104:107], v2 offset:7168
  buffer_load_dwordx4 v9, s[4:7], s27 offen offset:128 sc1 lds
  v_smfmac_f32_16x16x64_bf16 v[24:27], v[120:123], v[76:83], v0
  s_waitcnt lgkmcnt(4)
  ds_read_b128 v[108:111], v1 offset:7168
  s_mov_b32 m0, s33
  v_smfmac_f32_16x16x64_bf16 v[16:19], v[92:95], v[160:167], v0
  s_waitcnt lgkmcnt(4)
  ds_read_b128 v[112:115], v2 offset:4096
  v_mov_b32 v122, s98
  v_smfmac_f32_16x16x64_bf16 v[16:19], v[96:99], v[168:175], v0
  s_waitcnt lgkmcnt(4)
  ds_read_b128 v[84:87], v1 offset:4096
  v_smfmac_f32_16x16x64_bf16 v[16:19], v[116:119], v[192:199], v0
  s_waitcnt lgkmcnt(4)
  ds_read_b128 v[88:91], v2 offset:5120
  buffer_load_dwordx4 v10, s[4:7], s28 offen sc1 lds
  v_smfmac_f32_16x16x64_bf16 v[16:19], v[124:127], v[200:207], v0
  s_waitcnt lgkmcnt(4)
  ds_read_b128 v[100:103], v1 offset:5120
  s_mov_b32 m0, s34
  v_smfmac_f32_16x16x64_bf16 v[16:19], v[104:107], a[16:23], v0
  s_waitcnt lgkmcnt(4)
  ds_read_b128 v[68:71], v4 offset:16384
  v_smfmac_f32_16x16x64_bf16 v[16:19], v[108:111], a[24:31], v0
  s_waitcnt lgkmcnt(4)
  ds_read_b128 v[72:75], v4 offset:17408
  v_smfmac_f32_16x16x64_bf16 v[16:19], v[112:115], a[64:71], v0
  s_waitcnt lgkmcnt(4)
  ds_read_b128 v[76:79], v4 offset:18432
  buffer_load_dwordx4 v10, s[4:7], s28 offen offset:256 sc1 lds
  v_smfmac_f32_16x16x64_bf16 v[16:19], v[84:87], a[72:79], v0
  s_waitcnt lgkmcnt(4)
  ds_read_b128 v[80:83], v4 offset:19456
  v_smfmac_f32_16x16x64_bf16 v[16:19], v[88:91], a[112:119], v0
  s_waitcnt lgkmcnt(4)
  v_smfmac_f32_16x16x64_bf16 v[16:19], v[100:103], a[120:127], v0
  s_add_u32 s24, s36, 145752064
  s_add_u32 s25, s36, 145756160
  v_smfmac_f32_16x16x64_bf16 v[20:23], v[92:95], v[176:183], v0
  buffer_store_dword v122, v3, s[4:7], s15 offen sc1
  s_add_u32 s35, s36, s23
  v_smfmac_f32_16x16x64_bf16 v[20:23], v[96:99], v[184:191], v0
  s_waitcnt lgkmcnt(2)
  s_add_u32 s98, s14, 1
  v_smfmac_f32_16x16x64_bf16 v[20:23], v[116:119], v[68:75], v0
  s_waitcnt lgkmcnt(0)
  ds_read_b128 v[68:71], v4 offset:20480
  v_mul_f32 v16, s18, v16
  v_smfmac_f32_16x16x64_bf16 v[20:23], v[124:127], v[76:83], v0
  ds_read_b128 v[72:75], v4 offset:21504
  v_mul_f32 v17, s18, v17
  v_smfmac_f32_16x16x64_bf16 v[20:23], v[104:107], a[32:39], v0
  ds_read_b128 v[76:79], v4 offset:22528
  v_mul_f32 v18, s18, v18
  v_smfmac_f32_16x16x64_bf16 v[20:23], v[108:111], a[40:47], v0
  ds_read_b128 v[80:83], v4 offset:23552
  v_mul_f32 v19, s18, v19
  v_smfmac_f32_16x16x64_bf16 v[20:23], v[112:115], a[80:87], v0
  v_cvt_pk_bf16_f32 v120, v16, v17
  v_smfmac_f32_16x16x64_bf16 v[20:23], v[84:87], a[88:95], v0
  v_cvt_pk_bf16_f32 v121, v18, v19
  v_smfmac_f32_16x16x64_bf16 v[20:23], v[88:91], a[128:135], v0
  ds_write_b64 v5, v[120:121] offset:24576
  v_smfmac_f32_16x16x64_bf16 v[20:23], v[100:103], a[136:143], v0
  s_waitcnt lgkmcnt(3)
  v_smfmac_f32_16x16x64_bf16 v[24:27], v[92:95], v[68:75], v0
  s_waitcnt lgkmcnt(1)
  v_mov_b64 v[92:93], 0
  v_smfmac_f32_16x16x64_bf16 v[24:27], v[96:99], v[76:83], v0
  s_nop 1
  v_cvt_pk_bf16_f32 v122, v20, v21
  v_cvt_pk_bf16_f32 v123, v22, v23
  v_smfmac_f32_16x16x64_bf16 v[24:27], v[116:119], v[208:215], v0
  ds_write_b64 v5, v[122:123] offset:26880
  v_mov_b64 v[94:95], 0
  v_smfmac_f32_16x16x64_bf16 v[24:27], v[124:127], v[216:223], v0
  s_waitcnt lgkmcnt(1)
  s_barrier
  ds_read_b64_tr_b16 v[68:69], v6 offset:24576
  v_smfmac_f32_16x16x64_bf16 v[24:27], v[104:107], a[48:55], v0
  s_add_u32 s27, s27, 8192
  ds_read_b64_tr_b16 v[70:71], v6 offset:24640
  ds_read_b64_tr_b16 v[72:73], v6 offset:24832
  v_smfmac_f32_16x16x64_bf16 v[24:27], v[108:111], a[56:63], v0
  s_add_u32 s28, s28, 8192
  ds_read_b64_tr_b16 v[74:75], v6 offset:24896
  ds_read_b64_tr_b16 v[76:77], v6 offset:25088
  v_smfmac_f32_16x16x64_bf16 v[24:27], v[112:115], a[96:103], v0
  s_nop 0
  ds_read_b64_tr_b16 v[78:79], v6 offset:25152
  ds_read_b64_tr_b16 v[80:81], v6 offset:25344
  v_smfmac_f32_16x16x64_bf16 v[24:27], v[84:87], a[104:111], v0
  ds_read_b64_tr_b16 v[82:83], v6 offset:25408
  v_mov_b64 v[96:97], 0
  v_smfmac_f32_16x16x64_bf16 v[24:27], v[88:91], a[144:151], v0
  s_waitcnt lgkmcnt(8)
  s_barrier
  ds_read_b64_tr_b16 v[116:117], v6 offset:26880
  v_smfmac_f32_16x16x64_bf16 v[24:27], v[100:103], a[152:159], v0
  s_waitcnt lgkmcnt(7)
  ds_read_b64_tr_b16 v[118:119], v6 offset:26944
  v_mfma_f32_16x16x32_bf16 v[16:19], v[36:39], v[68:71], 0
  s_waitcnt lgkmcnt(6)
  ds_read_b64_tr_b16 v[124:125], v6 offset:27136
  ds_read_b64_tr_b16 v[126:127], v6 offset:27200
  v_mfma_f32_16x16x32_bf16 v[16:19], v[40:43], v[72:75], v[16:19]
  s_waitcnt lgkmcnt(6)
  ds_read_b64_tr_b16 v[104:105], v6 offset:27392
  ds_read_b64_tr_b16 v[106:107], v6 offset:27456
  v_mfma_f32_16x16x32_bf16 v[16:19], v[44:47], v[76:79], v[16:19]
  s_waitcnt lgkmcnt(6)
  ds_read_b64_tr_b16 v[108:109], v6 offset:27648
  ds_read_b64_tr_b16 v[110:111], v6 offset:27712
  v_mfma_f32_16x16x32_bf16 v[16:19], v[48:51], v[80:83], v[16:19]
  s_waitcnt lgkmcnt(6)
  v_cvt_pk_bf16_f32 v120, v24, v25
  v_cvt_pk_bf16_f32 v121, v26, v27
  v_mfma_f32_16x16x32_bf16 v[112:115], v[116:119], v[68:71], 0
  s_waitcnt lgkmcnt(4)
  v_mov_b64 v[98:99], 0
  v_mfma_f32_16x16x32_bf16 v[112:115], v[124:127], v[72:75], v[112:115]
  s_waitcnt lgkmcnt(2)
  v_mov_b64 v[36:37], 0
  v_exp_f32 v100, v16
  v_mfma_f32_16x16x32_bf16 v[112:115], v[104:107], v[76:79], v[112:115]
  s_waitcnt lgkmcnt(0)
  buffer_store_dwordx4 v[120:123], v2, s[4:7], s29 offen offset:2048 sc1
  v_exp_f32 v101, v17
  v_mfma_f32_16x16x32_bf16 v[112:115], v[108:111], v[80:83], v[112:115]
  v_exp_f32 v102, v18
  v_mfma_f32_16x16x32_bf16 v[20:23], v[52:55], v[68:71], 0
  v_exp_f32 v103, v19
  v_mfma_f32_16x16x32_bf16 v[20:23], v[56:59], v[72:75], v[20:23]
  v_cvt_pk_bf16_f32 v44, v100, v101
  v_cvt_pk_bf16_f32 v45, v102, v103
  v_mfma_f32_16x16x32_bf16 v[20:23], v[60:63], v[76:79], v[20:23]
  s_add_u32 s29, s29, 131072
  v_exp_f32 v100, v112
  v_mfma_f32_16x16x32_bf16 v[20:23], v[64:67], v[80:83], v[20:23]
  v_exp_f32 v101, v113
  v_exp_f32 v102, v114
  v_exp_f32 v103, v115
  v_cvt_pk_bf16_f32 v84, v100, v101
  v_cvt_pk_bf16_f32 v85, v102, v103
  v_cndmask_b32 v48, v84, 0, s[16:17]
  v_cndmask_b32 v49, v85, 0, s[16:17]
  v_cndmask_b32 v50, 0, v84, s[16:17]
  v_cndmask_b32 v51, 0, v85, s[16:17]
  v_exp_f32 v100, v20
  v_mfma_f32_16x16x16_bf16 v[88:91], v[12:13], v[48:49], 0
  v_exp_f32 v101, v21
  v_mfma_f32_16x16x16_bf16 v[24:27], v[120:121], v[48:49], 0
  v_exp_f32 v102, v22
  v_mfma_f32_16x16x16_bf16 v[116:119], v[120:121], v[50:51], 0
  v_exp_f32 v103, v23
  v_cvt_pk_bf16_f32 v46, v100, v101
  v_cvt_pk_bf16_f32 v47, v102, v103
  v_mov_b64 v[38:39], 0
  s_nop 0
  v_mfma_f32_16x16x32_bf16 v[88:91], v[12:15], v[44:47], v[88:91]
  v_mov_b64 v[40:41], 0
  v_mov_b64 v[42:43], 0
  v_mfma_f32_16x16x32_bf16 v[24:27], v[28:31], v[44:47], v[24:27]
  ds_read_b128 v[52:55], v4 offset:24576
  ds_read_b128 v[56:59], v4 offset:25600
  v_mfma_f32_16x16x32_bf16 v[116:119], v[32:35], v[44:47], v[116:119]
  s_nop 1
T_back_110:
  v_rcp_f32 v89, v88
  v_subrev_u32 v100, s54, v88
  v_cmp_le_u32 vcc, s96, v100
  v_mul_f32 v24, v89, v24
  v_mul_f32 v25, v89, v25
  v_cvt_pk_bf16_f32 v124, v24, v25
  v_pk_mul_f32 v[26:27], v[26:27], v[88:89] op_sel:[0,1] op_sel_hi:[1,1]
  v_cvt_pk_bf16_f32 v125, v26, v27
  ds_write_b64 v11, v[124:125] offset:30208
  v_pk_mul_f32 v[116:117], v[116:117], v[88:89] op_sel:[0,1] op_sel_hi:[1,1]
  v_pk_mul_f32 v[118:119], v[118:119], v[88:89] op_sel:[0,1] op_sel_hi:[1,1]
  v_cvt_pk_bf16_f32 v126, v116, v117
  v_cvt_pk_bf16_f32 v127, v118, v119
  ds_write_b64 v11, v[126:127] offset:30216
  s_cbranch_vccnz T_slow_109
  v_smfmac_f32_16x16x64_bf16 v[92:95], v[124:127], a[160:167], v0
  s_mov_b32 s96, s55
  v_smfmac_f32_16x16x64_bf16 v[96:99], v[124:127], a[168:175], v0
  s_cmp_eq_u32 s14, 63
  v_smfmac_f32_16x16x64_bf16 v[36:39], v[124:127], a[176:183], v0
  s_waitcnt lgkmcnt(0)
  s_barrier
  ds_read_b128 v[104:107], v11 offset:30720
  ds_read_b128 v[108:111], v11 offset:29184
  ds_read_b128 v[68:71], v11 offset:29696
  s_cbranch_scc1 M_tdone
  v_smfmac_f32_16x16x64_bf16 v[40:43], v[124:127], a[184:191], v0
  s_waitcnt lgkmcnt(2)
  v_smfmac_f32_16x16x64_bf16 v[92:95], v[104:107], a[192:199], v0
  s_waitcnt lgkmcnt(1)
  ds_read_b128 v[76:79], v4 offset:28672
  v_smfmac_f32_16x16x64_bf16 v[92:95], v[108:111], a[224:231], v0
  s_waitcnt lgkmcnt(1)
  ds_read_b128 v[80:83], v4 offset:29696
  v_smfmac_f32_16x16x64_bf16 v[92:95], v[68:71], a[240:247], v0
  ds_read_b128 v[60:63], v4 offset:26624
  v_smfmac_f32_16x16x64_bf16 v[96:99], v[104:107], a[200:207], v0
  ds_read_b128 v[64:67], v4 offset:27648
  v_smfmac_f32_16x16x64_bf16 v[96:99], v[108:111], a[232:239], v0
  ds_read_b128 v[28:31], v4 offset:30720
  s_nop 0
  v_cvt_pk_bf16_f32 v16, v92, v93
  v_cvt_pk_bf16_f32 v17, v94, v95
  v_bfi_b32 v16, 1, s57, v16
  v_smfmac_f32_16x16x64_bf16 v[96:99], v[68:71], a[248:255], v0
  buffer_store_dwordx2 v[16:17], v7, s[4:7], s20 offen offset:0 sc1
  v_smfmac_f32_16x16x64_bf16 v[36:39], v[104:107], a[208:215], v0
  ds_read_b128 v[32:35], v4 offset:31744
  v_smfmac_f32_16x16x64_bf16 v[36:39], v[108:111], v[52:59], v0
  s_waitcnt lgkmcnt(4)
  s_nop 0
  v_cvt_pk_bf16_f32 v18, v96, v97
  v_cvt_pk_bf16_f32 v19, v98, v99
  v_bfi_b32 v18, 1, s57, v18
  v_smfmac_f32_16x16x64_bf16 v[36:39], v[68:71], v[76:83], v0
  buffer_store_dwordx2 v[18:19], v7, s[4:7], s20 offen offset:64 sc1
  v_smfmac_f32_16x16x64_bf16 v[40:43], v[104:107], a[216:223], v0
  s_waitcnt lgkmcnt(2)
  v_smfmac_f32_16x16x64_bf16 v[40:43], v[108:111], v[60:67], v0
  s_waitcnt lgkmcnt(0)
  s_nop 0
  v_cvt_pk_bf16_f32 v20, v36, v37
  v_cvt_pk_bf16_f32 v21, v38, v39
  v_bfi_b32 v20, 1, s57, v20
  v_smfmac_f32_16x16x64_bf16 v[40:43], v[68:71], v[28:35], v0
  buffer_store_dwordx2 v[20:21], v7, s[4:7], s21 offen offset:0 sc1
  s_nop 6
  v_cvt_pk_bf16_f32 v22, v40, v41
  v_cvt_pk_bf16_f32 v23, v42, v43
  v_bfi_b32 v22, 1, s57, v22
  buffer_store_dwordx2 v[22:23], v7, s[4:7], s21 offen offset:64 sc1
  ds_read_b128 v[68:71], v4 offset:0
  ds_read_b128 v[72:75], v4 offset:1024
  ds_read_b128 v[76:79], v4 offset:4096
  ds_read_b128 v[80:83], v4 offset:5120
  ds_read_b128 v[84:87], v4 offset:8192
  ds_read_b128 v[88:91], v4 offset:9216
  ds_read_b128 v[92:95], v4 offset:2048
  ds_read_b128 v[96:99], v4 offset:3072
  ds_read_b128 v[100:103], v4 offset:6144
  ds_read_b128 v[104:107], v4 offset:7168
  ds_read_b128 v[108:111], v4 offset:10240
  ds_read_b128 v[112:115], v4 offset:11264
  v_mov_b64 v[16:17], 0
  v_mov_b64 v[18:19], 0
  v_mov_b64 v[20:21], 0
  v_mov_b64 v[22:23], 0
  v_mov_b64 v[24:25], 0
  v_mov_b64 v[26:27], 0
  ds_read_b64 v[44:45], v2 offset:32256
  s_waitcnt lgkmcnt(0)
  v_readfirstlane_b32 s38, v44
  v_readfirstlane_b32 s37, v45
  s_nop 0
  s_lshl_b32 s38, s38, 1
  s_lshl1_add_u32 s37, s37, 1
  s_min_u32 s38, s38, s37
  s_cmp_ge_u32 s38, 64
  s_cselect_b32 s38, 100, s38
  s_sub_u32 s38, s38, 1
  s_max_i32 s30, s30, s38
  s_waitcnt vmcnt(4)
  s_barrier
  ds_read_b128 v[28:31], v2 offset:18432
  ds_read_b128 v[32:35], v2 offset:22528
  ds_read_b128 v[36:39], v2 offset:8192
  ds_read_b128 v[40:43], v2 offset:9216
  ds_read_b128 v[44:47], v2 offset:10240
  ds_read_b128 v[48:51], v2 offset:11264
  buffer_load_dwordx4 v[124:127], v2, s[4:7], s24 offen offset:2048 sc1
  buffer_load_dwordx4 v[116:119], v2, s[4:7], s25 offen offset:2048 sc1
  ds_read_b128 v[52:55], v2 offset:12288
  ds_read_b128 v[56:59], v2 offset:13312
  ds_read_b128 v[60:63], v2 offset:14336
  ds_read_b128 v[64:67], v2 offset:15360
  buffer_load_dwordx4 v[124:127], v2, s[4:7], s24 offen offset:2048 sc1
  buffer_load_dwordx4 v[116:119], v2, s[4:7], s25 offen offset:2048 sc1
  s_add_u32 s14, s14, 1
  s_cmp_ge_i32 s14, s30
  s_cbranch_scc1 T_kvw_106
T_kvb_107:
  s_mov_b32 s19, 0
  s_branch T_loop_102
T_kvw_106:
  s_mov_b32 s19, 0
  s_branch T_kvok_115
T_kv_114:
  s_sleep 4
  s_add_u32 s19, s19, 1
  s_cmp_gt_u32 s19, 32768
  s_cbranch_scc1 M_exit
T_kvok_115:
  s_add_u32 s39, s99, 128
  s_mov_b32 s38, 0
  s_mov_b32 s37, 0
  s_atomic_or s38, s[58:59], s99 glc
  s_atomic_or s37, s[58:59], s39 glc
  s_waitcnt lgkmcnt(0)
  s_lshl_b32 s38, s38, 1
  s_lshl1_add_u32 s37, s37, 1
  s_min_u32 s38, s38, s37
  s_cmp_ge_u32 s38, 64
  s_cselect_b32 s38, 100, s38
  s_sub_u32 s38, s38, 1
  s_max_i32 s30, s30, s38
  s_cmp_ge_i32 s14, s30
  s_cbranch_scc1 T_kv_114
  s_branch T_kvb_107
T_slow_109:
  s_nop 7
  v_max3_f32 v100, v16, v17, v18
  v_max3_f32 v100, v100, v19, v20
  v_max3_f32 v100, v100, v21, v22
  v_max3_f32 v100, v100, v23, v112
  v_max3_f32 v100, v100, v113, v114
  v_max_f32 v100, v100, v115
  v_mov_b32 v101, v100
  s_nop 1
  v_permlane32_swap_b32 v100, v101
  s_nop 1
  v_max_f32 v100, v100, v101
  v_mov_b32 v101, v100
  s_nop 1
  v_permlane16_swap_b32 v100, v101
  s_nop 1
  v_max_f32 v100, v100, v101
  v_sub_f32 v16, v16, v100
  v_sub_f32 v17, v17, v100
  v_sub_f32 v18, v18, v100
  v_sub_f32 v19, v19, v100
  v_exp_f32 v16, v16
  v_exp_f32 v17, v17
  v_exp_f32 v18, v18
  v_exp_f32 v19, v19
  v_sub_f32 v20, v20, v100
  v_sub_f32 v21, v21, v100
  v_sub_f32 v22, v22, v100
  v_sub_f32 v23, v23, v100
  v_exp_f32 v20, v20
  v_exp_f32 v21, v21
  v_exp_f32 v22, v22
  v_exp_f32 v23, v23
  v_sub_f32 v112, v112, v100
  v_sub_f32 v113, v113, v100
  v_sub_f32 v114, v114, v100
  v_sub_f32 v115, v115, v100
  v_exp_f32 v112, v112
  v_exp_f32 v113, v113
  v_exp_f32 v114, v114
  v_exp_f32 v115, v115
  s_nop 0
  v_cvt_pk_bf16_f32 v44, v16, v17
  v_cvt_pk_bf16_f32 v45, v18, v19
  v_cvt_pk_bf16_f32 v46, v20, v21
  v_cvt_pk_bf16_f32 v47, v22, v23
  v_cvt_pk_bf16_f32 v84, v112, v113
  v_cvt_pk_bf16_f32 v85, v114, v115
  v_cndmask_b32 v48, v84, 0, s[16:17]
  v_cndmask_b32 v49, v85, 0, s[16:17]
  v_cndmask_b32 v50, 0, v84, s[16:17]
  v_cndmask_b32 v51, 0, v85, s[16:17]
  s_nop 1
  v_mfma_f32_16x16x16_bf16 v[88:91], v[12:13], v[48:49], 0
  v_mfma_f32_16x16x16_bf16 v[24:27], v[120:121], v[48:49], 0
  v_mfma_f32_16x16x16_bf16 v[116:119], v[120:121], v[50:51], 0
  v_mfma_f32_16x16x32_bf16 v[88:91], v[12:15], v[44:47], v[88:91]
  v_mfma_f32_16x16x32_bf16 v[24:27], v[28:31], v[44:47], v[24:27]
  v_mfma_f32_16x16x32_bf16 v[116:119], v[32:35], v[44:47], v[116:119]
  s_nop 7
  s_nop 1
  s_mov_b32 s96, -1
  s_branch T_back_110
T_w_73:
  s_mov_b32 s19, 0
  s_add_u32 s14, s14, 1
  v_mov_b64 v[16:17], 0
  v_mov_b64 v[18:19], 0
  v_mov_b64 v[20:21], 0
  v_mov_b64 v[22:23], 0
  v_mov_b64 v[24:25], 0
  v_mov_b64 v[26:27], 0
  buffer_load_dwordx4 v[124:127], v2, s[4:7], s24 offen offset:3072 sc1
  buffer_load_dwordx4 v[116:119], v2, s[4:7], s25 offen offset:3072 sc1
  buffer_load_dwordx4 v[124:127], v2, s[4:7], s24 offen offset:3072 sc1
  buffer_load_dwordx4 v[116:119], v2, s[4:7], s25 offen offset:3072 sc1
  s_branch T_loop_116
.p2align 6
T_retry_117:
  s_mov_b64 exec, vcc
  buffer_load_dwordx4 v[124:127], v2, s[4:7], s24 offen offset:3072 sc1
  buffer_load_dwordx4 v[116:119], v2, s[4:7], s25 offen offset:3072 sc1
  s_mov_b64 exec, -1
  s_add_u32 s19, s19, 1
  s_cmp_gt_u32 s19, 32768
  s_cbranch_scc1 M_exit
  s_nop 0
  v_mov_b64 v[16:17], 0
  v_mov_b64 v[18:19], 0
T_loop_116:
  s_waitcnt vmcnt(3) lgkmcnt(0)
  v_max3_u32 v123, v124, v125, v126
  v_max_u32 v123, v123, v127
  v_mov_b32_dpp v120, v124 row_ror:8 row_mask:0xf bank_mask:0xf
  v_mov_b32_dpp v121, v125 row_ror:8 row_mask:0xf bank_mask:0xf
  s_waitcnt vmcnt(2)
  v_max3_u32 v123, v123, v116, v117
  v_max3_u32 v123, v123, v118, v119
  v_cmp_eq_u32 vcc, -1, v123
  v_smfmac_f32_16x16x64_bf16 v[16:19], v[124:127], v[68:75], v0
  s_cbranch_vccnz T_retry_117
  ds_write_b128 v2, v[124:127] offset:3072
  v_mov_b32_dpp v122, v126 row_ror:8 row_mask:0xf bank_mask:0xf
  v_smfmac_f32_16x16x64_bf16 v[20:23], v[124:127], v[76:83], v0
  s_and_b32 s57, s14, 1
  v_mov_b32_dpp v123, v127 row_ror:8 row_mask:0xf bank_mask:0xf
  v_smfmac_f32_16x16x64_bf16 v[24:27], v[124:127], v[84:91], v0
  s_and_b32 s36, s14, 3
  ds_write_b128 v2, v[116:119] offset:7168
  v_smfmac_f32_16x16x64_bf16 v[16:19], v[120:123], v[92:99], v0
  s_lshl_b32 s36, s36, 13
  v_mov_b32_dpp v84, v116 row_ror:8 row_mask:0xf bank_mask:0xf
  v_smfmac_f32_16x16x64_bf16 v[20:23], v[120:123], v[100:107], v0
  s_add_u32 s26, s36, s23
  ds_read_b128 v[68:71], v4 offset:12288
  v_mov_b32_dpp v85, v117 row_ror:8 row_mask:0xf bank_mask:0xf
  v_smfmac_f32_16x16x64_bf16 v[24:27], v[120:123], v[108:115], v0
  s_add_u32 s36, s36, 8192
  ds_read_b128 v[72:75], v4 offset:13312
  v_mov_b32_dpp v86, v118 row_ror:8 row_mask:0xf bank_mask:0xf
  v_smfmac_f32_16x16x64_bf16 v[16:19], v[116:119], v[224:231], v0
  s_and_b32 s36, s36, 0x7fff
  ds_read_b128 v[76:79], v4 offset:14336
  v_mov_b32_dpp v87, v119 row_ror:8 row_mask:0xf bank_mask:0xf
  v_smfmac_f32_16x16x64_bf16 v[20:23], v[116:119], v[240:247], v0
  s_waitcnt lgkmcnt(3)
  s_barrier
  ds_read_b128 v[100:103], v2 offset:2048
  v_smfmac_f32_16x16x64_bf16 v[24:27], v[116:119], a[0:7], v0
  s_mov_b32 m0, s31
  ds_read_b128 v[120:123], v1 offset:2048
  v_smfmac_f32_16x16x64_bf16 v[16:19], v[84:87], v[232:239], v0
  v_smfmac_f32_16x16x64_bf16 v[20:23], v[84:87], v[248:255], v0
  ds_read_b128 v[80:83], v4 offset:15360
  v_smfmac_f32_16x16x64_bf16 v[24:27], v[84:87], a[8:15], v0
  s_waitcnt lgkmcnt(2)
  v_smfmac_f32_16x16x64_bf16 v[16:19], v[100:103], v[128:135], v0
  ds_read_b128 v[92:95], v2 offset:1024
  v_smfmac_f32_16x16x64_bf16 v[20:23], v[100:103], v[144:151], v0
  ds_read_b128 v[96:99], v1 offset:1024
  buffer_load_dwordx4 v9, s[4:7], s27 offen sc1 lds
  v_smfmac_f32_16x16x64_bf16 v[24:27], v[100:103], v[68:75], v0
  s_waitcnt vmcnt(1) lgkmcnt(3)
  ds_read_b128 v[116:119], v2 offset:0
  s_mov_b32 m0, s32
  v_smfmac_f32_16x16x64_bf16 v[16:19], v[120:123], v[136:143], v0
  ds_read_b128 v[124:127], v1 offset:0
  v_smfmac_f32_16x16x64_bf16 v[20:23], v[120:123], v[152:159], v0
  s_waitcnt lgkmcnt(4)
  ds_read_b128 v[104:107], v2 offset:6144
  v_smfmac_f32_16x16x64_bf16 v[24:27], v[120:123], v[76:83], v0
  s_waitcnt lgkmcnt(4)
  ds_read_b128 v[108:111], v1 offset:6144
  buffer_load_dwordx4 v9, s[4:7], s27 offen offset:128 sc1 lds
  v_smfmac_f32_16x16x64_bf16 v[16:19], v[92:95], v[160:167], v0
  s_waitcnt lgkmcnt(4)
  ds_read_b128 v[112:115], v2 offset:5120
  s_mov_b32 m0, s33
  v_smfmac_f32_16x16x64_bf16 v[16:19], v[96:99], v[168:175], v0
  s_waitcnt lgkmcnt(4)
  ds_read_b128 v[84:87], v1 offset:5120
  v_smfmac_f32_16x16x64_bf16 v[16:19], v[116:119], v[192:199], v0
  s_waitcnt lgkmcnt(4)
  ds_read_b128 v[88:91], v2 offset:4096
  v_smfmac_f32_16x16x64_bf16 v[16:19], v[124:127], v[200:207], v0
  s_waitcnt lgkmcnt(4)
  ds_read_b128 v[100:103], v1 offset:4096
  buffer_load_dwordx4 v10, s[4:7], s28 offen sc1 lds
  v_smfmac_f32_16x16x64_bf16 v[16:19], v[104:107], a[16:23], v0
  s_waitcnt lgkmcnt(4)
  ds_read_b128 v[68:71], v4 offset:16384
  s_mov_b32 m0, s34
  v_smfmac_f32_16x16x64_bf16 v[16:19], v[108:111], a[24:31], v0
  s_waitcnt lgkmcnt(4)
  ds_read_b128 v[72:75], v4 offset:17408
  v_smfmac_f32_16x16x64_bf16 v[16:19], v[112:115], a[64:71], v0
  s_waitcnt lgkmcnt(4)
  ds_read_b128 v[76:79], v4 offset:18432
  v_smfmac_f32_16x16x64_bf16 v[16:19], v[84:87], a[72:79], v0
  s_waitcnt lgkmcnt(4)
  ds_read_b128 v[80:83], v4 offset:19456
  buffer_load_dwordx4 v10, s[4:7], s28 offen offset:256 sc1 lds
  v_smfmac_f32_16x16x64_bf16 v[16:19], v[88:91], a[112:119], v0
  s_waitcnt lgkmcnt(4)
  s_mov_b32 m0, 32256
  v_smfmac_f32_16x16x64_bf16 v[16:19], v[100:103], a[120:127], v0
  s_add_u32 s24, s36, 145752064
  s_add_u32 s25, s36, 145756160
  v_smfmac_f32_16x16x64_bf16 v[20:23], v[92:95], v[176:183], v0
  s_add_u32 s35, s36, s23
  v_smfmac_f32_16x16x64_bf16 v[20:23], v[96:99], v[184:191], v0
  s_waitcnt lgkmcnt(2)
  buffer_load_dword v3, s[4:7], s99 offen sc1 lds
  v_smfmac_f32_16x16x64_bf16 v[20:23], v[116:119], v[68:75], v0
  s_waitcnt lgkmcnt(0)
  ds_read_b128 v[68:71], v4 offset:20480
  v_mul_f32 v16, s18, v16
  v_smfmac_f32_16x16x64_bf16 v[20:23], v[124:127], v[76:83], v0
  ds_read_b128 v[72:75], v4 offset:21504
  v_mul_f32 v17, s18, v17
  v_smfmac_f32_16x16x64_bf16 v[20:23], v[104:107], a[32:39], v0
  ds_read_b128 v[76:79], v4 offset:22528
  v_mul_f32 v18, s18, v18
  v_smfmac_f32_16x16x64_bf16 v[20:23], v[108:111], a[40:47], v0
  ds_read_b128 v[80:83], v4 offset:23552
  v_mul_f32 v19, s18, v19
  v_smfmac_f32_16x16x64_bf16 v[20:23], v[112:115], a[80:87], v0
  v_cvt_pk_bf16_f32 v120, v16, v17
  v_smfmac_f32_16x16x64_bf16 v[20:23], v[84:87], a[88:95], v0
  v_cvt_pk_bf16_f32 v121, v18, v19
  v_smfmac_f32_16x16x64_bf16 v[20:23], v[88:91], a[128:135], v0
  ds_write_b64 v5, v[120:121] offset:24576
  v_smfmac_f32_16x16x64_bf16 v[20:23], v[100:103], a[136:143], v0
  s_waitcnt lgkmcnt(3)
  v_smfmac_f32_16x16x64_bf16 v[24:27], v[92:95], v[68:75], v0
  s_waitcnt lgkmcnt(1)
  v_mov_b64 v[92:93], 0
  v_smfmac_f32_16x16x64_bf16 v[24:27], v[96:99], v[76:83], v0
  s_nop 1
  v_cvt_pk_bf16_f32 v122, v20, v21
  v_cvt_pk_bf16_f32 v123, v22, v23
  v_smfmac_f32_16x16x64_bf16 v[24:27], v[116:119], v[208:215], v0
  ds_write_b64 v5, v[122:123] offset:26880
  v_mov_b64 v[94:95], 0
  v_smfmac_f32_16x16x64_bf16 v[24:27], v[124:127], v[216:223], v0
  s_waitcnt lgkmcnt(1)
  s_barrier
  ds_read_b64_tr_b16 v[68:69], v6 offset:24576
  v_smfmac_f32_16x16x64_bf16 v[24:27], v[104:107], a[48:55], v0
  s_add_u32 s27, s27, 8192
  ds_read_b64_tr_b16 v[70:71], v6 offset:24640
  ds_read_b64_tr_b16 v[72:73], v6 offset:24832
  v_smfmac_f32_16x16x64_bf16 v[24:27], v[108:111], a[56:63], v0
  s_add_u32 s28, s28, 8192
  ds_read_b64_tr_b16 v[74:75], v6 offset:24896
  ds_read_b64_tr_b16 v[76:77], v6 offset:25088
  v_smfmac_f32_16x16x64_bf16 v[24:27], v[112:115], a[96:103], v0
  s_nop 0
  ds_read_b64_tr_b16 v[78:79], v6 offset:25152
  ds_read_b64_tr_b16 v[80:81], v6 offset:25344
  v_smfmac_f32_16x16x64_bf16 v[24:27], v[84:87], a[104:111], v0
  ds_read_b64_tr_b16 v[82:83], v6 offset:25408
  v_mov_b64 v[96:97], 0
  v_smfmac_f32_16x16x64_bf16 v[24:27], v[88:91], a[144:151], v0
  s_waitcnt lgkmcnt(8)
  s_barrier
  ds_read_b64_tr_b16 v[116:117], v6 offset:26880
  v_smfmac_f32_16x16x64_bf16 v[24:27], v[100:103], a[152:159], v0
  s_waitcnt lgkmcnt(7)
  ds_read_b64_tr_b16 v[118:119], v6 offset:26944
  v_mfma_f32_16x16x32_bf16 v[16:19], v[36:39], v[68:71], 0
  s_waitcnt lgkmcnt(6)
  ds_read_b64_tr_b16 v[124:125], v6 offset:27136
  ds_read_b64_tr_b16 v[126:127], v6 offset:27200
  v_mfma_f32_16x16x32_bf16 v[16:19], v[40:43], v[72:75], v[16:19]
  s_waitcnt lgkmcnt(6)
  ds_read_b64_tr_b16 v[104:105], v6 offset:27392
  ds_read_b64_tr_b16 v[106:107], v6 offset:27456
  v_mfma_f32_16x16x32_bf16 v[16:19], v[44:47], v[76:79], v[16:19]
  s_waitcnt lgkmcnt(6)
  ds_read_b64_tr_b16 v[108:109], v6 offset:27648
  ds_read_b64_tr_b16 v[110:111], v6 offset:27712
  v_mfma_f32_16x16x32_bf16 v[16:19], v[48:51], v[80:83], v[16:19]
  s_waitcnt lgkmcnt(6)
  v_cvt_pk_bf16_f32 v120, v24, v25
  v_cvt_pk_bf16_f32 v121, v26, v27
  v_mfma_f32_16x16x32_bf16 v[112:115], v[116:119], v[68:71], 0
  s_waitcnt lgkmcnt(4)
  v_mov_b64 v[98:99], 0
  v_mfma_f32_16x16x32_bf16 v[112:115], v[124:127], v[72:75], v[112:115]
  s_waitcnt lgkmcnt(2)
  v_mov_b64 v[36:37], 0
  v_exp_f32 v100, v16
  v_mfma_f32_16x16x32_bf16 v[112:115], v[104:107], v[76:79], v[112:115]
  s_waitcnt lgkmcnt(0)
  v_exp_f32 v101, v17
  v_mfma_f32_16x16x32_bf16 v[112:115], v[108:111], v[80:83], v[112:115]
  buffer_store_dwordx4 v[120:123], v2, s[4:7], s29 offen offset:3072 sc1
  v_exp_f32 v102, v18
  v_mfma_f32_16x16x32_bf16 v[20:23], v[52:55], v[68:71], 0
  v_exp_f32 v103, v19
  v_mfma_f32_16x16x32_bf16 v[20:23], v[56:59], v[72:75], v[20:23]
  v_cvt_pk_bf16_f32 v44, v100, v101
  v_cvt_pk_bf16_f32 v45, v102, v103
  v_mfma_f32_16x16x32_bf16 v[20:23], v[60:63], v[76:79], v[20:23]
  s_add_u32 s29, s29, 131072
  v_exp_f32 v100, v112
  v_mfma_f32_16x16x32_bf16 v[20:23], v[64:67], v[80:83], v[20:23]
  v_exp_f32 v101, v113
  v_exp_f32 v102, v114
  v_exp_f32 v103, v115
  v_cvt_pk_bf16_f32 v84, v100, v101
  v_cvt_pk_bf16_f32 v85, v102, v103
  v_cndmask_b32 v48, v84, 0, s[16:17]
  v_cndmask_b32 v49, v85, 0, s[16:17]
  v_cndmask_b32 v50, 0, v84, s[16:17]
  v_cndmask_b32 v51, 0, v85, s[16:17]
  v_exp_f32 v100, v20
  v_mfma_f32_16x16x16_bf16 v[88:91], v[12:13], v[48:49], 0
  v_exp_f32 v101, v21
  v_mfma_f32_16x16x16_bf16 v[24:27], v[120:121], v[48:49], 0
  v_exp_f32 v102, v22
  v_mfma_f32_16x16x16_bf16 v[116:119], v[120:121], v[50:51], 0
  v_exp_f32 v103, v23
  v_cvt_pk_bf16_f32 v46, v100, v101
  v_cvt_pk_bf16_f32 v47, v102, v103
  v_mov_b64 v[38:39], 0
  s_nop 0
  v_mfma_f32_16x16x32_bf16 v[88:91], v[12:15], v[44:47], v[88:91]
  v_mov_b64 v[40:41], 0
  v_mov_b64 v[42:43], 0
  v_mfma_f32_16x16x32_bf16 v[24:27], v[28:31], v[44:47], v[24:27]
  ds_read_b128 v[52:55], v4 offset:24576
  ds_read_b128 v[56:59], v4 offset:25600
  v_mfma_f32_16x16x32_bf16 v[116:119], v[32:35], v[44:47], v[116:119]
  s_nop 1
T_back_124:
  v_rcp_f32 v89, v88
  v_subrev_u32 v100, s54, v88
  v_cmp_le_u32 vcc, s96, v100
  v_mul_f32 v24, v89, v24
  v_mul_f32 v25, v89, v25
  v_cvt_pk_bf16_f32 v124, v24, v25
  v_pk_mul_f32 v[26:27], v[26:27], v[88:89] op_sel:[0,1] op_sel_hi:[1,1]
  v_cvt_pk_bf16_f32 v125, v26, v27
  ds_write_b64 v11, v[124:125] offset:30720
  v_pk_mul_f32 v[116:117], v[116:117], v[88:89] op_sel:[0,1] op_sel_hi:[1,1]
  v_pk_mul_f32 v[118:119], v[118:119], v[88:89] op_sel:[0,1] op_sel_hi:[1,1]
  v_cvt_pk_bf16_f32 v126, v116, v117
  v_cvt_pk_bf16_f32 v127, v118, v119
  ds_write_b64 v11, v[126:127] offset:30728
  s_cbranch_vccnz T_slow_123
  v_smfmac_f32_16x16x64_bf16 v[92:95], v[124:127], a[160:167], v0
  s_mov_b32 s96, s55
  v_smfmac_f32_16x16x64_bf16 v[96:99], v[124:127], a[168:175], v0
  s_cmp_eq_u32 s14, 63
  v_smfmac_f32_16x16x64_bf16 v[36:39], v[124:127], a[176:183], v0
  s_waitcnt lgkmcnt(0)
  s_barrier
  ds_read_b128 v[104:107], v11 offset:30208
  ds_read_b128 v[108:111], v11 offset:29696
  ds_read_b128 v[68:71], v11 offset:29184
  s_cbranch_scc1 M_tdone
  v_smfmac_f32_16x16x64_bf16 v[40:43], v[124:127], a[184:191], v0
  s_waitcnt lgkmcnt(2)
  v_smfmac_f32_16x16x64_bf16 v[92:95], v[104:107], a[192:199], v0
  s_waitcnt lgkmcnt(1)
  ds_read_b128 v[76:79], v4 offset:28672
  v_smfmac_f32_16x16x64_bf16 v[92:95], v[108:111], a[224:231], v0
  s_waitcnt lgkmcnt(1)
  ds_read_b128 v[80:83], v4 offset:29696
  v_smfmac_f32_16x16x64_bf16 v[92:95], v[68:71], a[240:247], v0
  ds_read_b128 v[60:63], v4 offset:26624
  v_smfmac_f32_16x16x64_bf16 v[96:99], v[104:107], a[200:207], v0
  ds_read_b128 v[64:67], v4 offset:27648
  v_smfmac_f32_16x16x64_bf16 v[96:99], v[108:111], a[232:239], v0
  ds_read_b128 v[28:31], v4 offset:30720
  s_nop 0
  v_cvt_pk_bf16_f32 v16, v92, v93
  v_cvt_pk_bf16_f32 v17, v94, v95
  v_bfi_b32 v16, 1, s57, v16
  v_smfmac_f32_16x16x64_bf16 v[96:99], v[68:71], a[248:255], v0
  buffer_store_dwordx2 v[16:17], v7, s[4:7], s20 offen offset:0 sc1
  v_smfmac_f32_16x16x64_bf16 v[36:39], v[104:107], a[208:215], v0
  ds_read_b128 v[32:35], v4 offset:31744
  v_smfmac_f32_16x16x64_bf16 v[36:39], v[108:111], v[52:59], v0
  s_waitcnt lgkmcnt(4)
  s_nop 0
  v_cvt_pk_bf16_f32 v18, v96, v97
  v_cvt_pk_bf16_f32 v19, v98, v99
  v_bfi_b32 v18, 1, s57, v18
  v_smfmac_f32_16x16x64_bf16 v[36:39], v[68:71], v[76:83], v0
  buffer_store_dwordx2 v[18:19], v7, s[4:7], s20 offen offset:64 sc1
  v_smfmac_f32_16x16x64_bf16 v[40:43], v[104:107], a[216:223], v0
  s_waitcnt lgkmcnt(2)
  v_smfmac_f32_16x16x64_bf16 v[40:43], v[108:111], v[60:67], v0
  s_waitcnt lgkmcnt(0)
  s_nop 0
  v_cvt_pk_bf16_f32 v20, v36, v37
  v_cvt_pk_bf16_f32 v21, v38, v39
  v_bfi_b32 v20, 1, s57, v20
  v_smfmac_f32_16x16x64_bf16 v[40:43], v[68:71], v[28:35], v0
  buffer_store_dwordx2 v[20:21], v7, s[4:7], s21 offen offset:0 sc1
  s_nop 6
  v_cvt_pk_bf16_f32 v22, v40, v41
  v_cvt_pk_bf16_f32 v23, v42, v43
  v_bfi_b32 v22, 1, s57, v22
  buffer_store_dwordx2 v[22:23], v7, s[4:7], s21 offen offset:64 sc1
  ds_read_b128 v[68:71], v4 offset:0
  ds_read_b128 v[72:75], v4 offset:1024
  ds_read_b128 v[76:79], v4 offset:4096
  ds_read_b128 v[80:83], v4 offset:5120
  ds_read_b128 v[84:87], v4 offset:8192
  ds_read_b128 v[88:91], v4 offset:9216
  ds_read_b128 v[92:95], v4 offset:2048
  ds_read_b128 v[96:99], v4 offset:3072
  ds_read_b128 v[100:103], v4 offset:6144
  ds_read_b128 v[104:107], v4 offset:7168
  ds_read_b128 v[108:111], v4 offset:10240
  ds_read_b128 v[112:115], v4 offset:11264
  v_mov_b64 v[16:17], 0
  v_mov_b64 v[18:19], 0
  v_mov_b64 v[20:21], 0
  v_mov_b64 v[22:23], 0
  v_mov_b64 v[24:25], 0
  v_mov_b64 v[26:27], 0
  ds_read_b64 v[44:45], v2 offset:32256
  s_waitcnt lgkmcnt(0)
  v_readfirstlane_b32 s38, v44
  v_readfirstlane_b32 s37, v45
  s_nop 0
  s_lshl_b32 s38, s38, 1
  s_lshl1_add_u32 s37, s37, 1
  s_min_u32 s38, s38, s37
  s_cmp_ge_u32 s38, 64
  s_cselect_b32 s38, 100, s38
  s_sub_u32 s38, s38, 1
  s_max_i32 s30, s30, s38
  s_waitcnt vmcnt(4)
  s_barrier
  ds_read_b128 v[28:31], v2 offset:19456
  ds_read_b128 v[32:35], v2 offset:23552
  ds_read_b128 v[36:39], v2 offset:8192
  ds_read_b128 v[40:43], v2 offset:9216
  ds_read_b128 v[44:47], v2 offset:10240
  ds_read_b128 v[48:51], v2 offset:11264
  buffer_load_dwordx4 v[124:127], v2, s[4:7], s24 offen offset:3072 sc1
  buffer_load_dwordx4 v[116:119], v2, s[4:7], s25 offen offset:3072 sc1
  ds_read_b128 v[52:55], v2 offset:12288
  ds_read_b128 v[56:59], v2 offset:13312
  ds_read_b128 v[60:63], v2 offset:14336
  ds_read_b128 v[64:67], v2 offset:15360
  buffer_load_dwordx4 v[124:127], v2, s[4:7], s24 offen offset:3072 sc1
  buffer_load_dwordx4 v[116:119], v2, s[4:7], s25 offen offset:3072 sc1
  s_add_u32 s14, s14, 1
  s_cmp_ge_i32 s14, s30
  s_cbranch_scc1 T_kvw_120
T_kvb_121:
  s_mov_b32 s19, 0
  s_branch T_loop_116
T_kvw_120:
  s_mov_b32 s19, 0
  s_branch T_kvok_129
T_kv_128:
  s_sleep 4
  s_add_u32 s19, s19, 1
  s_cmp_gt_u32 s19, 32768
  s_cbranch_scc1 M_exit
T_kvok_129:
  s_add_u32 s39, s99, 128
  s_mov_b32 s38, 0
  s_mov_b32 s37, 0
  s_atomic_or s38, s[58:59], s99 glc
  s_atomic_or s37, s[58:59], s39 glc
  s_waitcnt lgkmcnt(0)
  s_lshl_b32 s38, s38, 1
  s_lshl1_add_u32 s37, s37, 1
  s_min_u32 s38, s38, s37
  s_cmp_ge_u32 s38, 64
  s_cselect_b32 s38, 100, s38
  s_sub_u32 s38, s38, 1
  s_max_i32 s30, s30, s38
  s_cmp_ge_i32 s14, s30
  s_cbranch_scc1 T_kv_128
  s_branch T_kvb_121
T_slow_123:
  s_nop 7
  v_max3_f32 v100, v16, v17, v18
  v_max3_f32 v100, v100, v19, v20
  v_max3_f32 v100, v100, v21, v22
  v_max3_f32 v100, v100, v23, v112
  v_max3_f32 v100, v100, v113, v114
  v_max_f32 v100, v100, v115
  v_mov_b32 v101, v100
  s_nop 1
  v_permlane32_swap_b32 v100, v101
  s_nop 1
  v_max_f32 v100, v100, v101
  v_mov_b32 v101, v100
  s_nop 1
  v_permlane16_swap_b32 v100, v101
  s_nop 1
  v_max_f32 v100, v100, v101
  v_sub_f32 v16, v16, v100
  v_sub_f32 v17, v17, v100
  v_sub_f32 v18, v18, v100
  v_sub_f32 v19, v19, v100
  v_exp_f32 v16, v16
  v_exp_f32 v17, v17
  v_exp_f32 v18, v18
  v_exp_f32 v19, v19
  v_sub_f32 v20, v20, v100
  v_sub_f32 v21, v21, v100
  v_sub_f32 v22, v22, v100
  v_sub_f32 v23, v23, v100
  v_exp_f32 v20, v20
  v_exp_f32 v21, v21
  v_exp_f32 v22, v22
  v_exp_f32 v23, v23
  v_sub_f32 v112, v112, v100
  v_sub_f32 v113, v113, v100
  v_sub_f32 v114, v114, v100
  v_sub_f32 v115, v115, v100
  v_exp_f32 v112, v112
  v_exp_f32 v113, v113
  v_exp_f32 v114, v114
  v_exp_f32 v115, v115
  s_nop 0
  v_cvt_pk_bf16_f32 v44, v16, v17
  v_cvt_pk_bf16_f32 v45, v18, v19
  v_cvt_pk_bf16_f32 v46, v20, v21
  v_cvt_pk_bf16_f32 v47, v22, v23
  v_cvt_pk_bf16_f32 v84, v112, v113
  v_cvt_pk_bf16_f32 v85, v114, v115
  v_cndmask_b32 v48, v84, 0, s[16:17]
  v_cndmask_b32 v49, v85, 0, s[16:17]
  v_cndmask_b32 v50, 0, v84, s[16:17]
  v_cndmask_b32 v51, 0, v85, s[16:17]
  s_nop 1
  v_mfma_f32_16x16x16_bf16 v[88:91], v[12:13], v[48:49], 0
  v_mfma_f32_16x16x16_bf16 v[24:27], v[120:121], v[48:49], 0
  v_mfma_f32_16x16x16_bf16 v[116:119], v[120:121], v[50:51], 0
  v_mfma_f32_16x16x32_bf16 v[88:91], v[12:15], v[44:47], v[88:91]
  v_mfma_f32_16x16x32_bf16 v[24:27], v[28:31], v[44:47], v[24:27]
  v_mfma_f32_16x16x32_bf16 v[116:119], v[32:35], v[44:47], v[116:119]
  s_nop 7
  s_nop 1
  s_mov_b32 s96, -1
  s_branch T_back_124
M_tdone:
  v_mov_b32 v16, 64
  v_or_b32 v17, s13, v2
  v_min_u32 v17, 1, v17
  v_lshlrev_b32 v17, 30, v17
  s_waitcnt vmcnt(0)
  s_barrier
  buffer_store_dword v16, v17, s[4:7], s15 offen sc1
  s_branch M_done
M_worker:
  s_load_dwordx4 s[72:75], s[0:1], 120
  v_lshrrev_b32 v3, 6, v0
  v_and_b32 v1, 63, v0
  v_readfirstlane_b32 s16, v3
  v_lshlrev_b32 v2, 4, v1
  s_waitcnt lgkmcnt(0)
  s_mov_b64 s[4:5], s[74:75]
  s_mov_b64 s[74:75], s[72:73]
  s_mov_b64 s[72:73], s[4:5]
  s_and_b32 s5, s5, 0xffff
  s_mov_b32 s6, 268435456
  s_mov_b32 s7, 0x20000
  s_sub_u32 s66, s76, 1
  s_lshl_b32 s66, s66, 5
  s_add_u32 s66, s66, s77
  s_mul_i32 s64, s66, 9363
  s_lshr_b32 s64, s64, 16
  s_mul_i32 s67, s64, 7
  s_sub_u32 s65, s66, s67
  s_lshl_b32 s31, s66, 7
  s_add_u32 s31, s31, 148897792
  s_lshl_b32 s67, s67, 7
  s_add_u32 s67, s67, 148897792
  s_getpc_b64 s[76:77]
M_pc:
  s_add_u32 s76, s76, M_table-M_pc
  s_addc_u32 s77, s77, 0
  s_lshl_b32 s26, s65, 6
  s_load_dwordx16 s[48:63], s[76:77], s26
  s_waitcnt lgkmcnt(0)
  s_mov_b32 s23, s51
  s_cmp_lg_u32 s48, 1
  s_cbranch_scc1 M_nobpf
  s_load_dwordx8 s[36:43], s[0:1], 64
  s_mul_i32 s76, s64, 3
  s_add_u32 s76, s76, s57
  v_lshlrev_b32 v4, 7, v0
  s_mov_b32 s10, 4194304
  s_mov_b32 s11, 0x20000
  s_waitcnt lgkmcnt(0)
  s_mov_b32 s8, s42
  s_and_b32 s9, s43, 0xffff
  s_mul_i32 s77, s76, 43776
  s_add_u32 s77, s77, 0
  v_min_u32 v5, 32640, v4
  v_add_u32 v5, s77, v5
  s_add_u32 s77, s77, 32768
  buffer_load_dword v6, v5, s[8:11], 0 offen
  v_min_u32 v5, 10880, v4
  v_add_u32 v5, s77, v5
  s_add_u32 s77, s77, 32768
  buffer_load_dword v6, v5, s[8:11], 0 offen
  s_mov_b32 s8, s38
  s_and_b32 s9, s39, 0xffff
  s_mul_i32 s77, s76, 21888
  s_add_u32 s77, s77, 2097152
  v_min_u32 v5, 21760, v4
  v_add_u32 v5, s77, v5
  s_add_u32 s77, s77, 32768
  buffer_load_dword v6, v5, s[8:11], 0 offen
  s_mov_b32 s8, s40
  s_and_b32 s9, s41, 0xffff
  s_mul_i32 s77, s76, 21888
  s_add_u32 s77, s77, 2097152
  v_min_u32 v5, 21760, v4
  v_add_u32 v5, s77, v5
  s_add_u32 s77, s77, 32768
  buffer_load_dword v6, v5, s[8:11], 0 offen
  s_mov_b32 s8, s36
  s_and_b32 s9, s37, 0xffff
  s_mul_i32 s77, s76, 21888
  s_add_u32 s77, s77, 2097152
  v_min_u32 v5, 21760, v4
  v_add_u32 v5, s77, v5
  s_add_u32 s77, s77, 32768
  buffer_load_dword v6, v5, s[8:11], 0 offen
  s_waitcnt vmcnt(0)
M_nobpf:
  s_lshr_b32 s29, s16, 1
  s_cmp_eq_u32 s29, 0
  s_cselect_b32 s26, 2, 8
  s_cselect_b32 s27, 3, 4
  s_cselect_b32 s28, 9, 10
  s_cmp_eq_u32 s48, 1
  s_cselect_b32 s26, s27, s26
  s_cmp_eq_u32 s48, 2
  s_cselect_b32 s26, s28, s26
  s_lshl_b32 s26, s26, 3
  s_load_dwordx2 s[8:9], s[0:1], s26
  s_cmp_eq_u32 s48, 1
  s_cselect_b32 s26, 8, 0
  s_load_dwordx2 s[12:13], s[0:1], s26
  s_cmp_eq_u32 s29, 0
  s_cselect_b32 s21, 0, 3
  s_cselect_b32 s27, 1, 2
  s_cselect_b32 s28, 4, 5
  s_cmp_eq_u32 s48, 1
  s_cselect_b32 s21, s27, s21
  s_cmp_eq_u32 s48, 2
  s_cselect_b32 s21, s28, s21
  s_lshl_b32 s21, s21, 5
  s_add_u32 s21, s21, s64
  s_lshl_b32 s21, s21, 6
  s_add_u32 s21, s21, s49
  s_and_b32 s27, s16, 1
  s_lshl_b32 s21, s21, 1
  s_add_u32 s21, s21, s27
  s_lshl_b32 s21, s21, 12
  s_lshl_b32 s22, s50, 13
  s_lshl_b32 s19, s49, 15
  s_lshl_b32 s20, s50, 15
  s_lshl_b32 s17, s64, 1
  s_add_u32 s17, s17, s27
  s_lshl_b32 s17, s17, 7
  s_mov_b32 s18, 8192
  s_mov_b32 s24, 0x3e0293ee
  s_waitcnt lgkmcnt(0)
  s_and_b32 s9, s9, 0xffff
  s_mov_b32 s10, 4194304
  s_mov_b32 s11, 0x20000
  s_and_b32 s13, s13, 0xffff
  s_mov_b32 s14, 2097152
  s_mov_b32 s15, 0x20000
  s_cmp_eq_u32 s48, 0
  s_cselect_b32 s32, 0, s16
  s_lshr_b32 s32, s32, 1
  v_lshrrev_b32 v144, 4, v1
  v_and_b32 v56, 0xff, v2
  v_lshl_add_u32 v56, v144, 9, v56
  v_and_b32 v146, 15, v1
  v_and_b32 v144, 8, v1
  v_add_u32 v144, v144, v146
  s_cmp_lg_u32 s32, 0
  s_cselect_b64 vcc, -1, 0
  s_cselect_b32 s26, 8, 16
  v_cndmask_b32 v144, v146, v144, vcc
  v_lshrrev_b32 v145, 4, v1
  v_add_u32 v148, s26, v144
  v_xor_b32 v147, 0, v145
  v_xor_b32 v147, v147, v146
  v_lshlrev_b32 v147, 4, v147
  v_lshl_add_u32 v8, v144, 8, v147
  v_xor_b32 v147, 8, v145
  v_xor_b32 v147, v147, v146
  v_lshlrev_b32 v147, 4, v147
  v_lshl_add_u32 v9, v148, 8, v147
  v_xor_b32 v147, 4, v145
  v_xor_b32 v147, v147, v146
  v_lshlrev_b32 v147, 4, v147
  v_lshl_add_u32 v10, v144, 8, v147
  v_xor_b32 v147, 12, v145
  v_xor_b32 v147, v147, v146
  v_lshlrev_b32 v147, 4, v147
  v_lshl_add_u32 v11, v148, 8, v147
  v_xor_b32 v147, 8, v145
  v_xor_b32 v147, v147, v146
  v_lshlrev_b32 v147, 4, v147
  v_lshl_add_u32 v12, v144, 8, v147
  v_xor_b32 v147, 0, v145
  v_xor_b32 v147, v147, v146
  v_lshlrev_b32 v147, 4, v147
  v_lshl_add_u32 v13, v148, 8, v147
  v_xor_b32 v147, 12, v145
  v_xor_b32 v147, v147, v146
  v_lshlrev_b32 v147, 4, v147
  v_lshl_add_u32 v14, v144, 8, v147
  v_xor_b32 v147, 4, v145
  v_xor_b32 v147, v147, v146
  v_lshlrev_b32 v147, 4, v147
  v_lshl_add_u32 v15, v148, 8, v147
  v_lshrrev_b32 v144, 4, v1
  s_lshl_b32 s26, s16, 8
  v_add_u32 v145, 0, v144
  v_or_b32 v147, 0, v144
  v_xor_b32 v147, v147, v146
  v_lshlrev_b32 v147, 4, v147
  v_lshl_add_u32 v147, v145, 10, v147
  v_add_u32 v16, s26, v147
  v_add_u32 v145, 4, v144
  v_or_b32 v147, 4, v144
  v_xor_b32 v147, v147, v146
  v_lshlrev_b32 v147, 4, v147
  v_lshl_add_u32 v147, v145, 10, v147
  v_add_u32 v17, s26, v147
  v_add_u32 v145, 8, v144
  v_or_b32 v147, 8, v144
  v_xor_b32 v147, v147, v146
  v_lshlrev_b32 v147, 4, v147
  v_lshl_add_u32 v147, v145, 10, v147
  v_add_u32 v18, s26, v147
  v_add_u32 v145, 12, v144
  v_or_b32 v147, 12, v144
  v_xor_b32 v147, v147, v146
  v_lshlrev_b32 v147, 4, v147
  v_lshl_add_u32 v147, v145, 10, v147
  v_add_u32 v19, s26, v147
  v_add_u32 v145, 16, v144
  v_or_b32 v147, 8, v144
  v_xor_b32 v147, v147, v146
  v_lshlrev_b32 v147, 4, v147
  v_lshl_add_u32 v147, v145, 10, v147
  v_add_u32 v20, s26, v147
  v_add_u32 v145, 20, v144
  v_or_b32 v147, 12, v144
  v_xor_b32 v147, v147, v146
  v_lshlrev_b32 v147, 4, v147
  v_lshl_add_u32 v147, v145, 10, v147
  v_add_u32 v21, s26, v147
  v_add_u32 v145, 24, v144
  v_or_b32 v147, 0, v144
  v_xor_b32 v147, v147, v146
  v_lshlrev_b32 v147, 4, v147
  v_lshl_add_u32 v147, v145, 10, v147
  v_add_u32 v22, s26, v147
  v_add_u32 v145, 28, v144
  v_or_b32 v147, 4, v144
  v_xor_b32 v147, v147, v146
  v_lshlrev_b32 v147, 4, v147
  v_lshl_add_u32 v147, v145, 10, v147
  v_add_u32 v23, s26, v147
  v_lshrrev_b32 v144, 3, v1
  v_mul_lo_u32 v144, v144, s18
  v_and_b32 v145, 7, v1
  v_lshl_add_u32 v144, v145, 4, v144
  s_lshl_b32 s28, s16, 15
  s_add_u32 s28, s28, 32768
  s_lshl_b32 s29, s18, 3
  s_add_u32 m0, s28, 0
  s_nop 0
  buffer_load_dwordx4 v144, s[8:11], s17 offen lds
  s_add_u32 s17, s17, s29
  s_add_u32 m0, s28, 1024
  s_nop 0
  buffer_load_dwordx4 v144, s[8:11], s17 offen lds
  s_add_u32 s17, s17, s29
  s_add_u32 m0, s28, 2048
  s_nop 0
  buffer_load_dwordx4 v144, s[8:11], s17 offen lds
  s_add_u32 s17, s17, s29
  s_add_u32 m0, s28, 3072
  s_nop 0
  buffer_load_dwordx4 v144, s[8:11], s17 offen lds
  s_add_u32 s17, s17, s29
  s_add_u32 m0, s28, 4096
  s_nop 0
  buffer_load_dwordx4 v144, s[8:11], s17 offen lds
  s_add_u32 s17, s17, s29
  s_add_u32 m0, s28, 5120
  s_nop 0
  buffer_load_dwordx4 v144, s[8:11], s17 offen lds
  s_add_u32 s17, s17, s29
  s_add_u32 m0, s28, 6144
  s_nop 0
  buffer_load_dwordx4 v144, s[8:11], s17 offen lds
  s_add_u32 s17, s17, s29
  s_add_u32 m0, s28, 7168
  s_nop 0
  buffer_load_dwordx4 v144, s[8:11], s17 offen lds
  s_add_u32 s17, s17, s29
  s_add_u32 m0, s28, 8192
  s_nop 0
  buffer_load_dwordx4 v144, s[8:11], s17 offen lds
  s_add_u32 s17, s17, s29
  s_add_u32 m0, s28, 9216
  s_nop 0
  buffer_load_dwordx4 v144, s[8:11], s17 offen lds
  s_add_u32 s17, s17, s29
  s_add_u32 m0, s28, 10240
  s_nop 0
  buffer_load_dwordx4 v144, s[8:11], s17 offen lds
  s_add_u32 s17, s17, s29
  s_add_u32 m0, s28, 11264
  s_nop 0
  buffer_load_dwordx4 v144, s[8:11], s17 offen lds
  s_add_u32 s17, s17, s29
  s_add_u32 m0, s28, 12288
  s_nop 0
  buffer_load_dwordx4 v144, s[8:11], s17 offen lds
  s_add_u32 s17, s17, s29
  s_add_u32 m0, s28, 13312
  s_nop 0
  buffer_load_dwordx4 v144, s[8:11], s17 offen lds
  s_add_u32 s17, s17, s29
  s_add_u32 m0, s28, 14336
  s_nop 0
  buffer_load_dwordx4 v144, s[8:11], s17 offen lds
  s_add_u32 s17, s17, s29
  s_add_u32 m0, s28, 15360
  s_nop 0
  buffer_load_dwordx4 v144, s[8:11], s17 offen lds
  s_add_u32 s17, s17, s29
  s_add_u32 m0, s28, 16384
  s_nop 0
  buffer_load_dwordx4 v144, s[8:11], s17 offen lds
  s_add_u32 s17, s17, s29
  s_add_u32 m0, s28, 17408
  s_nop 0
  buffer_load_dwordx4 v144, s[8:11], s17 offen lds
  s_add_u32 s17, s17, s29
  s_add_u32 m0, s28, 18432
  s_nop 0
  buffer_load_dwordx4 v144, s[8:11], s17 offen lds
  s_add_u32 s17, s17, s29
  s_add_u32 m0, s28, 19456
  s_nop 0
  buffer_load_dwordx4 v144, s[8:11], s17 offen lds
  s_add_u32 s17, s17, s29
  s_add_u32 m0, s28, 20480
  s_nop 0
  buffer_load_dwordx4 v144, s[8:11], s17 offen lds
  s_add_u32 s17, s17, s29
  s_add_u32 m0, s28, 21504
  s_nop 0
  buffer_load_dwordx4 v144, s[8:11], s17 offen lds
  s_add_u32 s17, s17, s29
  s_add_u32 m0, s28, 22528
  s_nop 0
  buffer_load_dwordx4 v144, s[8:11], s17 offen lds
  s_add_u32 s17, s17, s29
  s_add_u32 m0, s28, 23552
  s_nop 0
  buffer_load_dwordx4 v144, s[8:11], s17 offen lds
  s_add_u32 s17, s17, s29
  s_add_u32 m0, s28, 24576
  s_nop 0
  buffer_load_dwordx4 v144, s[8:11], s17 offen lds
  s_add_u32 s17, s17, s29
  s_add_u32 m0, s28, 25600
  s_nop 0
  buffer_load_dwordx4 v144, s[8:11], s17 offen lds
  s_add_u32 s17, s17, s29
  s_add_u32 m0, s28, 26624
  s_nop 0
  buffer_load_dwordx4 v144, s[8:11], s17 offen lds
  s_add_u32 s17, s17, s29
  s_add_u32 m0, s28, 27648
  s_nop 0
  buffer_load_dwordx4 v144, s[8:11], s17 offen lds
  s_add_u32 s17, s17, s29
  s_add_u32 m0, s28, 28672
  s_nop 0
  buffer_load_dwordx4 v144, s[8:11], s17 offen lds
  s_add_u32 s17, s17, s29
  s_add_u32 m0, s28, 29696
  s_nop 0
  buffer_load_dwordx4 v144, s[8:11], s17 offen lds
  s_add_u32 s17, s17, s29
  s_add_u32 m0, s28, 30720
  s_nop 0
  buffer_load_dwordx4 v144, s[8:11], s17 offen lds
  s_add_u32 s17, s17, s29
  s_add_u32 m0, s28, 31744
  s_nop 0
  buffer_load_dwordx4 v144, s[8:11], s17 offen lds
  s_add_u32 s17, s17, s29
  s_lshl_b32 s25, s16, 13
  s_add_u32 m0, s25, 0
  s_nop 0
  buffer_load_dwordx4 v16, s[12:15], s19 offen lds
  s_add_u32 m0, s25, 1024
  s_nop 0
  buffer_load_dwordx4 v17, s[12:15], s19 offen lds
  s_add_u32 m0, s25, 2048
  s_nop 0
  buffer_load_dwordx4 v18, s[12:15], s19 offen lds
  s_add_u32 m0, s25, 3072
  s_nop 0
  buffer_load_dwordx4 v19, s[12:15], s19 offen lds
  s_add_u32 m0, s25, 4096
  s_nop 0
  buffer_load_dwordx4 v20, s[12:15], s19 offen lds
  s_add_u32 m0, s25, 5120
  s_nop 0
  buffer_load_dwordx4 v21, s[12:15], s19 offen lds
  s_add_u32 m0, s25, 6144
  s_nop 0
  buffer_load_dwordx4 v22, s[12:15], s19 offen lds
  s_add_u32 m0, s25, 7168
  s_nop 0
  buffer_load_dwordx4 v23, s[12:15], s19 offen lds
  s_cmp_gt_u32 s23, 1
  s_cselect_b32 s26, s20, 0
  s_add_u32 s19, s19, s26
  s_add_u32 s25, s25, 32768
  s_and_b32 s25, s25, 0x1ffff
  s_cmp_lg_u32 s16, 3
  s_cbranch_scc1 M_noinit
  s_mov_b32 s79, 0
  s_atomic_swap s79, s[72:73], s31 glc
  s_waitcnt lgkmcnt(0)
  s_mov_b32 s79, 1
  s_atomic_add s79, s[74:75], 128
M_noinit:
  s_cmp_lg_u32 s65, 3
  s_cbranch_scc1 M_noarm
  v_lshlrev_b32 v4, 4, v0
  v_mov_b64 v[60:61], -1
  v_mov_b64 v[62:63], -1
  s_mul_i32 s76, s64, 4096
  s_add_u32 s77, s76, 142868480
  buffer_store_dwordx4 v[60:63], v4, s[4:7], s77 offen sc1
  s_add_u32 s77, s76, 142999552
  buffer_store_dwordx4 v[60:63], v4, s[4:7], s77 offen sc1
  s_add_u32 s77, s76, 143130624
  buffer_store_dwordx4 v[60:63], v4, s[4:7], s77 offen sc1
  s_add_u32 s77, s76, 143261696
  buffer_store_dwordx4 v[60:63], v4, s[4:7], s77 offen sc1
  s_add_u32 s77, s76, 143392768
  buffer_store_dwordx4 v[60:63], v4, s[4:7], s77 offen sc1
  s_add_u32 s77, s76, 143523840
  buffer_store_dwordx4 v[60:63], v4, s[4:7], s77 offen sc1
M_noarm:
  s_mul_i32 s76, s64, 3
  s_add_u32 s76, s76, s57
  s_mul_i32 s76, s76, 24576
  v_lshlrev_b32 v4, 7, v0
  v_add_u32 v4, s76, v4
  buffer_load_dword v5, v4, s[12:15], 0 offen
  v_bfe_u32 v148, v1, 2, 2
  v_lshrrev_b32 v149, 5, v1
  v_lshl_add_u32 v148, v149, 4, v148
  v_bfe_u32 v149, v1, 4, 1
  v_lshl_add_u32 v148, v149, 3, v148
  v_and_b32 v149, 3, v1
  v_and_b32 v150, 2, v149
  v_add_u32 v150, v150, v149
  s_cmp_lg_u32 s32, 0
  s_cselect_b64 vcc, -1, 0
  s_cselect_b32 s26, 32, 16
  v_cndmask_b32 v149, v150, v149, vcc
  v_lshlrev_b32 v149, 3, v149
  v_lshl_add_u32 v148, v148, 7, v149
  v_add_u32 v152, s28, v148
  v_add_u32 v153, 512, v152
  v_add_u32 v154, s26, v152
  v_add_u32 v155, s26, v153
  s_waitcnt vmcnt(37)
  ds_read_b64_tr_b16 a[0:1], v152 offset:0
  ds_read_b64_tr_b16 a[2:3], v153 offset:0
  ds_read_b64_tr_b16 a[4:5], v154 offset:0
  ds_read_b64_tr_b16 a[6:7], v155 offset:0
  ds_read_b64_tr_b16 a[8:9], v152 offset:64
  ds_read_b64_tr_b16 a[10:11], v153 offset:64
  ds_read_b64_tr_b16 a[12:13], v154 offset:64
  ds_read_b64_tr_b16 a[14:15], v155 offset:64
  s_waitcnt lgkmcnt(0)
  s_add_u32 m0, s28, 0
  s_nop 0
  buffer_load_dwordx4 v144, s[8:11], s17 offen lds
  s_add_u32 s17, s17, s29
  s_add_u32 m0, s28, 1024
  s_nop 0
  buffer_load_dwordx4 v144, s[8:11], s17 offen lds
  s_add_u32 s17, s17, s29
  s_add_u32 m0, s28, 2048
  s_nop 0
  buffer_load_dwordx4 v144, s[8:11], s17 offen lds
  s_add_u32 s17, s17, s29
  s_add_u32 m0, s28, 3072
  s_nop 0
  buffer_load_dwordx4 v144, s[8:11], s17 offen lds
  s_add_u32 s17, s17, s29
  s_waitcnt vmcnt(37)
  ds_read_b64_tr_b16 a[16:17], v152 offset:4096
  ds_read_b64_tr_b16 a[18:19], v153 offset:4096
  ds_read_b64_tr_b16 a[20:21], v154 offset:4096
  ds_read_b64_tr_b16 a[22:23], v155 offset:4096
  ds_read_b64_tr_b16 a[24:25], v152 offset:4160
  ds_read_b64_tr_b16 a[26:27], v153 offset:4160
  ds_read_b64_tr_b16 a[28:29], v154 offset:4160
  ds_read_b64_tr_b16 a[30:31], v155 offset:4160
  s_waitcnt lgkmcnt(0)
  s_add_u32 m0, s28, 4096
  s_nop 0
  buffer_load_dwordx4 v144, s[8:11], s17 offen lds
  s_add_u32 s17, s17, s29
  s_add_u32 m0, s28, 5120
  s_nop 0
  buffer_load_dwordx4 v144, s[8:11], s17 offen lds
  s_add_u32 s17, s17, s29
  s_add_u32 m0, s28, 6144
  s_nop 0
  buffer_load_dwordx4 v144, s[8:11], s17 offen lds
  s_add_u32 s17, s17, s29
  s_add_u32 m0, s28, 7168
  s_nop 0
  buffer_load_dwordx4 v144, s[8:11], s17 offen lds
  s_add_u32 s17, s17, s29
  s_waitcnt vmcnt(37)
  ds_read_b64_tr_b16 a[32:33], v152 offset:8192
  ds_read_b64_tr_b16 a[34:35], v153 offset:8192
  ds_read_b64_tr_b16 a[36:37], v154 offset:8192
  ds_read_b64_tr_b16 a[38:39], v155 offset:8192
  ds_read_b64_tr_b16 a[40:41], v152 offset:8256
  ds_read_b64_tr_b16 a[42:43], v153 offset:8256
  ds_read_b64_tr_b16 a[44:45], v154 offset:8256
  ds_read_b64_tr_b16 a[46:47], v155 offset:8256
  s_waitcnt lgkmcnt(0)
  s_add_u32 m0, s28, 8192
  s_nop 0
  buffer_load_dwordx4 v144, s[8:11], s17 offen lds
  s_add_u32 s17, s17, s29
  s_add_u32 m0, s28, 9216
  s_nop 0
  buffer_load_dwordx4 v144, s[8:11], s17 offen lds
  s_add_u32 s17, s17, s29
  s_add_u32 m0, s28, 10240
  s_nop 0
  buffer_load_dwordx4 v144, s[8:11], s17 offen lds
  s_add_u32 s17, s17, s29
  s_add_u32 m0, s28, 11264
  s_nop 0
  buffer_load_dwordx4 v144, s[8:11], s17 offen lds
  s_add_u32 s17, s17, s29
  s_waitcnt vmcnt(37)
  ds_read_b64_tr_b16 a[48:49], v152 offset:12288
  ds_read_b64_tr_b16 a[50:51], v153 offset:12288
  ds_read_b64_tr_b16 a[52:53], v154 offset:12288
  ds_read_b64_tr_b16 a[54:55], v155 offset:12288
  ds_read_b64_tr_b16 a[56:57], v152 offset:12352
  ds_read_b64_tr_b16 a[58:59], v153 offset:12352
  ds_read_b64_tr_b16 a[60:61], v154 offset:12352
  ds_read_b64_tr_b16 a[62:63], v155 offset:12352
  s_waitcnt lgkmcnt(0)
  s_add_u32 m0, s28, 12288
  s_nop 0
  buffer_load_dwordx4 v144, s[8:11], s17 offen lds
  s_add_u32 s17, s17, s29
  s_add_u32 m0, s28, 13312
  s_nop 0
  buffer_load_dwordx4 v144, s[8:11], s17 offen lds
  s_add_u32 s17, s17, s29
  s_add_u32 m0, s28, 14336
  s_nop 0
  buffer_load_dwordx4 v144, s[8:11], s17 offen lds
  s_add_u32 s17, s17, s29
  s_add_u32 m0, s28, 15360
  s_nop 0
  buffer_load_dwordx4 v144, s[8:11], s17 offen lds
  s_add_u32 s17, s17, s29
  s_waitcnt vmcnt(37)
  ds_read_b64_tr_b16 a[64:65], v152 offset:16384
  ds_read_b64_tr_b16 a[66:67], v153 offset:16384
  ds_read_b64_tr_b16 a[68:69], v154 offset:16384
  ds_read_b64_tr_b16 a[70:71], v155 offset:16384
  ds_read_b64_tr_b16 a[72:73], v152 offset:16448
  ds_read_b64_tr_b16 a[74:75], v153 offset:16448
  ds_read_b64_tr_b16 a[76:77], v154 offset:16448
  ds_read_b64_tr_b16 a[78:79], v155 offset:16448
  s_waitcnt lgkmcnt(0)
  s_add_u32 m0, s28, 16384
  s_nop 0
  buffer_load_dwordx4 v144, s[8:11], s17 offen lds
  s_add_u32 s17, s17, s29
  s_add_u32 m0, s28, 17408
  s_nop 0
  buffer_load_dwordx4 v144, s[8:11], s17 offen lds
  s_add_u32 s17, s17, s29
  s_add_u32 m0, s28, 18432
  s_nop 0
  buffer_load_dwordx4 v144, s[8:11], s17 offen lds
  s_add_u32 s17, s17, s29
  s_add_u32 m0, s28, 19456
  s_nop 0
  buffer_load_dwordx4 v144, s[8:11], s17 offen lds
  s_add_u32 s17, s17, s29
  s_waitcnt vmcnt(37)
  ds_read_b64_tr_b16 a[80:81], v152 offset:20480
  ds_read_b64_tr_b16 a[82:83], v153 offset:20480
  ds_read_b64_tr_b16 a[84:85], v154 offset:20480
  ds_read_b64_tr_b16 a[86:87], v155 offset:20480
  ds_read_b64_tr_b16 a[88:89], v152 offset:20544
  ds_read_b64_tr_b16 a[90:91], v153 offset:20544
  ds_read_b64_tr_b16 a[92:93], v154 offset:20544
  ds_read_b64_tr_b16 a[94:95], v155 offset:20544
  s_waitcnt lgkmcnt(0)
  s_add_u32 m0, s28, 20480
  s_nop 0
  buffer_load_dwordx4 v144, s[8:11], s17 offen lds
  s_add_u32 s17, s17, s29
  s_add_u32 m0, s28, 21504
  s_nop 0
  buffer_load_dwordx4 v144, s[8:11], s17 offen lds
  s_add_u32 s17, s17, s29
  s_add_u32 m0, s28, 22528
  s_nop 0
  buffer_load_dwordx4 v144, s[8:11], s17 offen lds
  s_add_u32 s17, s17, s29
  s_add_u32 m0, s28, 23552
  s_nop 0
  buffer_load_dwordx4 v144, s[8:11], s17 offen lds
  s_add_u32 s17, s17, s29
  s_waitcnt vmcnt(37)
  ds_read_b64_tr_b16 a[96:97], v152 offset:24576
  ds_read_b64_tr_b16 a[98:99], v153 offset:24576
  ds_read_b64_tr_b16 a[100:101], v154 offset:24576
  ds_read_b64_tr_b16 a[102:103], v155 offset:24576
  ds_read_b64_tr_b16 a[104:105], v152 offset:24640
  ds_read_b64_tr_b16 a[106:107], v153 offset:24640
  ds_read_b64_tr_b16 a[108:109], v154 offset:24640
  ds_read_b64_tr_b16 a[110:111], v155 offset:24640
  s_waitcnt lgkmcnt(0)
  s_add_u32 m0, s28, 24576
  s_nop 0
  buffer_load_dwordx4 v144, s[8:11], s17 offen lds
  s_add_u32 s17, s17, s29
  s_add_u32 m0, s28, 25600
  s_nop 0
  buffer_load_dwordx4 v144, s[8:11], s17 offen lds
  s_add_u32 s17, s17, s29
  s_add_u32 m0, s28, 26624
  s_nop 0
  buffer_load_dwordx4 v144, s[8:11], s17 offen lds
  s_add_u32 s17, s17, s29
  s_add_u32 m0, s28, 27648
  s_nop 0
  buffer_load_dwordx4 v144, s[8:11], s17 offen lds
  s_add_u32 s17, s17, s29
  s_waitcnt vmcnt(37)
  ds_read_b64_tr_b16 a[112:113], v152 offset:28672
  ds_read_b64_tr_b16 a[114:115], v153 offset:28672
  ds_read_b64_tr_b16 a[116:117], v154 offset:28672
  ds_read_b64_tr_b16 a[118:119], v155 offset:28672
  ds_read_b64_tr_b16 a[120:121], v152 offset:28736
  ds_read_b64_tr_b16 a[122:123], v153 offset:28736
  ds_read_b64_tr_b16 a[124:125], v154 offset:28736
  ds_read_b64_tr_b16 a[126:127], v155 offset:28736
  s_waitcnt lgkmcnt(0)
  s_add_u32 m0, s28, 28672
  s_nop 0
  buffer_load_dwordx4 v144, s[8:11], s17 offen lds
  s_add_u32 s17, s17, s29
  s_add_u32 m0, s28, 29696
  s_nop 0
  buffer_load_dwordx4 v144, s[8:11], s17 offen lds
  s_add_u32 s17, s17, s29
  s_add_u32 m0, s28, 30720
  s_nop 0
  buffer_load_dwordx4 v144, s[8:11], s17 offen lds
  s_add_u32 s17, s17, s29
  s_add_u32 m0, s28, 31744
  s_nop 0
  buffer_load_dwordx4 v144, s[8:11], s17 offen lds
  s_add_u32 s17, s17, s29
  s_waitcnt vmcnt(28)
  ds_read_b64_tr_b16 a[128:129], v152 offset:0
  ds_read_b64_tr_b16 a[130:131], v153 offset:0
  ds_read_b64_tr_b16 a[132:133], v154 offset:0
  ds_read_b64_tr_b16 a[134:135], v155 offset:0
  ds_read_b64_tr_b16 a[136:137], v152 offset:64
  ds_read_b64_tr_b16 a[138:139], v153 offset:64
  ds_read_b64_tr_b16 a[140:141], v154 offset:64
  ds_read_b64_tr_b16 a[142:143], v155 offset:64
  s_waitcnt lgkmcnt(0)
  s_waitcnt vmcnt(24)
  ds_read_b64_tr_b16 a[144:145], v152 offset:4096
  ds_read_b64_tr_b16 a[146:147], v153 offset:4096
  ds_read_b64_tr_b16 a[148:149], v154 offset:4096
  ds_read_b64_tr_b16 a[150:151], v155 offset:4096
  ds_read_b64_tr_b16 a[152:153], v152 offset:4160
  ds_read_b64_tr_b16 a[154:155], v153 offset:4160
  ds_read_b64_tr_b16 a[156:157], v154 offset:4160
  ds_read_b64_tr_b16 a[158:159], v155 offset:4160
  s_waitcnt lgkmcnt(0)
  s_waitcnt vmcnt(20)
  ds_read_b64_tr_b16 a[160:161], v152 offset:8192
  ds_read_b64_tr_b16 a[162:163], v153 offset:8192
  ds_read_b64_tr_b16 a[164:165], v154 offset:8192
  ds_read_b64_tr_b16 a[166:167], v155 offset:8192
  ds_read_b64_tr_b16 a[168:169], v152 offset:8256
  ds_read_b64_tr_b16 a[170:171], v153 offset:8256
  ds_read_b64_tr_b16 a[172:173], v154 offset:8256
  ds_read_b64_tr_b16 a[174:175], v155 offset:8256
  s_waitcnt lgkmcnt(0)
  s_waitcnt vmcnt(16)
  ds_read_b64_tr_b16 a[176:177], v152 offset:12288
  ds_read_b64_tr_b16 a[178:179], v153 offset:12288
  ds_read_b64_tr_b16 a[180:181], v154 offset:12288
  ds_read_b64_tr_b16 a[182:183], v155 offset:12288
  ds_read_b64_tr_b16 a[184:185], v152 offset:12352
  ds_read_b64_tr_b16 a[186:187], v153 offset:12352
  ds_read_b64_tr_b16 a[188:189], v154 offset:12352
  ds_read_b64_tr_b16 a[190:191], v155 offset:12352
  s_waitcnt lgkmcnt(0)
  s_waitcnt vmcnt(12)
  ds_read_b64_tr_b16 a[192:193], v152 offset:16384
  ds_read_b64_tr_b16 a[194:195], v153 offset:16384
  ds_read_b64_tr_b16 a[196:197], v154 offset:16384
  ds_read_b64_tr_b16 a[198:199], v155 offset:16384
  ds_read_b64_tr_b16 a[200:201], v152 offset:16448
  ds_read_b64_tr_b16 a[202:203], v153 offset:16448
  ds_read_b64_tr_b16 a[204:205], v154 offset:16448
  ds_read_b64_tr_b16 a[206:207], v155 offset:16448
  s_waitcnt lgkmcnt(0)
  s_waitcnt vmcnt(8)
  ds_read_b64_tr_b16 a[208:209], v152 offset:20480
  ds_read_b64_tr_b16 a[210:211], v153 offset:20480
  ds_read_b64_tr_b16 a[212:213], v154 offset:20480
  ds_read_b64_tr_b16 a[214:215], v155 offset:20480
  ds_read_b64_tr_b16 a[216:217], v152 offset:20544
  ds_read_b64_tr_b16 a[218:219], v153 offset:20544
  ds_read_b64_tr_b16 a[220:221], v154 offset:20544
  ds_read_b64_tr_b16 a[222:223], v155 offset:20544
  s_waitcnt lgkmcnt(0)
  s_waitcnt vmcnt(4)
  ds_read_b64_tr_b16 a[224:225], v152 offset:24576
  ds_read_b64_tr_b16 a[226:227], v153 offset:24576
  ds_read_b64_tr_b16 a[228:229], v154 offset:24576
  ds_read_b64_tr_b16 a[230:231], v155 offset:24576
  ds_read_b64_tr_b16 a[232:233], v152 offset:24640
  ds_read_b64_tr_b16 a[234:235], v153 offset:24640
  ds_read_b64_tr_b16 a[236:237], v154 offset:24640
  ds_read_b64_tr_b16 a[238:239], v155 offset:24640
  s_waitcnt lgkmcnt(0)
  s_waitcnt vmcnt(0)
  ds_read_b64_tr_b16 a[240:241], v152 offset:28672
  ds_read_b64_tr_b16 a[242:243], v153 offset:28672
  ds_read_b64_tr_b16 a[244:245], v154 offset:28672
  ds_read_b64_tr_b16 a[246:247], v155 offset:28672
  ds_read_b64_tr_b16 a[248:249], v152 offset:28736
  ds_read_b64_tr_b16 a[250:251], v153 offset:28736
  ds_read_b64_tr_b16 a[252:253], v154 offset:28736
  ds_read_b64_tr_b16 a[254:255], v155 offset:28736
  s_waitcnt lgkmcnt(0)
  s_barrier
  s_add_u32 m0, s25, 0
  s_nop 0
  buffer_load_dwordx4 v16, s[12:15], s19 offen lds
  s_add_u32 m0, s25, 1024
  s_nop 0
  buffer_load_dwordx4 v17, s[12:15], s19 offen lds
  s_add_u32 m0, s25, 2048
  s_nop 0
  buffer_load_dwordx4 v18, s[12:15], s19 offen lds
  s_add_u32 m0, s25, 3072
  s_nop 0
  buffer_load_dwordx4 v19, s[12:15], s19 offen lds
  s_add_u32 m0, s25, 4096
  s_nop 0
  buffer_load_dwordx4 v20, s[12:15], s19 offen lds
  s_add_u32 m0, s25, 5120
  s_nop 0
  buffer_load_dwordx4 v21, s[12:15], s19 offen lds
  s_add_u32 m0, s25, 6144
  s_nop 0
  buffer_load_dwordx4 v22, s[12:15], s19 offen lds
  s_add_u32 m0, s25, 7168
  s_nop 0
  buffer_load_dwordx4 v23, s[12:15], s19 offen lds
  s_cmp_gt_u32 s23, 2
  s_cselect_b32 s26, s20, 0
  s_add_u32 s19, s19, s26
  s_add_u32 s25, s25, 32768
  s_and_b32 s25, s25, 0x1ffff
  s_waitcnt vmcnt(0)
  s_barrier
  s_load_dwordx2 s[8:9], s[0:1], 40
  s_mul_i32 s76, s66, 18816
  v_min_u32 v200, 146, v0
  v_lshl_add_u32 v200, v200, 7, s76
  s_waitcnt lgkmcnt(0)
  s_and_b32 s9, s9, 0xffff
  buffer_load_dword v201, v200, s[8:11], 0 offen
  s_cmp_lg_u32 s32, 0
  s_cbranch_scc1 P_v_130
  s_cmp_eq_u32 s48, 0
  s_cbranch_scc1 P_q_132
  s_mov_b32 s27, s21
  v_mov_b32 v7, 0x40000000
  s_mov_b32 s29, -2
  v_min_u32 v145, 1, v0
  v_lshlrev_b32 v145, 30, v145
  ds_read_b128 v[24:27], v8 offset:0
  ds_read_b128 v[28:31], v9 offset:0
  ds_read_b128 v[32:35], v10 offset:0
  ds_read_b128 v[36:39], v11 offset:0
  ds_read_b128 v[40:43], v12 offset:0
  ds_read_b128 v[44:47], v13 offset:0
.p2align 6
G_top_133:
  s_waitcnt lgkmcnt(5)
  v_mfma_f32_16x16x32_bf16 v[64:67], a[0:3], v[24:27], 0
  s_add_u32 m0, s25, 0
  ds_read_b128 v[48:51], v14 offset:0
  v_mfma_f32_16x16x32_bf16 v[68:71], a[4:7], v[24:27], 0
  v_mfma_f32_16x16x32_bf16 v[80:83], a[8:11], v[24:27], 0
  buffer_load_dwordx4 v16, s[12:15], s19 offen lds
  v_mfma_f32_16x16x32_bf16 v[84:87], a[12:15], v[24:27], 0
  s_waitcnt lgkmcnt(5)
  v_mfma_f32_16x16x32_bf16 v[72:75], a[0:3], v[28:31], 0
  ds_read_b128 v[52:55], v15 offset:0
  v_mfma_f32_16x16x32_bf16 v[76:79], a[4:7], v[28:31], 0
  v_cvt_pk_bf16_f32 v128, v96, v97
  v_cvt_pk_bf16_f32 v129, v98, v99
  v_mfma_f32_16x16x32_bf16 v[88:91], a[8:11], v[28:31], 0
  v_mfma_f32_16x16x32_bf16 v[92:95], a[12:15], v[28:31], 0
  s_waitcnt lgkmcnt(5)
  v_cvt_pk_bf16_f32 v130, v100, v101
  v_cvt_pk_bf16_f32 v131, v102, v103
  v_mfma_f32_16x16x32_bf16 v[64:67], a[16:19], v[32:35], v[64:67]
  s_add_u32 m0, s25, 1024
  ds_read_b128 v[24:27], v8 offset:8192
  v_mfma_f32_16x16x32_bf16 v[68:71], a[20:23], v[32:35], v[68:71]
  v_mfma_f32_16x16x32_bf16 v[80:83], a[24:27], v[32:35], v[80:83]
  buffer_load_dwordx4 v17, s[12:15], s19 offen lds
  v_mfma_f32_16x16x32_bf16 v[84:87], a[28:31], v[32:35], v[84:87]
  s_waitcnt lgkmcnt(5)
  v_mfma_f32_16x16x32_bf16 v[72:75], a[16:19], v[36:39], v[72:75]
  ds_read_b128 v[28:31], v9 offset:8192
  v_mfma_f32_16x16x32_bf16 v[76:79], a[20:23], v[36:39], v[76:79]
  v_mfma_f32_16x16x32_bf16 v[88:91], a[24:27], v[36:39], v[88:91]
  v_mfma_f32_16x16x32_bf16 v[92:95], a[28:31], v[36:39], v[92:95]
  s_waitcnt lgkmcnt(5)
  v_mfma_f32_16x16x32_bf16 v[64:67], a[32:35], v[40:43], v[64:67]
  s_add_u32 m0, s25, 2048
  ds_read_b128 v[32:35], v10 offset:8192
  v_mfma_f32_16x16x32_bf16 v[68:71], a[36:39], v[40:43], v[68:71]
  v_cvt_pk_bf16_f32 v132, v104, v105
  v_cvt_pk_bf16_f32 v133, v106, v107
  v_mfma_f32_16x16x32_bf16 v[80:83], a[40:43], v[40:43], v[80:83]
  buffer_load_dwordx4 v18, s[12:15], s19 offen lds
  v_mfma_f32_16x16x32_bf16 v[84:87], a[44:47], v[40:43], v[84:87]
  s_waitcnt lgkmcnt(5)
  v_cvt_pk_bf16_f32 v134, v108, v109
  v_cvt_pk_bf16_f32 v135, v110, v111
  v_mfma_f32_16x16x32_bf16 v[72:75], a[32:35], v[44:47], v[72:75]
  ds_read_b128 v[36:39], v11 offset:8192
  v_mfma_f32_16x16x32_bf16 v[76:79], a[36:39], v[44:47], v[76:79]
  v_mfma_f32_16x16x32_bf16 v[88:91], a[40:43], v[44:47], v[88:91]
  v_mfma_f32_16x16x32_bf16 v[92:95], a[44:47], v[44:47], v[92:95]
  s_waitcnt lgkmcnt(5)
  v_mfma_f32_16x16x32_bf16 v[64:67], a[48:51], v[48:51], v[64:67]
  s_add_u32 m0, s25, 3072
  ds_read_b128 v[40:43], v12 offset:8192
  v_mfma_f32_16x16x32_bf16 v[68:71], a[52:55], v[48:51], v[68:71]
  v_mfma_f32_16x16x32_bf16 v[80:83], a[56:59], v[48:51], v[80:83]
  buffer_load_dwordx4 v19, s[12:15], s19 offen lds
  v_mfma_f32_16x16x32_bf16 v[84:87], a[60:63], v[48:51], v[84:87]
  s_waitcnt lgkmcnt(5)
  v_mfma_f32_16x16x32_bf16 v[72:75], a[48:51], v[52:55], v[72:75]
  ds_read_b128 v[44:47], v13 offset:8192
  v_mfma_f32_16x16x32_bf16 v[76:79], a[52:55], v[52:55], v[76:79]
  v_cvt_pk_bf16_f32 v136, v112, v113
  v_cvt_pk_bf16_f32 v137, v114, v115
  v_mfma_f32_16x16x32_bf16 v[88:91], a[56:59], v[52:55], v[88:91]
  v_mfma_f32_16x16x32_bf16 v[92:95], a[60:63], v[52:55], v[92:95]
  s_waitcnt lgkmcnt(5)
  v_cvt_pk_bf16_f32 v138, v116, v117
  v_cvt_pk_bf16_f32 v139, v118, v119
  v_mfma_f32_16x16x32_bf16 v[64:67], a[64:67], v[24:27], v[64:67]
  s_add_u32 m0, s25, 4096
  ds_read_b128 v[48:51], v14 offset:8192
  v_mfma_f32_16x16x32_bf16 v[68:71], a[68:71], v[24:27], v[68:71]
  v_mfma_f32_16x16x32_bf16 v[80:83], a[72:75], v[24:27], v[80:83]
  buffer_load_dwordx4 v20, s[12:15], s19 offen lds
  v_mfma_f32_16x16x32_bf16 v[84:87], a[76:79], v[24:27], v[84:87]
  s_waitcnt lgkmcnt(5)
  v_mfma_f32_16x16x32_bf16 v[72:75], a[64:67], v[28:31], v[72:75]
  ds_read_b128 v[52:55], v15 offset:8192
  v_mfma_f32_16x16x32_bf16 v[76:79], a[68:71], v[28:31], v[76:79]
  v_mfma_f32_16x16x32_bf16 v[88:91], a[72:75], v[28:31], v[88:91]
  v_mfma_f32_16x16x32_bf16 v[92:95], a[76:79], v[28:31], v[92:95]
  s_waitcnt lgkmcnt(5)
  v_mfma_f32_16x16x32_bf16 v[64:67], a[80:83], v[32:35], v[64:67]
  s_add_u32 m0, s25, 5120
  ds_read_b128 v[24:27], v8 offset:16384
  v_mfma_f32_16x16x32_bf16 v[68:71], a[84:87], v[32:35], v[68:71]
  v_cvt_pk_bf16_f32 v140, v120, v121
  v_cvt_pk_bf16_f32 v141, v122, v123
  v_mfma_f32_16x16x32_bf16 v[80:83], a[88:91], v[32:35], v[80:83]
  buffer_load_dwordx4 v21, s[12:15], s19 offen lds
  v_mfma_f32_16x16x32_bf16 v[84:87], a[92:95], v[32:35], v[84:87]
  s_waitcnt lgkmcnt(5)
  v_cvt_pk_bf16_f32 v142, v124, v125
  v_cvt_pk_bf16_f32 v143, v126, v127
  v_mfma_f32_16x16x32_bf16 v[72:75], a[80:83], v[36:39], v[72:75]
  ds_read_b128 v[28:31], v9 offset:16384
  v_mfma_f32_16x16x32_bf16 v[76:79], a[84:87], v[36:39], v[76:79]
  v_mfma_f32_16x16x32_bf16 v[88:91], a[88:91], v[36:39], v[88:91]
  v_mfma_f32_16x16x32_bf16 v[92:95], a[92:95], v[36:39], v[92:95]
  s_waitcnt lgkmcnt(5)
  v_mfma_f32_16x16x32_bf16 v[64:67], a[96:99], v[40:43], v[64:67]
  s_add_u32 m0, s25, 6144
  ds_read_b128 v[32:35], v10 offset:16384
  v_mfma_f32_16x16x32_bf16 v[68:71], a[100:103], v[40:43], v[68:71]
  v_mfma_f32_16x16x32_bf16 v[80:83], a[104:107], v[40:43], v[80:83]
  buffer_load_dwordx4 v22, s[12:15], s19 offen lds
  v_mfma_f32_16x16x32_bf16 v[84:87], a[108:111], v[40:43], v[84:87]
  s_waitcnt lgkmcnt(5)
  v_mfma_f32_16x16x32_bf16 v[72:75], a[96:99], v[44:47], v[72:75]
  ds_read_b128 v[36:39], v11 offset:16384
  v_mfma_f32_16x16x32_bf16 v[76:79], a[100:103], v[44:47], v[76:79]
  v_mfma_f32_16x16x32_bf16 v[88:91], a[104:107], v[44:47], v[88:91]
  v_mfma_f32_16x16x32_bf16 v[92:95], a[108:111], v[44:47], v[92:95]
  s_waitcnt lgkmcnt(5)
  v_mfma_f32_16x16x32_bf16 v[64:67], a[112:115], v[48:51], v[64:67]
  s_add_u32 m0, s25, 7168
  ds_read_b128 v[40:43], v12 offset:16384
  v_mfma_f32_16x16x32_bf16 v[68:71], a[116:119], v[48:51], v[68:71]
  v_mfma_f32_16x16x32_bf16 v[80:83], a[120:123], v[48:51], v[80:83]
  buffer_load_dwordx4 v23, s[12:15], s19 offen lds
  v_mfma_f32_16x16x32_bf16 v[84:87], a[124:127], v[48:51], v[84:87]
  s_waitcnt lgkmcnt(5)
  v_mfma_f32_16x16x32_bf16 v[72:75], a[112:115], v[52:55], v[72:75]
  s_cmp_gt_u32 s23, 3
  ds_read_b128 v[44:47], v13 offset:16384
  v_mfma_f32_16x16x32_bf16 v[76:79], a[116:119], v[52:55], v[76:79]
  v_mfma_f32_16x16x32_bf16 v[88:91], a[120:123], v[52:55], v[88:91]
  s_cselect_b32 s26, s20, 0
  v_mfma_f32_16x16x32_bf16 v[92:95], a[124:127], v[52:55], v[92:95]
  s_waitcnt lgkmcnt(5)
  v_mfma_f32_16x16x32_bf16 v[64:67], a[128:131], v[24:27], v[64:67]
  s_add_u32 s19, s19, s26
  ds_read_b128 v[48:51], v14 offset:16384
  v_mfma_f32_16x16x32_bf16 v[68:71], a[132:135], v[24:27], v[68:71]
  v_mfma_f32_16x16x32_bf16 v[80:83], a[136:139], v[24:27], v[80:83]
  s_add_u32 s25, s25, 32768
  v_mfma_f32_16x16x32_bf16 v[84:87], a[140:143], v[24:27], v[84:87]
  s_waitcnt lgkmcnt(5)
  v_mfma_f32_16x16x32_bf16 v[72:75], a[128:131], v[28:31], v[72:75]
  s_and_b32 s25, s25, 0x1ffff
  ds_read_b128 v[52:55], v15 offset:16384
  v_mfma_f32_16x16x32_bf16 v[76:79], a[132:135], v[28:31], v[76:79]
  v_mfma_f32_16x16x32_bf16 v[88:91], a[136:139], v[28:31], v[88:91]
  buffer_store_dwordx4 v[128:131], v7, s[4:7], s21 offen offset:0 sc1
  v_mfma_f32_16x16x32_bf16 v[92:95], a[140:143], v[28:31], v[92:95]
  s_waitcnt lgkmcnt(5)
  v_mfma_f32_16x16x32_bf16 v[64:67], a[144:147], v[32:35], v[64:67]
  ds_read_b128 v[24:27], v8 offset:24576
  v_mfma_f32_16x16x32_bf16 v[68:71], a[148:151], v[32:35], v[68:71]
  v_mfma_f32_16x16x32_bf16 v[80:83], a[152:155], v[32:35], v[80:83]
  v_mfma_f32_16x16x32_bf16 v[84:87], a[156:159], v[32:35], v[84:87]
  s_waitcnt lgkmcnt(5)
  v_mfma_f32_16x16x32_bf16 v[72:75], a[144:147], v[36:39], v[72:75]
  ds_read_b128 v[28:31], v9 offset:24576
  v_mfma_f32_16x16x32_bf16 v[76:79], a[148:151], v[36:39], v[76:79]
  v_mfma_f32_16x16x32_bf16 v[88:91], a[152:155], v[36:39], v[88:91]
  buffer_store_dwordx4 v[132:135], v7, s[4:7], s21 offen offset:256 sc1
  v_mfma_f32_16x16x32_bf16 v[92:95], a[156:159], v[36:39], v[92:95]
  s_waitcnt lgkmcnt(5)
  v_mfma_f32_16x16x32_bf16 v[64:67], a[160:163], v[40:43], v[64:67]
  ds_read_b128 v[32:35], v10 offset:24576
  v_mfma_f32_16x16x32_bf16 v[68:71], a[164:167], v[40:43], v[68:71]
  v_mfma_f32_16x16x32_bf16 v[80:83], a[168:171], v[40:43], v[80:83]
  v_mfma_f32_16x16x32_bf16 v[84:87], a[172:175], v[40:43], v[84:87]
  s_waitcnt lgkmcnt(5)
  v_mfma_f32_16x16x32_bf16 v[72:75], a[160:163], v[44:47], v[72:75]
  ds_read_b128 v[36:39], v11 offset:24576
  v_mfma_f32_16x16x32_bf16 v[76:79], a[164:167], v[44:47], v[76:79]
  v_mfma_f32_16x16x32_bf16 v[88:91], a[168:171], v[44:47], v[88:91]
  buffer_store_dwordx4 v[136:139], v7, s[4:7], s21 offen offset:2048 sc1
  v_mfma_f32_16x16x32_bf16 v[92:95], a[172:175], v[44:47], v[92:95]
  s_waitcnt lgkmcnt(5)
  v_mfma_f32_16x16x32_bf16 v[64:67], a[176:179], v[48:51], v[64:67]
  ds_read_b128 v[40:43], v12 offset:24576
  v_mfma_f32_16x16x32_bf16 v[68:71], a[180:183], v[48:51], v[68:71]
  v_mfma_f32_16x16x32_bf16 v[80:83], a[184:187], v[48:51], v[80:83]
  v_mfma_f32_16x16x32_bf16 v[84:87], a[188:191], v[48:51], v[84:87]
  s_waitcnt lgkmcnt(5)
  v_mfma_f32_16x16x32_bf16 v[72:75], a[176:179], v[52:55], v[72:75]
  ds_read_b128 v[44:47], v13 offset:24576
  v_mfma_f32_16x16x32_bf16 v[76:79], a[180:183], v[52:55], v[76:79]
  v_mfma_f32_16x16x32_bf16 v[88:91], a[184:187], v[52:55], v[88:91]
  buffer_store_dwordx4 v[140:143], v7, s[4:7], s21 offen offset:2304 sc1
  v_mfma_f32_16x16x32_bf16 v[92:95], a[188:191], v[52:55], v[92:95]
  s_waitcnt lgkmcnt(5)
  v_mfma_f32_16x16x32_bf16 v[64:67], a[192:195], v[24:27], v[64:67]
  s_mov_b32 s21, s27
  ds_read_b128 v[48:51], v14 offset:24576
  v_mfma_f32_16x16x32_bf16 v[68:71], a[196:199], v[24:27], v[68:71]
  v_mov_b32 v7, v56
  v_mfma_f32_16x16x32_bf16 v[80:83], a[200:203], v[24:27], v[80:83]
  v_mfma_f32_16x16x32_bf16 v[84:87], a[204:207], v[24:27], v[84:87]
  s_waitcnt lgkmcnt(5)
  v_mfma_f32_16x16x32_bf16 v[72:75], a[192:195], v[28:31], v[72:75]
  s_add_u32 s27, s27, s22
  ds_read_b128 v[52:55], v15 offset:24576
  v_mfma_f32_16x16x32_bf16 v[76:79], a[196:199], v[28:31], v[76:79]
  v_mfma_f32_16x16x32_bf16 v[88:91], a[200:203], v[28:31], v[88:91]
  s_waitcnt vmcnt(13)
  s_barrier
  v_mfma_f32_16x16x32_bf16 v[92:95], a[204:207], v[28:31], v[92:95]
  s_waitcnt lgkmcnt(5)
  v_mfma_f32_16x16x32_bf16 v[64:67], a[208:211], v[32:35], v[64:67]
  ds_read_b128 v[24:27], v8 offset:32768
  v_mfma_f32_16x16x32_bf16 v[68:71], a[212:215], v[32:35], v[68:71]
  v_mfma_f32_16x16x32_bf16 v[80:83], a[216:219], v[32:35], v[80:83]
  v_mfma_f32_16x16x32_bf16 v[84:87], a[220:223], v[32:35], v[84:87]
  s_waitcnt lgkmcnt(5)
  v_mfma_f32_16x16x32_bf16 v[72:75], a[208:211], v[36:39], v[72:75]
  s_add_u32 s29, s29, 1
  ds_read_b128 v[28:31], v9 offset:32768
  v_mfma_f32_16x16x32_bf16 v[76:79], a[212:215], v[36:39], v[76:79]
  v_mfma_f32_16x16x32_bf16 v[88:91], a[216:219], v[36:39], v[88:91]
  s_max_i32 s30, s29, 0
  v_mfma_f32_16x16x32_bf16 v[92:95], a[220:223], v[36:39], v[92:95]
  s_waitcnt lgkmcnt(5)
  v_mov_b32 v144, s30
  v_mfma_f32_16x16x32_bf16 v[64:67], a[224:227], v[40:43], v[64:67]
  ds_read_b128 v[32:35], v10 offset:32768
  v_mfma_f32_16x16x32_bf16 v[68:71], a[228:231], v[40:43], v[68:71]
  v_mfma_f32_16x16x32_bf16 v[80:83], a[232:235], v[40:43], v[80:83]
  buffer_store_dword v144, v145, s[4:7], s31 offen sc1
  v_mfma_f32_16x16x32_bf16 v[84:87], a[236:239], v[40:43], v[84:87]
  s_waitcnt lgkmcnt(5)
  v_mfma_f32_16x16x32_bf16 v[72:75], a[224:227], v[44:47], v[72:75]
  ds_read_b128 v[36:39], v11 offset:32768
  v_mfma_f32_16x16x32_bf16 v[76:79], a[228:231], v[44:47], v[76:79]
  v_mfma_f32_16x16x32_bf16 v[88:91], a[232:235], v[44:47], v[88:91]
  v_mfma_f32_16x16x32_bf16 v[92:95], a[236:239], v[44:47], v[92:95]
  s_waitcnt lgkmcnt(5)
  v_mfma_f32_16x16x32_bf16 v[64:67], a[240:243], v[48:51], v[64:67]
  s_sub_u32 s23, s23, 1
  ds_read_b128 v[40:43], v12 offset:32768
  v_mfma_f32_16x16x32_bf16 v[68:71], a[244:247], v[48:51], v[68:71]
  v_mfma_f32_16x16x32_bf16 v[80:83], a[248:251], v[48:51], v[80:83]
  v_mfma_f32_16x16x32_bf16 v[84:87], a[252:255], v[48:51], v[84:87]
  s_waitcnt lgkmcnt(5)
  v_mfma_f32_16x16x32_bf16 v[72:75], a[240:243], v[52:55], v[72:75]
  s_cmp_eq_u32 s23, 0
  ds_read_b128 v[44:47], v13 offset:32768
  v_mfma_f32_16x16x32_bf16 v[76:79], a[244:247], v[52:55], v[76:79]
  v_mfma_f32_16x16x32_bf16 v[88:91], a[248:251], v[52:55], v[88:91]
  v_mfma_f32_16x16x32_bf16 v[92:95], a[252:255], v[52:55], v[92:95]
  s_cbranch_scc1 G_done0_134
  s_waitcnt lgkmcnt(5)
  v_mfma_f32_16x16x32_bf16 v[96:99], a[0:3], v[24:27], 0
  s_add_u32 m0, s25, 0
  ds_read_b128 v[48:51], v14 offset:32768
  v_mfma_f32_16x16x32_bf16 v[100:103], a[4:7], v[24:27], 0
  v_mfma_f32_16x16x32_bf16 v[112:115], a[8:11], v[24:27], 0
  buffer_load_dwordx4 v16, s[12:15], s19 offen lds
  v_mfma_f32_16x16x32_bf16 v[116:119], a[12:15], v[24:27], 0
  s_waitcnt lgkmcnt(5)
  v_mfma_f32_16x16x32_bf16 v[104:107], a[0:3], v[28:31], 0
  ds_read_b128 v[52:55], v15 offset:32768
  v_mfma_f32_16x16x32_bf16 v[108:111], a[4:7], v[28:31], 0
  v_cvt_pk_bf16_f32 v128, v64, v65
  v_cvt_pk_bf16_f32 v129, v66, v67
  v_mfma_f32_16x16x32_bf16 v[120:123], a[8:11], v[28:31], 0
  v_mfma_f32_16x16x32_bf16 v[124:127], a[12:15], v[28:31], 0
  s_waitcnt lgkmcnt(5)
  v_cvt_pk_bf16_f32 v130, v68, v69
  v_cvt_pk_bf16_f32 v131, v70, v71
  v_mfma_f32_16x16x32_bf16 v[96:99], a[16:19], v[32:35], v[96:99]
  s_add_u32 m0, s25, 1024
  ds_read_b128 v[24:27], v8 offset:40960
  v_mfma_f32_16x16x32_bf16 v[100:103], a[20:23], v[32:35], v[100:103]
  v_mfma_f32_16x16x32_bf16 v[112:115], a[24:27], v[32:35], v[112:115]
  buffer_load_dwordx4 v17, s[12:15], s19 offen lds
  v_mfma_f32_16x16x32_bf16 v[116:119], a[28:31], v[32:35], v[116:119]
  s_waitcnt lgkmcnt(5)
  v_mfma_f32_16x16x32_bf16 v[104:107], a[16:19], v[36:39], v[104:107]
  ds_read_b128 v[28:31], v9 offset:40960
  v_mfma_f32_16x16x32_bf16 v[108:111], a[20:23], v[36:39], v[108:111]
  v_mfma_f32_16x16x32_bf16 v[120:123], a[24:27], v[36:39], v[120:123]
  v_mfma_f32_16x16x32_bf16 v[124:127], a[28:31], v[36:39], v[124:127]
  s_waitcnt lgkmcnt(5)
  v_mfma_f32_16x16x32_bf16 v[96:99], a[32:35], v[40:43], v[96:99]
  s_add_u32 m0, s25, 2048
  ds_read_b128 v[32:35], v10 offset:40960
  v_mfma_f32_16x16x32_bf16 v[100:103], a[36:39], v[40:43], v[100:103]
  v_cvt_pk_bf16_f32 v132, v72, v73
  v_cvt_pk_bf16_f32 v133, v74, v75
  v_mfma_f32_16x16x32_bf16 v[112:115], a[40:43], v[40:43], v[112:115]
  buffer_load_dwordx4 v18, s[12:15], s19 offen lds
  v_mfma_f32_16x16x32_bf16 v[116:119], a[44:47], v[40:43], v[116:119]
  s_waitcnt lgkmcnt(5)
  v_cvt_pk_bf16_f32 v134, v76, v77
  v_cvt_pk_bf16_f32 v135, v78, v79
  v_mfma_f32_16x16x32_bf16 v[104:107], a[32:35], v[44:47], v[104:107]
  ds_read_b128 v[36:39], v11 offset:40960
  v_mfma_f32_16x16x32_bf16 v[108:111], a[36:39], v[44:47], v[108:111]
  v_mfma_f32_16x16x32_bf16 v[120:123], a[40:43], v[44:47], v[120:123]
  v_mfma_f32_16x16x32_bf16 v[124:127], a[44:47], v[44:47], v[124:127]
  s_waitcnt lgkmcnt(5)
  v_mfma_f32_16x16x32_bf16 v[96:99], a[48:51], v[48:51], v[96:99]
  s_add_u32 m0, s25, 3072
  ds_read_b128 v[40:43], v12 offset:40960
  v_mfma_f32_16x16x32_bf16 v[100:103], a[52:55], v[48:51], v[100:103]
  v_mfma_f32_16x16x32_bf16 v[112:115], a[56:59], v[48:51], v[112:115]
  buffer_load_dwordx4 v19, s[12:15], s19 offen lds
  v_mfma_f32_16x16x32_bf16 v[116:119], a[60:63], v[48:51], v[116:119]
  s_waitcnt lgkmcnt(5)
  v_mfma_f32_16x16x32_bf16 v[104:107], a[48:51], v[52:55], v[104:107]
  ds_read_b128 v[44:47], v13 offset:40960
  v_mfma_f32_16x16x32_bf16 v[108:111], a[52:55], v[52:55], v[108:111]
  v_cvt_pk_bf16_f32 v136, v80, v81
  v_cvt_pk_bf16_f32 v137, v82, v83
  v_mfma_f32_16x16x32_bf16 v[120:123], a[56:59], v[52:55], v[120:123]
  v_mfma_f32_16x16x32_bf16 v[124:127], a[60:63], v[52:55], v[124:127]
  s_waitcnt lgkmcnt(5)
  v_cvt_pk_bf16_f32 v138, v84, v85
  v_cvt_pk_bf16_f32 v139, v86, v87
  v_mfma_f32_16x16x32_bf16 v[96:99], a[64:67], v[24:27], v[96:99]
  s_add_u32 m0, s25, 4096
  ds_read_b128 v[48:51], v14 offset:40960
  v_mfma_f32_16x16x32_bf16 v[100:103], a[68:71], v[24:27], v[100:103]
  v_mfma_f32_16x16x32_bf16 v[112:115], a[72:75], v[24:27], v[112:115]
  buffer_load_dwordx4 v20, s[12:15], s19 offen lds
  v_mfma_f32_16x16x32_bf16 v[116:119], a[76:79], v[24:27], v[116:119]
  s_waitcnt lgkmcnt(5)
  v_mfma_f32_16x16x32_bf16 v[104:107], a[64:67], v[28:31], v[104:107]
  ds_read_b128 v[52:55], v15 offset:40960
  v_mfma_f32_16x16x32_bf16 v[108:111], a[68:71], v[28:31], v[108:111]
  v_mfma_f32_16x16x32_bf16 v[120:123], a[72:75], v[28:31], v[120:123]
  v_mfma_f32_16x16x32_bf16 v[124:127], a[76:79], v[28:31], v[124:127]
  s_waitcnt lgkmcnt(5)
  v_mfma_f32_16x16x32_bf16 v[96:99], a[80:83], v[32:35], v[96:99]
  s_add_u32 m0, s25, 5120
  ds_read_b128 v[24:27], v8 offset:49152
  v_mfma_f32_16x16x32_bf16 v[100:103], a[84:87], v[32:35], v[100:103]
  v_cvt_pk_bf16_f32 v140, v88, v89
  v_cvt_pk_bf16_f32 v141, v90, v91
  v_mfma_f32_16x16x32_bf16 v[112:115], a[88:91], v[32:35], v[112:115]
  buffer_load_dwordx4 v21, s[12:15], s19 offen lds
  v_mfma_f32_16x16x32_bf16 v[116:119], a[92:95], v[32:35], v[116:119]
  s_waitcnt lgkmcnt(5)
  v_cvt_pk_bf16_f32 v142, v92, v93
  v_cvt_pk_bf16_f32 v143, v94, v95
  v_mfma_f32_16x16x32_bf16 v[104:107], a[80:83], v[36:39], v[104:107]
  ds_read_b128 v[28:31], v9 offset:49152
  v_mfma_f32_16x16x32_bf16 v[108:111], a[84:87], v[36:39], v[108:111]
  v_mfma_f32_16x16x32_bf16 v[120:123], a[88:91], v[36:39], v[120:123]
  v_mfma_f32_16x16x32_bf16 v[124:127], a[92:95], v[36:39], v[124:127]
  s_waitcnt lgkmcnt(5)
  v_mfma_f32_16x16x32_bf16 v[96:99], a[96:99], v[40:43], v[96:99]
  s_add_u32 m0, s25, 6144
  ds_read_b128 v[32:35], v10 offset:49152
  v_mfma_f32_16x16x32_bf16 v[100:103], a[100:103], v[40:43], v[100:103]
  v_mfma_f32_16x16x32_bf16 v[112:115], a[104:107], v[40:43], v[112:115]
  buffer_load_dwordx4 v22, s[12:15], s19 offen lds
  v_mfma_f32_16x16x32_bf16 v[116:119], a[108:111], v[40:43], v[116:119]
  s_waitcnt lgkmcnt(5)
  v_mfma_f32_16x16x32_bf16 v[104:107], a[96:99], v[44:47], v[104:107]
  ds_read_b128 v[36:39], v11 offset:49152
  v_mfma_f32_16x16x32_bf16 v[108:111], a[100:103], v[44:47], v[108:111]
  v_mfma_f32_16x16x32_bf16 v[120:123], a[104:107], v[44:47], v[120:123]
  v_mfma_f32_16x16x32_bf16 v[124:127], a[108:111], v[44:47], v[124:127]
  s_waitcnt lgkmcnt(5)
  v_mfma_f32_16x16x32_bf16 v[96:99], a[112:115], v[48:51], v[96:99]
  s_add_u32 m0, s25, 7168
  ds_read_b128 v[40:43], v12 offset:49152
  v_mfma_f32_16x16x32_bf16 v[100:103], a[116:119], v[48:51], v[100:103]
  v_mfma_f32_16x16x32_bf16 v[112:115], a[120:123], v[48:51], v[112:115]
  buffer_load_dwordx4 v23, s[12:15], s19 offen lds
  v_mfma_f32_16x16x32_bf16 v[116:119], a[124:127], v[48:51], v[116:119]
  s_waitcnt lgkmcnt(5)
  v_mfma_f32_16x16x32_bf16 v[104:107], a[112:115], v[52:55], v[104:107]
  s_cmp_gt_u32 s23, 3
  ds_read_b128 v[44:47], v13 offset:49152
  v_mfma_f32_16x16x32_bf16 v[108:111], a[116:119], v[52:55], v[108:111]
  v_mfma_f32_16x16x32_bf16 v[120:123], a[120:123], v[52:55], v[120:123]
  s_cselect_b32 s26, s20, 0
  v_mfma_f32_16x16x32_bf16 v[124:127], a[124:127], v[52:55], v[124:127]
  s_waitcnt lgkmcnt(5)
  v_mfma_f32_16x16x32_bf16 v[96:99], a[128:131], v[24:27], v[96:99]
  s_add_u32 s19, s19, s26
  ds_read_b128 v[48:51], v14 offset:49152
  v_mfma_f32_16x16x32_bf16 v[100:103], a[132:135], v[24:27], v[100:103]
  v_mfma_f32_16x16x32_bf16 v[112:115], a[136:139], v[24:27], v[112:115]
  s_add_u32 s25, s25, 32768
  v_mfma_f32_16x16x32_bf16 v[116:119], a[140:143], v[24:27], v[116:119]
  s_waitcnt lgkmcnt(5)
  v_mfma_f32_16x16x32_bf16 v[104:107], a[128:131], v[28:31], v[104:107]
  s_and_b32 s25, s25, 0x1ffff
  ds_read_b128 v[52:55], v15 offset:49152
  v_mfma_f32_16x16x32_bf16 v[108:111], a[132:135], v[28:31], v[108:111]
  v_mfma_f32_16x16x32_bf16 v[120:123], a[136:139], v[28:31], v[120:123]
  buffer_store_dwordx4 v[128:131], v7, s[4:7], s21 offen offset:0 sc1
  v_mfma_f32_16x16x32_bf16 v[124:127], a[140:143], v[28:31], v[124:127]
  s_waitcnt lgkmcnt(5)
  v_mfma_f32_16x16x32_bf16 v[96:99], a[144:147], v[32:35], v[96:99]
  ds_read_b128 v[24:27], v8 offset:57344
  v_mfma_f32_16x16x32_bf16 v[100:103], a[148:151], v[32:35], v[100:103]
  v_mfma_f32_16x16x32_bf16 v[112:115], a[152:155], v[32:35], v[112:115]
  v_mfma_f32_16x16x32_bf16 v[116:119], a[156:159], v[32:35], v[116:119]
  s_waitcnt lgkmcnt(5)
  v_xor_b32 v8, 0x10000, v8
  v_mfma_f32_16x16x32_bf16 v[104:107], a[144:147], v[36:39], v[104:107]
  ds_read_b128 v[28:31], v9 offset:57344
  v_mfma_f32_16x16x32_bf16 v[108:111], a[148:151], v[36:39], v[108:111]
  v_mfma_f32_16x16x32_bf16 v[120:123], a[152:155], v[36:39], v[120:123]
  buffer_store_dwordx4 v[132:135], v7, s[4:7], s21 offen offset:256 sc1
  v_mfma_f32_16x16x32_bf16 v[124:127], a[156:159], v[36:39], v[124:127]
  s_waitcnt lgkmcnt(5)
  v_xor_b32 v9, 0x10000, v9
  v_mfma_f32_16x16x32_bf16 v[96:99], a[160:163], v[40:43], v[96:99]
  ds_read_b128 v[32:35], v10 offset:57344
  v_mfma_f32_16x16x32_bf16 v[100:103], a[164:167], v[40:43], v[100:103]
  v_mfma_f32_16x16x32_bf16 v[112:115], a[168:171], v[40:43], v[112:115]
  v_mfma_f32_16x16x32_bf16 v[116:119], a[172:175], v[40:43], v[116:119]
  s_waitcnt lgkmcnt(5)
  v_xor_b32 v10, 0x10000, v10
  v_mfma_f32_16x16x32_bf16 v[104:107], a[160:163], v[44:47], v[104:107]
  ds_read_b128 v[36:39], v11 offset:57344
  v_mfma_f32_16x16x32_bf16 v[108:111], a[164:167], v[44:47], v[108:111]
  v_mfma_f32_16x16x32_bf16 v[120:123], a[168:171], v[44:47], v[120:123]
  buffer_store_dwordx4 v[136:139], v7, s[4:7], s21 offen offset:2048 sc1
  v_mfma_f32_16x16x32_bf16 v[124:127], a[172:175], v[44:47], v[124:127]
  s_waitcnt lgkmcnt(5)
  v_xor_b32 v11, 0x10000, v11
  v_mfma_f32_16x16x32_bf16 v[96:99], a[176:179], v[48:51], v[96:99]
  ds_read_b128 v[40:43], v12 offset:57344
  v_mfma_f32_16x16x32_bf16 v[100:103], a[180:183], v[48:51], v[100:103]
  v_mfma_f32_16x16x32_bf16 v[112:115], a[184:187], v[48:51], v[112:115]
  v_mfma_f32_16x16x32_bf16 v[116:119], a[188:191], v[48:51], v[116:119]
  s_waitcnt lgkmcnt(5)
  v_xor_b32 v12, 0x10000, v12
  v_mfma_f32_16x16x32_bf16 v[104:107], a[176:179], v[52:55], v[104:107]
  ds_read_b128 v[44:47], v13 offset:57344
  v_mfma_f32_16x16x32_bf16 v[108:111], a[180:183], v[52:55], v[108:111]
  v_mfma_f32_16x16x32_bf16 v[120:123], a[184:187], v[52:55], v[120:123]
  buffer_store_dwordx4 v[140:143], v7, s[4:7], s21 offen offset:2304 sc1
  v_mfma_f32_16x16x32_bf16 v[124:127], a[188:191], v[52:55], v[124:127]
  s_waitcnt lgkmcnt(5)
  v_xor_b32 v13, 0x10000, v13
  v_mfma_f32_16x16x32_bf16 v[96:99], a[192:195], v[24:27], v[96:99]
  s_mov_b32 s21, s27
  ds_read_b128 v[48:51], v14 offset:57344
  v_mfma_f32_16x16x32_bf16 v[100:103], a[196:199], v[24:27], v[100:103]
  v_mov_b32 v7, v56
  v_mfma_f32_16x16x32_bf16 v[112:115], a[200:203], v[24:27], v[112:115]
  v_mfma_f32_16x16x32_bf16 v[116:119], a[204:207], v[24:27], v[116:119]
  s_waitcnt lgkmcnt(5)
  v_xor_b32 v14, 0x10000, v14
  v_mfma_f32_16x16x32_bf16 v[104:107], a[192:195], v[28:31], v[104:107]
  s_add_u32 s27, s27, s22
  ds_read_b128 v[52:55], v15 offset:57344
  v_mfma_f32_16x16x32_bf16 v[108:111], a[196:199], v[28:31], v[108:111]
  v_mfma_f32_16x16x32_bf16 v[120:123], a[200:203], v[28:31], v[120:123]
  s_waitcnt vmcnt(13)
  s_barrier
  v_mfma_f32_16x16x32_bf16 v[124:127], a[204:207], v[28:31], v[124:127]
  s_waitcnt lgkmcnt(5)
  v_xor_b32 v15, 0x10000, v15
  v_mfma_f32_16x16x32_bf16 v[96:99], a[208:211], v[32:35], v[96:99]
  ds_read_b128 v[24:27], v8 offset:0
  v_mfma_f32_16x16x32_bf16 v[100:103], a[212:215], v[32:35], v[100:103]
  v_mfma_f32_16x16x32_bf16 v[112:115], a[216:219], v[32:35], v[112:115]
  v_mfma_f32_16x16x32_bf16 v[116:119], a[220:223], v[32:35], v[116:119]
  s_waitcnt lgkmcnt(5)
  v_mfma_f32_16x16x32_bf16 v[104:107], a[208:211], v[36:39], v[104:107]
  s_add_u32 s29, s29, 1
  ds_read_b128 v[28:31], v9 offset:0
  v_mfma_f32_16x16x32_bf16 v[108:111], a[212:215], v[36:39], v[108:111]
  v_mfma_f32_16x16x32_bf16 v[120:123], a[216:219], v[36:39], v[120:123]
  s_max_i32 s30, s29, 0
  v_mfma_f32_16x16x32_bf16 v[124:127], a[220:223], v[36:39], v[124:127]
  s_waitcnt lgkmcnt(5)
  v_mov_b32 v144, s30
  v_mfma_f32_16x16x32_bf16 v[96:99], a[224:227], v[40:43], v[96:99]
  ds_read_b128 v[32:35], v10 offset:0
  v_mfma_f32_16x16x32_bf16 v[100:103], a[228:231], v[40:43], v[100:103]
  v_mfma_f32_16x16x32_bf16 v[112:115], a[232:235], v[40:43], v[112:115]
  buffer_store_dword v144, v145, s[4:7], s31 offen sc1
  v_mfma_f32_16x16x32_bf16 v[116:119], a[236:239], v[40:43], v[116:119]
  s_waitcnt lgkmcnt(5)
  v_mfma_f32_16x16x32_bf16 v[104:107], a[224:227], v[44:47], v[104:107]
  ds_read_b128 v[36:39], v11 offset:0
  v_mfma_f32_16x16x32_bf16 v[108:111], a[228:231], v[44:47], v[108:111]
  v_mfma_f32_16x16x32_bf16 v[120:123], a[232:235], v[44:47], v[120:123]
  v_mfma_f32_16x16x32_bf16 v[124:127], a[236:239], v[44:47], v[124:127]
  s_waitcnt lgkmcnt(5)
  v_mfma_f32_16x16x32_bf16 v[96:99], a[240:243], v[48:51], v[96:99]
  s_sub_u32 s23, s23, 1
  ds_read_b128 v[40:43], v12 offset:0
  v_mfma_f32_16x16x32_bf16 v[100:103], a[244:247], v[48:51], v[100:103]
  v_mfma_f32_16x16x32_bf16 v[112:115], a[248:251], v[48:51], v[112:115]
  v_mfma_f32_16x16x32_bf16 v[116:119], a[252:255], v[48:51], v[116:119]
  s_waitcnt lgkmcnt(5)
  v_mfma_f32_16x16x32_bf16 v[104:107], a[240:243], v[52:55], v[104:107]
  s_cmp_eq_u32 s23, 0
  ds_read_b128 v[44:47], v13 offset:0
  v_mfma_f32_16x16x32_bf16 v[108:111], a[244:247], v[52:55], v[108:111]
  v_mfma_f32_16x16x32_bf16 v[120:123], a[248:251], v[52:55], v[120:123]
  v_mfma_f32_16x16x32_bf16 v[124:127], a[252:255], v[52:55], v[124:127]
  s_cbranch_scc1 G_done1_135
  s_branch G_top_133
G_done0_134:
  s_nop 7
  s_nop 3
  v_cvt_pk_bf16_f32 v128, v64, v65
  v_cvt_pk_bf16_f32 v129, v66, v67
  v_cvt_pk_bf16_f32 v130, v68, v69
  v_cvt_pk_bf16_f32 v131, v70, v71
  buffer_store_dwordx4 v[128:131], v7, s[4:7], s21 offen offset:0 sc1
  v_cvt_pk_bf16_f32 v132, v72, v73
  v_cvt_pk_bf16_f32 v133, v74, v75
  v_cvt_pk_bf16_f32 v134, v76, v77
  v_cvt_pk_bf16_f32 v135, v78, v79
  buffer_store_dwordx4 v[132:135], v7, s[4:7], s21 offen offset:256 sc1
  v_cvt_pk_bf16_f32 v136, v80, v81
  v_cvt_pk_bf16_f32 v137, v82, v83
  v_cvt_pk_bf16_f32 v138, v84, v85
  v_cvt_pk_bf16_f32 v139, v86, v87
  buffer_store_dwordx4 v[136:139], v7, s[4:7], s21 offen offset:2048 sc1
  v_cvt_pk_bf16_f32 v140, v88, v89
  v_cvt_pk_bf16_f32 v141, v90, v91
  v_cvt_pk_bf16_f32 v142, v92, v93
  v_cvt_pk_bf16_f32 v143, v94, v95
  buffer_store_dwordx4 v[140:143], v7, s[4:7], s21 offen offset:2304 sc1
  s_branch G_fin_136
G_done1_135:
  s_nop 7
  s_nop 3
  v_cvt_pk_bf16_f32 v128, v96, v97
  v_cvt_pk_bf16_f32 v129, v98, v99
  v_cvt_pk_bf16_f32 v130, v100, v101
  v_cvt_pk_bf16_f32 v131, v102, v103
  buffer_store_dwordx4 v[128:131], v7, s[4:7], s21 offen offset:0 sc1
  v_cvt_pk_bf16_f32 v132, v104, v105
  v_cvt_pk_bf16_f32 v133, v106, v107
  v_cvt_pk_bf16_f32 v134, v108, v109
  v_cvt_pk_bf16_f32 v135, v110, v111
  buffer_store_dwordx4 v[132:135], v7, s[4:7], s21 offen offset:256 sc1
  v_cvt_pk_bf16_f32 v136, v112, v113
  v_cvt_pk_bf16_f32 v137, v114, v115
  v_cvt_pk_bf16_f32 v138, v116, v117
  v_cvt_pk_bf16_f32 v139, v118, v119
  buffer_store_dwordx4 v[136:139], v7, s[4:7], s21 offen offset:2048 sc1
  v_cvt_pk_bf16_f32 v140, v120, v121
  v_cvt_pk_bf16_f32 v141, v122, v123
  v_cvt_pk_bf16_f32 v142, v124, v125
  v_cvt_pk_bf16_f32 v143, v126, v127
  buffer_store_dwordx4 v[140:143], v7, s[4:7], s21 offen offset:2304 sc1
G_fin_136:
  s_waitcnt vmcnt(0) lgkmcnt(0)
  s_barrier
  s_add_u32 s30, s29, 2
  v_mov_b32 v144, s30
  v_min_u32 v145, 1, v0
  v_lshlrev_b32 v145, 30, v145
  buffer_store_dword v144, v145, s[4:7], s31 offen sc1
  s_branch P_end_131
P_q_132:
  s_mov_b32 s27, s21
  v_mov_b32 v7, 0x40000000
  s_mov_b32 s29, -2
  v_min_u32 v145, 1, v0
  v_lshlrev_b32 v145, 30, v145
  ds_read_b128 v[24:27], v8 offset:0
  ds_read_b128 v[28:31], v9 offset:0
  ds_read_b128 v[32:35], v10 offset:0
  ds_read_b128 v[36:39], v11 offset:0
  ds_read_b128 v[40:43], v12 offset:0
  ds_read_b128 v[44:47], v13 offset:0
.p2align 6
G_top_137:
  s_waitcnt lgkmcnt(5)
  v_mfma_f32_16x16x32_bf16 v[64:67], a[0:3], v[24:27], 0
  s_add_u32 m0, s25, 0
  ds_read_b128 v[48:51], v14 offset:0
  v_mfma_f32_16x16x32_bf16 v[68:71], a[4:7], v[24:27], 0
  v_mfma_f32_16x16x32_bf16 v[80:83], a[8:11], v[24:27], 0
  buffer_load_dwordx4 v16, s[12:15], s19 offen lds
  v_mfma_f32_16x16x32_bf16 v[84:87], a[12:15], v[24:27], 0
  s_waitcnt lgkmcnt(5)
  v_mfma_f32_16x16x32_bf16 v[72:75], a[0:3], v[28:31], 0
  ds_read_b128 v[52:55], v15 offset:0
  v_mfma_f32_16x16x32_bf16 v[76:79], a[4:7], v[28:31], 0
  v_mul_f32 v96, s24, v96
  v_mul_f32 v97, s24, v97
  v_mfma_f32_16x16x32_bf16 v[88:91], a[8:11], v[28:31], 0
  v_mfma_f32_16x16x32_bf16 v[92:95], a[12:15], v[28:31], 0
  s_waitcnt lgkmcnt(5)
  v_cvt_pk_bf16_f32 v128, v96, v97
  v_mul_f32 v98, s24, v98
  v_mfma_f32_16x16x32_bf16 v[64:67], a[16:19], v[32:35], v[64:67]
  s_add_u32 m0, s25, 1024
  ds_read_b128 v[24:27], v8 offset:8192
  v_mfma_f32_16x16x32_bf16 v[68:71], a[20:23], v[32:35], v[68:71]
  v_mul_f32 v99, s24, v99
  v_cvt_pk_bf16_f32 v129, v98, v99
  v_mfma_f32_16x16x32_bf16 v[80:83], a[24:27], v[32:35], v[80:83]
  buffer_load_dwordx4 v17, s[12:15], s19 offen lds
  v_mfma_f32_16x16x32_bf16 v[84:87], a[28:31], v[32:35], v[84:87]
  s_waitcnt lgkmcnt(5)
  v_mul_f32 v100, s24, v100
  v_mul_f32 v101, s24, v101
  v_mfma_f32_16x16x32_bf16 v[72:75], a[16:19], v[36:39], v[72:75]
  ds_read_b128 v[28:31], v9 offset:8192
  v_mfma_f32_16x16x32_bf16 v[76:79], a[20:23], v[36:39], v[76:79]
  v_cvt_pk_bf16_f32 v130, v100, v101
  v_mul_f32 v102, s24, v102
  v_mfma_f32_16x16x32_bf16 v[88:91], a[24:27], v[36:39], v[88:91]
  v_mfma_f32_16x16x32_bf16 v[92:95], a[28:31], v[36:39], v[92:95]
  s_waitcnt lgkmcnt(5)
  v_mul_f32 v103, s24, v103
  v_cvt_pk_bf16_f32 v131, v102, v103
  v_mfma_f32_16x16x32_bf16 v[64:67], a[32:35], v[40:43], v[64:67]
  s_add_u32 m0, s25, 2048
  ds_read_b128 v[32:35], v10 offset:8192
  v_mfma_f32_16x16x32_bf16 v[68:71], a[36:39], v[40:43], v[68:71]
  v_mul_f32 v104, s24, v104
  v_mul_f32 v105, s24, v105
  v_mfma_f32_16x16x32_bf16 v[80:83], a[40:43], v[40:43], v[80:83]
  buffer_load_dwordx4 v18, s[12:15], s19 offen lds
  v_mfma_f32_16x16x32_bf16 v[84:87], a[44:47], v[40:43], v[84:87]
  s_waitcnt lgkmcnt(5)
  v_cvt_pk_bf16_f32 v132, v104, v105
  v_mul_f32 v106, s24, v106
  v_mfma_f32_16x16x32_bf16 v[72:75], a[32:35], v[44:47], v[72:75]
  ds_read_b128 v[36:39], v11 offset:8192
  v_mfma_f32_16x16x32_bf16 v[76:79], a[36:39], v[44:47], v[76:79]
  v_mul_f32 v107, s24, v107
  v_cvt_pk_bf16_f32 v133, v106, v107
  v_mfma_f32_16x16x32_bf16 v[88:91], a[40:43], v[44:47], v[88:91]
  v_mfma_f32_16x16x32_bf16 v[92:95], a[44:47], v[44:47], v[92:95]
  s_waitcnt lgkmcnt(5)
  v_mul_f32 v108, s24, v108
  v_mul_f32 v109, s24, v109
  v_mfma_f32_16x16x32_bf16 v[64:67], a[48:51], v[48:51], v[64:67]
  s_add_u32 m0, s25, 3072
  ds_read_b128 v[40:43], v12 offset:8192
  v_mfma_f32_16x16x32_bf16 v[68:71], a[52:55], v[48:51], v[68:71]
  v_cvt_pk_bf16_f32 v134, v108, v109
  v_mul_f32 v110, s24, v110
  v_mfma_f32_16x16x32_bf16 v[80:83], a[56:59], v[48:51], v[80:83]
  buffer_load_dwordx4 v19, s[12:15], s19 offen lds
  v_mfma_f32_16x16x32_bf16 v[84:87], a[60:63], v[48:51], v[84:87]
  s_waitcnt lgkmcnt(5)
  v_mul_f32 v111, s24, v111
  v_cvt_pk_bf16_f32 v135, v110, v111
  v_mfma_f32_16x16x32_bf16 v[72:75], a[48:51], v[52:55], v[72:75]
  ds_read_b128 v[44:47], v13 offset:8192
  v_mfma_f32_16x16x32_bf16 v[76:79], a[52:55], v[52:55], v[76:79]
  v_mul_f32 v112, s24, v112
  v_mul_f32 v113, s24, v113
  v_mfma_f32_16x16x32_bf16 v[88:91], a[56:59], v[52:55], v[88:91]
  v_mfma_f32_16x16x32_bf16 v[92:95], a[60:63], v[52:55], v[92:95]
  s_waitcnt lgkmcnt(5)
  v_cvt_pk_bf16_f32 v136, v112, v113
  v_mul_f32 v114, s24, v114
  v_mfma_f32_16x16x32_bf16 v[64:67], a[64:67], v[24:27], v[64:67]
  s_add_u32 m0, s25, 4096
  ds_read_b128 v[48:51], v14 offset:8192
  v_mfma_f32_16x16x32_bf16 v[68:71], a[68:71], v[24:27], v[68:71]
  v_mul_f32 v115, s24, v115
  v_cvt_pk_bf16_f32 v137, v114, v115
  v_mfma_f32_16x16x32_bf16 v[80:83], a[72:75], v[24:27], v[80:83]
  buffer_load_dwordx4 v20, s[12:15], s19 offen lds
  v_mfma_f32_16x16x32_bf16 v[84:87], a[76:79], v[24:27], v[84:87]
  s_waitcnt lgkmcnt(5)
  v_mul_f32 v116, s24, v116
  v_mul_f32 v117, s24, v117
  v_mfma_f32_16x16x32_bf16 v[72:75], a[64:67], v[28:31], v[72:75]
  ds_read_b128 v[52:55], v15 offset:8192
  v_mfma_f32_16x16x32_bf16 v[76:79], a[68:71], v[28:31], v[76:79]
  v_cvt_pk_bf16_f32 v138, v116, v117
  v_mul_f32 v118, s24, v118
  v_mfma_f32_16x16x32_bf16 v[88:91], a[72:75], v[28:31], v[88:91]
  v_mfma_f32_16x16x32_bf16 v[92:95], a[76:79], v[28:31], v[92:95]
  s_waitcnt lgkmcnt(5)
  v_mul_f32 v119, s24, v119
  v_cvt_pk_bf16_f32 v139, v118, v119
  v_mfma_f32_16x16x32_bf16 v[64:67], a[80:83], v[32:35], v[64:67]
  s_add_u32 m0, s25, 5120
  ds_read_b128 v[24:27], v8 offset:16384
  v_mfma_f32_16x16x32_bf16 v[68:71], a[84:87], v[32:35], v[68:71]
  v_mul_f32 v120, s24, v120
  v_mul_f32 v121, s24, v121
  v_mfma_f32_16x16x32_bf16 v[80:83], a[88:91], v[32:35], v[80:83]
  buffer_load_dwordx4 v21, s[12:15], s19 offen lds
  v_mfma_f32_16x16x32_bf16 v[84:87], a[92:95], v[32:35], v[84:87]
  s_waitcnt lgkmcnt(5)
  v_cvt_pk_bf16_f32 v140, v120, v121
  v_mul_f32 v122, s24, v122
  v_mfma_f32_16x16x32_bf16 v[72:75], a[80:83], v[36:39], v[72:75]
  ds_read_b128 v[28:31], v9 offset:16384
  v_mfma_f32_16x16x32_bf16 v[76:79], a[84:87], v[36:39], v[76:79]
  v_mul_f32 v123, s24, v123
  v_cvt_pk_bf16_f32 v141, v122, v123
  v_mfma_f32_16x16x32_bf16 v[88:91], a[88:91], v[36:39], v[88:91]
  v_mfma_f32_16x16x32_bf16 v[92:95], a[92:95], v[36:39], v[92:95]
  s_waitcnt lgkmcnt(5)
  v_mul_f32 v124, s24, v124
  v_mul_f32 v125, s24, v125
  v_mfma_f32_16x16x32_bf16 v[64:67], a[96:99], v[40:43], v[64:67]
  s_add_u32 m0, s25, 6144
  ds_read_b128 v[32:35], v10 offset:16384
  v_mfma_f32_16x16x32_bf16 v[68:71], a[100:103], v[40:43], v[68:71]
  v_cvt_pk_bf16_f32 v142, v124, v125
  v_mul_f32 v126, s24, v126
  v_mfma_f32_16x16x32_bf16 v[80:83], a[104:107], v[40:43], v[80:83]
  buffer_load_dwordx4 v22, s[12:15], s19 offen lds
  v_mfma_f32_16x16x32_bf16 v[84:87], a[108:111], v[40:43], v[84:87]
  s_waitcnt lgkmcnt(5)
  v_mul_f32 v127, s24, v127
  v_cvt_pk_bf16_f32 v143, v126, v127
  v_mfma_f32_16x16x32_bf16 v[72:75], a[96:99], v[44:47], v[72:75]
  ds_read_b128 v[36:39], v11 offset:16384
  v_mfma_f32_16x16x32_bf16 v[76:79], a[100:103], v[44:47], v[76:79]
  v_mfma_f32_16x16x32_bf16 v[88:91], a[104:107], v[44:47], v[88:91]
  v_mfma_f32_16x16x32_bf16 v[92:95], a[108:111], v[44:47], v[92:95]
  s_waitcnt lgkmcnt(5)
  v_mfma_f32_16x16x32_bf16 v[64:67], a[112:115], v[48:51], v[64:67]
  s_add_u32 m0, s25, 7168
  ds_read_b128 v[40:43], v12 offset:16384
  v_mfma_f32_16x16x32_bf16 v[68:71], a[116:119], v[48:51], v[68:71]
  v_mfma_f32_16x16x32_bf16 v[80:83], a[120:123], v[48:51], v[80:83]
  buffer_load_dwordx4 v23, s[12:15], s19 offen lds
  v_mfma_f32_16x16x32_bf16 v[84:87], a[124:127], v[48:51], v[84:87]
  s_waitcnt lgkmcnt(5)
  v_mfma_f32_16x16x32_bf16 v[72:75], a[112:115], v[52:55], v[72:75]
  s_cmp_gt_u32 s23, 3
  ds_read_b128 v[44:47], v13 offset:16384
  v_mfma_f32_16x16x32_bf16 v[76:79], a[116:119], v[52:55], v[76:79]
  v_mfma_f32_16x16x32_bf16 v[88:91], a[120:123], v[52:55], v[88:91]
  s_cselect_b32 s26, s20, 0
  v_mfma_f32_16x16x32_bf16 v[92:95], a[124:127], v[52:55], v[92:95]
  s_waitcnt lgkmcnt(5)
  v_mfma_f32_16x16x32_bf16 v[64:67], a[128:131], v[24:27], v[64:67]
  s_add_u32 s19, s19, s26
  ds_read_b128 v[48:51], v14 offset:16384
  v_mfma_f32_16x16x32_bf16 v[68:71], a[132:135], v[24:27], v[68:71]
  v_mfma_f32_16x16x32_bf16 v[80:83], a[136:139], v[24:27], v[80:83]
  s_add_u32 s25, s25, 32768
  v_mfma_f32_16x16x32_bf16 v[84:87], a[140:143], v[24:27], v[84:87]
  s_waitcnt lgkmcnt(5)
  v_mfma_f32_16x16x32_bf16 v[72:75], a[128:131], v[28:31], v[72:75]
  s_and_b32 s25, s25, 0x1ffff
  ds_read_b128 v[52:55], v15 offset:16384
  v_mfma_f32_16x16x32_bf16 v[76:79], a[132:135], v[28:31], v[76:79]
  v_mfma_f32_16x16x32_bf16 v[88:91], a[136:139], v[28:31], v[88:91]
  buffer_store_dwordx4 v[128:131], v7, s[4:7], s21 offen offset:0 sc1
  v_mfma_f32_16x16x32_bf16 v[92:95], a[140:143], v[28:31], v[92:95]
  s_waitcnt lgkmcnt(5)
  v_mfma_f32_16x16x32_bf16 v[64:67], a[144:147], v[32:35], v[64:67]
  ds_read_b128 v[24:27], v8 offset:24576
  v_mfma_f32_16x16x32_bf16 v[68:71], a[148:151], v[32:35], v[68:71]
  v_mfma_f32_16x16x32_bf16 v[80:83], a[152:155], v[32:35], v[80:83]
  v_mfma_f32_16x16x32_bf16 v[84:87], a[156:159], v[32:35], v[84:87]
  s_waitcnt lgkmcnt(5)
  v_mfma_f32_16x16x32_bf16 v[72:75], a[144:147], v[36:39], v[72:75]
  ds_read_b128 v[28:31], v9 offset:24576
  v_mfma_f32_16x16x32_bf16 v[76:79], a[148:151], v[36:39], v[76:79]
  v_mfma_f32_16x16x32_bf16 v[88:91], a[152:155], v[36:39], v[88:91]
  buffer_store_dwordx4 v[132:135], v7, s[4:7], s21 offen offset:256 sc1
  v_mfma_f32_16x16x32_bf16 v[92:95], a[156:159], v[36:39], v[92:95]
  s_waitcnt lgkmcnt(5)
  v_mfma_f32_16x16x32_bf16 v[64:67], a[160:163], v[40:43], v[64:67]
  ds_read_b128 v[32:35], v10 offset:24576
  v_mfma_f32_16x16x32_bf16 v[68:71], a[164:167], v[40:43], v[68:71]
  v_mfma_f32_16x16x32_bf16 v[80:83], a[168:171], v[40:43], v[80:83]
  v_mfma_f32_16x16x32_bf16 v[84:87], a[172:175], v[40:43], v[84:87]
  s_waitcnt lgkmcnt(5)
  v_mfma_f32_16x16x32_bf16 v[72:75], a[160:163], v[44:47], v[72:75]
  ds_read_b128 v[36:39], v11 offset:24576
  v_mfma_f32_16x16x32_bf16 v[76:79], a[164:167], v[44:47], v[76:79]
  v_mfma_f32_16x16x32_bf16 v[88:91], a[168:171], v[44:47], v[88:91]
  buffer_store_dwordx4 v[136:139], v7, s[4:7], s21 offen offset:2048 sc1
  v_mfma_f32_16x16x32_bf16 v[92:95], a[172:175], v[44:47], v[92:95]
  s_waitcnt lgkmcnt(5)
  v_mfma_f32_16x16x32_bf16 v[64:67], a[176:179], v[48:51], v[64:67]
  ds_read_b128 v[40:43], v12 offset:24576
  v_mfma_f32_16x16x32_bf16 v[68:71], a[180:183], v[48:51], v[68:71]
  v_mfma_f32_16x16x32_bf16 v[80:83], a[184:187], v[48:51], v[80:83]
  v_mfma_f32_16x16x32_bf16 v[84:87], a[188:191], v[48:51], v[84:87]
  s_waitcnt lgkmcnt(5)
  v_mfma_f32_16x16x32_bf16 v[72:75], a[176:179], v[52:55], v[72:75]
  ds_read_b128 v[44:47], v13 offset:24576
  v_mfma_f32_16x16x32_bf16 v[76:79], a[180:183], v[52:55], v[76:79]
  v_mfma_f32_16x16x32_bf16 v[88:91], a[184:187], v[52:55], v[88:91]
  buffer_store_dwordx4 v[140:143], v7, s[4:7], s21 offen offset:2304 sc1
  v_mfma_f32_16x16x32_bf16 v[92:95], a[188:191], v[52:55], v[92:95]
  s_waitcnt lgkmcnt(5)
  v_mfma_f32_16x16x32_bf16 v[64:67], a[192:195], v[24:27], v[64:67]
  s_mov_b32 s21, s27
  ds_read_b128 v[48:51], v14 offset:24576
  v_mfma_f32_16x16x32_bf16 v[68:71], a[196:199], v[24:27], v[68:71]
  v_mov_b32 v7, v56
  v_mfma_f32_16x16x32_bf16 v[80:83], a[200:203], v[24:27], v[80:83]
  v_mfma_f32_16x16x32_bf16 v[84:87], a[204:207], v[24:27], v[84:87]
  s_waitcnt lgkmcnt(5)
  v_mfma_f32_16x16x32_bf16 v[72:75], a[192:195], v[28:31], v[72:75]
  s_add_u32 s27, s27, s22
  ds_read_b128 v[52:55], v15 offset:24576
  v_mfma_f32_16x16x32_bf16 v[76:79], a[196:199], v[28:31], v[76:79]
  v_mfma_f32_16x16x32_bf16 v[88:91], a[200:203], v[28:31], v[88:91]
  s_waitcnt vmcnt(13)
  s_barrier
  v_mfma_f32_16x16x32_bf16 v[92:95], a[204:207], v[28:31], v[92:95]
  s_waitcnt lgkmcnt(5)
  v_mfma_f32_16x16x32_bf16 v[64:67], a[208:211], v[32:35], v[64:67]
  ds_read_b128 v[24:27], v8 offset:32768
  v_mfma_f32_16x16x32_bf16 v[68:71], a[212:215], v[32:35], v[68:71]
  v_mfma_f32_16x16x32_bf16 v[80:83], a[216:219], v[32:35], v[80:83]
  v_mfma_f32_16x16x32_bf16 v[84:87], a[220:223], v[32:35], v[84:87]
  s_waitcnt lgkmcnt(5)
  v_mfma_f32_16x16x32_bf16 v[72:75], a[208:211], v[36:39], v[72:75]
  s_add_u32 s29, s29, 1
  ds_read_b128 v[28:31], v9 offset:32768
  v_mfma_f32_16x16x32_bf16 v[76:79], a[212:215], v[36:39], v[76:79]
  v_mfma_f32_16x16x32_bf16 v[88:91], a[216:219], v[36:39], v[88:91]
  s_max_i32 s30, s29, 0
  v_mfma_f32_16x16x32_bf16 v[92:95], a[220:223], v[36:39], v[92:95]
  s_waitcnt lgkmcnt(5)
  v_mov_b32 v144, s30
  v_mfma_f32_16x16x32_bf16 v[64:67], a[224:227], v[40:43], v[64:67]
  ds_read_b128 v[32:35], v10 offset:32768
  v_mfma_f32_16x16x32_bf16 v[68:71], a[228:231], v[40:43], v[68:71]
  v_mfma_f32_16x16x32_bf16 v[80:83], a[232:235], v[40:43], v[80:83]
  buffer_store_dword v144, v145, s[4:7], s31 offen sc1
  v_mfma_f32_16x16x32_bf16 v[84:87], a[236:239], v[40:43], v[84:87]
  s_waitcnt lgkmcnt(5)
  v_mfma_f32_16x16x32_bf16 v[72:75], a[224:227], v[44:47], v[72:75]
  ds_read_b128 v[36:39], v11 offset:32768
  v_mfma_f32_16x16x32_bf16 v[76:79], a[228:231], v[44:47], v[76:79]
  v_mfma_f32_16x16x32_bf16 v[88:91], a[232:235], v[44:47], v[88:91]
  v_mfma_f32_16x16x32_bf16 v[92:95], a[236:239], v[44:47], v[92:95]
  s_waitcnt lgkmcnt(5)
  v_mfma_f32_16x16x32_bf16 v[64:67], a[240:243], v[48:51], v[64:67]
  s_sub_u32 s23, s23, 1
  ds_read_b128 v[40:43], v12 offset:32768
  v_mfma_f32_16x16x32_bf16 v[68:71], a[244:247], v[48:51], v[68:71]
  v_mfma_f32_16x16x32_bf16 v[80:83], a[248:251], v[48:51], v[80:83]
  v_mfma_f32_16x16x32_bf16 v[84:87], a[252:255], v[48:51], v[84:87]
  s_waitcnt lgkmcnt(5)
  v_mfma_f32_16x16x32_bf16 v[72:75], a[240:243], v[52:55], v[72:75]
  s_cmp_eq_u32 s23, 0
  ds_read_b128 v[44:47], v13 offset:32768
  v_mfma_f32_16x16x32_bf16 v[76:79], a[244:247], v[52:55], v[76:79]
  v_mfma_f32_16x16x32_bf16 v[88:91], a[248:251], v[52:55], v[88:91]
  v_mfma_f32_16x16x32_bf16 v[92:95], a[252:255], v[52:55], v[92:95]
  s_cbranch_scc1 G_done0_138
  s_waitcnt lgkmcnt(5)
  v_mfma_f32_16x16x32_bf16 v[96:99], a[0:3], v[24:27], 0
  s_add_u32 m0, s25, 0
  ds_read_b128 v[48:51], v14 offset:32768
  v_mfma_f32_16x16x32_bf16 v[100:103], a[4:7], v[24:27], 0
  v_mfma_f32_16x16x32_bf16 v[112:115], a[8:11], v[24:27], 0
  buffer_load_dwordx4 v16, s[12:15], s19 offen lds
  v_mfma_f32_16x16x32_bf16 v[116:119], a[12:15], v[24:27], 0
  s_waitcnt lgkmcnt(5)
  v_mfma_f32_16x16x32_bf16 v[104:107], a[0:3], v[28:31], 0
  ds_read_b128 v[52:55], v15 offset:32768
  v_mfma_f32_16x16x32_bf16 v[108:111], a[4:7], v[28:31], 0
  v_mul_f32 v64, s24, v64
  v_mul_f32 v65, s24, v65
  v_mfma_f32_16x16x32_bf16 v[120:123], a[8:11], v[28:31], 0
  v_mfma_f32_16x16x32_bf16 v[124:127], a[12:15], v[28:31], 0
  s_waitcnt lgkmcnt(5)
  v_cvt_pk_bf16_f32 v128, v64, v65
  v_mul_f32 v66, s24, v66
  v_mfma_f32_16x16x32_bf16 v[96:99], a[16:19], v[32:35], v[96:99]
  s_add_u32 m0, s25, 1024
  ds_read_b128 v[24:27], v8 offset:40960
  v_mfma_f32_16x16x32_bf16 v[100:103], a[20:23], v[32:35], v[100:103]
  v_mul_f32 v67, s24, v67
  v_cvt_pk_bf16_f32 v129, v66, v67
  v_mfma_f32_16x16x32_bf16 v[112:115], a[24:27], v[32:35], v[112:115]
  buffer_load_dwordx4 v17, s[12:15], s19 offen lds
  v_mfma_f32_16x16x32_bf16 v[116:119], a[28:31], v[32:35], v[116:119]
  s_waitcnt lgkmcnt(5)
  v_mul_f32 v68, s24, v68
  v_mul_f32 v69, s24, v69
  v_mfma_f32_16x16x32_bf16 v[104:107], a[16:19], v[36:39], v[104:107]
  ds_read_b128 v[28:31], v9 offset:40960
  v_mfma_f32_16x16x32_bf16 v[108:111], a[20:23], v[36:39], v[108:111]
  v_cvt_pk_bf16_f32 v130, v68, v69
  v_mul_f32 v70, s24, v70
  v_mfma_f32_16x16x32_bf16 v[120:123], a[24:27], v[36:39], v[120:123]
  v_mfma_f32_16x16x32_bf16 v[124:127], a[28:31], v[36:39], v[124:127]
  s_waitcnt lgkmcnt(5)
  v_mul_f32 v71, s24, v71
  v_cvt_pk_bf16_f32 v131, v70, v71
  v_mfma_f32_16x16x32_bf16 v[96:99], a[32:35], v[40:43], v[96:99]
  s_add_u32 m0, s25, 2048
  ds_read_b128 v[32:35], v10 offset:40960
  v_mfma_f32_16x16x32_bf16 v[100:103], a[36:39], v[40:43], v[100:103]
  v_mul_f32 v72, s24, v72
  v_mul_f32 v73, s24, v73
  v_mfma_f32_16x16x32_bf16 v[112:115], a[40:43], v[40:43], v[112:115]
  buffer_load_dwordx4 v18, s[12:15], s19 offen lds
  v_mfma_f32_16x16x32_bf16 v[116:119], a[44:47], v[40:43], v[116:119]
  s_waitcnt lgkmcnt(5)
  v_cvt_pk_bf16_f32 v132, v72, v73
  v_mul_f32 v74, s24, v74
  v_mfma_f32_16x16x32_bf16 v[104:107], a[32:35], v[44:47], v[104:107]
  ds_read_b128 v[36:39], v11 offset:40960
  v_mfma_f32_16x16x32_bf16 v[108:111], a[36:39], v[44:47], v[108:111]
  v_mul_f32 v75, s24, v75
  v_cvt_pk_bf16_f32 v133, v74, v75
  v_mfma_f32_16x16x32_bf16 v[120:123], a[40:43], v[44:47], v[120:123]
  v_mfma_f32_16x16x32_bf16 v[124:127], a[44:47], v[44:47], v[124:127]
  s_waitcnt lgkmcnt(5)
  v_mul_f32 v76, s24, v76
  v_mul_f32 v77, s24, v77
  v_mfma_f32_16x16x32_bf16 v[96:99], a[48:51], v[48:51], v[96:99]
  s_add_u32 m0, s25, 3072
  ds_read_b128 v[40:43], v12 offset:40960
  v_mfma_f32_16x16x32_bf16 v[100:103], a[52:55], v[48:51], v[100:103]
  v_cvt_pk_bf16_f32 v134, v76, v77
  v_mul_f32 v78, s24, v78
  v_mfma_f32_16x16x32_bf16 v[112:115], a[56:59], v[48:51], v[112:115]
  buffer_load_dwordx4 v19, s[12:15], s19 offen lds
  v_mfma_f32_16x16x32_bf16 v[116:119], a[60:63], v[48:51], v[116:119]
  s_waitcnt lgkmcnt(5)
  v_mul_f32 v79, s24, v79
  v_cvt_pk_bf16_f32 v135, v78, v79
  v_mfma_f32_16x16x32_bf16 v[104:107], a[48:51], v[52:55], v[104:107]
  ds_read_b128 v[44:47], v13 offset:40960
  v_mfma_f32_16x16x32_bf16 v[108:111], a[52:55], v[52:55], v[108:111]
  v_mul_f32 v80, s24, v80
  v_mul_f32 v81, s24, v81
  v_mfma_f32_16x16x32_bf16 v[120:123], a[56:59], v[52:55], v[120:123]
  v_mfma_f32_16x16x32_bf16 v[124:127], a[60:63], v[52:55], v[124:127]
  s_waitcnt lgkmcnt(5)
  v_cvt_pk_bf16_f32 v136, v80, v81
  v_mul_f32 v82, s24, v82
  v_mfma_f32_16x16x32_bf16 v[96:99], a[64:67], v[24:27], v[96:99]
  s_add_u32 m0, s25, 4096
  ds_read_b128 v[48:51], v14 offset:40960
  v_mfma_f32_16x16x32_bf16 v[100:103], a[68:71], v[24:27], v[100:103]
  v_mul_f32 v83, s24, v83
  v_cvt_pk_bf16_f32 v137, v82, v83
  v_mfma_f32_16x16x32_bf16 v[112:115], a[72:75], v[24:27], v[112:115]
  buffer_load_dwordx4 v20, s[12:15], s19 offen lds
  v_mfma_f32_16x16x32_bf16 v[116:119], a[76:79], v[24:27], v[116:119]
  s_waitcnt lgkmcnt(5)
  v_mul_f32 v84, s24, v84
  v_mul_f32 v85, s24, v85
  v_mfma_f32_16x16x32_bf16 v[104:107], a[64:67], v[28:31], v[104:107]
  ds_read_b128 v[52:55], v15 offset:40960
  v_mfma_f32_16x16x32_bf16 v[108:111], a[68:71], v[28:31], v[108:111]
  v_cvt_pk_bf16_f32 v138, v84, v85
  v_mul_f32 v86, s24, v86
  v_mfma_f32_16x16x32_bf16 v[120:123], a[72:75], v[28:31], v[120:123]
  v_mfma_f32_16x16x32_bf16 v[124:127], a[76:79], v[28:31], v[124:127]
  s_waitcnt lgkmcnt(5)
  v_mul_f32 v87, s24, v87
  v_cvt_pk_bf16_f32 v139, v86, v87
  v_mfma_f32_16x16x32_bf16 v[96:99], a[80:83], v[32:35], v[96:99]
  s_add_u32 m0, s25, 5120
  ds_read_b128 v[24:27], v8 offset:49152
  v_mfma_f32_16x16x32_bf16 v[100:103], a[84:87], v[32:35], v[100:103]
  v_mul_f32 v88, s24, v88
  v_mul_f32 v89, s24, v89
  v_mfma_f32_16x16x32_bf16 v[112:115], a[88:91], v[32:35], v[112:115]
  buffer_load_dwordx4 v21, s[12:15], s19 offen lds
  v_mfma_f32_16x16x32_bf16 v[116:119], a[92:95], v[32:35], v[116:119]
  s_waitcnt lgkmcnt(5)
  v_cvt_pk_bf16_f32 v140, v88, v89
  v_mul_f32 v90, s24, v90
  v_mfma_f32_16x16x32_bf16 v[104:107], a[80:83], v[36:39], v[104:107]
  ds_read_b128 v[28:31], v9 offset:49152
  v_mfma_f32_16x16x32_bf16 v[108:111], a[84:87], v[36:39], v[108:111]
  v_mul_f32 v91, s24, v91
  v_cvt_pk_bf16_f32 v141, v90, v91
  v_mfma_f32_16x16x32_bf16 v[120:123], a[88:91], v[36:39], v[120:123]
  v_mfma_f32_16x16x32_bf16 v[124:127], a[92:95], v[36:39], v[124:127]
  s_waitcnt lgkmcnt(5)
  v_mul_f32 v92, s24, v92
  v_mul_f32 v93, s24, v93
  v_mfma_f32_16x16x32_bf16 v[96:99], a[96:99], v[40:43], v[96:99]
  s_add_u32 m0, s25, 6144
  ds_read_b128 v[32:35], v10 offset:49152
  v_mfma_f32_16x16x32_bf16 v[100:103], a[100:103], v[40:43], v[100:103]
  v_cvt_pk_bf16_f32 v142, v92, v93
  v_mul_f32 v94, s24, v94
  v_mfma_f32_16x16x32_bf16 v[112:115], a[104:107], v[40:43], v[112:115]
  buffer_load_dwordx4 v22, s[12:15], s19 offen lds
  v_mfma_f32_16x16x32_bf16 v[116:119], a[108:111], v[40:43], v[116:119]
  s_waitcnt lgkmcnt(5)
  v_mul_f32 v95, s24, v95
  v_cvt_pk_bf16_f32 v143, v94, v95
  v_mfma_f32_16x16x32_bf16 v[104:107], a[96:99], v[44:47], v[104:107]
  ds_read_b128 v[36:39], v11 offset:49152
  v_mfma_f32_16x16x32_bf16 v[108:111], a[100:103], v[44:47], v[108:111]
  v_mfma_f32_16x16x32_bf16 v[120:123], a[104:107], v[44:47], v[120:123]
  v_mfma_f32_16x16x32_bf16 v[124:127], a[108:111], v[44:47], v[124:127]
  s_waitcnt lgkmcnt(5)
  v_mfma_f32_16x16x32_bf16 v[96:99], a[112:115], v[48:51], v[96:99]
  s_add_u32 m0, s25, 7168
  ds_read_b128 v[40:43], v12 offset:49152
  v_mfma_f32_16x16x32_bf16 v[100:103], a[116:119], v[48:51], v[100:103]
  v_mfma_f32_16x16x32_bf16 v[112:115], a[120:123], v[48:51], v[112:115]
  buffer_load_dwordx4 v23, s[12:15], s19 offen lds
  v_mfma_f32_16x16x32_bf16 v[116:119], a[124:127], v[48:51], v[116:119]
  s_waitcnt lgkmcnt(5)
  v_mfma_f32_16x16x32_bf16 v[104:107], a[112:115], v[52:55], v[104:107]
  s_cmp_gt_u32 s23, 3
  ds_read_b128 v[44:47], v13 offset:49152
  v_mfma_f32_16x16x32_bf16 v[108:111], a[116:119], v[52:55], v[108:111]
  v_mfma_f32_16x16x32_bf16 v[120:123], a[120:123], v[52:55], v[120:123]
  s_cselect_b32 s26, s20, 0
  v_mfma_f32_16x16x32_bf16 v[124:127], a[124:127], v[52:55], v[124:127]
  s_waitcnt lgkmcnt(5)
  v_mfma_f32_16x16x32_bf16 v[96:99], a[128:131], v[24:27], v[96:99]
  s_add_u32 s19, s19, s26
  ds_read_b128 v[48:51], v14 offset:49152
  v_mfma_f32_16x16x32_bf16 v[100:103], a[132:135], v[24:27], v[100:103]
  v_mfma_f32_16x16x32_bf16 v[112:115], a[136:139], v[24:27], v[112:115]
  s_add_u32 s25, s25, 32768
  v_mfma_f32_16x16x32_bf16 v[116:119], a[140:143], v[24:27], v[116:119]
  s_waitcnt lgkmcnt(5)
  v_mfma_f32_16x16x32_bf16 v[104:107], a[128:131], v[28:31], v[104:107]
  s_and_b32 s25, s25, 0x1ffff
  ds_read_b128 v[52:55], v15 offset:49152
  v_mfma_f32_16x16x32_bf16 v[108:111], a[132:135], v[28:31], v[108:111]
  v_mfma_f32_16x16x32_bf16 v[120:123], a[136:139], v[28:31], v[120:123]
  buffer_store_dwordx4 v[128:131], v7, s[4:7], s21 offen offset:0 sc1
  v_mfma_f32_16x16x32_bf16 v[124:127], a[140:143], v[28:31], v[124:127]
  s_waitcnt lgkmcnt(5)
  v_mfma_f32_16x16x32_bf16 v[96:99], a[144:147], v[32:35], v[96:99]
  ds_read_b128 v[24:27], v8 offset:57344
  v_mfma_f32_16x16x32_bf16 v[100:103], a[148:151], v[32:35], v[100:103]
  v_mfma_f32_16x16x32_bf16 v[112:115], a[152:155], v[32:35], v[112:115]
  v_mfma_f32_16x16x32_bf16 v[116:119], a[156:159], v[32:35], v[116:119]
  s_waitcnt lgkmcnt(5)
  v_xor_b32 v8, 0x10000, v8
  v_mfma_f32_16x16x32_bf16 v[104:107], a[144:147], v[36:39], v[104:107]
  ds_read_b128 v[28:31], v9 offset:57344
  v_mfma_f32_16x16x32_bf16 v[108:111], a[148:151], v[36:39], v[108:111]
  v_mfma_f32_16x16x32_bf16 v[120:123], a[152:155], v[36:39], v[120:123]
  buffer_store_dwordx4 v[132:135], v7, s[4:7], s21 offen offset:256 sc1
  v_mfma_f32_16x16x32_bf16 v[124:127], a[156:159], v[36:39], v[124:127]
  s_waitcnt lgkmcnt(5)
  v_xor_b32 v9, 0x10000, v9
  v_mfma_f32_16x16x32_bf16 v[96:99], a[160:163], v[40:43], v[96:99]
  ds_read_b128 v[32:35], v10 offset:57344
  v_mfma_f32_16x16x32_bf16 v[100:103], a[164:167], v[40:43], v[100:103]
  v_mfma_f32_16x16x32_bf16 v[112:115], a[168:171], v[40:43], v[112:115]
  v_mfma_f32_16x16x32_bf16 v[116:119], a[172:175], v[40:43], v[116:119]
  s_waitcnt lgkmcnt(5)
  v_xor_b32 v10, 0x10000, v10
  v_mfma_f32_16x16x32_bf16 v[104:107], a[160:163], v[44:47], v[104:107]
  ds_read_b128 v[36:39], v11 offset:57344
  v_mfma_f32_16x16x32_bf16 v[108:111], a[164:167], v[44:47], v[108:111]
  v_mfma_f32_16x16x32_bf16 v[120:123], a[168:171], v[44:47], v[120:123]
  buffer_store_dwordx4 v[136:139], v7, s[4:7], s21 offen offset:2048 sc1
  v_mfma_f32_16x16x32_bf16 v[124:127], a[172:175], v[44:47], v[124:127]
  s_waitcnt lgkmcnt(5)
  v_xor_b32 v11, 0x10000, v11
  v_mfma_f32_16x16x32_bf16 v[96:99], a[176:179], v[48:51], v[96:99]
  ds_read_b128 v[40:43], v12 offset:57344
  v_mfma_f32_16x16x32_bf16 v[100:103], a[180:183], v[48:51], v[100:103]
  v_mfma_f32_16x16x32_bf16 v[112:115], a[184:187], v[48:51], v[112:115]
  v_mfma_f32_16x16x32_bf16 v[116:119], a[188:191], v[48:51], v[116:119]
  s_waitcnt lgkmcnt(5)
  v_xor_b32 v12, 0x10000, v12
  v_mfma_f32_16x16x32_bf16 v[104:107], a[176:179], v[52:55], v[104:107]
  ds_read_b128 v[44:47], v13 offset:57344
  v_mfma_f32_16x16x32_bf16 v[108:111], a[180:183], v[52:55], v[108:111]
  v_mfma_f32_16x16x32_bf16 v[120:123], a[184:187], v[52:55], v[120:123]
  buffer_store_dwordx4 v[140:143], v7, s[4:7], s21 offen offset:2304 sc1
  v_mfma_f32_16x16x32_bf16 v[124:127], a[188:191], v[52:55], v[124:127]
  s_waitcnt lgkmcnt(5)
  v_xor_b32 v13, 0x10000, v13
  v_mfma_f32_16x16x32_bf16 v[96:99], a[192:195], v[24:27], v[96:99]
  s_mov_b32 s21, s27
  ds_read_b128 v[48:51], v14 offset:57344
  v_mfma_f32_16x16x32_bf16 v[100:103], a[196:199], v[24:27], v[100:103]
  v_mov_b32 v7, v56
  v_mfma_f32_16x16x32_bf16 v[112:115], a[200:203], v[24:27], v[112:115]
  v_mfma_f32_16x16x32_bf16 v[116:119], a[204:207], v[24:27], v[116:119]
  s_waitcnt lgkmcnt(5)
  v_xor_b32 v14, 0x10000, v14
  v_mfma_f32_16x16x32_bf16 v[104:107], a[192:195], v[28:31], v[104:107]
  s_add_u32 s27, s27, s22
  ds_read_b128 v[52:55], v15 offset:57344
  v_mfma_f32_16x16x32_bf16 v[108:111], a[196:199], v[28:31], v[108:111]
  v_mfma_f32_16x16x32_bf16 v[120:123], a[200:203], v[28:31], v[120:123]
  s_waitcnt vmcnt(13)
  s_barrier
  v_mfma_f32_16x16x32_bf16 v[124:127], a[204:207], v[28:31], v[124:127]
  s_waitcnt lgkmcnt(5)
  v_xor_b32 v15, 0x10000, v15
  v_mfma_f32_16x16x32_bf16 v[96:99], a[208:211], v[32:35], v[96:99]
  ds_read_b128 v[24:27], v8 offset:0
  v_mfma_f32_16x16x32_bf16 v[100:103], a[212:215], v[32:35], v[100:103]
  v_mfma_f32_16x16x32_bf16 v[112:115], a[216:219], v[32:35], v[112:115]
  v_mfma_f32_16x16x32_bf16 v[116:119], a[220:223], v[32:35], v[116:119]
  s_waitcnt lgkmcnt(5)
  v_mfma_f32_16x16x32_bf16 v[104:107], a[208:211], v[36:39], v[104:107]
  s_add_u32 s29, s29, 1
  ds_read_b128 v[28:31], v9 offset:0
  v_mfma_f32_16x16x32_bf16 v[108:111], a[212:215], v[36:39], v[108:111]
  v_mfma_f32_16x16x32_bf16 v[120:123], a[216:219], v[36:39], v[120:123]
  s_max_i32 s30, s29, 0
  v_mfma_f32_16x16x32_bf16 v[124:127], a[220:223], v[36:39], v[124:127]
  s_waitcnt lgkmcnt(5)
  v_mov_b32 v144, s30
  v_mfma_f32_16x16x32_bf16 v[96:99], a[224:227], v[40:43], v[96:99]
  ds_read_b128 v[32:35], v10 offset:0
  v_mfma_f32_16x16x32_bf16 v[100:103], a[228:231], v[40:43], v[100:103]
  v_mfma_f32_16x16x32_bf16 v[112:115], a[232:235], v[40:43], v[112:115]
  buffer_store_dword v144, v145, s[4:7], s31 offen sc1
  v_mfma_f32_16x16x32_bf16 v[116:119], a[236:239], v[40:43], v[116:119]
  s_waitcnt lgkmcnt(5)
  v_mfma_f32_16x16x32_bf16 v[104:107], a[224:227], v[44:47], v[104:107]
  ds_read_b128 v[36:39], v11 offset:0
  v_mfma_f32_16x16x32_bf16 v[108:111], a[228:231], v[44:47], v[108:111]
  v_mfma_f32_16x16x32_bf16 v[120:123], a[232:235], v[44:47], v[120:123]
  v_mfma_f32_16x16x32_bf16 v[124:127], a[236:239], v[44:47], v[124:127]
  s_waitcnt lgkmcnt(5)
  v_mfma_f32_16x16x32_bf16 v[96:99], a[240:243], v[48:51], v[96:99]
  s_sub_u32 s23, s23, 1
  ds_read_b128 v[40:43], v12 offset:0
  v_mfma_f32_16x16x32_bf16 v[100:103], a[244:247], v[48:51], v[100:103]
  v_mfma_f32_16x16x32_bf16 v[112:115], a[248:251], v[48:51], v[112:115]
  v_mfma_f32_16x16x32_bf16 v[116:119], a[252:255], v[48:51], v[116:119]
  s_waitcnt lgkmcnt(5)
  v_mfma_f32_16x16x32_bf16 v[104:107], a[240:243], v[52:55], v[104:107]
  s_cmp_eq_u32 s23, 0
  ds_read_b128 v[44:47], v13 offset:0
  v_mfma_f32_16x16x32_bf16 v[108:111], a[244:247], v[52:55], v[108:111]
  v_mfma_f32_16x16x32_bf16 v[120:123], a[248:251], v[52:55], v[120:123]
  v_mfma_f32_16x16x32_bf16 v[124:127], a[252:255], v[52:55], v[124:127]
  s_cbranch_scc1 G_done1_139
  s_branch G_top_137
G_done0_138:
  s_nop 7
  s_nop 3
  v_mul_f32 v64, s24, v64
  v_mul_f32 v65, s24, v65
  v_cvt_pk_bf16_f32 v128, v64, v65
  v_mul_f32 v66, s24, v66
  v_mul_f32 v67, s24, v67
  v_cvt_pk_bf16_f32 v129, v66, v67
  v_mul_f32 v68, s24, v68
  v_mul_f32 v69, s24, v69
  v_cvt_pk_bf16_f32 v130, v68, v69
  v_mul_f32 v70, s24, v70
  v_mul_f32 v71, s24, v71
  v_cvt_pk_bf16_f32 v131, v70, v71
  buffer_store_dwordx4 v[128:131], v7, s[4:7], s21 offen offset:0 sc1
  v_mul_f32 v72, s24, v72
  v_mul_f32 v73, s24, v73
  v_cvt_pk_bf16_f32 v132, v72, v73
  v_mul_f32 v74, s24, v74
  v_mul_f32 v75, s24, v75
  v_cvt_pk_bf16_f32 v133, v74, v75
  v_mul_f32 v76, s24, v76
  v_mul_f32 v77, s24, v77
  v_cvt_pk_bf16_f32 v134, v76, v77
  v_mul_f32 v78, s24, v78
  v_mul_f32 v79, s24, v79
  v_cvt_pk_bf16_f32 v135, v78, v79
  buffer_store_dwordx4 v[132:135], v7, s[4:7], s21 offen offset:256 sc1
  v_mul_f32 v80, s24, v80
  v_mul_f32 v81, s24, v81
  v_cvt_pk_bf16_f32 v136, v80, v81
  v_mul_f32 v82, s24, v82
  v_mul_f32 v83, s24, v83
  v_cvt_pk_bf16_f32 v137, v82, v83
  v_mul_f32 v84, s24, v84
  v_mul_f32 v85, s24, v85
  v_cvt_pk_bf16_f32 v138, v84, v85
  v_mul_f32 v86, s24, v86
  v_mul_f32 v87, s24, v87
  v_cvt_pk_bf16_f32 v139, v86, v87
  buffer_store_dwordx4 v[136:139], v7, s[4:7], s21 offen offset:2048 sc1
  v_mul_f32 v88, s24, v88
  v_mul_f32 v89, s24, v89
  v_cvt_pk_bf16_f32 v140, v88, v89
  v_mul_f32 v90, s24, v90
  v_mul_f32 v91, s24, v91
  v_cvt_pk_bf16_f32 v141, v90, v91
  v_mul_f32 v92, s24, v92
  v_mul_f32 v93, s24, v93
  v_cvt_pk_bf16_f32 v142, v92, v93
  v_mul_f32 v94, s24, v94
  v_mul_f32 v95, s24, v95
  v_cvt_pk_bf16_f32 v143, v94, v95
  buffer_store_dwordx4 v[140:143], v7, s[4:7], s21 offen offset:2304 sc1
  s_branch G_fin_140
G_done1_139:
  s_nop 7
  s_nop 3
  v_mul_f32 v96, s24, v96
  v_mul_f32 v97, s24, v97
  v_cvt_pk_bf16_f32 v128, v96, v97
  v_mul_f32 v98, s24, v98
  v_mul_f32 v99, s24, v99
  v_cvt_pk_bf16_f32 v129, v98, v99
  v_mul_f32 v100, s24, v100
  v_mul_f32 v101, s24, v101
  v_cvt_pk_bf16_f32 v130, v100, v101
  v_mul_f32 v102, s24, v102
  v_mul_f32 v103, s24, v103
  v_cvt_pk_bf16_f32 v131, v102, v103
  buffer_store_dwordx4 v[128:131], v7, s[4:7], s21 offen offset:0 sc1
  v_mul_f32 v104, s24, v104
  v_mul_f32 v105, s24, v105
  v_cvt_pk_bf16_f32 v132, v104, v105
  v_mul_f32 v106, s24, v106
  v_mul_f32 v107, s24, v107
  v_cvt_pk_bf16_f32 v133, v106, v107
  v_mul_f32 v108, s24, v108
  v_mul_f32 v109, s24, v109
  v_cvt_pk_bf16_f32 v134, v108, v109
  v_mul_f32 v110, s24, v110
  v_mul_f32 v111, s24, v111
  v_cvt_pk_bf16_f32 v135, v110, v111
  buffer_store_dwordx4 v[132:135], v7, s[4:7], s21 offen offset:256 sc1
  v_mul_f32 v112, s24, v112
  v_mul_f32 v113, s24, v113
  v_cvt_pk_bf16_f32 v136, v112, v113
  v_mul_f32 v114, s24, v114
  v_mul_f32 v115, s24, v115
  v_cvt_pk_bf16_f32 v137, v114, v115
  v_mul_f32 v116, s24, v116
  v_mul_f32 v117, s24, v117
  v_cvt_pk_bf16_f32 v138, v116, v117
  v_mul_f32 v118, s24, v118
  v_mul_f32 v119, s24, v119
  v_cvt_pk_bf16_f32 v139, v118, v119
  buffer_store_dwordx4 v[136:139], v7, s[4:7], s21 offen offset:2048 sc1
  v_mul_f32 v120, s24, v120
  v_mul_f32 v121, s24, v121
  v_cvt_pk_bf16_f32 v140, v120, v121
  v_mul_f32 v122, s24, v122
  v_mul_f32 v123, s24, v123
  v_cvt_pk_bf16_f32 v141, v122, v123
  v_mul_f32 v124, s24, v124
  v_mul_f32 v125, s24, v125
  v_cvt_pk_bf16_f32 v142, v124, v125
  v_mul_f32 v126, s24, v126
  v_mul_f32 v127, s24, v127
  v_cvt_pk_bf16_f32 v143, v126, v127
  buffer_store_dwordx4 v[140:143], v7, s[4:7], s21 offen offset:2304 sc1
G_fin_140:
  s_waitcnt vmcnt(0) lgkmcnt(0)
  s_barrier
  s_add_u32 s30, s29, 2
  v_mov_b32 v144, s30
  v_min_u32 v145, 1, v0
  v_lshlrev_b32 v145, 30, v145
  buffer_store_dword v144, v145, s[4:7], s31 offen sc1
  s_branch P_end_131
P_v_130:
  s_mov_b32 s27, s21
  v_mov_b32 v7, 0x40000000
  s_mov_b32 s29, -2
  v_min_u32 v145, 1, v0
  v_lshlrev_b32 v145, 30, v145
  ds_read_b128 v[24:27], v8 offset:0
  ds_read_b128 v[28:31], v9 offset:0
  ds_read_b128 v[32:35], v10 offset:0
  ds_read_b128 v[36:39], v11 offset:0
  ds_read_b128 v[40:43], v12 offset:0
  ds_read_b128 v[44:47], v13 offset:0
.p2align 6
G_top_141:
  s_waitcnt lgkmcnt(5)
  v_mfma_f32_16x16x32_bf16 v[64:67], v[24:27], a[0:3], 0
  s_add_u32 m0, s25, 0
  ds_read_b128 v[48:51], v14 offset:0
  v_mfma_f32_16x16x32_bf16 v[72:75], v[24:27], a[4:7], 0
  v_mfma_f32_16x16x32_bf16 v[80:83], v[24:27], a[8:11], 0
  buffer_load_dwordx4 v16, s[12:15], s19 offen lds
  v_mfma_f32_16x16x32_bf16 v[88:91], v[24:27], a[12:15], 0
  s_waitcnt lgkmcnt(5)
  v_mfma_f32_16x16x32_bf16 v[68:71], v[28:31], a[0:3], 0
  ds_read_b128 v[52:55], v15 offset:0
  v_mfma_f32_16x16x32_bf16 v[76:79], v[28:31], a[4:7], 0
  v_cvt_pk_bf16_f32 v128, v96, v97
  v_cvt_pk_bf16_f32 v129, v98, v99
  v_mfma_f32_16x16x32_bf16 v[84:87], v[28:31], a[8:11], 0
  v_mfma_f32_16x16x32_bf16 v[92:95], v[28:31], a[12:15], 0
  s_waitcnt lgkmcnt(5)
  v_cvt_pk_bf16_f32 v130, v100, v101
  v_cvt_pk_bf16_f32 v131, v102, v103
  v_mfma_f32_16x16x32_bf16 v[64:67], v[32:35], a[16:19], v[64:67]
  s_add_u32 m0, s25, 1024
  ds_read_b128 v[24:27], v8 offset:8192
  v_mfma_f32_16x16x32_bf16 v[72:75], v[32:35], a[20:23], v[72:75]
  v_mfma_f32_16x16x32_bf16 v[80:83], v[32:35], a[24:27], v[80:83]
  buffer_load_dwordx4 v17, s[12:15], s19 offen lds
  v_mfma_f32_16x16x32_bf16 v[88:91], v[32:35], a[28:31], v[88:91]
  s_waitcnt lgkmcnt(5)
  v_mfma_f32_16x16x32_bf16 v[68:71], v[36:39], a[16:19], v[68:71]
  ds_read_b128 v[28:31], v9 offset:8192
  v_mfma_f32_16x16x32_bf16 v[76:79], v[36:39], a[20:23], v[76:79]
  v_mfma_f32_16x16x32_bf16 v[84:87], v[36:39], a[24:27], v[84:87]
  v_mfma_f32_16x16x32_bf16 v[92:95], v[36:39], a[28:31], v[92:95]
  s_waitcnt lgkmcnt(5)
  v_mfma_f32_16x16x32_bf16 v[64:67], v[40:43], a[32:35], v[64:67]
  s_add_u32 m0, s25, 2048
  ds_read_b128 v[32:35], v10 offset:8192
  v_mfma_f32_16x16x32_bf16 v[72:75], v[40:43], a[36:39], v[72:75]
  v_cvt_pk_bf16_f32 v132, v104, v105
  v_cvt_pk_bf16_f32 v133, v106, v107
  v_mfma_f32_16x16x32_bf16 v[80:83], v[40:43], a[40:43], v[80:83]
  buffer_load_dwordx4 v18, s[12:15], s19 offen lds
  v_mfma_f32_16x16x32_bf16 v[88:91], v[40:43], a[44:47], v[88:91]
  s_waitcnt lgkmcnt(5)
  v_cvt_pk_bf16_f32 v134, v108, v109
  v_cvt_pk_bf16_f32 v135, v110, v111
  v_mfma_f32_16x16x32_bf16 v[68:71], v[44:47], a[32:35], v[68:71]
  ds_read_b128 v[36:39], v11 offset:8192
  v_mfma_f32_16x16x32_bf16 v[76:79], v[44:47], a[36:39], v[76:79]
  v_mfma_f32_16x16x32_bf16 v[84:87], v[44:47], a[40:43], v[84:87]
  v_mfma_f32_16x16x32_bf16 v[92:95], v[44:47], a[44:47], v[92:95]
  s_waitcnt lgkmcnt(5)
  v_mfma_f32_16x16x32_bf16 v[64:67], v[48:51], a[48:51], v[64:67]
  s_add_u32 m0, s25, 3072
  ds_read_b128 v[40:43], v12 offset:8192
  v_mfma_f32_16x16x32_bf16 v[72:75], v[48:51], a[52:55], v[72:75]
  v_mfma_f32_16x16x32_bf16 v[80:83], v[48:51], a[56:59], v[80:83]
  buffer_load_dwordx4 v19, s[12:15], s19 offen lds
  v_mfma_f32_16x16x32_bf16 v[88:91], v[48:51], a[60:63], v[88:91]
  s_waitcnt lgkmcnt(5)
  v_mfma_f32_16x16x32_bf16 v[68:71], v[52:55], a[48:51], v[68:71]
  ds_read_b128 v[44:47], v13 offset:8192
  v_mfma_f32_16x16x32_bf16 v[76:79], v[52:55], a[52:55], v[76:79]
  v_cvt_pk_bf16_f32 v136, v112, v113
  v_cvt_pk_bf16_f32 v137, v114, v115
  v_mfma_f32_16x16x32_bf16 v[84:87], v[52:55], a[56:59], v[84:87]
  v_mfma_f32_16x16x32_bf16 v[92:95], v[52:55], a[60:63], v[92:95]
  s_waitcnt lgkmcnt(5)
  v_cvt_pk_bf16_f32 v138, v116, v117
  v_cvt_pk_bf16_f32 v139, v118, v119
  v_mfma_f32_16x16x32_bf16 v[64:67], v[24:27], a[64:67], v[64:67]
  s_add_u32 m0, s25, 4096
  ds_read_b128 v[48:51], v14 offset:8192
  v_mfma_f32_16x16x32_bf16 v[72:75], v[24:27], a[68:71], v[72:75]
  v_mfma_f32_16x16x32_bf16 v[80:83], v[24:27], a[72:75], v[80:83]
  buffer_load_dwordx4 v20, s[12:15], s19 offen lds
  v_mfma_f32_16x16x32_bf16 v[88:91], v[24:27], a[76:79], v[88:91]
  s_waitcnt lgkmcnt(5)
  v_mfma_f32_16x16x32_bf16 v[68:71], v[28:31], a[64:67], v[68:71]
  ds_read_b128 v[52:55], v15 offset:8192
  v_mfma_f32_16x16x32_bf16 v[76:79], v[28:31], a[68:71], v[76:79]
  v_mfma_f32_16x16x32_bf16 v[84:87], v[28:31], a[72:75], v[84:87]
  v_mfma_f32_16x16x32_bf16 v[92:95], v[28:31], a[76:79], v[92:95]
  s_waitcnt lgkmcnt(5)
  v_mfma_f32_16x16x32_bf16 v[64:67], v[32:35], a[80:83], v[64:67]
  s_add_u32 m0, s25, 5120
  ds_read_b128 v[24:27], v8 offset:16384
  v_mfma_f32_16x16x32_bf16 v[72:75], v[32:35], a[84:87], v[72:75]
  v_cvt_pk_bf16_f32 v140, v120, v121
  v_cvt_pk_bf16_f32 v141, v122, v123
  v_mfma_f32_16x16x32_bf16 v[80:83], v[32:35], a[88:91], v[80:83]
  buffer_load_dwordx4 v21, s[12:15], s19 offen lds
  v_mfma_f32_16x16x32_bf16 v[88:91], v[32:35], a[92:95], v[88:91]
  s_waitcnt lgkmcnt(5)
  v_cvt_pk_bf16_f32 v142, v124, v125
  v_cvt_pk_bf16_f32 v143, v126, v127
  v_mfma_f32_16x16x32_bf16 v[68:71], v[36:39], a[80:83], v[68:71]
  ds_read_b128 v[28:31], v9 offset:16384
  v_mfma_f32_16x16x32_bf16 v[76:79], v[36:39], a[84:87], v[76:79]
  v_mfma_f32_16x16x32_bf16 v[84:87], v[36:39], a[88:91], v[84:87]
  v_mfma_f32_16x16x32_bf16 v[92:95], v[36:39], a[92:95], v[92:95]
  s_waitcnt lgkmcnt(5)
  v_mfma_f32_16x16x32_bf16 v[64:67], v[40:43], a[96:99], v[64:67]
  s_add_u32 m0, s25, 6144
  ds_read_b128 v[32:35], v10 offset:16384
  v_mfma_f32_16x16x32_bf16 v[72:75], v[40:43], a[100:103], v[72:75]
  v_mfma_f32_16x16x32_bf16 v[80:83], v[40:43], a[104:107], v[80:83]
  buffer_load_dwordx4 v22, s[12:15], s19 offen lds
  v_mfma_f32_16x16x32_bf16 v[88:91], v[40:43], a[108:111], v[88:91]
  s_waitcnt lgkmcnt(5)
  v_mfma_f32_16x16x32_bf16 v[68:71], v[44:47], a[96:99], v[68:71]
  ds_read_b128 v[36:39], v11 offset:16384
  v_mfma_f32_16x16x32_bf16 v[76:79], v[44:47], a[100:103], v[76:79]
  v_mfma_f32_16x16x32_bf16 v[84:87], v[44:47], a[104:107], v[84:87]
  v_mfma_f32_16x16x32_bf16 v[92:95], v[44:47], a[108:111], v[92:95]
  s_waitcnt lgkmcnt(5)
  v_mfma_f32_16x16x32_bf16 v[64:67], v[48:51], a[112:115], v[64:67]
  s_add_u32 m0, s25, 7168
  ds_read_b128 v[40:43], v12 offset:16384
  v_mfma_f32_16x16x32_bf16 v[72:75], v[48:51], a[116:119], v[72:75]
  v_mfma_f32_16x16x32_bf16 v[80:83], v[48:51], a[120:123], v[80:83]
  buffer_load_dwordx4 v23, s[12:15], s19 offen lds
  v_mfma_f32_16x16x32_bf16 v[88:91], v[48:51], a[124:127], v[88:91]
  s_waitcnt lgkmcnt(5)
  v_mfma_f32_16x16x32_bf16 v[68:71], v[52:55], a[112:115], v[68:71]
  s_cmp_gt_u32 s23, 3
  ds_read_b128 v[44:47], v13 offset:16384
  v_mfma_f32_16x16x32_bf16 v[76:79], v[52:55], a[116:119], v[76:79]
  v_mfma_f32_16x16x32_bf16 v[84:87], v[52:55], a[120:123], v[84:87]
  s_cselect_b32 s26, s20, 0
  v_mfma_f32_16x16x32_bf16 v[92:95], v[52:55], a[124:127], v[92:95]
  s_waitcnt lgkmcnt(5)
  v_mfma_f32_16x16x32_bf16 v[64:67], v[24:27], a[128:131], v[64:67]
  s_add_u32 s19, s19, s26
  ds_read_b128 v[48:51], v14 offset:16384
  v_mfma_f32_16x16x32_bf16 v[72:75], v[24:27], a[132:135], v[72:75]
  v_mfma_f32_16x16x32_bf16 v[80:83], v[24:27], a[136:139], v[80:83]
  s_add_u32 s25, s25, 32768
  v_mfma_f32_16x16x32_bf16 v[88:91], v[24:27], a[140:143], v[88:91]
  s_waitcnt lgkmcnt(5)
  v_mfma_f32_16x16x32_bf16 v[68:71], v[28:31], a[128:131], v[68:71]
  s_and_b32 s25, s25, 0x1ffff
  ds_read_b128 v[52:55], v15 offset:16384
  v_mfma_f32_16x16x32_bf16 v[76:79], v[28:31], a[132:135], v[76:79]
  v_mfma_f32_16x16x32_bf16 v[84:87], v[28:31], a[136:139], v[84:87]
  buffer_store_dwordx4 v[128:131], v7, s[4:7], s21 offen offset:0 sc1
  v_mfma_f32_16x16x32_bf16 v[92:95], v[28:31], a[140:143], v[92:95]
  s_waitcnt lgkmcnt(5)
  v_mfma_f32_16x16x32_bf16 v[64:67], v[32:35], a[144:147], v[64:67]
  ds_read_b128 v[24:27], v8 offset:24576
  v_mfma_f32_16x16x32_bf16 v[72:75], v[32:35], a[148:151], v[72:75]
  v_mfma_f32_16x16x32_bf16 v[80:83], v[32:35], a[152:155], v[80:83]
  v_mfma_f32_16x16x32_bf16 v[88:91], v[32:35], a[156:159], v[88:91]
  s_waitcnt lgkmcnt(5)
  v_mfma_f32_16x16x32_bf16 v[68:71], v[36:39], a[144:147], v[68:71]
  ds_read_b128 v[28:31], v9 offset:24576
  v_mfma_f32_16x16x32_bf16 v[76:79], v[36:39], a[148:151], v[76:79]
  v_mfma_f32_16x16x32_bf16 v[84:87], v[36:39], a[152:155], v[84:87]
  buffer_store_dwordx4 v[132:135], v7, s[4:7], s21 offen offset:256 sc1
  v_mfma_f32_16x16x32_bf16 v[92:95], v[36:39], a[156:159], v[92:95]
  s_waitcnt lgkmcnt(5)
  v_mfma_f32_16x16x32_bf16 v[64:67], v[40:43], a[160:163], v[64:67]
  ds_read_b128 v[32:35], v10 offset:24576
  v_mfma_f32_16x16x32_bf16 v[72:75], v[40:43], a[164:167], v[72:75]
  v_mfma_f32_16x16x32_bf16 v[80:83], v[40:43], a[168:171], v[80:83]
  v_mfma_f32_16x16x32_bf16 v[88:91], v[40:43], a[172:175], v[88:91]
  s_waitcnt lgkmcnt(5)
  v_mfma_f32_16x16x32_bf16 v[68:71], v[44:47], a[160:163], v[68:71]
  ds_read_b128 v[36:39], v11 offset:24576
  v_mfma_f32_16x16x32_bf16 v[76:79], v[44:47], a[164:167], v[76:79]
  v_mfma_f32_16x16x32_bf16 v[84:87], v[44:47], a[168:171], v[84:87]
  buffer_store_dwordx4 v[136:139], v7, s[4:7], s21 offen offset:2048 sc1
  v_mfma_f32_16x16x32_bf16 v[92:95], v[44:47], a[172:175], v[92:95]
  s_waitcnt lgkmcnt(5)
  v_mfma_f32_16x16x32_bf16 v[64:67], v[48:51], a[176:179], v[64:67]
  ds_read_b128 v[40:43], v12 offset:24576
  v_mfma_f32_16x16x32_bf16 v[72:75], v[48:51], a[180:183], v[72:75]
  v_mfma_f32_16x16x32_bf16 v[80:83], v[48:51], a[184:187], v[80:83]
  v_mfma_f32_16x16x32_bf16 v[88:91], v[48:51], a[188:191], v[88:91]
  s_waitcnt lgkmcnt(5)
  v_mfma_f32_16x16x32_bf16 v[68:71], v[52:55], a[176:179], v[68:71]
  ds_read_b128 v[44:47], v13 offset:24576
  v_mfma_f32_16x16x32_bf16 v[76:79], v[52:55], a[180:183], v[76:79]
  v_mfma_f32_16x16x32_bf16 v[84:87], v[52:55], a[184:187], v[84:87]
  buffer_store_dwordx4 v[140:143], v7, s[4:7], s21 offen offset:2304 sc1
  v_mfma_f32_16x16x32_bf16 v[92:95], v[52:55], a[188:191], v[92:95]
  s_waitcnt lgkmcnt(5)
  v_mfma_f32_16x16x32_bf16 v[64:67], v[24:27], a[192:195], v[64:67]
  s_mov_b32 s21, s27
  ds_read_b128 v[48:51], v14 offset:24576
  v_mfma_f32_16x16x32_bf16 v[72:75], v[24:27], a[196:199], v[72:75]
  v_mov_b32 v7, v56
  v_mfma_f32_16x16x32_bf16 v[80:83], v[24:27], a[200:203], v[80:83]
  v_mfma_f32_16x16x32_bf16 v[88:91], v[24:27], a[204:207], v[88:91]
  s_waitcnt lgkmcnt(5)
  v_mfma_f32_16x16x32_bf16 v[68:71], v[28:31], a[192:195], v[68:71]
  s_add_u32 s27, s27, s22
  ds_read_b128 v[52:55], v15 offset:24576
  v_mfma_f32_16x16x32_bf16 v[76:79], v[28:31], a[196:199], v[76:79]
  v_mfma_f32_16x16x32_bf16 v[84:87], v[28:31], a[200:203], v[84:87]
  s_waitcnt vmcnt(13)
  s_barrier
  v_mfma_f32_16x16x32_bf16 v[92:95], v[28:31], a[204:207], v[92:95]
  s_waitcnt lgkmcnt(5)
  v_mfma_f32_16x16x32_bf16 v[64:67], v[32:35], a[208:211], v[64:67]
  ds_read_b128 v[24:27], v8 offset:32768
  v_mfma_f32_16x16x32_bf16 v[72:75], v[32:35], a[212:215], v[72:75]
  v_mfma_f32_16x16x32_bf16 v[80:83], v[32:35], a[216:219], v[80:83]
  v_mfma_f32_16x16x32_bf16 v[88:91], v[32:35], a[220:223], v[88:91]
  s_waitcnt lgkmcnt(5)
  v_mfma_f32_16x16x32_bf16 v[68:71], v[36:39], a[208:211], v[68:71]
  s_add_u32 s29, s29, 1
  ds_read_b128 v[28:31], v9 offset:32768
  v_mfma_f32_16x16x32_bf16 v[76:79], v[36:39], a[212:215], v[76:79]
  v_mfma_f32_16x16x32_bf16 v[84:87], v[36:39], a[216:219], v[84:87]
  s_max_i32 s30, s29, 0
  v_mfma_f32_16x16x32_bf16 v[92:95], v[36:39], a[220:223], v[92:95]
  s_waitcnt lgkmcnt(5)
  v_mov_b32 v144, s30
  v_mfma_f32_16x16x32_bf16 v[64:67], v[40:43], a[224:227], v[64:67]
  ds_read_b128 v[32:35], v10 offset:32768
  v_mfma_f32_16x16x32_bf16 v[72:75], v[40:43], a[228:231], v[72:75]
  v_mfma_f32_16x16x32_bf16 v[80:83], v[40:43], a[232:235], v[80:83]
  buffer_store_dword v144, v145, s[4:7], s31 offen sc1
  v_mfma_f32_16x16x32_bf16 v[88:91], v[40:43], a[236:239], v[88:91]
  s_waitcnt lgkmcnt(5)
  v_mfma_f32_16x16x32_bf16 v[68:71], v[44:47], a[224:227], v[68:71]
  ds_read_b128 v[36:39], v11 offset:32768
  v_mfma_f32_16x16x32_bf16 v[76:79], v[44:47], a[228:231], v[76:79]
  v_mfma_f32_16x16x32_bf16 v[84:87], v[44:47], a[232:235], v[84:87]
  v_mfma_f32_16x16x32_bf16 v[92:95], v[44:47], a[236:239], v[92:95]
  s_waitcnt lgkmcnt(5)
  v_mfma_f32_16x16x32_bf16 v[64:67], v[48:51], a[240:243], v[64:67]
  s_sub_u32 s23, s23, 1
  ds_read_b128 v[40:43], v12 offset:32768
  v_mfma_f32_16x16x32_bf16 v[72:75], v[48:51], a[244:247], v[72:75]
  v_mfma_f32_16x16x32_bf16 v[80:83], v[48:51], a[248:251], v[80:83]
  v_mfma_f32_16x16x32_bf16 v[88:91], v[48:51], a[252:255], v[88:91]
  s_waitcnt lgkmcnt(5)
  v_mfma_f32_16x16x32_bf16 v[68:71], v[52:55], a[240:243], v[68:71]
  s_cmp_eq_u32 s23, 0
  ds_read_b128 v[44:47], v13 offset:32768
  v_mfma_f32_16x16x32_bf16 v[76:79], v[52:55], a[244:247], v[76:79]
  v_mfma_f32_16x16x32_bf16 v[84:87], v[52:55], a[248:251], v[84:87]
  v_mfma_f32_16x16x32_bf16 v[92:95], v[52:55], a[252:255], v[92:95]
  s_cbranch_scc1 G_done0_142
  s_waitcnt lgkmcnt(5)
  v_mfma_f32_16x16x32_bf16 v[96:99], v[24:27], a[0:3], 0
  s_add_u32 m0, s25, 0
  ds_read_b128 v[48:51], v14 offset:32768
  v_mfma_f32_16x16x32_bf16 v[104:107], v[24:27], a[4:7], 0
  v_mfma_f32_16x16x32_bf16 v[112:115], v[24:27], a[8:11], 0
  buffer_load_dwordx4 v16, s[12:15], s19 offen lds
  v_mfma_f32_16x16x32_bf16 v[120:123], v[24:27], a[12:15], 0
  s_waitcnt lgkmcnt(5)
  v_mfma_f32_16x16x32_bf16 v[100:103], v[28:31], a[0:3], 0
  ds_read_b128 v[52:55], v15 offset:32768
  v_mfma_f32_16x16x32_bf16 v[108:111], v[28:31], a[4:7], 0
  v_cvt_pk_bf16_f32 v128, v64, v65
  v_cvt_pk_bf16_f32 v129, v66, v67
  v_mfma_f32_16x16x32_bf16 v[116:119], v[28:31], a[8:11], 0
  v_mfma_f32_16x16x32_bf16 v[124:127], v[28:31], a[12:15], 0
  s_waitcnt lgkmcnt(5)
  v_cvt_pk_bf16_f32 v130, v68, v69
  v_cvt_pk_bf16_f32 v131, v70, v71
  v_mfma_f32_16x16x32_bf16 v[96:99], v[32:35], a[16:19], v[96:99]
  s_add_u32 m0, s25, 1024
  ds_read_b128 v[24:27], v8 offset:40960
  v_mfma_f32_16x16x32_bf16 v[104:107], v[32:35], a[20:23], v[104:107]
  v_mfma_f32_16x16x32_bf16 v[112:115], v[32:35], a[24:27], v[112:115]
  buffer_load_dwordx4 v17, s[12:15], s19 offen lds
  v_mfma_f32_16x16x32_bf16 v[120:123], v[32:35], a[28:31], v[120:123]
  s_waitcnt lgkmcnt(5)
  v_mfma_f32_16x16x32_bf16 v[100:103], v[36:39], a[16:19], v[100:103]
  ds_read_b128 v[28:31], v9 offset:40960
  v_mfma_f32_16x16x32_bf16 v[108:111], v[36:39], a[20:23], v[108:111]
  v_mfma_f32_16x16x32_bf16 v[116:119], v[36:39], a[24:27], v[116:119]
  v_mfma_f32_16x16x32_bf16 v[124:127], v[36:39], a[28:31], v[124:127]
  s_waitcnt lgkmcnt(5)
  v_mfma_f32_16x16x32_bf16 v[96:99], v[40:43], a[32:35], v[96:99]
  s_add_u32 m0, s25, 2048
  ds_read_b128 v[32:35], v10 offset:40960
  v_mfma_f32_16x16x32_bf16 v[104:107], v[40:43], a[36:39], v[104:107]
  v_cvt_pk_bf16_f32 v132, v72, v73
  v_cvt_pk_bf16_f32 v133, v74, v75
  v_mfma_f32_16x16x32_bf16 v[112:115], v[40:43], a[40:43], v[112:115]
  buffer_load_dwordx4 v18, s[12:15], s19 offen lds
  v_mfma_f32_16x16x32_bf16 v[120:123], v[40:43], a[44:47], v[120:123]
  s_waitcnt lgkmcnt(5)
  v_cvt_pk_bf16_f32 v134, v76, v77
  v_cvt_pk_bf16_f32 v135, v78, v79
  v_mfma_f32_16x16x32_bf16 v[100:103], v[44:47], a[32:35], v[100:103]
  ds_read_b128 v[36:39], v11 offset:40960
  v_mfma_f32_16x16x32_bf16 v[108:111], v[44:47], a[36:39], v[108:111]
  v_mfma_f32_16x16x32_bf16 v[116:119], v[44:47], a[40:43], v[116:119]
  v_mfma_f32_16x16x32_bf16 v[124:127], v[44:47], a[44:47], v[124:127]
  s_waitcnt lgkmcnt(5)
  v_mfma_f32_16x16x32_bf16 v[96:99], v[48:51], a[48:51], v[96:99]
  s_add_u32 m0, s25, 3072
  ds_read_b128 v[40:43], v12 offset:40960
  v_mfma_f32_16x16x32_bf16 v[104:107], v[48:51], a[52:55], v[104:107]
  v_mfma_f32_16x16x32_bf16 v[112:115], v[48:51], a[56:59], v[112:115]
  buffer_load_dwordx4 v19, s[12:15], s19 offen lds
  v_mfma_f32_16x16x32_bf16 v[120:123], v[48:51], a[60:63], v[120:123]
  s_waitcnt lgkmcnt(5)
  v_mfma_f32_16x16x32_bf16 v[100:103], v[52:55], a[48:51], v[100:103]
  ds_read_b128 v[44:47], v13 offset:40960
  v_mfma_f32_16x16x32_bf16 v[108:111], v[52:55], a[52:55], v[108:111]
  v_cvt_pk_bf16_f32 v136, v80, v81
  v_cvt_pk_bf16_f32 v137, v82, v83
  v_mfma_f32_16x16x32_bf16 v[116:119], v[52:55], a[56:59], v[116:119]
  v_mfma_f32_16x16x32_bf16 v[124:127], v[52:55], a[60:63], v[124:127]
  s_waitcnt lgkmcnt(5)
  v_cvt_pk_bf16_f32 v138, v84, v85
  v_cvt_pk_bf16_f32 v139, v86, v87
  v_mfma_f32_16x16x32_bf16 v[96:99], v[24:27], a[64:67], v[96:99]
  s_add_u32 m0, s25, 4096
  ds_read_b128 v[48:51], v14 offset:40960
  v_mfma_f32_16x16x32_bf16 v[104:107], v[24:27], a[68:71], v[104:107]
  v_mfma_f32_16x16x32_bf16 v[112:115], v[24:27], a[72:75], v[112:115]
  buffer_load_dwordx4 v20, s[12:15], s19 offen lds
  v_mfma_f32_16x16x32_bf16 v[120:123], v[24:27], a[76:79], v[120:123]
  s_waitcnt lgkmcnt(5)
  v_mfma_f32_16x16x32_bf16 v[100:103], v[28:31], a[64:67], v[100:103]
  ds_read_b128 v[52:55], v15 offset:40960
  v_mfma_f32_16x16x32_bf16 v[108:111], v[28:31], a[68:71], v[108:111]
  v_mfma_f32_16x16x32_bf16 v[116:119], v[28:31], a[72:75], v[116:119]
  v_mfma_f32_16x16x32_bf16 v[124:127], v[28:31], a[76:79], v[124:127]
  s_waitcnt lgkmcnt(5)
  v_mfma_f32_16x16x32_bf16 v[96:99], v[32:35], a[80:83], v[96:99]
  s_add_u32 m0, s25, 5120
  ds_read_b128 v[24:27], v8 offset:49152
  v_mfma_f32_16x16x32_bf16 v[104:107], v[32:35], a[84:87], v[104:107]
  v_cvt_pk_bf16_f32 v140, v88, v89
  v_cvt_pk_bf16_f32 v141, v90, v91
  v_mfma_f32_16x16x32_bf16 v[112:115], v[32:35], a[88:91], v[112:115]
  buffer_load_dwordx4 v21, s[12:15], s19 offen lds
  v_mfma_f32_16x16x32_bf16 v[120:123], v[32:35], a[92:95], v[120:123]
  s_waitcnt lgkmcnt(5)
  v_cvt_pk_bf16_f32 v142, v92, v93
  v_cvt_pk_bf16_f32 v143, v94, v95
  v_mfma_f32_16x16x32_bf16 v[100:103], v[36:39], a[80:83], v[100:103]
  ds_read_b128 v[28:31], v9 offset:49152
  v_mfma_f32_16x16x32_bf16 v[108:111], v[36:39], a[84:87], v[108:111]
  v_mfma_f32_16x16x32_bf16 v[116:119], v[36:39], a[88:91], v[116:119]
  v_mfma_f32_16x16x32_bf16 v[124:127], v[36:39], a[92:95], v[124:127]
  s_waitcnt lgkmcnt(5)
  v_mfma_f32_16x16x32_bf16 v[96:99], v[40:43], a[96:99], v[96:99]
  s_add_u32 m0, s25, 6144
  ds_read_b128 v[32:35], v10 offset:49152
  v_mfma_f32_16x16x32_bf16 v[104:107], v[40:43], a[100:103], v[104:107]
  v_mfma_f32_16x16x32_bf16 v[112:115], v[40:43], a[104:107], v[112:115]
  buffer_load_dwordx4 v22, s[12:15], s19 offen lds
  v_mfma_f32_16x16x32_bf16 v[120:123], v[40:43], a[108:111], v[120:123]
  s_waitcnt lgkmcnt(5)
  v_mfma_f32_16x16x32_bf16 v[100:103], v[44:47], a[96:99], v[100:103]
  ds_read_b128 v[36:39], v11 offset:49152
  v_mfma_f32_16x16x32_bf16 v[108:111], v[44:47], a[100:103], v[108:111]
  v_mfma_f32_16x16x32_bf16 v[116:119], v[44:47], a[104:107], v[116:119]
  v_mfma_f32_16x16x32_bf16 v[124:127], v[44:47], a[108:111], v[124:127]
  s_waitcnt lgkmcnt(5)
  v_mfma_f32_16x16x32_bf16 v[96:99], v[48:51], a[112:115], v[96:99]
  s_add_u32 m0, s25, 7168
  ds_read_b128 v[40:43], v12 offset:49152
  v_mfma_f32_16x16x32_bf16 v[104:107], v[48:51], a[116:119], v[104:107]
  v_mfma_f32_16x16x32_bf16 v[112:115], v[48:51], a[120:123], v[112:115]
  buffer_load_dwordx4 v23, s[12:15], s19 offen lds
  v_mfma_f32_16x16x32_bf16 v[120:123], v[48:51], a[124:127], v[120:123]
  s_waitcnt lgkmcnt(5)
  v_mfma_f32_16x16x32_bf16 v[100:103], v[52:55], a[112:115], v[100:103]
  s_cmp_gt_u32 s23, 3
  ds_read_b128 v[44:47], v13 offset:49152
  v_mfma_f32_16x16x32_bf16 v[108:111], v[52:55], a[116:119], v[108:111]
  v_mfma_f32_16x16x32_bf16 v[116:119], v[52:55], a[120:123], v[116:119]
  s_cselect_b32 s26, s20, 0
  v_mfma_f32_16x16x32_bf16 v[124:127], v[52:55], a[124:127], v[124:127]
  s_waitcnt lgkmcnt(5)
  v_mfma_f32_16x16x32_bf16 v[96:99], v[24:27], a[128:131], v[96:99]
  s_add_u32 s19, s19, s26
  ds_read_b128 v[48:51], v14 offset:49152
  v_mfma_f32_16x16x32_bf16 v[104:107], v[24:27], a[132:135], v[104:107]
  v_mfma_f32_16x16x32_bf16 v[112:115], v[24:27], a[136:139], v[112:115]
  s_add_u32 s25, s25, 32768
  v_mfma_f32_16x16x32_bf16 v[120:123], v[24:27], a[140:143], v[120:123]
  s_waitcnt lgkmcnt(5)
  v_mfma_f32_16x16x32_bf16 v[100:103], v[28:31], a[128:131], v[100:103]
  s_and_b32 s25, s25, 0x1ffff
  ds_read_b128 v[52:55], v15 offset:49152
  v_mfma_f32_16x16x32_bf16 v[108:111], v[28:31], a[132:135], v[108:111]
  v_mfma_f32_16x16x32_bf16 v[116:119], v[28:31], a[136:139], v[116:119]
  buffer_store_dwordx4 v[128:131], v7, s[4:7], s21 offen offset:0 sc1
  v_mfma_f32_16x16x32_bf16 v[124:127], v[28:31], a[140:143], v[124:127]
  s_waitcnt lgkmcnt(5)
  v_mfma_f32_16x16x32_bf16 v[96:99], v[32:35], a[144:147], v[96:99]
  ds_read_b128 v[24:27], v8 offset:57344
  v_mfma_f32_16x16x32_bf16 v[104:107], v[32:35], a[148:151], v[104:107]
  v_mfma_f32_16x16x32_bf16 v[112:115], v[32:35], a[152:155], v[112:115]
  v_mfma_f32_16x16x32_bf16 v[120:123], v[32:35], a[156:159], v[120:123]
  s_waitcnt lgkmcnt(5)
  v_xor_b32 v8, 0x10000, v8
  v_mfma_f32_16x16x32_bf16 v[100:103], v[36:39], a[144:147], v[100:103]
  ds_read_b128 v[28:31], v9 offset:57344
  v_mfma_f32_16x16x32_bf16 v[108:111], v[36:39], a[148:151], v[108:111]
  v_mfma_f32_16x16x32_bf16 v[116:119], v[36:39], a[152:155], v[116:119]
  buffer_store_dwordx4 v[132:135], v7, s[4:7], s21 offen offset:256 sc1
  v_mfma_f32_16x16x32_bf16 v[124:127], v[36:39], a[156:159], v[124:127]
  s_waitcnt lgkmcnt(5)
  v_xor_b32 v9, 0x10000, v9
  v_mfma_f32_16x16x32_bf16 v[96:99], v[40:43], a[160:163], v[96:99]
  ds_read_b128 v[32:35], v10 offset:57344
  v_mfma_f32_16x16x32_bf16 v[104:107], v[40:43], a[164:167], v[104:107]
  v_mfma_f32_16x16x32_bf16 v[112:115], v[40:43], a[168:171], v[112:115]
  v_mfma_f32_16x16x32_bf16 v[120:123], v[40:43], a[172:175], v[120:123]
  s_waitcnt lgkmcnt(5)
  v_xor_b32 v10, 0x10000, v10
  v_mfma_f32_16x16x32_bf16 v[100:103], v[44:47], a[160:163], v[100:103]
  ds_read_b128 v[36:39], v11 offset:57344
  v_mfma_f32_16x16x32_bf16 v[108:111], v[44:47], a[164:167], v[108:111]
  v_mfma_f32_16x16x32_bf16 v[116:119], v[44:47], a[168:171], v[116:119]
  buffer_store_dwordx4 v[136:139], v7, s[4:7], s21 offen offset:2048 sc1
  v_mfma_f32_16x16x32_bf16 v[124:127], v[44:47], a[172:175], v[124:127]
  s_waitcnt lgkmcnt(5)
  v_xor_b32 v11, 0x10000, v11
  v_mfma_f32_16x16x32_bf16 v[96:99], v[48:51], a[176:179], v[96:99]
  ds_read_b128 v[40:43], v12 offset:57344
  v_mfma_f32_16x16x32_bf16 v[104:107], v[48:51], a[180:183], v[104:107]
  v_mfma_f32_16x16x32_bf16 v[112:115], v[48:51], a[184:187], v[112:115]
  v_mfma_f32_16x16x32_bf16 v[120:123], v[48:51], a[188:191], v[120:123]
  s_waitcnt lgkmcnt(5)
  v_xor_b32 v12, 0x10000, v12
  v_mfma_f32_16x16x32_bf16 v[100:103], v[52:55], a[176:179], v[100:103]
  ds_read_b128 v[44:47], v13 offset:57344
  v_mfma_f32_16x16x32_bf16 v[108:111], v[52:55], a[180:183], v[108:111]
  v_mfma_f32_16x16x32_bf16 v[116:119], v[52:55], a[184:187], v[116:119]
  buffer_store_dwordx4 v[140:143], v7, s[4:7], s21 offen offset:2304 sc1
  v_mfma_f32_16x16x32_bf16 v[124:127], v[52:55], a[188:191], v[124:127]
  s_waitcnt lgkmcnt(5)
  v_xor_b32 v13, 0x10000, v13
  v_mfma_f32_16x16x32_bf16 v[96:99], v[24:27], a[192:195], v[96:99]
  s_mov_b32 s21, s27
  ds_read_b128 v[48:51], v14 offset:57344
  v_mfma_f32_16x16x32_bf16 v[104:107], v[24:27], a[196:199], v[104:107]
  v_mov_b32 v7, v56
  v_mfma_f32_16x16x32_bf16 v[112:115], v[24:27], a[200:203], v[112:115]
  v_mfma_f32_16x16x32_bf16 v[120:123], v[24:27], a[204:207], v[120:123]
  s_waitcnt lgkmcnt(5)
  v_xor_b32 v14, 0x10000, v14
  v_mfma_f32_16x16x32_bf16 v[100:103], v[28:31], a[192:195], v[100:103]
  s_add_u32 s27, s27, s22
  ds_read_b128 v[52:55], v15 offset:57344
  v_mfma_f32_16x16x32_bf16 v[108:111], v[28:31], a[196:199], v[108:111]
  v_mfma_f32_16x16x32_bf16 v[116:119], v[28:31], a[200:203], v[116:119]
  s_waitcnt vmcnt(13)
  s_barrier
  v_mfma_f32_16x16x32_bf16 v[124:127], v[28:31], a[204:207], v[124:127]
  s_waitcnt lgkmcnt(5)
  v_xor_b32 v15, 0x10000, v15
  v_mfma_f32_16x16x32_bf16 v[96:99], v[32:35], a[208:211], v[96:99]
  ds_read_b128 v[24:27], v8 offset:0
  v_mfma_f32_16x16x32_bf16 v[104:107], v[32:35], a[212:215], v[104:107]
  v_mfma_f32_16x16x32_bf16 v[112:115], v[32:35], a[216:219], v[112:115]
  v_mfma_f32_16x16x32_bf16 v[120:123], v[32:35], a[220:223], v[120:123]
  s_waitcnt lgkmcnt(5)
  v_mfma_f32_16x16x32_bf16 v[100:103], v[36:39], a[208:211], v[100:103]
  s_add_u32 s29, s29, 1
  ds_read_b128 v[28:31], v9 offset:0
  v_mfma_f32_16x16x32_bf16 v[108:111], v[36:39], a[212:215], v[108:111]
  v_mfma_f32_16x16x32_bf16 v[116:119], v[36:39], a[216:219], v[116:119]
  s_max_i32 s30, s29, 0
  v_mfma_f32_16x16x32_bf16 v[124:127], v[36:39], a[220:223], v[124:127]
  s_waitcnt lgkmcnt(5)
  v_mov_b32 v144, s30
  v_mfma_f32_16x16x32_bf16 v[96:99], v[40:43], a[224:227], v[96:99]
  ds_read_b128 v[32:35], v10 offset:0
  v_mfma_f32_16x16x32_bf16 v[104:107], v[40:43], a[228:231], v[104:107]
  v_mfma_f32_16x16x32_bf16 v[112:115], v[40:43], a[232:235], v[112:115]
  buffer_store_dword v144, v145, s[4:7], s31 offen sc1
  v_mfma_f32_16x16x32_bf16 v[120:123], v[40:43], a[236:239], v[120:123]
  s_waitcnt lgkmcnt(5)
  v_mfma_f32_16x16x32_bf16 v[100:103], v[44:47], a[224:227], v[100:103]
  ds_read_b128 v[36:39], v11 offset:0
  v_mfma_f32_16x16x32_bf16 v[108:111], v[44:47], a[228:231], v[108:111]
  v_mfma_f32_16x16x32_bf16 v[116:119], v[44:47], a[232:235], v[116:119]
  v_mfma_f32_16x16x32_bf16 v[124:127], v[44:47], a[236:239], v[124:127]
  s_waitcnt lgkmcnt(5)
  v_mfma_f32_16x16x32_bf16 v[96:99], v[48:51], a[240:243], v[96:99]
  s_sub_u32 s23, s23, 1
  ds_read_b128 v[40:43], v12 offset:0
  v_mfma_f32_16x16x32_bf16 v[104:107], v[48:51], a[244:247], v[104:107]
  v_mfma_f32_16x16x32_bf16 v[112:115], v[48:51], a[248:251], v[112:115]
  v_mfma_f32_16x16x32_bf16 v[120:123], v[48:51], a[252:255], v[120:123]
  s_waitcnt lgkmcnt(5)
  v_mfma_f32_16x16x32_bf16 v[100:103], v[52:55], a[240:243], v[100:103]
  s_cmp_eq_u32 s23, 0
  ds_read_b128 v[44:47], v13 offset:0
  v_mfma_f32_16x16x32_bf16 v[108:111], v[52:55], a[244:247], v[108:111]
  v_mfma_f32_16x16x32_bf16 v[116:119], v[52:55], a[248:251], v[116:119]
  v_mfma_f32_16x16x32_bf16 v[124:127], v[52:55], a[252:255], v[124:127]
  s_cbranch_scc1 G_done1_143
  s_branch G_top_141
G_done0_142:
  s_nop 7
  s_nop 3
  v_cvt_pk_bf16_f32 v128, v64, v65
  v_cvt_pk_bf16_f32 v129, v66, v67
  v_cvt_pk_bf16_f32 v130, v68, v69
  v_cvt_pk_bf16_f32 v131, v70, v71
  buffer_store_dwordx4 v[128:131], v7, s[4:7], s21 offen offset:0 sc1
  v_cvt_pk_bf16_f32 v132, v72, v73
  v_cvt_pk_bf16_f32 v133, v74, v75
  v_cvt_pk_bf16_f32 v134, v76, v77
  v_cvt_pk_bf16_f32 v135, v78, v79
  buffer_store_dwordx4 v[132:135], v7, s[4:7], s21 offen offset:256 sc1
  v_cvt_pk_bf16_f32 v136, v80, v81
  v_cvt_pk_bf16_f32 v137, v82, v83
  v_cvt_pk_bf16_f32 v138, v84, v85
  v_cvt_pk_bf16_f32 v139, v86, v87
  buffer_store_dwordx4 v[136:139], v7, s[4:7], s21 offen offset:2048 sc1
  v_cvt_pk_bf16_f32 v140, v88, v89
  v_cvt_pk_bf16_f32 v141, v90, v91
  v_cvt_pk_bf16_f32 v142, v92, v93
  v_cvt_pk_bf16_f32 v143, v94, v95
  buffer_store_dwordx4 v[140:143], v7, s[4:7], s21 offen offset:2304 sc1
  s_branch G_fin_144
G_done1_143:
  s_nop 7
  s_nop 3
  v_cvt_pk_bf16_f32 v128, v96, v97
  v_cvt_pk_bf16_f32 v129, v98, v99
  v_cvt_pk_bf16_f32 v130, v100, v101
  v_cvt_pk_bf16_f32 v131, v102, v103
  buffer_store_dwordx4 v[128:131], v7, s[4:7], s21 offen offset:0 sc1
  v_cvt_pk_bf16_f32 v132, v104, v105
  v_cvt_pk_bf16_f32 v133, v106, v107
  v_cvt_pk_bf16_f32 v134, v108, v109
  v_cvt_pk_bf16_f32 v135, v110, v111
  buffer_store_dwordx4 v[132:135], v7, s[4:7], s21 offen offset:256 sc1
  v_cvt_pk_bf16_f32 v136, v112, v113
  v_cvt_pk_bf16_f32 v137, v114, v115
  v_cvt_pk_bf16_f32 v138, v116, v117
  v_cvt_pk_bf16_f32 v139, v118, v119
  buffer_store_dwordx4 v[136:139], v7, s[4:7], s21 offen offset:2048 sc1
  v_cvt_pk_bf16_f32 v140, v120, v121
  v_cvt_pk_bf16_f32 v141, v122, v123
  v_cvt_pk_bf16_f32 v142, v124, v125
  v_cvt_pk_bf16_f32 v143, v126, v127
  buffer_store_dwordx4 v[140:143], v7, s[4:7], s21 offen offset:2304 sc1
G_fin_144:
  s_waitcnt vmcnt(0) lgkmcnt(0)
  s_barrier
  s_add_u32 s30, s29, 2
  v_mov_b32 v144, s30
  v_min_u32 v145, 1, v0
  v_lshlrev_b32 v145, 30, v145
  buffer_store_dword v144, v145, s[4:7], s31 offen sc1
P_end_131:
  s_mov_b32 s71, 0
  s_branch M_sg_146
M_sw_145:
  s_sleep 8
  s_add_u32 s71, s71, 1
  s_cmp_gt_u32 s71, 262144
  s_cbranch_scc1 M_exit
M_sg_146:
  s_mov_b32 s79, 0
  s_atomic_or s79, s[74:75], 128 glc
  s_waitcnt lgkmcnt(0)
  s_cmp_lt_u32 s79, 256
  s_cbranch_scc1 M_sw_145
  s_cmp_eq_u32 s65, 6
  s_cbranch_scc1 M_follow
  s_mov_b32 s68, 0
  s_mov_b32 s36, -1
  s_mov_b32 s69, s53
  s_mov_b32 s70, s54
  s_load_dwordx2 s[8:9], s[0:1], 40
  s_mul_i32 s76, s64, 6
  s_add_u32 s76, s76, s65
  s_mul_i32 s76, s76, 21888
  v_min_u32 v200, 170, v0
  v_mul_u32_u24 v200, 128, v200
  v_add_u32 v200, s76, v200
  s_waitcnt lgkmcnt(0)
  s_and_b32 s9, s9, 0xffff
  s_mov_b32 s10, 4194304
  s_mov_b32 s11, 0x20000
M_att:
  s_mov_b32 s24, 0xf149f2ca
  s_mov_b32 s29, 0
  v_mov_b32 v6, 0
  v_mov_b32 v7, 0
  s_lshl_b32 s26, s16, 11
  v_add_u32 v3, s26, v2
  v_and_b32 v5, 31, v1
  v_lshrrev_b32 v12, 5, v1
  v_lshlrev_b32 v12, 2, v12
  v_sub_u32 v5, v5, v12
  s_lshl_b32 s26, s64, 19
  s_add_u32 s19, s26, 16777216
  s_add_u32 s20, s26, 33554432
  s_lshl_b32 s27, s69, 2
  s_add_u32 s27, s27, s16
  s_lshl_b32 s27, s27, 14
  s_add_u32 s25, s26, s27
  s_bfe_u32 s78, s70, 0x80000
  s_add_u32 s76, s67, 512
  s_mov_b32 s71, 0
  s_branch M_sg_148
M_sw_147:
  s_sleep 8
  s_add_u32 s71, s71, 1
  s_cmp_gt_u32 s71, 262144
  s_cbranch_scc1 M_exit
M_sg_148:
  s_mov_b32 s79, 0
  s_atomic_or s79, s[72:73], s76 glc
  s_waitcnt lgkmcnt(0)
  s_cmp_lt_u32 s79, s78
  s_cbranch_scc1 M_sw_147
  s_bfe_u32 s78, s70, 0x80008
  s_add_u32 s76, s67, 640
  s_mov_b32 s71, 0
  s_branch M_sg_150
M_sw_149:
  s_sleep 8
  s_add_u32 s71, s71, 1
  s_cmp_gt_u32 s71, 262144
  s_cbranch_scc1 M_exit
M_sg_150:
  s_mov_b32 s79, 0
  s_atomic_or s79, s[72:73], s76 glc
  s_waitcnt lgkmcnt(0)
  s_cmp_lt_u32 s79, s78
  s_cbranch_scc1 M_sw_149
  s_lshl_b32 s27, s69, 16
  s_add_u32 s27, s27, 16384
  s_add_u32 s17, s19, s27
M_kv_151:
  s_cmp_ge_u32 s17, s36
  s_cbranch_scc1 M_kvok_152
  s_mov_b32 s76, 0
  s_mov_b32 s78, 23
  s_mov_b32 s77, 335872
  s_cmp_eq_u32 s68, 1
  s_cmov_b32 s76, 128
  s_cmov_b32 s78, 27
  s_cmov_b32 s77, 114688
  s_cmp_eq_u32 s68, 2
  s_cmov_b32 s76, 768
  s_cmov_b32 s78, 14
  s_cmov_b32 s77, 0
  s_add_u32 s76, s76, s67
  s_mov_b32 s71, 0
  s_branch M_sg_154
M_sw_153:
  s_sleep 8
  s_add_u32 s71, s71, 1
  s_cmp_gt_u32 s71, 262144
  s_cbranch_scc1 M_exit
M_sg_154:
  s_mov_b32 s79, 0
  s_atomic_or s79, s[72:73], s76 glc
  s_waitcnt lgkmcnt(0)
  s_cmp_lt_u32 s79, s78
  s_cbranch_scc1 M_sw_153
  s_add_u32 s36, s77, s19
  s_add_u32 s68, s68, 1
  s_branch M_kv_151
M_kvok_152:
  s_add_u32 s28, s25, 0
  buffer_load_dwordx4 a[128:131], v2, s[4:7], s28 offen offset:0 sc1
  buffer_load_dwordx4 a[132:135], v2, s[4:7], s28 offen offset:1024 sc1
  buffer_load_dwordx4 a[136:139], v2, s[4:7], s28 offen offset:2048 sc1
  buffer_load_dwordx4 a[140:143], v2, s[4:7], s28 offen offset:3072 sc1
  s_add_u32 s28, s25, 4096
  buffer_load_dwordx4 a[144:147], v2, s[4:7], s28 offen offset:0 sc1
  buffer_load_dwordx4 a[148:151], v2, s[4:7], s28 offen offset:1024 sc1
  buffer_load_dwordx4 a[152:155], v2, s[4:7], s28 offen offset:2048 sc1
  buffer_load_dwordx4 a[156:159], v2, s[4:7], s28 offen offset:3072 sc1
  s_add_u32 s28, s25, 8192
  buffer_load_dwordx4 a[160:163], v2, s[4:7], s28 offen offset:0 sc1
  buffer_load_dwordx4 a[164:167], v2, s[4:7], s28 offen offset:1024 sc1
  buffer_load_dwordx4 a[168:171], v2, s[4:7], s28 offen offset:2048 sc1
  buffer_load_dwordx4 a[172:175], v2, s[4:7], s28 offen offset:3072 sc1
  s_add_u32 s28, s25, 12288
  buffer_load_dwordx4 a[176:179], v2, s[4:7], s28 offen offset:0 sc1
  buffer_load_dwordx4 a[180:183], v2, s[4:7], s28 offen offset:1024 sc1
  buffer_load_dwordx4 a[184:187], v2, s[4:7], s28 offen offset:2048 sc1
  buffer_load_dwordx4 a[188:191], v2, s[4:7], s28 offen offset:3072 sc1
A_again_155:
  s_lshl_b32 s27, s69, 16
  s_add_u32 s27, s27, 57344
  s_add_u32 s17, s19, s27
  s_add_u32 s18, s20, s27
  s_lshl_b32 s21, s16, 11
  s_mov_b32 m0, s21
  s_nop 0
  buffer_load_dwordx4 v3, s[4:7], s18 offen offset:0 sc1 lds
  buffer_load_dwordx4 v3, s[4:7], s18 offen offset:1024 sc1 lds
  s_add_u32 m0, s21, 8192
  s_nop 0
  buffer_load_dwordx4 v3, s[4:7], s17 offen offset:0 sc1 lds
  buffer_load_dwordx4 v3, s[4:7], s17 offen offset:1024 sc1 lds
  s_add_u32 s18, s18, 8192
  s_sub_u32 s18, s18, 8192
  s_max_i32 s18, s18, s20
  s_sub_u32 s17, s17, 8192
  s_max_i32 s17, s17, s19
  s_add_u32 s21, s21, 16384
  s_and_b32 s21, s21, 131071
  s_mov_b32 m0, s21
  s_nop 0
  buffer_load_dwordx4 v3, s[4:7], s18 offen offset:0 sc1 lds
  buffer_load_dwordx4 v3, s[4:7], s18 offen offset:1024 sc1 lds
  s_add_u32 m0, s21, 8192
  s_nop 0
  buffer_load_dwordx4 v3, s[4:7], s17 offen offset:0 sc1 lds
  buffer_load_dwordx4 v3, s[4:7], s17 offen offset:1024 sc1 lds
  s_sub_u32 s18, s18, 8192
  s_max_i32 s18, s18, s20
  s_sub_u32 s17, s17, 8192
  s_max_i32 s17, s17, s19
  s_add_u32 s21, s21, 16384
  s_and_b32 s21, s21, 131071
  s_mov_b32 m0, s21
  s_nop 0
  buffer_load_dwordx4 v3, s[4:7], s18 offen offset:0 sc1 lds
  buffer_load_dwordx4 v3, s[4:7], s18 offen offset:1024 sc1 lds
  s_add_u32 m0, s21, 8192
  s_nop 0
  buffer_load_dwordx4 v3, s[4:7], s17 offen offset:0 sc1 lds
  buffer_load_dwordx4 v3, s[4:7], s17 offen offset:1024 sc1 lds
  s_sub_u32 s18, s18, 8192
  s_max_i32 s18, s18, s20
  s_sub_u32 s17, s17, 8192
  s_max_i32 s17, s17, s19
  s_add_u32 s21, s21, 16384
  s_and_b32 s21, s21, 131071
  s_mov_b32 m0, s21
  s_nop 0
  buffer_load_dwordx4 v3, s[4:7], s18 offen offset:0 sc1 lds
  buffer_load_dwordx4 v3, s[4:7], s18 offen offset:1024 sc1 lds
  s_add_u32 m0, s21, 8192
  s_nop 0
  buffer_load_dwordx4 v3, s[4:7], s17 offen offset:0 sc1 lds
  buffer_load_dwordx4 v3, s[4:7], s17 offen offset:1024 sc1 lds
  s_sub_u32 s18, s18, 8192
  s_max_i32 s18, s18, s20
  s_sub_u32 s17, s17, 8192
  s_max_i32 s17, s17, s19
  s_add_u32 s21, s21, 16384
  s_and_b32 s21, s21, 131071
  s_mov_b32 m0, s21
  s_nop 0
  buffer_load_dwordx4 v3, s[4:7], s18 offen offset:0 sc1 lds
  buffer_load_dwordx4 v3, s[4:7], s18 offen offset:1024 sc1 lds
  s_add_u32 m0, s21, 8192
  s_nop 0
  buffer_load_dwordx4 v3, s[4:7], s17 offen offset:0 sc1 lds
  buffer_load_dwordx4 v3, s[4:7], s17 offen offset:1024 sc1 lds
  s_sub_u32 s18, s18, 8192
  s_max_i32 s18, s18, s20
  s_sub_u32 s17, s17, 8192
  s_max_i32 s17, s17, s19
  s_add_u32 s21, s21, 16384
  s_and_b32 s21, s21, 131071
  s_mov_b32 m0, s21
  s_nop 0
  buffer_load_dwordx4 v3, s[4:7], s18 offen offset:0 sc1 lds
  buffer_load_dwordx4 v3, s[4:7], s18 offen offset:1024 sc1 lds
  s_add_u32 m0, s21, 8192
  s_nop 0
  buffer_load_dwordx4 v3, s[4:7], s17 offen offset:0 sc1 lds
  buffer_load_dwordx4 v3, s[4:7], s17 offen offset:1024 sc1 lds
  v_accvgpr_write_b32 a0, 0
  v_accvgpr_write_b32 a1, 0
  v_accvgpr_write_b32 a2, 0
  v_accvgpr_write_b32 a3, 0
  v_accvgpr_write_b32 a4, 0
  v_accvgpr_write_b32 a5, 0
  v_accvgpr_write_b32 a6, 0
  v_accvgpr_write_b32 a7, 0
  v_accvgpr_write_b32 a8, 0
  v_accvgpr_write_b32 a9, 0
  v_accvgpr_write_b32 a10, 0
  v_accvgpr_write_b32 a11, 0
  v_accvgpr_write_b32 a12, 0
  v_accvgpr_write_b32 a13, 0
  v_accvgpr_write_b32 a14, 0
  v_accvgpr_write_b32 a15, 0
  v_accvgpr_write_b32 a16, 0
  v_accvgpr_write_b32 a17, 0
  v_accvgpr_write_b32 a18, 0
  v_accvgpr_write_b32 a19, 0
  v_accvgpr_write_b32 a20, 0
  v_accvgpr_write_b32 a21, 0
  v_accvgpr_write_b32 a22, 0
  v_accvgpr_write_b32 a23, 0
  v_accvgpr_write_b32 a24, 0
  v_accvgpr_write_b32 a25, 0
  v_accvgpr_write_b32 a26, 0
  v_accvgpr_write_b32 a27, 0
  v_accvgpr_write_b32 a28, 0
  v_accvgpr_write_b32 a29, 0
  v_accvgpr_write_b32 a30, 0
  v_accvgpr_write_b32 a31, 0
  v_accvgpr_write_b32 a32, 0
  v_accvgpr_write_b32 a33, 0
  v_accvgpr_write_b32 a34, 0
  v_accvgpr_write_b32 a35, 0
  v_accvgpr_write_b32 a36, 0
  v_accvgpr_write_b32 a37, 0
  v_accvgpr_write_b32 a38, 0
  v_accvgpr_write_b32 a39, 0
  v_accvgpr_write_b32 a40, 0
  v_accvgpr_write_b32 a41, 0
  v_accvgpr_write_b32 a42, 0
  v_accvgpr_write_b32 a43, 0
  v_accvgpr_write_b32 a44, 0
  v_accvgpr_write_b32 a45, 0
  v_accvgpr_write_b32 a46, 0
  v_accvgpr_write_b32 a47, 0
  v_accvgpr_write_b32 a48, 0
  v_accvgpr_write_b32 a49, 0
  v_accvgpr_write_b32 a50, 0
  v_accvgpr_write_b32 a51, 0
  v_accvgpr_write_b32 a52, 0
  v_accvgpr_write_b32 a53, 0
  v_accvgpr_write_b32 a54, 0
  v_accvgpr_write_b32 a55, 0
  v_accvgpr_write_b32 a56, 0
  v_accvgpr_write_b32 a57, 0
  v_accvgpr_write_b32 a58, 0
  v_accvgpr_write_b32 a59, 0
  v_accvgpr_write_b32 a60, 0
  v_accvgpr_write_b32 a61, 0
  v_accvgpr_write_b32 a62, 0
  v_accvgpr_write_b32 a63, 0
  v_accvgpr_write_b32 a64, 0
  v_accvgpr_write_b32 a65, 0
  v_accvgpr_write_b32 a66, 0
  v_accvgpr_write_b32 a67, 0
  v_accvgpr_write_b32 a68, 0
  v_accvgpr_write_b32 a69, 0
  v_accvgpr_write_b32 a70, 0
  v_accvgpr_write_b32 a71, 0
  v_accvgpr_write_b32 a72, 0
  v_accvgpr_write_b32 a73, 0
  v_accvgpr_write_b32 a74, 0
  v_accvgpr_write_b32 a75, 0
  v_accvgpr_write_b32 a76, 0
  v_accvgpr_write_b32 a77, 0
  v_accvgpr_write_b32 a78, 0
  v_accvgpr_write_b32 a79, 0
  v_accvgpr_write_b32 a80, 0
  v_accvgpr_write_b32 a81, 0
  v_accvgpr_write_b32 a82, 0
  v_accvgpr_write_b32 a83, 0
  v_accvgpr_write_b32 a84, 0
  v_accvgpr_write_b32 a85, 0
  v_accvgpr_write_b32 a86, 0
  v_accvgpr_write_b32 a87, 0
  v_accvgpr_write_b32 a88, 0
  v_accvgpr_write_b32 a89, 0
  v_accvgpr_write_b32 a90, 0
  v_accvgpr_write_b32 a91, 0
  v_accvgpr_write_b32 a92, 0
  v_accvgpr_write_b32 a93, 0
  v_accvgpr_write_b32 a94, 0
  v_accvgpr_write_b32 a95, 0
  v_accvgpr_write_b32 a96, 0
  v_accvgpr_write_b32 a97, 0
  v_accvgpr_write_b32 a98, 0
  v_accvgpr_write_b32 a99, 0
  v_accvgpr_write_b32 a100, 0
  v_accvgpr_write_b32 a101, 0
  v_accvgpr_write_b32 a102, 0
  v_accvgpr_write_b32 a103, 0
  v_accvgpr_write_b32 a104, 0
  v_accvgpr_write_b32 a105, 0
  v_accvgpr_write_b32 a106, 0
  v_accvgpr_write_b32 a107, 0
  v_accvgpr_write_b32 a108, 0
  v_accvgpr_write_b32 a109, 0
  v_accvgpr_write_b32 a110, 0
  v_accvgpr_write_b32 a111, 0
  v_accvgpr_write_b32 a112, 0
  v_accvgpr_write_b32 a113, 0
  v_accvgpr_write_b32 a114, 0
  v_accvgpr_write_b32 a115, 0
  v_accvgpr_write_b32 a116, 0
  v_accvgpr_write_b32 a117, 0
  v_accvgpr_write_b32 a118, 0
  v_accvgpr_write_b32 a119, 0
  v_accvgpr_write_b32 a120, 0
  v_accvgpr_write_b32 a121, 0
  v_accvgpr_write_b32 a122, 0
  v_accvgpr_write_b32 a123, 0
  v_accvgpr_write_b32 a124, 0
  v_accvgpr_write_b32 a125, 0
  v_accvgpr_write_b32 a126, 0
  v_accvgpr_write_b32 a127, 0
  v_mov_b32 v8, 0
  v_mov_b32 v9, 0
  v_mov_b32 v10, 0
  v_mov_b32 v11, 0
  v_mov_b32 v52, 0
  v_mov_b32 v53, 0
  v_mov_b32 v54, s24
  v_mov_b32 v55, s24
  v_mov_b32 v56, s24
  v_mov_b32 v57, s24
  v_mov_b32 v58, s24
  v_mov_b32 v59, s24
  v_mov_b32 v60, s24
  v_mov_b32 v61, s24
  v_mov_b32 v62, s24
  v_mov_b32 v63, s24
  v_mov_b32 v104, 0
  v_mov_b32 v105, 0
  v_mov_b32 v4, v2
  v_mov_b32 v64, s24
  v_mov_b32 v65, s24
  v_mov_b32 v66, s24
  v_mov_b32 v67, s24
  v_mov_b32 v68, s24
  v_mov_b32 v69, s24
  v_mov_b32 v70, s24
  v_mov_b32 v71, s24
  v_mov_b32 v72, s24
  v_mov_b32 v73, s24
  v_mov_b32 v74, s24
  v_mov_b32 v75, s24
  v_mov_b32 v76, s24
  v_mov_b32 v77, s24
  v_mov_b32 v78, s24
  v_mov_b32 v79, s24
  v_mov_b32 v12, s24
  v_cmp_le_i32 s[40:41], 0, v5
  v_cmp_le_i32 s[42:43], 1, v5
  v_cmp_le_i32 s[44:45], 2, v5
  v_cmp_le_i32 s[46:47], 3, v5
  v_cndmask_b32 v80, v12, v7, s[40:41]
  v_cndmask_b32 v81, v12, v7, s[42:43]
  v_cndmask_b32 v82, v12, v7, s[44:45]
  v_cndmask_b32 v83, v12, v7, s[46:47]
  v_cmp_le_i32 s[40:41], 8, v5
  v_cmp_le_i32 s[42:43], 9, v5
  v_cmp_le_i32 s[44:45], 10, v5
  v_cmp_le_i32 s[46:47], 11, v5
  v_cndmask_b32 v84, v12, v7, s[40:41]
  v_cndmask_b32 v85, v12, v7, s[42:43]
  v_cndmask_b32 v86, v12, v7, s[44:45]
  v_cndmask_b32 v87, v12, v7, s[46:47]
  v_cmp_le_i32 s[40:41], 16, v5
  v_cmp_le_i32 s[42:43], 17, v5
  v_cmp_le_i32 s[44:45], 18, v5
  v_cmp_le_i32 s[46:47], 19, v5
  v_cndmask_b32 v88, v12, v7, s[40:41]
  v_cndmask_b32 v89, v12, v7, s[42:43]
  v_cndmask_b32 v90, v12, v7, s[44:45]
  v_cndmask_b32 v91, v12, v7, s[46:47]
  v_cmp_le_i32 s[40:41], 24, v5
  v_cmp_le_i32 s[42:43], 25, v5
  v_cmp_le_i32 s[44:45], 26, v5
  v_cmp_le_i32 s[46:47], 27, v5
  v_cndmask_b32 v92, v12, v7, s[40:41]
  v_cndmask_b32 v93, v12, v7, s[42:43]
  v_cndmask_b32 v94, v12, v7, s[44:45]
  v_cndmask_b32 v95, v12, v7, s[46:47]
  s_lshl_b32 s22, s69, 3
  s_add_u32 s22, s22, 8
  s_lshl_b32 s26, s16, 1
  s_sub_u32 s23, 6, s26
  s_waitcnt vmcnt(20)
  s_barrier
  s_cmp_eq_u32 s23, 0
  s_cbranch_scc1 A_go_157
A_idle_156:
  s_waitcnt vmcnt(16)
  s_barrier
  s_sub_u32 s18, s18, 8192
  s_max_i32 s18, s18, s20
  s_sub_u32 s17, s17, 8192
  s_max_i32 s17, s17, s19
  s_add_u32 s21, s21, 16384
  s_and_b32 s21, s21, 131071
M_kv_158:
  s_cmp_ge_u32 s17, s36
  s_cbranch_scc1 M_kvok_159
  s_mov_b32 s76, 0
  s_mov_b32 s78, 23
  s_mov_b32 s77, 335872
  s_cmp_eq_u32 s68, 1
  s_cmov_b32 s76, 128
  s_cmov_b32 s78, 27
  s_cmov_b32 s77, 114688
  s_cmp_eq_u32 s68, 2
  s_cmov_b32 s76, 768
  s_cmov_b32 s78, 14
  s_cmov_b32 s77, 0
  s_add_u32 s76, s76, s67
  s_mov_b32 s71, 0
  s_branch M_sg_161
M_sw_160:
  s_sleep 8
  s_add_u32 s71, s71, 1
  s_cmp_gt_u32 s71, 262144
  s_cbranch_scc1 M_exit
M_sg_161:
  s_mov_b32 s79, 0
  s_atomic_or s79, s[72:73], s76 glc
  s_waitcnt lgkmcnt(0)
  s_cmp_lt_u32 s79, s78
  s_cbranch_scc1 M_sw_160
  s_add_u32 s36, s77, s19
  s_add_u32 s68, s68, 1
  s_branch M_kv_158
M_kvok_159:
  s_mov_b32 m0, s21
  s_nop 0
  buffer_load_dwordx4 v3, s[4:7], s18 offen offset:0 sc1 lds
  buffer_load_dwordx4 v3, s[4:7], s18 offen offset:1024 sc1 lds
  s_add_u32 m0, s21, 8192
  s_nop 0
  buffer_load_dwordx4 v3, s[4:7], s17 offen offset:0 sc1 lds
  buffer_load_dwordx4 v3, s[4:7], s17 offen offset:1024 sc1 lds
  v_add_u32 v4, 16384, v4
  v_and_b32 v4, 131071, v4
  s_sub_u32 s22, s22, 1
  s_sub_u32 s23, s23, 1
  s_cmp_lg_u32 s23, 0
  s_cbranch_scc1 A_idle_156
A_go_157:
  ds_read_b128 a[224:227], v4 offset:0
  ds_read_b128 a[228:231], v4 offset:2048
  ds_read_b128 a[232:235], v4 offset:4096
  ds_read_b128 a[236:239], v4 offset:6144
  ds_read_b128 a[240:243], v4 offset:1024
  ds_read_b128 a[244:247], v4 offset:3072
  ds_read_b128 a[248:251], v4 offset:5120
  ds_read_b128 a[252:255], v4 offset:7168
  ds_read_b128 a[192:195], v4 offset:8192
  ds_read_b128 a[196:199], v4 offset:9216
  ds_read_b128 a[200:203], v4 offset:10240
  ds_read_b128 a[204:207], v4 offset:11264
  ds_read_b128 a[208:211], v4 offset:12288
  ds_read_b128 a[212:215], v4 offset:13312
  ds_read_b128 a[216:219], v4 offset:14336
  ds_read_b128 a[220:223], v4 offset:15360
  v_add_u32 v4, 16384, v4
  v_and_b32 v4, 131071, v4
  s_waitcnt lgkmcnt(8)
.p2align 6
A_top_162:
  s_waitcnt lgkmcnt(7)
  v_mfma_f32_32x32x16_bf16 v[32:47], a[192:195], a[128:131], v[64:79]
  s_waitcnt lgkmcnt(6)
  v_exp_f32 v54, v54
  v_add_f32 v11, v11, v53
  v_cvt_pk_bf16_f32 v106, v52, v53
  v_mfma_f32_32x32x16_bf16 v[32:47], a[196:199], a[132:135], v[32:47]
  s_waitcnt lgkmcnt(4)
  v_exp_f32 v55, v55
  v_add_f32 v10, v10, v54
  v_mfma_f32_32x32x16_bf16 v[32:47], a[200:203], a[136:139], v[32:47]
  v_exp_f32 v56, v56
  v_add_f32 v11, v11, v55
  v_cvt_pk_bf16_f32 v107, v54, v55
  v_mfma_f32_32x32x16_bf16 v[32:47], a[204:207], a[140:143], v[32:47]
  s_waitcnt lgkmcnt(2)
  v_exp_f32 v57, v57
  v_add_f32 v10, v10, v56
  v_mfma_f32_32x32x16_bf16 v[32:47], a[208:211], a[144:147], v[32:47]
  v_exp_f32 v58, v58
  v_add_f32 v11, v11, v57
  v_cvt_pk_bf16_f32 v108, v56, v57
  v_mfma_f32_32x32x16_bf16 v[32:47], a[212:215], a[148:151], v[32:47]
  s_waitcnt lgkmcnt(0)
  v_exp_f32 v59, v59
  v_add_f32 v10, v10, v58
  v_mfma_f32_32x32x16_bf16 v[32:47], a[216:219], a[152:155], v[32:47]
  v_exp_f32 v60, v60
  v_add_f32 v11, v11, v59
  v_cvt_pk_bf16_f32 v109, v58, v59
  v_mfma_f32_32x32x16_bf16 v[32:47], a[220:223], a[156:159], v[32:47]
  s_waitcnt vmcnt(16)
  s_barrier
  v_exp_f32 v61, v61
  v_add_f32 v10, v10, v60
  v_mfma_f32_32x32x16_bf16 a[64:79], a[224:227], v[104:107], a[64:79]
  ds_read_b128 a[224:227], v4 offset:0
  v_exp_f32 v62, v62
  v_add_f32 v11, v11, v61
  v_cvt_pk_bf16_f32 v110, v60, v61
  v_mfma_f32_32x32x16_bf16 a[80:95], a[228:231], v[104:107], a[80:95]
  s_sub_u32 s18, s18, 8192
  ds_read_b128 a[228:231], v4 offset:2048
  v_exp_f32 v63, v63
  v_add_f32 v10, v10, v62
  v_mfma_f32_32x32x16_bf16 a[96:111], a[232:235], v[104:107], a[96:111]
  s_max_i32 s18, s18, s20
  ds_read_b128 a[232:235], v4 offset:4096
  v_exp_f32 v32, v32
  v_add_f32 v11, v11, v63
  v_cvt_pk_bf16_f32 v111, v62, v63
  v_mfma_f32_32x32x16_bf16 a[112:127], a[236:239], v[104:107], a[112:127]
  s_sub_u32 s17, s17, 8192
  ds_read_b128 a[236:239], v4 offset:6144
  v_exp_f32 v33, v33
  v_add_f32 v8, v8, v32
  v_mfma_f32_32x32x16_bf16 a[64:79], a[240:243], v[108:111], a[64:79]
  s_max_i32 s17, s17, s19
  ds_read_b128 a[240:243], v4 offset:1024
  v_exp_f32 v34, v34
  v_add_f32 v9, v9, v33
  v_cvt_pk_bf16_f32 v96, v32, v33
  v_mfma_f32_32x32x16_bf16 a[80:95], a[244:247], v[108:111], a[80:95]
  s_add_u32 s21, s21, 16384
  ds_read_b128 a[244:247], v4 offset:3072
  v_exp_f32 v35, v35
  v_add_f32 v8, v8, v34
  v_mfma_f32_32x32x16_bf16 a[96:111], a[248:251], v[108:111], a[96:111]
  s_and_b32 s21, s21, 131071
  ds_read_b128 a[248:251], v4 offset:5120
  v_exp_f32 v36, v36
  v_add_f32 v9, v9, v35
  v_cvt_pk_bf16_f32 v97, v34, v35
  v_mfma_f32_32x32x16_bf16 a[112:127], a[252:255], v[108:111], a[112:127]
  ds_read_b128 a[252:255], v4 offset:7168
  v_exp_f32 v37, v37
  v_add_f32 v8, v8, v36
  v_mfma_f32_32x32x16_bf16 v[48:63], a[192:195], a[160:163], v[80:95]
  s_add_u32 s23, s23, 1
  ds_read_b128 a[192:195], v4 offset:8192
  v_exp_f32 v38, v38
  v_add_f32 v9, v9, v37
  v_cvt_pk_bf16_f32 v98, v36, v37
  v_mfma_f32_32x32x16_bf16 v[48:63], a[196:199], a[164:167], v[48:63]
  s_sub_u32 s22, s22, 1
  ds_read_b128 a[196:199], v4 offset:9216
  v_exp_f32 v39, v39
  v_add_f32 v8, v8, v38
  v_mfma_f32_32x32x16_bf16 v[48:63], a[200:203], a[168:171], v[48:63]
  s_cmp_lt_u32 s23, 3
  ds_read_b128 a[200:203], v4 offset:10240
  v_exp_f32 v40, v40
  v_add_f32 v9, v9, v39
  v_cvt_pk_bf16_f32 v99, v38, v39
  v_mfma_f32_32x32x16_bf16 v[48:63], a[204:207], a[172:175], v[48:63]
  s_cbranch_scc1 A_upd_163
A_back_164:
  ds_read_b128 a[204:207], v4 offset:11264
  v_exp_f32 v41, v41
  v_add_f32 v8, v8, v40
  v_mfma_f32_32x32x16_bf16 v[48:63], a[208:211], a[176:179], v[48:63]
  s_cmp_lt_u32 s17, s36
  ds_read_b128 a[208:211], v4 offset:12288
  v_exp_f32 v42, v42
  v_add_f32 v9, v9, v41
  v_cvt_pk_bf16_f32 v100, v40, v41
  v_mfma_f32_32x32x16_bf16 v[48:63], a[212:215], a[180:183], v[48:63]
  s_cbranch_scc1 A_kvw_166
A_kvb_167:
  ds_read_b128 a[212:215], v4 offset:13312
  v_exp_f32 v43, v43
  v_add_f32 v8, v8, v42
  v_mfma_f32_32x32x16_bf16 v[48:63], a[216:219], a[184:187], v[48:63]
  s_mov_b32 m0, s21
  ds_read_b128 a[216:219], v4 offset:14336
  v_exp_f32 v44, v44
  v_add_f32 v9, v9, v43
  v_cvt_pk_bf16_f32 v101, v42, v43
  v_mfma_f32_32x32x16_bf16 v[48:63], a[220:223], a[188:191], v[48:63]
  s_waitcnt lgkmcnt(13)
  ds_read_b128 a[220:223], v4 offset:15360
  v_exp_f32 v45, v45
  v_add_f32 v8, v8, v44
  v_mfma_f32_32x32x16_bf16 a[0:15], a[224:227], v[96:99], a[0:15]
  buffer_load_dwordx4 v3, s[4:7], s18 offen offset:0 sc1 lds
  v_exp_f32 v46, v46
  v_add_f32 v9, v9, v45
  v_cvt_pk_bf16_f32 v102, v44, v45
  v_mfma_f32_32x32x16_bf16 a[16:31], a[228:231], v[96:99], a[16:31]
  s_waitcnt lgkmcnt(12)
  v_exp_f32 v47, v47
  v_add_f32 v8, v8, v46
  v_add_u32 v4, 16384, v4
  v_mfma_f32_32x32x16_bf16 a[32:47], a[232:235], v[96:99], a[32:47]
  buffer_load_dwordx4 v3, s[4:7], s18 offen offset:1024 sc1 lds
  v_exp_f32 v48, v48
  v_add_f32 v9, v9, v47
  v_cvt_pk_bf16_f32 v103, v46, v47
  v_mfma_f32_32x32x16_bf16 a[48:63], a[236:239], v[96:99], a[48:63]
  s_waitcnt lgkmcnt(10)
  s_add_u32 m0, s21, 8192
  v_exp_f32 v49, v49
  v_add_f32 v10, v10, v48
  v_and_b32 v4, 131071, v4
  v_mfma_f32_32x32x16_bf16 a[0:15], a[240:243], v[100:103], a[0:15]
  buffer_load_dwordx4 v3, s[4:7], s17 offen offset:0 sc1 lds
  v_exp_f32 v50, v50
  v_add_f32 v11, v11, v49
  v_cvt_pk_bf16_f32 v104, v48, v49
  v_mfma_f32_32x32x16_bf16 a[16:31], a[244:247], v[100:103], a[16:31]
  s_waitcnt lgkmcnt(8)
  s_cmp_lg_u32 s22, 0
  v_exp_f32 v51, v51
  v_add_f32 v10, v10, v50
  v_mfma_f32_32x32x16_bf16 a[32:47], a[248:251], v[100:103], a[32:47]
  buffer_load_dwordx4 v3, s[4:7], s17 offen offset:1024 sc1 lds
  v_exp_f32 v52, v52
  v_add_f32 v11, v11, v51
  v_cvt_pk_bf16_f32 v105, v50, v51
  v_mfma_f32_32x32x16_bf16 a[48:63], a[252:255], v[100:103], a[48:63]
  v_exp_f32 v53, v53
  v_add_f32 v10, v10, v52
  s_cbranch_scc1 A_top_162
  v_exp_f32 v54, v54
  v_add_f32 v11, v11, v53
  v_cvt_pk_bf16_f32 v106, v52, v53
  v_exp_f32 v55, v55
  v_add_f32 v10, v10, v54
  v_exp_f32 v56, v56
  v_add_f32 v11, v11, v55
  v_cvt_pk_bf16_f32 v107, v54, v55
  v_exp_f32 v57, v57
  v_add_f32 v10, v10, v56
  v_exp_f32 v58, v58
  v_add_f32 v11, v11, v57
  v_cvt_pk_bf16_f32 v108, v56, v57
  v_exp_f32 v59, v59
  v_add_f32 v10, v10, v58
  v_exp_f32 v60, v60
  v_add_f32 v11, v11, v59
  v_cvt_pk_bf16_f32 v109, v58, v59
  v_exp_f32 v61, v61
  v_add_f32 v10, v10, v60
  v_exp_f32 v62, v62
  v_add_f32 v11, v11, v61
  v_cvt_pk_bf16_f32 v110, v60, v61
  v_exp_f32 v63, v63
  v_add_f32 v10, v10, v62
  v_add_f32 v11, v11, v63
  v_cvt_pk_bf16_f32 v111, v62, v63
  s_nop 1
  v_mfma_f32_32x32x16_bf16 a[64:79], a[224:227], v[104:107], a[64:79]
  v_mfma_f32_32x32x16_bf16 a[80:95], a[228:231], v[104:107], a[80:95]
  v_mfma_f32_32x32x16_bf16 a[96:111], a[232:235], v[104:107], a[96:111]
  v_mfma_f32_32x32x16_bf16 a[112:127], a[236:239], v[104:107], a[112:127]
  v_mfma_f32_32x32x16_bf16 a[64:79], a[240:243], v[108:111], a[64:79]
  v_mfma_f32_32x32x16_bf16 a[80:95], a[244:247], v[108:111], a[80:95]
  v_mfma_f32_32x32x16_bf16 a[96:111], a[248:251], v[108:111], a[96:111]
  v_mfma_f32_32x32x16_bf16 a[112:127], a[252:255], v[108:111], a[112:127]
  v_add_f32 v8, v8, v9
  v_mov_b32 v9, v8
  s_nop 1
  v_permlane32_swap_b32 v8, v9
  s_nop 1
  v_add_f32 v8, v8, v9
  v_add_f32 v10, v10, v11
  v_mov_b32 v11, v10
  s_nop 1
  v_permlane32_swap_b32 v10, v11
  s_nop 1
  v_add_f32 v10, v10, v11
  v_subrev_u32 v12, 0x2f800000, v8
  v_subrev_u32 v13, 0x2f800000, v10
  v_max_u32 v12, v12, v13
  v_cmp_le_u32 vcc, 0x28000000, v12
  s_nop 1
  s_cmp_lg_u64 vcc, 0
  s_cselect_b32 s26, 1, 0
  v_mov_b32 v12, s26
  s_lshl_b32 s26, s16, 2
  s_add_u32 s26, s26, 131072
  v_mov_b32 v13, s26
  ds_write_b32 v13, v12
  v_mov_b32 v14, 131072
  s_waitcnt vmcnt(0) lgkmcnt(0)
  s_barrier
  ds_read_b128 v[16:19], v14
  v_rcp_f32 v8, v8
  v_rcp_f32 v10, v10
  s_waitcnt lgkmcnt(0)
  v_or3_b32 v12, v16, v17, v18
  v_or_b32 v12, v12, v19
  s_nop 0
  v_readfirstlane_b32 s26, v12
  s_nop 1
  s_cmp_gt_u32 s26, s29
  s_cbranch_scc1 A_slow_168
  s_add_u32 s28, s25, 100663296
  v_accvgpr_read_b32 v112, a0
  v_accvgpr_read_b32 v113, a1
  v_accvgpr_read_b32 v114, a2
  v_accvgpr_read_b32 v115, a3
  v_accvgpr_read_b32 v116, a4
  v_accvgpr_read_b32 v117, a5
  v_accvgpr_read_b32 v118, a6
  v_accvgpr_read_b32 v119, a7
  v_pk_mul_f32 v[112:113], v[112:113], v[8:9] op_sel_hi:[1,0]
  v_pk_mul_f32 v[114:115], v[114:115], v[8:9] op_sel_hi:[1,0]
  v_pk_mul_f32 v[116:117], v[116:117], v[8:9] op_sel_hi:[1,0]
  v_pk_mul_f32 v[118:119], v[118:119], v[8:9] op_sel_hi:[1,0]
  v_cvt_pk_bf16_f32 v120, v112, v113
  v_cvt_pk_bf16_f32 v121, v114, v115
  v_cvt_pk_bf16_f32 v122, v116, v117
  v_cvt_pk_bf16_f32 v123, v118, v119
  buffer_store_dwordx4 v[120:123], v2, s[4:7], s28 offen offset:0 sc1
  v_accvgpr_read_b32 v124, a8
  v_accvgpr_read_b32 v125, a9
  v_accvgpr_read_b32 v126, a10
  v_accvgpr_read_b32 v127, a11
  v_accvgpr_read_b32 v128, a12
  v_accvgpr_read_b32 v129, a13
  v_accvgpr_read_b32 v130, a14
  v_accvgpr_read_b32 v131, a15
  v_pk_mul_f32 v[124:125], v[124:125], v[8:9] op_sel_hi:[1,0]
  v_pk_mul_f32 v[126:127], v[126:127], v[8:9] op_sel_hi:[1,0]
  v_pk_mul_f32 v[128:129], v[128:129], v[8:9] op_sel_hi:[1,0]
  v_pk_mul_f32 v[130:131], v[130:131], v[8:9] op_sel_hi:[1,0]
  v_cvt_pk_bf16_f32 v132, v124, v125
  v_cvt_pk_bf16_f32 v133, v126, v127
  v_cvt_pk_bf16_f32 v134, v128, v129
  v_cvt_pk_bf16_f32 v135, v130, v131
  buffer_store_dwordx4 v[132:135], v2, s[4:7], s28 offen offset:1024 sc1
  v_accvgpr_read_b32 v136, a16
  v_accvgpr_read_b32 v137, a17
  v_accvgpr_read_b32 v138, a18
  v_accvgpr_read_b32 v139, a19
  v_accvgpr_read_b32 v140, a20
  v_accvgpr_read_b32 v141, a21
  v_accvgpr_read_b32 v142, a22
  v_accvgpr_read_b32 v143, a23
  v_pk_mul_f32 v[136:137], v[136:137], v[8:9] op_sel_hi:[1,0]
  v_pk_mul_f32 v[138:139], v[138:139], v[8:9] op_sel_hi:[1,0]
  v_pk_mul_f32 v[140:141], v[140:141], v[8:9] op_sel_hi:[1,0]
  v_pk_mul_f32 v[142:143], v[142:143], v[8:9] op_sel_hi:[1,0]
  v_cvt_pk_bf16_f32 v144, v136, v137
  v_cvt_pk_bf16_f32 v145, v138, v139
  v_cvt_pk_bf16_f32 v146, v140, v141
  v_cvt_pk_bf16_f32 v147, v142, v143
  buffer_store_dwordx4 v[144:147], v2, s[4:7], s28 offen offset:2048 sc1
  v_accvgpr_read_b32 v148, a24
  v_accvgpr_read_b32 v149, a25
  v_accvgpr_read_b32 v150, a26
  v_accvgpr_read_b32 v151, a27
  v_accvgpr_read_b32 v152, a28
  v_accvgpr_read_b32 v153, a29
  v_accvgpr_read_b32 v154, a30
  v_accvgpr_read_b32 v155, a31
  v_pk_mul_f32 v[148:149], v[148:149], v[8:9] op_sel_hi:[1,0]
  v_pk_mul_f32 v[150:151], v[150:151], v[8:9] op_sel_hi:[1,0]
  v_pk_mul_f32 v[152:153], v[152:153], v[8:9] op_sel_hi:[1,0]
  v_pk_mul_f32 v[154:155], v[154:155], v[8:9] op_sel_hi:[1,0]
  v_cvt_pk_bf16_f32 v156, v148, v149
  v_cvt_pk_bf16_f32 v157, v150, v151
  v_cvt_pk_bf16_f32 v158, v152, v153
  v_cvt_pk_bf16_f32 v159, v154, v155
  buffer_store_dwordx4 v[156:159], v2, s[4:7], s28 offen offset:3072 sc1
  s_add_u32 s28, s25, 100667392
  v_accvgpr_read_b32 v112, a32
  v_accvgpr_read_b32 v113, a33
  v_accvgpr_read_b32 v114, a34
  v_accvgpr_read_b32 v115, a35
  v_accvgpr_read_b32 v116, a36
  v_accvgpr_read_b32 v117, a37
  v_accvgpr_read_b32 v118, a38
  v_accvgpr_read_b32 v119, a39
  v_pk_mul_f32 v[112:113], v[112:113], v[8:9] op_sel_hi:[1,0]
  v_pk_mul_f32 v[114:115], v[114:115], v[8:9] op_sel_hi:[1,0]
  v_pk_mul_f32 v[116:117], v[116:117], v[8:9] op_sel_hi:[1,0]
  v_pk_mul_f32 v[118:119], v[118:119], v[8:9] op_sel_hi:[1,0]
  v_cvt_pk_bf16_f32 v120, v112, v113
  v_cvt_pk_bf16_f32 v121, v114, v115
  v_cvt_pk_bf16_f32 v122, v116, v117
  v_cvt_pk_bf16_f32 v123, v118, v119
  buffer_store_dwordx4 v[120:123], v2, s[4:7], s28 offen offset:0 sc1
  v_accvgpr_read_b32 v124, a40
  v_accvgpr_read_b32 v125, a41
  v_accvgpr_read_b32 v126, a42
  v_accvgpr_read_b32 v127, a43
  v_accvgpr_read_b32 v128, a44
  v_accvgpr_read_b32 v129, a45
  v_accvgpr_read_b32 v130, a46
  v_accvgpr_read_b32 v131, a47
  v_pk_mul_f32 v[124:125], v[124:125], v[8:9] op_sel_hi:[1,0]
  v_pk_mul_f32 v[126:127], v[126:127], v[8:9] op_sel_hi:[1,0]
  v_pk_mul_f32 v[128:129], v[128:129], v[8:9] op_sel_hi:[1,0]
  v_pk_mul_f32 v[130:131], v[130:131], v[8:9] op_sel_hi:[1,0]
  v_cvt_pk_bf16_f32 v132, v124, v125
  v_cvt_pk_bf16_f32 v133, v126, v127
  v_cvt_pk_bf16_f32 v134, v128, v129
  v_cvt_pk_bf16_f32 v135, v130, v131
  buffer_store_dwordx4 v[132:135], v2, s[4:7], s28 offen offset:1024 sc1
  v_accvgpr_read_b32 v136, a48
  v_accvgpr_read_b32 v137, a49
  v_accvgpr_read_b32 v138, a50
  v_accvgpr_read_b32 v139, a51
  v_accvgpr_read_b32 v140, a52
  v_accvgpr_read_b32 v141, a53
  v_accvgpr_read_b32 v142, a54
  v_accvgpr_read_b32 v143, a55
  v_pk_mul_f32 v[136:137], v[136:137], v[8:9] op_sel_hi:[1,0]
  v_pk_mul_f32 v[138:139], v[138:139], v[8:9] op_sel_hi:[1,0]
  v_pk_mul_f32 v[140:141], v[140:141], v[8:9] op_sel_hi:[1,0]
  v_pk_mul_f32 v[142:143], v[142:143], v[8:9] op_sel_hi:[1,0]
  v_cvt_pk_bf16_f32 v144, v136, v137
  v_cvt_pk_bf16_f32 v145, v138, v139
  v_cvt_pk_bf16_f32 v146, v140, v141
  v_cvt_pk_bf16_f32 v147, v142, v143
  buffer_store_dwordx4 v[144:147], v2, s[4:7], s28 offen offset:2048 sc1
  v_accvgpr_read_b32 v148, a56
  v_accvgpr_read_b32 v149, a57
  v_accvgpr_read_b32 v150, a58
  v_accvgpr_read_b32 v151, a59
  v_accvgpr_read_b32 v152, a60
  v_accvgpr_read_b32 v153, a61
  v_accvgpr_read_b32 v154, a62
  v_accvgpr_read_b32 v155, a63
  v_pk_mul_f32 v[148:149], v[148:149], v[8:9] op_sel_hi:[1,0]
  v_pk_mul_f32 v[150:151], v[150:151], v[8:9] op_sel_hi:[1,0]
  v_pk_mul_f32 v[152:153], v[152:153], v[8:9] op_sel_hi:[1,0]
  v_pk_mul_f32 v[154:155], v[154:155], v[8:9] op_sel_hi:[1,0]
  v_cvt_pk_bf16_f32 v156, v148, v149
  v_cvt_pk_bf16_f32 v157, v150, v151
  v_cvt_pk_bf16_f32 v158, v152, v153
  v_cvt_pk_bf16_f32 v159, v154, v155
  buffer_store_dwordx4 v[156:159], v2, s[4:7], s28 offen offset:3072 sc1
  s_add_u32 s28, s25, 100671488
  v_accvgpr_read_b32 v112, a64
  v_accvgpr_read_b32 v113, a65
  v_accvgpr_read_b32 v114, a66
  v_accvgpr_read_b32 v115, a67
  v_accvgpr_read_b32 v116, a68
  v_accvgpr_read_b32 v117, a69
  v_accvgpr_read_b32 v118, a70
  v_accvgpr_read_b32 v119, a71
  v_pk_mul_f32 v[112:113], v[112:113], v[10:11] op_sel_hi:[1,0]
  v_pk_mul_f32 v[114:115], v[114:115], v[10:11] op_sel_hi:[1,0]
  v_pk_mul_f32 v[116:117], v[116:117], v[10:11] op_sel_hi:[1,0]
  v_pk_mul_f32 v[118:119], v[118:119], v[10:11] op_sel_hi:[1,0]
  v_cvt_pk_bf16_f32 v120, v112, v113
  v_cvt_pk_bf16_f32 v121, v114, v115
  v_cvt_pk_bf16_f32 v122, v116, v117
  v_cvt_pk_bf16_f32 v123, v118, v119
  buffer_store_dwordx4 v[120:123], v2, s[4:7], s28 offen offset:0 sc1
  v_accvgpr_read_b32 v124, a72
  v_accvgpr_read_b32 v125, a73
  v_accvgpr_read_b32 v126, a74
  v_accvgpr_read_b32 v127, a75
  v_accvgpr_read_b32 v128, a76
  v_accvgpr_read_b32 v129, a77
  v_accvgpr_read_b32 v130, a78
  v_accvgpr_read_b32 v131, a79
  v_pk_mul_f32 v[124:125], v[124:125], v[10:11] op_sel_hi:[1,0]
  v_pk_mul_f32 v[126:127], v[126:127], v[10:11] op_sel_hi:[1,0]
  v_pk_mul_f32 v[128:129], v[128:129], v[10:11] op_sel_hi:[1,0]
  v_pk_mul_f32 v[130:131], v[130:131], v[10:11] op_sel_hi:[1,0]
  v_cvt_pk_bf16_f32 v132, v124, v125
  v_cvt_pk_bf16_f32 v133, v126, v127
  v_cvt_pk_bf16_f32 v134, v128, v129
  v_cvt_pk_bf16_f32 v135, v130, v131
  buffer_store_dwordx4 v[132:135], v2, s[4:7], s28 offen offset:1024 sc1
  v_accvgpr_read_b32 v136, a80
  v_accvgpr_read_b32 v137, a81
  v_accvgpr_read_b32 v138, a82
  v_accvgpr_read_b32 v139, a83
  v_accvgpr_read_b32 v140, a84
  v_accvgpr_read_b32 v141, a85
  v_accvgpr_read_b32 v142, a86
  v_accvgpr_read_b32 v143, a87
  v_pk_mul_f32 v[136:137], v[136:137], v[10:11] op_sel_hi:[1,0]
  v_pk_mul_f32 v[138:139], v[138:139], v[10:11] op_sel_hi:[1,0]
  v_pk_mul_f32 v[140:141], v[140:141], v[10:11] op_sel_hi:[1,0]
  v_pk_mul_f32 v[142:143], v[142:143], v[10:11] op_sel_hi:[1,0]
  v_cvt_pk_bf16_f32 v144, v136, v137
  v_cvt_pk_bf16_f32 v145, v138, v139
  v_cvt_pk_bf16_f32 v146, v140, v141
  v_cvt_pk_bf16_f32 v147, v142, v143
  buffer_store_dwordx4 v[144:147], v2, s[4:7], s28 offen offset:2048 sc1
  v_accvgpr_read_b32 v148, a88
  v_accvgpr_read_b32 v149, a89
  v_accvgpr_read_b32 v150, a90
  v_accvgpr_read_b32 v151, a91
  v_accvgpr_read_b32 v152, a92
  v_accvgpr_read_b32 v153, a93
  v_accvgpr_read_b32 v154, a94
  v_accvgpr_read_b32 v155, a95
  v_pk_mul_f32 v[148:149], v[148:149], v[10:11] op_sel_hi:[1,0]
  v_pk_mul_f32 v[150:151], v[150:151], v[10:11] op_sel_hi:[1,0]
  v_pk_mul_f32 v[152:153], v[152:153], v[10:11] op_sel_hi:[1,0]
  v_pk_mul_f32 v[154:155], v[154:155], v[10:11] op_sel_hi:[1,0]
  v_cvt_pk_bf16_f32 v156, v148, v149
  v_cvt_pk_bf16_f32 v157, v150, v151
  v_cvt_pk_bf16_f32 v158, v152, v153
  v_cvt_pk_bf16_f32 v159, v154, v155
  buffer_store_dwordx4 v[156:159], v2, s[4:7], s28 offen offset:3072 sc1
  s_add_u32 s28, s25, 100675584
  v_accvgpr_read_b32 v112, a96
  v_accvgpr_read_b32 v113, a97
  v_accvgpr_read_b32 v114, a98
  v_accvgpr_read_b32 v115, a99
  v_accvgpr_read_b32 v116, a100
  v_accvgpr_read_b32 v117, a101
  v_accvgpr_read_b32 v118, a102
  v_accvgpr_read_b32 v119, a103
  v_pk_mul_f32 v[112:113], v[112:113], v[10:11] op_sel_hi:[1,0]
  v_pk_mul_f32 v[114:115], v[114:115], v[10:11] op_sel_hi:[1,0]
  v_pk_mul_f32 v[116:117], v[116:117], v[10:11] op_sel_hi:[1,0]
  v_pk_mul_f32 v[118:119], v[118:119], v[10:11] op_sel_hi:[1,0]
  v_cvt_pk_bf16_f32 v120, v112, v113
  v_cvt_pk_bf16_f32 v121, v114, v115
  v_cvt_pk_bf16_f32 v122, v116, v117
  v_cvt_pk_bf16_f32 v123, v118, v119
  buffer_store_dwordx4 v[120:123], v2, s[4:7], s28 offen offset:0 sc1
  v_accvgpr_read_b32 v124, a104
  v_accvgpr_read_b32 v125, a105
  v_accvgpr_read_b32 v126, a106
  v_accvgpr_read_b32 v127, a107
  v_accvgpr_read_b32 v128, a108
  v_accvgpr_read_b32 v129, a109
  v_accvgpr_read_b32 v130, a110
  v_accvgpr_read_b32 v131, a111
  v_pk_mul_f32 v[124:125], v[124:125], v[10:11] op_sel_hi:[1,0]
  v_pk_mul_f32 v[126:127], v[126:127], v[10:11] op_sel_hi:[1,0]
  v_pk_mul_f32 v[128:129], v[128:129], v[10:11] op_sel_hi:[1,0]
  v_pk_mul_f32 v[130:131], v[130:131], v[10:11] op_sel_hi:[1,0]
  v_cvt_pk_bf16_f32 v132, v124, v125
  v_cvt_pk_bf16_f32 v133, v126, v127
  v_cvt_pk_bf16_f32 v134, v128, v129
  v_cvt_pk_bf16_f32 v135, v130, v131
  buffer_store_dwordx4 v[132:135], v2, s[4:7], s28 offen offset:1024 sc1
  v_accvgpr_read_b32 v136, a112
  v_accvgpr_read_b32 v137, a113
  v_accvgpr_read_b32 v138, a114
  v_accvgpr_read_b32 v139, a115
  v_accvgpr_read_b32 v140, a116
  v_accvgpr_read_b32 v141, a117
  v_accvgpr_read_b32 v142, a118
  v_accvgpr_read_b32 v143, a119
  v_pk_mul_f32 v[136:137], v[136:137], v[10:11] op_sel_hi:[1,0]
  v_pk_mul_f32 v[138:139], v[138:139], v[10:11] op_sel_hi:[1,0]
  v_pk_mul_f32 v[140:141], v[140:141], v[10:11] op_sel_hi:[1,0]
  v_pk_mul_f32 v[142:143], v[142:143], v[10:11] op_sel_hi:[1,0]
  v_cvt_pk_bf16_f32 v144, v136, v137
  v_cvt_pk_bf16_f32 v145, v138, v139
  v_cvt_pk_bf16_f32 v146, v140, v141
  v_cvt_pk_bf16_f32 v147, v142, v143
  buffer_store_dwordx4 v[144:147], v2, s[4:7], s28 offen offset:2048 sc1
  v_accvgpr_read_b32 v148, a120
  v_accvgpr_read_b32 v149, a121
  v_accvgpr_read_b32 v150, a122
  v_accvgpr_read_b32 v151, a123
  v_accvgpr_read_b32 v152, a124
  v_accvgpr_read_b32 v153, a125
  v_accvgpr_read_b32 v154, a126
  v_accvgpr_read_b32 v155, a127
  v_pk_mul_f32 v[148:149], v[148:149], v[10:11] op_sel_hi:[1,0]
  v_pk_mul_f32 v[150:151], v[150:151], v[10:11] op_sel_hi:[1,0]
  v_pk_mul_f32 v[152:153], v[152:153], v[10:11] op_sel_hi:[1,0]
  v_pk_mul_f32 v[154:155], v[154:155], v[10:11] op_sel_hi:[1,0]
  v_cvt_pk_bf16_f32 v156, v148, v149
  v_cvt_pk_bf16_f32 v157, v150, v151
  v_cvt_pk_bf16_f32 v158, v152, v153
  v_cvt_pk_bf16_f32 v159, v154, v155
  buffer_store_dwordx4 v[156:159], v2, s[4:7], s28 offen offset:3072 sc1
  s_branch A_out_165
A_kvw_166:
M_kv_169:
  s_cmp_ge_u32 s17, s36
  s_cbranch_scc1 M_kvok_170
  s_mov_b32 s76, 0
  s_mov_b32 s78, 23
  s_mov_b32 s77, 335872
  s_cmp_eq_u32 s68, 1
  s_cmov_b32 s76, 128
  s_cmov_b32 s78, 27
  s_cmov_b32 s77, 114688
  s_cmp_eq_u32 s68, 2
  s_cmov_b32 s76, 768
  s_cmov_b32 s78, 14
  s_cmov_b32 s77, 0
  s_add_u32 s76, s76, s67
  s_mov_b32 s71, 0
  s_branch M_sg_172
M_sw_171:
  s_sleep 8
  s_add_u32 s71, s71, 1
  s_cmp_gt_u32 s71, 262144
  s_cbranch_scc1 M_exit
M_sg_172:
  s_mov_b32 s79, 0
  s_atomic_or s79, s[72:73], s76 glc
  s_waitcnt lgkmcnt(0)
  s_cmp_lt_u32 s79, s78
  s_cbranch_scc1 M_sw_171
  s_add_u32 s36, s77, s19
  s_add_u32 s68, s68, 1
  s_branch M_kv_169
M_kvok_170:
  s_branch A_kvb_167
A_upd_163:
  s_cmp_eq_u32 s23, 2
  s_cbranch_scc1 A_upd2_173
  v_mov_b32 v12, s24
  v_cmp_le_i32 s[40:41], 0, v5
  v_cmp_le_i32 s[42:43], 1, v5
  v_cmp_le_i32 s[44:45], 2, v5
  v_cmp_le_i32 s[46:47], 3, v5
  v_cndmask_b32 v64, v12, v6, s[40:41]
  v_cndmask_b32 v65, v12, v6, s[42:43]
  v_cndmask_b32 v66, v12, v6, s[44:45]
  v_cndmask_b32 v67, v12, v6, s[46:47]
  v_cmp_le_i32 s[40:41], 8, v5
  v_cmp_le_i32 s[42:43], 9, v5
  v_cmp_le_i32 s[44:45], 10, v5
  v_cmp_le_i32 s[46:47], 11, v5
  v_cndmask_b32 v68, v12, v6, s[40:41]
  v_cndmask_b32 v69, v12, v6, s[42:43]
  v_cndmask_b32 v70, v12, v6, s[44:45]
  v_cndmask_b32 v71, v12, v6, s[46:47]
  v_cmp_le_i32 s[40:41], 16, v5
  v_cmp_le_i32 s[42:43], 17, v5
  v_cmp_le_i32 s[44:45], 18, v5
  v_cmp_le_i32 s[46:47], 19, v5
  v_cndmask_b32 v72, v12, v6, s[40:41]
  v_cndmask_b32 v73, v12, v6, s[42:43]
  v_cndmask_b32 v74, v12, v6, s[44:45]
  v_cndmask_b32 v75, v12, v6, s[46:47]
  v_cmp_le_i32 s[40:41], 24, v5
  v_cmp_le_i32 s[42:43], 25, v5
  v_cmp_le_i32 s[44:45], 26, v5
  v_cmp_le_i32 s[46:47], 27, v5
  v_cndmask_b32 v76, v12, v6, s[40:41]
  v_cndmask_b32 v77, v12, v6, s[42:43]
  v_cndmask_b32 v78, v12, v6, s[44:45]
  v_cndmask_b32 v79, v12, v6, s[46:47]
  v_mov_b32 v80, v7
  v_mov_b32 v81, v7
  v_mov_b32 v82, v7
  v_mov_b32 v83, v7
  v_mov_b32 v84, v7
  v_mov_b32 v85, v7
  v_mov_b32 v86, v7
  v_mov_b32 v87, v7
  v_mov_b32 v88, v7
  v_mov_b32 v89, v7
  v_mov_b32 v90, v7
  v_mov_b32 v91, v7
  v_mov_b32 v92, v7
  v_mov_b32 v93, v7
  v_mov_b32 v94, v7
  v_mov_b32 v95, v7
  s_branch A_back_164
A_upd2_173:
  v_mov_b32 v64, v6
  v_mov_b32 v65, v6
  v_mov_b32 v66, v6
  v_mov_b32 v67, v6
  v_mov_b32 v68, v6
  v_mov_b32 v69, v6
  v_mov_b32 v70, v6
  v_mov_b32 v71, v6
  v_mov_b32 v72, v6
  v_mov_b32 v73, v6
  v_mov_b32 v74, v6
  v_mov_b32 v75, v6
  v_mov_b32 v76, v6
  v_mov_b32 v77, v6
  v_mov_b32 v78, v6
  v_mov_b32 v79, v6
  s_branch A_back_164
A_slow_168:
  s_mov_b32 s29, 1
  v_mov_b32 v64, s24
  v_mov_b32 v65, s24
  v_mov_b32 v66, s24
  v_mov_b32 v67, s24
  v_mov_b32 v68, s24
  v_mov_b32 v69, s24
  v_mov_b32 v70, s24
  v_mov_b32 v71, s24
  v_mov_b32 v72, s24
  v_mov_b32 v73, s24
  v_mov_b32 v74, s24
  v_mov_b32 v75, s24
  v_mov_b32 v76, s24
  v_mov_b32 v77, s24
  v_mov_b32 v78, s24
  v_mov_b32 v79, s24
  v_mov_b32 v12, s24
  v_cmp_le_i32 s[40:41], 0, v5
  v_cmp_le_i32 s[42:43], 1, v5
  v_cmp_le_i32 s[44:45], 2, v5
  v_cmp_le_i32 s[46:47], 3, v5
  v_cndmask_b32 v80, v12, v7, s[40:41]
  v_cndmask_b32 v81, v12, v7, s[42:43]
  v_cndmask_b32 v82, v12, v7, s[44:45]
  v_cndmask_b32 v83, v12, v7, s[46:47]
  v_cmp_le_i32 s[40:41], 8, v5
  v_cmp_le_i32 s[42:43], 9, v5
  v_cmp_le_i32 s[44:45], 10, v5
  v_cmp_le_i32 s[46:47], 11, v5
  v_cndmask_b32 v84, v12, v7, s[40:41]
  v_cndmask_b32 v85, v12, v7, s[42:43]
  v_cndmask_b32 v86, v12, v7, s[44:45]
  v_cndmask_b32 v87, v12, v7, s[46:47]
  v_cmp_le_i32 s[40:41], 16, v5
  v_cmp_le_i32 s[42:43], 17, v5
  v_cmp_le_i32 s[44:45], 18, v5
  v_cmp_le_i32 s[46:47], 19, v5
  v_cndmask_b32 v88, v12, v7, s[40:41]
  v_cndmask_b32 v89, v12, v7, s[42:43]
  v_cndmask_b32 v90, v12, v7, s[44:45]
  v_cndmask_b32 v91, v12, v7, s[46:47]
  v_cmp_le_i32 s[40:41], 24, v5
  v_cmp_le_i32 s[42:43], 25, v5
  v_cmp_le_i32 s[44:45], 26, v5
  v_cmp_le_i32 s[46:47], 27, v5
  v_cndmask_b32 v92, v12, v7, s[40:41]
  v_cndmask_b32 v93, v12, v7, s[42:43]
  v_cndmask_b32 v94, v12, v7, s[44:45]
  v_cndmask_b32 v95, v12, v7, s[46:47]
  v_mov_b32 v8, s24
  v_mov_b32 v10, s24
  s_add_u32 s17, s25, 16785408
  s_mov_b32 s23, 0
A_ml_174:
  s_add_u32 s28, s17, 4096
  buffer_load_dwordx4 a[192:195], v2, s[4:7], s17 offen offset:0 sc1
  buffer_load_dwordx4 a[196:199], v2, s[4:7], s17 offen offset:1024 sc1
  buffer_load_dwordx4 a[200:203], v2, s[4:7], s17 offen offset:2048 sc1
  buffer_load_dwordx4 a[204:207], v2, s[4:7], s17 offen offset:3072 sc1
  buffer_load_dwordx4 a[208:211], v2, s[4:7], s28 offen offset:0 sc1
  buffer_load_dwordx4 a[212:215], v2, s[4:7], s28 offen offset:1024 sc1
  buffer_load_dwordx4 a[216:219], v2, s[4:7], s28 offen offset:2048 sc1
  buffer_load_dwordx4 a[220:223], v2, s[4:7], s28 offen offset:3072 sc1
  s_waitcnt vmcnt(0)
  v_mfma_f32_32x32x16_bf16 v[32:47], a[192:195], a[128:131], v[64:79]
  v_mfma_f32_32x32x16_bf16 v[32:47], a[196:199], a[132:135], v[32:47]
  v_mfma_f32_32x32x16_bf16 v[32:47], a[200:203], a[136:139], v[32:47]
  v_mfma_f32_32x32x16_bf16 v[32:47], a[204:207], a[140:143], v[32:47]
  v_mfma_f32_32x32x16_bf16 v[32:47], a[208:211], a[144:147], v[32:47]
  v_mfma_f32_32x32x16_bf16 v[32:47], a[212:215], a[148:151], v[32:47]
  v_mfma_f32_32x32x16_bf16 v[32:47], a[216:219], a[152:155], v[32:47]
  v_mfma_f32_32x32x16_bf16 v[32:47], a[220:223], a[156:159], v[32:47]
  v_mfma_f32_32x32x16_bf16 v[48:63], a[192:195], a[160:163], v[80:95]
  v_mfma_f32_32x32x16_bf16 v[48:63], a[196:199], a[164:167], v[48:63]
  v_mfma_f32_32x32x16_bf16 v[48:63], a[200:203], a[168:171], v[48:63]
  v_mfma_f32_32x32x16_bf16 v[48:63], a[204:207], a[172:175], v[48:63]
  v_mfma_f32_32x32x16_bf16 v[48:63], a[208:211], a[176:179], v[48:63]
  v_mfma_f32_32x32x16_bf16 v[48:63], a[212:215], a[180:183], v[48:63]
  v_mfma_f32_32x32x16_bf16 v[48:63], a[216:219], a[184:187], v[48:63]
  v_mfma_f32_32x32x16_bf16 v[48:63], a[220:223], a[188:191], v[48:63]
  s_nop 7
  s_nop 3
  v_max3_f32 v8, v8, v32, v33
  v_max3_f32 v8, v8, v34, v35
  v_max3_f32 v8, v8, v36, v37
  v_max3_f32 v8, v8, v38, v39
  v_max3_f32 v8, v8, v40, v41
  v_max3_f32 v8, v8, v42, v43
  v_max3_f32 v8, v8, v44, v45
  v_max3_f32 v8, v8, v46, v47
  v_max3_f32 v10, v10, v48, v49
  v_max3_f32 v10, v10, v50, v51
  v_max3_f32 v10, v10, v52, v53
  v_max3_f32 v10, v10, v54, v55
  v_max3_f32 v10, v10, v56, v57
  v_max3_f32 v10, v10, v58, v59
  v_max3_f32 v10, v10, v60, v61
  v_max3_f32 v10, v10, v62, v63
  s_add_u32 s23, s23, 1
  s_cmp_lg_u32 s23, 1
  s_cbranch_scc1 A_m2_175
  v_mov_b32 v12, s24
  v_cmp_le_i32 s[40:41], 0, v5
  v_cmp_le_i32 s[42:43], 1, v5
  v_cmp_le_i32 s[44:45], 2, v5
  v_cmp_le_i32 s[46:47], 3, v5
  v_cndmask_b32 v64, v12, v6, s[40:41]
  v_cndmask_b32 v65, v12, v6, s[42:43]
  v_cndmask_b32 v66, v12, v6, s[44:45]
  v_cndmask_b32 v67, v12, v6, s[46:47]
  v_cmp_le_i32 s[40:41], 8, v5
  v_cmp_le_i32 s[42:43], 9, v5
  v_cmp_le_i32 s[44:45], 10, v5
  v_cmp_le_i32 s[46:47], 11, v5
  v_cndmask_b32 v68, v12, v6, s[40:41]
  v_cndmask_b32 v69, v12, v6, s[42:43]
  v_cndmask_b32 v70, v12, v6, s[44:45]
  v_cndmask_b32 v71, v12, v6, s[46:47]
  v_cmp_le_i32 s[40:41], 16, v5
  v_cmp_le_i32 s[42:43], 17, v5
  v_cmp_le_i32 s[44:45], 18, v5
  v_cmp_le_i32 s[46:47], 19, v5
  v_cndmask_b32 v72, v12, v6, s[40:41]
  v_cndmask_b32 v73, v12, v6, s[42:43]
  v_cndmask_b32 v74, v12, v6, s[44:45]
  v_cndmask_b32 v75, v12, v6, s[46:47]
  v_cmp_le_i32 s[40:41], 24, v5
  v_cmp_le_i32 s[42:43], 25, v5
  v_cmp_le_i32 s[44:45], 26, v5
  v_cmp_le_i32 s[46:47], 27, v5
  v_cndmask_b32 v76, v12, v6, s[40:41]
  v_cndmask_b32 v77, v12, v6, s[42:43]
  v_cndmask_b32 v78, v12, v6, s[44:45]
  v_cndmask_b32 v79, v12, v6, s[46:47]
  v_mov_b32 v80, v7
  v_mov_b32 v81, v7
  v_mov_b32 v82, v7
  v_mov_b32 v83, v7
  v_mov_b32 v84, v7
  v_mov_b32 v85, v7
  v_mov_b32 v86, v7
  v_mov_b32 v87, v7
  v_mov_b32 v88, v7
  v_mov_b32 v89, v7
  v_mov_b32 v90, v7
  v_mov_b32 v91, v7
  v_mov_b32 v92, v7
  v_mov_b32 v93, v7
  v_mov_b32 v94, v7
  v_mov_b32 v95, v7
A_m2_175:
  s_cmp_lg_u32 s23, 2
  s_cbranch_scc1 A_m3_176
  v_mov_b32 v64, v6
  v_mov_b32 v65, v6
  v_mov_b32 v66, v6
  v_mov_b32 v67, v6
  v_mov_b32 v68, v6
  v_mov_b32 v69, v6
  v_mov_b32 v70, v6
  v_mov_b32 v71, v6
  v_mov_b32 v72, v6
  v_mov_b32 v73, v6
  v_mov_b32 v74, v6
  v_mov_b32 v75, v6
  v_mov_b32 v76, v6
  v_mov_b32 v77, v6
  v_mov_b32 v78, v6
  v_mov_b32 v79, v6
A_m3_176:
  s_sub_u32 s17, s17, 8192
  s_cmp_ge_i32 s17, s19
  s_cbranch_scc1 A_ml_174
  v_mov_b32 v9, v8
  s_nop 1
  v_permlane32_swap_b32 v8, v9
  s_nop 1
  v_max_f32 v8, v8, v9
  v_sub_f32 v6, 0, v8
  v_mov_b32 v11, v10
  s_nop 1
  v_permlane32_swap_b32 v10, v11
  s_nop 1
  v_max_f32 v10, v10, v11
  v_sub_f32 v7, 0, v10
  s_branch A_again_155
A_out_165:
  s_mov_b32 s69, s55
  s_mov_b32 s70, s56
  s_sub_u32 s52, s52, 1
  s_cmp_lg_u32 s52, 0
  s_cbranch_scc1 M_att
  s_waitcnt vmcnt(0)
  s_barrier
  s_mov_b32 s30, 512
  v_mov_b32 v144, s30
  v_min_u32 v145, 1, v0
  v_lshlrev_b32 v145, 30, v145
  buffer_store_dword v144, v145, s[4:7], s31 offen sc1
  s_lshr_b32 s48, s64, 2
  s_bfe_u32 s49, s64, 0x10001
  s_and_b32 s50, s64, 1
  s_mul_i32 s50, s50, 6
  s_add_u32 s50, s50, s65
  s_mov_b32 s51, 12
  s_cmp_lt_u32 s50, 4
  s_cselect_b32 s23, 6, 5
  s_load_dwordx2 s[8:9], s[0:1], 40
  s_lshl_b32 s17, s48, 19
  s_lshl_b32 s26, s49, 2
  s_add_u32 s26, s26, s16
  s_lshl_b32 s27, s26, 7
  s_add_u32 s17, s17, s27
  s_mov_b32 s18, 1024
  s_lshl_b32 s21, s48, 6
  s_add_u32 s21, s21, s50
  s_lshl_b32 s21, s21, 3
  s_add_u32 s21, s21, s26
  s_lshl_b32 s21, s21, 12
  s_add_u32 s21, s21, 150994944
  s_lshl_b32 s22, s51, 15
  s_mov_b32 s24, 1.0
  s_waitcnt lgkmcnt(0)
  s_and_b32 s9, s9, 0xffff
  s_mov_b32 s10, 4194304
  s_mov_b32 s11, 0x20000
  s_mov_b32 s12, s4
  s_mov_b32 s13, s5
  s_mov_b32 s14, 268435456
  s_mov_b32 s15, 0x20000
  s_lshl_b32 s19, s48, 8
  s_add_u32 s19, s19, s50
  s_lshl_b32 s19, s19, 13
  s_add_u32 s19, s19, 100663296
  s_lshl_b32 s20, s51, 13
  v_lshrrev_b32 v144, 4, v1
  v_and_b32 v56, 0xff, v2
  v_lshl_add_u32 v56, v144, 9, v56
  s_mul_i32 s26, s16, 524288
  v_add_u32 v8, 0, v56
  v_add_u32 v16, 0, v2
  v_add_u32 v16, s26, v16
  v_add_u32 v9, 256, v56
  v_add_u32 v17, 1024, v2
  v_add_u32 v17, s26, v17
  v_add_u32 v10, 2048, v56
  v_add_u32 v18, 2048, v2
  v_add_u32 v18, s26, v18
  v_add_u32 v11, 2304, v56
  v_add_u32 v19, 3072, v2
  v_add_u32 v19, s26, v19
  v_add_u32 v12, 4096, v56
  v_add_u32 v20, 4096, v2
  v_add_u32 v20, s26, v20
  v_add_u32 v13, 4352, v56
  v_add_u32 v21, 5120, v2
  v_add_u32 v21, s26, v21
  v_add_u32 v14, 6144, v56
  v_add_u32 v22, 6144, v2
  v_add_u32 v22, s26, v22
  v_add_u32 v15, 6400, v56
  v_add_u32 v23, 7168, v2
  v_add_u32 v23, s26, v23
  v_lshrrev_b32 v144, 3, v1
  v_mul_lo_u32 v144, v144, s18
  v_and_b32 v145, 7, v1
  v_lshl_add_u32 v144, v145, 4, v144
  s_lshl_b32 s28, s16, 15
  s_add_u32 s28, s28, 32768
  s_lshl_b32 s29, s18, 3
  s_add_u32 m0, s28, 0
  s_nop 0
  buffer_load_dwordx4 v144, s[8:11], s17 offen lds
  s_add_u32 s17, s17, s29
  s_add_u32 m0, s28, 1024
  s_nop 0
  buffer_load_dwordx4 v144, s[8:11], s17 offen lds
  s_add_u32 s17, s17, s29
  s_add_u32 m0, s28, 2048
  s_nop 0
  buffer_load_dwordx4 v144, s[8:11], s17 offen lds
  s_add_u32 s17, s17, s29
  s_add_u32 m0, s28, 3072
  s_nop 0
  buffer_load_dwordx4 v144, s[8:11], s17 offen lds
  s_add_u32 s17, s17, s29
  s_add_u32 m0, s28, 4096
  s_nop 0
  buffer_load_dwordx4 v144, s[8:11], s17 offen lds
  s_add_u32 s17, s17, s29
  s_add_u32 m0, s28, 5120
  s_nop 0
  buffer_load_dwordx4 v144, s[8:11], s17 offen lds
  s_add_u32 s17, s17, s29
  s_add_u32 m0, s28, 6144
  s_nop 0
  buffer_load_dwordx4 v144, s[8:11], s17 offen lds
  s_add_u32 s17, s17, s29
  s_add_u32 m0, s28, 7168
  s_nop 0
  buffer_load_dwordx4 v144, s[8:11], s17 offen lds
  s_add_u32 s17, s17, s29
  s_add_u32 m0, s28, 8192
  s_nop 0
  buffer_load_dwordx4 v144, s[8:11], s17 offen lds
  s_add_u32 s17, s17, s29
  s_add_u32 m0, s28, 9216
  s_nop 0
  buffer_load_dwordx4 v144, s[8:11], s17 offen lds
  s_add_u32 s17, s17, s29
  s_add_u32 m0, s28, 10240
  s_nop 0
  buffer_load_dwordx4 v144, s[8:11], s17 offen lds
  s_add_u32 s17, s17, s29
  s_add_u32 m0, s28, 11264
  s_nop 0
  buffer_load_dwordx4 v144, s[8:11], s17 offen lds
  s_add_u32 s17, s17, s29
  s_add_u32 m0, s28, 12288
  s_nop 0
  buffer_load_dwordx4 v144, s[8:11], s17 offen lds
  s_add_u32 s17, s17, s29
  s_add_u32 m0, s28, 13312
  s_nop 0
  buffer_load_dwordx4 v144, s[8:11], s17 offen lds
  s_add_u32 s17, s17, s29
  s_add_u32 m0, s28, 14336
  s_nop 0
  buffer_load_dwordx4 v144, s[8:11], s17 offen lds
  s_add_u32 s17, s17, s29
  s_add_u32 m0, s28, 15360
  s_nop 0
  buffer_load_dwordx4 v144, s[8:11], s17 offen lds
  s_add_u32 s17, s17, s29
  s_add_u32 m0, s28, 16384
  s_nop 0
  buffer_load_dwordx4 v144, s[8:11], s17 offen lds
  s_add_u32 s17, s17, s29
  s_add_u32 m0, s28, 17408
  s_nop 0
  buffer_load_dwordx4 v144, s[8:11], s17 offen lds
  s_add_u32 s17, s17, s29
  s_add_u32 m0, s28, 18432
  s_nop 0
  buffer_load_dwordx4 v144, s[8:11], s17 offen lds
  s_add_u32 s17, s17, s29
  s_add_u32 m0, s28, 19456
  s_nop 0
  buffer_load_dwordx4 v144, s[8:11], s17 offen lds
  s_add_u32 s17, s17, s29
  s_add_u32 m0, s28, 20480
  s_nop 0
  buffer_load_dwordx4 v144, s[8:11], s17 offen lds
  s_add_u32 s17, s17, s29
  s_add_u32 m0, s28, 21504
  s_nop 0
  buffer_load_dwordx4 v144, s[8:11], s17 offen lds
  s_add_u32 s17, s17, s29
  s_add_u32 m0, s28, 22528
  s_nop 0
  buffer_load_dwordx4 v144, s[8:11], s17 offen lds
  s_add_u32 s17, s17, s29
  s_add_u32 m0, s28, 23552
  s_nop 0
  buffer_load_dwordx4 v144, s[8:11], s17 offen lds
  s_add_u32 s17, s17, s29
  s_add_u32 m0, s28, 24576
  s_nop 0
  buffer_load_dwordx4 v144, s[8:11], s17 offen lds
  s_add_u32 s17, s17, s29
  s_add_u32 m0, s28, 25600
  s_nop 0
  buffer_load_dwordx4 v144, s[8:11], s17 offen lds
  s_add_u32 s17, s17, s29
  s_add_u32 m0, s28, 26624
  s_nop 0
  buffer_load_dwordx4 v144, s[8:11], s17 offen lds
  s_add_u32 s17, s17, s29
  s_add_u32 m0, s28, 27648
  s_nop 0
  buffer_load_dwordx4 v144, s[8:11], s17 offen lds
  s_add_u32 s17, s17, s29
  s_add_u32 m0, s28, 28672
  s_nop 0
  buffer_load_dwordx4 v144, s[8:11], s17 offen lds
  s_add_u32 s17, s17, s29
  s_add_u32 m0, s28, 29696
  s_nop 0
  buffer_load_dwordx4 v144, s[8:11], s17 offen lds
  s_add_u32 s17, s17, s29
  s_add_u32 m0, s28, 30720
  s_nop 0
  buffer_load_dwordx4 v144, s[8:11], s17 offen lds
  s_add_u32 s17, s17, s29
  s_add_u32 m0, s28, 31744
  s_nop 0
  buffer_load_dwordx4 v144, s[8:11], s17 offen lds
  s_add_u32 s17, s17, s29
  v_bfe_u32 v148, v1, 2, 2
  v_lshrrev_b32 v149, 5, v1
  v_lshl_add_u32 v148, v149, 4, v148
  v_bfe_u32 v149, v1, 4, 1
  v_lshl_add_u32 v148, v149, 2, v148
  v_and_b32 v149, 3, v1
  v_lshlrev_b32 v149, 4, v149
  s_mov_b32 s26, 8
  v_lshl_add_u32 v148, v148, 7, v149
  v_add_u32 v152, s28, v148
  v_add_u32 v153, 1024, v152
  v_add_u32 v154, s26, v152
  v_add_u32 v155, s26, v153
  s_waitcnt vmcnt(28)
  ds_read_b64_tr_b16 a[0:1], v152 offset:0
  ds_read_b64_tr_b16 a[2:3], v153 offset:0
  ds_read_b64_tr_b16 a[4:5], v154 offset:0
  ds_read_b64_tr_b16 a[6:7], v155 offset:0
  ds_read_b64_tr_b16 a[8:9], v152 offset:64
  ds_read_b64_tr_b16 a[10:11], v153 offset:64
  ds_read_b64_tr_b16 a[12:13], v154 offset:64
  ds_read_b64_tr_b16 a[14:15], v155 offset:64
  s_waitcnt lgkmcnt(0)
  s_add_u32 m0, s28, 0
  s_nop 0
  buffer_load_dwordx4 v144, s[8:11], s17 offen lds
  s_add_u32 s17, s17, s29
  s_add_u32 m0, s28, 1024
  s_nop 0
  buffer_load_dwordx4 v144, s[8:11], s17 offen lds
  s_add_u32 s17, s17, s29
  s_add_u32 m0, s28, 2048
  s_nop 0
  buffer_load_dwordx4 v144, s[8:11], s17 offen lds
  s_add_u32 s17, s17, s29
  s_add_u32 m0, s28, 3072
  s_nop 0
  buffer_load_dwordx4 v144, s[8:11], s17 offen lds
  s_add_u32 s17, s17, s29
  s_waitcnt vmcnt(28)
  ds_read_b64_tr_b16 a[16:17], v152 offset:4096
  ds_read_b64_tr_b16 a[18:19], v153 offset:4096
  ds_read_b64_tr_b16 a[20:21], v154 offset:4096
  ds_read_b64_tr_b16 a[22:23], v155 offset:4096
  ds_read_b64_tr_b16 a[24:25], v152 offset:4160
  ds_read_b64_tr_b16 a[26:27], v153 offset:4160
  ds_read_b64_tr_b16 a[28:29], v154 offset:4160
  ds_read_b64_tr_b16 a[30:31], v155 offset:4160
  s_waitcnt lgkmcnt(0)
  s_add_u32 m0, s28, 4096
  s_nop 0
  buffer_load_dwordx4 v144, s[8:11], s17 offen lds
  s_add_u32 s17, s17, s29
  s_add_u32 m0, s28, 5120
  s_nop 0
  buffer_load_dwordx4 v144, s[8:11], s17 offen lds
  s_add_u32 s17, s17, s29
  s_add_u32 m0, s28, 6144
  s_nop 0
  buffer_load_dwordx4 v144, s[8:11], s17 offen lds
  s_add_u32 s17, s17, s29
  s_add_u32 m0, s28, 7168
  s_nop 0
  buffer_load_dwordx4 v144, s[8:11], s17 offen lds
  s_add_u32 s17, s17, s29
  s_waitcnt vmcnt(28)
  ds_read_b64_tr_b16 a[32:33], v152 offset:8192
  ds_read_b64_tr_b16 a[34:35], v153 offset:8192
  ds_read_b64_tr_b16 a[36:37], v154 offset:8192
  ds_read_b64_tr_b16 a[38:39], v155 offset:8192
  ds_read_b64_tr_b16 a[40:41], v152 offset:8256
  ds_read_b64_tr_b16 a[42:43], v153 offset:8256
  ds_read_b64_tr_b16 a[44:45], v154 offset:8256
  ds_read_b64_tr_b16 a[46:47], v155 offset:8256
  s_waitcnt lgkmcnt(0)
  s_add_u32 m0, s28, 8192
  s_nop 0
  buffer_load_dwordx4 v144, s[8:11], s17 offen lds
  s_add_u32 s17, s17, s29
  s_add_u32 m0, s28, 9216
  s_nop 0
  buffer_load_dwordx4 v144, s[8:11], s17 offen lds
  s_add_u32 s17, s17, s29
  s_add_u32 m0, s28, 10240
  s_nop 0
  buffer_load_dwordx4 v144, s[8:11], s17 offen lds
  s_add_u32 s17, s17, s29
  s_add_u32 m0, s28, 11264
  s_nop 0
  buffer_load_dwordx4 v144, s[8:11], s17 offen lds
  s_add_u32 s17, s17, s29
  s_waitcnt vmcnt(28)
  ds_read_b64_tr_b16 a[48:49], v152 offset:12288
  ds_read_b64_tr_b16 a[50:51], v153 offset:12288
  ds_read_b64_tr_b16 a[52:53], v154 offset:12288
  ds_read_b64_tr_b16 a[54:55], v155 offset:12288
  ds_read_b64_tr_b16 a[56:57], v152 offset:12352
  ds_read_b64_tr_b16 a[58:59], v153 offset:12352
  ds_read_b64_tr_b16 a[60:61], v154 offset:12352
  ds_read_b64_tr_b16 a[62:63], v155 offset:12352
  s_waitcnt lgkmcnt(0)
  s_add_u32 m0, s28, 12288
  s_nop 0
  buffer_load_dwordx4 v144, s[8:11], s17 offen lds
  s_add_u32 s17, s17, s29
  s_add_u32 m0, s28, 13312
  s_nop 0
  buffer_load_dwordx4 v144, s[8:11], s17 offen lds
  s_add_u32 s17, s17, s29
  s_add_u32 m0, s28, 14336
  s_nop 0
  buffer_load_dwordx4 v144, s[8:11], s17 offen lds
  s_add_u32 s17, s17, s29
  s_add_u32 m0, s28, 15360
  s_nop 0
  buffer_load_dwordx4 v144, s[8:11], s17 offen lds
  s_add_u32 s17, s17, s29
  s_waitcnt vmcnt(28)
  ds_read_b64_tr_b16 a[64:65], v152 offset:16384
  ds_read_b64_tr_b16 a[66:67], v153 offset:16384
  ds_read_b64_tr_b16 a[68:69], v154 offset:16384
  ds_read_b64_tr_b16 a[70:71], v155 offset:16384
  ds_read_b64_tr_b16 a[72:73], v152 offset:16448
  ds_read_b64_tr_b16 a[74:75], v153 offset:16448
  ds_read_b64_tr_b16 a[76:77], v154 offset:16448
  ds_read_b64_tr_b16 a[78:79], v155 offset:16448
  s_waitcnt lgkmcnt(0)
  s_add_u32 m0, s28, 16384
  s_nop 0
  buffer_load_dwordx4 v144, s[8:11], s17 offen lds
  s_add_u32 s17, s17, s29
  s_add_u32 m0, s28, 17408
  s_nop 0
  buffer_load_dwordx4 v144, s[8:11], s17 offen lds
  s_add_u32 s17, s17, s29
  s_add_u32 m0, s28, 18432
  s_nop 0
  buffer_load_dwordx4 v144, s[8:11], s17 offen lds
  s_add_u32 s17, s17, s29
  s_add_u32 m0, s28, 19456
  s_nop 0
  buffer_load_dwordx4 v144, s[8:11], s17 offen lds
  s_add_u32 s17, s17, s29
  s_waitcnt vmcnt(28)
  ds_read_b64_tr_b16 a[80:81], v152 offset:20480
  ds_read_b64_tr_b16 a[82:83], v153 offset:20480
  ds_read_b64_tr_b16 a[84:85], v154 offset:20480
  ds_read_b64_tr_b16 a[86:87], v155 offset:20480
  ds_read_b64_tr_b16 a[88:89], v152 offset:20544
  ds_read_b64_tr_b16 a[90:91], v153 offset:20544
  ds_read_b64_tr_b16 a[92:93], v154 offset:20544
  ds_read_b64_tr_b16 a[94:95], v155 offset:20544
  s_waitcnt lgkmcnt(0)
  s_add_u32 m0, s28, 20480
  s_nop 0
  buffer_load_dwordx4 v144, s[8:11], s17 offen lds
  s_add_u32 s17, s17, s29
  s_add_u32 m0, s28, 21504
  s_nop 0
  buffer_load_dwordx4 v144, s[8:11], s17 offen lds
  s_add_u32 s17, s17, s29
  s_add_u32 m0, s28, 22528
  s_nop 0
  buffer_load_dwordx4 v144, s[8:11], s17 offen lds
  s_add_u32 s17, s17, s29
  s_add_u32 m0, s28, 23552
  s_nop 0
  buffer_load_dwordx4 v144, s[8:11], s17 offen lds
  s_add_u32 s17, s17, s29
  s_waitcnt vmcnt(28)
  ds_read_b64_tr_b16 a[96:97], v152 offset:24576
  ds_read_b64_tr_b16 a[98:99], v153 offset:24576
  ds_read_b64_tr_b16 a[100:101], v154 offset:24576
  ds_read_b64_tr_b16 a[102:103], v155 offset:24576
  ds_read_b64_tr_b16 a[104:105], v152 offset:24640
  ds_read_b64_tr_b16 a[106:107], v153 offset:24640
  ds_read_b64_tr_b16 a[108:109], v154 offset:24640
  ds_read_b64_tr_b16 a[110:111], v155 offset:24640
  s_waitcnt lgkmcnt(0)
  s_add_u32 m0, s28, 24576
  s_nop 0
  buffer_load_dwordx4 v144, s[8:11], s17 offen lds
  s_add_u32 s17, s17, s29
  s_add_u32 m0, s28, 25600
  s_nop 0
  buffer_load_dwordx4 v144, s[8:11], s17 offen lds
  s_add_u32 s17, s17, s29
  s_add_u32 m0, s28, 26624
  s_nop 0
  buffer_load_dwordx4 v144, s[8:11], s17 offen lds
  s_add_u32 s17, s17, s29
  s_add_u32 m0, s28, 27648
  s_nop 0
  buffer_load_dwordx4 v144, s[8:11], s17 offen lds
  s_add_u32 s17, s17, s29
  s_waitcnt vmcnt(28)
  ds_read_b64_tr_b16 a[112:113], v152 offset:28672
  ds_read_b64_tr_b16 a[114:115], v153 offset:28672
  ds_read_b64_tr_b16 a[116:117], v154 offset:28672
  ds_read_b64_tr_b16 a[118:119], v155 offset:28672
  ds_read_b64_tr_b16 a[120:121], v152 offset:28736
  ds_read_b64_tr_b16 a[122:123], v153 offset:28736
  ds_read_b64_tr_b16 a[124:125], v154 offset:28736
  ds_read_b64_tr_b16 a[126:127], v155 offset:28736
  s_waitcnt lgkmcnt(0)
  s_add_u32 m0, s28, 28672
  s_nop 0
  buffer_load_dwordx4 v144, s[8:11], s17 offen lds
  s_add_u32 s17, s17, s29
  s_add_u32 m0, s28, 29696
  s_nop 0
  buffer_load_dwordx4 v144, s[8:11], s17 offen lds
  s_add_u32 s17, s17, s29
  s_add_u32 m0, s28, 30720
  s_nop 0
  buffer_load_dwordx4 v144, s[8:11], s17 offen lds
  s_add_u32 s17, s17, s29
  s_add_u32 m0, s28, 31744
  s_nop 0
  buffer_load_dwordx4 v144, s[8:11], s17 offen lds
  s_add_u32 s17, s17, s29
  s_waitcnt vmcnt(28)
  ds_read_b64_tr_b16 a[128:129], v152 offset:0
  ds_read_b64_tr_b16 a[130:131], v153 offset:0
  ds_read_b64_tr_b16 a[132:133], v154 offset:0
  ds_read_b64_tr_b16 a[134:135], v155 offset:0
  ds_read_b64_tr_b16 a[136:137], v152 offset:64
  ds_read_b64_tr_b16 a[138:139], v153 offset:64
  ds_read_b64_tr_b16 a[140:141], v154 offset:64
  ds_read_b64_tr_b16 a[142:143], v155 offset:64
  s_waitcnt lgkmcnt(0)
  s_waitcnt vmcnt(24)
  ds_read_b64_tr_b16 a[144:145], v152 offset:4096
  ds_read_b64_tr_b16 a[146:147], v153 offset:4096
  ds_read_b64_tr_b16 a[148:149], v154 offset:4096
  ds_read_b64_tr_b16 a[150:151], v155 offset:4096
  ds_read_b64_tr_b16 a[152:153], v152 offset:4160
  ds_read_b64_tr_b16 a[154:155], v153 offset:4160
  ds_read_b64_tr_b16 a[156:157], v154 offset:4160
  ds_read_b64_tr_b16 a[158:159], v155 offset:4160
  s_waitcnt lgkmcnt(0)
  s_waitcnt vmcnt(20)
  ds_read_b64_tr_b16 a[160:161], v152 offset:8192
  ds_read_b64_tr_b16 a[162:163], v153 offset:8192
  ds_read_b64_tr_b16 a[164:165], v154 offset:8192
  ds_read_b64_tr_b16 a[166:167], v155 offset:8192
  ds_read_b64_tr_b16 a[168:169], v152 offset:8256
  ds_read_b64_tr_b16 a[170:171], v153 offset:8256
  ds_read_b64_tr_b16 a[172:173], v154 offset:8256
  ds_read_b64_tr_b16 a[174:175], v155 offset:8256
  s_waitcnt lgkmcnt(0)
  s_waitcnt vmcnt(16)
  ds_read_b64_tr_b16 a[176:177], v152 offset:12288
  ds_read_b64_tr_b16 a[178:179], v153 offset:12288
  ds_read_b64_tr_b16 a[180:181], v154 offset:12288
  ds_read_b64_tr_b16 a[182:183], v155 offset:12288
  ds_read_b64_tr_b16 a[184:185], v152 offset:12352
  ds_read_b64_tr_b16 a[186:187], v153 offset:12352
  ds_read_b64_tr_b16 a[188:189], v154 offset:12352
  ds_read_b64_tr_b16 a[190:191], v155 offset:12352
  s_waitcnt lgkmcnt(0)
  s_waitcnt vmcnt(12)
  ds_read_b64_tr_b16 a[192:193], v152 offset:16384
  ds_read_b64_tr_b16 a[194:195], v153 offset:16384
  ds_read_b64_tr_b16 a[196:197], v154 offset:16384
  ds_read_b64_tr_b16 a[198:199], v155 offset:16384
  ds_read_b64_tr_b16 a[200:201], v152 offset:16448
  ds_read_b64_tr_b16 a[202:203], v153 offset:16448
  ds_read_b64_tr_b16 a[204:205], v154 offset:16448
  ds_read_b64_tr_b16 a[206:207], v155 offset:16448
  s_waitcnt lgkmcnt(0)
  s_waitcnt vmcnt(8)
  ds_read_b64_tr_b16 a[208:209], v152 offset:20480
  ds_read_b64_tr_b16 a[210:211], v153 offset:20480
  ds_read_b64_tr_b16 a[212:213], v154 offset:20480
  ds_read_b64_tr_b16 a[214:215], v155 offset:20480
  ds_read_b64_tr_b16 a[216:217], v152 offset:20544
  ds_read_b64_tr_b16 a[218:219], v153 offset:20544
  ds_read_b64_tr_b16 a[220:221], v154 offset:20544
  ds_read_b64_tr_b16 a[222:223], v155 offset:20544
  s_waitcnt lgkmcnt(0)
  s_waitcnt vmcnt(4)
  ds_read_b64_tr_b16 a[224:225], v152 offset:24576
  ds_read_b64_tr_b16 a[226:227], v153 offset:24576
  ds_read_b64_tr_b16 a[228:229], v154 offset:24576
  ds_read_b64_tr_b16 a[230:231], v155 offset:24576
  ds_read_b64_tr_b16 a[232:233], v152 offset:24640
  ds_read_b64_tr_b16 a[234:235], v153 offset:24640
  ds_read_b64_tr_b16 a[236:237], v154 offset:24640
  ds_read_b64_tr_b16 a[238:239], v155 offset:24640
  s_waitcnt lgkmcnt(0)
  s_waitcnt vmcnt(0)
  ds_read_b64_tr_b16 a[240:241], v152 offset:28672
  ds_read_b64_tr_b16 a[242:243], v153 offset:28672
  ds_read_b64_tr_b16 a[244:245], v154 offset:28672
  ds_read_b64_tr_b16 a[246:247], v155 offset:28672
  ds_read_b64_tr_b16 a[248:249], v152 offset:28736
  ds_read_b64_tr_b16 a[250:251], v153 offset:28736
  ds_read_b64_tr_b16 a[252:253], v154 offset:28736
  ds_read_b64_tr_b16 a[254:255], v155 offset:28736
  s_waitcnt lgkmcnt(0)
  v_min_u32 v4, 27, v1
  v_mul_u32_u24 v5, 37, v4
  v_lshrrev_b32 v5, 8, v5
  v_mul_u32_u24 v5, 7, v5
  v_sub_u32 v5, v4, v5
  v_mov_b32 v6, 0x200
  v_cmp_ne_u32 vcc, 6, v5
  s_mul_i32 s76, s48, 3584
  s_add_u32 s76, s76, 148897792
  v_cndmask_b32 v5, 0, v6, vcc
  v_lshl_add_u32 v4, v4, 7, s76
  s_mov_b32 s71, 0
  s_branch M_vg_178
M_vw_177:
  s_sleep 2
  s_add_u32 s71, s71, 1
  s_cmp_gt_u32 s71, 262144
  s_cbranch_scc1 M_exit
M_vg_178:
  buffer_load_dword v6, v4, s[4:7], 0 offen sc1
  s_waitcnt vmcnt(0)
  v_cmp_lt_u32 vcc, v6, v5
  s_cbranch_vccnz M_vw_177
  s_barrier
  s_lshl_b32 s25, s16, 13
  s_add_u32 m0, s25, 0
  s_nop 0
  buffer_load_dwordx4 v16, s[12:15], s19 offen sc1 lds
  s_add_u32 m0, s25, 1024
  s_nop 0
  buffer_load_dwordx4 v17, s[12:15], s19 offen sc1 lds
  s_add_u32 m0, s25, 2048
  s_nop 0
  buffer_load_dwordx4 v18, s[12:15], s19 offen sc1 lds
  s_add_u32 m0, s25, 3072
  s_nop 0
  buffer_load_dwordx4 v19, s[12:15], s19 offen sc1 lds
  s_add_u32 m0, s25, 4096
  s_nop 0
  buffer_load_dwordx4 v20, s[12:15], s19 offen sc1 lds
  s_add_u32 m0, s25, 5120
  s_nop 0
  buffer_load_dwordx4 v21, s[12:15], s19 offen sc1 lds
  s_add_u32 m0, s25, 6144
  s_nop 0
  buffer_load_dwordx4 v22, s[12:15], s19 offen sc1 lds
  s_add_u32 m0, s25, 7168
  s_nop 0
  buffer_load_dwordx4 v23, s[12:15], s19 offen sc1 lds
  s_cmp_gt_u32 s23, 1
  s_cselect_b32 s26, s20, 0
  s_add_u32 s19, s19, s26
  s_add_u32 s25, s25, 32768
  s_and_b32 s25, s25, 0x1ffff
  s_add_u32 m0, s25, 0
  s_nop 0
  buffer_load_dwordx4 v16, s[12:15], s19 offen sc1 lds
  s_add_u32 m0, s25, 1024
  s_nop 0
  buffer_load_dwordx4 v17, s[12:15], s19 offen sc1 lds
  s_add_u32 m0, s25, 2048
  s_nop 0
  buffer_load_dwordx4 v18, s[12:15], s19 offen sc1 lds
  s_add_u32 m0, s25, 3072
  s_nop 0
  buffer_load_dwordx4 v19, s[12:15], s19 offen sc1 lds
  s_add_u32 m0, s25, 4096
  s_nop 0
  buffer_load_dwordx4 v20, s[12:15], s19 offen sc1 lds
  s_add_u32 m0, s25, 5120
  s_nop 0
  buffer_load_dwordx4 v21, s[12:15], s19 offen sc1 lds
  s_add_u32 m0, s25, 6144
  s_nop 0
  buffer_load_dwordx4 v22, s[12:15], s19 offen sc1 lds
  s_add_u32 m0, s25, 7168
  s_nop 0
  buffer_load_dwordx4 v23, s[12:15], s19 offen sc1 lds
  s_cmp_gt_u32 s23, 2
  s_cselect_b32 s26, s20, 0
  s_add_u32 s19, s19, s26
  s_add_u32 s25, s25, 32768
  s_and_b32 s25, s25, 0x1ffff
  s_waitcnt vmcnt(0)
  s_barrier
  s_mov_b32 s27, s21
  v_mov_b32 v7, 0x40000000
  ds_read_b128 v[24:27], v8 offset:0
  ds_read_b128 v[28:31], v9 offset:0
  ds_read_b128 v[32:35], v10 offset:0
  ds_read_b128 v[36:39], v11 offset:0
  ds_read_b128 v[40:43], v12 offset:0
  ds_read_b128 v[44:47], v13 offset:0
.p2align 6
G_top_179:
  s_waitcnt lgkmcnt(5)
  v_mfma_f32_16x16x32_bf16 v[64:67], a[0:3], v[24:27], 0
  s_add_u32 m0, s25, 0
  ds_read_b128 v[48:51], v14 offset:0
  v_mfma_f32_16x16x32_bf16 v[68:71], a[4:7], v[24:27], 0
  v_mfma_f32_16x16x32_bf16 v[80:83], a[8:11], v[24:27], 0
  buffer_load_dwordx4 v16, s[12:15], s19 offen sc1 lds
  v_mfma_f32_16x16x32_bf16 v[84:87], a[12:15], v[24:27], 0
  s_waitcnt lgkmcnt(5)
  v_mfma_f32_16x16x32_bf16 v[72:75], a[0:3], v[28:31], 0
  ds_read_b128 v[52:55], v15 offset:0
  v_mfma_f32_16x16x32_bf16 v[76:79], a[4:7], v[28:31], 0
  v_cvt_pk_bf16_f32 v128, v96, v97
  v_cvt_pk_bf16_f32 v129, v98, v99
  v_mfma_f32_16x16x32_bf16 v[88:91], a[8:11], v[28:31], 0
  v_mfma_f32_16x16x32_bf16 v[92:95], a[12:15], v[28:31], 0
  s_waitcnt lgkmcnt(5)
  v_cvt_pk_bf16_f32 v130, v100, v101
  v_cvt_pk_bf16_f32 v131, v102, v103
  v_mfma_f32_16x16x32_bf16 v[64:67], a[16:19], v[32:35], v[64:67]
  s_add_u32 m0, s25, 1024
  ds_read_b128 v[24:27], v8 offset:8192
  v_mfma_f32_16x16x32_bf16 v[68:71], a[20:23], v[32:35], v[68:71]
  v_mfma_f32_16x16x32_bf16 v[80:83], a[24:27], v[32:35], v[80:83]
  buffer_load_dwordx4 v17, s[12:15], s19 offen sc1 lds
  v_mfma_f32_16x16x32_bf16 v[84:87], a[28:31], v[32:35], v[84:87]
  s_waitcnt lgkmcnt(5)
  v_mfma_f32_16x16x32_bf16 v[72:75], a[16:19], v[36:39], v[72:75]
  ds_read_b128 v[28:31], v9 offset:8192
  v_mfma_f32_16x16x32_bf16 v[76:79], a[20:23], v[36:39], v[76:79]
  v_mfma_f32_16x16x32_bf16 v[88:91], a[24:27], v[36:39], v[88:91]
  v_mfma_f32_16x16x32_bf16 v[92:95], a[28:31], v[36:39], v[92:95]
  s_waitcnt lgkmcnt(5)
  v_mfma_f32_16x16x32_bf16 v[64:67], a[32:35], v[40:43], v[64:67]
  s_add_u32 m0, s25, 2048
  ds_read_b128 v[32:35], v10 offset:8192
  v_mfma_f32_16x16x32_bf16 v[68:71], a[36:39], v[40:43], v[68:71]
  v_cvt_pk_bf16_f32 v132, v104, v105
  v_cvt_pk_bf16_f32 v133, v106, v107
  v_mfma_f32_16x16x32_bf16 v[80:83], a[40:43], v[40:43], v[80:83]
  buffer_load_dwordx4 v18, s[12:15], s19 offen sc1 lds
  v_mfma_f32_16x16x32_bf16 v[84:87], a[44:47], v[40:43], v[84:87]
  s_waitcnt lgkmcnt(5)
  v_cvt_pk_bf16_f32 v134, v108, v109
  v_cvt_pk_bf16_f32 v135, v110, v111
  v_mfma_f32_16x16x32_bf16 v[72:75], a[32:35], v[44:47], v[72:75]
  ds_read_b128 v[36:39], v11 offset:8192
  v_mfma_f32_16x16x32_bf16 v[76:79], a[36:39], v[44:47], v[76:79]
  v_mfma_f32_16x16x32_bf16 v[88:91], a[40:43], v[44:47], v[88:91]
  v_mfma_f32_16x16x32_bf16 v[92:95], a[44:47], v[44:47], v[92:95]
  s_waitcnt lgkmcnt(5)
  v_mfma_f32_16x16x32_bf16 v[64:67], a[48:51], v[48:51], v[64:67]
  s_add_u32 m0, s25, 3072
  ds_read_b128 v[40:43], v12 offset:8192
  v_mfma_f32_16x16x32_bf16 v[68:71], a[52:55], v[48:51], v[68:71]
  v_mfma_f32_16x16x32_bf16 v[80:83], a[56:59], v[48:51], v[80:83]
  buffer_load_dwordx4 v19, s[12:15], s19 offen sc1 lds
  v_mfma_f32_16x16x32_bf16 v[84:87], a[60:63], v[48:51], v[84:87]
  s_waitcnt lgkmcnt(5)
  v_mfma_f32_16x16x32_bf16 v[72:75], a[48:51], v[52:55], v[72:75]
  ds_read_b128 v[44:47], v13 offset:8192
  v_mfma_f32_16x16x32_bf16 v[76:79], a[52:55], v[52:55], v[76:79]
  v_cvt_pk_bf16_f32 v136, v112, v113
  v_cvt_pk_bf16_f32 v137, v114, v115
  v_mfma_f32_16x16x32_bf16 v[88:91], a[56:59], v[52:55], v[88:91]
  v_mfma_f32_16x16x32_bf16 v[92:95], a[60:63], v[52:55], v[92:95]
  s_waitcnt lgkmcnt(5)
  v_cvt_pk_bf16_f32 v138, v116, v117
  v_cvt_pk_bf16_f32 v139, v118, v119
  v_mfma_f32_16x16x32_bf16 v[64:67], a[64:67], v[24:27], v[64:67]
  s_add_u32 m0, s25, 4096
  ds_read_b128 v[48:51], v14 offset:8192
  v_mfma_f32_16x16x32_bf16 v[68:71], a[68:71], v[24:27], v[68:71]
  v_mfma_f32_16x16x32_bf16 v[80:83], a[72:75], v[24:27], v[80:83]
  buffer_load_dwordx4 v20, s[12:15], s19 offen sc1 lds
  v_mfma_f32_16x16x32_bf16 v[84:87], a[76:79], v[24:27], v[84:87]
  s_waitcnt lgkmcnt(5)
  v_mfma_f32_16x16x32_bf16 v[72:75], a[64:67], v[28:31], v[72:75]
  ds_read_b128 v[52:55], v15 offset:8192
  v_mfma_f32_16x16x32_bf16 v[76:79], a[68:71], v[28:31], v[76:79]
  v_mfma_f32_16x16x32_bf16 v[88:91], a[72:75], v[28:31], v[88:91]
  v_mfma_f32_16x16x32_bf16 v[92:95], a[76:79], v[28:31], v[92:95]
  s_waitcnt lgkmcnt(5)
  v_mfma_f32_16x16x32_bf16 v[64:67], a[80:83], v[32:35], v[64:67]
  s_add_u32 m0, s25, 5120
  ds_read_b128 v[24:27], v8 offset:16384
  v_mfma_f32_16x16x32_bf16 v[68:71], a[84:87], v[32:35], v[68:71]
  v_cvt_pk_bf16_f32 v140, v120, v121
  v_cvt_pk_bf16_f32 v141, v122, v123
  v_mfma_f32_16x16x32_bf16 v[80:83], a[88:91], v[32:35], v[80:83]
  buffer_load_dwordx4 v21, s[12:15], s19 offen sc1 lds
  v_mfma_f32_16x16x32_bf16 v[84:87], a[92:95], v[32:35], v[84:87]
  s_waitcnt lgkmcnt(5)
  v_cvt_pk_bf16_f32 v142, v124, v125
  v_cvt_pk_bf16_f32 v143, v126, v127
  v_mfma_f32_16x16x32_bf16 v[72:75], a[80:83], v[36:39], v[72:75]
  ds_read_b128 v[28:31], v9 offset:16384
  v_mfma_f32_16x16x32_bf16 v[76:79], a[84:87], v[36:39], v[76:79]
  v_mfma_f32_16x16x32_bf16 v[88:91], a[88:91], v[36:39], v[88:91]
  v_mfma_f32_16x16x32_bf16 v[92:95], a[92:95], v[36:39], v[92:95]
  s_waitcnt lgkmcnt(5)
  v_mfma_f32_16x16x32_bf16 v[64:67], a[96:99], v[40:43], v[64:67]
  s_add_u32 m0, s25, 6144
  ds_read_b128 v[32:35], v10 offset:16384
  v_mfma_f32_16x16x32_bf16 v[68:71], a[100:103], v[40:43], v[68:71]
  v_mfma_f32_16x16x32_bf16 v[80:83], a[104:107], v[40:43], v[80:83]
  buffer_load_dwordx4 v22, s[12:15], s19 offen sc1 lds
  v_mfma_f32_16x16x32_bf16 v[84:87], a[108:111], v[40:43], v[84:87]
  s_waitcnt lgkmcnt(5)
  v_mfma_f32_16x16x32_bf16 v[72:75], a[96:99], v[44:47], v[72:75]
  ds_read_b128 v[36:39], v11 offset:16384
  v_mfma_f32_16x16x32_bf16 v[76:79], a[100:103], v[44:47], v[76:79]
  v_mfma_f32_16x16x32_bf16 v[88:91], a[104:107], v[44:47], v[88:91]
  v_mfma_f32_16x16x32_bf16 v[92:95], a[108:111], v[44:47], v[92:95]
  s_waitcnt lgkmcnt(5)
  v_mfma_f32_16x16x32_bf16 v[64:67], a[112:115], v[48:51], v[64:67]
  s_add_u32 m0, s25, 7168
  ds_read_b128 v[40:43], v12 offset:16384
  v_mfma_f32_16x16x32_bf16 v[68:71], a[116:119], v[48:51], v[68:71]
  v_mfma_f32_16x16x32_bf16 v[80:83], a[120:123], v[48:51], v[80:83]
  buffer_load_dwordx4 v23, s[12:15], s19 offen sc1 lds
  v_mfma_f32_16x16x32_bf16 v[84:87], a[124:127], v[48:51], v[84:87]
  s_waitcnt lgkmcnt(5)
  v_mfma_f32_16x16x32_bf16 v[72:75], a[112:115], v[52:55], v[72:75]
  s_cmp_gt_u32 s23, 3
  ds_read_b128 v[44:47], v13 offset:16384
  v_mfma_f32_16x16x32_bf16 v[76:79], a[116:119], v[52:55], v[76:79]
  v_mfma_f32_16x16x32_bf16 v[88:91], a[120:123], v[52:55], v[88:91]
  s_cselect_b32 s26, s20, 0
  v_mfma_f32_16x16x32_bf16 v[92:95], a[124:127], v[52:55], v[92:95]
  s_waitcnt lgkmcnt(5)
  v_mfma_f32_16x16x32_bf16 v[64:67], a[128:131], v[24:27], v[64:67]
  s_add_u32 s19, s19, s26
  ds_read_b128 v[48:51], v14 offset:16384
  v_mfma_f32_16x16x32_bf16 v[68:71], a[132:135], v[24:27], v[68:71]
  v_mfma_f32_16x16x32_bf16 v[80:83], a[136:139], v[24:27], v[80:83]
  s_add_u32 s25, s25, 32768
  v_mfma_f32_16x16x32_bf16 v[84:87], a[140:143], v[24:27], v[84:87]
  s_waitcnt lgkmcnt(5)
  v_mfma_f32_16x16x32_bf16 v[72:75], a[128:131], v[28:31], v[72:75]
  s_and_b32 s25, s25, 0x1ffff
  ds_read_b128 v[52:55], v15 offset:16384
  v_mfma_f32_16x16x32_bf16 v[76:79], a[132:135], v[28:31], v[76:79]
  v_mfma_f32_16x16x32_bf16 v[88:91], a[136:139], v[28:31], v[88:91]
  buffer_store_dwordx4 v[128:131], v7, s[4:7], s21 offen offset:0 sc1
  v_mfma_f32_16x16x32_bf16 v[92:95], a[140:143], v[28:31], v[92:95]
  s_waitcnt lgkmcnt(5)
  v_mfma_f32_16x16x32_bf16 v[64:67], a[144:147], v[32:35], v[64:67]
  ds_read_b128 v[24:27], v8 offset:24576
  v_mfma_f32_16x16x32_bf16 v[68:71], a[148:151], v[32:35], v[68:71]
  v_mfma_f32_16x16x32_bf16 v[80:83], a[152:155], v[32:35], v[80:83]
  v_mfma_f32_16x16x32_bf16 v[84:87], a[156:159], v[32:35], v[84:87]
  s_waitcnt lgkmcnt(5)
  v_mfma_f32_16x16x32_bf16 v[72:75], a[144:147], v[36:39], v[72:75]
  ds_read_b128 v[28:31], v9 offset:24576
  v_mfma_f32_16x16x32_bf16 v[76:79], a[148:151], v[36:39], v[76:79]
  v_mfma_f32_16x16x32_bf16 v[88:91], a[152:155], v[36:39], v[88:91]
  buffer_store_dwordx4 v[132:135], v7, s[4:7], s21 offen offset:256 sc1
  v_mfma_f32_16x16x32_bf16 v[92:95], a[156:159], v[36:39], v[92:95]
  s_waitcnt lgkmcnt(5)
  v_mfma_f32_16x16x32_bf16 v[64:67], a[160:163], v[40:43], v[64:67]
  ds_read_b128 v[32:35], v10 offset:24576
  v_mfma_f32_16x16x32_bf16 v[68:71], a[164:167], v[40:43], v[68:71]
  v_mfma_f32_16x16x32_bf16 v[80:83], a[168:171], v[40:43], v[80:83]
  v_mfma_f32_16x16x32_bf16 v[84:87], a[172:175], v[40:43], v[84:87]
  s_waitcnt lgkmcnt(5)
  v_mfma_f32_16x16x32_bf16 v[72:75], a[160:163], v[44:47], v[72:75]
  ds_read_b128 v[36:39], v11 offset:24576
  v_mfma_f32_16x16x32_bf16 v[76:79], a[164:167], v[44:47], v[76:79]
  v_mfma_f32_16x16x32_bf16 v[88:91], a[168:171], v[44:47], v[88:91]
  buffer_store_dwordx4 v[136:139], v7, s[4:7], s21 offen offset:2048 sc1
  v_mfma_f32_16x16x32_bf16 v[92:95], a[172:175], v[44:47], v[92:95]
  s_waitcnt lgkmcnt(5)
  v_mfma_f32_16x16x32_bf16 v[64:67], a[176:179], v[48:51], v[64:67]
  ds_read_b128 v[40:43], v12 offset:24576
  v_mfma_f32_16x16x32_bf16 v[68:71], a[180:183], v[48:51], v[68:71]
  v_mfma_f32_16x16x32_bf16 v[80:83], a[184:187], v[48:51], v[80:83]
  v_mfma_f32_16x16x32_bf16 v[84:87], a[188:191], v[48:51], v[84:87]
  s_waitcnt lgkmcnt(5)
  v_mfma_f32_16x16x32_bf16 v[72:75], a[176:179], v[52:55], v[72:75]
  ds_read_b128 v[44:47], v13 offset:24576
  v_mfma_f32_16x16x32_bf16 v[76:79], a[180:183], v[52:55], v[76:79]
  v_mfma_f32_16x16x32_bf16 v[88:91], a[184:187], v[52:55], v[88:91]
  buffer_store_dwordx4 v[140:143], v7, s[4:7], s21 offen offset:2304 sc1
  v_mfma_f32_16x16x32_bf16 v[92:95], a[188:191], v[52:55], v[92:95]
  s_waitcnt lgkmcnt(5)
  v_mfma_f32_16x16x32_bf16 v[64:67], a[192:195], v[24:27], v[64:67]
  s_mov_b32 s21, s27
  ds_read_b128 v[48:51], v14 offset:24576
  v_mfma_f32_16x16x32_bf16 v[68:71], a[196:199], v[24:27], v[68:71]
  v_mov_b32 v7, v56
  v_mfma_f32_16x16x32_bf16 v[80:83], a[200:203], v[24:27], v[80:83]
  v_mfma_f32_16x16x32_bf16 v[84:87], a[204:207], v[24:27], v[84:87]
  s_waitcnt lgkmcnt(5)
  v_mfma_f32_16x16x32_bf16 v[72:75], a[192:195], v[28:31], v[72:75]
  s_add_u32 s27, s27, s22
  ds_read_b128 v[52:55], v15 offset:24576
  v_mfma_f32_16x16x32_bf16 v[76:79], a[196:199], v[28:31], v[76:79]
  v_mfma_f32_16x16x32_bf16 v[88:91], a[200:203], v[28:31], v[88:91]
  s_waitcnt vmcnt(16)
  s_barrier
  v_mfma_f32_16x16x32_bf16 v[92:95], a[204:207], v[28:31], v[92:95]
  s_waitcnt lgkmcnt(5)
  v_mfma_f32_16x16x32_bf16 v[64:67], a[208:211], v[32:35], v[64:67]
  ds_read_b128 v[24:27], v8 offset:32768
  v_mfma_f32_16x16x32_bf16 v[68:71], a[212:215], v[32:35], v[68:71]
  v_mfma_f32_16x16x32_bf16 v[80:83], a[216:219], v[32:35], v[80:83]
  v_mfma_f32_16x16x32_bf16 v[84:87], a[220:223], v[32:35], v[84:87]
  s_waitcnt lgkmcnt(5)
  v_mfma_f32_16x16x32_bf16 v[72:75], a[208:211], v[36:39], v[72:75]
  ds_read_b128 v[28:31], v9 offset:32768
  v_mfma_f32_16x16x32_bf16 v[76:79], a[212:215], v[36:39], v[76:79]
  v_mfma_f32_16x16x32_bf16 v[88:91], a[216:219], v[36:39], v[88:91]
  v_mfma_f32_16x16x32_bf16 v[92:95], a[220:223], v[36:39], v[92:95]
  s_waitcnt lgkmcnt(5)
  v_mfma_f32_16x16x32_bf16 v[64:67], a[224:227], v[40:43], v[64:67]
  ds_read_b128 v[32:35], v10 offset:32768
  v_mfma_f32_16x16x32_bf16 v[68:71], a[228:231], v[40:43], v[68:71]
  v_mfma_f32_16x16x32_bf16 v[80:83], a[232:235], v[40:43], v[80:83]
  v_mfma_f32_16x16x32_bf16 v[84:87], a[236:239], v[40:43], v[84:87]
  s_waitcnt lgkmcnt(5)
  v_mfma_f32_16x16x32_bf16 v[72:75], a[224:227], v[44:47], v[72:75]
  ds_read_b128 v[36:39], v11 offset:32768
  v_mfma_f32_16x16x32_bf16 v[76:79], a[228:231], v[44:47], v[76:79]
  v_mfma_f32_16x16x32_bf16 v[88:91], a[232:235], v[44:47], v[88:91]
  v_mfma_f32_16x16x32_bf16 v[92:95], a[236:239], v[44:47], v[92:95]
  s_waitcnt lgkmcnt(5)
  v_mfma_f32_16x16x32_bf16 v[64:67], a[240:243], v[48:51], v[64:67]
  s_sub_u32 s23, s23, 1
  ds_read_b128 v[40:43], v12 offset:32768
  v_mfma_f32_16x16x32_bf16 v[68:71], a[244:247], v[48:51], v[68:71]
  v_mfma_f32_16x16x32_bf16 v[80:83], a[248:251], v[48:51], v[80:83]
  v_mfma_f32_16x16x32_bf16 v[84:87], a[252:255], v[48:51], v[84:87]
  s_waitcnt lgkmcnt(5)
  v_mfma_f32_16x16x32_bf16 v[72:75], a[240:243], v[52:55], v[72:75]
  s_cmp_eq_u32 s23, 0
  ds_read_b128 v[44:47], v13 offset:32768
  v_mfma_f32_16x16x32_bf16 v[76:79], a[244:247], v[52:55], v[76:79]
  v_mfma_f32_16x16x32_bf16 v[88:91], a[248:251], v[52:55], v[88:91]
  v_mfma_f32_16x16x32_bf16 v[92:95], a[252:255], v[52:55], v[92:95]
  s_cbranch_scc1 G_done0_180
  s_waitcnt lgkmcnt(5)
  v_mfma_f32_16x16x32_bf16 v[96:99], a[0:3], v[24:27], 0
  s_add_u32 m0, s25, 0
  ds_read_b128 v[48:51], v14 offset:32768
  v_mfma_f32_16x16x32_bf16 v[100:103], a[4:7], v[24:27], 0
  v_mfma_f32_16x16x32_bf16 v[112:115], a[8:11], v[24:27], 0
  buffer_load_dwordx4 v16, s[12:15], s19 offen sc1 lds
  v_mfma_f32_16x16x32_bf16 v[116:119], a[12:15], v[24:27], 0
  s_waitcnt lgkmcnt(5)
  v_mfma_f32_16x16x32_bf16 v[104:107], a[0:3], v[28:31], 0
  ds_read_b128 v[52:55], v15 offset:32768
  v_mfma_f32_16x16x32_bf16 v[108:111], a[4:7], v[28:31], 0
  v_cvt_pk_bf16_f32 v128, v64, v65
  v_cvt_pk_bf16_f32 v129, v66, v67
  v_mfma_f32_16x16x32_bf16 v[120:123], a[8:11], v[28:31], 0
  v_mfma_f32_16x16x32_bf16 v[124:127], a[12:15], v[28:31], 0
  s_waitcnt lgkmcnt(5)
  v_cvt_pk_bf16_f32 v130, v68, v69
  v_cvt_pk_bf16_f32 v131, v70, v71
  v_mfma_f32_16x16x32_bf16 v[96:99], a[16:19], v[32:35], v[96:99]
  s_add_u32 m0, s25, 1024
  ds_read_b128 v[24:27], v8 offset:40960
  v_mfma_f32_16x16x32_bf16 v[100:103], a[20:23], v[32:35], v[100:103]
  v_mfma_f32_16x16x32_bf16 v[112:115], a[24:27], v[32:35], v[112:115]
  buffer_load_dwordx4 v17, s[12:15], s19 offen sc1 lds
  v_mfma_f32_16x16x32_bf16 v[116:119], a[28:31], v[32:35], v[116:119]
  s_waitcnt lgkmcnt(5)
  v_mfma_f32_16x16x32_bf16 v[104:107], a[16:19], v[36:39], v[104:107]
  ds_read_b128 v[28:31], v9 offset:40960
  v_mfma_f32_16x16x32_bf16 v[108:111], a[20:23], v[36:39], v[108:111]
  v_mfma_f32_16x16x32_bf16 v[120:123], a[24:27], v[36:39], v[120:123]
  v_mfma_f32_16x16x32_bf16 v[124:127], a[28:31], v[36:39], v[124:127]
  s_waitcnt lgkmcnt(5)
  v_mfma_f32_16x16x32_bf16 v[96:99], a[32:35], v[40:43], v[96:99]
  s_add_u32 m0, s25, 2048
  ds_read_b128 v[32:35], v10 offset:40960
  v_mfma_f32_16x16x32_bf16 v[100:103], a[36:39], v[40:43], v[100:103]
  v_cvt_pk_bf16_f32 v132, v72, v73
  v_cvt_pk_bf16_f32 v133, v74, v75
  v_mfma_f32_16x16x32_bf16 v[112:115], a[40:43], v[40:43], v[112:115]
  buffer_load_dwordx4 v18, s[12:15], s19 offen sc1 lds
  v_mfma_f32_16x16x32_bf16 v[116:119], a[44:47], v[40:43], v[116:119]
  s_waitcnt lgkmcnt(5)
  v_cvt_pk_bf16_f32 v134, v76, v77
  v_cvt_pk_bf16_f32 v135, v78, v79
  v_mfma_f32_16x16x32_bf16 v[104:107], a[32:35], v[44:47], v[104:107]
  ds_read_b128 v[36:39], v11 offset:40960
  v_mfma_f32_16x16x32_bf16 v[108:111], a[36:39], v[44:47], v[108:111]
  v_mfma_f32_16x16x32_bf16 v[120:123], a[40:43], v[44:47], v[120:123]
  v_mfma_f32_16x16x32_bf16 v[124:127], a[44:47], v[44:47], v[124:127]
  s_waitcnt lgkmcnt(5)
  v_mfma_f32_16x16x32_bf16 v[96:99], a[48:51], v[48:51], v[96:99]
  s_add_u32 m0, s25, 3072
  ds_read_b128 v[40:43], v12 offset:40960
  v_mfma_f32_16x16x32_bf16 v[100:103], a[52:55], v[48:51], v[100:103]
  v_mfma_f32_16x16x32_bf16 v[112:115], a[56:59], v[48:51], v[112:115]
  buffer_load_dwordx4 v19, s[12:15], s19 offen sc1 lds
  v_mfma_f32_16x16x32_bf16 v[116:119], a[60:63], v[48:51], v[116:119]
  s_waitcnt lgkmcnt(5)
  v_mfma_f32_16x16x32_bf16 v[104:107], a[48:51], v[52:55], v[104:107]
  ds_read_b128 v[44:47], v13 offset:40960
  v_mfma_f32_16x16x32_bf16 v[108:111], a[52:55], v[52:55], v[108:111]
  v_cvt_pk_bf16_f32 v136, v80, v81
  v_cvt_pk_bf16_f32 v137, v82, v83
  v_mfma_f32_16x16x32_bf16 v[120:123], a[56:59], v[52:55], v[120:123]
  v_mfma_f32_16x16x32_bf16 v[124:127], a[60:63], v[52:55], v[124:127]
  s_waitcnt lgkmcnt(5)
  v_cvt_pk_bf16_f32 v138, v84, v85
  v_cvt_pk_bf16_f32 v139, v86, v87
  v_mfma_f32_16x16x32_bf16 v[96:99], a[64:67], v[24:27], v[96:99]
  s_add_u32 m0, s25, 4096
  ds_read_b128 v[48:51], v14 offset:40960
  v_mfma_f32_16x16x32_bf16 v[100:103], a[68:71], v[24:27], v[100:103]
  v_mfma_f32_16x16x32_bf16 v[112:115], a[72:75], v[24:27], v[112:115]
  buffer_load_dwordx4 v20, s[12:15], s19 offen sc1 lds
  v_mfma_f32_16x16x32_bf16 v[116:119], a[76:79], v[24:27], v[116:119]
  s_waitcnt lgkmcnt(5)
  v_mfma_f32_16x16x32_bf16 v[104:107], a[64:67], v[28:31], v[104:107]
  ds_read_b128 v[52:55], v15 offset:40960
  v_mfma_f32_16x16x32_bf16 v[108:111], a[68:71], v[28:31], v[108:111]
  v_mfma_f32_16x16x32_bf16 v[120:123], a[72:75], v[28:31], v[120:123]
  v_mfma_f32_16x16x32_bf16 v[124:127], a[76:79], v[28:31], v[124:127]
  s_waitcnt lgkmcnt(5)
  v_mfma_f32_16x16x32_bf16 v[96:99], a[80:83], v[32:35], v[96:99]
  s_add_u32 m0, s25, 5120
  ds_read_b128 v[24:27], v8 offset:49152
  v_mfma_f32_16x16x32_bf16 v[100:103], a[84:87], v[32:35], v[100:103]
  v_cvt_pk_bf16_f32 v140, v88, v89
  v_cvt_pk_bf16_f32 v141, v90, v91
  v_mfma_f32_16x16x32_bf16 v[112:115], a[88:91], v[32:35], v[112:115]
  buffer_load_dwordx4 v21, s[12:15], s19 offen sc1 lds
  v_mfma_f32_16x16x32_bf16 v[116:119], a[92:95], v[32:35], v[116:119]
  s_waitcnt lgkmcnt(5)
  v_cvt_pk_bf16_f32 v142, v92, v93
  v_cvt_pk_bf16_f32 v143, v94, v95
  v_mfma_f32_16x16x32_bf16 v[104:107], a[80:83], v[36:39], v[104:107]
  ds_read_b128 v[28:31], v9 offset:49152
  v_mfma_f32_16x16x32_bf16 v[108:111], a[84:87], v[36:39], v[108:111]
  v_mfma_f32_16x16x32_bf16 v[120:123], a[88:91], v[36:39], v[120:123]
  v_mfma_f32_16x16x32_bf16 v[124:127], a[92:95], v[36:39], v[124:127]
  s_waitcnt lgkmcnt(5)
  v_mfma_f32_16x16x32_bf16 v[96:99], a[96:99], v[40:43], v[96:99]
  s_add_u32 m0, s25, 6144
  ds_read_b128 v[32:35], v10 offset:49152
  v_mfma_f32_16x16x32_bf16 v[100:103], a[100:103], v[40:43], v[100:103]
  v_mfma_f32_16x16x32_bf16 v[112:115], a[104:107], v[40:43], v[112:115]
  buffer_load_dwordx4 v22, s[12:15], s19 offen sc1 lds
  v_mfma_f32_16x16x32_bf16 v[116:119], a[108:111], v[40:43], v[116:119]
  s_waitcnt lgkmcnt(5)
  v_mfma_f32_16x16x32_bf16 v[104:107], a[96:99], v[44:47], v[104:107]
  ds_read_b128 v[36:39], v11 offset:49152
  v_mfma_f32_16x16x32_bf16 v[108:111], a[100:103], v[44:47], v[108:111]
  v_mfma_f32_16x16x32_bf16 v[120:123], a[104:107], v[44:47], v[120:123]
  v_mfma_f32_16x16x32_bf16 v[124:127], a[108:111], v[44:47], v[124:127]
  s_waitcnt lgkmcnt(5)
  v_mfma_f32_16x16x32_bf16 v[96:99], a[112:115], v[48:51], v[96:99]
  s_add_u32 m0, s25, 7168
  ds_read_b128 v[40:43], v12 offset:49152
  v_mfma_f32_16x16x32_bf16 v[100:103], a[116:119], v[48:51], v[100:103]
  v_mfma_f32_16x16x32_bf16 v[112:115], a[120:123], v[48:51], v[112:115]
  buffer_load_dwordx4 v23, s[12:15], s19 offen sc1 lds
  v_mfma_f32_16x16x32_bf16 v[116:119], a[124:127], v[48:51], v[116:119]
  s_waitcnt lgkmcnt(5)
  v_mfma_f32_16x16x32_bf16 v[104:107], a[112:115], v[52:55], v[104:107]
  s_cmp_gt_u32 s23, 3
  ds_read_b128 v[44:47], v13 offset:49152
  v_mfma_f32_16x16x32_bf16 v[108:111], a[116:119], v[52:55], v[108:111]
  v_mfma_f32_16x16x32_bf16 v[120:123], a[120:123], v[52:55], v[120:123]
  s_cselect_b32 s26, s20, 0
  v_mfma_f32_16x16x32_bf16 v[124:127], a[124:127], v[52:55], v[124:127]
  s_waitcnt lgkmcnt(5)
  v_mfma_f32_16x16x32_bf16 v[96:99], a[128:131], v[24:27], v[96:99]
  s_add_u32 s19, s19, s26
  ds_read_b128 v[48:51], v14 offset:49152
  v_mfma_f32_16x16x32_bf16 v[100:103], a[132:135], v[24:27], v[100:103]
  v_mfma_f32_16x16x32_bf16 v[112:115], a[136:139], v[24:27], v[112:115]
  s_add_u32 s25, s25, 32768
  v_mfma_f32_16x16x32_bf16 v[116:119], a[140:143], v[24:27], v[116:119]
  s_waitcnt lgkmcnt(5)
  v_mfma_f32_16x16x32_bf16 v[104:107], a[128:131], v[28:31], v[104:107]
  s_and_b32 s25, s25, 0x1ffff
  ds_read_b128 v[52:55], v15 offset:49152
  v_mfma_f32_16x16x32_bf16 v[108:111], a[132:135], v[28:31], v[108:111]
  v_mfma_f32_16x16x32_bf16 v[120:123], a[136:139], v[28:31], v[120:123]
  buffer_store_dwordx4 v[128:131], v7, s[4:7], s21 offen offset:0 sc1
  v_mfma_f32_16x16x32_bf16 v[124:127], a[140:143], v[28:31], v[124:127]
  s_waitcnt lgkmcnt(5)
  v_mfma_f32_16x16x32_bf16 v[96:99], a[144:147], v[32:35], v[96:99]
  ds_read_b128 v[24:27], v8 offset:57344
  v_mfma_f32_16x16x32_bf16 v[100:103], a[148:151], v[32:35], v[100:103]
  v_mfma_f32_16x16x32_bf16 v[112:115], a[152:155], v[32:35], v[112:115]
  v_mfma_f32_16x16x32_bf16 v[116:119], a[156:159], v[32:35], v[116:119]
  s_waitcnt lgkmcnt(5)
  v_xor_b32 v8, 0x10000, v8
  v_mfma_f32_16x16x32_bf16 v[104:107], a[144:147], v[36:39], v[104:107]
  ds_read_b128 v[28:31], v9 offset:57344
  v_mfma_f32_16x16x32_bf16 v[108:111], a[148:151], v[36:39], v[108:111]
  v_mfma_f32_16x16x32_bf16 v[120:123], a[152:155], v[36:39], v[120:123]
  buffer_store_dwordx4 v[132:135], v7, s[4:7], s21 offen offset:256 sc1
  v_mfma_f32_16x16x32_bf16 v[124:127], a[156:159], v[36:39], v[124:127]
  s_waitcnt lgkmcnt(5)
  v_xor_b32 v9, 0x10000, v9
  v_mfma_f32_16x16x32_bf16 v[96:99], a[160:163], v[40:43], v[96:99]
  ds_read_b128 v[32:35], v10 offset:57344
  v_mfma_f32_16x16x32_bf16 v[100:103], a[164:167], v[40:43], v[100:103]
  v_mfma_f32_16x16x32_bf16 v[112:115], a[168:171], v[40:43], v[112:115]
  v_mfma_f32_16x16x32_bf16 v[116:119], a[172:175], v[40:43], v[116:119]
  s_waitcnt lgkmcnt(5)
  v_xor_b32 v10, 0x10000, v10
  v_mfma_f32_16x16x32_bf16 v[104:107], a[160:163], v[44:47], v[104:107]
  ds_read_b128 v[36:39], v11 offset:57344
  v_mfma_f32_16x16x32_bf16 v[108:111], a[164:167], v[44:47], v[108:111]
  v_mfma_f32_16x16x32_bf16 v[120:123], a[168:171], v[44:47], v[120:123]
  buffer_store_dwordx4 v[136:139], v7, s[4:7], s21 offen offset:2048 sc1
  v_mfma_f32_16x16x32_bf16 v[124:127], a[172:175], v[44:47], v[124:127]
  s_waitcnt lgkmcnt(5)
  v_xor_b32 v11, 0x10000, v11
  v_mfma_f32_16x16x32_bf16 v[96:99], a[176:179], v[48:51], v[96:99]
  ds_read_b128 v[40:43], v12 offset:57344
  v_mfma_f32_16x16x32_bf16 v[100:103], a[180:183], v[48:51], v[100:103]
  v_mfma_f32_16x16x32_bf16 v[112:115], a[184:187], v[48:51], v[112:115]
  v_mfma_f32_16x16x32_bf16 v[116:119], a[188:191], v[48:51], v[116:119]
  s_waitcnt lgkmcnt(5)
  v_xor_b32 v12, 0x10000, v12
  v_mfma_f32_16x16x32_bf16 v[104:107], a[176:179], v[52:55], v[104:107]
  ds_read_b128 v[44:47], v13 offset:57344
  v_mfma_f32_16x16x32_bf16 v[108:111], a[180:183], v[52:55], v[108:111]
  v_mfma_f32_16x16x32_bf16 v[120:123], a[184:187], v[52:55], v[120:123]
  buffer_store_dwordx4 v[140:143], v7, s[4:7], s21 offen offset:2304 sc1
  v_mfma_f32_16x16x32_bf16 v[124:127], a[188:191], v[52:55], v[124:127]
  s_waitcnt lgkmcnt(5)
  v_xor_b32 v13, 0x10000, v13
  v_mfma_f32_16x16x32_bf16 v[96:99], a[192:195], v[24:27], v[96:99]
  s_mov_b32 s21, s27
  ds_read_b128 v[48:51], v14 offset:57344
  v_mfma_f32_16x16x32_bf16 v[100:103], a[196:199], v[24:27], v[100:103]
  v_mov_b32 v7, v56
  v_mfma_f32_16x16x32_bf16 v[112:115], a[200:203], v[24:27], v[112:115]
  v_mfma_f32_16x16x32_bf16 v[116:119], a[204:207], v[24:27], v[116:119]
  s_waitcnt lgkmcnt(5)
  v_xor_b32 v14, 0x10000, v14
  v_mfma_f32_16x16x32_bf16 v[104:107], a[192:195], v[28:31], v[104:107]
  s_add_u32 s27, s27, s22
  ds_read_b128 v[52:55], v15 offset:57344
  v_mfma_f32_16x16x32_bf16 v[108:111], a[196:199], v[28:31], v[108:111]
  v_mfma_f32_16x16x32_bf16 v[120:123], a[200:203], v[28:31], v[120:123]
  s_waitcnt vmcnt(16)
  s_barrier
  v_mfma_f32_16x16x32_bf16 v[124:127], a[204:207], v[28:31], v[124:127]
  s_waitcnt lgkmcnt(5)
  v_xor_b32 v15, 0x10000, v15
  v_mfma_f32_16x16x32_bf16 v[96:99], a[208:211], v[32:35], v[96:99]
  ds_read_b128 v[24:27], v8 offset:0
  v_mfma_f32_16x16x32_bf16 v[100:103], a[212:215], v[32:35], v[100:103]
  v_mfma_f32_16x16x32_bf16 v[112:115], a[216:219], v[32:35], v[112:115]
  v_mfma_f32_16x16x32_bf16 v[116:119], a[220:223], v[32:35], v[116:119]
  s_waitcnt lgkmcnt(5)
  v_mfma_f32_16x16x32_bf16 v[104:107], a[208:211], v[36:39], v[104:107]
  ds_read_b128 v[28:31], v9 offset:0
  v_mfma_f32_16x16x32_bf16 v[108:111], a[212:215], v[36:39], v[108:111]
  v_mfma_f32_16x16x32_bf16 v[120:123], a[216:219], v[36:39], v[120:123]
  v_mfma_f32_16x16x32_bf16 v[124:127], a[220:223], v[36:39], v[124:127]
  s_waitcnt lgkmcnt(5)
  v_mfma_f32_16x16x32_bf16 v[96:99], a[224:227], v[40:43], v[96:99]
  ds_read_b128 v[32:35], v10 offset:0
  v_mfma_f32_16x16x32_bf16 v[100:103], a[228:231], v[40:43], v[100:103]
  v_mfma_f32_16x16x32_bf16 v[112:115], a[232:235], v[40:43], v[112:115]
  v_mfma_f32_16x16x32_bf16 v[116:119], a[236:239], v[40:43], v[116:119]
  s_waitcnt lgkmcnt(5)
  v_mfma_f32_16x16x32_bf16 v[104:107], a[224:227], v[44:47], v[104:107]
  ds_read_b128 v[36:39], v11 offset:0
  v_mfma_f32_16x16x32_bf16 v[108:111], a[228:231], v[44:47], v[108:111]
  v_mfma_f32_16x16x32_bf16 v[120:123], a[232:235], v[44:47], v[120:123]
  v_mfma_f32_16x16x32_bf16 v[124:127], a[236:239], v[44:47], v[124:127]
  s_waitcnt lgkmcnt(5)
  v_mfma_f32_16x16x32_bf16 v[96:99], a[240:243], v[48:51], v[96:99]
  s_sub_u32 s23, s23, 1
  ds_read_b128 v[40:43], v12 offset:0
  v_mfma_f32_16x16x32_bf16 v[100:103], a[244:247], v[48:51], v[100:103]
  v_mfma_f32_16x16x32_bf16 v[112:115], a[248:251], v[48:51], v[112:115]
  v_mfma_f32_16x16x32_bf16 v[116:119], a[252:255], v[48:51], v[116:119]
  s_waitcnt lgkmcnt(5)
  v_mfma_f32_16x16x32_bf16 v[104:107], a[240:243], v[52:55], v[104:107]
  s_cmp_eq_u32 s23, 0
  ds_read_b128 v[44:47], v13 offset:0
  v_mfma_f32_16x16x32_bf16 v[108:111], a[244:247], v[52:55], v[108:111]
  v_mfma_f32_16x16x32_bf16 v[120:123], a[248:251], v[52:55], v[120:123]
  v_mfma_f32_16x16x32_bf16 v[124:127], a[252:255], v[52:55], v[124:127]
  s_cbranch_scc1 G_done1_181
  s_branch G_top_179
G_done0_180:
  s_nop 7
  s_nop 3
  v_cvt_pk_bf16_f32 v128, v64, v65
  v_cvt_pk_bf16_f32 v129, v66, v67
  v_cvt_pk_bf16_f32 v130, v68, v69
  v_cvt_pk_bf16_f32 v131, v70, v71
  buffer_store_dwordx4 v[128:131], v7, s[4:7], s21 offen offset:0 sc1
  v_cvt_pk_bf16_f32 v132, v72, v73
  v_cvt_pk_bf16_f32 v133, v74, v75
  v_cvt_pk_bf16_f32 v134, v76, v77
  v_cvt_pk_bf16_f32 v135, v78, v79
  buffer_store_dwordx4 v[132:135], v7, s[4:7], s21 offen offset:256 sc1
  v_cvt_pk_bf16_f32 v136, v80, v81
  v_cvt_pk_bf16_f32 v137, v82, v83
  v_cvt_pk_bf16_f32 v138, v84, v85
  v_cvt_pk_bf16_f32 v139, v86, v87
  buffer_store_dwordx4 v[136:139], v7, s[4:7], s21 offen offset:2048 sc1
  v_cvt_pk_bf16_f32 v140, v88, v89
  v_cvt_pk_bf16_f32 v141, v90, v91
  v_cvt_pk_bf16_f32 v142, v92, v93
  v_cvt_pk_bf16_f32 v143, v94, v95
  buffer_store_dwordx4 v[140:143], v7, s[4:7], s21 offen offset:2304 sc1
  s_branch G_fin_182
G_done1_181:
  s_nop 7
  s_nop 3
  v_cvt_pk_bf16_f32 v128, v96, v97
  v_cvt_pk_bf16_f32 v129, v98, v99
  v_cvt_pk_bf16_f32 v130, v100, v101
  v_cvt_pk_bf16_f32 v131, v102, v103
  buffer_store_dwordx4 v[128:131], v7, s[4:7], s21 offen offset:0 sc1
  v_cvt_pk_bf16_f32 v132, v104, v105
  v_cvt_pk_bf16_f32 v133, v106, v107
  v_cvt_pk_bf16_f32 v134, v108, v109
  v_cvt_pk_bf16_f32 v135, v110, v111
  buffer_store_dwordx4 v[132:135], v7, s[4:7], s21 offen offset:256 sc1
  v_cvt_pk_bf16_f32 v136, v112, v113
  v_cvt_pk_bf16_f32 v137, v114, v115
  v_cvt_pk_bf16_f32 v138, v116, v117
  v_cvt_pk_bf16_f32 v139, v118, v119
  buffer_store_dwordx4 v[136:139], v7, s[4:7], s21 offen offset:2048 sc1
  v_cvt_pk_bf16_f32 v140, v120, v121
  v_cvt_pk_bf16_f32 v141, v122, v123
  v_cvt_pk_bf16_f32 v142, v124, v125
  v_cvt_pk_bf16_f32 v143, v126, v127
  buffer_store_dwordx4 v[140:143], v7, s[4:7], s21 offen offset:2304 sc1
G_fin_182:
  s_waitcnt vmcnt(0) lgkmcnt(0)
  s_barrier
  s_waitcnt vmcnt(0)
  s_barrier
  s_mov_b32 s30, 768
  v_mov_b32 v144, s30
  v_min_u32 v145, 1, v0
  v_lshlrev_b32 v145, 30, v145
  buffer_store_dword v144, v145, s[4:7], s31 offen sc1
  s_mul_i32 s50, s64, 6
  s_add_u32 s50, s50, s65
  s_mul_i32 s76, s50, 21846
  s_lshr_b32 s76, s76, 16
  s_mul_i32 s77, s76, 3
  s_add_u32 s51, s50, 64
  s_cmp_eq_u32 s77, s50
  s_cselect_b32 s50, s76, s51
M_fin:
  s_lshr_b32 s48, s50, 2
  s_and_b32 s49, s50, 3
  s_load_dwordx2 s[8:9], s[0:1], 0
  s_load_dwordx2 s[12:13], s[0:1], 104
  s_load_dwordx2 s[32:33], s[0:1], 112
  v_and_b32 v4, 31, v1
  v_lshrrev_b32 v5, 5, v1
  v_lshlrev_b32 v5, 4, v5
  v_lshl_add_u32 v6, v4, 10, v5
  s_lshl_b32 s26, s16, 8
  s_lshl_b32 s27, s48, 15
  s_add_u32 s27, s27, s26
  s_waitcnt lgkmcnt(0)
  s_and_b32 s9, s9, 0xffff
  s_mov_b32 s10, 2097152
  s_mov_b32 s11, 0x20000
  s_and_b32 s13, s13, 0xffff
  s_mov_b32 s14, 1024
  s_mov_b32 s15, 0x20000
  s_and_b32 s33, s33, 0xffff
  s_mov_b32 s34, 2097152
  s_mov_b32 s35, 0x20000
  buffer_load_dwordx4 v[16:19], v6, s[8:11], s27 offen offset:0
  buffer_load_dwordx4 v[48:51], v5, s[12:15], s26 offen offset:0
  buffer_load_dwordx4 v[20:23], v6, s[8:11], s27 offen offset:32
  buffer_load_dwordx4 v[52:55], v5, s[12:15], s26 offen offset:32
  buffer_load_dwordx4 v[24:27], v6, s[8:11], s27 offen offset:64
  buffer_load_dwordx4 v[56:59], v5, s[12:15], s26 offen offset:64
  buffer_load_dwordx4 v[28:31], v6, s[8:11], s27 offen offset:96
  buffer_load_dwordx4 v[60:63], v5, s[12:15], s26 offen offset:96
  buffer_load_dwordx4 v[32:35], v6, s[8:11], s27 offen offset:128
  buffer_load_dwordx4 v[64:67], v5, s[12:15], s26 offen offset:128
  buffer_load_dwordx4 v[36:39], v6, s[8:11], s27 offen offset:160
  buffer_load_dwordx4 v[68:71], v5, s[12:15], s26 offen offset:160
  buffer_load_dwordx4 v[40:43], v6, s[8:11], s27 offen offset:192
  buffer_load_dwordx4 v[72:75], v5, s[12:15], s26 offen offset:192
  buffer_load_dwordx4 v[44:47], v6, s[8:11], s27 offen offset:224
  buffer_load_dwordx4 v[76:79], v5, s[12:15], s26 offen offset:224
  s_lshl_b32 s28, s48, 2
  s_add_u32 s28, s28, s49
  s_lshl_b32 s28, s28, 2
  s_add_u32 s28, s28, s16
  s_lshl_b32 s28, s28, 11
  s_waitcnt vmcnt(14)
  v_mfma_f32_32x32x16_bf16 v[80:95], v[48:51], v[16:19], 0
  s_waitcnt vmcnt(12)
  v_mfma_f32_32x32x16_bf16 v[80:95], v[52:55], v[20:23], v[80:95]
  s_waitcnt vmcnt(10)
  v_mfma_f32_32x32x16_bf16 v[80:95], v[56:59], v[24:27], v[80:95]
  s_waitcnt vmcnt(8)
  v_mfma_f32_32x32x16_bf16 v[80:95], v[60:63], v[28:31], v[80:95]
  s_waitcnt vmcnt(6)
  v_mfma_f32_32x32x16_bf16 v[80:95], v[64:67], v[32:35], v[80:95]
  s_waitcnt vmcnt(4)
  v_mfma_f32_32x32x16_bf16 v[80:95], v[68:71], v[36:39], v[80:95]
  s_waitcnt vmcnt(2)
  v_mfma_f32_32x32x16_bf16 v[80:95], v[72:75], v[40:43], v[80:95]
  s_waitcnt vmcnt(0)
  v_mfma_f32_32x32x16_bf16 v[80:95], v[76:79], v[44:47], v[80:95]
  s_mul_i32 s76, s48, 43
  s_lshr_b32 s76, s76, 9
  s_mul_i32 s76, s76, 12
  s_sub_u32 s76, s48, s76
  s_cmp_ge_u32 s76, 6
  s_addc_u32 s76, s76, 0
  s_and_b32 s77, s49, 2
  s_mul_i32 s77, s77, 7
  s_add_u32 s76, s76, s77
  v_mov_b32 v193, 0x300
  s_lshl_b32 s76, s76, 7
  s_add_u32 s76, s76, 148897792
  v_and_b32 v192, 7, v1
  v_mul_u32_u24 v192, 3584, v192
  v_add_u32 v192, s76, v192
  s_mov_b32 s71, 0
  s_branch M_vg_184
M_vw_183:
  s_sleep 2
  s_add_u32 s71, s71, 1
  s_cmp_gt_u32 s71, 262144
  s_cbranch_scc1 M_exit
M_vg_184:
  buffer_load_dword v194, v192, s[4:7], 0 offen sc1
  s_waitcnt vmcnt(0)
  v_cmp_lt_u32 vcc, v194, v193
  s_cbranch_vccnz M_vw_183
  s_add_u32 s29, s28, 150994944
  buffer_load_dwordx4 v[96:99], v2, s[4:7], s29 offen offset:0 sc1
  buffer_load_dwordx4 v[100:103], v2, s[4:7], s29 offen offset:1024 sc1
  s_add_u32 s29, s28, 153092096
  buffer_load_dwordx4 v[104:107], v2, s[4:7], s29 offen offset:0 sc1
  buffer_load_dwordx4 v[108:111], v2, s[4:7], s29 offen offset:1024 sc1
  s_add_u32 s29, s28, 155189248
  buffer_load_dwordx4 v[112:115], v2, s[4:7], s29 offen offset:0 sc1
  buffer_load_dwordx4 v[116:119], v2, s[4:7], s29 offen offset:1024 sc1
  s_add_u32 s29, s28, 157286400
  buffer_load_dwordx4 v[120:123], v2, s[4:7], s29 offen offset:0 sc1
  buffer_load_dwordx4 v[124:127], v2, s[4:7], s29 offen offset:1024 sc1
  s_add_u32 s29, s28, 159383552
  buffer_load_dwordx4 v[128:131], v2, s[4:7], s29 offen offset:0 sc1
  buffer_load_dwordx4 v[132:135], v2, s[4:7], s29 offen offset:1024 sc1
  s_add_u32 s29, s28, 161480704
  buffer_load_dwordx4 v[136:139], v2, s[4:7], s29 offen offset:0 sc1
  buffer_load_dwordx4 v[140:143], v2, s[4:7], s29 offen offset:1024 sc1
  s_add_u32 s29, s28, 163577856
  buffer_load_dwordx4 v[144:147], v2, s[4:7], s29 offen offset:0 sc1
  buffer_load_dwordx4 v[148:151], v2, s[4:7], s29 offen offset:1024 sc1
  s_add_u32 s29, s28, 165675008
  buffer_load_dwordx4 v[152:155], v2, s[4:7], s29 offen offset:0 sc1
  buffer_load_dwordx4 v[156:159], v2, s[4:7], s29 offen offset:1024 sc1
  v_lshlrev_b32 v7, 4, v4
  s_lshl_b32 s26, s16, 2
  v_add_u32 v4, s26, v7
  s_barrier
  ds_write_b32 v4, v80
  s_waitcnt lgkmcnt(0)
  s_barrier
  ds_read_b128 v[84:87], v7
  s_waitcnt lgkmcnt(0)
  v_add_f32 v80, v84, v85
  v_add_f32 v81, v86, v87
  v_add_f32 v80, v80, v81
  v_mul_f32 v80, 0xbfb8aa3b, v80
  v_exp_f32 v80, v80
  s_nop 0
  v_add_f32 v80, 1.0, v80
  v_rcp_f32 v80, v80
  s_nop 0
  v_sub_f32 v82, 1.0, v80
  s_waitcnt vmcnt(14)
  v_lshlrev_b32 v160, 16, v96
  v_and_b32 v161, 0xffff0000, v96
  v_lshlrev_b32 v162, 16, v97
  v_and_b32 v163, 0xffff0000, v97
  v_lshlrev_b32 v164, 16, v98
  v_and_b32 v165, 0xffff0000, v98
  v_lshlrev_b32 v166, 16, v99
  v_and_b32 v167, 0xffff0000, v99
  v_lshlrev_b32 v168, 16, v100
  v_and_b32 v169, 0xffff0000, v100
  v_lshlrev_b32 v170, 16, v101
  v_and_b32 v171, 0xffff0000, v101
  v_lshlrev_b32 v172, 16, v102
  v_and_b32 v173, 0xffff0000, v102
  v_lshlrev_b32 v174, 16, v103
  v_and_b32 v175, 0xffff0000, v103
  s_waitcnt vmcnt(12)
  v_lshlrev_b32 v8, 16, v104
  v_and_b32 v9, 0xffff0000, v104
  v_pk_add_f32 v[160:161], v[160:161], v[8:9]
  v_lshlrev_b32 v10, 16, v105
  v_and_b32 v11, 0xffff0000, v105
  v_pk_add_f32 v[162:163], v[162:163], v[10:11]
  v_lshlrev_b32 v12, 16, v106
  v_and_b32 v13, 0xffff0000, v106
  v_pk_add_f32 v[164:165], v[164:165], v[12:13]
  v_lshlrev_b32 v14, 16, v107
  v_and_b32 v15, 0xffff0000, v107
  v_pk_add_f32 v[166:167], v[166:167], v[14:15]
  v_lshlrev_b32 v8, 16, v108
  v_and_b32 v9, 0xffff0000, v108
  v_pk_add_f32 v[168:169], v[168:169], v[8:9]
  v_lshlrev_b32 v10, 16, v109
  v_and_b32 v11, 0xffff0000, v109
  v_pk_add_f32 v[170:171], v[170:171], v[10:11]
  v_lshlrev_b32 v12, 16, v110
  v_and_b32 v13, 0xffff0000, v110
  v_pk_add_f32 v[172:173], v[172:173], v[12:13]
  v_lshlrev_b32 v14, 16, v111
  v_and_b32 v15, 0xffff0000, v111
  v_pk_add_f32 v[174:175], v[174:175], v[14:15]
  s_waitcnt vmcnt(10)
  v_lshlrev_b32 v8, 16, v112
  v_and_b32 v9, 0xffff0000, v112
  v_pk_add_f32 v[160:161], v[160:161], v[8:9]
  v_lshlrev_b32 v10, 16, v113
  v_and_b32 v11, 0xffff0000, v113
  v_pk_add_f32 v[162:163], v[162:163], v[10:11]
  v_lshlrev_b32 v12, 16, v114
  v_and_b32 v13, 0xffff0000, v114
  v_pk_add_f32 v[164:165], v[164:165], v[12:13]
  v_lshlrev_b32 v14, 16, v115
  v_and_b32 v15, 0xffff0000, v115
  v_pk_add_f32 v[166:167], v[166:167], v[14:15]
  v_lshlrev_b32 v8, 16, v116
  v_and_b32 v9, 0xffff0000, v116
  v_pk_add_f32 v[168:169], v[168:169], v[8:9]
  v_lshlrev_b32 v10, 16, v117
  v_and_b32 v11, 0xffff0000, v117
  v_pk_add_f32 v[170:171], v[170:171], v[10:11]
  v_lshlrev_b32 v12, 16, v118
  v_and_b32 v13, 0xffff0000, v118
  v_pk_add_f32 v[172:173], v[172:173], v[12:13]
  v_lshlrev_b32 v14, 16, v119
  v_and_b32 v15, 0xffff0000, v119
  v_pk_add_f32 v[174:175], v[174:175], v[14:15]
  s_waitcnt vmcnt(8)
  v_lshlrev_b32 v8, 16, v120
  v_and_b32 v9, 0xffff0000, v120
  v_pk_add_f32 v[160:161], v[160:161], v[8:9]
  v_lshlrev_b32 v10, 16, v121
  v_and_b32 v11, 0xffff0000, v121
  v_pk_add_f32 v[162:163], v[162:163], v[10:11]
  v_lshlrev_b32 v12, 16, v122
  v_and_b32 v13, 0xffff0000, v122
  v_pk_add_f32 v[164:165], v[164:165], v[12:13]
  v_lshlrev_b32 v14, 16, v123
  v_and_b32 v15, 0xffff0000, v123
  v_pk_add_f32 v[166:167], v[166:167], v[14:15]
  v_lshlrev_b32 v8, 16, v124
  v_and_b32 v9, 0xffff0000, v124
  v_pk_add_f32 v[168:169], v[168:169], v[8:9]
  v_lshlrev_b32 v10, 16, v125
  v_and_b32 v11, 0xffff0000, v125
  v_pk_add_f32 v[170:171], v[170:171], v[10:11]
  v_lshlrev_b32 v12, 16, v126
  v_and_b32 v13, 0xffff0000, v126
  v_pk_add_f32 v[172:173], v[172:173], v[12:13]
  v_lshlrev_b32 v14, 16, v127
  v_and_b32 v15, 0xffff0000, v127
  v_pk_add_f32 v[174:175], v[174:175], v[14:15]
  s_waitcnt vmcnt(6)
  v_lshlrev_b32 v8, 16, v128
  v_and_b32 v9, 0xffff0000, v128
  v_pk_add_f32 v[160:161], v[160:161], v[8:9]
  v_lshlrev_b32 v10, 16, v129
  v_and_b32 v11, 0xffff0000, v129
  v_pk_add_f32 v[162:163], v[162:163], v[10:11]
  v_lshlrev_b32 v12, 16, v130
  v_and_b32 v13, 0xffff0000, v130
  v_pk_add_f32 v[164:165], v[164:165], v[12:13]
  v_lshlrev_b32 v14, 16, v131
  v_and_b32 v15, 0xffff0000, v131
  v_pk_add_f32 v[166:167], v[166:167], v[14:15]
  v_lshlrev_b32 v8, 16, v132
  v_and_b32 v9, 0xffff0000, v132
  v_pk_add_f32 v[168:169], v[168:169], v[8:9]
  v_lshlrev_b32 v10, 16, v133
  v_and_b32 v11, 0xffff0000, v133
  v_pk_add_f32 v[170:171], v[170:171], v[10:11]
  v_lshlrev_b32 v12, 16, v134
  v_and_b32 v13, 0xffff0000, v134
  v_pk_add_f32 v[172:173], v[172:173], v[12:13]
  v_lshlrev_b32 v14, 16, v135
  v_and_b32 v15, 0xffff0000, v135
  v_pk_add_f32 v[174:175], v[174:175], v[14:15]
  s_waitcnt vmcnt(4)
  v_lshlrev_b32 v8, 16, v136
  v_and_b32 v9, 0xffff0000, v136
  v_pk_add_f32 v[160:161], v[160:161], v[8:9]
  v_lshlrev_b32 v10, 16, v137
  v_and_b32 v11, 0xffff0000, v137
  v_pk_add_f32 v[162:163], v[162:163], v[10:11]
  v_lshlrev_b32 v12, 16, v138
  v_and_b32 v13, 0xffff0000, v138
  v_pk_add_f32 v[164:165], v[164:165], v[12:13]
  v_lshlrev_b32 v14, 16, v139
  v_and_b32 v15, 0xffff0000, v139
  v_pk_add_f32 v[166:167], v[166:167], v[14:15]
  v_lshlrev_b32 v8, 16, v140
  v_and_b32 v9, 0xffff0000, v140
  v_pk_add_f32 v[168:169], v[168:169], v[8:9]
  v_lshlrev_b32 v10, 16, v141
  v_and_b32 v11, 0xffff0000, v141
  v_pk_add_f32 v[170:171], v[170:171], v[10:11]
  v_lshlrev_b32 v12, 16, v142
  v_and_b32 v13, 0xffff0000, v142
  v_pk_add_f32 v[172:173], v[172:173], v[12:13]
  v_lshlrev_b32 v14, 16, v143
  v_and_b32 v15, 0xffff0000, v143
  v_pk_add_f32 v[174:175], v[174:175], v[14:15]
  s_waitcnt vmcnt(2)
  v_lshlrev_b32 v8, 16, v144
  v_and_b32 v9, 0xffff0000, v144
  v_pk_add_f32 v[160:161], v[160:161], v[8:9]
  v_lshlrev_b32 v10, 16, v145
  v_and_b32 v11, 0xffff0000, v145
  v_pk_add_f32 v[162:163], v[162:163], v[10:11]
  v_lshlrev_b32 v12, 16, v146
  v_and_b32 v13, 0xffff0000, v146
  v_pk_add_f32 v[164:165], v[164:165], v[12:13]
  v_lshlrev_b32 v14, 16, v147
  v_and_b32 v15, 0xffff0000, v147
  v_pk_add_f32 v[166:167], v[166:167], v[14:15]
  v_lshlrev_b32 v8, 16, v148
  v_and_b32 v9, 0xffff0000, v148
  v_pk_add_f32 v[168:169], v[168:169], v[8:9]
  v_lshlrev_b32 v10, 16, v149
  v_and_b32 v11, 0xffff0000, v149
  v_pk_add_f32 v[170:171], v[170:171], v[10:11]
  v_lshlrev_b32 v12, 16, v150
  v_and_b32 v13, 0xffff0000, v150
  v_pk_add_f32 v[172:173], v[172:173], v[12:13]
  v_lshlrev_b32 v14, 16, v151
  v_and_b32 v15, 0xffff0000, v151
  v_pk_add_f32 v[174:175], v[174:175], v[14:15]
  s_waitcnt vmcnt(0)
  v_lshlrev_b32 v8, 16, v152
  v_and_b32 v9, 0xffff0000, v152
  v_pk_add_f32 v[160:161], v[160:161], v[8:9]
  v_lshlrev_b32 v10, 16, v153
  v_and_b32 v11, 0xffff0000, v153
  v_pk_add_f32 v[162:163], v[162:163], v[10:11]
  v_lshlrev_b32 v12, 16, v154
  v_and_b32 v13, 0xffff0000, v154
  v_pk_add_f32 v[164:165], v[164:165], v[12:13]
  v_lshlrev_b32 v14, 16, v155
  v_and_b32 v15, 0xffff0000, v155
  v_pk_add_f32 v[166:167], v[166:167], v[14:15]
  v_lshlrev_b32 v8, 16, v156
  v_and_b32 v9, 0xffff0000, v156
  v_pk_add_f32 v[168:169], v[168:169], v[8:9]
  v_lshlrev_b32 v10, 16, v157
  v_and_b32 v11, 0xffff0000, v157
  v_pk_add_f32 v[170:171], v[170:171], v[10:11]
  v_lshlrev_b32 v12, 16, v158
  v_and_b32 v13, 0xffff0000, v158
  v_pk_add_f32 v[172:173], v[172:173], v[12:13]
  v_lshlrev_b32 v14, 16, v159
  v_and_b32 v15, 0xffff0000, v159
  v_pk_add_f32 v[174:175], v[174:175], v[14:15]
  s_and_b32 s76, s48, 1
  s_lshl_b32 s76, s76, 1
  s_lshr_b32 s77, s49, 1
  s_add_u32 s76, s76, s77
  s_mul_i32 s76, s76, 7
  s_add_u32 s76, s76, 6
  s_lshr_b32 s77, s48, 1
  s_add_u32 s77, s77, 0x201
  v_mov_b32 v193, s77
  s_lshl_b32 s76, s76, 7
  s_add_u32 s76, s76, 148897792
  v_and_b32 v192, 7, v1
  v_mul_u32_u24 v192, 3584, v192
  v_add_u32 v192, s76, v192
  s_mov_b32 s71, 0
  s_branch M_vg_186
M_vw_185:
  s_sleep 2
  s_add_u32 s71, s71, 1
  s_cmp_gt_u32 s71, 262144
  s_cbranch_scc1 M_exit
M_vg_186:
  buffer_load_dword v194, v192, s[4:7], 0 offen sc1
  s_waitcnt vmcnt(0)
  v_cmp_lt_u32 vcc, v194, v193
  s_cbranch_vccnz M_vw_185
  s_add_u32 s29, s28, 167772160
  buffer_load_dwordx4 v[96:99], v2, s[4:7], s29 offen offset:0 sc1
  buffer_load_dwordx4 v[100:103], v2, s[4:7], s29 offen offset:1024 sc1
  s_add_u32 s29, s28, 169869312
  buffer_load_dwordx4 v[104:107], v2, s[4:7], s29 offen offset:0 sc1
  buffer_load_dwordx4 v[108:111], v2, s[4:7], s29 offen offset:1024 sc1
  s_add_u32 s29, s28, 171966464
  buffer_load_dwordx4 v[112:115], v2, s[4:7], s29 offen offset:0 sc1
  buffer_load_dwordx4 v[116:119], v2, s[4:7], s29 offen offset:1024 sc1
  s_add_u32 s29, s28, 174063616
  buffer_load_dwordx4 v[120:123], v2, s[4:7], s29 offen offset:0 sc1
  buffer_load_dwordx4 v[124:127], v2, s[4:7], s29 offen offset:1024 sc1
  s_add_u32 s29, s28, 176160768
  buffer_load_dwordx4 v[128:131], v2, s[4:7], s29 offen offset:0 sc1
  buffer_load_dwordx4 v[132:135], v2, s[4:7], s29 offen offset:1024 sc1
  s_add_u32 s29, s28, 178257920
  buffer_load_dwordx4 v[136:139], v2, s[4:7], s29 offen offset:0 sc1
  buffer_load_dwordx4 v[140:143], v2, s[4:7], s29 offen offset:1024 sc1
  s_add_u32 s29, s28, 180355072
  buffer_load_dwordx4 v[144:147], v2, s[4:7], s29 offen offset:0 sc1
  buffer_load_dwordx4 v[148:151], v2, s[4:7], s29 offen offset:1024 sc1
  s_add_u32 s29, s28, 182452224
  buffer_load_dwordx4 v[152:155], v2, s[4:7], s29 offen offset:0 sc1
  buffer_load_dwordx4 v[156:159], v2, s[4:7], s29 offen offset:1024 sc1
  v_pk_mul_f32 v[160:161], v[160:161], v[80:81] op_sel_hi:[1,0]
  v_pk_mul_f32 v[162:163], v[162:163], v[80:81] op_sel_hi:[1,0]
  v_pk_mul_f32 v[164:165], v[164:165], v[80:81] op_sel_hi:[1,0]
  v_pk_mul_f32 v[166:167], v[166:167], v[80:81] op_sel_hi:[1,0]
  v_pk_mul_f32 v[168:169], v[168:169], v[80:81] op_sel_hi:[1,0]
  v_pk_mul_f32 v[170:171], v[170:171], v[80:81] op_sel_hi:[1,0]
  v_pk_mul_f32 v[172:173], v[172:173], v[80:81] op_sel_hi:[1,0]
  v_pk_mul_f32 v[174:175], v[174:175], v[80:81] op_sel_hi:[1,0]
  s_waitcnt vmcnt(14)
  v_lshlrev_b32 v176, 16, v96
  v_and_b32 v177, 0xffff0000, v96
  v_lshlrev_b32 v178, 16, v97
  v_and_b32 v179, 0xffff0000, v97
  v_lshlrev_b32 v180, 16, v98
  v_and_b32 v181, 0xffff0000, v98
  v_lshlrev_b32 v182, 16, v99
  v_and_b32 v183, 0xffff0000, v99
  v_lshlrev_b32 v184, 16, v100
  v_and_b32 v185, 0xffff0000, v100
  v_lshlrev_b32 v186, 16, v101
  v_and_b32 v187, 0xffff0000, v101
  v_lshlrev_b32 v188, 16, v102
  v_and_b32 v189, 0xffff0000, v102
  v_lshlrev_b32 v190, 16, v103
  v_and_b32 v191, 0xffff0000, v103
  s_waitcnt vmcnt(12)
  v_lshlrev_b32 v8, 16, v104
  v_and_b32 v9, 0xffff0000, v104
  v_pk_add_f32 v[176:177], v[176:177], v[8:9]
  v_lshlrev_b32 v10, 16, v105
  v_and_b32 v11, 0xffff0000, v105
  v_pk_add_f32 v[178:179], v[178:179], v[10:11]
  v_lshlrev_b32 v12, 16, v106
  v_and_b32 v13, 0xffff0000, v106
  v_pk_add_f32 v[180:181], v[180:181], v[12:13]
  v_lshlrev_b32 v14, 16, v107
  v_and_b32 v15, 0xffff0000, v107
  v_pk_add_f32 v[182:183], v[182:183], v[14:15]
  v_lshlrev_b32 v8, 16, v108
  v_and_b32 v9, 0xffff0000, v108
  v_pk_add_f32 v[184:185], v[184:185], v[8:9]
  v_lshlrev_b32 v10, 16, v109
  v_and_b32 v11, 0xffff0000, v109
  v_pk_add_f32 v[186:187], v[186:187], v[10:11]
  v_lshlrev_b32 v12, 16, v110
  v_and_b32 v13, 0xffff0000, v110
  v_pk_add_f32 v[188:189], v[188:189], v[12:13]
  v_lshlrev_b32 v14, 16, v111
  v_and_b32 v15, 0xffff0000, v111
  v_pk_add_f32 v[190:191], v[190:191], v[14:15]
  s_waitcnt vmcnt(10)
  v_lshlrev_b32 v8, 16, v112
  v_and_b32 v9, 0xffff0000, v112
  v_pk_add_f32 v[176:177], v[176:177], v[8:9]
  v_lshlrev_b32 v10, 16, v113
  v_and_b32 v11, 0xffff0000, v113
  v_pk_add_f32 v[178:179], v[178:179], v[10:11]
  v_lshlrev_b32 v12, 16, v114
  v_and_b32 v13, 0xffff0000, v114
  v_pk_add_f32 v[180:181], v[180:181], v[12:13]
  v_lshlrev_b32 v14, 16, v115
  v_and_b32 v15, 0xffff0000, v115
  v_pk_add_f32 v[182:183], v[182:183], v[14:15]
  v_lshlrev_b32 v8, 16, v116
  v_and_b32 v9, 0xffff0000, v116
  v_pk_add_f32 v[184:185], v[184:185], v[8:9]
  v_lshlrev_b32 v10, 16, v117
  v_and_b32 v11, 0xffff0000, v117
  v_pk_add_f32 v[186:187], v[186:187], v[10:11]
  v_lshlrev_b32 v12, 16, v118
  v_and_b32 v13, 0xffff0000, v118
  v_pk_add_f32 v[188:189], v[188:189], v[12:13]
  v_lshlrev_b32 v14, 16, v119
  v_and_b32 v15, 0xffff0000, v119
  v_pk_add_f32 v[190:191], v[190:191], v[14:15]
  s_waitcnt vmcnt(8)
  v_lshlrev_b32 v8, 16, v120
  v_and_b32 v9, 0xffff0000, v120
  v_pk_add_f32 v[176:177], v[176:177], v[8:9]
  v_lshlrev_b32 v10, 16, v121
  v_and_b32 v11, 0xffff0000, v121
  v_pk_add_f32 v[178:179], v[178:179], v[10:11]
  v_lshlrev_b32 v12, 16, v122
  v_and_b32 v13, 0xffff0000, v122
  v_pk_add_f32 v[180:181], v[180:181], v[12:13]
  v_lshlrev_b32 v14, 16, v123
  v_and_b32 v15, 0xffff0000, v123
  v_pk_add_f32 v[182:183], v[182:183], v[14:15]
  v_lshlrev_b32 v8, 16, v124
  v_and_b32 v9, 0xffff0000, v124
  v_pk_add_f32 v[184:185], v[184:185], v[8:9]
  v_lshlrev_b32 v10, 16, v125
  v_and_b32 v11, 0xffff0000, v125
  v_pk_add_f32 v[186:187], v[186:187], v[10:11]
  v_lshlrev_b32 v12, 16, v126
  v_and_b32 v13, 0xffff0000, v126
  v_pk_add_f32 v[188:189], v[188:189], v[12:13]
  v_lshlrev_b32 v14, 16, v127
  v_and_b32 v15, 0xffff0000, v127
  v_pk_add_f32 v[190:191], v[190:191], v[14:15]
  s_waitcnt vmcnt(6)
  v_lshlrev_b32 v8, 16, v128
  v_and_b32 v9, 0xffff0000, v128
  v_pk_add_f32 v[176:177], v[176:177], v[8:9]
  v_lshlrev_b32 v10, 16, v129
  v_and_b32 v11, 0xffff0000, v129
  v_pk_add_f32 v[178:179], v[178:179], v[10:11]
  v_lshlrev_b32 v12, 16, v130
  v_and_b32 v13, 0xffff0000, v130
  v_pk_add_f32 v[180:181], v[180:181], v[12:13]
  v_lshlrev_b32 v14, 16, v131
  v_and_b32 v15, 0xffff0000, v131
  v_pk_add_f32 v[182:183], v[182:183], v[14:15]
  v_lshlrev_b32 v8, 16, v132
  v_and_b32 v9, 0xffff0000, v132
  v_pk_add_f32 v[184:185], v[184:185], v[8:9]
  v_lshlrev_b32 v10, 16, v133
  v_and_b32 v11, 0xffff0000, v133
  v_pk_add_f32 v[186:187], v[186:187], v[10:11]
  v_lshlrev_b32 v12, 16, v134
  v_and_b32 v13, 0xffff0000, v134
  v_pk_add_f32 v[188:189], v[188:189], v[12:13]
  v_lshlrev_b32 v14, 16, v135
  v_and_b32 v15, 0xffff0000, v135
  v_pk_add_f32 v[190:191], v[190:191], v[14:15]
  s_waitcnt vmcnt(4)
  v_lshlrev_b32 v8, 16, v136
  v_and_b32 v9, 0xffff0000, v136
  v_pk_add_f32 v[176:177], v[176:177], v[8:9]
  v_lshlrev_b32 v10, 16, v137
  v_and_b32 v11, 0xffff0000, v137
  v_pk_add_f32 v[178:179], v[178:179], v[10:11]
  v_lshlrev_b32 v12, 16, v138
  v_and_b32 v13, 0xffff0000, v138
  v_pk_add_f32 v[180:181], v[180:181], v[12:13]
  v_lshlrev_b32 v14, 16, v139
  v_and_b32 v15, 0xffff0000, v139
  v_pk_add_f32 v[182:183], v[182:183], v[14:15]
  v_lshlrev_b32 v8, 16, v140
  v_and_b32 v9, 0xffff0000, v140
  v_pk_add_f32 v[184:185], v[184:185], v[8:9]
  v_lshlrev_b32 v10, 16, v141
  v_and_b32 v11, 0xffff0000, v141
  v_pk_add_f32 v[186:187], v[186:187], v[10:11]
  v_lshlrev_b32 v12, 16, v142
  v_and_b32 v13, 0xffff0000, v142
  v_pk_add_f32 v[188:189], v[188:189], v[12:13]
  v_lshlrev_b32 v14, 16, v143
  v_and_b32 v15, 0xffff0000, v143
  v_pk_add_f32 v[190:191], v[190:191], v[14:15]
  s_waitcnt vmcnt(2)
  v_lshlrev_b32 v8, 16, v144
  v_and_b32 v9, 0xffff0000, v144
  v_pk_add_f32 v[176:177], v[176:177], v[8:9]
  v_lshlrev_b32 v10, 16, v145
  v_and_b32 v11, 0xffff0000, v145
  v_pk_add_f32 v[178:179], v[178:179], v[10:11]
  v_lshlrev_b32 v12, 16, v146
  v_and_b32 v13, 0xffff0000, v146
  v_pk_add_f32 v[180:181], v[180:181], v[12:13]
  v_lshlrev_b32 v14, 16, v147
  v_and_b32 v15, 0xffff0000, v147
  v_pk_add_f32 v[182:183], v[182:183], v[14:15]
  v_lshlrev_b32 v8, 16, v148
  v_and_b32 v9, 0xffff0000, v148
  v_pk_add_f32 v[184:185], v[184:185], v[8:9]
  v_lshlrev_b32 v10, 16, v149
  v_and_b32 v11, 0xffff0000, v149
  v_pk_add_f32 v[186:187], v[186:187], v[10:11]
  v_lshlrev_b32 v12, 16, v150
  v_and_b32 v13, 0xffff0000, v150
  v_pk_add_f32 v[188:189], v[188:189], v[12:13]
  v_lshlrev_b32 v14, 16, v151
  v_and_b32 v15, 0xffff0000, v151
  v_pk_add_f32 v[190:191], v[190:191], v[14:15]
  s_waitcnt vmcnt(0)
  v_lshlrev_b32 v8, 16, v152
  v_and_b32 v9, 0xffff0000, v152
  v_pk_add_f32 v[176:177], v[176:177], v[8:9]
  v_lshlrev_b32 v10, 16, v153
  v_and_b32 v11, 0xffff0000, v153
  v_pk_add_f32 v[178:179], v[178:179], v[10:11]
  v_lshlrev_b32 v12, 16, v154
  v_and_b32 v13, 0xffff0000, v154
  v_pk_add_f32 v[180:181], v[180:181], v[12:13]
  v_lshlrev_b32 v14, 16, v155
  v_and_b32 v15, 0xffff0000, v155
  v_pk_add_f32 v[182:183], v[182:183], v[14:15]
  v_lshlrev_b32 v8, 16, v156
  v_and_b32 v9, 0xffff0000, v156
  v_pk_add_f32 v[184:185], v[184:185], v[8:9]
  v_lshlrev_b32 v10, 16, v157
  v_and_b32 v11, 0xffff0000, v157
  v_pk_add_f32 v[186:187], v[186:187], v[10:11]
  v_lshlrev_b32 v12, 16, v158
  v_and_b32 v13, 0xffff0000, v158
  v_pk_add_f32 v[188:189], v[188:189], v[12:13]
  v_lshlrev_b32 v14, 16, v159
  v_and_b32 v15, 0xffff0000, v159
  v_pk_add_f32 v[190:191], v[190:191], v[14:15]
  v_pk_fma_f32 v[160:161], v[176:177], v[82:83], v[160:161] op_sel_hi:[1,0,1]
  v_cvt_pk_bf16_f32 v16, v160, v161
  v_pk_fma_f32 v[162:163], v[178:179], v[82:83], v[162:163] op_sel_hi:[1,0,1]
  v_cvt_pk_bf16_f32 v17, v162, v163
  v_pk_fma_f32 v[164:165], v[180:181], v[82:83], v[164:165] op_sel_hi:[1,0,1]
  v_cvt_pk_bf16_f32 v18, v164, v165
  v_pk_fma_f32 v[166:167], v[182:183], v[82:83], v[166:167] op_sel_hi:[1,0,1]
  v_cvt_pk_bf16_f32 v19, v166, v167
  v_pk_fma_f32 v[168:169], v[184:185], v[82:83], v[168:169] op_sel_hi:[1,0,1]
  v_cvt_pk_bf16_f32 v20, v168, v169
  v_pk_fma_f32 v[170:171], v[186:187], v[82:83], v[170:171] op_sel_hi:[1,0,1]
  v_cvt_pk_bf16_f32 v21, v170, v171
  v_pk_fma_f32 v[172:173], v[188:189], v[82:83], v[172:173] op_sel_hi:[1,0,1]
  v_cvt_pk_bf16_f32 v22, v172, v173
  v_pk_fma_f32 v[174:175], v[190:191], v[82:83], v[174:175] op_sel_hi:[1,0,1]
  v_cvt_pk_bf16_f32 v23, v174, v175
  s_lshl_b32 s26, s49, 2
  s_add_u32 s26, s26, s16
  s_lshl_b32 s26, s26, 6
  s_lshl_b32 s27, s48, 15
  s_add_u32 s26, s26, s27
  buffer_store_dwordx4 v[16:19], v6, s[32:35], s26 offen offset:0
  buffer_store_dwordx4 v[20:23], v6, s[32:35], s26 offen offset:32
  s_cmp_lt_u32 s50, 64
  s_mov_b32 s50, s51
  s_cbranch_scc1 M_fin
  s_branch M_done
M_follow:
  s_lshr_b32 s48, s64, 2
  s_and_b32 s49, s64, 1
  s_bfe_u32 s50, s64, 0x10001
  s_mov_b32 s51, 2
  s_mov_b32 s23, 32
  s_load_dwordx2 s[8:9], s[0:1], 88
  s_lshl_b32 s17, s48, 19
  s_lshl_b32 s26, s49, 2
  s_add_u32 s26, s26, s16
  s_lshl_b32 s27, s26, 7
  s_add_u32 s17, s17, s27
  s_mov_b32 s18, 1024
  s_lshl_b32 s21, s48, 6
  s_add_u32 s21, s21, s50
  s_lshl_b32 s21, s21, 3
  s_add_u32 s21, s21, s26
  s_lshl_b32 s21, s21, 12
  s_add_u32 s21, s21, 167772160
  s_lshl_b32 s22, s51, 15
  s_mov_b32 s24, 1.0
  s_waitcnt lgkmcnt(0)
  s_and_b32 s9, s9, 0xffff
  s_mov_b32 s10, 4194304
  s_mov_b32 s11, 0x20000
  v_lshrrev_b32 v144, 4, v1
  v_and_b32 v56, 0xff, v2
  v_lshl_add_u32 v56, v144, 9, v56
  s_mul_i32 s26, s16, 0
  v_add_u32 v8, 0, v56
  v_add_u32 v16, 0, v2
  v_add_u32 v16, s26, v16
  v_add_u32 v9, 256, v56
  v_add_u32 v17, 1024, v2
  v_add_u32 v17, s26, v17
  v_add_u32 v10, 2048, v56
  v_add_u32 v18, 2048, v2
  v_add_u32 v18, s26, v18
  v_add_u32 v11, 2304, v56
  v_add_u32 v19, 3072, v2
  v_add_u32 v19, s26, v19
  v_add_u32 v12, 4096, v56
  v_add_u32 v20, 4096, v2
  v_add_u32 v20, s26, v20
  v_add_u32 v13, 4352, v56
  v_add_u32 v21, 5120, v2
  v_add_u32 v21, s26, v21
  v_add_u32 v14, 6144, v56
  v_add_u32 v22, 6144, v2
  v_add_u32 v22, s26, v22
  v_add_u32 v15, 6400, v56
  v_add_u32 v23, 7168, v2
  v_add_u32 v23, s26, v23
  v_mov_b32 v20, v56
  v_lshrrev_b32 v144, 3, v1
  v_mul_lo_u32 v144, v144, s18
  v_and_b32 v145, 7, v1
  v_lshl_add_u32 v144, v145, 4, v144
  s_lshl_b32 s28, s16, 15
  s_add_u32 s28, s28, 32768
  s_lshl_b32 s29, s18, 3
  s_add_u32 m0, s28, 0
  s_nop 0
  buffer_load_dwordx4 v144, s[8:11], s17 offen lds
  s_add_u32 s17, s17, s29
  s_add_u32 m0, s28, 1024
  s_nop 0
  buffer_load_dwordx4 v144, s[8:11], s17 offen lds
  s_add_u32 s17, s17, s29
  s_add_u32 m0, s28, 2048
  s_nop 0
  buffer_load_dwordx4 v144, s[8:11], s17 offen lds
  s_add_u32 s17, s17, s29
  s_add_u32 m0, s28, 3072
  s_nop 0
  buffer_load_dwordx4 v144, s[8:11], s17 offen lds
  s_add_u32 s17, s17, s29
  s_add_u32 m0, s28, 4096
  s_nop 0
  buffer_load_dwordx4 v144, s[8:11], s17 offen lds
  s_add_u32 s17, s17, s29
  s_add_u32 m0, s28, 5120
  s_nop 0
  buffer_load_dwordx4 v144, s[8:11], s17 offen lds
  s_add_u32 s17, s17, s29
  s_add_u32 m0, s28, 6144
  s_nop 0
  buffer_load_dwordx4 v144, s[8:11], s17 offen lds
  s_add_u32 s17, s17, s29
  s_add_u32 m0, s28, 7168
  s_nop 0
  buffer_load_dwordx4 v144, s[8:11], s17 offen lds
  s_add_u32 s17, s17, s29
  s_add_u32 m0, s28, 8192
  s_nop 0
  buffer_load_dwordx4 v144, s[8:11], s17 offen lds
  s_add_u32 s17, s17, s29
  s_add_u32 m0, s28, 9216
  s_nop 0
  buffer_load_dwordx4 v144, s[8:11], s17 offen lds
  s_add_u32 s17, s17, s29
  s_add_u32 m0, s28, 10240
  s_nop 0
  buffer_load_dwordx4 v144, s[8:11], s17 offen lds
  s_add_u32 s17, s17, s29
  s_add_u32 m0, s28, 11264
  s_nop 0
  buffer_load_dwordx4 v144, s[8:11], s17 offen lds
  s_add_u32 s17, s17, s29
  s_add_u32 m0, s28, 12288
  s_nop 0
  buffer_load_dwordx4 v144, s[8:11], s17 offen lds
  s_add_u32 s17, s17, s29
  s_add_u32 m0, s28, 13312
  s_nop 0
  buffer_load_dwordx4 v144, s[8:11], s17 offen lds
  s_add_u32 s17, s17, s29
  s_add_u32 m0, s28, 14336
  s_nop 0
  buffer_load_dwordx4 v144, s[8:11], s17 offen lds
  s_add_u32 s17, s17, s29
  s_add_u32 m0, s28, 15360
  s_nop 0
  buffer_load_dwordx4 v144, s[8:11], s17 offen lds
  s_add_u32 s17, s17, s29
  s_add_u32 m0, s28, 16384
  s_nop 0
  buffer_load_dwordx4 v144, s[8:11], s17 offen lds
  s_add_u32 s17, s17, s29
  s_add_u32 m0, s28, 17408
  s_nop 0
  buffer_load_dwordx4 v144, s[8:11], s17 offen lds
  s_add_u32 s17, s17, s29
  s_add_u32 m0, s28, 18432
  s_nop 0
  buffer_load_dwordx4 v144, s[8:11], s17 offen lds
  s_add_u32 s17, s17, s29
  s_add_u32 m0, s28, 19456
  s_nop 0
  buffer_load_dwordx4 v144, s[8:11], s17 offen lds
  s_add_u32 s17, s17, s29
  s_add_u32 m0, s28, 20480
  s_nop 0
  buffer_load_dwordx4 v144, s[8:11], s17 offen lds
  s_add_u32 s17, s17, s29
  s_add_u32 m0, s28, 21504
  s_nop 0
  buffer_load_dwordx4 v144, s[8:11], s17 offen lds
  s_add_u32 s17, s17, s29
  s_add_u32 m0, s28, 22528
  s_nop 0
  buffer_load_dwordx4 v144, s[8:11], s17 offen lds
  s_add_u32 s17, s17, s29
  s_add_u32 m0, s28, 23552
  s_nop 0
  buffer_load_dwordx4 v144, s[8:11], s17 offen lds
  s_add_u32 s17, s17, s29
  s_add_u32 m0, s28, 24576
  s_nop 0
  buffer_load_dwordx4 v144, s[8:11], s17 offen lds
  s_add_u32 s17, s17, s29
  s_add_u32 m0, s28, 25600
  s_nop 0
  buffer_load_dwordx4 v144, s[8:11], s17 offen lds
  s_add_u32 s17, s17, s29
  s_add_u32 m0, s28, 26624
  s_nop 0
  buffer_load_dwordx4 v144, s[8:11], s17 offen lds
  s_add_u32 s17, s17, s29
  s_add_u32 m0, s28, 27648
  s_nop 0
  buffer_load_dwordx4 v144, s[8:11], s17 offen lds
  s_add_u32 s17, s17, s29
  s_add_u32 m0, s28, 28672
  s_nop 0
  buffer_load_dwordx4 v144, s[8:11], s17 offen lds
  s_add_u32 s17, s17, s29
  s_add_u32 m0, s28, 29696
  s_nop 0
  buffer_load_dwordx4 v144, s[8:11], s17 offen lds
  s_add_u32 s17, s17, s29
  s_add_u32 m0, s28, 30720
  s_nop 0
  buffer_load_dwordx4 v144, s[8:11], s17 offen lds
  s_add_u32 s17, s17, s29
  s_add_u32 m0, s28, 31744
  s_nop 0
  buffer_load_dwordx4 v144, s[8:11], s17 offen lds
  s_add_u32 s17, s17, s29
  v_bfe_u32 v148, v1, 2, 2
  v_lshrrev_b32 v149, 5, v1
  v_lshl_add_u32 v148, v149, 4, v148
  v_bfe_u32 v149, v1, 4, 1
  v_lshl_add_u32 v148, v149, 2, v148
  v_and_b32 v149, 3, v1
  v_lshlrev_b32 v149, 4, v149
  s_mov_b32 s26, 8
  v_lshl_add_u32 v148, v148, 7, v149
  v_add_u32 v152, s28, v148
  v_add_u32 v153, 1024, v152
  v_add_u32 v154, s26, v152
  v_add_u32 v155, s26, v153
  s_waitcnt vmcnt(28)
  ds_read_b64_tr_b16 a[0:1], v152 offset:0
  ds_read_b64_tr_b16 a[2:3], v153 offset:0
  ds_read_b64_tr_b16 a[4:5], v154 offset:0
  ds_read_b64_tr_b16 a[6:7], v155 offset:0
  ds_read_b64_tr_b16 a[8:9], v152 offset:64
  ds_read_b64_tr_b16 a[10:11], v153 offset:64
  ds_read_b64_tr_b16 a[12:13], v154 offset:64
  ds_read_b64_tr_b16 a[14:15], v155 offset:64
  s_waitcnt lgkmcnt(0)
  s_add_u32 m0, s28, 0
  s_nop 0
  buffer_load_dwordx4 v144, s[8:11], s17 offen lds
  s_add_u32 s17, s17, s29
  s_add_u32 m0, s28, 1024
  s_nop 0
  buffer_load_dwordx4 v144, s[8:11], s17 offen lds
  s_add_u32 s17, s17, s29
  s_add_u32 m0, s28, 2048
  s_nop 0
  buffer_load_dwordx4 v144, s[8:11], s17 offen lds
  s_add_u32 s17, s17, s29
  s_add_u32 m0, s28, 3072
  s_nop 0
  buffer_load_dwordx4 v144, s[8:11], s17 offen lds
  s_add_u32 s17, s17, s29
  s_waitcnt vmcnt(28)
  ds_read_b64_tr_b16 a[16:17], v152 offset:4096
  ds_read_b64_tr_b16 a[18:19], v153 offset:4096
  ds_read_b64_tr_b16 a[20:21], v154 offset:4096
  ds_read_b64_tr_b16 a[22:23], v155 offset:4096
  ds_read_b64_tr_b16 a[24:25], v152 offset:4160
  ds_read_b64_tr_b16 a[26:27], v153 offset:4160
  ds_read_b64_tr_b16 a[28:29], v154 offset:4160
  ds_read_b64_tr_b16 a[30:31], v155 offset:4160
  s_waitcnt lgkmcnt(0)
  s_add_u32 m0, s28, 4096
  s_nop 0
  buffer_load_dwordx4 v144, s[8:11], s17 offen lds
  s_add_u32 s17, s17, s29
  s_add_u32 m0, s28, 5120
  s_nop 0
  buffer_load_dwordx4 v144, s[8:11], s17 offen lds
  s_add_u32 s17, s17, s29
  s_add_u32 m0, s28, 6144
  s_nop 0
  buffer_load_dwordx4 v144, s[8:11], s17 offen lds
  s_add_u32 s17, s17, s29
  s_add_u32 m0, s28, 7168
  s_nop 0
  buffer_load_dwordx4 v144, s[8:11], s17 offen lds
  s_add_u32 s17, s17, s29
  s_waitcnt vmcnt(28)
  ds_read_b64_tr_b16 a[32:33], v152 offset:8192
  ds_read_b64_tr_b16 a[34:35], v153 offset:8192
  ds_read_b64_tr_b16 a[36:37], v154 offset:8192
  ds_read_b64_tr_b16 a[38:39], v155 offset:8192
  ds_read_b64_tr_b16 a[40:41], v152 offset:8256
  ds_read_b64_tr_b16 a[42:43], v153 offset:8256
  ds_read_b64_tr_b16 a[44:45], v154 offset:8256
  ds_read_b64_tr_b16 a[46:47], v155 offset:8256
  s_waitcnt lgkmcnt(0)
  s_add_u32 m0, s28, 8192
  s_nop 0
  buffer_load_dwordx4 v144, s[8:11], s17 offen lds
  s_add_u32 s17, s17, s29
  s_add_u32 m0, s28, 9216
  s_nop 0
  buffer_load_dwordx4 v144, s[8:11], s17 offen lds
  s_add_u32 s17, s17, s29
  s_add_u32 m0, s28, 10240
  s_nop 0
  buffer_load_dwordx4 v144, s[8:11], s17 offen lds
  s_add_u32 s17, s17, s29
  s_add_u32 m0, s28, 11264
  s_nop 0
  buffer_load_dwordx4 v144, s[8:11], s17 offen lds
  s_add_u32 s17, s17, s29
  s_waitcnt vmcnt(28)
  ds_read_b64_tr_b16 a[48:49], v152 offset:12288
  ds_read_b64_tr_b16 a[50:51], v153 offset:12288
  ds_read_b64_tr_b16 a[52:53], v154 offset:12288
  ds_read_b64_tr_b16 a[54:55], v155 offset:12288
  ds_read_b64_tr_b16 a[56:57], v152 offset:12352
  ds_read_b64_tr_b16 a[58:59], v153 offset:12352
  ds_read_b64_tr_b16 a[60:61], v154 offset:12352
  ds_read_b64_tr_b16 a[62:63], v155 offset:12352
  s_waitcnt lgkmcnt(0)
  s_add_u32 m0, s28, 12288
  s_nop 0
  buffer_load_dwordx4 v144, s[8:11], s17 offen lds
  s_add_u32 s17, s17, s29
  s_add_u32 m0, s28, 13312
  s_nop 0
  buffer_load_dwordx4 v144, s[8:11], s17 offen lds
  s_add_u32 s17, s17, s29
  s_add_u32 m0, s28, 14336
  s_nop 0
  buffer_load_dwordx4 v144, s[8:11], s17 offen lds
  s_add_u32 s17, s17, s29
  s_add_u32 m0, s28, 15360
  s_nop 0
  buffer_load_dwordx4 v144, s[8:11], s17 offen lds
  s_add_u32 s17, s17, s29
  s_waitcnt vmcnt(28)
  ds_read_b64_tr_b16 a[64:65], v152 offset:16384
  ds_read_b64_tr_b16 a[66:67], v153 offset:16384
  ds_read_b64_tr_b16 a[68:69], v154 offset:16384
  ds_read_b64_tr_b16 a[70:71], v155 offset:16384
  ds_read_b64_tr_b16 a[72:73], v152 offset:16448
  ds_read_b64_tr_b16 a[74:75], v153 offset:16448
  ds_read_b64_tr_b16 a[76:77], v154 offset:16448
  ds_read_b64_tr_b16 a[78:79], v155 offset:16448
  s_waitcnt lgkmcnt(0)
  s_add_u32 m0, s28, 16384
  s_nop 0
  buffer_load_dwordx4 v144, s[8:11], s17 offen lds
  s_add_u32 s17, s17, s29
  s_add_u32 m0, s28, 17408
  s_nop 0
  buffer_load_dwordx4 v144, s[8:11], s17 offen lds
  s_add_u32 s17, s17, s29
  s_add_u32 m0, s28, 18432
  s_nop 0
  buffer_load_dwordx4 v144, s[8:11], s17 offen lds
  s_add_u32 s17, s17, s29
  s_add_u32 m0, s28, 19456
  s_nop 0
  buffer_load_dwordx4 v144, s[8:11], s17 offen lds
  s_add_u32 s17, s17, s29
  s_waitcnt vmcnt(28)
  ds_read_b64_tr_b16 a[80:81], v152 offset:20480
  ds_read_b64_tr_b16 a[82:83], v153 offset:20480
  ds_read_b64_tr_b16 a[84:85], v154 offset:20480
  ds_read_b64_tr_b16 a[86:87], v155 offset:20480
  ds_read_b64_tr_b16 a[88:89], v152 offset:20544
  ds_read_b64_tr_b16 a[90:91], v153 offset:20544
  ds_read_b64_tr_b16 a[92:93], v154 offset:20544
  ds_read_b64_tr_b16 a[94:95], v155 offset:20544
  s_waitcnt lgkmcnt(0)
  s_add_u32 m0, s28, 20480
  s_nop 0
  buffer_load_dwordx4 v144, s[8:11], s17 offen lds
  s_add_u32 s17, s17, s29
  s_add_u32 m0, s28, 21504
  s_nop 0
  buffer_load_dwordx4 v144, s[8:11], s17 offen lds
  s_add_u32 s17, s17, s29
  s_add_u32 m0, s28, 22528
  s_nop 0
  buffer_load_dwordx4 v144, s[8:11], s17 offen lds
  s_add_u32 s17, s17, s29
  s_add_u32 m0, s28, 23552
  s_nop 0
  buffer_load_dwordx4 v144, s[8:11], s17 offen lds
  s_add_u32 s17, s17, s29
  s_waitcnt vmcnt(28)
  ds_read_b64_tr_b16 a[96:97], v152 offset:24576
  ds_read_b64_tr_b16 a[98:99], v153 offset:24576
  ds_read_b64_tr_b16 a[100:101], v154 offset:24576
  ds_read_b64_tr_b16 a[102:103], v155 offset:24576
  ds_read_b64_tr_b16 a[104:105], v152 offset:24640
  ds_read_b64_tr_b16 a[106:107], v153 offset:24640
  ds_read_b64_tr_b16 a[108:109], v154 offset:24640
  ds_read_b64_tr_b16 a[110:111], v155 offset:24640
  s_waitcnt lgkmcnt(0)
  s_add_u32 m0, s28, 24576
  s_nop 0
  buffer_load_dwordx4 v144, s[8:11], s17 offen lds
  s_add_u32 s17, s17, s29
  s_add_u32 m0, s28, 25600
  s_nop 0
  buffer_load_dwordx4 v144, s[8:11], s17 offen lds
  s_add_u32 s17, s17, s29
  s_add_u32 m0, s28, 26624
  s_nop 0
  buffer_load_dwordx4 v144, s[8:11], s17 offen lds
  s_add_u32 s17, s17, s29
  s_add_u32 m0, s28, 27648
  s_nop 0
  buffer_load_dwordx4 v144, s[8:11], s17 offen lds
  s_add_u32 s17, s17, s29
  s_waitcnt vmcnt(28)
  ds_read_b64_tr_b16 a[112:113], v152 offset:28672
  ds_read_b64_tr_b16 a[114:115], v153 offset:28672
  ds_read_b64_tr_b16 a[116:117], v154 offset:28672
  ds_read_b64_tr_b16 a[118:119], v155 offset:28672
  ds_read_b64_tr_b16 a[120:121], v152 offset:28736
  ds_read_b64_tr_b16 a[122:123], v153 offset:28736
  ds_read_b64_tr_b16 a[124:125], v154 offset:28736
  ds_read_b64_tr_b16 a[126:127], v155 offset:28736
  s_waitcnt lgkmcnt(0)
  s_add_u32 m0, s28, 28672
  s_nop 0
  buffer_load_dwordx4 v144, s[8:11], s17 offen lds
  s_add_u32 s17, s17, s29
  s_add_u32 m0, s28, 29696
  s_nop 0
  buffer_load_dwordx4 v144, s[8:11], s17 offen lds
  s_add_u32 s17, s17, s29
  s_add_u32 m0, s28, 30720
  s_nop 0
  buffer_load_dwordx4 v144, s[8:11], s17 offen lds
  s_add_u32 s17, s17, s29
  s_add_u32 m0, s28, 31744
  s_nop 0
  buffer_load_dwordx4 v144, s[8:11], s17 offen lds
  s_add_u32 s17, s17, s29
  s_waitcnt vmcnt(28)
  ds_read_b64_tr_b16 a[128:129], v152 offset:0
  ds_read_b64_tr_b16 a[130:131], v153 offset:0
  ds_read_b64_tr_b16 a[132:133], v154 offset:0
  ds_read_b64_tr_b16 a[134:135], v155 offset:0
  ds_read_b64_tr_b16 a[136:137], v152 offset:64
  ds_read_b64_tr_b16 a[138:139], v153 offset:64
  ds_read_b64_tr_b16 a[140:141], v154 offset:64
  ds_read_b64_tr_b16 a[142:143], v155 offset:64
  s_waitcnt lgkmcnt(0)
  s_waitcnt vmcnt(24)
  ds_read_b64_tr_b16 a[144:145], v152 offset:4096
  ds_read_b64_tr_b16 a[146:147], v153 offset:4096
  ds_read_b64_tr_b16 a[148:149], v154 offset:4096
  ds_read_b64_tr_b16 a[150:151], v155 offset:4096
  ds_read_b64_tr_b16 a[152:153], v152 offset:4160
  ds_read_b64_tr_b16 a[154:155], v153 offset:4160
  ds_read_b64_tr_b16 a[156:157], v154 offset:4160
  ds_read_b64_tr_b16 a[158:159], v155 offset:4160
  s_waitcnt lgkmcnt(0)
  s_waitcnt vmcnt(20)
  ds_read_b64_tr_b16 a[160:161], v152 offset:8192
  ds_read_b64_tr_b16 a[162:163], v153 offset:8192
  ds_read_b64_tr_b16 a[164:165], v154 offset:8192
  ds_read_b64_tr_b16 a[166:167], v155 offset:8192
  ds_read_b64_tr_b16 a[168:169], v152 offset:8256
  ds_read_b64_tr_b16 a[170:171], v153 offset:8256
  ds_read_b64_tr_b16 a[172:173], v154 offset:8256
  ds_read_b64_tr_b16 a[174:175], v155 offset:8256
  s_waitcnt lgkmcnt(0)
  s_waitcnt vmcnt(16)
  ds_read_b64_tr_b16 a[176:177], v152 offset:12288
  ds_read_b64_tr_b16 a[178:179], v153 offset:12288
  ds_read_b64_tr_b16 a[180:181], v154 offset:12288
  ds_read_b64_tr_b16 a[182:183], v155 offset:12288
  ds_read_b64_tr_b16 a[184:185], v152 offset:12352
  ds_read_b64_tr_b16 a[186:187], v153 offset:12352
  ds_read_b64_tr_b16 a[188:189], v154 offset:12352
  ds_read_b64_tr_b16 a[190:191], v155 offset:12352
  s_waitcnt lgkmcnt(0)
  s_waitcnt vmcnt(12)
  ds_read_b64_tr_b16 a[192:193], v152 offset:16384
  ds_read_b64_tr_b16 a[194:195], v153 offset:16384
  ds_read_b64_tr_b16 a[196:197], v154 offset:16384
  ds_read_b64_tr_b16 a[198:199], v155 offset:16384
  ds_read_b64_tr_b16 a[200:201], v152 offset:16448
  ds_read_b64_tr_b16 a[202:203], v153 offset:16448
  ds_read_b64_tr_b16 a[204:205], v154 offset:16448
  ds_read_b64_tr_b16 a[206:207], v155 offset:16448
  s_waitcnt lgkmcnt(0)
  s_waitcnt vmcnt(8)
  ds_read_b64_tr_b16 a[208:209], v152 offset:20480
  ds_read_b64_tr_b16 a[210:211], v153 offset:20480
  ds_read_b64_tr_b16 a[212:213], v154 offset:20480
  ds_read_b64_tr_b16 a[214:215], v155 offset:20480
  ds_read_b64_tr_b16 a[216:217], v152 offset:20544
  ds_read_b64_tr_b16 a[218:219], v153 offset:20544
  ds_read_b64_tr_b16 a[220:221], v154 offset:20544
  ds_read_b64_tr_b16 a[222:223], v155 offset:20544
  s_waitcnt lgkmcnt(0)
  s_waitcnt vmcnt(4)
  ds_read_b64_tr_b16 a[224:225], v152 offset:24576
  ds_read_b64_tr_b16 a[226:227], v153 offset:24576
  ds_read_b64_tr_b16 a[228:229], v154 offset:24576
  ds_read_b64_tr_b16 a[230:231], v155 offset:24576
  ds_read_b64_tr_b16 a[232:233], v152 offset:24640
  ds_read_b64_tr_b16 a[234:235], v153 offset:24640
  ds_read_b64_tr_b16 a[236:237], v154 offset:24640
  ds_read_b64_tr_b16 a[238:239], v155 offset:24640
  s_waitcnt lgkmcnt(0)
  s_waitcnt vmcnt(0)
  ds_read_b64_tr_b16 a[240:241], v152 offset:28672
  ds_read_b64_tr_b16 a[242:243], v153 offset:28672
  ds_read_b64_tr_b16 a[244:245], v154 offset:28672
  ds_read_b64_tr_b16 a[246:247], v155 offset:28672
  ds_read_b64_tr_b16 a[248:249], v152 offset:28736
  ds_read_b64_tr_b16 a[250:251], v153 offset:28736
  ds_read_b64_tr_b16 a[252:253], v154 offset:28736
  ds_read_b64_tr_b16 a[254:255], v155 offset:28736
  s_waitcnt lgkmcnt(0)
  s_lshl_b32 s26, s48, 2
  s_add_u32 s26, s26, s16
  s_lshl_b32 s27, s26, 6
  s_add_u32 s27, s27, s50
  s_lshl_b32 s19, s27, 13
  s_lshl_b32 s27, s50, 5
  s_add_u32 s27, s27, s26
  s_mul_i32 s27, s27, 4096
  s_add_u32 s20, s27, 135266304
  s_lshl_b32 s25, s16, 12
  s_add_u32 s25, s25, 65536
  s_lshl_b32 s26, s16, 13
  v_add_u32 v3, s26, v2
  v_lshrrev_b32 v16, 5, v1
  v_and_b32 v17, 31, v1
  v_bfe_u32 v18, v1, 4, 1
  v_lshl_add_u32 v18, v18, 1, v16
  v_and_b32 v19, 15, v1
  v_lshl_add_u32 v18, v18, 4, v19
  v_lshl_add_u32 v5, v18, 4, s25
  v_bfe_u32 v18, v1, 2, 2
  v_lshl_add_u32 v18, v16, 2, v18
  v_and_b32 v19, 1, v1
  v_lshl_add_u32 v18, v19, 4, v18
  v_lshl_add_u32 v4, v18, 4, s25
  v_lshlrev_b32 v16, 2, v16
  v_sub_u32 v17, v17, v16
  v_mov_b32 v18, 0xf149f2ca
  v_cmp_le_i32 vcc, 0, v17
  s_nop 1
  v_cndmask_b32 v240, v18, 0, vcc
  v_cmp_le_i32 vcc, 1, v17
  s_nop 1
  v_cndmask_b32 v241, v18, 0, vcc
  v_cmp_le_i32 vcc, 2, v17
  s_nop 1
  v_cndmask_b32 v242, v18, 0, vcc
  v_cmp_le_i32 vcc, 3, v17
  s_nop 1
  v_cndmask_b32 v243, v18, 0, vcc
  v_cmp_le_i32 vcc, 8, v17
  s_nop 1
  v_cndmask_b32 v244, v18, 0, vcc
  v_cmp_le_i32 vcc, 9, v17
  s_nop 1
  v_cndmask_b32 v245, v18, 0, vcc
  v_cmp_le_i32 vcc, 10, v17
  s_nop 1
  v_cndmask_b32 v246, v18, 0, vcc
  v_cmp_le_i32 vcc, 11, v17
  s_nop 1
  v_cndmask_b32 v247, v18, 0, vcc
  v_cmp_le_i32 vcc, 16, v17
  s_nop 1
  v_cndmask_b32 v248, v18, 0, vcc
  v_cmp_le_i32 vcc, 17, v17
  s_nop 1
  v_cndmask_b32 v249, v18, 0, vcc
  v_cmp_le_i32 vcc, 18, v17
  s_nop 1
  v_cndmask_b32 v250, v18, 0, vcc
  v_cmp_le_i32 vcc, 19, v17
  s_nop 1
  v_cndmask_b32 v251, v18, 0, vcc
  v_cmp_le_i32 vcc, 24, v17
  s_nop 1
  v_cndmask_b32 v252, v18, 0, vcc
  v_cmp_le_i32 vcc, 25, v17
  s_nop 1
  v_cndmask_b32 v253, v18, 0, vcc
  v_cmp_le_i32 vcc, 26, v17
  s_nop 1
  v_cndmask_b32 v254, v18, 0, vcc
  v_cmp_le_i32 vcc, 27, v17
  s_nop 1
  v_cndmask_b32 v255, v18, 0, vcc
  v_mov_b32 v21, v2
  s_barrier
  s_lshl_b32 s77, s48, 2
  s_add_u32 s77, s77, s16
  s_mul_i32 s78, s77, 896
  s_add_u32 s76, s78, 148898304
  s_mov_b32 s71, 0
  s_branch M_sg_189
M_sw_188:
  s_sleep 8
  s_add_u32 s71, s71, 1
  s_cmp_gt_u32 s71, 262144
  s_cbranch_scc1 M_exit
M_sg_189:
  s_mov_b32 s79, 0
  s_atomic_or s79, s[72:73], s76 glc
  s_waitcnt lgkmcnt(0)
  s_cmp_lt_u32 s79, 16
  s_cbranch_scc1 M_sw_188
  s_add_u32 s76, s78, 148898048
  s_mov_b32 s71, 0
  s_branch M_sg_191
M_sw_190:
  s_sleep 8
  s_add_u32 s71, s71, 1
  s_cmp_gt_u32 s71, 262144
  s_cbranch_scc1 M_exit
M_sg_191:
  s_mov_b32 s79, 0
  s_atomic_or s79, s[72:73], s76 glc
  s_waitcnt lgkmcnt(0)
  s_cmp_lt_u32 s79, 8
  s_cbranch_scc1 M_sw_190
  s_add_u32 s76, s78, 148898176
  s_mov_b32 s71, 0
  s_branch M_sg_193
M_sw_192:
  s_sleep 8
  s_add_u32 s71, s71, 1
  s_cmp_gt_u32 s71, 262144
  s_cbranch_scc1 M_exit
M_sg_193:
  s_mov_b32 s79, 0
  s_atomic_or s79, s[72:73], s76 glc
  s_waitcnt lgkmcnt(0)
  s_cmp_lt_u32 s79, 8
  s_cbranch_scc1 M_sw_192
M_xok_187:
  s_lshl_b32 s77, s77, 7
  s_add_u32 s54, s77, 148926464
  s_add_u32 s52, s50, 1
  s_mov_b32 s53, 0
  s_mov_b32 s30, 0x200
  s_add_u32 s28, s19, 50331648
  buffer_load_dwordx4 v[144:147], v21, s[4:7], s28 offen offset:0 sc1
  buffer_load_dwordx4 v[148:151], v21, s[4:7], s28 offen offset:1024 sc1
  buffer_load_dwordx4 v[152:155], v21, s[4:7], s28 offen offset:2048 sc1
  buffer_load_dwordx4 v[156:159], v21, s[4:7], s28 offen offset:3072 sc1
  s_add_u32 s29, s19, 50335744
  buffer_load_dwordx4 v[160:163], v21, s[4:7], s29 offen offset:0 sc1
  buffer_load_dwordx4 v[164:167], v21, s[4:7], s29 offen offset:1024 sc1
  buffer_load_dwordx4 v[168:171], v21, s[4:7], s29 offen offset:2048 sc1
  buffer_load_dwordx4 v[172:175], v21, s[4:7], s29 offen offset:3072 sc1
  s_add_u32 s28, s19, 67108864
  buffer_load_dwordx4 v[176:179], v21, s[4:7], s28 offen offset:0 sc1
  buffer_load_dwordx4 v[180:183], v21, s[4:7], s28 offen offset:1024 sc1
  buffer_load_dwordx4 v[184:187], v21, s[4:7], s28 offen offset:2048 sc1
  buffer_load_dwordx4 v[188:191], v21, s[4:7], s28 offen offset:3072 sc1
  s_add_u32 s29, s19, 67112960
  buffer_load_dwordx4 v[192:195], v21, s[4:7], s29 offen offset:0 sc1
  buffer_load_dwordx4 v[196:199], v21, s[4:7], s29 offen offset:1024 sc1
  buffer_load_dwordx4 v[200:203], v21, s[4:7], s29 offen offset:2048 sc1
  buffer_load_dwordx4 v[204:207], v21, s[4:7], s29 offen offset:3072 sc1
  s_add_u32 s28, s19, 83886080
  buffer_load_dwordx4 v[208:211], v21, s[4:7], s28 offen offset:0 sc1
  buffer_load_dwordx4 v[212:215], v21, s[4:7], s28 offen offset:1024 sc1
  buffer_load_dwordx4 v[216:219], v21, s[4:7], s28 offen offset:2048 sc1
  buffer_load_dwordx4 v[220:223], v21, s[4:7], s28 offen offset:3072 sc1
  s_add_u32 s29, s19, 83890176
  buffer_load_dwordx4 v[224:227], v21, s[4:7], s29 offen offset:0 sc1
  buffer_load_dwordx4 v[228:231], v21, s[4:7], s29 offen offset:1024 sc1
  buffer_load_dwordx4 v[232:235], v21, s[4:7], s29 offen offset:2048 sc1
  buffer_load_dwordx4 v[236:239], v21, s[4:7], s29 offen offset:3072 sc1
  s_mov_b32 s24, 0
  v_mov_b32 v22, 0x40000000
  s_sub_u32 s21, s21, s22
F_top_194:
  s_waitcnt vmcnt(8)
  v_mfma_f32_32x32x16_bf16 v[24:39], v[176:179], v[144:147], v[240:255]
  s_nop 1
  v_cvt_pk_bf16_f32 v128, v64, v65
  v_cvt_pk_bf16_f32 v129, v66, v67
  v_cvt_pk_bf16_f32 v130, v68, v69
  v_cvt_pk_bf16_f32 v131, v70, v71
  v_mfma_f32_32x32x16_bf16 v[24:39], v[180:183], v[148:151], v[24:39]
  buffer_store_dwordx4 v[128:131], v22, s[4:7], s21 offen offset:0 sc1
  v_mfma_f32_32x32x16_bf16 v[24:39], v[184:187], v[152:155], v[24:39]
  v_cvt_pk_bf16_f32 v132, v72, v73
  v_cvt_pk_bf16_f32 v133, v74, v75
  v_cvt_pk_bf16_f32 v134, v76, v77
  v_cvt_pk_bf16_f32 v135, v78, v79
  v_mfma_f32_32x32x16_bf16 v[24:39], v[188:191], v[156:159], v[24:39]
  buffer_store_dwordx4 v[132:135], v22, s[4:7], s21 offen offset:256 sc1
  v_mfma_f32_32x32x16_bf16 v[24:39], v[192:195], v[160:163], v[24:39]
  v_cvt_pk_bf16_f32 v136, v80, v81
  v_cvt_pk_bf16_f32 v137, v82, v83
  v_cvt_pk_bf16_f32 v138, v84, v85
  v_cvt_pk_bf16_f32 v139, v86, v87
  v_mfma_f32_32x32x16_bf16 v[24:39], v[196:199], v[164:167], v[24:39]
  buffer_store_dwordx4 v[136:139], v22, s[4:7], s21 offen offset:2048 sc1
  v_mfma_f32_32x32x16_bf16 v[24:39], v[200:203], v[168:171], v[24:39]
  v_cvt_pk_bf16_f32 v140, v88, v89
  v_cvt_pk_bf16_f32 v141, v90, v91
  v_cvt_pk_bf16_f32 v142, v92, v93
  v_cvt_pk_bf16_f32 v143, v94, v95
  v_mfma_f32_32x32x16_bf16 v[24:39], v[204:207], v[172:175], v[24:39]
  buffer_store_dwordx4 v[140:143], v22, s[4:7], s21 offen offset:2304 sc1
  s_add_u32 s21, s21, s22
  v_mov_b32 v22, v20
  s_cmp_lg_u32 s24, 0
  s_cbranch_scc1 F_have_195
  s_cmp_le_u32 s52, 58
  s_cbranch_scc1 M_dp_196
  s_mov_b32 s71, 0
  v_add_u32 v16, s25, v2
  s_branch M_dp_198
M_dp_197:
  s_sleep 1
  s_add_u32 s71, s71, 1
  s_cmp_gt_u32 s71, 262144
  s_cbranch_scc1 M_exit
M_dp_198:
  buffer_load_dword v23, off, s[4:7], s54 sc1
  buffer_load_dwordx4 v[96:99], v2, s[4:7], s20 offen offset:0 sc1
  buffer_load_dwordx4 v[100:103], v2, s[4:7], s20 offen offset:1024 sc1
  buffer_load_dwordx4 v[104:107], v2, s[4:7], s20 offen offset:2048 sc1
  buffer_load_dwordx4 v[108:111], v2, s[4:7], s20 offen offset:3072 sc1
  s_waitcnt vmcnt(3)
  v_max_u32 v17, v96, v97
  v_max3_u32 v17, v17, v98, v99
  s_waitcnt vmcnt(2)
  v_max3_u32 v17, v17, v100, v101
  v_max3_u32 v17, v17, v102, v103
  s_waitcnt vmcnt(1)
  v_max3_u32 v17, v17, v104, v105
  v_max3_u32 v17, v17, v106, v107
  s_waitcnt vmcnt(0)
  v_max3_u32 v17, v17, v108, v109
  v_max3_u32 v17, v17, v110, v111
  v_cmp_eq_u32 vcc, -1, v17
  s_cbranch_vccz M_dp_199
  v_cmp_gt_u32 vcc, s52, v23
  s_cbranch_vccnz M_dp_197
  s_branch M_dp_196
M_dp_199:
  ds_write_b128 v16, v[96:99] offset:0
  ds_write_b128 v16, v[100:103] offset:1024
  ds_write_b128 v16, v[104:107] offset:2048
  ds_write_b128 v16, v[108:111] offset:3072
  s_branch F_have_195
M_dp_196:
  v_mov_b32 v16, s54
  v_mov_b32 v17, s52
  s_mov_b32 s71, 0
  s_branch M_vg_201
M_vw_200:
  s_sleep 2
  s_add_u32 s71, s71, 1
  s_cmp_gt_u32 s71, 262144
  s_cbranch_scc1 M_exit
M_vg_201:
  buffer_load_dword v23, v16, s[4:7], 0 offen sc1
  s_waitcnt vmcnt(0)
  v_cmp_lt_u32 vcc, v23, v17
  s_cbranch_vccnz M_vw_200
  s_mov_b32 m0, s25
  s_nop 0
  buffer_load_dwordx4 v2, s[4:7], s20 offen offset:0 sc1 lds
  buffer_load_dwordx4 v2, s[4:7], s20 offen offset:1024 sc1 lds
  buffer_load_dwordx4 v2, s[4:7], s20 offen offset:2048 sc1 lds
  buffer_load_dwordx4 v2, s[4:7], s20 offen offset:3072 sc1 lds
  s_waitcnt vmcnt(0)
F_have_195:
  ds_read_b64_tr_b16 v[176:177], v4 offset:8
  ds_read_b64_tr_b16 v[178:179], v4 offset:136
  ds_read_b64_tr_b16 v[180:181], v4 offset:520
  ds_read_b64_tr_b16 v[182:183], v4 offset:648
  ds_read_b64_tr_b16 v[184:185], v4 offset:1032
  ds_read_b64_tr_b16 v[186:187], v4 offset:1160
  ds_read_b64_tr_b16 v[188:189], v4 offset:1544
  ds_read_b64_tr_b16 v[190:191], v4 offset:1672
  ds_read_b64_tr_b16 v[192:193], v4 offset:2056
  ds_read_b64_tr_b16 v[194:195], v4 offset:2184
  ds_read_b64_tr_b16 v[196:197], v4 offset:2568
  ds_read_b64_tr_b16 v[198:199], v4 offset:2696
  s_sub_u32 s23, s23, 1
  s_cmp_gt_u32 s23, 0
  s_cselect_b32 s26, s51, 0
  s_cselect_b32 s27, 0, 0x40000000
  v_or_b32 v21, s27, v21
  s_lshl_b32 s27, s26, 13
  s_add_u32 s19, s19, s27
  s_mul_i32 s27, s26, 131072
  s_add_u32 s20, s20, s27
  s_cmp_lg_u32 s23, 24
  s_cbranch_scc1 M_xok_202
  s_lshl_b32 s77, s48, 2
  s_add_u32 s77, s77, s16
  s_mul_i32 s78, s77, 896
  s_add_u32 s76, s78, 148898304
  s_mov_b32 s71, 0
  s_branch M_sg_204
M_sw_203:
  s_sleep 8
  s_add_u32 s71, s71, 1
  s_cmp_gt_u32 s71, 262144
  s_cbranch_scc1 M_exit
M_sg_204:
  s_mov_b32 s79, 0
  s_atomic_or s79, s[72:73], s76 glc
  s_waitcnt lgkmcnt(0)
  s_cmp_lt_u32 s79, 32
  s_cbranch_scc1 M_sw_203
  s_add_u32 s76, s78, 148898432
  s_mov_b32 s71, 0
  s_branch M_sg_206
M_sw_205:
  s_sleep 8
  s_add_u32 s71, s71, 1
  s_cmp_gt_u32 s71, 262144
  s_cbranch_scc1 M_exit
M_sg_206:
  s_mov_b32 s79, 0
  s_atomic_or s79, s[72:73], s76 glc
  s_waitcnt lgkmcnt(0)
  s_cmp_lt_u32 s79, 32
  s_cbranch_scc1 M_sw_205
  s_add_u32 s76, s78, 148898048
  s_mov_b32 s71, 0
  s_branch M_sg_208
M_sw_207:
  s_sleep 8
  s_add_u32 s71, s71, 1
  s_cmp_gt_u32 s71, 262144
  s_cbranch_scc1 M_exit
M_sg_208:
  s_mov_b32 s79, 0
  s_atomic_or s79, s[72:73], s76 glc
  s_waitcnt lgkmcnt(0)
  s_cmp_lt_u32 s79, 32
  s_cbranch_scc1 M_sw_207
  s_add_u32 s76, s78, 148898176
  s_mov_b32 s71, 0
  s_branch M_sg_210
M_sw_209:
  s_sleep 8
  s_add_u32 s71, s71, 1
  s_cmp_gt_u32 s71, 262144
  s_cbranch_scc1 M_exit
M_sg_210:
  s_mov_b32 s79, 0
  s_atomic_or s79, s[72:73], s76 glc
  s_waitcnt lgkmcnt(0)
  s_cmp_lt_u32 s79, 32
  s_cbranch_scc1 M_sw_209
M_xok_202:
  s_waitcnt lgkmcnt(10)
  v_mfma_f32_32x32x16_bf16 v[40:55], v[176:179], v[144:147], 0
  ds_read_b64_tr_b16 v[200:201], v4 offset:3080
  ds_read_b64_tr_b16 v[202:203], v4 offset:3208
  v_max_f32 v6, v24, v25
  s_waitcnt lgkmcnt(10)
  v_mfma_f32_32x32x16_bf16 v[40:55], v[180:183], v[148:151], v[40:55]
  ds_read_b64_tr_b16 v[204:205], v4 offset:3592
  ds_read_b64_tr_b16 v[206:207], v4 offset:3720
  v_max3_f32 v6, v6, v26, v27
  s_waitcnt lgkmcnt(10)
  v_mfma_f32_32x32x16_bf16 v[40:55], v[184:187], v[152:155], v[40:55]
  ds_read_b64 v[56:57], v5 offset:0
  ds_read_b64 v[58:59], v5 offset:1024
  v_max3_f32 v6, v6, v28, v29
  s_waitcnt lgkmcnt(10)
  v_mfma_f32_32x32x16_bf16 v[40:55], v[188:191], v[156:159], v[40:55]
  ds_read_b64 v[60:61], v5 offset:2048
  ds_read_b64 v[62:63], v5 offset:3072
  v_max3_f32 v6, v6, v30, v31
  s_waitcnt lgkmcnt(10)
  v_mfma_f32_32x32x16_bf16 v[40:55], v[192:195], v[160:163], v[40:55]
  v_max3_f32 v6, v6, v32, v33
  s_waitcnt lgkmcnt(8)
  v_mfma_f32_32x32x16_bf16 v[40:55], v[196:199], v[164:167], v[40:55]
  v_max3_f32 v6, v6, v34, v35
  s_waitcnt lgkmcnt(6)
  v_mfma_f32_32x32x16_bf16 v[40:55], v[200:203], v[168:171], v[40:55]
  v_max3_f32 v6, v6, v36, v37
  s_waitcnt lgkmcnt(4)
  v_mfma_f32_32x32x16_bf16 v[40:55], v[204:207], v[172:175], v[40:55]
  v_max3_f32 v6, v6, v38, v39
  s_add_u32 s28, s19, 50331648
  buffer_load_dwordx4 v[144:147], v21, s[4:7], s28 offen offset:0 sc1
  buffer_load_dwordx4 v[148:151], v21, s[4:7], s28 offen offset:1024 sc1
  s_nop 7
  v_max3_f32 v6, v6, v40, v41
  v_max3_f32 v6, v6, v42, v43
  v_mov_b32 v16, v6
  s_nop 1
  v_permlane32_swap_b32 v6, v16
  s_nop 1
  v_max_f32 v6, v6, v16
  v_pk_add_f32 v[24:25], v[24:25], v[6:7] op_sel_hi:[1,0] neg_lo:[0,1] neg_hi:[0,1]
  v_pk_add_f32 v[26:27], v[26:27], v[6:7] op_sel_hi:[1,0] neg_lo:[0,1] neg_hi:[0,1]
  v_pk_add_f32 v[28:29], v[28:29], v[6:7] op_sel_hi:[1,0] neg_lo:[0,1] neg_hi:[0,1]
  v_pk_add_f32 v[30:31], v[30:31], v[6:7] op_sel_hi:[1,0] neg_lo:[0,1] neg_hi:[0,1]
  v_pk_add_f32 v[32:33], v[32:33], v[6:7] op_sel_hi:[1,0] neg_lo:[0,1] neg_hi:[0,1]
  v_pk_add_f32 v[34:35], v[34:35], v[6:7] op_sel_hi:[1,0] neg_lo:[0,1] neg_hi:[0,1]
  v_pk_add_f32 v[36:37], v[36:37], v[6:7] op_sel_hi:[1,0] neg_lo:[0,1] neg_hi:[0,1]
  v_pk_add_f32 v[38:39], v[38:39], v[6:7] op_sel_hi:[1,0] neg_lo:[0,1] neg_hi:[0,1]
  v_pk_add_f32 v[40:41], v[40:41], v[6:7] op_sel_hi:[1,0] neg_lo:[0,1] neg_hi:[0,1]
  v_pk_add_f32 v[42:43], v[42:43], v[6:7] op_sel_hi:[1,0] neg_lo:[0,1] neg_hi:[0,1]
  v_exp_f32 v24, v24
  v_exp_f32 v25, v25
  v_exp_f32 v26, v26
  v_exp_f32 v27, v27
  v_exp_f32 v28, v28
  v_exp_f32 v29, v29
  v_exp_f32 v30, v30
  v_exp_f32 v31, v31
  v_exp_f32 v32, v32
  v_exp_f32 v33, v33
  buffer_load_dwordx4 v[152:155], v21, s[4:7], s28 offen offset:2048 sc1
  v_exp_f32 v34, v34
  v_exp_f32 v35, v35
  v_exp_f32 v36, v36
  v_exp_f32 v37, v37
  v_exp_f32 v38, v38
  v_exp_f32 v39, v39
  v_exp_f32 v40, v40
  v_exp_f32 v41, v41
  v_exp_f32 v42, v42
  v_exp_f32 v43, v43
  v_pk_add_f32 v[16:17], v[24:25], v[26:27]
  v_pk_add_f32 v[16:17], v[16:17], v[28:29]
  v_pk_add_f32 v[16:17], v[16:17], v[30:31]
  v_pk_add_f32 v[16:17], v[16:17], v[32:33]
  v_pk_add_f32 v[16:17], v[16:17], v[34:35]
  v_pk_add_f32 v[16:17], v[16:17], v[36:37]
  v_pk_add_f32 v[16:17], v[16:17], v[38:39]
  v_pk_add_f32 v[16:17], v[16:17], v[40:41]
  v_pk_add_f32 v[16:17], v[16:17], v[42:43]
  v_add_f32 v16, v16, v17
  v_mov_b32 v17, v16
  buffer_load_dwordx4 v[156:159], v21, s[4:7], s28 offen offset:3072 sc1
  s_nop 0
  v_permlane32_swap_b32 v16, v17
  s_nop 1
  v_add_f32 v16, v16, v17
  v_rcp_f32 v6, v16
  s_nop 0
  v_pk_mul_f32 v[24:25], v[24:25], v[6:7] op_sel_hi:[1,0]
  v_pk_mul_f32 v[26:27], v[26:27], v[6:7] op_sel_hi:[1,0]
  v_pk_mul_f32 v[28:29], v[28:29], v[6:7] op_sel_hi:[1,0]
  v_pk_mul_f32 v[30:31], v[30:31], v[6:7] op_sel_hi:[1,0]
  v_pk_mul_f32 v[32:33], v[32:33], v[6:7] op_sel_hi:[1,0]
  v_pk_mul_f32 v[34:35], v[34:35], v[6:7] op_sel_hi:[1,0]
  v_pk_mul_f32 v[36:37], v[36:37], v[6:7] op_sel_hi:[1,0]
  v_pk_mul_f32 v[38:39], v[38:39], v[6:7] op_sel_hi:[1,0]
  v_pk_mul_f32 v[40:41], v[40:41], v[6:7] op_sel_hi:[1,0]
  v_pk_mul_f32 v[42:43], v[42:43], v[6:7] op_sel_hi:[1,0]
  v_cvt_pk_bf16_f32 v128, v24, v25
  v_cvt_pk_bf16_f32 v129, v26, v27
  v_cvt_pk_bf16_f32 v130, v28, v29
  v_cvt_pk_bf16_f32 v131, v30, v31
  v_cvt_pk_bf16_f32 v132, v32, v33
  v_cvt_pk_bf16_f32 v133, v34, v35
  v_cvt_pk_bf16_f32 v134, v36, v37
  v_cvt_pk_bf16_f32 v135, v38, v39
  v_cvt_pk_bf16_f32 v136, v40, v41
  v_cvt_pk_bf16_f32 v137, v42, v43
  s_waitcnt vmcnt(8) lgkmcnt(0)
  v_mfma_f32_32x32x16_bf16 v[64:79], v[208:211], v[128:131], 0
  s_add_u32 s29, s19, 50335744
  buffer_load_dwordx4 v[160:163], v21, s[4:7], s29 offen offset:0 sc1
  v_mfma_f32_32x32x16_bf16 v[64:79], v[212:215], v[132:135], v[64:79]
  v_mfma_f32_32x32x8_bf16 v[64:79], v[56:57], v[136:137], v[64:79]
  v_mfma_f32_32x32x16_bf16 v[80:95], v[216:219], v[128:131], 0
  buffer_load_dwordx4 v[164:167], v21, s[4:7], s29 offen offset:1024 sc1
  v_mfma_f32_32x32x16_bf16 v[80:95], v[220:223], v[132:135], v[80:95]
  v_cvt_pk_bf16_f32 v24, v64, v65
  v_cvt_pk_bf16_f32 v25, v66, v67
  v_cvt_pk_bf16_f32 v26, v68, v69
  v_cvt_pk_bf16_f32 v27, v70, v71
  v_mfma_f32_32x32x8_bf16 v[80:95], v[58:59], v[136:137], v[80:95]
  ds_write_b128 v3, v[24:27] offset:0
  v_cvt_pk_bf16_f32 v28, v72, v73
  v_cvt_pk_bf16_f32 v29, v74, v75
  v_cvt_pk_bf16_f32 v30, v76, v77
  v_cvt_pk_bf16_f32 v31, v78, v79
  v_mfma_f32_32x32x16_bf16 v[96:111], v[224:227], v[128:131], 0
  ds_write_b128 v3, v[28:31] offset:1024
  buffer_load_dwordx4 v[168:171], v21, s[4:7], s29 offen offset:2048 sc1
  v_mfma_f32_32x32x16_bf16 v[96:111], v[228:231], v[132:135], v[96:111]
  v_cvt_pk_bf16_f32 v32, v80, v81
  v_cvt_pk_bf16_f32 v33, v82, v83
  v_cvt_pk_bf16_f32 v34, v84, v85
  v_cvt_pk_bf16_f32 v35, v86, v87
  v_mfma_f32_32x32x8_bf16 v[96:111], v[60:61], v[136:137], v[96:111]
  ds_write_b128 v3, v[32:35] offset:2048
  v_cvt_pk_bf16_f32 v36, v88, v89
  v_cvt_pk_bf16_f32 v37, v90, v91
  v_cvt_pk_bf16_f32 v38, v92, v93
  v_cvt_pk_bf16_f32 v39, v94, v95
  v_mfma_f32_32x32x16_bf16 v[112:127], v[232:235], v[128:131], 0
  ds_write_b128 v3, v[36:39] offset:3072
  buffer_load_dwordx4 v[172:175], v21, s[4:7], s29 offen offset:3072 sc1
  v_mfma_f32_32x32x16_bf16 v[112:127], v[236:239], v[132:135], v[112:127]
  v_cvt_pk_bf16_f32 v40, v96, v97
  v_cvt_pk_bf16_f32 v41, v98, v99
  v_cvt_pk_bf16_f32 v42, v100, v101
  v_cvt_pk_bf16_f32 v43, v102, v103
  v_mfma_f32_32x32x8_bf16 v[112:127], v[62:63], v[136:137], v[112:127]
  ds_write_b128 v3, v[40:43] offset:4096
  v_cvt_pk_bf16_f32 v44, v104, v105
  v_cvt_pk_bf16_f32 v45, v106, v107
  v_cvt_pk_bf16_f32 v46, v108, v109
  v_cvt_pk_bf16_f32 v47, v110, v111
  ds_write_b128 v3, v[44:47] offset:5120
  s_nop 5
  v_cvt_pk_bf16_f32 v48, v112, v113
  v_cvt_pk_bf16_f32 v49, v114, v115
  v_cvt_pk_bf16_f32 v50, v116, v117
  v_cvt_pk_bf16_f32 v51, v118, v119
  ds_write_b128 v3, v[48:51] offset:6144
  v_cvt_pk_bf16_f32 v52, v120, v121
  v_cvt_pk_bf16_f32 v53, v122, v123
  v_cvt_pk_bf16_f32 v54, v124, v125
  v_cvt_pk_bf16_f32 v55, v126, v127
  ds_write_b128 v3, v[52:55] offset:7168
  s_waitcnt vmcnt(8)
  s_waitcnt lgkmcnt(0)
  s_barrier
  ds_read_b128 v[24:27], v8 offset:0
  ds_read_b128 v[28:31], v9 offset:0
  ds_read_b128 v[32:35], v10 offset:0
  ds_read_b128 v[36:39], v11 offset:0
  ds_read_b128 v[40:43], v12 offset:0
  ds_read_b128 v[44:47], v13 offset:0
  buffer_load_dword v23, off, s[4:7], s54 sc1
  v_mov_b32 v16, s30
  v_min_u32 v17, 1, v0
  v_lshlrev_b32 v17, 30, v17
  buffer_store_dword v16, v17, s[4:7], s31 offen sc1
  s_add_u32 s30, s30, 1
  s_add_u32 s52, s52, 2
  s_waitcnt lgkmcnt(5)
  v_mfma_f32_16x16x32_bf16 v[64:67], a[0:3], v[24:27], 0
  s_add_u32 s28, s19, 67108864
  ds_read_b128 v[48:51], v14 offset:0
  v_mfma_f32_16x16x32_bf16 v[68:71], a[4:7], v[24:27], 0
  v_mfma_f32_16x16x32_bf16 v[80:83], a[8:11], v[24:27], 0
  v_mfma_f32_16x16x32_bf16 v[84:87], a[12:15], v[24:27], 0
  s_waitcnt lgkmcnt(5)
  v_mfma_f32_16x16x32_bf16 v[72:75], a[0:3], v[28:31], 0
  ds_read_b128 v[52:55], v15 offset:0
  v_mfma_f32_16x16x32_bf16 v[76:79], a[4:7], v[28:31], 0
  v_mfma_f32_16x16x32_bf16 v[88:91], a[8:11], v[28:31], 0
  buffer_load_dwordx4 v[176:179], v21, s[4:7], s28 offen offset:0 sc1
  v_mfma_f32_16x16x32_bf16 v[92:95], a[12:15], v[28:31], 0
  s_waitcnt lgkmcnt(5)
  v_mfma_f32_16x16x32_bf16 v[64:67], a[16:19], v[32:35], v[64:67]
  ds_read_b128 v[24:27], v8 offset:8192
  v_mfma_f32_16x16x32_bf16 v[68:71], a[20:23], v[32:35], v[68:71]
  v_mfma_f32_16x16x32_bf16 v[80:83], a[24:27], v[32:35], v[80:83]
  v_mfma_f32_16x16x32_bf16 v[84:87], a[28:31], v[32:35], v[84:87]
  s_waitcnt lgkmcnt(5)
  v_mfma_f32_16x16x32_bf16 v[72:75], a[16:19], v[36:39], v[72:75]
  ds_read_b128 v[28:31], v9 offset:8192
  v_mfma_f32_16x16x32_bf16 v[76:79], a[20:23], v[36:39], v[76:79]
  v_mfma_f32_16x16x32_bf16 v[88:91], a[24:27], v[36:39], v[88:91]
  buffer_load_dwordx4 v[180:183], v21, s[4:7], s28 offen offset:1024 sc1
  v_mfma_f32_16x16x32_bf16 v[92:95], a[28:31], v[36:39], v[92:95]
  s_waitcnt lgkmcnt(5)
  v_mfma_f32_16x16x32_bf16 v[64:67], a[32:35], v[40:43], v[64:67]
  ds_read_b128 v[32:35], v10 offset:8192
  v_mfma_f32_16x16x32_bf16 v[68:71], a[36:39], v[40:43], v[68:71]
  v_mfma_f32_16x16x32_bf16 v[80:83], a[40:43], v[40:43], v[80:83]
  v_mfma_f32_16x16x32_bf16 v[84:87], a[44:47], v[40:43], v[84:87]
  s_waitcnt lgkmcnt(5)
  v_mfma_f32_16x16x32_bf16 v[72:75], a[32:35], v[44:47], v[72:75]
  ds_read_b128 v[36:39], v11 offset:8192
  v_mfma_f32_16x16x32_bf16 v[76:79], a[36:39], v[44:47], v[76:79]
  v_mfma_f32_16x16x32_bf16 v[88:91], a[40:43], v[44:47], v[88:91]
  buffer_load_dwordx4 v[184:187], v21, s[4:7], s28 offen offset:2048 sc1
  v_mfma_f32_16x16x32_bf16 v[92:95], a[44:47], v[44:47], v[92:95]
  s_waitcnt lgkmcnt(5)
  v_mfma_f32_16x16x32_bf16 v[64:67], a[48:51], v[48:51], v[64:67]
  ds_read_b128 v[40:43], v12 offset:8192
  v_mfma_f32_16x16x32_bf16 v[68:71], a[52:55], v[48:51], v[68:71]
  v_mfma_f32_16x16x32_bf16 v[80:83], a[56:59], v[48:51], v[80:83]
  v_mfma_f32_16x16x32_bf16 v[84:87], a[60:63], v[48:51], v[84:87]
  s_waitcnt lgkmcnt(5)
  v_mfma_f32_16x16x32_bf16 v[72:75], a[48:51], v[52:55], v[72:75]
  ds_read_b128 v[44:47], v13 offset:8192
  v_mfma_f32_16x16x32_bf16 v[76:79], a[52:55], v[52:55], v[76:79]
  v_mfma_f32_16x16x32_bf16 v[88:91], a[56:59], v[52:55], v[88:91]
  buffer_load_dwordx4 v[188:191], v21, s[4:7], s28 offen offset:3072 sc1
  v_mfma_f32_16x16x32_bf16 v[92:95], a[60:63], v[52:55], v[92:95]
  s_waitcnt lgkmcnt(5)
  v_mfma_f32_16x16x32_bf16 v[64:67], a[64:67], v[24:27], v[64:67]
  s_add_u32 s29, s19, 67112960
  ds_read_b128 v[48:51], v14 offset:8192
  v_mfma_f32_16x16x32_bf16 v[68:71], a[68:71], v[24:27], v[68:71]
  v_mfma_f32_16x16x32_bf16 v[80:83], a[72:75], v[24:27], v[80:83]
  v_mfma_f32_16x16x32_bf16 v[84:87], a[76:79], v[24:27], v[84:87]
  s_waitcnt lgkmcnt(5)
  v_mfma_f32_16x16x32_bf16 v[72:75], a[64:67], v[28:31], v[72:75]
  ds_read_b128 v[52:55], v15 offset:8192
  v_mfma_f32_16x16x32_bf16 v[76:79], a[68:71], v[28:31], v[76:79]
  v_mfma_f32_16x16x32_bf16 v[88:91], a[72:75], v[28:31], v[88:91]
  buffer_load_dwordx4 v[192:195], v21, s[4:7], s29 offen offset:0 sc1
  v_mfma_f32_16x16x32_bf16 v[92:95], a[76:79], v[28:31], v[92:95]
  s_waitcnt lgkmcnt(5)
  v_mfma_f32_16x16x32_bf16 v[64:67], a[80:83], v[32:35], v[64:67]
  ds_read_b128 v[24:27], v8 offset:16384
  v_mfma_f32_16x16x32_bf16 v[68:71], a[84:87], v[32:35], v[68:71]
  v_mfma_f32_16x16x32_bf16 v[80:83], a[88:91], v[32:35], v[80:83]
  v_mfma_f32_16x16x32_bf16 v[84:87], a[92:95], v[32:35], v[84:87]
  s_waitcnt lgkmcnt(5)
  v_mfma_f32_16x16x32_bf16 v[72:75], a[80:83], v[36:39], v[72:75]
  ds_read_b128 v[28:31], v9 offset:16384
  v_mfma_f32_16x16x32_bf16 v[76:79], a[84:87], v[36:39], v[76:79]
  v_mfma_f32_16x16x32_bf16 v[88:91], a[88:91], v[36:39], v[88:91]
  buffer_load_dwordx4 v[196:199], v21, s[4:7], s29 offen offset:1024 sc1
  v_mfma_f32_16x16x32_bf16 v[92:95], a[92:95], v[36:39], v[92:95]
  s_waitcnt lgkmcnt(5)
  v_mfma_f32_16x16x32_bf16 v[64:67], a[96:99], v[40:43], v[64:67]
  ds_read_b128 v[32:35], v10 offset:16384
  v_mfma_f32_16x16x32_bf16 v[68:71], a[100:103], v[40:43], v[68:71]
  v_mfma_f32_16x16x32_bf16 v[80:83], a[104:107], v[40:43], v[80:83]
  v_mfma_f32_16x16x32_bf16 v[84:87], a[108:111], v[40:43], v[84:87]
  s_waitcnt lgkmcnt(5)
  s_waitcnt vmcnt(7)
  v_readfirstlane_b32 s53, v23
  s_nop 0
  s_cmp_ge_u32 s53, s52
  s_cselect_b32 s24, 1, 0
  s_cbranch_scc0 F_nopre_211
  s_mov_b32 m0, s25
  s_nop 0
  buffer_load_dwordx4 v2, s[4:7], s20 offen offset:0 sc1 lds
  buffer_load_dwordx4 v2, s[4:7], s20 offen offset:1024 sc1 lds
  buffer_load_dwordx4 v2, s[4:7], s20 offen offset:2048 sc1 lds
  buffer_load_dwordx4 v2, s[4:7], s20 offen offset:3072 sc1 lds
F_nopre_211:
  v_mfma_f32_16x16x32_bf16 v[72:75], a[96:99], v[44:47], v[72:75]
  ds_read_b128 v[36:39], v11 offset:16384
  v_mfma_f32_16x16x32_bf16 v[76:79], a[100:103], v[44:47], v[76:79]
  v_mfma_f32_16x16x32_bf16 v[88:91], a[104:107], v[44:47], v[88:91]
  buffer_load_dwordx4 v[200:203], v21, s[4:7], s29 offen offset:2048 sc1
  v_mfma_f32_16x16x32_bf16 v[92:95], a[108:111], v[44:47], v[92:95]
  s_waitcnt lgkmcnt(5)
  v_mfma_f32_16x16x32_bf16 v[64:67], a[112:115], v[48:51], v[64:67]
  ds_read_b128 v[40:43], v12 offset:16384
  v_mfma_f32_16x16x32_bf16 v[68:71], a[116:119], v[48:51], v[68:71]
  v_mfma_f32_16x16x32_bf16 v[80:83], a[120:123], v[48:51], v[80:83]
  v_mfma_f32_16x16x32_bf16 v[84:87], a[124:127], v[48:51], v[84:87]
  s_waitcnt lgkmcnt(5)
  v_mfma_f32_16x16x32_bf16 v[72:75], a[112:115], v[52:55], v[72:75]
  ds_read_b128 v[44:47], v13 offset:16384
  v_mfma_f32_16x16x32_bf16 v[76:79], a[116:119], v[52:55], v[76:79]
  v_mfma_f32_16x16x32_bf16 v[88:91], a[120:123], v[52:55], v[88:91]
  buffer_load_dwordx4 v[204:207], v21, s[4:7], s29 offen offset:3072 sc1
  v_mfma_f32_16x16x32_bf16 v[92:95], a[124:127], v[52:55], v[92:95]
  s_waitcnt lgkmcnt(5)
  v_mfma_f32_16x16x32_bf16 v[64:67], a[128:131], v[24:27], v[64:67]
  s_add_u32 s28, s19, 83886080
  ds_read_b128 v[48:51], v14 offset:16384
  v_mfma_f32_16x16x32_bf16 v[68:71], a[132:135], v[24:27], v[68:71]
  v_mfma_f32_16x16x32_bf16 v[80:83], a[136:139], v[24:27], v[80:83]
  v_mfma_f32_16x16x32_bf16 v[84:87], a[140:143], v[24:27], v[84:87]
  s_waitcnt lgkmcnt(5)
  v_mfma_f32_16x16x32_bf16 v[72:75], a[128:131], v[28:31], v[72:75]
  ds_read_b128 v[52:55], v15 offset:16384
  v_mfma_f32_16x16x32_bf16 v[76:79], a[132:135], v[28:31], v[76:79]
  v_mfma_f32_16x16x32_bf16 v[88:91], a[136:139], v[28:31], v[88:91]
  buffer_load_dwordx4 v[208:211], v21, s[4:7], s28 offen offset:0 sc1
  v_mfma_f32_16x16x32_bf16 v[92:95], a[140:143], v[28:31], v[92:95]
  s_waitcnt lgkmcnt(5)
  v_mfma_f32_16x16x32_bf16 v[64:67], a[144:147], v[32:35], v[64:67]
  ds_read_b128 v[24:27], v8 offset:24576
  v_mfma_f32_16x16x32_bf16 v[68:71], a[148:151], v[32:35], v[68:71]
  v_mfma_f32_16x16x32_bf16 v[80:83], a[152:155], v[32:35], v[80:83]
  v_mfma_f32_16x16x32_bf16 v[84:87], a[156:159], v[32:35], v[84:87]
  s_waitcnt lgkmcnt(5)
  v_mfma_f32_16x16x32_bf16 v[72:75], a[144:147], v[36:39], v[72:75]
  ds_read_b128 v[28:31], v9 offset:24576
  v_mfma_f32_16x16x32_bf16 v[76:79], a[148:151], v[36:39], v[76:79]
  v_mfma_f32_16x16x32_bf16 v[88:91], a[152:155], v[36:39], v[88:91]
  buffer_load_dwordx4 v[212:215], v21, s[4:7], s28 offen offset:1024 sc1
  v_mfma_f32_16x16x32_bf16 v[92:95], a[156:159], v[36:39], v[92:95]
  s_waitcnt lgkmcnt(5)
  v_mfma_f32_16x16x32_bf16 v[64:67], a[160:163], v[40:43], v[64:67]
  ds_read_b128 v[32:35], v10 offset:24576
  v_mfma_f32_16x16x32_bf16 v[68:71], a[164:167], v[40:43], v[68:71]
  v_mfma_f32_16x16x32_bf16 v[80:83], a[168:171], v[40:43], v[80:83]
  v_mfma_f32_16x16x32_bf16 v[84:87], a[172:175], v[40:43], v[84:87]
  s_waitcnt lgkmcnt(5)
  v_mfma_f32_16x16x32_bf16 v[72:75], a[160:163], v[44:47], v[72:75]
  ds_read_b128 v[36:39], v11 offset:24576
  v_mfma_f32_16x16x32_bf16 v[76:79], a[164:167], v[44:47], v[76:79]
  v_mfma_f32_16x16x32_bf16 v[88:91], a[168:171], v[44:47], v[88:91]
  buffer_load_dwordx4 v[216:219], v21, s[4:7], s28 offen offset:2048 sc1
  v_mfma_f32_16x16x32_bf16 v[92:95], a[172:175], v[44:47], v[92:95]
  s_waitcnt lgkmcnt(5)
  v_mfma_f32_16x16x32_bf16 v[64:67], a[176:179], v[48:51], v[64:67]
  ds_read_b128 v[40:43], v12 offset:24576
  v_mfma_f32_16x16x32_bf16 v[68:71], a[180:183], v[48:51], v[68:71]
  v_mfma_f32_16x16x32_bf16 v[80:83], a[184:187], v[48:51], v[80:83]
  v_mfma_f32_16x16x32_bf16 v[84:87], a[188:191], v[48:51], v[84:87]
  s_waitcnt lgkmcnt(5)
  v_mfma_f32_16x16x32_bf16 v[72:75], a[176:179], v[52:55], v[72:75]
  ds_read_b128 v[44:47], v13 offset:24576
  v_mfma_f32_16x16x32_bf16 v[76:79], a[180:183], v[52:55], v[76:79]
  v_mfma_f32_16x16x32_bf16 v[88:91], a[184:187], v[52:55], v[88:91]
  buffer_load_dwordx4 v[220:223], v21, s[4:7], s28 offen offset:3072 sc1
  v_mfma_f32_16x16x32_bf16 v[92:95], a[188:191], v[52:55], v[92:95]
  s_waitcnt lgkmcnt(5)
  v_mfma_f32_16x16x32_bf16 v[64:67], a[192:195], v[24:27], v[64:67]
  s_add_u32 s29, s19, 83890176
  ds_read_b128 v[48:51], v14 offset:24576
  v_mfma_f32_16x16x32_bf16 v[68:71], a[196:199], v[24:27], v[68:71]
  v_mfma_f32_16x16x32_bf16 v[80:83], a[200:203], v[24:27], v[80:83]
  v_mfma_f32_16x16x32_bf16 v[84:87], a[204:207], v[24:27], v[84:87]
  s_waitcnt lgkmcnt(5)
  v_mfma_f32_16x16x32_bf16 v[72:75], a[192:195], v[28:31], v[72:75]
  ds_read_b128 v[52:55], v15 offset:24576
  v_mfma_f32_16x16x32_bf16 v[76:79], a[196:199], v[28:31], v[76:79]
  v_mfma_f32_16x16x32_bf16 v[88:91], a[200:203], v[28:31], v[88:91]
  buffer_load_dwordx4 v[224:227], v21, s[4:7], s29 offen offset:0 sc1
  v_mfma_f32_16x16x32_bf16 v[92:95], a[204:207], v[28:31], v[92:95]
  s_waitcnt lgkmcnt(5)
  v_mfma_f32_16x16x32_bf16 v[64:67], a[208:211], v[32:35], v[64:67]
  v_mfma_f32_16x16x32_bf16 v[68:71], a[212:215], v[32:35], v[68:71]
  v_mfma_f32_16x16x32_bf16 v[80:83], a[216:219], v[32:35], v[80:83]
  v_mfma_f32_16x16x32_bf16 v[84:87], a[220:223], v[32:35], v[84:87]
  s_waitcnt lgkmcnt(4)
  v_mfma_f32_16x16x32_bf16 v[72:75], a[208:211], v[36:39], v[72:75]
  v_mfma_f32_16x16x32_bf16 v[76:79], a[212:215], v[36:39], v[76:79]
  v_xor_b32 v8, 0x8000, v8
  v_mfma_f32_16x16x32_bf16 v[88:91], a[216:219], v[36:39], v[88:91]
  buffer_load_dwordx4 v[228:231], v21, s[4:7], s29 offen offset:1024 sc1
  v_mfma_f32_16x16x32_bf16 v[92:95], a[220:223], v[36:39], v[92:95]
  s_waitcnt lgkmcnt(3)
  v_xor_b32 v9, 0x8000, v9
  v_mfma_f32_16x16x32_bf16 v[64:67], a[224:227], v[40:43], v[64:67]
  v_mfma_f32_16x16x32_bf16 v[68:71], a[228:231], v[40:43], v[68:71]
  v_xor_b32 v10, 0x8000, v10
  v_mfma_f32_16x16x32_bf16 v[80:83], a[232:235], v[40:43], v[80:83]
  v_mfma_f32_16x16x32_bf16 v[84:87], a[236:239], v[40:43], v[84:87]
  s_waitcnt lgkmcnt(2)
  v_xor_b32 v11, 0x8000, v11
  v_mfma_f32_16x16x32_bf16 v[72:75], a[224:227], v[44:47], v[72:75]
  v_mfma_f32_16x16x32_bf16 v[76:79], a[228:231], v[44:47], v[76:79]
  v_xor_b32 v12, 0x8000, v12
  v_mfma_f32_16x16x32_bf16 v[88:91], a[232:235], v[44:47], v[88:91]
  buffer_load_dwordx4 v[232:235], v21, s[4:7], s29 offen offset:2048 sc1
  v_mfma_f32_16x16x32_bf16 v[92:95], a[236:239], v[44:47], v[92:95]
  s_waitcnt lgkmcnt(1)
  v_xor_b32 v13, 0x8000, v13
  v_mfma_f32_16x16x32_bf16 v[64:67], a[240:243], v[48:51], v[64:67]
  v_mfma_f32_16x16x32_bf16 v[68:71], a[244:247], v[48:51], v[68:71]
  v_xor_b32 v14, 0x8000, v14
  v_mfma_f32_16x16x32_bf16 v[80:83], a[248:251], v[48:51], v[80:83]
  v_mfma_f32_16x16x32_bf16 v[84:87], a[252:255], v[48:51], v[84:87]
  s_waitcnt lgkmcnt(0)
  v_xor_b32 v15, 0x8000, v15
  v_mfma_f32_16x16x32_bf16 v[72:75], a[240:243], v[52:55], v[72:75]
  v_mfma_f32_16x16x32_bf16 v[76:79], a[244:247], v[52:55], v[76:79]
  v_xor_b32 v3, 0x8000, v3
  v_mfma_f32_16x16x32_bf16 v[88:91], a[248:251], v[52:55], v[88:91]
  buffer_load_dwordx4 v[236:239], v21, s[4:7], s29 offen offset:3072 sc1
  v_mfma_f32_16x16x32_bf16 v[92:95], a[252:255], v[52:55], v[92:95]
  s_cmp_gt_u32 s23, 0
  s_cbranch_scc1 F_top_194
  s_nop 2
  v_cvt_pk_bf16_f32 v128, v64, v65
  v_cvt_pk_bf16_f32 v129, v66, v67
  v_cvt_pk_bf16_f32 v130, v68, v69
  v_cvt_pk_bf16_f32 v131, v70, v71
  buffer_store_dwordx4 v[128:131], v22, s[4:7], s21 offen offset:0 sc1
  v_cvt_pk_bf16_f32 v132, v72, v73
  v_cvt_pk_bf16_f32 v133, v74, v75
  v_cvt_pk_bf16_f32 v134, v76, v77
  v_cvt_pk_bf16_f32 v135, v78, v79
  buffer_store_dwordx4 v[132:135], v22, s[4:7], s21 offen offset:256 sc1
  v_cvt_pk_bf16_f32 v136, v80, v81
  v_cvt_pk_bf16_f32 v137, v82, v83
  v_cvt_pk_bf16_f32 v138, v84, v85
  v_cvt_pk_bf16_f32 v139, v86, v87
  buffer_store_dwordx4 v[136:139], v22, s[4:7], s21 offen offset:2048 sc1
  v_cvt_pk_bf16_f32 v140, v88, v89
  v_cvt_pk_bf16_f32 v141, v90, v91
  v_cvt_pk_bf16_f32 v142, v92, v93
  v_cvt_pk_bf16_f32 v143, v94, v95
  buffer_store_dwordx4 v[140:143], v22, s[4:7], s21 offen offset:2304 sc1
  s_waitcnt vmcnt(0) lgkmcnt(0)
  s_barrier
  v_mov_b32 v144, s30
  v_min_u32 v145, 1, v0
  v_lshlrev_b32 v145, 30, v145
  buffer_store_dword v144, v145, s[4:7], s31 offen sc1
M_done:
M_exit:
  s_endpgm
.p2align 6
.type M_table,@object
M_table:
.long 0x1, 0x3f, 0xffffffff, 0x17, 0x1, 0x7, 0x800, 0x0, 0x8, 0x0, 0x0, 0x0, 0x0, 0x0, 0x0, 0x0
.long 0x1, 0x28, 0xffffffff, 0x1b, 0x1, 0x6, 0x1000, 0x0, 0x8, 0x1, 0x0, 0x0, 0x0, 0x0, 0x0, 0x0
.long 0x2, 0x0, 0x2, 0x20, 0x1, 0x5, 0x1800, 0x0, 0x8, 0x0, 0x0, 0x0, 0x0, 0x0, 0x0, 0x0
.long 0x2, 0x1, 0x2, 0x20, 0x1, 0x4, 0x2000, 0x0, 0x8, 0x1, 0x0, 0x0, 0x0, 0x0, 0x0, 0x0
.long 0x0, 0x0, 0x1, 0x20, 0x2, 0x3, 0x20, 0x0, 0x8, 0x2, 0x0, 0x0, 0x0, 0x0, 0x0, 0x0
.long 0x0, 0x3f, 0xffffffff, 0x20, 0x2, 0x2, 0x18, 0x1, 0x10, 0x0, 0x0, 0x0, 0x0, 0x0, 0x0, 0x0
.long 0x1, 0xd, 0xffffffff, 0xe, 0x0, 0x0, 0x8, 0x0, 0x8, 0x2, 0x0, 0x0, 0x0, 0x0, 0x0, 0x0
.size M_table, 448
.section .rodata,"a"
.p2align 6
.amdhsa_kernel gated_mix__compressed_kv_cla__memory_aug_recurrent_mem_tr__prompt_kernel
.amdhsa_next_free_vgpr 512
.amdhsa_next_free_sgpr 102
.amdhsa_accum_offset 256
.amdhsa_group_segment_fixed_size 0
.amdhsa_kernarg_size 136
.amdhsa_user_sgpr_count 2
.amdhsa_user_sgpr_kernarg_segment_ptr 1
.amdhsa_system_sgpr_workgroup_id_x 1
.end_amdhsa_kernel
```

```asm
; @launch grid=(256,1,1) block=(256,1,1) lds=163840
.amdgcn_target "amdgcn-amd-amdhsa--gfx950"
.text
.globl gated_mix__compressed_kv_cla__memory_aug_recurrent_mem_tr__prompt_kernel
.p2align 8
.type gated_mix__compressed_kv_cla__memory_aug_recurrent_mem_tr__prompt_kernel,@function
gated_mix__compressed_kv_cla__memory_aug_recurrent_mem_tr__prompt_kernel:
  s_cmp_ge_u32 s2, 256
  s_cbranch_scc1 M_exit
  s_getpc_b64 s[60:61]
M_pc0:
  s_lshr_b32 s62, s2, 3
  s_and_b32 s62, s62, 3
  s_lshl_b32 s62, s62, 15
  v_lshl_add_u32 v104, v0, 7, s62
  v_min_u32 v104, M_table-M_pc0, v104
  global_load_dword v105, v104, s[60:61]
  s_lshr_b32 s77, s2, 3
  s_and_b32 s76, s2, 7
  s_cbranch_scc1 M_worker
  s_mov_b32 s12, s77
  s_load_dwordx4 s[60:63], s[0:1], 64
  s_load_dwordx4 s[64:67], s[0:1], 80
  s_load_dwordx4 s[68:71], s[0:1], 120
  s_load_dwordx2 s[72:73], s[0:1], 56
  v_lshrrev_b32 v1, 6, v0
  v_and_b32 v20, 63, v0
  v_readfirstlane_b32 s13, v1
  v_lshrrev_b32 v26, 3, v20
  v_lshlrev_b32 v26, 10, v26
  v_and_b32 v1, 7, v20
  v_lshl_add_u32 v26, v1, 4, v26
  s_lshl_b32 s36, s13, 7
  s_lshl_b32 s38, s12, 17
  s_add_u32 s36, s36, s38
  v_add_u32 v26, s36, v26
  s_lshl_b32 s39, s13, 15
  s_add_u32 s39, s39, 32768
  s_waitcnt lgkmcnt(0)
  s_mov_b32 s48, s66
  s_and_b32 s49, s67, 0xffff
  s_mov_b32 s50, 0x400000
  s_mov_b32 s51, 0x20000
  s_xor_b32 s36, s13, 0
  s_lshl_b32 s36, s36, 15
  s_add_u32 m0, s39, 28672
  s_add_u32 s37, s36, 0
  buffer_load_dwordx4 v26, s[48:51], s37 offen lds
  s_add_u32 m0, s39, 29696
  s_add_u32 s37, s36, 8192
  buffer_load_dwordx4 v26, s[48:51], s37 offen lds
  s_add_u32 m0, s39, 30720
  s_add_u32 s37, s36, 16384
  buffer_load_dwordx4 v26, s[48:51], s37 offen lds
  s_add_u32 m0, s39, 31744
  s_add_u32 s37, s36, 24576
  buffer_load_dwordx4 v26, s[48:51], s37 offen lds
  s_xor_b32 s36, s13, 0
  s_lshl_b32 s36, s36, 15
  s_add_u32 m0, s39, 24576
  s_add_u32 s37, s36, 512
  buffer_load_dwordx4 v26, s[48:51], s37 offen lds
  s_add_u32 m0, s39, 25600
  s_add_u32 s37, s36, 8704
  buffer_load_dwordx4 v26, s[48:51], s37 offen lds
  s_add_u32 m0, s39, 26624
  s_add_u32 s37, s36, 16896
  buffer_load_dwordx4 v26, s[48:51], s37 offen lds
  s_add_u32 m0, s39, 27648
  s_add_u32 s37, s36, 25088
  buffer_load_dwordx4 v26, s[48:51], s37 offen lds
  s_xor_b32 s36, s13, 1
  s_lshl_b32 s36, s36, 15
  s_add_u32 m0, s39, 12288
  s_add_u32 s37, s36, 0
  buffer_load_dwordx4 v26, s[48:51], s37 offen lds
  s_add_u32 m0, s39, 13312
  s_add_u32 s37, s36, 8192
  buffer_load_dwordx4 v26, s[48:51], s37 offen lds
  s_add_u32 m0, s39, 14336
  s_add_u32 s37, s36, 16384
  buffer_load_dwordx4 v26, s[48:51], s37 offen lds
  s_add_u32 m0, s39, 15360
  s_add_u32 s37, s36, 24576
  buffer_load_dwordx4 v26, s[48:51], s37 offen lds
  s_xor_b32 s36, s13, 1
  s_lshl_b32 s36, s36, 15
  s_add_u32 m0, s39, 8192
  s_add_u32 s37, s36, 512
  buffer_load_dwordx4 v26, s[48:51], s37 offen lds
  s_add_u32 m0, s39, 9216
  s_add_u32 s37, s36, 8704
  buffer_load_dwordx4 v26, s[48:51], s37 offen lds
  s_add_u32 m0, s39, 10240
  s_add_u32 s37, s36, 16896
  buffer_load_dwordx4 v26, s[48:51], s37 offen lds
  s_add_u32 m0, s39, 11264
  s_add_u32 s37, s36, 25088
  buffer_load_dwordx4 v26, s[48:51], s37 offen lds
  s_mov_b32 s8, s60
  s_and_b32 s9, s61, 0xffff
  s_mov_b32 s10, 0x400000
  s_mov_b32 s11, 0x20000
  s_mov_b32 s40, s62
  s_and_b32 s41, s63, 0xffff
  s_mov_b32 s42, 0x400000
  s_mov_b32 s43, 0x20000
  s_mov_b32 s44, s64
  s_and_b32 s45, s65, 0xffff
  s_mov_b32 s46, 0x400000
  s_mov_b32 s47, 0x20000
  s_mov_b32 s4, s70
  s_and_b32 s5, s71, 0xffff
  s_mov_b32 s6, 0x10000000
  s_mov_b32 s7, 0x20000
  s_mov_b32 s76, s72
  s_and_b32 s77, s73, 0xffff
  s_mov_b32 s78, 0x2000
  s_mov_b32 s79, 0x20000
  s_mov_b32 s72, s68
  s_and_b32 s73, s69, 0xffff
  s_mov_b32 s74, 0x100
  s_mov_b32 s75, 0x20000
  s_mov_b64 s[52:53], s[68:69]
  s_mov_b64 s[58:59], s[70:71]
  s_mul_i32 s99, s12, 896
  s_add_u32 s99, s99, 148898048
  s_lshl_b32 s15, s12, 7
  s_add_u32 s15, s15, 148926464
  v_lshrrev_b32 v21, 4, v20
  v_and_b32 v22, 15, v20
  v_and_b32 v23, 1, v21
  v_lshrrev_b32 v24, 1, v21
  v_lshlrev_b32 v2, 4, v20
  s_lshl_b32 s36, s13, 10
  v_add_u32 v59, s36, v2
  s_mov_b32 s37, s39
  v_add_u32 v4, s37, v2
  v_lshrrev_b32 v25, 2, v20
  v_lshlrev_b32 v25, 13, v25
  v_and_b32 v1, 3, v20
  v_lshl_add_u32 v25, v1, 4, v25
  s_lshl_b32 s36, s13, 6
  s_lshl_b32 s38, s12, 8
  s_add_u32 s36, s36, s38
  v_add_u32 v25, s36, v25
  v_bfe_u32 v29, v20, 2, 1
  v_bfe_u32 v30, v20, 3, 1
  v_and_b32 v31, 3, v20
  v_lshl_add_u32 v27, v21, 2, v29
  v_lshlrev_b32 v27, 6, v27
  v_lshl_add_u32 v27, v30, 5, v27
  v_lshl_add_u32 v27, v31, 3, v27
  v_add_u32 v27, s37, v27
  v_xor_b32 v36, 1, v30
  v_lshl_add_u32 v36, v36, 11, v27
  v_lshl_add_u32 v27, v30, 11, v27
  v_lshl_add_u32 v28, v23, 2, v24
  v_lshl_add_u32 v28, v28, 2, v29
  v_lshlrev_b32 v28, 7, v28
  v_lshl_add_u32 v28, v30, 6, v28
  v_lshl_add_u32 v28, v31, 4, v28
  v_add_u32 v28, s37, v28
  v_lshrrev_b32 v25, 3, v20
  v_lshlrev_b32 v25, 13, v25
  v_and_b32 v1, 7, v20
  v_lshl_add_u32 v25, v1, 4, v25
  s_lshr_b32 s36, s13, 1
  s_lshl1_add_u32 s36, s12, s36
  s_lshl_b32 s36, s36, 7
  v_add_u32 v25, s36, v25
  v_lshl_add_u32 v27, v21, 2, v29
  v_lshlrev_b32 v27, 7, v27
  v_lshl_add_u32 v27, v30, 5, v27
  v_lshl_add_u32 v27, v31, 3, v27
  s_and_b32 s36, s13, 1
  s_lshl_b32 s36, s36, 6
  s_xor_b32 s37, s13, 1
  s_lshl_b32 s37, s37, 15
  s_add_u32 s37, s37, s36
  s_add_u32 s37, s37, 32768
  s_add_u32 s36, s36, s39
  v_add_u32 v36, s37, v27
  v_add_u32 v27, s36, v27
  v_lshlrev_b32 v101, 12, v30
  v_xor_b32 v100, 0x1000, v101
  v_mov_b32 v0, 0x4444
  v_mov_b32 v1, 0xeeee
  v_cmp_lt_u32 vcc, 7, v22
  s_nop 1
  v_cndmask_b32 v32, v0, v1, vcc
  v_mov_b32 v0, v32
  v_and_b32 v32, 7, v20
  v_lshlrev_b32 v32, 4, v32
  v_lshl_add_u32 v11, v21, 7, v32
  v_xor_b32 v1, 128, v2
  v_lshl_add_u32 v33, v24, 4, v22
  s_lshl_b32 s36, s13, 5
  v_add_u32 v33, s36, v33
  v_lshlrev_b32 v33, 3, v33
  v_mul_u32_u24 v34, 1152, v23
  v_add_u32 v5, v33, v34
  v_bfe_u32 v33, v20, 2, 2
  v_lshl_add_u32 v33, v23, 2, v33
  v_lshl_add_u32 v33, v24, 4, v33
  v_lshlrev_b32 v33, 3, v33
  v_and_b32 v34, 1, v20
  v_mul_u32_u24 v34, 1152, v34
  v_add_u32 v6, v33, v34
  s_lshl_b32 s36, s13, 3
  v_lshrrev_b32 v33, 3, v20
  v_add_u32 v33, s36, v33
  v_mul_u32_u24 v34, 0, v33
  v_add_u32 v34, s12, v34
  v_and_b32 v34, 31, v34
  v_lshrrev_b32 v37, 1, v32
  v_lshl_add_u32 v33, v33, 13, v37
  v_lshl_add_u32 v7, v34, 7, v33
  v_and_b32 v37, 1, v20
  v_bfe_u32 v38, v20, 1, 1
  v_lshl_add_u32 v37, v29, 1, v37
  s_lshr_b32 s36, s12, 3
  s_lshl_b32 s36, s36, 10
  s_and_b32 s37, s12, 1
  s_lshl_b32 s37, s37, 9
  s_add_u32 s36, s36, s37
  s_and_b32 s37, s12, 6
  s_lshl_b32 s37, s37, 5
  s_add_u32 s36, s36, s37
  v_lshlrev_b32 v33, 4, v21
  v_lshl_add_u32 v33, v37, 2, v33
  v_lshl_add_u32 v33, v38, 8, v33
  v_lshl_add_u32 v33, v30, 30, v33
  v_add_u32 v8, s36, v33
  v_mov_b32 v39, v21
  s_lshr_b32 s36, s12, 2
  s_lshl_b32 s36, s36, 6
  s_and_b32 s37, s12, 1
  s_lshl_b32 s37, s37, 5
  s_add_u32 s36, s36, s37
  s_and_b32 s37, s12, 2
  s_lshl_b32 s37, s37, 11
  s_add_u32 s36, s36, s37
  v_lshlrev_b32 v35, 10, v39
  v_lshl_add_u32 v35, v37, 2, v35
  v_lshl_add_u32 v35, v38, 4, v35
  v_add_u32 v35, s36, v35
  buffer_load_ushort v44, v35, s[76:79], 0 offen offset:0
  buffer_load_ushort v45, v35, s[76:79], 0 offen offset:2
  buffer_load_ushort v46, v35, s[76:79], 0 offen offset:512
  buffer_load_ushort v47, v35, s[76:79], 0 offen offset:514
  v_lshlrev_b32 v33, 4, v29
  v_mov_b32 v34, 0x3f80
  v_lshlrev_b32 v33, v33, v34
  v_and_b32 v34, 1, v20
  v_lshl_add_u32 v34, v34, 1, v30
  v_cmp_eq_u32 vcc, 0, v34
  s_nop 1
  v_cndmask_b32 v48, 0, v33, vcc
  v_cmp_eq_u32 vcc, 1, v34
  s_nop 1
  v_cndmask_b32 v49, 0, v33, vcc
  v_cmp_eq_u32 vcc, 2, v34
  s_nop 1
  v_cndmask_b32 v50, 0, v33, vcc
  v_cmp_eq_u32 vcc, 3, v34
  s_nop 1
  v_cndmask_b32 v51, 0, v33, vcc
  ds_write_b128 v2, v[48:51] offset:31232
  v_lshlrev_b32 v33, 9, v21
  s_lshl_b32 s36, s13, 11
  v_add_u32 v33, s36, v33
  v_lshl_add_u32 v10, v22, 4, v33
  v_lshl_add_u32 v33, v30, 8, v33
  v_add_u32 v9, v33, v32
  v_mov_b32 v12, 0x3f803f80
  v_mov_b32 v13, 0x3f803f80
  v_mov_b32 v14, 0x3f803f80
  v_mov_b32 v15, 0x3f803f80
  s_mov_b32 s2, 0x3f803f80
  s_mov_b32 s3, 0x3f803f80
  s_mov_b32 s98, 0
  v_and_b32 v33, 1, v20
  v_mul_u32_u24 v33, 128, v33
  v_min_u32 v34, 1, v20
  v_lshlrev_b32 v34, 30, v34
  s_cmp_eq_u32 s13, 3
  s_cselect_b64 vcc, -1, 0
  v_cndmask_b32 v19, v34, v33, vcc
  v_mov_b64 v[60:61], 0
  v_mov_b32 v62, 32256
  ds_write_b64 v62, v[60:61]
  s_mov_b32 s16, 0
  s_mov_b32 s17, -1
  s_mov_b32 s18, 0x3e0293ee
  s_mov_b32 s54, 0x2f800000
  s_mov_b32 s55, 0x28000000
  s_mov_b32 s96, s55
  s_lshl_b32 s36, s13, 10
  s_add_u32 s31, s36, 8192
  s_add_u32 s32, s36, 12160
  s_add_u32 s33, s36, 16384
  s_add_u32 s34, s36, 20224
  s_lshl_b32 s36, s12, 19
  s_add_u32 s27, s36, 67108864
  s_add_u32 s28, s36, 83886080
  s_mul_i32 s36, s12, 4096
  s_add_u32 s29, s36, 135266304
  s_lshl_b32 s36, s12, 13
  s_add_u32 s22, s36, 144703488
  s_add_u32 s23, s36, 144707584
  s_mov_b32 s20, 144703488
  s_mov_b32 s21, 144707584
  v_mov_b32 v40, -1
  v_mov_b32 v41, -1
  v_mov_b32 v42, -1
  v_mov_b32 v43, -1
  s_lshl_b32 s36, s13, 13
  s_add_u32 s36, s36, 145752064
  s_add_u32 s37, s36, 4096
  buffer_store_dwordx4 v[40:43], v59, s[4:7], s22 offen sc1
  buffer_store_dwordx4 v[40:43], v59, s[4:7], s23 offen sc1
  buffer_store_dword v40, v8, s[4:7], s36 offen sc1
  buffer_store_dword v40, v8, s[4:7], s37 offen sc1
  v_mov_b32 v52, 0
  v_min_u32 v53, 1, v59
  v_lshlrev_b32 v53, 30, v53
  buffer_store_dword v52, v53, s[4:7], s15 offen sc1
  s_waitcnt vmcnt(21)
  ds_read_b64_tr_b16 a[160:161], v28 offset:28672
  ds_read_b64_tr_b16 a[162:163], v28 offset:28928
  ds_read_b64_tr_b16 a[164:165], v28 offset:29696
  ds_read_b64_tr_b16 a[166:167], v28 offset:29952
  ds_read_b64_tr_b16 a[168:169], v28 offset:28680
  ds_read_b64_tr_b16 a[170:171], v28 offset:28936
  ds_read_b64_tr_b16 a[172:173], v28 offset:29704
  ds_read_b64_tr_b16 a[174:175], v28 offset:29960
  s_waitcnt lgkmcnt(0)
  s_waitcnt vmcnt(17)
  ds_read_b64_tr_b16 a[176:177], v28 offset:24576
  ds_read_b64_tr_b16 a[178:179], v28 offset:24832
  ds_read_b64_tr_b16 a[180:181], v28 offset:25600
  ds_read_b64_tr_b16 a[182:183], v28 offset:25856
  ds_read_b64_tr_b16 a[184:185], v28 offset:24584
  ds_read_b64_tr_b16 a[186:187], v28 offset:24840
  ds_read_b64_tr_b16 a[188:189], v28 offset:25608
  ds_read_b64_tr_b16 a[190:191], v28 offset:25864
  s_waitcnt lgkmcnt(0)
  s_xor_b32 s36, s13, 2
  s_lshl_b32 s36, s36, 15
  s_add_u32 m0, s39, 28672
  s_add_u32 s37, s36, 0
  buffer_load_dwordx4 v26, s[48:51], s37 offen lds
  s_add_u32 m0, s39, 29696
  s_add_u32 s37, s36, 8192
  buffer_load_dwordx4 v26, s[48:51], s37 offen lds
  s_add_u32 m0, s39, 30720
  s_add_u32 s37, s36, 16384
  buffer_load_dwordx4 v26, s[48:51], s37 offen lds
  s_add_u32 m0, s39, 31744
  s_add_u32 s37, s36, 24576
  buffer_load_dwordx4 v26, s[48:51], s37 offen lds
  s_xor_b32 s36, s13, 3
  s_lshl_b32 s36, s36, 15
  s_add_u32 m0, s39, 24576
  s_add_u32 s37, s36, 0
  buffer_load_dwordx4 v26, s[48:51], s37 offen lds
  s_add_u32 m0, s39, 25600
  s_add_u32 s37, s36, 8192
  buffer_load_dwordx4 v26, s[48:51], s37 offen lds
  s_add_u32 m0, s39, 26624
  s_add_u32 s37, s36, 16384
  buffer_load_dwordx4 v26, s[48:51], s37 offen lds
  s_add_u32 m0, s39, 27648
  s_add_u32 s37, s36, 24576
  buffer_load_dwordx4 v26, s[48:51], s37 offen lds
  s_waitcnt vmcnt(21)
  ds_read_b64_tr_b16 a[192:193], v28 offset:12288
  ds_read_b64_tr_b16 a[194:195], v28 offset:12544
  ds_read_b64_tr_b16 a[196:197], v28 offset:13312
  ds_read_b64_tr_b16 a[198:199], v28 offset:13568
  ds_read_b64_tr_b16 a[200:201], v28 offset:12296
  ds_read_b64_tr_b16 a[202:203], v28 offset:12552
  ds_read_b64_tr_b16 a[204:205], v28 offset:13320
  ds_read_b64_tr_b16 a[206:207], v28 offset:13576
  s_waitcnt lgkmcnt(0)
  s_waitcnt vmcnt(17)
  ds_read_b64_tr_b16 a[208:209], v28 offset:8192
  ds_read_b64_tr_b16 a[210:211], v28 offset:8448
  ds_read_b64_tr_b16 a[212:213], v28 offset:9216
  ds_read_b64_tr_b16 a[214:215], v28 offset:9472
  ds_read_b64_tr_b16 a[216:217], v28 offset:8200
  ds_read_b64_tr_b16 a[218:219], v28 offset:8456
  ds_read_b64_tr_b16 a[220:221], v28 offset:9224
  ds_read_b64_tr_b16 a[222:223], v28 offset:9480
  s_waitcnt lgkmcnt(0)
  s_xor_b32 s36, s13, 2
  s_lshl_b32 s36, s36, 19
  s_add_u32 m0, s39, 12288
  s_add_u32 s37, s36, 0
  buffer_load_dwordx4 v25, s[8:11], s37 offen lds
  s_add_u32 m0, s39, 13312
  s_add_u32 s37, s36, 65536
  buffer_load_dwordx4 v25, s[8:11], s37 offen lds
  s_add_u32 m0, s39, 14336
  s_add_u32 s37, s36, 131072
  buffer_load_dwordx4 v25, s[8:11], s37 offen lds
  s_add_u32 m0, s39, 15360
  s_add_u32 s37, s36, 196608
  buffer_load_dwordx4 v25, s[8:11], s37 offen lds
  s_xor_b32 s36, s13, 2
  s_lshl_b32 s36, s36, 19
  s_add_u32 m0, s39, 8192
  s_add_u32 s37, s36, 262144
  buffer_load_dwordx4 v25, s[8:11], s37 offen lds
  s_add_u32 m0, s39, 9216
  s_add_u32 s37, s36, 327680
  buffer_load_dwordx4 v25, s[8:11], s37 offen lds
  s_add_u32 m0, s39, 10240
  s_add_u32 s37, s36, 393216
  buffer_load_dwordx4 v25, s[8:11], s37 offen lds
  s_add_u32 m0, s39, 11264
  s_add_u32 s37, s36, 458752
  buffer_load_dwordx4 v25, s[8:11], s37 offen lds
  s_waitcnt vmcnt(12)
  ds_read_b64_tr_b16 a[224:225], v28 offset:28672
  ds_read_b64_tr_b16 a[226:227], v28 offset:28928
  ds_read_b64_tr_b16 a[228:229], v28 offset:29696
  ds_read_b64_tr_b16 a[230:231], v28 offset:29952
  ds_read_b64_tr_b16 a[232:233], v28 offset:28680
  ds_read_b64_tr_b16 a[234:235], v28 offset:28936
  ds_read_b64_tr_b16 a[236:237], v28 offset:29704
  ds_read_b64_tr_b16 a[238:239], v28 offset:29960
  s_waitcnt lgkmcnt(0)
  s_waitcnt vmcnt(8)
  ds_read_b64_tr_b16 a[240:241], v28 offset:24576
  ds_read_b64_tr_b16 a[242:243], v28 offset:24832
  ds_read_b64_tr_b16 a[244:245], v28 offset:25600
  ds_read_b64_tr_b16 a[246:247], v28 offset:25856
  ds_read_b64_tr_b16 a[248:249], v28 offset:24584
  ds_read_b64_tr_b16 a[250:251], v28 offset:24840
  ds_read_b64_tr_b16 a[252:253], v28 offset:25608
  ds_read_b64_tr_b16 a[254:255], v28 offset:25864
  s_waitcnt lgkmcnt(0)
  s_xor_b32 s36, s13, 4
  s_lshl_b32 s36, s36, 19
  s_add_u32 m0, s39, 28672
  s_add_u32 s37, s36, 0
  buffer_load_dwordx4 v25, s[8:11], s37 offen lds
  s_add_u32 m0, s39, 29696
  s_add_u32 s37, s36, 65536
  buffer_load_dwordx4 v25, s[8:11], s37 offen lds
  s_add_u32 m0, s39, 30720
  s_add_u32 s37, s36, 131072
  buffer_load_dwordx4 v25, s[8:11], s37 offen lds
  s_add_u32 m0, s39, 31744
  s_add_u32 s37, s36, 196608
  buffer_load_dwordx4 v25, s[8:11], s37 offen lds
  s_xor_b32 s36, s13, 4
  s_lshl_b32 s36, s36, 19
  s_add_u32 m0, s39, 24576
  s_add_u32 s37, s36, 262144
  buffer_load_dwordx4 v25, s[8:11], s37 offen lds
  s_add_u32 m0, s39, 25600
  s_add_u32 s37, s36, 327680
  buffer_load_dwordx4 v25, s[8:11], s37 offen lds
  s_add_u32 m0, s39, 26624
  s_add_u32 s37, s36, 393216
  buffer_load_dwordx4 v25, s[8:11], s37 offen lds
  s_add_u32 m0, s39, 27648
  s_add_u32 s37, s36, 458752
  buffer_load_dwordx4 v25, s[8:11], s37 offen lds
  s_barrier
  s_cmp_lg_u32 s13, 0
  s_cbranch_scc1 T_arm_1
  s_getreg_b32 s36, hwreg(HW_REG_XCC_ID, 0, 3)
  s_lshl_b32 s36, s36, 3
  s_lshl_b64 s[60:61], 1, s36
  s_mov_b32 s62, 1
  s_atomic_add_x2 s[60:61], s[52:53], 0
  s_atomic_add s62, s[52:53], 128
  v_lshl_or_b32 v44, v45, 16, v44
  v_lshl_or_b32 v46, v47, 16, v46
  v_min_u32 v44, -2, v44
  v_min_u32 v46, -2, v46
  s_mov_b32 s36, 145752064
  s_mov_b32 s37, 145756160
  buffer_store_dword v44, v8, s[4:7], s36 offen sc1
  buffer_store_dword v46, v8, s[4:7], s37 offen sc1
T_arm_1:
  v_mad_u32_u24 v96, v100, 1, v27
  v_mad_u32_u24 v97, v101, 1, v27
  v_mad_u32_u24 v98, v100, 1, v36
  v_mad_u32_u24 v99, v101, 1, v36
  s_waitcnt vmcnt(8)
  s_barrier
  ds_read_b64_tr_b16 v[160:161], v96 offset:8192
  ds_read_b64_tr_b16 v[162:163], v96 offset:8448
  ds_read_b64_tr_b16 v[164:165], v96 offset:10240
  ds_read_b64_tr_b16 v[166:167], v96 offset:10496
  ds_read_b64_tr_b16 v[168:169], v97 offset:8192
  ds_read_b64_tr_b16 v[170:171], v97 offset:8448
  ds_read_b64_tr_b16 v[172:173], v97 offset:10240
  ds_read_b64_tr_b16 v[174:175], v97 offset:10496
  ds_read_b64_tr_b16 v[192:193], v98 offset:8192
  ds_read_b64_tr_b16 v[194:195], v98 offset:8448
  ds_read_b64_tr_b16 v[196:197], v98 offset:10240
  ds_read_b64_tr_b16 v[198:199], v98 offset:10496
  ds_read_b64_tr_b16 v[200:201], v99 offset:8192
  ds_read_b64_tr_b16 v[202:203], v99 offset:8448
  ds_read_b64_tr_b16 v[204:205], v99 offset:10240
  ds_read_b64_tr_b16 v[206:207], v99 offset:10496
  s_waitcnt lgkmcnt(0)
  s_barrier
  s_xor_b32 s36, s13, 4
  s_lshl_b32 s36, s36, 19
  s_add_u32 m0, s39, 12288
  s_add_u32 s37, s36, 0
  buffer_load_dwordx4 v25, s[40:43], s37 offen lds
  s_add_u32 m0, s39, 13312
  s_add_u32 s37, s36, 65536
  buffer_load_dwordx4 v25, s[40:43], s37 offen lds
  s_add_u32 m0, s39, 14336
  s_add_u32 s37, s36, 131072
  buffer_load_dwordx4 v25, s[40:43], s37 offen lds
  s_add_u32 m0, s39, 15360
  s_add_u32 s37, s36, 196608
  buffer_load_dwordx4 v25, s[40:43], s37 offen lds
  s_xor_b32 s36, s13, 4
  s_lshl_b32 s36, s36, 19
  s_add_u32 m0, s39, 8192
  s_add_u32 s37, s36, 262144
  buffer_load_dwordx4 v25, s[40:43], s37 offen lds
  s_add_u32 m0, s39, 9216
  s_add_u32 s37, s36, 327680
  buffer_load_dwordx4 v25, s[40:43], s37 offen lds
  s_add_u32 m0, s39, 10240
  s_add_u32 s37, s36, 393216
  buffer_load_dwordx4 v25, s[40:43], s37 offen lds
  s_add_u32 m0, s39, 11264
  s_add_u32 s37, s36, 458752
  buffer_load_dwordx4 v25, s[40:43], s37 offen lds
  v_mad_u32_u24 v96, v100, 1, v27
  v_mad_u32_u24 v97, v101, 1, v27
  v_mad_u32_u24 v98, v100, 1, v36
  v_mad_u32_u24 v99, v101, 1, v36
  s_waitcnt vmcnt(8)
  s_barrier
  ds_read_b64_tr_b16 v[224:225], v96 offset:24576
  ds_read_b64_tr_b16 v[226:227], v96 offset:24832
  ds_read_b64_tr_b16 v[228:229], v96 offset:26624
  ds_read_b64_tr_b16 v[230:231], v96 offset:26880
  ds_read_b64_tr_b16 v[232:233], v97 offset:24576
  ds_read_b64_tr_b16 v[234:235], v97 offset:24832
  ds_read_b64_tr_b16 v[236:237], v97 offset:26624
  ds_read_b64_tr_b16 v[238:239], v97 offset:26880
  ds_read_b64_tr_b16 a[16:17], v98 offset:24576
  ds_read_b64_tr_b16 a[18:19], v98 offset:24832
  ds_read_b64_tr_b16 a[20:21], v98 offset:26624
  ds_read_b64_tr_b16 a[22:23], v98 offset:26880
  ds_read_b64_tr_b16 a[24:25], v99 offset:24576
  ds_read_b64_tr_b16 a[26:27], v99 offset:24832
  ds_read_b64_tr_b16 a[28:29], v99 offset:26624
  ds_read_b64_tr_b16 a[30:31], v99 offset:26880
  s_waitcnt lgkmcnt(0)
  s_barrier
  s_xor_b32 s36, s13, 4
  s_lshl_b32 s36, s36, 19
  s_add_u32 m0, s39, 28672
  s_add_u32 s37, s36, 0
  buffer_load_dwordx4 v25, s[44:47], s37 offen lds
  s_add_u32 m0, s39, 29696
  s_add_u32 s37, s36, 65536
  buffer_load_dwordx4 v25, s[44:47], s37 offen lds
  s_add_u32 m0, s39, 30720
  s_add_u32 s37, s36, 131072
  buffer_load_dwordx4 v25, s[44:47], s37 offen lds
  s_add_u32 m0, s39, 31744
  s_add_u32 s37, s36, 196608
  buffer_load_dwordx4 v25, s[44:47], s37 offen lds
  s_xor_b32 s36, s13, 4
  s_lshl_b32 s36, s36, 19
  s_add_u32 m0, s39, 24576
  s_add_u32 s37, s36, 262144
  buffer_load_dwordx4 v25, s[44:47], s37 offen lds
  s_add_u32 m0, s39, 25600
  s_add_u32 s37, s36, 327680
  buffer_load_dwordx4 v25, s[44:47], s37 offen lds
  s_add_u32 m0, s39, 26624
  s_add_u32 s37, s36, 393216
  buffer_load_dwordx4 v25, s[44:47], s37 offen lds
  s_add_u32 m0, s39, 27648
  s_add_u32 s37, s36, 458752
  buffer_load_dwordx4 v25, s[44:47], s37 offen lds
  v_mad_u32_u24 v96, v100, 1, v27
  v_mad_u32_u24 v97, v101, 1, v27
  v_mad_u32_u24 v98, v100, 1, v36
  v_mad_u32_u24 v99, v101, 1, v36
  s_waitcnt vmcnt(8)
  s_barrier
  ds_read_b64_tr_b16 v[240:241], v96 offset:8192
  ds_read_b64_tr_b16 v[242:243], v96 offset:8448
  ds_read_b64_tr_b16 v[244:245], v96 offset:10240
  ds_read_b64_tr_b16 v[246:247], v96 offset:10496
  ds_read_b64_tr_b16 v[248:249], v97 offset:8192
  ds_read_b64_tr_b16 v[250:251], v97 offset:8448
  ds_read_b64_tr_b16 v[252:253], v97 offset:10240
  ds_read_b64_tr_b16 v[254:255], v97 offset:10496
  ds_read_b64_tr_b16 a[32:33], v98 offset:8192
  ds_read_b64_tr_b16 a[34:35], v98 offset:8448
  ds_read_b64_tr_b16 a[36:37], v98 offset:10240
  ds_read_b64_tr_b16 a[38:39], v98 offset:10496
  ds_read_b64_tr_b16 a[40:41], v99 offset:8192
  ds_read_b64_tr_b16 a[42:43], v99 offset:8448
  ds_read_b64_tr_b16 a[44:45], v99 offset:10240
  ds_read_b64_tr_b16 a[46:47], v99 offset:10496
  s_waitcnt lgkmcnt(0)
  s_barrier
  s_xor_b32 s36, s13, 6
  s_lshl_b32 s36, s36, 19
  s_add_u32 m0, s39, 12288
  s_add_u32 s37, s36, 0
  buffer_load_dwordx4 v25, s[8:11], s37 offen lds
  s_add_u32 m0, s39, 13312
  s_add_u32 s37, s36, 65536
  buffer_load_dwordx4 v25, s[8:11], s37 offen lds
  s_add_u32 m0, s39, 14336
  s_add_u32 s37, s36, 131072
  buffer_load_dwordx4 v25, s[8:11], s37 offen lds
  s_add_u32 m0, s39, 15360
  s_add_u32 s37, s36, 196608
  buffer_load_dwordx4 v25, s[8:11], s37 offen lds
  s_xor_b32 s36, s13, 6
  s_lshl_b32 s36, s36, 19
  s_add_u32 m0, s39, 8192
  s_add_u32 s37, s36, 262144
  buffer_load_dwordx4 v25, s[8:11], s37 offen lds
  s_add_u32 m0, s39, 9216
  s_add_u32 s37, s36, 327680
  buffer_load_dwordx4 v25, s[8:11], s37 offen lds
  s_add_u32 m0, s39, 10240
  s_add_u32 s37, s36, 393216
  buffer_load_dwordx4 v25, s[8:11], s37 offen lds
  s_add_u32 m0, s39, 11264
  s_add_u32 s37, s36, 458752
  buffer_load_dwordx4 v25, s[8:11], s37 offen lds
  v_mad_u32_u24 v96, v100, 1, v27
  v_mad_u32_u24 v97, v101, 1, v27
  v_mad_u32_u24 v98, v100, 1, v36
  v_mad_u32_u24 v99, v101, 1, v36
  s_waitcnt vmcnt(8)
  s_barrier
  ds_read_b64_tr_b16 a[0:1], v96 offset:24576
  ds_read_b64_tr_b16 a[2:3], v96 offset:24832
  ds_read_b64_tr_b16 a[4:5], v96 offset:26624
  ds_read_b64_tr_b16 a[6:7], v96 offset:26880
  ds_read_b64_tr_b16 a[8:9], v97 offset:24576
  ds_read_b64_tr_b16 a[10:11], v97 offset:24832
  ds_read_b64_tr_b16 a[12:13], v97 offset:26624
  ds_read_b64_tr_b16 a[14:15], v97 offset:26880
  ds_read_b64_tr_b16 a[48:49], v98 offset:24576
  ds_read_b64_tr_b16 a[50:51], v98 offset:24832
  ds_read_b64_tr_b16 a[52:53], v98 offset:26624
  ds_read_b64_tr_b16 a[54:55], v98 offset:26880
  ds_read_b64_tr_b16 a[56:57], v99 offset:24576
  ds_read_b64_tr_b16 a[58:59], v99 offset:24832
  ds_read_b64_tr_b16 a[60:61], v99 offset:26624
  ds_read_b64_tr_b16 a[62:63], v99 offset:26880
  s_waitcnt lgkmcnt(0)
  s_barrier
  s_xor_b32 s36, s13, 6
  s_lshl_b32 s36, s36, 19
  s_add_u32 m0, s39, 28672
  s_add_u32 s37, s36, 0
  buffer_load_dwordx4 v25, s[40:43], s37 offen lds
  s_add_u32 m0, s39, 29696
  s_add_u32 s37, s36, 65536
  buffer_load_dwordx4 v25, s[40:43], s37 offen lds
  s_add_u32 m0, s39, 30720
  s_add_u32 s37, s36, 131072
  buffer_load_dwordx4 v25, s[40:43], s37 offen lds
  s_add_u32 m0, s39, 31744
  s_add_u32 s37, s36, 196608
  buffer_load_dwordx4 v25, s[40:43], s37 offen lds
  s_xor_b32 s36, s13, 6
  s_lshl_b32 s36, s36, 19
  s_add_u32 m0, s39, 24576
  s_add_u32 s37, s36, 262144
  buffer_load_dwordx4 v25, s[40:43], s37 offen lds
  s_add_u32 m0, s39, 25600
  s_add_u32 s37, s36, 327680
  buffer_load_dwordx4 v25, s[40:43], s37 offen lds
  s_add_u32 m0, s39, 26624
  s_add_u32 s37, s36, 393216
  buffer_load_dwordx4 v25, s[40:43], s37 offen lds
  s_add_u32 m0, s39, 27648
  s_add_u32 s37, s36, 458752
  buffer_load_dwordx4 v25, s[40:43], s37 offen lds
  v_mad_u32_u24 v96, v100, 1, v27
  v_mad_u32_u24 v97, v101, 1, v27
  v_mad_u32_u24 v98, v100, 1, v36
  v_mad_u32_u24 v99, v101, 1, v36
  s_waitcnt vmcnt(8)
  s_barrier
  ds_read_b64_tr_b16 a[64:65], v96 offset:8192
  ds_read_b64_tr_b16 a[66:67], v96 offset:8448
  ds_read_b64_tr_b16 a[68:69], v96 offset:10240
  ds_read_b64_tr_b16 a[70:71], v96 offset:10496
  ds_read_b64_tr_b16 a[72:73], v97 offset:8192
  ds_read_b64_tr_b16 a[74:75], v97 offset:8448
  ds_read_b64_tr_b16 a[76:77], v97 offset:10240
  ds_read_b64_tr_b16 a[78:79], v97 offset:10496
  ds_read_b64_tr_b16 a[112:113], v98 offset:8192
  ds_read_b64_tr_b16 a[114:115], v98 offset:8448
  ds_read_b64_tr_b16 a[116:117], v98 offset:10240
  ds_read_b64_tr_b16 a[118:119], v98 offset:10496
  ds_read_b64_tr_b16 a[120:121], v99 offset:8192
  ds_read_b64_tr_b16 a[122:123], v99 offset:8448
  ds_read_b64_tr_b16 a[124:125], v99 offset:10240
  ds_read_b64_tr_b16 a[126:127], v99 offset:10496
  s_waitcnt lgkmcnt(0)
  s_barrier
  s_xor_b32 s36, s13, 6
  s_lshl_b32 s36, s36, 19
  s_add_u32 m0, s39, 12288
  s_add_u32 s37, s36, 0
  buffer_load_dwordx4 v25, s[44:47], s37 offen lds
  s_add_u32 m0, s39, 13312
  s_add_u32 s37, s36, 65536
  buffer_load_dwordx4 v25, s[44:47], s37 offen lds
  s_add_u32 m0, s39, 14336
  s_add_u32 s37, s36, 131072
  buffer_load_dwordx4 v25, s[44:47], s37 offen lds
  s_add_u32 m0, s39, 15360
  s_add_u32 s37, s36, 196608
  buffer_load_dwordx4 v25, s[44:47], s37 offen lds
  s_xor_b32 s36, s13, 6
  s_lshl_b32 s36, s36, 19
  s_add_u32 m0, s39, 8192
  s_add_u32 s37, s36, 262144
  buffer_load_dwordx4 v25, s[44:47], s37 offen lds
  s_add_u32 m0, s39, 9216
  s_add_u32 s37, s36, 327680
  buffer_load_dwordx4 v25, s[44:47], s37 offen lds
  s_add_u32 m0, s39, 10240
  s_add_u32 s37, s36, 393216
  buffer_load_dwordx4 v25, s[44:47], s37 offen lds
  s_add_u32 m0, s39, 11264
  s_add_u32 s37, s36, 458752
  buffer_load_dwordx4 v25, s[44:47], s37 offen lds
  v_mad_u32_u24 v96, v100, 1, v27
  v_mad_u32_u24 v97, v101, 1, v27
  v_mad_u32_u24 v98, v100, 1, v36
  v_mad_u32_u24 v99, v101, 1, v36
  s_waitcnt vmcnt(8)
  s_barrier
  ds_read_b64_tr_b16 a[80:81], v96 offset:24576
  ds_read_b64_tr_b16 a[82:83], v96 offset:24832
  ds_read_b64_tr_b16 a[84:85], v96 offset:26624
  ds_read_b64_tr_b16 a[86:87], v96 offset:26880
  ds_read_b64_tr_b16 a[88:89], v97 offset:24576
  ds_read_b64_tr_b16 a[90:91], v97 offset:24832
  ds_read_b64_tr_b16 a[92:93], v97 offset:26624
  ds_read_b64_tr_b16 a[94:95], v97 offset:26880
  ds_read_b64_tr_b16 a[128:129], v98 offset:24576
  ds_read_b64_tr_b16 a[130:131], v98 offset:24832
  ds_read_b64_tr_b16 a[132:133], v98 offset:26624
  ds_read_b64_tr_b16 a[134:135], v98 offset:26880
  ds_read_b64_tr_b16 a[136:137], v99 offset:24576
  ds_read_b64_tr_b16 a[138:139], v99 offset:24832
  ds_read_b64_tr_b16 a[140:141], v99 offset:26624
  ds_read_b64_tr_b16 a[142:143], v99 offset:26880
  s_waitcnt lgkmcnt(0)
  s_barrier
  s_xor_b32 s36, s13, 0
  s_lshl_b32 s36, s36, 19
  s_add_u32 m0, s39, 28672
  s_add_u32 s37, s36, 0
  buffer_load_dwordx4 v25, s[8:11], s37 offen lds
  s_add_u32 m0, s39, 29696
  s_add_u32 s37, s36, 65536
  buffer_load_dwordx4 v25, s[8:11], s37 offen lds
  s_add_u32 m0, s39, 30720
  s_add_u32 s37, s36, 131072
  buffer_load_dwordx4 v25, s[8:11], s37 offen lds
  s_add_u32 m0, s39, 31744
  s_add_u32 s37, s36, 196608
  buffer_load_dwordx4 v25, s[8:11], s37 offen lds
  s_xor_b32 s36, s13, 0
  s_lshl_b32 s36, s36, 19
  s_add_u32 m0, s39, 0
  s_add_u32 s37, s36, 262144
  buffer_load_dwordx4 v25, s[8:11], s37 offen lds
  s_add_u32 m0, s39, 1024
  s_add_u32 s37, s36, 327680
  buffer_load_dwordx4 v25, s[8:11], s37 offen lds
  s_add_u32 m0, s39, 2048
  s_add_u32 s37, s36, 393216
  buffer_load_dwordx4 v25, s[8:11], s37 offen lds
  s_add_u32 m0, s39, 3072
  s_add_u32 s37, s36, 458752
  buffer_load_dwordx4 v25, s[8:11], s37 offen lds
  v_mad_u32_u24 v96, v100, 1, v27
  v_mad_u32_u24 v97, v101, 1, v27
  v_mad_u32_u24 v98, v100, 1, v36
  v_mad_u32_u24 v99, v101, 1, v36
  s_waitcnt vmcnt(8)
  s_barrier
  ds_read_b64_tr_b16 a[96:97], v96 offset:8192
  ds_read_b64_tr_b16 a[98:99], v96 offset:8448
  ds_read_b64_tr_b16 a[100:101], v96 offset:10240
  ds_read_b64_tr_b16 a[102:103], v96 offset:10496
  ds_read_b64_tr_b16 a[104:105], v97 offset:8192
  ds_read_b64_tr_b16 a[106:107], v97 offset:8448
  ds_read_b64_tr_b16 a[108:109], v97 offset:10240
  ds_read_b64_tr_b16 a[110:111], v97 offset:10496
  ds_read_b64_tr_b16 a[144:145], v98 offset:8192
  ds_read_b64_tr_b16 a[146:147], v98 offset:8448
  ds_read_b64_tr_b16 a[148:149], v98 offset:10240
  ds_read_b64_tr_b16 a[150:151], v98 offset:10496
  ds_read_b64_tr_b16 a[152:153], v99 offset:8192
  ds_read_b64_tr_b16 a[154:155], v99 offset:8448
  ds_read_b64_tr_b16 a[156:157], v99 offset:10240
  ds_read_b64_tr_b16 a[158:159], v99 offset:10496
  s_waitcnt lgkmcnt(0)
  s_barrier
  s_xor_b32 s36, s13, 0
  s_lshl_b32 s36, s36, 19
  s_add_u32 m0, s39, 24576
  s_add_u32 s37, s36, 0
  buffer_load_dwordx4 v25, s[40:43], s37 offen lds
  s_add_u32 m0, s39, 25600
  s_add_u32 s37, s36, 65536
  buffer_load_dwordx4 v25, s[40:43], s37 offen lds
  s_add_u32 m0, s39, 26624
  s_add_u32 s37, s36, 131072
  buffer_load_dwordx4 v25, s[40:43], s37 offen lds
  s_add_u32 m0, s39, 27648
  s_add_u32 s37, s36, 196608
  buffer_load_dwordx4 v25, s[40:43], s37 offen lds
  s_xor_b32 s36, s13, 0
  s_lshl_b32 s36, s36, 19
  s_add_u32 m0, s39, 4096
  s_add_u32 s37, s36, 262144
  buffer_load_dwordx4 v25, s[40:43], s37 offen lds
  s_add_u32 m0, s39, 5120
  s_add_u32 s37, s36, 327680
  buffer_load_dwordx4 v25, s[40:43], s37 offen lds
  s_add_u32 m0, s39, 6144
  s_add_u32 s37, s36, 393216
  buffer_load_dwordx4 v25, s[40:43], s37 offen lds
  s_add_u32 m0, s39, 7168
  s_add_u32 s37, s36, 458752
  buffer_load_dwordx4 v25, s[40:43], s37 offen lds
  v_mad_u32_u24 v96, v100, 7, v27
  v_mad_u32_u24 v97, v101, 7, v27
  v_mad_u32_u24 v98, v100, 7, v36
  v_mad_u32_u24 v99, v101, 7, v36
  s_waitcnt vmcnt(8)
  s_barrier
  ds_read_b64_tr_b16 v[128:129], v98 offset:0
  ds_read_b64_tr_b16 v[130:131], v98 offset:256
  ds_read_b64_tr_b16 v[132:133], v98 offset:2048
  ds_read_b64_tr_b16 v[134:135], v98 offset:2304
  ds_read_b64_tr_b16 v[136:137], v99 offset:0
  ds_read_b64_tr_b16 v[138:139], v99 offset:256
  ds_read_b64_tr_b16 v[140:141], v99 offset:2048
  ds_read_b64_tr_b16 v[142:143], v99 offset:2304
  ds_read_b64_tr_b16 v[64:65], v96 offset:0
  ds_read_b64_tr_b16 v[66:67], v96 offset:256
  ds_read_b64_tr_b16 v[68:69], v96 offset:2048
  ds_read_b64_tr_b16 v[70:71], v96 offset:2304
  ds_read_b64_tr_b16 v[72:73], v97 offset:0
  ds_read_b64_tr_b16 v[74:75], v97 offset:256
  ds_read_b64_tr_b16 v[76:77], v97 offset:2048
  ds_read_b64_tr_b16 v[78:79], v97 offset:2304
  s_waitcnt lgkmcnt(0)
  s_barrier
  ds_write_b128 v4, v[64:67] offset:0
  ds_write_b128 v4, v[68:71] offset:1024
  ds_write_b128 v4, v[72:75] offset:2048
  ds_write_b128 v4, v[76:79] offset:3072
  s_xor_b32 s36, s13, 2
  s_lshl_b32 s36, s36, 19
  s_add_u32 m0, s39, 28672
  s_add_u32 s37, s36, 0
  buffer_load_dwordx4 v25, s[40:43], s37 offen lds
  s_add_u32 m0, s39, 29696
  s_add_u32 s37, s36, 65536
  buffer_load_dwordx4 v25, s[40:43], s37 offen lds
  s_add_u32 m0, s39, 30720
  s_add_u32 s37, s36, 131072
  buffer_load_dwordx4 v25, s[40:43], s37 offen lds
  s_add_u32 m0, s39, 31744
  s_add_u32 s37, s36, 196608
  buffer_load_dwordx4 v25, s[40:43], s37 offen lds
  s_xor_b32 s36, s13, 2
  s_lshl_b32 s36, s36, 19
  s_add_u32 m0, s39, 16384
  s_add_u32 s37, s36, 262144
  buffer_load_dwordx4 v25, s[40:43], s37 offen lds
  s_add_u32 m0, s39, 17408
  s_add_u32 s37, s36, 327680
  buffer_load_dwordx4 v25, s[40:43], s37 offen lds
  s_add_u32 m0, s39, 18432
  s_add_u32 s37, s36, 393216
  buffer_load_dwordx4 v25, s[40:43], s37 offen lds
  s_add_u32 m0, s39, 19456
  s_add_u32 s37, s36, 458752
  buffer_load_dwordx4 v25, s[40:43], s37 offen lds
  s_getpc_b64 s[60:61]
T_pc_2:
  s_add_u32 s60, s60, T_code-T_pc_2
  s_addc_u32 s61, s61, 0
  v_lshlrev_b32 v102, 3, v59
  v_min_u32 v102, 16384, v102
  global_load_dword v103, v102, s[60:61]
  buffer_load_dwordx2 v[54:55], off, s[72:75], 0 sc1
  buffer_load_dword v56, off, s[72:75], 0 offset:128 sc1
  v_mad_u32_u24 v96, v100, 5, v27
  v_mad_u32_u24 v97, v101, 5, v27
  v_mad_u32_u24 v98, v100, 5, v36
  v_mad_u32_u24 v99, v101, 5, v36
  s_waitcnt vmcnt(11)
  s_barrier
  ds_read_b64_tr_b16 v[144:145], v98 offset:4096
  ds_read_b64_tr_b16 v[146:147], v98 offset:4352
  ds_read_b64_tr_b16 v[148:149], v98 offset:6144
  ds_read_b64_tr_b16 v[150:151], v98 offset:6400
  ds_read_b64_tr_b16 v[152:153], v99 offset:4096
  ds_read_b64_tr_b16 v[154:155], v99 offset:4352
  ds_read_b64_tr_b16 v[156:157], v99 offset:6144
  ds_read_b64_tr_b16 v[158:159], v99 offset:6400
  ds_read_b64_tr_b16 v[64:65], v96 offset:4096
  ds_read_b64_tr_b16 v[66:67], v96 offset:4352
  ds_read_b64_tr_b16 v[68:69], v96 offset:6144
  ds_read_b64_tr_b16 v[70:71], v96 offset:6400
  ds_read_b64_tr_b16 v[72:73], v97 offset:4096
  ds_read_b64_tr_b16 v[74:75], v97 offset:4352
  ds_read_b64_tr_b16 v[76:77], v97 offset:6144
  ds_read_b64_tr_b16 v[78:79], v97 offset:6400
  s_waitcnt lgkmcnt(0)
  s_barrier
  ds_write_b128 v4, v[64:67] offset:4096
  ds_write_b128 v4, v[68:71] offset:5120
  ds_write_b128 v4, v[72:75] offset:6144
  ds_write_b128 v4, v[76:79] offset:7168
  s_xor_b32 s36, s13, 2
  s_lshl_b32 s36, s36, 19
  s_add_u32 m0, s39, 24576
  s_add_u32 s37, s36, 0
  buffer_load_dwordx4 v25, s[44:47], s37 offen lds
  s_add_u32 m0, s39, 25600
  s_add_u32 s37, s36, 65536
  buffer_load_dwordx4 v25, s[44:47], s37 offen lds
  s_add_u32 m0, s39, 26624
  s_add_u32 s37, s36, 131072
  buffer_load_dwordx4 v25, s[44:47], s37 offen lds
  s_add_u32 m0, s39, 27648
  s_add_u32 s37, s36, 196608
  buffer_load_dwordx4 v25, s[44:47], s37 offen lds
  s_xor_b32 s36, s13, 2
  s_lshl_b32 s36, s36, 19
  s_add_u32 m0, s39, 20480
  s_add_u32 s37, s36, 262144
  buffer_load_dwordx4 v25, s[44:47], s37 offen lds
  s_add_u32 m0, s39, 21504
  s_add_u32 s37, s36, 327680
  buffer_load_dwordx4 v25, s[44:47], s37 offen lds
  s_add_u32 m0, s39, 22528
  s_add_u32 s37, s36, 393216
  buffer_load_dwordx4 v25, s[44:47], s37 offen lds
  s_add_u32 m0, s39, 23552
  s_add_u32 s37, s36, 458752
  buffer_load_dwordx4 v25, s[44:47], s37 offen lds
  v_mad_u32_u24 v96, v100, 3, v27
  v_mad_u32_u24 v97, v101, 3, v27
  v_mad_u32_u24 v98, v100, 3, v36
  v_mad_u32_u24 v99, v101, 3, v36
  s_waitcnt vmcnt(11)
  s_barrier
  ds_read_b64_tr_b16 v[176:177], v96 offset:16384
  ds_read_b64_tr_b16 v[178:179], v96 offset:16640
  ds_read_b64_tr_b16 v[180:181], v96 offset:18432
  ds_read_b64_tr_b16 v[182:183], v96 offset:18688
  ds_read_b64_tr_b16 v[184:185], v97 offset:16384
  ds_read_b64_tr_b16 v[186:187], v97 offset:16640
  ds_read_b64_tr_b16 v[188:189], v97 offset:18432
  ds_read_b64_tr_b16 v[190:191], v97 offset:18688
  ds_read_b64_tr_b16 v[64:65], v98 offset:16384
  ds_read_b64_tr_b16 v[66:67], v98 offset:16640
  ds_read_b64_tr_b16 v[68:69], v98 offset:18432
  ds_read_b64_tr_b16 v[70:71], v98 offset:18688
  ds_read_b64_tr_b16 v[72:73], v99 offset:16384
  ds_read_b64_tr_b16 v[74:75], v99 offset:16640
  ds_read_b64_tr_b16 v[76:77], v99 offset:18432
  ds_read_b64_tr_b16 v[78:79], v99 offset:18688
  s_waitcnt lgkmcnt(0)
  s_barrier
  ds_write_b128 v4, v[64:67] offset:16384
  ds_write_b128 v4, v[68:71] offset:17408
  ds_write_b128 v4, v[72:75] offset:18432
  ds_write_b128 v4, v[76:79] offset:19456
  s_xor_b32 s36, s13, 0
  s_lshl_b32 s36, s36, 19
  s_add_u32 m0, s39, 8192
  s_add_u32 s37, s36, 0
  buffer_load_dwordx4 v25, s[44:47], s37 offen lds
  s_add_u32 m0, s39, 9216
  s_add_u32 s37, s36, 65536
  buffer_load_dwordx4 v25, s[44:47], s37 offen lds
  s_add_u32 m0, s39, 10240
  s_add_u32 s37, s36, 131072
  buffer_load_dwordx4 v25, s[44:47], s37 offen lds
  s_add_u32 m0, s39, 11264
  s_add_u32 s37, s36, 196608
  buffer_load_dwordx4 v25, s[44:47], s37 offen lds
  s_xor_b32 s36, s13, 0
  s_lshl_b32 s36, s36, 19
  s_add_u32 m0, s39, 12288
  s_add_u32 s37, s36, 262144
  buffer_load_dwordx4 v25, s[44:47], s37 offen lds
  s_add_u32 m0, s39, 13312
  s_add_u32 s37, s36, 327680
  buffer_load_dwordx4 v25, s[44:47], s37 offen lds
  s_add_u32 m0, s39, 14336
  s_add_u32 s37, s36, 393216
  buffer_load_dwordx4 v25, s[44:47], s37 offen lds
  s_add_u32 m0, s39, 15360
  s_add_u32 s37, s36, 458752
  buffer_load_dwordx4 v25, s[44:47], s37 offen lds
  v_mad_u32_u24 v96, v100, 1, v27
  v_mad_u32_u24 v97, v101, 1, v27
  v_mad_u32_u24 v98, v100, 1, v36
  v_mad_u32_u24 v99, v101, 1, v36
  s_waitcnt vmcnt(8)
  s_barrier
  ds_read_b64_tr_b16 v[208:209], v98 offset:20480
  ds_read_b64_tr_b16 v[210:211], v98 offset:20736
  ds_read_b64_tr_b16 v[212:213], v98 offset:22528
  ds_read_b64_tr_b16 v[214:215], v98 offset:22784
  ds_read_b64_tr_b16 v[216:217], v99 offset:20480
  ds_read_b64_tr_b16 v[218:219], v99 offset:20736
  ds_read_b64_tr_b16 v[220:221], v99 offset:22528
  ds_read_b64_tr_b16 v[222:223], v99 offset:22784
  ds_read_b64_tr_b16 v[64:65], v96 offset:20480
  ds_read_b64_tr_b16 v[66:67], v96 offset:20736
  ds_read_b64_tr_b16 v[68:69], v96 offset:22528
  ds_read_b64_tr_b16 v[70:71], v96 offset:22784
  ds_read_b64_tr_b16 v[72:73], v97 offset:20480
  ds_read_b64_tr_b16 v[74:75], v97 offset:20736
  ds_read_b64_tr_b16 v[76:77], v97 offset:22528
  ds_read_b64_tr_b16 v[78:79], v97 offset:22784
  s_waitcnt lgkmcnt(0)
  s_barrier
  ds_write_b128 v4, v[64:67] offset:20480
  ds_write_b128 v4, v[68:71] offset:21504
  ds_write_b128 v4, v[72:75] offset:22528
  ds_write_b128 v4, v[76:79] offset:23552
  s_xor_b32 s36, s13, 2
  s_lshl_b32 s36, s36, 15
  s_add_u32 m0, s39, 24576
  s_add_u32 s37, s36, 512
  buffer_load_dwordx4 v26, s[48:51], s37 offen lds
  s_add_u32 m0, s39, 25600
  s_add_u32 s37, s36, 8704
  buffer_load_dwordx4 v26, s[48:51], s37 offen lds
  s_add_u32 m0, s39, 26624
  s_add_u32 s37, s36, 16896
  buffer_load_dwordx4 v26, s[48:51], s37 offen lds
  s_add_u32 m0, s39, 27648
  s_add_u32 s37, s36, 25088
  buffer_load_dwordx4 v26, s[48:51], s37 offen lds
  s_xor_b32 s36, s13, 3
  s_lshl_b32 s36, s36, 15
  s_add_u32 m0, s39, 28672
  s_add_u32 s37, s36, 512
  buffer_load_dwordx4 v26, s[48:51], s37 offen lds
  s_add_u32 m0, s39, 29696
  s_add_u32 s37, s36, 8704
  buffer_load_dwordx4 v26, s[48:51], s37 offen lds
  s_add_u32 m0, s39, 30720
  s_add_u32 s37, s36, 16896
  buffer_load_dwordx4 v26, s[48:51], s37 offen lds
  s_add_u32 m0, s39, 31744
  s_add_u32 s37, s36, 25088
  buffer_load_dwordx4 v26, s[48:51], s37 offen lds
  s_mov_b32 s19, 0
  s_branch T_arrgo_4
T_arr_3:
  s_add_u32 s19, s19, 1
  s_cmp_gt_u32 s19, 32768
  s_cbranch_scc1 M_exit
  buffer_load_dwordx2 v[54:55], off, s[72:75], 0 sc1
  buffer_load_dword v56, off, s[72:75], 0 offset:128 sc1
  s_waitcnt vmcnt(0)
T_arrgo_4:
  v_sad_u8 v57, v54, 0, 0
  v_sad_u8 v57, v55, 0, v57
  v_or_b32 v58, v54, v55
  v_cmp_gt_u32 vcc, 32, v57
  s_cbranch_vccnz T_arr_3
  v_cmp_gt_u32 vcc, 0x100, v56
  s_cbranch_vccnz T_arr_3
  v_readfirstlane_b32 s36, v58
  s_nop 0
  s_and_b32 s36, s36, 0x20202020
  s_cselect_b32 s56, 0, 1
  s_mov_b32 s14, -1
  s_mov_b32 s30, -1
  s_mov_b32 s19, 0
  s_branch T_kvok_6
T_kv_5:
  s_sleep 4
  s_add_u32 s19, s19, 1
  s_cmp_gt_u32 s19, 32768
  s_cbranch_scc1 M_exit
T_kvok_6:
  s_add_u32 s39, s99, 128
  s_mov_b32 s38, 0
  s_mov_b32 s37, 0
  s_atomic_or s38, s[58:59], s99 glc
  s_atomic_or s37, s[58:59], s39 glc
  s_waitcnt lgkmcnt(0)
  s_lshl_b32 s38, s38, 1
  s_lshl1_add_u32 s37, s37, 1
  s_min_u32 s38, s38, s37
  s_cmp_ge_u32 s38, 64
  s_cselect_b32 s38, 100, s38
  s_sub_u32 s38, s38, 1
  s_max_i32 s30, s30, s38
  s_cmp_ge_i32 s14, s30
  s_cbranch_scc1 T_kv_5
  s_mov_b32 m0, s31
  s_nop 0
  buffer_load_dwordx4 v9, s[4:7], s27 offen sc1 lds
  s_mov_b32 m0, s32
  s_nop 0
  buffer_load_dwordx4 v9, s[4:7], s27 offen offset:128 sc1 lds
  s_mov_b32 m0, s33
  s_nop 0
  buffer_load_dwordx4 v10, s[4:7], s28 offen sc1 lds
  s_mov_b32 m0, s34
  s_nop 0
  buffer_load_dwordx4 v10, s[4:7], s28 offen offset:256 sc1 lds
  s_add_u32 s27, s27, 8192
  s_add_u32 s28, s28, 8192
  s_lshl_b32 s36, s12, 10
  s_add_u32 s36, s36, 145752064
  buffer_load_dwordx4 v[40:43], v2, s[4:7], s36 offen sc1
  v_mad_u32_u24 v96, v101, 1, v27
  v_mad_u32_u24 v97, v100, 1, v27
  v_mad_u32_u24 v98, v101, 1, v36
  v_mad_u32_u24 v99, v100, 1, v36
  s_waitcnt vmcnt(13)
  s_barrier
  ds_read_b64_tr_b16 v[64:65], v96 offset:8192
  ds_read_b64_tr_b16 v[66:67], v96 offset:8448
  ds_read_b64_tr_b16 v[68:69], v96 offset:10240
  ds_read_b64_tr_b16 v[70:71], v96 offset:10496
  ds_read_b64_tr_b16 v[72:73], v97 offset:8192
  ds_read_b64_tr_b16 v[74:75], v97 offset:8448
  ds_read_b64_tr_b16 v[76:77], v97 offset:10240
  ds_read_b64_tr_b16 v[78:79], v97 offset:10496
  ds_read_b64_tr_b16 v[80:81], v98 offset:8192
  ds_read_b64_tr_b16 v[82:83], v98 offset:8448
  ds_read_b64_tr_b16 v[84:85], v98 offset:10240
  ds_read_b64_tr_b16 v[86:87], v98 offset:10496
  ds_read_b64_tr_b16 v[88:89], v99 offset:8192
  ds_read_b64_tr_b16 v[90:91], v99 offset:8448
  ds_read_b64_tr_b16 v[92:93], v99 offset:10240
  ds_read_b64_tr_b16 v[94:95], v99 offset:10496
  s_waitcnt lgkmcnt(0)
  s_barrier
  ds_write_b128 v4, v[64:67] offset:8192
  ds_write_b128 v4, v[68:71] offset:9216
  ds_write_b128 v4, v[72:75] offset:10240
  ds_write_b128 v4, v[76:79] offset:11264
  ds_write_b128 v4, v[80:83] offset:12288
  ds_write_b128 v4, v[84:87] offset:13312
  ds_write_b128 v4, v[88:91] offset:14336
  ds_write_b128 v4, v[92:95] offset:15360
  s_waitcnt vmcnt(9)
  ds_read_b64_tr_b16 v[64:65], v28 offset:24576
  ds_read_b64_tr_b16 v[66:67], v28 offset:24832
  ds_read_b64_tr_b16 v[68:69], v28 offset:25600
  ds_read_b64_tr_b16 v[70:71], v28 offset:25856
  ds_read_b64_tr_b16 v[72:73], v28 offset:24584
  ds_read_b64_tr_b16 v[74:75], v28 offset:24840
  ds_read_b64_tr_b16 v[76:77], v28 offset:25608
  ds_read_b64_tr_b16 v[78:79], v28 offset:25864
  s_waitcnt lgkmcnt(0)
  ds_write_b128 v4, v[64:67] offset:24576
  ds_write_b128 v4, v[68:71] offset:25600
  ds_write_b128 v4, v[72:75] offset:26624
  ds_write_b128 v4, v[76:79] offset:27648
  s_waitcnt lgkmcnt(0)
  s_waitcnt vmcnt(5)
  ds_read_b64_tr_b16 v[64:65], v28 offset:28672
  ds_read_b64_tr_b16 v[66:67], v28 offset:28928
  ds_read_b64_tr_b16 v[68:69], v28 offset:29696
  ds_read_b64_tr_b16 v[70:71], v28 offset:29952
  ds_read_b64_tr_b16 v[72:73], v28 offset:28680
  ds_read_b64_tr_b16 v[74:75], v28 offset:28936
  ds_read_b64_tr_b16 v[76:77], v28 offset:29704
  ds_read_b64_tr_b16 v[78:79], v28 offset:29960
  s_waitcnt lgkmcnt(0)
  ds_write_b128 v4, v[64:67] offset:28672
  ds_write_b128 v4, v[68:71] offset:29696
  ds_write_b128 v4, v[72:75] offset:30720
  ds_write_b128 v4, v[76:79] offset:31744
  s_waitcnt lgkmcnt(0)
  s_mov_b32 s14, 1
  s_cmp_lt_i32 s14, s30
  s_cbranch_scc1 T_kv2_7
  s_mov_b32 s19, 0
  s_branch T_kvok_9
T_kv_8:
  s_sleep 4
  s_add_u32 s19, s19, 1
  s_cmp_gt_u32 s19, 32768
  s_cbranch_scc1 M_exit
T_kvok_9:
  s_add_u32 s39, s99, 128
  s_mov_b32 s38, 0
  s_mov_b32 s37, 0
  s_atomic_or s38, s[58:59], s99 glc
  s_atomic_or s37, s[58:59], s39 glc
  s_waitcnt lgkmcnt(0)
  s_lshl_b32 s38, s38, 1
  s_lshl1_add_u32 s37, s37, 1
  s_min_u32 s38, s38, s37
  s_cmp_ge_u32 s38, 64
  s_cselect_b32 s38, 100, s38
  s_sub_u32 s38, s38, 1
  s_max_i32 s30, s30, s38
  s_cmp_ge_i32 s14, s30
  s_cbranch_scc1 T_kv_8
T_kv2_7:
  s_waitcnt vmcnt(0) lgkmcnt(0)
  s_barrier
  s_cmp_ge_u32 s13, 2
  s_cselect_b64 vcc, -1, 0
  v_cndmask_b32 v3, v8, v19, vcc
  ds_read_b128 v[68:71], v4 offset:0
  ds_read_b128 v[72:75], v4 offset:1024
  ds_read_b128 v[76:79], v4 offset:4096
  ds_read_b128 v[80:83], v4 offset:5120
  ds_read_b128 v[84:87], v4 offset:8192
  ds_read_b128 v[88:91], v4 offset:9216
  ds_read_b128 v[92:95], v4 offset:2048
  ds_read_b128 v[96:99], v4 offset:3072
  ds_read_b128 v[100:103], v4 offset:6144
  ds_read_b128 v[104:107], v4 offset:7168
  ds_read_b128 v[108:111], v4 offset:10240
  ds_read_b128 v[112:115], v4 offset:11264
  ds_read_b128 v[28:31], v59 offset:16384
  ds_read_b128 v[32:35], v59 offset:20480
  ds_read_b128 v[36:39], v2 offset:8192
  ds_read_b128 v[40:43], v2 offset:9216
  ds_read_b128 v[44:47], v2 offset:10240
  ds_read_b128 v[48:51], v2 offset:11264
  ds_read_b128 v[52:55], v2 offset:12288
  ds_read_b128 v[56:59], v2 offset:13312
  ds_read_b128 v[60:63], v2 offset:14336
  ds_read_b128 v[64:67], v2 offset:15360
  s_and_b32 s36, s13, 1
  s_lshl_b32 s36, s36, 12
  s_add_u32 s22, s22, s36
  s_add_u32 s23, s36, 145752064
  s_mov_b32 s14, -1
  s_and_b32 s57, s14, 1
  s_and_b32 s36, s14, 3
  s_lshl_b32 s36, s36, 13
  s_add_u32 s26, s36, s23
  s_add_u32 s36, s36, 8192
  s_and_b32 s36, s36, 0x7fff
  s_add_u32 s24, s36, 145752064
  s_add_u32 s25, s36, 145756160
  s_add_u32 s35, s36, s23
  s_waitcnt lgkmcnt(0)
  s_cmp_lg_u32 s56, 0
  s_cbranch_scc1 M_global
T_code:
  s_cmp_eq_u32 s13, 1
  s_cbranch_scc1 T_w_11
  s_cmp_eq_u32 s13, 2
  s_cbranch_scc1 T_w_12
  s_cmp_eq_u32 s13, 3
  s_cbranch_scc1 T_w_13
T_w_10:
  s_mov_b32 s19, 0
  s_add_u32 s14, s14, 1
  s_and_b32 s57, s14, 1
  v_mov_b64 v[16:17], 0
  v_mov_b64 v[18:19], 0
  v_mov_b64 v[20:21], 0
  v_mov_b64 v[22:23], 0
  v_mov_b64 v[24:25], 0
  v_mov_b64 v[26:27], 0
  buffer_load_dwordx4 v[124:127], v2, s[4:7], s24 offen offset:0 sc1
  buffer_load_dwordx4 v[116:119], v2, s[4:7], s25 offen offset:0 sc1
  buffer_load_dwordx4 v[124:127], v2, s[4:7], s24 offen offset:0 sc1
  buffer_load_dwordx4 v[116:119], v2, s[4:7], s25 offen offset:0 sc1
  s_branch T_loop_14
.p2align 6
T_retry_15:
  s_mov_b64 exec, vcc
  buffer_load_dwordx4 v[124:127], v2, s[4:7], s24 offen offset:0 sc1
  buffer_load_dwordx4 v[116:119], v2, s[4:7], s25 offen offset:0 sc1
  s_mov_b64 exec, -1
  s_add_u32 s19, s19, 1
  s_cmp_gt_u32 s19, 32768
  s_cbranch_scc1 M_exit
  s_nop 0
  v_mov_b64 v[16:17], 0
  v_mov_b64 v[18:19], 0
T_loop_14:
  s_waitcnt vmcnt(3) lgkmcnt(0)
  v_max3_u32 v123, v124, v125, v126
  v_max_u32 v123, v123, v127
  v_mov_b32_dpp v120, v124 row_ror:8 row_mask:0xf bank_mask:0xf
  v_mov_b32_dpp v121, v125 row_ror:8 row_mask:0xf bank_mask:0xf
  s_waitcnt vmcnt(2)
  v_max3_u32 v123, v123, v116, v117
  v_max3_u32 v123, v123, v118, v119
  v_cmp_eq_u32 vcc, -1, v123
  v_smfmac_f32_16x16x64_bf16 v[16:19], v[124:127], v[68:75], v0
  s_cbranch_vccnz T_retry_15
  ds_write_b128 v2, v[124:127] offset:0
  v_mov_b32_dpp v122, v126 row_ror:8 row_mask:0xf bank_mask:0xf
  v_smfmac_f32_16x16x64_bf16 v[20:23], v[124:127], v[76:83], v0
  s_and_b32 s57, s14, 1
  v_mov_b32_dpp v123, v127 row_ror:8 row_mask:0xf bank_mask:0xf
  v_smfmac_f32_16x16x64_bf16 v[24:27], v[124:127], v[84:91], v0
  s_and_b32 s36, s14, 3
  ds_write_b128 v2, v[116:119] offset:4096
  v_smfmac_f32_16x16x64_bf16 v[16:19], v[120:123], v[92:99], v0
  s_lshl_b32 s36, s36, 13
  v_mov_b32_dpp v84, v116 row_ror:8 row_mask:0xf bank_mask:0xf
  v_smfmac_f32_16x16x64_bf16 v[20:23], v[120:123], v[100:107], v0
  s_add_u32 s26, s36, s23
  ds_read_b128 v[68:71], v4 offset:12288
  v_mov_b32_dpp v85, v117 row_ror:8 row_mask:0xf bank_mask:0xf
  v_smfmac_f32_16x16x64_bf16 v[24:27], v[120:123], v[108:115], v0
  s_add_u32 s36, s36, 8192
  ds_read_b128 v[72:75], v4 offset:13312
  v_mov_b32_dpp v86, v118 row_ror:8 row_mask:0xf bank_mask:0xf
  v_smfmac_f32_16x16x64_bf16 v[16:19], v[116:119], v[224:231], v0
  s_and_b32 s36, s36, 0x7fff
  ds_read_b128 v[76:79], v4 offset:14336
  v_mov_b32_dpp v87, v119 row_ror:8 row_mask:0xf bank_mask:0xf
  v_smfmac_f32_16x16x64_bf16 v[20:23], v[116:119], v[240:247], v0
  s_waitcnt lgkmcnt(3)
  s_barrier
  ds_read_b128 v[100:103], v2 offset:1024
  v_smfmac_f32_16x16x64_bf16 v[24:27], v[116:119], a[0:7], v0
  s_mov_b32 m0, s31
  ds_read_b128 v[120:123], v1 offset:1024
  buffer_load_dwordx4 v9, s[4:7], s27 offen sc1 lds
  v_smfmac_f32_16x16x64_bf16 v[16:19], v[84:87], v[232:239], v0
  s_mov_b32 m0, s32
  v_smfmac_f32_16x16x64_bf16 v[20:23], v[84:87], v[248:255], v0
  ds_read_b128 v[80:83], v4 offset:15360
  v_smfmac_f32_16x16x64_bf16 v[24:27], v[84:87], a[8:15], v0
  s_waitcnt lgkmcnt(2)
  v_smfmac_f32_16x16x64_bf16 v[16:19], v[100:103], v[128:135], v0
  ds_read_b128 v[92:95], v2 offset:2048
  buffer_load_dwordx4 v9, s[4:7], s27 offen offset:128 sc1 lds
  v_smfmac_f32_16x16x64_bf16 v[20:23], v[100:103], v[144:151], v0
  ds_read_b128 v[96:99], v1 offset:2048
  s_mov_b32 m0, s33
  v_smfmac_f32_16x16x64_bf16 v[24:27], v[100:103], v[68:75], v0
  s_waitcnt vmcnt(2) lgkmcnt(3)
  ds_read_b128 v[116:119], v2 offset:3072
  v_smfmac_f32_16x16x64_bf16 v[16:19], v[120:123], v[136:143], v0
  ds_read_b128 v[124:127], v1 offset:3072
  v_smfmac_f32_16x16x64_bf16 v[20:23], v[120:123], v[152:159], v0
  s_waitcnt lgkmcnt(4)
  ds_read_b128 v[104:107], v2 offset:5120
  buffer_load_dwordx4 v10, s[4:7], s28 offen sc1 lds
  v_smfmac_f32_16x16x64_bf16 v[24:27], v[120:123], v[76:83], v0
  s_waitcnt lgkmcnt(4)
  ds_read_b128 v[108:111], v1 offset:5120
  s_mov_b32 m0, s34
  v_smfmac_f32_16x16x64_bf16 v[16:19], v[92:95], v[160:167], v0
  s_waitcnt lgkmcnt(4)
  ds_read_b128 v[112:115], v2 offset:6144
  v_smfmac_f32_16x16x64_bf16 v[16:19], v[96:99], v[168:175], v0
  s_waitcnt lgkmcnt(4)
  ds_read_b128 v[84:87], v1 offset:6144
  v_smfmac_f32_16x16x64_bf16 v[16:19], v[116:119], v[192:199], v0
  s_waitcnt lgkmcnt(4)
  ds_read_b128 v[88:91], v2 offset:7168
  buffer_load_dwordx4 v10, s[4:7], s28 offen offset:256 sc1 lds
  v_smfmac_f32_16x16x64_bf16 v[16:19], v[124:127], v[200:207], v0
  s_waitcnt lgkmcnt(4)
  ds_read_b128 v[100:103], v1 offset:7168
  v_smfmac_f32_16x16x64_bf16 v[16:19], v[104:107], a[16:23], v0
  s_waitcnt lgkmcnt(4)
  ds_read_b128 v[68:71], v4 offset:16384
  v_smfmac_f32_16x16x64_bf16 v[16:19], v[108:111], a[24:31], v0
  s_waitcnt lgkmcnt(4)
  ds_read_b128 v[72:75], v4 offset:17408
  v_smfmac_f32_16x16x64_bf16 v[16:19], v[112:115], a[64:71], v0
  s_waitcnt lgkmcnt(4)
  ds_read_b128 v[76:79], v4 offset:18432
  v_smfmac_f32_16x16x64_bf16 v[16:19], v[84:87], a[72:79], v0
  s_waitcnt lgkmcnt(4)
  ds_read_b128 v[80:83], v4 offset:19456
  v_smfmac_f32_16x16x64_bf16 v[16:19], v[88:91], a[112:119], v0
  s_waitcnt lgkmcnt(4)
  v_smfmac_f32_16x16x64_bf16 v[16:19], v[100:103], a[120:127], v0
  s_add_u32 s24, s36, 145752064
  s_add_u32 s25, s36, 145756160
  v_smfmac_f32_16x16x64_bf16 v[20:23], v[92:95], v[176:183], v0
  s_add_u32 s35, s36, s23
  v_smfmac_f32_16x16x64_bf16 v[20:23], v[96:99], v[184:191], v0
  s_waitcnt lgkmcnt(2)
  v_smfmac_f32_16x16x64_bf16 v[20:23], v[116:119], v[68:75], v0
  s_waitcnt lgkmcnt(0)
  ds_read_b128 v[68:71], v4 offset:20480
  v_mul_f32 v16, s18, v16
  v_smfmac_f32_16x16x64_bf16 v[20:23], v[124:127], v[76:83], v0
  ds_read_b128 v[72:75], v4 offset:21504
  v_mul_f32 v17, s18, v17
  v_smfmac_f32_16x16x64_bf16 v[20:23], v[104:107], a[32:39], v0
  ds_read_b128 v[76:79], v4 offset:22528
  v_mul_f32 v18, s18, v18
  v_smfmac_f32_16x16x64_bf16 v[20:23], v[108:111], a[40:47], v0
  ds_read_b128 v[80:83], v4 offset:23552
  v_mul_f32 v19, s18, v19
  v_smfmac_f32_16x16x64_bf16 v[20:23], v[112:115], a[80:87], v0
  v_cvt_pk_bf16_f32 v120, v16, v17
  v_smfmac_f32_16x16x64_bf16 v[20:23], v[84:87], a[88:95], v0
  v_cvt_pk_bf16_f32 v121, v18, v19
  v_smfmac_f32_16x16x64_bf16 v[20:23], v[88:91], a[128:135], v0
  ds_write_b64 v5, v[120:121] offset:24576
  v_smfmac_f32_16x16x64_bf16 v[20:23], v[100:103], a[136:143], v0
  s_waitcnt lgkmcnt(3)
  v_smfmac_f32_16x16x64_bf16 v[24:27], v[92:95], v[68:75], v0
  s_waitcnt lgkmcnt(1)
  v_mov_b64 v[92:93], 0
  v_smfmac_f32_16x16x64_bf16 v[24:27], v[96:99], v[76:83], v0
  s_nop 1
  v_cvt_pk_bf16_f32 v122, v20, v21
  v_cvt_pk_bf16_f32 v123, v22, v23
  v_smfmac_f32_16x16x64_bf16 v[24:27], v[116:119], v[208:215], v0
  ds_write_b64 v5, v[122:123] offset:26880
  v_mov_b64 v[94:95], 0
  v_smfmac_f32_16x16x64_bf16 v[24:27], v[124:127], v[216:223], v0
  s_waitcnt lgkmcnt(1)
  s_barrier
  ds_read_b64_tr_b16 v[68:69], v6 offset:24576
  v_smfmac_f32_16x16x64_bf16 v[24:27], v[104:107], a[48:55], v0
  s_add_u32 s27, s27, 8192
  ds_read_b64_tr_b16 v[70:71], v6 offset:24640
  ds_read_b64_tr_b16 v[72:73], v6 offset:24832
  v_smfmac_f32_16x16x64_bf16 v[24:27], v[108:111], a[56:63], v0
  s_add_u32 s28, s28, 8192
  ds_read_b64_tr_b16 v[74:75], v6 offset:24896
  ds_read_b64_tr_b16 v[76:77], v6 offset:25088
  v_smfmac_f32_16x16x64_bf16 v[24:27], v[112:115], a[96:103], v0
  s_nop 0
  ds_read_b64_tr_b16 v[78:79], v6 offset:25152
  ds_read_b64_tr_b16 v[80:81], v6 offset:25344
  v_smfmac_f32_16x16x64_bf16 v[24:27], v[84:87], a[104:111], v0
  ds_read_b64_tr_b16 v[82:83], v6 offset:25408
  v_mov_b64 v[96:97], 0
  v_smfmac_f32_16x16x64_bf16 v[24:27], v[88:91], a[144:151], v0
  s_waitcnt lgkmcnt(8)
  s_barrier
  ds_read_b64_tr_b16 v[116:117], v6 offset:26880
  v_smfmac_f32_16x16x64_bf16 v[24:27], v[100:103], a[152:159], v0
  s_waitcnt lgkmcnt(7)
  ds_read_b64_tr_b16 v[118:119], v6 offset:26944
  v_mfma_f32_16x16x32_bf16 v[16:19], v[36:39], v[68:71], 0
  s_waitcnt lgkmcnt(6)
  ds_read_b64_tr_b16 v[124:125], v6 offset:27136
  ds_read_b64_tr_b16 v[126:127], v6 offset:27200
  v_mfma_f32_16x16x32_bf16 v[16:19], v[40:43], v[72:75], v[16:19]
  s_waitcnt lgkmcnt(6)
  ds_read_b64_tr_b16 v[104:105], v6 offset:27392
  ds_read_b64_tr_b16 v[106:107], v6 offset:27456
  v_mfma_f32_16x16x32_bf16 v[16:19], v[44:47], v[76:79], v[16:19]
  s_waitcnt lgkmcnt(6)
  ds_read_b64_tr_b16 v[108:109], v6 offset:27648
  ds_read_b64_tr_b16 v[110:111], v6 offset:27712
  v_mfma_f32_16x16x32_bf16 v[16:19], v[48:51], v[80:83], v[16:19]
  s_waitcnt lgkmcnt(6)
  v_cvt_pk_bf16_f32 v120, v24, v25
  v_cvt_pk_bf16_f32 v121, v26, v27
  v_mfma_f32_16x16x32_bf16 v[112:115], v[116:119], v[68:71], 0
  s_waitcnt lgkmcnt(4)
  buffer_store_dwordx4 v[120:123], v2, s[4:7], s29 offen offset:0 sc1
  v_mov_b64 v[98:99], 0
  v_mfma_f32_16x16x32_bf16 v[112:115], v[124:127], v[72:75], v[112:115]
  s_waitcnt lgkmcnt(2)
  v_mov_b64 v[36:37], 0
  v_exp_f32 v100, v16
  v_mfma_f32_16x16x32_bf16 v[112:115], v[104:107], v[76:79], v[112:115]
  s_waitcnt lgkmcnt(0)
  v_exp_f32 v101, v17
  v_mfma_f32_16x16x32_bf16 v[112:115], v[108:111], v[80:83], v[112:115]
  v_exp_f32 v102, v18
  v_mfma_f32_16x16x32_bf16 v[20:23], v[52:55], v[68:71], 0
  v_exp_f32 v103, v19
  v_mfma_f32_16x16x32_bf16 v[20:23], v[56:59], v[72:75], v[20:23]
  v_cvt_pk_bf16_f32 v44, v100, v101
  v_cvt_pk_bf16_f32 v45, v102, v103
  v_mfma_f32_16x16x32_bf16 v[20:23], v[60:63], v[76:79], v[20:23]
  s_add_u32 s29, s29, 131072
  v_exp_f32 v100, v112
  v_mfma_f32_16x16x32_bf16 v[20:23], v[64:67], v[80:83], v[20:23]
  v_exp_f32 v101, v113
  v_exp_f32 v102, v114
  v_exp_f32 v103, v115
  v_cvt_pk_bf16_f32 v84, v100, v101
  v_cvt_pk_bf16_f32 v85, v102, v103
  v_cndmask_b32 v48, v84, 0, s[16:17]
  v_cndmask_b32 v49, v85, 0, s[16:17]
  v_cndmask_b32 v50, 0, v84, s[16:17]
  v_cndmask_b32 v51, 0, v85, s[16:17]
  v_exp_f32 v100, v20
  v_mfma_f32_16x16x16_bf16 v[88:91], v[12:13], v[48:49], 0
  v_exp_f32 v101, v21
  v_mfma_f32_16x16x16_bf16 v[24:27], v[120:121], v[48:49], 0
  v_exp_f32 v102, v22
  v_mfma_f32_16x16x16_bf16 v[116:119], v[120:121], v[50:51], 0
  v_exp_f32 v103, v23
  v_cvt_pk_bf16_f32 v46, v100, v101
  v_cvt_pk_bf16_f32 v47, v102, v103
  v_mov_b64 v[38:39], 0
  s_nop 0
  v_mfma_f32_16x16x32_bf16 v[88:91], v[12:15], v[44:47], v[88:91]
  v_mov_b64 v[40:41], 0
  v_mov_b64 v[42:43], 0
  v_mfma_f32_16x16x32_bf16 v[24:27], v[28:31], v[44:47], v[24:27]
  ds_read_b128 v[52:55], v4 offset:24576
  ds_read_b128 v[56:59], v4 offset:25600
  v_mfma_f32_16x16x32_bf16 v[116:119], v[32:35], v[44:47], v[116:119]
  s_nop 1
T_back_22:
  v_rcp_f32 v89, v88
  v_subrev_u32 v100, s54, v88
  v_cmp_le_u32 vcc, s96, v100
  v_mul_f32 v24, v89, v24
  v_mul_f32 v25, v89, v25
  v_cvt_pk_bf16_f32 v124, v24, v25
  v_pk_mul_f32 v[26:27], v[26:27], v[88:89] op_sel:[0,1] op_sel_hi:[1,1]
  v_pk_mul_f32 v[116:117], v[116:117], v[88:89] op_sel:[0,1] op_sel_hi:[1,1]
  v_pk_mul_f32 v[118:119], v[118:119], v[88:89] op_sel:[0,1] op_sel_hi:[1,1]
  v_cvt_pk_bf16_f32 v125, v26, v27
  v_cvt_pk_bf16_f32 v126, v116, v117
  v_cvt_pk_bf16_f32 v127, v118, v119
  ds_write_b128 v11, v[124:127] offset:29184
  s_cbranch_vccnz T_slow_21
  v_smfmac_f32_16x16x64_bf16 v[92:95], v[124:127], a[160:167], v0
  s_mov_b32 s96, s55
  v_smfmac_f32_16x16x64_bf16 v[96:99], v[124:127], a[168:175], v0
  v_smfmac_f32_16x16x64_bf16 v[36:39], v[124:127], a[176:183], v0
  s_waitcnt lgkmcnt(0)
  s_barrier
  ds_read_b128 v[104:107], v11 offset:29696
  ds_read_b128 v[108:111], v11 offset:30208
  ds_read_b128 v[68:71], v11 offset:30720
  v_smfmac_f32_16x16x64_bf16 v[40:43], v[124:127], a[184:191], v0
  s_waitcnt lgkmcnt(2)
  v_smfmac_f32_16x16x64_bf16 v[92:95], v[104:107], a[192:199], v0
  s_waitcnt lgkmcnt(1)
  ds_read_b128 v[76:79], v4 offset:28672
  v_smfmac_f32_16x16x64_bf16 v[92:95], v[108:111], a[224:231], v0
  s_waitcnt lgkmcnt(1)
  ds_read_b128 v[80:83], v4 offset:29696
  v_smfmac_f32_16x16x64_bf16 v[92:95], v[68:71], a[240:247], v0
  ds_read_b128 v[60:63], v4 offset:26624
  v_smfmac_f32_16x16x64_bf16 v[96:99], v[104:107], a[200:207], v0
  ds_read_b128 v[64:67], v4 offset:27648
  v_smfmac_f32_16x16x64_bf16 v[96:99], v[108:111], a[232:239], v0
  ds_read_b128 v[28:31], v4 offset:30720
  s_nop 0
  v_cvt_pk_bf16_f32 v16, v92, v93
  v_cvt_pk_bf16_f32 v17, v94, v95
  v_bfi_b32 v16, 1, s57, v16
  v_smfmac_f32_16x16x64_bf16 v[96:99], v[68:71], a[248:255], v0
  buffer_store_dwordx2 v[16:17], v7, s[4:7], s20 offen offset:0
  v_smfmac_f32_16x16x64_bf16 v[36:39], v[104:107], a[208:215], v0
  ds_read_b128 v[32:35], v4 offset:31744
  v_smfmac_f32_16x16x64_bf16 v[36:39], v[108:111], v[52:59], v0
  s_waitcnt lgkmcnt(4)
  s_nop 0
  v_cvt_pk_bf16_f32 v18, v96, v97
  v_cvt_pk_bf16_f32 v19, v98, v99
  v_bfi_b32 v18, 1, s57, v18
  v_smfmac_f32_16x16x64_bf16 v[36:39], v[68:71], v[76:83], v0
  buffer_store_dwordx2 v[18:19], v7, s[4:7], s20 offen offset:64
  v_smfmac_f32_16x16x64_bf16 v[40:43], v[104:107], a[216:223], v0
  s_waitcnt lgkmcnt(2)
  ds_read_b128 v[116:119], v2 offset:31232
  v_smfmac_f32_16x16x64_bf16 v[40:43], v[108:111], v[60:67], v0
  s_waitcnt lgkmcnt(1)
  s_nop 0
  v_cvt_pk_bf16_f32 v20, v36, v37
  v_cvt_pk_bf16_f32 v21, v38, v39
  v_bfi_b32 v20, 1, s57, v20
  v_smfmac_f32_16x16x64_bf16 v[40:43], v[68:71], v[28:35], v0
  buffer_store_dwordx2 v[20:21], v7, s[4:7], s21 offen offset:0
  s_nop 6
  v_cvt_pk_bf16_f32 v22, v40, v41
  v_cvt_pk_bf16_f32 v23, v42, v43
  v_bfi_b32 v22, 1, s57, v22
  buffer_store_dwordx2 v[22:23], v7, s[4:7], s21 offen offset:64
  ds_read_b128 v[68:71], v4 offset:0
  ds_read_b128 v[72:75], v4 offset:1024
  ds_read_b128 v[76:79], v4 offset:4096
  ds_read_b128 v[80:83], v4 offset:5120
  ds_read_b128 v[84:87], v4 offset:8192
  ds_read_b128 v[88:91], v4 offset:9216
  v_mov_b64 v[16:17], 0
  v_mov_b64 v[18:19], 0
  v_mov_b64 v[20:21], 0
  v_mov_b64 v[22:23], 0
  v_mov_b64 v[24:25], 0
  v_mov_b64 v[26:27], 0
  s_mov_b32 s19, 0
  v_mov_b32 v49, -1
  s_waitcnt vmcnt(2)
  buffer_load_dwordx4 v[52:55], v2, s[4:7], s22 offen offset:0 sc1
  buffer_load_dwordx4 v[56:59], v2, s[4:7], s22 offen offset:1024 sc1
  buffer_load_dwordx4 v[60:63], v2, s[4:7], s22 offen offset:2048 sc1
  buffer_load_dwordx4 v[64:67], v2, s[4:7], s22 offen offset:3072 sc1
  ds_read_b128 v[92:95], v4 offset:2048
  ds_read_b128 v[96:99], v4 offset:3072
  ds_read_b128 v[100:103], v4 offset:6144
  ds_read_b128 v[104:107], v4 offset:7168
  ds_read_b128 v[108:111], v4 offset:10240
  ds_read_b128 v[112:115], v4 offset:11264
  ds_read_b64 v[44:45], v2 offset:32256
  s_waitcnt lgkmcnt(0)
  v_readfirstlane_b32 s38, v44
  v_readfirstlane_b32 s37, v45
  s_nop 0
  s_lshl_b32 s38, s38, 1
  s_lshl1_add_u32 s37, s37, 1
  s_min_u32 s38, s38, s37
  s_cmp_ge_u32 s38, 64
  s_cselect_b32 s38, 100, s38
  s_sub_u32 s38, s38, 1
  s_max_i32 s30, s30, s38
  s_waitcnt lgkmcnt(12)
  s_waitcnt vmcnt(3)
  v_mfma_f32_16x16x32_bf16 v[120:123], v[116:119], v[52:55], 0
  v_xor_b32 v48, s57, v52
  v_bitop3_b32 v48, v48, v54, s57 bitop3:0xf6
  s_waitcnt vmcnt(2)
  v_mfma_f32_16x16x32_bf16 v[120:123], v[116:119], v[56:59], v[120:123]
  v_bitop3_b32 v48, v48, v56, s57 bitop3:0xf6
  v_bitop3_b32 v48, v48, v58, s57 bitop3:0xf6
  s_waitcnt vmcnt(1)
  v_mfma_f32_16x16x32_bf16 v[120:123], v[116:119], v[60:63], v[120:123]
  v_bitop3_b32 v48, v48, v60, s57 bitop3:0xf6
  v_bitop3_b32 v48, v48, v62, s57 bitop3:0xf6
  s_waitcnt vmcnt(0)
  v_mfma_f32_16x16x32_bf16 v[120:123], v[116:119], v[64:67], v[120:123]
  v_bitop3_b32 v48, v48, v64, s57 bitop3:0xf6
  v_bitop3_b32 v48, v48, v66, s57 bitop3:0xf6
  v_and_b32 v48, 1, v48
  v_cmp_ne_u32 vcc, 0, v48
  s_cbranch_vccnz T_p1re_24
T_p1ok_25:
  s_nop 2
  v_add_f32_dpp v120, v120, v120 row_ror:8 row_mask:0xf bank_mask:0xf
  v_add_f32_dpp v121, v121, v121 row_ror:8 row_mask:0xf bank_mask:0xf
  v_cvt_pk_bf16_f32 v48, v120, v121
  buffer_store_dword v48, v8, s[4:7], s35 offen
  buffer_store_dword v49, v8, s[4:7], s26 offen
  s_barrier
  ds_read_b128 v[28:31], v2 offset:16384
  ds_read_b128 v[32:35], v2 offset:20480
  ds_read_b128 v[36:39], v2 offset:8192
  ds_read_b128 v[40:43], v2 offset:9216
  ds_read_b128 v[44:47], v2 offset:10240
  ds_read_b128 v[48:51], v2 offset:11264
  buffer_load_dwordx4 v[124:127], v2, s[4:7], s24 offen offset:0 sc1
  buffer_load_dwordx4 v[116:119], v2, s[4:7], s25 offen offset:0 sc1
  ds_read_b128 v[52:55], v2 offset:12288
  ds_read_b128 v[56:59], v2 offset:13312
  ds_read_b128 v[60:63], v2 offset:14336
  ds_read_b128 v[64:67], v2 offset:15360
  buffer_load_dwordx4 v[124:127], v2, s[4:7], s24 offen offset:0 sc1
  buffer_load_dwordx4 v[116:119], v2, s[4:7], s25 offen offset:0 sc1
  s_add_u32 s14, s14, 1
  s_cmp_ge_i32 s14, s30
  s_cbranch_scc1 T_kvw_18
T_kvb_19:
  s_mov_b32 s19, 0
  s_cmp_lg_u32 s14, 63
  s_cbranch_scc1 T_loop_14
  s_branch T_last_20
T_p1re_24:
  s_mov_b64 exec, vcc
  buffer_load_dwordx4 v[52:55], v2, s[4:7], s22 offen offset:0 sc1
  buffer_load_dwordx4 v[56:59], v2, s[4:7], s22 offen offset:1024 sc1
  buffer_load_dwordx4 v[60:63], v2, s[4:7], s22 offen offset:2048 sc1
  buffer_load_dwordx4 v[64:67], v2, s[4:7], s22 offen offset:3072 sc1
  s_mov_b64 exec, -1
  s_add_u32 s19, s19, 1
  s_cmp_gt_u32 s19, 32768
  s_cbranch_scc1 M_exit
  s_waitcnt vmcnt(3)
  v_mfma_f32_16x16x32_bf16 v[120:123], v[116:119], v[52:55], 0
  v_xor_b32 v48, s57, v52
  v_bitop3_b32 v48, v48, v54, s57 bitop3:0xf6
  s_waitcnt vmcnt(2)
  v_mfma_f32_16x16x32_bf16 v[120:123], v[116:119], v[56:59], v[120:123]
  v_bitop3_b32 v48, v48, v56, s57 bitop3:0xf6
  v_bitop3_b32 v48, v48, v58, s57 bitop3:0xf6
  s_waitcnt vmcnt(1)
  v_mfma_f32_16x16x32_bf16 v[120:123], v[116:119], v[60:63], v[120:123]
  v_bitop3_b32 v48, v48, v60, s57 bitop3:0xf6
  v_bitop3_b32 v48, v48, v62, s57 bitop3:0xf6
  s_waitcnt vmcnt(0)
  v_mfma_f32_16x16x32_bf16 v[120:123], v[116:119], v[64:67], v[120:123]
  v_bitop3_b32 v48, v48, v64, s57 bitop3:0xf6
  v_bitop3_b32 v48, v48, v66, s57 bitop3:0xf6
  v_and_b32 v48, 1, v48
  v_cmp_ne_u32 vcc, 0, v48
  s_cbranch_vccnz T_p1re_24
  s_branch T_p1ok_25
T_kvw_18:
  s_mov_b32 s19, 0
  s_branch T_kvok_27
T_kv_26:
  s_sleep 4
  s_add_u32 s19, s19, 1
  s_cmp_gt_u32 s19, 32768
  s_cbranch_scc1 M_exit
T_kvok_27:
  s_add_u32 s39, s99, 128
  s_mov_b32 s38, 0
  s_mov_b32 s37, 0
  s_atomic_or s38, s[58:59], s99 glc
  s_atomic_or s37, s[58:59], s39 glc
  s_waitcnt lgkmcnt(0)
  s_lshl_b32 s38, s38, 1
  s_lshl1_add_u32 s37, s37, 1
  s_min_u32 s38, s38, s37
  s_cmp_ge_u32 s38, 64
  s_cselect_b32 s38, 100, s38
  s_sub_u32 s38, s38, 1
  s_max_i32 s30, s30, s38
  s_cmp_ge_i32 s14, s30
  s_cbranch_scc1 T_kv_26
  s_branch T_kvb_19
T_slow_21:
  s_nop 7
  v_max3_f32 v100, v16, v17, v18
  v_max3_f32 v100, v100, v19, v20
  v_max3_f32 v100, v100, v21, v22
  v_max3_f32 v100, v100, v23, v112
  v_max3_f32 v100, v100, v113, v114
  v_max_f32 v100, v100, v115
  v_mov_b32 v101, v100
  s_nop 1
  v_permlane32_swap_b32 v100, v101
  s_nop 1
  v_max_f32 v100, v100, v101
  v_mov_b32 v101, v100
  s_nop 1
  v_permlane16_swap_b32 v100, v101
  s_nop 1
  v_max_f32 v100, v100, v101
  v_sub_f32 v16, v16, v100
  v_sub_f32 v17, v17, v100
  v_sub_f32 v18, v18, v100
  v_sub_f32 v19, v19, v100
  v_exp_f32 v16, v16
  v_exp_f32 v17, v17
  v_exp_f32 v18, v18
  v_exp_f32 v19, v19
  v_sub_f32 v20, v20, v100
  v_sub_f32 v21, v21, v100
  v_sub_f32 v22, v22, v100
  v_sub_f32 v23, v23, v100
  v_exp_f32 v20, v20
  v_exp_f32 v21, v21
  v_exp_f32 v22, v22
  v_exp_f32 v23, v23
  v_sub_f32 v112, v112, v100
  v_sub_f32 v113, v113, v100
  v_sub_f32 v114, v114, v100
  v_sub_f32 v115, v115, v100
  v_exp_f32 v112, v112
  v_exp_f32 v113, v113
  v_exp_f32 v114, v114
  v_exp_f32 v115, v115
  s_nop 0
  v_cvt_pk_bf16_f32 v44, v16, v17
  v_cvt_pk_bf16_f32 v45, v18, v19
  v_cvt_pk_bf16_f32 v46, v20, v21
  v_cvt_pk_bf16_f32 v47, v22, v23
  v_cvt_pk_bf16_f32 v84, v112, v113
  v_cvt_pk_bf16_f32 v85, v114, v115
  v_cndmask_b32 v48, v84, 0, s[16:17]
  v_cndmask_b32 v49, v85, 0, s[16:17]
  v_cndmask_b32 v50, 0, v84, s[16:17]
  v_cndmask_b32 v51, 0, v85, s[16:17]
  s_nop 1
  v_mfma_f32_16x16x16_bf16 v[88:91], v[12:13], v[48:49], 0
  v_mfma_f32_16x16x16_bf16 v[24:27], v[120:121], v[48:49], 0
  v_mfma_f32_16x16x16_bf16 v[116:119], v[120:121], v[50:51], 0
  v_mfma_f32_16x16x32_bf16 v[88:91], v[12:15], v[44:47], v[88:91]
  v_mfma_f32_16x16x32_bf16 v[24:27], v[28:31], v[44:47], v[24:27]
  v_mfma_f32_16x16x32_bf16 v[116:119], v[32:35], v[44:47], v[116:119]
  s_nop 7
  s_nop 1
  s_mov_b32 s96, -1
  s_branch T_back_22
.p2align 6
T_retry_28:
  s_mov_b64 exec, vcc
  buffer_load_dwordx4 v[124:127], v2, s[4:7], s24 offen offset:0 sc1
  buffer_load_dwordx4 v[116:119], v2, s[4:7], s25 offen offset:0 sc1
  s_mov_b64 exec, -1
  s_add_u32 s19, s19, 1
  s_cmp_gt_u32 s19, 32768
  s_cbranch_scc1 M_exit
T_last_20:
  s_waitcnt vmcnt(3) lgkmcnt(0)
  v_max3_u32 v123, v124, v125, v126
  v_max_u32 v123, v123, v127
  v_mov_b32_dpp v120, v124 row_ror:8 row_mask:0xf bank_mask:0xf
  v_mov_b32_dpp v121, v125 row_ror:8 row_mask:0xf bank_mask:0xf
  s_waitcnt vmcnt(2)
  v_max3_u32 v123, v123, v116, v117
  v_max3_u32 v123, v123, v118, v119
  v_cmp_eq_u32 vcc, -1, v123
  s_cbranch_vccnz T_retry_28
  v_smfmac_f32_16x16x64_bf16 v[20:23], v[124:127], v[76:83], v0
  ds_write_b128 v2, v[124:127] offset:0
  v_mov_b32_dpp v122, v126 row_ror:8 row_mask:0xf bank_mask:0xf
  v_mov_b32_dpp v123, v127 row_ror:8 row_mask:0xf bank_mask:0xf
  v_smfmac_f32_16x16x64_bf16 v[24:27], v[124:127], v[84:91], v0
  ds_write_b128 v2, v[116:119] offset:4096
  v_mov_b32_dpp v84, v116 row_ror:8 row_mask:0xf bank_mask:0xf
  v_smfmac_f32_16x16x64_bf16 v[20:23], v[120:123], v[100:107], v0
  ds_read_b128 v[68:71], v4 offset:12288
  v_mov_b32_dpp v85, v117 row_ror:8 row_mask:0xf bank_mask:0xf
  v_smfmac_f32_16x16x64_bf16 v[24:27], v[120:123], v[108:115], v0
  ds_read_b128 v[72:75], v4 offset:13312
  v_mov_b32_dpp v86, v118 row_ror:8 row_mask:0xf bank_mask:0xf
  ds_read_b128 v[76:79], v4 offset:14336
  v_mov_b32_dpp v87, v119 row_ror:8 row_mask:0xf bank_mask:0xf
  v_smfmac_f32_16x16x64_bf16 v[20:23], v[116:119], v[240:247], v0
  s_waitcnt lgkmcnt(3)
  s_barrier
  ds_read_b128 v[100:103], v2 offset:1024
  v_smfmac_f32_16x16x64_bf16 v[24:27], v[116:119], a[0:7], v0
  ds_read_b128 v[120:123], v1 offset:1024
  v_smfmac_f32_16x16x64_bf16 v[20:23], v[84:87], v[248:255], v0
  ds_read_b128 v[80:83], v4 offset:15360
  v_smfmac_f32_16x16x64_bf16 v[24:27], v[84:87], a[8:15], v0
  s_waitcnt lgkmcnt(2)
  ds_read_b128 v[92:95], v2 offset:2048
  v_smfmac_f32_16x16x64_bf16 v[20:23], v[100:103], v[144:151], v0
  ds_read_b128 v[96:99], v1 offset:2048
  v_smfmac_f32_16x16x64_bf16 v[24:27], v[100:103], v[68:75], v0
  s_waitcnt vmcnt(0) lgkmcnt(3)
  ds_read_b128 v[116:119], v2 offset:3072
  ds_read_b128 v[124:127], v1 offset:3072
  v_smfmac_f32_16x16x64_bf16 v[20:23], v[120:123], v[152:159], v0
  s_waitcnt lgkmcnt(4)
  ds_read_b128 v[104:107], v2 offset:5120
  v_smfmac_f32_16x16x64_bf16 v[24:27], v[120:123], v[76:83], v0
  s_waitcnt lgkmcnt(4)
  ds_read_b128 v[108:111], v1 offset:5120
  ds_read_b128 v[112:115], v2 offset:6144
  ds_read_b128 v[84:87], v1 offset:6144
  ds_read_b128 v[88:91], v2 offset:7168
  ds_read_b128 v[100:103], v1 offset:7168
  ds_read_b128 v[68:71], v4 offset:16384
  ds_read_b128 v[72:75], v4 offset:17408
  ds_read_b128 v[76:79], v4 offset:18432
  ds_read_b128 v[80:83], v4 offset:19456
  v_smfmac_f32_16x16x64_bf16 v[20:23], v[92:95], v[176:183], v0
  s_waitcnt lgkmcnt(12)
  v_smfmac_f32_16x16x64_bf16 v[20:23], v[96:99], v[184:191], v0
  s_waitcnt lgkmcnt(2)
  v_smfmac_f32_16x16x64_bf16 v[20:23], v[116:119], v[68:75], v0
  s_waitcnt lgkmcnt(0)
  ds_read_b128 v[68:71], v4 offset:20480
  v_smfmac_f32_16x16x64_bf16 v[20:23], v[124:127], v[76:83], v0
  ds_read_b128 v[72:75], v4 offset:21504
  v_smfmac_f32_16x16x64_bf16 v[20:23], v[104:107], a[32:39], v0
  ds_read_b128 v[76:79], v4 offset:22528
  v_smfmac_f32_16x16x64_bf16 v[20:23], v[108:111], a[40:47], v0
  ds_read_b128 v[80:83], v4 offset:23552
  v_smfmac_f32_16x16x64_bf16 v[20:23], v[112:115], a[80:87], v0
  v_smfmac_f32_16x16x64_bf16 v[20:23], v[84:87], a[88:95], v0
  v_smfmac_f32_16x16x64_bf16 v[20:23], v[88:91], a[128:135], v0
  v_smfmac_f32_16x16x64_bf16 v[20:23], v[100:103], a[136:143], v0
  s_waitcnt lgkmcnt(2)
  v_smfmac_f32_16x16x64_bf16 v[24:27], v[92:95], v[68:75], v0
  s_waitcnt lgkmcnt(0)
  v_smfmac_f32_16x16x64_bf16 v[24:27], v[96:99], v[76:83], v0
  v_smfmac_f32_16x16x64_bf16 v[24:27], v[116:119], v[208:215], v0
  v_smfmac_f32_16x16x64_bf16 v[24:27], v[124:127], v[216:223], v0
  v_smfmac_f32_16x16x64_bf16 v[24:27], v[104:107], a[48:55], v0
  v_smfmac_f32_16x16x64_bf16 v[24:27], v[108:111], a[56:63], v0
  v_smfmac_f32_16x16x64_bf16 v[24:27], v[112:115], a[96:103], v0
  v_smfmac_f32_16x16x64_bf16 v[24:27], v[84:87], a[104:111], v0
  v_smfmac_f32_16x16x64_bf16 v[24:27], v[88:91], a[144:151], v0
  v_smfmac_f32_16x16x64_bf16 v[24:27], v[100:103], a[152:159], v0
  v_cvt_pk_bf16_f32 v122, v20, v21
  v_cvt_pk_bf16_f32 v123, v22, v23
  s_nop 5
  v_cvt_pk_bf16_f32 v120, v24, v25
  v_cvt_pk_bf16_f32 v121, v26, v27
  buffer_store_dwordx4 v[120:123], v2, s[4:7], s29 offen offset:0 sc1
  s_branch M_tdone
T_w_11:
  s_mov_b32 s19, 0
  s_add_u32 s14, s14, 1
  s_and_b32 s57, s14, 1
  v_mov_b64 v[16:17], 0
  v_mov_b64 v[18:19], 0
  v_mov_b64 v[20:21], 0
  v_mov_b64 v[22:23], 0
  v_mov_b64 v[24:25], 0
  v_mov_b64 v[26:27], 0
  buffer_load_dwordx4 v[124:127], v2, s[4:7], s24 offen offset:1024 sc1
  buffer_load_dwordx4 v[116:119], v2, s[4:7], s25 offen offset:1024 sc1
  buffer_load_dwordx4 v[124:127], v2, s[4:7], s24 offen offset:1024 sc1
  buffer_load_dwordx4 v[116:119], v2, s[4:7], s25 offen offset:1024 sc1
  s_branch T_loop_33
.p2align 6
T_retry_34:
  s_mov_b64 exec, vcc
  buffer_load_dwordx4 v[124:127], v2, s[4:7], s24 offen offset:1024 sc1
  buffer_load_dwordx4 v[116:119], v2, s[4:7], s25 offen offset:1024 sc1
  s_mov_b64 exec, -1
  s_add_u32 s19, s19, 1
  s_cmp_gt_u32 s19, 32768
  s_cbranch_scc1 M_exit
  s_nop 0
  v_mov_b64 v[16:17], 0
  v_mov_b64 v[18:19], 0
T_loop_33:
  s_waitcnt vmcnt(3) lgkmcnt(0)
  v_max3_u32 v123, v124, v125, v126
  v_max_u32 v123, v123, v127
  v_mov_b32_dpp v120, v124 row_ror:8 row_mask:0xf bank_mask:0xf
  v_mov_b32_dpp v121, v125 row_ror:8 row_mask:0xf bank_mask:0xf
  s_waitcnt vmcnt(2)
  v_max3_u32 v123, v123, v116, v117
  v_max3_u32 v123, v123, v118, v119
  v_cmp_eq_u32 vcc, -1, v123
  v_smfmac_f32_16x16x64_bf16 v[16:19], v[124:127], v[68:75], v0
  s_cbranch_vccnz T_retry_34
  ds_write_b128 v2, v[124:127] offset:1024
  v_mov_b32_dpp v122, v126 row_ror:8 row_mask:0xf bank_mask:0xf
  v_smfmac_f32_16x16x64_bf16 v[20:23], v[124:127], v[76:83], v0
  s_and_b32 s57, s14, 1
  v_mov_b32_dpp v123, v127 row_ror:8 row_mask:0xf bank_mask:0xf
  v_smfmac_f32_16x16x64_bf16 v[24:27], v[124:127], v[84:91], v0
  s_and_b32 s36, s14, 3
  ds_write_b128 v2, v[116:119] offset:5120
  v_smfmac_f32_16x16x64_bf16 v[16:19], v[120:123], v[92:99], v0
  s_lshl_b32 s36, s36, 13
  v_mov_b32_dpp v84, v116 row_ror:8 row_mask:0xf bank_mask:0xf
  v_smfmac_f32_16x16x64_bf16 v[20:23], v[120:123], v[100:107], v0
  s_add_u32 s26, s36, s23
  ds_read_b128 v[68:71], v4 offset:12288
  v_mov_b32_dpp v85, v117 row_ror:8 row_mask:0xf bank_mask:0xf
  v_smfmac_f32_16x16x64_bf16 v[24:27], v[120:123], v[108:115], v0
  s_add_u32 s36, s36, 8192
  ds_read_b128 v[72:75], v4 offset:13312
  v_mov_b32_dpp v86, v118 row_ror:8 row_mask:0xf bank_mask:0xf
  v_smfmac_f32_16x16x64_bf16 v[16:19], v[116:119], v[224:231], v0
  s_and_b32 s36, s36, 0x7fff
  ds_read_b128 v[76:79], v4 offset:14336
  v_mov_b32_dpp v87, v119 row_ror:8 row_mask:0xf bank_mask:0xf
  v_smfmac_f32_16x16x64_bf16 v[20:23], v[116:119], v[240:247], v0
  s_waitcnt lgkmcnt(3)
  s_barrier
  ds_read_b128 v[100:103], v2 offset:0
  v_smfmac_f32_16x16x64_bf16 v[24:27], v[116:119], a[0:7], v0
  s_mov_b32 m0, s31
  ds_read_b128 v[120:123], v1 offset:0
  v_smfmac_f32_16x16x64_bf16 v[16:19], v[84:87], v[232:239], v0
  buffer_load_dwordx4 v9, s[4:7], s27 offen sc1 lds
  v_smfmac_f32_16x16x64_bf16 v[20:23], v[84:87], v[248:255], v0
  ds_read_b128 v[80:83], v4 offset:15360
  s_mov_b32 m0, s32
  v_smfmac_f32_16x16x64_bf16 v[24:27], v[84:87], a[8:15], v0
  s_waitcnt lgkmcnt(2)
  v_smfmac_f32_16x16x64_bf16 v[16:19], v[100:103], v[128:135], v0
  ds_read_b128 v[92:95], v2 offset:3072
  v_smfmac_f32_16x16x64_bf16 v[20:23], v[100:103], v[144:151], v0
  ds_read_b128 v[96:99], v1 offset:3072
  buffer_load_dwordx4 v9, s[4:7], s27 offen offset:128 sc1 lds
  v_smfmac_f32_16x16x64_bf16 v[24:27], v[100:103], v[68:75], v0
  s_waitcnt vmcnt(2) lgkmcnt(3)
  ds_read_b128 v[116:119], v2 offset:2048
  s_mov_b32 m0, s33
  v_smfmac_f32_16x16x64_bf16 v[16:19], v[120:123], v[136:143], v0
  ds_read_b128 v[124:127], v1 offset:2048
  v_smfmac_f32_16x16x64_bf16 v[20:23], v[120:123], v[152:159], v0
  s_waitcnt lgkmcnt(4)
  ds_read_b128 v[104:107], v2 offset:4096
  v_smfmac_f32_16x16x64_bf16 v[24:27], v[120:123], v[76:83], v0
  s_waitcnt lgkmcnt(4)
  ds_read_b128 v[108:111], v1 offset:4096
  buffer_load_dwordx4 v10, s[4:7], s28 offen sc1 lds
  v_smfmac_f32_16x16x64_bf16 v[16:19], v[92:95], v[160:167], v0
  s_waitcnt lgkmcnt(4)
  ds_read_b128 v[112:115], v2 offset:7168
  s_mov_b32 m0, s34
  v_smfmac_f32_16x16x64_bf16 v[16:19], v[96:99], v[168:175], v0
  s_waitcnt lgkmcnt(4)
  ds_read_b128 v[84:87], v1 offset:7168
  v_smfmac_f32_16x16x64_bf16 v[16:19], v[116:119], v[192:199], v0
  s_waitcnt lgkmcnt(4)
  ds_read_b128 v[88:91], v2 offset:6144
  v_smfmac_f32_16x16x64_bf16 v[16:19], v[124:127], v[200:207], v0
  s_waitcnt lgkmcnt(4)
  ds_read_b128 v[100:103], v1 offset:6144
  buffer_load_dwordx4 v10, s[4:7], s28 offen offset:256 sc1 lds
  v_smfmac_f32_16x16x64_bf16 v[16:19], v[104:107], a[16:23], v0
  s_waitcnt lgkmcnt(4)
  ds_read_b128 v[68:71], v4 offset:16384
  v_smfmac_f32_16x16x64_bf16 v[16:19], v[108:111], a[24:31], v0
  s_waitcnt lgkmcnt(4)
  ds_read_b128 v[72:75], v4 offset:17408
  v_smfmac_f32_16x16x64_bf16 v[16:19], v[112:115], a[64:71], v0
  s_waitcnt lgkmcnt(4)
  ds_read_b128 v[76:79], v4 offset:18432
  v_smfmac_f32_16x16x64_bf16 v[16:19], v[84:87], a[72:79], v0
  s_waitcnt lgkmcnt(4)
  ds_read_b128 v[80:83], v4 offset:19456
  v_smfmac_f32_16x16x64_bf16 v[16:19], v[88:91], a[112:119], v0
  s_waitcnt lgkmcnt(4)
  v_smfmac_f32_16x16x64_bf16 v[16:19], v[100:103], a[120:127], v0
  s_add_u32 s24, s36, 145752064
  s_add_u32 s25, s36, 145756160
  v_smfmac_f32_16x16x64_bf16 v[20:23], v[92:95], v[176:183], v0
  s_add_u32 s35, s36, s23
  v_smfmac_f32_16x16x64_bf16 v[20:23], v[96:99], v[184:191], v0
  s_waitcnt lgkmcnt(2)
  v_smfmac_f32_16x16x64_bf16 v[20:23], v[116:119], v[68:75], v0
  s_waitcnt lgkmcnt(0)
  ds_read_b128 v[68:71], v4 offset:20480
  v_mul_f32 v16, s18, v16
  v_smfmac_f32_16x16x64_bf16 v[20:23], v[124:127], v[76:83], v0
  ds_read_b128 v[72:75], v4 offset:21504
  v_mul_f32 v17, s18, v17
  v_smfmac_f32_16x16x64_bf16 v[20:23], v[104:107], a[32:39], v0
  ds_read_b128 v[76:79], v4 offset:22528
  v_mul_f32 v18, s18, v18
  v_smfmac_f32_16x16x64_bf16 v[20:23], v[108:111], a[40:47], v0
  ds_read_b128 v[80:83], v4 offset:23552
  v_mul_f32 v19, s18, v19
  v_smfmac_f32_16x16x64_bf16 v[20:23], v[112:115], a[80:87], v0
  v_cvt_pk_bf16_f32 v120, v16, v17
  v_smfmac_f32_16x16x64_bf16 v[20:23], v[84:87], a[88:95], v0
  v_cvt_pk_bf16_f32 v121, v18, v19
  v_smfmac_f32_16x16x64_bf16 v[20:23], v[88:91], a[128:135], v0
  ds_write_b64 v5, v[120:121] offset:24576
  v_smfmac_f32_16x16x64_bf16 v[20:23], v[100:103], a[136:143], v0
  s_waitcnt lgkmcnt(3)
  v_smfmac_f32_16x16x64_bf16 v[24:27], v[92:95], v[68:75], v0
  s_waitcnt lgkmcnt(1)
  v_mov_b64 v[92:93], 0
  v_smfmac_f32_16x16x64_bf16 v[24:27], v[96:99], v[76:83], v0
  s_nop 1
  v_cvt_pk_bf16_f32 v122, v20, v21
  v_cvt_pk_bf16_f32 v123, v22, v23
  v_smfmac_f32_16x16x64_bf16 v[24:27], v[116:119], v[208:215], v0
  ds_write_b64 v5, v[122:123] offset:26880
  v_mov_b64 v[94:95], 0
  v_smfmac_f32_16x16x64_bf16 v[24:27], v[124:127], v[216:223], v0
  s_waitcnt lgkmcnt(1)
  s_barrier
  ds_read_b64_tr_b16 v[68:69], v6 offset:24576
  v_smfmac_f32_16x16x64_bf16 v[24:27], v[104:107], a[48:55], v0
  s_add_u32 s27, s27, 8192
  ds_read_b64_tr_b16 v[70:71], v6 offset:24640
  ds_read_b64_tr_b16 v[72:73], v6 offset:24832
  v_smfmac_f32_16x16x64_bf16 v[24:27], v[108:111], a[56:63], v0
  s_add_u32 s28, s28, 8192
  ds_read_b64_tr_b16 v[74:75], v6 offset:24896
  ds_read_b64_tr_b16 v[76:77], v6 offset:25088
  v_smfmac_f32_16x16x64_bf16 v[24:27], v[112:115], a[96:103], v0
  s_nop 0
  ds_read_b64_tr_b16 v[78:79], v6 offset:25152
  ds_read_b64_tr_b16 v[80:81], v6 offset:25344
  v_smfmac_f32_16x16x64_bf16 v[24:27], v[84:87], a[104:111], v0
  ds_read_b64_tr_b16 v[82:83], v6 offset:25408
  v_mov_b64 v[96:97], 0
  v_smfmac_f32_16x16x64_bf16 v[24:27], v[88:91], a[144:151], v0
  s_waitcnt lgkmcnt(8)
  s_barrier
  ds_read_b64_tr_b16 v[116:117], v6 offset:26880
  v_smfmac_f32_16x16x64_bf16 v[24:27], v[100:103], a[152:159], v0
  s_waitcnt lgkmcnt(7)
  ds_read_b64_tr_b16 v[118:119], v6 offset:26944
  v_mfma_f32_16x16x32_bf16 v[16:19], v[36:39], v[68:71], 0
  s_waitcnt lgkmcnt(6)
  ds_read_b64_tr_b16 v[124:125], v6 offset:27136
  ds_read_b64_tr_b16 v[126:127], v6 offset:27200
  v_mfma_f32_16x16x32_bf16 v[16:19], v[40:43], v[72:75], v[16:19]
  s_waitcnt lgkmcnt(6)
  ds_read_b64_tr_b16 v[104:105], v6 offset:27392
  ds_read_b64_tr_b16 v[106:107], v6 offset:27456
  v_mfma_f32_16x16x32_bf16 v[16:19], v[44:47], v[76:79], v[16:19]
  s_waitcnt lgkmcnt(6)
  ds_read_b64_tr_b16 v[108:109], v6 offset:27648
  ds_read_b64_tr_b16 v[110:111], v6 offset:27712
  v_mfma_f32_16x16x32_bf16 v[16:19], v[48:51], v[80:83], v[16:19]
  s_waitcnt lgkmcnt(6)
  v_cvt_pk_bf16_f32 v120, v24, v25
  v_cvt_pk_bf16_f32 v121, v26, v27
  v_mfma_f32_16x16x32_bf16 v[112:115], v[116:119], v[68:71], 0
  s_waitcnt lgkmcnt(4)
  v_mov_b64 v[98:99], 0
  v_mfma_f32_16x16x32_bf16 v[112:115], v[124:127], v[72:75], v[112:115]
  s_waitcnt lgkmcnt(2)
  buffer_store_dwordx4 v[120:123], v2, s[4:7], s29 offen offset:1024 sc1
  v_mov_b64 v[36:37], 0
  v_exp_f32 v100, v16
  v_mfma_f32_16x16x32_bf16 v[112:115], v[104:107], v[76:79], v[112:115]
  s_waitcnt lgkmcnt(0)
  v_exp_f32 v101, v17
  v_mfma_f32_16x16x32_bf16 v[112:115], v[108:111], v[80:83], v[112:115]
  v_exp_f32 v102, v18
  v_mfma_f32_16x16x32_bf16 v[20:23], v[52:55], v[68:71], 0
  v_exp_f32 v103, v19
  v_mfma_f32_16x16x32_bf16 v[20:23], v[56:59], v[72:75], v[20:23]
  v_cvt_pk_bf16_f32 v44, v100, v101
  v_cvt_pk_bf16_f32 v45, v102, v103
  v_mfma_f32_16x16x32_bf16 v[20:23], v[60:63], v[76:79], v[20:23]
  s_add_u32 s29, s29, 131072
  v_exp_f32 v100, v112
  v_mfma_f32_16x16x32_bf16 v[20:23], v[64:67], v[80:83], v[20:23]
  v_exp_f32 v101, v113
  v_exp_f32 v102, v114
  v_exp_f32 v103, v115
  v_cvt_pk_bf16_f32 v84, v100, v101
  v_cvt_pk_bf16_f32 v85, v102, v103
  v_cndmask_b32 v48, v84, 0, s[16:17]
  v_cndmask_b32 v49, v85, 0, s[16:17]
  v_cndmask_b32 v50, 0, v84, s[16:17]
  v_cndmask_b32 v51, 0, v85, s[16:17]
  v_exp_f32 v100, v20
  v_mfma_f32_16x16x16_bf16 v[88:91], v[12:13], v[48:49], 0
  v_exp_f32 v101, v21
  v_mfma_f32_16x16x16_bf16 v[24:27], v[120:121], v[48:49], 0
  v_exp_f32 v102, v22
  v_mfma_f32_16x16x16_bf16 v[116:119], v[120:121], v[50:51], 0
  v_exp_f32 v103, v23
  v_cvt_pk_bf16_f32 v46, v100, v101
  v_cvt_pk_bf16_f32 v47, v102, v103
  v_mov_b64 v[38:39], 0
  s_nop 0
  v_mfma_f32_16x16x32_bf16 v[88:91], v[12:15], v[44:47], v[88:91]
  v_mov_b64 v[40:41], 0
  v_mov_b64 v[42:43], 0
  v_mfma_f32_16x16x32_bf16 v[24:27], v[28:31], v[44:47], v[24:27]
  ds_read_b128 v[52:55], v4 offset:24576
  ds_read_b128 v[56:59], v4 offset:25600
  v_mfma_f32_16x16x32_bf16 v[116:119], v[32:35], v[44:47], v[116:119]
  s_nop 1
T_back_41:
  v_rcp_f32 v89, v88
  v_subrev_u32 v100, s54, v88
  v_cmp_le_u32 vcc, s96, v100
  v_mul_f32 v24, v89, v24
  v_mul_f32 v25, v89, v25
  v_cvt_pk_bf16_f32 v124, v24, v25
  v_pk_mul_f32 v[26:27], v[26:27], v[88:89] op_sel:[0,1] op_sel_hi:[1,1]
  v_pk_mul_f32 v[116:117], v[116:117], v[88:89] op_sel:[0,1] op_sel_hi:[1,1]
  v_pk_mul_f32 v[118:119], v[118:119], v[88:89] op_sel:[0,1] op_sel_hi:[1,1]
  v_cvt_pk_bf16_f32 v125, v26, v27
  v_cvt_pk_bf16_f32 v126, v116, v117
  v_cvt_pk_bf16_f32 v127, v118, v119
  ds_write_b128 v11, v[124:127] offset:29696
  s_cbranch_vccnz T_slow_40
  v_smfmac_f32_16x16x64_bf16 v[92:95], v[124:127], a[160:167], v0
  s_mov_b32 s96, s55
  v_smfmac_f32_16x16x64_bf16 v[96:99], v[124:127], a[168:175], v0
  v_smfmac_f32_16x16x64_bf16 v[36:39], v[124:127], a[176:183], v0
  s_waitcnt lgkmcnt(0)
  s_barrier
  ds_read_b128 v[104:107], v11 offset:29184
  ds_read_b128 v[108:111], v11 offset:30720
  ds_read_b128 v[68:71], v11 offset:30208
  v_smfmac_f32_16x16x64_bf16 v[40:43], v[124:127], a[184:191], v0
  s_waitcnt lgkmcnt(2)
  v_smfmac_f32_16x16x64_bf16 v[92:95], v[104:107], a[192:199], v0
  s_waitcnt lgkmcnt(1)
  ds_read_b128 v[76:79], v4 offset:28672
  v_smfmac_f32_16x16x64_bf16 v[92:95], v[108:111], a[224:231], v0
  s_waitcnt lgkmcnt(1)
  ds_read_b128 v[80:83], v4 offset:29696
  v_smfmac_f32_16x16x64_bf16 v[92:95], v[68:71], a[240:247], v0
  ds_read_b128 v[60:63], v4 offset:26624
  v_smfmac_f32_16x16x64_bf16 v[96:99], v[104:107], a[200:207], v0
  ds_read_b128 v[64:67], v4 offset:27648
  v_smfmac_f32_16x16x64_bf16 v[96:99], v[108:111], a[232:239], v0
  ds_read_b128 v[28:31], v4 offset:30720
  s_nop 0
  v_cvt_pk_bf16_f32 v16, v92, v93
  v_cvt_pk_bf16_f32 v17, v94, v95
  v_bfi_b32 v16, 1, s57, v16
  v_smfmac_f32_16x16x64_bf16 v[96:99], v[68:71], a[248:255], v0
  buffer_store_dwordx2 v[16:17], v7, s[4:7], s20 offen offset:0
  v_smfmac_f32_16x16x64_bf16 v[36:39], v[104:107], a[208:215], v0
  ds_read_b128 v[32:35], v4 offset:31744
  v_smfmac_f32_16x16x64_bf16 v[36:39], v[108:111], v[52:59], v0
  s_waitcnt lgkmcnt(4)
  s_nop 0
  v_cvt_pk_bf16_f32 v18, v96, v97
  v_cvt_pk_bf16_f32 v19, v98, v99
  v_bfi_b32 v18, 1, s57, v18
  v_smfmac_f32_16x16x64_bf16 v[36:39], v[68:71], v[76:83], v0
  buffer_store_dwordx2 v[18:19], v7, s[4:7], s20 offen offset:64
  v_smfmac_f32_16x16x64_bf16 v[40:43], v[104:107], a[216:223], v0
  s_waitcnt lgkmcnt(2)
  ds_read_b128 v[116:119], v2 offset:31232
  v_smfmac_f32_16x16x64_bf16 v[40:43], v[108:111], v[60:67], v0
  s_waitcnt lgkmcnt(1)
  s_nop 0
  v_cvt_pk_bf16_f32 v20, v36, v37
  v_cvt_pk_bf16_f32 v21, v38, v39
  v_bfi_b32 v20, 1, s57, v20
  v_smfmac_f32_16x16x64_bf16 v[40:43], v[68:71], v[28:35], v0
  buffer_store_dwordx2 v[20:21], v7, s[4:7], s21 offen offset:0
  s_nop 6
  v_cvt_pk_bf16_f32 v22, v40, v41
  v_cvt_pk_bf16_f32 v23, v42, v43
  v_bfi_b32 v22, 1, s57, v22
  buffer_store_dwordx2 v[22:23], v7, s[4:7], s21 offen offset:64
  ds_read_b128 v[68:71], v4 offset:0
  ds_read_b128 v[72:75], v4 offset:1024
  ds_read_b128 v[76:79], v4 offset:4096
  ds_read_b128 v[80:83], v4 offset:5120
  ds_read_b128 v[84:87], v4 offset:8192
  ds_read_b128 v[88:91], v4 offset:9216
  ds_read_b128 v[92:95], v4 offset:2048
  ds_read_b128 v[96:99], v4 offset:3072
  ds_read_b128 v[100:103], v4 offset:6144
  ds_read_b128 v[104:107], v4 offset:7168
  ds_read_b128 v[108:111], v4 offset:10240
  ds_read_b128 v[112:115], v4 offset:11264
  v_mov_b64 v[16:17], 0
  v_mov_b64 v[18:19], 0
  v_mov_b64 v[20:21], 0
  v_mov_b64 v[22:23], 0
  v_mov_b64 v[24:25], 0
  v_mov_b64 v[26:27], 0
  s_mov_b32 s19, 0
  v_mov_b32 v49, -1
  ds_read_b64 v[44:45], v2 offset:32256
  s_waitcnt lgkmcnt(0)
  v_readfirstlane_b32 s38, v44
  v_readfirstlane_b32 s37, v45
  s_nop 0
  s_lshl_b32 s38, s38, 1
  s_lshl1_add_u32 s37, s37, 1
  s_min_u32 s38, s38, s37
  s_cmp_ge_u32 s38, 64
  s_cselect_b32 s38, 100, s38
  s_sub_u32 s38, s38, 1
  s_max_i32 s30, s30, s38
  s_waitcnt vmcnt(0)
  buffer_load_dwordx4 v[52:55], v2, s[4:7], s22 offen offset:0 sc1
  buffer_load_dwordx4 v[56:59], v2, s[4:7], s22 offen offset:1024 sc1
  buffer_load_dwordx4 v[60:63], v2, s[4:7], s22 offen offset:2048 sc1
  buffer_load_dwordx4 v[64:67], v2, s[4:7], s22 offen offset:3072 sc1
  s_waitcnt lgkmcnt(12)
  s_waitcnt vmcnt(3)
  v_mfma_f32_16x16x32_bf16 v[120:123], v[116:119], v[52:55], 0
  v_xor_b32 v48, s57, v52
  v_bitop3_b32 v48, v48, v54, s57 bitop3:0xf6
  s_waitcnt vmcnt(2)
  v_mfma_f32_16x16x32_bf16 v[120:123], v[116:119], v[56:59], v[120:123]
  v_bitop3_b32 v48, v48, v56, s57 bitop3:0xf6
  v_bitop3_b32 v48, v48, v58, s57 bitop3:0xf6
  s_waitcnt vmcnt(1)
  v_mfma_f32_16x16x32_bf16 v[120:123], v[116:119], v[60:63], v[120:123]
  v_bitop3_b32 v48, v48, v60, s57 bitop3:0xf6
  v_bitop3_b32 v48, v48, v62, s57 bitop3:0xf6
  s_waitcnt vmcnt(0)
  v_mfma_f32_16x16x32_bf16 v[120:123], v[116:119], v[64:67], v[120:123]
  v_bitop3_b32 v48, v48, v64, s57 bitop3:0xf6
  v_bitop3_b32 v48, v48, v66, s57 bitop3:0xf6
  v_and_b32 v48, 1, v48
  v_cmp_ne_u32 vcc, 0, v48
  s_cbranch_vccnz T_p1re_43
T_p1ok_44:
  s_nop 2
  v_add_f32_dpp v120, v120, v120 row_ror:8 row_mask:0xf bank_mask:0xf
  v_add_f32_dpp v121, v121, v121 row_ror:8 row_mask:0xf bank_mask:0xf
  v_cvt_pk_bf16_f32 v48, v120, v121
  buffer_store_dword v48, v8, s[4:7], s35 offen
  buffer_store_dword v49, v8, s[4:7], s26 offen
  s_barrier
  ds_read_b128 v[28:31], v2 offset:17408
  ds_read_b128 v[32:35], v2 offset:21504
  ds_read_b128 v[36:39], v2 offset:8192
  ds_read_b128 v[40:43], v2 offset:9216
  ds_read_b128 v[44:47], v2 offset:10240
  ds_read_b128 v[48:51], v2 offset:11264
  buffer_load_dwordx4 v[124:127], v2, s[4:7], s24 offen offset:1024 sc1
  buffer_load_dwordx4 v[116:119], v2, s[4:7], s25 offen offset:1024 sc1
  ds_read_b128 v[52:55], v2 offset:12288
  ds_read_b128 v[56:59], v2 offset:13312
  ds_read_b128 v[60:63], v2 offset:14336
  ds_read_b128 v[64:67], v2 offset:15360
  buffer_load_dwordx4 v[124:127], v2, s[4:7], s24 offen offset:1024 sc1
  buffer_load_dwordx4 v[116:119], v2, s[4:7], s25 offen offset:1024 sc1
  s_add_u32 s14, s14, 1
  s_cmp_ge_i32 s14, s30
  s_cbranch_scc1 T_kvw_37
T_kvb_38:
  s_mov_b32 s19, 0
  s_cmp_lg_u32 s14, 63
  s_cbranch_scc1 T_loop_33
  s_branch T_last_39
T_p1re_43:
  s_mov_b64 exec, vcc
  buffer_load_dwordx4 v[52:55], v2, s[4:7], s22 offen offset:0 sc1
  buffer_load_dwordx4 v[56:59], v2, s[4:7], s22 offen offset:1024 sc1
  buffer_load_dwordx4 v[60:63], v2, s[4:7], s22 offen offset:2048 sc1
  buffer_load_dwordx4 v[64:67], v2, s[4:7], s22 offen offset:3072 sc1
  s_mov_b64 exec, -1
  s_add_u32 s19, s19, 1
  s_cmp_gt_u32 s19, 32768
  s_cbranch_scc1 M_exit
  s_waitcnt vmcnt(3)
  v_mfma_f32_16x16x32_bf16 v[120:123], v[116:119], v[52:55], 0
  v_xor_b32 v48, s57, v52
  v_bitop3_b32 v48, v48, v54, s57 bitop3:0xf6
  s_waitcnt vmcnt(2)
  v_mfma_f32_16x16x32_bf16 v[120:123], v[116:119], v[56:59], v[120:123]
  v_bitop3_b32 v48, v48, v56, s57 bitop3:0xf6
  v_bitop3_b32 v48, v48, v58, s57 bitop3:0xf6
  s_waitcnt vmcnt(1)
  v_mfma_f32_16x16x32_bf16 v[120:123], v[116:119], v[60:63], v[120:123]
  v_bitop3_b32 v48, v48, v60, s57 bitop3:0xf6
  v_bitop3_b32 v48, v48, v62, s57 bitop3:0xf6
  s_waitcnt vmcnt(0)
  v_mfma_f32_16x16x32_bf16 v[120:123], v[116:119], v[64:67], v[120:123]
  v_bitop3_b32 v48, v48, v64, s57 bitop3:0xf6
  v_bitop3_b32 v48, v48, v66, s57 bitop3:0xf6
  v_and_b32 v48, 1, v48
  v_cmp_ne_u32 vcc, 0, v48
  s_cbranch_vccnz T_p1re_43
  s_branch T_p1ok_44
T_kvw_37:
  s_mov_b32 s19, 0
  s_branch T_kvok_46
T_kv_45:
  s_sleep 4
  s_add_u32 s19, s19, 1
  s_cmp_gt_u32 s19, 32768
  s_cbranch_scc1 M_exit
T_kvok_46:
  s_add_u32 s39, s99, 128
  s_mov_b32 s38, 0
  s_mov_b32 s37, 0
  s_atomic_or s38, s[58:59], s99 glc
  s_atomic_or s37, s[58:59], s39 glc
  s_waitcnt lgkmcnt(0)
  s_lshl_b32 s38, s38, 1
  s_lshl1_add_u32 s37, s37, 1
  s_min_u32 s38, s38, s37
  s_cmp_ge_u32 s38, 64
  s_cselect_b32 s38, 100, s38
  s_sub_u32 s38, s38, 1
  s_max_i32 s30, s30, s38
  s_cmp_ge_i32 s14, s30
  s_cbranch_scc1 T_kv_45
  s_branch T_kvb_38
T_slow_40:
  s_nop 7
  v_max3_f32 v100, v16, v17, v18
  v_max3_f32 v100, v100, v19, v20
  v_max3_f32 v100, v100, v21, v22
  v_max3_f32 v100, v100, v23, v112
  v_max3_f32 v100, v100, v113, v114
  v_max_f32 v100, v100, v115
  v_mov_b32 v101, v100
  s_nop 1
  v_permlane32_swap_b32 v100, v101
  s_nop 1
  v_max_f32 v100, v100, v101
  v_mov_b32 v101, v100
  s_nop 1
  v_permlane16_swap_b32 v100, v101
  s_nop 1
  v_max_f32 v100, v100, v101
  v_sub_f32 v16, v16, v100
  v_sub_f32 v17, v17, v100
  v_sub_f32 v18, v18, v100
  v_sub_f32 v19, v19, v100
  v_exp_f32 v16, v16
  v_exp_f32 v17, v17
  v_exp_f32 v18, v18
  v_exp_f32 v19, v19
  v_sub_f32 v20, v20, v100
  v_sub_f32 v21, v21, v100
  v_sub_f32 v22, v22, v100
  v_sub_f32 v23, v23, v100
  v_exp_f32 v20, v20
  v_exp_f32 v21, v21
  v_exp_f32 v22, v22
  v_exp_f32 v23, v23
  v_sub_f32 v112, v112, v100
  v_sub_f32 v113, v113, v100
  v_sub_f32 v114, v114, v100
  v_sub_f32 v115, v115, v100
  v_exp_f32 v112, v112
  v_exp_f32 v113, v113
  v_exp_f32 v114, v114
  v_exp_f32 v115, v115
  s_nop 0
  v_cvt_pk_bf16_f32 v44, v16, v17
  v_cvt_pk_bf16_f32 v45, v18, v19
  v_cvt_pk_bf16_f32 v46, v20, v21
  v_cvt_pk_bf16_f32 v47, v22, v23
  v_cvt_pk_bf16_f32 v84, v112, v113
  v_cvt_pk_bf16_f32 v85, v114, v115
  v_cndmask_b32 v48, v84, 0, s[16:17]
  v_cndmask_b32 v49, v85, 0, s[16:17]
  v_cndmask_b32 v50, 0, v84, s[16:17]
  v_cndmask_b32 v51, 0, v85, s[16:17]
  s_nop 1
  v_mfma_f32_16x16x16_bf16 v[88:91], v[12:13], v[48:49], 0
  v_mfma_f32_16x16x16_bf16 v[24:27], v[120:121], v[48:49], 0
  v_mfma_f32_16x16x16_bf16 v[116:119], v[120:121], v[50:51], 0
  v_mfma_f32_16x16x32_bf16 v[88:91], v[12:15], v[44:47], v[88:91]
  v_mfma_f32_16x16x32_bf16 v[24:27], v[28:31], v[44:47], v[24:27]
  v_mfma_f32_16x16x32_bf16 v[116:119], v[32:35], v[44:47], v[116:119]
  s_nop 7
  s_nop 1
  s_mov_b32 s96, -1
  s_branch T_back_41
.p2align 6
T_retry_47:
  s_mov_b64 exec, vcc
  buffer_load_dwordx4 v[124:127], v2, s[4:7], s24 offen offset:1024 sc1
  buffer_load_dwordx4 v[116:119], v2, s[4:7], s25 offen offset:1024 sc1
  s_mov_b64 exec, -1
  s_add_u32 s19, s19, 1
  s_cmp_gt_u32 s19, 32768
  s_cbranch_scc1 M_exit
T_last_39:
  s_waitcnt vmcnt(3) lgkmcnt(0)
  v_max3_u32 v123, v124, v125, v126
  v_max_u32 v123, v123, v127
  v_mov_b32_dpp v120, v124 row_ror:8 row_mask:0xf bank_mask:0xf
  v_mov_b32_dpp v121, v125 row_ror:8 row_mask:0xf bank_mask:0xf
  s_waitcnt vmcnt(2)
  v_max3_u32 v123, v123, v116, v117
  v_max3_u32 v123, v123, v118, v119
  v_cmp_eq_u32 vcc, -1, v123
  s_cbranch_vccnz T_retry_47
  v_smfmac_f32_16x16x64_bf16 v[20:23], v[124:127], v[76:83], v0
  ds_write_b128 v2, v[124:127] offset:1024
  v_mov_b32_dpp v122, v126 row_ror:8 row_mask:0xf bank_mask:0xf
  v_mov_b32_dpp v123, v127 row_ror:8 row_mask:0xf bank_mask:0xf
  v_smfmac_f32_16x16x64_bf16 v[24:27], v[124:127], v[84:91], v0
  ds_write_b128 v2, v[116:119] offset:5120
  v_mov_b32_dpp v84, v116 row_ror:8 row_mask:0xf bank_mask:0xf
  v_smfmac_f32_16x16x64_bf16 v[20:23], v[120:123], v[100:107], v0
  ds_read_b128 v[68:71], v4 offset:12288
  v_mov_b32_dpp v85, v117 row_ror:8 row_mask:0xf bank_mask:0xf
  v_smfmac_f32_16x16x64_bf16 v[24:27], v[120:123], v[108:115], v0
  ds_read_b128 v[72:75], v4 offset:13312
  v_mov_b32_dpp v86, v118 row_ror:8 row_mask:0xf bank_mask:0xf
  ds_read_b128 v[76:79], v4 offset:14336
  v_mov_b32_dpp v87, v119 row_ror:8 row_mask:0xf bank_mask:0xf
  v_smfmac_f32_16x16x64_bf16 v[20:23], v[116:119], v[240:247], v0
  s_waitcnt lgkmcnt(3)
  s_barrier
  ds_read_b128 v[100:103], v2 offset:0
  v_smfmac_f32_16x16x64_bf16 v[24:27], v[116:119], a[0:7], v0
  ds_read_b128 v[120:123], v1 offset:0
  v_smfmac_f32_16x16x64_bf16 v[20:23], v[84:87], v[248:255], v0
  ds_read_b128 v[80:83], v4 offset:15360
  v_smfmac_f32_16x16x64_bf16 v[24:27], v[84:87], a[8:15], v0
  s_waitcnt lgkmcnt(2)
  ds_read_b128 v[92:95], v2 offset:3072
  v_smfmac_f32_16x16x64_bf16 v[20:23], v[100:103], v[144:151], v0
  ds_read_b128 v[96:99], v1 offset:3072
  v_smfmac_f32_16x16x64_bf16 v[24:27], v[100:103], v[68:75], v0
  s_waitcnt vmcnt(0) lgkmcnt(3)
  ds_read_b128 v[116:119], v2 offset:2048
  ds_read_b128 v[124:127], v1 offset:2048
  v_smfmac_f32_16x16x64_bf16 v[20:23], v[120:123], v[152:159], v0
  s_waitcnt lgkmcnt(4)
  ds_read_b128 v[104:107], v2 offset:4096
  v_smfmac_f32_16x16x64_bf16 v[24:27], v[120:123], v[76:83], v0
  s_waitcnt lgkmcnt(4)
  ds_read_b128 v[108:111], v1 offset:4096
  ds_read_b128 v[112:115], v2 offset:7168
  ds_read_b128 v[84:87], v1 offset:7168
  ds_read_b128 v[88:91], v2 offset:6144
  ds_read_b128 v[100:103], v1 offset:6144
  ds_read_b128 v[68:71], v4 offset:16384
  ds_read_b128 v[72:75], v4 offset:17408
  ds_read_b128 v[76:79], v4 offset:18432
  ds_read_b128 v[80:83], v4 offset:19456
  v_smfmac_f32_16x16x64_bf16 v[20:23], v[92:95], v[176:183], v0
  s_waitcnt lgkmcnt(12)
  v_smfmac_f32_16x16x64_bf16 v[20:23], v[96:99], v[184:191], v0
  s_waitcnt lgkmcnt(2)
  v_smfmac_f32_16x16x64_bf16 v[20:23], v[116:119], v[68:75], v0
  s_waitcnt lgkmcnt(0)
  ds_read_b128 v[68:71], v4 offset:20480
  v_smfmac_f32_16x16x64_bf16 v[20:23], v[124:127], v[76:83], v0
  ds_read_b128 v[72:75], v4 offset:21504
  v_smfmac_f32_16x16x64_bf16 v[20:23], v[104:107], a[32:39], v0
  ds_read_b128 v[76:79], v4 offset:22528
  v_smfmac_f32_16x16x64_bf16 v[20:23], v[108:111], a[40:47], v0
  ds_read_b128 v[80:83], v4 offset:23552
  v_smfmac_f32_16x16x64_bf16 v[20:23], v[112:115], a[80:87], v0
  v_smfmac_f32_16x16x64_bf16 v[20:23], v[84:87], a[88:95], v0
  v_smfmac_f32_16x16x64_bf16 v[20:23], v[88:91], a[128:135], v0
  v_smfmac_f32_16x16x64_bf16 v[20:23], v[100:103], a[136:143], v0
  s_waitcnt lgkmcnt(2)
  v_smfmac_f32_16x16x64_bf16 v[24:27], v[92:95], v[68:75], v0
  s_waitcnt lgkmcnt(0)
  v_smfmac_f32_16x16x64_bf16 v[24:27], v[96:99], v[76:83], v0
  v_smfmac_f32_16x16x64_bf16 v[24:27], v[116:119], v[208:215], v0
  v_smfmac_f32_16x16x64_bf16 v[24:27], v[124:127], v[216:223], v0
  v_smfmac_f32_16x16x64_bf16 v[24:27], v[104:107], a[48:55], v0
  v_smfmac_f32_16x16x64_bf16 v[24:27], v[108:111], a[56:63], v0
  v_smfmac_f32_16x16x64_bf16 v[24:27], v[112:115], a[96:103], v0
  v_smfmac_f32_16x16x64_bf16 v[24:27], v[84:87], a[104:111], v0
  v_smfmac_f32_16x16x64_bf16 v[24:27], v[88:91], a[144:151], v0
  v_smfmac_f32_16x16x64_bf16 v[24:27], v[100:103], a[152:159], v0
  v_cvt_pk_bf16_f32 v122, v20, v21
  v_cvt_pk_bf16_f32 v123, v22, v23
  s_nop 5
  v_cvt_pk_bf16_f32 v120, v24, v25
  v_cvt_pk_bf16_f32 v121, v26, v27
  buffer_store_dwordx4 v[120:123], v2, s[4:7], s29 offen offset:1024 sc1
  s_branch M_tdone
T_w_12:
  s_mov_b32 s19, 0
  s_add_u32 s14, s14, 1
  s_and_b32 s57, s14, 1
  v_mov_b64 v[16:17], 0
  v_mov_b64 v[18:19], 0
  v_mov_b64 v[20:21], 0
  v_mov_b64 v[22:23], 0
  v_mov_b64 v[24:25], 0
  v_mov_b64 v[26:27], 0
  buffer_load_dwordx4 v[124:127], v2, s[4:7], s24 offen offset:2048 sc1
  buffer_load_dwordx4 v[116:119], v2, s[4:7], s25 offen offset:2048 sc1
  buffer_load_dwordx4 v[124:127], v2, s[4:7], s24 offen offset:2048 sc1
  buffer_load_dwordx4 v[116:119], v2, s[4:7], s25 offen offset:2048 sc1
  s_branch T_loop_52
.p2align 6
T_retry_53:
  s_mov_b64 exec, vcc
  buffer_load_dwordx4 v[124:127], v2, s[4:7], s24 offen offset:2048 sc1
  buffer_load_dwordx4 v[116:119], v2, s[4:7], s25 offen offset:2048 sc1
  s_mov_b64 exec, -1
  s_add_u32 s19, s19, 1
  s_cmp_gt_u32 s19, 32768
  s_cbranch_scc1 M_exit
  s_nop 0
  v_mov_b64 v[16:17], 0
  v_mov_b64 v[18:19], 0
T_loop_52:
  s_waitcnt vmcnt(3) lgkmcnt(0)
  v_max3_u32 v123, v124, v125, v126
  v_max_u32 v123, v123, v127
  v_mov_b32_dpp v120, v124 row_ror:8 row_mask:0xf bank_mask:0xf
  v_mov_b32_dpp v121, v125 row_ror:8 row_mask:0xf bank_mask:0xf
  s_waitcnt vmcnt(2)
  v_max3_u32 v123, v123, v116, v117
  v_max3_u32 v123, v123, v118, v119
  v_cmp_eq_u32 vcc, -1, v123
  v_smfmac_f32_16x16x64_bf16 v[16:19], v[124:127], v[68:75], v0
  s_cbranch_vccnz T_retry_53
  ds_write_b128 v2, v[124:127] offset:2048
  v_mov_b32_dpp v122, v126 row_ror:8 row_mask:0xf bank_mask:0xf
  v_smfmac_f32_16x16x64_bf16 v[20:23], v[124:127], v[76:83], v0
  s_and_b32 s57, s14, 1
  v_mov_b32_dpp v123, v127 row_ror:8 row_mask:0xf bank_mask:0xf
  v_smfmac_f32_16x16x64_bf16 v[24:27], v[124:127], v[84:91], v0
  s_and_b32 s36, s14, 3
  ds_write_b128 v2, v[116:119] offset:6144
  v_smfmac_f32_16x16x64_bf16 v[16:19], v[120:123], v[92:99], v0
  s_lshl_b32 s36, s36, 13
  v_mov_b32_dpp v84, v116 row_ror:8 row_mask:0xf bank_mask:0xf
  v_smfmac_f32_16x16x64_bf16 v[20:23], v[120:123], v[100:107], v0
  s_add_u32 s26, s36, s23
  ds_read_b128 v[68:71], v4 offset:12288
  v_mov_b32_dpp v85, v117 row_ror:8 row_mask:0xf bank_mask:0xf
  v_smfmac_f32_16x16x64_bf16 v[24:27], v[120:123], v[108:115], v0
  s_add_u32 s36, s36, 8192
  ds_read_b128 v[72:75], v4 offset:13312
  v_mov_b32_dpp v86, v118 row_ror:8 row_mask:0xf bank_mask:0xf
  v_smfmac_f32_16x16x64_bf16 v[16:19], v[116:119], v[224:231], v0
  s_and_b32 s36, s36, 0x7fff
  ds_read_b128 v[76:79], v4 offset:14336
  v_mov_b32_dpp v87, v119 row_ror:8 row_mask:0xf bank_mask:0xf
  v_smfmac_f32_16x16x64_bf16 v[20:23], v[116:119], v[240:247], v0
  s_waitcnt lgkmcnt(3)
  s_barrier
  ds_read_b128 v[100:103], v2 offset:3072
  v_smfmac_f32_16x16x64_bf16 v[24:27], v[116:119], a[0:7], v0
  s_mov_b32 m0, s31
  ds_read_b128 v[120:123], v1 offset:3072
  v_smfmac_f32_16x16x64_bf16 v[16:19], v[84:87], v[232:239], v0
  v_smfmac_f32_16x16x64_bf16 v[20:23], v[84:87], v[248:255], v0
  ds_read_b128 v[80:83], v4 offset:15360
  buffer_load_dwordx4 v9, s[4:7], s27 offen sc1 lds
  v_smfmac_f32_16x16x64_bf16 v[24:27], v[84:87], a[8:15], v0
  s_waitcnt lgkmcnt(2)
  s_mov_b32 m0, s32
  v_smfmac_f32_16x16x64_bf16 v[16:19], v[100:103], v[128:135], v0
  ds_read_b128 v[92:95], v2 offset:0
  v_smfmac_f32_16x16x64_bf16 v[20:23], v[100:103], v[144:151], v0
  ds_read_b128 v[96:99], v1 offset:0
  v_smfmac_f32_16x16x64_bf16 v[24:27], v[100:103], v[68:75], v0
  s_waitcnt vmcnt(1) lgkmcnt(3)
  ds_read_b128 v[116:119], v2 offset:1024
  buffer_load_dwordx4 v9, s[4:7], s27 offen offset:128 sc1 lds
  v_smfmac_f32_16x16x64_bf16 v[16:19], v[120:123], v[136:143], v0
  ds_read_b128 v[124:127], v1 offset:1024
  s_mov_b32 m0, s33
  v_smfmac_f32_16x16x64_bf16 v[20:23], v[120:123], v[152:159], v0
  s_waitcnt lgkmcnt(4)
  ds_read_b128 v[104:107], v2 offset:7168
  v_smfmac_f32_16x16x64_bf16 v[24:27], v[120:123], v[76:83], v0
  s_waitcnt lgkmcnt(4)
  ds_read_b128 v[108:111], v1 offset:7168
  v_smfmac_f32_16x16x64_bf16 v[16:19], v[92:95], v[160:167], v0
  s_waitcnt lgkmcnt(4)
  ds_read_b128 v[112:115], v2 offset:4096
  v_mov_b32 v122, s98
  buffer_load_dwordx4 v10, s[4:7], s28 offen sc1 lds
  v_smfmac_f32_16x16x64_bf16 v[16:19], v[96:99], v[168:175], v0
  s_waitcnt lgkmcnt(4)
  ds_read_b128 v[84:87], v1 offset:4096
  s_mov_b32 m0, s34
  v_smfmac_f32_16x16x64_bf16 v[16:19], v[116:119], v[192:199], v0
  s_waitcnt lgkmcnt(4)
  ds_read_b128 v[88:91], v2 offset:5120
  v_smfmac_f32_16x16x64_bf16 v[16:19], v[124:127], v[200:207], v0
  s_waitcnt lgkmcnt(4)
  ds_read_b128 v[100:103], v1 offset:5120
  v_smfmac_f32_16x16x64_bf16 v[16:19], v[104:107], a[16:23], v0
  s_waitcnt lgkmcnt(4)
  ds_read_b128 v[68:71], v4 offset:16384
  buffer_load_dwordx4 v10, s[4:7], s28 offen offset:256 sc1 lds
  v_smfmac_f32_16x16x64_bf16 v[16:19], v[108:111], a[24:31], v0
  s_waitcnt lgkmcnt(4)
  ds_read_b128 v[72:75], v4 offset:17408
  v_smfmac_f32_16x16x64_bf16 v[16:19], v[112:115], a[64:71], v0
  s_waitcnt lgkmcnt(4)
  ds_read_b128 v[76:79], v4 offset:18432
  v_smfmac_f32_16x16x64_bf16 v[16:19], v[84:87], a[72:79], v0
  s_waitcnt lgkmcnt(4)
  ds_read_b128 v[80:83], v4 offset:19456
  v_smfmac_f32_16x16x64_bf16 v[16:19], v[88:91], a[112:119], v0
  s_waitcnt lgkmcnt(4)
  buffer_store_dword v122, v3, s[4:7], s15 offen sc1
  v_smfmac_f32_16x16x64_bf16 v[16:19], v[100:103], a[120:127], v0
  s_add_u32 s98, s14, 1
  s_add_u32 s24, s36, 145752064
  s_add_u32 s25, s36, 145756160
  v_smfmac_f32_16x16x64_bf16 v[20:23], v[92:95], v[176:183], v0
  s_add_u32 s35, s36, s23
  v_smfmac_f32_16x16x64_bf16 v[20:23], v[96:99], v[184:191], v0
  s_waitcnt lgkmcnt(2)
  v_smfmac_f32_16x16x64_bf16 v[20:23], v[116:119], v[68:75], v0
  s_waitcnt lgkmcnt(0)
  ds_read_b128 v[68:71], v4 offset:20480
  v_mul_f32 v16, s18, v16
  v_smfmac_f32_16x16x64_bf16 v[20:23], v[124:127], v[76:83], v0
  ds_read_b128 v[72:75], v4 offset:21504
  v_mul_f32 v17, s18, v17
  v_smfmac_f32_16x16x64_bf16 v[20:23], v[104:107], a[32:39], v0
  ds_read_b128 v[76:79], v4 offset:22528
  v_mul_f32 v18, s18, v18
  v_smfmac_f32_16x16x64_bf16 v[20:23], v[108:111], a[40:47], v0
  ds_read_b128 v[80:83], v4 offset:23552
  v_mul_f32 v19, s18, v19
  v_smfmac_f32_16x16x64_bf16 v[20:23], v[112:115], a[80:87], v0
  v_cvt_pk_bf16_f32 v120, v16, v17
  v_smfmac_f32_16x16x64_bf16 v[20:23], v[84:87], a[88:95], v0
  v_cvt_pk_bf16_f32 v121, v18, v19
  v_smfmac_f32_16x16x64_bf16 v[20:23], v[88:91], a[128:135], v0
  ds_write_b64 v5, v[120:121] offset:24576
  v_smfmac_f32_16x16x64_bf16 v[20:23], v[100:103], a[136:143], v0
  s_waitcnt lgkmcnt(3)
  v_smfmac_f32_16x16x64_bf16 v[24:27], v[92:95], v[68:75], v0
  s_waitcnt lgkmcnt(1)
  v_mov_b64 v[92:93], 0
  v_smfmac_f32_16x16x64_bf16 v[24:27], v[96:99], v[76:83], v0
  s_nop 1
  v_cvt_pk_bf16_f32 v122, v20, v21
  v_cvt_pk_bf16_f32 v123, v22, v23
  v_smfmac_f32_16x16x64_bf16 v[24:27], v[116:119], v[208:215], v0
  ds_write_b64 v5, v[122:123] offset:26880
  v_mov_b64 v[94:95], 0
  v_smfmac_f32_16x16x64_bf16 v[24:27], v[124:127], v[216:223], v0
  s_waitcnt lgkmcnt(1)
  s_barrier
  ds_read_b64_tr_b16 v[68:69], v6 offset:24576
  v_smfmac_f32_16x16x64_bf16 v[24:27], v[104:107], a[48:55], v0
  s_add_u32 s27, s27, 8192
  ds_read_b64_tr_b16 v[70:71], v6 offset:24640
  ds_read_b64_tr_b16 v[72:73], v6 offset:24832
  v_smfmac_f32_16x16x64_bf16 v[24:27], v[108:111], a[56:63], v0
  s_add_u32 s28, s28, 8192
  ds_read_b64_tr_b16 v[74:75], v6 offset:24896
  ds_read_b64_tr_b16 v[76:77], v6 offset:25088
  v_smfmac_f32_16x16x64_bf16 v[24:27], v[112:115], a[96:103], v0
  s_nop 0
  ds_read_b64_tr_b16 v[78:79], v6 offset:25152
  ds_read_b64_tr_b16 v[80:81], v6 offset:25344
  v_smfmac_f32_16x16x64_bf16 v[24:27], v[84:87], a[104:111], v0
  ds_read_b64_tr_b16 v[82:83], v6 offset:25408
  v_mov_b64 v[96:97], 0
  v_smfmac_f32_16x16x64_bf16 v[24:27], v[88:91], a[144:151], v0
  s_waitcnt lgkmcnt(8)
  s_barrier
  ds_read_b64_tr_b16 v[116:117], v6 offset:26880
  v_smfmac_f32_16x16x64_bf16 v[24:27], v[100:103], a[152:159], v0
  s_waitcnt lgkmcnt(7)
  ds_read_b64_tr_b16 v[118:119], v6 offset:26944
  v_mfma_f32_16x16x32_bf16 v[16:19], v[36:39], v[68:71], 0
  s_waitcnt lgkmcnt(6)
  ds_read_b64_tr_b16 v[124:125], v6 offset:27136
  ds_read_b64_tr_b16 v[126:127], v6 offset:27200
  v_mfma_f32_16x16x32_bf16 v[16:19], v[40:43], v[72:75], v[16:19]
  s_waitcnt lgkmcnt(6)
  ds_read_b64_tr_b16 v[104:105], v6 offset:27392
  ds_read_b64_tr_b16 v[106:107], v6 offset:27456
  v_mfma_f32_16x16x32_bf16 v[16:19], v[44:47], v[76:79], v[16:19]
  s_waitcnt lgkmcnt(6)
  ds_read_b64_tr_b16 v[108:109], v6 offset:27648
  ds_read_b64_tr_b16 v[110:111], v6 offset:27712
  v_mfma_f32_16x16x32_bf16 v[16:19], v[48:51], v[80:83], v[16:19]
  s_waitcnt lgkmcnt(6)
  v_cvt_pk_bf16_f32 v120, v24, v25
  v_cvt_pk_bf16_f32 v121, v26, v27
  v_mfma_f32_16x16x32_bf16 v[112:115], v[116:119], v[68:71], 0
  s_waitcnt lgkmcnt(4)
  v_mov_b64 v[98:99], 0
  v_mfma_f32_16x16x32_bf16 v[112:115], v[124:127], v[72:75], v[112:115]
  s_waitcnt lgkmcnt(2)
  v_mov_b64 v[36:37], 0
  v_exp_f32 v100, v16
  v_mfma_f32_16x16x32_bf16 v[112:115], v[104:107], v[76:79], v[112:115]
  s_waitcnt lgkmcnt(0)
  buffer_store_dwordx4 v[120:123], v2, s[4:7], s29 offen offset:2048 sc1
  v_exp_f32 v101, v17
  v_mfma_f32_16x16x32_bf16 v[112:115], v[108:111], v[80:83], v[112:115]
  v_exp_f32 v102, v18
  v_mfma_f32_16x16x32_bf16 v[20:23], v[52:55], v[68:71], 0
  v_exp_f32 v103, v19
  v_mfma_f32_16x16x32_bf16 v[20:23], v[56:59], v[72:75], v[20:23]
  v_cvt_pk_bf16_f32 v44, v100, v101
  v_cvt_pk_bf16_f32 v45, v102, v103
  v_mfma_f32_16x16x32_bf16 v[20:23], v[60:63], v[76:79], v[20:23]
  s_add_u32 s29, s29, 131072
  v_exp_f32 v100, v112
  v_mfma_f32_16x16x32_bf16 v[20:23], v[64:67], v[80:83], v[20:23]
  v_exp_f32 v101, v113
  v_exp_f32 v102, v114
  v_exp_f32 v103, v115
  v_cvt_pk_bf16_f32 v84, v100, v101
  v_cvt_pk_bf16_f32 v85, v102, v103
  v_cndmask_b32 v48, v84, 0, s[16:17]
  v_cndmask_b32 v49, v85, 0, s[16:17]
  v_cndmask_b32 v50, 0, v84, s[16:17]
  v_cndmask_b32 v51, 0, v85, s[16:17]
  v_exp_f32 v100, v20
  v_mfma_f32_16x16x16_bf16 v[88:91], v[12:13], v[48:49], 0
  v_exp_f32 v101, v21
  v_mfma_f32_16x16x16_bf16 v[24:27], v[120:121], v[48:49], 0
  v_exp_f32 v102, v22
  v_mfma_f32_16x16x16_bf16 v[116:119], v[120:121], v[50:51], 0
  v_exp_f32 v103, v23
  v_cvt_pk_bf16_f32 v46, v100, v101
  v_cvt_pk_bf16_f32 v47, v102, v103
  v_mov_b64 v[38:39], 0
  s_nop 0
  v_mfma_f32_16x16x32_bf16 v[88:91], v[12:15], v[44:47], v[88:91]
  v_mov_b64 v[40:41], 0
  v_mov_b64 v[42:43], 0
  v_mfma_f32_16x16x32_bf16 v[24:27], v[28:31], v[44:47], v[24:27]
  ds_read_b128 v[52:55], v4 offset:24576
  ds_read_b128 v[56:59], v4 offset:25600
  v_mfma_f32_16x16x32_bf16 v[116:119], v[32:35], v[44:47], v[116:119]
  s_nop 1
T_back_60:
  v_rcp_f32 v89, v88
  v_subrev_u32 v100, s54, v88
  v_cmp_le_u32 vcc, s96, v100
  v_mul_f32 v24, v89, v24
  v_mul_f32 v25, v89, v25
  v_cvt_pk_bf16_f32 v124, v24, v25
  v_pk_mul_f32 v[26:27], v[26:27], v[88:89] op_sel:[0,1] op_sel_hi:[1,1]
  v_pk_mul_f32 v[116:117], v[116:117], v[88:89] op_sel:[0,1] op_sel_hi:[1,1]
  v_pk_mul_f32 v[118:119], v[118:119], v[88:89] op_sel:[0,1] op_sel_hi:[1,1]
  v_cvt_pk_bf16_f32 v125, v26, v27
  v_cvt_pk_bf16_f32 v126, v116, v117
  v_cvt_pk_bf16_f32 v127, v118, v119
  ds_write_b128 v11, v[124:127] offset:30208
  s_cbranch_vccnz T_slow_59
  v_smfmac_f32_16x16x64_bf16 v[92:95], v[124:127], a[160:167], v0
  s_mov_b32 s96, s55
  v_smfmac_f32_16x16x64_bf16 v[96:99], v[124:127], a[168:175], v0
  v_smfmac_f32_16x16x64_bf16 v[36:39], v[124:127], a[176:183], v0
  s_waitcnt lgkmcnt(0)
  s_barrier
  ds_read_b128 v[104:107], v11 offset:30720
  ds_read_b128 v[108:111], v11 offset:29184
  ds_read_b128 v[68:71], v11 offset:29696
  v_smfmac_f32_16x16x64_bf16 v[40:43], v[124:127], a[184:191], v0
  s_waitcnt lgkmcnt(2)
  v_smfmac_f32_16x16x64_bf16 v[92:95], v[104:107], a[192:199], v0
  s_waitcnt lgkmcnt(1)
  ds_read_b128 v[76:79], v4 offset:28672
  v_smfmac_f32_16x16x64_bf16 v[92:95], v[108:111], a[224:231], v0
  s_waitcnt lgkmcnt(1)
  ds_read_b128 v[80:83], v4 offset:29696
  v_smfmac_f32_16x16x64_bf16 v[92:95], v[68:71], a[240:247], v0
  ds_read_b128 v[60:63], v4 offset:26624
  v_smfmac_f32_16x16x64_bf16 v[96:99], v[104:107], a[200:207], v0
  ds_read_b128 v[64:67], v4 offset:27648
  v_smfmac_f32_16x16x64_bf16 v[96:99], v[108:111], a[232:239], v0
  ds_read_b128 v[28:31], v4 offset:30720
  s_nop 0
  v_cvt_pk_bf16_f32 v16, v92, v93
  v_cvt_pk_bf16_f32 v17, v94, v95
  v_bfi_b32 v16, 1, s57, v16
  v_smfmac_f32_16x16x64_bf16 v[96:99], v[68:71], a[248:255], v0
  buffer_store_dwordx2 v[16:17], v7, s[4:7], s20 offen offset:0
  v_smfmac_f32_16x16x64_bf16 v[36:39], v[104:107], a[208:215], v0
  ds_read_b128 v[32:35], v4 offset:31744
  v_smfmac_f32_16x16x64_bf16 v[36:39], v[108:111], v[52:59], v0
  s_waitcnt lgkmcnt(4)
  s_nop 0
  v_cvt_pk_bf16_f32 v18, v96, v97
  v_cvt_pk_bf16_f32 v19, v98, v99
  v_bfi_b32 v18, 1, s57, v18
  v_smfmac_f32_16x16x64_bf16 v[36:39], v[68:71], v[76:83], v0
  buffer_store_dwordx2 v[18:19], v7, s[4:7], s20 offen offset:64
  v_smfmac_f32_16x16x64_bf16 v[40:43], v[104:107], a[216:223], v0
  s_waitcnt lgkmcnt(2)
  v_smfmac_f32_16x16x64_bf16 v[40:43], v[108:111], v[60:67], v0
  s_waitcnt lgkmcnt(0)
  s_nop 0
  v_cvt_pk_bf16_f32 v20, v36, v37
  v_cvt_pk_bf16_f32 v21, v38, v39
  v_bfi_b32 v20, 1, s57, v20
  v_smfmac_f32_16x16x64_bf16 v[40:43], v[68:71], v[28:35], v0
  buffer_store_dwordx2 v[20:21], v7, s[4:7], s21 offen offset:0
  s_nop 6
  v_cvt_pk_bf16_f32 v22, v40, v41
  v_cvt_pk_bf16_f32 v23, v42, v43
  v_bfi_b32 v22, 1, s57, v22
  buffer_store_dwordx2 v[22:23], v7, s[4:7], s21 offen offset:64
  ds_read_b128 v[68:71], v4 offset:0
  ds_read_b128 v[72:75], v4 offset:1024
  ds_read_b128 v[76:79], v4 offset:4096
  ds_read_b128 v[80:83], v4 offset:5120
  ds_read_b128 v[84:87], v4 offset:8192
  ds_read_b128 v[88:91], v4 offset:9216
  ds_read_b128 v[92:95], v4 offset:2048
  ds_read_b128 v[96:99], v4 offset:3072
  ds_read_b128 v[100:103], v4 offset:6144
  ds_read_b128 v[104:107], v4 offset:7168
  ds_read_b128 v[108:111], v4 offset:10240
  ds_read_b128 v[112:115], v4 offset:11264
  v_mov_b64 v[16:17], 0
  v_mov_b64 v[18:19], 0
  v_mov_b64 v[20:21], 0
  v_mov_b64 v[22:23], 0
  v_mov_b64 v[24:25], 0
  v_mov_b64 v[26:27], 0
  ds_read_b64 v[44:45], v2 offset:32256
  s_waitcnt lgkmcnt(0)
  v_readfirstlane_b32 s38, v44
  v_readfirstlane_b32 s37, v45
  s_nop 0
  s_lshl_b32 s38, s38, 1
  s_lshl1_add_u32 s37, s37, 1
  s_min_u32 s38, s38, s37
  s_cmp_ge_u32 s38, 64
  s_cselect_b32 s38, 100, s38
  s_sub_u32 s38, s38, 1
  s_max_i32 s30, s30, s38
  s_waitcnt vmcnt(4)
  s_barrier
  ds_read_b128 v[28:31], v2 offset:18432
  ds_read_b128 v[32:35], v2 offset:22528
  ds_read_b128 v[36:39], v2 offset:8192
  ds_read_b128 v[40:43], v2 offset:9216
  ds_read_b128 v[44:47], v2 offset:10240
  ds_read_b128 v[48:51], v2 offset:11264
  buffer_load_dwordx4 v[124:127], v2, s[4:7], s24 offen offset:2048 sc1
  buffer_load_dwordx4 v[116:119], v2, s[4:7], s25 offen offset:2048 sc1
  ds_read_b128 v[52:55], v2 offset:12288
  ds_read_b128 v[56:59], v2 offset:13312
  ds_read_b128 v[60:63], v2 offset:14336
  ds_read_b128 v[64:67], v2 offset:15360
  buffer_load_dwordx4 v[124:127], v2, s[4:7], s24 offen offset:2048 sc1
  buffer_load_dwordx4 v[116:119], v2, s[4:7], s25 offen offset:2048 sc1
  s_add_u32 s14, s14, 1
  s_cmp_ge_i32 s14, s30
  s_cbranch_scc1 T_kvw_56
T_kvb_57:
  s_mov_b32 s19, 0
  s_cmp_lg_u32 s14, 63
  s_cbranch_scc1 T_loop_52
  s_branch T_last_58
T_kvw_56:
  s_mov_b32 s19, 0
  s_branch T_kvok_65
T_kv_64:
  s_sleep 4
  s_add_u32 s19, s19, 1
  s_cmp_gt_u32 s19, 32768
  s_cbranch_scc1 M_exit
T_kvok_65:
  s_add_u32 s39, s99, 128
  s_mov_b32 s38, 0
  s_mov_b32 s37, 0
  s_atomic_or s38, s[58:59], s99 glc
  s_atomic_or s37, s[58:59], s39 glc
  s_waitcnt lgkmcnt(0)
  s_lshl_b32 s38, s38, 1
  s_lshl1_add_u32 s37, s37, 1
  s_min_u32 s38, s38, s37
  s_cmp_ge_u32 s38, 64
  s_cselect_b32 s38, 100, s38
  s_sub_u32 s38, s38, 1
  s_max_i32 s30, s30, s38
  s_cmp_ge_i32 s14, s30
  s_cbranch_scc1 T_kv_64
  s_branch T_kvb_57
T_slow_59:
  s_nop 7
  v_max3_f32 v100, v16, v17, v18
  v_max3_f32 v100, v100, v19, v20
  v_max3_f32 v100, v100, v21, v22
  v_max3_f32 v100, v100, v23, v112
  v_max3_f32 v100, v100, v113, v114
  v_max_f32 v100, v100, v115
  v_mov_b32 v101, v100
  s_nop 1
  v_permlane32_swap_b32 v100, v101
  s_nop 1
  v_max_f32 v100, v100, v101
  v_mov_b32 v101, v100
  s_nop 1
  v_permlane16_swap_b32 v100, v101
  s_nop 1
  v_max_f32 v100, v100, v101
  v_sub_f32 v16, v16, v100
  v_sub_f32 v17, v17, v100
  v_sub_f32 v18, v18, v100
  v_sub_f32 v19, v19, v100
  v_exp_f32 v16, v16
  v_exp_f32 v17, v17
  v_exp_f32 v18, v18
  v_exp_f32 v19, v19
  v_sub_f32 v20, v20, v100
  v_sub_f32 v21, v21, v100
  v_sub_f32 v22, v22, v100
  v_sub_f32 v23, v23, v100
  v_exp_f32 v20, v20
  v_exp_f32 v21, v21
  v_exp_f32 v22, v22
  v_exp_f32 v23, v23
  v_sub_f32 v112, v112, v100
  v_sub_f32 v113, v113, v100
  v_sub_f32 v114, v114, v100
  v_sub_f32 v115, v115, v100
  v_exp_f32 v112, v112
  v_exp_f32 v113, v113
  v_exp_f32 v114, v114
  v_exp_f32 v115, v115
  s_nop 0
  v_cvt_pk_bf16_f32 v44, v16, v17
  v_cvt_pk_bf16_f32 v45, v18, v19
  v_cvt_pk_bf16_f32 v46, v20, v21
  v_cvt_pk_bf16_f32 v47, v22, v23
  v_cvt_pk_bf16_f32 v84, v112, v113
  v_cvt_pk_bf16_f32 v85, v114, v115
  v_cndmask_b32 v48, v84, 0, s[16:17]
  v_cndmask_b32 v49, v85, 0, s[16:17]
  v_cndmask_b32 v50, 0, v84, s[16:17]
  v_cndmask_b32 v51, 0, v85, s[16:17]
  s_nop 1
  v_mfma_f32_16x16x16_bf16 v[88:91], v[12:13], v[48:49], 0
  v_mfma_f32_16x16x16_bf16 v[24:27], v[120:121], v[48:49], 0
  v_mfma_f32_16x16x16_bf16 v[116:119], v[120:121], v[50:51], 0
  v_mfma_f32_16x16x32_bf16 v[88:91], v[12:15], v[44:47], v[88:91]
  v_mfma_f32_16x16x32_bf16 v[24:27], v[28:31], v[44:47], v[24:27]
  v_mfma_f32_16x16x32_bf16 v[116:119], v[32:35], v[44:47], v[116:119]
  s_nop 7
  s_nop 1
  s_mov_b32 s96, -1
  s_branch T_back_60
.p2align 6
T_retry_66:
  s_mov_b64 exec, vcc
  buffer_load_dwordx4 v[124:127], v2, s[4:7], s24 offen offset:2048 sc1
  buffer_load_dwordx4 v[116:119], v2, s[4:7], s25 offen offset:2048 sc1
  s_mov_b64 exec, -1
  s_add_u32 s19, s19, 1
  s_cmp_gt_u32 s19, 32768
  s_cbranch_scc1 M_exit
T_last_58:
  s_waitcnt vmcnt(3) lgkmcnt(0)
  v_max3_u32 v123, v124, v125, v126
  v_max_u32 v123, v123, v127
  v_mov_b32_dpp v120, v124 row_ror:8 row_mask:0xf bank_mask:0xf
  v_mov_b32_dpp v121, v125 row_ror:8 row_mask:0xf bank_mask:0xf
  s_waitcnt vmcnt(2)
  v_max3_u32 v123, v123, v116, v117
  v_max3_u32 v123, v123, v118, v119
  v_cmp_eq_u32 vcc, -1, v123
  s_cbranch_vccnz T_retry_66
  v_smfmac_f32_16x16x64_bf16 v[20:23], v[124:127], v[76:83], v0
  ds_write_b128 v2, v[124:127] offset:2048
  v_mov_b32_dpp v122, v126 row_ror:8 row_mask:0xf bank_mask:0xf
  v_mov_b32_dpp v123, v127 row_ror:8 row_mask:0xf bank_mask:0xf
  v_smfmac_f32_16x16x64_bf16 v[24:27], v[124:127], v[84:91], v0
  ds_write_b128 v2, v[116:119] offset:6144
  v_mov_b32_dpp v84, v116 row_ror:8 row_mask:0xf bank_mask:0xf
  v_smfmac_f32_16x16x64_bf16 v[20:23], v[120:123], v[100:107], v0
  ds_read_b128 v[68:71], v4 offset:12288
  v_mov_b32_dpp v85, v117 row_ror:8 row_mask:0xf bank_mask:0xf
  v_smfmac_f32_16x16x64_bf16 v[24:27], v[120:123], v[108:115], v0
  ds_read_b128 v[72:75], v4 offset:13312
  v_mov_b32_dpp v86, v118 row_ror:8 row_mask:0xf bank_mask:0xf
  ds_read_b128 v[76:79], v4 offset:14336
  v_mov_b32_dpp v87, v119 row_ror:8 row_mask:0xf bank_mask:0xf
  v_smfmac_f32_16x16x64_bf16 v[20:23], v[116:119], v[240:247], v0
  s_waitcnt lgkmcnt(3)
  s_barrier
  ds_read_b128 v[100:103], v2 offset:3072
  v_smfmac_f32_16x16x64_bf16 v[24:27], v[116:119], a[0:7], v0
  ds_read_b128 v[120:123], v1 offset:3072
  v_smfmac_f32_16x16x64_bf16 v[20:23], v[84:87], v[248:255], v0
  ds_read_b128 v[80:83], v4 offset:15360
  v_smfmac_f32_16x16x64_bf16 v[24:27], v[84:87], a[8:15], v0
  s_waitcnt lgkmcnt(2)
  ds_read_b128 v[92:95], v2 offset:0
  v_smfmac_f32_16x16x64_bf16 v[20:23], v[100:103], v[144:151], v0
  ds_read_b128 v[96:99], v1 offset:0
  v_smfmac_f32_16x16x64_bf16 v[24:27], v[100:103], v[68:75], v0
  s_waitcnt vmcnt(0) lgkmcnt(3)
  ds_read_b128 v[116:119], v2 offset:1024
  ds_read_b128 v[124:127], v1 offset:1024
  v_smfmac_f32_16x16x64_bf16 v[20:23], v[120:123], v[152:159], v0
  s_waitcnt lgkmcnt(4)
  ds_read_b128 v[104:107], v2 offset:7168
  v_smfmac_f32_16x16x64_bf16 v[24:27], v[120:123], v[76:83], v0
  s_waitcnt lgkmcnt(4)
  ds_read_b128 v[108:111], v1 offset:7168
  ds_read_b128 v[112:115], v2 offset:4096
  ds_read_b128 v[84:87], v1 offset:4096
  ds_read_b128 v[88:91], v2 offset:5120
  ds_read_b128 v[100:103], v1 offset:5120
  ds_read_b128 v[68:71], v4 offset:16384
  ds_read_b128 v[72:75], v4 offset:17408
  ds_read_b128 v[76:79], v4 offset:18432
  ds_read_b128 v[80:83], v4 offset:19456
  v_smfmac_f32_16x16x64_bf16 v[20:23], v[92:95], v[176:183], v0
  s_waitcnt lgkmcnt(12)
  v_smfmac_f32_16x16x64_bf16 v[20:23], v[96:99], v[184:191], v0
  s_waitcnt lgkmcnt(2)
  v_smfmac_f32_16x16x64_bf16 v[20:23], v[116:119], v[68:75], v0
  s_waitcnt lgkmcnt(0)
  ds_read_b128 v[68:71], v4 offset:20480
  v_smfmac_f32_16x16x64_bf16 v[20:23], v[124:127], v[76:83], v0
  ds_read_b128 v[72:75], v4 offset:21504
  v_smfmac_f32_16x16x64_bf16 v[20:23], v[104:107], a[32:39], v0
  ds_read_b128 v[76:79], v4 offset:22528
  v_smfmac_f32_16x16x64_bf16 v[20:23], v[108:111], a[40:47], v0
  ds_read_b128 v[80:83], v4 offset:23552
  v_smfmac_f32_16x16x64_bf16 v[20:23], v[112:115], a[80:87], v0
  v_smfmac_f32_16x16x64_bf16 v[20:23], v[84:87], a[88:95], v0
  v_smfmac_f32_16x16x64_bf16 v[20:23], v[88:91], a[128:135], v0
  v_smfmac_f32_16x16x64_bf16 v[20:23], v[100:103], a[136:143], v0
  s_waitcnt lgkmcnt(2)
  v_smfmac_f32_16x16x64_bf16 v[24:27], v[92:95], v[68:75], v0
  s_waitcnt lgkmcnt(0)
  v_smfmac_f32_16x16x64_bf16 v[24:27], v[96:99], v[76:83], v0
  v_smfmac_f32_16x16x64_bf16 v[24:27], v[116:119], v[208:215], v0
  v_smfmac_f32_16x16x64_bf16 v[24:27], v[124:127], v[216:223], v0
  v_smfmac_f32_16x16x64_bf16 v[24:27], v[104:107], a[48:55], v0
  v_smfmac_f32_16x16x64_bf16 v[24:27], v[108:111], a[56:63], v0
  v_smfmac_f32_16x16x64_bf16 v[24:27], v[112:115], a[96:103], v0
  v_smfmac_f32_16x16x64_bf16 v[24:27], v[84:87], a[104:111], v0
  v_smfmac_f32_16x16x64_bf16 v[24:27], v[88:91], a[144:151], v0
  v_smfmac_f32_16x16x64_bf16 v[24:27], v[100:103], a[152:159], v0
  v_cvt_pk_bf16_f32 v122, v20, v21
  v_cvt_pk_bf16_f32 v123, v22, v23
  s_nop 5
  v_cvt_pk_bf16_f32 v120, v24, v25
  v_cvt_pk_bf16_f32 v121, v26, v27
  buffer_store_dwordx4 v[120:123], v2, s[4:7], s29 offen offset:2048 sc1
  s_branch M_tdone
T_w_13:
  s_mov_b32 s19, 0
  s_add_u32 s14, s14, 1
  s_and_b32 s57, s14, 1
  v_mov_b64 v[16:17], 0
  v_mov_b64 v[18:19], 0
  v_mov_b64 v[20:21], 0
  v_mov_b64 v[22:23], 0
  v_mov_b64 v[24:25], 0
  v_mov_b64 v[26:27], 0
  buffer_load_dwordx4 v[124:127], v2, s[4:7], s24 offen offset:3072 sc1
  buffer_load_dwordx4 v[116:119], v2, s[4:7], s25 offen offset:3072 sc1
  buffer_load_dwordx4 v[124:127], v2, s[4:7], s24 offen offset:3072 sc1
  buffer_load_dwordx4 v[116:119], v2, s[4:7], s25 offen offset:3072 sc1
  s_branch T_loop_71
.p2align 6
T_retry_72:
  s_mov_b64 exec, vcc
  buffer_load_dwordx4 v[124:127], v2, s[4:7], s24 offen offset:3072 sc1
  buffer_load_dwordx4 v[116:119], v2, s[4:7], s25 offen offset:3072 sc1
  s_mov_b64 exec, -1
  s_add_u32 s19, s19, 1
  s_cmp_gt_u32 s19, 32768
  s_cbranch_scc1 M_exit
  s_nop 0
  v_mov_b64 v[16:17], 0
  v_mov_b64 v[18:19], 0
T_loop_71:
  s_waitcnt vmcnt(3) lgkmcnt(0)
  v_max3_u32 v123, v124, v125, v126
  v_max_u32 v123, v123, v127
  v_mov_b32_dpp v120, v124 row_ror:8 row_mask:0xf bank_mask:0xf
  v_mov_b32_dpp v121, v125 row_ror:8 row_mask:0xf bank_mask:0xf
  s_waitcnt vmcnt(2)
  v_max3_u32 v123, v123, v116, v117
  v_max3_u32 v123, v123, v118, v119
  v_cmp_eq_u32 vcc, -1, v123
  v_smfmac_f32_16x16x64_bf16 v[16:19], v[124:127], v[68:75], v0
  s_cbranch_vccnz T_retry_72
  ds_write_b128 v2, v[124:127] offset:3072
  v_mov_b32_dpp v122, v126 row_ror:8 row_mask:0xf bank_mask:0xf
  v_smfmac_f32_16x16x64_bf16 v[20:23], v[124:127], v[76:83], v0
  s_and_b32 s57, s14, 1
  v_mov_b32_dpp v123, v127 row_ror:8 row_mask:0xf bank_mask:0xf
  v_smfmac_f32_16x16x64_bf16 v[24:27], v[124:127], v[84:91], v0
  s_and_b32 s36, s14, 3
  ds_write_b128 v2, v[116:119] offset:7168
  v_smfmac_f32_16x16x64_bf16 v[16:19], v[120:123], v[92:99], v0
  s_lshl_b32 s36, s36, 13
  v_mov_b32_dpp v84, v116 row_ror:8 row_mask:0xf bank_mask:0xf
  v_smfmac_f32_16x16x64_bf16 v[20:23], v[120:123], v[100:107], v0
  s_add_u32 s26, s36, s23
  ds_read_b128 v[68:71], v4 offset:12288
  v_mov_b32_dpp v85, v117 row_ror:8 row_mask:0xf bank_mask:0xf
  v_smfmac_f32_16x16x64_bf16 v[24:27], v[120:123], v[108:115], v0
  s_add_u32 s36, s36, 8192
  ds_read_b128 v[72:75], v4 offset:13312
  v_mov_b32_dpp v86, v118 row_ror:8 row_mask:0xf bank_mask:0xf
  v_smfmac_f32_16x16x64_bf16 v[16:19], v[116:119], v[224:231], v0
  s_and_b32 s36, s36, 0x7fff
  ds_read_b128 v[76:79], v4 offset:14336
  v_mov_b32_dpp v87, v119 row_ror:8 row_mask:0xf bank_mask:0xf
  v_smfmac_f32_16x16x64_bf16 v[20:23], v[116:119], v[240:247], v0
  s_waitcnt lgkmcnt(3)
  s_barrier
  ds_read_b128 v[100:103], v2 offset:2048
  v_smfmac_f32_16x16x64_bf16 v[24:27], v[116:119], a[0:7], v0
  s_mov_b32 m0, s31
  ds_read_b128 v[120:123], v1 offset:2048
  v_smfmac_f32_16x16x64_bf16 v[16:19], v[84:87], v[232:239], v0
  v_smfmac_f32_16x16x64_bf16 v[20:23], v[84:87], v[248:255], v0
  ds_read_b128 v[80:83], v4 offset:15360
  v_smfmac_f32_16x16x64_bf16 v[24:27], v[84:87], a[8:15], v0
  s_waitcnt lgkmcnt(2)
  buffer_load_dwordx4 v9, s[4:7], s27 offen sc1 lds
  v_smfmac_f32_16x16x64_bf16 v[16:19], v[100:103], v[128:135], v0
  ds_read_b128 v[92:95], v2 offset:1024
  s_mov_b32 m0, s32
  v_smfmac_f32_16x16x64_bf16 v[20:23], v[100:103], v[144:151], v0
  ds_read_b128 v[96:99], v1 offset:1024
  v_smfmac_f32_16x16x64_bf16 v[24:27], v[100:103], v[68:75], v0
  s_waitcnt vmcnt(1) lgkmcnt(3)
  ds_read_b128 v[116:119], v2 offset:0
  v_smfmac_f32_16x16x64_bf16 v[16:19], v[120:123], v[136:143], v0
  ds_read_b128 v[124:127], v1 offset:0
  buffer_load_dwordx4 v9, s[4:7], s27 offen offset:128 sc1 lds
  v_smfmac_f32_16x16x64_bf16 v[20:23], v[120:123], v[152:159], v0
  s_waitcnt lgkmcnt(4)
  ds_read_b128 v[104:107], v2 offset:6144
  s_mov_b32 m0, s33
  v_smfmac_f32_16x16x64_bf16 v[24:27], v[120:123], v[76:83], v0
  s_waitcnt lgkmcnt(4)
  ds_read_b128 v[108:111], v1 offset:6144
  v_smfmac_f32_16x16x64_bf16 v[16:19], v[92:95], v[160:167], v0
  s_waitcnt lgkmcnt(4)
  ds_read_b128 v[112:115], v2 offset:5120
  v_smfmac_f32_16x16x64_bf16 v[16:19], v[96:99], v[168:175], v0
  s_waitcnt lgkmcnt(4)
  ds_read_b128 v[84:87], v1 offset:5120
  buffer_load_dwordx4 v10, s[4:7], s28 offen sc1 lds
  v_smfmac_f32_16x16x64_bf16 v[16:19], v[116:119], v[192:199], v0
  s_waitcnt lgkmcnt(4)
  ds_read_b128 v[88:91], v2 offset:4096
  s_mov_b32 m0, s34
  v_smfmac_f32_16x16x64_bf16 v[16:19], v[124:127], v[200:207], v0
  s_waitcnt lgkmcnt(4)
  ds_read_b128 v[100:103], v1 offset:4096
  v_smfmac_f32_16x16x64_bf16 v[16:19], v[104:107], a[16:23], v0
  s_waitcnt lgkmcnt(4)
  ds_read_b128 v[68:71], v4 offset:16384
  v_smfmac_f32_16x16x64_bf16 v[16:19], v[108:111], a[24:31], v0
  s_waitcnt lgkmcnt(4)
  ds_read_b128 v[72:75], v4 offset:17408
  buffer_load_dwordx4 v10, s[4:7], s28 offen offset:256 sc1 lds
  v_smfmac_f32_16x16x64_bf16 v[16:19], v[112:115], a[64:71], v0
  s_waitcnt lgkmcnt(4)
  ds_read_b128 v[76:79], v4 offset:18432
  s_mov_b32 m0, 32256
  v_smfmac_f32_16x16x64_bf16 v[16:19], v[84:87], a[72:79], v0
  s_waitcnt lgkmcnt(4)
  ds_read_b128 v[80:83], v4 offset:19456
  v_smfmac_f32_16x16x64_bf16 v[16:19], v[88:91], a[112:119], v0
  s_waitcnt lgkmcnt(4)
  v_smfmac_f32_16x16x64_bf16 v[16:19], v[100:103], a[120:127], v0
  buffer_load_dword v3, s[4:7], s99 offen sc1 lds
  s_add_u32 s24, s36, 145752064
  s_add_u32 s25, s36, 145756160
  v_smfmac_f32_16x16x64_bf16 v[20:23], v[92:95], v[176:183], v0
  s_add_u32 s35, s36, s23
  v_smfmac_f32_16x16x64_bf16 v[20:23], v[96:99], v[184:191], v0
  s_waitcnt lgkmcnt(2)
  v_smfmac_f32_16x16x64_bf16 v[20:23], v[116:119], v[68:75], v0
  s_waitcnt lgkmcnt(0)
  ds_read_b128 v[68:71], v4 offset:20480
  v_mul_f32 v16, s18, v16
  v_smfmac_f32_16x16x64_bf16 v[20:23], v[124:127], v[76:83], v0
  ds_read_b128 v[72:75], v4 offset:21504
  v_mul_f32 v17, s18, v17
  v_smfmac_f32_16x16x64_bf16 v[20:23], v[104:107], a[32:39], v0
  ds_read_b128 v[76:79], v4 offset:22528
  v_mul_f32 v18, s18, v18
  v_smfmac_f32_16x16x64_bf16 v[20:23], v[108:111], a[40:47], v0
  ds_read_b128 v[80:83], v4 offset:23552
  v_mul_f32 v19, s18, v19
  v_smfmac_f32_16x16x64_bf16 v[20:23], v[112:115], a[80:87], v0
  v_cvt_pk_bf16_f32 v120, v16, v17
  v_smfmac_f32_16x16x64_bf16 v[20:23], v[84:87], a[88:95], v0
  v_cvt_pk_bf16_f32 v121, v18, v19
  v_smfmac_f32_16x16x64_bf16 v[20:23], v[88:91], a[128:135], v0
  ds_write_b64 v5, v[120:121] offset:24576
  v_smfmac_f32_16x16x64_bf16 v[20:23], v[100:103], a[136:143], v0
  s_waitcnt lgkmcnt(3)
  v_smfmac_f32_16x16x64_bf16 v[24:27], v[92:95], v[68:75], v0
  s_waitcnt lgkmcnt(1)
  v_mov_b64 v[92:93], 0
  v_smfmac_f32_16x16x64_bf16 v[24:27], v[96:99], v[76:83], v0
  s_nop 1
  v_cvt_pk_bf16_f32 v122, v20, v21
  v_cvt_pk_bf16_f32 v123, v22, v23
  v_smfmac_f32_16x16x64_bf16 v[24:27], v[116:119], v[208:215], v0
  ds_write_b64 v5, v[122:123] offset:26880
  v_mov_b64 v[94:95], 0
  v_smfmac_f32_16x16x64_bf16 v[24:27], v[124:127], v[216:223], v0
  s_waitcnt lgkmcnt(1)
  s_barrier
  ds_read_b64_tr_b16 v[68:69], v6 offset:24576
  v_smfmac_f32_16x16x64_bf16 v[24:27], v[104:107], a[48:55], v0
  s_add_u32 s27, s27, 8192
  ds_read_b64_tr_b16 v[70:71], v6 offset:24640
  ds_read_b64_tr_b16 v[72:73], v6 offset:24832
  v_smfmac_f32_16x16x64_bf16 v[24:27], v[108:111], a[56:63], v0
  s_add_u32 s28, s28, 8192
  ds_read_b64_tr_b16 v[74:75], v6 offset:24896
  ds_read_b64_tr_b16 v[76:77], v6 offset:25088
  v_smfmac_f32_16x16x64_bf16 v[24:27], v[112:115], a[96:103], v0
  s_nop 0
  ds_read_b64_tr_b16 v[78:79], v6 offset:25152
  ds_read_b64_tr_b16 v[80:81], v6 offset:25344
  v_smfmac_f32_16x16x64_bf16 v[24:27], v[84:87], a[104:111], v0
  ds_read_b64_tr_b16 v[82:83], v6 offset:25408
  v_mov_b64 v[96:97], 0
  v_smfmac_f32_16x16x64_bf16 v[24:27], v[88:91], a[144:151], v0
  s_waitcnt lgkmcnt(8)
  s_barrier
  ds_read_b64_tr_b16 v[116:117], v6 offset:26880
  v_smfmac_f32_16x16x64_bf16 v[24:27], v[100:103], a[152:159], v0
  s_waitcnt lgkmcnt(7)
  ds_read_b64_tr_b16 v[118:119], v6 offset:26944
  v_mfma_f32_16x16x32_bf16 v[16:19], v[36:39], v[68:71], 0
  s_waitcnt lgkmcnt(6)
  ds_read_b64_tr_b16 v[124:125], v6 offset:27136
  ds_read_b64_tr_b16 v[126:127], v6 offset:27200
  v_mfma_f32_16x16x32_bf16 v[16:19], v[40:43], v[72:75], v[16:19]
  s_waitcnt lgkmcnt(6)
  ds_read_b64_tr_b16 v[104:105], v6 offset:27392
  ds_read_b64_tr_b16 v[106:107], v6 offset:27456
  v_mfma_f32_16x16x32_bf16 v[16:19], v[44:47], v[76:79], v[16:19]
  s_waitcnt lgkmcnt(6)
  ds_read_b64_tr_b16 v[108:109], v6 offset:27648
  ds_read_b64_tr_b16 v[110:111], v6 offset:27712
  v_mfma_f32_16x16x32_bf16 v[16:19], v[48:51], v[80:83], v[16:19]
  s_waitcnt lgkmcnt(6)
  v_cvt_pk_bf16_f32 v120, v24, v25
  v_cvt_pk_bf16_f32 v121, v26, v27
  v_mfma_f32_16x16x32_bf16 v[112:115], v[116:119], v[68:71], 0
  s_waitcnt lgkmcnt(4)
  v_mov_b64 v[98:99], 0
  v_mfma_f32_16x16x32_bf16 v[112:115], v[124:127], v[72:75], v[112:115]
  s_waitcnt lgkmcnt(2)
  v_mov_b64 v[36:37], 0
  v_exp_f32 v100, v16
  v_mfma_f32_16x16x32_bf16 v[112:115], v[104:107], v[76:79], v[112:115]
  s_waitcnt lgkmcnt(0)
  v_exp_f32 v101, v17
  v_mfma_f32_16x16x32_bf16 v[112:115], v[108:111], v[80:83], v[112:115]
  buffer_store_dwordx4 v[120:123], v2, s[4:7], s29 offen offset:3072 sc1
  v_exp_f32 v102, v18
  v_mfma_f32_16x16x32_bf16 v[20:23], v[52:55], v[68:71], 0
  v_exp_f32 v103, v19
  v_mfma_f32_16x16x32_bf16 v[20:23], v[56:59], v[72:75], v[20:23]
  v_cvt_pk_bf16_f32 v44, v100, v101
  v_cvt_pk_bf16_f32 v45, v102, v103
  v_mfma_f32_16x16x32_bf16 v[20:23], v[60:63], v[76:79], v[20:23]
  s_add_u32 s29, s29, 131072
  v_exp_f32 v100, v112
  v_mfma_f32_16x16x32_bf16 v[20:23], v[64:67], v[80:83], v[20:23]
  v_exp_f32 v101, v113
  v_exp_f32 v102, v114
  v_exp_f32 v103, v115
  v_cvt_pk_bf16_f32 v84, v100, v101
  v_cvt_pk_bf16_f32 v85, v102, v103
  v_cndmask_b32 v48, v84, 0, s[16:17]
  v_cndmask_b32 v49, v85, 0, s[16:17]
  v_cndmask_b32 v50, 0, v84, s[16:17]
  v_cndmask_b32 v51, 0, v85, s[16:17]
  v_exp_f32 v100, v20
  v_mfma_f32_16x16x16_bf16 v[88:91], v[12:13], v[48:49], 0
  v_exp_f32 v101, v21
  v_mfma_f32_16x16x16_bf16 v[24:27], v[120:121], v[48:49], 0
  v_exp_f32 v102, v22
  v_mfma_f32_16x16x16_bf16 v[116:119], v[120:121], v[50:51], 0
  v_exp_f32 v103, v23
  v_cvt_pk_bf16_f32 v46, v100, v101
  v_cvt_pk_bf16_f32 v47, v102, v103
  v_mov_b64 v[38:39], 0
  s_nop 0
  v_mfma_f32_16x16x32_bf16 v[88:91], v[12:15], v[44:47], v[88:91]
  v_mov_b64 v[40:41], 0
  v_mov_b64 v[42:43], 0
  v_mfma_f32_16x16x32_bf16 v[24:27], v[28:31], v[44:47], v[24:27]
  ds_read_b128 v[52:55], v4 offset:24576
  ds_read_b128 v[56:59], v4 offset:25600
  v_mfma_f32_16x16x32_bf16 v[116:119], v[32:35], v[44:47], v[116:119]
  s_nop 1
T_back_79:
  v_rcp_f32 v89, v88
  v_subrev_u32 v100, s54, v88
  v_cmp_le_u32 vcc, s96, v100
  v_mul_f32 v24, v89, v24
  v_mul_f32 v25, v89, v25
  v_cvt_pk_bf16_f32 v124, v24, v25
  v_pk_mul_f32 v[26:27], v[26:27], v[88:89] op_sel:[0,1] op_sel_hi:[1,1]
  v_pk_mul_f32 v[116:117], v[116:117], v[88:89] op_sel:[0,1] op_sel_hi:[1,1]
  v_pk_mul_f32 v[118:119], v[118:119], v[88:89] op_sel:[0,1] op_sel_hi:[1,1]
  v_cvt_pk_bf16_f32 v125, v26, v27
  v_cvt_pk_bf16_f32 v126, v116, v117
  v_cvt_pk_bf16_f32 v127, v118, v119
  ds_write_b128 v11, v[124:127] offset:30720
  s_cbranch_vccnz T_slow_78
  v_smfmac_f32_16x16x64_bf16 v[92:95], v[124:127], a[160:167], v0
  s_mov_b32 s96, s55
  v_smfmac_f32_16x16x64_bf16 v[96:99], v[124:127], a[168:175], v0
  v_smfmac_f32_16x16x64_bf16 v[36:39], v[124:127], a[176:183], v0
  s_waitcnt lgkmcnt(0)
  s_barrier
  ds_read_b128 v[104:107], v11 offset:30208
  ds_read_b128 v[108:111], v11 offset:29696
  ds_read_b128 v[68:71], v11 offset:29184
  v_smfmac_f32_16x16x64_bf16 v[40:43], v[124:127], a[184:191], v0
  s_waitcnt lgkmcnt(2)
  v_smfmac_f32_16x16x64_bf16 v[92:95], v[104:107], a[192:199], v0
  s_waitcnt lgkmcnt(1)
  ds_read_b128 v[76:79], v4 offset:28672
  v_smfmac_f32_16x16x64_bf16 v[92:95], v[108:111], a[224:231], v0
  s_waitcnt lgkmcnt(1)
  ds_read_b128 v[80:83], v4 offset:29696
  v_smfmac_f32_16x16x64_bf16 v[92:95], v[68:71], a[240:247], v0
  ds_read_b128 v[60:63], v4 offset:26624
  v_smfmac_f32_16x16x64_bf16 v[96:99], v[104:107], a[200:207], v0
  ds_read_b128 v[64:67], v4 offset:27648
  v_smfmac_f32_16x16x64_bf16 v[96:99], v[108:111], a[232:239], v0
  ds_read_b128 v[28:31], v4 offset:30720
  s_nop 0
  v_cvt_pk_bf16_f32 v16, v92, v93
  v_cvt_pk_bf16_f32 v17, v94, v95
  v_bfi_b32 v16, 1, s57, v16
  v_smfmac_f32_16x16x64_bf16 v[96:99], v[68:71], a[248:255], v0
  buffer_store_dwordx2 v[16:17], v7, s[4:7], s20 offen offset:0
  v_smfmac_f32_16x16x64_bf16 v[36:39], v[104:107], a[208:215], v0
  ds_read_b128 v[32:35], v4 offset:31744
  v_smfmac_f32_16x16x64_bf16 v[36:39], v[108:111], v[52:59], v0
  s_waitcnt lgkmcnt(4)
  s_nop 0
  v_cvt_pk_bf16_f32 v18, v96, v97
  v_cvt_pk_bf16_f32 v19, v98, v99
  v_bfi_b32 v18, 1, s57, v18
  v_smfmac_f32_16x16x64_bf16 v[36:39], v[68:71], v[76:83], v0
  buffer_store_dwordx2 v[18:19], v7, s[4:7], s20 offen offset:64
  v_smfmac_f32_16x16x64_bf16 v[40:43], v[104:107], a[216:223], v0
  s_waitcnt lgkmcnt(2)
  v_smfmac_f32_16x16x64_bf16 v[40:43], v[108:111], v[60:67], v0
  s_waitcnt lgkmcnt(0)
  s_nop 0
  v_cvt_pk_bf16_f32 v20, v36, v37
  v_cvt_pk_bf16_f32 v21, v38, v39
  v_bfi_b32 v20, 1, s57, v20
  v_smfmac_f32_16x16x64_bf16 v[40:43], v[68:71], v[28:35], v0
  buffer_store_dwordx2 v[20:21], v7, s[4:7], s21 offen offset:0
  s_nop 6
  v_cvt_pk_bf16_f32 v22, v40, v41
  v_cvt_pk_bf16_f32 v23, v42, v43
  v_bfi_b32 v22, 1, s57, v22
  buffer_store_dwordx2 v[22:23], v7, s[4:7], s21 offen offset:64
  ds_read_b128 v[68:71], v4 offset:0
  ds_read_b128 v[72:75], v4 offset:1024
  ds_read_b128 v[76:79], v4 offset:4096
  ds_read_b128 v[80:83], v4 offset:5120
  ds_read_b128 v[84:87], v4 offset:8192
  ds_read_b128 v[88:91], v4 offset:9216
  ds_read_b128 v[92:95], v4 offset:2048
  ds_read_b128 v[96:99], v4 offset:3072
  ds_read_b128 v[100:103], v4 offset:6144
  ds_read_b128 v[104:107], v4 offset:7168
  ds_read_b128 v[108:111], v4 offset:10240
  ds_read_b128 v[112:115], v4 offset:11264
  v_mov_b64 v[16:17], 0
  v_mov_b64 v[18:19], 0
  v_mov_b64 v[20:21], 0
  v_mov_b64 v[22:23], 0
  v_mov_b64 v[24:25], 0
  v_mov_b64 v[26:27], 0
  ds_read_b64 v[44:45], v2 offset:32256
  s_waitcnt lgkmcnt(0)
  v_readfirstlane_b32 s38, v44
  v_readfirstlane_b32 s37, v45
  s_nop 0
  s_lshl_b32 s38, s38, 1
  s_lshl1_add_u32 s37, s37, 1
  s_min_u32 s38, s38, s37
  s_cmp_ge_u32 s38, 64
  s_cselect_b32 s38, 100, s38
  s_sub_u32 s38, s38, 1
  s_max_i32 s30, s30, s38
  s_waitcnt vmcnt(4)
  s_barrier
  ds_read_b128 v[28:31], v2 offset:19456
  ds_read_b128 v[32:35], v2 offset:23552
  ds_read_b128 v[36:39], v2 offset:8192
  ds_read_b128 v[40:43], v2 offset:9216
  ds_read_b128 v[44:47], v2 offset:10240
  ds_read_b128 v[48:51], v2 offset:11264
  buffer_load_dwordx4 v[124:127], v2, s[4:7], s24 offen offset:3072 sc1
  buffer_load_dwordx4 v[116:119], v2, s[4:7], s25 offen offset:3072 sc1
  ds_read_b128 v[52:55], v2 offset:12288
  ds_read_b128 v[56:59], v2 offset:13312
  ds_read_b128 v[60:63], v2 offset:14336
  ds_read_b128 v[64:67], v2 offset:15360
  buffer_load_dwordx4 v[124:127], v2, s[4:7], s24 offen offset:3072 sc1
  buffer_load_dwordx4 v[116:119], v2, s[4:7], s25 offen offset:3072 sc1
  s_add_u32 s14, s14, 1
  s_cmp_ge_i32 s14, s30
  s_cbranch_scc1 T_kvw_75
T_kvb_76:
  s_mov_b32 s19, 0
  s_cmp_lg_u32 s14, 63
  s_cbranch_scc1 T_loop_71
  s_branch T_last_77
T_kvw_75:
  s_mov_b32 s19, 0
  s_branch T_kvok_84
T_kv_83:
  s_sleep 4
  s_add_u32 s19, s19, 1
  s_cmp_gt_u32 s19, 32768
  s_cbranch_scc1 M_exit
T_kvok_84:
  s_add_u32 s39, s99, 128
  s_mov_b32 s38, 0
  s_mov_b32 s37, 0
  s_atomic_or s38, s[58:59], s99 glc
  s_atomic_or s37, s[58:59], s39 glc
  s_waitcnt lgkmcnt(0)
  s_lshl_b32 s38, s38, 1
  s_lshl1_add_u32 s37, s37, 1
  s_min_u32 s38, s38, s37
  s_cmp_ge_u32 s38, 64
  s_cselect_b32 s38, 100, s38
  s_sub_u32 s38, s38, 1
  s_max_i32 s30, s30, s38
  s_cmp_ge_i32 s14, s30
  s_cbranch_scc1 T_kv_83
  s_branch T_kvb_76
T_slow_78:
  s_nop 7
  v_max3_f32 v100, v16, v17, v18
  v_max3_f32 v100, v100, v19, v20
  v_max3_f32 v100, v100, v21, v22
  v_max3_f32 v100, v100, v23, v112
  v_max3_f32 v100, v100, v113, v114
  v_max_f32 v100, v100, v115
  v_mov_b32 v101, v100
  s_nop 1
  v_permlane32_swap_b32 v100, v101
  s_nop 1
  v_max_f32 v100, v100, v101
  v_mov_b32 v101, v100
  s_nop 1
  v_permlane16_swap_b32 v100, v101
  s_nop 1
  v_max_f32 v100, v100, v101
  v_sub_f32 v16, v16, v100
  v_sub_f32 v17, v17, v100
  v_sub_f32 v18, v18, v100
  v_sub_f32 v19, v19, v100
  v_exp_f32 v16, v16
  v_exp_f32 v17, v17
  v_exp_f32 v18, v18
  v_exp_f32 v19, v19
  v_sub_f32 v20, v20, v100
  v_sub_f32 v21, v21, v100
  v_sub_f32 v22, v22, v100
  v_sub_f32 v23, v23, v100
  v_exp_f32 v20, v20
  v_exp_f32 v21, v21
  v_exp_f32 v22, v22
  v_exp_f32 v23, v23
  v_sub_f32 v112, v112, v100
  v_sub_f32 v113, v113, v100
  v_sub_f32 v114, v114, v100
  v_sub_f32 v115, v115, v100
  v_exp_f32 v112, v112
  v_exp_f32 v113, v113
  v_exp_f32 v114, v114
  v_exp_f32 v115, v115
  s_nop 0
  v_cvt_pk_bf16_f32 v44, v16, v17
  v_cvt_pk_bf16_f32 v45, v18, v19
  v_cvt_pk_bf16_f32 v46, v20, v21
  v_cvt_pk_bf16_f32 v47, v22, v23
  v_cvt_pk_bf16_f32 v84, v112, v113
  v_cvt_pk_bf16_f32 v85, v114, v115
  v_cndmask_b32 v48, v84, 0, s[16:17]
  v_cndmask_b32 v49, v85, 0, s[16:17]
  v_cndmask_b32 v50, 0, v84, s[16:17]
  v_cndmask_b32 v51, 0, v85, s[16:17]
  s_nop 1
  v_mfma_f32_16x16x16_bf16 v[88:91], v[12:13], v[48:49], 0
  v_mfma_f32_16x16x16_bf16 v[24:27], v[120:121], v[48:49], 0
  v_mfma_f32_16x16x16_bf16 v[116:119], v[120:121], v[50:51], 0
  v_mfma_f32_16x16x32_bf16 v[88:91], v[12:15], v[44:47], v[88:91]
  v_mfma_f32_16x16x32_bf16 v[24:27], v[28:31], v[44:47], v[24:27]
  v_mfma_f32_16x16x32_bf16 v[116:119], v[32:35], v[44:47], v[116:119]
  s_nop 7
  s_nop 1
  s_mov_b32 s96, -1
  s_branch T_back_79
.p2align 6
T_retry_85:
  s_mov_b64 exec, vcc
  buffer_load_dwordx4 v[124:127], v2, s[4:7], s24 offen offset:3072 sc1
  buffer_load_dwordx4 v[116:119], v2, s[4:7], s25 offen offset:3072 sc1
  s_mov_b64 exec, -1
  s_add_u32 s19, s19, 1
  s_cmp_gt_u32 s19, 32768
  s_cbranch_scc1 M_exit
T_last_77:
  s_waitcnt vmcnt(3) lgkmcnt(0)
  v_max3_u32 v123, v124, v125, v126
  v_max_u32 v123, v123, v127
  v_mov_b32_dpp v120, v124 row_ror:8 row_mask:0xf bank_mask:0xf
  v_mov_b32_dpp v121, v125 row_ror:8 row_mask:0xf bank_mask:0xf
  s_waitcnt vmcnt(2)
  v_max3_u32 v123, v123, v116, v117
  v_max3_u32 v123, v123, v118, v119
  v_cmp_eq_u32 vcc, -1, v123
  s_cbranch_vccnz T_retry_85
  v_smfmac_f32_16x16x64_bf16 v[20:23], v[124:127], v[76:83], v0
  ds_write_b128 v2, v[124:127] offset:3072
  v_mov_b32_dpp v122, v126 row_ror:8 row_mask:0xf bank_mask:0xf
  v_mov_b32_dpp v123, v127 row_ror:8 row_mask:0xf bank_mask:0xf
  v_smfmac_f32_16x16x64_bf16 v[24:27], v[124:127], v[84:91], v0
  ds_write_b128 v2, v[116:119] offset:7168
  v_mov_b32_dpp v84, v116 row_ror:8 row_mask:0xf bank_mask:0xf
  v_smfmac_f32_16x16x64_bf16 v[20:23], v[120:123], v[100:107], v0
  ds_read_b128 v[68:71], v4 offset:12288
  v_mov_b32_dpp v85, v117 row_ror:8 row_mask:0xf bank_mask:0xf
  v_smfmac_f32_16x16x64_bf16 v[24:27], v[120:123], v[108:115], v0
  ds_read_b128 v[72:75], v4 offset:13312
  v_mov_b32_dpp v86, v118 row_ror:8 row_mask:0xf bank_mask:0xf
  ds_read_b128 v[76:79], v4 offset:14336
  v_mov_b32_dpp v87, v119 row_ror:8 row_mask:0xf bank_mask:0xf
  v_smfmac_f32_16x16x64_bf16 v[20:23], v[116:119], v[240:247], v0
  s_waitcnt lgkmcnt(3)
  s_barrier
  ds_read_b128 v[100:103], v2 offset:2048
  v_smfmac_f32_16x16x64_bf16 v[24:27], v[116:119], a[0:7], v0
  ds_read_b128 v[120:123], v1 offset:2048
  v_smfmac_f32_16x16x64_bf16 v[20:23], v[84:87], v[248:255], v0
  ds_read_b128 v[80:83], v4 offset:15360
  v_smfmac_f32_16x16x64_bf16 v[24:27], v[84:87], a[8:15], v0
  s_waitcnt lgkmcnt(2)
  ds_read_b128 v[92:95], v2 offset:1024
  v_smfmac_f32_16x16x64_bf16 v[20:23], v[100:103], v[144:151], v0
  ds_read_b128 v[96:99], v1 offset:1024
  v_smfmac_f32_16x16x64_bf16 v[24:27], v[100:103], v[68:75], v0
  s_waitcnt vmcnt(0) lgkmcnt(3)
  ds_read_b128 v[116:119], v2 offset:0
  ds_read_b128 v[124:127], v1 offset:0
  v_smfmac_f32_16x16x64_bf16 v[20:23], v[120:123], v[152:159], v0
  s_waitcnt lgkmcnt(4)
  ds_read_b128 v[104:107], v2 offset:6144
  v_smfmac_f32_16x16x64_bf16 v[24:27], v[120:123], v[76:83], v0
  s_waitcnt lgkmcnt(4)
  ds_read_b128 v[108:111], v1 offset:6144
  ds_read_b128 v[112:115], v2 offset:5120
  ds_read_b128 v[84:87], v1 offset:5120
  ds_read_b128 v[88:91], v2 offset:4096
  ds_read_b128 v[100:103], v1 offset:4096
  ds_read_b128 v[68:71], v4 offset:16384
  ds_read_b128 v[72:75], v4 offset:17408
  ds_read_b128 v[76:79], v4 offset:18432
  ds_read_b128 v[80:83], v4 offset:19456
  v_smfmac_f32_16x16x64_bf16 v[20:23], v[92:95], v[176:183], v0
  s_waitcnt lgkmcnt(12)
  v_smfmac_f32_16x16x64_bf16 v[20:23], v[96:99], v[184:191], v0
  s_waitcnt lgkmcnt(2)
  v_smfmac_f32_16x16x64_bf16 v[20:23], v[116:119], v[68:75], v0
  s_waitcnt lgkmcnt(0)
  ds_read_b128 v[68:71], v4 offset:20480
  v_smfmac_f32_16x16x64_bf16 v[20:23], v[124:127], v[76:83], v0
  ds_read_b128 v[72:75], v4 offset:21504
  v_smfmac_f32_16x16x64_bf16 v[20:23], v[104:107], a[32:39], v0
  ds_read_b128 v[76:79], v4 offset:22528
  v_smfmac_f32_16x16x64_bf16 v[20:23], v[108:111], a[40:47], v0
  ds_read_b128 v[80:83], v4 offset:23552
  v_smfmac_f32_16x16x64_bf16 v[20:23], v[112:115], a[80:87], v0
  v_smfmac_f32_16x16x64_bf16 v[20:23], v[84:87], a[88:95], v0
  v_smfmac_f32_16x16x64_bf16 v[20:23], v[88:91], a[128:135], v0
  v_smfmac_f32_16x16x64_bf16 v[20:23], v[100:103], a[136:143], v0
  s_waitcnt lgkmcnt(2)
  v_smfmac_f32_16x16x64_bf16 v[24:27], v[92:95], v[68:75], v0
  s_waitcnt lgkmcnt(0)
  v_smfmac_f32_16x16x64_bf16 v[24:27], v[96:99], v[76:83], v0
  v_smfmac_f32_16x16x64_bf16 v[24:27], v[116:119], v[208:215], v0
  v_smfmac_f32_16x16x64_bf16 v[24:27], v[124:127], v[216:223], v0
  v_smfmac_f32_16x16x64_bf16 v[24:27], v[104:107], a[48:55], v0
  v_smfmac_f32_16x16x64_bf16 v[24:27], v[108:111], a[56:63], v0
  v_smfmac_f32_16x16x64_bf16 v[24:27], v[112:115], a[96:103], v0
  v_smfmac_f32_16x16x64_bf16 v[24:27], v[84:87], a[104:111], v0
  v_smfmac_f32_16x16x64_bf16 v[24:27], v[88:91], a[144:151], v0
  v_smfmac_f32_16x16x64_bf16 v[24:27], v[100:103], a[152:159], v0
  v_cvt_pk_bf16_f32 v122, v20, v21
  v_cvt_pk_bf16_f32 v123, v22, v23
  s_nop 5
  v_cvt_pk_bf16_f32 v120, v24, v25
  v_cvt_pk_bf16_f32 v121, v26, v27
  buffer_store_dwordx4 v[120:123], v2, s[4:7], s29 offen offset:3072 sc1
  s_branch M_tdone
M_global:
  s_cmp_eq_u32 s13, 1
  s_cbranch_scc1 T_w_91
  s_cmp_eq_u32 s13, 2
  s_cbranch_scc1 T_w_92
  s_cmp_eq_u32 s13, 3
  s_cbranch_scc1 T_w_93
T_w_90:
  s_mov_b32 s19, 0
  s_add_u32 s14, s14, 1
  s_and_b32 s57, s14, 1
  v_mov_b64 v[16:17], 0
  v_mov_b64 v[18:19], 0
  v_mov_b64 v[20:21], 0
  v_mov_b64 v[22:23], 0
  v_mov_b64 v[24:25], 0
  v_mov_b64 v[26:27], 0
  buffer_load_dwordx4 v[124:127], v2, s[4:7], s24 offen offset:0 sc1
  buffer_load_dwordx4 v[116:119], v2, s[4:7], s25 offen offset:0 sc1
  buffer_load_dwordx4 v[124:127], v2, s[4:7], s24 offen offset:0 sc1
  buffer_load_dwordx4 v[116:119], v2, s[4:7], s25 offen offset:0 sc1
  s_branch T_loop_94
.p2align 6
T_retry_95:
  s_mov_b64 exec, vcc
  buffer_load_dwordx4 v[124:127], v2, s[4:7], s24 offen offset:0 sc1
  buffer_load_dwordx4 v[116:119], v2, s[4:7], s25 offen offset:0 sc1
  s_mov_b64 exec, -1
  s_add_u32 s19, s19, 1
  s_cmp_gt_u32 s19, 32768
  s_cbranch_scc1 M_exit
  s_nop 0
  v_mov_b64 v[16:17], 0
  v_mov_b64 v[18:19], 0
T_loop_94:
  s_waitcnt vmcnt(3) lgkmcnt(0)
  v_max3_u32 v123, v124, v125, v126
  v_max_u32 v123, v123, v127
  v_mov_b32_dpp v120, v124 row_ror:8 row_mask:0xf bank_mask:0xf
  v_mov_b32_dpp v121, v125 row_ror:8 row_mask:0xf bank_mask:0xf
  s_waitcnt vmcnt(2)
  v_max3_u32 v123, v123, v116, v117
  v_max3_u32 v123, v123, v118, v119
  v_cmp_eq_u32 vcc, -1, v123
  v_smfmac_f32_16x16x64_bf16 v[16:19], v[124:127], v[68:75], v0
  s_cbranch_vccnz T_retry_95
  ds_write_b128 v2, v[124:127] offset:0
  v_mov_b32_dpp v122, v126 row_ror:8 row_mask:0xf bank_mask:0xf
  v_smfmac_f32_16x16x64_bf16 v[20:23], v[124:127], v[76:83], v0
  s_and_b32 s57, s14, 1
  v_mov_b32_dpp v123, v127 row_ror:8 row_mask:0xf bank_mask:0xf
  v_smfmac_f32_16x16x64_bf16 v[24:27], v[124:127], v[84:91], v0
  s_and_b32 s36, s14, 3
  ds_write_b128 v2, v[116:119] offset:4096
  v_smfmac_f32_16x16x64_bf16 v[16:19], v[120:123], v[92:99], v0
  s_lshl_b32 s36, s36, 13
  v_mov_b32_dpp v84, v116 row_ror:8 row_mask:0xf bank_mask:0xf
  v_smfmac_f32_16x16x64_bf16 v[20:23], v[120:123], v[100:107], v0
  s_add_u32 s26, s36, s23
  ds_read_b128 v[68:71], v4 offset:12288
  v_mov_b32_dpp v85, v117 row_ror:8 row_mask:0xf bank_mask:0xf
  v_smfmac_f32_16x16x64_bf16 v[24:27], v[120:123], v[108:115], v0
  s_add_u32 s36, s36, 8192
  ds_read_b128 v[72:75], v4 offset:13312
  v_mov_b32_dpp v86, v118 row_ror:8 row_mask:0xf bank_mask:0xf
  v_smfmac_f32_16x16x64_bf16 v[16:19], v[116:119], v[224:231], v0
  s_and_b32 s36, s36, 0x7fff
  ds_read_b128 v[76:79], v4 offset:14336
  v_mov_b32_dpp v87, v119 row_ror:8 row_mask:0xf bank_mask:0xf
  v_smfmac_f32_16x16x64_bf16 v[20:23], v[116:119], v[240:247], v0
  s_waitcnt lgkmcnt(3)
  s_barrier
  ds_read_b128 v[100:103], v2 offset:1024
  v_smfmac_f32_16x16x64_bf16 v[24:27], v[116:119], a[0:7], v0
  s_mov_b32 m0, s31
  ds_read_b128 v[120:123], v1 offset:1024
  buffer_load_dwordx4 v9, s[4:7], s27 offen sc1 lds
  v_smfmac_f32_16x16x64_bf16 v[16:19], v[84:87], v[232:239], v0
  s_mov_b32 m0, s32
  v_smfmac_f32_16x16x64_bf16 v[20:23], v[84:87], v[248:255], v0
  ds_read_b128 v[80:83], v4 offset:15360
  v_smfmac_f32_16x16x64_bf16 v[24:27], v[84:87], a[8:15], v0
  s_waitcnt lgkmcnt(2)
  v_smfmac_f32_16x16x64_bf16 v[16:19], v[100:103], v[128:135], v0
  ds_read_b128 v[92:95], v2 offset:2048
  buffer_load_dwordx4 v9, s[4:7], s27 offen offset:128 sc1 lds
  v_smfmac_f32_16x16x64_bf16 v[20:23], v[100:103], v[144:151], v0
  ds_read_b128 v[96:99], v1 offset:2048
  s_mov_b32 m0, s33
  v_smfmac_f32_16x16x64_bf16 v[24:27], v[100:103], v[68:75], v0
  s_waitcnt vmcnt(2) lgkmcnt(3)
  ds_read_b128 v[116:119], v2 offset:3072
  v_smfmac_f32_16x16x64_bf16 v[16:19], v[120:123], v[136:143], v0
  ds_read_b128 v[124:127], v1 offset:3072
  v_smfmac_f32_16x16x64_bf16 v[20:23], v[120:123], v[152:159], v0
  s_waitcnt lgkmcnt(4)
  ds_read_b128 v[104:107], v2 offset:5120
  buffer_load_dwordx4 v10, s[4:7], s28 offen sc1 lds
  v_smfmac_f32_16x16x64_bf16 v[24:27], v[120:123], v[76:83], v0
  s_waitcnt lgkmcnt(4)
  ds_read_b128 v[108:111], v1 offset:5120
  s_mov_b32 m0, s34
  v_smfmac_f32_16x16x64_bf16 v[16:19], v[92:95], v[160:167], v0
  s_waitcnt lgkmcnt(4)
  ds_read_b128 v[112:115], v2 offset:6144
  v_smfmac_f32_16x16x64_bf16 v[16:19], v[96:99], v[168:175], v0
  s_waitcnt lgkmcnt(4)
  ds_read_b128 v[84:87], v1 offset:6144
  v_smfmac_f32_16x16x64_bf16 v[16:19], v[116:119], v[192:199], v0
  s_waitcnt lgkmcnt(4)
  ds_read_b128 v[88:91], v2 offset:7168
  buffer_load_dwordx4 v10, s[4:7], s28 offen offset:256 sc1 lds
  v_smfmac_f32_16x16x64_bf16 v[16:19], v[124:127], v[200:207], v0
  s_waitcnt lgkmcnt(4)
  ds_read_b128 v[100:103], v1 offset:7168
  v_smfmac_f32_16x16x64_bf16 v[16:19], v[104:107], a[16:23], v0
  s_waitcnt lgkmcnt(4)
  ds_read_b128 v[68:71], v4 offset:16384
  v_smfmac_f32_16x16x64_bf16 v[16:19], v[108:111], a[24:31], v0
  s_waitcnt lgkmcnt(4)
  ds_read_b128 v[72:75], v4 offset:17408
  v_smfmac_f32_16x16x64_bf16 v[16:19], v[112:115], a[64:71], v0
  s_waitcnt lgkmcnt(4)
  ds_read_b128 v[76:79], v4 offset:18432
  v_smfmac_f32_16x16x64_bf16 v[16:19], v[84:87], a[72:79], v0
  s_waitcnt lgkmcnt(4)
  ds_read_b128 v[80:83], v4 offset:19456
  v_smfmac_f32_16x16x64_bf16 v[16:19], v[88:91], a[112:119], v0
  s_waitcnt lgkmcnt(4)
  v_smfmac_f32_16x16x64_bf16 v[16:19], v[100:103], a[120:127], v0
  s_add_u32 s24, s36, 145752064
  s_add_u32 s25, s36, 145756160
  v_smfmac_f32_16x16x64_bf16 v[20:23], v[92:95], v[176:183], v0
  s_add_u32 s35, s36, s23
  v_smfmac_f32_16x16x64_bf16 v[20:23], v[96:99], v[184:191], v0
  s_waitcnt lgkmcnt(2)
  v_smfmac_f32_16x16x64_bf16 v[20:23], v[116:119], v[68:75], v0
  s_waitcnt lgkmcnt(0)
  ds_read_b128 v[68:71], v4 offset:20480
  v_mul_f32 v16, s18, v16
  v_smfmac_f32_16x16x64_bf16 v[20:23], v[124:127], v[76:83], v0
  ds_read_b128 v[72:75], v4 offset:21504
  v_mul_f32 v17, s18, v17
  v_smfmac_f32_16x16x64_bf16 v[20:23], v[104:107], a[32:39], v0
  ds_read_b128 v[76:79], v4 offset:22528
  v_mul_f32 v18, s18, v18
  v_smfmac_f32_16x16x64_bf16 v[20:23], v[108:111], a[40:47], v0
  ds_read_b128 v[80:83], v4 offset:23552
  v_mul_f32 v19, s18, v19
  v_smfmac_f32_16x16x64_bf16 v[20:23], v[112:115], a[80:87], v0
  v_cvt_pk_bf16_f32 v120, v16, v17
  v_smfmac_f32_16x16x64_bf16 v[20:23], v[84:87], a[88:95], v0
  v_cvt_pk_bf16_f32 v121, v18, v19
  v_smfmac_f32_16x16x64_bf16 v[20:23], v[88:91], a[128:135], v0
  ds_write_b64 v5, v[120:121] offset:24576
  v_smfmac_f32_16x16x64_bf16 v[20:23], v[100:103], a[136:143], v0
  s_waitcnt lgkmcnt(3)
  v_smfmac_f32_16x16x64_bf16 v[24:27], v[92:95], v[68:75], v0
  s_waitcnt lgkmcnt(1)
  v_mov_b64 v[92:93], 0
  v_smfmac_f32_16x16x64_bf16 v[24:27], v[96:99], v[76:83], v0
  s_nop 1
  v_cvt_pk_bf16_f32 v122, v20, v21
  v_cvt_pk_bf16_f32 v123, v22, v23
  v_smfmac_f32_16x16x64_bf16 v[24:27], v[116:119], v[208:215], v0
  ds_write_b64 v5, v[122:123] offset:26880
  v_mov_b64 v[94:95], 0
  v_smfmac_f32_16x16x64_bf16 v[24:27], v[124:127], v[216:223], v0
  s_waitcnt lgkmcnt(1)
  s_barrier
  ds_read_b64_tr_b16 v[68:69], v6 offset:24576
  v_smfmac_f32_16x16x64_bf16 v[24:27], v[104:107], a[48:55], v0
  s_add_u32 s27, s27, 8192
  ds_read_b64_tr_b16 v[70:71], v6 offset:24640
  ds_read_b64_tr_b16 v[72:73], v6 offset:24832
  v_smfmac_f32_16x16x64_bf16 v[24:27], v[108:111], a[56:63], v0
  s_add_u32 s28, s28, 8192
  ds_read_b64_tr_b16 v[74:75], v6 offset:24896
  ds_read_b64_tr_b16 v[76:77], v6 offset:25088
  v_smfmac_f32_16x16x64_bf16 v[24:27], v[112:115], a[96:103], v0
  s_nop 0
  ds_read_b64_tr_b16 v[78:79], v6 offset:25152
  ds_read_b64_tr_b16 v[80:81], v6 offset:25344
  v_smfmac_f32_16x16x64_bf16 v[24:27], v[84:87], a[104:111], v0
  ds_read_b64_tr_b16 v[82:83], v6 offset:25408
  v_mov_b64 v[96:97], 0
  v_smfmac_f32_16x16x64_bf16 v[24:27], v[88:91], a[144:151], v0
  s_waitcnt lgkmcnt(8)
  s_barrier
  ds_read_b64_tr_b16 v[116:117], v6 offset:26880
  v_smfmac_f32_16x16x64_bf16 v[24:27], v[100:103], a[152:159], v0
  s_waitcnt lgkmcnt(7)
  ds_read_b64_tr_b16 v[118:119], v6 offset:26944
  v_mfma_f32_16x16x32_bf16 v[16:19], v[36:39], v[68:71], 0
  s_waitcnt lgkmcnt(6)
  ds_read_b64_tr_b16 v[124:125], v6 offset:27136
  ds_read_b64_tr_b16 v[126:127], v6 offset:27200
  v_mfma_f32_16x16x32_bf16 v[16:19], v[40:43], v[72:75], v[16:19]
  s_waitcnt lgkmcnt(6)
  ds_read_b64_tr_b16 v[104:105], v6 offset:27392
  ds_read_b64_tr_b16 v[106:107], v6 offset:27456
  v_mfma_f32_16x16x32_bf16 v[16:19], v[44:47], v[76:79], v[16:19]
  s_waitcnt lgkmcnt(6)
  ds_read_b64_tr_b16 v[108:109], v6 offset:27648
  ds_read_b64_tr_b16 v[110:111], v6 offset:27712
  v_mfma_f32_16x16x32_bf16 v[16:19], v[48:51], v[80:83], v[16:19]
  s_waitcnt lgkmcnt(6)
  v_cvt_pk_bf16_f32 v120, v24, v25
  v_cvt_pk_bf16_f32 v121, v26, v27
  v_mfma_f32_16x16x32_bf16 v[112:115], v[116:119], v[68:71], 0
  s_waitcnt lgkmcnt(4)
  buffer_store_dwordx4 v[120:123], v2, s[4:7], s29 offen offset:0 sc1
  v_mov_b64 v[98:99], 0
  v_mfma_f32_16x16x32_bf16 v[112:115], v[124:127], v[72:75], v[112:115]
  s_waitcnt lgkmcnt(2)
  v_mov_b64 v[36:37], 0
  v_exp_f32 v100, v16
  v_mfma_f32_16x16x32_bf16 v[112:115], v[104:107], v[76:79], v[112:115]
  s_waitcnt lgkmcnt(0)
  v_exp_f32 v101, v17
  v_mfma_f32_16x16x32_bf16 v[112:115], v[108:111], v[80:83], v[112:115]
  v_exp_f32 v102, v18
  v_mfma_f32_16x16x32_bf16 v[20:23], v[52:55], v[68:71], 0
  v_exp_f32 v103, v19
  v_mfma_f32_16x16x32_bf16 v[20:23], v[56:59], v[72:75], v[20:23]
  v_cvt_pk_bf16_f32 v44, v100, v101
  v_cvt_pk_bf16_f32 v45, v102, v103
  v_mfma_f32_16x16x32_bf16 v[20:23], v[60:63], v[76:79], v[20:23]
  s_add_u32 s29, s29, 131072
  v_exp_f32 v100, v112
  v_mfma_f32_16x16x32_bf16 v[20:23], v[64:67], v[80:83], v[20:23]
  v_exp_f32 v101, v113
  v_exp_f32 v102, v114
  v_exp_f32 v103, v115
  v_cvt_pk_bf16_f32 v84, v100, v101
  v_cvt_pk_bf16_f32 v85, v102, v103
  v_cndmask_b32 v48, v84, 0, s[16:17]
  v_cndmask_b32 v49, v85, 0, s[16:17]
  v_cndmask_b32 v50, 0, v84, s[16:17]
  v_cndmask_b32 v51, 0, v85, s[16:17]
  v_exp_f32 v100, v20
  v_mfma_f32_16x16x16_bf16 v[88:91], v[12:13], v[48:49], 0
  v_exp_f32 v101, v21
  v_mfma_f32_16x16x16_bf16 v[24:27], v[120:121], v[48:49], 0
  v_exp_f32 v102, v22
  v_mfma_f32_16x16x16_bf16 v[116:119], v[120:121], v[50:51], 0
  v_exp_f32 v103, v23
  v_cvt_pk_bf16_f32 v46, v100, v101
  v_cvt_pk_bf16_f32 v47, v102, v103
  v_mov_b64 v[38:39], 0
  s_nop 0
  v_mfma_f32_16x16x32_bf16 v[88:91], v[12:15], v[44:47], v[88:91]
  v_mov_b64 v[40:41], 0
  v_mov_b64 v[42:43], 0
  v_mfma_f32_16x16x32_bf16 v[24:27], v[28:31], v[44:47], v[24:27]
  ds_read_b128 v[52:55], v4 offset:24576
  ds_read_b128 v[56:59], v4 offset:25600
  v_mfma_f32_16x16x32_bf16 v[116:119], v[32:35], v[44:47], v[116:119]
  s_nop 1
T_back_102:
  v_rcp_f32 v89, v88
  v_subrev_u32 v100, s54, v88
  v_cmp_le_u32 vcc, s96, v100
  v_mul_f32 v24, v89, v24
  v_mul_f32 v25, v89, v25
  v_cvt_pk_bf16_f32 v124, v24, v25
  v_pk_mul_f32 v[26:27], v[26:27], v[88:89] op_sel:[0,1] op_sel_hi:[1,1]
  v_pk_mul_f32 v[116:117], v[116:117], v[88:89] op_sel:[0,1] op_sel_hi:[1,1]
  v_pk_mul_f32 v[118:119], v[118:119], v[88:89] op_sel:[0,1] op_sel_hi:[1,1]
  v_cvt_pk_bf16_f32 v125, v26, v27
  v_cvt_pk_bf16_f32 v126, v116, v117
  v_cvt_pk_bf16_f32 v127, v118, v119
  ds_write_b128 v11, v[124:127] offset:29184
  s_cbranch_vccnz T_slow_101
  v_smfmac_f32_16x16x64_bf16 v[92:95], v[124:127], a[160:167], v0
  s_mov_b32 s96, s55
  v_smfmac_f32_16x16x64_bf16 v[96:99], v[124:127], a[168:175], v0
  v_smfmac_f32_16x16x64_bf16 v[36:39], v[124:127], a[176:183], v0
  s_waitcnt lgkmcnt(0)
  s_barrier
  ds_read_b128 v[104:107], v11 offset:29696
  ds_read_b128 v[108:111], v11 offset:30208
  ds_read_b128 v[68:71], v11 offset:30720
  v_smfmac_f32_16x16x64_bf16 v[40:43], v[124:127], a[184:191], v0
  s_waitcnt lgkmcnt(2)
  v_smfmac_f32_16x16x64_bf16 v[92:95], v[104:107], a[192:199], v0
  s_waitcnt lgkmcnt(1)
  ds_read_b128 v[76:79], v4 offset:28672
  v_smfmac_f32_16x16x64_bf16 v[92:95], v[108:111], a[224:231], v0
  s_waitcnt lgkmcnt(1)
  ds_read_b128 v[80:83], v4 offset:29696
  v_smfmac_f32_16x16x64_bf16 v[92:95], v[68:71], a[240:247], v0
  ds_read_b128 v[60:63], v4 offset:26624
  v_smfmac_f32_16x16x64_bf16 v[96:99], v[104:107], a[200:207], v0
  ds_read_b128 v[64:67], v4 offset:27648
  v_smfmac_f32_16x16x64_bf16 v[96:99], v[108:111], a[232:239], v0
  ds_read_b128 v[28:31], v4 offset:30720
  s_nop 0
  v_cvt_pk_bf16_f32 v16, v92, v93
  v_cvt_pk_bf16_f32 v17, v94, v95
  v_bfi_b32 v16, 1, s57, v16
  v_smfmac_f32_16x16x64_bf16 v[96:99], v[68:71], a[248:255], v0
  buffer_store_dwordx2 v[16:17], v7, s[4:7], s20 offen offset:0 sc1
  v_smfmac_f32_16x16x64_bf16 v[36:39], v[104:107], a[208:215], v0
  ds_read_b128 v[32:35], v4 offset:31744
  v_smfmac_f32_16x16x64_bf16 v[36:39], v[108:111], v[52:59], v0
  s_waitcnt lgkmcnt(4)
  s_nop 0
  v_cvt_pk_bf16_f32 v18, v96, v97
  v_cvt_pk_bf16_f32 v19, v98, v99
  v_bfi_b32 v18, 1, s57, v18
  v_smfmac_f32_16x16x64_bf16 v[36:39], v[68:71], v[76:83], v0
  buffer_store_dwordx2 v[18:19], v7, s[4:7], s20 offen offset:64 sc1
  v_smfmac_f32_16x16x64_bf16 v[40:43], v[104:107], a[216:223], v0
  s_waitcnt lgkmcnt(2)
  ds_read_b128 v[116:119], v2 offset:31232
  v_smfmac_f32_16x16x64_bf16 v[40:43], v[108:111], v[60:67], v0
  s_waitcnt lgkmcnt(1)
  s_nop 0
  v_cvt_pk_bf16_f32 v20, v36, v37
  v_cvt_pk_bf16_f32 v21, v38, v39
  v_bfi_b32 v20, 1, s57, v20
  v_smfmac_f32_16x16x64_bf16 v[40:43], v[68:71], v[28:35], v0
  buffer_store_dwordx2 v[20:21], v7, s[4:7], s21 offen offset:0 sc1
  s_nop 6
  v_cvt_pk_bf16_f32 v22, v40, v41
  v_cvt_pk_bf16_f32 v23, v42, v43
  v_bfi_b32 v22, 1, s57, v22
  buffer_store_dwordx2 v[22:23], v7, s[4:7], s21 offen offset:64 sc1
  ds_read_b128 v[68:71], v4 offset:0
  ds_read_b128 v[72:75], v4 offset:1024
  ds_read_b128 v[76:79], v4 offset:4096
  ds_read_b128 v[80:83], v4 offset:5120
  ds_read_b128 v[84:87], v4 offset:8192
  ds_read_b128 v[88:91], v4 offset:9216
  v_mov_b64 v[16:17], 0
  v_mov_b64 v[18:19], 0
  v_mov_b64 v[20:21], 0
  v_mov_b64 v[22:23], 0
  v_mov_b64 v[24:25], 0
  v_mov_b64 v[26:27], 0
  s_mov_b32 s19, 0
  v_mov_b32 v49, -1
  s_waitcnt vmcnt(2)
  buffer_load_dwordx4 v[52:55], v2, s[4:7], s22 offen offset:0 sc1
  buffer_load_dwordx4 v[56:59], v2, s[4:7], s22 offen offset:1024 sc1
  buffer_load_dwordx4 v[60:63], v2, s[4:7], s22 offen offset:2048 sc1
  buffer_load_dwordx4 v[64:67], v2, s[4:7], s22 offen offset:3072 sc1
  ds_read_b128 v[92:95], v4 offset:2048
  ds_read_b128 v[96:99], v4 offset:3072
  ds_read_b128 v[100:103], v4 offset:6144
  ds_read_b128 v[104:107], v4 offset:7168
  ds_read_b128 v[108:111], v4 offset:10240
  ds_read_b128 v[112:115], v4 offset:11264
  ds_read_b64 v[44:45], v2 offset:32256
  s_waitcnt lgkmcnt(0)
  v_readfirstlane_b32 s38, v44
  v_readfirstlane_b32 s37, v45
  s_nop 0
  s_lshl_b32 s38, s38, 1
  s_lshl1_add_u32 s37, s37, 1
  s_min_u32 s38, s38, s37
  s_cmp_ge_u32 s38, 64
  s_cselect_b32 s38, 100, s38
  s_sub_u32 s38, s38, 1
  s_max_i32 s30, s30, s38
  s_waitcnt lgkmcnt(12)
  s_waitcnt vmcnt(3)
  v_mfma_f32_16x16x32_bf16 v[120:123], v[116:119], v[52:55], 0
  v_xor_b32 v48, s57, v52
  v_bitop3_b32 v48, v48, v54, s57 bitop3:0xf6
  s_waitcnt vmcnt(2)
  v_mfma_f32_16x16x32_bf16 v[120:123], v[116:119], v[56:59], v[120:123]
  v_bitop3_b32 v48, v48, v56, s57 bitop3:0xf6
  v_bitop3_b32 v48, v48, v58, s57 bitop3:0xf6
  s_waitcnt vmcnt(1)
  v_mfma_f32_16x16x32_bf16 v[120:123], v[116:119], v[60:63], v[120:123]
  v_bitop3_b32 v48, v48, v60, s57 bitop3:0xf6
  v_bitop3_b32 v48, v48, v62, s57 bitop3:0xf6
  s_waitcnt vmcnt(0)
  v_mfma_f32_16x16x32_bf16 v[120:123], v[116:119], v[64:67], v[120:123]
  v_bitop3_b32 v48, v48, v64, s57 bitop3:0xf6
  v_bitop3_b32 v48, v48, v66, s57 bitop3:0xf6
  v_and_b32 v48, 1, v48
  v_cmp_ne_u32 vcc, 0, v48
  s_cbranch_vccnz T_p1re_104
T_p1ok_105:
  s_nop 2
  v_add_f32_dpp v120, v120, v120 row_ror:8 row_mask:0xf bank_mask:0xf
  v_add_f32_dpp v121, v121, v121 row_ror:8 row_mask:0xf bank_mask:0xf
  v_cvt_pk_bf16_f32 v48, v120, v121
  buffer_store_dword v48, v8, s[4:7], s35 offen sc1
  buffer_store_dword v49, v8, s[4:7], s26 offen sc1
  s_barrier
  ds_read_b128 v[28:31], v2 offset:16384
  ds_read_b128 v[32:35], v2 offset:20480
  ds_read_b128 v[36:39], v2 offset:8192
  ds_read_b128 v[40:43], v2 offset:9216
  ds_read_b128 v[44:47], v2 offset:10240
  ds_read_b128 v[48:51], v2 offset:11264
  buffer_load_dwordx4 v[124:127], v2, s[4:7], s24 offen offset:0 sc1
  buffer_load_dwordx4 v[116:119], v2, s[4:7], s25 offen offset:0 sc1
  ds_read_b128 v[52:55], v2 offset:12288
  ds_read_b128 v[56:59], v2 offset:13312
  ds_read_b128 v[60:63], v2 offset:14336
  ds_read_b128 v[64:67], v2 offset:15360
  buffer_load_dwordx4 v[124:127], v2, s[4:7], s24 offen offset:0 sc1
  buffer_load_dwordx4 v[116:119], v2, s[4:7], s25 offen offset:0 sc1
  s_add_u32 s14, s14, 1
  s_cmp_ge_i32 s14, s30
  s_cbranch_scc1 T_kvw_98
T_kvb_99:
  s_mov_b32 s19, 0
  s_cmp_lg_u32 s14, 63
  s_cbranch_scc1 T_loop_94
  s_branch T_last_100
T_p1re_104:
  s_mov_b64 exec, vcc
  buffer_load_dwordx4 v[52:55], v2, s[4:7], s22 offen offset:0 sc1
  buffer_load_dwordx4 v[56:59], v2, s[4:7], s22 offen offset:1024 sc1
  buffer_load_dwordx4 v[60:63], v2, s[4:7], s22 offen offset:2048 sc1
  buffer_load_dwordx4 v[64:67], v2, s[4:7], s22 offen offset:3072 sc1
  s_mov_b64 exec, -1
  s_add_u32 s19, s19, 1
  s_cmp_gt_u32 s19, 32768
  s_cbranch_scc1 M_exit
  s_waitcnt vmcnt(3)
  v_mfma_f32_16x16x32_bf16 v[120:123], v[116:119], v[52:55], 0
  v_xor_b32 v48, s57, v52
  v_bitop3_b32 v48, v48, v54, s57 bitop3:0xf6
  s_waitcnt vmcnt(2)
  v_mfma_f32_16x16x32_bf16 v[120:123], v[116:119], v[56:59], v[120:123]
  v_bitop3_b32 v48, v48, v56, s57 bitop3:0xf6
  v_bitop3_b32 v48, v48, v58, s57 bitop3:0xf6
  s_waitcnt vmcnt(1)
  v_mfma_f32_16x16x32_bf16 v[120:123], v[116:119], v[60:63], v[120:123]
  v_bitop3_b32 v48, v48, v60, s57 bitop3:0xf6
  v_bitop3_b32 v48, v48, v62, s57 bitop3:0xf6
  s_waitcnt vmcnt(0)
  v_mfma_f32_16x16x32_bf16 v[120:123], v[116:119], v[64:67], v[120:123]
  v_bitop3_b32 v48, v48, v64, s57 bitop3:0xf6
  v_bitop3_b32 v48, v48, v66, s57 bitop3:0xf6
  v_and_b32 v48, 1, v48
  v_cmp_ne_u32 vcc, 0, v48
  s_cbranch_vccnz T_p1re_104
  s_branch T_p1ok_105
T_kvw_98:
  s_mov_b32 s19, 0
  s_branch T_kvok_107
T_kv_106:
  s_sleep 4
  s_add_u32 s19, s19, 1
  s_cmp_gt_u32 s19, 32768
  s_cbranch_scc1 M_exit
T_kvok_107:
  s_add_u32 s39, s99, 128
  s_mov_b32 s38, 0
  s_mov_b32 s37, 0
  s_atomic_or s38, s[58:59], s99 glc
  s_atomic_or s37, s[58:59], s39 glc
  s_waitcnt lgkmcnt(0)
  s_lshl_b32 s38, s38, 1
  s_lshl1_add_u32 s37, s37, 1
  s_min_u32 s38, s38, s37
  s_cmp_ge_u32 s38, 64
  s_cselect_b32 s38, 100, s38
  s_sub_u32 s38, s38, 1
  s_max_i32 s30, s30, s38
  s_cmp_ge_i32 s14, s30
  s_cbranch_scc1 T_kv_106
  s_branch T_kvb_99
T_slow_101:
  s_nop 7
  v_max3_f32 v100, v16, v17, v18
  v_max3_f32 v100, v100, v19, v20
  v_max3_f32 v100, v100, v21, v22
  v_max3_f32 v100, v100, v23, v112
  v_max3_f32 v100, v100, v113, v114
  v_max_f32 v100, v100, v115
  v_mov_b32 v101, v100
  s_nop 1
  v_permlane32_swap_b32 v100, v101
  s_nop 1
  v_max_f32 v100, v100, v101
  v_mov_b32 v101, v100
  s_nop 1
  v_permlane16_swap_b32 v100, v101
  s_nop 1
  v_max_f32 v100, v100, v101
  v_sub_f32 v16, v16, v100
  v_sub_f32 v17, v17, v100
  v_sub_f32 v18, v18, v100
  v_sub_f32 v19, v19, v100
  v_exp_f32 v16, v16
  v_exp_f32 v17, v17
  v_exp_f32 v18, v18
  v_exp_f32 v19, v19
  v_sub_f32 v20, v20, v100
  v_sub_f32 v21, v21, v100
  v_sub_f32 v22, v22, v100
  v_sub_f32 v23, v23, v100
  v_exp_f32 v20, v20
  v_exp_f32 v21, v21
  v_exp_f32 v22, v22
  v_exp_f32 v23, v23
  v_sub_f32 v112, v112, v100
  v_sub_f32 v113, v113, v100
  v_sub_f32 v114, v114, v100
  v_sub_f32 v115, v115, v100
  v_exp_f32 v112, v112
  v_exp_f32 v113, v113
  v_exp_f32 v114, v114
  v_exp_f32 v115, v115
  s_nop 0
  v_cvt_pk_bf16_f32 v44, v16, v17
  v_cvt_pk_bf16_f32 v45, v18, v19
  v_cvt_pk_bf16_f32 v46, v20, v21
  v_cvt_pk_bf16_f32 v47, v22, v23
  v_cvt_pk_bf16_f32 v84, v112, v113
  v_cvt_pk_bf16_f32 v85, v114, v115
  v_cndmask_b32 v48, v84, 0, s[16:17]
  v_cndmask_b32 v49, v85, 0, s[16:17]
  v_cndmask_b32 v50, 0, v84, s[16:17]
  v_cndmask_b32 v51, 0, v85, s[16:17]
  s_nop 1
  v_mfma_f32_16x16x16_bf16 v[88:91], v[12:13], v[48:49], 0
  v_mfma_f32_16x16x16_bf16 v[24:27], v[120:121], v[48:49], 0
  v_mfma_f32_16x16x16_bf16 v[116:119], v[120:121], v[50:51], 0
  v_mfma_f32_16x16x32_bf16 v[88:91], v[12:15], v[44:47], v[88:91]
  v_mfma_f32_16x16x32_bf16 v[24:27], v[28:31], v[44:47], v[24:27]
  v_mfma_f32_16x16x32_bf16 v[116:119], v[32:35], v[44:47], v[116:119]
  s_nop 7
  s_nop 1
  s_mov_b32 s96, -1
  s_branch T_back_102
.p2align 6
T_retry_108:
  s_mov_b64 exec, vcc
  buffer_load_dwordx4 v[124:127], v2, s[4:7], s24 offen offset:0 sc1
  buffer_load_dwordx4 v[116:119], v2, s[4:7], s25 offen offset:0 sc1
  s_mov_b64 exec, -1
  s_add_u32 s19, s19, 1
  s_cmp_gt_u32 s19, 32768
  s_cbranch_scc1 M_exit
T_last_100:
  s_waitcnt vmcnt(3) lgkmcnt(0)
  v_max3_u32 v123, v124, v125, v126
  v_max_u32 v123, v123, v127
  v_mov_b32_dpp v120, v124 row_ror:8 row_mask:0xf bank_mask:0xf
  v_mov_b32_dpp v121, v125 row_ror:8 row_mask:0xf bank_mask:0xf
  s_waitcnt vmcnt(2)
  v_max3_u32 v123, v123, v116, v117
  v_max3_u32 v123, v123, v118, v119
  v_cmp_eq_u32 vcc, -1, v123
  s_cbranch_vccnz T_retry_108
  v_smfmac_f32_16x16x64_bf16 v[20:23], v[124:127], v[76:83], v0
  ds_write_b128 v2, v[124:127] offset:0
  v_mov_b32_dpp v122, v126 row_ror:8 row_mask:0xf bank_mask:0xf
  v_mov_b32_dpp v123, v127 row_ror:8 row_mask:0xf bank_mask:0xf
  v_smfmac_f32_16x16x64_bf16 v[24:27], v[124:127], v[84:91], v0
  ds_write_b128 v2, v[116:119] offset:4096
  v_mov_b32_dpp v84, v116 row_ror:8 row_mask:0xf bank_mask:0xf
  v_smfmac_f32_16x16x64_bf16 v[20:23], v[120:123], v[100:107], v0
  ds_read_b128 v[68:71], v4 offset:12288
  v_mov_b32_dpp v85, v117 row_ror:8 row_mask:0xf bank_mask:0xf
  v_smfmac_f32_16x16x64_bf16 v[24:27], v[120:123], v[108:115], v0
  ds_read_b128 v[72:75], v4 offset:13312
  v_mov_b32_dpp v86, v118 row_ror:8 row_mask:0xf bank_mask:0xf
  ds_read_b128 v[76:79], v4 offset:14336
  v_mov_b32_dpp v87, v119 row_ror:8 row_mask:0xf bank_mask:0xf
  v_smfmac_f32_16x16x64_bf16 v[20:23], v[116:119], v[240:247], v0
  s_waitcnt lgkmcnt(3)
  s_barrier
  ds_read_b128 v[100:103], v2 offset:1024
  v_smfmac_f32_16x16x64_bf16 v[24:27], v[116:119], a[0:7], v0
  ds_read_b128 v[120:123], v1 offset:1024
  v_smfmac_f32_16x16x64_bf16 v[20:23], v[84:87], v[248:255], v0
  ds_read_b128 v[80:83], v4 offset:15360
  v_smfmac_f32_16x16x64_bf16 v[24:27], v[84:87], a[8:15], v0
  s_waitcnt lgkmcnt(2)
  ds_read_b128 v[92:95], v2 offset:2048
  v_smfmac_f32_16x16x64_bf16 v[20:23], v[100:103], v[144:151], v0
  ds_read_b128 v[96:99], v1 offset:2048
  v_smfmac_f32_16x16x64_bf16 v[24:27], v[100:103], v[68:75], v0
  s_waitcnt vmcnt(0) lgkmcnt(3)
  ds_read_b128 v[116:119], v2 offset:3072
  ds_read_b128 v[124:127], v1 offset:3072
  v_smfmac_f32_16x16x64_bf16 v[20:23], v[120:123], v[152:159], v0
  s_waitcnt lgkmcnt(4)
  ds_read_b128 v[104:107], v2 offset:5120
  v_smfmac_f32_16x16x64_bf16 v[24:27], v[120:123], v[76:83], v0
  s_waitcnt lgkmcnt(4)
  ds_read_b128 v[108:111], v1 offset:5120
  ds_read_b128 v[112:115], v2 offset:6144
  ds_read_b128 v[84:87], v1 offset:6144
  ds_read_b128 v[88:91], v2 offset:7168
  ds_read_b128 v[100:103], v1 offset:7168
  ds_read_b128 v[68:71], v4 offset:16384
  ds_read_b128 v[72:75], v4 offset:17408
  ds_read_b128 v[76:79], v4 offset:18432
  ds_read_b128 v[80:83], v4 offset:19456
  v_smfmac_f32_16x16x64_bf16 v[20:23], v[92:95], v[176:183], v0
  s_waitcnt lgkmcnt(12)
  v_smfmac_f32_16x16x64_bf16 v[20:23], v[96:99], v[184:191], v0
  s_waitcnt lgkmcnt(2)
  v_smfmac_f32_16x16x64_bf16 v[20:23], v[116:119], v[68:75], v0
  s_waitcnt lgkmcnt(0)
  ds_read_b128 v[68:71], v4 offset:20480
  v_smfmac_f32_16x16x64_bf16 v[20:23], v[124:127], v[76:83], v0
  ds_read_b128 v[72:75], v4 offset:21504
  v_smfmac_f32_16x16x64_bf16 v[20:23], v[104:107], a[32:39], v0
  ds_read_b128 v[76:79], v4 offset:22528
  v_smfmac_f32_16x16x64_bf16 v[20:23], v[108:111], a[40:47], v0
  ds_read_b128 v[80:83], v4 offset:23552
  v_smfmac_f32_16x16x64_bf16 v[20:23], v[112:115], a[80:87], v0
  v_smfmac_f32_16x16x64_bf16 v[20:23], v[84:87], a[88:95], v0
  v_smfmac_f32_16x16x64_bf16 v[20:23], v[88:91], a[128:135], v0
  v_smfmac_f32_16x16x64_bf16 v[20:23], v[100:103], a[136:143], v0
  s_waitcnt lgkmcnt(2)
  v_smfmac_f32_16x16x64_bf16 v[24:27], v[92:95], v[68:75], v0
  s_waitcnt lgkmcnt(0)
  v_smfmac_f32_16x16x64_bf16 v[24:27], v[96:99], v[76:83], v0
  v_smfmac_f32_16x16x64_bf16 v[24:27], v[116:119], v[208:215], v0
  v_smfmac_f32_16x16x64_bf16 v[24:27], v[124:127], v[216:223], v0
  v_smfmac_f32_16x16x64_bf16 v[24:27], v[104:107], a[48:55], v0
  v_smfmac_f32_16x16x64_bf16 v[24:27], v[108:111], a[56:63], v0
  v_smfmac_f32_16x16x64_bf16 v[24:27], v[112:115], a[96:103], v0
  v_smfmac_f32_16x16x64_bf16 v[24:27], v[84:87], a[104:111], v0
  v_smfmac_f32_16x16x64_bf16 v[24:27], v[88:91], a[144:151], v0
  v_smfmac_f32_16x16x64_bf16 v[24:27], v[100:103], a[152:159], v0
  v_cvt_pk_bf16_f32 v122, v20, v21
  v_cvt_pk_bf16_f32 v123, v22, v23
  s_nop 5
  v_cvt_pk_bf16_f32 v120, v24, v25
  v_cvt_pk_bf16_f32 v121, v26, v27
  buffer_store_dwordx4 v[120:123], v2, s[4:7], s29 offen offset:0 sc1
  s_branch M_tdone
T_w_91:
  s_mov_b32 s19, 0
  s_add_u32 s14, s14, 1
  s_and_b32 s57, s14, 1
  v_mov_b64 v[16:17], 0
  v_mov_b64 v[18:19], 0
  v_mov_b64 v[20:21], 0
  v_mov_b64 v[22:23], 0
  v_mov_b64 v[24:25], 0
  v_mov_b64 v[26:27], 0
  buffer_load_dwordx4 v[124:127], v2, s[4:7], s24 offen offset:1024 sc1
  buffer_load_dwordx4 v[116:119], v2, s[4:7], s25 offen offset:1024 sc1
  buffer_load_dwordx4 v[124:127], v2, s[4:7], s24 offen offset:1024 sc1
  buffer_load_dwordx4 v[116:119], v2, s[4:7], s25 offen offset:1024 sc1
  s_branch T_loop_113
.p2align 6
T_retry_114:
  s_mov_b64 exec, vcc
  buffer_load_dwordx4 v[124:127], v2, s[4:7], s24 offen offset:1024 sc1
  buffer_load_dwordx4 v[116:119], v2, s[4:7], s25 offen offset:1024 sc1
  s_mov_b64 exec, -1
  s_add_u32 s19, s19, 1
  s_cmp_gt_u32 s19, 32768
  s_cbranch_scc1 M_exit
  s_nop 0
  v_mov_b64 v[16:17], 0
  v_mov_b64 v[18:19], 0
T_loop_113:
  s_waitcnt vmcnt(3) lgkmcnt(0)
  v_max3_u32 v123, v124, v125, v126
  v_max_u32 v123, v123, v127
  v_mov_b32_dpp v120, v124 row_ror:8 row_mask:0xf bank_mask:0xf
  v_mov_b32_dpp v121, v125 row_ror:8 row_mask:0xf bank_mask:0xf
  s_waitcnt vmcnt(2)
  v_max3_u32 v123, v123, v116, v117
  v_max3_u32 v123, v123, v118, v119
  v_cmp_eq_u32 vcc, -1, v123
  v_smfmac_f32_16x16x64_bf16 v[16:19], v[124:127], v[68:75], v0
  s_cbranch_vccnz T_retry_114
  ds_write_b128 v2, v[124:127] offset:1024
  v_mov_b32_dpp v122, v126 row_ror:8 row_mask:0xf bank_mask:0xf
  v_smfmac_f32_16x16x64_bf16 v[20:23], v[124:127], v[76:83], v0
  s_and_b32 s57, s14, 1
  v_mov_b32_dpp v123, v127 row_ror:8 row_mask:0xf bank_mask:0xf
  v_smfmac_f32_16x16x64_bf16 v[24:27], v[124:127], v[84:91], v0
  s_and_b32 s36, s14, 3
  ds_write_b128 v2, v[116:119] offset:5120
  v_smfmac_f32_16x16x64_bf16 v[16:19], v[120:123], v[92:99], v0
  s_lshl_b32 s36, s36, 13
  v_mov_b32_dpp v84, v116 row_ror:8 row_mask:0xf bank_mask:0xf
  v_smfmac_f32_16x16x64_bf16 v[20:23], v[120:123], v[100:107], v0
  s_add_u32 s26, s36, s23
  ds_read_b128 v[68:71], v4 offset:12288
  v_mov_b32_dpp v85, v117 row_ror:8 row_mask:0xf bank_mask:0xf
  v_smfmac_f32_16x16x64_bf16 v[24:27], v[120:123], v[108:115], v0
  s_add_u32 s36, s36, 8192
  ds_read_b128 v[72:75], v4 offset:13312
  v_mov_b32_dpp v86, v118 row_ror:8 row_mask:0xf bank_mask:0xf
  v_smfmac_f32_16x16x64_bf16 v[16:19], v[116:119], v[224:231], v0
  s_and_b32 s36, s36, 0x7fff
  ds_read_b128 v[76:79], v4 offset:14336
  v_mov_b32_dpp v87, v119 row_ror:8 row_mask:0xf bank_mask:0xf
  v_smfmac_f32_16x16x64_bf16 v[20:23], v[116:119], v[240:247], v0
  s_waitcnt lgkmcnt(3)
  s_barrier
  ds_read_b128 v[100:103], v2 offset:0
  v_smfmac_f32_16x16x64_bf16 v[24:27], v[116:119], a[0:7], v0
  s_mov_b32 m0, s31
  ds_read_b128 v[120:123], v1 offset:0
  v_smfmac_f32_16x16x64_bf16 v[16:19], v[84:87], v[232:239], v0
  buffer_load_dwordx4 v9, s[4:7], s27 offen sc1 lds
  v_smfmac_f32_16x16x64_bf16 v[20:23], v[84:87], v[248:255], v0
  ds_read_b128 v[80:83], v4 offset:15360
  s_mov_b32 m0, s32
  v_smfmac_f32_16x16x64_bf16 v[24:27], v[84:87], a[8:15], v0
  s_waitcnt lgkmcnt(2)
  v_smfmac_f32_16x16x64_bf16 v[16:19], v[100:103], v[128:135], v0
  ds_read_b128 v[92:95], v2 offset:3072
  v_smfmac_f32_16x16x64_bf16 v[20:23], v[100:103], v[144:151], v0
  ds_read_b128 v[96:99], v1 offset:3072
  buffer_load_dwordx4 v9, s[4:7], s27 offen offset:128 sc1 lds
  v_smfmac_f32_16x16x64_bf16 v[24:27], v[100:103], v[68:75], v0
  s_waitcnt vmcnt(2) lgkmcnt(3)
  ds_read_b128 v[116:119], v2 offset:2048
  s_mov_b32 m0, s33
  v_smfmac_f32_16x16x64_bf16 v[16:19], v[120:123], v[136:143], v0
  ds_read_b128 v[124:127], v1 offset:2048
  v_smfmac_f32_16x16x64_bf16 v[20:23], v[120:123], v[152:159], v0
  s_waitcnt lgkmcnt(4)
  ds_read_b128 v[104:107], v2 offset:4096
  v_smfmac_f32_16x16x64_bf16 v[24:27], v[120:123], v[76:83], v0
  s_waitcnt lgkmcnt(4)
  ds_read_b128 v[108:111], v1 offset:4096
  buffer_load_dwordx4 v10, s[4:7], s28 offen sc1 lds
  v_smfmac_f32_16x16x64_bf16 v[16:19], v[92:95], v[160:167], v0
  s_waitcnt lgkmcnt(4)
  ds_read_b128 v[112:115], v2 offset:7168
  s_mov_b32 m0, s34
  v_smfmac_f32_16x16x64_bf16 v[16:19], v[96:99], v[168:175], v0
  s_waitcnt lgkmcnt(4)
  ds_read_b128 v[84:87], v1 offset:7168
  v_smfmac_f32_16x16x64_bf16 v[16:19], v[116:119], v[192:199], v0
  s_waitcnt lgkmcnt(4)
  ds_read_b128 v[88:91], v2 offset:6144
  v_smfmac_f32_16x16x64_bf16 v[16:19], v[124:127], v[200:207], v0
  s_waitcnt lgkmcnt(4)
  ds_read_b128 v[100:103], v1 offset:6144
  buffer_load_dwordx4 v10, s[4:7], s28 offen offset:256 sc1 lds
  v_smfmac_f32_16x16x64_bf16 v[16:19], v[104:107], a[16:23], v0
  s_waitcnt lgkmcnt(4)
  ds_read_b128 v[68:71], v4 offset:16384
  v_smfmac_f32_16x16x64_bf16 v[16:19], v[108:111], a[24:31], v0
  s_waitcnt lgkmcnt(4)
  ds_read_b128 v[72:75], v4 offset:17408
  v_smfmac_f32_16x16x64_bf16 v[16:19], v[112:115], a[64:71], v0
  s_waitcnt lgkmcnt(4)
  ds_read_b128 v[76:79], v4 offset:18432
  v_smfmac_f32_16x16x64_bf16 v[16:19], v[84:87], a[72:79], v0
  s_waitcnt lgkmcnt(4)
  ds_read_b128 v[80:83], v4 offset:19456
  v_smfmac_f32_16x16x64_bf16 v[16:19], v[88:91], a[112:119], v0
  s_waitcnt lgkmcnt(4)
  v_smfmac_f32_16x16x64_bf16 v[16:19], v[100:103], a[120:127], v0
  s_add_u32 s24, s36, 145752064
  s_add_u32 s25, s36, 145756160
  v_smfmac_f32_16x16x64_bf16 v[20:23], v[92:95], v[176:183], v0
  s_add_u32 s35, s36, s23
  v_smfmac_f32_16x16x64_bf16 v[20:23], v[96:99], v[184:191], v0
  s_waitcnt lgkmcnt(2)
  v_smfmac_f32_16x16x64_bf16 v[20:23], v[116:119], v[68:75], v0
  s_waitcnt lgkmcnt(0)
  ds_read_b128 v[68:71], v4 offset:20480
  v_mul_f32 v16, s18, v16
  v_smfmac_f32_16x16x64_bf16 v[20:23], v[124:127], v[76:83], v0
  ds_read_b128 v[72:75], v4 offset:21504
  v_mul_f32 v17, s18, v17
  v_smfmac_f32_16x16x64_bf16 v[20:23], v[104:107], a[32:39], v0
  ds_read_b128 v[76:79], v4 offset:22528
  v_mul_f32 v18, s18, v18
  v_smfmac_f32_16x16x64_bf16 v[20:23], v[108:111], a[40:47], v0
  ds_read_b128 v[80:83], v4 offset:23552
  v_mul_f32 v19, s18, v19
  v_smfmac_f32_16x16x64_bf16 v[20:23], v[112:115], a[80:87], v0
  v_cvt_pk_bf16_f32 v120, v16, v17
  v_smfmac_f32_16x16x64_bf16 v[20:23], v[84:87], a[88:95], v0
  v_cvt_pk_bf16_f32 v121, v18, v19
  v_smfmac_f32_16x16x64_bf16 v[20:23], v[88:91], a[128:135], v0
  ds_write_b64 v5, v[120:121] offset:24576
  v_smfmac_f32_16x16x64_bf16 v[20:23], v[100:103], a[136:143], v0
  s_waitcnt lgkmcnt(3)
  v_smfmac_f32_16x16x64_bf16 v[24:27], v[92:95], v[68:75], v0
  s_waitcnt lgkmcnt(1)
  v_mov_b64 v[92:93], 0
  v_smfmac_f32_16x16x64_bf16 v[24:27], v[96:99], v[76:83], v0
  s_nop 1
  v_cvt_pk_bf16_f32 v122, v20, v21
  v_cvt_pk_bf16_f32 v123, v22, v23
  v_smfmac_f32_16x16x64_bf16 v[24:27], v[116:119], v[208:215], v0
  ds_write_b64 v5, v[122:123] offset:26880
  v_mov_b64 v[94:95], 0
  v_smfmac_f32_16x16x64_bf16 v[24:27], v[124:127], v[216:223], v0
  s_waitcnt lgkmcnt(1)
  s_barrier
  ds_read_b64_tr_b16 v[68:69], v6 offset:24576
  v_smfmac_f32_16x16x64_bf16 v[24:27], v[104:107], a[48:55], v0
  s_add_u32 s27, s27, 8192
  ds_read_b64_tr_b16 v[70:71], v6 offset:24640
  ds_read_b64_tr_b16 v[72:73], v6 offset:24832
  v_smfmac_f32_16x16x64_bf16 v[24:27], v[108:111], a[56:63], v0
  s_add_u32 s28, s28, 8192
  ds_read_b64_tr_b16 v[74:75], v6 offset:24896
  ds_read_b64_tr_b16 v[76:77], v6 offset:25088
  v_smfmac_f32_16x16x64_bf16 v[24:27], v[112:115], a[96:103], v0
  s_nop 0
  ds_read_b64_tr_b16 v[78:79], v6 offset:25152
  ds_read_b64_tr_b16 v[80:81], v6 offset:25344
  v_smfmac_f32_16x16x64_bf16 v[24:27], v[84:87], a[104:111], v0
  ds_read_b64_tr_b16 v[82:83], v6 offset:25408
  v_mov_b64 v[96:97], 0
  v_smfmac_f32_16x16x64_bf16 v[24:27], v[88:91], a[144:151], v0
  s_waitcnt lgkmcnt(8)
  s_barrier
  ds_read_b64_tr_b16 v[116:117], v6 offset:26880
  v_smfmac_f32_16x16x64_bf16 v[24:27], v[100:103], a[152:159], v0
  s_waitcnt lgkmcnt(7)
  ds_read_b64_tr_b16 v[118:119], v6 offset:26944
  v_mfma_f32_16x16x32_bf16 v[16:19], v[36:39], v[68:71], 0
  s_waitcnt lgkmcnt(6)
  ds_read_b64_tr_b16 v[124:125], v6 offset:27136
  ds_read_b64_tr_b16 v[126:127], v6 offset:27200
  v_mfma_f32_16x16x32_bf16 v[16:19], v[40:43], v[72:75], v[16:19]
  s_waitcnt lgkmcnt(6)
  ds_read_b64_tr_b16 v[104:105], v6 offset:27392
  ds_read_b64_tr_b16 v[106:107], v6 offset:27456
  v_mfma_f32_16x16x32_bf16 v[16:19], v[44:47], v[76:79], v[16:19]
  s_waitcnt lgkmcnt(6)
  ds_read_b64_tr_b16 v[108:109], v6 offset:27648
  ds_read_b64_tr_b16 v[110:111], v6 offset:27712
  v_mfma_f32_16x16x32_bf16 v[16:19], v[48:51], v[80:83], v[16:19]
  s_waitcnt lgkmcnt(6)
  v_cvt_pk_bf16_f32 v120, v24, v25
  v_cvt_pk_bf16_f32 v121, v26, v27
  v_mfma_f32_16x16x32_bf16 v[112:115], v[116:119], v[68:71], 0
  s_waitcnt lgkmcnt(4)
  v_mov_b64 v[98:99], 0
  v_mfma_f32_16x16x32_bf16 v[112:115], v[124:127], v[72:75], v[112:115]
  s_waitcnt lgkmcnt(2)
  buffer_store_dwordx4 v[120:123], v2, s[4:7], s29 offen offset:1024 sc1
  v_mov_b64 v[36:37], 0
  v_exp_f32 v100, v16
  v_mfma_f32_16x16x32_bf16 v[112:115], v[104:107], v[76:79], v[112:115]
  s_waitcnt lgkmcnt(0)
  v_exp_f32 v101, v17
  v_mfma_f32_16x16x32_bf16 v[112:115], v[108:111], v[80:83], v[112:115]
  v_exp_f32 v102, v18
  v_mfma_f32_16x16x32_bf16 v[20:23], v[52:55], v[68:71], 0
  v_exp_f32 v103, v19
  v_mfma_f32_16x16x32_bf16 v[20:23], v[56:59], v[72:75], v[20:23]
  v_cvt_pk_bf16_f32 v44, v100, v101
  v_cvt_pk_bf16_f32 v45, v102, v103
  v_mfma_f32_16x16x32_bf16 v[20:23], v[60:63], v[76:79], v[20:23]
  s_add_u32 s29, s29, 131072
  v_exp_f32 v100, v112
  v_mfma_f32_16x16x32_bf16 v[20:23], v[64:67], v[80:83], v[20:23]
  v_exp_f32 v101, v113
  v_exp_f32 v102, v114
  v_exp_f32 v103, v115
  v_cvt_pk_bf16_f32 v84, v100, v101
  v_cvt_pk_bf16_f32 v85, v102, v103
  v_cndmask_b32 v48, v84, 0, s[16:17]
  v_cndmask_b32 v49, v85, 0, s[16:17]
  v_cndmask_b32 v50, 0, v84, s[16:17]
  v_cndmask_b32 v51, 0, v85, s[16:17]
  v_exp_f32 v100, v20
  v_mfma_f32_16x16x16_bf16 v[88:91], v[12:13], v[48:49], 0
  v_exp_f32 v101, v21
  v_mfma_f32_16x16x16_bf16 v[24:27], v[120:121], v[48:49], 0
  v_exp_f32 v102, v22
  v_mfma_f32_16x16x16_bf16 v[116:119], v[120:121], v[50:51], 0
  v_exp_f32 v103, v23
  v_cvt_pk_bf16_f32 v46, v100, v101
  v_cvt_pk_bf16_f32 v47, v102, v103
  v_mov_b64 v[38:39], 0
  s_nop 0
  v_mfma_f32_16x16x32_bf16 v[88:91], v[12:15], v[44:47], v[88:91]
  v_mov_b64 v[40:41], 0
  v_mov_b64 v[42:43], 0
  v_mfma_f32_16x16x32_bf16 v[24:27], v[28:31], v[44:47], v[24:27]
  ds_read_b128 v[52:55], v4 offset:24576
  ds_read_b128 v[56:59], v4 offset:25600
  v_mfma_f32_16x16x32_bf16 v[116:119], v[32:35], v[44:47], v[116:119]
  s_nop 1
T_back_121:
  v_rcp_f32 v89, v88
  v_subrev_u32 v100, s54, v88
  v_cmp_le_u32 vcc, s96, v100
  v_mul_f32 v24, v89, v24
  v_mul_f32 v25, v89, v25
  v_cvt_pk_bf16_f32 v124, v24, v25
  v_pk_mul_f32 v[26:27], v[26:27], v[88:89] op_sel:[0,1] op_sel_hi:[1,1]
  v_pk_mul_f32 v[116:117], v[116:117], v[88:89] op_sel:[0,1] op_sel_hi:[1,1]
  v_pk_mul_f32 v[118:119], v[118:119], v[88:89] op_sel:[0,1] op_sel_hi:[1,1]
  v_cvt_pk_bf16_f32 v125, v26, v27
  v_cvt_pk_bf16_f32 v126, v116, v117
  v_cvt_pk_bf16_f32 v127, v118, v119
  ds_write_b128 v11, v[124:127] offset:29696
  s_cbranch_vccnz T_slow_120
  v_smfmac_f32_16x16x64_bf16 v[92:95], v[124:127], a[160:167], v0
  s_mov_b32 s96, s55
  v_smfmac_f32_16x16x64_bf16 v[96:99], v[124:127], a[168:175], v0
  v_smfmac_f32_16x16x64_bf16 v[36:39], v[124:127], a[176:183], v0
  s_waitcnt lgkmcnt(0)
  s_barrier
  ds_read_b128 v[104:107], v11 offset:29184
  ds_read_b128 v[108:111], v11 offset:30720
  ds_read_b128 v[68:71], v11 offset:30208
  v_smfmac_f32_16x16x64_bf16 v[40:43], v[124:127], a[184:191], v0
  s_waitcnt lgkmcnt(2)
  v_smfmac_f32_16x16x64_bf16 v[92:95], v[104:107], a[192:199], v0
  s_waitcnt lgkmcnt(1)
  ds_read_b128 v[76:79], v4 offset:28672
  v_smfmac_f32_16x16x64_bf16 v[92:95], v[108:111], a[224:231], v0
  s_waitcnt lgkmcnt(1)
  ds_read_b128 v[80:83], v4 offset:29696
  v_smfmac_f32_16x16x64_bf16 v[92:95], v[68:71], a[240:247], v0
  ds_read_b128 v[60:63], v4 offset:26624
  v_smfmac_f32_16x16x64_bf16 v[96:99], v[104:107], a[200:207], v0
  ds_read_b128 v[64:67], v4 offset:27648
  v_smfmac_f32_16x16x64_bf16 v[96:99], v[108:111], a[232:239], v0
  ds_read_b128 v[28:31], v4 offset:30720
  s_nop 0
  v_cvt_pk_bf16_f32 v16, v92, v93
  v_cvt_pk_bf16_f32 v17, v94, v95
  v_bfi_b32 v16, 1, s57, v16
  v_smfmac_f32_16x16x64_bf16 v[96:99], v[68:71], a[248:255], v0
  buffer_store_dwordx2 v[16:17], v7, s[4:7], s20 offen offset:0 sc1
  v_smfmac_f32_16x16x64_bf16 v[36:39], v[104:107], a[208:215], v0
  ds_read_b128 v[32:35], v4 offset:31744
  v_smfmac_f32_16x16x64_bf16 v[36:39], v[108:111], v[52:59], v0
  s_waitcnt lgkmcnt(4)
  s_nop 0
  v_cvt_pk_bf16_f32 v18, v96, v97
  v_cvt_pk_bf16_f32 v19, v98, v99
  v_bfi_b32 v18, 1, s57, v18
  v_smfmac_f32_16x16x64_bf16 v[36:39], v[68:71], v[76:83], v0
  buffer_store_dwordx2 v[18:19], v7, s[4:7], s20 offen offset:64 sc1
  v_smfmac_f32_16x16x64_bf16 v[40:43], v[104:107], a[216:223], v0
  s_waitcnt lgkmcnt(2)
  ds_read_b128 v[116:119], v2 offset:31232
  v_smfmac_f32_16x16x64_bf16 v[40:43], v[108:111], v[60:67], v0
  s_waitcnt lgkmcnt(1)
  s_nop 0
  v_cvt_pk_bf16_f32 v20, v36, v37
  v_cvt_pk_bf16_f32 v21, v38, v39
  v_bfi_b32 v20, 1, s57, v20
  v_smfmac_f32_16x16x64_bf16 v[40:43], v[68:71], v[28:35], v0
  buffer_store_dwordx2 v[20:21], v7, s[4:7], s21 offen offset:0 sc1
  s_nop 6
  v_cvt_pk_bf16_f32 v22, v40, v41
  v_cvt_pk_bf16_f32 v23, v42, v43
  v_bfi_b32 v22, 1, s57, v22
  buffer_store_dwordx2 v[22:23], v7, s[4:7], s21 offen offset:64 sc1
  ds_read_b128 v[68:71], v4 offset:0
  ds_read_b128 v[72:75], v4 offset:1024
  ds_read_b128 v[76:79], v4 offset:4096
  ds_read_b128 v[80:83], v4 offset:5120
  ds_read_b128 v[84:87], v4 offset:8192
  ds_read_b128 v[88:91], v4 offset:9216
  ds_read_b128 v[92:95], v4 offset:2048
  ds_read_b128 v[96:99], v4 offset:3072
  ds_read_b128 v[100:103], v4 offset:6144
  ds_read_b128 v[104:107], v4 offset:7168
  ds_read_b128 v[108:111], v4 offset:10240
  ds_read_b128 v[112:115], v4 offset:11264
  v_mov_b64 v[16:17], 0
  v_mov_b64 v[18:19], 0
  v_mov_b64 v[20:21], 0
  v_mov_b64 v[22:23], 0
  v_mov_b64 v[24:25], 0
  v_mov_b64 v[26:27], 0
  s_mov_b32 s19, 0
  v_mov_b32 v49, -1
  ds_read_b64 v[44:45], v2 offset:32256
  s_waitcnt lgkmcnt(0)
  v_readfirstlane_b32 s38, v44
  v_readfirstlane_b32 s37, v45
  s_nop 0
  s_lshl_b32 s38, s38, 1
  s_lshl1_add_u32 s37, s37, 1
  s_min_u32 s38, s38, s37
  s_cmp_ge_u32 s38, 64
  s_cselect_b32 s38, 100, s38
  s_sub_u32 s38, s38, 1
  s_max_i32 s30, s30, s38
  s_waitcnt vmcnt(0)
  buffer_load_dwordx4 v[52:55], v2, s[4:7], s22 offen offset:0 sc1
  buffer_load_dwordx4 v[56:59], v2, s[4:7], s22 offen offset:1024 sc1
  buffer_load_dwordx4 v[60:63], v2, s[4:7], s22 offen offset:2048 sc1
  buffer_load_dwordx4 v[64:67], v2, s[4:7], s22 offen offset:3072 sc1
  s_waitcnt lgkmcnt(12)
  s_waitcnt vmcnt(3)
  v_mfma_f32_16x16x32_bf16 v[120:123], v[116:119], v[52:55], 0
  v_xor_b32 v48, s57, v52
  v_bitop3_b32 v48, v48, v54, s57 bitop3:0xf6
  s_waitcnt vmcnt(2)
  v_mfma_f32_16x16x32_bf16 v[120:123], v[116:119], v[56:59], v[120:123]
  v_bitop3_b32 v48, v48, v56, s57 bitop3:0xf6
  v_bitop3_b32 v48, v48, v58, s57 bitop3:0xf6
  s_waitcnt vmcnt(1)
  v_mfma_f32_16x16x32_bf16 v[120:123], v[116:119], v[60:63], v[120:123]
  v_bitop3_b32 v48, v48, v60, s57 bitop3:0xf6
  v_bitop3_b32 v48, v48, v62, s57 bitop3:0xf6
  s_waitcnt vmcnt(0)
  v_mfma_f32_16x16x32_bf16 v[120:123], v[116:119], v[64:67], v[120:123]
  v_bitop3_b32 v48, v48, v64, s57 bitop3:0xf6
  v_bitop3_b32 v48, v48, v66, s57 bitop3:0xf6
  v_and_b32 v48, 1, v48
  v_cmp_ne_u32 vcc, 0, v48
  s_cbranch_vccnz T_p1re_123
T_p1ok_124:
  s_nop 2
  v_add_f32_dpp v120, v120, v120 row_ror:8 row_mask:0xf bank_mask:0xf
  v_add_f32_dpp v121, v121, v121 row_ror:8 row_mask:0xf bank_mask:0xf
  v_cvt_pk_bf16_f32 v48, v120, v121
  buffer_store_dword v48, v8, s[4:7], s35 offen sc1
  buffer_store_dword v49, v8, s[4:7], s26 offen sc1
  s_barrier
  ds_read_b128 v[28:31], v2 offset:17408
  ds_read_b128 v[32:35], v2 offset:21504
  ds_read_b128 v[36:39], v2 offset:8192
  ds_read_b128 v[40:43], v2 offset:9216
  ds_read_b128 v[44:47], v2 offset:10240
  ds_read_b128 v[48:51], v2 offset:11264
  buffer_load_dwordx4 v[124:127], v2, s[4:7], s24 offen offset:1024 sc1
  buffer_load_dwordx4 v[116:119], v2, s[4:7], s25 offen offset:1024 sc1
  ds_read_b128 v[52:55], v2 offset:12288
  ds_read_b128 v[56:59], v2 offset:13312
  ds_read_b128 v[60:63], v2 offset:14336
  ds_read_b128 v[64:67], v2 offset:15360
  buffer_load_dwordx4 v[124:127], v2, s[4:7], s24 offen offset:1024 sc1
  buffer_load_dwordx4 v[116:119], v2, s[4:7], s25 offen offset:1024 sc1
  s_add_u32 s14, s14, 1
  s_cmp_ge_i32 s14, s30
  s_cbranch_scc1 T_kvw_117
T_kvb_118:
  s_mov_b32 s19, 0
  s_cmp_lg_u32 s14, 63
  s_cbranch_scc1 T_loop_113
  s_branch T_last_119
T_p1re_123:
  s_mov_b64 exec, vcc
  buffer_load_dwordx4 v[52:55], v2, s[4:7], s22 offen offset:0 sc1
  buffer_load_dwordx4 v[56:59], v2, s[4:7], s22 offen offset:1024 sc1
  buffer_load_dwordx4 v[60:63], v2, s[4:7], s22 offen offset:2048 sc1
  buffer_load_dwordx4 v[64:67], v2, s[4:7], s22 offen offset:3072 sc1
  s_mov_b64 exec, -1
  s_add_u32 s19, s19, 1
  s_cmp_gt_u32 s19, 32768
  s_cbranch_scc1 M_exit
  s_waitcnt vmcnt(3)
  v_mfma_f32_16x16x32_bf16 v[120:123], v[116:119], v[52:55], 0
  v_xor_b32 v48, s57, v52
  v_bitop3_b32 v48, v48, v54, s57 bitop3:0xf6
  s_waitcnt vmcnt(2)
  v_mfma_f32_16x16x32_bf16 v[120:123], v[116:119], v[56:59], v[120:123]
  v_bitop3_b32 v48, v48, v56, s57 bitop3:0xf6
  v_bitop3_b32 v48, v48, v58, s57 bitop3:0xf6
  s_waitcnt vmcnt(1)
  v_mfma_f32_16x16x32_bf16 v[120:123], v[116:119], v[60:63], v[120:123]
  v_bitop3_b32 v48, v48, v60, s57 bitop3:0xf6
  v_bitop3_b32 v48, v48, v62, s57 bitop3:0xf6
  s_waitcnt vmcnt(0)
  v_mfma_f32_16x16x32_bf16 v[120:123], v[116:119], v[64:67], v[120:123]
  v_bitop3_b32 v48, v48, v64, s57 bitop3:0xf6
  v_bitop3_b32 v48, v48, v66, s57 bitop3:0xf6
  v_and_b32 v48, 1, v48
  v_cmp_ne_u32 vcc, 0, v48
  s_cbranch_vccnz T_p1re_123
  s_branch T_p1ok_124
T_kvw_117:
  s_mov_b32 s19, 0
  s_branch T_kvok_126
T_kv_125:
  s_sleep 4
  s_add_u32 s19, s19, 1
  s_cmp_gt_u32 s19, 32768
  s_cbranch_scc1 M_exit
T_kvok_126:
  s_add_u32 s39, s99, 128
  s_mov_b32 s38, 0
  s_mov_b32 s37, 0
  s_atomic_or s38, s[58:59], s99 glc
  s_atomic_or s37, s[58:59], s39 glc
  s_waitcnt lgkmcnt(0)
  s_lshl_b32 s38, s38, 1
  s_lshl1_add_u32 s37, s37, 1
  s_min_u32 s38, s38, s37
  s_cmp_ge_u32 s38, 64
  s_cselect_b32 s38, 100, s38
  s_sub_u32 s38, s38, 1
  s_max_i32 s30, s30, s38
  s_cmp_ge_i32 s14, s30
  s_cbranch_scc1 T_kv_125
  s_branch T_kvb_118
T_slow_120:
  s_nop 7
  v_max3_f32 v100, v16, v17, v18
  v_max3_f32 v100, v100, v19, v20
  v_max3_f32 v100, v100, v21, v22
  v_max3_f32 v100, v100, v23, v112
  v_max3_f32 v100, v100, v113, v114
  v_max_f32 v100, v100, v115
  v_mov_b32 v101, v100
  s_nop 1
  v_permlane32_swap_b32 v100, v101
  s_nop 1
  v_max_f32 v100, v100, v101
  v_mov_b32 v101, v100
  s_nop 1
  v_permlane16_swap_b32 v100, v101
  s_nop 1
  v_max_f32 v100, v100, v101
  v_sub_f32 v16, v16, v100
  v_sub_f32 v17, v17, v100
  v_sub_f32 v18, v18, v100
  v_sub_f32 v19, v19, v100
  v_exp_f32 v16, v16
  v_exp_f32 v17, v17
  v_exp_f32 v18, v18
  v_exp_f32 v19, v19
  v_sub_f32 v20, v20, v100
  v_sub_f32 v21, v21, v100
  v_sub_f32 v22, v22, v100
  v_sub_f32 v23, v23, v100
  v_exp_f32 v20, v20
  v_exp_f32 v21, v21
  v_exp_f32 v22, v22
  v_exp_f32 v23, v23
  v_sub_f32 v112, v112, v100
  v_sub_f32 v113, v113, v100
  v_sub_f32 v114, v114, v100
  v_sub_f32 v115, v115, v100
  v_exp_f32 v112, v112
  v_exp_f32 v113, v113
  v_exp_f32 v114, v114
  v_exp_f32 v115, v115
  s_nop 0
  v_cvt_pk_bf16_f32 v44, v16, v17
  v_cvt_pk_bf16_f32 v45, v18, v19
  v_cvt_pk_bf16_f32 v46, v20, v21
  v_cvt_pk_bf16_f32 v47, v22, v23
  v_cvt_pk_bf16_f32 v84, v112, v113
  v_cvt_pk_bf16_f32 v85, v114, v115
  v_cndmask_b32 v48, v84, 0, s[16:17]
  v_cndmask_b32 v49, v85, 0, s[16:17]
  v_cndmask_b32 v50, 0, v84, s[16:17]
  v_cndmask_b32 v51, 0, v85, s[16:17]
  s_nop 1
  v_mfma_f32_16x16x16_bf16 v[88:91], v[12:13], v[48:49], 0
  v_mfma_f32_16x16x16_bf16 v[24:27], v[120:121], v[48:49], 0
  v_mfma_f32_16x16x16_bf16 v[116:119], v[120:121], v[50:51], 0
  v_mfma_f32_16x16x32_bf16 v[88:91], v[12:15], v[44:47], v[88:91]
  v_mfma_f32_16x16x32_bf16 v[24:27], v[28:31], v[44:47], v[24:27]
  v_mfma_f32_16x16x32_bf16 v[116:119], v[32:35], v[44:47], v[116:119]
  s_nop 7
  s_nop 1
  s_mov_b32 s96, -1
  s_branch T_back_121
.p2align 6
T_retry_127:
  s_mov_b64 exec, vcc
  buffer_load_dwordx4 v[124:127], v2, s[4:7], s24 offen offset:1024 sc1
  buffer_load_dwordx4 v[116:119], v2, s[4:7], s25 offen offset:1024 sc1
  s_mov_b64 exec, -1
  s_add_u32 s19, s19, 1
  s_cmp_gt_u32 s19, 32768
  s_cbranch_scc1 M_exit
T_last_119:
  s_waitcnt vmcnt(3) lgkmcnt(0)
  v_max3_u32 v123, v124, v125, v126
  v_max_u32 v123, v123, v127
  v_mov_b32_dpp v120, v124 row_ror:8 row_mask:0xf bank_mask:0xf
  v_mov_b32_dpp v121, v125 row_ror:8 row_mask:0xf bank_mask:0xf
  s_waitcnt vmcnt(2)
  v_max3_u32 v123, v123, v116, v117
  v_max3_u32 v123, v123, v118, v119
  v_cmp_eq_u32 vcc, -1, v123
  s_cbranch_vccnz T_retry_127
  v_smfmac_f32_16x16x64_bf16 v[20:23], v[124:127], v[76:83], v0
  ds_write_b128 v2, v[124:127] offset:1024
  v_mov_b32_dpp v122, v126 row_ror:8 row_mask:0xf bank_mask:0xf
  v_mov_b32_dpp v123, v127 row_ror:8 row_mask:0xf bank_mask:0xf
  v_smfmac_f32_16x16x64_bf16 v[24:27], v[124:127], v[84:91], v0
  ds_write_b128 v2, v[116:119] offset:5120
  v_mov_b32_dpp v84, v116 row_ror:8 row_mask:0xf bank_mask:0xf
  v_smfmac_f32_16x16x64_bf16 v[20:23], v[120:123], v[100:107], v0
  ds_read_b128 v[68:71], v4 offset:12288
  v_mov_b32_dpp v85, v117 row_ror:8 row_mask:0xf bank_mask:0xf
  v_smfmac_f32_16x16x64_bf16 v[24:27], v[120:123], v[108:115], v0
  ds_read_b128 v[72:75], v4 offset:13312
  v_mov_b32_dpp v86, v118 row_ror:8 row_mask:0xf bank_mask:0xf
  ds_read_b128 v[76:79], v4 offset:14336
  v_mov_b32_dpp v87, v119 row_ror:8 row_mask:0xf bank_mask:0xf
  v_smfmac_f32_16x16x64_bf16 v[20:23], v[116:119], v[240:247], v0
  s_waitcnt lgkmcnt(3)
  s_barrier
  ds_read_b128 v[100:103], v2 offset:0
  v_smfmac_f32_16x16x64_bf16 v[24:27], v[116:119], a[0:7], v0
  ds_read_b128 v[120:123], v1 offset:0
  v_smfmac_f32_16x16x64_bf16 v[20:23], v[84:87], v[248:255], v0
  ds_read_b128 v[80:83], v4 offset:15360
  v_smfmac_f32_16x16x64_bf16 v[24:27], v[84:87], a[8:15], v0
  s_waitcnt lgkmcnt(2)
  ds_read_b128 v[92:95], v2 offset:3072
  v_smfmac_f32_16x16x64_bf16 v[20:23], v[100:103], v[144:151], v0
  ds_read_b128 v[96:99], v1 offset:3072
  v_smfmac_f32_16x16x64_bf16 v[24:27], v[100:103], v[68:75], v0
  s_waitcnt vmcnt(0) lgkmcnt(3)
  ds_read_b128 v[116:119], v2 offset:2048
  ds_read_b128 v[124:127], v1 offset:2048
  v_smfmac_f32_16x16x64_bf16 v[20:23], v[120:123], v[152:159], v0
  s_waitcnt lgkmcnt(4)
  ds_read_b128 v[104:107], v2 offset:4096
  v_smfmac_f32_16x16x64_bf16 v[24:27], v[120:123], v[76:83], v0
  s_waitcnt lgkmcnt(4)
  ds_read_b128 v[108:111], v1 offset:4096
  ds_read_b128 v[112:115], v2 offset:7168
  ds_read_b128 v[84:87], v1 offset:7168
  ds_read_b128 v[88:91], v2 offset:6144
  ds_read_b128 v[100:103], v1 offset:6144
  ds_read_b128 v[68:71], v4 offset:16384
  ds_read_b128 v[72:75], v4 offset:17408
  ds_read_b128 v[76:79], v4 offset:18432
  ds_read_b128 v[80:83], v4 offset:19456
  v_smfmac_f32_16x16x64_bf16 v[20:23], v[92:95], v[176:183], v0
  s_waitcnt lgkmcnt(12)
  v_smfmac_f32_16x16x64_bf16 v[20:23], v[96:99], v[184:191], v0
  s_waitcnt lgkmcnt(2)
  v_smfmac_f32_16x16x64_bf16 v[20:23], v[116:119], v[68:75], v0
  s_waitcnt lgkmcnt(0)
  ds_read_b128 v[68:71], v4 offset:20480
  v_smfmac_f32_16x16x64_bf16 v[20:23], v[124:127], v[76:83], v0
  ds_read_b128 v[72:75], v4 offset:21504
  v_smfmac_f32_16x16x64_bf16 v[20:23], v[104:107], a[32:39], v0
  ds_read_b128 v[76:79], v4 offset:22528
  v_smfmac_f32_16x16x64_bf16 v[20:23], v[108:111], a[40:47], v0
  ds_read_b128 v[80:83], v4 offset:23552
  v_smfmac_f32_16x16x64_bf16 v[20:23], v[112:115], a[80:87], v0
  v_smfmac_f32_16x16x64_bf16 v[20:23], v[84:87], a[88:95], v0
  v_smfmac_f32_16x16x64_bf16 v[20:23], v[88:91], a[128:135], v0
  v_smfmac_f32_16x16x64_bf16 v[20:23], v[100:103], a[136:143], v0
  s_waitcnt lgkmcnt(2)
  v_smfmac_f32_16x16x64_bf16 v[24:27], v[92:95], v[68:75], v0
  s_waitcnt lgkmcnt(0)
  v_smfmac_f32_16x16x64_bf16 v[24:27], v[96:99], v[76:83], v0
  v_smfmac_f32_16x16x64_bf16 v[24:27], v[116:119], v[208:215], v0
  v_smfmac_f32_16x16x64_bf16 v[24:27], v[124:127], v[216:223], v0
  v_smfmac_f32_16x16x64_bf16 v[24:27], v[104:107], a[48:55], v0
  v_smfmac_f32_16x16x64_bf16 v[24:27], v[108:111], a[56:63], v0
  v_smfmac_f32_16x16x64_bf16 v[24:27], v[112:115], a[96:103], v0
  v_smfmac_f32_16x16x64_bf16 v[24:27], v[84:87], a[104:111], v0
  v_smfmac_f32_16x16x64_bf16 v[24:27], v[88:91], a[144:151], v0
  v_smfmac_f32_16x16x64_bf16 v[24:27], v[100:103], a[152:159], v0
  v_cvt_pk_bf16_f32 v122, v20, v21
  v_cvt_pk_bf16_f32 v123, v22, v23
  s_nop 5
  v_cvt_pk_bf16_f32 v120, v24, v25
  v_cvt_pk_bf16_f32 v121, v26, v27
  buffer_store_dwordx4 v[120:123], v2, s[4:7], s29 offen offset:1024 sc1
  s_branch M_tdone
T_w_92:
  s_mov_b32 s19, 0
  s_add_u32 s14, s14, 1
  s_and_b32 s57, s14, 1
  v_mov_b64 v[16:17], 0
  v_mov_b64 v[18:19], 0
  v_mov_b64 v[20:21], 0
  v_mov_b64 v[22:23], 0
  v_mov_b64 v[24:25], 0
  v_mov_b64 v[26:27], 0
  buffer_load_dwordx4 v[124:127], v2, s[4:7], s24 offen offset:2048 sc1
  buffer_load_dwordx4 v[116:119], v2, s[4:7], s25 offen offset:2048 sc1
  buffer_load_dwordx4 v[124:127], v2, s[4:7], s24 offen offset:2048 sc1
  buffer_load_dwordx4 v[116:119], v2, s[4:7], s25 offen offset:2048 sc1
  s_branch T_loop_132
.p2align 6
T_retry_133:
  s_mov_b64 exec, vcc
  buffer_load_dwordx4 v[124:127], v2, s[4:7], s24 offen offset:2048 sc1
  buffer_load_dwordx4 v[116:119], v2, s[4:7], s25 offen offset:2048 sc1
  s_mov_b64 exec, -1
  s_add_u32 s19, s19, 1
  s_cmp_gt_u32 s19, 32768
  s_cbranch_scc1 M_exit
  s_nop 0
  v_mov_b64 v[16:17], 0
  v_mov_b64 v[18:19], 0
T_loop_132:
  s_waitcnt vmcnt(3) lgkmcnt(0)
  v_max3_u32 v123, v124, v125, v126
  v_max_u32 v123, v123, v127
  v_mov_b32_dpp v120, v124 row_ror:8 row_mask:0xf bank_mask:0xf
  v_mov_b32_dpp v121, v125 row_ror:8 row_mask:0xf bank_mask:0xf
  s_waitcnt vmcnt(2)
  v_max3_u32 v123, v123, v116, v117
  v_max3_u32 v123, v123, v118, v119
  v_cmp_eq_u32 vcc, -1, v123
  v_smfmac_f32_16x16x64_bf16 v[16:19], v[124:127], v[68:75], v0
  s_cbranch_vccnz T_retry_133
  ds_write_b128 v2, v[124:127] offset:2048
  v_mov_b32_dpp v122, v126 row_ror:8 row_mask:0xf bank_mask:0xf
  v_smfmac_f32_16x16x64_bf16 v[20:23], v[124:127], v[76:83], v0
  s_and_b32 s57, s14, 1
  v_mov_b32_dpp v123, v127 row_ror:8 row_mask:0xf bank_mask:0xf
  v_smfmac_f32_16x16x64_bf16 v[24:27], v[124:127], v[84:91], v0
  s_and_b32 s36, s14, 3
  ds_write_b128 v2, v[116:119] offset:6144
  v_smfmac_f32_16x16x64_bf16 v[16:19], v[120:123], v[92:99], v0
  s_lshl_b32 s36, s36, 13
  v_mov_b32_dpp v84, v116 row_ror:8 row_mask:0xf bank_mask:0xf
  v_smfmac_f32_16x16x64_bf16 v[20:23], v[120:123], v[100:107], v0
  s_add_u32 s26, s36, s23
  ds_read_b128 v[68:71], v4 offset:12288
  v_mov_b32_dpp v85, v117 row_ror:8 row_mask:0xf bank_mask:0xf
  v_smfmac_f32_16x16x64_bf16 v[24:27], v[120:123], v[108:115], v0
  s_add_u32 s36, s36, 8192
  ds_read_b128 v[72:75], v4 offset:13312
  v_mov_b32_dpp v86, v118 row_ror:8 row_mask:0xf bank_mask:0xf
  v_smfmac_f32_16x16x64_bf16 v[16:19], v[116:119], v[224:231], v0
  s_and_b32 s36, s36, 0x7fff
  ds_read_b128 v[76:79], v4 offset:14336
  v_mov_b32_dpp v87, v119 row_ror:8 row_mask:0xf bank_mask:0xf
  v_smfmac_f32_16x16x64_bf16 v[20:23], v[116:119], v[240:247], v0
  s_waitcnt lgkmcnt(3)
  s_barrier
  ds_read_b128 v[100:103], v2 offset:3072
  v_smfmac_f32_16x16x64_bf16 v[24:27], v[116:119], a[0:7], v0
  s_mov_b32 m0, s31
  ds_read_b128 v[120:123], v1 offset:3072
  v_smfmac_f32_16x16x64_bf16 v[16:19], v[84:87], v[232:239], v0
  v_smfmac_f32_16x16x64_bf16 v[20:23], v[84:87], v[248:255], v0
  ds_read_b128 v[80:83], v4 offset:15360
  buffer_load_dwordx4 v9, s[4:7], s27 offen sc1 lds
  v_smfmac_f32_16x16x64_bf16 v[24:27], v[84:87], a[8:15], v0
  s_waitcnt lgkmcnt(2)
  s_mov_b32 m0, s32
  v_smfmac_f32_16x16x64_bf16 v[16:19], v[100:103], v[128:135], v0
  ds_read_b128 v[92:95], v2 offset:0
  v_smfmac_f32_16x16x64_bf16 v[20:23], v[100:103], v[144:151], v0
  ds_read_b128 v[96:99], v1 offset:0
  v_smfmac_f32_16x16x64_bf16 v[24:27], v[100:103], v[68:75], v0
  s_waitcnt vmcnt(1) lgkmcnt(3)
  ds_read_b128 v[116:119], v2 offset:1024
  buffer_load_dwordx4 v9, s[4:7], s27 offen offset:128 sc1 lds
  v_smfmac_f32_16x16x64_bf16 v[16:19], v[120:123], v[136:143], v0
  ds_read_b128 v[124:127], v1 offset:1024
  s_mov_b32 m0, s33
  v_smfmac_f32_16x16x64_bf16 v[20:23], v[120:123], v[152:159], v0
  s_waitcnt lgkmcnt(4)
  ds_read_b128 v[104:107], v2 offset:7168
  v_smfmac_f32_16x16x64_bf16 v[24:27], v[120:123], v[76:83], v0
  s_waitcnt lgkmcnt(4)
  ds_read_b128 v[108:111], v1 offset:7168
  v_smfmac_f32_16x16x64_bf16 v[16:19], v[92:95], v[160:167], v0
  s_waitcnt lgkmcnt(4)
  ds_read_b128 v[112:115], v2 offset:4096
  v_mov_b32 v122, s98
  buffer_load_dwordx4 v10, s[4:7], s28 offen sc1 lds
  v_smfmac_f32_16x16x64_bf16 v[16:19], v[96:99], v[168:175], v0
  s_waitcnt lgkmcnt(4)
  ds_read_b128 v[84:87], v1 offset:4096
  s_mov_b32 m0, s34
  v_smfmac_f32_16x16x64_bf16 v[16:19], v[116:119], v[192:199], v0
  s_waitcnt lgkmcnt(4)
  ds_read_b128 v[88:91], v2 offset:5120
  v_smfmac_f32_16x16x64_bf16 v[16:19], v[124:127], v[200:207], v0
  s_waitcnt lgkmcnt(4)
  ds_read_b128 v[100:103], v1 offset:5120
  v_smfmac_f32_16x16x64_bf16 v[16:19], v[104:107], a[16:23], v0
  s_waitcnt lgkmcnt(4)
  ds_read_b128 v[68:71], v4 offset:16384
  buffer_load_dwordx4 v10, s[4:7], s28 offen offset:256 sc1 lds
  v_smfmac_f32_16x16x64_bf16 v[16:19], v[108:111], a[24:31], v0
  s_waitcnt lgkmcnt(4)
  ds_read_b128 v[72:75], v4 offset:17408
  v_smfmac_f32_16x16x64_bf16 v[16:19], v[112:115], a[64:71], v0
  s_waitcnt lgkmcnt(4)
  ds_read_b128 v[76:79], v4 offset:18432
  v_smfmac_f32_16x16x64_bf16 v[16:19], v[84:87], a[72:79], v0
  s_waitcnt lgkmcnt(4)
  ds_read_b128 v[80:83], v4 offset:19456
  v_smfmac_f32_16x16x64_bf16 v[16:19], v[88:91], a[112:119], v0
  s_waitcnt lgkmcnt(4)
  buffer_store_dword v122, v3, s[4:7], s15 offen sc1
  v_smfmac_f32_16x16x64_bf16 v[16:19], v[100:103], a[120:127], v0
  s_add_u32 s98, s14, 1
  s_add_u32 s24, s36, 145752064
  s_add_u32 s25, s36, 145756160
  v_smfmac_f32_16x16x64_bf16 v[20:23], v[92:95], v[176:183], v0
  s_add_u32 s35, s36, s23
  v_smfmac_f32_16x16x64_bf16 v[20:23], v[96:99], v[184:191], v0
  s_waitcnt lgkmcnt(2)
  v_smfmac_f32_16x16x64_bf16 v[20:23], v[116:119], v[68:75], v0
  s_waitcnt lgkmcnt(0)
  ds_read_b128 v[68:71], v4 offset:20480
  v_mul_f32 v16, s18, v16
  v_smfmac_f32_16x16x64_bf16 v[20:23], v[124:127], v[76:83], v0
  ds_read_b128 v[72:75], v4 offset:21504
  v_mul_f32 v17, s18, v17
  v_smfmac_f32_16x16x64_bf16 v[20:23], v[104:107], a[32:39], v0
  ds_read_b128 v[76:79], v4 offset:22528
  v_mul_f32 v18, s18, v18
  v_smfmac_f32_16x16x64_bf16 v[20:23], v[108:111], a[40:47], v0
  ds_read_b128 v[80:83], v4 offset:23552
  v_mul_f32 v19, s18, v19
  v_smfmac_f32_16x16x64_bf16 v[20:23], v[112:115], a[80:87], v0
  v_cvt_pk_bf16_f32 v120, v16, v17
  v_smfmac_f32_16x16x64_bf16 v[20:23], v[84:87], a[88:95], v0
  v_cvt_pk_bf16_f32 v121, v18, v19
  v_smfmac_f32_16x16x64_bf16 v[20:23], v[88:91], a[128:135], v0
  ds_write_b64 v5, v[120:121] offset:24576
  v_smfmac_f32_16x16x64_bf16 v[20:23], v[100:103], a[136:143], v0
  s_waitcnt lgkmcnt(3)
  v_smfmac_f32_16x16x64_bf16 v[24:27], v[92:95], v[68:75], v0
  s_waitcnt lgkmcnt(1)
  v_mov_b64 v[92:93], 0
  v_smfmac_f32_16x16x64_bf16 v[24:27], v[96:99], v[76:83], v0
  s_nop 1
  v_cvt_pk_bf16_f32 v122, v20, v21
  v_cvt_pk_bf16_f32 v123, v22, v23
  v_smfmac_f32_16x16x64_bf16 v[24:27], v[116:119], v[208:215], v0
  ds_write_b64 v5, v[122:123] offset:26880
  v_mov_b64 v[94:95], 0
  v_smfmac_f32_16x16x64_bf16 v[24:27], v[124:127], v[216:223], v0
  s_waitcnt lgkmcnt(1)
  s_barrier
  ds_read_b64_tr_b16 v[68:69], v6 offset:24576
  v_smfmac_f32_16x16x64_bf16 v[24:27], v[104:107], a[48:55], v0
  s_add_u32 s27, s27, 8192
  ds_read_b64_tr_b16 v[70:71], v6 offset:24640
  ds_read_b64_tr_b16 v[72:73], v6 offset:24832
  v_smfmac_f32_16x16x64_bf16 v[24:27], v[108:111], a[56:63], v0
  s_add_u32 s28, s28, 8192
  ds_read_b64_tr_b16 v[74:75], v6 offset:24896
  ds_read_b64_tr_b16 v[76:77], v6 offset:25088
  v_smfmac_f32_16x16x64_bf16 v[24:27], v[112:115], a[96:103], v0
  s_nop 0
  ds_read_b64_tr_b16 v[78:79], v6 offset:25152
  ds_read_b64_tr_b16 v[80:81], v6 offset:25344
  v_smfmac_f32_16x16x64_bf16 v[24:27], v[84:87], a[104:111], v0
  ds_read_b64_tr_b16 v[82:83], v6 offset:25408
  v_mov_b64 v[96:97], 0
  v_smfmac_f32_16x16x64_bf16 v[24:27], v[88:91], a[144:151], v0
  s_waitcnt lgkmcnt(8)
  s_barrier
  ds_read_b64_tr_b16 v[116:117], v6 offset:26880
  v_smfmac_f32_16x16x64_bf16 v[24:27], v[100:103], a[152:159], v0
  s_waitcnt lgkmcnt(7)
  ds_read_b64_tr_b16 v[118:119], v6 offset:26944
  v_mfma_f32_16x16x32_bf16 v[16:19], v[36:39], v[68:71], 0
  s_waitcnt lgkmcnt(6)
  ds_read_b64_tr_b16 v[124:125], v6 offset:27136
  ds_read_b64_tr_b16 v[126:127], v6 offset:27200
  v_mfma_f32_16x16x32_bf16 v[16:19], v[40:43], v[72:75], v[16:19]
  s_waitcnt lgkmcnt(6)
  ds_read_b64_tr_b16 v[104:105], v6 offset:27392
  ds_read_b64_tr_b16 v[106:107], v6 offset:27456
  v_mfma_f32_16x16x32_bf16 v[16:19], v[44:47], v[76:79], v[16:19]
  s_waitcnt lgkmcnt(6)
  ds_read_b64_tr_b16 v[108:109], v6 offset:27648
  ds_read_b64_tr_b16 v[110:111], v6 offset:27712
  v_mfma_f32_16x16x32_bf16 v[16:19], v[48:51], v[80:83], v[16:19]
  s_waitcnt lgkmcnt(6)
  v_cvt_pk_bf16_f32 v120, v24, v25
  v_cvt_pk_bf16_f32 v121, v26, v27
  v_mfma_f32_16x16x32_bf16 v[112:115], v[116:119], v[68:71], 0
  s_waitcnt lgkmcnt(4)
  v_mov_b64 v[98:99], 0
  v_mfma_f32_16x16x32_bf16 v[112:115], v[124:127], v[72:75], v[112:115]
  s_waitcnt lgkmcnt(2)
  v_mov_b64 v[36:37], 0
  v_exp_f32 v100, v16
  v_mfma_f32_16x16x32_bf16 v[112:115], v[104:107], v[76:79], v[112:115]
  s_waitcnt lgkmcnt(0)
  buffer_store_dwordx4 v[120:123], v2, s[4:7], s29 offen offset:2048 sc1
  v_exp_f32 v101, v17
  v_mfma_f32_16x16x32_bf16 v[112:115], v[108:111], v[80:83], v[112:115]
  v_exp_f32 v102, v18
  v_mfma_f32_16x16x32_bf16 v[20:23], v[52:55], v[68:71], 0
  v_exp_f32 v103, v19
  v_mfma_f32_16x16x32_bf16 v[20:23], v[56:59], v[72:75], v[20:23]
  v_cvt_pk_bf16_f32 v44, v100, v101
  v_cvt_pk_bf16_f32 v45, v102, v103
  v_mfma_f32_16x16x32_bf16 v[20:23], v[60:63], v[76:79], v[20:23]
  s_add_u32 s29, s29, 131072
  v_exp_f32 v100, v112
  v_mfma_f32_16x16x32_bf16 v[20:23], v[64:67], v[80:83], v[20:23]
  v_exp_f32 v101, v113
  v_exp_f32 v102, v114
  v_exp_f32 v103, v115
  v_cvt_pk_bf16_f32 v84, v100, v101
  v_cvt_pk_bf16_f32 v85, v102, v103
  v_cndmask_b32 v48, v84, 0, s[16:17]
  v_cndmask_b32 v49, v85, 0, s[16:17]
  v_cndmask_b32 v50, 0, v84, s[16:17]
  v_cndmask_b32 v51, 0, v85, s[16:17]
  v_exp_f32 v100, v20
  v_mfma_f32_16x16x16_bf16 v[88:91], v[12:13], v[48:49], 0
  v_exp_f32 v101, v21
  v_mfma_f32_16x16x16_bf16 v[24:27], v[120:121], v[48:49], 0
  v_exp_f32 v102, v22
  v_mfma_f32_16x16x16_bf16 v[116:119], v[120:121], v[50:51], 0
  v_exp_f32 v103, v23
  v_cvt_pk_bf16_f32 v46, v100, v101
  v_cvt_pk_bf16_f32 v47, v102, v103
  v_mov_b64 v[38:39], 0
  s_nop 0
  v_mfma_f32_16x16x32_bf16 v[88:91], v[12:15], v[44:47], v[88:91]
  v_mov_b64 v[40:41], 0
  v_mov_b64 v[42:43], 0
  v_mfma_f32_16x16x32_bf16 v[24:27], v[28:31], v[44:47], v[24:27]
  ds_read_b128 v[52:55], v4 offset:24576
  ds_read_b128 v[56:59], v4 offset:25600
  v_mfma_f32_16x16x32_bf16 v[116:119], v[32:35], v[44:47], v[116:119]
  s_nop 1
T_back_140:
  v_rcp_f32 v89, v88
  v_subrev_u32 v100, s54, v88
  v_cmp_le_u32 vcc, s96, v100
  v_mul_f32 v24, v89, v24
  v_mul_f32 v25, v89, v25
  v_cvt_pk_bf16_f32 v124, v24, v25
  v_pk_mul_f32 v[26:27], v[26:27], v[88:89] op_sel:[0,1] op_sel_hi:[1,1]
  v_pk_mul_f32 v[116:117], v[116:117], v[88:89] op_sel:[0,1] op_sel_hi:[1,1]
  v_pk_mul_f32 v[118:119], v[118:119], v[88:89] op_sel:[0,1] op_sel_hi:[1,1]
  v_cvt_pk_bf16_f32 v125, v26, v27
  v_cvt_pk_bf16_f32 v126, v116, v117
  v_cvt_pk_bf16_f32 v127, v118, v119
  ds_write_b128 v11, v[124:127] offset:30208
  s_cbranch_vccnz T_slow_139
  v_smfmac_f32_16x16x64_bf16 v[92:95], v[124:127], a[160:167], v0
  s_mov_b32 s96, s55
  v_smfmac_f32_16x16x64_bf16 v[96:99], v[124:127], a[168:175], v0
  v_smfmac_f32_16x16x64_bf16 v[36:39], v[124:127], a[176:183], v0
  s_waitcnt lgkmcnt(0)
  s_barrier
  ds_read_b128 v[104:107], v11 offset:30720
  ds_read_b128 v[108:111], v11 offset:29184
  ds_read_b128 v[68:71], v11 offset:29696
  v_smfmac_f32_16x16x64_bf16 v[40:43], v[124:127], a[184:191], v0
  s_waitcnt lgkmcnt(2)
  v_smfmac_f32_16x16x64_bf16 v[92:95], v[104:107], a[192:199], v0
  s_waitcnt lgkmcnt(1)
  ds_read_b128 v[76:79], v4 offset:28672
  v_smfmac_f32_16x16x64_bf16 v[92:95], v[108:111], a[224:231], v0
  s_waitcnt lgkmcnt(1)
  ds_read_b128 v[80:83], v4 offset:29696
  v_smfmac_f32_16x16x64_bf16 v[92:95], v[68:71], a[240:247], v0
  ds_read_b128 v[60:63], v4 offset:26624
  v_smfmac_f32_16x16x64_bf16 v[96:99], v[104:107], a[200:207], v0
  ds_read_b128 v[64:67], v4 offset:27648
  v_smfmac_f32_16x16x64_bf16 v[96:99], v[108:111], a[232:239], v0
  ds_read_b128 v[28:31], v4 offset:30720
  s_nop 0
  v_cvt_pk_bf16_f32 v16, v92, v93
  v_cvt_pk_bf16_f32 v17, v94, v95
  v_bfi_b32 v16, 1, s57, v16
  v_smfmac_f32_16x16x64_bf16 v[96:99], v[68:71], a[248:255], v0
  buffer_store_dwordx2 v[16:17], v7, s[4:7], s20 offen offset:0 sc1
  v_smfmac_f32_16x16x64_bf16 v[36:39], v[104:107], a[208:215], v0
  ds_read_b128 v[32:35], v4 offset:31744
  v_smfmac_f32_16x16x64_bf16 v[36:39], v[108:111], v[52:59], v0
  s_waitcnt lgkmcnt(4)
  s_nop 0
  v_cvt_pk_bf16_f32 v18, v96, v97
  v_cvt_pk_bf16_f32 v19, v98, v99
  v_bfi_b32 v18, 1, s57, v18
  v_smfmac_f32_16x16x64_bf16 v[36:39], v[68:71], v[76:83], v0
  buffer_store_dwordx2 v[18:19], v7, s[4:7], s20 offen offset:64 sc1
  v_smfmac_f32_16x16x64_bf16 v[40:43], v[104:107], a[216:223], v0
  s_waitcnt lgkmcnt(2)
  v_smfmac_f32_16x16x64_bf16 v[40:43], v[108:111], v[60:67], v0
  s_waitcnt lgkmcnt(0)
  s_nop 0
  v_cvt_pk_bf16_f32 v20, v36, v37
  v_cvt_pk_bf16_f32 v21, v38, v39
  v_bfi_b32 v20, 1, s57, v20
  v_smfmac_f32_16x16x64_bf16 v[40:43], v[68:71], v[28:35], v0
  buffer_store_dwordx2 v[20:21], v7, s[4:7], s21 offen offset:0 sc1
  s_nop 6
  v_cvt_pk_bf16_f32 v22, v40, v41
  v_cvt_pk_bf16_f32 v23, v42, v43
  v_bfi_b32 v22, 1, s57, v22
  buffer_store_dwordx2 v[22:23], v7, s[4:7], s21 offen offset:64 sc1
  ds_read_b128 v[68:71], v4 offset:0
  ds_read_b128 v[72:75], v4 offset:1024
  ds_read_b128 v[76:79], v4 offset:4096
  ds_read_b128 v[80:83], v4 offset:5120
  ds_read_b128 v[84:87], v4 offset:8192
  ds_read_b128 v[88:91], v4 offset:9216
  ds_read_b128 v[92:95], v4 offset:2048
  ds_read_b128 v[96:99], v4 offset:3072
  ds_read_b128 v[100:103], v4 offset:6144
  ds_read_b128 v[104:107], v4 offset:7168
  ds_read_b128 v[108:111], v4 offset:10240
  ds_read_b128 v[112:115], v4 offset:11264
  v_mov_b64 v[16:17], 0
  v_mov_b64 v[18:19], 0
  v_mov_b64 v[20:21], 0
  v_mov_b64 v[22:23], 0
  v_mov_b64 v[24:25], 0
  v_mov_b64 v[26:27], 0
  ds_read_b64 v[44:45], v2 offset:32256
  s_waitcnt lgkmcnt(0)
  v_readfirstlane_b32 s38, v44
  v_readfirstlane_b32 s37, v45
  s_nop 0
  s_lshl_b32 s38, s38, 1
  s_lshl1_add_u32 s37, s37, 1
  s_min_u32 s38, s38, s37
  s_cmp_ge_u32 s38, 64
  s_cselect_b32 s38, 100, s38
  s_sub_u32 s38, s38, 1
  s_max_i32 s30, s30, s38
  s_waitcnt vmcnt(4)
  s_barrier
  ds_read_b128 v[28:31], v2 offset:18432
  ds_read_b128 v[32:35], v2 offset:22528
  ds_read_b128 v[36:39], v2 offset:8192
  ds_read_b128 v[40:43], v2 offset:9216
  ds_read_b128 v[44:47], v2 offset:10240
  ds_read_b128 v[48:51], v2 offset:11264
  buffer_load_dwordx4 v[124:127], v2, s[4:7], s24 offen offset:2048 sc1
  buffer_load_dwordx4 v[116:119], v2, s[4:7], s25 offen offset:2048 sc1
  ds_read_b128 v[52:55], v2 offset:12288
  ds_read_b128 v[56:59], v2 offset:13312
  ds_read_b128 v[60:63], v2 offset:14336
  ds_read_b128 v[64:67], v2 offset:15360
  buffer_load_dwordx4 v[124:127], v2, s[4:7], s24 offen offset:2048 sc1
  buffer_load_dwordx4 v[116:119], v2, s[4:7], s25 offen offset:2048 sc1
  s_add_u32 s14, s14, 1
  s_cmp_ge_i32 s14, s30
  s_cbranch_scc1 T_kvw_136
T_kvb_137:
  s_mov_b32 s19, 0
  s_cmp_lg_u32 s14, 63
  s_cbranch_scc1 T_loop_132
  s_branch T_last_138
T_kvw_136:
  s_mov_b32 s19, 0
  s_branch T_kvok_145
T_kv_144:
  s_sleep 4
  s_add_u32 s19, s19, 1
  s_cmp_gt_u32 s19, 32768
  s_cbranch_scc1 M_exit
T_kvok_145:
  s_add_u32 s39, s99, 128
  s_mov_b32 s38, 0
  s_mov_b32 s37, 0
  s_atomic_or s38, s[58:59], s99 glc
  s_atomic_or s37, s[58:59], s39 glc
  s_waitcnt lgkmcnt(0)
  s_lshl_b32 s38, s38, 1
  s_lshl1_add_u32 s37, s37, 1
  s_min_u32 s38, s38, s37
  s_cmp_ge_u32 s38, 64
  s_cselect_b32 s38, 100, s38
  s_sub_u32 s38, s38, 1
  s_max_i32 s30, s30, s38
  s_cmp_ge_i32 s14, s30
  s_cbranch_scc1 T_kv_144
  s_branch T_kvb_137
T_slow_139:
  s_nop 7
  v_max3_f32 v100, v16, v17, v18
  v_max3_f32 v100, v100, v19, v20
  v_max3_f32 v100, v100, v21, v22
  v_max3_f32 v100, v100, v23, v112
  v_max3_f32 v100, v100, v113, v114
  v_max_f32 v100, v100, v115
  v_mov_b32 v101, v100
  s_nop 1
  v_permlane32_swap_b32 v100, v101
  s_nop 1
  v_max_f32 v100, v100, v101
  v_mov_b32 v101, v100
  s_nop 1
  v_permlane16_swap_b32 v100, v101
  s_nop 1
  v_max_f32 v100, v100, v101
  v_sub_f32 v16, v16, v100
  v_sub_f32 v17, v17, v100
  v_sub_f32 v18, v18, v100
  v_sub_f32 v19, v19, v100
  v_exp_f32 v16, v16
  v_exp_f32 v17, v17
  v_exp_f32 v18, v18
  v_exp_f32 v19, v19
  v_sub_f32 v20, v20, v100
  v_sub_f32 v21, v21, v100
  v_sub_f32 v22, v22, v100
  v_sub_f32 v23, v23, v100
  v_exp_f32 v20, v20
  v_exp_f32 v21, v21
  v_exp_f32 v22, v22
  v_exp_f32 v23, v23
  v_sub_f32 v112, v112, v100
  v_sub_f32 v113, v113, v100
  v_sub_f32 v114, v114, v100
  v_sub_f32 v115, v115, v100
  v_exp_f32 v112, v112
  v_exp_f32 v113, v113
  v_exp_f32 v114, v114
  v_exp_f32 v115, v115
  s_nop 0
  v_cvt_pk_bf16_f32 v44, v16, v17
  v_cvt_pk_bf16_f32 v45, v18, v19
  v_cvt_pk_bf16_f32 v46, v20, v21
  v_cvt_pk_bf16_f32 v47, v22, v23
  v_cvt_pk_bf16_f32 v84, v112, v113
  v_cvt_pk_bf16_f32 v85, v114, v115
  v_cndmask_b32 v48, v84, 0, s[16:17]
  v_cndmask_b32 v49, v85, 0, s[16:17]
  v_cndmask_b32 v50, 0, v84, s[16:17]
  v_cndmask_b32 v51, 0, v85, s[16:17]
  s_nop 1
  v_mfma_f32_16x16x16_bf16 v[88:91], v[12:13], v[48:49], 0
  v_mfma_f32_16x16x16_bf16 v[24:27], v[120:121], v[48:49], 0
  v_mfma_f32_16x16x16_bf16 v[116:119], v[120:121], v[50:51], 0
  v_mfma_f32_16x16x32_bf16 v[88:91], v[12:15], v[44:47], v[88:91]
  v_mfma_f32_16x16x32_bf16 v[24:27], v[28:31], v[44:47], v[24:27]
  v_mfma_f32_16x16x32_bf16 v[116:119], v[32:35], v[44:47], v[116:119]
  s_nop 7
  s_nop 1
  s_mov_b32 s96, -1
  s_branch T_back_140
.p2align 6
T_retry_146:
  s_mov_b64 exec, vcc
  buffer_load_dwordx4 v[124:127], v2, s[4:7], s24 offen offset:2048 sc1
  buffer_load_dwordx4 v[116:119], v2, s[4:7], s25 offen offset:2048 sc1
  s_mov_b64 exec, -1
  s_add_u32 s19, s19, 1
  s_cmp_gt_u32 s19, 32768
  s_cbranch_scc1 M_exit
T_last_138:
  s_waitcnt vmcnt(3) lgkmcnt(0)
  v_max3_u32 v123, v124, v125, v126
  v_max_u32 v123, v123, v127
  v_mov_b32_dpp v120, v124 row_ror:8 row_mask:0xf bank_mask:0xf
  v_mov_b32_dpp v121, v125 row_ror:8 row_mask:0xf bank_mask:0xf
  s_waitcnt vmcnt(2)
  v_max3_u32 v123, v123, v116, v117
  v_max3_u32 v123, v123, v118, v119
  v_cmp_eq_u32 vcc, -1, v123
  s_cbranch_vccnz T_retry_146
  v_smfmac_f32_16x16x64_bf16 v[20:23], v[124:127], v[76:83], v0
  ds_write_b128 v2, v[124:127] offset:2048
  v_mov_b32_dpp v122, v126 row_ror:8 row_mask:0xf bank_mask:0xf
  v_mov_b32_dpp v123, v127 row_ror:8 row_mask:0xf bank_mask:0xf
  v_smfmac_f32_16x16x64_bf16 v[24:27], v[124:127], v[84:91], v0
  ds_write_b128 v2, v[116:119] offset:6144
  v_mov_b32_dpp v84, v116 row_ror:8 row_mask:0xf bank_mask:0xf
  v_smfmac_f32_16x16x64_bf16 v[20:23], v[120:123], v[100:107], v0
  ds_read_b128 v[68:71], v4 offset:12288
  v_mov_b32_dpp v85, v117 row_ror:8 row_mask:0xf bank_mask:0xf
  v_smfmac_f32_16x16x64_bf16 v[24:27], v[120:123], v[108:115], v0
  ds_read_b128 v[72:75], v4 offset:13312
  v_mov_b32_dpp v86, v118 row_ror:8 row_mask:0xf bank_mask:0xf
  ds_read_b128 v[76:79], v4 offset:14336
  v_mov_b32_dpp v87, v119 row_ror:8 row_mask:0xf bank_mask:0xf
  v_smfmac_f32_16x16x64_bf16 v[20:23], v[116:119], v[240:247], v0
  s_waitcnt lgkmcnt(3)
  s_barrier
  ds_read_b128 v[100:103], v2 offset:3072
  v_smfmac_f32_16x16x64_bf16 v[24:27], v[116:119], a[0:7], v0
  ds_read_b128 v[120:123], v1 offset:3072
  v_smfmac_f32_16x16x64_bf16 v[20:23], v[84:87], v[248:255], v0
  ds_read_b128 v[80:83], v4 offset:15360
  v_smfmac_f32_16x16x64_bf16 v[24:27], v[84:87], a[8:15], v0
  s_waitcnt lgkmcnt(2)
  ds_read_b128 v[92:95], v2 offset:0
  v_smfmac_f32_16x16x64_bf16 v[20:23], v[100:103], v[144:151], v0
  ds_read_b128 v[96:99], v1 offset:0
  v_smfmac_f32_16x16x64_bf16 v[24:27], v[100:103], v[68:75], v0
  s_waitcnt vmcnt(0) lgkmcnt(3)
  ds_read_b128 v[116:119], v2 offset:1024
  ds_read_b128 v[124:127], v1 offset:1024
  v_smfmac_f32_16x16x64_bf16 v[20:23], v[120:123], v[152:159], v0
  s_waitcnt lgkmcnt(4)
  ds_read_b128 v[104:107], v2 offset:7168
  v_smfmac_f32_16x16x64_bf16 v[24:27], v[120:123], v[76:83], v0
  s_waitcnt lgkmcnt(4)
  ds_read_b128 v[108:111], v1 offset:7168
  ds_read_b128 v[112:115], v2 offset:4096
  ds_read_b128 v[84:87], v1 offset:4096
  ds_read_b128 v[88:91], v2 offset:5120
  ds_read_b128 v[100:103], v1 offset:5120
  ds_read_b128 v[68:71], v4 offset:16384
  ds_read_b128 v[72:75], v4 offset:17408
  ds_read_b128 v[76:79], v4 offset:18432
  ds_read_b128 v[80:83], v4 offset:19456
  v_smfmac_f32_16x16x64_bf16 v[20:23], v[92:95], v[176:183], v0
  s_waitcnt lgkmcnt(12)
  v_smfmac_f32_16x16x64_bf16 v[20:23], v[96:99], v[184:191], v0
  s_waitcnt lgkmcnt(2)
  v_smfmac_f32_16x16x64_bf16 v[20:23], v[116:119], v[68:75], v0
  s_waitcnt lgkmcnt(0)
  ds_read_b128 v[68:71], v4 offset:20480
  v_smfmac_f32_16x16x64_bf16 v[20:23], v[124:127], v[76:83], v0
  ds_read_b128 v[72:75], v4 offset:21504
  v_smfmac_f32_16x16x64_bf16 v[20:23], v[104:107], a[32:39], v0
  ds_read_b128 v[76:79], v4 offset:22528
  v_smfmac_f32_16x16x64_bf16 v[20:23], v[108:111], a[40:47], v0
  ds_read_b128 v[80:83], v4 offset:23552
  v_smfmac_f32_16x16x64_bf16 v[20:23], v[112:115], a[80:87], v0
  v_smfmac_f32_16x16x64_bf16 v[20:23], v[84:87], a[88:95], v0
  v_smfmac_f32_16x16x64_bf16 v[20:23], v[88:91], a[128:135], v0
  v_smfmac_f32_16x16x64_bf16 v[20:23], v[100:103], a[136:143], v0
  s_waitcnt lgkmcnt(2)
  v_smfmac_f32_16x16x64_bf16 v[24:27], v[92:95], v[68:75], v0
  s_waitcnt lgkmcnt(0)
  v_smfmac_f32_16x16x64_bf16 v[24:27], v[96:99], v[76:83], v0
  v_smfmac_f32_16x16x64_bf16 v[24:27], v[116:119], v[208:215], v0
  v_smfmac_f32_16x16x64_bf16 v[24:27], v[124:127], v[216:223], v0
  v_smfmac_f32_16x16x64_bf16 v[24:27], v[104:107], a[48:55], v0
  v_smfmac_f32_16x16x64_bf16 v[24:27], v[108:111], a[56:63], v0
  v_smfmac_f32_16x16x64_bf16 v[24:27], v[112:115], a[96:103], v0
  v_smfmac_f32_16x16x64_bf16 v[24:27], v[84:87], a[104:111], v0
  v_smfmac_f32_16x16x64_bf16 v[24:27], v[88:91], a[144:151], v0
  v_smfmac_f32_16x16x64_bf16 v[24:27], v[100:103], a[152:159], v0
  v_cvt_pk_bf16_f32 v122, v20, v21
  v_cvt_pk_bf16_f32 v123, v22, v23
  s_nop 5
  v_cvt_pk_bf16_f32 v120, v24, v25
  v_cvt_pk_bf16_f32 v121, v26, v27
  buffer_store_dwordx4 v[120:123], v2, s[4:7], s29 offen offset:2048 sc1
  s_branch M_tdone
T_w_93:
  s_mov_b32 s19, 0
  s_add_u32 s14, s14, 1
  s_and_b32 s57, s14, 1
  v_mov_b64 v[16:17], 0
  v_mov_b64 v[18:19], 0
  v_mov_b64 v[20:21], 0
  v_mov_b64 v[22:23], 0
  v_mov_b64 v[24:25], 0
  v_mov_b64 v[26:27], 0
  buffer_load_dwordx4 v[124:127], v2, s[4:7], s24 offen offset:3072 sc1
  buffer_load_dwordx4 v[116:119], v2, s[4:7], s25 offen offset:3072 sc1
  buffer_load_dwordx4 v[124:127], v2, s[4:7], s24 offen offset:3072 sc1
  buffer_load_dwordx4 v[116:119], v2, s[4:7], s25 offen offset:3072 sc1
  s_branch T_loop_151
.p2align 6
T_retry_152:
  s_mov_b64 exec, vcc
  buffer_load_dwordx4 v[124:127], v2, s[4:7], s24 offen offset:3072 sc1
  buffer_load_dwordx4 v[116:119], v2, s[4:7], s25 offen offset:3072 sc1
  s_mov_b64 exec, -1
  s_add_u32 s19, s19, 1
  s_cmp_gt_u32 s19, 32768
  s_cbranch_scc1 M_exit
  s_nop 0
  v_mov_b64 v[16:17], 0
  v_mov_b64 v[18:19], 0
T_loop_151:
  s_waitcnt vmcnt(3) lgkmcnt(0)
  v_max3_u32 v123, v124, v125, v126
  v_max_u32 v123, v123, v127
  v_mov_b32_dpp v120, v124 row_ror:8 row_mask:0xf bank_mask:0xf
  v_mov_b32_dpp v121, v125 row_ror:8 row_mask:0xf bank_mask:0xf
  s_waitcnt vmcnt(2)
  v_max3_u32 v123, v123, v116, v117
  v_max3_u32 v123, v123, v118, v119
  v_cmp_eq_u32 vcc, -1, v123
  v_smfmac_f32_16x16x64_bf16 v[16:19], v[124:127], v[68:75], v0
  s_cbranch_vccnz T_retry_152
  ds_write_b128 v2, v[124:127] offset:3072
  v_mov_b32_dpp v122, v126 row_ror:8 row_mask:0xf bank_mask:0xf
  v_smfmac_f32_16x16x64_bf16 v[20:23], v[124:127], v[76:83], v0
  s_and_b32 s57, s14, 1
  v_mov_b32_dpp v123, v127 row_ror:8 row_mask:0xf bank_mask:0xf
  v_smfmac_f32_16x16x64_bf16 v[24:27], v[124:127], v[84:91], v0
  s_and_b32 s36, s14, 3
  ds_write_b128 v2, v[116:119] offset:7168
  v_smfmac_f32_16x16x64_bf16 v[16:19], v[120:123], v[92:99], v0
  s_lshl_b32 s36, s36, 13
  v_mov_b32_dpp v84, v116 row_ror:8 row_mask:0xf bank_mask:0xf
  v_smfmac_f32_16x16x64_bf16 v[20:23], v[120:123], v[100:107], v0
  s_add_u32 s26, s36, s23
  ds_read_b128 v[68:71], v4 offset:12288
  v_mov_b32_dpp v85, v117 row_ror:8 row_mask:0xf bank_mask:0xf
  v_smfmac_f32_16x16x64_bf16 v[24:27], v[120:123], v[108:115], v0
  s_add_u32 s36, s36, 8192
  ds_read_b128 v[72:75], v4 offset:13312
  v_mov_b32_dpp v86, v118 row_ror:8 row_mask:0xf bank_mask:0xf
  v_smfmac_f32_16x16x64_bf16 v[16:19], v[116:119], v[224:231], v0
  s_and_b32 s36, s36, 0x7fff
  ds_read_b128 v[76:79], v4 offset:14336
  v_mov_b32_dpp v87, v119 row_ror:8 row_mask:0xf bank_mask:0xf
  v_smfmac_f32_16x16x64_bf16 v[20:23], v[116:119], v[240:247], v0
  s_waitcnt lgkmcnt(3)
  s_barrier
  ds_read_b128 v[100:103], v2 offset:2048
  v_smfmac_f32_16x16x64_bf16 v[24:27], v[116:119], a[0:7], v0
  s_mov_b32 m0, s31
  ds_read_b128 v[120:123], v1 offset:2048
  v_smfmac_f32_16x16x64_bf16 v[16:19], v[84:87], v[232:239], v0
  v_smfmac_f32_16x16x64_bf16 v[20:23], v[84:87], v[248:255], v0
  ds_read_b128 v[80:83], v4 offset:15360
  v_smfmac_f32_16x16x64_bf16 v[24:27], v[84:87], a[8:15], v0
  s_waitcnt lgkmcnt(2)
  buffer_load_dwordx4 v9, s[4:7], s27 offen sc1 lds
  v_smfmac_f32_16x16x64_bf16 v[16:19], v[100:103], v[128:135], v0
  ds_read_b128 v[92:95], v2 offset:1024
  s_mov_b32 m0, s32
  v_smfmac_f32_16x16x64_bf16 v[20:23], v[100:103], v[144:151], v0
  ds_read_b128 v[96:99], v1 offset:1024
  v_smfmac_f32_16x16x64_bf16 v[24:27], v[100:103], v[68:75], v0
  s_waitcnt vmcnt(1) lgkmcnt(3)
  ds_read_b128 v[116:119], v2 offset:0
  v_smfmac_f32_16x16x64_bf16 v[16:19], v[120:123], v[136:143], v0
  ds_read_b128 v[124:127], v1 offset:0
  buffer_load_dwordx4 v9, s[4:7], s27 offen offset:128 sc1 lds
  v_smfmac_f32_16x16x64_bf16 v[20:23], v[120:123], v[152:159], v0
  s_waitcnt lgkmcnt(4)
  ds_read_b128 v[104:107], v2 offset:6144
  s_mov_b32 m0, s33
  v_smfmac_f32_16x16x64_bf16 v[24:27], v[120:123], v[76:83], v0
  s_waitcnt lgkmcnt(4)
  ds_read_b128 v[108:111], v1 offset:6144
  v_smfmac_f32_16x16x64_bf16 v[16:19], v[92:95], v[160:167], v0
  s_waitcnt lgkmcnt(4)
  ds_read_b128 v[112:115], v2 offset:5120
  v_smfmac_f32_16x16x64_bf16 v[16:19], v[96:99], v[168:175], v0
  s_waitcnt lgkmcnt(4)
  ds_read_b128 v[84:87], v1 offset:5120
  buffer_load_dwordx4 v10, s[4:7], s28 offen sc1 lds
  v_smfmac_f32_16x16x64_bf16 v[16:19], v[116:119], v[192:199], v0
  s_waitcnt lgkmcnt(4)
  ds_read_b128 v[88:91], v2 offset:4096
  s_mov_b32 m0, s34
  v_smfmac_f32_16x16x64_bf16 v[16:19], v[124:127], v[200:207], v0
  s_waitcnt lgkmcnt(4)
  ds_read_b128 v[100:103], v1 offset:4096
  v_smfmac_f32_16x16x64_bf16 v[16:19], v[104:107], a[16:23], v0
  s_waitcnt lgkmcnt(4)
  ds_read_b128 v[68:71], v4 offset:16384
  v_smfmac_f32_16x16x64_bf16 v[16:19], v[108:111], a[24:31], v0
  s_waitcnt lgkmcnt(4)
  ds_read_b128 v[72:75], v4 offset:17408
  buffer_load_dwordx4 v10, s[4:7], s28 offen offset:256 sc1 lds
  v_smfmac_f32_16x16x64_bf16 v[16:19], v[112:115], a[64:71], v0
  s_waitcnt lgkmcnt(4)
  ds_read_b128 v[76:79], v4 offset:18432
  s_mov_b32 m0, 32256
  v_smfmac_f32_16x16x64_bf16 v[16:19], v[84:87], a[72:79], v0
  s_waitcnt lgkmcnt(4)
  ds_read_b128 v[80:83], v4 offset:19456
  v_smfmac_f32_16x16x64_bf16 v[16:19], v[88:91], a[112:119], v0
  s_waitcnt lgkmcnt(4)
  v_smfmac_f32_16x16x64_bf16 v[16:19], v[100:103], a[120:127], v0
  buffer_load_dword v3, s[4:7], s99 offen sc1 lds
  s_add_u32 s24, s36, 145752064
  s_add_u32 s25, s36, 145756160
  v_smfmac_f32_16x16x64_bf16 v[20:23], v[92:95], v[176:183], v0
  s_add_u32 s35, s36, s23
  v_smfmac_f32_16x16x64_bf16 v[20:23], v[96:99], v[184:191], v0
  s_waitcnt lgkmcnt(2)
  v_smfmac_f32_16x16x64_bf16 v[20:23], v[116:119], v[68:75], v0
  s_waitcnt lgkmcnt(0)
  ds_read_b128 v[68:71], v4 offset:20480
  v_mul_f32 v16, s18, v16
  v_smfmac_f32_16x16x64_bf16 v[20:23], v[124:127], v[76:83], v0
  ds_read_b128 v[72:75], v4 offset:21504
  v_mul_f32 v17, s18, v17
  v_smfmac_f32_16x16x64_bf16 v[20:23], v[104:107], a[32:39], v0
  ds_read_b128 v[76:79], v4 offset:22528
  v_mul_f32 v18, s18, v18
  v_smfmac_f32_16x16x64_bf16 v[20:23], v[108:111], a[40:47], v0
  ds_read_b128 v[80:83], v4 offset:23552
  v_mul_f32 v19, s18, v19
  v_smfmac_f32_16x16x64_bf16 v[20:23], v[112:115], a[80:87], v0
  v_cvt_pk_bf16_f32 v120, v16, v17
  v_smfmac_f32_16x16x64_bf16 v[20:23], v[84:87], a[88:95], v0
  v_cvt_pk_bf16_f32 v121, v18, v19
  v_smfmac_f32_16x16x64_bf16 v[20:23], v[88:91], a[128:135], v0
  ds_write_b64 v5, v[120:121] offset:24576
  v_smfmac_f32_16x16x64_bf16 v[20:23], v[100:103], a[136:143], v0
  s_waitcnt lgkmcnt(3)
  v_smfmac_f32_16x16x64_bf16 v[24:27], v[92:95], v[68:75], v0
  s_waitcnt lgkmcnt(1)
  v_mov_b64 v[92:93], 0
  v_smfmac_f32_16x16x64_bf16 v[24:27], v[96:99], v[76:83], v0
  s_nop 1
  v_cvt_pk_bf16_f32 v122, v20, v21
  v_cvt_pk_bf16_f32 v123, v22, v23
  v_smfmac_f32_16x16x64_bf16 v[24:27], v[116:119], v[208:215], v0
  ds_write_b64 v5, v[122:123] offset:26880
  v_mov_b64 v[94:95], 0
  v_smfmac_f32_16x16x64_bf16 v[24:27], v[124:127], v[216:223], v0
  s_waitcnt lgkmcnt(1)
  s_barrier
  ds_read_b64_tr_b16 v[68:69], v6 offset:24576
  v_smfmac_f32_16x16x64_bf16 v[24:27], v[104:107], a[48:55], v0
  s_add_u32 s27, s27, 8192
  ds_read_b64_tr_b16 v[70:71], v6 offset:24640
  ds_read_b64_tr_b16 v[72:73], v6 offset:24832
  v_smfmac_f32_16x16x64_bf16 v[24:27], v[108:111], a[56:63], v0
  s_add_u32 s28, s28, 8192
  ds_read_b64_tr_b16 v[74:75], v6 offset:24896
  ds_read_b64_tr_b16 v[76:77], v6 offset:25088
  v_smfmac_f32_16x16x64_bf16 v[24:27], v[112:115], a[96:103], v0
  s_nop 0
  ds_read_b64_tr_b16 v[78:79], v6 offset:25152
  ds_read_b64_tr_b16 v[80:81], v6 offset:25344
  v_smfmac_f32_16x16x64_bf16 v[24:27], v[84:87], a[104:111], v0
  ds_read_b64_tr_b16 v[82:83], v6 offset:25408
  v_mov_b64 v[96:97], 0
  v_smfmac_f32_16x16x64_bf16 v[24:27], v[88:91], a[144:151], v0
  s_waitcnt lgkmcnt(8)
  s_barrier
  ds_read_b64_tr_b16 v[116:117], v6 offset:26880
  v_smfmac_f32_16x16x64_bf16 v[24:27], v[100:103], a[152:159], v0
  s_waitcnt lgkmcnt(7)
  ds_read_b64_tr_b16 v[118:119], v6 offset:26944
  v_mfma_f32_16x16x32_bf16 v[16:19], v[36:39], v[68:71], 0
  s_waitcnt lgkmcnt(6)
  ds_read_b64_tr_b16 v[124:125], v6 offset:27136
  ds_read_b64_tr_b16 v[126:127], v6 offset:27200
  v_mfma_f32_16x16x32_bf16 v[16:19], v[40:43], v[72:75], v[16:19]
  s_waitcnt lgkmcnt(6)
  ds_read_b64_tr_b16 v[104:105], v6 offset:27392
  ds_read_b64_tr_b16 v[106:107], v6 offset:27456
  v_mfma_f32_16x16x32_bf16 v[16:19], v[44:47], v[76:79], v[16:19]
  s_waitcnt lgkmcnt(6)
  ds_read_b64_tr_b16 v[108:109], v6 offset:27648
  ds_read_b64_tr_b16 v[110:111], v6 offset:27712
  v_mfma_f32_16x16x32_bf16 v[16:19], v[48:51], v[80:83], v[16:19]
  s_waitcnt lgkmcnt(6)
  v_cvt_pk_bf16_f32 v120, v24, v25
  v_cvt_pk_bf16_f32 v121, v26, v27
  v_mfma_f32_16x16x32_bf16 v[112:115], v[116:119], v[68:71], 0
  s_waitcnt lgkmcnt(4)
  v_mov_b64 v[98:99], 0
  v_mfma_f32_16x16x32_bf16 v[112:115], v[124:127], v[72:75], v[112:115]
  s_waitcnt lgkmcnt(2)
  v_mov_b64 v[36:37], 0
  v_exp_f32 v100, v16
  v_mfma_f32_16x16x32_bf16 v[112:115], v[104:107], v[76:79], v[112:115]
  s_waitcnt lgkmcnt(0)
  v_exp_f32 v101, v17
  v_mfma_f32_16x16x32_bf16 v[112:115], v[108:111], v[80:83], v[112:115]
  buffer_store_dwordx4 v[120:123], v2, s[4:7], s29 offen offset:3072 sc1
  v_exp_f32 v102, v18
  v_mfma_f32_16x16x32_bf16 v[20:23], v[52:55], v[68:71], 0
  v_exp_f32 v103, v19
  v_mfma_f32_16x16x32_bf16 v[20:23], v[56:59], v[72:75], v[20:23]
  v_cvt_pk_bf16_f32 v44, v100, v101
  v_cvt_pk_bf16_f32 v45, v102, v103
  v_mfma_f32_16x16x32_bf16 v[20:23], v[60:63], v[76:79], v[20:23]
  s_add_u32 s29, s29, 131072
  v_exp_f32 v100, v112
  v_mfma_f32_16x16x32_bf16 v[20:23], v[64:67], v[80:83], v[20:23]
  v_exp_f32 v101, v113
  v_exp_f32 v102, v114
  v_exp_f32 v103, v115
  v_cvt_pk_bf16_f32 v84, v100, v101
  v_cvt_pk_bf16_f32 v85, v102, v103
  v_cndmask_b32 v48, v84, 0, s[16:17]
  v_cndmask_b32 v49, v85, 0, s[16:17]
  v_cndmask_b32 v50, 0, v84, s[16:17]
  v_cndmask_b32 v51, 0, v85, s[16:17]
  v_exp_f32 v100, v20
  v_mfma_f32_16x16x16_bf16 v[88:91], v[12:13], v[48:49], 0
  v_exp_f32 v101, v21
  v_mfma_f32_16x16x16_bf16 v[24:27], v[120:121], v[48:49], 0
  v_exp_f32 v102, v22
  v_mfma_f32_16x16x16_bf16 v[116:119], v[120:121], v[50:51], 0
  v_exp_f32 v103, v23
  v_cvt_pk_bf16_f32 v46, v100, v101
  v_cvt_pk_bf16_f32 v47, v102, v103
  v_mov_b64 v[38:39], 0
  s_nop 0
  v_mfma_f32_16x16x32_bf16 v[88:91], v[12:15], v[44:47], v[88:91]
  v_mov_b64 v[40:41], 0
  v_mov_b64 v[42:43], 0
  v_mfma_f32_16x16x32_bf16 v[24:27], v[28:31], v[44:47], v[24:27]
  ds_read_b128 v[52:55], v4 offset:24576
  ds_read_b128 v[56:59], v4 offset:25600
  v_mfma_f32_16x16x32_bf16 v[116:119], v[32:35], v[44:47], v[116:119]
  s_nop 1
T_back_159:
  v_rcp_f32 v89, v88
  v_subrev_u32 v100, s54, v88
  v_cmp_le_u32 vcc, s96, v100
  v_mul_f32 v24, v89, v24
  v_mul_f32 v25, v89, v25
  v_cvt_pk_bf16_f32 v124, v24, v25
  v_pk_mul_f32 v[26:27], v[26:27], v[88:89] op_sel:[0,1] op_sel_hi:[1,1]
  v_pk_mul_f32 v[116:117], v[116:117], v[88:89] op_sel:[0,1] op_sel_hi:[1,1]
  v_pk_mul_f32 v[118:119], v[118:119], v[88:89] op_sel:[0,1] op_sel_hi:[1,1]
  v_cvt_pk_bf16_f32 v125, v26, v27
  v_cvt_pk_bf16_f32 v126, v116, v117
  v_cvt_pk_bf16_f32 v127, v118, v119
  ds_write_b128 v11, v[124:127] offset:30720
  s_cbranch_vccnz T_slow_158
  v_smfmac_f32_16x16x64_bf16 v[92:95], v[124:127], a[160:167], v0
  s_mov_b32 s96, s55
  v_smfmac_f32_16x16x64_bf16 v[96:99], v[124:127], a[168:175], v0
  v_smfmac_f32_16x16x64_bf16 v[36:39], v[124:127], a[176:183], v0
  s_waitcnt lgkmcnt(0)
  s_barrier
  ds_read_b128 v[104:107], v11 offset:30208
  ds_read_b128 v[108:111], v11 offset:29696
  ds_read_b128 v[68:71], v11 offset:29184
  v_smfmac_f32_16x16x64_bf16 v[40:43], v[124:127], a[184:191], v0
  s_waitcnt lgkmcnt(2)
  v_smfmac_f32_16x16x64_bf16 v[92:95], v[104:107], a[192:199], v0
  s_waitcnt lgkmcnt(1)
  ds_read_b128 v[76:79], v4 offset:28672
  v_smfmac_f32_16x16x64_bf16 v[92:95], v[108:111], a[224:231], v0
  s_waitcnt lgkmcnt(1)
  ds_read_b128 v[80:83], v4 offset:29696
  v_smfmac_f32_16x16x64_bf16 v[92:95], v[68:71], a[240:247], v0
  ds_read_b128 v[60:63], v4 offset:26624
  v_smfmac_f32_16x16x64_bf16 v[96:99], v[104:107], a[200:207], v0
  ds_read_b128 v[64:67], v4 offset:27648
  v_smfmac_f32_16x16x64_bf16 v[96:99], v[108:111], a[232:239], v0
  ds_read_b128 v[28:31], v4 offset:30720
  s_nop 0
  v_cvt_pk_bf16_f32 v16, v92, v93
  v_cvt_pk_bf16_f32 v17, v94, v95
  v_bfi_b32 v16, 1, s57, v16
  v_smfmac_f32_16x16x64_bf16 v[96:99], v[68:71], a[248:255], v0
  buffer_store_dwordx2 v[16:17], v7, s[4:7], s20 offen offset:0 sc1
  v_smfmac_f32_16x16x64_bf16 v[36:39], v[104:107], a[208:215], v0
  ds_read_b128 v[32:35], v4 offset:31744
  v_smfmac_f32_16x16x64_bf16 v[36:39], v[108:111], v[52:59], v0
  s_waitcnt lgkmcnt(4)
  s_nop 0
  v_cvt_pk_bf16_f32 v18, v96, v97
  v_cvt_pk_bf16_f32 v19, v98, v99
  v_bfi_b32 v18, 1, s57, v18
  v_smfmac_f32_16x16x64_bf16 v[36:39], v[68:71], v[76:83], v0
  buffer_store_dwordx2 v[18:19], v7, s[4:7], s20 offen offset:64 sc1
  v_smfmac_f32_16x16x64_bf16 v[40:43], v[104:107], a[216:223], v0
  s_waitcnt lgkmcnt(2)
  v_smfmac_f32_16x16x64_bf16 v[40:43], v[108:111], v[60:67], v0
  s_waitcnt lgkmcnt(0)
  s_nop 0
  v_cvt_pk_bf16_f32 v20, v36, v37
  v_cvt_pk_bf16_f32 v21, v38, v39
  v_bfi_b32 v20, 1, s57, v20
  v_smfmac_f32_16x16x64_bf16 v[40:43], v[68:71], v[28:35], v0
  buffer_store_dwordx2 v[20:21], v7, s[4:7], s21 offen offset:0 sc1
  s_nop 6
  v_cvt_pk_bf16_f32 v22, v40, v41
  v_cvt_pk_bf16_f32 v23, v42, v43
  v_bfi_b32 v22, 1, s57, v22
  buffer_store_dwordx2 v[22:23], v7, s[4:7], s21 offen offset:64 sc1
  ds_read_b128 v[68:71], v4 offset:0
  ds_read_b128 v[72:75], v4 offset:1024
  ds_read_b128 v[76:79], v4 offset:4096
  ds_read_b128 v[80:83], v4 offset:5120
  ds_read_b128 v[84:87], v4 offset:8192
  ds_read_b128 v[88:91], v4 offset:9216
  ds_read_b128 v[92:95], v4 offset:2048
  ds_read_b128 v[96:99], v4 offset:3072
  ds_read_b128 v[100:103], v4 offset:6144
  ds_read_b128 v[104:107], v4 offset:7168
  ds_read_b128 v[108:111], v4 offset:10240
  ds_read_b128 v[112:115], v4 offset:11264
  v_mov_b64 v[16:17], 0
  v_mov_b64 v[18:19], 0
  v_mov_b64 v[20:21], 0
  v_mov_b64 v[22:23], 0
  v_mov_b64 v[24:25], 0
  v_mov_b64 v[26:27], 0
  ds_read_b64 v[44:45], v2 offset:32256
  s_waitcnt lgkmcnt(0)
  v_readfirstlane_b32 s38, v44
  v_readfirstlane_b32 s37, v45
  s_nop 0
  s_lshl_b32 s38, s38, 1
  s_lshl1_add_u32 s37, s37, 1
  s_min_u32 s38, s38, s37
  s_cmp_ge_u32 s38, 64
  s_cselect_b32 s38, 100, s38
  s_sub_u32 s38, s38, 1
  s_max_i32 s30, s30, s38
  s_waitcnt vmcnt(4)
  s_barrier
  ds_read_b128 v[28:31], v2 offset:19456
  ds_read_b128 v[32:35], v2 offset:23552
  ds_read_b128 v[36:39], v2 offset:8192
  ds_read_b128 v[40:43], v2 offset:9216
  ds_read_b128 v[44:47], v2 offset:10240
  ds_read_b128 v[48:51], v2 offset:11264
  buffer_load_dwordx4 v[124:127], v2, s[4:7], s24 offen offset:3072 sc1
  buffer_load_dwordx4 v[116:119], v2, s[4:7], s25 offen offset:3072 sc1
  ds_read_b128 v[52:55], v2 offset:12288
  ds_read_b128 v[56:59], v2 offset:13312
  ds_read_b128 v[60:63], v2 offset:14336
  ds_read_b128 v[64:67], v2 offset:15360
  buffer_load_dwordx4 v[124:127], v2, s[4:7], s24 offen offset:3072 sc1
  buffer_load_dwordx4 v[116:119], v2, s[4:7], s25 offen offset:3072 sc1
  s_add_u32 s14, s14, 1
  s_cmp_ge_i32 s14, s30
  s_cbranch_scc1 T_kvw_155
T_kvb_156:
  s_mov_b32 s19, 0
  s_cmp_lg_u32 s14, 63
  s_cbranch_scc1 T_loop_151
  s_branch T_last_157
T_kvw_155:
  s_mov_b32 s19, 0
  s_branch T_kvok_164
T_kv_163:
  s_sleep 4
  s_add_u32 s19, s19, 1
  s_cmp_gt_u32 s19, 32768
  s_cbranch_scc1 M_exit
T_kvok_164:
  s_add_u32 s39, s99, 128
  s_mov_b32 s38, 0
  s_mov_b32 s37, 0
  s_atomic_or s38, s[58:59], s99 glc
  s_atomic_or s37, s[58:59], s39 glc
  s_waitcnt lgkmcnt(0)
  s_lshl_b32 s38, s38, 1
  s_lshl1_add_u32 s37, s37, 1
  s_min_u32 s38, s38, s37
  s_cmp_ge_u32 s38, 64
  s_cselect_b32 s38, 100, s38
  s_sub_u32 s38, s38, 1
  s_max_i32 s30, s30, s38
  s_cmp_ge_i32 s14, s30
  s_cbranch_scc1 T_kv_163
  s_branch T_kvb_156
T_slow_158:
  s_nop 7
  v_max3_f32 v100, v16, v17, v18
  v_max3_f32 v100, v100, v19, v20
  v_max3_f32 v100, v100, v21, v22
  v_max3_f32 v100, v100, v23, v112
  v_max3_f32 v100, v100, v113, v114
  v_max_f32 v100, v100, v115
  v_mov_b32 v101, v100
  s_nop 1
  v_permlane32_swap_b32 v100, v101
  s_nop 1
  v_max_f32 v100, v100, v101
  v_mov_b32 v101, v100
  s_nop 1
  v_permlane16_swap_b32 v100, v101
  s_nop 1
  v_max_f32 v100, v100, v101
  v_sub_f32 v16, v16, v100
  v_sub_f32 v17, v17, v100
  v_sub_f32 v18, v18, v100
  v_sub_f32 v19, v19, v100
  v_exp_f32 v16, v16
  v_exp_f32 v17, v17
  v_exp_f32 v18, v18
  v_exp_f32 v19, v19
  v_sub_f32 v20, v20, v100
  v_sub_f32 v21, v21, v100
  v_sub_f32 v22, v22, v100
  v_sub_f32 v23, v23, v100
  v_exp_f32 v20, v20
  v_exp_f32 v21, v21
  v_exp_f32 v22, v22
  v_exp_f32 v23, v23
  v_sub_f32 v112, v112, v100
  v_sub_f32 v113, v113, v100
  v_sub_f32 v114, v114, v100
  v_sub_f32 v115, v115, v100
  v_exp_f32 v112, v112
  v_exp_f32 v113, v113
  v_exp_f32 v114, v114
  v_exp_f32 v115, v115
  s_nop 0
  v_cvt_pk_bf16_f32 v44, v16, v17
  v_cvt_pk_bf16_f32 v45, v18, v19
  v_cvt_pk_bf16_f32 v46, v20, v21
  v_cvt_pk_bf16_f32 v47, v22, v23
  v_cvt_pk_bf16_f32 v84, v112, v113
  v_cvt_pk_bf16_f32 v85, v114, v115
  v_cndmask_b32 v48, v84, 0, s[16:17]
  v_cndmask_b32 v49, v85, 0, s[16:17]
  v_cndmask_b32 v50, 0, v84, s[16:17]
  v_cndmask_b32 v51, 0, v85, s[16:17]
  s_nop 1
  v_mfma_f32_16x16x16_bf16 v[88:91], v[12:13], v[48:49], 0
  v_mfma_f32_16x16x16_bf16 v[24:27], v[120:121], v[48:49], 0
  v_mfma_f32_16x16x16_bf16 v[116:119], v[120:121], v[50:51], 0
  v_mfma_f32_16x16x32_bf16 v[88:91], v[12:15], v[44:47], v[88:91]
  v_mfma_f32_16x16x32_bf16 v[24:27], v[28:31], v[44:47], v[24:27]
  v_mfma_f32_16x16x32_bf16 v[116:119], v[32:35], v[44:47], v[116:119]
  s_nop 7
  s_nop 1
  s_mov_b32 s96, -1
  s_branch T_back_159
.p2align 6
T_retry_165:
  s_mov_b64 exec, vcc
  buffer_load_dwordx4 v[124:127], v2, s[4:7], s24 offen offset:3072 sc1
  buffer_load_dwordx4 v[116:119], v2, s[4:7], s25 offen offset:3072 sc1
  s_mov_b64 exec, -1
  s_add_u32 s19, s19, 1
  s_cmp_gt_u32 s19, 32768
  s_cbranch_scc1 M_exit
T_last_157:
  s_waitcnt vmcnt(3) lgkmcnt(0)
  v_max3_u32 v123, v124, v125, v126
  v_max_u32 v123, v123, v127
  v_mov_b32_dpp v120, v124 row_ror:8 row_mask:0xf bank_mask:0xf
  v_mov_b32_dpp v121, v125 row_ror:8 row_mask:0xf bank_mask:0xf
  s_waitcnt vmcnt(2)
  v_max3_u32 v123, v123, v116, v117
  v_max3_u32 v123, v123, v118, v119
  v_cmp_eq_u32 vcc, -1, v123
  s_cbranch_vccnz T_retry_165
  v_smfmac_f32_16x16x64_bf16 v[20:23], v[124:127], v[76:83], v0
  ds_write_b128 v2, v[124:127] offset:3072
  v_mov_b32_dpp v122, v126 row_ror:8 row_mask:0xf bank_mask:0xf
  v_mov_b32_dpp v123, v127 row_ror:8 row_mask:0xf bank_mask:0xf
  v_smfmac_f32_16x16x64_bf16 v[24:27], v[124:127], v[84:91], v0
  ds_write_b128 v2, v[116:119] offset:7168
  v_mov_b32_dpp v84, v116 row_ror:8 row_mask:0xf bank_mask:0xf
  v_smfmac_f32_16x16x64_bf16 v[20:23], v[120:123], v[100:107], v0
  ds_read_b128 v[68:71], v4 offset:12288
  v_mov_b32_dpp v85, v117 row_ror:8 row_mask:0xf bank_mask:0xf
  v_smfmac_f32_16x16x64_bf16 v[24:27], v[120:123], v[108:115], v0
  ds_read_b128 v[72:75], v4 offset:13312
  v_mov_b32_dpp v86, v118 row_ror:8 row_mask:0xf bank_mask:0xf
  ds_read_b128 v[76:79], v4 offset:14336
  v_mov_b32_dpp v87, v119 row_ror:8 row_mask:0xf bank_mask:0xf
  v_smfmac_f32_16x16x64_bf16 v[20:23], v[116:119], v[240:247], v0
  s_waitcnt lgkmcnt(3)
  s_barrier
  ds_read_b128 v[100:103], v2 offset:2048
  v_smfmac_f32_16x16x64_bf16 v[24:27], v[116:119], a[0:7], v0
  ds_read_b128 v[120:123], v1 offset:2048
  v_smfmac_f32_16x16x64_bf16 v[20:23], v[84:87], v[248:255], v0
  ds_read_b128 v[80:83], v4 offset:15360
  v_smfmac_f32_16x16x64_bf16 v[24:27], v[84:87], a[8:15], v0
  s_waitcnt lgkmcnt(2)
  ds_read_b128 v[92:95], v2 offset:1024
  v_smfmac_f32_16x16x64_bf16 v[20:23], v[100:103], v[144:151], v0
  ds_read_b128 v[96:99], v1 offset:1024
  v_smfmac_f32_16x16x64_bf16 v[24:27], v[100:103], v[68:75], v0
  s_waitcnt vmcnt(0) lgkmcnt(3)
  ds_read_b128 v[116:119], v2 offset:0
  ds_read_b128 v[124:127], v1 offset:0
  v_smfmac_f32_16x16x64_bf16 v[20:23], v[120:123], v[152:159], v0
  s_waitcnt lgkmcnt(4)
  ds_read_b128 v[104:107], v2 offset:6144
  v_smfmac_f32_16x16x64_bf16 v[24:27], v[120:123], v[76:83], v0
  s_waitcnt lgkmcnt(4)
  ds_read_b128 v[108:111], v1 offset:6144
  ds_read_b128 v[112:115], v2 offset:5120
  ds_read_b128 v[84:87], v1 offset:5120
  ds_read_b128 v[88:91], v2 offset:4096
  ds_read_b128 v[100:103], v1 offset:4096
  ds_read_b128 v[68:71], v4 offset:16384
  ds_read_b128 v[72:75], v4 offset:17408
  ds_read_b128 v[76:79], v4 offset:18432
  ds_read_b128 v[80:83], v4 offset:19456
  v_smfmac_f32_16x16x64_bf16 v[20:23], v[92:95], v[176:183], v0
  s_waitcnt lgkmcnt(12)
  v_smfmac_f32_16x16x64_bf16 v[20:23], v[96:99], v[184:191], v0
  s_waitcnt lgkmcnt(2)
  v_smfmac_f32_16x16x64_bf16 v[20:23], v[116:119], v[68:75], v0
  s_waitcnt lgkmcnt(0)
  ds_read_b128 v[68:71], v4 offset:20480
  v_smfmac_f32_16x16x64_bf16 v[20:23], v[124:127], v[76:83], v0
  ds_read_b128 v[72:75], v4 offset:21504
  v_smfmac_f32_16x16x64_bf16 v[20:23], v[104:107], a[32:39], v0
  ds_read_b128 v[76:79], v4 offset:22528
  v_smfmac_f32_16x16x64_bf16 v[20:23], v[108:111], a[40:47], v0
  ds_read_b128 v[80:83], v4 offset:23552
  v_smfmac_f32_16x16x64_bf16 v[20:23], v[112:115], a[80:87], v0
  v_smfmac_f32_16x16x64_bf16 v[20:23], v[84:87], a[88:95], v0
  v_smfmac_f32_16x16x64_bf16 v[20:23], v[88:91], a[128:135], v0
  v_smfmac_f32_16x16x64_bf16 v[20:23], v[100:103], a[136:143], v0
  s_waitcnt lgkmcnt(2)
  v_smfmac_f32_16x16x64_bf16 v[24:27], v[92:95], v[68:75], v0
  s_waitcnt lgkmcnt(0)
  v_smfmac_f32_16x16x64_bf16 v[24:27], v[96:99], v[76:83], v0
  v_smfmac_f32_16x16x64_bf16 v[24:27], v[116:119], v[208:215], v0
  v_smfmac_f32_16x16x64_bf16 v[24:27], v[124:127], v[216:223], v0
  v_smfmac_f32_16x16x64_bf16 v[24:27], v[104:107], a[48:55], v0
  v_smfmac_f32_16x16x64_bf16 v[24:27], v[108:111], a[56:63], v0
  v_smfmac_f32_16x16x64_bf16 v[24:27], v[112:115], a[96:103], v0
  v_smfmac_f32_16x16x64_bf16 v[24:27], v[84:87], a[104:111], v0
  v_smfmac_f32_16x16x64_bf16 v[24:27], v[88:91], a[144:151], v0
  v_smfmac_f32_16x16x64_bf16 v[24:27], v[100:103], a[152:159], v0
  v_cvt_pk_bf16_f32 v122, v20, v21
  v_cvt_pk_bf16_f32 v123, v22, v23
  s_nop 5
  v_cvt_pk_bf16_f32 v120, v24, v25
  v_cvt_pk_bf16_f32 v121, v26, v27
  buffer_store_dwordx4 v[120:123], v2, s[4:7], s29 offen offset:3072 sc1
  s_branch M_tdone
M_tdone:
  v_mov_b32 v16, 64
  v_or_b32 v17, s13, v2
  v_min_u32 v17, 1, v17
  v_lshlrev_b32 v17, 30, v17
  s_waitcnt vmcnt(0)
  s_barrier
  buffer_store_dword v16, v17, s[4:7], s15 offen sc1
  s_branch M_done
M_worker:
  s_load_dwordx4 s[72:75], s[0:1], 120
  v_lshrrev_b32 v3, 6, v0
  v_and_b32 v1, 63, v0
  v_readfirstlane_b32 s16, v3
  v_lshlrev_b32 v2, 4, v1
  s_waitcnt lgkmcnt(0)
  s_mov_b64 s[4:5], s[74:75]
  s_mov_b64 s[74:75], s[72:73]
  s_mov_b64 s[72:73], s[4:5]
  s_and_b32 s5, s5, 0xffff
  s_mov_b32 s6, 268435456
  s_mov_b32 s7, 0x20000
  s_sub_u32 s66, s76, 1
  s_lshl_b32 s66, s66, 5
  s_add_u32 s66, s66, s77
  s_mul_i32 s64, s66, 9363
  s_lshr_b32 s64, s64, 16
  s_mul_i32 s67, s64, 7
  s_sub_u32 s65, s66, s67
  s_lshl_b32 s31, s66, 7
  s_add_u32 s31, s31, 148897792
  s_lshl_b32 s67, s67, 7
  s_add_u32 s67, s67, 148897792
  s_getpc_b64 s[76:77]
M_pc:
  s_add_u32 s76, s76, M_table-M_pc
  s_addc_u32 s77, s77, 0
  s_lshl_b32 s26, s65, 6
  s_load_dwordx16 s[48:63], s[76:77], s26
  s_waitcnt lgkmcnt(0)
  s_mov_b32 s23, s51
  s_cmp_lg_u32 s48, 1
  s_cbranch_scc1 M_nobpf
  s_load_dwordx8 s[36:43], s[0:1], 64
  s_mul_i32 s76, s64, 3
  s_add_u32 s76, s76, s57
  v_lshlrev_b32 v4, 7, v0
  s_mov_b32 s10, 4194304
  s_mov_b32 s11, 0x20000
  s_waitcnt lgkmcnt(0)
  s_mov_b32 s8, s42
  s_and_b32 s9, s43, 0xffff
  s_mul_i32 s77, s76, 43776
  s_add_u32 s77, s77, 0
  v_min_u32 v5, 32640, v4
  v_add_u32 v5, s77, v5
  s_add_u32 s77, s77, 32768
  buffer_load_dword v6, v5, s[8:11], 0 offen
  v_min_u32 v5, 10880, v4
  v_add_u32 v5, s77, v5
  s_add_u32 s77, s77, 32768
  buffer_load_dword v6, v5, s[8:11], 0 offen
  s_mov_b32 s8, s38
  s_and_b32 s9, s39, 0xffff
  s_mul_i32 s77, s76, 21888
  s_add_u32 s77, s77, 2097152
  v_min_u32 v5, 21760, v4
  v_add_u32 v5, s77, v5
  s_add_u32 s77, s77, 32768
  buffer_load_dword v6, v5, s[8:11], 0 offen
  s_mov_b32 s8, s40
  s_and_b32 s9, s41, 0xffff
  s_mul_i32 s77, s76, 21888
  s_add_u32 s77, s77, 2097152
  v_min_u32 v5, 21760, v4
  v_add_u32 v5, s77, v5
  s_add_u32 s77, s77, 32768
  buffer_load_dword v6, v5, s[8:11], 0 offen
  s_mov_b32 s8, s36
  s_and_b32 s9, s37, 0xffff
  s_mul_i32 s77, s76, 21888
  s_add_u32 s77, s77, 2097152
  v_min_u32 v5, 21760, v4
  v_add_u32 v5, s77, v5
  s_add_u32 s77, s77, 32768
  buffer_load_dword v6, v5, s[8:11], 0 offen
  s_waitcnt vmcnt(0)
M_nobpf:
  s_lshr_b32 s29, s16, 1
  s_cmp_eq_u32 s29, 0
  s_cselect_b32 s26, 2, 8
  s_cselect_b32 s27, 3, 4
  s_cselect_b32 s28, 9, 10
  s_cmp_eq_u32 s48, 1
  s_cselect_b32 s26, s27, s26
  s_cmp_eq_u32 s48, 2
  s_cselect_b32 s26, s28, s26
  s_lshl_b32 s26, s26, 3
  s_load_dwordx2 s[8:9], s[0:1], s26
  s_cmp_eq_u32 s48, 1
  s_cselect_b32 s26, 8, 0
  s_load_dwordx2 s[12:13], s[0:1], s26
  s_cmp_eq_u32 s29, 0
  s_cselect_b32 s21, 0, 3
  s_cselect_b32 s27, 1, 2
  s_cselect_b32 s28, 4, 5
  s_cmp_eq_u32 s48, 1
  s_cselect_b32 s21, s27, s21
  s_cmp_eq_u32 s48, 2
  s_cselect_b32 s21, s28, s21
  s_lshl_b32 s21, s21, 5
  s_add_u32 s21, s21, s64
  s_lshl_b32 s21, s21, 6
  s_add_u32 s21, s21, s49
  s_and_b32 s27, s16, 1
  s_lshl_b32 s21, s21, 1
  s_add_u32 s21, s21, s27
  s_lshl_b32 s21, s21, 12
  s_lshl_b32 s22, s50, 13
  s_lshl_b32 s19, s49, 15
  s_lshl_b32 s20, s50, 15
  s_lshl_b32 s17, s64, 1
  s_add_u32 s17, s17, s27
  s_lshl_b32 s17, s17, 7
  s_mov_b32 s18, 8192
  s_mov_b32 s24, 0x3e0293ee
  s_waitcnt lgkmcnt(0)
  s_and_b32 s9, s9, 0xffff
  s_mov_b32 s10, 4194304
  s_mov_b32 s11, 0x20000
  s_and_b32 s13, s13, 0xffff
  s_mov_b32 s14, 2097152
  s_mov_b32 s15, 0x20000
  s_cmp_eq_u32 s48, 0
  s_cselect_b32 s32, 0, s16
  s_lshr_b32 s32, s32, 1
  v_lshrrev_b32 v144, 4, v1
  v_and_b32 v56, 0xff, v2
  v_lshl_add_u32 v56, v144, 9, v56
  v_and_b32 v146, 15, v1
  v_and_b32 v144, 8, v1
  v_add_u32 v144, v144, v146
  s_cmp_lg_u32 s32, 0
  s_cselect_b64 vcc, -1, 0
  s_cselect_b32 s26, 8, 16
  v_cndmask_b32 v144, v146, v144, vcc
  v_lshrrev_b32 v145, 4, v1
  v_add_u32 v148, s26, v144
  v_xor_b32 v147, 0, v145
  v_xor_b32 v147, v147, v146
  v_lshlrev_b32 v147, 4, v147
  v_lshl_add_u32 v8, v144, 8, v147
  v_xor_b32 v147, 8, v145
  v_xor_b32 v147, v147, v146
  v_lshlrev_b32 v147, 4, v147
  v_lshl_add_u32 v9, v148, 8, v147
  v_xor_b32 v147, 4, v145
  v_xor_b32 v147, v147, v146
  v_lshlrev_b32 v147, 4, v147
  v_lshl_add_u32 v10, v144, 8, v147
  v_xor_b32 v147, 12, v145
  v_xor_b32 v147, v147, v146
  v_lshlrev_b32 v147, 4, v147
  v_lshl_add_u32 v11, v148, 8, v147
  v_xor_b32 v147, 8, v145
  v_xor_b32 v147, v147, v146
  v_lshlrev_b32 v147, 4, v147
  v_lshl_add_u32 v12, v144, 8, v147
  v_xor_b32 v147, 0, v145
  v_xor_b32 v147, v147, v146
  v_lshlrev_b32 v147, 4, v147
  v_lshl_add_u32 v13, v148, 8, v147
  v_xor_b32 v147, 12, v145
  v_xor_b32 v147, v147, v146
  v_lshlrev_b32 v147, 4, v147
  v_lshl_add_u32 v14, v144, 8, v147
  v_xor_b32 v147, 4, v145
  v_xor_b32 v147, v147, v146
  v_lshlrev_b32 v147, 4, v147
  v_lshl_add_u32 v15, v148, 8, v147
  v_lshrrev_b32 v144, 4, v1
  s_lshl_b32 s26, s16, 8
  v_add_u32 v145, 0, v144
  v_or_b32 v147, 0, v144
  v_xor_b32 v147, v147, v146
  v_lshlrev_b32 v147, 4, v147
  v_lshl_add_u32 v147, v145, 10, v147
  v_add_u32 v16, s26, v147
  v_add_u32 v145, 4, v144
  v_or_b32 v147, 4, v144
  v_xor_b32 v147, v147, v146
  v_lshlrev_b32 v147, 4, v147
  v_lshl_add_u32 v147, v145, 10, v147
  v_add_u32 v17, s26, v147
  v_add_u32 v145, 8, v144
  v_or_b32 v147, 8, v144
  v_xor_b32 v147, v147, v146
  v_lshlrev_b32 v147, 4, v147
  v_lshl_add_u32 v147, v145, 10, v147
  v_add_u32 v18, s26, v147
  v_add_u32 v145, 12, v144
  v_or_b32 v147, 12, v144
  v_xor_b32 v147, v147, v146
  v_lshlrev_b32 v147, 4, v147
  v_lshl_add_u32 v147, v145, 10, v147
  v_add_u32 v19, s26, v147
  v_add_u32 v145, 16, v144
  v_or_b32 v147, 8, v144
  v_xor_b32 v147, v147, v146
  v_lshlrev_b32 v147, 4, v147
  v_lshl_add_u32 v147, v145, 10, v147
  v_add_u32 v20, s26, v147
  v_add_u32 v145, 20, v144
  v_or_b32 v147, 12, v144
  v_xor_b32 v147, v147, v146
  v_lshlrev_b32 v147, 4, v147
  v_lshl_add_u32 v147, v145, 10, v147
  v_add_u32 v21, s26, v147
  v_add_u32 v145, 24, v144
  v_or_b32 v147, 0, v144
  v_xor_b32 v147, v147, v146
  v_lshlrev_b32 v147, 4, v147
  v_lshl_add_u32 v147, v145, 10, v147
  v_add_u32 v22, s26, v147
  v_add_u32 v145, 28, v144
  v_or_b32 v147, 4, v144
  v_xor_b32 v147, v147, v146
  v_lshlrev_b32 v147, 4, v147
  v_lshl_add_u32 v147, v145, 10, v147
  v_add_u32 v23, s26, v147
  v_lshrrev_b32 v144, 3, v1
  v_mul_lo_u32 v144, v144, s18
  v_and_b32 v145, 7, v1
  v_lshl_add_u32 v144, v145, 4, v144
  s_lshl_b32 s28, s16, 15
  s_add_u32 s28, s28, 32768
  s_lshl_b32 s29, s18, 3
  s_add_u32 m0, s28, 0
  s_nop 0
  buffer_load_dwordx4 v144, s[8:11], s17 offen lds
  s_add_u32 s17, s17, s29
  s_add_u32 m0, s28, 1024
  s_nop 0
  buffer_load_dwordx4 v144, s[8:11], s17 offen lds
  s_add_u32 s17, s17, s29
  s_add_u32 m0, s28, 2048
  s_nop 0
  buffer_load_dwordx4 v144, s[8:11], s17 offen lds
  s_add_u32 s17, s17, s29
  s_add_u32 m0, s28, 3072
  s_nop 0
  buffer_load_dwordx4 v144, s[8:11], s17 offen lds
  s_add_u32 s17, s17, s29
  s_add_u32 m0, s28, 4096
  s_nop 0
  buffer_load_dwordx4 v144, s[8:11], s17 offen lds
  s_add_u32 s17, s17, s29
  s_add_u32 m0, s28, 5120
  s_nop 0
  buffer_load_dwordx4 v144, s[8:11], s17 offen lds
  s_add_u32 s17, s17, s29
  s_add_u32 m0, s28, 6144
  s_nop 0
  buffer_load_dwordx4 v144, s[8:11], s17 offen lds
  s_add_u32 s17, s17, s29
  s_add_u32 m0, s28, 7168
  s_nop 0
  buffer_load_dwordx4 v144, s[8:11], s17 offen lds
  s_add_u32 s17, s17, s29
  s_add_u32 m0, s28, 8192
  s_nop 0
  buffer_load_dwordx4 v144, s[8:11], s17 offen lds
  s_add_u32 s17, s17, s29
  s_add_u32 m0, s28, 9216
  s_nop 0
  buffer_load_dwordx4 v144, s[8:11], s17 offen lds
  s_add_u32 s17, s17, s29
  s_add_u32 m0, s28, 10240
  s_nop 0
  buffer_load_dwordx4 v144, s[8:11], s17 offen lds
  s_add_u32 s17, s17, s29
  s_add_u32 m0, s28, 11264
  s_nop 0
  buffer_load_dwordx4 v144, s[8:11], s17 offen lds
  s_add_u32 s17, s17, s29
  s_add_u32 m0, s28, 12288
  s_nop 0
  buffer_load_dwordx4 v144, s[8:11], s17 offen lds
  s_add_u32 s17, s17, s29
  s_add_u32 m0, s28, 13312
  s_nop 0
  buffer_load_dwordx4 v144, s[8:11], s17 offen lds
  s_add_u32 s17, s17, s29
  s_add_u32 m0, s28, 14336
  s_nop 0
  buffer_load_dwordx4 v144, s[8:11], s17 offen lds
  s_add_u32 s17, s17, s29
  s_add_u32 m0, s28, 15360
  s_nop 0
  buffer_load_dwordx4 v144, s[8:11], s17 offen lds
  s_add_u32 s17, s17, s29
  s_add_u32 m0, s28, 16384
  s_nop 0
  buffer_load_dwordx4 v144, s[8:11], s17 offen lds
  s_add_u32 s17, s17, s29
  s_add_u32 m0, s28, 17408
  s_nop 0
  buffer_load_dwordx4 v144, s[8:11], s17 offen lds
  s_add_u32 s17, s17, s29
  s_add_u32 m0, s28, 18432
  s_nop 0
  buffer_load_dwordx4 v144, s[8:11], s17 offen lds
  s_add_u32 s17, s17, s29
  s_add_u32 m0, s28, 19456
  s_nop 0
  buffer_load_dwordx4 v144, s[8:11], s17 offen lds
  s_add_u32 s17, s17, s29
  s_add_u32 m0, s28, 20480
  s_nop 0
  buffer_load_dwordx4 v144, s[8:11], s17 offen lds
  s_add_u32 s17, s17, s29
  s_add_u32 m0, s28, 21504
  s_nop 0
  buffer_load_dwordx4 v144, s[8:11], s17 offen lds
  s_add_u32 s17, s17, s29
  s_add_u32 m0, s28, 22528
  s_nop 0
  buffer_load_dwordx4 v144, s[8:11], s17 offen lds
  s_add_u32 s17, s17, s29
  s_add_u32 m0, s28, 23552
  s_nop 0
  buffer_load_dwordx4 v144, s[8:11], s17 offen lds
  s_add_u32 s17, s17, s29
  s_add_u32 m0, s28, 24576
  s_nop 0
  buffer_load_dwordx4 v144, s[8:11], s17 offen lds
  s_add_u32 s17, s17, s29
  s_add_u32 m0, s28, 25600
  s_nop 0
  buffer_load_dwordx4 v144, s[8:11], s17 offen lds
  s_add_u32 s17, s17, s29
  s_add_u32 m0, s28, 26624
  s_nop 0
  buffer_load_dwordx4 v144, s[8:11], s17 offen lds
  s_add_u32 s17, s17, s29
  s_add_u32 m0, s28, 27648
  s_nop 0
  buffer_load_dwordx4 v144, s[8:11], s17 offen lds
  s_add_u32 s17, s17, s29
  s_add_u32 m0, s28, 28672
  s_nop 0
  buffer_load_dwordx4 v144, s[8:11], s17 offen lds
  s_add_u32 s17, s17, s29
  s_add_u32 m0, s28, 29696
  s_nop 0
  buffer_load_dwordx4 v144, s[8:11], s17 offen lds
  s_add_u32 s17, s17, s29
  s_add_u32 m0, s28, 30720
  s_nop 0
  buffer_load_dwordx4 v144, s[8:11], s17 offen lds
  s_add_u32 s17, s17, s29
  s_add_u32 m0, s28, 31744
  s_nop 0
  buffer_load_dwordx4 v144, s[8:11], s17 offen lds
  s_add_u32 s17, s17, s29
  s_lshl_b32 s25, s16, 13
  s_add_u32 m0, s25, 0
  s_nop 0
  buffer_load_dwordx4 v16, s[12:15], s19 offen lds
  s_add_u32 m0, s25, 1024
  s_nop 0
  buffer_load_dwordx4 v17, s[12:15], s19 offen lds
  s_add_u32 m0, s25, 2048
  s_nop 0
  buffer_load_dwordx4 v18, s[12:15], s19 offen lds
  s_add_u32 m0, s25, 3072
  s_nop 0
  buffer_load_dwordx4 v19, s[12:15], s19 offen lds
  s_add_u32 m0, s25, 4096
  s_nop 0
  buffer_load_dwordx4 v20, s[12:15], s19 offen lds
  s_add_u32 m0, s25, 5120
  s_nop 0
  buffer_load_dwordx4 v21, s[12:15], s19 offen lds
  s_add_u32 m0, s25, 6144
  s_nop 0
  buffer_load_dwordx4 v22, s[12:15], s19 offen lds
  s_add_u32 m0, s25, 7168
  s_nop 0
  buffer_load_dwordx4 v23, s[12:15], s19 offen lds
  s_cmp_gt_u32 s23, 1
  s_cselect_b32 s26, s20, 0
  s_add_u32 s19, s19, s26
  s_add_u32 s25, s25, 32768
  s_and_b32 s25, s25, 0x1ffff
  s_cmp_lg_u32 s16, 3
  s_cbranch_scc1 M_noinit
  s_mov_b32 s79, 0
  s_atomic_swap s79, s[72:73], s31 glc
  s_waitcnt lgkmcnt(0)
  s_mov_b32 s79, 1
  s_atomic_add s79, s[74:75], 128
M_noinit:
  s_cmp_lg_u32 s65, 3
  s_cbranch_scc1 M_noarm
  v_lshlrev_b32 v4, 4, v0
  v_mov_b64 v[60:61], -1
  v_mov_b64 v[62:63], -1
  s_mul_i32 s76, s64, 4096
  s_add_u32 s77, s76, 142868480
  buffer_store_dwordx4 v[60:63], v4, s[4:7], s77 offen sc1
  s_add_u32 s77, s76, 142999552
  buffer_store_dwordx4 v[60:63], v4, s[4:7], s77 offen sc1
  s_add_u32 s77, s76, 143130624
  buffer_store_dwordx4 v[60:63], v4, s[4:7], s77 offen sc1
  s_add_u32 s77, s76, 143261696
  buffer_store_dwordx4 v[60:63], v4, s[4:7], s77 offen sc1
  s_add_u32 s77, s76, 143392768
  buffer_store_dwordx4 v[60:63], v4, s[4:7], s77 offen sc1
  s_add_u32 s77, s76, 143523840
  buffer_store_dwordx4 v[60:63], v4, s[4:7], s77 offen sc1
M_noarm:
  s_mul_i32 s76, s64, 3
  s_add_u32 s76, s76, s57
  s_mul_i32 s76, s76, 24576
  v_lshlrev_b32 v4, 7, v0
  v_add_u32 v4, s76, v4
  buffer_load_dword v5, v4, s[12:15], 0 offen
  v_bfe_u32 v148, v1, 2, 2
  v_lshrrev_b32 v149, 5, v1
  v_lshl_add_u32 v148, v149, 4, v148
  v_bfe_u32 v149, v1, 4, 1
  v_lshl_add_u32 v148, v149, 3, v148
  v_and_b32 v149, 3, v1
  v_and_b32 v150, 2, v149
  v_add_u32 v150, v150, v149
  s_cmp_lg_u32 s32, 0
  s_cselect_b64 vcc, -1, 0
  s_cselect_b32 s26, 32, 16
  v_cndmask_b32 v149, v150, v149, vcc
  v_lshlrev_b32 v149, 3, v149
  v_lshl_add_u32 v148, v148, 7, v149
  v_add_u32 v152, s28, v148
  v_add_u32 v153, 512, v152
  v_add_u32 v154, s26, v152
  v_add_u32 v155, s26, v153
  s_waitcnt vmcnt(37)
  ds_read_b64_tr_b16 a[0:1], v152 offset:0
  ds_read_b64_tr_b16 a[2:3], v153 offset:0
  ds_read_b64_tr_b16 a[4:5], v154 offset:0
  ds_read_b64_tr_b16 a[6:7], v155 offset:0
  ds_read_b64_tr_b16 a[8:9], v152 offset:64
  ds_read_b64_tr_b16 a[10:11], v153 offset:64
  ds_read_b64_tr_b16 a[12:13], v154 offset:64
  ds_read_b64_tr_b16 a[14:15], v155 offset:64
  s_waitcnt lgkmcnt(0)
  s_add_u32 m0, s28, 0
  s_nop 0
  buffer_load_dwordx4 v144, s[8:11], s17 offen lds
  s_add_u32 s17, s17, s29
  s_add_u32 m0, s28, 1024
  s_nop 0
  buffer_load_dwordx4 v144, s[8:11], s17 offen lds
  s_add_u32 s17, s17, s29
  s_add_u32 m0, s28, 2048
  s_nop 0
  buffer_load_dwordx4 v144, s[8:11], s17 offen lds
  s_add_u32 s17, s17, s29
  s_add_u32 m0, s28, 3072
  s_nop 0
  buffer_load_dwordx4 v144, s[8:11], s17 offen lds
  s_add_u32 s17, s17, s29
  s_waitcnt vmcnt(37)
  ds_read_b64_tr_b16 a[16:17], v152 offset:4096
  ds_read_b64_tr_b16 a[18:19], v153 offset:4096
  ds_read_b64_tr_b16 a[20:21], v154 offset:4096
  ds_read_b64_tr_b16 a[22:23], v155 offset:4096
  ds_read_b64_tr_b16 a[24:25], v152 offset:4160
  ds_read_b64_tr_b16 a[26:27], v153 offset:4160
  ds_read_b64_tr_b16 a[28:29], v154 offset:4160
  ds_read_b64_tr_b16 a[30:31], v155 offset:4160
  s_waitcnt lgkmcnt(0)
  s_add_u32 m0, s28, 4096
  s_nop 0
  buffer_load_dwordx4 v144, s[8:11], s17 offen lds
  s_add_u32 s17, s17, s29
  s_add_u32 m0, s28, 5120
  s_nop 0
  buffer_load_dwordx4 v144, s[8:11], s17 offen lds
  s_add_u32 s17, s17, s29
  s_add_u32 m0, s28, 6144
  s_nop 0
  buffer_load_dwordx4 v144, s[8:11], s17 offen lds
  s_add_u32 s17, s17, s29
  s_add_u32 m0, s28, 7168
  s_nop 0
  buffer_load_dwordx4 v144, s[8:11], s17 offen lds
  s_add_u32 s17, s17, s29
  s_waitcnt vmcnt(37)
  ds_read_b64_tr_b16 a[32:33], v152 offset:8192
  ds_read_b64_tr_b16 a[34:35], v153 offset:8192
  ds_read_b64_tr_b16 a[36:37], v154 offset:8192
  ds_read_b64_tr_b16 a[38:39], v155 offset:8192
  ds_read_b64_tr_b16 a[40:41], v152 offset:8256
  ds_read_b64_tr_b16 a[42:43], v153 offset:8256
  ds_read_b64_tr_b16 a[44:45], v154 offset:8256
  ds_read_b64_tr_b16 a[46:47], v155 offset:8256
  s_waitcnt lgkmcnt(0)
  s_add_u32 m0, s28, 8192
  s_nop 0
  buffer_load_dwordx4 v144, s[8:11], s17 offen lds
  s_add_u32 s17, s17, s29
  s_add_u32 m0, s28, 9216
  s_nop 0
  buffer_load_dwordx4 v144, s[8:11], s17 offen lds
  s_add_u32 s17, s17, s29
  s_add_u32 m0, s28, 10240
  s_nop 0
  buffer_load_dwordx4 v144, s[8:11], s17 offen lds
  s_add_u32 s17, s17, s29
  s_add_u32 m0, s28, 11264
  s_nop 0
  buffer_load_dwordx4 v144, s[8:11], s17 offen lds
  s_add_u32 s17, s17, s29
  s_waitcnt vmcnt(37)
  ds_read_b64_tr_b16 a[48:49], v152 offset:12288
  ds_read_b64_tr_b16 a[50:51], v153 offset:12288
  ds_read_b64_tr_b16 a[52:53], v154 offset:12288
  ds_read_b64_tr_b16 a[54:55], v155 offset:12288
  ds_read_b64_tr_b16 a[56:57], v152 offset:12352
  ds_read_b64_tr_b16 a[58:59], v153 offset:12352
  ds_read_b64_tr_b16 a[60:61], v154 offset:12352
  ds_read_b64_tr_b16 a[62:63], v155 offset:12352
  s_waitcnt lgkmcnt(0)
  s_add_u32 m0, s28, 12288
  s_nop 0
  buffer_load_dwordx4 v144, s[8:11], s17 offen lds
  s_add_u32 s17, s17, s29
  s_add_u32 m0, s28, 13312
  s_nop 0
  buffer_load_dwordx4 v144, s[8:11], s17 offen lds
  s_add_u32 s17, s17, s29
  s_add_u32 m0, s28, 14336
  s_nop 0
  buffer_load_dwordx4 v144, s[8:11], s17 offen lds
  s_add_u32 s17, s17, s29
  s_add_u32 m0, s28, 15360
  s_nop 0
  buffer_load_dwordx4 v144, s[8:11], s17 offen lds
  s_add_u32 s17, s17, s29
  s_waitcnt vmcnt(37)
  ds_read_b64_tr_b16 a[64:65], v152 offset:16384
  ds_read_b64_tr_b16 a[66:67], v153 offset:16384
  ds_read_b64_tr_b16 a[68:69], v154 offset:16384
  ds_read_b64_tr_b16 a[70:71], v155 offset:16384
  ds_read_b64_tr_b16 a[72:73], v152 offset:16448
  ds_read_b64_tr_b16 a[74:75], v153 offset:16448
  ds_read_b64_tr_b16 a[76:77], v154 offset:16448
  ds_read_b64_tr_b16 a[78:79], v155 offset:16448
  s_waitcnt lgkmcnt(0)
  s_add_u32 m0, s28, 16384
  s_nop 0
  buffer_load_dwordx4 v144, s[8:11], s17 offen lds
  s_add_u32 s17, s17, s29
  s_add_u32 m0, s28, 17408
  s_nop 0
  buffer_load_dwordx4 v144, s[8:11], s17 offen lds
  s_add_u32 s17, s17, s29
  s_add_u32 m0, s28, 18432
  s_nop 0
  buffer_load_dwordx4 v144, s[8:11], s17 offen lds
  s_add_u32 s17, s17, s29
  s_add_u32 m0, s28, 19456
  s_nop 0
  buffer_load_dwordx4 v144, s[8:11], s17 offen lds
  s_add_u32 s17, s17, s29
  s_waitcnt vmcnt(37)
  ds_read_b64_tr_b16 a[80:81], v152 offset:20480
  ds_read_b64_tr_b16 a[82:83], v153 offset:20480
  ds_read_b64_tr_b16 a[84:85], v154 offset:20480
  ds_read_b64_tr_b16 a[86:87], v155 offset:20480
  ds_read_b64_tr_b16 a[88:89], v152 offset:20544
  ds_read_b64_tr_b16 a[90:91], v153 offset:20544
  ds_read_b64_tr_b16 a[92:93], v154 offset:20544
  ds_read_b64_tr_b16 a[94:95], v155 offset:20544
  s_waitcnt lgkmcnt(0)
  s_add_u32 m0, s28, 20480
  s_nop 0
  buffer_load_dwordx4 v144, s[8:11], s17 offen lds
  s_add_u32 s17, s17, s29
  s_add_u32 m0, s28, 21504
  s_nop 0
  buffer_load_dwordx4 v144, s[8:11], s17 offen lds
  s_add_u32 s17, s17, s29
  s_add_u32 m0, s28, 22528
  s_nop 0
  buffer_load_dwordx4 v144, s[8:11], s17 offen lds
  s_add_u32 s17, s17, s29
  s_add_u32 m0, s28, 23552
  s_nop 0
  buffer_load_dwordx4 v144, s[8:11], s17 offen lds
  s_add_u32 s17, s17, s29
  s_waitcnt vmcnt(37)
  ds_read_b64_tr_b16 a[96:97], v152 offset:24576
  ds_read_b64_tr_b16 a[98:99], v153 offset:24576
  ds_read_b64_tr_b16 a[100:101], v154 offset:24576
  ds_read_b64_tr_b16 a[102:103], v155 offset:24576
  ds_read_b64_tr_b16 a[104:105], v152 offset:24640
  ds_read_b64_tr_b16 a[106:107], v153 offset:24640
  ds_read_b64_tr_b16 a[108:109], v154 offset:24640
  ds_read_b64_tr_b16 a[110:111], v155 offset:24640
  s_waitcnt lgkmcnt(0)
  s_add_u32 m0, s28, 24576
  s_nop 0
  buffer_load_dwordx4 v144, s[8:11], s17 offen lds
  s_add_u32 s17, s17, s29
  s_add_u32 m0, s28, 25600
  s_nop 0
  buffer_load_dwordx4 v144, s[8:11], s17 offen lds
  s_add_u32 s17, s17, s29
  s_add_u32 m0, s28, 26624
  s_nop 0
  buffer_load_dwordx4 v144, s[8:11], s17 offen lds
  s_add_u32 s17, s17, s29
  s_add_u32 m0, s28, 27648
  s_nop 0
  buffer_load_dwordx4 v144, s[8:11], s17 offen lds
  s_add_u32 s17, s17, s29
  s_waitcnt vmcnt(37)
  ds_read_b64_tr_b16 a[112:113], v152 offset:28672
  ds_read_b64_tr_b16 a[114:115], v153 offset:28672
  ds_read_b64_tr_b16 a[116:117], v154 offset:28672
  ds_read_b64_tr_b16 a[118:119], v155 offset:28672
  ds_read_b64_tr_b16 a[120:121], v152 offset:28736
  ds_read_b64_tr_b16 a[122:123], v153 offset:28736
  ds_read_b64_tr_b16 a[124:125], v154 offset:28736
  ds_read_b64_tr_b16 a[126:127], v155 offset:28736
  s_waitcnt lgkmcnt(0)
  s_add_u32 m0, s28, 28672
  s_nop 0
  buffer_load_dwordx4 v144, s[8:11], s17 offen lds
  s_add_u32 s17, s17, s29
  s_add_u32 m0, s28, 29696
  s_nop 0
  buffer_load_dwordx4 v144, s[8:11], s17 offen lds
  s_add_u32 s17, s17, s29
  s_add_u32 m0, s28, 30720
  s_nop 0
  buffer_load_dwordx4 v144, s[8:11], s17 offen lds
  s_add_u32 s17, s17, s29
  s_add_u32 m0, s28, 31744
  s_nop 0
  buffer_load_dwordx4 v144, s[8:11], s17 offen lds
  s_add_u32 s17, s17, s29
  s_waitcnt vmcnt(28)
  ds_read_b64_tr_b16 a[128:129], v152 offset:0
  ds_read_b64_tr_b16 a[130:131], v153 offset:0
  ds_read_b64_tr_b16 a[132:133], v154 offset:0
  ds_read_b64_tr_b16 a[134:135], v155 offset:0
  ds_read_b64_tr_b16 a[136:137], v152 offset:64
  ds_read_b64_tr_b16 a[138:139], v153 offset:64
  ds_read_b64_tr_b16 a[140:141], v154 offset:64
  ds_read_b64_tr_b16 a[142:143], v155 offset:64
  s_waitcnt lgkmcnt(0)
  s_waitcnt vmcnt(24)
  ds_read_b64_tr_b16 a[144:145], v152 offset:4096
  ds_read_b64_tr_b16 a[146:147], v153 offset:4096
  ds_read_b64_tr_b16 a[148:149], v154 offset:4096
  ds_read_b64_tr_b16 a[150:151], v155 offset:4096
  ds_read_b64_tr_b16 a[152:153], v152 offset:4160
  ds_read_b64_tr_b16 a[154:155], v153 offset:4160
  ds_read_b64_tr_b16 a[156:157], v154 offset:4160
  ds_read_b64_tr_b16 a[158:159], v155 offset:4160
  s_waitcnt lgkmcnt(0)
  s_waitcnt vmcnt(20)
  ds_read_b64_tr_b16 a[160:161], v152 offset:8192
  ds_read_b64_tr_b16 a[162:163], v153 offset:8192
  ds_read_b64_tr_b16 a[164:165], v154 offset:8192
  ds_read_b64_tr_b16 a[166:167], v155 offset:8192
  ds_read_b64_tr_b16 a[168:169], v152 offset:8256
  ds_read_b64_tr_b16 a[170:171], v153 offset:8256
  ds_read_b64_tr_b16 a[172:173], v154 offset:8256
  ds_read_b64_tr_b16 a[174:175], v155 offset:8256
  s_waitcnt lgkmcnt(0)
  s_waitcnt vmcnt(16)
  ds_read_b64_tr_b16 a[176:177], v152 offset:12288
  ds_read_b64_tr_b16 a[178:179], v153 offset:12288
  ds_read_b64_tr_b16 a[180:181], v154 offset:12288
  ds_read_b64_tr_b16 a[182:183], v155 offset:12288
  ds_read_b64_tr_b16 a[184:185], v152 offset:12352
  ds_read_b64_tr_b16 a[186:187], v153 offset:12352
  ds_read_b64_tr_b16 a[188:189], v154 offset:12352
  ds_read_b64_tr_b16 a[190:191], v155 offset:12352
  s_waitcnt lgkmcnt(0)
  s_waitcnt vmcnt(12)
  ds_read_b64_tr_b16 a[192:193], v152 offset:16384
  ds_read_b64_tr_b16 a[194:195], v153 offset:16384
  ds_read_b64_tr_b16 a[196:197], v154 offset:16384
  ds_read_b64_tr_b16 a[198:199], v155 offset:16384
  ds_read_b64_tr_b16 a[200:201], v152 offset:16448
  ds_read_b64_tr_b16 a[202:203], v153 offset:16448
  ds_read_b64_tr_b16 a[204:205], v154 offset:16448
  ds_read_b64_tr_b16 a[206:207], v155 offset:16448
  s_waitcnt lgkmcnt(0)
  s_waitcnt vmcnt(8)
  ds_read_b64_tr_b16 a[208:209], v152 offset:20480
  ds_read_b64_tr_b16 a[210:211], v153 offset:20480
  ds_read_b64_tr_b16 a[212:213], v154 offset:20480
  ds_read_b64_tr_b16 a[214:215], v155 offset:20480
  ds_read_b64_tr_b16 a[216:217], v152 offset:20544
  ds_read_b64_tr_b16 a[218:219], v153 offset:20544
  ds_read_b64_tr_b16 a[220:221], v154 offset:20544
  ds_read_b64_tr_b16 a[222:223], v155 offset:20544
  s_waitcnt lgkmcnt(0)
  s_waitcnt vmcnt(4)
  ds_read_b64_tr_b16 a[224:225], v152 offset:24576
  ds_read_b64_tr_b16 a[226:227], v153 offset:24576
  ds_read_b64_tr_b16 a[228:229], v154 offset:24576
  ds_read_b64_tr_b16 a[230:231], v155 offset:24576
  ds_read_b64_tr_b16 a[232:233], v152 offset:24640
  ds_read_b64_tr_b16 a[234:235], v153 offset:24640
  ds_read_b64_tr_b16 a[236:237], v154 offset:24640
  ds_read_b64_tr_b16 a[238:239], v155 offset:24640
  s_waitcnt lgkmcnt(0)
  s_waitcnt vmcnt(0)
  ds_read_b64_tr_b16 a[240:241], v152 offset:28672
  ds_read_b64_tr_b16 a[242:243], v153 offset:28672
  ds_read_b64_tr_b16 a[244:245], v154 offset:28672
  ds_read_b64_tr_b16 a[246:247], v155 offset:28672
  ds_read_b64_tr_b16 a[248:249], v152 offset:28736
  ds_read_b64_tr_b16 a[250:251], v153 offset:28736
  ds_read_b64_tr_b16 a[252:253], v154 offset:28736
  ds_read_b64_tr_b16 a[254:255], v155 offset:28736
  s_waitcnt lgkmcnt(0)
  s_barrier
  s_add_u32 m0, s25, 0
  s_nop 0
  buffer_load_dwordx4 v16, s[12:15], s19 offen lds
  s_add_u32 m0, s25, 1024
  s_nop 0
  buffer_load_dwordx4 v17, s[12:15], s19 offen lds
  s_add_u32 m0, s25, 2048
  s_nop 0
  buffer_load_dwordx4 v18, s[12:15], s19 offen lds
  s_add_u32 m0, s25, 3072
  s_nop 0
  buffer_load_dwordx4 v19, s[12:15], s19 offen lds
  s_add_u32 m0, s25, 4096
  s_nop 0
  buffer_load_dwordx4 v20, s[12:15], s19 offen lds
  s_add_u32 m0, s25, 5120
  s_nop 0
  buffer_load_dwordx4 v21, s[12:15], s19 offen lds
  s_add_u32 m0, s25, 6144
  s_nop 0
  buffer_load_dwordx4 v22, s[12:15], s19 offen lds
  s_add_u32 m0, s25, 7168
  s_nop 0
  buffer_load_dwordx4 v23, s[12:15], s19 offen lds
  s_cmp_gt_u32 s23, 2
  s_cselect_b32 s26, s20, 0
  s_add_u32 s19, s19, s26
  s_add_u32 s25, s25, 32768
  s_and_b32 s25, s25, 0x1ffff
  s_waitcnt vmcnt(0)
  s_barrier
  s_load_dwordx2 s[8:9], s[0:1], 40
  s_mul_i32 s76, s66, 18816
  v_min_u32 v200, 146, v0
  v_lshl_add_u32 v200, v200, 7, s76
  s_waitcnt lgkmcnt(0)
  s_and_b32 s9, s9, 0xffff
  buffer_load_dword v201, v200, s[8:11], 0 offen
  s_cmp_lg_u32 s32, 0
  s_cbranch_scc1 P_v_170
  s_cmp_eq_u32 s48, 0
  s_cbranch_scc1 P_q_172
  s_mov_b32 s27, s21
  v_mov_b32 v7, 0x40000000
  s_mov_b32 s29, -2
  v_min_u32 v145, 1, v0
  v_lshlrev_b32 v145, 30, v145
  ds_read_b128 v[24:27], v8 offset:0
  ds_read_b128 v[28:31], v9 offset:0
  ds_read_b128 v[32:35], v10 offset:0
  ds_read_b128 v[36:39], v11 offset:0
  ds_read_b128 v[40:43], v12 offset:0
  ds_read_b128 v[44:47], v13 offset:0
.p2align 6
G_top_173:
  s_waitcnt lgkmcnt(5)
  v_mfma_f32_16x16x32_bf16 v[64:67], a[0:3], v[24:27], 0
  s_add_u32 m0, s25, 0
  ds_read_b128 v[48:51], v14 offset:0
  v_mfma_f32_16x16x32_bf16 v[68:71], a[4:7], v[24:27], 0
  v_mfma_f32_16x16x32_bf16 v[80:83], a[8:11], v[24:27], 0
  buffer_load_dwordx4 v16, s[12:15], s19 offen lds
  v_mfma_f32_16x16x32_bf16 v[84:87], a[12:15], v[24:27], 0
  s_waitcnt lgkmcnt(5)
  v_mfma_f32_16x16x32_bf16 v[72:75], a[0:3], v[28:31], 0
  ds_read_b128 v[52:55], v15 offset:0
  v_mfma_f32_16x16x32_bf16 v[76:79], a[4:7], v[28:31], 0
  v_cvt_pk_bf16_f32 v128, v96, v97
  v_cvt_pk_bf16_f32 v129, v98, v99
  v_mfma_f32_16x16x32_bf16 v[88:91], a[8:11], v[28:31], 0
  v_mfma_f32_16x16x32_bf16 v[92:95], a[12:15], v[28:31], 0
  s_waitcnt lgkmcnt(5)
  v_cvt_pk_bf16_f32 v130, v100, v101
  v_cvt_pk_bf16_f32 v131, v102, v103
  v_mfma_f32_16x16x32_bf16 v[64:67], a[16:19], v[32:35], v[64:67]
  s_add_u32 m0, s25, 1024
  ds_read_b128 v[24:27], v8 offset:8192
  v_mfma_f32_16x16x32_bf16 v[68:71], a[20:23], v[32:35], v[68:71]
  v_mfma_f32_16x16x32_bf16 v[80:83], a[24:27], v[32:35], v[80:83]
  buffer_load_dwordx4 v17, s[12:15], s19 offen lds
  v_mfma_f32_16x16x32_bf16 v[84:87], a[28:31], v[32:35], v[84:87]
  s_waitcnt lgkmcnt(5)
  v_mfma_f32_16x16x32_bf16 v[72:75], a[16:19], v[36:39], v[72:75]
  ds_read_b128 v[28:31], v9 offset:8192
  v_mfma_f32_16x16x32_bf16 v[76:79], a[20:23], v[36:39], v[76:79]
  v_mfma_f32_16x16x32_bf16 v[88:91], a[24:27], v[36:39], v[88:91]
  v_mfma_f32_16x16x32_bf16 v[92:95], a[28:31], v[36:39], v[92:95]
  s_waitcnt lgkmcnt(5)
  v_mfma_f32_16x16x32_bf16 v[64:67], a[32:35], v[40:43], v[64:67]
  s_add_u32 m0, s25, 2048
  ds_read_b128 v[32:35], v10 offset:8192
  v_mfma_f32_16x16x32_bf16 v[68:71], a[36:39], v[40:43], v[68:71]
  v_cvt_pk_bf16_f32 v132, v104, v105
  v_cvt_pk_bf16_f32 v133, v106, v107
  v_mfma_f32_16x16x32_bf16 v[80:83], a[40:43], v[40:43], v[80:83]
  buffer_load_dwordx4 v18, s[12:15], s19 offen lds
  v_mfma_f32_16x16x32_bf16 v[84:87], a[44:47], v[40:43], v[84:87]
  s_waitcnt lgkmcnt(5)
  v_cvt_pk_bf16_f32 v134, v108, v109
  v_cvt_pk_bf16_f32 v135, v110, v111
  v_mfma_f32_16x16x32_bf16 v[72:75], a[32:35], v[44:47], v[72:75]
  ds_read_b128 v[36:39], v11 offset:8192
  v_mfma_f32_16x16x32_bf16 v[76:79], a[36:39], v[44:47], v[76:79]
  v_mfma_f32_16x16x32_bf16 v[88:91], a[40:43], v[44:47], v[88:91]
  v_mfma_f32_16x16x32_bf16 v[92:95], a[44:47], v[44:47], v[92:95]
  s_waitcnt lgkmcnt(5)
  v_mfma_f32_16x16x32_bf16 v[64:67], a[48:51], v[48:51], v[64:67]
  s_add_u32 m0, s25, 3072
  ds_read_b128 v[40:43], v12 offset:8192
  v_mfma_f32_16x16x32_bf16 v[68:71], a[52:55], v[48:51], v[68:71]
  v_mfma_f32_16x16x32_bf16 v[80:83], a[56:59], v[48:51], v[80:83]
  buffer_load_dwordx4 v19, s[12:15], s19 offen lds
  v_mfma_f32_16x16x32_bf16 v[84:87], a[60:63], v[48:51], v[84:87]
  s_waitcnt lgkmcnt(5)
  v_mfma_f32_16x16x32_bf16 v[72:75], a[48:51], v[52:55], v[72:75]
  ds_read_b128 v[44:47], v13 offset:8192
  v_mfma_f32_16x16x32_bf16 v[76:79], a[52:55], v[52:55], v[76:79]
  v_cvt_pk_bf16_f32 v136, v112, v113
  v_cvt_pk_bf16_f32 v137, v114, v115
  v_mfma_f32_16x16x32_bf16 v[88:91], a[56:59], v[52:55], v[88:91]
  v_mfma_f32_16x16x32_bf16 v[92:95], a[60:63], v[52:55], v[92:95]
  s_waitcnt lgkmcnt(5)
  v_cvt_pk_bf16_f32 v138, v116, v117
  v_cvt_pk_bf16_f32 v139, v118, v119
  v_mfma_f32_16x16x32_bf16 v[64:67], a[64:67], v[24:27], v[64:67]
  s_add_u32 m0, s25, 4096
  ds_read_b128 v[48:51], v14 offset:8192
  v_mfma_f32_16x16x32_bf16 v[68:71], a[68:71], v[24:27], v[68:71]
  v_mfma_f32_16x16x32_bf16 v[80:83], a[72:75], v[24:27], v[80:83]
  buffer_load_dwordx4 v20, s[12:15], s19 offen lds
  v_mfma_f32_16x16x32_bf16 v[84:87], a[76:79], v[24:27], v[84:87]
  s_waitcnt lgkmcnt(5)
  v_mfma_f32_16x16x32_bf16 v[72:75], a[64:67], v[28:31], v[72:75]
  ds_read_b128 v[52:55], v15 offset:8192
  v_mfma_f32_16x16x32_bf16 v[76:79], a[68:71], v[28:31], v[76:79]
  v_mfma_f32_16x16x32_bf16 v[88:91], a[72:75], v[28:31], v[88:91]
  v_mfma_f32_16x16x32_bf16 v[92:95], a[76:79], v[28:31], v[92:95]
  s_waitcnt lgkmcnt(5)
  v_mfma_f32_16x16x32_bf16 v[64:67], a[80:83], v[32:35], v[64:67]
  s_add_u32 m0, s25, 5120
  ds_read_b128 v[24:27], v8 offset:16384
  v_mfma_f32_16x16x32_bf16 v[68:71], a[84:87], v[32:35], v[68:71]
  v_cvt_pk_bf16_f32 v140, v120, v121
  v_cvt_pk_bf16_f32 v141, v122, v123
  v_mfma_f32_16x16x32_bf16 v[80:83], a[88:91], v[32:35], v[80:83]
  buffer_load_dwordx4 v21, s[12:15], s19 offen lds
  v_mfma_f32_16x16x32_bf16 v[84:87], a[92:95], v[32:35], v[84:87]
  s_waitcnt lgkmcnt(5)
  v_cvt_pk_bf16_f32 v142, v124, v125
  v_cvt_pk_bf16_f32 v143, v126, v127
  v_mfma_f32_16x16x32_bf16 v[72:75], a[80:83], v[36:39], v[72:75]
  ds_read_b128 v[28:31], v9 offset:16384
  v_mfma_f32_16x16x32_bf16 v[76:79], a[84:87], v[36:39], v[76:79]
  v_mfma_f32_16x16x32_bf16 v[88:91], a[88:91], v[36:39], v[88:91]
  v_mfma_f32_16x16x32_bf16 v[92:95], a[92:95], v[36:39], v[92:95]
  s_waitcnt lgkmcnt(5)
  v_mfma_f32_16x16x32_bf16 v[64:67], a[96:99], v[40:43], v[64:67]
  s_add_u32 m0, s25, 6144
  ds_read_b128 v[32:35], v10 offset:16384
  v_mfma_f32_16x16x32_bf16 v[68:71], a[100:103], v[40:43], v[68:71]
  v_mfma_f32_16x16x32_bf16 v[80:83], a[104:107], v[40:43], v[80:83]
  buffer_load_dwordx4 v22, s[12:15], s19 offen lds
  v_mfma_f32_16x16x32_bf16 v[84:87], a[108:111], v[40:43], v[84:87]
  s_waitcnt lgkmcnt(5)
  v_mfma_f32_16x16x32_bf16 v[72:75], a[96:99], v[44:47], v[72:75]
  ds_read_b128 v[36:39], v11 offset:16384
  v_mfma_f32_16x16x32_bf16 v[76:79], a[100:103], v[44:47], v[76:79]
  v_mfma_f32_16x16x32_bf16 v[88:91], a[104:107], v[44:47], v[88:91]
  v_mfma_f32_16x16x32_bf16 v[92:95], a[108:111], v[44:47], v[92:95]
  s_waitcnt lgkmcnt(5)
  v_mfma_f32_16x16x32_bf16 v[64:67], a[112:115], v[48:51], v[64:67]
  s_add_u32 m0, s25, 7168
  ds_read_b128 v[40:43], v12 offset:16384
  v_mfma_f32_16x16x32_bf16 v[68:71], a[116:119], v[48:51], v[68:71]
  v_mfma_f32_16x16x32_bf16 v[80:83], a[120:123], v[48:51], v[80:83]
  buffer_load_dwordx4 v23, s[12:15], s19 offen lds
  v_mfma_f32_16x16x32_bf16 v[84:87], a[124:127], v[48:51], v[84:87]
  s_waitcnt lgkmcnt(5)
  v_mfma_f32_16x16x32_bf16 v[72:75], a[112:115], v[52:55], v[72:75]
  s_cmp_gt_u32 s23, 3
  ds_read_b128 v[44:47], v13 offset:16384
  v_mfma_f32_16x16x32_bf16 v[76:79], a[116:119], v[52:55], v[76:79]
  v_mfma_f32_16x16x32_bf16 v[88:91], a[120:123], v[52:55], v[88:91]
  s_cselect_b32 s26, s20, 0
  v_mfma_f32_16x16x32_bf16 v[92:95], a[124:127], v[52:55], v[92:95]
  s_waitcnt lgkmcnt(5)
  v_mfma_f32_16x16x32_bf16 v[64:67], a[128:131], v[24:27], v[64:67]
  s_add_u32 s19, s19, s26
  ds_read_b128 v[48:51], v14 offset:16384
  v_mfma_f32_16x16x32_bf16 v[68:71], a[132:135], v[24:27], v[68:71]
  v_mfma_f32_16x16x32_bf16 v[80:83], a[136:139], v[24:27], v[80:83]
  s_add_u32 s25, s25, 32768
  v_mfma_f32_16x16x32_bf16 v[84:87], a[140:143], v[24:27], v[84:87]
  s_waitcnt lgkmcnt(5)
  v_mfma_f32_16x16x32_bf16 v[72:75], a[128:131], v[28:31], v[72:75]
  s_and_b32 s25, s25, 0x1ffff
  ds_read_b128 v[52:55], v15 offset:16384
  v_mfma_f32_16x16x32_bf16 v[76:79], a[132:135], v[28:31], v[76:79]
  v_mfma_f32_16x16x32_bf16 v[88:91], a[136:139], v[28:31], v[88:91]
  buffer_store_dwordx4 v[128:131], v7, s[4:7], s21 offen offset:0 sc1
  v_mfma_f32_16x16x32_bf16 v[92:95], a[140:143], v[28:31], v[92:95]
  s_waitcnt lgkmcnt(5)
  v_mfma_f32_16x16x32_bf16 v[64:67], a[144:147], v[32:35], v[64:67]
  ds_read_b128 v[24:27], v8 offset:24576
  v_mfma_f32_16x16x32_bf16 v[68:71], a[148:151], v[32:35], v[68:71]
  v_mfma_f32_16x16x32_bf16 v[80:83], a[152:155], v[32:35], v[80:83]
  v_mfma_f32_16x16x32_bf16 v[84:87], a[156:159], v[32:35], v[84:87]
  s_waitcnt lgkmcnt(5)
  v_mfma_f32_16x16x32_bf16 v[72:75], a[144:147], v[36:39], v[72:75]
  ds_read_b128 v[28:31], v9 offset:24576
  v_mfma_f32_16x16x32_bf16 v[76:79], a[148:151], v[36:39], v[76:79]
  v_mfma_f32_16x16x32_bf16 v[88:91], a[152:155], v[36:39], v[88:91]
  buffer_store_dwordx4 v[132:135], v7, s[4:7], s21 offen offset:256 sc1
  v_mfma_f32_16x16x32_bf16 v[92:95], a[156:159], v[36:39], v[92:95]
  s_waitcnt lgkmcnt(5)
  v_mfma_f32_16x16x32_bf16 v[64:67], a[160:163], v[40:43], v[64:67]
  ds_read_b128 v[32:35], v10 offset:24576
  v_mfma_f32_16x16x32_bf16 v[68:71], a[164:167], v[40:43], v[68:71]
  v_mfma_f32_16x16x32_bf16 v[80:83], a[168:171], v[40:43], v[80:83]
  v_mfma_f32_16x16x32_bf16 v[84:87], a[172:175], v[40:43], v[84:87]
  s_waitcnt lgkmcnt(5)
  v_mfma_f32_16x16x32_bf16 v[72:75], a[160:163], v[44:47], v[72:75]
  ds_read_b128 v[36:39], v11 offset:24576
  v_mfma_f32_16x16x32_bf16 v[76:79], a[164:167], v[44:47], v[76:79]
  v_mfma_f32_16x16x32_bf16 v[88:91], a[168:171], v[44:47], v[88:91]
  buffer_store_dwordx4 v[136:139], v7, s[4:7], s21 offen offset:2048 sc1
  v_mfma_f32_16x16x32_bf16 v[92:95], a[172:175], v[44:47], v[92:95]
  s_waitcnt lgkmcnt(5)
  v_mfma_f32_16x16x32_bf16 v[64:67], a[176:179], v[48:51], v[64:67]
  ds_read_b128 v[40:43], v12 offset:24576
  v_mfma_f32_16x16x32_bf16 v[68:71], a[180:183], v[48:51], v[68:71]
  v_mfma_f32_16x16x32_bf16 v[80:83], a[184:187], v[48:51], v[80:83]
  v_mfma_f32_16x16x32_bf16 v[84:87], a[188:191], v[48:51], v[84:87]
  s_waitcnt lgkmcnt(5)
  v_mfma_f32_16x16x32_bf16 v[72:75], a[176:179], v[52:55], v[72:75]
  ds_read_b128 v[44:47], v13 offset:24576
  v_mfma_f32_16x16x32_bf16 v[76:79], a[180:183], v[52:55], v[76:79]
  v_mfma_f32_16x16x32_bf16 v[88:91], a[184:187], v[52:55], v[88:91]
  buffer_store_dwordx4 v[140:143], v7, s[4:7], s21 offen offset:2304 sc1
  v_mfma_f32_16x16x32_bf16 v[92:95], a[188:191], v[52:55], v[92:95]
  s_waitcnt lgkmcnt(5)
  v_mfma_f32_16x16x32_bf16 v[64:67], a[192:195], v[24:27], v[64:67]
  s_mov_b32 s21, s27
  ds_read_b128 v[48:51], v14 offset:24576
  v_mfma_f32_16x16x32_bf16 v[68:71], a[196:199], v[24:27], v[68:71]
  v_mov_b32 v7, v56
  v_mfma_f32_16x16x32_bf16 v[80:83], a[200:203], v[24:27], v[80:83]
  v_mfma_f32_16x16x32_bf16 v[84:87], a[204:207], v[24:27], v[84:87]
  s_waitcnt lgkmcnt(5)
  v_mfma_f32_16x16x32_bf16 v[72:75], a[192:195], v[28:31], v[72:75]
  s_add_u32 s27, s27, s22
  ds_read_b128 v[52:55], v15 offset:24576
  v_mfma_f32_16x16x32_bf16 v[76:79], a[196:199], v[28:31], v[76:79]
  v_mfma_f32_16x16x32_bf16 v[88:91], a[200:203], v[28:31], v[88:91]
  s_waitcnt vmcnt(13)
  s_barrier
  v_mfma_f32_16x16x32_bf16 v[92:95], a[204:207], v[28:31], v[92:95]
  s_waitcnt lgkmcnt(5)
  v_mfma_f32_16x16x32_bf16 v[64:67], a[208:211], v[32:35], v[64:67]
  ds_read_b128 v[24:27], v8 offset:32768
  v_mfma_f32_16x16x32_bf16 v[68:71], a[212:215], v[32:35], v[68:71]
  v_mfma_f32_16x16x32_bf16 v[80:83], a[216:219], v[32:35], v[80:83]
  v_mfma_f32_16x16x32_bf16 v[84:87], a[220:223], v[32:35], v[84:87]
  s_waitcnt lgkmcnt(5)
  v_mfma_f32_16x16x32_bf16 v[72:75], a[208:211], v[36:39], v[72:75]
  s_add_u32 s29, s29, 1
  ds_read_b128 v[28:31], v9 offset:32768
  v_mfma_f32_16x16x32_bf16 v[76:79], a[212:215], v[36:39], v[76:79]
  v_mfma_f32_16x16x32_bf16 v[88:91], a[216:219], v[36:39], v[88:91]
  s_max_i32 s30, s29, 0
  v_mfma_f32_16x16x32_bf16 v[92:95], a[220:223], v[36:39], v[92:95]
  s_waitcnt lgkmcnt(5)
  v_mov_b32 v144, s30
  v_mfma_f32_16x16x32_bf16 v[64:67], a[224:227], v[40:43], v[64:67]
  ds_read_b128 v[32:35], v10 offset:32768
  v_mfma_f32_16x16x32_bf16 v[68:71], a[228:231], v[40:43], v[68:71]
  v_mfma_f32_16x16x32_bf16 v[80:83], a[232:235], v[40:43], v[80:83]
  buffer_store_dword v144, v145, s[4:7], s31 offen sc1
  v_mfma_f32_16x16x32_bf16 v[84:87], a[236:239], v[40:43], v[84:87]
  s_waitcnt lgkmcnt(5)
  v_mfma_f32_16x16x32_bf16 v[72:75], a[224:227], v[44:47], v[72:75]
  ds_read_b128 v[36:39], v11 offset:32768
  v_mfma_f32_16x16x32_bf16 v[76:79], a[228:231], v[44:47], v[76:79]
  v_mfma_f32_16x16x32_bf16 v[88:91], a[232:235], v[44:47], v[88:91]
  v_mfma_f32_16x16x32_bf16 v[92:95], a[236:239], v[44:47], v[92:95]
  s_waitcnt lgkmcnt(5)
  v_mfma_f32_16x16x32_bf16 v[64:67], a[240:243], v[48:51], v[64:67]
  s_sub_u32 s23, s23, 1
  ds_read_b128 v[40:43], v12 offset:32768
  v_mfma_f32_16x16x32_bf16 v[68:71], a[244:247], v[48:51], v[68:71]
  v_mfma_f32_16x16x32_bf16 v[80:83], a[248:251], v[48:51], v[80:83]
  v_mfma_f32_16x16x32_bf16 v[84:87], a[252:255], v[48:51], v[84:87]
  s_waitcnt lgkmcnt(5)
  v_mfma_f32_16x16x32_bf16 v[72:75], a[240:243], v[52:55], v[72:75]
  s_cmp_eq_u32 s23, 0
  ds_read_b128 v[44:47], v13 offset:32768
  v_mfma_f32_16x16x32_bf16 v[76:79], a[244:247], v[52:55], v[76:79]
  v_mfma_f32_16x16x32_bf16 v[88:91], a[248:251], v[52:55], v[88:91]
  v_mfma_f32_16x16x32_bf16 v[92:95], a[252:255], v[52:55], v[92:95]
  s_cbranch_scc1 G_done0_174
  s_waitcnt lgkmcnt(5)
  v_mfma_f32_16x16x32_bf16 v[96:99], a[0:3], v[24:27], 0
  s_add_u32 m0, s25, 0
  ds_read_b128 v[48:51], v14 offset:32768
  v_mfma_f32_16x16x32_bf16 v[100:103], a[4:7], v[24:27], 0
  v_mfma_f32_16x16x32_bf16 v[112:115], a[8:11], v[24:27], 0
  buffer_load_dwordx4 v16, s[12:15], s19 offen lds
  v_mfma_f32_16x16x32_bf16 v[116:119], a[12:15], v[24:27], 0
  s_waitcnt lgkmcnt(5)
  v_mfma_f32_16x16x32_bf16 v[104:107], a[0:3], v[28:31], 0
  ds_read_b128 v[52:55], v15 offset:32768
  v_mfma_f32_16x16x32_bf16 v[108:111], a[4:7], v[28:31], 0
  v_cvt_pk_bf16_f32 v128, v64, v65
  v_cvt_pk_bf16_f32 v129, v66, v67
  v_mfma_f32_16x16x32_bf16 v[120:123], a[8:11], v[28:31], 0
  v_mfma_f32_16x16x32_bf16 v[124:127], a[12:15], v[28:31], 0
  s_waitcnt lgkmcnt(5)
  v_cvt_pk_bf16_f32 v130, v68, v69
  v_cvt_pk_bf16_f32 v131, v70, v71
  v_mfma_f32_16x16x32_bf16 v[96:99], a[16:19], v[32:35], v[96:99]
  s_add_u32 m0, s25, 1024
  ds_read_b128 v[24:27], v8 offset:40960
  v_mfma_f32_16x16x32_bf16 v[100:103], a[20:23], v[32:35], v[100:103]
  v_mfma_f32_16x16x32_bf16 v[112:115], a[24:27], v[32:35], v[112:115]
  buffer_load_dwordx4 v17, s[12:15], s19 offen lds
  v_mfma_f32_16x16x32_bf16 v[116:119], a[28:31], v[32:35], v[116:119]
  s_waitcnt lgkmcnt(5)
  v_mfma_f32_16x16x32_bf16 v[104:107], a[16:19], v[36:39], v[104:107]
  ds_read_b128 v[28:31], v9 offset:40960
  v_mfma_f32_16x16x32_bf16 v[108:111], a[20:23], v[36:39], v[108:111]
  v_mfma_f32_16x16x32_bf16 v[120:123], a[24:27], v[36:39], v[120:123]
  v_mfma_f32_16x16x32_bf16 v[124:127], a[28:31], v[36:39], v[124:127]
  s_waitcnt lgkmcnt(5)
  v_mfma_f32_16x16x32_bf16 v[96:99], a[32:35], v[40:43], v[96:99]
  s_add_u32 m0, s25, 2048
  ds_read_b128 v[32:35], v10 offset:40960
  v_mfma_f32_16x16x32_bf16 v[100:103], a[36:39], v[40:43], v[100:103]
  v_cvt_pk_bf16_f32 v132, v72, v73
  v_cvt_pk_bf16_f32 v133, v74, v75
  v_mfma_f32_16x16x32_bf16 v[112:115], a[40:43], v[40:43], v[112:115]
  buffer_load_dwordx4 v18, s[12:15], s19 offen lds
  v_mfma_f32_16x16x32_bf16 v[116:119], a[44:47], v[40:43], v[116:119]
  s_waitcnt lgkmcnt(5)
  v_cvt_pk_bf16_f32 v134, v76, v77
  v_cvt_pk_bf16_f32 v135, v78, v79
  v_mfma_f32_16x16x32_bf16 v[104:107], a[32:35], v[44:47], v[104:107]
  ds_read_b128 v[36:39], v11 offset:40960
  v_mfma_f32_16x16x32_bf16 v[108:111], a[36:39], v[44:47], v[108:111]
  v_mfma_f32_16x16x32_bf16 v[120:123], a[40:43], v[44:47], v[120:123]
  v_mfma_f32_16x16x32_bf16 v[124:127], a[44:47], v[44:47], v[124:127]
  s_waitcnt lgkmcnt(5)
  v_mfma_f32_16x16x32_bf16 v[96:99], a[48:51], v[48:51], v[96:99]
  s_add_u32 m0, s25, 3072
  ds_read_b128 v[40:43], v12 offset:40960
  v_mfma_f32_16x16x32_bf16 v[100:103], a[52:55], v[48:51], v[100:103]
  v_mfma_f32_16x16x32_bf16 v[112:115], a[56:59], v[48:51], v[112:115]
  buffer_load_dwordx4 v19, s[12:15], s19 offen lds
  v_mfma_f32_16x16x32_bf16 v[116:119], a[60:63], v[48:51], v[116:119]
  s_waitcnt lgkmcnt(5)
  v_mfma_f32_16x16x32_bf16 v[104:107], a[48:51], v[52:55], v[104:107]
  ds_read_b128 v[44:47], v13 offset:40960
  v_mfma_f32_16x16x32_bf16 v[108:111], a[52:55], v[52:55], v[108:111]
  v_cvt_pk_bf16_f32 v136, v80, v81
  v_cvt_pk_bf16_f32 v137, v82, v83
  v_mfma_f32_16x16x32_bf16 v[120:123], a[56:59], v[52:55], v[120:123]
  v_mfma_f32_16x16x32_bf16 v[124:127], a[60:63], v[52:55], v[124:127]
  s_waitcnt lgkmcnt(5)
  v_cvt_pk_bf16_f32 v138, v84, v85
  v_cvt_pk_bf16_f32 v139, v86, v87
  v_mfma_f32_16x16x32_bf16 v[96:99], a[64:67], v[24:27], v[96:99]
  s_add_u32 m0, s25, 4096
  ds_read_b128 v[48:51], v14 offset:40960
  v_mfma_f32_16x16x32_bf16 v[100:103], a[68:71], v[24:27], v[100:103]
  v_mfma_f32_16x16x32_bf16 v[112:115], a[72:75], v[24:27], v[112:115]
  buffer_load_dwordx4 v20, s[12:15], s19 offen lds
  v_mfma_f32_16x16x32_bf16 v[116:119], a[76:79], v[24:27], v[116:119]
  s_waitcnt lgkmcnt(5)
  v_mfma_f32_16x16x32_bf16 v[104:107], a[64:67], v[28:31], v[104:107]
  ds_read_b128 v[52:55], v15 offset:40960
  v_mfma_f32_16x16x32_bf16 v[108:111], a[68:71], v[28:31], v[108:111]
  v_mfma_f32_16x16x32_bf16 v[120:123], a[72:75], v[28:31], v[120:123]
  v_mfma_f32_16x16x32_bf16 v[124:127], a[76:79], v[28:31], v[124:127]
  s_waitcnt lgkmcnt(5)
  v_mfma_f32_16x16x32_bf16 v[96:99], a[80:83], v[32:35], v[96:99]
  s_add_u32 m0, s25, 5120
  ds_read_b128 v[24:27], v8 offset:49152
  v_mfma_f32_16x16x32_bf16 v[100:103], a[84:87], v[32:35], v[100:103]
  v_cvt_pk_bf16_f32 v140, v88, v89
  v_cvt_pk_bf16_f32 v141, v90, v91
  v_mfma_f32_16x16x32_bf16 v[112:115], a[88:91], v[32:35], v[112:115]
  buffer_load_dwordx4 v21, s[12:15], s19 offen lds
  v_mfma_f32_16x16x32_bf16 v[116:119], a[92:95], v[32:35], v[116:119]
  s_waitcnt lgkmcnt(5)
  v_cvt_pk_bf16_f32 v142, v92, v93
  v_cvt_pk_bf16_f32 v143, v94, v95
  v_mfma_f32_16x16x32_bf16 v[104:107], a[80:83], v[36:39], v[104:107]
  ds_read_b128 v[28:31], v9 offset:49152
  v_mfma_f32_16x16x32_bf16 v[108:111], a[84:87], v[36:39], v[108:111]
  v_mfma_f32_16x16x32_bf16 v[120:123], a[88:91], v[36:39], v[120:123]
  v_mfma_f32_16x16x32_bf16 v[124:127], a[92:95], v[36:39], v[124:127]
  s_waitcnt lgkmcnt(5)
  v_mfma_f32_16x16x32_bf16 v[96:99], a[96:99], v[40:43], v[96:99]
  s_add_u32 m0, s25, 6144
  ds_read_b128 v[32:35], v10 offset:49152
  v_mfma_f32_16x16x32_bf16 v[100:103], a[100:103], v[40:43], v[100:103]
  v_mfma_f32_16x16x32_bf16 v[112:115], a[104:107], v[40:43], v[112:115]
  buffer_load_dwordx4 v22, s[12:15], s19 offen lds
  v_mfma_f32_16x16x32_bf16 v[116:119], a[108:111], v[40:43], v[116:119]
  s_waitcnt lgkmcnt(5)
  v_mfma_f32_16x16x32_bf16 v[104:107], a[96:99], v[44:47], v[104:107]
  ds_read_b128 v[36:39], v11 offset:49152
  v_mfma_f32_16x16x32_bf16 v[108:111], a[100:103], v[44:47], v[108:111]
  v_mfma_f32_16x16x32_bf16 v[120:123], a[104:107], v[44:47], v[120:123]
  v_mfma_f32_16x16x32_bf16 v[124:127], a[108:111], v[44:47], v[124:127]
  s_waitcnt lgkmcnt(5)
  v_mfma_f32_16x16x32_bf16 v[96:99], a[112:115], v[48:51], v[96:99]
  s_add_u32 m0, s25, 7168
  ds_read_b128 v[40:43], v12 offset:49152
  v_mfma_f32_16x16x32_bf16 v[100:103], a[116:119], v[48:51], v[100:103]
  v_mfma_f32_16x16x32_bf16 v[112:115], a[120:123], v[48:51], v[112:115]
  buffer_load_dwordx4 v23, s[12:15], s19 offen lds
  v_mfma_f32_16x16x32_bf16 v[116:119], a[124:127], v[48:51], v[116:119]
  s_waitcnt lgkmcnt(5)
  v_mfma_f32_16x16x32_bf16 v[104:107], a[112:115], v[52:55], v[104:107]
  s_cmp_gt_u32 s23, 3
  ds_read_b128 v[44:47], v13 offset:49152
  v_mfma_f32_16x16x32_bf16 v[108:111], a[116:119], v[52:55], v[108:111]
  v_mfma_f32_16x16x32_bf16 v[120:123], a[120:123], v[52:55], v[120:123]
  s_cselect_b32 s26, s20, 0
  v_mfma_f32_16x16x32_bf16 v[124:127], a[124:127], v[52:55], v[124:127]
  s_waitcnt lgkmcnt(5)
  v_mfma_f32_16x16x32_bf16 v[96:99], a[128:131], v[24:27], v[96:99]
  s_add_u32 s19, s19, s26
  ds_read_b128 v[48:51], v14 offset:49152
  v_mfma_f32_16x16x32_bf16 v[100:103], a[132:135], v[24:27], v[100:103]
  v_mfma_f32_16x16x32_bf16 v[112:115], a[136:139], v[24:27], v[112:115]
  s_add_u32 s25, s25, 32768
  v_mfma_f32_16x16x32_bf16 v[116:119], a[140:143], v[24:27], v[116:119]
  s_waitcnt lgkmcnt(5)
  v_mfma_f32_16x16x32_bf16 v[104:107], a[128:131], v[28:31], v[104:107]
  s_and_b32 s25, s25, 0x1ffff
  ds_read_b128 v[52:55], v15 offset:49152
  v_mfma_f32_16x16x32_bf16 v[108:111], a[132:135], v[28:31], v[108:111]
  v_mfma_f32_16x16x32_bf16 v[120:123], a[136:139], v[28:31], v[120:123]
  buffer_store_dwordx4 v[128:131], v7, s[4:7], s21 offen offset:0 sc1
  v_mfma_f32_16x16x32_bf16 v[124:127], a[140:143], v[28:31], v[124:127]
  s_waitcnt lgkmcnt(5)
  v_mfma_f32_16x16x32_bf16 v[96:99], a[144:147], v[32:35], v[96:99]
  ds_read_b128 v[24:27], v8 offset:57344
  v_mfma_f32_16x16x32_bf16 v[100:103], a[148:151], v[32:35], v[100:103]
  v_mfma_f32_16x16x32_bf16 v[112:115], a[152:155], v[32:35], v[112:115]
  v_mfma_f32_16x16x32_bf16 v[116:119], a[156:159], v[32:35], v[116:119]
  s_waitcnt lgkmcnt(5)
  v_xor_b32 v8, 0x10000, v8
  v_mfma_f32_16x16x32_bf16 v[104:107], a[144:147], v[36:39], v[104:107]
  ds_read_b128 v[28:31], v9 offset:57344
  v_mfma_f32_16x16x32_bf16 v[108:111], a[148:151], v[36:39], v[108:111]
  v_mfma_f32_16x16x32_bf16 v[120:123], a[152:155], v[36:39], v[120:123]
  buffer_store_dwordx4 v[132:135], v7, s[4:7], s21 offen offset:256 sc1
  v_mfma_f32_16x16x32_bf16 v[124:127], a[156:159], v[36:39], v[124:127]
  s_waitcnt lgkmcnt(5)
  v_xor_b32 v9, 0x10000, v9
  v_mfma_f32_16x16x32_bf16 v[96:99], a[160:163], v[40:43], v[96:99]
  ds_read_b128 v[32:35], v10 offset:57344
  v_mfma_f32_16x16x32_bf16 v[100:103], a[164:167], v[40:43], v[100:103]
  v_mfma_f32_16x16x32_bf16 v[112:115], a[168:171], v[40:43], v[112:115]
  v_mfma_f32_16x16x32_bf16 v[116:119], a[172:175], v[40:43], v[116:119]
  s_waitcnt lgkmcnt(5)
  v_xor_b32 v10, 0x10000, v10
  v_mfma_f32_16x16x32_bf16 v[104:107], a[160:163], v[44:47], v[104:107]
  ds_read_b128 v[36:39], v11 offset:57344
  v_mfma_f32_16x16x32_bf16 v[108:111], a[164:167], v[44:47], v[108:111]
  v_mfma_f32_16x16x32_bf16 v[120:123], a[168:171], v[44:47], v[120:123]
  buffer_store_dwordx4 v[136:139], v7, s[4:7], s21 offen offset:2048 sc1
  v_mfma_f32_16x16x32_bf16 v[124:127], a[172:175], v[44:47], v[124:127]
  s_waitcnt lgkmcnt(5)
  v_xor_b32 v11, 0x10000, v11
  v_mfma_f32_16x16x32_bf16 v[96:99], a[176:179], v[48:51], v[96:99]
  ds_read_b128 v[40:43], v12 offset:57344
  v_mfma_f32_16x16x32_bf16 v[100:103], a[180:183], v[48:51], v[100:103]
  v_mfma_f32_16x16x32_bf16 v[112:115], a[184:187], v[48:51], v[112:115]
  v_mfma_f32_16x16x32_bf16 v[116:119], a[188:191], v[48:51], v[116:119]
  s_waitcnt lgkmcnt(5)
  v_xor_b32 v12, 0x10000, v12
  v_mfma_f32_16x16x32_bf16 v[104:107], a[176:179], v[52:55], v[104:107]
  ds_read_b128 v[44:47], v13 offset:57344
  v_mfma_f32_16x16x32_bf16 v[108:111], a[180:183], v[52:55], v[108:111]
  v_mfma_f32_16x16x32_bf16 v[120:123], a[184:187], v[52:55], v[120:123]
  buffer_store_dwordx4 v[140:143], v7, s[4:7], s21 offen offset:2304 sc1
  v_mfma_f32_16x16x32_bf16 v[124:127], a[188:191], v[52:55], v[124:127]
  s_waitcnt lgkmcnt(5)
  v_xor_b32 v13, 0x10000, v13
  v_mfma_f32_16x16x32_bf16 v[96:99], a[192:195], v[24:27], v[96:99]
  s_mov_b32 s21, s27
  ds_read_b128 v[48:51], v14 offset:57344
  v_mfma_f32_16x16x32_bf16 v[100:103], a[196:199], v[24:27], v[100:103]
  v_mov_b32 v7, v56
  v_mfma_f32_16x16x32_bf16 v[112:115], a[200:203], v[24:27], v[112:115]
  v_mfma_f32_16x16x32_bf16 v[116:119], a[204:207], v[24:27], v[116:119]
  s_waitcnt lgkmcnt(5)
  v_xor_b32 v14, 0x10000, v14
  v_mfma_f32_16x16x32_bf16 v[104:107], a[192:195], v[28:31], v[104:107]
  s_add_u32 s27, s27, s22
  ds_read_b128 v[52:55], v15 offset:57344
  v_mfma_f32_16x16x32_bf16 v[108:111], a[196:199], v[28:31], v[108:111]
  v_mfma_f32_16x16x32_bf16 v[120:123], a[200:203], v[28:31], v[120:123]
  s_waitcnt vmcnt(13)
  s_barrier
  v_mfma_f32_16x16x32_bf16 v[124:127], a[204:207], v[28:31], v[124:127]
  s_waitcnt lgkmcnt(5)
  v_xor_b32 v15, 0x10000, v15
  v_mfma_f32_16x16x32_bf16 v[96:99], a[208:211], v[32:35], v[96:99]
  ds_read_b128 v[24:27], v8 offset:0
  v_mfma_f32_16x16x32_bf16 v[100:103], a[212:215], v[32:35], v[100:103]
  v_mfma_f32_16x16x32_bf16 v[112:115], a[216:219], v[32:35], v[112:115]
  v_mfma_f32_16x16x32_bf16 v[116:119], a[220:223], v[32:35], v[116:119]
  s_waitcnt lgkmcnt(5)
  v_mfma_f32_16x16x32_bf16 v[104:107], a[208:211], v[36:39], v[104:107]
  s_add_u32 s29, s29, 1
  ds_read_b128 v[28:31], v9 offset:0
  v_mfma_f32_16x16x32_bf16 v[108:111], a[212:215], v[36:39], v[108:111]
  v_mfma_f32_16x16x32_bf16 v[120:123], a[216:219], v[36:39], v[120:123]
  s_max_i32 s30, s29, 0
  v_mfma_f32_16x16x32_bf16 v[124:127], a[220:223], v[36:39], v[124:127]
  s_waitcnt lgkmcnt(5)
  v_mov_b32 v144, s30
  v_mfma_f32_16x16x32_bf16 v[96:99], a[224:227], v[40:43], v[96:99]
  ds_read_b128 v[32:35], v10 offset:0
  v_mfma_f32_16x16x32_bf16 v[100:103], a[228:231], v[40:43], v[100:103]
  v_mfma_f32_16x16x32_bf16 v[112:115], a[232:235], v[40:43], v[112:115]
  buffer_store_dword v144, v145, s[4:7], s31 offen sc1
  v_mfma_f32_16x16x32_bf16 v[116:119], a[236:239], v[40:43], v[116:119]
  s_waitcnt lgkmcnt(5)
  v_mfma_f32_16x16x32_bf16 v[104:107], a[224:227], v[44:47], v[104:107]
  ds_read_b128 v[36:39], v11 offset:0
  v_mfma_f32_16x16x32_bf16 v[108:111], a[228:231], v[44:47], v[108:111]
  v_mfma_f32_16x16x32_bf16 v[120:123], a[232:235], v[44:47], v[120:123]
  v_mfma_f32_16x16x32_bf16 v[124:127], a[236:239], v[44:47], v[124:127]
  s_waitcnt lgkmcnt(5)
  v_mfma_f32_16x16x32_bf16 v[96:99], a[240:243], v[48:51], v[96:99]
  s_sub_u32 s23, s23, 1
  ds_read_b128 v[40:43], v12 offset:0
  v_mfma_f32_16x16x32_bf16 v[100:103], a[244:247], v[48:51], v[100:103]
  v_mfma_f32_16x16x32_bf16 v[112:115], a[248:251], v[48:51], v[112:115]
  v_mfma_f32_16x16x32_bf16 v[116:119], a[252:255], v[48:51], v[116:119]
  s_waitcnt lgkmcnt(5)
  v_mfma_f32_16x16x32_bf16 v[104:107], a[240:243], v[52:55], v[104:107]
  s_cmp_eq_u32 s23, 0
  ds_read_b128 v[44:47], v13 offset:0
  v_mfma_f32_16x16x32_bf16 v[108:111], a[244:247], v[52:55], v[108:111]
  v_mfma_f32_16x16x32_bf16 v[120:123], a[248:251], v[52:55], v[120:123]
  v_mfma_f32_16x16x32_bf16 v[124:127], a[252:255], v[52:55], v[124:127]
  s_cbranch_scc1 G_done1_175
  s_branch G_top_173
G_done0_174:
  s_nop 7
  s_nop 3
  v_cvt_pk_bf16_f32 v128, v64, v65
  v_cvt_pk_bf16_f32 v129, v66, v67
  v_cvt_pk_bf16_f32 v130, v68, v69
  v_cvt_pk_bf16_f32 v131, v70, v71
  buffer_store_dwordx4 v[128:131], v7, s[4:7], s21 offen offset:0 sc1
  v_cvt_pk_bf16_f32 v132, v72, v73
  v_cvt_pk_bf16_f32 v133, v74, v75
  v_cvt_pk_bf16_f32 v134, v76, v77
  v_cvt_pk_bf16_f32 v135, v78, v79
  buffer_store_dwordx4 v[132:135], v7, s[4:7], s21 offen offset:256 sc1
  v_cvt_pk_bf16_f32 v136, v80, v81
  v_cvt_pk_bf16_f32 v137, v82, v83
  v_cvt_pk_bf16_f32 v138, v84, v85
  v_cvt_pk_bf16_f32 v139, v86, v87
  buffer_store_dwordx4 v[136:139], v7, s[4:7], s21 offen offset:2048 sc1
  v_cvt_pk_bf16_f32 v140, v88, v89
  v_cvt_pk_bf16_f32 v141, v90, v91
  v_cvt_pk_bf16_f32 v142, v92, v93
  v_cvt_pk_bf16_f32 v143, v94, v95
  buffer_store_dwordx4 v[140:143], v7, s[4:7], s21 offen offset:2304 sc1
  s_branch G_fin_176
G_done1_175:
  s_nop 7
  s_nop 3
  v_cvt_pk_bf16_f32 v128, v96, v97
  v_cvt_pk_bf16_f32 v129, v98, v99
  v_cvt_pk_bf16_f32 v130, v100, v101
  v_cvt_pk_bf16_f32 v131, v102, v103
  buffer_store_dwordx4 v[128:131], v7, s[4:7], s21 offen offset:0 sc1
  v_cvt_pk_bf16_f32 v132, v104, v105
  v_cvt_pk_bf16_f32 v133, v106, v107
  v_cvt_pk_bf16_f32 v134, v108, v109
  v_cvt_pk_bf16_f32 v135, v110, v111
  buffer_store_dwordx4 v[132:135], v7, s[4:7], s21 offen offset:256 sc1
  v_cvt_pk_bf16_f32 v136, v112, v113
  v_cvt_pk_bf16_f32 v137, v114, v115
  v_cvt_pk_bf16_f32 v138, v116, v117
  v_cvt_pk_bf16_f32 v139, v118, v119
  buffer_store_dwordx4 v[136:139], v7, s[4:7], s21 offen offset:2048 sc1
  v_cvt_pk_bf16_f32 v140, v120, v121
  v_cvt_pk_bf16_f32 v141, v122, v123
  v_cvt_pk_bf16_f32 v142, v124, v125
  v_cvt_pk_bf16_f32 v143, v126, v127
  buffer_store_dwordx4 v[140:143], v7, s[4:7], s21 offen offset:2304 sc1
G_fin_176:
  s_waitcnt vmcnt(0) lgkmcnt(0)
  s_barrier
  s_add_u32 s30, s29, 2
  v_mov_b32 v144, s30
  v_min_u32 v145, 1, v0
  v_lshlrev_b32 v145, 30, v145
  buffer_store_dword v144, v145, s[4:7], s31 offen sc1
  s_branch P_end_171
P_q_172:
  s_mov_b32 s27, s21
  v_mov_b32 v7, 0x40000000
  s_mov_b32 s29, -2
  v_min_u32 v145, 1, v0
  v_lshlrev_b32 v145, 30, v145
  ds_read_b128 v[24:27], v8 offset:0
  ds_read_b128 v[28:31], v9 offset:0
  ds_read_b128 v[32:35], v10 offset:0
  ds_read_b128 v[36:39], v11 offset:0
  ds_read_b128 v[40:43], v12 offset:0
  ds_read_b128 v[44:47], v13 offset:0
.p2align 6
G_top_177:
  s_waitcnt lgkmcnt(5)
  v_mfma_f32_16x16x32_bf16 v[64:67], a[0:3], v[24:27], 0
  s_add_u32 m0, s25, 0
  ds_read_b128 v[48:51], v14 offset:0
  v_mfma_f32_16x16x32_bf16 v[68:71], a[4:7], v[24:27], 0
  v_mfma_f32_16x16x32_bf16 v[80:83], a[8:11], v[24:27], 0
  buffer_load_dwordx4 v16, s[12:15], s19 offen lds
  v_mfma_f32_16x16x32_bf16 v[84:87], a[12:15], v[24:27], 0
  s_waitcnt lgkmcnt(5)
  v_mfma_f32_16x16x32_bf16 v[72:75], a[0:3], v[28:31], 0
  ds_read_b128 v[52:55], v15 offset:0
  v_mfma_f32_16x16x32_bf16 v[76:79], a[4:7], v[28:31], 0
  v_mul_f32 v96, s24, v96
  v_mul_f32 v97, s24, v97
  v_mfma_f32_16x16x32_bf16 v[88:91], a[8:11], v[28:31], 0
  v_mfma_f32_16x16x32_bf16 v[92:95], a[12:15], v[28:31], 0
  s_waitcnt lgkmcnt(5)
  v_cvt_pk_bf16_f32 v128, v96, v97
  v_mul_f32 v98, s24, v98
  v_mfma_f32_16x16x32_bf16 v[64:67], a[16:19], v[32:35], v[64:67]
  s_add_u32 m0, s25, 1024
  ds_read_b128 v[24:27], v8 offset:8192
  v_mfma_f32_16x16x32_bf16 v[68:71], a[20:23], v[32:35], v[68:71]
  v_mul_f32 v99, s24, v99
  v_cvt_pk_bf16_f32 v129, v98, v99
  v_mfma_f32_16x16x32_bf16 v[80:83], a[24:27], v[32:35], v[80:83]
  buffer_load_dwordx4 v17, s[12:15], s19 offen lds
  v_mfma_f32_16x16x32_bf16 v[84:87], a[28:31], v[32:35], v[84:87]
  s_waitcnt lgkmcnt(5)
  v_mul_f32 v100, s24, v100
  v_mul_f32 v101, s24, v101
  v_mfma_f32_16x16x32_bf16 v[72:75], a[16:19], v[36:39], v[72:75]
  ds_read_b128 v[28:31], v9 offset:8192
  v_mfma_f32_16x16x32_bf16 v[76:79], a[20:23], v[36:39], v[76:79]
  v_cvt_pk_bf16_f32 v130, v100, v101
  v_mul_f32 v102, s24, v102
  v_mfma_f32_16x16x32_bf16 v[88:91], a[24:27], v[36:39], v[88:91]
  v_mfma_f32_16x16x32_bf16 v[92:95], a[28:31], v[36:39], v[92:95]
  s_waitcnt lgkmcnt(5)
  v_mul_f32 v103, s24, v103
  v_cvt_pk_bf16_f32 v131, v102, v103
  v_mfma_f32_16x16x32_bf16 v[64:67], a[32:35], v[40:43], v[64:67]
  s_add_u32 m0, s25, 2048
  ds_read_b128 v[32:35], v10 offset:8192
  v_mfma_f32_16x16x32_bf16 v[68:71], a[36:39], v[40:43], v[68:71]
  v_mul_f32 v104, s24, v104
  v_mul_f32 v105, s24, v105
  v_mfma_f32_16x16x32_bf16 v[80:83], a[40:43], v[40:43], v[80:83]
  buffer_load_dwordx4 v18, s[12:15], s19 offen lds
  v_mfma_f32_16x16x32_bf16 v[84:87], a[44:47], v[40:43], v[84:87]
  s_waitcnt lgkmcnt(5)
  v_cvt_pk_bf16_f32 v132, v104, v105
  v_mul_f32 v106, s24, v106
  v_mfma_f32_16x16x32_bf16 v[72:75], a[32:35], v[44:47], v[72:75]
  ds_read_b128 v[36:39], v11 offset:8192
  v_mfma_f32_16x16x32_bf16 v[76:79], a[36:39], v[44:47], v[76:79]
  v_mul_f32 v107, s24, v107
  v_cvt_pk_bf16_f32 v133, v106, v107
  v_mfma_f32_16x16x32_bf16 v[88:91], a[40:43], v[44:47], v[88:91]
  v_mfma_f32_16x16x32_bf16 v[92:95], a[44:47], v[44:47], v[92:95]
  s_waitcnt lgkmcnt(5)
  v_mul_f32 v108, s24, v108
  v_mul_f32 v109, s24, v109
  v_mfma_f32_16x16x32_bf16 v[64:67], a[48:51], v[48:51], v[64:67]
  s_add_u32 m0, s25, 3072
  ds_read_b128 v[40:43], v12 offset:8192
  v_mfma_f32_16x16x32_bf16 v[68:71], a[52:55], v[48:51], v[68:71]
  v_cvt_pk_bf16_f32 v134, v108, v109
  v_mul_f32 v110, s24, v110
  v_mfma_f32_16x16x32_bf16 v[80:83], a[56:59], v[48:51], v[80:83]
  buffer_load_dwordx4 v19, s[12:15], s19 offen lds
  v_mfma_f32_16x16x32_bf16 v[84:87], a[60:63], v[48:51], v[84:87]
  s_waitcnt lgkmcnt(5)
  v_mul_f32 v111, s24, v111
  v_cvt_pk_bf16_f32 v135, v110, v111
  v_mfma_f32_16x16x32_bf16 v[72:75], a[48:51], v[52:55], v[72:75]
  ds_read_b128 v[44:47], v13 offset:8192
  v_mfma_f32_16x16x32_bf16 v[76:79], a[52:55], v[52:55], v[76:79]
  v_mul_f32 v112, s24, v112
  v_mul_f32 v113, s24, v113
  v_mfma_f32_16x16x32_bf16 v[88:91], a[56:59], v[52:55], v[88:91]
  v_mfma_f32_16x16x32_bf16 v[92:95], a[60:63], v[52:55], v[92:95]
  s_waitcnt lgkmcnt(5)
  v_cvt_pk_bf16_f32 v136, v112, v113
  v_mul_f32 v114, s24, v114
  v_mfma_f32_16x16x32_bf16 v[64:67], a[64:67], v[24:27], v[64:67]
  s_add_u32 m0, s25, 4096
  ds_read_b128 v[48:51], v14 offset:8192
  v_mfma_f32_16x16x32_bf16 v[68:71], a[68:71], v[24:27], v[68:71]
  v_mul_f32 v115, s24, v115
  v_cvt_pk_bf16_f32 v137, v114, v115
  v_mfma_f32_16x16x32_bf16 v[80:83], a[72:75], v[24:27], v[80:83]
  buffer_load_dwordx4 v20, s[12:15], s19 offen lds
  v_mfma_f32_16x16x32_bf16 v[84:87], a[76:79], v[24:27], v[84:87]
  s_waitcnt lgkmcnt(5)
  v_mul_f32 v116, s24, v116
  v_mul_f32 v117, s24, v117
  v_mfma_f32_16x16x32_bf16 v[72:75], a[64:67], v[28:31], v[72:75]
  ds_read_b128 v[52:55], v15 offset:8192
  v_mfma_f32_16x16x32_bf16 v[76:79], a[68:71], v[28:31], v[76:79]
  v_cvt_pk_bf16_f32 v138, v116, v117
  v_mul_f32 v118, s24, v118
  v_mfma_f32_16x16x32_bf16 v[88:91], a[72:75], v[28:31], v[88:91]
  v_mfma_f32_16x16x32_bf16 v[92:95], a[76:79], v[28:31], v[92:95]
  s_waitcnt lgkmcnt(5)
  v_mul_f32 v119, s24, v119
  v_cvt_pk_bf16_f32 v139, v118, v119
  v_mfma_f32_16x16x32_bf16 v[64:67], a[80:83], v[32:35], v[64:67]
  s_add_u32 m0, s25, 5120
  ds_read_b128 v[24:27], v8 offset:16384
  v_mfma_f32_16x16x32_bf16 v[68:71], a[84:87], v[32:35], v[68:71]
  v_mul_f32 v120, s24, v120
  v_mul_f32 v121, s24, v121
  v_mfma_f32_16x16x32_bf16 v[80:83], a[88:91], v[32:35], v[80:83]
  buffer_load_dwordx4 v21, s[12:15], s19 offen lds
  v_mfma_f32_16x16x32_bf16 v[84:87], a[92:95], v[32:35], v[84:87]
  s_waitcnt lgkmcnt(5)
  v_cvt_pk_bf16_f32 v140, v120, v121
  v_mul_f32 v122, s24, v122
  v_mfma_f32_16x16x32_bf16 v[72:75], a[80:83], v[36:39], v[72:75]
  ds_read_b128 v[28:31], v9 offset:16384
  v_mfma_f32_16x16x32_bf16 v[76:79], a[84:87], v[36:39], v[76:79]
  v_mul_f32 v123, s24, v123
  v_cvt_pk_bf16_f32 v141, v122, v123
  v_mfma_f32_16x16x32_bf16 v[88:91], a[88:91], v[36:39], v[88:91]
  v_mfma_f32_16x16x32_bf16 v[92:95], a[92:95], v[36:39], v[92:95]
  s_waitcnt lgkmcnt(5)
  v_mul_f32 v124, s24, v124
  v_mul_f32 v125, s24, v125
  v_mfma_f32_16x16x32_bf16 v[64:67], a[96:99], v[40:43], v[64:67]
  s_add_u32 m0, s25, 6144
  ds_read_b128 v[32:35], v10 offset:16384
  v_mfma_f32_16x16x32_bf16 v[68:71], a[100:103], v[40:43], v[68:71]
  v_cvt_pk_bf16_f32 v142, v124, v125
  v_mul_f32 v126, s24, v126
  v_mfma_f32_16x16x32_bf16 v[80:83], a[104:107], v[40:43], v[80:83]
  buffer_load_dwordx4 v22, s[12:15], s19 offen lds
  v_mfma_f32_16x16x32_bf16 v[84:87], a[108:111], v[40:43], v[84:87]
  s_waitcnt lgkmcnt(5)
  v_mul_f32 v127, s24, v127
  v_cvt_pk_bf16_f32 v143, v126, v127
  v_mfma_f32_16x16x32_bf16 v[72:75], a[96:99], v[44:47], v[72:75]
  ds_read_b128 v[36:39], v11 offset:16384
  v_mfma_f32_16x16x32_bf16 v[76:79], a[100:103], v[44:47], v[76:79]
  v_mfma_f32_16x16x32_bf16 v[88:91], a[104:107], v[44:47], v[88:91]
  v_mfma_f32_16x16x32_bf16 v[92:95], a[108:111], v[44:47], v[92:95]
  s_waitcnt lgkmcnt(5)
  v_mfma_f32_16x16x32_bf16 v[64:67], a[112:115], v[48:51], v[64:67]
  s_add_u32 m0, s25, 7168
  ds_read_b128 v[40:43], v12 offset:16384
  v_mfma_f32_16x16x32_bf16 v[68:71], a[116:119], v[48:51], v[68:71]
  v_mfma_f32_16x16x32_bf16 v[80:83], a[120:123], v[48:51], v[80:83]
  buffer_load_dwordx4 v23, s[12:15], s19 offen lds
  v_mfma_f32_16x16x32_bf16 v[84:87], a[124:127], v[48:51], v[84:87]
  s_waitcnt lgkmcnt(5)
  v_mfma_f32_16x16x32_bf16 v[72:75], a[112:115], v[52:55], v[72:75]
  s_cmp_gt_u32 s23, 3
  ds_read_b128 v[44:47], v13 offset:16384
  v_mfma_f32_16x16x32_bf16 v[76:79], a[116:119], v[52:55], v[76:79]
  v_mfma_f32_16x16x32_bf16 v[88:91], a[120:123], v[52:55], v[88:91]
  s_cselect_b32 s26, s20, 0
  v_mfma_f32_16x16x32_bf16 v[92:95], a[124:127], v[52:55], v[92:95]
  s_waitcnt lgkmcnt(5)
  v_mfma_f32_16x16x32_bf16 v[64:67], a[128:131], v[24:27], v[64:67]
  s_add_u32 s19, s19, s26
  ds_read_b128 v[48:51], v14 offset:16384
  v_mfma_f32_16x16x32_bf16 v[68:71], a[132:135], v[24:27], v[68:71]
  v_mfma_f32_16x16x32_bf16 v[80:83], a[136:139], v[24:27], v[80:83]
  s_add_u32 s25, s25, 32768
  v_mfma_f32_16x16x32_bf16 v[84:87], a[140:143], v[24:27], v[84:87]
  s_waitcnt lgkmcnt(5)
  v_mfma_f32_16x16x32_bf16 v[72:75], a[128:131], v[28:31], v[72:75]
  s_and_b32 s25, s25, 0x1ffff
  ds_read_b128 v[52:55], v15 offset:16384
  v_mfma_f32_16x16x32_bf16 v[76:79], a[132:135], v[28:31], v[76:79]
  v_mfma_f32_16x16x32_bf16 v[88:91], a[136:139], v[28:31], v[88:91]
  buffer_store_dwordx4 v[128:131], v7, s[4:7], s21 offen offset:0 sc1
  v_mfma_f32_16x16x32_bf16 v[92:95], a[140:143], v[28:31], v[92:95]
  s_waitcnt lgkmcnt(5)
  v_mfma_f32_16x16x32_bf16 v[64:67], a[144:147], v[32:35], v[64:67]
  ds_read_b128 v[24:27], v8 offset:24576
  v_mfma_f32_16x16x32_bf16 v[68:71], a[148:151], v[32:35], v[68:71]
  v_mfma_f32_16x16x32_bf16 v[80:83], a[152:155], v[32:35], v[80:83]
  v_mfma_f32_16x16x32_bf16 v[84:87], a[156:159], v[32:35], v[84:87]
  s_waitcnt lgkmcnt(5)
  v_mfma_f32_16x16x32_bf16 v[72:75], a[144:147], v[36:39], v[72:75]
  ds_read_b128 v[28:31], v9 offset:24576
  v_mfma_f32_16x16x32_bf16 v[76:79], a[148:151], v[36:39], v[76:79]
  v_mfma_f32_16x16x32_bf16 v[88:91], a[152:155], v[36:39], v[88:91]
  buffer_store_dwordx4 v[132:135], v7, s[4:7], s21 offen offset:256 sc1
  v_mfma_f32_16x16x32_bf16 v[92:95], a[156:159], v[36:39], v[92:95]
  s_waitcnt lgkmcnt(5)
  v_mfma_f32_16x16x32_bf16 v[64:67], a[160:163], v[40:43], v[64:67]
  ds_read_b128 v[32:35], v10 offset:24576
  v_mfma_f32_16x16x32_bf16 v[68:71], a[164:167], v[40:43], v[68:71]
  v_mfma_f32_16x16x32_bf16 v[80:83], a[168:171], v[40:43], v[80:83]
  v_mfma_f32_16x16x32_bf16 v[84:87], a[172:175], v[40:43], v[84:87]
  s_waitcnt lgkmcnt(5)
  v_mfma_f32_16x16x32_bf16 v[72:75], a[160:163], v[44:47], v[72:75]
  ds_read_b128 v[36:39], v11 offset:24576
  v_mfma_f32_16x16x32_bf16 v[76:79], a[164:167], v[44:47], v[76:79]
  v_mfma_f32_16x16x32_bf16 v[88:91], a[168:171], v[44:47], v[88:91]
  buffer_store_dwordx4 v[136:139], v7, s[4:7], s21 offen offset:2048 sc1
  v_mfma_f32_16x16x32_bf16 v[92:95], a[172:175], v[44:47], v[92:95]
  s_waitcnt lgkmcnt(5)
  v_mfma_f32_16x16x32_bf16 v[64:67], a[176:179], v[48:51], v[64:67]
  ds_read_b128 v[40:43], v12 offset:24576
  v_mfma_f32_16x16x32_bf16 v[68:71], a[180:183], v[48:51], v[68:71]
  v_mfma_f32_16x16x32_bf16 v[80:83], a[184:187], v[48:51], v[80:83]
  v_mfma_f32_16x16x32_bf16 v[84:87], a[188:191], v[48:51], v[84:87]
  s_waitcnt lgkmcnt(5)
  v_mfma_f32_16x16x32_bf16 v[72:75], a[176:179], v[52:55], v[72:75]
  ds_read_b128 v[44:47], v13 offset:24576
  v_mfma_f32_16x16x32_bf16 v[76:79], a[180:183], v[52:55], v[76:79]
  v_mfma_f32_16x16x32_bf16 v[88:91], a[184:187], v[52:55], v[88:91]
  buffer_store_dwordx4 v[140:143], v7, s[4:7], s21 offen offset:2304 sc1
  v_mfma_f32_16x16x32_bf16 v[92:95], a[188:191], v[52:55], v[92:95]
  s_waitcnt lgkmcnt(5)
  v_mfma_f32_16x16x32_bf16 v[64:67], a[192:195], v[24:27], v[64:67]
  s_mov_b32 s21, s27
  ds_read_b128 v[48:51], v14 offset:24576
  v_mfma_f32_16x16x32_bf16 v[68:71], a[196:199], v[24:27], v[68:71]
  v_mov_b32 v7, v56
  v_mfma_f32_16x16x32_bf16 v[80:83], a[200:203], v[24:27], v[80:83]
  v_mfma_f32_16x16x32_bf16 v[84:87], a[204:207], v[24:27], v[84:87]
  s_waitcnt lgkmcnt(5)
  v_mfma_f32_16x16x32_bf16 v[72:75], a[192:195], v[28:31], v[72:75]
  s_add_u32 s27, s27, s22
  ds_read_b128 v[52:55], v15 offset:24576
  v_mfma_f32_16x16x32_bf16 v[76:79], a[196:199], v[28:31], v[76:79]
  v_mfma_f32_16x16x32_bf16 v[88:91], a[200:203], v[28:31], v[88:91]
  s_waitcnt vmcnt(13)
  s_barrier
  v_mfma_f32_16x16x32_bf16 v[92:95], a[204:207], v[28:31], v[92:95]
  s_waitcnt lgkmcnt(5)
  v_mfma_f32_16x16x32_bf16 v[64:67], a[208:211], v[32:35], v[64:67]
  ds_read_b128 v[24:27], v8 offset:32768
  v_mfma_f32_16x16x32_bf16 v[68:71], a[212:215], v[32:35], v[68:71]
  v_mfma_f32_16x16x32_bf16 v[80:83], a[216:219], v[32:35], v[80:83]
  v_mfma_f32_16x16x32_bf16 v[84:87], a[220:223], v[32:35], v[84:87]
  s_waitcnt lgkmcnt(5)
  v_mfma_f32_16x16x32_bf16 v[72:75], a[208:211], v[36:39], v[72:75]
  s_add_u32 s29, s29, 1
  ds_read_b128 v[28:31], v9 offset:32768
  v_mfma_f32_16x16x32_bf16 v[76:79], a[212:215], v[36:39], v[76:79]
  v_mfma_f32_16x16x32_bf16 v[88:91], a[216:219], v[36:39], v[88:91]
  s_max_i32 s30, s29, 0
  v_mfma_f32_16x16x32_bf16 v[92:95], a[220:223], v[36:39], v[92:95]
  s_waitcnt lgkmcnt(5)
  v_mov_b32 v144, s30
  v_mfma_f32_16x16x32_bf16 v[64:67], a[224:227], v[40:43], v[64:67]
  ds_read_b128 v[32:35], v10 offset:32768
  v_mfma_f32_16x16x32_bf16 v[68:71], a[228:231], v[40:43], v[68:71]
  v_mfma_f32_16x16x32_bf16 v[80:83], a[232:235], v[40:43], v[80:83]
  buffer_store_dword v144, v145, s[4:7], s31 offen sc1
  v_mfma_f32_16x16x32_bf16 v[84:87], a[236:239], v[40:43], v[84:87]
  s_waitcnt lgkmcnt(5)
  v_mfma_f32_16x16x32_bf16 v[72:75], a[224:227], v[44:47], v[72:75]
  ds_read_b128 v[36:39], v11 offset:32768
  v_mfma_f32_16x16x32_bf16 v[76:79], a[228:231], v[44:47], v[76:79]
  v_mfma_f32_16x16x32_bf16 v[88:91], a[232:235], v[44:47], v[88:91]
  v_mfma_f32_16x16x32_bf16 v[92:95], a[236:239], v[44:47], v[92:95]
  s_waitcnt lgkmcnt(5)
  v_mfma_f32_16x16x32_bf16 v[64:67], a[240:243], v[48:51], v[64:67]
  s_sub_u32 s23, s23, 1
  ds_read_b128 v[40:43], v12 offset:32768
  v_mfma_f32_16x16x32_bf16 v[68:71], a[244:247], v[48:51], v[68:71]
  v_mfma_f32_16x16x32_bf16 v[80:83], a[248:251], v[48:51], v[80:83]
  v_mfma_f32_16x16x32_bf16 v[84:87], a[252:255], v[48:51], v[84:87]
  s_waitcnt lgkmcnt(5)
  v_mfma_f32_16x16x32_bf16 v[72:75], a[240:243], v[52:55], v[72:75]
  s_cmp_eq_u32 s23, 0
  ds_read_b128 v[44:47], v13 offset:32768
  v_mfma_f32_16x16x32_bf16 v[76:79], a[244:247], v[52:55], v[76:79]
  v_mfma_f32_16x16x32_bf16 v[88:91], a[248:251], v[52:55], v[88:91]
  v_mfma_f32_16x16x32_bf16 v[92:95], a[252:255], v[52:55], v[92:95]
  s_cbranch_scc1 G_done0_178
  s_waitcnt lgkmcnt(5)
  v_mfma_f32_16x16x32_bf16 v[96:99], a[0:3], v[24:27], 0
  s_add_u32 m0, s25, 0
  ds_read_b128 v[48:51], v14 offset:32768
  v_mfma_f32_16x16x32_bf16 v[100:103], a[4:7], v[24:27], 0
  v_mfma_f32_16x16x32_bf16 v[112:115], a[8:11], v[24:27], 0
  buffer_load_dwordx4 v16, s[12:15], s19 offen lds
  v_mfma_f32_16x16x32_bf16 v[116:119], a[12:15], v[24:27], 0
  s_waitcnt lgkmcnt(5)
  v_mfma_f32_16x16x32_bf16 v[104:107], a[0:3], v[28:31], 0
  ds_read_b128 v[52:55], v15 offset:32768
  v_mfma_f32_16x16x32_bf16 v[108:111], a[4:7], v[28:31], 0
  v_mul_f32 v64, s24, v64
  v_mul_f32 v65, s24, v65
  v_mfma_f32_16x16x32_bf16 v[120:123], a[8:11], v[28:31], 0
  v_mfma_f32_16x16x32_bf16 v[124:127], a[12:15], v[28:31], 0
  s_waitcnt lgkmcnt(5)
  v_cvt_pk_bf16_f32 v128, v64, v65
  v_mul_f32 v66, s24, v66
  v_mfma_f32_16x16x32_bf16 v[96:99], a[16:19], v[32:35], v[96:99]
  s_add_u32 m0, s25, 1024
  ds_read_b128 v[24:27], v8 offset:40960
  v_mfma_f32_16x16x32_bf16 v[100:103], a[20:23], v[32:35], v[100:103]
  v_mul_f32 v67, s24, v67
  v_cvt_pk_bf16_f32 v129, v66, v67
  v_mfma_f32_16x16x32_bf16 v[112:115], a[24:27], v[32:35], v[112:115]
  buffer_load_dwordx4 v17, s[12:15], s19 offen lds
  v_mfma_f32_16x16x32_bf16 v[116:119], a[28:31], v[32:35], v[116:119]
  s_waitcnt lgkmcnt(5)
  v_mul_f32 v68, s24, v68
  v_mul_f32 v69, s24, v69
  v_mfma_f32_16x16x32_bf16 v[104:107], a[16:19], v[36:39], v[104:107]
  ds_read_b128 v[28:31], v9 offset:40960
  v_mfma_f32_16x16x32_bf16 v[108:111], a[20:23], v[36:39], v[108:111]
  v_cvt_pk_bf16_f32 v130, v68, v69
  v_mul_f32 v70, s24, v70
  v_mfma_f32_16x16x32_bf16 v[120:123], a[24:27], v[36:39], v[120:123]
  v_mfma_f32_16x16x32_bf16 v[124:127], a[28:31], v[36:39], v[124:127]
  s_waitcnt lgkmcnt(5)
  v_mul_f32 v71, s24, v71
  v_cvt_pk_bf16_f32 v131, v70, v71
  v_mfma_f32_16x16x32_bf16 v[96:99], a[32:35], v[40:43], v[96:99]
  s_add_u32 m0, s25, 2048
  ds_read_b128 v[32:35], v10 offset:40960
  v_mfma_f32_16x16x32_bf16 v[100:103], a[36:39], v[40:43], v[100:103]
  v_mul_f32 v72, s24, v72
  v_mul_f32 v73, s24, v73
  v_mfma_f32_16x16x32_bf16 v[112:115], a[40:43], v[40:43], v[112:115]
  buffer_load_dwordx4 v18, s[12:15], s19 offen lds
  v_mfma_f32_16x16x32_bf16 v[116:119], a[44:47], v[40:43], v[116:119]
  s_waitcnt lgkmcnt(5)
  v_cvt_pk_bf16_f32 v132, v72, v73
  v_mul_f32 v74, s24, v74
  v_mfma_f32_16x16x32_bf16 v[104:107], a[32:35], v[44:47], v[104:107]
  ds_read_b128 v[36:39], v11 offset:40960
  v_mfma_f32_16x16x32_bf16 v[108:111], a[36:39], v[44:47], v[108:111]
  v_mul_f32 v75, s24, v75
  v_cvt_pk_bf16_f32 v133, v74, v75
  v_mfma_f32_16x16x32_bf16 v[120:123], a[40:43], v[44:47], v[120:123]
  v_mfma_f32_16x16x32_bf16 v[124:127], a[44:47], v[44:47], v[124:127]
  s_waitcnt lgkmcnt(5)
  v_mul_f32 v76, s24, v76
  v_mul_f32 v77, s24, v77
  v_mfma_f32_16x16x32_bf16 v[96:99], a[48:51], v[48:51], v[96:99]
  s_add_u32 m0, s25, 3072
  ds_read_b128 v[40:43], v12 offset:40960
  v_mfma_f32_16x16x32_bf16 v[100:103], a[52:55], v[48:51], v[100:103]
  v_cvt_pk_bf16_f32 v134, v76, v77
  v_mul_f32 v78, s24, v78
  v_mfma_f32_16x16x32_bf16 v[112:115], a[56:59], v[48:51], v[112:115]
  buffer_load_dwordx4 v19, s[12:15], s19 offen lds
  v_mfma_f32_16x16x32_bf16 v[116:119], a[60:63], v[48:51], v[116:119]
  s_waitcnt lgkmcnt(5)
  v_mul_f32 v79, s24, v79
  v_cvt_pk_bf16_f32 v135, v78, v79
  v_mfma_f32_16x16x32_bf16 v[104:107], a[48:51], v[52:55], v[104:107]
  ds_read_b128 v[44:47], v13 offset:40960
  v_mfma_f32_16x16x32_bf16 v[108:111], a[52:55], v[52:55], v[108:111]
  v_mul_f32 v80, s24, v80
  v_mul_f32 v81, s24, v81
  v_mfma_f32_16x16x32_bf16 v[120:123], a[56:59], v[52:55], v[120:123]
  v_mfma_f32_16x16x32_bf16 v[124:127], a[60:63], v[52:55], v[124:127]
  s_waitcnt lgkmcnt(5)
  v_cvt_pk_bf16_f32 v136, v80, v81
  v_mul_f32 v82, s24, v82
  v_mfma_f32_16x16x32_bf16 v[96:99], a[64:67], v[24:27], v[96:99]
  s_add_u32 m0, s25, 4096
  ds_read_b128 v[48:51], v14 offset:40960
  v_mfma_f32_16x16x32_bf16 v[100:103], a[68:71], v[24:27], v[100:103]
  v_mul_f32 v83, s24, v83
  v_cvt_pk_bf16_f32 v137, v82, v83
  v_mfma_f32_16x16x32_bf16 v[112:115], a[72:75], v[24:27], v[112:115]
  buffer_load_dwordx4 v20, s[12:15], s19 offen lds
  v_mfma_f32_16x16x32_bf16 v[116:119], a[76:79], v[24:27], v[116:119]
  s_waitcnt lgkmcnt(5)
  v_mul_f32 v84, s24, v84
  v_mul_f32 v85, s24, v85
  v_mfma_f32_16x16x32_bf16 v[104:107], a[64:67], v[28:31], v[104:107]
  ds_read_b128 v[52:55], v15 offset:40960
  v_mfma_f32_16x16x32_bf16 v[108:111], a[68:71], v[28:31], v[108:111]
  v_cvt_pk_bf16_f32 v138, v84, v85
  v_mul_f32 v86, s24, v86
  v_mfma_f32_16x16x32_bf16 v[120:123], a[72:75], v[28:31], v[120:123]
  v_mfma_f32_16x16x32_bf16 v[124:127], a[76:79], v[28:31], v[124:127]
  s_waitcnt lgkmcnt(5)
  v_mul_f32 v87, s24, v87
  v_cvt_pk_bf16_f32 v139, v86, v87
  v_mfma_f32_16x16x32_bf16 v[96:99], a[80:83], v[32:35], v[96:99]
  s_add_u32 m0, s25, 5120
  ds_read_b128 v[24:27], v8 offset:49152
  v_mfma_f32_16x16x32_bf16 v[100:103], a[84:87], v[32:35], v[100:103]
  v_mul_f32 v88, s24, v88
  v_mul_f32 v89, s24, v89
  v_mfma_f32_16x16x32_bf16 v[112:115], a[88:91], v[32:35], v[112:115]
  buffer_load_dwordx4 v21, s[12:15], s19 offen lds
  v_mfma_f32_16x16x32_bf16 v[116:119], a[92:95], v[32:35], v[116:119]
  s_waitcnt lgkmcnt(5)
  v_cvt_pk_bf16_f32 v140, v88, v89
  v_mul_f32 v90, s24, v90
  v_mfma_f32_16x16x32_bf16 v[104:107], a[80:83], v[36:39], v[104:107]
  ds_read_b128 v[28:31], v9 offset:49152
  v_mfma_f32_16x16x32_bf16 v[108:111], a[84:87], v[36:39], v[108:111]
  v_mul_f32 v91, s24, v91
  v_cvt_pk_bf16_f32 v141, v90, v91
  v_mfma_f32_16x16x32_bf16 v[120:123], a[88:91], v[36:39], v[120:123]
  v_mfma_f32_16x16x32_bf16 v[124:127], a[92:95], v[36:39], v[124:127]
  s_waitcnt lgkmcnt(5)
  v_mul_f32 v92, s24, v92
  v_mul_f32 v93, s24, v93
  v_mfma_f32_16x16x32_bf16 v[96:99], a[96:99], v[40:43], v[96:99]
  s_add_u32 m0, s25, 6144
  ds_read_b128 v[32:35], v10 offset:49152
  v_mfma_f32_16x16x32_bf16 v[100:103], a[100:103], v[40:43], v[100:103]
  v_cvt_pk_bf16_f32 v142, v92, v93
  v_mul_f32 v94, s24, v94
  v_mfma_f32_16x16x32_bf16 v[112:115], a[104:107], v[40:43], v[112:115]
  buffer_load_dwordx4 v22, s[12:15], s19 offen lds
  v_mfma_f32_16x16x32_bf16 v[116:119], a[108:111], v[40:43], v[116:119]
  s_waitcnt lgkmcnt(5)
  v_mul_f32 v95, s24, v95
  v_cvt_pk_bf16_f32 v143, v94, v95
  v_mfma_f32_16x16x32_bf16 v[104:107], a[96:99], v[44:47], v[104:107]
  ds_read_b128 v[36:39], v11 offset:49152
  v_mfma_f32_16x16x32_bf16 v[108:111], a[100:103], v[44:47], v[108:111]
  v_mfma_f32_16x16x32_bf16 v[120:123], a[104:107], v[44:47], v[120:123]
  v_mfma_f32_16x16x32_bf16 v[124:127], a[108:111], v[44:47], v[124:127]
  s_waitcnt lgkmcnt(5)
  v_mfma_f32_16x16x32_bf16 v[96:99], a[112:115], v[48:51], v[96:99]
  s_add_u32 m0, s25, 7168
  ds_read_b128 v[40:43], v12 offset:49152
  v_mfma_f32_16x16x32_bf16 v[100:103], a[116:119], v[48:51], v[100:103]
  v_mfma_f32_16x16x32_bf16 v[112:115], a[120:123], v[48:51], v[112:115]
  buffer_load_dwordx4 v23, s[12:15], s19 offen lds
  v_mfma_f32_16x16x32_bf16 v[116:119], a[124:127], v[48:51], v[116:119]
  s_waitcnt lgkmcnt(5)
  v_mfma_f32_16x16x32_bf16 v[104:107], a[112:115], v[52:55], v[104:107]
  s_cmp_gt_u32 s23, 3
  ds_read_b128 v[44:47], v13 offset:49152
  v_mfma_f32_16x16x32_bf16 v[108:111], a[116:119], v[52:55], v[108:111]
  v_mfma_f32_16x16x32_bf16 v[120:123], a[120:123], v[52:55], v[120:123]
  s_cselect_b32 s26, s20, 0
  v_mfma_f32_16x16x32_bf16 v[124:127], a[124:127], v[52:55], v[124:127]
  s_waitcnt lgkmcnt(5)
  v_mfma_f32_16x16x32_bf16 v[96:99], a[128:131], v[24:27], v[96:99]
  s_add_u32 s19, s19, s26
  ds_read_b128 v[48:51], v14 offset:49152
  v_mfma_f32_16x16x32_bf16 v[100:103], a[132:135], v[24:27], v[100:103]
  v_mfma_f32_16x16x32_bf16 v[112:115], a[136:139], v[24:27], v[112:115]
  s_add_u32 s25, s25, 32768
  v_mfma_f32_16x16x32_bf16 v[116:119], a[140:143], v[24:27], v[116:119]
  s_waitcnt lgkmcnt(5)
  v_mfma_f32_16x16x32_bf16 v[104:107], a[128:131], v[28:31], v[104:107]
  s_and_b32 s25, s25, 0x1ffff
  ds_read_b128 v[52:55], v15 offset:49152
  v_mfma_f32_16x16x32_bf16 v[108:111], a[132:135], v[28:31], v[108:111]
  v_mfma_f32_16x16x32_bf16 v[120:123], a[136:139], v[28:31], v[120:123]
  buffer_store_dwordx4 v[128:131], v7, s[4:7], s21 offen offset:0 sc1
  v_mfma_f32_16x16x32_bf16 v[124:127], a[140:143], v[28:31], v[124:127]
  s_waitcnt lgkmcnt(5)
  v_mfma_f32_16x16x32_bf16 v[96:99], a[144:147], v[32:35], v[96:99]
  ds_read_b128 v[24:27], v8 offset:57344
  v_mfma_f32_16x16x32_bf16 v[100:103], a[148:151], v[32:35], v[100:103]
  v_mfma_f32_16x16x32_bf16 v[112:115], a[152:155], v[32:35], v[112:115]
  v_mfma_f32_16x16x32_bf16 v[116:119], a[156:159], v[32:35], v[116:119]
  s_waitcnt lgkmcnt(5)
  v_xor_b32 v8, 0x10000, v8
  v_mfma_f32_16x16x32_bf16 v[104:107], a[144:147], v[36:39], v[104:107]
  ds_read_b128 v[28:31], v9 offset:57344
  v_mfma_f32_16x16x32_bf16 v[108:111], a[148:151], v[36:39], v[108:111]
  v_mfma_f32_16x16x32_bf16 v[120:123], a[152:155], v[36:39], v[120:123]
  buffer_store_dwordx4 v[132:135], v7, s[4:7], s21 offen offset:256 sc1
  v_mfma_f32_16x16x32_bf16 v[124:127], a[156:159], v[36:39], v[124:127]
  s_waitcnt lgkmcnt(5)
  v_xor_b32 v9, 0x10000, v9
  v_mfma_f32_16x16x32_bf16 v[96:99], a[160:163], v[40:43], v[96:99]
  ds_read_b128 v[32:35], v10 offset:57344
  v_mfma_f32_16x16x32_bf16 v[100:103], a[164:167], v[40:43], v[100:103]
  v_mfma_f32_16x16x32_bf16 v[112:115], a[168:171], v[40:43], v[112:115]
  v_mfma_f32_16x16x32_bf16 v[116:119], a[172:175], v[40:43], v[116:119]
  s_waitcnt lgkmcnt(5)
  v_xor_b32 v10, 0x10000, v10
  v_mfma_f32_16x16x32_bf16 v[104:107], a[160:163], v[44:47], v[104:107]
  ds_read_b128 v[36:39], v11 offset:57344
  v_mfma_f32_16x16x32_bf16 v[108:111], a[164:167], v[44:47], v[108:111]
  v_mfma_f32_16x16x32_bf16 v[120:123], a[168:171], v[44:47], v[120:123]
  buffer_store_dwordx4 v[136:139], v7, s[4:7], s21 offen offset:2048 sc1
  v_mfma_f32_16x16x32_bf16 v[124:127], a[172:175], v[44:47], v[124:127]
  s_waitcnt lgkmcnt(5)
  v_xor_b32 v11, 0x10000, v11
  v_mfma_f32_16x16x32_bf16 v[96:99], a[176:179], v[48:51], v[96:99]
  ds_read_b128 v[40:43], v12 offset:57344
  v_mfma_f32_16x16x32_bf16 v[100:103], a[180:183], v[48:51], v[100:103]
  v_mfma_f32_16x16x32_bf16 v[112:115], a[184:187], v[48:51], v[112:115]
  v_mfma_f32_16x16x32_bf16 v[116:119], a[188:191], v[48:51], v[116:119]
  s_waitcnt lgkmcnt(5)
  v_xor_b32 v12, 0x10000, v12
  v_mfma_f32_16x16x32_bf16 v[104:107], a[176:179], v[52:55], v[104:107]
  ds_read_b128 v[44:47], v13 offset:57344
  v_mfma_f32_16x16x32_bf16 v[108:111], a[180:183], v[52:55], v[108:111]
  v_mfma_f32_16x16x32_bf16 v[120:123], a[184:187], v[52:55], v[120:123]
  buffer_store_dwordx4 v[140:143], v7, s[4:7], s21 offen offset:2304 sc1
  v_mfma_f32_16x16x32_bf16 v[124:127], a[188:191], v[52:55], v[124:127]
  s_waitcnt lgkmcnt(5)
  v_xor_b32 v13, 0x10000, v13
  v_mfma_f32_16x16x32_bf16 v[96:99], a[192:195], v[24:27], v[96:99]
  s_mov_b32 s21, s27
  ds_read_b128 v[48:51], v14 offset:57344
  v_mfma_f32_16x16x32_bf16 v[100:103], a[196:199], v[24:27], v[100:103]
  v_mov_b32 v7, v56
  v_mfma_f32_16x16x32_bf16 v[112:115], a[200:203], v[24:27], v[112:115]
  v_mfma_f32_16x16x32_bf16 v[116:119], a[204:207], v[24:27], v[116:119]
  s_waitcnt lgkmcnt(5)
  v_xor_b32 v14, 0x10000, v14
  v_mfma_f32_16x16x32_bf16 v[104:107], a[192:195], v[28:31], v[104:107]
  s_add_u32 s27, s27, s22
  ds_read_b128 v[52:55], v15 offset:57344
  v_mfma_f32_16x16x32_bf16 v[108:111], a[196:199], v[28:31], v[108:111]
  v_mfma_f32_16x16x32_bf16 v[120:123], a[200:203], v[28:31], v[120:123]
  s_waitcnt vmcnt(13)
  s_barrier
  v_mfma_f32_16x16x32_bf16 v[124:127], a[204:207], v[28:31], v[124:127]
  s_waitcnt lgkmcnt(5)
  v_xor_b32 v15, 0x10000, v15
  v_mfma_f32_16x16x32_bf16 v[96:99], a[208:211], v[32:35], v[96:99]
  ds_read_b128 v[24:27], v8 offset:0
  v_mfma_f32_16x16x32_bf16 v[100:103], a[212:215], v[32:35], v[100:103]
  v_mfma_f32_16x16x32_bf16 v[112:115], a[216:219], v[32:35], v[112:115]
  v_mfma_f32_16x16x32_bf16 v[116:119], a[220:223], v[32:35], v[116:119]
  s_waitcnt lgkmcnt(5)
  v_mfma_f32_16x16x32_bf16 v[104:107], a[208:211], v[36:39], v[104:107]
  s_add_u32 s29, s29, 1
  ds_read_b128 v[28:31], v9 offset:0
  v_mfma_f32_16x16x32_bf16 v[108:111], a[212:215], v[36:39], v[108:111]
  v_mfma_f32_16x16x32_bf16 v[120:123], a[216:219], v[36:39], v[120:123]
  s_max_i32 s30, s29, 0
  v_mfma_f32_16x16x32_bf16 v[124:127], a[220:223], v[36:39], v[124:127]
  s_waitcnt lgkmcnt(5)
  v_mov_b32 v144, s30
  v_mfma_f32_16x16x32_bf16 v[96:99], a[224:227], v[40:43], v[96:99]
  ds_read_b128 v[32:35], v10 offset:0
  v_mfma_f32_16x16x32_bf16 v[100:103], a[228:231], v[40:43], v[100:103]
  v_mfma_f32_16x16x32_bf16 v[112:115], a[232:235], v[40:43], v[112:115]
  buffer_store_dword v144, v145, s[4:7], s31 offen sc1
  v_mfma_f32_16x16x32_bf16 v[116:119], a[236:239], v[40:43], v[116:119]
  s_waitcnt lgkmcnt(5)
  v_mfma_f32_16x16x32_bf16 v[104:107], a[224:227], v[44:47], v[104:107]
  ds_read_b128 v[36:39], v11 offset:0
  v_mfma_f32_16x16x32_bf16 v[108:111], a[228:231], v[44:47], v[108:111]
  v_mfma_f32_16x16x32_bf16 v[120:123], a[232:235], v[44:47], v[120:123]
  v_mfma_f32_16x16x32_bf16 v[124:127], a[236:239], v[44:47], v[124:127]
  s_waitcnt lgkmcnt(5)
  v_mfma_f32_16x16x32_bf16 v[96:99], a[240:243], v[48:51], v[96:99]
  s_sub_u32 s23, s23, 1
  ds_read_b128 v[40:43], v12 offset:0
  v_mfma_f32_16x16x32_bf16 v[100:103], a[244:247], v[48:51], v[100:103]
  v_mfma_f32_16x16x32_bf16 v[112:115], a[248:251], v[48:51], v[112:115]
  v_mfma_f32_16x16x32_bf16 v[116:119], a[252:255], v[48:51], v[116:119]
  s_waitcnt lgkmcnt(5)
  v_mfma_f32_16x16x32_bf16 v[104:107], a[240:243], v[52:55], v[104:107]
  s_cmp_eq_u32 s23, 0
  ds_read_b128 v[44:47], v13 offset:0
  v_mfma_f32_16x16x32_bf16 v[108:111], a[244:247], v[52:55], v[108:111]
  v_mfma_f32_16x16x32_bf16 v[120:123], a[248:251], v[52:55], v[120:123]
  v_mfma_f32_16x16x32_bf16 v[124:127], a[252:255], v[52:55], v[124:127]
  s_cbranch_scc1 G_done1_179
  s_branch G_top_177
G_done0_178:
  s_nop 7
  s_nop 3
  v_mul_f32 v64, s24, v64
  v_mul_f32 v65, s24, v65
  v_cvt_pk_bf16_f32 v128, v64, v65
  v_mul_f32 v66, s24, v66
  v_mul_f32 v67, s24, v67
  v_cvt_pk_bf16_f32 v129, v66, v67
  v_mul_f32 v68, s24, v68
  v_mul_f32 v69, s24, v69
  v_cvt_pk_bf16_f32 v130, v68, v69
  v_mul_f32 v70, s24, v70
  v_mul_f32 v71, s24, v71
  v_cvt_pk_bf16_f32 v131, v70, v71
  buffer_store_dwordx4 v[128:131], v7, s[4:7], s21 offen offset:0 sc1
  v_mul_f32 v72, s24, v72
  v_mul_f32 v73, s24, v73
  v_cvt_pk_bf16_f32 v132, v72, v73
  v_mul_f32 v74, s24, v74
  v_mul_f32 v75, s24, v75
  v_cvt_pk_bf16_f32 v133, v74, v75
  v_mul_f32 v76, s24, v76
  v_mul_f32 v77, s24, v77
  v_cvt_pk_bf16_f32 v134, v76, v77
  v_mul_f32 v78, s24, v78
  v_mul_f32 v79, s24, v79
  v_cvt_pk_bf16_f32 v135, v78, v79
  buffer_store_dwordx4 v[132:135], v7, s[4:7], s21 offen offset:256 sc1
  v_mul_f32 v80, s24, v80
  v_mul_f32 v81, s24, v81
  v_cvt_pk_bf16_f32 v136, v80, v81
  v_mul_f32 v82, s24, v82
  v_mul_f32 v83, s24, v83
  v_cvt_pk_bf16_f32 v137, v82, v83
  v_mul_f32 v84, s24, v84
  v_mul_f32 v85, s24, v85
  v_cvt_pk_bf16_f32 v138, v84, v85
  v_mul_f32 v86, s24, v86
  v_mul_f32 v87, s24, v87
  v_cvt_pk_bf16_f32 v139, v86, v87
  buffer_store_dwordx4 v[136:139], v7, s[4:7], s21 offen offset:2048 sc1
  v_mul_f32 v88, s24, v88
  v_mul_f32 v89, s24, v89
  v_cvt_pk_bf16_f32 v140, v88, v89
  v_mul_f32 v90, s24, v90
  v_mul_f32 v91, s24, v91
  v_cvt_pk_bf16_f32 v141, v90, v91
  v_mul_f32 v92, s24, v92
  v_mul_f32 v93, s24, v93
  v_cvt_pk_bf16_f32 v142, v92, v93
  v_mul_f32 v94, s24, v94
  v_mul_f32 v95, s24, v95
  v_cvt_pk_bf16_f32 v143, v94, v95
  buffer_store_dwordx4 v[140:143], v7, s[4:7], s21 offen offset:2304 sc1
  s_branch G_fin_180
G_done1_179:
  s_nop 7
  s_nop 3
  v_mul_f32 v96, s24, v96
  v_mul_f32 v97, s24, v97
  v_cvt_pk_bf16_f32 v128, v96, v97
  v_mul_f32 v98, s24, v98
  v_mul_f32 v99, s24, v99
  v_cvt_pk_bf16_f32 v129, v98, v99
  v_mul_f32 v100, s24, v100
  v_mul_f32 v101, s24, v101
  v_cvt_pk_bf16_f32 v130, v100, v101
  v_mul_f32 v102, s24, v102
  v_mul_f32 v103, s24, v103
  v_cvt_pk_bf16_f32 v131, v102, v103
  buffer_store_dwordx4 v[128:131], v7, s[4:7], s21 offen offset:0 sc1
  v_mul_f32 v104, s24, v104
  v_mul_f32 v105, s24, v105
  v_cvt_pk_bf16_f32 v132, v104, v105
  v_mul_f32 v106, s24, v106
  v_mul_f32 v107, s24, v107
  v_cvt_pk_bf16_f32 v133, v106, v107
  v_mul_f32 v108, s24, v108
  v_mul_f32 v109, s24, v109
  v_cvt_pk_bf16_f32 v134, v108, v109
  v_mul_f32 v110, s24, v110
  v_mul_f32 v111, s24, v111
  v_cvt_pk_bf16_f32 v135, v110, v111
  buffer_store_dwordx4 v[132:135], v7, s[4:7], s21 offen offset:256 sc1
  v_mul_f32 v112, s24, v112
  v_mul_f32 v113, s24, v113
  v_cvt_pk_bf16_f32 v136, v112, v113
  v_mul_f32 v114, s24, v114
  v_mul_f32 v115, s24, v115
  v_cvt_pk_bf16_f32 v137, v114, v115
  v_mul_f32 v116, s24, v116
  v_mul_f32 v117, s24, v117
  v_cvt_pk_bf16_f32 v138, v116, v117
  v_mul_f32 v118, s24, v118
  v_mul_f32 v119, s24, v119
  v_cvt_pk_bf16_f32 v139, v118, v119
  buffer_store_dwordx4 v[136:139], v7, s[4:7], s21 offen offset:2048 sc1
  v_mul_f32 v120, s24, v120
  v_mul_f32 v121, s24, v121
  v_cvt_pk_bf16_f32 v140, v120, v121
  v_mul_f32 v122, s24, v122
  v_mul_f32 v123, s24, v123
  v_cvt_pk_bf16_f32 v141, v122, v123
  v_mul_f32 v124, s24, v124
  v_mul_f32 v125, s24, v125
  v_cvt_pk_bf16_f32 v142, v124, v125
  v_mul_f32 v126, s24, v126
  v_mul_f32 v127, s24, v127
  v_cvt_pk_bf16_f32 v143, v126, v127
  buffer_store_dwordx4 v[140:143], v7, s[4:7], s21 offen offset:2304 sc1
G_fin_180:
  s_waitcnt vmcnt(0) lgkmcnt(0)
  s_barrier
  s_add_u32 s30, s29, 2
  v_mov_b32 v144, s30
  v_min_u32 v145, 1, v0
  v_lshlrev_b32 v145, 30, v145
  buffer_store_dword v144, v145, s[4:7], s31 offen sc1
  s_branch P_end_171
P_v_170:
  s_mov_b32 s27, s21
  v_mov_b32 v7, 0x40000000
  s_mov_b32 s29, -2
  v_min_u32 v145, 1, v0
  v_lshlrev_b32 v145, 30, v145
  ds_read_b128 v[24:27], v8 offset:0
  ds_read_b128 v[28:31], v9 offset:0
  ds_read_b128 v[32:35], v10 offset:0
  ds_read_b128 v[36:39], v11 offset:0
  ds_read_b128 v[40:43], v12 offset:0
  ds_read_b128 v[44:47], v13 offset:0
.p2align 6
G_top_181:
  s_waitcnt lgkmcnt(5)
  v_mfma_f32_16x16x32_bf16 v[64:67], v[24:27], a[0:3], 0
  s_add_u32 m0, s25, 0
  ds_read_b128 v[48:51], v14 offset:0
  v_mfma_f32_16x16x32_bf16 v[72:75], v[24:27], a[4:7], 0
  v_mfma_f32_16x16x32_bf16 v[80:83], v[24:27], a[8:11], 0
  buffer_load_dwordx4 v16, s[12:15], s19 offen lds
  v_mfma_f32_16x16x32_bf16 v[88:91], v[24:27], a[12:15], 0
  s_waitcnt lgkmcnt(5)
  v_mfma_f32_16x16x32_bf16 v[68:71], v[28:31], a[0:3], 0
  ds_read_b128 v[52:55], v15 offset:0
  v_mfma_f32_16x16x32_bf16 v[76:79], v[28:31], a[4:7], 0
  v_cvt_pk_bf16_f32 v128, v96, v97
  v_cvt_pk_bf16_f32 v129, v98, v99
  v_mfma_f32_16x16x32_bf16 v[84:87], v[28:31], a[8:11], 0
  v_mfma_f32_16x16x32_bf16 v[92:95], v[28:31], a[12:15], 0
  s_waitcnt lgkmcnt(5)
  v_cvt_pk_bf16_f32 v130, v100, v101
  v_cvt_pk_bf16_f32 v131, v102, v103
  v_mfma_f32_16x16x32_bf16 v[64:67], v[32:35], a[16:19], v[64:67]
  s_add_u32 m0, s25, 1024
  ds_read_b128 v[24:27], v8 offset:8192
  v_mfma_f32_16x16x32_bf16 v[72:75], v[32:35], a[20:23], v[72:75]
  v_mfma_f32_16x16x32_bf16 v[80:83], v[32:35], a[24:27], v[80:83]
  buffer_load_dwordx4 v17, s[12:15], s19 offen lds
  v_mfma_f32_16x16x32_bf16 v[88:91], v[32:35], a[28:31], v[88:91]
  s_waitcnt lgkmcnt(5)
  v_mfma_f32_16x16x32_bf16 v[68:71], v[36:39], a[16:19], v[68:71]
  ds_read_b128 v[28:31], v9 offset:8192
  v_mfma_f32_16x16x32_bf16 v[76:79], v[36:39], a[20:23], v[76:79]
  v_mfma_f32_16x16x32_bf16 v[84:87], v[36:39], a[24:27], v[84:87]
  v_mfma_f32_16x16x32_bf16 v[92:95], v[36:39], a[28:31], v[92:95]
  s_waitcnt lgkmcnt(5)
  v_mfma_f32_16x16x32_bf16 v[64:67], v[40:43], a[32:35], v[64:67]
  s_add_u32 m0, s25, 2048
  ds_read_b128 v[32:35], v10 offset:8192
  v_mfma_f32_16x16x32_bf16 v[72:75], v[40:43], a[36:39], v[72:75]
  v_cvt_pk_bf16_f32 v132, v104, v105
  v_cvt_pk_bf16_f32 v133, v106, v107
  v_mfma_f32_16x16x32_bf16 v[80:83], v[40:43], a[40:43], v[80:83]
  buffer_load_dwordx4 v18, s[12:15], s19 offen lds
  v_mfma_f32_16x16x32_bf16 v[88:91], v[40:43], a[44:47], v[88:91]
  s_waitcnt lgkmcnt(5)
  v_cvt_pk_bf16_f32 v134, v108, v109
  v_cvt_pk_bf16_f32 v135, v110, v111
  v_mfma_f32_16x16x32_bf16 v[68:71], v[44:47], a[32:35], v[68:71]
  ds_read_b128 v[36:39], v11 offset:8192
  v_mfma_f32_16x16x32_bf16 v[76:79], v[44:47], a[36:39], v[76:79]
  v_mfma_f32_16x16x32_bf16 v[84:87], v[44:47], a[40:43], v[84:87]
  v_mfma_f32_16x16x32_bf16 v[92:95], v[44:47], a[44:47], v[92:95]
  s_waitcnt lgkmcnt(5)
  v_mfma_f32_16x16x32_bf16 v[64:67], v[48:51], a[48:51], v[64:67]
  s_add_u32 m0, s25, 3072
  ds_read_b128 v[40:43], v12 offset:8192
  v_mfma_f32_16x16x32_bf16 v[72:75], v[48:51], a[52:55], v[72:75]
  v_mfma_f32_16x16x32_bf16 v[80:83], v[48:51], a[56:59], v[80:83]
  buffer_load_dwordx4 v19, s[12:15], s19 offen lds
  v_mfma_f32_16x16x32_bf16 v[88:91], v[48:51], a[60:63], v[88:91]
  s_waitcnt lgkmcnt(5)
  v_mfma_f32_16x16x32_bf16 v[68:71], v[52:55], a[48:51], v[68:71]
  ds_read_b128 v[44:47], v13 offset:8192
  v_mfma_f32_16x16x32_bf16 v[76:79], v[52:55], a[52:55], v[76:79]
  v_cvt_pk_bf16_f32 v136, v112, v113
  v_cvt_pk_bf16_f32 v137, v114, v115
  v_mfma_f32_16x16x32_bf16 v[84:87], v[52:55], a[56:59], v[84:87]
  v_mfma_f32_16x16x32_bf16 v[92:95], v[52:55], a[60:63], v[92:95]
  s_waitcnt lgkmcnt(5)
  v_cvt_pk_bf16_f32 v138, v116, v117
  v_cvt_pk_bf16_f32 v139, v118, v119
  v_mfma_f32_16x16x32_bf16 v[64:67], v[24:27], a[64:67], v[64:67]
  s_add_u32 m0, s25, 4096
  ds_read_b128 v[48:51], v14 offset:8192
  v_mfma_f32_16x16x32_bf16 v[72:75], v[24:27], a[68:71], v[72:75]
  v_mfma_f32_16x16x32_bf16 v[80:83], v[24:27], a[72:75], v[80:83]
  buffer_load_dwordx4 v20, s[12:15], s19 offen lds
  v_mfma_f32_16x16x32_bf16 v[88:91], v[24:27], a[76:79], v[88:91]
  s_waitcnt lgkmcnt(5)
  v_mfma_f32_16x16x32_bf16 v[68:71], v[28:31], a[64:67], v[68:71]
  ds_read_b128 v[52:55], v15 offset:8192
  v_mfma_f32_16x16x32_bf16 v[76:79], v[28:31], a[68:71], v[76:79]
  v_mfma_f32_16x16x32_bf16 v[84:87], v[28:31], a[72:75], v[84:87]
  v_mfma_f32_16x16x32_bf16 v[92:95], v[28:31], a[76:79], v[92:95]
  s_waitcnt lgkmcnt(5)
  v_mfma_f32_16x16x32_bf16 v[64:67], v[32:35], a[80:83], v[64:67]
  s_add_u32 m0, s25, 5120
  ds_read_b128 v[24:27], v8 offset:16384
  v_mfma_f32_16x16x32_bf16 v[72:75], v[32:35], a[84:87], v[72:75]
  v_cvt_pk_bf16_f32 v140, v120, v121
  v_cvt_pk_bf16_f32 v141, v122, v123
  v_mfma_f32_16x16x32_bf16 v[80:83], v[32:35], a[88:91], v[80:83]
  buffer_load_dwordx4 v21, s[12:15], s19 offen lds
  v_mfma_f32_16x16x32_bf16 v[88:91], v[32:35], a[92:95], v[88:91]
  s_waitcnt lgkmcnt(5)
  v_cvt_pk_bf16_f32 v142, v124, v125
  v_cvt_pk_bf16_f32 v143, v126, v127
  v_mfma_f32_16x16x32_bf16 v[68:71], v[36:39], a[80:83], v[68:71]
  ds_read_b128 v[28:31], v9 offset:16384
  v_mfma_f32_16x16x32_bf16 v[76:79], v[36:39], a[84:87], v[76:79]
  v_mfma_f32_16x16x32_bf16 v[84:87], v[36:39], a[88:91], v[84:87]
  v_mfma_f32_16x16x32_bf16 v[92:95], v[36:39], a[92:95], v[92:95]
  s_waitcnt lgkmcnt(5)
  v_mfma_f32_16x16x32_bf16 v[64:67], v[40:43], a[96:99], v[64:67]
  s_add_u32 m0, s25, 6144
  ds_read_b128 v[32:35], v10 offset:16384
  v_mfma_f32_16x16x32_bf16 v[72:75], v[40:43], a[100:103], v[72:75]
  v_mfma_f32_16x16x32_bf16 v[80:83], v[40:43], a[104:107], v[80:83]
  buffer_load_dwordx4 v22, s[12:15], s19 offen lds
  v_mfma_f32_16x16x32_bf16 v[88:91], v[40:43], a[108:111], v[88:91]
  s_waitcnt lgkmcnt(5)
  v_mfma_f32_16x16x32_bf16 v[68:71], v[44:47], a[96:99], v[68:71]
  ds_read_b128 v[36:39], v11 offset:16384
  v_mfma_f32_16x16x32_bf16 v[76:79], v[44:47], a[100:103], v[76:79]
  v_mfma_f32_16x16x32_bf16 v[84:87], v[44:47], a[104:107], v[84:87]
  v_mfma_f32_16x16x32_bf16 v[92:95], v[44:47], a[108:111], v[92:95]
  s_waitcnt lgkmcnt(5)
  v_mfma_f32_16x16x32_bf16 v[64:67], v[48:51], a[112:115], v[64:67]
  s_add_u32 m0, s25, 7168
  ds_read_b128 v[40:43], v12 offset:16384
  v_mfma_f32_16x16x32_bf16 v[72:75], v[48:51], a[116:119], v[72:75]
  v_mfma_f32_16x16x32_bf16 v[80:83], v[48:51], a[120:123], v[80:83]
  buffer_load_dwordx4 v23, s[12:15], s19 offen lds
  v_mfma_f32_16x16x32_bf16 v[88:91], v[48:51], a[124:127], v[88:91]
  s_waitcnt lgkmcnt(5)
  v_mfma_f32_16x16x32_bf16 v[68:71], v[52:55], a[112:115], v[68:71]
  s_cmp_gt_u32 s23, 3
  ds_read_b128 v[44:47], v13 offset:16384
  v_mfma_f32_16x16x32_bf16 v[76:79], v[52:55], a[116:119], v[76:79]
  v_mfma_f32_16x16x32_bf16 v[84:87], v[52:55], a[120:123], v[84:87]
  s_cselect_b32 s26, s20, 0
  v_mfma_f32_16x16x32_bf16 v[92:95], v[52:55], a[124:127], v[92:95]
  s_waitcnt lgkmcnt(5)
  v_mfma_f32_16x16x32_bf16 v[64:67], v[24:27], a[128:131], v[64:67]
  s_add_u32 s19, s19, s26
  ds_read_b128 v[48:51], v14 offset:16384
  v_mfma_f32_16x16x32_bf16 v[72:75], v[24:27], a[132:135], v[72:75]
  v_mfma_f32_16x16x32_bf16 v[80:83], v[24:27], a[136:139], v[80:83]
  s_add_u32 s25, s25, 32768
  v_mfma_f32_16x16x32_bf16 v[88:91], v[24:27], a[140:143], v[88:91]
  s_waitcnt lgkmcnt(5)
  v_mfma_f32_16x16x32_bf16 v[68:71], v[28:31], a[128:131], v[68:71]
  s_and_b32 s25, s25, 0x1ffff
  ds_read_b128 v[52:55], v15 offset:16384
  v_mfma_f32_16x16x32_bf16 v[76:79], v[28:31], a[132:135], v[76:79]
  v_mfma_f32_16x16x32_bf16 v[84:87], v[28:31], a[136:139], v[84:87]
  buffer_store_dwordx4 v[128:131], v7, s[4:7], s21 offen offset:0 sc1
  v_mfma_f32_16x16x32_bf16 v[92:95], v[28:31], a[140:143], v[92:95]
  s_waitcnt lgkmcnt(5)
  v_mfma_f32_16x16x32_bf16 v[64:67], v[32:35], a[144:147], v[64:67]
  ds_read_b128 v[24:27], v8 offset:24576
  v_mfma_f32_16x16x32_bf16 v[72:75], v[32:35], a[148:151], v[72:75]
  v_mfma_f32_16x16x32_bf16 v[80:83], v[32:35], a[152:155], v[80:83]
  v_mfma_f32_16x16x32_bf16 v[88:91], v[32:35], a[156:159], v[88:91]
  s_waitcnt lgkmcnt(5)
  v_mfma_f32_16x16x32_bf16 v[68:71], v[36:39], a[144:147], v[68:71]
  ds_read_b128 v[28:31], v9 offset:24576
  v_mfma_f32_16x16x32_bf16 v[76:79], v[36:39], a[148:151], v[76:79]
  v_mfma_f32_16x16x32_bf16 v[84:87], v[36:39], a[152:155], v[84:87]
  buffer_store_dwordx4 v[132:135], v7, s[4:7], s21 offen offset:256 sc1
  v_mfma_f32_16x16x32_bf16 v[92:95], v[36:39], a[156:159], v[92:95]
  s_waitcnt lgkmcnt(5)
  v_mfma_f32_16x16x32_bf16 v[64:67], v[40:43], a[160:163], v[64:67]
  ds_read_b128 v[32:35], v10 offset:24576
  v_mfma_f32_16x16x32_bf16 v[72:75], v[40:43], a[164:167], v[72:75]
  v_mfma_f32_16x16x32_bf16 v[80:83], v[40:43], a[168:171], v[80:83]
  v_mfma_f32_16x16x32_bf16 v[88:91], v[40:43], a[172:175], v[88:91]
  s_waitcnt lgkmcnt(5)
  v_mfma_f32_16x16x32_bf16 v[68:71], v[44:47], a[160:163], v[68:71]
  ds_read_b128 v[36:39], v11 offset:24576
  v_mfma_f32_16x16x32_bf16 v[76:79], v[44:47], a[164:167], v[76:79]
  v_mfma_f32_16x16x32_bf16 v[84:87], v[44:47], a[168:171], v[84:87]
  buffer_store_dwordx4 v[136:139], v7, s[4:7], s21 offen offset:2048 sc1
  v_mfma_f32_16x16x32_bf16 v[92:95], v[44:47], a[172:175], v[92:95]
  s_waitcnt lgkmcnt(5)
  v_mfma_f32_16x16x32_bf16 v[64:67], v[48:51], a[176:179], v[64:67]
  ds_read_b128 v[40:43], v12 offset:24576
  v_mfma_f32_16x16x32_bf16 v[72:75], v[48:51], a[180:183], v[72:75]
  v_mfma_f32_16x16x32_bf16 v[80:83], v[48:51], a[184:187], v[80:83]
  v_mfma_f32_16x16x32_bf16 v[88:91], v[48:51], a[188:191], v[88:91]
  s_waitcnt lgkmcnt(5)
  v_mfma_f32_16x16x32_bf16 v[68:71], v[52:55], a[176:179], v[68:71]
  ds_read_b128 v[44:47], v13 offset:24576
  v_mfma_f32_16x16x32_bf16 v[76:79], v[52:55], a[180:183], v[76:79]
  v_mfma_f32_16x16x32_bf16 v[84:87], v[52:55], a[184:187], v[84:87]
  buffer_store_dwordx4 v[140:143], v7, s[4:7], s21 offen offset:2304 sc1
  v_mfma_f32_16x16x32_bf16 v[92:95], v[52:55], a[188:191], v[92:95]
  s_waitcnt lgkmcnt(5)
  v_mfma_f32_16x16x32_bf16 v[64:67], v[24:27], a[192:195], v[64:67]
  s_mov_b32 s21, s27
  ds_read_b128 v[48:51], v14 offset:24576
  v_mfma_f32_16x16x32_bf16 v[72:75], v[24:27], a[196:199], v[72:75]
  v_mov_b32 v7, v56
  v_mfma_f32_16x16x32_bf16 v[80:83], v[24:27], a[200:203], v[80:83]
  v_mfma_f32_16x16x32_bf16 v[88:91], v[24:27], a[204:207], v[88:91]
  s_waitcnt lgkmcnt(5)
  v_mfma_f32_16x16x32_bf16 v[68:71], v[28:31], a[192:195], v[68:71]
  s_add_u32 s27, s27, s22
  ds_read_b128 v[52:55], v15 offset:24576
  v_mfma_f32_16x16x32_bf16 v[76:79], v[28:31], a[196:199], v[76:79]
  v_mfma_f32_16x16x32_bf16 v[84:87], v[28:31], a[200:203], v[84:87]
  s_waitcnt vmcnt(13)
  s_barrier
  v_mfma_f32_16x16x32_bf16 v[92:95], v[28:31], a[204:207], v[92:95]
  s_waitcnt lgkmcnt(5)
  v_mfma_f32_16x16x32_bf16 v[64:67], v[32:35], a[208:211], v[64:67]
  ds_read_b128 v[24:27], v8 offset:32768
  v_mfma_f32_16x16x32_bf16 v[72:75], v[32:35], a[212:215], v[72:75]
  v_mfma_f32_16x16x32_bf16 v[80:83], v[32:35], a[216:219], v[80:83]
  v_mfma_f32_16x16x32_bf16 v[88:91], v[32:35], a[220:223], v[88:91]
  s_waitcnt lgkmcnt(5)
  v_mfma_f32_16x16x32_bf16 v[68:71], v[36:39], a[208:211], v[68:71]
  s_add_u32 s29, s29, 1
  ds_read_b128 v[28:31], v9 offset:32768
  v_mfma_f32_16x16x32_bf16 v[76:79], v[36:39], a[212:215], v[76:79]
  v_mfma_f32_16x16x32_bf16 v[84:87], v[36:39], a[216:219], v[84:87]
  s_max_i32 s30, s29, 0
  v_mfma_f32_16x16x32_bf16 v[92:95], v[36:39], a[220:223], v[92:95]
  s_waitcnt lgkmcnt(5)
  v_mov_b32 v144, s30
  v_mfma_f32_16x16x32_bf16 v[64:67], v[40:43], a[224:227], v[64:67]
  ds_read_b128 v[32:35], v10 offset:32768
  v_mfma_f32_16x16x32_bf16 v[72:75], v[40:43], a[228:231], v[72:75]
  v_mfma_f32_16x16x32_bf16 v[80:83], v[40:43], a[232:235], v[80:83]
  buffer_store_dword v144, v145, s[4:7], s31 offen sc1
  v_mfma_f32_16x16x32_bf16 v[88:91], v[40:43], a[236:239], v[88:91]
  s_waitcnt lgkmcnt(5)
  v_mfma_f32_16x16x32_bf16 v[68:71], v[44:47], a[224:227], v[68:71]
  ds_read_b128 v[36:39], v11 offset:32768
  v_mfma_f32_16x16x32_bf16 v[76:79], v[44:47], a[228:231], v[76:79]
  v_mfma_f32_16x16x32_bf16 v[84:87], v[44:47], a[232:235], v[84:87]
  v_mfma_f32_16x16x32_bf16 v[92:95], v[44:47], a[236:239], v[92:95]
  s_waitcnt lgkmcnt(5)
  v_mfma_f32_16x16x32_bf16 v[64:67], v[48:51], a[240:243], v[64:67]
  s_sub_u32 s23, s23, 1
  ds_read_b128 v[40:43], v12 offset:32768
  v_mfma_f32_16x16x32_bf16 v[72:75], v[48:51], a[244:247], v[72:75]
  v_mfma_f32_16x16x32_bf16 v[80:83], v[48:51], a[248:251], v[80:83]
  v_mfma_f32_16x16x32_bf16 v[88:91], v[48:51], a[252:255], v[88:91]
  s_waitcnt lgkmcnt(5)
  v_mfma_f32_16x16x32_bf16 v[68:71], v[52:55], a[240:243], v[68:71]
  s_cmp_eq_u32 s23, 0
  ds_read_b128 v[44:47], v13 offset:32768
  v_mfma_f32_16x16x32_bf16 v[76:79], v[52:55], a[244:247], v[76:79]
  v_mfma_f32_16x16x32_bf16 v[84:87], v[52:55], a[248:251], v[84:87]
  v_mfma_f32_16x16x32_bf16 v[92:95], v[52:55], a[252:255], v[92:95]
  s_cbranch_scc1 G_done0_182
  s_waitcnt lgkmcnt(5)
  v_mfma_f32_16x16x32_bf16 v[96:99], v[24:27], a[0:3], 0
  s_add_u32 m0, s25, 0
  ds_read_b128 v[48:51], v14 offset:32768
  v_mfma_f32_16x16x32_bf16 v[104:107], v[24:27], a[4:7], 0
  v_mfma_f32_16x16x32_bf16 v[112:115], v[24:27], a[8:11], 0
  buffer_load_dwordx4 v16, s[12:15], s19 offen lds
  v_mfma_f32_16x16x32_bf16 v[120:123], v[24:27], a[12:15], 0
  s_waitcnt lgkmcnt(5)
  v_mfma_f32_16x16x32_bf16 v[100:103], v[28:31], a[0:3], 0
  ds_read_b128 v[52:55], v15 offset:32768
  v_mfma_f32_16x16x32_bf16 v[108:111], v[28:31], a[4:7], 0
  v_cvt_pk_bf16_f32 v128, v64, v65
  v_cvt_pk_bf16_f32 v129, v66, v67
  v_mfma_f32_16x16x32_bf16 v[116:119], v[28:31], a[8:11], 0
  v_mfma_f32_16x16x32_bf16 v[124:127], v[28:31], a[12:15], 0
  s_waitcnt lgkmcnt(5)
  v_cvt_pk_bf16_f32 v130, v68, v69
  v_cvt_pk_bf16_f32 v131, v70, v71
  v_mfma_f32_16x16x32_bf16 v[96:99], v[32:35], a[16:19], v[96:99]
  s_add_u32 m0, s25, 1024
  ds_read_b128 v[24:27], v8 offset:40960
  v_mfma_f32_16x16x32_bf16 v[104:107], v[32:35], a[20:23], v[104:107]
  v_mfma_f32_16x16x32_bf16 v[112:115], v[32:35], a[24:27], v[112:115]
  buffer_load_dwordx4 v17, s[12:15], s19 offen lds
  v_mfma_f32_16x16x32_bf16 v[120:123], v[32:35], a[28:31], v[120:123]
  s_waitcnt lgkmcnt(5)
  v_mfma_f32_16x16x32_bf16 v[100:103], v[36:39], a[16:19], v[100:103]
  ds_read_b128 v[28:31], v9 offset:40960
  v_mfma_f32_16x16x32_bf16 v[108:111], v[36:39], a[20:23], v[108:111]
  v_mfma_f32_16x16x32_bf16 v[116:119], v[36:39], a[24:27], v[116:119]
  v_mfma_f32_16x16x32_bf16 v[124:127], v[36:39], a[28:31], v[124:127]
  s_waitcnt lgkmcnt(5)
  v_mfma_f32_16x16x32_bf16 v[96:99], v[40:43], a[32:35], v[96:99]
  s_add_u32 m0, s25, 2048
  ds_read_b128 v[32:35], v10 offset:40960
  v_mfma_f32_16x16x32_bf16 v[104:107], v[40:43], a[36:39], v[104:107]
  v_cvt_pk_bf16_f32 v132, v72, v73
  v_cvt_pk_bf16_f32 v133, v74, v75
  v_mfma_f32_16x16x32_bf16 v[112:115], v[40:43], a[40:43], v[112:115]
  buffer_load_dwordx4 v18, s[12:15], s19 offen lds
  v_mfma_f32_16x16x32_bf16 v[120:123], v[40:43], a[44:47], v[120:123]
  s_waitcnt lgkmcnt(5)
  v_cvt_pk_bf16_f32 v134, v76, v77
  v_cvt_pk_bf16_f32 v135, v78, v79
  v_mfma_f32_16x16x32_bf16 v[100:103], v[44:47], a[32:35], v[100:103]
  ds_read_b128 v[36:39], v11 offset:40960
  v_mfma_f32_16x16x32_bf16 v[108:111], v[44:47], a[36:39], v[108:111]
  v_mfma_f32_16x16x32_bf16 v[116:119], v[44:47], a[40:43], v[116:119]
  v_mfma_f32_16x16x32_bf16 v[124:127], v[44:47], a[44:47], v[124:127]
  s_waitcnt lgkmcnt(5)
  v_mfma_f32_16x16x32_bf16 v[96:99], v[48:51], a[48:51], v[96:99]
  s_add_u32 m0, s25, 3072
  ds_read_b128 v[40:43], v12 offset:40960
  v_mfma_f32_16x16x32_bf16 v[104:107], v[48:51], a[52:55], v[104:107]
  v_mfma_f32_16x16x32_bf16 v[112:115], v[48:51], a[56:59], v[112:115]
  buffer_load_dwordx4 v19, s[12:15], s19 offen lds
  v_mfma_f32_16x16x32_bf16 v[120:123], v[48:51], a[60:63], v[120:123]
  s_waitcnt lgkmcnt(5)
  v_mfma_f32_16x16x32_bf16 v[100:103], v[52:55], a[48:51], v[100:103]
  ds_read_b128 v[44:47], v13 offset:40960
  v_mfma_f32_16x16x32_bf16 v[108:111], v[52:55], a[52:55], v[108:111]
  v_cvt_pk_bf16_f32 v136, v80, v81
  v_cvt_pk_bf16_f32 v137, v82, v83
  v_mfma_f32_16x16x32_bf16 v[116:119], v[52:55], a[56:59], v[116:119]
  v_mfma_f32_16x16x32_bf16 v[124:127], v[52:55], a[60:63], v[124:127]
  s_waitcnt lgkmcnt(5)
  v_cvt_pk_bf16_f32 v138, v84, v85
  v_cvt_pk_bf16_f32 v139, v86, v87
  v_mfma_f32_16x16x32_bf16 v[96:99], v[24:27], a[64:67], v[96:99]
  s_add_u32 m0, s25, 4096
  ds_read_b128 v[48:51], v14 offset:40960
  v_mfma_f32_16x16x32_bf16 v[104:107], v[24:27], a[68:71], v[104:107]
  v_mfma_f32_16x16x32_bf16 v[112:115], v[24:27], a[72:75], v[112:115]
  buffer_load_dwordx4 v20, s[12:15], s19 offen lds
  v_mfma_f32_16x16x32_bf16 v[120:123], v[24:27], a[76:79], v[120:123]
  s_waitcnt lgkmcnt(5)
  v_mfma_f32_16x16x32_bf16 v[100:103], v[28:31], a[64:67], v[100:103]
  ds_read_b128 v[52:55], v15 offset:40960
  v_mfma_f32_16x16x32_bf16 v[108:111], v[28:31], a[68:71], v[108:111]
  v_mfma_f32_16x16x32_bf16 v[116:119], v[28:31], a[72:75], v[116:119]
  v_mfma_f32_16x16x32_bf16 v[124:127], v[28:31], a[76:79], v[124:127]
  s_waitcnt lgkmcnt(5)
  v_mfma_f32_16x16x32_bf16 v[96:99], v[32:35], a[80:83], v[96:99]
  s_add_u32 m0, s25, 5120
  ds_read_b128 v[24:27], v8 offset:49152
  v_mfma_f32_16x16x32_bf16 v[104:107], v[32:35], a[84:87], v[104:107]
  v_cvt_pk_bf16_f32 v140, v88, v89
  v_cvt_pk_bf16_f32 v141, v90, v91
  v_mfma_f32_16x16x32_bf16 v[112:115], v[32:35], a[88:91], v[112:115]
  buffer_load_dwordx4 v21, s[12:15], s19 offen lds
  v_mfma_f32_16x16x32_bf16 v[120:123], v[32:35], a[92:95], v[120:123]
  s_waitcnt lgkmcnt(5)
  v_cvt_pk_bf16_f32 v142, v92, v93
  v_cvt_pk_bf16_f32 v143, v94, v95
  v_mfma_f32_16x16x32_bf16 v[100:103], v[36:39], a[80:83], v[100:103]
  ds_read_b128 v[28:31], v9 offset:49152
  v_mfma_f32_16x16x32_bf16 v[108:111], v[36:39], a[84:87], v[108:111]
  v_mfma_f32_16x16x32_bf16 v[116:119], v[36:39], a[88:91], v[116:119]
  v_mfma_f32_16x16x32_bf16 v[124:127], v[36:39], a[92:95], v[124:127]
  s_waitcnt lgkmcnt(5)
  v_mfma_f32_16x16x32_bf16 v[96:99], v[40:43], a[96:99], v[96:99]
  s_add_u32 m0, s25, 6144
  ds_read_b128 v[32:35], v10 offset:49152
  v_mfma_f32_16x16x32_bf16 v[104:107], v[40:43], a[100:103], v[104:107]
  v_mfma_f32_16x16x32_bf16 v[112:115], v[40:43], a[104:107], v[112:115]
  buffer_load_dwordx4 v22, s[12:15], s19 offen lds
  v_mfma_f32_16x16x32_bf16 v[120:123], v[40:43], a[108:111], v[120:123]
  s_waitcnt lgkmcnt(5)
  v_mfma_f32_16x16x32_bf16 v[100:103], v[44:47], a[96:99], v[100:103]
  ds_read_b128 v[36:39], v11 offset:49152
  v_mfma_f32_16x16x32_bf16 v[108:111], v[44:47], a[100:103], v[108:111]
  v_mfma_f32_16x16x32_bf16 v[116:119], v[44:47], a[104:107], v[116:119]
  v_mfma_f32_16x16x32_bf16 v[124:127], v[44:47], a[108:111], v[124:127]
  s_waitcnt lgkmcnt(5)
  v_mfma_f32_16x16x32_bf16 v[96:99], v[48:51], a[112:115], v[96:99]
  s_add_u32 m0, s25, 7168
  ds_read_b128 v[40:43], v12 offset:49152
  v_mfma_f32_16x16x32_bf16 v[104:107], v[48:51], a[116:119], v[104:107]
  v_mfma_f32_16x16x32_bf16 v[112:115], v[48:51], a[120:123], v[112:115]
  buffer_load_dwordx4 v23, s[12:15], s19 offen lds
  v_mfma_f32_16x16x32_bf16 v[120:123], v[48:51], a[124:127], v[120:123]
  s_waitcnt lgkmcnt(5)
  v_mfma_f32_16x16x32_bf16 v[100:103], v[52:55], a[112:115], v[100:103]
  s_cmp_gt_u32 s23, 3
  ds_read_b128 v[44:47], v13 offset:49152
  v_mfma_f32_16x16x32_bf16 v[108:111], v[52:55], a[116:119], v[108:111]
  v_mfma_f32_16x16x32_bf16 v[116:119], v[52:55], a[120:123], v[116:119]
  s_cselect_b32 s26, s20, 0
  v_mfma_f32_16x16x32_bf16 v[124:127], v[52:55], a[124:127], v[124:127]
  s_waitcnt lgkmcnt(5)
  v_mfma_f32_16x16x32_bf16 v[96:99], v[24:27], a[128:131], v[96:99]
  s_add_u32 s19, s19, s26
  ds_read_b128 v[48:51], v14 offset:49152
  v_mfma_f32_16x16x32_bf16 v[104:107], v[24:27], a[132:135], v[104:107]
  v_mfma_f32_16x16x32_bf16 v[112:115], v[24:27], a[136:139], v[112:115]
  s_add_u32 s25, s25, 32768
  v_mfma_f32_16x16x32_bf16 v[120:123], v[24:27], a[140:143], v[120:123]
  s_waitcnt lgkmcnt(5)
  v_mfma_f32_16x16x32_bf16 v[100:103], v[28:31], a[128:131], v[100:103]
  s_and_b32 s25, s25, 0x1ffff
  ds_read_b128 v[52:55], v15 offset:49152
  v_mfma_f32_16x16x32_bf16 v[108:111], v[28:31], a[132:135], v[108:111]
  v_mfma_f32_16x16x32_bf16 v[116:119], v[28:31], a[136:139], v[116:119]
  buffer_store_dwordx4 v[128:131], v7, s[4:7], s21 offen offset:0 sc1
  v_mfma_f32_16x16x32_bf16 v[124:127], v[28:31], a[140:143], v[124:127]
  s_waitcnt lgkmcnt(5)
  v_mfma_f32_16x16x32_bf16 v[96:99], v[32:35], a[144:147], v[96:99]
  ds_read_b128 v[24:27], v8 offset:57344
  v_mfma_f32_16x16x32_bf16 v[104:107], v[32:35], a[148:151], v[104:107]
  v_mfma_f32_16x16x32_bf16 v[112:115], v[32:35], a[152:155], v[112:115]
  v_mfma_f32_16x16x32_bf16 v[120:123], v[32:35], a[156:159], v[120:123]
  s_waitcnt lgkmcnt(5)
  v_xor_b32 v8, 0x10000, v8
  v_mfma_f32_16x16x32_bf16 v[100:103], v[36:39], a[144:147], v[100:103]
  ds_read_b128 v[28:31], v9 offset:57344
  v_mfma_f32_16x16x32_bf16 v[108:111], v[36:39], a[148:151], v[108:111]
  v_mfma_f32_16x16x32_bf16 v[116:119], v[36:39], a[152:155], v[116:119]
  buffer_store_dwordx4 v[132:135], v7, s[4:7], s21 offen offset:256 sc1
  v_mfma_f32_16x16x32_bf16 v[124:127], v[36:39], a[156:159], v[124:127]
  s_waitcnt lgkmcnt(5)
  v_xor_b32 v9, 0x10000, v9
  v_mfma_f32_16x16x32_bf16 v[96:99], v[40:43], a[160:163], v[96:99]
  ds_read_b128 v[32:35], v10 offset:57344
  v_mfma_f32_16x16x32_bf16 v[104:107], v[40:43], a[164:167], v[104:107]
  v_mfma_f32_16x16x32_bf16 v[112:115], v[40:43], a[168:171], v[112:115]
  v_mfma_f32_16x16x32_bf16 v[120:123], v[40:43], a[172:175], v[120:123]
  s_waitcnt lgkmcnt(5)
  v_xor_b32 v10, 0x10000, v10
  v_mfma_f32_16x16x32_bf16 v[100:103], v[44:47], a[160:163], v[100:103]
  ds_read_b128 v[36:39], v11 offset:57344
  v_mfma_f32_16x16x32_bf16 v[108:111], v[44:47], a[164:167], v[108:111]
  v_mfma_f32_16x16x32_bf16 v[116:119], v[44:47], a[168:171], v[116:119]
  buffer_store_dwordx4 v[136:139], v7, s[4:7], s21 offen offset:2048 sc1
  v_mfma_f32_16x16x32_bf16 v[124:127], v[44:47], a[172:175], v[124:127]
  s_waitcnt lgkmcnt(5)
  v_xor_b32 v11, 0x10000, v11
  v_mfma_f32_16x16x32_bf16 v[96:99], v[48:51], a[176:179], v[96:99]
  ds_read_b128 v[40:43], v12 offset:57344
  v_mfma_f32_16x16x32_bf16 v[104:107], v[48:51], a[180:183], v[104:107]
  v_mfma_f32_16x16x32_bf16 v[112:115], v[48:51], a[184:187], v[112:115]
  v_mfma_f32_16x16x32_bf16 v[120:123], v[48:51], a[188:191], v[120:123]
  s_waitcnt lgkmcnt(5)
  v_xor_b32 v12, 0x10000, v12
  v_mfma_f32_16x16x32_bf16 v[100:103], v[52:55], a[176:179], v[100:103]
  ds_read_b128 v[44:47], v13 offset:57344
  v_mfma_f32_16x16x32_bf16 v[108:111], v[52:55], a[180:183], v[108:111]
  v_mfma_f32_16x16x32_bf16 v[116:119], v[52:55], a[184:187], v[116:119]
  buffer_store_dwordx4 v[140:143], v7, s[4:7], s21 offen offset:2304 sc1
  v_mfma_f32_16x16x32_bf16 v[124:127], v[52:55], a[188:191], v[124:127]
  s_waitcnt lgkmcnt(5)
  v_xor_b32 v13, 0x10000, v13
  v_mfma_f32_16x16x32_bf16 v[96:99], v[24:27], a[192:195], v[96:99]
  s_mov_b32 s21, s27
  ds_read_b128 v[48:51], v14 offset:57344
  v_mfma_f32_16x16x32_bf16 v[104:107], v[24:27], a[196:199], v[104:107]
  v_mov_b32 v7, v56
  v_mfma_f32_16x16x32_bf16 v[112:115], v[24:27], a[200:203], v[112:115]
  v_mfma_f32_16x16x32_bf16 v[120:123], v[24:27], a[204:207], v[120:123]
  s_waitcnt lgkmcnt(5)
  v_xor_b32 v14, 0x10000, v14
  v_mfma_f32_16x16x32_bf16 v[100:103], v[28:31], a[192:195], v[100:103]
  s_add_u32 s27, s27, s22
  ds_read_b128 v[52:55], v15 offset:57344
  v_mfma_f32_16x16x32_bf16 v[108:111], v[28:31], a[196:199], v[108:111]
  v_mfma_f32_16x16x32_bf16 v[116:119], v[28:31], a[200:203], v[116:119]
  s_waitcnt vmcnt(13)
  s_barrier
  v_mfma_f32_16x16x32_bf16 v[124:127], v[28:31], a[204:207], v[124:127]
  s_waitcnt lgkmcnt(5)
  v_xor_b32 v15, 0x10000, v15
  v_mfma_f32_16x16x32_bf16 v[96:99], v[32:35], a[208:211], v[96:99]
  ds_read_b128 v[24:27], v8 offset:0
  v_mfma_f32_16x16x32_bf16 v[104:107], v[32:35], a[212:215], v[104:107]
  v_mfma_f32_16x16x32_bf16 v[112:115], v[32:35], a[216:219], v[112:115]
  v_mfma_f32_16x16x32_bf16 v[120:123], v[32:35], a[220:223], v[120:123]
  s_waitcnt lgkmcnt(5)
  v_mfma_f32_16x16x32_bf16 v[100:103], v[36:39], a[208:211], v[100:103]
  s_add_u32 s29, s29, 1
  ds_read_b128 v[28:31], v9 offset:0
  v_mfma_f32_16x16x32_bf16 v[108:111], v[36:39], a[212:215], v[108:111]
  v_mfma_f32_16x16x32_bf16 v[116:119], v[36:39], a[216:219], v[116:119]
  s_max_i32 s30, s29, 0
  v_mfma_f32_16x16x32_bf16 v[124:127], v[36:39], a[220:223], v[124:127]
  s_waitcnt lgkmcnt(5)
  v_mov_b32 v144, s30
  v_mfma_f32_16x16x32_bf16 v[96:99], v[40:43], a[224:227], v[96:99]
  ds_read_b128 v[32:35], v10 offset:0
  v_mfma_f32_16x16x32_bf16 v[104:107], v[40:43], a[228:231], v[104:107]
  v_mfma_f32_16x16x32_bf16 v[112:115], v[40:43], a[232:235], v[112:115]
  buffer_store_dword v144, v145, s[4:7], s31 offen sc1
  v_mfma_f32_16x16x32_bf16 v[120:123], v[40:43], a[236:239], v[120:123]
  s_waitcnt lgkmcnt(5)
  v_mfma_f32_16x16x32_bf16 v[100:103], v[44:47], a[224:227], v[100:103]
  ds_read_b128 v[36:39], v11 offset:0
  v_mfma_f32_16x16x32_bf16 v[108:111], v[44:47], a[228:231], v[108:111]
  v_mfma_f32_16x16x32_bf16 v[116:119], v[44:47], a[232:235], v[116:119]
  v_mfma_f32_16x16x32_bf16 v[124:127], v[44:47], a[236:239], v[124:127]
  s_waitcnt lgkmcnt(5)
  v_mfma_f32_16x16x32_bf16 v[96:99], v[48:51], a[240:243], v[96:99]
  s_sub_u32 s23, s23, 1
  ds_read_b128 v[40:43], v12 offset:0
  v_mfma_f32_16x16x32_bf16 v[104:107], v[48:51], a[244:247], v[104:107]
  v_mfma_f32_16x16x32_bf16 v[112:115], v[48:51], a[248:251], v[112:115]
  v_mfma_f32_16x16x32_bf16 v[120:123], v[48:51], a[252:255], v[120:123]
  s_waitcnt lgkmcnt(5)
  v_mfma_f32_16x16x32_bf16 v[100:103], v[52:55], a[240:243], v[100:103]
  s_cmp_eq_u32 s23, 0
  ds_read_b128 v[44:47], v13 offset:0
  v_mfma_f32_16x16x32_bf16 v[108:111], v[52:55], a[244:247], v[108:111]
  v_mfma_f32_16x16x32_bf16 v[116:119], v[52:55], a[248:251], v[116:119]
  v_mfma_f32_16x16x32_bf16 v[124:127], v[52:55], a[252:255], v[124:127]
  s_cbranch_scc1 G_done1_183
  s_branch G_top_181
G_done0_182:
  s_nop 7
  s_nop 3
  v_cvt_pk_bf16_f32 v128, v64, v65
  v_cvt_pk_bf16_f32 v129, v66, v67
  v_cvt_pk_bf16_f32 v130, v68, v69
  v_cvt_pk_bf16_f32 v131, v70, v71
  buffer_store_dwordx4 v[128:131], v7, s[4:7], s21 offen offset:0 sc1
  v_cvt_pk_bf16_f32 v132, v72, v73
  v_cvt_pk_bf16_f32 v133, v74, v75
  v_cvt_pk_bf16_f32 v134, v76, v77
  v_cvt_pk_bf16_f32 v135, v78, v79
  buffer_store_dwordx4 v[132:135], v7, s[4:7], s21 offen offset:256 sc1
  v_cvt_pk_bf16_f32 v136, v80, v81
  v_cvt_pk_bf16_f32 v137, v82, v83
  v_cvt_pk_bf16_f32 v138, v84, v85
  v_cvt_pk_bf16_f32 v139, v86, v87
  buffer_store_dwordx4 v[136:139], v7, s[4:7], s21 offen offset:2048 sc1
  v_cvt_pk_bf16_f32 v140, v88, v89
  v_cvt_pk_bf16_f32 v141, v90, v91
  v_cvt_pk_bf16_f32 v142, v92, v93
  v_cvt_pk_bf16_f32 v143, v94, v95
  buffer_store_dwordx4 v[140:143], v7, s[4:7], s21 offen offset:2304 sc1
  s_branch G_fin_184
G_done1_183:
  s_nop 7
  s_nop 3
  v_cvt_pk_bf16_f32 v128, v96, v97
  v_cvt_pk_bf16_f32 v129, v98, v99
  v_cvt_pk_bf16_f32 v130, v100, v101
  v_cvt_pk_bf16_f32 v131, v102, v103
  buffer_store_dwordx4 v[128:131], v7, s[4:7], s21 offen offset:0 sc1
  v_cvt_pk_bf16_f32 v132, v104, v105
  v_cvt_pk_bf16_f32 v133, v106, v107
  v_cvt_pk_bf16_f32 v134, v108, v109
  v_cvt_pk_bf16_f32 v135, v110, v111
  buffer_store_dwordx4 v[132:135], v7, s[4:7], s21 offen offset:256 sc1
  v_cvt_pk_bf16_f32 v136, v112, v113
  v_cvt_pk_bf16_f32 v137, v114, v115
  v_cvt_pk_bf16_f32 v138, v116, v117
  v_cvt_pk_bf16_f32 v139, v118, v119
  buffer_store_dwordx4 v[136:139], v7, s[4:7], s21 offen offset:2048 sc1
  v_cvt_pk_bf16_f32 v140, v120, v121
  v_cvt_pk_bf16_f32 v141, v122, v123
  v_cvt_pk_bf16_f32 v142, v124, v125
  v_cvt_pk_bf16_f32 v143, v126, v127
  buffer_store_dwordx4 v[140:143], v7, s[4:7], s21 offen offset:2304 sc1
G_fin_184:
  s_waitcnt vmcnt(0) lgkmcnt(0)
  s_barrier
  s_add_u32 s30, s29, 2
  v_mov_b32 v144, s30
  v_min_u32 v145, 1, v0
  v_lshlrev_b32 v145, 30, v145
  buffer_store_dword v144, v145, s[4:7], s31 offen sc1
P_end_171:
  s_mov_b32 s71, 0
  s_branch M_sg_186
M_sw_185:
  s_sleep 8
  s_add_u32 s71, s71, 1
  s_cmp_gt_u32 s71, 262144
  s_cbranch_scc1 M_exit
M_sg_186:
  s_mov_b32 s79, 0
  s_atomic_or s79, s[74:75], 128 glc
  s_waitcnt lgkmcnt(0)
  s_cmp_lt_u32 s79, 256
  s_cbranch_scc1 M_sw_185
  s_cmp_eq_u32 s65, 6
  s_cbranch_scc1 M_follow
  s_mov_b32 s68, 0
  s_mov_b32 s36, -1
  s_mov_b32 s69, s53
  s_mov_b32 s70, s54
  s_load_dwordx2 s[8:9], s[0:1], 40
  s_mul_i32 s76, s64, 6
  s_add_u32 s76, s76, s65
  s_mul_i32 s76, s76, 21888
  v_min_u32 v200, 170, v0
  v_mul_u32_u24 v200, 128, v200
  v_add_u32 v200, s76, v200
  s_waitcnt lgkmcnt(0)
  s_and_b32 s9, s9, 0xffff
  s_mov_b32 s10, 4194304
  s_mov_b32 s11, 0x20000
M_att:
  s_mov_b32 s24, 0xf149f2ca
  s_mov_b32 s29, 0
  v_mov_b32 v6, 0
  v_mov_b32 v7, 0
  s_lshl_b32 s26, s16, 11
  v_add_u32 v3, s26, v2
  v_and_b32 v5, 31, v1
  v_lshrrev_b32 v12, 5, v1
  v_lshlrev_b32 v12, 2, v12
  v_sub_u32 v5, v5, v12
  s_lshl_b32 s26, s64, 19
  s_add_u32 s19, s26, 16777216
  s_add_u32 s20, s26, 33554432
  s_lshl_b32 s27, s69, 2
  s_add_u32 s27, s27, s16
  s_lshl_b32 s27, s27, 14
  s_add_u32 s25, s26, s27
  s_bfe_u32 s78, s70, 0x80000
  s_add_u32 s76, s67, 512
  s_mov_b32 s71, 0
  s_branch M_sg_188
M_sw_187:
  s_sleep 8
  s_add_u32 s71, s71, 1
  s_cmp_gt_u32 s71, 262144
  s_cbranch_scc1 M_exit
M_sg_188:
  s_mov_b32 s79, 0
  s_atomic_or s79, s[72:73], s76 glc
  s_waitcnt lgkmcnt(0)
  s_cmp_lt_u32 s79, s78
  s_cbranch_scc1 M_sw_187
  s_bfe_u32 s78, s70, 0x80008
  s_add_u32 s76, s67, 640
  s_mov_b32 s71, 0
  s_branch M_sg_190
M_sw_189:
  s_sleep 8
  s_add_u32 s71, s71, 1
  s_cmp_gt_u32 s71, 262144
  s_cbranch_scc1 M_exit
M_sg_190:
  s_mov_b32 s79, 0
  s_atomic_or s79, s[72:73], s76 glc
  s_waitcnt lgkmcnt(0)
  s_cmp_lt_u32 s79, s78
  s_cbranch_scc1 M_sw_189
  s_lshl_b32 s27, s69, 16
  s_add_u32 s27, s27, 16384
  s_add_u32 s17, s19, s27
M_kv_191:
  s_cmp_ge_u32 s17, s36
  s_cbranch_scc1 M_kvok_192
  s_mov_b32 s76, 0
  s_mov_b32 s78, 23
  s_mov_b32 s77, 335872
  s_cmp_eq_u32 s68, 1
  s_cmov_b32 s76, 128
  s_cmov_b32 s78, 27
  s_cmov_b32 s77, 114688
  s_cmp_eq_u32 s68, 2
  s_cmov_b32 s76, 768
  s_cmov_b32 s78, 14
  s_cmov_b32 s77, 0
  s_add_u32 s76, s76, s67
  s_mov_b32 s71, 0
  s_branch M_sg_194
M_sw_193:
  s_sleep 8
  s_add_u32 s71, s71, 1
  s_cmp_gt_u32 s71, 262144
  s_cbranch_scc1 M_exit
M_sg_194:
  s_mov_b32 s79, 0
  s_atomic_or s79, s[72:73], s76 glc
  s_waitcnt lgkmcnt(0)
  s_cmp_lt_u32 s79, s78
  s_cbranch_scc1 M_sw_193
  s_add_u32 s36, s77, s19
  s_add_u32 s68, s68, 1
  s_branch M_kv_191
M_kvok_192:
  s_add_u32 s28, s25, 0
  buffer_load_dwordx4 a[128:131], v2, s[4:7], s28 offen offset:0 sc1
  buffer_load_dwordx4 a[132:135], v2, s[4:7], s28 offen offset:1024 sc1
  buffer_load_dwordx4 a[136:139], v2, s[4:7], s28 offen offset:2048 sc1
  buffer_load_dwordx4 a[140:143], v2, s[4:7], s28 offen offset:3072 sc1
  s_add_u32 s28, s25, 4096
  buffer_load_dwordx4 a[144:147], v2, s[4:7], s28 offen offset:0 sc1
  buffer_load_dwordx4 a[148:151], v2, s[4:7], s28 offen offset:1024 sc1
  buffer_load_dwordx4 a[152:155], v2, s[4:7], s28 offen offset:2048 sc1
  buffer_load_dwordx4 a[156:159], v2, s[4:7], s28 offen offset:3072 sc1
  s_add_u32 s28, s25, 8192
  buffer_load_dwordx4 a[160:163], v2, s[4:7], s28 offen offset:0 sc1
  buffer_load_dwordx4 a[164:167], v2, s[4:7], s28 offen offset:1024 sc1
  buffer_load_dwordx4 a[168:171], v2, s[4:7], s28 offen offset:2048 sc1
  buffer_load_dwordx4 a[172:175], v2, s[4:7], s28 offen offset:3072 sc1
  s_add_u32 s28, s25, 12288
  buffer_load_dwordx4 a[176:179], v2, s[4:7], s28 offen offset:0 sc1
  buffer_load_dwordx4 a[180:183], v2, s[4:7], s28 offen offset:1024 sc1
  buffer_load_dwordx4 a[184:187], v2, s[4:7], s28 offen offset:2048 sc1
  buffer_load_dwordx4 a[188:191], v2, s[4:7], s28 offen offset:3072 sc1
A_again_195:
  s_lshl_b32 s27, s69, 16
  s_add_u32 s27, s27, 57344
  s_add_u32 s17, s19, s27
  s_add_u32 s18, s20, s27
  s_lshl_b32 s21, s16, 11
  s_mov_b32 m0, s21
  s_nop 0
  buffer_load_dwordx4 v3, s[4:7], s18 offen offset:0 sc1 lds
  buffer_load_dwordx4 v3, s[4:7], s18 offen offset:1024 sc1 lds
  s_add_u32 m0, s21, 8192
  s_nop 0
  buffer_load_dwordx4 v3, s[4:7], s17 offen offset:0 sc1 lds
  buffer_load_dwordx4 v3, s[4:7], s17 offen offset:1024 sc1 lds
  s_add_u32 s18, s18, 8192
  s_sub_u32 s18, s18, 8192
  s_max_i32 s18, s18, s20
  s_sub_u32 s17, s17, 8192
  s_max_i32 s17, s17, s19
  s_add_u32 s21, s21, 16384
  s_and_b32 s21, s21, 131071
  s_mov_b32 m0, s21
  s_nop 0
  buffer_load_dwordx4 v3, s[4:7], s18 offen offset:0 sc1 lds
  buffer_load_dwordx4 v3, s[4:7], s18 offen offset:1024 sc1 lds
  s_add_u32 m0, s21, 8192
  s_nop 0
  buffer_load_dwordx4 v3, s[4:7], s17 offen offset:0 sc1 lds
  buffer_load_dwordx4 v3, s[4:7], s17 offen offset:1024 sc1 lds
  s_sub_u32 s18, s18, 8192
  s_max_i32 s18, s18, s20
  s_sub_u32 s17, s17, 8192
  s_max_i32 s17, s17, s19
  s_add_u32 s21, s21, 16384
  s_and_b32 s21, s21, 131071
  s_mov_b32 m0, s21
  s_nop 0
  buffer_load_dwordx4 v3, s[4:7], s18 offen offset:0 sc1 lds
  buffer_load_dwordx4 v3, s[4:7], s18 offen offset:1024 sc1 lds
  s_add_u32 m0, s21, 8192
  s_nop 0
  buffer_load_dwordx4 v3, s[4:7], s17 offen offset:0 sc1 lds
  buffer_load_dwordx4 v3, s[4:7], s17 offen offset:1024 sc1 lds
  s_sub_u32 s18, s18, 8192
  s_max_i32 s18, s18, s20
  s_sub_u32 s17, s17, 8192
  s_max_i32 s17, s17, s19
  s_add_u32 s21, s21, 16384
  s_and_b32 s21, s21, 131071
  s_mov_b32 m0, s21
  s_nop 0
  buffer_load_dwordx4 v3, s[4:7], s18 offen offset:0 sc1 lds
  buffer_load_dwordx4 v3, s[4:7], s18 offen offset:1024 sc1 lds
  s_add_u32 m0, s21, 8192
  s_nop 0
  buffer_load_dwordx4 v3, s[4:7], s17 offen offset:0 sc1 lds
  buffer_load_dwordx4 v3, s[4:7], s17 offen offset:1024 sc1 lds
  s_sub_u32 s18, s18, 8192
  s_max_i32 s18, s18, s20
  s_sub_u32 s17, s17, 8192
  s_max_i32 s17, s17, s19
  s_add_u32 s21, s21, 16384
  s_and_b32 s21, s21, 131071
  s_mov_b32 m0, s21
  s_nop 0
  buffer_load_dwordx4 v3, s[4:7], s18 offen offset:0 sc1 lds
  buffer_load_dwordx4 v3, s[4:7], s18 offen offset:1024 sc1 lds
  s_add_u32 m0, s21, 8192
  s_nop 0
  buffer_load_dwordx4 v3, s[4:7], s17 offen offset:0 sc1 lds
  buffer_load_dwordx4 v3, s[4:7], s17 offen offset:1024 sc1 lds
  s_sub_u32 s18, s18, 8192
  s_max_i32 s18, s18, s20
  s_sub_u32 s17, s17, 8192
  s_max_i32 s17, s17, s19
  s_add_u32 s21, s21, 16384
  s_and_b32 s21, s21, 131071
  s_mov_b32 m0, s21
  s_nop 0
  buffer_load_dwordx4 v3, s[4:7], s18 offen offset:0 sc1 lds
  buffer_load_dwordx4 v3, s[4:7], s18 offen offset:1024 sc1 lds
  s_add_u32 m0, s21, 8192
  s_nop 0
  buffer_load_dwordx4 v3, s[4:7], s17 offen offset:0 sc1 lds
  buffer_load_dwordx4 v3, s[4:7], s17 offen offset:1024 sc1 lds
  v_accvgpr_write_b32 a0, 0
  v_accvgpr_write_b32 a1, 0
  v_accvgpr_write_b32 a2, 0
  v_accvgpr_write_b32 a3, 0
  v_accvgpr_write_b32 a4, 0
  v_accvgpr_write_b32 a5, 0
  v_accvgpr_write_b32 a6, 0
  v_accvgpr_write_b32 a7, 0
  v_accvgpr_write_b32 a8, 0
  v_accvgpr_write_b32 a9, 0
  v_accvgpr_write_b32 a10, 0
  v_accvgpr_write_b32 a11, 0
  v_accvgpr_write_b32 a12, 0
  v_accvgpr_write_b32 a13, 0
  v_accvgpr_write_b32 a14, 0
  v_accvgpr_write_b32 a15, 0
  v_accvgpr_write_b32 a16, 0
  v_accvgpr_write_b32 a17, 0
  v_accvgpr_write_b32 a18, 0
  v_accvgpr_write_b32 a19, 0
  v_accvgpr_write_b32 a20, 0
  v_accvgpr_write_b32 a21, 0
  v_accvgpr_write_b32 a22, 0
  v_accvgpr_write_b32 a23, 0
  v_accvgpr_write_b32 a24, 0
  v_accvgpr_write_b32 a25, 0
  v_accvgpr_write_b32 a26, 0
  v_accvgpr_write_b32 a27, 0
  v_accvgpr_write_b32 a28, 0
  v_accvgpr_write_b32 a29, 0
  v_accvgpr_write_b32 a30, 0
  v_accvgpr_write_b32 a31, 0
  v_accvgpr_write_b32 a32, 0
  v_accvgpr_write_b32 a33, 0
  v_accvgpr_write_b32 a34, 0
  v_accvgpr_write_b32 a35, 0
  v_accvgpr_write_b32 a36, 0
  v_accvgpr_write_b32 a37, 0
  v_accvgpr_write_b32 a38, 0
  v_accvgpr_write_b32 a39, 0
  v_accvgpr_write_b32 a40, 0
  v_accvgpr_write_b32 a41, 0
  v_accvgpr_write_b32 a42, 0
  v_accvgpr_write_b32 a43, 0
  v_accvgpr_write_b32 a44, 0
  v_accvgpr_write_b32 a45, 0
  v_accvgpr_write_b32 a46, 0
  v_accvgpr_write_b32 a47, 0
  v_accvgpr_write_b32 a48, 0
  v_accvgpr_write_b32 a49, 0
  v_accvgpr_write_b32 a50, 0
  v_accvgpr_write_b32 a51, 0
  v_accvgpr_write_b32 a52, 0
  v_accvgpr_write_b32 a53, 0
  v_accvgpr_write_b32 a54, 0
  v_accvgpr_write_b32 a55, 0
  v_accvgpr_write_b32 a56, 0
  v_accvgpr_write_b32 a57, 0
  v_accvgpr_write_b32 a58, 0
  v_accvgpr_write_b32 a59, 0
  v_accvgpr_write_b32 a60, 0
  v_accvgpr_write_b32 a61, 0
  v_accvgpr_write_b32 a62, 0
  v_accvgpr_write_b32 a63, 0
  v_accvgpr_write_b32 a64, 0
  v_accvgpr_write_b32 a65, 0
  v_accvgpr_write_b32 a66, 0
  v_accvgpr_write_b32 a67, 0
  v_accvgpr_write_b32 a68, 0
  v_accvgpr_write_b32 a69, 0
  v_accvgpr_write_b32 a70, 0
  v_accvgpr_write_b32 a71, 0
  v_accvgpr_write_b32 a72, 0
  v_accvgpr_write_b32 a73, 0
  v_accvgpr_write_b32 a74, 0
  v_accvgpr_write_b32 a75, 0
  v_accvgpr_write_b32 a76, 0
  v_accvgpr_write_b32 a77, 0
  v_accvgpr_write_b32 a78, 0
  v_accvgpr_write_b32 a79, 0
  v_accvgpr_write_b32 a80, 0
  v_accvgpr_write_b32 a81, 0
  v_accvgpr_write_b32 a82, 0
  v_accvgpr_write_b32 a83, 0
  v_accvgpr_write_b32 a84, 0
  v_accvgpr_write_b32 a85, 0
  v_accvgpr_write_b32 a86, 0
  v_accvgpr_write_b32 a87, 0
  v_accvgpr_write_b32 a88, 0
  v_accvgpr_write_b32 a89, 0
  v_accvgpr_write_b32 a90, 0
  v_accvgpr_write_b32 a91, 0
  v_accvgpr_write_b32 a92, 0
  v_accvgpr_write_b32 a93, 0
  v_accvgpr_write_b32 a94, 0
  v_accvgpr_write_b32 a95, 0
  v_accvgpr_write_b32 a96, 0
  v_accvgpr_write_b32 a97, 0
  v_accvgpr_write_b32 a98, 0
  v_accvgpr_write_b32 a99, 0
  v_accvgpr_write_b32 a100, 0
  v_accvgpr_write_b32 a101, 0
  v_accvgpr_write_b32 a102, 0
  v_accvgpr_write_b32 a103, 0
  v_accvgpr_write_b32 a104, 0
  v_accvgpr_write_b32 a105, 0
  v_accvgpr_write_b32 a106, 0
  v_accvgpr_write_b32 a107, 0
  v_accvgpr_write_b32 a108, 0
  v_accvgpr_write_b32 a109, 0
  v_accvgpr_write_b32 a110, 0
  v_accvgpr_write_b32 a111, 0
  v_accvgpr_write_b32 a112, 0
  v_accvgpr_write_b32 a113, 0
  v_accvgpr_write_b32 a114, 0
  v_accvgpr_write_b32 a115, 0
  v_accvgpr_write_b32 a116, 0
  v_accvgpr_write_b32 a117, 0
  v_accvgpr_write_b32 a118, 0
  v_accvgpr_write_b32 a119, 0
  v_accvgpr_write_b32 a120, 0
  v_accvgpr_write_b32 a121, 0
  v_accvgpr_write_b32 a122, 0
  v_accvgpr_write_b32 a123, 0
  v_accvgpr_write_b32 a124, 0
  v_accvgpr_write_b32 a125, 0
  v_accvgpr_write_b32 a126, 0
  v_accvgpr_write_b32 a127, 0
  v_mov_b32 v8, 0
  v_mov_b32 v9, 0
  v_mov_b32 v10, 0
  v_mov_b32 v11, 0
  v_mov_b32 v52, 0
  v_mov_b32 v53, 0
  v_mov_b32 v54, s24
  v_mov_b32 v55, s24
  v_mov_b32 v56, s24
  v_mov_b32 v57, s24
  v_mov_b32 v58, s24
  v_mov_b32 v59, s24
  v_mov_b32 v60, s24
  v_mov_b32 v61, s24
  v_mov_b32 v62, s24
  v_mov_b32 v63, s24
  v_mov_b32 v104, 0
  v_mov_b32 v105, 0
  v_mov_b32 v4, v2
  v_mov_b32 v64, s24
  v_mov_b32 v65, s24
  v_mov_b32 v66, s24
  v_mov_b32 v67, s24
  v_mov_b32 v68, s24
  v_mov_b32 v69, s24
  v_mov_b32 v70, s24
  v_mov_b32 v71, s24
  v_mov_b32 v72, s24
  v_mov_b32 v73, s24
  v_mov_b32 v74, s24
  v_mov_b32 v75, s24
  v_mov_b32 v76, s24
  v_mov_b32 v77, s24
  v_mov_b32 v78, s24
  v_mov_b32 v79, s24
  v_mov_b32 v12, s24
  v_cmp_le_i32 s[40:41], 0, v5
  v_cmp_le_i32 s[42:43], 1, v5
  v_cmp_le_i32 s[44:45], 2, v5
  v_cmp_le_i32 s[46:47], 3, v5
  v_cndmask_b32 v80, v12, v7, s[40:41]
  v_cndmask_b32 v81, v12, v7, s[42:43]
  v_cndmask_b32 v82, v12, v7, s[44:45]
  v_cndmask_b32 v83, v12, v7, s[46:47]
  v_cmp_le_i32 s[40:41], 8, v5
  v_cmp_le_i32 s[42:43], 9, v5
  v_cmp_le_i32 s[44:45], 10, v5
  v_cmp_le_i32 s[46:47], 11, v5
  v_cndmask_b32 v84, v12, v7, s[40:41]
  v_cndmask_b32 v85, v12, v7, s[42:43]
  v_cndmask_b32 v86, v12, v7, s[44:45]
  v_cndmask_b32 v87, v12, v7, s[46:47]
  v_cmp_le_i32 s[40:41], 16, v5
  v_cmp_le_i32 s[42:43], 17, v5
  v_cmp_le_i32 s[44:45], 18, v5
  v_cmp_le_i32 s[46:47], 19, v5
  v_cndmask_b32 v88, v12, v7, s[40:41]
  v_cndmask_b32 v89, v12, v7, s[42:43]
  v_cndmask_b32 v90, v12, v7, s[44:45]
  v_cndmask_b32 v91, v12, v7, s[46:47]
  v_cmp_le_i32 s[40:41], 24, v5
  v_cmp_le_i32 s[42:43], 25, v5
  v_cmp_le_i32 s[44:45], 26, v5
  v_cmp_le_i32 s[46:47], 27, v5
  v_cndmask_b32 v92, v12, v7, s[40:41]
  v_cndmask_b32 v93, v12, v7, s[42:43]
  v_cndmask_b32 v94, v12, v7, s[44:45]
  v_cndmask_b32 v95, v12, v7, s[46:47]
  s_lshl_b32 s22, s69, 3
  s_add_u32 s22, s22, 8
  s_lshl_b32 s26, s16, 1
  s_sub_u32 s23, 6, s26
  s_waitcnt vmcnt(20)
  s_barrier
  s_cmp_eq_u32 s23, 0
  s_cbranch_scc1 A_go_197
A_idle_196:
  s_waitcnt vmcnt(16)
  s_barrier
  s_sub_u32 s18, s18, 8192
  s_max_i32 s18, s18, s20
  s_sub_u32 s17, s17, 8192
  s_max_i32 s17, s17, s19
  s_add_u32 s21, s21, 16384
  s_and_b32 s21, s21, 131071
M_kv_198:
  s_cmp_ge_u32 s17, s36
  s_cbranch_scc1 M_kvok_199
  s_mov_b32 s76, 0
  s_mov_b32 s78, 23
  s_mov_b32 s77, 335872
  s_cmp_eq_u32 s68, 1
  s_cmov_b32 s76, 128
  s_cmov_b32 s78, 27
  s_cmov_b32 s77, 114688
  s_cmp_eq_u32 s68, 2
  s_cmov_b32 s76, 768
  s_cmov_b32 s78, 14
  s_cmov_b32 s77, 0
  s_add_u32 s76, s76, s67
  s_mov_b32 s71, 0
  s_branch M_sg_201
M_sw_200:
  s_sleep 8
  s_add_u32 s71, s71, 1
  s_cmp_gt_u32 s71, 262144
  s_cbranch_scc1 M_exit
M_sg_201:
  s_mov_b32 s79, 0
  s_atomic_or s79, s[72:73], s76 glc
  s_waitcnt lgkmcnt(0)
  s_cmp_lt_u32 s79, s78
  s_cbranch_scc1 M_sw_200
  s_add_u32 s36, s77, s19
  s_add_u32 s68, s68, 1
  s_branch M_kv_198
M_kvok_199:
  s_mov_b32 m0, s21
  s_nop 0
  buffer_load_dwordx4 v3, s[4:7], s18 offen offset:0 sc1 lds
  buffer_load_dwordx4 v3, s[4:7], s18 offen offset:1024 sc1 lds
  s_add_u32 m0, s21, 8192
  s_nop 0
  buffer_load_dwordx4 v3, s[4:7], s17 offen offset:0 sc1 lds
  buffer_load_dwordx4 v3, s[4:7], s17 offen offset:1024 sc1 lds
  v_add_u32 v4, 16384, v4
  v_and_b32 v4, 131071, v4
  s_sub_u32 s22, s22, 1
  s_sub_u32 s23, s23, 1
  s_cmp_lg_u32 s23, 0
  s_cbranch_scc1 A_idle_196
A_go_197:
  ds_read_b128 a[224:227], v4 offset:0
  ds_read_b128 a[228:231], v4 offset:2048
  ds_read_b128 a[232:235], v4 offset:4096
  ds_read_b128 a[236:239], v4 offset:6144
  ds_read_b128 a[240:243], v4 offset:1024
  ds_read_b128 a[244:247], v4 offset:3072
  ds_read_b128 a[248:251], v4 offset:5120
  ds_read_b128 a[252:255], v4 offset:7168
  ds_read_b128 a[192:195], v4 offset:8192
  ds_read_b128 a[196:199], v4 offset:9216
  ds_read_b128 a[200:203], v4 offset:10240
  ds_read_b128 a[204:207], v4 offset:11264
  ds_read_b128 a[208:211], v4 offset:12288
  ds_read_b128 a[212:215], v4 offset:13312
  ds_read_b128 a[216:219], v4 offset:14336
  ds_read_b128 a[220:223], v4 offset:15360
  v_add_u32 v4, 16384, v4
  v_and_b32 v4, 131071, v4
  s_waitcnt lgkmcnt(8)
.p2align 6
A_top_202:
  s_waitcnt lgkmcnt(7)
  v_mfma_f32_32x32x16_bf16 v[32:47], a[192:195], a[128:131], v[64:79]
  s_waitcnt lgkmcnt(6)
  v_exp_f32 v54, v54
  v_add_f32 v11, v11, v53
  v_cvt_pk_bf16_f32 v106, v52, v53
  v_mfma_f32_32x32x16_bf16 v[32:47], a[196:199], a[132:135], v[32:47]
  s_waitcnt lgkmcnt(4)
  v_exp_f32 v55, v55
  v_add_f32 v10, v10, v54
  v_mfma_f32_32x32x16_bf16 v[32:47], a[200:203], a[136:139], v[32:47]
  v_exp_f32 v56, v56
  v_add_f32 v11, v11, v55
  v_cvt_pk_bf16_f32 v107, v54, v55
  v_mfma_f32_32x32x16_bf16 v[32:47], a[204:207], a[140:143], v[32:47]
  s_waitcnt lgkmcnt(2)
  v_exp_f32 v57, v57
  v_add_f32 v10, v10, v56
  v_mfma_f32_32x32x16_bf16 v[32:47], a[208:211], a[144:147], v[32:47]
  v_exp_f32 v58, v58
  v_add_f32 v11, v11, v57
  v_cvt_pk_bf16_f32 v108, v56, v57
  v_mfma_f32_32x32x16_bf16 v[32:47], a[212:215], a[148:151], v[32:47]
  s_waitcnt lgkmcnt(0)
  v_exp_f32 v59, v59
  v_add_f32 v10, v10, v58
  v_mfma_f32_32x32x16_bf16 v[32:47], a[216:219], a[152:155], v[32:47]
  v_exp_f32 v60, v60
  v_add_f32 v11, v11, v59
  v_cvt_pk_bf16_f32 v109, v58, v59
  v_mfma_f32_32x32x16_bf16 v[32:47], a[220:223], a[156:159], v[32:47]
  s_waitcnt vmcnt(16)
  s_barrier
  v_exp_f32 v61, v61
  v_add_f32 v10, v10, v60
  v_mfma_f32_32x32x16_bf16 a[64:79], a[224:227], v[104:107], a[64:79]
  ds_read_b128 a[224:227], v4 offset:0
  v_exp_f32 v62, v62
  v_add_f32 v11, v11, v61
  v_cvt_pk_bf16_f32 v110, v60, v61
  v_mfma_f32_32x32x16_bf16 a[80:95], a[228:231], v[104:107], a[80:95]
  s_sub_u32 s18, s18, 8192
  ds_read_b128 a[228:231], v4 offset:2048
  v_exp_f32 v63, v63
  v_add_f32 v10, v10, v62
  v_mfma_f32_32x32x16_bf16 a[96:111], a[232:235], v[104:107], a[96:111]
  s_max_i32 s18, s18, s20
  ds_read_b128 a[232:235], v4 offset:4096
  v_exp_f32 v32, v32
  v_add_f32 v11, v11, v63
  v_cvt_pk_bf16_f32 v111, v62, v63
  v_mfma_f32_32x32x16_bf16 a[112:127], a[236:239], v[104:107], a[112:127]
  s_sub_u32 s17, s17, 8192
  ds_read_b128 a[236:239], v4 offset:6144
  v_exp_f32 v33, v33
  v_add_f32 v8, v8, v32
  v_mfma_f32_32x32x16_bf16 a[64:79], a[240:243], v[108:111], a[64:79]
  s_max_i32 s17, s17, s19
  ds_read_b128 a[240:243], v4 offset:1024
  v_exp_f32 v34, v34
  v_add_f32 v9, v9, v33
  v_cvt_pk_bf16_f32 v96, v32, v33
  v_mfma_f32_32x32x16_bf16 a[80:95], a[244:247], v[108:111], a[80:95]
  s_add_u32 s21, s21, 16384
  ds_read_b128 a[244:247], v4 offset:3072
  v_exp_f32 v35, v35
  v_add_f32 v8, v8, v34
  v_mfma_f32_32x32x16_bf16 a[96:111], a[248:251], v[108:111], a[96:111]
  s_and_b32 s21, s21, 131071
  ds_read_b128 a[248:251], v4 offset:5120
  v_exp_f32 v36, v36
  v_add_f32 v9, v9, v35
  v_cvt_pk_bf16_f32 v97, v34, v35
  v_mfma_f32_32x32x16_bf16 a[112:127], a[252:255], v[108:111], a[112:127]
  ds_read_b128 a[252:255], v4 offset:7168
  v_exp_f32 v37, v37
  v_add_f32 v8, v8, v36
  v_mfma_f32_32x32x16_bf16 v[48:63], a[192:195], a[160:163], v[80:95]
  s_add_u32 s23, s23, 1
  ds_read_b128 a[192:195], v4 offset:8192
  v_exp_f32 v38, v38
  v_add_f32 v9, v9, v37
  v_cvt_pk_bf16_f32 v98, v36, v37
  v_mfma_f32_32x32x16_bf16 v[48:63], a[196:199], a[164:167], v[48:63]
  s_sub_u32 s22, s22, 1
  ds_read_b128 a[196:199], v4 offset:9216
  v_exp_f32 v39, v39
  v_add_f32 v8, v8, v38
  v_mfma_f32_32x32x16_bf16 v[48:63], a[200:203], a[168:171], v[48:63]
  s_cmp_lt_u32 s23, 3
  ds_read_b128 a[200:203], v4 offset:10240
  v_exp_f32 v40, v40
  v_add_f32 v9, v9, v39
  v_cvt_pk_bf16_f32 v99, v38, v39
  v_mfma_f32_32x32x16_bf16 v[48:63], a[204:207], a[172:175], v[48:63]
  s_cbranch_scc1 A_upd_203
A_back_204:
  ds_read_b128 a[204:207], v4 offset:11264
  v_exp_f32 v41, v41
  v_add_f32 v8, v8, v40
  v_mfma_f32_32x32x16_bf16 v[48:63], a[208:211], a[176:179], v[48:63]
  s_cmp_lt_u32 s17, s36
  ds_read_b128 a[208:211], v4 offset:12288
  v_exp_f32 v42, v42
  v_add_f32 v9, v9, v41
  v_cvt_pk_bf16_f32 v100, v40, v41
  v_mfma_f32_32x32x16_bf16 v[48:63], a[212:215], a[180:183], v[48:63]
  s_cbranch_scc1 A_kvw_206
A_kvb_207:
  ds_read_b128 a[212:215], v4 offset:13312
  v_exp_f32 v43, v43
  v_add_f32 v8, v8, v42
  v_mfma_f32_32x32x16_bf16 v[48:63], a[216:219], a[184:187], v[48:63]
  s_mov_b32 m0, s21
  ds_read_b128 a[216:219], v4 offset:14336
  v_exp_f32 v44, v44
  v_add_f32 v9, v9, v43
  v_cvt_pk_bf16_f32 v101, v42, v43
  v_mfma_f32_32x32x16_bf16 v[48:63], a[220:223], a[188:191], v[48:63]
  s_waitcnt lgkmcnt(13)
  ds_read_b128 a[220:223], v4 offset:15360
  v_exp_f32 v45, v45
  v_add_f32 v8, v8, v44
  v_mfma_f32_32x32x16_bf16 a[0:15], a[224:227], v[96:99], a[0:15]
  buffer_load_dwordx4 v3, s[4:7], s18 offen offset:0 sc1 lds
  v_exp_f32 v46, v46
  v_add_f32 v9, v9, v45
  v_cvt_pk_bf16_f32 v102, v44, v45
  v_mfma_f32_32x32x16_bf16 a[16:31], a[228:231], v[96:99], a[16:31]
  s_waitcnt lgkmcnt(12)
  v_exp_f32 v47, v47
  v_add_f32 v8, v8, v46
  v_add_u32 v4, 16384, v4
  v_mfma_f32_32x32x16_bf16 a[32:47], a[232:235], v[96:99], a[32:47]
  buffer_load_dwordx4 v3, s[4:7], s18 offen offset:1024 sc1 lds
  v_exp_f32 v48, v48
  v_add_f32 v9, v9, v47
  v_cvt_pk_bf16_f32 v103, v46, v47
  v_mfma_f32_32x32x16_bf16 a[48:63], a[236:239], v[96:99], a[48:63]
  s_waitcnt lgkmcnt(10)
  s_add_u32 m0, s21, 8192
  v_exp_f32 v49, v49
  v_add_f32 v10, v10, v48
  v_and_b32 v4, 131071, v4
  v_mfma_f32_32x32x16_bf16 a[0:15], a[240:243], v[100:103], a[0:15]
  buffer_load_dwordx4 v3, s[4:7], s17 offen offset:0 sc1 lds
  v_exp_f32 v50, v50
  v_add_f32 v11, v11, v49
  v_cvt_pk_bf16_f32 v104, v48, v49
  v_mfma_f32_32x32x16_bf16 a[16:31], a[244:247], v[100:103], a[16:31]
  s_waitcnt lgkmcnt(8)
  s_cmp_lg_u32 s22, 0
  v_exp_f32 v51, v51
  v_add_f32 v10, v10, v50
  v_mfma_f32_32x32x16_bf16 a[32:47], a[248:251], v[100:103], a[32:47]
  buffer_load_dwordx4 v3, s[4:7], s17 offen offset:1024 sc1 lds
  v_exp_f32 v52, v52
  v_add_f32 v11, v11, v51
  v_cvt_pk_bf16_f32 v105, v50, v51
  v_mfma_f32_32x32x16_bf16 a[48:63], a[252:255], v[100:103], a[48:63]
  v_exp_f32 v53, v53
  v_add_f32 v10, v10, v52
  s_cbranch_scc1 A_top_202
  v_exp_f32 v54, v54
  v_add_f32 v11, v11, v53
  v_cvt_pk_bf16_f32 v106, v52, v53
  v_exp_f32 v55, v55
  v_add_f32 v10, v10, v54
  v_exp_f32 v56, v56
  v_add_f32 v11, v11, v55
  v_cvt_pk_bf16_f32 v107, v54, v55
  v_exp_f32 v57, v57
  v_add_f32 v10, v10, v56
  v_exp_f32 v58, v58
  v_add_f32 v11, v11, v57
  v_cvt_pk_bf16_f32 v108, v56, v57
  v_exp_f32 v59, v59
  v_add_f32 v10, v10, v58
  v_exp_f32 v60, v60
  v_add_f32 v11, v11, v59
  v_cvt_pk_bf16_f32 v109, v58, v59
  v_exp_f32 v61, v61
  v_add_f32 v10, v10, v60
  v_exp_f32 v62, v62
  v_add_f32 v11, v11, v61
  v_cvt_pk_bf16_f32 v110, v60, v61
  v_exp_f32 v63, v63
  v_add_f32 v10, v10, v62
  v_add_f32 v11, v11, v63
  v_cvt_pk_bf16_f32 v111, v62, v63
  s_nop 1
  v_mfma_f32_32x32x16_bf16 a[64:79], a[224:227], v[104:107], a[64:79]
  v_mfma_f32_32x32x16_bf16 a[80:95], a[228:231], v[104:107], a[80:95]
  v_mfma_f32_32x32x16_bf16 a[96:111], a[232:235], v[104:107], a[96:111]
  v_mfma_f32_32x32x16_bf16 a[112:127], a[236:239], v[104:107], a[112:127]
  v_mfma_f32_32x32x16_bf16 a[64:79], a[240:243], v[108:111], a[64:79]
  v_mfma_f32_32x32x16_bf16 a[80:95], a[244:247], v[108:111], a[80:95]
  v_mfma_f32_32x32x16_bf16 a[96:111], a[248:251], v[108:111], a[96:111]
  v_mfma_f32_32x32x16_bf16 a[112:127], a[252:255], v[108:111], a[112:127]
  v_add_f32 v8, v8, v9
  v_mov_b32 v9, v8
  s_nop 1
  v_permlane32_swap_b32 v8, v9
  s_nop 1
  v_add_f32 v8, v8, v9
  v_add_f32 v10, v10, v11
  v_mov_b32 v11, v10
  s_nop 1
  v_permlane32_swap_b32 v10, v11
  s_nop 1
  v_add_f32 v10, v10, v11
  v_subrev_u32 v12, 0x2f800000, v8
  v_subrev_u32 v13, 0x2f800000, v10
  v_max_u32 v12, v12, v13
  v_cmp_le_u32 vcc, 0x28000000, v12
  s_nop 1
  s_cmp_lg_u64 vcc, 0
  s_cselect_b32 s26, 1, 0
  v_mov_b32 v12, s26
  s_lshl_b32 s26, s16, 2
  s_add_u32 s26, s26, 131072
  v_mov_b32 v13, s26
  ds_write_b32 v13, v12
  v_mov_b32 v14, 131072
  s_waitcnt vmcnt(0) lgkmcnt(0)
  s_barrier
  ds_read_b128 v[16:19], v14
  v_rcp_f32 v8, v8
  v_rcp_f32 v10, v10
  s_waitcnt lgkmcnt(0)
  v_or3_b32 v12, v16, v17, v18
  v_or_b32 v12, v12, v19
  s_nop 0
  v_readfirstlane_b32 s26, v12
  s_nop 1
  s_cmp_gt_u32 s26, s29
  s_cbranch_scc1 A_slow_208
  s_add_u32 s28, s25, 100663296
  v_accvgpr_read_b32 v112, a0
  v_accvgpr_read_b32 v113, a1
  v_accvgpr_read_b32 v114, a2
  v_accvgpr_read_b32 v115, a3
  v_accvgpr_read_b32 v116, a4
  v_accvgpr_read_b32 v117, a5
  v_accvgpr_read_b32 v118, a6
  v_accvgpr_read_b32 v119, a7
  v_pk_mul_f32 v[112:113], v[112:113], v[8:9] op_sel_hi:[1,0]
  v_pk_mul_f32 v[114:115], v[114:115], v[8:9] op_sel_hi:[1,0]
  v_pk_mul_f32 v[116:117], v[116:117], v[8:9] op_sel_hi:[1,0]
  v_pk_mul_f32 v[118:119], v[118:119], v[8:9] op_sel_hi:[1,0]
  v_cvt_pk_bf16_f32 v120, v112, v113
  v_cvt_pk_bf16_f32 v121, v114, v115
  v_cvt_pk_bf16_f32 v122, v116, v117
  v_cvt_pk_bf16_f32 v123, v118, v119
  buffer_store_dwordx4 v[120:123], v2, s[4:7], s28 offen offset:0 sc1
  v_accvgpr_read_b32 v124, a8
  v_accvgpr_read_b32 v125, a9
  v_accvgpr_read_b32 v126, a10
  v_accvgpr_read_b32 v127, a11
  v_accvgpr_read_b32 v128, a12
  v_accvgpr_read_b32 v129, a13
  v_accvgpr_read_b32 v130, a14
  v_accvgpr_read_b32 v131, a15
  v_pk_mul_f32 v[124:125], v[124:125], v[8:9] op_sel_hi:[1,0]
  v_pk_mul_f32 v[126:127], v[126:127], v[8:9] op_sel_hi:[1,0]
  v_pk_mul_f32 v[128:129], v[128:129], v[8:9] op_sel_hi:[1,0]
  v_pk_mul_f32 v[130:131], v[130:131], v[8:9] op_sel_hi:[1,0]
  v_cvt_pk_bf16_f32 v132, v124, v125
  v_cvt_pk_bf16_f32 v133, v126, v127
  v_cvt_pk_bf16_f32 v134, v128, v129
  v_cvt_pk_bf16_f32 v135, v130, v131
  buffer_store_dwordx4 v[132:135], v2, s[4:7], s28 offen offset:1024 sc1
  v_accvgpr_read_b32 v136, a16
  v_accvgpr_read_b32 v137, a17
  v_accvgpr_read_b32 v138, a18
  v_accvgpr_read_b32 v139, a19
  v_accvgpr_read_b32 v140, a20
  v_accvgpr_read_b32 v141, a21
  v_accvgpr_read_b32 v142, a22
  v_accvgpr_read_b32 v143, a23
  v_pk_mul_f32 v[136:137], v[136:137], v[8:9] op_sel_hi:[1,0]
  v_pk_mul_f32 v[138:139], v[138:139], v[8:9] op_sel_hi:[1,0]
  v_pk_mul_f32 v[140:141], v[140:141], v[8:9] op_sel_hi:[1,0]
  v_pk_mul_f32 v[142:143], v[142:143], v[8:9] op_sel_hi:[1,0]
  v_cvt_pk_bf16_f32 v144, v136, v137
  v_cvt_pk_bf16_f32 v145, v138, v139
  v_cvt_pk_bf16_f32 v146, v140, v141
  v_cvt_pk_bf16_f32 v147, v142, v143
  buffer_store_dwordx4 v[144:147], v2, s[4:7], s28 offen offset:2048 sc1
  v_accvgpr_read_b32 v148, a24
  v_accvgpr_read_b32 v149, a25
  v_accvgpr_read_b32 v150, a26
  v_accvgpr_read_b32 v151, a27
  v_accvgpr_read_b32 v152, a28
  v_accvgpr_read_b32 v153, a29
  v_accvgpr_read_b32 v154, a30
  v_accvgpr_read_b32 v155, a31
  v_pk_mul_f32 v[148:149], v[148:149], v[8:9] op_sel_hi:[1,0]
  v_pk_mul_f32 v[150:151], v[150:151], v[8:9] op_sel_hi:[1,0]
  v_pk_mul_f32 v[152:153], v[152:153], v[8:9] op_sel_hi:[1,0]
  v_pk_mul_f32 v[154:155], v[154:155], v[8:9] op_sel_hi:[1,0]
  v_cvt_pk_bf16_f32 v156, v148, v149
  v_cvt_pk_bf16_f32 v157, v150, v151
  v_cvt_pk_bf16_f32 v158, v152, v153
  v_cvt_pk_bf16_f32 v159, v154, v155
  buffer_store_dwordx4 v[156:159], v2, s[4:7], s28 offen offset:3072 sc1
  s_add_u32 s28, s25, 100667392
  v_accvgpr_read_b32 v112, a32
  v_accvgpr_read_b32 v113, a33
  v_accvgpr_read_b32 v114, a34
  v_accvgpr_read_b32 v115, a35
  v_accvgpr_read_b32 v116, a36
  v_accvgpr_read_b32 v117, a37
  v_accvgpr_read_b32 v118, a38
  v_accvgpr_read_b32 v119, a39
  v_pk_mul_f32 v[112:113], v[112:113], v[8:9] op_sel_hi:[1,0]
  v_pk_mul_f32 v[114:115], v[114:115], v[8:9] op_sel_hi:[1,0]
  v_pk_mul_f32 v[116:117], v[116:117], v[8:9] op_sel_hi:[1,0]
  v_pk_mul_f32 v[118:119], v[118:119], v[8:9] op_sel_hi:[1,0]
  v_cvt_pk_bf16_f32 v120, v112, v113
  v_cvt_pk_bf16_f32 v121, v114, v115
  v_cvt_pk_bf16_f32 v122, v116, v117
  v_cvt_pk_bf16_f32 v123, v118, v119
  buffer_store_dwordx4 v[120:123], v2, s[4:7], s28 offen offset:0 sc1
  v_accvgpr_read_b32 v124, a40
  v_accvgpr_read_b32 v125, a41
  v_accvgpr_read_b32 v126, a42
  v_accvgpr_read_b32 v127, a43
  v_accvgpr_read_b32 v128, a44
  v_accvgpr_read_b32 v129, a45
  v_accvgpr_read_b32 v130, a46
  v_accvgpr_read_b32 v131, a47
  v_pk_mul_f32 v[124:125], v[124:125], v[8:9] op_sel_hi:[1,0]
  v_pk_mul_f32 v[126:127], v[126:127], v[8:9] op_sel_hi:[1,0]
  v_pk_mul_f32 v[128:129], v[128:129], v[8:9] op_sel_hi:[1,0]
  v_pk_mul_f32 v[130:131], v[130:131], v[8:9] op_sel_hi:[1,0]
  v_cvt_pk_bf16_f32 v132, v124, v125
  v_cvt_pk_bf16_f32 v133, v126, v127
  v_cvt_pk_bf16_f32 v134, v128, v129
  v_cvt_pk_bf16_f32 v135, v130, v131
  buffer_store_dwordx4 v[132:135], v2, s[4:7], s28 offen offset:1024 sc1
  v_accvgpr_read_b32 v136, a48
  v_accvgpr_read_b32 v137, a49
  v_accvgpr_read_b32 v138, a50
  v_accvgpr_read_b32 v139, a51
  v_accvgpr_read_b32 v140, a52
  v_accvgpr_read_b32 v141, a53
  v_accvgpr_read_b32 v142, a54
  v_accvgpr_read_b32 v143, a55
  v_pk_mul_f32 v[136:137], v[136:137], v[8:9] op_sel_hi:[1,0]
  v_pk_mul_f32 v[138:139], v[138:139], v[8:9] op_sel_hi:[1,0]
  v_pk_mul_f32 v[140:141], v[140:141], v[8:9] op_sel_hi:[1,0]
  v_pk_mul_f32 v[142:143], v[142:143], v[8:9] op_sel_hi:[1,0]
  v_cvt_pk_bf16_f32 v144, v136, v137
  v_cvt_pk_bf16_f32 v145, v138, v139
  v_cvt_pk_bf16_f32 v146, v140, v141
  v_cvt_pk_bf16_f32 v147, v142, v143
  buffer_store_dwordx4 v[144:147], v2, s[4:7], s28 offen offset:2048 sc1
  v_accvgpr_read_b32 v148, a56
  v_accvgpr_read_b32 v149, a57
  v_accvgpr_read_b32 v150, a58
  v_accvgpr_read_b32 v151, a59
  v_accvgpr_read_b32 v152, a60
  v_accvgpr_read_b32 v153, a61
  v_accvgpr_read_b32 v154, a62
  v_accvgpr_read_b32 v155, a63
  v_pk_mul_f32 v[148:149], v[148:149], v[8:9] op_sel_hi:[1,0]
  v_pk_mul_f32 v[150:151], v[150:151], v[8:9] op_sel_hi:[1,0]
  v_pk_mul_f32 v[152:153], v[152:153], v[8:9] op_sel_hi:[1,0]
  v_pk_mul_f32 v[154:155], v[154:155], v[8:9] op_sel_hi:[1,0]
  v_cvt_pk_bf16_f32 v156, v148, v149
  v_cvt_pk_bf16_f32 v157, v150, v151
  v_cvt_pk_bf16_f32 v158, v152, v153
  v_cvt_pk_bf16_f32 v159, v154, v155
  buffer_store_dwordx4 v[156:159], v2, s[4:7], s28 offen offset:3072 sc1
  s_add_u32 s28, s25, 100671488
  v_accvgpr_read_b32 v112, a64
  v_accvgpr_read_b32 v113, a65
  v_accvgpr_read_b32 v114, a66
  v_accvgpr_read_b32 v115, a67
  v_accvgpr_read_b32 v116, a68
  v_accvgpr_read_b32 v117, a69
  v_accvgpr_read_b32 v118, a70
  v_accvgpr_read_b32 v119, a71
  v_pk_mul_f32 v[112:113], v[112:113], v[10:11] op_sel_hi:[1,0]
  v_pk_mul_f32 v[114:115], v[114:115], v[10:11] op_sel_hi:[1,0]
  v_pk_mul_f32 v[116:117], v[116:117], v[10:11] op_sel_hi:[1,0]
  v_pk_mul_f32 v[118:119], v[118:119], v[10:11] op_sel_hi:[1,0]
  v_cvt_pk_bf16_f32 v120, v112, v113
  v_cvt_pk_bf16_f32 v121, v114, v115
  v_cvt_pk_bf16_f32 v122, v116, v117
  v_cvt_pk_bf16_f32 v123, v118, v119
  buffer_store_dwordx4 v[120:123], v2, s[4:7], s28 offen offset:0 sc1
  v_accvgpr_read_b32 v124, a72
  v_accvgpr_read_b32 v125, a73
  v_accvgpr_read_b32 v126, a74
  v_accvgpr_read_b32 v127, a75
  v_accvgpr_read_b32 v128, a76
  v_accvgpr_read_b32 v129, a77
  v_accvgpr_read_b32 v130, a78
  v_accvgpr_read_b32 v131, a79
  v_pk_mul_f32 v[124:125], v[124:125], v[10:11] op_sel_hi:[1,0]
  v_pk_mul_f32 v[126:127], v[126:127], v[10:11] op_sel_hi:[1,0]
  v_pk_mul_f32 v[128:129], v[128:129], v[10:11] op_sel_hi:[1,0]
  v_pk_mul_f32 v[130:131], v[130:131], v[10:11] op_sel_hi:[1,0]
  v_cvt_pk_bf16_f32 v132, v124, v125
  v_cvt_pk_bf16_f32 v133, v126, v127
  v_cvt_pk_bf16_f32 v134, v128, v129
  v_cvt_pk_bf16_f32 v135, v130, v131
  buffer_store_dwordx4 v[132:135], v2, s[4:7], s28 offen offset:1024 sc1
  v_accvgpr_read_b32 v136, a80
  v_accvgpr_read_b32 v137, a81
  v_accvgpr_read_b32 v138, a82
  v_accvgpr_read_b32 v139, a83
  v_accvgpr_read_b32 v140, a84
  v_accvgpr_read_b32 v141, a85
  v_accvgpr_read_b32 v142, a86
  v_accvgpr_read_b32 v143, a87
  v_pk_mul_f32 v[136:137], v[136:137], v[10:11] op_sel_hi:[1,0]
  v_pk_mul_f32 v[138:139], v[138:139], v[10:11] op_sel_hi:[1,0]
  v_pk_mul_f32 v[140:141], v[140:141], v[10:11] op_sel_hi:[1,0]
  v_pk_mul_f32 v[142:143], v[142:143], v[10:11] op_sel_hi:[1,0]
  v_cvt_pk_bf16_f32 v144, v136, v137
  v_cvt_pk_bf16_f32 v145, v138, v139
  v_cvt_pk_bf16_f32 v146, v140, v141
  v_cvt_pk_bf16_f32 v147, v142, v143
  buffer_store_dwordx4 v[144:147], v2, s[4:7], s28 offen offset:2048 sc1
  v_accvgpr_read_b32 v148, a88
  v_accvgpr_read_b32 v149, a89
  v_accvgpr_read_b32 v150, a90
  v_accvgpr_read_b32 v151, a91
  v_accvgpr_read_b32 v152, a92
  v_accvgpr_read_b32 v153, a93
  v_accvgpr_read_b32 v154, a94
  v_accvgpr_read_b32 v155, a95
  v_pk_mul_f32 v[148:149], v[148:149], v[10:11] op_sel_hi:[1,0]
  v_pk_mul_f32 v[150:151], v[150:151], v[10:11] op_sel_hi:[1,0]
  v_pk_mul_f32 v[152:153], v[152:153], v[10:11] op_sel_hi:[1,0]
  v_pk_mul_f32 v[154:155], v[154:155], v[10:11] op_sel_hi:[1,0]
  v_cvt_pk_bf16_f32 v156, v148, v149
  v_cvt_pk_bf16_f32 v157, v150, v151
  v_cvt_pk_bf16_f32 v158, v152, v153
  v_cvt_pk_bf16_f32 v159, v154, v155
  buffer_store_dwordx4 v[156:159], v2, s[4:7], s28 offen offset:3072 sc1
  s_add_u32 s28, s25, 100675584
  v_accvgpr_read_b32 v112, a96
  v_accvgpr_read_b32 v113, a97
  v_accvgpr_read_b32 v114, a98
  v_accvgpr_read_b32 v115, a99
  v_accvgpr_read_b32 v116, a100
  v_accvgpr_read_b32 v117, a101
  v_accvgpr_read_b32 v118, a102
  v_accvgpr_read_b32 v119, a103
  v_pk_mul_f32 v[112:113], v[112:113], v[10:11] op_sel_hi:[1,0]
  v_pk_mul_f32 v[114:115], v[114:115], v[10:11] op_sel_hi:[1,0]
  v_pk_mul_f32 v[116:117], v[116:117], v[10:11] op_sel_hi:[1,0]
  v_pk_mul_f32 v[118:119], v[118:119], v[10:11] op_sel_hi:[1,0]
  v_cvt_pk_bf16_f32 v120, v112, v113
  v_cvt_pk_bf16_f32 v121, v114, v115
  v_cvt_pk_bf16_f32 v122, v116, v117
  v_cvt_pk_bf16_f32 v123, v118, v119
  buffer_store_dwordx4 v[120:123], v2, s[4:7], s28 offen offset:0 sc1
  v_accvgpr_read_b32 v124, a104
  v_accvgpr_read_b32 v125, a105
  v_accvgpr_read_b32 v126, a106
  v_accvgpr_read_b32 v127, a107
  v_accvgpr_read_b32 v128, a108
  v_accvgpr_read_b32 v129, a109
  v_accvgpr_read_b32 v130, a110
  v_accvgpr_read_b32 v131, a111
  v_pk_mul_f32 v[124:125], v[124:125], v[10:11] op_sel_hi:[1,0]
  v_pk_mul_f32 v[126:127], v[126:127], v[10:11] op_sel_hi:[1,0]
  v_pk_mul_f32 v[128:129], v[128:129], v[10:11] op_sel_hi:[1,0]
  v_pk_mul_f32 v[130:131], v[130:131], v[10:11] op_sel_hi:[1,0]
  v_cvt_pk_bf16_f32 v132, v124, v125
  v_cvt_pk_bf16_f32 v133, v126, v127
  v_cvt_pk_bf16_f32 v134, v128, v129
  v_cvt_pk_bf16_f32 v135, v130, v131
  buffer_store_dwordx4 v[132:135], v2, s[4:7], s28 offen offset:1024 sc1
  v_accvgpr_read_b32 v136, a112
  v_accvgpr_read_b32 v137, a113
  v_accvgpr_read_b32 v138, a114
  v_accvgpr_read_b32 v139, a115
  v_accvgpr_read_b32 v140, a116
  v_accvgpr_read_b32 v141, a117
  v_accvgpr_read_b32 v142, a118
  v_accvgpr_read_b32 v143, a119
  v_pk_mul_f32 v[136:137], v[136:137], v[10:11] op_sel_hi:[1,0]
  v_pk_mul_f32 v[138:139], v[138:139], v[10:11] op_sel_hi:[1,0]
  v_pk_mul_f32 v[140:141], v[140:141], v[10:11] op_sel_hi:[1,0]
  v_pk_mul_f32 v[142:143], v[142:143], v[10:11] op_sel_hi:[1,0]
  v_cvt_pk_bf16_f32 v144, v136, v137
  v_cvt_pk_bf16_f32 v145, v138, v139
  v_cvt_pk_bf16_f32 v146, v140, v141
  v_cvt_pk_bf16_f32 v147, v142, v143
  buffer_store_dwordx4 v[144:147], v2, s[4:7], s28 offen offset:2048 sc1
  v_accvgpr_read_b32 v148, a120
  v_accvgpr_read_b32 v149, a121
  v_accvgpr_read_b32 v150, a122
  v_accvgpr_read_b32 v151, a123
  v_accvgpr_read_b32 v152, a124
  v_accvgpr_read_b32 v153, a125
  v_accvgpr_read_b32 v154, a126
  v_accvgpr_read_b32 v155, a127
  v_pk_mul_f32 v[148:149], v[148:149], v[10:11] op_sel_hi:[1,0]
  v_pk_mul_f32 v[150:151], v[150:151], v[10:11] op_sel_hi:[1,0]
  v_pk_mul_f32 v[152:153], v[152:153], v[10:11] op_sel_hi:[1,0]
  v_pk_mul_f32 v[154:155], v[154:155], v[10:11] op_sel_hi:[1,0]
  v_cvt_pk_bf16_f32 v156, v148, v149
  v_cvt_pk_bf16_f32 v157, v150, v151
  v_cvt_pk_bf16_f32 v158, v152, v153
  v_cvt_pk_bf16_f32 v159, v154, v155
  buffer_store_dwordx4 v[156:159], v2, s[4:7], s28 offen offset:3072 sc1
  s_branch A_out_205
A_kvw_206:
M_kv_209:
  s_cmp_ge_u32 s17, s36
  s_cbranch_scc1 M_kvok_210
  s_mov_b32 s76, 0
  s_mov_b32 s78, 23
  s_mov_b32 s77, 335872
  s_cmp_eq_u32 s68, 1
  s_cmov_b32 s76, 128
  s_cmov_b32 s78, 27
  s_cmov_b32 s77, 114688
  s_cmp_eq_u32 s68, 2
  s_cmov_b32 s76, 768
  s_cmov_b32 s78, 14
  s_cmov_b32 s77, 0
  s_add_u32 s76, s76, s67
  s_mov_b32 s71, 0
  s_branch M_sg_212
M_sw_211:
  s_sleep 8
  s_add_u32 s71, s71, 1
  s_cmp_gt_u32 s71, 262144
  s_cbranch_scc1 M_exit
M_sg_212:
  s_mov_b32 s79, 0
  s_atomic_or s79, s[72:73], s76 glc
  s_waitcnt lgkmcnt(0)
  s_cmp_lt_u32 s79, s78
  s_cbranch_scc1 M_sw_211
  s_add_u32 s36, s77, s19
  s_add_u32 s68, s68, 1
  s_branch M_kv_209
M_kvok_210:
  s_branch A_kvb_207
A_upd_203:
  s_cmp_eq_u32 s23, 2
  s_cbranch_scc1 A_upd2_213
  v_mov_b32 v12, s24
  v_cmp_le_i32 s[40:41], 0, v5
  v_cmp_le_i32 s[42:43], 1, v5
  v_cmp_le_i32 s[44:45], 2, v5
  v_cmp_le_i32 s[46:47], 3, v5
  v_cndmask_b32 v64, v12, v6, s[40:41]
  v_cndmask_b32 v65, v12, v6, s[42:43]
  v_cndmask_b32 v66, v12, v6, s[44:45]
  v_cndmask_b32 v67, v12, v6, s[46:47]
  v_cmp_le_i32 s[40:41], 8, v5
  v_cmp_le_i32 s[42:43], 9, v5
  v_cmp_le_i32 s[44:45], 10, v5
  v_cmp_le_i32 s[46:47], 11, v5
  v_cndmask_b32 v68, v12, v6, s[40:41]
  v_cndmask_b32 v69, v12, v6, s[42:43]
  v_cndmask_b32 v70, v12, v6, s[44:45]
  v_cndmask_b32 v71, v12, v6, s[46:47]
  v_cmp_le_i32 s[40:41], 16, v5
  v_cmp_le_i32 s[42:43], 17, v5
  v_cmp_le_i32 s[44:45], 18, v5
  v_cmp_le_i32 s[46:47], 19, v5
  v_cndmask_b32 v72, v12, v6, s[40:41]
  v_cndmask_b32 v73, v12, v6, s[42:43]
  v_cndmask_b32 v74, v12, v6, s[44:45]
  v_cndmask_b32 v75, v12, v6, s[46:47]
  v_cmp_le_i32 s[40:41], 24, v5
  v_cmp_le_i32 s[42:43], 25, v5
  v_cmp_le_i32 s[44:45], 26, v5
  v_cmp_le_i32 s[46:47], 27, v5
  v_cndmask_b32 v76, v12, v6, s[40:41]
  v_cndmask_b32 v77, v12, v6, s[42:43]
  v_cndmask_b32 v78, v12, v6, s[44:45]
  v_cndmask_b32 v79, v12, v6, s[46:47]
  v_mov_b32 v80, v7
  v_mov_b32 v81, v7
  v_mov_b32 v82, v7
  v_mov_b32 v83, v7
  v_mov_b32 v84, v7
  v_mov_b32 v85, v7
  v_mov_b32 v86, v7
  v_mov_b32 v87, v7
  v_mov_b32 v88, v7
  v_mov_b32 v89, v7
  v_mov_b32 v90, v7
  v_mov_b32 v91, v7
  v_mov_b32 v92, v7
  v_mov_b32 v93, v7
  v_mov_b32 v94, v7
  v_mov_b32 v95, v7
  s_branch A_back_204
A_upd2_213:
  v_mov_b32 v64, v6
  v_mov_b32 v65, v6
  v_mov_b32 v66, v6
  v_mov_b32 v67, v6
  v_mov_b32 v68, v6
  v_mov_b32 v69, v6
  v_mov_b32 v70, v6
  v_mov_b32 v71, v6
  v_mov_b32 v72, v6
  v_mov_b32 v73, v6
  v_mov_b32 v74, v6
  v_mov_b32 v75, v6
  v_mov_b32 v76, v6
  v_mov_b32 v77, v6
  v_mov_b32 v78, v6
  v_mov_b32 v79, v6
  s_branch A_back_204
A_slow_208:
  s_mov_b32 s29, 1
  v_mov_b32 v64, s24
  v_mov_b32 v65, s24
  v_mov_b32 v66, s24
  v_mov_b32 v67, s24
  v_mov_b32 v68, s24
  v_mov_b32 v69, s24
  v_mov_b32 v70, s24
  v_mov_b32 v71, s24
  v_mov_b32 v72, s24
  v_mov_b32 v73, s24
  v_mov_b32 v74, s24
  v_mov_b32 v75, s24
  v_mov_b32 v76, s24
  v_mov_b32 v77, s24
  v_mov_b32 v78, s24
  v_mov_b32 v79, s24
  v_mov_b32 v12, s24
  v_cmp_le_i32 s[40:41], 0, v5
  v_cmp_le_i32 s[42:43], 1, v5
  v_cmp_le_i32 s[44:45], 2, v5
  v_cmp_le_i32 s[46:47], 3, v5
  v_cndmask_b32 v80, v12, v7, s[40:41]
  v_cndmask_b32 v81, v12, v7, s[42:43]
  v_cndmask_b32 v82, v12, v7, s[44:45]
  v_cndmask_b32 v83, v12, v7, s[46:47]
  v_cmp_le_i32 s[40:41], 8, v5
  v_cmp_le_i32 s[42:43], 9, v5
  v_cmp_le_i32 s[44:45], 10, v5
  v_cmp_le_i32 s[46:47], 11, v5
  v_cndmask_b32 v84, v12, v7, s[40:41]
  v_cndmask_b32 v85, v12, v7, s[42:43]
  v_cndmask_b32 v86, v12, v7, s[44:45]
  v_cndmask_b32 v87, v12, v7, s[46:47]
  v_cmp_le_i32 s[40:41], 16, v5
  v_cmp_le_i32 s[42:43], 17, v5
  v_cmp_le_i32 s[44:45], 18, v5
  v_cmp_le_i32 s[46:47], 19, v5
  v_cndmask_b32 v88, v12, v7, s[40:41]
  v_cndmask_b32 v89, v12, v7, s[42:43]
  v_cndmask_b32 v90, v12, v7, s[44:45]
  v_cndmask_b32 v91, v12, v7, s[46:47]
  v_cmp_le_i32 s[40:41], 24, v5
  v_cmp_le_i32 s[42:43], 25, v5
  v_cmp_le_i32 s[44:45], 26, v5
  v_cmp_le_i32 s[46:47], 27, v5
  v_cndmask_b32 v92, v12, v7, s[40:41]
  v_cndmask_b32 v93, v12, v7, s[42:43]
  v_cndmask_b32 v94, v12, v7, s[44:45]
  v_cndmask_b32 v95, v12, v7, s[46:47]
  v_mov_b32 v8, s24
  v_mov_b32 v10, s24
  s_add_u32 s17, s25, 16785408
  s_mov_b32 s23, 0
A_ml_214:
  s_add_u32 s28, s17, 4096
  buffer_load_dwordx4 a[192:195], v2, s[4:7], s17 offen offset:0 sc1
  buffer_load_dwordx4 a[196:199], v2, s[4:7], s17 offen offset:1024 sc1
  buffer_load_dwordx4 a[200:203], v2, s[4:7], s17 offen offset:2048 sc1
  buffer_load_dwordx4 a[204:207], v2, s[4:7], s17 offen offset:3072 sc1
  buffer_load_dwordx4 a[208:211], v2, s[4:7], s28 offen offset:0 sc1
  buffer_load_dwordx4 a[212:215], v2, s[4:7], s28 offen offset:1024 sc1
  buffer_load_dwordx4 a[216:219], v2, s[4:7], s28 offen offset:2048 sc1
  buffer_load_dwordx4 a[220:223], v2, s[4:7], s28 offen offset:3072 sc1
  s_waitcnt vmcnt(0)
  v_mfma_f32_32x32x16_bf16 v[32:47], a[192:195], a[128:131], v[64:79]
  v_mfma_f32_32x32x16_bf16 v[32:47], a[196:199], a[132:135], v[32:47]
  v_mfma_f32_32x32x16_bf16 v[32:47], a[200:203], a[136:139], v[32:47]
  v_mfma_f32_32x32x16_bf16 v[32:47], a[204:207], a[140:143], v[32:47]
  v_mfma_f32_32x32x16_bf16 v[32:47], a[208:211], a[144:147], v[32:47]
  v_mfma_f32_32x32x16_bf16 v[32:47], a[212:215], a[148:151], v[32:47]
  v_mfma_f32_32x32x16_bf16 v[32:47], a[216:219], a[152:155], v[32:47]
  v_mfma_f32_32x32x16_bf16 v[32:47], a[220:223], a[156:159], v[32:47]
  v_mfma_f32_32x32x16_bf16 v[48:63], a[192:195], a[160:163], v[80:95]
  v_mfma_f32_32x32x16_bf16 v[48:63], a[196:199], a[164:167], v[48:63]
  v_mfma_f32_32x32x16_bf16 v[48:63], a[200:203], a[168:171], v[48:63]
  v_mfma_f32_32x32x16_bf16 v[48:63], a[204:207], a[172:175], v[48:63]
  v_mfma_f32_32x32x16_bf16 v[48:63], a[208:211], a[176:179], v[48:63]
  v_mfma_f32_32x32x16_bf16 v[48:63], a[212:215], a[180:183], v[48:63]
  v_mfma_f32_32x32x16_bf16 v[48:63], a[216:219], a[184:187], v[48:63]
  v_mfma_f32_32x32x16_bf16 v[48:63], a[220:223], a[188:191], v[48:63]
  s_nop 7
  s_nop 3
  v_max3_f32 v8, v8, v32, v33
  v_max3_f32 v8, v8, v34, v35
  v_max3_f32 v8, v8, v36, v37
  v_max3_f32 v8, v8, v38, v39
  v_max3_f32 v8, v8, v40, v41
  v_max3_f32 v8, v8, v42, v43
  v_max3_f32 v8, v8, v44, v45
  v_max3_f32 v8, v8, v46, v47
  v_max3_f32 v10, v10, v48, v49
  v_max3_f32 v10, v10, v50, v51
  v_max3_f32 v10, v10, v52, v53
  v_max3_f32 v10, v10, v54, v55
  v_max3_f32 v10, v10, v56, v57
  v_max3_f32 v10, v10, v58, v59
  v_max3_f32 v10, v10, v60, v61
  v_max3_f32 v10, v10, v62, v63
  s_add_u32 s23, s23, 1
  s_cmp_lg_u32 s23, 1
  s_cbranch_scc1 A_m2_215
  v_mov_b32 v12, s24
  v_cmp_le_i32 s[40:41], 0, v5
  v_cmp_le_i32 s[42:43], 1, v5
  v_cmp_le_i32 s[44:45], 2, v5
  v_cmp_le_i32 s[46:47], 3, v5
  v_cndmask_b32 v64, v12, v6, s[40:41]
  v_cndmask_b32 v65, v12, v6, s[42:43]
  v_cndmask_b32 v66, v12, v6, s[44:45]
  v_cndmask_b32 v67, v12, v6, s[46:47]
  v_cmp_le_i32 s[40:41], 8, v5
  v_cmp_le_i32 s[42:43], 9, v5
  v_cmp_le_i32 s[44:45], 10, v5
  v_cmp_le_i32 s[46:47], 11, v5
  v_cndmask_b32 v68, v12, v6, s[40:41]
  v_cndmask_b32 v69, v12, v6, s[42:43]
  v_cndmask_b32 v70, v12, v6, s[44:45]
  v_cndmask_b32 v71, v12, v6, s[46:47]
  v_cmp_le_i32 s[40:41], 16, v5
  v_cmp_le_i32 s[42:43], 17, v5
  v_cmp_le_i32 s[44:45], 18, v5
  v_cmp_le_i32 s[46:47], 19, v5
  v_cndmask_b32 v72, v12, v6, s[40:41]
  v_cndmask_b32 v73, v12, v6, s[42:43]
  v_cndmask_b32 v74, v12, v6, s[44:45]
  v_cndmask_b32 v75, v12, v6, s[46:47]
  v_cmp_le_i32 s[40:41], 24, v5
  v_cmp_le_i32 s[42:43], 25, v5
  v_cmp_le_i32 s[44:45], 26, v5
  v_cmp_le_i32 s[46:47], 27, v5
  v_cndmask_b32 v76, v12, v6, s[40:41]
  v_cndmask_b32 v77, v12, v6, s[42:43]
  v_cndmask_b32 v78, v12, v6, s[44:45]
  v_cndmask_b32 v79, v12, v6, s[46:47]
  v_mov_b32 v80, v7
  v_mov_b32 v81, v7
  v_mov_b32 v82, v7
  v_mov_b32 v83, v7
  v_mov_b32 v84, v7
  v_mov_b32 v85, v7
  v_mov_b32 v86, v7
  v_mov_b32 v87, v7
  v_mov_b32 v88, v7
  v_mov_b32 v89, v7
  v_mov_b32 v90, v7
  v_mov_b32 v91, v7
  v_mov_b32 v92, v7
  v_mov_b32 v93, v7
  v_mov_b32 v94, v7
  v_mov_b32 v95, v7
A_m2_215:
  s_cmp_lg_u32 s23, 2
  s_cbranch_scc1 A_m3_216
  v_mov_b32 v64, v6
  v_mov_b32 v65, v6
  v_mov_b32 v66, v6
  v_mov_b32 v67, v6
  v_mov_b32 v68, v6
  v_mov_b32 v69, v6
  v_mov_b32 v70, v6
  v_mov_b32 v71, v6
  v_mov_b32 v72, v6
  v_mov_b32 v73, v6
  v_mov_b32 v74, v6
  v_mov_b32 v75, v6
  v_mov_b32 v76, v6
  v_mov_b32 v77, v6
  v_mov_b32 v78, v6
  v_mov_b32 v79, v6
A_m3_216:
  s_sub_u32 s17, s17, 8192
  s_cmp_ge_i32 s17, s19
  s_cbranch_scc1 A_ml_214
  v_mov_b32 v9, v8
  s_nop 1
  v_permlane32_swap_b32 v8, v9
  s_nop 1
  v_max_f32 v8, v8, v9
  v_sub_f32 v6, 0, v8
  v_mov_b32 v11, v10
  s_nop 1
  v_permlane32_swap_b32 v10, v11
  s_nop 1
  v_max_f32 v10, v10, v11
  v_sub_f32 v7, 0, v10
  s_branch A_again_195
A_out_205:
  s_mov_b32 s69, s55
  s_mov_b32 s70, s56
  s_sub_u32 s52, s52, 1
  s_cmp_lg_u32 s52, 0
  s_cbranch_scc1 M_att
  s_waitcnt vmcnt(0)
  s_barrier
  s_mov_b32 s30, 512
  v_mov_b32 v144, s30
  v_min_u32 v145, 1, v0
  v_lshlrev_b32 v145, 30, v145
  buffer_store_dword v144, v145, s[4:7], s31 offen sc1
  s_lshr_b32 s48, s64, 2
  s_bfe_u32 s49, s64, 0x10001
  s_and_b32 s50, s64, 1
  s_mul_i32 s50, s50, 6
  s_add_u32 s50, s50, s65
  s_mov_b32 s51, 12
  s_cmp_lt_u32 s50, 4
  s_cselect_b32 s23, 6, 5
  s_load_dwordx2 s[8:9], s[0:1], 40
  s_lshl_b32 s17, s48, 19
  s_lshl_b32 s26, s49, 2
  s_add_u32 s26, s26, s16
  s_lshl_b32 s27, s26, 7
  s_add_u32 s17, s17, s27
  s_mov_b32 s18, 1024
  s_lshl_b32 s21, s48, 6
  s_add_u32 s21, s21, s50
  s_lshl_b32 s21, s21, 3
  s_add_u32 s21, s21, s26
  s_lshl_b32 s21, s21, 12
  s_add_u32 s21, s21, 150994944
  s_lshl_b32 s22, s51, 15
  s_mov_b32 s24, 1.0
  s_waitcnt lgkmcnt(0)
  s_and_b32 s9, s9, 0xffff
  s_mov_b32 s10, 4194304
  s_mov_b32 s11, 0x20000
  s_mov_b32 s12, s4
  s_mov_b32 s13, s5
  s_mov_b32 s14, 268435456
  s_mov_b32 s15, 0x20000
  s_lshl_b32 s19, s48, 8
  s_add_u32 s19, s19, s50
  s_lshl_b32 s19, s19, 13
  s_add_u32 s19, s19, 100663296
  s_lshl_b32 s20, s51, 13
  v_lshrrev_b32 v144, 4, v1
  v_and_b32 v56, 0xff, v2
  v_lshl_add_u32 v56, v144, 9, v56
  s_mul_i32 s26, s16, 524288
  v_add_u32 v8, 0, v56
  v_add_u32 v16, 0, v2
  v_add_u32 v16, s26, v16
  v_add_u32 v9, 256, v56
  v_add_u32 v17, 1024, v2
  v_add_u32 v17, s26, v17
  v_add_u32 v10, 2048, v56
  v_add_u32 v18, 2048, v2
  v_add_u32 v18, s26, v18
  v_add_u32 v11, 2304, v56
  v_add_u32 v19, 3072, v2
  v_add_u32 v19, s26, v19
  v_add_u32 v12, 4096, v56
  v_add_u32 v20, 4096, v2
  v_add_u32 v20, s26, v20
  v_add_u32 v13, 4352, v56
  v_add_u32 v21, 5120, v2
  v_add_u32 v21, s26, v21
  v_add_u32 v14, 6144, v56
  v_add_u32 v22, 6144, v2
  v_add_u32 v22, s26, v22
  v_add_u32 v15, 6400, v56
  v_add_u32 v23, 7168, v2
  v_add_u32 v23, s26, v23
  v_lshrrev_b32 v144, 3, v1
  v_mul_lo_u32 v144, v144, s18
  v_and_b32 v145, 7, v1
  v_lshl_add_u32 v144, v145, 4, v144
  s_lshl_b32 s28, s16, 15
  s_add_u32 s28, s28, 32768
  s_lshl_b32 s29, s18, 3
  s_add_u32 m0, s28, 0
  s_nop 0
  buffer_load_dwordx4 v144, s[8:11], s17 offen lds
  s_add_u32 s17, s17, s29
  s_add_u32 m0, s28, 1024
  s_nop 0
  buffer_load_dwordx4 v144, s[8:11], s17 offen lds
  s_add_u32 s17, s17, s29
  s_add_u32 m0, s28, 2048
  s_nop 0
  buffer_load_dwordx4 v144, s[8:11], s17 offen lds
  s_add_u32 s17, s17, s29
  s_add_u32 m0, s28, 3072
  s_nop 0
  buffer_load_dwordx4 v144, s[8:11], s17 offen lds
  s_add_u32 s17, s17, s29
  s_add_u32 m0, s28, 4096
  s_nop 0
  buffer_load_dwordx4 v144, s[8:11], s17 offen lds
  s_add_u32 s17, s17, s29
  s_add_u32 m0, s28, 5120
  s_nop 0
  buffer_load_dwordx4 v144, s[8:11], s17 offen lds
  s_add_u32 s17, s17, s29
  s_add_u32 m0, s28, 6144
  s_nop 0
  buffer_load_dwordx4 v144, s[8:11], s17 offen lds
  s_add_u32 s17, s17, s29
  s_add_u32 m0, s28, 7168
  s_nop 0
  buffer_load_dwordx4 v144, s[8:11], s17 offen lds
  s_add_u32 s17, s17, s29
  s_add_u32 m0, s28, 8192
  s_nop 0
  buffer_load_dwordx4 v144, s[8:11], s17 offen lds
  s_add_u32 s17, s17, s29
  s_add_u32 m0, s28, 9216
  s_nop 0
  buffer_load_dwordx4 v144, s[8:11], s17 offen lds
  s_add_u32 s17, s17, s29
  s_add_u32 m0, s28, 10240
  s_nop 0
  buffer_load_dwordx4 v144, s[8:11], s17 offen lds
  s_add_u32 s17, s17, s29
  s_add_u32 m0, s28, 11264
  s_nop 0
  buffer_load_dwordx4 v144, s[8:11], s17 offen lds
  s_add_u32 s17, s17, s29
  s_add_u32 m0, s28, 12288
  s_nop 0
  buffer_load_dwordx4 v144, s[8:11], s17 offen lds
  s_add_u32 s17, s17, s29
  s_add_u32 m0, s28, 13312
  s_nop 0
  buffer_load_dwordx4 v144, s[8:11], s17 offen lds
  s_add_u32 s17, s17, s29
  s_add_u32 m0, s28, 14336
  s_nop 0
  buffer_load_dwordx4 v144, s[8:11], s17 offen lds
  s_add_u32 s17, s17, s29
  s_add_u32 m0, s28, 15360
  s_nop 0
  buffer_load_dwordx4 v144, s[8:11], s17 offen lds
  s_add_u32 s17, s17, s29
  s_add_u32 m0, s28, 16384
  s_nop 0
  buffer_load_dwordx4 v144, s[8:11], s17 offen lds
  s_add_u32 s17, s17, s29
  s_add_u32 m0, s28, 17408
  s_nop 0
  buffer_load_dwordx4 v144, s[8:11], s17 offen lds
  s_add_u32 s17, s17, s29
  s_add_u32 m0, s28, 18432
  s_nop 0
  buffer_load_dwordx4 v144, s[8:11], s17 offen lds
  s_add_u32 s17, s17, s29
  s_add_u32 m0, s28, 19456
  s_nop 0
  buffer_load_dwordx4 v144, s[8:11], s17 offen lds
  s_add_u32 s17, s17, s29
  s_add_u32 m0, s28, 20480
  s_nop 0
  buffer_load_dwordx4 v144, s[8:11], s17 offen lds
  s_add_u32 s17, s17, s29
  s_add_u32 m0, s28, 21504
  s_nop 0
  buffer_load_dwordx4 v144, s[8:11], s17 offen lds
  s_add_u32 s17, s17, s29
  s_add_u32 m0, s28, 22528
  s_nop 0
  buffer_load_dwordx4 v144, s[8:11], s17 offen lds
  s_add_u32 s17, s17, s29
  s_add_u32 m0, s28, 23552
  s_nop 0
  buffer_load_dwordx4 v144, s[8:11], s17 offen lds
  s_add_u32 s17, s17, s29
  s_add_u32 m0, s28, 24576
  s_nop 0
  buffer_load_dwordx4 v144, s[8:11], s17 offen lds
  s_add_u32 s17, s17, s29
  s_add_u32 m0, s28, 25600
  s_nop 0
  buffer_load_dwordx4 v144, s[8:11], s17 offen lds
  s_add_u32 s17, s17, s29
  s_add_u32 m0, s28, 26624
  s_nop 0
  buffer_load_dwordx4 v144, s[8:11], s17 offen lds
  s_add_u32 s17, s17, s29
  s_add_u32 m0, s28, 27648
  s_nop 0
  buffer_load_dwordx4 v144, s[8:11], s17 offen lds
  s_add_u32 s17, s17, s29
  s_add_u32 m0, s28, 28672
  s_nop 0
  buffer_load_dwordx4 v144, s[8:11], s17 offen lds
  s_add_u32 s17, s17, s29
  s_add_u32 m0, s28, 29696
  s_nop 0
  buffer_load_dwordx4 v144, s[8:11], s17 offen lds
  s_add_u32 s17, s17, s29
  s_add_u32 m0, s28, 30720
  s_nop 0
  buffer_load_dwordx4 v144, s[8:11], s17 offen lds
  s_add_u32 s17, s17, s29
  s_add_u32 m0, s28, 31744
  s_nop 0
  buffer_load_dwordx4 v144, s[8:11], s17 offen lds
  s_add_u32 s17, s17, s29
  v_bfe_u32 v148, v1, 2, 2
  v_lshrrev_b32 v149, 5, v1
  v_lshl_add_u32 v148, v149, 4, v148
  v_bfe_u32 v149, v1, 4, 1
  v_lshl_add_u32 v148, v149, 2, v148
  v_and_b32 v149, 3, v1
  v_lshlrev_b32 v149, 4, v149
  s_mov_b32 s26, 8
  v_lshl_add_u32 v148, v148, 7, v149
  v_add_u32 v152, s28, v148
  v_add_u32 v153, 1024, v152
  v_add_u32 v154, s26, v152
  v_add_u32 v155, s26, v153
  s_waitcnt vmcnt(28)
  ds_read_b64_tr_b16 a[0:1], v152 offset:0
  ds_read_b64_tr_b16 a[2:3], v153 offset:0
  ds_read_b64_tr_b16 a[4:5], v154 offset:0
  ds_read_b64_tr_b16 a[6:7], v155 offset:0
  ds_read_b64_tr_b16 a[8:9], v152 offset:64
  ds_read_b64_tr_b16 a[10:11], v153 offset:64
  ds_read_b64_tr_b16 a[12:13], v154 offset:64
  ds_read_b64_tr_b16 a[14:15], v155 offset:64
  s_waitcnt lgkmcnt(0)
  s_add_u32 m0, s28, 0
  s_nop 0
  buffer_load_dwordx4 v144, s[8:11], s17 offen lds
  s_add_u32 s17, s17, s29
  s_add_u32 m0, s28, 1024
  s_nop 0
  buffer_load_dwordx4 v144, s[8:11], s17 offen lds
  s_add_u32 s17, s17, s29
  s_add_u32 m0, s28, 2048
  s_nop 0
  buffer_load_dwordx4 v144, s[8:11], s17 offen lds
  s_add_u32 s17, s17, s29
  s_add_u32 m0, s28, 3072
  s_nop 0
  buffer_load_dwordx4 v144, s[8:11], s17 offen lds
  s_add_u32 s17, s17, s29
  s_waitcnt vmcnt(28)
  ds_read_b64_tr_b16 a[16:17], v152 offset:4096
  ds_read_b64_tr_b16 a[18:19], v153 offset:4096
  ds_read_b64_tr_b16 a[20:21], v154 offset:4096
  ds_read_b64_tr_b16 a[22:23], v155 offset:4096
  ds_read_b64_tr_b16 a[24:25], v152 offset:4160
  ds_read_b64_tr_b16 a[26:27], v153 offset:4160
  ds_read_b64_tr_b16 a[28:29], v154 offset:4160
  ds_read_b64_tr_b16 a[30:31], v155 offset:4160
  s_waitcnt lgkmcnt(0)
  s_add_u32 m0, s28, 4096
  s_nop 0
  buffer_load_dwordx4 v144, s[8:11], s17 offen lds
  s_add_u32 s17, s17, s29
  s_add_u32 m0, s28, 5120
  s_nop 0
  buffer_load_dwordx4 v144, s[8:11], s17 offen lds
  s_add_u32 s17, s17, s29
  s_add_u32 m0, s28, 6144
  s_nop 0
  buffer_load_dwordx4 v144, s[8:11], s17 offen lds
  s_add_u32 s17, s17, s29
  s_add_u32 m0, s28, 7168
  s_nop 0
  buffer_load_dwordx4 v144, s[8:11], s17 offen lds
  s_add_u32 s17, s17, s29
  s_waitcnt vmcnt(28)
  ds_read_b64_tr_b16 a[32:33], v152 offset:8192
  ds_read_b64_tr_b16 a[34:35], v153 offset:8192
  ds_read_b64_tr_b16 a[36:37], v154 offset:8192
  ds_read_b64_tr_b16 a[38:39], v155 offset:8192
  ds_read_b64_tr_b16 a[40:41], v152 offset:8256
  ds_read_b64_tr_b16 a[42:43], v153 offset:8256
  ds_read_b64_tr_b16 a[44:45], v154 offset:8256
  ds_read_b64_tr_b16 a[46:47], v155 offset:8256
  s_waitcnt lgkmcnt(0)
  s_add_u32 m0, s28, 8192
  s_nop 0
  buffer_load_dwordx4 v144, s[8:11], s17 offen lds
  s_add_u32 s17, s17, s29
  s_add_u32 m0, s28, 9216
  s_nop 0
  buffer_load_dwordx4 v144, s[8:11], s17 offen lds
  s_add_u32 s17, s17, s29
  s_add_u32 m0, s28, 10240
  s_nop 0
  buffer_load_dwordx4 v144, s[8:11], s17 offen lds
  s_add_u32 s17, s17, s29
  s_add_u32 m0, s28, 11264
  s_nop 0
  buffer_load_dwordx4 v144, s[8:11], s17 offen lds
  s_add_u32 s17, s17, s29
  s_waitcnt vmcnt(28)
  ds_read_b64_tr_b16 a[48:49], v152 offset:12288
  ds_read_b64_tr_b16 a[50:51], v153 offset:12288
  ds_read_b64_tr_b16 a[52:53], v154 offset:12288
  ds_read_b64_tr_b16 a[54:55], v155 offset:12288
  ds_read_b64_tr_b16 a[56:57], v152 offset:12352
  ds_read_b64_tr_b16 a[58:59], v153 offset:12352
  ds_read_b64_tr_b16 a[60:61], v154 offset:12352
  ds_read_b64_tr_b16 a[62:63], v155 offset:12352
  s_waitcnt lgkmcnt(0)
  s_add_u32 m0, s28, 12288
  s_nop 0
  buffer_load_dwordx4 v144, s[8:11], s17 offen lds
  s_add_u32 s17, s17, s29
  s_add_u32 m0, s28, 13312
  s_nop 0
  buffer_load_dwordx4 v144, s[8:11], s17 offen lds
  s_add_u32 s17, s17, s29
  s_add_u32 m0, s28, 14336
  s_nop 0
  buffer_load_dwordx4 v144, s[8:11], s17 offen lds
  s_add_u32 s17, s17, s29
  s_add_u32 m0, s28, 15360
  s_nop 0
  buffer_load_dwordx4 v144, s[8:11], s17 offen lds
  s_add_u32 s17, s17, s29
  s_waitcnt vmcnt(28)
  ds_read_b64_tr_b16 a[64:65], v152 offset:16384
  ds_read_b64_tr_b16 a[66:67], v153 offset:16384
  ds_read_b64_tr_b16 a[68:69], v154 offset:16384
  ds_read_b64_tr_b16 a[70:71], v155 offset:16384
  ds_read_b64_tr_b16 a[72:73], v152 offset:16448
  ds_read_b64_tr_b16 a[74:75], v153 offset:16448
  ds_read_b64_tr_b16 a[76:77], v154 offset:16448
  ds_read_b64_tr_b16 a[78:79], v155 offset:16448
  s_waitcnt lgkmcnt(0)
  s_add_u32 m0, s28, 16384
  s_nop 0
  buffer_load_dwordx4 v144, s[8:11], s17 offen lds
  s_add_u32 s17, s17, s29
  s_add_u32 m0, s28, 17408
  s_nop 0
  buffer_load_dwordx4 v144, s[8:11], s17 offen lds
  s_add_u32 s17, s17, s29
  s_add_u32 m0, s28, 18432
  s_nop 0
  buffer_load_dwordx4 v144, s[8:11], s17 offen lds
  s_add_u32 s17, s17, s29
  s_add_u32 m0, s28, 19456
  s_nop 0
  buffer_load_dwordx4 v144, s[8:11], s17 offen lds
  s_add_u32 s17, s17, s29
  s_waitcnt vmcnt(28)
  ds_read_b64_tr_b16 a[80:81], v152 offset:20480
  ds_read_b64_tr_b16 a[82:83], v153 offset:20480
  ds_read_b64_tr_b16 a[84:85], v154 offset:20480
  ds_read_b64_tr_b16 a[86:87], v155 offset:20480
  ds_read_b64_tr_b16 a[88:89], v152 offset:20544
  ds_read_b64_tr_b16 a[90:91], v153 offset:20544
  ds_read_b64_tr_b16 a[92:93], v154 offset:20544
  ds_read_b64_tr_b16 a[94:95], v155 offset:20544
  s_waitcnt lgkmcnt(0)
  s_add_u32 m0, s28, 20480
  s_nop 0
  buffer_load_dwordx4 v144, s[8:11], s17 offen lds
  s_add_u32 s17, s17, s29
  s_add_u32 m0, s28, 21504
  s_nop 0
  buffer_load_dwordx4 v144, s[8:11], s17 offen lds
  s_add_u32 s17, s17, s29
  s_add_u32 m0, s28, 22528
  s_nop 0
  buffer_load_dwordx4 v144, s[8:11], s17 offen lds
  s_add_u32 s17, s17, s29
  s_add_u32 m0, s28, 23552
  s_nop 0
  buffer_load_dwordx4 v144, s[8:11], s17 offen lds
  s_add_u32 s17, s17, s29
  s_waitcnt vmcnt(28)
  ds_read_b64_tr_b16 a[96:97], v152 offset:24576
  ds_read_b64_tr_b16 a[98:99], v153 offset:24576
  ds_read_b64_tr_b16 a[100:101], v154 offset:24576
  ds_read_b64_tr_b16 a[102:103], v155 offset:24576
  ds_read_b64_tr_b16 a[104:105], v152 offset:24640
  ds_read_b64_tr_b16 a[106:107], v153 offset:24640
  ds_read_b64_tr_b16 a[108:109], v154 offset:24640
  ds_read_b64_tr_b16 a[110:111], v155 offset:24640
  s_waitcnt lgkmcnt(0)
  s_add_u32 m0, s28, 24576
  s_nop 0
  buffer_load_dwordx4 v144, s[8:11], s17 offen lds
  s_add_u32 s17, s17, s29
  s_add_u32 m0, s28, 25600
  s_nop 0
  buffer_load_dwordx4 v144, s[8:11], s17 offen lds
  s_add_u32 s17, s17, s29
  s_add_u32 m0, s28, 26624
  s_nop 0
  buffer_load_dwordx4 v144, s[8:11], s17 offen lds
  s_add_u32 s17, s17, s29
  s_add_u32 m0, s28, 27648
  s_nop 0
  buffer_load_dwordx4 v144, s[8:11], s17 offen lds
  s_add_u32 s17, s17, s29
  s_waitcnt vmcnt(28)
  ds_read_b64_tr_b16 a[112:113], v152 offset:28672
  ds_read_b64_tr_b16 a[114:115], v153 offset:28672
  ds_read_b64_tr_b16 a[116:117], v154 offset:28672
  ds_read_b64_tr_b16 a[118:119], v155 offset:28672
  ds_read_b64_tr_b16 a[120:121], v152 offset:28736
  ds_read_b64_tr_b16 a[122:123], v153 offset:28736
  ds_read_b64_tr_b16 a[124:125], v154 offset:28736
  ds_read_b64_tr_b16 a[126:127], v155 offset:28736
  s_waitcnt lgkmcnt(0)
  s_add_u32 m0, s28, 28672
  s_nop 0
  buffer_load_dwordx4 v144, s[8:11], s17 offen lds
  s_add_u32 s17, s17, s29
  s_add_u32 m0, s28, 29696
  s_nop 0
  buffer_load_dwordx4 v144, s[8:11], s17 offen lds
  s_add_u32 s17, s17, s29
  s_add_u32 m0, s28, 30720
  s_nop 0
  buffer_load_dwordx4 v144, s[8:11], s17 offen lds
  s_add_u32 s17, s17, s29
  s_add_u32 m0, s28, 31744
  s_nop 0
  buffer_load_dwordx4 v144, s[8:11], s17 offen lds
  s_add_u32 s17, s17, s29
  s_waitcnt vmcnt(28)
  ds_read_b64_tr_b16 a[128:129], v152 offset:0
  ds_read_b64_tr_b16 a[130:131], v153 offset:0
  ds_read_b64_tr_b16 a[132:133], v154 offset:0
  ds_read_b64_tr_b16 a[134:135], v155 offset:0
  ds_read_b64_tr_b16 a[136:137], v152 offset:64
  ds_read_b64_tr_b16 a[138:139], v153 offset:64
  ds_read_b64_tr_b16 a[140:141], v154 offset:64
  ds_read_b64_tr_b16 a[142:143], v155 offset:64
  s_waitcnt lgkmcnt(0)
  s_waitcnt vmcnt(24)
  ds_read_b64_tr_b16 a[144:145], v152 offset:4096
  ds_read_b64_tr_b16 a[146:147], v153 offset:4096
  ds_read_b64_tr_b16 a[148:149], v154 offset:4096
  ds_read_b64_tr_b16 a[150:151], v155 offset:4096
  ds_read_b64_tr_b16 a[152:153], v152 offset:4160
  ds_read_b64_tr_b16 a[154:155], v153 offset:4160
  ds_read_b64_tr_b16 a[156:157], v154 offset:4160
  ds_read_b64_tr_b16 a[158:159], v155 offset:4160
  s_waitcnt lgkmcnt(0)
  s_waitcnt vmcnt(20)
  ds_read_b64_tr_b16 a[160:161], v152 offset:8192
  ds_read_b64_tr_b16 a[162:163], v153 offset:8192
  ds_read_b64_tr_b16 a[164:165], v154 offset:8192
  ds_read_b64_tr_b16 a[166:167], v155 offset:8192
  ds_read_b64_tr_b16 a[168:169], v152 offset:8256
  ds_read_b64_tr_b16 a[170:171], v153 offset:8256
  ds_read_b64_tr_b16 a[172:173], v154 offset:8256
  ds_read_b64_tr_b16 a[174:175], v155 offset:8256
  s_waitcnt lgkmcnt(0)
  s_waitcnt vmcnt(16)
  ds_read_b64_tr_b16 a[176:177], v152 offset:12288
  ds_read_b64_tr_b16 a[178:179], v153 offset:12288
  ds_read_b64_tr_b16 a[180:181], v154 offset:12288
  ds_read_b64_tr_b16 a[182:183], v155 offset:12288
  ds_read_b64_tr_b16 a[184:185], v152 offset:12352
  ds_read_b64_tr_b16 a[186:187], v153 offset:12352
  ds_read_b64_tr_b16 a[188:189], v154 offset:12352
  ds_read_b64_tr_b16 a[190:191], v155 offset:12352
  s_waitcnt lgkmcnt(0)
  s_waitcnt vmcnt(12)
  ds_read_b64_tr_b16 a[192:193], v152 offset:16384
  ds_read_b64_tr_b16 a[194:195], v153 offset:16384
  ds_read_b64_tr_b16 a[196:197], v154 offset:16384
  ds_read_b64_tr_b16 a[198:199], v155 offset:16384
  ds_read_b64_tr_b16 a[200:201], v152 offset:16448
  ds_read_b64_tr_b16 a[202:203], v153 offset:16448
  ds_read_b64_tr_b16 a[204:205], v154 offset:16448
  ds_read_b64_tr_b16 a[206:207], v155 offset:16448
  s_waitcnt lgkmcnt(0)
  s_waitcnt vmcnt(8)
  ds_read_b64_tr_b16 a[208:209], v152 offset:20480
  ds_read_b64_tr_b16 a[210:211], v153 offset:20480
  ds_read_b64_tr_b16 a[212:213], v154 offset:20480
  ds_read_b64_tr_b16 a[214:215], v155 offset:20480
  ds_read_b64_tr_b16 a[216:217], v152 offset:20544
  ds_read_b64_tr_b16 a[218:219], v153 offset:20544
  ds_read_b64_tr_b16 a[220:221], v154 offset:20544
  ds_read_b64_tr_b16 a[222:223], v155 offset:20544
  s_waitcnt lgkmcnt(0)
  s_waitcnt vmcnt(4)
  ds_read_b64_tr_b16 a[224:225], v152 offset:24576
  ds_read_b64_tr_b16 a[226:227], v153 offset:24576
  ds_read_b64_tr_b16 a[228:229], v154 offset:24576
  ds_read_b64_tr_b16 a[230:231], v155 offset:24576
  ds_read_b64_tr_b16 a[232:233], v152 offset:24640
  ds_read_b64_tr_b16 a[234:235], v153 offset:24640
  ds_read_b64_tr_b16 a[236:237], v154 offset:24640
  ds_read_b64_tr_b16 a[238:239], v155 offset:24640
  s_waitcnt lgkmcnt(0)
  s_waitcnt vmcnt(0)
  ds_read_b64_tr_b16 a[240:241], v152 offset:28672
  ds_read_b64_tr_b16 a[242:243], v153 offset:28672
  ds_read_b64_tr_b16 a[244:245], v154 offset:28672
  ds_read_b64_tr_b16 a[246:247], v155 offset:28672
  ds_read_b64_tr_b16 a[248:249], v152 offset:28736
  ds_read_b64_tr_b16 a[250:251], v153 offset:28736
  ds_read_b64_tr_b16 a[252:253], v154 offset:28736
  ds_read_b64_tr_b16 a[254:255], v155 offset:28736
  s_waitcnt lgkmcnt(0)
  v_min_u32 v4, 27, v1
  v_mul_u32_u24 v5, 37, v4
  v_lshrrev_b32 v5, 8, v5
  v_mul_u32_u24 v5, 7, v5
  v_sub_u32 v5, v4, v5
  v_mov_b32 v6, 0x200
  v_cmp_ne_u32 vcc, 6, v5
  s_mul_i32 s76, s48, 3584
  s_add_u32 s76, s76, 148897792
  v_cndmask_b32 v5, 0, v6, vcc
  v_lshl_add_u32 v4, v4, 7, s76
  s_mov_b32 s71, 0
  s_branch M_vg_218
M_vw_217:
  s_sleep 2
  s_add_u32 s71, s71, 1
  s_cmp_gt_u32 s71, 262144
  s_cbranch_scc1 M_exit
M_vg_218:
  buffer_load_dword v6, v4, s[4:7], 0 offen sc1
  s_waitcnt vmcnt(0)
  v_cmp_lt_u32 vcc, v6, v5
  s_cbranch_vccnz M_vw_217
  s_barrier
  s_lshl_b32 s25, s16, 13
  s_add_u32 m0, s25, 0
  s_nop 0
  buffer_load_dwordx4 v16, s[12:15], s19 offen sc1 lds
  s_add_u32 m0, s25, 1024
  s_nop 0
  buffer_load_dwordx4 v17, s[12:15], s19 offen sc1 lds
  s_add_u32 m0, s25, 2048
  s_nop 0
  buffer_load_dwordx4 v18, s[12:15], s19 offen sc1 lds
  s_add_u32 m0, s25, 3072
  s_nop 0
  buffer_load_dwordx4 v19, s[12:15], s19 offen sc1 lds
  s_add_u32 m0, s25, 4096
  s_nop 0
  buffer_load_dwordx4 v20, s[12:15], s19 offen sc1 lds
  s_add_u32 m0, s25, 5120
  s_nop 0
  buffer_load_dwordx4 v21, s[12:15], s19 offen sc1 lds
  s_add_u32 m0, s25, 6144
  s_nop 0
  buffer_load_dwordx4 v22, s[12:15], s19 offen sc1 lds
  s_add_u32 m0, s25, 7168
  s_nop 0
  buffer_load_dwordx4 v23, s[12:15], s19 offen sc1 lds
  s_cmp_gt_u32 s23, 1
  s_cselect_b32 s26, s20, 0
  s_add_u32 s19, s19, s26
  s_add_u32 s25, s25, 32768
  s_and_b32 s25, s25, 0x1ffff
  s_add_u32 m0, s25, 0
  s_nop 0
  buffer_load_dwordx4 v16, s[12:15], s19 offen sc1 lds
  s_add_u32 m0, s25, 1024
  s_nop 0
  buffer_load_dwordx4 v17, s[12:15], s19 offen sc1 lds
  s_add_u32 m0, s25, 2048
  s_nop 0
  buffer_load_dwordx4 v18, s[12:15], s19 offen sc1 lds
  s_add_u32 m0, s25, 3072
  s_nop 0
  buffer_load_dwordx4 v19, s[12:15], s19 offen sc1 lds
  s_add_u32 m0, s25, 4096
  s_nop 0
  buffer_load_dwordx4 v20, s[12:15], s19 offen sc1 lds
  s_add_u32 m0, s25, 5120
  s_nop 0
  buffer_load_dwordx4 v21, s[12:15], s19 offen sc1 lds
  s_add_u32 m0, s25, 6144
  s_nop 0
  buffer_load_dwordx4 v22, s[12:15], s19 offen sc1 lds
  s_add_u32 m0, s25, 7168
  s_nop 0
  buffer_load_dwordx4 v23, s[12:15], s19 offen sc1 lds
  s_cmp_gt_u32 s23, 2
  s_cselect_b32 s26, s20, 0
  s_add_u32 s19, s19, s26
  s_add_u32 s25, s25, 32768
  s_and_b32 s25, s25, 0x1ffff
  s_waitcnt vmcnt(0)
  s_barrier
  s_mov_b32 s27, s21
  v_mov_b32 v7, 0x40000000
  ds_read_b128 v[24:27], v8 offset:0
  ds_read_b128 v[28:31], v9 offset:0
  ds_read_b128 v[32:35], v10 offset:0
  ds_read_b128 v[36:39], v11 offset:0
  ds_read_b128 v[40:43], v12 offset:0
  ds_read_b128 v[44:47], v13 offset:0
.p2align 6
G_top_219:
  s_waitcnt lgkmcnt(5)
  v_mfma_f32_16x16x32_bf16 v[64:67], a[0:3], v[24:27], 0
  s_add_u32 m0, s25, 0
  ds_read_b128 v[48:51], v14 offset:0
  v_mfma_f32_16x16x32_bf16 v[68:71], a[4:7], v[24:27], 0
  v_mfma_f32_16x16x32_bf16 v[80:83], a[8:11], v[24:27], 0
  buffer_load_dwordx4 v16, s[12:15], s19 offen sc1 lds
  v_mfma_f32_16x16x32_bf16 v[84:87], a[12:15], v[24:27], 0
  s_waitcnt lgkmcnt(5)
  v_mfma_f32_16x16x32_bf16 v[72:75], a[0:3], v[28:31], 0
  ds_read_b128 v[52:55], v15 offset:0
  v_mfma_f32_16x16x32_bf16 v[76:79], a[4:7], v[28:31], 0
  v_cvt_pk_bf16_f32 v128, v96, v97
  v_cvt_pk_bf16_f32 v129, v98, v99
  v_mfma_f32_16x16x32_bf16 v[88:91], a[8:11], v[28:31], 0
  v_mfma_f32_16x16x32_bf16 v[92:95], a[12:15], v[28:31], 0
  s_waitcnt lgkmcnt(5)
  v_cvt_pk_bf16_f32 v130, v100, v101
  v_cvt_pk_bf16_f32 v131, v102, v103
  v_mfma_f32_16x16x32_bf16 v[64:67], a[16:19], v[32:35], v[64:67]
  s_add_u32 m0, s25, 1024
  ds_read_b128 v[24:27], v8 offset:8192
  v_mfma_f32_16x16x32_bf16 v[68:71], a[20:23], v[32:35], v[68:71]
  v_mfma_f32_16x16x32_bf16 v[80:83], a[24:27], v[32:35], v[80:83]
  buffer_load_dwordx4 v17, s[12:15], s19 offen sc1 lds
  v_mfma_f32_16x16x32_bf16 v[84:87], a[28:31], v[32:35], v[84:87]
  s_waitcnt lgkmcnt(5)
  v_mfma_f32_16x16x32_bf16 v[72:75], a[16:19], v[36:39], v[72:75]
  ds_read_b128 v[28:31], v9 offset:8192
  v_mfma_f32_16x16x32_bf16 v[76:79], a[20:23], v[36:39], v[76:79]
  v_mfma_f32_16x16x32_bf16 v[88:91], a[24:27], v[36:39], v[88:91]
  v_mfma_f32_16x16x32_bf16 v[92:95], a[28:31], v[36:39], v[92:95]
  s_waitcnt lgkmcnt(5)
  v_mfma_f32_16x16x32_bf16 v[64:67], a[32:35], v[40:43], v[64:67]
  s_add_u32 m0, s25, 2048
  ds_read_b128 v[32:35], v10 offset:8192
  v_mfma_f32_16x16x32_bf16 v[68:71], a[36:39], v[40:43], v[68:71]
  v_cvt_pk_bf16_f32 v132, v104, v105
  v_cvt_pk_bf16_f32 v133, v106, v107
  v_mfma_f32_16x16x32_bf16 v[80:83], a[40:43], v[40:43], v[80:83]
  buffer_load_dwordx4 v18, s[12:15], s19 offen sc1 lds
  v_mfma_f32_16x16x32_bf16 v[84:87], a[44:47], v[40:43], v[84:87]
  s_waitcnt lgkmcnt(5)
  v_cvt_pk_bf16_f32 v134, v108, v109
  v_cvt_pk_bf16_f32 v135, v110, v111
  v_mfma_f32_16x16x32_bf16 v[72:75], a[32:35], v[44:47], v[72:75]
  ds_read_b128 v[36:39], v11 offset:8192
  v_mfma_f32_16x16x32_bf16 v[76:79], a[36:39], v[44:47], v[76:79]
  v_mfma_f32_16x16x32_bf16 v[88:91], a[40:43], v[44:47], v[88:91]
  v_mfma_f32_16x16x32_bf16 v[92:95], a[44:47], v[44:47], v[92:95]
  s_waitcnt lgkmcnt(5)
  v_mfma_f32_16x16x32_bf16 v[64:67], a[48:51], v[48:51], v[64:67]
  s_add_u32 m0, s25, 3072
  ds_read_b128 v[40:43], v12 offset:8192
  v_mfma_f32_16x16x32_bf16 v[68:71], a[52:55], v[48:51], v[68:71]
  v_mfma_f32_16x16x32_bf16 v[80:83], a[56:59], v[48:51], v[80:83]
  buffer_load_dwordx4 v19, s[12:15], s19 offen sc1 lds
  v_mfma_f32_16x16x32_bf16 v[84:87], a[60:63], v[48:51], v[84:87]
  s_waitcnt lgkmcnt(5)
  v_mfma_f32_16x16x32_bf16 v[72:75], a[48:51], v[52:55], v[72:75]
  ds_read_b128 v[44:47], v13 offset:8192
  v_mfma_f32_16x16x32_bf16 v[76:79], a[52:55], v[52:55], v[76:79]
  v_cvt_pk_bf16_f32 v136, v112, v113
  v_cvt_pk_bf16_f32 v137, v114, v115
  v_mfma_f32_16x16x32_bf16 v[88:91], a[56:59], v[52:55], v[88:91]
  v_mfma_f32_16x16x32_bf16 v[92:95], a[60:63], v[52:55], v[92:95]
  s_waitcnt lgkmcnt(5)
  v_cvt_pk_bf16_f32 v138, v116, v117
  v_cvt_pk_bf16_f32 v139, v118, v119
  v_mfma_f32_16x16x32_bf16 v[64:67], a[64:67], v[24:27], v[64:67]
  s_add_u32 m0, s25, 4096
  ds_read_b128 v[48:51], v14 offset:8192
  v_mfma_f32_16x16x32_bf16 v[68:71], a[68:71], v[24:27], v[68:71]
  v_mfma_f32_16x16x32_bf16 v[80:83], a[72:75], v[24:27], v[80:83]
  buffer_load_dwordx4 v20, s[12:15], s19 offen sc1 lds
  v_mfma_f32_16x16x32_bf16 v[84:87], a[76:79], v[24:27], v[84:87]
  s_waitcnt lgkmcnt(5)
  v_mfma_f32_16x16x32_bf16 v[72:75], a[64:67], v[28:31], v[72:75]
  ds_read_b128 v[52:55], v15 offset:8192
  v_mfma_f32_16x16x32_bf16 v[76:79], a[68:71], v[28:31], v[76:79]
  v_mfma_f32_16x16x32_bf16 v[88:91], a[72:75], v[28:31], v[88:91]
  v_mfma_f32_16x16x32_bf16 v[92:95], a[76:79], v[28:31], v[92:95]
  s_waitcnt lgkmcnt(5)
  v_mfma_f32_16x16x32_bf16 v[64:67], a[80:83], v[32:35], v[64:67]
  s_add_u32 m0, s25, 5120
  ds_read_b128 v[24:27], v8 offset:16384
  v_mfma_f32_16x16x32_bf16 v[68:71], a[84:87], v[32:35], v[68:71]
  v_cvt_pk_bf16_f32 v140, v120, v121
  v_cvt_pk_bf16_f32 v141, v122, v123
  v_mfma_f32_16x16x32_bf16 v[80:83], a[88:91], v[32:35], v[80:83]
  buffer_load_dwordx4 v21, s[12:15], s19 offen sc1 lds
  v_mfma_f32_16x16x32_bf16 v[84:87], a[92:95], v[32:35], v[84:87]
  s_waitcnt lgkmcnt(5)
  v_cvt_pk_bf16_f32 v142, v124, v125
  v_cvt_pk_bf16_f32 v143, v126, v127
  v_mfma_f32_16x16x32_bf16 v[72:75], a[80:83], v[36:39], v[72:75]
  ds_read_b128 v[28:31], v9 offset:16384
  v_mfma_f32_16x16x32_bf16 v[76:79], a[84:87], v[36:39], v[76:79]
  v_mfma_f32_16x16x32_bf16 v[88:91], a[88:91], v[36:39], v[88:91]
  v_mfma_f32_16x16x32_bf16 v[92:95], a[92:95], v[36:39], v[92:95]
  s_waitcnt lgkmcnt(5)
  v_mfma_f32_16x16x32_bf16 v[64:67], a[96:99], v[40:43], v[64:67]
  s_add_u32 m0, s25, 6144
  ds_read_b128 v[32:35], v10 offset:16384
  v_mfma_f32_16x16x32_bf16 v[68:71], a[100:103], v[40:43], v[68:71]
  v_mfma_f32_16x16x32_bf16 v[80:83], a[104:107], v[40:43], v[80:83]
  buffer_load_dwordx4 v22, s[12:15], s19 offen sc1 lds
  v_mfma_f32_16x16x32_bf16 v[84:87], a[108:111], v[40:43], v[84:87]
  s_waitcnt lgkmcnt(5)
  v_mfma_f32_16x16x32_bf16 v[72:75], a[96:99], v[44:47], v[72:75]
  ds_read_b128 v[36:39], v11 offset:16384
  v_mfma_f32_16x16x32_bf16 v[76:79], a[100:103], v[44:47], v[76:79]
  v_mfma_f32_16x16x32_bf16 v[88:91], a[104:107], v[44:47], v[88:91]
  v_mfma_f32_16x16x32_bf16 v[92:95], a[108:111], v[44:47], v[92:95]
  s_waitcnt lgkmcnt(5)
  v_mfma_f32_16x16x32_bf16 v[64:67], a[112:115], v[48:51], v[64:67]
  s_add_u32 m0, s25, 7168
  ds_read_b128 v[40:43], v12 offset:16384
  v_mfma_f32_16x16x32_bf16 v[68:71], a[116:119], v[48:51], v[68:71]
  v_mfma_f32_16x16x32_bf16 v[80:83], a[120:123], v[48:51], v[80:83]
  buffer_load_dwordx4 v23, s[12:15], s19 offen sc1 lds
  v_mfma_f32_16x16x32_bf16 v[84:87], a[124:127], v[48:51], v[84:87]
  s_waitcnt lgkmcnt(5)
  v_mfma_f32_16x16x32_bf16 v[72:75], a[112:115], v[52:55], v[72:75]
  s_cmp_gt_u32 s23, 3
  ds_read_b128 v[44:47], v13 offset:16384
  v_mfma_f32_16x16x32_bf16 v[76:79], a[116:119], v[52:55], v[76:79]
  v_mfma_f32_16x16x32_bf16 v[88:91], a[120:123], v[52:55], v[88:91]
  s_cselect_b32 s26, s20, 0
  v_mfma_f32_16x16x32_bf16 v[92:95], a[124:127], v[52:55], v[92:95]
  s_waitcnt lgkmcnt(5)
  v_mfma_f32_16x16x32_bf16 v[64:67], a[128:131], v[24:27], v[64:67]
  s_add_u32 s19, s19, s26
  ds_read_b128 v[48:51], v14 offset:16384
  v_mfma_f32_16x16x32_bf16 v[68:71], a[132:135], v[24:27], v[68:71]
  v_mfma_f32_16x16x32_bf16 v[80:83], a[136:139], v[24:27], v[80:83]
  s_add_u32 s25, s25, 32768
  v_mfma_f32_16x16x32_bf16 v[84:87], a[140:143], v[24:27], v[84:87]
  s_waitcnt lgkmcnt(5)
  v_mfma_f32_16x16x32_bf16 v[72:75], a[128:131], v[28:31], v[72:75]
  s_and_b32 s25, s25, 0x1ffff
  ds_read_b128 v[52:55], v15 offset:16384
  v_mfma_f32_16x16x32_bf16 v[76:79], a[132:135], v[28:31], v[76:79]
  v_mfma_f32_16x16x32_bf16 v[88:91], a[136:139], v[28:31], v[88:91]
  buffer_store_dwordx4 v[128:131], v7, s[4:7], s21 offen offset:0 sc1
  v_mfma_f32_16x16x32_bf16 v[92:95], a[140:143], v[28:31], v[92:95]
  s_waitcnt lgkmcnt(5)
  v_mfma_f32_16x16x32_bf16 v[64:67], a[144:147], v[32:35], v[64:67]
  ds_read_b128 v[24:27], v8 offset:24576
  v_mfma_f32_16x16x32_bf16 v[68:71], a[148:151], v[32:35], v[68:71]
  v_mfma_f32_16x16x32_bf16 v[80:83], a[152:155], v[32:35], v[80:83]
  v_mfma_f32_16x16x32_bf16 v[84:87], a[156:159], v[32:35], v[84:87]
  s_waitcnt lgkmcnt(5)
  v_mfma_f32_16x16x32_bf16 v[72:75], a[144:147], v[36:39], v[72:75]
  ds_read_b128 v[28:31], v9 offset:24576
  v_mfma_f32_16x16x32_bf16 v[76:79], a[148:151], v[36:39], v[76:79]
  v_mfma_f32_16x16x32_bf16 v[88:91], a[152:155], v[36:39], v[88:91]
  buffer_store_dwordx4 v[132:135], v7, s[4:7], s21 offen offset:256 sc1
  v_mfma_f32_16x16x32_bf16 v[92:95], a[156:159], v[36:39], v[92:95]
  s_waitcnt lgkmcnt(5)
  v_mfma_f32_16x16x32_bf16 v[64:67], a[160:163], v[40:43], v[64:67]
  ds_read_b128 v[32:35], v10 offset:24576
  v_mfma_f32_16x16x32_bf16 v[68:71], a[164:167], v[40:43], v[68:71]
  v_mfma_f32_16x16x32_bf16 v[80:83], a[168:171], v[40:43], v[80:83]
  v_mfma_f32_16x16x32_bf16 v[84:87], a[172:175], v[40:43], v[84:87]
  s_waitcnt lgkmcnt(5)
  v_mfma_f32_16x16x32_bf16 v[72:75], a[160:163], v[44:47], v[72:75]
  ds_read_b128 v[36:39], v11 offset:24576
  v_mfma_f32_16x16x32_bf16 v[76:79], a[164:167], v[44:47], v[76:79]
  v_mfma_f32_16x16x32_bf16 v[88:91], a[168:171], v[44:47], v[88:91]
  buffer_store_dwordx4 v[136:139], v7, s[4:7], s21 offen offset:2048 sc1
  v_mfma_f32_16x16x32_bf16 v[92:95], a[172:175], v[44:47], v[92:95]
  s_waitcnt lgkmcnt(5)
  v_mfma_f32_16x16x32_bf16 v[64:67], a[176:179], v[48:51], v[64:67]
  ds_read_b128 v[40:43], v12 offset:24576
  v_mfma_f32_16x16x32_bf16 v[68:71], a[180:183], v[48:51], v[68:71]
  v_mfma_f32_16x16x32_bf16 v[80:83], a[184:187], v[48:51], v[80:83]
  v_mfma_f32_16x16x32_bf16 v[84:87], a[188:191], v[48:51], v[84:87]
  s_waitcnt lgkmcnt(5)
  v_mfma_f32_16x16x32_bf16 v[72:75], a[176:179], v[52:55], v[72:75]
  ds_read_b128 v[44:47], v13 offset:24576
  v_mfma_f32_16x16x32_bf16 v[76:79], a[180:183], v[52:55], v[76:79]
  v_mfma_f32_16x16x32_bf16 v[88:91], a[184:187], v[52:55], v[88:91]
  buffer_store_dwordx4 v[140:143], v7, s[4:7], s21 offen offset:2304 sc1
  v_mfma_f32_16x16x32_bf16 v[92:95], a[188:191], v[52:55], v[92:95]
  s_waitcnt lgkmcnt(5)
  v_mfma_f32_16x16x32_bf16 v[64:67], a[192:195], v[24:27], v[64:67]
  s_mov_b32 s21, s27
  ds_read_b128 v[48:51], v14 offset:24576
  v_mfma_f32_16x16x32_bf16 v[68:71], a[196:199], v[24:27], v[68:71]
  v_mov_b32 v7, v56
  v_mfma_f32_16x16x32_bf16 v[80:83], a[200:203], v[24:27], v[80:83]
  v_mfma_f32_16x16x32_bf16 v[84:87], a[204:207], v[24:27], v[84:87]
  s_waitcnt lgkmcnt(5)
  v_mfma_f32_16x16x32_bf16 v[72:75], a[192:195], v[28:31], v[72:75]
  s_add_u32 s27, s27, s22
  ds_read_b128 v[52:55], v15 offset:24576
  v_mfma_f32_16x16x32_bf16 v[76:79], a[196:199], v[28:31], v[76:79]
  v_mfma_f32_16x16x32_bf16 v[88:91], a[200:203], v[28:31], v[88:91]
  s_waitcnt vmcnt(16)
  s_barrier
  v_mfma_f32_16x16x32_bf16 v[92:95], a[204:207], v[28:31], v[92:95]
  s_waitcnt lgkmcnt(5)
  v_mfma_f32_16x16x32_bf16 v[64:67], a[208:211], v[32:35], v[64:67]
  ds_read_b128 v[24:27], v8 offset:32768
  v_mfma_f32_16x16x32_bf16 v[68:71], a[212:215], v[32:35], v[68:71]
  v_mfma_f32_16x16x32_bf16 v[80:83], a[216:219], v[32:35], v[80:83]
  v_mfma_f32_16x16x32_bf16 v[84:87], a[220:223], v[32:35], v[84:87]
  s_waitcnt lgkmcnt(5)
  v_mfma_f32_16x16x32_bf16 v[72:75], a[208:211], v[36:39], v[72:75]
  ds_read_b128 v[28:31], v9 offset:32768
  v_mfma_f32_16x16x32_bf16 v[76:79], a[212:215], v[36:39], v[76:79]
  v_mfma_f32_16x16x32_bf16 v[88:91], a[216:219], v[36:39], v[88:91]
  v_mfma_f32_16x16x32_bf16 v[92:95], a[220:223], v[36:39], v[92:95]
  s_waitcnt lgkmcnt(5)
  v_mfma_f32_16x16x32_bf16 v[64:67], a[224:227], v[40:43], v[64:67]
  ds_read_b128 v[32:35], v10 offset:32768
  v_mfma_f32_16x16x32_bf16 v[68:71], a[228:231], v[40:43], v[68:71]
  v_mfma_f32_16x16x32_bf16 v[80:83], a[232:235], v[40:43], v[80:83]
  v_mfma_f32_16x16x32_bf16 v[84:87], a[236:239], v[40:43], v[84:87]
  s_waitcnt lgkmcnt(5)
  v_mfma_f32_16x16x32_bf16 v[72:75], a[224:227], v[44:47], v[72:75]
  ds_read_b128 v[36:39], v11 offset:32768
  v_mfma_f32_16x16x32_bf16 v[76:79], a[228:231], v[44:47], v[76:79]
  v_mfma_f32_16x16x32_bf16 v[88:91], a[232:235], v[44:47], v[88:91]
  v_mfma_f32_16x16x32_bf16 v[92:95], a[236:239], v[44:47], v[92:95]
  s_waitcnt lgkmcnt(5)
  v_mfma_f32_16x16x32_bf16 v[64:67], a[240:243], v[48:51], v[64:67]
  s_sub_u32 s23, s23, 1
  ds_read_b128 v[40:43], v12 offset:32768
  v_mfma_f32_16x16x32_bf16 v[68:71], a[244:247], v[48:51], v[68:71]
  v_mfma_f32_16x16x32_bf16 v[80:83], a[248:251], v[48:51], v[80:83]
  v_mfma_f32_16x16x32_bf16 v[84:87], a[252:255], v[48:51], v[84:87]
  s_waitcnt lgkmcnt(5)
  v_mfma_f32_16x16x32_bf16 v[72:75], a[240:243], v[52:55], v[72:75]
  s_cmp_eq_u32 s23, 0
  ds_read_b128 v[44:47], v13 offset:32768
  v_mfma_f32_16x16x32_bf16 v[76:79], a[244:247], v[52:55], v[76:79]
  v_mfma_f32_16x16x32_bf16 v[88:91], a[248:251], v[52:55], v[88:91]
  v_mfma_f32_16x16x32_bf16 v[92:95], a[252:255], v[52:55], v[92:95]
  s_cbranch_scc1 G_done0_220
  s_waitcnt lgkmcnt(5)
  v_mfma_f32_16x16x32_bf16 v[96:99], a[0:3], v[24:27], 0
  s_add_u32 m0, s25, 0
  ds_read_b128 v[48:51], v14 offset:32768
  v_mfma_f32_16x16x32_bf16 v[100:103], a[4:7], v[24:27], 0
  v_mfma_f32_16x16x32_bf16 v[112:115], a[8:11], v[24:27], 0
  buffer_load_dwordx4 v16, s[12:15], s19 offen sc1 lds
  v_mfma_f32_16x16x32_bf16 v[116:119], a[12:15], v[24:27], 0
  s_waitcnt lgkmcnt(5)
  v_mfma_f32_16x16x32_bf16 v[104:107], a[0:3], v[28:31], 0
  ds_read_b128 v[52:55], v15 offset:32768
  v_mfma_f32_16x16x32_bf16 v[108:111], a[4:7], v[28:31], 0
  v_cvt_pk_bf16_f32 v128, v64, v65
  v_cvt_pk_bf16_f32 v129, v66, v67
  v_mfma_f32_16x16x32_bf16 v[120:123], a[8:11], v[28:31], 0
  v_mfma_f32_16x16x32_bf16 v[124:127], a[12:15], v[28:31], 0
  s_waitcnt lgkmcnt(5)
  v_cvt_pk_bf16_f32 v130, v68, v69
  v_cvt_pk_bf16_f32 v131, v70, v71
  v_mfma_f32_16x16x32_bf16 v[96:99], a[16:19], v[32:35], v[96:99]
  s_add_u32 m0, s25, 1024
  ds_read_b128 v[24:27], v8 offset:40960
  v_mfma_f32_16x16x32_bf16 v[100:103], a[20:23], v[32:35], v[100:103]
  v_mfma_f32_16x16x32_bf16 v[112:115], a[24:27], v[32:35], v[112:115]
  buffer_load_dwordx4 v17, s[12:15], s19 offen sc1 lds
  v_mfma_f32_16x16x32_bf16 v[116:119], a[28:31], v[32:35], v[116:119]
  s_waitcnt lgkmcnt(5)
  v_mfma_f32_16x16x32_bf16 v[104:107], a[16:19], v[36:39], v[104:107]
  ds_read_b128 v[28:31], v9 offset:40960
  v_mfma_f32_16x16x32_bf16 v[108:111], a[20:23], v[36:39], v[108:111]
  v_mfma_f32_16x16x32_bf16 v[120:123], a[24:27], v[36:39], v[120:123]
  v_mfma_f32_16x16x32_bf16 v[124:127], a[28:31], v[36:39], v[124:127]
  s_waitcnt lgkmcnt(5)
  v_mfma_f32_16x16x32_bf16 v[96:99], a[32:35], v[40:43], v[96:99]
  s_add_u32 m0, s25, 2048
  ds_read_b128 v[32:35], v10 offset:40960
  v_mfma_f32_16x16x32_bf16 v[100:103], a[36:39], v[40:43], v[100:103]
  v_cvt_pk_bf16_f32 v132, v72, v73
  v_cvt_pk_bf16_f32 v133, v74, v75
  v_mfma_f32_16x16x32_bf16 v[112:115], a[40:43], v[40:43], v[112:115]
  buffer_load_dwordx4 v18, s[12:15], s19 offen sc1 lds
  v_mfma_f32_16x16x32_bf16 v[116:119], a[44:47], v[40:43], v[116:119]
  s_waitcnt lgkmcnt(5)
  v_cvt_pk_bf16_f32 v134, v76, v77
  v_cvt_pk_bf16_f32 v135, v78, v79
  v_mfma_f32_16x16x32_bf16 v[104:107], a[32:35], v[44:47], v[104:107]
  ds_read_b128 v[36:39], v11 offset:40960
  v_mfma_f32_16x16x32_bf16 v[108:111], a[36:39], v[44:47], v[108:111]
  v_mfma_f32_16x16x32_bf16 v[120:123], a[40:43], v[44:47], v[120:123]
  v_mfma_f32_16x16x32_bf16 v[124:127], a[44:47], v[44:47], v[124:127]
  s_waitcnt lgkmcnt(5)
  v_mfma_f32_16x16x32_bf16 v[96:99], a[48:51], v[48:51], v[96:99]
  s_add_u32 m0, s25, 3072
  ds_read_b128 v[40:43], v12 offset:40960
  v_mfma_f32_16x16x32_bf16 v[100:103], a[52:55], v[48:51], v[100:103]
  v_mfma_f32_16x16x32_bf16 v[112:115], a[56:59], v[48:51], v[112:115]
  buffer_load_dwordx4 v19, s[12:15], s19 offen sc1 lds
  v_mfma_f32_16x16x32_bf16 v[116:119], a[60:63], v[48:51], v[116:119]
  s_waitcnt lgkmcnt(5)
  v_mfma_f32_16x16x32_bf16 v[104:107], a[48:51], v[52:55], v[104:107]
  ds_read_b128 v[44:47], v13 offset:40960
  v_mfma_f32_16x16x32_bf16 v[108:111], a[52:55], v[52:55], v[108:111]
  v_cvt_pk_bf16_f32 v136, v80, v81
  v_cvt_pk_bf16_f32 v137, v82, v83
  v_mfma_f32_16x16x32_bf16 v[120:123], a[56:59], v[52:55], v[120:123]
  v_mfma_f32_16x16x32_bf16 v[124:127], a[60:63], v[52:55], v[124:127]
  s_waitcnt lgkmcnt(5)
  v_cvt_pk_bf16_f32 v138, v84, v85
  v_cvt_pk_bf16_f32 v139, v86, v87
  v_mfma_f32_16x16x32_bf16 v[96:99], a[64:67], v[24:27], v[96:99]
  s_add_u32 m0, s25, 4096
  ds_read_b128 v[48:51], v14 offset:40960
  v_mfma_f32_16x16x32_bf16 v[100:103], a[68:71], v[24:27], v[100:103]
  v_mfma_f32_16x16x32_bf16 v[112:115], a[72:75], v[24:27], v[112:115]
  buffer_load_dwordx4 v20, s[12:15], s19 offen sc1 lds
  v_mfma_f32_16x16x32_bf16 v[116:119], a[76:79], v[24:27], v[116:119]
  s_waitcnt lgkmcnt(5)
  v_mfma_f32_16x16x32_bf16 v[104:107], a[64:67], v[28:31], v[104:107]
  ds_read_b128 v[52:55], v15 offset:40960
  v_mfma_f32_16x16x32_bf16 v[108:111], a[68:71], v[28:31], v[108:111]
  v_mfma_f32_16x16x32_bf16 v[120:123], a[72:75], v[28:31], v[120:123]
  v_mfma_f32_16x16x32_bf16 v[124:127], a[76:79], v[28:31], v[124:127]
  s_waitcnt lgkmcnt(5)
  v_mfma_f32_16x16x32_bf16 v[96:99], a[80:83], v[32:35], v[96:99]
  s_add_u32 m0, s25, 5120
  ds_read_b128 v[24:27], v8 offset:49152
  v_mfma_f32_16x16x32_bf16 v[100:103], a[84:87], v[32:35], v[100:103]
  v_cvt_pk_bf16_f32 v140, v88, v89
  v_cvt_pk_bf16_f32 v141, v90, v91
  v_mfma_f32_16x16x32_bf16 v[112:115], a[88:91], v[32:35], v[112:115]
  buffer_load_dwordx4 v21, s[12:15], s19 offen sc1 lds
  v_mfma_f32_16x16x32_bf16 v[116:119], a[92:95], v[32:35], v[116:119]
  s_waitcnt lgkmcnt(5)
  v_cvt_pk_bf16_f32 v142, v92, v93
  v_cvt_pk_bf16_f32 v143, v94, v95
  v_mfma_f32_16x16x32_bf16 v[104:107], a[80:83], v[36:39], v[104:107]
  ds_read_b128 v[28:31], v9 offset:49152
  v_mfma_f32_16x16x32_bf16 v[108:111], a[84:87], v[36:39], v[108:111]
  v_mfma_f32_16x16x32_bf16 v[120:123], a[88:91], v[36:39], v[120:123]
  v_mfma_f32_16x16x32_bf16 v[124:127], a[92:95], v[36:39], v[124:127]
  s_waitcnt lgkmcnt(5)
  v_mfma_f32_16x16x32_bf16 v[96:99], a[96:99], v[40:43], v[96:99]
  s_add_u32 m0, s25, 6144
  ds_read_b128 v[32:35], v10 offset:49152
  v_mfma_f32_16x16x32_bf16 v[100:103], a[100:103], v[40:43], v[100:103]
  v_mfma_f32_16x16x32_bf16 v[112:115], a[104:107], v[40:43], v[112:115]
  buffer_load_dwordx4 v22, s[12:15], s19 offen sc1 lds
  v_mfma_f32_16x16x32_bf16 v[116:119], a[108:111], v[40:43], v[116:119]
  s_waitcnt lgkmcnt(5)
  v_mfma_f32_16x16x32_bf16 v[104:107], a[96:99], v[44:47], v[104:107]
  ds_read_b128 v[36:39], v11 offset:49152
  v_mfma_f32_16x16x32_bf16 v[108:111], a[100:103], v[44:47], v[108:111]
  v_mfma_f32_16x16x32_bf16 v[120:123], a[104:107], v[44:47], v[120:123]
  v_mfma_f32_16x16x32_bf16 v[124:127], a[108:111], v[44:47], v[124:127]
  s_waitcnt lgkmcnt(5)
  v_mfma_f32_16x16x32_bf16 v[96:99], a[112:115], v[48:51], v[96:99]
  s_add_u32 m0, s25, 7168
  ds_read_b128 v[40:43], v12 offset:49152
  v_mfma_f32_16x16x32_bf16 v[100:103], a[116:119], v[48:51], v[100:103]
  v_mfma_f32_16x16x32_bf16 v[112:115], a[120:123], v[48:51], v[112:115]
  buffer_load_dwordx4 v23, s[12:15], s19 offen sc1 lds
  v_mfma_f32_16x16x32_bf16 v[116:119], a[124:127], v[48:51], v[116:119]
  s_waitcnt lgkmcnt(5)
  v_mfma_f32_16x16x32_bf16 v[104:107], a[112:115], v[52:55], v[104:107]
  s_cmp_gt_u32 s23, 3
  ds_read_b128 v[44:47], v13 offset:49152
  v_mfma_f32_16x16x32_bf16 v[108:111], a[116:119], v[52:55], v[108:111]
  v_mfma_f32_16x16x32_bf16 v[120:123], a[120:123], v[52:55], v[120:123]
  s_cselect_b32 s26, s20, 0
  v_mfma_f32_16x16x32_bf16 v[124:127], a[124:127], v[52:55], v[124:127]
  s_waitcnt lgkmcnt(5)
  v_mfma_f32_16x16x32_bf16 v[96:99], a[128:131], v[24:27], v[96:99]
  s_add_u32 s19, s19, s26
  ds_read_b128 v[48:51], v14 offset:49152
  v_mfma_f32_16x16x32_bf16 v[100:103], a[132:135], v[24:27], v[100:103]
  v_mfma_f32_16x16x32_bf16 v[112:115], a[136:139], v[24:27], v[112:115]
  s_add_u32 s25, s25, 32768
  v_mfma_f32_16x16x32_bf16 v[116:119], a[140:143], v[24:27], v[116:119]
  s_waitcnt lgkmcnt(5)
  v_mfma_f32_16x16x32_bf16 v[104:107], a[128:131], v[28:31], v[104:107]
  s_and_b32 s25, s25, 0x1ffff
  ds_read_b128 v[52:55], v15 offset:49152
  v_mfma_f32_16x16x32_bf16 v[108:111], a[132:135], v[28:31], v[108:111]
  v_mfma_f32_16x16x32_bf16 v[120:123], a[136:139], v[28:31], v[120:123]
  buffer_store_dwordx4 v[128:131], v7, s[4:7], s21 offen offset:0 sc1
  v_mfma_f32_16x16x32_bf16 v[124:127], a[140:143], v[28:31], v[124:127]
  s_waitcnt lgkmcnt(5)
  v_mfma_f32_16x16x32_bf16 v[96:99], a[144:147], v[32:35], v[96:99]
  ds_read_b128 v[24:27], v8 offset:57344
  v_mfma_f32_16x16x32_bf16 v[100:103], a[148:151], v[32:35], v[100:103]
  v_mfma_f32_16x16x32_bf16 v[112:115], a[152:155], v[32:35], v[112:115]
  v_mfma_f32_16x16x32_bf16 v[116:119], a[156:159], v[32:35], v[116:119]
  s_waitcnt lgkmcnt(5)
  v_xor_b32 v8, 0x10000, v8
  v_mfma_f32_16x16x32_bf16 v[104:107], a[144:147], v[36:39], v[104:107]
  ds_read_b128 v[28:31], v9 offset:57344
  v_mfma_f32_16x16x32_bf16 v[108:111], a[148:151], v[36:39], v[108:111]
  v_mfma_f32_16x16x32_bf16 v[120:123], a[152:155], v[36:39], v[120:123]
  buffer_store_dwordx4 v[132:135], v7, s[4:7], s21 offen offset:256 sc1
  v_mfma_f32_16x16x32_bf16 v[124:127], a[156:159], v[36:39], v[124:127]
  s_waitcnt lgkmcnt(5)
  v_xor_b32 v9, 0x10000, v9
  v_mfma_f32_16x16x32_bf16 v[96:99], a[160:163], v[40:43], v[96:99]
  ds_read_b128 v[32:35], v10 offset:57344
  v_mfma_f32_16x16x32_bf16 v[100:103], a[164:167], v[40:43], v[100:103]
  v_mfma_f32_16x16x32_bf16 v[112:115], a[168:171], v[40:43], v[112:115]
  v_mfma_f32_16x16x32_bf16 v[116:119], a[172:175], v[40:43], v[116:119]
  s_waitcnt lgkmcnt(5)
  v_xor_b32 v10, 0x10000, v10
  v_mfma_f32_16x16x32_bf16 v[104:107], a[160:163], v[44:47], v[104:107]
  ds_read_b128 v[36:39], v11 offset:57344
  v_mfma_f32_16x16x32_bf16 v[108:111], a[164:167], v[44:47], v[108:111]
  v_mfma_f32_16x16x32_bf16 v[120:123], a[168:171], v[44:47], v[120:123]
  buffer_store_dwordx4 v[136:139], v7, s[4:7], s21 offen offset:2048 sc1
  v_mfma_f32_16x16x32_bf16 v[124:127], a[172:175], v[44:47], v[124:127]
  s_waitcnt lgkmcnt(5)
  v_xor_b32 v11, 0x10000, v11
  v_mfma_f32_16x16x32_bf16 v[96:99], a[176:179], v[48:51], v[96:99]
  ds_read_b128 v[40:43], v12 offset:57344
  v_mfma_f32_16x16x32_bf16 v[100:103], a[180:183], v[48:51], v[100:103]
  v_mfma_f32_16x16x32_bf16 v[112:115], a[184:187], v[48:51], v[112:115]
  v_mfma_f32_16x16x32_bf16 v[116:119], a[188:191], v[48:51], v[116:119]
  s_waitcnt lgkmcnt(5)
  v_xor_b32 v12, 0x10000, v12
  v_mfma_f32_16x16x32_bf16 v[104:107], a[176:179], v[52:55], v[104:107]
  ds_read_b128 v[44:47], v13 offset:57344
  v_mfma_f32_16x16x32_bf16 v[108:111], a[180:183], v[52:55], v[108:111]
  v_mfma_f32_16x16x32_bf16 v[120:123], a[184:187], v[52:55], v[120:123]
  buffer_store_dwordx4 v[140:143], v7, s[4:7], s21 offen offset:2304 sc1
  v_mfma_f32_16x16x32_bf16 v[124:127], a[188:191], v[52:55], v[124:127]
  s_waitcnt lgkmcnt(5)
  v_xor_b32 v13, 0x10000, v13
  v_mfma_f32_16x16x32_bf16 v[96:99], a[192:195], v[24:27], v[96:99]
  s_mov_b32 s21, s27
  ds_read_b128 v[48:51], v14 offset:57344
  v_mfma_f32_16x16x32_bf16 v[100:103], a[196:199], v[24:27], v[100:103]
  v_mov_b32 v7, v56
  v_mfma_f32_16x16x32_bf16 v[112:115], a[200:203], v[24:27], v[112:115]
  v_mfma_f32_16x16x32_bf16 v[116:119], a[204:207], v[24:27], v[116:119]
  s_waitcnt lgkmcnt(5)
  v_xor_b32 v14, 0x10000, v14
  v_mfma_f32_16x16x32_bf16 v[104:107], a[192:195], v[28:31], v[104:107]
  s_add_u32 s27, s27, s22
  ds_read_b128 v[52:55], v15 offset:57344
  v_mfma_f32_16x16x32_bf16 v[108:111], a[196:199], v[28:31], v[108:111]
  v_mfma_f32_16x16x32_bf16 v[120:123], a[200:203], v[28:31], v[120:123]
  s_waitcnt vmcnt(16)
  s_barrier
  v_mfma_f32_16x16x32_bf16 v[124:127], a[204:207], v[28:31], v[124:127]
  s_waitcnt lgkmcnt(5)
  v_xor_b32 v15, 0x10000, v15
  v_mfma_f32_16x16x32_bf16 v[96:99], a[208:211], v[32:35], v[96:99]
  ds_read_b128 v[24:27], v8 offset:0
  v_mfma_f32_16x16x32_bf16 v[100:103], a[212:215], v[32:35], v[100:103]
  v_mfma_f32_16x16x32_bf16 v[112:115], a[216:219], v[32:35], v[112:115]
  v_mfma_f32_16x16x32_bf16 v[116:119], a[220:223], v[32:35], v[116:119]
  s_waitcnt lgkmcnt(5)
  v_mfma_f32_16x16x32_bf16 v[104:107], a[208:211], v[36:39], v[104:107]
  ds_read_b128 v[28:31], v9 offset:0
  v_mfma_f32_16x16x32_bf16 v[108:111], a[212:215], v[36:39], v[108:111]
  v_mfma_f32_16x16x32_bf16 v[120:123], a[216:219], v[36:39], v[120:123]
  v_mfma_f32_16x16x32_bf16 v[124:127], a[220:223], v[36:39], v[124:127]
  s_waitcnt lgkmcnt(5)
  v_mfma_f32_16x16x32_bf16 v[96:99], a[224:227], v[40:43], v[96:99]
  ds_read_b128 v[32:35], v10 offset:0
  v_mfma_f32_16x16x32_bf16 v[100:103], a[228:231], v[40:43], v[100:103]
  v_mfma_f32_16x16x32_bf16 v[112:115], a[232:235], v[40:43], v[112:115]
  v_mfma_f32_16x16x32_bf16 v[116:119], a[236:239], v[40:43], v[116:119]
  s_waitcnt lgkmcnt(5)
  v_mfma_f32_16x16x32_bf16 v[104:107], a[224:227], v[44:47], v[104:107]
  ds_read_b128 v[36:39], v11 offset:0
  v_mfma_f32_16x16x32_bf16 v[108:111], a[228:231], v[44:47], v[108:111]
  v_mfma_f32_16x16x32_bf16 v[120:123], a[232:235], v[44:47], v[120:123]
  v_mfma_f32_16x16x32_bf16 v[124:127], a[236:239], v[44:47], v[124:127]
  s_waitcnt lgkmcnt(5)
  v_mfma_f32_16x16x32_bf16 v[96:99], a[240:243], v[48:51], v[96:99]
  s_sub_u32 s23, s23, 1
  ds_read_b128 v[40:43], v12 offset:0
  v_mfma_f32_16x16x32_bf16 v[100:103], a[244:247], v[48:51], v[100:103]
  v_mfma_f32_16x16x32_bf16 v[112:115], a[248:251], v[48:51], v[112:115]
  v_mfma_f32_16x16x32_bf16 v[116:119], a[252:255], v[48:51], v[116:119]
  s_waitcnt lgkmcnt(5)
  v_mfma_f32_16x16x32_bf16 v[104:107], a[240:243], v[52:55], v[104:107]
  s_cmp_eq_u32 s23, 0
  ds_read_b128 v[44:47], v13 offset:0
  v_mfma_f32_16x16x32_bf16 v[108:111], a[244:247], v[52:55], v[108:111]
  v_mfma_f32_16x16x32_bf16 v[120:123], a[248:251], v[52:55], v[120:123]
  v_mfma_f32_16x16x32_bf16 v[124:127], a[252:255], v[52:55], v[124:127]
  s_cbranch_scc1 G_done1_221
  s_branch G_top_219
G_done0_220:
  s_nop 7
  s_nop 3
  v_cvt_pk_bf16_f32 v128, v64, v65
  v_cvt_pk_bf16_f32 v129, v66, v67
  v_cvt_pk_bf16_f32 v130, v68, v69
  v_cvt_pk_bf16_f32 v131, v70, v71
  buffer_store_dwordx4 v[128:131], v7, s[4:7], s21 offen offset:0 sc1
  v_cvt_pk_bf16_f32 v132, v72, v73
  v_cvt_pk_bf16_f32 v133, v74, v75
  v_cvt_pk_bf16_f32 v134, v76, v77
  v_cvt_pk_bf16_f32 v135, v78, v79
  buffer_store_dwordx4 v[132:135], v7, s[4:7], s21 offen offset:256 sc1
  v_cvt_pk_bf16_f32 v136, v80, v81
  v_cvt_pk_bf16_f32 v137, v82, v83
  v_cvt_pk_bf16_f32 v138, v84, v85
  v_cvt_pk_bf16_f32 v139, v86, v87
  buffer_store_dwordx4 v[136:139], v7, s[4:7], s21 offen offset:2048 sc1
  v_cvt_pk_bf16_f32 v140, v88, v89
  v_cvt_pk_bf16_f32 v141, v90, v91
  v_cvt_pk_bf16_f32 v142, v92, v93
  v_cvt_pk_bf16_f32 v143, v94, v95
  buffer_store_dwordx4 v[140:143], v7, s[4:7], s21 offen offset:2304 sc1
  s_branch G_fin_222
G_done1_221:
  s_nop 7
  s_nop 3
  v_cvt_pk_bf16_f32 v128, v96, v97
  v_cvt_pk_bf16_f32 v129, v98, v99
  v_cvt_pk_bf16_f32 v130, v100, v101
  v_cvt_pk_bf16_f32 v131, v102, v103
  buffer_store_dwordx4 v[128:131], v7, s[4:7], s21 offen offset:0 sc1
  v_cvt_pk_bf16_f32 v132, v104, v105
  v_cvt_pk_bf16_f32 v133, v106, v107
  v_cvt_pk_bf16_f32 v134, v108, v109
  v_cvt_pk_bf16_f32 v135, v110, v111
  buffer_store_dwordx4 v[132:135], v7, s[4:7], s21 offen offset:256 sc1
  v_cvt_pk_bf16_f32 v136, v112, v113
  v_cvt_pk_bf16_f32 v137, v114, v115
  v_cvt_pk_bf16_f32 v138, v116, v117
  v_cvt_pk_bf16_f32 v139, v118, v119
  buffer_store_dwordx4 v[136:139], v7, s[4:7], s21 offen offset:2048 sc1
  v_cvt_pk_bf16_f32 v140, v120, v121
  v_cvt_pk_bf16_f32 v141, v122, v123
  v_cvt_pk_bf16_f32 v142, v124, v125
  v_cvt_pk_bf16_f32 v143, v126, v127
  buffer_store_dwordx4 v[140:143], v7, s[4:7], s21 offen offset:2304 sc1
G_fin_222:
  s_waitcnt vmcnt(0) lgkmcnt(0)
  s_barrier
  s_waitcnt vmcnt(0)
  s_barrier
  s_mov_b32 s30, 768
  v_mov_b32 v144, s30
  v_min_u32 v145, 1, v0
  v_lshlrev_b32 v145, 30, v145
  buffer_store_dword v144, v145, s[4:7], s31 offen sc1
  s_mul_i32 s50, s64, 6
  s_add_u32 s50, s50, s65
  s_mul_i32 s76, s50, 21846
  s_lshr_b32 s76, s76, 16
  s_mul_i32 s77, s76, 3
  s_add_u32 s51, s50, 64
  s_cmp_eq_u32 s77, s50
  s_cselect_b32 s50, s76, s51
M_fin:
  s_lshr_b32 s48, s50, 2
  s_and_b32 s49, s50, 3
  s_load_dwordx2 s[8:9], s[0:1], 0
  s_load_dwordx2 s[12:13], s[0:1], 104
  s_load_dwordx2 s[32:33], s[0:1], 112
  v_and_b32 v4, 31, v1
  v_lshrrev_b32 v5, 5, v1
  v_lshlrev_b32 v5, 4, v5
  v_lshl_add_u32 v6, v4, 10, v5
  s_lshl_b32 s26, s16, 8
  s_lshl_b32 s27, s48, 15
  s_add_u32 s27, s27, s26
  s_waitcnt lgkmcnt(0)
  s_and_b32 s9, s9, 0xffff
  s_mov_b32 s10, 2097152
  s_mov_b32 s11, 0x20000
  s_and_b32 s13, s13, 0xffff
  s_mov_b32 s14, 1024
  s_mov_b32 s15, 0x20000
  s_and_b32 s33, s33, 0xffff
  s_mov_b32 s34, 2097152
  s_mov_b32 s35, 0x20000
  buffer_load_dwordx4 v[16:19], v6, s[8:11], s27 offen offset:0
  buffer_load_dwordx4 v[48:51], v5, s[12:15], s26 offen offset:0
  buffer_load_dwordx4 v[20:23], v6, s[8:11], s27 offen offset:32
  buffer_load_dwordx4 v[52:55], v5, s[12:15], s26 offen offset:32
  buffer_load_dwordx4 v[24:27], v6, s[8:11], s27 offen offset:64
  buffer_load_dwordx4 v[56:59], v5, s[12:15], s26 offen offset:64
  buffer_load_dwordx4 v[28:31], v6, s[8:11], s27 offen offset:96
  buffer_load_dwordx4 v[60:63], v5, s[12:15], s26 offen offset:96
  buffer_load_dwordx4 v[32:35], v6, s[8:11], s27 offen offset:128
  buffer_load_dwordx4 v[64:67], v5, s[12:15], s26 offen offset:128
  buffer_load_dwordx4 v[36:39], v6, s[8:11], s27 offen offset:160
  buffer_load_dwordx4 v[68:71], v5, s[12:15], s26 offen offset:160
  buffer_load_dwordx4 v[40:43], v6, s[8:11], s27 offen offset:192
  buffer_load_dwordx4 v[72:75], v5, s[12:15], s26 offen offset:192
  buffer_load_dwordx4 v[44:47], v6, s[8:11], s27 offen offset:224
  buffer_load_dwordx4 v[76:79], v5, s[12:15], s26 offen offset:224
  s_lshl_b32 s28, s48, 2
  s_add_u32 s28, s28, s49
  s_lshl_b32 s28, s28, 2
  s_add_u32 s28, s28, s16
  s_lshl_b32 s28, s28, 11
  s_waitcnt vmcnt(14)
  v_mfma_f32_32x32x16_bf16 v[80:95], v[48:51], v[16:19], 0
  s_waitcnt vmcnt(12)
  v_mfma_f32_32x32x16_bf16 v[80:95], v[52:55], v[20:23], v[80:95]
  s_waitcnt vmcnt(10)
  v_mfma_f32_32x32x16_bf16 v[80:95], v[56:59], v[24:27], v[80:95]
  s_waitcnt vmcnt(8)
  v_mfma_f32_32x32x16_bf16 v[80:95], v[60:63], v[28:31], v[80:95]
  s_waitcnt vmcnt(6)
  v_mfma_f32_32x32x16_bf16 v[80:95], v[64:67], v[32:35], v[80:95]
  s_waitcnt vmcnt(4)
  v_mfma_f32_32x32x16_bf16 v[80:95], v[68:71], v[36:39], v[80:95]
  s_waitcnt vmcnt(2)
  v_mfma_f32_32x32x16_bf16 v[80:95], v[72:75], v[40:43], v[80:95]
  s_waitcnt vmcnt(0)
  v_mfma_f32_32x32x16_bf16 v[80:95], v[76:79], v[44:47], v[80:95]
  s_mul_i32 s76, s48, 43
  s_lshr_b32 s76, s76, 9
  s_mul_i32 s76, s76, 12
  s_sub_u32 s76, s48, s76
  s_cmp_ge_u32 s76, 6
  s_addc_u32 s76, s76, 0
  s_and_b32 s77, s49, 2
  s_mul_i32 s77, s77, 7
  s_add_u32 s76, s76, s77
  v_mov_b32 v193, 0x300
  s_lshl_b32 s76, s76, 7
  s_add_u32 s76, s76, 148897792
  v_and_b32 v192, 7, v1
  v_mul_u32_u24 v192, 3584, v192
  v_add_u32 v192, s76, v192
  s_mov_b32 s71, 0
  s_branch M_vg_224
M_vw_223:
  s_sleep 2
  s_add_u32 s71, s71, 1
  s_cmp_gt_u32 s71, 262144
  s_cbranch_scc1 M_exit
M_vg_224:
  buffer_load_dword v194, v192, s[4:7], 0 offen sc1
  s_waitcnt vmcnt(0)
  v_cmp_lt_u32 vcc, v194, v193
  s_cbranch_vccnz M_vw_223
  s_add_u32 s29, s28, 150994944
  buffer_load_dwordx4 v[96:99], v2, s[4:7], s29 offen offset:0 sc1
  buffer_load_dwordx4 v[100:103], v2, s[4:7], s29 offen offset:1024 sc1
  s_add_u32 s29, s28, 153092096
  buffer_load_dwordx4 v[104:107], v2, s[4:7], s29 offen offset:0 sc1
  buffer_load_dwordx4 v[108:111], v2, s[4:7], s29 offen offset:1024 sc1
  s_add_u32 s29, s28, 155189248
  buffer_load_dwordx4 v[112:115], v2, s[4:7], s29 offen offset:0 sc1
  buffer_load_dwordx4 v[116:119], v2, s[4:7], s29 offen offset:1024 sc1
  s_add_u32 s29, s28, 157286400
  buffer_load_dwordx4 v[120:123], v2, s[4:7], s29 offen offset:0 sc1
  buffer_load_dwordx4 v[124:127], v2, s[4:7], s29 offen offset:1024 sc1
  s_add_u32 s29, s28, 159383552
  buffer_load_dwordx4 v[128:131], v2, s[4:7], s29 offen offset:0 sc1
  buffer_load_dwordx4 v[132:135], v2, s[4:7], s29 offen offset:1024 sc1
  s_add_u32 s29, s28, 161480704
  buffer_load_dwordx4 v[136:139], v2, s[4:7], s29 offen offset:0 sc1
  buffer_load_dwordx4 v[140:143], v2, s[4:7], s29 offen offset:1024 sc1
  s_add_u32 s29, s28, 163577856
  buffer_load_dwordx4 v[144:147], v2, s[4:7], s29 offen offset:0 sc1
  buffer_load_dwordx4 v[148:151], v2, s[4:7], s29 offen offset:1024 sc1
  s_add_u32 s29, s28, 165675008
  buffer_load_dwordx4 v[152:155], v2, s[4:7], s29 offen offset:0 sc1
  buffer_load_dwordx4 v[156:159], v2, s[4:7], s29 offen offset:1024 sc1
  v_lshlrev_b32 v7, 4, v4
  s_lshl_b32 s26, s16, 2
  v_add_u32 v4, s26, v7
  s_barrier
  ds_write_b32 v4, v80
  s_waitcnt lgkmcnt(0)
  s_barrier
  ds_read_b128 v[84:87], v7
  s_waitcnt lgkmcnt(0)
  v_add_f32 v80, v84, v85
  v_add_f32 v81, v86, v87
  v_add_f32 v80, v80, v81
  v_mul_f32 v80, 0xbfb8aa3b, v80
  v_exp_f32 v80, v80
  s_nop 0
  v_add_f32 v80, 1.0, v80
  v_rcp_f32 v80, v80
  s_nop 0
  v_sub_f32 v82, 1.0, v80
  s_waitcnt vmcnt(14)
  v_lshlrev_b32 v160, 16, v96
  v_and_b32 v161, 0xffff0000, v96
  v_lshlrev_b32 v162, 16, v97
  v_and_b32 v163, 0xffff0000, v97
  v_lshlrev_b32 v164, 16, v98
  v_and_b32 v165, 0xffff0000, v98
  v_lshlrev_b32 v166, 16, v99
  v_and_b32 v167, 0xffff0000, v99
  v_lshlrev_b32 v168, 16, v100
  v_and_b32 v169, 0xffff0000, v100
  v_lshlrev_b32 v170, 16, v101
  v_and_b32 v171, 0xffff0000, v101
  v_lshlrev_b32 v172, 16, v102
  v_and_b32 v173, 0xffff0000, v102
  v_lshlrev_b32 v174, 16, v103
  v_and_b32 v175, 0xffff0000, v103
  s_waitcnt vmcnt(12)
  v_lshlrev_b32 v8, 16, v104
  v_and_b32 v9, 0xffff0000, v104
  v_pk_add_f32 v[160:161], v[160:161], v[8:9]
  v_lshlrev_b32 v10, 16, v105
  v_and_b32 v11, 0xffff0000, v105
  v_pk_add_f32 v[162:163], v[162:163], v[10:11]
  v_lshlrev_b32 v12, 16, v106
  v_and_b32 v13, 0xffff0000, v106
  v_pk_add_f32 v[164:165], v[164:165], v[12:13]
  v_lshlrev_b32 v14, 16, v107
  v_and_b32 v15, 0xffff0000, v107
  v_pk_add_f32 v[166:167], v[166:167], v[14:15]
  v_lshlrev_b32 v8, 16, v108
  v_and_b32 v9, 0xffff0000, v108
  v_pk_add_f32 v[168:169], v[168:169], v[8:9]
  v_lshlrev_b32 v10, 16, v109
  v_and_b32 v11, 0xffff0000, v109
  v_pk_add_f32 v[170:171], v[170:171], v[10:11]
  v_lshlrev_b32 v12, 16, v110
  v_and_b32 v13, 0xffff0000, v110
  v_pk_add_f32 v[172:173], v[172:173], v[12:13]
  v_lshlrev_b32 v14, 16, v111
  v_and_b32 v15, 0xffff0000, v111
  v_pk_add_f32 v[174:175], v[174:175], v[14:15]
  s_waitcnt vmcnt(10)
  v_lshlrev_b32 v8, 16, v112
  v_and_b32 v9, 0xffff0000, v112
  v_pk_add_f32 v[160:161], v[160:161], v[8:9]
  v_lshlrev_b32 v10, 16, v113
  v_and_b32 v11, 0xffff0000, v113
  v_pk_add_f32 v[162:163], v[162:163], v[10:11]
  v_lshlrev_b32 v12, 16, v114
  v_and_b32 v13, 0xffff0000, v114
  v_pk_add_f32 v[164:165], v[164:165], v[12:13]
  v_lshlrev_b32 v14, 16, v115
  v_and_b32 v15, 0xffff0000, v115
  v_pk_add_f32 v[166:167], v[166:167], v[14:15]
  v_lshlrev_b32 v8, 16, v116
  v_and_b32 v9, 0xffff0000, v116
  v_pk_add_f32 v[168:169], v[168:169], v[8:9]
  v_lshlrev_b32 v10, 16, v117
  v_and_b32 v11, 0xffff0000, v117
  v_pk_add_f32 v[170:171], v[170:171], v[10:11]
  v_lshlrev_b32 v12, 16, v118
  v_and_b32 v13, 0xffff0000, v118
  v_pk_add_f32 v[172:173], v[172:173], v[12:13]
  v_lshlrev_b32 v14, 16, v119
  v_and_b32 v15, 0xffff0000, v119
  v_pk_add_f32 v[174:175], v[174:175], v[14:15]
  s_waitcnt vmcnt(8)
  v_lshlrev_b32 v8, 16, v120
  v_and_b32 v9, 0xffff0000, v120
  v_pk_add_f32 v[160:161], v[160:161], v[8:9]
  v_lshlrev_b32 v10, 16, v121
  v_and_b32 v11, 0xffff0000, v121
  v_pk_add_f32 v[162:163], v[162:163], v[10:11]
  v_lshlrev_b32 v12, 16, v122
  v_and_b32 v13, 0xffff0000, v122
  v_pk_add_f32 v[164:165], v[164:165], v[12:13]
  v_lshlrev_b32 v14, 16, v123
  v_and_b32 v15, 0xffff0000, v123
  v_pk_add_f32 v[166:167], v[166:167], v[14:15]
  v_lshlrev_b32 v8, 16, v124
  v_and_b32 v9, 0xffff0000, v124
  v_pk_add_f32 v[168:169], v[168:169], v[8:9]
  v_lshlrev_b32 v10, 16, v125
  v_and_b32 v11, 0xffff0000, v125
  v_pk_add_f32 v[170:171], v[170:171], v[10:11]
  v_lshlrev_b32 v12, 16, v126
  v_and_b32 v13, 0xffff0000, v126
  v_pk_add_f32 v[172:173], v[172:173], v[12:13]
  v_lshlrev_b32 v14, 16, v127
  v_and_b32 v15, 0xffff0000, v127
  v_pk_add_f32 v[174:175], v[174:175], v[14:15]
  s_waitcnt vmcnt(6)
  v_lshlrev_b32 v8, 16, v128
  v_and_b32 v9, 0xffff0000, v128
  v_pk_add_f32 v[160:161], v[160:161], v[8:9]
  v_lshlrev_b32 v10, 16, v129
  v_and_b32 v11, 0xffff0000, v129
  v_pk_add_f32 v[162:163], v[162:163], v[10:11]
  v_lshlrev_b32 v12, 16, v130
  v_and_b32 v13, 0xffff0000, v130
  v_pk_add_f32 v[164:165], v[164:165], v[12:13]
  v_lshlrev_b32 v14, 16, v131
  v_and_b32 v15, 0xffff0000, v131
  v_pk_add_f32 v[166:167], v[166:167], v[14:15]
  v_lshlrev_b32 v8, 16, v132
  v_and_b32 v9, 0xffff0000, v132
  v_pk_add_f32 v[168:169], v[168:169], v[8:9]
  v_lshlrev_b32 v10, 16, v133
  v_and_b32 v11, 0xffff0000, v133
  v_pk_add_f32 v[170:171], v[170:171], v[10:11]
  v_lshlrev_b32 v12, 16, v134
  v_and_b32 v13, 0xffff0000, v134
  v_pk_add_f32 v[172:173], v[172:173], v[12:13]
  v_lshlrev_b32 v14, 16, v135
  v_and_b32 v15, 0xffff0000, v135
  v_pk_add_f32 v[174:175], v[174:175], v[14:15]
  s_waitcnt vmcnt(4)
  v_lshlrev_b32 v8, 16, v136
  v_and_b32 v9, 0xffff0000, v136
  v_pk_add_f32 v[160:161], v[160:161], v[8:9]
  v_lshlrev_b32 v10, 16, v137
  v_and_b32 v11, 0xffff0000, v137
  v_pk_add_f32 v[162:163], v[162:163], v[10:11]
  v_lshlrev_b32 v12, 16, v138
  v_and_b32 v13, 0xffff0000, v138
  v_pk_add_f32 v[164:165], v[164:165], v[12:13]
  v_lshlrev_b32 v14, 16, v139
  v_and_b32 v15, 0xffff0000, v139
  v_pk_add_f32 v[166:167], v[166:167], v[14:15]
  v_lshlrev_b32 v8, 16, v140
  v_and_b32 v9, 0xffff0000, v140
  v_pk_add_f32 v[168:169], v[168:169], v[8:9]
  v_lshlrev_b32 v10, 16, v141
  v_and_b32 v11, 0xffff0000, v141
  v_pk_add_f32 v[170:171], v[170:171], v[10:11]
  v_lshlrev_b32 v12, 16, v142
  v_and_b32 v13, 0xffff0000, v142
  v_pk_add_f32 v[172:173], v[172:173], v[12:13]
  v_lshlrev_b32 v14, 16, v143
  v_and_b32 v15, 0xffff0000, v143
  v_pk_add_f32 v[174:175], v[174:175], v[14:15]
  s_waitcnt vmcnt(2)
  v_lshlrev_b32 v8, 16, v144
  v_and_b32 v9, 0xffff0000, v144
  v_pk_add_f32 v[160:161], v[160:161], v[8:9]
  v_lshlrev_b32 v10, 16, v145
  v_and_b32 v11, 0xffff0000, v145
  v_pk_add_f32 v[162:163], v[162:163], v[10:11]
  v_lshlrev_b32 v12, 16, v146
  v_and_b32 v13, 0xffff0000, v146
  v_pk_add_f32 v[164:165], v[164:165], v[12:13]
  v_lshlrev_b32 v14, 16, v147
  v_and_b32 v15, 0xffff0000, v147
  v_pk_add_f32 v[166:167], v[166:167], v[14:15]
  v_lshlrev_b32 v8, 16, v148
  v_and_b32 v9, 0xffff0000, v148
  v_pk_add_f32 v[168:169], v[168:169], v[8:9]
  v_lshlrev_b32 v10, 16, v149
  v_and_b32 v11, 0xffff0000, v149
  v_pk_add_f32 v[170:171], v[170:171], v[10:11]
  v_lshlrev_b32 v12, 16, v150
  v_and_b32 v13, 0xffff0000, v150
  v_pk_add_f32 v[172:173], v[172:173], v[12:13]
  v_lshlrev_b32 v14, 16, v151
  v_and_b32 v15, 0xffff0000, v151
  v_pk_add_f32 v[174:175], v[174:175], v[14:15]
  s_waitcnt vmcnt(0)
  v_lshlrev_b32 v8, 16, v152
  v_and_b32 v9, 0xffff0000, v152
  v_pk_add_f32 v[160:161], v[160:161], v[8:9]
  v_lshlrev_b32 v10, 16, v153
  v_and_b32 v11, 0xffff0000, v153
  v_pk_add_f32 v[162:163], v[162:163], v[10:11]
  v_lshlrev_b32 v12, 16, v154
  v_and_b32 v13, 0xffff0000, v154
  v_pk_add_f32 v[164:165], v[164:165], v[12:13]
  v_lshlrev_b32 v14, 16, v155
  v_and_b32 v15, 0xffff0000, v155
  v_pk_add_f32 v[166:167], v[166:167], v[14:15]
  v_lshlrev_b32 v8, 16, v156
  v_and_b32 v9, 0xffff0000, v156
  v_pk_add_f32 v[168:169], v[168:169], v[8:9]
  v_lshlrev_b32 v10, 16, v157
  v_and_b32 v11, 0xffff0000, v157
  v_pk_add_f32 v[170:171], v[170:171], v[10:11]
  v_lshlrev_b32 v12, 16, v158
  v_and_b32 v13, 0xffff0000, v158
  v_pk_add_f32 v[172:173], v[172:173], v[12:13]
  v_lshlrev_b32 v14, 16, v159
  v_and_b32 v15, 0xffff0000, v159
  v_pk_add_f32 v[174:175], v[174:175], v[14:15]
  s_and_b32 s76, s48, 1
  s_lshl_b32 s76, s76, 1
  s_lshr_b32 s77, s49, 1
  s_add_u32 s76, s76, s77
  s_mul_i32 s76, s76, 7
  s_add_u32 s76, s76, 6
  s_lshr_b32 s77, s48, 1
  s_add_u32 s77, s77, 0x201
  v_mov_b32 v193, s77
  s_lshl_b32 s76, s76, 7
  s_add_u32 s76, s76, 148897792
  v_and_b32 v192, 7, v1
  v_mul_u32_u24 v192, 3584, v192
  v_add_u32 v192, s76, v192
  s_mov_b32 s71, 0
  s_branch M_vg_226
M_vw_225:
  s_sleep 2
  s_add_u32 s71, s71, 1
  s_cmp_gt_u32 s71, 262144
  s_cbranch_scc1 M_exit
M_vg_226:
  buffer_load_dword v194, v192, s[4:7], 0 offen sc1
  s_waitcnt vmcnt(0)
  v_cmp_lt_u32 vcc, v194, v193
  s_cbranch_vccnz M_vw_225
  s_add_u32 s29, s28, 167772160
  buffer_load_dwordx4 v[96:99], v2, s[4:7], s29 offen offset:0 sc1
  buffer_load_dwordx4 v[100:103], v2, s[4:7], s29 offen offset:1024 sc1
  s_add_u32 s29, s28, 169869312
  buffer_load_dwordx4 v[104:107], v2, s[4:7], s29 offen offset:0 sc1
  buffer_load_dwordx4 v[108:111], v2, s[4:7], s29 offen offset:1024 sc1
  s_add_u32 s29, s28, 171966464
  buffer_load_dwordx4 v[112:115], v2, s[4:7], s29 offen offset:0 sc1
  buffer_load_dwordx4 v[116:119], v2, s[4:7], s29 offen offset:1024 sc1
  s_add_u32 s29, s28, 174063616
  buffer_load_dwordx4 v[120:123], v2, s[4:7], s29 offen offset:0 sc1
  buffer_load_dwordx4 v[124:127], v2, s[4:7], s29 offen offset:1024 sc1
  s_add_u32 s29, s28, 176160768
  buffer_load_dwordx4 v[128:131], v2, s[4:7], s29 offen offset:0 sc1
  buffer_load_dwordx4 v[132:135], v2, s[4:7], s29 offen offset:1024 sc1
  s_add_u32 s29, s28, 178257920
  buffer_load_dwordx4 v[136:139], v2, s[4:7], s29 offen offset:0 sc1
  buffer_load_dwordx4 v[140:143], v2, s[4:7], s29 offen offset:1024 sc1
  s_add_u32 s29, s28, 180355072
  buffer_load_dwordx4 v[144:147], v2, s[4:7], s29 offen offset:0 sc1
  buffer_load_dwordx4 v[148:151], v2, s[4:7], s29 offen offset:1024 sc1
  s_add_u32 s29, s28, 182452224
  buffer_load_dwordx4 v[152:155], v2, s[4:7], s29 offen offset:0 sc1
  buffer_load_dwordx4 v[156:159], v2, s[4:7], s29 offen offset:1024 sc1
  v_pk_mul_f32 v[160:161], v[160:161], v[80:81] op_sel_hi:[1,0]
  v_pk_mul_f32 v[162:163], v[162:163], v[80:81] op_sel_hi:[1,0]
  v_pk_mul_f32 v[164:165], v[164:165], v[80:81] op_sel_hi:[1,0]
  v_pk_mul_f32 v[166:167], v[166:167], v[80:81] op_sel_hi:[1,0]
  v_pk_mul_f32 v[168:169], v[168:169], v[80:81] op_sel_hi:[1,0]
  v_pk_mul_f32 v[170:171], v[170:171], v[80:81] op_sel_hi:[1,0]
  v_pk_mul_f32 v[172:173], v[172:173], v[80:81] op_sel_hi:[1,0]
  v_pk_mul_f32 v[174:175], v[174:175], v[80:81] op_sel_hi:[1,0]
  s_waitcnt vmcnt(14)
  v_lshlrev_b32 v176, 16, v96
  v_and_b32 v177, 0xffff0000, v96
  v_lshlrev_b32 v178, 16, v97
  v_and_b32 v179, 0xffff0000, v97
  v_lshlrev_b32 v180, 16, v98
  v_and_b32 v181, 0xffff0000, v98
  v_lshlrev_b32 v182, 16, v99
  v_and_b32 v183, 0xffff0000, v99
  v_lshlrev_b32 v184, 16, v100
  v_and_b32 v185, 0xffff0000, v100
  v_lshlrev_b32 v186, 16, v101
  v_and_b32 v187, 0xffff0000, v101
  v_lshlrev_b32 v188, 16, v102
  v_and_b32 v189, 0xffff0000, v102
  v_lshlrev_b32 v190, 16, v103
  v_and_b32 v191, 0xffff0000, v103
  s_waitcnt vmcnt(12)
  v_lshlrev_b32 v8, 16, v104
  v_and_b32 v9, 0xffff0000, v104
  v_pk_add_f32 v[176:177], v[176:177], v[8:9]
  v_lshlrev_b32 v10, 16, v105
  v_and_b32 v11, 0xffff0000, v105
  v_pk_add_f32 v[178:179], v[178:179], v[10:11]
  v_lshlrev_b32 v12, 16, v106
  v_and_b32 v13, 0xffff0000, v106
  v_pk_add_f32 v[180:181], v[180:181], v[12:13]
  v_lshlrev_b32 v14, 16, v107
  v_and_b32 v15, 0xffff0000, v107
  v_pk_add_f32 v[182:183], v[182:183], v[14:15]
  v_lshlrev_b32 v8, 16, v108
  v_and_b32 v9, 0xffff0000, v108
  v_pk_add_f32 v[184:185], v[184:185], v[8:9]
  v_lshlrev_b32 v10, 16, v109
  v_and_b32 v11, 0xffff0000, v109
  v_pk_add_f32 v[186:187], v[186:187], v[10:11]
  v_lshlrev_b32 v12, 16, v110
  v_and_b32 v13, 0xffff0000, v110
  v_pk_add_f32 v[188:189], v[188:189], v[12:13]
  v_lshlrev_b32 v14, 16, v111
  v_and_b32 v15, 0xffff0000, v111
  v_pk_add_f32 v[190:191], v[190:191], v[14:15]
  s_waitcnt vmcnt(10)
  v_lshlrev_b32 v8, 16, v112
  v_and_b32 v9, 0xffff0000, v112
  v_pk_add_f32 v[176:177], v[176:177], v[8:9]
  v_lshlrev_b32 v10, 16, v113
  v_and_b32 v11, 0xffff0000, v113
  v_pk_add_f32 v[178:179], v[178:179], v[10:11]
  v_lshlrev_b32 v12, 16, v114
  v_and_b32 v13, 0xffff0000, v114
  v_pk_add_f32 v[180:181], v[180:181], v[12:13]
  v_lshlrev_b32 v14, 16, v115
  v_and_b32 v15, 0xffff0000, v115
  v_pk_add_f32 v[182:183], v[182:183], v[14:15]
  v_lshlrev_b32 v8, 16, v116
  v_and_b32 v9, 0xffff0000, v116
  v_pk_add_f32 v[184:185], v[184:185], v[8:9]
  v_lshlrev_b32 v10, 16, v117
  v_and_b32 v11, 0xffff0000, v117
  v_pk_add_f32 v[186:187], v[186:187], v[10:11]
  v_lshlrev_b32 v12, 16, v118
  v_and_b32 v13, 0xffff0000, v118
  v_pk_add_f32 v[188:189], v[188:189], v[12:13]
  v_lshlrev_b32 v14, 16, v119
  v_and_b32 v15, 0xffff0000, v119
  v_pk_add_f32 v[190:191], v[190:191], v[14:15]
  s_waitcnt vmcnt(8)
  v_lshlrev_b32 v8, 16, v120
  v_and_b32 v9, 0xffff0000, v120
  v_pk_add_f32 v[176:177], v[176:177], v[8:9]
  v_lshlrev_b32 v10, 16, v121
  v_and_b32 v11, 0xffff0000, v121
  v_pk_add_f32 v[178:179], v[178:179], v[10:11]
  v_lshlrev_b32 v12, 16, v122
  v_and_b32 v13, 0xffff0000, v122
  v_pk_add_f32 v[180:181], v[180:181], v[12:13]
  v_lshlrev_b32 v14, 16, v123
  v_and_b32 v15, 0xffff0000, v123
  v_pk_add_f32 v[182:183], v[182:183], v[14:15]
  v_lshlrev_b32 v8, 16, v124
  v_and_b32 v9, 0xffff0000, v124
  v_pk_add_f32 v[184:185], v[184:185], v[8:9]
  v_lshlrev_b32 v10, 16, v125
  v_and_b32 v11, 0xffff0000, v125
  v_pk_add_f32 v[186:187], v[186:187], v[10:11]
  v_lshlrev_b32 v12, 16, v126
  v_and_b32 v13, 0xffff0000, v126
  v_pk_add_f32 v[188:189], v[188:189], v[12:13]
  v_lshlrev_b32 v14, 16, v127
  v_and_b32 v15, 0xffff0000, v127
  v_pk_add_f32 v[190:191], v[190:191], v[14:15]
  s_waitcnt vmcnt(6)
  v_lshlrev_b32 v8, 16, v128
  v_and_b32 v9, 0xffff0000, v128
  v_pk_add_f32 v[176:177], v[176:177], v[8:9]
  v_lshlrev_b32 v10, 16, v129
  v_and_b32 v11, 0xffff0000, v129
  v_pk_add_f32 v[178:179], v[178:179], v[10:11]
  v_lshlrev_b32 v12, 16, v130
  v_and_b32 v13, 0xffff0000, v130
  v_pk_add_f32 v[180:181], v[180:181], v[12:13]
  v_lshlrev_b32 v14, 16, v131
  v_and_b32 v15, 0xffff0000, v131
  v_pk_add_f32 v[182:183], v[182:183], v[14:15]
  v_lshlrev_b32 v8, 16, v132
  v_and_b32 v9, 0xffff0000, v132
  v_pk_add_f32 v[184:185], v[184:185], v[8:9]
  v_lshlrev_b32 v10, 16, v133
  v_and_b32 v11, 0xffff0000, v133
  v_pk_add_f32 v[186:187], v[186:187], v[10:11]
  v_lshlrev_b32 v12, 16, v134
  v_and_b32 v13, 0xffff0000, v134
  v_pk_add_f32 v[188:189], v[188:189], v[12:13]
  v_lshlrev_b32 v14, 16, v135
  v_and_b32 v15, 0xffff0000, v135
  v_pk_add_f32 v[190:191], v[190:191], v[14:15]
  s_waitcnt vmcnt(4)
  v_lshlrev_b32 v8, 16, v136
  v_and_b32 v9, 0xffff0000, v136
  v_pk_add_f32 v[176:177], v[176:177], v[8:9]
  v_lshlrev_b32 v10, 16, v137
  v_and_b32 v11, 0xffff0000, v137
  v_pk_add_f32 v[178:179], v[178:179], v[10:11]
  v_lshlrev_b32 v12, 16, v138
  v_and_b32 v13, 0xffff0000, v138
  v_pk_add_f32 v[180:181], v[180:181], v[12:13]
  v_lshlrev_b32 v14, 16, v139
  v_and_b32 v15, 0xffff0000, v139
  v_pk_add_f32 v[182:183], v[182:183], v[14:15]
  v_lshlrev_b32 v8, 16, v140
  v_and_b32 v9, 0xffff0000, v140
  v_pk_add_f32 v[184:185], v[184:185], v[8:9]
  v_lshlrev_b32 v10, 16, v141
  v_and_b32 v11, 0xffff0000, v141
  v_pk_add_f32 v[186:187], v[186:187], v[10:11]
  v_lshlrev_b32 v12, 16, v142
  v_and_b32 v13, 0xffff0000, v142
  v_pk_add_f32 v[188:189], v[188:189], v[12:13]
  v_lshlrev_b32 v14, 16, v143
  v_and_b32 v15, 0xffff0000, v143
  v_pk_add_f32 v[190:191], v[190:191], v[14:15]
  s_waitcnt vmcnt(2)
  v_lshlrev_b32 v8, 16, v144
  v_and_b32 v9, 0xffff0000, v144
  v_pk_add_f32 v[176:177], v[176:177], v[8:9]
  v_lshlrev_b32 v10, 16, v145
  v_and_b32 v11, 0xffff0000, v145
  v_pk_add_f32 v[178:179], v[178:179], v[10:11]
  v_lshlrev_b32 v12, 16, v146
  v_and_b32 v13, 0xffff0000, v146
  v_pk_add_f32 v[180:181], v[180:181], v[12:13]
  v_lshlrev_b32 v14, 16, v147
  v_and_b32 v15, 0xffff0000, v147
  v_pk_add_f32 v[182:183], v[182:183], v[14:15]
  v_lshlrev_b32 v8, 16, v148
  v_and_b32 v9, 0xffff0000, v148
  v_pk_add_f32 v[184:185], v[184:185], v[8:9]
  v_lshlrev_b32 v10, 16, v149
  v_and_b32 v11, 0xffff0000, v149
  v_pk_add_f32 v[186:187], v[186:187], v[10:11]
  v_lshlrev_b32 v12, 16, v150
  v_and_b32 v13, 0xffff0000, v150
  v_pk_add_f32 v[188:189], v[188:189], v[12:13]
  v_lshlrev_b32 v14, 16, v151
  v_and_b32 v15, 0xffff0000, v151
  v_pk_add_f32 v[190:191], v[190:191], v[14:15]
  s_waitcnt vmcnt(0)
  v_lshlrev_b32 v8, 16, v152
  v_and_b32 v9, 0xffff0000, v152
  v_pk_add_f32 v[176:177], v[176:177], v[8:9]
  v_lshlrev_b32 v10, 16, v153
  v_and_b32 v11, 0xffff0000, v153
  v_pk_add_f32 v[178:179], v[178:179], v[10:11]
  v_lshlrev_b32 v12, 16, v154
  v_and_b32 v13, 0xffff0000, v154
  v_pk_add_f32 v[180:181], v[180:181], v[12:13]
  v_lshlrev_b32 v14, 16, v155
  v_and_b32 v15, 0xffff0000, v155
  v_pk_add_f32 v[182:183], v[182:183], v[14:15]
  v_lshlrev_b32 v8, 16, v156
  v_and_b32 v9, 0xffff0000, v156
  v_pk_add_f32 v[184:185], v[184:185], v[8:9]
  v_lshlrev_b32 v10, 16, v157
  v_and_b32 v11, 0xffff0000, v157
  v_pk_add_f32 v[186:187], v[186:187], v[10:11]
  v_lshlrev_b32 v12, 16, v158
  v_and_b32 v13, 0xffff0000, v158
  v_pk_add_f32 v[188:189], v[188:189], v[12:13]
  v_lshlrev_b32 v14, 16, v159
  v_and_b32 v15, 0xffff0000, v159
  v_pk_add_f32 v[190:191], v[190:191], v[14:15]
  v_pk_fma_f32 v[160:161], v[176:177], v[82:83], v[160:161] op_sel_hi:[1,0,1]
  v_cvt_pk_bf16_f32 v16, v160, v161
  v_pk_fma_f32 v[162:163], v[178:179], v[82:83], v[162:163] op_sel_hi:[1,0,1]
  v_cvt_pk_bf16_f32 v17, v162, v163
  v_pk_fma_f32 v[164:165], v[180:181], v[82:83], v[164:165] op_sel_hi:[1,0,1]
  v_cvt_pk_bf16_f32 v18, v164, v165
  v_pk_fma_f32 v[166:167], v[182:183], v[82:83], v[166:167] op_sel_hi:[1,0,1]
  v_cvt_pk_bf16_f32 v19, v166, v167
  v_pk_fma_f32 v[168:169], v[184:185], v[82:83], v[168:169] op_sel_hi:[1,0,1]
  v_cvt_pk_bf16_f32 v20, v168, v169
  v_pk_fma_f32 v[170:171], v[186:187], v[82:83], v[170:171] op_sel_hi:[1,0,1]
  v_cvt_pk_bf16_f32 v21, v170, v171
  v_pk_fma_f32 v[172:173], v[188:189], v[82:83], v[172:173] op_sel_hi:[1,0,1]
  v_cvt_pk_bf16_f32 v22, v172, v173
  v_pk_fma_f32 v[174:175], v[190:191], v[82:83], v[174:175] op_sel_hi:[1,0,1]
  v_cvt_pk_bf16_f32 v23, v174, v175
  s_lshl_b32 s26, s49, 2
  s_add_u32 s26, s26, s16
  s_lshl_b32 s26, s26, 6
  s_lshl_b32 s27, s48, 15
  s_add_u32 s26, s26, s27
  buffer_store_dwordx4 v[16:19], v6, s[32:35], s26 offen offset:0
  buffer_store_dwordx4 v[20:23], v6, s[32:35], s26 offen offset:32
  s_cmp_lt_u32 s50, 64
  s_mov_b32 s50, s51
  s_cbranch_scc1 M_fin
  s_branch M_done
M_follow:
  s_lshr_b32 s48, s64, 2
  s_and_b32 s49, s64, 1
  s_bfe_u32 s50, s64, 0x10001
  s_mov_b32 s51, 2
  s_mov_b32 s23, 32
  s_load_dwordx2 s[8:9], s[0:1], 88
  s_lshl_b32 s17, s48, 19
  s_lshl_b32 s26, s49, 2
  s_add_u32 s26, s26, s16
  s_lshl_b32 s27, s26, 7
  s_add_u32 s17, s17, s27
  s_mov_b32 s18, 1024
  s_lshl_b32 s21, s48, 6
  s_add_u32 s21, s21, s50
  s_lshl_b32 s21, s21, 3
  s_add_u32 s21, s21, s26
  s_lshl_b32 s21, s21, 12
  s_add_u32 s21, s21, 167772160
  s_lshl_b32 s22, s51, 15
  s_mov_b32 s24, 1.0
  s_waitcnt lgkmcnt(0)
  s_and_b32 s9, s9, 0xffff
  s_mov_b32 s10, 4194304
  s_mov_b32 s11, 0x20000
  v_lshrrev_b32 v144, 4, v1
  v_and_b32 v56, 0xff, v2
  v_lshl_add_u32 v56, v144, 9, v56
  s_mul_i32 s26, s16, 0
  v_add_u32 v8, 0, v56
  v_add_u32 v16, 0, v2
  v_add_u32 v16, s26, v16
  v_add_u32 v9, 256, v56
  v_add_u32 v17, 1024, v2
  v_add_u32 v17, s26, v17
  v_add_u32 v10, 2048, v56
  v_add_u32 v18, 2048, v2
  v_add_u32 v18, s26, v18
  v_add_u32 v11, 2304, v56
  v_add_u32 v19, 3072, v2
  v_add_u32 v19, s26, v19
  v_add_u32 v12, 4096, v56
  v_add_u32 v20, 4096, v2
  v_add_u32 v20, s26, v20
  v_add_u32 v13, 4352, v56
  v_add_u32 v21, 5120, v2
  v_add_u32 v21, s26, v21
  v_add_u32 v14, 6144, v56
  v_add_u32 v22, 6144, v2
  v_add_u32 v22, s26, v22
  v_add_u32 v15, 6400, v56
  v_add_u32 v23, 7168, v2
  v_add_u32 v23, s26, v23
  v_mov_b32 v20, v56
  v_lshrrev_b32 v144, 3, v1
  v_mul_lo_u32 v144, v144, s18
  v_and_b32 v145, 7, v1
  v_lshl_add_u32 v144, v145, 4, v144
  s_lshl_b32 s28, s16, 15
  s_add_u32 s28, s28, 32768
  s_lshl_b32 s29, s18, 3
  s_add_u32 m0, s28, 0
  s_nop 0
  buffer_load_dwordx4 v144, s[8:11], s17 offen lds
  s_add_u32 s17, s17, s29
  s_add_u32 m0, s28, 1024
  s_nop 0
  buffer_load_dwordx4 v144, s[8:11], s17 offen lds
  s_add_u32 s17, s17, s29
  s_add_u32 m0, s28, 2048
  s_nop 0
  buffer_load_dwordx4 v144, s[8:11], s17 offen lds
  s_add_u32 s17, s17, s29
  s_add_u32 m0, s28, 3072
  s_nop 0
  buffer_load_dwordx4 v144, s[8:11], s17 offen lds
  s_add_u32 s17, s17, s29
  s_add_u32 m0, s28, 4096
  s_nop 0
  buffer_load_dwordx4 v144, s[8:11], s17 offen lds
  s_add_u32 s17, s17, s29
  s_add_u32 m0, s28, 5120
  s_nop 0
  buffer_load_dwordx4 v144, s[8:11], s17 offen lds
  s_add_u32 s17, s17, s29
  s_add_u32 m0, s28, 6144
  s_nop 0
  buffer_load_dwordx4 v144, s[8:11], s17 offen lds
  s_add_u32 s17, s17, s29
  s_add_u32 m0, s28, 7168
  s_nop 0
  buffer_load_dwordx4 v144, s[8:11], s17 offen lds
  s_add_u32 s17, s17, s29
  s_add_u32 m0, s28, 8192
  s_nop 0
  buffer_load_dwordx4 v144, s[8:11], s17 offen lds
  s_add_u32 s17, s17, s29
  s_add_u32 m0, s28, 9216
  s_nop 0
  buffer_load_dwordx4 v144, s[8:11], s17 offen lds
  s_add_u32 s17, s17, s29
  s_add_u32 m0, s28, 10240
  s_nop 0
  buffer_load_dwordx4 v144, s[8:11], s17 offen lds
  s_add_u32 s17, s17, s29
  s_add_u32 m0, s28, 11264
  s_nop 0
  buffer_load_dwordx4 v144, s[8:11], s17 offen lds
  s_add_u32 s17, s17, s29
  s_add_u32 m0, s28, 12288
  s_nop 0
  buffer_load_dwordx4 v144, s[8:11], s17 offen lds
  s_add_u32 s17, s17, s29
  s_add_u32 m0, s28, 13312
  s_nop 0
  buffer_load_dwordx4 v144, s[8:11], s17 offen lds
  s_add_u32 s17, s17, s29
  s_add_u32 m0, s28, 14336
  s_nop 0
  buffer_load_dwordx4 v144, s[8:11], s17 offen lds
  s_add_u32 s17, s17, s29
  s_add_u32 m0, s28, 15360
  s_nop 0
  buffer_load_dwordx4 v144, s[8:11], s17 offen lds
  s_add_u32 s17, s17, s29
  s_add_u32 m0, s28, 16384
  s_nop 0
  buffer_load_dwordx4 v144, s[8:11], s17 offen lds
  s_add_u32 s17, s17, s29
  s_add_u32 m0, s28, 17408
  s_nop 0
  buffer_load_dwordx4 v144, s[8:11], s17 offen lds
  s_add_u32 s17, s17, s29
  s_add_u32 m0, s28, 18432
  s_nop 0
  buffer_load_dwordx4 v144, s[8:11], s17 offen lds
  s_add_u32 s17, s17, s29
  s_add_u32 m0, s28, 19456
  s_nop 0
  buffer_load_dwordx4 v144, s[8:11], s17 offen lds
  s_add_u32 s17, s17, s29
  s_add_u32 m0, s28, 20480
  s_nop 0
  buffer_load_dwordx4 v144, s[8:11], s17 offen lds
  s_add_u32 s17, s17, s29
  s_add_u32 m0, s28, 21504
  s_nop 0
  buffer_load_dwordx4 v144, s[8:11], s17 offen lds
  s_add_u32 s17, s17, s29
  s_add_u32 m0, s28, 22528
  s_nop 0
  buffer_load_dwordx4 v144, s[8:11], s17 offen lds
  s_add_u32 s17, s17, s29
  s_add_u32 m0, s28, 23552
  s_nop 0
  buffer_load_dwordx4 v144, s[8:11], s17 offen lds
  s_add_u32 s17, s17, s29
  s_add_u32 m0, s28, 24576
  s_nop 0
  buffer_load_dwordx4 v144, s[8:11], s17 offen lds
  s_add_u32 s17, s17, s29
  s_add_u32 m0, s28, 25600
  s_nop 0
  buffer_load_dwordx4 v144, s[8:11], s17 offen lds
  s_add_u32 s17, s17, s29
  s_add_u32 m0, s28, 26624
  s_nop 0
  buffer_load_dwordx4 v144, s[8:11], s17 offen lds
  s_add_u32 s17, s17, s29
  s_add_u32 m0, s28, 27648
  s_nop 0
  buffer_load_dwordx4 v144, s[8:11], s17 offen lds
  s_add_u32 s17, s17, s29
  s_add_u32 m0, s28, 28672
  s_nop 0
  buffer_load_dwordx4 v144, s[8:11], s17 offen lds
  s_add_u32 s17, s17, s29
  s_add_u32 m0, s28, 29696
  s_nop 0
  buffer_load_dwordx4 v144, s[8:11], s17 offen lds
  s_add_u32 s17, s17, s29
  s_add_u32 m0, s28, 30720
  s_nop 0
  buffer_load_dwordx4 v144, s[8:11], s17 offen lds
  s_add_u32 s17, s17, s29
  s_add_u32 m0, s28, 31744
  s_nop 0
  buffer_load_dwordx4 v144, s[8:11], s17 offen lds
  s_add_u32 s17, s17, s29
  v_bfe_u32 v148, v1, 2, 2
  v_lshrrev_b32 v149, 5, v1
  v_lshl_add_u32 v148, v149, 4, v148
  v_bfe_u32 v149, v1, 4, 1
  v_lshl_add_u32 v148, v149, 2, v148
  v_and_b32 v149, 3, v1
  v_lshlrev_b32 v149, 4, v149
  s_mov_b32 s26, 8
  v_lshl_add_u32 v148, v148, 7, v149
  v_add_u32 v152, s28, v148
  v_add_u32 v153, 1024, v152
  v_add_u32 v154, s26, v152
  v_add_u32 v155, s26, v153
  s_waitcnt vmcnt(28)
  ds_read_b64_tr_b16 a[0:1], v152 offset:0
  ds_read_b64_tr_b16 a[2:3], v153 offset:0
  ds_read_b64_tr_b16 a[4:5], v154 offset:0
  ds_read_b64_tr_b16 a[6:7], v155 offset:0
  ds_read_b64_tr_b16 a[8:9], v152 offset:64
  ds_read_b64_tr_b16 a[10:11], v153 offset:64
  ds_read_b64_tr_b16 a[12:13], v154 offset:64
  ds_read_b64_tr_b16 a[14:15], v155 offset:64
  s_waitcnt lgkmcnt(0)
  s_add_u32 m0, s28, 0
  s_nop 0
  buffer_load_dwordx4 v144, s[8:11], s17 offen lds
  s_add_u32 s17, s17, s29
  s_add_u32 m0, s28, 1024
  s_nop 0
  buffer_load_dwordx4 v144, s[8:11], s17 offen lds
  s_add_u32 s17, s17, s29
  s_add_u32 m0, s28, 2048
  s_nop 0
  buffer_load_dwordx4 v144, s[8:11], s17 offen lds
  s_add_u32 s17, s17, s29
  s_add_u32 m0, s28, 3072
  s_nop 0
  buffer_load_dwordx4 v144, s[8:11], s17 offen lds
  s_add_u32 s17, s17, s29
  s_waitcnt vmcnt(28)
  ds_read_b64_tr_b16 a[16:17], v152 offset:4096
  ds_read_b64_tr_b16 a[18:19], v153 offset:4096
  ds_read_b64_tr_b16 a[20:21], v154 offset:4096
  ds_read_b64_tr_b16 a[22:23], v155 offset:4096
  ds_read_b64_tr_b16 a[24:25], v152 offset:4160
  ds_read_b64_tr_b16 a[26:27], v153 offset:4160
  ds_read_b64_tr_b16 a[28:29], v154 offset:4160
  ds_read_b64_tr_b16 a[30:31], v155 offset:4160
  s_waitcnt lgkmcnt(0)
  s_add_u32 m0, s28, 4096
  s_nop 0
  buffer_load_dwordx4 v144, s[8:11], s17 offen lds
  s_add_u32 s17, s17, s29
  s_add_u32 m0, s28, 5120
  s_nop 0
  buffer_load_dwordx4 v144, s[8:11], s17 offen lds
  s_add_u32 s17, s17, s29
  s_add_u32 m0, s28, 6144
  s_nop 0
  buffer_load_dwordx4 v144, s[8:11], s17 offen lds
  s_add_u32 s17, s17, s29
  s_add_u32 m0, s28, 7168
  s_nop 0
  buffer_load_dwordx4 v144, s[8:11], s17 offen lds
  s_add_u32 s17, s17, s29
  s_waitcnt vmcnt(28)
  ds_read_b64_tr_b16 a[32:33], v152 offset:8192
  ds_read_b64_tr_b16 a[34:35], v153 offset:8192
  ds_read_b64_tr_b16 a[36:37], v154 offset:8192
  ds_read_b64_tr_b16 a[38:39], v155 offset:8192
  ds_read_b64_tr_b16 a[40:41], v152 offset:8256
  ds_read_b64_tr_b16 a[42:43], v153 offset:8256
  ds_read_b64_tr_b16 a[44:45], v154 offset:8256
  ds_read_b64_tr_b16 a[46:47], v155 offset:8256
  s_waitcnt lgkmcnt(0)
  s_add_u32 m0, s28, 8192
  s_nop 0
  buffer_load_dwordx4 v144, s[8:11], s17 offen lds
  s_add_u32 s17, s17, s29
  s_add_u32 m0, s28, 9216
  s_nop 0
  buffer_load_dwordx4 v144, s[8:11], s17 offen lds
  s_add_u32 s17, s17, s29
  s_add_u32 m0, s28, 10240
  s_nop 0
  buffer_load_dwordx4 v144, s[8:11], s17 offen lds
  s_add_u32 s17, s17, s29
  s_add_u32 m0, s28, 11264
  s_nop 0
  buffer_load_dwordx4 v144, s[8:11], s17 offen lds
  s_add_u32 s17, s17, s29
  s_waitcnt vmcnt(28)
  ds_read_b64_tr_b16 a[48:49], v152 offset:12288
  ds_read_b64_tr_b16 a[50:51], v153 offset:12288
  ds_read_b64_tr_b16 a[52:53], v154 offset:12288
  ds_read_b64_tr_b16 a[54:55], v155 offset:12288
  ds_read_b64_tr_b16 a[56:57], v152 offset:12352
  ds_read_b64_tr_b16 a[58:59], v153 offset:12352
  ds_read_b64_tr_b16 a[60:61], v154 offset:12352
  ds_read_b64_tr_b16 a[62:63], v155 offset:12352
  s_waitcnt lgkmcnt(0)
  s_add_u32 m0, s28, 12288
  s_nop 0
  buffer_load_dwordx4 v144, s[8:11], s17 offen lds
  s_add_u32 s17, s17, s29
  s_add_u32 m0, s28, 13312
  s_nop 0
  buffer_load_dwordx4 v144, s[8:11], s17 offen lds
  s_add_u32 s17, s17, s29
  s_add_u32 m0, s28, 14336
  s_nop 0
  buffer_load_dwordx4 v144, s[8:11], s17 offen lds
  s_add_u32 s17, s17, s29
  s_add_u32 m0, s28, 15360
  s_nop 0
  buffer_load_dwordx4 v144, s[8:11], s17 offen lds
  s_add_u32 s17, s17, s29
  s_waitcnt vmcnt(28)
  ds_read_b64_tr_b16 a[64:65], v152 offset:16384
  ds_read_b64_tr_b16 a[66:67], v153 offset:16384
  ds_read_b64_tr_b16 a[68:69], v154 offset:16384
  ds_read_b64_tr_b16 a[70:71], v155 offset:16384
  ds_read_b64_tr_b16 a[72:73], v152 offset:16448
  ds_read_b64_tr_b16 a[74:75], v153 offset:16448
  ds_read_b64_tr_b16 a[76:77], v154 offset:16448
  ds_read_b64_tr_b16 a[78:79], v155 offset:16448
  s_waitcnt lgkmcnt(0)
  s_add_u32 m0, s28, 16384
  s_nop 0
  buffer_load_dwordx4 v144, s[8:11], s17 offen lds
  s_add_u32 s17, s17, s29
  s_add_u32 m0, s28, 17408
  s_nop 0
  buffer_load_dwordx4 v144, s[8:11], s17 offen lds
  s_add_u32 s17, s17, s29
  s_add_u32 m0, s28, 18432
  s_nop 0
  buffer_load_dwordx4 v144, s[8:11], s17 offen lds
  s_add_u32 s17, s17, s29
  s_add_u32 m0, s28, 19456
  s_nop 0
  buffer_load_dwordx4 v144, s[8:11], s17 offen lds
  s_add_u32 s17, s17, s29
  s_waitcnt vmcnt(28)
  ds_read_b64_tr_b16 a[80:81], v152 offset:20480
  ds_read_b64_tr_b16 a[82:83], v153 offset:20480
  ds_read_b64_tr_b16 a[84:85], v154 offset:20480
  ds_read_b64_tr_b16 a[86:87], v155 offset:20480
  ds_read_b64_tr_b16 a[88:89], v152 offset:20544
  ds_read_b64_tr_b16 a[90:91], v153 offset:20544
  ds_read_b64_tr_b16 a[92:93], v154 offset:20544
  ds_read_b64_tr_b16 a[94:95], v155 offset:20544
  s_waitcnt lgkmcnt(0)
  s_add_u32 m0, s28, 20480
  s_nop 0
  buffer_load_dwordx4 v144, s[8:11], s17 offen lds
  s_add_u32 s17, s17, s29
  s_add_u32 m0, s28, 21504
  s_nop 0
  buffer_load_dwordx4 v144, s[8:11], s17 offen lds
  s_add_u32 s17, s17, s29
  s_add_u32 m0, s28, 22528
  s_nop 0
  buffer_load_dwordx4 v144, s[8:11], s17 offen lds
  s_add_u32 s17, s17, s29
  s_add_u32 m0, s28, 23552
  s_nop 0
  buffer_load_dwordx4 v144, s[8:11], s17 offen lds
  s_add_u32 s17, s17, s29
  s_waitcnt vmcnt(28)
  ds_read_b64_tr_b16 a[96:97], v152 offset:24576
  ds_read_b64_tr_b16 a[98:99], v153 offset:24576
  ds_read_b64_tr_b16 a[100:101], v154 offset:24576
  ds_read_b64_tr_b16 a[102:103], v155 offset:24576
  ds_read_b64_tr_b16 a[104:105], v152 offset:24640
  ds_read_b64_tr_b16 a[106:107], v153 offset:24640
  ds_read_b64_tr_b16 a[108:109], v154 offset:24640
  ds_read_b64_tr_b16 a[110:111], v155 offset:24640
  s_waitcnt lgkmcnt(0)
  s_add_u32 m0, s28, 24576
  s_nop 0
  buffer_load_dwordx4 v144, s[8:11], s17 offen lds
  s_add_u32 s17, s17, s29
  s_add_u32 m0, s28, 25600
  s_nop 0
  buffer_load_dwordx4 v144, s[8:11], s17 offen lds
  s_add_u32 s17, s17, s29
  s_add_u32 m0, s28, 26624
  s_nop 0
  buffer_load_dwordx4 v144, s[8:11], s17 offen lds
  s_add_u32 s17, s17, s29
  s_add_u32 m0, s28, 27648
  s_nop 0
  buffer_load_dwordx4 v144, s[8:11], s17 offen lds
  s_add_u32 s17, s17, s29
  s_waitcnt vmcnt(28)
  ds_read_b64_tr_b16 a[112:113], v152 offset:28672
  ds_read_b64_tr_b16 a[114:115], v153 offset:28672
  ds_read_b64_tr_b16 a[116:117], v154 offset:28672
  ds_read_b64_tr_b16 a[118:119], v155 offset:28672
  ds_read_b64_tr_b16 a[120:121], v152 offset:28736
  ds_read_b64_tr_b16 a[122:123], v153 offset:28736
  ds_read_b64_tr_b16 a[124:125], v154 offset:28736
  ds_read_b64_tr_b16 a[126:127], v155 offset:28736
  s_waitcnt lgkmcnt(0)
  s_add_u32 m0, s28, 28672
  s_nop 0
  buffer_load_dwordx4 v144, s[8:11], s17 offen lds
  s_add_u32 s17, s17, s29
  s_add_u32 m0, s28, 29696
  s_nop 0
  buffer_load_dwordx4 v144, s[8:11], s17 offen lds
  s_add_u32 s17, s17, s29
  s_add_u32 m0, s28, 30720
  s_nop 0
  buffer_load_dwordx4 v144, s[8:11], s17 offen lds
  s_add_u32 s17, s17, s29
  s_add_u32 m0, s28, 31744
  s_nop 0
  buffer_load_dwordx4 v144, s[8:11], s17 offen lds
  s_add_u32 s17, s17, s29
  s_waitcnt vmcnt(28)
  ds_read_b64_tr_b16 a[128:129], v152 offset:0
  ds_read_b64_tr_b16 a[130:131], v153 offset:0
  ds_read_b64_tr_b16 a[132:133], v154 offset:0
  ds_read_b64_tr_b16 a[134:135], v155 offset:0
  ds_read_b64_tr_b16 a[136:137], v152 offset:64
  ds_read_b64_tr_b16 a[138:139], v153 offset:64
  ds_read_b64_tr_b16 a[140:141], v154 offset:64
  ds_read_b64_tr_b16 a[142:143], v155 offset:64
  s_waitcnt lgkmcnt(0)
  s_waitcnt vmcnt(24)
  ds_read_b64_tr_b16 a[144:145], v152 offset:4096
  ds_read_b64_tr_b16 a[146:147], v153 offset:4096
  ds_read_b64_tr_b16 a[148:149], v154 offset:4096
  ds_read_b64_tr_b16 a[150:151], v155 offset:4096
  ds_read_b64_tr_b16 a[152:153], v152 offset:4160
  ds_read_b64_tr_b16 a[154:155], v153 offset:4160
  ds_read_b64_tr_b16 a[156:157], v154 offset:4160
  ds_read_b64_tr_b16 a[158:159], v155 offset:4160
  s_waitcnt lgkmcnt(0)
  s_waitcnt vmcnt(20)
  ds_read_b64_tr_b16 a[160:161], v152 offset:8192
  ds_read_b64_tr_b16 a[162:163], v153 offset:8192
  ds_read_b64_tr_b16 a[164:165], v154 offset:8192
  ds_read_b64_tr_b16 a[166:167], v155 offset:8192
  ds_read_b64_tr_b16 a[168:169], v152 offset:8256
  ds_read_b64_tr_b16 a[170:171], v153 offset:8256
  ds_read_b64_tr_b16 a[172:173], v154 offset:8256
  ds_read_b64_tr_b16 a[174:175], v155 offset:8256
  s_waitcnt lgkmcnt(0)
  s_waitcnt vmcnt(16)
  ds_read_b64_tr_b16 a[176:177], v152 offset:12288
  ds_read_b64_tr_b16 a[178:179], v153 offset:12288
  ds_read_b64_tr_b16 a[180:181], v154 offset:12288
  ds_read_b64_tr_b16 a[182:183], v155 offset:12288
  ds_read_b64_tr_b16 a[184:185], v152 offset:12352
  ds_read_b64_tr_b16 a[186:187], v153 offset:12352
  ds_read_b64_tr_b16 a[188:189], v154 offset:12352
  ds_read_b64_tr_b16 a[190:191], v155 offset:12352
  s_waitcnt lgkmcnt(0)
  s_waitcnt vmcnt(12)
  ds_read_b64_tr_b16 a[192:193], v152 offset:16384
  ds_read_b64_tr_b16 a[194:195], v153 offset:16384
  ds_read_b64_tr_b16 a[196:197], v154 offset:16384
  ds_read_b64_tr_b16 a[198:199], v155 offset:16384
  ds_read_b64_tr_b16 a[200:201], v152 offset:16448
  ds_read_b64_tr_b16 a[202:203], v153 offset:16448
  ds_read_b64_tr_b16 a[204:205], v154 offset:16448
  ds_read_b64_tr_b16 a[206:207], v155 offset:16448
  s_waitcnt lgkmcnt(0)
  s_waitcnt vmcnt(8)
  ds_read_b64_tr_b16 a[208:209], v152 offset:20480
  ds_read_b64_tr_b16 a[210:211], v153 offset:20480
  ds_read_b64_tr_b16 a[212:213], v154 offset:20480
  ds_read_b64_tr_b16 a[214:215], v155 offset:20480
  ds_read_b64_tr_b16 a[216:217], v152 offset:20544
  ds_read_b64_tr_b16 a[218:219], v153 offset:20544
  ds_read_b64_tr_b16 a[220:221], v154 offset:20544
  ds_read_b64_tr_b16 a[222:223], v155 offset:20544
  s_waitcnt lgkmcnt(0)
  s_waitcnt vmcnt(4)
  ds_read_b64_tr_b16 a[224:225], v152 offset:24576
  ds_read_b64_tr_b16 a[226:227], v153 offset:24576
  ds_read_b64_tr_b16 a[228:229], v154 offset:24576
  ds_read_b64_tr_b16 a[230:231], v155 offset:24576
  ds_read_b64_tr_b16 a[232:233], v152 offset:24640
  ds_read_b64_tr_b16 a[234:235], v153 offset:24640
  ds_read_b64_tr_b16 a[236:237], v154 offset:24640
  ds_read_b64_tr_b16 a[238:239], v155 offset:24640
  s_waitcnt lgkmcnt(0)
  s_waitcnt vmcnt(0)
  ds_read_b64_tr_b16 a[240:241], v152 offset:28672
  ds_read_b64_tr_b16 a[242:243], v153 offset:28672
  ds_read_b64_tr_b16 a[244:245], v154 offset:28672
  ds_read_b64_tr_b16 a[246:247], v155 offset:28672
  ds_read_b64_tr_b16 a[248:249], v152 offset:28736
  ds_read_b64_tr_b16 a[250:251], v153 offset:28736
  ds_read_b64_tr_b16 a[252:253], v154 offset:28736
  ds_read_b64_tr_b16 a[254:255], v155 offset:28736
  s_waitcnt lgkmcnt(0)
  s_lshl_b32 s26, s48, 2
  s_add_u32 s26, s26, s16
  s_lshl_b32 s27, s26, 6
  s_add_u32 s27, s27, s50
  s_lshl_b32 s19, s27, 13
  s_lshl_b32 s27, s50, 5
  s_add_u32 s27, s27, s26
  s_mul_i32 s27, s27, 4096
  s_add_u32 s20, s27, 135266304
  s_lshl_b32 s25, s16, 12
  s_add_u32 s25, s25, 65536
  s_lshl_b32 s26, s16, 13
  v_add_u32 v3, s26, v2
  v_lshrrev_b32 v16, 5, v1
  v_and_b32 v17, 31, v1
  v_bfe_u32 v18, v1, 4, 1
  v_lshl_add_u32 v18, v18, 1, v16
  v_and_b32 v19, 15, v1
  v_lshl_add_u32 v18, v18, 4, v19
  v_lshl_add_u32 v5, v18, 4, s25
  v_bfe_u32 v18, v1, 2, 2
  v_lshl_add_u32 v18, v16, 2, v18
  v_and_b32 v19, 1, v1
  v_lshl_add_u32 v18, v19, 4, v18
  v_lshl_add_u32 v4, v18, 4, s25
  v_lshlrev_b32 v16, 2, v16
  v_sub_u32 v17, v17, v16
  v_mov_b32 v18, 0xf149f2ca
  v_cmp_le_i32 vcc, 0, v17
  s_nop 1
  v_cndmask_b32 v240, v18, 0, vcc
  v_cmp_le_i32 vcc, 1, v17
  s_nop 1
  v_cndmask_b32 v241, v18, 0, vcc
  v_cmp_le_i32 vcc, 2, v17
  s_nop 1
  v_cndmask_b32 v242, v18, 0, vcc
  v_cmp_le_i32 vcc, 3, v17
  s_nop 1
  v_cndmask_b32 v243, v18, 0, vcc
  v_cmp_le_i32 vcc, 8, v17
  s_nop 1
  v_cndmask_b32 v244, v18, 0, vcc
  v_cmp_le_i32 vcc, 9, v17
  s_nop 1
  v_cndmask_b32 v245, v18, 0, vcc
  v_cmp_le_i32 vcc, 10, v17
  s_nop 1
  v_cndmask_b32 v246, v18, 0, vcc
  v_cmp_le_i32 vcc, 11, v17
  s_nop 1
  v_cndmask_b32 v247, v18, 0, vcc
  v_cmp_le_i32 vcc, 16, v17
  s_nop 1
  v_cndmask_b32 v248, v18, 0, vcc
  v_cmp_le_i32 vcc, 17, v17
  s_nop 1
  v_cndmask_b32 v249, v18, 0, vcc
  v_cmp_le_i32 vcc, 18, v17
  s_nop 1
  v_cndmask_b32 v250, v18, 0, vcc
  v_cmp_le_i32 vcc, 19, v17
  s_nop 1
  v_cndmask_b32 v251, v18, 0, vcc
  v_cmp_le_i32 vcc, 24, v17
  s_nop 1
  v_cndmask_b32 v252, v18, 0, vcc
  v_cmp_le_i32 vcc, 25, v17
  s_nop 1
  v_cndmask_b32 v253, v18, 0, vcc
  v_cmp_le_i32 vcc, 26, v17
  s_nop 1
  v_cndmask_b32 v254, v18, 0, vcc
  v_cmp_le_i32 vcc, 27, v17
  s_nop 1
  v_cndmask_b32 v255, v18, 0, vcc
  v_mov_b32 v21, v2
  s_barrier
  s_lshl_b32 s77, s48, 2
  s_add_u32 s77, s77, s16
  s_mul_i32 s78, s77, 896
  s_add_u32 s76, s78, 148898304
  s_mov_b32 s71, 0
  s_branch M_sg_229
M_sw_228:
  s_sleep 8
  s_add_u32 s71, s71, 1
  s_cmp_gt_u32 s71, 262144
  s_cbranch_scc1 M_exit
M_sg_229:
  s_mov_b32 s79, 0
  s_atomic_or s79, s[72:73], s76 glc
  s_waitcnt lgkmcnt(0)
  s_cmp_lt_u32 s79, 16
  s_cbranch_scc1 M_sw_228
  s_add_u32 s76, s78, 148898048
  s_mov_b32 s71, 0
  s_branch M_sg_231
M_sw_230:
  s_sleep 8
  s_add_u32 s71, s71, 1
  s_cmp_gt_u32 s71, 262144
  s_cbranch_scc1 M_exit
M_sg_231:
  s_mov_b32 s79, 0
  s_atomic_or s79, s[72:73], s76 glc
  s_waitcnt lgkmcnt(0)
  s_cmp_lt_u32 s79, 8
  s_cbranch_scc1 M_sw_230
  s_add_u32 s76, s78, 148898176
  s_mov_b32 s71, 0
  s_branch M_sg_233
M_sw_232:
  s_sleep 8
  s_add_u32 s71, s71, 1
  s_cmp_gt_u32 s71, 262144
  s_cbranch_scc1 M_exit
M_sg_233:
  s_mov_b32 s79, 0
  s_atomic_or s79, s[72:73], s76 glc
  s_waitcnt lgkmcnt(0)
  s_cmp_lt_u32 s79, 8
  s_cbranch_scc1 M_sw_232
M_xok_227:
  s_lshl_b32 s77, s77, 7
  s_add_u32 s54, s77, 148926464
  s_add_u32 s52, s50, 1
  s_mov_b32 s53, 0
  s_mov_b32 s30, 0x200
  s_add_u32 s28, s19, 50331648
  buffer_load_dwordx4 v[144:147], v21, s[4:7], s28 offen offset:0 sc1
  buffer_load_dwordx4 v[148:151], v21, s[4:7], s28 offen offset:1024 sc1
  buffer_load_dwordx4 v[152:155], v21, s[4:7], s28 offen offset:2048 sc1
  buffer_load_dwordx4 v[156:159], v21, s[4:7], s28 offen offset:3072 sc1
  s_add_u32 s29, s19, 50335744
  buffer_load_dwordx4 v[160:163], v21, s[4:7], s29 offen offset:0 sc1
  buffer_load_dwordx4 v[164:167], v21, s[4:7], s29 offen offset:1024 sc1
  buffer_load_dwordx4 v[168:171], v21, s[4:7], s29 offen offset:2048 sc1
  buffer_load_dwordx4 v[172:175], v21, s[4:7], s29 offen offset:3072 sc1
  s_add_u32 s28, s19, 67108864
  buffer_load_dwordx4 v[176:179], v21, s[4:7], s28 offen offset:0 sc1
  buffer_load_dwordx4 v[180:183], v21, s[4:7], s28 offen offset:1024 sc1
  buffer_load_dwordx4 v[184:187], v21, s[4:7], s28 offen offset:2048 sc1
  buffer_load_dwordx4 v[188:191], v21, s[4:7], s28 offen offset:3072 sc1
  s_add_u32 s29, s19, 67112960
  buffer_load_dwordx4 v[192:195], v21, s[4:7], s29 offen offset:0 sc1
  buffer_load_dwordx4 v[196:199], v21, s[4:7], s29 offen offset:1024 sc1
  buffer_load_dwordx4 v[200:203], v21, s[4:7], s29 offen offset:2048 sc1
  buffer_load_dwordx4 v[204:207], v21, s[4:7], s29 offen offset:3072 sc1
  s_add_u32 s28, s19, 83886080
  buffer_load_dwordx4 v[208:211], v21, s[4:7], s28 offen offset:0 sc1
  buffer_load_dwordx4 v[212:215], v21, s[4:7], s28 offen offset:1024 sc1
  buffer_load_dwordx4 v[216:219], v21, s[4:7], s28 offen offset:2048 sc1
  buffer_load_dwordx4 v[220:223], v21, s[4:7], s28 offen offset:3072 sc1
  s_add_u32 s29, s19, 83890176
  buffer_load_dwordx4 v[224:227], v21, s[4:7], s29 offen offset:0 sc1
  buffer_load_dwordx4 v[228:231], v21, s[4:7], s29 offen offset:1024 sc1
  buffer_load_dwordx4 v[232:235], v21, s[4:7], s29 offen offset:2048 sc1
  buffer_load_dwordx4 v[236:239], v21, s[4:7], s29 offen offset:3072 sc1
  s_mov_b32 s24, 0
  v_mov_b32 v22, 0x40000000
  s_sub_u32 s21, s21, s22
F_top_234:
  s_waitcnt vmcnt(8)
  v_mfma_f32_32x32x16_bf16 v[24:39], v[176:179], v[144:147], v[240:255]
  s_nop 1
  v_cvt_pk_bf16_f32 v128, v64, v65
  v_cvt_pk_bf16_f32 v129, v66, v67
  v_cvt_pk_bf16_f32 v130, v68, v69
  v_cvt_pk_bf16_f32 v131, v70, v71
  v_mfma_f32_32x32x16_bf16 v[24:39], v[180:183], v[148:151], v[24:39]
  buffer_store_dwordx4 v[128:131], v22, s[4:7], s21 offen offset:0 sc1
  v_mfma_f32_32x32x16_bf16 v[24:39], v[184:187], v[152:155], v[24:39]
  v_cvt_pk_bf16_f32 v132, v72, v73
  v_cvt_pk_bf16_f32 v133, v74, v75
  v_cvt_pk_bf16_f32 v134, v76, v77
  v_cvt_pk_bf16_f32 v135, v78, v79
  v_mfma_f32_32x32x16_bf16 v[24:39], v[188:191], v[156:159], v[24:39]
  buffer_store_dwordx4 v[132:135], v22, s[4:7], s21 offen offset:256 sc1
  v_mfma_f32_32x32x16_bf16 v[24:39], v[192:195], v[160:163], v[24:39]
  v_cvt_pk_bf16_f32 v136, v80, v81
  v_cvt_pk_bf16_f32 v137, v82, v83
  v_cvt_pk_bf16_f32 v138, v84, v85
  v_cvt_pk_bf16_f32 v139, v86, v87
  v_mfma_f32_32x32x16_bf16 v[24:39], v[196:199], v[164:167], v[24:39]
  buffer_store_dwordx4 v[136:139], v22, s[4:7], s21 offen offset:2048 sc1
  v_mfma_f32_32x32x16_bf16 v[24:39], v[200:203], v[168:171], v[24:39]
  v_cvt_pk_bf16_f32 v140, v88, v89
  v_cvt_pk_bf16_f32 v141, v90, v91
  v_cvt_pk_bf16_f32 v142, v92, v93
  v_cvt_pk_bf16_f32 v143, v94, v95
  v_mfma_f32_32x32x16_bf16 v[24:39], v[204:207], v[172:175], v[24:39]
  buffer_store_dwordx4 v[140:143], v22, s[4:7], s21 offen offset:2304 sc1
  s_add_u32 s21, s21, s22
  v_mov_b32 v22, v20
  s_cmp_lg_u32 s24, 0
  s_cbranch_scc1 F_have_235
  s_cmp_le_u32 s52, 58
  s_cbranch_scc1 M_dp_236
  s_mov_b32 s71, 0
  v_add_u32 v16, s25, v2
  s_branch M_dp_238
M_dp_237:
  s_sleep 1
  s_add_u32 s71, s71, 1
  s_cmp_gt_u32 s71, 262144
  s_cbranch_scc1 M_exit
M_dp_238:
  buffer_load_dword v23, off, s[4:7], s54 sc1
  buffer_load_dwordx4 v[96:99], v2, s[4:7], s20 offen offset:0 sc1
  buffer_load_dwordx4 v[100:103], v2, s[4:7], s20 offen offset:1024 sc1
  buffer_load_dwordx4 v[104:107], v2, s[4:7], s20 offen offset:2048 sc1
  buffer_load_dwordx4 v[108:111], v2, s[4:7], s20 offen offset:3072 sc1
  s_waitcnt vmcnt(3)
  v_max_u32 v17, v96, v97
  v_max3_u32 v17, v17, v98, v99
  s_waitcnt vmcnt(2)
  v_max3_u32 v17, v17, v100, v101
  v_max3_u32 v17, v17, v102, v103
  s_waitcnt vmcnt(1)
  v_max3_u32 v17, v17, v104, v105
  v_max3_u32 v17, v17, v106, v107
  s_waitcnt vmcnt(0)
  v_max3_u32 v17, v17, v108, v109
  v_max3_u32 v17, v17, v110, v111
  v_cmp_eq_u32 vcc, -1, v17
  s_cbranch_vccz M_dp_239
  v_cmp_gt_u32 vcc, s52, v23
  s_cbranch_vccnz M_dp_237
  s_branch M_dp_236
M_dp_239:
  ds_write_b128 v16, v[96:99] offset:0
  ds_write_b128 v16, v[100:103] offset:1024
  ds_write_b128 v16, v[104:107] offset:2048
  ds_write_b128 v16, v[108:111] offset:3072
  s_branch F_have_235
M_dp_236:
  v_mov_b32 v16, s54
  v_mov_b32 v17, s52
  s_mov_b32 s71, 0
  s_branch M_vg_241
M_vw_240:
  s_sleep 2
  s_add_u32 s71, s71, 1
  s_cmp_gt_u32 s71, 262144
  s_cbranch_scc1 M_exit
M_vg_241:
  buffer_load_dword v23, v16, s[4:7], 0 offen sc1
  s_waitcnt vmcnt(0)
  v_cmp_lt_u32 vcc, v23, v17
  s_cbranch_vccnz M_vw_240
  s_mov_b32 m0, s25
  s_nop 0
  buffer_load_dwordx4 v2, s[4:7], s20 offen offset:0 sc1 lds
  buffer_load_dwordx4 v2, s[4:7], s20 offen offset:1024 sc1 lds
  buffer_load_dwordx4 v2, s[4:7], s20 offen offset:2048 sc1 lds
  buffer_load_dwordx4 v2, s[4:7], s20 offen offset:3072 sc1 lds
  s_waitcnt vmcnt(0)
F_have_235:
  ds_read_b64_tr_b16 v[176:177], v4 offset:8
  ds_read_b64_tr_b16 v[178:179], v4 offset:136
  ds_read_b64_tr_b16 v[180:181], v4 offset:520
  ds_read_b64_tr_b16 v[182:183], v4 offset:648
  ds_read_b64_tr_b16 v[184:185], v4 offset:1032
  ds_read_b64_tr_b16 v[186:187], v4 offset:1160
  ds_read_b64_tr_b16 v[188:189], v4 offset:1544
  ds_read_b64_tr_b16 v[190:191], v4 offset:1672
  ds_read_b64_tr_b16 v[192:193], v4 offset:2056
  ds_read_b64_tr_b16 v[194:195], v4 offset:2184
  ds_read_b64_tr_b16 v[196:197], v4 offset:2568
  ds_read_b64_tr_b16 v[198:199], v4 offset:2696
  s_sub_u32 s23, s23, 1
  s_cmp_gt_u32 s23, 0
  s_cselect_b32 s26, s51, 0
  s_cselect_b32 s27, 0, 0x40000000
  v_or_b32 v21, s27, v21
  s_lshl_b32 s27, s26, 13
  s_add_u32 s19, s19, s27
  s_mul_i32 s27, s26, 131072
  s_add_u32 s20, s20, s27
  s_cmp_lg_u32 s23, 24
  s_cbranch_scc1 M_xok_242
  s_lshl_b32 s77, s48, 2
  s_add_u32 s77, s77, s16
  s_mul_i32 s78, s77, 896
  s_add_u32 s76, s78, 148898304
  s_mov_b32 s71, 0
  s_branch M_sg_244
M_sw_243:
  s_sleep 8
  s_add_u32 s71, s71, 1
  s_cmp_gt_u32 s71, 262144
  s_cbranch_scc1 M_exit
M_sg_244:
  s_mov_b32 s79, 0
  s_atomic_or s79, s[72:73], s76 glc
  s_waitcnt lgkmcnt(0)
  s_cmp_lt_u32 s79, 32
  s_cbranch_scc1 M_sw_243
  s_add_u32 s76, s78, 148898432
  s_mov_b32 s71, 0
  s_branch M_sg_246
M_sw_245:
  s_sleep 8
  s_add_u32 s71, s71, 1
  s_cmp_gt_u32 s71, 262144
  s_cbranch_scc1 M_exit
M_sg_246:
  s_mov_b32 s79, 0
  s_atomic_or s79, s[72:73], s76 glc
  s_waitcnt lgkmcnt(0)
  s_cmp_lt_u32 s79, 32
  s_cbranch_scc1 M_sw_245
  s_add_u32 s76, s78, 148898048
  s_mov_b32 s71, 0
  s_branch M_sg_248
M_sw_247:
  s_sleep 8
  s_add_u32 s71, s71, 1
  s_cmp_gt_u32 s71, 262144
  s_cbranch_scc1 M_exit
M_sg_248:
  s_mov_b32 s79, 0
  s_atomic_or s79, s[72:73], s76 glc
  s_waitcnt lgkmcnt(0)
  s_cmp_lt_u32 s79, 32
  s_cbranch_scc1 M_sw_247
  s_add_u32 s76, s78, 148898176
  s_mov_b32 s71, 0
  s_branch M_sg_250
M_sw_249:
  s_sleep 8
  s_add_u32 s71, s71, 1
  s_cmp_gt_u32 s71, 262144
  s_cbranch_scc1 M_exit
M_sg_250:
  s_mov_b32 s79, 0
  s_atomic_or s79, s[72:73], s76 glc
  s_waitcnt lgkmcnt(0)
  s_cmp_lt_u32 s79, 32
  s_cbranch_scc1 M_sw_249
M_xok_242:
  s_waitcnt lgkmcnt(10)
  v_mfma_f32_32x32x16_bf16 v[40:55], v[176:179], v[144:147], 0
  ds_read_b64_tr_b16 v[200:201], v4 offset:3080
  ds_read_b64_tr_b16 v[202:203], v4 offset:3208
  v_max_f32 v6, v24, v25
  s_waitcnt lgkmcnt(10)
  v_mfma_f32_32x32x16_bf16 v[40:55], v[180:183], v[148:151], v[40:55]
  ds_read_b64_tr_b16 v[204:205], v4 offset:3592
  ds_read_b64_tr_b16 v[206:207], v4 offset:3720
  v_max3_f32 v6, v6, v26, v27
  s_waitcnt lgkmcnt(10)
  v_mfma_f32_32x32x16_bf16 v[40:55], v[184:187], v[152:155], v[40:55]
  ds_read_b64 v[56:57], v5 offset:0
  ds_read_b64 v[58:59], v5 offset:1024
  v_max3_f32 v6, v6, v28, v29
  s_waitcnt lgkmcnt(10)
  v_mfma_f32_32x32x16_bf16 v[40:55], v[188:191], v[156:159], v[40:55]
  ds_read_b64 v[60:61], v5 offset:2048
  ds_read_b64 v[62:63], v5 offset:3072
  v_max3_f32 v6, v6, v30, v31
  s_waitcnt lgkmcnt(10)
  v_mfma_f32_32x32x16_bf16 v[40:55], v[192:195], v[160:163], v[40:55]
  v_max3_f32 v6, v6, v32, v33
  s_waitcnt lgkmcnt(8)
  v_mfma_f32_32x32x16_bf16 v[40:55], v[196:199], v[164:167], v[40:55]
  v_max3_f32 v6, v6, v34, v35
  s_waitcnt lgkmcnt(6)
  v_mfma_f32_32x32x16_bf16 v[40:55], v[200:203], v[168:171], v[40:55]
  v_max3_f32 v6, v6, v36, v37
  s_waitcnt lgkmcnt(4)
  v_mfma_f32_32x32x16_bf16 v[40:55], v[204:207], v[172:175], v[40:55]
  v_max3_f32 v6, v6, v38, v39
  s_add_u32 s28, s19, 50331648
  buffer_load_dwordx4 v[144:147], v21, s[4:7], s28 offen offset:0 sc1
  buffer_load_dwordx4 v[148:151], v21, s[4:7], s28 offen offset:1024 sc1
  s_nop 7
  v_max3_f32 v6, v6, v40, v41
  v_max3_f32 v6, v6, v42, v43
  v_mov_b32 v16, v6
  s_nop 1
  v_permlane32_swap_b32 v6, v16
  s_nop 1
  v_max_f32 v6, v6, v16
  v_pk_add_f32 v[24:25], v[24:25], v[6:7] op_sel_hi:[1,0] neg_lo:[0,1] neg_hi:[0,1]
  v_pk_add_f32 v[26:27], v[26:27], v[6:7] op_sel_hi:[1,0] neg_lo:[0,1] neg_hi:[0,1]
  v_pk_add_f32 v[28:29], v[28:29], v[6:7] op_sel_hi:[1,0] neg_lo:[0,1] neg_hi:[0,1]
  v_pk_add_f32 v[30:31], v[30:31], v[6:7] op_sel_hi:[1,0] neg_lo:[0,1] neg_hi:[0,1]
  v_pk_add_f32 v[32:33], v[32:33], v[6:7] op_sel_hi:[1,0] neg_lo:[0,1] neg_hi:[0,1]
  v_pk_add_f32 v[34:35], v[34:35], v[6:7] op_sel_hi:[1,0] neg_lo:[0,1] neg_hi:[0,1]
  v_pk_add_f32 v[36:37], v[36:37], v[6:7] op_sel_hi:[1,0] neg_lo:[0,1] neg_hi:[0,1]
  v_pk_add_f32 v[38:39], v[38:39], v[6:7] op_sel_hi:[1,0] neg_lo:[0,1] neg_hi:[0,1]
  v_pk_add_f32 v[40:41], v[40:41], v[6:7] op_sel_hi:[1,0] neg_lo:[0,1] neg_hi:[0,1]
  v_pk_add_f32 v[42:43], v[42:43], v[6:7] op_sel_hi:[1,0] neg_lo:[0,1] neg_hi:[0,1]
  v_exp_f32 v24, v24
  v_exp_f32 v25, v25
  v_exp_f32 v26, v26
  v_exp_f32 v27, v27
  v_exp_f32 v28, v28
  v_exp_f32 v29, v29
  v_exp_f32 v30, v30
  v_exp_f32 v31, v31
  v_exp_f32 v32, v32
  v_exp_f32 v33, v33
  buffer_load_dwordx4 v[152:155], v21, s[4:7], s28 offen offset:2048 sc1
  v_exp_f32 v34, v34
  v_exp_f32 v35, v35
  v_exp_f32 v36, v36
  v_exp_f32 v37, v37
  v_exp_f32 v38, v38
  v_exp_f32 v39, v39
  v_exp_f32 v40, v40
  v_exp_f32 v41, v41
  v_exp_f32 v42, v42
  v_exp_f32 v43, v43
  v_pk_add_f32 v[16:17], v[24:25], v[26:27]
  v_pk_add_f32 v[16:17], v[16:17], v[28:29]
  v_pk_add_f32 v[16:17], v[16:17], v[30:31]
  v_pk_add_f32 v[16:17], v[16:17], v[32:33]
  v_pk_add_f32 v[16:17], v[16:17], v[34:35]
  v_pk_add_f32 v[16:17], v[16:17], v[36:37]
  v_pk_add_f32 v[16:17], v[16:17], v[38:39]
  v_pk_add_f32 v[16:17], v[16:17], v[40:41]
  v_pk_add_f32 v[16:17], v[16:17], v[42:43]
  v_add_f32 v16, v16, v17
  v_mov_b32 v17, v16
  buffer_load_dwordx4 v[156:159], v21, s[4:7], s28 offen offset:3072 sc1
  s_nop 0
  v_permlane32_swap_b32 v16, v17
  s_nop 1
  v_add_f32 v16, v16, v17
  v_rcp_f32 v6, v16
  s_nop 0
  v_pk_mul_f32 v[24:25], v[24:25], v[6:7] op_sel_hi:[1,0]
  v_pk_mul_f32 v[26:27], v[26:27], v[6:7] op_sel_hi:[1,0]
  v_pk_mul_f32 v[28:29], v[28:29], v[6:7] op_sel_hi:[1,0]
  v_pk_mul_f32 v[30:31], v[30:31], v[6:7] op_sel_hi:[1,0]
  v_pk_mul_f32 v[32:33], v[32:33], v[6:7] op_sel_hi:[1,0]
  v_pk_mul_f32 v[34:35], v[34:35], v[6:7] op_sel_hi:[1,0]
  v_pk_mul_f32 v[36:37], v[36:37], v[6:7] op_sel_hi:[1,0]
  v_pk_mul_f32 v[38:39], v[38:39], v[6:7] op_sel_hi:[1,0]
  v_pk_mul_f32 v[40:41], v[40:41], v[6:7] op_sel_hi:[1,0]
  v_pk_mul_f32 v[42:43], v[42:43], v[6:7] op_sel_hi:[1,0]
  v_cvt_pk_bf16_f32 v128, v24, v25
  v_cvt_pk_bf16_f32 v129, v26, v27
  v_cvt_pk_bf16_f32 v130, v28, v29
  v_cvt_pk_bf16_f32 v131, v30, v31
  v_cvt_pk_bf16_f32 v132, v32, v33
  v_cvt_pk_bf16_f32 v133, v34, v35
  v_cvt_pk_bf16_f32 v134, v36, v37
  v_cvt_pk_bf16_f32 v135, v38, v39
  v_cvt_pk_bf16_f32 v136, v40, v41
  v_cvt_pk_bf16_f32 v137, v42, v43
  s_waitcnt vmcnt(8) lgkmcnt(0)
  v_mfma_f32_32x32x16_bf16 v[64:79], v[208:211], v[128:131], 0
  s_add_u32 s29, s19, 50335744
  buffer_load_dwordx4 v[160:163], v21, s[4:7], s29 offen offset:0 sc1
  v_mfma_f32_32x32x16_bf16 v[64:79], v[212:215], v[132:135], v[64:79]
  v_mfma_f32_32x32x8_bf16 v[64:79], v[56:57], v[136:137], v[64:79]
  v_mfma_f32_32x32x16_bf16 v[80:95], v[216:219], v[128:131], 0
  buffer_load_dwordx4 v[164:167], v21, s[4:7], s29 offen offset:1024 sc1
  v_mfma_f32_32x32x16_bf16 v[80:95], v[220:223], v[132:135], v[80:95]
  v_cvt_pk_bf16_f32 v24, v64, v65
  v_cvt_pk_bf16_f32 v25, v66, v67
  v_cvt_pk_bf16_f32 v26, v68, v69
  v_cvt_pk_bf16_f32 v27, v70, v71
  v_mfma_f32_32x32x8_bf16 v[80:95], v[58:59], v[136:137], v[80:95]
  ds_write_b128 v3, v[24:27] offset:0
  v_cvt_pk_bf16_f32 v28, v72, v73
  v_cvt_pk_bf16_f32 v29, v74, v75
  v_cvt_pk_bf16_f32 v30, v76, v77
  v_cvt_pk_bf16_f32 v31, v78, v79
  v_mfma_f32_32x32x16_bf16 v[96:111], v[224:227], v[128:131], 0
  ds_write_b128 v3, v[28:31] offset:1024
  buffer_load_dwordx4 v[168:171], v21, s[4:7], s29 offen offset:2048 sc1
  v_mfma_f32_32x32x16_bf16 v[96:111], v[228:231], v[132:135], v[96:111]
  v_cvt_pk_bf16_f32 v32, v80, v81
  v_cvt_pk_bf16_f32 v33, v82, v83
  v_cvt_pk_bf16_f32 v34, v84, v85
  v_cvt_pk_bf16_f32 v35, v86, v87
  v_mfma_f32_32x32x8_bf16 v[96:111], v[60:61], v[136:137], v[96:111]
  ds_write_b128 v3, v[32:35] offset:2048
  v_cvt_pk_bf16_f32 v36, v88, v89
  v_cvt_pk_bf16_f32 v37, v90, v91
  v_cvt_pk_bf16_f32 v38, v92, v93
  v_cvt_pk_bf16_f32 v39, v94, v95
  v_mfma_f32_32x32x16_bf16 v[112:127], v[232:235], v[128:131], 0
  ds_write_b128 v3, v[36:39] offset:3072
  buffer_load_dwordx4 v[172:175], v21, s[4:7], s29 offen offset:3072 sc1
  v_mfma_f32_32x32x16_bf16 v[112:127], v[236:239], v[132:135], v[112:127]
  v_cvt_pk_bf16_f32 v40, v96, v97
  v_cvt_pk_bf16_f32 v41, v98, v99
  v_cvt_pk_bf16_f32 v42, v100, v101
  v_cvt_pk_bf16_f32 v43, v102, v103
  v_mfma_f32_32x32x8_bf16 v[112:127], v[62:63], v[136:137], v[112:127]
  ds_write_b128 v3, v[40:43] offset:4096
  v_cvt_pk_bf16_f32 v44, v104, v105
  v_cvt_pk_bf16_f32 v45, v106, v107
  v_cvt_pk_bf16_f32 v46, v108, v109
  v_cvt_pk_bf16_f32 v47, v110, v111
  ds_write_b128 v3, v[44:47] offset:5120
  s_nop 5
  v_cvt_pk_bf16_f32 v48, v112, v113
  v_cvt_pk_bf16_f32 v49, v114, v115
  v_cvt_pk_bf16_f32 v50, v116, v117
  v_cvt_pk_bf16_f32 v51, v118, v119
  ds_write_b128 v3, v[48:51] offset:6144
  v_cvt_pk_bf16_f32 v52, v120, v121
  v_cvt_pk_bf16_f32 v53, v122, v123
  v_cvt_pk_bf16_f32 v54, v124, v125
  v_cvt_pk_bf16_f32 v55, v126, v127
  ds_write_b128 v3, v[52:55] offset:7168
  s_waitcnt vmcnt(8)
  s_waitcnt lgkmcnt(0)
  s_barrier
  ds_read_b128 v[24:27], v8 offset:0
  ds_read_b128 v[28:31], v9 offset:0
  ds_read_b128 v[32:35], v10 offset:0
  ds_read_b128 v[36:39], v11 offset:0
  ds_read_b128 v[40:43], v12 offset:0
  ds_read_b128 v[44:47], v13 offset:0
  buffer_load_dword v23, off, s[4:7], s54 sc1
  v_mov_b32 v16, s30
  v_min_u32 v17, 1, v0
  v_lshlrev_b32 v17, 30, v17
  buffer_store_dword v16, v17, s[4:7], s31 offen sc1
  s_add_u32 s30, s30, 1
  s_add_u32 s52, s52, 2
  s_waitcnt lgkmcnt(5)
  v_mfma_f32_16x16x32_bf16 v[64:67], a[0:3], v[24:27], 0
  s_add_u32 s28, s19, 67108864
  ds_read_b128 v[48:51], v14 offset:0
  v_mfma_f32_16x16x32_bf16 v[68:71], a[4:7], v[24:27], 0
  v_mfma_f32_16x16x32_bf16 v[80:83], a[8:11], v[24:27], 0
  v_mfma_f32_16x16x32_bf16 v[84:87], a[12:15], v[24:27], 0
  s_waitcnt lgkmcnt(5)
  v_mfma_f32_16x16x32_bf16 v[72:75], a[0:3], v[28:31], 0
  ds_read_b128 v[52:55], v15 offset:0
  v_mfma_f32_16x16x32_bf16 v[76:79], a[4:7], v[28:31], 0
  v_mfma_f32_16x16x32_bf16 v[88:91], a[8:11], v[28:31], 0
  buffer_load_dwordx4 v[176:179], v21, s[4:7], s28 offen offset:0 sc1
  v_mfma_f32_16x16x32_bf16 v[92:95], a[12:15], v[28:31], 0
  s_waitcnt lgkmcnt(5)
  v_mfma_f32_16x16x32_bf16 v[64:67], a[16:19], v[32:35], v[64:67]
  ds_read_b128 v[24:27], v8 offset:8192
  v_mfma_f32_16x16x32_bf16 v[68:71], a[20:23], v[32:35], v[68:71]
  v_mfma_f32_16x16x32_bf16 v[80:83], a[24:27], v[32:35], v[80:83]
  v_mfma_f32_16x16x32_bf16 v[84:87], a[28:31], v[32:35], v[84:87]
  s_waitcnt lgkmcnt(5)
  v_mfma_f32_16x16x32_bf16 v[72:75], a[16:19], v[36:39], v[72:75]
  ds_read_b128 v[28:31], v9 offset:8192
  v_mfma_f32_16x16x32_bf16 v[76:79], a[20:23], v[36:39], v[76:79]
  v_mfma_f32_16x16x32_bf16 v[88:91], a[24:27], v[36:39], v[88:91]
  buffer_load_dwordx4 v[180:183], v21, s[4:7], s28 offen offset:1024 sc1
  v_mfma_f32_16x16x32_bf16 v[92:95], a[28:31], v[36:39], v[92:95]
  s_waitcnt lgkmcnt(5)
  v_mfma_f32_16x16x32_bf16 v[64:67], a[32:35], v[40:43], v[64:67]
  ds_read_b128 v[32:35], v10 offset:8192
  v_mfma_f32_16x16x32_bf16 v[68:71], a[36:39], v[40:43], v[68:71]
  v_mfma_f32_16x16x32_bf16 v[80:83], a[40:43], v[40:43], v[80:83]
  v_mfma_f32_16x16x32_bf16 v[84:87], a[44:47], v[40:43], v[84:87]
  s_waitcnt lgkmcnt(5)
  v_mfma_f32_16x16x32_bf16 v[72:75], a[32:35], v[44:47], v[72:75]
  ds_read_b128 v[36:39], v11 offset:8192
  v_mfma_f32_16x16x32_bf16 v[76:79], a[36:39], v[44:47], v[76:79]
  v_mfma_f32_16x16x32_bf16 v[88:91], a[40:43], v[44:47], v[88:91]
  buffer_load_dwordx4 v[184:187], v21, s[4:7], s28 offen offset:2048 sc1
  v_mfma_f32_16x16x32_bf16 v[92:95], a[44:47], v[44:47], v[92:95]
  s_waitcnt lgkmcnt(5)
  v_mfma_f32_16x16x32_bf16 v[64:67], a[48:51], v[48:51], v[64:67]
  ds_read_b128 v[40:43], v12 offset:8192
  v_mfma_f32_16x16x32_bf16 v[68:71], a[52:55], v[48:51], v[68:71]
  v_mfma_f32_16x16x32_bf16 v[80:83], a[56:59], v[48:51], v[80:83]
  v_mfma_f32_16x16x32_bf16 v[84:87], a[60:63], v[48:51], v[84:87]
  s_waitcnt lgkmcnt(5)
  v_mfma_f32_16x16x32_bf16 v[72:75], a[48:51], v[52:55], v[72:75]
  ds_read_b128 v[44:47], v13 offset:8192
  v_mfma_f32_16x16x32_bf16 v[76:79], a[52:55], v[52:55], v[76:79]
  v_mfma_f32_16x16x32_bf16 v[88:91], a[56:59], v[52:55], v[88:91]
  buffer_load_dwordx4 v[188:191], v21, s[4:7], s28 offen offset:3072 sc1
  v_mfma_f32_16x16x32_bf16 v[92:95], a[60:63], v[52:55], v[92:95]
  s_waitcnt lgkmcnt(5)
  v_mfma_f32_16x16x32_bf16 v[64:67], a[64:67], v[24:27], v[64:67]
  s_add_u32 s29, s19, 67112960
  ds_read_b128 v[48:51], v14 offset:8192
  v_mfma_f32_16x16x32_bf16 v[68:71], a[68:71], v[24:27], v[68:71]
  v_mfma_f32_16x16x32_bf16 v[80:83], a[72:75], v[24:27], v[80:83]
  v_mfma_f32_16x16x32_bf16 v[84:87], a[76:79], v[24:27], v[84:87]
  s_waitcnt lgkmcnt(5)
  v_mfma_f32_16x16x32_bf16 v[72:75], a[64:67], v[28:31], v[72:75]
  ds_read_b128 v[52:55], v15 offset:8192
  v_mfma_f32_16x16x32_bf16 v[76:79], a[68:71], v[28:31], v[76:79]
  v_mfma_f32_16x16x32_bf16 v[88:91], a[72:75], v[28:31], v[88:91]
  buffer_load_dwordx4 v[192:195], v21, s[4:7], s29 offen offset:0 sc1
  v_mfma_f32_16x16x32_bf16 v[92:95], a[76:79], v[28:31], v[92:95]
  s_waitcnt lgkmcnt(5)
  v_mfma_f32_16x16x32_bf16 v[64:67], a[80:83], v[32:35], v[64:67]
  ds_read_b128 v[24:27], v8 offset:16384
  v_mfma_f32_16x16x32_bf16 v[68:71], a[84:87], v[32:35], v[68:71]
  v_mfma_f32_16x16x32_bf16 v[80:83], a[88:91], v[32:35], v[80:83]
  v_mfma_f32_16x16x32_bf16 v[84:87], a[92:95], v[32:35], v[84:87]
  s_waitcnt lgkmcnt(5)
  v_mfma_f32_16x16x32_bf16 v[72:75], a[80:83], v[36:39], v[72:75]
  ds_read_b128 v[28:31], v9 offset:16384
  v_mfma_f32_16x16x32_bf16 v[76:79], a[84:87], v[36:39], v[76:79]
  v_mfma_f32_16x16x32_bf16 v[88:91], a[88:91], v[36:39], v[88:91]
  buffer_load_dwordx4 v[196:199], v21, s[4:7], s29 offen offset:1024 sc1
  v_mfma_f32_16x16x32_bf16 v[92:95], a[92:95], v[36:39], v[92:95]
  s_waitcnt lgkmcnt(5)
  v_mfma_f32_16x16x32_bf16 v[64:67], a[96:99], v[40:43], v[64:67]
  ds_read_b128 v[32:35], v10 offset:16384
  v_mfma_f32_16x16x32_bf16 v[68:71], a[100:103], v[40:43], v[68:71]
  v_mfma_f32_16x16x32_bf16 v[80:83], a[104:107], v[40:43], v[80:83]
  v_mfma_f32_16x16x32_bf16 v[84:87], a[108:111], v[40:43], v[84:87]
  s_waitcnt lgkmcnt(5)
  s_waitcnt vmcnt(7)
  v_readfirstlane_b32 s53, v23
  s_nop 0
  s_cmp_ge_u32 s53, s52
  s_cselect_b32 s24, 1, 0
  s_cbranch_scc0 F_nopre_251
  s_mov_b32 m0, s25
  s_nop 0
  buffer_load_dwordx4 v2, s[4:7], s20 offen offset:0 sc1 lds
  buffer_load_dwordx4 v2, s[4:7], s20 offen offset:1024 sc1 lds
  buffer_load_dwordx4 v2, s[4:7], s20 offen offset:2048 sc1 lds
  buffer_load_dwordx4 v2, s[4:7], s20 offen offset:3072 sc1 lds
F_nopre_251:
  v_mfma_f32_16x16x32_bf16 v[72:75], a[96:99], v[44:47], v[72:75]
  ds_read_b128 v[36:39], v11 offset:16384
  v_mfma_f32_16x16x32_bf16 v[76:79], a[100:103], v[44:47], v[76:79]
  v_mfma_f32_16x16x32_bf16 v[88:91], a[104:107], v[44:47], v[88:91]
  buffer_load_dwordx4 v[200:203], v21, s[4:7], s29 offen offset:2048 sc1
  v_mfma_f32_16x16x32_bf16 v[92:95], a[108:111], v[44:47], v[92:95]
  s_waitcnt lgkmcnt(5)
  v_mfma_f32_16x16x32_bf16 v[64:67], a[112:115], v[48:51], v[64:67]
  ds_read_b128 v[40:43], v12 offset:16384
  v_mfma_f32_16x16x32_bf16 v[68:71], a[116:119], v[48:51], v[68:71]
  v_mfma_f32_16x16x32_bf16 v[80:83], a[120:123], v[48:51], v[80:83]
  v_mfma_f32_16x16x32_bf16 v[84:87], a[124:127], v[48:51], v[84:87]
  s_waitcnt lgkmcnt(5)
  v_mfma_f32_16x16x32_bf16 v[72:75], a[112:115], v[52:55], v[72:75]
  ds_read_b128 v[44:47], v13 offset:16384
  v_mfma_f32_16x16x32_bf16 v[76:79], a[116:119], v[52:55], v[76:79]
  v_mfma_f32_16x16x32_bf16 v[88:91], a[120:123], v[52:55], v[88:91]
  buffer_load_dwordx4 v[204:207], v21, s[4:7], s29 offen offset:3072 sc1
  v_mfma_f32_16x16x32_bf16 v[92:95], a[124:127], v[52:55], v[92:95]
  s_waitcnt lgkmcnt(5)
  v_mfma_f32_16x16x32_bf16 v[64:67], a[128:131], v[24:27], v[64:67]
  s_add_u32 s28, s19, 83886080
  ds_read_b128 v[48:51], v14 offset:16384
  v_mfma_f32_16x16x32_bf16 v[68:71], a[132:135], v[24:27], v[68:71]
  v_mfma_f32_16x16x32_bf16 v[80:83], a[136:139], v[24:27], v[80:83]
  v_mfma_f32_16x16x32_bf16 v[84:87], a[140:143], v[24:27], v[84:87]
  s_waitcnt lgkmcnt(5)
  v_mfma_f32_16x16x32_bf16 v[72:75], a[128:131], v[28:31], v[72:75]
  ds_read_b128 v[52:55], v15 offset:16384
  v_mfma_f32_16x16x32_bf16 v[76:79], a[132:135], v[28:31], v[76:79]
  v_mfma_f32_16x16x32_bf16 v[88:91], a[136:139], v[28:31], v[88:91]
  buffer_load_dwordx4 v[208:211], v21, s[4:7], s28 offen offset:0 sc1
  v_mfma_f32_16x16x32_bf16 v[92:95], a[140:143], v[28:31], v[92:95]
  s_waitcnt lgkmcnt(5)
  v_mfma_f32_16x16x32_bf16 v[64:67], a[144:147], v[32:35], v[64:67]
  ds_read_b128 v[24:27], v8 offset:24576
  v_mfma_f32_16x16x32_bf16 v[68:71], a[148:151], v[32:35], v[68:71]
  v_mfma_f32_16x16x32_bf16 v[80:83], a[152:155], v[32:35], v[80:83]
  v_mfma_f32_16x16x32_bf16 v[84:87], a[156:159], v[32:35], v[84:87]
  s_waitcnt lgkmcnt(5)
  v_mfma_f32_16x16x32_bf16 v[72:75], a[144:147], v[36:39], v[72:75]
  ds_read_b128 v[28:31], v9 offset:24576
  v_mfma_f32_16x16x32_bf16 v[76:79], a[148:151], v[36:39], v[76:79]
  v_mfma_f32_16x16x32_bf16 v[88:91], a[152:155], v[36:39], v[88:91]
  buffer_load_dwordx4 v[212:215], v21, s[4:7], s28 offen offset:1024 sc1
  v_mfma_f32_16x16x32_bf16 v[92:95], a[156:159], v[36:39], v[92:95]
  s_waitcnt lgkmcnt(5)
  v_mfma_f32_16x16x32_bf16 v[64:67], a[160:163], v[40:43], v[64:67]
  ds_read_b128 v[32:35], v10 offset:24576
  v_mfma_f32_16x16x32_bf16 v[68:71], a[164:167], v[40:43], v[68:71]
  v_mfma_f32_16x16x32_bf16 v[80:83], a[168:171], v[40:43], v[80:83]
  v_mfma_f32_16x16x32_bf16 v[84:87], a[172:175], v[40:43], v[84:87]
  s_waitcnt lgkmcnt(5)
  v_mfma_f32_16x16x32_bf16 v[72:75], a[160:163], v[44:47], v[72:75]
  ds_read_b128 v[36:39], v11 offset:24576
  v_mfma_f32_16x16x32_bf16 v[76:79], a[164:167], v[44:47], v[76:79]
  v_mfma_f32_16x16x32_bf16 v[88:91], a[168:171], v[44:47], v[88:91]
  buffer_load_dwordx4 v[216:219], v21, s[4:7], s28 offen offset:2048 sc1
  v_mfma_f32_16x16x32_bf16 v[92:95], a[172:175], v[44:47], v[92:95]
  s_waitcnt lgkmcnt(5)
  v_mfma_f32_16x16x32_bf16 v[64:67], a[176:179], v[48:51], v[64:67]
  ds_read_b128 v[40:43], v12 offset:24576
  v_mfma_f32_16x16x32_bf16 v[68:71], a[180:183], v[48:51], v[68:71]
  v_mfma_f32_16x16x32_bf16 v[80:83], a[184:187], v[48:51], v[80:83]
  v_mfma_f32_16x16x32_bf16 v[84:87], a[188:191], v[48:51], v[84:87]
  s_waitcnt lgkmcnt(5)
  v_mfma_f32_16x16x32_bf16 v[72:75], a[176:179], v[52:55], v[72:75]
  ds_read_b128 v[44:47], v13 offset:24576
  v_mfma_f32_16x16x32_bf16 v[76:79], a[180:183], v[52:55], v[76:79]
  v_mfma_f32_16x16x32_bf16 v[88:91], a[184:187], v[52:55], v[88:91]
  buffer_load_dwordx4 v[220:223], v21, s[4:7], s28 offen offset:3072 sc1
  v_mfma_f32_16x16x32_bf16 v[92:95], a[188:191], v[52:55], v[92:95]
  s_waitcnt lgkmcnt(5)
  v_mfma_f32_16x16x32_bf16 v[64:67], a[192:195], v[24:27], v[64:67]
  s_add_u32 s29, s19, 83890176
  ds_read_b128 v[48:51], v14 offset:24576
  v_mfma_f32_16x16x32_bf16 v[68:71], a[196:199], v[24:27], v[68:71]
  v_mfma_f32_16x16x32_bf16 v[80:83], a[200:203], v[24:27], v[80:83]
  v_mfma_f32_16x16x32_bf16 v[84:87], a[204:207], v[24:27], v[84:87]
  s_waitcnt lgkmcnt(5)
  v_mfma_f32_16x16x32_bf16 v[72:75], a[192:195], v[28:31], v[72:75]
  ds_read_b128 v[52:55], v15 offset:24576
  v_mfma_f32_16x16x32_bf16 v[76:79], a[196:199], v[28:31], v[76:79]
  v_mfma_f32_16x16x32_bf16 v[88:91], a[200:203], v[28:31], v[88:91]
  buffer_load_dwordx4 v[224:227], v21, s[4:7], s29 offen offset:0 sc1
  v_mfma_f32_16x16x32_bf16 v[92:95], a[204:207], v[28:31], v[92:95]
  s_waitcnt lgkmcnt(5)
  v_mfma_f32_16x16x32_bf16 v[64:67], a[208:211], v[32:35], v[64:67]
  v_mfma_f32_16x16x32_bf16 v[68:71], a[212:215], v[32:35], v[68:71]
  v_mfma_f32_16x16x32_bf16 v[80:83], a[216:219], v[32:35], v[80:83]
  v_mfma_f32_16x16x32_bf16 v[84:87], a[220:223], v[32:35], v[84:87]
  s_waitcnt lgkmcnt(4)
  v_mfma_f32_16x16x32_bf16 v[72:75], a[208:211], v[36:39], v[72:75]
  v_mfma_f32_16x16x32_bf16 v[76:79], a[212:215], v[36:39], v[76:79]
  v_xor_b32 v8, 0x8000, v8
  v_mfma_f32_16x16x32_bf16 v[88:91], a[216:219], v[36:39], v[88:91]
  buffer_load_dwordx4 v[228:231], v21, s[4:7], s29 offen offset:1024 sc1
  v_mfma_f32_16x16x32_bf16 v[92:95], a[220:223], v[36:39], v[92:95]
  s_waitcnt lgkmcnt(3)
  v_xor_b32 v9, 0x8000, v9
  v_mfma_f32_16x16x32_bf16 v[64:67], a[224:227], v[40:43], v[64:67]
  v_mfma_f32_16x16x32_bf16 v[68:71], a[228:231], v[40:43], v[68:71]
  v_xor_b32 v10, 0x8000, v10
  v_mfma_f32_16x16x32_bf16 v[80:83], a[232:235], v[40:43], v[80:83]
  v_mfma_f32_16x16x32_bf16 v[84:87], a[236:239], v[40:43], v[84:87]
  s_waitcnt lgkmcnt(2)
  v_xor_b32 v11, 0x8000, v11
  v_mfma_f32_16x16x32_bf16 v[72:75], a[224:227], v[44:47], v[72:75]
  v_mfma_f32_16x16x32_bf16 v[76:79], a[228:231], v[44:47], v[76:79]
  v_xor_b32 v12, 0x8000, v12
  v_mfma_f32_16x16x32_bf16 v[88:91], a[232:235], v[44:47], v[88:91]
  buffer_load_dwordx4 v[232:235], v21, s[4:7], s29 offen offset:2048 sc1
  v_mfma_f32_16x16x32_bf16 v[92:95], a[236:239], v[44:47], v[92:95]
  s_waitcnt lgkmcnt(1)
  v_xor_b32 v13, 0x8000, v13
  v_mfma_f32_16x16x32_bf16 v[64:67], a[240:243], v[48:51], v[64:67]
  v_mfma_f32_16x16x32_bf16 v[68:71], a[244:247], v[48:51], v[68:71]
  v_xor_b32 v14, 0x8000, v14
  v_mfma_f32_16x16x32_bf16 v[80:83], a[248:251], v[48:51], v[80:83]
  v_mfma_f32_16x16x32_bf16 v[84:87], a[252:255], v[48:51], v[84:87]
  s_waitcnt lgkmcnt(0)
  v_xor_b32 v15, 0x8000, v15
  v_mfma_f32_16x16x32_bf16 v[72:75], a[240:243], v[52:55], v[72:75]
  v_mfma_f32_16x16x32_bf16 v[76:79], a[244:247], v[52:55], v[76:79]
  v_xor_b32 v3, 0x8000, v3
  v_mfma_f32_16x16x32_bf16 v[88:91], a[248:251], v[52:55], v[88:91]
  buffer_load_dwordx4 v[236:239], v21, s[4:7], s29 offen offset:3072 sc1
  v_mfma_f32_16x16x32_bf16 v[92:95], a[252:255], v[52:55], v[92:95]
  s_cmp_gt_u32 s23, 0
  s_cbranch_scc1 F_top_234
  s_nop 2
  v_cvt_pk_bf16_f32 v128, v64, v65
  v_cvt_pk_bf16_f32 v129, v66, v67
  v_cvt_pk_bf16_f32 v130, v68, v69
  v_cvt_pk_bf16_f32 v131, v70, v71
  buffer_store_dwordx4 v[128:131], v22, s[4:7], s21 offen offset:0 sc1
  v_cvt_pk_bf16_f32 v132, v72, v73
  v_cvt_pk_bf16_f32 v133, v74, v75
  v_cvt_pk_bf16_f32 v134, v76, v77
  v_cvt_pk_bf16_f32 v135, v78, v79
  buffer_store_dwordx4 v[132:135], v22, s[4:7], s21 offen offset:256 sc1
  v_cvt_pk_bf16_f32 v136, v80, v81
  v_cvt_pk_bf16_f32 v137, v82, v83
  v_cvt_pk_bf16_f32 v138, v84, v85
  v_cvt_pk_bf16_f32 v139, v86, v87
  buffer_store_dwordx4 v[136:139], v22, s[4:7], s21 offen offset:2048 sc1
  v_cvt_pk_bf16_f32 v140, v88, v89
  v_cvt_pk_bf16_f32 v141, v90, v91
  v_cvt_pk_bf16_f32 v142, v92, v93
  v_cvt_pk_bf16_f32 v143, v94, v95
  buffer_store_dwordx4 v[140:143], v22, s[4:7], s21 offen offset:2304 sc1
  s_waitcnt vmcnt(0) lgkmcnt(0)
  s_barrier
  v_mov_b32 v144, s30
  v_min_u32 v145, 1, v0
  v_lshlrev_b32 v145, 30, v145
  buffer_store_dword v144, v145, s[4:7], s31 offen sc1
M_done:
M_exit:
  s_endpgm
.p2align 6
.type M_table,@object
M_table:
.long 0x1, 0x3f, 0xffffffff, 0x17, 0x1, 0x7, 0x800, 0x0, 0x8, 0x0, 0x0, 0x0, 0x0, 0x0, 0x0, 0x0
.long 0x1, 0x28, 0xffffffff, 0x1b, 0x1, 0x6, 0x1000, 0x0, 0x8, 0x1, 0x0, 0x0, 0x0, 0x0, 0x0, 0x0
.long 0x2, 0x0, 0x2, 0x20, 0x1, 0x5, 0x1800, 0x0, 0x8, 0x0, 0x0, 0x0, 0x0, 0x0, 0x0, 0x0
.long 0x2, 0x1, 0x2, 0x20, 0x1, 0x4, 0x2000, 0x0, 0x8, 0x1, 0x0, 0x0, 0x0, 0x0, 0x0, 0x0
.long 0x0, 0x0, 0x1, 0x20, 0x2, 0x3, 0x20, 0x0, 0x8, 0x2, 0x0, 0x0, 0x0, 0x0, 0x0, 0x0
.long 0x0, 0x3f, 0xffffffff, 0x20, 0x2, 0x2, 0x18, 0x1, 0x10, 0x0, 0x0, 0x0, 0x0, 0x0, 0x0, 0x0
.long 0x1, 0xd, 0xffffffff, 0xe, 0x0, 0x0, 0x8, 0x0, 0x8, 0x2, 0x0, 0x0, 0x0, 0x0, 0x0, 0x0
.size M_table, 448
.section .rodata,"a"
.p2align 6
.amdhsa_kernel gated_mix__compressed_kv_cla__memory_aug_recurrent_mem_tr__prompt_kernel
.amdhsa_next_free_vgpr 512
.amdhsa_next_free_sgpr 102
.amdhsa_accum_offset 256
.amdhsa_group_segment_fixed_size 0
.amdhsa_kernarg_size 136
.amdhsa_user_sgpr_count 2
.amdhsa_user_sgpr_kernarg_segment_ptr 1
.amdhsa_system_sgpr_workgroup_id_x 1
.end_amdhsa_kernel
```

```asm
; @launch grid=(256,1,1) block=(256,1,1) lds=163840
.amdgcn_target "amdgcn-amd-amdhsa--gfx950"
.text
.globl gated_mix__compressed_kv_cla__memory_aug_recurrent_mem_tr__prompt_kernel
.p2align 8
.type gated_mix__compressed_kv_cla__memory_aug_recurrent_mem_tr__prompt_kernel,@function
gated_mix__compressed_kv_cla__memory_aug_recurrent_mem_tr__prompt_kernel:
  s_cmp_ge_u32 s2, 256
  s_cbranch_scc1 M_exit
  s_getpc_b64 s[60:61]
M_pc0:
  s_lshr_b32 s62, s2, 3
  s_and_b32 s62, s62, 3
  s_lshl_b32 s62, s62, 15
  v_lshl_add_u32 v104, v0, 7, s62
  v_min_u32 v104, M_table-M_pc0, v104
  global_load_dword v105, v104, s[60:61]
  s_lshr_b32 s77, s2, 3
  s_and_b32 s76, s2, 7
  s_cbranch_scc1 M_worker
  s_mov_b32 s12, s77
  s_load_dwordx4 s[60:63], s[0:1], 64
  s_load_dwordx4 s[64:67], s[0:1], 80
  s_load_dwordx4 s[68:71], s[0:1], 120
  s_load_dwordx2 s[72:73], s[0:1], 56
  v_lshrrev_b32 v1, 6, v0
  v_and_b32 v20, 63, v0
  v_readfirstlane_b32 s13, v1
  v_lshrrev_b32 v26, 3, v20
  v_lshlrev_b32 v26, 10, v26
  v_and_b32 v1, 7, v20
  v_lshl_add_u32 v26, v1, 4, v26
  s_lshl_b32 s36, s13, 7
  s_lshl_b32 s38, s12, 17
  s_add_u32 s36, s36, s38
  v_add_u32 v26, s36, v26
  s_lshl_b32 s39, s13, 15
  s_add_u32 s39, s39, 32768
  s_waitcnt lgkmcnt(0)
  s_mov_b32 s48, s66
  s_and_b32 s49, s67, 0xffff
  s_mov_b32 s50, 0x400000
  s_mov_b32 s51, 0x20000
  s_xor_b32 s36, s13, 0
  s_lshl_b32 s36, s36, 15
  s_add_u32 m0, s39, 28672
  s_add_u32 s37, s36, 0
  buffer_load_dwordx4 v26, s[48:51], s37 offen lds
  s_add_u32 m0, s39, 29696
  s_add_u32 s37, s36, 8192
  buffer_load_dwordx4 v26, s[48:51], s37 offen lds
  s_add_u32 m0, s39, 30720
  s_add_u32 s37, s36, 16384
  buffer_load_dwordx4 v26, s[48:51], s37 offen lds
  s_add_u32 m0, s39, 31744
  s_add_u32 s37, s36, 24576
  buffer_load_dwordx4 v26, s[48:51], s37 offen lds
  s_xor_b32 s36, s13, 0
  s_lshl_b32 s36, s36, 15
  s_add_u32 m0, s39, 24576
  s_add_u32 s37, s36, 512
  buffer_load_dwordx4 v26, s[48:51], s37 offen lds
  s_add_u32 m0, s39, 25600
  s_add_u32 s37, s36, 8704
  buffer_load_dwordx4 v26, s[48:51], s37 offen lds
  s_add_u32 m0, s39, 26624
  s_add_u32 s37, s36, 16896
  buffer_load_dwordx4 v26, s[48:51], s37 offen lds
  s_add_u32 m0, s39, 27648
  s_add_u32 s37, s36, 25088
  buffer_load_dwordx4 v26, s[48:51], s37 offen lds
  s_xor_b32 s36, s13, 1
  s_lshl_b32 s36, s36, 15
  s_add_u32 m0, s39, 12288
  s_add_u32 s37, s36, 0
  buffer_load_dwordx4 v26, s[48:51], s37 offen lds
  s_add_u32 m0, s39, 13312
  s_add_u32 s37, s36, 8192
  buffer_load_dwordx4 v26, s[48:51], s37 offen lds
  s_add_u32 m0, s39, 14336
  s_add_u32 s37, s36, 16384
  buffer_load_dwordx4 v26, s[48:51], s37 offen lds
  s_add_u32 m0, s39, 15360
  s_add_u32 s37, s36, 24576
  buffer_load_dwordx4 v26, s[48:51], s37 offen lds
  s_xor_b32 s36, s13, 1
  s_lshl_b32 s36, s36, 15
  s_add_u32 m0, s39, 8192
  s_add_u32 s37, s36, 512
  buffer_load_dwordx4 v26, s[48:51], s37 offen lds
  s_add_u32 m0, s39, 9216
  s_add_u32 s37, s36, 8704
  buffer_load_dwordx4 v26, s[48:51], s37 offen lds
  s_add_u32 m0, s39, 10240
  s_add_u32 s37, s36, 16896
  buffer_load_dwordx4 v26, s[48:51], s37 offen lds
  s_add_u32 m0, s39, 11264
  s_add_u32 s37, s36, 25088
  buffer_load_dwordx4 v26, s[48:51], s37 offen lds
  s_mov_b32 s8, s60
  s_and_b32 s9, s61, 0xffff
  s_mov_b32 s10, 0x400000
  s_mov_b32 s11, 0x20000
  s_mov_b32 s40, s62
  s_and_b32 s41, s63, 0xffff
  s_mov_b32 s42, 0x400000
  s_mov_b32 s43, 0x20000
  s_mov_b32 s44, s64
  s_and_b32 s45, s65, 0xffff
  s_mov_b32 s46, 0x400000
  s_mov_b32 s47, 0x20000
  s_mov_b32 s4, s70
  s_and_b32 s5, s71, 0xffff
  s_mov_b32 s6, 0x10000000
  s_mov_b32 s7, 0x20000
  s_mov_b32 s76, s72
  s_and_b32 s77, s73, 0xffff
  s_mov_b32 s78, 0x2000
  s_mov_b32 s79, 0x20000
  s_mov_b32 s72, s68
  s_and_b32 s73, s69, 0xffff
  s_mov_b32 s74, 0x100
  s_mov_b32 s75, 0x20000
  s_mov_b64 s[52:53], s[68:69]
  s_mov_b64 s[58:59], s[70:71]
  s_mul_i32 s99, s12, 896
  s_add_u32 s99, s99, 148898048
  s_lshl_b32 s15, s12, 7
  s_add_u32 s15, s15, 148926464
  v_lshrrev_b32 v21, 4, v20
  v_and_b32 v22, 15, v20
  v_and_b32 v23, 1, v21
  v_lshrrev_b32 v24, 1, v21
  v_lshlrev_b32 v2, 4, v20
  s_lshl_b32 s36, s13, 10
  v_add_u32 v59, s36, v2
  s_mov_b32 s37, s39
  v_add_u32 v4, s37, v2
  v_lshrrev_b32 v25, 2, v20
  v_lshlrev_b32 v25, 13, v25
  v_and_b32 v1, 3, v20
  v_lshl_add_u32 v25, v1, 4, v25
  s_lshl_b32 s36, s13, 6
  s_lshl_b32 s38, s12, 8
  s_add_u32 s36, s36, s38
  v_add_u32 v25, s36, v25
  v_bfe_u32 v29, v20, 2, 1
  v_bfe_u32 v30, v20, 3, 1
  v_and_b32 v31, 3, v20
  v_lshl_add_u32 v27, v21, 2, v29
  v_lshlrev_b32 v27, 6, v27
  v_lshl_add_u32 v27, v30, 5, v27
  v_lshl_add_u32 v27, v31, 3, v27
  v_add_u32 v27, s37, v27
  v_xor_b32 v36, 1, v30
  v_lshl_add_u32 v36, v36, 11, v27
  v_lshl_add_u32 v27, v30, 11, v27
  v_lshl_add_u32 v28, v23, 2, v24
  v_lshl_add_u32 v28, v28, 2, v29
  v_lshlrev_b32 v28, 7, v28
  v_lshl_add_u32 v28, v30, 6, v28
  v_lshl_add_u32 v28, v31, 4, v28
  v_add_u32 v28, s37, v28
  v_lshrrev_b32 v25, 3, v20
  v_lshlrev_b32 v25, 13, v25
  v_and_b32 v1, 7, v20
  v_lshl_add_u32 v25, v1, 4, v25
  s_lshr_b32 s36, s13, 1
  s_lshl1_add_u32 s36, s12, s36
  s_lshl_b32 s36, s36, 7
  v_add_u32 v25, s36, v25
  v_lshl_add_u32 v27, v21, 2, v29
  v_lshlrev_b32 v27, 7, v27
  v_lshl_add_u32 v27, v30, 5, v27
  v_lshl_add_u32 v27, v31, 3, v27
  s_and_b32 s36, s13, 1
  s_lshl_b32 s36, s36, 6
  s_xor_b32 s37, s13, 1
  s_lshl_b32 s37, s37, 15
  s_add_u32 s37, s37, s36
  s_add_u32 s37, s37, 32768
  s_add_u32 s36, s36, s39
  v_add_u32 v36, s37, v27
  v_add_u32 v27, s36, v27
  v_lshlrev_b32 v101, 12, v30
  v_xor_b32 v100, 0x1000, v101
  v_mov_b32 v0, 0x4444
  v_mov_b32 v1, 0xeeee
  v_cmp_lt_u32 vcc, 7, v22
  s_nop 1
  v_cndmask_b32 v32, v0, v1, vcc
  v_mov_b32 v0, v32
  v_and_b32 v32, 7, v20
  v_lshlrev_b32 v32, 4, v32
  v_lshl_add_u32 v11, v21, 7, v32
  v_xor_b32 v1, 128, v2
  v_lshl_add_u32 v33, v24, 4, v22
  s_lshl_b32 s36, s13, 5
  v_add_u32 v33, s36, v33
  v_lshlrev_b32 v33, 3, v33
  v_mul_u32_u24 v34, 1152, v23
  v_add_u32 v5, v33, v34
  v_bfe_u32 v33, v20, 2, 2
  v_lshl_add_u32 v33, v23, 2, v33
  v_lshl_add_u32 v33, v24, 4, v33
  v_lshlrev_b32 v33, 3, v33
  v_and_b32 v34, 1, v20
  v_mul_u32_u24 v34, 1152, v34
  v_add_u32 v6, v33, v34
  s_lshl_b32 s36, s13, 3
  v_lshrrev_b32 v33, 3, v20
  v_add_u32 v33, s36, v33
  v_mul_u32_u24 v34, 0, v33
  v_add_u32 v34, s12, v34
  v_and_b32 v34, 31, v34
  v_lshrrev_b32 v37, 1, v32
  v_lshl_add_u32 v33, v33, 13, v37
  v_lshl_add_u32 v7, v34, 7, v33
  v_and_b32 v37, 1, v20
  v_bfe_u32 v38, v20, 1, 1
  v_lshl_add_u32 v37, v29, 1, v37
  s_lshr_b32 s36, s12, 3
  s_lshl_b32 s36, s36, 10
  s_and_b32 s37, s12, 1
  s_lshl_b32 s37, s37, 9
  s_add_u32 s36, s36, s37
  s_and_b32 s37, s12, 6
  s_lshl_b32 s37, s37, 5
  s_add_u32 s36, s36, s37
  v_lshlrev_b32 v33, 4, v21
  v_lshl_add_u32 v33, v37, 2, v33
  v_lshl_add_u32 v33, v38, 8, v33
  v_lshl_add_u32 v33, v30, 30, v33
  v_add_u32 v8, s36, v33
  v_mov_b32 v39, v21
  s_lshr_b32 s36, s12, 2
  s_lshl_b32 s36, s36, 6
  s_and_b32 s37, s12, 1
  s_lshl_b32 s37, s37, 5
  s_add_u32 s36, s36, s37
  s_and_b32 s37, s12, 2
  s_lshl_b32 s37, s37, 11
  s_add_u32 s36, s36, s37
  v_lshlrev_b32 v35, 10, v39
  v_lshl_add_u32 v35, v37, 2, v35
  v_lshl_add_u32 v35, v38, 4, v35
  v_add_u32 v35, s36, v35
  buffer_load_ushort v44, v35, s[76:79], 0 offen offset:0
  buffer_load_ushort v45, v35, s[76:79], 0 offen offset:2
  buffer_load_ushort v46, v35, s[76:79], 0 offen offset:512
  buffer_load_ushort v47, v35, s[76:79], 0 offen offset:514
  v_lshlrev_b32 v33, 4, v29
  v_mov_b32 v34, 0x3f80
  v_lshlrev_b32 v33, v33, v34
  v_and_b32 v34, 1, v20
  v_lshl_add_u32 v34, v34, 1, v30
  v_cmp_eq_u32 vcc, 0, v34
  s_nop 1
  v_cndmask_b32 v48, 0, v33, vcc
  v_cmp_eq_u32 vcc, 1, v34
  s_nop 1
  v_cndmask_b32 v49, 0, v33, vcc
  v_cmp_eq_u32 vcc, 2, v34
  s_nop 1
  v_cndmask_b32 v50, 0, v33, vcc
  v_cmp_eq_u32 vcc, 3, v34
  s_nop 1
  v_cndmask_b32 v51, 0, v33, vcc
  ds_write_b128 v2, v[48:51] offset:31232
  v_lshlrev_b32 v33, 9, v21
  s_lshl_b32 s36, s13, 11
  v_add_u32 v33, s36, v33
  v_lshl_add_u32 v10, v22, 4, v33
  v_lshl_add_u32 v33, v30, 8, v33
  v_add_u32 v9, v33, v32
  v_mov_b32 v12, 0x3f803f80
  v_mov_b32 v13, 0x3f803f80
  v_mov_b32 v14, 0x3f803f80
  v_mov_b32 v15, 0x3f803f80
  s_mov_b32 s2, 0x3f803f80
  s_mov_b32 s3, 0x3f803f80
  s_mov_b32 s98, 0
  v_and_b32 v33, 1, v20
  v_mul_u32_u24 v33, 128, v33
  v_min_u32 v34, 1, v20
  v_lshlrev_b32 v34, 30, v34
  s_cmp_eq_u32 s13, 3
  s_cselect_b64 vcc, -1, 0
  v_cndmask_b32 v19, v34, v33, vcc
  v_mov_b64 v[60:61], 0
  v_mov_b32 v62, 32256
  ds_write_b64 v62, v[60:61]
  s_mov_b32 s16, 0
  s_mov_b32 s17, -1
  s_mov_b32 s18, 0x3e0293ee
  s_mov_b32 s54, 0x2f800000
  s_mov_b32 s55, 0x28000000
  s_mov_b32 s96, s55
  s_lshl_b32 s36, s13, 10
  s_add_u32 s31, s36, 8192
  s_add_u32 s32, s36, 12160
  s_add_u32 s33, s36, 16384
  s_add_u32 s34, s36, 20224
  s_lshl_b32 s36, s12, 19
  s_add_u32 s27, s36, 67108864
  s_add_u32 s28, s36, 83886080
  s_mul_i32 s36, s12, 4096
  s_add_u32 s29, s36, 135266304
  s_lshl_b32 s36, s12, 13
  s_add_u32 s22, s36, 144703488
  s_add_u32 s23, s36, 144707584
  s_mov_b32 s20, 144703488
  s_mov_b32 s21, 144707584
  v_mov_b32 v40, -1
  v_mov_b32 v41, -1
  v_mov_b32 v42, -1
  v_mov_b32 v43, -1
  s_lshl_b32 s36, s13, 13
  s_add_u32 s36, s36, 145752064
  s_add_u32 s37, s36, 4096
  buffer_store_dwordx4 v[40:43], v59, s[4:7], s22 offen sc1
  buffer_store_dwordx4 v[40:43], v59, s[4:7], s23 offen sc1
  buffer_store_dword v40, v8, s[4:7], s36 offen sc1
  buffer_store_dword v40, v8, s[4:7], s37 offen sc1
  v_mov_b32 v52, 0
  v_min_u32 v53, 1, v59
  v_lshlrev_b32 v53, 30, v53
  buffer_store_dword v52, v53, s[4:7], s15 offen sc1
  s_waitcnt vmcnt(21)
  ds_read_b64_tr_b16 a[160:161], v28 offset:28672
  ds_read_b64_tr_b16 a[162:163], v28 offset:28928
  ds_read_b64_tr_b16 a[164:165], v28 offset:29696
  ds_read_b64_tr_b16 a[166:167], v28 offset:29952
  ds_read_b64_tr_b16 a[168:169], v28 offset:28680
  ds_read_b64_tr_b16 a[170:171], v28 offset:28936
  ds_read_b64_tr_b16 a[172:173], v28 offset:29704
  ds_read_b64_tr_b16 a[174:175], v28 offset:29960
  s_waitcnt lgkmcnt(0)
  s_waitcnt vmcnt(17)
  ds_read_b64_tr_b16 a[176:177], v28 offset:24576
  ds_read_b64_tr_b16 a[178:179], v28 offset:24832
  ds_read_b64_tr_b16 a[180:181], v28 offset:25600
  ds_read_b64_tr_b16 a[182:183], v28 offset:25856
  ds_read_b64_tr_b16 a[184:185], v28 offset:24584
  ds_read_b64_tr_b16 a[186:187], v28 offset:24840
  ds_read_b64_tr_b16 a[188:189], v28 offset:25608
  ds_read_b64_tr_b16 a[190:191], v28 offset:25864
  s_waitcnt lgkmcnt(0)
  s_xor_b32 s36, s13, 2
  s_lshl_b32 s36, s36, 15
  s_add_u32 m0, s39, 28672
  s_add_u32 s37, s36, 0
  buffer_load_dwordx4 v26, s[48:51], s37 offen lds
  s_add_u32 m0, s39, 29696
  s_add_u32 s37, s36, 8192
  buffer_load_dwordx4 v26, s[48:51], s37 offen lds
  s_add_u32 m0, s39, 30720
  s_add_u32 s37, s36, 16384
  buffer_load_dwordx4 v26, s[48:51], s37 offen lds
  s_add_u32 m0, s39, 31744
  s_add_u32 s37, s36, 24576
  buffer_load_dwordx4 v26, s[48:51], s37 offen lds
  s_xor_b32 s36, s13, 3
  s_lshl_b32 s36, s36, 15
  s_add_u32 m0, s39, 24576
  s_add_u32 s37, s36, 0
  buffer_load_dwordx4 v26, s[48:51], s37 offen lds
  s_add_u32 m0, s39, 25600
  s_add_u32 s37, s36, 8192
  buffer_load_dwordx4 v26, s[48:51], s37 offen lds
  s_add_u32 m0, s39, 26624
  s_add_u32 s37, s36, 16384
  buffer_load_dwordx4 v26, s[48:51], s37 offen lds
  s_add_u32 m0, s39, 27648
  s_add_u32 s37, s36, 24576
  buffer_load_dwordx4 v26, s[48:51], s37 offen lds
  s_waitcnt vmcnt(21)
  ds_read_b64_tr_b16 a[192:193], v28 offset:12288
  ds_read_b64_tr_b16 a[194:195], v28 offset:12544
  ds_read_b64_tr_b16 a[196:197], v28 offset:13312
  ds_read_b64_tr_b16 a[198:199], v28 offset:13568
  ds_read_b64_tr_b16 a[200:201], v28 offset:12296
  ds_read_b64_tr_b16 a[202:203], v28 offset:12552
  ds_read_b64_tr_b16 a[204:205], v28 offset:13320
  ds_read_b64_tr_b16 a[206:207], v28 offset:13576
  s_waitcnt lgkmcnt(0)
  s_waitcnt vmcnt(17)
  ds_read_b64_tr_b16 a[208:209], v28 offset:8192
  ds_read_b64_tr_b16 a[210:211], v28 offset:8448
  ds_read_b64_tr_b16 a[212:213], v28 offset:9216
  ds_read_b64_tr_b16 a[214:215], v28 offset:9472
  ds_read_b64_tr_b16 a[216:217], v28 offset:8200
  ds_read_b64_tr_b16 a[218:219], v28 offset:8456
  ds_read_b64_tr_b16 a[220:221], v28 offset:9224
  ds_read_b64_tr_b16 a[222:223], v28 offset:9480
  s_waitcnt lgkmcnt(0)
  s_xor_b32 s36, s13, 2
  s_lshl_b32 s36, s36, 19
  s_add_u32 m0, s39, 12288
  s_add_u32 s37, s36, 0
  buffer_load_dwordx4 v25, s[8:11], s37 offen lds
  s_add_u32 m0, s39, 13312
  s_add_u32 s37, s36, 65536
  buffer_load_dwordx4 v25, s[8:11], s37 offen lds
  s_add_u32 m0, s39, 14336
  s_add_u32 s37, s36, 131072
  buffer_load_dwordx4 v25, s[8:11], s37 offen lds
  s_add_u32 m0, s39, 15360
  s_add_u32 s37, s36, 196608
  buffer_load_dwordx4 v25, s[8:11], s37 offen lds
  s_xor_b32 s36, s13, 2
  s_lshl_b32 s36, s36, 19
  s_add_u32 m0, s39, 8192
  s_add_u32 s37, s36, 262144
  buffer_load_dwordx4 v25, s[8:11], s37 offen lds
  s_add_u32 m0, s39, 9216
  s_add_u32 s37, s36, 327680
  buffer_load_dwordx4 v25, s[8:11], s37 offen lds
  s_add_u32 m0, s39, 10240
  s_add_u32 s37, s36, 393216
  buffer_load_dwordx4 v25, s[8:11], s37 offen lds
  s_add_u32 m0, s39, 11264
  s_add_u32 s37, s36, 458752
  buffer_load_dwordx4 v25, s[8:11], s37 offen lds
  s_waitcnt vmcnt(12)
  ds_read_b64_tr_b16 a[224:225], v28 offset:28672
  ds_read_b64_tr_b16 a[226:227], v28 offset:28928
  ds_read_b64_tr_b16 a[228:229], v28 offset:29696
  ds_read_b64_tr_b16 a[230:231], v28 offset:29952
  ds_read_b64_tr_b16 a[232:233], v28 offset:28680
  ds_read_b64_tr_b16 a[234:235], v28 offset:28936
  ds_read_b64_tr_b16 a[236:237], v28 offset:29704
  ds_read_b64_tr_b16 a[238:239], v28 offset:29960
  s_waitcnt lgkmcnt(0)
  s_waitcnt vmcnt(8)
  ds_read_b64_tr_b16 a[240:241], v28 offset:24576
  ds_read_b64_tr_b16 a[242:243], v28 offset:24832
  ds_read_b64_tr_b16 a[244:245], v28 offset:25600
  ds_read_b64_tr_b16 a[246:247], v28 offset:25856
  ds_read_b64_tr_b16 a[248:249], v28 offset:24584
  ds_read_b64_tr_b16 a[250:251], v28 offset:24840
  ds_read_b64_tr_b16 a[252:253], v28 offset:25608
  ds_read_b64_tr_b16 a[254:255], v28 offset:25864
  s_waitcnt lgkmcnt(0)
  s_xor_b32 s36, s13, 4
  s_lshl_b32 s36, s36, 19
  s_add_u32 m0, s39, 28672
  s_add_u32 s37, s36, 0
  buffer_load_dwordx4 v25, s[8:11], s37 offen lds
  s_add_u32 m0, s39, 29696
  s_add_u32 s37, s36, 65536
  buffer_load_dwordx4 v25, s[8:11], s37 offen lds
  s_add_u32 m0, s39, 30720
  s_add_u32 s37, s36, 131072
  buffer_load_dwordx4 v25, s[8:11], s37 offen lds
  s_add_u32 m0, s39, 31744
  s_add_u32 s37, s36, 196608
  buffer_load_dwordx4 v25, s[8:11], s37 offen lds
  s_xor_b32 s36, s13, 4
  s_lshl_b32 s36, s36, 19
  s_add_u32 m0, s39, 24576
  s_add_u32 s37, s36, 262144
  buffer_load_dwordx4 v25, s[8:11], s37 offen lds
  s_add_u32 m0, s39, 25600
  s_add_u32 s37, s36, 327680
  buffer_load_dwordx4 v25, s[8:11], s37 offen lds
  s_add_u32 m0, s39, 26624
  s_add_u32 s37, s36, 393216
  buffer_load_dwordx4 v25, s[8:11], s37 offen lds
  s_add_u32 m0, s39, 27648
  s_add_u32 s37, s36, 458752
  buffer_load_dwordx4 v25, s[8:11], s37 offen lds
  s_barrier
  s_cmp_lg_u32 s13, 0
  s_cbranch_scc1 T_arm_1
  s_getreg_b32 s36, hwreg(HW_REG_XCC_ID, 0, 3)
  s_lshl_b32 s36, s36, 3
  s_lshl_b64 s[60:61], 1, s36
  s_mov_b32 s62, 1
  s_atomic_add_x2 s[60:61], s[52:53], 0
  s_atomic_add s62, s[52:53], 128
  v_lshl_or_b32 v44, v45, 16, v44
  v_lshl_or_b32 v46, v47, 16, v46
  v_min_u32 v44, -2, v44
  v_min_u32 v46, -2, v46
  s_mov_b32 s36, 145752064
  s_mov_b32 s37, 145756160
  buffer_store_dword v44, v8, s[4:7], s36 offen sc1
  buffer_store_dword v46, v8, s[4:7], s37 offen sc1
T_arm_1:
  v_mad_u32_u24 v96, v100, 1, v27
  v_mad_u32_u24 v97, v101, 1, v27
  v_mad_u32_u24 v98, v100, 1, v36
  v_mad_u32_u24 v99, v101, 1, v36
  s_waitcnt vmcnt(8)
  s_barrier
  ds_read_b64_tr_b16 v[160:161], v96 offset:8192
  ds_read_b64_tr_b16 v[162:163], v96 offset:8448
  ds_read_b64_tr_b16 v[164:165], v96 offset:10240
  ds_read_b64_tr_b16 v[166:167], v96 offset:10496
  ds_read_b64_tr_b16 v[168:169], v97 offset:8192
  ds_read_b64_tr_b16 v[170:171], v97 offset:8448
  ds_read_b64_tr_b16 v[172:173], v97 offset:10240
  ds_read_b64_tr_b16 v[174:175], v97 offset:10496
  ds_read_b64_tr_b16 v[192:193], v98 offset:8192
  ds_read_b64_tr_b16 v[194:195], v98 offset:8448
  ds_read_b64_tr_b16 v[196:197], v98 offset:10240
  ds_read_b64_tr_b16 v[198:199], v98 offset:10496
  ds_read_b64_tr_b16 v[200:201], v99 offset:8192
  ds_read_b64_tr_b16 v[202:203], v99 offset:8448
  ds_read_b64_tr_b16 v[204:205], v99 offset:10240
  ds_read_b64_tr_b16 v[206:207], v99 offset:10496
  s_waitcnt lgkmcnt(0)
  s_barrier
  s_xor_b32 s36, s13, 4
  s_lshl_b32 s36, s36, 19
  s_add_u32 m0, s39, 12288
  s_add_u32 s37, s36, 0
  buffer_load_dwordx4 v25, s[40:43], s37 offen lds
  s_add_u32 m0, s39, 13312
  s_add_u32 s37, s36, 65536
  buffer_load_dwordx4 v25, s[40:43], s37 offen lds
  s_add_u32 m0, s39, 14336
  s_add_u32 s37, s36, 131072
  buffer_load_dwordx4 v25, s[40:43], s37 offen lds
  s_add_u32 m0, s39, 15360
  s_add_u32 s37, s36, 196608
  buffer_load_dwordx4 v25, s[40:43], s37 offen lds
  s_xor_b32 s36, s13, 4
  s_lshl_b32 s36, s36, 19
  s_add_u32 m0, s39, 8192
  s_add_u32 s37, s36, 262144
  buffer_load_dwordx4 v25, s[40:43], s37 offen lds
  s_add_u32 m0, s39, 9216
  s_add_u32 s37, s36, 327680
  buffer_load_dwordx4 v25, s[40:43], s37 offen lds
  s_add_u32 m0, s39, 10240
  s_add_u32 s37, s36, 393216
  buffer_load_dwordx4 v25, s[40:43], s37 offen lds
  s_add_u32 m0, s39, 11264
  s_add_u32 s37, s36, 458752
  buffer_load_dwordx4 v25, s[40:43], s37 offen lds
  v_mad_u32_u24 v96, v100, 1, v27
  v_mad_u32_u24 v97, v101, 1, v27
  v_mad_u32_u24 v98, v100, 1, v36
  v_mad_u32_u24 v99, v101, 1, v36
  s_waitcnt vmcnt(8)
  s_barrier
  ds_read_b64_tr_b16 v[224:225], v96 offset:24576
  ds_read_b64_tr_b16 v[226:227], v96 offset:24832
  ds_read_b64_tr_b16 v[228:229], v96 offset:26624
  ds_read_b64_tr_b16 v[230:231], v96 offset:26880
  ds_read_b64_tr_b16 v[232:233], v97 offset:24576
  ds_read_b64_tr_b16 v[234:235], v97 offset:24832
  ds_read_b64_tr_b16 v[236:237], v97 offset:26624
  ds_read_b64_tr_b16 v[238:239], v97 offset:26880
  ds_read_b64_tr_b16 a[16:17], v98 offset:24576
  ds_read_b64_tr_b16 a[18:19], v98 offset:24832
  ds_read_b64_tr_b16 a[20:21], v98 offset:26624
  ds_read_b64_tr_b16 a[22:23], v98 offset:26880
  ds_read_b64_tr_b16 a[24:25], v99 offset:24576
  ds_read_b64_tr_b16 a[26:27], v99 offset:24832
  ds_read_b64_tr_b16 a[28:29], v99 offset:26624
  ds_read_b64_tr_b16 a[30:31], v99 offset:26880
  s_waitcnt lgkmcnt(0)
  s_barrier
  s_xor_b32 s36, s13, 4
  s_lshl_b32 s36, s36, 19
  s_add_u32 m0, s39, 28672
  s_add_u32 s37, s36, 0
  buffer_load_dwordx4 v25, s[44:47], s37 offen lds
  s_add_u32 m0, s39, 29696
  s_add_u32 s37, s36, 65536
  buffer_load_dwordx4 v25, s[44:47], s37 offen lds
  s_add_u32 m0, s39, 30720
  s_add_u32 s37, s36, 131072
  buffer_load_dwordx4 v25, s[44:47], s37 offen lds
  s_add_u32 m0, s39, 31744
  s_add_u32 s37, s36, 196608
  buffer_load_dwordx4 v25, s[44:47], s37 offen lds
  s_xor_b32 s36, s13, 4
  s_lshl_b32 s36, s36, 19
  s_add_u32 m0, s39, 24576
  s_add_u32 s37, s36, 262144
  buffer_load_dwordx4 v25, s[44:47], s37 offen lds
  s_add_u32 m0, s39, 25600
  s_add_u32 s37, s36, 327680
  buffer_load_dwordx4 v25, s[44:47], s37 offen lds
  s_add_u32 m0, s39, 26624
  s_add_u32 s37, s36, 393216
  buffer_load_dwordx4 v25, s[44:47], s37 offen lds
  s_add_u32 m0, s39, 27648
  s_add_u32 s37, s36, 458752
  buffer_load_dwordx4 v25, s[44:47], s37 offen lds
  v_mad_u32_u24 v96, v100, 1, v27
  v_mad_u32_u24 v97, v101, 1, v27
  v_mad_u32_u24 v98, v100, 1, v36
  v_mad_u32_u24 v99, v101, 1, v36
  s_waitcnt vmcnt(8)
  s_barrier
  ds_read_b64_tr_b16 v[240:241], v96 offset:8192
  ds_read_b64_tr_b16 v[242:243], v96 offset:8448
  ds_read_b64_tr_b16 v[244:245], v96 offset:10240
  ds_read_b64_tr_b16 v[246:247], v96 offset:10496
  ds_read_b64_tr_b16 v[248:249], v97 offset:8192
  ds_read_b64_tr_b16 v[250:251], v97 offset:8448
  ds_read_b64_tr_b16 v[252:253], v97 offset:10240
  ds_read_b64_tr_b16 v[254:255], v97 offset:10496
  ds_read_b64_tr_b16 a[32:33], v98 offset:8192
  ds_read_b64_tr_b16 a[34:35], v98 offset:8448
  ds_read_b64_tr_b16 a[36:37], v98 offset:10240
  ds_read_b64_tr_b16 a[38:39], v98 offset:10496
  ds_read_b64_tr_b16 a[40:41], v99 offset:8192
  ds_read_b64_tr_b16 a[42:43], v99 offset:8448
  ds_read_b64_tr_b16 a[44:45], v99 offset:10240
  ds_read_b64_tr_b16 a[46:47], v99 offset:10496
  s_waitcnt lgkmcnt(0)
  s_barrier
  s_xor_b32 s36, s13, 6
  s_lshl_b32 s36, s36, 19
  s_add_u32 m0, s39, 12288
  s_add_u32 s37, s36, 0
  buffer_load_dwordx4 v25, s[8:11], s37 offen lds
  s_add_u32 m0, s39, 13312
  s_add_u32 s37, s36, 65536
  buffer_load_dwordx4 v25, s[8:11], s37 offen lds
  s_add_u32 m0, s39, 14336
  s_add_u32 s37, s36, 131072
  buffer_load_dwordx4 v25, s[8:11], s37 offen lds
  s_add_u32 m0, s39, 15360
  s_add_u32 s37, s36, 196608
  buffer_load_dwordx4 v25, s[8:11], s37 offen lds
  s_xor_b32 s36, s13, 6
  s_lshl_b32 s36, s36, 19
  s_add_u32 m0, s39, 8192
  s_add_u32 s37, s36, 262144
  buffer_load_dwordx4 v25, s[8:11], s37 offen lds
  s_add_u32 m0, s39, 9216
  s_add_u32 s37, s36, 327680
  buffer_load_dwordx4 v25, s[8:11], s37 offen lds
  s_add_u32 m0, s39, 10240
  s_add_u32 s37, s36, 393216
  buffer_load_dwordx4 v25, s[8:11], s37 offen lds
  s_add_u32 m0, s39, 11264
  s_add_u32 s37, s36, 458752
  buffer_load_dwordx4 v25, s[8:11], s37 offen lds
  v_mad_u32_u24 v96, v100, 1, v27
  v_mad_u32_u24 v97, v101, 1, v27
  v_mad_u32_u24 v98, v100, 1, v36
  v_mad_u32_u24 v99, v101, 1, v36
  s_waitcnt vmcnt(8)
  s_barrier
  ds_read_b64_tr_b16 a[0:1], v96 offset:24576
  ds_read_b64_tr_b16 a[2:3], v96 offset:24832
  ds_read_b64_tr_b16 a[4:5], v96 offset:26624
  ds_read_b64_tr_b16 a[6:7], v96 offset:26880
  ds_read_b64_tr_b16 a[8:9], v97 offset:24576
  ds_read_b64_tr_b16 a[10:11], v97 offset:24832
  ds_read_b64_tr_b16 a[12:13], v97 offset:26624
  ds_read_b64_tr_b16 a[14:15], v97 offset:26880
  ds_read_b64_tr_b16 a[48:49], v98 offset:24576
  ds_read_b64_tr_b16 a[50:51], v98 offset:24832
  ds_read_b64_tr_b16 a[52:53], v98 offset:26624
  ds_read_b64_tr_b16 a[54:55], v98 offset:26880
  ds_read_b64_tr_b16 a[56:57], v99 offset:24576
  ds_read_b64_tr_b16 a[58:59], v99 offset:24832
  ds_read_b64_tr_b16 a[60:61], v99 offset:26624
  ds_read_b64_tr_b16 a[62:63], v99 offset:26880
  s_waitcnt lgkmcnt(0)
  s_barrier
  s_xor_b32 s36, s13, 6
  s_lshl_b32 s36, s36, 19
  s_add_u32 m0, s39, 28672
  s_add_u32 s37, s36, 0
  buffer_load_dwordx4 v25, s[40:43], s37 offen lds
  s_add_u32 m0, s39, 29696
  s_add_u32 s37, s36, 65536
  buffer_load_dwordx4 v25, s[40:43], s37 offen lds
  s_add_u32 m0, s39, 30720
  s_add_u32 s37, s36, 131072
  buffer_load_dwordx4 v25, s[40:43], s37 offen lds
  s_add_u32 m0, s39, 31744
  s_add_u32 s37, s36, 196608
  buffer_load_dwordx4 v25, s[40:43], s37 offen lds
  s_xor_b32 s36, s13, 6
  s_lshl_b32 s36, s36, 19
  s_add_u32 m0, s39, 24576
  s_add_u32 s37, s36, 262144
  buffer_load_dwordx4 v25, s[40:43], s37 offen lds
  s_add_u32 m0, s39, 25600
  s_add_u32 s37, s36, 327680
  buffer_load_dwordx4 v25, s[40:43], s37 offen lds
  s_add_u32 m0, s39, 26624
  s_add_u32 s37, s36, 393216
  buffer_load_dwordx4 v25, s[40:43], s37 offen lds
  s_add_u32 m0, s39, 27648
  s_add_u32 s37, s36, 458752
  buffer_load_dwordx4 v25, s[40:43], s37 offen lds
  v_mad_u32_u24 v96, v100, 1, v27
  v_mad_u32_u24 v97, v101, 1, v27
  v_mad_u32_u24 v98, v100, 1, v36
  v_mad_u32_u24 v99, v101, 1, v36
  s_waitcnt vmcnt(8)
  s_barrier
  ds_read_b64_tr_b16 a[64:65], v96 offset:8192
  ds_read_b64_tr_b16 a[66:67], v96 offset:8448
  ds_read_b64_tr_b16 a[68:69], v96 offset:10240
  ds_read_b64_tr_b16 a[70:71], v96 offset:10496
  ds_read_b64_tr_b16 a[72:73], v97 offset:8192
  ds_read_b64_tr_b16 a[74:75], v97 offset:8448
  ds_read_b64_tr_b16 a[76:77], v97 offset:10240
  ds_read_b64_tr_b16 a[78:79], v97 offset:10496
  ds_read_b64_tr_b16 a[112:113], v98 offset:8192
  ds_read_b64_tr_b16 a[114:115], v98 offset:8448
  ds_read_b64_tr_b16 a[116:117], v98 offset:10240
  ds_read_b64_tr_b16 a[118:119], v98 offset:10496
  ds_read_b64_tr_b16 a[120:121], v99 offset:8192
  ds_read_b64_tr_b16 a[122:123], v99 offset:8448
  ds_read_b64_tr_b16 a[124:125], v99 offset:10240
  ds_read_b64_tr_b16 a[126:127], v99 offset:10496
  s_waitcnt lgkmcnt(0)
  s_barrier
  s_xor_b32 s36, s13, 6
  s_lshl_b32 s36, s36, 19
  s_add_u32 m0, s39, 12288
  s_add_u32 s37, s36, 0
  buffer_load_dwordx4 v25, s[44:47], s37 offen lds
  s_add_u32 m0, s39, 13312
  s_add_u32 s37, s36, 65536
  buffer_load_dwordx4 v25, s[44:47], s37 offen lds
  s_add_u32 m0, s39, 14336
  s_add_u32 s37, s36, 131072
  buffer_load_dwordx4 v25, s[44:47], s37 offen lds
  s_add_u32 m0, s39, 15360
  s_add_u32 s37, s36, 196608
  buffer_load_dwordx4 v25, s[44:47], s37 offen lds
  s_xor_b32 s36, s13, 6
  s_lshl_b32 s36, s36, 19
  s_add_u32 m0, s39, 8192
  s_add_u32 s37, s36, 262144
  buffer_load_dwordx4 v25, s[44:47], s37 offen lds
  s_add_u32 m0, s39, 9216
  s_add_u32 s37, s36, 327680
  buffer_load_dwordx4 v25, s[44:47], s37 offen lds
  s_add_u32 m0, s39, 10240
  s_add_u32 s37, s36, 393216
  buffer_load_dwordx4 v25, s[44:47], s37 offen lds
  s_add_u32 m0, s39, 11264
  s_add_u32 s37, s36, 458752
  buffer_load_dwordx4 v25, s[44:47], s37 offen lds
  v_mad_u32_u24 v96, v100, 1, v27
  v_mad_u32_u24 v97, v101, 1, v27
  v_mad_u32_u24 v98, v100, 1, v36
  v_mad_u32_u24 v99, v101, 1, v36
  s_waitcnt vmcnt(8)
  s_barrier
  ds_read_b64_tr_b16 a[80:81], v96 offset:24576
  ds_read_b64_tr_b16 a[82:83], v96 offset:24832
  ds_read_b64_tr_b16 a[84:85], v96 offset:26624
  ds_read_b64_tr_b16 a[86:87], v96 offset:26880
  ds_read_b64_tr_b16 a[88:89], v97 offset:24576
  ds_read_b64_tr_b16 a[90:91], v97 offset:24832
  ds_read_b64_tr_b16 a[92:93], v97 offset:26624
  ds_read_b64_tr_b16 a[94:95], v97 offset:26880
  ds_read_b64_tr_b16 a[128:129], v98 offset:24576
  ds_read_b64_tr_b16 a[130:131], v98 offset:24832
  ds_read_b64_tr_b16 a[132:133], v98 offset:26624
  ds_read_b64_tr_b16 a[134:135], v98 offset:26880
  ds_read_b64_tr_b16 a[136:137], v99 offset:24576
  ds_read_b64_tr_b16 a[138:139], v99 offset:24832
  ds_read_b64_tr_b16 a[140:141], v99 offset:26624
  ds_read_b64_tr_b16 a[142:143], v99 offset:26880
  s_waitcnt lgkmcnt(0)
  s_barrier
  s_xor_b32 s36, s13, 0
  s_lshl_b32 s36, s36, 19
  s_add_u32 m0, s39, 28672
  s_add_u32 s37, s36, 0
  buffer_load_dwordx4 v25, s[8:11], s37 offen lds
  s_add_u32 m0, s39, 29696
  s_add_u32 s37, s36, 65536
  buffer_load_dwordx4 v25, s[8:11], s37 offen lds
  s_add_u32 m0, s39, 30720
  s_add_u32 s37, s36, 131072
  buffer_load_dwordx4 v25, s[8:11], s37 offen lds
  s_add_u32 m0, s39, 31744
  s_add_u32 s37, s36, 196608
  buffer_load_dwordx4 v25, s[8:11], s37 offen lds
  s_xor_b32 s36, s13, 0
  s_lshl_b32 s36, s36, 19
  s_add_u32 m0, s39, 0
  s_add_u32 s37, s36, 262144
  buffer_load_dwordx4 v25, s[8:11], s37 offen lds
  s_add_u32 m0, s39, 1024
  s_add_u32 s37, s36, 327680
  buffer_load_dwordx4 v25, s[8:11], s37 offen lds
  s_add_u32 m0, s39, 2048
  s_add_u32 s37, s36, 393216
  buffer_load_dwordx4 v25, s[8:11], s37 offen lds
  s_add_u32 m0, s39, 3072
  s_add_u32 s37, s36, 458752
  buffer_load_dwordx4 v25, s[8:11], s37 offen lds
  v_mad_u32_u24 v96, v100, 1, v27
  v_mad_u32_u24 v97, v101, 1, v27
  v_mad_u32_u24 v98, v100, 1, v36
  v_mad_u32_u24 v99, v101, 1, v36
  s_waitcnt vmcnt(8)
  s_barrier
  ds_read_b64_tr_b16 a[96:97], v96 offset:8192
  ds_read_b64_tr_b16 a[98:99], v96 offset:8448
  ds_read_b64_tr_b16 a[100:101], v96 offset:10240
  ds_read_b64_tr_b16 a[102:103], v96 offset:10496
  ds_read_b64_tr_b16 a[104:105], v97 offset:8192
  ds_read_b64_tr_b16 a[106:107], v97 offset:8448
  ds_read_b64_tr_b16 a[108:109], v97 offset:10240
  ds_read_b64_tr_b16 a[110:111], v97 offset:10496
  ds_read_b64_tr_b16 a[144:145], v98 offset:8192
  ds_read_b64_tr_b16 a[146:147], v98 offset:8448
  ds_read_b64_tr_b16 a[148:149], v98 offset:10240
  ds_read_b64_tr_b16 a[150:151], v98 offset:10496
  ds_read_b64_tr_b16 a[152:153], v99 offset:8192
  ds_read_b64_tr_b16 a[154:155], v99 offset:8448
  ds_read_b64_tr_b16 a[156:157], v99 offset:10240
  ds_read_b64_tr_b16 a[158:159], v99 offset:10496
  s_waitcnt lgkmcnt(0)
  s_barrier
  s_xor_b32 s36, s13, 0
  s_lshl_b32 s36, s36, 19
  s_add_u32 m0, s39, 24576
  s_add_u32 s37, s36, 0
  buffer_load_dwordx4 v25, s[40:43], s37 offen lds
  s_add_u32 m0, s39, 25600
  s_add_u32 s37, s36, 65536
  buffer_load_dwordx4 v25, s[40:43], s37 offen lds
  s_add_u32 m0, s39, 26624
  s_add_u32 s37, s36, 131072
  buffer_load_dwordx4 v25, s[40:43], s37 offen lds
  s_add_u32 m0, s39, 27648
  s_add_u32 s37, s36, 196608
  buffer_load_dwordx4 v25, s[40:43], s37 offen lds
  s_xor_b32 s36, s13, 0
  s_lshl_b32 s36, s36, 19
  s_add_u32 m0, s39, 4096
  s_add_u32 s37, s36, 262144
  buffer_load_dwordx4 v25, s[40:43], s37 offen lds
  s_add_u32 m0, s39, 5120
  s_add_u32 s37, s36, 327680
  buffer_load_dwordx4 v25, s[40:43], s37 offen lds
  s_add_u32 m0, s39, 6144
  s_add_u32 s37, s36, 393216
  buffer_load_dwordx4 v25, s[40:43], s37 offen lds
  s_add_u32 m0, s39, 7168
  s_add_u32 s37, s36, 458752
  buffer_load_dwordx4 v25, s[40:43], s37 offen lds
  v_mad_u32_u24 v96, v100, 7, v27
  v_mad_u32_u24 v97, v101, 7, v27
  v_mad_u32_u24 v98, v100, 7, v36
  v_mad_u32_u24 v99, v101, 7, v36
  s_waitcnt vmcnt(8)
  s_barrier
  ds_read_b64_tr_b16 v[128:129], v98 offset:0
  ds_read_b64_tr_b16 v[130:131], v98 offset:256
  ds_read_b64_tr_b16 v[132:133], v98 offset:2048
  ds_read_b64_tr_b16 v[134:135], v98 offset:2304
  ds_read_b64_tr_b16 v[136:137], v99 offset:0
  ds_read_b64_tr_b16 v[138:139], v99 offset:256
  ds_read_b64_tr_b16 v[140:141], v99 offset:2048
  ds_read_b64_tr_b16 v[142:143], v99 offset:2304
  ds_read_b64_tr_b16 v[64:65], v96 offset:0
  ds_read_b64_tr_b16 v[66:67], v96 offset:256
  ds_read_b64_tr_b16 v[68:69], v96 offset:2048
  ds_read_b64_tr_b16 v[70:71], v96 offset:2304
  ds_read_b64_tr_b16 v[72:73], v97 offset:0
  ds_read_b64_tr_b16 v[74:75], v97 offset:256
  ds_read_b64_tr_b16 v[76:77], v97 offset:2048
  ds_read_b64_tr_b16 v[78:79], v97 offset:2304
  s_waitcnt lgkmcnt(0)
  s_barrier
  ds_write_b128 v4, v[64:67] offset:0
  ds_write_b128 v4, v[68:71] offset:1024
  ds_write_b128 v4, v[72:75] offset:2048
  ds_write_b128 v4, v[76:79] offset:3072
  s_xor_b32 s36, s13, 2
  s_lshl_b32 s36, s36, 19
  s_add_u32 m0, s39, 28672
  s_add_u32 s37, s36, 0
  buffer_load_dwordx4 v25, s[40:43], s37 offen lds
  s_add_u32 m0, s39, 29696
  s_add_u32 s37, s36, 65536
  buffer_load_dwordx4 v25, s[40:43], s37 offen lds
  s_add_u32 m0, s39, 30720
  s_add_u32 s37, s36, 131072
  buffer_load_dwordx4 v25, s[40:43], s37 offen lds
  s_add_u32 m0, s39, 31744
  s_add_u32 s37, s36, 196608
  buffer_load_dwordx4 v25, s[40:43], s37 offen lds
  s_xor_b32 s36, s13, 2
  s_lshl_b32 s36, s36, 19
  s_add_u32 m0, s39, 16384
  s_add_u32 s37, s36, 262144
  buffer_load_dwordx4 v25, s[40:43], s37 offen lds
  s_add_u32 m0, s39, 17408
  s_add_u32 s37, s36, 327680
  buffer_load_dwordx4 v25, s[40:43], s37 offen lds
  s_add_u32 m0, s39, 18432
  s_add_u32 s37, s36, 393216
  buffer_load_dwordx4 v25, s[40:43], s37 offen lds
  s_add_u32 m0, s39, 19456
  s_add_u32 s37, s36, 458752
  buffer_load_dwordx4 v25, s[40:43], s37 offen lds
  s_getpc_b64 s[60:61]
T_pc_2:
  s_add_u32 s60, s60, T_code-T_pc_2
  s_addc_u32 s61, s61, 0
  v_lshlrev_b32 v102, 3, v59
  v_min_u32 v102, 16384, v102
  global_load_dword v103, v102, s[60:61]
  buffer_load_dwordx2 v[54:55], off, s[72:75], 0 sc1
  buffer_load_dword v56, off, s[72:75], 0 offset:128 sc1
  v_mad_u32_u24 v96, v100, 5, v27
  v_mad_u32_u24 v97, v101, 5, v27
  v_mad_u32_u24 v98, v100, 5, v36
  v_mad_u32_u24 v99, v101, 5, v36
  s_waitcnt vmcnt(11)
  s_barrier
  ds_read_b64_tr_b16 v[144:145], v98 offset:4096
  ds_read_b64_tr_b16 v[146:147], v98 offset:4352
  ds_read_b64_tr_b16 v[148:149], v98 offset:6144
  ds_read_b64_tr_b16 v[150:151], v98 offset:6400
  ds_read_b64_tr_b16 v[152:153], v99 offset:4096
  ds_read_b64_tr_b16 v[154:155], v99 offset:4352
  ds_read_b64_tr_b16 v[156:157], v99 offset:6144
  ds_read_b64_tr_b16 v[158:159], v99 offset:6400
  ds_read_b64_tr_b16 v[64:65], v96 offset:4096
  ds_read_b64_tr_b16 v[66:67], v96 offset:4352
  ds_read_b64_tr_b16 v[68:69], v96 offset:6144
  ds_read_b64_tr_b16 v[70:71], v96 offset:6400
  ds_read_b64_tr_b16 v[72:73], v97 offset:4096
  ds_read_b64_tr_b16 v[74:75], v97 offset:4352
  ds_read_b64_tr_b16 v[76:77], v97 offset:6144
  ds_read_b64_tr_b16 v[78:79], v97 offset:6400
  s_waitcnt lgkmcnt(0)
  s_barrier
  ds_write_b128 v4, v[64:67] offset:4096
  ds_write_b128 v4, v[68:71] offset:5120
  ds_write_b128 v4, v[72:75] offset:6144
  ds_write_b128 v4, v[76:79] offset:7168
  s_xor_b32 s36, s13, 2
  s_lshl_b32 s36, s36, 19
  s_add_u32 m0, s39, 24576
  s_add_u32 s37, s36, 0
  buffer_load_dwordx4 v25, s[44:47], s37 offen lds
  s_add_u32 m0, s39, 25600
  s_add_u32 s37, s36, 65536
  buffer_load_dwordx4 v25, s[44:47], s37 offen lds
  s_add_u32 m0, s39, 26624
  s_add_u32 s37, s36, 131072
  buffer_load_dwordx4 v25, s[44:47], s37 offen lds
  s_add_u32 m0, s39, 27648
  s_add_u32 s37, s36, 196608
  buffer_load_dwordx4 v25, s[44:47], s37 offen lds
  s_xor_b32 s36, s13, 2
  s_lshl_b32 s36, s36, 19
  s_add_u32 m0, s39, 20480
  s_add_u32 s37, s36, 262144
  buffer_load_dwordx4 v25, s[44:47], s37 offen lds
  s_add_u32 m0, s39, 21504
  s_add_u32 s37, s36, 327680
  buffer_load_dwordx4 v25, s[44:47], s37 offen lds
  s_add_u32 m0, s39, 22528
  s_add_u32 s37, s36, 393216
  buffer_load_dwordx4 v25, s[44:47], s37 offen lds
  s_add_u32 m0, s39, 23552
  s_add_u32 s37, s36, 458752
  buffer_load_dwordx4 v25, s[44:47], s37 offen lds
  v_mad_u32_u24 v96, v100, 3, v27
  v_mad_u32_u24 v97, v101, 3, v27
  v_mad_u32_u24 v98, v100, 3, v36
  v_mad_u32_u24 v99, v101, 3, v36
  s_waitcnt vmcnt(11)
  s_barrier
  ds_read_b64_tr_b16 v[176:177], v96 offset:16384
  ds_read_b64_tr_b16 v[178:179], v96 offset:16640
  ds_read_b64_tr_b16 v[180:181], v96 offset:18432
  ds_read_b64_tr_b16 v[182:183], v96 offset:18688
  ds_read_b64_tr_b16 v[184:185], v97 offset:16384
  ds_read_b64_tr_b16 v[186:187], v97 offset:16640
  ds_read_b64_tr_b16 v[188:189], v97 offset:18432
  ds_read_b64_tr_b16 v[190:191], v97 offset:18688
  ds_read_b64_tr_b16 v[64:65], v98 offset:16384
  ds_read_b64_tr_b16 v[66:67], v98 offset:16640
  ds_read_b64_tr_b16 v[68:69], v98 offset:18432
  ds_read_b64_tr_b16 v[70:71], v98 offset:18688
  ds_read_b64_tr_b16 v[72:73], v99 offset:16384
  ds_read_b64_tr_b16 v[74:75], v99 offset:16640
  ds_read_b64_tr_b16 v[76:77], v99 offset:18432
  ds_read_b64_tr_b16 v[78:79], v99 offset:18688
  s_waitcnt lgkmcnt(0)
  s_barrier
  ds_write_b128 v4, v[64:67] offset:16384
  ds_write_b128 v4, v[68:71] offset:17408
  ds_write_b128 v4, v[72:75] offset:18432
  ds_write_b128 v4, v[76:79] offset:19456
  s_xor_b32 s36, s13, 0
  s_lshl_b32 s36, s36, 19
  s_add_u32 m0, s39, 8192
  s_add_u32 s37, s36, 0
  buffer_load_dwordx4 v25, s[44:47], s37 offen lds
  s_add_u32 m0, s39, 9216
  s_add_u32 s37, s36, 65536
  buffer_load_dwordx4 v25, s[44:47], s37 offen lds
  s_add_u32 m0, s39, 10240
  s_add_u32 s37, s36, 131072
  buffer_load_dwordx4 v25, s[44:47], s37 offen lds
  s_add_u32 m0, s39, 11264
  s_add_u32 s37, s36, 196608
  buffer_load_dwordx4 v25, s[44:47], s37 offen lds
  s_xor_b32 s36, s13, 0
  s_lshl_b32 s36, s36, 19
  s_add_u32 m0, s39, 12288
  s_add_u32 s37, s36, 262144
  buffer_load_dwordx4 v25, s[44:47], s37 offen lds
  s_add_u32 m0, s39, 13312
  s_add_u32 s37, s36, 327680
  buffer_load_dwordx4 v25, s[44:47], s37 offen lds
  s_add_u32 m0, s39, 14336
  s_add_u32 s37, s36, 393216
  buffer_load_dwordx4 v25, s[44:47], s37 offen lds
  s_add_u32 m0, s39, 15360
  s_add_u32 s37, s36, 458752
  buffer_load_dwordx4 v25, s[44:47], s37 offen lds
  v_mad_u32_u24 v96, v100, 1, v27
  v_mad_u32_u24 v97, v101, 1, v27
  v_mad_u32_u24 v98, v100, 1, v36
  v_mad_u32_u24 v99, v101, 1, v36
  s_waitcnt vmcnt(8)
  s_barrier
  ds_read_b64_tr_b16 v[208:209], v98 offset:20480
  ds_read_b64_tr_b16 v[210:211], v98 offset:20736
  ds_read_b64_tr_b16 v[212:213], v98 offset:22528
  ds_read_b64_tr_b16 v[214:215], v98 offset:22784
  ds_read_b64_tr_b16 v[216:217], v99 offset:20480
  ds_read_b64_tr_b16 v[218:219], v99 offset:20736
  ds_read_b64_tr_b16 v[220:221], v99 offset:22528
  ds_read_b64_tr_b16 v[222:223], v99 offset:22784
  ds_read_b64_tr_b16 v[64:65], v96 offset:20480
  ds_read_b64_tr_b16 v[66:67], v96 offset:20736
  ds_read_b64_tr_b16 v[68:69], v96 offset:22528
  ds_read_b64_tr_b16 v[70:71], v96 offset:22784
  ds_read_b64_tr_b16 v[72:73], v97 offset:20480
  ds_read_b64_tr_b16 v[74:75], v97 offset:20736
  ds_read_b64_tr_b16 v[76:77], v97 offset:22528
  ds_read_b64_tr_b16 v[78:79], v97 offset:22784
  s_waitcnt lgkmcnt(0)
  s_barrier
  ds_write_b128 v4, v[64:67] offset:20480
  ds_write_b128 v4, v[68:71] offset:21504
  ds_write_b128 v4, v[72:75] offset:22528
  ds_write_b128 v4, v[76:79] offset:23552
  s_xor_b32 s36, s13, 2
  s_lshl_b32 s36, s36, 15
  s_add_u32 m0, s39, 24576
  s_add_u32 s37, s36, 512
  buffer_load_dwordx4 v26, s[48:51], s37 offen lds
  s_add_u32 m0, s39, 25600
  s_add_u32 s37, s36, 8704
  buffer_load_dwordx4 v26, s[48:51], s37 offen lds
  s_add_u32 m0, s39, 26624
  s_add_u32 s37, s36, 16896
  buffer_load_dwordx4 v26, s[48:51], s37 offen lds
  s_add_u32 m0, s39, 27648
  s_add_u32 s37, s36, 25088
  buffer_load_dwordx4 v26, s[48:51], s37 offen lds
  s_xor_b32 s36, s13, 3
  s_lshl_b32 s36, s36, 15
  s_add_u32 m0, s39, 28672
  s_add_u32 s37, s36, 512
  buffer_load_dwordx4 v26, s[48:51], s37 offen lds
  s_add_u32 m0, s39, 29696
  s_add_u32 s37, s36, 8704
  buffer_load_dwordx4 v26, s[48:51], s37 offen lds
  s_add_u32 m0, s39, 30720
  s_add_u32 s37, s36, 16896
  buffer_load_dwordx4 v26, s[48:51], s37 offen lds
  s_add_u32 m0, s39, 31744
  s_add_u32 s37, s36, 25088
  buffer_load_dwordx4 v26, s[48:51], s37 offen lds
  s_mov_b32 s19, 0
  s_branch T_arrgo_4
T_arr_3:
  s_add_u32 s19, s19, 1
  s_cmp_gt_u32 s19, 32768
  s_cbranch_scc1 M_exit
  buffer_load_dwordx2 v[54:55], off, s[72:75], 0 sc1
  buffer_load_dword v56, off, s[72:75], 0 offset:128 sc1
  s_waitcnt vmcnt(0)
T_arrgo_4:
  v_sad_u8 v57, v54, 0, 0
  v_sad_u8 v57, v55, 0, v57
  v_or_b32 v58, v54, v55
  v_cmp_gt_u32 vcc, 32, v57
  s_cbranch_vccnz T_arr_3
  v_cmp_gt_u32 vcc, 0x100, v56
  s_cbranch_vccnz T_arr_3
  v_readfirstlane_b32 s36, v58
  s_nop 0
  s_and_b32 s36, s36, 0x20202020
  s_cselect_b32 s56, 0, 1
  s_mov_b32 s14, -1
  s_mov_b32 s30, -1
  s_mov_b32 s19, 0
  s_branch T_kvok_6
T_kv_5:
  s_sleep 4
  s_add_u32 s19, s19, 1
  s_cmp_gt_u32 s19, 32768
  s_cbranch_scc1 M_exit
T_kvok_6:
  s_add_u32 s39, s99, 128
  s_mov_b32 s38, 0
  s_mov_b32 s37, 0
  s_atomic_or s38, s[58:59], s99 glc
  s_atomic_or s37, s[58:59], s39 glc
  s_waitcnt lgkmcnt(0)
  s_lshl_b32 s38, s38, 1
  s_lshl1_add_u32 s37, s37, 1
  s_min_u32 s38, s38, s37
  s_cmp_ge_u32 s38, 64
  s_cselect_b32 s38, 100, s38
  s_sub_u32 s38, s38, 1
  s_max_i32 s30, s30, s38
  s_cmp_ge_i32 s14, s30
  s_cbranch_scc1 T_kv_5
  s_mov_b32 m0, s31
  s_nop 0
  buffer_load_dwordx4 v9, s[4:7], s27 offen sc1 lds
  s_mov_b32 m0, s32
  s_nop 0
  buffer_load_dwordx4 v9, s[4:7], s27 offen offset:128 sc1 lds
  s_mov_b32 m0, s33
  s_nop 0
  buffer_load_dwordx4 v10, s[4:7], s28 offen sc1 lds
  s_mov_b32 m0, s34
  s_nop 0
  buffer_load_dwordx4 v10, s[4:7], s28 offen offset:256 sc1 lds
  s_add_u32 s27, s27, 8192
  s_add_u32 s28, s28, 8192
  s_lshl_b32 s36, s12, 10
  s_add_u32 s36, s36, 145752064
  buffer_load_dwordx4 v[40:43], v2, s[4:7], s36 offen sc1
  v_mad_u32_u24 v96, v101, 1, v27
  v_mad_u32_u24 v97, v100, 1, v27
  v_mad_u32_u24 v98, v101, 1, v36
  v_mad_u32_u24 v99, v100, 1, v36
  s_waitcnt vmcnt(13)
  s_barrier
  ds_read_b64_tr_b16 v[64:65], v96 offset:8192
  ds_read_b64_tr_b16 v[66:67], v96 offset:8448
  ds_read_b64_tr_b16 v[68:69], v96 offset:10240
  ds_read_b64_tr_b16 v[70:71], v96 offset:10496
  ds_read_b64_tr_b16 v[72:73], v97 offset:8192
  ds_read_b64_tr_b16 v[74:75], v97 offset:8448
  ds_read_b64_tr_b16 v[76:77], v97 offset:10240
  ds_read_b64_tr_b16 v[78:79], v97 offset:10496
  ds_read_b64_tr_b16 v[80:81], v98 offset:8192
  ds_read_b64_tr_b16 v[82:83], v98 offset:8448
  ds_read_b64_tr_b16 v[84:85], v98 offset:10240
  ds_read_b64_tr_b16 v[86:87], v98 offset:10496
  ds_read_b64_tr_b16 v[88:89], v99 offset:8192
  ds_read_b64_tr_b16 v[90:91], v99 offset:8448
  ds_read_b64_tr_b16 v[92:93], v99 offset:10240
  ds_read_b64_tr_b16 v[94:95], v99 offset:10496
  s_waitcnt lgkmcnt(0)
  s_barrier
  ds_write_b128 v4, v[64:67] offset:8192
  ds_write_b128 v4, v[68:71] offset:9216
  ds_write_b128 v4, v[72:75] offset:10240
  ds_write_b128 v4, v[76:79] offset:11264
  ds_write_b128 v4, v[80:83] offset:12288
  ds_write_b128 v4, v[84:87] offset:13312
  ds_write_b128 v4, v[88:91] offset:14336
  ds_write_b128 v4, v[92:95] offset:15360
  s_waitcnt vmcnt(9)
  ds_read_b64_tr_b16 v[64:65], v28 offset:24576
  ds_read_b64_tr_b16 v[66:67], v28 offset:24832
  ds_read_b64_tr_b16 v[68:69], v28 offset:25600
  ds_read_b64_tr_b16 v[70:71], v28 offset:25856
  ds_read_b64_tr_b16 v[72:73], v28 offset:24584
  ds_read_b64_tr_b16 v[74:75], v28 offset:24840
  ds_read_b64_tr_b16 v[76:77], v28 offset:25608
  ds_read_b64_tr_b16 v[78:79], v28 offset:25864
  s_waitcnt lgkmcnt(0)
  ds_write_b128 v4, v[64:67] offset:24576
  ds_write_b128 v4, v[68:71] offset:25600
  ds_write_b128 v4, v[72:75] offset:26624
  ds_write_b128 v4, v[76:79] offset:27648
  s_waitcnt lgkmcnt(0)
  s_waitcnt vmcnt(5)
  ds_read_b64_tr_b16 v[64:65], v28 offset:28672
  ds_read_b64_tr_b16 v[66:67], v28 offset:28928
  ds_read_b64_tr_b16 v[68:69], v28 offset:29696
  ds_read_b64_tr_b16 v[70:71], v28 offset:29952
  ds_read_b64_tr_b16 v[72:73], v28 offset:28680
  ds_read_b64_tr_b16 v[74:75], v28 offset:28936
  ds_read_b64_tr_b16 v[76:77], v28 offset:29704
  ds_read_b64_tr_b16 v[78:79], v28 offset:29960
  s_waitcnt lgkmcnt(0)
  ds_write_b128 v4, v[64:67] offset:28672
  ds_write_b128 v4, v[68:71] offset:29696
  ds_write_b128 v4, v[72:75] offset:30720
  ds_write_b128 v4, v[76:79] offset:31744
  s_waitcnt lgkmcnt(0)
  s_mov_b32 s14, 1
  s_cmp_lt_i32 s14, s30
  s_cbranch_scc1 T_kv2_7
  s_mov_b32 s19, 0
  s_branch T_kvok_9
T_kv_8:
  s_sleep 4
  s_add_u32 s19, s19, 1
  s_cmp_gt_u32 s19, 32768
  s_cbranch_scc1 M_exit
T_kvok_9:
  s_add_u32 s39, s99, 128
  s_mov_b32 s38, 0
  s_mov_b32 s37, 0
  s_atomic_or s38, s[58:59], s99 glc
  s_atomic_or s37, s[58:59], s39 glc
  s_waitcnt lgkmcnt(0)
  s_lshl_b32 s38, s38, 1
  s_lshl1_add_u32 s37, s37, 1
  s_min_u32 s38, s38, s37
  s_cmp_ge_u32 s38, 64
  s_cselect_b32 s38, 100, s38
  s_sub_u32 s38, s38, 1
  s_max_i32 s30, s30, s38
  s_cmp_ge_i32 s14, s30
  s_cbranch_scc1 T_kv_8
T_kv2_7:
  s_waitcnt vmcnt(0) lgkmcnt(0)
  s_barrier
  s_cmp_ge_u32 s13, 2
  s_cselect_b64 vcc, -1, 0
  v_cndmask_b32 v3, v8, v19, vcc
  ds_read_b128 v[68:71], v4 offset:0
  ds_read_b128 v[72:75], v4 offset:1024
  ds_read_b128 v[76:79], v4 offset:4096
  ds_read_b128 v[80:83], v4 offset:5120
  ds_read_b128 v[84:87], v4 offset:8192
  ds_read_b128 v[88:91], v4 offset:9216
  ds_read_b128 v[92:95], v4 offset:2048
  ds_read_b128 v[96:99], v4 offset:3072
  ds_read_b128 v[100:103], v4 offset:6144
  ds_read_b128 v[104:107], v4 offset:7168
  ds_read_b128 v[108:111], v4 offset:10240
  ds_read_b128 v[112:115], v4 offset:11264
  ds_read_b128 v[28:31], v59 offset:16384
  ds_read_b128 v[32:35], v59 offset:20480
  ds_read_b128 v[36:39], v2 offset:8192
  ds_read_b128 v[40:43], v2 offset:9216
  ds_read_b128 v[44:47], v2 offset:10240
  ds_read_b128 v[48:51], v2 offset:11264
  ds_read_b128 v[52:55], v2 offset:12288
  ds_read_b128 v[56:59], v2 offset:13312
  ds_read_b128 v[60:63], v2 offset:14336
  ds_read_b128 v[64:67], v2 offset:15360
  s_and_b32 s36, s13, 1
  s_lshl_b32 s36, s36, 12
  s_add_u32 s22, s22, s36
  s_add_u32 s23, s36, 145752064
  s_mov_b32 s14, -1
  s_and_b32 s57, s14, 1
  s_and_b32 s36, s14, 3
  s_lshl_b32 s36, s36, 13
  s_add_u32 s26, s36, s23
  s_add_u32 s36, s36, 8192
  s_and_b32 s36, s36, 0x7fff
  s_add_u32 s24, s36, 145752064
  s_add_u32 s25, s36, 145756160
  s_add_u32 s35, s36, s23
  s_waitcnt lgkmcnt(0)
  s_cmp_lg_u32 s56, 0
  s_cbranch_scc1 M_global
T_code:
  s_cmp_eq_u32 s13, 1
  s_cbranch_scc1 T_w_11
  s_cmp_eq_u32 s13, 2
  s_cbranch_scc1 T_w_12
  s_cmp_eq_u32 s13, 3
  s_cbranch_scc1 T_w_13
T_w_10:
  s_mov_b32 s19, 0
  s_add_u32 s14, s14, 1
  s_and_b32 s57, s14, 1
  v_mov_b64 v[16:17], 0
  v_mov_b64 v[18:19], 0
  v_mov_b64 v[20:21], 0
  v_mov_b64 v[22:23], 0
  v_mov_b64 v[24:25], 0
  v_mov_b64 v[26:27], 0
  buffer_load_dwordx4 v[124:127], v2, s[4:7], s24 offen offset:0 sc1
  buffer_load_dwordx4 v[116:119], v2, s[4:7], s25 offen offset:0 sc1
  buffer_load_dwordx4 v[124:127], v2, s[4:7], s24 offen offset:0 sc1
  buffer_load_dwordx4 v[116:119], v2, s[4:7], s25 offen offset:0 sc1
  s_branch T_loop_14
.p2align 6
T_retry_15:
  s_mov_b64 exec, vcc
  buffer_load_dwordx4 v[124:127], v2, s[4:7], s24 offen offset:0 sc1
  buffer_load_dwordx4 v[116:119], v2, s[4:7], s25 offen offset:0 sc1
  s_mov_b64 exec, -1
  s_add_u32 s19, s19, 1
  s_cmp_gt_u32 s19, 32768
  s_cbranch_scc1 M_exit
  s_nop 0
  v_mov_b64 v[16:17], 0
  v_mov_b64 v[18:19], 0
T_loop_14:
  s_waitcnt vmcnt(3) lgkmcnt(0)
  v_max3_u32 v123, v124, v125, v126
  v_max_u32 v123, v123, v127
  v_mov_b32_dpp v120, v124 row_ror:8 row_mask:0xf bank_mask:0xf
  v_mov_b32_dpp v121, v125 row_ror:8 row_mask:0xf bank_mask:0xf
  s_waitcnt vmcnt(2)
  v_max3_u32 v123, v123, v116, v117
  v_max3_u32 v123, v123, v118, v119
  v_cmp_eq_u32 vcc, -1, v123
  v_smfmac_f32_16x16x64_bf16 v[16:19], v[124:127], v[68:75], v0
  s_cbranch_vccnz T_retry_15
  ds_write_b128 v2, v[124:127] offset:0
  v_mov_b32_dpp v122, v126 row_ror:8 row_mask:0xf bank_mask:0xf
  v_smfmac_f32_16x16x64_bf16 v[20:23], v[124:127], v[76:83], v0
  s_and_b32 s57, s14, 1
  v_mov_b32_dpp v123, v127 row_ror:8 row_mask:0xf bank_mask:0xf
  v_smfmac_f32_16x16x64_bf16 v[24:27], v[124:127], v[84:91], v0
  s_and_b32 s36, s14, 3
  ds_write_b128 v2, v[116:119] offset:4096
  v_smfmac_f32_16x16x64_bf16 v[16:19], v[120:123], v[92:99], v0
  s_lshl_b32 s36, s36, 13
  v_mov_b32_dpp v84, v116 row_ror:8 row_mask:0xf bank_mask:0xf
  v_smfmac_f32_16x16x64_bf16 v[20:23], v[120:123], v[100:107], v0
  s_add_u32 s26, s36, s23
  ds_read_b128 v[68:71], v4 offset:12288
  v_mov_b32_dpp v85, v117 row_ror:8 row_mask:0xf bank_mask:0xf
  v_smfmac_f32_16x16x64_bf16 v[24:27], v[120:123], v[108:115], v0
  s_add_u32 s36, s36, 8192
  ds_read_b128 v[72:75], v4 offset:13312
  v_mov_b32_dpp v86, v118 row_ror:8 row_mask:0xf bank_mask:0xf
  v_smfmac_f32_16x16x64_bf16 v[16:19], v[116:119], v[224:231], v0
  s_and_b32 s36, s36, 0x7fff
  ds_read_b128 v[76:79], v4 offset:14336
  v_mov_b32_dpp v87, v119 row_ror:8 row_mask:0xf bank_mask:0xf
  v_smfmac_f32_16x16x64_bf16 v[20:23], v[116:119], v[240:247], v0
  s_waitcnt lgkmcnt(3)
  s_barrier
  ds_read_b128 v[100:103], v2 offset:1024
  v_smfmac_f32_16x16x64_bf16 v[24:27], v[116:119], a[0:7], v0
  s_mov_b32 m0, s31
  ds_read_b128 v[120:123], v1 offset:1024
  buffer_load_dwordx4 v9, s[4:7], s27 offen sc1 lds
  v_smfmac_f32_16x16x64_bf16 v[16:19], v[84:87], v[232:239], v0
  s_mov_b32 m0, s32
  v_smfmac_f32_16x16x64_bf16 v[20:23], v[84:87], v[248:255], v0
  ds_read_b128 v[80:83], v4 offset:15360
  v_smfmac_f32_16x16x64_bf16 v[24:27], v[84:87], a[8:15], v0
  s_waitcnt lgkmcnt(2)
  v_smfmac_f32_16x16x64_bf16 v[16:19], v[100:103], v[128:135], v0
  ds_read_b128 v[92:95], v2 offset:2048
  buffer_load_dwordx4 v9, s[4:7], s27 offen offset:128 sc1 lds
  v_smfmac_f32_16x16x64_bf16 v[20:23], v[100:103], v[144:151], v0
  ds_read_b128 v[96:99], v1 offset:2048
  s_mov_b32 m0, s33
  v_smfmac_f32_16x16x64_bf16 v[24:27], v[100:103], v[68:75], v0
  s_waitcnt vmcnt(2) lgkmcnt(3)
  ds_read_b128 v[116:119], v2 offset:3072
  v_smfmac_f32_16x16x64_bf16 v[16:19], v[120:123], v[136:143], v0
  ds_read_b128 v[124:127], v1 offset:3072
  v_smfmac_f32_16x16x64_bf16 v[20:23], v[120:123], v[152:159], v0
  s_waitcnt lgkmcnt(4)
  ds_read_b128 v[104:107], v2 offset:5120
  buffer_load_dwordx4 v10, s[4:7], s28 offen sc1 lds
  v_smfmac_f32_16x16x64_bf16 v[24:27], v[120:123], v[76:83], v0
  s_waitcnt lgkmcnt(4)
  ds_read_b128 v[108:111], v1 offset:5120
  s_mov_b32 m0, s34
  v_smfmac_f32_16x16x64_bf16 v[16:19], v[92:95], v[160:167], v0
  s_waitcnt lgkmcnt(4)
  ds_read_b128 v[112:115], v2 offset:6144
  v_smfmac_f32_16x16x64_bf16 v[16:19], v[96:99], v[168:175], v0
  s_waitcnt lgkmcnt(4)
  ds_read_b128 v[84:87], v1 offset:6144
  v_smfmac_f32_16x16x64_bf16 v[16:19], v[116:119], v[192:199], v0
  s_waitcnt lgkmcnt(4)
  ds_read_b128 v[88:91], v2 offset:7168
  buffer_load_dwordx4 v10, s[4:7], s28 offen offset:256 sc1 lds
  v_smfmac_f32_16x16x64_bf16 v[16:19], v[124:127], v[200:207], v0
  s_waitcnt lgkmcnt(4)
  ds_read_b128 v[100:103], v1 offset:7168
  v_smfmac_f32_16x16x64_bf16 v[16:19], v[104:107], a[16:23], v0
  s_waitcnt lgkmcnt(4)
  ds_read_b128 v[68:71], v4 offset:16384
  v_smfmac_f32_16x16x64_bf16 v[16:19], v[108:111], a[24:31], v0
  s_waitcnt lgkmcnt(4)
  ds_read_b128 v[72:75], v4 offset:17408
  v_smfmac_f32_16x16x64_bf16 v[16:19], v[112:115], a[64:71], v0
  s_waitcnt lgkmcnt(4)
  ds_read_b128 v[76:79], v4 offset:18432
  v_smfmac_f32_16x16x64_bf16 v[16:19], v[84:87], a[72:79], v0
  s_waitcnt lgkmcnt(4)
  ds_read_b128 v[80:83], v4 offset:19456
  v_smfmac_f32_16x16x64_bf16 v[16:19], v[88:91], a[112:119], v0
  s_waitcnt lgkmcnt(4)
  v_smfmac_f32_16x16x64_bf16 v[16:19], v[100:103], a[120:127], v0
  s_add_u32 s24, s36, 145752064
  s_add_u32 s25, s36, 145756160
  v_smfmac_f32_16x16x64_bf16 v[20:23], v[92:95], v[176:183], v0
  s_add_u32 s35, s36, s23
  v_smfmac_f32_16x16x64_bf16 v[20:23], v[96:99], v[184:191], v0
  s_waitcnt lgkmcnt(2)
  v_smfmac_f32_16x16x64_bf16 v[20:23], v[116:119], v[68:75], v0
  s_waitcnt lgkmcnt(0)
  ds_read_b128 v[68:71], v4 offset:20480
  v_mul_f32 v16, s18, v16
  v_smfmac_f32_16x16x64_bf16 v[20:23], v[124:127], v[76:83], v0
  ds_read_b128 v[72:75], v4 offset:21504
  v_mul_f32 v17, s18, v17
  v_smfmac_f32_16x16x64_bf16 v[20:23], v[104:107], a[32:39], v0
  ds_read_b128 v[76:79], v4 offset:22528
  v_mul_f32 v18, s18, v18
  v_smfmac_f32_16x16x64_bf16 v[20:23], v[108:111], a[40:47], v0
  ds_read_b128 v[80:83], v4 offset:23552
  v_mul_f32 v19, s18, v19
  v_smfmac_f32_16x16x64_bf16 v[20:23], v[112:115], a[80:87], v0
  v_cvt_pk_bf16_f32 v120, v16, v17
  v_smfmac_f32_16x16x64_bf16 v[20:23], v[84:87], a[88:95], v0
  v_cvt_pk_bf16_f32 v121, v18, v19
  v_smfmac_f32_16x16x64_bf16 v[20:23], v[88:91], a[128:135], v0
  ds_write_b64 v5, v[120:121] offset:24576
  v_smfmac_f32_16x16x64_bf16 v[20:23], v[100:103], a[136:143], v0
  s_waitcnt lgkmcnt(3)
  v_smfmac_f32_16x16x64_bf16 v[24:27], v[92:95], v[68:75], v0
  s_waitcnt lgkmcnt(1)
  v_mov_b64 v[92:93], 0
  v_smfmac_f32_16x16x64_bf16 v[24:27], v[96:99], v[76:83], v0
  s_nop 1
  v_cvt_pk_bf16_f32 v122, v20, v21
  v_cvt_pk_bf16_f32 v123, v22, v23
  v_smfmac_f32_16x16x64_bf16 v[24:27], v[116:119], v[208:215], v0
  ds_write_b64 v5, v[122:123] offset:26880
  v_mov_b64 v[94:95], 0
  v_smfmac_f32_16x16x64_bf16 v[24:27], v[124:127], v[216:223], v0
  s_waitcnt lgkmcnt(1)
  s_barrier
  ds_read_b64_tr_b16 v[68:69], v6 offset:24576
  v_smfmac_f32_16x16x64_bf16 v[24:27], v[104:107], a[48:55], v0
  s_add_u32 s27, s27, 8192
  ds_read_b64_tr_b16 v[70:71], v6 offset:24640
  ds_read_b64_tr_b16 v[72:73], v6 offset:24832
  v_smfmac_f32_16x16x64_bf16 v[24:27], v[108:111], a[56:63], v0
  s_add_u32 s28, s28, 8192
  ds_read_b64_tr_b16 v[74:75], v6 offset:24896
  ds_read_b64_tr_b16 v[76:77], v6 offset:25088
  v_smfmac_f32_16x16x64_bf16 v[24:27], v[112:115], a[96:103], v0
  s_nop 0
  ds_read_b64_tr_b16 v[78:79], v6 offset:25152
  ds_read_b64_tr_b16 v[80:81], v6 offset:25344
  v_smfmac_f32_16x16x64_bf16 v[24:27], v[84:87], a[104:111], v0
  ds_read_b64_tr_b16 v[82:83], v6 offset:25408
  v_mov_b64 v[96:97], 0
  v_smfmac_f32_16x16x64_bf16 v[24:27], v[88:91], a[144:151], v0
  s_waitcnt lgkmcnt(8)
  s_barrier
  ds_read_b64_tr_b16 v[116:117], v6 offset:26880
  v_smfmac_f32_16x16x64_bf16 v[24:27], v[100:103], a[152:159], v0
  s_waitcnt lgkmcnt(7)
  ds_read_b64_tr_b16 v[118:119], v6 offset:26944
  v_mfma_f32_16x16x32_bf16 v[16:19], v[36:39], v[68:71], 0
  s_waitcnt lgkmcnt(6)
  ds_read_b64_tr_b16 v[124:125], v6 offset:27136
  ds_read_b64_tr_b16 v[126:127], v6 offset:27200
  v_mfma_f32_16x16x32_bf16 v[16:19], v[40:43], v[72:75], v[16:19]
  s_waitcnt lgkmcnt(6)
  ds_read_b64_tr_b16 v[104:105], v6 offset:27392
  ds_read_b64_tr_b16 v[106:107], v6 offset:27456
  v_mfma_f32_16x16x32_bf16 v[16:19], v[44:47], v[76:79], v[16:19]
  s_waitcnt lgkmcnt(6)
  ds_read_b64_tr_b16 v[108:109], v6 offset:27648
  ds_read_b64_tr_b16 v[110:111], v6 offset:27712
  v_mfma_f32_16x16x32_bf16 v[16:19], v[48:51], v[80:83], v[16:19]
  s_waitcnt lgkmcnt(6)
  v_cvt_pk_bf16_f32 v120, v24, v25
  v_cvt_pk_bf16_f32 v121, v26, v27
  v_mfma_f32_16x16x32_bf16 v[112:115], v[116:119], v[68:71], 0
  s_waitcnt lgkmcnt(4)
  buffer_store_dwordx4 v[120:123], v2, s[4:7], s29 offen offset:0 sc1
  v_mov_b64 v[98:99], 0
  v_mfma_f32_16x16x32_bf16 v[112:115], v[124:127], v[72:75], v[112:115]
  s_waitcnt lgkmcnt(2)
  v_mov_b64 v[36:37], 0
  v_exp_f32 v100, v16
  v_mfma_f32_16x16x32_bf16 v[112:115], v[104:107], v[76:79], v[112:115]
  s_waitcnt lgkmcnt(0)
  v_exp_f32 v101, v17
  v_mfma_f32_16x16x32_bf16 v[112:115], v[108:111], v[80:83], v[112:115]
  v_exp_f32 v102, v18
  v_mfma_f32_16x16x32_bf16 v[20:23], v[52:55], v[68:71], 0
  v_exp_f32 v103, v19
  v_mfma_f32_16x16x32_bf16 v[20:23], v[56:59], v[72:75], v[20:23]
  v_cvt_pk_bf16_f32 v44, v100, v101
  v_cvt_pk_bf16_f32 v45, v102, v103
  v_mfma_f32_16x16x32_bf16 v[20:23], v[60:63], v[76:79], v[20:23]
  s_add_u32 s29, s29, 131072
  v_exp_f32 v100, v112
  v_mfma_f32_16x16x32_bf16 v[20:23], v[64:67], v[80:83], v[20:23]
  v_exp_f32 v101, v113
  v_exp_f32 v102, v114
  v_exp_f32 v103, v115
  v_cvt_pk_bf16_f32 v84, v100, v101
  v_cvt_pk_bf16_f32 v85, v102, v103
  v_cndmask_b32 v48, v84, 0, s[16:17]
  v_cndmask_b32 v49, v85, 0, s[16:17]
  v_cndmask_b32 v50, 0, v84, s[16:17]
  v_cndmask_b32 v51, 0, v85, s[16:17]
  v_exp_f32 v100, v20
  v_mfma_f32_16x16x16_bf16 v[88:91], v[12:13], v[48:49], 0
  v_exp_f32 v101, v21
  v_mfma_f32_16x16x16_bf16 v[24:27], v[120:121], v[48:49], 0
  v_exp_f32 v102, v22
  v_mfma_f32_16x16x16_bf16 v[116:119], v[120:121], v[50:51], 0
  v_exp_f32 v103, v23
  v_cvt_pk_bf16_f32 v46, v100, v101
  v_cvt_pk_bf16_f32 v47, v102, v103
  v_mov_b64 v[38:39], 0
  s_nop 0
  v_mfma_f32_16x16x32_bf16 v[88:91], v[12:15], v[44:47], v[88:91]
  v_mov_b64 v[40:41], 0
  v_mov_b64 v[42:43], 0
  v_mfma_f32_16x16x32_bf16 v[24:27], v[28:31], v[44:47], v[24:27]
  ds_read_b128 v[52:55], v4 offset:24576
  ds_read_b128 v[56:59], v4 offset:25600
  v_mfma_f32_16x16x32_bf16 v[116:119], v[32:35], v[44:47], v[116:119]
  s_nop 1
T_back_22:
  v_rcp_f32 v89, v88
  v_subrev_u32 v100, s54, v88
  v_cmp_le_u32 vcc, s96, v100
  v_mul_f32 v24, v89, v24
  v_mul_f32 v25, v89, v25
  v_cvt_pk_bf16_f32 v124, v24, v25
  v_pk_mul_f32 v[26:27], v[26:27], v[88:89] op_sel:[0,1] op_sel_hi:[1,1]
  v_pk_mul_f32 v[116:117], v[116:117], v[88:89] op_sel:[0,1] op_sel_hi:[1,1]
  v_pk_mul_f32 v[118:119], v[118:119], v[88:89] op_sel:[0,1] op_sel_hi:[1,1]
  v_cvt_pk_bf16_f32 v125, v26, v27
  v_cvt_pk_bf16_f32 v126, v116, v117
  v_cvt_pk_bf16_f32 v127, v118, v119
  ds_write_b128 v11, v[124:127] offset:29184
  s_cbranch_vccnz T_slow_21
  v_smfmac_f32_16x16x64_bf16 v[92:95], v[124:127], a[160:167], v0
  s_mov_b32 s96, s55
  v_smfmac_f32_16x16x64_bf16 v[96:99], v[124:127], a[168:175], v0
  v_smfmac_f32_16x16x64_bf16 v[36:39], v[124:127], a[176:183], v0
  s_waitcnt lgkmcnt(0)
  s_barrier
  ds_read_b128 v[104:107], v11 offset:29696
  ds_read_b128 v[108:111], v11 offset:30208
  ds_read_b128 v[68:71], v11 offset:30720
  v_smfmac_f32_16x16x64_bf16 v[40:43], v[124:127], a[184:191], v0
  s_waitcnt lgkmcnt(2)
  v_smfmac_f32_16x16x64_bf16 v[92:95], v[104:107], a[192:199], v0
  s_waitcnt lgkmcnt(1)
  ds_read_b128 v[76:79], v4 offset:28672
  v_smfmac_f32_16x16x64_bf16 v[92:95], v[108:111], a[224:231], v0
  s_waitcnt lgkmcnt(1)
  ds_read_b128 v[80:83], v4 offset:29696
  v_smfmac_f32_16x16x64_bf16 v[92:95], v[68:71], a[240:247], v0
  ds_read_b128 v[60:63], v4 offset:26624
  v_smfmac_f32_16x16x64_bf16 v[96:99], v[104:107], a[200:207], v0
  ds_read_b128 v[64:67], v4 offset:27648
  v_smfmac_f32_16x16x64_bf16 v[96:99], v[108:111], a[232:239], v0
  ds_read_b128 v[28:31], v4 offset:30720
  s_nop 0
  v_cvt_pk_bf16_f32 v16, v92, v93
  v_cvt_pk_bf16_f32 v17, v94, v95
  v_bfi_b32 v16, 1, s57, v16
  v_smfmac_f32_16x16x64_bf16 v[96:99], v[68:71], a[248:255], v0
  buffer_store_dwordx2 v[16:17], v7, s[4:7], s20 offen offset:0
  v_smfmac_f32_16x16x64_bf16 v[36:39], v[104:107], a[208:215], v0
  ds_read_b128 v[32:35], v4 offset:31744
  v_smfmac_f32_16x16x64_bf16 v[36:39], v[108:111], v[52:59], v0
  s_waitcnt lgkmcnt(4)
  s_nop 0
  v_cvt_pk_bf16_f32 v18, v96, v97
  v_cvt_pk_bf16_f32 v19, v98, v99
  v_bfi_b32 v18, 1, s57, v18
  v_smfmac_f32_16x16x64_bf16 v[36:39], v[68:71], v[76:83], v0
  buffer_store_dwordx2 v[18:19], v7, s[4:7], s20 offen offset:64
  v_smfmac_f32_16x16x64_bf16 v[40:43], v[104:107], a[216:223], v0
  s_waitcnt lgkmcnt(2)
  ds_read_b128 v[116:119], v2 offset:31232
  v_smfmac_f32_16x16x64_bf16 v[40:43], v[108:111], v[60:67], v0
  s_waitcnt lgkmcnt(1)
  s_nop 0
  v_cvt_pk_bf16_f32 v20, v36, v37
  v_cvt_pk_bf16_f32 v21, v38, v39
  v_bfi_b32 v20, 1, s57, v20
  v_smfmac_f32_16x16x64_bf16 v[40:43], v[68:71], v[28:35], v0
  buffer_store_dwordx2 v[20:21], v7, s[4:7], s21 offen offset:0
  s_nop 6
  v_cvt_pk_bf16_f32 v22, v40, v41
  v_cvt_pk_bf16_f32 v23, v42, v43
  v_bfi_b32 v22, 1, s57, v22
  buffer_store_dwordx2 v[22:23], v7, s[4:7], s21 offen offset:64
  ds_read_b128 v[68:71], v4 offset:0
  ds_read_b128 v[72:75], v4 offset:1024
  ds_read_b128 v[76:79], v4 offset:4096
  ds_read_b128 v[80:83], v4 offset:5120
  ds_read_b128 v[84:87], v4 offset:8192
  ds_read_b128 v[88:91], v4 offset:9216
  v_mov_b64 v[16:17], 0
  v_mov_b64 v[18:19], 0
  v_mov_b64 v[20:21], 0
  v_mov_b64 v[22:23], 0
  v_mov_b64 v[24:25], 0
  v_mov_b64 v[26:27], 0
  s_mov_b32 s19, 0
  v_mov_b32 v49, -1
  s_waitcnt vmcnt(2)
  buffer_load_dwordx4 v[52:55], v2, s[4:7], s22 offen offset:0 sc1
  buffer_load_dwordx4 v[56:59], v2, s[4:7], s22 offen offset:1024 sc1
  buffer_load_dwordx4 v[60:63], v2, s[4:7], s22 offen offset:2048 sc1
  buffer_load_dwordx4 v[64:67], v2, s[4:7], s22 offen offset:3072 sc1
  ds_read_b128 v[92:95], v4 offset:2048
  ds_read_b128 v[96:99], v4 offset:3072
  ds_read_b128 v[100:103], v4 offset:6144
  ds_read_b128 v[104:107], v4 offset:7168
  ds_read_b128 v[108:111], v4 offset:10240
  ds_read_b128 v[112:115], v4 offset:11264
  ds_read_b64 v[44:45], v2 offset:32256
  s_waitcnt lgkmcnt(0)
  v_readfirstlane_b32 s38, v44
  v_readfirstlane_b32 s37, v45
  s_nop 0
  s_lshl_b32 s38, s38, 1
  s_lshl1_add_u32 s37, s37, 1
  s_min_u32 s38, s38, s37
  s_cmp_ge_u32 s38, 64
  s_cselect_b32 s38, 100, s38
  s_sub_u32 s38, s38, 1
  s_max_i32 s30, s30, s38
  s_waitcnt lgkmcnt(12)
  s_waitcnt vmcnt(3)
  v_mfma_f32_16x16x32_bf16 v[120:123], v[116:119], v[52:55], 0
  v_xor_b32 v48, s57, v52
  v_bitop3_b32 v48, v48, v54, s57 bitop3:0xf6
  s_waitcnt vmcnt(2)
  v_mfma_f32_16x16x32_bf16 v[120:123], v[116:119], v[56:59], v[120:123]
  v_bitop3_b32 v48, v48, v56, s57 bitop3:0xf6
  v_bitop3_b32 v48, v48, v58, s57 bitop3:0xf6
  s_waitcnt vmcnt(1)
  v_mfma_f32_16x16x32_bf16 v[120:123], v[116:119], v[60:63], v[120:123]
  v_bitop3_b32 v48, v48, v60, s57 bitop3:0xf6
  v_bitop3_b32 v48, v48, v62, s57 bitop3:0xf6
  s_waitcnt vmcnt(0)
  v_mfma_f32_16x16x32_bf16 v[120:123], v[116:119], v[64:67], v[120:123]
  v_bitop3_b32 v48, v48, v64, s57 bitop3:0xf6
  v_bitop3_b32 v48, v48, v66, s57 bitop3:0xf6
  v_and_b32 v48, 1, v48
  v_cmp_ne_u32 vcc, 0, v48
  s_cbranch_vccnz T_p1re_24
T_p1ok_25:
  s_nop 2
  v_add_f32_dpp v120, v120, v120 row_ror:8 row_mask:0xf bank_mask:0xf
  v_add_f32_dpp v121, v121, v121 row_ror:8 row_mask:0xf bank_mask:0xf
  v_cvt_pk_bf16_f32 v48, v120, v121
  buffer_store_dword v48, v8, s[4:7], s35 offen
  buffer_store_dword v49, v8, s[4:7], s26 offen
  s_barrier
  ds_read_b128 v[28:31], v2 offset:16384
  ds_read_b128 v[32:35], v2 offset:20480
  ds_read_b128 v[36:39], v2 offset:8192
  ds_read_b128 v[40:43], v2 offset:9216
  ds_read_b128 v[44:47], v2 offset:10240
  ds_read_b128 v[48:51], v2 offset:11264
  buffer_load_dwordx4 v[124:127], v2, s[4:7], s24 offen offset:0 sc1
  buffer_load_dwordx4 v[116:119], v2, s[4:7], s25 offen offset:0 sc1
  ds_read_b128 v[52:55], v2 offset:12288
  ds_read_b128 v[56:59], v2 offset:13312
  ds_read_b128 v[60:63], v2 offset:14336
  ds_read_b128 v[64:67], v2 offset:15360
  buffer_load_dwordx4 v[124:127], v2, s[4:7], s24 offen offset:0 sc1
  buffer_load_dwordx4 v[116:119], v2, s[4:7], s25 offen offset:0 sc1
  s_add_u32 s14, s14, 1
  s_cmp_ge_i32 s14, s30
  s_cbranch_scc1 T_kvw_18
T_kvb_19:
  s_mov_b32 s19, 0
  s_cmp_lg_u32 s14, 63
  s_cbranch_scc1 T_loop_14
  s_branch T_last_20
T_p1re_24:
  s_mov_b64 exec, vcc
  buffer_load_dwordx4 v[52:55], v2, s[4:7], s22 offen offset:0 sc1
  buffer_load_dwordx4 v[56:59], v2, s[4:7], s22 offen offset:1024 sc1
  buffer_load_dwordx4 v[60:63], v2, s[4:7], s22 offen offset:2048 sc1
  buffer_load_dwordx4 v[64:67], v2, s[4:7], s22 offen offset:3072 sc1
  s_mov_b64 exec, -1
  s_add_u32 s19, s19, 1
  s_cmp_gt_u32 s19, 32768
  s_cbranch_scc1 M_exit
  s_waitcnt vmcnt(3)
  v_mfma_f32_16x16x32_bf16 v[120:123], v[116:119], v[52:55], 0
  v_xor_b32 v48, s57, v52
  v_bitop3_b32 v48, v48, v54, s57 bitop3:0xf6
  s_waitcnt vmcnt(2)
  v_mfma_f32_16x16x32_bf16 v[120:123], v[116:119], v[56:59], v[120:123]
  v_bitop3_b32 v48, v48, v56, s57 bitop3:0xf6
  v_bitop3_b32 v48, v48, v58, s57 bitop3:0xf6
  s_waitcnt vmcnt(1)
  v_mfma_f32_16x16x32_bf16 v[120:123], v[116:119], v[60:63], v[120:123]
  v_bitop3_b32 v48, v48, v60, s57 bitop3:0xf6
  v_bitop3_b32 v48, v48, v62, s57 bitop3:0xf6
  s_waitcnt vmcnt(0)
  v_mfma_f32_16x16x32_bf16 v[120:123], v[116:119], v[64:67], v[120:123]
  v_bitop3_b32 v48, v48, v64, s57 bitop3:0xf6
  v_bitop3_b32 v48, v48, v66, s57 bitop3:0xf6
  v_and_b32 v48, 1, v48
  v_cmp_ne_u32 vcc, 0, v48
  s_cbranch_vccnz T_p1re_24
  s_branch T_p1ok_25
T_kvw_18:
  s_mov_b32 s19, 0
  s_branch T_kvok_27
T_kv_26:
  s_sleep 4
  s_add_u32 s19, s19, 1
  s_cmp_gt_u32 s19, 32768
  s_cbranch_scc1 M_exit
T_kvok_27:
  s_add_u32 s39, s99, 128
  s_mov_b32 s38, 0
  s_mov_b32 s37, 0
  s_atomic_or s38, s[58:59], s99 glc
  s_atomic_or s37, s[58:59], s39 glc
  s_waitcnt lgkmcnt(0)
  s_lshl_b32 s38, s38, 1
  s_lshl1_add_u32 s37, s37, 1
  s_min_u32 s38, s38, s37
  s_cmp_ge_u32 s38, 64
  s_cselect_b32 s38, 100, s38
  s_sub_u32 s38, s38, 1
  s_max_i32 s30, s30, s38
  s_cmp_ge_i32 s14, s30
  s_cbranch_scc1 T_kv_26
  s_branch T_kvb_19
T_slow_21:
  s_nop 7
  v_max3_f32 v100, v16, v17, v18
  v_max3_f32 v100, v100, v19, v20
  v_max3_f32 v100, v100, v21, v22
  v_max3_f32 v100, v100, v23, v112
  v_max3_f32 v100, v100, v113, v114
  v_max_f32 v100, v100, v115
  v_mov_b32 v101, v100
  s_nop 1
  v_permlane32_swap_b32 v100, v101
  s_nop 1
  v_max_f32 v100, v100, v101
  v_mov_b32 v101, v100
  s_nop 1
  v_permlane16_swap_b32 v100, v101
  s_nop 1
  v_max_f32 v100, v100, v101
  v_sub_f32 v16, v16, v100
  v_sub_f32 v17, v17, v100
  v_sub_f32 v18, v18, v100
  v_sub_f32 v19, v19, v100
  v_exp_f32 v16, v16
  v_exp_f32 v17, v17
  v_exp_f32 v18, v18
  v_exp_f32 v19, v19
  v_sub_f32 v20, v20, v100
  v_sub_f32 v21, v21, v100
  v_sub_f32 v22, v22, v100
  v_sub_f32 v23, v23, v100
  v_exp_f32 v20, v20
  v_exp_f32 v21, v21
  v_exp_f32 v22, v22
  v_exp_f32 v23, v23
  v_sub_f32 v112, v112, v100
  v_sub_f32 v113, v113, v100
  v_sub_f32 v114, v114, v100
  v_sub_f32 v115, v115, v100
  v_exp_f32 v112, v112
  v_exp_f32 v113, v113
  v_exp_f32 v114, v114
  v_exp_f32 v115, v115
  s_nop 0
  v_cvt_pk_bf16_f32 v44, v16, v17
  v_cvt_pk_bf16_f32 v45, v18, v19
  v_cvt_pk_bf16_f32 v46, v20, v21
  v_cvt_pk_bf16_f32 v47, v22, v23
  v_cvt_pk_bf16_f32 v84, v112, v113
  v_cvt_pk_bf16_f32 v85, v114, v115
  v_cndmask_b32 v48, v84, 0, s[16:17]
  v_cndmask_b32 v49, v85, 0, s[16:17]
  v_cndmask_b32 v50, 0, v84, s[16:17]
  v_cndmask_b32 v51, 0, v85, s[16:17]
  s_nop 1
  v_mfma_f32_16x16x16_bf16 v[88:91], v[12:13], v[48:49], 0
  v_mfma_f32_16x16x16_bf16 v[24:27], v[120:121], v[48:49], 0
  v_mfma_f32_16x16x16_bf16 v[116:119], v[120:121], v[50:51], 0
  v_mfma_f32_16x16x32_bf16 v[88:91], v[12:15], v[44:47], v[88:91]
  v_mfma_f32_16x16x32_bf16 v[24:27], v[28:31], v[44:47], v[24:27]
  v_mfma_f32_16x16x32_bf16 v[116:119], v[32:35], v[44:47], v[116:119]
  s_nop 7
  s_nop 1
  s_mov_b32 s96, -1
  s_branch T_back_22
.p2align 6
T_retry_28:
  s_mov_b64 exec, vcc
  buffer_load_dwordx4 v[124:127], v2, s[4:7], s24 offen offset:0 sc1
  buffer_load_dwordx4 v[116:119], v2, s[4:7], s25 offen offset:0 sc1
  s_mov_b64 exec, -1
  s_add_u32 s19, s19, 1
  s_cmp_gt_u32 s19, 32768
  s_cbranch_scc1 M_exit
T_last_20:
  s_waitcnt vmcnt(3) lgkmcnt(0)
  v_max3_u32 v123, v124, v125, v126
  v_max_u32 v123, v123, v127
  v_mov_b32_dpp v120, v124 row_ror:8 row_mask:0xf bank_mask:0xf
  v_mov_b32_dpp v121, v125 row_ror:8 row_mask:0xf bank_mask:0xf
  s_waitcnt vmcnt(2)
  v_max3_u32 v123, v123, v116, v117
  v_max3_u32 v123, v123, v118, v119
  v_cmp_eq_u32 vcc, -1, v123
  s_cbranch_vccnz T_retry_28
  v_smfmac_f32_16x16x64_bf16 v[20:23], v[124:127], v[76:83], v0
  ds_write_b128 v2, v[124:127] offset:0
  v_mov_b32_dpp v122, v126 row_ror:8 row_mask:0xf bank_mask:0xf
  v_mov_b32_dpp v123, v127 row_ror:8 row_mask:0xf bank_mask:0xf
  v_smfmac_f32_16x16x64_bf16 v[24:27], v[124:127], v[84:91], v0
  ds_write_b128 v2, v[116:119] offset:4096
  v_mov_b32_dpp v84, v116 row_ror:8 row_mask:0xf bank_mask:0xf
  v_smfmac_f32_16x16x64_bf16 v[20:23], v[120:123], v[100:107], v0
  ds_read_b128 v[68:71], v4 offset:12288
  v_mov_b32_dpp v85, v117 row_ror:8 row_mask:0xf bank_mask:0xf
  v_smfmac_f32_16x16x64_bf16 v[24:27], v[120:123], v[108:115], v0
  ds_read_b128 v[72:75], v4 offset:13312
  v_mov_b32_dpp v86, v118 row_ror:8 row_mask:0xf bank_mask:0xf
  ds_read_b128 v[76:79], v4 offset:14336
  v_mov_b32_dpp v87, v119 row_ror:8 row_mask:0xf bank_mask:0xf
  v_smfmac_f32_16x16x64_bf16 v[20:23], v[116:119], v[240:247], v0
  s_waitcnt lgkmcnt(3)
  s_barrier
  ds_read_b128 v[100:103], v2 offset:1024
  v_smfmac_f32_16x16x64_bf16 v[24:27], v[116:119], a[0:7], v0
  ds_read_b128 v[120:123], v1 offset:1024
  v_smfmac_f32_16x16x64_bf16 v[20:23], v[84:87], v[248:255], v0
  ds_read_b128 v[80:83], v4 offset:15360
  v_smfmac_f32_16x16x64_bf16 v[24:27], v[84:87], a[8:15], v0
  s_waitcnt lgkmcnt(2)
  ds_read_b128 v[92:95], v2 offset:2048
  v_smfmac_f32_16x16x64_bf16 v[20:23], v[100:103], v[144:151], v0
  ds_read_b128 v[96:99], v1 offset:2048
  v_smfmac_f32_16x16x64_bf16 v[24:27], v[100:103], v[68:75], v0
  s_waitcnt vmcnt(0) lgkmcnt(3)
  ds_read_b128 v[116:119], v2 offset:3072
  ds_read_b128 v[124:127], v1 offset:3072
  v_smfmac_f32_16x16x64_bf16 v[20:23], v[120:123], v[152:159], v0
  s_waitcnt lgkmcnt(4)
  ds_read_b128 v[104:107], v2 offset:5120
  v_smfmac_f32_16x16x64_bf16 v[24:27], v[120:123], v[76:83], v0
  s_waitcnt lgkmcnt(4)
  ds_read_b128 v[108:111], v1 offset:5120
  ds_read_b128 v[112:115], v2 offset:6144
  ds_read_b128 v[84:87], v1 offset:6144
  ds_read_b128 v[88:91], v2 offset:7168
  ds_read_b128 v[100:103], v1 offset:7168
  ds_read_b128 v[68:71], v4 offset:16384
  ds_read_b128 v[72:75], v4 offset:17408
  ds_read_b128 v[76:79], v4 offset:18432
  ds_read_b128 v[80:83], v4 offset:19456
  v_smfmac_f32_16x16x64_bf16 v[20:23], v[92:95], v[176:183], v0
  s_waitcnt lgkmcnt(12)
  v_smfmac_f32_16x16x64_bf16 v[20:23], v[96:99], v[184:191], v0
  s_waitcnt lgkmcnt(2)
  v_smfmac_f32_16x16x64_bf16 v[20:23], v[116:119], v[68:75], v0
  s_waitcnt lgkmcnt(0)
  ds_read_b128 v[68:71], v4 offset:20480
  v_smfmac_f32_16x16x64_bf16 v[20:23], v[124:127], v[76:83], v0
  ds_read_b128 v[72:75], v4 offset:21504
  v_smfmac_f32_16x16x64_bf16 v[20:23], v[104:107], a[32:39], v0
  ds_read_b128 v[76:79], v4 offset:22528
  v_smfmac_f32_16x16x64_bf16 v[20:23], v[108:111], a[40:47], v0
  ds_read_b128 v[80:83], v4 offset:23552
  v_smfmac_f32_16x16x64_bf16 v[20:23], v[112:115], a[80:87], v0
  v_smfmac_f32_16x16x64_bf16 v[20:23], v[84:87], a[88:95], v0
  v_smfmac_f32_16x16x64_bf16 v[20:23], v[88:91], a[128:135], v0
  v_smfmac_f32_16x16x64_bf16 v[20:23], v[100:103], a[136:143], v0
  s_waitcnt lgkmcnt(2)
  v_smfmac_f32_16x16x64_bf16 v[24:27], v[92:95], v[68:75], v0
  s_waitcnt lgkmcnt(0)
  v_smfmac_f32_16x16x64_bf16 v[24:27], v[96:99], v[76:83], v0
  v_smfmac_f32_16x16x64_bf16 v[24:27], v[116:119], v[208:215], v0
  v_smfmac_f32_16x16x64_bf16 v[24:27], v[124:127], v[216:223], v0
  v_smfmac_f32_16x16x64_bf16 v[24:27], v[104:107], a[48:55], v0
  v_smfmac_f32_16x16x64_bf16 v[24:27], v[108:111], a[56:63], v0
  v_smfmac_f32_16x16x64_bf16 v[24:27], v[112:115], a[96:103], v0
  v_smfmac_f32_16x16x64_bf16 v[24:27], v[84:87], a[104:111], v0
  v_smfmac_f32_16x16x64_bf16 v[24:27], v[88:91], a[144:151], v0
  v_smfmac_f32_16x16x64_bf16 v[24:27], v[100:103], a[152:159], v0
  v_cvt_pk_bf16_f32 v122, v20, v21
  v_cvt_pk_bf16_f32 v123, v22, v23
  s_nop 5
  v_cvt_pk_bf16_f32 v120, v24, v25
  v_cvt_pk_bf16_f32 v121, v26, v27
  buffer_store_dwordx4 v[120:123], v2, s[4:7], s29 offen offset:0 sc1
  s_branch M_tdone
T_w_11:
  s_mov_b32 s19, 0
  s_add_u32 s14, s14, 1
  s_and_b32 s57, s14, 1
  v_mov_b64 v[16:17], 0
  v_mov_b64 v[18:19], 0
  v_mov_b64 v[20:21], 0
  v_mov_b64 v[22:23], 0
  v_mov_b64 v[24:25], 0
  v_mov_b64 v[26:27], 0
  buffer_load_dwordx4 v[124:127], v2, s[4:7], s24 offen offset:1024 sc1
  buffer_load_dwordx4 v[116:119], v2, s[4:7], s25 offen offset:1024 sc1
  buffer_load_dwordx4 v[124:127], v2, s[4:7], s24 offen offset:1024 sc1
  buffer_load_dwordx4 v[116:119], v2, s[4:7], s25 offen offset:1024 sc1
  s_branch T_loop_33
.p2align 6
T_retry_34:
  s_mov_b64 exec, vcc
  buffer_load_dwordx4 v[124:127], v2, s[4:7], s24 offen offset:1024 sc1
  buffer_load_dwordx4 v[116:119], v2, s[4:7], s25 offen offset:1024 sc1
  s_mov_b64 exec, -1
  s_add_u32 s19, s19, 1
  s_cmp_gt_u32 s19, 32768
  s_cbranch_scc1 M_exit
  s_nop 0
  v_mov_b64 v[16:17], 0
  v_mov_b64 v[18:19], 0
T_loop_33:
  s_waitcnt vmcnt(3) lgkmcnt(0)
  v_max3_u32 v123, v124, v125, v126
  v_max_u32 v123, v123, v127
  v_mov_b32_dpp v120, v124 row_ror:8 row_mask:0xf bank_mask:0xf
  v_mov_b32_dpp v121, v125 row_ror:8 row_mask:0xf bank_mask:0xf
  s_waitcnt vmcnt(2)
  v_max3_u32 v123, v123, v116, v117
  v_max3_u32 v123, v123, v118, v119
  v_cmp_eq_u32 vcc, -1, v123
  v_smfmac_f32_16x16x64_bf16 v[16:19], v[124:127], v[68:75], v0
  s_cbranch_vccnz T_retry_34
  ds_write_b128 v2, v[124:127] offset:1024
  v_mov_b32_dpp v122, v126 row_ror:8 row_mask:0xf bank_mask:0xf
  v_smfmac_f32_16x16x64_bf16 v[20:23], v[124:127], v[76:83], v0
  s_and_b32 s57, s14, 1
  v_mov_b32_dpp v123, v127 row_ror:8 row_mask:0xf bank_mask:0xf
  v_smfmac_f32_16x16x64_bf16 v[24:27], v[124:127], v[84:91], v0
  s_and_b32 s36, s14, 3
  ds_write_b128 v2, v[116:119] offset:5120
  v_smfmac_f32_16x16x64_bf16 v[16:19], v[120:123], v[92:99], v0
  s_lshl_b32 s36, s36, 13
  v_mov_b32_dpp v84, v116 row_ror:8 row_mask:0xf bank_mask:0xf
  v_smfmac_f32_16x16x64_bf16 v[20:23], v[120:123], v[100:107], v0
  s_add_u32 s26, s36, s23
  ds_read_b128 v[68:71], v4 offset:12288
  v_mov_b32_dpp v85, v117 row_ror:8 row_mask:0xf bank_mask:0xf
  v_smfmac_f32_16x16x64_bf16 v[24:27], v[120:123], v[108:115], v0
  s_add_u32 s36, s36, 8192
  ds_read_b128 v[72:75], v4 offset:13312
  v_mov_b32_dpp v86, v118 row_ror:8 row_mask:0xf bank_mask:0xf
  v_smfmac_f32_16x16x64_bf16 v[16:19], v[116:119], v[224:231], v0
  s_and_b32 s36, s36, 0x7fff
  ds_read_b128 v[76:79], v4 offset:14336
  v_mov_b32_dpp v87, v119 row_ror:8 row_mask:0xf bank_mask:0xf
  v_smfmac_f32_16x16x64_bf16 v[20:23], v[116:119], v[240:247], v0
  s_waitcnt lgkmcnt(3)
  s_barrier
  ds_read_b128 v[100:103], v2 offset:0
  v_smfmac_f32_16x16x64_bf16 v[24:27], v[116:119], a[0:7], v0
  s_mov_b32 m0, s31
  ds_read_b128 v[120:123], v1 offset:0
  v_smfmac_f32_16x16x64_bf16 v[16:19], v[84:87], v[232:239], v0
  buffer_load_dwordx4 v9, s[4:7], s27 offen sc1 lds
  v_smfmac_f32_16x16x64_bf16 v[20:23], v[84:87], v[248:255], v0
  ds_read_b128 v[80:83], v4 offset:15360
  s_mov_b32 m0, s32
  v_smfmac_f32_16x16x64_bf16 v[24:27], v[84:87], a[8:15], v0
  s_waitcnt lgkmcnt(2)
  v_smfmac_f32_16x16x64_bf16 v[16:19], v[100:103], v[128:135], v0
  ds_read_b128 v[92:95], v2 offset:3072
  v_smfmac_f32_16x16x64_bf16 v[20:23], v[100:103], v[144:151], v0
  ds_read_b128 v[96:99], v1 offset:3072
  buffer_load_dwordx4 v9, s[4:7], s27 offen offset:128 sc1 lds
  v_smfmac_f32_16x16x64_bf16 v[24:27], v[100:103], v[68:75], v0
  s_waitcnt vmcnt(2) lgkmcnt(3)
  ds_read_b128 v[116:119], v2 offset:2048
  s_mov_b32 m0, s33
  v_smfmac_f32_16x16x64_bf16 v[16:19], v[120:123], v[136:143], v0
  ds_read_b128 v[124:127], v1 offset:2048
  v_smfmac_f32_16x16x64_bf16 v[20:23], v[120:123], v[152:159], v0
  s_waitcnt lgkmcnt(4)
  ds_read_b128 v[104:107], v2 offset:4096
  v_smfmac_f32_16x16x64_bf16 v[24:27], v[120:123], v[76:83], v0
  s_waitcnt lgkmcnt(4)
  ds_read_b128 v[108:111], v1 offset:4096
  buffer_load_dwordx4 v10, s[4:7], s28 offen sc1 lds
  v_smfmac_f32_16x16x64_bf16 v[16:19], v[92:95], v[160:167], v0
  s_waitcnt lgkmcnt(4)
  ds_read_b128 v[112:115], v2 offset:7168
  s_mov_b32 m0, s34
  v_smfmac_f32_16x16x64_bf16 v[16:19], v[96:99], v[168:175], v0
  s_waitcnt lgkmcnt(4)
  ds_read_b128 v[84:87], v1 offset:7168
  v_smfmac_f32_16x16x64_bf16 v[16:19], v[116:119], v[192:199], v0
  s_waitcnt lgkmcnt(4)
  ds_read_b128 v[88:91], v2 offset:6144
  v_smfmac_f32_16x16x64_bf16 v[16:19], v[124:127], v[200:207], v0
  s_waitcnt lgkmcnt(4)
  ds_read_b128 v[100:103], v1 offset:6144
  buffer_load_dwordx4 v10, s[4:7], s28 offen offset:256 sc1 lds
  v_smfmac_f32_16x16x64_bf16 v[16:19], v[104:107], a[16:23], v0
  s_waitcnt lgkmcnt(4)
  ds_read_b128 v[68:71], v4 offset:16384
  v_smfmac_f32_16x16x64_bf16 v[16:19], v[108:111], a[24:31], v0
  s_waitcnt lgkmcnt(4)
  ds_read_b128 v[72:75], v4 offset:17408
  v_smfmac_f32_16x16x64_bf16 v[16:19], v[112:115], a[64:71], v0
  s_waitcnt lgkmcnt(4)
  ds_read_b128 v[76:79], v4 offset:18432
  v_smfmac_f32_16x16x64_bf16 v[16:19], v[84:87], a[72:79], v0
  s_waitcnt lgkmcnt(4)
  ds_read_b128 v[80:83], v4 offset:19456
  v_smfmac_f32_16x16x64_bf16 v[16:19], v[88:91], a[112:119], v0
  s_waitcnt lgkmcnt(4)
  v_smfmac_f32_16x16x64_bf16 v[16:19], v[100:103], a[120:127], v0
  s_add_u32 s24, s36, 145752064
  s_add_u32 s25, s36, 145756160
  v_smfmac_f32_16x16x64_bf16 v[20:23], v[92:95], v[176:183], v0
  s_add_u32 s35, s36, s23
  v_smfmac_f32_16x16x64_bf16 v[20:23], v[96:99], v[184:191], v0
  s_waitcnt lgkmcnt(2)
  v_smfmac_f32_16x16x64_bf16 v[20:23], v[116:119], v[68:75], v0
  s_waitcnt lgkmcnt(0)
  ds_read_b128 v[68:71], v4 offset:20480
  v_mul_f32 v16, s18, v16
  v_smfmac_f32_16x16x64_bf16 v[20:23], v[124:127], v[76:83], v0
  ds_read_b128 v[72:75], v4 offset:21504
  v_mul_f32 v17, s18, v17
  v_smfmac_f32_16x16x64_bf16 v[20:23], v[104:107], a[32:39], v0
  ds_read_b128 v[76:79], v4 offset:22528
  v_mul_f32 v18, s18, v18
  v_smfmac_f32_16x16x64_bf16 v[20:23], v[108:111], a[40:47], v0
  ds_read_b128 v[80:83], v4 offset:23552
  v_mul_f32 v19, s18, v19
  v_smfmac_f32_16x16x64_bf16 v[20:23], v[112:115], a[80:87], v0
  v_cvt_pk_bf16_f32 v120, v16, v17
  v_smfmac_f32_16x16x64_bf16 v[20:23], v[84:87], a[88:95], v0
  v_cvt_pk_bf16_f32 v121, v18, v19
  v_smfmac_f32_16x16x64_bf16 v[20:23], v[88:91], a[128:135], v0
  ds_write_b64 v5, v[120:121] offset:24576
  v_smfmac_f32_16x16x64_bf16 v[20:23], v[100:103], a[136:143], v0
  s_waitcnt lgkmcnt(3)
  v_smfmac_f32_16x16x64_bf16 v[24:27], v[92:95], v[68:75], v0
  s_waitcnt lgkmcnt(1)
  v_mov_b64 v[92:93], 0
  v_smfmac_f32_16x16x64_bf16 v[24:27], v[96:99], v[76:83], v0
  s_nop 1
  v_cvt_pk_bf16_f32 v122, v20, v21
  v_cvt_pk_bf16_f32 v123, v22, v23
  v_smfmac_f32_16x16x64_bf16 v[24:27], v[116:119], v[208:215], v0
  ds_write_b64 v5, v[122:123] offset:26880
  v_mov_b64 v[94:95], 0
  v_smfmac_f32_16x16x64_bf16 v[24:27], v[124:127], v[216:223], v0
  s_waitcnt lgkmcnt(1)
  s_barrier
  ds_read_b64_tr_b16 v[68:69], v6 offset:24576
  v_smfmac_f32_16x16x64_bf16 v[24:27], v[104:107], a[48:55], v0
  s_add_u32 s27, s27, 8192
  ds_read_b64_tr_b16 v[70:71], v6 offset:24640
  ds_read_b64_tr_b16 v[72:73], v6 offset:24832
  v_smfmac_f32_16x16x64_bf16 v[24:27], v[108:111], a[56:63], v0
  s_add_u32 s28, s28, 8192
  ds_read_b64_tr_b16 v[74:75], v6 offset:24896
  ds_read_b64_tr_b16 v[76:77], v6 offset:25088
  v_smfmac_f32_16x16x64_bf16 v[24:27], v[112:115], a[96:103], v0
  s_nop 0
  ds_read_b64_tr_b16 v[78:79], v6 offset:25152
  ds_read_b64_tr_b16 v[80:81], v6 offset:25344
  v_smfmac_f32_16x16x64_bf16 v[24:27], v[84:87], a[104:111], v0
  ds_read_b64_tr_b16 v[82:83], v6 offset:25408
  v_mov_b64 v[96:97], 0
  v_smfmac_f32_16x16x64_bf16 v[24:27], v[88:91], a[144:151], v0
  s_waitcnt lgkmcnt(8)
  s_barrier
  ds_read_b64_tr_b16 v[116:117], v6 offset:26880
  v_smfmac_f32_16x16x64_bf16 v[24:27], v[100:103], a[152:159], v0
  s_waitcnt lgkmcnt(7)
  ds_read_b64_tr_b16 v[118:119], v6 offset:26944
  v_mfma_f32_16x16x32_bf16 v[16:19], v[36:39], v[68:71], 0
  s_waitcnt lgkmcnt(6)
  ds_read_b64_tr_b16 v[124:125], v6 offset:27136
  ds_read_b64_tr_b16 v[126:127], v6 offset:27200
  v_mfma_f32_16x16x32_bf16 v[16:19], v[40:43], v[72:75], v[16:19]
  s_waitcnt lgkmcnt(6)
  ds_read_b64_tr_b16 v[104:105], v6 offset:27392
  ds_read_b64_tr_b16 v[106:107], v6 offset:27456
  v_mfma_f32_16x16x32_bf16 v[16:19], v[44:47], v[76:79], v[16:19]
  s_waitcnt lgkmcnt(6)
  ds_read_b64_tr_b16 v[108:109], v6 offset:27648
  ds_read_b64_tr_b16 v[110:111], v6 offset:27712
  v_mfma_f32_16x16x32_bf16 v[16:19], v[48:51], v[80:83], v[16:19]
  s_waitcnt lgkmcnt(6)
  v_cvt_pk_bf16_f32 v120, v24, v25
  v_cvt_pk_bf16_f32 v121, v26, v27
  v_mfma_f32_16x16x32_bf16 v[112:115], v[116:119], v[68:71], 0
  s_waitcnt lgkmcnt(4)
  v_mov_b64 v[98:99], 0
  v_mfma_f32_16x16x32_bf16 v[112:115], v[124:127], v[72:75], v[112:115]
  s_waitcnt lgkmcnt(2)
  buffer_store_dwordx4 v[120:123], v2, s[4:7], s29 offen offset:1024 sc1
  v_mov_b64 v[36:37], 0
  v_exp_f32 v100, v16
  v_mfma_f32_16x16x32_bf16 v[112:115], v[104:107], v[76:79], v[112:115]
  s_waitcnt lgkmcnt(0)
  v_exp_f32 v101, v17
  v_mfma_f32_16x16x32_bf16 v[112:115], v[108:111], v[80:83], v[112:115]
  v_exp_f32 v102, v18
  v_mfma_f32_16x16x32_bf16 v[20:23], v[52:55], v[68:71], 0
  v_exp_f32 v103, v19
  v_mfma_f32_16x16x32_bf16 v[20:23], v[56:59], v[72:75], v[20:23]
  v_cvt_pk_bf16_f32 v44, v100, v101
  v_cvt_pk_bf16_f32 v45, v102, v103
  v_mfma_f32_16x16x32_bf16 v[20:23], v[60:63], v[76:79], v[20:23]
  s_add_u32 s29, s29, 131072
  v_exp_f32 v100, v112
  v_mfma_f32_16x16x32_bf16 v[20:23], v[64:67], v[80:83], v[20:23]
  v_exp_f32 v101, v113
  v_exp_f32 v102, v114
  v_exp_f32 v103, v115
  v_cvt_pk_bf16_f32 v84, v100, v101
  v_cvt_pk_bf16_f32 v85, v102, v103
  v_cndmask_b32 v48, v84, 0, s[16:17]
  v_cndmask_b32 v49, v85, 0, s[16:17]
  v_cndmask_b32 v50, 0, v84, s[16:17]
  v_cndmask_b32 v51, 0, v85, s[16:17]
  v_exp_f32 v100, v20
  v_mfma_f32_16x16x16_bf16 v[88:91], v[12:13], v[48:49], 0
  v_exp_f32 v101, v21
  v_mfma_f32_16x16x16_bf16 v[24:27], v[120:121], v[48:49], 0
  v_exp_f32 v102, v22
  v_mfma_f32_16x16x16_bf16 v[116:119], v[120:121], v[50:51], 0
  v_exp_f32 v103, v23
  v_cvt_pk_bf16_f32 v46, v100, v101
  v_cvt_pk_bf16_f32 v47, v102, v103
  v_mov_b64 v[38:39], 0
  s_nop 0
  v_mfma_f32_16x16x32_bf16 v[88:91], v[12:15], v[44:47], v[88:91]
  v_mov_b64 v[40:41], 0
  v_mov_b64 v[42:43], 0
  v_mfma_f32_16x16x32_bf16 v[24:27], v[28:31], v[44:47], v[24:27]
  ds_read_b128 v[52:55], v4 offset:24576
  ds_read_b128 v[56:59], v4 offset:25600
  v_mfma_f32_16x16x32_bf16 v[116:119], v[32:35], v[44:47], v[116:119]
  s_nop 1
T_back_41:
  v_rcp_f32 v89, v88
  v_subrev_u32 v100, s54, v88
  v_cmp_le_u32 vcc, s96, v100
  v_mul_f32 v24, v89, v24
  v_mul_f32 v25, v89, v25
  v_cvt_pk_bf16_f32 v124, v24, v25
  v_pk_mul_f32 v[26:27], v[26:27], v[88:89] op_sel:[0,1] op_sel_hi:[1,1]
  v_pk_mul_f32 v[116:117], v[116:117], v[88:89] op_sel:[0,1] op_sel_hi:[1,1]
  v_pk_mul_f32 v[118:119], v[118:119], v[88:89] op_sel:[0,1] op_sel_hi:[1,1]
  v_cvt_pk_bf16_f32 v125, v26, v27
  v_cvt_pk_bf16_f32 v126, v116, v117
  v_cvt_pk_bf16_f32 v127, v118, v119
  ds_write_b128 v11, v[124:127] offset:29696
  s_cbranch_vccnz T_slow_40
  v_smfmac_f32_16x16x64_bf16 v[92:95], v[124:127], a[160:167], v0
  s_mov_b32 s96, s55
  v_smfmac_f32_16x16x64_bf16 v[96:99], v[124:127], a[168:175], v0
  v_smfmac_f32_16x16x64_bf16 v[36:39], v[124:127], a[176:183], v0
  s_waitcnt lgkmcnt(0)
  s_barrier
  ds_read_b128 v[104:107], v11 offset:29184
  ds_read_b128 v[108:111], v11 offset:30720
  ds_read_b128 v[68:71], v11 offset:30208
  v_smfmac_f32_16x16x64_bf16 v[40:43], v[124:127], a[184:191], v0
  s_waitcnt lgkmcnt(2)
  v_smfmac_f32_16x16x64_bf16 v[92:95], v[104:107], a[192:199], v0
  s_waitcnt lgkmcnt(1)
  ds_read_b128 v[76:79], v4 offset:28672
  v_smfmac_f32_16x16x64_bf16 v[92:95], v[108:111], a[224:231], v0
  s_waitcnt lgkmcnt(1)
  ds_read_b128 v[80:83], v4 offset:29696
  v_smfmac_f32_16x16x64_bf16 v[92:95], v[68:71], a[240:247], v0
  ds_read_b128 v[60:63], v4 offset:26624
  v_smfmac_f32_16x16x64_bf16 v[96:99], v[104:107], a[200:207], v0
  ds_read_b128 v[64:67], v4 offset:27648
  v_smfmac_f32_16x16x64_bf16 v[96:99], v[108:111], a[232:239], v0
  ds_read_b128 v[28:31], v4 offset:30720
  s_nop 0
  v_cvt_pk_bf16_f32 v16, v92, v93
  v_cvt_pk_bf16_f32 v17, v94, v95
  v_bfi_b32 v16, 1, s57, v16
  v_smfmac_f32_16x16x64_bf16 v[96:99], v[68:71], a[248:255], v0
  buffer_store_dwordx2 v[16:17], v7, s[4:7], s20 offen offset:0
  v_smfmac_f32_16x16x64_bf16 v[36:39], v[104:107], a[208:215], v0
  ds_read_b128 v[32:35], v4 offset:31744
  v_smfmac_f32_16x16x64_bf16 v[36:39], v[108:111], v[52:59], v0
  s_waitcnt lgkmcnt(4)
  s_nop 0
  v_cvt_pk_bf16_f32 v18, v96, v97
  v_cvt_pk_bf16_f32 v19, v98, v99
  v_bfi_b32 v18, 1, s57, v18
  v_smfmac_f32_16x16x64_bf16 v[36:39], v[68:71], v[76:83], v0
  buffer_store_dwordx2 v[18:19], v7, s[4:7], s20 offen offset:64
  v_smfmac_f32_16x16x64_bf16 v[40:43], v[104:107], a[216:223], v0
  s_waitcnt lgkmcnt(2)
  ds_read_b128 v[116:119], v2 offset:31232
  v_smfmac_f32_16x16x64_bf16 v[40:43], v[108:111], v[60:67], v0
  s_waitcnt lgkmcnt(1)
  s_nop 0
  v_cvt_pk_bf16_f32 v20, v36, v37
  v_cvt_pk_bf16_f32 v21, v38, v39
  v_bfi_b32 v20, 1, s57, v20
  v_smfmac_f32_16x16x64_bf16 v[40:43], v[68:71], v[28:35], v0
  buffer_store_dwordx2 v[20:21], v7, s[4:7], s21 offen offset:0
  s_nop 6
  v_cvt_pk_bf16_f32 v22, v40, v41
  v_cvt_pk_bf16_f32 v23, v42, v43
  v_bfi_b32 v22, 1, s57, v22
  buffer_store_dwordx2 v[22:23], v7, s[4:7], s21 offen offset:64
  ds_read_b128 v[68:71], v4 offset:0
  ds_read_b128 v[72:75], v4 offset:1024
  ds_read_b128 v[76:79], v4 offset:4096
  ds_read_b128 v[80:83], v4 offset:5120
  ds_read_b128 v[84:87], v4 offset:8192
  ds_read_b128 v[88:91], v4 offset:9216
  ds_read_b128 v[92:95], v4 offset:2048
  ds_read_b128 v[96:99], v4 offset:3072
  ds_read_b128 v[100:103], v4 offset:6144
  ds_read_b128 v[104:107], v4 offset:7168
  ds_read_b128 v[108:111], v4 offset:10240
  ds_read_b128 v[112:115], v4 offset:11264
  v_mov_b64 v[16:17], 0
  v_mov_b64 v[18:19], 0
  v_mov_b64 v[20:21], 0
  v_mov_b64 v[22:23], 0
  v_mov_b64 v[24:25], 0
  v_mov_b64 v[26:27], 0
  s_mov_b32 s19, 0
  v_mov_b32 v49, -1
  ds_read_b64 v[44:45], v2 offset:32256
  s_waitcnt lgkmcnt(0)
  v_readfirstlane_b32 s38, v44
  v_readfirstlane_b32 s37, v45
  s_nop 0
  s_lshl_b32 s38, s38, 1
  s_lshl1_add_u32 s37, s37, 1
  s_min_u32 s38, s38, s37
  s_cmp_ge_u32 s38, 64
  s_cselect_b32 s38, 100, s38
  s_sub_u32 s38, s38, 1
  s_max_i32 s30, s30, s38
  s_waitcnt vmcnt(0)
  buffer_load_dwordx4 v[52:55], v2, s[4:7], s22 offen offset:0 sc1
  buffer_load_dwordx4 v[56:59], v2, s[4:7], s22 offen offset:1024 sc1
  buffer_load_dwordx4 v[60:63], v2, s[4:7], s22 offen offset:2048 sc1
  buffer_load_dwordx4 v[64:67], v2, s[4:7], s22 offen offset:3072 sc1
  s_waitcnt lgkmcnt(12)
  s_waitcnt vmcnt(3)
  v_mfma_f32_16x16x32_bf16 v[120:123], v[116:119], v[52:55], 0
  v_xor_b32 v48, s57, v52
  v_bitop3_b32 v48, v48, v54, s57 bitop3:0xf6
  s_waitcnt vmcnt(2)
  v_mfma_f32_16x16x32_bf16 v[120:123], v[116:119], v[56:59], v[120:123]
  v_bitop3_b32 v48, v48, v56, s57 bitop3:0xf6
  v_bitop3_b32 v48, v48, v58, s57 bitop3:0xf6
  s_waitcnt vmcnt(1)
  v_mfma_f32_16x16x32_bf16 v[120:123], v[116:119], v[60:63], v[120:123]
  v_bitop3_b32 v48, v48, v60, s57 bitop3:0xf6
  v_bitop3_b32 v48, v48, v62, s57 bitop3:0xf6
  s_waitcnt vmcnt(0)
  v_mfma_f32_16x16x32_bf16 v[120:123], v[116:119], v[64:67], v[120:123]
  v_bitop3_b32 v48, v48, v64, s57 bitop3:0xf6
  v_bitop3_b32 v48, v48, v66, s57 bitop3:0xf6
  v_and_b32 v48, 1, v48
  v_cmp_ne_u32 vcc, 0, v48
  s_cbranch_vccnz T_p1re_43
T_p1ok_44:
  s_nop 2
  v_add_f32_dpp v120, v120, v120 row_ror:8 row_mask:0xf bank_mask:0xf
  v_add_f32_dpp v121, v121, v121 row_ror:8 row_mask:0xf bank_mask:0xf
  v_cvt_pk_bf16_f32 v48, v120, v121
  buffer_store_dword v48, v8, s[4:7], s35 offen
  buffer_store_dword v49, v8, s[4:7], s26 offen
  s_barrier
  ds_read_b128 v[28:31], v2 offset:17408
  ds_read_b128 v[32:35], v2 offset:21504
  ds_read_b128 v[36:39], v2 offset:8192
  ds_read_b128 v[40:43], v2 offset:9216
  ds_read_b128 v[44:47], v2 offset:10240
  ds_read_b128 v[48:51], v2 offset:11264
  buffer_load_dwordx4 v[124:127], v2, s[4:7], s24 offen offset:1024 sc1
  buffer_load_dwordx4 v[116:119], v2, s[4:7], s25 offen offset:1024 sc1
  ds_read_b128 v[52:55], v2 offset:12288
  ds_read_b128 v[56:59], v2 offset:13312
  ds_read_b128 v[60:63], v2 offset:14336
  ds_read_b128 v[64:67], v2 offset:15360
  buffer_load_dwordx4 v[124:127], v2, s[4:7], s24 offen offset:1024 sc1
  buffer_load_dwordx4 v[116:119], v2, s[4:7], s25 offen offset:1024 sc1
  s_add_u32 s14, s14, 1
  s_cmp_ge_i32 s14, s30
  s_cbranch_scc1 T_kvw_37
T_kvb_38:
  s_mov_b32 s19, 0
  s_cmp_lg_u32 s14, 63
  s_cbranch_scc1 T_loop_33
  s_branch T_last_39
T_p1re_43:
  s_mov_b64 exec, vcc
  buffer_load_dwordx4 v[52:55], v2, s[4:7], s22 offen offset:0 sc1
  buffer_load_dwordx4 v[56:59], v2, s[4:7], s22 offen offset:1024 sc1
  buffer_load_dwordx4 v[60:63], v2, s[4:7], s22 offen offset:2048 sc1
  buffer_load_dwordx4 v[64:67], v2, s[4:7], s22 offen offset:3072 sc1
  s_mov_b64 exec, -1
  s_add_u32 s19, s19, 1
  s_cmp_gt_u32 s19, 32768
  s_cbranch_scc1 M_exit
  s_waitcnt vmcnt(3)
  v_mfma_f32_16x16x32_bf16 v[120:123], v[116:119], v[52:55], 0
  v_xor_b32 v48, s57, v52
  v_bitop3_b32 v48, v48, v54, s57 bitop3:0xf6
  s_waitcnt vmcnt(2)
  v_mfma_f32_16x16x32_bf16 v[120:123], v[116:119], v[56:59], v[120:123]
  v_bitop3_b32 v48, v48, v56, s57 bitop3:0xf6
  v_bitop3_b32 v48, v48, v58, s57 bitop3:0xf6
  s_waitcnt vmcnt(1)
  v_mfma_f32_16x16x32_bf16 v[120:123], v[116:119], v[60:63], v[120:123]
  v_bitop3_b32 v48, v48, v60, s57 bitop3:0xf6
  v_bitop3_b32 v48, v48, v62, s57 bitop3:0xf6
  s_waitcnt vmcnt(0)
  v_mfma_f32_16x16x32_bf16 v[120:123], v[116:119], v[64:67], v[120:123]
  v_bitop3_b32 v48, v48, v64, s57 bitop3:0xf6
  v_bitop3_b32 v48, v48, v66, s57 bitop3:0xf6
  v_and_b32 v48, 1, v48
  v_cmp_ne_u32 vcc, 0, v48
  s_cbranch_vccnz T_p1re_43
  s_branch T_p1ok_44
T_kvw_37:
  s_mov_b32 s19, 0
  s_branch T_kvok_46
T_kv_45:
  s_sleep 4
  s_add_u32 s19, s19, 1
  s_cmp_gt_u32 s19, 32768
  s_cbranch_scc1 M_exit
T_kvok_46:
  s_add_u32 s39, s99, 128
  s_mov_b32 s38, 0
  s_mov_b32 s37, 0
  s_atomic_or s38, s[58:59], s99 glc
  s_atomic_or s37, s[58:59], s39 glc
  s_waitcnt lgkmcnt(0)
  s_lshl_b32 s38, s38, 1
  s_lshl1_add_u32 s37, s37, 1
  s_min_u32 s38, s38, s37
  s_cmp_ge_u32 s38, 64
  s_cselect_b32 s38, 100, s38
  s_sub_u32 s38, s38, 1
  s_max_i32 s30, s30, s38
  s_cmp_ge_i32 s14, s30
  s_cbranch_scc1 T_kv_45
  s_branch T_kvb_38
T_slow_40:
  s_nop 7
  v_max3_f32 v100, v16, v17, v18
  v_max3_f32 v100, v100, v19, v20
  v_max3_f32 v100, v100, v21, v22
  v_max3_f32 v100, v100, v23, v112
  v_max3_f32 v100, v100, v113, v114
  v_max_f32 v100, v100, v115
  v_mov_b32 v101, v100
  s_nop 1
  v_permlane32_swap_b32 v100, v101
  s_nop 1
  v_max_f32 v100, v100, v101
  v_mov_b32 v101, v100
  s_nop 1
  v_permlane16_swap_b32 v100, v101
  s_nop 1
  v_max_f32 v100, v100, v101
  v_sub_f32 v16, v16, v100
  v_sub_f32 v17, v17, v100
  v_sub_f32 v18, v18, v100
  v_sub_f32 v19, v19, v100
  v_exp_f32 v16, v16
  v_exp_f32 v17, v17
  v_exp_f32 v18, v18
  v_exp_f32 v19, v19
  v_sub_f32 v20, v20, v100
  v_sub_f32 v21, v21, v100
  v_sub_f32 v22, v22, v100
  v_sub_f32 v23, v23, v100
  v_exp_f32 v20, v20
  v_exp_f32 v21, v21
  v_exp_f32 v22, v22
  v_exp_f32 v23, v23
  v_sub_f32 v112, v112, v100
  v_sub_f32 v113, v113, v100
  v_sub_f32 v114, v114, v100
  v_sub_f32 v115, v115, v100
  v_exp_f32 v112, v112
  v_exp_f32 v113, v113
  v_exp_f32 v114, v114
  v_exp_f32 v115, v115
  s_nop 0
  v_cvt_pk_bf16_f32 v44, v16, v17
  v_cvt_pk_bf16_f32 v45, v18, v19
  v_cvt_pk_bf16_f32 v46, v20, v21
  v_cvt_pk_bf16_f32 v47, v22, v23
  v_cvt_pk_bf16_f32 v84, v112, v113
  v_cvt_pk_bf16_f32 v85, v114, v115
  v_cndmask_b32 v48, v84, 0, s[16:17]
  v_cndmask_b32 v49, v85, 0, s[16:17]
  v_cndmask_b32 v50, 0, v84, s[16:17]
  v_cndmask_b32 v51, 0, v85, s[16:17]
  s_nop 1
  v_mfma_f32_16x16x16_bf16 v[88:91], v[12:13], v[48:49], 0
  v_mfma_f32_16x16x16_bf16 v[24:27], v[120:121], v[48:49], 0
  v_mfma_f32_16x16x16_bf16 v[116:119], v[120:121], v[50:51], 0
  v_mfma_f32_16x16x32_bf16 v[88:91], v[12:15], v[44:47], v[88:91]
  v_mfma_f32_16x16x32_bf16 v[24:27], v[28:31], v[44:47], v[24:27]
  v_mfma_f32_16x16x32_bf16 v[116:119], v[32:35], v[44:47], v[116:119]
  s_nop 7
  s_nop 1
  s_mov_b32 s96, -1
  s_branch T_back_41
.p2align 6
T_retry_47:
  s_mov_b64 exec, vcc
  buffer_load_dwordx4 v[124:127], v2, s[4:7], s24 offen offset:1024 sc1
  buffer_load_dwordx4 v[116:119], v2, s[4:7], s25 offen offset:1024 sc1
  s_mov_b64 exec, -1
  s_add_u32 s19, s19, 1
  s_cmp_gt_u32 s19, 32768
  s_cbranch_scc1 M_exit
T_last_39:
  s_waitcnt vmcnt(3) lgkmcnt(0)
  v_max3_u32 v123, v124, v125, v126
  v_max_u32 v123, v123, v127
  v_mov_b32_dpp v120, v124 row_ror:8 row_mask:0xf bank_mask:0xf
  v_mov_b32_dpp v121, v125 row_ror:8 row_mask:0xf bank_mask:0xf
  s_waitcnt vmcnt(2)
  v_max3_u32 v123, v123, v116, v117
  v_max3_u32 v123, v123, v118, v119
  v_cmp_eq_u32 vcc, -1, v123
  s_cbranch_vccnz T_retry_47
  v_smfmac_f32_16x16x64_bf16 v[20:23], v[124:127], v[76:83], v0
  ds_write_b128 v2, v[124:127] offset:1024
  v_mov_b32_dpp v122, v126 row_ror:8 row_mask:0xf bank_mask:0xf
  v_mov_b32_dpp v123, v127 row_ror:8 row_mask:0xf bank_mask:0xf
  v_smfmac_f32_16x16x64_bf16 v[24:27], v[124:127], v[84:91], v0
  ds_write_b128 v2, v[116:119] offset:5120
  v_mov_b32_dpp v84, v116 row_ror:8 row_mask:0xf bank_mask:0xf
  v_smfmac_f32_16x16x64_bf16 v[20:23], v[120:123], v[100:107], v0
  ds_read_b128 v[68:71], v4 offset:12288
  v_mov_b32_dpp v85, v117 row_ror:8 row_mask:0xf bank_mask:0xf
  v_smfmac_f32_16x16x64_bf16 v[24:27], v[120:123], v[108:115], v0
  ds_read_b128 v[72:75], v4 offset:13312
  v_mov_b32_dpp v86, v118 row_ror:8 row_mask:0xf bank_mask:0xf
  ds_read_b128 v[76:79], v4 offset:14336
  v_mov_b32_dpp v87, v119 row_ror:8 row_mask:0xf bank_mask:0xf
  v_smfmac_f32_16x16x64_bf16 v[20:23], v[116:119], v[240:247], v0
  s_waitcnt lgkmcnt(3)
  s_barrier
  ds_read_b128 v[100:103], v2 offset:0
  v_smfmac_f32_16x16x64_bf16 v[24:27], v[116:119], a[0:7], v0
  ds_read_b128 v[120:123], v1 offset:0
  v_smfmac_f32_16x16x64_bf16 v[20:23], v[84:87], v[248:255], v0
  ds_read_b128 v[80:83], v4 offset:15360
  v_smfmac_f32_16x16x64_bf16 v[24:27], v[84:87], a[8:15], v0
  s_waitcnt lgkmcnt(2)
  ds_read_b128 v[92:95], v2 offset:3072
  v_smfmac_f32_16x16x64_bf16 v[20:23], v[100:103], v[144:151], v0
  ds_read_b128 v[96:99], v1 offset:3072
  v_smfmac_f32_16x16x64_bf16 v[24:27], v[100:103], v[68:75], v0
  s_waitcnt vmcnt(0) lgkmcnt(3)
  ds_read_b128 v[116:119], v2 offset:2048
  ds_read_b128 v[124:127], v1 offset:2048
  v_smfmac_f32_16x16x64_bf16 v[20:23], v[120:123], v[152:159], v0
  s_waitcnt lgkmcnt(4)
  ds_read_b128 v[104:107], v2 offset:4096
  v_smfmac_f32_16x16x64_bf16 v[24:27], v[120:123], v[76:83], v0
  s_waitcnt lgkmcnt(4)
  ds_read_b128 v[108:111], v1 offset:4096
  ds_read_b128 v[112:115], v2 offset:7168
  ds_read_b128 v[84:87], v1 offset:7168
  ds_read_b128 v[88:91], v2 offset:6144
  ds_read_b128 v[100:103], v1 offset:6144
  ds_read_b128 v[68:71], v4 offset:16384
  ds_read_b128 v[72:75], v4 offset:17408
  ds_read_b128 v[76:79], v4 offset:18432
  ds_read_b128 v[80:83], v4 offset:19456
  v_smfmac_f32_16x16x64_bf16 v[20:23], v[92:95], v[176:183], v0
  s_waitcnt lgkmcnt(12)
  v_smfmac_f32_16x16x64_bf16 v[20:23], v[96:99], v[184:191], v0
  s_waitcnt lgkmcnt(2)
  v_smfmac_f32_16x16x64_bf16 v[20:23], v[116:119], v[68:75], v0
  s_waitcnt lgkmcnt(0)
  ds_read_b128 v[68:71], v4 offset:20480
  v_smfmac_f32_16x16x64_bf16 v[20:23], v[124:127], v[76:83], v0
  ds_read_b128 v[72:75], v4 offset:21504
  v_smfmac_f32_16x16x64_bf16 v[20:23], v[104:107], a[32:39], v0
  ds_read_b128 v[76:79], v4 offset:22528
  v_smfmac_f32_16x16x64_bf16 v[20:23], v[108:111], a[40:47], v0
  ds_read_b128 v[80:83], v4 offset:23552
  v_smfmac_f32_16x16x64_bf16 v[20:23], v[112:115], a[80:87], v0
  v_smfmac_f32_16x16x64_bf16 v[20:23], v[84:87], a[88:95], v0
  v_smfmac_f32_16x16x64_bf16 v[20:23], v[88:91], a[128:135], v0
  v_smfmac_f32_16x16x64_bf16 v[20:23], v[100:103], a[136:143], v0
  s_waitcnt lgkmcnt(2)
  v_smfmac_f32_16x16x64_bf16 v[24:27], v[92:95], v[68:75], v0
  s_waitcnt lgkmcnt(0)
  v_smfmac_f32_16x16x64_bf16 v[24:27], v[96:99], v[76:83], v0
  v_smfmac_f32_16x16x64_bf16 v[24:27], v[116:119], v[208:215], v0
  v_smfmac_f32_16x16x64_bf16 v[24:27], v[124:127], v[216:223], v0
  v_smfmac_f32_16x16x64_bf16 v[24:27], v[104:107], a[48:55], v0
  v_smfmac_f32_16x16x64_bf16 v[24:27], v[108:111], a[56:63], v0
  v_smfmac_f32_16x16x64_bf16 v[24:27], v[112:115], a[96:103], v0
  v_smfmac_f32_16x16x64_bf16 v[24:27], v[84:87], a[104:111], v0
  v_smfmac_f32_16x16x64_bf16 v[24:27], v[88:91], a[144:151], v0
  v_smfmac_f32_16x16x64_bf16 v[24:27], v[100:103], a[152:159], v0
  v_cvt_pk_bf16_f32 v122, v20, v21
  v_cvt_pk_bf16_f32 v123, v22, v23
  s_nop 5
  v_cvt_pk_bf16_f32 v120, v24, v25
  v_cvt_pk_bf16_f32 v121, v26, v27
  buffer_store_dwordx4 v[120:123], v2, s[4:7], s29 offen offset:1024 sc1
  s_branch M_tdone
T_w_12:
  s_mov_b32 s19, 0
  s_add_u32 s14, s14, 1
  s_and_b32 s57, s14, 1
  v_mov_b64 v[16:17], 0
  v_mov_b64 v[18:19], 0
  v_mov_b64 v[20:21], 0
  v_mov_b64 v[22:23], 0
  v_mov_b64 v[24:25], 0
  v_mov_b64 v[26:27], 0
  buffer_load_dwordx4 v[124:127], v2, s[4:7], s24 offen offset:2048 sc1
  buffer_load_dwordx4 v[116:119], v2, s[4:7], s25 offen offset:2048 sc1
  buffer_load_dwordx4 v[124:127], v2, s[4:7], s24 offen offset:2048 sc1
  buffer_load_dwordx4 v[116:119], v2, s[4:7], s25 offen offset:2048 sc1
  s_branch T_loop_52
.p2align 6
T_retry_53:
  s_mov_b64 exec, vcc
  buffer_load_dwordx4 v[124:127], v2, s[4:7], s24 offen offset:2048 sc1
  buffer_load_dwordx4 v[116:119], v2, s[4:7], s25 offen offset:2048 sc1
  s_mov_b64 exec, -1
  s_add_u32 s19, s19, 1
  s_cmp_gt_u32 s19, 32768
  s_cbranch_scc1 M_exit
  s_nop 0
  v_mov_b64 v[16:17], 0
  v_mov_b64 v[18:19], 0
T_loop_52:
  s_waitcnt vmcnt(3) lgkmcnt(0)
  v_max3_u32 v123, v124, v125, v126
  v_max_u32 v123, v123, v127
  v_mov_b32_dpp v120, v124 row_ror:8 row_mask:0xf bank_mask:0xf
  v_mov_b32_dpp v121, v125 row_ror:8 row_mask:0xf bank_mask:0xf
  s_waitcnt vmcnt(2)
  v_max3_u32 v123, v123, v116, v117
  v_max3_u32 v123, v123, v118, v119
  v_cmp_eq_u32 vcc, -1, v123
  v_smfmac_f32_16x16x64_bf16 v[16:19], v[124:127], v[68:75], v0
  s_cbranch_vccnz T_retry_53
  ds_write_b128 v2, v[124:127] offset:2048
  v_mov_b32_dpp v122, v126 row_ror:8 row_mask:0xf bank_mask:0xf
  v_smfmac_f32_16x16x64_bf16 v[20:23], v[124:127], v[76:83], v0
  s_and_b32 s57, s14, 1
  v_mov_b32_dpp v123, v127 row_ror:8 row_mask:0xf bank_mask:0xf
  v_smfmac_f32_16x16x64_bf16 v[24:27], v[124:127], v[84:91], v0
  s_and_b32 s36, s14, 3
  ds_write_b128 v2, v[116:119] offset:6144
  v_smfmac_f32_16x16x64_bf16 v[16:19], v[120:123], v[92:99], v0
  s_lshl_b32 s36, s36, 13
  v_mov_b32_dpp v84, v116 row_ror:8 row_mask:0xf bank_mask:0xf
  v_smfmac_f32_16x16x64_bf16 v[20:23], v[120:123], v[100:107], v0
  s_add_u32 s26, s36, s23
  ds_read_b128 v[68:71], v4 offset:12288
  v_mov_b32_dpp v85, v117 row_ror:8 row_mask:0xf bank_mask:0xf
  v_smfmac_f32_16x16x64_bf16 v[24:27], v[120:123], v[108:115], v0
  s_add_u32 s36, s36, 8192
  ds_read_b128 v[72:75], v4 offset:13312
  v_mov_b32_dpp v86, v118 row_ror:8 row_mask:0xf bank_mask:0xf
  v_smfmac_f32_16x16x64_bf16 v[16:19], v[116:119], v[224:231], v0
  s_and_b32 s36, s36, 0x7fff
  ds_read_b128 v[76:79], v4 offset:14336
  v_mov_b32_dpp v87, v119 row_ror:8 row_mask:0xf bank_mask:0xf
  v_smfmac_f32_16x16x64_bf16 v[20:23], v[116:119], v[240:247], v0
  s_waitcnt lgkmcnt(3)
  s_barrier
  ds_read_b128 v[100:103], v2 offset:3072
  v_smfmac_f32_16x16x64_bf16 v[24:27], v[116:119], a[0:7], v0
  s_mov_b32 m0, s31
  ds_read_b128 v[120:123], v1 offset:3072
  v_smfmac_f32_16x16x64_bf16 v[16:19], v[84:87], v[232:239], v0
  v_smfmac_f32_16x16x64_bf16 v[20:23], v[84:87], v[248:255], v0
  ds_read_b128 v[80:83], v4 offset:15360
  buffer_load_dwordx4 v9, s[4:7], s27 offen sc1 lds
  v_smfmac_f32_16x16x64_bf16 v[24:27], v[84:87], a[8:15], v0
  s_waitcnt lgkmcnt(2)
  s_mov_b32 m0, s32
  v_smfmac_f32_16x16x64_bf16 v[16:19], v[100:103], v[128:135], v0
  ds_read_b128 v[92:95], v2 offset:0
  v_smfmac_f32_16x16x64_bf16 v[20:23], v[100:103], v[144:151], v0
  ds_read_b128 v[96:99], v1 offset:0
  v_smfmac_f32_16x16x64_bf16 v[24:27], v[100:103], v[68:75], v0
  s_waitcnt vmcnt(1) lgkmcnt(3)
  ds_read_b128 v[116:119], v2 offset:1024
  buffer_load_dwordx4 v9, s[4:7], s27 offen offset:128 sc1 lds
  v_smfmac_f32_16x16x64_bf16 v[16:19], v[120:123], v[136:143], v0
  ds_read_b128 v[124:127], v1 offset:1024
  s_mov_b32 m0, s33
  v_smfmac_f32_16x16x64_bf16 v[20:23], v[120:123], v[152:159], v0
  s_waitcnt lgkmcnt(4)
  ds_read_b128 v[104:107], v2 offset:7168
  v_smfmac_f32_16x16x64_bf16 v[24:27], v[120:123], v[76:83], v0
  s_waitcnt lgkmcnt(4)
  ds_read_b128 v[108:111], v1 offset:7168
  v_smfmac_f32_16x16x64_bf16 v[16:19], v[92:95], v[160:167], v0
  s_waitcnt lgkmcnt(4)
  ds_read_b128 v[112:115], v2 offset:4096
  v_mov_b32 v122, s98
  buffer_load_dwordx4 v10, s[4:7], s28 offen sc1 lds
  v_smfmac_f32_16x16x64_bf16 v[16:19], v[96:99], v[168:175], v0
  s_waitcnt lgkmcnt(4)
  ds_read_b128 v[84:87], v1 offset:4096
  s_mov_b32 m0, s34
  v_smfmac_f32_16x16x64_bf16 v[16:19], v[116:119], v[192:199], v0
  s_waitcnt lgkmcnt(4)
  ds_read_b128 v[88:91], v2 offset:5120
  v_smfmac_f32_16x16x64_bf16 v[16:19], v[124:127], v[200:207], v0
  s_waitcnt lgkmcnt(4)
  ds_read_b128 v[100:103], v1 offset:5120
  v_smfmac_f32_16x16x64_bf16 v[16:19], v[104:107], a[16:23], v0
  s_waitcnt lgkmcnt(4)
  ds_read_b128 v[68:71], v4 offset:16384
  buffer_load_dwordx4 v10, s[4:7], s28 offen offset:256 sc1 lds
  v_smfmac_f32_16x16x64_bf16 v[16:19], v[108:111], a[24:31], v0
  s_waitcnt lgkmcnt(4)
  ds_read_b128 v[72:75], v4 offset:17408
  v_smfmac_f32_16x16x64_bf16 v[16:19], v[112:115], a[64:71], v0
  s_waitcnt lgkmcnt(4)
  ds_read_b128 v[76:79], v4 offset:18432
  v_smfmac_f32_16x16x64_bf16 v[16:19], v[84:87], a[72:79], v0
  s_waitcnt lgkmcnt(4)
  ds_read_b128 v[80:83], v4 offset:19456
  v_smfmac_f32_16x16x64_bf16 v[16:19], v[88:91], a[112:119], v0
  s_waitcnt lgkmcnt(4)
  buffer_store_dword v122, v3, s[4:7], s15 offen sc1
  v_smfmac_f32_16x16x64_bf16 v[16:19], v[100:103], a[120:127], v0
  s_add_u32 s98, s14, 1
  s_add_u32 s24, s36, 145752064
  s_add_u32 s25, s36, 145756160
  v_smfmac_f32_16x16x64_bf16 v[20:23], v[92:95], v[176:183], v0
  s_add_u32 s35, s36, s23
  v_smfmac_f32_16x16x64_bf16 v[20:23], v[96:99], v[184:191], v0
  s_waitcnt lgkmcnt(2)
  v_smfmac_f32_16x16x64_bf16 v[20:23], v[116:119], v[68:75], v0
  s_waitcnt lgkmcnt(0)
  ds_read_b128 v[68:71], v4 offset:20480
  v_mul_f32 v16, s18, v16
  v_smfmac_f32_16x16x64_bf16 v[20:23], v[124:127], v[76:83], v0
  ds_read_b128 v[72:75], v4 offset:21504
  v_mul_f32 v17, s18, v17
  v_smfmac_f32_16x16x64_bf16 v[20:23], v[104:107], a[32:39], v0
  ds_read_b128 v[76:79], v4 offset:22528
  v_mul_f32 v18, s18, v18
  v_smfmac_f32_16x16x64_bf16 v[20:23], v[108:111], a[40:47], v0
  ds_read_b128 v[80:83], v4 offset:23552
  v_mul_f32 v19, s18, v19
  v_smfmac_f32_16x16x64_bf16 v[20:23], v[112:115], a[80:87], v0
  v_cvt_pk_bf16_f32 v120, v16, v17
  v_smfmac_f32_16x16x64_bf16 v[20:23], v[84:87], a[88:95], v0
  v_cvt_pk_bf16_f32 v121, v18, v19
  v_smfmac_f32_16x16x64_bf16 v[20:23], v[88:91], a[128:135], v0
  ds_write_b64 v5, v[120:121] offset:24576
  v_smfmac_f32_16x16x64_bf16 v[20:23], v[100:103], a[136:143], v0
  s_waitcnt lgkmcnt(3)
  v_smfmac_f32_16x16x64_bf16 v[24:27], v[92:95], v[68:75], v0
  s_waitcnt lgkmcnt(1)
  v_mov_b64 v[92:93], 0
  v_smfmac_f32_16x16x64_bf16 v[24:27], v[96:99], v[76:83], v0
  s_nop 1
  v_cvt_pk_bf16_f32 v122, v20, v21
  v_cvt_pk_bf16_f32 v123, v22, v23
  v_smfmac_f32_16x16x64_bf16 v[24:27], v[116:119], v[208:215], v0
  ds_write_b64 v5, v[122:123] offset:26880
  v_mov_b64 v[94:95], 0
  v_smfmac_f32_16x16x64_bf16 v[24:27], v[124:127], v[216:223], v0
  s_waitcnt lgkmcnt(1)
  s_barrier
  ds_read_b64_tr_b16 v[68:69], v6 offset:24576
  v_smfmac_f32_16x16x64_bf16 v[24:27], v[104:107], a[48:55], v0
  s_add_u32 s27, s27, 8192
  ds_read_b64_tr_b16 v[70:71], v6 offset:24640
  ds_read_b64_tr_b16 v[72:73], v6 offset:24832
  v_smfmac_f32_16x16x64_bf16 v[24:27], v[108:111], a[56:63], v0
  s_add_u32 s28, s28, 8192
  ds_read_b64_tr_b16 v[74:75], v6 offset:24896
  ds_read_b64_tr_b16 v[76:77], v6 offset:25088
  v_smfmac_f32_16x16x64_bf16 v[24:27], v[112:115], a[96:103], v0
  s_nop 0
  ds_read_b64_tr_b16 v[78:79], v6 offset:25152
  ds_read_b64_tr_b16 v[80:81], v6 offset:25344
  v_smfmac_f32_16x16x64_bf16 v[24:27], v[84:87], a[104:111], v0
  ds_read_b64_tr_b16 v[82:83], v6 offset:25408
  v_mov_b64 v[96:97], 0
  v_smfmac_f32_16x16x64_bf16 v[24:27], v[88:91], a[144:151], v0
  s_waitcnt lgkmcnt(8)
  s_barrier
  ds_read_b64_tr_b16 v[116:117], v6 offset:26880
  v_smfmac_f32_16x16x64_bf16 v[24:27], v[100:103], a[152:159], v0
  s_waitcnt lgkmcnt(7)
  ds_read_b64_tr_b16 v[118:119], v6 offset:26944
  v_mfma_f32_16x16x32_bf16 v[16:19], v[36:39], v[68:71], 0
  s_waitcnt lgkmcnt(6)
  ds_read_b64_tr_b16 v[124:125], v6 offset:27136
  ds_read_b64_tr_b16 v[126:127], v6 offset:27200
  v_mfma_f32_16x16x32_bf16 v[16:19], v[40:43], v[72:75], v[16:19]
  s_waitcnt lgkmcnt(6)
  ds_read_b64_tr_b16 v[104:105], v6 offset:27392
  ds_read_b64_tr_b16 v[106:107], v6 offset:27456
  v_mfma_f32_16x16x32_bf16 v[16:19], v[44:47], v[76:79], v[16:19]
  s_waitcnt lgkmcnt(6)
  ds_read_b64_tr_b16 v[108:109], v6 offset:27648
  ds_read_b64_tr_b16 v[110:111], v6 offset:27712
  v_mfma_f32_16x16x32_bf16 v[16:19], v[48:51], v[80:83], v[16:19]
  s_waitcnt lgkmcnt(6)
  v_cvt_pk_bf16_f32 v120, v24, v25
  v_cvt_pk_bf16_f32 v121, v26, v27
  v_mfma_f32_16x16x32_bf16 v[112:115], v[116:119], v[68:71], 0
  s_waitcnt lgkmcnt(4)
  v_mov_b64 v[98:99], 0
  v_mfma_f32_16x16x32_bf16 v[112:115], v[124:127], v[72:75], v[112:115]
  s_waitcnt lgkmcnt(2)
  v_mov_b64 v[36:37], 0
  v_exp_f32 v100, v16
  v_mfma_f32_16x16x32_bf16 v[112:115], v[104:107], v[76:79], v[112:115]
  s_waitcnt lgkmcnt(0)
  buffer_store_dwordx4 v[120:123], v2, s[4:7], s29 offen offset:2048 sc1
  v_exp_f32 v101, v17
  v_mfma_f32_16x16x32_bf16 v[112:115], v[108:111], v[80:83], v[112:115]
  v_exp_f32 v102, v18
  v_mfma_f32_16x16x32_bf16 v[20:23], v[52:55], v[68:71], 0
  v_exp_f32 v103, v19
  v_mfma_f32_16x16x32_bf16 v[20:23], v[56:59], v[72:75], v[20:23]
  v_cvt_pk_bf16_f32 v44, v100, v101
  v_cvt_pk_bf16_f32 v45, v102, v103
  v_mfma_f32_16x16x32_bf16 v[20:23], v[60:63], v[76:79], v[20:23]
  s_add_u32 s29, s29, 131072
  v_exp_f32 v100, v112
  v_mfma_f32_16x16x32_bf16 v[20:23], v[64:67], v[80:83], v[20:23]
  v_exp_f32 v101, v113
  v_exp_f32 v102, v114
  v_exp_f32 v103, v115
  v_cvt_pk_bf16_f32 v84, v100, v101
  v_cvt_pk_bf16_f32 v85, v102, v103
  v_cndmask_b32 v48, v84, 0, s[16:17]
  v_cndmask_b32 v49, v85, 0, s[16:17]
  v_cndmask_b32 v50, 0, v84, s[16:17]
  v_cndmask_b32 v51, 0, v85, s[16:17]
  v_exp_f32 v100, v20
  v_mfma_f32_16x16x16_bf16 v[88:91], v[12:13], v[48:49], 0
  v_exp_f32 v101, v21
  v_mfma_f32_16x16x16_bf16 v[24:27], v[120:121], v[48:49], 0
  v_exp_f32 v102, v22
  v_mfma_f32_16x16x16_bf16 v[116:119], v[120:121], v[50:51], 0
  v_exp_f32 v103, v23
  v_cvt_pk_bf16_f32 v46, v100, v101
  v_cvt_pk_bf16_f32 v47, v102, v103
  v_mov_b64 v[38:39], 0
  s_nop 0
  v_mfma_f32_16x16x32_bf16 v[88:91], v[12:15], v[44:47], v[88:91]
  v_mov_b64 v[40:41], 0
  v_mov_b64 v[42:43], 0
  v_mfma_f32_16x16x32_bf16 v[24:27], v[28:31], v[44:47], v[24:27]
  ds_read_b128 v[52:55], v4 offset:24576
  ds_read_b128 v[56:59], v4 offset:25600
  v_mfma_f32_16x16x32_bf16 v[116:119], v[32:35], v[44:47], v[116:119]
  s_nop 1
T_back_60:
  v_rcp_f32 v89, v88
  v_subrev_u32 v100, s54, v88
  v_cmp_le_u32 vcc, s96, v100
  v_mul_f32 v24, v89, v24
  v_mul_f32 v25, v89, v25
  v_cvt_pk_bf16_f32 v124, v24, v25
  v_pk_mul_f32 v[26:27], v[26:27], v[88:89] op_sel:[0,1] op_sel_hi:[1,1]
  v_pk_mul_f32 v[116:117], v[116:117], v[88:89] op_sel:[0,1] op_sel_hi:[1,1]
  v_pk_mul_f32 v[118:119], v[118:119], v[88:89] op_sel:[0,1] op_sel_hi:[1,1]
  v_cvt_pk_bf16_f32 v125, v26, v27
  v_cvt_pk_bf16_f32 v126, v116, v117
  v_cvt_pk_bf16_f32 v127, v118, v119
  ds_write_b128 v11, v[124:127] offset:30208
  s_cbranch_vccnz T_slow_59
  v_smfmac_f32_16x16x64_bf16 v[92:95], v[124:127], a[160:167], v0
  s_mov_b32 s96, s55
  v_smfmac_f32_16x16x64_bf16 v[96:99], v[124:127], a[168:175], v0
  v_smfmac_f32_16x16x64_bf16 v[36:39], v[124:127], a[176:183], v0
  s_waitcnt lgkmcnt(0)
  s_barrier
  ds_read_b128 v[104:107], v11 offset:30720
  ds_read_b128 v[108:111], v11 offset:29184
  ds_read_b128 v[68:71], v11 offset:29696
  v_smfmac_f32_16x16x64_bf16 v[40:43], v[124:127], a[184:191], v0
  s_waitcnt lgkmcnt(2)
  v_smfmac_f32_16x16x64_bf16 v[92:95], v[104:107], a[192:199], v0
  s_waitcnt lgkmcnt(1)
  ds_read_b128 v[76:79], v4 offset:28672
  v_smfmac_f32_16x16x64_bf16 v[92:95], v[108:111], a[224:231], v0
  s_waitcnt lgkmcnt(1)
  ds_read_b128 v[80:83], v4 offset:29696
  v_smfmac_f32_16x16x64_bf16 v[92:95], v[68:71], a[240:247], v0
  ds_read_b128 v[60:63], v4 offset:26624
  v_smfmac_f32_16x16x64_bf16 v[96:99], v[104:107], a[200:207], v0
  ds_read_b128 v[64:67], v4 offset:27648
  v_smfmac_f32_16x16x64_bf16 v[96:99], v[108:111], a[232:239], v0
  ds_read_b128 v[28:31], v4 offset:30720
  s_nop 0
  v_cvt_pk_bf16_f32 v16, v92, v93
  v_cvt_pk_bf16_f32 v17, v94, v95
  v_bfi_b32 v16, 1, s57, v16
  v_smfmac_f32_16x16x64_bf16 v[96:99], v[68:71], a[248:255], v0
  buffer_store_dwordx2 v[16:17], v7, s[4:7], s20 offen offset:0
  v_smfmac_f32_16x16x64_bf16 v[36:39], v[104:107], a[208:215], v0
  ds_read_b128 v[32:35], v4 offset:31744
  v_smfmac_f32_16x16x64_bf16 v[36:39], v[108:111], v[52:59], v0
  s_waitcnt lgkmcnt(4)
  s_nop 0
  v_cvt_pk_bf16_f32 v18, v96, v97
  v_cvt_pk_bf16_f32 v19, v98, v99
  v_bfi_b32 v18, 1, s57, v18
  v_smfmac_f32_16x16x64_bf16 v[36:39], v[68:71], v[76:83], v0
  buffer_store_dwordx2 v[18:19], v7, s[4:7], s20 offen offset:64
  v_smfmac_f32_16x16x64_bf16 v[40:43], v[104:107], a[216:223], v0
  s_waitcnt lgkmcnt(2)
  v_smfmac_f32_16x16x64_bf16 v[40:43], v[108:111], v[60:67], v0
  s_waitcnt lgkmcnt(0)
  s_nop 0
  v_cvt_pk_bf16_f32 v20, v36, v37
  v_cvt_pk_bf16_f32 v21, v38, v39
  v_bfi_b32 v20, 1, s57, v20
  v_smfmac_f32_16x16x64_bf16 v[40:43], v[68:71], v[28:35], v0
  buffer_store_dwordx2 v[20:21], v7, s[4:7], s21 offen offset:0
  s_nop 6
  v_cvt_pk_bf16_f32 v22, v40, v41
  v_cvt_pk_bf16_f32 v23, v42, v43
  v_bfi_b32 v22, 1, s57, v22
  buffer_store_dwordx2 v[22:23], v7, s[4:7], s21 offen offset:64
  ds_read_b128 v[68:71], v4 offset:0
  ds_read_b128 v[72:75], v4 offset:1024
  ds_read_b128 v[76:79], v4 offset:4096
  ds_read_b128 v[80:83], v4 offset:5120
  ds_read_b128 v[84:87], v4 offset:8192
  ds_read_b128 v[88:91], v4 offset:9216
  ds_read_b128 v[92:95], v4 offset:2048
  ds_read_b128 v[96:99], v4 offset:3072
  ds_read_b128 v[100:103], v4 offset:6144
  ds_read_b128 v[104:107], v4 offset:7168
  ds_read_b128 v[108:111], v4 offset:10240
  ds_read_b128 v[112:115], v4 offset:11264
  v_mov_b64 v[16:17], 0
  v_mov_b64 v[18:19], 0
  v_mov_b64 v[20:21], 0
  v_mov_b64 v[22:23], 0
  v_mov_b64 v[24:25], 0
  v_mov_b64 v[26:27], 0
  ds_read_b64 v[44:45], v2 offset:32256
  s_waitcnt lgkmcnt(0)
  v_readfirstlane_b32 s38, v44
  v_readfirstlane_b32 s37, v45
  s_nop 0
  s_lshl_b32 s38, s38, 1
  s_lshl1_add_u32 s37, s37, 1
  s_min_u32 s38, s38, s37
  s_cmp_ge_u32 s38, 64
  s_cselect_b32 s38, 100, s38
  s_sub_u32 s38, s38, 1
  s_max_i32 s30, s30, s38
  s_waitcnt vmcnt(4)
  s_barrier
  ds_read_b128 v[28:31], v2 offset:18432
  ds_read_b128 v[32:35], v2 offset:22528
  ds_read_b128 v[36:39], v2 offset:8192
  ds_read_b128 v[40:43], v2 offset:9216
  ds_read_b128 v[44:47], v2 offset:10240
  ds_read_b128 v[48:51], v2 offset:11264
  buffer_load_dwordx4 v[124:127], v2, s[4:7], s24 offen offset:2048 sc1
  buffer_load_dwordx4 v[116:119], v2, s[4:7], s25 offen offset:2048 sc1
  ds_read_b128 v[52:55], v2 offset:12288
  ds_read_b128 v[56:59], v2 offset:13312
  ds_read_b128 v[60:63], v2 offset:14336
  ds_read_b128 v[64:67], v2 offset:15360
  buffer_load_dwordx4 v[124:127], v2, s[4:7], s24 offen offset:2048 sc1
  buffer_load_dwordx4 v[116:119], v2, s[4:7], s25 offen offset:2048 sc1
  s_add_u32 s14, s14, 1
  s_cmp_ge_i32 s14, s30
  s_cbranch_scc1 T_kvw_56
T_kvb_57:
  s_mov_b32 s19, 0
  s_cmp_lg_u32 s14, 63
  s_cbranch_scc1 T_loop_52
  s_branch T_last_58
T_kvw_56:
  s_mov_b32 s19, 0
  s_branch T_kvok_65
T_kv_64:
  s_sleep 4
  s_add_u32 s19, s19, 1
  s_cmp_gt_u32 s19, 32768
  s_cbranch_scc1 M_exit
T_kvok_65:
  s_add_u32 s39, s99, 128
  s_mov_b32 s38, 0
  s_mov_b32 s37, 0
  s_atomic_or s38, s[58:59], s99 glc
  s_atomic_or s37, s[58:59], s39 glc
  s_waitcnt lgkmcnt(0)
  s_lshl_b32 s38, s38, 1
  s_lshl1_add_u32 s37, s37, 1
  s_min_u32 s38, s38, s37
  s_cmp_ge_u32 s38, 64
  s_cselect_b32 s38, 100, s38
  s_sub_u32 s38, s38, 1
  s_max_i32 s30, s30, s38
  s_cmp_ge_i32 s14, s30
  s_cbranch_scc1 T_kv_64
  s_branch T_kvb_57
T_slow_59:
  s_nop 7
  v_max3_f32 v100, v16, v17, v18
  v_max3_f32 v100, v100, v19, v20
  v_max3_f32 v100, v100, v21, v22
  v_max3_f32 v100, v100, v23, v112
  v_max3_f32 v100, v100, v113, v114
  v_max_f32 v100, v100, v115
  v_mov_b32 v101, v100
  s_nop 1
  v_permlane32_swap_b32 v100, v101
  s_nop 1
  v_max_f32 v100, v100, v101
  v_mov_b32 v101, v100
  s_nop 1
  v_permlane16_swap_b32 v100, v101
  s_nop 1
  v_max_f32 v100, v100, v101
  v_sub_f32 v16, v16, v100
  v_sub_f32 v17, v17, v100
  v_sub_f32 v18, v18, v100
  v_sub_f32 v19, v19, v100
  v_exp_f32 v16, v16
  v_exp_f32 v17, v17
  v_exp_f32 v18, v18
  v_exp_f32 v19, v19
  v_sub_f32 v20, v20, v100
  v_sub_f32 v21, v21, v100
  v_sub_f32 v22, v22, v100
  v_sub_f32 v23, v23, v100
  v_exp_f32 v20, v20
  v_exp_f32 v21, v21
  v_exp_f32 v22, v22
  v_exp_f32 v23, v23
  v_sub_f32 v112, v112, v100
  v_sub_f32 v113, v113, v100
  v_sub_f32 v114, v114, v100
  v_sub_f32 v115, v115, v100
  v_exp_f32 v112, v112
  v_exp_f32 v113, v113
  v_exp_f32 v114, v114
  v_exp_f32 v115, v115
  s_nop 0
  v_cvt_pk_bf16_f32 v44, v16, v17
  v_cvt_pk_bf16_f32 v45, v18, v19
  v_cvt_pk_bf16_f32 v46, v20, v21
  v_cvt_pk_bf16_f32 v47, v22, v23
  v_cvt_pk_bf16_f32 v84, v112, v113
  v_cvt_pk_bf16_f32 v85, v114, v115
  v_cndmask_b32 v48, v84, 0, s[16:17]
  v_cndmask_b32 v49, v85, 0, s[16:17]
  v_cndmask_b32 v50, 0, v84, s[16:17]
  v_cndmask_b32 v51, 0, v85, s[16:17]
  s_nop 1
  v_mfma_f32_16x16x16_bf16 v[88:91], v[12:13], v[48:49], 0
  v_mfma_f32_16x16x16_bf16 v[24:27], v[120:121], v[48:49], 0
  v_mfma_f32_16x16x16_bf16 v[116:119], v[120:121], v[50:51], 0
  v_mfma_f32_16x16x32_bf16 v[88:91], v[12:15], v[44:47], v[88:91]
  v_mfma_f32_16x16x32_bf16 v[24:27], v[28:31], v[44:47], v[24:27]
  v_mfma_f32_16x16x32_bf16 v[116:119], v[32:35], v[44:47], v[116:119]
  s_nop 7
  s_nop 1
  s_mov_b32 s96, -1
  s_branch T_back_60
.p2align 6
T_retry_66:
  s_mov_b64 exec, vcc
  buffer_load_dwordx4 v[124:127], v2, s[4:7], s24 offen offset:2048 sc1
  buffer_load_dwordx4 v[116:119], v2, s[4:7], s25 offen offset:2048 sc1
  s_mov_b64 exec, -1
  s_add_u32 s19, s19, 1
  s_cmp_gt_u32 s19, 32768
  s_cbranch_scc1 M_exit
T_last_58:
  s_waitcnt vmcnt(3) lgkmcnt(0)
  v_max3_u32 v123, v124, v125, v126
  v_max_u32 v123, v123, v127
  v_mov_b32_dpp v120, v124 row_ror:8 row_mask:0xf bank_mask:0xf
  v_mov_b32_dpp v121, v125 row_ror:8 row_mask:0xf bank_mask:0xf
  s_waitcnt vmcnt(2)
  v_max3_u32 v123, v123, v116, v117
  v_max3_u32 v123, v123, v118, v119
  v_cmp_eq_u32 vcc, -1, v123
  s_cbranch_vccnz T_retry_66
  v_smfmac_f32_16x16x64_bf16 v[20:23], v[124:127], v[76:83], v0
  ds_write_b128 v2, v[124:127] offset:2048
  v_mov_b32_dpp v122, v126 row_ror:8 row_mask:0xf bank_mask:0xf
  v_mov_b32_dpp v123, v127 row_ror:8 row_mask:0xf bank_mask:0xf
  v_smfmac_f32_16x16x64_bf16 v[24:27], v[124:127], v[84:91], v0
  ds_write_b128 v2, v[116:119] offset:6144
  v_mov_b32_dpp v84, v116 row_ror:8 row_mask:0xf bank_mask:0xf
  v_smfmac_f32_16x16x64_bf16 v[20:23], v[120:123], v[100:107], v0
  ds_read_b128 v[68:71], v4 offset:12288
  v_mov_b32_dpp v85, v117 row_ror:8 row_mask:0xf bank_mask:0xf
  v_smfmac_f32_16x16x64_bf16 v[24:27], v[120:123], v[108:115], v0
  ds_read_b128 v[72:75], v4 offset:13312
  v_mov_b32_dpp v86, v118 row_ror:8 row_mask:0xf bank_mask:0xf
  ds_read_b128 v[76:79], v4 offset:14336
  v_mov_b32_dpp v87, v119 row_ror:8 row_mask:0xf bank_mask:0xf
  v_smfmac_f32_16x16x64_bf16 v[20:23], v[116:119], v[240:247], v0
  s_waitcnt lgkmcnt(3)
  s_barrier
  ds_read_b128 v[100:103], v2 offset:3072
  v_smfmac_f32_16x16x64_bf16 v[24:27], v[116:119], a[0:7], v0
  ds_read_b128 v[120:123], v1 offset:3072
  v_smfmac_f32_16x16x64_bf16 v[20:23], v[84:87], v[248:255], v0
  ds_read_b128 v[80:83], v4 offset:15360
  v_smfmac_f32_16x16x64_bf16 v[24:27], v[84:87], a[8:15], v0
  s_waitcnt lgkmcnt(2)
  ds_read_b128 v[92:95], v2 offset:0
  v_smfmac_f32_16x16x64_bf16 v[20:23], v[100:103], v[144:151], v0
  ds_read_b128 v[96:99], v1 offset:0
  v_smfmac_f32_16x16x64_bf16 v[24:27], v[100:103], v[68:75], v0
  s_waitcnt vmcnt(0) lgkmcnt(3)
  ds_read_b128 v[116:119], v2 offset:1024
  ds_read_b128 v[124:127], v1 offset:1024
  v_smfmac_f32_16x16x64_bf16 v[20:23], v[120:123], v[152:159], v0
  s_waitcnt lgkmcnt(4)
  ds_read_b128 v[104:107], v2 offset:7168
  v_smfmac_f32_16x16x64_bf16 v[24:27], v[120:123], v[76:83], v0
  s_waitcnt lgkmcnt(4)
  ds_read_b128 v[108:111], v1 offset:7168
  ds_read_b128 v[112:115], v2 offset:4096
  ds_read_b128 v[84:87], v1 offset:4096
  ds_read_b128 v[88:91], v2 offset:5120
  ds_read_b128 v[100:103], v1 offset:5120
  ds_read_b128 v[68:71], v4 offset:16384
  ds_read_b128 v[72:75], v4 offset:17408
  ds_read_b128 v[76:79], v4 offset:18432
  ds_read_b128 v[80:83], v4 offset:19456
  v_smfmac_f32_16x16x64_bf16 v[20:23], v[92:95], v[176:183], v0
  s_waitcnt lgkmcnt(12)
  v_smfmac_f32_16x16x64_bf16 v[20:23], v[96:99], v[184:191], v0
  s_waitcnt lgkmcnt(2)
  v_smfmac_f32_16x16x64_bf16 v[20:23], v[116:119], v[68:75], v0
  s_waitcnt lgkmcnt(0)
  ds_read_b128 v[68:71], v4 offset:20480
  v_smfmac_f32_16x16x64_bf16 v[20:23], v[124:127], v[76:83], v0
  ds_read_b128 v[72:75], v4 offset:21504
  v_smfmac_f32_16x16x64_bf16 v[20:23], v[104:107], a[32:39], v0
  ds_read_b128 v[76:79], v4 offset:22528
  v_smfmac_f32_16x16x64_bf16 v[20:23], v[108:111], a[40:47], v0
  ds_read_b128 v[80:83], v4 offset:23552
  v_smfmac_f32_16x16x64_bf16 v[20:23], v[112:115], a[80:87], v0
  v_smfmac_f32_16x16x64_bf16 v[20:23], v[84:87], a[88:95], v0
  v_smfmac_f32_16x16x64_bf16 v[20:23], v[88:91], a[128:135], v0
  v_smfmac_f32_16x16x64_bf16 v[20:23], v[100:103], a[136:143], v0
  s_waitcnt lgkmcnt(2)
  v_smfmac_f32_16x16x64_bf16 v[24:27], v[92:95], v[68:75], v0
  s_waitcnt lgkmcnt(0)
  v_smfmac_f32_16x16x64_bf16 v[24:27], v[96:99], v[76:83], v0
  v_smfmac_f32_16x16x64_bf16 v[24:27], v[116:119], v[208:215], v0
  v_smfmac_f32_16x16x64_bf16 v[24:27], v[124:127], v[216:223], v0
  v_smfmac_f32_16x16x64_bf16 v[24:27], v[104:107], a[48:55], v0
  v_smfmac_f32_16x16x64_bf16 v[24:27], v[108:111], a[56:63], v0
  v_smfmac_f32_16x16x64_bf16 v[24:27], v[112:115], a[96:103], v0
  v_smfmac_f32_16x16x64_bf16 v[24:27], v[84:87], a[104:111], v0
  v_smfmac_f32_16x16x64_bf16 v[24:27], v[88:91], a[144:151], v0
  v_smfmac_f32_16x16x64_bf16 v[24:27], v[100:103], a[152:159], v0
  v_cvt_pk_bf16_f32 v122, v20, v21
  v_cvt_pk_bf16_f32 v123, v22, v23
  s_nop 5
  v_cvt_pk_bf16_f32 v120, v24, v25
  v_cvt_pk_bf16_f32 v121, v26, v27
  buffer_store_dwordx4 v[120:123], v2, s[4:7], s29 offen offset:2048 sc1
  s_branch M_tdone
T_w_13:
  s_mov_b32 s19, 0
  s_add_u32 s14, s14, 1
  s_and_b32 s57, s14, 1
  v_mov_b64 v[16:17], 0
  v_mov_b64 v[18:19], 0
  v_mov_b64 v[20:21], 0
  v_mov_b64 v[22:23], 0
  v_mov_b64 v[24:25], 0
  v_mov_b64 v[26:27], 0
  buffer_load_dwordx4 v[124:127], v2, s[4:7], s24 offen offset:3072 sc1
  buffer_load_dwordx4 v[116:119], v2, s[4:7], s25 offen offset:3072 sc1
  buffer_load_dwordx4 v[124:127], v2, s[4:7], s24 offen offset:3072 sc1
  buffer_load_dwordx4 v[116:119], v2, s[4:7], s25 offen offset:3072 sc1
  s_branch T_loop_71
.p2align 6
T_retry_72:
  s_mov_b64 exec, vcc
  buffer_load_dwordx4 v[124:127], v2, s[4:7], s24 offen offset:3072 sc1
  buffer_load_dwordx4 v[116:119], v2, s[4:7], s25 offen offset:3072 sc1
  s_mov_b64 exec, -1
  s_add_u32 s19, s19, 1
  s_cmp_gt_u32 s19, 32768
  s_cbranch_scc1 M_exit
  s_nop 0
  v_mov_b64 v[16:17], 0
  v_mov_b64 v[18:19], 0
T_loop_71:
  s_waitcnt vmcnt(3) lgkmcnt(0)
  v_max3_u32 v123, v124, v125, v126
  v_max_u32 v123, v123, v127
  v_mov_b32_dpp v120, v124 row_ror:8 row_mask:0xf bank_mask:0xf
  v_mov_b32_dpp v121, v125 row_ror:8 row_mask:0xf bank_mask:0xf
  s_waitcnt vmcnt(2)
  v_max3_u32 v123, v123, v116, v117
  v_max3_u32 v123, v123, v118, v119
  v_cmp_eq_u32 vcc, -1, v123
  v_smfmac_f32_16x16x64_bf16 v[16:19], v[124:127], v[68:75], v0
  s_cbranch_vccnz T_retry_72
  ds_write_b128 v2, v[124:127] offset:3072
  v_mov_b32_dpp v122, v126 row_ror:8 row_mask:0xf bank_mask:0xf
  v_smfmac_f32_16x16x64_bf16 v[20:23], v[124:127], v[76:83], v0
  s_and_b32 s57, s14, 1
  v_mov_b32_dpp v123, v127 row_ror:8 row_mask:0xf bank_mask:0xf
  v_smfmac_f32_16x16x64_bf16 v[24:27], v[124:127], v[84:91], v0
  s_and_b32 s36, s14, 3
  ds_write_b128 v2, v[116:119] offset:7168
  v_smfmac_f32_16x16x64_bf16 v[16:19], v[120:123], v[92:99], v0
  s_lshl_b32 s36, s36, 13
  v_mov_b32_dpp v84, v116 row_ror:8 row_mask:0xf bank_mask:0xf
  v_smfmac_f32_16x16x64_bf16 v[20:23], v[120:123], v[100:107], v0
  s_add_u32 s26, s36, s23
  ds_read_b128 v[68:71], v4 offset:12288
  v_mov_b32_dpp v85, v117 row_ror:8 row_mask:0xf bank_mask:0xf
  v_smfmac_f32_16x16x64_bf16 v[24:27], v[120:123], v[108:115], v0
  s_add_u32 s36, s36, 8192
  ds_read_b128 v[72:75], v4 offset:13312
  v_mov_b32_dpp v86, v118 row_ror:8 row_mask:0xf bank_mask:0xf
  v_smfmac_f32_16x16x64_bf16 v[16:19], v[116:119], v[224:231], v0
  s_and_b32 s36, s36, 0x7fff
  ds_read_b128 v[76:79], v4 offset:14336
  v_mov_b32_dpp v87, v119 row_ror:8 row_mask:0xf bank_mask:0xf
  v_smfmac_f32_16x16x64_bf16 v[20:23], v[116:119], v[240:247], v0
  s_waitcnt lgkmcnt(3)
  s_barrier
  ds_read_b128 v[100:103], v2 offset:2048
  v_smfmac_f32_16x16x64_bf16 v[24:27], v[116:119], a[0:7], v0
  s_mov_b32 m0, s31
  ds_read_b128 v[120:123], v1 offset:2048
  v_smfmac_f32_16x16x64_bf16 v[16:19], v[84:87], v[232:239], v0
  v_smfmac_f32_16x16x64_bf16 v[20:23], v[84:87], v[248:255], v0
  ds_read_b128 v[80:83], v4 offset:15360
  v_smfmac_f32_16x16x64_bf16 v[24:27], v[84:87], a[8:15], v0
  s_waitcnt lgkmcnt(2)
  buffer_load_dwordx4 v9, s[4:7], s27 offen sc1 lds
  v_smfmac_f32_16x16x64_bf16 v[16:19], v[100:103], v[128:135], v0
  ds_read_b128 v[92:95], v2 offset:1024
  s_mov_b32 m0, s32
  v_smfmac_f32_16x16x64_bf16 v[20:23], v[100:103], v[144:151], v0
  ds_read_b128 v[96:99], v1 offset:1024
  v_smfmac_f32_16x16x64_bf16 v[24:27], v[100:103], v[68:75], v0
  s_waitcnt vmcnt(1) lgkmcnt(3)
  ds_read_b128 v[116:119], v2 offset:0
  v_smfmac_f32_16x16x64_bf16 v[16:19], v[120:123], v[136:143], v0
  ds_read_b128 v[124:127], v1 offset:0
  buffer_load_dwordx4 v9, s[4:7], s27 offen offset:128 sc1 lds
  v_smfmac_f32_16x16x64_bf16 v[20:23], v[120:123], v[152:159], v0
  s_waitcnt lgkmcnt(4)
  ds_read_b128 v[104:107], v2 offset:6144
  s_mov_b32 m0, s33
  v_smfmac_f32_16x16x64_bf16 v[24:27], v[120:123], v[76:83], v0
  s_waitcnt lgkmcnt(4)
  ds_read_b128 v[108:111], v1 offset:6144
  v_smfmac_f32_16x16x64_bf16 v[16:19], v[92:95], v[160:167], v0
  s_waitcnt lgkmcnt(4)
  ds_read_b128 v[112:115], v2 offset:5120
  v_smfmac_f32_16x16x64_bf16 v[16:19], v[96:99], v[168:175], v0
  s_waitcnt lgkmcnt(4)
  ds_read_b128 v[84:87], v1 offset:5120
  buffer_load_dwordx4 v10, s[4:7], s28 offen sc1 lds
  v_smfmac_f32_16x16x64_bf16 v[16:19], v[116:119], v[192:199], v0
  s_waitcnt lgkmcnt(4)
  ds_read_b128 v[88:91], v2 offset:4096
  s_mov_b32 m0, s34
  v_smfmac_f32_16x16x64_bf16 v[16:19], v[124:127], v[200:207], v0
  s_waitcnt lgkmcnt(4)
  ds_read_b128 v[100:103], v1 offset:4096
  v_smfmac_f32_16x16x64_bf16 v[16:19], v[104:107], a[16:23], v0
  s_waitcnt lgkmcnt(4)
  ds_read_b128 v[68:71], v4 offset:16384
  v_smfmac_f32_16x16x64_bf16 v[16:19], v[108:111], a[24:31], v0
  s_waitcnt lgkmcnt(4)
  ds_read_b128 v[72:75], v4 offset:17408
  buffer_load_dwordx4 v10, s[4:7], s28 offen offset:256 sc1 lds
  v_smfmac_f32_16x16x64_bf16 v[16:19], v[112:115], a[64:71], v0
  s_waitcnt lgkmcnt(4)
  ds_read_b128 v[76:79], v4 offset:18432
  s_mov_b32 m0, 32256
  v_smfmac_f32_16x16x64_bf16 v[16:19], v[84:87], a[72:79], v0
  s_waitcnt lgkmcnt(4)
  ds_read_b128 v[80:83], v4 offset:19456
  v_smfmac_f32_16x16x64_bf16 v[16:19], v[88:91], a[112:119], v0
  s_waitcnt lgkmcnt(4)
  v_smfmac_f32_16x16x64_bf16 v[16:19], v[100:103], a[120:127], v0
  buffer_load_dword v3, s[4:7], s99 offen sc1 lds
  s_add_u32 s24, s36, 145752064
  s_add_u32 s25, s36, 145756160
  v_smfmac_f32_16x16x64_bf16 v[20:23], v[92:95], v[176:183], v0
  s_add_u32 s35, s36, s23
  v_smfmac_f32_16x16x64_bf16 v[20:23], v[96:99], v[184:191], v0
  s_waitcnt lgkmcnt(2)
  v_smfmac_f32_16x16x64_bf16 v[20:23], v[116:119], v[68:75], v0
  s_waitcnt lgkmcnt(0)
  ds_read_b128 v[68:71], v4 offset:20480
  v_mul_f32 v16, s18, v16
  v_smfmac_f32_16x16x64_bf16 v[20:23], v[124:127], v[76:83], v0
  ds_read_b128 v[72:75], v4 offset:21504
  v_mul_f32 v17, s18, v17
  v_smfmac_f32_16x16x64_bf16 v[20:23], v[104:107], a[32:39], v0
  ds_read_b128 v[76:79], v4 offset:22528
  v_mul_f32 v18, s18, v18
  v_smfmac_f32_16x16x64_bf16 v[20:23], v[108:111], a[40:47], v0
  ds_read_b128 v[80:83], v4 offset:23552
  v_mul_f32 v19, s18, v19
  v_smfmac_f32_16x16x64_bf16 v[20:23], v[112:115], a[80:87], v0
  v_cvt_pk_bf16_f32 v120, v16, v17
  v_smfmac_f32_16x16x64_bf16 v[20:23], v[84:87], a[88:95], v0
  v_cvt_pk_bf16_f32 v121, v18, v19
  v_smfmac_f32_16x16x64_bf16 v[20:23], v[88:91], a[128:135], v0
  ds_write_b64 v5, v[120:121] offset:24576
  v_smfmac_f32_16x16x64_bf16 v[20:23], v[100:103], a[136:143], v0
  s_waitcnt lgkmcnt(3)
  v_smfmac_f32_16x16x64_bf16 v[24:27], v[92:95], v[68:75], v0
  s_waitcnt lgkmcnt(1)
  v_mov_b64 v[92:93], 0
  v_smfmac_f32_16x16x64_bf16 v[24:27], v[96:99], v[76:83], v0
  s_nop 1
  v_cvt_pk_bf16_f32 v122, v20, v21
  v_cvt_pk_bf16_f32 v123, v22, v23
  v_smfmac_f32_16x16x64_bf16 v[24:27], v[116:119], v[208:215], v0
  ds_write_b64 v5, v[122:123] offset:26880
  v_mov_b64 v[94:95], 0
  v_smfmac_f32_16x16x64_bf16 v[24:27], v[124:127], v[216:223], v0
  s_waitcnt lgkmcnt(1)
  s_barrier
  ds_read_b64_tr_b16 v[68:69], v6 offset:24576
  v_smfmac_f32_16x16x64_bf16 v[24:27], v[104:107], a[48:55], v0
  s_add_u32 s27, s27, 8192
  ds_read_b64_tr_b16 v[70:71], v6 offset:24640
  ds_read_b64_tr_b16 v[72:73], v6 offset:24832
  v_smfmac_f32_16x16x64_bf16 v[24:27], v[108:111], a[56:63], v0
  s_add_u32 s28, s28, 8192
  ds_read_b64_tr_b16 v[74:75], v6 offset:24896
  ds_read_b64_tr_b16 v[76:77], v6 offset:25088
  v_smfmac_f32_16x16x64_bf16 v[24:27], v[112:115], a[96:103], v0
  s_nop 0
  ds_read_b64_tr_b16 v[78:79], v6 offset:25152
  ds_read_b64_tr_b16 v[80:81], v6 offset:25344
  v_smfmac_f32_16x16x64_bf16 v[24:27], v[84:87], a[104:111], v0
  ds_read_b64_tr_b16 v[82:83], v6 offset:25408
  v_mov_b64 v[96:97], 0
  v_smfmac_f32_16x16x64_bf16 v[24:27], v[88:91], a[144:151], v0
  s_waitcnt lgkmcnt(8)
  s_barrier
  ds_read_b64_tr_b16 v[116:117], v6 offset:26880
  v_smfmac_f32_16x16x64_bf16 v[24:27], v[100:103], a[152:159], v0
  s_waitcnt lgkmcnt(7)
  ds_read_b64_tr_b16 v[118:119], v6 offset:26944
  v_mfma_f32_16x16x32_bf16 v[16:19], v[36:39], v[68:71], 0
  s_waitcnt lgkmcnt(6)
  ds_read_b64_tr_b16 v[124:125], v6 offset:27136
  ds_read_b64_tr_b16 v[126:127], v6 offset:27200
  v_mfma_f32_16x16x32_bf16 v[16:19], v[40:43], v[72:75], v[16:19]
  s_waitcnt lgkmcnt(6)
  ds_read_b64_tr_b16 v[104:105], v6 offset:27392
  ds_read_b64_tr_b16 v[106:107], v6 offset:27456
  v_mfma_f32_16x16x32_bf16 v[16:19], v[44:47], v[76:79], v[16:19]
  s_waitcnt lgkmcnt(6)
  ds_read_b64_tr_b16 v[108:109], v6 offset:27648
  ds_read_b64_tr_b16 v[110:111], v6 offset:27712
  v_mfma_f32_16x16x32_bf16 v[16:19], v[48:51], v[80:83], v[16:19]
  s_waitcnt lgkmcnt(6)
  v_cvt_pk_bf16_f32 v120, v24, v25
  v_cvt_pk_bf16_f32 v121, v26, v27
  v_mfma_f32_16x16x32_bf16 v[112:115], v[116:119], v[68:71], 0
  s_waitcnt lgkmcnt(4)
  v_mov_b64 v[98:99], 0
  v_mfma_f32_16x16x32_bf16 v[112:115], v[124:127], v[72:75], v[112:115]
  s_waitcnt lgkmcnt(2)
  v_mov_b64 v[36:37], 0
  v_exp_f32 v100, v16
  v_mfma_f32_16x16x32_bf16 v[112:115], v[104:107], v[76:79], v[112:115]
  s_waitcnt lgkmcnt(0)
  v_exp_f32 v101, v17
  v_mfma_f32_16x16x32_bf16 v[112:115], v[108:111], v[80:83], v[112:115]
  buffer_store_dwordx4 v[120:123], v2, s[4:7], s29 offen offset:3072 sc1
  v_exp_f32 v102, v18
  v_mfma_f32_16x16x32_bf16 v[20:23], v[52:55], v[68:71], 0
  v_exp_f32 v103, v19
  v_mfma_f32_16x16x32_bf16 v[20:23], v[56:59], v[72:75], v[20:23]
  v_cvt_pk_bf16_f32 v44, v100, v101
  v_cvt_pk_bf16_f32 v45, v102, v103
  v_mfma_f32_16x16x32_bf16 v[20:23], v[60:63], v[76:79], v[20:23]
  s_add_u32 s29, s29, 131072
  v_exp_f32 v100, v112
  v_mfma_f32_16x16x32_bf16 v[20:23], v[64:67], v[80:83], v[20:23]
  v_exp_f32 v101, v113
  v_exp_f32 v102, v114
  v_exp_f32 v103, v115
  v_cvt_pk_bf16_f32 v84, v100, v101
  v_cvt_pk_bf16_f32 v85, v102, v103
  v_cndmask_b32 v48, v84, 0, s[16:17]
  v_cndmask_b32 v49, v85, 0, s[16:17]
  v_cndmask_b32 v50, 0, v84, s[16:17]
  v_cndmask_b32 v51, 0, v85, s[16:17]
  v_exp_f32 v100, v20
  v_mfma_f32_16x16x16_bf16 v[88:91], v[12:13], v[48:49], 0
  v_exp_f32 v101, v21
  v_mfma_f32_16x16x16_bf16 v[24:27], v[120:121], v[48:49], 0
  v_exp_f32 v102, v22
  v_mfma_f32_16x16x16_bf16 v[116:119], v[120:121], v[50:51], 0
  v_exp_f32 v103, v23
  v_cvt_pk_bf16_f32 v46, v100, v101
  v_cvt_pk_bf16_f32 v47, v102, v103
  v_mov_b64 v[38:39], 0
  s_nop 0
  v_mfma_f32_16x16x32_bf16 v[88:91], v[12:15], v[44:47], v[88:91]
  v_mov_b64 v[40:41], 0
  v_mov_b64 v[42:43], 0
  v_mfma_f32_16x16x32_bf16 v[24:27], v[28:31], v[44:47], v[24:27]
  ds_read_b128 v[52:55], v4 offset:24576
  ds_read_b128 v[56:59], v4 offset:25600
  v_mfma_f32_16x16x32_bf16 v[116:119], v[32:35], v[44:47], v[116:119]
  s_nop 1
T_back_79:
  v_rcp_f32 v89, v88
  v_subrev_u32 v100, s54, v88
  v_cmp_le_u32 vcc, s96, v100
  v_mul_f32 v24, v89, v24
  v_mul_f32 v25, v89, v25
  v_cvt_pk_bf16_f32 v124, v24, v25
  v_pk_mul_f32 v[26:27], v[26:27], v[88:89] op_sel:[0,1] op_sel_hi:[1,1]
  v_pk_mul_f32 v[116:117], v[116:117], v[88:89] op_sel:[0,1] op_sel_hi:[1,1]
  v_pk_mul_f32 v[118:119], v[118:119], v[88:89] op_sel:[0,1] op_sel_hi:[1,1]
  v_cvt_pk_bf16_f32 v125, v26, v27
  v_cvt_pk_bf16_f32 v126, v116, v117
  v_cvt_pk_bf16_f32 v127, v118, v119
  ds_write_b128 v11, v[124:127] offset:30720
  s_cbranch_vccnz T_slow_78
  v_smfmac_f32_16x16x64_bf16 v[92:95], v[124:127], a[160:167], v0
  s_mov_b32 s96, s55
  v_smfmac_f32_16x16x64_bf16 v[96:99], v[124:127], a[168:175], v0
  v_smfmac_f32_16x16x64_bf16 v[36:39], v[124:127], a[176:183], v0
  s_waitcnt lgkmcnt(0)
  s_barrier
  ds_read_b128 v[104:107], v11 offset:30208
  ds_read_b128 v[108:111], v11 offset:29696
  ds_read_b128 v[68:71], v11 offset:29184
  v_smfmac_f32_16x16x64_bf16 v[40:43], v[124:127], a[184:191], v0
  s_waitcnt lgkmcnt(2)
  v_smfmac_f32_16x16x64_bf16 v[92:95], v[104:107], a[192:199], v0
  s_waitcnt lgkmcnt(1)
  ds_read_b128 v[76:79], v4 offset:28672
  v_smfmac_f32_16x16x64_bf16 v[92:95], v[108:111], a[224:231], v0
  s_waitcnt lgkmcnt(1)
  ds_read_b128 v[80:83], v4 offset:29696
  v_smfmac_f32_16x16x64_bf16 v[92:95], v[68:71], a[240:247], v0
  ds_read_b128 v[60:63], v4 offset:26624
  v_smfmac_f32_16x16x64_bf16 v[96:99], v[104:107], a[200:207], v0
  ds_read_b128 v[64:67], v4 offset:27648
  v_smfmac_f32_16x16x64_bf16 v[96:99], v[108:111], a[232:239], v0
  ds_read_b128 v[28:31], v4 offset:30720
  s_nop 0
  v_cvt_pk_bf16_f32 v16, v92, v93
  v_cvt_pk_bf16_f32 v17, v94, v95
  v_bfi_b32 v16, 1, s57, v16
  v_smfmac_f32_16x16x64_bf16 v[96:99], v[68:71], a[248:255], v0
  buffer_store_dwordx2 v[16:17], v7, s[4:7], s20 offen offset:0
  v_smfmac_f32_16x16x64_bf16 v[36:39], v[104:107], a[208:215], v0
  ds_read_b128 v[32:35], v4 offset:31744
  v_smfmac_f32_16x16x64_bf16 v[36:39], v[108:111], v[52:59], v0
  s_waitcnt lgkmcnt(4)
  s_nop 0
  v_cvt_pk_bf16_f32 v18, v96, v97
  v_cvt_pk_bf16_f32 v19, v98, v99
  v_bfi_b32 v18, 1, s57, v18
  v_smfmac_f32_16x16x64_bf16 v[36:39], v[68:71], v[76:83], v0
  buffer_store_dwordx2 v[18:19], v7, s[4:7], s20 offen offset:64
  v_smfmac_f32_16x16x64_bf16 v[40:43], v[104:107], a[216:223], v0
  s_waitcnt lgkmcnt(2)
  v_smfmac_f32_16x16x64_bf16 v[40:43], v[108:111], v[60:67], v0
  s_waitcnt lgkmcnt(0)
  s_nop 0
  v_cvt_pk_bf16_f32 v20, v36, v37
  v_cvt_pk_bf16_f32 v21, v38, v39
  v_bfi_b32 v20, 1, s57, v20
  v_smfmac_f32_16x16x64_bf16 v[40:43], v[68:71], v[28:35], v0
  buffer_store_dwordx2 v[20:21], v7, s[4:7], s21 offen offset:0
  s_nop 6
  v_cvt_pk_bf16_f32 v22, v40, v41
  v_cvt_pk_bf16_f32 v23, v42, v43
  v_bfi_b32 v22, 1, s57, v22
  buffer_store_dwordx2 v[22:23], v7, s[4:7], s21 offen offset:64
  ds_read_b128 v[68:71], v4 offset:0
  ds_read_b128 v[72:75], v4 offset:1024
  ds_read_b128 v[76:79], v4 offset:4096
  ds_read_b128 v[80:83], v4 offset:5120
  ds_read_b128 v[84:87], v4 offset:8192
  ds_read_b128 v[88:91], v4 offset:9216
  ds_read_b128 v[92:95], v4 offset:2048
  ds_read_b128 v[96:99], v4 offset:3072
  ds_read_b128 v[100:103], v4 offset:6144
  ds_read_b128 v[104:107], v4 offset:7168
  ds_read_b128 v[108:111], v4 offset:10240
  ds_read_b128 v[112:115], v4 offset:11264
  v_mov_b64 v[16:17], 0
  v_mov_b64 v[18:19], 0
  v_mov_b64 v[20:21], 0
  v_mov_b64 v[22:23], 0
  v_mov_b64 v[24:25], 0
  v_mov_b64 v[26:27], 0
  ds_read_b64 v[44:45], v2 offset:32256
  s_waitcnt lgkmcnt(0)
  v_readfirstlane_b32 s38, v44
  v_readfirstlane_b32 s37, v45
  s_nop 0
  s_lshl_b32 s38, s38, 1
  s_lshl1_add_u32 s37, s37, 1
  s_min_u32 s38, s38, s37
  s_cmp_ge_u32 s38, 64
  s_cselect_b32 s38, 100, s38
  s_sub_u32 s38, s38, 1
  s_max_i32 s30, s30, s38
  s_waitcnt vmcnt(4)
  s_barrier
  ds_read_b128 v[28:31], v2 offset:19456
  ds_read_b128 v[32:35], v2 offset:23552
  ds_read_b128 v[36:39], v2 offset:8192
  ds_read_b128 v[40:43], v2 offset:9216
  ds_read_b128 v[44:47], v2 offset:10240
  ds_read_b128 v[48:51], v2 offset:11264
  buffer_load_dwordx4 v[124:127], v2, s[4:7], s24 offen offset:3072 sc1
  buffer_load_dwordx4 v[116:119], v2, s[4:7], s25 offen offset:3072 sc1
  ds_read_b128 v[52:55], v2 offset:12288
  ds_read_b128 v[56:59], v2 offset:13312
  ds_read_b128 v[60:63], v2 offset:14336
  ds_read_b128 v[64:67], v2 offset:15360
  buffer_load_dwordx4 v[124:127], v2, s[4:7], s24 offen offset:3072 sc1
  buffer_load_dwordx4 v[116:119], v2, s[4:7], s25 offen offset:3072 sc1
  s_add_u32 s14, s14, 1
  s_cmp_ge_i32 s14, s30
  s_cbranch_scc1 T_kvw_75
T_kvb_76:
  s_mov_b32 s19, 0
  s_cmp_lg_u32 s14, 63
  s_cbranch_scc1 T_loop_71
  s_branch T_last_77
T_kvw_75:
  s_mov_b32 s19, 0
  s_branch T_kvok_84
T_kv_83:
  s_sleep 4
  s_add_u32 s19, s19, 1
  s_cmp_gt_u32 s19, 32768
  s_cbranch_scc1 M_exit
T_kvok_84:
  s_add_u32 s39, s99, 128
  s_mov_b32 s38, 0
  s_mov_b32 s37, 0
  s_atomic_or s38, s[58:59], s99 glc
  s_atomic_or s37, s[58:59], s39 glc
  s_waitcnt lgkmcnt(0)
  s_lshl_b32 s38, s38, 1
  s_lshl1_add_u32 s37, s37, 1
  s_min_u32 s38, s38, s37
  s_cmp_ge_u32 s38, 64
  s_cselect_b32 s38, 100, s38
  s_sub_u32 s38, s38, 1
  s_max_i32 s30, s30, s38
  s_cmp_ge_i32 s14, s30
  s_cbranch_scc1 T_kv_83
  s_branch T_kvb_76
T_slow_78:
  s_nop 7
  v_max3_f32 v100, v16, v17, v18
  v_max3_f32 v100, v100, v19, v20
  v_max3_f32 v100, v100, v21, v22
  v_max3_f32 v100, v100, v23, v112
  v_max3_f32 v100, v100, v113, v114
  v_max_f32 v100, v100, v115
  v_mov_b32 v101, v100
  s_nop 1
  v_permlane32_swap_b32 v100, v101
  s_nop 1
  v_max_f32 v100, v100, v101
  v_mov_b32 v101, v100
  s_nop 1
  v_permlane16_swap_b32 v100, v101
  s_nop 1
  v_max_f32 v100, v100, v101
  v_sub_f32 v16, v16, v100
  v_sub_f32 v17, v17, v100
  v_sub_f32 v18, v18, v100
  v_sub_f32 v19, v19, v100
  v_exp_f32 v16, v16
  v_exp_f32 v17, v17
  v_exp_f32 v18, v18
  v_exp_f32 v19, v19
  v_sub_f32 v20, v20, v100
  v_sub_f32 v21, v21, v100
  v_sub_f32 v22, v22, v100
  v_sub_f32 v23, v23, v100
  v_exp_f32 v20, v20
  v_exp_f32 v21, v21
  v_exp_f32 v22, v22
  v_exp_f32 v23, v23
  v_sub_f32 v112, v112, v100
  v_sub_f32 v113, v113, v100
  v_sub_f32 v114, v114, v100
  v_sub_f32 v115, v115, v100
  v_exp_f32 v112, v112
  v_exp_f32 v113, v113
  v_exp_f32 v114, v114
  v_exp_f32 v115, v115
  s_nop 0
  v_cvt_pk_bf16_f32 v44, v16, v17
  v_cvt_pk_bf16_f32 v45, v18, v19
  v_cvt_pk_bf16_f32 v46, v20, v21
  v_cvt_pk_bf16_f32 v47, v22, v23
  v_cvt_pk_bf16_f32 v84, v112, v113
  v_cvt_pk_bf16_f32 v85, v114, v115
  v_cndmask_b32 v48, v84, 0, s[16:17]
  v_cndmask_b32 v49, v85, 0, s[16:17]
  v_cndmask_b32 v50, 0, v84, s[16:17]
  v_cndmask_b32 v51, 0, v85, s[16:17]
  s_nop 1
  v_mfma_f32_16x16x16_bf16 v[88:91], v[12:13], v[48:49], 0
  v_mfma_f32_16x16x16_bf16 v[24:27], v[120:121], v[48:49], 0
  v_mfma_f32_16x16x16_bf16 v[116:119], v[120:121], v[50:51], 0
  v_mfma_f32_16x16x32_bf16 v[88:91], v[12:15], v[44:47], v[88:91]
  v_mfma_f32_16x16x32_bf16 v[24:27], v[28:31], v[44:47], v[24:27]
  v_mfma_f32_16x16x32_bf16 v[116:119], v[32:35], v[44:47], v[116:119]
  s_nop 7
  s_nop 1
  s_mov_b32 s96, -1
  s_branch T_back_79
.p2align 6
T_retry_85:
  s_mov_b64 exec, vcc
  buffer_load_dwordx4 v[124:127], v2, s[4:7], s24 offen offset:3072 sc1
  buffer_load_dwordx4 v[116:119], v2, s[4:7], s25 offen offset:3072 sc1
  s_mov_b64 exec, -1
  s_add_u32 s19, s19, 1
  s_cmp_gt_u32 s19, 32768
  s_cbranch_scc1 M_exit
T_last_77:
  s_waitcnt vmcnt(3) lgkmcnt(0)
  v_max3_u32 v123, v124, v125, v126
  v_max_u32 v123, v123, v127
  v_mov_b32_dpp v120, v124 row_ror:8 row_mask:0xf bank_mask:0xf
  v_mov_b32_dpp v121, v125 row_ror:8 row_mask:0xf bank_mask:0xf
  s_waitcnt vmcnt(2)
  v_max3_u32 v123, v123, v116, v117
  v_max3_u32 v123, v123, v118, v119
  v_cmp_eq_u32 vcc, -1, v123
  s_cbranch_vccnz T_retry_85
  v_smfmac_f32_16x16x64_bf16 v[20:23], v[124:127], v[76:83], v0
  ds_write_b128 v2, v[124:127] offset:3072
  v_mov_b32_dpp v122, v126 row_ror:8 row_mask:0xf bank_mask:0xf
  v_mov_b32_dpp v123, v127 row_ror:8 row_mask:0xf bank_mask:0xf
  v_smfmac_f32_16x16x64_bf16 v[24:27], v[124:127], v[84:91], v0
  ds_write_b128 v2, v[116:119] offset:7168
  v_mov_b32_dpp v84, v116 row_ror:8 row_mask:0xf bank_mask:0xf
  v_smfmac_f32_16x16x64_bf16 v[20:23], v[120:123], v[100:107], v0
  ds_read_b128 v[68:71], v4 offset:12288
  v_mov_b32_dpp v85, v117 row_ror:8 row_mask:0xf bank_mask:0xf
  v_smfmac_f32_16x16x64_bf16 v[24:27], v[120:123], v[108:115], v0
  ds_read_b128 v[72:75], v4 offset:13312
  v_mov_b32_dpp v86, v118 row_ror:8 row_mask:0xf bank_mask:0xf
  ds_read_b128 v[76:79], v4 offset:14336
  v_mov_b32_dpp v87, v119 row_ror:8 row_mask:0xf bank_mask:0xf
  v_smfmac_f32_16x16x64_bf16 v[20:23], v[116:119], v[240:247], v0
  s_waitcnt lgkmcnt(3)
  s_barrier
  ds_read_b128 v[100:103], v2 offset:2048
  v_smfmac_f32_16x16x64_bf16 v[24:27], v[116:119], a[0:7], v0
  ds_read_b128 v[120:123], v1 offset:2048
  v_smfmac_f32_16x16x64_bf16 v[20:23], v[84:87], v[248:255], v0
  ds_read_b128 v[80:83], v4 offset:15360
  v_smfmac_f32_16x16x64_bf16 v[24:27], v[84:87], a[8:15], v0
  s_waitcnt lgkmcnt(2)
  ds_read_b128 v[92:95], v2 offset:1024
  v_smfmac_f32_16x16x64_bf16 v[20:23], v[100:103], v[144:151], v0
  ds_read_b128 v[96:99], v1 offset:1024
  v_smfmac_f32_16x16x64_bf16 v[24:27], v[100:103], v[68:75], v0
  s_waitcnt vmcnt(0) lgkmcnt(3)
  ds_read_b128 v[116:119], v2 offset:0
  ds_read_b128 v[124:127], v1 offset:0
  v_smfmac_f32_16x16x64_bf16 v[20:23], v[120:123], v[152:159], v0
  s_waitcnt lgkmcnt(4)
  ds_read_b128 v[104:107], v2 offset:6144
  v_smfmac_f32_16x16x64_bf16 v[24:27], v[120:123], v[76:83], v0
  s_waitcnt lgkmcnt(4)
  ds_read_b128 v[108:111], v1 offset:6144
  ds_read_b128 v[112:115], v2 offset:5120
  ds_read_b128 v[84:87], v1 offset:5120
  ds_read_b128 v[88:91], v2 offset:4096
  ds_read_b128 v[100:103], v1 offset:4096
  ds_read_b128 v[68:71], v4 offset:16384
  ds_read_b128 v[72:75], v4 offset:17408
  ds_read_b128 v[76:79], v4 offset:18432
  ds_read_b128 v[80:83], v4 offset:19456
  v_smfmac_f32_16x16x64_bf16 v[20:23], v[92:95], v[176:183], v0
  s_waitcnt lgkmcnt(12)
  v_smfmac_f32_16x16x64_bf16 v[20:23], v[96:99], v[184:191], v0
  s_waitcnt lgkmcnt(2)
  v_smfmac_f32_16x16x64_bf16 v[20:23], v[116:119], v[68:75], v0
  s_waitcnt lgkmcnt(0)
  ds_read_b128 v[68:71], v4 offset:20480
  v_smfmac_f32_16x16x64_bf16 v[20:23], v[124:127], v[76:83], v0
  ds_read_b128 v[72:75], v4 offset:21504
  v_smfmac_f32_16x16x64_bf16 v[20:23], v[104:107], a[32:39], v0
  ds_read_b128 v[76:79], v4 offset:22528
  v_smfmac_f32_16x16x64_bf16 v[20:23], v[108:111], a[40:47], v0
  ds_read_b128 v[80:83], v4 offset:23552
  v_smfmac_f32_16x16x64_bf16 v[20:23], v[112:115], a[80:87], v0
  v_smfmac_f32_16x16x64_bf16 v[20:23], v[84:87], a[88:95], v0
  v_smfmac_f32_16x16x64_bf16 v[20:23], v[88:91], a[128:135], v0
  v_smfmac_f32_16x16x64_bf16 v[20:23], v[100:103], a[136:143], v0
  s_waitcnt lgkmcnt(2)
  v_smfmac_f32_16x16x64_bf16 v[24:27], v[92:95], v[68:75], v0
  s_waitcnt lgkmcnt(0)
  v_smfmac_f32_16x16x64_bf16 v[24:27], v[96:99], v[76:83], v0
  v_smfmac_f32_16x16x64_bf16 v[24:27], v[116:119], v[208:215], v0
  v_smfmac_f32_16x16x64_bf16 v[24:27], v[124:127], v[216:223], v0
  v_smfmac_f32_16x16x64_bf16 v[24:27], v[104:107], a[48:55], v0
  v_smfmac_f32_16x16x64_bf16 v[24:27], v[108:111], a[56:63], v0
  v_smfmac_f32_16x16x64_bf16 v[24:27], v[112:115], a[96:103], v0
  v_smfmac_f32_16x16x64_bf16 v[24:27], v[84:87], a[104:111], v0
  v_smfmac_f32_16x16x64_bf16 v[24:27], v[88:91], a[144:151], v0
  v_smfmac_f32_16x16x64_bf16 v[24:27], v[100:103], a[152:159], v0
  v_cvt_pk_bf16_f32 v122, v20, v21
  v_cvt_pk_bf16_f32 v123, v22, v23
  s_nop 5
  v_cvt_pk_bf16_f32 v120, v24, v25
  v_cvt_pk_bf16_f32 v121, v26, v27
  buffer_store_dwordx4 v[120:123], v2, s[4:7], s29 offen offset:3072 sc1
  s_branch M_tdone
M_global:
  s_cmp_eq_u32 s13, 1
  s_cbranch_scc1 T_w_91
  s_cmp_eq_u32 s13, 2
  s_cbranch_scc1 T_w_92
  s_cmp_eq_u32 s13, 3
  s_cbranch_scc1 T_w_93
T_w_90:
  s_mov_b32 s19, 0
  s_add_u32 s14, s14, 1
  s_and_b32 s57, s14, 1
  v_mov_b64 v[16:17], 0
  v_mov_b64 v[18:19], 0
  v_mov_b64 v[20:21], 0
  v_mov_b64 v[22:23], 0
  v_mov_b64 v[24:25], 0
  v_mov_b64 v[26:27], 0
  buffer_load_dwordx4 v[124:127], v2, s[4:7], s24 offen offset:0 sc1
  buffer_load_dwordx4 v[116:119], v2, s[4:7], s25 offen offset:0 sc1
  buffer_load_dwordx4 v[124:127], v2, s[4:7], s24 offen offset:0 sc1
  buffer_load_dwordx4 v[116:119], v2, s[4:7], s25 offen offset:0 sc1
  s_branch T_loop_94
.p2align 6
T_retry_95:
  s_mov_b64 exec, vcc
  buffer_load_dwordx4 v[124:127], v2, s[4:7], s24 offen offset:0 sc1
  buffer_load_dwordx4 v[116:119], v2, s[4:7], s25 offen offset:0 sc1
  s_mov_b64 exec, -1
  s_add_u32 s19, s19, 1
  s_cmp_gt_u32 s19, 32768
  s_cbranch_scc1 M_exit
  s_nop 0
  v_mov_b64 v[16:17], 0
  v_mov_b64 v[18:19], 0
T_loop_94:
  s_waitcnt vmcnt(3) lgkmcnt(0)
  v_max3_u32 v123, v124, v125, v126
  v_max_u32 v123, v123, v127
  v_mov_b32_dpp v120, v124 row_ror:8 row_mask:0xf bank_mask:0xf
  v_mov_b32_dpp v121, v125 row_ror:8 row_mask:0xf bank_mask:0xf
  s_waitcnt vmcnt(2)
  v_max3_u32 v123, v123, v116, v117
  v_max3_u32 v123, v123, v118, v119
  v_cmp_eq_u32 vcc, -1, v123
  v_smfmac_f32_16x16x64_bf16 v[16:19], v[124:127], v[68:75], v0
  s_cbranch_vccnz T_retry_95
  ds_write_b128 v2, v[124:127] offset:0
  v_mov_b32_dpp v122, v126 row_ror:8 row_mask:0xf bank_mask:0xf
  v_smfmac_f32_16x16x64_bf16 v[20:23], v[124:127], v[76:83], v0
  s_and_b32 s57, s14, 1
  v_mov_b32_dpp v123, v127 row_ror:8 row_mask:0xf bank_mask:0xf
  v_smfmac_f32_16x16x64_bf16 v[24:27], v[124:127], v[84:91], v0
  s_and_b32 s36, s14, 3
  ds_write_b128 v2, v[116:119] offset:4096
  v_smfmac_f32_16x16x64_bf16 v[16:19], v[120:123], v[92:99], v0
  s_lshl_b32 s36, s36, 13
  v_mov_b32_dpp v84, v116 row_ror:8 row_mask:0xf bank_mask:0xf
  v_smfmac_f32_16x16x64_bf16 v[20:23], v[120:123], v[100:107], v0
  s_add_u32 s26, s36, s23
  ds_read_b128 v[68:71], v4 offset:12288
  v_mov_b32_dpp v85, v117 row_ror:8 row_mask:0xf bank_mask:0xf
  v_smfmac_f32_16x16x64_bf16 v[24:27], v[120:123], v[108:115], v0
  s_add_u32 s36, s36, 8192
  ds_read_b128 v[72:75], v4 offset:13312
  v_mov_b32_dpp v86, v118 row_ror:8 row_mask:0xf bank_mask:0xf
  v_smfmac_f32_16x16x64_bf16 v[16:19], v[116:119], v[224:231], v0
  s_and_b32 s36, s36, 0x7fff
  ds_read_b128 v[76:79], v4 offset:14336
  v_mov_b32_dpp v87, v119 row_ror:8 row_mask:0xf bank_mask:0xf
  v_smfmac_f32_16x16x64_bf16 v[20:23], v[116:119], v[240:247], v0
  s_waitcnt lgkmcnt(3)
  s_barrier
  ds_read_b128 v[100:103], v2 offset:1024
  v_smfmac_f32_16x16x64_bf16 v[24:27], v[116:119], a[0:7], v0
  s_mov_b32 m0, s31
  ds_read_b128 v[120:123], v1 offset:1024
  buffer_load_dwordx4 v9, s[4:7], s27 offen sc1 lds
  v_smfmac_f32_16x16x64_bf16 v[16:19], v[84:87], v[232:239], v0
  s_mov_b32 m0, s32
  v_smfmac_f32_16x16x64_bf16 v[20:23], v[84:87], v[248:255], v0
  ds_read_b128 v[80:83], v4 offset:15360
  v_smfmac_f32_16x16x64_bf16 v[24:27], v[84:87], a[8:15], v0
  s_waitcnt lgkmcnt(2)
  v_smfmac_f32_16x16x64_bf16 v[16:19], v[100:103], v[128:135], v0
  ds_read_b128 v[92:95], v2 offset:2048
  buffer_load_dwordx4 v9, s[4:7], s27 offen offset:128 sc1 lds
  v_smfmac_f32_16x16x64_bf16 v[20:23], v[100:103], v[144:151], v0
  ds_read_b128 v[96:99], v1 offset:2048
  s_mov_b32 m0, s33
  v_smfmac_f32_16x16x64_bf16 v[24:27], v[100:103], v[68:75], v0
  s_waitcnt vmcnt(2) lgkmcnt(3)
  ds_read_b128 v[116:119], v2 offset:3072
  v_smfmac_f32_16x16x64_bf16 v[16:19], v[120:123], v[136:143], v0
  ds_read_b128 v[124:127], v1 offset:3072
  v_smfmac_f32_16x16x64_bf16 v[20:23], v[120:123], v[152:159], v0
  s_waitcnt lgkmcnt(4)
  ds_read_b128 v[104:107], v2 offset:5120
  buffer_load_dwordx4 v10, s[4:7], s28 offen sc1 lds
  v_smfmac_f32_16x16x64_bf16 v[24:27], v[120:123], v[76:83], v0
  s_waitcnt lgkmcnt(4)
  ds_read_b128 v[108:111], v1 offset:5120
  s_mov_b32 m0, s34
  v_smfmac_f32_16x16x64_bf16 v[16:19], v[92:95], v[160:167], v0
  s_waitcnt lgkmcnt(4)
  ds_read_b128 v[112:115], v2 offset:6144
  v_smfmac_f32_16x16x64_bf16 v[16:19], v[96:99], v[168:175], v0
  s_waitcnt lgkmcnt(4)
  ds_read_b128 v[84:87], v1 offset:6144
  v_smfmac_f32_16x16x64_bf16 v[16:19], v[116:119], v[192:199], v0
  s_waitcnt lgkmcnt(4)
  ds_read_b128 v[88:91], v2 offset:7168
  buffer_load_dwordx4 v10, s[4:7], s28 offen offset:256 sc1 lds
  v_smfmac_f32_16x16x64_bf16 v[16:19], v[124:127], v[200:207], v0
  s_waitcnt lgkmcnt(4)
  ds_read_b128 v[100:103], v1 offset:7168
  v_smfmac_f32_16x16x64_bf16 v[16:19], v[104:107], a[16:23], v0
  s_waitcnt lgkmcnt(4)
  ds_read_b128 v[68:71], v4 offset:16384
  v_smfmac_f32_16x16x64_bf16 v[16:19], v[108:111], a[24:31], v0
  s_waitcnt lgkmcnt(4)
  ds_read_b128 v[72:75], v4 offset:17408
  v_smfmac_f32_16x16x64_bf16 v[16:19], v[112:115], a[64:71], v0
  s_waitcnt lgkmcnt(4)
  ds_read_b128 v[76:79], v4 offset:18432
  v_smfmac_f32_16x16x64_bf16 v[16:19], v[84:87], a[72:79], v0
  s_waitcnt lgkmcnt(4)
  ds_read_b128 v[80:83], v4 offset:19456
  v_smfmac_f32_16x16x64_bf16 v[16:19], v[88:91], a[112:119], v0
  s_waitcnt lgkmcnt(4)
  v_smfmac_f32_16x16x64_bf16 v[16:19], v[100:103], a[120:127], v0
  s_add_u32 s24, s36, 145752064
  s_add_u32 s25, s36, 145756160
  v_smfmac_f32_16x16x64_bf16 v[20:23], v[92:95], v[176:183], v0
  s_add_u32 s35, s36, s23
  v_smfmac_f32_16x16x64_bf16 v[20:23], v[96:99], v[184:191], v0
  s_waitcnt lgkmcnt(2)
  v_smfmac_f32_16x16x64_bf16 v[20:23], v[116:119], v[68:75], v0
  s_waitcnt lgkmcnt(0)
  ds_read_b128 v[68:71], v4 offset:20480
  v_mul_f32 v16, s18, v16
  v_smfmac_f32_16x16x64_bf16 v[20:23], v[124:127], v[76:83], v0
  ds_read_b128 v[72:75], v4 offset:21504
  v_mul_f32 v17, s18, v17
  v_smfmac_f32_16x16x64_bf16 v[20:23], v[104:107], a[32:39], v0
  ds_read_b128 v[76:79], v4 offset:22528
  v_mul_f32 v18, s18, v18
  v_smfmac_f32_16x16x64_bf16 v[20:23], v[108:111], a[40:47], v0
  ds_read_b128 v[80:83], v4 offset:23552
  v_mul_f32 v19, s18, v19
  v_smfmac_f32_16x16x64_bf16 v[20:23], v[112:115], a[80:87], v0
  v_cvt_pk_bf16_f32 v120, v16, v17
  v_smfmac_f32_16x16x64_bf16 v[20:23], v[84:87], a[88:95], v0
  v_cvt_pk_bf16_f32 v121, v18, v19
  v_smfmac_f32_16x16x64_bf16 v[20:23], v[88:91], a[128:135], v0
  ds_write_b64 v5, v[120:121] offset:24576
  v_smfmac_f32_16x16x64_bf16 v[20:23], v[100:103], a[136:143], v0
  s_waitcnt lgkmcnt(3)
  v_smfmac_f32_16x16x64_bf16 v[24:27], v[92:95], v[68:75], v0
  s_waitcnt lgkmcnt(1)
  v_mov_b64 v[92:93], 0
  v_smfmac_f32_16x16x64_bf16 v[24:27], v[96:99], v[76:83], v0
  s_nop 1
  v_cvt_pk_bf16_f32 v122, v20, v21
  v_cvt_pk_bf16_f32 v123, v22, v23
  v_smfmac_f32_16x16x64_bf16 v[24:27], v[116:119], v[208:215], v0
  ds_write_b64 v5, v[122:123] offset:26880
  v_mov_b64 v[94:95], 0
  v_smfmac_f32_16x16x64_bf16 v[24:27], v[124:127], v[216:223], v0
  s_waitcnt lgkmcnt(1)
  s_barrier
  ds_read_b64_tr_b16 v[68:69], v6 offset:24576
  v_smfmac_f32_16x16x64_bf16 v[24:27], v[104:107], a[48:55], v0
  s_add_u32 s27, s27, 8192
  ds_read_b64_tr_b16 v[70:71], v6 offset:24640
  ds_read_b64_tr_b16 v[72:73], v6 offset:24832
  v_smfmac_f32_16x16x64_bf16 v[24:27], v[108:111], a[56:63], v0
  s_add_u32 s28, s28, 8192
  ds_read_b64_tr_b16 v[74:75], v6 offset:24896
  ds_read_b64_tr_b16 v[76:77], v6 offset:25088
  v_smfmac_f32_16x16x64_bf16 v[24:27], v[112:115], a[96:103], v0
  s_nop 0
  ds_read_b64_tr_b16 v[78:79], v6 offset:25152
  ds_read_b64_tr_b16 v[80:81], v6 offset:25344
  v_smfmac_f32_16x16x64_bf16 v[24:27], v[84:87], a[104:111], v0
  ds_read_b64_tr_b16 v[82:83], v6 offset:25408
  v_mov_b64 v[96:97], 0
  v_smfmac_f32_16x16x64_bf16 v[24:27], v[88:91], a[144:151], v0
  s_waitcnt lgkmcnt(8)
  s_barrier
  ds_read_b64_tr_b16 v[116:117], v6 offset:26880
  v_smfmac_f32_16x16x64_bf16 v[24:27], v[100:103], a[152:159], v0
  s_waitcnt lgkmcnt(7)
  ds_read_b64_tr_b16 v[118:119], v6 offset:26944
  v_mfma_f32_16x16x32_bf16 v[16:19], v[36:39], v[68:71], 0
  s_waitcnt lgkmcnt(6)
  ds_read_b64_tr_b16 v[124:125], v6 offset:27136
  ds_read_b64_tr_b16 v[126:127], v6 offset:27200
  v_mfma_f32_16x16x32_bf16 v[16:19], v[40:43], v[72:75], v[16:19]
  s_waitcnt lgkmcnt(6)
  ds_read_b64_tr_b16 v[104:105], v6 offset:27392
  ds_read_b64_tr_b16 v[106:107], v6 offset:27456
  v_mfma_f32_16x16x32_bf16 v[16:19], v[44:47], v[76:79], v[16:19]
  s_waitcnt lgkmcnt(6)
  ds_read_b64_tr_b16 v[108:109], v6 offset:27648
  ds_read_b64_tr_b16 v[110:111], v6 offset:27712
  v_mfma_f32_16x16x32_bf16 v[16:19], v[48:51], v[80:83], v[16:19]
  s_waitcnt lgkmcnt(6)
  v_cvt_pk_bf16_f32 v120, v24, v25
  v_cvt_pk_bf16_f32 v121, v26, v27
  v_mfma_f32_16x16x32_bf16 v[112:115], v[116:119], v[68:71], 0
  s_waitcnt lgkmcnt(4)
  buffer_store_dwordx4 v[120:123], v2, s[4:7], s29 offen offset:0 sc1
  v_mov_b64 v[98:99], 0
  v_mfma_f32_16x16x32_bf16 v[112:115], v[124:127], v[72:75], v[112:115]
  s_waitcnt lgkmcnt(2)
  v_mov_b64 v[36:37], 0
  v_exp_f32 v100, v16
  v_mfma_f32_16x16x32_bf16 v[112:115], v[104:107], v[76:79], v[112:115]
  s_waitcnt lgkmcnt(0)
  v_exp_f32 v101, v17
  v_mfma_f32_16x16x32_bf16 v[112:115], v[108:111], v[80:83], v[112:115]
  v_exp_f32 v102, v18
  v_mfma_f32_16x16x32_bf16 v[20:23], v[52:55], v[68:71], 0
  v_exp_f32 v103, v19
  v_mfma_f32_16x16x32_bf16 v[20:23], v[56:59], v[72:75], v[20:23]
  v_cvt_pk_bf16_f32 v44, v100, v101
  v_cvt_pk_bf16_f32 v45, v102, v103
  v_mfma_f32_16x16x32_bf16 v[20:23], v[60:63], v[76:79], v[20:23]
  s_add_u32 s29, s29, 131072
  v_exp_f32 v100, v112
  v_mfma_f32_16x16x32_bf16 v[20:23], v[64:67], v[80:83], v[20:23]
  v_exp_f32 v101, v113
  v_exp_f32 v102, v114
  v_exp_f32 v103, v115
  v_cvt_pk_bf16_f32 v84, v100, v101
  v_cvt_pk_bf16_f32 v85, v102, v103
  v_cndmask_b32 v48, v84, 0, s[16:17]
  v_cndmask_b32 v49, v85, 0, s[16:17]
  v_cndmask_b32 v50, 0, v84, s[16:17]
  v_cndmask_b32 v51, 0, v85, s[16:17]
  v_exp_f32 v100, v20
  v_mfma_f32_16x16x16_bf16 v[88:91], v[12:13], v[48:49], 0
  v_exp_f32 v101, v21
  v_mfma_f32_16x16x16_bf16 v[24:27], v[120:121], v[48:49], 0
  v_exp_f32 v102, v22
  v_mfma_f32_16x16x16_bf16 v[116:119], v[120:121], v[50:51], 0
  v_exp_f32 v103, v23
  v_cvt_pk_bf16_f32 v46, v100, v101
  v_cvt_pk_bf16_f32 v47, v102, v103
  v_mov_b64 v[38:39], 0
  s_nop 0
  v_mfma_f32_16x16x32_bf16 v[88:91], v[12:15], v[44:47], v[88:91]
  v_mov_b64 v[40:41], 0
  v_mov_b64 v[42:43], 0
  v_mfma_f32_16x16x32_bf16 v[24:27], v[28:31], v[44:47], v[24:27]
  ds_read_b128 v[52:55], v4 offset:24576
  ds_read_b128 v[56:59], v4 offset:25600
  v_mfma_f32_16x16x32_bf16 v[116:119], v[32:35], v[44:47], v[116:119]
  s_nop 1
T_back_102:
  v_rcp_f32 v89, v88
  v_subrev_u32 v100, s54, v88
  v_cmp_le_u32 vcc, s96, v100
  v_mul_f32 v24, v89, v24
  v_mul_f32 v25, v89, v25
  v_cvt_pk_bf16_f32 v124, v24, v25
  v_pk_mul_f32 v[26:27], v[26:27], v[88:89] op_sel:[0,1] op_sel_hi:[1,1]
  v_pk_mul_f32 v[116:117], v[116:117], v[88:89] op_sel:[0,1] op_sel_hi:[1,1]
  v_pk_mul_f32 v[118:119], v[118:119], v[88:89] op_sel:[0,1] op_sel_hi:[1,1]
  v_cvt_pk_bf16_f32 v125, v26, v27
  v_cvt_pk_bf16_f32 v126, v116, v117
  v_cvt_pk_bf16_f32 v127, v118, v119
  ds_write_b128 v11, v[124:127] offset:29184
  s_cbranch_vccnz T_slow_101
  v_smfmac_f32_16x16x64_bf16 v[92:95], v[124:127], a[160:167], v0
  s_mov_b32 s96, s55
  v_smfmac_f32_16x16x64_bf16 v[96:99], v[124:127], a[168:175], v0
  v_smfmac_f32_16x16x64_bf16 v[36:39], v[124:127], a[176:183], v0
  s_waitcnt lgkmcnt(0)
  s_barrier
  ds_read_b128 v[104:107], v11 offset:29696
  ds_read_b128 v[108:111], v11 offset:30208
  ds_read_b128 v[68:71], v11 offset:30720
  v_smfmac_f32_16x16x64_bf16 v[40:43], v[124:127], a[184:191], v0
  s_waitcnt lgkmcnt(2)
  v_smfmac_f32_16x16x64_bf16 v[92:95], v[104:107], a[192:199], v0
  s_waitcnt lgkmcnt(1)
  ds_read_b128 v[76:79], v4 offset:28672
  v_smfmac_f32_16x16x64_bf16 v[92:95], v[108:111], a[224:231], v0
  s_waitcnt lgkmcnt(1)
  ds_read_b128 v[80:83], v4 offset:29696
  v_smfmac_f32_16x16x64_bf16 v[92:95], v[68:71], a[240:247], v0
  ds_read_b128 v[60:63], v4 offset:26624
  v_smfmac_f32_16x16x64_bf16 v[96:99], v[104:107], a[200:207], v0
  ds_read_b128 v[64:67], v4 offset:27648
  v_smfmac_f32_16x16x64_bf16 v[96:99], v[108:111], a[232:239], v0
  ds_read_b128 v[28:31], v4 offset:30720
  s_nop 0
  v_cvt_pk_bf16_f32 v16, v92, v93
  v_cvt_pk_bf16_f32 v17, v94, v95
  v_bfi_b32 v16, 1, s57, v16
  v_smfmac_f32_16x16x64_bf16 v[96:99], v[68:71], a[248:255], v0
  buffer_store_dwordx2 v[16:17], v7, s[4:7], s20 offen offset:0 sc1
  v_smfmac_f32_16x16x64_bf16 v[36:39], v[104:107], a[208:215], v0
  ds_read_b128 v[32:35], v4 offset:31744
  v_smfmac_f32_16x16x64_bf16 v[36:39], v[108:111], v[52:59], v0
  s_waitcnt lgkmcnt(4)
  s_nop 0
  v_cvt_pk_bf16_f32 v18, v96, v97
  v_cvt_pk_bf16_f32 v19, v98, v99
  v_bfi_b32 v18, 1, s57, v18
  v_smfmac_f32_16x16x64_bf16 v[36:39], v[68:71], v[76:83], v0
  buffer_store_dwordx2 v[18:19], v7, s[4:7], s20 offen offset:64 sc1
  v_smfmac_f32_16x16x64_bf16 v[40:43], v[104:107], a[216:223], v0
  s_waitcnt lgkmcnt(2)
  ds_read_b128 v[116:119], v2 offset:31232
  v_smfmac_f32_16x16x64_bf16 v[40:43], v[108:111], v[60:67], v0
  s_waitcnt lgkmcnt(1)
  s_nop 0
  v_cvt_pk_bf16_f32 v20, v36, v37
  v_cvt_pk_bf16_f32 v21, v38, v39
  v_bfi_b32 v20, 1, s57, v20
  v_smfmac_f32_16x16x64_bf16 v[40:43], v[68:71], v[28:35], v0
  buffer_store_dwordx2 v[20:21], v7, s[4:7], s21 offen offset:0 sc1
  s_nop 6
  v_cvt_pk_bf16_f32 v22, v40, v41
  v_cvt_pk_bf16_f32 v23, v42, v43
  v_bfi_b32 v22, 1, s57, v22
  buffer_store_dwordx2 v[22:23], v7, s[4:7], s21 offen offset:64 sc1
  ds_read_b128 v[68:71], v4 offset:0
  ds_read_b128 v[72:75], v4 offset:1024
  ds_read_b128 v[76:79], v4 offset:4096
  ds_read_b128 v[80:83], v4 offset:5120
  ds_read_b128 v[84:87], v4 offset:8192
  ds_read_b128 v[88:91], v4 offset:9216
  v_mov_b64 v[16:17], 0
  v_mov_b64 v[18:19], 0
  v_mov_b64 v[20:21], 0
  v_mov_b64 v[22:23], 0
  v_mov_b64 v[24:25], 0
  v_mov_b64 v[26:27], 0
  s_mov_b32 s19, 0
  v_mov_b32 v49, -1
  s_waitcnt vmcnt(2)
  buffer_load_dwordx4 v[52:55], v2, s[4:7], s22 offen offset:0 sc1
  buffer_load_dwordx4 v[56:59], v2, s[4:7], s22 offen offset:1024 sc1
  buffer_load_dwordx4 v[60:63], v2, s[4:7], s22 offen offset:2048 sc1
  buffer_load_dwordx4 v[64:67], v2, s[4:7], s22 offen offset:3072 sc1
  ds_read_b128 v[92:95], v4 offset:2048
  ds_read_b128 v[96:99], v4 offset:3072
  ds_read_b128 v[100:103], v4 offset:6144
  ds_read_b128 v[104:107], v4 offset:7168
  ds_read_b128 v[108:111], v4 offset:10240
  ds_read_b128 v[112:115], v4 offset:11264
  ds_read_b64 v[44:45], v2 offset:32256
  s_waitcnt lgkmcnt(0)
  v_readfirstlane_b32 s38, v44
  v_readfirstlane_b32 s37, v45
  s_nop 0
  s_lshl_b32 s38, s38, 1
  s_lshl1_add_u32 s37, s37, 1
  s_min_u32 s38, s38, s37
  s_cmp_ge_u32 s38, 64
  s_cselect_b32 s38, 100, s38
  s_sub_u32 s38, s38, 1
  s_max_i32 s30, s30, s38
  s_waitcnt lgkmcnt(12)
  s_waitcnt vmcnt(3)
  v_mfma_f32_16x16x32_bf16 v[120:123], v[116:119], v[52:55], 0
  v_xor_b32 v48, s57, v52
  v_bitop3_b32 v48, v48, v54, s57 bitop3:0xf6
  s_waitcnt vmcnt(2)
  v_mfma_f32_16x16x32_bf16 v[120:123], v[116:119], v[56:59], v[120:123]
  v_bitop3_b32 v48, v48, v56, s57 bitop3:0xf6
  v_bitop3_b32 v48, v48, v58, s57 bitop3:0xf6
  s_waitcnt vmcnt(1)
  v_mfma_f32_16x16x32_bf16 v[120:123], v[116:119], v[60:63], v[120:123]
  v_bitop3_b32 v48, v48, v60, s57 bitop3:0xf6
  v_bitop3_b32 v48, v48, v62, s57 bitop3:0xf6
  s_waitcnt vmcnt(0)
  v_mfma_f32_16x16x32_bf16 v[120:123], v[116:119], v[64:67], v[120:123]
  v_bitop3_b32 v48, v48, v64, s57 bitop3:0xf6
  v_bitop3_b32 v48, v48, v66, s57 bitop3:0xf6
  v_and_b32 v48, 1, v48
  v_cmp_ne_u32 vcc, 0, v48
  s_cbranch_vccnz T_p1re_104
T_p1ok_105:
  s_nop 2
  v_add_f32_dpp v120, v120, v120 row_ror:8 row_mask:0xf bank_mask:0xf
  v_add_f32_dpp v121, v121, v121 row_ror:8 row_mask:0xf bank_mask:0xf
  v_cvt_pk_bf16_f32 v48, v120, v121
  buffer_store_dword v48, v8, s[4:7], s35 offen sc1
  buffer_store_dword v49, v8, s[4:7], s26 offen sc1
  s_barrier
  ds_read_b128 v[28:31], v2 offset:16384
  ds_read_b128 v[32:35], v2 offset:20480
  ds_read_b128 v[36:39], v2 offset:8192
  ds_read_b128 v[40:43], v2 offset:9216
  ds_read_b128 v[44:47], v2 offset:10240
  ds_read_b128 v[48:51], v2 offset:11264
  buffer_load_dwordx4 v[124:127], v2, s[4:7], s24 offen offset:0 sc1
  buffer_load_dwordx4 v[116:119], v2, s[4:7], s25 offen offset:0 sc1
  ds_read_b128 v[52:55], v2 offset:12288
  ds_read_b128 v[56:59], v2 offset:13312
  ds_read_b128 v[60:63], v2 offset:14336
  ds_read_b128 v[64:67], v2 offset:15360
  buffer_load_dwordx4 v[124:127], v2, s[4:7], s24 offen offset:0 sc1
  buffer_load_dwordx4 v[116:119], v2, s[4:7], s25 offen offset:0 sc1
  s_add_u32 s14, s14, 1
  s_cmp_ge_i32 s14, s30
  s_cbranch_scc1 T_kvw_98
T_kvb_99:
  s_mov_b32 s19, 0
  s_cmp_lg_u32 s14, 63
  s_cbranch_scc1 T_loop_94
  s_branch T_last_100
T_p1re_104:
  s_mov_b64 exec, vcc
  buffer_load_dwordx4 v[52:55], v2, s[4:7], s22 offen offset:0 sc1
  buffer_load_dwordx4 v[56:59], v2, s[4:7], s22 offen offset:1024 sc1
  buffer_load_dwordx4 v[60:63], v2, s[4:7], s22 offen offset:2048 sc1
  buffer_load_dwordx4 v[64:67], v2, s[4:7], s22 offen offset:3072 sc1
  s_mov_b64 exec, -1
  s_add_u32 s19, s19, 1
  s_cmp_gt_u32 s19, 32768
  s_cbranch_scc1 M_exit
  s_waitcnt vmcnt(3)
  v_mfma_f32_16x16x32_bf16 v[120:123], v[116:119], v[52:55], 0
  v_xor_b32 v48, s57, v52
  v_bitop3_b32 v48, v48, v54, s57 bitop3:0xf6
  s_waitcnt vmcnt(2)
  v_mfma_f32_16x16x32_bf16 v[120:123], v[116:119], v[56:59], v[120:123]
  v_bitop3_b32 v48, v48, v56, s57 bitop3:0xf6
  v_bitop3_b32 v48, v48, v58, s57 bitop3:0xf6
  s_waitcnt vmcnt(1)
  v_mfma_f32_16x16x32_bf16 v[120:123], v[116:119], v[60:63], v[120:123]
  v_bitop3_b32 v48, v48, v60, s57 bitop3:0xf6
  v_bitop3_b32 v48, v48, v62, s57 bitop3:0xf6
  s_waitcnt vmcnt(0)
  v_mfma_f32_16x16x32_bf16 v[120:123], v[116:119], v[64:67], v[120:123]
  v_bitop3_b32 v48, v48, v64, s57 bitop3:0xf6
  v_bitop3_b32 v48, v48, v66, s57 bitop3:0xf6
  v_and_b32 v48, 1, v48
  v_cmp_ne_u32 vcc, 0, v48
  s_cbranch_vccnz T_p1re_104
  s_branch T_p1ok_105
T_kvw_98:
  s_mov_b32 s19, 0
  s_branch T_kvok_107
T_kv_106:
  s_sleep 4
  s_add_u32 s19, s19, 1
  s_cmp_gt_u32 s19, 32768
  s_cbranch_scc1 M_exit
T_kvok_107:
  s_add_u32 s39, s99, 128
  s_mov_b32 s38, 0
  s_mov_b32 s37, 0
  s_atomic_or s38, s[58:59], s99 glc
  s_atomic_or s37, s[58:59], s39 glc
  s_waitcnt lgkmcnt(0)
  s_lshl_b32 s38, s38, 1
  s_lshl1_add_u32 s37, s37, 1
  s_min_u32 s38, s38, s37
  s_cmp_ge_u32 s38, 64
  s_cselect_b32 s38, 100, s38
  s_sub_u32 s38, s38, 1
  s_max_i32 s30, s30, s38
  s_cmp_ge_i32 s14, s30
  s_cbranch_scc1 T_kv_106
  s_branch T_kvb_99
T_slow_101:
  s_nop 7
  v_max3_f32 v100, v16, v17, v18
  v_max3_f32 v100, v100, v19, v20
  v_max3_f32 v100, v100, v21, v22
  v_max3_f32 v100, v100, v23, v112
  v_max3_f32 v100, v100, v113, v114
  v_max_f32 v100, v100, v115
  v_mov_b32 v101, v100
  s_nop 1
  v_permlane32_swap_b32 v100, v101
  s_nop 1
  v_max_f32 v100, v100, v101
  v_mov_b32 v101, v100
  s_nop 1
  v_permlane16_swap_b32 v100, v101
  s_nop 1
  v_max_f32 v100, v100, v101
  v_sub_f32 v16, v16, v100
  v_sub_f32 v17, v17, v100
  v_sub_f32 v18, v18, v100
  v_sub_f32 v19, v19, v100
  v_exp_f32 v16, v16
  v_exp_f32 v17, v17
  v_exp_f32 v18, v18
  v_exp_f32 v19, v19
  v_sub_f32 v20, v20, v100
  v_sub_f32 v21, v21, v100
  v_sub_f32 v22, v22, v100
  v_sub_f32 v23, v23, v100
  v_exp_f32 v20, v20
  v_exp_f32 v21, v21
  v_exp_f32 v22, v22
  v_exp_f32 v23, v23
  v_sub_f32 v112, v112, v100
  v_sub_f32 v113, v113, v100
  v_sub_f32 v114, v114, v100
  v_sub_f32 v115, v115, v100
  v_exp_f32 v112, v112
  v_exp_f32 v113, v113
  v_exp_f32 v114, v114
  v_exp_f32 v115, v115
  s_nop 0
  v_cvt_pk_bf16_f32 v44, v16, v17
  v_cvt_pk_bf16_f32 v45, v18, v19
  v_cvt_pk_bf16_f32 v46, v20, v21
  v_cvt_pk_bf16_f32 v47, v22, v23
  v_cvt_pk_bf16_f32 v84, v112, v113
  v_cvt_pk_bf16_f32 v85, v114, v115
  v_cndmask_b32 v48, v84, 0, s[16:17]
  v_cndmask_b32 v49, v85, 0, s[16:17]
  v_cndmask_b32 v50, 0, v84, s[16:17]
  v_cndmask_b32 v51, 0, v85, s[16:17]
  s_nop 1
  v_mfma_f32_16x16x16_bf16 v[88:91], v[12:13], v[48:49], 0
  v_mfma_f32_16x16x16_bf16 v[24:27], v[120:121], v[48:49], 0
  v_mfma_f32_16x16x16_bf16 v[116:119], v[120:121], v[50:51], 0
  v_mfma_f32_16x16x32_bf16 v[88:91], v[12:15], v[44:47], v[88:91]
  v_mfma_f32_16x16x32_bf16 v[24:27], v[28:31], v[44:47], v[24:27]
  v_mfma_f32_16x16x32_bf16 v[116:119], v[32:35], v[44:47], v[116:119]
  s_nop 7
  s_nop 1
  s_mov_b32 s96, -1
  s_branch T_back_102
.p2align 6
T_retry_108:
  s_mov_b64 exec, vcc
  buffer_load_dwordx4 v[124:127], v2, s[4:7], s24 offen offset:0 sc1
  buffer_load_dwordx4 v[116:119], v2, s[4:7], s25 offen offset:0 sc1
  s_mov_b64 exec, -1
  s_add_u32 s19, s19, 1
  s_cmp_gt_u32 s19, 32768
  s_cbranch_scc1 M_exit
T_last_100:
  s_waitcnt vmcnt(3) lgkmcnt(0)
  v_max3_u32 v123, v124, v125, v126
  v_max_u32 v123, v123, v127
  v_mov_b32_dpp v120, v124 row_ror:8 row_mask:0xf bank_mask:0xf
  v_mov_b32_dpp v121, v125 row_ror:8 row_mask:0xf bank_mask:0xf
  s_waitcnt vmcnt(2)
  v_max3_u32 v123, v123, v116, v117
  v_max3_u32 v123, v123, v118, v119
  v_cmp_eq_u32 vcc, -1, v123
  s_cbranch_vccnz T_retry_108
  v_smfmac_f32_16x16x64_bf16 v[20:23], v[124:127], v[76:83], v0
  ds_write_b128 v2, v[124:127] offset:0
  v_mov_b32_dpp v122, v126 row_ror:8 row_mask:0xf bank_mask:0xf
  v_mov_b32_dpp v123, v127 row_ror:8 row_mask:0xf bank_mask:0xf
  v_smfmac_f32_16x16x64_bf16 v[24:27], v[124:127], v[84:91], v0
  ds_write_b128 v2, v[116:119] offset:4096
  v_mov_b32_dpp v84, v116 row_ror:8 row_mask:0xf bank_mask:0xf
  v_smfmac_f32_16x16x64_bf16 v[20:23], v[120:123], v[100:107], v0
  ds_read_b128 v[68:71], v4 offset:12288
  v_mov_b32_dpp v85, v117 row_ror:8 row_mask:0xf bank_mask:0xf
  v_smfmac_f32_16x16x64_bf16 v[24:27], v[120:123], v[108:115], v0
  ds_read_b128 v[72:75], v4 offset:13312
  v_mov_b32_dpp v86, v118 row_ror:8 row_mask:0xf bank_mask:0xf
  ds_read_b128 v[76:79], v4 offset:14336
  v_mov_b32_dpp v87, v119 row_ror:8 row_mask:0xf bank_mask:0xf
  v_smfmac_f32_16x16x64_bf16 v[20:23], v[116:119], v[240:247], v0
  s_waitcnt lgkmcnt(3)
  s_barrier
  ds_read_b128 v[100:103], v2 offset:1024
  v_smfmac_f32_16x16x64_bf16 v[24:27], v[116:119], a[0:7], v0
  ds_read_b128 v[120:123], v1 offset:1024
  v_smfmac_f32_16x16x64_bf16 v[20:23], v[84:87], v[248:255], v0
  ds_read_b128 v[80:83], v4 offset:15360
  v_smfmac_f32_16x16x64_bf16 v[24:27], v[84:87], a[8:15], v0
  s_waitcnt lgkmcnt(2)
  ds_read_b128 v[92:95], v2 offset:2048
  v_smfmac_f32_16x16x64_bf16 v[20:23], v[100:103], v[144:151], v0
  ds_read_b128 v[96:99], v1 offset:2048
  v_smfmac_f32_16x16x64_bf16 v[24:27], v[100:103], v[68:75], v0
  s_waitcnt vmcnt(0) lgkmcnt(3)
  ds_read_b128 v[116:119], v2 offset:3072
  ds_read_b128 v[124:127], v1 offset:3072
  v_smfmac_f32_16x16x64_bf16 v[20:23], v[120:123], v[152:159], v0
  s_waitcnt lgkmcnt(4)
  ds_read_b128 v[104:107], v2 offset:5120
  v_smfmac_f32_16x16x64_bf16 v[24:27], v[120:123], v[76:83], v0
  s_waitcnt lgkmcnt(4)
  ds_read_b128 v[108:111], v1 offset:5120
  ds_read_b128 v[112:115], v2 offset:6144
  ds_read_b128 v[84:87], v1 offset:6144
  ds_read_b128 v[88:91], v2 offset:7168
  ds_read_b128 v[100:103], v1 offset:7168
  ds_read_b128 v[68:71], v4 offset:16384
  ds_read_b128 v[72:75], v4 offset:17408
  ds_read_b128 v[76:79], v4 offset:18432
  ds_read_b128 v[80:83], v4 offset:19456
  v_smfmac_f32_16x16x64_bf16 v[20:23], v[92:95], v[176:183], v0
  s_waitcnt lgkmcnt(12)
  v_smfmac_f32_16x16x64_bf16 v[20:23], v[96:99], v[184:191], v0
  s_waitcnt lgkmcnt(2)
  v_smfmac_f32_16x16x64_bf16 v[20:23], v[116:119], v[68:75], v0
  s_waitcnt lgkmcnt(0)
  ds_read_b128 v[68:71], v4 offset:20480
  v_smfmac_f32_16x16x64_bf16 v[20:23], v[124:127], v[76:83], v0
  ds_read_b128 v[72:75], v4 offset:21504
  v_smfmac_f32_16x16x64_bf16 v[20:23], v[104:107], a[32:39], v0
  ds_read_b128 v[76:79], v4 offset:22528
  v_smfmac_f32_16x16x64_bf16 v[20:23], v[108:111], a[40:47], v0
  ds_read_b128 v[80:83], v4 offset:23552
  v_smfmac_f32_16x16x64_bf16 v[20:23], v[112:115], a[80:87], v0
  v_smfmac_f32_16x16x64_bf16 v[20:23], v[84:87], a[88:95], v0
  v_smfmac_f32_16x16x64_bf16 v[20:23], v[88:91], a[128:135], v0
  v_smfmac_f32_16x16x64_bf16 v[20:23], v[100:103], a[136:143], v0
  s_waitcnt lgkmcnt(2)
  v_smfmac_f32_16x16x64_bf16 v[24:27], v[92:95], v[68:75], v0
  s_waitcnt lgkmcnt(0)
  v_smfmac_f32_16x16x64_bf16 v[24:27], v[96:99], v[76:83], v0
  v_smfmac_f32_16x16x64_bf16 v[24:27], v[116:119], v[208:215], v0
  v_smfmac_f32_16x16x64_bf16 v[24:27], v[124:127], v[216:223], v0
  v_smfmac_f32_16x16x64_bf16 v[24:27], v[104:107], a[48:55], v0
  v_smfmac_f32_16x16x64_bf16 v[24:27], v[108:111], a[56:63], v0
  v_smfmac_f32_16x16x64_bf16 v[24:27], v[112:115], a[96:103], v0
  v_smfmac_f32_16x16x64_bf16 v[24:27], v[84:87], a[104:111], v0
  v_smfmac_f32_16x16x64_bf16 v[24:27], v[88:91], a[144:151], v0
  v_smfmac_f32_16x16x64_bf16 v[24:27], v[100:103], a[152:159], v0
  v_cvt_pk_bf16_f32 v122, v20, v21
  v_cvt_pk_bf16_f32 v123, v22, v23
  s_nop 5
  v_cvt_pk_bf16_f32 v120, v24, v25
  v_cvt_pk_bf16_f32 v121, v26, v27
  buffer_store_dwordx4 v[120:123], v2, s[4:7], s29 offen offset:0 sc1
  s_branch M_tdone
T_w_91:
  s_mov_b32 s19, 0
  s_add_u32 s14, s14, 1
  s_and_b32 s57, s14, 1
  v_mov_b64 v[16:17], 0
  v_mov_b64 v[18:19], 0
  v_mov_b64 v[20:21], 0
  v_mov_b64 v[22:23], 0
  v_mov_b64 v[24:25], 0
  v_mov_b64 v[26:27], 0
  buffer_load_dwordx4 v[124:127], v2, s[4:7], s24 offen offset:1024 sc1
  buffer_load_dwordx4 v[116:119], v2, s[4:7], s25 offen offset:1024 sc1
  buffer_load_dwordx4 v[124:127], v2, s[4:7], s24 offen offset:1024 sc1
  buffer_load_dwordx4 v[116:119], v2, s[4:7], s25 offen offset:1024 sc1
  s_branch T_loop_113
.p2align 6
T_retry_114:
  s_mov_b64 exec, vcc
  buffer_load_dwordx4 v[124:127], v2, s[4:7], s24 offen offset:1024 sc1
  buffer_load_dwordx4 v[116:119], v2, s[4:7], s25 offen offset:1024 sc1
  s_mov_b64 exec, -1
  s_add_u32 s19, s19, 1
  s_cmp_gt_u32 s19, 32768
  s_cbranch_scc1 M_exit
  s_nop 0
  v_mov_b64 v[16:17], 0
  v_mov_b64 v[18:19], 0
T_loop_113:
  s_waitcnt vmcnt(3) lgkmcnt(0)
  v_max3_u32 v123, v124, v125, v126
  v_max_u32 v123, v123, v127
  v_mov_b32_dpp v120, v124 row_ror:8 row_mask:0xf bank_mask:0xf
  v_mov_b32_dpp v121, v125 row_ror:8 row_mask:0xf bank_mask:0xf
  s_waitcnt vmcnt(2)
  v_max3_u32 v123, v123, v116, v117
  v_max3_u32 v123, v123, v118, v119
  v_cmp_eq_u32 vcc, -1, v123
  v_smfmac_f32_16x16x64_bf16 v[16:19], v[124:127], v[68:75], v0
  s_cbranch_vccnz T_retry_114
  ds_write_b128 v2, v[124:127] offset:1024
  v_mov_b32_dpp v122, v126 row_ror:8 row_mask:0xf bank_mask:0xf
  v_smfmac_f32_16x16x64_bf16 v[20:23], v[124:127], v[76:83], v0
  s_and_b32 s57, s14, 1
  v_mov_b32_dpp v123, v127 row_ror:8 row_mask:0xf bank_mask:0xf
  v_smfmac_f32_16x16x64_bf16 v[24:27], v[124:127], v[84:91], v0
  s_and_b32 s36, s14, 3
  ds_write_b128 v2, v[116:119] offset:5120
  v_smfmac_f32_16x16x64_bf16 v[16:19], v[120:123], v[92:99], v0
  s_lshl_b32 s36, s36, 13
  v_mov_b32_dpp v84, v116 row_ror:8 row_mask:0xf bank_mask:0xf
  v_smfmac_f32_16x16x64_bf16 v[20:23], v[120:123], v[100:107], v0
  s_add_u32 s26, s36, s23
  ds_read_b128 v[68:71], v4 offset:12288
  v_mov_b32_dpp v85, v117 row_ror:8 row_mask:0xf bank_mask:0xf
  v_smfmac_f32_16x16x64_bf16 v[24:27], v[120:123], v[108:115], v0
  s_add_u32 s36, s36, 8192
  ds_read_b128 v[72:75], v4 offset:13312
  v_mov_b32_dpp v86, v118 row_ror:8 row_mask:0xf bank_mask:0xf
  v_smfmac_f32_16x16x64_bf16 v[16:19], v[116:119], v[224:231], v0
  s_and_b32 s36, s36, 0x7fff
  ds_read_b128 v[76:79], v4 offset:14336
  v_mov_b32_dpp v87, v119 row_ror:8 row_mask:0xf bank_mask:0xf
  v_smfmac_f32_16x16x64_bf16 v[20:23], v[116:119], v[240:247], v0
  s_waitcnt lgkmcnt(3)
  s_barrier
  ds_read_b128 v[100:103], v2 offset:0
  v_smfmac_f32_16x16x64_bf16 v[24:27], v[116:119], a[0:7], v0
  s_mov_b32 m0, s31
  ds_read_b128 v[120:123], v1 offset:0
  v_smfmac_f32_16x16x64_bf16 v[16:19], v[84:87], v[232:239], v0
  buffer_load_dwordx4 v9, s[4:7], s27 offen sc1 lds
  v_smfmac_f32_16x16x64_bf16 v[20:23], v[84:87], v[248:255], v0
  ds_read_b128 v[80:83], v4 offset:15360
  s_mov_b32 m0, s32
  v_smfmac_f32_16x16x64_bf16 v[24:27], v[84:87], a[8:15], v0
  s_waitcnt lgkmcnt(2)
  v_smfmac_f32_16x16x64_bf16 v[16:19], v[100:103], v[128:135], v0
  ds_read_b128 v[92:95], v2 offset:3072
  v_smfmac_f32_16x16x64_bf16 v[20:23], v[100:103], v[144:151], v0
  ds_read_b128 v[96:99], v1 offset:3072
  buffer_load_dwordx4 v9, s[4:7], s27 offen offset:128 sc1 lds
  v_smfmac_f32_16x16x64_bf16 v[24:27], v[100:103], v[68:75], v0
  s_waitcnt vmcnt(2) lgkmcnt(3)
  ds_read_b128 v[116:119], v2 offset:2048
  s_mov_b32 m0, s33
  v_smfmac_f32_16x16x64_bf16 v[16:19], v[120:123], v[136:143], v0
  ds_read_b128 v[124:127], v1 offset:2048
  v_smfmac_f32_16x16x64_bf16 v[20:23], v[120:123], v[152:159], v0
  s_waitcnt lgkmcnt(4)
  ds_read_b128 v[104:107], v2 offset:4096
  v_smfmac_f32_16x16x64_bf16 v[24:27], v[120:123], v[76:83], v0
  s_waitcnt lgkmcnt(4)
  ds_read_b128 v[108:111], v1 offset:4096
  buffer_load_dwordx4 v10, s[4:7], s28 offen sc1 lds
  v_smfmac_f32_16x16x64_bf16 v[16:19], v[92:95], v[160:167], v0
  s_waitcnt lgkmcnt(4)
  ds_read_b128 v[112:115], v2 offset:7168
  s_mov_b32 m0, s34
  v_smfmac_f32_16x16x64_bf16 v[16:19], v[96:99], v[168:175], v0
  s_waitcnt lgkmcnt(4)
  ds_read_b128 v[84:87], v1 offset:7168
  v_smfmac_f32_16x16x64_bf16 v[16:19], v[116:119], v[192:199], v0
  s_waitcnt lgkmcnt(4)
  ds_read_b128 v[88:91], v2 offset:6144
  v_smfmac_f32_16x16x64_bf16 v[16:19], v[124:127], v[200:207], v0
  s_waitcnt lgkmcnt(4)
  ds_read_b128 v[100:103], v1 offset:6144
  buffer_load_dwordx4 v10, s[4:7], s28 offen offset:256 sc1 lds
  v_smfmac_f32_16x16x64_bf16 v[16:19], v[104:107], a[16:23], v0
  s_waitcnt lgkmcnt(4)
  ds_read_b128 v[68:71], v4 offset:16384
  v_smfmac_f32_16x16x64_bf16 v[16:19], v[108:111], a[24:31], v0
  s_waitcnt lgkmcnt(4)
  ds_read_b128 v[72:75], v4 offset:17408
  v_smfmac_f32_16x16x64_bf16 v[16:19], v[112:115], a[64:71], v0
  s_waitcnt lgkmcnt(4)
  ds_read_b128 v[76:79], v4 offset:18432
  v_smfmac_f32_16x16x64_bf16 v[16:19], v[84:87], a[72:79], v0
  s_waitcnt lgkmcnt(4)
  ds_read_b128 v[80:83], v4 offset:19456
  v_smfmac_f32_16x16x64_bf16 v[16:19], v[88:91], a[112:119], v0
  s_waitcnt lgkmcnt(4)
  v_smfmac_f32_16x16x64_bf16 v[16:19], v[100:103], a[120:127], v0
  s_add_u32 s24, s36, 145752064
  s_add_u32 s25, s36, 145756160
  v_smfmac_f32_16x16x64_bf16 v[20:23], v[92:95], v[176:183], v0
  s_add_u32 s35, s36, s23
  v_smfmac_f32_16x16x64_bf16 v[20:23], v[96:99], v[184:191], v0
  s_waitcnt lgkmcnt(2)
  v_smfmac_f32_16x16x64_bf16 v[20:23], v[116:119], v[68:75], v0
  s_waitcnt lgkmcnt(0)
  ds_read_b128 v[68:71], v4 offset:20480
  v_mul_f32 v16, s18, v16
  v_smfmac_f32_16x16x64_bf16 v[20:23], v[124:127], v[76:83], v0
  ds_read_b128 v[72:75], v4 offset:21504
  v_mul_f32 v17, s18, v17
  v_smfmac_f32_16x16x64_bf16 v[20:23], v[104:107], a[32:39], v0
  ds_read_b128 v[76:79], v4 offset:22528
  v_mul_f32 v18, s18, v18
  v_smfmac_f32_16x16x64_bf16 v[20:23], v[108:111], a[40:47], v0
  ds_read_b128 v[80:83], v4 offset:23552
  v_mul_f32 v19, s18, v19
  v_smfmac_f32_16x16x64_bf16 v[20:23], v[112:115], a[80:87], v0
  v_cvt_pk_bf16_f32 v120, v16, v17
  v_smfmac_f32_16x16x64_bf16 v[20:23], v[84:87], a[88:95], v0
  v_cvt_pk_bf16_f32 v121, v18, v19
  v_smfmac_f32_16x16x64_bf16 v[20:23], v[88:91], a[128:135], v0
  ds_write_b64 v5, v[120:121] offset:24576
  v_smfmac_f32_16x16x64_bf16 v[20:23], v[100:103], a[136:143], v0
  s_waitcnt lgkmcnt(3)
  v_smfmac_f32_16x16x64_bf16 v[24:27], v[92:95], v[68:75], v0
  s_waitcnt lgkmcnt(1)
  v_mov_b64 v[92:93], 0
  v_smfmac_f32_16x16x64_bf16 v[24:27], v[96:99], v[76:83], v0
  s_nop 1
  v_cvt_pk_bf16_f32 v122, v20, v21
  v_cvt_pk_bf16_f32 v123, v22, v23
  v_smfmac_f32_16x16x64_bf16 v[24:27], v[116:119], v[208:215], v0
  ds_write_b64 v5, v[122:123] offset:26880
  v_mov_b64 v[94:95], 0
  v_smfmac_f32_16x16x64_bf16 v[24:27], v[124:127], v[216:223], v0
  s_waitcnt lgkmcnt(1)
  s_barrier
  ds_read_b64_tr_b16 v[68:69], v6 offset:24576
  v_smfmac_f32_16x16x64_bf16 v[24:27], v[104:107], a[48:55], v0
  s_add_u32 s27, s27, 8192
  ds_read_b64_tr_b16 v[70:71], v6 offset:24640
  ds_read_b64_tr_b16 v[72:73], v6 offset:24832
  v_smfmac_f32_16x16x64_bf16 v[24:27], v[108:111], a[56:63], v0
  s_add_u32 s28, s28, 8192
  ds_read_b64_tr_b16 v[74:75], v6 offset:24896
  ds_read_b64_tr_b16 v[76:77], v6 offset:25088
  v_smfmac_f32_16x16x64_bf16 v[24:27], v[112:115], a[96:103], v0
  s_nop 0
  ds_read_b64_tr_b16 v[78:79], v6 offset:25152
  ds_read_b64_tr_b16 v[80:81], v6 offset:25344
  v_smfmac_f32_16x16x64_bf16 v[24:27], v[84:87], a[104:111], v0
  ds_read_b64_tr_b16 v[82:83], v6 offset:25408
  v_mov_b64 v[96:97], 0
  v_smfmac_f32_16x16x64_bf16 v[24:27], v[88:91], a[144:151], v0
  s_waitcnt lgkmcnt(8)
  s_barrier
  ds_read_b64_tr_b16 v[116:117], v6 offset:26880
  v_smfmac_f32_16x16x64_bf16 v[24:27], v[100:103], a[152:159], v0
  s_waitcnt lgkmcnt(7)
  ds_read_b64_tr_b16 v[118:119], v6 offset:26944
  v_mfma_f32_16x16x32_bf16 v[16:19], v[36:39], v[68:71], 0
  s_waitcnt lgkmcnt(6)
  ds_read_b64_tr_b16 v[124:125], v6 offset:27136
  ds_read_b64_tr_b16 v[126:127], v6 offset:27200
  v_mfma_f32_16x16x32_bf16 v[16:19], v[40:43], v[72:75], v[16:19]
  s_waitcnt lgkmcnt(6)
  ds_read_b64_tr_b16 v[104:105], v6 offset:27392
  ds_read_b64_tr_b16 v[106:107], v6 offset:27456
  v_mfma_f32_16x16x32_bf16 v[16:19], v[44:47], v[76:79], v[16:19]
  s_waitcnt lgkmcnt(6)
  ds_read_b64_tr_b16 v[108:109], v6 offset:27648
  ds_read_b64_tr_b16 v[110:111], v6 offset:27712
  v_mfma_f32_16x16x32_bf16 v[16:19], v[48:51], v[80:83], v[16:19]
  s_waitcnt lgkmcnt(6)
  v_cvt_pk_bf16_f32 v120, v24, v25
  v_cvt_pk_bf16_f32 v121, v26, v27
  v_mfma_f32_16x16x32_bf16 v[112:115], v[116:119], v[68:71], 0
  s_waitcnt lgkmcnt(4)
  v_mov_b64 v[98:99], 0
  v_mfma_f32_16x16x32_bf16 v[112:115], v[124:127], v[72:75], v[112:115]
  s_waitcnt lgkmcnt(2)
  buffer_store_dwordx4 v[120:123], v2, s[4:7], s29 offen offset:1024 sc1
  v_mov_b64 v[36:37], 0
  v_exp_f32 v100, v16
  v_mfma_f32_16x16x32_bf16 v[112:115], v[104:107], v[76:79], v[112:115]
  s_waitcnt lgkmcnt(0)
  v_exp_f32 v101, v17
  v_mfma_f32_16x16x32_bf16 v[112:115], v[108:111], v[80:83], v[112:115]
  v_exp_f32 v102, v18
  v_mfma_f32_16x16x32_bf16 v[20:23], v[52:55], v[68:71], 0
  v_exp_f32 v103, v19
  v_mfma_f32_16x16x32_bf16 v[20:23], v[56:59], v[72:75], v[20:23]
  v_cvt_pk_bf16_f32 v44, v100, v101
  v_cvt_pk_bf16_f32 v45, v102, v103
  v_mfma_f32_16x16x32_bf16 v[20:23], v[60:63], v[76:79], v[20:23]
  s_add_u32 s29, s29, 131072
  v_exp_f32 v100, v112
  v_mfma_f32_16x16x32_bf16 v[20:23], v[64:67], v[80:83], v[20:23]
  v_exp_f32 v101, v113
  v_exp_f32 v102, v114
  v_exp_f32 v103, v115
  v_cvt_pk_bf16_f32 v84, v100, v101
  v_cvt_pk_bf16_f32 v85, v102, v103
  v_cndmask_b32 v48, v84, 0, s[16:17]
  v_cndmask_b32 v49, v85, 0, s[16:17]
  v_cndmask_b32 v50, 0, v84, s[16:17]
  v_cndmask_b32 v51, 0, v85, s[16:17]
  v_exp_f32 v100, v20
  v_mfma_f32_16x16x16_bf16 v[88:91], v[12:13], v[48:49], 0
  v_exp_f32 v101, v21
  v_mfma_f32_16x16x16_bf16 v[24:27], v[120:121], v[48:49], 0
  v_exp_f32 v102, v22
  v_mfma_f32_16x16x16_bf16 v[116:119], v[120:121], v[50:51], 0
  v_exp_f32 v103, v23
  v_cvt_pk_bf16_f32 v46, v100, v101
  v_cvt_pk_bf16_f32 v47, v102, v103
  v_mov_b64 v[38:39], 0
  s_nop 0
  v_mfma_f32_16x16x32_bf16 v[88:91], v[12:15], v[44:47], v[88:91]
  v_mov_b64 v[40:41], 0
  v_mov_b64 v[42:43], 0
  v_mfma_f32_16x16x32_bf16 v[24:27], v[28:31], v[44:47], v[24:27]
  ds_read_b128 v[52:55], v4 offset:24576
  ds_read_b128 v[56:59], v4 offset:25600
  v_mfma_f32_16x16x32_bf16 v[116:119], v[32:35], v[44:47], v[116:119]
  s_nop 1
T_back_121:
  v_rcp_f32 v89, v88
  v_subrev_u32 v100, s54, v88
  v_cmp_le_u32 vcc, s96, v100
  v_mul_f32 v24, v89, v24
  v_mul_f32 v25, v89, v25
  v_cvt_pk_bf16_f32 v124, v24, v25
  v_pk_mul_f32 v[26:27], v[26:27], v[88:89] op_sel:[0,1] op_sel_hi:[1,1]
  v_pk_mul_f32 v[116:117], v[116:117], v[88:89] op_sel:[0,1] op_sel_hi:[1,1]
  v_pk_mul_f32 v[118:119], v[118:119], v[88:89] op_sel:[0,1] op_sel_hi:[1,1]
  v_cvt_pk_bf16_f32 v125, v26, v27
  v_cvt_pk_bf16_f32 v126, v116, v117
  v_cvt_pk_bf16_f32 v127, v118, v119
  ds_write_b128 v11, v[124:127] offset:29696
  s_cbranch_vccnz T_slow_120
  v_smfmac_f32_16x16x64_bf16 v[92:95], v[124:127], a[160:167], v0
  s_mov_b32 s96, s55
  v_smfmac_f32_16x16x64_bf16 v[96:99], v[124:127], a[168:175], v0
  v_smfmac_f32_16x16x64_bf16 v[36:39], v[124:127], a[176:183], v0
  s_waitcnt lgkmcnt(0)
  s_barrier
  ds_read_b128 v[104:107], v11 offset:29184
  ds_read_b128 v[108:111], v11 offset:30720
  ds_read_b128 v[68:71], v11 offset:30208
  v_smfmac_f32_16x16x64_bf16 v[40:43], v[124:127], a[184:191], v0
  s_waitcnt lgkmcnt(2)
  v_smfmac_f32_16x16x64_bf16 v[92:95], v[104:107], a[192:199], v0
  s_waitcnt lgkmcnt(1)
  ds_read_b128 v[76:79], v4 offset:28672
  v_smfmac_f32_16x16x64_bf16 v[92:95], v[108:111], a[224:231], v0
  s_waitcnt lgkmcnt(1)
  ds_read_b128 v[80:83], v4 offset:29696
  v_smfmac_f32_16x16x64_bf16 v[92:95], v[68:71], a[240:247], v0
  ds_read_b128 v[60:63], v4 offset:26624
  v_smfmac_f32_16x16x64_bf16 v[96:99], v[104:107], a[200:207], v0
  ds_read_b128 v[64:67], v4 offset:27648
  v_smfmac_f32_16x16x64_bf16 v[96:99], v[108:111], a[232:239], v0
  ds_read_b128 v[28:31], v4 offset:30720
  s_nop 0
  v_cvt_pk_bf16_f32 v16, v92, v93
  v_cvt_pk_bf16_f32 v17, v94, v95
  v_bfi_b32 v16, 1, s57, v16
  v_smfmac_f32_16x16x64_bf16 v[96:99], v[68:71], a[248:255], v0
  buffer_store_dwordx2 v[16:17], v7, s[4:7], s20 offen offset:0 sc1
  v_smfmac_f32_16x16x64_bf16 v[36:39], v[104:107], a[208:215], v0
  ds_read_b128 v[32:35], v4 offset:31744
  v_smfmac_f32_16x16x64_bf16 v[36:39], v[108:111], v[52:59], v0
  s_waitcnt lgkmcnt(4)
  s_nop 0
  v_cvt_pk_bf16_f32 v18, v96, v97
  v_cvt_pk_bf16_f32 v19, v98, v99
  v_bfi_b32 v18, 1, s57, v18
  v_smfmac_f32_16x16x64_bf16 v[36:39], v[68:71], v[76:83], v0
  buffer_store_dwordx2 v[18:19], v7, s[4:7], s20 offen offset:64 sc1
  v_smfmac_f32_16x16x64_bf16 v[40:43], v[104:107], a[216:223], v0
  s_waitcnt lgkmcnt(2)
  ds_read_b128 v[116:119], v2 offset:31232
  v_smfmac_f32_16x16x64_bf16 v[40:43], v[108:111], v[60:67], v0
  s_waitcnt lgkmcnt(1)
  s_nop 0
  v_cvt_pk_bf16_f32 v20, v36, v37
  v_cvt_pk_bf16_f32 v21, v38, v39
  v_bfi_b32 v20, 1, s57, v20
  v_smfmac_f32_16x16x64_bf16 v[40:43], v[68:71], v[28:35], v0
  buffer_store_dwordx2 v[20:21], v7, s[4:7], s21 offen offset:0 sc1
  s_nop 6
  v_cvt_pk_bf16_f32 v22, v40, v41
  v_cvt_pk_bf16_f32 v23, v42, v43
  v_bfi_b32 v22, 1, s57, v22
  buffer_store_dwordx2 v[22:23], v7, s[4:7], s21 offen offset:64 sc1
  ds_read_b128 v[68:71], v4 offset:0
  ds_read_b128 v[72:75], v4 offset:1024
  ds_read_b128 v[76:79], v4 offset:4096
  ds_read_b128 v[80:83], v4 offset:5120
  ds_read_b128 v[84:87], v4 offset:8192
  ds_read_b128 v[88:91], v4 offset:9216
  ds_read_b128 v[92:95], v4 offset:2048
  ds_read_b128 v[96:99], v4 offset:3072
  ds_read_b128 v[100:103], v4 offset:6144
  ds_read_b128 v[104:107], v4 offset:7168
  ds_read_b128 v[108:111], v4 offset:10240
  ds_read_b128 v[112:115], v4 offset:11264
  v_mov_b64 v[16:17], 0
  v_mov_b64 v[18:19], 0
  v_mov_b64 v[20:21], 0
  v_mov_b64 v[22:23], 0
  v_mov_b64 v[24:25], 0
  v_mov_b64 v[26:27], 0
  s_mov_b32 s19, 0
  v_mov_b32 v49, -1
  ds_read_b64 v[44:45], v2 offset:32256
  s_waitcnt lgkmcnt(0)
  v_readfirstlane_b32 s38, v44
  v_readfirstlane_b32 s37, v45
  s_nop 0
  s_lshl_b32 s38, s38, 1
  s_lshl1_add_u32 s37, s37, 1
  s_min_u32 s38, s38, s37
  s_cmp_ge_u32 s38, 64
  s_cselect_b32 s38, 100, s38
  s_sub_u32 s38, s38, 1
  s_max_i32 s30, s30, s38
  s_waitcnt vmcnt(0)
  buffer_load_dwordx4 v[52:55], v2, s[4:7], s22 offen offset:0 sc1
  buffer_load_dwordx4 v[56:59], v2, s[4:7], s22 offen offset:1024 sc1
  buffer_load_dwordx4 v[60:63], v2, s[4:7], s22 offen offset:2048 sc1
  buffer_load_dwordx4 v[64:67], v2, s[4:7], s22 offen offset:3072 sc1
  s_waitcnt lgkmcnt(12)
  s_waitcnt vmcnt(3)
  v_mfma_f32_16x16x32_bf16 v[120:123], v[116:119], v[52:55], 0
  v_xor_b32 v48, s57, v52
  v_bitop3_b32 v48, v48, v54, s57 bitop3:0xf6
  s_waitcnt vmcnt(2)
  v_mfma_f32_16x16x32_bf16 v[120:123], v[116:119], v[56:59], v[120:123]
  v_bitop3_b32 v48, v48, v56, s57 bitop3:0xf6
  v_bitop3_b32 v48, v48, v58, s57 bitop3:0xf6
  s_waitcnt vmcnt(1)
  v_mfma_f32_16x16x32_bf16 v[120:123], v[116:119], v[60:63], v[120:123]
  v_bitop3_b32 v48, v48, v60, s57 bitop3:0xf6
  v_bitop3_b32 v48, v48, v62, s57 bitop3:0xf6
  s_waitcnt vmcnt(0)
  v_mfma_f32_16x16x32_bf16 v[120:123], v[116:119], v[64:67], v[120:123]
  v_bitop3_b32 v48, v48, v64, s57 bitop3:0xf6
  v_bitop3_b32 v48, v48, v66, s57 bitop3:0xf6
  v_and_b32 v48, 1, v48
  v_cmp_ne_u32 vcc, 0, v48
  s_cbranch_vccnz T_p1re_123
T_p1ok_124:
  s_nop 2
  v_add_f32_dpp v120, v120, v120 row_ror:8 row_mask:0xf bank_mask:0xf
  v_add_f32_dpp v121, v121, v121 row_ror:8 row_mask:0xf bank_mask:0xf
  v_cvt_pk_bf16_f32 v48, v120, v121
  buffer_store_dword v48, v8, s[4:7], s35 offen sc1
  buffer_store_dword v49, v8, s[4:7], s26 offen sc1
  s_barrier
  ds_read_b128 v[28:31], v2 offset:17408
  ds_read_b128 v[32:35], v2 offset:21504
  ds_read_b128 v[36:39], v2 offset:8192
  ds_read_b128 v[40:43], v2 offset:9216
  ds_read_b128 v[44:47], v2 offset:10240
  ds_read_b128 v[48:51], v2 offset:11264
  buffer_load_dwordx4 v[124:127], v2, s[4:7], s24 offen offset:1024 sc1
  buffer_load_dwordx4 v[116:119], v2, s[4:7], s25 offen offset:1024 sc1
  ds_read_b128 v[52:55], v2 offset:12288
  ds_read_b128 v[56:59], v2 offset:13312
  ds_read_b128 v[60:63], v2 offset:14336
  ds_read_b128 v[64:67], v2 offset:15360
  buffer_load_dwordx4 v[124:127], v2, s[4:7], s24 offen offset:1024 sc1
  buffer_load_dwordx4 v[116:119], v2, s[4:7], s25 offen offset:1024 sc1
  s_add_u32 s14, s14, 1
  s_cmp_ge_i32 s14, s30
  s_cbranch_scc1 T_kvw_117
T_kvb_118:
  s_mov_b32 s19, 0
  s_cmp_lg_u32 s14, 63
  s_cbranch_scc1 T_loop_113
  s_branch T_last_119
T_p1re_123:
  s_mov_b64 exec, vcc
  buffer_load_dwordx4 v[52:55], v2, s[4:7], s22 offen offset:0 sc1
  buffer_load_dwordx4 v[56:59], v2, s[4:7], s22 offen offset:1024 sc1
  buffer_load_dwordx4 v[60:63], v2, s[4:7], s22 offen offset:2048 sc1
  buffer_load_dwordx4 v[64:67], v2, s[4:7], s22 offen offset:3072 sc1
  s_mov_b64 exec, -1
  s_add_u32 s19, s19, 1
  s_cmp_gt_u32 s19, 32768
  s_cbranch_scc1 M_exit
  s_waitcnt vmcnt(3)
  v_mfma_f32_16x16x32_bf16 v[120:123], v[116:119], v[52:55], 0
  v_xor_b32 v48, s57, v52
  v_bitop3_b32 v48, v48, v54, s57 bitop3:0xf6
  s_waitcnt vmcnt(2)
  v_mfma_f32_16x16x32_bf16 v[120:123], v[116:119], v[56:59], v[120:123]
  v_bitop3_b32 v48, v48, v56, s57 bitop3:0xf6
  v_bitop3_b32 v48, v48, v58, s57 bitop3:0xf6
  s_waitcnt vmcnt(1)
  v_mfma_f32_16x16x32_bf16 v[120:123], v[116:119], v[60:63], v[120:123]
  v_bitop3_b32 v48, v48, v60, s57 bitop3:0xf6
  v_bitop3_b32 v48, v48, v62, s57 bitop3:0xf6
  s_waitcnt vmcnt(0)
  v_mfma_f32_16x16x32_bf16 v[120:123], v[116:119], v[64:67], v[120:123]
  v_bitop3_b32 v48, v48, v64, s57 bitop3:0xf6
  v_bitop3_b32 v48, v48, v66, s57 bitop3:0xf6
  v_and_b32 v48, 1, v48
  v_cmp_ne_u32 vcc, 0, v48
  s_cbranch_vccnz T_p1re_123
  s_branch T_p1ok_124
T_kvw_117:
  s_mov_b32 s19, 0
  s_branch T_kvok_126
T_kv_125:
  s_sleep 4
  s_add_u32 s19, s19, 1
  s_cmp_gt_u32 s19, 32768
  s_cbranch_scc1 M_exit
T_kvok_126:
  s_add_u32 s39, s99, 128
  s_mov_b32 s38, 0
  s_mov_b32 s37, 0
  s_atomic_or s38, s[58:59], s99 glc
  s_atomic_or s37, s[58:59], s39 glc
  s_waitcnt lgkmcnt(0)
  s_lshl_b32 s38, s38, 1
  s_lshl1_add_u32 s37, s37, 1
  s_min_u32 s38, s38, s37
  s_cmp_ge_u32 s38, 64
  s_cselect_b32 s38, 100, s38
  s_sub_u32 s38, s38, 1
  s_max_i32 s30, s30, s38
  s_cmp_ge_i32 s14, s30
  s_cbranch_scc1 T_kv_125
  s_branch T_kvb_118
T_slow_120:
  s_nop 7
  v_max3_f32 v100, v16, v17, v18
  v_max3_f32 v100, v100, v19, v20
  v_max3_f32 v100, v100, v21, v22
  v_max3_f32 v100, v100, v23, v112
  v_max3_f32 v100, v100, v113, v114
  v_max_f32 v100, v100, v115
  v_mov_b32 v101, v100
  s_nop 1
  v_permlane32_swap_b32 v100, v101
  s_nop 1
  v_max_f32 v100, v100, v101
  v_mov_b32 v101, v100
  s_nop 1
  v_permlane16_swap_b32 v100, v101
  s_nop 1
  v_max_f32 v100, v100, v101
  v_sub_f32 v16, v16, v100
  v_sub_f32 v17, v17, v100
  v_sub_f32 v18, v18, v100
  v_sub_f32 v19, v19, v100
  v_exp_f32 v16, v16
  v_exp_f32 v17, v17
  v_exp_f32 v18, v18
  v_exp_f32 v19, v19
  v_sub_f32 v20, v20, v100
  v_sub_f32 v21, v21, v100
  v_sub_f32 v22, v22, v100
  v_sub_f32 v23, v23, v100
  v_exp_f32 v20, v20
  v_exp_f32 v21, v21
  v_exp_f32 v22, v22
  v_exp_f32 v23, v23
  v_sub_f32 v112, v112, v100
  v_sub_f32 v113, v113, v100
  v_sub_f32 v114, v114, v100
  v_sub_f32 v115, v115, v100
  v_exp_f32 v112, v112
  v_exp_f32 v113, v113
  v_exp_f32 v114, v114
  v_exp_f32 v115, v115
  s_nop 0
  v_cvt_pk_bf16_f32 v44, v16, v17
  v_cvt_pk_bf16_f32 v45, v18, v19
  v_cvt_pk_bf16_f32 v46, v20, v21
  v_cvt_pk_bf16_f32 v47, v22, v23
  v_cvt_pk_bf16_f32 v84, v112, v113
  v_cvt_pk_bf16_f32 v85, v114, v115
  v_cndmask_b32 v48, v84, 0, s[16:17]
  v_cndmask_b32 v49, v85, 0, s[16:17]
  v_cndmask_b32 v50, 0, v84, s[16:17]
  v_cndmask_b32 v51, 0, v85, s[16:17]
  s_nop 1
  v_mfma_f32_16x16x16_bf16 v[88:91], v[12:13], v[48:49], 0
  v_mfma_f32_16x16x16_bf16 v[24:27], v[120:121], v[48:49], 0
  v_mfma_f32_16x16x16_bf16 v[116:119], v[120:121], v[50:51], 0
  v_mfma_f32_16x16x32_bf16 v[88:91], v[12:15], v[44:47], v[88:91]
  v_mfma_f32_16x16x32_bf16 v[24:27], v[28:31], v[44:47], v[24:27]
  v_mfma_f32_16x16x32_bf16 v[116:119], v[32:35], v[44:47], v[116:119]
  s_nop 7
  s_nop 1
  s_mov_b32 s96, -1
  s_branch T_back_121
.p2align 6
T_retry_127:
  s_mov_b64 exec, vcc
  buffer_load_dwordx4 v[124:127], v2, s[4:7], s24 offen offset:1024 sc1
  buffer_load_dwordx4 v[116:119], v2, s[4:7], s25 offen offset:1024 sc1
  s_mov_b64 exec, -1
  s_add_u32 s19, s19, 1
  s_cmp_gt_u32 s19, 32768
  s_cbranch_scc1 M_exit
T_last_119:
  s_waitcnt vmcnt(3) lgkmcnt(0)
  v_max3_u32 v123, v124, v125, v126
  v_max_u32 v123, v123, v127
  v_mov_b32_dpp v120, v124 row_ror:8 row_mask:0xf bank_mask:0xf
  v_mov_b32_dpp v121, v125 row_ror:8 row_mask:0xf bank_mask:0xf
  s_waitcnt vmcnt(2)
  v_max3_u32 v123, v123, v116, v117
  v_max3_u32 v123, v123, v118, v119
  v_cmp_eq_u32 vcc, -1, v123
  s_cbranch_vccnz T_retry_127
  v_smfmac_f32_16x16x64_bf16 v[20:23], v[124:127], v[76:83], v0
  ds_write_b128 v2, v[124:127] offset:1024
  v_mov_b32_dpp v122, v126 row_ror:8 row_mask:0xf bank_mask:0xf
  v_mov_b32_dpp v123, v127 row_ror:8 row_mask:0xf bank_mask:0xf
  v_smfmac_f32_16x16x64_bf16 v[24:27], v[124:127], v[84:91], v0
  ds_write_b128 v2, v[116:119] offset:5120
  v_mov_b32_dpp v84, v116 row_ror:8 row_mask:0xf bank_mask:0xf
  v_smfmac_f32_16x16x64_bf16 v[20:23], v[120:123], v[100:107], v0
  ds_read_b128 v[68:71], v4 offset:12288
  v_mov_b32_dpp v85, v117 row_ror:8 row_mask:0xf bank_mask:0xf
  v_smfmac_f32_16x16x64_bf16 v[24:27], v[120:123], v[108:115], v0
  ds_read_b128 v[72:75], v4 offset:13312
  v_mov_b32_dpp v86, v118 row_ror:8 row_mask:0xf bank_mask:0xf
  ds_read_b128 v[76:79], v4 offset:14336
  v_mov_b32_dpp v87, v119 row_ror:8 row_mask:0xf bank_mask:0xf
  v_smfmac_f32_16x16x64_bf16 v[20:23], v[116:119], v[240:247], v0
  s_waitcnt lgkmcnt(3)
  s_barrier
  ds_read_b128 v[100:103], v2 offset:0
  v_smfmac_f32_16x16x64_bf16 v[24:27], v[116:119], a[0:7], v0
  ds_read_b128 v[120:123], v1 offset:0
  v_smfmac_f32_16x16x64_bf16 v[20:23], v[84:87], v[248:255], v0
  ds_read_b128 v[80:83], v4 offset:15360
  v_smfmac_f32_16x16x64_bf16 v[24:27], v[84:87], a[8:15], v0
  s_waitcnt lgkmcnt(2)
  ds_read_b128 v[92:95], v2 offset:3072
  v_smfmac_f32_16x16x64_bf16 v[20:23], v[100:103], v[144:151], v0
  ds_read_b128 v[96:99], v1 offset:3072
  v_smfmac_f32_16x16x64_bf16 v[24:27], v[100:103], v[68:75], v0
  s_waitcnt vmcnt(0) lgkmcnt(3)
  ds_read_b128 v[116:119], v2 offset:2048
  ds_read_b128 v[124:127], v1 offset:2048
  v_smfmac_f32_16x16x64_bf16 v[20:23], v[120:123], v[152:159], v0
  s_waitcnt lgkmcnt(4)
  ds_read_b128 v[104:107], v2 offset:4096
  v_smfmac_f32_16x16x64_bf16 v[24:27], v[120:123], v[76:83], v0
  s_waitcnt lgkmcnt(4)
  ds_read_b128 v[108:111], v1 offset:4096
  ds_read_b128 v[112:115], v2 offset:7168
  ds_read_b128 v[84:87], v1 offset:7168
  ds_read_b128 v[88:91], v2 offset:6144
  ds_read_b128 v[100:103], v1 offset:6144
  ds_read_b128 v[68:71], v4 offset:16384
  ds_read_b128 v[72:75], v4 offset:17408
  ds_read_b128 v[76:79], v4 offset:18432
  ds_read_b128 v[80:83], v4 offset:19456
  v_smfmac_f32_16x16x64_bf16 v[20:23], v[92:95], v[176:183], v0
  s_waitcnt lgkmcnt(12)
  v_smfmac_f32_16x16x64_bf16 v[20:23], v[96:99], v[184:191], v0
  s_waitcnt lgkmcnt(2)
  v_smfmac_f32_16x16x64_bf16 v[20:23], v[116:119], v[68:75], v0
  s_waitcnt lgkmcnt(0)
  ds_read_b128 v[68:71], v4 offset:20480
  v_smfmac_f32_16x16x64_bf16 v[20:23], v[124:127], v[76:83], v0
  ds_read_b128 v[72:75], v4 offset:21504
  v_smfmac_f32_16x16x64_bf16 v[20:23], v[104:107], a[32:39], v0
  ds_read_b128 v[76:79], v4 offset:22528
  v_smfmac_f32_16x16x64_bf16 v[20:23], v[108:111], a[40:47], v0
  ds_read_b128 v[80:83], v4 offset:23552
  v_smfmac_f32_16x16x64_bf16 v[20:23], v[112:115], a[80:87], v0
  v_smfmac_f32_16x16x64_bf16 v[20:23], v[84:87], a[88:95], v0
  v_smfmac_f32_16x16x64_bf16 v[20:23], v[88:91], a[128:135], v0
  v_smfmac_f32_16x16x64_bf16 v[20:23], v[100:103], a[136:143], v0
  s_waitcnt lgkmcnt(2)
  v_smfmac_f32_16x16x64_bf16 v[24:27], v[92:95], v[68:75], v0
  s_waitcnt lgkmcnt(0)
  v_smfmac_f32_16x16x64_bf16 v[24:27], v[96:99], v[76:83], v0
  v_smfmac_f32_16x16x64_bf16 v[24:27], v[116:119], v[208:215], v0
  v_smfmac_f32_16x16x64_bf16 v[24:27], v[124:127], v[216:223], v0
  v_smfmac_f32_16x16x64_bf16 v[24:27], v[104:107], a[48:55], v0
  v_smfmac_f32_16x16x64_bf16 v[24:27], v[108:111], a[56:63], v0
  v_smfmac_f32_16x16x64_bf16 v[24:27], v[112:115], a[96:103], v0
  v_smfmac_f32_16x16x64_bf16 v[24:27], v[84:87], a[104:111], v0
  v_smfmac_f32_16x16x64_bf16 v[24:27], v[88:91], a[144:151], v0
  v_smfmac_f32_16x16x64_bf16 v[24:27], v[100:103], a[152:159], v0
  v_cvt_pk_bf16_f32 v122, v20, v21
  v_cvt_pk_bf16_f32 v123, v22, v23
  s_nop 5
  v_cvt_pk_bf16_f32 v120, v24, v25
  v_cvt_pk_bf16_f32 v121, v26, v27
  buffer_store_dwordx4 v[120:123], v2, s[4:7], s29 offen offset:1024 sc1
  s_branch M_tdone
T_w_92:
  s_mov_b32 s19, 0
  s_add_u32 s14, s14, 1
  s_and_b32 s57, s14, 1
  v_mov_b64 v[16:17], 0
  v_mov_b64 v[18:19], 0
  v_mov_b64 v[20:21], 0
  v_mov_b64 v[22:23], 0
  v_mov_b64 v[24:25], 0
  v_mov_b64 v[26:27], 0
  buffer_load_dwordx4 v[124:127], v2, s[4:7], s24 offen offset:2048 sc1
  buffer_load_dwordx4 v[116:119], v2, s[4:7], s25 offen offset:2048 sc1
  buffer_load_dwordx4 v[124:127], v2, s[4:7], s24 offen offset:2048 sc1
  buffer_load_dwordx4 v[116:119], v2, s[4:7], s25 offen offset:2048 sc1
  s_branch T_loop_132
.p2align 6
T_retry_133:
  s_mov_b64 exec, vcc
  buffer_load_dwordx4 v[124:127], v2, s[4:7], s24 offen offset:2048 sc1
  buffer_load_dwordx4 v[116:119], v2, s[4:7], s25 offen offset:2048 sc1
  s_mov_b64 exec, -1
  s_add_u32 s19, s19, 1
  s_cmp_gt_u32 s19, 32768
  s_cbranch_scc1 M_exit
  s_nop 0
  v_mov_b64 v[16:17], 0
  v_mov_b64 v[18:19], 0
T_loop_132:
  s_waitcnt vmcnt(3) lgkmcnt(0)
  v_max3_u32 v123, v124, v125, v126
  v_max_u32 v123, v123, v127
  v_mov_b32_dpp v120, v124 row_ror:8 row_mask:0xf bank_mask:0xf
  v_mov_b32_dpp v121, v125 row_ror:8 row_mask:0xf bank_mask:0xf
  s_waitcnt vmcnt(2)
  v_max3_u32 v123, v123, v116, v117
  v_max3_u32 v123, v123, v118, v119
  v_cmp_eq_u32 vcc, -1, v123
  v_smfmac_f32_16x16x64_bf16 v[16:19], v[124:127], v[68:75], v0
  s_cbranch_vccnz T_retry_133
  ds_write_b128 v2, v[124:127] offset:2048
  v_mov_b32_dpp v122, v126 row_ror:8 row_mask:0xf bank_mask:0xf
  v_smfmac_f32_16x16x64_bf16 v[20:23], v[124:127], v[76:83], v0
  s_and_b32 s57, s14, 1
  v_mov_b32_dpp v123, v127 row_ror:8 row_mask:0xf bank_mask:0xf
  v_smfmac_f32_16x16x64_bf16 v[24:27], v[124:127], v[84:91], v0
  s_and_b32 s36, s14, 3
  ds_write_b128 v2, v[116:119] offset:6144
  v_smfmac_f32_16x16x64_bf16 v[16:19], v[120:123], v[92:99], v0
  s_lshl_b32 s36, s36, 13
  v_mov_b32_dpp v84, v116 row_ror:8 row_mask:0xf bank_mask:0xf
  v_smfmac_f32_16x16x64_bf16 v[20:23], v[120:123], v[100:107], v0
  s_add_u32 s26, s36, s23
  ds_read_b128 v[68:71], v4 offset:12288
  v_mov_b32_dpp v85, v117 row_ror:8 row_mask:0xf bank_mask:0xf
  v_smfmac_f32_16x16x64_bf16 v[24:27], v[120:123], v[108:115], v0
  s_add_u32 s36, s36, 8192
  ds_read_b128 v[72:75], v4 offset:13312
  v_mov_b32_dpp v86, v118 row_ror:8 row_mask:0xf bank_mask:0xf
  v_smfmac_f32_16x16x64_bf16 v[16:19], v[116:119], v[224:231], v0
  s_and_b32 s36, s36, 0x7fff
  ds_read_b128 v[76:79], v4 offset:14336
  v_mov_b32_dpp v87, v119 row_ror:8 row_mask:0xf bank_mask:0xf
  v_smfmac_f32_16x16x64_bf16 v[20:23], v[116:119], v[240:247], v0
  s_waitcnt lgkmcnt(3)
  s_barrier
  ds_read_b128 v[100:103], v2 offset:3072
  v_smfmac_f32_16x16x64_bf16 v[24:27], v[116:119], a[0:7], v0
  s_mov_b32 m0, s31
  ds_read_b128 v[120:123], v1 offset:3072
  v_smfmac_f32_16x16x64_bf16 v[16:19], v[84:87], v[232:239], v0
  v_smfmac_f32_16x16x64_bf16 v[20:23], v[84:87], v[248:255], v0
  ds_read_b128 v[80:83], v4 offset:15360
  buffer_load_dwordx4 v9, s[4:7], s27 offen sc1 lds
  v_smfmac_f32_16x16x64_bf16 v[24:27], v[84:87], a[8:15], v0
  s_waitcnt lgkmcnt(2)
  s_mov_b32 m0, s32
  v_smfmac_f32_16x16x64_bf16 v[16:19], v[100:103], v[128:135], v0
  ds_read_b128 v[92:95], v2 offset:0
  v_smfmac_f32_16x16x64_bf16 v[20:23], v[100:103], v[144:151], v0
  ds_read_b128 v[96:99], v1 offset:0
  v_smfmac_f32_16x16x64_bf16 v[24:27], v[100:103], v[68:75], v0
  s_waitcnt vmcnt(1) lgkmcnt(3)
  ds_read_b128 v[116:119], v2 offset:1024
  buffer_load_dwordx4 v9, s[4:7], s27 offen offset:128 sc1 lds
  v_smfmac_f32_16x16x64_bf16 v[16:19], v[120:123], v[136:143], v0
  ds_read_b128 v[124:127], v1 offset:1024
  s_mov_b32 m0, s33
  v_smfmac_f32_16x16x64_bf16 v[20:23], v[120:123], v[152:159], v0
  s_waitcnt lgkmcnt(4)
  ds_read_b128 v[104:107], v2 offset:7168
  v_smfmac_f32_16x16x64_bf16 v[24:27], v[120:123], v[76:83], v0
  s_waitcnt lgkmcnt(4)
  ds_read_b128 v[108:111], v1 offset:7168
  v_smfmac_f32_16x16x64_bf16 v[16:19], v[92:95], v[160:167], v0
  s_waitcnt lgkmcnt(4)
  ds_read_b128 v[112:115], v2 offset:4096
  v_mov_b32 v122, s98
  buffer_load_dwordx4 v10, s[4:7], s28 offen sc1 lds
  v_smfmac_f32_16x16x64_bf16 v[16:19], v[96:99], v[168:175], v0
  s_waitcnt lgkmcnt(4)
  ds_read_b128 v[84:87], v1 offset:4096
  s_mov_b32 m0, s34
  v_smfmac_f32_16x16x64_bf16 v[16:19], v[116:119], v[192:199], v0
  s_waitcnt lgkmcnt(4)
  ds_read_b128 v[88:91], v2 offset:5120
  v_smfmac_f32_16x16x64_bf16 v[16:19], v[124:127], v[200:207], v0
  s_waitcnt lgkmcnt(4)
  ds_read_b128 v[100:103], v1 offset:5120
  v_smfmac_f32_16x16x64_bf16 v[16:19], v[104:107], a[16:23], v0
  s_waitcnt lgkmcnt(4)
  ds_read_b128 v[68:71], v4 offset:16384
  buffer_load_dwordx4 v10, s[4:7], s28 offen offset:256 sc1 lds
  v_smfmac_f32_16x16x64_bf16 v[16:19], v[108:111], a[24:31], v0
  s_waitcnt lgkmcnt(4)
  ds_read_b128 v[72:75], v4 offset:17408
  v_smfmac_f32_16x16x64_bf16 v[16:19], v[112:115], a[64:71], v0
  s_waitcnt lgkmcnt(4)
  ds_read_b128 v[76:79], v4 offset:18432
  v_smfmac_f32_16x16x64_bf16 v[16:19], v[84:87], a[72:79], v0
  s_waitcnt lgkmcnt(4)
  ds_read_b128 v[80:83], v4 offset:19456
  v_smfmac_f32_16x16x64_bf16 v[16:19], v[88:91], a[112:119], v0
  s_waitcnt lgkmcnt(4)
  buffer_store_dword v122, v3, s[4:7], s15 offen sc1
  v_smfmac_f32_16x16x64_bf16 v[16:19], v[100:103], a[120:127], v0
  s_add_u32 s98, s14, 1
  s_add_u32 s24, s36, 145752064
  s_add_u32 s25, s36, 145756160
  v_smfmac_f32_16x16x64_bf16 v[20:23], v[92:95], v[176:183], v0
  s_add_u32 s35, s36, s23
  v_smfmac_f32_16x16x64_bf16 v[20:23], v[96:99], v[184:191], v0
  s_waitcnt lgkmcnt(2)
  v_smfmac_f32_16x16x64_bf16 v[20:23], v[116:119], v[68:75], v0
  s_waitcnt lgkmcnt(0)
  ds_read_b128 v[68:71], v4 offset:20480
  v_mul_f32 v16, s18, v16
  v_smfmac_f32_16x16x64_bf16 v[20:23], v[124:127], v[76:83], v0
  ds_read_b128 v[72:75], v4 offset:21504
  v_mul_f32 v17, s18, v17
  v_smfmac_f32_16x16x64_bf16 v[20:23], v[104:107], a[32:39], v0
  ds_read_b128 v[76:79], v4 offset:22528
  v_mul_f32 v18, s18, v18
  v_smfmac_f32_16x16x64_bf16 v[20:23], v[108:111], a[40:47], v0
  ds_read_b128 v[80:83], v4 offset:23552
  v_mul_f32 v19, s18, v19
  v_smfmac_f32_16x16x64_bf16 v[20:23], v[112:115], a[80:87], v0
  v_cvt_pk_bf16_f32 v120, v16, v17
  v_smfmac_f32_16x16x64_bf16 v[20:23], v[84:87], a[88:95], v0
  v_cvt_pk_bf16_f32 v121, v18, v19
  v_smfmac_f32_16x16x64_bf16 v[20:23], v[88:91], a[128:135], v0
  ds_write_b64 v5, v[120:121] offset:24576
  v_smfmac_f32_16x16x64_bf16 v[20:23], v[100:103], a[136:143], v0
  s_waitcnt lgkmcnt(3)
  v_smfmac_f32_16x16x64_bf16 v[24:27], v[92:95], v[68:75], v0
  s_waitcnt lgkmcnt(1)
  v_mov_b64 v[92:93], 0
  v_smfmac_f32_16x16x64_bf16 v[24:27], v[96:99], v[76:83], v0
  s_nop 1
  v_cvt_pk_bf16_f32 v122, v20, v21
  v_cvt_pk_bf16_f32 v123, v22, v23
  v_smfmac_f32_16x16x64_bf16 v[24:27], v[116:119], v[208:215], v0
  ds_write_b64 v5, v[122:123] offset:26880
  v_mov_b64 v[94:95], 0
  v_smfmac_f32_16x16x64_bf16 v[24:27], v[124:127], v[216:223], v0
  s_waitcnt lgkmcnt(1)
  s_barrier
  ds_read_b64_tr_b16 v[68:69], v6 offset:24576
  v_smfmac_f32_16x16x64_bf16 v[24:27], v[104:107], a[48:55], v0
  s_add_u32 s27, s27, 8192
  ds_read_b64_tr_b16 v[70:71], v6 offset:24640
  ds_read_b64_tr_b16 v[72:73], v6 offset:24832
  v_smfmac_f32_16x16x64_bf16 v[24:27], v[108:111], a[56:63], v0
  s_add_u32 s28, s28, 8192
  ds_read_b64_tr_b16 v[74:75], v6 offset:24896
  ds_read_b64_tr_b16 v[76:77], v6 offset:25088
  v_smfmac_f32_16x16x64_bf16 v[24:27], v[112:115], a[96:103], v0
  s_nop 0
  ds_read_b64_tr_b16 v[78:79], v6 offset:25152
  ds_read_b64_tr_b16 v[80:81], v6 offset:25344
  v_smfmac_f32_16x16x64_bf16 v[24:27], v[84:87], a[104:111], v0
  ds_read_b64_tr_b16 v[82:83], v6 offset:25408
  v_mov_b64 v[96:97], 0
  v_smfmac_f32_16x16x64_bf16 v[24:27], v[88:91], a[144:151], v0
  s_waitcnt lgkmcnt(8)
  s_barrier
  ds_read_b64_tr_b16 v[116:117], v6 offset:26880
  v_smfmac_f32_16x16x64_bf16 v[24:27], v[100:103], a[152:159], v0
  s_waitcnt lgkmcnt(7)
  ds_read_b64_tr_b16 v[118:119], v6 offset:26944
  v_mfma_f32_16x16x32_bf16 v[16:19], v[36:39], v[68:71], 0
  s_waitcnt lgkmcnt(6)
  ds_read_b64_tr_b16 v[124:125], v6 offset:27136
  ds_read_b64_tr_b16 v[126:127], v6 offset:27200
  v_mfma_f32_16x16x32_bf16 v[16:19], v[40:43], v[72:75], v[16:19]
  s_waitcnt lgkmcnt(6)
  ds_read_b64_tr_b16 v[104:105], v6 offset:27392
  ds_read_b64_tr_b16 v[106:107], v6 offset:27456
  v_mfma_f32_16x16x32_bf16 v[16:19], v[44:47], v[76:79], v[16:19]
  s_waitcnt lgkmcnt(6)
  ds_read_b64_tr_b16 v[108:109], v6 offset:27648
  ds_read_b64_tr_b16 v[110:111], v6 offset:27712
  v_mfma_f32_16x16x32_bf16 v[16:19], v[48:51], v[80:83], v[16:19]
  s_waitcnt lgkmcnt(6)
  v_cvt_pk_bf16_f32 v120, v24, v25
  v_cvt_pk_bf16_f32 v121, v26, v27
  v_mfma_f32_16x16x32_bf16 v[112:115], v[116:119], v[68:71], 0
  s_waitcnt lgkmcnt(4)
  v_mov_b64 v[98:99], 0
  v_mfma_f32_16x16x32_bf16 v[112:115], v[124:127], v[72:75], v[112:115]
  s_waitcnt lgkmcnt(2)
  v_mov_b64 v[36:37], 0
  v_exp_f32 v100, v16
  v_mfma_f32_16x16x32_bf16 v[112:115], v[104:107], v[76:79], v[112:115]
  s_waitcnt lgkmcnt(0)
  buffer_store_dwordx4 v[120:123], v2, s[4:7], s29 offen offset:2048 sc1
  v_exp_f32 v101, v17
  v_mfma_f32_16x16x32_bf16 v[112:115], v[108:111], v[80:83], v[112:115]
  v_exp_f32 v102, v18
  v_mfma_f32_16x16x32_bf16 v[20:23], v[52:55], v[68:71], 0
  v_exp_f32 v103, v19
  v_mfma_f32_16x16x32_bf16 v[20:23], v[56:59], v[72:75], v[20:23]
  v_cvt_pk_bf16_f32 v44, v100, v101
  v_cvt_pk_bf16_f32 v45, v102, v103
  v_mfma_f32_16x16x32_bf16 v[20:23], v[60:63], v[76:79], v[20:23]
  s_add_u32 s29, s29, 131072
  v_exp_f32 v100, v112
  v_mfma_f32_16x16x32_bf16 v[20:23], v[64:67], v[80:83], v[20:23]
  v_exp_f32 v101, v113
  v_exp_f32 v102, v114
  v_exp_f32 v103, v115
  v_cvt_pk_bf16_f32 v84, v100, v101
  v_cvt_pk_bf16_f32 v85, v102, v103
  v_cndmask_b32 v48, v84, 0, s[16:17]
  v_cndmask_b32 v49, v85, 0, s[16:17]
  v_cndmask_b32 v50, 0, v84, s[16:17]
  v_cndmask_b32 v51, 0, v85, s[16:17]
  v_exp_f32 v100, v20
  v_mfma_f32_16x16x16_bf16 v[88:91], v[12:13], v[48:49], 0
  v_exp_f32 v101, v21
  v_mfma_f32_16x16x16_bf16 v[24:27], v[120:121], v[48:49], 0
  v_exp_f32 v102, v22
  v_mfma_f32_16x16x16_bf16 v[116:119], v[120:121], v[50:51], 0
  v_exp_f32 v103, v23
  v_cvt_pk_bf16_f32 v46, v100, v101
  v_cvt_pk_bf16_f32 v47, v102, v103
  v_mov_b64 v[38:39], 0
  s_nop 0
  v_mfma_f32_16x16x32_bf16 v[88:91], v[12:15], v[44:47], v[88:91]
  v_mov_b64 v[40:41], 0
  v_mov_b64 v[42:43], 0
  v_mfma_f32_16x16x32_bf16 v[24:27], v[28:31], v[44:47], v[24:27]
  ds_read_b128 v[52:55], v4 offset:24576
  ds_read_b128 v[56:59], v4 offset:25600
  v_mfma_f32_16x16x32_bf16 v[116:119], v[32:35], v[44:47], v[116:119]
  s_nop 1
T_back_140:
  v_rcp_f32 v89, v88
  v_subrev_u32 v100, s54, v88
  v_cmp_le_u32 vcc, s96, v100
  v_mul_f32 v24, v89, v24
  v_mul_f32 v25, v89, v25
  v_cvt_pk_bf16_f32 v124, v24, v25
  v_pk_mul_f32 v[26:27], v[26:27], v[88:89] op_sel:[0,1] op_sel_hi:[1,1]
  v_pk_mul_f32 v[116:117], v[116:117], v[88:89] op_sel:[0,1] op_sel_hi:[1,1]
  v_pk_mul_f32 v[118:119], v[118:119], v[88:89] op_sel:[0,1] op_sel_hi:[1,1]
  v_cvt_pk_bf16_f32 v125, v26, v27
  v_cvt_pk_bf16_f32 v126, v116, v117
  v_cvt_pk_bf16_f32 v127, v118, v119
  ds_write_b128 v11, v[124:127] offset:30208
  s_cbranch_vccnz T_slow_139
  v_smfmac_f32_16x16x64_bf16 v[92:95], v[124:127], a[160:167], v0
  s_mov_b32 s96, s55
  v_smfmac_f32_16x16x64_bf16 v[96:99], v[124:127], a[168:175], v0
  v_smfmac_f32_16x16x64_bf16 v[36:39], v[124:127], a[176:183], v0
  s_waitcnt lgkmcnt(0)
  s_barrier
  ds_read_b128 v[104:107], v11 offset:30720
  ds_read_b128 v[108:111], v11 offset:29184
  ds_read_b128 v[68:71], v11 offset:29696
  v_smfmac_f32_16x16x64_bf16 v[40:43], v[124:127], a[184:191], v0
  s_waitcnt lgkmcnt(2)
  v_smfmac_f32_16x16x64_bf16 v[92:95], v[104:107], a[192:199], v0
  s_waitcnt lgkmcnt(1)
  ds_read_b128 v[76:79], v4 offset:28672
  v_smfmac_f32_16x16x64_bf16 v[92:95], v[108:111], a[224:231], v0
  s_waitcnt lgkmcnt(1)
  ds_read_b128 v[80:83], v4 offset:29696
  v_smfmac_f32_16x16x64_bf16 v[92:95], v[68:71], a[240:247], v0
  ds_read_b128 v[60:63], v4 offset:26624
  v_smfmac_f32_16x16x64_bf16 v[96:99], v[104:107], a[200:207], v0
  ds_read_b128 v[64:67], v4 offset:27648
  v_smfmac_f32_16x16x64_bf16 v[96:99], v[108:111], a[232:239], v0
  ds_read_b128 v[28:31], v4 offset:30720
  s_nop 0
  v_cvt_pk_bf16_f32 v16, v92, v93
  v_cvt_pk_bf16_f32 v17, v94, v95
  v_bfi_b32 v16, 1, s57, v16
  v_smfmac_f32_16x16x64_bf16 v[96:99], v[68:71], a[248:255], v0
  buffer_store_dwordx2 v[16:17], v7, s[4:7], s20 offen offset:0 sc1
  v_smfmac_f32_16x16x64_bf16 v[36:39], v[104:107], a[208:215], v0
  ds_read_b128 v[32:35], v4 offset:31744
  v_smfmac_f32_16x16x64_bf16 v[36:39], v[108:111], v[52:59], v0
  s_waitcnt lgkmcnt(4)
  s_nop 0
  v_cvt_pk_bf16_f32 v18, v96, v97
  v_cvt_pk_bf16_f32 v19, v98, v99
  v_bfi_b32 v18, 1, s57, v18
  v_smfmac_f32_16x16x64_bf16 v[36:39], v[68:71], v[76:83], v0
  buffer_store_dwordx2 v[18:19], v7, s[4:7], s20 offen offset:64 sc1
  v_smfmac_f32_16x16x64_bf16 v[40:43], v[104:107], a[216:223], v0
  s_waitcnt lgkmcnt(2)
  v_smfmac_f32_16x16x64_bf16 v[40:43], v[108:111], v[60:67], v0
  s_waitcnt lgkmcnt(0)
  s_nop 0
  v_cvt_pk_bf16_f32 v20, v36, v37
  v_cvt_pk_bf16_f32 v21, v38, v39
  v_bfi_b32 v20, 1, s57, v20
  v_smfmac_f32_16x16x64_bf16 v[40:43], v[68:71], v[28:35], v0
  buffer_store_dwordx2 v[20:21], v7, s[4:7], s21 offen offset:0 sc1
  s_nop 6
  v_cvt_pk_bf16_f32 v22, v40, v41
  v_cvt_pk_bf16_f32 v23, v42, v43
  v_bfi_b32 v22, 1, s57, v22
  buffer_store_dwordx2 v[22:23], v7, s[4:7], s21 offen offset:64 sc1
  ds_read_b128 v[68:71], v4 offset:0
  ds_read_b128 v[72:75], v4 offset:1024
  ds_read_b128 v[76:79], v4 offset:4096
  ds_read_b128 v[80:83], v4 offset:5120
  ds_read_b128 v[84:87], v4 offset:8192
  ds_read_b128 v[88:91], v4 offset:9216
  ds_read_b128 v[92:95], v4 offset:2048
  ds_read_b128 v[96:99], v4 offset:3072
  ds_read_b128 v[100:103], v4 offset:6144
  ds_read_b128 v[104:107], v4 offset:7168
  ds_read_b128 v[108:111], v4 offset:10240
  ds_read_b128 v[112:115], v4 offset:11264
  v_mov_b64 v[16:17], 0
  v_mov_b64 v[18:19], 0
  v_mov_b64 v[20:21], 0
  v_mov_b64 v[22:23], 0
  v_mov_b64 v[24:25], 0
  v_mov_b64 v[26:27], 0
  ds_read_b64 v[44:45], v2 offset:32256
  s_waitcnt lgkmcnt(0)
  v_readfirstlane_b32 s38, v44
  v_readfirstlane_b32 s37, v45
  s_nop 0
  s_lshl_b32 s38, s38, 1
  s_lshl1_add_u32 s37, s37, 1
  s_min_u32 s38, s38, s37
  s_cmp_ge_u32 s38, 64
  s_cselect_b32 s38, 100, s38
  s_sub_u32 s38, s38, 1
  s_max_i32 s30, s30, s38
  s_waitcnt vmcnt(4)
  s_barrier
  ds_read_b128 v[28:31], v2 offset:18432
  ds_read_b128 v[32:35], v2 offset:22528
  ds_read_b128 v[36:39], v2 offset:8192
  ds_read_b128 v[40:43], v2 offset:9216
  ds_read_b128 v[44:47], v2 offset:10240
  ds_read_b128 v[48:51], v2 offset:11264
  buffer_load_dwordx4 v[124:127], v2, s[4:7], s24 offen offset:2048 sc1
  buffer_load_dwordx4 v[116:119], v2, s[4:7], s25 offen offset:2048 sc1
  ds_read_b128 v[52:55], v2 offset:12288
  ds_read_b128 v[56:59], v2 offset:13312
  ds_read_b128 v[60:63], v2 offset:14336
  ds_read_b128 v[64:67], v2 offset:15360
  buffer_load_dwordx4 v[124:127], v2, s[4:7], s24 offen offset:2048 sc1
  buffer_load_dwordx4 v[116:119], v2, s[4:7], s25 offen offset:2048 sc1
  s_add_u32 s14, s14, 1
  s_cmp_ge_i32 s14, s30
  s_cbranch_scc1 T_kvw_136
T_kvb_137:
  s_mov_b32 s19, 0
  s_cmp_lg_u32 s14, 63
  s_cbranch_scc1 T_loop_132
  s_branch T_last_138
T_kvw_136:
  s_mov_b32 s19, 0
  s_branch T_kvok_145
T_kv_144:
  s_sleep 4
  s_add_u32 s19, s19, 1
  s_cmp_gt_u32 s19, 32768
  s_cbranch_scc1 M_exit
T_kvok_145:
  s_add_u32 s39, s99, 128
  s_mov_b32 s38, 0
  s_mov_b32 s37, 0
  s_atomic_or s38, s[58:59], s99 glc
  s_atomic_or s37, s[58:59], s39 glc
  s_waitcnt lgkmcnt(0)
  s_lshl_b32 s38, s38, 1
  s_lshl1_add_u32 s37, s37, 1
  s_min_u32 s38, s38, s37
  s_cmp_ge_u32 s38, 64
  s_cselect_b32 s38, 100, s38
  s_sub_u32 s38, s38, 1
  s_max_i32 s30, s30, s38
  s_cmp_ge_i32 s14, s30
  s_cbranch_scc1 T_kv_144
  s_branch T_kvb_137
T_slow_139:
  s_nop 7
  v_max3_f32 v100, v16, v17, v18
  v_max3_f32 v100, v100, v19, v20
  v_max3_f32 v100, v100, v21, v22
  v_max3_f32 v100, v100, v23, v112
  v_max3_f32 v100, v100, v113, v114
  v_max_f32 v100, v100, v115
  v_mov_b32 v101, v100
  s_nop 1
  v_permlane32_swap_b32 v100, v101
  s_nop 1
  v_max_f32 v100, v100, v101
  v_mov_b32 v101, v100
  s_nop 1
  v_permlane16_swap_b32 v100, v101
  s_nop 1
  v_max_f32 v100, v100, v101
  v_sub_f32 v16, v16, v100
  v_sub_f32 v17, v17, v100
  v_sub_f32 v18, v18, v100
  v_sub_f32 v19, v19, v100
  v_exp_f32 v16, v16
  v_exp_f32 v17, v17
  v_exp_f32 v18, v18
  v_exp_f32 v19, v19
  v_sub_f32 v20, v20, v100
  v_sub_f32 v21, v21, v100
  v_sub_f32 v22, v22, v100
  v_sub_f32 v23, v23, v100
  v_exp_f32 v20, v20
  v_exp_f32 v21, v21
  v_exp_f32 v22, v22
  v_exp_f32 v23, v23
  v_sub_f32 v112, v112, v100
  v_sub_f32 v113, v113, v100
  v_sub_f32 v114, v114, v100
  v_sub_f32 v115, v115, v100
  v_exp_f32 v112, v112
  v_exp_f32 v113, v113
  v_exp_f32 v114, v114
  v_exp_f32 v115, v115
  s_nop 0
  v_cvt_pk_bf16_f32 v44, v16, v17
  v_cvt_pk_bf16_f32 v45, v18, v19
  v_cvt_pk_bf16_f32 v46, v20, v21
  v_cvt_pk_bf16_f32 v47, v22, v23
  v_cvt_pk_bf16_f32 v84, v112, v113
  v_cvt_pk_bf16_f32 v85, v114, v115
  v_cndmask_b32 v48, v84, 0, s[16:17]
  v_cndmask_b32 v49, v85, 0, s[16:17]
  v_cndmask_b32 v50, 0, v84, s[16:17]
  v_cndmask_b32 v51, 0, v85, s[16:17]
  s_nop 1
  v_mfma_f32_16x16x16_bf16 v[88:91], v[12:13], v[48:49], 0
  v_mfma_f32_16x16x16_bf16 v[24:27], v[120:121], v[48:49], 0
  v_mfma_f32_16x16x16_bf16 v[116:119], v[120:121], v[50:51], 0
  v_mfma_f32_16x16x32_bf16 v[88:91], v[12:15], v[44:47], v[88:91]
  v_mfma_f32_16x16x32_bf16 v[24:27], v[28:31], v[44:47], v[24:27]
  v_mfma_f32_16x16x32_bf16 v[116:119], v[32:35], v[44:47], v[116:119]
  s_nop 7
  s_nop 1
  s_mov_b32 s96, -1
  s_branch T_back_140
.p2align 6
T_retry_146:
  s_mov_b64 exec, vcc
  buffer_load_dwordx4 v[124:127], v2, s[4:7], s24 offen offset:2048 sc1
  buffer_load_dwordx4 v[116:119], v2, s[4:7], s25 offen offset:2048 sc1
  s_mov_b64 exec, -1
  s_add_u32 s19, s19, 1
  s_cmp_gt_u32 s19, 32768
  s_cbranch_scc1 M_exit
T_last_138:
  s_waitcnt vmcnt(3) lgkmcnt(0)
  v_max3_u32 v123, v124, v125, v126
  v_max_u32 v123, v123, v127
  v_mov_b32_dpp v120, v124 row_ror:8 row_mask:0xf bank_mask:0xf
  v_mov_b32_dpp v121, v125 row_ror:8 row_mask:0xf bank_mask:0xf
  s_waitcnt vmcnt(2)
  v_max3_u32 v123, v123, v116, v117
  v_max3_u32 v123, v123, v118, v119
  v_cmp_eq_u32 vcc, -1, v123
  s_cbranch_vccnz T_retry_146
  v_smfmac_f32_16x16x64_bf16 v[20:23], v[124:127], v[76:83], v0
  ds_write_b128 v2, v[124:127] offset:2048
  v_mov_b32_dpp v122, v126 row_ror:8 row_mask:0xf bank_mask:0xf
  v_mov_b32_dpp v123, v127 row_ror:8 row_mask:0xf bank_mask:0xf
  v_smfmac_f32_16x16x64_bf16 v[24:27], v[124:127], v[84:91], v0
  ds_write_b128 v2, v[116:119] offset:6144
  v_mov_b32_dpp v84, v116 row_ror:8 row_mask:0xf bank_mask:0xf
  v_smfmac_f32_16x16x64_bf16 v[20:23], v[120:123], v[100:107], v0
  ds_read_b128 v[68:71], v4 offset:12288
  v_mov_b32_dpp v85, v117 row_ror:8 row_mask:0xf bank_mask:0xf
  v_smfmac_f32_16x16x64_bf16 v[24:27], v[120:123], v[108:115], v0
  ds_read_b128 v[72:75], v4 offset:13312
  v_mov_b32_dpp v86, v118 row_ror:8 row_mask:0xf bank_mask:0xf
  ds_read_b128 v[76:79], v4 offset:14336
  v_mov_b32_dpp v87, v119 row_ror:8 row_mask:0xf bank_mask:0xf
  v_smfmac_f32_16x16x64_bf16 v[20:23], v[116:119], v[240:247], v0
  s_waitcnt lgkmcnt(3)
  s_barrier
  ds_read_b128 v[100:103], v2 offset:3072
  v_smfmac_f32_16x16x64_bf16 v[24:27], v[116:119], a[0:7], v0
  ds_read_b128 v[120:123], v1 offset:3072
  v_smfmac_f32_16x16x64_bf16 v[20:23], v[84:87], v[248:255], v0
  ds_read_b128 v[80:83], v4 offset:15360
  v_smfmac_f32_16x16x64_bf16 v[24:27], v[84:87], a[8:15], v0
  s_waitcnt lgkmcnt(2)
  ds_read_b128 v[92:95], v2 offset:0
  v_smfmac_f32_16x16x64_bf16 v[20:23], v[100:103], v[144:151], v0
  ds_read_b128 v[96:99], v1 offset:0
  v_smfmac_f32_16x16x64_bf16 v[24:27], v[100:103], v[68:75], v0
  s_waitcnt vmcnt(0) lgkmcnt(3)
  ds_read_b128 v[116:119], v2 offset:1024
  ds_read_b128 v[124:127], v1 offset:1024
  v_smfmac_f32_16x16x64_bf16 v[20:23], v[120:123], v[152:159], v0
  s_waitcnt lgkmcnt(4)
  ds_read_b128 v[104:107], v2 offset:7168
  v_smfmac_f32_16x16x64_bf16 v[24:27], v[120:123], v[76:83], v0
  s_waitcnt lgkmcnt(4)
  ds_read_b128 v[108:111], v1 offset:7168
  ds_read_b128 v[112:115], v2 offset:4096
  ds_read_b128 v[84:87], v1 offset:4096
  ds_read_b128 v[88:91], v2 offset:5120
  ds_read_b128 v[100:103], v1 offset:5120
  ds_read_b128 v[68:71], v4 offset:16384
  ds_read_b128 v[72:75], v4 offset:17408
  ds_read_b128 v[76:79], v4 offset:18432
  ds_read_b128 v[80:83], v4 offset:19456
  v_smfmac_f32_16x16x64_bf16 v[20:23], v[92:95], v[176:183], v0
  s_waitcnt lgkmcnt(12)
  v_smfmac_f32_16x16x64_bf16 v[20:23], v[96:99], v[184:191], v0
  s_waitcnt lgkmcnt(2)
  v_smfmac_f32_16x16x64_bf16 v[20:23], v[116:119], v[68:75], v0
  s_waitcnt lgkmcnt(0)
  ds_read_b128 v[68:71], v4 offset:20480
  v_smfmac_f32_16x16x64_bf16 v[20:23], v[124:127], v[76:83], v0
  ds_read_b128 v[72:75], v4 offset:21504
  v_smfmac_f32_16x16x64_bf16 v[20:23], v[104:107], a[32:39], v0
  ds_read_b128 v[76:79], v4 offset:22528
  v_smfmac_f32_16x16x64_bf16 v[20:23], v[108:111], a[40:47], v0
  ds_read_b128 v[80:83], v4 offset:23552
  v_smfmac_f32_16x16x64_bf16 v[20:23], v[112:115], a[80:87], v0
  v_smfmac_f32_16x16x64_bf16 v[20:23], v[84:87], a[88:95], v0
  v_smfmac_f32_16x16x64_bf16 v[20:23], v[88:91], a[128:135], v0
  v_smfmac_f32_16x16x64_bf16 v[20:23], v[100:103], a[136:143], v0
  s_waitcnt lgkmcnt(2)
  v_smfmac_f32_16x16x64_bf16 v[24:27], v[92:95], v[68:75], v0
  s_waitcnt lgkmcnt(0)
  v_smfmac_f32_16x16x64_bf16 v[24:27], v[96:99], v[76:83], v0
  v_smfmac_f32_16x16x64_bf16 v[24:27], v[116:119], v[208:215], v0
  v_smfmac_f32_16x16x64_bf16 v[24:27], v[124:127], v[216:223], v0
  v_smfmac_f32_16x16x64_bf16 v[24:27], v[104:107], a[48:55], v0
  v_smfmac_f32_16x16x64_bf16 v[24:27], v[108:111], a[56:63], v0
  v_smfmac_f32_16x16x64_bf16 v[24:27], v[112:115], a[96:103], v0
  v_smfmac_f32_16x16x64_bf16 v[24:27], v[84:87], a[104:111], v0
  v_smfmac_f32_16x16x64_bf16 v[24:27], v[88:91], a[144:151], v0
  v_smfmac_f32_16x16x64_bf16 v[24:27], v[100:103], a[152:159], v0
  v_cvt_pk_bf16_f32 v122, v20, v21
  v_cvt_pk_bf16_f32 v123, v22, v23
  s_nop 5
  v_cvt_pk_bf16_f32 v120, v24, v25
  v_cvt_pk_bf16_f32 v121, v26, v27
  buffer_store_dwordx4 v[120:123], v2, s[4:7], s29 offen offset:2048 sc1
  s_branch M_tdone
T_w_93:
  s_mov_b32 s19, 0
  s_add_u32 s14, s14, 1
  s_and_b32 s57, s14, 1
  v_mov_b64 v[16:17], 0
  v_mov_b64 v[18:19], 0
  v_mov_b64 v[20:21], 0
  v_mov_b64 v[22:23], 0
  v_mov_b64 v[24:25], 0
  v_mov_b64 v[26:27], 0
  buffer_load_dwordx4 v[124:127], v2, s[4:7], s24 offen offset:3072 sc1
  buffer_load_dwordx4 v[116:119], v2, s[4:7], s25 offen offset:3072 sc1
  buffer_load_dwordx4 v[124:127], v2, s[4:7], s24 offen offset:3072 sc1
  buffer_load_dwordx4 v[116:119], v2, s[4:7], s25 offen offset:3072 sc1
  s_branch T_loop_151
.p2align 6
T_retry_152:
  s_mov_b64 exec, vcc
  buffer_load_dwordx4 v[124:127], v2, s[4:7], s24 offen offset:3072 sc1
  buffer_load_dwordx4 v[116:119], v2, s[4:7], s25 offen offset:3072 sc1
  s_mov_b64 exec, -1
  s_add_u32 s19, s19, 1
  s_cmp_gt_u32 s19, 32768
  s_cbranch_scc1 M_exit
  s_nop 0
  v_mov_b64 v[16:17], 0
  v_mov_b64 v[18:19], 0
T_loop_151:
  s_waitcnt vmcnt(3) lgkmcnt(0)
  v_max3_u32 v123, v124, v125, v126
  v_max_u32 v123, v123, v127
  v_mov_b32_dpp v120, v124 row_ror:8 row_mask:0xf bank_mask:0xf
  v_mov_b32_dpp v121, v125 row_ror:8 row_mask:0xf bank_mask:0xf
  s_waitcnt vmcnt(2)
  v_max3_u32 v123, v123, v116, v117
  v_max3_u32 v123, v123, v118, v119
  v_cmp_eq_u32 vcc, -1, v123
  v_smfmac_f32_16x16x64_bf16 v[16:19], v[124:127], v[68:75], v0
  s_cbranch_vccnz T_retry_152
  ds_write_b128 v2, v[124:127] offset:3072
  v_mov_b32_dpp v122, v126 row_ror:8 row_mask:0xf bank_mask:0xf
  v_smfmac_f32_16x16x64_bf16 v[20:23], v[124:127], v[76:83], v0
  s_and_b32 s57, s14, 1
  v_mov_b32_dpp v123, v127 row_ror:8 row_mask:0xf bank_mask:0xf
  v_smfmac_f32_16x16x64_bf16 v[24:27], v[124:127], v[84:91], v0
  s_and_b32 s36, s14, 3
  ds_write_b128 v2, v[116:119] offset:7168
  v_smfmac_f32_16x16x64_bf16 v[16:19], v[120:123], v[92:99], v0
  s_lshl_b32 s36, s36, 13
  v_mov_b32_dpp v84, v116 row_ror:8 row_mask:0xf bank_mask:0xf
  v_smfmac_f32_16x16x64_bf16 v[20:23], v[120:123], v[100:107], v0
  s_add_u32 s26, s36, s23
  ds_read_b128 v[68:71], v4 offset:12288
  v_mov_b32_dpp v85, v117 row_ror:8 row_mask:0xf bank_mask:0xf
  v_smfmac_f32_16x16x64_bf16 v[24:27], v[120:123], v[108:115], v0
  s_add_u32 s36, s36, 8192
  ds_read_b128 v[72:75], v4 offset:13312
  v_mov_b32_dpp v86, v118 row_ror:8 row_mask:0xf bank_mask:0xf
  v_smfmac_f32_16x16x64_bf16 v[16:19], v[116:119], v[224:231], v0
  s_and_b32 s36, s36, 0x7fff
  ds_read_b128 v[76:79], v4 offset:14336
  v_mov_b32_dpp v87, v119 row_ror:8 row_mask:0xf bank_mask:0xf
  v_smfmac_f32_16x16x64_bf16 v[20:23], v[116:119], v[240:247], v0
  s_waitcnt lgkmcnt(3)
  s_barrier
  ds_read_b128 v[100:103], v2 offset:2048
  v_smfmac_f32_16x16x64_bf16 v[24:27], v[116:119], a[0:7], v0
  s_mov_b32 m0, s31
  ds_read_b128 v[120:123], v1 offset:2048
  v_smfmac_f32_16x16x64_bf16 v[16:19], v[84:87], v[232:239], v0
  v_smfmac_f32_16x16x64_bf16 v[20:23], v[84:87], v[248:255], v0
  ds_read_b128 v[80:83], v4 offset:15360
  v_smfmac_f32_16x16x64_bf16 v[24:27], v[84:87], a[8:15], v0
  s_waitcnt lgkmcnt(2)
  buffer_load_dwordx4 v9, s[4:7], s27 offen sc1 lds
  v_smfmac_f32_16x16x64_bf16 v[16:19], v[100:103], v[128:135], v0
  ds_read_b128 v[92:95], v2 offset:1024
  s_mov_b32 m0, s32
  v_smfmac_f32_16x16x64_bf16 v[20:23], v[100:103], v[144:151], v0
  ds_read_b128 v[96:99], v1 offset:1024
  v_smfmac_f32_16x16x64_bf16 v[24:27], v[100:103], v[68:75], v0
  s_waitcnt vmcnt(1) lgkmcnt(3)
  ds_read_b128 v[116:119], v2 offset:0
  v_smfmac_f32_16x16x64_bf16 v[16:19], v[120:123], v[136:143], v0
  ds_read_b128 v[124:127], v1 offset:0
  buffer_load_dwordx4 v9, s[4:7], s27 offen offset:128 sc1 lds
  v_smfmac_f32_16x16x64_bf16 v[20:23], v[120:123], v[152:159], v0
  s_waitcnt lgkmcnt(4)
  ds_read_b128 v[104:107], v2 offset:6144
  s_mov_b32 m0, s33
  v_smfmac_f32_16x16x64_bf16 v[24:27], v[120:123], v[76:83], v0
  s_waitcnt lgkmcnt(4)
  ds_read_b128 v[108:111], v1 offset:6144
  v_smfmac_f32_16x16x64_bf16 v[16:19], v[92:95], v[160:167], v0
  s_waitcnt lgkmcnt(4)
  ds_read_b128 v[112:115], v2 offset:5120
  v_smfmac_f32_16x16x64_bf16 v[16:19], v[96:99], v[168:175], v0
  s_waitcnt lgkmcnt(4)
  ds_read_b128 v[84:87], v1 offset:5120
  buffer_load_dwordx4 v10, s[4:7], s28 offen sc1 lds
  v_smfmac_f32_16x16x64_bf16 v[16:19], v[116:119], v[192:199], v0
  s_waitcnt lgkmcnt(4)
  ds_read_b128 v[88:91], v2 offset:4096
  s_mov_b32 m0, s34
  v_smfmac_f32_16x16x64_bf16 v[16:19], v[124:127], v[200:207], v0
  s_waitcnt lgkmcnt(4)
  ds_read_b128 v[100:103], v1 offset:4096
  v_smfmac_f32_16x16x64_bf16 v[16:19], v[104:107], a[16:23], v0
  s_waitcnt lgkmcnt(4)
  ds_read_b128 v[68:71], v4 offset:16384
  v_smfmac_f32_16x16x64_bf16 v[16:19], v[108:111], a[24:31], v0
  s_waitcnt lgkmcnt(4)
  ds_read_b128 v[72:75], v4 offset:17408
  buffer_load_dwordx4 v10, s[4:7], s28 offen offset:256 sc1 lds
  v_smfmac_f32_16x16x64_bf16 v[16:19], v[112:115], a[64:71], v0
  s_waitcnt lgkmcnt(4)
  ds_read_b128 v[76:79], v4 offset:18432
  s_mov_b32 m0, 32256
  v_smfmac_f32_16x16x64_bf16 v[16:19], v[84:87], a[72:79], v0
  s_waitcnt lgkmcnt(4)
  ds_read_b128 v[80:83], v4 offset:19456
  v_smfmac_f32_16x16x64_bf16 v[16:19], v[88:91], a[112:119], v0
  s_waitcnt lgkmcnt(4)
  v_smfmac_f32_16x16x64_bf16 v[16:19], v[100:103], a[120:127], v0
  buffer_load_dword v3, s[4:7], s99 offen sc1 lds
  s_add_u32 s24, s36, 145752064
  s_add_u32 s25, s36, 145756160
  v_smfmac_f32_16x16x64_bf16 v[20:23], v[92:95], v[176:183], v0
  s_add_u32 s35, s36, s23
  v_smfmac_f32_16x16x64_bf16 v[20:23], v[96:99], v[184:191], v0
  s_waitcnt lgkmcnt(2)
  v_smfmac_f32_16x16x64_bf16 v[20:23], v[116:119], v[68:75], v0
  s_waitcnt lgkmcnt(0)
  ds_read_b128 v[68:71], v4 offset:20480
  v_mul_f32 v16, s18, v16
  v_smfmac_f32_16x16x64_bf16 v[20:23], v[124:127], v[76:83], v0
  ds_read_b128 v[72:75], v4 offset:21504
  v_mul_f32 v17, s18, v17
  v_smfmac_f32_16x16x64_bf16 v[20:23], v[104:107], a[32:39], v0
  ds_read_b128 v[76:79], v4 offset:22528
  v_mul_f32 v18, s18, v18
  v_smfmac_f32_16x16x64_bf16 v[20:23], v[108:111], a[40:47], v0
  ds_read_b128 v[80:83], v4 offset:23552
  v_mul_f32 v19, s18, v19
  v_smfmac_f32_16x16x64_bf16 v[20:23], v[112:115], a[80:87], v0
  v_cvt_pk_bf16_f32 v120, v16, v17
  v_smfmac_f32_16x16x64_bf16 v[20:23], v[84:87], a[88:95], v0
  v_cvt_pk_bf16_f32 v121, v18, v19
  v_smfmac_f32_16x16x64_bf16 v[20:23], v[88:91], a[128:135], v0
  ds_write_b64 v5, v[120:121] offset:24576
  v_smfmac_f32_16x16x64_bf16 v[20:23], v[100:103], a[136:143], v0
  s_waitcnt lgkmcnt(3)
  v_smfmac_f32_16x16x64_bf16 v[24:27], v[92:95], v[68:75], v0
  s_waitcnt lgkmcnt(1)
  v_mov_b64 v[92:93], 0
  v_smfmac_f32_16x16x64_bf16 v[24:27], v[96:99], v[76:83], v0
  s_nop 1
  v_cvt_pk_bf16_f32 v122, v20, v21
  v_cvt_pk_bf16_f32 v123, v22, v23
  v_smfmac_f32_16x16x64_bf16 v[24:27], v[116:119], v[208:215], v0
  ds_write_b64 v5, v[122:123] offset:26880
  v_mov_b64 v[94:95], 0
  v_smfmac_f32_16x16x64_bf16 v[24:27], v[124:127], v[216:223], v0
  s_waitcnt lgkmcnt(1)
  s_barrier
  ds_read_b64_tr_b16 v[68:69], v6 offset:24576
  v_smfmac_f32_16x16x64_bf16 v[24:27], v[104:107], a[48:55], v0
  s_add_u32 s27, s27, 8192
  ds_read_b64_tr_b16 v[70:71], v6 offset:24640
  ds_read_b64_tr_b16 v[72:73], v6 offset:24832
  v_smfmac_f32_16x16x64_bf16 v[24:27], v[108:111], a[56:63], v0
  s_add_u32 s28, s28, 8192
  ds_read_b64_tr_b16 v[74:75], v6 offset:24896
  ds_read_b64_tr_b16 v[76:77], v6 offset:25088
  v_smfmac_f32_16x16x64_bf16 v[24:27], v[112:115], a[96:103], v0
  s_nop 0
  ds_read_b64_tr_b16 v[78:79], v6 offset:25152
  ds_read_b64_tr_b16 v[80:81], v6 offset:25344
  v_smfmac_f32_16x16x64_bf16 v[24:27], v[84:87], a[104:111], v0
  ds_read_b64_tr_b16 v[82:83], v6 offset:25408
  v_mov_b64 v[96:97], 0
  v_smfmac_f32_16x16x64_bf16 v[24:27], v[88:91], a[144:151], v0
  s_waitcnt lgkmcnt(8)
  s_barrier
  ds_read_b64_tr_b16 v[116:117], v6 offset:26880
  v_smfmac_f32_16x16x64_bf16 v[24:27], v[100:103], a[152:159], v0
  s_waitcnt lgkmcnt(7)
  ds_read_b64_tr_b16 v[118:119], v6 offset:26944
  v_mfma_f32_16x16x32_bf16 v[16:19], v[36:39], v[68:71], 0
  s_waitcnt lgkmcnt(6)
  ds_read_b64_tr_b16 v[124:125], v6 offset:27136
  ds_read_b64_tr_b16 v[126:127], v6 offset:27200
  v_mfma_f32_16x16x32_bf16 v[16:19], v[40:43], v[72:75], v[16:19]
  s_waitcnt lgkmcnt(6)
  ds_read_b64_tr_b16 v[104:105], v6 offset:27392
  ds_read_b64_tr_b16 v[106:107], v6 offset:27456
  v_mfma_f32_16x16x32_bf16 v[16:19], v[44:47], v[76:79], v[16:19]
  s_waitcnt lgkmcnt(6)
  ds_read_b64_tr_b16 v[108:109], v6 offset:27648
  ds_read_b64_tr_b16 v[110:111], v6 offset:27712
  v_mfma_f32_16x16x32_bf16 v[16:19], v[48:51], v[80:83], v[16:19]
  s_waitcnt lgkmcnt(6)
  v_cvt_pk_bf16_f32 v120, v24, v25
  v_cvt_pk_bf16_f32 v121, v26, v27
  v_mfma_f32_16x16x32_bf16 v[112:115], v[116:119], v[68:71], 0
  s_waitcnt lgkmcnt(4)
  v_mov_b64 v[98:99], 0
  v_mfma_f32_16x16x32_bf16 v[112:115], v[124:127], v[72:75], v[112:115]
  s_waitcnt lgkmcnt(2)
  v_mov_b64 v[36:37], 0
  v_exp_f32 v100, v16
  v_mfma_f32_16x16x32_bf16 v[112:115], v[104:107], v[76:79], v[112:115]
  s_waitcnt lgkmcnt(0)
  v_exp_f32 v101, v17
  v_mfma_f32_16x16x32_bf16 v[112:115], v[108:111], v[80:83], v[112:115]
  buffer_store_dwordx4 v[120:123], v2, s[4:7], s29 offen offset:3072 sc1
  v_exp_f32 v102, v18
  v_mfma_f32_16x16x32_bf16 v[20:23], v[52:55], v[68:71], 0
  v_exp_f32 v103, v19
  v_mfma_f32_16x16x32_bf16 v[20:23], v[56:59], v[72:75], v[20:23]
  v_cvt_pk_bf16_f32 v44, v100, v101
  v_cvt_pk_bf16_f32 v45, v102, v103
  v_mfma_f32_16x16x32_bf16 v[20:23], v[60:63], v[76:79], v[20:23]
  s_add_u32 s29, s29, 131072
  v_exp_f32 v100, v112
  v_mfma_f32_16x16x32_bf16 v[20:23], v[64:67], v[80:83], v[20:23]
  v_exp_f32 v101, v113
  v_exp_f32 v102, v114
  v_exp_f32 v103, v115
  v_cvt_pk_bf16_f32 v84, v100, v101
  v_cvt_pk_bf16_f32 v85, v102, v103
  v_cndmask_b32 v48, v84, 0, s[16:17]
  v_cndmask_b32 v49, v85, 0, s[16:17]
  v_cndmask_b32 v50, 0, v84, s[16:17]
  v_cndmask_b32 v51, 0, v85, s[16:17]
  v_exp_f32 v100, v20
  v_mfma_f32_16x16x16_bf16 v[88:91], v[12:13], v[48:49], 0
  v_exp_f32 v101, v21
  v_mfma_f32_16x16x16_bf16 v[24:27], v[120:121], v[48:49], 0
  v_exp_f32 v102, v22
  v_mfma_f32_16x16x16_bf16 v[116:119], v[120:121], v[50:51], 0
  v_exp_f32 v103, v23
  v_cvt_pk_bf16_f32 v46, v100, v101
  v_cvt_pk_bf16_f32 v47, v102, v103
  v_mov_b64 v[38:39], 0
  s_nop 0
  v_mfma_f32_16x16x32_bf16 v[88:91], v[12:15], v[44:47], v[88:91]
  v_mov_b64 v[40:41], 0
  v_mov_b64 v[42:43], 0
  v_mfma_f32_16x16x32_bf16 v[24:27], v[28:31], v[44:47], v[24:27]
  ds_read_b128 v[52:55], v4 offset:24576
  ds_read_b128 v[56:59], v4 offset:25600
  v_mfma_f32_16x16x32_bf16 v[116:119], v[32:35], v[44:47], v[116:119]
  s_nop 1
T_back_159:
  v_rcp_f32 v89, v88
  v_subrev_u32 v100, s54, v88
  v_cmp_le_u32 vcc, s96, v100
  v_mul_f32 v24, v89, v24
  v_mul_f32 v25, v89, v25
  v_cvt_pk_bf16_f32 v124, v24, v25
  v_pk_mul_f32 v[26:27], v[26:27], v[88:89] op_sel:[0,1] op_sel_hi:[1,1]
  v_pk_mul_f32 v[116:117], v[116:117], v[88:89] op_sel:[0,1] op_sel_hi:[1,1]
  v_pk_mul_f32 v[118:119], v[118:119], v[88:89] op_sel:[0,1] op_sel_hi:[1,1]
  v_cvt_pk_bf16_f32 v125, v26, v27
  v_cvt_pk_bf16_f32 v126, v116, v117
  v_cvt_pk_bf16_f32 v127, v118, v119
  ds_write_b128 v11, v[124:127] offset:30720
  s_cbranch_vccnz T_slow_158
  v_smfmac_f32_16x16x64_bf16 v[92:95], v[124:127], a[160:167], v0
  s_mov_b32 s96, s55
  v_smfmac_f32_16x16x64_bf16 v[96:99], v[124:127], a[168:175], v0
  v_smfmac_f32_16x16x64_bf16 v[36:39], v[124:127], a[176:183], v0
  s_waitcnt lgkmcnt(0)
  s_barrier
  ds_read_b128 v[104:107], v11 offset:30208
  ds_read_b128 v[108:111], v11 offset:29696
  ds_read_b128 v[68:71], v11 offset:29184
  v_smfmac_f32_16x16x64_bf16 v[40:43], v[124:127], a[184:191], v0
  s_waitcnt lgkmcnt(2)
  v_smfmac_f32_16x16x64_bf16 v[92:95], v[104:107], a[192:199], v0
  s_waitcnt lgkmcnt(1)
  ds_read_b128 v[76:79], v4 offset:28672
  v_smfmac_f32_16x16x64_bf16 v[92:95], v[108:111], a[224:231], v0
  s_waitcnt lgkmcnt(1)
  ds_read_b128 v[80:83], v4 offset:29696
  v_smfmac_f32_16x16x64_bf16 v[92:95], v[68:71], a[240:247], v0
  ds_read_b128 v[60:63], v4 offset:26624
  v_smfmac_f32_16x16x64_bf16 v[96:99], v[104:107], a[200:207], v0
  ds_read_b128 v[64:67], v4 offset:27648
  v_smfmac_f32_16x16x64_bf16 v[96:99], v[108:111], a[232:239], v0
  ds_read_b128 v[28:31], v4 offset:30720
  s_nop 0
  v_cvt_pk_bf16_f32 v16, v92, v93
  v_cvt_pk_bf16_f32 v17, v94, v95
  v_bfi_b32 v16, 1, s57, v16
  v_smfmac_f32_16x16x64_bf16 v[96:99], v[68:71], a[248:255], v0
  buffer_store_dwordx2 v[16:17], v7, s[4:7], s20 offen offset:0 sc1
  v_smfmac_f32_16x16x64_bf16 v[36:39], v[104:107], a[208:215], v0
  ds_read_b128 v[32:35], v4 offset:31744
  v_smfmac_f32_16x16x64_bf16 v[36:39], v[108:111], v[52:59], v0
  s_waitcnt lgkmcnt(4)
  s_nop 0
  v_cvt_pk_bf16_f32 v18, v96, v97
  v_cvt_pk_bf16_f32 v19, v98, v99
  v_bfi_b32 v18, 1, s57, v18
  v_smfmac_f32_16x16x64_bf16 v[36:39], v[68:71], v[76:83], v0
  buffer_store_dwordx2 v[18:19], v7, s[4:7], s20 offen offset:64 sc1
  v_smfmac_f32_16x16x64_bf16 v[40:43], v[104:107], a[216:223], v0
  s_waitcnt lgkmcnt(2)
  v_smfmac_f32_16x16x64_bf16 v[40:43], v[108:111], v[60:67], v0
  s_waitcnt lgkmcnt(0)
  s_nop 0
  v_cvt_pk_bf16_f32 v20, v36, v37
  v_cvt_pk_bf16_f32 v21, v38, v39
  v_bfi_b32 v20, 1, s57, v20
  v_smfmac_f32_16x16x64_bf16 v[40:43], v[68:71], v[28:35], v0
  buffer_store_dwordx2 v[20:21], v7, s[4:7], s21 offen offset:0 sc1
  s_nop 6
  v_cvt_pk_bf16_f32 v22, v40, v41
  v_cvt_pk_bf16_f32 v23, v42, v43
  v_bfi_b32 v22, 1, s57, v22
  buffer_store_dwordx2 v[22:23], v7, s[4:7], s21 offen offset:64 sc1
  ds_read_b128 v[68:71], v4 offset:0
  ds_read_b128 v[72:75], v4 offset:1024
  ds_read_b128 v[76:79], v4 offset:4096
  ds_read_b128 v[80:83], v4 offset:5120
  ds_read_b128 v[84:87], v4 offset:8192
  ds_read_b128 v[88:91], v4 offset:9216
  ds_read_b128 v[92:95], v4 offset:2048
  ds_read_b128 v[96:99], v4 offset:3072
  ds_read_b128 v[100:103], v4 offset:6144
  ds_read_b128 v[104:107], v4 offset:7168
  ds_read_b128 v[108:111], v4 offset:10240
  ds_read_b128 v[112:115], v4 offset:11264
  v_mov_b64 v[16:17], 0
  v_mov_b64 v[18:19], 0
  v_mov_b64 v[20:21], 0
  v_mov_b64 v[22:23], 0
  v_mov_b64 v[24:25], 0
  v_mov_b64 v[26:27], 0
  ds_read_b64 v[44:45], v2 offset:32256
  s_waitcnt lgkmcnt(0)
  v_readfirstlane_b32 s38, v44
  v_readfirstlane_b32 s37, v45
  s_nop 0
  s_lshl_b32 s38, s38, 1
  s_lshl1_add_u32 s37, s37, 1
  s_min_u32 s38, s38, s37
  s_cmp_ge_u32 s38, 64
  s_cselect_b32 s38, 100, s38
  s_sub_u32 s38, s38, 1
  s_max_i32 s30, s30, s38
  s_waitcnt vmcnt(4)
  s_barrier
  ds_read_b128 v[28:31], v2 offset:19456
  ds_read_b128 v[32:35], v2 offset:23552
  ds_read_b128 v[36:39], v2 offset:8192
  ds_read_b128 v[40:43], v2 offset:9216
  ds_read_b128 v[44:47], v2 offset:10240
  ds_read_b128 v[48:51], v2 offset:11264
  buffer_load_dwordx4 v[124:127], v2, s[4:7], s24 offen offset:3072 sc1
  buffer_load_dwordx4 v[116:119], v2, s[4:7], s25 offen offset:3072 sc1
  ds_read_b128 v[52:55], v2 offset:12288
  ds_read_b128 v[56:59], v2 offset:13312
  ds_read_b128 v[60:63], v2 offset:14336
  ds_read_b128 v[64:67], v2 offset:15360
  buffer_load_dwordx4 v[124:127], v2, s[4:7], s24 offen offset:3072 sc1
  buffer_load_dwordx4 v[116:119], v2, s[4:7], s25 offen offset:3072 sc1
  s_add_u32 s14, s14, 1
  s_cmp_ge_i32 s14, s30
  s_cbranch_scc1 T_kvw_155
T_kvb_156:
  s_mov_b32 s19, 0
  s_cmp_lg_u32 s14, 63
  s_cbranch_scc1 T_loop_151
  s_branch T_last_157
T_kvw_155:
  s_mov_b32 s19, 0
  s_branch T_kvok_164
T_kv_163:
  s_sleep 4
  s_add_u32 s19, s19, 1
  s_cmp_gt_u32 s19, 32768
  s_cbranch_scc1 M_exit
T_kvok_164:
  s_add_u32 s39, s99, 128
  s_mov_b32 s38, 0
  s_mov_b32 s37, 0
  s_atomic_or s38, s[58:59], s99 glc
  s_atomic_or s37, s[58:59], s39 glc
  s_waitcnt lgkmcnt(0)
  s_lshl_b32 s38, s38, 1
  s_lshl1_add_u32 s37, s37, 1
  s_min_u32 s38, s38, s37
  s_cmp_ge_u32 s38, 64
  s_cselect_b32 s38, 100, s38
  s_sub_u32 s38, s38, 1
  s_max_i32 s30, s30, s38
  s_cmp_ge_i32 s14, s30
  s_cbranch_scc1 T_kv_163
  s_branch T_kvb_156
T_slow_158:
  s_nop 7
  v_max3_f32 v100, v16, v17, v18
  v_max3_f32 v100, v100, v19, v20
  v_max3_f32 v100, v100, v21, v22
  v_max3_f32 v100, v100, v23, v112
  v_max3_f32 v100, v100, v113, v114
  v_max_f32 v100, v100, v115
  v_mov_b32 v101, v100
  s_nop 1
  v_permlane32_swap_b32 v100, v101
  s_nop 1
  v_max_f32 v100, v100, v101
  v_mov_b32 v101, v100
  s_nop 1
  v_permlane16_swap_b32 v100, v101
  s_nop 1
  v_max_f32 v100, v100, v101
  v_sub_f32 v16, v16, v100
  v_sub_f32 v17, v17, v100
  v_sub_f32 v18, v18, v100
  v_sub_f32 v19, v19, v100
  v_exp_f32 v16, v16
  v_exp_f32 v17, v17
  v_exp_f32 v18, v18
  v_exp_f32 v19, v19
  v_sub_f32 v20, v20, v100
  v_sub_f32 v21, v21, v100
  v_sub_f32 v22, v22, v100
  v_sub_f32 v23, v23, v100
  v_exp_f32 v20, v20
  v_exp_f32 v21, v21
  v_exp_f32 v22, v22
  v_exp_f32 v23, v23
  v_sub_f32 v112, v112, v100
  v_sub_f32 v113, v113, v100
  v_sub_f32 v114, v114, v100
  v_sub_f32 v115, v115, v100
  v_exp_f32 v112, v112
  v_exp_f32 v113, v113
  v_exp_f32 v114, v114
  v_exp_f32 v115, v115
  s_nop 0
  v_cvt_pk_bf16_f32 v44, v16, v17
  v_cvt_pk_bf16_f32 v45, v18, v19
  v_cvt_pk_bf16_f32 v46, v20, v21
  v_cvt_pk_bf16_f32 v47, v22, v23
  v_cvt_pk_bf16_f32 v84, v112, v113
  v_cvt_pk_bf16_f32 v85, v114, v115
  v_cndmask_b32 v48, v84, 0, s[16:17]
  v_cndmask_b32 v49, v85, 0, s[16:17]
  v_cndmask_b32 v50, 0, v84, s[16:17]
  v_cndmask_b32 v51, 0, v85, s[16:17]
  s_nop 1
  v_mfma_f32_16x16x16_bf16 v[88:91], v[12:13], v[48:49], 0
  v_mfma_f32_16x16x16_bf16 v[24:27], v[120:121], v[48:49], 0
  v_mfma_f32_16x16x16_bf16 v[116:119], v[120:121], v[50:51], 0
  v_mfma_f32_16x16x32_bf16 v[88:91], v[12:15], v[44:47], v[88:91]
  v_mfma_f32_16x16x32_bf16 v[24:27], v[28:31], v[44:47], v[24:27]
  v_mfma_f32_16x16x32_bf16 v[116:119], v[32:35], v[44:47], v[116:119]
  s_nop 7
  s_nop 1
  s_mov_b32 s96, -1
  s_branch T_back_159
.p2align 6
T_retry_165:
  s_mov_b64 exec, vcc
  buffer_load_dwordx4 v[124:127], v2, s[4:7], s24 offen offset:3072 sc1
  buffer_load_dwordx4 v[116:119], v2, s[4:7], s25 offen offset:3072 sc1
  s_mov_b64 exec, -1
  s_add_u32 s19, s19, 1
  s_cmp_gt_u32 s19, 32768
  s_cbranch_scc1 M_exit
T_last_157:
  s_waitcnt vmcnt(3) lgkmcnt(0)
  v_max3_u32 v123, v124, v125, v126
  v_max_u32 v123, v123, v127
  v_mov_b32_dpp v120, v124 row_ror:8 row_mask:0xf bank_mask:0xf
  v_mov_b32_dpp v121, v125 row_ror:8 row_mask:0xf bank_mask:0xf
  s_waitcnt vmcnt(2)
  v_max3_u32 v123, v123, v116, v117
  v_max3_u32 v123, v123, v118, v119
  v_cmp_eq_u32 vcc, -1, v123
  s_cbranch_vccnz T_retry_165
  v_smfmac_f32_16x16x64_bf16 v[20:23], v[124:127], v[76:83], v0
  ds_write_b128 v2, v[124:127] offset:3072
  v_mov_b32_dpp v122, v126 row_ror:8 row_mask:0xf bank_mask:0xf
  v_mov_b32_dpp v123, v127 row_ror:8 row_mask:0xf bank_mask:0xf
  v_smfmac_f32_16x16x64_bf16 v[24:27], v[124:127], v[84:91], v0
  ds_write_b128 v2, v[116:119] offset:7168
  v_mov_b32_dpp v84, v116 row_ror:8 row_mask:0xf bank_mask:0xf
  v_smfmac_f32_16x16x64_bf16 v[20:23], v[120:123], v[100:107], v0
  ds_read_b128 v[68:71], v4 offset:12288
  v_mov_b32_dpp v85, v117 row_ror:8 row_mask:0xf bank_mask:0xf
  v_smfmac_f32_16x16x64_bf16 v[24:27], v[120:123], v[108:115], v0
  ds_read_b128 v[72:75], v4 offset:13312
  v_mov_b32_dpp v86, v118 row_ror:8 row_mask:0xf bank_mask:0xf
  ds_read_b128 v[76:79], v4 offset:14336
  v_mov_b32_dpp v87, v119 row_ror:8 row_mask:0xf bank_mask:0xf
  v_smfmac_f32_16x16x64_bf16 v[20:23], v[116:119], v[240:247], v0
  s_waitcnt lgkmcnt(3)
  s_barrier
  ds_read_b128 v[100:103], v2 offset:2048
  v_smfmac_f32_16x16x64_bf16 v[24:27], v[116:119], a[0:7], v0
  ds_read_b128 v[120:123], v1 offset:2048
  v_smfmac_f32_16x16x64_bf16 v[20:23], v[84:87], v[248:255], v0
  ds_read_b128 v[80:83], v4 offset:15360
  v_smfmac_f32_16x16x64_bf16 v[24:27], v[84:87], a[8:15], v0
  s_waitcnt lgkmcnt(2)
  ds_read_b128 v[92:95], v2 offset:1024
  v_smfmac_f32_16x16x64_bf16 v[20:23], v[100:103], v[144:151], v0
  ds_read_b128 v[96:99], v1 offset:1024
  v_smfmac_f32_16x16x64_bf16 v[24:27], v[100:103], v[68:75], v0
  s_waitcnt vmcnt(0) lgkmcnt(3)
  ds_read_b128 v[116:119], v2 offset:0
  ds_read_b128 v[124:127], v1 offset:0
  v_smfmac_f32_16x16x64_bf16 v[20:23], v[120:123], v[152:159], v0
  s_waitcnt lgkmcnt(4)
  ds_read_b128 v[104:107], v2 offset:6144
  v_smfmac_f32_16x16x64_bf16 v[24:27], v[120:123], v[76:83], v0
  s_waitcnt lgkmcnt(4)
  ds_read_b128 v[108:111], v1 offset:6144
  ds_read_b128 v[112:115], v2 offset:5120
  ds_read_b128 v[84:87], v1 offset:5120
  ds_read_b128 v[88:91], v2 offset:4096
  ds_read_b128 v[100:103], v1 offset:4096
  ds_read_b128 v[68:71], v4 offset:16384
  ds_read_b128 v[72:75], v4 offset:17408
  ds_read_b128 v[76:79], v4 offset:18432
  ds_read_b128 v[80:83], v4 offset:19456
  v_smfmac_f32_16x16x64_bf16 v[20:23], v[92:95], v[176:183], v0
  s_waitcnt lgkmcnt(12)
  v_smfmac_f32_16x16x64_bf16 v[20:23], v[96:99], v[184:191], v0
  s_waitcnt lgkmcnt(2)
  v_smfmac_f32_16x16x64_bf16 v[20:23], v[116:119], v[68:75], v0
  s_waitcnt lgkmcnt(0)
  ds_read_b128 v[68:71], v4 offset:20480
  v_smfmac_f32_16x16x64_bf16 v[20:23], v[124:127], v[76:83], v0
  ds_read_b128 v[72:75], v4 offset:21504
  v_smfmac_f32_16x16x64_bf16 v[20:23], v[104:107], a[32:39], v0
  ds_read_b128 v[76:79], v4 offset:22528
  v_smfmac_f32_16x16x64_bf16 v[20:23], v[108:111], a[40:47], v0
  ds_read_b128 v[80:83], v4 offset:23552
  v_smfmac_f32_16x16x64_bf16 v[20:23], v[112:115], a[80:87], v0
  v_smfmac_f32_16x16x64_bf16 v[20:23], v[84:87], a[88:95], v0
  v_smfmac_f32_16x16x64_bf16 v[20:23], v[88:91], a[128:135], v0
  v_smfmac_f32_16x16x64_bf16 v[20:23], v[100:103], a[136:143], v0
  s_waitcnt lgkmcnt(2)
  v_smfmac_f32_16x16x64_bf16 v[24:27], v[92:95], v[68:75], v0
  s_waitcnt lgkmcnt(0)
  v_smfmac_f32_16x16x64_bf16 v[24:27], v[96:99], v[76:83], v0
  v_smfmac_f32_16x16x64_bf16 v[24:27], v[116:119], v[208:215], v0
  v_smfmac_f32_16x16x64_bf16 v[24:27], v[124:127], v[216:223], v0
  v_smfmac_f32_16x16x64_bf16 v[24:27], v[104:107], a[48:55], v0
  v_smfmac_f32_16x16x64_bf16 v[24:27], v[108:111], a[56:63], v0
  v_smfmac_f32_16x16x64_bf16 v[24:27], v[112:115], a[96:103], v0
  v_smfmac_f32_16x16x64_bf16 v[24:27], v[84:87], a[104:111], v0
  v_smfmac_f32_16x16x64_bf16 v[24:27], v[88:91], a[144:151], v0
  v_smfmac_f32_16x16x64_bf16 v[24:27], v[100:103], a[152:159], v0
  v_cvt_pk_bf16_f32 v122, v20, v21
  v_cvt_pk_bf16_f32 v123, v22, v23
  s_nop 5
  v_cvt_pk_bf16_f32 v120, v24, v25
  v_cvt_pk_bf16_f32 v121, v26, v27
  buffer_store_dwordx4 v[120:123], v2, s[4:7], s29 offen offset:3072 sc1
  s_branch M_tdone
M_tdone:
  v_mov_b32 v16, 64
  v_or_b32 v17, s13, v2
  v_min_u32 v17, 1, v17
  v_lshlrev_b32 v17, 30, v17
  s_waitcnt vmcnt(0)
  s_barrier
  buffer_store_dword v16, v17, s[4:7], s15 offen sc1
  s_branch M_done
M_worker:
  s_load_dwordx4 s[72:75], s[0:1], 120
  v_lshrrev_b32 v3, 6, v0
  v_and_b32 v1, 63, v0
  v_readfirstlane_b32 s16, v3
  v_lshlrev_b32 v2, 4, v1
  s_waitcnt lgkmcnt(0)
  s_mov_b64 s[4:5], s[74:75]
  s_mov_b64 s[74:75], s[72:73]
  s_mov_b64 s[72:73], s[4:5]
  s_and_b32 s5, s5, 0xffff
  s_mov_b32 s6, 268435456
  s_mov_b32 s7, 0x20000
  s_sub_u32 s66, s76, 1
  s_lshl_b32 s66, s66, 5
  s_add_u32 s66, s66, s77
  s_mul_i32 s64, s66, 9363
  s_lshr_b32 s64, s64, 16
  s_mul_i32 s67, s64, 7
  s_sub_u32 s65, s66, s67
  s_lshl_b32 s31, s66, 7
  s_add_u32 s31, s31, 148897792
  s_lshl_b32 s67, s67, 7
  s_add_u32 s67, s67, 148897792
  s_getpc_b64 s[76:77]
M_pc:
  s_add_u32 s76, s76, M_table-M_pc
  s_addc_u32 s77, s77, 0
  s_lshl_b32 s26, s65, 6
  s_load_dwordx16 s[48:63], s[76:77], s26
  s_waitcnt lgkmcnt(0)
  s_mov_b32 s23, s51
  s_cmp_lg_u32 s48, 1
  s_cbranch_scc1 M_nobpf
  s_load_dwordx8 s[36:43], s[0:1], 64
  s_mul_i32 s76, s64, 3
  s_add_u32 s76, s76, s57
  v_lshlrev_b32 v4, 7, v0
  s_mov_b32 s10, 4194304
  s_mov_b32 s11, 0x20000
  s_waitcnt lgkmcnt(0)
  s_mov_b32 s8, s42
  s_and_b32 s9, s43, 0xffff
  s_mul_i32 s77, s76, 43776
  s_add_u32 s77, s77, 0
  v_min_u32 v5, 32640, v4
  v_add_u32 v5, s77, v5
  s_add_u32 s77, s77, 32768
  buffer_load_dword v6, v5, s[8:11], 0 offen
  v_min_u32 v5, 10880, v4
  v_add_u32 v5, s77, v5
  s_add_u32 s77, s77, 32768
  buffer_load_dword v6, v5, s[8:11], 0 offen
  s_mov_b32 s8, s38
  s_and_b32 s9, s39, 0xffff
  s_mul_i32 s77, s76, 21888
  s_add_u32 s77, s77, 2097152
  v_min_u32 v5, 21760, v4
  v_add_u32 v5, s77, v5
  s_add_u32 s77, s77, 32768
  buffer_load_dword v6, v5, s[8:11], 0 offen
  s_mov_b32 s8, s40
  s_and_b32 s9, s41, 0xffff
  s_mul_i32 s77, s76, 21888
  s_add_u32 s77, s77, 2097152
  v_min_u32 v5, 21760, v4
  v_add_u32 v5, s77, v5
  s_add_u32 s77, s77, 32768
  buffer_load_dword v6, v5, s[8:11], 0 offen
  s_mov_b32 s8, s36
  s_and_b32 s9, s37, 0xffff
  s_mul_i32 s77, s76, 21888
  s_add_u32 s77, s77, 2097152
  v_min_u32 v5, 21760, v4
  v_add_u32 v5, s77, v5
  s_add_u32 s77, s77, 32768
  buffer_load_dword v6, v5, s[8:11], 0 offen
  s_waitcnt vmcnt(0)
M_nobpf:
  s_lshr_b32 s29, s16, 1
  s_cmp_eq_u32 s29, 0
  s_cselect_b32 s26, 2, 8
  s_cselect_b32 s27, 3, 4
  s_cselect_b32 s28, 9, 10
  s_cmp_eq_u32 s48, 1
  s_cselect_b32 s26, s27, s26
  s_cmp_eq_u32 s48, 2
  s_cselect_b32 s26, s28, s26
  s_lshl_b32 s26, s26, 3
  s_load_dwordx2 s[8:9], s[0:1], s26
  s_cmp_eq_u32 s48, 1
  s_cselect_b32 s26, 8, 0
  s_load_dwordx2 s[12:13], s[0:1], s26
  s_cmp_eq_u32 s29, 0
  s_cselect_b32 s21, 0, 3
  s_cselect_b32 s27, 1, 2
  s_cselect_b32 s28, 4, 5
  s_cmp_eq_u32 s48, 1
  s_cselect_b32 s21, s27, s21
  s_cmp_eq_u32 s48, 2
  s_cselect_b32 s21, s28, s21
  s_lshl_b32 s21, s21, 5
  s_add_u32 s21, s21, s64
  s_lshl_b32 s21, s21, 6
  s_add_u32 s21, s21, s49
  s_and_b32 s27, s16, 1
  s_lshl_b32 s21, s21, 1
  s_add_u32 s21, s21, s27
  s_lshl_b32 s21, s21, 12
  s_lshl_b32 s22, s50, 13
  s_lshl_b32 s19, s49, 15
  s_lshl_b32 s20, s50, 15
  s_lshl_b32 s17, s64, 1
  s_add_u32 s17, s17, s27
  s_lshl_b32 s17, s17, 7
  s_mov_b32 s18, 8192
  s_mov_b32 s24, 0x3e0293ee
  s_waitcnt lgkmcnt(0)
  s_and_b32 s9, s9, 0xffff
  s_mov_b32 s10, 4194304
  s_mov_b32 s11, 0x20000
  s_and_b32 s13, s13, 0xffff
  s_mov_b32 s14, 2097152
  s_mov_b32 s15, 0x20000
  s_cmp_eq_u32 s48, 0
  s_cselect_b32 s32, 0, s16
  s_lshr_b32 s32, s32, 1
  v_lshrrev_b32 v144, 4, v1
  v_and_b32 v56, 0xff, v2
  v_lshl_add_u32 v56, v144, 9, v56
  v_and_b32 v146, 15, v1
  v_and_b32 v144, 8, v1
  v_add_u32 v144, v144, v146
  s_cmp_lg_u32 s32, 0
  s_cselect_b64 vcc, -1, 0
  s_cselect_b32 s26, 8, 16
  v_cndmask_b32 v144, v146, v144, vcc
  v_lshrrev_b32 v145, 4, v1
  v_add_u32 v148, s26, v144
  v_xor_b32 v147, 0, v145
  v_xor_b32 v147, v147, v146
  v_lshlrev_b32 v147, 4, v147
  v_lshl_add_u32 v8, v144, 8, v147
  v_xor_b32 v147, 8, v145
  v_xor_b32 v147, v147, v146
  v_lshlrev_b32 v147, 4, v147
  v_lshl_add_u32 v9, v148, 8, v147
  v_xor_b32 v147, 4, v145
  v_xor_b32 v147, v147, v146
  v_lshlrev_b32 v147, 4, v147
  v_lshl_add_u32 v10, v144, 8, v147
  v_xor_b32 v147, 12, v145
  v_xor_b32 v147, v147, v146
  v_lshlrev_b32 v147, 4, v147
  v_lshl_add_u32 v11, v148, 8, v147
  v_xor_b32 v147, 8, v145
  v_xor_b32 v147, v147, v146
  v_lshlrev_b32 v147, 4, v147
  v_lshl_add_u32 v12, v144, 8, v147
  v_xor_b32 v147, 0, v145
  v_xor_b32 v147, v147, v146
  v_lshlrev_b32 v147, 4, v147
  v_lshl_add_u32 v13, v148, 8, v147
  v_xor_b32 v147, 12, v145
  v_xor_b32 v147, v147, v146
  v_lshlrev_b32 v147, 4, v147
  v_lshl_add_u32 v14, v144, 8, v147
  v_xor_b32 v147, 4, v145
  v_xor_b32 v147, v147, v146
  v_lshlrev_b32 v147, 4, v147
  v_lshl_add_u32 v15, v148, 8, v147
  v_lshrrev_b32 v144, 4, v1
  s_lshl_b32 s26, s16, 8
  v_add_u32 v145, 0, v144
  v_or_b32 v147, 0, v144
  v_xor_b32 v147, v147, v146
  v_lshlrev_b32 v147, 4, v147
  v_lshl_add_u32 v147, v145, 10, v147
  v_add_u32 v16, s26, v147
  v_add_u32 v145, 4, v144
  v_or_b32 v147, 4, v144
  v_xor_b32 v147, v147, v146
  v_lshlrev_b32 v147, 4, v147
  v_lshl_add_u32 v147, v145, 10, v147
  v_add_u32 v17, s26, v147
  v_add_u32 v145, 8, v144
  v_or_b32 v147, 8, v144
  v_xor_b32 v147, v147, v146
  v_lshlrev_b32 v147, 4, v147
  v_lshl_add_u32 v147, v145, 10, v147
  v_add_u32 v18, s26, v147
  v_add_u32 v145, 12, v144
  v_or_b32 v147, 12, v144
  v_xor_b32 v147, v147, v146
  v_lshlrev_b32 v147, 4, v147
  v_lshl_add_u32 v147, v145, 10, v147
  v_add_u32 v19, s26, v147
  v_add_u32 v145, 16, v144
  v_or_b32 v147, 8, v144
  v_xor_b32 v147, v147, v146
  v_lshlrev_b32 v147, 4, v147
  v_lshl_add_u32 v147, v145, 10, v147
  v_add_u32 v20, s26, v147
  v_add_u32 v145, 20, v144
  v_or_b32 v147, 12, v144
  v_xor_b32 v147, v147, v146
  v_lshlrev_b32 v147, 4, v147
  v_lshl_add_u32 v147, v145, 10, v147
  v_add_u32 v21, s26, v147
  v_add_u32 v145, 24, v144
  v_or_b32 v147, 0, v144
  v_xor_b32 v147, v147, v146
  v_lshlrev_b32 v147, 4, v147
  v_lshl_add_u32 v147, v145, 10, v147
  v_add_u32 v22, s26, v147
  v_add_u32 v145, 28, v144
  v_or_b32 v147, 4, v144
  v_xor_b32 v147, v147, v146
  v_lshlrev_b32 v147, 4, v147
  v_lshl_add_u32 v147, v145, 10, v147
  v_add_u32 v23, s26, v147
  v_lshrrev_b32 v144, 3, v1
  v_mul_lo_u32 v144, v144, s18
  v_and_b32 v145, 7, v1
  v_lshl_add_u32 v144, v145, 4, v144
  s_lshl_b32 s28, s16, 15
  s_add_u32 s28, s28, 32768
  s_lshl_b32 s29, s18, 3
  s_add_u32 m0, s28, 0
  s_nop 0
  buffer_load_dwordx4 v144, s[8:11], s17 offen lds
  s_add_u32 s17, s17, s29
  s_add_u32 m0, s28, 1024
  s_nop 0
  buffer_load_dwordx4 v144, s[8:11], s17 offen lds
  s_add_u32 s17, s17, s29
  s_add_u32 m0, s28, 2048
  s_nop 0
  buffer_load_dwordx4 v144, s[8:11], s17 offen lds
  s_add_u32 s17, s17, s29
  s_add_u32 m0, s28, 3072
  s_nop 0
  buffer_load_dwordx4 v144, s[8:11], s17 offen lds
  s_add_u32 s17, s17, s29
  s_add_u32 m0, s28, 4096
  s_nop 0
  buffer_load_dwordx4 v144, s[8:11], s17 offen lds
  s_add_u32 s17, s17, s29
  s_add_u32 m0, s28, 5120
  s_nop 0
  buffer_load_dwordx4 v144, s[8:11], s17 offen lds
  s_add_u32 s17, s17, s29
  s_add_u32 m0, s28, 6144
  s_nop 0
  buffer_load_dwordx4 v144, s[8:11], s17 offen lds
  s_add_u32 s17, s17, s29
  s_add_u32 m0, s28, 7168
  s_nop 0
  buffer_load_dwordx4 v144, s[8:11], s17 offen lds
  s_add_u32 s17, s17, s29
  s_add_u32 m0, s28, 8192
  s_nop 0
  buffer_load_dwordx4 v144, s[8:11], s17 offen lds
  s_add_u32 s17, s17, s29
  s_add_u32 m0, s28, 9216
  s_nop 0
  buffer_load_dwordx4 v144, s[8:11], s17 offen lds
  s_add_u32 s17, s17, s29
  s_add_u32 m0, s28, 10240
  s_nop 0
  buffer_load_dwordx4 v144, s[8:11], s17 offen lds
  s_add_u32 s17, s17, s29
  s_add_u32 m0, s28, 11264
  s_nop 0
  buffer_load_dwordx4 v144, s[8:11], s17 offen lds
  s_add_u32 s17, s17, s29
  s_add_u32 m0, s28, 12288
  s_nop 0
  buffer_load_dwordx4 v144, s[8:11], s17 offen lds
  s_add_u32 s17, s17, s29
  s_add_u32 m0, s28, 13312
  s_nop 0
  buffer_load_dwordx4 v144, s[8:11], s17 offen lds
  s_add_u32 s17, s17, s29
  s_add_u32 m0, s28, 14336
  s_nop 0
  buffer_load_dwordx4 v144, s[8:11], s17 offen lds
  s_add_u32 s17, s17, s29
  s_add_u32 m0, s28, 15360
  s_nop 0
  buffer_load_dwordx4 v144, s[8:11], s17 offen lds
  s_add_u32 s17, s17, s29
  s_add_u32 m0, s28, 16384
  s_nop 0
  buffer_load_dwordx4 v144, s[8:11], s17 offen lds
  s_add_u32 s17, s17, s29
  s_add_u32 m0, s28, 17408
  s_nop 0
  buffer_load_dwordx4 v144, s[8:11], s17 offen lds
  s_add_u32 s17, s17, s29
  s_add_u32 m0, s28, 18432
  s_nop 0
  buffer_load_dwordx4 v144, s[8:11], s17 offen lds
  s_add_u32 s17, s17, s29
  s_add_u32 m0, s28, 19456
  s_nop 0
  buffer_load_dwordx4 v144, s[8:11], s17 offen lds
  s_add_u32 s17, s17, s29
  s_add_u32 m0, s28, 20480
  s_nop 0
  buffer_load_dwordx4 v144, s[8:11], s17 offen lds
  s_add_u32 s17, s17, s29
  s_add_u32 m0, s28, 21504
  s_nop 0
  buffer_load_dwordx4 v144, s[8:11], s17 offen lds
  s_add_u32 s17, s17, s29
  s_add_u32 m0, s28, 22528
  s_nop 0
  buffer_load_dwordx4 v144, s[8:11], s17 offen lds
  s_add_u32 s17, s17, s29
  s_add_u32 m0, s28, 23552
  s_nop 0
  buffer_load_dwordx4 v144, s[8:11], s17 offen lds
  s_add_u32 s17, s17, s29
  s_add_u32 m0, s28, 24576
  s_nop 0
  buffer_load_dwordx4 v144, s[8:11], s17 offen lds
  s_add_u32 s17, s17, s29
  s_add_u32 m0, s28, 25600
  s_nop 0
  buffer_load_dwordx4 v144, s[8:11], s17 offen lds
  s_add_u32 s17, s17, s29
  s_add_u32 m0, s28, 26624
  s_nop 0
  buffer_load_dwordx4 v144, s[8:11], s17 offen lds
  s_add_u32 s17, s17, s29
  s_add_u32 m0, s28, 27648
  s_nop 0
  buffer_load_dwordx4 v144, s[8:11], s17 offen lds
  s_add_u32 s17, s17, s29
  s_add_u32 m0, s28, 28672
  s_nop 0
  buffer_load_dwordx4 v144, s[8:11], s17 offen lds
  s_add_u32 s17, s17, s29
  s_add_u32 m0, s28, 29696
  s_nop 0
  buffer_load_dwordx4 v144, s[8:11], s17 offen lds
  s_add_u32 s17, s17, s29
  s_add_u32 m0, s28, 30720
  s_nop 0
  buffer_load_dwordx4 v144, s[8:11], s17 offen lds
  s_add_u32 s17, s17, s29
  s_add_u32 m0, s28, 31744
  s_nop 0
  buffer_load_dwordx4 v144, s[8:11], s17 offen lds
  s_add_u32 s17, s17, s29
  s_lshl_b32 s25, s16, 13
  s_add_u32 m0, s25, 0
  s_nop 0
  buffer_load_dwordx4 v16, s[12:15], s19 offen lds
  s_add_u32 m0, s25, 1024
  s_nop 0
  buffer_load_dwordx4 v17, s[12:15], s19 offen lds
  s_add_u32 m0, s25, 2048
  s_nop 0
  buffer_load_dwordx4 v18, s[12:15], s19 offen lds
  s_add_u32 m0, s25, 3072
  s_nop 0
  buffer_load_dwordx4 v19, s[12:15], s19 offen lds
  s_add_u32 m0, s25, 4096
  s_nop 0
  buffer_load_dwordx4 v20, s[12:15], s19 offen lds
  s_add_u32 m0, s25, 5120
  s_nop 0
  buffer_load_dwordx4 v21, s[12:15], s19 offen lds
  s_add_u32 m0, s25, 6144
  s_nop 0
  buffer_load_dwordx4 v22, s[12:15], s19 offen lds
  s_add_u32 m0, s25, 7168
  s_nop 0
  buffer_load_dwordx4 v23, s[12:15], s19 offen lds
  s_cmp_gt_u32 s23, 1
  s_cselect_b32 s26, s20, 0
  s_add_u32 s19, s19, s26
  s_add_u32 s25, s25, 32768
  s_and_b32 s25, s25, 0x1ffff
  s_cmp_lg_u32 s16, 3
  s_cbranch_scc1 M_noinit
  s_mov_b32 s79, 0
  s_atomic_swap s79, s[72:73], s31 glc
  s_waitcnt lgkmcnt(0)
  s_mov_b32 s79, 1
  s_atomic_add s79, s[74:75], 128
M_noinit:
  s_cmp_lg_u32 s65, 3
  s_cbranch_scc1 M_noarm
  v_lshlrev_b32 v4, 4, v0
  v_mov_b64 v[60:61], -1
  v_mov_b64 v[62:63], -1
  s_mul_i32 s76, s64, 4096
  s_add_u32 s77, s76, 142868480
  buffer_store_dwordx4 v[60:63], v4, s[4:7], s77 offen sc1
  s_add_u32 s77, s76, 142999552
  buffer_store_dwordx4 v[60:63], v4, s[4:7], s77 offen sc1
  s_add_u32 s77, s76, 143130624
  buffer_store_dwordx4 v[60:63], v4, s[4:7], s77 offen sc1
  s_add_u32 s77, s76, 143261696
  buffer_store_dwordx4 v[60:63], v4, s[4:7], s77 offen sc1
  s_add_u32 s77, s76, 143392768
  buffer_store_dwordx4 v[60:63], v4, s[4:7], s77 offen sc1
  s_add_u32 s77, s76, 143523840
  buffer_store_dwordx4 v[60:63], v4, s[4:7], s77 offen sc1
M_noarm:
  s_mul_i32 s76, s64, 3
  s_add_u32 s76, s76, s57
  s_mul_i32 s76, s76, 24576
  v_lshlrev_b32 v4, 7, v0
  v_add_u32 v4, s76, v4
  buffer_load_dword v5, v4, s[12:15], 0 offen
  v_bfe_u32 v148, v1, 2, 2
  v_lshrrev_b32 v149, 5, v1
  v_lshl_add_u32 v148, v149, 4, v148
  v_bfe_u32 v149, v1, 4, 1
  v_lshl_add_u32 v148, v149, 3, v148
  v_and_b32 v149, 3, v1
  v_and_b32 v150, 2, v149
  v_add_u32 v150, v150, v149
  s_cmp_lg_u32 s32, 0
  s_cselect_b64 vcc, -1, 0
  s_cselect_b32 s26, 32, 16
  v_cndmask_b32 v149, v150, v149, vcc
  v_lshlrev_b32 v149, 3, v149
  v_lshl_add_u32 v148, v148, 7, v149
  v_add_u32 v152, s28, v148
  v_add_u32 v153, 512, v152
  v_add_u32 v154, s26, v152
  v_add_u32 v155, s26, v153
  s_waitcnt vmcnt(37)
  ds_read_b64_tr_b16 a[0:1], v152 offset:0
  ds_read_b64_tr_b16 a[2:3], v153 offset:0
  ds_read_b64_tr_b16 a[4:5], v154 offset:0
  ds_read_b64_tr_b16 a[6:7], v155 offset:0
  ds_read_b64_tr_b16 a[8:9], v152 offset:64
  ds_read_b64_tr_b16 a[10:11], v153 offset:64
  ds_read_b64_tr_b16 a[12:13], v154 offset:64
  ds_read_b64_tr_b16 a[14:15], v155 offset:64
  s_waitcnt lgkmcnt(0)
  s_add_u32 m0, s28, 0
  s_nop 0
  buffer_load_dwordx4 v144, s[8:11], s17 offen lds
  s_add_u32 s17, s17, s29
  s_add_u32 m0, s28, 1024
  s_nop 0
  buffer_load_dwordx4 v144, s[8:11], s17 offen lds
  s_add_u32 s17, s17, s29
  s_add_u32 m0, s28, 2048
  s_nop 0
  buffer_load_dwordx4 v144, s[8:11], s17 offen lds
  s_add_u32 s17, s17, s29
  s_add_u32 m0, s28, 3072
  s_nop 0
  buffer_load_dwordx4 v144, s[8:11], s17 offen lds
  s_add_u32 s17, s17, s29
  s_waitcnt vmcnt(37)
  ds_read_b64_tr_b16 a[16:17], v152 offset:4096
  ds_read_b64_tr_b16 a[18:19], v153 offset:4096
  ds_read_b64_tr_b16 a[20:21], v154 offset:4096
  ds_read_b64_tr_b16 a[22:23], v155 offset:4096
  ds_read_b64_tr_b16 a[24:25], v152 offset:4160
  ds_read_b64_tr_b16 a[26:27], v153 offset:4160
  ds_read_b64_tr_b16 a[28:29], v154 offset:4160
  ds_read_b64_tr_b16 a[30:31], v155 offset:4160
  s_waitcnt lgkmcnt(0)
  s_add_u32 m0, s28, 4096
  s_nop 0
  buffer_load_dwordx4 v144, s[8:11], s17 offen lds
  s_add_u32 s17, s17, s29
  s_add_u32 m0, s28, 5120
  s_nop 0
  buffer_load_dwordx4 v144, s[8:11], s17 offen lds
  s_add_u32 s17, s17, s29
  s_add_u32 m0, s28, 6144
  s_nop 0
  buffer_load_dwordx4 v144, s[8:11], s17 offen lds
  s_add_u32 s17, s17, s29
  s_add_u32 m0, s28, 7168
  s_nop 0
  buffer_load_dwordx4 v144, s[8:11], s17 offen lds
  s_add_u32 s17, s17, s29
  s_waitcnt vmcnt(37)
  ds_read_b64_tr_b16 a[32:33], v152 offset:8192
  ds_read_b64_tr_b16 a[34:35], v153 offset:8192
  ds_read_b64_tr_b16 a[36:37], v154 offset:8192
  ds_read_b64_tr_b16 a[38:39], v155 offset:8192
  ds_read_b64_tr_b16 a[40:41], v152 offset:8256
  ds_read_b64_tr_b16 a[42:43], v153 offset:8256
  ds_read_b64_tr_b16 a[44:45], v154 offset:8256
  ds_read_b64_tr_b16 a[46:47], v155 offset:8256
  s_waitcnt lgkmcnt(0)
  s_add_u32 m0, s28, 8192
  s_nop 0
  buffer_load_dwordx4 v144, s[8:11], s17 offen lds
  s_add_u32 s17, s17, s29
  s_add_u32 m0, s28, 9216
  s_nop 0
  buffer_load_dwordx4 v144, s[8:11], s17 offen lds
  s_add_u32 s17, s17, s29
  s_add_u32 m0, s28, 10240
  s_nop 0
  buffer_load_dwordx4 v144, s[8:11], s17 offen lds
  s_add_u32 s17, s17, s29
  s_add_u32 m0, s28, 11264
  s_nop 0
  buffer_load_dwordx4 v144, s[8:11], s17 offen lds
  s_add_u32 s17, s17, s29
  s_waitcnt vmcnt(37)
  ds_read_b64_tr_b16 a[48:49], v152 offset:12288
  ds_read_b64_tr_b16 a[50:51], v153 offset:12288
  ds_read_b64_tr_b16 a[52:53], v154 offset:12288
  ds_read_b64_tr_b16 a[54:55], v155 offset:12288
  ds_read_b64_tr_b16 a[56:57], v152 offset:12352
  ds_read_b64_tr_b16 a[58:59], v153 offset:12352
  ds_read_b64_tr_b16 a[60:61], v154 offset:12352
  ds_read_b64_tr_b16 a[62:63], v155 offset:12352
  s_waitcnt lgkmcnt(0)
  s_add_u32 m0, s28, 12288
  s_nop 0
  buffer_load_dwordx4 v144, s[8:11], s17 offen lds
  s_add_u32 s17, s17, s29
  s_add_u32 m0, s28, 13312
  s_nop 0
  buffer_load_dwordx4 v144, s[8:11], s17 offen lds
  s_add_u32 s17, s17, s29
  s_add_u32 m0, s28, 14336
  s_nop 0
  buffer_load_dwordx4 v144, s[8:11], s17 offen lds
  s_add_u32 s17, s17, s29
  s_add_u32 m0, s28, 15360
  s_nop 0
  buffer_load_dwordx4 v144, s[8:11], s17 offen lds
  s_add_u32 s17, s17, s29
  s_waitcnt vmcnt(37)
  ds_read_b64_tr_b16 a[64:65], v152 offset:16384
  ds_read_b64_tr_b16 a[66:67], v153 offset:16384
  ds_read_b64_tr_b16 a[68:69], v154 offset:16384
  ds_read_b64_tr_b16 a[70:71], v155 offset:16384
  ds_read_b64_tr_b16 a[72:73], v152 offset:16448
  ds_read_b64_tr_b16 a[74:75], v153 offset:16448
  ds_read_b64_tr_b16 a[76:77], v154 offset:16448
  ds_read_b64_tr_b16 a[78:79], v155 offset:16448
  s_waitcnt lgkmcnt(0)
  s_add_u32 m0, s28, 16384
  s_nop 0
  buffer_load_dwordx4 v144, s[8:11], s17 offen lds
  s_add_u32 s17, s17, s29
  s_add_u32 m0, s28, 17408
  s_nop 0
  buffer_load_dwordx4 v144, s[8:11], s17 offen lds
  s_add_u32 s17, s17, s29
  s_add_u32 m0, s28, 18432
  s_nop 0
  buffer_load_dwordx4 v144, s[8:11], s17 offen lds
  s_add_u32 s17, s17, s29
  s_add_u32 m0, s28, 19456
  s_nop 0
  buffer_load_dwordx4 v144, s[8:11], s17 offen lds
  s_add_u32 s17, s17, s29
  s_waitcnt vmcnt(37)
  ds_read_b64_tr_b16 a[80:81], v152 offset:20480
  ds_read_b64_tr_b16 a[82:83], v153 offset:20480
  ds_read_b64_tr_b16 a[84:85], v154 offset:20480
  ds_read_b64_tr_b16 a[86:87], v155 offset:20480
  ds_read_b64_tr_b16 a[88:89], v152 offset:20544
  ds_read_b64_tr_b16 a[90:91], v153 offset:20544
  ds_read_b64_tr_b16 a[92:93], v154 offset:20544
  ds_read_b64_tr_b16 a[94:95], v155 offset:20544
  s_waitcnt lgkmcnt(0)
  s_add_u32 m0, s28, 20480
  s_nop 0
  buffer_load_dwordx4 v144, s[8:11], s17 offen lds
  s_add_u32 s17, s17, s29
  s_add_u32 m0, s28, 21504
  s_nop 0
  buffer_load_dwordx4 v144, s[8:11], s17 offen lds
  s_add_u32 s17, s17, s29
  s_add_u32 m0, s28, 22528
  s_nop 0
  buffer_load_dwordx4 v144, s[8:11], s17 offen lds
  s_add_u32 s17, s17, s29
  s_add_u32 m0, s28, 23552
  s_nop 0
  buffer_load_dwordx4 v144, s[8:11], s17 offen lds
  s_add_u32 s17, s17, s29
  s_waitcnt vmcnt(37)
  ds_read_b64_tr_b16 a[96:97], v152 offset:24576
  ds_read_b64_tr_b16 a[98:99], v153 offset:24576
  ds_read_b64_tr_b16 a[100:101], v154 offset:24576
  ds_read_b64_tr_b16 a[102:103], v155 offset:24576
  ds_read_b64_tr_b16 a[104:105], v152 offset:24640
  ds_read_b64_tr_b16 a[106:107], v153 offset:24640
  ds_read_b64_tr_b16 a[108:109], v154 offset:24640
  ds_read_b64_tr_b16 a[110:111], v155 offset:24640
  s_waitcnt lgkmcnt(0)
  s_add_u32 m0, s28, 24576
  s_nop 0
  buffer_load_dwordx4 v144, s[8:11], s17 offen lds
  s_add_u32 s17, s17, s29
  s_add_u32 m0, s28, 25600
  s_nop 0
  buffer_load_dwordx4 v144, s[8:11], s17 offen lds
  s_add_u32 s17, s17, s29
  s_add_u32 m0, s28, 26624
  s_nop 0
  buffer_load_dwordx4 v144, s[8:11], s17 offen lds
  s_add_u32 s17, s17, s29
  s_add_u32 m0, s28, 27648
  s_nop 0
  buffer_load_dwordx4 v144, s[8:11], s17 offen lds
  s_add_u32 s17, s17, s29
  s_waitcnt vmcnt(37)
  ds_read_b64_tr_b16 a[112:113], v152 offset:28672
  ds_read_b64_tr_b16 a[114:115], v153 offset:28672
  ds_read_b64_tr_b16 a[116:117], v154 offset:28672
  ds_read_b64_tr_b16 a[118:119], v155 offset:28672
  ds_read_b64_tr_b16 a[120:121], v152 offset:28736
  ds_read_b64_tr_b16 a[122:123], v153 offset:28736
  ds_read_b64_tr_b16 a[124:125], v154 offset:28736
  ds_read_b64_tr_b16 a[126:127], v155 offset:28736
  s_waitcnt lgkmcnt(0)
  s_add_u32 m0, s28, 28672
  s_nop 0
  buffer_load_dwordx4 v144, s[8:11], s17 offen lds
  s_add_u32 s17, s17, s29
  s_add_u32 m0, s28, 29696
  s_nop 0
  buffer_load_dwordx4 v144, s[8:11], s17 offen lds
  s_add_u32 s17, s17, s29
  s_add_u32 m0, s28, 30720
  s_nop 0
  buffer_load_dwordx4 v144, s[8:11], s17 offen lds
  s_add_u32 s17, s17, s29
  s_add_u32 m0, s28, 31744
  s_nop 0
  buffer_load_dwordx4 v144, s[8:11], s17 offen lds
  s_add_u32 s17, s17, s29
  s_waitcnt vmcnt(28)
  ds_read_b64_tr_b16 a[128:129], v152 offset:0
  ds_read_b64_tr_b16 a[130:131], v153 offset:0
  ds_read_b64_tr_b16 a[132:133], v154 offset:0
  ds_read_b64_tr_b16 a[134:135], v155 offset:0
  ds_read_b64_tr_b16 a[136:137], v152 offset:64
  ds_read_b64_tr_b16 a[138:139], v153 offset:64
  ds_read_b64_tr_b16 a[140:141], v154 offset:64
  ds_read_b64_tr_b16 a[142:143], v155 offset:64
  s_waitcnt lgkmcnt(0)
  s_waitcnt vmcnt(24)
  ds_read_b64_tr_b16 a[144:145], v152 offset:4096
  ds_read_b64_tr_b16 a[146:147], v153 offset:4096
  ds_read_b64_tr_b16 a[148:149], v154 offset:4096
  ds_read_b64_tr_b16 a[150:151], v155 offset:4096
  ds_read_b64_tr_b16 a[152:153], v152 offset:4160
  ds_read_b64_tr_b16 a[154:155], v153 offset:4160
  ds_read_b64_tr_b16 a[156:157], v154 offset:4160
  ds_read_b64_tr_b16 a[158:159], v155 offset:4160
  s_waitcnt lgkmcnt(0)
  s_waitcnt vmcnt(20)
  ds_read_b64_tr_b16 a[160:161], v152 offset:8192
  ds_read_b64_tr_b16 a[162:163], v153 offset:8192
  ds_read_b64_tr_b16 a[164:165], v154 offset:8192
  ds_read_b64_tr_b16 a[166:167], v155 offset:8192
  ds_read_b64_tr_b16 a[168:169], v152 offset:8256
  ds_read_b64_tr_b16 a[170:171], v153 offset:8256
  ds_read_b64_tr_b16 a[172:173], v154 offset:8256
  ds_read_b64_tr_b16 a[174:175], v155 offset:8256
  s_waitcnt lgkmcnt(0)
  s_waitcnt vmcnt(16)
  ds_read_b64_tr_b16 a[176:177], v152 offset:12288
  ds_read_b64_tr_b16 a[178:179], v153 offset:12288
  ds_read_b64_tr_b16 a[180:181], v154 offset:12288
  ds_read_b64_tr_b16 a[182:183], v155 offset:12288
  ds_read_b64_tr_b16 a[184:185], v152 offset:12352
  ds_read_b64_tr_b16 a[186:187], v153 offset:12352
  ds_read_b64_tr_b16 a[188:189], v154 offset:12352
  ds_read_b64_tr_b16 a[190:191], v155 offset:12352
  s_waitcnt lgkmcnt(0)
  s_waitcnt vmcnt(12)
  ds_read_b64_tr_b16 a[192:193], v152 offset:16384
  ds_read_b64_tr_b16 a[194:195], v153 offset:16384
  ds_read_b64_tr_b16 a[196:197], v154 offset:16384
  ds_read_b64_tr_b16 a[198:199], v155 offset:16384
  ds_read_b64_tr_b16 a[200:201], v152 offset:16448
  ds_read_b64_tr_b16 a[202:203], v153 offset:16448
  ds_read_b64_tr_b16 a[204:205], v154 offset:16448
  ds_read_b64_tr_b16 a[206:207], v155 offset:16448
  s_waitcnt lgkmcnt(0)
  s_waitcnt vmcnt(8)
  ds_read_b64_tr_b16 a[208:209], v152 offset:20480
  ds_read_b64_tr_b16 a[210:211], v153 offset:20480
  ds_read_b64_tr_b16 a[212:213], v154 offset:20480
  ds_read_b64_tr_b16 a[214:215], v155 offset:20480
  ds_read_b64_tr_b16 a[216:217], v152 offset:20544
  ds_read_b64_tr_b16 a[218:219], v153 offset:20544
  ds_read_b64_tr_b16 a[220:221], v154 offset:20544
  ds_read_b64_tr_b16 a[222:223], v155 offset:20544
  s_waitcnt lgkmcnt(0)
  s_waitcnt vmcnt(4)
  ds_read_b64_tr_b16 a[224:225], v152 offset:24576
  ds_read_b64_tr_b16 a[226:227], v153 offset:24576
  ds_read_b64_tr_b16 a[228:229], v154 offset:24576
  ds_read_b64_tr_b16 a[230:231], v155 offset:24576
  ds_read_b64_tr_b16 a[232:233], v152 offset:24640
  ds_read_b64_tr_b16 a[234:235], v153 offset:24640
  ds_read_b64_tr_b16 a[236:237], v154 offset:24640
  ds_read_b64_tr_b16 a[238:239], v155 offset:24640
  s_waitcnt lgkmcnt(0)
  s_waitcnt vmcnt(0)
  ds_read_b64_tr_b16 a[240:241], v152 offset:28672
  ds_read_b64_tr_b16 a[242:243], v153 offset:28672
  ds_read_b64_tr_b16 a[244:245], v154 offset:28672
  ds_read_b64_tr_b16 a[246:247], v155 offset:28672
  ds_read_b64_tr_b16 a[248:249], v152 offset:28736
  ds_read_b64_tr_b16 a[250:251], v153 offset:28736
  ds_read_b64_tr_b16 a[252:253], v154 offset:28736
  ds_read_b64_tr_b16 a[254:255], v155 offset:28736
  s_waitcnt lgkmcnt(0)
  s_barrier
  s_add_u32 m0, s25, 0
  s_nop 0
  buffer_load_dwordx4 v16, s[12:15], s19 offen lds
  s_add_u32 m0, s25, 1024
  s_nop 0
  buffer_load_dwordx4 v17, s[12:15], s19 offen lds
  s_add_u32 m0, s25, 2048
  s_nop 0
  buffer_load_dwordx4 v18, s[12:15], s19 offen lds
  s_add_u32 m0, s25, 3072
  s_nop 0
  buffer_load_dwordx4 v19, s[12:15], s19 offen lds
  s_add_u32 m0, s25, 4096
  s_nop 0
  buffer_load_dwordx4 v20, s[12:15], s19 offen lds
  s_add_u32 m0, s25, 5120
  s_nop 0
  buffer_load_dwordx4 v21, s[12:15], s19 offen lds
  s_add_u32 m0, s25, 6144
  s_nop 0
  buffer_load_dwordx4 v22, s[12:15], s19 offen lds
  s_add_u32 m0, s25, 7168
  s_nop 0
  buffer_load_dwordx4 v23, s[12:15], s19 offen lds
  s_cmp_gt_u32 s23, 2
  s_cselect_b32 s26, s20, 0
  s_add_u32 s19, s19, s26
  s_add_u32 s25, s25, 32768
  s_and_b32 s25, s25, 0x1ffff
  s_waitcnt vmcnt(0)
  s_barrier
  s_load_dwordx2 s[8:9], s[0:1], 40
  s_mul_i32 s76, s66, 18816
  v_min_u32 v200, 146, v0
  v_lshl_add_u32 v200, v200, 7, s76
  s_waitcnt lgkmcnt(0)
  s_and_b32 s9, s9, 0xffff
  buffer_load_dword v201, v200, s[8:11], 0 offen
  s_cmp_lg_u32 s32, 0
  s_cbranch_scc1 P_v_170
  s_cmp_eq_u32 s48, 0
  s_cbranch_scc1 P_q_172
  s_mov_b32 s27, s21
  v_mov_b32 v7, 0x40000000
  s_mov_b32 s29, -2
  v_min_u32 v145, 1, v0
  v_lshlrev_b32 v145, 30, v145
  ds_read_b128 v[24:27], v8 offset:0
  ds_read_b128 v[28:31], v9 offset:0
  ds_read_b128 v[32:35], v10 offset:0
  ds_read_b128 v[36:39], v11 offset:0
  ds_read_b128 v[40:43], v12 offset:0
  ds_read_b128 v[44:47], v13 offset:0
.p2align 6
G_top_173:
  s_waitcnt lgkmcnt(5)
  v_mfma_f32_16x16x32_bf16 v[64:67], a[0:3], v[24:27], 0
  s_add_u32 m0, s25, 0
  ds_read_b128 v[48:51], v14 offset:0
  v_mfma_f32_16x16x32_bf16 v[68:71], a[4:7], v[24:27], 0
  v_mfma_f32_16x16x32_bf16 v[80:83], a[8:11], v[24:27], 0
  buffer_load_dwordx4 v16, s[12:15], s19 offen lds
  v_mfma_f32_16x16x32_bf16 v[84:87], a[12:15], v[24:27], 0
  s_waitcnt lgkmcnt(5)
  v_mfma_f32_16x16x32_bf16 v[72:75], a[0:3], v[28:31], 0
  ds_read_b128 v[52:55], v15 offset:0
  v_mfma_f32_16x16x32_bf16 v[76:79], a[4:7], v[28:31], 0
  v_cvt_pk_bf16_f32 v128, v96, v97
  v_cvt_pk_bf16_f32 v129, v98, v99
  v_mfma_f32_16x16x32_bf16 v[88:91], a[8:11], v[28:31], 0
  v_mfma_f32_16x16x32_bf16 v[92:95], a[12:15], v[28:31], 0
  s_waitcnt lgkmcnt(5)
  v_cvt_pk_bf16_f32 v130, v100, v101
  v_cvt_pk_bf16_f32 v131, v102, v103
  v_mfma_f32_16x16x32_bf16 v[64:67], a[16:19], v[32:35], v[64:67]
  s_add_u32 m0, s25, 1024
  ds_read_b128 v[24:27], v8 offset:8192
  v_mfma_f32_16x16x32_bf16 v[68:71], a[20:23], v[32:35], v[68:71]
  v_mfma_f32_16x16x32_bf16 v[80:83], a[24:27], v[32:35], v[80:83]
  buffer_load_dwordx4 v17, s[12:15], s19 offen lds
  v_mfma_f32_16x16x32_bf16 v[84:87], a[28:31], v[32:35], v[84:87]
  s_waitcnt lgkmcnt(5)
  v_mfma_f32_16x16x32_bf16 v[72:75], a[16:19], v[36:39], v[72:75]
  ds_read_b128 v[28:31], v9 offset:8192
  v_mfma_f32_16x16x32_bf16 v[76:79], a[20:23], v[36:39], v[76:79]
  v_mfma_f32_16x16x32_bf16 v[88:91], a[24:27], v[36:39], v[88:91]
  v_mfma_f32_16x16x32_bf16 v[92:95], a[28:31], v[36:39], v[92:95]
  s_waitcnt lgkmcnt(5)
  v_mfma_f32_16x16x32_bf16 v[64:67], a[32:35], v[40:43], v[64:67]
  s_add_u32 m0, s25, 2048
  ds_read_b128 v[32:35], v10 offset:8192
  v_mfma_f32_16x16x32_bf16 v[68:71], a[36:39], v[40:43], v[68:71]
  v_cvt_pk_bf16_f32 v132, v104, v105
  v_cvt_pk_bf16_f32 v133, v106, v107
  v_mfma_f32_16x16x32_bf16 v[80:83], a[40:43], v[40:43], v[80:83]
  buffer_load_dwordx4 v18, s[12:15], s19 offen lds
  v_mfma_f32_16x16x32_bf16 v[84:87], a[44:47], v[40:43], v[84:87]
  s_waitcnt lgkmcnt(5)
  v_cvt_pk_bf16_f32 v134, v108, v109
  v_cvt_pk_bf16_f32 v135, v110, v111
  v_mfma_f32_16x16x32_bf16 v[72:75], a[32:35], v[44:47], v[72:75]
  ds_read_b128 v[36:39], v11 offset:8192
  v_mfma_f32_16x16x32_bf16 v[76:79], a[36:39], v[44:47], v[76:79]
  v_mfma_f32_16x16x32_bf16 v[88:91], a[40:43], v[44:47], v[88:91]
  v_mfma_f32_16x16x32_bf16 v[92:95], a[44:47], v[44:47], v[92:95]
  s_waitcnt lgkmcnt(5)
  v_mfma_f32_16x16x32_bf16 v[64:67], a[48:51], v[48:51], v[64:67]
  s_add_u32 m0, s25, 3072
  ds_read_b128 v[40:43], v12 offset:8192
  v_mfma_f32_16x16x32_bf16 v[68:71], a[52:55], v[48:51], v[68:71]
  v_mfma_f32_16x16x32_bf16 v[80:83], a[56:59], v[48:51], v[80:83]
  buffer_load_dwordx4 v19, s[12:15], s19 offen lds
  v_mfma_f32_16x16x32_bf16 v[84:87], a[60:63], v[48:51], v[84:87]
  s_waitcnt lgkmcnt(5)
  v_mfma_f32_16x16x32_bf16 v[72:75], a[48:51], v[52:55], v[72:75]
  ds_read_b128 v[44:47], v13 offset:8192
  v_mfma_f32_16x16x32_bf16 v[76:79], a[52:55], v[52:55], v[76:79]
  v_cvt_pk_bf16_f32 v136, v112, v113
  v_cvt_pk_bf16_f32 v137, v114, v115
  v_mfma_f32_16x16x32_bf16 v[88:91], a[56:59], v[52:55], v[88:91]
  v_mfma_f32_16x16x32_bf16 v[92:95], a[60:63], v[52:55], v[92:95]
  s_waitcnt lgkmcnt(5)
  v_cvt_pk_bf16_f32 v138, v116, v117
  v_cvt_pk_bf16_f32 v139, v118, v119
  v_mfma_f32_16x16x32_bf16 v[64:67], a[64:67], v[24:27], v[64:67]
  s_add_u32 m0, s25, 4096
  ds_read_b128 v[48:51], v14 offset:8192
  v_mfma_f32_16x16x32_bf16 v[68:71], a[68:71], v[24:27], v[68:71]
  v_mfma_f32_16x16x32_bf16 v[80:83], a[72:75], v[24:27], v[80:83]
  buffer_load_dwordx4 v20, s[12:15], s19 offen lds
  v_mfma_f32_16x16x32_bf16 v[84:87], a[76:79], v[24:27], v[84:87]
  s_waitcnt lgkmcnt(5)
  v_mfma_f32_16x16x32_bf16 v[72:75], a[64:67], v[28:31], v[72:75]
  ds_read_b128 v[52:55], v15 offset:8192
  v_mfma_f32_16x16x32_bf16 v[76:79], a[68:71], v[28:31], v[76:79]
  v_mfma_f32_16x16x32_bf16 v[88:91], a[72:75], v[28:31], v[88:91]
  v_mfma_f32_16x16x32_bf16 v[92:95], a[76:79], v[28:31], v[92:95]
  s_waitcnt lgkmcnt(5)
  v_mfma_f32_16x16x32_bf16 v[64:67], a[80:83], v[32:35], v[64:67]
  s_add_u32 m0, s25, 5120
  ds_read_b128 v[24:27], v8 offset:16384
  v_mfma_f32_16x16x32_bf16 v[68:71], a[84:87], v[32:35], v[68:71]
  v_cvt_pk_bf16_f32 v140, v120, v121
  v_cvt_pk_bf16_f32 v141, v122, v123
  v_mfma_f32_16x16x32_bf16 v[80:83], a[88:91], v[32:35], v[80:83]
  buffer_load_dwordx4 v21, s[12:15], s19 offen lds
  v_mfma_f32_16x16x32_bf16 v[84:87], a[92:95], v[32:35], v[84:87]
  s_waitcnt lgkmcnt(5)
  v_cvt_pk_bf16_f32 v142, v124, v125
  v_cvt_pk_bf16_f32 v143, v126, v127
  v_mfma_f32_16x16x32_bf16 v[72:75], a[80:83], v[36:39], v[72:75]
  ds_read_b128 v[28:31], v9 offset:16384
  v_mfma_f32_16x16x32_bf16 v[76:79], a[84:87], v[36:39], v[76:79]
  v_mfma_f32_16x16x32_bf16 v[88:91], a[88:91], v[36:39], v[88:91]
  v_mfma_f32_16x16x32_bf16 v[92:95], a[92:95], v[36:39], v[92:95]
  s_waitcnt lgkmcnt(5)
  v_mfma_f32_16x16x32_bf16 v[64:67], a[96:99], v[40:43], v[64:67]
  s_add_u32 m0, s25, 6144
  ds_read_b128 v[32:35], v10 offset:16384
  v_mfma_f32_16x16x32_bf16 v[68:71], a[100:103], v[40:43], v[68:71]
  v_mfma_f32_16x16x32_bf16 v[80:83], a[104:107], v[40:43], v[80:83]
  buffer_load_dwordx4 v22, s[12:15], s19 offen lds
  v_mfma_f32_16x16x32_bf16 v[84:87], a[108:111], v[40:43], v[84:87]
  s_waitcnt lgkmcnt(5)
  v_mfma_f32_16x16x32_bf16 v[72:75], a[96:99], v[44:47], v[72:75]
  ds_read_b128 v[36:39], v11 offset:16384
  v_mfma_f32_16x16x32_bf16 v[76:79], a[100:103], v[44:47], v[76:79]
  v_mfma_f32_16x16x32_bf16 v[88:91], a[104:107], v[44:47], v[88:91]
  v_mfma_f32_16x16x32_bf16 v[92:95], a[108:111], v[44:47], v[92:95]
  s_waitcnt lgkmcnt(5)
  v_mfma_f32_16x16x32_bf16 v[64:67], a[112:115], v[48:51], v[64:67]
  s_add_u32 m0, s25, 7168
  ds_read_b128 v[40:43], v12 offset:16384
  v_mfma_f32_16x16x32_bf16 v[68:71], a[116:119], v[48:51], v[68:71]
  v_mfma_f32_16x16x32_bf16 v[80:83], a[120:123], v[48:51], v[80:83]
  buffer_load_dwordx4 v23, s[12:15], s19 offen lds
  v_mfma_f32_16x16x32_bf16 v[84:87], a[124:127], v[48:51], v[84:87]
  s_waitcnt lgkmcnt(5)
  v_mfma_f32_16x16x32_bf16 v[72:75], a[112:115], v[52:55], v[72:75]
  s_cmp_gt_u32 s23, 3
  ds_read_b128 v[44:47], v13 offset:16384
  v_mfma_f32_16x16x32_bf16 v[76:79], a[116:119], v[52:55], v[76:79]
  v_mfma_f32_16x16x32_bf16 v[88:91], a[120:123], v[52:55], v[88:91]
  s_cselect_b32 s26, s20, 0
  v_mfma_f32_16x16x32_bf16 v[92:95], a[124:127], v[52:55], v[92:95]
  s_waitcnt lgkmcnt(5)
  v_mfma_f32_16x16x32_bf16 v[64:67], a[128:131], v[24:27], v[64:67]
  s_add_u32 s19, s19, s26
  ds_read_b128 v[48:51], v14 offset:16384
  v_mfma_f32_16x16x32_bf16 v[68:71], a[132:135], v[24:27], v[68:71]
  v_mfma_f32_16x16x32_bf16 v[80:83], a[136:139], v[24:27], v[80:83]
  s_add_u32 s25, s25, 32768
  v_mfma_f32_16x16x32_bf16 v[84:87], a[140:143], v[24:27], v[84:87]
  s_waitcnt lgkmcnt(5)
  v_mfma_f32_16x16x32_bf16 v[72:75], a[128:131], v[28:31], v[72:75]
  s_and_b32 s25, s25, 0x1ffff
  ds_read_b128 v[52:55], v15 offset:16384
  v_mfma_f32_16x16x32_bf16 v[76:79], a[132:135], v[28:31], v[76:79]
  v_mfma_f32_16x16x32_bf16 v[88:91], a[136:139], v[28:31], v[88:91]
  buffer_store_dwordx4 v[128:131], v7, s[4:7], s21 offen offset:0 sc1
  v_mfma_f32_16x16x32_bf16 v[92:95], a[140:143], v[28:31], v[92:95]
  s_waitcnt lgkmcnt(5)
  v_mfma_f32_16x16x32_bf16 v[64:67], a[144:147], v[32:35], v[64:67]
  ds_read_b128 v[24:27], v8 offset:24576
  v_mfma_f32_16x16x32_bf16 v[68:71], a[148:151], v[32:35], v[68:71]
  v_mfma_f32_16x16x32_bf16 v[80:83], a[152:155], v[32:35], v[80:83]
  v_mfma_f32_16x16x32_bf16 v[84:87], a[156:159], v[32:35], v[84:87]
  s_waitcnt lgkmcnt(5)
  v_mfma_f32_16x16x32_bf16 v[72:75], a[144:147], v[36:39], v[72:75]
  ds_read_b128 v[28:31], v9 offset:24576
  v_mfma_f32_16x16x32_bf16 v[76:79], a[148:151], v[36:39], v[76:79]
  v_mfma_f32_16x16x32_bf16 v[88:91], a[152:155], v[36:39], v[88:91]
  buffer_store_dwordx4 v[132:135], v7, s[4:7], s21 offen offset:256 sc1
  v_mfma_f32_16x16x32_bf16 v[92:95], a[156:159], v[36:39], v[92:95]
  s_waitcnt lgkmcnt(5)
  v_mfma_f32_16x16x32_bf16 v[64:67], a[160:163], v[40:43], v[64:67]
  ds_read_b128 v[32:35], v10 offset:24576
  v_mfma_f32_16x16x32_bf16 v[68:71], a[164:167], v[40:43], v[68:71]
  v_mfma_f32_16x16x32_bf16 v[80:83], a[168:171], v[40:43], v[80:83]
  v_mfma_f32_16x16x32_bf16 v[84:87], a[172:175], v[40:43], v[84:87]
  s_waitcnt lgkmcnt(5)
  v_mfma_f32_16x16x32_bf16 v[72:75], a[160:163], v[44:47], v[72:75]
  ds_read_b128 v[36:39], v11 offset:24576
  v_mfma_f32_16x16x32_bf16 v[76:79], a[164:167], v[44:47], v[76:79]
  v_mfma_f32_16x16x32_bf16 v[88:91], a[168:171], v[44:47], v[88:91]
  buffer_store_dwordx4 v[136:139], v7, s[4:7], s21 offen offset:2048 sc1
  v_mfma_f32_16x16x32_bf16 v[92:95], a[172:175], v[44:47], v[92:95]
  s_waitcnt lgkmcnt(5)
  v_mfma_f32_16x16x32_bf16 v[64:67], a[176:179], v[48:51], v[64:67]
  ds_read_b128 v[40:43], v12 offset:24576
  v_mfma_f32_16x16x32_bf16 v[68:71], a[180:183], v[48:51], v[68:71]
  v_mfma_f32_16x16x32_bf16 v[80:83], a[184:187], v[48:51], v[80:83]
  v_mfma_f32_16x16x32_bf16 v[84:87], a[188:191], v[48:51], v[84:87]
  s_waitcnt lgkmcnt(5)
  v_mfma_f32_16x16x32_bf16 v[72:75], a[176:179], v[52:55], v[72:75]
  ds_read_b128 v[44:47], v13 offset:24576
  v_mfma_f32_16x16x32_bf16 v[76:79], a[180:183], v[52:55], v[76:79]
  v_mfma_f32_16x16x32_bf16 v[88:91], a[184:187], v[52:55], v[88:91]
  buffer_store_dwordx4 v[140:143], v7, s[4:7], s21 offen offset:2304 sc1
  v_mfma_f32_16x16x32_bf16 v[92:95], a[188:191], v[52:55], v[92:95]
  s_waitcnt lgkmcnt(5)
  v_mfma_f32_16x16x32_bf16 v[64:67], a[192:195], v[24:27], v[64:67]
  s_mov_b32 s21, s27
  ds_read_b128 v[48:51], v14 offset:24576
  v_mfma_f32_16x16x32_bf16 v[68:71], a[196:199], v[24:27], v[68:71]
  v_mov_b32 v7, v56
  v_mfma_f32_16x16x32_bf16 v[80:83], a[200:203], v[24:27], v[80:83]
  v_mfma_f32_16x16x32_bf16 v[84:87], a[204:207], v[24:27], v[84:87]
  s_waitcnt lgkmcnt(5)
  v_mfma_f32_16x16x32_bf16 v[72:75], a[192:195], v[28:31], v[72:75]
  s_add_u32 s27, s27, s22
  ds_read_b128 v[52:55], v15 offset:24576
  v_mfma_f32_16x16x32_bf16 v[76:79], a[196:199], v[28:31], v[76:79]
  v_mfma_f32_16x16x32_bf16 v[88:91], a[200:203], v[28:31], v[88:91]
  s_waitcnt vmcnt(13)
  s_barrier
  v_mfma_f32_16x16x32_bf16 v[92:95], a[204:207], v[28:31], v[92:95]
  s_waitcnt lgkmcnt(5)
  v_mfma_f32_16x16x32_bf16 v[64:67], a[208:211], v[32:35], v[64:67]
  ds_read_b128 v[24:27], v8 offset:32768
  v_mfma_f32_16x16x32_bf16 v[68:71], a[212:215], v[32:35], v[68:71]
  v_mfma_f32_16x16x32_bf16 v[80:83], a[216:219], v[32:35], v[80:83]
  v_mfma_f32_16x16x32_bf16 v[84:87], a[220:223], v[32:35], v[84:87]
  s_waitcnt lgkmcnt(5)
  v_mfma_f32_16x16x32_bf16 v[72:75], a[208:211], v[36:39], v[72:75]
  s_add_u32 s29, s29, 1
  ds_read_b128 v[28:31], v9 offset:32768
  v_mfma_f32_16x16x32_bf16 v[76:79], a[212:215], v[36:39], v[76:79]
  v_mfma_f32_16x16x32_bf16 v[88:91], a[216:219], v[36:39], v[88:91]
  s_max_i32 s30, s29, 0
  v_mfma_f32_16x16x32_bf16 v[92:95], a[220:223], v[36:39], v[92:95]
  s_waitcnt lgkmcnt(5)
  v_mov_b32 v144, s30
  v_mfma_f32_16x16x32_bf16 v[64:67], a[224:227], v[40:43], v[64:67]
  ds_read_b128 v[32:35], v10 offset:32768
  v_mfma_f32_16x16x32_bf16 v[68:71], a[228:231], v[40:43], v[68:71]
  v_mfma_f32_16x16x32_bf16 v[80:83], a[232:235], v[40:43], v[80:83]
  buffer_store_dword v144, v145, s[4:7], s31 offen sc1
  v_mfma_f32_16x16x32_bf16 v[84:87], a[236:239], v[40:43], v[84:87]
  s_waitcnt lgkmcnt(5)
  v_mfma_f32_16x16x32_bf16 v[72:75], a[224:227], v[44:47], v[72:75]
  ds_read_b128 v[36:39], v11 offset:32768
  v_mfma_f32_16x16x32_bf16 v[76:79], a[228:231], v[44:47], v[76:79]
  v_mfma_f32_16x16x32_bf16 v[88:91], a[232:235], v[44:47], v[88:91]
  v_mfma_f32_16x16x32_bf16 v[92:95], a[236:239], v[44:47], v[92:95]
  s_waitcnt lgkmcnt(5)
  v_mfma_f32_16x16x32_bf16 v[64:67], a[240:243], v[48:51], v[64:67]
  s_sub_u32 s23, s23, 1
  ds_read_b128 v[40:43], v12 offset:32768
  v_mfma_f32_16x16x32_bf16 v[68:71], a[244:247], v[48:51], v[68:71]
  v_mfma_f32_16x16x32_bf16 v[80:83], a[248:251], v[48:51], v[80:83]
  v_mfma_f32_16x16x32_bf16 v[84:87], a[252:255], v[48:51], v[84:87]
  s_waitcnt lgkmcnt(5)
  v_mfma_f32_16x16x32_bf16 v[72:75], a[240:243], v[52:55], v[72:75]
  s_cmp_eq_u32 s23, 0
  ds_read_b128 v[44:47], v13 offset:32768
  v_mfma_f32_16x16x32_bf16 v[76:79], a[244:247], v[52:55], v[76:79]
  v_mfma_f32_16x16x32_bf16 v[88:91], a[248:251], v[52:55], v[88:91]
  v_mfma_f32_16x16x32_bf16 v[92:95], a[252:255], v[52:55], v[92:95]
  s_cbranch_scc1 G_done0_174
  s_waitcnt lgkmcnt(5)
  v_mfma_f32_16x16x32_bf16 v[96:99], a[0:3], v[24:27], 0
  s_add_u32 m0, s25, 0
  ds_read_b128 v[48:51], v14 offset:32768
  v_mfma_f32_16x16x32_bf16 v[100:103], a[4:7], v[24:27], 0
  v_mfma_f32_16x16x32_bf16 v[112:115], a[8:11], v[24:27], 0
  buffer_load_dwordx4 v16, s[12:15], s19 offen lds
  v_mfma_f32_16x16x32_bf16 v[116:119], a[12:15], v[24:27], 0
  s_waitcnt lgkmcnt(5)
  v_mfma_f32_16x16x32_bf16 v[104:107], a[0:3], v[28:31], 0
  ds_read_b128 v[52:55], v15 offset:32768
  v_mfma_f32_16x16x32_bf16 v[108:111], a[4:7], v[28:31], 0
  v_cvt_pk_bf16_f32 v128, v64, v65
  v_cvt_pk_bf16_f32 v129, v66, v67
  v_mfma_f32_16x16x32_bf16 v[120:123], a[8:11], v[28:31], 0
  v_mfma_f32_16x16x32_bf16 v[124:127], a[12:15], v[28:31], 0
  s_waitcnt lgkmcnt(5)
  v_cvt_pk_bf16_f32 v130, v68, v69
  v_cvt_pk_bf16_f32 v131, v70, v71
  v_mfma_f32_16x16x32_bf16 v[96:99], a[16:19], v[32:35], v[96:99]
  s_add_u32 m0, s25, 1024
  ds_read_b128 v[24:27], v8 offset:40960
  v_mfma_f32_16x16x32_bf16 v[100:103], a[20:23], v[32:35], v[100:103]
  v_mfma_f32_16x16x32_bf16 v[112:115], a[24:27], v[32:35], v[112:115]
  buffer_load_dwordx4 v17, s[12:15], s19 offen lds
  v_mfma_f32_16x16x32_bf16 v[116:119], a[28:31], v[32:35], v[116:119]
  s_waitcnt lgkmcnt(5)
  v_mfma_f32_16x16x32_bf16 v[104:107], a[16:19], v[36:39], v[104:107]
  ds_read_b128 v[28:31], v9 offset:40960
  v_mfma_f32_16x16x32_bf16 v[108:111], a[20:23], v[36:39], v[108:111]
  v_mfma_f32_16x16x32_bf16 v[120:123], a[24:27], v[36:39], v[120:123]
  v_mfma_f32_16x16x32_bf16 v[124:127], a[28:31], v[36:39], v[124:127]
  s_waitcnt lgkmcnt(5)
  v_mfma_f32_16x16x32_bf16 v[96:99], a[32:35], v[40:43], v[96:99]
  s_add_u32 m0, s25, 2048
  ds_read_b128 v[32:35], v10 offset:40960
  v_mfma_f32_16x16x32_bf16 v[100:103], a[36:39], v[40:43], v[100:103]
  v_cvt_pk_bf16_f32 v132, v72, v73
  v_cvt_pk_bf16_f32 v133, v74, v75
  v_mfma_f32_16x16x32_bf16 v[112:115], a[40:43], v[40:43], v[112:115]
  buffer_load_dwordx4 v18, s[12:15], s19 offen lds
  v_mfma_f32_16x16x32_bf16 v[116:119], a[44:47], v[40:43], v[116:119]
  s_waitcnt lgkmcnt(5)
  v_cvt_pk_bf16_f32 v134, v76, v77
  v_cvt_pk_bf16_f32 v135, v78, v79
  v_mfma_f32_16x16x32_bf16 v[104:107], a[32:35], v[44:47], v[104:107]
  ds_read_b128 v[36:39], v11 offset:40960
  v_mfma_f32_16x16x32_bf16 v[108:111], a[36:39], v[44:47], v[108:111]
  v_mfma_f32_16x16x32_bf16 v[120:123], a[40:43], v[44:47], v[120:123]
  v_mfma_f32_16x16x32_bf16 v[124:127], a[44:47], v[44:47], v[124:127]
  s_waitcnt lgkmcnt(5)
  v_mfma_f32_16x16x32_bf16 v[96:99], a[48:51], v[48:51], v[96:99]
  s_add_u32 m0, s25, 3072
  ds_read_b128 v[40:43], v12 offset:40960
  v_mfma_f32_16x16x32_bf16 v[100:103], a[52:55], v[48:51], v[100:103]
  v_mfma_f32_16x16x32_bf16 v[112:115], a[56:59], v[48:51], v[112:115]
  buffer_load_dwordx4 v19, s[12:15], s19 offen lds
  v_mfma_f32_16x16x32_bf16 v[116:119], a[60:63], v[48:51], v[116:119]
  s_waitcnt lgkmcnt(5)
  v_mfma_f32_16x16x32_bf16 v[104:107], a[48:51], v[52:55], v[104:107]
  ds_read_b128 v[44:47], v13 offset:40960
  v_mfma_f32_16x16x32_bf16 v[108:111], a[52:55], v[52:55], v[108:111]
  v_cvt_pk_bf16_f32 v136, v80, v81
  v_cvt_pk_bf16_f32 v137, v82, v83
  v_mfma_f32_16x16x32_bf16 v[120:123], a[56:59], v[52:55], v[120:123]
  v_mfma_f32_16x16x32_bf16 v[124:127], a[60:63], v[52:55], v[124:127]
  s_waitcnt lgkmcnt(5)
  v_cvt_pk_bf16_f32 v138, v84, v85
  v_cvt_pk_bf16_f32 v139, v86, v87
  v_mfma_f32_16x16x32_bf16 v[96:99], a[64:67], v[24:27], v[96:99]
  s_add_u32 m0, s25, 4096
  ds_read_b128 v[48:51], v14 offset:40960
  v_mfma_f32_16x16x32_bf16 v[100:103], a[68:71], v[24:27], v[100:103]
  v_mfma_f32_16x16x32_bf16 v[112:115], a[72:75], v[24:27], v[112:115]
  buffer_load_dwordx4 v20, s[12:15], s19 offen lds
  v_mfma_f32_16x16x32_bf16 v[116:119], a[76:79], v[24:27], v[116:119]
  s_waitcnt lgkmcnt(5)
  v_mfma_f32_16x16x32_bf16 v[104:107], a[64:67], v[28:31], v[104:107]
  ds_read_b128 v[52:55], v15 offset:40960
  v_mfma_f32_16x16x32_bf16 v[108:111], a[68:71], v[28:31], v[108:111]
  v_mfma_f32_16x16x32_bf16 v[120:123], a[72:75], v[28:31], v[120:123]
  v_mfma_f32_16x16x32_bf16 v[124:127], a[76:79], v[28:31], v[124:127]
  s_waitcnt lgkmcnt(5)
  v_mfma_f32_16x16x32_bf16 v[96:99], a[80:83], v[32:35], v[96:99]
  s_add_u32 m0, s25, 5120
  ds_read_b128 v[24:27], v8 offset:49152
  v_mfma_f32_16x16x32_bf16 v[100:103], a[84:87], v[32:35], v[100:103]
  v_cvt_pk_bf16_f32 v140, v88, v89
  v_cvt_pk_bf16_f32 v141, v90, v91
  v_mfma_f32_16x16x32_bf16 v[112:115], a[88:91], v[32:35], v[112:115]
  buffer_load_dwordx4 v21, s[12:15], s19 offen lds
  v_mfma_f32_16x16x32_bf16 v[116:119], a[92:95], v[32:35], v[116:119]
  s_waitcnt lgkmcnt(5)
  v_cvt_pk_bf16_f32 v142, v92, v93
  v_cvt_pk_bf16_f32 v143, v94, v95
  v_mfma_f32_16x16x32_bf16 v[104:107], a[80:83], v[36:39], v[104:107]
  ds_read_b128 v[28:31], v9 offset:49152
  v_mfma_f32_16x16x32_bf16 v[108:111], a[84:87], v[36:39], v[108:111]
  v_mfma_f32_16x16x32_bf16 v[120:123], a[88:91], v[36:39], v[120:123]
  v_mfma_f32_16x16x32_bf16 v[124:127], a[92:95], v[36:39], v[124:127]
  s_waitcnt lgkmcnt(5)
  v_mfma_f32_16x16x32_bf16 v[96:99], a[96:99], v[40:43], v[96:99]
  s_add_u32 m0, s25, 6144
  ds_read_b128 v[32:35], v10 offset:49152
  v_mfma_f32_16x16x32_bf16 v[100:103], a[100:103], v[40:43], v[100:103]
  v_mfma_f32_16x16x32_bf16 v[112:115], a[104:107], v[40:43], v[112:115]
  buffer_load_dwordx4 v22, s[12:15], s19 offen lds
  v_mfma_f32_16x16x32_bf16 v[116:119], a[108:111], v[40:43], v[116:119]
  s_waitcnt lgkmcnt(5)
  v_mfma_f32_16x16x32_bf16 v[104:107], a[96:99], v[44:47], v[104:107]
  ds_read_b128 v[36:39], v11 offset:49152
  v_mfma_f32_16x16x32_bf16 v[108:111], a[100:103], v[44:47], v[108:111]
  v_mfma_f32_16x16x32_bf16 v[120:123], a[104:107], v[44:47], v[120:123]
  v_mfma_f32_16x16x32_bf16 v[124:127], a[108:111], v[44:47], v[124:127]
  s_waitcnt lgkmcnt(5)
  v_mfma_f32_16x16x32_bf16 v[96:99], a[112:115], v[48:51], v[96:99]
  s_add_u32 m0, s25, 7168
  ds_read_b128 v[40:43], v12 offset:49152
  v_mfma_f32_16x16x32_bf16 v[100:103], a[116:119], v[48:51], v[100:103]
  v_mfma_f32_16x16x32_bf16 v[112:115], a[120:123], v[48:51], v[112:115]
  buffer_load_dwordx4 v23, s[12:15], s19 offen lds
  v_mfma_f32_16x16x32_bf16 v[116:119], a[124:127], v[48:51], v[116:119]
  s_waitcnt lgkmcnt(5)
  v_mfma_f32_16x16x32_bf16 v[104:107], a[112:115], v[52:55], v[104:107]
  s_cmp_gt_u32 s23, 3
  ds_read_b128 v[44:47], v13 offset:49152
  v_mfma_f32_16x16x32_bf16 v[108:111], a[116:119], v[52:55], v[108:111]
  v_mfma_f32_16x16x32_bf16 v[120:123], a[120:123], v[52:55], v[120:123]
  s_cselect_b32 s26, s20, 0
  v_mfma_f32_16x16x32_bf16 v[124:127], a[124:127], v[52:55], v[124:127]
  s_waitcnt lgkmcnt(5)
  v_mfma_f32_16x16x32_bf16 v[96:99], a[128:131], v[24:27], v[96:99]
  s_add_u32 s19, s19, s26
  ds_read_b128 v[48:51], v14 offset:49152
  v_mfma_f32_16x16x32_bf16 v[100:103], a[132:135], v[24:27], v[100:103]
  v_mfma_f32_16x16x32_bf16 v[112:115], a[136:139], v[24:27], v[112:115]
  s_add_u32 s25, s25, 32768
  v_mfma_f32_16x16x32_bf16 v[116:119], a[140:143], v[24:27], v[116:119]
  s_waitcnt lgkmcnt(5)
  v_mfma_f32_16x16x32_bf16 v[104:107], a[128:131], v[28:31], v[104:107]
  s_and_b32 s25, s25, 0x1ffff
  ds_read_b128 v[52:55], v15 offset:49152
  v_mfma_f32_16x16x32_bf16 v[108:111], a[132:135], v[28:31], v[108:111]
  v_mfma_f32_16x16x32_bf16 v[120:123], a[136:139], v[28:31], v[120:123]
  buffer_store_dwordx4 v[128:131], v7, s[4:7], s21 offen offset:0 sc1
  v_mfma_f32_16x16x32_bf16 v[124:127], a[140:143], v[28:31], v[124:127]
  s_waitcnt lgkmcnt(5)
  v_mfma_f32_16x16x32_bf16 v[96:99], a[144:147], v[32:35], v[96:99]
  ds_read_b128 v[24:27], v8 offset:57344
  v_mfma_f32_16x16x32_bf16 v[100:103], a[148:151], v[32:35], v[100:103]
  v_mfma_f32_16x16x32_bf16 v[112:115], a[152:155], v[32:35], v[112:115]
  v_mfma_f32_16x16x32_bf16 v[116:119], a[156:159], v[32:35], v[116:119]
  s_waitcnt lgkmcnt(5)
  v_xor_b32 v8, 0x10000, v8
  v_mfma_f32_16x16x32_bf16 v[104:107], a[144:147], v[36:39], v[104:107]
  ds_read_b128 v[28:31], v9 offset:57344
  v_mfma_f32_16x16x32_bf16 v[108:111], a[148:151], v[36:39], v[108:111]
  v_mfma_f32_16x16x32_bf16 v[120:123], a[152:155], v[36:39], v[120:123]
  buffer_store_dwordx4 v[132:135], v7, s[4:7], s21 offen offset:256 sc1
  v_mfma_f32_16x16x32_bf16 v[124:127], a[156:159], v[36:39], v[124:127]
  s_waitcnt lgkmcnt(5)
  v_xor_b32 v9, 0x10000, v9
  v_mfma_f32_16x16x32_bf16 v[96:99], a[160:163], v[40:43], v[96:99]
  ds_read_b128 v[32:35], v10 offset:57344
  v_mfma_f32_16x16x32_bf16 v[100:103], a[164:167], v[40:43], v[100:103]
  v_mfma_f32_16x16x32_bf16 v[112:115], a[168:171], v[40:43], v[112:115]
  v_mfma_f32_16x16x32_bf16 v[116:119], a[172:175], v[40:43], v[116:119]
  s_waitcnt lgkmcnt(5)
  v_xor_b32 v10, 0x10000, v10
  v_mfma_f32_16x16x32_bf16 v[104:107], a[160:163], v[44:47], v[104:107]
  ds_read_b128 v[36:39], v11 offset:57344
  v_mfma_f32_16x16x32_bf16 v[108:111], a[164:167], v[44:47], v[108:111]
  v_mfma_f32_16x16x32_bf16 v[120:123], a[168:171], v[44:47], v[120:123]
  buffer_store_dwordx4 v[136:139], v7, s[4:7], s21 offen offset:2048 sc1
  v_mfma_f32_16x16x32_bf16 v[124:127], a[172:175], v[44:47], v[124:127]
  s_waitcnt lgkmcnt(5)
  v_xor_b32 v11, 0x10000, v11
  v_mfma_f32_16x16x32_bf16 v[96:99], a[176:179], v[48:51], v[96:99]
  ds_read_b128 v[40:43], v12 offset:57344
  v_mfma_f32_16x16x32_bf16 v[100:103], a[180:183], v[48:51], v[100:103]
  v_mfma_f32_16x16x32_bf16 v[112:115], a[184:187], v[48:51], v[112:115]
  v_mfma_f32_16x16x32_bf16 v[116:119], a[188:191], v[48:51], v[116:119]
  s_waitcnt lgkmcnt(5)
  v_xor_b32 v12, 0x10000, v12
  v_mfma_f32_16x16x32_bf16 v[104:107], a[176:179], v[52:55], v[104:107]
  ds_read_b128 v[44:47], v13 offset:57344
  v_mfma_f32_16x16x32_bf16 v[108:111], a[180:183], v[52:55], v[108:111]
  v_mfma_f32_16x16x32_bf16 v[120:123], a[184:187], v[52:55], v[120:123]
  buffer_store_dwordx4 v[140:143], v7, s[4:7], s21 offen offset:2304 sc1
  v_mfma_f32_16x16x32_bf16 v[124:127], a[188:191], v[52:55], v[124:127]
  s_waitcnt lgkmcnt(5)
  v_xor_b32 v13, 0x10000, v13
  v_mfma_f32_16x16x32_bf16 v[96:99], a[192:195], v[24:27], v[96:99]
  s_mov_b32 s21, s27
  ds_read_b128 v[48:51], v14 offset:57344
  v_mfma_f32_16x16x32_bf16 v[100:103], a[196:199], v[24:27], v[100:103]
  v_mov_b32 v7, v56
  v_mfma_f32_16x16x32_bf16 v[112:115], a[200:203], v[24:27], v[112:115]
  v_mfma_f32_16x16x32_bf16 v[116:119], a[204:207], v[24:27], v[116:119]
  s_waitcnt lgkmcnt(5)
  v_xor_b32 v14, 0x10000, v14
  v_mfma_f32_16x16x32_bf16 v[104:107], a[192:195], v[28:31], v[104:107]
  s_add_u32 s27, s27, s22
  ds_read_b128 v[52:55], v15 offset:57344
  v_mfma_f32_16x16x32_bf16 v[108:111], a[196:199], v[28:31], v[108:111]
  v_mfma_f32_16x16x32_bf16 v[120:123], a[200:203], v[28:31], v[120:123]
  s_waitcnt vmcnt(13)
  s_barrier
  v_mfma_f32_16x16x32_bf16 v[124:127], a[204:207], v[28:31], v[124:127]
  s_waitcnt lgkmcnt(5)
  v_xor_b32 v15, 0x10000, v15
  v_mfma_f32_16x16x32_bf16 v[96:99], a[208:211], v[32:35], v[96:99]
  ds_read_b128 v[24:27], v8 offset:0
  v_mfma_f32_16x16x32_bf16 v[100:103], a[212:215], v[32:35], v[100:103]
  v_mfma_f32_16x16x32_bf16 v[112:115], a[216:219], v[32:35], v[112:115]
  v_mfma_f32_16x16x32_bf16 v[116:119], a[220:223], v[32:35], v[116:119]
  s_waitcnt lgkmcnt(5)
  v_mfma_f32_16x16x32_bf16 v[104:107], a[208:211], v[36:39], v[104:107]
  s_add_u32 s29, s29, 1
  ds_read_b128 v[28:31], v9 offset:0
  v_mfma_f32_16x16x32_bf16 v[108:111], a[212:215], v[36:39], v[108:111]
  v_mfma_f32_16x16x32_bf16 v[120:123], a[216:219], v[36:39], v[120:123]
  s_max_i32 s30, s29, 0
  v_mfma_f32_16x16x32_bf16 v[124:127], a[220:223], v[36:39], v[124:127]
  s_waitcnt lgkmcnt(5)
  v_mov_b32 v144, s30
  v_mfma_f32_16x16x32_bf16 v[96:99], a[224:227], v[40:43], v[96:99]
  ds_read_b128 v[32:35], v10 offset:0
  v_mfma_f32_16x16x32_bf16 v[100:103], a[228:231], v[40:43], v[100:103]
  v_mfma_f32_16x16x32_bf16 v[112:115], a[232:235], v[40:43], v[112:115]
  buffer_store_dword v144, v145, s[4:7], s31 offen sc1
  v_mfma_f32_16x16x32_bf16 v[116:119], a[236:239], v[40:43], v[116:119]
  s_waitcnt lgkmcnt(5)
  v_mfma_f32_16x16x32_bf16 v[104:107], a[224:227], v[44:47], v[104:107]
  ds_read_b128 v[36:39], v11 offset:0
  v_mfma_f32_16x16x32_bf16 v[108:111], a[228:231], v[44:47], v[108:111]
  v_mfma_f32_16x16x32_bf16 v[120:123], a[232:235], v[44:47], v[120:123]
  v_mfma_f32_16x16x32_bf16 v[124:127], a[236:239], v[44:47], v[124:127]
  s_waitcnt lgkmcnt(5)
  v_mfma_f32_16x16x32_bf16 v[96:99], a[240:243], v[48:51], v[96:99]
  s_sub_u32 s23, s23, 1
  ds_read_b128 v[40:43], v12 offset:0
  v_mfma_f32_16x16x32_bf16 v[100:103], a[244:247], v[48:51], v[100:103]
  v_mfma_f32_16x16x32_bf16 v[112:115], a[248:251], v[48:51], v[112:115]
  v_mfma_f32_16x16x32_bf16 v[116:119], a[252:255], v[48:51], v[116:119]
  s_waitcnt lgkmcnt(5)
  v_mfma_f32_16x16x32_bf16 v[104:107], a[240:243], v[52:55], v[104:107]
  s_cmp_eq_u32 s23, 0
  ds_read_b128 v[44:47], v13 offset:0
  v_mfma_f32_16x16x32_bf16 v[108:111], a[244:247], v[52:55], v[108:111]
  v_mfma_f32_16x16x32_bf16 v[120:123], a[248:251], v[52:55], v[120:123]
  v_mfma_f32_16x16x32_bf16 v[124:127], a[252:255], v[52:55], v[124:127]
  s_cbranch_scc1 G_done1_175
  s_branch G_top_173
G_done0_174:
  s_nop 7
  s_nop 3
  v_cvt_pk_bf16_f32 v128, v64, v65
  v_cvt_pk_bf16_f32 v129, v66, v67
  v_cvt_pk_bf16_f32 v130, v68, v69
  v_cvt_pk_bf16_f32 v131, v70, v71
  buffer_store_dwordx4 v[128:131], v7, s[4:7], s21 offen offset:0 sc1
  v_cvt_pk_bf16_f32 v132, v72, v73
  v_cvt_pk_bf16_f32 v133, v74, v75
  v_cvt_pk_bf16_f32 v134, v76, v77
  v_cvt_pk_bf16_f32 v135, v78, v79
  buffer_store_dwordx4 v[132:135], v7, s[4:7], s21 offen offset:256 sc1
  v_cvt_pk_bf16_f32 v136, v80, v81
  v_cvt_pk_bf16_f32 v137, v82, v83
  v_cvt_pk_bf16_f32 v138, v84, v85
  v_cvt_pk_bf16_f32 v139, v86, v87
  buffer_store_dwordx4 v[136:139], v7, s[4:7], s21 offen offset:2048 sc1
  v_cvt_pk_bf16_f32 v140, v88, v89
  v_cvt_pk_bf16_f32 v141, v90, v91
  v_cvt_pk_bf16_f32 v142, v92, v93
  v_cvt_pk_bf16_f32 v143, v94, v95
  buffer_store_dwordx4 v[140:143], v7, s[4:7], s21 offen offset:2304 sc1
  s_branch G_fin_176
G_done1_175:
  s_nop 7
  s_nop 3
  v_cvt_pk_bf16_f32 v128, v96, v97
  v_cvt_pk_bf16_f32 v129, v98, v99
  v_cvt_pk_bf16_f32 v130, v100, v101
  v_cvt_pk_bf16_f32 v131, v102, v103
  buffer_store_dwordx4 v[128:131], v7, s[4:7], s21 offen offset:0 sc1
  v_cvt_pk_bf16_f32 v132, v104, v105
  v_cvt_pk_bf16_f32 v133, v106, v107
  v_cvt_pk_bf16_f32 v134, v108, v109
  v_cvt_pk_bf16_f32 v135, v110, v111
  buffer_store_dwordx4 v[132:135], v7, s[4:7], s21 offen offset:256 sc1
  v_cvt_pk_bf16_f32 v136, v112, v113
  v_cvt_pk_bf16_f32 v137, v114, v115
  v_cvt_pk_bf16_f32 v138, v116, v117
  v_cvt_pk_bf16_f32 v139, v118, v119
  buffer_store_dwordx4 v[136:139], v7, s[4:7], s21 offen offset:2048 sc1
  v_cvt_pk_bf16_f32 v140, v120, v121
  v_cvt_pk_bf16_f32 v141, v122, v123
  v_cvt_pk_bf16_f32 v142, v124, v125
  v_cvt_pk_bf16_f32 v143, v126, v127
  buffer_store_dwordx4 v[140:143], v7, s[4:7], s21 offen offset:2304 sc1
G_fin_176:
  s_waitcnt vmcnt(0) lgkmcnt(0)
  s_barrier
  s_add_u32 s30, s29, 2
  v_mov_b32 v144, s30
  v_min_u32 v145, 1, v0
  v_lshlrev_b32 v145, 30, v145
  buffer_store_dword v144, v145, s[4:7], s31 offen sc1
  s_branch P_end_171
P_q_172:
  s_mov_b32 s27, s21
  v_mov_b32 v7, 0x40000000
  s_mov_b32 s29, -2
  v_min_u32 v145, 1, v0
  v_lshlrev_b32 v145, 30, v145
  ds_read_b128 v[24:27], v8 offset:0
  ds_read_b128 v[28:31], v9 offset:0
  ds_read_b128 v[32:35], v10 offset:0
  ds_read_b128 v[36:39], v11 offset:0
  ds_read_b128 v[40:43], v12 offset:0
  ds_read_b128 v[44:47], v13 offset:0
.p2align 6
G_top_177:
  s_waitcnt lgkmcnt(5)
  v_mfma_f32_16x16x32_bf16 v[64:67], a[0:3], v[24:27], 0
  s_add_u32 m0, s25, 0
  ds_read_b128 v[48:51], v14 offset:0
  v_mfma_f32_16x16x32_bf16 v[68:71], a[4:7], v[24:27], 0
  v_mfma_f32_16x16x32_bf16 v[80:83], a[8:11], v[24:27], 0
  buffer_load_dwordx4 v16, s[12:15], s19 offen lds
  v_mfma_f32_16x16x32_bf16 v[84:87], a[12:15], v[24:27], 0
  s_waitcnt lgkmcnt(5)
  v_mfma_f32_16x16x32_bf16 v[72:75], a[0:3], v[28:31], 0
  ds_read_b128 v[52:55], v15 offset:0
  v_mfma_f32_16x16x32_bf16 v[76:79], a[4:7], v[28:31], 0
  v_mul_f32 v96, s24, v96
  v_mul_f32 v97, s24, v97
  v_mfma_f32_16x16x32_bf16 v[88:91], a[8:11], v[28:31], 0
  v_mfma_f32_16x16x32_bf16 v[92:95], a[12:15], v[28:31], 0
  s_waitcnt lgkmcnt(5)
  v_cvt_pk_bf16_f32 v128, v96, v97
  v_mul_f32 v98, s24, v98
  v_mfma_f32_16x16x32_bf16 v[64:67], a[16:19], v[32:35], v[64:67]
  s_add_u32 m0, s25, 1024
  ds_read_b128 v[24:27], v8 offset:8192
  v_mfma_f32_16x16x32_bf16 v[68:71], a[20:23], v[32:35], v[68:71]
  v_mul_f32 v99, s24, v99
  v_cvt_pk_bf16_f32 v129, v98, v99
  v_mfma_f32_16x16x32_bf16 v[80:83], a[24:27], v[32:35], v[80:83]
  buffer_load_dwordx4 v17, s[12:15], s19 offen lds
  v_mfma_f32_16x16x32_bf16 v[84:87], a[28:31], v[32:35], v[84:87]
  s_waitcnt lgkmcnt(5)
  v_mul_f32 v100, s24, v100
  v_mul_f32 v101, s24, v101
  v_mfma_f32_16x16x32_bf16 v[72:75], a[16:19], v[36:39], v[72:75]
  ds_read_b128 v[28:31], v9 offset:8192
  v_mfma_f32_16x16x32_bf16 v[76:79], a[20:23], v[36:39], v[76:79]
  v_cvt_pk_bf16_f32 v130, v100, v101
  v_mul_f32 v102, s24, v102
  v_mfma_f32_16x16x32_bf16 v[88:91], a[24:27], v[36:39], v[88:91]
  v_mfma_f32_16x16x32_bf16 v[92:95], a[28:31], v[36:39], v[92:95]
  s_waitcnt lgkmcnt(5)
  v_mul_f32 v103, s24, v103
  v_cvt_pk_bf16_f32 v131, v102, v103
  v_mfma_f32_16x16x32_bf16 v[64:67], a[32:35], v[40:43], v[64:67]
  s_add_u32 m0, s25, 2048
  ds_read_b128 v[32:35], v10 offset:8192
  v_mfma_f32_16x16x32_bf16 v[68:71], a[36:39], v[40:43], v[68:71]
  v_mul_f32 v104, s24, v104
  v_mul_f32 v105, s24, v105
  v_mfma_f32_16x16x32_bf16 v[80:83], a[40:43], v[40:43], v[80:83]
  buffer_load_dwordx4 v18, s[12:15], s19 offen lds
  v_mfma_f32_16x16x32_bf16 v[84:87], a[44:47], v[40:43], v[84:87]
  s_waitcnt lgkmcnt(5)
  v_cvt_pk_bf16_f32 v132, v104, v105
  v_mul_f32 v106, s24, v106
  v_mfma_f32_16x16x32_bf16 v[72:75], a[32:35], v[44:47], v[72:75]
  ds_read_b128 v[36:39], v11 offset:8192
  v_mfma_f32_16x16x32_bf16 v[76:79], a[36:39], v[44:47], v[76:79]
  v_mul_f32 v107, s24, v107
  v_cvt_pk_bf16_f32 v133, v106, v107
  v_mfma_f32_16x16x32_bf16 v[88:91], a[40:43], v[44:47], v[88:91]
  v_mfma_f32_16x16x32_bf16 v[92:95], a[44:47], v[44:47], v[92:95]
  s_waitcnt lgkmcnt(5)
  v_mul_f32 v108, s24, v108
  v_mul_f32 v109, s24, v109
  v_mfma_f32_16x16x32_bf16 v[64:67], a[48:51], v[48:51], v[64:67]
  s_add_u32 m0, s25, 3072
  ds_read_b128 v[40:43], v12 offset:8192
  v_mfma_f32_16x16x32_bf16 v[68:71], a[52:55], v[48:51], v[68:71]
  v_cvt_pk_bf16_f32 v134, v108, v109
  v_mul_f32 v110, s24, v110
  v_mfma_f32_16x16x32_bf16 v[80:83], a[56:59], v[48:51], v[80:83]
  buffer_load_dwordx4 v19, s[12:15], s19 offen lds
  v_mfma_f32_16x16x32_bf16 v[84:87], a[60:63], v[48:51], v[84:87]
  s_waitcnt lgkmcnt(5)
  v_mul_f32 v111, s24, v111
  v_cvt_pk_bf16_f32 v135, v110, v111
  v_mfma_f32_16x16x32_bf16 v[72:75], a[48:51], v[52:55], v[72:75]
  ds_read_b128 v[44:47], v13 offset:8192
  v_mfma_f32_16x16x32_bf16 v[76:79], a[52:55], v[52:55], v[76:79]
  v_mul_f32 v112, s24, v112
  v_mul_f32 v113, s24, v113
  v_mfma_f32_16x16x32_bf16 v[88:91], a[56:59], v[52:55], v[88:91]
  v_mfma_f32_16x16x32_bf16 v[92:95], a[60:63], v[52:55], v[92:95]
  s_waitcnt lgkmcnt(5)
  v_cvt_pk_bf16_f32 v136, v112, v113
  v_mul_f32 v114, s24, v114
  v_mfma_f32_16x16x32_bf16 v[64:67], a[64:67], v[24:27], v[64:67]
  s_add_u32 m0, s25, 4096
  ds_read_b128 v[48:51], v14 offset:8192
  v_mfma_f32_16x16x32_bf16 v[68:71], a[68:71], v[24:27], v[68:71]
  v_mul_f32 v115, s24, v115
  v_cvt_pk_bf16_f32 v137, v114, v115
  v_mfma_f32_16x16x32_bf16 v[80:83], a[72:75], v[24:27], v[80:83]
  buffer_load_dwordx4 v20, s[12:15], s19 offen lds
  v_mfma_f32_16x16x32_bf16 v[84:87], a[76:79], v[24:27], v[84:87]
  s_waitcnt lgkmcnt(5)
  v_mul_f32 v116, s24, v116
  v_mul_f32 v117, s24, v117
  v_mfma_f32_16x16x32_bf16 v[72:75], a[64:67], v[28:31], v[72:75]
  ds_read_b128 v[52:55], v15 offset:8192
  v_mfma_f32_16x16x32_bf16 v[76:79], a[68:71], v[28:31], v[76:79]
  v_cvt_pk_bf16_f32 v138, v116, v117
  v_mul_f32 v118, s24, v118
  v_mfma_f32_16x16x32_bf16 v[88:91], a[72:75], v[28:31], v[88:91]
  v_mfma_f32_16x16x32_bf16 v[92:95], a[76:79], v[28:31], v[92:95]
  s_waitcnt lgkmcnt(5)
  v_mul_f32 v119, s24, v119
  v_cvt_pk_bf16_f32 v139, v118, v119
  v_mfma_f32_16x16x32_bf16 v[64:67], a[80:83], v[32:35], v[64:67]
  s_add_u32 m0, s25, 5120
  ds_read_b128 v[24:27], v8 offset:16384
  v_mfma_f32_16x16x32_bf16 v[68:71], a[84:87], v[32:35], v[68:71]
  v_mul_f32 v120, s24, v120
  v_mul_f32 v121, s24, v121
  v_mfma_f32_16x16x32_bf16 v[80:83], a[88:91], v[32:35], v[80:83]
  buffer_load_dwordx4 v21, s[12:15], s19 offen lds
  v_mfma_f32_16x16x32_bf16 v[84:87], a[92:95], v[32:35], v[84:87]
  s_waitcnt lgkmcnt(5)
  v_cvt_pk_bf16_f32 v140, v120, v121
  v_mul_f32 v122, s24, v122
  v_mfma_f32_16x16x32_bf16 v[72:75], a[80:83], v[36:39], v[72:75]
  ds_read_b128 v[28:31], v9 offset:16384
  v_mfma_f32_16x16x32_bf16 v[76:79], a[84:87], v[36:39], v[76:79]
  v_mul_f32 v123, s24, v123
  v_cvt_pk_bf16_f32 v141, v122, v123
  v_mfma_f32_16x16x32_bf16 v[88:91], a[88:91], v[36:39], v[88:91]
  v_mfma_f32_16x16x32_bf16 v[92:95], a[92:95], v[36:39], v[92:95]
  s_waitcnt lgkmcnt(5)
  v_mul_f32 v124, s24, v124
  v_mul_f32 v125, s24, v125
  v_mfma_f32_16x16x32_bf16 v[64:67], a[96:99], v[40:43], v[64:67]
  s_add_u32 m0, s25, 6144
  ds_read_b128 v[32:35], v10 offset:16384
  v_mfma_f32_16x16x32_bf16 v[68:71], a[100:103], v[40:43], v[68:71]
  v_cvt_pk_bf16_f32 v142, v124, v125
  v_mul_f32 v126, s24, v126
  v_mfma_f32_16x16x32_bf16 v[80:83], a[104:107], v[40:43], v[80:83]
  buffer_load_dwordx4 v22, s[12:15], s19 offen lds
  v_mfma_f32_16x16x32_bf16 v[84:87], a[108:111], v[40:43], v[84:87]
  s_waitcnt lgkmcnt(5)
  v_mul_f32 v127, s24, v127
  v_cvt_pk_bf16_f32 v143, v126, v127
  v_mfma_f32_16x16x32_bf16 v[72:75], a[96:99], v[44:47], v[72:75]
  ds_read_b128 v[36:39], v11 offset:16384
  v_mfma_f32_16x16x32_bf16 v[76:79], a[100:103], v[44:47], v[76:79]
  v_mfma_f32_16x16x32_bf16 v[88:91], a[104:107], v[44:47], v[88:91]
  v_mfma_f32_16x16x32_bf16 v[92:95], a[108:111], v[44:47], v[92:95]
  s_waitcnt lgkmcnt(5)
  v_mfma_f32_16x16x32_bf16 v[64:67], a[112:115], v[48:51], v[64:67]
  s_add_u32 m0, s25, 7168
  ds_read_b128 v[40:43], v12 offset:16384
  v_mfma_f32_16x16x32_bf16 v[68:71], a[116:119], v[48:51], v[68:71]
  v_mfma_f32_16x16x32_bf16 v[80:83], a[120:123], v[48:51], v[80:83]
  buffer_load_dwordx4 v23, s[12:15], s19 offen lds
  v_mfma_f32_16x16x32_bf16 v[84:87], a[124:127], v[48:51], v[84:87]
  s_waitcnt lgkmcnt(5)
  v_mfma_f32_16x16x32_bf16 v[72:75], a[112:115], v[52:55], v[72:75]
  s_cmp_gt_u32 s23, 3
  ds_read_b128 v[44:47], v13 offset:16384
  v_mfma_f32_16x16x32_bf16 v[76:79], a[116:119], v[52:55], v[76:79]
  v_mfma_f32_16x16x32_bf16 v[88:91], a[120:123], v[52:55], v[88:91]
  s_cselect_b32 s26, s20, 0
  v_mfma_f32_16x16x32_bf16 v[92:95], a[124:127], v[52:55], v[92:95]
  s_waitcnt lgkmcnt(5)
  v_mfma_f32_16x16x32_bf16 v[64:67], a[128:131], v[24:27], v[64:67]
  s_add_u32 s19, s19, s26
  ds_read_b128 v[48:51], v14 offset:16384
  v_mfma_f32_16x16x32_bf16 v[68:71], a[132:135], v[24:27], v[68:71]
  v_mfma_f32_16x16x32_bf16 v[80:83], a[136:139], v[24:27], v[80:83]
  s_add_u32 s25, s25, 32768
  v_mfma_f32_16x16x32_bf16 v[84:87], a[140:143], v[24:27], v[84:87]
  s_waitcnt lgkmcnt(5)
  v_mfma_f32_16x16x32_bf16 v[72:75], a[128:131], v[28:31], v[72:75]
  s_and_b32 s25, s25, 0x1ffff
  ds_read_b128 v[52:55], v15 offset:16384
  v_mfma_f32_16x16x32_bf16 v[76:79], a[132:135], v[28:31], v[76:79]
  v_mfma_f32_16x16x32_bf16 v[88:91], a[136:139], v[28:31], v[88:91]
  buffer_store_dwordx4 v[128:131], v7, s[4:7], s21 offen offset:0 sc1
  v_mfma_f32_16x16x32_bf16 v[92:95], a[140:143], v[28:31], v[92:95]
  s_waitcnt lgkmcnt(5)
  v_mfma_f32_16x16x32_bf16 v[64:67], a[144:147], v[32:35], v[64:67]
  ds_read_b128 v[24:27], v8 offset:24576
  v_mfma_f32_16x16x32_bf16 v[68:71], a[148:151], v[32:35], v[68:71]
  v_mfma_f32_16x16x32_bf16 v[80:83], a[152:155], v[32:35], v[80:83]
  v_mfma_f32_16x16x32_bf16 v[84:87], a[156:159], v[32:35], v[84:87]
  s_waitcnt lgkmcnt(5)
  v_mfma_f32_16x16x32_bf16 v[72:75], a[144:147], v[36:39], v[72:75]
  ds_read_b128 v[28:31], v9 offset:24576
  v_mfma_f32_16x16x32_bf16 v[76:79], a[148:151], v[36:39], v[76:79]
  v_mfma_f32_16x16x32_bf16 v[88:91], a[152:155], v[36:39], v[88:91]
  buffer_store_dwordx4 v[132:135], v7, s[4:7], s21 offen offset:256 sc1
  v_mfma_f32_16x16x32_bf16 v[92:95], a[156:159], v[36:39], v[92:95]
  s_waitcnt lgkmcnt(5)
  v_mfma_f32_16x16x32_bf16 v[64:67], a[160:163], v[40:43], v[64:67]
  ds_read_b128 v[32:35], v10 offset:24576
  v_mfma_f32_16x16x32_bf16 v[68:71], a[164:167], v[40:43], v[68:71]
  v_mfma_f32_16x16x32_bf16 v[80:83], a[168:171], v[40:43], v[80:83]
  v_mfma_f32_16x16x32_bf16 v[84:87], a[172:175], v[40:43], v[84:87]
  s_waitcnt lgkmcnt(5)
  v_mfma_f32_16x16x32_bf16 v[72:75], a[160:163], v[44:47], v[72:75]
  ds_read_b128 v[36:39], v11 offset:24576
  v_mfma_f32_16x16x32_bf16 v[76:79], a[164:167], v[44:47], v[76:79]
  v_mfma_f32_16x16x32_bf16 v[88:91], a[168:171], v[44:47], v[88:91]
  buffer_store_dwordx4 v[136:139], v7, s[4:7], s21 offen offset:2048 sc1
  v_mfma_f32_16x16x32_bf16 v[92:95], a[172:175], v[44:47], v[92:95]
  s_waitcnt lgkmcnt(5)
  v_mfma_f32_16x16x32_bf16 v[64:67], a[176:179], v[48:51], v[64:67]
  ds_read_b128 v[40:43], v12 offset:24576
  v_mfma_f32_16x16x32_bf16 v[68:71], a[180:183], v[48:51], v[68:71]
  v_mfma_f32_16x16x32_bf16 v[80:83], a[184:187], v[48:51], v[80:83]
  v_mfma_f32_16x16x32_bf16 v[84:87], a[188:191], v[48:51], v[84:87]
  s_waitcnt lgkmcnt(5)
  v_mfma_f32_16x16x32_bf16 v[72:75], a[176:179], v[52:55], v[72:75]
  ds_read_b128 v[44:47], v13 offset:24576
  v_mfma_f32_16x16x32_bf16 v[76:79], a[180:183], v[52:55], v[76:79]
  v_mfma_f32_16x16x32_bf16 v[88:91], a[184:187], v[52:55], v[88:91]
  buffer_store_dwordx4 v[140:143], v7, s[4:7], s21 offen offset:2304 sc1
  v_mfma_f32_16x16x32_bf16 v[92:95], a[188:191], v[52:55], v[92:95]
  s_waitcnt lgkmcnt(5)
  v_mfma_f32_16x16x32_bf16 v[64:67], a[192:195], v[24:27], v[64:67]
  s_mov_b32 s21, s27
  ds_read_b128 v[48:51], v14 offset:24576
  v_mfma_f32_16x16x32_bf16 v[68:71], a[196:199], v[24:27], v[68:71]
  v_mov_b32 v7, v56
  v_mfma_f32_16x16x32_bf16 v[80:83], a[200:203], v[24:27], v[80:83]
  v_mfma_f32_16x16x32_bf16 v[84:87], a[204:207], v[24:27], v[84:87]
  s_waitcnt lgkmcnt(5)
  v_mfma_f32_16x16x32_bf16 v[72:75], a[192:195], v[28:31], v[72:75]
  s_add_u32 s27, s27, s22
  ds_read_b128 v[52:55], v15 offset:24576
  v_mfma_f32_16x16x32_bf16 v[76:79], a[196:199], v[28:31], v[76:79]
  v_mfma_f32_16x16x32_bf16 v[88:91], a[200:203], v[28:31], v[88:91]
  s_waitcnt vmcnt(13)
  s_barrier
  v_mfma_f32_16x16x32_bf16 v[92:95], a[204:207], v[28:31], v[92:95]
  s_waitcnt lgkmcnt(5)
  v_mfma_f32_16x16x32_bf16 v[64:67], a[208:211], v[32:35], v[64:67]
  ds_read_b128 v[24:27], v8 offset:32768
  v_mfma_f32_16x16x32_bf16 v[68:71], a[212:215], v[32:35], v[68:71]
  v_mfma_f32_16x16x32_bf16 v[80:83], a[216:219], v[32:35], v[80:83]
  v_mfma_f32_16x16x32_bf16 v[84:87], a[220:223], v[32:35], v[84:87]
  s_waitcnt lgkmcnt(5)
  v_mfma_f32_16x16x32_bf16 v[72:75], a[208:211], v[36:39], v[72:75]
  s_add_u32 s29, s29, 1
  ds_read_b128 v[28:31], v9 offset:32768
  v_mfma_f32_16x16x32_bf16 v[76:79], a[212:215], v[36:39], v[76:79]
  v_mfma_f32_16x16x32_bf16 v[88:91], a[216:219], v[36:39], v[88:91]
  s_max_i32 s30, s29, 0
  v_mfma_f32_16x16x32_bf16 v[92:95], a[220:223], v[36:39], v[92:95]
  s_waitcnt lgkmcnt(5)
  v_mov_b32 v144, s30
  v_mfma_f32_16x16x32_bf16 v[64:67], a[224:227], v[40:43], v[64:67]
  ds_read_b128 v[32:35], v10 offset:32768
  v_mfma_f32_16x16x32_bf16 v[68:71], a[228:231], v[40:43], v[68:71]
  v_mfma_f32_16x16x32_bf16 v[80:83], a[232:235], v[40:43], v[80:83]
  buffer_store_dword v144, v145, s[4:7], s31 offen sc1
  v_mfma_f32_16x16x32_bf16 v[84:87], a[236:239], v[40:43], v[84:87]
  s_waitcnt lgkmcnt(5)
  v_mfma_f32_16x16x32_bf16 v[72:75], a[224:227], v[44:47], v[72:75]
  ds_read_b128 v[36:39], v11 offset:32768
  v_mfma_f32_16x16x32_bf16 v[76:79], a[228:231], v[44:47], v[76:79]
  v_mfma_f32_16x16x32_bf16 v[88:91], a[232:235], v[44:47], v[88:91]
  v_mfma_f32_16x16x32_bf16 v[92:95], a[236:239], v[44:47], v[92:95]
  s_waitcnt lgkmcnt(5)
  v_mfma_f32_16x16x32_bf16 v[64:67], a[240:243], v[48:51], v[64:67]
  s_sub_u32 s23, s23, 1
  ds_read_b128 v[40:43], v12 offset:32768
  v_mfma_f32_16x16x32_bf16 v[68:71], a[244:247], v[48:51], v[68:71]
  v_mfma_f32_16x16x32_bf16 v[80:83], a[248:251], v[48:51], v[80:83]
  v_mfma_f32_16x16x32_bf16 v[84:87], a[252:255], v[48:51], v[84:87]
  s_waitcnt lgkmcnt(5)
  v_mfma_f32_16x16x32_bf16 v[72:75], a[240:243], v[52:55], v[72:75]
  s_cmp_eq_u32 s23, 0
  ds_read_b128 v[44:47], v13 offset:32768
  v_mfma_f32_16x16x32_bf16 v[76:79], a[244:247], v[52:55], v[76:79]
  v_mfma_f32_16x16x32_bf16 v[88:91], a[248:251], v[52:55], v[88:91]
  v_mfma_f32_16x16x32_bf16 v[92:95], a[252:255], v[52:55], v[92:95]
  s_cbranch_scc1 G_done0_178
  s_waitcnt lgkmcnt(5)
  v_mfma_f32_16x16x32_bf16 v[96:99], a[0:3], v[24:27], 0
  s_add_u32 m0, s25, 0
  ds_read_b128 v[48:51], v14 offset:32768
  v_mfma_f32_16x16x32_bf16 v[100:103], a[4:7], v[24:27], 0
  v_mfma_f32_16x16x32_bf16 v[112:115], a[8:11], v[24:27], 0
  buffer_load_dwordx4 v16, s[12:15], s19 offen lds
  v_mfma_f32_16x16x32_bf16 v[116:119], a[12:15], v[24:27], 0
  s_waitcnt lgkmcnt(5)
  v_mfma_f32_16x16x32_bf16 v[104:107], a[0:3], v[28:31], 0
  ds_read_b128 v[52:55], v15 offset:32768
  v_mfma_f32_16x16x32_bf16 v[108:111], a[4:7], v[28:31], 0
  v_mul_f32 v64, s24, v64
  v_mul_f32 v65, s24, v65
  v_mfma_f32_16x16x32_bf16 v[120:123], a[8:11], v[28:31], 0
  v_mfma_f32_16x16x32_bf16 v[124:127], a[12:15], v[28:31], 0
  s_waitcnt lgkmcnt(5)
  v_cvt_pk_bf16_f32 v128, v64, v65
  v_mul_f32 v66, s24, v66
  v_mfma_f32_16x16x32_bf16 v[96:99], a[16:19], v[32:35], v[96:99]
  s_add_u32 m0, s25, 1024
  ds_read_b128 v[24:27], v8 offset:40960
  v_mfma_f32_16x16x32_bf16 v[100:103], a[20:23], v[32:35], v[100:103]
  v_mul_f32 v67, s24, v67
  v_cvt_pk_bf16_f32 v129, v66, v67
  v_mfma_f32_16x16x32_bf16 v[112:115], a[24:27], v[32:35], v[112:115]
  buffer_load_dwordx4 v17, s[12:15], s19 offen lds
  v_mfma_f32_16x16x32_bf16 v[116:119], a[28:31], v[32:35], v[116:119]
  s_waitcnt lgkmcnt(5)
  v_mul_f32 v68, s24, v68
  v_mul_f32 v69, s24, v69
  v_mfma_f32_16x16x32_bf16 v[104:107], a[16:19], v[36:39], v[104:107]
  ds_read_b128 v[28:31], v9 offset:40960
  v_mfma_f32_16x16x32_bf16 v[108:111], a[20:23], v[36:39], v[108:111]
  v_cvt_pk_bf16_f32 v130, v68, v69
  v_mul_f32 v70, s24, v70
  v_mfma_f32_16x16x32_bf16 v[120:123], a[24:27], v[36:39], v[120:123]
  v_mfma_f32_16x16x32_bf16 v[124:127], a[28:31], v[36:39], v[124:127]
  s_waitcnt lgkmcnt(5)
  v_mul_f32 v71, s24, v71
  v_cvt_pk_bf16_f32 v131, v70, v71
  v_mfma_f32_16x16x32_bf16 v[96:99], a[32:35], v[40:43], v[96:99]
  s_add_u32 m0, s25, 2048
  ds_read_b128 v[32:35], v10 offset:40960
  v_mfma_f32_16x16x32_bf16 v[100:103], a[36:39], v[40:43], v[100:103]
  v_mul_f32 v72, s24, v72
  v_mul_f32 v73, s24, v73
  v_mfma_f32_16x16x32_bf16 v[112:115], a[40:43], v[40:43], v[112:115]
  buffer_load_dwordx4 v18, s[12:15], s19 offen lds
  v_mfma_f32_16x16x32_bf16 v[116:119], a[44:47], v[40:43], v[116:119]
  s_waitcnt lgkmcnt(5)
  v_cvt_pk_bf16_f32 v132, v72, v73
  v_mul_f32 v74, s24, v74
  v_mfma_f32_16x16x32_bf16 v[104:107], a[32:35], v[44:47], v[104:107]
  ds_read_b128 v[36:39], v11 offset:40960
  v_mfma_f32_16x16x32_bf16 v[108:111], a[36:39], v[44:47], v[108:111]
  v_mul_f32 v75, s24, v75
  v_cvt_pk_bf16_f32 v133, v74, v75
  v_mfma_f32_16x16x32_bf16 v[120:123], a[40:43], v[44:47], v[120:123]
  v_mfma_f32_16x16x32_bf16 v[124:127], a[44:47], v[44:47], v[124:127]
  s_waitcnt lgkmcnt(5)
  v_mul_f32 v76, s24, v76
  v_mul_f32 v77, s24, v77
  v_mfma_f32_16x16x32_bf16 v[96:99], a[48:51], v[48:51], v[96:99]
  s_add_u32 m0, s25, 3072
  ds_read_b128 v[40:43], v12 offset:40960
  v_mfma_f32_16x16x32_bf16 v[100:103], a[52:55], v[48:51], v[100:103]
  v_cvt_pk_bf16_f32 v134, v76, v77
  v_mul_f32 v78, s24, v78
  v_mfma_f32_16x16x32_bf16 v[112:115], a[56:59], v[48:51], v[112:115]
  buffer_load_dwordx4 v19, s[12:15], s19 offen lds
  v_mfma_f32_16x16x32_bf16 v[116:119], a[60:63], v[48:51], v[116:119]
  s_waitcnt lgkmcnt(5)
  v_mul_f32 v79, s24, v79
  v_cvt_pk_bf16_f32 v135, v78, v79
  v_mfma_f32_16x16x32_bf16 v[104:107], a[48:51], v[52:55], v[104:107]
  ds_read_b128 v[44:47], v13 offset:40960
  v_mfma_f32_16x16x32_bf16 v[108:111], a[52:55], v[52:55], v[108:111]
  v_mul_f32 v80, s24, v80
  v_mul_f32 v81, s24, v81
  v_mfma_f32_16x16x32_bf16 v[120:123], a[56:59], v[52:55], v[120:123]
  v_mfma_f32_16x16x32_bf16 v[124:127], a[60:63], v[52:55], v[124:127]
  s_waitcnt lgkmcnt(5)
  v_cvt_pk_bf16_f32 v136, v80, v81
  v_mul_f32 v82, s24, v82
  v_mfma_f32_16x16x32_bf16 v[96:99], a[64:67], v[24:27], v[96:99]
  s_add_u32 m0, s25, 4096
  ds_read_b128 v[48:51], v14 offset:40960
  v_mfma_f32_16x16x32_bf16 v[100:103], a[68:71], v[24:27], v[100:103]
  v_mul_f32 v83, s24, v83
  v_cvt_pk_bf16_f32 v137, v82, v83
  v_mfma_f32_16x16x32_bf16 v[112:115], a[72:75], v[24:27], v[112:115]
  buffer_load_dwordx4 v20, s[12:15], s19 offen lds
  v_mfma_f32_16x16x32_bf16 v[116:119], a[76:79], v[24:27], v[116:119]
  s_waitcnt lgkmcnt(5)
  v_mul_f32 v84, s24, v84
  v_mul_f32 v85, s24, v85
  v_mfma_f32_16x16x32_bf16 v[104:107], a[64:67], v[28:31], v[104:107]
  ds_read_b128 v[52:55], v15 offset:40960
  v_mfma_f32_16x16x32_bf16 v[108:111], a[68:71], v[28:31], v[108:111]
  v_cvt_pk_bf16_f32 v138, v84, v85
  v_mul_f32 v86, s24, v86
  v_mfma_f32_16x16x32_bf16 v[120:123], a[72:75], v[28:31], v[120:123]
  v_mfma_f32_16x16x32_bf16 v[124:127], a[76:79], v[28:31], v[124:127]
  s_waitcnt lgkmcnt(5)
  v_mul_f32 v87, s24, v87
  v_cvt_pk_bf16_f32 v139, v86, v87
  v_mfma_f32_16x16x32_bf16 v[96:99], a[80:83], v[32:35], v[96:99]
  s_add_u32 m0, s25, 5120
  ds_read_b128 v[24:27], v8 offset:49152
  v_mfma_f32_16x16x32_bf16 v[100:103], a[84:87], v[32:35], v[100:103]
  v_mul_f32 v88, s24, v88
  v_mul_f32 v89, s24, v89
  v_mfma_f32_16x16x32_bf16 v[112:115], a[88:91], v[32:35], v[112:115]
  buffer_load_dwordx4 v21, s[12:15], s19 offen lds
  v_mfma_f32_16x16x32_bf16 v[116:119], a[92:95], v[32:35], v[116:119]
  s_waitcnt lgkmcnt(5)
  v_cvt_pk_bf16_f32 v140, v88, v89
  v_mul_f32 v90, s24, v90
  v_mfma_f32_16x16x32_bf16 v[104:107], a[80:83], v[36:39], v[104:107]
  ds_read_b128 v[28:31], v9 offset:49152
  v_mfma_f32_16x16x32_bf16 v[108:111], a[84:87], v[36:39], v[108:111]
  v_mul_f32 v91, s24, v91
  v_cvt_pk_bf16_f32 v141, v90, v91
  v_mfma_f32_16x16x32_bf16 v[120:123], a[88:91], v[36:39], v[120:123]
  v_mfma_f32_16x16x32_bf16 v[124:127], a[92:95], v[36:39], v[124:127]
  s_waitcnt lgkmcnt(5)
  v_mul_f32 v92, s24, v92
  v_mul_f32 v93, s24, v93
  v_mfma_f32_16x16x32_bf16 v[96:99], a[96:99], v[40:43], v[96:99]
  s_add_u32 m0, s25, 6144
  ds_read_b128 v[32:35], v10 offset:49152
  v_mfma_f32_16x16x32_bf16 v[100:103], a[100:103], v[40:43], v[100:103]
  v_cvt_pk_bf16_f32 v142, v92, v93
  v_mul_f32 v94, s24, v94
  v_mfma_f32_16x16x32_bf16 v[112:115], a[104:107], v[40:43], v[112:115]
  buffer_load_dwordx4 v22, s[12:15], s19 offen lds
  v_mfma_f32_16x16x32_bf16 v[116:119], a[108:111], v[40:43], v[116:119]
  s_waitcnt lgkmcnt(5)
  v_mul_f32 v95, s24, v95
  v_cvt_pk_bf16_f32 v143, v94, v95
  v_mfma_f32_16x16x32_bf16 v[104:107], a[96:99], v[44:47], v[104:107]
  ds_read_b128 v[36:39], v11 offset:49152
  v_mfma_f32_16x16x32_bf16 v[108:111], a[100:103], v[44:47], v[108:111]
  v_mfma_f32_16x16x32_bf16 v[120:123], a[104:107], v[44:47], v[120:123]
  v_mfma_f32_16x16x32_bf16 v[124:127], a[108:111], v[44:47], v[124:127]
  s_waitcnt lgkmcnt(5)
  v_mfma_f32_16x16x32_bf16 v[96:99], a[112:115], v[48:51], v[96:99]
  s_add_u32 m0, s25, 7168
  ds_read_b128 v[40:43], v12 offset:49152
  v_mfma_f32_16x16x32_bf16 v[100:103], a[116:119], v[48:51], v[100:103]
  v_mfma_f32_16x16x32_bf16 v[112:115], a[120:123], v[48:51], v[112:115]
  buffer_load_dwordx4 v23, s[12:15], s19 offen lds
  v_mfma_f32_16x16x32_bf16 v[116:119], a[124:127], v[48:51], v[116:119]
  s_waitcnt lgkmcnt(5)
  v_mfma_f32_16x16x32_bf16 v[104:107], a[112:115], v[52:55], v[104:107]
  s_cmp_gt_u32 s23, 3
  ds_read_b128 v[44:47], v13 offset:49152
  v_mfma_f32_16x16x32_bf16 v[108:111], a[116:119], v[52:55], v[108:111]
  v_mfma_f32_16x16x32_bf16 v[120:123], a[120:123], v[52:55], v[120:123]
  s_cselect_b32 s26, s20, 0
  v_mfma_f32_16x16x32_bf16 v[124:127], a[124:127], v[52:55], v[124:127]
  s_waitcnt lgkmcnt(5)
  v_mfma_f32_16x16x32_bf16 v[96:99], a[128:131], v[24:27], v[96:99]
  s_add_u32 s19, s19, s26
  ds_read_b128 v[48:51], v14 offset:49152
  v_mfma_f32_16x16x32_bf16 v[100:103], a[132:135], v[24:27], v[100:103]
  v_mfma_f32_16x16x32_bf16 v[112:115], a[136:139], v[24:27], v[112:115]
  s_add_u32 s25, s25, 32768
  v_mfma_f32_16x16x32_bf16 v[116:119], a[140:143], v[24:27], v[116:119]
  s_waitcnt lgkmcnt(5)
  v_mfma_f32_16x16x32_bf16 v[104:107], a[128:131], v[28:31], v[104:107]
  s_and_b32 s25, s25, 0x1ffff
  ds_read_b128 v[52:55], v15 offset:49152
  v_mfma_f32_16x16x32_bf16 v[108:111], a[132:135], v[28:31], v[108:111]
  v_mfma_f32_16x16x32_bf16 v[120:123], a[136:139], v[28:31], v[120:123]
  buffer_store_dwordx4 v[128:131], v7, s[4:7], s21 offen offset:0 sc1
  v_mfma_f32_16x16x32_bf16 v[124:127], a[140:143], v[28:31], v[124:127]
  s_waitcnt lgkmcnt(5)
  v_mfma_f32_16x16x32_bf16 v[96:99], a[144:147], v[32:35], v[96:99]
  ds_read_b128 v[24:27], v8 offset:57344
  v_mfma_f32_16x16x32_bf16 v[100:103], a[148:151], v[32:35], v[100:103]
  v_mfma_f32_16x16x32_bf16 v[112:115], a[152:155], v[32:35], v[112:115]
  v_mfma_f32_16x16x32_bf16 v[116:119], a[156:159], v[32:35], v[116:119]
  s_waitcnt lgkmcnt(5)
  v_xor_b32 v8, 0x10000, v8
  v_mfma_f32_16x16x32_bf16 v[104:107], a[144:147], v[36:39], v[104:107]
  ds_read_b128 v[28:31], v9 offset:57344
  v_mfma_f32_16x16x32_bf16 v[108:111], a[148:151], v[36:39], v[108:111]
  v_mfma_f32_16x16x32_bf16 v[120:123], a[152:155], v[36:39], v[120:123]
  buffer_store_dwordx4 v[132:135], v7, s[4:7], s21 offen offset:256 sc1
  v_mfma_f32_16x16x32_bf16 v[124:127], a[156:159], v[36:39], v[124:127]
  s_waitcnt lgkmcnt(5)
  v_xor_b32 v9, 0x10000, v9
  v_mfma_f32_16x16x32_bf16 v[96:99], a[160:163], v[40:43], v[96:99]
  ds_read_b128 v[32:35], v10 offset:57344
  v_mfma_f32_16x16x32_bf16 v[100:103], a[164:167], v[40:43], v[100:103]
  v_mfma_f32_16x16x32_bf16 v[112:115], a[168:171], v[40:43], v[112:115]
  v_mfma_f32_16x16x32_bf16 v[116:119], a[172:175], v[40:43], v[116:119]
  s_waitcnt lgkmcnt(5)
  v_xor_b32 v10, 0x10000, v10
  v_mfma_f32_16x16x32_bf16 v[104:107], a[160:163], v[44:47], v[104:107]
  ds_read_b128 v[36:39], v11 offset:57344
  v_mfma_f32_16x16x32_bf16 v[108:111], a[164:167], v[44:47], v[108:111]
  v_mfma_f32_16x16x32_bf16 v[120:123], a[168:171], v[44:47], v[120:123]
  buffer_store_dwordx4 v[136:139], v7, s[4:7], s21 offen offset:2048 sc1
  v_mfma_f32_16x16x32_bf16 v[124:127], a[172:175], v[44:47], v[124:127]
  s_waitcnt lgkmcnt(5)
  v_xor_b32 v11, 0x10000, v11
  v_mfma_f32_16x16x32_bf16 v[96:99], a[176:179], v[48:51], v[96:99]
  ds_read_b128 v[40:43], v12 offset:57344
  v_mfma_f32_16x16x32_bf16 v[100:103], a[180:183], v[48:51], v[100:103]
  v_mfma_f32_16x16x32_bf16 v[112:115], a[184:187], v[48:51], v[112:115]
  v_mfma_f32_16x16x32_bf16 v[116:119], a[188:191], v[48:51], v[116:119]
  s_waitcnt lgkmcnt(5)
  v_xor_b32 v12, 0x10000, v12
  v_mfma_f32_16x16x32_bf16 v[104:107], a[176:179], v[52:55], v[104:107]
  ds_read_b128 v[44:47], v13 offset:57344
  v_mfma_f32_16x16x32_bf16 v[108:111], a[180:183], v[52:55], v[108:111]
  v_mfma_f32_16x16x32_bf16 v[120:123], a[184:187], v[52:55], v[120:123]
  buffer_store_dwordx4 v[140:143], v7, s[4:7], s21 offen offset:2304 sc1
  v_mfma_f32_16x16x32_bf16 v[124:127], a[188:191], v[52:55], v[124:127]
  s_waitcnt lgkmcnt(5)
  v_xor_b32 v13, 0x10000, v13
  v_mfma_f32_16x16x32_bf16 v[96:99], a[192:195], v[24:27], v[96:99]
  s_mov_b32 s21, s27
  ds_read_b128 v[48:51], v14 offset:57344
  v_mfma_f32_16x16x32_bf16 v[100:103], a[196:199], v[24:27], v[100:103]
  v_mov_b32 v7, v56
  v_mfma_f32_16x16x32_bf16 v[112:115], a[200:203], v[24:27], v[112:115]
  v_mfma_f32_16x16x32_bf16 v[116:119], a[204:207], v[24:27], v[116:119]
  s_waitcnt lgkmcnt(5)
  v_xor_b32 v14, 0x10000, v14
  v_mfma_f32_16x16x32_bf16 v[104:107], a[192:195], v[28:31], v[104:107]
  s_add_u32 s27, s27, s22
  ds_read_b128 v[52:55], v15 offset:57344
  v_mfma_f32_16x16x32_bf16 v[108:111], a[196:199], v[28:31], v[108:111]
  v_mfma_f32_16x16x32_bf16 v[120:123], a[200:203], v[28:31], v[120:123]
  s_waitcnt vmcnt(13)
  s_barrier
  v_mfma_f32_16x16x32_bf16 v[124:127], a[204:207], v[28:31], v[124:127]
  s_waitcnt lgkmcnt(5)
  v_xor_b32 v15, 0x10000, v15
  v_mfma_f32_16x16x32_bf16 v[96:99], a[208:211], v[32:35], v[96:99]
  ds_read_b128 v[24:27], v8 offset:0
  v_mfma_f32_16x16x32_bf16 v[100:103], a[212:215], v[32:35], v[100:103]
  v_mfma_f32_16x16x32_bf16 v[112:115], a[216:219], v[32:35], v[112:115]
  v_mfma_f32_16x16x32_bf16 v[116:119], a[220:223], v[32:35], v[116:119]
  s_waitcnt lgkmcnt(5)
  v_mfma_f32_16x16x32_bf16 v[104:107], a[208:211], v[36:39], v[104:107]
  s_add_u32 s29, s29, 1
  ds_read_b128 v[28:31], v9 offset:0
  v_mfma_f32_16x16x32_bf16 v[108:111], a[212:215], v[36:39], v[108:111]
  v_mfma_f32_16x16x32_bf16 v[120:123], a[216:219], v[36:39], v[120:123]
  s_max_i32 s30, s29, 0
  v_mfma_f32_16x16x32_bf16 v[124:127], a[220:223], v[36:39], v[124:127]
  s_waitcnt lgkmcnt(5)
  v_mov_b32 v144, s30
  v_mfma_f32_16x16x32_bf16 v[96:99], a[224:227], v[40:43], v[96:99]
  ds_read_b128 v[32:35], v10 offset:0
  v_mfma_f32_16x16x32_bf16 v[100:103], a[228:231], v[40:43], v[100:103]
  v_mfma_f32_16x16x32_bf16 v[112:115], a[232:235], v[40:43], v[112:115]
  buffer_store_dword v144, v145, s[4:7], s31 offen sc1
  v_mfma_f32_16x16x32_bf16 v[116:119], a[236:239], v[40:43], v[116:119]
  s_waitcnt lgkmcnt(5)
  v_mfma_f32_16x16x32_bf16 v[104:107], a[224:227], v[44:47], v[104:107]
  ds_read_b128 v[36:39], v11 offset:0
  v_mfma_f32_16x16x32_bf16 v[108:111], a[228:231], v[44:47], v[108:111]
  v_mfma_f32_16x16x32_bf16 v[120:123], a[232:235], v[44:47], v[120:123]
  v_mfma_f32_16x16x32_bf16 v[124:127], a[236:239], v[44:47], v[124:127]
  s_waitcnt lgkmcnt(5)
  v_mfma_f32_16x16x32_bf16 v[96:99], a[240:243], v[48:51], v[96:99]
  s_sub_u32 s23, s23, 1
  ds_read_b128 v[40:43], v12 offset:0
  v_mfma_f32_16x16x32_bf16 v[100:103], a[244:247], v[48:51], v[100:103]
  v_mfma_f32_16x16x32_bf16 v[112:115], a[248:251], v[48:51], v[112:115]
  v_mfma_f32_16x16x32_bf16 v[116:119], a[252:255], v[48:51], v[116:119]
  s_waitcnt lgkmcnt(5)
  v_mfma_f32_16x16x32_bf16 v[104:107], a[240:243], v[52:55], v[104:107]
  s_cmp_eq_u32 s23, 0
  ds_read_b128 v[44:47], v13 offset:0
  v_mfma_f32_16x16x32_bf16 v[108:111], a[244:247], v[52:55], v[108:111]
  v_mfma_f32_16x16x32_bf16 v[120:123], a[248:251], v[52:55], v[120:123]
  v_mfma_f32_16x16x32_bf16 v[124:127], a[252:255], v[52:55], v[124:127]
  s_cbranch_scc1 G_done1_179
  s_branch G_top_177
G_done0_178:
  s_nop 7
  s_nop 3
  v_mul_f32 v64, s24, v64
  v_mul_f32 v65, s24, v65
  v_cvt_pk_bf16_f32 v128, v64, v65
  v_mul_f32 v66, s24, v66
  v_mul_f32 v67, s24, v67
  v_cvt_pk_bf16_f32 v129, v66, v67
  v_mul_f32 v68, s24, v68
  v_mul_f32 v69, s24, v69
  v_cvt_pk_bf16_f32 v130, v68, v69
  v_mul_f32 v70, s24, v70
  v_mul_f32 v71, s24, v71
  v_cvt_pk_bf16_f32 v131, v70, v71
  buffer_store_dwordx4 v[128:131], v7, s[4:7], s21 offen offset:0 sc1
  v_mul_f32 v72, s24, v72
  v_mul_f32 v73, s24, v73
  v_cvt_pk_bf16_f32 v132, v72, v73
  v_mul_f32 v74, s24, v74
  v_mul_f32 v75, s24, v75
  v_cvt_pk_bf16_f32 v133, v74, v75
  v_mul_f32 v76, s24, v76
  v_mul_f32 v77, s24, v77
  v_cvt_pk_bf16_f32 v134, v76, v77
  v_mul_f32 v78, s24, v78
  v_mul_f32 v79, s24, v79
  v_cvt_pk_bf16_f32 v135, v78, v79
  buffer_store_dwordx4 v[132:135], v7, s[4:7], s21 offen offset:256 sc1
  v_mul_f32 v80, s24, v80
  v_mul_f32 v81, s24, v81
  v_cvt_pk_bf16_f32 v136, v80, v81
  v_mul_f32 v82, s24, v82
  v_mul_f32 v83, s24, v83
  v_cvt_pk_bf16_f32 v137, v82, v83
  v_mul_f32 v84, s24, v84
  v_mul_f32 v85, s24, v85
  v_cvt_pk_bf16_f32 v138, v84, v85
  v_mul_f32 v86, s24, v86
  v_mul_f32 v87, s24, v87
  v_cvt_pk_bf16_f32 v139, v86, v87
  buffer_store_dwordx4 v[136:139], v7, s[4:7], s21 offen offset:2048 sc1
  v_mul_f32 v88, s24, v88
  v_mul_f32 v89, s24, v89
  v_cvt_pk_bf16_f32 v140, v88, v89
  v_mul_f32 v90, s24, v90
  v_mul_f32 v91, s24, v91
  v_cvt_pk_bf16_f32 v141, v90, v91
  v_mul_f32 v92, s24, v92
  v_mul_f32 v93, s24, v93
  v_cvt_pk_bf16_f32 v142, v92, v93
  v_mul_f32 v94, s24, v94
  v_mul_f32 v95, s24, v95
  v_cvt_pk_bf16_f32 v143, v94, v95
  buffer_store_dwordx4 v[140:143], v7, s[4:7], s21 offen offset:2304 sc1
  s_branch G_fin_180
G_done1_179:
  s_nop 7
  s_nop 3
  v_mul_f32 v96, s24, v96
  v_mul_f32 v97, s24, v97
  v_cvt_pk_bf16_f32 v128, v96, v97
  v_mul_f32 v98, s24, v98
  v_mul_f32 v99, s24, v99
  v_cvt_pk_bf16_f32 v129, v98, v99
  v_mul_f32 v100, s24, v100
  v_mul_f32 v101, s24, v101
  v_cvt_pk_bf16_f32 v130, v100, v101
  v_mul_f32 v102, s24, v102
  v_mul_f32 v103, s24, v103
  v_cvt_pk_bf16_f32 v131, v102, v103
  buffer_store_dwordx4 v[128:131], v7, s[4:7], s21 offen offset:0 sc1
  v_mul_f32 v104, s24, v104
  v_mul_f32 v105, s24, v105
  v_cvt_pk_bf16_f32 v132, v104, v105
  v_mul_f32 v106, s24, v106
  v_mul_f32 v107, s24, v107
  v_cvt_pk_bf16_f32 v133, v106, v107
  v_mul_f32 v108, s24, v108
  v_mul_f32 v109, s24, v109
  v_cvt_pk_bf16_f32 v134, v108, v109
  v_mul_f32 v110, s24, v110
  v_mul_f32 v111, s24, v111
  v_cvt_pk_bf16_f32 v135, v110, v111
  buffer_store_dwordx4 v[132:135], v7, s[4:7], s21 offen offset:256 sc1
  v_mul_f32 v112, s24, v112
  v_mul_f32 v113, s24, v113
  v_cvt_pk_bf16_f32 v136, v112, v113
  v_mul_f32 v114, s24, v114
  v_mul_f32 v115, s24, v115
  v_cvt_pk_bf16_f32 v137, v114, v115
  v_mul_f32 v116, s24, v116
  v_mul_f32 v117, s24, v117
  v_cvt_pk_bf16_f32 v138, v116, v117
  v_mul_f32 v118, s24, v118
  v_mul_f32 v119, s24, v119
  v_cvt_pk_bf16_f32 v139, v118, v119
  buffer_store_dwordx4 v[136:139], v7, s[4:7], s21 offen offset:2048 sc1
  v_mul_f32 v120, s24, v120
  v_mul_f32 v121, s24, v121
  v_cvt_pk_bf16_f32 v140, v120, v121
  v_mul_f32 v122, s24, v122
  v_mul_f32 v123, s24, v123
  v_cvt_pk_bf16_f32 v141, v122, v123
  v_mul_f32 v124, s24, v124
  v_mul_f32 v125, s24, v125
  v_cvt_pk_bf16_f32 v142, v124, v125
  v_mul_f32 v126, s24, v126
  v_mul_f32 v127, s24, v127
  v_cvt_pk_bf16_f32 v143, v126, v127
  buffer_store_dwordx4 v[140:143], v7, s[4:7], s21 offen offset:2304 sc1
G_fin_180:
  s_waitcnt vmcnt(0) lgkmcnt(0)
  s_barrier
  s_add_u32 s30, s29, 2
  v_mov_b32 v144, s30
  v_min_u32 v145, 1, v0
  v_lshlrev_b32 v145, 30, v145
  buffer_store_dword v144, v145, s[4:7], s31 offen sc1
  s_branch P_end_171
P_v_170:
  s_mov_b32 s27, s21
  v_mov_b32 v7, 0x40000000
  s_mov_b32 s29, -2
  v_min_u32 v145, 1, v0
  v_lshlrev_b32 v145, 30, v145
  ds_read_b128 v[24:27], v8 offset:0
  ds_read_b128 v[28:31], v9 offset:0
  ds_read_b128 v[32:35], v10 offset:0
  ds_read_b128 v[36:39], v11 offset:0
  ds_read_b128 v[40:43], v12 offset:0
  ds_read_b128 v[44:47], v13 offset:0
.p2align 6
G_top_181:
  s_waitcnt lgkmcnt(5)
  v_mfma_f32_16x16x32_bf16 v[64:67], v[24:27], a[0:3], 0
  s_add_u32 m0, s25, 0
  ds_read_b128 v[48:51], v14 offset:0
  v_mfma_f32_16x16x32_bf16 v[72:75], v[24:27], a[4:7], 0
  v_mfma_f32_16x16x32_bf16 v[80:83], v[24:27], a[8:11], 0
  buffer_load_dwordx4 v16, s[12:15], s19 offen lds
  v_mfma_f32_16x16x32_bf16 v[88:91], v[24:27], a[12:15], 0
  s_waitcnt lgkmcnt(5)
  v_mfma_f32_16x16x32_bf16 v[68:71], v[28:31], a[0:3], 0
  ds_read_b128 v[52:55], v15 offset:0
  v_mfma_f32_16x16x32_bf16 v[76:79], v[28:31], a[4:7], 0
  v_cvt_pk_bf16_f32 v128, v96, v97
  v_cvt_pk_bf16_f32 v129, v98, v99
  v_mfma_f32_16x16x32_bf16 v[84:87], v[28:31], a[8:11], 0
  v_mfma_f32_16x16x32_bf16 v[92:95], v[28:31], a[12:15], 0
  s_waitcnt lgkmcnt(5)
  v_cvt_pk_bf16_f32 v130, v100, v101
  v_cvt_pk_bf16_f32 v131, v102, v103
  v_mfma_f32_16x16x32_bf16 v[64:67], v[32:35], a[16:19], v[64:67]
  s_add_u32 m0, s25, 1024
  ds_read_b128 v[24:27], v8 offset:8192
  v_mfma_f32_16x16x32_bf16 v[72:75], v[32:35], a[20:23], v[72:75]
  v_mfma_f32_16x16x32_bf16 v[80:83], v[32:35], a[24:27], v[80:83]
  buffer_load_dwordx4 v17, s[12:15], s19 offen lds
  v_mfma_f32_16x16x32_bf16 v[88:91], v[32:35], a[28:31], v[88:91]
  s_waitcnt lgkmcnt(5)
  v_mfma_f32_16x16x32_bf16 v[68:71], v[36:39], a[16:19], v[68:71]
  ds_read_b128 v[28:31], v9 offset:8192
  v_mfma_f32_16x16x32_bf16 v[76:79], v[36:39], a[20:23], v[76:79]
  v_mfma_f32_16x16x32_bf16 v[84:87], v[36:39], a[24:27], v[84:87]
  v_mfma_f32_16x16x32_bf16 v[92:95], v[36:39], a[28:31], v[92:95]
  s_waitcnt lgkmcnt(5)
  v_mfma_f32_16x16x32_bf16 v[64:67], v[40:43], a[32:35], v[64:67]
  s_add_u32 m0, s25, 2048
  ds_read_b128 v[32:35], v10 offset:8192
  v_mfma_f32_16x16x32_bf16 v[72:75], v[40:43], a[36:39], v[72:75]
  v_cvt_pk_bf16_f32 v132, v104, v105
  v_cvt_pk_bf16_f32 v133, v106, v107
  v_mfma_f32_16x16x32_bf16 v[80:83], v[40:43], a[40:43], v[80:83]
  buffer_load_dwordx4 v18, s[12:15], s19 offen lds
  v_mfma_f32_16x16x32_bf16 v[88:91], v[40:43], a[44:47], v[88:91]
  s_waitcnt lgkmcnt(5)
  v_cvt_pk_bf16_f32 v134, v108, v109
  v_cvt_pk_bf16_f32 v135, v110, v111
  v_mfma_f32_16x16x32_bf16 v[68:71], v[44:47], a[32:35], v[68:71]
  ds_read_b128 v[36:39], v11 offset:8192
  v_mfma_f32_16x16x32_bf16 v[76:79], v[44:47], a[36:39], v[76:79]
  v_mfma_f32_16x16x32_bf16 v[84:87], v[44:47], a[40:43], v[84:87]
  v_mfma_f32_16x16x32_bf16 v[92:95], v[44:47], a[44:47], v[92:95]
  s_waitcnt lgkmcnt(5)
  v_mfma_f32_16x16x32_bf16 v[64:67], v[48:51], a[48:51], v[64:67]
  s_add_u32 m0, s25, 3072
  ds_read_b128 v[40:43], v12 offset:8192
  v_mfma_f32_16x16x32_bf16 v[72:75], v[48:51], a[52:55], v[72:75]
  v_mfma_f32_16x16x32_bf16 v[80:83], v[48:51], a[56:59], v[80:83]
  buffer_load_dwordx4 v19, s[12:15], s19 offen lds
  v_mfma_f32_16x16x32_bf16 v[88:91], v[48:51], a[60:63], v[88:91]
  s_waitcnt lgkmcnt(5)
  v_mfma_f32_16x16x32_bf16 v[68:71], v[52:55], a[48:51], v[68:71]
  ds_read_b128 v[44:47], v13 offset:8192
  v_mfma_f32_16x16x32_bf16 v[76:79], v[52:55], a[52:55], v[76:79]
  v_cvt_pk_bf16_f32 v136, v112, v113
  v_cvt_pk_bf16_f32 v137, v114, v115
  v_mfma_f32_16x16x32_bf16 v[84:87], v[52:55], a[56:59], v[84:87]
  v_mfma_f32_16x16x32_bf16 v[92:95], v[52:55], a[60:63], v[92:95]
  s_waitcnt lgkmcnt(5)
  v_cvt_pk_bf16_f32 v138, v116, v117
  v_cvt_pk_bf16_f32 v139, v118, v119
  v_mfma_f32_16x16x32_bf16 v[64:67], v[24:27], a[64:67], v[64:67]
  s_add_u32 m0, s25, 4096
  ds_read_b128 v[48:51], v14 offset:8192
  v_mfma_f32_16x16x32_bf16 v[72:75], v[24:27], a[68:71], v[72:75]
  v_mfma_f32_16x16x32_bf16 v[80:83], v[24:27], a[72:75], v[80:83]
  buffer_load_dwordx4 v20, s[12:15], s19 offen lds
  v_mfma_f32_16x16x32_bf16 v[88:91], v[24:27], a[76:79], v[88:91]
  s_waitcnt lgkmcnt(5)
  v_mfma_f32_16x16x32_bf16 v[68:71], v[28:31], a[64:67], v[68:71]
  ds_read_b128 v[52:55], v15 offset:8192
  v_mfma_f32_16x16x32_bf16 v[76:79], v[28:31], a[68:71], v[76:79]
  v_mfma_f32_16x16x32_bf16 v[84:87], v[28:31], a[72:75], v[84:87]
  v_mfma_f32_16x16x32_bf16 v[92:95], v[28:31], a[76:79], v[92:95]
  s_waitcnt lgkmcnt(5)
  v_mfma_f32_16x16x32_bf16 v[64:67], v[32:35], a[80:83], v[64:67]
  s_add_u32 m0, s25, 5120
  ds_read_b128 v[24:27], v8 offset:16384
  v_mfma_f32_16x16x32_bf16 v[72:75], v[32:35], a[84:87], v[72:75]
  v_cvt_pk_bf16_f32 v140, v120, v121
  v_cvt_pk_bf16_f32 v141, v122, v123
  v_mfma_f32_16x16x32_bf16 v[80:83], v[32:35], a[88:91], v[80:83]
  buffer_load_dwordx4 v21, s[12:15], s19 offen lds
  v_mfma_f32_16x16x32_bf16 v[88:91], v[32:35], a[92:95], v[88:91]
  s_waitcnt lgkmcnt(5)
  v_cvt_pk_bf16_f32 v142, v124, v125
  v_cvt_pk_bf16_f32 v143, v126, v127
  v_mfma_f32_16x16x32_bf16 v[68:71], v[36:39], a[80:83], v[68:71]
  ds_read_b128 v[28:31], v9 offset:16384
  v_mfma_f32_16x16x32_bf16 v[76:79], v[36:39], a[84:87], v[76:79]
  v_mfma_f32_16x16x32_bf16 v[84:87], v[36:39], a[88:91], v[84:87]
  v_mfma_f32_16x16x32_bf16 v[92:95], v[36:39], a[92:95], v[92:95]
  s_waitcnt lgkmcnt(5)
  v_mfma_f32_16x16x32_bf16 v[64:67], v[40:43], a[96:99], v[64:67]
  s_add_u32 m0, s25, 6144
  ds_read_b128 v[32:35], v10 offset:16384
  v_mfma_f32_16x16x32_bf16 v[72:75], v[40:43], a[100:103], v[72:75]
  v_mfma_f32_16x16x32_bf16 v[80:83], v[40:43], a[104:107], v[80:83]
  buffer_load_dwordx4 v22, s[12:15], s19 offen lds
  v_mfma_f32_16x16x32_bf16 v[88:91], v[40:43], a[108:111], v[88:91]
  s_waitcnt lgkmcnt(5)
  v_mfma_f32_16x16x32_bf16 v[68:71], v[44:47], a[96:99], v[68:71]
  ds_read_b128 v[36:39], v11 offset:16384
  v_mfma_f32_16x16x32_bf16 v[76:79], v[44:47], a[100:103], v[76:79]
  v_mfma_f32_16x16x32_bf16 v[84:87], v[44:47], a[104:107], v[84:87]
  v_mfma_f32_16x16x32_bf16 v[92:95], v[44:47], a[108:111], v[92:95]
  s_waitcnt lgkmcnt(5)
  v_mfma_f32_16x16x32_bf16 v[64:67], v[48:51], a[112:115], v[64:67]
  s_add_u32 m0, s25, 7168
  ds_read_b128 v[40:43], v12 offset:16384
  v_mfma_f32_16x16x32_bf16 v[72:75], v[48:51], a[116:119], v[72:75]
  v_mfma_f32_16x16x32_bf16 v[80:83], v[48:51], a[120:123], v[80:83]
  buffer_load_dwordx4 v23, s[12:15], s19 offen lds
  v_mfma_f32_16x16x32_bf16 v[88:91], v[48:51], a[124:127], v[88:91]
  s_waitcnt lgkmcnt(5)
  v_mfma_f32_16x16x32_bf16 v[68:71], v[52:55], a[112:115], v[68:71]
  s_cmp_gt_u32 s23, 3
  ds_read_b128 v[44:47], v13 offset:16384
  v_mfma_f32_16x16x32_bf16 v[76:79], v[52:55], a[116:119], v[76:79]
  v_mfma_f32_16x16x32_bf16 v[84:87], v[52:55], a[120:123], v[84:87]
  s_cselect_b32 s26, s20, 0
  v_mfma_f32_16x16x32_bf16 v[92:95], v[52:55], a[124:127], v[92:95]
  s_waitcnt lgkmcnt(5)
  v_mfma_f32_16x16x32_bf16 v[64:67], v[24:27], a[128:131], v[64:67]
  s_add_u32 s19, s19, s26
  ds_read_b128 v[48:51], v14 offset:16384
  v_mfma_f32_16x16x32_bf16 v[72:75], v[24:27], a[132:135], v[72:75]
  v_mfma_f32_16x16x32_bf16 v[80:83], v[24:27], a[136:139], v[80:83]
  s_add_u32 s25, s25, 32768
  v_mfma_f32_16x16x32_bf16 v[88:91], v[24:27], a[140:143], v[88:91]
  s_waitcnt lgkmcnt(5)
  v_mfma_f32_16x16x32_bf16 v[68:71], v[28:31], a[128:131], v[68:71]
  s_and_b32 s25, s25, 0x1ffff
  ds_read_b128 v[52:55], v15 offset:16384
  v_mfma_f32_16x16x32_bf16 v[76:79], v[28:31], a[132:135], v[76:79]
  v_mfma_f32_16x16x32_bf16 v[84:87], v[28:31], a[136:139], v[84:87]
  buffer_store_dwordx4 v[128:131], v7, s[4:7], s21 offen offset:0 sc1
  v_mfma_f32_16x16x32_bf16 v[92:95], v[28:31], a[140:143], v[92:95]
  s_waitcnt lgkmcnt(5)
  v_mfma_f32_16x16x32_bf16 v[64:67], v[32:35], a[144:147], v[64:67]
  ds_read_b128 v[24:27], v8 offset:24576
  v_mfma_f32_16x16x32_bf16 v[72:75], v[32:35], a[148:151], v[72:75]
  v_mfma_f32_16x16x32_bf16 v[80:83], v[32:35], a[152:155], v[80:83]
  v_mfma_f32_16x16x32_bf16 v[88:91], v[32:35], a[156:159], v[88:91]
  s_waitcnt lgkmcnt(5)
  v_mfma_f32_16x16x32_bf16 v[68:71], v[36:39], a[144:147], v[68:71]
  ds_read_b128 v[28:31], v9 offset:24576
  v_mfma_f32_16x16x32_bf16 v[76:79], v[36:39], a[148:151], v[76:79]
  v_mfma_f32_16x16x32_bf16 v[84:87], v[36:39], a[152:155], v[84:87]
  buffer_store_dwordx4 v[132:135], v7, s[4:7], s21 offen offset:256 sc1
  v_mfma_f32_16x16x32_bf16 v[92:95], v[36:39], a[156:159], v[92:95]
  s_waitcnt lgkmcnt(5)
  v_mfma_f32_16x16x32_bf16 v[64:67], v[40:43], a[160:163], v[64:67]
  ds_read_b128 v[32:35], v10 offset:24576
  v_mfma_f32_16x16x32_bf16 v[72:75], v[40:43], a[164:167], v[72:75]
  v_mfma_f32_16x16x32_bf16 v[80:83], v[40:43], a[168:171], v[80:83]
  v_mfma_f32_16x16x32_bf16 v[88:91], v[40:43], a[172:175], v[88:91]
  s_waitcnt lgkmcnt(5)
  v_mfma_f32_16x16x32_bf16 v[68:71], v[44:47], a[160:163], v[68:71]
  ds_read_b128 v[36:39], v11 offset:24576
  v_mfma_f32_16x16x32_bf16 v[76:79], v[44:47], a[164:167], v[76:79]
  v_mfma_f32_16x16x32_bf16 v[84:87], v[44:47], a[168:171], v[84:87]
  buffer_store_dwordx4 v[136:139], v7, s[4:7], s21 offen offset:2048 sc1
  v_mfma_f32_16x16x32_bf16 v[92:95], v[44:47], a[172:175], v[92:95]
  s_waitcnt lgkmcnt(5)
  v_mfma_f32_16x16x32_bf16 v[64:67], v[48:51], a[176:179], v[64:67]
  ds_read_b128 v[40:43], v12 offset:24576
  v_mfma_f32_16x16x32_bf16 v[72:75], v[48:51], a[180:183], v[72:75]
  v_mfma_f32_16x16x32_bf16 v[80:83], v[48:51], a[184:187], v[80:83]
  v_mfma_f32_16x16x32_bf16 v[88:91], v[48:51], a[188:191], v[88:91]
  s_waitcnt lgkmcnt(5)
  v_mfma_f32_16x16x32_bf16 v[68:71], v[52:55], a[176:179], v[68:71]
  ds_read_b128 v[44:47], v13 offset:24576
  v_mfma_f32_16x16x32_bf16 v[76:79], v[52:55], a[180:183], v[76:79]
  v_mfma_f32_16x16x32_bf16 v[84:87], v[52:55], a[184:187], v[84:87]
  buffer_store_dwordx4 v[140:143], v7, s[4:7], s21 offen offset:2304 sc1
  v_mfma_f32_16x16x32_bf16 v[92:95], v[52:55], a[188:191], v[92:95]
  s_waitcnt lgkmcnt(5)
  v_mfma_f32_16x16x32_bf16 v[64:67], v[24:27], a[192:195], v[64:67]
  s_mov_b32 s21, s27
  ds_read_b128 v[48:51], v14 offset:24576
  v_mfma_f32_16x16x32_bf16 v[72:75], v[24:27], a[196:199], v[72:75]
  v_mov_b32 v7, v56
  v_mfma_f32_16x16x32_bf16 v[80:83], v[24:27], a[200:203], v[80:83]
  v_mfma_f32_16x16x32_bf16 v[88:91], v[24:27], a[204:207], v[88:91]
  s_waitcnt lgkmcnt(5)
  v_mfma_f32_16x16x32_bf16 v[68:71], v[28:31], a[192:195], v[68:71]
  s_add_u32 s27, s27, s22
  ds_read_b128 v[52:55], v15 offset:24576
  v_mfma_f32_16x16x32_bf16 v[76:79], v[28:31], a[196:199], v[76:79]
  v_mfma_f32_16x16x32_bf16 v[84:87], v[28:31], a[200:203], v[84:87]
  s_waitcnt vmcnt(13)
  s_barrier
  v_mfma_f32_16x16x32_bf16 v[92:95], v[28:31], a[204:207], v[92:95]
  s_waitcnt lgkmcnt(5)
  v_mfma_f32_16x16x32_bf16 v[64:67], v[32:35], a[208:211], v[64:67]
  ds_read_b128 v[24:27], v8 offset:32768
  v_mfma_f32_16x16x32_bf16 v[72:75], v[32:35], a[212:215], v[72:75]
  v_mfma_f32_16x16x32_bf16 v[80:83], v[32:35], a[216:219], v[80:83]
  v_mfma_f32_16x16x32_bf16 v[88:91], v[32:35], a[220:223], v[88:91]
  s_waitcnt lgkmcnt(5)
  v_mfma_f32_16x16x32_bf16 v[68:71], v[36:39], a[208:211], v[68:71]
  s_add_u32 s29, s29, 1
  ds_read_b128 v[28:31], v9 offset:32768
  v_mfma_f32_16x16x32_bf16 v[76:79], v[36:39], a[212:215], v[76:79]
  v_mfma_f32_16x16x32_bf16 v[84:87], v[36:39], a[216:219], v[84:87]
  s_max_i32 s30, s29, 0
  v_mfma_f32_16x16x32_bf16 v[92:95], v[36:39], a[220:223], v[92:95]
  s_waitcnt lgkmcnt(5)
  v_mov_b32 v144, s30
  v_mfma_f32_16x16x32_bf16 v[64:67], v[40:43], a[224:227], v[64:67]
  ds_read_b128 v[32:35], v10 offset:32768
  v_mfma_f32_16x16x32_bf16 v[72:75], v[40:43], a[228:231], v[72:75]
  v_mfma_f32_16x16x32_bf16 v[80:83], v[40:43], a[232:235], v[80:83]
  buffer_store_dword v144, v145, s[4:7], s31 offen sc1
  v_mfma_f32_16x16x32_bf16 v[88:91], v[40:43], a[236:239], v[88:91]
  s_waitcnt lgkmcnt(5)
  v_mfma_f32_16x16x32_bf16 v[68:71], v[44:47], a[224:227], v[68:71]
  ds_read_b128 v[36:39], v11 offset:32768
  v_mfma_f32_16x16x32_bf16 v[76:79], v[44:47], a[228:231], v[76:79]
  v_mfma_f32_16x16x32_bf16 v[84:87], v[44:47], a[232:235], v[84:87]
  v_mfma_f32_16x16x32_bf16 v[92:95], v[44:47], a[236:239], v[92:95]
  s_waitcnt lgkmcnt(5)
  v_mfma_f32_16x16x32_bf16 v[64:67], v[48:51], a[240:243], v[64:67]
  s_sub_u32 s23, s23, 1
  ds_read_b128 v[40:43], v12 offset:32768
  v_mfma_f32_16x16x32_bf16 v[72:75], v[48:51], a[244:247], v[72:75]
  v_mfma_f32_16x16x32_bf16 v[80:83], v[48:51], a[248:251], v[80:83]
  v_mfma_f32_16x16x32_bf16 v[88:91], v[48:51], a[252:255], v[88:91]
  s_waitcnt lgkmcnt(5)
  v_mfma_f32_16x16x32_bf16 v[68:71], v[52:55], a[240:243], v[68:71]
  s_cmp_eq_u32 s23, 0
  ds_read_b128 v[44:47], v13 offset:32768
  v_mfma_f32_16x16x32_bf16 v[76:79], v[52:55], a[244:247], v[76:79]
  v_mfma_f32_16x16x32_bf16 v[84:87], v[52:55], a[248:251], v[84:87]
  v_mfma_f32_16x16x32_bf16 v[92:95], v[52:55], a[252:255], v[92:95]
  s_cbranch_scc1 G_done0_182
  s_waitcnt lgkmcnt(5)
  v_mfma_f32_16x16x32_bf16 v[96:99], v[24:27], a[0:3], 0
  s_add_u32 m0, s25, 0
  ds_read_b128 v[48:51], v14 offset:32768
  v_mfma_f32_16x16x32_bf16 v[104:107], v[24:27], a[4:7], 0
  v_mfma_f32_16x16x32_bf16 v[112:115], v[24:27], a[8:11], 0
  buffer_load_dwordx4 v16, s[12:15], s19 offen lds
  v_mfma_f32_16x16x32_bf16 v[120:123], v[24:27], a[12:15], 0
  s_waitcnt lgkmcnt(5)
  v_mfma_f32_16x16x32_bf16 v[100:103], v[28:31], a[0:3], 0
  ds_read_b128 v[52:55], v15 offset:32768
  v_mfma_f32_16x16x32_bf16 v[108:111], v[28:31], a[4:7], 0
  v_cvt_pk_bf16_f32 v128, v64, v65
  v_cvt_pk_bf16_f32 v129, v66, v67
  v_mfma_f32_16x16x32_bf16 v[116:119], v[28:31], a[8:11], 0
  v_mfma_f32_16x16x32_bf16 v[124:127], v[28:31], a[12:15], 0
  s_waitcnt lgkmcnt(5)
  v_cvt_pk_bf16_f32 v130, v68, v69
  v_cvt_pk_bf16_f32 v131, v70, v71
  v_mfma_f32_16x16x32_bf16 v[96:99], v[32:35], a[16:19], v[96:99]
  s_add_u32 m0, s25, 1024
  ds_read_b128 v[24:27], v8 offset:40960
  v_mfma_f32_16x16x32_bf16 v[104:107], v[32:35], a[20:23], v[104:107]
  v_mfma_f32_16x16x32_bf16 v[112:115], v[32:35], a[24:27], v[112:115]
  buffer_load_dwordx4 v17, s[12:15], s19 offen lds
  v_mfma_f32_16x16x32_bf16 v[120:123], v[32:35], a[28:31], v[120:123]
  s_waitcnt lgkmcnt(5)
  v_mfma_f32_16x16x32_bf16 v[100:103], v[36:39], a[16:19], v[100:103]
  ds_read_b128 v[28:31], v9 offset:40960
  v_mfma_f32_16x16x32_bf16 v[108:111], v[36:39], a[20:23], v[108:111]
  v_mfma_f32_16x16x32_bf16 v[116:119], v[36:39], a[24:27], v[116:119]
  v_mfma_f32_16x16x32_bf16 v[124:127], v[36:39], a[28:31], v[124:127]
  s_waitcnt lgkmcnt(5)
  v_mfma_f32_16x16x32_bf16 v[96:99], v[40:43], a[32:35], v[96:99]
  s_add_u32 m0, s25, 2048
  ds_read_b128 v[32:35], v10 offset:40960
  v_mfma_f32_16x16x32_bf16 v[104:107], v[40:43], a[36:39], v[104:107]
  v_cvt_pk_bf16_f32 v132, v72, v73
  v_cvt_pk_bf16_f32 v133, v74, v75
  v_mfma_f32_16x16x32_bf16 v[112:115], v[40:43], a[40:43], v[112:115]
  buffer_load_dwordx4 v18, s[12:15], s19 offen lds
  v_mfma_f32_16x16x32_bf16 v[120:123], v[40:43], a[44:47], v[120:123]
  s_waitcnt lgkmcnt(5)
  v_cvt_pk_bf16_f32 v134, v76, v77
  v_cvt_pk_bf16_f32 v135, v78, v79
  v_mfma_f32_16x16x32_bf16 v[100:103], v[44:47], a[32:35], v[100:103]
  ds_read_b128 v[36:39], v11 offset:40960
  v_mfma_f32_16x16x32_bf16 v[108:111], v[44:47], a[36:39], v[108:111]
  v_mfma_f32_16x16x32_bf16 v[116:119], v[44:47], a[40:43], v[116:119]
  v_mfma_f32_16x16x32_bf16 v[124:127], v[44:47], a[44:47], v[124:127]
  s_waitcnt lgkmcnt(5)
  v_mfma_f32_16x16x32_bf16 v[96:99], v[48:51], a[48:51], v[96:99]
  s_add_u32 m0, s25, 3072
  ds_read_b128 v[40:43], v12 offset:40960
  v_mfma_f32_16x16x32_bf16 v[104:107], v[48:51], a[52:55], v[104:107]
  v_mfma_f32_16x16x32_bf16 v[112:115], v[48:51], a[56:59], v[112:115]
  buffer_load_dwordx4 v19, s[12:15], s19 offen lds
  v_mfma_f32_16x16x32_bf16 v[120:123], v[48:51], a[60:63], v[120:123]
  s_waitcnt lgkmcnt(5)
  v_mfma_f32_16x16x32_bf16 v[100:103], v[52:55], a[48:51], v[100:103]
  ds_read_b128 v[44:47], v13 offset:40960
  v_mfma_f32_16x16x32_bf16 v[108:111], v[52:55], a[52:55], v[108:111]
  v_cvt_pk_bf16_f32 v136, v80, v81
  v_cvt_pk_bf16_f32 v137, v82, v83
  v_mfma_f32_16x16x32_bf16 v[116:119], v[52:55], a[56:59], v[116:119]
  v_mfma_f32_16x16x32_bf16 v[124:127], v[52:55], a[60:63], v[124:127]
  s_waitcnt lgkmcnt(5)
  v_cvt_pk_bf16_f32 v138, v84, v85
  v_cvt_pk_bf16_f32 v139, v86, v87
  v_mfma_f32_16x16x32_bf16 v[96:99], v[24:27], a[64:67], v[96:99]
  s_add_u32 m0, s25, 4096
  ds_read_b128 v[48:51], v14 offset:40960
  v_mfma_f32_16x16x32_bf16 v[104:107], v[24:27], a[68:71], v[104:107]
  v_mfma_f32_16x16x32_bf16 v[112:115], v[24:27], a[72:75], v[112:115]
  buffer_load_dwordx4 v20, s[12:15], s19 offen lds
  v_mfma_f32_16x16x32_bf16 v[120:123], v[24:27], a[76:79], v[120:123]
  s_waitcnt lgkmcnt(5)
  v_mfma_f32_16x16x32_bf16 v[100:103], v[28:31], a[64:67], v[100:103]
  ds_read_b128 v[52:55], v15 offset:40960
  v_mfma_f32_16x16x32_bf16 v[108:111], v[28:31], a[68:71], v[108:111]
  v_mfma_f32_16x16x32_bf16 v[116:119], v[28:31], a[72:75], v[116:119]
  v_mfma_f32_16x16x32_bf16 v[124:127], v[28:31], a[76:79], v[124:127]
  s_waitcnt lgkmcnt(5)
  v_mfma_f32_16x16x32_bf16 v[96:99], v[32:35], a[80:83], v[96:99]
  s_add_u32 m0, s25, 5120
  ds_read_b128 v[24:27], v8 offset:49152
  v_mfma_f32_16x16x32_bf16 v[104:107], v[32:35], a[84:87], v[104:107]
  v_cvt_pk_bf16_f32 v140, v88, v89
  v_cvt_pk_bf16_f32 v141, v90, v91
  v_mfma_f32_16x16x32_bf16 v[112:115], v[32:35], a[88:91], v[112:115]
  buffer_load_dwordx4 v21, s[12:15], s19 offen lds
  v_mfma_f32_16x16x32_bf16 v[120:123], v[32:35], a[92:95], v[120:123]
  s_waitcnt lgkmcnt(5)
  v_cvt_pk_bf16_f32 v142, v92, v93
  v_cvt_pk_bf16_f32 v143, v94, v95
  v_mfma_f32_16x16x32_bf16 v[100:103], v[36:39], a[80:83], v[100:103]
  ds_read_b128 v[28:31], v9 offset:49152
  v_mfma_f32_16x16x32_bf16 v[108:111], v[36:39], a[84:87], v[108:111]
  v_mfma_f32_16x16x32_bf16 v[116:119], v[36:39], a[88:91], v[116:119]
  v_mfma_f32_16x16x32_bf16 v[124:127], v[36:39], a[92:95], v[124:127]
  s_waitcnt lgkmcnt(5)
  v_mfma_f32_16x16x32_bf16 v[96:99], v[40:43], a[96:99], v[96:99]
  s_add_u32 m0, s25, 6144
  ds_read_b128 v[32:35], v10 offset:49152
  v_mfma_f32_16x16x32_bf16 v[104:107], v[40:43], a[100:103], v[104:107]
  v_mfma_f32_16x16x32_bf16 v[112:115], v[40:43], a[104:107], v[112:115]
  buffer_load_dwordx4 v22, s[12:15], s19 offen lds
  v_mfma_f32_16x16x32_bf16 v[120:123], v[40:43], a[108:111], v[120:123]
  s_waitcnt lgkmcnt(5)
  v_mfma_f32_16x16x32_bf16 v[100:103], v[44:47], a[96:99], v[100:103]
  ds_read_b128 v[36:39], v11 offset:49152
  v_mfma_f32_16x16x32_bf16 v[108:111], v[44:47], a[100:103], v[108:111]
  v_mfma_f32_16x16x32_bf16 v[116:119], v[44:47], a[104:107], v[116:119]
  v_mfma_f32_16x16x32_bf16 v[124:127], v[44:47], a[108:111], v[124:127]
  s_waitcnt lgkmcnt(5)
  v_mfma_f32_16x16x32_bf16 v[96:99], v[48:51], a[112:115], v[96:99]
  s_add_u32 m0, s25, 7168
  ds_read_b128 v[40:43], v12 offset:49152
  v_mfma_f32_16x16x32_bf16 v[104:107], v[48:51], a[116:119], v[104:107]
  v_mfma_f32_16x16x32_bf16 v[112:115], v[48:51], a[120:123], v[112:115]
  buffer_load_dwordx4 v23, s[12:15], s19 offen lds
  v_mfma_f32_16x16x32_bf16 v[120:123], v[48:51], a[124:127], v[120:123]
  s_waitcnt lgkmcnt(5)
  v_mfma_f32_16x16x32_bf16 v[100:103], v[52:55], a[112:115], v[100:103]
  s_cmp_gt_u32 s23, 3
  ds_read_b128 v[44:47], v13 offset:49152
  v_mfma_f32_16x16x32_bf16 v[108:111], v[52:55], a[116:119], v[108:111]
  v_mfma_f32_16x16x32_bf16 v[116:119], v[52:55], a[120:123], v[116:119]
  s_cselect_b32 s26, s20, 0
  v_mfma_f32_16x16x32_bf16 v[124:127], v[52:55], a[124:127], v[124:127]
  s_waitcnt lgkmcnt(5)
  v_mfma_f32_16x16x32_bf16 v[96:99], v[24:27], a[128:131], v[96:99]
  s_add_u32 s19, s19, s26
  ds_read_b128 v[48:51], v14 offset:49152
  v_mfma_f32_16x16x32_bf16 v[104:107], v[24:27], a[132:135], v[104:107]
  v_mfma_f32_16x16x32_bf16 v[112:115], v[24:27], a[136:139], v[112:115]
  s_add_u32 s25, s25, 32768
  v_mfma_f32_16x16x32_bf16 v[120:123], v[24:27], a[140:143], v[120:123]
  s_waitcnt lgkmcnt(5)
  v_mfma_f32_16x16x32_bf16 v[100:103], v[28:31], a[128:131], v[100:103]
  s_and_b32 s25, s25, 0x1ffff
  ds_read_b128 v[52:55], v15 offset:49152
  v_mfma_f32_16x16x32_bf16 v[108:111], v[28:31], a[132:135], v[108:111]
  v_mfma_f32_16x16x32_bf16 v[116:119], v[28:31], a[136:139], v[116:119]
  buffer_store_dwordx4 v[128:131], v7, s[4:7], s21 offen offset:0 sc1
  v_mfma_f32_16x16x32_bf16 v[124:127], v[28:31], a[140:143], v[124:127]
  s_waitcnt lgkmcnt(5)
  v_mfma_f32_16x16x32_bf16 v[96:99], v[32:35], a[144:147], v[96:99]
  ds_read_b128 v[24:27], v8 offset:57344
  v_mfma_f32_16x16x32_bf16 v[104:107], v[32:35], a[148:151], v[104:107]
  v_mfma_f32_16x16x32_bf16 v[112:115], v[32:35], a[152:155], v[112:115]
  v_mfma_f32_16x16x32_bf16 v[120:123], v[32:35], a[156:159], v[120:123]
  s_waitcnt lgkmcnt(5)
  v_xor_b32 v8, 0x10000, v8
  v_mfma_f32_16x16x32_bf16 v[100:103], v[36:39], a[144:147], v[100:103]
  ds_read_b128 v[28:31], v9 offset:57344
  v_mfma_f32_16x16x32_bf16 v[108:111], v[36:39], a[148:151], v[108:111]
  v_mfma_f32_16x16x32_bf16 v[116:119], v[36:39], a[152:155], v[116:119]
  buffer_store_dwordx4 v[132:135], v7, s[4:7], s21 offen offset:256 sc1
  v_mfma_f32_16x16x32_bf16 v[124:127], v[36:39], a[156:159], v[124:127]
  s_waitcnt lgkmcnt(5)
  v_xor_b32 v9, 0x10000, v9
  v_mfma_f32_16x16x32_bf16 v[96:99], v[40:43], a[160:163], v[96:99]
  ds_read_b128 v[32:35], v10 offset:57344
  v_mfma_f32_16x16x32_bf16 v[104:107], v[40:43], a[164:167], v[104:107]
  v_mfma_f32_16x16x32_bf16 v[112:115], v[40:43], a[168:171], v[112:115]
  v_mfma_f32_16x16x32_bf16 v[120:123], v[40:43], a[172:175], v[120:123]
  s_waitcnt lgkmcnt(5)
  v_xor_b32 v10, 0x10000, v10
  v_mfma_f32_16x16x32_bf16 v[100:103], v[44:47], a[160:163], v[100:103]
  ds_read_b128 v[36:39], v11 offset:57344
  v_mfma_f32_16x16x32_bf16 v[108:111], v[44:47], a[164:167], v[108:111]
  v_mfma_f32_16x16x32_bf16 v[116:119], v[44:47], a[168:171], v[116:119]
  buffer_store_dwordx4 v[136:139], v7, s[4:7], s21 offen offset:2048 sc1
  v_mfma_f32_16x16x32_bf16 v[124:127], v[44:47], a[172:175], v[124:127]
  s_waitcnt lgkmcnt(5)
  v_xor_b32 v11, 0x10000, v11
  v_mfma_f32_16x16x32_bf16 v[96:99], v[48:51], a[176:179], v[96:99]
  ds_read_b128 v[40:43], v12 offset:57344
  v_mfma_f32_16x16x32_bf16 v[104:107], v[48:51], a[180:183], v[104:107]
  v_mfma_f32_16x16x32_bf16 v[112:115], v[48:51], a[184:187], v[112:115]
  v_mfma_f32_16x16x32_bf16 v[120:123], v[48:51], a[188:191], v[120:123]
  s_waitcnt lgkmcnt(5)
  v_xor_b32 v12, 0x10000, v12
  v_mfma_f32_16x16x32_bf16 v[100:103], v[52:55], a[176:179], v[100:103]
  ds_read_b128 v[44:47], v13 offset:57344
  v_mfma_f32_16x16x32_bf16 v[108:111], v[52:55], a[180:183], v[108:111]
  v_mfma_f32_16x16x32_bf16 v[116:119], v[52:55], a[184:187], v[116:119]
  buffer_store_dwordx4 v[140:143], v7, s[4:7], s21 offen offset:2304 sc1
  v_mfma_f32_16x16x32_bf16 v[124:127], v[52:55], a[188:191], v[124:127]
  s_waitcnt lgkmcnt(5)
  v_xor_b32 v13, 0x10000, v13
  v_mfma_f32_16x16x32_bf16 v[96:99], v[24:27], a[192:195], v[96:99]
  s_mov_b32 s21, s27
  ds_read_b128 v[48:51], v14 offset:57344
  v_mfma_f32_16x16x32_bf16 v[104:107], v[24:27], a[196:199], v[104:107]
  v_mov_b32 v7, v56
  v_mfma_f32_16x16x32_bf16 v[112:115], v[24:27], a[200:203], v[112:115]
  v_mfma_f32_16x16x32_bf16 v[120:123], v[24:27], a[204:207], v[120:123]
  s_waitcnt lgkmcnt(5)
  v_xor_b32 v14, 0x10000, v14
  v_mfma_f32_16x16x32_bf16 v[100:103], v[28:31], a[192:195], v[100:103]
  s_add_u32 s27, s27, s22
  ds_read_b128 v[52:55], v15 offset:57344
  v_mfma_f32_16x16x32_bf16 v[108:111], v[28:31], a[196:199], v[108:111]
  v_mfma_f32_16x16x32_bf16 v[116:119], v[28:31], a[200:203], v[116:119]
  s_waitcnt vmcnt(13)
  s_barrier
  v_mfma_f32_16x16x32_bf16 v[124:127], v[28:31], a[204:207], v[124:127]
  s_waitcnt lgkmcnt(5)
  v_xor_b32 v15, 0x10000, v15
  v_mfma_f32_16x16x32_bf16 v[96:99], v[32:35], a[208:211], v[96:99]
  ds_read_b128 v[24:27], v8 offset:0
  v_mfma_f32_16x16x32_bf16 v[104:107], v[32:35], a[212:215], v[104:107]
  v_mfma_f32_16x16x32_bf16 v[112:115], v[32:35], a[216:219], v[112:115]
  v_mfma_f32_16x16x32_bf16 v[120:123], v[32:35], a[220:223], v[120:123]
  s_waitcnt lgkmcnt(5)
  v_mfma_f32_16x16x32_bf16 v[100:103], v[36:39], a[208:211], v[100:103]
  s_add_u32 s29, s29, 1
  ds_read_b128 v[28:31], v9 offset:0
  v_mfma_f32_16x16x32_bf16 v[108:111], v[36:39], a[212:215], v[108:111]
  v_mfma_f32_16x16x32_bf16 v[116:119], v[36:39], a[216:219], v[116:119]
  s_max_i32 s30, s29, 0
  v_mfma_f32_16x16x32_bf16 v[124:127], v[36:39], a[220:223], v[124:127]
  s_waitcnt lgkmcnt(5)
  v_mov_b32 v144, s30
  v_mfma_f32_16x16x32_bf16 v[96:99], v[40:43], a[224:227], v[96:99]
  ds_read_b128 v[32:35], v10 offset:0
  v_mfma_f32_16x16x32_bf16 v[104:107], v[40:43], a[228:231], v[104:107]
  v_mfma_f32_16x16x32_bf16 v[112:115], v[40:43], a[232:235], v[112:115]
  buffer_store_dword v144, v145, s[4:7], s31 offen sc1
  v_mfma_f32_16x16x32_bf16 v[120:123], v[40:43], a[236:239], v[120:123]
  s_waitcnt lgkmcnt(5)
  v_mfma_f32_16x16x32_bf16 v[100:103], v[44:47], a[224:227], v[100:103]
  ds_read_b128 v[36:39], v11 offset:0
  v_mfma_f32_16x16x32_bf16 v[108:111], v[44:47], a[228:231], v[108:111]
  v_mfma_f32_16x16x32_bf16 v[116:119], v[44:47], a[232:235], v[116:119]
  v_mfma_f32_16x16x32_bf16 v[124:127], v[44:47], a[236:239], v[124:127]
  s_waitcnt lgkmcnt(5)
  v_mfma_f32_16x16x32_bf16 v[96:99], v[48:51], a[240:243], v[96:99]
  s_sub_u32 s23, s23, 1
  ds_read_b128 v[40:43], v12 offset:0
  v_mfma_f32_16x16x32_bf16 v[104:107], v[48:51], a[244:247], v[104:107]
  v_mfma_f32_16x16x32_bf16 v[112:115], v[48:51], a[248:251], v[112:115]
  v_mfma_f32_16x16x32_bf16 v[120:123], v[48:51], a[252:255], v[120:123]
  s_waitcnt lgkmcnt(5)
  v_mfma_f32_16x16x32_bf16 v[100:103], v[52:55], a[240:243], v[100:103]
  s_cmp_eq_u32 s23, 0
  ds_read_b128 v[44:47], v13 offset:0
  v_mfma_f32_16x16x32_bf16 v[108:111], v[52:55], a[244:247], v[108:111]
  v_mfma_f32_16x16x32_bf16 v[116:119], v[52:55], a[248:251], v[116:119]
  v_mfma_f32_16x16x32_bf16 v[124:127], v[52:55], a[252:255], v[124:127]
  s_cbranch_scc1 G_done1_183
  s_branch G_top_181
G_done0_182:
  s_nop 7
  s_nop 3
  v_cvt_pk_bf16_f32 v128, v64, v65
  v_cvt_pk_bf16_f32 v129, v66, v67
  v_cvt_pk_bf16_f32 v130, v68, v69
  v_cvt_pk_bf16_f32 v131, v70, v71
  buffer_store_dwordx4 v[128:131], v7, s[4:7], s21 offen offset:0 sc1
  v_cvt_pk_bf16_f32 v132, v72, v73
  v_cvt_pk_bf16_f32 v133, v74, v75
  v_cvt_pk_bf16_f32 v134, v76, v77
  v_cvt_pk_bf16_f32 v135, v78, v79
  buffer_store_dwordx4 v[132:135], v7, s[4:7], s21 offen offset:256 sc1
  v_cvt_pk_bf16_f32 v136, v80, v81
  v_cvt_pk_bf16_f32 v137, v82, v83
  v_cvt_pk_bf16_f32 v138, v84, v85
  v_cvt_pk_bf16_f32 v139, v86, v87
  buffer_store_dwordx4 v[136:139], v7, s[4:7], s21 offen offset:2048 sc1
  v_cvt_pk_bf16_f32 v140, v88, v89
  v_cvt_pk_bf16_f32 v141, v90, v91
  v_cvt_pk_bf16_f32 v142, v92, v93
  v_cvt_pk_bf16_f32 v143, v94, v95
  buffer_store_dwordx4 v[140:143], v7, s[4:7], s21 offen offset:2304 sc1
  s_branch G_fin_184
G_done1_183:
  s_nop 7
  s_nop 3
  v_cvt_pk_bf16_f32 v128, v96, v97
  v_cvt_pk_bf16_f32 v129, v98, v99
  v_cvt_pk_bf16_f32 v130, v100, v101
  v_cvt_pk_bf16_f32 v131, v102, v103
  buffer_store_dwordx4 v[128:131], v7, s[4:7], s21 offen offset:0 sc1
  v_cvt_pk_bf16_f32 v132, v104, v105
  v_cvt_pk_bf16_f32 v133, v106, v107
  v_cvt_pk_bf16_f32 v134, v108, v109
  v_cvt_pk_bf16_f32 v135, v110, v111
  buffer_store_dwordx4 v[132:135], v7, s[4:7], s21 offen offset:256 sc1
  v_cvt_pk_bf16_f32 v136, v112, v113
  v_cvt_pk_bf16_f32 v137, v114, v115
  v_cvt_pk_bf16_f32 v138, v116, v117
  v_cvt_pk_bf16_f32 v139, v118, v119
  buffer_store_dwordx4 v[136:139], v7, s[4:7], s21 offen offset:2048 sc1
  v_cvt_pk_bf16_f32 v140, v120, v121
  v_cvt_pk_bf16_f32 v141, v122, v123
  v_cvt_pk_bf16_f32 v142, v124, v125
  v_cvt_pk_bf16_f32 v143, v126, v127
  buffer_store_dwordx4 v[140:143], v7, s[4:7], s21 offen offset:2304 sc1
G_fin_184:
  s_waitcnt vmcnt(0) lgkmcnt(0)
  s_barrier
  s_add_u32 s30, s29, 2
  v_mov_b32 v144, s30
  v_min_u32 v145, 1, v0
  v_lshlrev_b32 v145, 30, v145
  buffer_store_dword v144, v145, s[4:7], s31 offen sc1
P_end_171:
  s_mov_b32 s71, 0
  s_branch M_sg_186
M_sw_185:
  s_sleep 8
  s_add_u32 s71, s71, 1
  s_cmp_gt_u32 s71, 262144
  s_cbranch_scc1 M_exit
M_sg_186:
  s_mov_b32 s79, 0
  s_atomic_or s79, s[74:75], 128 glc
  s_waitcnt lgkmcnt(0)
  s_cmp_lt_u32 s79, 256
  s_cbranch_scc1 M_sw_185
  s_cmp_eq_u32 s65, 6
  s_cbranch_scc1 M_follow
  s_mov_b32 s68, 0
  s_mov_b32 s36, -1
  s_mov_b32 s69, s53
  s_mov_b32 s70, s54
  s_load_dwordx2 s[8:9], s[0:1], 40
  s_mul_i32 s76, s64, 6
  s_add_u32 s76, s76, s65
  s_mul_i32 s76, s76, 21888
  v_min_u32 v200, 170, v0
  v_mul_u32_u24 v200, 128, v200
  v_add_u32 v200, s76, v200
  s_waitcnt lgkmcnt(0)
  s_and_b32 s9, s9, 0xffff
  s_mov_b32 s10, 4194304
  s_mov_b32 s11, 0x20000
M_att:
  s_mov_b32 s24, 0xf149f2ca
  s_mov_b32 s29, 0
  v_mov_b32 v6, 0
  v_mov_b32 v7, 0
  s_lshl_b32 s26, s16, 11
  v_add_u32 v3, s26, v2
  v_and_b32 v5, 31, v1
  v_lshrrev_b32 v12, 5, v1
  v_lshlrev_b32 v12, 2, v12
  v_sub_u32 v5, v5, v12
  s_lshl_b32 s26, s64, 19
  s_add_u32 s19, s26, 16777216
  s_add_u32 s20, s26, 33554432
  s_lshl_b32 s27, s69, 2
  s_add_u32 s27, s27, s16
  s_lshl_b32 s27, s27, 14
  s_add_u32 s25, s26, s27
  s_bfe_u32 s78, s70, 0x80000
  s_add_u32 s76, s67, 512
  s_mov_b32 s71, 0
  s_branch M_sg_188
M_sw_187:
  s_sleep 8
  s_add_u32 s71, s71, 1
  s_cmp_gt_u32 s71, 262144
  s_cbranch_scc1 M_exit
M_sg_188:
  s_mov_b32 s79, 0
  s_atomic_or s79, s[72:73], s76 glc
  s_waitcnt lgkmcnt(0)
  s_cmp_lt_u32 s79, s78
  s_cbranch_scc1 M_sw_187
  s_bfe_u32 s78, s70, 0x80008
  s_add_u32 s76, s67, 640
  s_mov_b32 s71, 0
  s_branch M_sg_190
M_sw_189:
  s_sleep 8
  s_add_u32 s71, s71, 1
  s_cmp_gt_u32 s71, 262144
  s_cbranch_scc1 M_exit
M_sg_190:
  s_mov_b32 s79, 0
  s_atomic_or s79, s[72:73], s76 glc
  s_waitcnt lgkmcnt(0)
  s_cmp_lt_u32 s79, s78
  s_cbranch_scc1 M_sw_189
  s_lshl_b32 s27, s69, 16
  s_add_u32 s27, s27, 16384
  s_add_u32 s17, s19, s27
M_kv_191:
  s_cmp_ge_u32 s17, s36
  s_cbranch_scc1 M_kvok_192
  s_mov_b32 s76, 0
  s_mov_b32 s78, 23
  s_mov_b32 s77, 335872
  s_cmp_eq_u32 s68, 1
  s_cmov_b32 s76, 128
  s_cmov_b32 s78, 27
  s_cmov_b32 s77, 114688
  s_cmp_eq_u32 s68, 2
  s_cmov_b32 s76, 768
  s_cmov_b32 s78, 14
  s_cmov_b32 s77, 0
  s_add_u32 s76, s76, s67
  s_mov_b32 s71, 0
  s_branch M_sg_194
M_sw_193:
  s_sleep 8
  s_add_u32 s71, s71, 1
  s_cmp_gt_u32 s71, 262144
  s_cbranch_scc1 M_exit
M_sg_194:
  s_mov_b32 s79, 0
  s_atomic_or s79, s[72:73], s76 glc
  s_waitcnt lgkmcnt(0)
  s_cmp_lt_u32 s79, s78
  s_cbranch_scc1 M_sw_193
  s_add_u32 s36, s77, s19
  s_add_u32 s68, s68, 1
  s_branch M_kv_191
M_kvok_192:
  s_add_u32 s28, s25, 0
  buffer_load_dwordx4 a[128:131], v2, s[4:7], s28 offen offset:0 sc1
  buffer_load_dwordx4 a[132:135], v2, s[4:7], s28 offen offset:1024 sc1
  buffer_load_dwordx4 a[136:139], v2, s[4:7], s28 offen offset:2048 sc1
  buffer_load_dwordx4 a[140:143], v2, s[4:7], s28 offen offset:3072 sc1
  s_add_u32 s28, s25, 4096
  buffer_load_dwordx4 a[144:147], v2, s[4:7], s28 offen offset:0 sc1
  buffer_load_dwordx4 a[148:151], v2, s[4:7], s28 offen offset:1024 sc1
  buffer_load_dwordx4 a[152:155], v2, s[4:7], s28 offen offset:2048 sc1
  buffer_load_dwordx4 a[156:159], v2, s[4:7], s28 offen offset:3072 sc1
  s_add_u32 s28, s25, 8192
  buffer_load_dwordx4 a[160:163], v2, s[4:7], s28 offen offset:0 sc1
  buffer_load_dwordx4 a[164:167], v2, s[4:7], s28 offen offset:1024 sc1
  buffer_load_dwordx4 a[168:171], v2, s[4:7], s28 offen offset:2048 sc1
  buffer_load_dwordx4 a[172:175], v2, s[4:7], s28 offen offset:3072 sc1
  s_add_u32 s28, s25, 12288
  buffer_load_dwordx4 a[176:179], v2, s[4:7], s28 offen offset:0 sc1
  buffer_load_dwordx4 a[180:183], v2, s[4:7], s28 offen offset:1024 sc1
  buffer_load_dwordx4 a[184:187], v2, s[4:7], s28 offen offset:2048 sc1
  buffer_load_dwordx4 a[188:191], v2, s[4:7], s28 offen offset:3072 sc1
A_again_195:
  s_lshl_b32 s27, s69, 16
  s_add_u32 s27, s27, 57344
  s_add_u32 s17, s19, s27
  s_add_u32 s18, s20, s27
  s_lshl_b32 s21, s16, 11
  s_mov_b32 m0, s21
  s_nop 0
  buffer_load_dwordx4 v3, s[4:7], s18 offen offset:0 sc1 lds
  buffer_load_dwordx4 v3, s[4:7], s18 offen offset:1024 sc1 lds
  s_add_u32 m0, s21, 8192
  s_nop 0
  buffer_load_dwordx4 v3, s[4:7], s17 offen offset:0 sc1 lds
  buffer_load_dwordx4 v3, s[4:7], s17 offen offset:1024 sc1 lds
  s_add_u32 s18, s18, 8192
  s_sub_u32 s18, s18, 8192
  s_max_i32 s18, s18, s20
  s_sub_u32 s17, s17, 8192
  s_max_i32 s17, s17, s19
  s_add_u32 s21, s21, 16384
  s_and_b32 s21, s21, 131071
  s_mov_b32 m0, s21
  s_nop 0
  buffer_load_dwordx4 v3, s[4:7], s18 offen offset:0 sc1 lds
  buffer_load_dwordx4 v3, s[4:7], s18 offen offset:1024 sc1 lds
  s_add_u32 m0, s21, 8192
  s_nop 0
  buffer_load_dwordx4 v3, s[4:7], s17 offen offset:0 sc1 lds
  buffer_load_dwordx4 v3, s[4:7], s17 offen offset:1024 sc1 lds
  s_sub_u32 s18, s18, 8192
  s_max_i32 s18, s18, s20
  s_sub_u32 s17, s17, 8192
  s_max_i32 s17, s17, s19
  s_add_u32 s21, s21, 16384
  s_and_b32 s21, s21, 131071
  s_mov_b32 m0, s21
  s_nop 0
  buffer_load_dwordx4 v3, s[4:7], s18 offen offset:0 sc1 lds
  buffer_load_dwordx4 v3, s[4:7], s18 offen offset:1024 sc1 lds
  s_add_u32 m0, s21, 8192
  s_nop 0
  buffer_load_dwordx4 v3, s[4:7], s17 offen offset:0 sc1 lds
  buffer_load_dwordx4 v3, s[4:7], s17 offen offset:1024 sc1 lds
  s_sub_u32 s18, s18, 8192
  s_max_i32 s18, s18, s20
  s_sub_u32 s17, s17, 8192
  s_max_i32 s17, s17, s19
  s_add_u32 s21, s21, 16384
  s_and_b32 s21, s21, 131071
  s_mov_b32 m0, s21
  s_nop 0
  buffer_load_dwordx4 v3, s[4:7], s18 offen offset:0 sc1 lds
  buffer_load_dwordx4 v3, s[4:7], s18 offen offset:1024 sc1 lds
  s_add_u32 m0, s21, 8192
  s_nop 0
  buffer_load_dwordx4 v3, s[4:7], s17 offen offset:0 sc1 lds
  buffer_load_dwordx4 v3, s[4:7], s17 offen offset:1024 sc1 lds
  s_sub_u32 s18, s18, 8192
  s_max_i32 s18, s18, s20
  s_sub_u32 s17, s17, 8192
  s_max_i32 s17, s17, s19
  s_add_u32 s21, s21, 16384
  s_and_b32 s21, s21, 131071
  s_mov_b32 m0, s21
  s_nop 0
  buffer_load_dwordx4 v3, s[4:7], s18 offen offset:0 sc1 lds
  buffer_load_dwordx4 v3, s[4:7], s18 offen offset:1024 sc1 lds
  s_add_u32 m0, s21, 8192
  s_nop 0
  buffer_load_dwordx4 v3, s[4:7], s17 offen offset:0 sc1 lds
  buffer_load_dwordx4 v3, s[4:7], s17 offen offset:1024 sc1 lds
  s_sub_u32 s18, s18, 8192
  s_max_i32 s18, s18, s20
  s_sub_u32 s17, s17, 8192
  s_max_i32 s17, s17, s19
  s_add_u32 s21, s21, 16384
  s_and_b32 s21, s21, 131071
  s_mov_b32 m0, s21
  s_nop 0
  buffer_load_dwordx4 v3, s[4:7], s18 offen offset:0 sc1 lds
  buffer_load_dwordx4 v3, s[4:7], s18 offen offset:1024 sc1 lds
  s_add_u32 m0, s21, 8192
  s_nop 0
  buffer_load_dwordx4 v3, s[4:7], s17 offen offset:0 sc1 lds
  buffer_load_dwordx4 v3, s[4:7], s17 offen offset:1024 sc1 lds
  v_accvgpr_write_b32 a0, 0
  v_accvgpr_write_b32 a1, 0
  v_accvgpr_write_b32 a2, 0
  v_accvgpr_write_b32 a3, 0
  v_accvgpr_write_b32 a4, 0
  v_accvgpr_write_b32 a5, 0
  v_accvgpr_write_b32 a6, 0
  v_accvgpr_write_b32 a7, 0
  v_accvgpr_write_b32 a8, 0
  v_accvgpr_write_b32 a9, 0
  v_accvgpr_write_b32 a10, 0
  v_accvgpr_write_b32 a11, 0
  v_accvgpr_write_b32 a12, 0
  v_accvgpr_write_b32 a13, 0
  v_accvgpr_write_b32 a14, 0
  v_accvgpr_write_b32 a15, 0
  v_accvgpr_write_b32 a16, 0
  v_accvgpr_write_b32 a17, 0
  v_accvgpr_write_b32 a18, 0
  v_accvgpr_write_b32 a19, 0
  v_accvgpr_write_b32 a20, 0
  v_accvgpr_write_b32 a21, 0
  v_accvgpr_write_b32 a22, 0
  v_accvgpr_write_b32 a23, 0
  v_accvgpr_write_b32 a24, 0
  v_accvgpr_write_b32 a25, 0
  v_accvgpr_write_b32 a26, 0
  v_accvgpr_write_b32 a27, 0
  v_accvgpr_write_b32 a28, 0
  v_accvgpr_write_b32 a29, 0
  v_accvgpr_write_b32 a30, 0
  v_accvgpr_write_b32 a31, 0
  v_accvgpr_write_b32 a32, 0
  v_accvgpr_write_b32 a33, 0
  v_accvgpr_write_b32 a34, 0
  v_accvgpr_write_b32 a35, 0
  v_accvgpr_write_b32 a36, 0
  v_accvgpr_write_b32 a37, 0
  v_accvgpr_write_b32 a38, 0
  v_accvgpr_write_b32 a39, 0
  v_accvgpr_write_b32 a40, 0
  v_accvgpr_write_b32 a41, 0
  v_accvgpr_write_b32 a42, 0
  v_accvgpr_write_b32 a43, 0
  v_accvgpr_write_b32 a44, 0
  v_accvgpr_write_b32 a45, 0
  v_accvgpr_write_b32 a46, 0
  v_accvgpr_write_b32 a47, 0
  v_accvgpr_write_b32 a48, 0
  v_accvgpr_write_b32 a49, 0
  v_accvgpr_write_b32 a50, 0
  v_accvgpr_write_b32 a51, 0
  v_accvgpr_write_b32 a52, 0
  v_accvgpr_write_b32 a53, 0
  v_accvgpr_write_b32 a54, 0
  v_accvgpr_write_b32 a55, 0
  v_accvgpr_write_b32 a56, 0
  v_accvgpr_write_b32 a57, 0
  v_accvgpr_write_b32 a58, 0
  v_accvgpr_write_b32 a59, 0
  v_accvgpr_write_b32 a60, 0
  v_accvgpr_write_b32 a61, 0
  v_accvgpr_write_b32 a62, 0
  v_accvgpr_write_b32 a63, 0
  v_accvgpr_write_b32 a64, 0
  v_accvgpr_write_b32 a65, 0
  v_accvgpr_write_b32 a66, 0
  v_accvgpr_write_b32 a67, 0
  v_accvgpr_write_b32 a68, 0
  v_accvgpr_write_b32 a69, 0
  v_accvgpr_write_b32 a70, 0
  v_accvgpr_write_b32 a71, 0
  v_accvgpr_write_b32 a72, 0
  v_accvgpr_write_b32 a73, 0
  v_accvgpr_write_b32 a74, 0
  v_accvgpr_write_b32 a75, 0
  v_accvgpr_write_b32 a76, 0
  v_accvgpr_write_b32 a77, 0
  v_accvgpr_write_b32 a78, 0
  v_accvgpr_write_b32 a79, 0
  v_accvgpr_write_b32 a80, 0
  v_accvgpr_write_b32 a81, 0
  v_accvgpr_write_b32 a82, 0
  v_accvgpr_write_b32 a83, 0
  v_accvgpr_write_b32 a84, 0
  v_accvgpr_write_b32 a85, 0
  v_accvgpr_write_b32 a86, 0
  v_accvgpr_write_b32 a87, 0
  v_accvgpr_write_b32 a88, 0
  v_accvgpr_write_b32 a89, 0
  v_accvgpr_write_b32 a90, 0
  v_accvgpr_write_b32 a91, 0
  v_accvgpr_write_b32 a92, 0
  v_accvgpr_write_b32 a93, 0
  v_accvgpr_write_b32 a94, 0
  v_accvgpr_write_b32 a95, 0
  v_accvgpr_write_b32 a96, 0
  v_accvgpr_write_b32 a97, 0
  v_accvgpr_write_b32 a98, 0
  v_accvgpr_write_b32 a99, 0
  v_accvgpr_write_b32 a100, 0
  v_accvgpr_write_b32 a101, 0
  v_accvgpr_write_b32 a102, 0
  v_accvgpr_write_b32 a103, 0
  v_accvgpr_write_b32 a104, 0
  v_accvgpr_write_b32 a105, 0
  v_accvgpr_write_b32 a106, 0
  v_accvgpr_write_b32 a107, 0
  v_accvgpr_write_b32 a108, 0
  v_accvgpr_write_b32 a109, 0
  v_accvgpr_write_b32 a110, 0
  v_accvgpr_write_b32 a111, 0
  v_accvgpr_write_b32 a112, 0
  v_accvgpr_write_b32 a113, 0
  v_accvgpr_write_b32 a114, 0
  v_accvgpr_write_b32 a115, 0
  v_accvgpr_write_b32 a116, 0
  v_accvgpr_write_b32 a117, 0
  v_accvgpr_write_b32 a118, 0
  v_accvgpr_write_b32 a119, 0
  v_accvgpr_write_b32 a120, 0
  v_accvgpr_write_b32 a121, 0
  v_accvgpr_write_b32 a122, 0
  v_accvgpr_write_b32 a123, 0
  v_accvgpr_write_b32 a124, 0
  v_accvgpr_write_b32 a125, 0
  v_accvgpr_write_b32 a126, 0
  v_accvgpr_write_b32 a127, 0
  v_mov_b32 v8, 0
  v_mov_b32 v9, 0
  v_mov_b32 v10, 0
  v_mov_b32 v11, 0
  v_mov_b32 v52, 0
  v_mov_b32 v53, 0
  v_mov_b32 v54, s24
  v_mov_b32 v55, s24
  v_mov_b32 v56, s24
  v_mov_b32 v57, s24
  v_mov_b32 v58, s24
  v_mov_b32 v59, s24
  v_mov_b32 v60, s24
  v_mov_b32 v61, s24
  v_mov_b32 v62, s24
  v_mov_b32 v63, s24
  v_mov_b32 v104, 0
  v_mov_b32 v105, 0
  v_mov_b32 v4, v2
  v_mov_b32 v64, s24
  v_mov_b32 v65, s24
  v_mov_b32 v66, s24
  v_mov_b32 v67, s24
  v_mov_b32 v68, s24
  v_mov_b32 v69, s24
  v_mov_b32 v70, s24
  v_mov_b32 v71, s24
  v_mov_b32 v72, s24
  v_mov_b32 v73, s24
  v_mov_b32 v74, s24
  v_mov_b32 v75, s24
  v_mov_b32 v76, s24
  v_mov_b32 v77, s24
  v_mov_b32 v78, s24
  v_mov_b32 v79, s24
  v_mov_b32 v12, s24
  v_cmp_le_i32 s[40:41], 0, v5
  v_cmp_le_i32 s[42:43], 1, v5
  v_cmp_le_i32 s[44:45], 2, v5
  v_cmp_le_i32 s[46:47], 3, v5
  v_cndmask_b32 v80, v12, v7, s[40:41]
  v_cndmask_b32 v81, v12, v7, s[42:43]
  v_cndmask_b32 v82, v12, v7, s[44:45]
  v_cndmask_b32 v83, v12, v7, s[46:47]
  v_cmp_le_i32 s[40:41], 8, v5
  v_cmp_le_i32 s[42:43], 9, v5
  v_cmp_le_i32 s[44:45], 10, v5
  v_cmp_le_i32 s[46:47], 11, v5
  v_cndmask_b32 v84, v12, v7, s[40:41]
  v_cndmask_b32 v85, v12, v7, s[42:43]
  v_cndmask_b32 v86, v12, v7, s[44:45]
  v_cndmask_b32 v87, v12, v7, s[46:47]
  v_cmp_le_i32 s[40:41], 16, v5
  v_cmp_le_i32 s[42:43], 17, v5
  v_cmp_le_i32 s[44:45], 18, v5
  v_cmp_le_i32 s[46:47], 19, v5
  v_cndmask_b32 v88, v12, v7, s[40:41]
  v_cndmask_b32 v89, v12, v7, s[42:43]
  v_cndmask_b32 v90, v12, v7, s[44:45]
  v_cndmask_b32 v91, v12, v7, s[46:47]
  v_cmp_le_i32 s[40:41], 24, v5
  v_cmp_le_i32 s[42:43], 25, v5
  v_cmp_le_i32 s[44:45], 26, v5
  v_cmp_le_i32 s[46:47], 27, v5
  v_cndmask_b32 v92, v12, v7, s[40:41]
  v_cndmask_b32 v93, v12, v7, s[42:43]
  v_cndmask_b32 v94, v12, v7, s[44:45]
  v_cndmask_b32 v95, v12, v7, s[46:47]
  s_lshl_b32 s22, s69, 3
  s_add_u32 s22, s22, 8
  s_lshl_b32 s26, s16, 1
  s_sub_u32 s23, 6, s26
  s_waitcnt vmcnt(20)
  s_barrier
  s_cmp_eq_u32 s23, 0
  s_cbranch_scc1 A_go_197
A_idle_196:
  s_waitcnt vmcnt(16)
  s_barrier
  s_sub_u32 s18, s18, 8192
  s_max_i32 s18, s18, s20
  s_sub_u32 s17, s17, 8192
  s_max_i32 s17, s17, s19
  s_add_u32 s21, s21, 16384
  s_and_b32 s21, s21, 131071
M_kv_198:
  s_cmp_ge_u32 s17, s36
  s_cbranch_scc1 M_kvok_199
  s_mov_b32 s76, 0
  s_mov_b32 s78, 23
  s_mov_b32 s77, 335872
  s_cmp_eq_u32 s68, 1
  s_cmov_b32 s76, 128
  s_cmov_b32 s78, 27
  s_cmov_b32 s77, 114688
  s_cmp_eq_u32 s68, 2
  s_cmov_b32 s76, 768
  s_cmov_b32 s78, 14
  s_cmov_b32 s77, 0
  s_add_u32 s76, s76, s67
  s_mov_b32 s71, 0
  s_branch M_sg_201
M_sw_200:
  s_sleep 8
  s_add_u32 s71, s71, 1
  s_cmp_gt_u32 s71, 262144
  s_cbranch_scc1 M_exit
M_sg_201:
  s_mov_b32 s79, 0
  s_atomic_or s79, s[72:73], s76 glc
  s_waitcnt lgkmcnt(0)
  s_cmp_lt_u32 s79, s78
  s_cbranch_scc1 M_sw_200
  s_add_u32 s36, s77, s19
  s_add_u32 s68, s68, 1
  s_branch M_kv_198
M_kvok_199:
  s_mov_b32 m0, s21
  s_nop 0
  buffer_load_dwordx4 v3, s[4:7], s18 offen offset:0 sc1 lds
  buffer_load_dwordx4 v3, s[4:7], s18 offen offset:1024 sc1 lds
  s_add_u32 m0, s21, 8192
  s_nop 0
  buffer_load_dwordx4 v3, s[4:7], s17 offen offset:0 sc1 lds
  buffer_load_dwordx4 v3, s[4:7], s17 offen offset:1024 sc1 lds
  v_add_u32 v4, 16384, v4
  v_and_b32 v4, 131071, v4
  s_sub_u32 s22, s22, 1
  s_sub_u32 s23, s23, 1
  s_cmp_lg_u32 s23, 0
  s_cbranch_scc1 A_idle_196
A_go_197:
  ds_read_b128 a[224:227], v4 offset:0
  ds_read_b128 a[228:231], v4 offset:2048
  ds_read_b128 a[232:235], v4 offset:4096
  ds_read_b128 a[236:239], v4 offset:6144
  ds_read_b128 a[240:243], v4 offset:1024
  ds_read_b128 a[244:247], v4 offset:3072
  ds_read_b128 a[248:251], v4 offset:5120
  ds_read_b128 a[252:255], v4 offset:7168
  ds_read_b128 a[192:195], v4 offset:8192
  ds_read_b128 a[196:199], v4 offset:9216
  ds_read_b128 a[200:203], v4 offset:10240
  ds_read_b128 a[204:207], v4 offset:11264
  ds_read_b128 a[208:211], v4 offset:12288
  ds_read_b128 a[212:215], v4 offset:13312
  ds_read_b128 a[216:219], v4 offset:14336
  ds_read_b128 a[220:223], v4 offset:15360
  v_add_u32 v4, 16384, v4
  v_and_b32 v4, 131071, v4
  s_waitcnt lgkmcnt(8)
.p2align 6
A_top_202:
  s_waitcnt lgkmcnt(7)
  v_mfma_f32_32x32x16_bf16 v[32:47], a[192:195], a[128:131], v[64:79]
  s_waitcnt lgkmcnt(6)
  v_exp_f32 v54, v54
  v_add_f32 v11, v11, v53
  v_cvt_pk_bf16_f32 v106, v52, v53
  v_mfma_f32_32x32x16_bf16 v[32:47], a[196:199], a[132:135], v[32:47]
  s_waitcnt lgkmcnt(4)
  v_exp_f32 v55, v55
  v_add_f32 v10, v10, v54
  v_mfma_f32_32x32x16_bf16 v[32:47], a[200:203], a[136:139], v[32:47]
  v_exp_f32 v56, v56
  v_add_f32 v11, v11, v55
  v_cvt_pk_bf16_f32 v107, v54, v55
  v_mfma_f32_32x32x16_bf16 v[32:47], a[204:207], a[140:143], v[32:47]
  s_waitcnt lgkmcnt(2)
  v_exp_f32 v57, v57
  v_add_f32 v10, v10, v56
  v_mfma_f32_32x32x16_bf16 v[32:47], a[208:211], a[144:147], v[32:47]
  v_exp_f32 v58, v58
  v_add_f32 v11, v11, v57
  v_cvt_pk_bf16_f32 v108, v56, v57
  v_mfma_f32_32x32x16_bf16 v[32:47], a[212:215], a[148:151], v[32:47]
  s_waitcnt lgkmcnt(0)
  v_exp_f32 v59, v59
  v_add_f32 v10, v10, v58
  v_mfma_f32_32x32x16_bf16 v[32:47], a[216:219], a[152:155], v[32:47]
  v_exp_f32 v60, v60
  v_add_f32 v11, v11, v59
  v_cvt_pk_bf16_f32 v109, v58, v59
  v_mfma_f32_32x32x16_bf16 v[32:47], a[220:223], a[156:159], v[32:47]
  s_waitcnt vmcnt(16)
  s_barrier
  v_exp_f32 v61, v61
  v_add_f32 v10, v10, v60
  v_mfma_f32_32x32x16_bf16 a[64:79], a[224:227], v[104:107], a[64:79]
  ds_read_b128 a[224:227], v4 offset:0
  v_exp_f32 v62, v62
  v_add_f32 v11, v11, v61
  v_cvt_pk_bf16_f32 v110, v60, v61
  v_mfma_f32_32x32x16_bf16 a[80:95], a[228:231], v[104:107], a[80:95]
  s_sub_u32 s18, s18, 8192
  ds_read_b128 a[228:231], v4 offset:2048
  v_exp_f32 v63, v63
  v_add_f32 v10, v10, v62
  v_mfma_f32_32x32x16_bf16 a[96:111], a[232:235], v[104:107], a[96:111]
  s_max_i32 s18, s18, s20
  ds_read_b128 a[232:235], v4 offset:4096
  v_exp_f32 v32, v32
  v_add_f32 v11, v11, v63
  v_cvt_pk_bf16_f32 v111, v62, v63
  v_mfma_f32_32x32x16_bf16 a[112:127], a[236:239], v[104:107], a[112:127]
  s_sub_u32 s17, s17, 8192
  ds_read_b128 a[236:239], v4 offset:6144
  v_exp_f32 v33, v33
  v_add_f32 v8, v8, v32
  v_mfma_f32_32x32x16_bf16 a[64:79], a[240:243], v[108:111], a[64:79]
  s_max_i32 s17, s17, s19
  ds_read_b128 a[240:243], v4 offset:1024
  v_exp_f32 v34, v34
  v_add_f32 v9, v9, v33
  v_cvt_pk_bf16_f32 v96, v32, v33
  v_mfma_f32_32x32x16_bf16 a[80:95], a[244:247], v[108:111], a[80:95]
  s_add_u32 s21, s21, 16384
  ds_read_b128 a[244:247], v4 offset:3072
  v_exp_f32 v35, v35
  v_add_f32 v8, v8, v34
  v_mfma_f32_32x32x16_bf16 a[96:111], a[248:251], v[108:111], a[96:111]
  s_and_b32 s21, s21, 131071
  ds_read_b128 a[248:251], v4 offset:5120
  v_exp_f32 v36, v36
  v_add_f32 v9, v9, v35
  v_cvt_pk_bf16_f32 v97, v34, v35
  v_mfma_f32_32x32x16_bf16 a[112:127], a[252:255], v[108:111], a[112:127]
  ds_read_b128 a[252:255], v4 offset:7168
  v_exp_f32 v37, v37
  v_add_f32 v8, v8, v36
  v_mfma_f32_32x32x16_bf16 v[48:63], a[192:195], a[160:163], v[80:95]
  s_add_u32 s23, s23, 1
  ds_read_b128 a[192:195], v4 offset:8192
  v_exp_f32 v38, v38
  v_add_f32 v9, v9, v37
  v_cvt_pk_bf16_f32 v98, v36, v37
  v_mfma_f32_32x32x16_bf16 v[48:63], a[196:199], a[164:167], v[48:63]
  s_sub_u32 s22, s22, 1
  ds_read_b128 a[196:199], v4 offset:9216
  v_exp_f32 v39, v39
  v_add_f32 v8, v8, v38
  v_mfma_f32_32x32x16_bf16 v[48:63], a[200:203], a[168:171], v[48:63]
  s_cmp_lt_u32 s23, 3
  ds_read_b128 a[200:203], v4 offset:10240
  v_exp_f32 v40, v40
  v_add_f32 v9, v9, v39
  v_cvt_pk_bf16_f32 v99, v38, v39
  v_mfma_f32_32x32x16_bf16 v[48:63], a[204:207], a[172:175], v[48:63]
  s_cbranch_scc1 A_upd_203
A_back_204:
  ds_read_b128 a[204:207], v4 offset:11264
  v_exp_f32 v41, v41
  v_add_f32 v8, v8, v40
  v_mfma_f32_32x32x16_bf16 v[48:63], a[208:211], a[176:179], v[48:63]
  s_cmp_lt_u32 s17, s36
  ds_read_b128 a[208:211], v4 offset:12288
  v_exp_f32 v42, v42
  v_add_f32 v9, v9, v41
  v_cvt_pk_bf16_f32 v100, v40, v41
  v_mfma_f32_32x32x16_bf16 v[48:63], a[212:215], a[180:183], v[48:63]
  s_cbranch_scc1 A_kvw_206
A_kvb_207:
  ds_read_b128 a[212:215], v4 offset:13312
  v_exp_f32 v43, v43
  v_add_f32 v8, v8, v42
  v_mfma_f32_32x32x16_bf16 v[48:63], a[216:219], a[184:187], v[48:63]
  s_mov_b32 m0, s21
  ds_read_b128 a[216:219], v4 offset:14336
  v_exp_f32 v44, v44
  v_add_f32 v9, v9, v43
  v_cvt_pk_bf16_f32 v101, v42, v43
  v_mfma_f32_32x32x16_bf16 v[48:63], a[220:223], a[188:191], v[48:63]
  s_waitcnt lgkmcnt(13)
  ds_read_b128 a[220:223], v4 offset:15360
  v_exp_f32 v45, v45
  v_add_f32 v8, v8, v44
  v_mfma_f32_32x32x16_bf16 a[0:15], a[224:227], v[96:99], a[0:15]
  buffer_load_dwordx4 v3, s[4:7], s18 offen offset:0 sc1 lds
  v_exp_f32 v46, v46
  v_add_f32 v9, v9, v45
  v_cvt_pk_bf16_f32 v102, v44, v45
  v_mfma_f32_32x32x16_bf16 a[16:31], a[228:231], v[96:99], a[16:31]
  s_waitcnt lgkmcnt(12)
  v_exp_f32 v47, v47
  v_add_f32 v8, v8, v46
  v_add_u32 v4, 16384, v4
  v_mfma_f32_32x32x16_bf16 a[32:47], a[232:235], v[96:99], a[32:47]
  buffer_load_dwordx4 v3, s[4:7], s18 offen offset:1024 sc1 lds
  v_exp_f32 v48, v48
  v_add_f32 v9, v9, v47
  v_cvt_pk_bf16_f32 v103, v46, v47
  v_mfma_f32_32x32x16_bf16 a[48:63], a[236:239], v[96:99], a[48:63]
  s_waitcnt lgkmcnt(10)
  s_add_u32 m0, s21, 8192
  v_exp_f32 v49, v49
  v_add_f32 v10, v10, v48
  v_and_b32 v4, 131071, v4
  v_mfma_f32_32x32x16_bf16 a[0:15], a[240:243], v[100:103], a[0:15]
  buffer_load_dwordx4 v3, s[4:7], s17 offen offset:0 sc1 lds
  v_exp_f32 v50, v50
  v_add_f32 v11, v11, v49
  v_cvt_pk_bf16_f32 v104, v48, v49
  v_mfma_f32_32x32x16_bf16 a[16:31], a[244:247], v[100:103], a[16:31]
  s_waitcnt lgkmcnt(8)
  s_cmp_lg_u32 s22, 0
  v_exp_f32 v51, v51
  v_add_f32 v10, v10, v50
  v_mfma_f32_32x32x16_bf16 a[32:47], a[248:251], v[100:103], a[32:47]
  buffer_load_dwordx4 v3, s[4:7], s17 offen offset:1024 sc1 lds
  v_exp_f32 v52, v52
  v_add_f32 v11, v11, v51
  v_cvt_pk_bf16_f32 v105, v50, v51
  v_mfma_f32_32x32x16_bf16 a[48:63], a[252:255], v[100:103], a[48:63]
  v_exp_f32 v53, v53
  v_add_f32 v10, v10, v52
  s_cbranch_scc1 A_top_202
  v_exp_f32 v54, v54
  v_add_f32 v11, v11, v53
  v_cvt_pk_bf16_f32 v106, v52, v53
  v_exp_f32 v55, v55
  v_add_f32 v10, v10, v54
  v_exp_f32 v56, v56
  v_add_f32 v11, v11, v55
  v_cvt_pk_bf16_f32 v107, v54, v55
  v_exp_f32 v57, v57
  v_add_f32 v10, v10, v56
  v_exp_f32 v58, v58
  v_add_f32 v11, v11, v57
  v_cvt_pk_bf16_f32 v108, v56, v57
  v_exp_f32 v59, v59
  v_add_f32 v10, v10, v58
  v_exp_f32 v60, v60
  v_add_f32 v11, v11, v59
  v_cvt_pk_bf16_f32 v109, v58, v59
  v_exp_f32 v61, v61
  v_add_f32 v10, v10, v60
  v_exp_f32 v62, v62
  v_add_f32 v11, v11, v61
  v_cvt_pk_bf16_f32 v110, v60, v61
  v_exp_f32 v63, v63
  v_add_f32 v10, v10, v62
  v_add_f32 v11, v11, v63
  v_cvt_pk_bf16_f32 v111, v62, v63
  s_nop 1
  v_mfma_f32_32x32x16_bf16 a[64:79], a[224:227], v[104:107], a[64:79]
  v_mfma_f32_32x32x16_bf16 a[80:95], a[228:231], v[104:107], a[80:95]
  v_mfma_f32_32x32x16_bf16 a[96:111], a[232:235], v[104:107], a[96:111]
  v_mfma_f32_32x32x16_bf16 a[112:127], a[236:239], v[104:107], a[112:127]
  v_mfma_f32_32x32x16_bf16 a[64:79], a[240:243], v[108:111], a[64:79]
  v_mfma_f32_32x32x16_bf16 a[80:95], a[244:247], v[108:111], a[80:95]
  v_mfma_f32_32x32x16_bf16 a[96:111], a[248:251], v[108:111], a[96:111]
  v_mfma_f32_32x32x16_bf16 a[112:127], a[252:255], v[108:111], a[112:127]
  v_add_f32 v8, v8, v9
  v_mov_b32 v9, v8
  s_nop 1
  v_permlane32_swap_b32 v8, v9
  s_nop 1
  v_add_f32 v8, v8, v9
  v_add_f32 v10, v10, v11
  v_mov_b32 v11, v10
  s_nop 1
  v_permlane32_swap_b32 v10, v11
  s_nop 1
  v_add_f32 v10, v10, v11
  v_subrev_u32 v12, 0x2f800000, v8
  v_subrev_u32 v13, 0x2f800000, v10
  v_max_u32 v12, v12, v13
  v_cmp_le_u32 vcc, 0x28000000, v12
  s_nop 1
  s_cmp_lg_u64 vcc, 0
  s_cselect_b32 s26, 1, 0
  v_mov_b32 v12, s26
  s_lshl_b32 s26, s16, 2
  s_add_u32 s26, s26, 131072
  v_mov_b32 v13, s26
  ds_write_b32 v13, v12
  v_mov_b32 v14, 131072
  s_waitcnt vmcnt(0) lgkmcnt(0)
  s_barrier
  ds_read_b128 v[16:19], v14
  v_rcp_f32 v8, v8
  v_rcp_f32 v10, v10
  s_waitcnt lgkmcnt(0)
  v_or3_b32 v12, v16, v17, v18
  v_or_b32 v12, v12, v19
  s_nop 0
  v_readfirstlane_b32 s26, v12
  s_nop 1
  s_cmp_gt_u32 s26, s29
  s_cbranch_scc1 A_slow_208
  s_add_u32 s28, s25, 100663296
  v_accvgpr_read_b32 v112, a0
  v_accvgpr_read_b32 v113, a1
  v_accvgpr_read_b32 v114, a2
  v_accvgpr_read_b32 v115, a3
  v_accvgpr_read_b32 v116, a4
  v_accvgpr_read_b32 v117, a5
  v_accvgpr_read_b32 v118, a6
  v_accvgpr_read_b32 v119, a7
  v_pk_mul_f32 v[112:113], v[112:113], v[8:9] op_sel_hi:[1,0]
  v_pk_mul_f32 v[114:115], v[114:115], v[8:9] op_sel_hi:[1,0]
  v_pk_mul_f32 v[116:117], v[116:117], v[8:9] op_sel_hi:[1,0]
  v_pk_mul_f32 v[118:119], v[118:119], v[8:9] op_sel_hi:[1,0]
  v_cvt_pk_bf16_f32 v120, v112, v113
  v_cvt_pk_bf16_f32 v121, v114, v115
  v_cvt_pk_bf16_f32 v122, v116, v117
  v_cvt_pk_bf16_f32 v123, v118, v119
  buffer_store_dwordx4 v[120:123], v2, s[4:7], s28 offen offset:0 sc1
  v_accvgpr_read_b32 v124, a8
  v_accvgpr_read_b32 v125, a9
  v_accvgpr_read_b32 v126, a10
  v_accvgpr_read_b32 v127, a11
  v_accvgpr_read_b32 v128, a12
  v_accvgpr_read_b32 v129, a13
  v_accvgpr_read_b32 v130, a14
  v_accvgpr_read_b32 v131, a15
  v_pk_mul_f32 v[124:125], v[124:125], v[8:9] op_sel_hi:[1,0]
  v_pk_mul_f32 v[126:127], v[126:127], v[8:9] op_sel_hi:[1,0]
  v_pk_mul_f32 v[128:129], v[128:129], v[8:9] op_sel_hi:[1,0]
  v_pk_mul_f32 v[130:131], v[130:131], v[8:9] op_sel_hi:[1,0]
  v_cvt_pk_bf16_f32 v132, v124, v125
  v_cvt_pk_bf16_f32 v133, v126, v127
  v_cvt_pk_bf16_f32 v134, v128, v129
  v_cvt_pk_bf16_f32 v135, v130, v131
  buffer_store_dwordx4 v[132:135], v2, s[4:7], s28 offen offset:1024 sc1
  v_accvgpr_read_b32 v136, a16
  v_accvgpr_read_b32 v137, a17
  v_accvgpr_read_b32 v138, a18
  v_accvgpr_read_b32 v139, a19
  v_accvgpr_read_b32 v140, a20
  v_accvgpr_read_b32 v141, a21
  v_accvgpr_read_b32 v142, a22
  v_accvgpr_read_b32 v143, a23
  v_pk_mul_f32 v[136:137], v[136:137], v[8:9] op_sel_hi:[1,0]
  v_pk_mul_f32 v[138:139], v[138:139], v[8:9] op_sel_hi:[1,0]
  v_pk_mul_f32 v[140:141], v[140:141], v[8:9] op_sel_hi:[1,0]
  v_pk_mul_f32 v[142:143], v[142:143], v[8:9] op_sel_hi:[1,0]
  v_cvt_pk_bf16_f32 v144, v136, v137
  v_cvt_pk_bf16_f32 v145, v138, v139
  v_cvt_pk_bf16_f32 v146, v140, v141
  v_cvt_pk_bf16_f32 v147, v142, v143
  buffer_store_dwordx4 v[144:147], v2, s[4:7], s28 offen offset:2048 sc1
  v_accvgpr_read_b32 v148, a24
  v_accvgpr_read_b32 v149, a25
  v_accvgpr_read_b32 v150, a26
  v_accvgpr_read_b32 v151, a27
  v_accvgpr_read_b32 v152, a28
  v_accvgpr_read_b32 v153, a29
  v_accvgpr_read_b32 v154, a30
  v_accvgpr_read_b32 v155, a31
  v_pk_mul_f32 v[148:149], v[148:149], v[8:9] op_sel_hi:[1,0]
  v_pk_mul_f32 v[150:151], v[150:151], v[8:9] op_sel_hi:[1,0]
  v_pk_mul_f32 v[152:153], v[152:153], v[8:9] op_sel_hi:[1,0]
  v_pk_mul_f32 v[154:155], v[154:155], v[8:9] op_sel_hi:[1,0]
  v_cvt_pk_bf16_f32 v156, v148, v149
  v_cvt_pk_bf16_f32 v157, v150, v151
  v_cvt_pk_bf16_f32 v158, v152, v153
  v_cvt_pk_bf16_f32 v159, v154, v155
  buffer_store_dwordx4 v[156:159], v2, s[4:7], s28 offen offset:3072 sc1
  s_add_u32 s28, s25, 100667392
  v_accvgpr_read_b32 v112, a32
  v_accvgpr_read_b32 v113, a33
  v_accvgpr_read_b32 v114, a34
  v_accvgpr_read_b32 v115, a35
  v_accvgpr_read_b32 v116, a36
  v_accvgpr_read_b32 v117, a37
  v_accvgpr_read_b32 v118, a38
  v_accvgpr_read_b32 v119, a39
  v_pk_mul_f32 v[112:113], v[112:113], v[8:9] op_sel_hi:[1,0]
  v_pk_mul_f32 v[114:115], v[114:115], v[8:9] op_sel_hi:[1,0]
  v_pk_mul_f32 v[116:117], v[116:117], v[8:9] op_sel_hi:[1,0]
  v_pk_mul_f32 v[118:119], v[118:119], v[8:9] op_sel_hi:[1,0]
  v_cvt_pk_bf16_f32 v120, v112, v113
  v_cvt_pk_bf16_f32 v121, v114, v115
  v_cvt_pk_bf16_f32 v122, v116, v117
  v_cvt_pk_bf16_f32 v123, v118, v119
  buffer_store_dwordx4 v[120:123], v2, s[4:7], s28 offen offset:0 sc1
  v_accvgpr_read_b32 v124, a40
  v_accvgpr_read_b32 v125, a41
  v_accvgpr_read_b32 v126, a42
  v_accvgpr_read_b32 v127, a43
  v_accvgpr_read_b32 v128, a44
  v_accvgpr_read_b32 v129, a45
  v_accvgpr_read_b32 v130, a46
  v_accvgpr_read_b32 v131, a47
  v_pk_mul_f32 v[124:125], v[124:125], v[8:9] op_sel_hi:[1,0]
  v_pk_mul_f32 v[126:127], v[126:127], v[8:9] op_sel_hi:[1,0]
  v_pk_mul_f32 v[128:129], v[128:129], v[8:9] op_sel_hi:[1,0]
  v_pk_mul_f32 v[130:131], v[130:131], v[8:9] op_sel_hi:[1,0]
  v_cvt_pk_bf16_f32 v132, v124, v125
  v_cvt_pk_bf16_f32 v133, v126, v127
  v_cvt_pk_bf16_f32 v134, v128, v129
  v_cvt_pk_bf16_f32 v135, v130, v131
  buffer_store_dwordx4 v[132:135], v2, s[4:7], s28 offen offset:1024 sc1
  v_accvgpr_read_b32 v136, a48
  v_accvgpr_read_b32 v137, a49
  v_accvgpr_read_b32 v138, a50
  v_accvgpr_read_b32 v139, a51
  v_accvgpr_read_b32 v140, a52
  v_accvgpr_read_b32 v141, a53
  v_accvgpr_read_b32 v142, a54
  v_accvgpr_read_b32 v143, a55
  v_pk_mul_f32 v[136:137], v[136:137], v[8:9] op_sel_hi:[1,0]
  v_pk_mul_f32 v[138:139], v[138:139], v[8:9] op_sel_hi:[1,0]
  v_pk_mul_f32 v[140:141], v[140:141], v[8:9] op_sel_hi:[1,0]
  v_pk_mul_f32 v[142:143], v[142:143], v[8:9] op_sel_hi:[1,0]
  v_cvt_pk_bf16_f32 v144, v136, v137
  v_cvt_pk_bf16_f32 v145, v138, v139
  v_cvt_pk_bf16_f32 v146, v140, v141
  v_cvt_pk_bf16_f32 v147, v142, v143
  buffer_store_dwordx4 v[144:147], v2, s[4:7], s28 offen offset:2048 sc1
  v_accvgpr_read_b32 v148, a56
  v_accvgpr_read_b32 v149, a57
  v_accvgpr_read_b32 v150, a58
  v_accvgpr_read_b32 v151, a59
  v_accvgpr_read_b32 v152, a60
  v_accvgpr_read_b32 v153, a61
  v_accvgpr_read_b32 v154, a62
  v_accvgpr_read_b32 v155, a63
  v_pk_mul_f32 v[148:149], v[148:149], v[8:9] op_sel_hi:[1,0]
  v_pk_mul_f32 v[150:151], v[150:151], v[8:9] op_sel_hi:[1,0]
  v_pk_mul_f32 v[152:153], v[152:153], v[8:9] op_sel_hi:[1,0]
  v_pk_mul_f32 v[154:155], v[154:155], v[8:9] op_sel_hi:[1,0]
  v_cvt_pk_bf16_f32 v156, v148, v149
  v_cvt_pk_bf16_f32 v157, v150, v151
  v_cvt_pk_bf16_f32 v158, v152, v153
  v_cvt_pk_bf16_f32 v159, v154, v155
  buffer_store_dwordx4 v[156:159], v2, s[4:7], s28 offen offset:3072 sc1
  s_add_u32 s28, s25, 100671488
  v_accvgpr_read_b32 v112, a64
  v_accvgpr_read_b32 v113, a65
  v_accvgpr_read_b32 v114, a66
  v_accvgpr_read_b32 v115, a67
  v_accvgpr_read_b32 v116, a68
  v_accvgpr_read_b32 v117, a69
  v_accvgpr_read_b32 v118, a70
  v_accvgpr_read_b32 v119, a71
  v_pk_mul_f32 v[112:113], v[112:113], v[10:11] op_sel_hi:[1,0]
  v_pk_mul_f32 v[114:115], v[114:115], v[10:11] op_sel_hi:[1,0]
  v_pk_mul_f32 v[116:117], v[116:117], v[10:11] op_sel_hi:[1,0]
  v_pk_mul_f32 v[118:119], v[118:119], v[10:11] op_sel_hi:[1,0]
  v_cvt_pk_bf16_f32 v120, v112, v113
  v_cvt_pk_bf16_f32 v121, v114, v115
  v_cvt_pk_bf16_f32 v122, v116, v117
  v_cvt_pk_bf16_f32 v123, v118, v119
  buffer_store_dwordx4 v[120:123], v2, s[4:7], s28 offen offset:0 sc1
  v_accvgpr_read_b32 v124, a72
  v_accvgpr_read_b32 v125, a73
  v_accvgpr_read_b32 v126, a74
  v_accvgpr_read_b32 v127, a75
  v_accvgpr_read_b32 v128, a76
  v_accvgpr_read_b32 v129, a77
  v_accvgpr_read_b32 v130, a78
  v_accvgpr_read_b32 v131, a79
  v_pk_mul_f32 v[124:125], v[124:125], v[10:11] op_sel_hi:[1,0]
  v_pk_mul_f32 v[126:127], v[126:127], v[10:11] op_sel_hi:[1,0]
  v_pk_mul_f32 v[128:129], v[128:129], v[10:11] op_sel_hi:[1,0]
  v_pk_mul_f32 v[130:131], v[130:131], v[10:11] op_sel_hi:[1,0]
  v_cvt_pk_bf16_f32 v132, v124, v125
  v_cvt_pk_bf16_f32 v133, v126, v127
  v_cvt_pk_bf16_f32 v134, v128, v129
  v_cvt_pk_bf16_f32 v135, v130, v131
  buffer_store_dwordx4 v[132:135], v2, s[4:7], s28 offen offset:1024 sc1
  v_accvgpr_read_b32 v136, a80
  v_accvgpr_read_b32 v137, a81
  v_accvgpr_read_b32 v138, a82
  v_accvgpr_read_b32 v139, a83
  v_accvgpr_read_b32 v140, a84
  v_accvgpr_read_b32 v141, a85
  v_accvgpr_read_b32 v142, a86
  v_accvgpr_read_b32 v143, a87
  v_pk_mul_f32 v[136:137], v[136:137], v[10:11] op_sel_hi:[1,0]
  v_pk_mul_f32 v[138:139], v[138:139], v[10:11] op_sel_hi:[1,0]
  v_pk_mul_f32 v[140:141], v[140:141], v[10:11] op_sel_hi:[1,0]
  v_pk_mul_f32 v[142:143], v[142:143], v[10:11] op_sel_hi:[1,0]
  v_cvt_pk_bf16_f32 v144, v136, v137
  v_cvt_pk_bf16_f32 v145, v138, v139
  v_cvt_pk_bf16_f32 v146, v140, v141
  v_cvt_pk_bf16_f32 v147, v142, v143
  buffer_store_dwordx4 v[144:147], v2, s[4:7], s28 offen offset:2048 sc1
  v_accvgpr_read_b32 v148, a88
  v_accvgpr_read_b32 v149, a89
  v_accvgpr_read_b32 v150, a90
  v_accvgpr_read_b32 v151, a91
  v_accvgpr_read_b32 v152, a92
  v_accvgpr_read_b32 v153, a93
  v_accvgpr_read_b32 v154, a94
  v_accvgpr_read_b32 v155, a95
  v_pk_mul_f32 v[148:149], v[148:149], v[10:11] op_sel_hi:[1,0]
  v_pk_mul_f32 v[150:151], v[150:151], v[10:11] op_sel_hi:[1,0]
  v_pk_mul_f32 v[152:153], v[152:153], v[10:11] op_sel_hi:[1,0]
  v_pk_mul_f32 v[154:155], v[154:155], v[10:11] op_sel_hi:[1,0]
  v_cvt_pk_bf16_f32 v156, v148, v149
  v_cvt_pk_bf16_f32 v157, v150, v151
  v_cvt_pk_bf16_f32 v158, v152, v153
  v_cvt_pk_bf16_f32 v159, v154, v155
  buffer_store_dwordx4 v[156:159], v2, s[4:7], s28 offen offset:3072 sc1
  s_add_u32 s28, s25, 100675584
  v_accvgpr_read_b32 v112, a96
  v_accvgpr_read_b32 v113, a97
  v_accvgpr_read_b32 v114, a98
  v_accvgpr_read_b32 v115, a99
  v_accvgpr_read_b32 v116, a100
  v_accvgpr_read_b32 v117, a101
  v_accvgpr_read_b32 v118, a102
  v_accvgpr_read_b32 v119, a103
  v_pk_mul_f32 v[112:113], v[112:113], v[10:11] op_sel_hi:[1,0]
  v_pk_mul_f32 v[114:115], v[114:115], v[10:11] op_sel_hi:[1,0]
  v_pk_mul_f32 v[116:117], v[116:117], v[10:11] op_sel_hi:[1,0]
  v_pk_mul_f32 v[118:119], v[118:119], v[10:11] op_sel_hi:[1,0]
  v_cvt_pk_bf16_f32 v120, v112, v113
  v_cvt_pk_bf16_f32 v121, v114, v115
  v_cvt_pk_bf16_f32 v122, v116, v117
  v_cvt_pk_bf16_f32 v123, v118, v119
  buffer_store_dwordx4 v[120:123], v2, s[4:7], s28 offen offset:0 sc1
  v_accvgpr_read_b32 v124, a104
  v_accvgpr_read_b32 v125, a105
  v_accvgpr_read_b32 v126, a106
  v_accvgpr_read_b32 v127, a107
  v_accvgpr_read_b32 v128, a108
  v_accvgpr_read_b32 v129, a109
  v_accvgpr_read_b32 v130, a110
  v_accvgpr_read_b32 v131, a111
  v_pk_mul_f32 v[124:125], v[124:125], v[10:11] op_sel_hi:[1,0]
  v_pk_mul_f32 v[126:127], v[126:127], v[10:11] op_sel_hi:[1,0]
  v_pk_mul_f32 v[128:129], v[128:129], v[10:11] op_sel_hi:[1,0]
  v_pk_mul_f32 v[130:131], v[130:131], v[10:11] op_sel_hi:[1,0]
  v_cvt_pk_bf16_f32 v132, v124, v125
  v_cvt_pk_bf16_f32 v133, v126, v127
  v_cvt_pk_bf16_f32 v134, v128, v129
  v_cvt_pk_bf16_f32 v135, v130, v131
  buffer_store_dwordx4 v[132:135], v2, s[4:7], s28 offen offset:1024 sc1
  v_accvgpr_read_b32 v136, a112
  v_accvgpr_read_b32 v137, a113
  v_accvgpr_read_b32 v138, a114
  v_accvgpr_read_b32 v139, a115
  v_accvgpr_read_b32 v140, a116
  v_accvgpr_read_b32 v141, a117
  v_accvgpr_read_b32 v142, a118
  v_accvgpr_read_b32 v143, a119
  v_pk_mul_f32 v[136:137], v[136:137], v[10:11] op_sel_hi:[1,0]
  v_pk_mul_f32 v[138:139], v[138:139], v[10:11] op_sel_hi:[1,0]
  v_pk_mul_f32 v[140:141], v[140:141], v[10:11] op_sel_hi:[1,0]
  v_pk_mul_f32 v[142:143], v[142:143], v[10:11] op_sel_hi:[1,0]
  v_cvt_pk_bf16_f32 v144, v136, v137
  v_cvt_pk_bf16_f32 v145, v138, v139
  v_cvt_pk_bf16_f32 v146, v140, v141
  v_cvt_pk_bf16_f32 v147, v142, v143
  buffer_store_dwordx4 v[144:147], v2, s[4:7], s28 offen offset:2048 sc1
  v_accvgpr_read_b32 v148, a120
  v_accvgpr_read_b32 v149, a121
  v_accvgpr_read_b32 v150, a122
  v_accvgpr_read_b32 v151, a123
  v_accvgpr_read_b32 v152, a124
  v_accvgpr_read_b32 v153, a125
  v_accvgpr_read_b32 v154, a126
  v_accvgpr_read_b32 v155, a127
  v_pk_mul_f32 v[148:149], v[148:149], v[10:11] op_sel_hi:[1,0]
  v_pk_mul_f32 v[150:151], v[150:151], v[10:11] op_sel_hi:[1,0]
  v_pk_mul_f32 v[152:153], v[152:153], v[10:11] op_sel_hi:[1,0]
  v_pk_mul_f32 v[154:155], v[154:155], v[10:11] op_sel_hi:[1,0]
  v_cvt_pk_bf16_f32 v156, v148, v149
  v_cvt_pk_bf16_f32 v157, v150, v151
  v_cvt_pk_bf16_f32 v158, v152, v153
  v_cvt_pk_bf16_f32 v159, v154, v155
  buffer_store_dwordx4 v[156:159], v2, s[4:7], s28 offen offset:3072 sc1
  s_branch A_out_205
A_kvw_206:
M_kv_209:
  s_cmp_ge_u32 s17, s36
  s_cbranch_scc1 M_kvok_210
  s_mov_b32 s76, 0
  s_mov_b32 s78, 23
  s_mov_b32 s77, 335872
  s_cmp_eq_u32 s68, 1
  s_cmov_b32 s76, 128
  s_cmov_b32 s78, 27
  s_cmov_b32 s77, 114688
  s_cmp_eq_u32 s68, 2
  s_cmov_b32 s76, 768
  s_cmov_b32 s78, 14
  s_cmov_b32 s77, 0
  s_add_u32 s76, s76, s67
  s_mov_b32 s71, 0
  s_branch M_sg_212
M_sw_211:
  s_sleep 8
  s_add_u32 s71, s71, 1
  s_cmp_gt_u32 s71, 262144
  s_cbranch_scc1 M_exit
M_sg_212:
  s_mov_b32 s79, 0
  s_atomic_or s79, s[72:73], s76 glc
  s_waitcnt lgkmcnt(0)
  s_cmp_lt_u32 s79, s78
  s_cbranch_scc1 M_sw_211
  s_add_u32 s36, s77, s19
  s_add_u32 s68, s68, 1
  s_branch M_kv_209
M_kvok_210:
  s_branch A_kvb_207
A_upd_203:
  s_cmp_eq_u32 s23, 2
  s_cbranch_scc1 A_upd2_213
  v_mov_b32 v12, s24
  v_cmp_le_i32 s[40:41], 0, v5
  v_cmp_le_i32 s[42:43], 1, v5
  v_cmp_le_i32 s[44:45], 2, v5
  v_cmp_le_i32 s[46:47], 3, v5
  v_cndmask_b32 v64, v12, v6, s[40:41]
  v_cndmask_b32 v65, v12, v6, s[42:43]
  v_cndmask_b32 v66, v12, v6, s[44:45]
  v_cndmask_b32 v67, v12, v6, s[46:47]
  v_cmp_le_i32 s[40:41], 8, v5
  v_cmp_le_i32 s[42:43], 9, v5
  v_cmp_le_i32 s[44:45], 10, v5
  v_cmp_le_i32 s[46:47], 11, v5
  v_cndmask_b32 v68, v12, v6, s[40:41]
  v_cndmask_b32 v69, v12, v6, s[42:43]
  v_cndmask_b32 v70, v12, v6, s[44:45]
  v_cndmask_b32 v71, v12, v6, s[46:47]
  v_cmp_le_i32 s[40:41], 16, v5
  v_cmp_le_i32 s[42:43], 17, v5
  v_cmp_le_i32 s[44:45], 18, v5
  v_cmp_le_i32 s[46:47], 19, v5
  v_cndmask_b32 v72, v12, v6, s[40:41]
  v_cndmask_b32 v73, v12, v6, s[42:43]
  v_cndmask_b32 v74, v12, v6, s[44:45]
  v_cndmask_b32 v75, v12, v6, s[46:47]
  v_cmp_le_i32 s[40:41], 24, v5
  v_cmp_le_i32 s[42:43], 25, v5
  v_cmp_le_i32 s[44:45], 26, v5
  v_cmp_le_i32 s[46:47], 27, v5
  v_cndmask_b32 v76, v12, v6, s[40:41]
  v_cndmask_b32 v77, v12, v6, s[42:43]
  v_cndmask_b32 v78, v12, v6, s[44:45]
  v_cndmask_b32 v79, v12, v6, s[46:47]
  v_mov_b32 v80, v7
  v_mov_b32 v81, v7
  v_mov_b32 v82, v7
  v_mov_b32 v83, v7
  v_mov_b32 v84, v7
  v_mov_b32 v85, v7
  v_mov_b32 v86, v7
  v_mov_b32 v87, v7
  v_mov_b32 v88, v7
  v_mov_b32 v89, v7
  v_mov_b32 v90, v7
  v_mov_b32 v91, v7
  v_mov_b32 v92, v7
  v_mov_b32 v93, v7
  v_mov_b32 v94, v7
  v_mov_b32 v95, v7
  s_branch A_back_204
A_upd2_213:
  v_mov_b32 v64, v6
  v_mov_b32 v65, v6
  v_mov_b32 v66, v6
  v_mov_b32 v67, v6
  v_mov_b32 v68, v6
  v_mov_b32 v69, v6
  v_mov_b32 v70, v6
  v_mov_b32 v71, v6
  v_mov_b32 v72, v6
  v_mov_b32 v73, v6
  v_mov_b32 v74, v6
  v_mov_b32 v75, v6
  v_mov_b32 v76, v6
  v_mov_b32 v77, v6
  v_mov_b32 v78, v6
  v_mov_b32 v79, v6
  s_branch A_back_204
A_slow_208:
  s_mov_b32 s29, 1
  v_mov_b32 v64, s24
  v_mov_b32 v65, s24
  v_mov_b32 v66, s24
  v_mov_b32 v67, s24
  v_mov_b32 v68, s24
  v_mov_b32 v69, s24
  v_mov_b32 v70, s24
  v_mov_b32 v71, s24
  v_mov_b32 v72, s24
  v_mov_b32 v73, s24
  v_mov_b32 v74, s24
  v_mov_b32 v75, s24
  v_mov_b32 v76, s24
  v_mov_b32 v77, s24
  v_mov_b32 v78, s24
  v_mov_b32 v79, s24
  v_mov_b32 v12, s24
  v_cmp_le_i32 s[40:41], 0, v5
  v_cmp_le_i32 s[42:43], 1, v5
  v_cmp_le_i32 s[44:45], 2, v5
  v_cmp_le_i32 s[46:47], 3, v5
  v_cndmask_b32 v80, v12, v7, s[40:41]
  v_cndmask_b32 v81, v12, v7, s[42:43]
  v_cndmask_b32 v82, v12, v7, s[44:45]
  v_cndmask_b32 v83, v12, v7, s[46:47]
  v_cmp_le_i32 s[40:41], 8, v5
  v_cmp_le_i32 s[42:43], 9, v5
  v_cmp_le_i32 s[44:45], 10, v5
  v_cmp_le_i32 s[46:47], 11, v5
  v_cndmask_b32 v84, v12, v7, s[40:41]
  v_cndmask_b32 v85, v12, v7, s[42:43]
  v_cndmask_b32 v86, v12, v7, s[44:45]
  v_cndmask_b32 v87, v12, v7, s[46:47]
  v_cmp_le_i32 s[40:41], 16, v5
  v_cmp_le_i32 s[42:43], 17, v5
  v_cmp_le_i32 s[44:45], 18, v5
  v_cmp_le_i32 s[46:47], 19, v5
  v_cndmask_b32 v88, v12, v7, s[40:41]
  v_cndmask_b32 v89, v12, v7, s[42:43]
  v_cndmask_b32 v90, v12, v7, s[44:45]
  v_cndmask_b32 v91, v12, v7, s[46:47]
  v_cmp_le_i32 s[40:41], 24, v5
  v_cmp_le_i32 s[42:43], 25, v5
  v_cmp_le_i32 s[44:45], 26, v5
  v_cmp_le_i32 s[46:47], 27, v5
  v_cndmask_b32 v92, v12, v7, s[40:41]
  v_cndmask_b32 v93, v12, v7, s[42:43]
  v_cndmask_b32 v94, v12, v7, s[44:45]
  v_cndmask_b32 v95, v12, v7, s[46:47]
  v_mov_b32 v8, s24
  v_mov_b32 v10, s24
  s_add_u32 s17, s25, 16785408
  s_mov_b32 s23, 0
A_ml_214:
  s_add_u32 s28, s17, 4096
  buffer_load_dwordx4 a[192:195], v2, s[4:7], s17 offen offset:0 sc1
  buffer_load_dwordx4 a[196:199], v2, s[4:7], s17 offen offset:1024 sc1
  buffer_load_dwordx4 a[200:203], v2, s[4:7], s17 offen offset:2048 sc1
  buffer_load_dwordx4 a[204:207], v2, s[4:7], s17 offen offset:3072 sc1
  buffer_load_dwordx4 a[208:211], v2, s[4:7], s28 offen offset:0 sc1
  buffer_load_dwordx4 a[212:215], v2, s[4:7], s28 offen offset:1024 sc1
  buffer_load_dwordx4 a[216:219], v2, s[4:7], s28 offen offset:2048 sc1
  buffer_load_dwordx4 a[220:223], v2, s[4:7], s28 offen offset:3072 sc1
  s_waitcnt vmcnt(0)
  v_mfma_f32_32x32x16_bf16 v[32:47], a[192:195], a[128:131], v[64:79]
  v_mfma_f32_32x32x16_bf16 v[32:47], a[196:199], a[132:135], v[32:47]
  v_mfma_f32_32x32x16_bf16 v[32:47], a[200:203], a[136:139], v[32:47]
  v_mfma_f32_32x32x16_bf16 v[32:47], a[204:207], a[140:143], v[32:47]
  v_mfma_f32_32x32x16_bf16 v[32:47], a[208:211], a[144:147], v[32:47]
  v_mfma_f32_32x32x16_bf16 v[32:47], a[212:215], a[148:151], v[32:47]
  v_mfma_f32_32x32x16_bf16 v[32:47], a[216:219], a[152:155], v[32:47]
  v_mfma_f32_32x32x16_bf16 v[32:47], a[220:223], a[156:159], v[32:47]
  v_mfma_f32_32x32x16_bf16 v[48:63], a[192:195], a[160:163], v[80:95]
  v_mfma_f32_32x32x16_bf16 v[48:63], a[196:199], a[164:167], v[48:63]
  v_mfma_f32_32x32x16_bf16 v[48:63], a[200:203], a[168:171], v[48:63]
  v_mfma_f32_32x32x16_bf16 v[48:63], a[204:207], a[172:175], v[48:63]
  v_mfma_f32_32x32x16_bf16 v[48:63], a[208:211], a[176:179], v[48:63]
  v_mfma_f32_32x32x16_bf16 v[48:63], a[212:215], a[180:183], v[48:63]
  v_mfma_f32_32x32x16_bf16 v[48:63], a[216:219], a[184:187], v[48:63]
  v_mfma_f32_32x32x16_bf16 v[48:63], a[220:223], a[188:191], v[48:63]
  s_nop 7
  s_nop 3
  v_max3_f32 v8, v8, v32, v33
  v_max3_f32 v8, v8, v34, v35
  v_max3_f32 v8, v8, v36, v37
  v_max3_f32 v8, v8, v38, v39
  v_max3_f32 v8, v8, v40, v41
  v_max3_f32 v8, v8, v42, v43
  v_max3_f32 v8, v8, v44, v45
  v_max3_f32 v8, v8, v46, v47
  v_max3_f32 v10, v10, v48, v49
  v_max3_f32 v10, v10, v50, v51
  v_max3_f32 v10, v10, v52, v53
  v_max3_f32 v10, v10, v54, v55
  v_max3_f32 v10, v10, v56, v57
  v_max3_f32 v10, v10, v58, v59
  v_max3_f32 v10, v10, v60, v61
  v_max3_f32 v10, v10, v62, v63
  s_add_u32 s23, s23, 1
  s_cmp_lg_u32 s23, 1
  s_cbranch_scc1 A_m2_215
  v_mov_b32 v12, s24
  v_cmp_le_i32 s[40:41], 0, v5
  v_cmp_le_i32 s[42:43], 1, v5
  v_cmp_le_i32 s[44:45], 2, v5
  v_cmp_le_i32 s[46:47], 3, v5
  v_cndmask_b32 v64, v12, v6, s[40:41]
  v_cndmask_b32 v65, v12, v6, s[42:43]
  v_cndmask_b32 v66, v12, v6, s[44:45]
  v_cndmask_b32 v67, v12, v6, s[46:47]
  v_cmp_le_i32 s[40:41], 8, v5
  v_cmp_le_i32 s[42:43], 9, v5
  v_cmp_le_i32 s[44:45], 10, v5
  v_cmp_le_i32 s[46:47], 11, v5
  v_cndmask_b32 v68, v12, v6, s[40:41]
  v_cndmask_b32 v69, v12, v6, s[42:43]
  v_cndmask_b32 v70, v12, v6, s[44:45]
  v_cndmask_b32 v71, v12, v6, s[46:47]
  v_cmp_le_i32 s[40:41], 16, v5
  v_cmp_le_i32 s[42:43], 17, v5
  v_cmp_le_i32 s[44:45], 18, v5
  v_cmp_le_i32 s[46:47], 19, v5
  v_cndmask_b32 v72, v12, v6, s[40:41]
  v_cndmask_b32 v73, v12, v6, s[42:43]
  v_cndmask_b32 v74, v12, v6, s[44:45]
  v_cndmask_b32 v75, v12, v6, s[46:47]
  v_cmp_le_i32 s[40:41], 24, v5
  v_cmp_le_i32 s[42:43], 25, v5
  v_cmp_le_i32 s[44:45], 26, v5
  v_cmp_le_i32 s[46:47], 27, v5
  v_cndmask_b32 v76, v12, v6, s[40:41]
  v_cndmask_b32 v77, v12, v6, s[42:43]
  v_cndmask_b32 v78, v12, v6, s[44:45]
  v_cndmask_b32 v79, v12, v6, s[46:47]
  v_mov_b32 v80, v7
  v_mov_b32 v81, v7
  v_mov_b32 v82, v7
  v_mov_b32 v83, v7
  v_mov_b32 v84, v7
  v_mov_b32 v85, v7
  v_mov_b32 v86, v7
  v_mov_b32 v87, v7
  v_mov_b32 v88, v7
  v_mov_b32 v89, v7
  v_mov_b32 v90, v7
  v_mov_b32 v91, v7
  v_mov_b32 v92, v7
  v_mov_b32 v93, v7
  v_mov_b32 v94, v7
  v_mov_b32 v95, v7
A_m2_215:
  s_cmp_lg_u32 s23, 2
  s_cbranch_scc1 A_m3_216
  v_mov_b32 v64, v6
  v_mov_b32 v65, v6
  v_mov_b32 v66, v6
  v_mov_b32 v67, v6
  v_mov_b32 v68, v6
  v_mov_b32 v69, v6
  v_mov_b32 v70, v6
  v_mov_b32 v71, v6
  v_mov_b32 v72, v6
  v_mov_b32 v73, v6
  v_mov_b32 v74, v6
  v_mov_b32 v75, v6
  v_mov_b32 v76, v6
  v_mov_b32 v77, v6
  v_mov_b32 v78, v6
  v_mov_b32 v79, v6
A_m3_216:
  s_sub_u32 s17, s17, 8192
  s_cmp_ge_i32 s17, s19
  s_cbranch_scc1 A_ml_214
  v_mov_b32 v9, v8
  s_nop 1
  v_permlane32_swap_b32 v8, v9
  s_nop 1
  v_max_f32 v8, v8, v9
  v_sub_f32 v6, 0, v8
  v_mov_b32 v11, v10
  s_nop 1
  v_permlane32_swap_b32 v10, v11
  s_nop 1
  v_max_f32 v10, v10, v11
  v_sub_f32 v7, 0, v10
  s_branch A_again_195
A_out_205:
  s_mov_b32 s69, s55
  s_mov_b32 s70, s56
  s_sub_u32 s52, s52, 1
  s_cmp_lg_u32 s52, 0
  s_cbranch_scc1 M_att
  s_waitcnt vmcnt(0)
  s_barrier
  s_mov_b32 s30, 512
  v_mov_b32 v144, s30
  v_min_u32 v145, 1, v0
  v_lshlrev_b32 v145, 30, v145
  buffer_store_dword v144, v145, s[4:7], s31 offen sc1
  s_lshr_b32 s48, s64, 2
  s_bfe_u32 s49, s64, 0x10001
  s_and_b32 s50, s64, 1
  s_mul_i32 s50, s50, 6
  s_add_u32 s50, s50, s65
  s_mov_b32 s51, 12
  s_cmp_lt_u32 s50, 4
  s_cselect_b32 s23, 6, 5
  s_load_dwordx2 s[8:9], s[0:1], 40
  s_lshl_b32 s17, s48, 19
  s_lshl_b32 s26, s49, 2
  s_add_u32 s26, s26, s16
  s_lshl_b32 s27, s26, 7
  s_add_u32 s17, s17, s27
  s_mov_b32 s18, 1024
  s_lshl_b32 s21, s48, 6
  s_add_u32 s21, s21, s50
  s_lshl_b32 s21, s21, 3
  s_add_u32 s21, s21, s26
  s_lshl_b32 s21, s21, 12
  s_add_u32 s21, s21, 150994944
  s_lshl_b32 s22, s51, 15
  s_mov_b32 s24, 1.0
  s_waitcnt lgkmcnt(0)
  s_and_b32 s9, s9, 0xffff
  s_mov_b32 s10, 4194304
  s_mov_b32 s11, 0x20000
  s_mov_b32 s12, s4
  s_mov_b32 s13, s5
  s_mov_b32 s14, 268435456
  s_mov_b32 s15, 0x20000
  s_lshl_b32 s19, s48, 8
  s_add_u32 s19, s19, s50
  s_lshl_b32 s19, s19, 13
  s_add_u32 s19, s19, 100663296
  s_lshl_b32 s20, s51, 13
  v_lshrrev_b32 v144, 4, v1
  v_and_b32 v56, 0xff, v2
  v_lshl_add_u32 v56, v144, 9, v56
  s_mul_i32 s26, s16, 524288
  v_add_u32 v8, 0, v56
  v_add_u32 v16, 0, v2
  v_add_u32 v16, s26, v16
  v_add_u32 v9, 256, v56
  v_add_u32 v17, 1024, v2
  v_add_u32 v17, s26, v17
  v_add_u32 v10, 2048, v56
  v_add_u32 v18, 2048, v2
  v_add_u32 v18, s26, v18
  v_add_u32 v11, 2304, v56
  v_add_u32 v19, 3072, v2
  v_add_u32 v19, s26, v19
  v_add_u32 v12, 4096, v56
  v_add_u32 v20, 4096, v2
  v_add_u32 v20, s26, v20
  v_add_u32 v13, 4352, v56
  v_add_u32 v21, 5120, v2
  v_add_u32 v21, s26, v21
  v_add_u32 v14, 6144, v56
  v_add_u32 v22, 6144, v2
  v_add_u32 v22, s26, v22
  v_add_u32 v15, 6400, v56
  v_add_u32 v23, 7168, v2
  v_add_u32 v23, s26, v23
  v_lshrrev_b32 v144, 3, v1
  v_mul_lo_u32 v144, v144, s18
  v_and_b32 v145, 7, v1
  v_lshl_add_u32 v144, v145, 4, v144
  s_lshl_b32 s28, s16, 15
  s_add_u32 s28, s28, 32768
  s_lshl_b32 s29, s18, 3
  s_add_u32 m0, s28, 0
  s_nop 0
  buffer_load_dwordx4 v144, s[8:11], s17 offen lds
  s_add_u32 s17, s17, s29
  s_add_u32 m0, s28, 1024
  s_nop 0
  buffer_load_dwordx4 v144, s[8:11], s17 offen lds
  s_add_u32 s17, s17, s29
  s_add_u32 m0, s28, 2048
  s_nop 0
  buffer_load_dwordx4 v144, s[8:11], s17 offen lds
  s_add_u32 s17, s17, s29
  s_add_u32 m0, s28, 3072
  s_nop 0
  buffer_load_dwordx4 v144, s[8:11], s17 offen lds
  s_add_u32 s17, s17, s29
  s_add_u32 m0, s28, 4096
  s_nop 0
  buffer_load_dwordx4 v144, s[8:11], s17 offen lds
  s_add_u32 s17, s17, s29
  s_add_u32 m0, s28, 5120
  s_nop 0
  buffer_load_dwordx4 v144, s[8:11], s17 offen lds
  s_add_u32 s17, s17, s29
  s_add_u32 m0, s28, 6144
  s_nop 0
  buffer_load_dwordx4 v144, s[8:11], s17 offen lds
  s_add_u32 s17, s17, s29
  s_add_u32 m0, s28, 7168
  s_nop 0
  buffer_load_dwordx4 v144, s[8:11], s17 offen lds
  s_add_u32 s17, s17, s29
  s_add_u32 m0, s28, 8192
  s_nop 0
  buffer_load_dwordx4 v144, s[8:11], s17 offen lds
  s_add_u32 s17, s17, s29
  s_add_u32 m0, s28, 9216
  s_nop 0
  buffer_load_dwordx4 v144, s[8:11], s17 offen lds
  s_add_u32 s17, s17, s29
  s_add_u32 m0, s28, 10240
  s_nop 0
  buffer_load_dwordx4 v144, s[8:11], s17 offen lds
  s_add_u32 s17, s17, s29
  s_add_u32 m0, s28, 11264
  s_nop 0
  buffer_load_dwordx4 v144, s[8:11], s17 offen lds
  s_add_u32 s17, s17, s29
  s_add_u32 m0, s28, 12288
  s_nop 0
  buffer_load_dwordx4 v144, s[8:11], s17 offen lds
  s_add_u32 s17, s17, s29
  s_add_u32 m0, s28, 13312
  s_nop 0
  buffer_load_dwordx4 v144, s[8:11], s17 offen lds
  s_add_u32 s17, s17, s29
  s_add_u32 m0, s28, 14336
  s_nop 0
  buffer_load_dwordx4 v144, s[8:11], s17 offen lds
  s_add_u32 s17, s17, s29
  s_add_u32 m0, s28, 15360
  s_nop 0
  buffer_load_dwordx4 v144, s[8:11], s17 offen lds
  s_add_u32 s17, s17, s29
  s_add_u32 m0, s28, 16384
  s_nop 0
  buffer_load_dwordx4 v144, s[8:11], s17 offen lds
  s_add_u32 s17, s17, s29
  s_add_u32 m0, s28, 17408
  s_nop 0
  buffer_load_dwordx4 v144, s[8:11], s17 offen lds
  s_add_u32 s17, s17, s29
  s_add_u32 m0, s28, 18432
  s_nop 0
  buffer_load_dwordx4 v144, s[8:11], s17 offen lds
  s_add_u32 s17, s17, s29
  s_add_u32 m0, s28, 19456
  s_nop 0
  buffer_load_dwordx4 v144, s[8:11], s17 offen lds
  s_add_u32 s17, s17, s29
  s_add_u32 m0, s28, 20480
  s_nop 0
  buffer_load_dwordx4 v144, s[8:11], s17 offen lds
  s_add_u32 s17, s17, s29
  s_add_u32 m0, s28, 21504
  s_nop 0
  buffer_load_dwordx4 v144, s[8:11], s17 offen lds
  s_add_u32 s17, s17, s29
  s_add_u32 m0, s28, 22528
  s_nop 0
  buffer_load_dwordx4 v144, s[8:11], s17 offen lds
  s_add_u32 s17, s17, s29
  s_add_u32 m0, s28, 23552
  s_nop 0
  buffer_load_dwordx4 v144, s[8:11], s17 offen lds
  s_add_u32 s17, s17, s29
  s_add_u32 m0, s28, 24576
  s_nop 0
  buffer_load_dwordx4 v144, s[8:11], s17 offen lds
  s_add_u32 s17, s17, s29
  s_add_u32 m0, s28, 25600
  s_nop 0
  buffer_load_dwordx4 v144, s[8:11], s17 offen lds
  s_add_u32 s17, s17, s29
  s_add_u32 m0, s28, 26624
  s_nop 0
  buffer_load_dwordx4 v144, s[8:11], s17 offen lds
  s_add_u32 s17, s17, s29
  s_add_u32 m0, s28, 27648
  s_nop 0
  buffer_load_dwordx4 v144, s[8:11], s17 offen lds
  s_add_u32 s17, s17, s29
  s_add_u32 m0, s28, 28672
  s_nop 0
  buffer_load_dwordx4 v144, s[8:11], s17 offen lds
  s_add_u32 s17, s17, s29
  s_add_u32 m0, s28, 29696
  s_nop 0
  buffer_load_dwordx4 v144, s[8:11], s17 offen lds
  s_add_u32 s17, s17, s29
  s_add_u32 m0, s28, 30720
  s_nop 0
  buffer_load_dwordx4 v144, s[8:11], s17 offen lds
  s_add_u32 s17, s17, s29
  s_add_u32 m0, s28, 31744
  s_nop 0
  buffer_load_dwordx4 v144, s[8:11], s17 offen lds
  s_add_u32 s17, s17, s29
  v_bfe_u32 v148, v1, 2, 2
  v_lshrrev_b32 v149, 5, v1
  v_lshl_add_u32 v148, v149, 4, v148
  v_bfe_u32 v149, v1, 4, 1
  v_lshl_add_u32 v148, v149, 2, v148
  v_and_b32 v149, 3, v1
  v_lshlrev_b32 v149, 4, v149
  s_mov_b32 s26, 8
  v_lshl_add_u32 v148, v148, 7, v149
  v_add_u32 v152, s28, v148
  v_add_u32 v153, 1024, v152
  v_add_u32 v154, s26, v152
  v_add_u32 v155, s26, v153
  s_waitcnt vmcnt(28)
  ds_read_b64_tr_b16 a[0:1], v152 offset:0
  ds_read_b64_tr_b16 a[2:3], v153 offset:0
  ds_read_b64_tr_b16 a[4:5], v154 offset:0
  ds_read_b64_tr_b16 a[6:7], v155 offset:0
  ds_read_b64_tr_b16 a[8:9], v152 offset:64
  ds_read_b64_tr_b16 a[10:11], v153 offset:64
  ds_read_b64_tr_b16 a[12:13], v154 offset:64
  ds_read_b64_tr_b16 a[14:15], v155 offset:64
  s_waitcnt lgkmcnt(0)
  s_add_u32 m0, s28, 0
  s_nop 0
  buffer_load_dwordx4 v144, s[8:11], s17 offen lds
  s_add_u32 s17, s17, s29
  s_add_u32 m0, s28, 1024
  s_nop 0
  buffer_load_dwordx4 v144, s[8:11], s17 offen lds
  s_add_u32 s17, s17, s29
  s_add_u32 m0, s28, 2048
  s_nop 0
  buffer_load_dwordx4 v144, s[8:11], s17 offen lds
  s_add_u32 s17, s17, s29
  s_add_u32 m0, s28, 3072
  s_nop 0
  buffer_load_dwordx4 v144, s[8:11], s17 offen lds
  s_add_u32 s17, s17, s29
  s_waitcnt vmcnt(28)
  ds_read_b64_tr_b16 a[16:17], v152 offset:4096
  ds_read_b64_tr_b16 a[18:19], v153 offset:4096
  ds_read_b64_tr_b16 a[20:21], v154 offset:4096
  ds_read_b64_tr_b16 a[22:23], v155 offset:4096
  ds_read_b64_tr_b16 a[24:25], v152 offset:4160
  ds_read_b64_tr_b16 a[26:27], v153 offset:4160
  ds_read_b64_tr_b16 a[28:29], v154 offset:4160
  ds_read_b64_tr_b16 a[30:31], v155 offset:4160
  s_waitcnt lgkmcnt(0)
  s_add_u32 m0, s28, 4096
  s_nop 0
  buffer_load_dwordx4 v144, s[8:11], s17 offen lds
  s_add_u32 s17, s17, s29
  s_add_u32 m0, s28, 5120
  s_nop 0
  buffer_load_dwordx4 v144, s[8:11], s17 offen lds
  s_add_u32 s17, s17, s29
  s_add_u32 m0, s28, 6144
  s_nop 0
  buffer_load_dwordx4 v144, s[8:11], s17 offen lds
  s_add_u32 s17, s17, s29
  s_add_u32 m0, s28, 7168
  s_nop 0
  buffer_load_dwordx4 v144, s[8:11], s17 offen lds
  s_add_u32 s17, s17, s29
  s_waitcnt vmcnt(28)
  ds_read_b64_tr_b16 a[32:33], v152 offset:8192
  ds_read_b64_tr_b16 a[34:35], v153 offset:8192
  ds_read_b64_tr_b16 a[36:37], v154 offset:8192
  ds_read_b64_tr_b16 a[38:39], v155 offset:8192
  ds_read_b64_tr_b16 a[40:41], v152 offset:8256
  ds_read_b64_tr_b16 a[42:43], v153 offset:8256
  ds_read_b64_tr_b16 a[44:45], v154 offset:8256
  ds_read_b64_tr_b16 a[46:47], v155 offset:8256
  s_waitcnt lgkmcnt(0)
  s_add_u32 m0, s28, 8192
  s_nop 0
  buffer_load_dwordx4 v144, s[8:11], s17 offen lds
  s_add_u32 s17, s17, s29
  s_add_u32 m0, s28, 9216
  s_nop 0
  buffer_load_dwordx4 v144, s[8:11], s17 offen lds
  s_add_u32 s17, s17, s29
  s_add_u32 m0, s28, 10240
  s_nop 0
  buffer_load_dwordx4 v144, s[8:11], s17 offen lds
  s_add_u32 s17, s17, s29
  s_add_u32 m0, s28, 11264
  s_nop 0
  buffer_load_dwordx4 v144, s[8:11], s17 offen lds
  s_add_u32 s17, s17, s29
  s_waitcnt vmcnt(28)
  ds_read_b64_tr_b16 a[48:49], v152 offset:12288
  ds_read_b64_tr_b16 a[50:51], v153 offset:12288
  ds_read_b64_tr_b16 a[52:53], v154 offset:12288
  ds_read_b64_tr_b16 a[54:55], v155 offset:12288
  ds_read_b64_tr_b16 a[56:57], v152 offset:12352
  ds_read_b64_tr_b16 a[58:59], v153 offset:12352
  ds_read_b64_tr_b16 a[60:61], v154 offset:12352
  ds_read_b64_tr_b16 a[62:63], v155 offset:12352
  s_waitcnt lgkmcnt(0)
  s_add_u32 m0, s28, 12288
  s_nop 0
  buffer_load_dwordx4 v144, s[8:11], s17 offen lds
  s_add_u32 s17, s17, s29
  s_add_u32 m0, s28, 13312
  s_nop 0
  buffer_load_dwordx4 v144, s[8:11], s17 offen lds
  s_add_u32 s17, s17, s29
  s_add_u32 m0, s28, 14336
  s_nop 0
  buffer_load_dwordx4 v144, s[8:11], s17 offen lds
  s_add_u32 s17, s17, s29
  s_add_u32 m0, s28, 15360
  s_nop 0
  buffer_load_dwordx4 v144, s[8:11], s17 offen lds
  s_add_u32 s17, s17, s29
  s_waitcnt vmcnt(28)
  ds_read_b64_tr_b16 a[64:65], v152 offset:16384
  ds_read_b64_tr_b16 a[66:67], v153 offset:16384
  ds_read_b64_tr_b16 a[68:69], v154 offset:16384
  ds_read_b64_tr_b16 a[70:71], v155 offset:16384
  ds_read_b64_tr_b16 a[72:73], v152 offset:16448
  ds_read_b64_tr_b16 a[74:75], v153 offset:16448
  ds_read_b64_tr_b16 a[76:77], v154 offset:16448
  ds_read_b64_tr_b16 a[78:79], v155 offset:16448
  s_waitcnt lgkmcnt(0)
  s_add_u32 m0, s28, 16384
  s_nop 0
  buffer_load_dwordx4 v144, s[8:11], s17 offen lds
  s_add_u32 s17, s17, s29
  s_add_u32 m0, s28, 17408
  s_nop 0
  buffer_load_dwordx4 v144, s[8:11], s17 offen lds
  s_add_u32 s17, s17, s29
  s_add_u32 m0, s28, 18432
  s_nop 0
  buffer_load_dwordx4 v144, s[8:11], s17 offen lds
  s_add_u32 s17, s17, s29
  s_add_u32 m0, s28, 19456
  s_nop 0
  buffer_load_dwordx4 v144, s[8:11], s17 offen lds
  s_add_u32 s17, s17, s29
  s_waitcnt vmcnt(28)
  ds_read_b64_tr_b16 a[80:81], v152 offset:20480
  ds_read_b64_tr_b16 a[82:83], v153 offset:20480
  ds_read_b64_tr_b16 a[84:85], v154 offset:20480
  ds_read_b64_tr_b16 a[86:87], v155 offset:20480
  ds_read_b64_tr_b16 a[88:89], v152 offset:20544
  ds_read_b64_tr_b16 a[90:91], v153 offset:20544
  ds_read_b64_tr_b16 a[92:93], v154 offset:20544
  ds_read_b64_tr_b16 a[94:95], v155 offset:20544
  s_waitcnt lgkmcnt(0)
  s_add_u32 m0, s28, 20480
  s_nop 0
  buffer_load_dwordx4 v144, s[8:11], s17 offen lds
  s_add_u32 s17, s17, s29
  s_add_u32 m0, s28, 21504
  s_nop 0
  buffer_load_dwordx4 v144, s[8:11], s17 offen lds
  s_add_u32 s17, s17, s29
  s_add_u32 m0, s28, 22528
  s_nop 0
  buffer_load_dwordx4 v144, s[8:11], s17 offen lds
  s_add_u32 s17, s17, s29
  s_add_u32 m0, s28, 23552
  s_nop 0
  buffer_load_dwordx4 v144, s[8:11], s17 offen lds
  s_add_u32 s17, s17, s29
  s_waitcnt vmcnt(28)
  ds_read_b64_tr_b16 a[96:97], v152 offset:24576
  ds_read_b64_tr_b16 a[98:99], v153 offset:24576
  ds_read_b64_tr_b16 a[100:101], v154 offset:24576
  ds_read_b64_tr_b16 a[102:103], v155 offset:24576
  ds_read_b64_tr_b16 a[104:105], v152 offset:24640
  ds_read_b64_tr_b16 a[106:107], v153 offset:24640
  ds_read_b64_tr_b16 a[108:109], v154 offset:24640
  ds_read_b64_tr_b16 a[110:111], v155 offset:24640
  s_waitcnt lgkmcnt(0)
  s_add_u32 m0, s28, 24576
  s_nop 0
  buffer_load_dwordx4 v144, s[8:11], s17 offen lds
  s_add_u32 s17, s17, s29
  s_add_u32 m0, s28, 25600
  s_nop 0
  buffer_load_dwordx4 v144, s[8:11], s17 offen lds
  s_add_u32 s17, s17, s29
  s_add_u32 m0, s28, 26624
  s_nop 0
  buffer_load_dwordx4 v144, s[8:11], s17 offen lds
  s_add_u32 s17, s17, s29
  s_add_u32 m0, s28, 27648
  s_nop 0
  buffer_load_dwordx4 v144, s[8:11], s17 offen lds
  s_add_u32 s17, s17, s29
  s_waitcnt vmcnt(28)
  ds_read_b64_tr_b16 a[112:113], v152 offset:28672
  ds_read_b64_tr_b16 a[114:115], v153 offset:28672
  ds_read_b64_tr_b16 a[116:117], v154 offset:28672
  ds_read_b64_tr_b16 a[118:119], v155 offset:28672
  ds_read_b64_tr_b16 a[120:121], v152 offset:28736
  ds_read_b64_tr_b16 a[122:123], v153 offset:28736
  ds_read_b64_tr_b16 a[124:125], v154 offset:28736
  ds_read_b64_tr_b16 a[126:127], v155 offset:28736
  s_waitcnt lgkmcnt(0)
  s_add_u32 m0, s28, 28672
  s_nop 0
  buffer_load_dwordx4 v144, s[8:11], s17 offen lds
  s_add_u32 s17, s17, s29
  s_add_u32 m0, s28, 29696
  s_nop 0
  buffer_load_dwordx4 v144, s[8:11], s17 offen lds
  s_add_u32 s17, s17, s29
  s_add_u32 m0, s28, 30720
  s_nop 0
  buffer_load_dwordx4 v144, s[8:11], s17 offen lds
  s_add_u32 s17, s17, s29
  s_add_u32 m0, s28, 31744
  s_nop 0
  buffer_load_dwordx4 v144, s[8:11], s17 offen lds
  s_add_u32 s17, s17, s29
  s_waitcnt vmcnt(28)
  ds_read_b64_tr_b16 a[128:129], v152 offset:0
  ds_read_b64_tr_b16 a[130:131], v153 offset:0
  ds_read_b64_tr_b16 a[132:133], v154 offset:0
  ds_read_b64_tr_b16 a[134:135], v155 offset:0
  ds_read_b64_tr_b16 a[136:137], v152 offset:64
  ds_read_b64_tr_b16 a[138:139], v153 offset:64
  ds_read_b64_tr_b16 a[140:141], v154 offset:64
  ds_read_b64_tr_b16 a[142:143], v155 offset:64
  s_waitcnt lgkmcnt(0)
  s_waitcnt vmcnt(24)
  ds_read_b64_tr_b16 a[144:145], v152 offset:4096
  ds_read_b64_tr_b16 a[146:147], v153 offset:4096
  ds_read_b64_tr_b16 a[148:149], v154 offset:4096
  ds_read_b64_tr_b16 a[150:151], v155 offset:4096
  ds_read_b64_tr_b16 a[152:153], v152 offset:4160
  ds_read_b64_tr_b16 a[154:155], v153 offset:4160
  ds_read_b64_tr_b16 a[156:157], v154 offset:4160
  ds_read_b64_tr_b16 a[158:159], v155 offset:4160
  s_waitcnt lgkmcnt(0)
  s_waitcnt vmcnt(20)
  ds_read_b64_tr_b16 a[160:161], v152 offset:8192
  ds_read_b64_tr_b16 a[162:163], v153 offset:8192
  ds_read_b64_tr_b16 a[164:165], v154 offset:8192
  ds_read_b64_tr_b16 a[166:167], v155 offset:8192
  ds_read_b64_tr_b16 a[168:169], v152 offset:8256
  ds_read_b64_tr_b16 a[170:171], v153 offset:8256
  ds_read_b64_tr_b16 a[172:173], v154 offset:8256
  ds_read_b64_tr_b16 a[174:175], v155 offset:8256
  s_waitcnt lgkmcnt(0)
  s_waitcnt vmcnt(16)
  ds_read_b64_tr_b16 a[176:177], v152 offset:12288
  ds_read_b64_tr_b16 a[178:179], v153 offset:12288
  ds_read_b64_tr_b16 a[180:181], v154 offset:12288
  ds_read_b64_tr_b16 a[182:183], v155 offset:12288
  ds_read_b64_tr_b16 a[184:185], v152 offset:12352
  ds_read_b64_tr_b16 a[186:187], v153 offset:12352
  ds_read_b64_tr_b16 a[188:189], v154 offset:12352
  ds_read_b64_tr_b16 a[190:191], v155 offset:12352
  s_waitcnt lgkmcnt(0)
  s_waitcnt vmcnt(12)
  ds_read_b64_tr_b16 a[192:193], v152 offset:16384
  ds_read_b64_tr_b16 a[194:195], v153 offset:16384
  ds_read_b64_tr_b16 a[196:197], v154 offset:16384
  ds_read_b64_tr_b16 a[198:199], v155 offset:16384
  ds_read_b64_tr_b16 a[200:201], v152 offset:16448
  ds_read_b64_tr_b16 a[202:203], v153 offset:16448
  ds_read_b64_tr_b16 a[204:205], v154 offset:16448
  ds_read_b64_tr_b16 a[206:207], v155 offset:16448
  s_waitcnt lgkmcnt(0)
  s_waitcnt vmcnt(8)
  ds_read_b64_tr_b16 a[208:209], v152 offset:20480
  ds_read_b64_tr_b16 a[210:211], v153 offset:20480
  ds_read_b64_tr_b16 a[212:213], v154 offset:20480
  ds_read_b64_tr_b16 a[214:215], v155 offset:20480
  ds_read_b64_tr_b16 a[216:217], v152 offset:20544
  ds_read_b64_tr_b16 a[218:219], v153 offset:20544
  ds_read_b64_tr_b16 a[220:221], v154 offset:20544
  ds_read_b64_tr_b16 a[222:223], v155 offset:20544
  s_waitcnt lgkmcnt(0)
  s_waitcnt vmcnt(4)
  ds_read_b64_tr_b16 a[224:225], v152 offset:24576
  ds_read_b64_tr_b16 a[226:227], v153 offset:24576
  ds_read_b64_tr_b16 a[228:229], v154 offset:24576
  ds_read_b64_tr_b16 a[230:231], v155 offset:24576
  ds_read_b64_tr_b16 a[232:233], v152 offset:24640
  ds_read_b64_tr_b16 a[234:235], v153 offset:24640
  ds_read_b64_tr_b16 a[236:237], v154 offset:24640
  ds_read_b64_tr_b16 a[238:239], v155 offset:24640
  s_waitcnt lgkmcnt(0)
  s_waitcnt vmcnt(0)
  ds_read_b64_tr_b16 a[240:241], v152 offset:28672
  ds_read_b64_tr_b16 a[242:243], v153 offset:28672
  ds_read_b64_tr_b16 a[244:245], v154 offset:28672
  ds_read_b64_tr_b16 a[246:247], v155 offset:28672
  ds_read_b64_tr_b16 a[248:249], v152 offset:28736
  ds_read_b64_tr_b16 a[250:251], v153 offset:28736
  ds_read_b64_tr_b16 a[252:253], v154 offset:28736
  ds_read_b64_tr_b16 a[254:255], v155 offset:28736
  s_waitcnt lgkmcnt(0)
  v_min_u32 v4, 27, v1
  v_mul_u32_u24 v5, 37, v4
  v_lshrrev_b32 v5, 8, v5
  v_mul_u32_u24 v5, 7, v5
  v_sub_u32 v5, v4, v5
  v_mov_b32 v6, 0x200
  v_cmp_ne_u32 vcc, 6, v5
  s_mul_i32 s76, s48, 3584
  s_add_u32 s76, s76, 148897792
  v_cndmask_b32 v5, 0, v6, vcc
  v_lshl_add_u32 v4, v4, 7, s76
  s_mov_b32 s71, 0
  s_branch M_vg_218
M_vw_217:
  s_sleep 2
  s_add_u32 s71, s71, 1
  s_cmp_gt_u32 s71, 262144
  s_cbranch_scc1 M_exit
M_vg_218:
  buffer_load_dword v6, v4, s[4:7], 0 offen sc1
  s_waitcnt vmcnt(0)
  v_cmp_lt_u32 vcc, v6, v5
  s_cbranch_vccnz M_vw_217
  s_barrier
  s_lshl_b32 s25, s16, 13
  s_add_u32 m0, s25, 0
  s_nop 0
  buffer_load_dwordx4 v16, s[12:15], s19 offen sc1 lds
  s_add_u32 m0, s25, 1024
  s_nop 0
  buffer_load_dwordx4 v17, s[12:15], s19 offen sc1 lds
  s_add_u32 m0, s25, 2048
  s_nop 0
  buffer_load_dwordx4 v18, s[12:15], s19 offen sc1 lds
  s_add_u32 m0, s25, 3072
  s_nop 0
  buffer_load_dwordx4 v19, s[12:15], s19 offen sc1 lds
  s_add_u32 m0, s25, 4096
  s_nop 0
  buffer_load_dwordx4 v20, s[12:15], s19 offen sc1 lds
  s_add_u32 m0, s25, 5120
  s_nop 0
  buffer_load_dwordx4 v21, s[12:15], s19 offen sc1 lds
  s_add_u32 m0, s25, 6144
  s_nop 0
  buffer_load_dwordx4 v22, s[12:15], s19 offen sc1 lds
  s_add_u32 m0, s25, 7168
  s_nop 0
  buffer_load_dwordx4 v23, s[12:15], s19 offen sc1 lds
  s_cmp_gt_u32 s23, 1
  s_cselect_b32 s26, s20, 0
  s_add_u32 s19, s19, s26
  s_add_u32 s25, s25, 32768
  s_and_b32 s25, s25, 0x1ffff
  s_add_u32 m0, s25, 0
  s_nop 0
  buffer_load_dwordx4 v16, s[12:15], s19 offen sc1 lds
  s_add_u32 m0, s25, 1024
  s_nop 0
  buffer_load_dwordx4 v17, s[12:15], s19 offen sc1 lds
  s_add_u32 m0, s25, 2048
  s_nop 0
  buffer_load_dwordx4 v18, s[12:15], s19 offen sc1 lds
  s_add_u32 m0, s25, 3072
  s_nop 0
  buffer_load_dwordx4 v19, s[12:15], s19 offen sc1 lds
  s_add_u32 m0, s25, 4096
  s_nop 0
  buffer_load_dwordx4 v20, s[12:15], s19 offen sc1 lds
  s_add_u32 m0, s25, 5120
  s_nop 0
  buffer_load_dwordx4 v21, s[12:15], s19 offen sc1 lds
  s_add_u32 m0, s25, 6144
  s_nop 0
  buffer_load_dwordx4 v22, s[12:15], s19 offen sc1 lds
  s_add_u32 m0, s25, 7168
  s_nop 0
  buffer_load_dwordx4 v23, s[12:15], s19 offen sc1 lds
  s_cmp_gt_u32 s23, 2
  s_cselect_b32 s26, s20, 0
  s_add_u32 s19, s19, s26
  s_add_u32 s25, s25, 32768
  s_and_b32 s25, s25, 0x1ffff
  s_waitcnt vmcnt(0)
  s_barrier
  s_mov_b32 s27, s21
  v_mov_b32 v7, 0x40000000
  ds_read_b128 v[24:27], v8 offset:0
  ds_read_b128 v[28:31], v9 offset:0
  ds_read_b128 v[32:35], v10 offset:0
  ds_read_b128 v[36:39], v11 offset:0
  ds_read_b128 v[40:43], v12 offset:0
  ds_read_b128 v[44:47], v13 offset:0
.p2align 6
G_top_219:
  s_waitcnt lgkmcnt(5)
  v_mfma_f32_16x16x32_bf16 v[64:67], a[0:3], v[24:27], 0
  s_add_u32 m0, s25, 0
  ds_read_b128 v[48:51], v14 offset:0
  v_mfma_f32_16x16x32_bf16 v[68:71], a[4:7], v[24:27], 0
  v_mfma_f32_16x16x32_bf16 v[80:83], a[8:11], v[24:27], 0
  buffer_load_dwordx4 v16, s[12:15], s19 offen sc1 lds
  v_mfma_f32_16x16x32_bf16 v[84:87], a[12:15], v[24:27], 0
  s_waitcnt lgkmcnt(5)
  v_mfma_f32_16x16x32_bf16 v[72:75], a[0:3], v[28:31], 0
  ds_read_b128 v[52:55], v15 offset:0
  v_mfma_f32_16x16x32_bf16 v[76:79], a[4:7], v[28:31], 0
  v_cvt_pk_bf16_f32 v128, v96, v97
  v_cvt_pk_bf16_f32 v129, v98, v99
  v_mfma_f32_16x16x32_bf16 v[88:91], a[8:11], v[28:31], 0
  v_mfma_f32_16x16x32_bf16 v[92:95], a[12:15], v[28:31], 0
  s_waitcnt lgkmcnt(5)
  v_cvt_pk_bf16_f32 v130, v100, v101
  v_cvt_pk_bf16_f32 v131, v102, v103
  v_mfma_f32_16x16x32_bf16 v[64:67], a[16:19], v[32:35], v[64:67]
  s_add_u32 m0, s25, 1024
  ds_read_b128 v[24:27], v8 offset:8192
  v_mfma_f32_16x16x32_bf16 v[68:71], a[20:23], v[32:35], v[68:71]
  v_mfma_f32_16x16x32_bf16 v[80:83], a[24:27], v[32:35], v[80:83]
  buffer_load_dwordx4 v17, s[12:15], s19 offen sc1 lds
  v_mfma_f32_16x16x32_bf16 v[84:87], a[28:31], v[32:35], v[84:87]
  s_waitcnt lgkmcnt(5)
  v_mfma_f32_16x16x32_bf16 v[72:75], a[16:19], v[36:39], v[72:75]
  ds_read_b128 v[28:31], v9 offset:8192
  v_mfma_f32_16x16x32_bf16 v[76:79], a[20:23], v[36:39], v[76:79]
  v_mfma_f32_16x16x32_bf16 v[88:91], a[24:27], v[36:39], v[88:91]
  v_mfma_f32_16x16x32_bf16 v[92:95], a[28:31], v[36:39], v[92:95]
  s_waitcnt lgkmcnt(5)
  v_mfma_f32_16x16x32_bf16 v[64:67], a[32:35], v[40:43], v[64:67]
  s_add_u32 m0, s25, 2048
  ds_read_b128 v[32:35], v10 offset:8192
  v_mfma_f32_16x16x32_bf16 v[68:71], a[36:39], v[40:43], v[68:71]
  v_cvt_pk_bf16_f32 v132, v104, v105
  v_cvt_pk_bf16_f32 v133, v106, v107
  v_mfma_f32_16x16x32_bf16 v[80:83], a[40:43], v[40:43], v[80:83]
  buffer_load_dwordx4 v18, s[12:15], s19 offen sc1 lds
  v_mfma_f32_16x16x32_bf16 v[84:87], a[44:47], v[40:43], v[84:87]
  s_waitcnt lgkmcnt(5)
  v_cvt_pk_bf16_f32 v134, v108, v109
  v_cvt_pk_bf16_f32 v135, v110, v111
  v_mfma_f32_16x16x32_bf16 v[72:75], a[32:35], v[44:47], v[72:75]
  ds_read_b128 v[36:39], v11 offset:8192
  v_mfma_f32_16x16x32_bf16 v[76:79], a[36:39], v[44:47], v[76:79]
  v_mfma_f32_16x16x32_bf16 v[88:91], a[40:43], v[44:47], v[88:91]
  v_mfma_f32_16x16x32_bf16 v[92:95], a[44:47], v[44:47], v[92:95]
  s_waitcnt lgkmcnt(5)
  v_mfma_f32_16x16x32_bf16 v[64:67], a[48:51], v[48:51], v[64:67]
  s_add_u32 m0, s25, 3072
  ds_read_b128 v[40:43], v12 offset:8192
  v_mfma_f32_16x16x32_bf16 v[68:71], a[52:55], v[48:51], v[68:71]
  v_mfma_f32_16x16x32_bf16 v[80:83], a[56:59], v[48:51], v[80:83]
  buffer_load_dwordx4 v19, s[12:15], s19 offen sc1 lds
  v_mfma_f32_16x16x32_bf16 v[84:87], a[60:63], v[48:51], v[84:87]
  s_waitcnt lgkmcnt(5)
  v_mfma_f32_16x16x32_bf16 v[72:75], a[48:51], v[52:55], v[72:75]
  ds_read_b128 v[44:47], v13 offset:8192
  v_mfma_f32_16x16x32_bf16 v[76:79], a[52:55], v[52:55], v[76:79]
  v_cvt_pk_bf16_f32 v136, v112, v113
  v_cvt_pk_bf16_f32 v137, v114, v115
  v_mfma_f32_16x16x32_bf16 v[88:91], a[56:59], v[52:55], v[88:91]
  v_mfma_f32_16x16x32_bf16 v[92:95], a[60:63], v[52:55], v[92:95]
  s_waitcnt lgkmcnt(5)
  v_cvt_pk_bf16_f32 v138, v116, v117
  v_cvt_pk_bf16_f32 v139, v118, v119
  v_mfma_f32_16x16x32_bf16 v[64:67], a[64:67], v[24:27], v[64:67]
  s_add_u32 m0, s25, 4096
  ds_read_b128 v[48:51], v14 offset:8192
  v_mfma_f32_16x16x32_bf16 v[68:71], a[68:71], v[24:27], v[68:71]
  v_mfma_f32_16x16x32_bf16 v[80:83], a[72:75], v[24:27], v[80:83]
  buffer_load_dwordx4 v20, s[12:15], s19 offen sc1 lds
  v_mfma_f32_16x16x32_bf16 v[84:87], a[76:79], v[24:27], v[84:87]
  s_waitcnt lgkmcnt(5)
  v_mfma_f32_16x16x32_bf16 v[72:75], a[64:67], v[28:31], v[72:75]
  ds_read_b128 v[52:55], v15 offset:8192
  v_mfma_f32_16x16x32_bf16 v[76:79], a[68:71], v[28:31], v[76:79]
  v_mfma_f32_16x16x32_bf16 v[88:91], a[72:75], v[28:31], v[88:91]
  v_mfma_f32_16x16x32_bf16 v[92:95], a[76:79], v[28:31], v[92:95]
  s_waitcnt lgkmcnt(5)
  v_mfma_f32_16x16x32_bf16 v[64:67], a[80:83], v[32:35], v[64:67]
  s_add_u32 m0, s25, 5120
  ds_read_b128 v[24:27], v8 offset:16384
  v_mfma_f32_16x16x32_bf16 v[68:71], a[84:87], v[32:35], v[68:71]
  v_cvt_pk_bf16_f32 v140, v120, v121
  v_cvt_pk_bf16_f32 v141, v122, v123
  v_mfma_f32_16x16x32_bf16 v[80:83], a[88:91], v[32:35], v[80:83]
  buffer_load_dwordx4 v21, s[12:15], s19 offen sc1 lds
  v_mfma_f32_16x16x32_bf16 v[84:87], a[92:95], v[32:35], v[84:87]
  s_waitcnt lgkmcnt(5)
  v_cvt_pk_bf16_f32 v142, v124, v125
  v_cvt_pk_bf16_f32 v143, v126, v127
  v_mfma_f32_16x16x32_bf16 v[72:75], a[80:83], v[36:39], v[72:75]
  ds_read_b128 v[28:31], v9 offset:16384
  v_mfma_f32_16x16x32_bf16 v[76:79], a[84:87], v[36:39], v[76:79]
  v_mfma_f32_16x16x32_bf16 v[88:91], a[88:91], v[36:39], v[88:91]
  v_mfma_f32_16x16x32_bf16 v[92:95], a[92:95], v[36:39], v[92:95]
  s_waitcnt lgkmcnt(5)
  v_mfma_f32_16x16x32_bf16 v[64:67], a[96:99], v[40:43], v[64:67]
  s_add_u32 m0, s25, 6144
  ds_read_b128 v[32:35], v10 offset:16384
  v_mfma_f32_16x16x32_bf16 v[68:71], a[100:103], v[40:43], v[68:71]
  v_mfma_f32_16x16x32_bf16 v[80:83], a[104:107], v[40:43], v[80:83]
  buffer_load_dwordx4 v22, s[12:15], s19 offen sc1 lds
  v_mfma_f32_16x16x32_bf16 v[84:87], a[108:111], v[40:43], v[84:87]
  s_waitcnt lgkmcnt(5)
  v_mfma_f32_16x16x32_bf16 v[72:75], a[96:99], v[44:47], v[72:75]
  ds_read_b128 v[36:39], v11 offset:16384
  v_mfma_f32_16x16x32_bf16 v[76:79], a[100:103], v[44:47], v[76:79]
  v_mfma_f32_16x16x32_bf16 v[88:91], a[104:107], v[44:47], v[88:91]
  v_mfma_f32_16x16x32_bf16 v[92:95], a[108:111], v[44:47], v[92:95]
  s_waitcnt lgkmcnt(5)
  v_mfma_f32_16x16x32_bf16 v[64:67], a[112:115], v[48:51], v[64:67]
  s_add_u32 m0, s25, 7168
  ds_read_b128 v[40:43], v12 offset:16384
  v_mfma_f32_16x16x32_bf16 v[68:71], a[116:119], v[48:51], v[68:71]
  v_mfma_f32_16x16x32_bf16 v[80:83], a[120:123], v[48:51], v[80:83]
  buffer_load_dwordx4 v23, s[12:15], s19 offen sc1 lds
  v_mfma_f32_16x16x32_bf16 v[84:87], a[124:127], v[48:51], v[84:87]
  s_waitcnt lgkmcnt(5)
  v_mfma_f32_16x16x32_bf16 v[72:75], a[112:115], v[52:55], v[72:75]
  s_cmp_gt_u32 s23, 3
  ds_read_b128 v[44:47], v13 offset:16384
  v_mfma_f32_16x16x32_bf16 v[76:79], a[116:119], v[52:55], v[76:79]
  v_mfma_f32_16x16x32_bf16 v[88:91], a[120:123], v[52:55], v[88:91]
  s_cselect_b32 s26, s20, 0
  v_mfma_f32_16x16x32_bf16 v[92:95], a[124:127], v[52:55], v[92:95]
  s_waitcnt lgkmcnt(5)
  v_mfma_f32_16x16x32_bf16 v[64:67], a[128:131], v[24:27], v[64:67]
  s_add_u32 s19, s19, s26
  ds_read_b128 v[48:51], v14 offset:16384
  v_mfma_f32_16x16x32_bf16 v[68:71], a[132:135], v[24:27], v[68:71]
  v_mfma_f32_16x16x32_bf16 v[80:83], a[136:139], v[24:27], v[80:83]
  s_add_u32 s25, s25, 32768
  v_mfma_f32_16x16x32_bf16 v[84:87], a[140:143], v[24:27], v[84:87]
  s_waitcnt lgkmcnt(5)
  v_mfma_f32_16x16x32_bf16 v[72:75], a[128:131], v[28:31], v[72:75]
  s_and_b32 s25, s25, 0x1ffff
  ds_read_b128 v[52:55], v15 offset:16384
  v_mfma_f32_16x16x32_bf16 v[76:79], a[132:135], v[28:31], v[76:79]
  v_mfma_f32_16x16x32_bf16 v[88:91], a[136:139], v[28:31], v[88:91]
  buffer_store_dwordx4 v[128:131], v7, s[4:7], s21 offen offset:0 sc1
  v_mfma_f32_16x16x32_bf16 v[92:95], a[140:143], v[28:31], v[92:95]
  s_waitcnt lgkmcnt(5)
  v_mfma_f32_16x16x32_bf16 v[64:67], a[144:147], v[32:35], v[64:67]
  ds_read_b128 v[24:27], v8 offset:24576
  v_mfma_f32_16x16x32_bf16 v[68:71], a[148:151], v[32:35], v[68:71]
  v_mfma_f32_16x16x32_bf16 v[80:83], a[152:155], v[32:35], v[80:83]
  v_mfma_f32_16x16x32_bf16 v[84:87], a[156:159], v[32:35], v[84:87]
  s_waitcnt lgkmcnt(5)
  v_mfma_f32_16x16x32_bf16 v[72:75], a[144:147], v[36:39], v[72:75]
  ds_read_b128 v[28:31], v9 offset:24576
  v_mfma_f32_16x16x32_bf16 v[76:79], a[148:151], v[36:39], v[76:79]
  v_mfma_f32_16x16x32_bf16 v[88:91], a[152:155], v[36:39], v[88:91]
  buffer_store_dwordx4 v[132:135], v7, s[4:7], s21 offen offset:256 sc1
  v_mfma_f32_16x16x32_bf16 v[92:95], a[156:159], v[36:39], v[92:95]
  s_waitcnt lgkmcnt(5)
  v_mfma_f32_16x16x32_bf16 v[64:67], a[160:163], v[40:43], v[64:67]
  ds_read_b128 v[32:35], v10 offset:24576
  v_mfma_f32_16x16x32_bf16 v[68:71], a[164:167], v[40:43], v[68:71]
  v_mfma_f32_16x16x32_bf16 v[80:83], a[168:171], v[40:43], v[80:83]
  v_mfma_f32_16x16x32_bf16 v[84:87], a[172:175], v[40:43], v[84:87]
  s_waitcnt lgkmcnt(5)
  v_mfma_f32_16x16x32_bf16 v[72:75], a[160:163], v[44:47], v[72:75]
  ds_read_b128 v[36:39], v11 offset:24576
  v_mfma_f32_16x16x32_bf16 v[76:79], a[164:167], v[44:47], v[76:79]
  v_mfma_f32_16x16x32_bf16 v[88:91], a[168:171], v[44:47], v[88:91]
  buffer_store_dwordx4 v[136:139], v7, s[4:7], s21 offen offset:2048 sc1
  v_mfma_f32_16x16x32_bf16 v[92:95], a[172:175], v[44:47], v[92:95]
  s_waitcnt lgkmcnt(5)
  v_mfma_f32_16x16x32_bf16 v[64:67], a[176:179], v[48:51], v[64:67]
  ds_read_b128 v[40:43], v12 offset:24576
  v_mfma_f32_16x16x32_bf16 v[68:71], a[180:183], v[48:51], v[68:71]
  v_mfma_f32_16x16x32_bf16 v[80:83], a[184:187], v[48:51], v[80:83]
  v_mfma_f32_16x16x32_bf16 v[84:87], a[188:191], v[48:51], v[84:87]
  s_waitcnt lgkmcnt(5)
  v_mfma_f32_16x16x32_bf16 v[72:75], a[176:179], v[52:55], v[72:75]
  ds_read_b128 v[44:47], v13 offset:24576
  v_mfma_f32_16x16x32_bf16 v[76:79], a[180:183], v[52:55], v[76:79]
  v_mfma_f32_16x16x32_bf16 v[88:91], a[184:187], v[52:55], v[88:91]
  buffer_store_dwordx4 v[140:143], v7, s[4:7], s21 offen offset:2304 sc1
  v_mfma_f32_16x16x32_bf16 v[92:95], a[188:191], v[52:55], v[92:95]
  s_waitcnt lgkmcnt(5)
  v_mfma_f32_16x16x32_bf16 v[64:67], a[192:195], v[24:27], v[64:67]
  s_mov_b32 s21, s27
  ds_read_b128 v[48:51], v14 offset:24576
  v_mfma_f32_16x16x32_bf16 v[68:71], a[196:199], v[24:27], v[68:71]
  v_mov_b32 v7, v56
  v_mfma_f32_16x16x32_bf16 v[80:83], a[200:203], v[24:27], v[80:83]
  v_mfma_f32_16x16x32_bf16 v[84:87], a[204:207], v[24:27], v[84:87]
  s_waitcnt lgkmcnt(5)
  v_mfma_f32_16x16x32_bf16 v[72:75], a[192:195], v[28:31], v[72:75]
  s_add_u32 s27, s27, s22
  ds_read_b128 v[52:55], v15 offset:24576
  v_mfma_f32_16x16x32_bf16 v[76:79], a[196:199], v[28:31], v[76:79]
  v_mfma_f32_16x16x32_bf16 v[88:91], a[200:203], v[28:31], v[88:91]
  s_waitcnt vmcnt(16)
  s_barrier
  v_mfma_f32_16x16x32_bf16 v[92:95], a[204:207], v[28:31], v[92:95]
  s_waitcnt lgkmcnt(5)
  v_mfma_f32_16x16x32_bf16 v[64:67], a[208:211], v[32:35], v[64:67]
  ds_read_b128 v[24:27], v8 offset:32768
  v_mfma_f32_16x16x32_bf16 v[68:71], a[212:215], v[32:35], v[68:71]
  v_mfma_f32_16x16x32_bf16 v[80:83], a[216:219], v[32:35], v[80:83]
  v_mfma_f32_16x16x32_bf16 v[84:87], a[220:223], v[32:35], v[84:87]
  s_waitcnt lgkmcnt(5)
  v_mfma_f32_16x16x32_bf16 v[72:75], a[208:211], v[36:39], v[72:75]
  ds_read_b128 v[28:31], v9 offset:32768
  v_mfma_f32_16x16x32_bf16 v[76:79], a[212:215], v[36:39], v[76:79]
  v_mfma_f32_16x16x32_bf16 v[88:91], a[216:219], v[36:39], v[88:91]
  v_mfma_f32_16x16x32_bf16 v[92:95], a[220:223], v[36:39], v[92:95]
  s_waitcnt lgkmcnt(5)
  v_mfma_f32_16x16x32_bf16 v[64:67], a[224:227], v[40:43], v[64:67]
  ds_read_b128 v[32:35], v10 offset:32768
  v_mfma_f32_16x16x32_bf16 v[68:71], a[228:231], v[40:43], v[68:71]
  v_mfma_f32_16x16x32_bf16 v[80:83], a[232:235], v[40:43], v[80:83]
  v_mfma_f32_16x16x32_bf16 v[84:87], a[236:239], v[40:43], v[84:87]
  s_waitcnt lgkmcnt(5)
  v_mfma_f32_16x16x32_bf16 v[72:75], a[224:227], v[44:47], v[72:75]
  ds_read_b128 v[36:39], v11 offset:32768
  v_mfma_f32_16x16x32_bf16 v[76:79], a[228:231], v[44:47], v[76:79]
  v_mfma_f32_16x16x32_bf16 v[88:91], a[232:235], v[44:47], v[88:91]
  v_mfma_f32_16x16x32_bf16 v[92:95], a[236:239], v[44:47], v[92:95]
  s_waitcnt lgkmcnt(5)
  v_mfma_f32_16x16x32_bf16 v[64:67], a[240:243], v[48:51], v[64:67]
  s_sub_u32 s23, s23, 1
  ds_read_b128 v[40:43], v12 offset:32768
  v_mfma_f32_16x16x32_bf16 v[68:71], a[244:247], v[48:51], v[68:71]
  v_mfma_f32_16x16x32_bf16 v[80:83], a[248:251], v[48:51], v[80:83]
  v_mfma_f32_16x16x32_bf16 v[84:87], a[252:255], v[48:51], v[84:87]
  s_waitcnt lgkmcnt(5)
  v_mfma_f32_16x16x32_bf16 v[72:75], a[240:243], v[52:55], v[72:75]
  s_cmp_eq_u32 s23, 0
  ds_read_b128 v[44:47], v13 offset:32768
  v_mfma_f32_16x16x32_bf16 v[76:79], a[244:247], v[52:55], v[76:79]
  v_mfma_f32_16x16x32_bf16 v[88:91], a[248:251], v[52:55], v[88:91]
  v_mfma_f32_16x16x32_bf16 v[92:95], a[252:255], v[52:55], v[92:95]
  s_cbranch_scc1 G_done0_220
  s_waitcnt lgkmcnt(5)
  v_mfma_f32_16x16x32_bf16 v[96:99], a[0:3], v[24:27], 0
  s_add_u32 m0, s25, 0
  ds_read_b128 v[48:51], v14 offset:32768
  v_mfma_f32_16x16x32_bf16 v[100:103], a[4:7], v[24:27], 0
  v_mfma_f32_16x16x32_bf16 v[112:115], a[8:11], v[24:27], 0
  buffer_load_dwordx4 v16, s[12:15], s19 offen sc1 lds
  v_mfma_f32_16x16x32_bf16 v[116:119], a[12:15], v[24:27], 0
  s_waitcnt lgkmcnt(5)
  v_mfma_f32_16x16x32_bf16 v[104:107], a[0:3], v[28:31], 0
  ds_read_b128 v[52:55], v15 offset:32768
  v_mfma_f32_16x16x32_bf16 v[108:111], a[4:7], v[28:31], 0
  v_cvt_pk_bf16_f32 v128, v64, v65
  v_cvt_pk_bf16_f32 v129, v66, v67
  v_mfma_f32_16x16x32_bf16 v[120:123], a[8:11], v[28:31], 0
  v_mfma_f32_16x16x32_bf16 v[124:127], a[12:15], v[28:31], 0
  s_waitcnt lgkmcnt(5)
  v_cvt_pk_bf16_f32 v130, v68, v69
  v_cvt_pk_bf16_f32 v131, v70, v71
  v_mfma_f32_16x16x32_bf16 v[96:99], a[16:19], v[32:35], v[96:99]
  s_add_u32 m0, s25, 1024
  ds_read_b128 v[24:27], v8 offset:40960
  v_mfma_f32_16x16x32_bf16 v[100:103], a[20:23], v[32:35], v[100:103]
  v_mfma_f32_16x16x32_bf16 v[112:115], a[24:27], v[32:35], v[112:115]
  buffer_load_dwordx4 v17, s[12:15], s19 offen sc1 lds
  v_mfma_f32_16x16x32_bf16 v[116:119], a[28:31], v[32:35], v[116:119]
  s_waitcnt lgkmcnt(5)
  v_mfma_f32_16x16x32_bf16 v[104:107], a[16:19], v[36:39], v[104:107]
  ds_read_b128 v[28:31], v9 offset:40960
  v_mfma_f32_16x16x32_bf16 v[108:111], a[20:23], v[36:39], v[108:111]
  v_mfma_f32_16x16x32_bf16 v[120:123], a[24:27], v[36:39], v[120:123]
  v_mfma_f32_16x16x32_bf16 v[124:127], a[28:31], v[36:39], v[124:127]
  s_waitcnt lgkmcnt(5)
  v_mfma_f32_16x16x32_bf16 v[96:99], a[32:35], v[40:43], v[96:99]
  s_add_u32 m0, s25, 2048
  ds_read_b128 v[32:35], v10 offset:40960
  v_mfma_f32_16x16x32_bf16 v[100:103], a[36:39], v[40:43], v[100:103]
  v_cvt_pk_bf16_f32 v132, v72, v73
  v_cvt_pk_bf16_f32 v133, v74, v75
  v_mfma_f32_16x16x32_bf16 v[112:115], a[40:43], v[40:43], v[112:115]
  buffer_load_dwordx4 v18, s[12:15], s19 offen sc1 lds
  v_mfma_f32_16x16x32_bf16 v[116:119], a[44:47], v[40:43], v[116:119]
  s_waitcnt lgkmcnt(5)
  v_cvt_pk_bf16_f32 v134, v76, v77
  v_cvt_pk_bf16_f32 v135, v78, v79
  v_mfma_f32_16x16x32_bf16 v[104:107], a[32:35], v[44:47], v[104:107]
  ds_read_b128 v[36:39], v11 offset:40960
  v_mfma_f32_16x16x32_bf16 v[108:111], a[36:39], v[44:47], v[108:111]
  v_mfma_f32_16x16x32_bf16 v[120:123], a[40:43], v[44:47], v[120:123]
  v_mfma_f32_16x16x32_bf16 v[124:127], a[44:47], v[44:47], v[124:127]
  s_waitcnt lgkmcnt(5)
  v_mfma_f32_16x16x32_bf16 v[96:99], a[48:51], v[48:51], v[96:99]
  s_add_u32 m0, s25, 3072
  ds_read_b128 v[40:43], v12 offset:40960
  v_mfma_f32_16x16x32_bf16 v[100:103], a[52:55], v[48:51], v[100:103]
  v_mfma_f32_16x16x32_bf16 v[112:115], a[56:59], v[48:51], v[112:115]
  buffer_load_dwordx4 v19, s[12:15], s19 offen sc1 lds
  v_mfma_f32_16x16x32_bf16 v[116:119], a[60:63], v[48:51], v[116:119]
  s_waitcnt lgkmcnt(5)
  v_mfma_f32_16x16x32_bf16 v[104:107], a[48:51], v[52:55], v[104:107]
  ds_read_b128 v[44:47], v13 offset:40960
  v_mfma_f32_16x16x32_bf16 v[108:111], a[52:55], v[52:55], v[108:111]
  v_cvt_pk_bf16_f32 v136, v80, v81
  v_cvt_pk_bf16_f32 v137, v82, v83
  v_mfma_f32_16x16x32_bf16 v[120:123], a[56:59], v[52:55], v[120:123]
  v_mfma_f32_16x16x32_bf16 v[124:127], a[60:63], v[52:55], v[124:127]
  s_waitcnt lgkmcnt(5)
  v_cvt_pk_bf16_f32 v138, v84, v85
  v_cvt_pk_bf16_f32 v139, v86, v87
  v_mfma_f32_16x16x32_bf16 v[96:99], a[64:67], v[24:27], v[96:99]
  s_add_u32 m0, s25, 4096
  ds_read_b128 v[48:51], v14 offset:40960
  v_mfma_f32_16x16x32_bf16 v[100:103], a[68:71], v[24:27], v[100:103]
  v_mfma_f32_16x16x32_bf16 v[112:115], a[72:75], v[24:27], v[112:115]
  buffer_load_dwordx4 v20, s[12:15], s19 offen sc1 lds
  v_mfma_f32_16x16x32_bf16 v[116:119], a[76:79], v[24:27], v[116:119]
  s_waitcnt lgkmcnt(5)
  v_mfma_f32_16x16x32_bf16 v[104:107], a[64:67], v[28:31], v[104:107]
  ds_read_b128 v[52:55], v15 offset:40960
  v_mfma_f32_16x16x32_bf16 v[108:111], a[68:71], v[28:31], v[108:111]
  v_mfma_f32_16x16x32_bf16 v[120:123], a[72:75], v[28:31], v[120:123]
  v_mfma_f32_16x16x32_bf16 v[124:127], a[76:79], v[28:31], v[124:127]
  s_waitcnt lgkmcnt(5)
  v_mfma_f32_16x16x32_bf16 v[96:99], a[80:83], v[32:35], v[96:99]
  s_add_u32 m0, s25, 5120
  ds_read_b128 v[24:27], v8 offset:49152
  v_mfma_f32_16x16x32_bf16 v[100:103], a[84:87], v[32:35], v[100:103]
  v_cvt_pk_bf16_f32 v140, v88, v89
  v_cvt_pk_bf16_f32 v141, v90, v91
  v_mfma_f32_16x16x32_bf16 v[112:115], a[88:91], v[32:35], v[112:115]
  buffer_load_dwordx4 v21, s[12:15], s19 offen sc1 lds
  v_mfma_f32_16x16x32_bf16 v[116:119], a[92:95], v[32:35], v[116:119]
  s_waitcnt lgkmcnt(5)
  v_cvt_pk_bf16_f32 v142, v92, v93
  v_cvt_pk_bf16_f32 v143, v94, v95
  v_mfma_f32_16x16x32_bf16 v[104:107], a[80:83], v[36:39], v[104:107]
  ds_read_b128 v[28:31], v9 offset:49152
  v_mfma_f32_16x16x32_bf16 v[108:111], a[84:87], v[36:39], v[108:111]
  v_mfma_f32_16x16x32_bf16 v[120:123], a[88:91], v[36:39], v[120:123]
  v_mfma_f32_16x16x32_bf16 v[124:127], a[92:95], v[36:39], v[124:127]
  s_waitcnt lgkmcnt(5)
  v_mfma_f32_16x16x32_bf16 v[96:99], a[96:99], v[40:43], v[96:99]
  s_add_u32 m0, s25, 6144
  ds_read_b128 v[32:35], v10 offset:49152
  v_mfma_f32_16x16x32_bf16 v[100:103], a[100:103], v[40:43], v[100:103]
  v_mfma_f32_16x16x32_bf16 v[112:115], a[104:107], v[40:43], v[112:115]
  buffer_load_dwordx4 v22, s[12:15], s19 offen sc1 lds
  v_mfma_f32_16x16x32_bf16 v[116:119], a[108:111], v[40:43], v[116:119]
  s_waitcnt lgkmcnt(5)
  v_mfma_f32_16x16x32_bf16 v[104:107], a[96:99], v[44:47], v[104:107]
  ds_read_b128 v[36:39], v11 offset:49152
  v_mfma_f32_16x16x32_bf16 v[108:111], a[100:103], v[44:47], v[108:111]
  v_mfma_f32_16x16x32_bf16 v[120:123], a[104:107], v[44:47], v[120:123]
  v_mfma_f32_16x16x32_bf16 v[124:127], a[108:111], v[44:47], v[124:127]
  s_waitcnt lgkmcnt(5)
  v_mfma_f32_16x16x32_bf16 v[96:99], a[112:115], v[48:51], v[96:99]
  s_add_u32 m0, s25, 7168
  ds_read_b128 v[40:43], v12 offset:49152
  v_mfma_f32_16x16x32_bf16 v[100:103], a[116:119], v[48:51], v[100:103]
  v_mfma_f32_16x16x32_bf16 v[112:115], a[120:123], v[48:51], v[112:115]
  buffer_load_dwordx4 v23, s[12:15], s19 offen sc1 lds
  v_mfma_f32_16x16x32_bf16 v[116:119], a[124:127], v[48:51], v[116:119]
  s_waitcnt lgkmcnt(5)
  v_mfma_f32_16x16x32_bf16 v[104:107], a[112:115], v[52:55], v[104:107]
  s_cmp_gt_u32 s23, 3
  ds_read_b128 v[44:47], v13 offset:49152
  v_mfma_f32_16x16x32_bf16 v[108:111], a[116:119], v[52:55], v[108:111]
  v_mfma_f32_16x16x32_bf16 v[120:123], a[120:123], v[52:55], v[120:123]
  s_cselect_b32 s26, s20, 0
  v_mfma_f32_16x16x32_bf16 v[124:127], a[124:127], v[52:55], v[124:127]
  s_waitcnt lgkmcnt(5)
  v_mfma_f32_16x16x32_bf16 v[96:99], a[128:131], v[24:27], v[96:99]
  s_add_u32 s19, s19, s26
  ds_read_b128 v[48:51], v14 offset:49152
  v_mfma_f32_16x16x32_bf16 v[100:103], a[132:135], v[24:27], v[100:103]
  v_mfma_f32_16x16x32_bf16 v[112:115], a[136:139], v[24:27], v[112:115]
  s_add_u32 s25, s25, 32768
  v_mfma_f32_16x16x32_bf16 v[116:119], a[140:143], v[24:27], v[116:119]
  s_waitcnt lgkmcnt(5)
  v_mfma_f32_16x16x32_bf16 v[104:107], a[128:131], v[28:31], v[104:107]
  s_and_b32 s25, s25, 0x1ffff
  ds_read_b128 v[52:55], v15 offset:49152
  v_mfma_f32_16x16x32_bf16 v[108:111], a[132:135], v[28:31], v[108:111]
  v_mfma_f32_16x16x32_bf16 v[120:123], a[136:139], v[28:31], v[120:123]
  buffer_store_dwordx4 v[128:131], v7, s[4:7], s21 offen offset:0 sc1
  v_mfma_f32_16x16x32_bf16 v[124:127], a[140:143], v[28:31], v[124:127]
  s_waitcnt lgkmcnt(5)
  v_mfma_f32_16x16x32_bf16 v[96:99], a[144:147], v[32:35], v[96:99]
  ds_read_b128 v[24:27], v8 offset:57344
  v_mfma_f32_16x16x32_bf16 v[100:103], a[148:151], v[32:35], v[100:103]
  v_mfma_f32_16x16x32_bf16 v[112:115], a[152:155], v[32:35], v[112:115]
  v_mfma_f32_16x16x32_bf16 v[116:119], a[156:159], v[32:35], v[116:119]
  s_waitcnt lgkmcnt(5)
  v_xor_b32 v8, 0x10000, v8
  v_mfma_f32_16x16x32_bf16 v[104:107], a[144:147], v[36:39], v[104:107]
  ds_read_b128 v[28:31], v9 offset:57344
  v_mfma_f32_16x16x32_bf16 v[108:111], a[148:151], v[36:39], v[108:111]
  v_mfma_f32_16x16x32_bf16 v[120:123], a[152:155], v[36:39], v[120:123]
  buffer_store_dwordx4 v[132:135], v7, s[4:7], s21 offen offset:256 sc1
  v_mfma_f32_16x16x32_bf16 v[124:127], a[156:159], v[36:39], v[124:127]
  s_waitcnt lgkmcnt(5)
  v_xor_b32 v9, 0x10000, v9
  v_mfma_f32_16x16x32_bf16 v[96:99], a[160:163], v[40:43], v[96:99]
  ds_read_b128 v[32:35], v10 offset:57344
  v_mfma_f32_16x16x32_bf16 v[100:103], a[164:167], v[40:43], v[100:103]
  v_mfma_f32_16x16x32_bf16 v[112:115], a[168:171], v[40:43], v[112:115]
  v_mfma_f32_16x16x32_bf16 v[116:119], a[172:175], v[40:43], v[116:119]
  s_waitcnt lgkmcnt(5)
  v_xor_b32 v10, 0x10000, v10
  v_mfma_f32_16x16x32_bf16 v[104:107], a[160:163], v[44:47], v[104:107]
  ds_read_b128 v[36:39], v11 offset:57344
  v_mfma_f32_16x16x32_bf16 v[108:111], a[164:167], v[44:47], v[108:111]
  v_mfma_f32_16x16x32_bf16 v[120:123], a[168:171], v[44:47], v[120:123]
  buffer_store_dwordx4 v[136:139], v7, s[4:7], s21 offen offset:2048 sc1
  v_mfma_f32_16x16x32_bf16 v[124:127], a[172:175], v[44:47], v[124:127]
  s_waitcnt lgkmcnt(5)
  v_xor_b32 v11, 0x10000, v11
  v_mfma_f32_16x16x32_bf16 v[96:99], a[176:179], v[48:51], v[96:99]
  ds_read_b128 v[40:43], v12 offset:57344
  v_mfma_f32_16x16x32_bf16 v[100:103], a[180:183], v[48:51], v[100:103]
  v_mfma_f32_16x16x32_bf16 v[112:115], a[184:187], v[48:51], v[112:115]
  v_mfma_f32_16x16x32_bf16 v[116:119], a[188:191], v[48:51], v[116:119]
  s_waitcnt lgkmcnt(5)
  v_xor_b32 v12, 0x10000, v12
  v_mfma_f32_16x16x32_bf16 v[104:107], a[176:179], v[52:55], v[104:107]
  ds_read_b128 v[44:47], v13 offset:57344
  v_mfma_f32_16x16x32_bf16 v[108:111], a[180:183], v[52:55], v[108:111]
  v_mfma_f32_16x16x32_bf16 v[120:123], a[184:187], v[52:55], v[120:123]
  buffer_store_dwordx4 v[140:143], v7, s[4:7], s21 offen offset:2304 sc1
  v_mfma_f32_16x16x32_bf16 v[124:127], a[188:191], v[52:55], v[124:127]
  s_waitcnt lgkmcnt(5)
  v_xor_b32 v13, 0x10000, v13
  v_mfma_f32_16x16x32_bf16 v[96:99], a[192:195], v[24:27], v[96:99]
  s_mov_b32 s21, s27
  ds_read_b128 v[48:51], v14 offset:57344
  v_mfma_f32_16x16x32_bf16 v[100:103], a[196:199], v[24:27], v[100:103]
  v_mov_b32 v7, v56
  v_mfma_f32_16x16x32_bf16 v[112:115], a[200:203], v[24:27], v[112:115]
  v_mfma_f32_16x16x32_bf16 v[116:119], a[204:207], v[24:27], v[116:119]
  s_waitcnt lgkmcnt(5)
  v_xor_b32 v14, 0x10000, v14
  v_mfma_f32_16x16x32_bf16 v[104:107], a[192:195], v[28:31], v[104:107]
  s_add_u32 s27, s27, s22
  ds_read_b128 v[52:55], v15 offset:57344
  v_mfma_f32_16x16x32_bf16 v[108:111], a[196:199], v[28:31], v[108:111]
  v_mfma_f32_16x16x32_bf16 v[120:123], a[200:203], v[28:31], v[120:123]
  s_waitcnt vmcnt(16)
  s_barrier
  v_mfma_f32_16x16x32_bf16 v[124:127], a[204:207], v[28:31], v[124:127]
  s_waitcnt lgkmcnt(5)
  v_xor_b32 v15, 0x10000, v15
  v_mfma_f32_16x16x32_bf16 v[96:99], a[208:211], v[32:35], v[96:99]
  ds_read_b128 v[24:27], v8 offset:0
  v_mfma_f32_16x16x32_bf16 v[100:103], a[212:215], v[32:35], v[100:103]
  v_mfma_f32_16x16x32_bf16 v[112:115], a[216:219], v[32:35], v[112:115]
  v_mfma_f32_16x16x32_bf16 v[116:119], a[220:223], v[32:35], v[116:119]
  s_waitcnt lgkmcnt(5)
  v_mfma_f32_16x16x32_bf16 v[104:107], a[208:211], v[36:39], v[104:107]
  ds_read_b128 v[28:31], v9 offset:0
  v_mfma_f32_16x16x32_bf16 v[108:111], a[212:215], v[36:39], v[108:111]
  v_mfma_f32_16x16x32_bf16 v[120:123], a[216:219], v[36:39], v[120:123]
  v_mfma_f32_16x16x32_bf16 v[124:127], a[220:223], v[36:39], v[124:127]
  s_waitcnt lgkmcnt(5)
  v_mfma_f32_16x16x32_bf16 v[96:99], a[224:227], v[40:43], v[96:99]
  ds_read_b128 v[32:35], v10 offset:0
  v_mfma_f32_16x16x32_bf16 v[100:103], a[228:231], v[40:43], v[100:103]
  v_mfma_f32_16x16x32_bf16 v[112:115], a[232:235], v[40:43], v[112:115]
  v_mfma_f32_16x16x32_bf16 v[116:119], a[236:239], v[40:43], v[116:119]
  s_waitcnt lgkmcnt(5)
  v_mfma_f32_16x16x32_bf16 v[104:107], a[224:227], v[44:47], v[104:107]
  ds_read_b128 v[36:39], v11 offset:0
  v_mfma_f32_16x16x32_bf16 v[108:111], a[228:231], v[44:47], v[108:111]
  v_mfma_f32_16x16x32_bf16 v[120:123], a[232:235], v[44:47], v[120:123]
  v_mfma_f32_16x16x32_bf16 v[124:127], a[236:239], v[44:47], v[124:127]
  s_waitcnt lgkmcnt(5)
  v_mfma_f32_16x16x32_bf16 v[96:99], a[240:243], v[48:51], v[96:99]
  s_sub_u32 s23, s23, 1
  ds_read_b128 v[40:43], v12 offset:0
  v_mfma_f32_16x16x32_bf16 v[100:103], a[244:247], v[48:51], v[100:103]
  v_mfma_f32_16x16x32_bf16 v[112:115], a[248:251], v[48:51], v[112:115]
  v_mfma_f32_16x16x32_bf16 v[116:119], a[252:255], v[48:51], v[116:119]
  s_waitcnt lgkmcnt(5)
  v_mfma_f32_16x16x32_bf16 v[104:107], a[240:243], v[52:55], v[104:107]
  s_cmp_eq_u32 s23, 0
  ds_read_b128 v[44:47], v13 offset:0
  v_mfma_f32_16x16x32_bf16 v[108:111], a[244:247], v[52:55], v[108:111]
  v_mfma_f32_16x16x32_bf16 v[120:123], a[248:251], v[52:55], v[120:123]
  v_mfma_f32_16x16x32_bf16 v[124:127], a[252:255], v[52:55], v[124:127]
  s_cbranch_scc1 G_done1_221
  s_branch G_top_219
G_done0_220:
  s_nop 7
  s_nop 3
  v_cvt_pk_bf16_f32 v128, v64, v65
  v_cvt_pk_bf16_f32 v129, v66, v67
  v_cvt_pk_bf16_f32 v130, v68, v69
  v_cvt_pk_bf16_f32 v131, v70, v71
  buffer_store_dwordx4 v[128:131], v7, s[4:7], s21 offen offset:0 sc1
  v_cvt_pk_bf16_f32 v132, v72, v73
  v_cvt_pk_bf16_f32 v133, v74, v75
  v_cvt_pk_bf16_f32 v134, v76, v77
  v_cvt_pk_bf16_f32 v135, v78, v79
  buffer_store_dwordx4 v[132:135], v7, s[4:7], s21 offen offset:256 sc1
  v_cvt_pk_bf16_f32 v136, v80, v81
  v_cvt_pk_bf16_f32 v137, v82, v83
  v_cvt_pk_bf16_f32 v138, v84, v85
  v_cvt_pk_bf16_f32 v139, v86, v87
  buffer_store_dwordx4 v[136:139], v7, s[4:7], s21 offen offset:2048 sc1
  v_cvt_pk_bf16_f32 v140, v88, v89
  v_cvt_pk_bf16_f32 v141, v90, v91
  v_cvt_pk_bf16_f32 v142, v92, v93
  v_cvt_pk_bf16_f32 v143, v94, v95
  buffer_store_dwordx4 v[140:143], v7, s[4:7], s21 offen offset:2304 sc1
  s_branch G_fin_222
G_done1_221:
  s_nop 7
  s_nop 3
  v_cvt_pk_bf16_f32 v128, v96, v97
  v_cvt_pk_bf16_f32 v129, v98, v99
  v_cvt_pk_bf16_f32 v130, v100, v101
  v_cvt_pk_bf16_f32 v131, v102, v103
  buffer_store_dwordx4 v[128:131], v7, s[4:7], s21 offen offset:0 sc1
  v_cvt_pk_bf16_f32 v132, v104, v105
  v_cvt_pk_bf16_f32 v133, v106, v107
  v_cvt_pk_bf16_f32 v134, v108, v109
  v_cvt_pk_bf16_f32 v135, v110, v111
  buffer_store_dwordx4 v[132:135], v7, s[4:7], s21 offen offset:256 sc1
  v_cvt_pk_bf16_f32 v136, v112, v113
  v_cvt_pk_bf16_f32 v137, v114, v115
  v_cvt_pk_bf16_f32 v138, v116, v117
  v_cvt_pk_bf16_f32 v139, v118, v119
  buffer_store_dwordx4 v[136:139], v7, s[4:7], s21 offen offset:2048 sc1
  v_cvt_pk_bf16_f32 v140, v120, v121
  v_cvt_pk_bf16_f32 v141, v122, v123
  v_cvt_pk_bf16_f32 v142, v124, v125
  v_cvt_pk_bf16_f32 v143, v126, v127
  buffer_store_dwordx4 v[140:143], v7, s[4:7], s21 offen offset:2304 sc1
G_fin_222:
  s_waitcnt vmcnt(0) lgkmcnt(0)
  s_barrier
  s_waitcnt vmcnt(0)
  s_barrier
  s_mov_b32 s30, 768
  v_mov_b32 v144, s30
  v_min_u32 v145, 1, v0
  v_lshlrev_b32 v145, 30, v145
  buffer_store_dword v144, v145, s[4:7], s31 offen sc1
  s_mul_i32 s50, s64, 6
  s_add_u32 s50, s50, s65
  s_mul_i32 s76, s50, 21846
  s_lshr_b32 s76, s76, 16
  s_mul_i32 s77, s76, 3
  s_add_u32 s51, s50, 64
  s_cmp_eq_u32 s77, s50
  s_cselect_b32 s50, s76, s51
M_fin:
  s_lshr_b32 s48, s50, 2
  s_and_b32 s49, s50, 3
  s_load_dwordx2 s[8:9], s[0:1], 0
  s_load_dwordx2 s[12:13], s[0:1], 104
  s_load_dwordx2 s[32:33], s[0:1], 112
  v_and_b32 v4, 31, v1
  v_lshrrev_b32 v5, 5, v1
  v_lshlrev_b32 v5, 4, v5
  v_lshl_add_u32 v6, v4, 10, v5
  s_lshl_b32 s26, s16, 8
  s_lshl_b32 s27, s48, 15
  s_add_u32 s27, s27, s26
  s_waitcnt lgkmcnt(0)
  s_and_b32 s9, s9, 0xffff
  s_mov_b32 s10, 2097152
  s_mov_b32 s11, 0x20000
  s_and_b32 s13, s13, 0xffff
  s_mov_b32 s14, 1024
  s_mov_b32 s15, 0x20000
  s_and_b32 s33, s33, 0xffff
  s_mov_b32 s34, 2097152
  s_mov_b32 s35, 0x20000
  buffer_load_dwordx4 v[16:19], v6, s[8:11], s27 offen offset:0
  buffer_load_dwordx4 v[48:51], v5, s[12:15], s26 offen offset:0
  buffer_load_dwordx4 v[20:23], v6, s[8:11], s27 offen offset:32
  buffer_load_dwordx4 v[52:55], v5, s[12:15], s26 offen offset:32
  buffer_load_dwordx4 v[24:27], v6, s[8:11], s27 offen offset:64
  buffer_load_dwordx4 v[56:59], v5, s[12:15], s26 offen offset:64
  buffer_load_dwordx4 v[28:31], v6, s[8:11], s27 offen offset:96
  buffer_load_dwordx4 v[60:63], v5, s[12:15], s26 offen offset:96
  buffer_load_dwordx4 v[32:35], v6, s[8:11], s27 offen offset:128
  buffer_load_dwordx4 v[64:67], v5, s[12:15], s26 offen offset:128
  buffer_load_dwordx4 v[36:39], v6, s[8:11], s27 offen offset:160
  buffer_load_dwordx4 v[68:71], v5, s[12:15], s26 offen offset:160
  buffer_load_dwordx4 v[40:43], v6, s[8:11], s27 offen offset:192
  buffer_load_dwordx4 v[72:75], v5, s[12:15], s26 offen offset:192
  buffer_load_dwordx4 v[44:47], v6, s[8:11], s27 offen offset:224
  buffer_load_dwordx4 v[76:79], v5, s[12:15], s26 offen offset:224
  s_lshl_b32 s28, s48, 2
  s_add_u32 s28, s28, s49
  s_lshl_b32 s28, s28, 2
  s_add_u32 s28, s28, s16
  s_lshl_b32 s28, s28, 11
  s_waitcnt vmcnt(14)
  v_mfma_f32_32x32x16_bf16 v[80:95], v[48:51], v[16:19], 0
  s_waitcnt vmcnt(12)
  v_mfma_f32_32x32x16_bf16 v[80:95], v[52:55], v[20:23], v[80:95]
  s_waitcnt vmcnt(10)
  v_mfma_f32_32x32x16_bf16 v[80:95], v[56:59], v[24:27], v[80:95]
  s_waitcnt vmcnt(8)
  v_mfma_f32_32x32x16_bf16 v[80:95], v[60:63], v[28:31], v[80:95]
  s_waitcnt vmcnt(6)
  v_mfma_f32_32x32x16_bf16 v[80:95], v[64:67], v[32:35], v[80:95]
  s_waitcnt vmcnt(4)
  v_mfma_f32_32x32x16_bf16 v[80:95], v[68:71], v[36:39], v[80:95]
  s_waitcnt vmcnt(2)
  v_mfma_f32_32x32x16_bf16 v[80:95], v[72:75], v[40:43], v[80:95]
  s_waitcnt vmcnt(0)
  v_mfma_f32_32x32x16_bf16 v[80:95], v[76:79], v[44:47], v[80:95]
  s_mul_i32 s76, s48, 43
  s_lshr_b32 s76, s76, 9
  s_mul_i32 s76, s76, 12
  s_sub_u32 s76, s48, s76
  s_cmp_ge_u32 s76, 6
  s_addc_u32 s76, s76, 0
  s_and_b32 s77, s49, 2
  s_mul_i32 s77, s77, 7
  s_add_u32 s76, s76, s77
  v_mov_b32 v193, 0x300
  s_lshl_b32 s76, s76, 7
  s_add_u32 s76, s76, 148897792
  v_and_b32 v192, 7, v1
  v_mul_u32_u24 v192, 3584, v192
  v_add_u32 v192, s76, v192
  s_mov_b32 s71, 0
  s_branch M_vg_224
M_vw_223:
  s_sleep 2
  s_add_u32 s71, s71, 1
  s_cmp_gt_u32 s71, 262144
  s_cbranch_scc1 M_exit
M_vg_224:
  buffer_load_dword v194, v192, s[4:7], 0 offen sc1
  s_waitcnt vmcnt(0)
  v_cmp_lt_u32 vcc, v194, v193
  s_cbranch_vccnz M_vw_223
  s_add_u32 s29, s28, 150994944
  buffer_load_dwordx4 v[96:99], v2, s[4:7], s29 offen offset:0 sc1
  buffer_load_dwordx4 v[100:103], v2, s[4:7], s29 offen offset:1024 sc1
  s_add_u32 s29, s28, 153092096
  buffer_load_dwordx4 v[104:107], v2, s[4:7], s29 offen offset:0 sc1
  buffer_load_dwordx4 v[108:111], v2, s[4:7], s29 offen offset:1024 sc1
  s_add_u32 s29, s28, 155189248
  buffer_load_dwordx4 v[112:115], v2, s[4:7], s29 offen offset:0 sc1
  buffer_load_dwordx4 v[116:119], v2, s[4:7], s29 offen offset:1024 sc1
  s_add_u32 s29, s28, 157286400
  buffer_load_dwordx4 v[120:123], v2, s[4:7], s29 offen offset:0 sc1
  buffer_load_dwordx4 v[124:127], v2, s[4:7], s29 offen offset:1024 sc1
  s_add_u32 s29, s28, 159383552
  buffer_load_dwordx4 v[128:131], v2, s[4:7], s29 offen offset:0 sc1
  buffer_load_dwordx4 v[132:135], v2, s[4:7], s29 offen offset:1024 sc1
  s_add_u32 s29, s28, 161480704
  buffer_load_dwordx4 v[136:139], v2, s[4:7], s29 offen offset:0 sc1
  buffer_load_dwordx4 v[140:143], v2, s[4:7], s29 offen offset:1024 sc1
  s_add_u32 s29, s28, 163577856
  buffer_load_dwordx4 v[144:147], v2, s[4:7], s29 offen offset:0 sc1
  buffer_load_dwordx4 v[148:151], v2, s[4:7], s29 offen offset:1024 sc1
  s_add_u32 s29, s28, 165675008
  buffer_load_dwordx4 v[152:155], v2, s[4:7], s29 offen offset:0 sc1
  buffer_load_dwordx4 v[156:159], v2, s[4:7], s29 offen offset:1024 sc1
  v_lshlrev_b32 v7, 4, v4
  s_lshl_b32 s26, s16, 2
  v_add_u32 v4, s26, v7
  s_barrier
  ds_write_b32 v4, v80
  s_waitcnt lgkmcnt(0)
  s_barrier
  ds_read_b128 v[84:87], v7
  s_waitcnt lgkmcnt(0)
  v_add_f32 v80, v84, v85
  v_add_f32 v81, v86, v87
  v_add_f32 v80, v80, v81
  v_mul_f32 v80, 0xbfb8aa3b, v80
  v_exp_f32 v80, v80
  s_nop 0
  v_add_f32 v80, 1.0, v80
  v_rcp_f32 v80, v80
  s_nop 0
  v_sub_f32 v82, 1.0, v80
  s_waitcnt vmcnt(14)
  v_lshlrev_b32 v160, 16, v96
  v_and_b32 v161, 0xffff0000, v96
  v_lshlrev_b32 v162, 16, v97
  v_and_b32 v163, 0xffff0000, v97
  v_lshlrev_b32 v164, 16, v98
  v_and_b32 v165, 0xffff0000, v98
  v_lshlrev_b32 v166, 16, v99
  v_and_b32 v167, 0xffff0000, v99
  v_lshlrev_b32 v168, 16, v100
  v_and_b32 v169, 0xffff0000, v100
  v_lshlrev_b32 v170, 16, v101
  v_and_b32 v171, 0xffff0000, v101
  v_lshlrev_b32 v172, 16, v102
  v_and_b32 v173, 0xffff0000, v102
  v_lshlrev_b32 v174, 16, v103
  v_and_b32 v175, 0xffff0000, v103
  s_waitcnt vmcnt(12)
  v_lshlrev_b32 v8, 16, v104
  v_and_b32 v9, 0xffff0000, v104
  v_pk_add_f32 v[160:161], v[160:161], v[8:9]
  v_lshlrev_b32 v10, 16, v105
  v_and_b32 v11, 0xffff0000, v105
  v_pk_add_f32 v[162:163], v[162:163], v[10:11]
  v_lshlrev_b32 v12, 16, v106
  v_and_b32 v13, 0xffff0000, v106
  v_pk_add_f32 v[164:165], v[164:165], v[12:13]
  v_lshlrev_b32 v14, 16, v107
  v_and_b32 v15, 0xffff0000, v107
  v_pk_add_f32 v[166:167], v[166:167], v[14:15]
  v_lshlrev_b32 v8, 16, v108
  v_and_b32 v9, 0xffff0000, v108
  v_pk_add_f32 v[168:169], v[168:169], v[8:9]
  v_lshlrev_b32 v10, 16, v109
  v_and_b32 v11, 0xffff0000, v109
  v_pk_add_f32 v[170:171], v[170:171], v[10:11]
  v_lshlrev_b32 v12, 16, v110
  v_and_b32 v13, 0xffff0000, v110
  v_pk_add_f32 v[172:173], v[172:173], v[12:13]
  v_lshlrev_b32 v14, 16, v111
  v_and_b32 v15, 0xffff0000, v111
  v_pk_add_f32 v[174:175], v[174:175], v[14:15]
  s_waitcnt vmcnt(10)
  v_lshlrev_b32 v8, 16, v112
  v_and_b32 v9, 0xffff0000, v112
  v_pk_add_f32 v[160:161], v[160:161], v[8:9]
  v_lshlrev_b32 v10, 16, v113
  v_and_b32 v11, 0xffff0000, v113
  v_pk_add_f32 v[162:163], v[162:163], v[10:11]
  v_lshlrev_b32 v12, 16, v114
  v_and_b32 v13, 0xffff0000, v114
  v_pk_add_f32 v[164:165], v[164:165], v[12:13]
  v_lshlrev_b32 v14, 16, v115
  v_and_b32 v15, 0xffff0000, v115
  v_pk_add_f32 v[166:167], v[166:167], v[14:15]
  v_lshlrev_b32 v8, 16, v116
  v_and_b32 v9, 0xffff0000, v116
  v_pk_add_f32 v[168:169], v[168:169], v[8:9]
  v_lshlrev_b32 v10, 16, v117
  v_and_b32 v11, 0xffff0000, v117
  v_pk_add_f32 v[170:171], v[170:171], v[10:11]
  v_lshlrev_b32 v12, 16, v118
  v_and_b32 v13, 0xffff0000, v118
  v_pk_add_f32 v[172:173], v[172:173], v[12:13]
  v_lshlrev_b32 v14, 16, v119
  v_and_b32 v15, 0xffff0000, v119
  v_pk_add_f32 v[174:175], v[174:175], v[14:15]
  s_waitcnt vmcnt(8)
  v_lshlrev_b32 v8, 16, v120
  v_and_b32 v9, 0xffff0000, v120
  v_pk_add_f32 v[160:161], v[160:161], v[8:9]
  v_lshlrev_b32 v10, 16, v121
  v_and_b32 v11, 0xffff0000, v121
  v_pk_add_f32 v[162:163], v[162:163], v[10:11]
  v_lshlrev_b32 v12, 16, v122
  v_and_b32 v13, 0xffff0000, v122
  v_pk_add_f32 v[164:165], v[164:165], v[12:13]
  v_lshlrev_b32 v14, 16, v123
  v_and_b32 v15, 0xffff0000, v123
  v_pk_add_f32 v[166:167], v[166:167], v[14:15]
  v_lshlrev_b32 v8, 16, v124
  v_and_b32 v9, 0xffff0000, v124
  v_pk_add_f32 v[168:169], v[168:169], v[8:9]
  v_lshlrev_b32 v10, 16, v125
  v_and_b32 v11, 0xffff0000, v125
  v_pk_add_f32 v[170:171], v[170:171], v[10:11]
  v_lshlrev_b32 v12, 16, v126
  v_and_b32 v13, 0xffff0000, v126
  v_pk_add_f32 v[172:173], v[172:173], v[12:13]
  v_lshlrev_b32 v14, 16, v127
  v_and_b32 v15, 0xffff0000, v127
  v_pk_add_f32 v[174:175], v[174:175], v[14:15]
  s_waitcnt vmcnt(6)
  v_lshlrev_b32 v8, 16, v128
  v_and_b32 v9, 0xffff0000, v128
  v_pk_add_f32 v[160:161], v[160:161], v[8:9]
  v_lshlrev_b32 v10, 16, v129
  v_and_b32 v11, 0xffff0000, v129
  v_pk_add_f32 v[162:163], v[162:163], v[10:11]
  v_lshlrev_b32 v12, 16, v130
  v_and_b32 v13, 0xffff0000, v130
  v_pk_add_f32 v[164:165], v[164:165], v[12:13]
  v_lshlrev_b32 v14, 16, v131
  v_and_b32 v15, 0xffff0000, v131
  v_pk_add_f32 v[166:167], v[166:167], v[14:15]
  v_lshlrev_b32 v8, 16, v132
  v_and_b32 v9, 0xffff0000, v132
  v_pk_add_f32 v[168:169], v[168:169], v[8:9]
  v_lshlrev_b32 v10, 16, v133
  v_and_b32 v11, 0xffff0000, v133
  v_pk_add_f32 v[170:171], v[170:171], v[10:11]
  v_lshlrev_b32 v12, 16, v134
  v_and_b32 v13, 0xffff0000, v134
  v_pk_add_f32 v[172:173], v[172:173], v[12:13]
  v_lshlrev_b32 v14, 16, v135
  v_and_b32 v15, 0xffff0000, v135
  v_pk_add_f32 v[174:175], v[174:175], v[14:15]
  s_waitcnt vmcnt(4)
  v_lshlrev_b32 v8, 16, v136
  v_and_b32 v9, 0xffff0000, v136
  v_pk_add_f32 v[160:161], v[160:161], v[8:9]
  v_lshlrev_b32 v10, 16, v137
  v_and_b32 v11, 0xffff0000, v137
  v_pk_add_f32 v[162:163], v[162:163], v[10:11]
  v_lshlrev_b32 v12, 16, v138
  v_and_b32 v13, 0xffff0000, v138
  v_pk_add_f32 v[164:165], v[164:165], v[12:13]
  v_lshlrev_b32 v14, 16, v139
  v_and_b32 v15, 0xffff0000, v139
  v_pk_add_f32 v[166:167], v[166:167], v[14:15]
  v_lshlrev_b32 v8, 16, v140
  v_and_b32 v9, 0xffff0000, v140
  v_pk_add_f32 v[168:169], v[168:169], v[8:9]
  v_lshlrev_b32 v10, 16, v141
  v_and_b32 v11, 0xffff0000, v141
  v_pk_add_f32 v[170:171], v[170:171], v[10:11]
  v_lshlrev_b32 v12, 16, v142
  v_and_b32 v13, 0xffff0000, v142
  v_pk_add_f32 v[172:173], v[172:173], v[12:13]
  v_lshlrev_b32 v14, 16, v143
  v_and_b32 v15, 0xffff0000, v143
  v_pk_add_f32 v[174:175], v[174:175], v[14:15]
  s_waitcnt vmcnt(2)
  v_lshlrev_b32 v8, 16, v144
  v_and_b32 v9, 0xffff0000, v144
  v_pk_add_f32 v[160:161], v[160:161], v[8:9]
  v_lshlrev_b32 v10, 16, v145
  v_and_b32 v11, 0xffff0000, v145
  v_pk_add_f32 v[162:163], v[162:163], v[10:11]
  v_lshlrev_b32 v12, 16, v146
  v_and_b32 v13, 0xffff0000, v146
  v_pk_add_f32 v[164:165], v[164:165], v[12:13]
  v_lshlrev_b32 v14, 16, v147
  v_and_b32 v15, 0xffff0000, v147
  v_pk_add_f32 v[166:167], v[166:167], v[14:15]
  v_lshlrev_b32 v8, 16, v148
  v_and_b32 v9, 0xffff0000, v148
  v_pk_add_f32 v[168:169], v[168:169], v[8:9]
  v_lshlrev_b32 v10, 16, v149
  v_and_b32 v11, 0xffff0000, v149
  v_pk_add_f32 v[170:171], v[170:171], v[10:11]
  v_lshlrev_b32 v12, 16, v150
  v_and_b32 v13, 0xffff0000, v150
  v_pk_add_f32 v[172:173], v[172:173], v[12:13]
  v_lshlrev_b32 v14, 16, v151
  v_and_b32 v15, 0xffff0000, v151
  v_pk_add_f32 v[174:175], v[174:175], v[14:15]
  s_waitcnt vmcnt(0)
  v_lshlrev_b32 v8, 16, v152
  v_and_b32 v9, 0xffff0000, v152
  v_pk_add_f32 v[160:161], v[160:161], v[8:9]
  v_lshlrev_b32 v10, 16, v153
  v_and_b32 v11, 0xffff0000, v153
  v_pk_add_f32 v[162:163], v[162:163], v[10:11]
  v_lshlrev_b32 v12, 16, v154
  v_and_b32 v13, 0xffff0000, v154
  v_pk_add_f32 v[164:165], v[164:165], v[12:13]
  v_lshlrev_b32 v14, 16, v155
  v_and_b32 v15, 0xffff0000, v155
  v_pk_add_f32 v[166:167], v[166:167], v[14:15]
  v_lshlrev_b32 v8, 16, v156
  v_and_b32 v9, 0xffff0000, v156
  v_pk_add_f32 v[168:169], v[168:169], v[8:9]
  v_lshlrev_b32 v10, 16, v157
  v_and_b32 v11, 0xffff0000, v157
  v_pk_add_f32 v[170:171], v[170:171], v[10:11]
  v_lshlrev_b32 v12, 16, v158
  v_and_b32 v13, 0xffff0000, v158
  v_pk_add_f32 v[172:173], v[172:173], v[12:13]
  v_lshlrev_b32 v14, 16, v159
  v_and_b32 v15, 0xffff0000, v159
  v_pk_add_f32 v[174:175], v[174:175], v[14:15]
  s_and_b32 s76, s48, 1
  s_lshl_b32 s76, s76, 1
  s_lshr_b32 s77, s49, 1
  s_add_u32 s76, s76, s77
  s_mul_i32 s76, s76, 7
  s_add_u32 s76, s76, 6
  s_lshr_b32 s77, s48, 1
  s_add_u32 s77, s77, 0x201
  v_mov_b32 v193, s77
  s_lshl_b32 s76, s76, 7
  s_add_u32 s76, s76, 148897792
  v_and_b32 v192, 7, v1
  v_mul_u32_u24 v192, 3584, v192
  v_add_u32 v192, s76, v192
  s_mov_b32 s71, 0
  s_branch M_vg_226
M_vw_225:
  s_sleep 2
  s_add_u32 s71, s71, 1
  s_cmp_gt_u32 s71, 262144
  s_cbranch_scc1 M_exit
M_vg_226:
  buffer_load_dword v194, v192, s[4:7], 0 offen sc1
  s_waitcnt vmcnt(0)
  v_cmp_lt_u32 vcc, v194, v193
  s_cbranch_vccnz M_vw_225
  s_add_u32 s29, s28, 167772160
  buffer_load_dwordx4 v[96:99], v2, s[4:7], s29 offen offset:0 sc1
  buffer_load_dwordx4 v[100:103], v2, s[4:7], s29 offen offset:1024 sc1
  s_add_u32 s29, s28, 169869312
  buffer_load_dwordx4 v[104:107], v2, s[4:7], s29 offen offset:0 sc1
  buffer_load_dwordx4 v[108:111], v2, s[4:7], s29 offen offset:1024 sc1
  s_add_u32 s29, s28, 171966464
  buffer_load_dwordx4 v[112:115], v2, s[4:7], s29 offen offset:0 sc1
  buffer_load_dwordx4 v[116:119], v2, s[4:7], s29 offen offset:1024 sc1
  s_add_u32 s29, s28, 174063616
  buffer_load_dwordx4 v[120:123], v2, s[4:7], s29 offen offset:0 sc1
  buffer_load_dwordx4 v[124:127], v2, s[4:7], s29 offen offset:1024 sc1
  s_add_u32 s29, s28, 176160768
  buffer_load_dwordx4 v[128:131], v2, s[4:7], s29 offen offset:0 sc1
  buffer_load_dwordx4 v[132:135], v2, s[4:7], s29 offen offset:1024 sc1
  s_add_u32 s29, s28, 178257920
  buffer_load_dwordx4 v[136:139], v2, s[4:7], s29 offen offset:0 sc1
  buffer_load_dwordx4 v[140:143], v2, s[4:7], s29 offen offset:1024 sc1
  s_add_u32 s29, s28, 180355072
  buffer_load_dwordx4 v[144:147], v2, s[4:7], s29 offen offset:0 sc1
  buffer_load_dwordx4 v[148:151], v2, s[4:7], s29 offen offset:1024 sc1
  s_add_u32 s29, s28, 182452224
  buffer_load_dwordx4 v[152:155], v2, s[4:7], s29 offen offset:0 sc1
  buffer_load_dwordx4 v[156:159], v2, s[4:7], s29 offen offset:1024 sc1
  v_pk_mul_f32 v[160:161], v[160:161], v[80:81] op_sel_hi:[1,0]
  v_pk_mul_f32 v[162:163], v[162:163], v[80:81] op_sel_hi:[1,0]
  v_pk_mul_f32 v[164:165], v[164:165], v[80:81] op_sel_hi:[1,0]
  v_pk_mul_f32 v[166:167], v[166:167], v[80:81] op_sel_hi:[1,0]
  v_pk_mul_f32 v[168:169], v[168:169], v[80:81] op_sel_hi:[1,0]
  v_pk_mul_f32 v[170:171], v[170:171], v[80:81] op_sel_hi:[1,0]
  v_pk_mul_f32 v[172:173], v[172:173], v[80:81] op_sel_hi:[1,0]
  v_pk_mul_f32 v[174:175], v[174:175], v[80:81] op_sel_hi:[1,0]
  s_waitcnt vmcnt(14)
  v_lshlrev_b32 v176, 16, v96
  v_and_b32 v177, 0xffff0000, v96
  v_lshlrev_b32 v178, 16, v97
  v_and_b32 v179, 0xffff0000, v97
  v_lshlrev_b32 v180, 16, v98
  v_and_b32 v181, 0xffff0000, v98
  v_lshlrev_b32 v182, 16, v99
  v_and_b32 v183, 0xffff0000, v99
  v_lshlrev_b32 v184, 16, v100
  v_and_b32 v185, 0xffff0000, v100
  v_lshlrev_b32 v186, 16, v101
  v_and_b32 v187, 0xffff0000, v101
  v_lshlrev_b32 v188, 16, v102
  v_and_b32 v189, 0xffff0000, v102
  v_lshlrev_b32 v190, 16, v103
  v_and_b32 v191, 0xffff0000, v103
  s_waitcnt vmcnt(12)
  v_lshlrev_b32 v8, 16, v104
  v_and_b32 v9, 0xffff0000, v104
  v_pk_add_f32 v[176:177], v[176:177], v[8:9]
  v_lshlrev_b32 v10, 16, v105
  v_and_b32 v11, 0xffff0000, v105
  v_pk_add_f32 v[178:179], v[178:179], v[10:11]
  v_lshlrev_b32 v12, 16, v106
  v_and_b32 v13, 0xffff0000, v106
  v_pk_add_f32 v[180:181], v[180:181], v[12:13]
  v_lshlrev_b32 v14, 16, v107
  v_and_b32 v15, 0xffff0000, v107
  v_pk_add_f32 v[182:183], v[182:183], v[14:15]
  v_lshlrev_b32 v8, 16, v108
  v_and_b32 v9, 0xffff0000, v108
  v_pk_add_f32 v[184:185], v[184:185], v[8:9]
  v_lshlrev_b32 v10, 16, v109
  v_and_b32 v11, 0xffff0000, v109
  v_pk_add_f32 v[186:187], v[186:187], v[10:11]
  v_lshlrev_b32 v12, 16, v110
  v_and_b32 v13, 0xffff0000, v110
  v_pk_add_f32 v[188:189], v[188:189], v[12:13]
  v_lshlrev_b32 v14, 16, v111
  v_and_b32 v15, 0xffff0000, v111
  v_pk_add_f32 v[190:191], v[190:191], v[14:15]
  s_waitcnt vmcnt(10)
  v_lshlrev_b32 v8, 16, v112
  v_and_b32 v9, 0xffff0000, v112
  v_pk_add_f32 v[176:177], v[176:177], v[8:9]
  v_lshlrev_b32 v10, 16, v113
  v_and_b32 v11, 0xffff0000, v113
  v_pk_add_f32 v[178:179], v[178:179], v[10:11]
  v_lshlrev_b32 v12, 16, v114
  v_and_b32 v13, 0xffff0000, v114
  v_pk_add_f32 v[180:181], v[180:181], v[12:13]
  v_lshlrev_b32 v14, 16, v115
  v_and_b32 v15, 0xffff0000, v115
  v_pk_add_f32 v[182:183], v[182:183], v[14:15]
  v_lshlrev_b32 v8, 16, v116
  v_and_b32 v9, 0xffff0000, v116
  v_pk_add_f32 v[184:185], v[184:185], v[8:9]
  v_lshlrev_b32 v10, 16, v117
  v_and_b32 v11, 0xffff0000, v117
  v_pk_add_f32 v[186:187], v[186:187], v[10:11]
  v_lshlrev_b32 v12, 16, v118
  v_and_b32 v13, 0xffff0000, v118
  v_pk_add_f32 v[188:189], v[188:189], v[12:13]
  v_lshlrev_b32 v14, 16, v119
  v_and_b32 v15, 0xffff0000, v119
  v_pk_add_f32 v[190:191], v[190:191], v[14:15]
  s_waitcnt vmcnt(8)
  v_lshlrev_b32 v8, 16, v120
  v_and_b32 v9, 0xffff0000, v120
  v_pk_add_f32 v[176:177], v[176:177], v[8:9]
  v_lshlrev_b32 v10, 16, v121
  v_and_b32 v11, 0xffff0000, v121
  v_pk_add_f32 v[178:179], v[178:179], v[10:11]
  v_lshlrev_b32 v12, 16, v122
  v_and_b32 v13, 0xffff0000, v122
  v_pk_add_f32 v[180:181], v[180:181], v[12:13]
  v_lshlrev_b32 v14, 16, v123
  v_and_b32 v15, 0xffff0000, v123
  v_pk_add_f32 v[182:183], v[182:183], v[14:15]
  v_lshlrev_b32 v8, 16, v124
  v_and_b32 v9, 0xffff0000, v124
  v_pk_add_f32 v[184:185], v[184:185], v[8:9]
  v_lshlrev_b32 v10, 16, v125
  v_and_b32 v11, 0xffff0000, v125
  v_pk_add_f32 v[186:187], v[186:187], v[10:11]
  v_lshlrev_b32 v12, 16, v126
  v_and_b32 v13, 0xffff0000, v126
  v_pk_add_f32 v[188:189], v[188:189], v[12:13]
  v_lshlrev_b32 v14, 16, v127
  v_and_b32 v15, 0xffff0000, v127
  v_pk_add_f32 v[190:191], v[190:191], v[14:15]
  s_waitcnt vmcnt(6)
  v_lshlrev_b32 v8, 16, v128
  v_and_b32 v9, 0xffff0000, v128
  v_pk_add_f32 v[176:177], v[176:177], v[8:9]
  v_lshlrev_b32 v10, 16, v129
  v_and_b32 v11, 0xffff0000, v129
  v_pk_add_f32 v[178:179], v[178:179], v[10:11]
  v_lshlrev_b32 v12, 16, v130
  v_and_b32 v13, 0xffff0000, v130
  v_pk_add_f32 v[180:181], v[180:181], v[12:13]
  v_lshlrev_b32 v14, 16, v131
  v_and_b32 v15, 0xffff0000, v131
  v_pk_add_f32 v[182:183], v[182:183], v[14:15]
  v_lshlrev_b32 v8, 16, v132
  v_and_b32 v9, 0xffff0000, v132
  v_pk_add_f32 v[184:185], v[184:185], v[8:9]
  v_lshlrev_b32 v10, 16, v133
  v_and_b32 v11, 0xffff0000, v133
  v_pk_add_f32 v[186:187], v[186:187], v[10:11]
  v_lshlrev_b32 v12, 16, v134
  v_and_b32 v13, 0xffff0000, v134
  v_pk_add_f32 v[188:189], v[188:189], v[12:13]
  v_lshlrev_b32 v14, 16, v135
  v_and_b32 v15, 0xffff0000, v135
  v_pk_add_f32 v[190:191], v[190:191], v[14:15]
  s_waitcnt vmcnt(4)
  v_lshlrev_b32 v8, 16, v136
  v_and_b32 v9, 0xffff0000, v136
  v_pk_add_f32 v[176:177], v[176:177], v[8:9]
  v_lshlrev_b32 v10, 16, v137
  v_and_b32 v11, 0xffff0000, v137
  v_pk_add_f32 v[178:179], v[178:179], v[10:11]
  v_lshlrev_b32 v12, 16, v138
  v_and_b32 v13, 0xffff0000, v138
  v_pk_add_f32 v[180:181], v[180:181], v[12:13]
  v_lshlrev_b32 v14, 16, v139
  v_and_b32 v15, 0xffff0000, v139
  v_pk_add_f32 v[182:183], v[182:183], v[14:15]
  v_lshlrev_b32 v8, 16, v140
  v_and_b32 v9, 0xffff0000, v140
  v_pk_add_f32 v[184:185], v[184:185], v[8:9]
  v_lshlrev_b32 v10, 16, v141
  v_and_b32 v11, 0xffff0000, v141
  v_pk_add_f32 v[186:187], v[186:187], v[10:11]
  v_lshlrev_b32 v12, 16, v142
  v_and_b32 v13, 0xffff0000, v142
  v_pk_add_f32 v[188:189], v[188:189], v[12:13]
  v_lshlrev_b32 v14, 16, v143
  v_and_b32 v15, 0xffff0000, v143
  v_pk_add_f32 v[190:191], v[190:191], v[14:15]
  s_waitcnt vmcnt(2)
  v_lshlrev_b32 v8, 16, v144
  v_and_b32 v9, 0xffff0000, v144
  v_pk_add_f32 v[176:177], v[176:177], v[8:9]
  v_lshlrev_b32 v10, 16, v145
  v_and_b32 v11, 0xffff0000, v145
  v_pk_add_f32 v[178:179], v[178:179], v[10:11]
  v_lshlrev_b32 v12, 16, v146
  v_and_b32 v13, 0xffff0000, v146
  v_pk_add_f32 v[180:181], v[180:181], v[12:13]
  v_lshlrev_b32 v14, 16, v147
  v_and_b32 v15, 0xffff0000, v147
  v_pk_add_f32 v[182:183], v[182:183], v[14:15]
  v_lshlrev_b32 v8, 16, v148
  v_and_b32 v9, 0xffff0000, v148
  v_pk_add_f32 v[184:185], v[184:185], v[8:9]
  v_lshlrev_b32 v10, 16, v149
  v_and_b32 v11, 0xffff0000, v149
  v_pk_add_f32 v[186:187], v[186:187], v[10:11]
  v_lshlrev_b32 v12, 16, v150
  v_and_b32 v13, 0xffff0000, v150
  v_pk_add_f32 v[188:189], v[188:189], v[12:13]
  v_lshlrev_b32 v14, 16, v151
  v_and_b32 v15, 0xffff0000, v151
  v_pk_add_f32 v[190:191], v[190:191], v[14:15]
  s_waitcnt vmcnt(0)
  v_lshlrev_b32 v8, 16, v152
  v_and_b32 v9, 0xffff0000, v152
  v_pk_add_f32 v[176:177], v[176:177], v[8:9]
  v_lshlrev_b32 v10, 16, v153
  v_and_b32 v11, 0xffff0000, v153
  v_pk_add_f32 v[178:179], v[178:179], v[10:11]
  v_lshlrev_b32 v12, 16, v154
  v_and_b32 v13, 0xffff0000, v154
  v_pk_add_f32 v[180:181], v[180:181], v[12:13]
  v_lshlrev_b32 v14, 16, v155
  v_and_b32 v15, 0xffff0000, v155
  v_pk_add_f32 v[182:183], v[182:183], v[14:15]
  v_lshlrev_b32 v8, 16, v156
  v_and_b32 v9, 0xffff0000, v156
  v_pk_add_f32 v[184:185], v[184:185], v[8:9]
  v_lshlrev_b32 v10, 16, v157
  v_and_b32 v11, 0xffff0000, v157
  v_pk_add_f32 v[186:187], v[186:187], v[10:11]
  v_lshlrev_b32 v12, 16, v158
  v_and_b32 v13, 0xffff0000, v158
  v_pk_add_f32 v[188:189], v[188:189], v[12:13]
  v_lshlrev_b32 v14, 16, v159
  v_and_b32 v15, 0xffff0000, v159
  v_pk_add_f32 v[190:191], v[190:191], v[14:15]
  v_pk_fma_f32 v[160:161], v[176:177], v[82:83], v[160:161] op_sel_hi:[1,0,1]
  v_cvt_pk_bf16_f32 v16, v160, v161
  v_pk_fma_f32 v[162:163], v[178:179], v[82:83], v[162:163] op_sel_hi:[1,0,1]
  v_cvt_pk_bf16_f32 v17, v162, v163
  v_pk_fma_f32 v[164:165], v[180:181], v[82:83], v[164:165] op_sel_hi:[1,0,1]
  v_cvt_pk_bf16_f32 v18, v164, v165
  v_pk_fma_f32 v[166:167], v[182:183], v[82:83], v[166:167] op_sel_hi:[1,0,1]
  v_cvt_pk_bf16_f32 v19, v166, v167
  v_pk_fma_f32 v[168:169], v[184:185], v[82:83], v[168:169] op_sel_hi:[1,0,1]
  v_cvt_pk_bf16_f32 v20, v168, v169
  v_pk_fma_f32 v[170:171], v[186:187], v[82:83], v[170:171] op_sel_hi:[1,0,1]
  v_cvt_pk_bf16_f32 v21, v170, v171
  v_pk_fma_f32 v[172:173], v[188:189], v[82:83], v[172:173] op_sel_hi:[1,0,1]
  v_cvt_pk_bf16_f32 v22, v172, v173
  v_pk_fma_f32 v[174:175], v[190:191], v[82:83], v[174:175] op_sel_hi:[1,0,1]
  v_cvt_pk_bf16_f32 v23, v174, v175
  s_lshl_b32 s26, s49, 2
  s_add_u32 s26, s26, s16
  s_lshl_b32 s26, s26, 6
  s_lshl_b32 s27, s48, 15
  s_add_u32 s26, s26, s27
  buffer_store_dwordx4 v[16:19], v6, s[32:35], s26 offen offset:0
  buffer_store_dwordx4 v[20:23], v6, s[32:35], s26 offen offset:32
  s_cmp_lt_u32 s50, 64
  s_mov_b32 s50, s51
  s_cbranch_scc1 M_fin
  s_branch M_done
M_follow:
  s_lshr_b32 s48, s64, 2
  s_and_b32 s49, s64, 1
  s_bfe_u32 s50, s64, 0x10001
  s_mov_b32 s51, 2
  s_mov_b32 s23, 32
  s_load_dwordx2 s[8:9], s[0:1], 88
  s_lshl_b32 s17, s48, 19
  s_lshl_b32 s26, s49, 2
  s_add_u32 s26, s26, s16
  s_lshl_b32 s27, s26, 7
  s_add_u32 s17, s17, s27
  s_mov_b32 s18, 1024
  s_lshl_b32 s21, s48, 6
  s_add_u32 s21, s21, s50
  s_lshl_b32 s21, s21, 3
  s_add_u32 s21, s21, s26
  s_lshl_b32 s21, s21, 12
  s_add_u32 s21, s21, 167772160
  s_lshl_b32 s22, s51, 15
  s_mov_b32 s24, 1.0
  s_waitcnt lgkmcnt(0)
  s_and_b32 s9, s9, 0xffff
  s_mov_b32 s10, 4194304
  s_mov_b32 s11, 0x20000
  v_lshrrev_b32 v144, 4, v1
  v_and_b32 v56, 0xff, v2
  v_lshl_add_u32 v56, v144, 9, v56
  s_mul_i32 s26, s16, 0
  v_add_u32 v8, 0, v56
  v_add_u32 v16, 0, v2
  v_add_u32 v16, s26, v16
  v_add_u32 v9, 256, v56
  v_add_u32 v17, 1024, v2
  v_add_u32 v17, s26, v17
  v_add_u32 v10, 2048, v56
  v_add_u32 v18, 2048, v2
  v_add_u32 v18, s26, v18
  v_add_u32 v11, 2304, v56
  v_add_u32 v19, 3072, v2
  v_add_u32 v19, s26, v19
  v_add_u32 v12, 4096, v56
  v_add_u32 v20, 4096, v2
  v_add_u32 v20, s26, v20
  v_add_u32 v13, 4352, v56
  v_add_u32 v21, 5120, v2
  v_add_u32 v21, s26, v21
  v_add_u32 v14, 6144, v56
  v_add_u32 v22, 6144, v2
  v_add_u32 v22, s26, v22
  v_add_u32 v15, 6400, v56
  v_add_u32 v23, 7168, v2
  v_add_u32 v23, s26, v23
  v_mov_b32 v20, v56
  v_lshrrev_b32 v144, 3, v1
  v_mul_lo_u32 v144, v144, s18
  v_and_b32 v145, 7, v1
  v_lshl_add_u32 v144, v145, 4, v144
  s_lshl_b32 s28, s16, 15
  s_add_u32 s28, s28, 32768
  s_lshl_b32 s29, s18, 3
  s_add_u32 m0, s28, 0
  s_nop 0
  buffer_load_dwordx4 v144, s[8:11], s17 offen lds
  s_add_u32 s17, s17, s29
  s_add_u32 m0, s28, 1024
  s_nop 0
  buffer_load_dwordx4 v144, s[8:11], s17 offen lds
  s_add_u32 s17, s17, s29
  s_add_u32 m0, s28, 2048
  s_nop 0
  buffer_load_dwordx4 v144, s[8:11], s17 offen lds
  s_add_u32 s17, s17, s29
  s_add_u32 m0, s28, 3072
  s_nop 0
  buffer_load_dwordx4 v144, s[8:11], s17 offen lds
  s_add_u32 s17, s17, s29
  s_add_u32 m0, s28, 4096
  s_nop 0
  buffer_load_dwordx4 v144, s[8:11], s17 offen lds
  s_add_u32 s17, s17, s29
  s_add_u32 m0, s28, 5120
  s_nop 0
  buffer_load_dwordx4 v144, s[8:11], s17 offen lds
  s_add_u32 s17, s17, s29
  s_add_u32 m0, s28, 6144
  s_nop 0
  buffer_load_dwordx4 v144, s[8:11], s17 offen lds
  s_add_u32 s17, s17, s29
  s_add_u32 m0, s28, 7168
  s_nop 0
  buffer_load_dwordx4 v144, s[8:11], s17 offen lds
  s_add_u32 s17, s17, s29
  s_add_u32 m0, s28, 8192
  s_nop 0
  buffer_load_dwordx4 v144, s[8:11], s17 offen lds
  s_add_u32 s17, s17, s29
  s_add_u32 m0, s28, 9216
  s_nop 0
  buffer_load_dwordx4 v144, s[8:11], s17 offen lds
  s_add_u32 s17, s17, s29
  s_add_u32 m0, s28, 10240
  s_nop 0
  buffer_load_dwordx4 v144, s[8:11], s17 offen lds
  s_add_u32 s17, s17, s29
  s_add_u32 m0, s28, 11264
  s_nop 0
  buffer_load_dwordx4 v144, s[8:11], s17 offen lds
  s_add_u32 s17, s17, s29
  s_add_u32 m0, s28, 12288
  s_nop 0
  buffer_load_dwordx4 v144, s[8:11], s17 offen lds
  s_add_u32 s17, s17, s29
  s_add_u32 m0, s28, 13312
  s_nop 0
  buffer_load_dwordx4 v144, s[8:11], s17 offen lds
  s_add_u32 s17, s17, s29
  s_add_u32 m0, s28, 14336
  s_nop 0
  buffer_load_dwordx4 v144, s[8:11], s17 offen lds
  s_add_u32 s17, s17, s29
  s_add_u32 m0, s28, 15360
  s_nop 0
  buffer_load_dwordx4 v144, s[8:11], s17 offen lds
  s_add_u32 s17, s17, s29
  s_add_u32 m0, s28, 16384
  s_nop 0
  buffer_load_dwordx4 v144, s[8:11], s17 offen lds
  s_add_u32 s17, s17, s29
  s_add_u32 m0, s28, 17408
  s_nop 0
  buffer_load_dwordx4 v144, s[8:11], s17 offen lds
  s_add_u32 s17, s17, s29
  s_add_u32 m0, s28, 18432
  s_nop 0
  buffer_load_dwordx4 v144, s[8:11], s17 offen lds
  s_add_u32 s17, s17, s29
  s_add_u32 m0, s28, 19456
  s_nop 0
  buffer_load_dwordx4 v144, s[8:11], s17 offen lds
  s_add_u32 s17, s17, s29
  s_add_u32 m0, s28, 20480
  s_nop 0
  buffer_load_dwordx4 v144, s[8:11], s17 offen lds
  s_add_u32 s17, s17, s29
  s_add_u32 m0, s28, 21504
  s_nop 0
  buffer_load_dwordx4 v144, s[8:11], s17 offen lds
  s_add_u32 s17, s17, s29
  s_add_u32 m0, s28, 22528
  s_nop 0
  buffer_load_dwordx4 v144, s[8:11], s17 offen lds
  s_add_u32 s17, s17, s29
  s_add_u32 m0, s28, 23552
  s_nop 0
  buffer_load_dwordx4 v144, s[8:11], s17 offen lds
  s_add_u32 s17, s17, s29
  s_add_u32 m0, s28, 24576
  s_nop 0
  buffer_load_dwordx4 v144, s[8:11], s17 offen lds
  s_add_u32 s17, s17, s29
  s_add_u32 m0, s28, 25600
  s_nop 0
  buffer_load_dwordx4 v144, s[8:11], s17 offen lds
  s_add_u32 s17, s17, s29
  s_add_u32 m0, s28, 26624
  s_nop 0
  buffer_load_dwordx4 v144, s[8:11], s17 offen lds
  s_add_u32 s17, s17, s29
  s_add_u32 m0, s28, 27648
  s_nop 0
  buffer_load_dwordx4 v144, s[8:11], s17 offen lds
  s_add_u32 s17, s17, s29
  s_add_u32 m0, s28, 28672
  s_nop 0
  buffer_load_dwordx4 v144, s[8:11], s17 offen lds
  s_add_u32 s17, s17, s29
  s_add_u32 m0, s28, 29696
  s_nop 0
  buffer_load_dwordx4 v144, s[8:11], s17 offen lds
  s_add_u32 s17, s17, s29
  s_add_u32 m0, s28, 30720
  s_nop 0
  buffer_load_dwordx4 v144, s[8:11], s17 offen lds
  s_add_u32 s17, s17, s29
  s_add_u32 m0, s28, 31744
  s_nop 0
  buffer_load_dwordx4 v144, s[8:11], s17 offen lds
  s_add_u32 s17, s17, s29
  v_bfe_u32 v148, v1, 2, 2
  v_lshrrev_b32 v149, 5, v1
  v_lshl_add_u32 v148, v149, 4, v148
  v_bfe_u32 v149, v1, 4, 1
  v_lshl_add_u32 v148, v149, 2, v148
  v_and_b32 v149, 3, v1
  v_lshlrev_b32 v149, 4, v149
  s_mov_b32 s26, 8
  v_lshl_add_u32 v148, v148, 7, v149
  v_add_u32 v152, s28, v148
  v_add_u32 v153, 1024, v152
  v_add_u32 v154, s26, v152
  v_add_u32 v155, s26, v153
  s_waitcnt vmcnt(28)
  ds_read_b64_tr_b16 a[0:1], v152 offset:0
  ds_read_b64_tr_b16 a[2:3], v153 offset:0
  ds_read_b64_tr_b16 a[4:5], v154 offset:0
  ds_read_b64_tr_b16 a[6:7], v155 offset:0
  ds_read_b64_tr_b16 a[8:9], v152 offset:64
  ds_read_b64_tr_b16 a[10:11], v153 offset:64
  ds_read_b64_tr_b16 a[12:13], v154 offset:64
  ds_read_b64_tr_b16 a[14:15], v155 offset:64
  s_waitcnt lgkmcnt(0)
  s_add_u32 m0, s28, 0
  s_nop 0
  buffer_load_dwordx4 v144, s[8:11], s17 offen lds
  s_add_u32 s17, s17, s29
  s_add_u32 m0, s28, 1024
  s_nop 0
  buffer_load_dwordx4 v144, s[8:11], s17 offen lds
  s_add_u32 s17, s17, s29
  s_add_u32 m0, s28, 2048
  s_nop 0
  buffer_load_dwordx4 v144, s[8:11], s17 offen lds
  s_add_u32 s17, s17, s29
  s_add_u32 m0, s28, 3072
  s_nop 0
  buffer_load_dwordx4 v144, s[8:11], s17 offen lds
  s_add_u32 s17, s17, s29
  s_waitcnt vmcnt(28)
  ds_read_b64_tr_b16 a[16:17], v152 offset:4096
  ds_read_b64_tr_b16 a[18:19], v153 offset:4096
  ds_read_b64_tr_b16 a[20:21], v154 offset:4096
  ds_read_b64_tr_b16 a[22:23], v155 offset:4096
  ds_read_b64_tr_b16 a[24:25], v152 offset:4160
  ds_read_b64_tr_b16 a[26:27], v153 offset:4160
  ds_read_b64_tr_b16 a[28:29], v154 offset:4160
  ds_read_b64_tr_b16 a[30:31], v155 offset:4160
  s_waitcnt lgkmcnt(0)
  s_add_u32 m0, s28, 4096
  s_nop 0
  buffer_load_dwordx4 v144, s[8:11], s17 offen lds
  s_add_u32 s17, s17, s29
  s_add_u32 m0, s28, 5120
  s_nop 0
  buffer_load_dwordx4 v144, s[8:11], s17 offen lds
  s_add_u32 s17, s17, s29
  s_add_u32 m0, s28, 6144
  s_nop 0
  buffer_load_dwordx4 v144, s[8:11], s17 offen lds
  s_add_u32 s17, s17, s29
  s_add_u32 m0, s28, 7168
  s_nop 0
  buffer_load_dwordx4 v144, s[8:11], s17 offen lds
  s_add_u32 s17, s17, s29
  s_waitcnt vmcnt(28)
  ds_read_b64_tr_b16 a[32:33], v152 offset:8192
  ds_read_b64_tr_b16 a[34:35], v153 offset:8192
  ds_read_b64_tr_b16 a[36:37], v154 offset:8192
  ds_read_b64_tr_b16 a[38:39], v155 offset:8192
  ds_read_b64_tr_b16 a[40:41], v152 offset:8256
  ds_read_b64_tr_b16 a[42:43], v153 offset:8256
  ds_read_b64_tr_b16 a[44:45], v154 offset:8256
  ds_read_b64_tr_b16 a[46:47], v155 offset:8256
  s_waitcnt lgkmcnt(0)
  s_add_u32 m0, s28, 8192
  s_nop 0
  buffer_load_dwordx4 v144, s[8:11], s17 offen lds
  s_add_u32 s17, s17, s29
  s_add_u32 m0, s28, 9216
  s_nop 0
  buffer_load_dwordx4 v144, s[8:11], s17 offen lds
  s_add_u32 s17, s17, s29
  s_add_u32 m0, s28, 10240
  s_nop 0
  buffer_load_dwordx4 v144, s[8:11], s17 offen lds
  s_add_u32 s17, s17, s29
  s_add_u32 m0, s28, 11264
  s_nop 0
  buffer_load_dwordx4 v144, s[8:11], s17 offen lds
  s_add_u32 s17, s17, s29
  s_waitcnt vmcnt(28)
  ds_read_b64_tr_b16 a[48:49], v152 offset:12288
  ds_read_b64_tr_b16 a[50:51], v153 offset:12288
  ds_read_b64_tr_b16 a[52:53], v154 offset:12288
  ds_read_b64_tr_b16 a[54:55], v155 offset:12288
  ds_read_b64_tr_b16 a[56:57], v152 offset:12352
  ds_read_b64_tr_b16 a[58:59], v153 offset:12352
  ds_read_b64_tr_b16 a[60:61], v154 offset:12352
  ds_read_b64_tr_b16 a[62:63], v155 offset:12352
  s_waitcnt lgkmcnt(0)
  s_add_u32 m0, s28, 12288
  s_nop 0
  buffer_load_dwordx4 v144, s[8:11], s17 offen lds
  s_add_u32 s17, s17, s29
  s_add_u32 m0, s28, 13312
  s_nop 0
  buffer_load_dwordx4 v144, s[8:11], s17 offen lds
  s_add_u32 s17, s17, s29
  s_add_u32 m0, s28, 14336
  s_nop 0
  buffer_load_dwordx4 v144, s[8:11], s17 offen lds
  s_add_u32 s17, s17, s29
  s_add_u32 m0, s28, 15360
  s_nop 0
  buffer_load_dwordx4 v144, s[8:11], s17 offen lds
  s_add_u32 s17, s17, s29
  s_waitcnt vmcnt(28)
  ds_read_b64_tr_b16 a[64:65], v152 offset:16384
  ds_read_b64_tr_b16 a[66:67], v153 offset:16384
  ds_read_b64_tr_b16 a[68:69], v154 offset:16384
  ds_read_b64_tr_b16 a[70:71], v155 offset:16384
  ds_read_b64_tr_b16 a[72:73], v152 offset:16448
  ds_read_b64_tr_b16 a[74:75], v153 offset:16448
  ds_read_b64_tr_b16 a[76:77], v154 offset:16448
  ds_read_b64_tr_b16 a[78:79], v155 offset:16448
  s_waitcnt lgkmcnt(0)
  s_add_u32 m0, s28, 16384
  s_nop 0
  buffer_load_dwordx4 v144, s[8:11], s17 offen lds
  s_add_u32 s17, s17, s29
  s_add_u32 m0, s28, 17408
  s_nop 0
  buffer_load_dwordx4 v144, s[8:11], s17 offen lds
  s_add_u32 s17, s17, s29
  s_add_u32 m0, s28, 18432
  s_nop 0
  buffer_load_dwordx4 v144, s[8:11], s17 offen lds
  s_add_u32 s17, s17, s29
  s_add_u32 m0, s28, 19456
  s_nop 0
  buffer_load_dwordx4 v144, s[8:11], s17 offen lds
  s_add_u32 s17, s17, s29
  s_waitcnt vmcnt(28)
  ds_read_b64_tr_b16 a[80:81], v152 offset:20480
  ds_read_b64_tr_b16 a[82:83], v153 offset:20480
  ds_read_b64_tr_b16 a[84:85], v154 offset:20480
  ds_read_b64_tr_b16 a[86:87], v155 offset:20480
  ds_read_b64_tr_b16 a[88:89], v152 offset:20544
  ds_read_b64_tr_b16 a[90:91], v153 offset:20544
  ds_read_b64_tr_b16 a[92:93], v154 offset:20544
  ds_read_b64_tr_b16 a[94:95], v155 offset:20544
  s_waitcnt lgkmcnt(0)
  s_add_u32 m0, s28, 20480
  s_nop 0
  buffer_load_dwordx4 v144, s[8:11], s17 offen lds
  s_add_u32 s17, s17, s29
  s_add_u32 m0, s28, 21504
  s_nop 0
  buffer_load_dwordx4 v144, s[8:11], s17 offen lds
  s_add_u32 s17, s17, s29
  s_add_u32 m0, s28, 22528
  s_nop 0
  buffer_load_dwordx4 v144, s[8:11], s17 offen lds
  s_add_u32 s17, s17, s29
  s_add_u32 m0, s28, 23552
  s_nop 0
  buffer_load_dwordx4 v144, s[8:11], s17 offen lds
  s_add_u32 s17, s17, s29
  s_waitcnt vmcnt(28)
  ds_read_b64_tr_b16 a[96:97], v152 offset:24576
  ds_read_b64_tr_b16 a[98:99], v153 offset:24576
  ds_read_b64_tr_b16 a[100:101], v154 offset:24576
  ds_read_b64_tr_b16 a[102:103], v155 offset:24576
  ds_read_b64_tr_b16 a[104:105], v152 offset:24640
  ds_read_b64_tr_b16 a[106:107], v153 offset:24640
  ds_read_b64_tr_b16 a[108:109], v154 offset:24640
  ds_read_b64_tr_b16 a[110:111], v155 offset:24640
  s_waitcnt lgkmcnt(0)
  s_add_u32 m0, s28, 24576
  s_nop 0
  buffer_load_dwordx4 v144, s[8:11], s17 offen lds
  s_add_u32 s17, s17, s29
  s_add_u32 m0, s28, 25600
  s_nop 0
  buffer_load_dwordx4 v144, s[8:11], s17 offen lds
  s_add_u32 s17, s17, s29
  s_add_u32 m0, s28, 26624
  s_nop 0
  buffer_load_dwordx4 v144, s[8:11], s17 offen lds
  s_add_u32 s17, s17, s29
  s_add_u32 m0, s28, 27648
  s_nop 0
  buffer_load_dwordx4 v144, s[8:11], s17 offen lds
  s_add_u32 s17, s17, s29
  s_waitcnt vmcnt(28)
  ds_read_b64_tr_b16 a[112:113], v152 offset:28672
  ds_read_b64_tr_b16 a[114:115], v153 offset:28672
  ds_read_b64_tr_b16 a[116:117], v154 offset:28672
  ds_read_b64_tr_b16 a[118:119], v155 offset:28672
  ds_read_b64_tr_b16 a[120:121], v152 offset:28736
  ds_read_b64_tr_b16 a[122:123], v153 offset:28736
  ds_read_b64_tr_b16 a[124:125], v154 offset:28736
  ds_read_b64_tr_b16 a[126:127], v155 offset:28736
  s_waitcnt lgkmcnt(0)
  s_add_u32 m0, s28, 28672
  s_nop 0
  buffer_load_dwordx4 v144, s[8:11], s17 offen lds
  s_add_u32 s17, s17, s29
  s_add_u32 m0, s28, 29696
  s_nop 0
  buffer_load_dwordx4 v144, s[8:11], s17 offen lds
  s_add_u32 s17, s17, s29
  s_add_u32 m0, s28, 30720
  s_nop 0
  buffer_load_dwordx4 v144, s[8:11], s17 offen lds
  s_add_u32 s17, s17, s29
  s_add_u32 m0, s28, 31744
  s_nop 0
  buffer_load_dwordx4 v144, s[8:11], s17 offen lds
  s_add_u32 s17, s17, s29
  s_waitcnt vmcnt(28)
  ds_read_b64_tr_b16 a[128:129], v152 offset:0
  ds_read_b64_tr_b16 a[130:131], v153 offset:0
  ds_read_b64_tr_b16 a[132:133], v154 offset:0
  ds_read_b64_tr_b16 a[134:135], v155 offset:0
  ds_read_b64_tr_b16 a[136:137], v152 offset:64
  ds_read_b64_tr_b16 a[138:139], v153 offset:64
  ds_read_b64_tr_b16 a[140:141], v154 offset:64
  ds_read_b64_tr_b16 a[142:143], v155 offset:64
  s_waitcnt lgkmcnt(0)
  s_waitcnt vmcnt(24)
  ds_read_b64_tr_b16 a[144:145], v152 offset:4096
  ds_read_b64_tr_b16 a[146:147], v153 offset:4096
  ds_read_b64_tr_b16 a[148:149], v154 offset:4096
  ds_read_b64_tr_b16 a[150:151], v155 offset:4096
  ds_read_b64_tr_b16 a[152:153], v152 offset:4160
  ds_read_b64_tr_b16 a[154:155], v153 offset:4160
  ds_read_b64_tr_b16 a[156:157], v154 offset:4160
  ds_read_b64_tr_b16 a[158:159], v155 offset:4160
  s_waitcnt lgkmcnt(0)
  s_waitcnt vmcnt(20)
  ds_read_b64_tr_b16 a[160:161], v152 offset:8192
  ds_read_b64_tr_b16 a[162:163], v153 offset:8192
  ds_read_b64_tr_b16 a[164:165], v154 offset:8192
  ds_read_b64_tr_b16 a[166:167], v155 offset:8192
  ds_read_b64_tr_b16 a[168:169], v152 offset:8256
  ds_read_b64_tr_b16 a[170:171], v153 offset:8256
  ds_read_b64_tr_b16 a[172:173], v154 offset:8256
  ds_read_b64_tr_b16 a[174:175], v155 offset:8256
  s_waitcnt lgkmcnt(0)
  s_waitcnt vmcnt(16)
  ds_read_b64_tr_b16 a[176:177], v152 offset:12288
  ds_read_b64_tr_b16 a[178:179], v153 offset:12288
  ds_read_b64_tr_b16 a[180:181], v154 offset:12288
  ds_read_b64_tr_b16 a[182:183], v155 offset:12288
  ds_read_b64_tr_b16 a[184:185], v152 offset:12352
  ds_read_b64_tr_b16 a[186:187], v153 offset:12352
  ds_read_b64_tr_b16 a[188:189], v154 offset:12352
  ds_read_b64_tr_b16 a[190:191], v155 offset:12352
  s_waitcnt lgkmcnt(0)
  s_waitcnt vmcnt(12)
  ds_read_b64_tr_b16 a[192:193], v152 offset:16384
  ds_read_b64_tr_b16 a[194:195], v153 offset:16384
  ds_read_b64_tr_b16 a[196:197], v154 offset:16384
  ds_read_b64_tr_b16 a[198:199], v155 offset:16384
  ds_read_b64_tr_b16 a[200:201], v152 offset:16448
  ds_read_b64_tr_b16 a[202:203], v153 offset:16448
  ds_read_b64_tr_b16 a[204:205], v154 offset:16448
  ds_read_b64_tr_b16 a[206:207], v155 offset:16448
  s_waitcnt lgkmcnt(0)
  s_waitcnt vmcnt(8)
  ds_read_b64_tr_b16 a[208:209], v152 offset:20480
  ds_read_b64_tr_b16 a[210:211], v153 offset:20480
  ds_read_b64_tr_b16 a[212:213], v154 offset:20480
  ds_read_b64_tr_b16 a[214:215], v155 offset:20480
  ds_read_b64_tr_b16 a[216:217], v152 offset:20544
  ds_read_b64_tr_b16 a[218:219], v153 offset:20544
  ds_read_b64_tr_b16 a[220:221], v154 offset:20544
  ds_read_b64_tr_b16 a[222:223], v155 offset:20544
  s_waitcnt lgkmcnt(0)
  s_waitcnt vmcnt(4)
  ds_read_b64_tr_b16 a[224:225], v152 offset:24576
  ds_read_b64_tr_b16 a[226:227], v153 offset:24576
  ds_read_b64_tr_b16 a[228:229], v154 offset:24576
  ds_read_b64_tr_b16 a[230:231], v155 offset:24576
  ds_read_b64_tr_b16 a[232:233], v152 offset:24640
  ds_read_b64_tr_b16 a[234:235], v153 offset:24640
  ds_read_b64_tr_b16 a[236:237], v154 offset:24640
  ds_read_b64_tr_b16 a[238:239], v155 offset:24640
  s_waitcnt lgkmcnt(0)
  s_waitcnt vmcnt(0)
  ds_read_b64_tr_b16 a[240:241], v152 offset:28672
  ds_read_b64_tr_b16 a[242:243], v153 offset:28672
  ds_read_b64_tr_b16 a[244:245], v154 offset:28672
  ds_read_b64_tr_b16 a[246:247], v155 offset:28672
  ds_read_b64_tr_b16 a[248:249], v152 offset:28736
  ds_read_b64_tr_b16 a[250:251], v153 offset:28736
  ds_read_b64_tr_b16 a[252:253], v154 offset:28736
  ds_read_b64_tr_b16 a[254:255], v155 offset:28736
  s_waitcnt lgkmcnt(0)
  s_lshl_b32 s26, s48, 2
  s_add_u32 s26, s26, s16
  s_lshl_b32 s27, s26, 6
  s_add_u32 s27, s27, s50
  s_lshl_b32 s19, s27, 13
  s_lshl_b32 s27, s50, 5
  s_add_u32 s27, s27, s26
  s_mul_i32 s27, s27, 4096
  s_add_u32 s20, s27, 135266304
  s_lshl_b32 s25, s16, 12
  s_add_u32 s25, s25, 65536
  s_lshl_b32 s26, s16, 13
  v_add_u32 v3, s26, v2
  v_lshrrev_b32 v16, 5, v1
  v_and_b32 v17, 31, v1
  v_bfe_u32 v18, v1, 4, 1
  v_lshl_add_u32 v18, v18, 1, v16
  v_and_b32 v19, 15, v1
  v_lshl_add_u32 v18, v18, 4, v19
  v_lshl_add_u32 v5, v18, 4, s25
  v_bfe_u32 v18, v1, 2, 2
  v_lshl_add_u32 v18, v16, 2, v18
  v_and_b32 v19, 1, v1
  v_lshl_add_u32 v18, v19, 4, v18
  v_lshl_add_u32 v4, v18, 4, s25
  v_lshlrev_b32 v16, 2, v16
  v_sub_u32 v17, v17, v16
  v_mov_b32 v18, 0xf149f2ca
  v_cmp_le_i32 vcc, 0, v17
  s_nop 1
  v_cndmask_b32 v240, v18, 0, vcc
  v_cmp_le_i32 vcc, 1, v17
  s_nop 1
  v_cndmask_b32 v241, v18, 0, vcc
  v_cmp_le_i32 vcc, 2, v17
  s_nop 1
  v_cndmask_b32 v242, v18, 0, vcc
  v_cmp_le_i32 vcc, 3, v17
  s_nop 1
  v_cndmask_b32 v243, v18, 0, vcc
  v_cmp_le_i32 vcc, 8, v17
  s_nop 1
  v_cndmask_b32 v244, v18, 0, vcc
  v_cmp_le_i32 vcc, 9, v17
  s_nop 1
  v_cndmask_b32 v245, v18, 0, vcc
  v_cmp_le_i32 vcc, 10, v17
  s_nop 1
  v_cndmask_b32 v246, v18, 0, vcc
  v_cmp_le_i32 vcc, 11, v17
  s_nop 1
  v_cndmask_b32 v247, v18, 0, vcc
  v_cmp_le_i32 vcc, 16, v17
  s_nop 1
  v_cndmask_b32 v248, v18, 0, vcc
  v_cmp_le_i32 vcc, 17, v17
  s_nop 1
  v_cndmask_b32 v249, v18, 0, vcc
  v_cmp_le_i32 vcc, 18, v17
  s_nop 1
  v_cndmask_b32 v250, v18, 0, vcc
  v_cmp_le_i32 vcc, 19, v17
  s_nop 1
  v_cndmask_b32 v251, v18, 0, vcc
  v_cmp_le_i32 vcc, 24, v17
  s_nop 1
  v_cndmask_b32 v252, v18, 0, vcc
  v_cmp_le_i32 vcc, 25, v17
  s_nop 1
  v_cndmask_b32 v253, v18, 0, vcc
  v_cmp_le_i32 vcc, 26, v17
  s_nop 1
  v_cndmask_b32 v254, v18, 0, vcc
  v_cmp_le_i32 vcc, 27, v17
  s_nop 1
  v_cndmask_b32 v255, v18, 0, vcc
  v_mov_b32 v21, v2
  s_barrier
  s_lshl_b32 s77, s48, 2
  s_add_u32 s77, s77, s16
  s_mul_i32 s78, s77, 896
  s_add_u32 s76, s78, 148898304
  s_mov_b32 s71, 0
  s_branch M_sg_229
M_sw_228:
  s_sleep 8
  s_add_u32 s71, s71, 1
  s_cmp_gt_u32 s71, 262144
  s_cbranch_scc1 M_exit
M_sg_229:
  s_mov_b32 s79, 0
  s_atomic_or s79, s[72:73], s76 glc
  s_waitcnt lgkmcnt(0)
  s_cmp_lt_u32 s79, 16
  s_cbranch_scc1 M_sw_228
  s_add_u32 s76, s78, 148898048
  s_mov_b32 s71, 0
  s_branch M_sg_231
M_sw_230:
  s_sleep 8
  s_add_u32 s71, s71, 1
  s_cmp_gt_u32 s71, 262144
  s_cbranch_scc1 M_exit
M_sg_231:
  s_mov_b32 s79, 0
  s_atomic_or s79, s[72:73], s76 glc
  s_waitcnt lgkmcnt(0)
  s_cmp_lt_u32 s79, 8
  s_cbranch_scc1 M_sw_230
  s_add_u32 s76, s78, 148898176
  s_mov_b32 s71, 0
  s_branch M_sg_233
M_sw_232:
  s_sleep 8
  s_add_u32 s71, s71, 1
  s_cmp_gt_u32 s71, 262144
  s_cbranch_scc1 M_exit
M_sg_233:
  s_mov_b32 s79, 0
  s_atomic_or s79, s[72:73], s76 glc
  s_waitcnt lgkmcnt(0)
  s_cmp_lt_u32 s79, 8
  s_cbranch_scc1 M_sw_232
M_xok_227:
  s_lshl_b32 s77, s77, 7
  s_add_u32 s54, s77, 148926464
  s_add_u32 s52, s50, 1
  s_mov_b32 s53, 0
  s_mov_b32 s30, 0x200
  s_add_u32 s28, s19, 50331648
  buffer_load_dwordx4 v[144:147], v21, s[4:7], s28 offen offset:0 sc1
  buffer_load_dwordx4 v[148:151], v21, s[4:7], s28 offen offset:1024 sc1
  buffer_load_dwordx4 v[152:155], v21, s[4:7], s28 offen offset:2048 sc1
  buffer_load_dwordx4 v[156:159], v21, s[4:7], s28 offen offset:3072 sc1
  s_add_u32 s29, s19, 50335744
  buffer_load_dwordx4 v[160:163], v21, s[4:7], s29 offen offset:0 sc1
  buffer_load_dwordx4 v[164:167], v21, s[4:7], s29 offen offset:1024 sc1
  buffer_load_dwordx4 v[168:171], v21, s[4:7], s29 offen offset:2048 sc1
  buffer_load_dwordx4 v[172:175], v21, s[4:7], s29 offen offset:3072 sc1
  s_add_u32 s28, s19, 67108864
  buffer_load_dwordx4 v[176:179], v21, s[4:7], s28 offen offset:0 sc1
  buffer_load_dwordx4 v[180:183], v21, s[4:7], s28 offen offset:1024 sc1
  buffer_load_dwordx4 v[184:187], v21, s[4:7], s28 offen offset:2048 sc1
  buffer_load_dwordx4 v[188:191], v21, s[4:7], s28 offen offset:3072 sc1
  s_add_u32 s29, s19, 67112960
  buffer_load_dwordx4 v[192:195], v21, s[4:7], s29 offen offset:0 sc1
  buffer_load_dwordx4 v[196:199], v21, s[4:7], s29 offen offset:1024 sc1
  buffer_load_dwordx4 v[200:203], v21, s[4:7], s29 offen offset:2048 sc1
  buffer_load_dwordx4 v[204:207], v21, s[4:7], s29 offen offset:3072 sc1
  s_add_u32 s28, s19, 83886080
  buffer_load_dwordx4 v[208:211], v21, s[4:7], s28 offen offset:0 sc1
  buffer_load_dwordx4 v[212:215], v21, s[4:7], s28 offen offset:1024 sc1
  buffer_load_dwordx4 v[216:219], v21, s[4:7], s28 offen offset:2048 sc1
  buffer_load_dwordx4 v[220:223], v21, s[4:7], s28 offen offset:3072 sc1
  s_add_u32 s29, s19, 83890176
  buffer_load_dwordx4 v[224:227], v21, s[4:7], s29 offen offset:0 sc1
  buffer_load_dwordx4 v[228:231], v21, s[4:7], s29 offen offset:1024 sc1
  buffer_load_dwordx4 v[232:235], v21, s[4:7], s29 offen offset:2048 sc1
  buffer_load_dwordx4 v[236:239], v21, s[4:7], s29 offen offset:3072 sc1
  s_mov_b32 s24, 0
  v_mov_b32 v22, 0x40000000
  s_sub_u32 s21, s21, s22
F_top_234:
  s_waitcnt vmcnt(8)
  v_mfma_f32_32x32x16_bf16 v[24:39], v[176:179], v[144:147], v[240:255]
  s_nop 1
  v_cvt_pk_bf16_f32 v128, v64, v65
  v_cvt_pk_bf16_f32 v129, v66, v67
  v_cvt_pk_bf16_f32 v130, v68, v69
  v_cvt_pk_bf16_f32 v131, v70, v71
  v_mfma_f32_32x32x16_bf16 v[24:39], v[180:183], v[148:151], v[24:39]
  buffer_store_dwordx4 v[128:131], v22, s[4:7], s21 offen offset:0 sc1
  v_mfma_f32_32x32x16_bf16 v[24:39], v[184:187], v[152:155], v[24:39]
  v_cvt_pk_bf16_f32 v132, v72, v73
  v_cvt_pk_bf16_f32 v133, v74, v75
  v_cvt_pk_bf16_f32 v134, v76, v77
  v_cvt_pk_bf16_f32 v135, v78, v79
  v_mfma_f32_32x32x16_bf16 v[24:39], v[188:191], v[156:159], v[24:39]
  buffer_store_dwordx4 v[132:135], v22, s[4:7], s21 offen offset:256 sc1
  v_mfma_f32_32x32x16_bf16 v[24:39], v[192:195], v[160:163], v[24:39]
  v_cvt_pk_bf16_f32 v136, v80, v81
  v_cvt_pk_bf16_f32 v137, v82, v83
  v_cvt_pk_bf16_f32 v138, v84, v85
  v_cvt_pk_bf16_f32 v139, v86, v87
  v_mfma_f32_32x32x16_bf16 v[24:39], v[196:199], v[164:167], v[24:39]
  buffer_store_dwordx4 v[136:139], v22, s[4:7], s21 offen offset:2048 sc1
  v_mfma_f32_32x32x16_bf16 v[24:39], v[200:203], v[168:171], v[24:39]
  v_cvt_pk_bf16_f32 v140, v88, v89
  v_cvt_pk_bf16_f32 v141, v90, v91
  v_cvt_pk_bf16_f32 v142, v92, v93
  v_cvt_pk_bf16_f32 v143, v94, v95
  v_mfma_f32_32x32x16_bf16 v[24:39], v[204:207], v[172:175], v[24:39]
  buffer_store_dwordx4 v[140:143], v22, s[4:7], s21 offen offset:2304 sc1
  s_add_u32 s21, s21, s22
  v_mov_b32 v22, v20
  s_cmp_lg_u32 s24, 0
  s_cbranch_scc1 F_have_235
  s_cmp_le_u32 s52, 58
  s_cbranch_scc1 M_dp_236
  s_mov_b32 s71, 0
  v_add_u32 v16, s25, v2
  s_waitcnt vmcnt(9)
  s_branch M_dp_238
M_dp_237:
  s_add_u32 s71, s71, 1
  s_cmp_gt_u32 s71, 262144
  s_cbranch_scc1 M_exit
  buffer_load_dword v23, off, s[4:7], s54 sc1
  buffer_load_dwordx4 v[96:99], v2, s[4:7], s20 offen offset:0 sc1
  buffer_load_dwordx4 v[100:103], v2, s[4:7], s20 offen offset:1024 sc1
  buffer_load_dwordx4 v[104:107], v2, s[4:7], s20 offen offset:2048 sc1
  buffer_load_dwordx4 v[108:111], v2, s[4:7], s20 offen offset:3072 sc1
  s_waitcnt vmcnt(0)
M_dp_238:
  v_max_u32 v17, v96, v97
  v_max3_u32 v17, v17, v98, v99
  v_max3_u32 v17, v17, v100, v101
  v_max3_u32 v17, v17, v102, v103
  v_max3_u32 v17, v17, v104, v105
  v_max3_u32 v17, v17, v106, v107
  v_max3_u32 v17, v17, v108, v109
  v_max3_u32 v17, v17, v110, v111
  v_cmp_eq_u32 vcc, -1, v17
  s_cbranch_vccz M_dp_239
  v_cmp_gt_u32 vcc, s52, v23
  s_cbranch_vccnz M_dp_237
  s_branch M_dp_236
M_dp_239:
  ds_write_b128 v16, v[96:99] offset:0
  ds_write_b128 v16, v[100:103] offset:1024
  ds_write_b128 v16, v[104:107] offset:2048
  ds_write_b128 v16, v[108:111] offset:3072
  s_branch F_have_235
M_dp_236:
  v_mov_b32 v16, s54
  v_mov_b32 v17, s52
  s_mov_b32 s71, 0
  s_branch M_vg_241
M_vw_240:
  s_sleep 2
  s_add_u32 s71, s71, 1
  s_cmp_gt_u32 s71, 262144
  s_cbranch_scc1 M_exit
M_vg_241:
  buffer_load_dword v23, v16, s[4:7], 0 offen sc1
  s_waitcnt vmcnt(0)
  v_cmp_lt_u32 vcc, v23, v17
  s_cbranch_vccnz M_vw_240
  s_mov_b32 m0, s25
  s_nop 0
  buffer_load_dwordx4 v2, s[4:7], s20 offen offset:0 sc1 lds
  buffer_load_dwordx4 v2, s[4:7], s20 offen offset:1024 sc1 lds
  buffer_load_dwordx4 v2, s[4:7], s20 offen offset:2048 sc1 lds
  buffer_load_dwordx4 v2, s[4:7], s20 offen offset:3072 sc1 lds
  s_waitcnt vmcnt(0)
F_have_235:
  ds_read_b64_tr_b16 v[176:177], v4 offset:8
  ds_read_b64_tr_b16 v[178:179], v4 offset:136
  ds_read_b64_tr_b16 v[180:181], v4 offset:520
  ds_read_b64_tr_b16 v[182:183], v4 offset:648
  ds_read_b64_tr_b16 v[184:185], v4 offset:1032
  ds_read_b64_tr_b16 v[186:187], v4 offset:1160
  ds_read_b64_tr_b16 v[188:189], v4 offset:1544
  ds_read_b64_tr_b16 v[190:191], v4 offset:1672
  ds_read_b64_tr_b16 v[192:193], v4 offset:2056
  ds_read_b64_tr_b16 v[194:195], v4 offset:2184
  ds_read_b64_tr_b16 v[196:197], v4 offset:2568
  ds_read_b64_tr_b16 v[198:199], v4 offset:2696
  s_sub_u32 s23, s23, 1
  s_cmp_gt_u32 s23, 0
  s_cselect_b32 s26, s51, 0
  s_cselect_b32 s27, 0, 0x40000000
  v_or_b32 v21, s27, v21
  s_lshl_b32 s27, s26, 13
  s_add_u32 s19, s19, s27
  s_mul_i32 s27, s26, 131072
  s_add_u32 s20, s20, s27
  s_cmp_lg_u32 s23, 24
  s_cbranch_scc1 M_xok_242
  s_lshl_b32 s77, s48, 2
  s_add_u32 s77, s77, s16
  s_mul_i32 s78, s77, 896
  s_add_u32 s76, s78, 148898304
  s_mov_b32 s71, 0
  s_branch M_sg_244
M_sw_243:
  s_sleep 8
  s_add_u32 s71, s71, 1
  s_cmp_gt_u32 s71, 262144
  s_cbranch_scc1 M_exit
M_sg_244:
  s_mov_b32 s79, 0
  s_atomic_or s79, s[72:73], s76 glc
  s_waitcnt lgkmcnt(0)
  s_cmp_lt_u32 s79, 32
  s_cbranch_scc1 M_sw_243
  s_add_u32 s76, s78, 148898432
  s_mov_b32 s71, 0
  s_branch M_sg_246
M_sw_245:
  s_sleep 8
  s_add_u32 s71, s71, 1
  s_cmp_gt_u32 s71, 262144
  s_cbranch_scc1 M_exit
M_sg_246:
  s_mov_b32 s79, 0
  s_atomic_or s79, s[72:73], s76 glc
  s_waitcnt lgkmcnt(0)
  s_cmp_lt_u32 s79, 32
  s_cbranch_scc1 M_sw_245
  s_add_u32 s76, s78, 148898048
  s_mov_b32 s71, 0
  s_branch M_sg_248
M_sw_247:
  s_sleep 8
  s_add_u32 s71, s71, 1
  s_cmp_gt_u32 s71, 262144
  s_cbranch_scc1 M_exit
M_sg_248:
  s_mov_b32 s79, 0
  s_atomic_or s79, s[72:73], s76 glc
  s_waitcnt lgkmcnt(0)
  s_cmp_lt_u32 s79, 32
  s_cbranch_scc1 M_sw_247
  s_add_u32 s76, s78, 148898176
  s_mov_b32 s71, 0
  s_branch M_sg_250
M_sw_249:
  s_sleep 8
  s_add_u32 s71, s71, 1
  s_cmp_gt_u32 s71, 262144
  s_cbranch_scc1 M_exit
M_sg_250:
  s_mov_b32 s79, 0
  s_atomic_or s79, s[72:73], s76 glc
  s_waitcnt lgkmcnt(0)
  s_cmp_lt_u32 s79, 32
  s_cbranch_scc1 M_sw_249
M_xok_242:
  s_waitcnt lgkmcnt(10)
  v_mfma_f32_32x32x16_bf16 v[40:55], v[176:179], v[144:147], 0
  ds_read_b64_tr_b16 v[200:201], v4 offset:3080
  ds_read_b64_tr_b16 v[202:203], v4 offset:3208
  v_max_f32 v6, v24, v25
  s_waitcnt lgkmcnt(10)
  v_mfma_f32_32x32x16_bf16 v[40:55], v[180:183], v[148:151], v[40:55]
  ds_read_b64_tr_b16 v[204:205], v4 offset:3592
  ds_read_b64_tr_b16 v[206:207], v4 offset:3720
  v_max3_f32 v6, v6, v26, v27
  s_waitcnt lgkmcnt(10)
  v_mfma_f32_32x32x16_bf16 v[40:55], v[184:187], v[152:155], v[40:55]
  ds_read_b64 v[56:57], v5 offset:0
  ds_read_b64 v[58:59], v5 offset:1024
  v_max3_f32 v6, v6, v28, v29
  s_waitcnt lgkmcnt(10)
  v_mfma_f32_32x32x16_bf16 v[40:55], v[188:191], v[156:159], v[40:55]
  ds_read_b64 v[60:61], v5 offset:2048
  ds_read_b64 v[62:63], v5 offset:3072
  v_max3_f32 v6, v6, v30, v31
  s_waitcnt lgkmcnt(10)
  v_mfma_f32_32x32x16_bf16 v[40:55], v[192:195], v[160:163], v[40:55]
  v_max3_f32 v6, v6, v32, v33
  s_waitcnt lgkmcnt(8)
  v_mfma_f32_32x32x16_bf16 v[40:55], v[196:199], v[164:167], v[40:55]
  v_max3_f32 v6, v6, v34, v35
  s_waitcnt lgkmcnt(6)
  v_mfma_f32_32x32x16_bf16 v[40:55], v[200:203], v[168:171], v[40:55]
  v_max3_f32 v6, v6, v36, v37
  s_waitcnt lgkmcnt(4)
  v_mfma_f32_32x32x16_bf16 v[40:55], v[204:207], v[172:175], v[40:55]
  v_max3_f32 v6, v6, v38, v39
  s_add_u32 s28, s19, 50331648
  buffer_load_dwordx4 v[144:147], v21, s[4:7], s28 offen offset:0 sc1
  buffer_load_dwordx4 v[148:151], v21, s[4:7], s28 offen offset:1024 sc1
  s_nop 7
  v_max3_f32 v6, v6, v40, v41
  v_max3_f32 v6, v6, v42, v43
  v_mov_b32 v16, v6
  s_nop 1
  v_permlane32_swap_b32 v6, v16
  s_nop 1
  v_max_f32 v6, v6, v16
  v_pk_add_f32 v[24:25], v[24:25], v[6:7] op_sel_hi:[1,0] neg_lo:[0,1] neg_hi:[0,1]
  v_pk_add_f32 v[26:27], v[26:27], v[6:7] op_sel_hi:[1,0] neg_lo:[0,1] neg_hi:[0,1]
  v_pk_add_f32 v[28:29], v[28:29], v[6:7] op_sel_hi:[1,0] neg_lo:[0,1] neg_hi:[0,1]
  v_pk_add_f32 v[30:31], v[30:31], v[6:7] op_sel_hi:[1,0] neg_lo:[0,1] neg_hi:[0,1]
  v_pk_add_f32 v[32:33], v[32:33], v[6:7] op_sel_hi:[1,0] neg_lo:[0,1] neg_hi:[0,1]
  v_pk_add_f32 v[34:35], v[34:35], v[6:7] op_sel_hi:[1,0] neg_lo:[0,1] neg_hi:[0,1]
  v_pk_add_f32 v[36:37], v[36:37], v[6:7] op_sel_hi:[1,0] neg_lo:[0,1] neg_hi:[0,1]
  v_pk_add_f32 v[38:39], v[38:39], v[6:7] op_sel_hi:[1,0] neg_lo:[0,1] neg_hi:[0,1]
  v_pk_add_f32 v[40:41], v[40:41], v[6:7] op_sel_hi:[1,0] neg_lo:[0,1] neg_hi:[0,1]
  v_pk_add_f32 v[42:43], v[42:43], v[6:7] op_sel_hi:[1,0] neg_lo:[0,1] neg_hi:[0,1]
  v_exp_f32 v24, v24
  v_exp_f32 v25, v25
  v_exp_f32 v26, v26
  v_exp_f32 v27, v27
  v_exp_f32 v28, v28
  v_exp_f32 v29, v29
  v_exp_f32 v30, v30
  v_exp_f32 v31, v31
  v_exp_f32 v32, v32
  v_exp_f32 v33, v33
  buffer_load_dwordx4 v[152:155], v21, s[4:7], s28 offen offset:2048 sc1
  v_exp_f32 v34, v34
  v_exp_f32 v35, v35
  v_exp_f32 v36, v36
  v_exp_f32 v37, v37
  v_exp_f32 v38, v38
  v_exp_f32 v39, v39
  v_exp_f32 v40, v40
  v_exp_f32 v41, v41
  v_exp_f32 v42, v42
  v_exp_f32 v43, v43
  v_pk_add_f32 v[16:17], v[24:25], v[26:27]
  v_pk_add_f32 v[16:17], v[16:17], v[28:29]
  v_pk_add_f32 v[16:17], v[16:17], v[30:31]
  v_pk_add_f32 v[16:17], v[16:17], v[32:33]
  v_pk_add_f32 v[16:17], v[16:17], v[34:35]
  v_pk_add_f32 v[16:17], v[16:17], v[36:37]
  v_pk_add_f32 v[16:17], v[16:17], v[38:39]
  v_pk_add_f32 v[16:17], v[16:17], v[40:41]
  v_pk_add_f32 v[16:17], v[16:17], v[42:43]
  v_add_f32 v16, v16, v17
  v_mov_b32 v17, v16
  buffer_load_dwordx4 v[156:159], v21, s[4:7], s28 offen offset:3072 sc1
  s_nop 0
  v_permlane32_swap_b32 v16, v17
  s_nop 1
  v_add_f32 v16, v16, v17
  v_rcp_f32 v6, v16
  s_nop 0
  v_pk_mul_f32 v[24:25], v[24:25], v[6:7] op_sel_hi:[1,0]
  v_pk_mul_f32 v[26:27], v[26:27], v[6:7] op_sel_hi:[1,0]
  v_pk_mul_f32 v[28:29], v[28:29], v[6:7] op_sel_hi:[1,0]
  v_pk_mul_f32 v[30:31], v[30:31], v[6:7] op_sel_hi:[1,0]
  v_pk_mul_f32 v[32:33], v[32:33], v[6:7] op_sel_hi:[1,0]
  v_pk_mul_f32 v[34:35], v[34:35], v[6:7] op_sel_hi:[1,0]
  v_pk_mul_f32 v[36:37], v[36:37], v[6:7] op_sel_hi:[1,0]
  v_pk_mul_f32 v[38:39], v[38:39], v[6:7] op_sel_hi:[1,0]
  v_pk_mul_f32 v[40:41], v[40:41], v[6:7] op_sel_hi:[1,0]
  v_pk_mul_f32 v[42:43], v[42:43], v[6:7] op_sel_hi:[1,0]
  v_cvt_pk_bf16_f32 v128, v24, v25
  v_cvt_pk_bf16_f32 v129, v26, v27
  v_cvt_pk_bf16_f32 v130, v28, v29
  v_cvt_pk_bf16_f32 v131, v30, v31
  v_cvt_pk_bf16_f32 v132, v32, v33
  v_cvt_pk_bf16_f32 v133, v34, v35
  v_cvt_pk_bf16_f32 v134, v36, v37
  v_cvt_pk_bf16_f32 v135, v38, v39
  v_cvt_pk_bf16_f32 v136, v40, v41
  v_cvt_pk_bf16_f32 v137, v42, v43
  s_waitcnt vmcnt(8) lgkmcnt(0)
  v_mfma_f32_32x32x16_bf16 v[64:79], v[208:211], v[128:131], 0
  s_add_u32 s29, s19, 50335744
  buffer_load_dwordx4 v[160:163], v21, s[4:7], s29 offen offset:0 sc1
  v_mfma_f32_32x32x16_bf16 v[64:79], v[212:215], v[132:135], v[64:79]
  v_mfma_f32_32x32x8_bf16 v[64:79], v[56:57], v[136:137], v[64:79]
  v_mfma_f32_32x32x16_bf16 v[80:95], v[216:219], v[128:131], 0
  buffer_load_dwordx4 v[164:167], v21, s[4:7], s29 offen offset:1024 sc1
  v_mfma_f32_32x32x16_bf16 v[80:95], v[220:223], v[132:135], v[80:95]
  v_cvt_pk_bf16_f32 v24, v64, v65
  v_cvt_pk_bf16_f32 v25, v66, v67
  v_cvt_pk_bf16_f32 v26, v68, v69
  v_cvt_pk_bf16_f32 v27, v70, v71
  v_mfma_f32_32x32x8_bf16 v[80:95], v[58:59], v[136:137], v[80:95]
  ds_write_b128 v3, v[24:27] offset:0
  v_cvt_pk_bf16_f32 v28, v72, v73
  v_cvt_pk_bf16_f32 v29, v74, v75
  v_cvt_pk_bf16_f32 v30, v76, v77
  v_cvt_pk_bf16_f32 v31, v78, v79
  v_mfma_f32_32x32x16_bf16 v[96:111], v[224:227], v[128:131], 0
  ds_write_b128 v3, v[28:31] offset:1024
  buffer_load_dwordx4 v[168:171], v21, s[4:7], s29 offen offset:2048 sc1
  v_mfma_f32_32x32x16_bf16 v[96:111], v[228:231], v[132:135], v[96:111]
  v_cvt_pk_bf16_f32 v32, v80, v81
  v_cvt_pk_bf16_f32 v33, v82, v83
  v_cvt_pk_bf16_f32 v34, v84, v85
  v_cvt_pk_bf16_f32 v35, v86, v87
  v_mfma_f32_32x32x8_bf16 v[96:111], v[60:61], v[136:137], v[96:111]
  ds_write_b128 v3, v[32:35] offset:2048
  v_cvt_pk_bf16_f32 v36, v88, v89
  v_cvt_pk_bf16_f32 v37, v90, v91
  v_cvt_pk_bf16_f32 v38, v92, v93
  v_cvt_pk_bf16_f32 v39, v94, v95
  v_mfma_f32_32x32x16_bf16 v[112:127], v[232:235], v[128:131], 0
  ds_write_b128 v3, v[36:39] offset:3072
  buffer_load_dwordx4 v[172:175], v21, s[4:7], s29 offen offset:3072 sc1
  v_mfma_f32_32x32x16_bf16 v[112:127], v[236:239], v[132:135], v[112:127]
  v_cvt_pk_bf16_f32 v40, v96, v97
  v_cvt_pk_bf16_f32 v41, v98, v99
  v_cvt_pk_bf16_f32 v42, v100, v101
  v_cvt_pk_bf16_f32 v43, v102, v103
  v_mfma_f32_32x32x8_bf16 v[112:127], v[62:63], v[136:137], v[112:127]
  ds_write_b128 v3, v[40:43] offset:4096
  v_cvt_pk_bf16_f32 v44, v104, v105
  v_cvt_pk_bf16_f32 v45, v106, v107
  v_cvt_pk_bf16_f32 v46, v108, v109
  v_cvt_pk_bf16_f32 v47, v110, v111
  ds_write_b128 v3, v[44:47] offset:5120
  s_nop 5
  v_cvt_pk_bf16_f32 v48, v112, v113
  v_cvt_pk_bf16_f32 v49, v114, v115
  v_cvt_pk_bf16_f32 v50, v116, v117
  v_cvt_pk_bf16_f32 v51, v118, v119
  ds_write_b128 v3, v[48:51] offset:6144
  v_cvt_pk_bf16_f32 v52, v120, v121
  v_cvt_pk_bf16_f32 v53, v122, v123
  v_cvt_pk_bf16_f32 v54, v124, v125
  v_cvt_pk_bf16_f32 v55, v126, v127
  ds_write_b128 v3, v[52:55] offset:7168
  s_waitcnt vmcnt(8)
  s_waitcnt lgkmcnt(0)
  s_barrier
  ds_read_b128 v[24:27], v8 offset:0
  ds_read_b128 v[28:31], v9 offset:0
  ds_read_b128 v[32:35], v10 offset:0
  ds_read_b128 v[36:39], v11 offset:0
  ds_read_b128 v[40:43], v12 offset:0
  ds_read_b128 v[44:47], v13 offset:0
  buffer_load_dword v23, off, s[4:7], s54 sc1
  v_mov_b32 v16, s30
  v_min_u32 v17, 1, v0
  v_lshlrev_b32 v17, 30, v17
  buffer_store_dword v16, v17, s[4:7], s31 offen sc1
  s_add_u32 s30, s30, 1
  s_add_u32 s52, s52, 2
  s_waitcnt lgkmcnt(5)
  v_mfma_f32_16x16x32_bf16 v[64:67], a[0:3], v[24:27], 0
  s_add_u32 s28, s19, 67108864
  ds_read_b128 v[48:51], v14 offset:0
  v_mfma_f32_16x16x32_bf16 v[68:71], a[4:7], v[24:27], 0
  v_mfma_f32_16x16x32_bf16 v[80:83], a[8:11], v[24:27], 0
  v_mfma_f32_16x16x32_bf16 v[84:87], a[12:15], v[24:27], 0
  s_waitcnt lgkmcnt(5)
  v_mfma_f32_16x16x32_bf16 v[72:75], a[0:3], v[28:31], 0
  ds_read_b128 v[52:55], v15 offset:0
  v_mfma_f32_16x16x32_bf16 v[76:79], a[4:7], v[28:31], 0
  v_mfma_f32_16x16x32_bf16 v[88:91], a[8:11], v[28:31], 0
  buffer_load_dwordx4 v[176:179], v21, s[4:7], s28 offen offset:0 sc1
  v_mfma_f32_16x16x32_bf16 v[92:95], a[12:15], v[28:31], 0
  s_waitcnt lgkmcnt(5)
  v_mfma_f32_16x16x32_bf16 v[64:67], a[16:19], v[32:35], v[64:67]
  ds_read_b128 v[24:27], v8 offset:8192
  v_mfma_f32_16x16x32_bf16 v[68:71], a[20:23], v[32:35], v[68:71]
  v_mfma_f32_16x16x32_bf16 v[80:83], a[24:27], v[32:35], v[80:83]
  v_mfma_f32_16x16x32_bf16 v[84:87], a[28:31], v[32:35], v[84:87]
  s_waitcnt lgkmcnt(5)
  v_mfma_f32_16x16x32_bf16 v[72:75], a[16:19], v[36:39], v[72:75]
  ds_read_b128 v[28:31], v9 offset:8192
  v_mfma_f32_16x16x32_bf16 v[76:79], a[20:23], v[36:39], v[76:79]
  v_mfma_f32_16x16x32_bf16 v[88:91], a[24:27], v[36:39], v[88:91]
  buffer_load_dwordx4 v[180:183], v21, s[4:7], s28 offen offset:1024 sc1
  v_mfma_f32_16x16x32_bf16 v[92:95], a[28:31], v[36:39], v[92:95]
  s_waitcnt lgkmcnt(5)
  v_mfma_f32_16x16x32_bf16 v[64:67], a[32:35], v[40:43], v[64:67]
  ds_read_b128 v[32:35], v10 offset:8192
  v_mfma_f32_16x16x32_bf16 v[68:71], a[36:39], v[40:43], v[68:71]
  v_mfma_f32_16x16x32_bf16 v[80:83], a[40:43], v[40:43], v[80:83]
  v_mfma_f32_16x16x32_bf16 v[84:87], a[44:47], v[40:43], v[84:87]
  s_waitcnt lgkmcnt(5)
  v_mfma_f32_16x16x32_bf16 v[72:75], a[32:35], v[44:47], v[72:75]
  ds_read_b128 v[36:39], v11 offset:8192
  v_mfma_f32_16x16x32_bf16 v[76:79], a[36:39], v[44:47], v[76:79]
  v_mfma_f32_16x16x32_bf16 v[88:91], a[40:43], v[44:47], v[88:91]
  buffer_load_dwordx4 v[184:187], v21, s[4:7], s28 offen offset:2048 sc1
  v_mfma_f32_16x16x32_bf16 v[92:95], a[44:47], v[44:47], v[92:95]
  s_waitcnt lgkmcnt(5)
  v_mfma_f32_16x16x32_bf16 v[64:67], a[48:51], v[48:51], v[64:67]
  ds_read_b128 v[40:43], v12 offset:8192
  v_mfma_f32_16x16x32_bf16 v[68:71], a[52:55], v[48:51], v[68:71]
  v_mfma_f32_16x16x32_bf16 v[80:83], a[56:59], v[48:51], v[80:83]
  v_mfma_f32_16x16x32_bf16 v[84:87], a[60:63], v[48:51], v[84:87]
  s_waitcnt lgkmcnt(5)
  v_mfma_f32_16x16x32_bf16 v[72:75], a[48:51], v[52:55], v[72:75]
  ds_read_b128 v[44:47], v13 offset:8192
  v_mfma_f32_16x16x32_bf16 v[76:79], a[52:55], v[52:55], v[76:79]
  v_mfma_f32_16x16x32_bf16 v[88:91], a[56:59], v[52:55], v[88:91]
  buffer_load_dwordx4 v[188:191], v21, s[4:7], s28 offen offset:3072 sc1
  v_mfma_f32_16x16x32_bf16 v[92:95], a[60:63], v[52:55], v[92:95]
  s_waitcnt lgkmcnt(5)
  v_mfma_f32_16x16x32_bf16 v[64:67], a[64:67], v[24:27], v[64:67]
  s_add_u32 s29, s19, 67112960
  ds_read_b128 v[48:51], v14 offset:8192
  v_mfma_f32_16x16x32_bf16 v[68:71], a[68:71], v[24:27], v[68:71]
  v_mfma_f32_16x16x32_bf16 v[80:83], a[72:75], v[24:27], v[80:83]
  v_mfma_f32_16x16x32_bf16 v[84:87], a[76:79], v[24:27], v[84:87]
  s_waitcnt lgkmcnt(5)
  v_mfma_f32_16x16x32_bf16 v[72:75], a[64:67], v[28:31], v[72:75]
  ds_read_b128 v[52:55], v15 offset:8192
  v_mfma_f32_16x16x32_bf16 v[76:79], a[68:71], v[28:31], v[76:79]
  v_mfma_f32_16x16x32_bf16 v[88:91], a[72:75], v[28:31], v[88:91]
  buffer_load_dwordx4 v[192:195], v21, s[4:7], s29 offen offset:0 sc1
  v_mfma_f32_16x16x32_bf16 v[92:95], a[76:79], v[28:31], v[92:95]
  s_waitcnt lgkmcnt(5)
  v_mfma_f32_16x16x32_bf16 v[64:67], a[80:83], v[32:35], v[64:67]
  ds_read_b128 v[24:27], v8 offset:16384
  v_mfma_f32_16x16x32_bf16 v[68:71], a[84:87], v[32:35], v[68:71]
  v_mfma_f32_16x16x32_bf16 v[80:83], a[88:91], v[32:35], v[80:83]
  v_mfma_f32_16x16x32_bf16 v[84:87], a[92:95], v[32:35], v[84:87]
  s_waitcnt lgkmcnt(5)
  v_mfma_f32_16x16x32_bf16 v[72:75], a[80:83], v[36:39], v[72:75]
  ds_read_b128 v[28:31], v9 offset:16384
  v_mfma_f32_16x16x32_bf16 v[76:79], a[84:87], v[36:39], v[76:79]
  v_mfma_f32_16x16x32_bf16 v[88:91], a[88:91], v[36:39], v[88:91]
  buffer_load_dwordx4 v[196:199], v21, s[4:7], s29 offen offset:1024 sc1
  v_mfma_f32_16x16x32_bf16 v[92:95], a[92:95], v[36:39], v[92:95]
  s_waitcnt lgkmcnt(5)
  v_mfma_f32_16x16x32_bf16 v[64:67], a[96:99], v[40:43], v[64:67]
  ds_read_b128 v[32:35], v10 offset:16384
  v_mfma_f32_16x16x32_bf16 v[68:71], a[100:103], v[40:43], v[68:71]
  v_mfma_f32_16x16x32_bf16 v[80:83], a[104:107], v[40:43], v[80:83]
  v_mfma_f32_16x16x32_bf16 v[84:87], a[108:111], v[40:43], v[84:87]
  s_waitcnt lgkmcnt(5)
  s_waitcnt vmcnt(7)
  v_readfirstlane_b32 s53, v23
  s_nop 0
  s_cmp_ge_u32 s53, s52
  s_cselect_b32 s24, 1, 0
  s_cbranch_scc0 F_nopre_251
  s_mov_b32 m0, s25
  s_nop 0
  buffer_load_dwordx4 v2, s[4:7], s20 offen offset:0 sc1 lds
  buffer_load_dwordx4 v2, s[4:7], s20 offen offset:1024 sc1 lds
  buffer_load_dwordx4 v2, s[4:7], s20 offen offset:2048 sc1 lds
  buffer_load_dwordx4 v2, s[4:7], s20 offen offset:3072 sc1 lds
F_nopre_251:
  v_mfma_f32_16x16x32_bf16 v[72:75], a[96:99], v[44:47], v[72:75]
  ds_read_b128 v[36:39], v11 offset:16384
  v_mfma_f32_16x16x32_bf16 v[76:79], a[100:103], v[44:47], v[76:79]
  v_mfma_f32_16x16x32_bf16 v[88:91], a[104:107], v[44:47], v[88:91]
  buffer_load_dwordx4 v[200:203], v21, s[4:7], s29 offen offset:2048 sc1
  v_mfma_f32_16x16x32_bf16 v[92:95], a[108:111], v[44:47], v[92:95]
  s_waitcnt lgkmcnt(5)
  v_mfma_f32_16x16x32_bf16 v[64:67], a[112:115], v[48:51], v[64:67]
  ds_read_b128 v[40:43], v12 offset:16384
  v_mfma_f32_16x16x32_bf16 v[68:71], a[116:119], v[48:51], v[68:71]
  v_mfma_f32_16x16x32_bf16 v[80:83], a[120:123], v[48:51], v[80:83]
  v_mfma_f32_16x16x32_bf16 v[84:87], a[124:127], v[48:51], v[84:87]
  s_waitcnt lgkmcnt(5)
  v_mfma_f32_16x16x32_bf16 v[72:75], a[112:115], v[52:55], v[72:75]
  ds_read_b128 v[44:47], v13 offset:16384
  v_mfma_f32_16x16x32_bf16 v[76:79], a[116:119], v[52:55], v[76:79]
  v_mfma_f32_16x16x32_bf16 v[88:91], a[120:123], v[52:55], v[88:91]
  buffer_load_dwordx4 v[204:207], v21, s[4:7], s29 offen offset:3072 sc1
  v_mfma_f32_16x16x32_bf16 v[92:95], a[124:127], v[52:55], v[92:95]
  s_waitcnt lgkmcnt(5)
  v_mfma_f32_16x16x32_bf16 v[64:67], a[128:131], v[24:27], v[64:67]
  s_add_u32 s28, s19, 83886080
  ds_read_b128 v[48:51], v14 offset:16384
  v_mfma_f32_16x16x32_bf16 v[68:71], a[132:135], v[24:27], v[68:71]
  v_mfma_f32_16x16x32_bf16 v[80:83], a[136:139], v[24:27], v[80:83]
  v_mfma_f32_16x16x32_bf16 v[84:87], a[140:143], v[24:27], v[84:87]
  s_waitcnt lgkmcnt(5)
  v_mfma_f32_16x16x32_bf16 v[72:75], a[128:131], v[28:31], v[72:75]
  ds_read_b128 v[52:55], v15 offset:16384
  v_mfma_f32_16x16x32_bf16 v[76:79], a[132:135], v[28:31], v[76:79]
  v_mfma_f32_16x16x32_bf16 v[88:91], a[136:139], v[28:31], v[88:91]
  buffer_load_dwordx4 v[208:211], v21, s[4:7], s28 offen offset:0 sc1
  v_mfma_f32_16x16x32_bf16 v[92:95], a[140:143], v[28:31], v[92:95]
  s_waitcnt lgkmcnt(5)
  v_mfma_f32_16x16x32_bf16 v[64:67], a[144:147], v[32:35], v[64:67]
  ds_read_b128 v[24:27], v8 offset:24576
  v_mfma_f32_16x16x32_bf16 v[68:71], a[148:151], v[32:35], v[68:71]
  v_mfma_f32_16x16x32_bf16 v[80:83], a[152:155], v[32:35], v[80:83]
  v_mfma_f32_16x16x32_bf16 v[84:87], a[156:159], v[32:35], v[84:87]
  s_waitcnt lgkmcnt(5)
  v_mfma_f32_16x16x32_bf16 v[72:75], a[144:147], v[36:39], v[72:75]
  ds_read_b128 v[28:31], v9 offset:24576
  v_mfma_f32_16x16x32_bf16 v[76:79], a[148:151], v[36:39], v[76:79]
  v_mfma_f32_16x16x32_bf16 v[88:91], a[152:155], v[36:39], v[88:91]
  buffer_load_dwordx4 v[212:215], v21, s[4:7], s28 offen offset:1024 sc1
  v_mfma_f32_16x16x32_bf16 v[92:95], a[156:159], v[36:39], v[92:95]
  s_waitcnt lgkmcnt(5)
  v_mfma_f32_16x16x32_bf16 v[64:67], a[160:163], v[40:43], v[64:67]
  ds_read_b128 v[32:35], v10 offset:24576
  v_mfma_f32_16x16x32_bf16 v[68:71], a[164:167], v[40:43], v[68:71]
  v_mfma_f32_16x16x32_bf16 v[80:83], a[168:171], v[40:43], v[80:83]
  v_mfma_f32_16x16x32_bf16 v[84:87], a[172:175], v[40:43], v[84:87]
  s_waitcnt lgkmcnt(5)
  v_mfma_f32_16x16x32_bf16 v[72:75], a[160:163], v[44:47], v[72:75]
  ds_read_b128 v[36:39], v11 offset:24576
  v_mfma_f32_16x16x32_bf16 v[76:79], a[164:167], v[44:47], v[76:79]
  v_mfma_f32_16x16x32_bf16 v[88:91], a[168:171], v[44:47], v[88:91]
  buffer_load_dwordx4 v[216:219], v21, s[4:7], s28 offen offset:2048 sc1
  v_mfma_f32_16x16x32_bf16 v[92:95], a[172:175], v[44:47], v[92:95]
  s_waitcnt lgkmcnt(5)
  v_mfma_f32_16x16x32_bf16 v[64:67], a[176:179], v[48:51], v[64:67]
  ds_read_b128 v[40:43], v12 offset:24576
  v_mfma_f32_16x16x32_bf16 v[68:71], a[180:183], v[48:51], v[68:71]
  v_mfma_f32_16x16x32_bf16 v[80:83], a[184:187], v[48:51], v[80:83]
  v_mfma_f32_16x16x32_bf16 v[84:87], a[188:191], v[48:51], v[84:87]
  s_waitcnt lgkmcnt(5)
  s_cmp_lg_u32 s24, 0
  s_cselect_b32 s76, 0, s52
  s_sub_u32 s76, s76, 59
  s_cmp_ge_u32 s76, 6
  s_cbranch_scc1 M_nosp_252
  buffer_load_dword v23, off, s[4:7], s54 sc1
  buffer_load_dwordx4 v[96:99], v2, s[4:7], s20 offen offset:0 sc1
  buffer_load_dwordx4 v[100:103], v2, s[4:7], s20 offen offset:1024 sc1
  buffer_load_dwordx4 v[104:107], v2, s[4:7], s20 offen offset:2048 sc1
  buffer_load_dwordx4 v[108:111], v2, s[4:7], s20 offen offset:3072 sc1
M_nosp_252:
  v_mfma_f32_16x16x32_bf16 v[72:75], a[176:179], v[52:55], v[72:75]
  ds_read_b128 v[44:47], v13 offset:24576
  v_mfma_f32_16x16x32_bf16 v[76:79], a[180:183], v[52:55], v[76:79]
  v_mfma_f32_16x16x32_bf16 v[88:91], a[184:187], v[52:55], v[88:91]
  buffer_load_dwordx4 v[220:223], v21, s[4:7], s28 offen offset:3072 sc1
  v_mfma_f32_16x16x32_bf16 v[92:95], a[188:191], v[52:55], v[92:95]
  s_waitcnt lgkmcnt(5)
  v_mfma_f32_16x16x32_bf16 v[64:67], a[192:195], v[24:27], v[64:67]
  s_add_u32 s29, s19, 83890176
  ds_read_b128 v[48:51], v14 offset:24576
  v_mfma_f32_16x16x32_bf16 v[68:71], a[196:199], v[24:27], v[68:71]
  v_mfma_f32_16x16x32_bf16 v[80:83], a[200:203], v[24:27], v[80:83]
  v_mfma_f32_16x16x32_bf16 v[84:87], a[204:207], v[24:27], v[84:87]
  s_waitcnt lgkmcnt(5)
  v_mfma_f32_16x16x32_bf16 v[72:75], a[192:195], v[28:31], v[72:75]
  ds_read_b128 v[52:55], v15 offset:24576
  v_mfma_f32_16x16x32_bf16 v[76:79], a[196:199], v[28:31], v[76:79]
  v_mfma_f32_16x16x32_bf16 v[88:91], a[200:203], v[28:31], v[88:91]
  buffer_load_dwordx4 v[224:227], v21, s[4:7], s29 offen offset:0 sc1
  v_mfma_f32_16x16x32_bf16 v[92:95], a[204:207], v[28:31], v[92:95]
  s_waitcnt lgkmcnt(5)
  v_mfma_f32_16x16x32_bf16 v[64:67], a[208:211], v[32:35], v[64:67]
  v_mfma_f32_16x16x32_bf16 v[68:71], a[212:215], v[32:35], v[68:71]
  v_mfma_f32_16x16x32_bf16 v[80:83], a[216:219], v[32:35], v[80:83]
  v_mfma_f32_16x16x32_bf16 v[84:87], a[220:223], v[32:35], v[84:87]
  s_waitcnt lgkmcnt(4)
  v_mfma_f32_16x16x32_bf16 v[72:75], a[208:211], v[36:39], v[72:75]
  v_mfma_f32_16x16x32_bf16 v[76:79], a[212:215], v[36:39], v[76:79]
  v_xor_b32 v8, 0x8000, v8
  v_mfma_f32_16x16x32_bf16 v[88:91], a[216:219], v[36:39], v[88:91]
  buffer_load_dwordx4 v[228:231], v21, s[4:7], s29 offen offset:1024 sc1
  v_mfma_f32_16x16x32_bf16 v[92:95], a[220:223], v[36:39], v[92:95]
  s_waitcnt lgkmcnt(3)
  v_xor_b32 v9, 0x8000, v9
  v_mfma_f32_16x16x32_bf16 v[64:67], a[224:227], v[40:43], v[64:67]
  v_mfma_f32_16x16x32_bf16 v[68:71], a[228:231], v[40:43], v[68:71]
  v_xor_b32 v10, 0x8000, v10
  v_mfma_f32_16x16x32_bf16 v[80:83], a[232:235], v[40:43], v[80:83]
  v_mfma_f32_16x16x32_bf16 v[84:87], a[236:239], v[40:43], v[84:87]
  s_waitcnt lgkmcnt(2)
  v_xor_b32 v11, 0x8000, v11
  v_mfma_f32_16x16x32_bf16 v[72:75], a[224:227], v[44:47], v[72:75]
  v_mfma_f32_16x16x32_bf16 v[76:79], a[228:231], v[44:47], v[76:79]
  v_xor_b32 v12, 0x8000, v12
  v_mfma_f32_16x16x32_bf16 v[88:91], a[232:235], v[44:47], v[88:91]
  buffer_load_dwordx4 v[232:235], v21, s[4:7], s29 offen offset:2048 sc1
  v_mfma_f32_16x16x32_bf16 v[92:95], a[236:239], v[44:47], v[92:95]
  s_waitcnt lgkmcnt(1)
  v_xor_b32 v13, 0x8000, v13
  v_mfma_f32_16x16x32_bf16 v[64:67], a[240:243], v[48:51], v[64:67]
  v_mfma_f32_16x16x32_bf16 v[68:71], a[244:247], v[48:51], v[68:71]
  v_xor_b32 v14, 0x8000, v14
  v_mfma_f32_16x16x32_bf16 v[80:83], a[248:251], v[48:51], v[80:83]
  v_mfma_f32_16x16x32_bf16 v[84:87], a[252:255], v[48:51], v[84:87]
  s_waitcnt lgkmcnt(0)
  v_xor_b32 v15, 0x8000, v15
  v_mfma_f32_16x16x32_bf16 v[72:75], a[240:243], v[52:55], v[72:75]
  v_mfma_f32_16x16x32_bf16 v[76:79], a[244:247], v[52:55], v[76:79]
  v_xor_b32 v3, 0x8000, v3
  v_mfma_f32_16x16x32_bf16 v[88:91], a[248:251], v[52:55], v[88:91]
  buffer_load_dwordx4 v[236:239], v21, s[4:7], s29 offen offset:3072 sc1
  v_mfma_f32_16x16x32_bf16 v[92:95], a[252:255], v[52:55], v[92:95]
  s_cmp_gt_u32 s23, 0
  s_cbranch_scc1 F_top_234
  s_nop 2
  v_cvt_pk_bf16_f32 v128, v64, v65
  v_cvt_pk_bf16_f32 v129, v66, v67
  v_cvt_pk_bf16_f32 v130, v68, v69
  v_cvt_pk_bf16_f32 v131, v70, v71
  buffer_store_dwordx4 v[128:131], v22, s[4:7], s21 offen offset:0 sc1
  v_cvt_pk_bf16_f32 v132, v72, v73
  v_cvt_pk_bf16_f32 v133, v74, v75
  v_cvt_pk_bf16_f32 v134, v76, v77
  v_cvt_pk_bf16_f32 v135, v78, v79
  buffer_store_dwordx4 v[132:135], v22, s[4:7], s21 offen offset:256 sc1
  v_cvt_pk_bf16_f32 v136, v80, v81
  v_cvt_pk_bf16_f32 v137, v82, v83
  v_cvt_pk_bf16_f32 v138, v84, v85
  v_cvt_pk_bf16_f32 v139, v86, v87
  buffer_store_dwordx4 v[136:139], v22, s[4:7], s21 offen offset:2048 sc1
  v_cvt_pk_bf16_f32 v140, v88, v89
  v_cvt_pk_bf16_f32 v141, v90, v91
  v_cvt_pk_bf16_f32 v142, v92, v93
  v_cvt_pk_bf16_f32 v143, v94, v95
  buffer_store_dwordx4 v[140:143], v22, s[4:7], s21 offen offset:2304 sc1
  s_waitcnt vmcnt(0) lgkmcnt(0)
  s_barrier
  v_mov_b32 v144, s30
  v_min_u32 v145, 1, v0
  v_lshlrev_b32 v145, 30, v145
  buffer_store_dword v144, v145, s[4:7], s31 offen sc1
M_done:
M_exit:
  s_endpgm
.p2align 6
.type M_table,@object
M_table:
.long 0x1, 0x3f, 0xffffffff, 0x17, 0x1, 0x7, 0x800, 0x0, 0x8, 0x0, 0x0, 0x0, 0x0, 0x0, 0x0, 0x0
.long 0x1, 0x28, 0xffffffff, 0x1b, 0x1, 0x6, 0x1000, 0x0, 0x8, 0x1, 0x0, 0x0, 0x0, 0x0, 0x0, 0x0
.long 0x2, 0x0, 0x2, 0x20, 0x1, 0x5, 0x1800, 0x0, 0x8, 0x0, 0x0, 0x0, 0x0, 0x0, 0x0, 0x0
.long 0x2, 0x1, 0x2, 0x20, 0x1, 0x4, 0x2000, 0x0, 0x8, 0x1, 0x0, 0x0, 0x0, 0x0, 0x0, 0x0
.long 0x0, 0x0, 0x1, 0x20, 0x2, 0x3, 0x20, 0x0, 0x8, 0x2, 0x0, 0x0, 0x0, 0x0, 0x0, 0x0
.long 0x0, 0x3f, 0xffffffff, 0x20, 0x2, 0x2, 0x18, 0x1, 0x10, 0x0, 0x0, 0x0, 0x0, 0x0, 0x0, 0x0
.long 0x1, 0xd, 0xffffffff, 0xe, 0x0, 0x0, 0x8, 0x0, 0x8, 0x2, 0x0, 0x0, 0x0, 0x0, 0x0, 0x0
.size M_table, 448
.section .rodata,"a"
.p2align 6
.amdhsa_kernel gated_mix__compressed_kv_cla__memory_aug_recurrent_mem_tr__prompt_kernel
.amdhsa_next_free_vgpr 512
.amdhsa_next_free_sgpr 102
.amdhsa_accum_offset 256
.amdhsa_group_segment_fixed_size 0
.amdhsa_kernarg_size 136
.amdhsa_user_sgpr_count 2
.amdhsa_user_sgpr_kernarg_segment_ptr 1
.amdhsa_system_sgpr_workgroup_id_x 1
.end_amdhsa_kernel
```

```asm
; @launch grid=(256,1,1) block=(256,1,1) lds=163840
.amdgcn_target "amdgcn-amd-amdhsa--gfx950"
.text
.globl gated_mix__compressed_kv_cla__memory_aug_recurrent_mem_tr__prompt_kernel
.p2align 8
.type gated_mix__compressed_kv_cla__memory_aug_recurrent_mem_tr__prompt_kernel,@function
gated_mix__compressed_kv_cla__memory_aug_recurrent_mem_tr__prompt_kernel:
  s_cmp_ge_u32 s2, 256
  s_cbranch_scc1 M_exit
  s_getpc_b64 s[60:61]
M_pc0:
  s_lshr_b32 s62, s2, 3
  s_and_b32 s62, s62, 3
  s_lshl_b32 s62, s62, 15
  v_lshl_add_u32 v104, v0, 7, s62
  v_min_u32 v104, M_table-M_pc0, v104
  global_load_dword v105, v104, s[60:61]
  s_lshr_b32 s77, s2, 3
  s_and_b32 s76, s2, 7
  s_cbranch_scc1 M_worker
  s_mov_b32 s12, s77
  s_load_dwordx4 s[60:63], s[0:1], 64
  s_load_dwordx4 s[64:67], s[0:1], 80
  s_load_dwordx4 s[68:71], s[0:1], 120
  s_load_dwordx2 s[72:73], s[0:1], 56
  v_lshrrev_b32 v1, 6, v0
  v_and_b32 v20, 63, v0
  v_readfirstlane_b32 s13, v1
  v_lshrrev_b32 v26, 3, v20
  v_lshlrev_b32 v26, 10, v26
  v_and_b32 v1, 7, v20
  v_lshl_add_u32 v26, v1, 4, v26
  s_lshl_b32 s36, s13, 7
  s_lshl_b32 s38, s12, 17
  s_add_u32 s36, s36, s38
  v_add_u32 v26, s36, v26
  s_lshl_b32 s39, s13, 15
  s_add_u32 s39, s39, 32768
  s_waitcnt lgkmcnt(0)
  s_mov_b32 s48, s66
  s_and_b32 s49, s67, 0xffff
  s_mov_b32 s50, 0x400000
  s_mov_b32 s51, 0x20000
  s_xor_b32 s36, s13, 0
  s_lshl_b32 s36, s36, 15
  s_add_u32 m0, s39, 28672
  s_add_u32 s37, s36, 0
  buffer_load_dwordx4 v26, s[48:51], s37 offen lds
  s_add_u32 m0, s39, 29696
  s_add_u32 s37, s36, 8192
  buffer_load_dwordx4 v26, s[48:51], s37 offen lds
  s_add_u32 m0, s39, 30720
  s_add_u32 s37, s36, 16384
  buffer_load_dwordx4 v26, s[48:51], s37 offen lds
  s_add_u32 m0, s39, 31744
  s_add_u32 s37, s36, 24576
  buffer_load_dwordx4 v26, s[48:51], s37 offen lds
  s_xor_b32 s36, s13, 0
  s_lshl_b32 s36, s36, 15
  s_add_u32 m0, s39, 24576
  s_add_u32 s37, s36, 512
  buffer_load_dwordx4 v26, s[48:51], s37 offen lds
  s_add_u32 m0, s39, 25600
  s_add_u32 s37, s36, 8704
  buffer_load_dwordx4 v26, s[48:51], s37 offen lds
  s_add_u32 m0, s39, 26624
  s_add_u32 s37, s36, 16896
  buffer_load_dwordx4 v26, s[48:51], s37 offen lds
  s_add_u32 m0, s39, 27648
  s_add_u32 s37, s36, 25088
  buffer_load_dwordx4 v26, s[48:51], s37 offen lds
  s_xor_b32 s36, s13, 1
  s_lshl_b32 s36, s36, 15
  s_add_u32 m0, s39, 12288
  s_add_u32 s37, s36, 0
  buffer_load_dwordx4 v26, s[48:51], s37 offen lds
  s_add_u32 m0, s39, 13312
  s_add_u32 s37, s36, 8192
  buffer_load_dwordx4 v26, s[48:51], s37 offen lds
  s_add_u32 m0, s39, 14336
  s_add_u32 s37, s36, 16384
  buffer_load_dwordx4 v26, s[48:51], s37 offen lds
  s_add_u32 m0, s39, 15360
  s_add_u32 s37, s36, 24576
  buffer_load_dwordx4 v26, s[48:51], s37 offen lds
  s_xor_b32 s36, s13, 1
  s_lshl_b32 s36, s36, 15
  s_add_u32 m0, s39, 8192
  s_add_u32 s37, s36, 512
  buffer_load_dwordx4 v26, s[48:51], s37 offen lds
  s_add_u32 m0, s39, 9216
  s_add_u32 s37, s36, 8704
  buffer_load_dwordx4 v26, s[48:51], s37 offen lds
  s_add_u32 m0, s39, 10240
  s_add_u32 s37, s36, 16896
  buffer_load_dwordx4 v26, s[48:51], s37 offen lds
  s_add_u32 m0, s39, 11264
  s_add_u32 s37, s36, 25088
  buffer_load_dwordx4 v26, s[48:51], s37 offen lds
  s_mov_b32 s8, s60
  s_and_b32 s9, s61, 0xffff
  s_mov_b32 s10, 0x400000
  s_mov_b32 s11, 0x20000
  s_mov_b32 s40, s62
  s_and_b32 s41, s63, 0xffff
  s_mov_b32 s42, 0x400000
  s_mov_b32 s43, 0x20000
  s_mov_b32 s44, s64
  s_and_b32 s45, s65, 0xffff
  s_mov_b32 s46, 0x400000
  s_mov_b32 s47, 0x20000
  s_mov_b32 s4, s70
  s_and_b32 s5, s71, 0xffff
  s_mov_b32 s6, 0x10000000
  s_mov_b32 s7, 0x20000
  s_mov_b32 s76, s72
  s_and_b32 s77, s73, 0xffff
  s_mov_b32 s78, 0x2000
  s_mov_b32 s79, 0x20000
  s_mov_b32 s72, s68
  s_and_b32 s73, s69, 0xffff
  s_mov_b32 s74, 0x100
  s_mov_b32 s75, 0x20000
  s_mov_b64 s[52:53], s[68:69]
  s_mov_b64 s[58:59], s[70:71]
  s_mul_i32 s99, s12, 896
  s_add_u32 s99, s99, 148898048
  s_lshl_b32 s15, s12, 7
  s_add_u32 s15, s15, 148926464
  v_lshrrev_b32 v21, 4, v20
  v_and_b32 v22, 15, v20
  v_and_b32 v23, 1, v21
  v_lshrrev_b32 v24, 1, v21
  v_lshlrev_b32 v2, 4, v20
  s_lshl_b32 s36, s13, 10
  v_add_u32 v59, s36, v2
  s_mov_b32 s37, s39
  v_add_u32 v4, s37, v2
  v_lshrrev_b32 v25, 2, v20
  v_lshlrev_b32 v25, 13, v25
  v_and_b32 v1, 3, v20
  v_lshl_add_u32 v25, v1, 4, v25
  s_lshl_b32 s36, s13, 6
  s_lshl_b32 s38, s12, 8
  s_add_u32 s36, s36, s38
  v_add_u32 v25, s36, v25
  v_bfe_u32 v29, v20, 2, 1
  v_bfe_u32 v30, v20, 3, 1
  v_and_b32 v31, 3, v20
  v_lshl_add_u32 v27, v21, 2, v29
  v_lshlrev_b32 v27, 6, v27
  v_lshl_add_u32 v27, v30, 5, v27
  v_lshl_add_u32 v27, v31, 3, v27
  v_add_u32 v27, s37, v27
  v_xor_b32 v36, 1, v30
  v_lshl_add_u32 v36, v36, 11, v27
  v_lshl_add_u32 v27, v30, 11, v27
  v_lshl_add_u32 v28, v23, 2, v24
  v_lshl_add_u32 v28, v28, 2, v29
  v_lshlrev_b32 v28, 7, v28
  v_lshl_add_u32 v28, v30, 6, v28
  v_lshl_add_u32 v28, v31, 4, v28
  v_add_u32 v28, s37, v28
  v_lshrrev_b32 v25, 3, v20
  v_lshlrev_b32 v25, 13, v25
  v_and_b32 v1, 7, v20
  v_lshl_add_u32 v25, v1, 4, v25
  s_lshr_b32 s36, s13, 1
  s_lshl1_add_u32 s36, s12, s36
  s_lshl_b32 s36, s36, 7
  v_add_u32 v25, s36, v25
  v_lshl_add_u32 v27, v21, 2, v29
  v_lshlrev_b32 v27, 7, v27
  v_lshl_add_u32 v27, v30, 5, v27
  v_lshl_add_u32 v27, v31, 3, v27
  s_and_b32 s36, s13, 1
  s_lshl_b32 s36, s36, 6
  s_xor_b32 s37, s13, 1
  s_lshl_b32 s37, s37, 15
  s_add_u32 s37, s37, s36
  s_add_u32 s37, s37, 32768
  s_add_u32 s36, s36, s39
  v_add_u32 v36, s37, v27
  v_add_u32 v27, s36, v27
  v_lshlrev_b32 v101, 12, v30
  v_xor_b32 v100, 0x1000, v101
  v_mov_b32 v0, 0x4444
  v_mov_b32 v1, 0xeeee
  v_cmp_lt_u32 vcc, 7, v22
  s_nop 1
  v_cndmask_b32 v32, v0, v1, vcc
  v_mov_b32 v0, v32
  v_and_b32 v32, 7, v20
  v_lshlrev_b32 v32, 4, v32
  v_lshl_add_u32 v11, v21, 7, v32
  v_xor_b32 v1, 128, v2
  v_lshl_add_u32 v33, v24, 4, v22
  s_lshl_b32 s36, s13, 5
  v_add_u32 v33, s36, v33
  v_lshlrev_b32 v33, 3, v33
  v_mul_u32_u24 v34, 1152, v23
  v_add_u32 v5, v33, v34
  v_bfe_u32 v33, v20, 2, 2
  v_lshl_add_u32 v33, v23, 2, v33
  v_lshl_add_u32 v33, v24, 4, v33
  v_lshlrev_b32 v33, 3, v33
  v_and_b32 v34, 1, v20
  v_mul_u32_u24 v34, 1152, v34
  v_add_u32 v6, v33, v34
  s_lshl_b32 s36, s13, 3
  v_lshrrev_b32 v33, 3, v20
  v_add_u32 v33, s36, v33
  v_mul_u32_u24 v34, 0, v33
  v_add_u32 v34, s12, v34
  v_and_b32 v34, 31, v34
  v_lshrrev_b32 v37, 1, v32
  v_lshl_add_u32 v33, v33, 13, v37
  v_lshl_add_u32 v7, v34, 7, v33
  v_and_b32 v37, 1, v20
  v_bfe_u32 v38, v20, 1, 1
  v_lshl_add_u32 v37, v29, 1, v37
  s_lshr_b32 s36, s12, 3
  s_lshl_b32 s36, s36, 10
  s_and_b32 s37, s12, 1
  s_lshl_b32 s37, s37, 9
  s_add_u32 s36, s36, s37
  s_and_b32 s37, s12, 6
  s_lshl_b32 s37, s37, 5
  s_add_u32 s36, s36, s37
  v_lshlrev_b32 v33, 4, v21
  v_lshl_add_u32 v33, v37, 2, v33
  v_lshl_add_u32 v33, v38, 8, v33
  v_lshl_add_u32 v33, v30, 30, v33
  v_add_u32 v8, s36, v33
  v_mov_b32 v39, v21
  s_lshr_b32 s36, s12, 2
  s_lshl_b32 s36, s36, 6
  s_and_b32 s37, s12, 1
  s_lshl_b32 s37, s37, 5
  s_add_u32 s36, s36, s37
  s_and_b32 s37, s12, 2
  s_lshl_b32 s37, s37, 11
  s_add_u32 s36, s36, s37
  v_lshlrev_b32 v35, 10, v39
  v_lshl_add_u32 v35, v37, 2, v35
  v_lshl_add_u32 v35, v38, 4, v35
  v_add_u32 v35, s36, v35
  buffer_load_ushort v44, v35, s[76:79], 0 offen offset:0
  buffer_load_ushort v45, v35, s[76:79], 0 offen offset:2
  buffer_load_ushort v46, v35, s[76:79], 0 offen offset:512
  buffer_load_ushort v47, v35, s[76:79], 0 offen offset:514
  v_lshlrev_b32 v33, 4, v29
  v_mov_b32 v34, 0x3f80
  v_lshlrev_b32 v33, v33, v34
  v_and_b32 v34, 1, v20
  v_lshl_add_u32 v34, v34, 1, v30
  v_cmp_eq_u32 vcc, 0, v34
  s_nop 1
  v_cndmask_b32 v48, 0, v33, vcc
  v_cmp_eq_u32 vcc, 1, v34
  s_nop 1
  v_cndmask_b32 v49, 0, v33, vcc
  v_cmp_eq_u32 vcc, 2, v34
  s_nop 1
  v_cndmask_b32 v50, 0, v33, vcc
  v_cmp_eq_u32 vcc, 3, v34
  s_nop 1
  v_cndmask_b32 v51, 0, v33, vcc
  ds_write_b128 v2, v[48:51] offset:31232
  v_lshlrev_b32 v33, 9, v21
  s_lshl_b32 s36, s13, 11
  v_add_u32 v33, s36, v33
  v_lshl_add_u32 v10, v22, 4, v33
  v_lshl_add_u32 v33, v30, 8, v33
  v_add_u32 v9, v33, v32
  v_mov_b32 v12, 0x3f803f80
  v_mov_b32 v13, 0x3f803f80
  v_mov_b32 v14, 0x3f803f80
  v_mov_b32 v15, 0x3f803f80
  s_mov_b32 s2, 0x3f803f80
  s_mov_b32 s3, 0x3f803f80
  s_mov_b32 s98, 0
  v_and_b32 v33, 1, v20
  v_mul_u32_u24 v33, 128, v33
  v_min_u32 v34, 1, v20
  v_lshlrev_b32 v34, 30, v34
  s_cmp_eq_u32 s13, 3
  s_cselect_b64 vcc, -1, 0
  v_cndmask_b32 v19, v34, v33, vcc
  v_mov_b64 v[60:61], 0
  v_mov_b32 v62, 32256
  ds_write_b64 v62, v[60:61]
  s_mov_b32 s16, 0
  s_mov_b32 s17, -1
  s_mov_b32 s18, 0x3e0293ee
  s_mov_b32 s54, 0x2f800000
  s_mov_b32 s55, 0x28000000
  s_mov_b32 s96, s55
  s_lshl_b32 s36, s13, 10
  s_add_u32 s31, s36, 8192
  s_add_u32 s32, s36, 12160
  s_add_u32 s33, s36, 16384
  s_add_u32 s34, s36, 20224
  s_lshl_b32 s36, s12, 19
  s_add_u32 s27, s36, 67108864
  s_add_u32 s28, s36, 83886080
  s_mul_i32 s36, s12, 4096
  s_add_u32 s29, s36, 135266304
  s_lshl_b32 s36, s12, 13
  s_add_u32 s22, s36, 144703488
  s_add_u32 s23, s36, 144707584
  s_mov_b32 s20, 144703488
  s_mov_b32 s21, 144707584
  v_mov_b32 v40, -1
  v_mov_b32 v41, -1
  v_mov_b32 v42, -1
  v_mov_b32 v43, -1
  s_lshl_b32 s36, s13, 13
  s_add_u32 s36, s36, 145752064
  s_add_u32 s37, s36, 4096
  buffer_store_dwordx4 v[40:43], v59, s[4:7], s22 offen sc1
  buffer_store_dwordx4 v[40:43], v59, s[4:7], s23 offen sc1
  buffer_store_dword v40, v8, s[4:7], s36 offen sc1
  buffer_store_dword v40, v8, s[4:7], s37 offen sc1
  v_mov_b32 v52, 0
  v_min_u32 v53, 1, v59
  v_lshlrev_b32 v53, 30, v53
  buffer_store_dword v52, v53, s[4:7], s15 offen sc1
  s_waitcnt vmcnt(21)
  ds_read_b64_tr_b16 a[160:161], v28 offset:28672
  ds_read_b64_tr_b16 a[162:163], v28 offset:28928
  ds_read_b64_tr_b16 a[164:165], v28 offset:29696
  ds_read_b64_tr_b16 a[166:167], v28 offset:29952
  ds_read_b64_tr_b16 a[168:169], v28 offset:28680
  ds_read_b64_tr_b16 a[170:171], v28 offset:28936
  ds_read_b64_tr_b16 a[172:173], v28 offset:29704
  ds_read_b64_tr_b16 a[174:175], v28 offset:29960
  s_waitcnt lgkmcnt(0)
  s_waitcnt vmcnt(17)
  ds_read_b64_tr_b16 a[176:177], v28 offset:24576
  ds_read_b64_tr_b16 a[178:179], v28 offset:24832
  ds_read_b64_tr_b16 a[180:181], v28 offset:25600
  ds_read_b64_tr_b16 a[182:183], v28 offset:25856
  ds_read_b64_tr_b16 a[184:185], v28 offset:24584
  ds_read_b64_tr_b16 a[186:187], v28 offset:24840
  ds_read_b64_tr_b16 a[188:189], v28 offset:25608
  ds_read_b64_tr_b16 a[190:191], v28 offset:25864
  s_waitcnt lgkmcnt(0)
  s_xor_b32 s36, s13, 2
  s_lshl_b32 s36, s36, 15
  s_add_u32 m0, s39, 28672
  s_add_u32 s37, s36, 0
  buffer_load_dwordx4 v26, s[48:51], s37 offen lds
  s_add_u32 m0, s39, 29696
  s_add_u32 s37, s36, 8192
  buffer_load_dwordx4 v26, s[48:51], s37 offen lds
  s_add_u32 m0, s39, 30720
  s_add_u32 s37, s36, 16384
  buffer_load_dwordx4 v26, s[48:51], s37 offen lds
  s_add_u32 m0, s39, 31744
  s_add_u32 s37, s36, 24576
  buffer_load_dwordx4 v26, s[48:51], s37 offen lds
  s_xor_b32 s36, s13, 3
  s_lshl_b32 s36, s36, 15
  s_add_u32 m0, s39, 24576
  s_add_u32 s37, s36, 0
  buffer_load_dwordx4 v26, s[48:51], s37 offen lds
  s_add_u32 m0, s39, 25600
  s_add_u32 s37, s36, 8192
  buffer_load_dwordx4 v26, s[48:51], s37 offen lds
  s_add_u32 m0, s39, 26624
  s_add_u32 s37, s36, 16384
  buffer_load_dwordx4 v26, s[48:51], s37 offen lds
  s_add_u32 m0, s39, 27648
  s_add_u32 s37, s36, 24576
  buffer_load_dwordx4 v26, s[48:51], s37 offen lds
  s_waitcnt vmcnt(21)
  ds_read_b64_tr_b16 a[192:193], v28 offset:12288
  ds_read_b64_tr_b16 a[194:195], v28 offset:12544
  ds_read_b64_tr_b16 a[196:197], v28 offset:13312
  ds_read_b64_tr_b16 a[198:199], v28 offset:13568
  ds_read_b64_tr_b16 a[200:201], v28 offset:12296
  ds_read_b64_tr_b16 a[202:203], v28 offset:12552
  ds_read_b64_tr_b16 a[204:205], v28 offset:13320
  ds_read_b64_tr_b16 a[206:207], v28 offset:13576
  s_waitcnt lgkmcnt(0)
  s_waitcnt vmcnt(17)
  ds_read_b64_tr_b16 a[208:209], v28 offset:8192
  ds_read_b64_tr_b16 a[210:211], v28 offset:8448
  ds_read_b64_tr_b16 a[212:213], v28 offset:9216
  ds_read_b64_tr_b16 a[214:215], v28 offset:9472
  ds_read_b64_tr_b16 a[216:217], v28 offset:8200
  ds_read_b64_tr_b16 a[218:219], v28 offset:8456
  ds_read_b64_tr_b16 a[220:221], v28 offset:9224
  ds_read_b64_tr_b16 a[222:223], v28 offset:9480
  s_waitcnt lgkmcnt(0)
  s_xor_b32 s36, s13, 2
  s_lshl_b32 s36, s36, 19
  s_add_u32 m0, s39, 12288
  s_add_u32 s37, s36, 0
  buffer_load_dwordx4 v25, s[8:11], s37 offen lds
  s_add_u32 m0, s39, 13312
  s_add_u32 s37, s36, 65536
  buffer_load_dwordx4 v25, s[8:11], s37 offen lds
  s_add_u32 m0, s39, 14336
  s_add_u32 s37, s36, 131072
  buffer_load_dwordx4 v25, s[8:11], s37 offen lds
  s_add_u32 m0, s39, 15360
  s_add_u32 s37, s36, 196608
  buffer_load_dwordx4 v25, s[8:11], s37 offen lds
  s_xor_b32 s36, s13, 2
  s_lshl_b32 s36, s36, 19
  s_add_u32 m0, s39, 8192
  s_add_u32 s37, s36, 262144
  buffer_load_dwordx4 v25, s[8:11], s37 offen lds
  s_add_u32 m0, s39, 9216
  s_add_u32 s37, s36, 327680
  buffer_load_dwordx4 v25, s[8:11], s37 offen lds
  s_add_u32 m0, s39, 10240
  s_add_u32 s37, s36, 393216
  buffer_load_dwordx4 v25, s[8:11], s37 offen lds
  s_add_u32 m0, s39, 11264
  s_add_u32 s37, s36, 458752
  buffer_load_dwordx4 v25, s[8:11], s37 offen lds
  s_waitcnt vmcnt(12)
  ds_read_b64_tr_b16 a[224:225], v28 offset:28672
  ds_read_b64_tr_b16 a[226:227], v28 offset:28928
  ds_read_b64_tr_b16 a[228:229], v28 offset:29696
  ds_read_b64_tr_b16 a[230:231], v28 offset:29952
  ds_read_b64_tr_b16 a[232:233], v28 offset:28680
  ds_read_b64_tr_b16 a[234:235], v28 offset:28936
  ds_read_b64_tr_b16 a[236:237], v28 offset:29704
  ds_read_b64_tr_b16 a[238:239], v28 offset:29960
  s_waitcnt lgkmcnt(0)
  s_waitcnt vmcnt(8)
  ds_read_b64_tr_b16 a[240:241], v28 offset:24576
  ds_read_b64_tr_b16 a[242:243], v28 offset:24832
  ds_read_b64_tr_b16 a[244:245], v28 offset:25600
  ds_read_b64_tr_b16 a[246:247], v28 offset:25856
  ds_read_b64_tr_b16 a[248:249], v28 offset:24584
  ds_read_b64_tr_b16 a[250:251], v28 offset:24840
  ds_read_b64_tr_b16 a[252:253], v28 offset:25608
  ds_read_b64_tr_b16 a[254:255], v28 offset:25864
  s_waitcnt lgkmcnt(0)
  s_xor_b32 s36, s13, 4
  s_lshl_b32 s36, s36, 19
  s_add_u32 m0, s39, 28672
  s_add_u32 s37, s36, 0
  buffer_load_dwordx4 v25, s[8:11], s37 offen lds
  s_add_u32 m0, s39, 29696
  s_add_u32 s37, s36, 65536
  buffer_load_dwordx4 v25, s[8:11], s37 offen lds
  s_add_u32 m0, s39, 30720
  s_add_u32 s37, s36, 131072
  buffer_load_dwordx4 v25, s[8:11], s37 offen lds
  s_add_u32 m0, s39, 31744
  s_add_u32 s37, s36, 196608
  buffer_load_dwordx4 v25, s[8:11], s37 offen lds
  s_xor_b32 s36, s13, 4
  s_lshl_b32 s36, s36, 19
  s_add_u32 m0, s39, 24576
  s_add_u32 s37, s36, 262144
  buffer_load_dwordx4 v25, s[8:11], s37 offen lds
  s_add_u32 m0, s39, 25600
  s_add_u32 s37, s36, 327680
  buffer_load_dwordx4 v25, s[8:11], s37 offen lds
  s_add_u32 m0, s39, 26624
  s_add_u32 s37, s36, 393216
  buffer_load_dwordx4 v25, s[8:11], s37 offen lds
  s_add_u32 m0, s39, 27648
  s_add_u32 s37, s36, 458752
  buffer_load_dwordx4 v25, s[8:11], s37 offen lds
  s_barrier
  s_cmp_lg_u32 s13, 0
  s_cbranch_scc1 T_arm_1
  s_getreg_b32 s36, hwreg(HW_REG_XCC_ID, 0, 3)
  s_lshl_b32 s36, s36, 3
  s_lshl_b64 s[60:61], 1, s36
  s_mov_b32 s62, 1
  s_atomic_add_x2 s[60:61], s[52:53], 0
  s_atomic_add s62, s[52:53], 128
  v_lshl_or_b32 v44, v45, 16, v44
  v_lshl_or_b32 v46, v47, 16, v46
  v_min_u32 v44, -2, v44
  v_min_u32 v46, -2, v46
  s_mov_b32 s36, 145752064
  s_mov_b32 s37, 145756160
  buffer_store_dword v44, v8, s[4:7], s36 offen sc1
  buffer_store_dword v46, v8, s[4:7], s37 offen sc1
T_arm_1:
  v_mad_u32_u24 v96, v100, 1, v27
  v_mad_u32_u24 v97, v101, 1, v27
  v_mad_u32_u24 v98, v100, 1, v36
  v_mad_u32_u24 v99, v101, 1, v36
  s_waitcnt vmcnt(8)
  s_barrier
  ds_read_b64_tr_b16 v[160:161], v96 offset:8192
  ds_read_b64_tr_b16 v[162:163], v96 offset:8448
  ds_read_b64_tr_b16 v[164:165], v96 offset:10240
  ds_read_b64_tr_b16 v[166:167], v96 offset:10496
  ds_read_b64_tr_b16 v[168:169], v97 offset:8192
  ds_read_b64_tr_b16 v[170:171], v97 offset:8448
  ds_read_b64_tr_b16 v[172:173], v97 offset:10240
  ds_read_b64_tr_b16 v[174:175], v97 offset:10496
  ds_read_b64_tr_b16 v[192:193], v98 offset:8192
  ds_read_b64_tr_b16 v[194:195], v98 offset:8448
  ds_read_b64_tr_b16 v[196:197], v98 offset:10240
  ds_read_b64_tr_b16 v[198:199], v98 offset:10496
  ds_read_b64_tr_b16 v[200:201], v99 offset:8192
  ds_read_b64_tr_b16 v[202:203], v99 offset:8448
  ds_read_b64_tr_b16 v[204:205], v99 offset:10240
  ds_read_b64_tr_b16 v[206:207], v99 offset:10496
  s_waitcnt lgkmcnt(0)
  s_barrier
  s_xor_b32 s36, s13, 4
  s_lshl_b32 s36, s36, 19
  s_add_u32 m0, s39, 12288
  s_add_u32 s37, s36, 0
  buffer_load_dwordx4 v25, s[40:43], s37 offen lds
  s_add_u32 m0, s39, 13312
  s_add_u32 s37, s36, 65536
  buffer_load_dwordx4 v25, s[40:43], s37 offen lds
  s_add_u32 m0, s39, 14336
  s_add_u32 s37, s36, 131072
  buffer_load_dwordx4 v25, s[40:43], s37 offen lds
  s_add_u32 m0, s39, 15360
  s_add_u32 s37, s36, 196608
  buffer_load_dwordx4 v25, s[40:43], s37 offen lds
  s_xor_b32 s36, s13, 4
  s_lshl_b32 s36, s36, 19
  s_add_u32 m0, s39, 8192
  s_add_u32 s37, s36, 262144
  buffer_load_dwordx4 v25, s[40:43], s37 offen lds
  s_add_u32 m0, s39, 9216
  s_add_u32 s37, s36, 327680
  buffer_load_dwordx4 v25, s[40:43], s37 offen lds
  s_add_u32 m0, s39, 10240
  s_add_u32 s37, s36, 393216
  buffer_load_dwordx4 v25, s[40:43], s37 offen lds
  s_add_u32 m0, s39, 11264
  s_add_u32 s37, s36, 458752
  buffer_load_dwordx4 v25, s[40:43], s37 offen lds
  v_mad_u32_u24 v96, v100, 1, v27
  v_mad_u32_u24 v97, v101, 1, v27
  v_mad_u32_u24 v98, v100, 1, v36
  v_mad_u32_u24 v99, v101, 1, v36
  s_waitcnt vmcnt(8)
  s_barrier
  ds_read_b64_tr_b16 v[224:225], v96 offset:24576
  ds_read_b64_tr_b16 v[226:227], v96 offset:24832
  ds_read_b64_tr_b16 v[228:229], v96 offset:26624
  ds_read_b64_tr_b16 v[230:231], v96 offset:26880
  ds_read_b64_tr_b16 v[232:233], v97 offset:24576
  ds_read_b64_tr_b16 v[234:235], v97 offset:24832
  ds_read_b64_tr_b16 v[236:237], v97 offset:26624
  ds_read_b64_tr_b16 v[238:239], v97 offset:26880
  ds_read_b64_tr_b16 a[16:17], v98 offset:24576
  ds_read_b64_tr_b16 a[18:19], v98 offset:24832
  ds_read_b64_tr_b16 a[20:21], v98 offset:26624
  ds_read_b64_tr_b16 a[22:23], v98 offset:26880
  ds_read_b64_tr_b16 a[24:25], v99 offset:24576
  ds_read_b64_tr_b16 a[26:27], v99 offset:24832
  ds_read_b64_tr_b16 a[28:29], v99 offset:26624
  ds_read_b64_tr_b16 a[30:31], v99 offset:26880
  s_waitcnt lgkmcnt(0)
  s_barrier
  s_xor_b32 s36, s13, 4
  s_lshl_b32 s36, s36, 19
  s_add_u32 m0, s39, 28672
  s_add_u32 s37, s36, 0
  buffer_load_dwordx4 v25, s[44:47], s37 offen lds
  s_add_u32 m0, s39, 29696
  s_add_u32 s37, s36, 65536
  buffer_load_dwordx4 v25, s[44:47], s37 offen lds
  s_add_u32 m0, s39, 30720
  s_add_u32 s37, s36, 131072
  buffer_load_dwordx4 v25, s[44:47], s37 offen lds
  s_add_u32 m0, s39, 31744
  s_add_u32 s37, s36, 196608
  buffer_load_dwordx4 v25, s[44:47], s37 offen lds
  s_xor_b32 s36, s13, 4
  s_lshl_b32 s36, s36, 19
  s_add_u32 m0, s39, 24576
  s_add_u32 s37, s36, 262144
  buffer_load_dwordx4 v25, s[44:47], s37 offen lds
  s_add_u32 m0, s39, 25600
  s_add_u32 s37, s36, 327680
  buffer_load_dwordx4 v25, s[44:47], s37 offen lds
  s_add_u32 m0, s39, 26624
  s_add_u32 s37, s36, 393216
  buffer_load_dwordx4 v25, s[44:47], s37 offen lds
  s_add_u32 m0, s39, 27648
  s_add_u32 s37, s36, 458752
  buffer_load_dwordx4 v25, s[44:47], s37 offen lds
  v_mad_u32_u24 v96, v100, 1, v27
  v_mad_u32_u24 v97, v101, 1, v27
  v_mad_u32_u24 v98, v100, 1, v36
  v_mad_u32_u24 v99, v101, 1, v36
  s_waitcnt vmcnt(8)
  s_barrier
  ds_read_b64_tr_b16 v[240:241], v96 offset:8192
  ds_read_b64_tr_b16 v[242:243], v96 offset:8448
  ds_read_b64_tr_b16 v[244:245], v96 offset:10240
  ds_read_b64_tr_b16 v[246:247], v96 offset:10496
  ds_read_b64_tr_b16 v[248:249], v97 offset:8192
  ds_read_b64_tr_b16 v[250:251], v97 offset:8448
  ds_read_b64_tr_b16 v[252:253], v97 offset:10240
  ds_read_b64_tr_b16 v[254:255], v97 offset:10496
  ds_read_b64_tr_b16 a[32:33], v98 offset:8192
  ds_read_b64_tr_b16 a[34:35], v98 offset:8448
  ds_read_b64_tr_b16 a[36:37], v98 offset:10240
  ds_read_b64_tr_b16 a[38:39], v98 offset:10496
  ds_read_b64_tr_b16 a[40:41], v99 offset:8192
  ds_read_b64_tr_b16 a[42:43], v99 offset:8448
  ds_read_b64_tr_b16 a[44:45], v99 offset:10240
  ds_read_b64_tr_b16 a[46:47], v99 offset:10496
  s_waitcnt lgkmcnt(0)
  s_barrier
  s_xor_b32 s36, s13, 6
  s_lshl_b32 s36, s36, 19
  s_add_u32 m0, s39, 12288
  s_add_u32 s37, s36, 0
  buffer_load_dwordx4 v25, s[8:11], s37 offen lds
  s_add_u32 m0, s39, 13312
  s_add_u32 s37, s36, 65536
  buffer_load_dwordx4 v25, s[8:11], s37 offen lds
  s_add_u32 m0, s39, 14336
  s_add_u32 s37, s36, 131072
  buffer_load_dwordx4 v25, s[8:11], s37 offen lds
  s_add_u32 m0, s39, 15360
  s_add_u32 s37, s36, 196608
  buffer_load_dwordx4 v25, s[8:11], s37 offen lds
  s_xor_b32 s36, s13, 6
  s_lshl_b32 s36, s36, 19
  s_add_u32 m0, s39, 8192
  s_add_u32 s37, s36, 262144
  buffer_load_dwordx4 v25, s[8:11], s37 offen lds
  s_add_u32 m0, s39, 9216
  s_add_u32 s37, s36, 327680
  buffer_load_dwordx4 v25, s[8:11], s37 offen lds
  s_add_u32 m0, s39, 10240
  s_add_u32 s37, s36, 393216
  buffer_load_dwordx4 v25, s[8:11], s37 offen lds
  s_add_u32 m0, s39, 11264
  s_add_u32 s37, s36, 458752
  buffer_load_dwordx4 v25, s[8:11], s37 offen lds
  v_mad_u32_u24 v96, v100, 1, v27
  v_mad_u32_u24 v97, v101, 1, v27
  v_mad_u32_u24 v98, v100, 1, v36
  v_mad_u32_u24 v99, v101, 1, v36
  s_waitcnt vmcnt(8)
  s_barrier
  ds_read_b64_tr_b16 a[0:1], v96 offset:24576
  ds_read_b64_tr_b16 a[2:3], v96 offset:24832
  ds_read_b64_tr_b16 a[4:5], v96 offset:26624
  ds_read_b64_tr_b16 a[6:7], v96 offset:26880
  ds_read_b64_tr_b16 a[8:9], v97 offset:24576
  ds_read_b64_tr_b16 a[10:11], v97 offset:24832
  ds_read_b64_tr_b16 a[12:13], v97 offset:26624
  ds_read_b64_tr_b16 a[14:15], v97 offset:26880
  ds_read_b64_tr_b16 a[48:49], v98 offset:24576
  ds_read_b64_tr_b16 a[50:51], v98 offset:24832
  ds_read_b64_tr_b16 a[52:53], v98 offset:26624
  ds_read_b64_tr_b16 a[54:55], v98 offset:26880
  ds_read_b64_tr_b16 a[56:57], v99 offset:24576
  ds_read_b64_tr_b16 a[58:59], v99 offset:24832
  ds_read_b64_tr_b16 a[60:61], v99 offset:26624
  ds_read_b64_tr_b16 a[62:63], v99 offset:26880
  s_waitcnt lgkmcnt(0)
  s_barrier
  s_xor_b32 s36, s13, 6
  s_lshl_b32 s36, s36, 19
  s_add_u32 m0, s39, 28672
  s_add_u32 s37, s36, 0
  buffer_load_dwordx4 v25, s[40:43], s37 offen lds
  s_add_u32 m0, s39, 29696
  s_add_u32 s37, s36, 65536
  buffer_load_dwordx4 v25, s[40:43], s37 offen lds
  s_add_u32 m0, s39, 30720
  s_add_u32 s37, s36, 131072
  buffer_load_dwordx4 v25, s[40:43], s37 offen lds
  s_add_u32 m0, s39, 31744
  s_add_u32 s37, s36, 196608
  buffer_load_dwordx4 v25, s[40:43], s37 offen lds
  s_xor_b32 s36, s13, 6
  s_lshl_b32 s36, s36, 19
  s_add_u32 m0, s39, 24576
  s_add_u32 s37, s36, 262144
  buffer_load_dwordx4 v25, s[40:43], s37 offen lds
  s_add_u32 m0, s39, 25600
  s_add_u32 s37, s36, 327680
  buffer_load_dwordx4 v25, s[40:43], s37 offen lds
  s_add_u32 m0, s39, 26624
  s_add_u32 s37, s36, 393216
  buffer_load_dwordx4 v25, s[40:43], s37 offen lds
  s_add_u32 m0, s39, 27648
  s_add_u32 s37, s36, 458752
  buffer_load_dwordx4 v25, s[40:43], s37 offen lds
  v_mad_u32_u24 v96, v100, 1, v27
  v_mad_u32_u24 v97, v101, 1, v27
  v_mad_u32_u24 v98, v100, 1, v36
  v_mad_u32_u24 v99, v101, 1, v36
  s_waitcnt vmcnt(8)
  s_barrier
  ds_read_b64_tr_b16 a[64:65], v96 offset:8192
  ds_read_b64_tr_b16 a[66:67], v96 offset:8448
  ds_read_b64_tr_b16 a[68:69], v96 offset:10240
  ds_read_b64_tr_b16 a[70:71], v96 offset:10496
  ds_read_b64_tr_b16 a[72:73], v97 offset:8192
  ds_read_b64_tr_b16 a[74:75], v97 offset:8448
  ds_read_b64_tr_b16 a[76:77], v97 offset:10240
  ds_read_b64_tr_b16 a[78:79], v97 offset:10496
  ds_read_b64_tr_b16 a[112:113], v98 offset:8192
  ds_read_b64_tr_b16 a[114:115], v98 offset:8448
  ds_read_b64_tr_b16 a[116:117], v98 offset:10240
  ds_read_b64_tr_b16 a[118:119], v98 offset:10496
  ds_read_b64_tr_b16 a[120:121], v99 offset:8192
  ds_read_b64_tr_b16 a[122:123], v99 offset:8448
  ds_read_b64_tr_b16 a[124:125], v99 offset:10240
  ds_read_b64_tr_b16 a[126:127], v99 offset:10496
  s_waitcnt lgkmcnt(0)
  s_barrier
  s_xor_b32 s36, s13, 6
  s_lshl_b32 s36, s36, 19
  s_add_u32 m0, s39, 12288
  s_add_u32 s37, s36, 0
  buffer_load_dwordx4 v25, s[44:47], s37 offen lds
  s_add_u32 m0, s39, 13312
  s_add_u32 s37, s36, 65536
  buffer_load_dwordx4 v25, s[44:47], s37 offen lds
  s_add_u32 m0, s39, 14336
  s_add_u32 s37, s36, 131072
  buffer_load_dwordx4 v25, s[44:47], s37 offen lds
  s_add_u32 m0, s39, 15360
  s_add_u32 s37, s36, 196608
  buffer_load_dwordx4 v25, s[44:47], s37 offen lds
  s_xor_b32 s36, s13, 6
  s_lshl_b32 s36, s36, 19
  s_add_u32 m0, s39, 8192
  s_add_u32 s37, s36, 262144
  buffer_load_dwordx4 v25, s[44:47], s37 offen lds
  s_add_u32 m0, s39, 9216
  s_add_u32 s37, s36, 327680
  buffer_load_dwordx4 v25, s[44:47], s37 offen lds
  s_add_u32 m0, s39, 10240
  s_add_u32 s37, s36, 393216
  buffer_load_dwordx4 v25, s[44:47], s37 offen lds
  s_add_u32 m0, s39, 11264
  s_add_u32 s37, s36, 458752
  buffer_load_dwordx4 v25, s[44:47], s37 offen lds
  v_mad_u32_u24 v96, v100, 1, v27
  v_mad_u32_u24 v97, v101, 1, v27
  v_mad_u32_u24 v98, v100, 1, v36
  v_mad_u32_u24 v99, v101, 1, v36
  s_waitcnt vmcnt(8)
  s_barrier
  ds_read_b64_tr_b16 a[80:81], v96 offset:24576
  ds_read_b64_tr_b16 a[82:83], v96 offset:24832
  ds_read_b64_tr_b16 a[84:85], v96 offset:26624
  ds_read_b64_tr_b16 a[86:87], v96 offset:26880
  ds_read_b64_tr_b16 a[88:89], v97 offset:24576
  ds_read_b64_tr_b16 a[90:91], v97 offset:24832
  ds_read_b64_tr_b16 a[92:93], v97 offset:26624
  ds_read_b64_tr_b16 a[94:95], v97 offset:26880
  ds_read_b64_tr_b16 a[128:129], v98 offset:24576
  ds_read_b64_tr_b16 a[130:131], v98 offset:24832
  ds_read_b64_tr_b16 a[132:133], v98 offset:26624
  ds_read_b64_tr_b16 a[134:135], v98 offset:26880
  ds_read_b64_tr_b16 a[136:137], v99 offset:24576
  ds_read_b64_tr_b16 a[138:139], v99 offset:24832
  ds_read_b64_tr_b16 a[140:141], v99 offset:26624
  ds_read_b64_tr_b16 a[142:143], v99 offset:26880
  s_waitcnt lgkmcnt(0)
  s_barrier
  s_xor_b32 s36, s13, 0
  s_lshl_b32 s36, s36, 19
  s_add_u32 m0, s39, 28672
  s_add_u32 s37, s36, 0
  buffer_load_dwordx4 v25, s[8:11], s37 offen lds
  s_add_u32 m0, s39, 29696
  s_add_u32 s37, s36, 65536
  buffer_load_dwordx4 v25, s[8:11], s37 offen lds
  s_add_u32 m0, s39, 30720
  s_add_u32 s37, s36, 131072
  buffer_load_dwordx4 v25, s[8:11], s37 offen lds
  s_add_u32 m0, s39, 31744
  s_add_u32 s37, s36, 196608
  buffer_load_dwordx4 v25, s[8:11], s37 offen lds
  s_xor_b32 s36, s13, 0
  s_lshl_b32 s36, s36, 19
  s_add_u32 m0, s39, 0
  s_add_u32 s37, s36, 262144
  buffer_load_dwordx4 v25, s[8:11], s37 offen lds
  s_add_u32 m0, s39, 1024
  s_add_u32 s37, s36, 327680
  buffer_load_dwordx4 v25, s[8:11], s37 offen lds
  s_add_u32 m0, s39, 2048
  s_add_u32 s37, s36, 393216
  buffer_load_dwordx4 v25, s[8:11], s37 offen lds
  s_add_u32 m0, s39, 3072
  s_add_u32 s37, s36, 458752
  buffer_load_dwordx4 v25, s[8:11], s37 offen lds
  v_mad_u32_u24 v96, v100, 1, v27
  v_mad_u32_u24 v97, v101, 1, v27
  v_mad_u32_u24 v98, v100, 1, v36
  v_mad_u32_u24 v99, v101, 1, v36
  s_waitcnt vmcnt(8)
  s_barrier
  ds_read_b64_tr_b16 a[96:97], v96 offset:8192
  ds_read_b64_tr_b16 a[98:99], v96 offset:8448
  ds_read_b64_tr_b16 a[100:101], v96 offset:10240
  ds_read_b64_tr_b16 a[102:103], v96 offset:10496
  ds_read_b64_tr_b16 a[104:105], v97 offset:8192
  ds_read_b64_tr_b16 a[106:107], v97 offset:8448
  ds_read_b64_tr_b16 a[108:109], v97 offset:10240
  ds_read_b64_tr_b16 a[110:111], v97 offset:10496
  ds_read_b64_tr_b16 a[144:145], v98 offset:8192
  ds_read_b64_tr_b16 a[146:147], v98 offset:8448
  ds_read_b64_tr_b16 a[148:149], v98 offset:10240
  ds_read_b64_tr_b16 a[150:151], v98 offset:10496
  ds_read_b64_tr_b16 a[152:153], v99 offset:8192
  ds_read_b64_tr_b16 a[154:155], v99 offset:8448
  ds_read_b64_tr_b16 a[156:157], v99 offset:10240
  ds_read_b64_tr_b16 a[158:159], v99 offset:10496
  s_waitcnt lgkmcnt(0)
  s_barrier
  s_xor_b32 s36, s13, 0
  s_lshl_b32 s36, s36, 19
  s_add_u32 m0, s39, 24576
  s_add_u32 s37, s36, 0
  buffer_load_dwordx4 v25, s[40:43], s37 offen lds
  s_add_u32 m0, s39, 25600
  s_add_u32 s37, s36, 65536
  buffer_load_dwordx4 v25, s[40:43], s37 offen lds
  s_add_u32 m0, s39, 26624
  s_add_u32 s37, s36, 131072
  buffer_load_dwordx4 v25, s[40:43], s37 offen lds
  s_add_u32 m0, s39, 27648
  s_add_u32 s37, s36, 196608
  buffer_load_dwordx4 v25, s[40:43], s37 offen lds
  s_xor_b32 s36, s13, 0
  s_lshl_b32 s36, s36, 19
  s_add_u32 m0, s39, 4096
  s_add_u32 s37, s36, 262144
  buffer_load_dwordx4 v25, s[40:43], s37 offen lds
  s_add_u32 m0, s39, 5120
  s_add_u32 s37, s36, 327680
  buffer_load_dwordx4 v25, s[40:43], s37 offen lds
  s_add_u32 m0, s39, 6144
  s_add_u32 s37, s36, 393216
  buffer_load_dwordx4 v25, s[40:43], s37 offen lds
  s_add_u32 m0, s39, 7168
  s_add_u32 s37, s36, 458752
  buffer_load_dwordx4 v25, s[40:43], s37 offen lds
  v_mad_u32_u24 v96, v100, 7, v27
  v_mad_u32_u24 v97, v101, 7, v27
  v_mad_u32_u24 v98, v100, 7, v36
  v_mad_u32_u24 v99, v101, 7, v36
  s_waitcnt vmcnt(8)
  s_barrier
  ds_read_b64_tr_b16 v[128:129], v98 offset:0
  ds_read_b64_tr_b16 v[130:131], v98 offset:256
  ds_read_b64_tr_b16 v[132:133], v98 offset:2048
  ds_read_b64_tr_b16 v[134:135], v98 offset:2304
  ds_read_b64_tr_b16 v[136:137], v99 offset:0
  ds_read_b64_tr_b16 v[138:139], v99 offset:256
  ds_read_b64_tr_b16 v[140:141], v99 offset:2048
  ds_read_b64_tr_b16 v[142:143], v99 offset:2304
  ds_read_b64_tr_b16 v[64:65], v96 offset:0
  ds_read_b64_tr_b16 v[66:67], v96 offset:256
  ds_read_b64_tr_b16 v[68:69], v96 offset:2048
  ds_read_b64_tr_b16 v[70:71], v96 offset:2304
  ds_read_b64_tr_b16 v[72:73], v97 offset:0
  ds_read_b64_tr_b16 v[74:75], v97 offset:256
  ds_read_b64_tr_b16 v[76:77], v97 offset:2048
  ds_read_b64_tr_b16 v[78:79], v97 offset:2304
  s_waitcnt lgkmcnt(0)
  s_barrier
  ds_write_b128 v4, v[64:67] offset:0
  ds_write_b128 v4, v[68:71] offset:1024
  ds_write_b128 v4, v[72:75] offset:2048
  ds_write_b128 v4, v[76:79] offset:3072
  s_xor_b32 s36, s13, 2
  s_lshl_b32 s36, s36, 19
  s_add_u32 m0, s39, 28672
  s_add_u32 s37, s36, 0
  buffer_load_dwordx4 v25, s[40:43], s37 offen lds
  s_add_u32 m0, s39, 29696
  s_add_u32 s37, s36, 65536
  buffer_load_dwordx4 v25, s[40:43], s37 offen lds
  s_add_u32 m0, s39, 30720
  s_add_u32 s37, s36, 131072
  buffer_load_dwordx4 v25, s[40:43], s37 offen lds
  s_add_u32 m0, s39, 31744
  s_add_u32 s37, s36, 196608
  buffer_load_dwordx4 v25, s[40:43], s37 offen lds
  s_xor_b32 s36, s13, 2
  s_lshl_b32 s36, s36, 19
  s_add_u32 m0, s39, 16384
  s_add_u32 s37, s36, 262144
  buffer_load_dwordx4 v25, s[40:43], s37 offen lds
  s_add_u32 m0, s39, 17408
  s_add_u32 s37, s36, 327680
  buffer_load_dwordx4 v25, s[40:43], s37 offen lds
  s_add_u32 m0, s39, 18432
  s_add_u32 s37, s36, 393216
  buffer_load_dwordx4 v25, s[40:43], s37 offen lds
  s_add_u32 m0, s39, 19456
  s_add_u32 s37, s36, 458752
  buffer_load_dwordx4 v25, s[40:43], s37 offen lds
  s_getpc_b64 s[60:61]
T_pc_2:
  s_add_u32 s60, s60, T_code-T_pc_2
  s_addc_u32 s61, s61, 0
  v_lshlrev_b32 v102, 3, v59
  v_min_u32 v102, 12800, v102
  global_load_dword v103, v102, s[60:61]
  buffer_load_dwordx2 v[54:55], off, s[72:75], 0 sc1
  buffer_load_dword v56, off, s[72:75], 0 offset:128 sc1
  v_mad_u32_u24 v96, v100, 5, v27
  v_mad_u32_u24 v97, v101, 5, v27
  v_mad_u32_u24 v98, v100, 5, v36
  v_mad_u32_u24 v99, v101, 5, v36
  s_waitcnt vmcnt(11)
  s_barrier
  ds_read_b64_tr_b16 v[144:145], v98 offset:4096
  ds_read_b64_tr_b16 v[146:147], v98 offset:4352
  ds_read_b64_tr_b16 v[148:149], v98 offset:6144
  ds_read_b64_tr_b16 v[150:151], v98 offset:6400
  ds_read_b64_tr_b16 v[152:153], v99 offset:4096
  ds_read_b64_tr_b16 v[154:155], v99 offset:4352
  ds_read_b64_tr_b16 v[156:157], v99 offset:6144
  ds_read_b64_tr_b16 v[158:159], v99 offset:6400
  ds_read_b64_tr_b16 v[64:65], v96 offset:4096
  ds_read_b64_tr_b16 v[66:67], v96 offset:4352
  ds_read_b64_tr_b16 v[68:69], v96 offset:6144
  ds_read_b64_tr_b16 v[70:71], v96 offset:6400
  ds_read_b64_tr_b16 v[72:73], v97 offset:4096
  ds_read_b64_tr_b16 v[74:75], v97 offset:4352
  ds_read_b64_tr_b16 v[76:77], v97 offset:6144
  ds_read_b64_tr_b16 v[78:79], v97 offset:6400
  s_waitcnt lgkmcnt(0)
  s_barrier
  ds_write_b128 v4, v[64:67] offset:4096
  ds_write_b128 v4, v[68:71] offset:5120
  ds_write_b128 v4, v[72:75] offset:6144
  ds_write_b128 v4, v[76:79] offset:7168
  s_xor_b32 s36, s13, 2
  s_lshl_b32 s36, s36, 19
  s_add_u32 m0, s39, 24576
  s_add_u32 s37, s36, 0
  buffer_load_dwordx4 v25, s[44:47], s37 offen lds
  s_add_u32 m0, s39, 25600
  s_add_u32 s37, s36, 65536
  buffer_load_dwordx4 v25, s[44:47], s37 offen lds
  s_add_u32 m0, s39, 26624
  s_add_u32 s37, s36, 131072
  buffer_load_dwordx4 v25, s[44:47], s37 offen lds
  s_add_u32 m0, s39, 27648
  s_add_u32 s37, s36, 196608
  buffer_load_dwordx4 v25, s[44:47], s37 offen lds
  s_xor_b32 s36, s13, 2
  s_lshl_b32 s36, s36, 19
  s_add_u32 m0, s39, 20480
  s_add_u32 s37, s36, 262144
  buffer_load_dwordx4 v25, s[44:47], s37 offen lds
  s_add_u32 m0, s39, 21504
  s_add_u32 s37, s36, 327680
  buffer_load_dwordx4 v25, s[44:47], s37 offen lds
  s_add_u32 m0, s39, 22528
  s_add_u32 s37, s36, 393216
  buffer_load_dwordx4 v25, s[44:47], s37 offen lds
  s_add_u32 m0, s39, 23552
  s_add_u32 s37, s36, 458752
  buffer_load_dwordx4 v25, s[44:47], s37 offen lds
  v_mad_u32_u24 v96, v100, 3, v27
  v_mad_u32_u24 v97, v101, 3, v27
  v_mad_u32_u24 v98, v100, 3, v36
  v_mad_u32_u24 v99, v101, 3, v36
  s_waitcnt vmcnt(11)
  s_barrier
  ds_read_b64_tr_b16 v[176:177], v96 offset:16384
  ds_read_b64_tr_b16 v[178:179], v96 offset:16640
  ds_read_b64_tr_b16 v[180:181], v96 offset:18432
  ds_read_b64_tr_b16 v[182:183], v96 offset:18688
  ds_read_b64_tr_b16 v[184:185], v97 offset:16384
  ds_read_b64_tr_b16 v[186:187], v97 offset:16640
  ds_read_b64_tr_b16 v[188:189], v97 offset:18432
  ds_read_b64_tr_b16 v[190:191], v97 offset:18688
  ds_read_b64_tr_b16 v[64:65], v98 offset:16384
  ds_read_b64_tr_b16 v[66:67], v98 offset:16640
  ds_read_b64_tr_b16 v[68:69], v98 offset:18432
  ds_read_b64_tr_b16 v[70:71], v98 offset:18688
  ds_read_b64_tr_b16 v[72:73], v99 offset:16384
  ds_read_b64_tr_b16 v[74:75], v99 offset:16640
  ds_read_b64_tr_b16 v[76:77], v99 offset:18432
  ds_read_b64_tr_b16 v[78:79], v99 offset:18688
  s_waitcnt lgkmcnt(0)
  s_barrier
  ds_write_b128 v4, v[64:67] offset:16384
  ds_write_b128 v4, v[68:71] offset:17408
  ds_write_b128 v4, v[72:75] offset:18432
  ds_write_b128 v4, v[76:79] offset:19456
  s_xor_b32 s36, s13, 0
  s_lshl_b32 s36, s36, 19
  s_add_u32 m0, s39, 8192
  s_add_u32 s37, s36, 0
  buffer_load_dwordx4 v25, s[44:47], s37 offen lds
  s_add_u32 m0, s39, 9216
  s_add_u32 s37, s36, 65536
  buffer_load_dwordx4 v25, s[44:47], s37 offen lds
  s_add_u32 m0, s39, 10240
  s_add_u32 s37, s36, 131072
  buffer_load_dwordx4 v25, s[44:47], s37 offen lds
  s_add_u32 m0, s39, 11264
  s_add_u32 s37, s36, 196608
  buffer_load_dwordx4 v25, s[44:47], s37 offen lds
  s_xor_b32 s36, s13, 0
  s_lshl_b32 s36, s36, 19
  s_add_u32 m0, s39, 12288
  s_add_u32 s37, s36, 262144
  buffer_load_dwordx4 v25, s[44:47], s37 offen lds
  s_add_u32 m0, s39, 13312
  s_add_u32 s37, s36, 327680
  buffer_load_dwordx4 v25, s[44:47], s37 offen lds
  s_add_u32 m0, s39, 14336
  s_add_u32 s37, s36, 393216
  buffer_load_dwordx4 v25, s[44:47], s37 offen lds
  s_add_u32 m0, s39, 15360
  s_add_u32 s37, s36, 458752
  buffer_load_dwordx4 v25, s[44:47], s37 offen lds
  v_mad_u32_u24 v96, v100, 1, v27
  v_mad_u32_u24 v97, v101, 1, v27
  v_mad_u32_u24 v98, v100, 1, v36
  v_mad_u32_u24 v99, v101, 1, v36
  s_waitcnt vmcnt(8)
  s_barrier
  ds_read_b64_tr_b16 v[208:209], v98 offset:20480
  ds_read_b64_tr_b16 v[210:211], v98 offset:20736
  ds_read_b64_tr_b16 v[212:213], v98 offset:22528
  ds_read_b64_tr_b16 v[214:215], v98 offset:22784
  ds_read_b64_tr_b16 v[216:217], v99 offset:20480
  ds_read_b64_tr_b16 v[218:219], v99 offset:20736
  ds_read_b64_tr_b16 v[220:221], v99 offset:22528
  ds_read_b64_tr_b16 v[222:223], v99 offset:22784
  ds_read_b64_tr_b16 v[64:65], v96 offset:20480
  ds_read_b64_tr_b16 v[66:67], v96 offset:20736
  ds_read_b64_tr_b16 v[68:69], v96 offset:22528
  ds_read_b64_tr_b16 v[70:71], v96 offset:22784
  ds_read_b64_tr_b16 v[72:73], v97 offset:20480
  ds_read_b64_tr_b16 v[74:75], v97 offset:20736
  ds_read_b64_tr_b16 v[76:77], v97 offset:22528
  ds_read_b64_tr_b16 v[78:79], v97 offset:22784
  s_waitcnt lgkmcnt(0)
  s_barrier
  ds_write_b128 v4, v[64:67] offset:20480
  ds_write_b128 v4, v[68:71] offset:21504
  ds_write_b128 v4, v[72:75] offset:22528
  ds_write_b128 v4, v[76:79] offset:23552
  s_xor_b32 s36, s13, 2
  s_lshl_b32 s36, s36, 15
  s_add_u32 m0, s39, 24576
  s_add_u32 s37, s36, 512
  buffer_load_dwordx4 v26, s[48:51], s37 offen lds
  s_add_u32 m0, s39, 25600
  s_add_u32 s37, s36, 8704
  buffer_load_dwordx4 v26, s[48:51], s37 offen lds
  s_add_u32 m0, s39, 26624
  s_add_u32 s37, s36, 16896
  buffer_load_dwordx4 v26, s[48:51], s37 offen lds
  s_add_u32 m0, s39, 27648
  s_add_u32 s37, s36, 25088
  buffer_load_dwordx4 v26, s[48:51], s37 offen lds
  s_xor_b32 s36, s13, 3
  s_lshl_b32 s36, s36, 15
  s_add_u32 m0, s39, 28672
  s_add_u32 s37, s36, 512
  buffer_load_dwordx4 v26, s[48:51], s37 offen lds
  s_add_u32 m0, s39, 29696
  s_add_u32 s37, s36, 8704
  buffer_load_dwordx4 v26, s[48:51], s37 offen lds
  s_add_u32 m0, s39, 30720
  s_add_u32 s37, s36, 16896
  buffer_load_dwordx4 v26, s[48:51], s37 offen lds
  s_add_u32 m0, s39, 31744
  s_add_u32 s37, s36, 25088
  buffer_load_dwordx4 v26, s[48:51], s37 offen lds
  s_mov_b32 s19, 0
  s_branch T_arrgo_4
T_arr_3:
  s_add_u32 s19, s19, 1
  s_cmp_gt_u32 s19, 32768
  s_cbranch_scc1 M_exit
  buffer_load_dwordx2 v[54:55], off, s[72:75], 0 sc1
  buffer_load_dword v56, off, s[72:75], 0 offset:128 sc1
  s_waitcnt vmcnt(0)
T_arrgo_4:
  v_sad_u8 v57, v54, 0, 0
  v_sad_u8 v57, v55, 0, v57
  v_or_b32 v58, v54, v55
  v_cmp_gt_u32 vcc, 32, v57
  s_cbranch_vccnz T_arr_3
  v_cmp_gt_u32 vcc, 0x100, v56
  s_cbranch_vccnz T_arr_3
  v_readfirstlane_b32 s36, v58
  s_nop 0
  s_and_b32 s36, s36, 0x20202020
  s_cselect_b32 s56, 0, 1
  s_mov_b32 s14, -1
  s_mov_b32 s30, -1
  s_mov_b32 s19, 0
  s_branch T_kvok_6
T_kv_5:
  s_sleep 4
  s_add_u32 s19, s19, 1
  s_cmp_gt_u32 s19, 32768
  s_cbranch_scc1 M_exit
T_kvok_6:
  s_add_u32 s39, s99, 128
  s_mov_b32 s38, 0
  s_mov_b32 s37, 0
  s_atomic_or s38, s[58:59], s99 glc
  s_atomic_or s37, s[58:59], s39 glc
  s_waitcnt lgkmcnt(0)
  s_lshl_b32 s38, s38, 1
  s_lshl1_add_u32 s37, s37, 1
  s_min_u32 s38, s38, s37
  s_cmp_ge_u32 s38, 64
  s_cselect_b32 s38, 100, s38
  s_sub_u32 s38, s38, 1
  s_max_i32 s30, s30, s38
  s_cmp_ge_i32 s14, s30
  s_cbranch_scc1 T_kv_5
  s_mov_b32 m0, s31
  s_nop 0
  buffer_load_dwordx4 v9, s[4:7], s27 offen sc1 lds
  s_mov_b32 m0, s32
  s_nop 0
  buffer_load_dwordx4 v9, s[4:7], s27 offen offset:128 sc1 lds
  s_mov_b32 m0, s33
  s_nop 0
  buffer_load_dwordx4 v10, s[4:7], s28 offen sc1 lds
  s_mov_b32 m0, s34
  s_nop 0
  buffer_load_dwordx4 v10, s[4:7], s28 offen offset:256 sc1 lds
  s_add_u32 s27, s27, 8192
  s_add_u32 s28, s28, 8192
  s_lshl_b32 s36, s12, 10
  s_add_u32 s36, s36, 145752064
  buffer_load_dwordx4 v[40:43], v2, s[4:7], s36 offen sc1
  v_mad_u32_u24 v96, v101, 1, v27
  v_mad_u32_u24 v97, v100, 1, v27
  v_mad_u32_u24 v98, v101, 1, v36
  v_mad_u32_u24 v99, v100, 1, v36
  s_waitcnt vmcnt(13)
  s_barrier
  ds_read_b64_tr_b16 v[64:65], v96 offset:8192
  ds_read_b64_tr_b16 v[66:67], v96 offset:8448
  ds_read_b64_tr_b16 v[68:69], v96 offset:10240
  ds_read_b64_tr_b16 v[70:71], v96 offset:10496
  ds_read_b64_tr_b16 v[72:73], v97 offset:8192
  ds_read_b64_tr_b16 v[74:75], v97 offset:8448
  ds_read_b64_tr_b16 v[76:77], v97 offset:10240
  ds_read_b64_tr_b16 v[78:79], v97 offset:10496
  ds_read_b64_tr_b16 v[80:81], v98 offset:8192
  ds_read_b64_tr_b16 v[82:83], v98 offset:8448
  ds_read_b64_tr_b16 v[84:85], v98 offset:10240
  ds_read_b64_tr_b16 v[86:87], v98 offset:10496
  ds_read_b64_tr_b16 v[88:89], v99 offset:8192
  ds_read_b64_tr_b16 v[90:91], v99 offset:8448
  ds_read_b64_tr_b16 v[92:93], v99 offset:10240
  ds_read_b64_tr_b16 v[94:95], v99 offset:10496
  s_waitcnt lgkmcnt(0)
  s_barrier
  ds_write_b128 v4, v[64:67] offset:8192
  ds_write_b128 v4, v[68:71] offset:9216
  ds_write_b128 v4, v[72:75] offset:10240
  ds_write_b128 v4, v[76:79] offset:11264
  ds_write_b128 v4, v[80:83] offset:12288
  ds_write_b128 v4, v[84:87] offset:13312
  ds_write_b128 v4, v[88:91] offset:14336
  ds_write_b128 v4, v[92:95] offset:15360
  s_waitcnt vmcnt(9)
  ds_read_b64_tr_b16 v[64:65], v28 offset:24576
  ds_read_b64_tr_b16 v[66:67], v28 offset:24832
  ds_read_b64_tr_b16 v[68:69], v28 offset:25600
  ds_read_b64_tr_b16 v[70:71], v28 offset:25856
  ds_read_b64_tr_b16 v[72:73], v28 offset:24584
  ds_read_b64_tr_b16 v[74:75], v28 offset:24840
  ds_read_b64_tr_b16 v[76:77], v28 offset:25608
  ds_read_b64_tr_b16 v[78:79], v28 offset:25864
  s_waitcnt lgkmcnt(0)
  ds_write_b128 v4, v[64:67] offset:24576
  ds_write_b128 v4, v[68:71] offset:25600
  ds_write_b128 v4, v[72:75] offset:26624
  ds_write_b128 v4, v[76:79] offset:27648
  s_waitcnt lgkmcnt(0)
  s_waitcnt vmcnt(5)
  ds_read_b64_tr_b16 v[64:65], v28 offset:28672
  ds_read_b64_tr_b16 v[66:67], v28 offset:28928
  ds_read_b64_tr_b16 v[68:69], v28 offset:29696
  ds_read_b64_tr_b16 v[70:71], v28 offset:29952
  ds_read_b64_tr_b16 v[72:73], v28 offset:28680
  ds_read_b64_tr_b16 v[74:75], v28 offset:28936
  ds_read_b64_tr_b16 v[76:77], v28 offset:29704
  ds_read_b64_tr_b16 v[78:79], v28 offset:29960
  s_waitcnt lgkmcnt(0)
  ds_write_b128 v4, v[64:67] offset:28672
  ds_write_b128 v4, v[68:71] offset:29696
  ds_write_b128 v4, v[72:75] offset:30720
  ds_write_b128 v4, v[76:79] offset:31744
  s_waitcnt lgkmcnt(0)
  s_mov_b32 s14, 1
  s_cmp_lt_i32 s14, s30
  s_cbranch_scc1 T_kv2_7
  s_mov_b32 s19, 0
  s_branch T_kvok_9
T_kv_8:
  s_sleep 4
  s_add_u32 s19, s19, 1
  s_cmp_gt_u32 s19, 32768
  s_cbranch_scc1 M_exit
T_kvok_9:
  s_add_u32 s39, s99, 128
  s_mov_b32 s38, 0
  s_mov_b32 s37, 0
  s_atomic_or s38, s[58:59], s99 glc
  s_atomic_or s37, s[58:59], s39 glc
  s_waitcnt lgkmcnt(0)
  s_lshl_b32 s38, s38, 1
  s_lshl1_add_u32 s37, s37, 1
  s_min_u32 s38, s38, s37
  s_cmp_ge_u32 s38, 64
  s_cselect_b32 s38, 100, s38
  s_sub_u32 s38, s38, 1
  s_max_i32 s30, s30, s38
  s_cmp_ge_i32 s14, s30
  s_cbranch_scc1 T_kv_8
T_kv2_7:
  s_waitcnt vmcnt(0) lgkmcnt(0)
  s_barrier
  s_cmp_ge_u32 s13, 2
  s_cselect_b64 vcc, -1, 0
  v_cndmask_b32 v3, v8, v19, vcc
  ds_read_b128 v[68:71], v4 offset:0
  ds_read_b128 v[72:75], v4 offset:1024
  ds_read_b128 v[76:79], v4 offset:4096
  ds_read_b128 v[80:83], v4 offset:5120
  ds_read_b128 v[84:87], v4 offset:8192
  ds_read_b128 v[88:91], v4 offset:9216
  ds_read_b128 v[92:95], v4 offset:2048
  ds_read_b128 v[96:99], v4 offset:3072
  ds_read_b128 v[100:103], v4 offset:6144
  ds_read_b128 v[104:107], v4 offset:7168
  ds_read_b128 v[108:111], v4 offset:10240
  ds_read_b128 v[112:115], v4 offset:11264
  ds_read_b128 v[28:31], v59 offset:16384
  ds_read_b128 v[32:35], v59 offset:20480
  ds_read_b128 v[36:39], v2 offset:8192
  ds_read_b128 v[40:43], v2 offset:9216
  ds_read_b128 v[44:47], v2 offset:10240
  ds_read_b128 v[48:51], v2 offset:11264
  ds_read_b128 v[52:55], v2 offset:12288
  ds_read_b128 v[56:59], v2 offset:13312
  ds_read_b128 v[60:63], v2 offset:14336
  ds_read_b128 v[64:67], v2 offset:15360
  s_and_b32 s36, s13, 1
  s_lshl_b32 s36, s36, 12
  s_add_u32 s22, s22, s36
  s_add_u32 s23, s36, 145752064
  s_mov_b32 s14, -1
  s_and_b32 s57, s14, 1
  s_and_b32 s36, s14, 3
  s_lshl_b32 s36, s36, 13
  s_add_u32 s26, s36, s23
  s_add_u32 s36, s36, 8192
  s_and_b32 s36, s36, 0x7fff
  s_add_u32 s24, s36, 145752064
  s_add_u32 s25, s36, 145756160
  s_add_u32 s35, s36, s23
  s_waitcnt lgkmcnt(0)
  s_cmp_lg_u32 s56, 0
  s_cbranch_scc1 M_global
T_code:
  s_cmp_eq_u32 s13, 1
  s_cbranch_scc1 T_w_11
  s_cmp_eq_u32 s13, 2
  s_cbranch_scc1 T_w_12
  s_cmp_eq_u32 s13, 3
  s_cbranch_scc1 T_w_13
T_w_10:
  s_mov_b32 s19, 0
  s_add_u32 s14, s14, 1
  s_and_b32 s57, s14, 1
  v_mov_b64 v[16:17], 0
  v_mov_b64 v[18:19], 0
  v_mov_b64 v[20:21], 0
  v_mov_b64 v[22:23], 0
  v_mov_b64 v[24:25], 0
  v_mov_b64 v[26:27], 0
  buffer_load_dwordx4 v[124:127], v2, s[4:7], s24 offen offset:0 sc1
  buffer_load_dwordx4 v[116:119], v2, s[4:7], s25 offen offset:0 sc1
  buffer_load_dwordx4 v[124:127], v2, s[4:7], s24 offen offset:0 sc1
  buffer_load_dwordx4 v[116:119], v2, s[4:7], s25 offen offset:0 sc1
  s_branch T_loop_14
.p2align 6
T_retry_15:
  s_mov_b64 exec, vcc
  buffer_load_dwordx4 v[124:127], v2, s[4:7], s24 offen offset:0 sc1
  buffer_load_dwordx4 v[116:119], v2, s[4:7], s25 offen offset:0 sc1
  s_mov_b64 exec, -1
  s_add_u32 s19, s19, 1
  s_cmp_gt_u32 s19, 32768
  s_cbranch_scc1 M_exit
  s_nop 0
  v_mov_b64 v[16:17], 0
  v_mov_b64 v[18:19], 0
T_loop_14:
  s_waitcnt vmcnt(3) lgkmcnt(0)
  v_max3_u32 v123, v124, v125, v126
  v_max_u32 v123, v123, v127
  v_mov_b32_dpp v120, v124 row_ror:8 row_mask:0xf bank_mask:0xf
  v_mov_b32_dpp v121, v125 row_ror:8 row_mask:0xf bank_mask:0xf
  s_waitcnt vmcnt(2)
  v_max3_u32 v123, v123, v116, v117
  v_max3_u32 v123, v123, v118, v119
  v_cmp_eq_u32 vcc, -1, v123
  v_smfmac_f32_16x16x64_bf16 v[16:19], v[124:127], v[68:75], v0
  s_cbranch_vccnz T_retry_15
  ds_write_b128 v2, v[124:127] offset:0
  v_mov_b32_dpp v122, v126 row_ror:8 row_mask:0xf bank_mask:0xf
  v_smfmac_f32_16x16x64_bf16 v[20:23], v[124:127], v[76:83], v0
  s_and_b32 s57, s14, 1
  v_mov_b32_dpp v123, v127 row_ror:8 row_mask:0xf bank_mask:0xf
  v_smfmac_f32_16x16x64_bf16 v[24:27], v[124:127], v[84:91], v0
  s_and_b32 s36, s14, 3
  ds_write_b128 v2, v[116:119] offset:4096
  v_smfmac_f32_16x16x64_bf16 v[16:19], v[120:123], v[92:99], v0
  s_lshl_b32 s36, s36, 13
  v_mov_b32_dpp v84, v116 row_ror:8 row_mask:0xf bank_mask:0xf
  v_smfmac_f32_16x16x64_bf16 v[20:23], v[120:123], v[100:107], v0
  s_add_u32 s26, s36, s23
  ds_read_b128 v[68:71], v4 offset:12288
  v_mov_b32_dpp v85, v117 row_ror:8 row_mask:0xf bank_mask:0xf
  v_smfmac_f32_16x16x64_bf16 v[24:27], v[120:123], v[108:115], v0
  s_add_u32 s36, s36, 8192
  ds_read_b128 v[72:75], v4 offset:13312
  v_mov_b32_dpp v86, v118 row_ror:8 row_mask:0xf bank_mask:0xf
  v_smfmac_f32_16x16x64_bf16 v[16:19], v[116:119], v[224:231], v0
  s_and_b32 s36, s36, 0x7fff
  ds_read_b128 v[76:79], v4 offset:14336
  v_mov_b32_dpp v87, v119 row_ror:8 row_mask:0xf bank_mask:0xf
  v_smfmac_f32_16x16x64_bf16 v[20:23], v[116:119], v[240:247], v0
  s_waitcnt lgkmcnt(3)
  s_barrier
  ds_read_b128 v[100:103], v2 offset:1024
  v_smfmac_f32_16x16x64_bf16 v[24:27], v[116:119], a[0:7], v0
  s_mov_b32 m0, s31
  ds_read_b128 v[120:123], v1 offset:1024
  buffer_load_dwordx4 v9, s[4:7], s27 offen sc1 lds
  v_smfmac_f32_16x16x64_bf16 v[16:19], v[84:87], v[232:239], v0
  s_mov_b32 m0, s32
  v_smfmac_f32_16x16x64_bf16 v[20:23], v[84:87], v[248:255], v0
  ds_read_b128 v[80:83], v4 offset:15360
  v_smfmac_f32_16x16x64_bf16 v[24:27], v[84:87], a[8:15], v0
  s_waitcnt lgkmcnt(2)
  v_smfmac_f32_16x16x64_bf16 v[16:19], v[100:103], v[128:135], v0
  ds_read_b128 v[92:95], v2 offset:2048
  buffer_load_dwordx4 v9, s[4:7], s27 offen offset:128 sc1 lds
  v_smfmac_f32_16x16x64_bf16 v[20:23], v[100:103], v[144:151], v0
  ds_read_b128 v[96:99], v1 offset:2048
  s_mov_b32 m0, s33
  v_smfmac_f32_16x16x64_bf16 v[24:27], v[100:103], v[68:75], v0
  s_waitcnt vmcnt(2) lgkmcnt(3)
  ds_read_b128 v[116:119], v2 offset:3072
  v_smfmac_f32_16x16x64_bf16 v[16:19], v[120:123], v[136:143], v0
  ds_read_b128 v[124:127], v1 offset:3072
  v_smfmac_f32_16x16x64_bf16 v[20:23], v[120:123], v[152:159], v0
  s_waitcnt lgkmcnt(4)
  ds_read_b128 v[104:107], v2 offset:5120
  buffer_load_dwordx4 v10, s[4:7], s28 offen sc1 lds
  v_smfmac_f32_16x16x64_bf16 v[24:27], v[120:123], v[76:83], v0
  s_waitcnt lgkmcnt(4)
  ds_read_b128 v[108:111], v1 offset:5120
  s_mov_b32 m0, s34
  v_smfmac_f32_16x16x64_bf16 v[16:19], v[92:95], v[160:167], v0
  s_waitcnt lgkmcnt(4)
  ds_read_b128 v[112:115], v2 offset:6144
  v_smfmac_f32_16x16x64_bf16 v[16:19], v[96:99], v[168:175], v0
  s_waitcnt lgkmcnt(4)
  ds_read_b128 v[84:87], v1 offset:6144
  v_smfmac_f32_16x16x64_bf16 v[16:19], v[116:119], v[192:199], v0
  s_waitcnt lgkmcnt(4)
  ds_read_b128 v[88:91], v2 offset:7168
  buffer_load_dwordx4 v10, s[4:7], s28 offen offset:256 sc1 lds
  v_smfmac_f32_16x16x64_bf16 v[16:19], v[124:127], v[200:207], v0
  s_waitcnt lgkmcnt(4)
  ds_read_b128 v[100:103], v1 offset:7168
  v_smfmac_f32_16x16x64_bf16 v[16:19], v[104:107], a[16:23], v0
  s_waitcnt lgkmcnt(4)
  ds_read_b128 v[68:71], v4 offset:16384
  v_smfmac_f32_16x16x64_bf16 v[16:19], v[108:111], a[24:31], v0
  s_waitcnt lgkmcnt(4)
  ds_read_b128 v[72:75], v4 offset:17408
  v_smfmac_f32_16x16x64_bf16 v[16:19], v[112:115], a[64:71], v0
  s_waitcnt lgkmcnt(4)
  ds_read_b128 v[76:79], v4 offset:18432
  v_smfmac_f32_16x16x64_bf16 v[16:19], v[84:87], a[72:79], v0
  s_waitcnt lgkmcnt(4)
  ds_read_b128 v[80:83], v4 offset:19456
  v_smfmac_f32_16x16x64_bf16 v[16:19], v[88:91], a[112:119], v0
  s_waitcnt lgkmcnt(4)
  v_smfmac_f32_16x16x64_bf16 v[16:19], v[100:103], a[120:127], v0
  s_add_u32 s24, s36, 145752064
  s_add_u32 s25, s36, 145756160
  v_smfmac_f32_16x16x64_bf16 v[20:23], v[92:95], v[176:183], v0
  s_add_u32 s35, s36, s23
  v_smfmac_f32_16x16x64_bf16 v[20:23], v[96:99], v[184:191], v0
  s_waitcnt lgkmcnt(2)
  v_smfmac_f32_16x16x64_bf16 v[20:23], v[116:119], v[68:75], v0
  s_waitcnt lgkmcnt(0)
  ds_read_b128 v[68:71], v4 offset:20480
  v_mul_f32 v16, s18, v16
  v_smfmac_f32_16x16x64_bf16 v[20:23], v[124:127], v[76:83], v0
  ds_read_b128 v[72:75], v4 offset:21504
  v_mul_f32 v17, s18, v17
  v_smfmac_f32_16x16x64_bf16 v[20:23], v[104:107], a[32:39], v0
  ds_read_b128 v[76:79], v4 offset:22528
  v_mul_f32 v18, s18, v18
  v_smfmac_f32_16x16x64_bf16 v[20:23], v[108:111], a[40:47], v0
  ds_read_b128 v[80:83], v4 offset:23552
  v_mul_f32 v19, s18, v19
  v_smfmac_f32_16x16x64_bf16 v[20:23], v[112:115], a[80:87], v0
  v_cvt_pk_bf16_f32 v120, v16, v17
  v_smfmac_f32_16x16x64_bf16 v[20:23], v[84:87], a[88:95], v0
  v_cvt_pk_bf16_f32 v121, v18, v19
  v_smfmac_f32_16x16x64_bf16 v[20:23], v[88:91], a[128:135], v0
  ds_write_b64 v5, v[120:121] offset:24576
  v_smfmac_f32_16x16x64_bf16 v[20:23], v[100:103], a[136:143], v0
  s_waitcnt lgkmcnt(3)
  v_smfmac_f32_16x16x64_bf16 v[24:27], v[92:95], v[68:75], v0
  s_waitcnt lgkmcnt(1)
  v_mov_b64 v[92:93], 0
  v_smfmac_f32_16x16x64_bf16 v[24:27], v[96:99], v[76:83], v0
  s_nop 1
  v_cvt_pk_bf16_f32 v122, v20, v21
  v_cvt_pk_bf16_f32 v123, v22, v23
  v_smfmac_f32_16x16x64_bf16 v[24:27], v[116:119], v[208:215], v0
  ds_write_b64 v5, v[122:123] offset:26880
  v_mov_b64 v[94:95], 0
  v_smfmac_f32_16x16x64_bf16 v[24:27], v[124:127], v[216:223], v0
  s_waitcnt lgkmcnt(1)
  s_barrier
  ds_read_b64_tr_b16 v[68:69], v6 offset:24576
  v_smfmac_f32_16x16x64_bf16 v[24:27], v[104:107], a[48:55], v0
  s_add_u32 s27, s27, 8192
  ds_read_b64_tr_b16 v[70:71], v6 offset:24640
  ds_read_b64_tr_b16 v[72:73], v6 offset:24832
  v_smfmac_f32_16x16x64_bf16 v[24:27], v[108:111], a[56:63], v0
  s_add_u32 s28, s28, 8192
  ds_read_b64_tr_b16 v[74:75], v6 offset:24896
  ds_read_b64_tr_b16 v[76:77], v6 offset:25088
  v_smfmac_f32_16x16x64_bf16 v[24:27], v[112:115], a[96:103], v0
  s_nop 0
  ds_read_b64_tr_b16 v[78:79], v6 offset:25152
  ds_read_b64_tr_b16 v[80:81], v6 offset:25344
  v_smfmac_f32_16x16x64_bf16 v[24:27], v[84:87], a[104:111], v0
  ds_read_b64_tr_b16 v[82:83], v6 offset:25408
  v_mov_b64 v[96:97], 0
  v_smfmac_f32_16x16x64_bf16 v[24:27], v[88:91], a[144:151], v0
  s_waitcnt lgkmcnt(8)
  s_barrier
  ds_read_b64_tr_b16 v[116:117], v6 offset:26880
  v_smfmac_f32_16x16x64_bf16 v[24:27], v[100:103], a[152:159], v0
  s_waitcnt lgkmcnt(7)
  ds_read_b64_tr_b16 v[118:119], v6 offset:26944
  v_mfma_f32_16x16x32_bf16 v[16:19], v[36:39], v[68:71], 0
  s_waitcnt lgkmcnt(6)
  ds_read_b64_tr_b16 v[124:125], v6 offset:27136
  ds_read_b64_tr_b16 v[126:127], v6 offset:27200
  v_mfma_f32_16x16x32_bf16 v[16:19], v[40:43], v[72:75], v[16:19]
  s_waitcnt lgkmcnt(6)
  ds_read_b64_tr_b16 v[104:105], v6 offset:27392
  ds_read_b64_tr_b16 v[106:107], v6 offset:27456
  v_mfma_f32_16x16x32_bf16 v[16:19], v[44:47], v[76:79], v[16:19]
  s_waitcnt lgkmcnt(6)
  ds_read_b64_tr_b16 v[108:109], v6 offset:27648
  ds_read_b64_tr_b16 v[110:111], v6 offset:27712
  v_mfma_f32_16x16x32_bf16 v[16:19], v[48:51], v[80:83], v[16:19]
  s_waitcnt lgkmcnt(6)
  v_cvt_pk_bf16_f32 v120, v24, v25
  v_cvt_pk_bf16_f32 v121, v26, v27
  v_mfma_f32_16x16x32_bf16 v[112:115], v[116:119], v[68:71], 0
  s_waitcnt lgkmcnt(4)
  buffer_store_dwordx4 v[120:123], v2, s[4:7], s29 offen offset:0 sc1
  v_mov_b64 v[98:99], 0
  v_mfma_f32_16x16x32_bf16 v[112:115], v[124:127], v[72:75], v[112:115]
  s_waitcnt lgkmcnt(2)
  v_mov_b64 v[36:37], 0
  v_exp_f32 v100, v16
  v_mfma_f32_16x16x32_bf16 v[112:115], v[104:107], v[76:79], v[112:115]
  s_waitcnt lgkmcnt(0)
  v_exp_f32 v101, v17
  v_mfma_f32_16x16x32_bf16 v[112:115], v[108:111], v[80:83], v[112:115]
  v_exp_f32 v102, v18
  v_mfma_f32_16x16x32_bf16 v[20:23], v[52:55], v[68:71], 0
  v_exp_f32 v103, v19
  v_mfma_f32_16x16x32_bf16 v[20:23], v[56:59], v[72:75], v[20:23]
  v_cvt_pk_bf16_f32 v44, v100, v101
  v_cvt_pk_bf16_f32 v45, v102, v103
  v_mfma_f32_16x16x32_bf16 v[20:23], v[60:63], v[76:79], v[20:23]
  s_add_u32 s29, s29, 131072
  v_exp_f32 v100, v112
  v_mfma_f32_16x16x32_bf16 v[20:23], v[64:67], v[80:83], v[20:23]
  v_exp_f32 v101, v113
  v_exp_f32 v102, v114
  v_exp_f32 v103, v115
  v_cvt_pk_bf16_f32 v84, v100, v101
  v_cvt_pk_bf16_f32 v85, v102, v103
  v_cndmask_b32 v48, v84, 0, s[16:17]
  v_cndmask_b32 v49, v85, 0, s[16:17]
  v_cndmask_b32 v50, 0, v84, s[16:17]
  v_cndmask_b32 v51, 0, v85, s[16:17]
  v_exp_f32 v100, v20
  v_mfma_f32_16x16x16_bf16 v[88:91], v[12:13], v[48:49], 0
  v_exp_f32 v101, v21
  v_mfma_f32_16x16x16_bf16 v[24:27], v[120:121], v[48:49], 0
  v_exp_f32 v102, v22
  v_mfma_f32_16x16x16_bf16 v[116:119], v[120:121], v[50:51], 0
  v_exp_f32 v103, v23
  v_cvt_pk_bf16_f32 v46, v100, v101
  v_cvt_pk_bf16_f32 v47, v102, v103
  v_mov_b64 v[38:39], 0
  s_nop 0
  v_mfma_f32_16x16x32_bf16 v[88:91], v[12:15], v[44:47], v[88:91]
  v_mov_b64 v[40:41], 0
  v_mov_b64 v[42:43], 0
  v_mfma_f32_16x16x32_bf16 v[24:27], v[28:31], v[44:47], v[24:27]
  ds_read_b128 v[52:55], v4 offset:24576
  ds_read_b128 v[56:59], v4 offset:25600
  v_mfma_f32_16x16x32_bf16 v[116:119], v[32:35], v[44:47], v[116:119]
  s_nop 1
T_back_22:
  v_rcp_f32 v89, v88
  v_subrev_u32 v100, s54, v88
  v_cmp_le_u32 vcc, s96, v100
  v_mul_f32 v24, v89, v24
  v_mul_f32 v25, v89, v25
  v_cvt_pk_bf16_f32 v124, v24, v25
  v_pk_mul_f32 v[26:27], v[26:27], v[88:89] op_sel:[0,1] op_sel_hi:[1,1]
  v_pk_mul_f32 v[116:117], v[116:117], v[88:89] op_sel:[0,1] op_sel_hi:[1,1]
  v_pk_mul_f32 v[118:119], v[118:119], v[88:89] op_sel:[0,1] op_sel_hi:[1,1]
  v_cvt_pk_bf16_f32 v125, v26, v27
  v_cvt_pk_bf16_f32 v126, v116, v117
  v_cvt_pk_bf16_f32 v127, v118, v119
  ds_write_b128 v11, v[124:127] offset:29184
  s_cbranch_vccnz T_slow_21
  v_smfmac_f32_16x16x64_bf16 v[92:95], v[124:127], a[160:167], v0
  s_mov_b32 s96, s55
  v_smfmac_f32_16x16x64_bf16 v[96:99], v[124:127], a[168:175], v0
  s_cmp_eq_u32 s14, 63
  v_smfmac_f32_16x16x64_bf16 v[36:39], v[124:127], a[176:183], v0
  s_waitcnt lgkmcnt(0)
  s_barrier
  ds_read_b128 v[104:107], v11 offset:29696
  ds_read_b128 v[108:111], v11 offset:30208
  ds_read_b128 v[68:71], v11 offset:30720
  s_cbranch_scc1 M_tdone
  v_smfmac_f32_16x16x64_bf16 v[40:43], v[124:127], a[184:191], v0
  s_waitcnt lgkmcnt(2)
  v_smfmac_f32_16x16x64_bf16 v[92:95], v[104:107], a[192:199], v0
  s_waitcnt lgkmcnt(1)
  ds_read_b128 v[76:79], v4 offset:28672
  v_smfmac_f32_16x16x64_bf16 v[92:95], v[108:111], a[224:231], v0
  s_waitcnt lgkmcnt(1)
  ds_read_b128 v[80:83], v4 offset:29696
  v_smfmac_f32_16x16x64_bf16 v[92:95], v[68:71], a[240:247], v0
  ds_read_b128 v[60:63], v4 offset:26624
  v_smfmac_f32_16x16x64_bf16 v[96:99], v[104:107], a[200:207], v0
  ds_read_b128 v[64:67], v4 offset:27648
  v_smfmac_f32_16x16x64_bf16 v[96:99], v[108:111], a[232:239], v0
  ds_read_b128 v[28:31], v4 offset:30720
  s_nop 0
  v_cvt_pk_bf16_f32 v16, v92, v93
  v_cvt_pk_bf16_f32 v17, v94, v95
  v_bfi_b32 v16, 1, s57, v16
  v_smfmac_f32_16x16x64_bf16 v[96:99], v[68:71], a[248:255], v0
  buffer_store_dwordx2 v[16:17], v7, s[4:7], s20 offen offset:0
  v_smfmac_f32_16x16x64_bf16 v[36:39], v[104:107], a[208:215], v0
  ds_read_b128 v[32:35], v4 offset:31744
  v_smfmac_f32_16x16x64_bf16 v[36:39], v[108:111], v[52:59], v0
  s_waitcnt lgkmcnt(4)
  s_nop 0
  v_cvt_pk_bf16_f32 v18, v96, v97
  v_cvt_pk_bf16_f32 v19, v98, v99
  v_bfi_b32 v18, 1, s57, v18
  v_smfmac_f32_16x16x64_bf16 v[36:39], v[68:71], v[76:83], v0
  buffer_store_dwordx2 v[18:19], v7, s[4:7], s20 offen offset:64
  v_smfmac_f32_16x16x64_bf16 v[40:43], v[104:107], a[216:223], v0
  s_waitcnt lgkmcnt(2)
  ds_read_b128 v[116:119], v2 offset:31232
  v_smfmac_f32_16x16x64_bf16 v[40:43], v[108:111], v[60:67], v0
  s_waitcnt lgkmcnt(1)
  s_nop 0
  v_cvt_pk_bf16_f32 v20, v36, v37
  v_cvt_pk_bf16_f32 v21, v38, v39
  v_bfi_b32 v20, 1, s57, v20
  v_smfmac_f32_16x16x64_bf16 v[40:43], v[68:71], v[28:35], v0
  buffer_store_dwordx2 v[20:21], v7, s[4:7], s21 offen offset:0
  s_nop 6
  v_cvt_pk_bf16_f32 v22, v40, v41
  v_cvt_pk_bf16_f32 v23, v42, v43
  v_bfi_b32 v22, 1, s57, v22
  buffer_store_dwordx2 v[22:23], v7, s[4:7], s21 offen offset:64
  ds_read_b128 v[68:71], v4 offset:0
  ds_read_b128 v[72:75], v4 offset:1024
  ds_read_b128 v[76:79], v4 offset:4096
  ds_read_b128 v[80:83], v4 offset:5120
  ds_read_b128 v[84:87], v4 offset:8192
  ds_read_b128 v[88:91], v4 offset:9216
  v_mov_b64 v[16:17], 0
  v_mov_b64 v[18:19], 0
  v_mov_b64 v[20:21], 0
  v_mov_b64 v[22:23], 0
  v_mov_b64 v[24:25], 0
  v_mov_b64 v[26:27], 0
  s_mov_b32 s19, 0
  v_mov_b32 v49, -1
  s_waitcnt vmcnt(2)
  buffer_load_dwordx4 v[52:55], v2, s[4:7], s22 offen offset:0 sc1
  buffer_load_dwordx4 v[56:59], v2, s[4:7], s22 offen offset:1024 sc1
  buffer_load_dwordx4 v[60:63], v2, s[4:7], s22 offen offset:2048 sc1
  buffer_load_dwordx4 v[64:67], v2, s[4:7], s22 offen offset:3072 sc1
  ds_read_b128 v[92:95], v4 offset:2048
  ds_read_b128 v[96:99], v4 offset:3072
  ds_read_b128 v[100:103], v4 offset:6144
  ds_read_b128 v[104:107], v4 offset:7168
  ds_read_b128 v[108:111], v4 offset:10240
  ds_read_b128 v[112:115], v4 offset:11264
  ds_read_b64 v[44:45], v2 offset:32256
  s_waitcnt lgkmcnt(0)
  v_readfirstlane_b32 s38, v44
  v_readfirstlane_b32 s37, v45
  s_nop 0
  s_lshl_b32 s38, s38, 1
  s_lshl1_add_u32 s37, s37, 1
  s_min_u32 s38, s38, s37
  s_cmp_ge_u32 s38, 64
  s_cselect_b32 s38, 100, s38
  s_sub_u32 s38, s38, 1
  s_max_i32 s30, s30, s38
  s_waitcnt lgkmcnt(12)
  s_waitcnt vmcnt(3)
  v_mfma_f32_16x16x32_bf16 v[120:123], v[116:119], v[52:55], 0
  v_xor_b32 v48, s57, v52
  v_bitop3_b32 v48, v48, v54, s57 bitop3:0xf6
  s_waitcnt vmcnt(2)
  v_mfma_f32_16x16x32_bf16 v[120:123], v[116:119], v[56:59], v[120:123]
  v_bitop3_b32 v48, v48, v56, s57 bitop3:0xf6
  v_bitop3_b32 v48, v48, v58, s57 bitop3:0xf6
  s_waitcnt vmcnt(1)
  v_mfma_f32_16x16x32_bf16 v[120:123], v[116:119], v[60:63], v[120:123]
  v_bitop3_b32 v48, v48, v60, s57 bitop3:0xf6
  v_bitop3_b32 v48, v48, v62, s57 bitop3:0xf6
  s_waitcnt vmcnt(0)
  v_mfma_f32_16x16x32_bf16 v[120:123], v[116:119], v[64:67], v[120:123]
  v_bitop3_b32 v48, v48, v64, s57 bitop3:0xf6
  v_bitop3_b32 v48, v48, v66, s57 bitop3:0xf6
  v_and_b32 v48, 1, v48
  v_cmp_ne_u32 vcc, 0, v48
  s_cbranch_vccnz T_p1re_24
T_p1ok_25:
  s_nop 2
  v_add_f32_dpp v120, v120, v120 row_ror:8 row_mask:0xf bank_mask:0xf
  v_add_f32_dpp v121, v121, v121 row_ror:8 row_mask:0xf bank_mask:0xf
  v_cvt_pk_bf16_f32 v48, v120, v121
  buffer_store_dword v48, v8, s[4:7], s35 offen
  buffer_store_dword v49, v8, s[4:7], s26 offen
  s_barrier
  ds_read_b128 v[28:31], v2 offset:16384
  ds_read_b128 v[32:35], v2 offset:20480
  ds_read_b128 v[36:39], v2 offset:8192
  ds_read_b128 v[40:43], v2 offset:9216
  ds_read_b128 v[44:47], v2 offset:10240
  ds_read_b128 v[48:51], v2 offset:11264
  buffer_load_dwordx4 v[124:127], v2, s[4:7], s24 offen offset:0 sc1
  buffer_load_dwordx4 v[116:119], v2, s[4:7], s25 offen offset:0 sc1
  ds_read_b128 v[52:55], v2 offset:12288
  ds_read_b128 v[56:59], v2 offset:13312
  ds_read_b128 v[60:63], v2 offset:14336
  ds_read_b128 v[64:67], v2 offset:15360
  buffer_load_dwordx4 v[124:127], v2, s[4:7], s24 offen offset:0 sc1
  buffer_load_dwordx4 v[116:119], v2, s[4:7], s25 offen offset:0 sc1
  s_add_u32 s14, s14, 1
  s_cmp_ge_i32 s14, s30
  s_cbranch_scc1 T_kvw_18
T_kvb_19:
  s_mov_b32 s19, 0
  s_branch T_loop_14
T_p1re_24:
  s_mov_b64 exec, vcc
  buffer_load_dwordx4 v[52:55], v2, s[4:7], s22 offen offset:0 sc1
  buffer_load_dwordx4 v[56:59], v2, s[4:7], s22 offen offset:1024 sc1
  buffer_load_dwordx4 v[60:63], v2, s[4:7], s22 offen offset:2048 sc1
  buffer_load_dwordx4 v[64:67], v2, s[4:7], s22 offen offset:3072 sc1
  s_mov_b64 exec, -1
  s_add_u32 s19, s19, 1
  s_cmp_gt_u32 s19, 32768
  s_cbranch_scc1 M_exit
  s_waitcnt vmcnt(3)
  v_mfma_f32_16x16x32_bf16 v[120:123], v[116:119], v[52:55], 0
  v_xor_b32 v48, s57, v52
  v_bitop3_b32 v48, v48, v54, s57 bitop3:0xf6
  s_waitcnt vmcnt(2)
  v_mfma_f32_16x16x32_bf16 v[120:123], v[116:119], v[56:59], v[120:123]
  v_bitop3_b32 v48, v48, v56, s57 bitop3:0xf6
  v_bitop3_b32 v48, v48, v58, s57 bitop3:0xf6
  s_waitcnt vmcnt(1)
  v_mfma_f32_16x16x32_bf16 v[120:123], v[116:119], v[60:63], v[120:123]
  v_bitop3_b32 v48, v48, v60, s57 bitop3:0xf6
  v_bitop3_b32 v48, v48, v62, s57 bitop3:0xf6
  s_waitcnt vmcnt(0)
  v_mfma_f32_16x16x32_bf16 v[120:123], v[116:119], v[64:67], v[120:123]
  v_bitop3_b32 v48, v48, v64, s57 bitop3:0xf6
  v_bitop3_b32 v48, v48, v66, s57 bitop3:0xf6
  v_and_b32 v48, 1, v48
  v_cmp_ne_u32 vcc, 0, v48
  s_cbranch_vccnz T_p1re_24
  s_branch T_p1ok_25
T_kvw_18:
  s_mov_b32 s19, 0
  s_branch T_kvok_27
T_kv_26:
  s_sleep 4
  s_add_u32 s19, s19, 1
  s_cmp_gt_u32 s19, 32768
  s_cbranch_scc1 M_exit
T_kvok_27:
  s_add_u32 s39, s99, 128
  s_mov_b32 s38, 0
  s_mov_b32 s37, 0
  s_atomic_or s38, s[58:59], s99 glc
  s_atomic_or s37, s[58:59], s39 glc
  s_waitcnt lgkmcnt(0)
  s_lshl_b32 s38, s38, 1
  s_lshl1_add_u32 s37, s37, 1
  s_min_u32 s38, s38, s37
  s_cmp_ge_u32 s38, 64
  s_cselect_b32 s38, 100, s38
  s_sub_u32 s38, s38, 1
  s_max_i32 s30, s30, s38
  s_cmp_ge_i32 s14, s30
  s_cbranch_scc1 T_kv_26
  s_branch T_kvb_19
T_slow_21:
  s_nop 7
  v_max3_f32 v100, v16, v17, v18
  v_max3_f32 v100, v100, v19, v20
  v_max3_f32 v100, v100, v21, v22
  v_max3_f32 v100, v100, v23, v112
  v_max3_f32 v100, v100, v113, v114
  v_max_f32 v100, v100, v115
  v_mov_b32 v101, v100
  s_nop 1
  v_permlane32_swap_b32 v100, v101
  s_nop 1
  v_max_f32 v100, v100, v101
  v_mov_b32 v101, v100
  s_nop 1
  v_permlane16_swap_b32 v100, v101
  s_nop 1
  v_max_f32 v100, v100, v101
  v_sub_f32 v16, v16, v100
  v_sub_f32 v17, v17, v100
  v_sub_f32 v18, v18, v100
  v_sub_f32 v19, v19, v100
  v_exp_f32 v16, v16
  v_exp_f32 v17, v17
  v_exp_f32 v18, v18
  v_exp_f32 v19, v19
  v_sub_f32 v20, v20, v100
  v_sub_f32 v21, v21, v100
  v_sub_f32 v22, v22, v100
  v_sub_f32 v23, v23, v100
  v_exp_f32 v20, v20
  v_exp_f32 v21, v21
  v_exp_f32 v22, v22
  v_exp_f32 v23, v23
  v_sub_f32 v112, v112, v100
  v_sub_f32 v113, v113, v100
  v_sub_f32 v114, v114, v100
  v_sub_f32 v115, v115, v100
  v_exp_f32 v112, v112
  v_exp_f32 v113, v113
  v_exp_f32 v114, v114
  v_exp_f32 v115, v115
  s_nop 0
  v_cvt_pk_bf16_f32 v44, v16, v17
  v_cvt_pk_bf16_f32 v45, v18, v19
  v_cvt_pk_bf16_f32 v46, v20, v21
  v_cvt_pk_bf16_f32 v47, v22, v23
  v_cvt_pk_bf16_f32 v84, v112, v113
  v_cvt_pk_bf16_f32 v85, v114, v115
  v_cndmask_b32 v48, v84, 0, s[16:17]
  v_cndmask_b32 v49, v85, 0, s[16:17]
  v_cndmask_b32 v50, 0, v84, s[16:17]
  v_cndmask_b32 v51, 0, v85, s[16:17]
  s_nop 1
  v_mfma_f32_16x16x16_bf16 v[88:91], v[12:13], v[48:49], 0
  v_mfma_f32_16x16x16_bf16 v[24:27], v[120:121], v[48:49], 0
  v_mfma_f32_16x16x16_bf16 v[116:119], v[120:121], v[50:51], 0
  v_mfma_f32_16x16x32_bf16 v[88:91], v[12:15], v[44:47], v[88:91]
  v_mfma_f32_16x16x32_bf16 v[24:27], v[28:31], v[44:47], v[24:27]
  v_mfma_f32_16x16x32_bf16 v[116:119], v[32:35], v[44:47], v[116:119]
  s_nop 7
  s_nop 1
  s_mov_b32 s96, -1
  s_branch T_back_22
T_w_11:
  s_mov_b32 s19, 0
  s_add_u32 s14, s14, 1
  s_and_b32 s57, s14, 1
  v_mov_b64 v[16:17], 0
  v_mov_b64 v[18:19], 0
  v_mov_b64 v[20:21], 0
  v_mov_b64 v[22:23], 0
  v_mov_b64 v[24:25], 0
  v_mov_b64 v[26:27], 0
  buffer_load_dwordx4 v[124:127], v2, s[4:7], s24 offen offset:1024 sc1
  buffer_load_dwordx4 v[116:119], v2, s[4:7], s25 offen offset:1024 sc1
  buffer_load_dwordx4 v[124:127], v2, s[4:7], s24 offen offset:1024 sc1
  buffer_load_dwordx4 v[116:119], v2, s[4:7], s25 offen offset:1024 sc1
  s_branch T_loop_28
.p2align 6
T_retry_29:
  s_mov_b64 exec, vcc
  buffer_load_dwordx4 v[124:127], v2, s[4:7], s24 offen offset:1024 sc1
  buffer_load_dwordx4 v[116:119], v2, s[4:7], s25 offen offset:1024 sc1
  s_mov_b64 exec, -1
  s_add_u32 s19, s19, 1
  s_cmp_gt_u32 s19, 32768
  s_cbranch_scc1 M_exit
  s_nop 0
  v_mov_b64 v[16:17], 0
  v_mov_b64 v[18:19], 0
T_loop_28:
  s_waitcnt vmcnt(3) lgkmcnt(0)
  v_max3_u32 v123, v124, v125, v126
  v_max_u32 v123, v123, v127
  v_mov_b32_dpp v120, v124 row_ror:8 row_mask:0xf bank_mask:0xf
  v_mov_b32_dpp v121, v125 row_ror:8 row_mask:0xf bank_mask:0xf
  s_waitcnt vmcnt(2)
  v_max3_u32 v123, v123, v116, v117
  v_max3_u32 v123, v123, v118, v119
  v_cmp_eq_u32 vcc, -1, v123
  v_smfmac_f32_16x16x64_bf16 v[16:19], v[124:127], v[68:75], v0
  s_cbranch_vccnz T_retry_29
  ds_write_b128 v2, v[124:127] offset:1024
  v_mov_b32_dpp v122, v126 row_ror:8 row_mask:0xf bank_mask:0xf
  v_smfmac_f32_16x16x64_bf16 v[20:23], v[124:127], v[76:83], v0
  s_and_b32 s57, s14, 1
  v_mov_b32_dpp v123, v127 row_ror:8 row_mask:0xf bank_mask:0xf
  v_smfmac_f32_16x16x64_bf16 v[24:27], v[124:127], v[84:91], v0
  s_and_b32 s36, s14, 3
  ds_write_b128 v2, v[116:119] offset:5120
  v_smfmac_f32_16x16x64_bf16 v[16:19], v[120:123], v[92:99], v0
  s_lshl_b32 s36, s36, 13
  v_mov_b32_dpp v84, v116 row_ror:8 row_mask:0xf bank_mask:0xf
  v_smfmac_f32_16x16x64_bf16 v[20:23], v[120:123], v[100:107], v0
  s_add_u32 s26, s36, s23
  ds_read_b128 v[68:71], v4 offset:12288
  v_mov_b32_dpp v85, v117 row_ror:8 row_mask:0xf bank_mask:0xf
  v_smfmac_f32_16x16x64_bf16 v[24:27], v[120:123], v[108:115], v0
  s_add_u32 s36, s36, 8192
  ds_read_b128 v[72:75], v4 offset:13312
  v_mov_b32_dpp v86, v118 row_ror:8 row_mask:0xf bank_mask:0xf
  v_smfmac_f32_16x16x64_bf16 v[16:19], v[116:119], v[224:231], v0
  s_and_b32 s36, s36, 0x7fff
  ds_read_b128 v[76:79], v4 offset:14336
  v_mov_b32_dpp v87, v119 row_ror:8 row_mask:0xf bank_mask:0xf
  v_smfmac_f32_16x16x64_bf16 v[20:23], v[116:119], v[240:247], v0
  s_waitcnt lgkmcnt(3)
  s_barrier
  ds_read_b128 v[100:103], v2 offset:0
  v_smfmac_f32_16x16x64_bf16 v[24:27], v[116:119], a[0:7], v0
  s_mov_b32 m0, s31
  ds_read_b128 v[120:123], v1 offset:0
  v_smfmac_f32_16x16x64_bf16 v[16:19], v[84:87], v[232:239], v0
  buffer_load_dwordx4 v9, s[4:7], s27 offen sc1 lds
  v_smfmac_f32_16x16x64_bf16 v[20:23], v[84:87], v[248:255], v0
  ds_read_b128 v[80:83], v4 offset:15360
  s_mov_b32 m0, s32
  v_smfmac_f32_16x16x64_bf16 v[24:27], v[84:87], a[8:15], v0
  s_waitcnt lgkmcnt(2)
  v_smfmac_f32_16x16x64_bf16 v[16:19], v[100:103], v[128:135], v0
  ds_read_b128 v[92:95], v2 offset:3072
  v_smfmac_f32_16x16x64_bf16 v[20:23], v[100:103], v[144:151], v0
  ds_read_b128 v[96:99], v1 offset:3072
  buffer_load_dwordx4 v9, s[4:7], s27 offen offset:128 sc1 lds
  v_smfmac_f32_16x16x64_bf16 v[24:27], v[100:103], v[68:75], v0
  s_waitcnt vmcnt(2) lgkmcnt(3)
  ds_read_b128 v[116:119], v2 offset:2048
  s_mov_b32 m0, s33
  v_smfmac_f32_16x16x64_bf16 v[16:19], v[120:123], v[136:143], v0
  ds_read_b128 v[124:127], v1 offset:2048
  v_smfmac_f32_16x16x64_bf16 v[20:23], v[120:123], v[152:159], v0
  s_waitcnt lgkmcnt(4)
  ds_read_b128 v[104:107], v2 offset:4096
  v_smfmac_f32_16x16x64_bf16 v[24:27], v[120:123], v[76:83], v0
  s_waitcnt lgkmcnt(4)
  ds_read_b128 v[108:111], v1 offset:4096
  buffer_load_dwordx4 v10, s[4:7], s28 offen sc1 lds
  v_smfmac_f32_16x16x64_bf16 v[16:19], v[92:95], v[160:167], v0
  s_waitcnt lgkmcnt(4)
  ds_read_b128 v[112:115], v2 offset:7168
  s_mov_b32 m0, s34
  v_smfmac_f32_16x16x64_bf16 v[16:19], v[96:99], v[168:175], v0
  s_waitcnt lgkmcnt(4)
  ds_read_b128 v[84:87], v1 offset:7168
  v_smfmac_f32_16x16x64_bf16 v[16:19], v[116:119], v[192:199], v0
  s_waitcnt lgkmcnt(4)
  ds_read_b128 v[88:91], v2 offset:6144
  v_smfmac_f32_16x16x64_bf16 v[16:19], v[124:127], v[200:207], v0
  s_waitcnt lgkmcnt(4)
  ds_read_b128 v[100:103], v1 offset:6144
  buffer_load_dwordx4 v10, s[4:7], s28 offen offset:256 sc1 lds
  v_smfmac_f32_16x16x64_bf16 v[16:19], v[104:107], a[16:23], v0
  s_waitcnt lgkmcnt(4)
  ds_read_b128 v[68:71], v4 offset:16384
  v_smfmac_f32_16x16x64_bf16 v[16:19], v[108:111], a[24:31], v0
  s_waitcnt lgkmcnt(4)
  ds_read_b128 v[72:75], v4 offset:17408
  v_smfmac_f32_16x16x64_bf16 v[16:19], v[112:115], a[64:71], v0
  s_waitcnt lgkmcnt(4)
  ds_read_b128 v[76:79], v4 offset:18432
  v_smfmac_f32_16x16x64_bf16 v[16:19], v[84:87], a[72:79], v0
  s_waitcnt lgkmcnt(4)
  ds_read_b128 v[80:83], v4 offset:19456
  v_smfmac_f32_16x16x64_bf16 v[16:19], v[88:91], a[112:119], v0
  s_waitcnt lgkmcnt(4)
  v_smfmac_f32_16x16x64_bf16 v[16:19], v[100:103], a[120:127], v0
  s_add_u32 s24, s36, 145752064
  s_add_u32 s25, s36, 145756160
  v_smfmac_f32_16x16x64_bf16 v[20:23], v[92:95], v[176:183], v0
  s_add_u32 s35, s36, s23
  v_smfmac_f32_16x16x64_bf16 v[20:23], v[96:99], v[184:191], v0
  s_waitcnt lgkmcnt(2)
  v_smfmac_f32_16x16x64_bf16 v[20:23], v[116:119], v[68:75], v0
  s_waitcnt lgkmcnt(0)
  ds_read_b128 v[68:71], v4 offset:20480
  v_mul_f32 v16, s18, v16
  v_smfmac_f32_16x16x64_bf16 v[20:23], v[124:127], v[76:83], v0
  ds_read_b128 v[72:75], v4 offset:21504
  v_mul_f32 v17, s18, v17
  v_smfmac_f32_16x16x64_bf16 v[20:23], v[104:107], a[32:39], v0
  ds_read_b128 v[76:79], v4 offset:22528
  v_mul_f32 v18, s18, v18
  v_smfmac_f32_16x16x64_bf16 v[20:23], v[108:111], a[40:47], v0
  ds_read_b128 v[80:83], v4 offset:23552
  v_mul_f32 v19, s18, v19
  v_smfmac_f32_16x16x64_bf16 v[20:23], v[112:115], a[80:87], v0
  v_cvt_pk_bf16_f32 v120, v16, v17
  v_smfmac_f32_16x16x64_bf16 v[20:23], v[84:87], a[88:95], v0
  v_cvt_pk_bf16_f32 v121, v18, v19
  v_smfmac_f32_16x16x64_bf16 v[20:23], v[88:91], a[128:135], v0
  ds_write_b64 v5, v[120:121] offset:24576
  v_smfmac_f32_16x16x64_bf16 v[20:23], v[100:103], a[136:143], v0
  s_waitcnt lgkmcnt(3)
  v_smfmac_f32_16x16x64_bf16 v[24:27], v[92:95], v[68:75], v0
  s_waitcnt lgkmcnt(1)
  v_mov_b64 v[92:93], 0
  v_smfmac_f32_16x16x64_bf16 v[24:27], v[96:99], v[76:83], v0
  s_nop 1
  v_cvt_pk_bf16_f32 v122, v20, v21
  v_cvt_pk_bf16_f32 v123, v22, v23
  v_smfmac_f32_16x16x64_bf16 v[24:27], v[116:119], v[208:215], v0
  ds_write_b64 v5, v[122:123] offset:26880
  v_mov_b64 v[94:95], 0
  v_smfmac_f32_16x16x64_bf16 v[24:27], v[124:127], v[216:223], v0
  s_waitcnt lgkmcnt(1)
  s_barrier
  ds_read_b64_tr_b16 v[68:69], v6 offset:24576
  v_smfmac_f32_16x16x64_bf16 v[24:27], v[104:107], a[48:55], v0
  s_add_u32 s27, s27, 8192
  ds_read_b64_tr_b16 v[70:71], v6 offset:24640
  ds_read_b64_tr_b16 v[72:73], v6 offset:24832
  v_smfmac_f32_16x16x64_bf16 v[24:27], v[108:111], a[56:63], v0
  s_add_u32 s28, s28, 8192
  ds_read_b64_tr_b16 v[74:75], v6 offset:24896
  ds_read_b64_tr_b16 v[76:77], v6 offset:25088
  v_smfmac_f32_16x16x64_bf16 v[24:27], v[112:115], a[96:103], v0
  s_nop 0
  ds_read_b64_tr_b16 v[78:79], v6 offset:25152
  ds_read_b64_tr_b16 v[80:81], v6 offset:25344
  v_smfmac_f32_16x16x64_bf16 v[24:27], v[84:87], a[104:111], v0
  ds_read_b64_tr_b16 v[82:83], v6 offset:25408
  v_mov_b64 v[96:97], 0
  v_smfmac_f32_16x16x64_bf16 v[24:27], v[88:91], a[144:151], v0
  s_waitcnt lgkmcnt(8)
  s_barrier
  ds_read_b64_tr_b16 v[116:117], v6 offset:26880
  v_smfmac_f32_16x16x64_bf16 v[24:27], v[100:103], a[152:159], v0
  s_waitcnt lgkmcnt(7)
  ds_read_b64_tr_b16 v[118:119], v6 offset:26944
  v_mfma_f32_16x16x32_bf16 v[16:19], v[36:39], v[68:71], 0
  s_waitcnt lgkmcnt(6)
  ds_read_b64_tr_b16 v[124:125], v6 offset:27136
  ds_read_b64_tr_b16 v[126:127], v6 offset:27200
  v_mfma_f32_16x16x32_bf16 v[16:19], v[40:43], v[72:75], v[16:19]
  s_waitcnt lgkmcnt(6)
  ds_read_b64_tr_b16 v[104:105], v6 offset:27392
  ds_read_b64_tr_b16 v[106:107], v6 offset:27456
  v_mfma_f32_16x16x32_bf16 v[16:19], v[44:47], v[76:79], v[16:19]
  s_waitcnt lgkmcnt(6)
  ds_read_b64_tr_b16 v[108:109], v6 offset:27648
  ds_read_b64_tr_b16 v[110:111], v6 offset:27712
  v_mfma_f32_16x16x32_bf16 v[16:19], v[48:51], v[80:83], v[16:19]
  s_waitcnt lgkmcnt(6)
  v_cvt_pk_bf16_f32 v120, v24, v25
  v_cvt_pk_bf16_f32 v121, v26, v27
  v_mfma_f32_16x16x32_bf16 v[112:115], v[116:119], v[68:71], 0
  s_waitcnt lgkmcnt(4)
  v_mov_b64 v[98:99], 0
  v_mfma_f32_16x16x32_bf16 v[112:115], v[124:127], v[72:75], v[112:115]
  s_waitcnt lgkmcnt(2)
  buffer_store_dwordx4 v[120:123], v2, s[4:7], s29 offen offset:1024 sc1
  v_mov_b64 v[36:37], 0
  v_exp_f32 v100, v16
  v_mfma_f32_16x16x32_bf16 v[112:115], v[104:107], v[76:79], v[112:115]
  s_waitcnt lgkmcnt(0)
  v_exp_f32 v101, v17
  v_mfma_f32_16x16x32_bf16 v[112:115], v[108:111], v[80:83], v[112:115]
  v_exp_f32 v102, v18
  v_mfma_f32_16x16x32_bf16 v[20:23], v[52:55], v[68:71], 0
  v_exp_f32 v103, v19
  v_mfma_f32_16x16x32_bf16 v[20:23], v[56:59], v[72:75], v[20:23]
  v_cvt_pk_bf16_f32 v44, v100, v101
  v_cvt_pk_bf16_f32 v45, v102, v103
  v_mfma_f32_16x16x32_bf16 v[20:23], v[60:63], v[76:79], v[20:23]
  s_add_u32 s29, s29, 131072
  v_exp_f32 v100, v112
  v_mfma_f32_16x16x32_bf16 v[20:23], v[64:67], v[80:83], v[20:23]
  v_exp_f32 v101, v113
  v_exp_f32 v102, v114
  v_exp_f32 v103, v115
  v_cvt_pk_bf16_f32 v84, v100, v101
  v_cvt_pk_bf16_f32 v85, v102, v103
  v_cndmask_b32 v48, v84, 0, s[16:17]
  v_cndmask_b32 v49, v85, 0, s[16:17]
  v_cndmask_b32 v50, 0, v84, s[16:17]
  v_cndmask_b32 v51, 0, v85, s[16:17]
  v_exp_f32 v100, v20
  v_mfma_f32_16x16x16_bf16 v[88:91], v[12:13], v[48:49], 0
  v_exp_f32 v101, v21
  v_mfma_f32_16x16x16_bf16 v[24:27], v[120:121], v[48:49], 0
  v_exp_f32 v102, v22
  v_mfma_f32_16x16x16_bf16 v[116:119], v[120:121], v[50:51], 0
  v_exp_f32 v103, v23
  v_cvt_pk_bf16_f32 v46, v100, v101
  v_cvt_pk_bf16_f32 v47, v102, v103
  v_mov_b64 v[38:39], 0
  s_nop 0
  v_mfma_f32_16x16x32_bf16 v[88:91], v[12:15], v[44:47], v[88:91]
  v_mov_b64 v[40:41], 0
  v_mov_b64 v[42:43], 0
  v_mfma_f32_16x16x32_bf16 v[24:27], v[28:31], v[44:47], v[24:27]
  ds_read_b128 v[52:55], v4 offset:24576
  ds_read_b128 v[56:59], v4 offset:25600
  v_mfma_f32_16x16x32_bf16 v[116:119], v[32:35], v[44:47], v[116:119]
  s_nop 1
T_back_36:
  v_rcp_f32 v89, v88
  v_subrev_u32 v100, s54, v88
  v_cmp_le_u32 vcc, s96, v100
  v_mul_f32 v24, v89, v24
  v_mul_f32 v25, v89, v25
  v_cvt_pk_bf16_f32 v124, v24, v25
  v_pk_mul_f32 v[26:27], v[26:27], v[88:89] op_sel:[0,1] op_sel_hi:[1,1]
  v_pk_mul_f32 v[116:117], v[116:117], v[88:89] op_sel:[0,1] op_sel_hi:[1,1]
  v_pk_mul_f32 v[118:119], v[118:119], v[88:89] op_sel:[0,1] op_sel_hi:[1,1]
  v_cvt_pk_bf16_f32 v125, v26, v27
  v_cvt_pk_bf16_f32 v126, v116, v117
  v_cvt_pk_bf16_f32 v127, v118, v119
  ds_write_b128 v11, v[124:127] offset:29696
  s_cbranch_vccnz T_slow_35
  v_smfmac_f32_16x16x64_bf16 v[92:95], v[124:127], a[160:167], v0
  s_mov_b32 s96, s55
  v_smfmac_f32_16x16x64_bf16 v[96:99], v[124:127], a[168:175], v0
  s_cmp_eq_u32 s14, 63
  v_smfmac_f32_16x16x64_bf16 v[36:39], v[124:127], a[176:183], v0
  s_waitcnt lgkmcnt(0)
  s_barrier
  ds_read_b128 v[104:107], v11 offset:29184
  ds_read_b128 v[108:111], v11 offset:30720
  ds_read_b128 v[68:71], v11 offset:30208
  s_cbranch_scc1 M_tdone
  v_smfmac_f32_16x16x64_bf16 v[40:43], v[124:127], a[184:191], v0
  s_waitcnt lgkmcnt(2)
  v_smfmac_f32_16x16x64_bf16 v[92:95], v[104:107], a[192:199], v0
  s_waitcnt lgkmcnt(1)
  ds_read_b128 v[76:79], v4 offset:28672
  v_smfmac_f32_16x16x64_bf16 v[92:95], v[108:111], a[224:231], v0
  s_waitcnt lgkmcnt(1)
  ds_read_b128 v[80:83], v4 offset:29696
  v_smfmac_f32_16x16x64_bf16 v[92:95], v[68:71], a[240:247], v0
  ds_read_b128 v[60:63], v4 offset:26624
  v_smfmac_f32_16x16x64_bf16 v[96:99], v[104:107], a[200:207], v0
  ds_read_b128 v[64:67], v4 offset:27648
  v_smfmac_f32_16x16x64_bf16 v[96:99], v[108:111], a[232:239], v0
  ds_read_b128 v[28:31], v4 offset:30720
  s_nop 0
  v_cvt_pk_bf16_f32 v16, v92, v93
  v_cvt_pk_bf16_f32 v17, v94, v95
  v_bfi_b32 v16, 1, s57, v16
  v_smfmac_f32_16x16x64_bf16 v[96:99], v[68:71], a[248:255], v0
  buffer_store_dwordx2 v[16:17], v7, s[4:7], s20 offen offset:0
  v_smfmac_f32_16x16x64_bf16 v[36:39], v[104:107], a[208:215], v0
  ds_read_b128 v[32:35], v4 offset:31744
  v_smfmac_f32_16x16x64_bf16 v[36:39], v[108:111], v[52:59], v0
  s_waitcnt lgkmcnt(4)
  s_nop 0
  v_cvt_pk_bf16_f32 v18, v96, v97
  v_cvt_pk_bf16_f32 v19, v98, v99
  v_bfi_b32 v18, 1, s57, v18
  v_smfmac_f32_16x16x64_bf16 v[36:39], v[68:71], v[76:83], v0
  buffer_store_dwordx2 v[18:19], v7, s[4:7], s20 offen offset:64
  v_smfmac_f32_16x16x64_bf16 v[40:43], v[104:107], a[216:223], v0
  s_waitcnt lgkmcnt(2)
  ds_read_b128 v[116:119], v2 offset:31232
  v_smfmac_f32_16x16x64_bf16 v[40:43], v[108:111], v[60:67], v0
  s_waitcnt lgkmcnt(1)
  s_nop 0
  v_cvt_pk_bf16_f32 v20, v36, v37
  v_cvt_pk_bf16_f32 v21, v38, v39
  v_bfi_b32 v20, 1, s57, v20
  v_smfmac_f32_16x16x64_bf16 v[40:43], v[68:71], v[28:35], v0
  buffer_store_dwordx2 v[20:21], v7, s[4:7], s21 offen offset:0
  s_nop 6
  v_cvt_pk_bf16_f32 v22, v40, v41
  v_cvt_pk_bf16_f32 v23, v42, v43
  v_bfi_b32 v22, 1, s57, v22
  buffer_store_dwordx2 v[22:23], v7, s[4:7], s21 offen offset:64
  ds_read_b128 v[68:71], v4 offset:0
  ds_read_b128 v[72:75], v4 offset:1024
  ds_read_b128 v[76:79], v4 offset:4096
  ds_read_b128 v[80:83], v4 offset:5120
  ds_read_b128 v[84:87], v4 offset:8192
  ds_read_b128 v[88:91], v4 offset:9216
  ds_read_b128 v[92:95], v4 offset:2048
  ds_read_b128 v[96:99], v4 offset:3072
  ds_read_b128 v[100:103], v4 offset:6144
  ds_read_b128 v[104:107], v4 offset:7168
  ds_read_b128 v[108:111], v4 offset:10240
  ds_read_b128 v[112:115], v4 offset:11264
  v_mov_b64 v[16:17], 0
  v_mov_b64 v[18:19], 0
  v_mov_b64 v[20:21], 0
  v_mov_b64 v[22:23], 0
  v_mov_b64 v[24:25], 0
  v_mov_b64 v[26:27], 0
  s_mov_b32 s19, 0
  v_mov_b32 v49, -1
  ds_read_b64 v[44:45], v2 offset:32256
  s_waitcnt lgkmcnt(0)
  v_readfirstlane_b32 s38, v44
  v_readfirstlane_b32 s37, v45
  s_nop 0
  s_lshl_b32 s38, s38, 1
  s_lshl1_add_u32 s37, s37, 1
  s_min_u32 s38, s38, s37
  s_cmp_ge_u32 s38, 64
  s_cselect_b32 s38, 100, s38
  s_sub_u32 s38, s38, 1
  s_max_i32 s30, s30, s38
  s_waitcnt vmcnt(0)
  buffer_load_dwordx4 v[52:55], v2, s[4:7], s22 offen offset:0 sc1
  buffer_load_dwordx4 v[56:59], v2, s[4:7], s22 offen offset:1024 sc1
  buffer_load_dwordx4 v[60:63], v2, s[4:7], s22 offen offset:2048 sc1
  buffer_load_dwordx4 v[64:67], v2, s[4:7], s22 offen offset:3072 sc1
  s_waitcnt lgkmcnt(12)
  s_waitcnt vmcnt(3)
  v_mfma_f32_16x16x32_bf16 v[120:123], v[116:119], v[52:55], 0
  v_xor_b32 v48, s57, v52
  v_bitop3_b32 v48, v48, v54, s57 bitop3:0xf6
  s_waitcnt vmcnt(2)
  v_mfma_f32_16x16x32_bf16 v[120:123], v[116:119], v[56:59], v[120:123]
  v_bitop3_b32 v48, v48, v56, s57 bitop3:0xf6
  v_bitop3_b32 v48, v48, v58, s57 bitop3:0xf6
  s_waitcnt vmcnt(1)
  v_mfma_f32_16x16x32_bf16 v[120:123], v[116:119], v[60:63], v[120:123]
  v_bitop3_b32 v48, v48, v60, s57 bitop3:0xf6
  v_bitop3_b32 v48, v48, v62, s57 bitop3:0xf6
  s_waitcnt vmcnt(0)
  v_mfma_f32_16x16x32_bf16 v[120:123], v[116:119], v[64:67], v[120:123]
  v_bitop3_b32 v48, v48, v64, s57 bitop3:0xf6
  v_bitop3_b32 v48, v48, v66, s57 bitop3:0xf6
  v_and_b32 v48, 1, v48
  v_cmp_ne_u32 vcc, 0, v48
  s_cbranch_vccnz T_p1re_38
T_p1ok_39:
  s_nop 2
  v_add_f32_dpp v120, v120, v120 row_ror:8 row_mask:0xf bank_mask:0xf
  v_add_f32_dpp v121, v121, v121 row_ror:8 row_mask:0xf bank_mask:0xf
  v_cvt_pk_bf16_f32 v48, v120, v121
  buffer_store_dword v48, v8, s[4:7], s35 offen
  buffer_store_dword v49, v8, s[4:7], s26 offen
  s_barrier
  ds_read_b128 v[28:31], v2 offset:17408
  ds_read_b128 v[32:35], v2 offset:21504
  ds_read_b128 v[36:39], v2 offset:8192
  ds_read_b128 v[40:43], v2 offset:9216
  ds_read_b128 v[44:47], v2 offset:10240
  ds_read_b128 v[48:51], v2 offset:11264
  buffer_load_dwordx4 v[124:127], v2, s[4:7], s24 offen offset:1024 sc1
  buffer_load_dwordx4 v[116:119], v2, s[4:7], s25 offen offset:1024 sc1
  ds_read_b128 v[52:55], v2 offset:12288
  ds_read_b128 v[56:59], v2 offset:13312
  ds_read_b128 v[60:63], v2 offset:14336
  ds_read_b128 v[64:67], v2 offset:15360
  buffer_load_dwordx4 v[124:127], v2, s[4:7], s24 offen offset:1024 sc1
  buffer_load_dwordx4 v[116:119], v2, s[4:7], s25 offen offset:1024 sc1
  s_add_u32 s14, s14, 1
  s_cmp_ge_i32 s14, s30
  s_cbranch_scc1 T_kvw_32
T_kvb_33:
  s_mov_b32 s19, 0
  s_branch T_loop_28
T_p1re_38:
  s_mov_b64 exec, vcc
  buffer_load_dwordx4 v[52:55], v2, s[4:7], s22 offen offset:0 sc1
  buffer_load_dwordx4 v[56:59], v2, s[4:7], s22 offen offset:1024 sc1
  buffer_load_dwordx4 v[60:63], v2, s[4:7], s22 offen offset:2048 sc1
  buffer_load_dwordx4 v[64:67], v2, s[4:7], s22 offen offset:3072 sc1
  s_mov_b64 exec, -1
  s_add_u32 s19, s19, 1
  s_cmp_gt_u32 s19, 32768
  s_cbranch_scc1 M_exit
  s_waitcnt vmcnt(3)
  v_mfma_f32_16x16x32_bf16 v[120:123], v[116:119], v[52:55], 0
  v_xor_b32 v48, s57, v52
  v_bitop3_b32 v48, v48, v54, s57 bitop3:0xf6
  s_waitcnt vmcnt(2)
  v_mfma_f32_16x16x32_bf16 v[120:123], v[116:119], v[56:59], v[120:123]
  v_bitop3_b32 v48, v48, v56, s57 bitop3:0xf6
  v_bitop3_b32 v48, v48, v58, s57 bitop3:0xf6
  s_waitcnt vmcnt(1)
  v_mfma_f32_16x16x32_bf16 v[120:123], v[116:119], v[60:63], v[120:123]
  v_bitop3_b32 v48, v48, v60, s57 bitop3:0xf6
  v_bitop3_b32 v48, v48, v62, s57 bitop3:0xf6
  s_waitcnt vmcnt(0)
  v_mfma_f32_16x16x32_bf16 v[120:123], v[116:119], v[64:67], v[120:123]
  v_bitop3_b32 v48, v48, v64, s57 bitop3:0xf6
  v_bitop3_b32 v48, v48, v66, s57 bitop3:0xf6
  v_and_b32 v48, 1, v48
  v_cmp_ne_u32 vcc, 0, v48
  s_cbranch_vccnz T_p1re_38
  s_branch T_p1ok_39
T_kvw_32:
  s_mov_b32 s19, 0
  s_branch T_kvok_41
T_kv_40:
  s_sleep 4
  s_add_u32 s19, s19, 1
  s_cmp_gt_u32 s19, 32768
  s_cbranch_scc1 M_exit
T_kvok_41:
  s_add_u32 s39, s99, 128
  s_mov_b32 s38, 0
  s_mov_b32 s37, 0
  s_atomic_or s38, s[58:59], s99 glc
  s_atomic_or s37, s[58:59], s39 glc
  s_waitcnt lgkmcnt(0)
  s_lshl_b32 s38, s38, 1
  s_lshl1_add_u32 s37, s37, 1
  s_min_u32 s38, s38, s37
  s_cmp_ge_u32 s38, 64
  s_cselect_b32 s38, 100, s38
  s_sub_u32 s38, s38, 1
  s_max_i32 s30, s30, s38
  s_cmp_ge_i32 s14, s30
  s_cbranch_scc1 T_kv_40
  s_branch T_kvb_33
T_slow_35:
  s_nop 7
  v_max3_f32 v100, v16, v17, v18
  v_max3_f32 v100, v100, v19, v20
  v_max3_f32 v100, v100, v21, v22
  v_max3_f32 v100, v100, v23, v112
  v_max3_f32 v100, v100, v113, v114
  v_max_f32 v100, v100, v115
  v_mov_b32 v101, v100
  s_nop 1
  v_permlane32_swap_b32 v100, v101
  s_nop 1
  v_max_f32 v100, v100, v101
  v_mov_b32 v101, v100
  s_nop 1
  v_permlane16_swap_b32 v100, v101
  s_nop 1
  v_max_f32 v100, v100, v101
  v_sub_f32 v16, v16, v100
  v_sub_f32 v17, v17, v100
  v_sub_f32 v18, v18, v100
  v_sub_f32 v19, v19, v100
  v_exp_f32 v16, v16
  v_exp_f32 v17, v17
  v_exp_f32 v18, v18
  v_exp_f32 v19, v19
  v_sub_f32 v20, v20, v100
  v_sub_f32 v21, v21, v100
  v_sub_f32 v22, v22, v100
  v_sub_f32 v23, v23, v100
  v_exp_f32 v20, v20
  v_exp_f32 v21, v21
  v_exp_f32 v22, v22
  v_exp_f32 v23, v23
  v_sub_f32 v112, v112, v100
  v_sub_f32 v113, v113, v100
  v_sub_f32 v114, v114, v100
  v_sub_f32 v115, v115, v100
  v_exp_f32 v112, v112
  v_exp_f32 v113, v113
  v_exp_f32 v114, v114
  v_exp_f32 v115, v115
  s_nop 0
  v_cvt_pk_bf16_f32 v44, v16, v17
  v_cvt_pk_bf16_f32 v45, v18, v19
  v_cvt_pk_bf16_f32 v46, v20, v21
  v_cvt_pk_bf16_f32 v47, v22, v23
  v_cvt_pk_bf16_f32 v84, v112, v113
  v_cvt_pk_bf16_f32 v85, v114, v115
  v_cndmask_b32 v48, v84, 0, s[16:17]
  v_cndmask_b32 v49, v85, 0, s[16:17]
  v_cndmask_b32 v50, 0, v84, s[16:17]
  v_cndmask_b32 v51, 0, v85, s[16:17]
  s_nop 1
  v_mfma_f32_16x16x16_bf16 v[88:91], v[12:13], v[48:49], 0
  v_mfma_f32_16x16x16_bf16 v[24:27], v[120:121], v[48:49], 0
  v_mfma_f32_16x16x16_bf16 v[116:119], v[120:121], v[50:51], 0
  v_mfma_f32_16x16x32_bf16 v[88:91], v[12:15], v[44:47], v[88:91]
  v_mfma_f32_16x16x32_bf16 v[24:27], v[28:31], v[44:47], v[24:27]
  v_mfma_f32_16x16x32_bf16 v[116:119], v[32:35], v[44:47], v[116:119]
  s_nop 7
  s_nop 1
  s_mov_b32 s96, -1
  s_branch T_back_36
T_w_12:
  s_mov_b32 s19, 0
  s_add_u32 s14, s14, 1
  s_and_b32 s57, s14, 1
  v_mov_b64 v[16:17], 0
  v_mov_b64 v[18:19], 0
  v_mov_b64 v[20:21], 0
  v_mov_b64 v[22:23], 0
  v_mov_b64 v[24:25], 0
  v_mov_b64 v[26:27], 0
  buffer_load_dwordx4 v[124:127], v2, s[4:7], s24 offen offset:2048 sc1
  buffer_load_dwordx4 v[116:119], v2, s[4:7], s25 offen offset:2048 sc1
  buffer_load_dwordx4 v[124:127], v2, s[4:7], s24 offen offset:2048 sc1
  buffer_load_dwordx4 v[116:119], v2, s[4:7], s25 offen offset:2048 sc1
  s_branch T_loop_42
.p2align 6
T_retry_43:
  s_mov_b64 exec, vcc
  buffer_load_dwordx4 v[124:127], v2, s[4:7], s24 offen offset:2048 sc1
  buffer_load_dwordx4 v[116:119], v2, s[4:7], s25 offen offset:2048 sc1
  s_mov_b64 exec, -1
  s_add_u32 s19, s19, 1
  s_cmp_gt_u32 s19, 32768
  s_cbranch_scc1 M_exit
  s_nop 0
  v_mov_b64 v[16:17], 0
  v_mov_b64 v[18:19], 0
T_loop_42:
  s_waitcnt vmcnt(3) lgkmcnt(0)
  v_max3_u32 v123, v124, v125, v126
  v_max_u32 v123, v123, v127
  v_mov_b32_dpp v120, v124 row_ror:8 row_mask:0xf bank_mask:0xf
  v_mov_b32_dpp v121, v125 row_ror:8 row_mask:0xf bank_mask:0xf
  s_waitcnt vmcnt(2)
  v_max3_u32 v123, v123, v116, v117
  v_max3_u32 v123, v123, v118, v119
  v_cmp_eq_u32 vcc, -1, v123
  v_smfmac_f32_16x16x64_bf16 v[16:19], v[124:127], v[68:75], v0
  s_cbranch_vccnz T_retry_43
  ds_write_b128 v2, v[124:127] offset:2048
  v_mov_b32_dpp v122, v126 row_ror:8 row_mask:0xf bank_mask:0xf
  v_smfmac_f32_16x16x64_bf16 v[20:23], v[124:127], v[76:83], v0
  s_and_b32 s57, s14, 1
  v_mov_b32_dpp v123, v127 row_ror:8 row_mask:0xf bank_mask:0xf
  v_smfmac_f32_16x16x64_bf16 v[24:27], v[124:127], v[84:91], v0
  s_and_b32 s36, s14, 3
  ds_write_b128 v2, v[116:119] offset:6144
  v_smfmac_f32_16x16x64_bf16 v[16:19], v[120:123], v[92:99], v0
  s_lshl_b32 s36, s36, 13
  v_mov_b32_dpp v84, v116 row_ror:8 row_mask:0xf bank_mask:0xf
  v_smfmac_f32_16x16x64_bf16 v[20:23], v[120:123], v[100:107], v0
  s_add_u32 s26, s36, s23
  ds_read_b128 v[68:71], v4 offset:12288
  v_mov_b32_dpp v85, v117 row_ror:8 row_mask:0xf bank_mask:0xf
  v_smfmac_f32_16x16x64_bf16 v[24:27], v[120:123], v[108:115], v0
  s_add_u32 s36, s36, 8192
  ds_read_b128 v[72:75], v4 offset:13312
  v_mov_b32_dpp v86, v118 row_ror:8 row_mask:0xf bank_mask:0xf
  v_smfmac_f32_16x16x64_bf16 v[16:19], v[116:119], v[224:231], v0
  s_and_b32 s36, s36, 0x7fff
  ds_read_b128 v[76:79], v4 offset:14336
  v_mov_b32_dpp v87, v119 row_ror:8 row_mask:0xf bank_mask:0xf
  v_smfmac_f32_16x16x64_bf16 v[20:23], v[116:119], v[240:247], v0
  s_waitcnt lgkmcnt(3)
  s_barrier
  ds_read_b128 v[100:103], v2 offset:3072
  v_smfmac_f32_16x16x64_bf16 v[24:27], v[116:119], a[0:7], v0
  s_mov_b32 m0, s31
  ds_read_b128 v[120:123], v1 offset:3072
  v_smfmac_f32_16x16x64_bf16 v[16:19], v[84:87], v[232:239], v0
  v_smfmac_f32_16x16x64_bf16 v[20:23], v[84:87], v[248:255], v0
  ds_read_b128 v[80:83], v4 offset:15360
  buffer_load_dwordx4 v9, s[4:7], s27 offen sc1 lds
  v_smfmac_f32_16x16x64_bf16 v[24:27], v[84:87], a[8:15], v0
  s_waitcnt lgkmcnt(2)
  s_mov_b32 m0, s32
  v_smfmac_f32_16x16x64_bf16 v[16:19], v[100:103], v[128:135], v0
  ds_read_b128 v[92:95], v2 offset:0
  v_smfmac_f32_16x16x64_bf16 v[20:23], v[100:103], v[144:151], v0
  ds_read_b128 v[96:99], v1 offset:0
  v_smfmac_f32_16x16x64_bf16 v[24:27], v[100:103], v[68:75], v0
  s_waitcnt vmcnt(1) lgkmcnt(3)
  ds_read_b128 v[116:119], v2 offset:1024
  buffer_load_dwordx4 v9, s[4:7], s27 offen offset:128 sc1 lds
  v_smfmac_f32_16x16x64_bf16 v[16:19], v[120:123], v[136:143], v0
  ds_read_b128 v[124:127], v1 offset:1024
  s_mov_b32 m0, s33
  v_smfmac_f32_16x16x64_bf16 v[20:23], v[120:123], v[152:159], v0
  s_waitcnt lgkmcnt(4)
  ds_read_b128 v[104:107], v2 offset:7168
  v_smfmac_f32_16x16x64_bf16 v[24:27], v[120:123], v[76:83], v0
  s_waitcnt lgkmcnt(4)
  ds_read_b128 v[108:111], v1 offset:7168
  v_smfmac_f32_16x16x64_bf16 v[16:19], v[92:95], v[160:167], v0
  s_waitcnt lgkmcnt(4)
  ds_read_b128 v[112:115], v2 offset:4096
  v_mov_b32 v122, s98
  buffer_load_dwordx4 v10, s[4:7], s28 offen sc1 lds
  v_smfmac_f32_16x16x64_bf16 v[16:19], v[96:99], v[168:175], v0
  s_waitcnt lgkmcnt(4)
  ds_read_b128 v[84:87], v1 offset:4096
  s_mov_b32 m0, s34
  v_smfmac_f32_16x16x64_bf16 v[16:19], v[116:119], v[192:199], v0
  s_waitcnt lgkmcnt(4)
  ds_read_b128 v[88:91], v2 offset:5120
  v_smfmac_f32_16x16x64_bf16 v[16:19], v[124:127], v[200:207], v0
  s_waitcnt lgkmcnt(4)
  ds_read_b128 v[100:103], v1 offset:5120
  v_smfmac_f32_16x16x64_bf16 v[16:19], v[104:107], a[16:23], v0
  s_waitcnt lgkmcnt(4)
  ds_read_b128 v[68:71], v4 offset:16384
  buffer_load_dwordx4 v10, s[4:7], s28 offen offset:256 sc1 lds
  v_smfmac_f32_16x16x64_bf16 v[16:19], v[108:111], a[24:31], v0
  s_waitcnt lgkmcnt(4)
  ds_read_b128 v[72:75], v4 offset:17408
  v_smfmac_f32_16x16x64_bf16 v[16:19], v[112:115], a[64:71], v0
  s_waitcnt lgkmcnt(4)
  ds_read_b128 v[76:79], v4 offset:18432
  v_smfmac_f32_16x16x64_bf16 v[16:19], v[84:87], a[72:79], v0
  s_waitcnt lgkmcnt(4)
  ds_read_b128 v[80:83], v4 offset:19456
  v_smfmac_f32_16x16x64_bf16 v[16:19], v[88:91], a[112:119], v0
  s_waitcnt lgkmcnt(4)
  buffer_store_dword v122, v3, s[4:7], s15 offen sc1
  v_smfmac_f32_16x16x64_bf16 v[16:19], v[100:103], a[120:127], v0
  s_add_u32 s98, s14, 1
  s_add_u32 s24, s36, 145752064
  s_add_u32 s25, s36, 145756160
  v_smfmac_f32_16x16x64_bf16 v[20:23], v[92:95], v[176:183], v0
  s_add_u32 s35, s36, s23
  v_smfmac_f32_16x16x64_bf16 v[20:23], v[96:99], v[184:191], v0
  s_waitcnt lgkmcnt(2)
  v_smfmac_f32_16x16x64_bf16 v[20:23], v[116:119], v[68:75], v0
  s_waitcnt lgkmcnt(0)
  ds_read_b128 v[68:71], v4 offset:20480
  v_mul_f32 v16, s18, v16
  v_smfmac_f32_16x16x64_bf16 v[20:23], v[124:127], v[76:83], v0
  ds_read_b128 v[72:75], v4 offset:21504
  v_mul_f32 v17, s18, v17
  v_smfmac_f32_16x16x64_bf16 v[20:23], v[104:107], a[32:39], v0
  ds_read_b128 v[76:79], v4 offset:22528
  v_mul_f32 v18, s18, v18
  v_smfmac_f32_16x16x64_bf16 v[20:23], v[108:111], a[40:47], v0
  ds_read_b128 v[80:83], v4 offset:23552
  v_mul_f32 v19, s18, v19
  v_smfmac_f32_16x16x64_bf16 v[20:23], v[112:115], a[80:87], v0
  v_cvt_pk_bf16_f32 v120, v16, v17
  v_smfmac_f32_16x16x64_bf16 v[20:23], v[84:87], a[88:95], v0
  v_cvt_pk_bf16_f32 v121, v18, v19
  v_smfmac_f32_16x16x64_bf16 v[20:23], v[88:91], a[128:135], v0
  ds_write_b64 v5, v[120:121] offset:24576
  v_smfmac_f32_16x16x64_bf16 v[20:23], v[100:103], a[136:143], v0
  s_waitcnt lgkmcnt(3)
  v_smfmac_f32_16x16x64_bf16 v[24:27], v[92:95], v[68:75], v0
  s_waitcnt lgkmcnt(1)
  v_mov_b64 v[92:93], 0
  v_smfmac_f32_16x16x64_bf16 v[24:27], v[96:99], v[76:83], v0
  s_nop 1
  v_cvt_pk_bf16_f32 v122, v20, v21
  v_cvt_pk_bf16_f32 v123, v22, v23
  v_smfmac_f32_16x16x64_bf16 v[24:27], v[116:119], v[208:215], v0
  ds_write_b64 v5, v[122:123] offset:26880
  v_mov_b64 v[94:95], 0
  v_smfmac_f32_16x16x64_bf16 v[24:27], v[124:127], v[216:223], v0
  s_waitcnt lgkmcnt(1)
  s_barrier
  ds_read_b64_tr_b16 v[68:69], v6 offset:24576
  v_smfmac_f32_16x16x64_bf16 v[24:27], v[104:107], a[48:55], v0
  s_add_u32 s27, s27, 8192
  ds_read_b64_tr_b16 v[70:71], v6 offset:24640
  ds_read_b64_tr_b16 v[72:73], v6 offset:24832
  v_smfmac_f32_16x16x64_bf16 v[24:27], v[108:111], a[56:63], v0
  s_add_u32 s28, s28, 8192
  ds_read_b64_tr_b16 v[74:75], v6 offset:24896
  ds_read_b64_tr_b16 v[76:77], v6 offset:25088
  v_smfmac_f32_16x16x64_bf16 v[24:27], v[112:115], a[96:103], v0
  s_nop 0
  ds_read_b64_tr_b16 v[78:79], v6 offset:25152
  ds_read_b64_tr_b16 v[80:81], v6 offset:25344
  v_smfmac_f32_16x16x64_bf16 v[24:27], v[84:87], a[104:111], v0
  ds_read_b64_tr_b16 v[82:83], v6 offset:25408
  v_mov_b64 v[96:97], 0
  v_smfmac_f32_16x16x64_bf16 v[24:27], v[88:91], a[144:151], v0
  s_waitcnt lgkmcnt(8)
  s_barrier
  ds_read_b64_tr_b16 v[116:117], v6 offset:26880
  v_smfmac_f32_16x16x64_bf16 v[24:27], v[100:103], a[152:159], v0
  s_waitcnt lgkmcnt(7)
  ds_read_b64_tr_b16 v[118:119], v6 offset:26944
  v_mfma_f32_16x16x32_bf16 v[16:19], v[36:39], v[68:71], 0
  s_waitcnt lgkmcnt(6)
  ds_read_b64_tr_b16 v[124:125], v6 offset:27136
  ds_read_b64_tr_b16 v[126:127], v6 offset:27200
  v_mfma_f32_16x16x32_bf16 v[16:19], v[40:43], v[72:75], v[16:19]
  s_waitcnt lgkmcnt(6)
  ds_read_b64_tr_b16 v[104:105], v6 offset:27392
  ds_read_b64_tr_b16 v[106:107], v6 offset:27456
  v_mfma_f32_16x16x32_bf16 v[16:19], v[44:47], v[76:79], v[16:19]
  s_waitcnt lgkmcnt(6)
  ds_read_b64_tr_b16 v[108:109], v6 offset:27648
  ds_read_b64_tr_b16 v[110:111], v6 offset:27712
  v_mfma_f32_16x16x32_bf16 v[16:19], v[48:51], v[80:83], v[16:19]
  s_waitcnt lgkmcnt(6)
  v_cvt_pk_bf16_f32 v120, v24, v25
  v_cvt_pk_bf16_f32 v121, v26, v27
  v_mfma_f32_16x16x32_bf16 v[112:115], v[116:119], v[68:71], 0
  s_waitcnt lgkmcnt(4)
  v_mov_b64 v[98:99], 0
  v_mfma_f32_16x16x32_bf16 v[112:115], v[124:127], v[72:75], v[112:115]
  s_waitcnt lgkmcnt(2)
  v_mov_b64 v[36:37], 0
  v_exp_f32 v100, v16
  v_mfma_f32_16x16x32_bf16 v[112:115], v[104:107], v[76:79], v[112:115]
  s_waitcnt lgkmcnt(0)
  buffer_store_dwordx4 v[120:123], v2, s[4:7], s29 offen offset:2048 sc1
  v_exp_f32 v101, v17
  v_mfma_f32_16x16x32_bf16 v[112:115], v[108:111], v[80:83], v[112:115]
  v_exp_f32 v102, v18
  v_mfma_f32_16x16x32_bf16 v[20:23], v[52:55], v[68:71], 0
  v_exp_f32 v103, v19
  v_mfma_f32_16x16x32_bf16 v[20:23], v[56:59], v[72:75], v[20:23]
  v_cvt_pk_bf16_f32 v44, v100, v101
  v_cvt_pk_bf16_f32 v45, v102, v103
  v_mfma_f32_16x16x32_bf16 v[20:23], v[60:63], v[76:79], v[20:23]
  s_add_u32 s29, s29, 131072
  v_exp_f32 v100, v112
  v_mfma_f32_16x16x32_bf16 v[20:23], v[64:67], v[80:83], v[20:23]
  v_exp_f32 v101, v113
  v_exp_f32 v102, v114
  v_exp_f32 v103, v115
  v_cvt_pk_bf16_f32 v84, v100, v101
  v_cvt_pk_bf16_f32 v85, v102, v103
  v_cndmask_b32 v48, v84, 0, s[16:17]
  v_cndmask_b32 v49, v85, 0, s[16:17]
  v_cndmask_b32 v50, 0, v84, s[16:17]
  v_cndmask_b32 v51, 0, v85, s[16:17]
  v_exp_f32 v100, v20
  v_mfma_f32_16x16x16_bf16 v[88:91], v[12:13], v[48:49], 0
  v_exp_f32 v101, v21
  v_mfma_f32_16x16x16_bf16 v[24:27], v[120:121], v[48:49], 0
  v_exp_f32 v102, v22
  v_mfma_f32_16x16x16_bf16 v[116:119], v[120:121], v[50:51], 0
  v_exp_f32 v103, v23
  v_cvt_pk_bf16_f32 v46, v100, v101
  v_cvt_pk_bf16_f32 v47, v102, v103
  v_mov_b64 v[38:39], 0
  s_nop 0
  v_mfma_f32_16x16x32_bf16 v[88:91], v[12:15], v[44:47], v[88:91]
  v_mov_b64 v[40:41], 0
  v_mov_b64 v[42:43], 0
  v_mfma_f32_16x16x32_bf16 v[24:27], v[28:31], v[44:47], v[24:27]
  ds_read_b128 v[52:55], v4 offset:24576
  ds_read_b128 v[56:59], v4 offset:25600
  v_mfma_f32_16x16x32_bf16 v[116:119], v[32:35], v[44:47], v[116:119]
  s_nop 1
T_back_50:
  v_rcp_f32 v89, v88
  v_subrev_u32 v100, s54, v88
  v_cmp_le_u32 vcc, s96, v100
  v_mul_f32 v24, v89, v24
  v_mul_f32 v25, v89, v25
  v_cvt_pk_bf16_f32 v124, v24, v25
  v_pk_mul_f32 v[26:27], v[26:27], v[88:89] op_sel:[0,1] op_sel_hi:[1,1]
  v_pk_mul_f32 v[116:117], v[116:117], v[88:89] op_sel:[0,1] op_sel_hi:[1,1]
  v_pk_mul_f32 v[118:119], v[118:119], v[88:89] op_sel:[0,1] op_sel_hi:[1,1]
  v_cvt_pk_bf16_f32 v125, v26, v27
  v_cvt_pk_bf16_f32 v126, v116, v117
  v_cvt_pk_bf16_f32 v127, v118, v119
  ds_write_b128 v11, v[124:127] offset:30208
  s_cbranch_vccnz T_slow_49
  v_smfmac_f32_16x16x64_bf16 v[92:95], v[124:127], a[160:167], v0
  s_mov_b32 s96, s55
  v_smfmac_f32_16x16x64_bf16 v[96:99], v[124:127], a[168:175], v0
  s_cmp_eq_u32 s14, 63
  v_smfmac_f32_16x16x64_bf16 v[36:39], v[124:127], a[176:183], v0
  s_waitcnt lgkmcnt(0)
  s_barrier
  ds_read_b128 v[104:107], v11 offset:30720
  ds_read_b128 v[108:111], v11 offset:29184
  ds_read_b128 v[68:71], v11 offset:29696
  s_cbranch_scc1 M_tdone
  v_smfmac_f32_16x16x64_bf16 v[40:43], v[124:127], a[184:191], v0
  s_waitcnt lgkmcnt(2)
  v_smfmac_f32_16x16x64_bf16 v[92:95], v[104:107], a[192:199], v0
  s_waitcnt lgkmcnt(1)
  ds_read_b128 v[76:79], v4 offset:28672
  v_smfmac_f32_16x16x64_bf16 v[92:95], v[108:111], a[224:231], v0
  s_waitcnt lgkmcnt(1)
  ds_read_b128 v[80:83], v4 offset:29696
  v_smfmac_f32_16x16x64_bf16 v[92:95], v[68:71], a[240:247], v0
  ds_read_b128 v[60:63], v4 offset:26624
  v_smfmac_f32_16x16x64_bf16 v[96:99], v[104:107], a[200:207], v0
  ds_read_b128 v[64:67], v4 offset:27648
  v_smfmac_f32_16x16x64_bf16 v[96:99], v[108:111], a[232:239], v0
  ds_read_b128 v[28:31], v4 offset:30720
  s_nop 0
  v_cvt_pk_bf16_f32 v16, v92, v93
  v_cvt_pk_bf16_f32 v17, v94, v95
  v_bfi_b32 v16, 1, s57, v16
  v_smfmac_f32_16x16x64_bf16 v[96:99], v[68:71], a[248:255], v0
  buffer_store_dwordx2 v[16:17], v7, s[4:7], s20 offen offset:0
  v_smfmac_f32_16x16x64_bf16 v[36:39], v[104:107], a[208:215], v0
  ds_read_b128 v[32:35], v4 offset:31744
  v_smfmac_f32_16x16x64_bf16 v[36:39], v[108:111], v[52:59], v0
  s_waitcnt lgkmcnt(4)
  s_nop 0
  v_cvt_pk_bf16_f32 v18, v96, v97
  v_cvt_pk_bf16_f32 v19, v98, v99
  v_bfi_b32 v18, 1, s57, v18
  v_smfmac_f32_16x16x64_bf16 v[36:39], v[68:71], v[76:83], v0
  buffer_store_dwordx2 v[18:19], v7, s[4:7], s20 offen offset:64
  v_smfmac_f32_16x16x64_bf16 v[40:43], v[104:107], a[216:223], v0
  s_waitcnt lgkmcnt(2)
  v_smfmac_f32_16x16x64_bf16 v[40:43], v[108:111], v[60:67], v0
  s_waitcnt lgkmcnt(0)
  s_nop 0
  v_cvt_pk_bf16_f32 v20, v36, v37
  v_cvt_pk_bf16_f32 v21, v38, v39
  v_bfi_b32 v20, 1, s57, v20
  v_smfmac_f32_16x16x64_bf16 v[40:43], v[68:71], v[28:35], v0
  buffer_store_dwordx2 v[20:21], v7, s[4:7], s21 offen offset:0
  s_nop 6
  v_cvt_pk_bf16_f32 v22, v40, v41
  v_cvt_pk_bf16_f32 v23, v42, v43
  v_bfi_b32 v22, 1, s57, v22
  buffer_store_dwordx2 v[22:23], v7, s[4:7], s21 offen offset:64
  ds_read_b128 v[68:71], v4 offset:0
  ds_read_b128 v[72:75], v4 offset:1024
  ds_read_b128 v[76:79], v4 offset:4096
  ds_read_b128 v[80:83], v4 offset:5120
  ds_read_b128 v[84:87], v4 offset:8192
  ds_read_b128 v[88:91], v4 offset:9216
  ds_read_b128 v[92:95], v4 offset:2048
  ds_read_b128 v[96:99], v4 offset:3072
  ds_read_b128 v[100:103], v4 offset:6144
  ds_read_b128 v[104:107], v4 offset:7168
  ds_read_b128 v[108:111], v4 offset:10240
  ds_read_b128 v[112:115], v4 offset:11264
  v_mov_b64 v[16:17], 0
  v_mov_b64 v[18:19], 0
  v_mov_b64 v[20:21], 0
  v_mov_b64 v[22:23], 0
  v_mov_b64 v[24:25], 0
  v_mov_b64 v[26:27], 0
  ds_read_b64 v[44:45], v2 offset:32256
  s_waitcnt lgkmcnt(0)
  v_readfirstlane_b32 s38, v44
  v_readfirstlane_b32 s37, v45
  s_nop 0
  s_lshl_b32 s38, s38, 1
  s_lshl1_add_u32 s37, s37, 1
  s_min_u32 s38, s38, s37
  s_cmp_ge_u32 s38, 64
  s_cselect_b32 s38, 100, s38
  s_sub_u32 s38, s38, 1
  s_max_i32 s30, s30, s38
  s_waitcnt vmcnt(4)
  s_barrier
  ds_read_b128 v[28:31], v2 offset:18432
  ds_read_b128 v[32:35], v2 offset:22528
  ds_read_b128 v[36:39], v2 offset:8192
  ds_read_b128 v[40:43], v2 offset:9216
  ds_read_b128 v[44:47], v2 offset:10240
  ds_read_b128 v[48:51], v2 offset:11264
  buffer_load_dwordx4 v[124:127], v2, s[4:7], s24 offen offset:2048 sc1
  buffer_load_dwordx4 v[116:119], v2, s[4:7], s25 offen offset:2048 sc1
  ds_read_b128 v[52:55], v2 offset:12288
  ds_read_b128 v[56:59], v2 offset:13312
  ds_read_b128 v[60:63], v2 offset:14336
  ds_read_b128 v[64:67], v2 offset:15360
  buffer_load_dwordx4 v[124:127], v2, s[4:7], s24 offen offset:2048 sc1
  buffer_load_dwordx4 v[116:119], v2, s[4:7], s25 offen offset:2048 sc1
  s_add_u32 s14, s14, 1
  s_cmp_ge_i32 s14, s30
  s_cbranch_scc1 T_kvw_46
T_kvb_47:
  s_mov_b32 s19, 0
  s_branch T_loop_42
T_kvw_46:
  s_mov_b32 s19, 0
  s_branch T_kvok_55
T_kv_54:
  s_sleep 4
  s_add_u32 s19, s19, 1
  s_cmp_gt_u32 s19, 32768
  s_cbranch_scc1 M_exit
T_kvok_55:
  s_add_u32 s39, s99, 128
  s_mov_b32 s38, 0
  s_mov_b32 s37, 0
  s_atomic_or s38, s[58:59], s99 glc
  s_atomic_or s37, s[58:59], s39 glc
  s_waitcnt lgkmcnt(0)
  s_lshl_b32 s38, s38, 1
  s_lshl1_add_u32 s37, s37, 1
  s_min_u32 s38, s38, s37
  s_cmp_ge_u32 s38, 64
  s_cselect_b32 s38, 100, s38
  s_sub_u32 s38, s38, 1
  s_max_i32 s30, s30, s38
  s_cmp_ge_i32 s14, s30
  s_cbranch_scc1 T_kv_54
  s_branch T_kvb_47
T_slow_49:
  s_nop 7
  v_max3_f32 v100, v16, v17, v18
  v_max3_f32 v100, v100, v19, v20
  v_max3_f32 v100, v100, v21, v22
  v_max3_f32 v100, v100, v23, v112
  v_max3_f32 v100, v100, v113, v114
  v_max_f32 v100, v100, v115
  v_mov_b32 v101, v100
  s_nop 1
  v_permlane32_swap_b32 v100, v101
  s_nop 1
  v_max_f32 v100, v100, v101
  v_mov_b32 v101, v100
  s_nop 1
  v_permlane16_swap_b32 v100, v101
  s_nop 1
  v_max_f32 v100, v100, v101
  v_sub_f32 v16, v16, v100
  v_sub_f32 v17, v17, v100
  v_sub_f32 v18, v18, v100
  v_sub_f32 v19, v19, v100
  v_exp_f32 v16, v16
  v_exp_f32 v17, v17
  v_exp_f32 v18, v18
  v_exp_f32 v19, v19
  v_sub_f32 v20, v20, v100
  v_sub_f32 v21, v21, v100
  v_sub_f32 v22, v22, v100
  v_sub_f32 v23, v23, v100
  v_exp_f32 v20, v20
  v_exp_f32 v21, v21
  v_exp_f32 v22, v22
  v_exp_f32 v23, v23
  v_sub_f32 v112, v112, v100
  v_sub_f32 v113, v113, v100
  v_sub_f32 v114, v114, v100
  v_sub_f32 v115, v115, v100
  v_exp_f32 v112, v112
  v_exp_f32 v113, v113
  v_exp_f32 v114, v114
  v_exp_f32 v115, v115
  s_nop 0
  v_cvt_pk_bf16_f32 v44, v16, v17
  v_cvt_pk_bf16_f32 v45, v18, v19
  v_cvt_pk_bf16_f32 v46, v20, v21
  v_cvt_pk_bf16_f32 v47, v22, v23
  v_cvt_pk_bf16_f32 v84, v112, v113
  v_cvt_pk_bf16_f32 v85, v114, v115
  v_cndmask_b32 v48, v84, 0, s[16:17]
  v_cndmask_b32 v49, v85, 0, s[16:17]
  v_cndmask_b32 v50, 0, v84, s[16:17]
  v_cndmask_b32 v51, 0, v85, s[16:17]
  s_nop 1
  v_mfma_f32_16x16x16_bf16 v[88:91], v[12:13], v[48:49], 0
  v_mfma_f32_16x16x16_bf16 v[24:27], v[120:121], v[48:49], 0
  v_mfma_f32_16x16x16_bf16 v[116:119], v[120:121], v[50:51], 0
  v_mfma_f32_16x16x32_bf16 v[88:91], v[12:15], v[44:47], v[88:91]
  v_mfma_f32_16x16x32_bf16 v[24:27], v[28:31], v[44:47], v[24:27]
  v_mfma_f32_16x16x32_bf16 v[116:119], v[32:35], v[44:47], v[116:119]
  s_nop 7
  s_nop 1
  s_mov_b32 s96, -1
  s_branch T_back_50
T_w_13:
  s_mov_b32 s19, 0
  s_add_u32 s14, s14, 1
  s_and_b32 s57, s14, 1
  v_mov_b64 v[16:17], 0
  v_mov_b64 v[18:19], 0
  v_mov_b64 v[20:21], 0
  v_mov_b64 v[22:23], 0
  v_mov_b64 v[24:25], 0
  v_mov_b64 v[26:27], 0
  buffer_load_dwordx4 v[124:127], v2, s[4:7], s24 offen offset:3072 sc1
  buffer_load_dwordx4 v[116:119], v2, s[4:7], s25 offen offset:3072 sc1
  buffer_load_dwordx4 v[124:127], v2, s[4:7], s24 offen offset:3072 sc1
  buffer_load_dwordx4 v[116:119], v2, s[4:7], s25 offen offset:3072 sc1
  s_branch T_loop_56
.p2align 6
T_retry_57:
  s_mov_b64 exec, vcc
  buffer_load_dwordx4 v[124:127], v2, s[4:7], s24 offen offset:3072 sc1
  buffer_load_dwordx4 v[116:119], v2, s[4:7], s25 offen offset:3072 sc1
  s_mov_b64 exec, -1
  s_add_u32 s19, s19, 1
  s_cmp_gt_u32 s19, 32768
  s_cbranch_scc1 M_exit
  s_nop 0
  v_mov_b64 v[16:17], 0
  v_mov_b64 v[18:19], 0
T_loop_56:
  s_waitcnt vmcnt(3) lgkmcnt(0)
  v_max3_u32 v123, v124, v125, v126
  v_max_u32 v123, v123, v127
  v_mov_b32_dpp v120, v124 row_ror:8 row_mask:0xf bank_mask:0xf
  v_mov_b32_dpp v121, v125 row_ror:8 row_mask:0xf bank_mask:0xf
  s_waitcnt vmcnt(2)
  v_max3_u32 v123, v123, v116, v117
  v_max3_u32 v123, v123, v118, v119
  v_cmp_eq_u32 vcc, -1, v123
  v_smfmac_f32_16x16x64_bf16 v[16:19], v[124:127], v[68:75], v0
  s_cbranch_vccnz T_retry_57
  ds_write_b128 v2, v[124:127] offset:3072
  v_mov_b32_dpp v122, v126 row_ror:8 row_mask:0xf bank_mask:0xf
  v_smfmac_f32_16x16x64_bf16 v[20:23], v[124:127], v[76:83], v0
  s_and_b32 s57, s14, 1
  v_mov_b32_dpp v123, v127 row_ror:8 row_mask:0xf bank_mask:0xf
  v_smfmac_f32_16x16x64_bf16 v[24:27], v[124:127], v[84:91], v0
  s_and_b32 s36, s14, 3
  ds_write_b128 v2, v[116:119] offset:7168
  v_smfmac_f32_16x16x64_bf16 v[16:19], v[120:123], v[92:99], v0
  s_lshl_b32 s36, s36, 13
  v_mov_b32_dpp v84, v116 row_ror:8 row_mask:0xf bank_mask:0xf
  v_smfmac_f32_16x16x64_bf16 v[20:23], v[120:123], v[100:107], v0
  s_add_u32 s26, s36, s23
  ds_read_b128 v[68:71], v4 offset:12288
  v_mov_b32_dpp v85, v117 row_ror:8 row_mask:0xf bank_mask:0xf
  v_smfmac_f32_16x16x64_bf16 v[24:27], v[120:123], v[108:115], v0
  s_add_u32 s36, s36, 8192
  ds_read_b128 v[72:75], v4 offset:13312
  v_mov_b32_dpp v86, v118 row_ror:8 row_mask:0xf bank_mask:0xf
  v_smfmac_f32_16x16x64_bf16 v[16:19], v[116:119], v[224:231], v0
  s_and_b32 s36, s36, 0x7fff
  ds_read_b128 v[76:79], v4 offset:14336
  v_mov_b32_dpp v87, v119 row_ror:8 row_mask:0xf bank_mask:0xf
  v_smfmac_f32_16x16x64_bf16 v[20:23], v[116:119], v[240:247], v0
  s_waitcnt lgkmcnt(3)
  s_barrier
  ds_read_b128 v[100:103], v2 offset:2048
  v_smfmac_f32_16x16x64_bf16 v[24:27], v[116:119], a[0:7], v0
  s_mov_b32 m0, s31
  ds_read_b128 v[120:123], v1 offset:2048
  v_smfmac_f32_16x16x64_bf16 v[16:19], v[84:87], v[232:239], v0
  v_smfmac_f32_16x16x64_bf16 v[20:23], v[84:87], v[248:255], v0
  ds_read_b128 v[80:83], v4 offset:15360
  v_smfmac_f32_16x16x64_bf16 v[24:27], v[84:87], a[8:15], v0
  s_waitcnt lgkmcnt(2)
  buffer_load_dwordx4 v9, s[4:7], s27 offen sc1 lds
  v_smfmac_f32_16x16x64_bf16 v[16:19], v[100:103], v[128:135], v0
  ds_read_b128 v[92:95], v2 offset:1024
  s_mov_b32 m0, s32
  v_smfmac_f32_16x16x64_bf16 v[20:23], v[100:103], v[144:151], v0
  ds_read_b128 v[96:99], v1 offset:1024
  v_smfmac_f32_16x16x64_bf16 v[24:27], v[100:103], v[68:75], v0
  s_waitcnt vmcnt(1) lgkmcnt(3)
  ds_read_b128 v[116:119], v2 offset:0
  v_smfmac_f32_16x16x64_bf16 v[16:19], v[120:123], v[136:143], v0
  ds_read_b128 v[124:127], v1 offset:0
  buffer_load_dwordx4 v9, s[4:7], s27 offen offset:128 sc1 lds
  v_smfmac_f32_16x16x64_bf16 v[20:23], v[120:123], v[152:159], v0
  s_waitcnt lgkmcnt(4)
  ds_read_b128 v[104:107], v2 offset:6144
  s_mov_b32 m0, s33
  v_smfmac_f32_16x16x64_bf16 v[24:27], v[120:123], v[76:83], v0
  s_waitcnt lgkmcnt(4)
  ds_read_b128 v[108:111], v1 offset:6144
  v_smfmac_f32_16x16x64_bf16 v[16:19], v[92:95], v[160:167], v0
  s_waitcnt lgkmcnt(4)
  ds_read_b128 v[112:115], v2 offset:5120
  v_smfmac_f32_16x16x64_bf16 v[16:19], v[96:99], v[168:175], v0
  s_waitcnt lgkmcnt(4)
  ds_read_b128 v[84:87], v1 offset:5120
  buffer_load_dwordx4 v10, s[4:7], s28 offen sc1 lds
  v_smfmac_f32_16x16x64_bf16 v[16:19], v[116:119], v[192:199], v0
  s_waitcnt lgkmcnt(4)
  ds_read_b128 v[88:91], v2 offset:4096
  s_mov_b32 m0, s34
  v_smfmac_f32_16x16x64_bf16 v[16:19], v[124:127], v[200:207], v0
  s_waitcnt lgkmcnt(4)
  ds_read_b128 v[100:103], v1 offset:4096
  v_smfmac_f32_16x16x64_bf16 v[16:19], v[104:107], a[16:23], v0
  s_waitcnt lgkmcnt(4)
  ds_read_b128 v[68:71], v4 offset:16384
  v_smfmac_f32_16x16x64_bf16 v[16:19], v[108:111], a[24:31], v0
  s_waitcnt lgkmcnt(4)
  ds_read_b128 v[72:75], v4 offset:17408
  buffer_load_dwordx4 v10, s[4:7], s28 offen offset:256 sc1 lds
  v_smfmac_f32_16x16x64_bf16 v[16:19], v[112:115], a[64:71], v0
  s_waitcnt lgkmcnt(4)
  ds_read_b128 v[76:79], v4 offset:18432
  s_mov_b32 m0, 32256
  v_smfmac_f32_16x16x64_bf16 v[16:19], v[84:87], a[72:79], v0
  s_waitcnt lgkmcnt(4)
  ds_read_b128 v[80:83], v4 offset:19456
  v_smfmac_f32_16x16x64_bf16 v[16:19], v[88:91], a[112:119], v0
  s_waitcnt lgkmcnt(4)
  v_smfmac_f32_16x16x64_bf16 v[16:19], v[100:103], a[120:127], v0
  buffer_load_dword v3, s[4:7], s99 offen sc1 lds
  s_add_u32 s24, s36, 145752064
  s_add_u32 s25, s36, 145756160
  v_smfmac_f32_16x16x64_bf16 v[20:23], v[92:95], v[176:183], v0
  s_add_u32 s35, s36, s23
  v_smfmac_f32_16x16x64_bf16 v[20:23], v[96:99], v[184:191], v0
  s_waitcnt lgkmcnt(2)
  v_smfmac_f32_16x16x64_bf16 v[20:23], v[116:119], v[68:75], v0
  s_waitcnt lgkmcnt(0)
  ds_read_b128 v[68:71], v4 offset:20480
  v_mul_f32 v16, s18, v16
  v_smfmac_f32_16x16x64_bf16 v[20:23], v[124:127], v[76:83], v0
  ds_read_b128 v[72:75], v4 offset:21504
  v_mul_f32 v17, s18, v17
  v_smfmac_f32_16x16x64_bf16 v[20:23], v[104:107], a[32:39], v0
  ds_read_b128 v[76:79], v4 offset:22528
  v_mul_f32 v18, s18, v18
  v_smfmac_f32_16x16x64_bf16 v[20:23], v[108:111], a[40:47], v0
  ds_read_b128 v[80:83], v4 offset:23552
  v_mul_f32 v19, s18, v19
  v_smfmac_f32_16x16x64_bf16 v[20:23], v[112:115], a[80:87], v0
  v_cvt_pk_bf16_f32 v120, v16, v17
  v_smfmac_f32_16x16x64_bf16 v[20:23], v[84:87], a[88:95], v0
  v_cvt_pk_bf16_f32 v121, v18, v19
  v_smfmac_f32_16x16x64_bf16 v[20:23], v[88:91], a[128:135], v0
  ds_write_b64 v5, v[120:121] offset:24576
  v_smfmac_f32_16x16x64_bf16 v[20:23], v[100:103], a[136:143], v0
  s_waitcnt lgkmcnt(3)
  v_smfmac_f32_16x16x64_bf16 v[24:27], v[92:95], v[68:75], v0
  s_waitcnt lgkmcnt(1)
  v_mov_b64 v[92:93], 0
  v_smfmac_f32_16x16x64_bf16 v[24:27], v[96:99], v[76:83], v0
  s_nop 1
  v_cvt_pk_bf16_f32 v122, v20, v21
  v_cvt_pk_bf16_f32 v123, v22, v23
  v_smfmac_f32_16x16x64_bf16 v[24:27], v[116:119], v[208:215], v0
  ds_write_b64 v5, v[122:123] offset:26880
  v_mov_b64 v[94:95], 0
  v_smfmac_f32_16x16x64_bf16 v[24:27], v[124:127], v[216:223], v0
  s_waitcnt lgkmcnt(1)
  s_barrier
  ds_read_b64_tr_b16 v[68:69], v6 offset:24576
  v_smfmac_f32_16x16x64_bf16 v[24:27], v[104:107], a[48:55], v0
  s_add_u32 s27, s27, 8192
  ds_read_b64_tr_b16 v[70:71], v6 offset:24640
  ds_read_b64_tr_b16 v[72:73], v6 offset:24832
  v_smfmac_f32_16x16x64_bf16 v[24:27], v[108:111], a[56:63], v0
  s_add_u32 s28, s28, 8192
  ds_read_b64_tr_b16 v[74:75], v6 offset:24896
  ds_read_b64_tr_b16 v[76:77], v6 offset:25088
  v_smfmac_f32_16x16x64_bf16 v[24:27], v[112:115], a[96:103], v0
  s_nop 0
  ds_read_b64_tr_b16 v[78:79], v6 offset:25152
  ds_read_b64_tr_b16 v[80:81], v6 offset:25344
  v_smfmac_f32_16x16x64_bf16 v[24:27], v[84:87], a[104:111], v0
  ds_read_b64_tr_b16 v[82:83], v6 offset:25408
  v_mov_b64 v[96:97], 0
  v_smfmac_f32_16x16x64_bf16 v[24:27], v[88:91], a[144:151], v0
  s_waitcnt lgkmcnt(8)
  s_barrier
  ds_read_b64_tr_b16 v[116:117], v6 offset:26880
  v_smfmac_f32_16x16x64_bf16 v[24:27], v[100:103], a[152:159], v0
  s_waitcnt lgkmcnt(7)
  ds_read_b64_tr_b16 v[118:119], v6 offset:26944
  v_mfma_f32_16x16x32_bf16 v[16:19], v[36:39], v[68:71], 0
  s_waitcnt lgkmcnt(6)
  ds_read_b64_tr_b16 v[124:125], v6 offset:27136
  ds_read_b64_tr_b16 v[126:127], v6 offset:27200
  v_mfma_f32_16x16x32_bf16 v[16:19], v[40:43], v[72:75], v[16:19]
  s_waitcnt lgkmcnt(6)
  ds_read_b64_tr_b16 v[104:105], v6 offset:27392
  ds_read_b64_tr_b16 v[106:107], v6 offset:27456
  v_mfma_f32_16x16x32_bf16 v[16:19], v[44:47], v[76:79], v[16:19]
  s_waitcnt lgkmcnt(6)
  ds_read_b64_tr_b16 v[108:109], v6 offset:27648
  ds_read_b64_tr_b16 v[110:111], v6 offset:27712
  v_mfma_f32_16x16x32_bf16 v[16:19], v[48:51], v[80:83], v[16:19]
  s_waitcnt lgkmcnt(6)
  v_cvt_pk_bf16_f32 v120, v24, v25
  v_cvt_pk_bf16_f32 v121, v26, v27
  v_mfma_f32_16x16x32_bf16 v[112:115], v[116:119], v[68:71], 0
  s_waitcnt lgkmcnt(4)
  v_mov_b64 v[98:99], 0
  v_mfma_f32_16x16x32_bf16 v[112:115], v[124:127], v[72:75], v[112:115]
  s_waitcnt lgkmcnt(2)
  v_mov_b64 v[36:37], 0
  v_exp_f32 v100, v16
  v_mfma_f32_16x16x32_bf16 v[112:115], v[104:107], v[76:79], v[112:115]
  s_waitcnt lgkmcnt(0)
  v_exp_f32 v101, v17
  v_mfma_f32_16x16x32_bf16 v[112:115], v[108:111], v[80:83], v[112:115]
  buffer_store_dwordx4 v[120:123], v2, s[4:7], s29 offen offset:3072 sc1
  v_exp_f32 v102, v18
  v_mfma_f32_16x16x32_bf16 v[20:23], v[52:55], v[68:71], 0
  v_exp_f32 v103, v19
  v_mfma_f32_16x16x32_bf16 v[20:23], v[56:59], v[72:75], v[20:23]
  v_cvt_pk_bf16_f32 v44, v100, v101
  v_cvt_pk_bf16_f32 v45, v102, v103
  v_mfma_f32_16x16x32_bf16 v[20:23], v[60:63], v[76:79], v[20:23]
  s_add_u32 s29, s29, 131072
  v_exp_f32 v100, v112
  v_mfma_f32_16x16x32_bf16 v[20:23], v[64:67], v[80:83], v[20:23]
  v_exp_f32 v101, v113
  v_exp_f32 v102, v114
  v_exp_f32 v103, v115
  v_cvt_pk_bf16_f32 v84, v100, v101
  v_cvt_pk_bf16_f32 v85, v102, v103
  v_cndmask_b32 v48, v84, 0, s[16:17]
  v_cndmask_b32 v49, v85, 0, s[16:17]
  v_cndmask_b32 v50, 0, v84, s[16:17]
  v_cndmask_b32 v51, 0, v85, s[16:17]
  v_exp_f32 v100, v20
  v_mfma_f32_16x16x16_bf16 v[88:91], v[12:13], v[48:49], 0
  v_exp_f32 v101, v21
  v_mfma_f32_16x16x16_bf16 v[24:27], v[120:121], v[48:49], 0
  v_exp_f32 v102, v22
  v_mfma_f32_16x16x16_bf16 v[116:119], v[120:121], v[50:51], 0
  v_exp_f32 v103, v23
  v_cvt_pk_bf16_f32 v46, v100, v101
  v_cvt_pk_bf16_f32 v47, v102, v103
  v_mov_b64 v[38:39], 0
  s_nop 0
  v_mfma_f32_16x16x32_bf16 v[88:91], v[12:15], v[44:47], v[88:91]
  v_mov_b64 v[40:41], 0
  v_mov_b64 v[42:43], 0
  v_mfma_f32_16x16x32_bf16 v[24:27], v[28:31], v[44:47], v[24:27]
  ds_read_b128 v[52:55], v4 offset:24576
  ds_read_b128 v[56:59], v4 offset:25600
  v_mfma_f32_16x16x32_bf16 v[116:119], v[32:35], v[44:47], v[116:119]
  s_nop 1
T_back_64:
  v_rcp_f32 v89, v88
  v_subrev_u32 v100, s54, v88
  v_cmp_le_u32 vcc, s96, v100
  v_mul_f32 v24, v89, v24
  v_mul_f32 v25, v89, v25
  v_cvt_pk_bf16_f32 v124, v24, v25
  v_pk_mul_f32 v[26:27], v[26:27], v[88:89] op_sel:[0,1] op_sel_hi:[1,1]
  v_pk_mul_f32 v[116:117], v[116:117], v[88:89] op_sel:[0,1] op_sel_hi:[1,1]
  v_pk_mul_f32 v[118:119], v[118:119], v[88:89] op_sel:[0,1] op_sel_hi:[1,1]
  v_cvt_pk_bf16_f32 v125, v26, v27
  v_cvt_pk_bf16_f32 v126, v116, v117
  v_cvt_pk_bf16_f32 v127, v118, v119
  ds_write_b128 v11, v[124:127] offset:30720
  s_cbranch_vccnz T_slow_63
  v_smfmac_f32_16x16x64_bf16 v[92:95], v[124:127], a[160:167], v0
  s_mov_b32 s96, s55
  v_smfmac_f32_16x16x64_bf16 v[96:99], v[124:127], a[168:175], v0
  s_cmp_eq_u32 s14, 63
  v_smfmac_f32_16x16x64_bf16 v[36:39], v[124:127], a[176:183], v0
  s_waitcnt lgkmcnt(0)
  s_barrier
  ds_read_b128 v[104:107], v11 offset:30208
  ds_read_b128 v[108:111], v11 offset:29696
  ds_read_b128 v[68:71], v11 offset:29184
  s_cbranch_scc1 M_tdone
  v_smfmac_f32_16x16x64_bf16 v[40:43], v[124:127], a[184:191], v0
  s_waitcnt lgkmcnt(2)
  v_smfmac_f32_16x16x64_bf16 v[92:95], v[104:107], a[192:199], v0
  s_waitcnt lgkmcnt(1)
  ds_read_b128 v[76:79], v4 offset:28672
  v_smfmac_f32_16x16x64_bf16 v[92:95], v[108:111], a[224:231], v0
  s_waitcnt lgkmcnt(1)
  ds_read_b128 v[80:83], v4 offset:29696
  v_smfmac_f32_16x16x64_bf16 v[92:95], v[68:71], a[240:247], v0
  ds_read_b128 v[60:63], v4 offset:26624
  v_smfmac_f32_16x16x64_bf16 v[96:99], v[104:107], a[200:207], v0
  ds_read_b128 v[64:67], v4 offset:27648
  v_smfmac_f32_16x16x64_bf16 v[96:99], v[108:111], a[232:239], v0
  ds_read_b128 v[28:31], v4 offset:30720
  s_nop 0
  v_cvt_pk_bf16_f32 v16, v92, v93
  v_cvt_pk_bf16_f32 v17, v94, v95
  v_bfi_b32 v16, 1, s57, v16
  v_smfmac_f32_16x16x64_bf16 v[96:99], v[68:71], a[248:255], v0
  buffer_store_dwordx2 v[16:17], v7, s[4:7], s20 offen offset:0
  v_smfmac_f32_16x16x64_bf16 v[36:39], v[104:107], a[208:215], v0
  ds_read_b128 v[32:35], v4 offset:31744
  v_smfmac_f32_16x16x64_bf16 v[36:39], v[108:111], v[52:59], v0
  s_waitcnt lgkmcnt(4)
  s_nop 0
  v_cvt_pk_bf16_f32 v18, v96, v97
  v_cvt_pk_bf16_f32 v19, v98, v99
  v_bfi_b32 v18, 1, s57, v18
  v_smfmac_f32_16x16x64_bf16 v[36:39], v[68:71], v[76:83], v0
  buffer_store_dwordx2 v[18:19], v7, s[4:7], s20 offen offset:64
  v_smfmac_f32_16x16x64_bf16 v[40:43], v[104:107], a[216:223], v0
  s_waitcnt lgkmcnt(2)
  v_smfmac_f32_16x16x64_bf16 v[40:43], v[108:111], v[60:67], v0
  s_waitcnt lgkmcnt(0)
  s_nop 0
  v_cvt_pk_bf16_f32 v20, v36, v37
  v_cvt_pk_bf16_f32 v21, v38, v39
  v_bfi_b32 v20, 1, s57, v20
  v_smfmac_f32_16x16x64_bf16 v[40:43], v[68:71], v[28:35], v0
  buffer_store_dwordx2 v[20:21], v7, s[4:7], s21 offen offset:0
  s_nop 6
  v_cvt_pk_bf16_f32 v22, v40, v41
  v_cvt_pk_bf16_f32 v23, v42, v43
  v_bfi_b32 v22, 1, s57, v22
  buffer_store_dwordx2 v[22:23], v7, s[4:7], s21 offen offset:64
  ds_read_b128 v[68:71], v4 offset:0
  ds_read_b128 v[72:75], v4 offset:1024
  ds_read_b128 v[76:79], v4 offset:4096
  ds_read_b128 v[80:83], v4 offset:5120
  ds_read_b128 v[84:87], v4 offset:8192
  ds_read_b128 v[88:91], v4 offset:9216
  ds_read_b128 v[92:95], v4 offset:2048
  ds_read_b128 v[96:99], v4 offset:3072
  ds_read_b128 v[100:103], v4 offset:6144
  ds_read_b128 v[104:107], v4 offset:7168
  ds_read_b128 v[108:111], v4 offset:10240
  ds_read_b128 v[112:115], v4 offset:11264
  v_mov_b64 v[16:17], 0
  v_mov_b64 v[18:19], 0
  v_mov_b64 v[20:21], 0
  v_mov_b64 v[22:23], 0
  v_mov_b64 v[24:25], 0
  v_mov_b64 v[26:27], 0
  ds_read_b64 v[44:45], v2 offset:32256
  s_waitcnt lgkmcnt(0)
  v_readfirstlane_b32 s38, v44
  v_readfirstlane_b32 s37, v45
  s_nop 0
  s_lshl_b32 s38, s38, 1
  s_lshl1_add_u32 s37, s37, 1
  s_min_u32 s38, s38, s37
  s_cmp_ge_u32 s38, 64
  s_cselect_b32 s38, 100, s38
  s_sub_u32 s38, s38, 1
  s_max_i32 s30, s30, s38
  s_waitcnt vmcnt(4)
  s_barrier
  ds_read_b128 v[28:31], v2 offset:19456
  ds_read_b128 v[32:35], v2 offset:23552
  ds_read_b128 v[36:39], v2 offset:8192
  ds_read_b128 v[40:43], v2 offset:9216
  ds_read_b128 v[44:47], v2 offset:10240
  ds_read_b128 v[48:51], v2 offset:11264
  buffer_load_dwordx4 v[124:127], v2, s[4:7], s24 offen offset:3072 sc1
  buffer_load_dwordx4 v[116:119], v2, s[4:7], s25 offen offset:3072 sc1
  ds_read_b128 v[52:55], v2 offset:12288
  ds_read_b128 v[56:59], v2 offset:13312
  ds_read_b128 v[60:63], v2 offset:14336
  ds_read_b128 v[64:67], v2 offset:15360
  buffer_load_dwordx4 v[124:127], v2, s[4:7], s24 offen offset:3072 sc1
  buffer_load_dwordx4 v[116:119], v2, s[4:7], s25 offen offset:3072 sc1
  s_add_u32 s14, s14, 1
  s_cmp_ge_i32 s14, s30
  s_cbranch_scc1 T_kvw_60
T_kvb_61:
  s_mov_b32 s19, 0
  s_branch T_loop_56
T_kvw_60:
  s_mov_b32 s19, 0
  s_branch T_kvok_69
T_kv_68:
  s_sleep 4
  s_add_u32 s19, s19, 1
  s_cmp_gt_u32 s19, 32768
  s_cbranch_scc1 M_exit
T_kvok_69:
  s_add_u32 s39, s99, 128
  s_mov_b32 s38, 0
  s_mov_b32 s37, 0
  s_atomic_or s38, s[58:59], s99 glc
  s_atomic_or s37, s[58:59], s39 glc
  s_waitcnt lgkmcnt(0)
  s_lshl_b32 s38, s38, 1
  s_lshl1_add_u32 s37, s37, 1
  s_min_u32 s38, s38, s37
  s_cmp_ge_u32 s38, 64
  s_cselect_b32 s38, 100, s38
  s_sub_u32 s38, s38, 1
  s_max_i32 s30, s30, s38
  s_cmp_ge_i32 s14, s30
  s_cbranch_scc1 T_kv_68
  s_branch T_kvb_61
T_slow_63:
  s_nop 7
  v_max3_f32 v100, v16, v17, v18
  v_max3_f32 v100, v100, v19, v20
  v_max3_f32 v100, v100, v21, v22
  v_max3_f32 v100, v100, v23, v112
  v_max3_f32 v100, v100, v113, v114
  v_max_f32 v100, v100, v115
  v_mov_b32 v101, v100
  s_nop 1
  v_permlane32_swap_b32 v100, v101
  s_nop 1
  v_max_f32 v100, v100, v101
  v_mov_b32 v101, v100
  s_nop 1
  v_permlane16_swap_b32 v100, v101
  s_nop 1
  v_max_f32 v100, v100, v101
  v_sub_f32 v16, v16, v100
  v_sub_f32 v17, v17, v100
  v_sub_f32 v18, v18, v100
  v_sub_f32 v19, v19, v100
  v_exp_f32 v16, v16
  v_exp_f32 v17, v17
  v_exp_f32 v18, v18
  v_exp_f32 v19, v19
  v_sub_f32 v20, v20, v100
  v_sub_f32 v21, v21, v100
  v_sub_f32 v22, v22, v100
  v_sub_f32 v23, v23, v100
  v_exp_f32 v20, v20
  v_exp_f32 v21, v21
  v_exp_f32 v22, v22
  v_exp_f32 v23, v23
  v_sub_f32 v112, v112, v100
  v_sub_f32 v113, v113, v100
  v_sub_f32 v114, v114, v100
  v_sub_f32 v115, v115, v100
  v_exp_f32 v112, v112
  v_exp_f32 v113, v113
  v_exp_f32 v114, v114
  v_exp_f32 v115, v115
  s_nop 0
  v_cvt_pk_bf16_f32 v44, v16, v17
  v_cvt_pk_bf16_f32 v45, v18, v19
  v_cvt_pk_bf16_f32 v46, v20, v21
  v_cvt_pk_bf16_f32 v47, v22, v23
  v_cvt_pk_bf16_f32 v84, v112, v113
  v_cvt_pk_bf16_f32 v85, v114, v115
  v_cndmask_b32 v48, v84, 0, s[16:17]
  v_cndmask_b32 v49, v85, 0, s[16:17]
  v_cndmask_b32 v50, 0, v84, s[16:17]
  v_cndmask_b32 v51, 0, v85, s[16:17]
  s_nop 1
  v_mfma_f32_16x16x16_bf16 v[88:91], v[12:13], v[48:49], 0
  v_mfma_f32_16x16x16_bf16 v[24:27], v[120:121], v[48:49], 0
  v_mfma_f32_16x16x16_bf16 v[116:119], v[120:121], v[50:51], 0
  v_mfma_f32_16x16x32_bf16 v[88:91], v[12:15], v[44:47], v[88:91]
  v_mfma_f32_16x16x32_bf16 v[24:27], v[28:31], v[44:47], v[24:27]
  v_mfma_f32_16x16x32_bf16 v[116:119], v[32:35], v[44:47], v[116:119]
  s_nop 7
  s_nop 1
  s_mov_b32 s96, -1
  s_branch T_back_64
M_global:
  s_cmp_eq_u32 s13, 1
  s_cbranch_scc1 T_w_71
  s_cmp_eq_u32 s13, 2
  s_cbranch_scc1 T_w_72
  s_cmp_eq_u32 s13, 3
  s_cbranch_scc1 T_w_73
T_w_70:
  s_mov_b32 s19, 0
  s_add_u32 s14, s14, 1
  s_and_b32 s57, s14, 1
  v_mov_b64 v[16:17], 0
  v_mov_b64 v[18:19], 0
  v_mov_b64 v[20:21], 0
  v_mov_b64 v[22:23], 0
  v_mov_b64 v[24:25], 0
  v_mov_b64 v[26:27], 0
  buffer_load_dwordx4 v[124:127], v2, s[4:7], s24 offen offset:0 sc1
  buffer_load_dwordx4 v[116:119], v2, s[4:7], s25 offen offset:0 sc1
  buffer_load_dwordx4 v[124:127], v2, s[4:7], s24 offen offset:0 sc1
  buffer_load_dwordx4 v[116:119], v2, s[4:7], s25 offen offset:0 sc1
  s_branch T_loop_74
.p2align 6
T_retry_75:
  s_mov_b64 exec, vcc
  buffer_load_dwordx4 v[124:127], v2, s[4:7], s24 offen offset:0 sc1
  buffer_load_dwordx4 v[116:119], v2, s[4:7], s25 offen offset:0 sc1
  s_mov_b64 exec, -1
  s_add_u32 s19, s19, 1
  s_cmp_gt_u32 s19, 32768
  s_cbranch_scc1 M_exit
  s_nop 0
  v_mov_b64 v[16:17], 0
  v_mov_b64 v[18:19], 0
T_loop_74:
  s_waitcnt vmcnt(3) lgkmcnt(0)
  v_max3_u32 v123, v124, v125, v126
  v_max_u32 v123, v123, v127
  v_mov_b32_dpp v120, v124 row_ror:8 row_mask:0xf bank_mask:0xf
  v_mov_b32_dpp v121, v125 row_ror:8 row_mask:0xf bank_mask:0xf
  s_waitcnt vmcnt(2)
  v_max3_u32 v123, v123, v116, v117
  v_max3_u32 v123, v123, v118, v119
  v_cmp_eq_u32 vcc, -1, v123
  v_smfmac_f32_16x16x64_bf16 v[16:19], v[124:127], v[68:75], v0
  s_cbranch_vccnz T_retry_75
  ds_write_b128 v2, v[124:127] offset:0
  v_mov_b32_dpp v122, v126 row_ror:8 row_mask:0xf bank_mask:0xf
  v_smfmac_f32_16x16x64_bf16 v[20:23], v[124:127], v[76:83], v0
  s_and_b32 s57, s14, 1
  v_mov_b32_dpp v123, v127 row_ror:8 row_mask:0xf bank_mask:0xf
  v_smfmac_f32_16x16x64_bf16 v[24:27], v[124:127], v[84:91], v0
  s_and_b32 s36, s14, 3
  ds_write_b128 v2, v[116:119] offset:4096
  v_smfmac_f32_16x16x64_bf16 v[16:19], v[120:123], v[92:99], v0
  s_lshl_b32 s36, s36, 13
  v_mov_b32_dpp v84, v116 row_ror:8 row_mask:0xf bank_mask:0xf
  v_smfmac_f32_16x16x64_bf16 v[20:23], v[120:123], v[100:107], v0
  s_add_u32 s26, s36, s23
  ds_read_b128 v[68:71], v4 offset:12288
  v_mov_b32_dpp v85, v117 row_ror:8 row_mask:0xf bank_mask:0xf
  v_smfmac_f32_16x16x64_bf16 v[24:27], v[120:123], v[108:115], v0
  s_add_u32 s36, s36, 8192
  ds_read_b128 v[72:75], v4 offset:13312
  v_mov_b32_dpp v86, v118 row_ror:8 row_mask:0xf bank_mask:0xf
  v_smfmac_f32_16x16x64_bf16 v[16:19], v[116:119], v[224:231], v0
  s_and_b32 s36, s36, 0x7fff
  ds_read_b128 v[76:79], v4 offset:14336
  v_mov_b32_dpp v87, v119 row_ror:8 row_mask:0xf bank_mask:0xf
  v_smfmac_f32_16x16x64_bf16 v[20:23], v[116:119], v[240:247], v0
  s_waitcnt lgkmcnt(3)
  s_barrier
  ds_read_b128 v[100:103], v2 offset:1024
  v_smfmac_f32_16x16x64_bf16 v[24:27], v[116:119], a[0:7], v0
  s_mov_b32 m0, s31
  ds_read_b128 v[120:123], v1 offset:1024
  buffer_load_dwordx4 v9, s[4:7], s27 offen sc1 lds
  v_smfmac_f32_16x16x64_bf16 v[16:19], v[84:87], v[232:239], v0
  s_mov_b32 m0, s32
  v_smfmac_f32_16x16x64_bf16 v[20:23], v[84:87], v[248:255], v0
  ds_read_b128 v[80:83], v4 offset:15360
  v_smfmac_f32_16x16x64_bf16 v[24:27], v[84:87], a[8:15], v0
  s_waitcnt lgkmcnt(2)
  v_smfmac_f32_16x16x64_bf16 v[16:19], v[100:103], v[128:135], v0
  ds_read_b128 v[92:95], v2 offset:2048
  buffer_load_dwordx4 v9, s[4:7], s27 offen offset:128 sc1 lds
  v_smfmac_f32_16x16x64_bf16 v[20:23], v[100:103], v[144:151], v0
  ds_read_b128 v[96:99], v1 offset:2048
  s_mov_b32 m0, s33
  v_smfmac_f32_16x16x64_bf16 v[24:27], v[100:103], v[68:75], v0
  s_waitcnt vmcnt(2) lgkmcnt(3)
  ds_read_b128 v[116:119], v2 offset:3072
  v_smfmac_f32_16x16x64_bf16 v[16:19], v[120:123], v[136:143], v0
  ds_read_b128 v[124:127], v1 offset:3072
  v_smfmac_f32_16x16x64_bf16 v[20:23], v[120:123], v[152:159], v0
  s_waitcnt lgkmcnt(4)
  ds_read_b128 v[104:107], v2 offset:5120
  buffer_load_dwordx4 v10, s[4:7], s28 offen sc1 lds
  v_smfmac_f32_16x16x64_bf16 v[24:27], v[120:123], v[76:83], v0
  s_waitcnt lgkmcnt(4)
  ds_read_b128 v[108:111], v1 offset:5120
  s_mov_b32 m0, s34
  v_smfmac_f32_16x16x64_bf16 v[16:19], v[92:95], v[160:167], v0
  s_waitcnt lgkmcnt(4)
  ds_read_b128 v[112:115], v2 offset:6144
  v_smfmac_f32_16x16x64_bf16 v[16:19], v[96:99], v[168:175], v0
  s_waitcnt lgkmcnt(4)
  ds_read_b128 v[84:87], v1 offset:6144
  v_smfmac_f32_16x16x64_bf16 v[16:19], v[116:119], v[192:199], v0
  s_waitcnt lgkmcnt(4)
  ds_read_b128 v[88:91], v2 offset:7168
  buffer_load_dwordx4 v10, s[4:7], s28 offen offset:256 sc1 lds
  v_smfmac_f32_16x16x64_bf16 v[16:19], v[124:127], v[200:207], v0
  s_waitcnt lgkmcnt(4)
  ds_read_b128 v[100:103], v1 offset:7168
  v_smfmac_f32_16x16x64_bf16 v[16:19], v[104:107], a[16:23], v0
  s_waitcnt lgkmcnt(4)
  ds_read_b128 v[68:71], v4 offset:16384
  v_smfmac_f32_16x16x64_bf16 v[16:19], v[108:111], a[24:31], v0
  s_waitcnt lgkmcnt(4)
  ds_read_b128 v[72:75], v4 offset:17408
  v_smfmac_f32_16x16x64_bf16 v[16:19], v[112:115], a[64:71], v0
  s_waitcnt lgkmcnt(4)
  ds_read_b128 v[76:79], v4 offset:18432
  v_smfmac_f32_16x16x64_bf16 v[16:19], v[84:87], a[72:79], v0
  s_waitcnt lgkmcnt(4)
  ds_read_b128 v[80:83], v4 offset:19456
  v_smfmac_f32_16x16x64_bf16 v[16:19], v[88:91], a[112:119], v0
  s_waitcnt lgkmcnt(4)
  v_smfmac_f32_16x16x64_bf16 v[16:19], v[100:103], a[120:127], v0
  s_add_u32 s24, s36, 145752064
  s_add_u32 s25, s36, 145756160
  v_smfmac_f32_16x16x64_bf16 v[20:23], v[92:95], v[176:183], v0
  s_add_u32 s35, s36, s23
  v_smfmac_f32_16x16x64_bf16 v[20:23], v[96:99], v[184:191], v0
  s_waitcnt lgkmcnt(2)
  v_smfmac_f32_16x16x64_bf16 v[20:23], v[116:119], v[68:75], v0
  s_waitcnt lgkmcnt(0)
  ds_read_b128 v[68:71], v4 offset:20480
  v_mul_f32 v16, s18, v16
  v_smfmac_f32_16x16x64_bf16 v[20:23], v[124:127], v[76:83], v0
  ds_read_b128 v[72:75], v4 offset:21504
  v_mul_f32 v17, s18, v17
  v_smfmac_f32_16x16x64_bf16 v[20:23], v[104:107], a[32:39], v0
  ds_read_b128 v[76:79], v4 offset:22528
  v_mul_f32 v18, s18, v18
  v_smfmac_f32_16x16x64_bf16 v[20:23], v[108:111], a[40:47], v0
  ds_read_b128 v[80:83], v4 offset:23552
  v_mul_f32 v19, s18, v19
  v_smfmac_f32_16x16x64_bf16 v[20:23], v[112:115], a[80:87], v0
  v_cvt_pk_bf16_f32 v120, v16, v17
  v_smfmac_f32_16x16x64_bf16 v[20:23], v[84:87], a[88:95], v0
  v_cvt_pk_bf16_f32 v121, v18, v19
  v_smfmac_f32_16x16x64_bf16 v[20:23], v[88:91], a[128:135], v0
  ds_write_b64 v5, v[120:121] offset:24576
  v_smfmac_f32_16x16x64_bf16 v[20:23], v[100:103], a[136:143], v0
  s_waitcnt lgkmcnt(3)
  v_smfmac_f32_16x16x64_bf16 v[24:27], v[92:95], v[68:75], v0
  s_waitcnt lgkmcnt(1)
  v_mov_b64 v[92:93], 0
  v_smfmac_f32_16x16x64_bf16 v[24:27], v[96:99], v[76:83], v0
  s_nop 1
  v_cvt_pk_bf16_f32 v122, v20, v21
  v_cvt_pk_bf16_f32 v123, v22, v23
  v_smfmac_f32_16x16x64_bf16 v[24:27], v[116:119], v[208:215], v0
  ds_write_b64 v5, v[122:123] offset:26880
  v_mov_b64 v[94:95], 0
  v_smfmac_f32_16x16x64_bf16 v[24:27], v[124:127], v[216:223], v0
  s_waitcnt lgkmcnt(1)
  s_barrier
  ds_read_b64_tr_b16 v[68:69], v6 offset:24576
  v_smfmac_f32_16x16x64_bf16 v[24:27], v[104:107], a[48:55], v0
  s_add_u32 s27, s27, 8192
  ds_read_b64_tr_b16 v[70:71], v6 offset:24640
  ds_read_b64_tr_b16 v[72:73], v6 offset:24832
  v_smfmac_f32_16x16x64_bf16 v[24:27], v[108:111], a[56:63], v0
  s_add_u32 s28, s28, 8192
  ds_read_b64_tr_b16 v[74:75], v6 offset:24896
  ds_read_b64_tr_b16 v[76:77], v6 offset:25088
  v_smfmac_f32_16x16x64_bf16 v[24:27], v[112:115], a[96:103], v0
  s_nop 0
  ds_read_b64_tr_b16 v[78:79], v6 offset:25152
  ds_read_b64_tr_b16 v[80:81], v6 offset:25344
  v_smfmac_f32_16x16x64_bf16 v[24:27], v[84:87], a[104:111], v0
  ds_read_b64_tr_b16 v[82:83], v6 offset:25408
  v_mov_b64 v[96:97], 0
  v_smfmac_f32_16x16x64_bf16 v[24:27], v[88:91], a[144:151], v0
  s_waitcnt lgkmcnt(8)
  s_barrier
  ds_read_b64_tr_b16 v[116:117], v6 offset:26880
  v_smfmac_f32_16x16x64_bf16 v[24:27], v[100:103], a[152:159], v0
  s_waitcnt lgkmcnt(7)
  ds_read_b64_tr_b16 v[118:119], v6 offset:26944
  v_mfma_f32_16x16x32_bf16 v[16:19], v[36:39], v[68:71], 0
  s_waitcnt lgkmcnt(6)
  ds_read_b64_tr_b16 v[124:125], v6 offset:27136
  ds_read_b64_tr_b16 v[126:127], v6 offset:27200
  v_mfma_f32_16x16x32_bf16 v[16:19], v[40:43], v[72:75], v[16:19]
  s_waitcnt lgkmcnt(6)
  ds_read_b64_tr_b16 v[104:105], v6 offset:27392
  ds_read_b64_tr_b16 v[106:107], v6 offset:27456
  v_mfma_f32_16x16x32_bf16 v[16:19], v[44:47], v[76:79], v[16:19]
  s_waitcnt lgkmcnt(6)
  ds_read_b64_tr_b16 v[108:109], v6 offset:27648
  ds_read_b64_tr_b16 v[110:111], v6 offset:27712
  v_mfma_f32_16x16x32_bf16 v[16:19], v[48:51], v[80:83], v[16:19]
  s_waitcnt lgkmcnt(6)
  v_cvt_pk_bf16_f32 v120, v24, v25
  v_cvt_pk_bf16_f32 v121, v26, v27
  v_mfma_f32_16x16x32_bf16 v[112:115], v[116:119], v[68:71], 0
  s_waitcnt lgkmcnt(4)
  buffer_store_dwordx4 v[120:123], v2, s[4:7], s29 offen offset:0 sc1
  v_mov_b64 v[98:99], 0
  v_mfma_f32_16x16x32_bf16 v[112:115], v[124:127], v[72:75], v[112:115]
  s_waitcnt lgkmcnt(2)
  v_mov_b64 v[36:37], 0
  v_exp_f32 v100, v16
  v_mfma_f32_16x16x32_bf16 v[112:115], v[104:107], v[76:79], v[112:115]
  s_waitcnt lgkmcnt(0)
  v_exp_f32 v101, v17
  v_mfma_f32_16x16x32_bf16 v[112:115], v[108:111], v[80:83], v[112:115]
  v_exp_f32 v102, v18
  v_mfma_f32_16x16x32_bf16 v[20:23], v[52:55], v[68:71], 0
  v_exp_f32 v103, v19
  v_mfma_f32_16x16x32_bf16 v[20:23], v[56:59], v[72:75], v[20:23]
  v_cvt_pk_bf16_f32 v44, v100, v101
  v_cvt_pk_bf16_f32 v45, v102, v103
  v_mfma_f32_16x16x32_bf16 v[20:23], v[60:63], v[76:79], v[20:23]
  s_add_u32 s29, s29, 131072
  v_exp_f32 v100, v112
  v_mfma_f32_16x16x32_bf16 v[20:23], v[64:67], v[80:83], v[20:23]
  v_exp_f32 v101, v113
  v_exp_f32 v102, v114
  v_exp_f32 v103, v115
  v_cvt_pk_bf16_f32 v84, v100, v101
  v_cvt_pk_bf16_f32 v85, v102, v103
  v_cndmask_b32 v48, v84, 0, s[16:17]
  v_cndmask_b32 v49, v85, 0, s[16:17]
  v_cndmask_b32 v50, 0, v84, s[16:17]
  v_cndmask_b32 v51, 0, v85, s[16:17]
  v_exp_f32 v100, v20
  v_mfma_f32_16x16x16_bf16 v[88:91], v[12:13], v[48:49], 0
  v_exp_f32 v101, v21
  v_mfma_f32_16x16x16_bf16 v[24:27], v[120:121], v[48:49], 0
  v_exp_f32 v102, v22
  v_mfma_f32_16x16x16_bf16 v[116:119], v[120:121], v[50:51], 0
  v_exp_f32 v103, v23
  v_cvt_pk_bf16_f32 v46, v100, v101
  v_cvt_pk_bf16_f32 v47, v102, v103
  v_mov_b64 v[38:39], 0
  s_nop 0
  v_mfma_f32_16x16x32_bf16 v[88:91], v[12:15], v[44:47], v[88:91]
  v_mov_b64 v[40:41], 0
  v_mov_b64 v[42:43], 0
  v_mfma_f32_16x16x32_bf16 v[24:27], v[28:31], v[44:47], v[24:27]
  ds_read_b128 v[52:55], v4 offset:24576
  ds_read_b128 v[56:59], v4 offset:25600
  v_mfma_f32_16x16x32_bf16 v[116:119], v[32:35], v[44:47], v[116:119]
  s_nop 1
T_back_82:
  v_rcp_f32 v89, v88
  v_subrev_u32 v100, s54, v88
  v_cmp_le_u32 vcc, s96, v100
  v_mul_f32 v24, v89, v24
  v_mul_f32 v25, v89, v25
  v_cvt_pk_bf16_f32 v124, v24, v25
  v_pk_mul_f32 v[26:27], v[26:27], v[88:89] op_sel:[0,1] op_sel_hi:[1,1]
  v_pk_mul_f32 v[116:117], v[116:117], v[88:89] op_sel:[0,1] op_sel_hi:[1,1]
  v_pk_mul_f32 v[118:119], v[118:119], v[88:89] op_sel:[0,1] op_sel_hi:[1,1]
  v_cvt_pk_bf16_f32 v125, v26, v27
  v_cvt_pk_bf16_f32 v126, v116, v117
  v_cvt_pk_bf16_f32 v127, v118, v119
  ds_write_b128 v11, v[124:127] offset:29184
  s_cbranch_vccnz T_slow_81
  v_smfmac_f32_16x16x64_bf16 v[92:95], v[124:127], a[160:167], v0
  s_mov_b32 s96, s55
  v_smfmac_f32_16x16x64_bf16 v[96:99], v[124:127], a[168:175], v0
  s_cmp_eq_u32 s14, 63
  v_smfmac_f32_16x16x64_bf16 v[36:39], v[124:127], a[176:183], v0
  s_waitcnt lgkmcnt(0)
  s_barrier
  ds_read_b128 v[104:107], v11 offset:29696
  ds_read_b128 v[108:111], v11 offset:30208
  ds_read_b128 v[68:71], v11 offset:30720
  s_cbranch_scc1 M_tdone
  v_smfmac_f32_16x16x64_bf16 v[40:43], v[124:127], a[184:191], v0
  s_waitcnt lgkmcnt(2)
  v_smfmac_f32_16x16x64_bf16 v[92:95], v[104:107], a[192:199], v0
  s_waitcnt lgkmcnt(1)
  ds_read_b128 v[76:79], v4 offset:28672
  v_smfmac_f32_16x16x64_bf16 v[92:95], v[108:111], a[224:231], v0
  s_waitcnt lgkmcnt(1)
  ds_read_b128 v[80:83], v4 offset:29696
  v_smfmac_f32_16x16x64_bf16 v[92:95], v[68:71], a[240:247], v0
  ds_read_b128 v[60:63], v4 offset:26624
  v_smfmac_f32_16x16x64_bf16 v[96:99], v[104:107], a[200:207], v0
  ds_read_b128 v[64:67], v4 offset:27648
  v_smfmac_f32_16x16x64_bf16 v[96:99], v[108:111], a[232:239], v0
  ds_read_b128 v[28:31], v4 offset:30720
  s_nop 0
  v_cvt_pk_bf16_f32 v16, v92, v93
  v_cvt_pk_bf16_f32 v17, v94, v95
  v_bfi_b32 v16, 1, s57, v16
  v_smfmac_f32_16x16x64_bf16 v[96:99], v[68:71], a[248:255], v0
  buffer_store_dwordx2 v[16:17], v7, s[4:7], s20 offen offset:0 sc1
  v_smfmac_f32_16x16x64_bf16 v[36:39], v[104:107], a[208:215], v0
  ds_read_b128 v[32:35], v4 offset:31744
  v_smfmac_f32_16x16x64_bf16 v[36:39], v[108:111], v[52:59], v0
  s_waitcnt lgkmcnt(4)
  s_nop 0
  v_cvt_pk_bf16_f32 v18, v96, v97
  v_cvt_pk_bf16_f32 v19, v98, v99
  v_bfi_b32 v18, 1, s57, v18
  v_smfmac_f32_16x16x64_bf16 v[36:39], v[68:71], v[76:83], v0
  buffer_store_dwordx2 v[18:19], v7, s[4:7], s20 offen offset:64 sc1
  v_smfmac_f32_16x16x64_bf16 v[40:43], v[104:107], a[216:223], v0
  s_waitcnt lgkmcnt(2)
  ds_read_b128 v[116:119], v2 offset:31232
  v_smfmac_f32_16x16x64_bf16 v[40:43], v[108:111], v[60:67], v0
  s_waitcnt lgkmcnt(1)
  s_nop 0
  v_cvt_pk_bf16_f32 v20, v36, v37
  v_cvt_pk_bf16_f32 v21, v38, v39
  v_bfi_b32 v20, 1, s57, v20
  v_smfmac_f32_16x16x64_bf16 v[40:43], v[68:71], v[28:35], v0
  buffer_store_dwordx2 v[20:21], v7, s[4:7], s21 offen offset:0 sc1
  s_nop 6
  v_cvt_pk_bf16_f32 v22, v40, v41
  v_cvt_pk_bf16_f32 v23, v42, v43
  v_bfi_b32 v22, 1, s57, v22
  buffer_store_dwordx2 v[22:23], v7, s[4:7], s21 offen offset:64 sc1
  ds_read_b128 v[68:71], v4 offset:0
  ds_read_b128 v[72:75], v4 offset:1024
  ds_read_b128 v[76:79], v4 offset:4096
  ds_read_b128 v[80:83], v4 offset:5120
  ds_read_b128 v[84:87], v4 offset:8192
  ds_read_b128 v[88:91], v4 offset:9216
  v_mov_b64 v[16:17], 0
  v_mov_b64 v[18:19], 0
  v_mov_b64 v[20:21], 0
  v_mov_b64 v[22:23], 0
  v_mov_b64 v[24:25], 0
  v_mov_b64 v[26:27], 0
  s_mov_b32 s19, 0
  v_mov_b32 v49, -1
  s_waitcnt vmcnt(2)
  buffer_load_dwordx4 v[52:55], v2, s[4:7], s22 offen offset:0 sc1
  buffer_load_dwordx4 v[56:59], v2, s[4:7], s22 offen offset:1024 sc1
  buffer_load_dwordx4 v[60:63], v2, s[4:7], s22 offen offset:2048 sc1
  buffer_load_dwordx4 v[64:67], v2, s[4:7], s22 offen offset:3072 sc1
  ds_read_b128 v[92:95], v4 offset:2048
  ds_read_b128 v[96:99], v4 offset:3072
  ds_read_b128 v[100:103], v4 offset:6144
  ds_read_b128 v[104:107], v4 offset:7168
  ds_read_b128 v[108:111], v4 offset:10240
  ds_read_b128 v[112:115], v4 offset:11264
  ds_read_b64 v[44:45], v2 offset:32256
  s_waitcnt lgkmcnt(0)
  v_readfirstlane_b32 s38, v44
  v_readfirstlane_b32 s37, v45
  s_nop 0
  s_lshl_b32 s38, s38, 1
  s_lshl1_add_u32 s37, s37, 1
  s_min_u32 s38, s38, s37
  s_cmp_ge_u32 s38, 64
  s_cselect_b32 s38, 100, s38
  s_sub_u32 s38, s38, 1
  s_max_i32 s30, s30, s38
  s_waitcnt lgkmcnt(12)
  s_waitcnt vmcnt(3)
  v_mfma_f32_16x16x32_bf16 v[120:123], v[116:119], v[52:55], 0
  v_xor_b32 v48, s57, v52
  v_bitop3_b32 v48, v48, v54, s57 bitop3:0xf6
  s_waitcnt vmcnt(2)
  v_mfma_f32_16x16x32_bf16 v[120:123], v[116:119], v[56:59], v[120:123]
  v_bitop3_b32 v48, v48, v56, s57 bitop3:0xf6
  v_bitop3_b32 v48, v48, v58, s57 bitop3:0xf6
  s_waitcnt vmcnt(1)
  v_mfma_f32_16x16x32_bf16 v[120:123], v[116:119], v[60:63], v[120:123]
  v_bitop3_b32 v48, v48, v60, s57 bitop3:0xf6
  v_bitop3_b32 v48, v48, v62, s57 bitop3:0xf6
  s_waitcnt vmcnt(0)
  v_mfma_f32_16x16x32_bf16 v[120:123], v[116:119], v[64:67], v[120:123]
  v_bitop3_b32 v48, v48, v64, s57 bitop3:0xf6
  v_bitop3_b32 v48, v48, v66, s57 bitop3:0xf6
  v_and_b32 v48, 1, v48
  v_cmp_ne_u32 vcc, 0, v48
  s_cbranch_vccnz T_p1re_84
T_p1ok_85:
  s_nop 2
  v_add_f32_dpp v120, v120, v120 row_ror:8 row_mask:0xf bank_mask:0xf
  v_add_f32_dpp v121, v121, v121 row_ror:8 row_mask:0xf bank_mask:0xf
  v_cvt_pk_bf16_f32 v48, v120, v121
  buffer_store_dword v48, v8, s[4:7], s35 offen sc1
  buffer_store_dword v49, v8, s[4:7], s26 offen sc1
  s_barrier
  ds_read_b128 v[28:31], v2 offset:16384
  ds_read_b128 v[32:35], v2 offset:20480
  ds_read_b128 v[36:39], v2 offset:8192
  ds_read_b128 v[40:43], v2 offset:9216
  ds_read_b128 v[44:47], v2 offset:10240
  ds_read_b128 v[48:51], v2 offset:11264
  buffer_load_dwordx4 v[124:127], v2, s[4:7], s24 offen offset:0 sc1
  buffer_load_dwordx4 v[116:119], v2, s[4:7], s25 offen offset:0 sc1
  ds_read_b128 v[52:55], v2 offset:12288
  ds_read_b128 v[56:59], v2 offset:13312
  ds_read_b128 v[60:63], v2 offset:14336
  ds_read_b128 v[64:67], v2 offset:15360
  buffer_load_dwordx4 v[124:127], v2, s[4:7], s24 offen offset:0 sc1
  buffer_load_dwordx4 v[116:119], v2, s[4:7], s25 offen offset:0 sc1
  s_add_u32 s14, s14, 1
  s_cmp_ge_i32 s14, s30
  s_cbranch_scc1 T_kvw_78
T_kvb_79:
  s_mov_b32 s19, 0
  s_branch T_loop_74
T_p1re_84:
  s_mov_b64 exec, vcc
  buffer_load_dwordx4 v[52:55], v2, s[4:7], s22 offen offset:0 sc1
  buffer_load_dwordx4 v[56:59], v2, s[4:7], s22 offen offset:1024 sc1
  buffer_load_dwordx4 v[60:63], v2, s[4:7], s22 offen offset:2048 sc1
  buffer_load_dwordx4 v[64:67], v2, s[4:7], s22 offen offset:3072 sc1
  s_mov_b64 exec, -1
  s_add_u32 s19, s19, 1
  s_cmp_gt_u32 s19, 32768
  s_cbranch_scc1 M_exit
  s_waitcnt vmcnt(3)
  v_mfma_f32_16x16x32_bf16 v[120:123], v[116:119], v[52:55], 0
  v_xor_b32 v48, s57, v52
  v_bitop3_b32 v48, v48, v54, s57 bitop3:0xf6
  s_waitcnt vmcnt(2)
  v_mfma_f32_16x16x32_bf16 v[120:123], v[116:119], v[56:59], v[120:123]
  v_bitop3_b32 v48, v48, v56, s57 bitop3:0xf6
  v_bitop3_b32 v48, v48, v58, s57 bitop3:0xf6
  s_waitcnt vmcnt(1)
  v_mfma_f32_16x16x32_bf16 v[120:123], v[116:119], v[60:63], v[120:123]
  v_bitop3_b32 v48, v48, v60, s57 bitop3:0xf6
  v_bitop3_b32 v48, v48, v62, s57 bitop3:0xf6
  s_waitcnt vmcnt(0)
  v_mfma_f32_16x16x32_bf16 v[120:123], v[116:119], v[64:67], v[120:123]
  v_bitop3_b32 v48, v48, v64, s57 bitop3:0xf6
  v_bitop3_b32 v48, v48, v66, s57 bitop3:0xf6
  v_and_b32 v48, 1, v48
  v_cmp_ne_u32 vcc, 0, v48
  s_cbranch_vccnz T_p1re_84
  s_branch T_p1ok_85
T_kvw_78:
  s_mov_b32 s19, 0
  s_branch T_kvok_87
T_kv_86:
  s_sleep 4
  s_add_u32 s19, s19, 1
  s_cmp_gt_u32 s19, 32768
  s_cbranch_scc1 M_exit
T_kvok_87:
  s_add_u32 s39, s99, 128
  s_mov_b32 s38, 0
  s_mov_b32 s37, 0
  s_atomic_or s38, s[58:59], s99 glc
  s_atomic_or s37, s[58:59], s39 glc
  s_waitcnt lgkmcnt(0)
  s_lshl_b32 s38, s38, 1
  s_lshl1_add_u32 s37, s37, 1
  s_min_u32 s38, s38, s37
  s_cmp_ge_u32 s38, 64
  s_cselect_b32 s38, 100, s38
  s_sub_u32 s38, s38, 1
  s_max_i32 s30, s30, s38
  s_cmp_ge_i32 s14, s30
  s_cbranch_scc1 T_kv_86
  s_branch T_kvb_79
T_slow_81:
  s_nop 7
  v_max3_f32 v100, v16, v17, v18
  v_max3_f32 v100, v100, v19, v20
  v_max3_f32 v100, v100, v21, v22
  v_max3_f32 v100, v100, v23, v112
  v_max3_f32 v100, v100, v113, v114
  v_max_f32 v100, v100, v115
  v_mov_b32 v101, v100
  s_nop 1
  v_permlane32_swap_b32 v100, v101
  s_nop 1
  v_max_f32 v100, v100, v101
  v_mov_b32 v101, v100
  s_nop 1
  v_permlane16_swap_b32 v100, v101
  s_nop 1
  v_max_f32 v100, v100, v101
  v_sub_f32 v16, v16, v100
  v_sub_f32 v17, v17, v100
  v_sub_f32 v18, v18, v100
  v_sub_f32 v19, v19, v100
  v_exp_f32 v16, v16
  v_exp_f32 v17, v17
  v_exp_f32 v18, v18
  v_exp_f32 v19, v19
  v_sub_f32 v20, v20, v100
  v_sub_f32 v21, v21, v100
  v_sub_f32 v22, v22, v100
  v_sub_f32 v23, v23, v100
  v_exp_f32 v20, v20
  v_exp_f32 v21, v21
  v_exp_f32 v22, v22
  v_exp_f32 v23, v23
  v_sub_f32 v112, v112, v100
  v_sub_f32 v113, v113, v100
  v_sub_f32 v114, v114, v100
  v_sub_f32 v115, v115, v100
  v_exp_f32 v112, v112
  v_exp_f32 v113, v113
  v_exp_f32 v114, v114
  v_exp_f32 v115, v115
  s_nop 0
  v_cvt_pk_bf16_f32 v44, v16, v17
  v_cvt_pk_bf16_f32 v45, v18, v19
  v_cvt_pk_bf16_f32 v46, v20, v21
  v_cvt_pk_bf16_f32 v47, v22, v23
  v_cvt_pk_bf16_f32 v84, v112, v113
  v_cvt_pk_bf16_f32 v85, v114, v115
  v_cndmask_b32 v48, v84, 0, s[16:17]
  v_cndmask_b32 v49, v85, 0, s[16:17]
  v_cndmask_b32 v50, 0, v84, s[16:17]
  v_cndmask_b32 v51, 0, v85, s[16:17]
  s_nop 1
  v_mfma_f32_16x16x16_bf16 v[88:91], v[12:13], v[48:49], 0
  v_mfma_f32_16x16x16_bf16 v[24:27], v[120:121], v[48:49], 0
  v_mfma_f32_16x16x16_bf16 v[116:119], v[120:121], v[50:51], 0
  v_mfma_f32_16x16x32_bf16 v[88:91], v[12:15], v[44:47], v[88:91]
  v_mfma_f32_16x16x32_bf16 v[24:27], v[28:31], v[44:47], v[24:27]
  v_mfma_f32_16x16x32_bf16 v[116:119], v[32:35], v[44:47], v[116:119]
  s_nop 7
  s_nop 1
  s_mov_b32 s96, -1
  s_branch T_back_82
T_w_71:
  s_mov_b32 s19, 0
  s_add_u32 s14, s14, 1
  s_and_b32 s57, s14, 1
  v_mov_b64 v[16:17], 0
  v_mov_b64 v[18:19], 0
  v_mov_b64 v[20:21], 0
  v_mov_b64 v[22:23], 0
  v_mov_b64 v[24:25], 0
  v_mov_b64 v[26:27], 0
  buffer_load_dwordx4 v[124:127], v2, s[4:7], s24 offen offset:1024 sc1
  buffer_load_dwordx4 v[116:119], v2, s[4:7], s25 offen offset:1024 sc1
  buffer_load_dwordx4 v[124:127], v2, s[4:7], s24 offen offset:1024 sc1
  buffer_load_dwordx4 v[116:119], v2, s[4:7], s25 offen offset:1024 sc1
  s_branch T_loop_88
.p2align 6
T_retry_89:
  s_mov_b64 exec, vcc
  buffer_load_dwordx4 v[124:127], v2, s[4:7], s24 offen offset:1024 sc1
  buffer_load_dwordx4 v[116:119], v2, s[4:7], s25 offen offset:1024 sc1
  s_mov_b64 exec, -1
  s_add_u32 s19, s19, 1
  s_cmp_gt_u32 s19, 32768
  s_cbranch_scc1 M_exit
  s_nop 0
  v_mov_b64 v[16:17], 0
  v_mov_b64 v[18:19], 0
T_loop_88:
  s_waitcnt vmcnt(3) lgkmcnt(0)
  v_max3_u32 v123, v124, v125, v126
  v_max_u32 v123, v123, v127
  v_mov_b32_dpp v120, v124 row_ror:8 row_mask:0xf bank_mask:0xf
  v_mov_b32_dpp v121, v125 row_ror:8 row_mask:0xf bank_mask:0xf
  s_waitcnt vmcnt(2)
  v_max3_u32 v123, v123, v116, v117
  v_max3_u32 v123, v123, v118, v119
  v_cmp_eq_u32 vcc, -1, v123
  v_smfmac_f32_16x16x64_bf16 v[16:19], v[124:127], v[68:75], v0
  s_cbranch_vccnz T_retry_89
  ds_write_b128 v2, v[124:127] offset:1024
  v_mov_b32_dpp v122, v126 row_ror:8 row_mask:0xf bank_mask:0xf
  v_smfmac_f32_16x16x64_bf16 v[20:23], v[124:127], v[76:83], v0
  s_and_b32 s57, s14, 1
  v_mov_b32_dpp v123, v127 row_ror:8 row_mask:0xf bank_mask:0xf
  v_smfmac_f32_16x16x64_bf16 v[24:27], v[124:127], v[84:91], v0
  s_and_b32 s36, s14, 3
  ds_write_b128 v2, v[116:119] offset:5120
  v_smfmac_f32_16x16x64_bf16 v[16:19], v[120:123], v[92:99], v0
  s_lshl_b32 s36, s36, 13
  v_mov_b32_dpp v84, v116 row_ror:8 row_mask:0xf bank_mask:0xf
  v_smfmac_f32_16x16x64_bf16 v[20:23], v[120:123], v[100:107], v0
  s_add_u32 s26, s36, s23
  ds_read_b128 v[68:71], v4 offset:12288
  v_mov_b32_dpp v85, v117 row_ror:8 row_mask:0xf bank_mask:0xf
  v_smfmac_f32_16x16x64_bf16 v[24:27], v[120:123], v[108:115], v0
  s_add_u32 s36, s36, 8192
  ds_read_b128 v[72:75], v4 offset:13312
  v_mov_b32_dpp v86, v118 row_ror:8 row_mask:0xf bank_mask:0xf
  v_smfmac_f32_16x16x64_bf16 v[16:19], v[116:119], v[224:231], v0
  s_and_b32 s36, s36, 0x7fff
  ds_read_b128 v[76:79], v4 offset:14336
  v_mov_b32_dpp v87, v119 row_ror:8 row_mask:0xf bank_mask:0xf
  v_smfmac_f32_16x16x64_bf16 v[20:23], v[116:119], v[240:247], v0
  s_waitcnt lgkmcnt(3)
  s_barrier
  ds_read_b128 v[100:103], v2 offset:0
  v_smfmac_f32_16x16x64_bf16 v[24:27], v[116:119], a[0:7], v0
  s_mov_b32 m0, s31
  ds_read_b128 v[120:123], v1 offset:0
  v_smfmac_f32_16x16x64_bf16 v[16:19], v[84:87], v[232:239], v0
  buffer_load_dwordx4 v9, s[4:7], s27 offen sc1 lds
  v_smfmac_f32_16x16x64_bf16 v[20:23], v[84:87], v[248:255], v0
  ds_read_b128 v[80:83], v4 offset:15360
  s_mov_b32 m0, s32
  v_smfmac_f32_16x16x64_bf16 v[24:27], v[84:87], a[8:15], v0
  s_waitcnt lgkmcnt(2)
  v_smfmac_f32_16x16x64_bf16 v[16:19], v[100:103], v[128:135], v0
  ds_read_b128 v[92:95], v2 offset:3072
  v_smfmac_f32_16x16x64_bf16 v[20:23], v[100:103], v[144:151], v0
  ds_read_b128 v[96:99], v1 offset:3072
  buffer_load_dwordx4 v9, s[4:7], s27 offen offset:128 sc1 lds
  v_smfmac_f32_16x16x64_bf16 v[24:27], v[100:103], v[68:75], v0
  s_waitcnt vmcnt(2) lgkmcnt(3)
  ds_read_b128 v[116:119], v2 offset:2048
  s_mov_b32 m0, s33
  v_smfmac_f32_16x16x64_bf16 v[16:19], v[120:123], v[136:143], v0
  ds_read_b128 v[124:127], v1 offset:2048
  v_smfmac_f32_16x16x64_bf16 v[20:23], v[120:123], v[152:159], v0
  s_waitcnt lgkmcnt(4)
  ds_read_b128 v[104:107], v2 offset:4096
  v_smfmac_f32_16x16x64_bf16 v[24:27], v[120:123], v[76:83], v0
  s_waitcnt lgkmcnt(4)
  ds_read_b128 v[108:111], v1 offset:4096
  buffer_load_dwordx4 v10, s[4:7], s28 offen sc1 lds
  v_smfmac_f32_16x16x64_bf16 v[16:19], v[92:95], v[160:167], v0
  s_waitcnt lgkmcnt(4)
  ds_read_b128 v[112:115], v2 offset:7168
  s_mov_b32 m0, s34
  v_smfmac_f32_16x16x64_bf16 v[16:19], v[96:99], v[168:175], v0
  s_waitcnt lgkmcnt(4)
  ds_read_b128 v[84:87], v1 offset:7168
  v_smfmac_f32_16x16x64_bf16 v[16:19], v[116:119], v[192:199], v0
  s_waitcnt lgkmcnt(4)
  ds_read_b128 v[88:91], v2 offset:6144
  v_smfmac_f32_16x16x64_bf16 v[16:19], v[124:127], v[200:207], v0
  s_waitcnt lgkmcnt(4)
  ds_read_b128 v[100:103], v1 offset:6144
  buffer_load_dwordx4 v10, s[4:7], s28 offen offset:256 sc1 lds
  v_smfmac_f32_16x16x64_bf16 v[16:19], v[104:107], a[16:23], v0
  s_waitcnt lgkmcnt(4)
  ds_read_b128 v[68:71], v4 offset:16384
  v_smfmac_f32_16x16x64_bf16 v[16:19], v[108:111], a[24:31], v0
  s_waitcnt lgkmcnt(4)
  ds_read_b128 v[72:75], v4 offset:17408
  v_smfmac_f32_16x16x64_bf16 v[16:19], v[112:115], a[64:71], v0
  s_waitcnt lgkmcnt(4)
  ds_read_b128 v[76:79], v4 offset:18432
  v_smfmac_f32_16x16x64_bf16 v[16:19], v[84:87], a[72:79], v0
  s_waitcnt lgkmcnt(4)
  ds_read_b128 v[80:83], v4 offset:19456
  v_smfmac_f32_16x16x64_bf16 v[16:19], v[88:91], a[112:119], v0
  s_waitcnt lgkmcnt(4)
  v_smfmac_f32_16x16x64_bf16 v[16:19], v[100:103], a[120:127], v0
  s_add_u32 s24, s36, 145752064
  s_add_u32 s25, s36, 145756160
  v_smfmac_f32_16x16x64_bf16 v[20:23], v[92:95], v[176:183], v0
  s_add_u32 s35, s36, s23
  v_smfmac_f32_16x16x64_bf16 v[20:23], v[96:99], v[184:191], v0
  s_waitcnt lgkmcnt(2)
  v_smfmac_f32_16x16x64_bf16 v[20:23], v[116:119], v[68:75], v0
  s_waitcnt lgkmcnt(0)
  ds_read_b128 v[68:71], v4 offset:20480
  v_mul_f32 v16, s18, v16
  v_smfmac_f32_16x16x64_bf16 v[20:23], v[124:127], v[76:83], v0
  ds_read_b128 v[72:75], v4 offset:21504
  v_mul_f32 v17, s18, v17
  v_smfmac_f32_16x16x64_bf16 v[20:23], v[104:107], a[32:39], v0
  ds_read_b128 v[76:79], v4 offset:22528
  v_mul_f32 v18, s18, v18
  v_smfmac_f32_16x16x64_bf16 v[20:23], v[108:111], a[40:47], v0
  ds_read_b128 v[80:83], v4 offset:23552
  v_mul_f32 v19, s18, v19
  v_smfmac_f32_16x16x64_bf16 v[20:23], v[112:115], a[80:87], v0
  v_cvt_pk_bf16_f32 v120, v16, v17
  v_smfmac_f32_16x16x64_bf16 v[20:23], v[84:87], a[88:95], v0
  v_cvt_pk_bf16_f32 v121, v18, v19
  v_smfmac_f32_16x16x64_bf16 v[20:23], v[88:91], a[128:135], v0
  ds_write_b64 v5, v[120:121] offset:24576
  v_smfmac_f32_16x16x64_bf16 v[20:23], v[100:103], a[136:143], v0
  s_waitcnt lgkmcnt(3)
  v_smfmac_f32_16x16x64_bf16 v[24:27], v[92:95], v[68:75], v0
  s_waitcnt lgkmcnt(1)
  v_mov_b64 v[92:93], 0
  v_smfmac_f32_16x16x64_bf16 v[24:27], v[96:99], v[76:83], v0
  s_nop 1
  v_cvt_pk_bf16_f32 v122, v20, v21
  v_cvt_pk_bf16_f32 v123, v22, v23
  v_smfmac_f32_16x16x64_bf16 v[24:27], v[116:119], v[208:215], v0
  ds_write_b64 v5, v[122:123] offset:26880
  v_mov_b64 v[94:95], 0
  v_smfmac_f32_16x16x64_bf16 v[24:27], v[124:127], v[216:223], v0
  s_waitcnt lgkmcnt(1)
  s_barrier
  ds_read_b64_tr_b16 v[68:69], v6 offset:24576
  v_smfmac_f32_16x16x64_bf16 v[24:27], v[104:107], a[48:55], v0
  s_add_u32 s27, s27, 8192
  ds_read_b64_tr_b16 v[70:71], v6 offset:24640
  ds_read_b64_tr_b16 v[72:73], v6 offset:24832
  v_smfmac_f32_16x16x64_bf16 v[24:27], v[108:111], a[56:63], v0
  s_add_u32 s28, s28, 8192
  ds_read_b64_tr_b16 v[74:75], v6 offset:24896
  ds_read_b64_tr_b16 v[76:77], v6 offset:25088
  v_smfmac_f32_16x16x64_bf16 v[24:27], v[112:115], a[96:103], v0
  s_nop 0
  ds_read_b64_tr_b16 v[78:79], v6 offset:25152
  ds_read_b64_tr_b16 v[80:81], v6 offset:25344
  v_smfmac_f32_16x16x64_bf16 v[24:27], v[84:87], a[104:111], v0
  ds_read_b64_tr_b16 v[82:83], v6 offset:25408
  v_mov_b64 v[96:97], 0
  v_smfmac_f32_16x16x64_bf16 v[24:27], v[88:91], a[144:151], v0
  s_waitcnt lgkmcnt(8)
  s_barrier
  ds_read_b64_tr_b16 v[116:117], v6 offset:26880
  v_smfmac_f32_16x16x64_bf16 v[24:27], v[100:103], a[152:159], v0
  s_waitcnt lgkmcnt(7)
  ds_read_b64_tr_b16 v[118:119], v6 offset:26944
  v_mfma_f32_16x16x32_bf16 v[16:19], v[36:39], v[68:71], 0
  s_waitcnt lgkmcnt(6)
  ds_read_b64_tr_b16 v[124:125], v6 offset:27136
  ds_read_b64_tr_b16 v[126:127], v6 offset:27200
  v_mfma_f32_16x16x32_bf16 v[16:19], v[40:43], v[72:75], v[16:19]
  s_waitcnt lgkmcnt(6)
  ds_read_b64_tr_b16 v[104:105], v6 offset:27392
  ds_read_b64_tr_b16 v[106:107], v6 offset:27456
  v_mfma_f32_16x16x32_bf16 v[16:19], v[44:47], v[76:79], v[16:19]
  s_waitcnt lgkmcnt(6)
  ds_read_b64_tr_b16 v[108:109], v6 offset:27648
  ds_read_b64_tr_b16 v[110:111], v6 offset:27712
  v_mfma_f32_16x16x32_bf16 v[16:19], v[48:51], v[80:83], v[16:19]
  s_waitcnt lgkmcnt(6)
  v_cvt_pk_bf16_f32 v120, v24, v25
  v_cvt_pk_bf16_f32 v121, v26, v27
  v_mfma_f32_16x16x32_bf16 v[112:115], v[116:119], v[68:71], 0
  s_waitcnt lgkmcnt(4)
  v_mov_b64 v[98:99], 0
  v_mfma_f32_16x16x32_bf16 v[112:115], v[124:127], v[72:75], v[112:115]
  s_waitcnt lgkmcnt(2)
  buffer_store_dwordx4 v[120:123], v2, s[4:7], s29 offen offset:1024 sc1
  v_mov_b64 v[36:37], 0
  v_exp_f32 v100, v16
  v_mfma_f32_16x16x32_bf16 v[112:115], v[104:107], v[76:79], v[112:115]
  s_waitcnt lgkmcnt(0)
  v_exp_f32 v101, v17
  v_mfma_f32_16x16x32_bf16 v[112:115], v[108:111], v[80:83], v[112:115]
  v_exp_f32 v102, v18
  v_mfma_f32_16x16x32_bf16 v[20:23], v[52:55], v[68:71], 0
  v_exp_f32 v103, v19
  v_mfma_f32_16x16x32_bf16 v[20:23], v[56:59], v[72:75], v[20:23]
  v_cvt_pk_bf16_f32 v44, v100, v101
  v_cvt_pk_bf16_f32 v45, v102, v103
  v_mfma_f32_16x16x32_bf16 v[20:23], v[60:63], v[76:79], v[20:23]
  s_add_u32 s29, s29, 131072
  v_exp_f32 v100, v112
  v_mfma_f32_16x16x32_bf16 v[20:23], v[64:67], v[80:83], v[20:23]
  v_exp_f32 v101, v113
  v_exp_f32 v102, v114
  v_exp_f32 v103, v115
  v_cvt_pk_bf16_f32 v84, v100, v101
  v_cvt_pk_bf16_f32 v85, v102, v103
  v_cndmask_b32 v48, v84, 0, s[16:17]
  v_cndmask_b32 v49, v85, 0, s[16:17]
  v_cndmask_b32 v50, 0, v84, s[16:17]
  v_cndmask_b32 v51, 0, v85, s[16:17]
  v_exp_f32 v100, v20
  v_mfma_f32_16x16x16_bf16 v[88:91], v[12:13], v[48:49], 0
  v_exp_f32 v101, v21
  v_mfma_f32_16x16x16_bf16 v[24:27], v[120:121], v[48:49], 0
  v_exp_f32 v102, v22
  v_mfma_f32_16x16x16_bf16 v[116:119], v[120:121], v[50:51], 0
  v_exp_f32 v103, v23
  v_cvt_pk_bf16_f32 v46, v100, v101
  v_cvt_pk_bf16_f32 v47, v102, v103
  v_mov_b64 v[38:39], 0
  s_nop 0
  v_mfma_f32_16x16x32_bf16 v[88:91], v[12:15], v[44:47], v[88:91]
  v_mov_b64 v[40:41], 0
  v_mov_b64 v[42:43], 0
  v_mfma_f32_16x16x32_bf16 v[24:27], v[28:31], v[44:47], v[24:27]
  ds_read_b128 v[52:55], v4 offset:24576
  ds_read_b128 v[56:59], v4 offset:25600
  v_mfma_f32_16x16x32_bf16 v[116:119], v[32:35], v[44:47], v[116:119]
  s_nop 1
T_back_96:
  v_rcp_f32 v89, v88
  v_subrev_u32 v100, s54, v88
  v_cmp_le_u32 vcc, s96, v100
  v_mul_f32 v24, v89, v24
  v_mul_f32 v25, v89, v25
  v_cvt_pk_bf16_f32 v124, v24, v25
  v_pk_mul_f32 v[26:27], v[26:27], v[88:89] op_sel:[0,1] op_sel_hi:[1,1]
  v_pk_mul_f32 v[116:117], v[116:117], v[88:89] op_sel:[0,1] op_sel_hi:[1,1]
  v_pk_mul_f32 v[118:119], v[118:119], v[88:89] op_sel:[0,1] op_sel_hi:[1,1]
  v_cvt_pk_bf16_f32 v125, v26, v27
  v_cvt_pk_bf16_f32 v126, v116, v117
  v_cvt_pk_bf16_f32 v127, v118, v119
  ds_write_b128 v11, v[124:127] offset:29696
  s_cbranch_vccnz T_slow_95
  v_smfmac_f32_16x16x64_bf16 v[92:95], v[124:127], a[160:167], v0
  s_mov_b32 s96, s55
  v_smfmac_f32_16x16x64_bf16 v[96:99], v[124:127], a[168:175], v0
  s_cmp_eq_u32 s14, 63
  v_smfmac_f32_16x16x64_bf16 v[36:39], v[124:127], a[176:183], v0
  s_waitcnt lgkmcnt(0)
  s_barrier
  ds_read_b128 v[104:107], v11 offset:29184
  ds_read_b128 v[108:111], v11 offset:30720
  ds_read_b128 v[68:71], v11 offset:30208
  s_cbranch_scc1 M_tdone
  v_smfmac_f32_16x16x64_bf16 v[40:43], v[124:127], a[184:191], v0
  s_waitcnt lgkmcnt(2)
  v_smfmac_f32_16x16x64_bf16 v[92:95], v[104:107], a[192:199], v0
  s_waitcnt lgkmcnt(1)
  ds_read_b128 v[76:79], v4 offset:28672
  v_smfmac_f32_16x16x64_bf16 v[92:95], v[108:111], a[224:231], v0
  s_waitcnt lgkmcnt(1)
  ds_read_b128 v[80:83], v4 offset:29696
  v_smfmac_f32_16x16x64_bf16 v[92:95], v[68:71], a[240:247], v0
  ds_read_b128 v[60:63], v4 offset:26624
  v_smfmac_f32_16x16x64_bf16 v[96:99], v[104:107], a[200:207], v0
  ds_read_b128 v[64:67], v4 offset:27648
  v_smfmac_f32_16x16x64_bf16 v[96:99], v[108:111], a[232:239], v0
  ds_read_b128 v[28:31], v4 offset:30720
  s_nop 0
  v_cvt_pk_bf16_f32 v16, v92, v93
  v_cvt_pk_bf16_f32 v17, v94, v95
  v_bfi_b32 v16, 1, s57, v16
  v_smfmac_f32_16x16x64_bf16 v[96:99], v[68:71], a[248:255], v0
  buffer_store_dwordx2 v[16:17], v7, s[4:7], s20 offen offset:0 sc1
  v_smfmac_f32_16x16x64_bf16 v[36:39], v[104:107], a[208:215], v0
  ds_read_b128 v[32:35], v4 offset:31744
  v_smfmac_f32_16x16x64_bf16 v[36:39], v[108:111], v[52:59], v0
  s_waitcnt lgkmcnt(4)
  s_nop 0
  v_cvt_pk_bf16_f32 v18, v96, v97
  v_cvt_pk_bf16_f32 v19, v98, v99
  v_bfi_b32 v18, 1, s57, v18
  v_smfmac_f32_16x16x64_bf16 v[36:39], v[68:71], v[76:83], v0
  buffer_store_dwordx2 v[18:19], v7, s[4:7], s20 offen offset:64 sc1
  v_smfmac_f32_16x16x64_bf16 v[40:43], v[104:107], a[216:223], v0
  s_waitcnt lgkmcnt(2)
  ds_read_b128 v[116:119], v2 offset:31232
  v_smfmac_f32_16x16x64_bf16 v[40:43], v[108:111], v[60:67], v0
  s_waitcnt lgkmcnt(1)
  s_nop 0
  v_cvt_pk_bf16_f32 v20, v36, v37
  v_cvt_pk_bf16_f32 v21, v38, v39
  v_bfi_b32 v20, 1, s57, v20
  v_smfmac_f32_16x16x64_bf16 v[40:43], v[68:71], v[28:35], v0
  buffer_store_dwordx2 v[20:21], v7, s[4:7], s21 offen offset:0 sc1
  s_nop 6
  v_cvt_pk_bf16_f32 v22, v40, v41
  v_cvt_pk_bf16_f32 v23, v42, v43
  v_bfi_b32 v22, 1, s57, v22
  buffer_store_dwordx2 v[22:23], v7, s[4:7], s21 offen offset:64 sc1
  ds_read_b128 v[68:71], v4 offset:0
  ds_read_b128 v[72:75], v4 offset:1024
  ds_read_b128 v[76:79], v4 offset:4096
  ds_read_b128 v[80:83], v4 offset:5120
  ds_read_b128 v[84:87], v4 offset:8192
  ds_read_b128 v[88:91], v4 offset:9216
  ds_read_b128 v[92:95], v4 offset:2048
  ds_read_b128 v[96:99], v4 offset:3072
  ds_read_b128 v[100:103], v4 offset:6144
  ds_read_b128 v[104:107], v4 offset:7168
  ds_read_b128 v[108:111], v4 offset:10240
  ds_read_b128 v[112:115], v4 offset:11264
  v_mov_b64 v[16:17], 0
  v_mov_b64 v[18:19], 0
  v_mov_b64 v[20:21], 0
  v_mov_b64 v[22:23], 0
  v_mov_b64 v[24:25], 0
  v_mov_b64 v[26:27], 0
  s_mov_b32 s19, 0
  v_mov_b32 v49, -1
  ds_read_b64 v[44:45], v2 offset:32256
  s_waitcnt lgkmcnt(0)
  v_readfirstlane_b32 s38, v44
  v_readfirstlane_b32 s37, v45
  s_nop 0
  s_lshl_b32 s38, s38, 1
  s_lshl1_add_u32 s37, s37, 1
  s_min_u32 s38, s38, s37
  s_cmp_ge_u32 s38, 64
  s_cselect_b32 s38, 100, s38
  s_sub_u32 s38, s38, 1
  s_max_i32 s30, s30, s38
  s_waitcnt vmcnt(0)
  buffer_load_dwordx4 v[52:55], v2, s[4:7], s22 offen offset:0 sc1
  buffer_load_dwordx4 v[56:59], v2, s[4:7], s22 offen offset:1024 sc1
  buffer_load_dwordx4 v[60:63], v2, s[4:7], s22 offen offset:2048 sc1
  buffer_load_dwordx4 v[64:67], v2, s[4:7], s22 offen offset:3072 sc1
  s_waitcnt lgkmcnt(12)
  s_waitcnt vmcnt(3)
  v_mfma_f32_16x16x32_bf16 v[120:123], v[116:119], v[52:55], 0
  v_xor_b32 v48, s57, v52
  v_bitop3_b32 v48, v48, v54, s57 bitop3:0xf6
  s_waitcnt vmcnt(2)
  v_mfma_f32_16x16x32_bf16 v[120:123], v[116:119], v[56:59], v[120:123]
  v_bitop3_b32 v48, v48, v56, s57 bitop3:0xf6
  v_bitop3_b32 v48, v48, v58, s57 bitop3:0xf6
  s_waitcnt vmcnt(1)
  v_mfma_f32_16x16x32_bf16 v[120:123], v[116:119], v[60:63], v[120:123]
  v_bitop3_b32 v48, v48, v60, s57 bitop3:0xf6
  v_bitop3_b32 v48, v48, v62, s57 bitop3:0xf6
  s_waitcnt vmcnt(0)
  v_mfma_f32_16x16x32_bf16 v[120:123], v[116:119], v[64:67], v[120:123]
  v_bitop3_b32 v48, v48, v64, s57 bitop3:0xf6
  v_bitop3_b32 v48, v48, v66, s57 bitop3:0xf6
  v_and_b32 v48, 1, v48
  v_cmp_ne_u32 vcc, 0, v48
  s_cbranch_vccnz T_p1re_98
T_p1ok_99:
  s_nop 2
  v_add_f32_dpp v120, v120, v120 row_ror:8 row_mask:0xf bank_mask:0xf
  v_add_f32_dpp v121, v121, v121 row_ror:8 row_mask:0xf bank_mask:0xf
  v_cvt_pk_bf16_f32 v48, v120, v121
  buffer_store_dword v48, v8, s[4:7], s35 offen sc1
  buffer_store_dword v49, v8, s[4:7], s26 offen sc1
  s_barrier
  ds_read_b128 v[28:31], v2 offset:17408
  ds_read_b128 v[32:35], v2 offset:21504
  ds_read_b128 v[36:39], v2 offset:8192
  ds_read_b128 v[40:43], v2 offset:9216
  ds_read_b128 v[44:47], v2 offset:10240
  ds_read_b128 v[48:51], v2 offset:11264
  buffer_load_dwordx4 v[124:127], v2, s[4:7], s24 offen offset:1024 sc1
  buffer_load_dwordx4 v[116:119], v2, s[4:7], s25 offen offset:1024 sc1
  ds_read_b128 v[52:55], v2 offset:12288
  ds_read_b128 v[56:59], v2 offset:13312
  ds_read_b128 v[60:63], v2 offset:14336
  ds_read_b128 v[64:67], v2 offset:15360
  buffer_load_dwordx4 v[124:127], v2, s[4:7], s24 offen offset:1024 sc1
  buffer_load_dwordx4 v[116:119], v2, s[4:7], s25 offen offset:1024 sc1
  s_add_u32 s14, s14, 1
  s_cmp_ge_i32 s14, s30
  s_cbranch_scc1 T_kvw_92
T_kvb_93:
  s_mov_b32 s19, 0
  s_branch T_loop_88
T_p1re_98:
  s_mov_b64 exec, vcc
  buffer_load_dwordx4 v[52:55], v2, s[4:7], s22 offen offset:0 sc1
  buffer_load_dwordx4 v[56:59], v2, s[4:7], s22 offen offset:1024 sc1
  buffer_load_dwordx4 v[60:63], v2, s[4:7], s22 offen offset:2048 sc1
  buffer_load_dwordx4 v[64:67], v2, s[4:7], s22 offen offset:3072 sc1
  s_mov_b64 exec, -1
  s_add_u32 s19, s19, 1
  s_cmp_gt_u32 s19, 32768
  s_cbranch_scc1 M_exit
  s_waitcnt vmcnt(3)
  v_mfma_f32_16x16x32_bf16 v[120:123], v[116:119], v[52:55], 0
  v_xor_b32 v48, s57, v52
  v_bitop3_b32 v48, v48, v54, s57 bitop3:0xf6
  s_waitcnt vmcnt(2)
  v_mfma_f32_16x16x32_bf16 v[120:123], v[116:119], v[56:59], v[120:123]
  v_bitop3_b32 v48, v48, v56, s57 bitop3:0xf6
  v_bitop3_b32 v48, v48, v58, s57 bitop3:0xf6
  s_waitcnt vmcnt(1)
  v_mfma_f32_16x16x32_bf16 v[120:123], v[116:119], v[60:63], v[120:123]
  v_bitop3_b32 v48, v48, v60, s57 bitop3:0xf6
  v_bitop3_b32 v48, v48, v62, s57 bitop3:0xf6
  s_waitcnt vmcnt(0)
  v_mfma_f32_16x16x32_bf16 v[120:123], v[116:119], v[64:67], v[120:123]
  v_bitop3_b32 v48, v48, v64, s57 bitop3:0xf6
  v_bitop3_b32 v48, v48, v66, s57 bitop3:0xf6
  v_and_b32 v48, 1, v48
  v_cmp_ne_u32 vcc, 0, v48
  s_cbranch_vccnz T_p1re_98
  s_branch T_p1ok_99
T_kvw_92:
  s_mov_b32 s19, 0
  s_branch T_kvok_101
T_kv_100:
  s_sleep 4
  s_add_u32 s19, s19, 1
  s_cmp_gt_u32 s19, 32768
  s_cbranch_scc1 M_exit
T_kvok_101:
  s_add_u32 s39, s99, 128
  s_mov_b32 s38, 0
  s_mov_b32 s37, 0
  s_atomic_or s38, s[58:59], s99 glc
  s_atomic_or s37, s[58:59], s39 glc
  s_waitcnt lgkmcnt(0)
  s_lshl_b32 s38, s38, 1
  s_lshl1_add_u32 s37, s37, 1
  s_min_u32 s38, s38, s37
  s_cmp_ge_u32 s38, 64
  s_cselect_b32 s38, 100, s38
  s_sub_u32 s38, s38, 1
  s_max_i32 s30, s30, s38
  s_cmp_ge_i32 s14, s30
  s_cbranch_scc1 T_kv_100
  s_branch T_kvb_93
T_slow_95:
  s_nop 7
  v_max3_f32 v100, v16, v17, v18
  v_max3_f32 v100, v100, v19, v20
  v_max3_f32 v100, v100, v21, v22
  v_max3_f32 v100, v100, v23, v112
  v_max3_f32 v100, v100, v113, v114
  v_max_f32 v100, v100, v115
  v_mov_b32 v101, v100
  s_nop 1
  v_permlane32_swap_b32 v100, v101
  s_nop 1
  v_max_f32 v100, v100, v101
  v_mov_b32 v101, v100
  s_nop 1
  v_permlane16_swap_b32 v100, v101
  s_nop 1
  v_max_f32 v100, v100, v101
  v_sub_f32 v16, v16, v100
  v_sub_f32 v17, v17, v100
  v_sub_f32 v18, v18, v100
  v_sub_f32 v19, v19, v100
  v_exp_f32 v16, v16
  v_exp_f32 v17, v17
  v_exp_f32 v18, v18
  v_exp_f32 v19, v19
  v_sub_f32 v20, v20, v100
  v_sub_f32 v21, v21, v100
  v_sub_f32 v22, v22, v100
  v_sub_f32 v23, v23, v100
  v_exp_f32 v20, v20
  v_exp_f32 v21, v21
  v_exp_f32 v22, v22
  v_exp_f32 v23, v23
  v_sub_f32 v112, v112, v100
  v_sub_f32 v113, v113, v100
  v_sub_f32 v114, v114, v100
  v_sub_f32 v115, v115, v100
  v_exp_f32 v112, v112
  v_exp_f32 v113, v113
  v_exp_f32 v114, v114
  v_exp_f32 v115, v115
  s_nop 0
  v_cvt_pk_bf16_f32 v44, v16, v17
  v_cvt_pk_bf16_f32 v45, v18, v19
  v_cvt_pk_bf16_f32 v46, v20, v21
  v_cvt_pk_bf16_f32 v47, v22, v23
  v_cvt_pk_bf16_f32 v84, v112, v113
  v_cvt_pk_bf16_f32 v85, v114, v115
  v_cndmask_b32 v48, v84, 0, s[16:17]
  v_cndmask_b32 v49, v85, 0, s[16:17]
  v_cndmask_b32 v50, 0, v84, s[16:17]
  v_cndmask_b32 v51, 0, v85, s[16:17]
  s_nop 1
  v_mfma_f32_16x16x16_bf16 v[88:91], v[12:13], v[48:49], 0
  v_mfma_f32_16x16x16_bf16 v[24:27], v[120:121], v[48:49], 0
  v_mfma_f32_16x16x16_bf16 v[116:119], v[120:121], v[50:51], 0
  v_mfma_f32_16x16x32_bf16 v[88:91], v[12:15], v[44:47], v[88:91]
  v_mfma_f32_16x16x32_bf16 v[24:27], v[28:31], v[44:47], v[24:27]
  v_mfma_f32_16x16x32_bf16 v[116:119], v[32:35], v[44:47], v[116:119]
  s_nop 7
  s_nop 1
  s_mov_b32 s96, -1
  s_branch T_back_96
T_w_72:
  s_mov_b32 s19, 0
  s_add_u32 s14, s14, 1
  s_and_b32 s57, s14, 1
  v_mov_b64 v[16:17], 0
  v_mov_b64 v[18:19], 0
  v_mov_b64 v[20:21], 0
  v_mov_b64 v[22:23], 0
  v_mov_b64 v[24:25], 0
  v_mov_b64 v[26:27], 0
  buffer_load_dwordx4 v[124:127], v2, s[4:7], s24 offen offset:2048 sc1
  buffer_load_dwordx4 v[116:119], v2, s[4:7], s25 offen offset:2048 sc1
  buffer_load_dwordx4 v[124:127], v2, s[4:7], s24 offen offset:2048 sc1
  buffer_load_dwordx4 v[116:119], v2, s[4:7], s25 offen offset:2048 sc1
  s_branch T_loop_102
.p2align 6
T_retry_103:
  s_mov_b64 exec, vcc
  buffer_load_dwordx4 v[124:127], v2, s[4:7], s24 offen offset:2048 sc1
  buffer_load_dwordx4 v[116:119], v2, s[4:7], s25 offen offset:2048 sc1
  s_mov_b64 exec, -1
  s_add_u32 s19, s19, 1
  s_cmp_gt_u32 s19, 32768
  s_cbranch_scc1 M_exit
  s_nop 0
  v_mov_b64 v[16:17], 0
  v_mov_b64 v[18:19], 0
T_loop_102:
  s_waitcnt vmcnt(3) lgkmcnt(0)
  v_max3_u32 v123, v124, v125, v126
  v_max_u32 v123, v123, v127
  v_mov_b32_dpp v120, v124 row_ror:8 row_mask:0xf bank_mask:0xf
  v_mov_b32_dpp v121, v125 row_ror:8 row_mask:0xf bank_mask:0xf
  s_waitcnt vmcnt(2)
  v_max3_u32 v123, v123, v116, v117
  v_max3_u32 v123, v123, v118, v119
  v_cmp_eq_u32 vcc, -1, v123
  v_smfmac_f32_16x16x64_bf16 v[16:19], v[124:127], v[68:75], v0
  s_cbranch_vccnz T_retry_103
  ds_write_b128 v2, v[124:127] offset:2048
  v_mov_b32_dpp v122, v126 row_ror:8 row_mask:0xf bank_mask:0xf
  v_smfmac_f32_16x16x64_bf16 v[20:23], v[124:127], v[76:83], v0
  s_and_b32 s57, s14, 1
  v_mov_b32_dpp v123, v127 row_ror:8 row_mask:0xf bank_mask:0xf
  v_smfmac_f32_16x16x64_bf16 v[24:27], v[124:127], v[84:91], v0
  s_and_b32 s36, s14, 3
  ds_write_b128 v2, v[116:119] offset:6144
  v_smfmac_f32_16x16x64_bf16 v[16:19], v[120:123], v[92:99], v0
  s_lshl_b32 s36, s36, 13
  v_mov_b32_dpp v84, v116 row_ror:8 row_mask:0xf bank_mask:0xf
  v_smfmac_f32_16x16x64_bf16 v[20:23], v[120:123], v[100:107], v0
  s_add_u32 s26, s36, s23
  ds_read_b128 v[68:71], v4 offset:12288
  v_mov_b32_dpp v85, v117 row_ror:8 row_mask:0xf bank_mask:0xf
  v_smfmac_f32_16x16x64_bf16 v[24:27], v[120:123], v[108:115], v0
  s_add_u32 s36, s36, 8192
  ds_read_b128 v[72:75], v4 offset:13312
  v_mov_b32_dpp v86, v118 row_ror:8 row_mask:0xf bank_mask:0xf
  v_smfmac_f32_16x16x64_bf16 v[16:19], v[116:119], v[224:231], v0
  s_and_b32 s36, s36, 0x7fff
  ds_read_b128 v[76:79], v4 offset:14336
  v_mov_b32_dpp v87, v119 row_ror:8 row_mask:0xf bank_mask:0xf
  v_smfmac_f32_16x16x64_bf16 v[20:23], v[116:119], v[240:247], v0
  s_waitcnt lgkmcnt(3)
  s_barrier
  ds_read_b128 v[100:103], v2 offset:3072
  v_smfmac_f32_16x16x64_bf16 v[24:27], v[116:119], a[0:7], v0
  s_mov_b32 m0, s31
  ds_read_b128 v[120:123], v1 offset:3072
  v_smfmac_f32_16x16x64_bf16 v[16:19], v[84:87], v[232:239], v0
  v_smfmac_f32_16x16x64_bf16 v[20:23], v[84:87], v[248:255], v0
  ds_read_b128 v[80:83], v4 offset:15360
  buffer_load_dwordx4 v9, s[4:7], s27 offen sc1 lds
  v_smfmac_f32_16x16x64_bf16 v[24:27], v[84:87], a[8:15], v0
  s_waitcnt lgkmcnt(2)
  s_mov_b32 m0, s32
  v_smfmac_f32_16x16x64_bf16 v[16:19], v[100:103], v[128:135], v0
  ds_read_b128 v[92:95], v2 offset:0
  v_smfmac_f32_16x16x64_bf16 v[20:23], v[100:103], v[144:151], v0
  ds_read_b128 v[96:99], v1 offset:0
  v_smfmac_f32_16x16x64_bf16 v[24:27], v[100:103], v[68:75], v0
  s_waitcnt vmcnt(1) lgkmcnt(3)
  ds_read_b128 v[116:119], v2 offset:1024
  buffer_load_dwordx4 v9, s[4:7], s27 offen offset:128 sc1 lds
  v_smfmac_f32_16x16x64_bf16 v[16:19], v[120:123], v[136:143], v0
  ds_read_b128 v[124:127], v1 offset:1024
  s_mov_b32 m0, s33
  v_smfmac_f32_16x16x64_bf16 v[20:23], v[120:123], v[152:159], v0
  s_waitcnt lgkmcnt(4)
  ds_read_b128 v[104:107], v2 offset:7168
  v_smfmac_f32_16x16x64_bf16 v[24:27], v[120:123], v[76:83], v0
  s_waitcnt lgkmcnt(4)
  ds_read_b128 v[108:111], v1 offset:7168
  v_smfmac_f32_16x16x64_bf16 v[16:19], v[92:95], v[160:167], v0
  s_waitcnt lgkmcnt(4)
  ds_read_b128 v[112:115], v2 offset:4096
  v_mov_b32 v122, s98
  buffer_load_dwordx4 v10, s[4:7], s28 offen sc1 lds
  v_smfmac_f32_16x16x64_bf16 v[16:19], v[96:99], v[168:175], v0
  s_waitcnt lgkmcnt(4)
  ds_read_b128 v[84:87], v1 offset:4096
  s_mov_b32 m0, s34
  v_smfmac_f32_16x16x64_bf16 v[16:19], v[116:119], v[192:199], v0
  s_waitcnt lgkmcnt(4)
  ds_read_b128 v[88:91], v2 offset:5120
  v_smfmac_f32_16x16x64_bf16 v[16:19], v[124:127], v[200:207], v0
  s_waitcnt lgkmcnt(4)
  ds_read_b128 v[100:103], v1 offset:5120
  v_smfmac_f32_16x16x64_bf16 v[16:19], v[104:107], a[16:23], v0
  s_waitcnt lgkmcnt(4)
  ds_read_b128 v[68:71], v4 offset:16384
  buffer_load_dwordx4 v10, s[4:7], s28 offen offset:256 sc1 lds
  v_smfmac_f32_16x16x64_bf16 v[16:19], v[108:111], a[24:31], v0
  s_waitcnt lgkmcnt(4)
  ds_read_b128 v[72:75], v4 offset:17408
  v_smfmac_f32_16x16x64_bf16 v[16:19], v[112:115], a[64:71], v0
  s_waitcnt lgkmcnt(4)
  ds_read_b128 v[76:79], v4 offset:18432
  v_smfmac_f32_16x16x64_bf16 v[16:19], v[84:87], a[72:79], v0
  s_waitcnt lgkmcnt(4)
  ds_read_b128 v[80:83], v4 offset:19456
  v_smfmac_f32_16x16x64_bf16 v[16:19], v[88:91], a[112:119], v0
  s_waitcnt lgkmcnt(4)
  buffer_store_dword v122, v3, s[4:7], s15 offen sc1
  v_smfmac_f32_16x16x64_bf16 v[16:19], v[100:103], a[120:127], v0
  s_add_u32 s98, s14, 1
  s_add_u32 s24, s36, 145752064
  s_add_u32 s25, s36, 145756160
  v_smfmac_f32_16x16x64_bf16 v[20:23], v[92:95], v[176:183], v0
  s_add_u32 s35, s36, s23
  v_smfmac_f32_16x16x64_bf16 v[20:23], v[96:99], v[184:191], v0
  s_waitcnt lgkmcnt(2)
  v_smfmac_f32_16x16x64_bf16 v[20:23], v[116:119], v[68:75], v0
  s_waitcnt lgkmcnt(0)
  ds_read_b128 v[68:71], v4 offset:20480
  v_mul_f32 v16, s18, v16
  v_smfmac_f32_16x16x64_bf16 v[20:23], v[124:127], v[76:83], v0
  ds_read_b128 v[72:75], v4 offset:21504
  v_mul_f32 v17, s18, v17
  v_smfmac_f32_16x16x64_bf16 v[20:23], v[104:107], a[32:39], v0
  ds_read_b128 v[76:79], v4 offset:22528
  v_mul_f32 v18, s18, v18
  v_smfmac_f32_16x16x64_bf16 v[20:23], v[108:111], a[40:47], v0
  ds_read_b128 v[80:83], v4 offset:23552
  v_mul_f32 v19, s18, v19
  v_smfmac_f32_16x16x64_bf16 v[20:23], v[112:115], a[80:87], v0
  v_cvt_pk_bf16_f32 v120, v16, v17
  v_smfmac_f32_16x16x64_bf16 v[20:23], v[84:87], a[88:95], v0
  v_cvt_pk_bf16_f32 v121, v18, v19
  v_smfmac_f32_16x16x64_bf16 v[20:23], v[88:91], a[128:135], v0
  ds_write_b64 v5, v[120:121] offset:24576
  v_smfmac_f32_16x16x64_bf16 v[20:23], v[100:103], a[136:143], v0
  s_waitcnt lgkmcnt(3)
  v_smfmac_f32_16x16x64_bf16 v[24:27], v[92:95], v[68:75], v0
  s_waitcnt lgkmcnt(1)
  v_mov_b64 v[92:93], 0
  v_smfmac_f32_16x16x64_bf16 v[24:27], v[96:99], v[76:83], v0
  s_nop 1
  v_cvt_pk_bf16_f32 v122, v20, v21
  v_cvt_pk_bf16_f32 v123, v22, v23
  v_smfmac_f32_16x16x64_bf16 v[24:27], v[116:119], v[208:215], v0
  ds_write_b64 v5, v[122:123] offset:26880
  v_mov_b64 v[94:95], 0
  v_smfmac_f32_16x16x64_bf16 v[24:27], v[124:127], v[216:223], v0
  s_waitcnt lgkmcnt(1)
  s_barrier
  ds_read_b64_tr_b16 v[68:69], v6 offset:24576
  v_smfmac_f32_16x16x64_bf16 v[24:27], v[104:107], a[48:55], v0
  s_add_u32 s27, s27, 8192
  ds_read_b64_tr_b16 v[70:71], v6 offset:24640
  ds_read_b64_tr_b16 v[72:73], v6 offset:24832
  v_smfmac_f32_16x16x64_bf16 v[24:27], v[108:111], a[56:63], v0
  s_add_u32 s28, s28, 8192
  ds_read_b64_tr_b16 v[74:75], v6 offset:24896
  ds_read_b64_tr_b16 v[76:77], v6 offset:25088
  v_smfmac_f32_16x16x64_bf16 v[24:27], v[112:115], a[96:103], v0
  s_nop 0
  ds_read_b64_tr_b16 v[78:79], v6 offset:25152
  ds_read_b64_tr_b16 v[80:81], v6 offset:25344
  v_smfmac_f32_16x16x64_bf16 v[24:27], v[84:87], a[104:111], v0
  ds_read_b64_tr_b16 v[82:83], v6 offset:25408
  v_mov_b64 v[96:97], 0
  v_smfmac_f32_16x16x64_bf16 v[24:27], v[88:91], a[144:151], v0
  s_waitcnt lgkmcnt(8)
  s_barrier
  ds_read_b64_tr_b16 v[116:117], v6 offset:26880
  v_smfmac_f32_16x16x64_bf16 v[24:27], v[100:103], a[152:159], v0
  s_waitcnt lgkmcnt(7)
  ds_read_b64_tr_b16 v[118:119], v6 offset:26944
  v_mfma_f32_16x16x32_bf16 v[16:19], v[36:39], v[68:71], 0
  s_waitcnt lgkmcnt(6)
  ds_read_b64_tr_b16 v[124:125], v6 offset:27136
  ds_read_b64_tr_b16 v[126:127], v6 offset:27200
  v_mfma_f32_16x16x32_bf16 v[16:19], v[40:43], v[72:75], v[16:19]
  s_waitcnt lgkmcnt(6)
  ds_read_b64_tr_b16 v[104:105], v6 offset:27392
  ds_read_b64_tr_b16 v[106:107], v6 offset:27456
  v_mfma_f32_16x16x32_bf16 v[16:19], v[44:47], v[76:79], v[16:19]
  s_waitcnt lgkmcnt(6)
  ds_read_b64_tr_b16 v[108:109], v6 offset:27648
  ds_read_b64_tr_b16 v[110:111], v6 offset:27712
  v_mfma_f32_16x16x32_bf16 v[16:19], v[48:51], v[80:83], v[16:19]
  s_waitcnt lgkmcnt(6)
  v_cvt_pk_bf16_f32 v120, v24, v25
  v_cvt_pk_bf16_f32 v121, v26, v27
  v_mfma_f32_16x16x32_bf16 v[112:115], v[116:119], v[68:71], 0
  s_waitcnt lgkmcnt(4)
  v_mov_b64 v[98:99], 0
  v_mfma_f32_16x16x32_bf16 v[112:115], v[124:127], v[72:75], v[112:115]
  s_waitcnt lgkmcnt(2)
  v_mov_b64 v[36:37], 0
  v_exp_f32 v100, v16
  v_mfma_f32_16x16x32_bf16 v[112:115], v[104:107], v[76:79], v[112:115]
  s_waitcnt lgkmcnt(0)
  buffer_store_dwordx4 v[120:123], v2, s[4:7], s29 offen offset:2048 sc1
  v_exp_f32 v101, v17
  v_mfma_f32_16x16x32_bf16 v[112:115], v[108:111], v[80:83], v[112:115]
  v_exp_f32 v102, v18
  v_mfma_f32_16x16x32_bf16 v[20:23], v[52:55], v[68:71], 0
  v_exp_f32 v103, v19
  v_mfma_f32_16x16x32_bf16 v[20:23], v[56:59], v[72:75], v[20:23]
  v_cvt_pk_bf16_f32 v44, v100, v101
  v_cvt_pk_bf16_f32 v45, v102, v103
  v_mfma_f32_16x16x32_bf16 v[20:23], v[60:63], v[76:79], v[20:23]
  s_add_u32 s29, s29, 131072
  v_exp_f32 v100, v112
  v_mfma_f32_16x16x32_bf16 v[20:23], v[64:67], v[80:83], v[20:23]
  v_exp_f32 v101, v113
  v_exp_f32 v102, v114
  v_exp_f32 v103, v115
  v_cvt_pk_bf16_f32 v84, v100, v101
  v_cvt_pk_bf16_f32 v85, v102, v103
  v_cndmask_b32 v48, v84, 0, s[16:17]
  v_cndmask_b32 v49, v85, 0, s[16:17]
  v_cndmask_b32 v50, 0, v84, s[16:17]
  v_cndmask_b32 v51, 0, v85, s[16:17]
  v_exp_f32 v100, v20
  v_mfma_f32_16x16x16_bf16 v[88:91], v[12:13], v[48:49], 0
  v_exp_f32 v101, v21
  v_mfma_f32_16x16x16_bf16 v[24:27], v[120:121], v[48:49], 0
  v_exp_f32 v102, v22
  v_mfma_f32_16x16x16_bf16 v[116:119], v[120:121], v[50:51], 0
  v_exp_f32 v103, v23
  v_cvt_pk_bf16_f32 v46, v100, v101
  v_cvt_pk_bf16_f32 v47, v102, v103
  v_mov_b64 v[38:39], 0
  s_nop 0
  v_mfma_f32_16x16x32_bf16 v[88:91], v[12:15], v[44:47], v[88:91]
  v_mov_b64 v[40:41], 0
  v_mov_b64 v[42:43], 0
  v_mfma_f32_16x16x32_bf16 v[24:27], v[28:31], v[44:47], v[24:27]
  ds_read_b128 v[52:55], v4 offset:24576
  ds_read_b128 v[56:59], v4 offset:25600
  v_mfma_f32_16x16x32_bf16 v[116:119], v[32:35], v[44:47], v[116:119]
  s_nop 1
T_back_110:
  v_rcp_f32 v89, v88
  v_subrev_u32 v100, s54, v88
  v_cmp_le_u32 vcc, s96, v100
  v_mul_f32 v24, v89, v24
  v_mul_f32 v25, v89, v25
  v_cvt_pk_bf16_f32 v124, v24, v25
  v_pk_mul_f32 v[26:27], v[26:27], v[88:89] op_sel:[0,1] op_sel_hi:[1,1]
  v_pk_mul_f32 v[116:117], v[116:117], v[88:89] op_sel:[0,1] op_sel_hi:[1,1]
  v_pk_mul_f32 v[118:119], v[118:119], v[88:89] op_sel:[0,1] op_sel_hi:[1,1]
  v_cvt_pk_bf16_f32 v125, v26, v27
  v_cvt_pk_bf16_f32 v126, v116, v117
  v_cvt_pk_bf16_f32 v127, v118, v119
  ds_write_b128 v11, v[124:127] offset:30208
  s_cbranch_vccnz T_slow_109
  v_smfmac_f32_16x16x64_bf16 v[92:95], v[124:127], a[160:167], v0
  s_mov_b32 s96, s55
  v_smfmac_f32_16x16x64_bf16 v[96:99], v[124:127], a[168:175], v0
  s_cmp_eq_u32 s14, 63
  v_smfmac_f32_16x16x64_bf16 v[36:39], v[124:127], a[176:183], v0
  s_waitcnt lgkmcnt(0)
  s_barrier
  ds_read_b128 v[104:107], v11 offset:30720
  ds_read_b128 v[108:111], v11 offset:29184
  ds_read_b128 v[68:71], v11 offset:29696
  s_cbranch_scc1 M_tdone
  v_smfmac_f32_16x16x64_bf16 v[40:43], v[124:127], a[184:191], v0
  s_waitcnt lgkmcnt(2)
  v_smfmac_f32_16x16x64_bf16 v[92:95], v[104:107], a[192:199], v0
  s_waitcnt lgkmcnt(1)
  ds_read_b128 v[76:79], v4 offset:28672
  v_smfmac_f32_16x16x64_bf16 v[92:95], v[108:111], a[224:231], v0
  s_waitcnt lgkmcnt(1)
  ds_read_b128 v[80:83], v4 offset:29696
  v_smfmac_f32_16x16x64_bf16 v[92:95], v[68:71], a[240:247], v0
  ds_read_b128 v[60:63], v4 offset:26624
  v_smfmac_f32_16x16x64_bf16 v[96:99], v[104:107], a[200:207], v0
  ds_read_b128 v[64:67], v4 offset:27648
  v_smfmac_f32_16x16x64_bf16 v[96:99], v[108:111], a[232:239], v0
  ds_read_b128 v[28:31], v4 offset:30720
  s_nop 0
  v_cvt_pk_bf16_f32 v16, v92, v93
  v_cvt_pk_bf16_f32 v17, v94, v95
  v_bfi_b32 v16, 1, s57, v16
  v_smfmac_f32_16x16x64_bf16 v[96:99], v[68:71], a[248:255], v0
  buffer_store_dwordx2 v[16:17], v7, s[4:7], s20 offen offset:0 sc1
  v_smfmac_f32_16x16x64_bf16 v[36:39], v[104:107], a[208:215], v0
  ds_read_b128 v[32:35], v4 offset:31744
  v_smfmac_f32_16x16x64_bf16 v[36:39], v[108:111], v[52:59], v0
  s_waitcnt lgkmcnt(4)
  s_nop 0
  v_cvt_pk_bf16_f32 v18, v96, v97
  v_cvt_pk_bf16_f32 v19, v98, v99
  v_bfi_b32 v18, 1, s57, v18
  v_smfmac_f32_16x16x64_bf16 v[36:39], v[68:71], v[76:83], v0
  buffer_store_dwordx2 v[18:19], v7, s[4:7], s20 offen offset:64 sc1
  v_smfmac_f32_16x16x64_bf16 v[40:43], v[104:107], a[216:223], v0
  s_waitcnt lgkmcnt(2)
  v_smfmac_f32_16x16x64_bf16 v[40:43], v[108:111], v[60:67], v0
  s_waitcnt lgkmcnt(0)
  s_nop 0
  v_cvt_pk_bf16_f32 v20, v36, v37
  v_cvt_pk_bf16_f32 v21, v38, v39
  v_bfi_b32 v20, 1, s57, v20
  v_smfmac_f32_16x16x64_bf16 v[40:43], v[68:71], v[28:35], v0
  buffer_store_dwordx2 v[20:21], v7, s[4:7], s21 offen offset:0 sc1
  s_nop 6
  v_cvt_pk_bf16_f32 v22, v40, v41
  v_cvt_pk_bf16_f32 v23, v42, v43
  v_bfi_b32 v22, 1, s57, v22
  buffer_store_dwordx2 v[22:23], v7, s[4:7], s21 offen offset:64 sc1
  ds_read_b128 v[68:71], v4 offset:0
  ds_read_b128 v[72:75], v4 offset:1024
  ds_read_b128 v[76:79], v4 offset:4096
  ds_read_b128 v[80:83], v4 offset:5120
  ds_read_b128 v[84:87], v4 offset:8192
  ds_read_b128 v[88:91], v4 offset:9216
  ds_read_b128 v[92:95], v4 offset:2048
  ds_read_b128 v[96:99], v4 offset:3072
  ds_read_b128 v[100:103], v4 offset:6144
  ds_read_b128 v[104:107], v4 offset:7168
  ds_read_b128 v[108:111], v4 offset:10240
  ds_read_b128 v[112:115], v4 offset:11264
  v_mov_b64 v[16:17], 0
  v_mov_b64 v[18:19], 0
  v_mov_b64 v[20:21], 0
  v_mov_b64 v[22:23], 0
  v_mov_b64 v[24:25], 0
  v_mov_b64 v[26:27], 0
  ds_read_b64 v[44:45], v2 offset:32256
  s_waitcnt lgkmcnt(0)
  v_readfirstlane_b32 s38, v44
  v_readfirstlane_b32 s37, v45
  s_nop 0
  s_lshl_b32 s38, s38, 1
  s_lshl1_add_u32 s37, s37, 1
  s_min_u32 s38, s38, s37
  s_cmp_ge_u32 s38, 64
  s_cselect_b32 s38, 100, s38
  s_sub_u32 s38, s38, 1
  s_max_i32 s30, s30, s38
  s_waitcnt vmcnt(4)
  s_barrier
  ds_read_b128 v[28:31], v2 offset:18432
  ds_read_b128 v[32:35], v2 offset:22528
  ds_read_b128 v[36:39], v2 offset:8192
  ds_read_b128 v[40:43], v2 offset:9216
  ds_read_b128 v[44:47], v2 offset:10240
  ds_read_b128 v[48:51], v2 offset:11264
  buffer_load_dwordx4 v[124:127], v2, s[4:7], s24 offen offset:2048 sc1
  buffer_load_dwordx4 v[116:119], v2, s[4:7], s25 offen offset:2048 sc1
  ds_read_b128 v[52:55], v2 offset:12288
  ds_read_b128 v[56:59], v2 offset:13312
  ds_read_b128 v[60:63], v2 offset:14336
  ds_read_b128 v[64:67], v2 offset:15360
  buffer_load_dwordx4 v[124:127], v2, s[4:7], s24 offen offset:2048 sc1
  buffer_load_dwordx4 v[116:119], v2, s[4:7], s25 offen offset:2048 sc1
  s_add_u32 s14, s14, 1
  s_cmp_ge_i32 s14, s30
  s_cbranch_scc1 T_kvw_106
T_kvb_107:
  s_mov_b32 s19, 0
  s_branch T_loop_102
T_kvw_106:
  s_mov_b32 s19, 0
  s_branch T_kvok_115
T_kv_114:
  s_sleep 4
  s_add_u32 s19, s19, 1
  s_cmp_gt_u32 s19, 32768
  s_cbranch_scc1 M_exit
T_kvok_115:
  s_add_u32 s39, s99, 128
  s_mov_b32 s38, 0
  s_mov_b32 s37, 0
  s_atomic_or s38, s[58:59], s99 glc
  s_atomic_or s37, s[58:59], s39 glc
  s_waitcnt lgkmcnt(0)
  s_lshl_b32 s38, s38, 1
  s_lshl1_add_u32 s37, s37, 1
  s_min_u32 s38, s38, s37
  s_cmp_ge_u32 s38, 64
  s_cselect_b32 s38, 100, s38
  s_sub_u32 s38, s38, 1
  s_max_i32 s30, s30, s38
  s_cmp_ge_i32 s14, s30
  s_cbranch_scc1 T_kv_114
  s_branch T_kvb_107
T_slow_109:
  s_nop 7
  v_max3_f32 v100, v16, v17, v18
  v_max3_f32 v100, v100, v19, v20
  v_max3_f32 v100, v100, v21, v22
  v_max3_f32 v100, v100, v23, v112
  v_max3_f32 v100, v100, v113, v114
  v_max_f32 v100, v100, v115
  v_mov_b32 v101, v100
  s_nop 1
  v_permlane32_swap_b32 v100, v101
  s_nop 1
  v_max_f32 v100, v100, v101
  v_mov_b32 v101, v100
  s_nop 1
  v_permlane16_swap_b32 v100, v101
  s_nop 1
  v_max_f32 v100, v100, v101
  v_sub_f32 v16, v16, v100
  v_sub_f32 v17, v17, v100
  v_sub_f32 v18, v18, v100
  v_sub_f32 v19, v19, v100
  v_exp_f32 v16, v16
  v_exp_f32 v17, v17
  v_exp_f32 v18, v18
  v_exp_f32 v19, v19
  v_sub_f32 v20, v20, v100
  v_sub_f32 v21, v21, v100
  v_sub_f32 v22, v22, v100
  v_sub_f32 v23, v23, v100
  v_exp_f32 v20, v20
  v_exp_f32 v21, v21
  v_exp_f32 v22, v22
  v_exp_f32 v23, v23
  v_sub_f32 v112, v112, v100
  v_sub_f32 v113, v113, v100
  v_sub_f32 v114, v114, v100
  v_sub_f32 v115, v115, v100
  v_exp_f32 v112, v112
  v_exp_f32 v113, v113
  v_exp_f32 v114, v114
  v_exp_f32 v115, v115
  s_nop 0
  v_cvt_pk_bf16_f32 v44, v16, v17
  v_cvt_pk_bf16_f32 v45, v18, v19
  v_cvt_pk_bf16_f32 v46, v20, v21
  v_cvt_pk_bf16_f32 v47, v22, v23
  v_cvt_pk_bf16_f32 v84, v112, v113
  v_cvt_pk_bf16_f32 v85, v114, v115
  v_cndmask_b32 v48, v84, 0, s[16:17]
  v_cndmask_b32 v49, v85, 0, s[16:17]
  v_cndmask_b32 v50, 0, v84, s[16:17]
  v_cndmask_b32 v51, 0, v85, s[16:17]
  s_nop 1
  v_mfma_f32_16x16x16_bf16 v[88:91], v[12:13], v[48:49], 0
  v_mfma_f32_16x16x16_bf16 v[24:27], v[120:121], v[48:49], 0
  v_mfma_f32_16x16x16_bf16 v[116:119], v[120:121], v[50:51], 0
  v_mfma_f32_16x16x32_bf16 v[88:91], v[12:15], v[44:47], v[88:91]
  v_mfma_f32_16x16x32_bf16 v[24:27], v[28:31], v[44:47], v[24:27]
  v_mfma_f32_16x16x32_bf16 v[116:119], v[32:35], v[44:47], v[116:119]
  s_nop 7
  s_nop 1
  s_mov_b32 s96, -1
  s_branch T_back_110
T_w_73:
  s_mov_b32 s19, 0
  s_add_u32 s14, s14, 1
  s_and_b32 s57, s14, 1
  v_mov_b64 v[16:17], 0
  v_mov_b64 v[18:19], 0
  v_mov_b64 v[20:21], 0
  v_mov_b64 v[22:23], 0
  v_mov_b64 v[24:25], 0
  v_mov_b64 v[26:27], 0
  buffer_load_dwordx4 v[124:127], v2, s[4:7], s24 offen offset:3072 sc1
  buffer_load_dwordx4 v[116:119], v2, s[4:7], s25 offen offset:3072 sc1
  buffer_load_dwordx4 v[124:127], v2, s[4:7], s24 offen offset:3072 sc1
  buffer_load_dwordx4 v[116:119], v2, s[4:7], s25 offen offset:3072 sc1
  s_branch T_loop_116
.p2align 6
T_retry_117:
  s_mov_b64 exec, vcc
  buffer_load_dwordx4 v[124:127], v2, s[4:7], s24 offen offset:3072 sc1
  buffer_load_dwordx4 v[116:119], v2, s[4:7], s25 offen offset:3072 sc1
  s_mov_b64 exec, -1
  s_add_u32 s19, s19, 1
  s_cmp_gt_u32 s19, 32768
  s_cbranch_scc1 M_exit
  s_nop 0
  v_mov_b64 v[16:17], 0
  v_mov_b64 v[18:19], 0
T_loop_116:
  s_waitcnt vmcnt(3) lgkmcnt(0)
  v_max3_u32 v123, v124, v125, v126
  v_max_u32 v123, v123, v127
  v_mov_b32_dpp v120, v124 row_ror:8 row_mask:0xf bank_mask:0xf
  v_mov_b32_dpp v121, v125 row_ror:8 row_mask:0xf bank_mask:0xf
  s_waitcnt vmcnt(2)
  v_max3_u32 v123, v123, v116, v117
  v_max3_u32 v123, v123, v118, v119
  v_cmp_eq_u32 vcc, -1, v123
  v_smfmac_f32_16x16x64_bf16 v[16:19], v[124:127], v[68:75], v0
  s_cbranch_vccnz T_retry_117
  ds_write_b128 v2, v[124:127] offset:3072
  v_mov_b32_dpp v122, v126 row_ror:8 row_mask:0xf bank_mask:0xf
  v_smfmac_f32_16x16x64_bf16 v[20:23], v[124:127], v[76:83], v0
  s_and_b32 s57, s14, 1
  v_mov_b32_dpp v123, v127 row_ror:8 row_mask:0xf bank_mask:0xf
  v_smfmac_f32_16x16x64_bf16 v[24:27], v[124:127], v[84:91], v0
  s_and_b32 s36, s14, 3
  ds_write_b128 v2, v[116:119] offset:7168
  v_smfmac_f32_16x16x64_bf16 v[16:19], v[120:123], v[92:99], v0
  s_lshl_b32 s36, s36, 13
  v_mov_b32_dpp v84, v116 row_ror:8 row_mask:0xf bank_mask:0xf
  v_smfmac_f32_16x16x64_bf16 v[20:23], v[120:123], v[100:107], v0
  s_add_u32 s26, s36, s23
  ds_read_b128 v[68:71], v4 offset:12288
  v_mov_b32_dpp v85, v117 row_ror:8 row_mask:0xf bank_mask:0xf
  v_smfmac_f32_16x16x64_bf16 v[24:27], v[120:123], v[108:115], v0
  s_add_u32 s36, s36, 8192
  ds_read_b128 v[72:75], v4 offset:13312
  v_mov_b32_dpp v86, v118 row_ror:8 row_mask:0xf bank_mask:0xf
  v_smfmac_f32_16x16x64_bf16 v[16:19], v[116:119], v[224:231], v0
  s_and_b32 s36, s36, 0x7fff
  ds_read_b128 v[76:79], v4 offset:14336
  v_mov_b32_dpp v87, v119 row_ror:8 row_mask:0xf bank_mask:0xf
  v_smfmac_f32_16x16x64_bf16 v[20:23], v[116:119], v[240:247], v0
  s_waitcnt lgkmcnt(3)
  s_barrier
  ds_read_b128 v[100:103], v2 offset:2048
  v_smfmac_f32_16x16x64_bf16 v[24:27], v[116:119], a[0:7], v0
  s_mov_b32 m0, s31
  ds_read_b128 v[120:123], v1 offset:2048
  v_smfmac_f32_16x16x64_bf16 v[16:19], v[84:87], v[232:239], v0
  v_smfmac_f32_16x16x64_bf16 v[20:23], v[84:87], v[248:255], v0
  ds_read_b128 v[80:83], v4 offset:15360
  v_smfmac_f32_16x16x64_bf16 v[24:27], v[84:87], a[8:15], v0
  s_waitcnt lgkmcnt(2)
  buffer_load_dwordx4 v9, s[4:7], s27 offen sc1 lds
  v_smfmac_f32_16x16x64_bf16 v[16:19], v[100:103], v[128:135], v0
  ds_read_b128 v[92:95], v2 offset:1024
  s_mov_b32 m0, s32
  v_smfmac_f32_16x16x64_bf16 v[20:23], v[100:103], v[144:151], v0
  ds_read_b128 v[96:99], v1 offset:1024
  v_smfmac_f32_16x16x64_bf16 v[24:27], v[100:103], v[68:75], v0
  s_waitcnt vmcnt(1) lgkmcnt(3)
  ds_read_b128 v[116:119], v2 offset:0
  v_smfmac_f32_16x16x64_bf16 v[16:19], v[120:123], v[136:143], v0
  ds_read_b128 v[124:127], v1 offset:0
  buffer_load_dwordx4 v9, s[4:7], s27 offen offset:128 sc1 lds
  v_smfmac_f32_16x16x64_bf16 v[20:23], v[120:123], v[152:159], v0
  s_waitcnt lgkmcnt(4)
  ds_read_b128 v[104:107], v2 offset:6144
  s_mov_b32 m0, s33
  v_smfmac_f32_16x16x64_bf16 v[24:27], v[120:123], v[76:83], v0
  s_waitcnt lgkmcnt(4)
  ds_read_b128 v[108:111], v1 offset:6144
  v_smfmac_f32_16x16x64_bf16 v[16:19], v[92:95], v[160:167], v0
  s_waitcnt lgkmcnt(4)
  ds_read_b128 v[112:115], v2 offset:5120
  v_smfmac_f32_16x16x64_bf16 v[16:19], v[96:99], v[168:175], v0
  s_waitcnt lgkmcnt(4)
  ds_read_b128 v[84:87], v1 offset:5120
  buffer_load_dwordx4 v10, s[4:7], s28 offen sc1 lds
  v_smfmac_f32_16x16x64_bf16 v[16:19], v[116:119], v[192:199], v0
  s_waitcnt lgkmcnt(4)
  ds_read_b128 v[88:91], v2 offset:4096
  s_mov_b32 m0, s34
  v_smfmac_f32_16x16x64_bf16 v[16:19], v[124:127], v[200:207], v0
  s_waitcnt lgkmcnt(4)
  ds_read_b128 v[100:103], v1 offset:4096
  v_smfmac_f32_16x16x64_bf16 v[16:19], v[104:107], a[16:23], v0
  s_waitcnt lgkmcnt(4)
  ds_read_b128 v[68:71], v4 offset:16384
  v_smfmac_f32_16x16x64_bf16 v[16:19], v[108:111], a[24:31], v0
  s_waitcnt lgkmcnt(4)
  ds_read_b128 v[72:75], v4 offset:17408
  buffer_load_dwordx4 v10, s[4:7], s28 offen offset:256 sc1 lds
  v_smfmac_f32_16x16x64_bf16 v[16:19], v[112:115], a[64:71], v0
  s_waitcnt lgkmcnt(4)
  ds_read_b128 v[76:79], v4 offset:18432
  s_mov_b32 m0, 32256
  v_smfmac_f32_16x16x64_bf16 v[16:19], v[84:87], a[72:79], v0
  s_waitcnt lgkmcnt(4)
  ds_read_b128 v[80:83], v4 offset:19456
  v_smfmac_f32_16x16x64_bf16 v[16:19], v[88:91], a[112:119], v0
  s_waitcnt lgkmcnt(4)
  v_smfmac_f32_16x16x64_bf16 v[16:19], v[100:103], a[120:127], v0
  buffer_load_dword v3, s[4:7], s99 offen sc1 lds
  s_add_u32 s24, s36, 145752064
  s_add_u32 s25, s36, 145756160
  v_smfmac_f32_16x16x64_bf16 v[20:23], v[92:95], v[176:183], v0
  s_add_u32 s35, s36, s23
  v_smfmac_f32_16x16x64_bf16 v[20:23], v[96:99], v[184:191], v0
  s_waitcnt lgkmcnt(2)
  v_smfmac_f32_16x16x64_bf16 v[20:23], v[116:119], v[68:75], v0
  s_waitcnt lgkmcnt(0)
  ds_read_b128 v[68:71], v4 offset:20480
  v_mul_f32 v16, s18, v16
  v_smfmac_f32_16x16x64_bf16 v[20:23], v[124:127], v[76:83], v0
  ds_read_b128 v[72:75], v4 offset:21504
  v_mul_f32 v17, s18, v17
  v_smfmac_f32_16x16x64_bf16 v[20:23], v[104:107], a[32:39], v0
  ds_read_b128 v[76:79], v4 offset:22528
  v_mul_f32 v18, s18, v18
  v_smfmac_f32_16x16x64_bf16 v[20:23], v[108:111], a[40:47], v0
  ds_read_b128 v[80:83], v4 offset:23552
  v_mul_f32 v19, s18, v19
  v_smfmac_f32_16x16x64_bf16 v[20:23], v[112:115], a[80:87], v0
  v_cvt_pk_bf16_f32 v120, v16, v17
  v_smfmac_f32_16x16x64_bf16 v[20:23], v[84:87], a[88:95], v0
  v_cvt_pk_bf16_f32 v121, v18, v19
  v_smfmac_f32_16x16x64_bf16 v[20:23], v[88:91], a[128:135], v0
  ds_write_b64 v5, v[120:121] offset:24576
  v_smfmac_f32_16x16x64_bf16 v[20:23], v[100:103], a[136:143], v0
  s_waitcnt lgkmcnt(3)
  v_smfmac_f32_16x16x64_bf16 v[24:27], v[92:95], v[68:75], v0
  s_waitcnt lgkmcnt(1)
  v_mov_b64 v[92:93], 0
  v_smfmac_f32_16x16x64_bf16 v[24:27], v[96:99], v[76:83], v0
  s_nop 1
  v_cvt_pk_bf16_f32 v122, v20, v21
  v_cvt_pk_bf16_f32 v123, v22, v23
  v_smfmac_f32_16x16x64_bf16 v[24:27], v[116:119], v[208:215], v0
  ds_write_b64 v5, v[122:123] offset:26880
  v_mov_b64 v[94:95], 0
  v_smfmac_f32_16x16x64_bf16 v[24:27], v[124:127], v[216:223], v0
  s_waitcnt lgkmcnt(1)
  s_barrier
  ds_read_b64_tr_b16 v[68:69], v6 offset:24576
  v_smfmac_f32_16x16x64_bf16 v[24:27], v[104:107], a[48:55], v0
  s_add_u32 s27, s27, 8192
  ds_read_b64_tr_b16 v[70:71], v6 offset:24640
  ds_read_b64_tr_b16 v[72:73], v6 offset:24832
  v_smfmac_f32_16x16x64_bf16 v[24:27], v[108:111], a[56:63], v0
  s_add_u32 s28, s28, 8192
  ds_read_b64_tr_b16 v[74:75], v6 offset:24896
  ds_read_b64_tr_b16 v[76:77], v6 offset:25088
  v_smfmac_f32_16x16x64_bf16 v[24:27], v[112:115], a[96:103], v0
  s_nop 0
  ds_read_b64_tr_b16 v[78:79], v6 offset:25152
  ds_read_b64_tr_b16 v[80:81], v6 offset:25344
  v_smfmac_f32_16x16x64_bf16 v[24:27], v[84:87], a[104:111], v0
  ds_read_b64_tr_b16 v[82:83], v6 offset:25408
  v_mov_b64 v[96:97], 0
  v_smfmac_f32_16x16x64_bf16 v[24:27], v[88:91], a[144:151], v0
  s_waitcnt lgkmcnt(8)
  s_barrier
  ds_read_b64_tr_b16 v[116:117], v6 offset:26880
  v_smfmac_f32_16x16x64_bf16 v[24:27], v[100:103], a[152:159], v0
  s_waitcnt lgkmcnt(7)
  ds_read_b64_tr_b16 v[118:119], v6 offset:26944
  v_mfma_f32_16x16x32_bf16 v[16:19], v[36:39], v[68:71], 0
  s_waitcnt lgkmcnt(6)
  ds_read_b64_tr_b16 v[124:125], v6 offset:27136
  ds_read_b64_tr_b16 v[126:127], v6 offset:27200
  v_mfma_f32_16x16x32_bf16 v[16:19], v[40:43], v[72:75], v[16:19]
  s_waitcnt lgkmcnt(6)
  ds_read_b64_tr_b16 v[104:105], v6 offset:27392
  ds_read_b64_tr_b16 v[106:107], v6 offset:27456
  v_mfma_f32_16x16x32_bf16 v[16:19], v[44:47], v[76:79], v[16:19]
  s_waitcnt lgkmcnt(6)
  ds_read_b64_tr_b16 v[108:109], v6 offset:27648
  ds_read_b64_tr_b16 v[110:111], v6 offset:27712
  v_mfma_f32_16x16x32_bf16 v[16:19], v[48:51], v[80:83], v[16:19]
  s_waitcnt lgkmcnt(6)
  v_cvt_pk_bf16_f32 v120, v24, v25
  v_cvt_pk_bf16_f32 v121, v26, v27
  v_mfma_f32_16x16x32_bf16 v[112:115], v[116:119], v[68:71], 0
  s_waitcnt lgkmcnt(4)
  v_mov_b64 v[98:99], 0
  v_mfma_f32_16x16x32_bf16 v[112:115], v[124:127], v[72:75], v[112:115]
  s_waitcnt lgkmcnt(2)
  v_mov_b64 v[36:37], 0
  v_exp_f32 v100, v16
  v_mfma_f32_16x16x32_bf16 v[112:115], v[104:107], v[76:79], v[112:115]
  s_waitcnt lgkmcnt(0)
  v_exp_f32 v101, v17
  v_mfma_f32_16x16x32_bf16 v[112:115], v[108:111], v[80:83], v[112:115]
  buffer_store_dwordx4 v[120:123], v2, s[4:7], s29 offen offset:3072 sc1
  v_exp_f32 v102, v18
  v_mfma_f32_16x16x32_bf16 v[20:23], v[52:55], v[68:71], 0
  v_exp_f32 v103, v19
  v_mfma_f32_16x16x32_bf16 v[20:23], v[56:59], v[72:75], v[20:23]
  v_cvt_pk_bf16_f32 v44, v100, v101
  v_cvt_pk_bf16_f32 v45, v102, v103
  v_mfma_f32_16x16x32_bf16 v[20:23], v[60:63], v[76:79], v[20:23]
  s_add_u32 s29, s29, 131072
  v_exp_f32 v100, v112
  v_mfma_f32_16x16x32_bf16 v[20:23], v[64:67], v[80:83], v[20:23]
  v_exp_f32 v101, v113
  v_exp_f32 v102, v114
  v_exp_f32 v103, v115
  v_cvt_pk_bf16_f32 v84, v100, v101
  v_cvt_pk_bf16_f32 v85, v102, v103
  v_cndmask_b32 v48, v84, 0, s[16:17]
  v_cndmask_b32 v49, v85, 0, s[16:17]
  v_cndmask_b32 v50, 0, v84, s[16:17]
  v_cndmask_b32 v51, 0, v85, s[16:17]
  v_exp_f32 v100, v20
  v_mfma_f32_16x16x16_bf16 v[88:91], v[12:13], v[48:49], 0
  v_exp_f32 v101, v21
  v_mfma_f32_16x16x16_bf16 v[24:27], v[120:121], v[48:49], 0
  v_exp_f32 v102, v22
  v_mfma_f32_16x16x16_bf16 v[116:119], v[120:121], v[50:51], 0
  v_exp_f32 v103, v23
  v_cvt_pk_bf16_f32 v46, v100, v101
  v_cvt_pk_bf16_f32 v47, v102, v103
  v_mov_b64 v[38:39], 0
  s_nop 0
  v_mfma_f32_16x16x32_bf16 v[88:91], v[12:15], v[44:47], v[88:91]
  v_mov_b64 v[40:41], 0
  v_mov_b64 v[42:43], 0
  v_mfma_f32_16x16x32_bf16 v[24:27], v[28:31], v[44:47], v[24:27]
  ds_read_b128 v[52:55], v4 offset:24576
  ds_read_b128 v[56:59], v4 offset:25600
  v_mfma_f32_16x16x32_bf16 v[116:119], v[32:35], v[44:47], v[116:119]
  s_nop 1
T_back_124:
  v_rcp_f32 v89, v88
  v_subrev_u32 v100, s54, v88
  v_cmp_le_u32 vcc, s96, v100
  v_mul_f32 v24, v89, v24
  v_mul_f32 v25, v89, v25
  v_cvt_pk_bf16_f32 v124, v24, v25
  v_pk_mul_f32 v[26:27], v[26:27], v[88:89] op_sel:[0,1] op_sel_hi:[1,1]
  v_pk_mul_f32 v[116:117], v[116:117], v[88:89] op_sel:[0,1] op_sel_hi:[1,1]
  v_pk_mul_f32 v[118:119], v[118:119], v[88:89] op_sel:[0,1] op_sel_hi:[1,1]
  v_cvt_pk_bf16_f32 v125, v26, v27
  v_cvt_pk_bf16_f32 v126, v116, v117
  v_cvt_pk_bf16_f32 v127, v118, v119
  ds_write_b128 v11, v[124:127] offset:30720
  s_cbranch_vccnz T_slow_123
  v_smfmac_f32_16x16x64_bf16 v[92:95], v[124:127], a[160:167], v0
  s_mov_b32 s96, s55
  v_smfmac_f32_16x16x64_bf16 v[96:99], v[124:127], a[168:175], v0
  s_cmp_eq_u32 s14, 63
  v_smfmac_f32_16x16x64_bf16 v[36:39], v[124:127], a[176:183], v0
  s_waitcnt lgkmcnt(0)
  s_barrier
  ds_read_b128 v[104:107], v11 offset:30208
  ds_read_b128 v[108:111], v11 offset:29696
  ds_read_b128 v[68:71], v11 offset:29184
  s_cbranch_scc1 M_tdone
  v_smfmac_f32_16x16x64_bf16 v[40:43], v[124:127], a[184:191], v0
  s_waitcnt lgkmcnt(2)
  v_smfmac_f32_16x16x64_bf16 v[92:95], v[104:107], a[192:199], v0
  s_waitcnt lgkmcnt(1)
  ds_read_b128 v[76:79], v4 offset:28672
  v_smfmac_f32_16x16x64_bf16 v[92:95], v[108:111], a[224:231], v0
  s_waitcnt lgkmcnt(1)
  ds_read_b128 v[80:83], v4 offset:29696
  v_smfmac_f32_16x16x64_bf16 v[92:95], v[68:71], a[240:247], v0
  ds_read_b128 v[60:63], v4 offset:26624
  v_smfmac_f32_16x16x64_bf16 v[96:99], v[104:107], a[200:207], v0
  ds_read_b128 v[64:67], v4 offset:27648
  v_smfmac_f32_16x16x64_bf16 v[96:99], v[108:111], a[232:239], v0
  ds_read_b128 v[28:31], v4 offset:30720
  s_nop 0
  v_cvt_pk_bf16_f32 v16, v92, v93
  v_cvt_pk_bf16_f32 v17, v94, v95
  v_bfi_b32 v16, 1, s57, v16
  v_smfmac_f32_16x16x64_bf16 v[96:99], v[68:71], a[248:255], v0
  buffer_store_dwordx2 v[16:17], v7, s[4:7], s20 offen offset:0 sc1
  v_smfmac_f32_16x16x64_bf16 v[36:39], v[104:107], a[208:215], v0
  ds_read_b128 v[32:35], v4 offset:31744
  v_smfmac_f32_16x16x64_bf16 v[36:39], v[108:111], v[52:59], v0
  s_waitcnt lgkmcnt(4)
  s_nop 0
  v_cvt_pk_bf16_f32 v18, v96, v97
  v_cvt_pk_bf16_f32 v19, v98, v99
  v_bfi_b32 v18, 1, s57, v18
  v_smfmac_f32_16x16x64_bf16 v[36:39], v[68:71], v[76:83], v0
  buffer_store_dwordx2 v[18:19], v7, s[4:7], s20 offen offset:64 sc1
  v_smfmac_f32_16x16x64_bf16 v[40:43], v[104:107], a[216:223], v0
  s_waitcnt lgkmcnt(2)
  v_smfmac_f32_16x16x64_bf16 v[40:43], v[108:111], v[60:67], v0
  s_waitcnt lgkmcnt(0)
  s_nop 0
  v_cvt_pk_bf16_f32 v20, v36, v37
  v_cvt_pk_bf16_f32 v21, v38, v39
  v_bfi_b32 v20, 1, s57, v20
  v_smfmac_f32_16x16x64_bf16 v[40:43], v[68:71], v[28:35], v0
  buffer_store_dwordx2 v[20:21], v7, s[4:7], s21 offen offset:0 sc1
  s_nop 6
  v_cvt_pk_bf16_f32 v22, v40, v41
  v_cvt_pk_bf16_f32 v23, v42, v43
  v_bfi_b32 v22, 1, s57, v22
  buffer_store_dwordx2 v[22:23], v7, s[4:7], s21 offen offset:64 sc1
  ds_read_b128 v[68:71], v4 offset:0
  ds_read_b128 v[72:75], v4 offset:1024
  ds_read_b128 v[76:79], v4 offset:4096
  ds_read_b128 v[80:83], v4 offset:5120
  ds_read_b128 v[84:87], v4 offset:8192
  ds_read_b128 v[88:91], v4 offset:9216
  ds_read_b128 v[92:95], v4 offset:2048
  ds_read_b128 v[96:99], v4 offset:3072
  ds_read_b128 v[100:103], v4 offset:6144
  ds_read_b128 v[104:107], v4 offset:7168
  ds_read_b128 v[108:111], v4 offset:10240
  ds_read_b128 v[112:115], v4 offset:11264
  v_mov_b64 v[16:17], 0
  v_mov_b64 v[18:19], 0
  v_mov_b64 v[20:21], 0
  v_mov_b64 v[22:23], 0
  v_mov_b64 v[24:25], 0
  v_mov_b64 v[26:27], 0
  ds_read_b64 v[44:45], v2 offset:32256
  s_waitcnt lgkmcnt(0)
  v_readfirstlane_b32 s38, v44
  v_readfirstlane_b32 s37, v45
  s_nop 0
  s_lshl_b32 s38, s38, 1
  s_lshl1_add_u32 s37, s37, 1
  s_min_u32 s38, s38, s37
  s_cmp_ge_u32 s38, 64
  s_cselect_b32 s38, 100, s38
  s_sub_u32 s38, s38, 1
  s_max_i32 s30, s30, s38
  s_waitcnt vmcnt(4)
  s_barrier
  ds_read_b128 v[28:31], v2 offset:19456
  ds_read_b128 v[32:35], v2 offset:23552
  ds_read_b128 v[36:39], v2 offset:8192
  ds_read_b128 v[40:43], v2 offset:9216
  ds_read_b128 v[44:47], v2 offset:10240
  ds_read_b128 v[48:51], v2 offset:11264
  buffer_load_dwordx4 v[124:127], v2, s[4:7], s24 offen offset:3072 sc1
  buffer_load_dwordx4 v[116:119], v2, s[4:7], s25 offen offset:3072 sc1
  ds_read_b128 v[52:55], v2 offset:12288
  ds_read_b128 v[56:59], v2 offset:13312
  ds_read_b128 v[60:63], v2 offset:14336
  ds_read_b128 v[64:67], v2 offset:15360
  buffer_load_dwordx4 v[124:127], v2, s[4:7], s24 offen offset:3072 sc1
  buffer_load_dwordx4 v[116:119], v2, s[4:7], s25 offen offset:3072 sc1
  s_add_u32 s14, s14, 1
  s_cmp_ge_i32 s14, s30
  s_cbranch_scc1 T_kvw_120
T_kvb_121:
  s_mov_b32 s19, 0
  s_branch T_loop_116
T_kvw_120:
  s_mov_b32 s19, 0
  s_branch T_kvok_129
T_kv_128:
  s_sleep 4
  s_add_u32 s19, s19, 1
  s_cmp_gt_u32 s19, 32768
  s_cbranch_scc1 M_exit
T_kvok_129:
  s_add_u32 s39, s99, 128
  s_mov_b32 s38, 0
  s_mov_b32 s37, 0
  s_atomic_or s38, s[58:59], s99 glc
  s_atomic_or s37, s[58:59], s39 glc
  s_waitcnt lgkmcnt(0)
  s_lshl_b32 s38, s38, 1
  s_lshl1_add_u32 s37, s37, 1
  s_min_u32 s38, s38, s37
  s_cmp_ge_u32 s38, 64
  s_cselect_b32 s38, 100, s38
  s_sub_u32 s38, s38, 1
  s_max_i32 s30, s30, s38
  s_cmp_ge_i32 s14, s30
  s_cbranch_scc1 T_kv_128
  s_branch T_kvb_121
T_slow_123:
  s_nop 7
  v_max3_f32 v100, v16, v17, v18
  v_max3_f32 v100, v100, v19, v20
  v_max3_f32 v100, v100, v21, v22
  v_max3_f32 v100, v100, v23, v112
  v_max3_f32 v100, v100, v113, v114
  v_max_f32 v100, v100, v115
  v_mov_b32 v101, v100
  s_nop 1
  v_permlane32_swap_b32 v100, v101
  s_nop 1
  v_max_f32 v100, v100, v101
  v_mov_b32 v101, v100
  s_nop 1
  v_permlane16_swap_b32 v100, v101
  s_nop 1
  v_max_f32 v100, v100, v101
  v_sub_f32 v16, v16, v100
  v_sub_f32 v17, v17, v100
  v_sub_f32 v18, v18, v100
  v_sub_f32 v19, v19, v100
  v_exp_f32 v16, v16
  v_exp_f32 v17, v17
  v_exp_f32 v18, v18
  v_exp_f32 v19, v19
  v_sub_f32 v20, v20, v100
  v_sub_f32 v21, v21, v100
  v_sub_f32 v22, v22, v100
  v_sub_f32 v23, v23, v100
  v_exp_f32 v20, v20
  v_exp_f32 v21, v21
  v_exp_f32 v22, v22
  v_exp_f32 v23, v23
  v_sub_f32 v112, v112, v100
  v_sub_f32 v113, v113, v100
  v_sub_f32 v114, v114, v100
  v_sub_f32 v115, v115, v100
  v_exp_f32 v112, v112
  v_exp_f32 v113, v113
  v_exp_f32 v114, v114
  v_exp_f32 v115, v115
  s_nop 0
  v_cvt_pk_bf16_f32 v44, v16, v17
  v_cvt_pk_bf16_f32 v45, v18, v19
  v_cvt_pk_bf16_f32 v46, v20, v21
  v_cvt_pk_bf16_f32 v47, v22, v23
  v_cvt_pk_bf16_f32 v84, v112, v113
  v_cvt_pk_bf16_f32 v85, v114, v115
  v_cndmask_b32 v48, v84, 0, s[16:17]
  v_cndmask_b32 v49, v85, 0, s[16:17]
  v_cndmask_b32 v50, 0, v84, s[16:17]
  v_cndmask_b32 v51, 0, v85, s[16:17]
  s_nop 1
  v_mfma_f32_16x16x16_bf16 v[88:91], v[12:13], v[48:49], 0
  v_mfma_f32_16x16x16_bf16 v[24:27], v[120:121], v[48:49], 0
  v_mfma_f32_16x16x16_bf16 v[116:119], v[120:121], v[50:51], 0
  v_mfma_f32_16x16x32_bf16 v[88:91], v[12:15], v[44:47], v[88:91]
  v_mfma_f32_16x16x32_bf16 v[24:27], v[28:31], v[44:47], v[24:27]
  v_mfma_f32_16x16x32_bf16 v[116:119], v[32:35], v[44:47], v[116:119]
  s_nop 7
  s_nop 1
  s_mov_b32 s96, -1
  s_branch T_back_124
M_tdone:
  v_mov_b32 v16, 64
  v_or_b32 v17, s13, v2
  v_min_u32 v17, 1, v17
  v_lshlrev_b32 v17, 30, v17
  s_waitcnt vmcnt(0)
  s_barrier
  buffer_store_dword v16, v17, s[4:7], s15 offen sc1
  s_branch M_done
M_worker:
  s_load_dwordx4 s[72:75], s[0:1], 120
  v_lshrrev_b32 v3, 6, v0
  v_and_b32 v1, 63, v0
  v_readfirstlane_b32 s16, v3
  v_lshlrev_b32 v2, 4, v1
  s_waitcnt lgkmcnt(0)
  s_mov_b64 s[4:5], s[74:75]
  s_mov_b64 s[74:75], s[72:73]
  s_mov_b64 s[72:73], s[4:5]
  s_and_b32 s5, s5, 0xffff
  s_mov_b32 s6, 268435456
  s_mov_b32 s7, 0x20000
  s_sub_u32 s66, s76, 1
  s_lshl_b32 s66, s66, 5
  s_add_u32 s66, s66, s77
  s_mul_i32 s64, s66, 9363
  s_lshr_b32 s64, s64, 16
  s_mul_i32 s67, s64, 7
  s_sub_u32 s65, s66, s67
  s_lshl_b32 s31, s66, 7
  s_add_u32 s31, s31, 148897792
  s_lshl_b32 s67, s67, 7
  s_add_u32 s67, s67, 148897792
  s_getpc_b64 s[76:77]
M_pc:
  s_add_u32 s76, s76, M_table-M_pc
  s_addc_u32 s77, s77, 0
  s_lshl_b32 s26, s65, 6
  s_load_dwordx16 s[48:63], s[76:77], s26
  s_waitcnt lgkmcnt(0)
  s_mov_b32 s23, s51
  s_cmp_lg_u32 s48, 1
  s_cbranch_scc1 M_nobpf
  s_load_dwordx8 s[36:43], s[0:1], 64
  s_mul_i32 s76, s64, 3
  s_add_u32 s76, s76, s57
  v_lshlrev_b32 v4, 7, v0
  s_mov_b32 s10, 4194304
  s_mov_b32 s11, 0x20000
  s_waitcnt lgkmcnt(0)
  s_mov_b32 s8, s42
  s_and_b32 s9, s43, 0xffff
  s_mul_i32 s77, s76, 43776
  s_add_u32 s77, s77, 0
  v_min_u32 v5, 32640, v4
  v_add_u32 v5, s77, v5
  s_add_u32 s77, s77, 32768
  buffer_load_dword v6, v5, s[8:11], 0 offen
  v_min_u32 v5, 10880, v4
  v_add_u32 v5, s77, v5
  s_add_u32 s77, s77, 32768
  buffer_load_dword v6, v5, s[8:11], 0 offen
  s_mov_b32 s8, s38
  s_and_b32 s9, s39, 0xffff
  s_mul_i32 s77, s76, 21888
  s_add_u32 s77, s77, 2097152
  v_min_u32 v5, 21760, v4
  v_add_u32 v5, s77, v5
  s_add_u32 s77, s77, 32768
  buffer_load_dword v6, v5, s[8:11], 0 offen
  s_mov_b32 s8, s40
  s_and_b32 s9, s41, 0xffff
  s_mul_i32 s77, s76, 21888
  s_add_u32 s77, s77, 2097152
  v_min_u32 v5, 21760, v4
  v_add_u32 v5, s77, v5
  s_add_u32 s77, s77, 32768
  buffer_load_dword v6, v5, s[8:11], 0 offen
  s_mov_b32 s8, s36
  s_and_b32 s9, s37, 0xffff
  s_mul_i32 s77, s76, 21888
  s_add_u32 s77, s77, 2097152
  v_min_u32 v5, 21760, v4
  v_add_u32 v5, s77, v5
  s_add_u32 s77, s77, 32768
  buffer_load_dword v6, v5, s[8:11], 0 offen
  s_waitcnt vmcnt(0)
M_nobpf:
  s_lshr_b32 s29, s16, 1
  s_cmp_eq_u32 s29, 0
  s_cselect_b32 s26, 2, 8
  s_cselect_b32 s27, 3, 4
  s_cselect_b32 s28, 9, 10
  s_cmp_eq_u32 s48, 1
  s_cselect_b32 s26, s27, s26
  s_cmp_eq_u32 s48, 2
  s_cselect_b32 s26, s28, s26
  s_lshl_b32 s26, s26, 3
  s_load_dwordx2 s[8:9], s[0:1], s26
  s_cmp_eq_u32 s48, 1
  s_cselect_b32 s26, 8, 0
  s_load_dwordx2 s[12:13], s[0:1], s26
  s_cmp_eq_u32 s29, 0
  s_cselect_b32 s21, 0, 3
  s_cselect_b32 s27, 1, 2
  s_cselect_b32 s28, 4, 5
  s_cmp_eq_u32 s48, 1
  s_cselect_b32 s21, s27, s21
  s_cmp_eq_u32 s48, 2
  s_cselect_b32 s21, s28, s21
  s_lshl_b32 s21, s21, 5
  s_add_u32 s21, s21, s64
  s_lshl_b32 s21, s21, 6
  s_add_u32 s21, s21, s49
  s_and_b32 s27, s16, 1
  s_lshl_b32 s21, s21, 1
  s_add_u32 s21, s21, s27
  s_lshl_b32 s21, s21, 12
  s_lshl_b32 s22, s50, 13
  s_lshl_b32 s19, s49, 15
  s_lshl_b32 s20, s50, 15
  s_lshl_b32 s17, s64, 1
  s_add_u32 s17, s17, s27
  s_lshl_b32 s17, s17, 7
  s_mov_b32 s18, 8192
  s_mov_b32 s24, 0x3e0293ee
  s_waitcnt lgkmcnt(0)
  s_and_b32 s9, s9, 0xffff
  s_mov_b32 s10, 4194304
  s_mov_b32 s11, 0x20000
  s_and_b32 s13, s13, 0xffff
  s_mov_b32 s14, 2097152
  s_mov_b32 s15, 0x20000
  s_cmp_eq_u32 s48, 0
  s_cselect_b32 s32, 0, s16
  s_lshr_b32 s32, s32, 1
  v_lshrrev_b32 v144, 4, v1
  v_and_b32 v56, 0xff, v2
  v_lshl_add_u32 v56, v144, 9, v56
  v_and_b32 v146, 15, v1
  v_and_b32 v144, 8, v1
  v_add_u32 v144, v144, v146
  s_cmp_lg_u32 s32, 0
  s_cselect_b64 vcc, -1, 0
  s_cselect_b32 s26, 8, 16
  v_cndmask_b32 v144, v146, v144, vcc
  v_lshrrev_b32 v145, 4, v1
  v_add_u32 v148, s26, v144
  v_xor_b32 v147, 0, v145
  v_xor_b32 v147, v147, v146
  v_lshlrev_b32 v147, 4, v147
  v_lshl_add_u32 v8, v144, 8, v147
  v_xor_b32 v147, 8, v145
  v_xor_b32 v147, v147, v146
  v_lshlrev_b32 v147, 4, v147
  v_lshl_add_u32 v9, v148, 8, v147
  v_xor_b32 v147, 4, v145
  v_xor_b32 v147, v147, v146
  v_lshlrev_b32 v147, 4, v147
  v_lshl_add_u32 v10, v144, 8, v147
  v_xor_b32 v147, 12, v145
  v_xor_b32 v147, v147, v146
  v_lshlrev_b32 v147, 4, v147
  v_lshl_add_u32 v11, v148, 8, v147
  v_xor_b32 v147, 8, v145
  v_xor_b32 v147, v147, v146
  v_lshlrev_b32 v147, 4, v147
  v_lshl_add_u32 v12, v144, 8, v147
  v_xor_b32 v147, 0, v145
  v_xor_b32 v147, v147, v146
  v_lshlrev_b32 v147, 4, v147
  v_lshl_add_u32 v13, v148, 8, v147
  v_xor_b32 v147, 12, v145
  v_xor_b32 v147, v147, v146
  v_lshlrev_b32 v147, 4, v147
  v_lshl_add_u32 v14, v144, 8, v147
  v_xor_b32 v147, 4, v145
  v_xor_b32 v147, v147, v146
  v_lshlrev_b32 v147, 4, v147
  v_lshl_add_u32 v15, v148, 8, v147
  v_lshrrev_b32 v144, 4, v1
  s_lshl_b32 s26, s16, 8
  v_add_u32 v145, 0, v144
  v_or_b32 v147, 0, v144
  v_xor_b32 v147, v147, v146
  v_lshlrev_b32 v147, 4, v147
  v_lshl_add_u32 v147, v145, 10, v147
  v_add_u32 v16, s26, v147
  v_add_u32 v145, 4, v144
  v_or_b32 v147, 4, v144
  v_xor_b32 v147, v147, v146
  v_lshlrev_b32 v147, 4, v147
  v_lshl_add_u32 v147, v145, 10, v147
  v_add_u32 v17, s26, v147
  v_add_u32 v145, 8, v144
  v_or_b32 v147, 8, v144
  v_xor_b32 v147, v147, v146
  v_lshlrev_b32 v147, 4, v147
  v_lshl_add_u32 v147, v145, 10, v147
  v_add_u32 v18, s26, v147
  v_add_u32 v145, 12, v144
  v_or_b32 v147, 12, v144
  v_xor_b32 v147, v147, v146
  v_lshlrev_b32 v147, 4, v147
  v_lshl_add_u32 v147, v145, 10, v147
  v_add_u32 v19, s26, v147
  v_add_u32 v145, 16, v144
  v_or_b32 v147, 8, v144
  v_xor_b32 v147, v147, v146
  v_lshlrev_b32 v147, 4, v147
  v_lshl_add_u32 v147, v145, 10, v147
  v_add_u32 v20, s26, v147
  v_add_u32 v145, 20, v144
  v_or_b32 v147, 12, v144
  v_xor_b32 v147, v147, v146
  v_lshlrev_b32 v147, 4, v147
  v_lshl_add_u32 v147, v145, 10, v147
  v_add_u32 v21, s26, v147
  v_add_u32 v145, 24, v144
  v_or_b32 v147, 0, v144
  v_xor_b32 v147, v147, v146
  v_lshlrev_b32 v147, 4, v147
  v_lshl_add_u32 v147, v145, 10, v147
  v_add_u32 v22, s26, v147
  v_add_u32 v145, 28, v144
  v_or_b32 v147, 4, v144
  v_xor_b32 v147, v147, v146
  v_lshlrev_b32 v147, 4, v147
  v_lshl_add_u32 v147, v145, 10, v147
  v_add_u32 v23, s26, v147
  v_lshrrev_b32 v144, 3, v1
  v_mul_lo_u32 v144, v144, s18
  v_and_b32 v145, 7, v1
  v_lshl_add_u32 v144, v145, 4, v144
  s_lshl_b32 s28, s16, 15
  s_add_u32 s28, s28, 32768
  s_lshl_b32 s29, s18, 3
  s_add_u32 m0, s28, 0
  s_nop 0
  buffer_load_dwordx4 v144, s[8:11], s17 offen lds
  s_add_u32 s17, s17, s29
  s_add_u32 m0, s28, 1024
  s_nop 0
  buffer_load_dwordx4 v144, s[8:11], s17 offen lds
  s_add_u32 s17, s17, s29
  s_add_u32 m0, s28, 2048
  s_nop 0
  buffer_load_dwordx4 v144, s[8:11], s17 offen lds
  s_add_u32 s17, s17, s29
  s_add_u32 m0, s28, 3072
  s_nop 0
  buffer_load_dwordx4 v144, s[8:11], s17 offen lds
  s_add_u32 s17, s17, s29
  s_add_u32 m0, s28, 4096
  s_nop 0
  buffer_load_dwordx4 v144, s[8:11], s17 offen lds
  s_add_u32 s17, s17, s29
  s_add_u32 m0, s28, 5120
  s_nop 0
  buffer_load_dwordx4 v144, s[8:11], s17 offen lds
  s_add_u32 s17, s17, s29
  s_add_u32 m0, s28, 6144
  s_nop 0
  buffer_load_dwordx4 v144, s[8:11], s17 offen lds
  s_add_u32 s17, s17, s29
  s_add_u32 m0, s28, 7168
  s_nop 0
  buffer_load_dwordx4 v144, s[8:11], s17 offen lds
  s_add_u32 s17, s17, s29
  s_add_u32 m0, s28, 8192
  s_nop 0
  buffer_load_dwordx4 v144, s[8:11], s17 offen lds
  s_add_u32 s17, s17, s29
  s_add_u32 m0, s28, 9216
  s_nop 0
  buffer_load_dwordx4 v144, s[8:11], s17 offen lds
  s_add_u32 s17, s17, s29
  s_add_u32 m0, s28, 10240
  s_nop 0
  buffer_load_dwordx4 v144, s[8:11], s17 offen lds
  s_add_u32 s17, s17, s29
  s_add_u32 m0, s28, 11264
  s_nop 0
  buffer_load_dwordx4 v144, s[8:11], s17 offen lds
  s_add_u32 s17, s17, s29
  s_add_u32 m0, s28, 12288
  s_nop 0
  buffer_load_dwordx4 v144, s[8:11], s17 offen lds
  s_add_u32 s17, s17, s29
  s_add_u32 m0, s28, 13312
  s_nop 0
  buffer_load_dwordx4 v144, s[8:11], s17 offen lds
  s_add_u32 s17, s17, s29
  s_add_u32 m0, s28, 14336
  s_nop 0
  buffer_load_dwordx4 v144, s[8:11], s17 offen lds
  s_add_u32 s17, s17, s29
  s_add_u32 m0, s28, 15360
  s_nop 0
  buffer_load_dwordx4 v144, s[8:11], s17 offen lds
  s_add_u32 s17, s17, s29
  s_add_u32 m0, s28, 16384
  s_nop 0
  buffer_load_dwordx4 v144, s[8:11], s17 offen lds
  s_add_u32 s17, s17, s29
  s_add_u32 m0, s28, 17408
  s_nop 0
  buffer_load_dwordx4 v144, s[8:11], s17 offen lds
  s_add_u32 s17, s17, s29
  s_add_u32 m0, s28, 18432
  s_nop 0
  buffer_load_dwordx4 v144, s[8:11], s17 offen lds
  s_add_u32 s17, s17, s29
  s_add_u32 m0, s28, 19456
  s_nop 0
  buffer_load_dwordx4 v144, s[8:11], s17 offen lds
  s_add_u32 s17, s17, s29
  s_add_u32 m0, s28, 20480
  s_nop 0
  buffer_load_dwordx4 v144, s[8:11], s17 offen lds
  s_add_u32 s17, s17, s29
  s_add_u32 m0, s28, 21504
  s_nop 0
  buffer_load_dwordx4 v144, s[8:11], s17 offen lds
  s_add_u32 s17, s17, s29
  s_add_u32 m0, s28, 22528
  s_nop 0
  buffer_load_dwordx4 v144, s[8:11], s17 offen lds
  s_add_u32 s17, s17, s29
  s_add_u32 m0, s28, 23552
  s_nop 0
  buffer_load_dwordx4 v144, s[8:11], s17 offen lds
  s_add_u32 s17, s17, s29
  s_add_u32 m0, s28, 24576
  s_nop 0
  buffer_load_dwordx4 v144, s[8:11], s17 offen lds
  s_add_u32 s17, s17, s29
  s_add_u32 m0, s28, 25600
  s_nop 0
  buffer_load_dwordx4 v144, s[8:11], s17 offen lds
  s_add_u32 s17, s17, s29
  s_add_u32 m0, s28, 26624
  s_nop 0
  buffer_load_dwordx4 v144, s[8:11], s17 offen lds
  s_add_u32 s17, s17, s29
  s_add_u32 m0, s28, 27648
  s_nop 0
  buffer_load_dwordx4 v144, s[8:11], s17 offen lds
  s_add_u32 s17, s17, s29
  s_add_u32 m0, s28, 28672
  s_nop 0
  buffer_load_dwordx4 v144, s[8:11], s17 offen lds
  s_add_u32 s17, s17, s29
  s_add_u32 m0, s28, 29696
  s_nop 0
  buffer_load_dwordx4 v144, s[8:11], s17 offen lds
  s_add_u32 s17, s17, s29
  s_add_u32 m0, s28, 30720
  s_nop 0
  buffer_load_dwordx4 v144, s[8:11], s17 offen lds
  s_add_u32 s17, s17, s29
  s_add_u32 m0, s28, 31744
  s_nop 0
  buffer_load_dwordx4 v144, s[8:11], s17 offen lds
  s_add_u32 s17, s17, s29
  s_lshl_b32 s25, s16, 13
  s_add_u32 m0, s25, 0
  s_nop 0
  buffer_load_dwordx4 v16, s[12:15], s19 offen lds
  s_add_u32 m0, s25, 1024
  s_nop 0
  buffer_load_dwordx4 v17, s[12:15], s19 offen lds
  s_add_u32 m0, s25, 2048
  s_nop 0
  buffer_load_dwordx4 v18, s[12:15], s19 offen lds
  s_add_u32 m0, s25, 3072
  s_nop 0
  buffer_load_dwordx4 v19, s[12:15], s19 offen lds
  s_add_u32 m0, s25, 4096
  s_nop 0
  buffer_load_dwordx4 v20, s[12:15], s19 offen lds
  s_add_u32 m0, s25, 5120
  s_nop 0
  buffer_load_dwordx4 v21, s[12:15], s19 offen lds
  s_add_u32 m0, s25, 6144
  s_nop 0
  buffer_load_dwordx4 v22, s[12:15], s19 offen lds
  s_add_u32 m0, s25, 7168
  s_nop 0
  buffer_load_dwordx4 v23, s[12:15], s19 offen lds
  s_cmp_gt_u32 s23, 1
  s_cselect_b32 s26, s20, 0
  s_add_u32 s19, s19, s26
  s_add_u32 s25, s25, 32768
  s_and_b32 s25, s25, 0x1ffff
  s_cmp_lg_u32 s16, 3
  s_cbranch_scc1 M_noinit
  s_mov_b32 s79, 0
  s_atomic_swap s79, s[72:73], s31 glc
  s_waitcnt lgkmcnt(0)
  s_mov_b32 s79, 1
  s_atomic_add s79, s[74:75], 128
M_noinit:
  s_cmp_lg_u32 s65, 3
  s_cbranch_scc1 M_noarm
  v_lshlrev_b32 v4, 4, v0
  v_mov_b64 v[60:61], -1
  v_mov_b64 v[62:63], -1
  s_mul_i32 s76, s64, 4096
  s_add_u32 s77, s76, 142868480
  buffer_store_dwordx4 v[60:63], v4, s[4:7], s77 offen sc1
  s_add_u32 s77, s76, 142999552
  buffer_store_dwordx4 v[60:63], v4, s[4:7], s77 offen sc1
  s_add_u32 s77, s76, 143130624
  buffer_store_dwordx4 v[60:63], v4, s[4:7], s77 offen sc1
  s_add_u32 s77, s76, 143261696
  buffer_store_dwordx4 v[60:63], v4, s[4:7], s77 offen sc1
  s_add_u32 s77, s76, 143392768
  buffer_store_dwordx4 v[60:63], v4, s[4:7], s77 offen sc1
  s_add_u32 s77, s76, 143523840
  buffer_store_dwordx4 v[60:63], v4, s[4:7], s77 offen sc1
M_noarm:
  s_mul_i32 s76, s64, 3
  s_add_u32 s76, s76, s57
  s_mul_i32 s76, s76, 24576
  v_lshlrev_b32 v4, 7, v0
  v_add_u32 v4, s76, v4
  buffer_load_dword v5, v4, s[12:15], 0 offen
  v_bfe_u32 v148, v1, 2, 2
  v_lshrrev_b32 v149, 5, v1
  v_lshl_add_u32 v148, v149, 4, v148
  v_bfe_u32 v149, v1, 4, 1
  v_lshl_add_u32 v148, v149, 3, v148
  v_and_b32 v149, 3, v1
  v_and_b32 v150, 2, v149
  v_add_u32 v150, v150, v149
  s_cmp_lg_u32 s32, 0
  s_cselect_b64 vcc, -1, 0
  s_cselect_b32 s26, 32, 16
  v_cndmask_b32 v149, v150, v149, vcc
  v_lshlrev_b32 v149, 3, v149
  v_lshl_add_u32 v148, v148, 7, v149
  v_add_u32 v152, s28, v148
  v_add_u32 v153, 512, v152
  v_add_u32 v154, s26, v152
  v_add_u32 v155, s26, v153
  s_waitcnt vmcnt(37)
  ds_read_b64_tr_b16 a[0:1], v152 offset:0
  ds_read_b64_tr_b16 a[2:3], v153 offset:0
  ds_read_b64_tr_b16 a[4:5], v154 offset:0
  ds_read_b64_tr_b16 a[6:7], v155 offset:0
  ds_read_b64_tr_b16 a[8:9], v152 offset:64
  ds_read_b64_tr_b16 a[10:11], v153 offset:64
  ds_read_b64_tr_b16 a[12:13], v154 offset:64
  ds_read_b64_tr_b16 a[14:15], v155 offset:64
  s_waitcnt lgkmcnt(0)
  s_add_u32 m0, s28, 0
  s_nop 0
  buffer_load_dwordx4 v144, s[8:11], s17 offen lds
  s_add_u32 s17, s17, s29
  s_add_u32 m0, s28, 1024
  s_nop 0
  buffer_load_dwordx4 v144, s[8:11], s17 offen lds
  s_add_u32 s17, s17, s29
  s_add_u32 m0, s28, 2048
  s_nop 0
  buffer_load_dwordx4 v144, s[8:11], s17 offen lds
  s_add_u32 s17, s17, s29
  s_add_u32 m0, s28, 3072
  s_nop 0
  buffer_load_dwordx4 v144, s[8:11], s17 offen lds
  s_add_u32 s17, s17, s29
  s_waitcnt vmcnt(37)
  ds_read_b64_tr_b16 a[16:17], v152 offset:4096
  ds_read_b64_tr_b16 a[18:19], v153 offset:4096
  ds_read_b64_tr_b16 a[20:21], v154 offset:4096
  ds_read_b64_tr_b16 a[22:23], v155 offset:4096
  ds_read_b64_tr_b16 a[24:25], v152 offset:4160
  ds_read_b64_tr_b16 a[26:27], v153 offset:4160
  ds_read_b64_tr_b16 a[28:29], v154 offset:4160
  ds_read_b64_tr_b16 a[30:31], v155 offset:4160
  s_waitcnt lgkmcnt(0)
  s_add_u32 m0, s28, 4096
  s_nop 0
  buffer_load_dwordx4 v144, s[8:11], s17 offen lds
  s_add_u32 s17, s17, s29
  s_add_u32 m0, s28, 5120
  s_nop 0
  buffer_load_dwordx4 v144, s[8:11], s17 offen lds
  s_add_u32 s17, s17, s29
  s_add_u32 m0, s28, 6144
  s_nop 0
  buffer_load_dwordx4 v144, s[8:11], s17 offen lds
  s_add_u32 s17, s17, s29
  s_add_u32 m0, s28, 7168
  s_nop 0
  buffer_load_dwordx4 v144, s[8:11], s17 offen lds
  s_add_u32 s17, s17, s29
  s_waitcnt vmcnt(37)
  ds_read_b64_tr_b16 a[32:33], v152 offset:8192
  ds_read_b64_tr_b16 a[34:35], v153 offset:8192
  ds_read_b64_tr_b16 a[36:37], v154 offset:8192
  ds_read_b64_tr_b16 a[38:39], v155 offset:8192
  ds_read_b64_tr_b16 a[40:41], v152 offset:8256
  ds_read_b64_tr_b16 a[42:43], v153 offset:8256
  ds_read_b64_tr_b16 a[44:45], v154 offset:8256
  ds_read_b64_tr_b16 a[46:47], v155 offset:8256
  s_waitcnt lgkmcnt(0)
  s_add_u32 m0, s28, 8192
  s_nop 0
  buffer_load_dwordx4 v144, s[8:11], s17 offen lds
  s_add_u32 s17, s17, s29
  s_add_u32 m0, s28, 9216
  s_nop 0
  buffer_load_dwordx4 v144, s[8:11], s17 offen lds
  s_add_u32 s17, s17, s29
  s_add_u32 m0, s28, 10240
  s_nop 0
  buffer_load_dwordx4 v144, s[8:11], s17 offen lds
  s_add_u32 s17, s17, s29
  s_add_u32 m0, s28, 11264
  s_nop 0
  buffer_load_dwordx4 v144, s[8:11], s17 offen lds
  s_add_u32 s17, s17, s29
  s_waitcnt vmcnt(37)
  ds_read_b64_tr_b16 a[48:49], v152 offset:12288
  ds_read_b64_tr_b16 a[50:51], v153 offset:12288
  ds_read_b64_tr_b16 a[52:53], v154 offset:12288
  ds_read_b64_tr_b16 a[54:55], v155 offset:12288
  ds_read_b64_tr_b16 a[56:57], v152 offset:12352
  ds_read_b64_tr_b16 a[58:59], v153 offset:12352
  ds_read_b64_tr_b16 a[60:61], v154 offset:12352
  ds_read_b64_tr_b16 a[62:63], v155 offset:12352
  s_waitcnt lgkmcnt(0)
  s_add_u32 m0, s28, 12288
  s_nop 0
  buffer_load_dwordx4 v144, s[8:11], s17 offen lds
  s_add_u32 s17, s17, s29
  s_add_u32 m0, s28, 13312
  s_nop 0
  buffer_load_dwordx4 v144, s[8:11], s17 offen lds
  s_add_u32 s17, s17, s29
  s_add_u32 m0, s28, 14336
  s_nop 0
  buffer_load_dwordx4 v144, s[8:11], s17 offen lds
  s_add_u32 s17, s17, s29
  s_add_u32 m0, s28, 15360
  s_nop 0
  buffer_load_dwordx4 v144, s[8:11], s17 offen lds
  s_add_u32 s17, s17, s29
  s_waitcnt vmcnt(37)
  ds_read_b64_tr_b16 a[64:65], v152 offset:16384
  ds_read_b64_tr_b16 a[66:67], v153 offset:16384
  ds_read_b64_tr_b16 a[68:69], v154 offset:16384
  ds_read_b64_tr_b16 a[70:71], v155 offset:16384
  ds_read_b64_tr_b16 a[72:73], v152 offset:16448
  ds_read_b64_tr_b16 a[74:75], v153 offset:16448
  ds_read_b64_tr_b16 a[76:77], v154 offset:16448
  ds_read_b64_tr_b16 a[78:79], v155 offset:16448
  s_waitcnt lgkmcnt(0)
  s_add_u32 m0, s28, 16384
  s_nop 0
  buffer_load_dwordx4 v144, s[8:11], s17 offen lds
  s_add_u32 s17, s17, s29
  s_add_u32 m0, s28, 17408
  s_nop 0
  buffer_load_dwordx4 v144, s[8:11], s17 offen lds
  s_add_u32 s17, s17, s29
  s_add_u32 m0, s28, 18432
  s_nop 0
  buffer_load_dwordx4 v144, s[8:11], s17 offen lds
  s_add_u32 s17, s17, s29
  s_add_u32 m0, s28, 19456
  s_nop 0
  buffer_load_dwordx4 v144, s[8:11], s17 offen lds
  s_add_u32 s17, s17, s29
  s_waitcnt vmcnt(37)
  ds_read_b64_tr_b16 a[80:81], v152 offset:20480
  ds_read_b64_tr_b16 a[82:83], v153 offset:20480
  ds_read_b64_tr_b16 a[84:85], v154 offset:20480
  ds_read_b64_tr_b16 a[86:87], v155 offset:20480
  ds_read_b64_tr_b16 a[88:89], v152 offset:20544
  ds_read_b64_tr_b16 a[90:91], v153 offset:20544
  ds_read_b64_tr_b16 a[92:93], v154 offset:20544
  ds_read_b64_tr_b16 a[94:95], v155 offset:20544
  s_waitcnt lgkmcnt(0)
  s_add_u32 m0, s28, 20480
  s_nop 0
  buffer_load_dwordx4 v144, s[8:11], s17 offen lds
  s_add_u32 s17, s17, s29
  s_add_u32 m0, s28, 21504
  s_nop 0
  buffer_load_dwordx4 v144, s[8:11], s17 offen lds
  s_add_u32 s17, s17, s29
  s_add_u32 m0, s28, 22528
  s_nop 0
  buffer_load_dwordx4 v144, s[8:11], s17 offen lds
  s_add_u32 s17, s17, s29
  s_add_u32 m0, s28, 23552
  s_nop 0
  buffer_load_dwordx4 v144, s[8:11], s17 offen lds
  s_add_u32 s17, s17, s29
  s_waitcnt vmcnt(37)
  ds_read_b64_tr_b16 a[96:97], v152 offset:24576
  ds_read_b64_tr_b16 a[98:99], v153 offset:24576
  ds_read_b64_tr_b16 a[100:101], v154 offset:24576
  ds_read_b64_tr_b16 a[102:103], v155 offset:24576
  ds_read_b64_tr_b16 a[104:105], v152 offset:24640
  ds_read_b64_tr_b16 a[106:107], v153 offset:24640
  ds_read_b64_tr_b16 a[108:109], v154 offset:24640
  ds_read_b64_tr_b16 a[110:111], v155 offset:24640
  s_waitcnt lgkmcnt(0)
  s_add_u32 m0, s28, 24576
  s_nop 0
  buffer_load_dwordx4 v144, s[8:11], s17 offen lds
  s_add_u32 s17, s17, s29
  s_add_u32 m0, s28, 25600
  s_nop 0
  buffer_load_dwordx4 v144, s[8:11], s17 offen lds
  s_add_u32 s17, s17, s29
  s_add_u32 m0, s28, 26624
  s_nop 0
  buffer_load_dwordx4 v144, s[8:11], s17 offen lds
  s_add_u32 s17, s17, s29
  s_add_u32 m0, s28, 27648
  s_nop 0
  buffer_load_dwordx4 v144, s[8:11], s17 offen lds
  s_add_u32 s17, s17, s29
  s_waitcnt vmcnt(37)
  ds_read_b64_tr_b16 a[112:113], v152 offset:28672
  ds_read_b64_tr_b16 a[114:115], v153 offset:28672
  ds_read_b64_tr_b16 a[116:117], v154 offset:28672
  ds_read_b64_tr_b16 a[118:119], v155 offset:28672
  ds_read_b64_tr_b16 a[120:121], v152 offset:28736
  ds_read_b64_tr_b16 a[122:123], v153 offset:28736
  ds_read_b64_tr_b16 a[124:125], v154 offset:28736
  ds_read_b64_tr_b16 a[126:127], v155 offset:28736
  s_waitcnt lgkmcnt(0)
  s_add_u32 m0, s28, 28672
  s_nop 0
  buffer_load_dwordx4 v144, s[8:11], s17 offen lds
  s_add_u32 s17, s17, s29
  s_add_u32 m0, s28, 29696
  s_nop 0
  buffer_load_dwordx4 v144, s[8:11], s17 offen lds
  s_add_u32 s17, s17, s29
  s_add_u32 m0, s28, 30720
  s_nop 0
  buffer_load_dwordx4 v144, s[8:11], s17 offen lds
  s_add_u32 s17, s17, s29
  s_add_u32 m0, s28, 31744
  s_nop 0
  buffer_load_dwordx4 v144, s[8:11], s17 offen lds
  s_add_u32 s17, s17, s29
  s_waitcnt vmcnt(28)
  ds_read_b64_tr_b16 a[128:129], v152 offset:0
  ds_read_b64_tr_b16 a[130:131], v153 offset:0
  ds_read_b64_tr_b16 a[132:133], v154 offset:0
  ds_read_b64_tr_b16 a[134:135], v155 offset:0
  ds_read_b64_tr_b16 a[136:137], v152 offset:64
  ds_read_b64_tr_b16 a[138:139], v153 offset:64
  ds_read_b64_tr_b16 a[140:141], v154 offset:64
  ds_read_b64_tr_b16 a[142:143], v155 offset:64
  s_waitcnt lgkmcnt(0)
  s_waitcnt vmcnt(24)
  ds_read_b64_tr_b16 a[144:145], v152 offset:4096
  ds_read_b64_tr_b16 a[146:147], v153 offset:4096
  ds_read_b64_tr_b16 a[148:149], v154 offset:4096
  ds_read_b64_tr_b16 a[150:151], v155 offset:4096
  ds_read_b64_tr_b16 a[152:153], v152 offset:4160
  ds_read_b64_tr_b16 a[154:155], v153 offset:4160
  ds_read_b64_tr_b16 a[156:157], v154 offset:4160
  ds_read_b64_tr_b16 a[158:159], v155 offset:4160
  s_waitcnt lgkmcnt(0)
  s_waitcnt vmcnt(20)
  ds_read_b64_tr_b16 a[160:161], v152 offset:8192
  ds_read_b64_tr_b16 a[162:163], v153 offset:8192
  ds_read_b64_tr_b16 a[164:165], v154 offset:8192
  ds_read_b64_tr_b16 a[166:167], v155 offset:8192
  ds_read_b64_tr_b16 a[168:169], v152 offset:8256
  ds_read_b64_tr_b16 a[170:171], v153 offset:8256
  ds_read_b64_tr_b16 a[172:173], v154 offset:8256
  ds_read_b64_tr_b16 a[174:175], v155 offset:8256
  s_waitcnt lgkmcnt(0)
  s_waitcnt vmcnt(16)
  ds_read_b64_tr_b16 a[176:177], v152 offset:12288
  ds_read_b64_tr_b16 a[178:179], v153 offset:12288
  ds_read_b64_tr_b16 a[180:181], v154 offset:12288
  ds_read_b64_tr_b16 a[182:183], v155 offset:12288
  ds_read_b64_tr_b16 a[184:185], v152 offset:12352
  ds_read_b64_tr_b16 a[186:187], v153 offset:12352
  ds_read_b64_tr_b16 a[188:189], v154 offset:12352
  ds_read_b64_tr_b16 a[190:191], v155 offset:12352
  s_waitcnt lgkmcnt(0)
  s_waitcnt vmcnt(12)
  ds_read_b64_tr_b16 a[192:193], v152 offset:16384
  ds_read_b64_tr_b16 a[194:195], v153 offset:16384
  ds_read_b64_tr_b16 a[196:197], v154 offset:16384
  ds_read_b64_tr_b16 a[198:199], v155 offset:16384
  ds_read_b64_tr_b16 a[200:201], v152 offset:16448
  ds_read_b64_tr_b16 a[202:203], v153 offset:16448
  ds_read_b64_tr_b16 a[204:205], v154 offset:16448
  ds_read_b64_tr_b16 a[206:207], v155 offset:16448
  s_waitcnt lgkmcnt(0)
  s_waitcnt vmcnt(8)
  ds_read_b64_tr_b16 a[208:209], v152 offset:20480
  ds_read_b64_tr_b16 a[210:211], v153 offset:20480
  ds_read_b64_tr_b16 a[212:213], v154 offset:20480
  ds_read_b64_tr_b16 a[214:215], v155 offset:20480
  ds_read_b64_tr_b16 a[216:217], v152 offset:20544
  ds_read_b64_tr_b16 a[218:219], v153 offset:20544
  ds_read_b64_tr_b16 a[220:221], v154 offset:20544
  ds_read_b64_tr_b16 a[222:223], v155 offset:20544
  s_waitcnt lgkmcnt(0)
  s_waitcnt vmcnt(4)
  ds_read_b64_tr_b16 a[224:225], v152 offset:24576
  ds_read_b64_tr_b16 a[226:227], v153 offset:24576
  ds_read_b64_tr_b16 a[228:229], v154 offset:24576
  ds_read_b64_tr_b16 a[230:231], v155 offset:24576
  ds_read_b64_tr_b16 a[232:233], v152 offset:24640
  ds_read_b64_tr_b16 a[234:235], v153 offset:24640
  ds_read_b64_tr_b16 a[236:237], v154 offset:24640
  ds_read_b64_tr_b16 a[238:239], v155 offset:24640
  s_waitcnt lgkmcnt(0)
  s_waitcnt vmcnt(0)
  ds_read_b64_tr_b16 a[240:241], v152 offset:28672
  ds_read_b64_tr_b16 a[242:243], v153 offset:28672
  ds_read_b64_tr_b16 a[244:245], v154 offset:28672
  ds_read_b64_tr_b16 a[246:247], v155 offset:28672
  ds_read_b64_tr_b16 a[248:249], v152 offset:28736
  ds_read_b64_tr_b16 a[250:251], v153 offset:28736
  ds_read_b64_tr_b16 a[252:253], v154 offset:28736
  ds_read_b64_tr_b16 a[254:255], v155 offset:28736
  s_waitcnt lgkmcnt(0)
  s_barrier
  s_add_u32 m0, s25, 0
  s_nop 0
  buffer_load_dwordx4 v16, s[12:15], s19 offen lds
  s_add_u32 m0, s25, 1024
  s_nop 0
  buffer_load_dwordx4 v17, s[12:15], s19 offen lds
  s_add_u32 m0, s25, 2048
  s_nop 0
  buffer_load_dwordx4 v18, s[12:15], s19 offen lds
  s_add_u32 m0, s25, 3072
  s_nop 0
  buffer_load_dwordx4 v19, s[12:15], s19 offen lds
  s_add_u32 m0, s25, 4096
  s_nop 0
  buffer_load_dwordx4 v20, s[12:15], s19 offen lds
  s_add_u32 m0, s25, 5120
  s_nop 0
  buffer_load_dwordx4 v21, s[12:15], s19 offen lds
  s_add_u32 m0, s25, 6144
  s_nop 0
  buffer_load_dwordx4 v22, s[12:15], s19 offen lds
  s_add_u32 m0, s25, 7168
  s_nop 0
  buffer_load_dwordx4 v23, s[12:15], s19 offen lds
  s_cmp_gt_u32 s23, 2
  s_cselect_b32 s26, s20, 0
  s_add_u32 s19, s19, s26
  s_add_u32 s25, s25, 32768
  s_and_b32 s25, s25, 0x1ffff
  s_waitcnt vmcnt(0)
  s_barrier
  s_load_dwordx2 s[8:9], s[0:1], 40
  s_mul_i32 s76, s66, 18816
  v_min_u32 v200, 146, v0
  v_lshl_add_u32 v200, v200, 7, s76
  s_waitcnt lgkmcnt(0)
  s_and_b32 s9, s9, 0xffff
  buffer_load_dword v201, v200, s[8:11], 0 offen
  s_cmp_lg_u32 s32, 0
  s_cbranch_scc1 P_v_130
  s_cmp_eq_u32 s48, 0
  s_cbranch_scc1 P_q_132
  s_mov_b32 s27, s21
  v_mov_b32 v7, 0x40000000
  s_mov_b32 s29, -2
  v_min_u32 v145, 1, v0
  v_lshlrev_b32 v145, 30, v145
  ds_read_b128 v[24:27], v8 offset:0
  ds_read_b128 v[28:31], v9 offset:0
  ds_read_b128 v[32:35], v10 offset:0
  ds_read_b128 v[36:39], v11 offset:0
  ds_read_b128 v[40:43], v12 offset:0
  ds_read_b128 v[44:47], v13 offset:0
.p2align 6
G_top_133:
  s_waitcnt lgkmcnt(5)
  v_mfma_f32_16x16x32_bf16 v[64:67], a[0:3], v[24:27], 0
  s_add_u32 m0, s25, 0
  ds_read_b128 v[48:51], v14 offset:0
  v_mfma_f32_16x16x32_bf16 v[68:71], a[4:7], v[24:27], 0
  v_mfma_f32_16x16x32_bf16 v[80:83], a[8:11], v[24:27], 0
  buffer_load_dwordx4 v16, s[12:15], s19 offen lds
  v_mfma_f32_16x16x32_bf16 v[84:87], a[12:15], v[24:27], 0
  s_waitcnt lgkmcnt(5)
  v_mfma_f32_16x16x32_bf16 v[72:75], a[0:3], v[28:31], 0
  ds_read_b128 v[52:55], v15 offset:0
  v_mfma_f32_16x16x32_bf16 v[76:79], a[4:7], v[28:31], 0
  v_cvt_pk_bf16_f32 v128, v96, v97
  v_cvt_pk_bf16_f32 v129, v98, v99
  v_mfma_f32_16x16x32_bf16 v[88:91], a[8:11], v[28:31], 0
  v_mfma_f32_16x16x32_bf16 v[92:95], a[12:15], v[28:31], 0
  s_waitcnt lgkmcnt(5)
  v_cvt_pk_bf16_f32 v130, v100, v101
  v_cvt_pk_bf16_f32 v131, v102, v103
  v_mfma_f32_16x16x32_bf16 v[64:67], a[16:19], v[32:35], v[64:67]
  s_add_u32 m0, s25, 1024
  ds_read_b128 v[24:27], v8 offset:8192
  v_mfma_f32_16x16x32_bf16 v[68:71], a[20:23], v[32:35], v[68:71]
  v_mfma_f32_16x16x32_bf16 v[80:83], a[24:27], v[32:35], v[80:83]
  buffer_load_dwordx4 v17, s[12:15], s19 offen lds
  v_mfma_f32_16x16x32_bf16 v[84:87], a[28:31], v[32:35], v[84:87]
  s_waitcnt lgkmcnt(5)
  v_mfma_f32_16x16x32_bf16 v[72:75], a[16:19], v[36:39], v[72:75]
  ds_read_b128 v[28:31], v9 offset:8192
  v_mfma_f32_16x16x32_bf16 v[76:79], a[20:23], v[36:39], v[76:79]
  v_mfma_f32_16x16x32_bf16 v[88:91], a[24:27], v[36:39], v[88:91]
  v_mfma_f32_16x16x32_bf16 v[92:95], a[28:31], v[36:39], v[92:95]
  s_waitcnt lgkmcnt(5)
  v_mfma_f32_16x16x32_bf16 v[64:67], a[32:35], v[40:43], v[64:67]
  s_add_u32 m0, s25, 2048
  ds_read_b128 v[32:35], v10 offset:8192
  v_mfma_f32_16x16x32_bf16 v[68:71], a[36:39], v[40:43], v[68:71]
  v_cvt_pk_bf16_f32 v132, v104, v105
  v_cvt_pk_bf16_f32 v133, v106, v107
  v_mfma_f32_16x16x32_bf16 v[80:83], a[40:43], v[40:43], v[80:83]
  buffer_load_dwordx4 v18, s[12:15], s19 offen lds
  v_mfma_f32_16x16x32_bf16 v[84:87], a[44:47], v[40:43], v[84:87]
  s_waitcnt lgkmcnt(5)
  v_cvt_pk_bf16_f32 v134, v108, v109
  v_cvt_pk_bf16_f32 v135, v110, v111
  v_mfma_f32_16x16x32_bf16 v[72:75], a[32:35], v[44:47], v[72:75]
  ds_read_b128 v[36:39], v11 offset:8192
  v_mfma_f32_16x16x32_bf16 v[76:79], a[36:39], v[44:47], v[76:79]
  v_mfma_f32_16x16x32_bf16 v[88:91], a[40:43], v[44:47], v[88:91]
  v_mfma_f32_16x16x32_bf16 v[92:95], a[44:47], v[44:47], v[92:95]
  s_waitcnt lgkmcnt(5)
  v_mfma_f32_16x16x32_bf16 v[64:67], a[48:51], v[48:51], v[64:67]
  s_add_u32 m0, s25, 3072
  ds_read_b128 v[40:43], v12 offset:8192
  v_mfma_f32_16x16x32_bf16 v[68:71], a[52:55], v[48:51], v[68:71]
  v_mfma_f32_16x16x32_bf16 v[80:83], a[56:59], v[48:51], v[80:83]
  buffer_load_dwordx4 v19, s[12:15], s19 offen lds
  v_mfma_f32_16x16x32_bf16 v[84:87], a[60:63], v[48:51], v[84:87]
  s_waitcnt lgkmcnt(5)
  v_mfma_f32_16x16x32_bf16 v[72:75], a[48:51], v[52:55], v[72:75]
  ds_read_b128 v[44:47], v13 offset:8192
  v_mfma_f32_16x16x32_bf16 v[76:79], a[52:55], v[52:55], v[76:79]
  v_cvt_pk_bf16_f32 v136, v112, v113
  v_cvt_pk_bf16_f32 v137, v114, v115
  v_mfma_f32_16x16x32_bf16 v[88:91], a[56:59], v[52:55], v[88:91]
  v_mfma_f32_16x16x32_bf16 v[92:95], a[60:63], v[52:55], v[92:95]
  s_waitcnt lgkmcnt(5)
  v_cvt_pk_bf16_f32 v138, v116, v117
  v_cvt_pk_bf16_f32 v139, v118, v119
  v_mfma_f32_16x16x32_bf16 v[64:67], a[64:67], v[24:27], v[64:67]
  s_add_u32 m0, s25, 4096
  ds_read_b128 v[48:51], v14 offset:8192
  v_mfma_f32_16x16x32_bf16 v[68:71], a[68:71], v[24:27], v[68:71]
  v_mfma_f32_16x16x32_bf16 v[80:83], a[72:75], v[24:27], v[80:83]
  buffer_load_dwordx4 v20, s[12:15], s19 offen lds
  v_mfma_f32_16x16x32_bf16 v[84:87], a[76:79], v[24:27], v[84:87]
  s_waitcnt lgkmcnt(5)
  v_mfma_f32_16x16x32_bf16 v[72:75], a[64:67], v[28:31], v[72:75]
  ds_read_b128 v[52:55], v15 offset:8192
  v_mfma_f32_16x16x32_bf16 v[76:79], a[68:71], v[28:31], v[76:79]
  v_mfma_f32_16x16x32_bf16 v[88:91], a[72:75], v[28:31], v[88:91]
  v_mfma_f32_16x16x32_bf16 v[92:95], a[76:79], v[28:31], v[92:95]
  s_waitcnt lgkmcnt(5)
  v_mfma_f32_16x16x32_bf16 v[64:67], a[80:83], v[32:35], v[64:67]
  s_add_u32 m0, s25, 5120
  ds_read_b128 v[24:27], v8 offset:16384
  v_mfma_f32_16x16x32_bf16 v[68:71], a[84:87], v[32:35], v[68:71]
  v_cvt_pk_bf16_f32 v140, v120, v121
  v_cvt_pk_bf16_f32 v141, v122, v123
  v_mfma_f32_16x16x32_bf16 v[80:83], a[88:91], v[32:35], v[80:83]
  buffer_load_dwordx4 v21, s[12:15], s19 offen lds
  v_mfma_f32_16x16x32_bf16 v[84:87], a[92:95], v[32:35], v[84:87]
  s_waitcnt lgkmcnt(5)
  v_cvt_pk_bf16_f32 v142, v124, v125
  v_cvt_pk_bf16_f32 v143, v126, v127
  v_mfma_f32_16x16x32_bf16 v[72:75], a[80:83], v[36:39], v[72:75]
  ds_read_b128 v[28:31], v9 offset:16384
  v_mfma_f32_16x16x32_bf16 v[76:79], a[84:87], v[36:39], v[76:79]
  v_mfma_f32_16x16x32_bf16 v[88:91], a[88:91], v[36:39], v[88:91]
  v_mfma_f32_16x16x32_bf16 v[92:95], a[92:95], v[36:39], v[92:95]
  s_waitcnt lgkmcnt(5)
  v_mfma_f32_16x16x32_bf16 v[64:67], a[96:99], v[40:43], v[64:67]
  s_add_u32 m0, s25, 6144
  ds_read_b128 v[32:35], v10 offset:16384
  v_mfma_f32_16x16x32_bf16 v[68:71], a[100:103], v[40:43], v[68:71]
  v_mfma_f32_16x16x32_bf16 v[80:83], a[104:107], v[40:43], v[80:83]
  buffer_load_dwordx4 v22, s[12:15], s19 offen lds
  v_mfma_f32_16x16x32_bf16 v[84:87], a[108:111], v[40:43], v[84:87]
  s_waitcnt lgkmcnt(5)
  v_mfma_f32_16x16x32_bf16 v[72:75], a[96:99], v[44:47], v[72:75]
  ds_read_b128 v[36:39], v11 offset:16384
  v_mfma_f32_16x16x32_bf16 v[76:79], a[100:103], v[44:47], v[76:79]
  v_mfma_f32_16x16x32_bf16 v[88:91], a[104:107], v[44:47], v[88:91]
  v_mfma_f32_16x16x32_bf16 v[92:95], a[108:111], v[44:47], v[92:95]
  s_waitcnt lgkmcnt(5)
  v_mfma_f32_16x16x32_bf16 v[64:67], a[112:115], v[48:51], v[64:67]
  s_add_u32 m0, s25, 7168
  ds_read_b128 v[40:43], v12 offset:16384
  v_mfma_f32_16x16x32_bf16 v[68:71], a[116:119], v[48:51], v[68:71]
  v_mfma_f32_16x16x32_bf16 v[80:83], a[120:123], v[48:51], v[80:83]
  buffer_load_dwordx4 v23, s[12:15], s19 offen lds
  v_mfma_f32_16x16x32_bf16 v[84:87], a[124:127], v[48:51], v[84:87]
  s_waitcnt lgkmcnt(5)
  v_mfma_f32_16x16x32_bf16 v[72:75], a[112:115], v[52:55], v[72:75]
  s_cmp_gt_u32 s23, 3
  ds_read_b128 v[44:47], v13 offset:16384
  v_mfma_f32_16x16x32_bf16 v[76:79], a[116:119], v[52:55], v[76:79]
  v_mfma_f32_16x16x32_bf16 v[88:91], a[120:123], v[52:55], v[88:91]
  s_cselect_b32 s26, s20, 0
  v_mfma_f32_16x16x32_bf16 v[92:95], a[124:127], v[52:55], v[92:95]
  s_waitcnt lgkmcnt(5)
  v_mfma_f32_16x16x32_bf16 v[64:67], a[128:131], v[24:27], v[64:67]
  s_add_u32 s19, s19, s26
  ds_read_b128 v[48:51], v14 offset:16384
  v_mfma_f32_16x16x32_bf16 v[68:71], a[132:135], v[24:27], v[68:71]
  v_mfma_f32_16x16x32_bf16 v[80:83], a[136:139], v[24:27], v[80:83]
  s_add_u32 s25, s25, 32768
  v_mfma_f32_16x16x32_bf16 v[84:87], a[140:143], v[24:27], v[84:87]
  s_waitcnt lgkmcnt(5)
  v_mfma_f32_16x16x32_bf16 v[72:75], a[128:131], v[28:31], v[72:75]
  s_and_b32 s25, s25, 0x1ffff
  ds_read_b128 v[52:55], v15 offset:16384
  v_mfma_f32_16x16x32_bf16 v[76:79], a[132:135], v[28:31], v[76:79]
  v_mfma_f32_16x16x32_bf16 v[88:91], a[136:139], v[28:31], v[88:91]
  buffer_store_dwordx4 v[128:131], v7, s[4:7], s21 offen offset:0 sc1
  v_mfma_f32_16x16x32_bf16 v[92:95], a[140:143], v[28:31], v[92:95]
  s_waitcnt lgkmcnt(5)
  v_mfma_f32_16x16x32_bf16 v[64:67], a[144:147], v[32:35], v[64:67]
  ds_read_b128 v[24:27], v8 offset:24576
  v_mfma_f32_16x16x32_bf16 v[68:71], a[148:151], v[32:35], v[68:71]
  v_mfma_f32_16x16x32_bf16 v[80:83], a[152:155], v[32:35], v[80:83]
  v_mfma_f32_16x16x32_bf16 v[84:87], a[156:159], v[32:35], v[84:87]
  s_waitcnt lgkmcnt(5)
  v_mfma_f32_16x16x32_bf16 v[72:75], a[144:147], v[36:39], v[72:75]
  ds_read_b128 v[28:31], v9 offset:24576
  v_mfma_f32_16x16x32_bf16 v[76:79], a[148:151], v[36:39], v[76:79]
  v_mfma_f32_16x16x32_bf16 v[88:91], a[152:155], v[36:39], v[88:91]
  buffer_store_dwordx4 v[132:135], v7, s[4:7], s21 offen offset:256 sc1
  v_mfma_f32_16x16x32_bf16 v[92:95], a[156:159], v[36:39], v[92:95]
  s_waitcnt lgkmcnt(5)
  v_mfma_f32_16x16x32_bf16 v[64:67], a[160:163], v[40:43], v[64:67]
  ds_read_b128 v[32:35], v10 offset:24576
  v_mfma_f32_16x16x32_bf16 v[68:71], a[164:167], v[40:43], v[68:71]
  v_mfma_f32_16x16x32_bf16 v[80:83], a[168:171], v[40:43], v[80:83]
  v_mfma_f32_16x16x32_bf16 v[84:87], a[172:175], v[40:43], v[84:87]
  s_waitcnt lgkmcnt(5)
  v_mfma_f32_16x16x32_bf16 v[72:75], a[160:163], v[44:47], v[72:75]
  ds_read_b128 v[36:39], v11 offset:24576
  v_mfma_f32_16x16x32_bf16 v[76:79], a[164:167], v[44:47], v[76:79]
  v_mfma_f32_16x16x32_bf16 v[88:91], a[168:171], v[44:47], v[88:91]
  buffer_store_dwordx4 v[136:139], v7, s[4:7], s21 offen offset:2048 sc1
  v_mfma_f32_16x16x32_bf16 v[92:95], a[172:175], v[44:47], v[92:95]
  s_waitcnt lgkmcnt(5)
  v_mfma_f32_16x16x32_bf16 v[64:67], a[176:179], v[48:51], v[64:67]
  ds_read_b128 v[40:43], v12 offset:24576
  v_mfma_f32_16x16x32_bf16 v[68:71], a[180:183], v[48:51], v[68:71]
  v_mfma_f32_16x16x32_bf16 v[80:83], a[184:187], v[48:51], v[80:83]
  v_mfma_f32_16x16x32_bf16 v[84:87], a[188:191], v[48:51], v[84:87]
  s_waitcnt lgkmcnt(5)
  v_mfma_f32_16x16x32_bf16 v[72:75], a[176:179], v[52:55], v[72:75]
  ds_read_b128 v[44:47], v13 offset:24576
  v_mfma_f32_16x16x32_bf16 v[76:79], a[180:183], v[52:55], v[76:79]
  v_mfma_f32_16x16x32_bf16 v[88:91], a[184:187], v[52:55], v[88:91]
  buffer_store_dwordx4 v[140:143], v7, s[4:7], s21 offen offset:2304 sc1
  v_mfma_f32_16x16x32_bf16 v[92:95], a[188:191], v[52:55], v[92:95]
  s_waitcnt lgkmcnt(5)
  v_mfma_f32_16x16x32_bf16 v[64:67], a[192:195], v[24:27], v[64:67]
  s_mov_b32 s21, s27
  ds_read_b128 v[48:51], v14 offset:24576
  v_mfma_f32_16x16x32_bf16 v[68:71], a[196:199], v[24:27], v[68:71]
  v_mov_b32 v7, v56
  v_mfma_f32_16x16x32_bf16 v[80:83], a[200:203], v[24:27], v[80:83]
  v_mfma_f32_16x16x32_bf16 v[84:87], a[204:207], v[24:27], v[84:87]
  s_waitcnt lgkmcnt(5)
  v_mfma_f32_16x16x32_bf16 v[72:75], a[192:195], v[28:31], v[72:75]
  s_add_u32 s27, s27, s22
  ds_read_b128 v[52:55], v15 offset:24576
  v_mfma_f32_16x16x32_bf16 v[76:79], a[196:199], v[28:31], v[76:79]
  v_mfma_f32_16x16x32_bf16 v[88:91], a[200:203], v[28:31], v[88:91]
  s_waitcnt vmcnt(13)
  s_barrier
  v_mfma_f32_16x16x32_bf16 v[92:95], a[204:207], v[28:31], v[92:95]
  s_waitcnt lgkmcnt(5)
  v_mfma_f32_16x16x32_bf16 v[64:67], a[208:211], v[32:35], v[64:67]
  ds_read_b128 v[24:27], v8 offset:32768
  v_mfma_f32_16x16x32_bf16 v[68:71], a[212:215], v[32:35], v[68:71]
  v_mfma_f32_16x16x32_bf16 v[80:83], a[216:219], v[32:35], v[80:83]
  v_mfma_f32_16x16x32_bf16 v[84:87], a[220:223], v[32:35], v[84:87]
  s_waitcnt lgkmcnt(5)
  v_mfma_f32_16x16x32_bf16 v[72:75], a[208:211], v[36:39], v[72:75]
  s_add_u32 s29, s29, 1
  ds_read_b128 v[28:31], v9 offset:32768
  v_mfma_f32_16x16x32_bf16 v[76:79], a[212:215], v[36:39], v[76:79]
  v_mfma_f32_16x16x32_bf16 v[88:91], a[216:219], v[36:39], v[88:91]
  s_max_i32 s30, s29, 0
  v_mfma_f32_16x16x32_bf16 v[92:95], a[220:223], v[36:39], v[92:95]
  s_waitcnt lgkmcnt(5)
  v_mov_b32 v144, s30
  v_mfma_f32_16x16x32_bf16 v[64:67], a[224:227], v[40:43], v[64:67]
  ds_read_b128 v[32:35], v10 offset:32768
  v_mfma_f32_16x16x32_bf16 v[68:71], a[228:231], v[40:43], v[68:71]
  v_mfma_f32_16x16x32_bf16 v[80:83], a[232:235], v[40:43], v[80:83]
  buffer_store_dword v144, v145, s[4:7], s31 offen sc1
  v_mfma_f32_16x16x32_bf16 v[84:87], a[236:239], v[40:43], v[84:87]
  s_waitcnt lgkmcnt(5)
  v_mfma_f32_16x16x32_bf16 v[72:75], a[224:227], v[44:47], v[72:75]
  ds_read_b128 v[36:39], v11 offset:32768
  v_mfma_f32_16x16x32_bf16 v[76:79], a[228:231], v[44:47], v[76:79]
  v_mfma_f32_16x16x32_bf16 v[88:91], a[232:235], v[44:47], v[88:91]
  v_mfma_f32_16x16x32_bf16 v[92:95], a[236:239], v[44:47], v[92:95]
  s_waitcnt lgkmcnt(5)
  v_mfma_f32_16x16x32_bf16 v[64:67], a[240:243], v[48:51], v[64:67]
  s_sub_u32 s23, s23, 1
  ds_read_b128 v[40:43], v12 offset:32768
  v_mfma_f32_16x16x32_bf16 v[68:71], a[244:247], v[48:51], v[68:71]
  v_mfma_f32_16x16x32_bf16 v[80:83], a[248:251], v[48:51], v[80:83]
  v_mfma_f32_16x16x32_bf16 v[84:87], a[252:255], v[48:51], v[84:87]
  s_waitcnt lgkmcnt(5)
  v_mfma_f32_16x16x32_bf16 v[72:75], a[240:243], v[52:55], v[72:75]
  s_cmp_eq_u32 s23, 0
  ds_read_b128 v[44:47], v13 offset:32768
  v_mfma_f32_16x16x32_bf16 v[76:79], a[244:247], v[52:55], v[76:79]
  v_mfma_f32_16x16x32_bf16 v[88:91], a[248:251], v[52:55], v[88:91]
  v_mfma_f32_16x16x32_bf16 v[92:95], a[252:255], v[52:55], v[92:95]
  s_cbranch_scc1 G_done0_134
  s_waitcnt lgkmcnt(5)
  v_mfma_f32_16x16x32_bf16 v[96:99], a[0:3], v[24:27], 0
  s_add_u32 m0, s25, 0
  ds_read_b128 v[48:51], v14 offset:32768
  v_mfma_f32_16x16x32_bf16 v[100:103], a[4:7], v[24:27], 0
  v_mfma_f32_16x16x32_bf16 v[112:115], a[8:11], v[24:27], 0
  buffer_load_dwordx4 v16, s[12:15], s19 offen lds
  v_mfma_f32_16x16x32_bf16 v[116:119], a[12:15], v[24:27], 0
  s_waitcnt lgkmcnt(5)
  v_mfma_f32_16x16x32_bf16 v[104:107], a[0:3], v[28:31], 0
  ds_read_b128 v[52:55], v15 offset:32768
  v_mfma_f32_16x16x32_bf16 v[108:111], a[4:7], v[28:31], 0
  v_cvt_pk_bf16_f32 v128, v64, v65
  v_cvt_pk_bf16_f32 v129, v66, v67
  v_mfma_f32_16x16x32_bf16 v[120:123], a[8:11], v[28:31], 0
  v_mfma_f32_16x16x32_bf16 v[124:127], a[12:15], v[28:31], 0
  s_waitcnt lgkmcnt(5)
  v_cvt_pk_bf16_f32 v130, v68, v69
  v_cvt_pk_bf16_f32 v131, v70, v71
  v_mfma_f32_16x16x32_bf16 v[96:99], a[16:19], v[32:35], v[96:99]
  s_add_u32 m0, s25, 1024
  ds_read_b128 v[24:27], v8 offset:40960
  v_mfma_f32_16x16x32_bf16 v[100:103], a[20:23], v[32:35], v[100:103]
  v_mfma_f32_16x16x32_bf16 v[112:115], a[24:27], v[32:35], v[112:115]
  buffer_load_dwordx4 v17, s[12:15], s19 offen lds
  v_mfma_f32_16x16x32_bf16 v[116:119], a[28:31], v[32:35], v[116:119]
  s_waitcnt lgkmcnt(5)
  v_mfma_f32_16x16x32_bf16 v[104:107], a[16:19], v[36:39], v[104:107]
  ds_read_b128 v[28:31], v9 offset:40960
  v_mfma_f32_16x16x32_bf16 v[108:111], a[20:23], v[36:39], v[108:111]
  v_mfma_f32_16x16x32_bf16 v[120:123], a[24:27], v[36:39], v[120:123]
  v_mfma_f32_16x16x32_bf16 v[124:127], a[28:31], v[36:39], v[124:127]
  s_waitcnt lgkmcnt(5)
  v_mfma_f32_16x16x32_bf16 v[96:99], a[32:35], v[40:43], v[96:99]
  s_add_u32 m0, s25, 2048
  ds_read_b128 v[32:35], v10 offset:40960
  v_mfma_f32_16x16x32_bf16 v[100:103], a[36:39], v[40:43], v[100:103]
  v_cvt_pk_bf16_f32 v132, v72, v73
  v_cvt_pk_bf16_f32 v133, v74, v75
  v_mfma_f32_16x16x32_bf16 v[112:115], a[40:43], v[40:43], v[112:115]
  buffer_load_dwordx4 v18, s[12:15], s19 offen lds
  v_mfma_f32_16x16x32_bf16 v[116:119], a[44:47], v[40:43], v[116:119]
  s_waitcnt lgkmcnt(5)
  v_cvt_pk_bf16_f32 v134, v76, v77
  v_cvt_pk_bf16_f32 v135, v78, v79
  v_mfma_f32_16x16x32_bf16 v[104:107], a[32:35], v[44:47], v[104:107]
  ds_read_b128 v[36:39], v11 offset:40960
  v_mfma_f32_16x16x32_bf16 v[108:111], a[36:39], v[44:47], v[108:111]
  v_mfma_f32_16x16x32_bf16 v[120:123], a[40:43], v[44:47], v[120:123]
  v_mfma_f32_16x16x32_bf16 v[124:127], a[44:47], v[44:47], v[124:127]
  s_waitcnt lgkmcnt(5)
  v_mfma_f32_16x16x32_bf16 v[96:99], a[48:51], v[48:51], v[96:99]
  s_add_u32 m0, s25, 3072
  ds_read_b128 v[40:43], v12 offset:40960
  v_mfma_f32_16x16x32_bf16 v[100:103], a[52:55], v[48:51], v[100:103]
  v_mfma_f32_16x16x32_bf16 v[112:115], a[56:59], v[48:51], v[112:115]
  buffer_load_dwordx4 v19, s[12:15], s19 offen lds
  v_mfma_f32_16x16x32_bf16 v[116:119], a[60:63], v[48:51], v[116:119]
  s_waitcnt lgkmcnt(5)
  v_mfma_f32_16x16x32_bf16 v[104:107], a[48:51], v[52:55], v[104:107]
  ds_read_b128 v[44:47], v13 offset:40960
  v_mfma_f32_16x16x32_bf16 v[108:111], a[52:55], v[52:55], v[108:111]
  v_cvt_pk_bf16_f32 v136, v80, v81
  v_cvt_pk_bf16_f32 v137, v82, v83
  v_mfma_f32_16x16x32_bf16 v[120:123], a[56:59], v[52:55], v[120:123]
  v_mfma_f32_16x16x32_bf16 v[124:127], a[60:63], v[52:55], v[124:127]
  s_waitcnt lgkmcnt(5)
  v_cvt_pk_bf16_f32 v138, v84, v85
  v_cvt_pk_bf16_f32 v139, v86, v87
  v_mfma_f32_16x16x32_bf16 v[96:99], a[64:67], v[24:27], v[96:99]
  s_add_u32 m0, s25, 4096
  ds_read_b128 v[48:51], v14 offset:40960
  v_mfma_f32_16x16x32_bf16 v[100:103], a[68:71], v[24:27], v[100:103]
  v_mfma_f32_16x16x32_bf16 v[112:115], a[72:75], v[24:27], v[112:115]
  buffer_load_dwordx4 v20, s[12:15], s19 offen lds
  v_mfma_f32_16x16x32_bf16 v[116:119], a[76:79], v[24:27], v[116:119]
  s_waitcnt lgkmcnt(5)
  v_mfma_f32_16x16x32_bf16 v[104:107], a[64:67], v[28:31], v[104:107]
  ds_read_b128 v[52:55], v15 offset:40960
  v_mfma_f32_16x16x32_bf16 v[108:111], a[68:71], v[28:31], v[108:111]
  v_mfma_f32_16x16x32_bf16 v[120:123], a[72:75], v[28:31], v[120:123]
  v_mfma_f32_16x16x32_bf16 v[124:127], a[76:79], v[28:31], v[124:127]
  s_waitcnt lgkmcnt(5)
  v_mfma_f32_16x16x32_bf16 v[96:99], a[80:83], v[32:35], v[96:99]
  s_add_u32 m0, s25, 5120
  ds_read_b128 v[24:27], v8 offset:49152
  v_mfma_f32_16x16x32_bf16 v[100:103], a[84:87], v[32:35], v[100:103]
  v_cvt_pk_bf16_f32 v140, v88, v89
  v_cvt_pk_bf16_f32 v141, v90, v91
  v_mfma_f32_16x16x32_bf16 v[112:115], a[88:91], v[32:35], v[112:115]
  buffer_load_dwordx4 v21, s[12:15], s19 offen lds
  v_mfma_f32_16x16x32_bf16 v[116:119], a[92:95], v[32:35], v[116:119]
  s_waitcnt lgkmcnt(5)
  v_cvt_pk_bf16_f32 v142, v92, v93
  v_cvt_pk_bf16_f32 v143, v94, v95
  v_mfma_f32_16x16x32_bf16 v[104:107], a[80:83], v[36:39], v[104:107]
  ds_read_b128 v[28:31], v9 offset:49152
  v_mfma_f32_16x16x32_bf16 v[108:111], a[84:87], v[36:39], v[108:111]
  v_mfma_f32_16x16x32_bf16 v[120:123], a[88:91], v[36:39], v[120:123]
  v_mfma_f32_16x16x32_bf16 v[124:127], a[92:95], v[36:39], v[124:127]
  s_waitcnt lgkmcnt(5)
  v_mfma_f32_16x16x32_bf16 v[96:99], a[96:99], v[40:43], v[96:99]
  s_add_u32 m0, s25, 6144
  ds_read_b128 v[32:35], v10 offset:49152
  v_mfma_f32_16x16x32_bf16 v[100:103], a[100:103], v[40:43], v[100:103]
  v_mfma_f32_16x16x32_bf16 v[112:115], a[104:107], v[40:43], v[112:115]
  buffer_load_dwordx4 v22, s[12:15], s19 offen lds
  v_mfma_f32_16x16x32_bf16 v[116:119], a[108:111], v[40:43], v[116:119]
  s_waitcnt lgkmcnt(5)
  v_mfma_f32_16x16x32_bf16 v[104:107], a[96:99], v[44:47], v[104:107]
  ds_read_b128 v[36:39], v11 offset:49152
  v_mfma_f32_16x16x32_bf16 v[108:111], a[100:103], v[44:47], v[108:111]
  v_mfma_f32_16x16x32_bf16 v[120:123], a[104:107], v[44:47], v[120:123]
  v_mfma_f32_16x16x32_bf16 v[124:127], a[108:111], v[44:47], v[124:127]
  s_waitcnt lgkmcnt(5)
  v_mfma_f32_16x16x32_bf16 v[96:99], a[112:115], v[48:51], v[96:99]
  s_add_u32 m0, s25, 7168
  ds_read_b128 v[40:43], v12 offset:49152
  v_mfma_f32_16x16x32_bf16 v[100:103], a[116:119], v[48:51], v[100:103]
  v_mfma_f32_16x16x32_bf16 v[112:115], a[120:123], v[48:51], v[112:115]
  buffer_load_dwordx4 v23, s[12:15], s19 offen lds
  v_mfma_f32_16x16x32_bf16 v[116:119], a[124:127], v[48:51], v[116:119]
  s_waitcnt lgkmcnt(5)
  v_mfma_f32_16x16x32_bf16 v[104:107], a[112:115], v[52:55], v[104:107]
  s_cmp_gt_u32 s23, 3
  ds_read_b128 v[44:47], v13 offset:49152
  v_mfma_f32_16x16x32_bf16 v[108:111], a[116:119], v[52:55], v[108:111]
  v_mfma_f32_16x16x32_bf16 v[120:123], a[120:123], v[52:55], v[120:123]
  s_cselect_b32 s26, s20, 0
  v_mfma_f32_16x16x32_bf16 v[124:127], a[124:127], v[52:55], v[124:127]
  s_waitcnt lgkmcnt(5)
  v_mfma_f32_16x16x32_bf16 v[96:99], a[128:131], v[24:27], v[96:99]
  s_add_u32 s19, s19, s26
  ds_read_b128 v[48:51], v14 offset:49152
  v_mfma_f32_16x16x32_bf16 v[100:103], a[132:135], v[24:27], v[100:103]
  v_mfma_f32_16x16x32_bf16 v[112:115], a[136:139], v[24:27], v[112:115]
  s_add_u32 s25, s25, 32768
  v_mfma_f32_16x16x32_bf16 v[116:119], a[140:143], v[24:27], v[116:119]
  s_waitcnt lgkmcnt(5)
  v_mfma_f32_16x16x32_bf16 v[104:107], a[128:131], v[28:31], v[104:107]
  s_and_b32 s25, s25, 0x1ffff
  ds_read_b128 v[52:55], v15 offset:49152
  v_mfma_f32_16x16x32_bf16 v[108:111], a[132:135], v[28:31], v[108:111]
  v_mfma_f32_16x16x32_bf16 v[120:123], a[136:139], v[28:31], v[120:123]
  buffer_store_dwordx4 v[128:131], v7, s[4:7], s21 offen offset:0 sc1
  v_mfma_f32_16x16x32_bf16 v[124:127], a[140:143], v[28:31], v[124:127]
  s_waitcnt lgkmcnt(5)
  v_mfma_f32_16x16x32_bf16 v[96:99], a[144:147], v[32:35], v[96:99]
  ds_read_b128 v[24:27], v8 offset:57344
  v_mfma_f32_16x16x32_bf16 v[100:103], a[148:151], v[32:35], v[100:103]
  v_mfma_f32_16x16x32_bf16 v[112:115], a[152:155], v[32:35], v[112:115]
  v_mfma_f32_16x16x32_bf16 v[116:119], a[156:159], v[32:35], v[116:119]
  s_waitcnt lgkmcnt(5)
  v_xor_b32 v8, 0x10000, v8
  v_mfma_f32_16x16x32_bf16 v[104:107], a[144:147], v[36:39], v[104:107]
  ds_read_b128 v[28:31], v9 offset:57344
  v_mfma_f32_16x16x32_bf16 v[108:111], a[148:151], v[36:39], v[108:111]
  v_mfma_f32_16x16x32_bf16 v[120:123], a[152:155], v[36:39], v[120:123]
  buffer_store_dwordx4 v[132:135], v7, s[4:7], s21 offen offset:256 sc1
  v_mfma_f32_16x16x32_bf16 v[124:127], a[156:159], v[36:39], v[124:127]
  s_waitcnt lgkmcnt(5)
  v_xor_b32 v9, 0x10000, v9
  v_mfma_f32_16x16x32_bf16 v[96:99], a[160:163], v[40:43], v[96:99]
  ds_read_b128 v[32:35], v10 offset:57344
  v_mfma_f32_16x16x32_bf16 v[100:103], a[164:167], v[40:43], v[100:103]
  v_mfma_f32_16x16x32_bf16 v[112:115], a[168:171], v[40:43], v[112:115]
  v_mfma_f32_16x16x32_bf16 v[116:119], a[172:175], v[40:43], v[116:119]
  s_waitcnt lgkmcnt(5)
  v_xor_b32 v10, 0x10000, v10
  v_mfma_f32_16x16x32_bf16 v[104:107], a[160:163], v[44:47], v[104:107]
  ds_read_b128 v[36:39], v11 offset:57344
  v_mfma_f32_16x16x32_bf16 v[108:111], a[164:167], v[44:47], v[108:111]
  v_mfma_f32_16x16x32_bf16 v[120:123], a[168:171], v[44:47], v[120:123]
  buffer_store_dwordx4 v[136:139], v7, s[4:7], s21 offen offset:2048 sc1
  v_mfma_f32_16x16x32_bf16 v[124:127], a[172:175], v[44:47], v[124:127]
  s_waitcnt lgkmcnt(5)
  v_xor_b32 v11, 0x10000, v11
  v_mfma_f32_16x16x32_bf16 v[96:99], a[176:179], v[48:51], v[96:99]
  ds_read_b128 v[40:43], v12 offset:57344
  v_mfma_f32_16x16x32_bf16 v[100:103], a[180:183], v[48:51], v[100:103]
  v_mfma_f32_16x16x32_bf16 v[112:115], a[184:187], v[48:51], v[112:115]
  v_mfma_f32_16x16x32_bf16 v[116:119], a[188:191], v[48:51], v[116:119]
  s_waitcnt lgkmcnt(5)
  v_xor_b32 v12, 0x10000, v12
  v_mfma_f32_16x16x32_bf16 v[104:107], a[176:179], v[52:55], v[104:107]
  ds_read_b128 v[44:47], v13 offset:57344
  v_mfma_f32_16x16x32_bf16 v[108:111], a[180:183], v[52:55], v[108:111]
  v_mfma_f32_16x16x32_bf16 v[120:123], a[184:187], v[52:55], v[120:123]
  buffer_store_dwordx4 v[140:143], v7, s[4:7], s21 offen offset:2304 sc1
  v_mfma_f32_16x16x32_bf16 v[124:127], a[188:191], v[52:55], v[124:127]
  s_waitcnt lgkmcnt(5)
  v_xor_b32 v13, 0x10000, v13
  v_mfma_f32_16x16x32_bf16 v[96:99], a[192:195], v[24:27], v[96:99]
  s_mov_b32 s21, s27
  ds_read_b128 v[48:51], v14 offset:57344
  v_mfma_f32_16x16x32_bf16 v[100:103], a[196:199], v[24:27], v[100:103]
  v_mov_b32 v7, v56
  v_mfma_f32_16x16x32_bf16 v[112:115], a[200:203], v[24:27], v[112:115]
  v_mfma_f32_16x16x32_bf16 v[116:119], a[204:207], v[24:27], v[116:119]
  s_waitcnt lgkmcnt(5)
  v_xor_b32 v14, 0x10000, v14
  v_mfma_f32_16x16x32_bf16 v[104:107], a[192:195], v[28:31], v[104:107]
  s_add_u32 s27, s27, s22
  ds_read_b128 v[52:55], v15 offset:57344
  v_mfma_f32_16x16x32_bf16 v[108:111], a[196:199], v[28:31], v[108:111]
  v_mfma_f32_16x16x32_bf16 v[120:123], a[200:203], v[28:31], v[120:123]
  s_waitcnt vmcnt(13)
  s_barrier
  v_mfma_f32_16x16x32_bf16 v[124:127], a[204:207], v[28:31], v[124:127]
  s_waitcnt lgkmcnt(5)
  v_xor_b32 v15, 0x10000, v15
  v_mfma_f32_16x16x32_bf16 v[96:99], a[208:211], v[32:35], v[96:99]
  ds_read_b128 v[24:27], v8 offset:0
  v_mfma_f32_16x16x32_bf16 v[100:103], a[212:215], v[32:35], v[100:103]
  v_mfma_f32_16x16x32_bf16 v[112:115], a[216:219], v[32:35], v[112:115]
  v_mfma_f32_16x16x32_bf16 v[116:119], a[220:223], v[32:35], v[116:119]
  s_waitcnt lgkmcnt(5)
  v_mfma_f32_16x16x32_bf16 v[104:107], a[208:211], v[36:39], v[104:107]
  s_add_u32 s29, s29, 1
  ds_read_b128 v[28:31], v9 offset:0
  v_mfma_f32_16x16x32_bf16 v[108:111], a[212:215], v[36:39], v[108:111]
  v_mfma_f32_16x16x32_bf16 v[120:123], a[216:219], v[36:39], v[120:123]
  s_max_i32 s30, s29, 0
  v_mfma_f32_16x16x32_bf16 v[124:127], a[220:223], v[36:39], v[124:127]
  s_waitcnt lgkmcnt(5)
  v_mov_b32 v144, s30
  v_mfma_f32_16x16x32_bf16 v[96:99], a[224:227], v[40:43], v[96:99]
  ds_read_b128 v[32:35], v10 offset:0
  v_mfma_f32_16x16x32_bf16 v[100:103], a[228:231], v[40:43], v[100:103]
  v_mfma_f32_16x16x32_bf16 v[112:115], a[232:235], v[40:43], v[112:115]
  buffer_store_dword v144, v145, s[4:7], s31 offen sc1
  v_mfma_f32_16x16x32_bf16 v[116:119], a[236:239], v[40:43], v[116:119]
  s_waitcnt lgkmcnt(5)
  v_mfma_f32_16x16x32_bf16 v[104:107], a[224:227], v[44:47], v[104:107]
  ds_read_b128 v[36:39], v11 offset:0
  v_mfma_f32_16x16x32_bf16 v[108:111], a[228:231], v[44:47], v[108:111]
  v_mfma_f32_16x16x32_bf16 v[120:123], a[232:235], v[44:47], v[120:123]
  v_mfma_f32_16x16x32_bf16 v[124:127], a[236:239], v[44:47], v[124:127]
  s_waitcnt lgkmcnt(5)
  v_mfma_f32_16x16x32_bf16 v[96:99], a[240:243], v[48:51], v[96:99]
  s_sub_u32 s23, s23, 1
  ds_read_b128 v[40:43], v12 offset:0
  v_mfma_f32_16x16x32_bf16 v[100:103], a[244:247], v[48:51], v[100:103]
  v_mfma_f32_16x16x32_bf16 v[112:115], a[248:251], v[48:51], v[112:115]
  v_mfma_f32_16x16x32_bf16 v[116:119], a[252:255], v[48:51], v[116:119]
  s_waitcnt lgkmcnt(5)
  v_mfma_f32_16x16x32_bf16 v[104:107], a[240:243], v[52:55], v[104:107]
  s_cmp_eq_u32 s23, 0
  ds_read_b128 v[44:47], v13 offset:0
  v_mfma_f32_16x16x32_bf16 v[108:111], a[244:247], v[52:55], v[108:111]
  v_mfma_f32_16x16x32_bf16 v[120:123], a[248:251], v[52:55], v[120:123]
  v_mfma_f32_16x16x32_bf16 v[124:127], a[252:255], v[52:55], v[124:127]
  s_cbranch_scc1 G_done1_135
  s_branch G_top_133
G_done0_134:
  s_nop 7
  s_nop 3
  v_cvt_pk_bf16_f32 v128, v64, v65
  v_cvt_pk_bf16_f32 v129, v66, v67
  v_cvt_pk_bf16_f32 v130, v68, v69
  v_cvt_pk_bf16_f32 v131, v70, v71
  buffer_store_dwordx4 v[128:131], v7, s[4:7], s21 offen offset:0 sc1
  v_cvt_pk_bf16_f32 v132, v72, v73
  v_cvt_pk_bf16_f32 v133, v74, v75
  v_cvt_pk_bf16_f32 v134, v76, v77
  v_cvt_pk_bf16_f32 v135, v78, v79
  buffer_store_dwordx4 v[132:135], v7, s[4:7], s21 offen offset:256 sc1
  v_cvt_pk_bf16_f32 v136, v80, v81
  v_cvt_pk_bf16_f32 v137, v82, v83
  v_cvt_pk_bf16_f32 v138, v84, v85
  v_cvt_pk_bf16_f32 v139, v86, v87
  buffer_store_dwordx4 v[136:139], v7, s[4:7], s21 offen offset:2048 sc1
  v_cvt_pk_bf16_f32 v140, v88, v89
  v_cvt_pk_bf16_f32 v141, v90, v91
  v_cvt_pk_bf16_f32 v142, v92, v93
  v_cvt_pk_bf16_f32 v143, v94, v95
  buffer_store_dwordx4 v[140:143], v7, s[4:7], s21 offen offset:2304 sc1
  s_branch G_fin_136
G_done1_135:
  s_nop 7
  s_nop 3
  v_cvt_pk_bf16_f32 v128, v96, v97
  v_cvt_pk_bf16_f32 v129, v98, v99
  v_cvt_pk_bf16_f32 v130, v100, v101
  v_cvt_pk_bf16_f32 v131, v102, v103
  buffer_store_dwordx4 v[128:131], v7, s[4:7], s21 offen offset:0 sc1
  v_cvt_pk_bf16_f32 v132, v104, v105
  v_cvt_pk_bf16_f32 v133, v106, v107
  v_cvt_pk_bf16_f32 v134, v108, v109
  v_cvt_pk_bf16_f32 v135, v110, v111
  buffer_store_dwordx4 v[132:135], v7, s[4:7], s21 offen offset:256 sc1
  v_cvt_pk_bf16_f32 v136, v112, v113
  v_cvt_pk_bf16_f32 v137, v114, v115
  v_cvt_pk_bf16_f32 v138, v116, v117
  v_cvt_pk_bf16_f32 v139, v118, v119
  buffer_store_dwordx4 v[136:139], v7, s[4:7], s21 offen offset:2048 sc1
  v_cvt_pk_bf16_f32 v140, v120, v121
  v_cvt_pk_bf16_f32 v141, v122, v123
  v_cvt_pk_bf16_f32 v142, v124, v125
  v_cvt_pk_bf16_f32 v143, v126, v127
  buffer_store_dwordx4 v[140:143], v7, s[4:7], s21 offen offset:2304 sc1
G_fin_136:
  s_waitcnt vmcnt(0) lgkmcnt(0)
  s_barrier
  s_add_u32 s30, s29, 2
  v_mov_b32 v144, s30
  v_min_u32 v145, 1, v0
  v_lshlrev_b32 v145, 30, v145
  buffer_store_dword v144, v145, s[4:7], s31 offen sc1
  s_branch P_end_131
P_q_132:
  s_mov_b32 s27, s21
  v_mov_b32 v7, 0x40000000
  s_mov_b32 s29, -2
  v_min_u32 v145, 1, v0
  v_lshlrev_b32 v145, 30, v145
  ds_read_b128 v[24:27], v8 offset:0
  ds_read_b128 v[28:31], v9 offset:0
  ds_read_b128 v[32:35], v10 offset:0
  ds_read_b128 v[36:39], v11 offset:0
  ds_read_b128 v[40:43], v12 offset:0
  ds_read_b128 v[44:47], v13 offset:0
.p2align 6
G_top_137:
  s_waitcnt lgkmcnt(5)
  v_mfma_f32_16x16x32_bf16 v[64:67], a[0:3], v[24:27], 0
  s_add_u32 m0, s25, 0
  ds_read_b128 v[48:51], v14 offset:0
  v_mfma_f32_16x16x32_bf16 v[68:71], a[4:7], v[24:27], 0
  v_mfma_f32_16x16x32_bf16 v[80:83], a[8:11], v[24:27], 0
  buffer_load_dwordx4 v16, s[12:15], s19 offen lds
  v_mfma_f32_16x16x32_bf16 v[84:87], a[12:15], v[24:27], 0
  s_waitcnt lgkmcnt(5)
  v_mfma_f32_16x16x32_bf16 v[72:75], a[0:3], v[28:31], 0
  ds_read_b128 v[52:55], v15 offset:0
  v_mfma_f32_16x16x32_bf16 v[76:79], a[4:7], v[28:31], 0
  v_mul_f32 v96, s24, v96
  v_mul_f32 v97, s24, v97
  v_mfma_f32_16x16x32_bf16 v[88:91], a[8:11], v[28:31], 0
  v_mfma_f32_16x16x32_bf16 v[92:95], a[12:15], v[28:31], 0
  s_waitcnt lgkmcnt(5)
  v_cvt_pk_bf16_f32 v128, v96, v97
  v_mul_f32 v98, s24, v98
  v_mfma_f32_16x16x32_bf16 v[64:67], a[16:19], v[32:35], v[64:67]
  s_add_u32 m0, s25, 1024
  ds_read_b128 v[24:27], v8 offset:8192
  v_mfma_f32_16x16x32_bf16 v[68:71], a[20:23], v[32:35], v[68:71]
  v_mul_f32 v99, s24, v99
  v_cvt_pk_bf16_f32 v129, v98, v99
  v_mfma_f32_16x16x32_bf16 v[80:83], a[24:27], v[32:35], v[80:83]
  buffer_load_dwordx4 v17, s[12:15], s19 offen lds
  v_mfma_f32_16x16x32_bf16 v[84:87], a[28:31], v[32:35], v[84:87]
  s_waitcnt lgkmcnt(5)
  v_mul_f32 v100, s24, v100
  v_mul_f32 v101, s24, v101
  v_mfma_f32_16x16x32_bf16 v[72:75], a[16:19], v[36:39], v[72:75]
  ds_read_b128 v[28:31], v9 offset:8192
  v_mfma_f32_16x16x32_bf16 v[76:79], a[20:23], v[36:39], v[76:79]
  v_cvt_pk_bf16_f32 v130, v100, v101
  v_mul_f32 v102, s24, v102
  v_mfma_f32_16x16x32_bf16 v[88:91], a[24:27], v[36:39], v[88:91]
  v_mfma_f32_16x16x32_bf16 v[92:95], a[28:31], v[36:39], v[92:95]
  s_waitcnt lgkmcnt(5)
  v_mul_f32 v103, s24, v103
  v_cvt_pk_bf16_f32 v131, v102, v103
  v_mfma_f32_16x16x32_bf16 v[64:67], a[32:35], v[40:43], v[64:67]
  s_add_u32 m0, s25, 2048
  ds_read_b128 v[32:35], v10 offset:8192
  v_mfma_f32_16x16x32_bf16 v[68:71], a[36:39], v[40:43], v[68:71]
  v_mul_f32 v104, s24, v104
  v_mul_f32 v105, s24, v105
  v_mfma_f32_16x16x32_bf16 v[80:83], a[40:43], v[40:43], v[80:83]
  buffer_load_dwordx4 v18, s[12:15], s19 offen lds
  v_mfma_f32_16x16x32_bf16 v[84:87], a[44:47], v[40:43], v[84:87]
  s_waitcnt lgkmcnt(5)
  v_cvt_pk_bf16_f32 v132, v104, v105
  v_mul_f32 v106, s24, v106
  v_mfma_f32_16x16x32_bf16 v[72:75], a[32:35], v[44:47], v[72:75]
  ds_read_b128 v[36:39], v11 offset:8192
  v_mfma_f32_16x16x32_bf16 v[76:79], a[36:39], v[44:47], v[76:79]
  v_mul_f32 v107, s24, v107
  v_cvt_pk_bf16_f32 v133, v106, v107
  v_mfma_f32_16x16x32_bf16 v[88:91], a[40:43], v[44:47], v[88:91]
  v_mfma_f32_16x16x32_bf16 v[92:95], a[44:47], v[44:47], v[92:95]
  s_waitcnt lgkmcnt(5)
  v_mul_f32 v108, s24, v108
  v_mul_f32 v109, s24, v109
  v_mfma_f32_16x16x32_bf16 v[64:67], a[48:51], v[48:51], v[64:67]
  s_add_u32 m0, s25, 3072
  ds_read_b128 v[40:43], v12 offset:8192
  v_mfma_f32_16x16x32_bf16 v[68:71], a[52:55], v[48:51], v[68:71]
  v_cvt_pk_bf16_f32 v134, v108, v109
  v_mul_f32 v110, s24, v110
  v_mfma_f32_16x16x32_bf16 v[80:83], a[56:59], v[48:51], v[80:83]
  buffer_load_dwordx4 v19, s[12:15], s19 offen lds
  v_mfma_f32_16x16x32_bf16 v[84:87], a[60:63], v[48:51], v[84:87]
  s_waitcnt lgkmcnt(5)
  v_mul_f32 v111, s24, v111
  v_cvt_pk_bf16_f32 v135, v110, v111
  v_mfma_f32_16x16x32_bf16 v[72:75], a[48:51], v[52:55], v[72:75]
  ds_read_b128 v[44:47], v13 offset:8192
  v_mfma_f32_16x16x32_bf16 v[76:79], a[52:55], v[52:55], v[76:79]
  v_mul_f32 v112, s24, v112
  v_mul_f32 v113, s24, v113
  v_mfma_f32_16x16x32_bf16 v[88:91], a[56:59], v[52:55], v[88:91]
  v_mfma_f32_16x16x32_bf16 v[92:95], a[60:63], v[52:55], v[92:95]
  s_waitcnt lgkmcnt(5)
  v_cvt_pk_bf16_f32 v136, v112, v113
  v_mul_f32 v114, s24, v114
  v_mfma_f32_16x16x32_bf16 v[64:67], a[64:67], v[24:27], v[64:67]
  s_add_u32 m0, s25, 4096
  ds_read_b128 v[48:51], v14 offset:8192
  v_mfma_f32_16x16x32_bf16 v[68:71], a[68:71], v[24:27], v[68:71]
  v_mul_f32 v115, s24, v115
  v_cvt_pk_bf16_f32 v137, v114, v115
  v_mfma_f32_16x16x32_bf16 v[80:83], a[72:75], v[24:27], v[80:83]
  buffer_load_dwordx4 v20, s[12:15], s19 offen lds
  v_mfma_f32_16x16x32_bf16 v[84:87], a[76:79], v[24:27], v[84:87]
  s_waitcnt lgkmcnt(5)
  v_mul_f32 v116, s24, v116
  v_mul_f32 v117, s24, v117
  v_mfma_f32_16x16x32_bf16 v[72:75], a[64:67], v[28:31], v[72:75]
  ds_read_b128 v[52:55], v15 offset:8192
  v_mfma_f32_16x16x32_bf16 v[76:79], a[68:71], v[28:31], v[76:79]
  v_cvt_pk_bf16_f32 v138, v116, v117
  v_mul_f32 v118, s24, v118
  v_mfma_f32_16x16x32_bf16 v[88:91], a[72:75], v[28:31], v[88:91]
  v_mfma_f32_16x16x32_bf16 v[92:95], a[76:79], v[28:31], v[92:95]
  s_waitcnt lgkmcnt(5)
  v_mul_f32 v119, s24, v119
  v_cvt_pk_bf16_f32 v139, v118, v119
  v_mfma_f32_16x16x32_bf16 v[64:67], a[80:83], v[32:35], v[64:67]
  s_add_u32 m0, s25, 5120
  ds_read_b128 v[24:27], v8 offset:16384
  v_mfma_f32_16x16x32_bf16 v[68:71], a[84:87], v[32:35], v[68:71]
  v_mul_f32 v120, s24, v120
  v_mul_f32 v121, s24, v121
  v_mfma_f32_16x16x32_bf16 v[80:83], a[88:91], v[32:35], v[80:83]
  buffer_load_dwordx4 v21, s[12:15], s19 offen lds
  v_mfma_f32_16x16x32_bf16 v[84:87], a[92:95], v[32:35], v[84:87]
  s_waitcnt lgkmcnt(5)
  v_cvt_pk_bf16_f32 v140, v120, v121
  v_mul_f32 v122, s24, v122
  v_mfma_f32_16x16x32_bf16 v[72:75], a[80:83], v[36:39], v[72:75]
  ds_read_b128 v[28:31], v9 offset:16384
  v_mfma_f32_16x16x32_bf16 v[76:79], a[84:87], v[36:39], v[76:79]
  v_mul_f32 v123, s24, v123
  v_cvt_pk_bf16_f32 v141, v122, v123
  v_mfma_f32_16x16x32_bf16 v[88:91], a[88:91], v[36:39], v[88:91]
  v_mfma_f32_16x16x32_bf16 v[92:95], a[92:95], v[36:39], v[92:95]
  s_waitcnt lgkmcnt(5)
  v_mul_f32 v124, s24, v124
  v_mul_f32 v125, s24, v125
  v_mfma_f32_16x16x32_bf16 v[64:67], a[96:99], v[40:43], v[64:67]
  s_add_u32 m0, s25, 6144
  ds_read_b128 v[32:35], v10 offset:16384
  v_mfma_f32_16x16x32_bf16 v[68:71], a[100:103], v[40:43], v[68:71]
  v_cvt_pk_bf16_f32 v142, v124, v125
  v_mul_f32 v126, s24, v126
  v_mfma_f32_16x16x32_bf16 v[80:83], a[104:107], v[40:43], v[80:83]
  buffer_load_dwordx4 v22, s[12:15], s19 offen lds
  v_mfma_f32_16x16x32_bf16 v[84:87], a[108:111], v[40:43], v[84:87]
  s_waitcnt lgkmcnt(5)
  v_mul_f32 v127, s24, v127
  v_cvt_pk_bf16_f32 v143, v126, v127
  v_mfma_f32_16x16x32_bf16 v[72:75], a[96:99], v[44:47], v[72:75]
  ds_read_b128 v[36:39], v11 offset:16384
  v_mfma_f32_16x16x32_bf16 v[76:79], a[100:103], v[44:47], v[76:79]
  v_mfma_f32_16x16x32_bf16 v[88:91], a[104:107], v[44:47], v[88:91]
  v_mfma_f32_16x16x32_bf16 v[92:95], a[108:111], v[44:47], v[92:95]
  s_waitcnt lgkmcnt(5)
  v_mfma_f32_16x16x32_bf16 v[64:67], a[112:115], v[48:51], v[64:67]
  s_add_u32 m0, s25, 7168
  ds_read_b128 v[40:43], v12 offset:16384
  v_mfma_f32_16x16x32_bf16 v[68:71], a[116:119], v[48:51], v[68:71]
  v_mfma_f32_16x16x32_bf16 v[80:83], a[120:123], v[48:51], v[80:83]
  buffer_load_dwordx4 v23, s[12:15], s19 offen lds
  v_mfma_f32_16x16x32_bf16 v[84:87], a[124:127], v[48:51], v[84:87]
  s_waitcnt lgkmcnt(5)
  v_mfma_f32_16x16x32_bf16 v[72:75], a[112:115], v[52:55], v[72:75]
  s_cmp_gt_u32 s23, 3
  ds_read_b128 v[44:47], v13 offset:16384
  v_mfma_f32_16x16x32_bf16 v[76:79], a[116:119], v[52:55], v[76:79]
  v_mfma_f32_16x16x32_bf16 v[88:91], a[120:123], v[52:55], v[88:91]
  s_cselect_b32 s26, s20, 0
  v_mfma_f32_16x16x32_bf16 v[92:95], a[124:127], v[52:55], v[92:95]
  s_waitcnt lgkmcnt(5)
  v_mfma_f32_16x16x32_bf16 v[64:67], a[128:131], v[24:27], v[64:67]
  s_add_u32 s19, s19, s26
  ds_read_b128 v[48:51], v14 offset:16384
  v_mfma_f32_16x16x32_bf16 v[68:71], a[132:135], v[24:27], v[68:71]
  v_mfma_f32_16x16x32_bf16 v[80:83], a[136:139], v[24:27], v[80:83]
  s_add_u32 s25, s25, 32768
  v_mfma_f32_16x16x32_bf16 v[84:87], a[140:143], v[24:27], v[84:87]
  s_waitcnt lgkmcnt(5)
  v_mfma_f32_16x16x32_bf16 v[72:75], a[128:131], v[28:31], v[72:75]
  s_and_b32 s25, s25, 0x1ffff
  ds_read_b128 v[52:55], v15 offset:16384
  v_mfma_f32_16x16x32_bf16 v[76:79], a[132:135], v[28:31], v[76:79]
  v_mfma_f32_16x16x32_bf16 v[88:91], a[136:139], v[28:31], v[88:91]
  buffer_store_dwordx4 v[128:131], v7, s[4:7], s21 offen offset:0 sc1
  v_mfma_f32_16x16x32_bf16 v[92:95], a[140:143], v[28:31], v[92:95]
  s_waitcnt lgkmcnt(5)
  v_mfma_f32_16x16x32_bf16 v[64:67], a[144:147], v[32:35], v[64:67]
  ds_read_b128 v[24:27], v8 offset:24576
  v_mfma_f32_16x16x32_bf16 v[68:71], a[148:151], v[32:35], v[68:71]
  v_mfma_f32_16x16x32_bf16 v[80:83], a[152:155], v[32:35], v[80:83]
  v_mfma_f32_16x16x32_bf16 v[84:87], a[156:159], v[32:35], v[84:87]
  s_waitcnt lgkmcnt(5)
  v_mfma_f32_16x16x32_bf16 v[72:75], a[144:147], v[36:39], v[72:75]
  ds_read_b128 v[28:31], v9 offset:24576
  v_mfma_f32_16x16x32_bf16 v[76:79], a[148:151], v[36:39], v[76:79]
  v_mfma_f32_16x16x32_bf16 v[88:91], a[152:155], v[36:39], v[88:91]
  buffer_store_dwordx4 v[132:135], v7, s[4:7], s21 offen offset:256 sc1
  v_mfma_f32_16x16x32_bf16 v[92:95], a[156:159], v[36:39], v[92:95]
  s_waitcnt lgkmcnt(5)
  v_mfma_f32_16x16x32_bf16 v[64:67], a[160:163], v[40:43], v[64:67]
  ds_read_b128 v[32:35], v10 offset:24576
  v_mfma_f32_16x16x32_bf16 v[68:71], a[164:167], v[40:43], v[68:71]
  v_mfma_f32_16x16x32_bf16 v[80:83], a[168:171], v[40:43], v[80:83]
  v_mfma_f32_16x16x32_bf16 v[84:87], a[172:175], v[40:43], v[84:87]
  s_waitcnt lgkmcnt(5)
  v_mfma_f32_16x16x32_bf16 v[72:75], a[160:163], v[44:47], v[72:75]
  ds_read_b128 v[36:39], v11 offset:24576
  v_mfma_f32_16x16x32_bf16 v[76:79], a[164:167], v[44:47], v[76:79]
  v_mfma_f32_16x16x32_bf16 v[88:91], a[168:171], v[44:47], v[88:91]
  buffer_store_dwordx4 v[136:139], v7, s[4:7], s21 offen offset:2048 sc1
  v_mfma_f32_16x16x32_bf16 v[92:95], a[172:175], v[44:47], v[92:95]
  s_waitcnt lgkmcnt(5)
  v_mfma_f32_16x16x32_bf16 v[64:67], a[176:179], v[48:51], v[64:67]
  ds_read_b128 v[40:43], v12 offset:24576
  v_mfma_f32_16x16x32_bf16 v[68:71], a[180:183], v[48:51], v[68:71]
  v_mfma_f32_16x16x32_bf16 v[80:83], a[184:187], v[48:51], v[80:83]
  v_mfma_f32_16x16x32_bf16 v[84:87], a[188:191], v[48:51], v[84:87]
  s_waitcnt lgkmcnt(5)
  v_mfma_f32_16x16x32_bf16 v[72:75], a[176:179], v[52:55], v[72:75]
  ds_read_b128 v[44:47], v13 offset:24576
  v_mfma_f32_16x16x32_bf16 v[76:79], a[180:183], v[52:55], v[76:79]
  v_mfma_f32_16x16x32_bf16 v[88:91], a[184:187], v[52:55], v[88:91]
  buffer_store_dwordx4 v[140:143], v7, s[4:7], s21 offen offset:2304 sc1
  v_mfma_f32_16x16x32_bf16 v[92:95], a[188:191], v[52:55], v[92:95]
  s_waitcnt lgkmcnt(5)
  v_mfma_f32_16x16x32_bf16 v[64:67], a[192:195], v[24:27], v[64:67]
  s_mov_b32 s21, s27
  ds_read_b128 v[48:51], v14 offset:24576
  v_mfma_f32_16x16x32_bf16 v[68:71], a[196:199], v[24:27], v[68:71]
  v_mov_b32 v7, v56
  v_mfma_f32_16x16x32_bf16 v[80:83], a[200:203], v[24:27], v[80:83]
  v_mfma_f32_16x16x32_bf16 v[84:87], a[204:207], v[24:27], v[84:87]
  s_waitcnt lgkmcnt(5)
  v_mfma_f32_16x16x32_bf16 v[72:75], a[192:195], v[28:31], v[72:75]
  s_add_u32 s27, s27, s22
  ds_read_b128 v[52:55], v15 offset:24576
  v_mfma_f32_16x16x32_bf16 v[76:79], a[196:199], v[28:31], v[76:79]
  v_mfma_f32_16x16x32_bf16 v[88:91], a[200:203], v[28:31], v[88:91]
  s_waitcnt vmcnt(13)
  s_barrier
  v_mfma_f32_16x16x32_bf16 v[92:95], a[204:207], v[28:31], v[92:95]
  s_waitcnt lgkmcnt(5)
  v_mfma_f32_16x16x32_bf16 v[64:67], a[208:211], v[32:35], v[64:67]
  ds_read_b128 v[24:27], v8 offset:32768
  v_mfma_f32_16x16x32_bf16 v[68:71], a[212:215], v[32:35], v[68:71]
  v_mfma_f32_16x16x32_bf16 v[80:83], a[216:219], v[32:35], v[80:83]
  v_mfma_f32_16x16x32_bf16 v[84:87], a[220:223], v[32:35], v[84:87]
  s_waitcnt lgkmcnt(5)
  v_mfma_f32_16x16x32_bf16 v[72:75], a[208:211], v[36:39], v[72:75]
  s_add_u32 s29, s29, 1
  ds_read_b128 v[28:31], v9 offset:32768
  v_mfma_f32_16x16x32_bf16 v[76:79], a[212:215], v[36:39], v[76:79]
  v_mfma_f32_16x16x32_bf16 v[88:91], a[216:219], v[36:39], v[88:91]
  s_max_i32 s30, s29, 0
  v_mfma_f32_16x16x32_bf16 v[92:95], a[220:223], v[36:39], v[92:95]
  s_waitcnt lgkmcnt(5)
  v_mov_b32 v144, s30
  v_mfma_f32_16x16x32_bf16 v[64:67], a[224:227], v[40:43], v[64:67]
  ds_read_b128 v[32:35], v10 offset:32768
  v_mfma_f32_16x16x32_bf16 v[68:71], a[228:231], v[40:43], v[68:71]
  v_mfma_f32_16x16x32_bf16 v[80:83], a[232:235], v[40:43], v[80:83]
  buffer_store_dword v144, v145, s[4:7], s31 offen sc1
  v_mfma_f32_16x16x32_bf16 v[84:87], a[236:239], v[40:43], v[84:87]
  s_waitcnt lgkmcnt(5)
  v_mfma_f32_16x16x32_bf16 v[72:75], a[224:227], v[44:47], v[72:75]
  ds_read_b128 v[36:39], v11 offset:32768
  v_mfma_f32_16x16x32_bf16 v[76:79], a[228:231], v[44:47], v[76:79]
  v_mfma_f32_16x16x32_bf16 v[88:91], a[232:235], v[44:47], v[88:91]
  v_mfma_f32_16x16x32_bf16 v[92:95], a[236:239], v[44:47], v[92:95]
  s_waitcnt lgkmcnt(5)
  v_mfma_f32_16x16x32_bf16 v[64:67], a[240:243], v[48:51], v[64:67]
  s_sub_u32 s23, s23, 1
  ds_read_b128 v[40:43], v12 offset:32768
  v_mfma_f32_16x16x32_bf16 v[68:71], a[244:247], v[48:51], v[68:71]
  v_mfma_f32_16x16x32_bf16 v[80:83], a[248:251], v[48:51], v[80:83]
  v_mfma_f32_16x16x32_bf16 v[84:87], a[252:255], v[48:51], v[84:87]
  s_waitcnt lgkmcnt(5)
  v_mfma_f32_16x16x32_bf16 v[72:75], a[240:243], v[52:55], v[72:75]
  s_cmp_eq_u32 s23, 0
  ds_read_b128 v[44:47], v13 offset:32768
  v_mfma_f32_16x16x32_bf16 v[76:79], a[244:247], v[52:55], v[76:79]
  v_mfma_f32_16x16x32_bf16 v[88:91], a[248:251], v[52:55], v[88:91]
  v_mfma_f32_16x16x32_bf16 v[92:95], a[252:255], v[52:55], v[92:95]
  s_cbranch_scc1 G_done0_138
  s_waitcnt lgkmcnt(5)
  v_mfma_f32_16x16x32_bf16 v[96:99], a[0:3], v[24:27], 0
  s_add_u32 m0, s25, 0
  ds_read_b128 v[48:51], v14 offset:32768
  v_mfma_f32_16x16x32_bf16 v[100:103], a[4:7], v[24:27], 0
  v_mfma_f32_16x16x32_bf16 v[112:115], a[8:11], v[24:27], 0
  buffer_load_dwordx4 v16, s[12:15], s19 offen lds
  v_mfma_f32_16x16x32_bf16 v[116:119], a[12:15], v[24:27], 0
  s_waitcnt lgkmcnt(5)
  v_mfma_f32_16x16x32_bf16 v[104:107], a[0:3], v[28:31], 0
  ds_read_b128 v[52:55], v15 offset:32768
  v_mfma_f32_16x16x32_bf16 v[108:111], a[4:7], v[28:31], 0
  v_mul_f32 v64, s24, v64
  v_mul_f32 v65, s24, v65
  v_mfma_f32_16x16x32_bf16 v[120:123], a[8:11], v[28:31], 0
  v_mfma_f32_16x16x32_bf16 v[124:127], a[12:15], v[28:31], 0
  s_waitcnt lgkmcnt(5)
  v_cvt_pk_bf16_f32 v128, v64, v65
  v_mul_f32 v66, s24, v66
  v_mfma_f32_16x16x32_bf16 v[96:99], a[16:19], v[32:35], v[96:99]
  s_add_u32 m0, s25, 1024
  ds_read_b128 v[24:27], v8 offset:40960
  v_mfma_f32_16x16x32_bf16 v[100:103], a[20:23], v[32:35], v[100:103]
  v_mul_f32 v67, s24, v67
  v_cvt_pk_bf16_f32 v129, v66, v67
  v_mfma_f32_16x16x32_bf16 v[112:115], a[24:27], v[32:35], v[112:115]
  buffer_load_dwordx4 v17, s[12:15], s19 offen lds
  v_mfma_f32_16x16x32_bf16 v[116:119], a[28:31], v[32:35], v[116:119]
  s_waitcnt lgkmcnt(5)
  v_mul_f32 v68, s24, v68
  v_mul_f32 v69, s24, v69
  v_mfma_f32_16x16x32_bf16 v[104:107], a[16:19], v[36:39], v[104:107]
  ds_read_b128 v[28:31], v9 offset:40960
  v_mfma_f32_16x16x32_bf16 v[108:111], a[20:23], v[36:39], v[108:111]
  v_cvt_pk_bf16_f32 v130, v68, v69
  v_mul_f32 v70, s24, v70
  v_mfma_f32_16x16x32_bf16 v[120:123], a[24:27], v[36:39], v[120:123]
  v_mfma_f32_16x16x32_bf16 v[124:127], a[28:31], v[36:39], v[124:127]
  s_waitcnt lgkmcnt(5)
  v_mul_f32 v71, s24, v71
  v_cvt_pk_bf16_f32 v131, v70, v71
  v_mfma_f32_16x16x32_bf16 v[96:99], a[32:35], v[40:43], v[96:99]
  s_add_u32 m0, s25, 2048
  ds_read_b128 v[32:35], v10 offset:40960
  v_mfma_f32_16x16x32_bf16 v[100:103], a[36:39], v[40:43], v[100:103]
  v_mul_f32 v72, s24, v72
  v_mul_f32 v73, s24, v73
  v_mfma_f32_16x16x32_bf16 v[112:115], a[40:43], v[40:43], v[112:115]
  buffer_load_dwordx4 v18, s[12:15], s19 offen lds
  v_mfma_f32_16x16x32_bf16 v[116:119], a[44:47], v[40:43], v[116:119]
  s_waitcnt lgkmcnt(5)
  v_cvt_pk_bf16_f32 v132, v72, v73
  v_mul_f32 v74, s24, v74
  v_mfma_f32_16x16x32_bf16 v[104:107], a[32:35], v[44:47], v[104:107]
  ds_read_b128 v[36:39], v11 offset:40960
  v_mfma_f32_16x16x32_bf16 v[108:111], a[36:39], v[44:47], v[108:111]
  v_mul_f32 v75, s24, v75
  v_cvt_pk_bf16_f32 v133, v74, v75
  v_mfma_f32_16x16x32_bf16 v[120:123], a[40:43], v[44:47], v[120:123]
  v_mfma_f32_16x16x32_bf16 v[124:127], a[44:47], v[44:47], v[124:127]
  s_waitcnt lgkmcnt(5)
  v_mul_f32 v76, s24, v76
  v_mul_f32 v77, s24, v77
  v_mfma_f32_16x16x32_bf16 v[96:99], a[48:51], v[48:51], v[96:99]
  s_add_u32 m0, s25, 3072
  ds_read_b128 v[40:43], v12 offset:40960
  v_mfma_f32_16x16x32_bf16 v[100:103], a[52:55], v[48:51], v[100:103]
  v_cvt_pk_bf16_f32 v134, v76, v77
  v_mul_f32 v78, s24, v78
  v_mfma_f32_16x16x32_bf16 v[112:115], a[56:59], v[48:51], v[112:115]
  buffer_load_dwordx4 v19, s[12:15], s19 offen lds
  v_mfma_f32_16x16x32_bf16 v[116:119], a[60:63], v[48:51], v[116:119]
  s_waitcnt lgkmcnt(5)
  v_mul_f32 v79, s24, v79
  v_cvt_pk_bf16_f32 v135, v78, v79
  v_mfma_f32_16x16x32_bf16 v[104:107], a[48:51], v[52:55], v[104:107]
  ds_read_b128 v[44:47], v13 offset:40960
  v_mfma_f32_16x16x32_bf16 v[108:111], a[52:55], v[52:55], v[108:111]
  v_mul_f32 v80, s24, v80
  v_mul_f32 v81, s24, v81
  v_mfma_f32_16x16x32_bf16 v[120:123], a[56:59], v[52:55], v[120:123]
  v_mfma_f32_16x16x32_bf16 v[124:127], a[60:63], v[52:55], v[124:127]
  s_waitcnt lgkmcnt(5)
  v_cvt_pk_bf16_f32 v136, v80, v81
  v_mul_f32 v82, s24, v82
  v_mfma_f32_16x16x32_bf16 v[96:99], a[64:67], v[24:27], v[96:99]
  s_add_u32 m0, s25, 4096
  ds_read_b128 v[48:51], v14 offset:40960
  v_mfma_f32_16x16x32_bf16 v[100:103], a[68:71], v[24:27], v[100:103]
  v_mul_f32 v83, s24, v83
  v_cvt_pk_bf16_f32 v137, v82, v83
  v_mfma_f32_16x16x32_bf16 v[112:115], a[72:75], v[24:27], v[112:115]
  buffer_load_dwordx4 v20, s[12:15], s19 offen lds
  v_mfma_f32_16x16x32_bf16 v[116:119], a[76:79], v[24:27], v[116:119]
  s_waitcnt lgkmcnt(5)
  v_mul_f32 v84, s24, v84
  v_mul_f32 v85, s24, v85
  v_mfma_f32_16x16x32_bf16 v[104:107], a[64:67], v[28:31], v[104:107]
  ds_read_b128 v[52:55], v15 offset:40960
  v_mfma_f32_16x16x32_bf16 v[108:111], a[68:71], v[28:31], v[108:111]
  v_cvt_pk_bf16_f32 v138, v84, v85
  v_mul_f32 v86, s24, v86
  v_mfma_f32_16x16x32_bf16 v[120:123], a[72:75], v[28:31], v[120:123]
  v_mfma_f32_16x16x32_bf16 v[124:127], a[76:79], v[28:31], v[124:127]
  s_waitcnt lgkmcnt(5)
  v_mul_f32 v87, s24, v87
  v_cvt_pk_bf16_f32 v139, v86, v87
  v_mfma_f32_16x16x32_bf16 v[96:99], a[80:83], v[32:35], v[96:99]
  s_add_u32 m0, s25, 5120
  ds_read_b128 v[24:27], v8 offset:49152
  v_mfma_f32_16x16x32_bf16 v[100:103], a[84:87], v[32:35], v[100:103]
  v_mul_f32 v88, s24, v88
  v_mul_f32 v89, s24, v89
  v_mfma_f32_16x16x32_bf16 v[112:115], a[88:91], v[32:35], v[112:115]
  buffer_load_dwordx4 v21, s[12:15], s19 offen lds
  v_mfma_f32_16x16x32_bf16 v[116:119], a[92:95], v[32:35], v[116:119]
  s_waitcnt lgkmcnt(5)
  v_cvt_pk_bf16_f32 v140, v88, v89
  v_mul_f32 v90, s24, v90
  v_mfma_f32_16x16x32_bf16 v[104:107], a[80:83], v[36:39], v[104:107]
  ds_read_b128 v[28:31], v9 offset:49152
  v_mfma_f32_16x16x32_bf16 v[108:111], a[84:87], v[36:39], v[108:111]
  v_mul_f32 v91, s24, v91
  v_cvt_pk_bf16_f32 v141, v90, v91
  v_mfma_f32_16x16x32_bf16 v[120:123], a[88:91], v[36:39], v[120:123]
  v_mfma_f32_16x16x32_bf16 v[124:127], a[92:95], v[36:39], v[124:127]
  s_waitcnt lgkmcnt(5)
  v_mul_f32 v92, s24, v92
  v_mul_f32 v93, s24, v93
  v_mfma_f32_16x16x32_bf16 v[96:99], a[96:99], v[40:43], v[96:99]
  s_add_u32 m0, s25, 6144
  ds_read_b128 v[32:35], v10 offset:49152
  v_mfma_f32_16x16x32_bf16 v[100:103], a[100:103], v[40:43], v[100:103]
  v_cvt_pk_bf16_f32 v142, v92, v93
  v_mul_f32 v94, s24, v94
  v_mfma_f32_16x16x32_bf16 v[112:115], a[104:107], v[40:43], v[112:115]
  buffer_load_dwordx4 v22, s[12:15], s19 offen lds
  v_mfma_f32_16x16x32_bf16 v[116:119], a[108:111], v[40:43], v[116:119]
  s_waitcnt lgkmcnt(5)
  v_mul_f32 v95, s24, v95
  v_cvt_pk_bf16_f32 v143, v94, v95
  v_mfma_f32_16x16x32_bf16 v[104:107], a[96:99], v[44:47], v[104:107]
  ds_read_b128 v[36:39], v11 offset:49152
  v_mfma_f32_16x16x32_bf16 v[108:111], a[100:103], v[44:47], v[108:111]
  v_mfma_f32_16x16x32_bf16 v[120:123], a[104:107], v[44:47], v[120:123]
  v_mfma_f32_16x16x32_bf16 v[124:127], a[108:111], v[44:47], v[124:127]
  s_waitcnt lgkmcnt(5)
  v_mfma_f32_16x16x32_bf16 v[96:99], a[112:115], v[48:51], v[96:99]
  s_add_u32 m0, s25, 7168
  ds_read_b128 v[40:43], v12 offset:49152
  v_mfma_f32_16x16x32_bf16 v[100:103], a[116:119], v[48:51], v[100:103]
  v_mfma_f32_16x16x32_bf16 v[112:115], a[120:123], v[48:51], v[112:115]
  buffer_load_dwordx4 v23, s[12:15], s19 offen lds
  v_mfma_f32_16x16x32_bf16 v[116:119], a[124:127], v[48:51], v[116:119]
  s_waitcnt lgkmcnt(5)
  v_mfma_f32_16x16x32_bf16 v[104:107], a[112:115], v[52:55], v[104:107]
  s_cmp_gt_u32 s23, 3
  ds_read_b128 v[44:47], v13 offset:49152
  v_mfma_f32_16x16x32_bf16 v[108:111], a[116:119], v[52:55], v[108:111]
  v_mfma_f32_16x16x32_bf16 v[120:123], a[120:123], v[52:55], v[120:123]
  s_cselect_b32 s26, s20, 0
  v_mfma_f32_16x16x32_bf16 v[124:127], a[124:127], v[52:55], v[124:127]
  s_waitcnt lgkmcnt(5)
  v_mfma_f32_16x16x32_bf16 v[96:99], a[128:131], v[24:27], v[96:99]
  s_add_u32 s19, s19, s26
  ds_read_b128 v[48:51], v14 offset:49152
  v_mfma_f32_16x16x32_bf16 v[100:103], a[132:135], v[24:27], v[100:103]
  v_mfma_f32_16x16x32_bf16 v[112:115], a[136:139], v[24:27], v[112:115]
  s_add_u32 s25, s25, 32768
  v_mfma_f32_16x16x32_bf16 v[116:119], a[140:143], v[24:27], v[116:119]
  s_waitcnt lgkmcnt(5)
  v_mfma_f32_16x16x32_bf16 v[104:107], a[128:131], v[28:31], v[104:107]
  s_and_b32 s25, s25, 0x1ffff
  ds_read_b128 v[52:55], v15 offset:49152
  v_mfma_f32_16x16x32_bf16 v[108:111], a[132:135], v[28:31], v[108:111]
  v_mfma_f32_16x16x32_bf16 v[120:123], a[136:139], v[28:31], v[120:123]
  buffer_store_dwordx4 v[128:131], v7, s[4:7], s21 offen offset:0 sc1
  v_mfma_f32_16x16x32_bf16 v[124:127], a[140:143], v[28:31], v[124:127]
  s_waitcnt lgkmcnt(5)
  v_mfma_f32_16x16x32_bf16 v[96:99], a[144:147], v[32:35], v[96:99]
  ds_read_b128 v[24:27], v8 offset:57344
  v_mfma_f32_16x16x32_bf16 v[100:103], a[148:151], v[32:35], v[100:103]
  v_mfma_f32_16x16x32_bf16 v[112:115], a[152:155], v[32:35], v[112:115]
  v_mfma_f32_16x16x32_bf16 v[116:119], a[156:159], v[32:35], v[116:119]
  s_waitcnt lgkmcnt(5)
  v_xor_b32 v8, 0x10000, v8
  v_mfma_f32_16x16x32_bf16 v[104:107], a[144:147], v[36:39], v[104:107]
  ds_read_b128 v[28:31], v9 offset:57344
  v_mfma_f32_16x16x32_bf16 v[108:111], a[148:151], v[36:39], v[108:111]
  v_mfma_f32_16x16x32_bf16 v[120:123], a[152:155], v[36:39], v[120:123]
  buffer_store_dwordx4 v[132:135], v7, s[4:7], s21 offen offset:256 sc1
  v_mfma_f32_16x16x32_bf16 v[124:127], a[156:159], v[36:39], v[124:127]
  s_waitcnt lgkmcnt(5)
  v_xor_b32 v9, 0x10000, v9
  v_mfma_f32_16x16x32_bf16 v[96:99], a[160:163], v[40:43], v[96:99]
  ds_read_b128 v[32:35], v10 offset:57344
  v_mfma_f32_16x16x32_bf16 v[100:103], a[164:167], v[40:43], v[100:103]
  v_mfma_f32_16x16x32_bf16 v[112:115], a[168:171], v[40:43], v[112:115]
  v_mfma_f32_16x16x32_bf16 v[116:119], a[172:175], v[40:43], v[116:119]
  s_waitcnt lgkmcnt(5)
  v_xor_b32 v10, 0x10000, v10
  v_mfma_f32_16x16x32_bf16 v[104:107], a[160:163], v[44:47], v[104:107]
  ds_read_b128 v[36:39], v11 offset:57344
  v_mfma_f32_16x16x32_bf16 v[108:111], a[164:167], v[44:47], v[108:111]
  v_mfma_f32_16x16x32_bf16 v[120:123], a[168:171], v[44:47], v[120:123]
  buffer_store_dwordx4 v[136:139], v7, s[4:7], s21 offen offset:2048 sc1
  v_mfma_f32_16x16x32_bf16 v[124:127], a[172:175], v[44:47], v[124:127]
  s_waitcnt lgkmcnt(5)
  v_xor_b32 v11, 0x10000, v11
  v_mfma_f32_16x16x32_bf16 v[96:99], a[176:179], v[48:51], v[96:99]
  ds_read_b128 v[40:43], v12 offset:57344
  v_mfma_f32_16x16x32_bf16 v[100:103], a[180:183], v[48:51], v[100:103]
  v_mfma_f32_16x16x32_bf16 v[112:115], a[184:187], v[48:51], v[112:115]
  v_mfma_f32_16x16x32_bf16 v[116:119], a[188:191], v[48:51], v[116:119]
  s_waitcnt lgkmcnt(5)
  v_xor_b32 v12, 0x10000, v12
  v_mfma_f32_16x16x32_bf16 v[104:107], a[176:179], v[52:55], v[104:107]
  ds_read_b128 v[44:47], v13 offset:57344
  v_mfma_f32_16x16x32_bf16 v[108:111], a[180:183], v[52:55], v[108:111]
  v_mfma_f32_16x16x32_bf16 v[120:123], a[184:187], v[52:55], v[120:123]
  buffer_store_dwordx4 v[140:143], v7, s[4:7], s21 offen offset:2304 sc1
  v_mfma_f32_16x16x32_bf16 v[124:127], a[188:191], v[52:55], v[124:127]
  s_waitcnt lgkmcnt(5)
  v_xor_b32 v13, 0x10000, v13
  v_mfma_f32_16x16x32_bf16 v[96:99], a[192:195], v[24:27], v[96:99]
  s_mov_b32 s21, s27
  ds_read_b128 v[48:51], v14 offset:57344
  v_mfma_f32_16x16x32_bf16 v[100:103], a[196:199], v[24:27], v[100:103]
  v_mov_b32 v7, v56
  v_mfma_f32_16x16x32_bf16 v[112:115], a[200:203], v[24:27], v[112:115]
  v_mfma_f32_16x16x32_bf16 v[116:119], a[204:207], v[24:27], v[116:119]
  s_waitcnt lgkmcnt(5)
  v_xor_b32 v14, 0x10000, v14
  v_mfma_f32_16x16x32_bf16 v[104:107], a[192:195], v[28:31], v[104:107]
  s_add_u32 s27, s27, s22
  ds_read_b128 v[52:55], v15 offset:57344
  v_mfma_f32_16x16x32_bf16 v[108:111], a[196:199], v[28:31], v[108:111]
  v_mfma_f32_16x16x32_bf16 v[120:123], a[200:203], v[28:31], v[120:123]
  s_waitcnt vmcnt(13)
  s_barrier
  v_mfma_f32_16x16x32_bf16 v[124:127], a[204:207], v[28:31], v[124:127]
  s_waitcnt lgkmcnt(5)
  v_xor_b32 v15, 0x10000, v15
  v_mfma_f32_16x16x32_bf16 v[96:99], a[208:211], v[32:35], v[96:99]
  ds_read_b128 v[24:27], v8 offset:0
  v_mfma_f32_16x16x32_bf16 v[100:103], a[212:215], v[32:35], v[100:103]
  v_mfma_f32_16x16x32_bf16 v[112:115], a[216:219], v[32:35], v[112:115]
  v_mfma_f32_16x16x32_bf16 v[116:119], a[220:223], v[32:35], v[116:119]
  s_waitcnt lgkmcnt(5)
  v_mfma_f32_16x16x32_bf16 v[104:107], a[208:211], v[36:39], v[104:107]
  s_add_u32 s29, s29, 1
  ds_read_b128 v[28:31], v9 offset:0
  v_mfma_f32_16x16x32_bf16 v[108:111], a[212:215], v[36:39], v[108:111]
  v_mfma_f32_16x16x32_bf16 v[120:123], a[216:219], v[36:39], v[120:123]
  s_max_i32 s30, s29, 0
  v_mfma_f32_16x16x32_bf16 v[124:127], a[220:223], v[36:39], v[124:127]
  s_waitcnt lgkmcnt(5)
  v_mov_b32 v144, s30
  v_mfma_f32_16x16x32_bf16 v[96:99], a[224:227], v[40:43], v[96:99]
  ds_read_b128 v[32:35], v10 offset:0
  v_mfma_f32_16x16x32_bf16 v[100:103], a[228:231], v[40:43], v[100:103]
  v_mfma_f32_16x16x32_bf16 v[112:115], a[232:235], v[40:43], v[112:115]
  buffer_store_dword v144, v145, s[4:7], s31 offen sc1
  v_mfma_f32_16x16x32_bf16 v[116:119], a[236:239], v[40:43], v[116:119]
  s_waitcnt lgkmcnt(5)
  v_mfma_f32_16x16x32_bf16 v[104:107], a[224:227], v[44:47], v[104:107]
  ds_read_b128 v[36:39], v11 offset:0
  v_mfma_f32_16x16x32_bf16 v[108:111], a[228:231], v[44:47], v[108:111]
  v_mfma_f32_16x16x32_bf16 v[120:123], a[232:235], v[44:47], v[120:123]
  v_mfma_f32_16x16x32_bf16 v[124:127], a[236:239], v[44:47], v[124:127]
  s_waitcnt lgkmcnt(5)
  v_mfma_f32_16x16x32_bf16 v[96:99], a[240:243], v[48:51], v[96:99]
  s_sub_u32 s23, s23, 1
  ds_read_b128 v[40:43], v12 offset:0
  v_mfma_f32_16x16x32_bf16 v[100:103], a[244:247], v[48:51], v[100:103]
  v_mfma_f32_16x16x32_bf16 v[112:115], a[248:251], v[48:51], v[112:115]
  v_mfma_f32_16x16x32_bf16 v[116:119], a[252:255], v[48:51], v[116:119]
  s_waitcnt lgkmcnt(5)
  v_mfma_f32_16x16x32_bf16 v[104:107], a[240:243], v[52:55], v[104:107]
  s_cmp_eq_u32 s23, 0
  ds_read_b128 v[44:47], v13 offset:0
  v_mfma_f32_16x16x32_bf16 v[108:111], a[244:247], v[52:55], v[108:111]
  v_mfma_f32_16x16x32_bf16 v[120:123], a[248:251], v[52:55], v[120:123]
  v_mfma_f32_16x16x32_bf16 v[124:127], a[252:255], v[52:55], v[124:127]
  s_cbranch_scc1 G_done1_139
  s_branch G_top_137
G_done0_138:
  s_nop 7
  s_nop 3
  v_mul_f32 v64, s24, v64
  v_mul_f32 v65, s24, v65
  v_cvt_pk_bf16_f32 v128, v64, v65
  v_mul_f32 v66, s24, v66
  v_mul_f32 v67, s24, v67
  v_cvt_pk_bf16_f32 v129, v66, v67
  v_mul_f32 v68, s24, v68
  v_mul_f32 v69, s24, v69
  v_cvt_pk_bf16_f32 v130, v68, v69
  v_mul_f32 v70, s24, v70
  v_mul_f32 v71, s24, v71
  v_cvt_pk_bf16_f32 v131, v70, v71
  buffer_store_dwordx4 v[128:131], v7, s[4:7], s21 offen offset:0 sc1
  v_mul_f32 v72, s24, v72
  v_mul_f32 v73, s24, v73
  v_cvt_pk_bf16_f32 v132, v72, v73
  v_mul_f32 v74, s24, v74
  v_mul_f32 v75, s24, v75
  v_cvt_pk_bf16_f32 v133, v74, v75
  v_mul_f32 v76, s24, v76
  v_mul_f32 v77, s24, v77
  v_cvt_pk_bf16_f32 v134, v76, v77
  v_mul_f32 v78, s24, v78
  v_mul_f32 v79, s24, v79
  v_cvt_pk_bf16_f32 v135, v78, v79
  buffer_store_dwordx4 v[132:135], v7, s[4:7], s21 offen offset:256 sc1
  v_mul_f32 v80, s24, v80
  v_mul_f32 v81, s24, v81
  v_cvt_pk_bf16_f32 v136, v80, v81
  v_mul_f32 v82, s24, v82
  v_mul_f32 v83, s24, v83
  v_cvt_pk_bf16_f32 v137, v82, v83
  v_mul_f32 v84, s24, v84
  v_mul_f32 v85, s24, v85
  v_cvt_pk_bf16_f32 v138, v84, v85
  v_mul_f32 v86, s24, v86
  v_mul_f32 v87, s24, v87
  v_cvt_pk_bf16_f32 v139, v86, v87
  buffer_store_dwordx4 v[136:139], v7, s[4:7], s21 offen offset:2048 sc1
  v_mul_f32 v88, s24, v88
  v_mul_f32 v89, s24, v89
  v_cvt_pk_bf16_f32 v140, v88, v89
  v_mul_f32 v90, s24, v90
  v_mul_f32 v91, s24, v91
  v_cvt_pk_bf16_f32 v141, v90, v91
  v_mul_f32 v92, s24, v92
  v_mul_f32 v93, s24, v93
  v_cvt_pk_bf16_f32 v142, v92, v93
  v_mul_f32 v94, s24, v94
  v_mul_f32 v95, s24, v95
  v_cvt_pk_bf16_f32 v143, v94, v95
  buffer_store_dwordx4 v[140:143], v7, s[4:7], s21 offen offset:2304 sc1
  s_branch G_fin_140
G_done1_139:
  s_nop 7
  s_nop 3
  v_mul_f32 v96, s24, v96
  v_mul_f32 v97, s24, v97
  v_cvt_pk_bf16_f32 v128, v96, v97
  v_mul_f32 v98, s24, v98
  v_mul_f32 v99, s24, v99
  v_cvt_pk_bf16_f32 v129, v98, v99
  v_mul_f32 v100, s24, v100
  v_mul_f32 v101, s24, v101
  v_cvt_pk_bf16_f32 v130, v100, v101
  v_mul_f32 v102, s24, v102
  v_mul_f32 v103, s24, v103
  v_cvt_pk_bf16_f32 v131, v102, v103
  buffer_store_dwordx4 v[128:131], v7, s[4:7], s21 offen offset:0 sc1
  v_mul_f32 v104, s24, v104
  v_mul_f32 v105, s24, v105
  v_cvt_pk_bf16_f32 v132, v104, v105
  v_mul_f32 v106, s24, v106
  v_mul_f32 v107, s24, v107
  v_cvt_pk_bf16_f32 v133, v106, v107
  v_mul_f32 v108, s24, v108
  v_mul_f32 v109, s24, v109
  v_cvt_pk_bf16_f32 v134, v108, v109
  v_mul_f32 v110, s24, v110
  v_mul_f32 v111, s24, v111
  v_cvt_pk_bf16_f32 v135, v110, v111
  buffer_store_dwordx4 v[132:135], v7, s[4:7], s21 offen offset:256 sc1
  v_mul_f32 v112, s24, v112
  v_mul_f32 v113, s24, v113
  v_cvt_pk_bf16_f32 v136, v112, v113
  v_mul_f32 v114, s24, v114
  v_mul_f32 v115, s24, v115
  v_cvt_pk_bf16_f32 v137, v114, v115
  v_mul_f32 v116, s24, v116
  v_mul_f32 v117, s24, v117
  v_cvt_pk_bf16_f32 v138, v116, v117
  v_mul_f32 v118, s24, v118
  v_mul_f32 v119, s24, v119
  v_cvt_pk_bf16_f32 v139, v118, v119
  buffer_store_dwordx4 v[136:139], v7, s[4:7], s21 offen offset:2048 sc1
  v_mul_f32 v120, s24, v120
  v_mul_f32 v121, s24, v121
  v_cvt_pk_bf16_f32 v140, v120, v121
  v_mul_f32 v122, s24, v122
  v_mul_f32 v123, s24, v123
  v_cvt_pk_bf16_f32 v141, v122, v123
  v_mul_f32 v124, s24, v124
  v_mul_f32 v125, s24, v125
  v_cvt_pk_bf16_f32 v142, v124, v125
  v_mul_f32 v126, s24, v126
  v_mul_f32 v127, s24, v127
  v_cvt_pk_bf16_f32 v143, v126, v127
  buffer_store_dwordx4 v[140:143], v7, s[4:7], s21 offen offset:2304 sc1
G_fin_140:
  s_waitcnt vmcnt(0) lgkmcnt(0)
  s_barrier
  s_add_u32 s30, s29, 2
  v_mov_b32 v144, s30
  v_min_u32 v145, 1, v0
  v_lshlrev_b32 v145, 30, v145
  buffer_store_dword v144, v145, s[4:7], s31 offen sc1
  s_branch P_end_131
P_v_130:
  s_mov_b32 s27, s21
  v_mov_b32 v7, 0x40000000
  s_mov_b32 s29, -2
  v_min_u32 v145, 1, v0
  v_lshlrev_b32 v145, 30, v145
  ds_read_b128 v[24:27], v8 offset:0
  ds_read_b128 v[28:31], v9 offset:0
  ds_read_b128 v[32:35], v10 offset:0
  ds_read_b128 v[36:39], v11 offset:0
  ds_read_b128 v[40:43], v12 offset:0
  ds_read_b128 v[44:47], v13 offset:0
.p2align 6
G_top_141:
  s_waitcnt lgkmcnt(5)
  v_mfma_f32_16x16x32_bf16 v[64:67], v[24:27], a[0:3], 0
  s_add_u32 m0, s25, 0
  ds_read_b128 v[48:51], v14 offset:0
  v_mfma_f32_16x16x32_bf16 v[72:75], v[24:27], a[4:7], 0
  v_mfma_f32_16x16x32_bf16 v[80:83], v[24:27], a[8:11], 0
  buffer_load_dwordx4 v16, s[12:15], s19 offen lds
  v_mfma_f32_16x16x32_bf16 v[88:91], v[24:27], a[12:15], 0
  s_waitcnt lgkmcnt(5)
  v_mfma_f32_16x16x32_bf16 v[68:71], v[28:31], a[0:3], 0
  ds_read_b128 v[52:55], v15 offset:0
  v_mfma_f32_16x16x32_bf16 v[76:79], v[28:31], a[4:7], 0
  v_cvt_pk_bf16_f32 v128, v96, v97
  v_cvt_pk_bf16_f32 v129, v98, v99
  v_mfma_f32_16x16x32_bf16 v[84:87], v[28:31], a[8:11], 0
  v_mfma_f32_16x16x32_bf16 v[92:95], v[28:31], a[12:15], 0
  s_waitcnt lgkmcnt(5)
  v_cvt_pk_bf16_f32 v130, v100, v101
  v_cvt_pk_bf16_f32 v131, v102, v103
  v_mfma_f32_16x16x32_bf16 v[64:67], v[32:35], a[16:19], v[64:67]
  s_add_u32 m0, s25, 1024
  ds_read_b128 v[24:27], v8 offset:8192
  v_mfma_f32_16x16x32_bf16 v[72:75], v[32:35], a[20:23], v[72:75]
  v_mfma_f32_16x16x32_bf16 v[80:83], v[32:35], a[24:27], v[80:83]
  buffer_load_dwordx4 v17, s[12:15], s19 offen lds
  v_mfma_f32_16x16x32_bf16 v[88:91], v[32:35], a[28:31], v[88:91]
  s_waitcnt lgkmcnt(5)
  v_mfma_f32_16x16x32_bf16 v[68:71], v[36:39], a[16:19], v[68:71]
  ds_read_b128 v[28:31], v9 offset:8192
  v_mfma_f32_16x16x32_bf16 v[76:79], v[36:39], a[20:23], v[76:79]
  v_mfma_f32_16x16x32_bf16 v[84:87], v[36:39], a[24:27], v[84:87]
  v_mfma_f32_16x16x32_bf16 v[92:95], v[36:39], a[28:31], v[92:95]
  s_waitcnt lgkmcnt(5)
  v_mfma_f32_16x16x32_bf16 v[64:67], v[40:43], a[32:35], v[64:67]
  s_add_u32 m0, s25, 2048
  ds_read_b128 v[32:35], v10 offset:8192
  v_mfma_f32_16x16x32_bf16 v[72:75], v[40:43], a[36:39], v[72:75]
  v_cvt_pk_bf16_f32 v132, v104, v105
  v_cvt_pk_bf16_f32 v133, v106, v107
  v_mfma_f32_16x16x32_bf16 v[80:83], v[40:43], a[40:43], v[80:83]
  buffer_load_dwordx4 v18, s[12:15], s19 offen lds
  v_mfma_f32_16x16x32_bf16 v[88:91], v[40:43], a[44:47], v[88:91]
  s_waitcnt lgkmcnt(5)
  v_cvt_pk_bf16_f32 v134, v108, v109
  v_cvt_pk_bf16_f32 v135, v110, v111
  v_mfma_f32_16x16x32_bf16 v[68:71], v[44:47], a[32:35], v[68:71]
  ds_read_b128 v[36:39], v11 offset:8192
  v_mfma_f32_16x16x32_bf16 v[76:79], v[44:47], a[36:39], v[76:79]
  v_mfma_f32_16x16x32_bf16 v[84:87], v[44:47], a[40:43], v[84:87]
  v_mfma_f32_16x16x32_bf16 v[92:95], v[44:47], a[44:47], v[92:95]
  s_waitcnt lgkmcnt(5)
  v_mfma_f32_16x16x32_bf16 v[64:67], v[48:51], a[48:51], v[64:67]
  s_add_u32 m0, s25, 3072
  ds_read_b128 v[40:43], v12 offset:8192
  v_mfma_f32_16x16x32_bf16 v[72:75], v[48:51], a[52:55], v[72:75]
  v_mfma_f32_16x16x32_bf16 v[80:83], v[48:51], a[56:59], v[80:83]
  buffer_load_dwordx4 v19, s[12:15], s19 offen lds
  v_mfma_f32_16x16x32_bf16 v[88:91], v[48:51], a[60:63], v[88:91]
  s_waitcnt lgkmcnt(5)
  v_mfma_f32_16x16x32_bf16 v[68:71], v[52:55], a[48:51], v[68:71]
  ds_read_b128 v[44:47], v13 offset:8192
  v_mfma_f32_16x16x32_bf16 v[76:79], v[52:55], a[52:55], v[76:79]
  v_cvt_pk_bf16_f32 v136, v112, v113
  v_cvt_pk_bf16_f32 v137, v114, v115
  v_mfma_f32_16x16x32_bf16 v[84:87], v[52:55], a[56:59], v[84:87]
  v_mfma_f32_16x16x32_bf16 v[92:95], v[52:55], a[60:63], v[92:95]
  s_waitcnt lgkmcnt(5)
  v_cvt_pk_bf16_f32 v138, v116, v117
  v_cvt_pk_bf16_f32 v139, v118, v119
  v_mfma_f32_16x16x32_bf16 v[64:67], v[24:27], a[64:67], v[64:67]
  s_add_u32 m0, s25, 4096
  ds_read_b128 v[48:51], v14 offset:8192
  v_mfma_f32_16x16x32_bf16 v[72:75], v[24:27], a[68:71], v[72:75]
  v_mfma_f32_16x16x32_bf16 v[80:83], v[24:27], a[72:75], v[80:83]
  buffer_load_dwordx4 v20, s[12:15], s19 offen lds
  v_mfma_f32_16x16x32_bf16 v[88:91], v[24:27], a[76:79], v[88:91]
  s_waitcnt lgkmcnt(5)
  v_mfma_f32_16x16x32_bf16 v[68:71], v[28:31], a[64:67], v[68:71]
  ds_read_b128 v[52:55], v15 offset:8192
  v_mfma_f32_16x16x32_bf16 v[76:79], v[28:31], a[68:71], v[76:79]
  v_mfma_f32_16x16x32_bf16 v[84:87], v[28:31], a[72:75], v[84:87]
  v_mfma_f32_16x16x32_bf16 v[92:95], v[28:31], a[76:79], v[92:95]
  s_waitcnt lgkmcnt(5)
  v_mfma_f32_16x16x32_bf16 v[64:67], v[32:35], a[80:83], v[64:67]
  s_add_u32 m0, s25, 5120
  ds_read_b128 v[24:27], v8 offset:16384
  v_mfma_f32_16x16x32_bf16 v[72:75], v[32:35], a[84:87], v[72:75]
  v_cvt_pk_bf16_f32 v140, v120, v121
  v_cvt_pk_bf16_f32 v141, v122, v123
  v_mfma_f32_16x16x32_bf16 v[80:83], v[32:35], a[88:91], v[80:83]
  buffer_load_dwordx4 v21, s[12:15], s19 offen lds
  v_mfma_f32_16x16x32_bf16 v[88:91], v[32:35], a[92:95], v[88:91]
  s_waitcnt lgkmcnt(5)
  v_cvt_pk_bf16_f32 v142, v124, v125
  v_cvt_pk_bf16_f32 v143, v126, v127
  v_mfma_f32_16x16x32_bf16 v[68:71], v[36:39], a[80:83], v[68:71]
  ds_read_b128 v[28:31], v9 offset:16384
  v_mfma_f32_16x16x32_bf16 v[76:79], v[36:39], a[84:87], v[76:79]
  v_mfma_f32_16x16x32_bf16 v[84:87], v[36:39], a[88:91], v[84:87]
  v_mfma_f32_16x16x32_bf16 v[92:95], v[36:39], a[92:95], v[92:95]
  s_waitcnt lgkmcnt(5)
  v_mfma_f32_16x16x32_bf16 v[64:67], v[40:43], a[96:99], v[64:67]
  s_add_u32 m0, s25, 6144
  ds_read_b128 v[32:35], v10 offset:16384
  v_mfma_f32_16x16x32_bf16 v[72:75], v[40:43], a[100:103], v[72:75]
  v_mfma_f32_16x16x32_bf16 v[80:83], v[40:43], a[104:107], v[80:83]
  buffer_load_dwordx4 v22, s[12:15], s19 offen lds
  v_mfma_f32_16x16x32_bf16 v[88:91], v[40:43], a[108:111], v[88:91]
  s_waitcnt lgkmcnt(5)
  v_mfma_f32_16x16x32_bf16 v[68:71], v[44:47], a[96:99], v[68:71]
  ds_read_b128 v[36:39], v11 offset:16384
  v_mfma_f32_16x16x32_bf16 v[76:79], v[44:47], a[100:103], v[76:79]
  v_mfma_f32_16x16x32_bf16 v[84:87], v[44:47], a[104:107], v[84:87]
  v_mfma_f32_16x16x32_bf16 v[92:95], v[44:47], a[108:111], v[92:95]
  s_waitcnt lgkmcnt(5)
  v_mfma_f32_16x16x32_bf16 v[64:67], v[48:51], a[112:115], v[64:67]
  s_add_u32 m0, s25, 7168
  ds_read_b128 v[40:43], v12 offset:16384
  v_mfma_f32_16x16x32_bf16 v[72:75], v[48:51], a[116:119], v[72:75]
  v_mfma_f32_16x16x32_bf16 v[80:83], v[48:51], a[120:123], v[80:83]
  buffer_load_dwordx4 v23, s[12:15], s19 offen lds
  v_mfma_f32_16x16x32_bf16 v[88:91], v[48:51], a[124:127], v[88:91]
  s_waitcnt lgkmcnt(5)
  v_mfma_f32_16x16x32_bf16 v[68:71], v[52:55], a[112:115], v[68:71]
  s_cmp_gt_u32 s23, 3
  ds_read_b128 v[44:47], v13 offset:16384
  v_mfma_f32_16x16x32_bf16 v[76:79], v[52:55], a[116:119], v[76:79]
  v_mfma_f32_16x16x32_bf16 v[84:87], v[52:55], a[120:123], v[84:87]
  s_cselect_b32 s26, s20, 0
  v_mfma_f32_16x16x32_bf16 v[92:95], v[52:55], a[124:127], v[92:95]
  s_waitcnt lgkmcnt(5)
  v_mfma_f32_16x16x32_bf16 v[64:67], v[24:27], a[128:131], v[64:67]
  s_add_u32 s19, s19, s26
  ds_read_b128 v[48:51], v14 offset:16384
  v_mfma_f32_16x16x32_bf16 v[72:75], v[24:27], a[132:135], v[72:75]
  v_mfma_f32_16x16x32_bf16 v[80:83], v[24:27], a[136:139], v[80:83]
  s_add_u32 s25, s25, 32768
  v_mfma_f32_16x16x32_bf16 v[88:91], v[24:27], a[140:143], v[88:91]
  s_waitcnt lgkmcnt(5)
  v_mfma_f32_16x16x32_bf16 v[68:71], v[28:31], a[128:131], v[68:71]
  s_and_b32 s25, s25, 0x1ffff
  ds_read_b128 v[52:55], v15 offset:16384
  v_mfma_f32_16x16x32_bf16 v[76:79], v[28:31], a[132:135], v[76:79]
  v_mfma_f32_16x16x32_bf16 v[84:87], v[28:31], a[136:139], v[84:87]
  buffer_store_dwordx4 v[128:131], v7, s[4:7], s21 offen offset:0 sc1
  v_mfma_f32_16x16x32_bf16 v[92:95], v[28:31], a[140:143], v[92:95]
  s_waitcnt lgkmcnt(5)
  v_mfma_f32_16x16x32_bf16 v[64:67], v[32:35], a[144:147], v[64:67]
  ds_read_b128 v[24:27], v8 offset:24576
  v_mfma_f32_16x16x32_bf16 v[72:75], v[32:35], a[148:151], v[72:75]
  v_mfma_f32_16x16x32_bf16 v[80:83], v[32:35], a[152:155], v[80:83]
  v_mfma_f32_16x16x32_bf16 v[88:91], v[32:35], a[156:159], v[88:91]
  s_waitcnt lgkmcnt(5)
  v_mfma_f32_16x16x32_bf16 v[68:71], v[36:39], a[144:147], v[68:71]
  ds_read_b128 v[28:31], v9 offset:24576
  v_mfma_f32_16x16x32_bf16 v[76:79], v[36:39], a[148:151], v[76:79]
  v_mfma_f32_16x16x32_bf16 v[84:87], v[36:39], a[152:155], v[84:87]
  buffer_store_dwordx4 v[132:135], v7, s[4:7], s21 offen offset:256 sc1
  v_mfma_f32_16x16x32_bf16 v[92:95], v[36:39], a[156:159], v[92:95]
  s_waitcnt lgkmcnt(5)
  v_mfma_f32_16x16x32_bf16 v[64:67], v[40:43], a[160:163], v[64:67]
  ds_read_b128 v[32:35], v10 offset:24576
  v_mfma_f32_16x16x32_bf16 v[72:75], v[40:43], a[164:167], v[72:75]
  v_mfma_f32_16x16x32_bf16 v[80:83], v[40:43], a[168:171], v[80:83]
  v_mfma_f32_16x16x32_bf16 v[88:91], v[40:43], a[172:175], v[88:91]
  s_waitcnt lgkmcnt(5)
  v_mfma_f32_16x16x32_bf16 v[68:71], v[44:47], a[160:163], v[68:71]
  ds_read_b128 v[36:39], v11 offset:24576
  v_mfma_f32_16x16x32_bf16 v[76:79], v[44:47], a[164:167], v[76:79]
  v_mfma_f32_16x16x32_bf16 v[84:87], v[44:47], a[168:171], v[84:87]
  buffer_store_dwordx4 v[136:139], v7, s[4:7], s21 offen offset:2048 sc1
  v_mfma_f32_16x16x32_bf16 v[92:95], v[44:47], a[172:175], v[92:95]
  s_waitcnt lgkmcnt(5)
  v_mfma_f32_16x16x32_bf16 v[64:67], v[48:51], a[176:179], v[64:67]
  ds_read_b128 v[40:43], v12 offset:24576
  v_mfma_f32_16x16x32_bf16 v[72:75], v[48:51], a[180:183], v[72:75]
  v_mfma_f32_16x16x32_bf16 v[80:83], v[48:51], a[184:187], v[80:83]
  v_mfma_f32_16x16x32_bf16 v[88:91], v[48:51], a[188:191], v[88:91]
  s_waitcnt lgkmcnt(5)
  v_mfma_f32_16x16x32_bf16 v[68:71], v[52:55], a[176:179], v[68:71]
  ds_read_b128 v[44:47], v13 offset:24576
  v_mfma_f32_16x16x32_bf16 v[76:79], v[52:55], a[180:183], v[76:79]
  v_mfma_f32_16x16x32_bf16 v[84:87], v[52:55], a[184:187], v[84:87]
  buffer_store_dwordx4 v[140:143], v7, s[4:7], s21 offen offset:2304 sc1
  v_mfma_f32_16x16x32_bf16 v[92:95], v[52:55], a[188:191], v[92:95]
  s_waitcnt lgkmcnt(5)
  v_mfma_f32_16x16x32_bf16 v[64:67], v[24:27], a[192:195], v[64:67]
  s_mov_b32 s21, s27
  ds_read_b128 v[48:51], v14 offset:24576
  v_mfma_f32_16x16x32_bf16 v[72:75], v[24:27], a[196:199], v[72:75]
  v_mov_b32 v7, v56
  v_mfma_f32_16x16x32_bf16 v[80:83], v[24:27], a[200:203], v[80:83]
  v_mfma_f32_16x16x32_bf16 v[88:91], v[24:27], a[204:207], v[88:91]
  s_waitcnt lgkmcnt(5)
  v_mfma_f32_16x16x32_bf16 v[68:71], v[28:31], a[192:195], v[68:71]
  s_add_u32 s27, s27, s22
  ds_read_b128 v[52:55], v15 offset:24576
  v_mfma_f32_16x16x32_bf16 v[76:79], v[28:31], a[196:199], v[76:79]
  v_mfma_f32_16x16x32_bf16 v[84:87], v[28:31], a[200:203], v[84:87]
  s_waitcnt vmcnt(13)
  s_barrier
  v_mfma_f32_16x16x32_bf16 v[92:95], v[28:31], a[204:207], v[92:95]
  s_waitcnt lgkmcnt(5)
  v_mfma_f32_16x16x32_bf16 v[64:67], v[32:35], a[208:211], v[64:67]
  ds_read_b128 v[24:27], v8 offset:32768
  v_mfma_f32_16x16x32_bf16 v[72:75], v[32:35], a[212:215], v[72:75]
  v_mfma_f32_16x16x32_bf16 v[80:83], v[32:35], a[216:219], v[80:83]
  v_mfma_f32_16x16x32_bf16 v[88:91], v[32:35], a[220:223], v[88:91]
  s_waitcnt lgkmcnt(5)
  v_mfma_f32_16x16x32_bf16 v[68:71], v[36:39], a[208:211], v[68:71]
  s_add_u32 s29, s29, 1
  ds_read_b128 v[28:31], v9 offset:32768
  v_mfma_f32_16x16x32_bf16 v[76:79], v[36:39], a[212:215], v[76:79]
  v_mfma_f32_16x16x32_bf16 v[84:87], v[36:39], a[216:219], v[84:87]
  s_max_i32 s30, s29, 0
  v_mfma_f32_16x16x32_bf16 v[92:95], v[36:39], a[220:223], v[92:95]
  s_waitcnt lgkmcnt(5)
  v_mov_b32 v144, s30
  v_mfma_f32_16x16x32_bf16 v[64:67], v[40:43], a[224:227], v[64:67]
  ds_read_b128 v[32:35], v10 offset:32768
  v_mfma_f32_16x16x32_bf16 v[72:75], v[40:43], a[228:231], v[72:75]
  v_mfma_f32_16x16x32_bf16 v[80:83], v[40:43], a[232:235], v[80:83]
  buffer_store_dword v144, v145, s[4:7], s31 offen sc1
  v_mfma_f32_16x16x32_bf16 v[88:91], v[40:43], a[236:239], v[88:91]
  s_waitcnt lgkmcnt(5)
  v_mfma_f32_16x16x32_bf16 v[68:71], v[44:47], a[224:227], v[68:71]
  ds_read_b128 v[36:39], v11 offset:32768
  v_mfma_f32_16x16x32_bf16 v[76:79], v[44:47], a[228:231], v[76:79]
  v_mfma_f32_16x16x32_bf16 v[84:87], v[44:47], a[232:235], v[84:87]
  v_mfma_f32_16x16x32_bf16 v[92:95], v[44:47], a[236:239], v[92:95]
  s_waitcnt lgkmcnt(5)
  v_mfma_f32_16x16x32_bf16 v[64:67], v[48:51], a[240:243], v[64:67]
  s_sub_u32 s23, s23, 1
  ds_read_b128 v[40:43], v12 offset:32768
  v_mfma_f32_16x16x32_bf16 v[72:75], v[48:51], a[244:247], v[72:75]
  v_mfma_f32_16x16x32_bf16 v[80:83], v[48:51], a[248:251], v[80:83]
  v_mfma_f32_16x16x32_bf16 v[88:91], v[48:51], a[252:255], v[88:91]
  s_waitcnt lgkmcnt(5)
  v_mfma_f32_16x16x32_bf16 v[68:71], v[52:55], a[240:243], v[68:71]
  s_cmp_eq_u32 s23, 0
  ds_read_b128 v[44:47], v13 offset:32768
  v_mfma_f32_16x16x32_bf16 v[76:79], v[52:55], a[244:247], v[76:79]
  v_mfma_f32_16x16x32_bf16 v[84:87], v[52:55], a[248:251], v[84:87]
  v_mfma_f32_16x16x32_bf16 v[92:95], v[52:55], a[252:255], v[92:95]
  s_cbranch_scc1 G_done0_142
  s_waitcnt lgkmcnt(5)
  v_mfma_f32_16x16x32_bf16 v[96:99], v[24:27], a[0:3], 0
  s_add_u32 m0, s25, 0
  ds_read_b128 v[48:51], v14 offset:32768
  v_mfma_f32_16x16x32_bf16 v[104:107], v[24:27], a[4:7], 0
  v_mfma_f32_16x16x32_bf16 v[112:115], v[24:27], a[8:11], 0
  buffer_load_dwordx4 v16, s[12:15], s19 offen lds
  v_mfma_f32_16x16x32_bf16 v[120:123], v[24:27], a[12:15], 0
  s_waitcnt lgkmcnt(5)
  v_mfma_f32_16x16x32_bf16 v[100:103], v[28:31], a[0:3], 0
  ds_read_b128 v[52:55], v15 offset:32768
  v_mfma_f32_16x16x32_bf16 v[108:111], v[28:31], a[4:7], 0
  v_cvt_pk_bf16_f32 v128, v64, v65
  v_cvt_pk_bf16_f32 v129, v66, v67
  v_mfma_f32_16x16x32_bf16 v[116:119], v[28:31], a[8:11], 0
  v_mfma_f32_16x16x32_bf16 v[124:127], v[28:31], a[12:15], 0
  s_waitcnt lgkmcnt(5)
  v_cvt_pk_bf16_f32 v130, v68, v69
  v_cvt_pk_bf16_f32 v131, v70, v71
  v_mfma_f32_16x16x32_bf16 v[96:99], v[32:35], a[16:19], v[96:99]
  s_add_u32 m0, s25, 1024
  ds_read_b128 v[24:27], v8 offset:40960
  v_mfma_f32_16x16x32_bf16 v[104:107], v[32:35], a[20:23], v[104:107]
  v_mfma_f32_16x16x32_bf16 v[112:115], v[32:35], a[24:27], v[112:115]
  buffer_load_dwordx4 v17, s[12:15], s19 offen lds
  v_mfma_f32_16x16x32_bf16 v[120:123], v[32:35], a[28:31], v[120:123]
  s_waitcnt lgkmcnt(5)
  v_mfma_f32_16x16x32_bf16 v[100:103], v[36:39], a[16:19], v[100:103]
  ds_read_b128 v[28:31], v9 offset:40960
  v_mfma_f32_16x16x32_bf16 v[108:111], v[36:39], a[20:23], v[108:111]
  v_mfma_f32_16x16x32_bf16 v[116:119], v[36:39], a[24:27], v[116:119]
  v_mfma_f32_16x16x32_bf16 v[124:127], v[36:39], a[28:31], v[124:127]
  s_waitcnt lgkmcnt(5)
  v_mfma_f32_16x16x32_bf16 v[96:99], v[40:43], a[32:35], v[96:99]
  s_add_u32 m0, s25, 2048
  ds_read_b128 v[32:35], v10 offset:40960
  v_mfma_f32_16x16x32_bf16 v[104:107], v[40:43], a[36:39], v[104:107]
  v_cvt_pk_bf16_f32 v132, v72, v73
  v_cvt_pk_bf16_f32 v133, v74, v75
  v_mfma_f32_16x16x32_bf16 v[112:115], v[40:43], a[40:43], v[112:115]
  buffer_load_dwordx4 v18, s[12:15], s19 offen lds
  v_mfma_f32_16x16x32_bf16 v[120:123], v[40:43], a[44:47], v[120:123]
  s_waitcnt lgkmcnt(5)
  v_cvt_pk_bf16_f32 v134, v76, v77
  v_cvt_pk_bf16_f32 v135, v78, v79
  v_mfma_f32_16x16x32_bf16 v[100:103], v[44:47], a[32:35], v[100:103]
  ds_read_b128 v[36:39], v11 offset:40960
  v_mfma_f32_16x16x32_bf16 v[108:111], v[44:47], a[36:39], v[108:111]
  v_mfma_f32_16x16x32_bf16 v[116:119], v[44:47], a[40:43], v[116:119]
  v_mfma_f32_16x16x32_bf16 v[124:127], v[44:47], a[44:47], v[124:127]
  s_waitcnt lgkmcnt(5)
  v_mfma_f32_16x16x32_bf16 v[96:99], v[48:51], a[48:51], v[96:99]
  s_add_u32 m0, s25, 3072
  ds_read_b128 v[40:43], v12 offset:40960
  v_mfma_f32_16x16x32_bf16 v[104:107], v[48:51], a[52:55], v[104:107]
  v_mfma_f32_16x16x32_bf16 v[112:115], v[48:51], a[56:59], v[112:115]
  buffer_load_dwordx4 v19, s[12:15], s19 offen lds
  v_mfma_f32_16x16x32_bf16 v[120:123], v[48:51], a[60:63], v[120:123]
  s_waitcnt lgkmcnt(5)
  v_mfma_f32_16x16x32_bf16 v[100:103], v[52:55], a[48:51], v[100:103]
  ds_read_b128 v[44:47], v13 offset:40960
  v_mfma_f32_16x16x32_bf16 v[108:111], v[52:55], a[52:55], v[108:111]
  v_cvt_pk_bf16_f32 v136, v80, v81
  v_cvt_pk_bf16_f32 v137, v82, v83
  v_mfma_f32_16x16x32_bf16 v[116:119], v[52:55], a[56:59], v[116:119]
  v_mfma_f32_16x16x32_bf16 v[124:127], v[52:55], a[60:63], v[124:127]
  s_waitcnt lgkmcnt(5)
  v_cvt_pk_bf16_f32 v138, v84, v85
  v_cvt_pk_bf16_f32 v139, v86, v87
  v_mfma_f32_16x16x32_bf16 v[96:99], v[24:27], a[64:67], v[96:99]
  s_add_u32 m0, s25, 4096
  ds_read_b128 v[48:51], v14 offset:40960
  v_mfma_f32_16x16x32_bf16 v[104:107], v[24:27], a[68:71], v[104:107]
  v_mfma_f32_16x16x32_bf16 v[112:115], v[24:27], a[72:75], v[112:115]
  buffer_load_dwordx4 v20, s[12:15], s19 offen lds
  v_mfma_f32_16x16x32_bf16 v[120:123], v[24:27], a[76:79], v[120:123]
  s_waitcnt lgkmcnt(5)
  v_mfma_f32_16x16x32_bf16 v[100:103], v[28:31], a[64:67], v[100:103]
  ds_read_b128 v[52:55], v15 offset:40960
  v_mfma_f32_16x16x32_bf16 v[108:111], v[28:31], a[68:71], v[108:111]
  v_mfma_f32_16x16x32_bf16 v[116:119], v[28:31], a[72:75], v[116:119]
  v_mfma_f32_16x16x32_bf16 v[124:127], v[28:31], a[76:79], v[124:127]
  s_waitcnt lgkmcnt(5)
  v_mfma_f32_16x16x32_bf16 v[96:99], v[32:35], a[80:83], v[96:99]
  s_add_u32 m0, s25, 5120
  ds_read_b128 v[24:27], v8 offset:49152
  v_mfma_f32_16x16x32_bf16 v[104:107], v[32:35], a[84:87], v[104:107]
  v_cvt_pk_bf16_f32 v140, v88, v89
  v_cvt_pk_bf16_f32 v141, v90, v91
  v_mfma_f32_16x16x32_bf16 v[112:115], v[32:35], a[88:91], v[112:115]
  buffer_load_dwordx4 v21, s[12:15], s19 offen lds
  v_mfma_f32_16x16x32_bf16 v[120:123], v[32:35], a[92:95], v[120:123]
  s_waitcnt lgkmcnt(5)
  v_cvt_pk_bf16_f32 v142, v92, v93
  v_cvt_pk_bf16_f32 v143, v94, v95
  v_mfma_f32_16x16x32_bf16 v[100:103], v[36:39], a[80:83], v[100:103]
  ds_read_b128 v[28:31], v9 offset:49152
  v_mfma_f32_16x16x32_bf16 v[108:111], v[36:39], a[84:87], v[108:111]
  v_mfma_f32_16x16x32_bf16 v[116:119], v[36:39], a[88:91], v[116:119]
  v_mfma_f32_16x16x32_bf16 v[124:127], v[36:39], a[92:95], v[124:127]
  s_waitcnt lgkmcnt(5)
  v_mfma_f32_16x16x32_bf16 v[96:99], v[40:43], a[96:99], v[96:99]
  s_add_u32 m0, s25, 6144
  ds_read_b128 v[32:35], v10 offset:49152
  v_mfma_f32_16x16x32_bf16 v[104:107], v[40:43], a[100:103], v[104:107]
  v_mfma_f32_16x16x32_bf16 v[112:115], v[40:43], a[104:107], v[112:115]
  buffer_load_dwordx4 v22, s[12:15], s19 offen lds
  v_mfma_f32_16x16x32_bf16 v[120:123], v[40:43], a[108:111], v[120:123]
  s_waitcnt lgkmcnt(5)
  v_mfma_f32_16x16x32_bf16 v[100:103], v[44:47], a[96:99], v[100:103]
  ds_read_b128 v[36:39], v11 offset:49152
  v_mfma_f32_16x16x32_bf16 v[108:111], v[44:47], a[100:103], v[108:111]
  v_mfma_f32_16x16x32_bf16 v[116:119], v[44:47], a[104:107], v[116:119]
  v_mfma_f32_16x16x32_bf16 v[124:127], v[44:47], a[108:111], v[124:127]
  s_waitcnt lgkmcnt(5)
  v_mfma_f32_16x16x32_bf16 v[96:99], v[48:51], a[112:115], v[96:99]
  s_add_u32 m0, s25, 7168
  ds_read_b128 v[40:43], v12 offset:49152
  v_mfma_f32_16x16x32_bf16 v[104:107], v[48:51], a[116:119], v[104:107]
  v_mfma_f32_16x16x32_bf16 v[112:115], v[48:51], a[120:123], v[112:115]
  buffer_load_dwordx4 v23, s[12:15], s19 offen lds
  v_mfma_f32_16x16x32_bf16 v[120:123], v[48:51], a[124:127], v[120:123]
  s_waitcnt lgkmcnt(5)
  v_mfma_f32_16x16x32_bf16 v[100:103], v[52:55], a[112:115], v[100:103]
  s_cmp_gt_u32 s23, 3
  ds_read_b128 v[44:47], v13 offset:49152
  v_mfma_f32_16x16x32_bf16 v[108:111], v[52:55], a[116:119], v[108:111]
  v_mfma_f32_16x16x32_bf16 v[116:119], v[52:55], a[120:123], v[116:119]
  s_cselect_b32 s26, s20, 0
  v_mfma_f32_16x16x32_bf16 v[124:127], v[52:55], a[124:127], v[124:127]
  s_waitcnt lgkmcnt(5)
  v_mfma_f32_16x16x32_bf16 v[96:99], v[24:27], a[128:131], v[96:99]
  s_add_u32 s19, s19, s26
  ds_read_b128 v[48:51], v14 offset:49152
  v_mfma_f32_16x16x32_bf16 v[104:107], v[24:27], a[132:135], v[104:107]
  v_mfma_f32_16x16x32_bf16 v[112:115], v[24:27], a[136:139], v[112:115]
  s_add_u32 s25, s25, 32768
  v_mfma_f32_16x16x32_bf16 v[120:123], v[24:27], a[140:143], v[120:123]
  s_waitcnt lgkmcnt(5)
  v_mfma_f32_16x16x32_bf16 v[100:103], v[28:31], a[128:131], v[100:103]
  s_and_b32 s25, s25, 0x1ffff
  ds_read_b128 v[52:55], v15 offset:49152
  v_mfma_f32_16x16x32_bf16 v[108:111], v[28:31], a[132:135], v[108:111]
  v_mfma_f32_16x16x32_bf16 v[116:119], v[28:31], a[136:139], v[116:119]
  buffer_store_dwordx4 v[128:131], v7, s[4:7], s21 offen offset:0 sc1
  v_mfma_f32_16x16x32_bf16 v[124:127], v[28:31], a[140:143], v[124:127]
  s_waitcnt lgkmcnt(5)
  v_mfma_f32_16x16x32_bf16 v[96:99], v[32:35], a[144:147], v[96:99]
  ds_read_b128 v[24:27], v8 offset:57344
  v_mfma_f32_16x16x32_bf16 v[104:107], v[32:35], a[148:151], v[104:107]
  v_mfma_f32_16x16x32_bf16 v[112:115], v[32:35], a[152:155], v[112:115]
  v_mfma_f32_16x16x32_bf16 v[120:123], v[32:35], a[156:159], v[120:123]
  s_waitcnt lgkmcnt(5)
  v_xor_b32 v8, 0x10000, v8
  v_mfma_f32_16x16x32_bf16 v[100:103], v[36:39], a[144:147], v[100:103]
  ds_read_b128 v[28:31], v9 offset:57344
  v_mfma_f32_16x16x32_bf16 v[108:111], v[36:39], a[148:151], v[108:111]
  v_mfma_f32_16x16x32_bf16 v[116:119], v[36:39], a[152:155], v[116:119]
  buffer_store_dwordx4 v[132:135], v7, s[4:7], s21 offen offset:256 sc1
  v_mfma_f32_16x16x32_bf16 v[124:127], v[36:39], a[156:159], v[124:127]
  s_waitcnt lgkmcnt(5)
  v_xor_b32 v9, 0x10000, v9
  v_mfma_f32_16x16x32_bf16 v[96:99], v[40:43], a[160:163], v[96:99]
  ds_read_b128 v[32:35], v10 offset:57344
  v_mfma_f32_16x16x32_bf16 v[104:107], v[40:43], a[164:167], v[104:107]
  v_mfma_f32_16x16x32_bf16 v[112:115], v[40:43], a[168:171], v[112:115]
  v_mfma_f32_16x16x32_bf16 v[120:123], v[40:43], a[172:175], v[120:123]
  s_waitcnt lgkmcnt(5)
  v_xor_b32 v10, 0x10000, v10
  v_mfma_f32_16x16x32_bf16 v[100:103], v[44:47], a[160:163], v[100:103]
  ds_read_b128 v[36:39], v11 offset:57344
  v_mfma_f32_16x16x32_bf16 v[108:111], v[44:47], a[164:167], v[108:111]
  v_mfma_f32_16x16x32_bf16 v[116:119], v[44:47], a[168:171], v[116:119]
  buffer_store_dwordx4 v[136:139], v7, s[4:7], s21 offen offset:2048 sc1
  v_mfma_f32_16x16x32_bf16 v[124:127], v[44:47], a[172:175], v[124:127]
  s_waitcnt lgkmcnt(5)
  v_xor_b32 v11, 0x10000, v11
  v_mfma_f32_16x16x32_bf16 v[96:99], v[48:51], a[176:179], v[96:99]
  ds_read_b128 v[40:43], v12 offset:57344
  v_mfma_f32_16x16x32_bf16 v[104:107], v[48:51], a[180:183], v[104:107]
  v_mfma_f32_16x16x32_bf16 v[112:115], v[48:51], a[184:187], v[112:115]
  v_mfma_f32_16x16x32_bf16 v[120:123], v[48:51], a[188:191], v[120:123]
  s_waitcnt lgkmcnt(5)
  v_xor_b32 v12, 0x10000, v12
  v_mfma_f32_16x16x32_bf16 v[100:103], v[52:55], a[176:179], v[100:103]
  ds_read_b128 v[44:47], v13 offset:57344
  v_mfma_f32_16x16x32_bf16 v[108:111], v[52:55], a[180:183], v[108:111]
  v_mfma_f32_16x16x32_bf16 v[116:119], v[52:55], a[184:187], v[116:119]
  buffer_store_dwordx4 v[140:143], v7, s[4:7], s21 offen offset:2304 sc1
  v_mfma_f32_16x16x32_bf16 v[124:127], v[52:55], a[188:191], v[124:127]
  s_waitcnt lgkmcnt(5)
  v_xor_b32 v13, 0x10000, v13
  v_mfma_f32_16x16x32_bf16 v[96:99], v[24:27], a[192:195], v[96:99]
  s_mov_b32 s21, s27
  ds_read_b128 v[48:51], v14 offset:57344
  v_mfma_f32_16x16x32_bf16 v[104:107], v[24:27], a[196:199], v[104:107]
  v_mov_b32 v7, v56
  v_mfma_f32_16x16x32_bf16 v[112:115], v[24:27], a[200:203], v[112:115]
  v_mfma_f32_16x16x32_bf16 v[120:123], v[24:27], a[204:207], v[120:123]
  s_waitcnt lgkmcnt(5)
  v_xor_b32 v14, 0x10000, v14
  v_mfma_f32_16x16x32_bf16 v[100:103], v[28:31], a[192:195], v[100:103]
  s_add_u32 s27, s27, s22
  ds_read_b128 v[52:55], v15 offset:57344
  v_mfma_f32_16x16x32_bf16 v[108:111], v[28:31], a[196:199], v[108:111]
  v_mfma_f32_16x16x32_bf16 v[116:119], v[28:31], a[200:203], v[116:119]
  s_waitcnt vmcnt(13)
  s_barrier
  v_mfma_f32_16x16x32_bf16 v[124:127], v[28:31], a[204:207], v[124:127]
  s_waitcnt lgkmcnt(5)
  v_xor_b32 v15, 0x10000, v15
  v_mfma_f32_16x16x32_bf16 v[96:99], v[32:35], a[208:211], v[96:99]
  ds_read_b128 v[24:27], v8 offset:0
  v_mfma_f32_16x16x32_bf16 v[104:107], v[32:35], a[212:215], v[104:107]
  v_mfma_f32_16x16x32_bf16 v[112:115], v[32:35], a[216:219], v[112:115]
  v_mfma_f32_16x16x32_bf16 v[120:123], v[32:35], a[220:223], v[120:123]
  s_waitcnt lgkmcnt(5)
  v_mfma_f32_16x16x32_bf16 v[100:103], v[36:39], a[208:211], v[100:103]
  s_add_u32 s29, s29, 1
  ds_read_b128 v[28:31], v9 offset:0
  v_mfma_f32_16x16x32_bf16 v[108:111], v[36:39], a[212:215], v[108:111]
  v_mfma_f32_16x16x32_bf16 v[116:119], v[36:39], a[216:219], v[116:119]
  s_max_i32 s30, s29, 0
  v_mfma_f32_16x16x32_bf16 v[124:127], v[36:39], a[220:223], v[124:127]
  s_waitcnt lgkmcnt(5)
  v_mov_b32 v144, s30
  v_mfma_f32_16x16x32_bf16 v[96:99], v[40:43], a[224:227], v[96:99]
  ds_read_b128 v[32:35], v10 offset:0
  v_mfma_f32_16x16x32_bf16 v[104:107], v[40:43], a[228:231], v[104:107]
  v_mfma_f32_16x16x32_bf16 v[112:115], v[40:43], a[232:235], v[112:115]
  buffer_store_dword v144, v145, s[4:7], s31 offen sc1
  v_mfma_f32_16x16x32_bf16 v[120:123], v[40:43], a[236:239], v[120:123]
  s_waitcnt lgkmcnt(5)
  v_mfma_f32_16x16x32_bf16 v[100:103], v[44:47], a[224:227], v[100:103]
  ds_read_b128 v[36:39], v11 offset:0
  v_mfma_f32_16x16x32_bf16 v[108:111], v[44:47], a[228:231], v[108:111]
  v_mfma_f32_16x16x32_bf16 v[116:119], v[44:47], a[232:235], v[116:119]
  v_mfma_f32_16x16x32_bf16 v[124:127], v[44:47], a[236:239], v[124:127]
  s_waitcnt lgkmcnt(5)
  v_mfma_f32_16x16x32_bf16 v[96:99], v[48:51], a[240:243], v[96:99]
  s_sub_u32 s23, s23, 1
  ds_read_b128 v[40:43], v12 offset:0
  v_mfma_f32_16x16x32_bf16 v[104:107], v[48:51], a[244:247], v[104:107]
  v_mfma_f32_16x16x32_bf16 v[112:115], v[48:51], a[248:251], v[112:115]
  v_mfma_f32_16x16x32_bf16 v[120:123], v[48:51], a[252:255], v[120:123]
  s_waitcnt lgkmcnt(5)
  v_mfma_f32_16x16x32_bf16 v[100:103], v[52:55], a[240:243], v[100:103]
  s_cmp_eq_u32 s23, 0
  ds_read_b128 v[44:47], v13 offset:0
  v_mfma_f32_16x16x32_bf16 v[108:111], v[52:55], a[244:247], v[108:111]
  v_mfma_f32_16x16x32_bf16 v[116:119], v[52:55], a[248:251], v[116:119]
  v_mfma_f32_16x16x32_bf16 v[124:127], v[52:55], a[252:255], v[124:127]
  s_cbranch_scc1 G_done1_143
  s_branch G_top_141
G_done0_142:
  s_nop 7
  s_nop 3
  v_cvt_pk_bf16_f32 v128, v64, v65
  v_cvt_pk_bf16_f32 v129, v66, v67
  v_cvt_pk_bf16_f32 v130, v68, v69
  v_cvt_pk_bf16_f32 v131, v70, v71
  buffer_store_dwordx4 v[128:131], v7, s[4:7], s21 offen offset:0 sc1
  v_cvt_pk_bf16_f32 v132, v72, v73
  v_cvt_pk_bf16_f32 v133, v74, v75
  v_cvt_pk_bf16_f32 v134, v76, v77
  v_cvt_pk_bf16_f32 v135, v78, v79
  buffer_store_dwordx4 v[132:135], v7, s[4:7], s21 offen offset:256 sc1
  v_cvt_pk_bf16_f32 v136, v80, v81
  v_cvt_pk_bf16_f32 v137, v82, v83
  v_cvt_pk_bf16_f32 v138, v84, v85
  v_cvt_pk_bf16_f32 v139, v86, v87
  buffer_store_dwordx4 v[136:139], v7, s[4:7], s21 offen offset:2048 sc1
  v_cvt_pk_bf16_f32 v140, v88, v89
  v_cvt_pk_bf16_f32 v141, v90, v91
  v_cvt_pk_bf16_f32 v142, v92, v93
  v_cvt_pk_bf16_f32 v143, v94, v95
  buffer_store_dwordx4 v[140:143], v7, s[4:7], s21 offen offset:2304 sc1
  s_branch G_fin_144
G_done1_143:
  s_nop 7
  s_nop 3
  v_cvt_pk_bf16_f32 v128, v96, v97
  v_cvt_pk_bf16_f32 v129, v98, v99
  v_cvt_pk_bf16_f32 v130, v100, v101
  v_cvt_pk_bf16_f32 v131, v102, v103
  buffer_store_dwordx4 v[128:131], v7, s[4:7], s21 offen offset:0 sc1
  v_cvt_pk_bf16_f32 v132, v104, v105
  v_cvt_pk_bf16_f32 v133, v106, v107
  v_cvt_pk_bf16_f32 v134, v108, v109
  v_cvt_pk_bf16_f32 v135, v110, v111
  buffer_store_dwordx4 v[132:135], v7, s[4:7], s21 offen offset:256 sc1
  v_cvt_pk_bf16_f32 v136, v112, v113
  v_cvt_pk_bf16_f32 v137, v114, v115
  v_cvt_pk_bf16_f32 v138, v116, v117
  v_cvt_pk_bf16_f32 v139, v118, v119
  buffer_store_dwordx4 v[136:139], v7, s[4:7], s21 offen offset:2048 sc1
  v_cvt_pk_bf16_f32 v140, v120, v121
  v_cvt_pk_bf16_f32 v141, v122, v123
  v_cvt_pk_bf16_f32 v142, v124, v125
  v_cvt_pk_bf16_f32 v143, v126, v127
  buffer_store_dwordx4 v[140:143], v7, s[4:7], s21 offen offset:2304 sc1
G_fin_144:
  s_waitcnt vmcnt(0) lgkmcnt(0)
  s_barrier
  s_add_u32 s30, s29, 2
  v_mov_b32 v144, s30
  v_min_u32 v145, 1, v0
  v_lshlrev_b32 v145, 30, v145
  buffer_store_dword v144, v145, s[4:7], s31 offen sc1
P_end_131:
  s_mov_b32 s71, 0
  s_branch M_sg_146
M_sw_145:
  s_sleep 8
  s_add_u32 s71, s71, 1
  s_cmp_gt_u32 s71, 262144
  s_cbranch_scc1 M_exit
M_sg_146:
  s_mov_b32 s79, 0
  s_atomic_or s79, s[74:75], 128 glc
  s_waitcnt lgkmcnt(0)
  s_cmp_lt_u32 s79, 256
  s_cbranch_scc1 M_sw_145
  s_cmp_eq_u32 s65, 6
  s_cbranch_scc1 M_follow
  s_mov_b32 s68, 0
  s_mov_b32 s36, -1
  s_mov_b32 s69, s53
  s_mov_b32 s70, s54
  s_load_dwordx2 s[8:9], s[0:1], 40
  s_mul_i32 s76, s64, 6
  s_add_u32 s76, s76, s65
  s_mul_i32 s76, s76, 21888
  v_min_u32 v200, 170, v0
  v_mul_u32_u24 v200, 128, v200
  v_add_u32 v200, s76, v200
  s_waitcnt lgkmcnt(0)
  s_and_b32 s9, s9, 0xffff
  s_mov_b32 s10, 4194304
  s_mov_b32 s11, 0x20000
M_att:
  s_mov_b32 s24, 0xf149f2ca
  s_mov_b32 s29, 0
  v_mov_b32 v6, 0
  v_mov_b32 v7, 0
  s_lshl_b32 s26, s16, 11
  v_add_u32 v3, s26, v2
  v_and_b32 v5, 31, v1
  v_lshrrev_b32 v12, 5, v1
  v_lshlrev_b32 v12, 2, v12
  v_sub_u32 v5, v5, v12
  s_lshl_b32 s26, s64, 19
  s_add_u32 s19, s26, 16777216
  s_add_u32 s20, s26, 33554432
  s_lshl_b32 s27, s69, 2
  s_add_u32 s27, s27, s16
  s_lshl_b32 s27, s27, 14
  s_add_u32 s25, s26, s27
  s_bfe_u32 s78, s70, 0x80000
  s_add_u32 s76, s67, 512
  s_mov_b32 s71, 0
  s_branch M_sg_148
M_sw_147:
  s_sleep 8
  s_add_u32 s71, s71, 1
  s_cmp_gt_u32 s71, 262144
  s_cbranch_scc1 M_exit
M_sg_148:
  s_mov_b32 s79, 0
  s_atomic_or s79, s[72:73], s76 glc
  s_waitcnt lgkmcnt(0)
  s_cmp_lt_u32 s79, s78
  s_cbranch_scc1 M_sw_147
  s_bfe_u32 s78, s70, 0x80008
  s_add_u32 s76, s67, 640
  s_mov_b32 s71, 0
  s_branch M_sg_150
M_sw_149:
  s_sleep 8
  s_add_u32 s71, s71, 1
  s_cmp_gt_u32 s71, 262144
  s_cbranch_scc1 M_exit
M_sg_150:
  s_mov_b32 s79, 0
  s_atomic_or s79, s[72:73], s76 glc
  s_waitcnt lgkmcnt(0)
  s_cmp_lt_u32 s79, s78
  s_cbranch_scc1 M_sw_149
  s_lshl_b32 s27, s69, 16
  s_add_u32 s27, s27, 16384
  s_add_u32 s17, s19, s27
M_kv_151:
  s_cmp_ge_u32 s17, s36
  s_cbranch_scc1 M_kvok_152
  s_mov_b32 s76, 0
  s_mov_b32 s78, 23
  s_mov_b32 s77, 335872
  s_cmp_eq_u32 s68, 1
  s_cmov_b32 s76, 128
  s_cmov_b32 s78, 27
  s_cmov_b32 s77, 114688
  s_cmp_eq_u32 s68, 2
  s_cmov_b32 s76, 768
  s_cmov_b32 s78, 14
  s_cmov_b32 s77, 0
  s_add_u32 s76, s76, s67
  s_mov_b32 s71, 0
  s_branch M_sg_154
M_sw_153:
  s_sleep 8
  s_add_u32 s71, s71, 1
  s_cmp_gt_u32 s71, 262144
  s_cbranch_scc1 M_exit
M_sg_154:
  s_mov_b32 s79, 0
  s_atomic_or s79, s[72:73], s76 glc
  s_waitcnt lgkmcnt(0)
  s_cmp_lt_u32 s79, s78
  s_cbranch_scc1 M_sw_153
  s_add_u32 s36, s77, s19
  s_add_u32 s68, s68, 1
  s_branch M_kv_151
M_kvok_152:
  s_add_u32 s28, s25, 0
  buffer_load_dwordx4 a[128:131], v2, s[4:7], s28 offen offset:0 sc1
  buffer_load_dwordx4 a[132:135], v2, s[4:7], s28 offen offset:1024 sc1
  buffer_load_dwordx4 a[136:139], v2, s[4:7], s28 offen offset:2048 sc1
  buffer_load_dwordx4 a[140:143], v2, s[4:7], s28 offen offset:3072 sc1
  s_add_u32 s28, s25, 4096
  buffer_load_dwordx4 a[144:147], v2, s[4:7], s28 offen offset:0 sc1
  buffer_load_dwordx4 a[148:151], v2, s[4:7], s28 offen offset:1024 sc1
  buffer_load_dwordx4 a[152:155], v2, s[4:7], s28 offen offset:2048 sc1
  buffer_load_dwordx4 a[156:159], v2, s[4:7], s28 offen offset:3072 sc1
  s_add_u32 s28, s25, 8192
  buffer_load_dwordx4 a[160:163], v2, s[4:7], s28 offen offset:0 sc1
  buffer_load_dwordx4 a[164:167], v2, s[4:7], s28 offen offset:1024 sc1
  buffer_load_dwordx4 a[168:171], v2, s[4:7], s28 offen offset:2048 sc1
  buffer_load_dwordx4 a[172:175], v2, s[4:7], s28 offen offset:3072 sc1
  s_add_u32 s28, s25, 12288
  buffer_load_dwordx4 a[176:179], v2, s[4:7], s28 offen offset:0 sc1
  buffer_load_dwordx4 a[180:183], v2, s[4:7], s28 offen offset:1024 sc1
  buffer_load_dwordx4 a[184:187], v2, s[4:7], s28 offen offset:2048 sc1
  buffer_load_dwordx4 a[188:191], v2, s[4:7], s28 offen offset:3072 sc1
A_again_155:
  s_lshl_b32 s27, s69, 16
  s_add_u32 s27, s27, 57344
  s_add_u32 s17, s19, s27
  s_add_u32 s18, s20, s27
  s_lshl_b32 s21, s16, 11
  s_mov_b32 m0, s21
  s_nop 0
  buffer_load_dwordx4 v3, s[4:7], s18 offen offset:0 sc1 lds
  buffer_load_dwordx4 v3, s[4:7], s18 offen offset:1024 sc1 lds
  s_add_u32 m0, s21, 8192
  s_nop 0
  buffer_load_dwordx4 v3, s[4:7], s17 offen offset:0 sc1 lds
  buffer_load_dwordx4 v3, s[4:7], s17 offen offset:1024 sc1 lds
  s_add_u32 s18, s18, 8192
  s_sub_u32 s18, s18, 8192
  s_max_i32 s18, s18, s20
  s_sub_u32 s17, s17, 8192
  s_max_i32 s17, s17, s19
  s_add_u32 s21, s21, 16384
  s_and_b32 s21, s21, 131071
  s_mov_b32 m0, s21
  s_nop 0
  buffer_load_dwordx4 v3, s[4:7], s18 offen offset:0 sc1 lds
  buffer_load_dwordx4 v3, s[4:7], s18 offen offset:1024 sc1 lds
  s_add_u32 m0, s21, 8192
  s_nop 0
  buffer_load_dwordx4 v3, s[4:7], s17 offen offset:0 sc1 lds
  buffer_load_dwordx4 v3, s[4:7], s17 offen offset:1024 sc1 lds
  s_sub_u32 s18, s18, 8192
  s_max_i32 s18, s18, s20
  s_sub_u32 s17, s17, 8192
  s_max_i32 s17, s17, s19
  s_add_u32 s21, s21, 16384
  s_and_b32 s21, s21, 131071
  s_mov_b32 m0, s21
  s_nop 0
  buffer_load_dwordx4 v3, s[4:7], s18 offen offset:0 sc1 lds
  buffer_load_dwordx4 v3, s[4:7], s18 offen offset:1024 sc1 lds
  s_add_u32 m0, s21, 8192
  s_nop 0
  buffer_load_dwordx4 v3, s[4:7], s17 offen offset:0 sc1 lds
  buffer_load_dwordx4 v3, s[4:7], s17 offen offset:1024 sc1 lds
  s_sub_u32 s18, s18, 8192
  s_max_i32 s18, s18, s20
  s_sub_u32 s17, s17, 8192
  s_max_i32 s17, s17, s19
  s_add_u32 s21, s21, 16384
  s_and_b32 s21, s21, 131071
  s_mov_b32 m0, s21
  s_nop 0
  buffer_load_dwordx4 v3, s[4:7], s18 offen offset:0 sc1 lds
  buffer_load_dwordx4 v3, s[4:7], s18 offen offset:1024 sc1 lds
  s_add_u32 m0, s21, 8192
  s_nop 0
  buffer_load_dwordx4 v3, s[4:7], s17 offen offset:0 sc1 lds
  buffer_load_dwordx4 v3, s[4:7], s17 offen offset:1024 sc1 lds
  s_sub_u32 s18, s18, 8192
  s_max_i32 s18, s18, s20
  s_sub_u32 s17, s17, 8192
  s_max_i32 s17, s17, s19
  s_add_u32 s21, s21, 16384
  s_and_b32 s21, s21, 131071
  s_mov_b32 m0, s21
  s_nop 0
  buffer_load_dwordx4 v3, s[4:7], s18 offen offset:0 sc1 lds
  buffer_load_dwordx4 v3, s[4:7], s18 offen offset:1024 sc1 lds
  s_add_u32 m0, s21, 8192
  s_nop 0
  buffer_load_dwordx4 v3, s[4:7], s17 offen offset:0 sc1 lds
  buffer_load_dwordx4 v3, s[4:7], s17 offen offset:1024 sc1 lds
  s_sub_u32 s18, s18, 8192
  s_max_i32 s18, s18, s20
  s_sub_u32 s17, s17, 8192
  s_max_i32 s17, s17, s19
  s_add_u32 s21, s21, 16384
  s_and_b32 s21, s21, 131071
  s_mov_b32 m0, s21
  s_nop 0
  buffer_load_dwordx4 v3, s[4:7], s18 offen offset:0 sc1 lds
  buffer_load_dwordx4 v3, s[4:7], s18 offen offset:1024 sc1 lds
  s_add_u32 m0, s21, 8192
  s_nop 0
  buffer_load_dwordx4 v3, s[4:7], s17 offen offset:0 sc1 lds
  buffer_load_dwordx4 v3, s[4:7], s17 offen offset:1024 sc1 lds
  v_accvgpr_write_b32 a0, 0
  v_accvgpr_write_b32 a1, 0
  v_accvgpr_write_b32 a2, 0
  v_accvgpr_write_b32 a3, 0
  v_accvgpr_write_b32 a4, 0
  v_accvgpr_write_b32 a5, 0
  v_accvgpr_write_b32 a6, 0
  v_accvgpr_write_b32 a7, 0
  v_accvgpr_write_b32 a8, 0
  v_accvgpr_write_b32 a9, 0
  v_accvgpr_write_b32 a10, 0
  v_accvgpr_write_b32 a11, 0
  v_accvgpr_write_b32 a12, 0
  v_accvgpr_write_b32 a13, 0
  v_accvgpr_write_b32 a14, 0
  v_accvgpr_write_b32 a15, 0
  v_accvgpr_write_b32 a16, 0
  v_accvgpr_write_b32 a17, 0
  v_accvgpr_write_b32 a18, 0
  v_accvgpr_write_b32 a19, 0
  v_accvgpr_write_b32 a20, 0
  v_accvgpr_write_b32 a21, 0
  v_accvgpr_write_b32 a22, 0
  v_accvgpr_write_b32 a23, 0
  v_accvgpr_write_b32 a24, 0
  v_accvgpr_write_b32 a25, 0
  v_accvgpr_write_b32 a26, 0
  v_accvgpr_write_b32 a27, 0
  v_accvgpr_write_b32 a28, 0
  v_accvgpr_write_b32 a29, 0
  v_accvgpr_write_b32 a30, 0
  v_accvgpr_write_b32 a31, 0
  v_accvgpr_write_b32 a32, 0
  v_accvgpr_write_b32 a33, 0
  v_accvgpr_write_b32 a34, 0
  v_accvgpr_write_b32 a35, 0
  v_accvgpr_write_b32 a36, 0
  v_accvgpr_write_b32 a37, 0
  v_accvgpr_write_b32 a38, 0
  v_accvgpr_write_b32 a39, 0
  v_accvgpr_write_b32 a40, 0
  v_accvgpr_write_b32 a41, 0
  v_accvgpr_write_b32 a42, 0
  v_accvgpr_write_b32 a43, 0
  v_accvgpr_write_b32 a44, 0
  v_accvgpr_write_b32 a45, 0
  v_accvgpr_write_b32 a46, 0
  v_accvgpr_write_b32 a47, 0
  v_accvgpr_write_b32 a48, 0
  v_accvgpr_write_b32 a49, 0
  v_accvgpr_write_b32 a50, 0
  v_accvgpr_write_b32 a51, 0
  v_accvgpr_write_b32 a52, 0
  v_accvgpr_write_b32 a53, 0
  v_accvgpr_write_b32 a54, 0
  v_accvgpr_write_b32 a55, 0
  v_accvgpr_write_b32 a56, 0
  v_accvgpr_write_b32 a57, 0
  v_accvgpr_write_b32 a58, 0
  v_accvgpr_write_b32 a59, 0
  v_accvgpr_write_b32 a60, 0
  v_accvgpr_write_b32 a61, 0
  v_accvgpr_write_b32 a62, 0
  v_accvgpr_write_b32 a63, 0
  v_accvgpr_write_b32 a64, 0
  v_accvgpr_write_b32 a65, 0
  v_accvgpr_write_b32 a66, 0
  v_accvgpr_write_b32 a67, 0
  v_accvgpr_write_b32 a68, 0
  v_accvgpr_write_b32 a69, 0
  v_accvgpr_write_b32 a70, 0
  v_accvgpr_write_b32 a71, 0
  v_accvgpr_write_b32 a72, 0
  v_accvgpr_write_b32 a73, 0
  v_accvgpr_write_b32 a74, 0
  v_accvgpr_write_b32 a75, 0
  v_accvgpr_write_b32 a76, 0
  v_accvgpr_write_b32 a77, 0
  v_accvgpr_write_b32 a78, 0
  v_accvgpr_write_b32 a79, 0
  v_accvgpr_write_b32 a80, 0
  v_accvgpr_write_b32 a81, 0
  v_accvgpr_write_b32 a82, 0
  v_accvgpr_write_b32 a83, 0
  v_accvgpr_write_b32 a84, 0
  v_accvgpr_write_b32 a85, 0
  v_accvgpr_write_b32 a86, 0
  v_accvgpr_write_b32 a87, 0
  v_accvgpr_write_b32 a88, 0
  v_accvgpr_write_b32 a89, 0
  v_accvgpr_write_b32 a90, 0
  v_accvgpr_write_b32 a91, 0
  v_accvgpr_write_b32 a92, 0
  v_accvgpr_write_b32 a93, 0
  v_accvgpr_write_b32 a94, 0
  v_accvgpr_write_b32 a95, 0
  v_accvgpr_write_b32 a96, 0
  v_accvgpr_write_b32 a97, 0
  v_accvgpr_write_b32 a98, 0
  v_accvgpr_write_b32 a99, 0
  v_accvgpr_write_b32 a100, 0
  v_accvgpr_write_b32 a101, 0
  v_accvgpr_write_b32 a102, 0
  v_accvgpr_write_b32 a103, 0
  v_accvgpr_write_b32 a104, 0
  v_accvgpr_write_b32 a105, 0
  v_accvgpr_write_b32 a106, 0
  v_accvgpr_write_b32 a107, 0
  v_accvgpr_write_b32 a108, 0
  v_accvgpr_write_b32 a109, 0
  v_accvgpr_write_b32 a110, 0
  v_accvgpr_write_b32 a111, 0
  v_accvgpr_write_b32 a112, 0
  v_accvgpr_write_b32 a113, 0
  v_accvgpr_write_b32 a114, 0
  v_accvgpr_write_b32 a115, 0
  v_accvgpr_write_b32 a116, 0
  v_accvgpr_write_b32 a117, 0
  v_accvgpr_write_b32 a118, 0
  v_accvgpr_write_b32 a119, 0
  v_accvgpr_write_b32 a120, 0
  v_accvgpr_write_b32 a121, 0
  v_accvgpr_write_b32 a122, 0
  v_accvgpr_write_b32 a123, 0
  v_accvgpr_write_b32 a124, 0
  v_accvgpr_write_b32 a125, 0
  v_accvgpr_write_b32 a126, 0
  v_accvgpr_write_b32 a127, 0
  v_mov_b32 v8, 0
  v_mov_b32 v9, 0
  v_mov_b32 v10, 0
  v_mov_b32 v11, 0
  v_mov_b32 v52, 0
  v_mov_b32 v53, 0
  v_mov_b32 v54, s24
  v_mov_b32 v55, s24
  v_mov_b32 v56, s24
  v_mov_b32 v57, s24
  v_mov_b32 v58, s24
  v_mov_b32 v59, s24
  v_mov_b32 v60, s24
  v_mov_b32 v61, s24
  v_mov_b32 v62, s24
  v_mov_b32 v63, s24
  v_mov_b32 v104, 0
  v_mov_b32 v105, 0
  v_mov_b32 v4, v2
  v_mov_b32 v64, s24
  v_mov_b32 v65, s24
  v_mov_b32 v66, s24
  v_mov_b32 v67, s24
  v_mov_b32 v68, s24
  v_mov_b32 v69, s24
  v_mov_b32 v70, s24
  v_mov_b32 v71, s24
  v_mov_b32 v72, s24
  v_mov_b32 v73, s24
  v_mov_b32 v74, s24
  v_mov_b32 v75, s24
  v_mov_b32 v76, s24
  v_mov_b32 v77, s24
  v_mov_b32 v78, s24
  v_mov_b32 v79, s24
  v_mov_b32 v12, s24
  v_cmp_le_i32 s[40:41], 0, v5
  v_cmp_le_i32 s[42:43], 1, v5
  v_cmp_le_i32 s[44:45], 2, v5
  v_cmp_le_i32 s[46:47], 3, v5
  v_cndmask_b32 v80, v12, v7, s[40:41]
  v_cndmask_b32 v81, v12, v7, s[42:43]
  v_cndmask_b32 v82, v12, v7, s[44:45]
  v_cndmask_b32 v83, v12, v7, s[46:47]
  v_cmp_le_i32 s[40:41], 8, v5
  v_cmp_le_i32 s[42:43], 9, v5
  v_cmp_le_i32 s[44:45], 10, v5
  v_cmp_le_i32 s[46:47], 11, v5
  v_cndmask_b32 v84, v12, v7, s[40:41]
  v_cndmask_b32 v85, v12, v7, s[42:43]
  v_cndmask_b32 v86, v12, v7, s[44:45]
  v_cndmask_b32 v87, v12, v7, s[46:47]
  v_cmp_le_i32 s[40:41], 16, v5
  v_cmp_le_i32 s[42:43], 17, v5
  v_cmp_le_i32 s[44:45], 18, v5
  v_cmp_le_i32 s[46:47], 19, v5
  v_cndmask_b32 v88, v12, v7, s[40:41]
  v_cndmask_b32 v89, v12, v7, s[42:43]
  v_cndmask_b32 v90, v12, v7, s[44:45]
  v_cndmask_b32 v91, v12, v7, s[46:47]
  v_cmp_le_i32 s[40:41], 24, v5
  v_cmp_le_i32 s[42:43], 25, v5
  v_cmp_le_i32 s[44:45], 26, v5
  v_cmp_le_i32 s[46:47], 27, v5
  v_cndmask_b32 v92, v12, v7, s[40:41]
  v_cndmask_b32 v93, v12, v7, s[42:43]
  v_cndmask_b32 v94, v12, v7, s[44:45]
  v_cndmask_b32 v95, v12, v7, s[46:47]
  s_lshl_b32 s22, s69, 3
  s_add_u32 s22, s22, 8
  s_lshl_b32 s26, s16, 1
  s_sub_u32 s23, 6, s26
  s_waitcnt vmcnt(20)
  s_barrier
  s_cmp_eq_u32 s23, 0
  s_cbranch_scc1 A_go_157
A_idle_156:
  s_waitcnt vmcnt(16)
  s_barrier
  s_sub_u32 s18, s18, 8192
  s_max_i32 s18, s18, s20
  s_sub_u32 s17, s17, 8192
  s_max_i32 s17, s17, s19
  s_add_u32 s21, s21, 16384
  s_and_b32 s21, s21, 131071
M_kv_158:
  s_cmp_ge_u32 s17, s36
  s_cbranch_scc1 M_kvok_159
  s_mov_b32 s76, 0
  s_mov_b32 s78, 23
  s_mov_b32 s77, 335872
  s_cmp_eq_u32 s68, 1
  s_cmov_b32 s76, 128
  s_cmov_b32 s78, 27
  s_cmov_b32 s77, 114688
  s_cmp_eq_u32 s68, 2
  s_cmov_b32 s76, 768
  s_cmov_b32 s78, 14
  s_cmov_b32 s77, 0
  s_add_u32 s76, s76, s67
  s_mov_b32 s71, 0
  s_branch M_sg_161
M_sw_160:
  s_sleep 8
  s_add_u32 s71, s71, 1
  s_cmp_gt_u32 s71, 262144
  s_cbranch_scc1 M_exit
M_sg_161:
  s_mov_b32 s79, 0
  s_atomic_or s79, s[72:73], s76 glc
  s_waitcnt lgkmcnt(0)
  s_cmp_lt_u32 s79, s78
  s_cbranch_scc1 M_sw_160
  s_add_u32 s36, s77, s19
  s_add_u32 s68, s68, 1
  s_branch M_kv_158
M_kvok_159:
  s_mov_b32 m0, s21
  s_nop 0
  buffer_load_dwordx4 v3, s[4:7], s18 offen offset:0 sc1 lds
  buffer_load_dwordx4 v3, s[4:7], s18 offen offset:1024 sc1 lds
  s_add_u32 m0, s21, 8192
  s_nop 0
  buffer_load_dwordx4 v3, s[4:7], s17 offen offset:0 sc1 lds
  buffer_load_dwordx4 v3, s[4:7], s17 offen offset:1024 sc1 lds
  v_add_u32 v4, 16384, v4
  v_and_b32 v4, 131071, v4
  s_sub_u32 s22, s22, 1
  s_sub_u32 s23, s23, 1
  s_cmp_lg_u32 s23, 0
  s_cbranch_scc1 A_idle_156
A_go_157:
  ds_read_b128 a[224:227], v4 offset:0
  ds_read_b128 a[228:231], v4 offset:2048
  ds_read_b128 a[232:235], v4 offset:4096
  ds_read_b128 a[236:239], v4 offset:6144
  ds_read_b128 a[240:243], v4 offset:1024
  ds_read_b128 a[244:247], v4 offset:3072
  ds_read_b128 a[248:251], v4 offset:5120
  ds_read_b128 a[252:255], v4 offset:7168
  ds_read_b128 a[192:195], v4 offset:8192
  ds_read_b128 a[196:199], v4 offset:9216
  ds_read_b128 a[200:203], v4 offset:10240
  ds_read_b128 a[204:207], v4 offset:11264
  ds_read_b128 a[208:211], v4 offset:12288
  ds_read_b128 a[212:215], v4 offset:13312
  ds_read_b128 a[216:219], v4 offset:14336
  ds_read_b128 a[220:223], v4 offset:15360
  v_add_u32 v4, 16384, v4
  v_and_b32 v4, 131071, v4
  s_waitcnt lgkmcnt(8)
.p2align 6
A_top_162:
  s_waitcnt lgkmcnt(7)
  v_mfma_f32_32x32x16_bf16 v[32:47], a[192:195], a[128:131], v[64:79]
  s_waitcnt lgkmcnt(6)
  v_exp_f32 v54, v54
  v_add_f32 v11, v11, v53
  v_cvt_pk_bf16_f32 v106, v52, v53
  v_mfma_f32_32x32x16_bf16 v[32:47], a[196:199], a[132:135], v[32:47]
  s_waitcnt lgkmcnt(4)
  v_exp_f32 v55, v55
  v_add_f32 v10, v10, v54
  v_mfma_f32_32x32x16_bf16 v[32:47], a[200:203], a[136:139], v[32:47]
  v_exp_f32 v56, v56
  v_add_f32 v11, v11, v55
  v_cvt_pk_bf16_f32 v107, v54, v55
  v_mfma_f32_32x32x16_bf16 v[32:47], a[204:207], a[140:143], v[32:47]
  s_waitcnt lgkmcnt(2)
  v_exp_f32 v57, v57
  v_add_f32 v10, v10, v56
  v_mfma_f32_32x32x16_bf16 v[32:47], a[208:211], a[144:147], v[32:47]
  v_exp_f32 v58, v58
  v_add_f32 v11, v11, v57
  v_cvt_pk_bf16_f32 v108, v56, v57
  v_mfma_f32_32x32x16_bf16 v[32:47], a[212:215], a[148:151], v[32:47]
  s_waitcnt lgkmcnt(0)
  v_exp_f32 v59, v59
  v_add_f32 v10, v10, v58
  v_mfma_f32_32x32x16_bf16 v[32:47], a[216:219], a[152:155], v[32:47]
  v_exp_f32 v60, v60
  v_add_f32 v11, v11, v59
  v_cvt_pk_bf16_f32 v109, v58, v59
  v_mfma_f32_32x32x16_bf16 v[32:47], a[220:223], a[156:159], v[32:47]
  s_waitcnt vmcnt(16)
  s_barrier
  v_exp_f32 v61, v61
  v_add_f32 v10, v10, v60
  v_mfma_f32_32x32x16_bf16 a[64:79], a[224:227], v[104:107], a[64:79]
  ds_read_b128 a[224:227], v4 offset:0
  v_exp_f32 v62, v62
  v_add_f32 v11, v11, v61
  v_cvt_pk_bf16_f32 v110, v60, v61
  v_mfma_f32_32x32x16_bf16 a[80:95], a[228:231], v[104:107], a[80:95]
  s_sub_u32 s18, s18, 8192
  ds_read_b128 a[228:231], v4 offset:2048
  v_exp_f32 v63, v63
  v_add_f32 v10, v10, v62
  v_mfma_f32_32x32x16_bf16 a[96:111], a[232:235], v[104:107], a[96:111]
  s_max_i32 s18, s18, s20
  ds_read_b128 a[232:235], v4 offset:4096
  v_exp_f32 v32, v32
  v_add_f32 v11, v11, v63
  v_cvt_pk_bf16_f32 v111, v62, v63
  v_mfma_f32_32x32x16_bf16 a[112:127], a[236:239], v[104:107], a[112:127]
  s_sub_u32 s17, s17, 8192
  ds_read_b128 a[236:239], v4 offset:6144
  v_exp_f32 v33, v33
  v_add_f32 v8, v8, v32
  v_mfma_f32_32x32x16_bf16 a[64:79], a[240:243], v[108:111], a[64:79]
  s_max_i32 s17, s17, s19
  ds_read_b128 a[240:243], v4 offset:1024
  v_exp_f32 v34, v34
  v_add_f32 v9, v9, v33
  v_cvt_pk_bf16_f32 v96, v32, v33
  v_mfma_f32_32x32x16_bf16 a[80:95], a[244:247], v[108:111], a[80:95]
  s_add_u32 s21, s21, 16384
  ds_read_b128 a[244:247], v4 offset:3072
  v_exp_f32 v35, v35
  v_add_f32 v8, v8, v34
  v_mfma_f32_32x32x16_bf16 a[96:111], a[248:251], v[108:111], a[96:111]
  s_and_b32 s21, s21, 131071
  ds_read_b128 a[248:251], v4 offset:5120
  v_exp_f32 v36, v36
  v_add_f32 v9, v9, v35
  v_cvt_pk_bf16_f32 v97, v34, v35
  v_mfma_f32_32x32x16_bf16 a[112:127], a[252:255], v[108:111], a[112:127]
  ds_read_b128 a[252:255], v4 offset:7168
  v_exp_f32 v37, v37
  v_add_f32 v8, v8, v36
  v_mfma_f32_32x32x16_bf16 v[48:63], a[192:195], a[160:163], v[80:95]
  s_add_u32 s23, s23, 1
  ds_read_b128 a[192:195], v4 offset:8192
  v_exp_f32 v38, v38
  v_add_f32 v9, v9, v37
  v_cvt_pk_bf16_f32 v98, v36, v37
  v_mfma_f32_32x32x16_bf16 v[48:63], a[196:199], a[164:167], v[48:63]
  s_sub_u32 s22, s22, 1
  ds_read_b128 a[196:199], v4 offset:9216
  v_exp_f32 v39, v39
  v_add_f32 v8, v8, v38
  v_mfma_f32_32x32x16_bf16 v[48:63], a[200:203], a[168:171], v[48:63]
  s_cmp_lt_u32 s23, 3
  ds_read_b128 a[200:203], v4 offset:10240
  v_exp_f32 v40, v40
  v_add_f32 v9, v9, v39
  v_cvt_pk_bf16_f32 v99, v38, v39
  v_mfma_f32_32x32x16_bf16 v[48:63], a[204:207], a[172:175], v[48:63]
  s_cbranch_scc1 A_upd_163
A_back_164:
  ds_read_b128 a[204:207], v4 offset:11264
  v_exp_f32 v41, v41
  v_add_f32 v8, v8, v40
  v_mfma_f32_32x32x16_bf16 v[48:63], a[208:211], a[176:179], v[48:63]
  s_cmp_lt_u32 s17, s36
  ds_read_b128 a[208:211], v4 offset:12288
  v_exp_f32 v42, v42
  v_add_f32 v9, v9, v41
  v_cvt_pk_bf16_f32 v100, v40, v41
  v_mfma_f32_32x32x16_bf16 v[48:63], a[212:215], a[180:183], v[48:63]
  s_cbranch_scc1 A_kvw_166
A_kvb_167:
  ds_read_b128 a[212:215], v4 offset:13312
  v_exp_f32 v43, v43
  v_add_f32 v8, v8, v42
  v_mfma_f32_32x32x16_bf16 v[48:63], a[216:219], a[184:187], v[48:63]
  s_mov_b32 m0, s21
  ds_read_b128 a[216:219], v4 offset:14336
  v_exp_f32 v44, v44
  v_add_f32 v9, v9, v43
  v_cvt_pk_bf16_f32 v101, v42, v43
  v_mfma_f32_32x32x16_bf16 v[48:63], a[220:223], a[188:191], v[48:63]
  s_waitcnt lgkmcnt(13)
  ds_read_b128 a[220:223], v4 offset:15360
  v_exp_f32 v45, v45
  v_add_f32 v8, v8, v44
  v_mfma_f32_32x32x16_bf16 a[0:15], a[224:227], v[96:99], a[0:15]
  buffer_load_dwordx4 v3, s[4:7], s18 offen offset:0 sc1 lds
  v_exp_f32 v46, v46
  v_add_f32 v9, v9, v45
  v_cvt_pk_bf16_f32 v102, v44, v45
  v_mfma_f32_32x32x16_bf16 a[16:31], a[228:231], v[96:99], a[16:31]
  s_waitcnt lgkmcnt(12)
  v_exp_f32 v47, v47
  v_add_f32 v8, v8, v46
  v_add_u32 v4, 16384, v4
  v_mfma_f32_32x32x16_bf16 a[32:47], a[232:235], v[96:99], a[32:47]
  buffer_load_dwordx4 v3, s[4:7], s18 offen offset:1024 sc1 lds
  v_exp_f32 v48, v48
  v_add_f32 v9, v9, v47
  v_cvt_pk_bf16_f32 v103, v46, v47
  v_mfma_f32_32x32x16_bf16 a[48:63], a[236:239], v[96:99], a[48:63]
  s_waitcnt lgkmcnt(10)
  s_add_u32 m0, s21, 8192
  v_exp_f32 v49, v49
  v_add_f32 v10, v10, v48
  v_and_b32 v4, 131071, v4
  v_mfma_f32_32x32x16_bf16 a[0:15], a[240:243], v[100:103], a[0:15]
  buffer_load_dwordx4 v3, s[4:7], s17 offen offset:0 sc1 lds
  v_exp_f32 v50, v50
  v_add_f32 v11, v11, v49
  v_cvt_pk_bf16_f32 v104, v48, v49
  v_mfma_f32_32x32x16_bf16 a[16:31], a[244:247], v[100:103], a[16:31]
  s_waitcnt lgkmcnt(8)
  s_cmp_lg_u32 s22, 0
  v_exp_f32 v51, v51
  v_add_f32 v10, v10, v50
  v_mfma_f32_32x32x16_bf16 a[32:47], a[248:251], v[100:103], a[32:47]
  buffer_load_dwordx4 v3, s[4:7], s17 offen offset:1024 sc1 lds
  v_exp_f32 v52, v52
  v_add_f32 v11, v11, v51
  v_cvt_pk_bf16_f32 v105, v50, v51
  v_mfma_f32_32x32x16_bf16 a[48:63], a[252:255], v[100:103], a[48:63]
  v_exp_f32 v53, v53
  v_add_f32 v10, v10, v52
  s_cbranch_scc1 A_top_162
  v_exp_f32 v54, v54
  v_add_f32 v11, v11, v53
  v_cvt_pk_bf16_f32 v106, v52, v53
  v_exp_f32 v55, v55
  v_add_f32 v10, v10, v54
  v_exp_f32 v56, v56
  v_add_f32 v11, v11, v55
  v_cvt_pk_bf16_f32 v107, v54, v55
  v_exp_f32 v57, v57
  v_add_f32 v10, v10, v56
  v_exp_f32 v58, v58
  v_add_f32 v11, v11, v57
  v_cvt_pk_bf16_f32 v108, v56, v57
  v_exp_f32 v59, v59
  v_add_f32 v10, v10, v58
  v_exp_f32 v60, v60
  v_add_f32 v11, v11, v59
  v_cvt_pk_bf16_f32 v109, v58, v59
  v_exp_f32 v61, v61
  v_add_f32 v10, v10, v60
  v_exp_f32 v62, v62
  v_add_f32 v11, v11, v61
  v_cvt_pk_bf16_f32 v110, v60, v61
  v_exp_f32 v63, v63
  v_add_f32 v10, v10, v62
  v_add_f32 v11, v11, v63
  v_cvt_pk_bf16_f32 v111, v62, v63
  s_nop 1
  v_mfma_f32_32x32x16_bf16 a[64:79], a[224:227], v[104:107], a[64:79]
  v_mfma_f32_32x32x16_bf16 a[80:95], a[228:231], v[104:107], a[80:95]
  v_mfma_f32_32x32x16_bf16 a[96:111], a[232:235], v[104:107], a[96:111]
  v_mfma_f32_32x32x16_bf16 a[112:127], a[236:239], v[104:107], a[112:127]
  v_mfma_f32_32x32x16_bf16 a[64:79], a[240:243], v[108:111], a[64:79]
  v_mfma_f32_32x32x16_bf16 a[80:95], a[244:247], v[108:111], a[80:95]
  v_mfma_f32_32x32x16_bf16 a[96:111], a[248:251], v[108:111], a[96:111]
  v_mfma_f32_32x32x16_bf16 a[112:127], a[252:255], v[108:111], a[112:127]
  v_add_f32 v8, v8, v9
  v_mov_b32 v9, v8
  s_nop 1
  v_permlane32_swap_b32 v8, v9
  s_nop 1
  v_add_f32 v8, v8, v9
  v_add_f32 v10, v10, v11
  v_mov_b32 v11, v10
  s_nop 1
  v_permlane32_swap_b32 v10, v11
  s_nop 1
  v_add_f32 v10, v10, v11
  v_subrev_u32 v12, 0x2f800000, v8
  v_subrev_u32 v13, 0x2f800000, v10
  v_max_u32 v12, v12, v13
  v_cmp_le_u32 vcc, 0x28000000, v12
  s_nop 1
  s_cmp_lg_u64 vcc, 0
  s_cselect_b32 s26, 1, 0
  v_mov_b32 v12, s26
  s_lshl_b32 s26, s16, 2
  s_add_u32 s26, s26, 131072
  v_mov_b32 v13, s26
  ds_write_b32 v13, v12
  v_mov_b32 v14, 131072
  s_waitcnt vmcnt(0) lgkmcnt(0)
  s_barrier
  ds_read_b128 v[16:19], v14
  v_rcp_f32 v8, v8
  v_rcp_f32 v10, v10
  s_waitcnt lgkmcnt(0)
  v_or3_b32 v12, v16, v17, v18
  v_or_b32 v12, v12, v19
  s_nop 0
  v_readfirstlane_b32 s26, v12
  s_nop 1
  s_cmp_gt_u32 s26, s29
  s_cbranch_scc1 A_slow_168
  s_add_u32 s28, s25, 100663296
  v_accvgpr_read_b32 v112, a0
  v_accvgpr_read_b32 v113, a1
  v_accvgpr_read_b32 v114, a2
  v_accvgpr_read_b32 v115, a3
  v_accvgpr_read_b32 v116, a4
  v_accvgpr_read_b32 v117, a5
  v_accvgpr_read_b32 v118, a6
  v_accvgpr_read_b32 v119, a7
  v_pk_mul_f32 v[112:113], v[112:113], v[8:9] op_sel_hi:[1,0]
  v_pk_mul_f32 v[114:115], v[114:115], v[8:9] op_sel_hi:[1,0]
  v_pk_mul_f32 v[116:117], v[116:117], v[8:9] op_sel_hi:[1,0]
  v_pk_mul_f32 v[118:119], v[118:119], v[8:9] op_sel_hi:[1,0]
  v_cvt_pk_bf16_f32 v120, v112, v113
  v_cvt_pk_bf16_f32 v121, v114, v115
  v_cvt_pk_bf16_f32 v122, v116, v117
  v_cvt_pk_bf16_f32 v123, v118, v119
  buffer_store_dwordx4 v[120:123], v2, s[4:7], s28 offen offset:0 sc1
  v_accvgpr_read_b32 v124, a8
  v_accvgpr_read_b32 v125, a9
  v_accvgpr_read_b32 v126, a10
  v_accvgpr_read_b32 v127, a11
  v_accvgpr_read_b32 v128, a12
  v_accvgpr_read_b32 v129, a13
  v_accvgpr_read_b32 v130, a14
  v_accvgpr_read_b32 v131, a15
  v_pk_mul_f32 v[124:125], v[124:125], v[8:9] op_sel_hi:[1,0]
  v_pk_mul_f32 v[126:127], v[126:127], v[8:9] op_sel_hi:[1,0]
  v_pk_mul_f32 v[128:129], v[128:129], v[8:9] op_sel_hi:[1,0]
  v_pk_mul_f32 v[130:131], v[130:131], v[8:9] op_sel_hi:[1,0]
  v_cvt_pk_bf16_f32 v132, v124, v125
  v_cvt_pk_bf16_f32 v133, v126, v127
  v_cvt_pk_bf16_f32 v134, v128, v129
  v_cvt_pk_bf16_f32 v135, v130, v131
  buffer_store_dwordx4 v[132:135], v2, s[4:7], s28 offen offset:1024 sc1
  v_accvgpr_read_b32 v136, a16
  v_accvgpr_read_b32 v137, a17
  v_accvgpr_read_b32 v138, a18
  v_accvgpr_read_b32 v139, a19
  v_accvgpr_read_b32 v140, a20
  v_accvgpr_read_b32 v141, a21
  v_accvgpr_read_b32 v142, a22
  v_accvgpr_read_b32 v143, a23
  v_pk_mul_f32 v[136:137], v[136:137], v[8:9] op_sel_hi:[1,0]
  v_pk_mul_f32 v[138:139], v[138:139], v[8:9] op_sel_hi:[1,0]
  v_pk_mul_f32 v[140:141], v[140:141], v[8:9] op_sel_hi:[1,0]
  v_pk_mul_f32 v[142:143], v[142:143], v[8:9] op_sel_hi:[1,0]
  v_cvt_pk_bf16_f32 v144, v136, v137
  v_cvt_pk_bf16_f32 v145, v138, v139
  v_cvt_pk_bf16_f32 v146, v140, v141
  v_cvt_pk_bf16_f32 v147, v142, v143
  buffer_store_dwordx4 v[144:147], v2, s[4:7], s28 offen offset:2048 sc1
  v_accvgpr_read_b32 v148, a24
  v_accvgpr_read_b32 v149, a25
  v_accvgpr_read_b32 v150, a26
  v_accvgpr_read_b32 v151, a27
  v_accvgpr_read_b32 v152, a28
  v_accvgpr_read_b32 v153, a29
  v_accvgpr_read_b32 v154, a30
  v_accvgpr_read_b32 v155, a31
  v_pk_mul_f32 v[148:149], v[148:149], v[8:9] op_sel_hi:[1,0]
  v_pk_mul_f32 v[150:151], v[150:151], v[8:9] op_sel_hi:[1,0]
  v_pk_mul_f32 v[152:153], v[152:153], v[8:9] op_sel_hi:[1,0]
  v_pk_mul_f32 v[154:155], v[154:155], v[8:9] op_sel_hi:[1,0]
  v_cvt_pk_bf16_f32 v156, v148, v149
  v_cvt_pk_bf16_f32 v157, v150, v151
  v_cvt_pk_bf16_f32 v158, v152, v153
  v_cvt_pk_bf16_f32 v159, v154, v155
  buffer_store_dwordx4 v[156:159], v2, s[4:7], s28 offen offset:3072 sc1
  s_add_u32 s28, s25, 100667392
  v_accvgpr_read_b32 v112, a32
  v_accvgpr_read_b32 v113, a33
  v_accvgpr_read_b32 v114, a34
  v_accvgpr_read_b32 v115, a35
  v_accvgpr_read_b32 v116, a36
  v_accvgpr_read_b32 v117, a37
  v_accvgpr_read_b32 v118, a38
  v_accvgpr_read_b32 v119, a39
  v_pk_mul_f32 v[112:113], v[112:113], v[8:9] op_sel_hi:[1,0]
  v_pk_mul_f32 v[114:115], v[114:115], v[8:9] op_sel_hi:[1,0]
  v_pk_mul_f32 v[116:117], v[116:117], v[8:9] op_sel_hi:[1,0]
  v_pk_mul_f32 v[118:119], v[118:119], v[8:9] op_sel_hi:[1,0]
  v_cvt_pk_bf16_f32 v120, v112, v113
  v_cvt_pk_bf16_f32 v121, v114, v115
  v_cvt_pk_bf16_f32 v122, v116, v117
  v_cvt_pk_bf16_f32 v123, v118, v119
  buffer_store_dwordx4 v[120:123], v2, s[4:7], s28 offen offset:0 sc1
  v_accvgpr_read_b32 v124, a40
  v_accvgpr_read_b32 v125, a41
  v_accvgpr_read_b32 v126, a42
  v_accvgpr_read_b32 v127, a43
  v_accvgpr_read_b32 v128, a44
  v_accvgpr_read_b32 v129, a45
  v_accvgpr_read_b32 v130, a46
  v_accvgpr_read_b32 v131, a47
  v_pk_mul_f32 v[124:125], v[124:125], v[8:9] op_sel_hi:[1,0]
  v_pk_mul_f32 v[126:127], v[126:127], v[8:9] op_sel_hi:[1,0]
  v_pk_mul_f32 v[128:129], v[128:129], v[8:9] op_sel_hi:[1,0]
  v_pk_mul_f32 v[130:131], v[130:131], v[8:9] op_sel_hi:[1,0]
  v_cvt_pk_bf16_f32 v132, v124, v125
  v_cvt_pk_bf16_f32 v133, v126, v127
  v_cvt_pk_bf16_f32 v134, v128, v129
  v_cvt_pk_bf16_f32 v135, v130, v131
  buffer_store_dwordx4 v[132:135], v2, s[4:7], s28 offen offset:1024 sc1
  v_accvgpr_read_b32 v136, a48
  v_accvgpr_read_b32 v137, a49
  v_accvgpr_read_b32 v138, a50
  v_accvgpr_read_b32 v139, a51
  v_accvgpr_read_b32 v140, a52
  v_accvgpr_read_b32 v141, a53
  v_accvgpr_read_b32 v142, a54
  v_accvgpr_read_b32 v143, a55
  v_pk_mul_f32 v[136:137], v[136:137], v[8:9] op_sel_hi:[1,0]
  v_pk_mul_f32 v[138:139], v[138:139], v[8:9] op_sel_hi:[1,0]
  v_pk_mul_f32 v[140:141], v[140:141], v[8:9] op_sel_hi:[1,0]
  v_pk_mul_f32 v[142:143], v[142:143], v[8:9] op_sel_hi:[1,0]
  v_cvt_pk_bf16_f32 v144, v136, v137
  v_cvt_pk_bf16_f32 v145, v138, v139
  v_cvt_pk_bf16_f32 v146, v140, v141
  v_cvt_pk_bf16_f32 v147, v142, v143
  buffer_store_dwordx4 v[144:147], v2, s[4:7], s28 offen offset:2048 sc1
  v_accvgpr_read_b32 v148, a56
  v_accvgpr_read_b32 v149, a57
  v_accvgpr_read_b32 v150, a58
  v_accvgpr_read_b32 v151, a59
  v_accvgpr_read_b32 v152, a60
  v_accvgpr_read_b32 v153, a61
  v_accvgpr_read_b32 v154, a62
  v_accvgpr_read_b32 v155, a63
  v_pk_mul_f32 v[148:149], v[148:149], v[8:9] op_sel_hi:[1,0]
  v_pk_mul_f32 v[150:151], v[150:151], v[8:9] op_sel_hi:[1,0]
  v_pk_mul_f32 v[152:153], v[152:153], v[8:9] op_sel_hi:[1,0]
  v_pk_mul_f32 v[154:155], v[154:155], v[8:9] op_sel_hi:[1,0]
  v_cvt_pk_bf16_f32 v156, v148, v149
  v_cvt_pk_bf16_f32 v157, v150, v151
  v_cvt_pk_bf16_f32 v158, v152, v153
  v_cvt_pk_bf16_f32 v159, v154, v155
  buffer_store_dwordx4 v[156:159], v2, s[4:7], s28 offen offset:3072 sc1
  s_add_u32 s28, s25, 100671488
  v_accvgpr_read_b32 v112, a64
  v_accvgpr_read_b32 v113, a65
  v_accvgpr_read_b32 v114, a66
  v_accvgpr_read_b32 v115, a67
  v_accvgpr_read_b32 v116, a68
  v_accvgpr_read_b32 v117, a69
  v_accvgpr_read_b32 v118, a70
  v_accvgpr_read_b32 v119, a71
  v_pk_mul_f32 v[112:113], v[112:113], v[10:11] op_sel_hi:[1,0]
  v_pk_mul_f32 v[114:115], v[114:115], v[10:11] op_sel_hi:[1,0]
  v_pk_mul_f32 v[116:117], v[116:117], v[10:11] op_sel_hi:[1,0]
  v_pk_mul_f32 v[118:119], v[118:119], v[10:11] op_sel_hi:[1,0]
  v_cvt_pk_bf16_f32 v120, v112, v113
  v_cvt_pk_bf16_f32 v121, v114, v115
  v_cvt_pk_bf16_f32 v122, v116, v117
  v_cvt_pk_bf16_f32 v123, v118, v119
  buffer_store_dwordx4 v[120:123], v2, s[4:7], s28 offen offset:0 sc1
  v_accvgpr_read_b32 v124, a72
  v_accvgpr_read_b32 v125, a73
  v_accvgpr_read_b32 v126, a74
  v_accvgpr_read_b32 v127, a75
  v_accvgpr_read_b32 v128, a76
  v_accvgpr_read_b32 v129, a77
  v_accvgpr_read_b32 v130, a78
  v_accvgpr_read_b32 v131, a79
  v_pk_mul_f32 v[124:125], v[124:125], v[10:11] op_sel_hi:[1,0]
  v_pk_mul_f32 v[126:127], v[126:127], v[10:11] op_sel_hi:[1,0]
  v_pk_mul_f32 v[128:129], v[128:129], v[10:11] op_sel_hi:[1,0]
  v_pk_mul_f32 v[130:131], v[130:131], v[10:11] op_sel_hi:[1,0]
  v_cvt_pk_bf16_f32 v132, v124, v125
  v_cvt_pk_bf16_f32 v133, v126, v127
  v_cvt_pk_bf16_f32 v134, v128, v129
  v_cvt_pk_bf16_f32 v135, v130, v131
  buffer_store_dwordx4 v[132:135], v2, s[4:7], s28 offen offset:1024 sc1
  v_accvgpr_read_b32 v136, a80
  v_accvgpr_read_b32 v137, a81
  v_accvgpr_read_b32 v138, a82
  v_accvgpr_read_b32 v139, a83
  v_accvgpr_read_b32 v140, a84
  v_accvgpr_read_b32 v141, a85
  v_accvgpr_read_b32 v142, a86
  v_accvgpr_read_b32 v143, a87
  v_pk_mul_f32 v[136:137], v[136:137], v[10:11] op_sel_hi:[1,0]
  v_pk_mul_f32 v[138:139], v[138:139], v[10:11] op_sel_hi:[1,0]
  v_pk_mul_f32 v[140:141], v[140:141], v[10:11] op_sel_hi:[1,0]
  v_pk_mul_f32 v[142:143], v[142:143], v[10:11] op_sel_hi:[1,0]
  v_cvt_pk_bf16_f32 v144, v136, v137
  v_cvt_pk_bf16_f32 v145, v138, v139
  v_cvt_pk_bf16_f32 v146, v140, v141
  v_cvt_pk_bf16_f32 v147, v142, v143
  buffer_store_dwordx4 v[144:147], v2, s[4:7], s28 offen offset:2048 sc1
  v_accvgpr_read_b32 v148, a88
  v_accvgpr_read_b32 v149, a89
  v_accvgpr_read_b32 v150, a90
  v_accvgpr_read_b32 v151, a91
  v_accvgpr_read_b32 v152, a92
  v_accvgpr_read_b32 v153, a93
  v_accvgpr_read_b32 v154, a94
  v_accvgpr_read_b32 v155, a95
  v_pk_mul_f32 v[148:149], v[148:149], v[10:11] op_sel_hi:[1,0]
  v_pk_mul_f32 v[150:151], v[150:151], v[10:11] op_sel_hi:[1,0]
  v_pk_mul_f32 v[152:153], v[152:153], v[10:11] op_sel_hi:[1,0]
  v_pk_mul_f32 v[154:155], v[154:155], v[10:11] op_sel_hi:[1,0]
  v_cvt_pk_bf16_f32 v156, v148, v149
  v_cvt_pk_bf16_f32 v157, v150, v151
  v_cvt_pk_bf16_f32 v158, v152, v153
  v_cvt_pk_bf16_f32 v159, v154, v155
  buffer_store_dwordx4 v[156:159], v2, s[4:7], s28 offen offset:3072 sc1
  s_add_u32 s28, s25, 100675584
  v_accvgpr_read_b32 v112, a96
  v_accvgpr_read_b32 v113, a97
  v_accvgpr_read_b32 v114, a98
  v_accvgpr_read_b32 v115, a99
  v_accvgpr_read_b32 v116, a100
  v_accvgpr_read_b32 v117, a101
  v_accvgpr_read_b32 v118, a102
  v_accvgpr_read_b32 v119, a103
  v_pk_mul_f32 v[112:113], v[112:113], v[10:11] op_sel_hi:[1,0]
  v_pk_mul_f32 v[114:115], v[114:115], v[10:11] op_sel_hi:[1,0]
  v_pk_mul_f32 v[116:117], v[116:117], v[10:11] op_sel_hi:[1,0]
  v_pk_mul_f32 v[118:119], v[118:119], v[10:11] op_sel_hi:[1,0]
  v_cvt_pk_bf16_f32 v120, v112, v113
  v_cvt_pk_bf16_f32 v121, v114, v115
  v_cvt_pk_bf16_f32 v122, v116, v117
  v_cvt_pk_bf16_f32 v123, v118, v119
  buffer_store_dwordx4 v[120:123], v2, s[4:7], s28 offen offset:0 sc1
  v_accvgpr_read_b32 v124, a104
  v_accvgpr_read_b32 v125, a105
  v_accvgpr_read_b32 v126, a106
  v_accvgpr_read_b32 v127, a107
  v_accvgpr_read_b32 v128, a108
  v_accvgpr_read_b32 v129, a109
  v_accvgpr_read_b32 v130, a110
  v_accvgpr_read_b32 v131, a111
  v_pk_mul_f32 v[124:125], v[124:125], v[10:11] op_sel_hi:[1,0]
  v_pk_mul_f32 v[126:127], v[126:127], v[10:11] op_sel_hi:[1,0]
  v_pk_mul_f32 v[128:129], v[128:129], v[10:11] op_sel_hi:[1,0]
  v_pk_mul_f32 v[130:131], v[130:131], v[10:11] op_sel_hi:[1,0]
  v_cvt_pk_bf16_f32 v132, v124, v125
  v_cvt_pk_bf16_f32 v133, v126, v127
  v_cvt_pk_bf16_f32 v134, v128, v129
  v_cvt_pk_bf16_f32 v135, v130, v131
  buffer_store_dwordx4 v[132:135], v2, s[4:7], s28 offen offset:1024 sc1
  v_accvgpr_read_b32 v136, a112
  v_accvgpr_read_b32 v137, a113
  v_accvgpr_read_b32 v138, a114
  v_accvgpr_read_b32 v139, a115
  v_accvgpr_read_b32 v140, a116
  v_accvgpr_read_b32 v141, a117
  v_accvgpr_read_b32 v142, a118
  v_accvgpr_read_b32 v143, a119
  v_pk_mul_f32 v[136:137], v[136:137], v[10:11] op_sel_hi:[1,0]
  v_pk_mul_f32 v[138:139], v[138:139], v[10:11] op_sel_hi:[1,0]
  v_pk_mul_f32 v[140:141], v[140:141], v[10:11] op_sel_hi:[1,0]
  v_pk_mul_f32 v[142:143], v[142:143], v[10:11] op_sel_hi:[1,0]
  v_cvt_pk_bf16_f32 v144, v136, v137
  v_cvt_pk_bf16_f32 v145, v138, v139
  v_cvt_pk_bf16_f32 v146, v140, v141
  v_cvt_pk_bf16_f32 v147, v142, v143
  buffer_store_dwordx4 v[144:147], v2, s[4:7], s28 offen offset:2048 sc1
  v_accvgpr_read_b32 v148, a120
  v_accvgpr_read_b32 v149, a121
  v_accvgpr_read_b32 v150, a122
  v_accvgpr_read_b32 v151, a123
  v_accvgpr_read_b32 v152, a124
  v_accvgpr_read_b32 v153, a125
  v_accvgpr_read_b32 v154, a126
  v_accvgpr_read_b32 v155, a127
  v_pk_mul_f32 v[148:149], v[148:149], v[10:11] op_sel_hi:[1,0]
  v_pk_mul_f32 v[150:151], v[150:151], v[10:11] op_sel_hi:[1,0]
  v_pk_mul_f32 v[152:153], v[152:153], v[10:11] op_sel_hi:[1,0]
  v_pk_mul_f32 v[154:155], v[154:155], v[10:11] op_sel_hi:[1,0]
  v_cvt_pk_bf16_f32 v156, v148, v149
  v_cvt_pk_bf16_f32 v157, v150, v151
  v_cvt_pk_bf16_f32 v158, v152, v153
  v_cvt_pk_bf16_f32 v159, v154, v155
  buffer_store_dwordx4 v[156:159], v2, s[4:7], s28 offen offset:3072 sc1
  s_branch A_out_165
A_kvw_166:
M_kv_169:
  s_cmp_ge_u32 s17, s36
  s_cbranch_scc1 M_kvok_170
  s_mov_b32 s76, 0
  s_mov_b32 s78, 23
  s_mov_b32 s77, 335872
  s_cmp_eq_u32 s68, 1
  s_cmov_b32 s76, 128
  s_cmov_b32 s78, 27
  s_cmov_b32 s77, 114688
  s_cmp_eq_u32 s68, 2
  s_cmov_b32 s76, 768
  s_cmov_b32 s78, 14
  s_cmov_b32 s77, 0
  s_add_u32 s76, s76, s67
  s_mov_b32 s71, 0
  s_branch M_sg_172
M_sw_171:
  s_sleep 8
  s_add_u32 s71, s71, 1
  s_cmp_gt_u32 s71, 262144
  s_cbranch_scc1 M_exit
M_sg_172:
  s_mov_b32 s79, 0
  s_atomic_or s79, s[72:73], s76 glc
  s_waitcnt lgkmcnt(0)
  s_cmp_lt_u32 s79, s78
  s_cbranch_scc1 M_sw_171
  s_add_u32 s36, s77, s19
  s_add_u32 s68, s68, 1
  s_branch M_kv_169
M_kvok_170:
  s_branch A_kvb_167
A_upd_163:
  s_cmp_eq_u32 s23, 2
  s_cbranch_scc1 A_upd2_173
  v_mov_b32 v12, s24
  v_cmp_le_i32 s[40:41], 0, v5
  v_cmp_le_i32 s[42:43], 1, v5
  v_cmp_le_i32 s[44:45], 2, v5
  v_cmp_le_i32 s[46:47], 3, v5
  v_cndmask_b32 v64, v12, v6, s[40:41]
  v_cndmask_b32 v65, v12, v6, s[42:43]
  v_cndmask_b32 v66, v12, v6, s[44:45]
  v_cndmask_b32 v67, v12, v6, s[46:47]
  v_cmp_le_i32 s[40:41], 8, v5
  v_cmp_le_i32 s[42:43], 9, v5
  v_cmp_le_i32 s[44:45], 10, v5
  v_cmp_le_i32 s[46:47], 11, v5
  v_cndmask_b32 v68, v12, v6, s[40:41]
  v_cndmask_b32 v69, v12, v6, s[42:43]
  v_cndmask_b32 v70, v12, v6, s[44:45]
  v_cndmask_b32 v71, v12, v6, s[46:47]
  v_cmp_le_i32 s[40:41], 16, v5
  v_cmp_le_i32 s[42:43], 17, v5
  v_cmp_le_i32 s[44:45], 18, v5
  v_cmp_le_i32 s[46:47], 19, v5
  v_cndmask_b32 v72, v12, v6, s[40:41]
  v_cndmask_b32 v73, v12, v6, s[42:43]
  v_cndmask_b32 v74, v12, v6, s[44:45]
  v_cndmask_b32 v75, v12, v6, s[46:47]
  v_cmp_le_i32 s[40:41], 24, v5
  v_cmp_le_i32 s[42:43], 25, v5
  v_cmp_le_i32 s[44:45], 26, v5
  v_cmp_le_i32 s[46:47], 27, v5
  v_cndmask_b32 v76, v12, v6, s[40:41]
  v_cndmask_b32 v77, v12, v6, s[42:43]
  v_cndmask_b32 v78, v12, v6, s[44:45]
  v_cndmask_b32 v79, v12, v6, s[46:47]
  v_mov_b32 v80, v7
  v_mov_b32 v81, v7
  v_mov_b32 v82, v7
  v_mov_b32 v83, v7
  v_mov_b32 v84, v7
  v_mov_b32 v85, v7
  v_mov_b32 v86, v7
  v_mov_b32 v87, v7
  v_mov_b32 v88, v7
  v_mov_b32 v89, v7
  v_mov_b32 v90, v7
  v_mov_b32 v91, v7
  v_mov_b32 v92, v7
  v_mov_b32 v93, v7
  v_mov_b32 v94, v7
  v_mov_b32 v95, v7
  s_branch A_back_164
A_upd2_173:
  v_mov_b32 v64, v6
  v_mov_b32 v65, v6
  v_mov_b32 v66, v6
  v_mov_b32 v67, v6
  v_mov_b32 v68, v6
  v_mov_b32 v69, v6
  v_mov_b32 v70, v6
  v_mov_b32 v71, v6
  v_mov_b32 v72, v6
  v_mov_b32 v73, v6
  v_mov_b32 v74, v6
  v_mov_b32 v75, v6
  v_mov_b32 v76, v6
  v_mov_b32 v77, v6
  v_mov_b32 v78, v6
  v_mov_b32 v79, v6
  s_branch A_back_164
A_slow_168:
  s_mov_b32 s29, 1
  v_mov_b32 v64, s24
  v_mov_b32 v65, s24
  v_mov_b32 v66, s24
  v_mov_b32 v67, s24
  v_mov_b32 v68, s24
  v_mov_b32 v69, s24
  v_mov_b32 v70, s24
  v_mov_b32 v71, s24
  v_mov_b32 v72, s24
  v_mov_b32 v73, s24
  v_mov_b32 v74, s24
  v_mov_b32 v75, s24
  v_mov_b32 v76, s24
  v_mov_b32 v77, s24
  v_mov_b32 v78, s24
  v_mov_b32 v79, s24
  v_mov_b32 v12, s24
  v_cmp_le_i32 s[40:41], 0, v5
  v_cmp_le_i32 s[42:43], 1, v5
  v_cmp_le_i32 s[44:45], 2, v5
  v_cmp_le_i32 s[46:47], 3, v5
  v_cndmask_b32 v80, v12, v7, s[40:41]
  v_cndmask_b32 v81, v12, v7, s[42:43]
  v_cndmask_b32 v82, v12, v7, s[44:45]
  v_cndmask_b32 v83, v12, v7, s[46:47]
  v_cmp_le_i32 s[40:41], 8, v5
  v_cmp_le_i32 s[42:43], 9, v5
  v_cmp_le_i32 s[44:45], 10, v5
  v_cmp_le_i32 s[46:47], 11, v5
  v_cndmask_b32 v84, v12, v7, s[40:41]
  v_cndmask_b32 v85, v12, v7, s[42:43]
  v_cndmask_b32 v86, v12, v7, s[44:45]
  v_cndmask_b32 v87, v12, v7, s[46:47]
  v_cmp_le_i32 s[40:41], 16, v5
  v_cmp_le_i32 s[42:43], 17, v5
  v_cmp_le_i32 s[44:45], 18, v5
  v_cmp_le_i32 s[46:47], 19, v5
  v_cndmask_b32 v88, v12, v7, s[40:41]
  v_cndmask_b32 v89, v12, v7, s[42:43]
  v_cndmask_b32 v90, v12, v7, s[44:45]
  v_cndmask_b32 v91, v12, v7, s[46:47]
  v_cmp_le_i32 s[40:41], 24, v5
  v_cmp_le_i32 s[42:43], 25, v5
  v_cmp_le_i32 s[44:45], 26, v5
  v_cmp_le_i32 s[46:47], 27, v5
  v_cndmask_b32 v92, v12, v7, s[40:41]
  v_cndmask_b32 v93, v12, v7, s[42:43]
  v_cndmask_b32 v94, v12, v7, s[44:45]
  v_cndmask_b32 v95, v12, v7, s[46:47]
  v_mov_b32 v8, s24
  v_mov_b32 v10, s24
  s_add_u32 s17, s25, 16785408
  s_mov_b32 s23, 0
A_ml_174:
  s_add_u32 s28, s17, 4096
  buffer_load_dwordx4 a[192:195], v2, s[4:7], s17 offen offset:0 sc1
  buffer_load_dwordx4 a[196:199], v2, s[4:7], s17 offen offset:1024 sc1
  buffer_load_dwordx4 a[200:203], v2, s[4:7], s17 offen offset:2048 sc1
  buffer_load_dwordx4 a[204:207], v2, s[4:7], s17 offen offset:3072 sc1
  buffer_load_dwordx4 a[208:211], v2, s[4:7], s28 offen offset:0 sc1
  buffer_load_dwordx4 a[212:215], v2, s[4:7], s28 offen offset:1024 sc1
  buffer_load_dwordx4 a[216:219], v2, s[4:7], s28 offen offset:2048 sc1
  buffer_load_dwordx4 a[220:223], v2, s[4:7], s28 offen offset:3072 sc1
  s_waitcnt vmcnt(0)
  v_mfma_f32_32x32x16_bf16 v[32:47], a[192:195], a[128:131], v[64:79]
  v_mfma_f32_32x32x16_bf16 v[32:47], a[196:199], a[132:135], v[32:47]
  v_mfma_f32_32x32x16_bf16 v[32:47], a[200:203], a[136:139], v[32:47]
  v_mfma_f32_32x32x16_bf16 v[32:47], a[204:207], a[140:143], v[32:47]
  v_mfma_f32_32x32x16_bf16 v[32:47], a[208:211], a[144:147], v[32:47]
  v_mfma_f32_32x32x16_bf16 v[32:47], a[212:215], a[148:151], v[32:47]
  v_mfma_f32_32x32x16_bf16 v[32:47], a[216:219], a[152:155], v[32:47]
  v_mfma_f32_32x32x16_bf16 v[32:47], a[220:223], a[156:159], v[32:47]
  v_mfma_f32_32x32x16_bf16 v[48:63], a[192:195], a[160:163], v[80:95]
  v_mfma_f32_32x32x16_bf16 v[48:63], a[196:199], a[164:167], v[48:63]
  v_mfma_f32_32x32x16_bf16 v[48:63], a[200:203], a[168:171], v[48:63]
  v_mfma_f32_32x32x16_bf16 v[48:63], a[204:207], a[172:175], v[48:63]
  v_mfma_f32_32x32x16_bf16 v[48:63], a[208:211], a[176:179], v[48:63]
  v_mfma_f32_32x32x16_bf16 v[48:63], a[212:215], a[180:183], v[48:63]
  v_mfma_f32_32x32x16_bf16 v[48:63], a[216:219], a[184:187], v[48:63]
  v_mfma_f32_32x32x16_bf16 v[48:63], a[220:223], a[188:191], v[48:63]
  s_nop 7
  s_nop 3
  v_max3_f32 v8, v8, v32, v33
  v_max3_f32 v8, v8, v34, v35
  v_max3_f32 v8, v8, v36, v37
  v_max3_f32 v8, v8, v38, v39
  v_max3_f32 v8, v8, v40, v41
  v_max3_f32 v8, v8, v42, v43
  v_max3_f32 v8, v8, v44, v45
  v_max3_f32 v8, v8, v46, v47
  v_max3_f32 v10, v10, v48, v49
  v_max3_f32 v10, v10, v50, v51
  v_max3_f32 v10, v10, v52, v53
  v_max3_f32 v10, v10, v54, v55
  v_max3_f32 v10, v10, v56, v57
  v_max3_f32 v10, v10, v58, v59
  v_max3_f32 v10, v10, v60, v61
  v_max3_f32 v10, v10, v62, v63
  s_add_u32 s23, s23, 1
  s_cmp_lg_u32 s23, 1
  s_cbranch_scc1 A_m2_175
  v_mov_b32 v12, s24
  v_cmp_le_i32 s[40:41], 0, v5
  v_cmp_le_i32 s[42:43], 1, v5
  v_cmp_le_i32 s[44:45], 2, v5
  v_cmp_le_i32 s[46:47], 3, v5
  v_cndmask_b32 v64, v12, v6, s[40:41]
  v_cndmask_b32 v65, v12, v6, s[42:43]
  v_cndmask_b32 v66, v12, v6, s[44:45]
  v_cndmask_b32 v67, v12, v6, s[46:47]
  v_cmp_le_i32 s[40:41], 8, v5
  v_cmp_le_i32 s[42:43], 9, v5
  v_cmp_le_i32 s[44:45], 10, v5
  v_cmp_le_i32 s[46:47], 11, v5
  v_cndmask_b32 v68, v12, v6, s[40:41]
  v_cndmask_b32 v69, v12, v6, s[42:43]
  v_cndmask_b32 v70, v12, v6, s[44:45]
  v_cndmask_b32 v71, v12, v6, s[46:47]
  v_cmp_le_i32 s[40:41], 16, v5
  v_cmp_le_i32 s[42:43], 17, v5
  v_cmp_le_i32 s[44:45], 18, v5
  v_cmp_le_i32 s[46:47], 19, v5
  v_cndmask_b32 v72, v12, v6, s[40:41]
  v_cndmask_b32 v73, v12, v6, s[42:43]
  v_cndmask_b32 v74, v12, v6, s[44:45]
  v_cndmask_b32 v75, v12, v6, s[46:47]
  v_cmp_le_i32 s[40:41], 24, v5
  v_cmp_le_i32 s[42:43], 25, v5
  v_cmp_le_i32 s[44:45], 26, v5
  v_cmp_le_i32 s[46:47], 27, v5
  v_cndmask_b32 v76, v12, v6, s[40:41]
  v_cndmask_b32 v77, v12, v6, s[42:43]
  v_cndmask_b32 v78, v12, v6, s[44:45]
  v_cndmask_b32 v79, v12, v6, s[46:47]
  v_mov_b32 v80, v7
  v_mov_b32 v81, v7
  v_mov_b32 v82, v7
  v_mov_b32 v83, v7
  v_mov_b32 v84, v7
  v_mov_b32 v85, v7
  v_mov_b32 v86, v7
  v_mov_b32 v87, v7
  v_mov_b32 v88, v7
  v_mov_b32 v89, v7
  v_mov_b32 v90, v7
  v_mov_b32 v91, v7
  v_mov_b32 v92, v7
  v_mov_b32 v93, v7
  v_mov_b32 v94, v7
  v_mov_b32 v95, v7
A_m2_175:
  s_cmp_lg_u32 s23, 2
  s_cbranch_scc1 A_m3_176
  v_mov_b32 v64, v6
  v_mov_b32 v65, v6
  v_mov_b32 v66, v6
  v_mov_b32 v67, v6
  v_mov_b32 v68, v6
  v_mov_b32 v69, v6
  v_mov_b32 v70, v6
  v_mov_b32 v71, v6
  v_mov_b32 v72, v6
  v_mov_b32 v73, v6
  v_mov_b32 v74, v6
  v_mov_b32 v75, v6
  v_mov_b32 v76, v6
  v_mov_b32 v77, v6
  v_mov_b32 v78, v6
  v_mov_b32 v79, v6
A_m3_176:
  s_sub_u32 s17, s17, 8192
  s_cmp_ge_i32 s17, s19
  s_cbranch_scc1 A_ml_174
  v_mov_b32 v9, v8
  s_nop 1
  v_permlane32_swap_b32 v8, v9
  s_nop 1
  v_max_f32 v8, v8, v9
  v_sub_f32 v6, 0, v8
  v_mov_b32 v11, v10
  s_nop 1
  v_permlane32_swap_b32 v10, v11
  s_nop 1
  v_max_f32 v10, v10, v11
  v_sub_f32 v7, 0, v10
  s_branch A_again_155
A_out_165:
  s_mov_b32 s69, s55
  s_mov_b32 s70, s56
  s_sub_u32 s52, s52, 1
  s_cmp_lg_u32 s52, 0
  s_cbranch_scc1 M_att
  s_waitcnt vmcnt(0)
  s_barrier
  s_mov_b32 s30, 512
  v_mov_b32 v144, s30
  v_min_u32 v145, 1, v0
  v_lshlrev_b32 v145, 30, v145
  buffer_store_dword v144, v145, s[4:7], s31 offen sc1
  s_lshr_b32 s48, s64, 2
  s_bfe_u32 s49, s64, 0x10001
  s_and_b32 s50, s64, 1
  s_mul_i32 s50, s50, 6
  s_add_u32 s50, s50, s65
  s_mov_b32 s51, 12
  s_cmp_lt_u32 s50, 4
  s_cselect_b32 s23, 6, 5
  s_load_dwordx2 s[8:9], s[0:1], 40
  s_lshl_b32 s17, s48, 19
  s_lshl_b32 s26, s49, 2
  s_add_u32 s26, s26, s16
  s_lshl_b32 s27, s26, 7
  s_add_u32 s17, s17, s27
  s_mov_b32 s18, 1024
  s_lshl_b32 s21, s48, 6
  s_add_u32 s21, s21, s50
  s_lshl_b32 s21, s21, 3
  s_add_u32 s21, s21, s26
  s_lshl_b32 s21, s21, 12
  s_add_u32 s21, s21, 150994944
  s_lshl_b32 s22, s51, 15
  s_mov_b32 s24, 1.0
  s_waitcnt lgkmcnt(0)
  s_and_b32 s9, s9, 0xffff
  s_mov_b32 s10, 4194304
  s_mov_b32 s11, 0x20000
  s_mov_b32 s12, s4
  s_mov_b32 s13, s5
  s_mov_b32 s14, 268435456
  s_mov_b32 s15, 0x20000
  s_lshl_b32 s19, s48, 8
  s_add_u32 s19, s19, s50
  s_lshl_b32 s19, s19, 13
  s_add_u32 s19, s19, 100663296
  s_lshl_b32 s20, s51, 13
  v_lshrrev_b32 v144, 4, v1
  v_and_b32 v56, 0xff, v2
  v_lshl_add_u32 v56, v144, 9, v56
  s_mul_i32 s26, s16, 524288
  v_add_u32 v8, 0, v56
  v_add_u32 v16, 0, v2
  v_add_u32 v16, s26, v16
  v_add_u32 v9, 256, v56
  v_add_u32 v17, 1024, v2
  v_add_u32 v17, s26, v17
  v_add_u32 v10, 2048, v56
  v_add_u32 v18, 2048, v2
  v_add_u32 v18, s26, v18
  v_add_u32 v11, 2304, v56
  v_add_u32 v19, 3072, v2
  v_add_u32 v19, s26, v19
  v_add_u32 v12, 4096, v56
  v_add_u32 v20, 4096, v2
  v_add_u32 v20, s26, v20
  v_add_u32 v13, 4352, v56
  v_add_u32 v21, 5120, v2
  v_add_u32 v21, s26, v21
  v_add_u32 v14, 6144, v56
  v_add_u32 v22, 6144, v2
  v_add_u32 v22, s26, v22
  v_add_u32 v15, 6400, v56
  v_add_u32 v23, 7168, v2
  v_add_u32 v23, s26, v23
  v_lshrrev_b32 v144, 3, v1
  v_mul_lo_u32 v144, v144, s18
  v_and_b32 v145, 7, v1
  v_lshl_add_u32 v144, v145, 4, v144
  s_lshl_b32 s28, s16, 15
  s_add_u32 s28, s28, 32768
  s_lshl_b32 s29, s18, 3
  s_add_u32 m0, s28, 0
  s_nop 0
  buffer_load_dwordx4 v144, s[8:11], s17 offen lds
  s_add_u32 s17, s17, s29
  s_add_u32 m0, s28, 1024
  s_nop 0
  buffer_load_dwordx4 v144, s[8:11], s17 offen lds
  s_add_u32 s17, s17, s29
  s_add_u32 m0, s28, 2048
  s_nop 0
  buffer_load_dwordx4 v144, s[8:11], s17 offen lds
  s_add_u32 s17, s17, s29
  s_add_u32 m0, s28, 3072
  s_nop 0
  buffer_load_dwordx4 v144, s[8:11], s17 offen lds
  s_add_u32 s17, s17, s29
  s_add_u32 m0, s28, 4096
  s_nop 0
  buffer_load_dwordx4 v144, s[8:11], s17 offen lds
  s_add_u32 s17, s17, s29
  s_add_u32 m0, s28, 5120
  s_nop 0
  buffer_load_dwordx4 v144, s[8:11], s17 offen lds
  s_add_u32 s17, s17, s29
  s_add_u32 m0, s28, 6144
  s_nop 0
  buffer_load_dwordx4 v144, s[8:11], s17 offen lds
  s_add_u32 s17, s17, s29
  s_add_u32 m0, s28, 7168
  s_nop 0
  buffer_load_dwordx4 v144, s[8:11], s17 offen lds
  s_add_u32 s17, s17, s29
  v_bfe_u32 v148, v1, 2, 2
  v_lshrrev_b32 v149, 5, v1
  v_lshl_add_u32 v148, v149, 4, v148
  v_bfe_u32 v149, v1, 4, 1
  v_lshl_add_u32 v148, v149, 2, v148
  v_and_b32 v149, 3, v1
  v_lshlrev_b32 v149, 4, v149
  s_mov_b32 s26, 8
  v_lshl_add_u32 v148, v148, 7, v149
  v_add_u32 v152, s28, v148
  v_add_u32 v153, 1024, v152
  v_add_u32 v154, s26, v152
  v_add_u32 v155, s26, v153
  s_waitcnt vmcnt(4)
  ds_read_b64_tr_b16 a[0:1], v152 offset:0
  ds_read_b64_tr_b16 a[2:3], v153 offset:0
  ds_read_b64_tr_b16 a[4:5], v154 offset:0
  ds_read_b64_tr_b16 a[6:7], v155 offset:0
  ds_read_b64_tr_b16 a[8:9], v152 offset:64
  ds_read_b64_tr_b16 a[10:11], v153 offset:64
  ds_read_b64_tr_b16 a[12:13], v154 offset:64
  ds_read_b64_tr_b16 a[14:15], v155 offset:64
  s_waitcnt lgkmcnt(0)
  s_add_u32 m0, s28, 8192
  s_nop 0
  buffer_load_dwordx4 v144, s[8:11], s17 offen lds
  s_add_u32 s17, s17, s29
  s_add_u32 m0, s28, 9216
  s_nop 0
  buffer_load_dwordx4 v144, s[8:11], s17 offen lds
  s_add_u32 s17, s17, s29
  s_add_u32 m0, s28, 10240
  s_nop 0
  buffer_load_dwordx4 v144, s[8:11], s17 offen lds
  s_add_u32 s17, s17, s29
  s_add_u32 m0, s28, 11264
  s_nop 0
  buffer_load_dwordx4 v144, s[8:11], s17 offen lds
  s_add_u32 s17, s17, s29
  s_waitcnt vmcnt(4)
  ds_read_b64_tr_b16 a[16:17], v152 offset:4096
  ds_read_b64_tr_b16 a[18:19], v153 offset:4096
  ds_read_b64_tr_b16 a[20:21], v154 offset:4096
  ds_read_b64_tr_b16 a[22:23], v155 offset:4096
  ds_read_b64_tr_b16 a[24:25], v152 offset:4160
  ds_read_b64_tr_b16 a[26:27], v153 offset:4160
  ds_read_b64_tr_b16 a[28:29], v154 offset:4160
  ds_read_b64_tr_b16 a[30:31], v155 offset:4160
  s_waitcnt lgkmcnt(0)
  s_add_u32 m0, s28, 12288
  s_nop 0
  buffer_load_dwordx4 v144, s[8:11], s17 offen lds
  s_add_u32 s17, s17, s29
  s_add_u32 m0, s28, 13312
  s_nop 0
  buffer_load_dwordx4 v144, s[8:11], s17 offen lds
  s_add_u32 s17, s17, s29
  s_add_u32 m0, s28, 14336
  s_nop 0
  buffer_load_dwordx4 v144, s[8:11], s17 offen lds
  s_add_u32 s17, s17, s29
  s_add_u32 m0, s28, 15360
  s_nop 0
  buffer_load_dwordx4 v144, s[8:11], s17 offen lds
  s_add_u32 s17, s17, s29
  s_waitcnt vmcnt(4)
  ds_read_b64_tr_b16 a[32:33], v152 offset:8192
  ds_read_b64_tr_b16 a[34:35], v153 offset:8192
  ds_read_b64_tr_b16 a[36:37], v154 offset:8192
  ds_read_b64_tr_b16 a[38:39], v155 offset:8192
  ds_read_b64_tr_b16 a[40:41], v152 offset:8256
  ds_read_b64_tr_b16 a[42:43], v153 offset:8256
  ds_read_b64_tr_b16 a[44:45], v154 offset:8256
  ds_read_b64_tr_b16 a[46:47], v155 offset:8256
  s_waitcnt lgkmcnt(0)
  s_add_u32 m0, s28, 16384
  s_nop 0
  buffer_load_dwordx4 v144, s[8:11], s17 offen lds
  s_add_u32 s17, s17, s29
  s_add_u32 m0, s28, 17408
  s_nop 0
  buffer_load_dwordx4 v144, s[8:11], s17 offen lds
  s_add_u32 s17, s17, s29
  s_add_u32 m0, s28, 18432
  s_nop 0
  buffer_load_dwordx4 v144, s[8:11], s17 offen lds
  s_add_u32 s17, s17, s29
  s_add_u32 m0, s28, 19456
  s_nop 0
  buffer_load_dwordx4 v144, s[8:11], s17 offen lds
  s_add_u32 s17, s17, s29
  s_waitcnt vmcnt(4)
  ds_read_b64_tr_b16 a[48:49], v152 offset:12288
  ds_read_b64_tr_b16 a[50:51], v153 offset:12288
  ds_read_b64_tr_b16 a[52:53], v154 offset:12288
  ds_read_b64_tr_b16 a[54:55], v155 offset:12288
  ds_read_b64_tr_b16 a[56:57], v152 offset:12352
  ds_read_b64_tr_b16 a[58:59], v153 offset:12352
  ds_read_b64_tr_b16 a[60:61], v154 offset:12352
  ds_read_b64_tr_b16 a[62:63], v155 offset:12352
  s_waitcnt lgkmcnt(0)
  s_add_u32 m0, s28, 20480
  s_nop 0
  buffer_load_dwordx4 v144, s[8:11], s17 offen lds
  s_add_u32 s17, s17, s29
  s_add_u32 m0, s28, 21504
  s_nop 0
  buffer_load_dwordx4 v144, s[8:11], s17 offen lds
  s_add_u32 s17, s17, s29
  s_add_u32 m0, s28, 22528
  s_nop 0
  buffer_load_dwordx4 v144, s[8:11], s17 offen lds
  s_add_u32 s17, s17, s29
  s_add_u32 m0, s28, 23552
  s_nop 0
  buffer_load_dwordx4 v144, s[8:11], s17 offen lds
  s_add_u32 s17, s17, s29
  s_waitcnt vmcnt(4)
  ds_read_b64_tr_b16 a[64:65], v152 offset:16384
  ds_read_b64_tr_b16 a[66:67], v153 offset:16384
  ds_read_b64_tr_b16 a[68:69], v154 offset:16384
  ds_read_b64_tr_b16 a[70:71], v155 offset:16384
  ds_read_b64_tr_b16 a[72:73], v152 offset:16448
  ds_read_b64_tr_b16 a[74:75], v153 offset:16448
  ds_read_b64_tr_b16 a[76:77], v154 offset:16448
  ds_read_b64_tr_b16 a[78:79], v155 offset:16448
  s_waitcnt lgkmcnt(0)
  s_add_u32 m0, s28, 24576
  s_nop 0
  buffer_load_dwordx4 v144, s[8:11], s17 offen lds
  s_add_u32 s17, s17, s29
  s_add_u32 m0, s28, 25600
  s_nop 0
  buffer_load_dwordx4 v144, s[8:11], s17 offen lds
  s_add_u32 s17, s17, s29
  s_add_u32 m0, s28, 26624
  s_nop 0
  buffer_load_dwordx4 v144, s[8:11], s17 offen lds
  s_add_u32 s17, s17, s29
  s_add_u32 m0, s28, 27648
  s_nop 0
  buffer_load_dwordx4 v144, s[8:11], s17 offen lds
  s_add_u32 s17, s17, s29
  s_waitcnt vmcnt(4)
  ds_read_b64_tr_b16 a[80:81], v152 offset:20480
  ds_read_b64_tr_b16 a[82:83], v153 offset:20480
  ds_read_b64_tr_b16 a[84:85], v154 offset:20480
  ds_read_b64_tr_b16 a[86:87], v155 offset:20480
  ds_read_b64_tr_b16 a[88:89], v152 offset:20544
  ds_read_b64_tr_b16 a[90:91], v153 offset:20544
  ds_read_b64_tr_b16 a[92:93], v154 offset:20544
  ds_read_b64_tr_b16 a[94:95], v155 offset:20544
  s_waitcnt lgkmcnt(0)
  s_add_u32 m0, s28, 28672
  s_nop 0
  buffer_load_dwordx4 v144, s[8:11], s17 offen lds
  s_add_u32 s17, s17, s29
  s_add_u32 m0, s28, 29696
  s_nop 0
  buffer_load_dwordx4 v144, s[8:11], s17 offen lds
  s_add_u32 s17, s17, s29
  s_add_u32 m0, s28, 30720
  s_nop 0
  buffer_load_dwordx4 v144, s[8:11], s17 offen lds
  s_add_u32 s17, s17, s29
  s_add_u32 m0, s28, 31744
  s_nop 0
  buffer_load_dwordx4 v144, s[8:11], s17 offen lds
  s_add_u32 s17, s17, s29
  s_waitcnt vmcnt(4)
  ds_read_b64_tr_b16 a[96:97], v152 offset:24576
  ds_read_b64_tr_b16 a[98:99], v153 offset:24576
  ds_read_b64_tr_b16 a[100:101], v154 offset:24576
  ds_read_b64_tr_b16 a[102:103], v155 offset:24576
  ds_read_b64_tr_b16 a[104:105], v152 offset:24640
  ds_read_b64_tr_b16 a[106:107], v153 offset:24640
  ds_read_b64_tr_b16 a[108:109], v154 offset:24640
  ds_read_b64_tr_b16 a[110:111], v155 offset:24640
  s_waitcnt lgkmcnt(0)
  s_add_u32 m0, s28, 0
  s_nop 0
  buffer_load_dwordx4 v144, s[8:11], s17 offen lds
  s_add_u32 s17, s17, s29
  s_add_u32 m0, s28, 1024
  s_nop 0
  buffer_load_dwordx4 v144, s[8:11], s17 offen lds
  s_add_u32 s17, s17, s29
  s_add_u32 m0, s28, 2048
  s_nop 0
  buffer_load_dwordx4 v144, s[8:11], s17 offen lds
  s_add_u32 s17, s17, s29
  s_add_u32 m0, s28, 3072
  s_nop 0
  buffer_load_dwordx4 v144, s[8:11], s17 offen lds
  s_add_u32 s17, s17, s29
  s_waitcnt vmcnt(4)
  ds_read_b64_tr_b16 a[112:113], v152 offset:28672
  ds_read_b64_tr_b16 a[114:115], v153 offset:28672
  ds_read_b64_tr_b16 a[116:117], v154 offset:28672
  ds_read_b64_tr_b16 a[118:119], v155 offset:28672
  ds_read_b64_tr_b16 a[120:121], v152 offset:28736
  ds_read_b64_tr_b16 a[122:123], v153 offset:28736
  ds_read_b64_tr_b16 a[124:125], v154 offset:28736
  ds_read_b64_tr_b16 a[126:127], v155 offset:28736
  s_waitcnt lgkmcnt(0)
  s_add_u32 m0, s28, 4096
  s_nop 0
  buffer_load_dwordx4 v144, s[8:11], s17 offen lds
  s_add_u32 s17, s17, s29
  s_add_u32 m0, s28, 5120
  s_nop 0
  buffer_load_dwordx4 v144, s[8:11], s17 offen lds
  s_add_u32 s17, s17, s29
  s_add_u32 m0, s28, 6144
  s_nop 0
  buffer_load_dwordx4 v144, s[8:11], s17 offen lds
  s_add_u32 s17, s17, s29
  s_add_u32 m0, s28, 7168
  s_nop 0
  buffer_load_dwordx4 v144, s[8:11], s17 offen lds
  s_add_u32 s17, s17, s29
  s_waitcnt vmcnt(4)
  ds_read_b64_tr_b16 a[128:129], v152 offset:0
  ds_read_b64_tr_b16 a[130:131], v153 offset:0
  ds_read_b64_tr_b16 a[132:133], v154 offset:0
  ds_read_b64_tr_b16 a[134:135], v155 offset:0
  ds_read_b64_tr_b16 a[136:137], v152 offset:64
  ds_read_b64_tr_b16 a[138:139], v153 offset:64
  ds_read_b64_tr_b16 a[140:141], v154 offset:64
  ds_read_b64_tr_b16 a[142:143], v155 offset:64
  s_waitcnt lgkmcnt(0)
  s_add_u32 m0, s28, 8192
  s_nop 0
  buffer_load_dwordx4 v144, s[8:11], s17 offen lds
  s_add_u32 s17, s17, s29
  s_add_u32 m0, s28, 9216
  s_nop 0
  buffer_load_dwordx4 v144, s[8:11], s17 offen lds
  s_add_u32 s17, s17, s29
  s_add_u32 m0, s28, 10240
  s_nop 0
  buffer_load_dwordx4 v144, s[8:11], s17 offen lds
  s_add_u32 s17, s17, s29
  s_add_u32 m0, s28, 11264
  s_nop 0
  buffer_load_dwordx4 v144, s[8:11], s17 offen lds
  s_add_u32 s17, s17, s29
  s_waitcnt vmcnt(4)
  ds_read_b64_tr_b16 a[144:145], v152 offset:4096
  ds_read_b64_tr_b16 a[146:147], v153 offset:4096
  ds_read_b64_tr_b16 a[148:149], v154 offset:4096
  ds_read_b64_tr_b16 a[150:151], v155 offset:4096
  ds_read_b64_tr_b16 a[152:153], v152 offset:4160
  ds_read_b64_tr_b16 a[154:155], v153 offset:4160
  ds_read_b64_tr_b16 a[156:157], v154 offset:4160
  ds_read_b64_tr_b16 a[158:159], v155 offset:4160
  s_waitcnt lgkmcnt(0)
  s_add_u32 m0, s28, 12288
  s_nop 0
  buffer_load_dwordx4 v144, s[8:11], s17 offen lds
  s_add_u32 s17, s17, s29
  s_add_u32 m0, s28, 13312
  s_nop 0
  buffer_load_dwordx4 v144, s[8:11], s17 offen lds
  s_add_u32 s17, s17, s29
  s_add_u32 m0, s28, 14336
  s_nop 0
  buffer_load_dwordx4 v144, s[8:11], s17 offen lds
  s_add_u32 s17, s17, s29
  s_add_u32 m0, s28, 15360
  s_nop 0
  buffer_load_dwordx4 v144, s[8:11], s17 offen lds
  s_add_u32 s17, s17, s29
  s_waitcnt vmcnt(4)
  ds_read_b64_tr_b16 a[160:161], v152 offset:8192
  ds_read_b64_tr_b16 a[162:163], v153 offset:8192
  ds_read_b64_tr_b16 a[164:165], v154 offset:8192
  ds_read_b64_tr_b16 a[166:167], v155 offset:8192
  ds_read_b64_tr_b16 a[168:169], v152 offset:8256
  ds_read_b64_tr_b16 a[170:171], v153 offset:8256
  ds_read_b64_tr_b16 a[172:173], v154 offset:8256
  ds_read_b64_tr_b16 a[174:175], v155 offset:8256
  s_waitcnt lgkmcnt(0)
  s_add_u32 m0, s28, 16384
  s_nop 0
  buffer_load_dwordx4 v144, s[8:11], s17 offen lds
  s_add_u32 s17, s17, s29
  s_add_u32 m0, s28, 17408
  s_nop 0
  buffer_load_dwordx4 v144, s[8:11], s17 offen lds
  s_add_u32 s17, s17, s29
  s_add_u32 m0, s28, 18432
  s_nop 0
  buffer_load_dwordx4 v144, s[8:11], s17 offen lds
  s_add_u32 s17, s17, s29
  s_add_u32 m0, s28, 19456
  s_nop 0
  buffer_load_dwordx4 v144, s[8:11], s17 offen lds
  s_add_u32 s17, s17, s29
  s_waitcnt vmcnt(4)
  ds_read_b64_tr_b16 a[176:177], v152 offset:12288
  ds_read_b64_tr_b16 a[178:179], v153 offset:12288
  ds_read_b64_tr_b16 a[180:181], v154 offset:12288
  ds_read_b64_tr_b16 a[182:183], v155 offset:12288
  ds_read_b64_tr_b16 a[184:185], v152 offset:12352
  ds_read_b64_tr_b16 a[186:187], v153 offset:12352
  ds_read_b64_tr_b16 a[188:189], v154 offset:12352
  ds_read_b64_tr_b16 a[190:191], v155 offset:12352
  s_waitcnt lgkmcnt(0)
  s_add_u32 m0, s28, 20480
  s_nop 0
  buffer_load_dwordx4 v144, s[8:11], s17 offen lds
  s_add_u32 s17, s17, s29
  s_add_u32 m0, s28, 21504
  s_nop 0
  buffer_load_dwordx4 v144, s[8:11], s17 offen lds
  s_add_u32 s17, s17, s29
  s_add_u32 m0, s28, 22528
  s_nop 0
  buffer_load_dwordx4 v144, s[8:11], s17 offen lds
  s_add_u32 s17, s17, s29
  s_add_u32 m0, s28, 23552
  s_nop 0
  buffer_load_dwordx4 v144, s[8:11], s17 offen lds
  s_add_u32 s17, s17, s29
  s_waitcnt vmcnt(4)
  ds_read_b64_tr_b16 a[192:193], v152 offset:16384
  ds_read_b64_tr_b16 a[194:195], v153 offset:16384
  ds_read_b64_tr_b16 a[196:197], v154 offset:16384
  ds_read_b64_tr_b16 a[198:199], v155 offset:16384
  ds_read_b64_tr_b16 a[200:201], v152 offset:16448
  ds_read_b64_tr_b16 a[202:203], v153 offset:16448
  ds_read_b64_tr_b16 a[204:205], v154 offset:16448
  ds_read_b64_tr_b16 a[206:207], v155 offset:16448
  s_waitcnt lgkmcnt(0)
  s_add_u32 m0, s28, 24576
  s_nop 0
  buffer_load_dwordx4 v144, s[8:11], s17 offen lds
  s_add_u32 s17, s17, s29
  s_add_u32 m0, s28, 25600
  s_nop 0
  buffer_load_dwordx4 v144, s[8:11], s17 offen lds
  s_add_u32 s17, s17, s29
  s_add_u32 m0, s28, 26624
  s_nop 0
  buffer_load_dwordx4 v144, s[8:11], s17 offen lds
  s_add_u32 s17, s17, s29
  s_add_u32 m0, s28, 27648
  s_nop 0
  buffer_load_dwordx4 v144, s[8:11], s17 offen lds
  s_add_u32 s17, s17, s29
  s_waitcnt vmcnt(4)
  ds_read_b64_tr_b16 a[208:209], v152 offset:20480
  ds_read_b64_tr_b16 a[210:211], v153 offset:20480
  ds_read_b64_tr_b16 a[212:213], v154 offset:20480
  ds_read_b64_tr_b16 a[214:215], v155 offset:20480
  ds_read_b64_tr_b16 a[216:217], v152 offset:20544
  ds_read_b64_tr_b16 a[218:219], v153 offset:20544
  ds_read_b64_tr_b16 a[220:221], v154 offset:20544
  ds_read_b64_tr_b16 a[222:223], v155 offset:20544
  s_waitcnt lgkmcnt(0)
  s_add_u32 m0, s28, 28672
  s_nop 0
  buffer_load_dwordx4 v144, s[8:11], s17 offen lds
  s_add_u32 s17, s17, s29
  s_add_u32 m0, s28, 29696
  s_nop 0
  buffer_load_dwordx4 v144, s[8:11], s17 offen lds
  s_add_u32 s17, s17, s29
  s_add_u32 m0, s28, 30720
  s_nop 0
  buffer_load_dwordx4 v144, s[8:11], s17 offen lds
  s_add_u32 s17, s17, s29
  s_add_u32 m0, s28, 31744
  s_nop 0
  buffer_load_dwordx4 v144, s[8:11], s17 offen lds
  s_add_u32 s17, s17, s29
  s_waitcnt vmcnt(4)
  ds_read_b64_tr_b16 a[224:225], v152 offset:24576
  ds_read_b64_tr_b16 a[226:227], v153 offset:24576
  ds_read_b64_tr_b16 a[228:229], v154 offset:24576
  ds_read_b64_tr_b16 a[230:231], v155 offset:24576
  ds_read_b64_tr_b16 a[232:233], v152 offset:24640
  ds_read_b64_tr_b16 a[234:235], v153 offset:24640
  ds_read_b64_tr_b16 a[236:237], v154 offset:24640
  ds_read_b64_tr_b16 a[238:239], v155 offset:24640
  s_waitcnt lgkmcnt(0)
  s_waitcnt vmcnt(0)
  ds_read_b64_tr_b16 a[240:241], v152 offset:28672
  ds_read_b64_tr_b16 a[242:243], v153 offset:28672
  ds_read_b64_tr_b16 a[244:245], v154 offset:28672
  ds_read_b64_tr_b16 a[246:247], v155 offset:28672
  ds_read_b64_tr_b16 a[248:249], v152 offset:28736
  ds_read_b64_tr_b16 a[250:251], v153 offset:28736
  ds_read_b64_tr_b16 a[252:253], v154 offset:28736
  ds_read_b64_tr_b16 a[254:255], v155 offset:28736
  s_waitcnt lgkmcnt(0)
  v_min_u32 v4, 27, v1
  v_mul_u32_u24 v5, 37, v4
  v_lshrrev_b32 v5, 8, v5
  v_mul_u32_u24 v5, 7, v5
  v_sub_u32 v5, v4, v5
  v_mov_b32 v6, 0x200
  v_cmp_ne_u32 vcc, 6, v5
  s_mul_i32 s76, s48, 3584
  s_add_u32 s76, s76, 148897792
  v_cndmask_b32 v5, 0, v6, vcc
  v_lshl_add_u32 v4, v4, 7, s76
  s_mov_b32 s71, 0
  s_branch M_vg_178
M_vw_177:
  s_sleep 2
  s_add_u32 s71, s71, 1
  s_cmp_gt_u32 s71, 262144
  s_cbranch_scc1 M_exit
M_vg_178:
  buffer_load_dword v6, v4, s[4:7], 0 offen sc1
  s_waitcnt vmcnt(0)
  v_cmp_lt_u32 vcc, v6, v5
  s_cbranch_vccnz M_vw_177
  s_barrier
  s_lshl_b32 s25, s16, 13
  s_add_u32 m0, s25, 0
  s_nop 0
  buffer_load_dwordx4 v16, s[12:15], s19 offen sc1 lds
  s_add_u32 m0, s25, 1024
  s_nop 0
  buffer_load_dwordx4 v17, s[12:15], s19 offen sc1 lds
  s_add_u32 m0, s25, 2048
  s_nop 0
  buffer_load_dwordx4 v18, s[12:15], s19 offen sc1 lds
  s_add_u32 m0, s25, 3072
  s_nop 0
  buffer_load_dwordx4 v19, s[12:15], s19 offen sc1 lds
  s_add_u32 m0, s25, 4096
  s_nop 0
  buffer_load_dwordx4 v20, s[12:15], s19 offen sc1 lds
  s_add_u32 m0, s25, 5120
  s_nop 0
  buffer_load_dwordx4 v21, s[12:15], s19 offen sc1 lds
  s_add_u32 m0, s25, 6144
  s_nop 0
  buffer_load_dwordx4 v22, s[12:15], s19 offen sc1 lds
  s_add_u32 m0, s25, 7168
  s_nop 0
  buffer_load_dwordx4 v23, s[12:15], s19 offen sc1 lds
  s_cmp_gt_u32 s23, 1
  s_cselect_b32 s26, s20, 0
  s_add_u32 s19, s19, s26
  s_add_u32 s25, s25, 32768
  s_and_b32 s25, s25, 0x1ffff
  s_waitcnt vmcnt(2)
  s_add_u32 m0, s25, 0
  s_nop 0
  buffer_load_dwordx4 v16, s[12:15], s19 offen sc1 lds
  s_add_u32 m0, s25, 1024
  s_nop 0
  buffer_load_dwordx4 v17, s[12:15], s19 offen sc1 lds
  s_add_u32 m0, s25, 2048
  s_nop 0
  buffer_load_dwordx4 v18, s[12:15], s19 offen sc1 lds
  s_add_u32 m0, s25, 3072
  s_nop 0
  buffer_load_dwordx4 v19, s[12:15], s19 offen sc1 lds
  s_add_u32 m0, s25, 4096
  s_nop 0
  buffer_load_dwordx4 v20, s[12:15], s19 offen sc1 lds
  s_add_u32 m0, s25, 5120
  s_nop 0
  buffer_load_dwordx4 v21, s[12:15], s19 offen sc1 lds
  s_add_u32 m0, s25, 6144
  s_nop 0
  buffer_load_dwordx4 v22, s[12:15], s19 offen sc1 lds
  s_add_u32 m0, s25, 7168
  s_nop 0
  buffer_load_dwordx4 v23, s[12:15], s19 offen sc1 lds
  s_cmp_gt_u32 s23, 2
  s_cselect_b32 s26, s20, 0
  s_add_u32 s19, s19, s26
  s_add_u32 s25, s25, 32768
  s_and_b32 s25, s25, 0x1ffff
  s_waitcnt vmcnt(0)
  s_barrier
  s_mov_b32 s27, s21
  v_mov_b32 v7, 0x40000000
  ds_read_b128 v[24:27], v8 offset:0
  ds_read_b128 v[28:31], v9 offset:0
  ds_read_b128 v[32:35], v10 offset:0
  ds_read_b128 v[36:39], v11 offset:0
  ds_read_b128 v[40:43], v12 offset:0
  ds_read_b128 v[44:47], v13 offset:0
.p2align 6
G_top_179:
  s_waitcnt lgkmcnt(5)
  v_mfma_f32_16x16x32_bf16 v[64:67], a[0:3], v[24:27], 0
  s_add_u32 m0, s25, 0
  ds_read_b128 v[48:51], v14 offset:0
  v_mfma_f32_16x16x32_bf16 v[68:71], a[4:7], v[24:27], 0
  v_mfma_f32_16x16x32_bf16 v[80:83], a[8:11], v[24:27], 0
  buffer_load_dwordx4 v16, s[12:15], s19 offen sc1 lds
  v_mfma_f32_16x16x32_bf16 v[84:87], a[12:15], v[24:27], 0
  s_waitcnt lgkmcnt(5)
  v_mfma_f32_16x16x32_bf16 v[72:75], a[0:3], v[28:31], 0
  ds_read_b128 v[52:55], v15 offset:0
  v_mfma_f32_16x16x32_bf16 v[76:79], a[4:7], v[28:31], 0
  v_cvt_pk_bf16_f32 v128, v96, v97
  v_cvt_pk_bf16_f32 v129, v98, v99
  v_mfma_f32_16x16x32_bf16 v[88:91], a[8:11], v[28:31], 0
  v_mfma_f32_16x16x32_bf16 v[92:95], a[12:15], v[28:31], 0
  s_waitcnt lgkmcnt(5)
  v_cvt_pk_bf16_f32 v130, v100, v101
  v_cvt_pk_bf16_f32 v131, v102, v103
  v_mfma_f32_16x16x32_bf16 v[64:67], a[16:19], v[32:35], v[64:67]
  s_add_u32 m0, s25, 1024
  ds_read_b128 v[24:27], v8 offset:8192
  v_mfma_f32_16x16x32_bf16 v[68:71], a[20:23], v[32:35], v[68:71]
  v_mfma_f32_16x16x32_bf16 v[80:83], a[24:27], v[32:35], v[80:83]
  buffer_load_dwordx4 v17, s[12:15], s19 offen sc1 lds
  v_mfma_f32_16x16x32_bf16 v[84:87], a[28:31], v[32:35], v[84:87]
  s_waitcnt lgkmcnt(5)
  v_mfma_f32_16x16x32_bf16 v[72:75], a[16:19], v[36:39], v[72:75]
  ds_read_b128 v[28:31], v9 offset:8192
  v_mfma_f32_16x16x32_bf16 v[76:79], a[20:23], v[36:39], v[76:79]
  v_mfma_f32_16x16x32_bf16 v[88:91], a[24:27], v[36:39], v[88:91]
  v_mfma_f32_16x16x32_bf16 v[92:95], a[28:31], v[36:39], v[92:95]
  s_waitcnt lgkmcnt(5)
  v_mfma_f32_16x16x32_bf16 v[64:67], a[32:35], v[40:43], v[64:67]
  s_add_u32 m0, s25, 2048
  ds_read_b128 v[32:35], v10 offset:8192
  v_mfma_f32_16x16x32_bf16 v[68:71], a[36:39], v[40:43], v[68:71]
  v_cvt_pk_bf16_f32 v132, v104, v105
  v_cvt_pk_bf16_f32 v133, v106, v107
  v_mfma_f32_16x16x32_bf16 v[80:83], a[40:43], v[40:43], v[80:83]
  buffer_load_dwordx4 v18, s[12:15], s19 offen sc1 lds
  v_mfma_f32_16x16x32_bf16 v[84:87], a[44:47], v[40:43], v[84:87]
  s_waitcnt lgkmcnt(5)
  v_cvt_pk_bf16_f32 v134, v108, v109
  v_cvt_pk_bf16_f32 v135, v110, v111
  v_mfma_f32_16x16x32_bf16 v[72:75], a[32:35], v[44:47], v[72:75]
  ds_read_b128 v[36:39], v11 offset:8192
  v_mfma_f32_16x16x32_bf16 v[76:79], a[36:39], v[44:47], v[76:79]
  v_mfma_f32_16x16x32_bf16 v[88:91], a[40:43], v[44:47], v[88:91]
  v_mfma_f32_16x16x32_bf16 v[92:95], a[44:47], v[44:47], v[92:95]
  s_waitcnt lgkmcnt(5)
  v_mfma_f32_16x16x32_bf16 v[64:67], a[48:51], v[48:51], v[64:67]
  s_add_u32 m0, s25, 3072
  ds_read_b128 v[40:43], v12 offset:8192
  v_mfma_f32_16x16x32_bf16 v[68:71], a[52:55], v[48:51], v[68:71]
  v_mfma_f32_16x16x32_bf16 v[80:83], a[56:59], v[48:51], v[80:83]
  buffer_load_dwordx4 v19, s[12:15], s19 offen sc1 lds
  v_mfma_f32_16x16x32_bf16 v[84:87], a[60:63], v[48:51], v[84:87]
  s_waitcnt lgkmcnt(5)
  v_mfma_f32_16x16x32_bf16 v[72:75], a[48:51], v[52:55], v[72:75]
  ds_read_b128 v[44:47], v13 offset:8192
  v_mfma_f32_16x16x32_bf16 v[76:79], a[52:55], v[52:55], v[76:79]
  v_cvt_pk_bf16_f32 v136, v112, v113
  v_cvt_pk_bf16_f32 v137, v114, v115
  v_mfma_f32_16x16x32_bf16 v[88:91], a[56:59], v[52:55], v[88:91]
  v_mfma_f32_16x16x32_bf16 v[92:95], a[60:63], v[52:55], v[92:95]
  s_waitcnt lgkmcnt(5)
  v_cvt_pk_bf16_f32 v138, v116, v117
  v_cvt_pk_bf16_f32 v139, v118, v119
  v_mfma_f32_16x16x32_bf16 v[64:67], a[64:67], v[24:27], v[64:67]
  s_add_u32 m0, s25, 4096
  ds_read_b128 v[48:51], v14 offset:8192
  v_mfma_f32_16x16x32_bf16 v[68:71], a[68:71], v[24:27], v[68:71]
  v_mfma_f32_16x16x32_bf16 v[80:83], a[72:75], v[24:27], v[80:83]
  buffer_load_dwordx4 v20, s[12:15], s19 offen sc1 lds
  v_mfma_f32_16x16x32_bf16 v[84:87], a[76:79], v[24:27], v[84:87]
  s_waitcnt lgkmcnt(5)
  v_mfma_f32_16x16x32_bf16 v[72:75], a[64:67], v[28:31], v[72:75]
  ds_read_b128 v[52:55], v15 offset:8192
  v_mfma_f32_16x16x32_bf16 v[76:79], a[68:71], v[28:31], v[76:79]
  v_mfma_f32_16x16x32_bf16 v[88:91], a[72:75], v[28:31], v[88:91]
  v_mfma_f32_16x16x32_bf16 v[92:95], a[76:79], v[28:31], v[92:95]
  s_waitcnt lgkmcnt(5)
  v_mfma_f32_16x16x32_bf16 v[64:67], a[80:83], v[32:35], v[64:67]
  s_add_u32 m0, s25, 5120
  ds_read_b128 v[24:27], v8 offset:16384
  v_mfma_f32_16x16x32_bf16 v[68:71], a[84:87], v[32:35], v[68:71]
  v_cvt_pk_bf16_f32 v140, v120, v121
  v_cvt_pk_bf16_f32 v141, v122, v123
  v_mfma_f32_16x16x32_bf16 v[80:83], a[88:91], v[32:35], v[80:83]
  buffer_load_dwordx4 v21, s[12:15], s19 offen sc1 lds
  v_mfma_f32_16x16x32_bf16 v[84:87], a[92:95], v[32:35], v[84:87]
  s_waitcnt lgkmcnt(5)
  v_cvt_pk_bf16_f32 v142, v124, v125
  v_cvt_pk_bf16_f32 v143, v126, v127
  v_mfma_f32_16x16x32_bf16 v[72:75], a[80:83], v[36:39], v[72:75]
  ds_read_b128 v[28:31], v9 offset:16384
  v_mfma_f32_16x16x32_bf16 v[76:79], a[84:87], v[36:39], v[76:79]
  v_mfma_f32_16x16x32_bf16 v[88:91], a[88:91], v[36:39], v[88:91]
  v_mfma_f32_16x16x32_bf16 v[92:95], a[92:95], v[36:39], v[92:95]
  s_waitcnt lgkmcnt(5)
  v_mfma_f32_16x16x32_bf16 v[64:67], a[96:99], v[40:43], v[64:67]
  s_add_u32 m0, s25, 6144
  ds_read_b128 v[32:35], v10 offset:16384
  v_mfma_f32_16x16x32_bf16 v[68:71], a[100:103], v[40:43], v[68:71]
  v_mfma_f32_16x16x32_bf16 v[80:83], a[104:107], v[40:43], v[80:83]
  buffer_load_dwordx4 v22, s[12:15], s19 offen sc1 lds
  v_mfma_f32_16x16x32_bf16 v[84:87], a[108:111], v[40:43], v[84:87]
  s_waitcnt lgkmcnt(5)
  v_mfma_f32_16x16x32_bf16 v[72:75], a[96:99], v[44:47], v[72:75]
  ds_read_b128 v[36:39], v11 offset:16384
  v_mfma_f32_16x16x32_bf16 v[76:79], a[100:103], v[44:47], v[76:79]
  v_mfma_f32_16x16x32_bf16 v[88:91], a[104:107], v[44:47], v[88:91]
  v_mfma_f32_16x16x32_bf16 v[92:95], a[108:111], v[44:47], v[92:95]
  s_waitcnt lgkmcnt(5)
  v_mfma_f32_16x16x32_bf16 v[64:67], a[112:115], v[48:51], v[64:67]
  s_add_u32 m0, s25, 7168
  ds_read_b128 v[40:43], v12 offset:16384
  v_mfma_f32_16x16x32_bf16 v[68:71], a[116:119], v[48:51], v[68:71]
  v_mfma_f32_16x16x32_bf16 v[80:83], a[120:123], v[48:51], v[80:83]
  buffer_load_dwordx4 v23, s[12:15], s19 offen sc1 lds
  v_mfma_f32_16x16x32_bf16 v[84:87], a[124:127], v[48:51], v[84:87]
  s_waitcnt lgkmcnt(5)
  v_mfma_f32_16x16x32_bf16 v[72:75], a[112:115], v[52:55], v[72:75]
  s_cmp_gt_u32 s23, 3
  ds_read_b128 v[44:47], v13 offset:16384
  v_mfma_f32_16x16x32_bf16 v[76:79], a[116:119], v[52:55], v[76:79]
  v_mfma_f32_16x16x32_bf16 v[88:91], a[120:123], v[52:55], v[88:91]
  s_cselect_b32 s26, s20, 0
  v_mfma_f32_16x16x32_bf16 v[92:95], a[124:127], v[52:55], v[92:95]
  s_waitcnt lgkmcnt(5)
  v_mfma_f32_16x16x32_bf16 v[64:67], a[128:131], v[24:27], v[64:67]
  s_add_u32 s19, s19, s26
  ds_read_b128 v[48:51], v14 offset:16384
  v_mfma_f32_16x16x32_bf16 v[68:71], a[132:135], v[24:27], v[68:71]
  v_mfma_f32_16x16x32_bf16 v[80:83], a[136:139], v[24:27], v[80:83]
  s_add_u32 s25, s25, 32768
  v_mfma_f32_16x16x32_bf16 v[84:87], a[140:143], v[24:27], v[84:87]
  s_waitcnt lgkmcnt(5)
  v_mfma_f32_16x16x32_bf16 v[72:75], a[128:131], v[28:31], v[72:75]
  s_and_b32 s25, s25, 0x1ffff
  ds_read_b128 v[52:55], v15 offset:16384
  v_mfma_f32_16x16x32_bf16 v[76:79], a[132:135], v[28:31], v[76:79]
  v_mfma_f32_16x16x32_bf16 v[88:91], a[136:139], v[28:31], v[88:91]
  buffer_store_dwordx4 v[128:131], v7, s[4:7], s21 offen offset:0 sc1
  v_mfma_f32_16x16x32_bf16 v[92:95], a[140:143], v[28:31], v[92:95]
  s_waitcnt lgkmcnt(5)
  v_mfma_f32_16x16x32_bf16 v[64:67], a[144:147], v[32:35], v[64:67]
  ds_read_b128 v[24:27], v8 offset:24576
  v_mfma_f32_16x16x32_bf16 v[68:71], a[148:151], v[32:35], v[68:71]
  v_mfma_f32_16x16x32_bf16 v[80:83], a[152:155], v[32:35], v[80:83]
  v_mfma_f32_16x16x32_bf16 v[84:87], a[156:159], v[32:35], v[84:87]
  s_waitcnt lgkmcnt(5)
  v_mfma_f32_16x16x32_bf16 v[72:75], a[144:147], v[36:39], v[72:75]
  ds_read_b128 v[28:31], v9 offset:24576
  v_mfma_f32_16x16x32_bf16 v[76:79], a[148:151], v[36:39], v[76:79]
  v_mfma_f32_16x16x32_bf16 v[88:91], a[152:155], v[36:39], v[88:91]
  buffer_store_dwordx4 v[132:135], v7, s[4:7], s21 offen offset:256 sc1
  v_mfma_f32_16x16x32_bf16 v[92:95], a[156:159], v[36:39], v[92:95]
  s_waitcnt lgkmcnt(5)
  v_mfma_f32_16x16x32_bf16 v[64:67], a[160:163], v[40:43], v[64:67]
  ds_read_b128 v[32:35], v10 offset:24576
  v_mfma_f32_16x16x32_bf16 v[68:71], a[164:167], v[40:43], v[68:71]
  v_mfma_f32_16x16x32_bf16 v[80:83], a[168:171], v[40:43], v[80:83]
  v_mfma_f32_16x16x32_bf16 v[84:87], a[172:175], v[40:43], v[84:87]
  s_waitcnt lgkmcnt(5)
  v_mfma_f32_16x16x32_bf16 v[72:75], a[160:163], v[44:47], v[72:75]
  ds_read_b128 v[36:39], v11 offset:24576
  v_mfma_f32_16x16x32_bf16 v[76:79], a[164:167], v[44:47], v[76:79]
  v_mfma_f32_16x16x32_bf16 v[88:91], a[168:171], v[44:47], v[88:91]
  buffer_store_dwordx4 v[136:139], v7, s[4:7], s21 offen offset:2048 sc1
  v_mfma_f32_16x16x32_bf16 v[92:95], a[172:175], v[44:47], v[92:95]
  s_waitcnt lgkmcnt(5)
  v_mfma_f32_16x16x32_bf16 v[64:67], a[176:179], v[48:51], v[64:67]
  ds_read_b128 v[40:43], v12 offset:24576
  v_mfma_f32_16x16x32_bf16 v[68:71], a[180:183], v[48:51], v[68:71]
  v_mfma_f32_16x16x32_bf16 v[80:83], a[184:187], v[48:51], v[80:83]
  v_mfma_f32_16x16x32_bf16 v[84:87], a[188:191], v[48:51], v[84:87]
  s_waitcnt lgkmcnt(5)
  v_mfma_f32_16x16x32_bf16 v[72:75], a[176:179], v[52:55], v[72:75]
  ds_read_b128 v[44:47], v13 offset:24576
  v_mfma_f32_16x16x32_bf16 v[76:79], a[180:183], v[52:55], v[76:79]
  v_mfma_f32_16x16x32_bf16 v[88:91], a[184:187], v[52:55], v[88:91]
  buffer_store_dwordx4 v[140:143], v7, s[4:7], s21 offen offset:2304 sc1
  v_mfma_f32_16x16x32_bf16 v[92:95], a[188:191], v[52:55], v[92:95]
  s_waitcnt lgkmcnt(5)
  v_mfma_f32_16x16x32_bf16 v[64:67], a[192:195], v[24:27], v[64:67]
  s_mov_b32 s21, s27
  ds_read_b128 v[48:51], v14 offset:24576
  v_mfma_f32_16x16x32_bf16 v[68:71], a[196:199], v[24:27], v[68:71]
  v_mov_b32 v7, v56
  v_mfma_f32_16x16x32_bf16 v[80:83], a[200:203], v[24:27], v[80:83]
  v_mfma_f32_16x16x32_bf16 v[84:87], a[204:207], v[24:27], v[84:87]
  s_waitcnt lgkmcnt(5)
  v_mfma_f32_16x16x32_bf16 v[72:75], a[192:195], v[28:31], v[72:75]
  s_add_u32 s27, s27, s22
  ds_read_b128 v[52:55], v15 offset:24576
  v_mfma_f32_16x16x32_bf16 v[76:79], a[196:199], v[28:31], v[76:79]
  v_mfma_f32_16x16x32_bf16 v[88:91], a[200:203], v[28:31], v[88:91]
  s_waitcnt vmcnt(16)
  s_barrier
  v_mfma_f32_16x16x32_bf16 v[92:95], a[204:207], v[28:31], v[92:95]
  s_waitcnt lgkmcnt(5)
  v_mfma_f32_16x16x32_bf16 v[64:67], a[208:211], v[32:35], v[64:67]
  ds_read_b128 v[24:27], v8 offset:32768
  v_mfma_f32_16x16x32_bf16 v[68:71], a[212:215], v[32:35], v[68:71]
  v_mfma_f32_16x16x32_bf16 v[80:83], a[216:219], v[32:35], v[80:83]
  v_mfma_f32_16x16x32_bf16 v[84:87], a[220:223], v[32:35], v[84:87]
  s_waitcnt lgkmcnt(5)
  v_mfma_f32_16x16x32_bf16 v[72:75], a[208:211], v[36:39], v[72:75]
  ds_read_b128 v[28:31], v9 offset:32768
  v_mfma_f32_16x16x32_bf16 v[76:79], a[212:215], v[36:39], v[76:79]
  v_mfma_f32_16x16x32_bf16 v[88:91], a[216:219], v[36:39], v[88:91]
  v_mfma_f32_16x16x32_bf16 v[92:95], a[220:223], v[36:39], v[92:95]
  s_waitcnt lgkmcnt(5)
  v_mfma_f32_16x16x32_bf16 v[64:67], a[224:227], v[40:43], v[64:67]
  ds_read_b128 v[32:35], v10 offset:32768
  v_mfma_f32_16x16x32_bf16 v[68:71], a[228:231], v[40:43], v[68:71]
  v_mfma_f32_16x16x32_bf16 v[80:83], a[232:235], v[40:43], v[80:83]
  v_mfma_f32_16x16x32_bf16 v[84:87], a[236:239], v[40:43], v[84:87]
  s_waitcnt lgkmcnt(5)
  v_mfma_f32_16x16x32_bf16 v[72:75], a[224:227], v[44:47], v[72:75]
  ds_read_b128 v[36:39], v11 offset:32768
  v_mfma_f32_16x16x32_bf16 v[76:79], a[228:231], v[44:47], v[76:79]
  v_mfma_f32_16x16x32_bf16 v[88:91], a[232:235], v[44:47], v[88:91]
  v_mfma_f32_16x16x32_bf16 v[92:95], a[236:239], v[44:47], v[92:95]
  s_waitcnt lgkmcnt(5)
  v_mfma_f32_16x16x32_bf16 v[64:67], a[240:243], v[48:51], v[64:67]
  s_sub_u32 s23, s23, 1
  ds_read_b128 v[40:43], v12 offset:32768
  v_mfma_f32_16x16x32_bf16 v[68:71], a[244:247], v[48:51], v[68:71]
  v_mfma_f32_16x16x32_bf16 v[80:83], a[248:251], v[48:51], v[80:83]
  v_mfma_f32_16x16x32_bf16 v[84:87], a[252:255], v[48:51], v[84:87]
  s_waitcnt lgkmcnt(5)
  v_mfma_f32_16x16x32_bf16 v[72:75], a[240:243], v[52:55], v[72:75]
  s_cmp_eq_u32 s23, 0
  ds_read_b128 v[44:47], v13 offset:32768
  v_mfma_f32_16x16x32_bf16 v[76:79], a[244:247], v[52:55], v[76:79]
  v_mfma_f32_16x16x32_bf16 v[88:91], a[248:251], v[52:55], v[88:91]
  v_mfma_f32_16x16x32_bf16 v[92:95], a[252:255], v[52:55], v[92:95]
  s_cbranch_scc1 G_done0_180
  s_waitcnt lgkmcnt(5)
  v_mfma_f32_16x16x32_bf16 v[96:99], a[0:3], v[24:27], 0
  s_add_u32 m0, s25, 0
  ds_read_b128 v[48:51], v14 offset:32768
  v_mfma_f32_16x16x32_bf16 v[100:103], a[4:7], v[24:27], 0
  v_mfma_f32_16x16x32_bf16 v[112:115], a[8:11], v[24:27], 0
  buffer_load_dwordx4 v16, s[12:15], s19 offen sc1 lds
  v_mfma_f32_16x16x32_bf16 v[116:119], a[12:15], v[24:27], 0
  s_waitcnt lgkmcnt(5)
  v_mfma_f32_16x16x32_bf16 v[104:107], a[0:3], v[28:31], 0
  ds_read_b128 v[52:55], v15 offset:32768
  v_mfma_f32_16x16x32_bf16 v[108:111], a[4:7], v[28:31], 0
  v_cvt_pk_bf16_f32 v128, v64, v65
  v_cvt_pk_bf16_f32 v129, v66, v67
  v_mfma_f32_16x16x32_bf16 v[120:123], a[8:11], v[28:31], 0
  v_mfma_f32_16x16x32_bf16 v[124:127], a[12:15], v[28:31], 0
  s_waitcnt lgkmcnt(5)
  v_cvt_pk_bf16_f32 v130, v68, v69
  v_cvt_pk_bf16_f32 v131, v70, v71
  v_mfma_f32_16x16x32_bf16 v[96:99], a[16:19], v[32:35], v[96:99]
  s_add_u32 m0, s25, 1024
  ds_read_b128 v[24:27], v8 offset:40960
  v_mfma_f32_16x16x32_bf16 v[100:103], a[20:23], v[32:35], v[100:103]
  v_mfma_f32_16x16x32_bf16 v[112:115], a[24:27], v[32:35], v[112:115]
  buffer_load_dwordx4 v17, s[12:15], s19 offen sc1 lds
  v_mfma_f32_16x16x32_bf16 v[116:119], a[28:31], v[32:35], v[116:119]
  s_waitcnt lgkmcnt(5)
  v_mfma_f32_16x16x32_bf16 v[104:107], a[16:19], v[36:39], v[104:107]
  ds_read_b128 v[28:31], v9 offset:40960
  v_mfma_f32_16x16x32_bf16 v[108:111], a[20:23], v[36:39], v[108:111]
  v_mfma_f32_16x16x32_bf16 v[120:123], a[24:27], v[36:39], v[120:123]
  v_mfma_f32_16x16x32_bf16 v[124:127], a[28:31], v[36:39], v[124:127]
  s_waitcnt lgkmcnt(5)
  v_mfma_f32_16x16x32_bf16 v[96:99], a[32:35], v[40:43], v[96:99]
  s_add_u32 m0, s25, 2048
  ds_read_b128 v[32:35], v10 offset:40960
  v_mfma_f32_16x16x32_bf16 v[100:103], a[36:39], v[40:43], v[100:103]
  v_cvt_pk_bf16_f32 v132, v72, v73
  v_cvt_pk_bf16_f32 v133, v74, v75
  v_mfma_f32_16x16x32_bf16 v[112:115], a[40:43], v[40:43], v[112:115]
  buffer_load_dwordx4 v18, s[12:15], s19 offen sc1 lds
  v_mfma_f32_16x16x32_bf16 v[116:119], a[44:47], v[40:43], v[116:119]
  s_waitcnt lgkmcnt(5)
  v_cvt_pk_bf16_f32 v134, v76, v77
  v_cvt_pk_bf16_f32 v135, v78, v79
  v_mfma_f32_16x16x32_bf16 v[104:107], a[32:35], v[44:47], v[104:107]
  ds_read_b128 v[36:39], v11 offset:40960
  v_mfma_f32_16x16x32_bf16 v[108:111], a[36:39], v[44:47], v[108:111]
  v_mfma_f32_16x16x32_bf16 v[120:123], a[40:43], v[44:47], v[120:123]
  v_mfma_f32_16x16x32_bf16 v[124:127], a[44:47], v[44:47], v[124:127]
  s_waitcnt lgkmcnt(5)
  v_mfma_f32_16x16x32_bf16 v[96:99], a[48:51], v[48:51], v[96:99]
  s_add_u32 m0, s25, 3072
  ds_read_b128 v[40:43], v12 offset:40960
  v_mfma_f32_16x16x32_bf16 v[100:103], a[52:55], v[48:51], v[100:103]
  v_mfma_f32_16x16x32_bf16 v[112:115], a[56:59], v[48:51], v[112:115]
  buffer_load_dwordx4 v19, s[12:15], s19 offen sc1 lds
  v_mfma_f32_16x16x32_bf16 v[116:119], a[60:63], v[48:51], v[116:119]
  s_waitcnt lgkmcnt(5)
  v_mfma_f32_16x16x32_bf16 v[104:107], a[48:51], v[52:55], v[104:107]
  ds_read_b128 v[44:47], v13 offset:40960
  v_mfma_f32_16x16x32_bf16 v[108:111], a[52:55], v[52:55], v[108:111]
  v_cvt_pk_bf16_f32 v136, v80, v81
  v_cvt_pk_bf16_f32 v137, v82, v83
  v_mfma_f32_16x16x32_bf16 v[120:123], a[56:59], v[52:55], v[120:123]
  v_mfma_f32_16x16x32_bf16 v[124:127], a[60:63], v[52:55], v[124:127]
  s_waitcnt lgkmcnt(5)
  v_cvt_pk_bf16_f32 v138, v84, v85
  v_cvt_pk_bf16_f32 v139, v86, v87
  v_mfma_f32_16x16x32_bf16 v[96:99], a[64:67], v[24:27], v[96:99]
  s_add_u32 m0, s25, 4096
  ds_read_b128 v[48:51], v14 offset:40960
  v_mfma_f32_16x16x32_bf16 v[100:103], a[68:71], v[24:27], v[100:103]
  v_mfma_f32_16x16x32_bf16 v[112:115], a[72:75], v[24:27], v[112:115]
  buffer_load_dwordx4 v20, s[12:15], s19 offen sc1 lds
  v_mfma_f32_16x16x32_bf16 v[116:119], a[76:79], v[24:27], v[116:119]
  s_waitcnt lgkmcnt(5)
  v_mfma_f32_16x16x32_bf16 v[104:107], a[64:67], v[28:31], v[104:107]
  ds_read_b128 v[52:55], v15 offset:40960
  v_mfma_f32_16x16x32_bf16 v[108:111], a[68:71], v[28:31], v[108:111]
  v_mfma_f32_16x16x32_bf16 v[120:123], a[72:75], v[28:31], v[120:123]
  v_mfma_f32_16x16x32_bf16 v[124:127], a[76:79], v[28:31], v[124:127]
  s_waitcnt lgkmcnt(5)
  v_mfma_f32_16x16x32_bf16 v[96:99], a[80:83], v[32:35], v[96:99]
  s_add_u32 m0, s25, 5120
  ds_read_b128 v[24:27], v8 offset:49152
  v_mfma_f32_16x16x32_bf16 v[100:103], a[84:87], v[32:35], v[100:103]
  v_cvt_pk_bf16_f32 v140, v88, v89
  v_cvt_pk_bf16_f32 v141, v90, v91
  v_mfma_f32_16x16x32_bf16 v[112:115], a[88:91], v[32:35], v[112:115]
  buffer_load_dwordx4 v21, s[12:15], s19 offen sc1 lds
  v_mfma_f32_16x16x32_bf16 v[116:119], a[92:95], v[32:35], v[116:119]
  s_waitcnt lgkmcnt(5)
  v_cvt_pk_bf16_f32 v142, v92, v93
  v_cvt_pk_bf16_f32 v143, v94, v95
  v_mfma_f32_16x16x32_bf16 v[104:107], a[80:83], v[36:39], v[104:107]
  ds_read_b128 v[28:31], v9 offset:49152
  v_mfma_f32_16x16x32_bf16 v[108:111], a[84:87], v[36:39], v[108:111]
  v_mfma_f32_16x16x32_bf16 v[120:123], a[88:91], v[36:39], v[120:123]
  v_mfma_f32_16x16x32_bf16 v[124:127], a[92:95], v[36:39], v[124:127]
  s_waitcnt lgkmcnt(5)
  v_mfma_f32_16x16x32_bf16 v[96:99], a[96:99], v[40:43], v[96:99]
  s_add_u32 m0, s25, 6144
  ds_read_b128 v[32:35], v10 offset:49152
  v_mfma_f32_16x16x32_bf16 v[100:103], a[100:103], v[40:43], v[100:103]
  v_mfma_f32_16x16x32_bf16 v[112:115], a[104:107], v[40:43], v[112:115]
  buffer_load_dwordx4 v22, s[12:15], s19 offen sc1 lds
  v_mfma_f32_16x16x32_bf16 v[116:119], a[108:111], v[40:43], v[116:119]
  s_waitcnt lgkmcnt(5)
  v_mfma_f32_16x16x32_bf16 v[104:107], a[96:99], v[44:47], v[104:107]
  ds_read_b128 v[36:39], v11 offset:49152
  v_mfma_f32_16x16x32_bf16 v[108:111], a[100:103], v[44:47], v[108:111]
  v_mfma_f32_16x16x32_bf16 v[120:123], a[104:107], v[44:47], v[120:123]
  v_mfma_f32_16x16x32_bf16 v[124:127], a[108:111], v[44:47], v[124:127]
  s_waitcnt lgkmcnt(5)
  v_mfma_f32_16x16x32_bf16 v[96:99], a[112:115], v[48:51], v[96:99]
  s_add_u32 m0, s25, 7168
  ds_read_b128 v[40:43], v12 offset:49152
  v_mfma_f32_16x16x32_bf16 v[100:103], a[116:119], v[48:51], v[100:103]
  v_mfma_f32_16x16x32_bf16 v[112:115], a[120:123], v[48:51], v[112:115]
  buffer_load_dwordx4 v23, s[12:15], s19 offen sc1 lds
  v_mfma_f32_16x16x32_bf16 v[116:119], a[124:127], v[48:51], v[116:119]
  s_waitcnt lgkmcnt(5)
  v_mfma_f32_16x16x32_bf16 v[104:107], a[112:115], v[52:55], v[104:107]
  s_cmp_gt_u32 s23, 3
  ds_read_b128 v[44:47], v13 offset:49152
  v_mfma_f32_16x16x32_bf16 v[108:111], a[116:119], v[52:55], v[108:111]
  v_mfma_f32_16x16x32_bf16 v[120:123], a[120:123], v[52:55], v[120:123]
  s_cselect_b32 s26, s20, 0
  v_mfma_f32_16x16x32_bf16 v[124:127], a[124:127], v[52:55], v[124:127]
  s_waitcnt lgkmcnt(5)
  v_mfma_f32_16x16x32_bf16 v[96:99], a[128:131], v[24:27], v[96:99]
  s_add_u32 s19, s19, s26
  ds_read_b128 v[48:51], v14 offset:49152
  v_mfma_f32_16x16x32_bf16 v[100:103], a[132:135], v[24:27], v[100:103]
  v_mfma_f32_16x16x32_bf16 v[112:115], a[136:139], v[24:27], v[112:115]
  s_add_u32 s25, s25, 32768
  v_mfma_f32_16x16x32_bf16 v[116:119], a[140:143], v[24:27], v[116:119]
  s_waitcnt lgkmcnt(5)
  v_mfma_f32_16x16x32_bf16 v[104:107], a[128:131], v[28:31], v[104:107]
  s_and_b32 s25, s25, 0x1ffff
  ds_read_b128 v[52:55], v15 offset:49152
  v_mfma_f32_16x16x32_bf16 v[108:111], a[132:135], v[28:31], v[108:111]
  v_mfma_f32_16x16x32_bf16 v[120:123], a[136:139], v[28:31], v[120:123]
  buffer_store_dwordx4 v[128:131], v7, s[4:7], s21 offen offset:0 sc1
  v_mfma_f32_16x16x32_bf16 v[124:127], a[140:143], v[28:31], v[124:127]
  s_waitcnt lgkmcnt(5)
  v_mfma_f32_16x16x32_bf16 v[96:99], a[144:147], v[32:35], v[96:99]
  ds_read_b128 v[24:27], v8 offset:57344
  v_mfma_f32_16x16x32_bf16 v[100:103], a[148:151], v[32:35], v[100:103]
  v_mfma_f32_16x16x32_bf16 v[112:115], a[152:155], v[32:35], v[112:115]
  v_mfma_f32_16x16x32_bf16 v[116:119], a[156:159], v[32:35], v[116:119]
  s_waitcnt lgkmcnt(5)
  v_xor_b32 v8, 0x10000, v8
  v_mfma_f32_16x16x32_bf16 v[104:107], a[144:147], v[36:39], v[104:107]
  ds_read_b128 v[28:31], v9 offset:57344
  v_mfma_f32_16x16x32_bf16 v[108:111], a[148:151], v[36:39], v[108:111]
  v_mfma_f32_16x16x32_bf16 v[120:123], a[152:155], v[36:39], v[120:123]
  buffer_store_dwordx4 v[132:135], v7, s[4:7], s21 offen offset:256 sc1
  v_mfma_f32_16x16x32_bf16 v[124:127], a[156:159], v[36:39], v[124:127]
  s_waitcnt lgkmcnt(5)
  v_xor_b32 v9, 0x10000, v9
  v_mfma_f32_16x16x32_bf16 v[96:99], a[160:163], v[40:43], v[96:99]
  ds_read_b128 v[32:35], v10 offset:57344
  v_mfma_f32_16x16x32_bf16 v[100:103], a[164:167], v[40:43], v[100:103]
  v_mfma_f32_16x16x32_bf16 v[112:115], a[168:171], v[40:43], v[112:115]
  v_mfma_f32_16x16x32_bf16 v[116:119], a[172:175], v[40:43], v[116:119]
  s_waitcnt lgkmcnt(5)
  v_xor_b32 v10, 0x10000, v10
  v_mfma_f32_16x16x32_bf16 v[104:107], a[160:163], v[44:47], v[104:107]
  ds_read_b128 v[36:39], v11 offset:57344
  v_mfma_f32_16x16x32_bf16 v[108:111], a[164:167], v[44:47], v[108:111]
  v_mfma_f32_16x16x32_bf16 v[120:123], a[168:171], v[44:47], v[120:123]
  buffer_store_dwordx4 v[136:139], v7, s[4:7], s21 offen offset:2048 sc1
  v_mfma_f32_16x16x32_bf16 v[124:127], a[172:175], v[44:47], v[124:127]
  s_waitcnt lgkmcnt(5)
  v_xor_b32 v11, 0x10000, v11
  v_mfma_f32_16x16x32_bf16 v[96:99], a[176:179], v[48:51], v[96:99]
  ds_read_b128 v[40:43], v12 offset:57344
  v_mfma_f32_16x16x32_bf16 v[100:103], a[180:183], v[48:51], v[100:103]
  v_mfma_f32_16x16x32_bf16 v[112:115], a[184:187], v[48:51], v[112:115]
  v_mfma_f32_16x16x32_bf16 v[116:119], a[188:191], v[48:51], v[116:119]
  s_waitcnt lgkmcnt(5)
  v_xor_b32 v12, 0x10000, v12
  v_mfma_f32_16x16x32_bf16 v[104:107], a[176:179], v[52:55], v[104:107]
  ds_read_b128 v[44:47], v13 offset:57344
  v_mfma_f32_16x16x32_bf16 v[108:111], a[180:183], v[52:55], v[108:111]
  v_mfma_f32_16x16x32_bf16 v[120:123], a[184:187], v[52:55], v[120:123]
  buffer_store_dwordx4 v[140:143], v7, s[4:7], s21 offen offset:2304 sc1
  v_mfma_f32_16x16x32_bf16 v[124:127], a[188:191], v[52:55], v[124:127]
  s_waitcnt lgkmcnt(5)
  v_xor_b32 v13, 0x10000, v13
  v_mfma_f32_16x16x32_bf16 v[96:99], a[192:195], v[24:27], v[96:99]
  s_mov_b32 s21, s27
  ds_read_b128 v[48:51], v14 offset:57344
  v_mfma_f32_16x16x32_bf16 v[100:103], a[196:199], v[24:27], v[100:103]
  v_mov_b32 v7, v56
  v_mfma_f32_16x16x32_bf16 v[112:115], a[200:203], v[24:27], v[112:115]
  v_mfma_f32_16x16x32_bf16 v[116:119], a[204:207], v[24:27], v[116:119]
  s_waitcnt lgkmcnt(5)
  v_xor_b32 v14, 0x10000, v14
  v_mfma_f32_16x16x32_bf16 v[104:107], a[192:195], v[28:31], v[104:107]
  s_add_u32 s27, s27, s22
  ds_read_b128 v[52:55], v15 offset:57344
  v_mfma_f32_16x16x32_bf16 v[108:111], a[196:199], v[28:31], v[108:111]
  v_mfma_f32_16x16x32_bf16 v[120:123], a[200:203], v[28:31], v[120:123]
  s_waitcnt vmcnt(16)
  s_barrier
  v_mfma_f32_16x16x32_bf16 v[124:127], a[204:207], v[28:31], v[124:127]
  s_waitcnt lgkmcnt(5)
  v_xor_b32 v15, 0x10000, v15
  v_mfma_f32_16x16x32_bf16 v[96:99], a[208:211], v[32:35], v[96:99]
  ds_read_b128 v[24:27], v8 offset:0
  v_mfma_f32_16x16x32_bf16 v[100:103], a[212:215], v[32:35], v[100:103]
  v_mfma_f32_16x16x32_bf16 v[112:115], a[216:219], v[32:35], v[112:115]
  v_mfma_f32_16x16x32_bf16 v[116:119], a[220:223], v[32:35], v[116:119]
  s_waitcnt lgkmcnt(5)
  v_mfma_f32_16x16x32_bf16 v[104:107], a[208:211], v[36:39], v[104:107]
  ds_read_b128 v[28:31], v9 offset:0
  v_mfma_f32_16x16x32_bf16 v[108:111], a[212:215], v[36:39], v[108:111]
  v_mfma_f32_16x16x32_bf16 v[120:123], a[216:219], v[36:39], v[120:123]
  v_mfma_f32_16x16x32_bf16 v[124:127], a[220:223], v[36:39], v[124:127]
  s_waitcnt lgkmcnt(5)
  v_mfma_f32_16x16x32_bf16 v[96:99], a[224:227], v[40:43], v[96:99]
  ds_read_b128 v[32:35], v10 offset:0
  v_mfma_f32_16x16x32_bf16 v[100:103], a[228:231], v[40:43], v[100:103]
  v_mfma_f32_16x16x32_bf16 v[112:115], a[232:235], v[40:43], v[112:115]
  v_mfma_f32_16x16x32_bf16 v[116:119], a[236:239], v[40:43], v[116:119]
  s_waitcnt lgkmcnt(5)
  v_mfma_f32_16x16x32_bf16 v[104:107], a[224:227], v[44:47], v[104:107]
  ds_read_b128 v[36:39], v11 offset:0
  v_mfma_f32_16x16x32_bf16 v[108:111], a[228:231], v[44:47], v[108:111]
  v_mfma_f32_16x16x32_bf16 v[120:123], a[232:235], v[44:47], v[120:123]
  v_mfma_f32_16x16x32_bf16 v[124:127], a[236:239], v[44:47], v[124:127]
  s_waitcnt lgkmcnt(5)
  v_mfma_f32_16x16x32_bf16 v[96:99], a[240:243], v[48:51], v[96:99]
  s_sub_u32 s23, s23, 1
  ds_read_b128 v[40:43], v12 offset:0
  v_mfma_f32_16x16x32_bf16 v[100:103], a[244:247], v[48:51], v[100:103]
  v_mfma_f32_16x16x32_bf16 v[112:115], a[248:251], v[48:51], v[112:115]
  v_mfma_f32_16x16x32_bf16 v[116:119], a[252:255], v[48:51], v[116:119]
  s_waitcnt lgkmcnt(5)
  v_mfma_f32_16x16x32_bf16 v[104:107], a[240:243], v[52:55], v[104:107]
  s_cmp_eq_u32 s23, 0
  ds_read_b128 v[44:47], v13 offset:0
  v_mfma_f32_16x16x32_bf16 v[108:111], a[244:247], v[52:55], v[108:111]
  v_mfma_f32_16x16x32_bf16 v[120:123], a[248:251], v[52:55], v[120:123]
  v_mfma_f32_16x16x32_bf16 v[124:127], a[252:255], v[52:55], v[124:127]
  s_cbranch_scc1 G_done1_181
  s_branch G_top_179
G_done0_180:
  s_nop 7
  s_nop 3
  v_cvt_pk_bf16_f32 v128, v64, v65
  v_cvt_pk_bf16_f32 v129, v66, v67
  v_cvt_pk_bf16_f32 v130, v68, v69
  v_cvt_pk_bf16_f32 v131, v70, v71
  buffer_store_dwordx4 v[128:131], v7, s[4:7], s21 offen offset:0 sc1
  v_cvt_pk_bf16_f32 v132, v72, v73
  v_cvt_pk_bf16_f32 v133, v74, v75
  v_cvt_pk_bf16_f32 v134, v76, v77
  v_cvt_pk_bf16_f32 v135, v78, v79
  buffer_store_dwordx4 v[132:135], v7, s[4:7], s21 offen offset:256 sc1
  v_cvt_pk_bf16_f32 v136, v80, v81
  v_cvt_pk_bf16_f32 v137, v82, v83
  v_cvt_pk_bf16_f32 v138, v84, v85
  v_cvt_pk_bf16_f32 v139, v86, v87
  buffer_store_dwordx4 v[136:139], v7, s[4:7], s21 offen offset:2048 sc1
  v_cvt_pk_bf16_f32 v140, v88, v89
  v_cvt_pk_bf16_f32 v141, v90, v91
  v_cvt_pk_bf16_f32 v142, v92, v93
  v_cvt_pk_bf16_f32 v143, v94, v95
  buffer_store_dwordx4 v[140:143], v7, s[4:7], s21 offen offset:2304 sc1
  s_branch G_fin_182
G_done1_181:
  s_nop 7
  s_nop 3
  v_cvt_pk_bf16_f32 v128, v96, v97
  v_cvt_pk_bf16_f32 v129, v98, v99
  v_cvt_pk_bf16_f32 v130, v100, v101
  v_cvt_pk_bf16_f32 v131, v102, v103
  buffer_store_dwordx4 v[128:131], v7, s[4:7], s21 offen offset:0 sc1
  v_cvt_pk_bf16_f32 v132, v104, v105
  v_cvt_pk_bf16_f32 v133, v106, v107
  v_cvt_pk_bf16_f32 v134, v108, v109
  v_cvt_pk_bf16_f32 v135, v110, v111
  buffer_store_dwordx4 v[132:135], v7, s[4:7], s21 offen offset:256 sc1
  v_cvt_pk_bf16_f32 v136, v112, v113
  v_cvt_pk_bf16_f32 v137, v114, v115
  v_cvt_pk_bf16_f32 v138, v116, v117
  v_cvt_pk_bf16_f32 v139, v118, v119
  buffer_store_dwordx4 v[136:139], v7, s[4:7], s21 offen offset:2048 sc1
  v_cvt_pk_bf16_f32 v140, v120, v121
  v_cvt_pk_bf16_f32 v141, v122, v123
  v_cvt_pk_bf16_f32 v142, v124, v125
  v_cvt_pk_bf16_f32 v143, v126, v127
  buffer_store_dwordx4 v[140:143], v7, s[4:7], s21 offen offset:2304 sc1
G_fin_182:
  s_waitcnt vmcnt(0) lgkmcnt(0)
  s_barrier
  s_waitcnt vmcnt(0)
  s_barrier
  s_mov_b32 s30, 768
  v_mov_b32 v144, s30
  v_min_u32 v145, 1, v0
  v_lshlrev_b32 v145, 30, v145
  buffer_store_dword v144, v145, s[4:7], s31 offen sc1
  s_mul_i32 s50, s64, 6
  s_add_u32 s50, s50, s65
  s_mul_i32 s76, s50, 21846
  s_lshr_b32 s76, s76, 16
  s_mul_i32 s77, s76, 3
  s_add_u32 s51, s50, 64
  s_cmp_eq_u32 s77, s50
  s_cselect_b32 s50, s76, s51
M_fin:
  s_lshr_b32 s48, s50, 2
  s_and_b32 s49, s50, 3
  s_load_dwordx2 s[8:9], s[0:1], 0
  s_load_dwordx2 s[12:13], s[0:1], 104
  s_load_dwordx2 s[32:33], s[0:1], 112
  v_and_b32 v4, 31, v1
  v_lshrrev_b32 v5, 5, v1
  v_lshlrev_b32 v5, 4, v5
  v_lshl_add_u32 v6, v4, 10, v5
  s_lshl_b32 s26, s16, 8
  s_lshl_b32 s27, s48, 15
  s_add_u32 s27, s27, s26
  s_waitcnt lgkmcnt(0)
  s_and_b32 s9, s9, 0xffff
  s_mov_b32 s10, 2097152
  s_mov_b32 s11, 0x20000
  s_and_b32 s13, s13, 0xffff
  s_mov_b32 s14, 1024
  s_mov_b32 s15, 0x20000
  s_and_b32 s33, s33, 0xffff
  s_mov_b32 s34, 2097152
  s_mov_b32 s35, 0x20000
  buffer_load_dwordx4 v[16:19], v6, s[8:11], s27 offen offset:0
  buffer_load_dwordx4 v[48:51], v5, s[12:15], s26 offen offset:0
  buffer_load_dwordx4 v[20:23], v6, s[8:11], s27 offen offset:32
  buffer_load_dwordx4 v[52:55], v5, s[12:15], s26 offen offset:32
  buffer_load_dwordx4 v[24:27], v6, s[8:11], s27 offen offset:64
  buffer_load_dwordx4 v[56:59], v5, s[12:15], s26 offen offset:64
  buffer_load_dwordx4 v[28:31], v6, s[8:11], s27 offen offset:96
  buffer_load_dwordx4 v[60:63], v5, s[12:15], s26 offen offset:96
  buffer_load_dwordx4 v[32:35], v6, s[8:11], s27 offen offset:128
  buffer_load_dwordx4 v[64:67], v5, s[12:15], s26 offen offset:128
  buffer_load_dwordx4 v[36:39], v6, s[8:11], s27 offen offset:160
  buffer_load_dwordx4 v[68:71], v5, s[12:15], s26 offen offset:160
  buffer_load_dwordx4 v[40:43], v6, s[8:11], s27 offen offset:192
  buffer_load_dwordx4 v[72:75], v5, s[12:15], s26 offen offset:192
  buffer_load_dwordx4 v[44:47], v6, s[8:11], s27 offen offset:224
  buffer_load_dwordx4 v[76:79], v5, s[12:15], s26 offen offset:224
  s_lshl_b32 s28, s48, 2
  s_add_u32 s28, s28, s49
  s_lshl_b32 s28, s28, 2
  s_add_u32 s28, s28, s16
  s_lshl_b32 s28, s28, 11
  s_waitcnt vmcnt(14)
  v_mfma_f32_32x32x16_bf16 v[80:95], v[48:51], v[16:19], 0
  s_waitcnt vmcnt(12)
  v_mfma_f32_32x32x16_bf16 v[80:95], v[52:55], v[20:23], v[80:95]
  s_waitcnt vmcnt(10)
  v_mfma_f32_32x32x16_bf16 v[80:95], v[56:59], v[24:27], v[80:95]
  s_waitcnt vmcnt(8)
  v_mfma_f32_32x32x16_bf16 v[80:95], v[60:63], v[28:31], v[80:95]
  s_waitcnt vmcnt(6)
  v_mfma_f32_32x32x16_bf16 v[80:95], v[64:67], v[32:35], v[80:95]
  s_waitcnt vmcnt(4)
  v_mfma_f32_32x32x16_bf16 v[80:95], v[68:71], v[36:39], v[80:95]
  s_waitcnt vmcnt(2)
  v_mfma_f32_32x32x16_bf16 v[80:95], v[72:75], v[40:43], v[80:95]
  s_waitcnt vmcnt(0)
  v_mfma_f32_32x32x16_bf16 v[80:95], v[76:79], v[44:47], v[80:95]
  s_mul_i32 s76, s48, 43
  s_lshr_b32 s76, s76, 9
  s_mul_i32 s76, s76, 12
  s_sub_u32 s76, s48, s76
  s_cmp_ge_u32 s76, 6
  s_addc_u32 s76, s76, 0
  s_and_b32 s77, s49, 2
  s_mul_i32 s77, s77, 7
  s_add_u32 s76, s76, s77
  v_mov_b32 v193, 0x300
  s_lshl_b32 s76, s76, 7
  s_add_u32 s76, s76, 148897792
  v_and_b32 v192, 7, v1
  v_mul_u32_u24 v192, 3584, v192
  v_add_u32 v192, s76, v192
  s_mov_b32 s71, 0
  s_branch M_vg_184
M_vw_183:
  s_sleep 2
  s_add_u32 s71, s71, 1
  s_cmp_gt_u32 s71, 262144
  s_cbranch_scc1 M_exit
M_vg_184:
  buffer_load_dword v194, v192, s[4:7], 0 offen sc1
  s_waitcnt vmcnt(0)
  v_cmp_lt_u32 vcc, v194, v193
  s_cbranch_vccnz M_vw_183
  s_add_u32 s29, s28, 150994944
  buffer_load_dwordx4 v[96:99], v2, s[4:7], s29 offen offset:0 sc1
  buffer_load_dwordx4 v[100:103], v2, s[4:7], s29 offen offset:1024 sc1
  s_add_u32 s29, s28, 153092096
  buffer_load_dwordx4 v[104:107], v2, s[4:7], s29 offen offset:0 sc1
  buffer_load_dwordx4 v[108:111], v2, s[4:7], s29 offen offset:1024 sc1
  s_add_u32 s29, s28, 155189248
  s_waitcnt vmcnt(2)
  buffer_load_dwordx4 v[112:115], v2, s[4:7], s29 offen offset:0 sc1
  buffer_load_dwordx4 v[116:119], v2, s[4:7], s29 offen offset:1024 sc1
  s_add_u32 s29, s28, 157286400
  s_waitcnt vmcnt(2)
  buffer_load_dwordx4 v[120:123], v2, s[4:7], s29 offen offset:0 sc1
  buffer_load_dwordx4 v[124:127], v2, s[4:7], s29 offen offset:1024 sc1
  s_add_u32 s29, s28, 159383552
  s_waitcnt vmcnt(2)
  buffer_load_dwordx4 v[128:131], v2, s[4:7], s29 offen offset:0 sc1
  buffer_load_dwordx4 v[132:135], v2, s[4:7], s29 offen offset:1024 sc1
  s_add_u32 s29, s28, 161480704
  s_waitcnt vmcnt(2)
  buffer_load_dwordx4 v[136:139], v2, s[4:7], s29 offen offset:0 sc1
  buffer_load_dwordx4 v[140:143], v2, s[4:7], s29 offen offset:1024 sc1
  s_add_u32 s29, s28, 163577856
  s_waitcnt vmcnt(2)
  buffer_load_dwordx4 v[144:147], v2, s[4:7], s29 offen offset:0 sc1
  buffer_load_dwordx4 v[148:151], v2, s[4:7], s29 offen offset:1024 sc1
  s_add_u32 s29, s28, 165675008
  s_waitcnt vmcnt(2)
  buffer_load_dwordx4 v[152:155], v2, s[4:7], s29 offen offset:0 sc1
  buffer_load_dwordx4 v[156:159], v2, s[4:7], s29 offen offset:1024 sc1
  v_lshlrev_b32 v7, 4, v4
  s_lshl_b32 s26, s16, 2
  v_add_u32 v4, s26, v7
  s_barrier
  ds_write_b32 v4, v80
  s_waitcnt lgkmcnt(0)
  s_barrier
  ds_read_b128 v[84:87], v7
  s_waitcnt lgkmcnt(0)
  v_add_f32 v80, v84, v85
  v_add_f32 v81, v86, v87
  v_add_f32 v80, v80, v81
  v_mul_f32 v80, 0xbfb8aa3b, v80
  v_exp_f32 v80, v80
  s_nop 0
  v_add_f32 v80, 1.0, v80
  v_rcp_f32 v80, v80
  s_nop 0
  v_sub_f32 v82, 1.0, v80
  s_waitcnt vmcnt(14)
  v_lshlrev_b32 v160, 16, v96
  v_and_b32 v161, 0xffff0000, v96
  v_lshlrev_b32 v162, 16, v97
  v_and_b32 v163, 0xffff0000, v97
  v_lshlrev_b32 v164, 16, v98
  v_and_b32 v165, 0xffff0000, v98
  v_lshlrev_b32 v166, 16, v99
  v_and_b32 v167, 0xffff0000, v99
  v_lshlrev_b32 v168, 16, v100
  v_and_b32 v169, 0xffff0000, v100
  v_lshlrev_b32 v170, 16, v101
  v_and_b32 v171, 0xffff0000, v101
  v_lshlrev_b32 v172, 16, v102
  v_and_b32 v173, 0xffff0000, v102
  v_lshlrev_b32 v174, 16, v103
  v_and_b32 v175, 0xffff0000, v103
  s_waitcnt vmcnt(12)
  v_lshlrev_b32 v8, 16, v104
  v_and_b32 v9, 0xffff0000, v104
  v_pk_add_f32 v[160:161], v[160:161], v[8:9]
  v_lshlrev_b32 v10, 16, v105
  v_and_b32 v11, 0xffff0000, v105
  v_pk_add_f32 v[162:163], v[162:163], v[10:11]
  v_lshlrev_b32 v12, 16, v106
  v_and_b32 v13, 0xffff0000, v106
  v_pk_add_f32 v[164:165], v[164:165], v[12:13]
  v_lshlrev_b32 v14, 16, v107
  v_and_b32 v15, 0xffff0000, v107
  v_pk_add_f32 v[166:167], v[166:167], v[14:15]
  v_lshlrev_b32 v8, 16, v108
  v_and_b32 v9, 0xffff0000, v108
  v_pk_add_f32 v[168:169], v[168:169], v[8:9]
  v_lshlrev_b32 v10, 16, v109
  v_and_b32 v11, 0xffff0000, v109
  v_pk_add_f32 v[170:171], v[170:171], v[10:11]
  v_lshlrev_b32 v12, 16, v110
  v_and_b32 v13, 0xffff0000, v110
  v_pk_add_f32 v[172:173], v[172:173], v[12:13]
  v_lshlrev_b32 v14, 16, v111
  v_and_b32 v15, 0xffff0000, v111
  v_pk_add_f32 v[174:175], v[174:175], v[14:15]
  s_waitcnt vmcnt(10)
  v_lshlrev_b32 v8, 16, v112
  v_and_b32 v9, 0xffff0000, v112
  v_pk_add_f32 v[160:161], v[160:161], v[8:9]
  v_lshlrev_b32 v10, 16, v113
  v_and_b32 v11, 0xffff0000, v113
  v_pk_add_f32 v[162:163], v[162:163], v[10:11]
  v_lshlrev_b32 v12, 16, v114
  v_and_b32 v13, 0xffff0000, v114
  v_pk_add_f32 v[164:165], v[164:165], v[12:13]
  v_lshlrev_b32 v14, 16, v115
  v_and_b32 v15, 0xffff0000, v115
  v_pk_add_f32 v[166:167], v[166:167], v[14:15]
  v_lshlrev_b32 v8, 16, v116
  v_and_b32 v9, 0xffff0000, v116
  v_pk_add_f32 v[168:169], v[168:169], v[8:9]
  v_lshlrev_b32 v10, 16, v117
  v_and_b32 v11, 0xffff0000, v117
  v_pk_add_f32 v[170:171], v[170:171], v[10:11]
  v_lshlrev_b32 v12, 16, v118
  v_and_b32 v13, 0xffff0000, v118
  v_pk_add_f32 v[172:173], v[172:173], v[12:13]
  v_lshlrev_b32 v14, 16, v119
  v_and_b32 v15, 0xffff0000, v119
  v_pk_add_f32 v[174:175], v[174:175], v[14:15]
  s_waitcnt vmcnt(8)
  v_lshlrev_b32 v8, 16, v120
  v_and_b32 v9, 0xffff0000, v120
  v_pk_add_f32 v[160:161], v[160:161], v[8:9]
  v_lshlrev_b32 v10, 16, v121
  v_and_b32 v11, 0xffff0000, v121
  v_pk_add_f32 v[162:163], v[162:163], v[10:11]
  v_lshlrev_b32 v12, 16, v122
  v_and_b32 v13, 0xffff0000, v122
  v_pk_add_f32 v[164:165], v[164:165], v[12:13]
  v_lshlrev_b32 v14, 16, v123
  v_and_b32 v15, 0xffff0000, v123
  v_pk_add_f32 v[166:167], v[166:167], v[14:15]
  v_lshlrev_b32 v8, 16, v124
  v_and_b32 v9, 0xffff0000, v124
  v_pk_add_f32 v[168:169], v[168:169], v[8:9]
  v_lshlrev_b32 v10, 16, v125
  v_and_b32 v11, 0xffff0000, v125
  v_pk_add_f32 v[170:171], v[170:171], v[10:11]
  v_lshlrev_b32 v12, 16, v126
  v_and_b32 v13, 0xffff0000, v126
  v_pk_add_f32 v[172:173], v[172:173], v[12:13]
  v_lshlrev_b32 v14, 16, v127
  v_and_b32 v15, 0xffff0000, v127
  v_pk_add_f32 v[174:175], v[174:175], v[14:15]
  s_waitcnt vmcnt(6)
  v_lshlrev_b32 v8, 16, v128
  v_and_b32 v9, 0xffff0000, v128
  v_pk_add_f32 v[160:161], v[160:161], v[8:9]
  v_lshlrev_b32 v10, 16, v129
  v_and_b32 v11, 0xffff0000, v129
  v_pk_add_f32 v[162:163], v[162:163], v[10:11]
  v_lshlrev_b32 v12, 16, v130
  v_and_b32 v13, 0xffff0000, v130
  v_pk_add_f32 v[164:165], v[164:165], v[12:13]
  v_lshlrev_b32 v14, 16, v131
  v_and_b32 v15, 0xffff0000, v131
  v_pk_add_f32 v[166:167], v[166:167], v[14:15]
  v_lshlrev_b32 v8, 16, v132
  v_and_b32 v9, 0xffff0000, v132
  v_pk_add_f32 v[168:169], v[168:169], v[8:9]
  v_lshlrev_b32 v10, 16, v133
  v_and_b32 v11, 0xffff0000, v133
  v_pk_add_f32 v[170:171], v[170:171], v[10:11]
  v_lshlrev_b32 v12, 16, v134
  v_and_b32 v13, 0xffff0000, v134
  v_pk_add_f32 v[172:173], v[172:173], v[12:13]
  v_lshlrev_b32 v14, 16, v135
  v_and_b32 v15, 0xffff0000, v135
  v_pk_add_f32 v[174:175], v[174:175], v[14:15]
  s_waitcnt vmcnt(4)
  v_lshlrev_b32 v8, 16, v136
  v_and_b32 v9, 0xffff0000, v136
  v_pk_add_f32 v[160:161], v[160:161], v[8:9]
  v_lshlrev_b32 v10, 16, v137
  v_and_b32 v11, 0xffff0000, v137
  v_pk_add_f32 v[162:163], v[162:163], v[10:11]
  v_lshlrev_b32 v12, 16, v138
  v_and_b32 v13, 0xffff0000, v138
  v_pk_add_f32 v[164:165], v[164:165], v[12:13]
  v_lshlrev_b32 v14, 16, v139
  v_and_b32 v15, 0xffff0000, v139
  v_pk_add_f32 v[166:167], v[166:167], v[14:15]
  v_lshlrev_b32 v8, 16, v140
  v_and_b32 v9, 0xffff0000, v140
  v_pk_add_f32 v[168:169], v[168:169], v[8:9]
  v_lshlrev_b32 v10, 16, v141
  v_and_b32 v11, 0xffff0000, v141
  v_pk_add_f32 v[170:171], v[170:171], v[10:11]
  v_lshlrev_b32 v12, 16, v142
  v_and_b32 v13, 0xffff0000, v142
  v_pk_add_f32 v[172:173], v[172:173], v[12:13]
  v_lshlrev_b32 v14, 16, v143
  v_and_b32 v15, 0xffff0000, v143
  v_pk_add_f32 v[174:175], v[174:175], v[14:15]
  s_waitcnt vmcnt(2)
  v_lshlrev_b32 v8, 16, v144
  v_and_b32 v9, 0xffff0000, v144
  v_pk_add_f32 v[160:161], v[160:161], v[8:9]
  v_lshlrev_b32 v10, 16, v145
  v_and_b32 v11, 0xffff0000, v145
  v_pk_add_f32 v[162:163], v[162:163], v[10:11]
  v_lshlrev_b32 v12, 16, v146
  v_and_b32 v13, 0xffff0000, v146
  v_pk_add_f32 v[164:165], v[164:165], v[12:13]
  v_lshlrev_b32 v14, 16, v147
  v_and_b32 v15, 0xffff0000, v147
  v_pk_add_f32 v[166:167], v[166:167], v[14:15]
  v_lshlrev_b32 v8, 16, v148
  v_and_b32 v9, 0xffff0000, v148
  v_pk_add_f32 v[168:169], v[168:169], v[8:9]
  v_lshlrev_b32 v10, 16, v149
  v_and_b32 v11, 0xffff0000, v149
  v_pk_add_f32 v[170:171], v[170:171], v[10:11]
  v_lshlrev_b32 v12, 16, v150
  v_and_b32 v13, 0xffff0000, v150
  v_pk_add_f32 v[172:173], v[172:173], v[12:13]
  v_lshlrev_b32 v14, 16, v151
  v_and_b32 v15, 0xffff0000, v151
  v_pk_add_f32 v[174:175], v[174:175], v[14:15]
  s_waitcnt vmcnt(0)
  v_lshlrev_b32 v8, 16, v152
  v_and_b32 v9, 0xffff0000, v152
  v_pk_add_f32 v[160:161], v[160:161], v[8:9]
  v_lshlrev_b32 v10, 16, v153
  v_and_b32 v11, 0xffff0000, v153
  v_pk_add_f32 v[162:163], v[162:163], v[10:11]
  v_lshlrev_b32 v12, 16, v154
  v_and_b32 v13, 0xffff0000, v154
  v_pk_add_f32 v[164:165], v[164:165], v[12:13]
  v_lshlrev_b32 v14, 16, v155
  v_and_b32 v15, 0xffff0000, v155
  v_pk_add_f32 v[166:167], v[166:167], v[14:15]
  v_lshlrev_b32 v8, 16, v156
  v_and_b32 v9, 0xffff0000, v156
  v_pk_add_f32 v[168:169], v[168:169], v[8:9]
  v_lshlrev_b32 v10, 16, v157
  v_and_b32 v11, 0xffff0000, v157
  v_pk_add_f32 v[170:171], v[170:171], v[10:11]
  v_lshlrev_b32 v12, 16, v158
  v_and_b32 v13, 0xffff0000, v158
  v_pk_add_f32 v[172:173], v[172:173], v[12:13]
  v_lshlrev_b32 v14, 16, v159
  v_and_b32 v15, 0xffff0000, v159
  v_pk_add_f32 v[174:175], v[174:175], v[14:15]
  s_and_b32 s76, s48, 1
  s_lshl_b32 s76, s76, 1
  s_lshr_b32 s77, s49, 1
  s_add_u32 s76, s76, s77
  s_mul_i32 s76, s76, 7
  s_add_u32 s76, s76, 6
  s_lshr_b32 s77, s48, 1
  s_add_u32 s77, s77, 0x201
  v_mov_b32 v193, s77
  s_lshl_b32 s76, s76, 7
  s_add_u32 s76, s76, 148897792
  v_and_b32 v192, 7, v1
  v_mul_u32_u24 v192, 3584, v192
  v_add_u32 v192, s76, v192
  s_mov_b32 s71, 0
  s_branch M_vg_186
M_vw_185:
  s_sleep 2
  s_add_u32 s71, s71, 1
  s_cmp_gt_u32 s71, 262144
  s_cbranch_scc1 M_exit
M_vg_186:
  buffer_load_dword v194, v192, s[4:7], 0 offen sc1
  s_waitcnt vmcnt(0)
  v_cmp_lt_u32 vcc, v194, v193
  s_cbranch_vccnz M_vw_185
  s_cmp_ge_u32 s48, 58
  s_cbranch_scc1 Z_fast_187
  s_add_u32 s29, s28, 167772160
  buffer_load_dwordx4 v[96:99], v2, s[4:7], s29 offen offset:0 sc1
  buffer_load_dwordx4 v[100:103], v2, s[4:7], s29 offen offset:1024 sc1
  s_add_u32 s29, s28, 169869312
  buffer_load_dwordx4 v[104:107], v2, s[4:7], s29 offen offset:0 sc1
  buffer_load_dwordx4 v[108:111], v2, s[4:7], s29 offen offset:1024 sc1
  s_add_u32 s29, s28, 171966464
  s_waitcnt vmcnt(2)
  buffer_load_dwordx4 v[112:115], v2, s[4:7], s29 offen offset:0 sc1
  buffer_load_dwordx4 v[116:119], v2, s[4:7], s29 offen offset:1024 sc1
  s_add_u32 s29, s28, 174063616
  s_waitcnt vmcnt(2)
  buffer_load_dwordx4 v[120:123], v2, s[4:7], s29 offen offset:0 sc1
  buffer_load_dwordx4 v[124:127], v2, s[4:7], s29 offen offset:1024 sc1
  s_add_u32 s29, s28, 176160768
  s_waitcnt vmcnt(2)
  buffer_load_dwordx4 v[128:131], v2, s[4:7], s29 offen offset:0 sc1
  buffer_load_dwordx4 v[132:135], v2, s[4:7], s29 offen offset:1024 sc1
  s_add_u32 s29, s28, 178257920
  s_waitcnt vmcnt(2)
  buffer_load_dwordx4 v[136:139], v2, s[4:7], s29 offen offset:0 sc1
  buffer_load_dwordx4 v[140:143], v2, s[4:7], s29 offen offset:1024 sc1
  s_add_u32 s29, s28, 180355072
  s_waitcnt vmcnt(2)
  buffer_load_dwordx4 v[144:147], v2, s[4:7], s29 offen offset:0 sc1
  buffer_load_dwordx4 v[148:151], v2, s[4:7], s29 offen offset:1024 sc1
  s_add_u32 s29, s28, 182452224
  s_waitcnt vmcnt(2)
  buffer_load_dwordx4 v[152:155], v2, s[4:7], s29 offen offset:0 sc1
  buffer_load_dwordx4 v[156:159], v2, s[4:7], s29 offen offset:1024 sc1
  s_branch Z_join_188
Z_fast_187:
  s_add_u32 s29, s28, 167772160
  buffer_load_dwordx4 v[96:99], v2, s[4:7], s29 offen offset:0 sc1
  buffer_load_dwordx4 v[100:103], v2, s[4:7], s29 offen offset:1024 sc1
  s_add_u32 s29, s28, 169869312
  buffer_load_dwordx4 v[104:107], v2, s[4:7], s29 offen offset:0 sc1
  buffer_load_dwordx4 v[108:111], v2, s[4:7], s29 offen offset:1024 sc1
  s_add_u32 s29, s28, 171966464
  buffer_load_dwordx4 v[112:115], v2, s[4:7], s29 offen offset:0 sc1
  buffer_load_dwordx4 v[116:119], v2, s[4:7], s29 offen offset:1024 sc1
  s_add_u32 s29, s28, 174063616
  buffer_load_dwordx4 v[120:123], v2, s[4:7], s29 offen offset:0 sc1
  buffer_load_dwordx4 v[124:127], v2, s[4:7], s29 offen offset:1024 sc1
  s_add_u32 s29, s28, 176160768
  buffer_load_dwordx4 v[128:131], v2, s[4:7], s29 offen offset:0 sc1
  buffer_load_dwordx4 v[132:135], v2, s[4:7], s29 offen offset:1024 sc1
  s_add_u32 s29, s28, 178257920
  buffer_load_dwordx4 v[136:139], v2, s[4:7], s29 offen offset:0 sc1
  buffer_load_dwordx4 v[140:143], v2, s[4:7], s29 offen offset:1024 sc1
  s_add_u32 s29, s28, 180355072
  buffer_load_dwordx4 v[144:147], v2, s[4:7], s29 offen offset:0 sc1
  buffer_load_dwordx4 v[148:151], v2, s[4:7], s29 offen offset:1024 sc1
  s_add_u32 s29, s28, 182452224
  buffer_load_dwordx4 v[152:155], v2, s[4:7], s29 offen offset:0 sc1
  buffer_load_dwordx4 v[156:159], v2, s[4:7], s29 offen offset:1024 sc1
Z_join_188:
  v_pk_mul_f32 v[160:161], v[160:161], v[80:81] op_sel_hi:[1,0]
  v_pk_mul_f32 v[162:163], v[162:163], v[80:81] op_sel_hi:[1,0]
  v_pk_mul_f32 v[164:165], v[164:165], v[80:81] op_sel_hi:[1,0]
  v_pk_mul_f32 v[166:167], v[166:167], v[80:81] op_sel_hi:[1,0]
  v_pk_mul_f32 v[168:169], v[168:169], v[80:81] op_sel_hi:[1,0]
  v_pk_mul_f32 v[170:171], v[170:171], v[80:81] op_sel_hi:[1,0]
  v_pk_mul_f32 v[172:173], v[172:173], v[80:81] op_sel_hi:[1,0]
  v_pk_mul_f32 v[174:175], v[174:175], v[80:81] op_sel_hi:[1,0]
  s_waitcnt vmcnt(14)
  v_lshlrev_b32 v176, 16, v96
  v_and_b32 v177, 0xffff0000, v96
  v_lshlrev_b32 v178, 16, v97
  v_and_b32 v179, 0xffff0000, v97
  v_lshlrev_b32 v180, 16, v98
  v_and_b32 v181, 0xffff0000, v98
  v_lshlrev_b32 v182, 16, v99
  v_and_b32 v183, 0xffff0000, v99
  v_lshlrev_b32 v184, 16, v100
  v_and_b32 v185, 0xffff0000, v100
  v_lshlrev_b32 v186, 16, v101
  v_and_b32 v187, 0xffff0000, v101
  v_lshlrev_b32 v188, 16, v102
  v_and_b32 v189, 0xffff0000, v102
  v_lshlrev_b32 v190, 16, v103
  v_and_b32 v191, 0xffff0000, v103
  s_waitcnt vmcnt(12)
  v_lshlrev_b32 v8, 16, v104
  v_and_b32 v9, 0xffff0000, v104
  v_pk_add_f32 v[176:177], v[176:177], v[8:9]
  v_lshlrev_b32 v10, 16, v105
  v_and_b32 v11, 0xffff0000, v105
  v_pk_add_f32 v[178:179], v[178:179], v[10:11]
  v_lshlrev_b32 v12, 16, v106
  v_and_b32 v13, 0xffff0000, v106
  v_pk_add_f32 v[180:181], v[180:181], v[12:13]
  v_lshlrev_b32 v14, 16, v107
  v_and_b32 v15, 0xffff0000, v107
  v_pk_add_f32 v[182:183], v[182:183], v[14:15]
  v_lshlrev_b32 v8, 16, v108
  v_and_b32 v9, 0xffff0000, v108
  v_pk_add_f32 v[184:185], v[184:185], v[8:9]
  v_lshlrev_b32 v10, 16, v109
  v_and_b32 v11, 0xffff0000, v109
  v_pk_add_f32 v[186:187], v[186:187], v[10:11]
  v_lshlrev_b32 v12, 16, v110
  v_and_b32 v13, 0xffff0000, v110
  v_pk_add_f32 v[188:189], v[188:189], v[12:13]
  v_lshlrev_b32 v14, 16, v111
  v_and_b32 v15, 0xffff0000, v111
  v_pk_add_f32 v[190:191], v[190:191], v[14:15]
  s_waitcnt vmcnt(10)
  v_lshlrev_b32 v8, 16, v112
  v_and_b32 v9, 0xffff0000, v112
  v_pk_add_f32 v[176:177], v[176:177], v[8:9]
  v_lshlrev_b32 v10, 16, v113
  v_and_b32 v11, 0xffff0000, v113
  v_pk_add_f32 v[178:179], v[178:179], v[10:11]
  v_lshlrev_b32 v12, 16, v114
  v_and_b32 v13, 0xffff0000, v114
  v_pk_add_f32 v[180:181], v[180:181], v[12:13]
  v_lshlrev_b32 v14, 16, v115
  v_and_b32 v15, 0xffff0000, v115
  v_pk_add_f32 v[182:183], v[182:183], v[14:15]
  v_lshlrev_b32 v8, 16, v116
  v_and_b32 v9, 0xffff0000, v116
  v_pk_add_f32 v[184:185], v[184:185], v[8:9]
  v_lshlrev_b32 v10, 16, v117
  v_and_b32 v11, 0xffff0000, v117
  v_pk_add_f32 v[186:187], v[186:187], v[10:11]
  v_lshlrev_b32 v12, 16, v118
  v_and_b32 v13, 0xffff0000, v118
  v_pk_add_f32 v[188:189], v[188:189], v[12:13]
  v_lshlrev_b32 v14, 16, v119
  v_and_b32 v15, 0xffff0000, v119
  v_pk_add_f32 v[190:191], v[190:191], v[14:15]
  s_waitcnt vmcnt(8)
  v_lshlrev_b32 v8, 16, v120
  v_and_b32 v9, 0xffff0000, v120
  v_pk_add_f32 v[176:177], v[176:177], v[8:9]
  v_lshlrev_b32 v10, 16, v121
  v_and_b32 v11, 0xffff0000, v121
  v_pk_add_f32 v[178:179], v[178:179], v[10:11]
  v_lshlrev_b32 v12, 16, v122
  v_and_b32 v13, 0xffff0000, v122
  v_pk_add_f32 v[180:181], v[180:181], v[12:13]
  v_lshlrev_b32 v14, 16, v123
  v_and_b32 v15, 0xffff0000, v123
  v_pk_add_f32 v[182:183], v[182:183], v[14:15]
  v_lshlrev_b32 v8, 16, v124
  v_and_b32 v9, 0xffff0000, v124
  v_pk_add_f32 v[184:185], v[184:185], v[8:9]
  v_lshlrev_b32 v10, 16, v125
  v_and_b32 v11, 0xffff0000, v125
  v_pk_add_f32 v[186:187], v[186:187], v[10:11]
  v_lshlrev_b32 v12, 16, v126
  v_and_b32 v13, 0xffff0000, v126
  v_pk_add_f32 v[188:189], v[188:189], v[12:13]
  v_lshlrev_b32 v14, 16, v127
  v_and_b32 v15, 0xffff0000, v127
  v_pk_add_f32 v[190:191], v[190:191], v[14:15]
  s_waitcnt vmcnt(6)
  v_lshlrev_b32 v8, 16, v128
  v_and_b32 v9, 0xffff0000, v128
  v_pk_add_f32 v[176:177], v[176:177], v[8:9]
  v_lshlrev_b32 v10, 16, v129
  v_and_b32 v11, 0xffff0000, v129
  v_pk_add_f32 v[178:179], v[178:179], v[10:11]
  v_lshlrev_b32 v12, 16, v130
  v_and_b32 v13, 0xffff0000, v130
  v_pk_add_f32 v[180:181], v[180:181], v[12:13]
  v_lshlrev_b32 v14, 16, v131
  v_and_b32 v15, 0xffff0000, v131
  v_pk_add_f32 v[182:183], v[182:183], v[14:15]
  v_lshlrev_b32 v8, 16, v132
  v_and_b32 v9, 0xffff0000, v132
  v_pk_add_f32 v[184:185], v[184:185], v[8:9]
  v_lshlrev_b32 v10, 16, v133
  v_and_b32 v11, 0xffff0000, v133
  v_pk_add_f32 v[186:187], v[186:187], v[10:11]
  v_lshlrev_b32 v12, 16, v134
  v_and_b32 v13, 0xffff0000, v134
  v_pk_add_f32 v[188:189], v[188:189], v[12:13]
  v_lshlrev_b32 v14, 16, v135
  v_and_b32 v15, 0xffff0000, v135
  v_pk_add_f32 v[190:191], v[190:191], v[14:15]
  s_waitcnt vmcnt(4)
  v_lshlrev_b32 v8, 16, v136
  v_and_b32 v9, 0xffff0000, v136
  v_pk_add_f32 v[176:177], v[176:177], v[8:9]
  v_lshlrev_b32 v10, 16, v137
  v_and_b32 v11, 0xffff0000, v137
  v_pk_add_f32 v[178:179], v[178:179], v[10:11]
  v_lshlrev_b32 v12, 16, v138
  v_and_b32 v13, 0xffff0000, v138
  v_pk_add_f32 v[180:181], v[180:181], v[12:13]
  v_lshlrev_b32 v14, 16, v139
  v_and_b32 v15, 0xffff0000, v139
  v_pk_add_f32 v[182:183], v[182:183], v[14:15]
  v_lshlrev_b32 v8, 16, v140
  v_and_b32 v9, 0xffff0000, v140
  v_pk_add_f32 v[184:185], v[184:185], v[8:9]
  v_lshlrev_b32 v10, 16, v141
  v_and_b32 v11, 0xffff0000, v141
  v_pk_add_f32 v[186:187], v[186:187], v[10:11]
  v_lshlrev_b32 v12, 16, v142
  v_and_b32 v13, 0xffff0000, v142
  v_pk_add_f32 v[188:189], v[188:189], v[12:13]
  v_lshlrev_b32 v14, 16, v143
  v_and_b32 v15, 0xffff0000, v143
  v_pk_add_f32 v[190:191], v[190:191], v[14:15]
  s_waitcnt vmcnt(2)
  v_lshlrev_b32 v8, 16, v144
  v_and_b32 v9, 0xffff0000, v144
  v_pk_add_f32 v[176:177], v[176:177], v[8:9]
  v_lshlrev_b32 v10, 16, v145
  v_and_b32 v11, 0xffff0000, v145
  v_pk_add_f32 v[178:179], v[178:179], v[10:11]
  v_lshlrev_b32 v12, 16, v146
  v_and_b32 v13, 0xffff0000, v146
  v_pk_add_f32 v[180:181], v[180:181], v[12:13]
  v_lshlrev_b32 v14, 16, v147
  v_and_b32 v15, 0xffff0000, v147
  v_pk_add_f32 v[182:183], v[182:183], v[14:15]
  v_lshlrev_b32 v8, 16, v148
  v_and_b32 v9, 0xffff0000, v148
  v_pk_add_f32 v[184:185], v[184:185], v[8:9]
  v_lshlrev_b32 v10, 16, v149
  v_and_b32 v11, 0xffff0000, v149
  v_pk_add_f32 v[186:187], v[186:187], v[10:11]
  v_lshlrev_b32 v12, 16, v150
  v_and_b32 v13, 0xffff0000, v150
  v_pk_add_f32 v[188:189], v[188:189], v[12:13]
  v_lshlrev_b32 v14, 16, v151
  v_and_b32 v15, 0xffff0000, v151
  v_pk_add_f32 v[190:191], v[190:191], v[14:15]
  s_waitcnt vmcnt(0)
  v_lshlrev_b32 v8, 16, v152
  v_and_b32 v9, 0xffff0000, v152
  v_pk_add_f32 v[176:177], v[176:177], v[8:9]
  v_lshlrev_b32 v10, 16, v153
  v_and_b32 v11, 0xffff0000, v153
  v_pk_add_f32 v[178:179], v[178:179], v[10:11]
  v_lshlrev_b32 v12, 16, v154
  v_and_b32 v13, 0xffff0000, v154
  v_pk_add_f32 v[180:181], v[180:181], v[12:13]
  v_lshlrev_b32 v14, 16, v155
  v_and_b32 v15, 0xffff0000, v155
  v_pk_add_f32 v[182:183], v[182:183], v[14:15]
  v_lshlrev_b32 v8, 16, v156
  v_and_b32 v9, 0xffff0000, v156
  v_pk_add_f32 v[184:185], v[184:185], v[8:9]
  v_lshlrev_b32 v10, 16, v157
  v_and_b32 v11, 0xffff0000, v157
  v_pk_add_f32 v[186:187], v[186:187], v[10:11]
  v_lshlrev_b32 v12, 16, v158
  v_and_b32 v13, 0xffff0000, v158
  v_pk_add_f32 v[188:189], v[188:189], v[12:13]
  v_lshlrev_b32 v14, 16, v159
  v_and_b32 v15, 0xffff0000, v159
  v_pk_add_f32 v[190:191], v[190:191], v[14:15]
  v_pk_fma_f32 v[160:161], v[176:177], v[82:83], v[160:161] op_sel_hi:[1,0,1]
  v_cvt_pk_bf16_f32 v16, v160, v161
  v_pk_fma_f32 v[162:163], v[178:179], v[82:83], v[162:163] op_sel_hi:[1,0,1]
  v_cvt_pk_bf16_f32 v17, v162, v163
  v_pk_fma_f32 v[164:165], v[180:181], v[82:83], v[164:165] op_sel_hi:[1,0,1]
  v_cvt_pk_bf16_f32 v18, v164, v165
  v_pk_fma_f32 v[166:167], v[182:183], v[82:83], v[166:167] op_sel_hi:[1,0,1]
  v_cvt_pk_bf16_f32 v19, v166, v167
  v_pk_fma_f32 v[168:169], v[184:185], v[82:83], v[168:169] op_sel_hi:[1,0,1]
  v_cvt_pk_bf16_f32 v20, v168, v169
  v_pk_fma_f32 v[170:171], v[186:187], v[82:83], v[170:171] op_sel_hi:[1,0,1]
  v_cvt_pk_bf16_f32 v21, v170, v171
  v_pk_fma_f32 v[172:173], v[188:189], v[82:83], v[172:173] op_sel_hi:[1,0,1]
  v_cvt_pk_bf16_f32 v22, v172, v173
  v_pk_fma_f32 v[174:175], v[190:191], v[82:83], v[174:175] op_sel_hi:[1,0,1]
  v_cvt_pk_bf16_f32 v23, v174, v175
  s_lshl_b32 s26, s49, 2
  s_add_u32 s26, s26, s16
  s_lshl_b32 s26, s26, 6
  s_lshl_b32 s27, s48, 15
  s_add_u32 s26, s26, s27
  buffer_store_dwordx4 v[16:19], v6, s[32:35], s26 offen offset:0
  buffer_store_dwordx4 v[20:23], v6, s[32:35], s26 offen offset:32
  s_cmp_lt_u32 s50, 64
  s_mov_b32 s50, s51
  s_cbranch_scc1 M_fin
  s_branch M_done
M_follow:
  s_lshr_b32 s48, s64, 2
  s_and_b32 s49, s64, 1
  s_bfe_u32 s50, s64, 0x10001
  s_mov_b32 s51, 2
  s_mov_b32 s23, 32
  s_load_dwordx2 s[8:9], s[0:1], 88
  s_lshl_b32 s17, s48, 19
  s_lshl_b32 s26, s49, 2
  s_add_u32 s26, s26, s16
  s_lshl_b32 s27, s26, 7
  s_add_u32 s17, s17, s27
  s_mov_b32 s18, 1024
  s_lshl_b32 s21, s48, 6
  s_add_u32 s21, s21, s50
  s_lshl_b32 s21, s21, 3
  s_add_u32 s21, s21, s26
  s_lshl_b32 s21, s21, 12
  s_add_u32 s21, s21, 167772160
  s_lshl_b32 s22, s51, 15
  s_mov_b32 s24, 1.0
  s_waitcnt lgkmcnt(0)
  s_and_b32 s9, s9, 0xffff
  s_mov_b32 s10, 4194304
  s_mov_b32 s11, 0x20000
  v_lshrrev_b32 v144, 4, v1
  v_and_b32 v56, 0xff, v2
  v_lshl_add_u32 v56, v144, 9, v56
  s_mul_i32 s26, s16, 0
  v_add_u32 v8, 0, v56
  v_add_u32 v16, 0, v2
  v_add_u32 v16, s26, v16
  v_add_u32 v9, 256, v56
  v_add_u32 v17, 1024, v2
  v_add_u32 v17, s26, v17
  v_add_u32 v10, 2048, v56
  v_add_u32 v18, 2048, v2
  v_add_u32 v18, s26, v18
  v_add_u32 v11, 2304, v56
  v_add_u32 v19, 3072, v2
  v_add_u32 v19, s26, v19
  v_add_u32 v12, 4096, v56
  v_add_u32 v20, 4096, v2
  v_add_u32 v20, s26, v20
  v_add_u32 v13, 4352, v56
  v_add_u32 v21, 5120, v2
  v_add_u32 v21, s26, v21
  v_add_u32 v14, 6144, v56
  v_add_u32 v22, 6144, v2
  v_add_u32 v22, s26, v22
  v_add_u32 v15, 6400, v56
  v_add_u32 v23, 7168, v2
  v_add_u32 v23, s26, v23
  v_mov_b32 v20, v56
  v_lshrrev_b32 v144, 3, v1
  v_mul_lo_u32 v144, v144, s18
  v_and_b32 v145, 7, v1
  v_lshl_add_u32 v144, v145, 4, v144
  s_lshl_b32 s28, s16, 15
  s_add_u32 s28, s28, 32768
  s_lshl_b32 s29, s18, 3
  s_add_u32 m0, s28, 0
  s_nop 0
  buffer_load_dwordx4 v144, s[8:11], s17 offen lds
  s_add_u32 s17, s17, s29
  s_add_u32 m0, s28, 1024
  s_nop 0
  buffer_load_dwordx4 v144, s[8:11], s17 offen lds
  s_add_u32 s17, s17, s29
  s_add_u32 m0, s28, 2048
  s_nop 0
  buffer_load_dwordx4 v144, s[8:11], s17 offen lds
  s_add_u32 s17, s17, s29
  s_add_u32 m0, s28, 3072
  s_nop 0
  buffer_load_dwordx4 v144, s[8:11], s17 offen lds
  s_add_u32 s17, s17, s29
  s_add_u32 m0, s28, 4096
  s_nop 0
  buffer_load_dwordx4 v144, s[8:11], s17 offen lds
  s_add_u32 s17, s17, s29
  s_add_u32 m0, s28, 5120
  s_nop 0
  buffer_load_dwordx4 v144, s[8:11], s17 offen lds
  s_add_u32 s17, s17, s29
  s_add_u32 m0, s28, 6144
  s_nop 0
  buffer_load_dwordx4 v144, s[8:11], s17 offen lds
  s_add_u32 s17, s17, s29
  s_add_u32 m0, s28, 7168
  s_nop 0
  buffer_load_dwordx4 v144, s[8:11], s17 offen lds
  s_add_u32 s17, s17, s29
  s_add_u32 m0, s28, 8192
  s_nop 0
  buffer_load_dwordx4 v144, s[8:11], s17 offen lds
  s_add_u32 s17, s17, s29
  s_add_u32 m0, s28, 9216
  s_nop 0
  buffer_load_dwordx4 v144, s[8:11], s17 offen lds
  s_add_u32 s17, s17, s29
  s_add_u32 m0, s28, 10240
  s_nop 0
  buffer_load_dwordx4 v144, s[8:11], s17 offen lds
  s_add_u32 s17, s17, s29
  s_add_u32 m0, s28, 11264
  s_nop 0
  buffer_load_dwordx4 v144, s[8:11], s17 offen lds
  s_add_u32 s17, s17, s29
  s_add_u32 m0, s28, 12288
  s_nop 0
  buffer_load_dwordx4 v144, s[8:11], s17 offen lds
  s_add_u32 s17, s17, s29
  s_add_u32 m0, s28, 13312
  s_nop 0
  buffer_load_dwordx4 v144, s[8:11], s17 offen lds
  s_add_u32 s17, s17, s29
  s_add_u32 m0, s28, 14336
  s_nop 0
  buffer_load_dwordx4 v144, s[8:11], s17 offen lds
  s_add_u32 s17, s17, s29
  s_add_u32 m0, s28, 15360
  s_nop 0
  buffer_load_dwordx4 v144, s[8:11], s17 offen lds
  s_add_u32 s17, s17, s29
  s_add_u32 m0, s28, 16384
  s_nop 0
  buffer_load_dwordx4 v144, s[8:11], s17 offen lds
  s_add_u32 s17, s17, s29
  s_add_u32 m0, s28, 17408
  s_nop 0
  buffer_load_dwordx4 v144, s[8:11], s17 offen lds
  s_add_u32 s17, s17, s29
  s_add_u32 m0, s28, 18432
  s_nop 0
  buffer_load_dwordx4 v144, s[8:11], s17 offen lds
  s_add_u32 s17, s17, s29
  s_add_u32 m0, s28, 19456
  s_nop 0
  buffer_load_dwordx4 v144, s[8:11], s17 offen lds
  s_add_u32 s17, s17, s29
  s_add_u32 m0, s28, 20480
  s_nop 0
  buffer_load_dwordx4 v144, s[8:11], s17 offen lds
  s_add_u32 s17, s17, s29
  s_add_u32 m0, s28, 21504
  s_nop 0
  buffer_load_dwordx4 v144, s[8:11], s17 offen lds
  s_add_u32 s17, s17, s29
  s_add_u32 m0, s28, 22528
  s_nop 0
  buffer_load_dwordx4 v144, s[8:11], s17 offen lds
  s_add_u32 s17, s17, s29
  s_add_u32 m0, s28, 23552
  s_nop 0
  buffer_load_dwordx4 v144, s[8:11], s17 offen lds
  s_add_u32 s17, s17, s29
  s_add_u32 m0, s28, 24576
  s_nop 0
  buffer_load_dwordx4 v144, s[8:11], s17 offen lds
  s_add_u32 s17, s17, s29
  s_add_u32 m0, s28, 25600
  s_nop 0
  buffer_load_dwordx4 v144, s[8:11], s17 offen lds
  s_add_u32 s17, s17, s29
  s_add_u32 m0, s28, 26624
  s_nop 0
  buffer_load_dwordx4 v144, s[8:11], s17 offen lds
  s_add_u32 s17, s17, s29
  s_add_u32 m0, s28, 27648
  s_nop 0
  buffer_load_dwordx4 v144, s[8:11], s17 offen lds
  s_add_u32 s17, s17, s29
  s_add_u32 m0, s28, 28672
  s_nop 0
  buffer_load_dwordx4 v144, s[8:11], s17 offen lds
  s_add_u32 s17, s17, s29
  s_add_u32 m0, s28, 29696
  s_nop 0
  buffer_load_dwordx4 v144, s[8:11], s17 offen lds
  s_add_u32 s17, s17, s29
  s_add_u32 m0, s28, 30720
  s_nop 0
  buffer_load_dwordx4 v144, s[8:11], s17 offen lds
  s_add_u32 s17, s17, s29
  s_add_u32 m0, s28, 31744
  s_nop 0
  buffer_load_dwordx4 v144, s[8:11], s17 offen lds
  s_add_u32 s17, s17, s29
  v_bfe_u32 v148, v1, 2, 2
  v_lshrrev_b32 v149, 5, v1
  v_lshl_add_u32 v148, v149, 4, v148
  v_bfe_u32 v149, v1, 4, 1
  v_lshl_add_u32 v148, v149, 2, v148
  v_and_b32 v149, 3, v1
  v_lshlrev_b32 v149, 4, v149
  s_mov_b32 s26, 8
  v_lshl_add_u32 v148, v148, 7, v149
  v_add_u32 v152, s28, v148
  v_add_u32 v153, 1024, v152
  v_add_u32 v154, s26, v152
  v_add_u32 v155, s26, v153
  s_waitcnt vmcnt(28)
  ds_read_b64_tr_b16 a[0:1], v152 offset:0
  ds_read_b64_tr_b16 a[2:3], v153 offset:0
  ds_read_b64_tr_b16 a[4:5], v154 offset:0
  ds_read_b64_tr_b16 a[6:7], v155 offset:0
  ds_read_b64_tr_b16 a[8:9], v152 offset:64
  ds_read_b64_tr_b16 a[10:11], v153 offset:64
  ds_read_b64_tr_b16 a[12:13], v154 offset:64
  ds_read_b64_tr_b16 a[14:15], v155 offset:64
  s_waitcnt lgkmcnt(0)
  s_add_u32 m0, s28, 0
  s_nop 0
  buffer_load_dwordx4 v144, s[8:11], s17 offen lds
  s_add_u32 s17, s17, s29
  s_add_u32 m0, s28, 1024
  s_nop 0
  buffer_load_dwordx4 v144, s[8:11], s17 offen lds
  s_add_u32 s17, s17, s29
  s_add_u32 m0, s28, 2048
  s_nop 0
  buffer_load_dwordx4 v144, s[8:11], s17 offen lds
  s_add_u32 s17, s17, s29
  s_add_u32 m0, s28, 3072
  s_nop 0
  buffer_load_dwordx4 v144, s[8:11], s17 offen lds
  s_add_u32 s17, s17, s29
  s_waitcnt vmcnt(28)
  ds_read_b64_tr_b16 a[16:17], v152 offset:4096
  ds_read_b64_tr_b16 a[18:19], v153 offset:4096
  ds_read_b64_tr_b16 a[20:21], v154 offset:4096
  ds_read_b64_tr_b16 a[22:23], v155 offset:4096
  ds_read_b64_tr_b16 a[24:25], v152 offset:4160
  ds_read_b64_tr_b16 a[26:27], v153 offset:4160
  ds_read_b64_tr_b16 a[28:29], v154 offset:4160
  ds_read_b64_tr_b16 a[30:31], v155 offset:4160
  s_waitcnt lgkmcnt(0)
  s_add_u32 m0, s28, 4096
  s_nop 0
  buffer_load_dwordx4 v144, s[8:11], s17 offen lds
  s_add_u32 s17, s17, s29
  s_add_u32 m0, s28, 5120
  s_nop 0
  buffer_load_dwordx4 v144, s[8:11], s17 offen lds
  s_add_u32 s17, s17, s29
  s_add_u32 m0, s28, 6144
  s_nop 0
  buffer_load_dwordx4 v144, s[8:11], s17 offen lds
  s_add_u32 s17, s17, s29
  s_add_u32 m0, s28, 7168
  s_nop 0
  buffer_load_dwordx4 v144, s[8:11], s17 offen lds
  s_add_u32 s17, s17, s29
  s_waitcnt vmcnt(28)
  ds_read_b64_tr_b16 a[32:33], v152 offset:8192
  ds_read_b64_tr_b16 a[34:35], v153 offset:8192
  ds_read_b64_tr_b16 a[36:37], v154 offset:8192
  ds_read_b64_tr_b16 a[38:39], v155 offset:8192
  ds_read_b64_tr_b16 a[40:41], v152 offset:8256
  ds_read_b64_tr_b16 a[42:43], v153 offset:8256
  ds_read_b64_tr_b16 a[44:45], v154 offset:8256
  ds_read_b64_tr_b16 a[46:47], v155 offset:8256
  s_waitcnt lgkmcnt(0)
  s_add_u32 m0, s28, 8192
  s_nop 0
  buffer_load_dwordx4 v144, s[8:11], s17 offen lds
  s_add_u32 s17, s17, s29
  s_add_u32 m0, s28, 9216
  s_nop 0
  buffer_load_dwordx4 v144, s[8:11], s17 offen lds
  s_add_u32 s17, s17, s29
  s_add_u32 m0, s28, 10240
  s_nop 0
  buffer_load_dwordx4 v144, s[8:11], s17 offen lds
  s_add_u32 s17, s17, s29
  s_add_u32 m0, s28, 11264
  s_nop 0
  buffer_load_dwordx4 v144, s[8:11], s17 offen lds
  s_add_u32 s17, s17, s29
  s_waitcnt vmcnt(28)
  ds_read_b64_tr_b16 a[48:49], v152 offset:12288
  ds_read_b64_tr_b16 a[50:51], v153 offset:12288
  ds_read_b64_tr_b16 a[52:53], v154 offset:12288
  ds_read_b64_tr_b16 a[54:55], v155 offset:12288
  ds_read_b64_tr_b16 a[56:57], v152 offset:12352
  ds_read_b64_tr_b16 a[58:59], v153 offset:12352
  ds_read_b64_tr_b16 a[60:61], v154 offset:12352
  ds_read_b64_tr_b16 a[62:63], v155 offset:12352
  s_waitcnt lgkmcnt(0)
  s_add_u32 m0, s28, 12288
  s_nop 0
  buffer_load_dwordx4 v144, s[8:11], s17 offen lds
  s_add_u32 s17, s17, s29
  s_add_u32 m0, s28, 13312
  s_nop 0
  buffer_load_dwordx4 v144, s[8:11], s17 offen lds
  s_add_u32 s17, s17, s29
  s_add_u32 m0, s28, 14336
  s_nop 0
  buffer_load_dwordx4 v144, s[8:11], s17 offen lds
  s_add_u32 s17, s17, s29
  s_add_u32 m0, s28, 15360
  s_nop 0
  buffer_load_dwordx4 v144, s[8:11], s17 offen lds
  s_add_u32 s17, s17, s29
  s_waitcnt vmcnt(28)
  ds_read_b64_tr_b16 a[64:65], v152 offset:16384
  ds_read_b64_tr_b16 a[66:67], v153 offset:16384
  ds_read_b64_tr_b16 a[68:69], v154 offset:16384
  ds_read_b64_tr_b16 a[70:71], v155 offset:16384
  ds_read_b64_tr_b16 a[72:73], v152 offset:16448
  ds_read_b64_tr_b16 a[74:75], v153 offset:16448
  ds_read_b64_tr_b16 a[76:77], v154 offset:16448
  ds_read_b64_tr_b16 a[78:79], v155 offset:16448
  s_waitcnt lgkmcnt(0)
  s_add_u32 m0, s28, 16384
  s_nop 0
  buffer_load_dwordx4 v144, s[8:11], s17 offen lds
  s_add_u32 s17, s17, s29
  s_add_u32 m0, s28, 17408
  s_nop 0
  buffer_load_dwordx4 v144, s[8:11], s17 offen lds
  s_add_u32 s17, s17, s29
  s_add_u32 m0, s28, 18432
  s_nop 0
  buffer_load_dwordx4 v144, s[8:11], s17 offen lds
  s_add_u32 s17, s17, s29
  s_add_u32 m0, s28, 19456
  s_nop 0
  buffer_load_dwordx4 v144, s[8:11], s17 offen lds
  s_add_u32 s17, s17, s29
  s_waitcnt vmcnt(28)
  ds_read_b64_tr_b16 a[80:81], v152 offset:20480
  ds_read_b64_tr_b16 a[82:83], v153 offset:20480
  ds_read_b64_tr_b16 a[84:85], v154 offset:20480
  ds_read_b64_tr_b16 a[86:87], v155 offset:20480
  ds_read_b64_tr_b16 a[88:89], v152 offset:20544
  ds_read_b64_tr_b16 a[90:91], v153 offset:20544
  ds_read_b64_tr_b16 a[92:93], v154 offset:20544
  ds_read_b64_tr_b16 a[94:95], v155 offset:20544
  s_waitcnt lgkmcnt(0)
  s_add_u32 m0, s28, 20480
  s_nop 0
  buffer_load_dwordx4 v144, s[8:11], s17 offen lds
  s_add_u32 s17, s17, s29
  s_add_u32 m0, s28, 21504
  s_nop 0
  buffer_load_dwordx4 v144, s[8:11], s17 offen lds
  s_add_u32 s17, s17, s29
  s_add_u32 m0, s28, 22528
  s_nop 0
  buffer_load_dwordx4 v144, s[8:11], s17 offen lds
  s_add_u32 s17, s17, s29
  s_add_u32 m0, s28, 23552
  s_nop 0
  buffer_load_dwordx4 v144, s[8:11], s17 offen lds
  s_add_u32 s17, s17, s29
  s_waitcnt vmcnt(28)
  ds_read_b64_tr_b16 a[96:97], v152 offset:24576
  ds_read_b64_tr_b16 a[98:99], v153 offset:24576
  ds_read_b64_tr_b16 a[100:101], v154 offset:24576
  ds_read_b64_tr_b16 a[102:103], v155 offset:24576
  ds_read_b64_tr_b16 a[104:105], v152 offset:24640
  ds_read_b64_tr_b16 a[106:107], v153 offset:24640
  ds_read_b64_tr_b16 a[108:109], v154 offset:24640
  ds_read_b64_tr_b16 a[110:111], v155 offset:24640
  s_waitcnt lgkmcnt(0)
  s_add_u32 m0, s28, 24576
  s_nop 0
  buffer_load_dwordx4 v144, s[8:11], s17 offen lds
  s_add_u32 s17, s17, s29
  s_add_u32 m0, s28, 25600
  s_nop 0
  buffer_load_dwordx4 v144, s[8:11], s17 offen lds
  s_add_u32 s17, s17, s29
  s_add_u32 m0, s28, 26624
  s_nop 0
  buffer_load_dwordx4 v144, s[8:11], s17 offen lds
  s_add_u32 s17, s17, s29
  s_add_u32 m0, s28, 27648
  s_nop 0
  buffer_load_dwordx4 v144, s[8:11], s17 offen lds
  s_add_u32 s17, s17, s29
  s_waitcnt vmcnt(28)
  ds_read_b64_tr_b16 a[112:113], v152 offset:28672
  ds_read_b64_tr_b16 a[114:115], v153 offset:28672
  ds_read_b64_tr_b16 a[116:117], v154 offset:28672
  ds_read_b64_tr_b16 a[118:119], v155 offset:28672
  ds_read_b64_tr_b16 a[120:121], v152 offset:28736
  ds_read_b64_tr_b16 a[122:123], v153 offset:28736
  ds_read_b64_tr_b16 a[124:125], v154 offset:28736
  ds_read_b64_tr_b16 a[126:127], v155 offset:28736
  s_waitcnt lgkmcnt(0)
  s_add_u32 m0, s28, 28672
  s_nop 0
  buffer_load_dwordx4 v144, s[8:11], s17 offen lds
  s_add_u32 s17, s17, s29
  s_add_u32 m0, s28, 29696
  s_nop 0
  buffer_load_dwordx4 v144, s[8:11], s17 offen lds
  s_add_u32 s17, s17, s29
  s_add_u32 m0, s28, 30720
  s_nop 0
  buffer_load_dwordx4 v144, s[8:11], s17 offen lds
  s_add_u32 s17, s17, s29
  s_add_u32 m0, s28, 31744
  s_nop 0
  buffer_load_dwordx4 v144, s[8:11], s17 offen lds
  s_add_u32 s17, s17, s29
  s_waitcnt vmcnt(28)
  ds_read_b64_tr_b16 a[128:129], v152 offset:0
  ds_read_b64_tr_b16 a[130:131], v153 offset:0
  ds_read_b64_tr_b16 a[132:133], v154 offset:0
  ds_read_b64_tr_b16 a[134:135], v155 offset:0
  ds_read_b64_tr_b16 a[136:137], v152 offset:64
  ds_read_b64_tr_b16 a[138:139], v153 offset:64
  ds_read_b64_tr_b16 a[140:141], v154 offset:64
  ds_read_b64_tr_b16 a[142:143], v155 offset:64
  s_waitcnt lgkmcnt(0)
  s_waitcnt vmcnt(24)
  ds_read_b64_tr_b16 a[144:145], v152 offset:4096
  ds_read_b64_tr_b16 a[146:147], v153 offset:4096
  ds_read_b64_tr_b16 a[148:149], v154 offset:4096
  ds_read_b64_tr_b16 a[150:151], v155 offset:4096
  ds_read_b64_tr_b16 a[152:153], v152 offset:4160
  ds_read_b64_tr_b16 a[154:155], v153 offset:4160
  ds_read_b64_tr_b16 a[156:157], v154 offset:4160
  ds_read_b64_tr_b16 a[158:159], v155 offset:4160
  s_waitcnt lgkmcnt(0)
  s_waitcnt vmcnt(20)
  ds_read_b64_tr_b16 a[160:161], v152 offset:8192
  ds_read_b64_tr_b16 a[162:163], v153 offset:8192
  ds_read_b64_tr_b16 a[164:165], v154 offset:8192
  ds_read_b64_tr_b16 a[166:167], v155 offset:8192
  ds_read_b64_tr_b16 a[168:169], v152 offset:8256
  ds_read_b64_tr_b16 a[170:171], v153 offset:8256
  ds_read_b64_tr_b16 a[172:173], v154 offset:8256
  ds_read_b64_tr_b16 a[174:175], v155 offset:8256
  s_waitcnt lgkmcnt(0)
  s_waitcnt vmcnt(16)
  ds_read_b64_tr_b16 a[176:177], v152 offset:12288
  ds_read_b64_tr_b16 a[178:179], v153 offset:12288
  ds_read_b64_tr_b16 a[180:181], v154 offset:12288
  ds_read_b64_tr_b16 a[182:183], v155 offset:12288
  ds_read_b64_tr_b16 a[184:185], v152 offset:12352
  ds_read_b64_tr_b16 a[186:187], v153 offset:12352
  ds_read_b64_tr_b16 a[188:189], v154 offset:12352
  ds_read_b64_tr_b16 a[190:191], v155 offset:12352
  s_waitcnt lgkmcnt(0)
  s_waitcnt vmcnt(12)
  ds_read_b64_tr_b16 a[192:193], v152 offset:16384
  ds_read_b64_tr_b16 a[194:195], v153 offset:16384
  ds_read_b64_tr_b16 a[196:197], v154 offset:16384
  ds_read_b64_tr_b16 a[198:199], v155 offset:16384
  ds_read_b64_tr_b16 a[200:201], v152 offset:16448
  ds_read_b64_tr_b16 a[202:203], v153 offset:16448
  ds_read_b64_tr_b16 a[204:205], v154 offset:16448
  ds_read_b64_tr_b16 a[206:207], v155 offset:16448
  s_waitcnt lgkmcnt(0)
  s_waitcnt vmcnt(8)
  ds_read_b64_tr_b16 a[208:209], v152 offset:20480
  ds_read_b64_tr_b16 a[210:211], v153 offset:20480
  ds_read_b64_tr_b16 a[212:213], v154 offset:20480
  ds_read_b64_tr_b16 a[214:215], v155 offset:20480
  ds_read_b64_tr_b16 a[216:217], v152 offset:20544
  ds_read_b64_tr_b16 a[218:219], v153 offset:20544
  ds_read_b64_tr_b16 a[220:221], v154 offset:20544
  ds_read_b64_tr_b16 a[222:223], v155 offset:20544
  s_waitcnt lgkmcnt(0)
  s_waitcnt vmcnt(4)
  ds_read_b64_tr_b16 a[224:225], v152 offset:24576
  ds_read_b64_tr_b16 a[226:227], v153 offset:24576
  ds_read_b64_tr_b16 a[228:229], v154 offset:24576
  ds_read_b64_tr_b16 a[230:231], v155 offset:24576
  ds_read_b64_tr_b16 a[232:233], v152 offset:24640
  ds_read_b64_tr_b16 a[234:235], v153 offset:24640
  ds_read_b64_tr_b16 a[236:237], v154 offset:24640
  ds_read_b64_tr_b16 a[238:239], v155 offset:24640
  s_waitcnt lgkmcnt(0)
  s_waitcnt vmcnt(0)
  ds_read_b64_tr_b16 a[240:241], v152 offset:28672
  ds_read_b64_tr_b16 a[242:243], v153 offset:28672
  ds_read_b64_tr_b16 a[244:245], v154 offset:28672
  ds_read_b64_tr_b16 a[246:247], v155 offset:28672
  ds_read_b64_tr_b16 a[248:249], v152 offset:28736
  ds_read_b64_tr_b16 a[250:251], v153 offset:28736
  ds_read_b64_tr_b16 a[252:253], v154 offset:28736
  ds_read_b64_tr_b16 a[254:255], v155 offset:28736
  s_waitcnt lgkmcnt(0)
  s_lshl_b32 s26, s48, 2
  s_add_u32 s26, s26, s16
  s_lshl_b32 s27, s26, 6
  s_add_u32 s27, s27, s50
  s_lshl_b32 s19, s27, 13
  s_lshl_b32 s27, s50, 5
  s_add_u32 s27, s27, s26
  s_mul_i32 s27, s27, 4096
  s_add_u32 s20, s27, 135266304
  s_lshl_b32 s25, s16, 12
  s_add_u32 s25, s25, 65536
  s_lshl_b32 s26, s16, 13
  v_add_u32 v3, s26, v2
  v_lshrrev_b32 v16, 5, v1
  v_and_b32 v17, 31, v1
  v_bfe_u32 v18, v1, 4, 1
  v_lshl_add_u32 v18, v18, 1, v16
  v_and_b32 v19, 15, v1
  v_lshl_add_u32 v18, v18, 4, v19
  v_lshl_add_u32 v5, v18, 4, s25
  v_bfe_u32 v18, v1, 2, 2
  v_lshl_add_u32 v18, v16, 2, v18
  v_and_b32 v19, 1, v1
  v_lshl_add_u32 v18, v19, 4, v18
  v_lshl_add_u32 v4, v18, 4, s25
  v_lshlrev_b32 v16, 2, v16
  v_sub_u32 v17, v17, v16
  v_mov_b32 v18, 0xf149f2ca
  v_cmp_le_i32 vcc, 0, v17
  s_nop 1
  v_cndmask_b32 v240, v18, 0, vcc
  v_cmp_le_i32 vcc, 1, v17
  s_nop 1
  v_cndmask_b32 v241, v18, 0, vcc
  v_cmp_le_i32 vcc, 2, v17
  s_nop 1
  v_cndmask_b32 v242, v18, 0, vcc
  v_cmp_le_i32 vcc, 3, v17
  s_nop 1
  v_cndmask_b32 v243, v18, 0, vcc
  v_cmp_le_i32 vcc, 8, v17
  s_nop 1
  v_cndmask_b32 v244, v18, 0, vcc
  v_cmp_le_i32 vcc, 9, v17
  s_nop 1
  v_cndmask_b32 v245, v18, 0, vcc
  v_cmp_le_i32 vcc, 10, v17
  s_nop 1
  v_cndmask_b32 v246, v18, 0, vcc
  v_cmp_le_i32 vcc, 11, v17
  s_nop 1
  v_cndmask_b32 v247, v18, 0, vcc
  v_cmp_le_i32 vcc, 16, v17
  s_nop 1
  v_cndmask_b32 v248, v18, 0, vcc
  v_cmp_le_i32 vcc, 17, v17
  s_nop 1
  v_cndmask_b32 v249, v18, 0, vcc
  v_cmp_le_i32 vcc, 18, v17
  s_nop 1
  v_cndmask_b32 v250, v18, 0, vcc
  v_cmp_le_i32 vcc, 19, v17
  s_nop 1
  v_cndmask_b32 v251, v18, 0, vcc
  v_cmp_le_i32 vcc, 24, v17
  s_nop 1
  v_cndmask_b32 v252, v18, 0, vcc
  v_cmp_le_i32 vcc, 25, v17
  s_nop 1
  v_cndmask_b32 v253, v18, 0, vcc
  v_cmp_le_i32 vcc, 26, v17
  s_nop 1
  v_cndmask_b32 v254, v18, 0, vcc
  v_cmp_le_i32 vcc, 27, v17
  s_nop 1
  v_cndmask_b32 v255, v18, 0, vcc
  v_mov_b32 v21, v2
  s_barrier
  s_lshl_b32 s77, s48, 2
  s_add_u32 s77, s77, s16
  s_mul_i32 s78, s77, 896
  s_add_u32 s76, s78, 148898304
  s_mov_b32 s71, 0
  s_branch M_sg_191
M_sw_190:
  s_sleep 8
  s_add_u32 s71, s71, 1
  s_cmp_gt_u32 s71, 262144
  s_cbranch_scc1 M_exit
M_sg_191:
  s_mov_b32 s79, 0
  s_atomic_or s79, s[72:73], s76 glc
  s_waitcnt lgkmcnt(0)
  s_cmp_lt_u32 s79, 16
  s_cbranch_scc1 M_sw_190
  s_add_u32 s76, s78, 148898048
  s_mov_b32 s71, 0
  s_branch M_sg_193
M_sw_192:
  s_sleep 8
  s_add_u32 s71, s71, 1
  s_cmp_gt_u32 s71, 262144
  s_cbranch_scc1 M_exit
M_sg_193:
  s_mov_b32 s79, 0
  s_atomic_or s79, s[72:73], s76 glc
  s_waitcnt lgkmcnt(0)
  s_cmp_lt_u32 s79, 8
  s_cbranch_scc1 M_sw_192
  s_add_u32 s76, s78, 148898176
  s_mov_b32 s71, 0
  s_branch M_sg_195
M_sw_194:
  s_sleep 8
  s_add_u32 s71, s71, 1
  s_cmp_gt_u32 s71, 262144
  s_cbranch_scc1 M_exit
M_sg_195:
  s_mov_b32 s79, 0
  s_atomic_or s79, s[72:73], s76 glc
  s_waitcnt lgkmcnt(0)
  s_cmp_lt_u32 s79, 8
  s_cbranch_scc1 M_sw_194
M_xok_189:
  s_lshl_b32 s77, s77, 7
  s_add_u32 s54, s77, 148926464
  s_add_u32 s52, s50, 1
  s_mov_b32 s53, 0
  s_mov_b32 s30, 0x200
  s_add_u32 s28, s19, 50331648
  buffer_load_dwordx4 v[144:147], v21, s[4:7], s28 offen offset:0 sc1
  buffer_load_dwordx4 v[148:151], v21, s[4:7], s28 offen offset:1024 sc1
  buffer_load_dwordx4 v[152:155], v21, s[4:7], s28 offen offset:2048 sc1
  buffer_load_dwordx4 v[156:159], v21, s[4:7], s28 offen offset:3072 sc1
  s_add_u32 s29, s19, 50335744
  buffer_load_dwordx4 v[160:163], v21, s[4:7], s29 offen offset:0 sc1
  buffer_load_dwordx4 v[164:167], v21, s[4:7], s29 offen offset:1024 sc1
  buffer_load_dwordx4 v[168:171], v21, s[4:7], s29 offen offset:2048 sc1
  buffer_load_dwordx4 v[172:175], v21, s[4:7], s29 offen offset:3072 sc1
  s_add_u32 s28, s19, 67108864
  buffer_load_dwordx4 v[176:179], v21, s[4:7], s28 offen offset:0 sc1
  buffer_load_dwordx4 v[180:183], v21, s[4:7], s28 offen offset:1024 sc1
  buffer_load_dwordx4 v[184:187], v21, s[4:7], s28 offen offset:2048 sc1
  buffer_load_dwordx4 v[188:191], v21, s[4:7], s28 offen offset:3072 sc1
  s_add_u32 s29, s19, 67112960
  buffer_load_dwordx4 v[192:195], v21, s[4:7], s29 offen offset:0 sc1
  buffer_load_dwordx4 v[196:199], v21, s[4:7], s29 offen offset:1024 sc1
  buffer_load_dwordx4 v[200:203], v21, s[4:7], s29 offen offset:2048 sc1
  buffer_load_dwordx4 v[204:207], v21, s[4:7], s29 offen offset:3072 sc1
  s_add_u32 s28, s19, 83886080
  buffer_load_dwordx4 v[208:211], v21, s[4:7], s28 offen offset:0 sc1
  buffer_load_dwordx4 v[212:215], v21, s[4:7], s28 offen offset:1024 sc1
  buffer_load_dwordx4 v[216:219], v21, s[4:7], s28 offen offset:2048 sc1
  buffer_load_dwordx4 v[220:223], v21, s[4:7], s28 offen offset:3072 sc1
  s_add_u32 s29, s19, 83890176
  buffer_load_dwordx4 v[224:227], v21, s[4:7], s29 offen offset:0 sc1
  buffer_load_dwordx4 v[228:231], v21, s[4:7], s29 offen offset:1024 sc1
  buffer_load_dwordx4 v[232:235], v21, s[4:7], s29 offen offset:2048 sc1
  buffer_load_dwordx4 v[236:239], v21, s[4:7], s29 offen offset:3072 sc1
  s_mov_b32 s24, 0
  v_mov_b32 v22, 0x40000000
  s_sub_u32 s21, s21, s22
F_top_196:
  s_waitcnt vmcnt(8)
  v_mfma_f32_32x32x16_bf16 v[24:39], v[176:179], v[144:147], v[240:255]
  s_nop 1
  v_cvt_pk_bf16_f32 v128, v64, v65
  v_cvt_pk_bf16_f32 v129, v66, v67
  v_cvt_pk_bf16_f32 v130, v68, v69
  v_cvt_pk_bf16_f32 v131, v70, v71
  v_mfma_f32_32x32x16_bf16 v[24:39], v[180:183], v[148:151], v[24:39]
  buffer_store_dwordx4 v[128:131], v22, s[4:7], s21 offen offset:0 sc1
  v_mfma_f32_32x32x16_bf16 v[24:39], v[184:187], v[152:155], v[24:39]
  v_cvt_pk_bf16_f32 v132, v72, v73
  v_cvt_pk_bf16_f32 v133, v74, v75
  v_cvt_pk_bf16_f32 v134, v76, v77
  v_cvt_pk_bf16_f32 v135, v78, v79
  v_mfma_f32_32x32x16_bf16 v[24:39], v[188:191], v[156:159], v[24:39]
  buffer_store_dwordx4 v[132:135], v22, s[4:7], s21 offen offset:256 sc1
  v_mfma_f32_32x32x16_bf16 v[24:39], v[192:195], v[160:163], v[24:39]
  v_cvt_pk_bf16_f32 v136, v80, v81
  v_cvt_pk_bf16_f32 v137, v82, v83
  v_cvt_pk_bf16_f32 v138, v84, v85
  v_cvt_pk_bf16_f32 v139, v86, v87
  v_mfma_f32_32x32x16_bf16 v[24:39], v[196:199], v[164:167], v[24:39]
  buffer_store_dwordx4 v[136:139], v22, s[4:7], s21 offen offset:2048 sc1
  v_mfma_f32_32x32x16_bf16 v[24:39], v[200:203], v[168:171], v[24:39]
  v_cvt_pk_bf16_f32 v140, v88, v89
  v_cvt_pk_bf16_f32 v141, v90, v91
  v_cvt_pk_bf16_f32 v142, v92, v93
  v_cvt_pk_bf16_f32 v143, v94, v95
  v_mfma_f32_32x32x16_bf16 v[24:39], v[204:207], v[172:175], v[24:39]
  buffer_store_dwordx4 v[140:143], v22, s[4:7], s21 offen offset:2304 sc1
  s_add_u32 s21, s21, s22
  v_mov_b32 v22, v20
  s_cmp_lg_u32 s24, 0
  s_cbranch_scc1 F_have_197
  s_cmp_le_u32 s52, 58
  s_cbranch_scc1 M_dp_198
  s_mov_b32 s71, 0
  v_add_u32 v16, s25, v2
  s_waitcnt vmcnt(9)
  s_branch M_dp_200
M_dp_199:
  s_add_u32 s71, s71, 1
  s_cmp_gt_u32 s71, 262144
  s_cbranch_scc1 M_exit
  buffer_load_dword v23, off, s[4:7], s54 sc1
  buffer_load_dwordx4 v[96:99], v2, s[4:7], s20 offen offset:0 sc1
  buffer_load_dwordx4 v[100:103], v2, s[4:7], s20 offen offset:1024 sc1
  buffer_load_dwordx4 v[104:107], v2, s[4:7], s20 offen offset:2048 sc1
  buffer_load_dwordx4 v[108:111], v2, s[4:7], s20 offen offset:3072 sc1
  s_waitcnt vmcnt(0)
M_dp_200:
  v_max_u32 v17, v96, v97
  v_max3_u32 v17, v17, v98, v99
  v_max3_u32 v17, v17, v100, v101
  v_max3_u32 v17, v17, v102, v103
  v_max3_u32 v17, v17, v104, v105
  v_max3_u32 v17, v17, v106, v107
  v_max3_u32 v17, v17, v108, v109
  v_max3_u32 v17, v17, v110, v111
  v_cmp_eq_u32 vcc, -1, v17
  s_cbranch_vccz M_dp_201
  v_cmp_gt_u32 vcc, s52, v23
  s_cbranch_vccnz M_dp_199
  s_branch M_dp_198
M_dp_201:
  ds_write_b128 v16, v[96:99] offset:0
  ds_write_b128 v16, v[100:103] offset:1024
  ds_write_b128 v16, v[104:107] offset:2048
  ds_write_b128 v16, v[108:111] offset:3072
  s_branch F_have_197
M_dp_198:
  v_mov_b32 v16, s54
  v_mov_b32 v17, s52
  s_mov_b32 s71, 0
  s_branch M_vg_203
M_vw_202:
  s_sleep 2
  s_add_u32 s71, s71, 1
  s_cmp_gt_u32 s71, 262144
  s_cbranch_scc1 M_exit
M_vg_203:
  buffer_load_dword v23, v16, s[4:7], 0 offen sc1
  s_waitcnt vmcnt(0)
  v_cmp_lt_u32 vcc, v23, v17
  s_cbranch_vccnz M_vw_202
  s_mov_b32 m0, s25
  s_nop 0
  buffer_load_dwordx4 v2, s[4:7], s20 offen offset:0 sc1 lds
  buffer_load_dwordx4 v2, s[4:7], s20 offen offset:1024 sc1 lds
  buffer_load_dwordx4 v2, s[4:7], s20 offen offset:2048 sc1 lds
  buffer_load_dwordx4 v2, s[4:7], s20 offen offset:3072 sc1 lds
  s_waitcnt vmcnt(0)
F_have_197:
  ds_read_b64_tr_b16 v[176:177], v4 offset:8
  ds_read_b64_tr_b16 v[178:179], v4 offset:136
  ds_read_b64_tr_b16 v[180:181], v4 offset:520
  ds_read_b64_tr_b16 v[182:183], v4 offset:648
  ds_read_b64_tr_b16 v[184:185], v4 offset:1032
  ds_read_b64_tr_b16 v[186:187], v4 offset:1160
  ds_read_b64_tr_b16 v[188:189], v4 offset:1544
  ds_read_b64_tr_b16 v[190:191], v4 offset:1672
  ds_read_b64_tr_b16 v[192:193], v4 offset:2056
  ds_read_b64_tr_b16 v[194:195], v4 offset:2184
  ds_read_b64_tr_b16 v[196:197], v4 offset:2568
  ds_read_b64_tr_b16 v[198:199], v4 offset:2696
  s_sub_u32 s23, s23, 1
  s_cmp_gt_u32 s23, 0
  s_cselect_b32 s26, s51, 0
  s_cselect_b32 s27, 0, 0x40000000
  v_or_b32 v21, s27, v21
  s_lshl_b32 s27, s26, 13
  s_add_u32 s19, s19, s27
  s_mul_i32 s27, s26, 131072
  s_add_u32 s20, s20, s27
  s_cmp_lg_u32 s23, 24
  s_cbranch_scc1 M_xok_204
  s_lshl_b32 s77, s48, 2
  s_add_u32 s77, s77, s16
  s_mul_i32 s78, s77, 896
  s_add_u32 s76, s78, 148898304
  s_mov_b32 s71, 0
  s_branch M_sg_206
M_sw_205:
  s_sleep 8
  s_add_u32 s71, s71, 1
  s_cmp_gt_u32 s71, 262144
  s_cbranch_scc1 M_exit
M_sg_206:
  s_mov_b32 s79, 0
  s_atomic_or s79, s[72:73], s76 glc
  s_waitcnt lgkmcnt(0)
  s_cmp_lt_u32 s79, 32
  s_cbranch_scc1 M_sw_205
  s_add_u32 s76, s78, 148898432
  s_mov_b32 s71, 0
  s_branch M_sg_208
M_sw_207:
  s_sleep 8
  s_add_u32 s71, s71, 1
  s_cmp_gt_u32 s71, 262144
  s_cbranch_scc1 M_exit
M_sg_208:
  s_mov_b32 s79, 0
  s_atomic_or s79, s[72:73], s76 glc
  s_waitcnt lgkmcnt(0)
  s_cmp_lt_u32 s79, 32
  s_cbranch_scc1 M_sw_207
  s_add_u32 s76, s78, 148898048
  s_mov_b32 s71, 0
  s_branch M_sg_210
M_sw_209:
  s_sleep 8
  s_add_u32 s71, s71, 1
  s_cmp_gt_u32 s71, 262144
  s_cbranch_scc1 M_exit
M_sg_210:
  s_mov_b32 s79, 0
  s_atomic_or s79, s[72:73], s76 glc
  s_waitcnt lgkmcnt(0)
  s_cmp_lt_u32 s79, 32
  s_cbranch_scc1 M_sw_209
  s_add_u32 s76, s78, 148898176
  s_mov_b32 s71, 0
  s_branch M_sg_212
M_sw_211:
  s_sleep 8
  s_add_u32 s71, s71, 1
  s_cmp_gt_u32 s71, 262144
  s_cbranch_scc1 M_exit
M_sg_212:
  s_mov_b32 s79, 0
  s_atomic_or s79, s[72:73], s76 glc
  s_waitcnt lgkmcnt(0)
  s_cmp_lt_u32 s79, 32
  s_cbranch_scc1 M_sw_211
M_xok_204:
  s_waitcnt lgkmcnt(10)
  v_mfma_f32_32x32x16_bf16 v[40:55], v[176:179], v[144:147], 0
  ds_read_b64_tr_b16 v[200:201], v4 offset:3080
  ds_read_b64_tr_b16 v[202:203], v4 offset:3208
  v_max_f32 v6, v24, v25
  s_waitcnt lgkmcnt(10)
  v_mfma_f32_32x32x16_bf16 v[40:55], v[180:183], v[148:151], v[40:55]
  ds_read_b64_tr_b16 v[204:205], v4 offset:3592
  ds_read_b64_tr_b16 v[206:207], v4 offset:3720
  v_max3_f32 v6, v6, v26, v27
  s_waitcnt lgkmcnt(10)
  v_mfma_f32_32x32x16_bf16 v[40:55], v[184:187], v[152:155], v[40:55]
  ds_read_b64 v[56:57], v5 offset:0
  ds_read_b64 v[58:59], v5 offset:1024
  v_max3_f32 v6, v6, v28, v29
  s_waitcnt lgkmcnt(10)
  v_mfma_f32_32x32x16_bf16 v[40:55], v[188:191], v[156:159], v[40:55]
  ds_read_b64 v[60:61], v5 offset:2048
  ds_read_b64 v[62:63], v5 offset:3072
  v_max3_f32 v6, v6, v30, v31
  s_waitcnt lgkmcnt(10)
  v_mfma_f32_32x32x16_bf16 v[40:55], v[192:195], v[160:163], v[40:55]
  v_max3_f32 v6, v6, v32, v33
  s_waitcnt lgkmcnt(8)
  v_mfma_f32_32x32x16_bf16 v[40:55], v[196:199], v[164:167], v[40:55]
  v_max3_f32 v6, v6, v34, v35
  s_waitcnt lgkmcnt(6)
  v_mfma_f32_32x32x16_bf16 v[40:55], v[200:203], v[168:171], v[40:55]
  v_max3_f32 v6, v6, v36, v37
  s_waitcnt lgkmcnt(4)
  v_mfma_f32_32x32x16_bf16 v[40:55], v[204:207], v[172:175], v[40:55]
  v_max3_f32 v6, v6, v38, v39
  s_add_u32 s28, s19, 50331648
  buffer_load_dwordx4 v[144:147], v21, s[4:7], s28 offen offset:0 sc1
  buffer_load_dwordx4 v[148:151], v21, s[4:7], s28 offen offset:1024 sc1
  s_nop 7
  v_max3_f32 v6, v6, v40, v41
  v_max3_f32 v6, v6, v42, v43
  v_mov_b32 v16, v6
  s_nop 1
  v_permlane32_swap_b32 v6, v16
  s_nop 1
  v_max_f32 v6, v6, v16
  v_pk_add_f32 v[24:25], v[24:25], v[6:7] op_sel_hi:[1,0] neg_lo:[0,1] neg_hi:[0,1]
  v_pk_add_f32 v[26:27], v[26:27], v[6:7] op_sel_hi:[1,0] neg_lo:[0,1] neg_hi:[0,1]
  v_pk_add_f32 v[28:29], v[28:29], v[6:7] op_sel_hi:[1,0] neg_lo:[0,1] neg_hi:[0,1]
  v_pk_add_f32 v[30:31], v[30:31], v[6:7] op_sel_hi:[1,0] neg_lo:[0,1] neg_hi:[0,1]
  v_pk_add_f32 v[32:33], v[32:33], v[6:7] op_sel_hi:[1,0] neg_lo:[0,1] neg_hi:[0,1]
  v_pk_add_f32 v[34:35], v[34:35], v[6:7] op_sel_hi:[1,0] neg_lo:[0,1] neg_hi:[0,1]
  v_pk_add_f32 v[36:37], v[36:37], v[6:7] op_sel_hi:[1,0] neg_lo:[0,1] neg_hi:[0,1]
  v_pk_add_f32 v[38:39], v[38:39], v[6:7] op_sel_hi:[1,0] neg_lo:[0,1] neg_hi:[0,1]
  v_pk_add_f32 v[40:41], v[40:41], v[6:7] op_sel_hi:[1,0] neg_lo:[0,1] neg_hi:[0,1]
  v_pk_add_f32 v[42:43], v[42:43], v[6:7] op_sel_hi:[1,0] neg_lo:[0,1] neg_hi:[0,1]
  v_exp_f32 v24, v24
  v_exp_f32 v25, v25
  v_exp_f32 v26, v26
  v_exp_f32 v27, v27
  v_exp_f32 v28, v28
  v_exp_f32 v29, v29
  v_exp_f32 v30, v30
  v_exp_f32 v31, v31
  v_exp_f32 v32, v32
  v_exp_f32 v33, v33
  buffer_load_dwordx4 v[152:155], v21, s[4:7], s28 offen offset:2048 sc1
  v_exp_f32 v34, v34
  v_exp_f32 v35, v35
  v_exp_f32 v36, v36
  v_exp_f32 v37, v37
  v_exp_f32 v38, v38
  v_exp_f32 v39, v39
  v_exp_f32 v40, v40
  v_exp_f32 v41, v41
  v_exp_f32 v42, v42
  v_exp_f32 v43, v43
  v_pk_add_f32 v[16:17], v[24:25], v[26:27]
  v_pk_add_f32 v[16:17], v[16:17], v[28:29]
  v_pk_add_f32 v[16:17], v[16:17], v[30:31]
  v_pk_add_f32 v[16:17], v[16:17], v[32:33]
  v_pk_add_f32 v[16:17], v[16:17], v[34:35]
  v_pk_add_f32 v[16:17], v[16:17], v[36:37]
  v_pk_add_f32 v[16:17], v[16:17], v[38:39]
  v_pk_add_f32 v[16:17], v[16:17], v[40:41]
  v_pk_add_f32 v[16:17], v[16:17], v[42:43]
  v_add_f32 v16, v16, v17
  v_mov_b32 v17, v16
  buffer_load_dwordx4 v[156:159], v21, s[4:7], s28 offen offset:3072 sc1
  s_nop 0
  v_permlane32_swap_b32 v16, v17
  s_nop 1
  v_add_f32 v16, v16, v17
  v_rcp_f32 v6, v16
  s_nop 0
  v_pk_mul_f32 v[24:25], v[24:25], v[6:7] op_sel_hi:[1,0]
  v_pk_mul_f32 v[26:27], v[26:27], v[6:7] op_sel_hi:[1,0]
  v_pk_mul_f32 v[28:29], v[28:29], v[6:7] op_sel_hi:[1,0]
  v_pk_mul_f32 v[30:31], v[30:31], v[6:7] op_sel_hi:[1,0]
  v_pk_mul_f32 v[32:33], v[32:33], v[6:7] op_sel_hi:[1,0]
  v_pk_mul_f32 v[34:35], v[34:35], v[6:7] op_sel_hi:[1,0]
  v_pk_mul_f32 v[36:37], v[36:37], v[6:7] op_sel_hi:[1,0]
  v_pk_mul_f32 v[38:39], v[38:39], v[6:7] op_sel_hi:[1,0]
  v_pk_mul_f32 v[40:41], v[40:41], v[6:7] op_sel_hi:[1,0]
  v_pk_mul_f32 v[42:43], v[42:43], v[6:7] op_sel_hi:[1,0]
  v_cvt_pk_bf16_f32 v128, v24, v25
  v_cvt_pk_bf16_f32 v129, v26, v27
  v_cvt_pk_bf16_f32 v130, v28, v29
  v_cvt_pk_bf16_f32 v131, v30, v31
  v_cvt_pk_bf16_f32 v132, v32, v33
  v_cvt_pk_bf16_f32 v133, v34, v35
  v_cvt_pk_bf16_f32 v134, v36, v37
  v_cvt_pk_bf16_f32 v135, v38, v39
  v_cvt_pk_bf16_f32 v136, v40, v41
  v_cvt_pk_bf16_f32 v137, v42, v43
  s_waitcnt vmcnt(8) lgkmcnt(0)
  v_mfma_f32_32x32x16_bf16 v[64:79], v[208:211], v[128:131], 0
  s_add_u32 s29, s19, 50335744
  buffer_load_dwordx4 v[160:163], v21, s[4:7], s29 offen offset:0 sc1
  v_mfma_f32_32x32x16_bf16 v[64:79], v[212:215], v[132:135], v[64:79]
  v_mfma_f32_32x32x8_bf16 v[64:79], v[56:57], v[136:137], v[64:79]
  v_mfma_f32_32x32x16_bf16 v[80:95], v[216:219], v[128:131], 0
  buffer_load_dwordx4 v[164:167], v21, s[4:7], s29 offen offset:1024 sc1
  v_mfma_f32_32x32x16_bf16 v[80:95], v[220:223], v[132:135], v[80:95]
  v_cvt_pk_bf16_f32 v24, v64, v65
  v_cvt_pk_bf16_f32 v25, v66, v67
  v_cvt_pk_bf16_f32 v26, v68, v69
  v_cvt_pk_bf16_f32 v27, v70, v71
  v_mfma_f32_32x32x8_bf16 v[80:95], v[58:59], v[136:137], v[80:95]
  ds_write_b128 v3, v[24:27] offset:0
  v_cvt_pk_bf16_f32 v28, v72, v73
  v_cvt_pk_bf16_f32 v29, v74, v75
  v_cvt_pk_bf16_f32 v30, v76, v77
  v_cvt_pk_bf16_f32 v31, v78, v79
  v_mfma_f32_32x32x16_bf16 v[96:111], v[224:227], v[128:131], 0
  ds_write_b128 v3, v[28:31] offset:1024
  buffer_load_dwordx4 v[168:171], v21, s[4:7], s29 offen offset:2048 sc1
  v_mfma_f32_32x32x16_bf16 v[96:111], v[228:231], v[132:135], v[96:111]
  v_cvt_pk_bf16_f32 v32, v80, v81
  v_cvt_pk_bf16_f32 v33, v82, v83
  v_cvt_pk_bf16_f32 v34, v84, v85
  v_cvt_pk_bf16_f32 v35, v86, v87
  v_mfma_f32_32x32x8_bf16 v[96:111], v[60:61], v[136:137], v[96:111]
  ds_write_b128 v3, v[32:35] offset:2048
  v_cvt_pk_bf16_f32 v36, v88, v89
  v_cvt_pk_bf16_f32 v37, v90, v91
  v_cvt_pk_bf16_f32 v38, v92, v93
  v_cvt_pk_bf16_f32 v39, v94, v95
  v_mfma_f32_32x32x16_bf16 v[112:127], v[232:235], v[128:131], 0
  ds_write_b128 v3, v[36:39] offset:3072
  buffer_load_dwordx4 v[172:175], v21, s[4:7], s29 offen offset:3072 sc1
  v_mfma_f32_32x32x16_bf16 v[112:127], v[236:239], v[132:135], v[112:127]
  v_cvt_pk_bf16_f32 v40, v96, v97
  v_cvt_pk_bf16_f32 v41, v98, v99
  v_cvt_pk_bf16_f32 v42, v100, v101
  v_cvt_pk_bf16_f32 v43, v102, v103
  v_mfma_f32_32x32x8_bf16 v[112:127], v[62:63], v[136:137], v[112:127]
  ds_write_b128 v3, v[40:43] offset:4096
  v_cvt_pk_bf16_f32 v44, v104, v105
  v_cvt_pk_bf16_f32 v45, v106, v107
  v_cvt_pk_bf16_f32 v46, v108, v109
  v_cvt_pk_bf16_f32 v47, v110, v111
  ds_write_b128 v3, v[44:47] offset:5120
  s_nop 5
  v_cvt_pk_bf16_f32 v48, v112, v113
  v_cvt_pk_bf16_f32 v49, v114, v115
  v_cvt_pk_bf16_f32 v50, v116, v117
  v_cvt_pk_bf16_f32 v51, v118, v119
  ds_write_b128 v3, v[48:51] offset:6144
  v_cvt_pk_bf16_f32 v52, v120, v121
  v_cvt_pk_bf16_f32 v53, v122, v123
  v_cvt_pk_bf16_f32 v54, v124, v125
  v_cvt_pk_bf16_f32 v55, v126, v127
  ds_write_b128 v3, v[52:55] offset:7168
  s_waitcnt vmcnt(8)
  s_waitcnt lgkmcnt(0)
  s_barrier
  ds_read_b128 v[24:27], v8 offset:0
  ds_read_b128 v[28:31], v9 offset:0
  ds_read_b128 v[32:35], v10 offset:0
  ds_read_b128 v[36:39], v11 offset:0
  ds_read_b128 v[40:43], v12 offset:0
  ds_read_b128 v[44:47], v13 offset:0
  buffer_load_dword v23, off, s[4:7], s54 sc1
  v_mov_b32 v16, s30
  v_min_u32 v17, 1, v0
  v_lshlrev_b32 v17, 30, v17
  buffer_store_dword v16, v17, s[4:7], s31 offen sc1
  s_add_u32 s30, s30, 1
  s_add_u32 s52, s52, 2
  s_waitcnt lgkmcnt(5)
  v_mfma_f32_16x16x32_bf16 v[64:67], a[0:3], v[24:27], 0
  s_add_u32 s28, s19, 67108864
  ds_read_b128 v[48:51], v14 offset:0
  v_mfma_f32_16x16x32_bf16 v[68:71], a[4:7], v[24:27], 0
  v_mfma_f32_16x16x32_bf16 v[80:83], a[8:11], v[24:27], 0
  v_mfma_f32_16x16x32_bf16 v[84:87], a[12:15], v[24:27], 0
  s_waitcnt lgkmcnt(5)
  v_mfma_f32_16x16x32_bf16 v[72:75], a[0:3], v[28:31], 0
  ds_read_b128 v[52:55], v15 offset:0
  v_mfma_f32_16x16x32_bf16 v[76:79], a[4:7], v[28:31], 0
  v_mfma_f32_16x16x32_bf16 v[88:91], a[8:11], v[28:31], 0
  buffer_load_dwordx4 v[176:179], v21, s[4:7], s28 offen offset:0 sc1
  v_mfma_f32_16x16x32_bf16 v[92:95], a[12:15], v[28:31], 0
  s_waitcnt lgkmcnt(5)
  v_mfma_f32_16x16x32_bf16 v[64:67], a[16:19], v[32:35], v[64:67]
  ds_read_b128 v[24:27], v8 offset:8192
  v_mfma_f32_16x16x32_bf16 v[68:71], a[20:23], v[32:35], v[68:71]
  v_mfma_f32_16x16x32_bf16 v[80:83], a[24:27], v[32:35], v[80:83]
  v_mfma_f32_16x16x32_bf16 v[84:87], a[28:31], v[32:35], v[84:87]
  s_waitcnt lgkmcnt(5)
  v_mfma_f32_16x16x32_bf16 v[72:75], a[16:19], v[36:39], v[72:75]
  ds_read_b128 v[28:31], v9 offset:8192
  v_mfma_f32_16x16x32_bf16 v[76:79], a[20:23], v[36:39], v[76:79]
  v_mfma_f32_16x16x32_bf16 v[88:91], a[24:27], v[36:39], v[88:91]
  buffer_load_dwordx4 v[180:183], v21, s[4:7], s28 offen offset:1024 sc1
  v_mfma_f32_16x16x32_bf16 v[92:95], a[28:31], v[36:39], v[92:95]
  s_waitcnt lgkmcnt(5)
  v_mfma_f32_16x16x32_bf16 v[64:67], a[32:35], v[40:43], v[64:67]
  ds_read_b128 v[32:35], v10 offset:8192
  v_mfma_f32_16x16x32_bf16 v[68:71], a[36:39], v[40:43], v[68:71]
  v_mfma_f32_16x16x32_bf16 v[80:83], a[40:43], v[40:43], v[80:83]
  v_mfma_f32_16x16x32_bf16 v[84:87], a[44:47], v[40:43], v[84:87]
  s_waitcnt lgkmcnt(5)
  v_mfma_f32_16x16x32_bf16 v[72:75], a[32:35], v[44:47], v[72:75]
  ds_read_b128 v[36:39], v11 offset:8192
  v_mfma_f32_16x16x32_bf16 v[76:79], a[36:39], v[44:47], v[76:79]
  v_mfma_f32_16x16x32_bf16 v[88:91], a[40:43], v[44:47], v[88:91]
  buffer_load_dwordx4 v[184:187], v21, s[4:7], s28 offen offset:2048 sc1
  v_mfma_f32_16x16x32_bf16 v[92:95], a[44:47], v[44:47], v[92:95]
  s_waitcnt lgkmcnt(5)
  v_mfma_f32_16x16x32_bf16 v[64:67], a[48:51], v[48:51], v[64:67]
  ds_read_b128 v[40:43], v12 offset:8192
  v_mfma_f32_16x16x32_bf16 v[68:71], a[52:55], v[48:51], v[68:71]
  v_mfma_f32_16x16x32_bf16 v[80:83], a[56:59], v[48:51], v[80:83]
  v_mfma_f32_16x16x32_bf16 v[84:87], a[60:63], v[48:51], v[84:87]
  s_waitcnt lgkmcnt(5)
  v_mfma_f32_16x16x32_bf16 v[72:75], a[48:51], v[52:55], v[72:75]
  ds_read_b128 v[44:47], v13 offset:8192
  v_mfma_f32_16x16x32_bf16 v[76:79], a[52:55], v[52:55], v[76:79]
  v_mfma_f32_16x16x32_bf16 v[88:91], a[56:59], v[52:55], v[88:91]
  buffer_load_dwordx4 v[188:191], v21, s[4:7], s28 offen offset:3072 sc1
  v_mfma_f32_16x16x32_bf16 v[92:95], a[60:63], v[52:55], v[92:95]
  s_waitcnt lgkmcnt(5)
  v_mfma_f32_16x16x32_bf16 v[64:67], a[64:67], v[24:27], v[64:67]
  s_add_u32 s29, s19, 67112960
  ds_read_b128 v[48:51], v14 offset:8192
  v_mfma_f32_16x16x32_bf16 v[68:71], a[68:71], v[24:27], v[68:71]
  v_mfma_f32_16x16x32_bf16 v[80:83], a[72:75], v[24:27], v[80:83]
  v_mfma_f32_16x16x32_bf16 v[84:87], a[76:79], v[24:27], v[84:87]
  s_waitcnt lgkmcnt(5)
  v_mfma_f32_16x16x32_bf16 v[72:75], a[64:67], v[28:31], v[72:75]
  ds_read_b128 v[52:55], v15 offset:8192
  v_mfma_f32_16x16x32_bf16 v[76:79], a[68:71], v[28:31], v[76:79]
  v_mfma_f32_16x16x32_bf16 v[88:91], a[72:75], v[28:31], v[88:91]
  buffer_load_dwordx4 v[192:195], v21, s[4:7], s29 offen offset:0 sc1
  v_mfma_f32_16x16x32_bf16 v[92:95], a[76:79], v[28:31], v[92:95]
  s_waitcnt lgkmcnt(5)
  v_mfma_f32_16x16x32_bf16 v[64:67], a[80:83], v[32:35], v[64:67]
  ds_read_b128 v[24:27], v8 offset:16384
  v_mfma_f32_16x16x32_bf16 v[68:71], a[84:87], v[32:35], v[68:71]
  v_mfma_f32_16x16x32_bf16 v[80:83], a[88:91], v[32:35], v[80:83]
  v_mfma_f32_16x16x32_bf16 v[84:87], a[92:95], v[32:35], v[84:87]
  s_waitcnt lgkmcnt(5)
  v_mfma_f32_16x16x32_bf16 v[72:75], a[80:83], v[36:39], v[72:75]
  ds_read_b128 v[28:31], v9 offset:16384
  v_mfma_f32_16x16x32_bf16 v[76:79], a[84:87], v[36:39], v[76:79]
  v_mfma_f32_16x16x32_bf16 v[88:91], a[88:91], v[36:39], v[88:91]
  buffer_load_dwordx4 v[196:199], v21, s[4:7], s29 offen offset:1024 sc1
  v_mfma_f32_16x16x32_bf16 v[92:95], a[92:95], v[36:39], v[92:95]
  s_waitcnt lgkmcnt(5)
  v_mfma_f32_16x16x32_bf16 v[64:67], a[96:99], v[40:43], v[64:67]
  ds_read_b128 v[32:35], v10 offset:16384
  v_mfma_f32_16x16x32_bf16 v[68:71], a[100:103], v[40:43], v[68:71]
  v_mfma_f32_16x16x32_bf16 v[80:83], a[104:107], v[40:43], v[80:83]
  v_mfma_f32_16x16x32_bf16 v[84:87], a[108:111], v[40:43], v[84:87]
  s_waitcnt lgkmcnt(5)
  s_waitcnt vmcnt(7)
  v_readfirstlane_b32 s53, v23
  s_nop 0
  s_cmp_ge_u32 s53, s52
  s_cselect_b32 s24, 1, 0
  s_cbranch_scc0 F_nopre_213
  s_mov_b32 m0, s25
  s_nop 0
  buffer_load_dwordx4 v2, s[4:7], s20 offen offset:0 sc1 lds
  buffer_load_dwordx4 v2, s[4:7], s20 offen offset:1024 sc1 lds
  buffer_load_dwordx4 v2, s[4:7], s20 offen offset:2048 sc1 lds
  buffer_load_dwordx4 v2, s[4:7], s20 offen offset:3072 sc1 lds
F_nopre_213:
  v_mfma_f32_16x16x32_bf16 v[72:75], a[96:99], v[44:47], v[72:75]
  ds_read_b128 v[36:39], v11 offset:16384
  v_mfma_f32_16x16x32_bf16 v[76:79], a[100:103], v[44:47], v[76:79]
  v_mfma_f32_16x16x32_bf16 v[88:91], a[104:107], v[44:47], v[88:91]
  buffer_load_dwordx4 v[200:203], v21, s[4:7], s29 offen offset:2048 sc1
  v_mfma_f32_16x16x32_bf16 v[92:95], a[108:111], v[44:47], v[92:95]
  s_waitcnt lgkmcnt(5)
  v_mfma_f32_16x16x32_bf16 v[64:67], a[112:115], v[48:51], v[64:67]
  ds_read_b128 v[40:43], v12 offset:16384
  v_mfma_f32_16x16x32_bf16 v[68:71], a[116:119], v[48:51], v[68:71]
  v_mfma_f32_16x16x32_bf16 v[80:83], a[120:123], v[48:51], v[80:83]
  v_mfma_f32_16x16x32_bf16 v[84:87], a[124:127], v[48:51], v[84:87]
  s_waitcnt lgkmcnt(5)
  v_mfma_f32_16x16x32_bf16 v[72:75], a[112:115], v[52:55], v[72:75]
  ds_read_b128 v[44:47], v13 offset:16384
  v_mfma_f32_16x16x32_bf16 v[76:79], a[116:119], v[52:55], v[76:79]
  v_mfma_f32_16x16x32_bf16 v[88:91], a[120:123], v[52:55], v[88:91]
  buffer_load_dwordx4 v[204:207], v21, s[4:7], s29 offen offset:3072 sc1
  v_mfma_f32_16x16x32_bf16 v[92:95], a[124:127], v[52:55], v[92:95]
  s_waitcnt lgkmcnt(5)
  v_mfma_f32_16x16x32_bf16 v[64:67], a[128:131], v[24:27], v[64:67]
  s_add_u32 s28, s19, 83886080
  ds_read_b128 v[48:51], v14 offset:16384
  v_mfma_f32_16x16x32_bf16 v[68:71], a[132:135], v[24:27], v[68:71]
  v_mfma_f32_16x16x32_bf16 v[80:83], a[136:139], v[24:27], v[80:83]
  v_mfma_f32_16x16x32_bf16 v[84:87], a[140:143], v[24:27], v[84:87]
  s_waitcnt lgkmcnt(5)
  v_mfma_f32_16x16x32_bf16 v[72:75], a[128:131], v[28:31], v[72:75]
  ds_read_b128 v[52:55], v15 offset:16384
  v_mfma_f32_16x16x32_bf16 v[76:79], a[132:135], v[28:31], v[76:79]
  v_mfma_f32_16x16x32_bf16 v[88:91], a[136:139], v[28:31], v[88:91]
  buffer_load_dwordx4 v[208:211], v21, s[4:7], s28 offen offset:0 sc1
  v_mfma_f32_16x16x32_bf16 v[92:95], a[140:143], v[28:31], v[92:95]
  s_waitcnt lgkmcnt(5)
  v_mfma_f32_16x16x32_bf16 v[64:67], a[144:147], v[32:35], v[64:67]
  ds_read_b128 v[24:27], v8 offset:24576
  v_mfma_f32_16x16x32_bf16 v[68:71], a[148:151], v[32:35], v[68:71]
  v_mfma_f32_16x16x32_bf16 v[80:83], a[152:155], v[32:35], v[80:83]
  v_mfma_f32_16x16x32_bf16 v[84:87], a[156:159], v[32:35], v[84:87]
  s_waitcnt lgkmcnt(5)
  v_mfma_f32_16x16x32_bf16 v[72:75], a[144:147], v[36:39], v[72:75]
  ds_read_b128 v[28:31], v9 offset:24576
  v_mfma_f32_16x16x32_bf16 v[76:79], a[148:151], v[36:39], v[76:79]
  v_mfma_f32_16x16x32_bf16 v[88:91], a[152:155], v[36:39], v[88:91]
  buffer_load_dwordx4 v[212:215], v21, s[4:7], s28 offen offset:1024 sc1
  v_mfma_f32_16x16x32_bf16 v[92:95], a[156:159], v[36:39], v[92:95]
  s_waitcnt lgkmcnt(5)
  v_mfma_f32_16x16x32_bf16 v[64:67], a[160:163], v[40:43], v[64:67]
  ds_read_b128 v[32:35], v10 offset:24576
  v_mfma_f32_16x16x32_bf16 v[68:71], a[164:167], v[40:43], v[68:71]
  v_mfma_f32_16x16x32_bf16 v[80:83], a[168:171], v[40:43], v[80:83]
  v_mfma_f32_16x16x32_bf16 v[84:87], a[172:175], v[40:43], v[84:87]
  s_waitcnt lgkmcnt(5)
  v_mfma_f32_16x16x32_bf16 v[72:75], a[160:163], v[44:47], v[72:75]
  ds_read_b128 v[36:39], v11 offset:24576
  v_mfma_f32_16x16x32_bf16 v[76:79], a[164:167], v[44:47], v[76:79]
  v_mfma_f32_16x16x32_bf16 v[88:91], a[168:171], v[44:47], v[88:91]
  buffer_load_dwordx4 v[216:219], v21, s[4:7], s28 offen offset:2048 sc1
  v_mfma_f32_16x16x32_bf16 v[92:95], a[172:175], v[44:47], v[92:95]
  s_waitcnt lgkmcnt(5)
  v_mfma_f32_16x16x32_bf16 v[64:67], a[176:179], v[48:51], v[64:67]
  ds_read_b128 v[40:43], v12 offset:24576
  v_mfma_f32_16x16x32_bf16 v[68:71], a[180:183], v[48:51], v[68:71]
  v_mfma_f32_16x16x32_bf16 v[80:83], a[184:187], v[48:51], v[80:83]
  v_mfma_f32_16x16x32_bf16 v[84:87], a[188:191], v[48:51], v[84:87]
  s_waitcnt lgkmcnt(5)
  s_cmp_lg_u32 s24, 0
  s_cselect_b32 s76, 0, s52
  s_sub_u32 s76, s76, 59
  s_cmp_ge_u32 s76, 6
  s_cbranch_scc1 M_nosp_214
  buffer_load_dword v23, off, s[4:7], s54 sc1
  buffer_load_dwordx4 v[96:99], v2, s[4:7], s20 offen offset:0 sc1
  buffer_load_dwordx4 v[100:103], v2, s[4:7], s20 offen offset:1024 sc1
  buffer_load_dwordx4 v[104:107], v2, s[4:7], s20 offen offset:2048 sc1
  buffer_load_dwordx4 v[108:111], v2, s[4:7], s20 offen offset:3072 sc1
M_nosp_214:
  v_mfma_f32_16x16x32_bf16 v[72:75], a[176:179], v[52:55], v[72:75]
  ds_read_b128 v[44:47], v13 offset:24576
  v_mfma_f32_16x16x32_bf16 v[76:79], a[180:183], v[52:55], v[76:79]
  v_mfma_f32_16x16x32_bf16 v[88:91], a[184:187], v[52:55], v[88:91]
  buffer_load_dwordx4 v[220:223], v21, s[4:7], s28 offen offset:3072 sc1
  v_mfma_f32_16x16x32_bf16 v[92:95], a[188:191], v[52:55], v[92:95]
  s_waitcnt lgkmcnt(5)
  v_mfma_f32_16x16x32_bf16 v[64:67], a[192:195], v[24:27], v[64:67]
  s_add_u32 s29, s19, 83890176
  ds_read_b128 v[48:51], v14 offset:24576
  v_mfma_f32_16x16x32_bf16 v[68:71], a[196:199], v[24:27], v[68:71]
  v_mfma_f32_16x16x32_bf16 v[80:83], a[200:203], v[24:27], v[80:83]
  v_mfma_f32_16x16x32_bf16 v[84:87], a[204:207], v[24:27], v[84:87]
  s_waitcnt lgkmcnt(5)
  v_mfma_f32_16x16x32_bf16 v[72:75], a[192:195], v[28:31], v[72:75]
  ds_read_b128 v[52:55], v15 offset:24576
  v_mfma_f32_16x16x32_bf16 v[76:79], a[196:199], v[28:31], v[76:79]
  v_mfma_f32_16x16x32_bf16 v[88:91], a[200:203], v[28:31], v[88:91]
  buffer_load_dwordx4 v[224:227], v21, s[4:7], s29 offen offset:0 sc1
  v_mfma_f32_16x16x32_bf16 v[92:95], a[204:207], v[28:31], v[92:95]
  s_waitcnt lgkmcnt(5)
  v_mfma_f32_16x16x32_bf16 v[64:67], a[208:211], v[32:35], v[64:67]
  v_mfma_f32_16x16x32_bf16 v[68:71], a[212:215], v[32:35], v[68:71]
  v_mfma_f32_16x16x32_bf16 v[80:83], a[216:219], v[32:35], v[80:83]
  v_mfma_f32_16x16x32_bf16 v[84:87], a[220:223], v[32:35], v[84:87]
  s_waitcnt lgkmcnt(4)
  v_mfma_f32_16x16x32_bf16 v[72:75], a[208:211], v[36:39], v[72:75]
  v_mfma_f32_16x16x32_bf16 v[76:79], a[212:215], v[36:39], v[76:79]
  v_xor_b32 v8, 0x8000, v8
  v_mfma_f32_16x16x32_bf16 v[88:91], a[216:219], v[36:39], v[88:91]
  buffer_load_dwordx4 v[228:231], v21, s[4:7], s29 offen offset:1024 sc1
  v_mfma_f32_16x16x32_bf16 v[92:95], a[220:223], v[36:39], v[92:95]
  s_waitcnt lgkmcnt(3)
  v_xor_b32 v9, 0x8000, v9
  v_mfma_f32_16x16x32_bf16 v[64:67], a[224:227], v[40:43], v[64:67]
  v_mfma_f32_16x16x32_bf16 v[68:71], a[228:231], v[40:43], v[68:71]
  v_xor_b32 v10, 0x8000, v10
  v_mfma_f32_16x16x32_bf16 v[80:83], a[232:235], v[40:43], v[80:83]
  v_mfma_f32_16x16x32_bf16 v[84:87], a[236:239], v[40:43], v[84:87]
  s_waitcnt lgkmcnt(2)
  v_xor_b32 v11, 0x8000, v11
  v_mfma_f32_16x16x32_bf16 v[72:75], a[224:227], v[44:47], v[72:75]
  v_mfma_f32_16x16x32_bf16 v[76:79], a[228:231], v[44:47], v[76:79]
  v_xor_b32 v12, 0x8000, v12
  v_mfma_f32_16x16x32_bf16 v[88:91], a[232:235], v[44:47], v[88:91]
  buffer_load_dwordx4 v[232:235], v21, s[4:7], s29 offen offset:2048 sc1
  v_mfma_f32_16x16x32_bf16 v[92:95], a[236:239], v[44:47], v[92:95]
  s_waitcnt lgkmcnt(1)
  v_xor_b32 v13, 0x8000, v13
  v_mfma_f32_16x16x32_bf16 v[64:67], a[240:243], v[48:51], v[64:67]
  v_mfma_f32_16x16x32_bf16 v[68:71], a[244:247], v[48:51], v[68:71]
  v_xor_b32 v14, 0x8000, v14
  v_mfma_f32_16x16x32_bf16 v[80:83], a[248:251], v[48:51], v[80:83]
  v_mfma_f32_16x16x32_bf16 v[84:87], a[252:255], v[48:51], v[84:87]
  s_waitcnt lgkmcnt(0)
  v_xor_b32 v15, 0x8000, v15
  v_mfma_f32_16x16x32_bf16 v[72:75], a[240:243], v[52:55], v[72:75]
  v_mfma_f32_16x16x32_bf16 v[76:79], a[244:247], v[52:55], v[76:79]
  v_xor_b32 v3, 0x8000, v3
  v_mfma_f32_16x16x32_bf16 v[88:91], a[248:251], v[52:55], v[88:91]
  buffer_load_dwordx4 v[236:239], v21, s[4:7], s29 offen offset:3072 sc1
  v_mfma_f32_16x16x32_bf16 v[92:95], a[252:255], v[52:55], v[92:95]
  s_cmp_gt_u32 s23, 0
  s_cbranch_scc1 F_top_196
  s_nop 2
  v_cvt_pk_bf16_f32 v128, v64, v65
  v_cvt_pk_bf16_f32 v129, v66, v67
  v_cvt_pk_bf16_f32 v130, v68, v69
  v_cvt_pk_bf16_f32 v131, v70, v71
  buffer_store_dwordx4 v[128:131], v22, s[4:7], s21 offen offset:0 sc1
  v_cvt_pk_bf16_f32 v132, v72, v73
  v_cvt_pk_bf16_f32 v133, v74, v75
  v_cvt_pk_bf16_f32 v134, v76, v77
  v_cvt_pk_bf16_f32 v135, v78, v79
  buffer_store_dwordx4 v[132:135], v22, s[4:7], s21 offen offset:256 sc1
  v_cvt_pk_bf16_f32 v136, v80, v81
  v_cvt_pk_bf16_f32 v137, v82, v83
  v_cvt_pk_bf16_f32 v138, v84, v85
  v_cvt_pk_bf16_f32 v139, v86, v87
  buffer_store_dwordx4 v[136:139], v22, s[4:7], s21 offen offset:2048 sc1
  v_cvt_pk_bf16_f32 v140, v88, v89
  v_cvt_pk_bf16_f32 v141, v90, v91
  v_cvt_pk_bf16_f32 v142, v92, v93
  v_cvt_pk_bf16_f32 v143, v94, v95
  buffer_store_dwordx4 v[140:143], v22, s[4:7], s21 offen offset:2304 sc1
  s_waitcnt vmcnt(0) lgkmcnt(0)
  s_barrier
  v_mov_b32 v144, s30
  v_min_u32 v145, 1, v0
  v_lshlrev_b32 v145, 30, v145
  buffer_store_dword v144, v145, s[4:7], s31 offen sc1
M_done:
M_exit:
  s_endpgm
.p2align 6
.type M_table,@object
M_table:
.long 0x1, 0x3f, 0xffffffff, 0x17, 0x1, 0x7, 0x800, 0x0, 0x8, 0x0, 0x0, 0x0, 0x0, 0x0, 0x0, 0x0
.long 0x1, 0x28, 0xffffffff, 0x1b, 0x1, 0x6, 0x1000, 0x0, 0x8, 0x1, 0x0, 0x0, 0x0, 0x0, 0x0, 0x0
.long 0x2, 0x0, 0x2, 0x20, 0x1, 0x5, 0x1800, 0x0, 0x8, 0x0, 0x0, 0x0, 0x0, 0x0, 0x0, 0x0
.long 0x2, 0x1, 0x2, 0x20, 0x1, 0x4, 0x2000, 0x0, 0x8, 0x1, 0x0, 0x0, 0x0, 0x0, 0x0, 0x0
.long 0x0, 0x0, 0x1, 0x20, 0x2, 0x3, 0x20, 0x0, 0x8, 0x2, 0x0, 0x0, 0x0, 0x0, 0x0, 0x0
.long 0x0, 0x3f, 0xffffffff, 0x20, 0x2, 0x2, 0x18, 0x1, 0x10, 0x0, 0x0, 0x0, 0x0, 0x0, 0x0, 0x0
.long 0x1, 0xd, 0xffffffff, 0xe, 0x0, 0x0, 0x8, 0x0, 0x8, 0x2, 0x0, 0x0, 0x0, 0x0, 0x0, 0x0
.size M_table, 448
.section .rodata,"a"
.p2align 6
.amdhsa_kernel gated_mix__compressed_kv_cla__memory_aug_recurrent_mem_tr__prompt_kernel
.amdhsa_next_free_vgpr 512
.amdhsa_next_free_sgpr 102
.amdhsa_accum_offset 256
.amdhsa_group_segment_fixed_size 0
.amdhsa_kernarg_size 136
.amdhsa_user_sgpr_count 2
.amdhsa_user_sgpr_kernarg_segment_ptr 1
.amdhsa_system_sgpr_workgroup_id_x 1
.end_amdhsa_kernel
```

```asm
; @launch grid=(256,1,1) block=(256,1,1) lds=163840
.amdgcn_target "amdgcn-amd-amdhsa--gfx950"
.text
.globl gated_mix__compressed_kv_cla__memory_aug_recurrent_mem_tr__prompt_kernel
.p2align 8
.type gated_mix__compressed_kv_cla__memory_aug_recurrent_mem_tr__prompt_kernel,@function
gated_mix__compressed_kv_cla__memory_aug_recurrent_mem_tr__prompt_kernel:
  s_cmp_ge_u32 s2, 256
  s_cbranch_scc1 M_exit
  s_getpc_b64 s[60:61]
M_pc0:
  s_lshr_b32 s62, s2, 3
  s_and_b32 s62, s62, 3
  s_lshl_b32 s62, s62, 15
  v_lshl_add_u32 v104, v0, 7, s62
  v_min_u32 v104, M_table-M_pc0, v104
  global_load_dword v105, v104, s[60:61]
  s_lshr_b32 s77, s2, 3
  s_and_b32 s76, s2, 7
  s_cbranch_scc1 M_worker
  s_mov_b32 s12, s77
  s_load_dwordx4 s[60:63], s[0:1], 64
  s_load_dwordx4 s[64:67], s[0:1], 80
  s_load_dwordx4 s[68:71], s[0:1], 120
  s_load_dwordx2 s[72:73], s[0:1], 56
  v_lshrrev_b32 v1, 6, v0
  v_and_b32 v20, 63, v0
  v_readfirstlane_b32 s13, v1
  v_lshrrev_b32 v26, 3, v20
  v_lshlrev_b32 v26, 10, v26
  v_and_b32 v1, 7, v20
  v_lshl_add_u32 v26, v1, 4, v26
  s_lshl_b32 s36, s13, 7
  s_lshl_b32 s38, s12, 17
  s_add_u32 s36, s36, s38
  v_add_u32 v26, s36, v26
  s_lshl_b32 s39, s13, 15
  s_add_u32 s39, s39, 32768
  s_waitcnt lgkmcnt(0)
  s_mov_b32 s48, s66
  s_and_b32 s49, s67, 0xffff
  s_mov_b32 s50, 0x400000
  s_mov_b32 s51, 0x20000
  s_xor_b32 s36, s13, 0
  s_lshl_b32 s36, s36, 15
  s_add_u32 m0, s39, 28672
  s_add_u32 s37, s36, 0
  buffer_load_dwordx4 v26, s[48:51], s37 offen lds
  s_add_u32 m0, s39, 29696
  s_add_u32 s37, s36, 8192
  buffer_load_dwordx4 v26, s[48:51], s37 offen lds
  s_add_u32 m0, s39, 30720
  s_add_u32 s37, s36, 16384
  buffer_load_dwordx4 v26, s[48:51], s37 offen lds
  s_add_u32 m0, s39, 31744
  s_add_u32 s37, s36, 24576
  buffer_load_dwordx4 v26, s[48:51], s37 offen lds
  s_xor_b32 s36, s13, 0
  s_lshl_b32 s36, s36, 15
  s_add_u32 m0, s39, 24576
  s_add_u32 s37, s36, 512
  buffer_load_dwordx4 v26, s[48:51], s37 offen lds
  s_add_u32 m0, s39, 25600
  s_add_u32 s37, s36, 8704
  buffer_load_dwordx4 v26, s[48:51], s37 offen lds
  s_add_u32 m0, s39, 26624
  s_add_u32 s37, s36, 16896
  buffer_load_dwordx4 v26, s[48:51], s37 offen lds
  s_add_u32 m0, s39, 27648
  s_add_u32 s37, s36, 25088
  buffer_load_dwordx4 v26, s[48:51], s37 offen lds
  s_xor_b32 s36, s13, 1
  s_lshl_b32 s36, s36, 15
  s_add_u32 m0, s39, 12288
  s_add_u32 s37, s36, 0
  buffer_load_dwordx4 v26, s[48:51], s37 offen lds
  s_add_u32 m0, s39, 13312
  s_add_u32 s37, s36, 8192
  buffer_load_dwordx4 v26, s[48:51], s37 offen lds
  s_add_u32 m0, s39, 14336
  s_add_u32 s37, s36, 16384
  buffer_load_dwordx4 v26, s[48:51], s37 offen lds
  s_add_u32 m0, s39, 15360
  s_add_u32 s37, s36, 24576
  buffer_load_dwordx4 v26, s[48:51], s37 offen lds
  s_xor_b32 s36, s13, 1
  s_lshl_b32 s36, s36, 15
  s_add_u32 m0, s39, 8192
  s_add_u32 s37, s36, 512
  buffer_load_dwordx4 v26, s[48:51], s37 offen lds
  s_add_u32 m0, s39, 9216
  s_add_u32 s37, s36, 8704
  buffer_load_dwordx4 v26, s[48:51], s37 offen lds
  s_add_u32 m0, s39, 10240
  s_add_u32 s37, s36, 16896
  buffer_load_dwordx4 v26, s[48:51], s37 offen lds
  s_add_u32 m0, s39, 11264
  s_add_u32 s37, s36, 25088
  buffer_load_dwordx4 v26, s[48:51], s37 offen lds
  s_mov_b32 s8, s60
  s_and_b32 s9, s61, 0xffff
  s_mov_b32 s10, 0x400000
  s_mov_b32 s11, 0x20000
  s_mov_b32 s40, s62
  s_and_b32 s41, s63, 0xffff
  s_mov_b32 s42, 0x400000
  s_mov_b32 s43, 0x20000
  s_mov_b32 s44, s64
  s_and_b32 s45, s65, 0xffff
  s_mov_b32 s46, 0x400000
  s_mov_b32 s47, 0x20000
  s_mov_b32 s4, s70
  s_and_b32 s5, s71, 0xffff
  s_mov_b32 s6, 0x10000000
  s_mov_b32 s7, 0x20000
  s_mov_b32 s76, s72
  s_and_b32 s77, s73, 0xffff
  s_mov_b32 s78, 0x2000
  s_mov_b32 s79, 0x20000
  s_mov_b32 s72, s68
  s_and_b32 s73, s69, 0xffff
  s_mov_b32 s74, 0x100
  s_mov_b32 s75, 0x20000
  s_mov_b64 s[52:53], s[68:69]
  s_mov_b64 s[58:59], s[70:71]
  s_mul_i32 s99, s12, 896
  s_add_u32 s99, s99, 148898048
  s_lshl_b32 s15, s12, 7
  s_add_u32 s15, s15, 148926464
  v_lshrrev_b32 v21, 4, v20
  v_and_b32 v22, 15, v20
  v_and_b32 v23, 1, v21
  v_lshrrev_b32 v24, 1, v21
  v_lshlrev_b32 v2, 4, v20
  s_lshl_b32 s36, s13, 10
  v_add_u32 v59, s36, v2
  s_mov_b32 s37, s39
  v_add_u32 v4, s37, v2
  v_lshrrev_b32 v25, 2, v20
  v_lshlrev_b32 v25, 13, v25
  v_and_b32 v1, 3, v20
  v_lshl_add_u32 v25, v1, 4, v25
  s_lshl_b32 s36, s13, 6
  s_lshl_b32 s38, s12, 8
  s_add_u32 s36, s36, s38
  v_add_u32 v25, s36, v25
  v_bfe_u32 v29, v20, 2, 1
  v_bfe_u32 v30, v20, 3, 1
  v_and_b32 v31, 3, v20
  v_lshl_add_u32 v27, v21, 2, v29
  v_lshlrev_b32 v27, 6, v27
  v_lshl_add_u32 v27, v30, 5, v27
  v_lshl_add_u32 v27, v31, 3, v27
  v_add_u32 v27, s37, v27
  v_xor_b32 v36, 1, v30
  v_lshl_add_u32 v36, v36, 11, v27
  v_lshl_add_u32 v27, v30, 11, v27
  v_lshl_add_u32 v28, v23, 2, v24
  v_lshl_add_u32 v28, v28, 2, v29
  v_lshlrev_b32 v28, 7, v28
  v_lshl_add_u32 v28, v30, 6, v28
  v_lshl_add_u32 v28, v31, 4, v28
  v_add_u32 v28, s37, v28
  v_lshrrev_b32 v25, 3, v20
  v_lshlrev_b32 v25, 13, v25
  v_and_b32 v1, 7, v20
  v_lshl_add_u32 v25, v1, 4, v25
  s_lshr_b32 s36, s13, 1
  s_lshl1_add_u32 s36, s12, s36
  s_lshl_b32 s36, s36, 7
  v_add_u32 v25, s36, v25
  v_lshl_add_u32 v27, v21, 2, v29
  v_lshlrev_b32 v27, 7, v27
  v_lshl_add_u32 v27, v30, 5, v27
  v_lshl_add_u32 v27, v31, 3, v27
  s_and_b32 s36, s13, 1
  s_lshl_b32 s36, s36, 6
  s_xor_b32 s37, s13, 1
  s_lshl_b32 s37, s37, 15
  s_add_u32 s37, s37, s36
  s_add_u32 s37, s37, 32768
  s_add_u32 s36, s36, s39
  v_add_u32 v36, s37, v27
  v_add_u32 v27, s36, v27
  v_lshlrev_b32 v101, 12, v30
  v_xor_b32 v100, 0x1000, v101
  v_mov_b32 v0, 0x4444
  v_mov_b32 v1, 0xeeee
  v_cmp_lt_u32 vcc, 7, v22
  s_nop 1
  v_cndmask_b32 v32, v0, v1, vcc
  v_mov_b32 v0, v32
  v_and_b32 v32, 7, v20
  v_lshlrev_b32 v32, 4, v32
  v_lshl_add_u32 v11, v21, 7, v32
  v_xor_b32 v1, 128, v2
  v_lshl_add_u32 v33, v24, 4, v22
  s_lshl_b32 s36, s13, 5
  v_add_u32 v33, s36, v33
  v_lshlrev_b32 v33, 3, v33
  v_mul_u32_u24 v34, 1152, v23
  v_add_u32 v5, v33, v34
  v_bfe_u32 v33, v20, 2, 2
  v_lshl_add_u32 v33, v23, 2, v33
  v_lshl_add_u32 v33, v24, 4, v33
  v_lshlrev_b32 v33, 3, v33
  v_and_b32 v34, 1, v20
  v_mul_u32_u24 v34, 1152, v34
  v_add_u32 v6, v33, v34
  s_lshl_b32 s36, s13, 3
  v_lshrrev_b32 v33, 3, v20
  v_add_u32 v33, s36, v33
  v_mul_u32_u24 v34, 0, v33
  v_add_u32 v34, s12, v34
  v_and_b32 v34, 31, v34
  v_lshrrev_b32 v37, 1, v32
  v_lshl_add_u32 v33, v33, 13, v37
  v_lshl_add_u32 v7, v34, 7, v33
  v_and_b32 v37, 1, v20
  v_bfe_u32 v38, v20, 1, 1
  v_lshl_add_u32 v37, v29, 1, v37
  s_lshr_b32 s36, s12, 3
  s_lshl_b32 s36, s36, 10
  s_and_b32 s37, s12, 1
  s_lshl_b32 s37, s37, 9
  s_add_u32 s36, s36, s37
  s_and_b32 s37, s12, 6
  s_lshl_b32 s37, s37, 5
  s_add_u32 s36, s36, s37
  v_lshlrev_b32 v33, 4, v21
  v_lshl_add_u32 v33, v37, 2, v33
  v_lshl_add_u32 v33, v38, 8, v33
  v_lshl_add_u32 v33, v30, 30, v33
  v_add_u32 v8, s36, v33
  v_mov_b32 v39, v21
  s_lshr_b32 s36, s12, 2
  s_lshl_b32 s36, s36, 6
  s_and_b32 s37, s12, 1
  s_lshl_b32 s37, s37, 5
  s_add_u32 s36, s36, s37
  s_and_b32 s37, s12, 2
  s_lshl_b32 s37, s37, 11
  s_add_u32 s36, s36, s37
  v_lshlrev_b32 v35, 10, v39
  v_lshl_add_u32 v35, v37, 2, v35
  v_lshl_add_u32 v35, v38, 4, v35
  v_add_u32 v35, s36, v35
  buffer_load_ushort v44, v35, s[76:79], 0 offen offset:0
  buffer_load_ushort v45, v35, s[76:79], 0 offen offset:2
  buffer_load_ushort v46, v35, s[76:79], 0 offen offset:512
  buffer_load_ushort v47, v35, s[76:79], 0 offen offset:514
  v_lshlrev_b32 v33, 4, v29
  v_mov_b32 v34, 0x3f80
  v_lshlrev_b32 v33, v33, v34
  v_and_b32 v34, 1, v20
  v_lshl_add_u32 v34, v34, 1, v30
  v_cmp_eq_u32 vcc, 0, v34
  s_nop 1
  v_cndmask_b32 v48, 0, v33, vcc
  v_cmp_eq_u32 vcc, 1, v34
  s_nop 1
  v_cndmask_b32 v49, 0, v33, vcc
  v_cmp_eq_u32 vcc, 2, v34
  s_nop 1
  v_cndmask_b32 v50, 0, v33, vcc
  v_cmp_eq_u32 vcc, 3, v34
  s_nop 1
  v_cndmask_b32 v51, 0, v33, vcc
  ds_write_b128 v2, v[48:51] offset:31232
  v_lshlrev_b32 v33, 9, v21
  s_lshl_b32 s36, s13, 11
  v_add_u32 v33, s36, v33
  v_lshl_add_u32 v10, v22, 4, v33
  v_lshl_add_u32 v33, v30, 8, v33
  v_add_u32 v9, v33, v32
  v_mov_b32 v12, 0x3f803f80
  v_mov_b32 v13, 0x3f803f80
  v_mov_b32 v14, 0x3f803f80
  v_mov_b32 v15, 0x3f803f80
  s_mov_b32 s2, 0x3f803f80
  s_mov_b32 s3, 0x3f803f80
  s_mov_b32 s98, 0
  v_and_b32 v33, 1, v20
  v_mul_u32_u24 v33, 128, v33
  v_min_u32 v34, 1, v20
  v_lshlrev_b32 v34, 30, v34
  s_cmp_eq_u32 s13, 3
  s_cselect_b64 vcc, -1, 0
  v_cndmask_b32 v19, v34, v33, vcc
  v_mov_b64 v[60:61], 0
  v_mov_b32 v62, 32256
  ds_write_b64 v62, v[60:61]
  s_mov_b32 s16, 0
  s_mov_b32 s17, -1
  s_mov_b32 s18, 0x3e0293ee
  s_mov_b32 s54, 0x2f800000
  s_mov_b32 s55, 0x28000000
  s_mov_b32 s96, s55
  s_lshl_b32 s36, s13, 10
  s_add_u32 s31, s36, 8192
  s_add_u32 s32, s36, 12160
  s_add_u32 s33, s36, 16384
  s_add_u32 s34, s36, 20224
  s_lshl_b32 s36, s12, 19
  s_add_u32 s27, s36, 67108864
  s_add_u32 s28, s36, 83886080
  s_mul_i32 s36, s12, 4096
  s_add_u32 s29, s36, 135266304
  s_lshl_b32 s36, s12, 13
  s_add_u32 s22, s36, 144703488
  s_add_u32 s23, s36, 144707584
  s_mov_b32 s20, 144703488
  s_mov_b32 s21, 144707584
  v_mov_b32 v40, -1
  v_mov_b32 v41, -1
  v_mov_b32 v42, -1
  v_mov_b32 v43, -1
  s_lshl_b32 s36, s13, 13
  s_add_u32 s36, s36, 145752064
  s_add_u32 s37, s36, 4096
  buffer_store_dwordx4 v[40:43], v59, s[4:7], s22 offen sc1
  buffer_store_dwordx4 v[40:43], v59, s[4:7], s23 offen sc1
  buffer_store_dword v40, v8, s[4:7], s36 offen sc1
  buffer_store_dword v40, v8, s[4:7], s37 offen sc1
  v_mov_b32 v52, 0
  v_min_u32 v53, 1, v59
  v_lshlrev_b32 v53, 30, v53
  buffer_store_dword v52, v53, s[4:7], s15 offen sc1
  s_waitcnt vmcnt(21)
  ds_read_b64_tr_b16 a[160:161], v28 offset:28672
  ds_read_b64_tr_b16 a[162:163], v28 offset:28928
  ds_read_b64_tr_b16 a[164:165], v28 offset:29696
  ds_read_b64_tr_b16 a[166:167], v28 offset:29952
  ds_read_b64_tr_b16 a[168:169], v28 offset:28680
  ds_read_b64_tr_b16 a[170:171], v28 offset:28936
  ds_read_b64_tr_b16 a[172:173], v28 offset:29704
  ds_read_b64_tr_b16 a[174:175], v28 offset:29960
  s_waitcnt lgkmcnt(0)
  s_waitcnt vmcnt(17)
  ds_read_b64_tr_b16 a[176:177], v28 offset:24576
  ds_read_b64_tr_b16 a[178:179], v28 offset:24832
  ds_read_b64_tr_b16 a[180:181], v28 offset:25600
  ds_read_b64_tr_b16 a[182:183], v28 offset:25856
  ds_read_b64_tr_b16 a[184:185], v28 offset:24584
  ds_read_b64_tr_b16 a[186:187], v28 offset:24840
  ds_read_b64_tr_b16 a[188:189], v28 offset:25608
  ds_read_b64_tr_b16 a[190:191], v28 offset:25864
  s_waitcnt lgkmcnt(0)
  s_xor_b32 s36, s13, 2
  s_lshl_b32 s36, s36, 15
  s_add_u32 m0, s39, 28672
  s_add_u32 s37, s36, 0
  buffer_load_dwordx4 v26, s[48:51], s37 offen lds
  s_add_u32 m0, s39, 29696
  s_add_u32 s37, s36, 8192
  buffer_load_dwordx4 v26, s[48:51], s37 offen lds
  s_add_u32 m0, s39, 30720
  s_add_u32 s37, s36, 16384
  buffer_load_dwordx4 v26, s[48:51], s37 offen lds
  s_add_u32 m0, s39, 31744
  s_add_u32 s37, s36, 24576
  buffer_load_dwordx4 v26, s[48:51], s37 offen lds
  s_xor_b32 s36, s13, 3
  s_lshl_b32 s36, s36, 15
  s_add_u32 m0, s39, 24576
  s_add_u32 s37, s36, 0
  buffer_load_dwordx4 v26, s[48:51], s37 offen lds
  s_add_u32 m0, s39, 25600
  s_add_u32 s37, s36, 8192
  buffer_load_dwordx4 v26, s[48:51], s37 offen lds
  s_add_u32 m0, s39, 26624
  s_add_u32 s37, s36, 16384
  buffer_load_dwordx4 v26, s[48:51], s37 offen lds
  s_add_u32 m0, s39, 27648
  s_add_u32 s37, s36, 24576
  buffer_load_dwordx4 v26, s[48:51], s37 offen lds
  s_waitcnt vmcnt(21)
  ds_read_b64_tr_b16 a[192:193], v28 offset:12288
  ds_read_b64_tr_b16 a[194:195], v28 offset:12544
  ds_read_b64_tr_b16 a[196:197], v28 offset:13312
  ds_read_b64_tr_b16 a[198:199], v28 offset:13568
  ds_read_b64_tr_b16 a[200:201], v28 offset:12296
  ds_read_b64_tr_b16 a[202:203], v28 offset:12552
  ds_read_b64_tr_b16 a[204:205], v28 offset:13320
  ds_read_b64_tr_b16 a[206:207], v28 offset:13576
  s_waitcnt lgkmcnt(0)
  s_waitcnt vmcnt(17)
  ds_read_b64_tr_b16 a[208:209], v28 offset:8192
  ds_read_b64_tr_b16 a[210:211], v28 offset:8448
  ds_read_b64_tr_b16 a[212:213], v28 offset:9216
  ds_read_b64_tr_b16 a[214:215], v28 offset:9472
  ds_read_b64_tr_b16 a[216:217], v28 offset:8200
  ds_read_b64_tr_b16 a[218:219], v28 offset:8456
  ds_read_b64_tr_b16 a[220:221], v28 offset:9224
  ds_read_b64_tr_b16 a[222:223], v28 offset:9480
  s_waitcnt lgkmcnt(0)
  s_xor_b32 s36, s13, 2
  s_lshl_b32 s36, s36, 19
  s_add_u32 m0, s39, 12288
  s_add_u32 s37, s36, 0
  buffer_load_dwordx4 v25, s[8:11], s37 offen lds
  s_add_u32 m0, s39, 13312
  s_add_u32 s37, s36, 65536
  buffer_load_dwordx4 v25, s[8:11], s37 offen lds
  s_add_u32 m0, s39, 14336
  s_add_u32 s37, s36, 131072
  buffer_load_dwordx4 v25, s[8:11], s37 offen lds
  s_add_u32 m0, s39, 15360
  s_add_u32 s37, s36, 196608
  buffer_load_dwordx4 v25, s[8:11], s37 offen lds
  s_xor_b32 s36, s13, 2
  s_lshl_b32 s36, s36, 19
  s_add_u32 m0, s39, 8192
  s_add_u32 s37, s36, 262144
  buffer_load_dwordx4 v25, s[8:11], s37 offen lds
  s_add_u32 m0, s39, 9216
  s_add_u32 s37, s36, 327680
  buffer_load_dwordx4 v25, s[8:11], s37 offen lds
  s_add_u32 m0, s39, 10240
  s_add_u32 s37, s36, 393216
  buffer_load_dwordx4 v25, s[8:11], s37 offen lds
  s_add_u32 m0, s39, 11264
  s_add_u32 s37, s36, 458752
  buffer_load_dwordx4 v25, s[8:11], s37 offen lds
  s_waitcnt vmcnt(12)
  ds_read_b64_tr_b16 a[224:225], v28 offset:28672
  ds_read_b64_tr_b16 a[226:227], v28 offset:28928
  ds_read_b64_tr_b16 a[228:229], v28 offset:29696
  ds_read_b64_tr_b16 a[230:231], v28 offset:29952
  ds_read_b64_tr_b16 a[232:233], v28 offset:28680
  ds_read_b64_tr_b16 a[234:235], v28 offset:28936
  ds_read_b64_tr_b16 a[236:237], v28 offset:29704
  ds_read_b64_tr_b16 a[238:239], v28 offset:29960
  s_waitcnt lgkmcnt(0)
  s_waitcnt vmcnt(8)
  ds_read_b64_tr_b16 a[240:241], v28 offset:24576
  ds_read_b64_tr_b16 a[242:243], v28 offset:24832
  ds_read_b64_tr_b16 a[244:245], v28 offset:25600
  ds_read_b64_tr_b16 a[246:247], v28 offset:25856
  ds_read_b64_tr_b16 a[248:249], v28 offset:24584
  ds_read_b64_tr_b16 a[250:251], v28 offset:24840
  ds_read_b64_tr_b16 a[252:253], v28 offset:25608
  ds_read_b64_tr_b16 a[254:255], v28 offset:25864
  s_waitcnt lgkmcnt(0)
  s_xor_b32 s36, s13, 4
  s_lshl_b32 s36, s36, 19
  s_add_u32 m0, s39, 28672
  s_add_u32 s37, s36, 0
  buffer_load_dwordx4 v25, s[8:11], s37 offen lds
  s_add_u32 m0, s39, 29696
  s_add_u32 s37, s36, 65536
  buffer_load_dwordx4 v25, s[8:11], s37 offen lds
  s_add_u32 m0, s39, 30720
  s_add_u32 s37, s36, 131072
  buffer_load_dwordx4 v25, s[8:11], s37 offen lds
  s_add_u32 m0, s39, 31744
  s_add_u32 s37, s36, 196608
  buffer_load_dwordx4 v25, s[8:11], s37 offen lds
  s_xor_b32 s36, s13, 4
  s_lshl_b32 s36, s36, 19
  s_add_u32 m0, s39, 24576
  s_add_u32 s37, s36, 262144
  buffer_load_dwordx4 v25, s[8:11], s37 offen lds
  s_add_u32 m0, s39, 25600
  s_add_u32 s37, s36, 327680
  buffer_load_dwordx4 v25, s[8:11], s37 offen lds
  s_add_u32 m0, s39, 26624
  s_add_u32 s37, s36, 393216
  buffer_load_dwordx4 v25, s[8:11], s37 offen lds
  s_add_u32 m0, s39, 27648
  s_add_u32 s37, s36, 458752
  buffer_load_dwordx4 v25, s[8:11], s37 offen lds
  s_barrier
  s_cmp_lg_u32 s13, 0
  s_cbranch_scc1 T_arm_1
  s_getreg_b32 s36, hwreg(HW_REG_XCC_ID, 0, 3)
  s_lshl_b32 s36, s36, 3
  s_lshl_b64 s[60:61], 1, s36
  s_mov_b32 s62, 1
  s_atomic_add_x2 s[60:61], s[52:53], 0
  s_atomic_add s62, s[52:53], 128
  v_lshl_or_b32 v44, v45, 16, v44
  v_lshl_or_b32 v46, v47, 16, v46
  v_min_u32 v44, -2, v44
  v_min_u32 v46, -2, v46
  s_mov_b32 s36, 145752064
  s_mov_b32 s37, 145756160
  buffer_store_dword v44, v8, s[4:7], s36 offen sc1
  buffer_store_dword v46, v8, s[4:7], s37 offen sc1
T_arm_1:
  v_mad_u32_u24 v96, v100, 1, v27
  v_mad_u32_u24 v97, v101, 1, v27
  v_mad_u32_u24 v98, v100, 1, v36
  v_mad_u32_u24 v99, v101, 1, v36
  s_waitcnt vmcnt(8)
  s_barrier
  ds_read_b64_tr_b16 v[160:161], v96 offset:8192
  ds_read_b64_tr_b16 v[162:163], v96 offset:8448
  ds_read_b64_tr_b16 v[164:165], v96 offset:10240
  ds_read_b64_tr_b16 v[166:167], v96 offset:10496
  ds_read_b64_tr_b16 v[168:169], v97 offset:8192
  ds_read_b64_tr_b16 v[170:171], v97 offset:8448
  ds_read_b64_tr_b16 v[172:173], v97 offset:10240
  ds_read_b64_tr_b16 v[174:175], v97 offset:10496
  ds_read_b64_tr_b16 v[192:193], v98 offset:8192
  ds_read_b64_tr_b16 v[194:195], v98 offset:8448
  ds_read_b64_tr_b16 v[196:197], v98 offset:10240
  ds_read_b64_tr_b16 v[198:199], v98 offset:10496
  ds_read_b64_tr_b16 v[200:201], v99 offset:8192
  ds_read_b64_tr_b16 v[202:203], v99 offset:8448
  ds_read_b64_tr_b16 v[204:205], v99 offset:10240
  ds_read_b64_tr_b16 v[206:207], v99 offset:10496
  s_waitcnt lgkmcnt(0)
  s_barrier
  s_xor_b32 s36, s13, 4
  s_lshl_b32 s36, s36, 19
  s_add_u32 m0, s39, 12288
  s_add_u32 s37, s36, 0
  buffer_load_dwordx4 v25, s[40:43], s37 offen lds
  s_add_u32 m0, s39, 13312
  s_add_u32 s37, s36, 65536
  buffer_load_dwordx4 v25, s[40:43], s37 offen lds
  s_add_u32 m0, s39, 14336
  s_add_u32 s37, s36, 131072
  buffer_load_dwordx4 v25, s[40:43], s37 offen lds
  s_add_u32 m0, s39, 15360
  s_add_u32 s37, s36, 196608
  buffer_load_dwordx4 v25, s[40:43], s37 offen lds
  s_xor_b32 s36, s13, 4
  s_lshl_b32 s36, s36, 19
  s_add_u32 m0, s39, 8192
  s_add_u32 s37, s36, 262144
  buffer_load_dwordx4 v25, s[40:43], s37 offen lds
  s_add_u32 m0, s39, 9216
  s_add_u32 s37, s36, 327680
  buffer_load_dwordx4 v25, s[40:43], s37 offen lds
  s_add_u32 m0, s39, 10240
  s_add_u32 s37, s36, 393216
  buffer_load_dwordx4 v25, s[40:43], s37 offen lds
  s_add_u32 m0, s39, 11264
  s_add_u32 s37, s36, 458752
  buffer_load_dwordx4 v25, s[40:43], s37 offen lds
  v_mad_u32_u24 v96, v100, 1, v27
  v_mad_u32_u24 v97, v101, 1, v27
  v_mad_u32_u24 v98, v100, 1, v36
  v_mad_u32_u24 v99, v101, 1, v36
  s_waitcnt vmcnt(8)
  s_barrier
  ds_read_b64_tr_b16 v[224:225], v96 offset:24576
  ds_read_b64_tr_b16 v[226:227], v96 offset:24832
  ds_read_b64_tr_b16 v[228:229], v96 offset:26624
  ds_read_b64_tr_b16 v[230:231], v96 offset:26880
  ds_read_b64_tr_b16 v[232:233], v97 offset:24576
  ds_read_b64_tr_b16 v[234:235], v97 offset:24832
  ds_read_b64_tr_b16 v[236:237], v97 offset:26624
  ds_read_b64_tr_b16 v[238:239], v97 offset:26880
  ds_read_b64_tr_b16 a[16:17], v98 offset:24576
  ds_read_b64_tr_b16 a[18:19], v98 offset:24832
  ds_read_b64_tr_b16 a[20:21], v98 offset:26624
  ds_read_b64_tr_b16 a[22:23], v98 offset:26880
  ds_read_b64_tr_b16 a[24:25], v99 offset:24576
  ds_read_b64_tr_b16 a[26:27], v99 offset:24832
  ds_read_b64_tr_b16 a[28:29], v99 offset:26624
  ds_read_b64_tr_b16 a[30:31], v99 offset:26880
  s_waitcnt lgkmcnt(0)
  s_barrier
  s_xor_b32 s36, s13, 4
  s_lshl_b32 s36, s36, 19
  s_add_u32 m0, s39, 28672
  s_add_u32 s37, s36, 0
  buffer_load_dwordx4 v25, s[44:47], s37 offen lds
  s_add_u32 m0, s39, 29696
  s_add_u32 s37, s36, 65536
  buffer_load_dwordx4 v25, s[44:47], s37 offen lds
  s_add_u32 m0, s39, 30720
  s_add_u32 s37, s36, 131072
  buffer_load_dwordx4 v25, s[44:47], s37 offen lds
  s_add_u32 m0, s39, 31744
  s_add_u32 s37, s36, 196608
  buffer_load_dwordx4 v25, s[44:47], s37 offen lds
  s_xor_b32 s36, s13, 4
  s_lshl_b32 s36, s36, 19
  s_add_u32 m0, s39, 24576
  s_add_u32 s37, s36, 262144
  buffer_load_dwordx4 v25, s[44:47], s37 offen lds
  s_add_u32 m0, s39, 25600
  s_add_u32 s37, s36, 327680
  buffer_load_dwordx4 v25, s[44:47], s37 offen lds
  s_add_u32 m0, s39, 26624
  s_add_u32 s37, s36, 393216
  buffer_load_dwordx4 v25, s[44:47], s37 offen lds
  s_add_u32 m0, s39, 27648
  s_add_u32 s37, s36, 458752
  buffer_load_dwordx4 v25, s[44:47], s37 offen lds
  v_mad_u32_u24 v96, v100, 1, v27
  v_mad_u32_u24 v97, v101, 1, v27
  v_mad_u32_u24 v98, v100, 1, v36
  v_mad_u32_u24 v99, v101, 1, v36
  s_waitcnt vmcnt(8)
  s_barrier
  ds_read_b64_tr_b16 v[240:241], v96 offset:8192
  ds_read_b64_tr_b16 v[242:243], v96 offset:8448
  ds_read_b64_tr_b16 v[244:245], v96 offset:10240
  ds_read_b64_tr_b16 v[246:247], v96 offset:10496
  ds_read_b64_tr_b16 v[248:249], v97 offset:8192
  ds_read_b64_tr_b16 v[250:251], v97 offset:8448
  ds_read_b64_tr_b16 v[252:253], v97 offset:10240
  ds_read_b64_tr_b16 v[254:255], v97 offset:10496
  ds_read_b64_tr_b16 a[32:33], v98 offset:8192
  ds_read_b64_tr_b16 a[34:35], v98 offset:8448
  ds_read_b64_tr_b16 a[36:37], v98 offset:10240
  ds_read_b64_tr_b16 a[38:39], v98 offset:10496
  ds_read_b64_tr_b16 a[40:41], v99 offset:8192
  ds_read_b64_tr_b16 a[42:43], v99 offset:8448
  ds_read_b64_tr_b16 a[44:45], v99 offset:10240
  ds_read_b64_tr_b16 a[46:47], v99 offset:10496
  s_waitcnt lgkmcnt(0)
  s_barrier
  s_xor_b32 s36, s13, 6
  s_lshl_b32 s36, s36, 19
  s_add_u32 m0, s39, 12288
  s_add_u32 s37, s36, 0
  buffer_load_dwordx4 v25, s[8:11], s37 offen lds
  s_add_u32 m0, s39, 13312
  s_add_u32 s37, s36, 65536
  buffer_load_dwordx4 v25, s[8:11], s37 offen lds
  s_add_u32 m0, s39, 14336
  s_add_u32 s37, s36, 131072
  buffer_load_dwordx4 v25, s[8:11], s37 offen lds
  s_add_u32 m0, s39, 15360
  s_add_u32 s37, s36, 196608
  buffer_load_dwordx4 v25, s[8:11], s37 offen lds
  s_xor_b32 s36, s13, 6
  s_lshl_b32 s36, s36, 19
  s_add_u32 m0, s39, 8192
  s_add_u32 s37, s36, 262144
  buffer_load_dwordx4 v25, s[8:11], s37 offen lds
  s_add_u32 m0, s39, 9216
  s_add_u32 s37, s36, 327680
  buffer_load_dwordx4 v25, s[8:11], s37 offen lds
  s_add_u32 m0, s39, 10240
  s_add_u32 s37, s36, 393216
  buffer_load_dwordx4 v25, s[8:11], s37 offen lds
  s_add_u32 m0, s39, 11264
  s_add_u32 s37, s36, 458752
  buffer_load_dwordx4 v25, s[8:11], s37 offen lds
  v_mad_u32_u24 v96, v100, 1, v27
  v_mad_u32_u24 v97, v101, 1, v27
  v_mad_u32_u24 v98, v100, 1, v36
  v_mad_u32_u24 v99, v101, 1, v36
  s_waitcnt vmcnt(8)
  s_barrier
  ds_read_b64_tr_b16 a[0:1], v96 offset:24576
  ds_read_b64_tr_b16 a[2:3], v96 offset:24832
  ds_read_b64_tr_b16 a[4:5], v96 offset:26624
  ds_read_b64_tr_b16 a[6:7], v96 offset:26880
  ds_read_b64_tr_b16 a[8:9], v97 offset:24576
  ds_read_b64_tr_b16 a[10:11], v97 offset:24832
  ds_read_b64_tr_b16 a[12:13], v97 offset:26624
  ds_read_b64_tr_b16 a[14:15], v97 offset:26880
  ds_read_b64_tr_b16 a[48:49], v98 offset:24576
  ds_read_b64_tr_b16 a[50:51], v98 offset:24832
  ds_read_b64_tr_b16 a[52:53], v98 offset:26624
  ds_read_b64_tr_b16 a[54:55], v98 offset:26880
  ds_read_b64_tr_b16 a[56:57], v99 offset:24576
  ds_read_b64_tr_b16 a[58:59], v99 offset:24832
  ds_read_b64_tr_b16 a[60:61], v99 offset:26624
  ds_read_b64_tr_b16 a[62:63], v99 offset:26880
  s_waitcnt lgkmcnt(0)
  s_barrier
  s_xor_b32 s36, s13, 6
  s_lshl_b32 s36, s36, 19
  s_add_u32 m0, s39, 28672
  s_add_u32 s37, s36, 0
  buffer_load_dwordx4 v25, s[40:43], s37 offen lds
  s_add_u32 m0, s39, 29696
  s_add_u32 s37, s36, 65536
  buffer_load_dwordx4 v25, s[40:43], s37 offen lds
  s_add_u32 m0, s39, 30720
  s_add_u32 s37, s36, 131072
  buffer_load_dwordx4 v25, s[40:43], s37 offen lds
  s_add_u32 m0, s39, 31744
  s_add_u32 s37, s36, 196608
  buffer_load_dwordx4 v25, s[40:43], s37 offen lds
  s_xor_b32 s36, s13, 6
  s_lshl_b32 s36, s36, 19
  s_add_u32 m0, s39, 24576
  s_add_u32 s37, s36, 262144
  buffer_load_dwordx4 v25, s[40:43], s37 offen lds
  s_add_u32 m0, s39, 25600
  s_add_u32 s37, s36, 327680
  buffer_load_dwordx4 v25, s[40:43], s37 offen lds
  s_add_u32 m0, s39, 26624
  s_add_u32 s37, s36, 393216
  buffer_load_dwordx4 v25, s[40:43], s37 offen lds
  s_add_u32 m0, s39, 27648
  s_add_u32 s37, s36, 458752
  buffer_load_dwordx4 v25, s[40:43], s37 offen lds
  v_mad_u32_u24 v96, v100, 1, v27
  v_mad_u32_u24 v97, v101, 1, v27
  v_mad_u32_u24 v98, v100, 1, v36
  v_mad_u32_u24 v99, v101, 1, v36
  s_waitcnt vmcnt(8)
  s_barrier
  ds_read_b64_tr_b16 a[64:65], v96 offset:8192
  ds_read_b64_tr_b16 a[66:67], v96 offset:8448
  ds_read_b64_tr_b16 a[68:69], v96 offset:10240
  ds_read_b64_tr_b16 a[70:71], v96 offset:10496
  ds_read_b64_tr_b16 a[72:73], v97 offset:8192
  ds_read_b64_tr_b16 a[74:75], v97 offset:8448
  ds_read_b64_tr_b16 a[76:77], v97 offset:10240
  ds_read_b64_tr_b16 a[78:79], v97 offset:10496
  ds_read_b64_tr_b16 a[112:113], v98 offset:8192
  ds_read_b64_tr_b16 a[114:115], v98 offset:8448
  ds_read_b64_tr_b16 a[116:117], v98 offset:10240
  ds_read_b64_tr_b16 a[118:119], v98 offset:10496
  ds_read_b64_tr_b16 a[120:121], v99 offset:8192
  ds_read_b64_tr_b16 a[122:123], v99 offset:8448
  ds_read_b64_tr_b16 a[124:125], v99 offset:10240
  ds_read_b64_tr_b16 a[126:127], v99 offset:10496
  s_waitcnt lgkmcnt(0)
  s_barrier
  s_xor_b32 s36, s13, 6
  s_lshl_b32 s36, s36, 19
  s_add_u32 m0, s39, 12288
  s_add_u32 s37, s36, 0
  buffer_load_dwordx4 v25, s[44:47], s37 offen lds
  s_add_u32 m0, s39, 13312
  s_add_u32 s37, s36, 65536
  buffer_load_dwordx4 v25, s[44:47], s37 offen lds
  s_add_u32 m0, s39, 14336
  s_add_u32 s37, s36, 131072
  buffer_load_dwordx4 v25, s[44:47], s37 offen lds
  s_add_u32 m0, s39, 15360
  s_add_u32 s37, s36, 196608
  buffer_load_dwordx4 v25, s[44:47], s37 offen lds
  s_xor_b32 s36, s13, 6
  s_lshl_b32 s36, s36, 19
  s_add_u32 m0, s39, 8192
  s_add_u32 s37, s36, 262144
  buffer_load_dwordx4 v25, s[44:47], s37 offen lds
  s_add_u32 m0, s39, 9216
  s_add_u32 s37, s36, 327680
  buffer_load_dwordx4 v25, s[44:47], s37 offen lds
  s_add_u32 m0, s39, 10240
  s_add_u32 s37, s36, 393216
  buffer_load_dwordx4 v25, s[44:47], s37 offen lds
  s_add_u32 m0, s39, 11264
  s_add_u32 s37, s36, 458752
  buffer_load_dwordx4 v25, s[44:47], s37 offen lds
  v_mad_u32_u24 v96, v100, 1, v27
  v_mad_u32_u24 v97, v101, 1, v27
  v_mad_u32_u24 v98, v100, 1, v36
  v_mad_u32_u24 v99, v101, 1, v36
  s_waitcnt vmcnt(8)
  s_barrier
  ds_read_b64_tr_b16 a[80:81], v96 offset:24576
  ds_read_b64_tr_b16 a[82:83], v96 offset:24832
  ds_read_b64_tr_b16 a[84:85], v96 offset:26624
  ds_read_b64_tr_b16 a[86:87], v96 offset:26880
  ds_read_b64_tr_b16 a[88:89], v97 offset:24576
  ds_read_b64_tr_b16 a[90:91], v97 offset:24832
  ds_read_b64_tr_b16 a[92:93], v97 offset:26624
  ds_read_b64_tr_b16 a[94:95], v97 offset:26880
  ds_read_b64_tr_b16 a[128:129], v98 offset:24576
  ds_read_b64_tr_b16 a[130:131], v98 offset:24832
  ds_read_b64_tr_b16 a[132:133], v98 offset:26624
  ds_read_b64_tr_b16 a[134:135], v98 offset:26880
  ds_read_b64_tr_b16 a[136:137], v99 offset:24576
  ds_read_b64_tr_b16 a[138:139], v99 offset:24832
  ds_read_b64_tr_b16 a[140:141], v99 offset:26624
  ds_read_b64_tr_b16 a[142:143], v99 offset:26880
  s_waitcnt lgkmcnt(0)
  s_barrier
  s_xor_b32 s36, s13, 0
  s_lshl_b32 s36, s36, 19
  s_add_u32 m0, s39, 28672
  s_add_u32 s37, s36, 0
  buffer_load_dwordx4 v25, s[8:11], s37 offen lds
  s_add_u32 m0, s39, 29696
  s_add_u32 s37, s36, 65536
  buffer_load_dwordx4 v25, s[8:11], s37 offen lds
  s_add_u32 m0, s39, 30720
  s_add_u32 s37, s36, 131072
  buffer_load_dwordx4 v25, s[8:11], s37 offen lds
  s_add_u32 m0, s39, 31744
  s_add_u32 s37, s36, 196608
  buffer_load_dwordx4 v25, s[8:11], s37 offen lds
  s_xor_b32 s36, s13, 0
  s_lshl_b32 s36, s36, 19
  s_add_u32 m0, s39, 0
  s_add_u32 s37, s36, 262144
  buffer_load_dwordx4 v25, s[8:11], s37 offen lds
  s_add_u32 m0, s39, 1024
  s_add_u32 s37, s36, 327680
  buffer_load_dwordx4 v25, s[8:11], s37 offen lds
  s_add_u32 m0, s39, 2048
  s_add_u32 s37, s36, 393216
  buffer_load_dwordx4 v25, s[8:11], s37 offen lds
  s_add_u32 m0, s39, 3072
  s_add_u32 s37, s36, 458752
  buffer_load_dwordx4 v25, s[8:11], s37 offen lds
  v_mad_u32_u24 v96, v100, 1, v27
  v_mad_u32_u24 v97, v101, 1, v27
  v_mad_u32_u24 v98, v100, 1, v36
  v_mad_u32_u24 v99, v101, 1, v36
  s_waitcnt vmcnt(8)
  s_barrier
  ds_read_b64_tr_b16 a[96:97], v96 offset:8192
  ds_read_b64_tr_b16 a[98:99], v96 offset:8448
  ds_read_b64_tr_b16 a[100:101], v96 offset:10240
  ds_read_b64_tr_b16 a[102:103], v96 offset:10496
  ds_read_b64_tr_b16 a[104:105], v97 offset:8192
  ds_read_b64_tr_b16 a[106:107], v97 offset:8448
  ds_read_b64_tr_b16 a[108:109], v97 offset:10240
  ds_read_b64_tr_b16 a[110:111], v97 offset:10496
  ds_read_b64_tr_b16 a[144:145], v98 offset:8192
  ds_read_b64_tr_b16 a[146:147], v98 offset:8448
  ds_read_b64_tr_b16 a[148:149], v98 offset:10240
  ds_read_b64_tr_b16 a[150:151], v98 offset:10496
  ds_read_b64_tr_b16 a[152:153], v99 offset:8192
  ds_read_b64_tr_b16 a[154:155], v99 offset:8448
  ds_read_b64_tr_b16 a[156:157], v99 offset:10240
  ds_read_b64_tr_b16 a[158:159], v99 offset:10496
  s_waitcnt lgkmcnt(0)
  s_barrier
  s_xor_b32 s36, s13, 0
  s_lshl_b32 s36, s36, 19
  s_add_u32 m0, s39, 24576
  s_add_u32 s37, s36, 0
  buffer_load_dwordx4 v25, s[40:43], s37 offen lds
  s_add_u32 m0, s39, 25600
  s_add_u32 s37, s36, 65536
  buffer_load_dwordx4 v25, s[40:43], s37 offen lds
  s_add_u32 m0, s39, 26624
  s_add_u32 s37, s36, 131072
  buffer_load_dwordx4 v25, s[40:43], s37 offen lds
  s_add_u32 m0, s39, 27648
  s_add_u32 s37, s36, 196608
  buffer_load_dwordx4 v25, s[40:43], s37 offen lds
  s_xor_b32 s36, s13, 0
  s_lshl_b32 s36, s36, 19
  s_add_u32 m0, s39, 4096
  s_add_u32 s37, s36, 262144
  buffer_load_dwordx4 v25, s[40:43], s37 offen lds
  s_add_u32 m0, s39, 5120
  s_add_u32 s37, s36, 327680
  buffer_load_dwordx4 v25, s[40:43], s37 offen lds
  s_add_u32 m0, s39, 6144
  s_add_u32 s37, s36, 393216
  buffer_load_dwordx4 v25, s[40:43], s37 offen lds
  s_add_u32 m0, s39, 7168
  s_add_u32 s37, s36, 458752
  buffer_load_dwordx4 v25, s[40:43], s37 offen lds
  v_mad_u32_u24 v96, v100, 7, v27
  v_mad_u32_u24 v97, v101, 7, v27
  v_mad_u32_u24 v98, v100, 7, v36
  v_mad_u32_u24 v99, v101, 7, v36
  s_waitcnt vmcnt(8)
  s_barrier
  ds_read_b64_tr_b16 v[128:129], v98 offset:0
  ds_read_b64_tr_b16 v[130:131], v98 offset:256
  ds_read_b64_tr_b16 v[132:133], v98 offset:2048
  ds_read_b64_tr_b16 v[134:135], v98 offset:2304
  ds_read_b64_tr_b16 v[136:137], v99 offset:0
  ds_read_b64_tr_b16 v[138:139], v99 offset:256
  ds_read_b64_tr_b16 v[140:141], v99 offset:2048
  ds_read_b64_tr_b16 v[142:143], v99 offset:2304
  ds_read_b64_tr_b16 v[64:65], v96 offset:0
  ds_read_b64_tr_b16 v[66:67], v96 offset:256
  ds_read_b64_tr_b16 v[68:69], v96 offset:2048
  ds_read_b64_tr_b16 v[70:71], v96 offset:2304
  ds_read_b64_tr_b16 v[72:73], v97 offset:0
  ds_read_b64_tr_b16 v[74:75], v97 offset:256
  ds_read_b64_tr_b16 v[76:77], v97 offset:2048
  ds_read_b64_tr_b16 v[78:79], v97 offset:2304
  s_waitcnt lgkmcnt(0)
  s_barrier
  ds_write_b128 v4, v[64:67] offset:0
  ds_write_b128 v4, v[68:71] offset:1024
  ds_write_b128 v4, v[72:75] offset:2048
  ds_write_b128 v4, v[76:79] offset:3072
  s_xor_b32 s36, s13, 2
  s_lshl_b32 s36, s36, 19
  s_add_u32 m0, s39, 28672
  s_add_u32 s37, s36, 0
  buffer_load_dwordx4 v25, s[40:43], s37 offen lds
  s_add_u32 m0, s39, 29696
  s_add_u32 s37, s36, 65536
  buffer_load_dwordx4 v25, s[40:43], s37 offen lds
  s_add_u32 m0, s39, 30720
  s_add_u32 s37, s36, 131072
  buffer_load_dwordx4 v25, s[40:43], s37 offen lds
  s_add_u32 m0, s39, 31744
  s_add_u32 s37, s36, 196608
  buffer_load_dwordx4 v25, s[40:43], s37 offen lds
  s_xor_b32 s36, s13, 2
  s_lshl_b32 s36, s36, 19
  s_add_u32 m0, s39, 16384
  s_add_u32 s37, s36, 262144
  buffer_load_dwordx4 v25, s[40:43], s37 offen lds
  s_add_u32 m0, s39, 17408
  s_add_u32 s37, s36, 327680
  buffer_load_dwordx4 v25, s[40:43], s37 offen lds
  s_add_u32 m0, s39, 18432
  s_add_u32 s37, s36, 393216
  buffer_load_dwordx4 v25, s[40:43], s37 offen lds
  s_add_u32 m0, s39, 19456
  s_add_u32 s37, s36, 458752
  buffer_load_dwordx4 v25, s[40:43], s37 offen lds
  s_getpc_b64 s[60:61]
T_pc_2:
  s_add_u32 s60, s60, T_code-T_pc_2
  s_addc_u32 s61, s61, 0
  v_lshlrev_b32 v102, 3, v59
  v_min_u32 v102, 12800, v102
  global_load_dword v103, v102, s[60:61]
  buffer_load_dwordx2 v[54:55], off, s[72:75], 0 sc1
  buffer_load_dword v56, off, s[72:75], 0 offset:128 sc1
  v_mad_u32_u24 v96, v100, 5, v27
  v_mad_u32_u24 v97, v101, 5, v27
  v_mad_u32_u24 v98, v100, 5, v36
  v_mad_u32_u24 v99, v101, 5, v36
  s_waitcnt vmcnt(11)
  s_barrier
  ds_read_b64_tr_b16 v[144:145], v98 offset:4096
  ds_read_b64_tr_b16 v[146:147], v98 offset:4352
  ds_read_b64_tr_b16 v[148:149], v98 offset:6144
  ds_read_b64_tr_b16 v[150:151], v98 offset:6400
  ds_read_b64_tr_b16 v[152:153], v99 offset:4096
  ds_read_b64_tr_b16 v[154:155], v99 offset:4352
  ds_read_b64_tr_b16 v[156:157], v99 offset:6144
  ds_read_b64_tr_b16 v[158:159], v99 offset:6400
  ds_read_b64_tr_b16 v[64:65], v96 offset:4096
  ds_read_b64_tr_b16 v[66:67], v96 offset:4352
  ds_read_b64_tr_b16 v[68:69], v96 offset:6144
  ds_read_b64_tr_b16 v[70:71], v96 offset:6400
  ds_read_b64_tr_b16 v[72:73], v97 offset:4096
  ds_read_b64_tr_b16 v[74:75], v97 offset:4352
  ds_read_b64_tr_b16 v[76:77], v97 offset:6144
  ds_read_b64_tr_b16 v[78:79], v97 offset:6400
  s_waitcnt lgkmcnt(0)
  s_barrier
  ds_write_b128 v4, v[64:67] offset:4096
  ds_write_b128 v4, v[68:71] offset:5120
  ds_write_b128 v4, v[72:75] offset:6144
  ds_write_b128 v4, v[76:79] offset:7168
  s_xor_b32 s36, s13, 2
  s_lshl_b32 s36, s36, 19
  s_add_u32 m0, s39, 24576
  s_add_u32 s37, s36, 0
  buffer_load_dwordx4 v25, s[44:47], s37 offen lds
  s_add_u32 m0, s39, 25600
  s_add_u32 s37, s36, 65536
  buffer_load_dwordx4 v25, s[44:47], s37 offen lds
  s_add_u32 m0, s39, 26624
  s_add_u32 s37, s36, 131072
  buffer_load_dwordx4 v25, s[44:47], s37 offen lds
  s_add_u32 m0, s39, 27648
  s_add_u32 s37, s36, 196608
  buffer_load_dwordx4 v25, s[44:47], s37 offen lds
  s_xor_b32 s36, s13, 2
  s_lshl_b32 s36, s36, 19
  s_add_u32 m0, s39, 20480
  s_add_u32 s37, s36, 262144
  buffer_load_dwordx4 v25, s[44:47], s37 offen lds
  s_add_u32 m0, s39, 21504
  s_add_u32 s37, s36, 327680
  buffer_load_dwordx4 v25, s[44:47], s37 offen lds
  s_add_u32 m0, s39, 22528
  s_add_u32 s37, s36, 393216
  buffer_load_dwordx4 v25, s[44:47], s37 offen lds
  s_add_u32 m0, s39, 23552
  s_add_u32 s37, s36, 458752
  buffer_load_dwordx4 v25, s[44:47], s37 offen lds
  v_mad_u32_u24 v96, v100, 3, v27
  v_mad_u32_u24 v97, v101, 3, v27
  v_mad_u32_u24 v98, v100, 3, v36
  v_mad_u32_u24 v99, v101, 3, v36
  s_waitcnt vmcnt(11)
  s_barrier
  ds_read_b64_tr_b16 v[176:177], v96 offset:16384
  ds_read_b64_tr_b16 v[178:179], v96 offset:16640
  ds_read_b64_tr_b16 v[180:181], v96 offset:18432
  ds_read_b64_tr_b16 v[182:183], v96 offset:18688
  ds_read_b64_tr_b16 v[184:185], v97 offset:16384
  ds_read_b64_tr_b16 v[186:187], v97 offset:16640
  ds_read_b64_tr_b16 v[188:189], v97 offset:18432
  ds_read_b64_tr_b16 v[190:191], v97 offset:18688
  ds_read_b64_tr_b16 v[64:65], v98 offset:16384
  ds_read_b64_tr_b16 v[66:67], v98 offset:16640
  ds_read_b64_tr_b16 v[68:69], v98 offset:18432
  ds_read_b64_tr_b16 v[70:71], v98 offset:18688
  ds_read_b64_tr_b16 v[72:73], v99 offset:16384
  ds_read_b64_tr_b16 v[74:75], v99 offset:16640
  ds_read_b64_tr_b16 v[76:77], v99 offset:18432
  ds_read_b64_tr_b16 v[78:79], v99 offset:18688
  s_waitcnt lgkmcnt(0)
  s_barrier
  ds_write_b128 v4, v[64:67] offset:16384
  ds_write_b128 v4, v[68:71] offset:17408
  ds_write_b128 v4, v[72:75] offset:18432
  ds_write_b128 v4, v[76:79] offset:19456
  s_xor_b32 s36, s13, 0
  s_lshl_b32 s36, s36, 19
  s_add_u32 m0, s39, 8192
  s_add_u32 s37, s36, 0
  buffer_load_dwordx4 v25, s[44:47], s37 offen lds
  s_add_u32 m0, s39, 9216
  s_add_u32 s37, s36, 65536
  buffer_load_dwordx4 v25, s[44:47], s37 offen lds
  s_add_u32 m0, s39, 10240
  s_add_u32 s37, s36, 131072
  buffer_load_dwordx4 v25, s[44:47], s37 offen lds
  s_add_u32 m0, s39, 11264
  s_add_u32 s37, s36, 196608
  buffer_load_dwordx4 v25, s[44:47], s37 offen lds
  s_xor_b32 s36, s13, 0
  s_lshl_b32 s36, s36, 19
  s_add_u32 m0, s39, 12288
  s_add_u32 s37, s36, 262144
  buffer_load_dwordx4 v25, s[44:47], s37 offen lds
  s_add_u32 m0, s39, 13312
  s_add_u32 s37, s36, 327680
  buffer_load_dwordx4 v25, s[44:47], s37 offen lds
  s_add_u32 m0, s39, 14336
  s_add_u32 s37, s36, 393216
  buffer_load_dwordx4 v25, s[44:47], s37 offen lds
  s_add_u32 m0, s39, 15360
  s_add_u32 s37, s36, 458752
  buffer_load_dwordx4 v25, s[44:47], s37 offen lds
  v_mad_u32_u24 v96, v100, 1, v27
  v_mad_u32_u24 v97, v101, 1, v27
  v_mad_u32_u24 v98, v100, 1, v36
  v_mad_u32_u24 v99, v101, 1, v36
  s_waitcnt vmcnt(8)
  s_barrier
  ds_read_b64_tr_b16 v[208:209], v98 offset:20480
  ds_read_b64_tr_b16 v[210:211], v98 offset:20736
  ds_read_b64_tr_b16 v[212:213], v98 offset:22528
  ds_read_b64_tr_b16 v[214:215], v98 offset:22784
  ds_read_b64_tr_b16 v[216:217], v99 offset:20480
  ds_read_b64_tr_b16 v[218:219], v99 offset:20736
  ds_read_b64_tr_b16 v[220:221], v99 offset:22528
  ds_read_b64_tr_b16 v[222:223], v99 offset:22784
  ds_read_b64_tr_b16 v[64:65], v96 offset:20480
  ds_read_b64_tr_b16 v[66:67], v96 offset:20736
  ds_read_b64_tr_b16 v[68:69], v96 offset:22528
  ds_read_b64_tr_b16 v[70:71], v96 offset:22784
  ds_read_b64_tr_b16 v[72:73], v97 offset:20480
  ds_read_b64_tr_b16 v[74:75], v97 offset:20736
  ds_read_b64_tr_b16 v[76:77], v97 offset:22528
  ds_read_b64_tr_b16 v[78:79], v97 offset:22784
  s_waitcnt lgkmcnt(0)
  s_barrier
  ds_write_b128 v4, v[64:67] offset:20480
  ds_write_b128 v4, v[68:71] offset:21504
  ds_write_b128 v4, v[72:75] offset:22528
  ds_write_b128 v4, v[76:79] offset:23552
  s_xor_b32 s36, s13, 2
  s_lshl_b32 s36, s36, 15
  s_add_u32 m0, s39, 24576
  s_add_u32 s37, s36, 512
  buffer_load_dwordx4 v26, s[48:51], s37 offen lds
  s_add_u32 m0, s39, 25600
  s_add_u32 s37, s36, 8704
  buffer_load_dwordx4 v26, s[48:51], s37 offen lds
  s_add_u32 m0, s39, 26624
  s_add_u32 s37, s36, 16896
  buffer_load_dwordx4 v26, s[48:51], s37 offen lds
  s_add_u32 m0, s39, 27648
  s_add_u32 s37, s36, 25088
  buffer_load_dwordx4 v26, s[48:51], s37 offen lds
  s_xor_b32 s36, s13, 3
  s_lshl_b32 s36, s36, 15
  s_add_u32 m0, s39, 28672
  s_add_u32 s37, s36, 512
  buffer_load_dwordx4 v26, s[48:51], s37 offen lds
  s_add_u32 m0, s39, 29696
  s_add_u32 s37, s36, 8704
  buffer_load_dwordx4 v26, s[48:51], s37 offen lds
  s_add_u32 m0, s39, 30720
  s_add_u32 s37, s36, 16896
  buffer_load_dwordx4 v26, s[48:51], s37 offen lds
  s_add_u32 m0, s39, 31744
  s_add_u32 s37, s36, 25088
  buffer_load_dwordx4 v26, s[48:51], s37 offen lds
  s_mov_b32 s19, 0
  s_branch T_arrgo_4
T_arr_3:
  s_add_u32 s19, s19, 1
  s_cmp_gt_u32 s19, 32768
  s_cbranch_scc1 M_exit
  buffer_load_dwordx2 v[54:55], off, s[72:75], 0 sc1
  buffer_load_dword v56, off, s[72:75], 0 offset:128 sc1
  s_waitcnt vmcnt(0)
T_arrgo_4:
  v_sad_u8 v57, v54, 0, 0
  v_sad_u8 v57, v55, 0, v57
  v_or_b32 v58, v54, v55
  v_cmp_gt_u32 vcc, 32, v57
  s_cbranch_vccnz T_arr_3
  v_cmp_gt_u32 vcc, 0x100, v56
  s_cbranch_vccnz T_arr_3
  v_readfirstlane_b32 s36, v58
  s_nop 0
  s_and_b32 s36, s36, 0x20202020
  s_cselect_b32 s56, 0, 1
  s_mov_b32 s14, -1
  s_mov_b32 s30, -1
  s_mov_b32 s19, 0
  s_branch T_kvok_6
T_kv_5:
  s_sleep 4
  s_add_u32 s19, s19, 1
  s_cmp_gt_u32 s19, 32768
  s_cbranch_scc1 M_exit
T_kvok_6:
  s_add_u32 s39, s99, 128
  s_mov_b32 s38, 0
  s_mov_b32 s37, 0
  s_atomic_or s38, s[58:59], s99 glc
  s_atomic_or s37, s[58:59], s39 glc
  s_waitcnt lgkmcnt(0)
  s_lshl_b32 s38, s38, 1
  s_lshl1_add_u32 s37, s37, 1
  s_min_u32 s38, s38, s37
  s_cmp_ge_u32 s38, 64
  s_cselect_b32 s38, 100, s38
  s_sub_u32 s38, s38, 1
  s_max_i32 s30, s30, s38
  s_cmp_ge_i32 s14, s30
  s_cbranch_scc1 T_kv_5
  s_mov_b32 m0, s31
  s_nop 0
  buffer_load_dwordx4 v9, s[4:7], s27 offen sc1 lds
  s_mov_b32 m0, s32
  s_nop 0
  buffer_load_dwordx4 v9, s[4:7], s27 offen offset:128 sc1 lds
  s_mov_b32 m0, s33
  s_nop 0
  buffer_load_dwordx4 v10, s[4:7], s28 offen sc1 lds
  s_mov_b32 m0, s34
  s_nop 0
  buffer_load_dwordx4 v10, s[4:7], s28 offen offset:256 sc1 lds
  s_add_u32 s27, s27, 8192
  s_add_u32 s28, s28, 8192
  s_lshl_b32 s36, s12, 10
  s_add_u32 s36, s36, 145752064
  buffer_load_dwordx4 v[40:43], v2, s[4:7], s36 offen sc1
  v_mad_u32_u24 v96, v101, 1, v27
  v_mad_u32_u24 v97, v100, 1, v27
  v_mad_u32_u24 v98, v101, 1, v36
  v_mad_u32_u24 v99, v100, 1, v36
  s_waitcnt vmcnt(13)
  s_barrier
  ds_read_b64_tr_b16 v[64:65], v96 offset:8192
  ds_read_b64_tr_b16 v[66:67], v96 offset:8448
  ds_read_b64_tr_b16 v[68:69], v96 offset:10240
  ds_read_b64_tr_b16 v[70:71], v96 offset:10496
  ds_read_b64_tr_b16 v[72:73], v97 offset:8192
  ds_read_b64_tr_b16 v[74:75], v97 offset:8448
  ds_read_b64_tr_b16 v[76:77], v97 offset:10240
  ds_read_b64_tr_b16 v[78:79], v97 offset:10496
  ds_read_b64_tr_b16 v[80:81], v98 offset:8192
  ds_read_b64_tr_b16 v[82:83], v98 offset:8448
  ds_read_b64_tr_b16 v[84:85], v98 offset:10240
  ds_read_b64_tr_b16 v[86:87], v98 offset:10496
  ds_read_b64_tr_b16 v[88:89], v99 offset:8192
  ds_read_b64_tr_b16 v[90:91], v99 offset:8448
  ds_read_b64_tr_b16 v[92:93], v99 offset:10240
  ds_read_b64_tr_b16 v[94:95], v99 offset:10496
  s_waitcnt lgkmcnt(0)
  s_barrier
  ds_write_b128 v4, v[64:67] offset:8192
  ds_write_b128 v4, v[68:71] offset:9216
  ds_write_b128 v4, v[72:75] offset:10240
  ds_write_b128 v4, v[76:79] offset:11264
  ds_write_b128 v4, v[80:83] offset:12288
  ds_write_b128 v4, v[84:87] offset:13312
  ds_write_b128 v4, v[88:91] offset:14336
  ds_write_b128 v4, v[92:95] offset:15360
  s_waitcnt vmcnt(9)
  ds_read_b64_tr_b16 v[64:65], v28 offset:24576
  ds_read_b64_tr_b16 v[66:67], v28 offset:24832
  ds_read_b64_tr_b16 v[68:69], v28 offset:25600
  ds_read_b64_tr_b16 v[70:71], v28 offset:25856
  ds_read_b64_tr_b16 v[72:73], v28 offset:24584
  ds_read_b64_tr_b16 v[74:75], v28 offset:24840
  ds_read_b64_tr_b16 v[76:77], v28 offset:25608
  ds_read_b64_tr_b16 v[78:79], v28 offset:25864
  s_waitcnt lgkmcnt(0)
  ds_write_b128 v4, v[64:67] offset:24576
  ds_write_b128 v4, v[68:71] offset:25600
  ds_write_b128 v4, v[72:75] offset:26624
  ds_write_b128 v4, v[76:79] offset:27648
  s_waitcnt lgkmcnt(0)
  s_waitcnt vmcnt(5)
  ds_read_b64_tr_b16 v[64:65], v28 offset:28672
  ds_read_b64_tr_b16 v[66:67], v28 offset:28928
  ds_read_b64_tr_b16 v[68:69], v28 offset:29696
  ds_read_b64_tr_b16 v[70:71], v28 offset:29952
  ds_read_b64_tr_b16 v[72:73], v28 offset:28680
  ds_read_b64_tr_b16 v[74:75], v28 offset:28936
  ds_read_b64_tr_b16 v[76:77], v28 offset:29704
  ds_read_b64_tr_b16 v[78:79], v28 offset:29960
  s_waitcnt lgkmcnt(0)
  ds_write_b128 v4, v[64:67] offset:28672
  ds_write_b128 v4, v[68:71] offset:29696
  ds_write_b128 v4, v[72:75] offset:30720
  ds_write_b128 v4, v[76:79] offset:31744
  s_waitcnt lgkmcnt(0)
  s_mov_b32 s14, 1
  s_cmp_lt_i32 s14, s30
  s_cbranch_scc1 T_kv2_7
  s_mov_b32 s19, 0
  s_branch T_kvok_9
T_kv_8:
  s_sleep 4
  s_add_u32 s19, s19, 1
  s_cmp_gt_u32 s19, 32768
  s_cbranch_scc1 M_exit
T_kvok_9:
  s_add_u32 s39, s99, 128
  s_mov_b32 s38, 0
  s_mov_b32 s37, 0
  s_atomic_or s38, s[58:59], s99 glc
  s_atomic_or s37, s[58:59], s39 glc
  s_waitcnt lgkmcnt(0)
  s_lshl_b32 s38, s38, 1
  s_lshl1_add_u32 s37, s37, 1
  s_min_u32 s38, s38, s37
  s_cmp_ge_u32 s38, 64
  s_cselect_b32 s38, 100, s38
  s_sub_u32 s38, s38, 1
  s_max_i32 s30, s30, s38
  s_cmp_ge_i32 s14, s30
  s_cbranch_scc1 T_kv_8
T_kv2_7:
  s_waitcnt vmcnt(0) lgkmcnt(0)
  s_barrier
  s_cmp_ge_u32 s13, 2
  s_cselect_b64 vcc, -1, 0
  v_cndmask_b32 v3, v8, v19, vcc
  ds_read_b128 v[68:71], v4 offset:0
  ds_read_b128 v[72:75], v4 offset:1024
  ds_read_b128 v[76:79], v4 offset:4096
  ds_read_b128 v[80:83], v4 offset:5120
  ds_read_b128 v[84:87], v4 offset:8192
  ds_read_b128 v[88:91], v4 offset:9216
  ds_read_b128 v[92:95], v4 offset:2048
  ds_read_b128 v[96:99], v4 offset:3072
  ds_read_b128 v[100:103], v4 offset:6144
  ds_read_b128 v[104:107], v4 offset:7168
  ds_read_b128 v[108:111], v4 offset:10240
  ds_read_b128 v[112:115], v4 offset:11264
  ds_read_b128 v[28:31], v59 offset:16384
  ds_read_b128 v[32:35], v59 offset:20480
  ds_read_b128 v[36:39], v2 offset:8192
  ds_read_b128 v[40:43], v2 offset:9216
  ds_read_b128 v[44:47], v2 offset:10240
  ds_read_b128 v[48:51], v2 offset:11264
  ds_read_b128 v[52:55], v2 offset:12288
  ds_read_b128 v[56:59], v2 offset:13312
  ds_read_b128 v[60:63], v2 offset:14336
  ds_read_b128 v[64:67], v2 offset:15360
  s_and_b32 s36, s13, 1
  s_lshl_b32 s36, s36, 12
  s_add_u32 s22, s22, s36
  s_add_u32 s23, s36, 145752064
  s_mov_b32 s14, -1
  s_and_b32 s57, s14, 1
  s_and_b32 s36, s14, 3
  s_lshl_b32 s36, s36, 13
  s_add_u32 s26, s36, s23
  s_add_u32 s36, s36, 8192
  s_and_b32 s36, s36, 0x7fff
  s_add_u32 s24, s36, 145752064
  s_add_u32 s25, s36, 145756160
  s_add_u32 s35, s36, s23
  s_waitcnt lgkmcnt(0)
  s_cmp_lg_u32 s56, 0
  s_cbranch_scc1 M_global
T_code:
  s_cmp_eq_u32 s13, 1
  s_cbranch_scc1 T_w_11
  s_cmp_eq_u32 s13, 2
  s_cbranch_scc1 T_w_12
  s_cmp_eq_u32 s13, 3
  s_cbranch_scc1 T_w_13
T_w_10:
  s_mov_b32 s19, 0
  s_add_u32 s14, s14, 1
  s_and_b32 s57, s14, 1
  v_mov_b64 v[16:17], 0
  v_mov_b64 v[18:19], 0
  v_mov_b64 v[20:21], 0
  v_mov_b64 v[22:23], 0
  v_mov_b64 v[24:25], 0
  v_mov_b64 v[26:27], 0
  buffer_load_dwordx4 v[124:127], v2, s[4:7], s24 offen offset:0 sc1
  buffer_load_dwordx4 v[116:119], v2, s[4:7], s25 offen offset:0 sc1
  buffer_load_dwordx4 v[124:127], v2, s[4:7], s24 offen offset:0 sc1
  buffer_load_dwordx4 v[116:119], v2, s[4:7], s25 offen offset:0 sc1
  s_branch T_loop_14
.p2align 6
T_retry_15:
  s_mov_b64 exec, vcc
  buffer_load_dwordx4 v[124:127], v2, s[4:7], s24 offen offset:0 sc1
  buffer_load_dwordx4 v[116:119], v2, s[4:7], s25 offen offset:0 sc1
  s_mov_b64 exec, -1
  s_add_u32 s19, s19, 1
  s_cmp_gt_u32 s19, 32768
  s_cbranch_scc1 M_exit
  s_nop 0
  v_mov_b64 v[16:17], 0
  v_mov_b64 v[18:19], 0
T_loop_14:
  s_waitcnt vmcnt(3) lgkmcnt(0)
  v_max3_u32 v123, v124, v125, v126
  v_max_u32 v123, v123, v127
  v_mov_b32_dpp v120, v124 row_ror:8 row_mask:0xf bank_mask:0xf
  v_mov_b32_dpp v121, v125 row_ror:8 row_mask:0xf bank_mask:0xf
  s_waitcnt vmcnt(2)
  v_max3_u32 v123, v123, v116, v117
  v_max3_u32 v123, v123, v118, v119
  v_cmp_eq_u32 vcc, -1, v123
  v_smfmac_f32_16x16x64_bf16 v[16:19], v[124:127], v[68:75], v0
  s_cbranch_vccnz T_retry_15
  ds_write_b128 v2, v[124:127] offset:0
  v_mov_b32_dpp v122, v126 row_ror:8 row_mask:0xf bank_mask:0xf
  v_smfmac_f32_16x16x64_bf16 v[20:23], v[124:127], v[76:83], v0
  s_and_b32 s57, s14, 1
  v_mov_b32_dpp v123, v127 row_ror:8 row_mask:0xf bank_mask:0xf
  v_smfmac_f32_16x16x64_bf16 v[24:27], v[124:127], v[84:91], v0
  s_and_b32 s36, s14, 3
  ds_write_b128 v2, v[116:119] offset:4096
  v_smfmac_f32_16x16x64_bf16 v[16:19], v[120:123], v[92:99], v0
  s_lshl_b32 s36, s36, 13
  v_mov_b32_dpp v84, v116 row_ror:8 row_mask:0xf bank_mask:0xf
  v_smfmac_f32_16x16x64_bf16 v[20:23], v[120:123], v[100:107], v0
  s_add_u32 s26, s36, s23
  ds_read_b128 v[68:71], v4 offset:12288
  v_mov_b32_dpp v85, v117 row_ror:8 row_mask:0xf bank_mask:0xf
  v_smfmac_f32_16x16x64_bf16 v[24:27], v[120:123], v[108:115], v0
  s_add_u32 s36, s36, 8192
  ds_read_b128 v[72:75], v4 offset:13312
  v_mov_b32_dpp v86, v118 row_ror:8 row_mask:0xf bank_mask:0xf
  v_smfmac_f32_16x16x64_bf16 v[16:19], v[116:119], v[224:231], v0
  s_and_b32 s36, s36, 0x7fff
  ds_read_b128 v[76:79], v4 offset:14336
  v_mov_b32_dpp v87, v119 row_ror:8 row_mask:0xf bank_mask:0xf
  v_smfmac_f32_16x16x64_bf16 v[20:23], v[116:119], v[240:247], v0
  s_waitcnt lgkmcnt(3)
  s_barrier
  ds_read_b128 v[100:103], v2 offset:1024
  v_smfmac_f32_16x16x64_bf16 v[24:27], v[116:119], a[0:7], v0
  s_mov_b32 m0, s31
  ds_read_b128 v[120:123], v1 offset:1024
  buffer_load_dwordx4 v9, s[4:7], s27 offen sc1 lds
  v_smfmac_f32_16x16x64_bf16 v[16:19], v[84:87], v[232:239], v0
  s_mov_b32 m0, s32
  v_smfmac_f32_16x16x64_bf16 v[20:23], v[84:87], v[248:255], v0
  ds_read_b128 v[80:83], v4 offset:15360
  v_smfmac_f32_16x16x64_bf16 v[24:27], v[84:87], a[8:15], v0
  s_waitcnt lgkmcnt(2)
  v_smfmac_f32_16x16x64_bf16 v[16:19], v[100:103], v[128:135], v0
  ds_read_b128 v[92:95], v2 offset:2048
  buffer_load_dwordx4 v9, s[4:7], s27 offen offset:128 sc1 lds
  v_smfmac_f32_16x16x64_bf16 v[20:23], v[100:103], v[144:151], v0
  ds_read_b128 v[96:99], v1 offset:2048
  s_mov_b32 m0, s33
  v_smfmac_f32_16x16x64_bf16 v[24:27], v[100:103], v[68:75], v0
  s_waitcnt vmcnt(2) lgkmcnt(3)
  ds_read_b128 v[116:119], v2 offset:3072
  v_smfmac_f32_16x16x64_bf16 v[16:19], v[120:123], v[136:143], v0
  ds_read_b128 v[124:127], v1 offset:3072
  v_smfmac_f32_16x16x64_bf16 v[20:23], v[120:123], v[152:159], v0
  s_waitcnt lgkmcnt(4)
  ds_read_b128 v[104:107], v2 offset:5120
  buffer_load_dwordx4 v10, s[4:7], s28 offen sc1 lds
  v_smfmac_f32_16x16x64_bf16 v[24:27], v[120:123], v[76:83], v0
  s_waitcnt lgkmcnt(4)
  ds_read_b128 v[108:111], v1 offset:5120
  s_mov_b32 m0, s34
  v_smfmac_f32_16x16x64_bf16 v[16:19], v[92:95], v[160:167], v0
  s_waitcnt lgkmcnt(4)
  ds_read_b128 v[112:115], v2 offset:6144
  v_smfmac_f32_16x16x64_bf16 v[16:19], v[96:99], v[168:175], v0
  s_waitcnt lgkmcnt(4)
  ds_read_b128 v[84:87], v1 offset:6144
  v_smfmac_f32_16x16x64_bf16 v[16:19], v[116:119], v[192:199], v0
  s_waitcnt lgkmcnt(4)
  ds_read_b128 v[88:91], v2 offset:7168
  buffer_load_dwordx4 v10, s[4:7], s28 offen offset:256 sc1 lds
  v_smfmac_f32_16x16x64_bf16 v[16:19], v[124:127], v[200:207], v0
  s_waitcnt lgkmcnt(4)
  ds_read_b128 v[100:103], v1 offset:7168
  v_smfmac_f32_16x16x64_bf16 v[16:19], v[104:107], a[16:23], v0
  s_waitcnt lgkmcnt(4)
  ds_read_b128 v[68:71], v4 offset:16384
  v_smfmac_f32_16x16x64_bf16 v[16:19], v[108:111], a[24:31], v0
  s_waitcnt lgkmcnt(4)
  ds_read_b128 v[72:75], v4 offset:17408
  v_smfmac_f32_16x16x64_bf16 v[16:19], v[112:115], a[64:71], v0
  s_waitcnt lgkmcnt(4)
  ds_read_b128 v[76:79], v4 offset:18432
  v_smfmac_f32_16x16x64_bf16 v[16:19], v[84:87], a[72:79], v0
  s_waitcnt lgkmcnt(4)
  ds_read_b128 v[80:83], v4 offset:19456
  v_smfmac_f32_16x16x64_bf16 v[16:19], v[88:91], a[112:119], v0
  s_waitcnt lgkmcnt(4)
  v_smfmac_f32_16x16x64_bf16 v[16:19], v[100:103], a[120:127], v0
  s_add_u32 s24, s36, 145752064
  s_add_u32 s25, s36, 145756160
  v_smfmac_f32_16x16x64_bf16 v[20:23], v[92:95], v[176:183], v0
  s_add_u32 s35, s36, s23
  v_smfmac_f32_16x16x64_bf16 v[20:23], v[96:99], v[184:191], v0
  s_waitcnt lgkmcnt(2)
  v_smfmac_f32_16x16x64_bf16 v[20:23], v[116:119], v[68:75], v0
  s_waitcnt lgkmcnt(0)
  ds_read_b128 v[68:71], v4 offset:20480
  v_mul_f32 v16, s18, v16
  v_smfmac_f32_16x16x64_bf16 v[20:23], v[124:127], v[76:83], v0
  ds_read_b128 v[72:75], v4 offset:21504
  v_mul_f32 v17, s18, v17
  v_smfmac_f32_16x16x64_bf16 v[20:23], v[104:107], a[32:39], v0
  ds_read_b128 v[76:79], v4 offset:22528
  v_mul_f32 v18, s18, v18
  v_smfmac_f32_16x16x64_bf16 v[20:23], v[108:111], a[40:47], v0
  ds_read_b128 v[80:83], v4 offset:23552
  v_mul_f32 v19, s18, v19
  v_smfmac_f32_16x16x64_bf16 v[20:23], v[112:115], a[80:87], v0
  v_cvt_pk_bf16_f32 v120, v16, v17
  v_smfmac_f32_16x16x64_bf16 v[20:23], v[84:87], a[88:95], v0
  v_cvt_pk_bf16_f32 v121, v18, v19
  v_smfmac_f32_16x16x64_bf16 v[20:23], v[88:91], a[128:135], v0
  ds_write_b64 v5, v[120:121] offset:24576
  v_smfmac_f32_16x16x64_bf16 v[20:23], v[100:103], a[136:143], v0
  s_waitcnt lgkmcnt(3)
  v_smfmac_f32_16x16x64_bf16 v[24:27], v[92:95], v[68:75], v0
  s_waitcnt lgkmcnt(1)
  v_mov_b64 v[92:93], 0
  v_smfmac_f32_16x16x64_bf16 v[24:27], v[96:99], v[76:83], v0
  s_nop 1
  v_cvt_pk_bf16_f32 v122, v20, v21
  v_cvt_pk_bf16_f32 v123, v22, v23
  v_smfmac_f32_16x16x64_bf16 v[24:27], v[116:119], v[208:215], v0
  ds_write_b64 v5, v[122:123] offset:26880
  v_mov_b64 v[94:95], 0
  v_smfmac_f32_16x16x64_bf16 v[24:27], v[124:127], v[216:223], v0
  s_waitcnt lgkmcnt(1)
  s_barrier
  ds_read_b64_tr_b16 v[68:69], v6 offset:24576
  v_smfmac_f32_16x16x64_bf16 v[24:27], v[104:107], a[48:55], v0
  s_add_u32 s27, s27, 8192
  ds_read_b64_tr_b16 v[70:71], v6 offset:24640
  ds_read_b64_tr_b16 v[72:73], v6 offset:24832
  v_smfmac_f32_16x16x64_bf16 v[24:27], v[108:111], a[56:63], v0
  s_add_u32 s28, s28, 8192
  ds_read_b64_tr_b16 v[74:75], v6 offset:24896
  ds_read_b64_tr_b16 v[76:77], v6 offset:25088
  v_smfmac_f32_16x16x64_bf16 v[24:27], v[112:115], a[96:103], v0
  s_nop 0
  ds_read_b64_tr_b16 v[78:79], v6 offset:25152
  ds_read_b64_tr_b16 v[80:81], v6 offset:25344
  v_smfmac_f32_16x16x64_bf16 v[24:27], v[84:87], a[104:111], v0
  ds_read_b64_tr_b16 v[82:83], v6 offset:25408
  v_mov_b64 v[96:97], 0
  v_smfmac_f32_16x16x64_bf16 v[24:27], v[88:91], a[144:151], v0
  s_waitcnt lgkmcnt(8)
  s_barrier
  ds_read_b64_tr_b16 v[116:117], v6 offset:26880
  v_smfmac_f32_16x16x64_bf16 v[24:27], v[100:103], a[152:159], v0
  s_waitcnt lgkmcnt(7)
  ds_read_b64_tr_b16 v[118:119], v6 offset:26944
  v_mfma_f32_16x16x32_bf16 v[16:19], v[36:39], v[68:71], 0
  s_waitcnt lgkmcnt(6)
  ds_read_b64_tr_b16 v[124:125], v6 offset:27136
  ds_read_b64_tr_b16 v[126:127], v6 offset:27200
  v_mfma_f32_16x16x32_bf16 v[16:19], v[40:43], v[72:75], v[16:19]
  s_waitcnt lgkmcnt(6)
  ds_read_b64_tr_b16 v[104:105], v6 offset:27392
  ds_read_b64_tr_b16 v[106:107], v6 offset:27456
  v_mfma_f32_16x16x32_bf16 v[16:19], v[44:47], v[76:79], v[16:19]
  s_waitcnt lgkmcnt(6)
  ds_read_b64_tr_b16 v[108:109], v6 offset:27648
  ds_read_b64_tr_b16 v[110:111], v6 offset:27712
  v_mfma_f32_16x16x32_bf16 v[16:19], v[48:51], v[80:83], v[16:19]
  s_waitcnt lgkmcnt(6)
  v_cvt_pk_bf16_f32 v120, v24, v25
  v_cvt_pk_bf16_f32 v121, v26, v27
  v_mfma_f32_16x16x32_bf16 v[112:115], v[116:119], v[68:71], 0
  s_waitcnt lgkmcnt(4)
  buffer_store_dwordx4 v[120:123], v2, s[4:7], s29 offen offset:0 sc1
  v_mov_b64 v[98:99], 0
  v_mfma_f32_16x16x32_bf16 v[112:115], v[124:127], v[72:75], v[112:115]
  s_waitcnt lgkmcnt(2)
  v_mov_b64 v[36:37], 0
  v_exp_f32 v100, v16
  v_mfma_f32_16x16x32_bf16 v[112:115], v[104:107], v[76:79], v[112:115]
  s_waitcnt lgkmcnt(0)
  v_exp_f32 v101, v17
  v_mfma_f32_16x16x32_bf16 v[112:115], v[108:111], v[80:83], v[112:115]
  v_exp_f32 v102, v18
  v_mfma_f32_16x16x32_bf16 v[20:23], v[52:55], v[68:71], 0
  v_exp_f32 v103, v19
  v_mfma_f32_16x16x32_bf16 v[20:23], v[56:59], v[72:75], v[20:23]
  v_cvt_pk_bf16_f32 v44, v100, v101
  v_cvt_pk_bf16_f32 v45, v102, v103
  v_mfma_f32_16x16x32_bf16 v[20:23], v[60:63], v[76:79], v[20:23]
  s_add_u32 s29, s29, 131072
  v_exp_f32 v100, v112
  v_mfma_f32_16x16x32_bf16 v[20:23], v[64:67], v[80:83], v[20:23]
  v_exp_f32 v101, v113
  v_exp_f32 v102, v114
  v_exp_f32 v103, v115
  v_cvt_pk_bf16_f32 v84, v100, v101
  v_cvt_pk_bf16_f32 v85, v102, v103
  v_cndmask_b32 v48, v84, 0, s[16:17]
  v_cndmask_b32 v49, v85, 0, s[16:17]
  v_cndmask_b32 v50, 0, v84, s[16:17]
  v_cndmask_b32 v51, 0, v85, s[16:17]
  v_exp_f32 v100, v20
  v_mfma_f32_16x16x16_bf16 v[88:91], v[12:13], v[48:49], 0
  v_exp_f32 v101, v21
  v_mfma_f32_16x16x16_bf16 v[24:27], v[120:121], v[48:49], 0
  v_exp_f32 v102, v22
  v_mfma_f32_16x16x16_bf16 v[116:119], v[120:121], v[50:51], 0
  v_exp_f32 v103, v23
  v_cvt_pk_bf16_f32 v46, v100, v101
  v_cvt_pk_bf16_f32 v47, v102, v103
  v_mov_b64 v[38:39], 0
  s_nop 0
  v_mfma_f32_16x16x32_bf16 v[88:91], v[12:15], v[44:47], v[88:91]
  v_mov_b64 v[40:41], 0
  v_mov_b64 v[42:43], 0
  v_mfma_f32_16x16x32_bf16 v[24:27], v[28:31], v[44:47], v[24:27]
  ds_read_b128 v[52:55], v4 offset:24576
  ds_read_b128 v[56:59], v4 offset:25600
  v_mfma_f32_16x16x32_bf16 v[116:119], v[32:35], v[44:47], v[116:119]
  s_nop 1
T_back_22:
  v_rcp_f32 v89, v88
  v_subrev_u32 v100, s54, v88
  v_cmp_le_u32 vcc, s96, v100
  v_mul_f32 v24, v89, v24
  v_mul_f32 v25, v89, v25
  v_cvt_pk_bf16_f32 v124, v24, v25
  v_pk_mul_f32 v[26:27], v[26:27], v[88:89] op_sel:[0,1] op_sel_hi:[1,1]
  v_pk_mul_f32 v[116:117], v[116:117], v[88:89] op_sel:[0,1] op_sel_hi:[1,1]
  v_pk_mul_f32 v[118:119], v[118:119], v[88:89] op_sel:[0,1] op_sel_hi:[1,1]
  v_cvt_pk_bf16_f32 v125, v26, v27
  v_cvt_pk_bf16_f32 v126, v116, v117
  v_cvt_pk_bf16_f32 v127, v118, v119
  ds_write_b128 v11, v[124:127] offset:29184
  s_cbranch_vccnz T_slow_21
  v_smfmac_f32_16x16x64_bf16 v[92:95], v[124:127], a[160:167], v0
  s_mov_b32 s96, s55
  v_smfmac_f32_16x16x64_bf16 v[96:99], v[124:127], a[168:175], v0
  s_cmp_eq_u32 s14, 63
  v_smfmac_f32_16x16x64_bf16 v[36:39], v[124:127], a[176:183], v0
  s_waitcnt lgkmcnt(0)
  s_barrier
  ds_read_b128 v[104:107], v11 offset:29696
  ds_read_b128 v[108:111], v11 offset:30208
  ds_read_b128 v[68:71], v11 offset:30720
  s_cbranch_scc1 M_tdone
  v_smfmac_f32_16x16x64_bf16 v[40:43], v[124:127], a[184:191], v0
  s_waitcnt lgkmcnt(2)
  v_smfmac_f32_16x16x64_bf16 v[92:95], v[104:107], a[192:199], v0
  s_waitcnt lgkmcnt(1)
  ds_read_b128 v[76:79], v4 offset:28672
  v_smfmac_f32_16x16x64_bf16 v[92:95], v[108:111], a[224:231], v0
  s_waitcnt lgkmcnt(1)
  ds_read_b128 v[80:83], v4 offset:29696
  v_smfmac_f32_16x16x64_bf16 v[92:95], v[68:71], a[240:247], v0
  ds_read_b128 v[60:63], v4 offset:26624
  v_smfmac_f32_16x16x64_bf16 v[96:99], v[104:107], a[200:207], v0
  ds_read_b128 v[64:67], v4 offset:27648
  v_smfmac_f32_16x16x64_bf16 v[96:99], v[108:111], a[232:239], v0
  ds_read_b128 v[28:31], v4 offset:30720
  s_nop 0
  v_cvt_pk_bf16_f32 v16, v92, v93
  v_cvt_pk_bf16_f32 v17, v94, v95
  v_bfi_b32 v16, 1, s57, v16
  v_smfmac_f32_16x16x64_bf16 v[96:99], v[68:71], a[248:255], v0
  buffer_store_dwordx2 v[16:17], v7, s[4:7], s20 offen offset:0
  v_smfmac_f32_16x16x64_bf16 v[36:39], v[104:107], a[208:215], v0
  ds_read_b128 v[32:35], v4 offset:31744
  v_smfmac_f32_16x16x64_bf16 v[36:39], v[108:111], v[52:59], v0
  s_waitcnt lgkmcnt(4)
  s_nop 0
  v_cvt_pk_bf16_f32 v18, v96, v97
  v_cvt_pk_bf16_f32 v19, v98, v99
  v_bfi_b32 v18, 1, s57, v18
  v_smfmac_f32_16x16x64_bf16 v[36:39], v[68:71], v[76:83], v0
  buffer_store_dwordx2 v[18:19], v7, s[4:7], s20 offen offset:64
  v_smfmac_f32_16x16x64_bf16 v[40:43], v[104:107], a[216:223], v0
  s_waitcnt lgkmcnt(2)
  ds_read_b128 v[116:119], v2 offset:31232
  v_smfmac_f32_16x16x64_bf16 v[40:43], v[108:111], v[60:67], v0
  s_waitcnt lgkmcnt(1)
  s_nop 0
  v_cvt_pk_bf16_f32 v20, v36, v37
  v_cvt_pk_bf16_f32 v21, v38, v39
  v_bfi_b32 v20, 1, s57, v20
  v_smfmac_f32_16x16x64_bf16 v[40:43], v[68:71], v[28:35], v0
  buffer_store_dwordx2 v[20:21], v7, s[4:7], s21 offen offset:0
  s_nop 6
  v_cvt_pk_bf16_f32 v22, v40, v41
  v_cvt_pk_bf16_f32 v23, v42, v43
  v_bfi_b32 v22, 1, s57, v22
  buffer_store_dwordx2 v[22:23], v7, s[4:7], s21 offen offset:64
  ds_read_b128 v[68:71], v4 offset:0
  ds_read_b128 v[72:75], v4 offset:1024
  ds_read_b128 v[76:79], v4 offset:4096
  ds_read_b128 v[80:83], v4 offset:5120
  ds_read_b128 v[84:87], v4 offset:8192
  ds_read_b128 v[88:91], v4 offset:9216
  v_mov_b64 v[16:17], 0
  v_mov_b64 v[18:19], 0
  v_mov_b64 v[20:21], 0
  v_mov_b64 v[22:23], 0
  v_mov_b64 v[24:25], 0
  v_mov_b64 v[26:27], 0
  s_mov_b32 s19, 0
  v_mov_b32 v49, -1
  s_waitcnt vmcnt(2)
  buffer_load_dwordx4 v[52:55], v2, s[4:7], s22 offen offset:0 sc1
  buffer_load_dwordx4 v[56:59], v2, s[4:7], s22 offen offset:1024 sc1
  buffer_load_dwordx4 v[60:63], v2, s[4:7], s22 offen offset:2048 sc1
  buffer_load_dwordx4 v[64:67], v2, s[4:7], s22 offen offset:3072 sc1
  ds_read_b128 v[92:95], v4 offset:2048
  ds_read_b128 v[96:99], v4 offset:3072
  ds_read_b128 v[100:103], v4 offset:6144
  ds_read_b128 v[104:107], v4 offset:7168
  ds_read_b128 v[108:111], v4 offset:10240
  ds_read_b128 v[112:115], v4 offset:11264
  ds_read_b64 v[44:45], v2 offset:32256
  s_waitcnt lgkmcnt(0)
  v_readfirstlane_b32 s38, v44
  v_readfirstlane_b32 s37, v45
  s_nop 0
  s_lshl_b32 s38, s38, 1
  s_lshl1_add_u32 s37, s37, 1
  s_min_u32 s38, s38, s37
  s_cmp_ge_u32 s38, 64
  s_cselect_b32 s38, 100, s38
  s_sub_u32 s38, s38, 1
  s_max_i32 s30, s30, s38
  s_waitcnt lgkmcnt(12)
  s_waitcnt vmcnt(3)
  v_mfma_f32_16x16x32_bf16 v[120:123], v[116:119], v[52:55], 0
  v_xor_b32 v48, s57, v52
  v_bitop3_b32 v48, v48, v54, s57 bitop3:0xf6
  s_waitcnt vmcnt(2)
  v_mfma_f32_16x16x32_bf16 v[120:123], v[116:119], v[56:59], v[120:123]
  v_bitop3_b32 v48, v48, v56, s57 bitop3:0xf6
  v_bitop3_b32 v48, v48, v58, s57 bitop3:0xf6
  s_waitcnt vmcnt(1)
  v_mfma_f32_16x16x32_bf16 v[120:123], v[116:119], v[60:63], v[120:123]
  v_bitop3_b32 v48, v48, v60, s57 bitop3:0xf6
  v_bitop3_b32 v48, v48, v62, s57 bitop3:0xf6
  s_waitcnt vmcnt(0)
  v_mfma_f32_16x16x32_bf16 v[120:123], v[116:119], v[64:67], v[120:123]
  v_bitop3_b32 v48, v48, v64, s57 bitop3:0xf6
  v_bitop3_b32 v48, v48, v66, s57 bitop3:0xf6
  v_and_b32 v48, 1, v48
  v_cmp_ne_u32 vcc, 0, v48
  s_cbranch_vccnz T_p1re_24
T_p1ok_25:
  s_nop 2
  v_add_f32_dpp v120, v120, v120 row_ror:8 row_mask:0xf bank_mask:0xf
  v_add_f32_dpp v121, v121, v121 row_ror:8 row_mask:0xf bank_mask:0xf
  v_cvt_pk_bf16_f32 v48, v120, v121
  buffer_store_dword v48, v8, s[4:7], s35 offen
  buffer_store_dword v49, v8, s[4:7], s26 offen
  s_barrier
  ds_read_b128 v[28:31], v2 offset:16384
  ds_read_b128 v[32:35], v2 offset:20480
  ds_read_b128 v[36:39], v2 offset:8192
  ds_read_b128 v[40:43], v2 offset:9216
  ds_read_b128 v[44:47], v2 offset:10240
  ds_read_b128 v[48:51], v2 offset:11264
  buffer_load_dwordx4 v[124:127], v2, s[4:7], s24 offen offset:0 sc1
  buffer_load_dwordx4 v[116:119], v2, s[4:7], s25 offen offset:0 sc1
  ds_read_b128 v[52:55], v2 offset:12288
  ds_read_b128 v[56:59], v2 offset:13312
  ds_read_b128 v[60:63], v2 offset:14336
  ds_read_b128 v[64:67], v2 offset:15360
  buffer_load_dwordx4 v[124:127], v2, s[4:7], s24 offen offset:0 sc1
  buffer_load_dwordx4 v[116:119], v2, s[4:7], s25 offen offset:0 sc1
  s_add_u32 s14, s14, 1
  s_cmp_ge_i32 s14, s30
  s_cbranch_scc1 T_kvw_18
T_kvb_19:
  s_mov_b32 s19, 0
  s_branch T_loop_14
T_p1re_24:
  s_mov_b64 exec, vcc
  buffer_load_dwordx4 v[52:55], v2, s[4:7], s22 offen offset:0 sc1
  buffer_load_dwordx4 v[56:59], v2, s[4:7], s22 offen offset:1024 sc1
  buffer_load_dwordx4 v[60:63], v2, s[4:7], s22 offen offset:2048 sc1
  buffer_load_dwordx4 v[64:67], v2, s[4:7], s22 offen offset:3072 sc1
  s_mov_b64 exec, -1
  s_add_u32 s19, s19, 1
  s_cmp_gt_u32 s19, 32768
  s_cbranch_scc1 M_exit
  s_waitcnt vmcnt(3)
  v_mfma_f32_16x16x32_bf16 v[120:123], v[116:119], v[52:55], 0
  v_xor_b32 v48, s57, v52
  v_bitop3_b32 v48, v48, v54, s57 bitop3:0xf6
  s_waitcnt vmcnt(2)
  v_mfma_f32_16x16x32_bf16 v[120:123], v[116:119], v[56:59], v[120:123]
  v_bitop3_b32 v48, v48, v56, s57 bitop3:0xf6
  v_bitop3_b32 v48, v48, v58, s57 bitop3:0xf6
  s_waitcnt vmcnt(1)
  v_mfma_f32_16x16x32_bf16 v[120:123], v[116:119], v[60:63], v[120:123]
  v_bitop3_b32 v48, v48, v60, s57 bitop3:0xf6
  v_bitop3_b32 v48, v48, v62, s57 bitop3:0xf6
  s_waitcnt vmcnt(0)
  v_mfma_f32_16x16x32_bf16 v[120:123], v[116:119], v[64:67], v[120:123]
  v_bitop3_b32 v48, v48, v64, s57 bitop3:0xf6
  v_bitop3_b32 v48, v48, v66, s57 bitop3:0xf6
  v_and_b32 v48, 1, v48
  v_cmp_ne_u32 vcc, 0, v48
  s_cbranch_vccnz T_p1re_24
  s_branch T_p1ok_25
T_kvw_18:
  s_mov_b32 s19, 0
  s_branch T_kvok_27
T_kv_26:
  s_sleep 4
  s_add_u32 s19, s19, 1
  s_cmp_gt_u32 s19, 32768
  s_cbranch_scc1 M_exit
T_kvok_27:
  s_add_u32 s39, s99, 128
  s_mov_b32 s38, 0
  s_mov_b32 s37, 0
  s_atomic_or s38, s[58:59], s99 glc
  s_atomic_or s37, s[58:59], s39 glc
  s_waitcnt lgkmcnt(0)
  s_lshl_b32 s38, s38, 1
  s_lshl1_add_u32 s37, s37, 1
  s_min_u32 s38, s38, s37
  s_cmp_ge_u32 s38, 64
  s_cselect_b32 s38, 100, s38
  s_sub_u32 s38, s38, 1
  s_max_i32 s30, s30, s38
  s_cmp_ge_i32 s14, s30
  s_cbranch_scc1 T_kv_26
  s_branch T_kvb_19
T_slow_21:
  s_nop 7
  v_max3_f32 v100, v16, v17, v18
  v_max3_f32 v100, v100, v19, v20
  v_max3_f32 v100, v100, v21, v22
  v_max3_f32 v100, v100, v23, v112
  v_max3_f32 v100, v100, v113, v114
  v_max_f32 v100, v100, v115
  v_mov_b32 v101, v100
  s_nop 1
  v_permlane32_swap_b32 v100, v101
  s_nop 1
  v_max_f32 v100, v100, v101
  v_mov_b32 v101, v100
  s_nop 1
  v_permlane16_swap_b32 v100, v101
  s_nop 1
  v_max_f32 v100, v100, v101
  v_sub_f32 v16, v16, v100
  v_sub_f32 v17, v17, v100
  v_sub_f32 v18, v18, v100
  v_sub_f32 v19, v19, v100
  v_exp_f32 v16, v16
  v_exp_f32 v17, v17
  v_exp_f32 v18, v18
  v_exp_f32 v19, v19
  v_sub_f32 v20, v20, v100
  v_sub_f32 v21, v21, v100
  v_sub_f32 v22, v22, v100
  v_sub_f32 v23, v23, v100
  v_exp_f32 v20, v20
  v_exp_f32 v21, v21
  v_exp_f32 v22, v22
  v_exp_f32 v23, v23
  v_sub_f32 v112, v112, v100
  v_sub_f32 v113, v113, v100
  v_sub_f32 v114, v114, v100
  v_sub_f32 v115, v115, v100
  v_exp_f32 v112, v112
  v_exp_f32 v113, v113
  v_exp_f32 v114, v114
  v_exp_f32 v115, v115
  s_nop 0
  v_cvt_pk_bf16_f32 v44, v16, v17
  v_cvt_pk_bf16_f32 v45, v18, v19
  v_cvt_pk_bf16_f32 v46, v20, v21
  v_cvt_pk_bf16_f32 v47, v22, v23
  v_cvt_pk_bf16_f32 v84, v112, v113
  v_cvt_pk_bf16_f32 v85, v114, v115
  v_cndmask_b32 v48, v84, 0, s[16:17]
  v_cndmask_b32 v49, v85, 0, s[16:17]
  v_cndmask_b32 v50, 0, v84, s[16:17]
  v_cndmask_b32 v51, 0, v85, s[16:17]
  s_nop 1
  v_mfma_f32_16x16x16_bf16 v[88:91], v[12:13], v[48:49], 0
  v_mfma_f32_16x16x16_bf16 v[24:27], v[120:121], v[48:49], 0
  v_mfma_f32_16x16x16_bf16 v[116:119], v[120:121], v[50:51], 0
  v_mfma_f32_16x16x32_bf16 v[88:91], v[12:15], v[44:47], v[88:91]
  v_mfma_f32_16x16x32_bf16 v[24:27], v[28:31], v[44:47], v[24:27]
  v_mfma_f32_16x16x32_bf16 v[116:119], v[32:35], v[44:47], v[116:119]
  s_nop 7
  s_nop 1
  s_mov_b32 s96, -1
  s_branch T_back_22
T_w_11:
  s_mov_b32 s19, 0
  s_add_u32 s14, s14, 1
  s_and_b32 s57, s14, 1
  v_mov_b64 v[16:17], 0
  v_mov_b64 v[18:19], 0
  v_mov_b64 v[20:21], 0
  v_mov_b64 v[22:23], 0
  v_mov_b64 v[24:25], 0
  v_mov_b64 v[26:27], 0
  buffer_load_dwordx4 v[124:127], v2, s[4:7], s24 offen offset:1024 sc1
  buffer_load_dwordx4 v[116:119], v2, s[4:7], s25 offen offset:1024 sc1
  buffer_load_dwordx4 v[124:127], v2, s[4:7], s24 offen offset:1024 sc1
  buffer_load_dwordx4 v[116:119], v2, s[4:7], s25 offen offset:1024 sc1
  s_branch T_loop_28
.p2align 6
T_retry_29:
  s_mov_b64 exec, vcc
  buffer_load_dwordx4 v[124:127], v2, s[4:7], s24 offen offset:1024 sc1
  buffer_load_dwordx4 v[116:119], v2, s[4:7], s25 offen offset:1024 sc1
  s_mov_b64 exec, -1
  s_add_u32 s19, s19, 1
  s_cmp_gt_u32 s19, 32768
  s_cbranch_scc1 M_exit
  s_nop 0
  v_mov_b64 v[16:17], 0
  v_mov_b64 v[18:19], 0
T_loop_28:
  s_waitcnt vmcnt(3) lgkmcnt(0)
  v_max3_u32 v123, v124, v125, v126
  v_max_u32 v123, v123, v127
  v_mov_b32_dpp v120, v124 row_ror:8 row_mask:0xf bank_mask:0xf
  v_mov_b32_dpp v121, v125 row_ror:8 row_mask:0xf bank_mask:0xf
  s_waitcnt vmcnt(2)
  v_max3_u32 v123, v123, v116, v117
  v_max3_u32 v123, v123, v118, v119
  v_cmp_eq_u32 vcc, -1, v123
  v_smfmac_f32_16x16x64_bf16 v[16:19], v[124:127], v[68:75], v0
  s_cbranch_vccnz T_retry_29
  ds_write_b128 v2, v[124:127] offset:1024
  v_mov_b32_dpp v122, v126 row_ror:8 row_mask:0xf bank_mask:0xf
  v_smfmac_f32_16x16x64_bf16 v[20:23], v[124:127], v[76:83], v0
  s_and_b32 s57, s14, 1
  v_mov_b32_dpp v123, v127 row_ror:8 row_mask:0xf bank_mask:0xf
  v_smfmac_f32_16x16x64_bf16 v[24:27], v[124:127], v[84:91], v0
  s_and_b32 s36, s14, 3
  ds_write_b128 v2, v[116:119] offset:5120
  v_smfmac_f32_16x16x64_bf16 v[16:19], v[120:123], v[92:99], v0
  s_lshl_b32 s36, s36, 13
  v_mov_b32_dpp v84, v116 row_ror:8 row_mask:0xf bank_mask:0xf
  v_smfmac_f32_16x16x64_bf16 v[20:23], v[120:123], v[100:107], v0
  s_add_u32 s26, s36, s23
  ds_read_b128 v[68:71], v4 offset:12288
  v_mov_b32_dpp v85, v117 row_ror:8 row_mask:0xf bank_mask:0xf
  v_smfmac_f32_16x16x64_bf16 v[24:27], v[120:123], v[108:115], v0
  s_add_u32 s36, s36, 8192
  ds_read_b128 v[72:75], v4 offset:13312
  v_mov_b32_dpp v86, v118 row_ror:8 row_mask:0xf bank_mask:0xf
  v_smfmac_f32_16x16x64_bf16 v[16:19], v[116:119], v[224:231], v0
  s_and_b32 s36, s36, 0x7fff
  ds_read_b128 v[76:79], v4 offset:14336
  v_mov_b32_dpp v87, v119 row_ror:8 row_mask:0xf bank_mask:0xf
  v_smfmac_f32_16x16x64_bf16 v[20:23], v[116:119], v[240:247], v0
  s_waitcnt lgkmcnt(3)
  s_barrier
  ds_read_b128 v[100:103], v2 offset:0
  v_smfmac_f32_16x16x64_bf16 v[24:27], v[116:119], a[0:7], v0
  s_mov_b32 m0, s31
  ds_read_b128 v[120:123], v1 offset:0
  v_smfmac_f32_16x16x64_bf16 v[16:19], v[84:87], v[232:239], v0
  buffer_load_dwordx4 v9, s[4:7], s27 offen sc1 lds
  v_smfmac_f32_16x16x64_bf16 v[20:23], v[84:87], v[248:255], v0
  ds_read_b128 v[80:83], v4 offset:15360
  s_mov_b32 m0, s32
  v_smfmac_f32_16x16x64_bf16 v[24:27], v[84:87], a[8:15], v0
  s_waitcnt lgkmcnt(2)
  v_smfmac_f32_16x16x64_bf16 v[16:19], v[100:103], v[128:135], v0
  ds_read_b128 v[92:95], v2 offset:3072
  v_smfmac_f32_16x16x64_bf16 v[20:23], v[100:103], v[144:151], v0
  ds_read_b128 v[96:99], v1 offset:3072
  buffer_load_dwordx4 v9, s[4:7], s27 offen offset:128 sc1 lds
  v_smfmac_f32_16x16x64_bf16 v[24:27], v[100:103], v[68:75], v0
  s_waitcnt vmcnt(2) lgkmcnt(3)
  ds_read_b128 v[116:119], v2 offset:2048
  s_mov_b32 m0, s33
  v_smfmac_f32_16x16x64_bf16 v[16:19], v[120:123], v[136:143], v0
  ds_read_b128 v[124:127], v1 offset:2048
  v_smfmac_f32_16x16x64_bf16 v[20:23], v[120:123], v[152:159], v0
  s_waitcnt lgkmcnt(4)
  ds_read_b128 v[104:107], v2 offset:4096
  v_smfmac_f32_16x16x64_bf16 v[24:27], v[120:123], v[76:83], v0
  s_waitcnt lgkmcnt(4)
  ds_read_b128 v[108:111], v1 offset:4096
  buffer_load_dwordx4 v10, s[4:7], s28 offen sc1 lds
  v_smfmac_f32_16x16x64_bf16 v[16:19], v[92:95], v[160:167], v0
  s_waitcnt lgkmcnt(4)
  ds_read_b128 v[112:115], v2 offset:7168
  s_mov_b32 m0, s34
  v_smfmac_f32_16x16x64_bf16 v[16:19], v[96:99], v[168:175], v0
  s_waitcnt lgkmcnt(4)
  ds_read_b128 v[84:87], v1 offset:7168
  v_smfmac_f32_16x16x64_bf16 v[16:19], v[116:119], v[192:199], v0
  s_waitcnt lgkmcnt(4)
  ds_read_b128 v[88:91], v2 offset:6144
  v_smfmac_f32_16x16x64_bf16 v[16:19], v[124:127], v[200:207], v0
  s_waitcnt lgkmcnt(4)
  ds_read_b128 v[100:103], v1 offset:6144
  buffer_load_dwordx4 v10, s[4:7], s28 offen offset:256 sc1 lds
  v_smfmac_f32_16x16x64_bf16 v[16:19], v[104:107], a[16:23], v0
  s_waitcnt lgkmcnt(4)
  ds_read_b128 v[68:71], v4 offset:16384
  v_smfmac_f32_16x16x64_bf16 v[16:19], v[108:111], a[24:31], v0
  s_waitcnt lgkmcnt(4)
  ds_read_b128 v[72:75], v4 offset:17408
  v_smfmac_f32_16x16x64_bf16 v[16:19], v[112:115], a[64:71], v0
  s_waitcnt lgkmcnt(4)
  ds_read_b128 v[76:79], v4 offset:18432
  v_smfmac_f32_16x16x64_bf16 v[16:19], v[84:87], a[72:79], v0
  s_waitcnt lgkmcnt(4)
  ds_read_b128 v[80:83], v4 offset:19456
  v_smfmac_f32_16x16x64_bf16 v[16:19], v[88:91], a[112:119], v0
  s_waitcnt lgkmcnt(4)
  v_smfmac_f32_16x16x64_bf16 v[16:19], v[100:103], a[120:127], v0
  s_add_u32 s24, s36, 145752064
  s_add_u32 s25, s36, 145756160
  v_smfmac_f32_16x16x64_bf16 v[20:23], v[92:95], v[176:183], v0
  s_add_u32 s35, s36, s23
  v_smfmac_f32_16x16x64_bf16 v[20:23], v[96:99], v[184:191], v0
  s_waitcnt lgkmcnt(2)
  v_smfmac_f32_16x16x64_bf16 v[20:23], v[116:119], v[68:75], v0
  s_waitcnt lgkmcnt(0)
  ds_read_b128 v[68:71], v4 offset:20480
  v_mul_f32 v16, s18, v16
  v_smfmac_f32_16x16x64_bf16 v[20:23], v[124:127], v[76:83], v0
  ds_read_b128 v[72:75], v4 offset:21504
  v_mul_f32 v17, s18, v17
  v_smfmac_f32_16x16x64_bf16 v[20:23], v[104:107], a[32:39], v0
  ds_read_b128 v[76:79], v4 offset:22528
  v_mul_f32 v18, s18, v18
  v_smfmac_f32_16x16x64_bf16 v[20:23], v[108:111], a[40:47], v0
  ds_read_b128 v[80:83], v4 offset:23552
  v_mul_f32 v19, s18, v19
  v_smfmac_f32_16x16x64_bf16 v[20:23], v[112:115], a[80:87], v0
  v_cvt_pk_bf16_f32 v120, v16, v17
  v_smfmac_f32_16x16x64_bf16 v[20:23], v[84:87], a[88:95], v0
  v_cvt_pk_bf16_f32 v121, v18, v19
  v_smfmac_f32_16x16x64_bf16 v[20:23], v[88:91], a[128:135], v0
  ds_write_b64 v5, v[120:121] offset:24576
  v_smfmac_f32_16x16x64_bf16 v[20:23], v[100:103], a[136:143], v0
  s_waitcnt lgkmcnt(3)
  v_smfmac_f32_16x16x64_bf16 v[24:27], v[92:95], v[68:75], v0
  s_waitcnt lgkmcnt(1)
  v_mov_b64 v[92:93], 0
  v_smfmac_f32_16x16x64_bf16 v[24:27], v[96:99], v[76:83], v0
  s_nop 1
  v_cvt_pk_bf16_f32 v122, v20, v21
  v_cvt_pk_bf16_f32 v123, v22, v23
  v_smfmac_f32_16x16x64_bf16 v[24:27], v[116:119], v[208:215], v0
  ds_write_b64 v5, v[122:123] offset:26880
  v_mov_b64 v[94:95], 0
  v_smfmac_f32_16x16x64_bf16 v[24:27], v[124:127], v[216:223], v0
  s_waitcnt lgkmcnt(1)
  s_barrier
  ds_read_b64_tr_b16 v[68:69], v6 offset:24576
  v_smfmac_f32_16x16x64_bf16 v[24:27], v[104:107], a[48:55], v0
  s_add_u32 s27, s27, 8192
  ds_read_b64_tr_b16 v[70:71], v6 offset:24640
  ds_read_b64_tr_b16 v[72:73], v6 offset:24832
  v_smfmac_f32_16x16x64_bf16 v[24:27], v[108:111], a[56:63], v0
  s_add_u32 s28, s28, 8192
  ds_read_b64_tr_b16 v[74:75], v6 offset:24896
  ds_read_b64_tr_b16 v[76:77], v6 offset:25088
  v_smfmac_f32_16x16x64_bf16 v[24:27], v[112:115], a[96:103], v0
  s_nop 0
  ds_read_b64_tr_b16 v[78:79], v6 offset:25152
  ds_read_b64_tr_b16 v[80:81], v6 offset:25344
  v_smfmac_f32_16x16x64_bf16 v[24:27], v[84:87], a[104:111], v0
  ds_read_b64_tr_b16 v[82:83], v6 offset:25408
  v_mov_b64 v[96:97], 0
  v_smfmac_f32_16x16x64_bf16 v[24:27], v[88:91], a[144:151], v0
  s_waitcnt lgkmcnt(8)
  s_barrier
  ds_read_b64_tr_b16 v[116:117], v6 offset:26880
  v_smfmac_f32_16x16x64_bf16 v[24:27], v[100:103], a[152:159], v0
  s_waitcnt lgkmcnt(7)
  ds_read_b64_tr_b16 v[118:119], v6 offset:26944
  v_mfma_f32_16x16x32_bf16 v[16:19], v[36:39], v[68:71], 0
  s_waitcnt lgkmcnt(6)
  ds_read_b64_tr_b16 v[124:125], v6 offset:27136
  ds_read_b64_tr_b16 v[126:127], v6 offset:27200
  v_mfma_f32_16x16x32_bf16 v[16:19], v[40:43], v[72:75], v[16:19]
  s_waitcnt lgkmcnt(6)
  ds_read_b64_tr_b16 v[104:105], v6 offset:27392
  ds_read_b64_tr_b16 v[106:107], v6 offset:27456
  v_mfma_f32_16x16x32_bf16 v[16:19], v[44:47], v[76:79], v[16:19]
  s_waitcnt lgkmcnt(6)
  ds_read_b64_tr_b16 v[108:109], v6 offset:27648
  ds_read_b64_tr_b16 v[110:111], v6 offset:27712
  v_mfma_f32_16x16x32_bf16 v[16:19], v[48:51], v[80:83], v[16:19]
  s_waitcnt lgkmcnt(6)
  v_cvt_pk_bf16_f32 v120, v24, v25
  v_cvt_pk_bf16_f32 v121, v26, v27
  v_mfma_f32_16x16x32_bf16 v[112:115], v[116:119], v[68:71], 0
  s_waitcnt lgkmcnt(4)
  v_mov_b64 v[98:99], 0
  v_mfma_f32_16x16x32_bf16 v[112:115], v[124:127], v[72:75], v[112:115]
  s_waitcnt lgkmcnt(2)
  buffer_store_dwordx4 v[120:123], v2, s[4:7], s29 offen offset:1024 sc1
  v_mov_b64 v[36:37], 0
  v_exp_f32 v100, v16
  v_mfma_f32_16x16x32_bf16 v[112:115], v[104:107], v[76:79], v[112:115]
  s_waitcnt lgkmcnt(0)
  v_exp_f32 v101, v17
  v_mfma_f32_16x16x32_bf16 v[112:115], v[108:111], v[80:83], v[112:115]
  v_exp_f32 v102, v18
  v_mfma_f32_16x16x32_bf16 v[20:23], v[52:55], v[68:71], 0
  v_exp_f32 v103, v19
  v_mfma_f32_16x16x32_bf16 v[20:23], v[56:59], v[72:75], v[20:23]
  v_cvt_pk_bf16_f32 v44, v100, v101
  v_cvt_pk_bf16_f32 v45, v102, v103
  v_mfma_f32_16x16x32_bf16 v[20:23], v[60:63], v[76:79], v[20:23]
  s_add_u32 s29, s29, 131072
  v_exp_f32 v100, v112
  v_mfma_f32_16x16x32_bf16 v[20:23], v[64:67], v[80:83], v[20:23]
  v_exp_f32 v101, v113
  v_exp_f32 v102, v114
  v_exp_f32 v103, v115
  v_cvt_pk_bf16_f32 v84, v100, v101
  v_cvt_pk_bf16_f32 v85, v102, v103
  v_cndmask_b32 v48, v84, 0, s[16:17]
  v_cndmask_b32 v49, v85, 0, s[16:17]
  v_cndmask_b32 v50, 0, v84, s[16:17]
  v_cndmask_b32 v51, 0, v85, s[16:17]
  v_exp_f32 v100, v20
  v_mfma_f32_16x16x16_bf16 v[88:91], v[12:13], v[48:49], 0
  v_exp_f32 v101, v21
  v_mfma_f32_16x16x16_bf16 v[24:27], v[120:121], v[48:49], 0
  v_exp_f32 v102, v22
  v_mfma_f32_16x16x16_bf16 v[116:119], v[120:121], v[50:51], 0
  v_exp_f32 v103, v23
  v_cvt_pk_bf16_f32 v46, v100, v101
  v_cvt_pk_bf16_f32 v47, v102, v103
  v_mov_b64 v[38:39], 0
  s_nop 0
  v_mfma_f32_16x16x32_bf16 v[88:91], v[12:15], v[44:47], v[88:91]
  v_mov_b64 v[40:41], 0
  v_mov_b64 v[42:43], 0
  v_mfma_f32_16x16x32_bf16 v[24:27], v[28:31], v[44:47], v[24:27]
  ds_read_b128 v[52:55], v4 offset:24576
  ds_read_b128 v[56:59], v4 offset:25600
  v_mfma_f32_16x16x32_bf16 v[116:119], v[32:35], v[44:47], v[116:119]
  s_nop 1
T_back_36:
  v_rcp_f32 v89, v88
  v_subrev_u32 v100, s54, v88
  v_cmp_le_u32 vcc, s96, v100
  v_mul_f32 v24, v89, v24
  v_mul_f32 v25, v89, v25
  v_cvt_pk_bf16_f32 v124, v24, v25
  v_pk_mul_f32 v[26:27], v[26:27], v[88:89] op_sel:[0,1] op_sel_hi:[1,1]
  v_pk_mul_f32 v[116:117], v[116:117], v[88:89] op_sel:[0,1] op_sel_hi:[1,1]
  v_pk_mul_f32 v[118:119], v[118:119], v[88:89] op_sel:[0,1] op_sel_hi:[1,1]
  v_cvt_pk_bf16_f32 v125, v26, v27
  v_cvt_pk_bf16_f32 v126, v116, v117
  v_cvt_pk_bf16_f32 v127, v118, v119
  ds_write_b128 v11, v[124:127] offset:29696
  s_cbranch_vccnz T_slow_35
  v_smfmac_f32_16x16x64_bf16 v[92:95], v[124:127], a[160:167], v0
  s_mov_b32 s96, s55
  v_smfmac_f32_16x16x64_bf16 v[96:99], v[124:127], a[168:175], v0
  s_cmp_eq_u32 s14, 63
  v_smfmac_f32_16x16x64_bf16 v[36:39], v[124:127], a[176:183], v0
  s_waitcnt lgkmcnt(0)
  s_barrier
  ds_read_b128 v[104:107], v11 offset:29184
  ds_read_b128 v[108:111], v11 offset:30720
  ds_read_b128 v[68:71], v11 offset:30208
  s_cbranch_scc1 M_tdone
  v_smfmac_f32_16x16x64_bf16 v[40:43], v[124:127], a[184:191], v0
  s_waitcnt lgkmcnt(2)
  v_smfmac_f32_16x16x64_bf16 v[92:95], v[104:107], a[192:199], v0
  s_waitcnt lgkmcnt(1)
  ds_read_b128 v[76:79], v4 offset:28672
  v_smfmac_f32_16x16x64_bf16 v[92:95], v[108:111], a[224:231], v0
  s_waitcnt lgkmcnt(1)
  ds_read_b128 v[80:83], v4 offset:29696
  v_smfmac_f32_16x16x64_bf16 v[92:95], v[68:71], a[240:247], v0
  ds_read_b128 v[60:63], v4 offset:26624
  v_smfmac_f32_16x16x64_bf16 v[96:99], v[104:107], a[200:207], v0
  ds_read_b128 v[64:67], v4 offset:27648
  v_smfmac_f32_16x16x64_bf16 v[96:99], v[108:111], a[232:239], v0
  ds_read_b128 v[28:31], v4 offset:30720
  s_nop 0
  v_cvt_pk_bf16_f32 v16, v92, v93
  v_cvt_pk_bf16_f32 v17, v94, v95
  v_bfi_b32 v16, 1, s57, v16
  v_smfmac_f32_16x16x64_bf16 v[96:99], v[68:71], a[248:255], v0
  buffer_store_dwordx2 v[16:17], v7, s[4:7], s20 offen offset:0
  v_smfmac_f32_16x16x64_bf16 v[36:39], v[104:107], a[208:215], v0
  ds_read_b128 v[32:35], v4 offset:31744
  v_smfmac_f32_16x16x64_bf16 v[36:39], v[108:111], v[52:59], v0
  s_waitcnt lgkmcnt(4)
  s_nop 0
  v_cvt_pk_bf16_f32 v18, v96, v97
  v_cvt_pk_bf16_f32 v19, v98, v99
  v_bfi_b32 v18, 1, s57, v18
  v_smfmac_f32_16x16x64_bf16 v[36:39], v[68:71], v[76:83], v0
  buffer_store_dwordx2 v[18:19], v7, s[4:7], s20 offen offset:64
  v_smfmac_f32_16x16x64_bf16 v[40:43], v[104:107], a[216:223], v0
  s_waitcnt lgkmcnt(2)
  ds_read_b128 v[116:119], v2 offset:31232
  v_smfmac_f32_16x16x64_bf16 v[40:43], v[108:111], v[60:67], v0
  s_waitcnt lgkmcnt(1)
  s_nop 0
  v_cvt_pk_bf16_f32 v20, v36, v37
  v_cvt_pk_bf16_f32 v21, v38, v39
  v_bfi_b32 v20, 1, s57, v20
  v_smfmac_f32_16x16x64_bf16 v[40:43], v[68:71], v[28:35], v0
  buffer_store_dwordx2 v[20:21], v7, s[4:7], s21 offen offset:0
  s_nop 6
  v_cvt_pk_bf16_f32 v22, v40, v41
  v_cvt_pk_bf16_f32 v23, v42, v43
  v_bfi_b32 v22, 1, s57, v22
  buffer_store_dwordx2 v[22:23], v7, s[4:7], s21 offen offset:64
  ds_read_b128 v[68:71], v4 offset:0
  ds_read_b128 v[72:75], v4 offset:1024
  ds_read_b128 v[76:79], v4 offset:4096
  ds_read_b128 v[80:83], v4 offset:5120
  ds_read_b128 v[84:87], v4 offset:8192
  ds_read_b128 v[88:91], v4 offset:9216
  ds_read_b128 v[92:95], v4 offset:2048
  ds_read_b128 v[96:99], v4 offset:3072
  ds_read_b128 v[100:103], v4 offset:6144
  ds_read_b128 v[104:107], v4 offset:7168
  ds_read_b128 v[108:111], v4 offset:10240
  ds_read_b128 v[112:115], v4 offset:11264
  v_mov_b64 v[16:17], 0
  v_mov_b64 v[18:19], 0
  v_mov_b64 v[20:21], 0
  v_mov_b64 v[22:23], 0
  v_mov_b64 v[24:25], 0
  v_mov_b64 v[26:27], 0
  s_mov_b32 s19, 0
  v_mov_b32 v49, -1
  ds_read_b64 v[44:45], v2 offset:32256
  s_waitcnt lgkmcnt(0)
  v_readfirstlane_b32 s38, v44
  v_readfirstlane_b32 s37, v45
  s_nop 0
  s_lshl_b32 s38, s38, 1
  s_lshl1_add_u32 s37, s37, 1
  s_min_u32 s38, s38, s37
  s_cmp_ge_u32 s38, 64
  s_cselect_b32 s38, 100, s38
  s_sub_u32 s38, s38, 1
  s_max_i32 s30, s30, s38
  s_waitcnt vmcnt(0)
  buffer_load_dwordx4 v[52:55], v2, s[4:7], s22 offen offset:0 sc1
  buffer_load_dwordx4 v[56:59], v2, s[4:7], s22 offen offset:1024 sc1
  buffer_load_dwordx4 v[60:63], v2, s[4:7], s22 offen offset:2048 sc1
  buffer_load_dwordx4 v[64:67], v2, s[4:7], s22 offen offset:3072 sc1
  s_waitcnt lgkmcnt(12)
  s_waitcnt vmcnt(3)
  v_mfma_f32_16x16x32_bf16 v[120:123], v[116:119], v[52:55], 0
  v_xor_b32 v48, s57, v52
  v_bitop3_b32 v48, v48, v54, s57 bitop3:0xf6
  s_waitcnt vmcnt(2)
  v_mfma_f32_16x16x32_bf16 v[120:123], v[116:119], v[56:59], v[120:123]
  v_bitop3_b32 v48, v48, v56, s57 bitop3:0xf6
  v_bitop3_b32 v48, v48, v58, s57 bitop3:0xf6
  s_waitcnt vmcnt(1)
  v_mfma_f32_16x16x32_bf16 v[120:123], v[116:119], v[60:63], v[120:123]
  v_bitop3_b32 v48, v48, v60, s57 bitop3:0xf6
  v_bitop3_b32 v48, v48, v62, s57 bitop3:0xf6
  s_waitcnt vmcnt(0)
  v_mfma_f32_16x16x32_bf16 v[120:123], v[116:119], v[64:67], v[120:123]
  v_bitop3_b32 v48, v48, v64, s57 bitop3:0xf6
  v_bitop3_b32 v48, v48, v66, s57 bitop3:0xf6
  v_and_b32 v48, 1, v48
  v_cmp_ne_u32 vcc, 0, v48
  s_cbranch_vccnz T_p1re_38
T_p1ok_39:
  s_nop 2
  v_add_f32_dpp v120, v120, v120 row_ror:8 row_mask:0xf bank_mask:0xf
  v_add_f32_dpp v121, v121, v121 row_ror:8 row_mask:0xf bank_mask:0xf
  v_cvt_pk_bf16_f32 v48, v120, v121
  buffer_store_dword v48, v8, s[4:7], s35 offen
  buffer_store_dword v49, v8, s[4:7], s26 offen
  s_barrier
  ds_read_b128 v[28:31], v2 offset:17408
  ds_read_b128 v[32:35], v2 offset:21504
  ds_read_b128 v[36:39], v2 offset:8192
  ds_read_b128 v[40:43], v2 offset:9216
  ds_read_b128 v[44:47], v2 offset:10240
  ds_read_b128 v[48:51], v2 offset:11264
  buffer_load_dwordx4 v[124:127], v2, s[4:7], s24 offen offset:1024 sc1
  buffer_load_dwordx4 v[116:119], v2, s[4:7], s25 offen offset:1024 sc1
  ds_read_b128 v[52:55], v2 offset:12288
  ds_read_b128 v[56:59], v2 offset:13312
  ds_read_b128 v[60:63], v2 offset:14336
  ds_read_b128 v[64:67], v2 offset:15360
  buffer_load_dwordx4 v[124:127], v2, s[4:7], s24 offen offset:1024 sc1
  buffer_load_dwordx4 v[116:119], v2, s[4:7], s25 offen offset:1024 sc1
  s_add_u32 s14, s14, 1
  s_cmp_ge_i32 s14, s30
  s_cbranch_scc1 T_kvw_32
T_kvb_33:
  s_mov_b32 s19, 0
  s_branch T_loop_28
T_p1re_38:
  s_mov_b64 exec, vcc
  buffer_load_dwordx4 v[52:55], v2, s[4:7], s22 offen offset:0 sc1
  buffer_load_dwordx4 v[56:59], v2, s[4:7], s22 offen offset:1024 sc1
  buffer_load_dwordx4 v[60:63], v2, s[4:7], s22 offen offset:2048 sc1
  buffer_load_dwordx4 v[64:67], v2, s[4:7], s22 offen offset:3072 sc1
  s_mov_b64 exec, -1
  s_add_u32 s19, s19, 1
  s_cmp_gt_u32 s19, 32768
  s_cbranch_scc1 M_exit
  s_waitcnt vmcnt(3)
  v_mfma_f32_16x16x32_bf16 v[120:123], v[116:119], v[52:55], 0
  v_xor_b32 v48, s57, v52
  v_bitop3_b32 v48, v48, v54, s57 bitop3:0xf6
  s_waitcnt vmcnt(2)
  v_mfma_f32_16x16x32_bf16 v[120:123], v[116:119], v[56:59], v[120:123]
  v_bitop3_b32 v48, v48, v56, s57 bitop3:0xf6
  v_bitop3_b32 v48, v48, v58, s57 bitop3:0xf6
  s_waitcnt vmcnt(1)
  v_mfma_f32_16x16x32_bf16 v[120:123], v[116:119], v[60:63], v[120:123]
  v_bitop3_b32 v48, v48, v60, s57 bitop3:0xf6
  v_bitop3_b32 v48, v48, v62, s57 bitop3:0xf6
  s_waitcnt vmcnt(0)
  v_mfma_f32_16x16x32_bf16 v[120:123], v[116:119], v[64:67], v[120:123]
  v_bitop3_b32 v48, v48, v64, s57 bitop3:0xf6
  v_bitop3_b32 v48, v48, v66, s57 bitop3:0xf6
  v_and_b32 v48, 1, v48
  v_cmp_ne_u32 vcc, 0, v48
  s_cbranch_vccnz T_p1re_38
  s_branch T_p1ok_39
T_kvw_32:
  s_mov_b32 s19, 0
  s_branch T_kvok_41
T_kv_40:
  s_sleep 4
  s_add_u32 s19, s19, 1
  s_cmp_gt_u32 s19, 32768
  s_cbranch_scc1 M_exit
T_kvok_41:
  s_add_u32 s39, s99, 128
  s_mov_b32 s38, 0
  s_mov_b32 s37, 0
  s_atomic_or s38, s[58:59], s99 glc
  s_atomic_or s37, s[58:59], s39 glc
  s_waitcnt lgkmcnt(0)
  s_lshl_b32 s38, s38, 1
  s_lshl1_add_u32 s37, s37, 1
  s_min_u32 s38, s38, s37
  s_cmp_ge_u32 s38, 64
  s_cselect_b32 s38, 100, s38
  s_sub_u32 s38, s38, 1
  s_max_i32 s30, s30, s38
  s_cmp_ge_i32 s14, s30
  s_cbranch_scc1 T_kv_40
  s_branch T_kvb_33
T_slow_35:
  s_nop 7
  v_max3_f32 v100, v16, v17, v18
  v_max3_f32 v100, v100, v19, v20
  v_max3_f32 v100, v100, v21, v22
  v_max3_f32 v100, v100, v23, v112
  v_max3_f32 v100, v100, v113, v114
  v_max_f32 v100, v100, v115
  v_mov_b32 v101, v100
  s_nop 1
  v_permlane32_swap_b32 v100, v101
  s_nop 1
  v_max_f32 v100, v100, v101
  v_mov_b32 v101, v100
  s_nop 1
  v_permlane16_swap_b32 v100, v101
  s_nop 1
  v_max_f32 v100, v100, v101
  v_sub_f32 v16, v16, v100
  v_sub_f32 v17, v17, v100
  v_sub_f32 v18, v18, v100
  v_sub_f32 v19, v19, v100
  v_exp_f32 v16, v16
  v_exp_f32 v17, v17
  v_exp_f32 v18, v18
  v_exp_f32 v19, v19
  v_sub_f32 v20, v20, v100
  v_sub_f32 v21, v21, v100
  v_sub_f32 v22, v22, v100
  v_sub_f32 v23, v23, v100
  v_exp_f32 v20, v20
  v_exp_f32 v21, v21
  v_exp_f32 v22, v22
  v_exp_f32 v23, v23
  v_sub_f32 v112, v112, v100
  v_sub_f32 v113, v113, v100
  v_sub_f32 v114, v114, v100
  v_sub_f32 v115, v115, v100
  v_exp_f32 v112, v112
  v_exp_f32 v113, v113
  v_exp_f32 v114, v114
  v_exp_f32 v115, v115
  s_nop 0
  v_cvt_pk_bf16_f32 v44, v16, v17
  v_cvt_pk_bf16_f32 v45, v18, v19
  v_cvt_pk_bf16_f32 v46, v20, v21
  v_cvt_pk_bf16_f32 v47, v22, v23
  v_cvt_pk_bf16_f32 v84, v112, v113
  v_cvt_pk_bf16_f32 v85, v114, v115
  v_cndmask_b32 v48, v84, 0, s[16:17]
  v_cndmask_b32 v49, v85, 0, s[16:17]
  v_cndmask_b32 v50, 0, v84, s[16:17]
  v_cndmask_b32 v51, 0, v85, s[16:17]
  s_nop 1
  v_mfma_f32_16x16x16_bf16 v[88:91], v[12:13], v[48:49], 0
  v_mfma_f32_16x16x16_bf16 v[24:27], v[120:121], v[48:49], 0
  v_mfma_f32_16x16x16_bf16 v[116:119], v[120:121], v[50:51], 0
  v_mfma_f32_16x16x32_bf16 v[88:91], v[12:15], v[44:47], v[88:91]
  v_mfma_f32_16x16x32_bf16 v[24:27], v[28:31], v[44:47], v[24:27]
  v_mfma_f32_16x16x32_bf16 v[116:119], v[32:35], v[44:47], v[116:119]
  s_nop 7
  s_nop 1
  s_mov_b32 s96, -1
  s_branch T_back_36
T_w_12:
  s_mov_b32 s19, 0
  s_add_u32 s14, s14, 1
  s_and_b32 s57, s14, 1
  v_mov_b64 v[16:17], 0
  v_mov_b64 v[18:19], 0
  v_mov_b64 v[20:21], 0
  v_mov_b64 v[22:23], 0
  v_mov_b64 v[24:25], 0
  v_mov_b64 v[26:27], 0
  buffer_load_dwordx4 v[124:127], v2, s[4:7], s24 offen offset:2048 sc1
  buffer_load_dwordx4 v[116:119], v2, s[4:7], s25 offen offset:2048 sc1
  buffer_load_dwordx4 v[124:127], v2, s[4:7], s24 offen offset:2048 sc1
  buffer_load_dwordx4 v[116:119], v2, s[4:7], s25 offen offset:2048 sc1
  s_branch T_loop_42
.p2align 6
T_retry_43:
  s_mov_b64 exec, vcc
  buffer_load_dwordx4 v[124:127], v2, s[4:7], s24 offen offset:2048 sc1
  buffer_load_dwordx4 v[116:119], v2, s[4:7], s25 offen offset:2048 sc1
  s_mov_b64 exec, -1
  s_add_u32 s19, s19, 1
  s_cmp_gt_u32 s19, 32768
  s_cbranch_scc1 M_exit
  s_nop 0
  v_mov_b64 v[16:17], 0
  v_mov_b64 v[18:19], 0
T_loop_42:
  s_waitcnt vmcnt(3) lgkmcnt(0)
  v_max3_u32 v123, v124, v125, v126
  v_max_u32 v123, v123, v127
  v_mov_b32_dpp v120, v124 row_ror:8 row_mask:0xf bank_mask:0xf
  v_mov_b32_dpp v121, v125 row_ror:8 row_mask:0xf bank_mask:0xf
  s_waitcnt vmcnt(2)
  v_max3_u32 v123, v123, v116, v117
  v_max3_u32 v123, v123, v118, v119
  v_cmp_eq_u32 vcc, -1, v123
  v_smfmac_f32_16x16x64_bf16 v[16:19], v[124:127], v[68:75], v0
  s_cbranch_vccnz T_retry_43
  ds_write_b128 v2, v[124:127] offset:2048
  v_mov_b32_dpp v122, v126 row_ror:8 row_mask:0xf bank_mask:0xf
  v_smfmac_f32_16x16x64_bf16 v[20:23], v[124:127], v[76:83], v0
  s_and_b32 s57, s14, 1
  v_mov_b32_dpp v123, v127 row_ror:8 row_mask:0xf bank_mask:0xf
  v_smfmac_f32_16x16x64_bf16 v[24:27], v[124:127], v[84:91], v0
  s_and_b32 s36, s14, 3
  ds_write_b128 v2, v[116:119] offset:6144
  v_smfmac_f32_16x16x64_bf16 v[16:19], v[120:123], v[92:99], v0
  s_lshl_b32 s36, s36, 13
  v_mov_b32_dpp v84, v116 row_ror:8 row_mask:0xf bank_mask:0xf
  v_smfmac_f32_16x16x64_bf16 v[20:23], v[120:123], v[100:107], v0
  s_add_u32 s26, s36, s23
  ds_read_b128 v[68:71], v4 offset:12288
  v_mov_b32_dpp v85, v117 row_ror:8 row_mask:0xf bank_mask:0xf
  v_smfmac_f32_16x16x64_bf16 v[24:27], v[120:123], v[108:115], v0
  s_add_u32 s36, s36, 8192
  ds_read_b128 v[72:75], v4 offset:13312
  v_mov_b32_dpp v86, v118 row_ror:8 row_mask:0xf bank_mask:0xf
  v_smfmac_f32_16x16x64_bf16 v[16:19], v[116:119], v[224:231], v0
  s_and_b32 s36, s36, 0x7fff
  ds_read_b128 v[76:79], v4 offset:14336
  v_mov_b32_dpp v87, v119 row_ror:8 row_mask:0xf bank_mask:0xf
  v_smfmac_f32_16x16x64_bf16 v[20:23], v[116:119], v[240:247], v0
  s_waitcnt lgkmcnt(3)
  s_barrier
  ds_read_b128 v[100:103], v2 offset:3072
  v_smfmac_f32_16x16x64_bf16 v[24:27], v[116:119], a[0:7], v0
  s_mov_b32 m0, s31
  ds_read_b128 v[120:123], v1 offset:3072
  v_smfmac_f32_16x16x64_bf16 v[16:19], v[84:87], v[232:239], v0
  v_smfmac_f32_16x16x64_bf16 v[20:23], v[84:87], v[248:255], v0
  ds_read_b128 v[80:83], v4 offset:15360
  buffer_load_dwordx4 v9, s[4:7], s27 offen sc1 lds
  v_smfmac_f32_16x16x64_bf16 v[24:27], v[84:87], a[8:15], v0
  s_waitcnt lgkmcnt(2)
  s_mov_b32 m0, s32
  v_smfmac_f32_16x16x64_bf16 v[16:19], v[100:103], v[128:135], v0
  ds_read_b128 v[92:95], v2 offset:0
  v_smfmac_f32_16x16x64_bf16 v[20:23], v[100:103], v[144:151], v0
  ds_read_b128 v[96:99], v1 offset:0
  v_smfmac_f32_16x16x64_bf16 v[24:27], v[100:103], v[68:75], v0
  s_waitcnt vmcnt(1) lgkmcnt(3)
  ds_read_b128 v[116:119], v2 offset:1024
  buffer_load_dwordx4 v9, s[4:7], s27 offen offset:128 sc1 lds
  v_smfmac_f32_16x16x64_bf16 v[16:19], v[120:123], v[136:143], v0
  ds_read_b128 v[124:127], v1 offset:1024
  s_mov_b32 m0, s33
  v_smfmac_f32_16x16x64_bf16 v[20:23], v[120:123], v[152:159], v0
  s_waitcnt lgkmcnt(4)
  ds_read_b128 v[104:107], v2 offset:7168
  v_smfmac_f32_16x16x64_bf16 v[24:27], v[120:123], v[76:83], v0
  s_waitcnt lgkmcnt(4)
  ds_read_b128 v[108:111], v1 offset:7168
  v_smfmac_f32_16x16x64_bf16 v[16:19], v[92:95], v[160:167], v0
  s_waitcnt lgkmcnt(4)
  ds_read_b128 v[112:115], v2 offset:4096
  v_mov_b32 v122, s98
  buffer_load_dwordx4 v10, s[4:7], s28 offen sc1 lds
  v_smfmac_f32_16x16x64_bf16 v[16:19], v[96:99], v[168:175], v0
  s_waitcnt lgkmcnt(4)
  ds_read_b128 v[84:87], v1 offset:4096
  s_mov_b32 m0, s34
  v_smfmac_f32_16x16x64_bf16 v[16:19], v[116:119], v[192:199], v0
  s_waitcnt lgkmcnt(4)
  ds_read_b128 v[88:91], v2 offset:5120
  v_smfmac_f32_16x16x64_bf16 v[16:19], v[124:127], v[200:207], v0
  s_waitcnt lgkmcnt(4)
  ds_read_b128 v[100:103], v1 offset:5120
  v_smfmac_f32_16x16x64_bf16 v[16:19], v[104:107], a[16:23], v0
  s_waitcnt lgkmcnt(4)
  ds_read_b128 v[68:71], v4 offset:16384
  buffer_load_dwordx4 v10, s[4:7], s28 offen offset:256 sc1 lds
  v_smfmac_f32_16x16x64_bf16 v[16:19], v[108:111], a[24:31], v0
  s_waitcnt lgkmcnt(4)
  ds_read_b128 v[72:75], v4 offset:17408
  v_smfmac_f32_16x16x64_bf16 v[16:19], v[112:115], a[64:71], v0
  s_waitcnt lgkmcnt(4)
  ds_read_b128 v[76:79], v4 offset:18432
  v_smfmac_f32_16x16x64_bf16 v[16:19], v[84:87], a[72:79], v0
  s_waitcnt lgkmcnt(4)
  ds_read_b128 v[80:83], v4 offset:19456
  v_smfmac_f32_16x16x64_bf16 v[16:19], v[88:91], a[112:119], v0
  s_waitcnt lgkmcnt(4)
  buffer_store_dword v122, v3, s[4:7], s15 offen sc1
  v_smfmac_f32_16x16x64_bf16 v[16:19], v[100:103], a[120:127], v0
  s_add_u32 s98, s14, 1
  s_add_u32 s24, s36, 145752064
  s_add_u32 s25, s36, 145756160
  v_smfmac_f32_16x16x64_bf16 v[20:23], v[92:95], v[176:183], v0
  s_add_u32 s35, s36, s23
  v_smfmac_f32_16x16x64_bf16 v[20:23], v[96:99], v[184:191], v0
  s_waitcnt lgkmcnt(2)
  v_smfmac_f32_16x16x64_bf16 v[20:23], v[116:119], v[68:75], v0
  s_waitcnt lgkmcnt(0)
  ds_read_b128 v[68:71], v4 offset:20480
  v_mul_f32 v16, s18, v16
  v_smfmac_f32_16x16x64_bf16 v[20:23], v[124:127], v[76:83], v0
  ds_read_b128 v[72:75], v4 offset:21504
  v_mul_f32 v17, s18, v17
  v_smfmac_f32_16x16x64_bf16 v[20:23], v[104:107], a[32:39], v0
  ds_read_b128 v[76:79], v4 offset:22528
  v_mul_f32 v18, s18, v18
  v_smfmac_f32_16x16x64_bf16 v[20:23], v[108:111], a[40:47], v0
  ds_read_b128 v[80:83], v4 offset:23552
  v_mul_f32 v19, s18, v19
  v_smfmac_f32_16x16x64_bf16 v[20:23], v[112:115], a[80:87], v0
  v_cvt_pk_bf16_f32 v120, v16, v17
  v_smfmac_f32_16x16x64_bf16 v[20:23], v[84:87], a[88:95], v0
  v_cvt_pk_bf16_f32 v121, v18, v19
  v_smfmac_f32_16x16x64_bf16 v[20:23], v[88:91], a[128:135], v0
  ds_write_b64 v5, v[120:121] offset:24576
  v_smfmac_f32_16x16x64_bf16 v[20:23], v[100:103], a[136:143], v0
  s_waitcnt lgkmcnt(3)
  v_smfmac_f32_16x16x64_bf16 v[24:27], v[92:95], v[68:75], v0
  s_waitcnt lgkmcnt(1)
  v_mov_b64 v[92:93], 0
  v_smfmac_f32_16x16x64_bf16 v[24:27], v[96:99], v[76:83], v0
  s_nop 1
  v_cvt_pk_bf16_f32 v122, v20, v21
  v_cvt_pk_bf16_f32 v123, v22, v23
  v_smfmac_f32_16x16x64_bf16 v[24:27], v[116:119], v[208:215], v0
  ds_write_b64 v5, v[122:123] offset:26880
  v_mov_b64 v[94:95], 0
  v_smfmac_f32_16x16x64_bf16 v[24:27], v[124:127], v[216:223], v0
  s_waitcnt lgkmcnt(1)
  s_barrier
  ds_read_b64_tr_b16 v[68:69], v6 offset:24576
  v_smfmac_f32_16x16x64_bf16 v[24:27], v[104:107], a[48:55], v0
  s_add_u32 s27, s27, 8192
  ds_read_b64_tr_b16 v[70:71], v6 offset:24640
  ds_read_b64_tr_b16 v[72:73], v6 offset:24832
  v_smfmac_f32_16x16x64_bf16 v[24:27], v[108:111], a[56:63], v0
  s_add_u32 s28, s28, 8192
  ds_read_b64_tr_b16 v[74:75], v6 offset:24896
  ds_read_b64_tr_b16 v[76:77], v6 offset:25088
  v_smfmac_f32_16x16x64_bf16 v[24:27], v[112:115], a[96:103], v0
  s_nop 0
  ds_read_b64_tr_b16 v[78:79], v6 offset:25152
  ds_read_b64_tr_b16 v[80:81], v6 offset:25344
  v_smfmac_f32_16x16x64_bf16 v[24:27], v[84:87], a[104:111], v0
  ds_read_b64_tr_b16 v[82:83], v6 offset:25408
  v_mov_b64 v[96:97], 0
  v_smfmac_f32_16x16x64_bf16 v[24:27], v[88:91], a[144:151], v0
  s_waitcnt lgkmcnt(8)
  s_barrier
  ds_read_b64_tr_b16 v[116:117], v6 offset:26880
  v_smfmac_f32_16x16x64_bf16 v[24:27], v[100:103], a[152:159], v0
  s_waitcnt lgkmcnt(7)
  ds_read_b64_tr_b16 v[118:119], v6 offset:26944
  v_mfma_f32_16x16x32_bf16 v[16:19], v[36:39], v[68:71], 0
  s_waitcnt lgkmcnt(6)
  ds_read_b64_tr_b16 v[124:125], v6 offset:27136
  ds_read_b64_tr_b16 v[126:127], v6 offset:27200
  v_mfma_f32_16x16x32_bf16 v[16:19], v[40:43], v[72:75], v[16:19]
  s_waitcnt lgkmcnt(6)
  ds_read_b64_tr_b16 v[104:105], v6 offset:27392
  ds_read_b64_tr_b16 v[106:107], v6 offset:27456
  v_mfma_f32_16x16x32_bf16 v[16:19], v[44:47], v[76:79], v[16:19]
  s_waitcnt lgkmcnt(6)
  ds_read_b64_tr_b16 v[108:109], v6 offset:27648
  ds_read_b64_tr_b16 v[110:111], v6 offset:27712
  v_mfma_f32_16x16x32_bf16 v[16:19], v[48:51], v[80:83], v[16:19]
  s_waitcnt lgkmcnt(6)
  v_cvt_pk_bf16_f32 v120, v24, v25
  v_cvt_pk_bf16_f32 v121, v26, v27
  v_mfma_f32_16x16x32_bf16 v[112:115], v[116:119], v[68:71], 0
  s_waitcnt lgkmcnt(4)
  v_mov_b64 v[98:99], 0
  v_mfma_f32_16x16x32_bf16 v[112:115], v[124:127], v[72:75], v[112:115]
  s_waitcnt lgkmcnt(2)
  v_mov_b64 v[36:37], 0
  v_exp_f32 v100, v16
  v_mfma_f32_16x16x32_bf16 v[112:115], v[104:107], v[76:79], v[112:115]
  s_waitcnt lgkmcnt(0)
  buffer_store_dwordx4 v[120:123], v2, s[4:7], s29 offen offset:2048 sc1
  v_exp_f32 v101, v17
  v_mfma_f32_16x16x32_bf16 v[112:115], v[108:111], v[80:83], v[112:115]
  v_exp_f32 v102, v18
  v_mfma_f32_16x16x32_bf16 v[20:23], v[52:55], v[68:71], 0
  v_exp_f32 v103, v19
  v_mfma_f32_16x16x32_bf16 v[20:23], v[56:59], v[72:75], v[20:23]
  v_cvt_pk_bf16_f32 v44, v100, v101
  v_cvt_pk_bf16_f32 v45, v102, v103
  v_mfma_f32_16x16x32_bf16 v[20:23], v[60:63], v[76:79], v[20:23]
  s_add_u32 s29, s29, 131072
  v_exp_f32 v100, v112
  v_mfma_f32_16x16x32_bf16 v[20:23], v[64:67], v[80:83], v[20:23]
  v_exp_f32 v101, v113
  v_exp_f32 v102, v114
  v_exp_f32 v103, v115
  v_cvt_pk_bf16_f32 v84, v100, v101
  v_cvt_pk_bf16_f32 v85, v102, v103
  v_cndmask_b32 v48, v84, 0, s[16:17]
  v_cndmask_b32 v49, v85, 0, s[16:17]
  v_cndmask_b32 v50, 0, v84, s[16:17]
  v_cndmask_b32 v51, 0, v85, s[16:17]
  v_exp_f32 v100, v20
  v_mfma_f32_16x16x16_bf16 v[88:91], v[12:13], v[48:49], 0
  v_exp_f32 v101, v21
  v_mfma_f32_16x16x16_bf16 v[24:27], v[120:121], v[48:49], 0
  v_exp_f32 v102, v22
  v_mfma_f32_16x16x16_bf16 v[116:119], v[120:121], v[50:51], 0
  v_exp_f32 v103, v23
  v_cvt_pk_bf16_f32 v46, v100, v101
  v_cvt_pk_bf16_f32 v47, v102, v103
  v_mov_b64 v[38:39], 0
  s_nop 0
  v_mfma_f32_16x16x32_bf16 v[88:91], v[12:15], v[44:47], v[88:91]
  v_mov_b64 v[40:41], 0
  v_mov_b64 v[42:43], 0
  v_mfma_f32_16x16x32_bf16 v[24:27], v[28:31], v[44:47], v[24:27]
  ds_read_b128 v[52:55], v4 offset:24576
  ds_read_b128 v[56:59], v4 offset:25600
  v_mfma_f32_16x16x32_bf16 v[116:119], v[32:35], v[44:47], v[116:119]
  s_nop 1
T_back_50:
  v_rcp_f32 v89, v88
  v_subrev_u32 v100, s54, v88
  v_cmp_le_u32 vcc, s96, v100
  v_mul_f32 v24, v89, v24
  v_mul_f32 v25, v89, v25
  v_cvt_pk_bf16_f32 v124, v24, v25
  v_pk_mul_f32 v[26:27], v[26:27], v[88:89] op_sel:[0,1] op_sel_hi:[1,1]
  v_pk_mul_f32 v[116:117], v[116:117], v[88:89] op_sel:[0,1] op_sel_hi:[1,1]
  v_pk_mul_f32 v[118:119], v[118:119], v[88:89] op_sel:[0,1] op_sel_hi:[1,1]
  v_cvt_pk_bf16_f32 v125, v26, v27
  v_cvt_pk_bf16_f32 v126, v116, v117
  v_cvt_pk_bf16_f32 v127, v118, v119
  ds_write_b128 v11, v[124:127] offset:30208
  s_cbranch_vccnz T_slow_49
  v_smfmac_f32_16x16x64_bf16 v[92:95], v[124:127], a[160:167], v0
  s_mov_b32 s96, s55
  v_smfmac_f32_16x16x64_bf16 v[96:99], v[124:127], a[168:175], v0
  s_cmp_eq_u32 s14, 63
  v_smfmac_f32_16x16x64_bf16 v[36:39], v[124:127], a[176:183], v0
  s_waitcnt lgkmcnt(0)
  s_barrier
  ds_read_b128 v[104:107], v11 offset:30720
  ds_read_b128 v[108:111], v11 offset:29184
  ds_read_b128 v[68:71], v11 offset:29696
  s_cbranch_scc1 M_tdone
  v_smfmac_f32_16x16x64_bf16 v[40:43], v[124:127], a[184:191], v0
  s_waitcnt lgkmcnt(2)
  v_smfmac_f32_16x16x64_bf16 v[92:95], v[104:107], a[192:199], v0
  s_waitcnt lgkmcnt(1)
  ds_read_b128 v[76:79], v4 offset:28672
  v_smfmac_f32_16x16x64_bf16 v[92:95], v[108:111], a[224:231], v0
  s_waitcnt lgkmcnt(1)
  ds_read_b128 v[80:83], v4 offset:29696
  v_smfmac_f32_16x16x64_bf16 v[92:95], v[68:71], a[240:247], v0
  ds_read_b128 v[60:63], v4 offset:26624
  v_smfmac_f32_16x16x64_bf16 v[96:99], v[104:107], a[200:207], v0
  ds_read_b128 v[64:67], v4 offset:27648
  v_smfmac_f32_16x16x64_bf16 v[96:99], v[108:111], a[232:239], v0
  ds_read_b128 v[28:31], v4 offset:30720
  s_nop 0
  v_cvt_pk_bf16_f32 v16, v92, v93
  v_cvt_pk_bf16_f32 v17, v94, v95
  v_bfi_b32 v16, 1, s57, v16
  v_smfmac_f32_16x16x64_bf16 v[96:99], v[68:71], a[248:255], v0
  buffer_store_dwordx2 v[16:17], v7, s[4:7], s20 offen offset:0
  v_smfmac_f32_16x16x64_bf16 v[36:39], v[104:107], a[208:215], v0
  ds_read_b128 v[32:35], v4 offset:31744
  v_smfmac_f32_16x16x64_bf16 v[36:39], v[108:111], v[52:59], v0
  s_waitcnt lgkmcnt(4)
  s_nop 0
  v_cvt_pk_bf16_f32 v18, v96, v97
  v_cvt_pk_bf16_f32 v19, v98, v99
  v_bfi_b32 v18, 1, s57, v18
  v_smfmac_f32_16x16x64_bf16 v[36:39], v[68:71], v[76:83], v0
  buffer_store_dwordx2 v[18:19], v7, s[4:7], s20 offen offset:64
  v_smfmac_f32_16x16x64_bf16 v[40:43], v[104:107], a[216:223], v0
  s_waitcnt lgkmcnt(2)
  v_smfmac_f32_16x16x64_bf16 v[40:43], v[108:111], v[60:67], v0
  s_waitcnt lgkmcnt(0)
  s_nop 0
  v_cvt_pk_bf16_f32 v20, v36, v37
  v_cvt_pk_bf16_f32 v21, v38, v39
  v_bfi_b32 v20, 1, s57, v20
  v_smfmac_f32_16x16x64_bf16 v[40:43], v[68:71], v[28:35], v0
  buffer_store_dwordx2 v[20:21], v7, s[4:7], s21 offen offset:0
  s_nop 6
  v_cvt_pk_bf16_f32 v22, v40, v41
  v_cvt_pk_bf16_f32 v23, v42, v43
  v_bfi_b32 v22, 1, s57, v22
  buffer_store_dwordx2 v[22:23], v7, s[4:7], s21 offen offset:64
  ds_read_b128 v[68:71], v4 offset:0
  ds_read_b128 v[72:75], v4 offset:1024
  ds_read_b128 v[76:79], v4 offset:4096
  ds_read_b128 v[80:83], v4 offset:5120
  ds_read_b128 v[84:87], v4 offset:8192
  ds_read_b128 v[88:91], v4 offset:9216
  ds_read_b128 v[92:95], v4 offset:2048
  ds_read_b128 v[96:99], v4 offset:3072
  ds_read_b128 v[100:103], v4 offset:6144
  ds_read_b128 v[104:107], v4 offset:7168
  ds_read_b128 v[108:111], v4 offset:10240
  ds_read_b128 v[112:115], v4 offset:11264
  v_mov_b64 v[16:17], 0
  v_mov_b64 v[18:19], 0
  v_mov_b64 v[20:21], 0
  v_mov_b64 v[22:23], 0
  v_mov_b64 v[24:25], 0
  v_mov_b64 v[26:27], 0
  ds_read_b64 v[44:45], v2 offset:32256
  s_waitcnt lgkmcnt(0)
  v_readfirstlane_b32 s38, v44
  v_readfirstlane_b32 s37, v45
  s_nop 0
  s_lshl_b32 s38, s38, 1
  s_lshl1_add_u32 s37, s37, 1
  s_min_u32 s38, s38, s37
  s_cmp_ge_u32 s38, 64
  s_cselect_b32 s38, 100, s38
  s_sub_u32 s38, s38, 1
  s_max_i32 s30, s30, s38
  s_waitcnt vmcnt(4)
  s_barrier
  ds_read_b128 v[28:31], v2 offset:18432
  ds_read_b128 v[32:35], v2 offset:22528
  ds_read_b128 v[36:39], v2 offset:8192
  ds_read_b128 v[40:43], v2 offset:9216
  ds_read_b128 v[44:47], v2 offset:10240
  ds_read_b128 v[48:51], v2 offset:11264
  buffer_load_dwordx4 v[124:127], v2, s[4:7], s24 offen offset:2048 sc1
  buffer_load_dwordx4 v[116:119], v2, s[4:7], s25 offen offset:2048 sc1
  ds_read_b128 v[52:55], v2 offset:12288
  ds_read_b128 v[56:59], v2 offset:13312
  ds_read_b128 v[60:63], v2 offset:14336
  ds_read_b128 v[64:67], v2 offset:15360
  buffer_load_dwordx4 v[124:127], v2, s[4:7], s24 offen offset:2048 sc1
  buffer_load_dwordx4 v[116:119], v2, s[4:7], s25 offen offset:2048 sc1
  s_add_u32 s14, s14, 1
  s_cmp_ge_i32 s14, s30
  s_cbranch_scc1 T_kvw_46
T_kvb_47:
  s_mov_b32 s19, 0
  s_branch T_loop_42
T_kvw_46:
  s_mov_b32 s19, 0
  s_branch T_kvok_55
T_kv_54:
  s_sleep 4
  s_add_u32 s19, s19, 1
  s_cmp_gt_u32 s19, 32768
  s_cbranch_scc1 M_exit
T_kvok_55:
  s_add_u32 s39, s99, 128
  s_mov_b32 s38, 0
  s_mov_b32 s37, 0
  s_atomic_or s38, s[58:59], s99 glc
  s_atomic_or s37, s[58:59], s39 glc
  s_waitcnt lgkmcnt(0)
  s_lshl_b32 s38, s38, 1
  s_lshl1_add_u32 s37, s37, 1
  s_min_u32 s38, s38, s37
  s_cmp_ge_u32 s38, 64
  s_cselect_b32 s38, 100, s38
  s_sub_u32 s38, s38, 1
  s_max_i32 s30, s30, s38
  s_cmp_ge_i32 s14, s30
  s_cbranch_scc1 T_kv_54
  s_branch T_kvb_47
T_slow_49:
  s_nop 7
  v_max3_f32 v100, v16, v17, v18
  v_max3_f32 v100, v100, v19, v20
  v_max3_f32 v100, v100, v21, v22
  v_max3_f32 v100, v100, v23, v112
  v_max3_f32 v100, v100, v113, v114
  v_max_f32 v100, v100, v115
  v_mov_b32 v101, v100
  s_nop 1
  v_permlane32_swap_b32 v100, v101
  s_nop 1
  v_max_f32 v100, v100, v101
  v_mov_b32 v101, v100
  s_nop 1
  v_permlane16_swap_b32 v100, v101
  s_nop 1
  v_max_f32 v100, v100, v101
  v_sub_f32 v16, v16, v100
  v_sub_f32 v17, v17, v100
  v_sub_f32 v18, v18, v100
  v_sub_f32 v19, v19, v100
  v_exp_f32 v16, v16
  v_exp_f32 v17, v17
  v_exp_f32 v18, v18
  v_exp_f32 v19, v19
  v_sub_f32 v20, v20, v100
  v_sub_f32 v21, v21, v100
  v_sub_f32 v22, v22, v100
  v_sub_f32 v23, v23, v100
  v_exp_f32 v20, v20
  v_exp_f32 v21, v21
  v_exp_f32 v22, v22
  v_exp_f32 v23, v23
  v_sub_f32 v112, v112, v100
  v_sub_f32 v113, v113, v100
  v_sub_f32 v114, v114, v100
  v_sub_f32 v115, v115, v100
  v_exp_f32 v112, v112
  v_exp_f32 v113, v113
  v_exp_f32 v114, v114
  v_exp_f32 v115, v115
  s_nop 0
  v_cvt_pk_bf16_f32 v44, v16, v17
  v_cvt_pk_bf16_f32 v45, v18, v19
  v_cvt_pk_bf16_f32 v46, v20, v21
  v_cvt_pk_bf16_f32 v47, v22, v23
  v_cvt_pk_bf16_f32 v84, v112, v113
  v_cvt_pk_bf16_f32 v85, v114, v115
  v_cndmask_b32 v48, v84, 0, s[16:17]
  v_cndmask_b32 v49, v85, 0, s[16:17]
  v_cndmask_b32 v50, 0, v84, s[16:17]
  v_cndmask_b32 v51, 0, v85, s[16:17]
  s_nop 1
  v_mfma_f32_16x16x16_bf16 v[88:91], v[12:13], v[48:49], 0
  v_mfma_f32_16x16x16_bf16 v[24:27], v[120:121], v[48:49], 0
  v_mfma_f32_16x16x16_bf16 v[116:119], v[120:121], v[50:51], 0
  v_mfma_f32_16x16x32_bf16 v[88:91], v[12:15], v[44:47], v[88:91]
  v_mfma_f32_16x16x32_bf16 v[24:27], v[28:31], v[44:47], v[24:27]
  v_mfma_f32_16x16x32_bf16 v[116:119], v[32:35], v[44:47], v[116:119]
  s_nop 7
  s_nop 1
  s_mov_b32 s96, -1
  s_branch T_back_50
T_w_13:
  s_mov_b32 s19, 0
  s_add_u32 s14, s14, 1
  s_and_b32 s57, s14, 1
  v_mov_b64 v[16:17], 0
  v_mov_b64 v[18:19], 0
  v_mov_b64 v[20:21], 0
  v_mov_b64 v[22:23], 0
  v_mov_b64 v[24:25], 0
  v_mov_b64 v[26:27], 0
  buffer_load_dwordx4 v[124:127], v2, s[4:7], s24 offen offset:3072 sc1
  buffer_load_dwordx4 v[116:119], v2, s[4:7], s25 offen offset:3072 sc1
  buffer_load_dwordx4 v[124:127], v2, s[4:7], s24 offen offset:3072 sc1
  buffer_load_dwordx4 v[116:119], v2, s[4:7], s25 offen offset:3072 sc1
  s_branch T_loop_56
.p2align 6
T_retry_57:
  s_mov_b64 exec, vcc
  buffer_load_dwordx4 v[124:127], v2, s[4:7], s24 offen offset:3072 sc1
  buffer_load_dwordx4 v[116:119], v2, s[4:7], s25 offen offset:3072 sc1
  s_mov_b64 exec, -1
  s_add_u32 s19, s19, 1
  s_cmp_gt_u32 s19, 32768
  s_cbranch_scc1 M_exit
  s_nop 0
  v_mov_b64 v[16:17], 0
  v_mov_b64 v[18:19], 0
T_loop_56:
  s_waitcnt vmcnt(3) lgkmcnt(0)
  v_max3_u32 v123, v124, v125, v126
  v_max_u32 v123, v123, v127
  v_mov_b32_dpp v120, v124 row_ror:8 row_mask:0xf bank_mask:0xf
  v_mov_b32_dpp v121, v125 row_ror:8 row_mask:0xf bank_mask:0xf
  s_waitcnt vmcnt(2)
  v_max3_u32 v123, v123, v116, v117
  v_max3_u32 v123, v123, v118, v119
  v_cmp_eq_u32 vcc, -1, v123
  v_smfmac_f32_16x16x64_bf16 v[16:19], v[124:127], v[68:75], v0
  s_cbranch_vccnz T_retry_57
  ds_write_b128 v2, v[124:127] offset:3072
  v_mov_b32_dpp v122, v126 row_ror:8 row_mask:0xf bank_mask:0xf
  v_smfmac_f32_16x16x64_bf16 v[20:23], v[124:127], v[76:83], v0
  s_and_b32 s57, s14, 1
  v_mov_b32_dpp v123, v127 row_ror:8 row_mask:0xf bank_mask:0xf
  v_smfmac_f32_16x16x64_bf16 v[24:27], v[124:127], v[84:91], v0
  s_and_b32 s36, s14, 3
  ds_write_b128 v2, v[116:119] offset:7168
  v_smfmac_f32_16x16x64_bf16 v[16:19], v[120:123], v[92:99], v0
  s_lshl_b32 s36, s36, 13
  v_mov_b32_dpp v84, v116 row_ror:8 row_mask:0xf bank_mask:0xf
  v_smfmac_f32_16x16x64_bf16 v[20:23], v[120:123], v[100:107], v0
  s_add_u32 s26, s36, s23
  ds_read_b128 v[68:71], v4 offset:12288
  v_mov_b32_dpp v85, v117 row_ror:8 row_mask:0xf bank_mask:0xf
  v_smfmac_f32_16x16x64_bf16 v[24:27], v[120:123], v[108:115], v0
  s_add_u32 s36, s36, 8192
  ds_read_b128 v[72:75], v4 offset:13312
  v_mov_b32_dpp v86, v118 row_ror:8 row_mask:0xf bank_mask:0xf
  v_smfmac_f32_16x16x64_bf16 v[16:19], v[116:119], v[224:231], v0
  s_and_b32 s36, s36, 0x7fff
  ds_read_b128 v[76:79], v4 offset:14336
  v_mov_b32_dpp v87, v119 row_ror:8 row_mask:0xf bank_mask:0xf
  v_smfmac_f32_16x16x64_bf16 v[20:23], v[116:119], v[240:247], v0
  s_waitcnt lgkmcnt(3)
  s_barrier
  ds_read_b128 v[100:103], v2 offset:2048
  v_smfmac_f32_16x16x64_bf16 v[24:27], v[116:119], a[0:7], v0
  s_mov_b32 m0, s31
  ds_read_b128 v[120:123], v1 offset:2048
  v_smfmac_f32_16x16x64_bf16 v[16:19], v[84:87], v[232:239], v0
  v_smfmac_f32_16x16x64_bf16 v[20:23], v[84:87], v[248:255], v0
  ds_read_b128 v[80:83], v4 offset:15360
  v_smfmac_f32_16x16x64_bf16 v[24:27], v[84:87], a[8:15], v0
  s_waitcnt lgkmcnt(2)
  buffer_load_dwordx4 v9, s[4:7], s27 offen sc1 lds
  v_smfmac_f32_16x16x64_bf16 v[16:19], v[100:103], v[128:135], v0
  ds_read_b128 v[92:95], v2 offset:1024
  s_mov_b32 m0, s32
  v_smfmac_f32_16x16x64_bf16 v[20:23], v[100:103], v[144:151], v0
  ds_read_b128 v[96:99], v1 offset:1024
  v_smfmac_f32_16x16x64_bf16 v[24:27], v[100:103], v[68:75], v0
  s_waitcnt vmcnt(1) lgkmcnt(3)
  ds_read_b128 v[116:119], v2 offset:0
  v_smfmac_f32_16x16x64_bf16 v[16:19], v[120:123], v[136:143], v0
  ds_read_b128 v[124:127], v1 offset:0
  buffer_load_dwordx4 v9, s[4:7], s27 offen offset:128 sc1 lds
  v_smfmac_f32_16x16x64_bf16 v[20:23], v[120:123], v[152:159], v0
  s_waitcnt lgkmcnt(4)
  ds_read_b128 v[104:107], v2 offset:6144
  s_mov_b32 m0, s33
  v_smfmac_f32_16x16x64_bf16 v[24:27], v[120:123], v[76:83], v0
  s_waitcnt lgkmcnt(4)
  ds_read_b128 v[108:111], v1 offset:6144
  v_smfmac_f32_16x16x64_bf16 v[16:19], v[92:95], v[160:167], v0
  s_waitcnt lgkmcnt(4)
  ds_read_b128 v[112:115], v2 offset:5120
  v_smfmac_f32_16x16x64_bf16 v[16:19], v[96:99], v[168:175], v0
  s_waitcnt lgkmcnt(4)
  ds_read_b128 v[84:87], v1 offset:5120
  buffer_load_dwordx4 v10, s[4:7], s28 offen sc1 lds
  v_smfmac_f32_16x16x64_bf16 v[16:19], v[116:119], v[192:199], v0
  s_waitcnt lgkmcnt(4)
  ds_read_b128 v[88:91], v2 offset:4096
  s_mov_b32 m0, s34
  v_smfmac_f32_16x16x64_bf16 v[16:19], v[124:127], v[200:207], v0
  s_waitcnt lgkmcnt(4)
  ds_read_b128 v[100:103], v1 offset:4096
  v_smfmac_f32_16x16x64_bf16 v[16:19], v[104:107], a[16:23], v0
  s_waitcnt lgkmcnt(4)
  ds_read_b128 v[68:71], v4 offset:16384
  v_smfmac_f32_16x16x64_bf16 v[16:19], v[108:111], a[24:31], v0
  s_waitcnt lgkmcnt(4)
  ds_read_b128 v[72:75], v4 offset:17408
  buffer_load_dwordx4 v10, s[4:7], s28 offen offset:256 sc1 lds
  v_smfmac_f32_16x16x64_bf16 v[16:19], v[112:115], a[64:71], v0
  s_waitcnt lgkmcnt(4)
  ds_read_b128 v[76:79], v4 offset:18432
  s_mov_b32 m0, 32256
  v_smfmac_f32_16x16x64_bf16 v[16:19], v[84:87], a[72:79], v0
  s_waitcnt lgkmcnt(4)
  ds_read_b128 v[80:83], v4 offset:19456
  v_smfmac_f32_16x16x64_bf16 v[16:19], v[88:91], a[112:119], v0
  s_waitcnt lgkmcnt(4)
  v_smfmac_f32_16x16x64_bf16 v[16:19], v[100:103], a[120:127], v0
  buffer_load_dword v3, s[4:7], s99 offen sc1 lds
  s_add_u32 s24, s36, 145752064
  s_add_u32 s25, s36, 145756160
  v_smfmac_f32_16x16x64_bf16 v[20:23], v[92:95], v[176:183], v0
  s_add_u32 s35, s36, s23
  v_smfmac_f32_16x16x64_bf16 v[20:23], v[96:99], v[184:191], v0
  s_waitcnt lgkmcnt(2)
  v_smfmac_f32_16x16x64_bf16 v[20:23], v[116:119], v[68:75], v0
  s_waitcnt lgkmcnt(0)
  ds_read_b128 v[68:71], v4 offset:20480
  v_mul_f32 v16, s18, v16
  v_smfmac_f32_16x16x64_bf16 v[20:23], v[124:127], v[76:83], v0
  ds_read_b128 v[72:75], v4 offset:21504
  v_mul_f32 v17, s18, v17
  v_smfmac_f32_16x16x64_bf16 v[20:23], v[104:107], a[32:39], v0
  ds_read_b128 v[76:79], v4 offset:22528
  v_mul_f32 v18, s18, v18
  v_smfmac_f32_16x16x64_bf16 v[20:23], v[108:111], a[40:47], v0
  ds_read_b128 v[80:83], v4 offset:23552
  v_mul_f32 v19, s18, v19
  v_smfmac_f32_16x16x64_bf16 v[20:23], v[112:115], a[80:87], v0
  v_cvt_pk_bf16_f32 v120, v16, v17
  v_smfmac_f32_16x16x64_bf16 v[20:23], v[84:87], a[88:95], v0
  v_cvt_pk_bf16_f32 v121, v18, v19
  v_smfmac_f32_16x16x64_bf16 v[20:23], v[88:91], a[128:135], v0
  ds_write_b64 v5, v[120:121] offset:24576
  v_smfmac_f32_16x16x64_bf16 v[20:23], v[100:103], a[136:143], v0
  s_waitcnt lgkmcnt(3)
  v_smfmac_f32_16x16x64_bf16 v[24:27], v[92:95], v[68:75], v0
  s_waitcnt lgkmcnt(1)
  v_mov_b64 v[92:93], 0
  v_smfmac_f32_16x16x64_bf16 v[24:27], v[96:99], v[76:83], v0
  s_nop 1
  v_cvt_pk_bf16_f32 v122, v20, v21
  v_cvt_pk_bf16_f32 v123, v22, v23
  v_smfmac_f32_16x16x64_bf16 v[24:27], v[116:119], v[208:215], v0
  ds_write_b64 v5, v[122:123] offset:26880
  v_mov_b64 v[94:95], 0
  v_smfmac_f32_16x16x64_bf16 v[24:27], v[124:127], v[216:223], v0
  s_waitcnt lgkmcnt(1)
  s_barrier
  ds_read_b64_tr_b16 v[68:69], v6 offset:24576
  v_smfmac_f32_16x16x64_bf16 v[24:27], v[104:107], a[48:55], v0
  s_add_u32 s27, s27, 8192
  ds_read_b64_tr_b16 v[70:71], v6 offset:24640
  ds_read_b64_tr_b16 v[72:73], v6 offset:24832
  v_smfmac_f32_16x16x64_bf16 v[24:27], v[108:111], a[56:63], v0
  s_add_u32 s28, s28, 8192
  ds_read_b64_tr_b16 v[74:75], v6 offset:24896
  ds_read_b64_tr_b16 v[76:77], v6 offset:25088
  v_smfmac_f32_16x16x64_bf16 v[24:27], v[112:115], a[96:103], v0
  s_nop 0
  ds_read_b64_tr_b16 v[78:79], v6 offset:25152
  ds_read_b64_tr_b16 v[80:81], v6 offset:25344
  v_smfmac_f32_16x16x64_bf16 v[24:27], v[84:87], a[104:111], v0
  ds_read_b64_tr_b16 v[82:83], v6 offset:25408
  v_mov_b64 v[96:97], 0
  v_smfmac_f32_16x16x64_bf16 v[24:27], v[88:91], a[144:151], v0
  s_waitcnt lgkmcnt(8)
  s_barrier
  ds_read_b64_tr_b16 v[116:117], v6 offset:26880
  v_smfmac_f32_16x16x64_bf16 v[24:27], v[100:103], a[152:159], v0
  s_waitcnt lgkmcnt(7)
  ds_read_b64_tr_b16 v[118:119], v6 offset:26944
  v_mfma_f32_16x16x32_bf16 v[16:19], v[36:39], v[68:71], 0
  s_waitcnt lgkmcnt(6)
  ds_read_b64_tr_b16 v[124:125], v6 offset:27136
  ds_read_b64_tr_b16 v[126:127], v6 offset:27200
  v_mfma_f32_16x16x32_bf16 v[16:19], v[40:43], v[72:75], v[16:19]
  s_waitcnt lgkmcnt(6)
  ds_read_b64_tr_b16 v[104:105], v6 offset:27392
  ds_read_b64_tr_b16 v[106:107], v6 offset:27456
  v_mfma_f32_16x16x32_bf16 v[16:19], v[44:47], v[76:79], v[16:19]
  s_waitcnt lgkmcnt(6)
  ds_read_b64_tr_b16 v[108:109], v6 offset:27648
  ds_read_b64_tr_b16 v[110:111], v6 offset:27712
  v_mfma_f32_16x16x32_bf16 v[16:19], v[48:51], v[80:83], v[16:19]
  s_waitcnt lgkmcnt(6)
  v_cvt_pk_bf16_f32 v120, v24, v25
  v_cvt_pk_bf16_f32 v121, v26, v27
  v_mfma_f32_16x16x32_bf16 v[112:115], v[116:119], v[68:71], 0
  s_waitcnt lgkmcnt(4)
  v_mov_b64 v[98:99], 0
  v_mfma_f32_16x16x32_bf16 v[112:115], v[124:127], v[72:75], v[112:115]
  s_waitcnt lgkmcnt(2)
  v_mov_b64 v[36:37], 0
  v_exp_f32 v100, v16
  v_mfma_f32_16x16x32_bf16 v[112:115], v[104:107], v[76:79], v[112:115]
  s_waitcnt lgkmcnt(0)
  v_exp_f32 v101, v17
  v_mfma_f32_16x16x32_bf16 v[112:115], v[108:111], v[80:83], v[112:115]
  buffer_store_dwordx4 v[120:123], v2, s[4:7], s29 offen offset:3072 sc1
  v_exp_f32 v102, v18
  v_mfma_f32_16x16x32_bf16 v[20:23], v[52:55], v[68:71], 0
  v_exp_f32 v103, v19
  v_mfma_f32_16x16x32_bf16 v[20:23], v[56:59], v[72:75], v[20:23]
  v_cvt_pk_bf16_f32 v44, v100, v101
  v_cvt_pk_bf16_f32 v45, v102, v103
  v_mfma_f32_16x16x32_bf16 v[20:23], v[60:63], v[76:79], v[20:23]
  s_add_u32 s29, s29, 131072
  v_exp_f32 v100, v112
  v_mfma_f32_16x16x32_bf16 v[20:23], v[64:67], v[80:83], v[20:23]
  v_exp_f32 v101, v113
  v_exp_f32 v102, v114
  v_exp_f32 v103, v115
  v_cvt_pk_bf16_f32 v84, v100, v101
  v_cvt_pk_bf16_f32 v85, v102, v103
  v_cndmask_b32 v48, v84, 0, s[16:17]
  v_cndmask_b32 v49, v85, 0, s[16:17]
  v_cndmask_b32 v50, 0, v84, s[16:17]
  v_cndmask_b32 v51, 0, v85, s[16:17]
  v_exp_f32 v100, v20
  v_mfma_f32_16x16x16_bf16 v[88:91], v[12:13], v[48:49], 0
  v_exp_f32 v101, v21
  v_mfma_f32_16x16x16_bf16 v[24:27], v[120:121], v[48:49], 0
  v_exp_f32 v102, v22
  v_mfma_f32_16x16x16_bf16 v[116:119], v[120:121], v[50:51], 0
  v_exp_f32 v103, v23
  v_cvt_pk_bf16_f32 v46, v100, v101
  v_cvt_pk_bf16_f32 v47, v102, v103
  v_mov_b64 v[38:39], 0
  s_nop 0
  v_mfma_f32_16x16x32_bf16 v[88:91], v[12:15], v[44:47], v[88:91]
  v_mov_b64 v[40:41], 0
  v_mov_b64 v[42:43], 0
  v_mfma_f32_16x16x32_bf16 v[24:27], v[28:31], v[44:47], v[24:27]
  ds_read_b128 v[52:55], v4 offset:24576
  ds_read_b128 v[56:59], v4 offset:25600
  v_mfma_f32_16x16x32_bf16 v[116:119], v[32:35], v[44:47], v[116:119]
  s_nop 1
T_back_64:
  v_rcp_f32 v89, v88
  v_subrev_u32 v100, s54, v88
  v_cmp_le_u32 vcc, s96, v100
  v_mul_f32 v24, v89, v24
  v_mul_f32 v25, v89, v25
  v_cvt_pk_bf16_f32 v124, v24, v25
  v_pk_mul_f32 v[26:27], v[26:27], v[88:89] op_sel:[0,1] op_sel_hi:[1,1]
  v_pk_mul_f32 v[116:117], v[116:117], v[88:89] op_sel:[0,1] op_sel_hi:[1,1]
  v_pk_mul_f32 v[118:119], v[118:119], v[88:89] op_sel:[0,1] op_sel_hi:[1,1]
  v_cvt_pk_bf16_f32 v125, v26, v27
  v_cvt_pk_bf16_f32 v126, v116, v117
  v_cvt_pk_bf16_f32 v127, v118, v119
  ds_write_b128 v11, v[124:127] offset:30720
  s_cbranch_vccnz T_slow_63
  v_smfmac_f32_16x16x64_bf16 v[92:95], v[124:127], a[160:167], v0
  s_mov_b32 s96, s55
  v_smfmac_f32_16x16x64_bf16 v[96:99], v[124:127], a[168:175], v0
  s_cmp_eq_u32 s14, 63
  v_smfmac_f32_16x16x64_bf16 v[36:39], v[124:127], a[176:183], v0
  s_waitcnt lgkmcnt(0)
  s_barrier
  ds_read_b128 v[104:107], v11 offset:30208
  ds_read_b128 v[108:111], v11 offset:29696
  ds_read_b128 v[68:71], v11 offset:29184
  s_cbranch_scc1 M_tdone
  v_smfmac_f32_16x16x64_bf16 v[40:43], v[124:127], a[184:191], v0
  s_waitcnt lgkmcnt(2)
  v_smfmac_f32_16x16x64_bf16 v[92:95], v[104:107], a[192:199], v0
  s_waitcnt lgkmcnt(1)
  ds_read_b128 v[76:79], v4 offset:28672
  v_smfmac_f32_16x16x64_bf16 v[92:95], v[108:111], a[224:231], v0
  s_waitcnt lgkmcnt(1)
  ds_read_b128 v[80:83], v4 offset:29696
  v_smfmac_f32_16x16x64_bf16 v[92:95], v[68:71], a[240:247], v0
  ds_read_b128 v[60:63], v4 offset:26624
  v_smfmac_f32_16x16x64_bf16 v[96:99], v[104:107], a[200:207], v0
  ds_read_b128 v[64:67], v4 offset:27648
  v_smfmac_f32_16x16x64_bf16 v[96:99], v[108:111], a[232:239], v0
  ds_read_b128 v[28:31], v4 offset:30720
  s_nop 0
  v_cvt_pk_bf16_f32 v16, v92, v93
  v_cvt_pk_bf16_f32 v17, v94, v95
  v_bfi_b32 v16, 1, s57, v16
  v_smfmac_f32_16x16x64_bf16 v[96:99], v[68:71], a[248:255], v0
  buffer_store_dwordx2 v[16:17], v7, s[4:7], s20 offen offset:0
  v_smfmac_f32_16x16x64_bf16 v[36:39], v[104:107], a[208:215], v0
  ds_read_b128 v[32:35], v4 offset:31744
  v_smfmac_f32_16x16x64_bf16 v[36:39], v[108:111], v[52:59], v0
  s_waitcnt lgkmcnt(4)
  s_nop 0
  v_cvt_pk_bf16_f32 v18, v96, v97
  v_cvt_pk_bf16_f32 v19, v98, v99
  v_bfi_b32 v18, 1, s57, v18
  v_smfmac_f32_16x16x64_bf16 v[36:39], v[68:71], v[76:83], v0
  buffer_store_dwordx2 v[18:19], v7, s[4:7], s20 offen offset:64
  v_smfmac_f32_16x16x64_bf16 v[40:43], v[104:107], a[216:223], v0
  s_waitcnt lgkmcnt(2)
  v_smfmac_f32_16x16x64_bf16 v[40:43], v[108:111], v[60:67], v0
  s_waitcnt lgkmcnt(0)
  s_nop 0
  v_cvt_pk_bf16_f32 v20, v36, v37
  v_cvt_pk_bf16_f32 v21, v38, v39
  v_bfi_b32 v20, 1, s57, v20
  v_smfmac_f32_16x16x64_bf16 v[40:43], v[68:71], v[28:35], v0
  buffer_store_dwordx2 v[20:21], v7, s[4:7], s21 offen offset:0
  s_nop 6
  v_cvt_pk_bf16_f32 v22, v40, v41
  v_cvt_pk_bf16_f32 v23, v42, v43
  v_bfi_b32 v22, 1, s57, v22
  buffer_store_dwordx2 v[22:23], v7, s[4:7], s21 offen offset:64
  ds_read_b128 v[68:71], v4 offset:0
  ds_read_b128 v[72:75], v4 offset:1024
  ds_read_b128 v[76:79], v4 offset:4096
  ds_read_b128 v[80:83], v4 offset:5120
  ds_read_b128 v[84:87], v4 offset:8192
  ds_read_b128 v[88:91], v4 offset:9216
  ds_read_b128 v[92:95], v4 offset:2048
  ds_read_b128 v[96:99], v4 offset:3072
  ds_read_b128 v[100:103], v4 offset:6144
  ds_read_b128 v[104:107], v4 offset:7168
  ds_read_b128 v[108:111], v4 offset:10240
  ds_read_b128 v[112:115], v4 offset:11264
  v_mov_b64 v[16:17], 0
  v_mov_b64 v[18:19], 0
  v_mov_b64 v[20:21], 0
  v_mov_b64 v[22:23], 0
  v_mov_b64 v[24:25], 0
  v_mov_b64 v[26:27], 0
  ds_read_b64 v[44:45], v2 offset:32256
  s_waitcnt lgkmcnt(0)
  v_readfirstlane_b32 s38, v44
  v_readfirstlane_b32 s37, v45
  s_nop 0
  s_lshl_b32 s38, s38, 1
  s_lshl1_add_u32 s37, s37, 1
  s_min_u32 s38, s38, s37
  s_cmp_ge_u32 s38, 64
  s_cselect_b32 s38, 100, s38
  s_sub_u32 s38, s38, 1
  s_max_i32 s30, s30, s38
  s_waitcnt vmcnt(4)
  s_barrier
  ds_read_b128 v[28:31], v2 offset:19456
  ds_read_b128 v[32:35], v2 offset:23552
  ds_read_b128 v[36:39], v2 offset:8192
  ds_read_b128 v[40:43], v2 offset:9216
  ds_read_b128 v[44:47], v2 offset:10240
  ds_read_b128 v[48:51], v2 offset:11264
  buffer_load_dwordx4 v[124:127], v2, s[4:7], s24 offen offset:3072 sc1
  buffer_load_dwordx4 v[116:119], v2, s[4:7], s25 offen offset:3072 sc1
  ds_read_b128 v[52:55], v2 offset:12288
  ds_read_b128 v[56:59], v2 offset:13312
  ds_read_b128 v[60:63], v2 offset:14336
  ds_read_b128 v[64:67], v2 offset:15360
  buffer_load_dwordx4 v[124:127], v2, s[4:7], s24 offen offset:3072 sc1
  buffer_load_dwordx4 v[116:119], v2, s[4:7], s25 offen offset:3072 sc1
  s_add_u32 s14, s14, 1
  s_cmp_ge_i32 s14, s30
  s_cbranch_scc1 T_kvw_60
T_kvb_61:
  s_mov_b32 s19, 0
  s_branch T_loop_56
T_kvw_60:
  s_mov_b32 s19, 0
  s_branch T_kvok_69
T_kv_68:
  s_sleep 4
  s_add_u32 s19, s19, 1
  s_cmp_gt_u32 s19, 32768
  s_cbranch_scc1 M_exit
T_kvok_69:
  s_add_u32 s39, s99, 128
  s_mov_b32 s38, 0
  s_mov_b32 s37, 0
  s_atomic_or s38, s[58:59], s99 glc
  s_atomic_or s37, s[58:59], s39 glc
  s_waitcnt lgkmcnt(0)
  s_lshl_b32 s38, s38, 1
  s_lshl1_add_u32 s37, s37, 1
  s_min_u32 s38, s38, s37
  s_cmp_ge_u32 s38, 64
  s_cselect_b32 s38, 100, s38
  s_sub_u32 s38, s38, 1
  s_max_i32 s30, s30, s38
  s_cmp_ge_i32 s14, s30
  s_cbranch_scc1 T_kv_68
  s_branch T_kvb_61
T_slow_63:
  s_nop 7
  v_max3_f32 v100, v16, v17, v18
  v_max3_f32 v100, v100, v19, v20
  v_max3_f32 v100, v100, v21, v22
  v_max3_f32 v100, v100, v23, v112
  v_max3_f32 v100, v100, v113, v114
  v_max_f32 v100, v100, v115
  v_mov_b32 v101, v100
  s_nop 1
  v_permlane32_swap_b32 v100, v101
  s_nop 1
  v_max_f32 v100, v100, v101
  v_mov_b32 v101, v100
  s_nop 1
  v_permlane16_swap_b32 v100, v101
  s_nop 1
  v_max_f32 v100, v100, v101
  v_sub_f32 v16, v16, v100
  v_sub_f32 v17, v17, v100
  v_sub_f32 v18, v18, v100
  v_sub_f32 v19, v19, v100
  v_exp_f32 v16, v16
  v_exp_f32 v17, v17
  v_exp_f32 v18, v18
  v_exp_f32 v19, v19
  v_sub_f32 v20, v20, v100
  v_sub_f32 v21, v21, v100
  v_sub_f32 v22, v22, v100
  v_sub_f32 v23, v23, v100
  v_exp_f32 v20, v20
  v_exp_f32 v21, v21
  v_exp_f32 v22, v22
  v_exp_f32 v23, v23
  v_sub_f32 v112, v112, v100
  v_sub_f32 v113, v113, v100
  v_sub_f32 v114, v114, v100
  v_sub_f32 v115, v115, v100
  v_exp_f32 v112, v112
  v_exp_f32 v113, v113
  v_exp_f32 v114, v114
  v_exp_f32 v115, v115
  s_nop 0
  v_cvt_pk_bf16_f32 v44, v16, v17
  v_cvt_pk_bf16_f32 v45, v18, v19
  v_cvt_pk_bf16_f32 v46, v20, v21
  v_cvt_pk_bf16_f32 v47, v22, v23
  v_cvt_pk_bf16_f32 v84, v112, v113
  v_cvt_pk_bf16_f32 v85, v114, v115
  v_cndmask_b32 v48, v84, 0, s[16:17]
  v_cndmask_b32 v49, v85, 0, s[16:17]
  v_cndmask_b32 v50, 0, v84, s[16:17]
  v_cndmask_b32 v51, 0, v85, s[16:17]
  s_nop 1
  v_mfma_f32_16x16x16_bf16 v[88:91], v[12:13], v[48:49], 0
  v_mfma_f32_16x16x16_bf16 v[24:27], v[120:121], v[48:49], 0
  v_mfma_f32_16x16x16_bf16 v[116:119], v[120:121], v[50:51], 0
  v_mfma_f32_16x16x32_bf16 v[88:91], v[12:15], v[44:47], v[88:91]
  v_mfma_f32_16x16x32_bf16 v[24:27], v[28:31], v[44:47], v[24:27]
  v_mfma_f32_16x16x32_bf16 v[116:119], v[32:35], v[44:47], v[116:119]
  s_nop 7
  s_nop 1
  s_mov_b32 s96, -1
  s_branch T_back_64
M_global:
  s_cmp_eq_u32 s13, 1
  s_cbranch_scc1 T_w_71
  s_cmp_eq_u32 s13, 2
  s_cbranch_scc1 T_w_72
  s_cmp_eq_u32 s13, 3
  s_cbranch_scc1 T_w_73
T_w_70:
  s_mov_b32 s19, 0
  s_add_u32 s14, s14, 1
  s_and_b32 s57, s14, 1
  v_mov_b64 v[16:17], 0
  v_mov_b64 v[18:19], 0
  v_mov_b64 v[20:21], 0
  v_mov_b64 v[22:23], 0
  v_mov_b64 v[24:25], 0
  v_mov_b64 v[26:27], 0
  buffer_load_dwordx4 v[124:127], v2, s[4:7], s24 offen offset:0 sc1
  buffer_load_dwordx4 v[116:119], v2, s[4:7], s25 offen offset:0 sc1
  buffer_load_dwordx4 v[124:127], v2, s[4:7], s24 offen offset:0 sc1
  buffer_load_dwordx4 v[116:119], v2, s[4:7], s25 offen offset:0 sc1
  s_branch T_loop_74
.p2align 6
T_retry_75:
  s_mov_b64 exec, vcc
  buffer_load_dwordx4 v[124:127], v2, s[4:7], s24 offen offset:0 sc1
  buffer_load_dwordx4 v[116:119], v2, s[4:7], s25 offen offset:0 sc1
  s_mov_b64 exec, -1
  s_add_u32 s19, s19, 1
  s_cmp_gt_u32 s19, 32768
  s_cbranch_scc1 M_exit
  s_nop 0
  v_mov_b64 v[16:17], 0
  v_mov_b64 v[18:19], 0
T_loop_74:
  s_waitcnt vmcnt(3) lgkmcnt(0)
  v_max3_u32 v123, v124, v125, v126
  v_max_u32 v123, v123, v127
  v_mov_b32_dpp v120, v124 row_ror:8 row_mask:0xf bank_mask:0xf
  v_mov_b32_dpp v121, v125 row_ror:8 row_mask:0xf bank_mask:0xf
  s_waitcnt vmcnt(2)
  v_max3_u32 v123, v123, v116, v117
  v_max3_u32 v123, v123, v118, v119
  v_cmp_eq_u32 vcc, -1, v123
  v_smfmac_f32_16x16x64_bf16 v[16:19], v[124:127], v[68:75], v0
  s_cbranch_vccnz T_retry_75
  ds_write_b128 v2, v[124:127] offset:0
  v_mov_b32_dpp v122, v126 row_ror:8 row_mask:0xf bank_mask:0xf
  v_smfmac_f32_16x16x64_bf16 v[20:23], v[124:127], v[76:83], v0
  s_and_b32 s57, s14, 1
  v_mov_b32_dpp v123, v127 row_ror:8 row_mask:0xf bank_mask:0xf
  v_smfmac_f32_16x16x64_bf16 v[24:27], v[124:127], v[84:91], v0
  s_and_b32 s36, s14, 3
  ds_write_b128 v2, v[116:119] offset:4096
  v_smfmac_f32_16x16x64_bf16 v[16:19], v[120:123], v[92:99], v0
  s_lshl_b32 s36, s36, 13
  v_mov_b32_dpp v84, v116 row_ror:8 row_mask:0xf bank_mask:0xf
  v_smfmac_f32_16x16x64_bf16 v[20:23], v[120:123], v[100:107], v0
  s_add_u32 s26, s36, s23
  ds_read_b128 v[68:71], v4 offset:12288
  v_mov_b32_dpp v85, v117 row_ror:8 row_mask:0xf bank_mask:0xf
  v_smfmac_f32_16x16x64_bf16 v[24:27], v[120:123], v[108:115], v0
  s_add_u32 s36, s36, 8192
  ds_read_b128 v[72:75], v4 offset:13312
  v_mov_b32_dpp v86, v118 row_ror:8 row_mask:0xf bank_mask:0xf
  v_smfmac_f32_16x16x64_bf16 v[16:19], v[116:119], v[224:231], v0
  s_and_b32 s36, s36, 0x7fff
  ds_read_b128 v[76:79], v4 offset:14336
  v_mov_b32_dpp v87, v119 row_ror:8 row_mask:0xf bank_mask:0xf
  v_smfmac_f32_16x16x64_bf16 v[20:23], v[116:119], v[240:247], v0
  s_waitcnt lgkmcnt(3)
  s_barrier
  ds_read_b128 v[100:103], v2 offset:1024
  v_smfmac_f32_16x16x64_bf16 v[24:27], v[116:119], a[0:7], v0
  s_mov_b32 m0, s31
  ds_read_b128 v[120:123], v1 offset:1024
  buffer_load_dwordx4 v9, s[4:7], s27 offen sc1 lds
  v_smfmac_f32_16x16x64_bf16 v[16:19], v[84:87], v[232:239], v0
  s_mov_b32 m0, s32
  v_smfmac_f32_16x16x64_bf16 v[20:23], v[84:87], v[248:255], v0
  ds_read_b128 v[80:83], v4 offset:15360
  v_smfmac_f32_16x16x64_bf16 v[24:27], v[84:87], a[8:15], v0
  s_waitcnt lgkmcnt(2)
  v_smfmac_f32_16x16x64_bf16 v[16:19], v[100:103], v[128:135], v0
  ds_read_b128 v[92:95], v2 offset:2048
  buffer_load_dwordx4 v9, s[4:7], s27 offen offset:128 sc1 lds
  v_smfmac_f32_16x16x64_bf16 v[20:23], v[100:103], v[144:151], v0
  ds_read_b128 v[96:99], v1 offset:2048
  s_mov_b32 m0, s33
  v_smfmac_f32_16x16x64_bf16 v[24:27], v[100:103], v[68:75], v0
  s_waitcnt vmcnt(2) lgkmcnt(3)
  ds_read_b128 v[116:119], v2 offset:3072
  v_smfmac_f32_16x16x64_bf16 v[16:19], v[120:123], v[136:143], v0
  ds_read_b128 v[124:127], v1 offset:3072
  v_smfmac_f32_16x16x64_bf16 v[20:23], v[120:123], v[152:159], v0
  s_waitcnt lgkmcnt(4)
  ds_read_b128 v[104:107], v2 offset:5120
  buffer_load_dwordx4 v10, s[4:7], s28 offen sc1 lds
  v_smfmac_f32_16x16x64_bf16 v[24:27], v[120:123], v[76:83], v0
  s_waitcnt lgkmcnt(4)
  ds_read_b128 v[108:111], v1 offset:5120
  s_mov_b32 m0, s34
  v_smfmac_f32_16x16x64_bf16 v[16:19], v[92:95], v[160:167], v0
  s_waitcnt lgkmcnt(4)
  ds_read_b128 v[112:115], v2 offset:6144
  v_smfmac_f32_16x16x64_bf16 v[16:19], v[96:99], v[168:175], v0
  s_waitcnt lgkmcnt(4)
  ds_read_b128 v[84:87], v1 offset:6144
  v_smfmac_f32_16x16x64_bf16 v[16:19], v[116:119], v[192:199], v0
  s_waitcnt lgkmcnt(4)
  ds_read_b128 v[88:91], v2 offset:7168
  buffer_load_dwordx4 v10, s[4:7], s28 offen offset:256 sc1 lds
  v_smfmac_f32_16x16x64_bf16 v[16:19], v[124:127], v[200:207], v0
  s_waitcnt lgkmcnt(4)
  ds_read_b128 v[100:103], v1 offset:7168
  v_smfmac_f32_16x16x64_bf16 v[16:19], v[104:107], a[16:23], v0
  s_waitcnt lgkmcnt(4)
  ds_read_b128 v[68:71], v4 offset:16384
  v_smfmac_f32_16x16x64_bf16 v[16:19], v[108:111], a[24:31], v0
  s_waitcnt lgkmcnt(4)
  ds_read_b128 v[72:75], v4 offset:17408
  v_smfmac_f32_16x16x64_bf16 v[16:19], v[112:115], a[64:71], v0
  s_waitcnt lgkmcnt(4)
  ds_read_b128 v[76:79], v4 offset:18432
  v_smfmac_f32_16x16x64_bf16 v[16:19], v[84:87], a[72:79], v0
  s_waitcnt lgkmcnt(4)
  ds_read_b128 v[80:83], v4 offset:19456
  v_smfmac_f32_16x16x64_bf16 v[16:19], v[88:91], a[112:119], v0
  s_waitcnt lgkmcnt(4)
  v_smfmac_f32_16x16x64_bf16 v[16:19], v[100:103], a[120:127], v0
  s_add_u32 s24, s36, 145752064
  s_add_u32 s25, s36, 145756160
  v_smfmac_f32_16x16x64_bf16 v[20:23], v[92:95], v[176:183], v0
  s_add_u32 s35, s36, s23
  v_smfmac_f32_16x16x64_bf16 v[20:23], v[96:99], v[184:191], v0
  s_waitcnt lgkmcnt(2)
  v_smfmac_f32_16x16x64_bf16 v[20:23], v[116:119], v[68:75], v0
  s_waitcnt lgkmcnt(0)
  ds_read_b128 v[68:71], v4 offset:20480
  v_mul_f32 v16, s18, v16
  v_smfmac_f32_16x16x64_bf16 v[20:23], v[124:127], v[76:83], v0
  ds_read_b128 v[72:75], v4 offset:21504
  v_mul_f32 v17, s18, v17
  v_smfmac_f32_16x16x64_bf16 v[20:23], v[104:107], a[32:39], v0
  ds_read_b128 v[76:79], v4 offset:22528
  v_mul_f32 v18, s18, v18
  v_smfmac_f32_16x16x64_bf16 v[20:23], v[108:111], a[40:47], v0
  ds_read_b128 v[80:83], v4 offset:23552
  v_mul_f32 v19, s18, v19
  v_smfmac_f32_16x16x64_bf16 v[20:23], v[112:115], a[80:87], v0
  v_cvt_pk_bf16_f32 v120, v16, v17
  v_smfmac_f32_16x16x64_bf16 v[20:23], v[84:87], a[88:95], v0
  v_cvt_pk_bf16_f32 v121, v18, v19
  v_smfmac_f32_16x16x64_bf16 v[20:23], v[88:91], a[128:135], v0
  ds_write_b64 v5, v[120:121] offset:24576
  v_smfmac_f32_16x16x64_bf16 v[20:23], v[100:103], a[136:143], v0
  s_waitcnt lgkmcnt(3)
  v_smfmac_f32_16x16x64_bf16 v[24:27], v[92:95], v[68:75], v0
  s_waitcnt lgkmcnt(1)
  v_mov_b64 v[92:93], 0
  v_smfmac_f32_16x16x64_bf16 v[24:27], v[96:99], v[76:83], v0
  s_nop 1
  v_cvt_pk_bf16_f32 v122, v20, v21
  v_cvt_pk_bf16_f32 v123, v22, v23
  v_smfmac_f32_16x16x64_bf16 v[24:27], v[116:119], v[208:215], v0
  ds_write_b64 v5, v[122:123] offset:26880
  v_mov_b64 v[94:95], 0
  v_smfmac_f32_16x16x64_bf16 v[24:27], v[124:127], v[216:223], v0
  s_waitcnt lgkmcnt(1)
  s_barrier
  ds_read_b64_tr_b16 v[68:69], v6 offset:24576
  v_smfmac_f32_16x16x64_bf16 v[24:27], v[104:107], a[48:55], v0
  s_add_u32 s27, s27, 8192
  ds_read_b64_tr_b16 v[70:71], v6 offset:24640
  ds_read_b64_tr_b16 v[72:73], v6 offset:24832
  v_smfmac_f32_16x16x64_bf16 v[24:27], v[108:111], a[56:63], v0
  s_add_u32 s28, s28, 8192
  ds_read_b64_tr_b16 v[74:75], v6 offset:24896
  ds_read_b64_tr_b16 v[76:77], v6 offset:25088
  v_smfmac_f32_16x16x64_bf16 v[24:27], v[112:115], a[96:103], v0
  s_nop 0
  ds_read_b64_tr_b16 v[78:79], v6 offset:25152
  ds_read_b64_tr_b16 v[80:81], v6 offset:25344
  v_smfmac_f32_16x16x64_bf16 v[24:27], v[84:87], a[104:111], v0
  ds_read_b64_tr_b16 v[82:83], v6 offset:25408
  v_mov_b64 v[96:97], 0
  v_smfmac_f32_16x16x64_bf16 v[24:27], v[88:91], a[144:151], v0
  s_waitcnt lgkmcnt(8)
  s_barrier
  ds_read_b64_tr_b16 v[116:117], v6 offset:26880
  v_smfmac_f32_16x16x64_bf16 v[24:27], v[100:103], a[152:159], v0
  s_waitcnt lgkmcnt(7)
  ds_read_b64_tr_b16 v[118:119], v6 offset:26944
  v_mfma_f32_16x16x32_bf16 v[16:19], v[36:39], v[68:71], 0
  s_waitcnt lgkmcnt(6)
  ds_read_b64_tr_b16 v[124:125], v6 offset:27136
  ds_read_b64_tr_b16 v[126:127], v6 offset:27200
  v_mfma_f32_16x16x32_bf16 v[16:19], v[40:43], v[72:75], v[16:19]
  s_waitcnt lgkmcnt(6)
  ds_read_b64_tr_b16 v[104:105], v6 offset:27392
  ds_read_b64_tr_b16 v[106:107], v6 offset:27456
  v_mfma_f32_16x16x32_bf16 v[16:19], v[44:47], v[76:79], v[16:19]
  s_waitcnt lgkmcnt(6)
  ds_read_b64_tr_b16 v[108:109], v6 offset:27648
  ds_read_b64_tr_b16 v[110:111], v6 offset:27712
  v_mfma_f32_16x16x32_bf16 v[16:19], v[48:51], v[80:83], v[16:19]
  s_waitcnt lgkmcnt(6)
  v_cvt_pk_bf16_f32 v120, v24, v25
  v_cvt_pk_bf16_f32 v121, v26, v27
  v_mfma_f32_16x16x32_bf16 v[112:115], v[116:119], v[68:71], 0
  s_waitcnt lgkmcnt(4)
  buffer_store_dwordx4 v[120:123], v2, s[4:7], s29 offen offset:0 sc1
  v_mov_b64 v[98:99], 0
  v_mfma_f32_16x16x32_bf16 v[112:115], v[124:127], v[72:75], v[112:115]
  s_waitcnt lgkmcnt(2)
  v_mov_b64 v[36:37], 0
  v_exp_f32 v100, v16
  v_mfma_f32_16x16x32_bf16 v[112:115], v[104:107], v[76:79], v[112:115]
  s_waitcnt lgkmcnt(0)
  v_exp_f32 v101, v17
  v_mfma_f32_16x16x32_bf16 v[112:115], v[108:111], v[80:83], v[112:115]
  v_exp_f32 v102, v18
  v_mfma_f32_16x16x32_bf16 v[20:23], v[52:55], v[68:71], 0
  v_exp_f32 v103, v19
  v_mfma_f32_16x16x32_bf16 v[20:23], v[56:59], v[72:75], v[20:23]
  v_cvt_pk_bf16_f32 v44, v100, v101
  v_cvt_pk_bf16_f32 v45, v102, v103
  v_mfma_f32_16x16x32_bf16 v[20:23], v[60:63], v[76:79], v[20:23]
  s_add_u32 s29, s29, 131072
  v_exp_f32 v100, v112
  v_mfma_f32_16x16x32_bf16 v[20:23], v[64:67], v[80:83], v[20:23]
  v_exp_f32 v101, v113
  v_exp_f32 v102, v114
  v_exp_f32 v103, v115
  v_cvt_pk_bf16_f32 v84, v100, v101
  v_cvt_pk_bf16_f32 v85, v102, v103
  v_cndmask_b32 v48, v84, 0, s[16:17]
  v_cndmask_b32 v49, v85, 0, s[16:17]
  v_cndmask_b32 v50, 0, v84, s[16:17]
  v_cndmask_b32 v51, 0, v85, s[16:17]
  v_exp_f32 v100, v20
  v_mfma_f32_16x16x16_bf16 v[88:91], v[12:13], v[48:49], 0
  v_exp_f32 v101, v21
  v_mfma_f32_16x16x16_bf16 v[24:27], v[120:121], v[48:49], 0
  v_exp_f32 v102, v22
  v_mfma_f32_16x16x16_bf16 v[116:119], v[120:121], v[50:51], 0
  v_exp_f32 v103, v23
  v_cvt_pk_bf16_f32 v46, v100, v101
  v_cvt_pk_bf16_f32 v47, v102, v103
  v_mov_b64 v[38:39], 0
  s_nop 0
  v_mfma_f32_16x16x32_bf16 v[88:91], v[12:15], v[44:47], v[88:91]
  v_mov_b64 v[40:41], 0
  v_mov_b64 v[42:43], 0
  v_mfma_f32_16x16x32_bf16 v[24:27], v[28:31], v[44:47], v[24:27]
  ds_read_b128 v[52:55], v4 offset:24576
  ds_read_b128 v[56:59], v4 offset:25600
  v_mfma_f32_16x16x32_bf16 v[116:119], v[32:35], v[44:47], v[116:119]
  s_nop 1
T_back_82:
  v_rcp_f32 v89, v88
  v_subrev_u32 v100, s54, v88
  v_cmp_le_u32 vcc, s96, v100
  v_mul_f32 v24, v89, v24
  v_mul_f32 v25, v89, v25
  v_cvt_pk_bf16_f32 v124, v24, v25
  v_pk_mul_f32 v[26:27], v[26:27], v[88:89] op_sel:[0,1] op_sel_hi:[1,1]
  v_pk_mul_f32 v[116:117], v[116:117], v[88:89] op_sel:[0,1] op_sel_hi:[1,1]
  v_pk_mul_f32 v[118:119], v[118:119], v[88:89] op_sel:[0,1] op_sel_hi:[1,1]
  v_cvt_pk_bf16_f32 v125, v26, v27
  v_cvt_pk_bf16_f32 v126, v116, v117
  v_cvt_pk_bf16_f32 v127, v118, v119
  ds_write_b128 v11, v[124:127] offset:29184
  s_cbranch_vccnz T_slow_81
  v_smfmac_f32_16x16x64_bf16 v[92:95], v[124:127], a[160:167], v0
  s_mov_b32 s96, s55
  v_smfmac_f32_16x16x64_bf16 v[96:99], v[124:127], a[168:175], v0
  s_cmp_eq_u32 s14, 63
  v_smfmac_f32_16x16x64_bf16 v[36:39], v[124:127], a[176:183], v0
  s_waitcnt lgkmcnt(0)
  s_barrier
  ds_read_b128 v[104:107], v11 offset:29696
  ds_read_b128 v[108:111], v11 offset:30208
  ds_read_b128 v[68:71], v11 offset:30720
  s_cbranch_scc1 M_tdone
  v_smfmac_f32_16x16x64_bf16 v[40:43], v[124:127], a[184:191], v0
  s_waitcnt lgkmcnt(2)
  v_smfmac_f32_16x16x64_bf16 v[92:95], v[104:107], a[192:199], v0
  s_waitcnt lgkmcnt(1)
  ds_read_b128 v[76:79], v4 offset:28672
  v_smfmac_f32_16x16x64_bf16 v[92:95], v[108:111], a[224:231], v0
  s_waitcnt lgkmcnt(1)
  ds_read_b128 v[80:83], v4 offset:29696
  v_smfmac_f32_16x16x64_bf16 v[92:95], v[68:71], a[240:247], v0
  ds_read_b128 v[60:63], v4 offset:26624
  v_smfmac_f32_16x16x64_bf16 v[96:99], v[104:107], a[200:207], v0
  ds_read_b128 v[64:67], v4 offset:27648
  v_smfmac_f32_16x16x64_bf16 v[96:99], v[108:111], a[232:239], v0
  ds_read_b128 v[28:31], v4 offset:30720
  s_nop 0
  v_cvt_pk_bf16_f32 v16, v92, v93
  v_cvt_pk_bf16_f32 v17, v94, v95
  v_bfi_b32 v16, 1, s57, v16
  v_smfmac_f32_16x16x64_bf16 v[96:99], v[68:71], a[248:255], v0
  buffer_store_dwordx2 v[16:17], v7, s[4:7], s20 offen offset:0 sc1
  v_smfmac_f32_16x16x64_bf16 v[36:39], v[104:107], a[208:215], v0
  ds_read_b128 v[32:35], v4 offset:31744
  v_smfmac_f32_16x16x64_bf16 v[36:39], v[108:111], v[52:59], v0
  s_waitcnt lgkmcnt(4)
  s_nop 0
  v_cvt_pk_bf16_f32 v18, v96, v97
  v_cvt_pk_bf16_f32 v19, v98, v99
  v_bfi_b32 v18, 1, s57, v18
  v_smfmac_f32_16x16x64_bf16 v[36:39], v[68:71], v[76:83], v0
  buffer_store_dwordx2 v[18:19], v7, s[4:7], s20 offen offset:64 sc1
  v_smfmac_f32_16x16x64_bf16 v[40:43], v[104:107], a[216:223], v0
  s_waitcnt lgkmcnt(2)
  ds_read_b128 v[116:119], v2 offset:31232
  v_smfmac_f32_16x16x64_bf16 v[40:43], v[108:111], v[60:67], v0
  s_waitcnt lgkmcnt(1)
  s_nop 0
  v_cvt_pk_bf16_f32 v20, v36, v37
  v_cvt_pk_bf16_f32 v21, v38, v39
  v_bfi_b32 v20, 1, s57, v20
  v_smfmac_f32_16x16x64_bf16 v[40:43], v[68:71], v[28:35], v0
  buffer_store_dwordx2 v[20:21], v7, s[4:7], s21 offen offset:0 sc1
  s_nop 6
  v_cvt_pk_bf16_f32 v22, v40, v41
  v_cvt_pk_bf16_f32 v23, v42, v43
  v_bfi_b32 v22, 1, s57, v22
  buffer_store_dwordx2 v[22:23], v7, s[4:7], s21 offen offset:64 sc1
  ds_read_b128 v[68:71], v4 offset:0
  ds_read_b128 v[72:75], v4 offset:1024
  ds_read_b128 v[76:79], v4 offset:4096
  ds_read_b128 v[80:83], v4 offset:5120
  ds_read_b128 v[84:87], v4 offset:8192
  ds_read_b128 v[88:91], v4 offset:9216
  v_mov_b64 v[16:17], 0
  v_mov_b64 v[18:19], 0
  v_mov_b64 v[20:21], 0
  v_mov_b64 v[22:23], 0
  v_mov_b64 v[24:25], 0
  v_mov_b64 v[26:27], 0
  s_mov_b32 s19, 0
  v_mov_b32 v49, -1
  s_waitcnt vmcnt(2)
  buffer_load_dwordx4 v[52:55], v2, s[4:7], s22 offen offset:0 sc1
  buffer_load_dwordx4 v[56:59], v2, s[4:7], s22 offen offset:1024 sc1
  buffer_load_dwordx4 v[60:63], v2, s[4:7], s22 offen offset:2048 sc1
  buffer_load_dwordx4 v[64:67], v2, s[4:7], s22 offen offset:3072 sc1
  ds_read_b128 v[92:95], v4 offset:2048
  ds_read_b128 v[96:99], v4 offset:3072
  ds_read_b128 v[100:103], v4 offset:6144
  ds_read_b128 v[104:107], v4 offset:7168
  ds_read_b128 v[108:111], v4 offset:10240
  ds_read_b128 v[112:115], v4 offset:11264
  ds_read_b64 v[44:45], v2 offset:32256
  s_waitcnt lgkmcnt(0)
  v_readfirstlane_b32 s38, v44
  v_readfirstlane_b32 s37, v45
  s_nop 0
  s_lshl_b32 s38, s38, 1
  s_lshl1_add_u32 s37, s37, 1
  s_min_u32 s38, s38, s37
  s_cmp_ge_u32 s38, 64
  s_cselect_b32 s38, 100, s38
  s_sub_u32 s38, s38, 1
  s_max_i32 s30, s30, s38
  s_waitcnt lgkmcnt(12)
  s_waitcnt vmcnt(3)
  v_mfma_f32_16x16x32_bf16 v[120:123], v[116:119], v[52:55], 0
  v_xor_b32 v48, s57, v52
  v_bitop3_b32 v48, v48, v54, s57 bitop3:0xf6
  s_waitcnt vmcnt(2)
  v_mfma_f32_16x16x32_bf16 v[120:123], v[116:119], v[56:59], v[120:123]
  v_bitop3_b32 v48, v48, v56, s57 bitop3:0xf6
  v_bitop3_b32 v48, v48, v58, s57 bitop3:0xf6
  s_waitcnt vmcnt(1)
  v_mfma_f32_16x16x32_bf16 v[120:123], v[116:119], v[60:63], v[120:123]
  v_bitop3_b32 v48, v48, v60, s57 bitop3:0xf6
  v_bitop3_b32 v48, v48, v62, s57 bitop3:0xf6
  s_waitcnt vmcnt(0)
  v_mfma_f32_16x16x32_bf16 v[120:123], v[116:119], v[64:67], v[120:123]
  v_bitop3_b32 v48, v48, v64, s57 bitop3:0xf6
  v_bitop3_b32 v48, v48, v66, s57 bitop3:0xf6
  v_and_b32 v48, 1, v48
  v_cmp_ne_u32 vcc, 0, v48
  s_cbranch_vccnz T_p1re_84
T_p1ok_85:
  s_nop 2
  v_add_f32_dpp v120, v120, v120 row_ror:8 row_mask:0xf bank_mask:0xf
  v_add_f32_dpp v121, v121, v121 row_ror:8 row_mask:0xf bank_mask:0xf
  v_cvt_pk_bf16_f32 v48, v120, v121
  buffer_store_dword v48, v8, s[4:7], s35 offen sc1
  buffer_store_dword v49, v8, s[4:7], s26 offen sc1
  s_barrier
  ds_read_b128 v[28:31], v2 offset:16384
  ds_read_b128 v[32:35], v2 offset:20480
  ds_read_b128 v[36:39], v2 offset:8192
  ds_read_b128 v[40:43], v2 offset:9216
  ds_read_b128 v[44:47], v2 offset:10240
  ds_read_b128 v[48:51], v2 offset:11264
  buffer_load_dwordx4 v[124:127], v2, s[4:7], s24 offen offset:0 sc1
  buffer_load_dwordx4 v[116:119], v2, s[4:7], s25 offen offset:0 sc1
  ds_read_b128 v[52:55], v2 offset:12288
  ds_read_b128 v[56:59], v2 offset:13312
  ds_read_b128 v[60:63], v2 offset:14336
  ds_read_b128 v[64:67], v2 offset:15360
  buffer_load_dwordx4 v[124:127], v2, s[4:7], s24 offen offset:0 sc1
  buffer_load_dwordx4 v[116:119], v2, s[4:7], s25 offen offset:0 sc1
  s_add_u32 s14, s14, 1
  s_cmp_ge_i32 s14, s30
  s_cbranch_scc1 T_kvw_78
T_kvb_79:
  s_mov_b32 s19, 0
  s_branch T_loop_74
T_p1re_84:
  s_mov_b64 exec, vcc
  buffer_load_dwordx4 v[52:55], v2, s[4:7], s22 offen offset:0 sc1
  buffer_load_dwordx4 v[56:59], v2, s[4:7], s22 offen offset:1024 sc1
  buffer_load_dwordx4 v[60:63], v2, s[4:7], s22 offen offset:2048 sc1
  buffer_load_dwordx4 v[64:67], v2, s[4:7], s22 offen offset:3072 sc1
  s_mov_b64 exec, -1
  s_add_u32 s19, s19, 1
  s_cmp_gt_u32 s19, 32768
  s_cbranch_scc1 M_exit
  s_waitcnt vmcnt(3)
  v_mfma_f32_16x16x32_bf16 v[120:123], v[116:119], v[52:55], 0
  v_xor_b32 v48, s57, v52
  v_bitop3_b32 v48, v48, v54, s57 bitop3:0xf6
  s_waitcnt vmcnt(2)
  v_mfma_f32_16x16x32_bf16 v[120:123], v[116:119], v[56:59], v[120:123]
  v_bitop3_b32 v48, v48, v56, s57 bitop3:0xf6
  v_bitop3_b32 v48, v48, v58, s57 bitop3:0xf6
  s_waitcnt vmcnt(1)
  v_mfma_f32_16x16x32_bf16 v[120:123], v[116:119], v[60:63], v[120:123]
  v_bitop3_b32 v48, v48, v60, s57 bitop3:0xf6
  v_bitop3_b32 v48, v48, v62, s57 bitop3:0xf6
  s_waitcnt vmcnt(0)
  v_mfma_f32_16x16x32_bf16 v[120:123], v[116:119], v[64:67], v[120:123]
  v_bitop3_b32 v48, v48, v64, s57 bitop3:0xf6
  v_bitop3_b32 v48, v48, v66, s57 bitop3:0xf6
  v_and_b32 v48, 1, v48
  v_cmp_ne_u32 vcc, 0, v48
  s_cbranch_vccnz T_p1re_84
  s_branch T_p1ok_85
T_kvw_78:
  s_mov_b32 s19, 0
  s_branch T_kvok_87
T_kv_86:
  s_sleep 4
  s_add_u32 s19, s19, 1
  s_cmp_gt_u32 s19, 32768
  s_cbranch_scc1 M_exit
T_kvok_87:
  s_add_u32 s39, s99, 128
  s_mov_b32 s38, 0
  s_mov_b32 s37, 0
  s_atomic_or s38, s[58:59], s99 glc
  s_atomic_or s37, s[58:59], s39 glc
  s_waitcnt lgkmcnt(0)
  s_lshl_b32 s38, s38, 1
  s_lshl1_add_u32 s37, s37, 1
  s_min_u32 s38, s38, s37
  s_cmp_ge_u32 s38, 64
  s_cselect_b32 s38, 100, s38
  s_sub_u32 s38, s38, 1
  s_max_i32 s30, s30, s38
  s_cmp_ge_i32 s14, s30
  s_cbranch_scc1 T_kv_86
  s_branch T_kvb_79
T_slow_81:
  s_nop 7
  v_max3_f32 v100, v16, v17, v18
  v_max3_f32 v100, v100, v19, v20
  v_max3_f32 v100, v100, v21, v22
  v_max3_f32 v100, v100, v23, v112
  v_max3_f32 v100, v100, v113, v114
  v_max_f32 v100, v100, v115
  v_mov_b32 v101, v100
  s_nop 1
  v_permlane32_swap_b32 v100, v101
  s_nop 1
  v_max_f32 v100, v100, v101
  v_mov_b32 v101, v100
  s_nop 1
  v_permlane16_swap_b32 v100, v101
  s_nop 1
  v_max_f32 v100, v100, v101
  v_sub_f32 v16, v16, v100
  v_sub_f32 v17, v17, v100
  v_sub_f32 v18, v18, v100
  v_sub_f32 v19, v19, v100
  v_exp_f32 v16, v16
  v_exp_f32 v17, v17
  v_exp_f32 v18, v18
  v_exp_f32 v19, v19
  v_sub_f32 v20, v20, v100
  v_sub_f32 v21, v21, v100
  v_sub_f32 v22, v22, v100
  v_sub_f32 v23, v23, v100
  v_exp_f32 v20, v20
  v_exp_f32 v21, v21
  v_exp_f32 v22, v22
  v_exp_f32 v23, v23
  v_sub_f32 v112, v112, v100
  v_sub_f32 v113, v113, v100
  v_sub_f32 v114, v114, v100
  v_sub_f32 v115, v115, v100
  v_exp_f32 v112, v112
  v_exp_f32 v113, v113
  v_exp_f32 v114, v114
  v_exp_f32 v115, v115
  s_nop 0
  v_cvt_pk_bf16_f32 v44, v16, v17
  v_cvt_pk_bf16_f32 v45, v18, v19
  v_cvt_pk_bf16_f32 v46, v20, v21
  v_cvt_pk_bf16_f32 v47, v22, v23
  v_cvt_pk_bf16_f32 v84, v112, v113
  v_cvt_pk_bf16_f32 v85, v114, v115
  v_cndmask_b32 v48, v84, 0, s[16:17]
  v_cndmask_b32 v49, v85, 0, s[16:17]
  v_cndmask_b32 v50, 0, v84, s[16:17]
  v_cndmask_b32 v51, 0, v85, s[16:17]
  s_nop 1
  v_mfma_f32_16x16x16_bf16 v[88:91], v[12:13], v[48:49], 0
  v_mfma_f32_16x16x16_bf16 v[24:27], v[120:121], v[48:49], 0
  v_mfma_f32_16x16x16_bf16 v[116:119], v[120:121], v[50:51], 0
  v_mfma_f32_16x16x32_bf16 v[88:91], v[12:15], v[44:47], v[88:91]
  v_mfma_f32_16x16x32_bf16 v[24:27], v[28:31], v[44:47], v[24:27]
  v_mfma_f32_16x16x32_bf16 v[116:119], v[32:35], v[44:47], v[116:119]
  s_nop 7
  s_nop 1
  s_mov_b32 s96, -1
  s_branch T_back_82
T_w_71:
  s_mov_b32 s19, 0
  s_add_u32 s14, s14, 1
  s_and_b32 s57, s14, 1
  v_mov_b64 v[16:17], 0
  v_mov_b64 v[18:19], 0
  v_mov_b64 v[20:21], 0
  v_mov_b64 v[22:23], 0
  v_mov_b64 v[24:25], 0
  v_mov_b64 v[26:27], 0
  buffer_load_dwordx4 v[124:127], v2, s[4:7], s24 offen offset:1024 sc1
  buffer_load_dwordx4 v[116:119], v2, s[4:7], s25 offen offset:1024 sc1
  buffer_load_dwordx4 v[124:127], v2, s[4:7], s24 offen offset:1024 sc1
  buffer_load_dwordx4 v[116:119], v2, s[4:7], s25 offen offset:1024 sc1
  s_branch T_loop_88
.p2align 6
T_retry_89:
  s_mov_b64 exec, vcc
  buffer_load_dwordx4 v[124:127], v2, s[4:7], s24 offen offset:1024 sc1
  buffer_load_dwordx4 v[116:119], v2, s[4:7], s25 offen offset:1024 sc1
  s_mov_b64 exec, -1
  s_add_u32 s19, s19, 1
  s_cmp_gt_u32 s19, 32768
  s_cbranch_scc1 M_exit
  s_nop 0
  v_mov_b64 v[16:17], 0
  v_mov_b64 v[18:19], 0
T_loop_88:
  s_waitcnt vmcnt(3) lgkmcnt(0)
  v_max3_u32 v123, v124, v125, v126
  v_max_u32 v123, v123, v127
  v_mov_b32_dpp v120, v124 row_ror:8 row_mask:0xf bank_mask:0xf
  v_mov_b32_dpp v121, v125 row_ror:8 row_mask:0xf bank_mask:0xf
  s_waitcnt vmcnt(2)
  v_max3_u32 v123, v123, v116, v117
  v_max3_u32 v123, v123, v118, v119
  v_cmp_eq_u32 vcc, -1, v123
  v_smfmac_f32_16x16x64_bf16 v[16:19], v[124:127], v[68:75], v0
  s_cbranch_vccnz T_retry_89
  ds_write_b128 v2, v[124:127] offset:1024
  v_mov_b32_dpp v122, v126 row_ror:8 row_mask:0xf bank_mask:0xf
  v_smfmac_f32_16x16x64_bf16 v[20:23], v[124:127], v[76:83], v0
  s_and_b32 s57, s14, 1
  v_mov_b32_dpp v123, v127 row_ror:8 row_mask:0xf bank_mask:0xf
  v_smfmac_f32_16x16x64_bf16 v[24:27], v[124:127], v[84:91], v0
  s_and_b32 s36, s14, 3
  ds_write_b128 v2, v[116:119] offset:5120
  v_smfmac_f32_16x16x64_bf16 v[16:19], v[120:123], v[92:99], v0
  s_lshl_b32 s36, s36, 13
  v_mov_b32_dpp v84, v116 row_ror:8 row_mask:0xf bank_mask:0xf
  v_smfmac_f32_16x16x64_bf16 v[20:23], v[120:123], v[100:107], v0
  s_add_u32 s26, s36, s23
  ds_read_b128 v[68:71], v4 offset:12288
  v_mov_b32_dpp v85, v117 row_ror:8 row_mask:0xf bank_mask:0xf
  v_smfmac_f32_16x16x64_bf16 v[24:27], v[120:123], v[108:115], v0
  s_add_u32 s36, s36, 8192
  ds_read_b128 v[72:75], v4 offset:13312
  v_mov_b32_dpp v86, v118 row_ror:8 row_mask:0xf bank_mask:0xf
  v_smfmac_f32_16x16x64_bf16 v[16:19], v[116:119], v[224:231], v0
  s_and_b32 s36, s36, 0x7fff
  ds_read_b128 v[76:79], v4 offset:14336
  v_mov_b32_dpp v87, v119 row_ror:8 row_mask:0xf bank_mask:0xf
  v_smfmac_f32_16x16x64_bf16 v[20:23], v[116:119], v[240:247], v0
  s_waitcnt lgkmcnt(3)
  s_barrier
  ds_read_b128 v[100:103], v2 offset:0
  v_smfmac_f32_16x16x64_bf16 v[24:27], v[116:119], a[0:7], v0
  s_mov_b32 m0, s31
  ds_read_b128 v[120:123], v1 offset:0
  v_smfmac_f32_16x16x64_bf16 v[16:19], v[84:87], v[232:239], v0
  buffer_load_dwordx4 v9, s[4:7], s27 offen sc1 lds
  v_smfmac_f32_16x16x64_bf16 v[20:23], v[84:87], v[248:255], v0
  ds_read_b128 v[80:83], v4 offset:15360
  s_mov_b32 m0, s32
  v_smfmac_f32_16x16x64_bf16 v[24:27], v[84:87], a[8:15], v0
  s_waitcnt lgkmcnt(2)
  v_smfmac_f32_16x16x64_bf16 v[16:19], v[100:103], v[128:135], v0
  ds_read_b128 v[92:95], v2 offset:3072
  v_smfmac_f32_16x16x64_bf16 v[20:23], v[100:103], v[144:151], v0
  ds_read_b128 v[96:99], v1 offset:3072
  buffer_load_dwordx4 v9, s[4:7], s27 offen offset:128 sc1 lds
  v_smfmac_f32_16x16x64_bf16 v[24:27], v[100:103], v[68:75], v0
  s_waitcnt vmcnt(2) lgkmcnt(3)
  ds_read_b128 v[116:119], v2 offset:2048
  s_mov_b32 m0, s33
  v_smfmac_f32_16x16x64_bf16 v[16:19], v[120:123], v[136:143], v0
  ds_read_b128 v[124:127], v1 offset:2048
  v_smfmac_f32_16x16x64_bf16 v[20:23], v[120:123], v[152:159], v0
  s_waitcnt lgkmcnt(4)
  ds_read_b128 v[104:107], v2 offset:4096
  v_smfmac_f32_16x16x64_bf16 v[24:27], v[120:123], v[76:83], v0
  s_waitcnt lgkmcnt(4)
  ds_read_b128 v[108:111], v1 offset:4096
  buffer_load_dwordx4 v10, s[4:7], s28 offen sc1 lds
  v_smfmac_f32_16x16x64_bf16 v[16:19], v[92:95], v[160:167], v0
  s_waitcnt lgkmcnt(4)
  ds_read_b128 v[112:115], v2 offset:7168
  s_mov_b32 m0, s34
  v_smfmac_f32_16x16x64_bf16 v[16:19], v[96:99], v[168:175], v0
  s_waitcnt lgkmcnt(4)
  ds_read_b128 v[84:87], v1 offset:7168
  v_smfmac_f32_16x16x64_bf16 v[16:19], v[116:119], v[192:199], v0
  s_waitcnt lgkmcnt(4)
  ds_read_b128 v[88:91], v2 offset:6144
  v_smfmac_f32_16x16x64_bf16 v[16:19], v[124:127], v[200:207], v0
  s_waitcnt lgkmcnt(4)
  ds_read_b128 v[100:103], v1 offset:6144
  buffer_load_dwordx4 v10, s[4:7], s28 offen offset:256 sc1 lds
  v_smfmac_f32_16x16x64_bf16 v[16:19], v[104:107], a[16:23], v0
  s_waitcnt lgkmcnt(4)
  ds_read_b128 v[68:71], v4 offset:16384
  v_smfmac_f32_16x16x64_bf16 v[16:19], v[108:111], a[24:31], v0
  s_waitcnt lgkmcnt(4)
  ds_read_b128 v[72:75], v4 offset:17408
  v_smfmac_f32_16x16x64_bf16 v[16:19], v[112:115], a[64:71], v0
  s_waitcnt lgkmcnt(4)
  ds_read_b128 v[76:79], v4 offset:18432
  v_smfmac_f32_16x16x64_bf16 v[16:19], v[84:87], a[72:79], v0
  s_waitcnt lgkmcnt(4)
  ds_read_b128 v[80:83], v4 offset:19456
  v_smfmac_f32_16x16x64_bf16 v[16:19], v[88:91], a[112:119], v0
  s_waitcnt lgkmcnt(4)
  v_smfmac_f32_16x16x64_bf16 v[16:19], v[100:103], a[120:127], v0
  s_add_u32 s24, s36, 145752064
  s_add_u32 s25, s36, 145756160
  v_smfmac_f32_16x16x64_bf16 v[20:23], v[92:95], v[176:183], v0
  s_add_u32 s35, s36, s23
  v_smfmac_f32_16x16x64_bf16 v[20:23], v[96:99], v[184:191], v0
  s_waitcnt lgkmcnt(2)
  v_smfmac_f32_16x16x64_bf16 v[20:23], v[116:119], v[68:75], v0
  s_waitcnt lgkmcnt(0)
  ds_read_b128 v[68:71], v4 offset:20480
  v_mul_f32 v16, s18, v16
  v_smfmac_f32_16x16x64_bf16 v[20:23], v[124:127], v[76:83], v0
  ds_read_b128 v[72:75], v4 offset:21504
  v_mul_f32 v17, s18, v17
  v_smfmac_f32_16x16x64_bf16 v[20:23], v[104:107], a[32:39], v0
  ds_read_b128 v[76:79], v4 offset:22528
  v_mul_f32 v18, s18, v18
  v_smfmac_f32_16x16x64_bf16 v[20:23], v[108:111], a[40:47], v0
  ds_read_b128 v[80:83], v4 offset:23552
  v_mul_f32 v19, s18, v19
  v_smfmac_f32_16x16x64_bf16 v[20:23], v[112:115], a[80:87], v0
  v_cvt_pk_bf16_f32 v120, v16, v17
  v_smfmac_f32_16x16x64_bf16 v[20:23], v[84:87], a[88:95], v0
  v_cvt_pk_bf16_f32 v121, v18, v19
  v_smfmac_f32_16x16x64_bf16 v[20:23], v[88:91], a[128:135], v0
  ds_write_b64 v5, v[120:121] offset:24576
  v_smfmac_f32_16x16x64_bf16 v[20:23], v[100:103], a[136:143], v0
  s_waitcnt lgkmcnt(3)
  v_smfmac_f32_16x16x64_bf16 v[24:27], v[92:95], v[68:75], v0
  s_waitcnt lgkmcnt(1)
  v_mov_b64 v[92:93], 0
  v_smfmac_f32_16x16x64_bf16 v[24:27], v[96:99], v[76:83], v0
  s_nop 1
  v_cvt_pk_bf16_f32 v122, v20, v21
  v_cvt_pk_bf16_f32 v123, v22, v23
  v_smfmac_f32_16x16x64_bf16 v[24:27], v[116:119], v[208:215], v0
  ds_write_b64 v5, v[122:123] offset:26880
  v_mov_b64 v[94:95], 0
  v_smfmac_f32_16x16x64_bf16 v[24:27], v[124:127], v[216:223], v0
  s_waitcnt lgkmcnt(1)
  s_barrier
  ds_read_b64_tr_b16 v[68:69], v6 offset:24576
  v_smfmac_f32_16x16x64_bf16 v[24:27], v[104:107], a[48:55], v0
  s_add_u32 s27, s27, 8192
  ds_read_b64_tr_b16 v[70:71], v6 offset:24640
  ds_read_b64_tr_b16 v[72:73], v6 offset:24832
  v_smfmac_f32_16x16x64_bf16 v[24:27], v[108:111], a[56:63], v0
  s_add_u32 s28, s28, 8192
  ds_read_b64_tr_b16 v[74:75], v6 offset:24896
  ds_read_b64_tr_b16 v[76:77], v6 offset:25088
  v_smfmac_f32_16x16x64_bf16 v[24:27], v[112:115], a[96:103], v0
  s_nop 0
  ds_read_b64_tr_b16 v[78:79], v6 offset:25152
  ds_read_b64_tr_b16 v[80:81], v6 offset:25344
  v_smfmac_f32_16x16x64_bf16 v[24:27], v[84:87], a[104:111], v0
  ds_read_b64_tr_b16 v[82:83], v6 offset:25408
  v_mov_b64 v[96:97], 0
  v_smfmac_f32_16x16x64_bf16 v[24:27], v[88:91], a[144:151], v0
  s_waitcnt lgkmcnt(8)
  s_barrier
  ds_read_b64_tr_b16 v[116:117], v6 offset:26880
  v_smfmac_f32_16x16x64_bf16 v[24:27], v[100:103], a[152:159], v0
  s_waitcnt lgkmcnt(7)
  ds_read_b64_tr_b16 v[118:119], v6 offset:26944
  v_mfma_f32_16x16x32_bf16 v[16:19], v[36:39], v[68:71], 0
  s_waitcnt lgkmcnt(6)
  ds_read_b64_tr_b16 v[124:125], v6 offset:27136
  ds_read_b64_tr_b16 v[126:127], v6 offset:27200
  v_mfma_f32_16x16x32_bf16 v[16:19], v[40:43], v[72:75], v[16:19]
  s_waitcnt lgkmcnt(6)
  ds_read_b64_tr_b16 v[104:105], v6 offset:27392
  ds_read_b64_tr_b16 v[106:107], v6 offset:27456
  v_mfma_f32_16x16x32_bf16 v[16:19], v[44:47], v[76:79], v[16:19]
  s_waitcnt lgkmcnt(6)
  ds_read_b64_tr_b16 v[108:109], v6 offset:27648
  ds_read_b64_tr_b16 v[110:111], v6 offset:27712
  v_mfma_f32_16x16x32_bf16 v[16:19], v[48:51], v[80:83], v[16:19]
  s_waitcnt lgkmcnt(6)
  v_cvt_pk_bf16_f32 v120, v24, v25
  v_cvt_pk_bf16_f32 v121, v26, v27
  v_mfma_f32_16x16x32_bf16 v[112:115], v[116:119], v[68:71], 0
  s_waitcnt lgkmcnt(4)
  v_mov_b64 v[98:99], 0
  v_mfma_f32_16x16x32_bf16 v[112:115], v[124:127], v[72:75], v[112:115]
  s_waitcnt lgkmcnt(2)
  buffer_store_dwordx4 v[120:123], v2, s[4:7], s29 offen offset:1024 sc1
  v_mov_b64 v[36:37], 0
  v_exp_f32 v100, v16
  v_mfma_f32_16x16x32_bf16 v[112:115], v[104:107], v[76:79], v[112:115]
  s_waitcnt lgkmcnt(0)
  v_exp_f32 v101, v17
  v_mfma_f32_16x16x32_bf16 v[112:115], v[108:111], v[80:83], v[112:115]
  v_exp_f32 v102, v18
  v_mfma_f32_16x16x32_bf16 v[20:23], v[52:55], v[68:71], 0
  v_exp_f32 v103, v19
  v_mfma_f32_16x16x32_bf16 v[20:23], v[56:59], v[72:75], v[20:23]
  v_cvt_pk_bf16_f32 v44, v100, v101
  v_cvt_pk_bf16_f32 v45, v102, v103
  v_mfma_f32_16x16x32_bf16 v[20:23], v[60:63], v[76:79], v[20:23]
  s_add_u32 s29, s29, 131072
  v_exp_f32 v100, v112
  v_mfma_f32_16x16x32_bf16 v[20:23], v[64:67], v[80:83], v[20:23]
  v_exp_f32 v101, v113
  v_exp_f32 v102, v114
  v_exp_f32 v103, v115
  v_cvt_pk_bf16_f32 v84, v100, v101
  v_cvt_pk_bf16_f32 v85, v102, v103
  v_cndmask_b32 v48, v84, 0, s[16:17]
  v_cndmask_b32 v49, v85, 0, s[16:17]
  v_cndmask_b32 v50, 0, v84, s[16:17]
  v_cndmask_b32 v51, 0, v85, s[16:17]
  v_exp_f32 v100, v20
  v_mfma_f32_16x16x16_bf16 v[88:91], v[12:13], v[48:49], 0
  v_exp_f32 v101, v21
  v_mfma_f32_16x16x16_bf16 v[24:27], v[120:121], v[48:49], 0
  v_exp_f32 v102, v22
  v_mfma_f32_16x16x16_bf16 v[116:119], v[120:121], v[50:51], 0
  v_exp_f32 v103, v23
  v_cvt_pk_bf16_f32 v46, v100, v101
  v_cvt_pk_bf16_f32 v47, v102, v103
  v_mov_b64 v[38:39], 0
  s_nop 0
  v_mfma_f32_16x16x32_bf16 v[88:91], v[12:15], v[44:47], v[88:91]
  v_mov_b64 v[40:41], 0
  v_mov_b64 v[42:43], 0
  v_mfma_f32_16x16x32_bf16 v[24:27], v[28:31], v[44:47], v[24:27]
  ds_read_b128 v[52:55], v4 offset:24576
  ds_read_b128 v[56:59], v4 offset:25600
  v_mfma_f32_16x16x32_bf16 v[116:119], v[32:35], v[44:47], v[116:119]
  s_nop 1
T_back_96:
  v_rcp_f32 v89, v88
  v_subrev_u32 v100, s54, v88
  v_cmp_le_u32 vcc, s96, v100
  v_mul_f32 v24, v89, v24
  v_mul_f32 v25, v89, v25
  v_cvt_pk_bf16_f32 v124, v24, v25
  v_pk_mul_f32 v[26:27], v[26:27], v[88:89] op_sel:[0,1] op_sel_hi:[1,1]
  v_pk_mul_f32 v[116:117], v[116:117], v[88:89] op_sel:[0,1] op_sel_hi:[1,1]
  v_pk_mul_f32 v[118:119], v[118:119], v[88:89] op_sel:[0,1] op_sel_hi:[1,1]
  v_cvt_pk_bf16_f32 v125, v26, v27
  v_cvt_pk_bf16_f32 v126, v116, v117
  v_cvt_pk_bf16_f32 v127, v118, v119
  ds_write_b128 v11, v[124:127] offset:29696
  s_cbranch_vccnz T_slow_95
  v_smfmac_f32_16x16x64_bf16 v[92:95], v[124:127], a[160:167], v0
  s_mov_b32 s96, s55
  v_smfmac_f32_16x16x64_bf16 v[96:99], v[124:127], a[168:175], v0
  s_cmp_eq_u32 s14, 63
  v_smfmac_f32_16x16x64_bf16 v[36:39], v[124:127], a[176:183], v0
  s_waitcnt lgkmcnt(0)
  s_barrier
  ds_read_b128 v[104:107], v11 offset:29184
  ds_read_b128 v[108:111], v11 offset:30720
  ds_read_b128 v[68:71], v11 offset:30208
  s_cbranch_scc1 M_tdone
  v_smfmac_f32_16x16x64_bf16 v[40:43], v[124:127], a[184:191], v0
  s_waitcnt lgkmcnt(2)
  v_smfmac_f32_16x16x64_bf16 v[92:95], v[104:107], a[192:199], v0
  s_waitcnt lgkmcnt(1)
  ds_read_b128 v[76:79], v4 offset:28672
  v_smfmac_f32_16x16x64_bf16 v[92:95], v[108:111], a[224:231], v0
  s_waitcnt lgkmcnt(1)
  ds_read_b128 v[80:83], v4 offset:29696
  v_smfmac_f32_16x16x64_bf16 v[92:95], v[68:71], a[240:247], v0
  ds_read_b128 v[60:63], v4 offset:26624
  v_smfmac_f32_16x16x64_bf16 v[96:99], v[104:107], a[200:207], v0
  ds_read_b128 v[64:67], v4 offset:27648
  v_smfmac_f32_16x16x64_bf16 v[96:99], v[108:111], a[232:239], v0
  ds_read_b128 v[28:31], v4 offset:30720
  s_nop 0
  v_cvt_pk_bf16_f32 v16, v92, v93
  v_cvt_pk_bf16_f32 v17, v94, v95
  v_bfi_b32 v16, 1, s57, v16
  v_smfmac_f32_16x16x64_bf16 v[96:99], v[68:71], a[248:255], v0
  buffer_store_dwordx2 v[16:17], v7, s[4:7], s20 offen offset:0 sc1
  v_smfmac_f32_16x16x64_bf16 v[36:39], v[104:107], a[208:215], v0
  ds_read_b128 v[32:35], v4 offset:31744
  v_smfmac_f32_16x16x64_bf16 v[36:39], v[108:111], v[52:59], v0
  s_waitcnt lgkmcnt(4)
  s_nop 0
  v_cvt_pk_bf16_f32 v18, v96, v97
  v_cvt_pk_bf16_f32 v19, v98, v99
  v_bfi_b32 v18, 1, s57, v18
  v_smfmac_f32_16x16x64_bf16 v[36:39], v[68:71], v[76:83], v0
  buffer_store_dwordx2 v[18:19], v7, s[4:7], s20 offen offset:64 sc1
  v_smfmac_f32_16x16x64_bf16 v[40:43], v[104:107], a[216:223], v0
  s_waitcnt lgkmcnt(2)
  ds_read_b128 v[116:119], v2 offset:31232
  v_smfmac_f32_16x16x64_bf16 v[40:43], v[108:111], v[60:67], v0
  s_waitcnt lgkmcnt(1)
  s_nop 0
  v_cvt_pk_bf16_f32 v20, v36, v37
  v_cvt_pk_bf16_f32 v21, v38, v39
  v_bfi_b32 v20, 1, s57, v20
  v_smfmac_f32_16x16x64_bf16 v[40:43], v[68:71], v[28:35], v0
  buffer_store_dwordx2 v[20:21], v7, s[4:7], s21 offen offset:0 sc1
  s_nop 6
  v_cvt_pk_bf16_f32 v22, v40, v41
  v_cvt_pk_bf16_f32 v23, v42, v43
  v_bfi_b32 v22, 1, s57, v22
  buffer_store_dwordx2 v[22:23], v7, s[4:7], s21 offen offset:64 sc1
  ds_read_b128 v[68:71], v4 offset:0
  ds_read_b128 v[72:75], v4 offset:1024
  ds_read_b128 v[76:79], v4 offset:4096
  ds_read_b128 v[80:83], v4 offset:5120
  ds_read_b128 v[84:87], v4 offset:8192
  ds_read_b128 v[88:91], v4 offset:9216
  ds_read_b128 v[92:95], v4 offset:2048
  ds_read_b128 v[96:99], v4 offset:3072
  ds_read_b128 v[100:103], v4 offset:6144
  ds_read_b128 v[104:107], v4 offset:7168
  ds_read_b128 v[108:111], v4 offset:10240
  ds_read_b128 v[112:115], v4 offset:11264
  v_mov_b64 v[16:17], 0
  v_mov_b64 v[18:19], 0
  v_mov_b64 v[20:21], 0
  v_mov_b64 v[22:23], 0
  v_mov_b64 v[24:25], 0
  v_mov_b64 v[26:27], 0
  s_mov_b32 s19, 0
  v_mov_b32 v49, -1
  ds_read_b64 v[44:45], v2 offset:32256
  s_waitcnt lgkmcnt(0)
  v_readfirstlane_b32 s38, v44
  v_readfirstlane_b32 s37, v45
  s_nop 0
  s_lshl_b32 s38, s38, 1
  s_lshl1_add_u32 s37, s37, 1
  s_min_u32 s38, s38, s37
  s_cmp_ge_u32 s38, 64
  s_cselect_b32 s38, 100, s38
  s_sub_u32 s38, s38, 1
  s_max_i32 s30, s30, s38
  s_waitcnt vmcnt(0)
  buffer_load_dwordx4 v[52:55], v2, s[4:7], s22 offen offset:0 sc1
  buffer_load_dwordx4 v[56:59], v2, s[4:7], s22 offen offset:1024 sc1
  buffer_load_dwordx4 v[60:63], v2, s[4:7], s22 offen offset:2048 sc1
  buffer_load_dwordx4 v[64:67], v2, s[4:7], s22 offen offset:3072 sc1
  s_waitcnt lgkmcnt(12)
  s_waitcnt vmcnt(3)
  v_mfma_f32_16x16x32_bf16 v[120:123], v[116:119], v[52:55], 0
  v_xor_b32 v48, s57, v52
  v_bitop3_b32 v48, v48, v54, s57 bitop3:0xf6
  s_waitcnt vmcnt(2)
  v_mfma_f32_16x16x32_bf16 v[120:123], v[116:119], v[56:59], v[120:123]
  v_bitop3_b32 v48, v48, v56, s57 bitop3:0xf6
  v_bitop3_b32 v48, v48, v58, s57 bitop3:0xf6
  s_waitcnt vmcnt(1)
  v_mfma_f32_16x16x32_bf16 v[120:123], v[116:119], v[60:63], v[120:123]
  v_bitop3_b32 v48, v48, v60, s57 bitop3:0xf6
  v_bitop3_b32 v48, v48, v62, s57 bitop3:0xf6
  s_waitcnt vmcnt(0)
  v_mfma_f32_16x16x32_bf16 v[120:123], v[116:119], v[64:67], v[120:123]
  v_bitop3_b32 v48, v48, v64, s57 bitop3:0xf6
  v_bitop3_b32 v48, v48, v66, s57 bitop3:0xf6
  v_and_b32 v48, 1, v48
  v_cmp_ne_u32 vcc, 0, v48
  s_cbranch_vccnz T_p1re_98
T_p1ok_99:
  s_nop 2
  v_add_f32_dpp v120, v120, v120 row_ror:8 row_mask:0xf bank_mask:0xf
  v_add_f32_dpp v121, v121, v121 row_ror:8 row_mask:0xf bank_mask:0xf
  v_cvt_pk_bf16_f32 v48, v120, v121
  buffer_store_dword v48, v8, s[4:7], s35 offen sc1
  buffer_store_dword v49, v8, s[4:7], s26 offen sc1
  s_barrier
  ds_read_b128 v[28:31], v2 offset:17408
  ds_read_b128 v[32:35], v2 offset:21504
  ds_read_b128 v[36:39], v2 offset:8192
  ds_read_b128 v[40:43], v2 offset:9216
  ds_read_b128 v[44:47], v2 offset:10240
  ds_read_b128 v[48:51], v2 offset:11264
  buffer_load_dwordx4 v[124:127], v2, s[4:7], s24 offen offset:1024 sc1
  buffer_load_dwordx4 v[116:119], v2, s[4:7], s25 offen offset:1024 sc1
  ds_read_b128 v[52:55], v2 offset:12288
  ds_read_b128 v[56:59], v2 offset:13312
  ds_read_b128 v[60:63], v2 offset:14336
  ds_read_b128 v[64:67], v2 offset:15360
  buffer_load_dwordx4 v[124:127], v2, s[4:7], s24 offen offset:1024 sc1
  buffer_load_dwordx4 v[116:119], v2, s[4:7], s25 offen offset:1024 sc1
  s_add_u32 s14, s14, 1
  s_cmp_ge_i32 s14, s30
  s_cbranch_scc1 T_kvw_92
T_kvb_93:
  s_mov_b32 s19, 0
  s_branch T_loop_88
T_p1re_98:
  s_mov_b64 exec, vcc
  buffer_load_dwordx4 v[52:55], v2, s[4:7], s22 offen offset:0 sc1
  buffer_load_dwordx4 v[56:59], v2, s[4:7], s22 offen offset:1024 sc1
  buffer_load_dwordx4 v[60:63], v2, s[4:7], s22 offen offset:2048 sc1
  buffer_load_dwordx4 v[64:67], v2, s[4:7], s22 offen offset:3072 sc1
  s_mov_b64 exec, -1
  s_add_u32 s19, s19, 1
  s_cmp_gt_u32 s19, 32768
  s_cbranch_scc1 M_exit
  s_waitcnt vmcnt(3)
  v_mfma_f32_16x16x32_bf16 v[120:123], v[116:119], v[52:55], 0
  v_xor_b32 v48, s57, v52
  v_bitop3_b32 v48, v48, v54, s57 bitop3:0xf6
  s_waitcnt vmcnt(2)
  v_mfma_f32_16x16x32_bf16 v[120:123], v[116:119], v[56:59], v[120:123]
  v_bitop3_b32 v48, v48, v56, s57 bitop3:0xf6
  v_bitop3_b32 v48, v48, v58, s57 bitop3:0xf6
  s_waitcnt vmcnt(1)
  v_mfma_f32_16x16x32_bf16 v[120:123], v[116:119], v[60:63], v[120:123]
  v_bitop3_b32 v48, v48, v60, s57 bitop3:0xf6
  v_bitop3_b32 v48, v48, v62, s57 bitop3:0xf6
  s_waitcnt vmcnt(0)
  v_mfma_f32_16x16x32_bf16 v[120:123], v[116:119], v[64:67], v[120:123]
  v_bitop3_b32 v48, v48, v64, s57 bitop3:0xf6
  v_bitop3_b32 v48, v48, v66, s57 bitop3:0xf6
  v_and_b32 v48, 1, v48
  v_cmp_ne_u32 vcc, 0, v48
  s_cbranch_vccnz T_p1re_98
  s_branch T_p1ok_99
T_kvw_92:
  s_mov_b32 s19, 0
  s_branch T_kvok_101
T_kv_100:
  s_sleep 4
  s_add_u32 s19, s19, 1
  s_cmp_gt_u32 s19, 32768
  s_cbranch_scc1 M_exit
T_kvok_101:
  s_add_u32 s39, s99, 128
  s_mov_b32 s38, 0
  s_mov_b32 s37, 0
  s_atomic_or s38, s[58:59], s99 glc
  s_atomic_or s37, s[58:59], s39 glc
  s_waitcnt lgkmcnt(0)
  s_lshl_b32 s38, s38, 1
  s_lshl1_add_u32 s37, s37, 1
  s_min_u32 s38, s38, s37
  s_cmp_ge_u32 s38, 64
  s_cselect_b32 s38, 100, s38
  s_sub_u32 s38, s38, 1
  s_max_i32 s30, s30, s38
  s_cmp_ge_i32 s14, s30
  s_cbranch_scc1 T_kv_100
  s_branch T_kvb_93
T_slow_95:
  s_nop 7
  v_max3_f32 v100, v16, v17, v18
  v_max3_f32 v100, v100, v19, v20
  v_max3_f32 v100, v100, v21, v22
  v_max3_f32 v100, v100, v23, v112
  v_max3_f32 v100, v100, v113, v114
  v_max_f32 v100, v100, v115
  v_mov_b32 v101, v100
  s_nop 1
  v_permlane32_swap_b32 v100, v101
  s_nop 1
  v_max_f32 v100, v100, v101
  v_mov_b32 v101, v100
  s_nop 1
  v_permlane16_swap_b32 v100, v101
  s_nop 1
  v_max_f32 v100, v100, v101
  v_sub_f32 v16, v16, v100
  v_sub_f32 v17, v17, v100
  v_sub_f32 v18, v18, v100
  v_sub_f32 v19, v19, v100
  v_exp_f32 v16, v16
  v_exp_f32 v17, v17
  v_exp_f32 v18, v18
  v_exp_f32 v19, v19
  v_sub_f32 v20, v20, v100
  v_sub_f32 v21, v21, v100
  v_sub_f32 v22, v22, v100
  v_sub_f32 v23, v23, v100
  v_exp_f32 v20, v20
  v_exp_f32 v21, v21
  v_exp_f32 v22, v22
  v_exp_f32 v23, v23
  v_sub_f32 v112, v112, v100
  v_sub_f32 v113, v113, v100
  v_sub_f32 v114, v114, v100
  v_sub_f32 v115, v115, v100
  v_exp_f32 v112, v112
  v_exp_f32 v113, v113
  v_exp_f32 v114, v114
  v_exp_f32 v115, v115
  s_nop 0
  v_cvt_pk_bf16_f32 v44, v16, v17
  v_cvt_pk_bf16_f32 v45, v18, v19
  v_cvt_pk_bf16_f32 v46, v20, v21
  v_cvt_pk_bf16_f32 v47, v22, v23
  v_cvt_pk_bf16_f32 v84, v112, v113
  v_cvt_pk_bf16_f32 v85, v114, v115
  v_cndmask_b32 v48, v84, 0, s[16:17]
  v_cndmask_b32 v49, v85, 0, s[16:17]
  v_cndmask_b32 v50, 0, v84, s[16:17]
  v_cndmask_b32 v51, 0, v85, s[16:17]
  s_nop 1
  v_mfma_f32_16x16x16_bf16 v[88:91], v[12:13], v[48:49], 0
  v_mfma_f32_16x16x16_bf16 v[24:27], v[120:121], v[48:49], 0
  v_mfma_f32_16x16x16_bf16 v[116:119], v[120:121], v[50:51], 0
  v_mfma_f32_16x16x32_bf16 v[88:91], v[12:15], v[44:47], v[88:91]
  v_mfma_f32_16x16x32_bf16 v[24:27], v[28:31], v[44:47], v[24:27]
  v_mfma_f32_16x16x32_bf16 v[116:119], v[32:35], v[44:47], v[116:119]
  s_nop 7
  s_nop 1
  s_mov_b32 s96, -1
  s_branch T_back_96
T_w_72:
  s_mov_b32 s19, 0
  s_add_u32 s14, s14, 1
  s_and_b32 s57, s14, 1
  v_mov_b64 v[16:17], 0
  v_mov_b64 v[18:19], 0
  v_mov_b64 v[20:21], 0
  v_mov_b64 v[22:23], 0
  v_mov_b64 v[24:25], 0
  v_mov_b64 v[26:27], 0
  buffer_load_dwordx4 v[124:127], v2, s[4:7], s24 offen offset:2048 sc1
  buffer_load_dwordx4 v[116:119], v2, s[4:7], s25 offen offset:2048 sc1
  buffer_load_dwordx4 v[124:127], v2, s[4:7], s24 offen offset:2048 sc1
  buffer_load_dwordx4 v[116:119], v2, s[4:7], s25 offen offset:2048 sc1
  s_branch T_loop_102
.p2align 6
T_retry_103:
  s_mov_b64 exec, vcc
  buffer_load_dwordx4 v[124:127], v2, s[4:7], s24 offen offset:2048 sc1
  buffer_load_dwordx4 v[116:119], v2, s[4:7], s25 offen offset:2048 sc1
  s_mov_b64 exec, -1
  s_add_u32 s19, s19, 1
  s_cmp_gt_u32 s19, 32768
  s_cbranch_scc1 M_exit
  s_nop 0
  v_mov_b64 v[16:17], 0
  v_mov_b64 v[18:19], 0
T_loop_102:
  s_waitcnt vmcnt(3) lgkmcnt(0)
  v_max3_u32 v123, v124, v125, v126
  v_max_u32 v123, v123, v127
  v_mov_b32_dpp v120, v124 row_ror:8 row_mask:0xf bank_mask:0xf
  v_mov_b32_dpp v121, v125 row_ror:8 row_mask:0xf bank_mask:0xf
  s_waitcnt vmcnt(2)
  v_max3_u32 v123, v123, v116, v117
  v_max3_u32 v123, v123, v118, v119
  v_cmp_eq_u32 vcc, -1, v123
  v_smfmac_f32_16x16x64_bf16 v[16:19], v[124:127], v[68:75], v0
  s_cbranch_vccnz T_retry_103
  ds_write_b128 v2, v[124:127] offset:2048
  v_mov_b32_dpp v122, v126 row_ror:8 row_mask:0xf bank_mask:0xf
  v_smfmac_f32_16x16x64_bf16 v[20:23], v[124:127], v[76:83], v0
  s_and_b32 s57, s14, 1
  v_mov_b32_dpp v123, v127 row_ror:8 row_mask:0xf bank_mask:0xf
  v_smfmac_f32_16x16x64_bf16 v[24:27], v[124:127], v[84:91], v0
  s_and_b32 s36, s14, 3
  ds_write_b128 v2, v[116:119] offset:6144
  v_smfmac_f32_16x16x64_bf16 v[16:19], v[120:123], v[92:99], v0
  s_lshl_b32 s36, s36, 13
  v_mov_b32_dpp v84, v116 row_ror:8 row_mask:0xf bank_mask:0xf
  v_smfmac_f32_16x16x64_bf16 v[20:23], v[120:123], v[100:107], v0
  s_add_u32 s26, s36, s23
  ds_read_b128 v[68:71], v4 offset:12288
  v_mov_b32_dpp v85, v117 row_ror:8 row_mask:0xf bank_mask:0xf
  v_smfmac_f32_16x16x64_bf16 v[24:27], v[120:123], v[108:115], v0
  s_add_u32 s36, s36, 8192
  ds_read_b128 v[72:75], v4 offset:13312
  v_mov_b32_dpp v86, v118 row_ror:8 row_mask:0xf bank_mask:0xf
  v_smfmac_f32_16x16x64_bf16 v[16:19], v[116:119], v[224:231], v0
  s_and_b32 s36, s36, 0x7fff
  ds_read_b128 v[76:79], v4 offset:14336
  v_mov_b32_dpp v87, v119 row_ror:8 row_mask:0xf bank_mask:0xf
  v_smfmac_f32_16x16x64_bf16 v[20:23], v[116:119], v[240:247], v0
  s_waitcnt lgkmcnt(3)
  s_barrier
  ds_read_b128 v[100:103], v2 offset:3072
  v_smfmac_f32_16x16x64_bf16 v[24:27], v[116:119], a[0:7], v0
  s_mov_b32 m0, s31
  ds_read_b128 v[120:123], v1 offset:3072
  v_smfmac_f32_16x16x64_bf16 v[16:19], v[84:87], v[232:239], v0
  v_smfmac_f32_16x16x64_bf16 v[20:23], v[84:87], v[248:255], v0
  ds_read_b128 v[80:83], v4 offset:15360
  buffer_load_dwordx4 v9, s[4:7], s27 offen sc1 lds
  v_smfmac_f32_16x16x64_bf16 v[24:27], v[84:87], a[8:15], v0
  s_waitcnt lgkmcnt(2)
  s_mov_b32 m0, s32
  v_smfmac_f32_16x16x64_bf16 v[16:19], v[100:103], v[128:135], v0
  ds_read_b128 v[92:95], v2 offset:0
  v_smfmac_f32_16x16x64_bf16 v[20:23], v[100:103], v[144:151], v0
  ds_read_b128 v[96:99], v1 offset:0
  v_smfmac_f32_16x16x64_bf16 v[24:27], v[100:103], v[68:75], v0
  s_waitcnt vmcnt(1) lgkmcnt(3)
  ds_read_b128 v[116:119], v2 offset:1024
  buffer_load_dwordx4 v9, s[4:7], s27 offen offset:128 sc1 lds
  v_smfmac_f32_16x16x64_bf16 v[16:19], v[120:123], v[136:143], v0
  ds_read_b128 v[124:127], v1 offset:1024
  s_mov_b32 m0, s33
  v_smfmac_f32_16x16x64_bf16 v[20:23], v[120:123], v[152:159], v0
  s_waitcnt lgkmcnt(4)
  ds_read_b128 v[104:107], v2 offset:7168
  v_smfmac_f32_16x16x64_bf16 v[24:27], v[120:123], v[76:83], v0
  s_waitcnt lgkmcnt(4)
  ds_read_b128 v[108:111], v1 offset:7168
  v_smfmac_f32_16x16x64_bf16 v[16:19], v[92:95], v[160:167], v0
  s_waitcnt lgkmcnt(4)
  ds_read_b128 v[112:115], v2 offset:4096
  v_mov_b32 v122, s98
  buffer_load_dwordx4 v10, s[4:7], s28 offen sc1 lds
  v_smfmac_f32_16x16x64_bf16 v[16:19], v[96:99], v[168:175], v0
  s_waitcnt lgkmcnt(4)
  ds_read_b128 v[84:87], v1 offset:4096
  s_mov_b32 m0, s34
  v_smfmac_f32_16x16x64_bf16 v[16:19], v[116:119], v[192:199], v0
  s_waitcnt lgkmcnt(4)
  ds_read_b128 v[88:91], v2 offset:5120
  v_smfmac_f32_16x16x64_bf16 v[16:19], v[124:127], v[200:207], v0
  s_waitcnt lgkmcnt(4)
  ds_read_b128 v[100:103], v1 offset:5120
  v_smfmac_f32_16x16x64_bf16 v[16:19], v[104:107], a[16:23], v0
  s_waitcnt lgkmcnt(4)
  ds_read_b128 v[68:71], v4 offset:16384
  buffer_load_dwordx4 v10, s[4:7], s28 offen offset:256 sc1 lds
  v_smfmac_f32_16x16x64_bf16 v[16:19], v[108:111], a[24:31], v0
  s_waitcnt lgkmcnt(4)
  ds_read_b128 v[72:75], v4 offset:17408
  v_smfmac_f32_16x16x64_bf16 v[16:19], v[112:115], a[64:71], v0
  s_waitcnt lgkmcnt(4)
  ds_read_b128 v[76:79], v4 offset:18432
  v_smfmac_f32_16x16x64_bf16 v[16:19], v[84:87], a[72:79], v0
  s_waitcnt lgkmcnt(4)
  ds_read_b128 v[80:83], v4 offset:19456
  v_smfmac_f32_16x16x64_bf16 v[16:19], v[88:91], a[112:119], v0
  s_waitcnt lgkmcnt(4)
  buffer_store_dword v122, v3, s[4:7], s15 offen sc1
  v_smfmac_f32_16x16x64_bf16 v[16:19], v[100:103], a[120:127], v0
  s_add_u32 s98, s14, 1
  s_add_u32 s24, s36, 145752064
  s_add_u32 s25, s36, 145756160
  v_smfmac_f32_16x16x64_bf16 v[20:23], v[92:95], v[176:183], v0
  s_add_u32 s35, s36, s23
  v_smfmac_f32_16x16x64_bf16 v[20:23], v[96:99], v[184:191], v0
  s_waitcnt lgkmcnt(2)
  v_smfmac_f32_16x16x64_bf16 v[20:23], v[116:119], v[68:75], v0
  s_waitcnt lgkmcnt(0)
  ds_read_b128 v[68:71], v4 offset:20480
  v_mul_f32 v16, s18, v16
  v_smfmac_f32_16x16x64_bf16 v[20:23], v[124:127], v[76:83], v0
  ds_read_b128 v[72:75], v4 offset:21504
  v_mul_f32 v17, s18, v17
  v_smfmac_f32_16x16x64_bf16 v[20:23], v[104:107], a[32:39], v0
  ds_read_b128 v[76:79], v4 offset:22528
  v_mul_f32 v18, s18, v18
  v_smfmac_f32_16x16x64_bf16 v[20:23], v[108:111], a[40:47], v0
  ds_read_b128 v[80:83], v4 offset:23552
  v_mul_f32 v19, s18, v19
  v_smfmac_f32_16x16x64_bf16 v[20:23], v[112:115], a[80:87], v0
  v_cvt_pk_bf16_f32 v120, v16, v17
  v_smfmac_f32_16x16x64_bf16 v[20:23], v[84:87], a[88:95], v0
  v_cvt_pk_bf16_f32 v121, v18, v19
  v_smfmac_f32_16x16x64_bf16 v[20:23], v[88:91], a[128:135], v0
  ds_write_b64 v5, v[120:121] offset:24576
  v_smfmac_f32_16x16x64_bf16 v[20:23], v[100:103], a[136:143], v0
  s_waitcnt lgkmcnt(3)
  v_smfmac_f32_16x16x64_bf16 v[24:27], v[92:95], v[68:75], v0
  s_waitcnt lgkmcnt(1)
  v_mov_b64 v[92:93], 0
  v_smfmac_f32_16x16x64_bf16 v[24:27], v[96:99], v[76:83], v0
  s_nop 1
  v_cvt_pk_bf16_f32 v122, v20, v21
  v_cvt_pk_bf16_f32 v123, v22, v23
  v_smfmac_f32_16x16x64_bf16 v[24:27], v[116:119], v[208:215], v0
  ds_write_b64 v5, v[122:123] offset:26880
  v_mov_b64 v[94:95], 0
  v_smfmac_f32_16x16x64_bf16 v[24:27], v[124:127], v[216:223], v0
  s_waitcnt lgkmcnt(1)
  s_barrier
  ds_read_b64_tr_b16 v[68:69], v6 offset:24576
  v_smfmac_f32_16x16x64_bf16 v[24:27], v[104:107], a[48:55], v0
  s_add_u32 s27, s27, 8192
  ds_read_b64_tr_b16 v[70:71], v6 offset:24640
  ds_read_b64_tr_b16 v[72:73], v6 offset:24832
  v_smfmac_f32_16x16x64_bf16 v[24:27], v[108:111], a[56:63], v0
  s_add_u32 s28, s28, 8192
  ds_read_b64_tr_b16 v[74:75], v6 offset:24896
  ds_read_b64_tr_b16 v[76:77], v6 offset:25088
  v_smfmac_f32_16x16x64_bf16 v[24:27], v[112:115], a[96:103], v0
  s_nop 0
  ds_read_b64_tr_b16 v[78:79], v6 offset:25152
  ds_read_b64_tr_b16 v[80:81], v6 offset:25344
  v_smfmac_f32_16x16x64_bf16 v[24:27], v[84:87], a[104:111], v0
  ds_read_b64_tr_b16 v[82:83], v6 offset:25408
  v_mov_b64 v[96:97], 0
  v_smfmac_f32_16x16x64_bf16 v[24:27], v[88:91], a[144:151], v0
  s_waitcnt lgkmcnt(8)
  s_barrier
  ds_read_b64_tr_b16 v[116:117], v6 offset:26880
  v_smfmac_f32_16x16x64_bf16 v[24:27], v[100:103], a[152:159], v0
  s_waitcnt lgkmcnt(7)
  ds_read_b64_tr_b16 v[118:119], v6 offset:26944
  v_mfma_f32_16x16x32_bf16 v[16:19], v[36:39], v[68:71], 0
  s_waitcnt lgkmcnt(6)
  ds_read_b64_tr_b16 v[124:125], v6 offset:27136
  ds_read_b64_tr_b16 v[126:127], v6 offset:27200
  v_mfma_f32_16x16x32_bf16 v[16:19], v[40:43], v[72:75], v[16:19]
  s_waitcnt lgkmcnt(6)
  ds_read_b64_tr_b16 v[104:105], v6 offset:27392
  ds_read_b64_tr_b16 v[106:107], v6 offset:27456
  v_mfma_f32_16x16x32_bf16 v[16:19], v[44:47], v[76:79], v[16:19]
  s_waitcnt lgkmcnt(6)
  ds_read_b64_tr_b16 v[108:109], v6 offset:27648
  ds_read_b64_tr_b16 v[110:111], v6 offset:27712
  v_mfma_f32_16x16x32_bf16 v[16:19], v[48:51], v[80:83], v[16:19]
  s_waitcnt lgkmcnt(6)
  v_cvt_pk_bf16_f32 v120, v24, v25
  v_cvt_pk_bf16_f32 v121, v26, v27
  v_mfma_f32_16x16x32_bf16 v[112:115], v[116:119], v[68:71], 0
  s_waitcnt lgkmcnt(4)
  v_mov_b64 v[98:99], 0
  v_mfma_f32_16x16x32_bf16 v[112:115], v[124:127], v[72:75], v[112:115]
  s_waitcnt lgkmcnt(2)
  v_mov_b64 v[36:37], 0
  v_exp_f32 v100, v16
  v_mfma_f32_16x16x32_bf16 v[112:115], v[104:107], v[76:79], v[112:115]
  s_waitcnt lgkmcnt(0)
  buffer_store_dwordx4 v[120:123], v2, s[4:7], s29 offen offset:2048 sc1
  v_exp_f32 v101, v17
  v_mfma_f32_16x16x32_bf16 v[112:115], v[108:111], v[80:83], v[112:115]
  v_exp_f32 v102, v18
  v_mfma_f32_16x16x32_bf16 v[20:23], v[52:55], v[68:71], 0
  v_exp_f32 v103, v19
  v_mfma_f32_16x16x32_bf16 v[20:23], v[56:59], v[72:75], v[20:23]
  v_cvt_pk_bf16_f32 v44, v100, v101
  v_cvt_pk_bf16_f32 v45, v102, v103
  v_mfma_f32_16x16x32_bf16 v[20:23], v[60:63], v[76:79], v[20:23]
  s_add_u32 s29, s29, 131072
  v_exp_f32 v100, v112
  v_mfma_f32_16x16x32_bf16 v[20:23], v[64:67], v[80:83], v[20:23]
  v_exp_f32 v101, v113
  v_exp_f32 v102, v114
  v_exp_f32 v103, v115
  v_cvt_pk_bf16_f32 v84, v100, v101
  v_cvt_pk_bf16_f32 v85, v102, v103
  v_cndmask_b32 v48, v84, 0, s[16:17]
  v_cndmask_b32 v49, v85, 0, s[16:17]
  v_cndmask_b32 v50, 0, v84, s[16:17]
  v_cndmask_b32 v51, 0, v85, s[16:17]
  v_exp_f32 v100, v20
  v_mfma_f32_16x16x16_bf16 v[88:91], v[12:13], v[48:49], 0
  v_exp_f32 v101, v21
  v_mfma_f32_16x16x16_bf16 v[24:27], v[120:121], v[48:49], 0
  v_exp_f32 v102, v22
  v_mfma_f32_16x16x16_bf16 v[116:119], v[120:121], v[50:51], 0
  v_exp_f32 v103, v23
  v_cvt_pk_bf16_f32 v46, v100, v101
  v_cvt_pk_bf16_f32 v47, v102, v103
  v_mov_b64 v[38:39], 0
  s_nop 0
  v_mfma_f32_16x16x32_bf16 v[88:91], v[12:15], v[44:47], v[88:91]
  v_mov_b64 v[40:41], 0
  v_mov_b64 v[42:43], 0
  v_mfma_f32_16x16x32_bf16 v[24:27], v[28:31], v[44:47], v[24:27]
  ds_read_b128 v[52:55], v4 offset:24576
  ds_read_b128 v[56:59], v4 offset:25600
  v_mfma_f32_16x16x32_bf16 v[116:119], v[32:35], v[44:47], v[116:119]
  s_nop 1
T_back_110:
  v_rcp_f32 v89, v88
  v_subrev_u32 v100, s54, v88
  v_cmp_le_u32 vcc, s96, v100
  v_mul_f32 v24, v89, v24
  v_mul_f32 v25, v89, v25
  v_cvt_pk_bf16_f32 v124, v24, v25
  v_pk_mul_f32 v[26:27], v[26:27], v[88:89] op_sel:[0,1] op_sel_hi:[1,1]
  v_pk_mul_f32 v[116:117], v[116:117], v[88:89] op_sel:[0,1] op_sel_hi:[1,1]
  v_pk_mul_f32 v[118:119], v[118:119], v[88:89] op_sel:[0,1] op_sel_hi:[1,1]
  v_cvt_pk_bf16_f32 v125, v26, v27
  v_cvt_pk_bf16_f32 v126, v116, v117
  v_cvt_pk_bf16_f32 v127, v118, v119
  ds_write_b128 v11, v[124:127] offset:30208
  s_cbranch_vccnz T_slow_109
  v_smfmac_f32_16x16x64_bf16 v[92:95], v[124:127], a[160:167], v0
  s_mov_b32 s96, s55
  v_smfmac_f32_16x16x64_bf16 v[96:99], v[124:127], a[168:175], v0
  s_cmp_eq_u32 s14, 63
  v_smfmac_f32_16x16x64_bf16 v[36:39], v[124:127], a[176:183], v0
  s_waitcnt lgkmcnt(0)
  s_barrier
  ds_read_b128 v[104:107], v11 offset:30720
  ds_read_b128 v[108:111], v11 offset:29184
  ds_read_b128 v[68:71], v11 offset:29696
  s_cbranch_scc1 M_tdone
  v_smfmac_f32_16x16x64_bf16 v[40:43], v[124:127], a[184:191], v0
  s_waitcnt lgkmcnt(2)
  v_smfmac_f32_16x16x64_bf16 v[92:95], v[104:107], a[192:199], v0
  s_waitcnt lgkmcnt(1)
  ds_read_b128 v[76:79], v4 offset:28672
  v_smfmac_f32_16x16x64_bf16 v[92:95], v[108:111], a[224:231], v0
  s_waitcnt lgkmcnt(1)
  ds_read_b128 v[80:83], v4 offset:29696
  v_smfmac_f32_16x16x64_bf16 v[92:95], v[68:71], a[240:247], v0
  ds_read_b128 v[60:63], v4 offset:26624
  v_smfmac_f32_16x16x64_bf16 v[96:99], v[104:107], a[200:207], v0
  ds_read_b128 v[64:67], v4 offset:27648
  v_smfmac_f32_16x16x64_bf16 v[96:99], v[108:111], a[232:239], v0
  ds_read_b128 v[28:31], v4 offset:30720
  s_nop 0
  v_cvt_pk_bf16_f32 v16, v92, v93
  v_cvt_pk_bf16_f32 v17, v94, v95
  v_bfi_b32 v16, 1, s57, v16
  v_smfmac_f32_16x16x64_bf16 v[96:99], v[68:71], a[248:255], v0
  buffer_store_dwordx2 v[16:17], v7, s[4:7], s20 offen offset:0 sc1
  v_smfmac_f32_16x16x64_bf16 v[36:39], v[104:107], a[208:215], v0
  ds_read_b128 v[32:35], v4 offset:31744
  v_smfmac_f32_16x16x64_bf16 v[36:39], v[108:111], v[52:59], v0
  s_waitcnt lgkmcnt(4)
  s_nop 0
  v_cvt_pk_bf16_f32 v18, v96, v97
  v_cvt_pk_bf16_f32 v19, v98, v99
  v_bfi_b32 v18, 1, s57, v18
  v_smfmac_f32_16x16x64_bf16 v[36:39], v[68:71], v[76:83], v0
  buffer_store_dwordx2 v[18:19], v7, s[4:7], s20 offen offset:64 sc1
  v_smfmac_f32_16x16x64_bf16 v[40:43], v[104:107], a[216:223], v0
  s_waitcnt lgkmcnt(2)
  v_smfmac_f32_16x16x64_bf16 v[40:43], v[108:111], v[60:67], v0
  s_waitcnt lgkmcnt(0)
  s_nop 0
  v_cvt_pk_bf16_f32 v20, v36, v37
  v_cvt_pk_bf16_f32 v21, v38, v39
  v_bfi_b32 v20, 1, s57, v20
  v_smfmac_f32_16x16x64_bf16 v[40:43], v[68:71], v[28:35], v0
  buffer_store_dwordx2 v[20:21], v7, s[4:7], s21 offen offset:0 sc1
  s_nop 6
  v_cvt_pk_bf16_f32 v22, v40, v41
  v_cvt_pk_bf16_f32 v23, v42, v43
  v_bfi_b32 v22, 1, s57, v22
  buffer_store_dwordx2 v[22:23], v7, s[4:7], s21 offen offset:64 sc1
  ds_read_b128 v[68:71], v4 offset:0
  ds_read_b128 v[72:75], v4 offset:1024
  ds_read_b128 v[76:79], v4 offset:4096
  ds_read_b128 v[80:83], v4 offset:5120
  ds_read_b128 v[84:87], v4 offset:8192
  ds_read_b128 v[88:91], v4 offset:9216
  ds_read_b128 v[92:95], v4 offset:2048
  ds_read_b128 v[96:99], v4 offset:3072
  ds_read_b128 v[100:103], v4 offset:6144
  ds_read_b128 v[104:107], v4 offset:7168
  ds_read_b128 v[108:111], v4 offset:10240
  ds_read_b128 v[112:115], v4 offset:11264
  v_mov_b64 v[16:17], 0
  v_mov_b64 v[18:19], 0
  v_mov_b64 v[20:21], 0
  v_mov_b64 v[22:23], 0
  v_mov_b64 v[24:25], 0
  v_mov_b64 v[26:27], 0
  ds_read_b64 v[44:45], v2 offset:32256
  s_waitcnt lgkmcnt(0)
  v_readfirstlane_b32 s38, v44
  v_readfirstlane_b32 s37, v45
  s_nop 0
  s_lshl_b32 s38, s38, 1
  s_lshl1_add_u32 s37, s37, 1
  s_min_u32 s38, s38, s37
  s_cmp_ge_u32 s38, 64
  s_cselect_b32 s38, 100, s38
  s_sub_u32 s38, s38, 1
  s_max_i32 s30, s30, s38
  s_waitcnt vmcnt(4)
  s_barrier
  ds_read_b128 v[28:31], v2 offset:18432
  ds_read_b128 v[32:35], v2 offset:22528
  ds_read_b128 v[36:39], v2 offset:8192
  ds_read_b128 v[40:43], v2 offset:9216
  ds_read_b128 v[44:47], v2 offset:10240
  ds_read_b128 v[48:51], v2 offset:11264
  buffer_load_dwordx4 v[124:127], v2, s[4:7], s24 offen offset:2048 sc1
  buffer_load_dwordx4 v[116:119], v2, s[4:7], s25 offen offset:2048 sc1
  ds_read_b128 v[52:55], v2 offset:12288
  ds_read_b128 v[56:59], v2 offset:13312
  ds_read_b128 v[60:63], v2 offset:14336
  ds_read_b128 v[64:67], v2 offset:15360
  buffer_load_dwordx4 v[124:127], v2, s[4:7], s24 offen offset:2048 sc1
  buffer_load_dwordx4 v[116:119], v2, s[4:7], s25 offen offset:2048 sc1
  s_add_u32 s14, s14, 1
  s_cmp_ge_i32 s14, s30
  s_cbranch_scc1 T_kvw_106
T_kvb_107:
  s_mov_b32 s19, 0
  s_branch T_loop_102
T_kvw_106:
  s_mov_b32 s19, 0
  s_branch T_kvok_115
T_kv_114:
  s_sleep 4
  s_add_u32 s19, s19, 1
  s_cmp_gt_u32 s19, 32768
  s_cbranch_scc1 M_exit
T_kvok_115:
  s_add_u32 s39, s99, 128
  s_mov_b32 s38, 0
  s_mov_b32 s37, 0
  s_atomic_or s38, s[58:59], s99 glc
  s_atomic_or s37, s[58:59], s39 glc
  s_waitcnt lgkmcnt(0)
  s_lshl_b32 s38, s38, 1
  s_lshl1_add_u32 s37, s37, 1
  s_min_u32 s38, s38, s37
  s_cmp_ge_u32 s38, 64
  s_cselect_b32 s38, 100, s38
  s_sub_u32 s38, s38, 1
  s_max_i32 s30, s30, s38
  s_cmp_ge_i32 s14, s30
  s_cbranch_scc1 T_kv_114
  s_branch T_kvb_107
T_slow_109:
  s_nop 7
  v_max3_f32 v100, v16, v17, v18
  v_max3_f32 v100, v100, v19, v20
  v_max3_f32 v100, v100, v21, v22
  v_max3_f32 v100, v100, v23, v112
  v_max3_f32 v100, v100, v113, v114
  v_max_f32 v100, v100, v115
  v_mov_b32 v101, v100
  s_nop 1
  v_permlane32_swap_b32 v100, v101
  s_nop 1
  v_max_f32 v100, v100, v101
  v_mov_b32 v101, v100
  s_nop 1
  v_permlane16_swap_b32 v100, v101
  s_nop 1
  v_max_f32 v100, v100, v101
  v_sub_f32 v16, v16, v100
  v_sub_f32 v17, v17, v100
  v_sub_f32 v18, v18, v100
  v_sub_f32 v19, v19, v100
  v_exp_f32 v16, v16
  v_exp_f32 v17, v17
  v_exp_f32 v18, v18
  v_exp_f32 v19, v19
  v_sub_f32 v20, v20, v100
  v_sub_f32 v21, v21, v100
  v_sub_f32 v22, v22, v100
  v_sub_f32 v23, v23, v100
  v_exp_f32 v20, v20
  v_exp_f32 v21, v21
  v_exp_f32 v22, v22
  v_exp_f32 v23, v23
  v_sub_f32 v112, v112, v100
  v_sub_f32 v113, v113, v100
  v_sub_f32 v114, v114, v100
  v_sub_f32 v115, v115, v100
  v_exp_f32 v112, v112
  v_exp_f32 v113, v113
  v_exp_f32 v114, v114
  v_exp_f32 v115, v115
  s_nop 0
  v_cvt_pk_bf16_f32 v44, v16, v17
  v_cvt_pk_bf16_f32 v45, v18, v19
  v_cvt_pk_bf16_f32 v46, v20, v21
  v_cvt_pk_bf16_f32 v47, v22, v23
  v_cvt_pk_bf16_f32 v84, v112, v113
  v_cvt_pk_bf16_f32 v85, v114, v115
  v_cndmask_b32 v48, v84, 0, s[16:17]
  v_cndmask_b32 v49, v85, 0, s[16:17]
  v_cndmask_b32 v50, 0, v84, s[16:17]
  v_cndmask_b32 v51, 0, v85, s[16:17]
  s_nop 1
  v_mfma_f32_16x16x16_bf16 v[88:91], v[12:13], v[48:49], 0
  v_mfma_f32_16x16x16_bf16 v[24:27], v[120:121], v[48:49], 0
  v_mfma_f32_16x16x16_bf16 v[116:119], v[120:121], v[50:51], 0
  v_mfma_f32_16x16x32_bf16 v[88:91], v[12:15], v[44:47], v[88:91]
  v_mfma_f32_16x16x32_bf16 v[24:27], v[28:31], v[44:47], v[24:27]
  v_mfma_f32_16x16x32_bf16 v[116:119], v[32:35], v[44:47], v[116:119]
  s_nop 7
  s_nop 1
  s_mov_b32 s96, -1
  s_branch T_back_110
T_w_73:
  s_mov_b32 s19, 0
  s_add_u32 s14, s14, 1
  s_and_b32 s57, s14, 1
  v_mov_b64 v[16:17], 0
  v_mov_b64 v[18:19], 0
  v_mov_b64 v[20:21], 0
  v_mov_b64 v[22:23], 0
  v_mov_b64 v[24:25], 0
  v_mov_b64 v[26:27], 0
  buffer_load_dwordx4 v[124:127], v2, s[4:7], s24 offen offset:3072 sc1
  buffer_load_dwordx4 v[116:119], v2, s[4:7], s25 offen offset:3072 sc1
  buffer_load_dwordx4 v[124:127], v2, s[4:7], s24 offen offset:3072 sc1
  buffer_load_dwordx4 v[116:119], v2, s[4:7], s25 offen offset:3072 sc1
  s_branch T_loop_116
.p2align 6
T_retry_117:
  s_mov_b64 exec, vcc
  buffer_load_dwordx4 v[124:127], v2, s[4:7], s24 offen offset:3072 sc1
  buffer_load_dwordx4 v[116:119], v2, s[4:7], s25 offen offset:3072 sc1
  s_mov_b64 exec, -1
  s_add_u32 s19, s19, 1
  s_cmp_gt_u32 s19, 32768
  s_cbranch_scc1 M_exit
  s_nop 0
  v_mov_b64 v[16:17], 0
  v_mov_b64 v[18:19], 0
T_loop_116:
  s_waitcnt vmcnt(3) lgkmcnt(0)
  v_max3_u32 v123, v124, v125, v126
  v_max_u32 v123, v123, v127
  v_mov_b32_dpp v120, v124 row_ror:8 row_mask:0xf bank_mask:0xf
  v_mov_b32_dpp v121, v125 row_ror:8 row_mask:0xf bank_mask:0xf
  s_waitcnt vmcnt(2)
  v_max3_u32 v123, v123, v116, v117
  v_max3_u32 v123, v123, v118, v119
  v_cmp_eq_u32 vcc, -1, v123
  v_smfmac_f32_16x16x64_bf16 v[16:19], v[124:127], v[68:75], v0
  s_cbranch_vccnz T_retry_117
  ds_write_b128 v2, v[124:127] offset:3072
  v_mov_b32_dpp v122, v126 row_ror:8 row_mask:0xf bank_mask:0xf
  v_smfmac_f32_16x16x64_bf16 v[20:23], v[124:127], v[76:83], v0
  s_and_b32 s57, s14, 1
  v_mov_b32_dpp v123, v127 row_ror:8 row_mask:0xf bank_mask:0xf
  v_smfmac_f32_16x16x64_bf16 v[24:27], v[124:127], v[84:91], v0
  s_and_b32 s36, s14, 3
  ds_write_b128 v2, v[116:119] offset:7168
  v_smfmac_f32_16x16x64_bf16 v[16:19], v[120:123], v[92:99], v0
  s_lshl_b32 s36, s36, 13
  v_mov_b32_dpp v84, v116 row_ror:8 row_mask:0xf bank_mask:0xf
  v_smfmac_f32_16x16x64_bf16 v[20:23], v[120:123], v[100:107], v0
  s_add_u32 s26, s36, s23
  ds_read_b128 v[68:71], v4 offset:12288
  v_mov_b32_dpp v85, v117 row_ror:8 row_mask:0xf bank_mask:0xf
  v_smfmac_f32_16x16x64_bf16 v[24:27], v[120:123], v[108:115], v0
  s_add_u32 s36, s36, 8192
  ds_read_b128 v[72:75], v4 offset:13312
  v_mov_b32_dpp v86, v118 row_ror:8 row_mask:0xf bank_mask:0xf
  v_smfmac_f32_16x16x64_bf16 v[16:19], v[116:119], v[224:231], v0
  s_and_b32 s36, s36, 0x7fff
  ds_read_b128 v[76:79], v4 offset:14336
  v_mov_b32_dpp v87, v119 row_ror:8 row_mask:0xf bank_mask:0xf
  v_smfmac_f32_16x16x64_bf16 v[20:23], v[116:119], v[240:247], v0
  s_waitcnt lgkmcnt(3)
  s_barrier
  ds_read_b128 v[100:103], v2 offset:2048
  v_smfmac_f32_16x16x64_bf16 v[24:27], v[116:119], a[0:7], v0
  s_mov_b32 m0, s31
  ds_read_b128 v[120:123], v1 offset:2048
  v_smfmac_f32_16x16x64_bf16 v[16:19], v[84:87], v[232:239], v0
  v_smfmac_f32_16x16x64_bf16 v[20:23], v[84:87], v[248:255], v0
  ds_read_b128 v[80:83], v4 offset:15360
  v_smfmac_f32_16x16x64_bf16 v[24:27], v[84:87], a[8:15], v0
  s_waitcnt lgkmcnt(2)
  buffer_load_dwordx4 v9, s[4:7], s27 offen sc1 lds
  v_smfmac_f32_16x16x64_bf16 v[16:19], v[100:103], v[128:135], v0
  ds_read_b128 v[92:95], v2 offset:1024
  s_mov_b32 m0, s32
  v_smfmac_f32_16x16x64_bf16 v[20:23], v[100:103], v[144:151], v0
  ds_read_b128 v[96:99], v1 offset:1024
  v_smfmac_f32_16x16x64_bf16 v[24:27], v[100:103], v[68:75], v0
  s_waitcnt vmcnt(1) lgkmcnt(3)
  ds_read_b128 v[116:119], v2 offset:0
  v_smfmac_f32_16x16x64_bf16 v[16:19], v[120:123], v[136:143], v0
  ds_read_b128 v[124:127], v1 offset:0
  buffer_load_dwordx4 v9, s[4:7], s27 offen offset:128 sc1 lds
  v_smfmac_f32_16x16x64_bf16 v[20:23], v[120:123], v[152:159], v0
  s_waitcnt lgkmcnt(4)
  ds_read_b128 v[104:107], v2 offset:6144
  s_mov_b32 m0, s33
  v_smfmac_f32_16x16x64_bf16 v[24:27], v[120:123], v[76:83], v0
  s_waitcnt lgkmcnt(4)
  ds_read_b128 v[108:111], v1 offset:6144
  v_smfmac_f32_16x16x64_bf16 v[16:19], v[92:95], v[160:167], v0
  s_waitcnt lgkmcnt(4)
  ds_read_b128 v[112:115], v2 offset:5120
  v_smfmac_f32_16x16x64_bf16 v[16:19], v[96:99], v[168:175], v0
  s_waitcnt lgkmcnt(4)
  ds_read_b128 v[84:87], v1 offset:5120
  buffer_load_dwordx4 v10, s[4:7], s28 offen sc1 lds
  v_smfmac_f32_16x16x64_bf16 v[16:19], v[116:119], v[192:199], v0
  s_waitcnt lgkmcnt(4)
  ds_read_b128 v[88:91], v2 offset:4096
  s_mov_b32 m0, s34
  v_smfmac_f32_16x16x64_bf16 v[16:19], v[124:127], v[200:207], v0
  s_waitcnt lgkmcnt(4)
  ds_read_b128 v[100:103], v1 offset:4096
  v_smfmac_f32_16x16x64_bf16 v[16:19], v[104:107], a[16:23], v0
  s_waitcnt lgkmcnt(4)
  ds_read_b128 v[68:71], v4 offset:16384
  v_smfmac_f32_16x16x64_bf16 v[16:19], v[108:111], a[24:31], v0
  s_waitcnt lgkmcnt(4)
  ds_read_b128 v[72:75], v4 offset:17408
  buffer_load_dwordx4 v10, s[4:7], s28 offen offset:256 sc1 lds
  v_smfmac_f32_16x16x64_bf16 v[16:19], v[112:115], a[64:71], v0
  s_waitcnt lgkmcnt(4)
  ds_read_b128 v[76:79], v4 offset:18432
  s_mov_b32 m0, 32256
  v_smfmac_f32_16x16x64_bf16 v[16:19], v[84:87], a[72:79], v0
  s_waitcnt lgkmcnt(4)
  ds_read_b128 v[80:83], v4 offset:19456
  v_smfmac_f32_16x16x64_bf16 v[16:19], v[88:91], a[112:119], v0
  s_waitcnt lgkmcnt(4)
  v_smfmac_f32_16x16x64_bf16 v[16:19], v[100:103], a[120:127], v0
  buffer_load_dword v3, s[4:7], s99 offen sc1 lds
  s_add_u32 s24, s36, 145752064
  s_add_u32 s25, s36, 145756160
  v_smfmac_f32_16x16x64_bf16 v[20:23], v[92:95], v[176:183], v0
  s_add_u32 s35, s36, s23
  v_smfmac_f32_16x16x64_bf16 v[20:23], v[96:99], v[184:191], v0
  s_waitcnt lgkmcnt(2)
  v_smfmac_f32_16x16x64_bf16 v[20:23], v[116:119], v[68:75], v0
  s_waitcnt lgkmcnt(0)
  ds_read_b128 v[68:71], v4 offset:20480
  v_mul_f32 v16, s18, v16
  v_smfmac_f32_16x16x64_bf16 v[20:23], v[124:127], v[76:83], v0
  ds_read_b128 v[72:75], v4 offset:21504
  v_mul_f32 v17, s18, v17
  v_smfmac_f32_16x16x64_bf16 v[20:23], v[104:107], a[32:39], v0
  ds_read_b128 v[76:79], v4 offset:22528
  v_mul_f32 v18, s18, v18
  v_smfmac_f32_16x16x64_bf16 v[20:23], v[108:111], a[40:47], v0
  ds_read_b128 v[80:83], v4 offset:23552
  v_mul_f32 v19, s18, v19
  v_smfmac_f32_16x16x64_bf16 v[20:23], v[112:115], a[80:87], v0
  v_cvt_pk_bf16_f32 v120, v16, v17
  v_smfmac_f32_16x16x64_bf16 v[20:23], v[84:87], a[88:95], v0
  v_cvt_pk_bf16_f32 v121, v18, v19
  v_smfmac_f32_16x16x64_bf16 v[20:23], v[88:91], a[128:135], v0
  ds_write_b64 v5, v[120:121] offset:24576
  v_smfmac_f32_16x16x64_bf16 v[20:23], v[100:103], a[136:143], v0
  s_waitcnt lgkmcnt(3)
  v_smfmac_f32_16x16x64_bf16 v[24:27], v[92:95], v[68:75], v0
  s_waitcnt lgkmcnt(1)
  v_mov_b64 v[92:93], 0
  v_smfmac_f32_16x16x64_bf16 v[24:27], v[96:99], v[76:83], v0
  s_nop 1
  v_cvt_pk_bf16_f32 v122, v20, v21
  v_cvt_pk_bf16_f32 v123, v22, v23
  v_smfmac_f32_16x16x64_bf16 v[24:27], v[116:119], v[208:215], v0
  ds_write_b64 v5, v[122:123] offset:26880
  v_mov_b64 v[94:95], 0
  v_smfmac_f32_16x16x64_bf16 v[24:27], v[124:127], v[216:223], v0
  s_waitcnt lgkmcnt(1)
  s_barrier
  ds_read_b64_tr_b16 v[68:69], v6 offset:24576
  v_smfmac_f32_16x16x64_bf16 v[24:27], v[104:107], a[48:55], v0
  s_add_u32 s27, s27, 8192
  ds_read_b64_tr_b16 v[70:71], v6 offset:24640
  ds_read_b64_tr_b16 v[72:73], v6 offset:24832
  v_smfmac_f32_16x16x64_bf16 v[24:27], v[108:111], a[56:63], v0
  s_add_u32 s28, s28, 8192
  ds_read_b64_tr_b16 v[74:75], v6 offset:24896
  ds_read_b64_tr_b16 v[76:77], v6 offset:25088
  v_smfmac_f32_16x16x64_bf16 v[24:27], v[112:115], a[96:103], v0
  s_nop 0
  ds_read_b64_tr_b16 v[78:79], v6 offset:25152
  ds_read_b64_tr_b16 v[80:81], v6 offset:25344
  v_smfmac_f32_16x16x64_bf16 v[24:27], v[84:87], a[104:111], v0
  ds_read_b64_tr_b16 v[82:83], v6 offset:25408
  v_mov_b64 v[96:97], 0
  v_smfmac_f32_16x16x64_bf16 v[24:27], v[88:91], a[144:151], v0
  s_waitcnt lgkmcnt(8)
  s_barrier
  ds_read_b64_tr_b16 v[116:117], v6 offset:26880
  v_smfmac_f32_16x16x64_bf16 v[24:27], v[100:103], a[152:159], v0
  s_waitcnt lgkmcnt(7)
  ds_read_b64_tr_b16 v[118:119], v6 offset:26944
  v_mfma_f32_16x16x32_bf16 v[16:19], v[36:39], v[68:71], 0
  s_waitcnt lgkmcnt(6)
  ds_read_b64_tr_b16 v[124:125], v6 offset:27136
  ds_read_b64_tr_b16 v[126:127], v6 offset:27200
  v_mfma_f32_16x16x32_bf16 v[16:19], v[40:43], v[72:75], v[16:19]
  s_waitcnt lgkmcnt(6)
  ds_read_b64_tr_b16 v[104:105], v6 offset:27392
  ds_read_b64_tr_b16 v[106:107], v6 offset:27456
  v_mfma_f32_16x16x32_bf16 v[16:19], v[44:47], v[76:79], v[16:19]
  s_waitcnt lgkmcnt(6)
  ds_read_b64_tr_b16 v[108:109], v6 offset:27648
  ds_read_b64_tr_b16 v[110:111], v6 offset:27712
  v_mfma_f32_16x16x32_bf16 v[16:19], v[48:51], v[80:83], v[16:19]
  s_waitcnt lgkmcnt(6)
  v_cvt_pk_bf16_f32 v120, v24, v25
  v_cvt_pk_bf16_f32 v121, v26, v27
  v_mfma_f32_16x16x32_bf16 v[112:115], v[116:119], v[68:71], 0
  s_waitcnt lgkmcnt(4)
  v_mov_b64 v[98:99], 0
  v_mfma_f32_16x16x32_bf16 v[112:115], v[124:127], v[72:75], v[112:115]
  s_waitcnt lgkmcnt(2)
  v_mov_b64 v[36:37], 0
  v_exp_f32 v100, v16
  v_mfma_f32_16x16x32_bf16 v[112:115], v[104:107], v[76:79], v[112:115]
  s_waitcnt lgkmcnt(0)
  v_exp_f32 v101, v17
  v_mfma_f32_16x16x32_bf16 v[112:115], v[108:111], v[80:83], v[112:115]
  buffer_store_dwordx4 v[120:123], v2, s[4:7], s29 offen offset:3072 sc1
  v_exp_f32 v102, v18
  v_mfma_f32_16x16x32_bf16 v[20:23], v[52:55], v[68:71], 0
  v_exp_f32 v103, v19
  v_mfma_f32_16x16x32_bf16 v[20:23], v[56:59], v[72:75], v[20:23]
  v_cvt_pk_bf16_f32 v44, v100, v101
  v_cvt_pk_bf16_f32 v45, v102, v103
  v_mfma_f32_16x16x32_bf16 v[20:23], v[60:63], v[76:79], v[20:23]
  s_add_u32 s29, s29, 131072
  v_exp_f32 v100, v112
  v_mfma_f32_16x16x32_bf16 v[20:23], v[64:67], v[80:83], v[20:23]
  v_exp_f32 v101, v113
  v_exp_f32 v102, v114
  v_exp_f32 v103, v115
  v_cvt_pk_bf16_f32 v84, v100, v101
  v_cvt_pk_bf16_f32 v85, v102, v103
  v_cndmask_b32 v48, v84, 0, s[16:17]
  v_cndmask_b32 v49, v85, 0, s[16:17]
  v_cndmask_b32 v50, 0, v84, s[16:17]
  v_cndmask_b32 v51, 0, v85, s[16:17]
  v_exp_f32 v100, v20
  v_mfma_f32_16x16x16_bf16 v[88:91], v[12:13], v[48:49], 0
  v_exp_f32 v101, v21
  v_mfma_f32_16x16x16_bf16 v[24:27], v[120:121], v[48:49], 0
  v_exp_f32 v102, v22
  v_mfma_f32_16x16x16_bf16 v[116:119], v[120:121], v[50:51], 0
  v_exp_f32 v103, v23
  v_cvt_pk_bf16_f32 v46, v100, v101
  v_cvt_pk_bf16_f32 v47, v102, v103
  v_mov_b64 v[38:39], 0
  s_nop 0
  v_mfma_f32_16x16x32_bf16 v[88:91], v[12:15], v[44:47], v[88:91]
  v_mov_b64 v[40:41], 0
  v_mov_b64 v[42:43], 0
  v_mfma_f32_16x16x32_bf16 v[24:27], v[28:31], v[44:47], v[24:27]
  ds_read_b128 v[52:55], v4 offset:24576
  ds_read_b128 v[56:59], v4 offset:25600
  v_mfma_f32_16x16x32_bf16 v[116:119], v[32:35], v[44:47], v[116:119]
  s_nop 1
T_back_124:
  v_rcp_f32 v89, v88
  v_subrev_u32 v100, s54, v88
  v_cmp_le_u32 vcc, s96, v100
  v_mul_f32 v24, v89, v24
  v_mul_f32 v25, v89, v25
  v_cvt_pk_bf16_f32 v124, v24, v25
  v_pk_mul_f32 v[26:27], v[26:27], v[88:89] op_sel:[0,1] op_sel_hi:[1,1]
  v_pk_mul_f32 v[116:117], v[116:117], v[88:89] op_sel:[0,1] op_sel_hi:[1,1]
  v_pk_mul_f32 v[118:119], v[118:119], v[88:89] op_sel:[0,1] op_sel_hi:[1,1]
  v_cvt_pk_bf16_f32 v125, v26, v27
  v_cvt_pk_bf16_f32 v126, v116, v117
  v_cvt_pk_bf16_f32 v127, v118, v119
  ds_write_b128 v11, v[124:127] offset:30720
  s_cbranch_vccnz T_slow_123
  v_smfmac_f32_16x16x64_bf16 v[92:95], v[124:127], a[160:167], v0
  s_mov_b32 s96, s55
  v_smfmac_f32_16x16x64_bf16 v[96:99], v[124:127], a[168:175], v0
  s_cmp_eq_u32 s14, 63
  v_smfmac_f32_16x16x64_bf16 v[36:39], v[124:127], a[176:183], v0
  s_waitcnt lgkmcnt(0)
  s_barrier
  ds_read_b128 v[104:107], v11 offset:30208
  ds_read_b128 v[108:111], v11 offset:29696
  ds_read_b128 v[68:71], v11 offset:29184
  s_cbranch_scc1 M_tdone
  v_smfmac_f32_16x16x64_bf16 v[40:43], v[124:127], a[184:191], v0
  s_waitcnt lgkmcnt(2)
  v_smfmac_f32_16x16x64_bf16 v[92:95], v[104:107], a[192:199], v0
  s_waitcnt lgkmcnt(1)
  ds_read_b128 v[76:79], v4 offset:28672
  v_smfmac_f32_16x16x64_bf16 v[92:95], v[108:111], a[224:231], v0
  s_waitcnt lgkmcnt(1)
  ds_read_b128 v[80:83], v4 offset:29696
  v_smfmac_f32_16x16x64_bf16 v[92:95], v[68:71], a[240:247], v0
  ds_read_b128 v[60:63], v4 offset:26624
  v_smfmac_f32_16x16x64_bf16 v[96:99], v[104:107], a[200:207], v0
  ds_read_b128 v[64:67], v4 offset:27648
  v_smfmac_f32_16x16x64_bf16 v[96:99], v[108:111], a[232:239], v0
  ds_read_b128 v[28:31], v4 offset:30720
  s_nop 0
  v_cvt_pk_bf16_f32 v16, v92, v93
  v_cvt_pk_bf16_f32 v17, v94, v95
  v_bfi_b32 v16, 1, s57, v16
  v_smfmac_f32_16x16x64_bf16 v[96:99], v[68:71], a[248:255], v0
  buffer_store_dwordx2 v[16:17], v7, s[4:7], s20 offen offset:0 sc1
  v_smfmac_f32_16x16x64_bf16 v[36:39], v[104:107], a[208:215], v0
  ds_read_b128 v[32:35], v4 offset:31744
  v_smfmac_f32_16x16x64_bf16 v[36:39], v[108:111], v[52:59], v0
  s_waitcnt lgkmcnt(4)
  s_nop 0
  v_cvt_pk_bf16_f32 v18, v96, v97
  v_cvt_pk_bf16_f32 v19, v98, v99
  v_bfi_b32 v18, 1, s57, v18
  v_smfmac_f32_16x16x64_bf16 v[36:39], v[68:71], v[76:83], v0
  buffer_store_dwordx2 v[18:19], v7, s[4:7], s20 offen offset:64 sc1
  v_smfmac_f32_16x16x64_bf16 v[40:43], v[104:107], a[216:223], v0
  s_waitcnt lgkmcnt(2)
  v_smfmac_f32_16x16x64_bf16 v[40:43], v[108:111], v[60:67], v0
  s_waitcnt lgkmcnt(0)
  s_nop 0
  v_cvt_pk_bf16_f32 v20, v36, v37
  v_cvt_pk_bf16_f32 v21, v38, v39
  v_bfi_b32 v20, 1, s57, v20
  v_smfmac_f32_16x16x64_bf16 v[40:43], v[68:71], v[28:35], v0
  buffer_store_dwordx2 v[20:21], v7, s[4:7], s21 offen offset:0 sc1
  s_nop 6
  v_cvt_pk_bf16_f32 v22, v40, v41
  v_cvt_pk_bf16_f32 v23, v42, v43
  v_bfi_b32 v22, 1, s57, v22
  buffer_store_dwordx2 v[22:23], v7, s[4:7], s21 offen offset:64 sc1
  ds_read_b128 v[68:71], v4 offset:0
  ds_read_b128 v[72:75], v4 offset:1024
  ds_read_b128 v[76:79], v4 offset:4096
  ds_read_b128 v[80:83], v4 offset:5120
  ds_read_b128 v[84:87], v4 offset:8192
  ds_read_b128 v[88:91], v4 offset:9216
  ds_read_b128 v[92:95], v4 offset:2048
  ds_read_b128 v[96:99], v4 offset:3072
  ds_read_b128 v[100:103], v4 offset:6144
  ds_read_b128 v[104:107], v4 offset:7168
  ds_read_b128 v[108:111], v4 offset:10240
  ds_read_b128 v[112:115], v4 offset:11264
  v_mov_b64 v[16:17], 0
  v_mov_b64 v[18:19], 0
  v_mov_b64 v[20:21], 0
  v_mov_b64 v[22:23], 0
  v_mov_b64 v[24:25], 0
  v_mov_b64 v[26:27], 0
  ds_read_b64 v[44:45], v2 offset:32256
  s_waitcnt lgkmcnt(0)
  v_readfirstlane_b32 s38, v44
  v_readfirstlane_b32 s37, v45
  s_nop 0
  s_lshl_b32 s38, s38, 1
  s_lshl1_add_u32 s37, s37, 1
  s_min_u32 s38, s38, s37
  s_cmp_ge_u32 s38, 64
  s_cselect_b32 s38, 100, s38
  s_sub_u32 s38, s38, 1
  s_max_i32 s30, s30, s38
  s_waitcnt vmcnt(4)
  s_barrier
  ds_read_b128 v[28:31], v2 offset:19456
  ds_read_b128 v[32:35], v2 offset:23552
  ds_read_b128 v[36:39], v2 offset:8192
  ds_read_b128 v[40:43], v2 offset:9216
  ds_read_b128 v[44:47], v2 offset:10240
  ds_read_b128 v[48:51], v2 offset:11264
  buffer_load_dwordx4 v[124:127], v2, s[4:7], s24 offen offset:3072 sc1
  buffer_load_dwordx4 v[116:119], v2, s[4:7], s25 offen offset:3072 sc1
  ds_read_b128 v[52:55], v2 offset:12288
  ds_read_b128 v[56:59], v2 offset:13312
  ds_read_b128 v[60:63], v2 offset:14336
  ds_read_b128 v[64:67], v2 offset:15360
  buffer_load_dwordx4 v[124:127], v2, s[4:7], s24 offen offset:3072 sc1
  buffer_load_dwordx4 v[116:119], v2, s[4:7], s25 offen offset:3072 sc1
  s_add_u32 s14, s14, 1
  s_cmp_ge_i32 s14, s30
  s_cbranch_scc1 T_kvw_120
T_kvb_121:
  s_mov_b32 s19, 0
  s_branch T_loop_116
T_kvw_120:
  s_mov_b32 s19, 0
  s_branch T_kvok_129
T_kv_128:
  s_sleep 4
  s_add_u32 s19, s19, 1
  s_cmp_gt_u32 s19, 32768
  s_cbranch_scc1 M_exit
T_kvok_129:
  s_add_u32 s39, s99, 128
  s_mov_b32 s38, 0
  s_mov_b32 s37, 0
  s_atomic_or s38, s[58:59], s99 glc
  s_atomic_or s37, s[58:59], s39 glc
  s_waitcnt lgkmcnt(0)
  s_lshl_b32 s38, s38, 1
  s_lshl1_add_u32 s37, s37, 1
  s_min_u32 s38, s38, s37
  s_cmp_ge_u32 s38, 64
  s_cselect_b32 s38, 100, s38
  s_sub_u32 s38, s38, 1
  s_max_i32 s30, s30, s38
  s_cmp_ge_i32 s14, s30
  s_cbranch_scc1 T_kv_128
  s_branch T_kvb_121
T_slow_123:
  s_nop 7
  v_max3_f32 v100, v16, v17, v18
  v_max3_f32 v100, v100, v19, v20
  v_max3_f32 v100, v100, v21, v22
  v_max3_f32 v100, v100, v23, v112
  v_max3_f32 v100, v100, v113, v114
  v_max_f32 v100, v100, v115
  v_mov_b32 v101, v100
  s_nop 1
  v_permlane32_swap_b32 v100, v101
  s_nop 1
  v_max_f32 v100, v100, v101
  v_mov_b32 v101, v100
  s_nop 1
  v_permlane16_swap_b32 v100, v101
  s_nop 1
  v_max_f32 v100, v100, v101
  v_sub_f32 v16, v16, v100
  v_sub_f32 v17, v17, v100
  v_sub_f32 v18, v18, v100
  v_sub_f32 v19, v19, v100
  v_exp_f32 v16, v16
  v_exp_f32 v17, v17
  v_exp_f32 v18, v18
  v_exp_f32 v19, v19
  v_sub_f32 v20, v20, v100
  v_sub_f32 v21, v21, v100
  v_sub_f32 v22, v22, v100
  v_sub_f32 v23, v23, v100
  v_exp_f32 v20, v20
  v_exp_f32 v21, v21
  v_exp_f32 v22, v22
  v_exp_f32 v23, v23
  v_sub_f32 v112, v112, v100
  v_sub_f32 v113, v113, v100
  v_sub_f32 v114, v114, v100
  v_sub_f32 v115, v115, v100
  v_exp_f32 v112, v112
  v_exp_f32 v113, v113
  v_exp_f32 v114, v114
  v_exp_f32 v115, v115
  s_nop 0
  v_cvt_pk_bf16_f32 v44, v16, v17
  v_cvt_pk_bf16_f32 v45, v18, v19
  v_cvt_pk_bf16_f32 v46, v20, v21
  v_cvt_pk_bf16_f32 v47, v22, v23
  v_cvt_pk_bf16_f32 v84, v112, v113
  v_cvt_pk_bf16_f32 v85, v114, v115
  v_cndmask_b32 v48, v84, 0, s[16:17]
  v_cndmask_b32 v49, v85, 0, s[16:17]
  v_cndmask_b32 v50, 0, v84, s[16:17]
  v_cndmask_b32 v51, 0, v85, s[16:17]
  s_nop 1
  v_mfma_f32_16x16x16_bf16 v[88:91], v[12:13], v[48:49], 0
  v_mfma_f32_16x16x16_bf16 v[24:27], v[120:121], v[48:49], 0
  v_mfma_f32_16x16x16_bf16 v[116:119], v[120:121], v[50:51], 0
  v_mfma_f32_16x16x32_bf16 v[88:91], v[12:15], v[44:47], v[88:91]
  v_mfma_f32_16x16x32_bf16 v[24:27], v[28:31], v[44:47], v[24:27]
  v_mfma_f32_16x16x32_bf16 v[116:119], v[32:35], v[44:47], v[116:119]
  s_nop 7
  s_nop 1
  s_mov_b32 s96, -1
  s_branch T_back_124
M_tdone:
  v_mov_b32 v16, 64
  v_or_b32 v17, s13, v2
  v_min_u32 v17, 1, v17
  v_lshlrev_b32 v17, 30, v17
  s_waitcnt vmcnt(0)
  s_barrier
  buffer_store_dword v16, v17, s[4:7], s15 offen sc1
  s_branch M_done
M_worker:
  s_load_dwordx4 s[72:75], s[0:1], 120
  v_lshrrev_b32 v3, 6, v0
  v_and_b32 v1, 63, v0
  v_readfirstlane_b32 s16, v3
  v_lshlrev_b32 v2, 4, v1
  s_waitcnt lgkmcnt(0)
  s_mov_b64 s[4:5], s[74:75]
  s_mov_b64 s[74:75], s[72:73]
  s_mov_b64 s[72:73], s[4:5]
  s_and_b32 s5, s5, 0xffff
  s_mov_b32 s6, 268435456
  s_mov_b32 s7, 0x20000
  s_sub_u32 s66, s76, 1
  s_lshl_b32 s66, s66, 5
  s_add_u32 s66, s66, s77
  s_mul_i32 s64, s66, 9363
  s_lshr_b32 s64, s64, 16
  s_mul_i32 s67, s64, 7
  s_sub_u32 s65, s66, s67
  s_lshl_b32 s31, s66, 7
  s_add_u32 s31, s31, 148897792
  s_lshl_b32 s67, s67, 7
  s_add_u32 s67, s67, 148897792
  s_getpc_b64 s[76:77]
M_pc:
  s_add_u32 s76, s76, M_table-M_pc
  s_addc_u32 s77, s77, 0
  s_lshl_b32 s26, s65, 6
  s_load_dwordx16 s[48:63], s[76:77], s26
  s_waitcnt lgkmcnt(0)
  s_mov_b32 s23, s51
  s_cmp_lg_u32 s48, 1
  s_cbranch_scc1 M_nobpf
  s_load_dwordx8 s[36:43], s[0:1], 64
  s_mul_i32 s76, s64, 3
  s_add_u32 s76, s76, s57
  v_lshlrev_b32 v4, 7, v0
  s_mov_b32 s10, 4194304
  s_mov_b32 s11, 0x20000
  s_waitcnt lgkmcnt(0)
  s_mov_b32 s8, s42
  s_and_b32 s9, s43, 0xffff
  s_mul_i32 s77, s76, 43776
  s_add_u32 s77, s77, 0
  v_min_u32 v5, 32640, v4
  v_add_u32 v5, s77, v5
  s_add_u32 s77, s77, 32768
  buffer_load_dword v6, v5, s[8:11], 0 offen
  v_min_u32 v5, 10880, v4
  v_add_u32 v5, s77, v5
  s_add_u32 s77, s77, 32768
  buffer_load_dword v6, v5, s[8:11], 0 offen
  s_mov_b32 s8, s38
  s_and_b32 s9, s39, 0xffff
  s_mul_i32 s77, s76, 21888
  s_add_u32 s77, s77, 2097152
  v_min_u32 v5, 21760, v4
  v_add_u32 v5, s77, v5
  s_add_u32 s77, s77, 32768
  buffer_load_dword v6, v5, s[8:11], 0 offen
  s_mov_b32 s8, s40
  s_and_b32 s9, s41, 0xffff
  s_mul_i32 s77, s76, 21888
  s_add_u32 s77, s77, 2097152
  v_min_u32 v5, 21760, v4
  v_add_u32 v5, s77, v5
  s_add_u32 s77, s77, 32768
  buffer_load_dword v6, v5, s[8:11], 0 offen
  s_mov_b32 s8, s36
  s_and_b32 s9, s37, 0xffff
  s_mul_i32 s77, s76, 21888
  s_add_u32 s77, s77, 2097152
  v_min_u32 v5, 21760, v4
  v_add_u32 v5, s77, v5
  s_add_u32 s77, s77, 32768
  buffer_load_dword v6, v5, s[8:11], 0 offen
  s_waitcnt vmcnt(0)
M_nobpf:
  s_lshr_b32 s29, s16, 1
  s_cmp_eq_u32 s29, 0
  s_cselect_b32 s26, 2, 8
  s_cselect_b32 s27, 3, 4
  s_cselect_b32 s28, 9, 10
  s_cmp_eq_u32 s48, 1
  s_cselect_b32 s26, s27, s26
  s_cmp_eq_u32 s48, 2
  s_cselect_b32 s26, s28, s26
  s_lshl_b32 s26, s26, 3
  s_load_dwordx2 s[8:9], s[0:1], s26
  s_cmp_eq_u32 s48, 1
  s_cselect_b32 s26, 8, 0
  s_load_dwordx2 s[12:13], s[0:1], s26
  s_cmp_eq_u32 s29, 0
  s_cselect_b32 s21, 0, 3
  s_cselect_b32 s27, 1, 2
  s_cselect_b32 s28, 4, 5
  s_cmp_eq_u32 s48, 1
  s_cselect_b32 s21, s27, s21
  s_cmp_eq_u32 s48, 2
  s_cselect_b32 s21, s28, s21
  s_lshl_b32 s21, s21, 5
  s_add_u32 s21, s21, s64
  s_lshl_b32 s21, s21, 6
  s_add_u32 s21, s21, s49
  s_and_b32 s27, s16, 1
  s_lshl_b32 s21, s21, 1
  s_add_u32 s21, s21, s27
  s_lshl_b32 s21, s21, 12
  s_lshl_b32 s22, s50, 13
  s_lshl_b32 s19, s49, 15
  s_lshl_b32 s20, s50, 15
  s_lshl_b32 s17, s64, 1
  s_add_u32 s17, s17, s27
  s_lshl_b32 s17, s17, 7
  s_mov_b32 s18, 8192
  s_mov_b32 s24, 0x3e0293ee
  s_waitcnt lgkmcnt(0)
  s_and_b32 s9, s9, 0xffff
  s_mov_b32 s10, 4194304
  s_mov_b32 s11, 0x20000
  s_and_b32 s13, s13, 0xffff
  s_mov_b32 s14, 2097152
  s_mov_b32 s15, 0x20000
  s_cmp_eq_u32 s48, 0
  s_cselect_b32 s32, 0, s16
  s_lshr_b32 s32, s32, 1
  v_lshrrev_b32 v144, 4, v1
  v_and_b32 v56, 0xff, v2
  v_lshl_add_u32 v56, v144, 9, v56
  v_and_b32 v146, 15, v1
  v_and_b32 v144, 8, v1
  v_add_u32 v144, v144, v146
  s_cmp_lg_u32 s32, 0
  s_cselect_b64 vcc, -1, 0
  s_cselect_b32 s26, 8, 16
  v_cndmask_b32 v144, v146, v144, vcc
  v_lshrrev_b32 v145, 4, v1
  v_add_u32 v148, s26, v144
  v_xor_b32 v147, 0, v145
  v_xor_b32 v147, v147, v146
  v_lshlrev_b32 v147, 4, v147
  v_lshl_add_u32 v8, v144, 8, v147
  v_xor_b32 v147, 8, v145
  v_xor_b32 v147, v147, v146
  v_lshlrev_b32 v147, 4, v147
  v_lshl_add_u32 v9, v148, 8, v147
  v_xor_b32 v147, 4, v145
  v_xor_b32 v147, v147, v146
  v_lshlrev_b32 v147, 4, v147
  v_lshl_add_u32 v10, v144, 8, v147
  v_xor_b32 v147, 12, v145
  v_xor_b32 v147, v147, v146
  v_lshlrev_b32 v147, 4, v147
  v_lshl_add_u32 v11, v148, 8, v147
  v_xor_b32 v147, 8, v145
  v_xor_b32 v147, v147, v146
  v_lshlrev_b32 v147, 4, v147
  v_lshl_add_u32 v12, v144, 8, v147
  v_xor_b32 v147, 0, v145
  v_xor_b32 v147, v147, v146
  v_lshlrev_b32 v147, 4, v147
  v_lshl_add_u32 v13, v148, 8, v147
  v_xor_b32 v147, 12, v145
  v_xor_b32 v147, v147, v146
  v_lshlrev_b32 v147, 4, v147
  v_lshl_add_u32 v14, v144, 8, v147
  v_xor_b32 v147, 4, v145
  v_xor_b32 v147, v147, v146
  v_lshlrev_b32 v147, 4, v147
  v_lshl_add_u32 v15, v148, 8, v147
  v_lshrrev_b32 v144, 4, v1
  s_lshl_b32 s26, s16, 8
  v_add_u32 v145, 0, v144
  v_or_b32 v147, 0, v144
  v_xor_b32 v147, v147, v146
  v_lshlrev_b32 v147, 4, v147
  v_lshl_add_u32 v147, v145, 10, v147
  v_add_u32 v16, s26, v147
  v_add_u32 v145, 4, v144
  v_or_b32 v147, 4, v144
  v_xor_b32 v147, v147, v146
  v_lshlrev_b32 v147, 4, v147
  v_lshl_add_u32 v147, v145, 10, v147
  v_add_u32 v17, s26, v147
  v_add_u32 v145, 8, v144
  v_or_b32 v147, 8, v144
  v_xor_b32 v147, v147, v146
  v_lshlrev_b32 v147, 4, v147
  v_lshl_add_u32 v147, v145, 10, v147
  v_add_u32 v18, s26, v147
  v_add_u32 v145, 12, v144
  v_or_b32 v147, 12, v144
  v_xor_b32 v147, v147, v146
  v_lshlrev_b32 v147, 4, v147
  v_lshl_add_u32 v147, v145, 10, v147
  v_add_u32 v19, s26, v147
  v_add_u32 v145, 16, v144
  v_or_b32 v147, 8, v144
  v_xor_b32 v147, v147, v146
  v_lshlrev_b32 v147, 4, v147
  v_lshl_add_u32 v147, v145, 10, v147
  v_add_u32 v20, s26, v147
  v_add_u32 v145, 20, v144
  v_or_b32 v147, 12, v144
  v_xor_b32 v147, v147, v146
  v_lshlrev_b32 v147, 4, v147
  v_lshl_add_u32 v147, v145, 10, v147
  v_add_u32 v21, s26, v147
  v_add_u32 v145, 24, v144
  v_or_b32 v147, 0, v144
  v_xor_b32 v147, v147, v146
  v_lshlrev_b32 v147, 4, v147
  v_lshl_add_u32 v147, v145, 10, v147
  v_add_u32 v22, s26, v147
  v_add_u32 v145, 28, v144
  v_or_b32 v147, 4, v144
  v_xor_b32 v147, v147, v146
  v_lshlrev_b32 v147, 4, v147
  v_lshl_add_u32 v147, v145, 10, v147
  v_add_u32 v23, s26, v147
  v_lshrrev_b32 v144, 3, v1
  v_mul_lo_u32 v144, v144, s18
  v_and_b32 v145, 7, v1
  v_lshl_add_u32 v144, v145, 4, v144
  s_lshl_b32 s28, s16, 15
  s_add_u32 s28, s28, 32768
  s_lshl_b32 s29, s18, 3
  s_add_u32 m0, s28, 0
  s_nop 0
  buffer_load_dwordx4 v144, s[8:11], s17 offen lds
  s_add_u32 s17, s17, s29
  s_add_u32 m0, s28, 1024
  s_nop 0
  buffer_load_dwordx4 v144, s[8:11], s17 offen lds
  s_add_u32 s17, s17, s29
  s_add_u32 m0, s28, 2048
  s_nop 0
  buffer_load_dwordx4 v144, s[8:11], s17 offen lds
  s_add_u32 s17, s17, s29
  s_add_u32 m0, s28, 3072
  s_nop 0
  buffer_load_dwordx4 v144, s[8:11], s17 offen lds
  s_add_u32 s17, s17, s29
  s_add_u32 m0, s28, 4096
  s_nop 0
  buffer_load_dwordx4 v144, s[8:11], s17 offen lds
  s_add_u32 s17, s17, s29
  s_add_u32 m0, s28, 5120
  s_nop 0
  buffer_load_dwordx4 v144, s[8:11], s17 offen lds
  s_add_u32 s17, s17, s29
  s_add_u32 m0, s28, 6144
  s_nop 0
  buffer_load_dwordx4 v144, s[8:11], s17 offen lds
  s_add_u32 s17, s17, s29
  s_add_u32 m0, s28, 7168
  s_nop 0
  buffer_load_dwordx4 v144, s[8:11], s17 offen lds
  s_add_u32 s17, s17, s29
  s_add_u32 m0, s28, 8192
  s_nop 0
  buffer_load_dwordx4 v144, s[8:11], s17 offen lds
  s_add_u32 s17, s17, s29
  s_add_u32 m0, s28, 9216
  s_nop 0
  buffer_load_dwordx4 v144, s[8:11], s17 offen lds
  s_add_u32 s17, s17, s29
  s_add_u32 m0, s28, 10240
  s_nop 0
  buffer_load_dwordx4 v144, s[8:11], s17 offen lds
  s_add_u32 s17, s17, s29
  s_add_u32 m0, s28, 11264
  s_nop 0
  buffer_load_dwordx4 v144, s[8:11], s17 offen lds
  s_add_u32 s17, s17, s29
  s_add_u32 m0, s28, 12288
  s_nop 0
  buffer_load_dwordx4 v144, s[8:11], s17 offen lds
  s_add_u32 s17, s17, s29
  s_add_u32 m0, s28, 13312
  s_nop 0
  buffer_load_dwordx4 v144, s[8:11], s17 offen lds
  s_add_u32 s17, s17, s29
  s_add_u32 m0, s28, 14336
  s_nop 0
  buffer_load_dwordx4 v144, s[8:11], s17 offen lds
  s_add_u32 s17, s17, s29
  s_add_u32 m0, s28, 15360
  s_nop 0
  buffer_load_dwordx4 v144, s[8:11], s17 offen lds
  s_add_u32 s17, s17, s29
  s_add_u32 m0, s28, 16384
  s_nop 0
  buffer_load_dwordx4 v144, s[8:11], s17 offen lds
  s_add_u32 s17, s17, s29
  s_add_u32 m0, s28, 17408
  s_nop 0
  buffer_load_dwordx4 v144, s[8:11], s17 offen lds
  s_add_u32 s17, s17, s29
  s_add_u32 m0, s28, 18432
  s_nop 0
  buffer_load_dwordx4 v144, s[8:11], s17 offen lds
  s_add_u32 s17, s17, s29
  s_add_u32 m0, s28, 19456
  s_nop 0
  buffer_load_dwordx4 v144, s[8:11], s17 offen lds
  s_add_u32 s17, s17, s29
  s_add_u32 m0, s28, 20480
  s_nop 0
  buffer_load_dwordx4 v144, s[8:11], s17 offen lds
  s_add_u32 s17, s17, s29
  s_add_u32 m0, s28, 21504
  s_nop 0
  buffer_load_dwordx4 v144, s[8:11], s17 offen lds
  s_add_u32 s17, s17, s29
  s_add_u32 m0, s28, 22528
  s_nop 0
  buffer_load_dwordx4 v144, s[8:11], s17 offen lds
  s_add_u32 s17, s17, s29
  s_add_u32 m0, s28, 23552
  s_nop 0
  buffer_load_dwordx4 v144, s[8:11], s17 offen lds
  s_add_u32 s17, s17, s29
  s_add_u32 m0, s28, 24576
  s_nop 0
  buffer_load_dwordx4 v144, s[8:11], s17 offen lds
  s_add_u32 s17, s17, s29
  s_add_u32 m0, s28, 25600
  s_nop 0
  buffer_load_dwordx4 v144, s[8:11], s17 offen lds
  s_add_u32 s17, s17, s29
  s_add_u32 m0, s28, 26624
  s_nop 0
  buffer_load_dwordx4 v144, s[8:11], s17 offen lds
  s_add_u32 s17, s17, s29
  s_add_u32 m0, s28, 27648
  s_nop 0
  buffer_load_dwordx4 v144, s[8:11], s17 offen lds
  s_add_u32 s17, s17, s29
  s_add_u32 m0, s28, 28672
  s_nop 0
  buffer_load_dwordx4 v144, s[8:11], s17 offen lds
  s_add_u32 s17, s17, s29
  s_add_u32 m0, s28, 29696
  s_nop 0
  buffer_load_dwordx4 v144, s[8:11], s17 offen lds
  s_add_u32 s17, s17, s29
  s_add_u32 m0, s28, 30720
  s_nop 0
  buffer_load_dwordx4 v144, s[8:11], s17 offen lds
  s_add_u32 s17, s17, s29
  s_add_u32 m0, s28, 31744
  s_nop 0
  buffer_load_dwordx4 v144, s[8:11], s17 offen lds
  s_add_u32 s17, s17, s29
  s_lshl_b32 s25, s16, 13
  s_add_u32 m0, s25, 0
  s_nop 0
  buffer_load_dwordx4 v16, s[12:15], s19 offen lds
  s_add_u32 m0, s25, 1024
  s_nop 0
  buffer_load_dwordx4 v17, s[12:15], s19 offen lds
  s_add_u32 m0, s25, 2048
  s_nop 0
  buffer_load_dwordx4 v18, s[12:15], s19 offen lds
  s_add_u32 m0, s25, 3072
  s_nop 0
  buffer_load_dwordx4 v19, s[12:15], s19 offen lds
  s_add_u32 m0, s25, 4096
  s_nop 0
  buffer_load_dwordx4 v20, s[12:15], s19 offen lds
  s_add_u32 m0, s25, 5120
  s_nop 0
  buffer_load_dwordx4 v21, s[12:15], s19 offen lds
  s_add_u32 m0, s25, 6144
  s_nop 0
  buffer_load_dwordx4 v22, s[12:15], s19 offen lds
  s_add_u32 m0, s25, 7168
  s_nop 0
  buffer_load_dwordx4 v23, s[12:15], s19 offen lds
  s_cmp_gt_u32 s23, 1
  s_cselect_b32 s26, s20, 0
  s_add_u32 s19, s19, s26
  s_add_u32 s25, s25, 32768
  s_and_b32 s25, s25, 0x1ffff
  s_cmp_lg_u32 s16, 3
  s_cbranch_scc1 M_noinit
  s_mov_b32 s79, 0
  s_atomic_swap s79, s[72:73], s31 glc
  s_waitcnt lgkmcnt(0)
  s_mov_b32 s79, 1
  s_atomic_add s79, s[74:75], 128
M_noinit:
  s_cmp_lg_u32 s65, 3
  s_cbranch_scc1 M_noarm
  v_lshlrev_b32 v4, 4, v0
  v_mov_b64 v[60:61], -1
  v_mov_b64 v[62:63], -1
  s_mul_i32 s76, s64, 4096
  s_add_u32 s77, s76, 142868480
  buffer_store_dwordx4 v[60:63], v4, s[4:7], s77 offen sc1
  s_add_u32 s77, s76, 142999552
  buffer_store_dwordx4 v[60:63], v4, s[4:7], s77 offen sc1
  s_add_u32 s77, s76, 143130624
  buffer_store_dwordx4 v[60:63], v4, s[4:7], s77 offen sc1
  s_add_u32 s77, s76, 143261696
  buffer_store_dwordx4 v[60:63], v4, s[4:7], s77 offen sc1
  s_add_u32 s77, s76, 143392768
  buffer_store_dwordx4 v[60:63], v4, s[4:7], s77 offen sc1
  s_add_u32 s77, s76, 143523840
  buffer_store_dwordx4 v[60:63], v4, s[4:7], s77 offen sc1
M_noarm:
  s_mul_i32 s76, s64, 3
  s_add_u32 s76, s76, s57
  s_mul_i32 s76, s76, 24576
  v_lshlrev_b32 v4, 7, v0
  v_add_u32 v4, s76, v4
  buffer_load_dword v5, v4, s[12:15], 0 offen
  v_bfe_u32 v148, v1, 2, 2
  v_lshrrev_b32 v149, 5, v1
  v_lshl_add_u32 v148, v149, 4, v148
  v_bfe_u32 v149, v1, 4, 1
  v_lshl_add_u32 v148, v149, 3, v148
  v_and_b32 v149, 3, v1
  v_and_b32 v150, 2, v149
  v_add_u32 v150, v150, v149
  s_cmp_lg_u32 s32, 0
  s_cselect_b64 vcc, -1, 0
  s_cselect_b32 s26, 32, 16
  v_cndmask_b32 v149, v150, v149, vcc
  v_lshlrev_b32 v149, 3, v149
  v_lshl_add_u32 v148, v148, 7, v149
  v_add_u32 v152, s28, v148
  v_add_u32 v153, 512, v152
  v_add_u32 v154, s26, v152
  v_add_u32 v155, s26, v153
  s_waitcnt vmcnt(37)
  ds_read_b64_tr_b16 a[0:1], v152 offset:0
  ds_read_b64_tr_b16 a[2:3], v153 offset:0
  ds_read_b64_tr_b16 a[4:5], v154 offset:0
  ds_read_b64_tr_b16 a[6:7], v155 offset:0
  ds_read_b64_tr_b16 a[8:9], v152 offset:64
  ds_read_b64_tr_b16 a[10:11], v153 offset:64
  ds_read_b64_tr_b16 a[12:13], v154 offset:64
  ds_read_b64_tr_b16 a[14:15], v155 offset:64
  s_waitcnt lgkmcnt(0)
  s_add_u32 m0, s28, 0
  s_nop 0
  buffer_load_dwordx4 v144, s[8:11], s17 offen lds
  s_add_u32 s17, s17, s29
  s_add_u32 m0, s28, 1024
  s_nop 0
  buffer_load_dwordx4 v144, s[8:11], s17 offen lds
  s_add_u32 s17, s17, s29
  s_add_u32 m0, s28, 2048
  s_nop 0
  buffer_load_dwordx4 v144, s[8:11], s17 offen lds
  s_add_u32 s17, s17, s29
  s_add_u32 m0, s28, 3072
  s_nop 0
  buffer_load_dwordx4 v144, s[8:11], s17 offen lds
  s_add_u32 s17, s17, s29
  s_waitcnt vmcnt(37)
  ds_read_b64_tr_b16 a[16:17], v152 offset:4096
  ds_read_b64_tr_b16 a[18:19], v153 offset:4096
  ds_read_b64_tr_b16 a[20:21], v154 offset:4096
  ds_read_b64_tr_b16 a[22:23], v155 offset:4096
  ds_read_b64_tr_b16 a[24:25], v152 offset:4160
  ds_read_b64_tr_b16 a[26:27], v153 offset:4160
  ds_read_b64_tr_b16 a[28:29], v154 offset:4160
  ds_read_b64_tr_b16 a[30:31], v155 offset:4160
  s_waitcnt lgkmcnt(0)
  s_add_u32 m0, s28, 4096
  s_nop 0
  buffer_load_dwordx4 v144, s[8:11], s17 offen lds
  s_add_u32 s17, s17, s29
  s_add_u32 m0, s28, 5120
  s_nop 0
  buffer_load_dwordx4 v144, s[8:11], s17 offen lds
  s_add_u32 s17, s17, s29
  s_add_u32 m0, s28, 6144
  s_nop 0
  buffer_load_dwordx4 v144, s[8:11], s17 offen lds
  s_add_u32 s17, s17, s29
  s_add_u32 m0, s28, 7168
  s_nop 0
  buffer_load_dwordx4 v144, s[8:11], s17 offen lds
  s_add_u32 s17, s17, s29
  s_waitcnt vmcnt(37)
  ds_read_b64_tr_b16 a[32:33], v152 offset:8192
  ds_read_b64_tr_b16 a[34:35], v153 offset:8192
  ds_read_b64_tr_b16 a[36:37], v154 offset:8192
  ds_read_b64_tr_b16 a[38:39], v155 offset:8192
  ds_read_b64_tr_b16 a[40:41], v152 offset:8256
  ds_read_b64_tr_b16 a[42:43], v153 offset:8256
  ds_read_b64_tr_b16 a[44:45], v154 offset:8256
  ds_read_b64_tr_b16 a[46:47], v155 offset:8256
  s_waitcnt lgkmcnt(0)
  s_add_u32 m0, s28, 8192
  s_nop 0
  buffer_load_dwordx4 v144, s[8:11], s17 offen lds
  s_add_u32 s17, s17, s29
  s_add_u32 m0, s28, 9216
  s_nop 0
  buffer_load_dwordx4 v144, s[8:11], s17 offen lds
  s_add_u32 s17, s17, s29
  s_add_u32 m0, s28, 10240
  s_nop 0
  buffer_load_dwordx4 v144, s[8:11], s17 offen lds
  s_add_u32 s17, s17, s29
  s_add_u32 m0, s28, 11264
  s_nop 0
  buffer_load_dwordx4 v144, s[8:11], s17 offen lds
  s_add_u32 s17, s17, s29
  s_waitcnt vmcnt(37)
  ds_read_b64_tr_b16 a[48:49], v152 offset:12288
  ds_read_b64_tr_b16 a[50:51], v153 offset:12288
  ds_read_b64_tr_b16 a[52:53], v154 offset:12288
  ds_read_b64_tr_b16 a[54:55], v155 offset:12288
  ds_read_b64_tr_b16 a[56:57], v152 offset:12352
  ds_read_b64_tr_b16 a[58:59], v153 offset:12352
  ds_read_b64_tr_b16 a[60:61], v154 offset:12352
  ds_read_b64_tr_b16 a[62:63], v155 offset:12352
  s_waitcnt lgkmcnt(0)
  s_add_u32 m0, s28, 12288
  s_nop 0
  buffer_load_dwordx4 v144, s[8:11], s17 offen lds
  s_add_u32 s17, s17, s29
  s_add_u32 m0, s28, 13312
  s_nop 0
  buffer_load_dwordx4 v144, s[8:11], s17 offen lds
  s_add_u32 s17, s17, s29
  s_add_u32 m0, s28, 14336
  s_nop 0
  buffer_load_dwordx4 v144, s[8:11], s17 offen lds
  s_add_u32 s17, s17, s29
  s_add_u32 m0, s28, 15360
  s_nop 0
  buffer_load_dwordx4 v144, s[8:11], s17 offen lds
  s_add_u32 s17, s17, s29
  s_waitcnt vmcnt(37)
  ds_read_b64_tr_b16 a[64:65], v152 offset:16384
  ds_read_b64_tr_b16 a[66:67], v153 offset:16384
  ds_read_b64_tr_b16 a[68:69], v154 offset:16384
  ds_read_b64_tr_b16 a[70:71], v155 offset:16384
  ds_read_b64_tr_b16 a[72:73], v152 offset:16448
  ds_read_b64_tr_b16 a[74:75], v153 offset:16448
  ds_read_b64_tr_b16 a[76:77], v154 offset:16448
  ds_read_b64_tr_b16 a[78:79], v155 offset:16448
  s_waitcnt lgkmcnt(0)
  s_add_u32 m0, s28, 16384
  s_nop 0
  buffer_load_dwordx4 v144, s[8:11], s17 offen lds
  s_add_u32 s17, s17, s29
  s_add_u32 m0, s28, 17408
  s_nop 0
  buffer_load_dwordx4 v144, s[8:11], s17 offen lds
  s_add_u32 s17, s17, s29
  s_add_u32 m0, s28, 18432
  s_nop 0
  buffer_load_dwordx4 v144, s[8:11], s17 offen lds
  s_add_u32 s17, s17, s29
  s_add_u32 m0, s28, 19456
  s_nop 0
  buffer_load_dwordx4 v144, s[8:11], s17 offen lds
  s_add_u32 s17, s17, s29
  s_waitcnt vmcnt(37)
  ds_read_b64_tr_b16 a[80:81], v152 offset:20480
  ds_read_b64_tr_b16 a[82:83], v153 offset:20480
  ds_read_b64_tr_b16 a[84:85], v154 offset:20480
  ds_read_b64_tr_b16 a[86:87], v155 offset:20480
  ds_read_b64_tr_b16 a[88:89], v152 offset:20544
  ds_read_b64_tr_b16 a[90:91], v153 offset:20544
  ds_read_b64_tr_b16 a[92:93], v154 offset:20544
  ds_read_b64_tr_b16 a[94:95], v155 offset:20544
  s_waitcnt lgkmcnt(0)
  s_add_u32 m0, s28, 20480
  s_nop 0
  buffer_load_dwordx4 v144, s[8:11], s17 offen lds
  s_add_u32 s17, s17, s29
  s_add_u32 m0, s28, 21504
  s_nop 0
  buffer_load_dwordx4 v144, s[8:11], s17 offen lds
  s_add_u32 s17, s17, s29
  s_add_u32 m0, s28, 22528
  s_nop 0
  buffer_load_dwordx4 v144, s[8:11], s17 offen lds
  s_add_u32 s17, s17, s29
  s_add_u32 m0, s28, 23552
  s_nop 0
  buffer_load_dwordx4 v144, s[8:11], s17 offen lds
  s_add_u32 s17, s17, s29
  s_waitcnt vmcnt(37)
  ds_read_b64_tr_b16 a[96:97], v152 offset:24576
  ds_read_b64_tr_b16 a[98:99], v153 offset:24576
  ds_read_b64_tr_b16 a[100:101], v154 offset:24576
  ds_read_b64_tr_b16 a[102:103], v155 offset:24576
  ds_read_b64_tr_b16 a[104:105], v152 offset:24640
  ds_read_b64_tr_b16 a[106:107], v153 offset:24640
  ds_read_b64_tr_b16 a[108:109], v154 offset:24640
  ds_read_b64_tr_b16 a[110:111], v155 offset:24640
  s_waitcnt lgkmcnt(0)
  s_add_u32 m0, s28, 24576
  s_nop 0
  buffer_load_dwordx4 v144, s[8:11], s17 offen lds
  s_add_u32 s17, s17, s29
  s_add_u32 m0, s28, 25600
  s_nop 0
  buffer_load_dwordx4 v144, s[8:11], s17 offen lds
  s_add_u32 s17, s17, s29
  s_add_u32 m0, s28, 26624
  s_nop 0
  buffer_load_dwordx4 v144, s[8:11], s17 offen lds
  s_add_u32 s17, s17, s29
  s_add_u32 m0, s28, 27648
  s_nop 0
  buffer_load_dwordx4 v144, s[8:11], s17 offen lds
  s_add_u32 s17, s17, s29
  s_waitcnt vmcnt(37)
  ds_read_b64_tr_b16 a[112:113], v152 offset:28672
  ds_read_b64_tr_b16 a[114:115], v153 offset:28672
  ds_read_b64_tr_b16 a[116:117], v154 offset:28672
  ds_read_b64_tr_b16 a[118:119], v155 offset:28672
  ds_read_b64_tr_b16 a[120:121], v152 offset:28736
  ds_read_b64_tr_b16 a[122:123], v153 offset:28736
  ds_read_b64_tr_b16 a[124:125], v154 offset:28736
  ds_read_b64_tr_b16 a[126:127], v155 offset:28736
  s_waitcnt lgkmcnt(0)
  s_add_u32 m0, s28, 28672
  s_nop 0
  buffer_load_dwordx4 v144, s[8:11], s17 offen lds
  s_add_u32 s17, s17, s29
  s_add_u32 m0, s28, 29696
  s_nop 0
  buffer_load_dwordx4 v144, s[8:11], s17 offen lds
  s_add_u32 s17, s17, s29
  s_add_u32 m0, s28, 30720
  s_nop 0
  buffer_load_dwordx4 v144, s[8:11], s17 offen lds
  s_add_u32 s17, s17, s29
  s_add_u32 m0, s28, 31744
  s_nop 0
  buffer_load_dwordx4 v144, s[8:11], s17 offen lds
  s_add_u32 s17, s17, s29
  s_waitcnt vmcnt(28)
  ds_read_b64_tr_b16 a[128:129], v152 offset:0
  ds_read_b64_tr_b16 a[130:131], v153 offset:0
  ds_read_b64_tr_b16 a[132:133], v154 offset:0
  ds_read_b64_tr_b16 a[134:135], v155 offset:0
  ds_read_b64_tr_b16 a[136:137], v152 offset:64
  ds_read_b64_tr_b16 a[138:139], v153 offset:64
  ds_read_b64_tr_b16 a[140:141], v154 offset:64
  ds_read_b64_tr_b16 a[142:143], v155 offset:64
  s_waitcnt lgkmcnt(0)
  s_waitcnt vmcnt(24)
  ds_read_b64_tr_b16 a[144:145], v152 offset:4096
  ds_read_b64_tr_b16 a[146:147], v153 offset:4096
  ds_read_b64_tr_b16 a[148:149], v154 offset:4096
  ds_read_b64_tr_b16 a[150:151], v155 offset:4096
  ds_read_b64_tr_b16 a[152:153], v152 offset:4160
  ds_read_b64_tr_b16 a[154:155], v153 offset:4160
  ds_read_b64_tr_b16 a[156:157], v154 offset:4160
  ds_read_b64_tr_b16 a[158:159], v155 offset:4160
  s_waitcnt lgkmcnt(0)
  s_waitcnt vmcnt(20)
  ds_read_b64_tr_b16 a[160:161], v152 offset:8192
  ds_read_b64_tr_b16 a[162:163], v153 offset:8192
  ds_read_b64_tr_b16 a[164:165], v154 offset:8192
  ds_read_b64_tr_b16 a[166:167], v155 offset:8192
  ds_read_b64_tr_b16 a[168:169], v152 offset:8256
  ds_read_b64_tr_b16 a[170:171], v153 offset:8256
  ds_read_b64_tr_b16 a[172:173], v154 offset:8256
  ds_read_b64_tr_b16 a[174:175], v155 offset:8256
  s_waitcnt lgkmcnt(0)
  s_waitcnt vmcnt(16)
  ds_read_b64_tr_b16 a[176:177], v152 offset:12288
  ds_read_b64_tr_b16 a[178:179], v153 offset:12288
  ds_read_b64_tr_b16 a[180:181], v154 offset:12288
  ds_read_b64_tr_b16 a[182:183], v155 offset:12288
  ds_read_b64_tr_b16 a[184:185], v152 offset:12352
  ds_read_b64_tr_b16 a[186:187], v153 offset:12352
  ds_read_b64_tr_b16 a[188:189], v154 offset:12352
  ds_read_b64_tr_b16 a[190:191], v155 offset:12352
  s_waitcnt lgkmcnt(0)
  s_waitcnt vmcnt(12)
  ds_read_b64_tr_b16 a[192:193], v152 offset:16384
  ds_read_b64_tr_b16 a[194:195], v153 offset:16384
  ds_read_b64_tr_b16 a[196:197], v154 offset:16384
  ds_read_b64_tr_b16 a[198:199], v155 offset:16384
  ds_read_b64_tr_b16 a[200:201], v152 offset:16448
  ds_read_b64_tr_b16 a[202:203], v153 offset:16448
  ds_read_b64_tr_b16 a[204:205], v154 offset:16448
  ds_read_b64_tr_b16 a[206:207], v155 offset:16448
  s_waitcnt lgkmcnt(0)
  s_waitcnt vmcnt(8)
  ds_read_b64_tr_b16 a[208:209], v152 offset:20480
  ds_read_b64_tr_b16 a[210:211], v153 offset:20480
  ds_read_b64_tr_b16 a[212:213], v154 offset:20480
  ds_read_b64_tr_b16 a[214:215], v155 offset:20480
  ds_read_b64_tr_b16 a[216:217], v152 offset:20544
  ds_read_b64_tr_b16 a[218:219], v153 offset:20544
  ds_read_b64_tr_b16 a[220:221], v154 offset:20544
  ds_read_b64_tr_b16 a[222:223], v155 offset:20544
  s_waitcnt lgkmcnt(0)
  s_waitcnt vmcnt(4)
  ds_read_b64_tr_b16 a[224:225], v152 offset:24576
  ds_read_b64_tr_b16 a[226:227], v153 offset:24576
  ds_read_b64_tr_b16 a[228:229], v154 offset:24576
  ds_read_b64_tr_b16 a[230:231], v155 offset:24576
  ds_read_b64_tr_b16 a[232:233], v152 offset:24640
  ds_read_b64_tr_b16 a[234:235], v153 offset:24640
  ds_read_b64_tr_b16 a[236:237], v154 offset:24640
  ds_read_b64_tr_b16 a[238:239], v155 offset:24640
  s_waitcnt lgkmcnt(0)
  s_waitcnt vmcnt(0)
  ds_read_b64_tr_b16 a[240:241], v152 offset:28672
  ds_read_b64_tr_b16 a[242:243], v153 offset:28672
  ds_read_b64_tr_b16 a[244:245], v154 offset:28672
  ds_read_b64_tr_b16 a[246:247], v155 offset:28672
  ds_read_b64_tr_b16 a[248:249], v152 offset:28736
  ds_read_b64_tr_b16 a[250:251], v153 offset:28736
  ds_read_b64_tr_b16 a[252:253], v154 offset:28736
  ds_read_b64_tr_b16 a[254:255], v155 offset:28736
  s_waitcnt lgkmcnt(0)
  s_barrier
  s_add_u32 m0, s25, 0
  s_nop 0
  buffer_load_dwordx4 v16, s[12:15], s19 offen lds
  s_add_u32 m0, s25, 1024
  s_nop 0
  buffer_load_dwordx4 v17, s[12:15], s19 offen lds
  s_add_u32 m0, s25, 2048
  s_nop 0
  buffer_load_dwordx4 v18, s[12:15], s19 offen lds
  s_add_u32 m0, s25, 3072
  s_nop 0
  buffer_load_dwordx4 v19, s[12:15], s19 offen lds
  s_add_u32 m0, s25, 4096
  s_nop 0
  buffer_load_dwordx4 v20, s[12:15], s19 offen lds
  s_add_u32 m0, s25, 5120
  s_nop 0
  buffer_load_dwordx4 v21, s[12:15], s19 offen lds
  s_add_u32 m0, s25, 6144
  s_nop 0
  buffer_load_dwordx4 v22, s[12:15], s19 offen lds
  s_add_u32 m0, s25, 7168
  s_nop 0
  buffer_load_dwordx4 v23, s[12:15], s19 offen lds
  s_cmp_gt_u32 s23, 2
  s_cselect_b32 s26, s20, 0
  s_add_u32 s19, s19, s26
  s_add_u32 s25, s25, 32768
  s_and_b32 s25, s25, 0x1ffff
  s_waitcnt vmcnt(0)
  s_barrier
  s_load_dwordx2 s[8:9], s[0:1], 40
  s_mul_i32 s76, s66, 18816
  v_min_u32 v200, 146, v0
  v_lshl_add_u32 v200, v200, 7, s76
  s_waitcnt lgkmcnt(0)
  s_and_b32 s9, s9, 0xffff
  buffer_load_dword v201, v200, s[8:11], 0 offen
  s_cmp_lg_u32 s32, 0
  s_cbranch_scc1 P_v_130
  s_cmp_eq_u32 s48, 0
  s_cbranch_scc1 P_q_132
  s_mov_b32 s27, s21
  v_mov_b32 v7, 0x40000000
  s_mov_b32 s29, -2
  v_min_u32 v145, 1, v0
  v_lshlrev_b32 v145, 30, v145
  ds_read_b128 v[24:27], v8 offset:0
  ds_read_b128 v[28:31], v9 offset:0
  ds_read_b128 v[32:35], v10 offset:0
  ds_read_b128 v[36:39], v11 offset:0
  ds_read_b128 v[40:43], v12 offset:0
  ds_read_b128 v[44:47], v13 offset:0
.p2align 6
G_top_133:
  s_waitcnt lgkmcnt(5)
  v_mfma_f32_16x16x32_bf16 v[64:67], a[0:3], v[24:27], 0
  s_add_u32 m0, s25, 0
  ds_read_b128 v[48:51], v14 offset:0
  v_mfma_f32_16x16x32_bf16 v[68:71], a[4:7], v[24:27], 0
  v_mfma_f32_16x16x32_bf16 v[80:83], a[8:11], v[24:27], 0
  buffer_load_dwordx4 v16, s[12:15], s19 offen lds
  v_mfma_f32_16x16x32_bf16 v[84:87], a[12:15], v[24:27], 0
  s_waitcnt lgkmcnt(5)
  v_mfma_f32_16x16x32_bf16 v[72:75], a[0:3], v[28:31], 0
  ds_read_b128 v[52:55], v15 offset:0
  v_mfma_f32_16x16x32_bf16 v[76:79], a[4:7], v[28:31], 0
  v_cvt_pk_bf16_f32 v128, v96, v97
  v_cvt_pk_bf16_f32 v129, v98, v99
  v_mfma_f32_16x16x32_bf16 v[88:91], a[8:11], v[28:31], 0
  v_mfma_f32_16x16x32_bf16 v[92:95], a[12:15], v[28:31], 0
  s_waitcnt lgkmcnt(5)
  v_cvt_pk_bf16_f32 v130, v100, v101
  v_cvt_pk_bf16_f32 v131, v102, v103
  v_mfma_f32_16x16x32_bf16 v[64:67], a[16:19], v[32:35], v[64:67]
  s_add_u32 m0, s25, 1024
  ds_read_b128 v[24:27], v8 offset:8192
  v_mfma_f32_16x16x32_bf16 v[68:71], a[20:23], v[32:35], v[68:71]
  v_mfma_f32_16x16x32_bf16 v[80:83], a[24:27], v[32:35], v[80:83]
  buffer_load_dwordx4 v17, s[12:15], s19 offen lds
  v_mfma_f32_16x16x32_bf16 v[84:87], a[28:31], v[32:35], v[84:87]
  s_waitcnt lgkmcnt(5)
  v_mfma_f32_16x16x32_bf16 v[72:75], a[16:19], v[36:39], v[72:75]
  ds_read_b128 v[28:31], v9 offset:8192
  v_mfma_f32_16x16x32_bf16 v[76:79], a[20:23], v[36:39], v[76:79]
  v_mfma_f32_16x16x32_bf16 v[88:91], a[24:27], v[36:39], v[88:91]
  v_mfma_f32_16x16x32_bf16 v[92:95], a[28:31], v[36:39], v[92:95]
  s_waitcnt lgkmcnt(5)
  v_mfma_f32_16x16x32_bf16 v[64:67], a[32:35], v[40:43], v[64:67]
  s_add_u32 m0, s25, 2048
  ds_read_b128 v[32:35], v10 offset:8192
  v_mfma_f32_16x16x32_bf16 v[68:71], a[36:39], v[40:43], v[68:71]
  v_cvt_pk_bf16_f32 v132, v104, v105
  v_cvt_pk_bf16_f32 v133, v106, v107
  v_mfma_f32_16x16x32_bf16 v[80:83], a[40:43], v[40:43], v[80:83]
  buffer_load_dwordx4 v18, s[12:15], s19 offen lds
  v_mfma_f32_16x16x32_bf16 v[84:87], a[44:47], v[40:43], v[84:87]
  s_waitcnt lgkmcnt(5)
  v_cvt_pk_bf16_f32 v134, v108, v109
  v_cvt_pk_bf16_f32 v135, v110, v111
  v_mfma_f32_16x16x32_bf16 v[72:75], a[32:35], v[44:47], v[72:75]
  ds_read_b128 v[36:39], v11 offset:8192
  v_mfma_f32_16x16x32_bf16 v[76:79], a[36:39], v[44:47], v[76:79]
  v_mfma_f32_16x16x32_bf16 v[88:91], a[40:43], v[44:47], v[88:91]
  v_mfma_f32_16x16x32_bf16 v[92:95], a[44:47], v[44:47], v[92:95]
  s_waitcnt lgkmcnt(5)
  v_mfma_f32_16x16x32_bf16 v[64:67], a[48:51], v[48:51], v[64:67]
  s_add_u32 m0, s25, 3072
  ds_read_b128 v[40:43], v12 offset:8192
  v_mfma_f32_16x16x32_bf16 v[68:71], a[52:55], v[48:51], v[68:71]
  v_mfma_f32_16x16x32_bf16 v[80:83], a[56:59], v[48:51], v[80:83]
  buffer_load_dwordx4 v19, s[12:15], s19 offen lds
  v_mfma_f32_16x16x32_bf16 v[84:87], a[60:63], v[48:51], v[84:87]
  s_waitcnt lgkmcnt(5)
  v_mfma_f32_16x16x32_bf16 v[72:75], a[48:51], v[52:55], v[72:75]
  ds_read_b128 v[44:47], v13 offset:8192
  v_mfma_f32_16x16x32_bf16 v[76:79], a[52:55], v[52:55], v[76:79]
  v_cvt_pk_bf16_f32 v136, v112, v113
  v_cvt_pk_bf16_f32 v137, v114, v115
  v_mfma_f32_16x16x32_bf16 v[88:91], a[56:59], v[52:55], v[88:91]
  v_mfma_f32_16x16x32_bf16 v[92:95], a[60:63], v[52:55], v[92:95]
  s_waitcnt lgkmcnt(5)
  v_cvt_pk_bf16_f32 v138, v116, v117
  v_cvt_pk_bf16_f32 v139, v118, v119
  v_mfma_f32_16x16x32_bf16 v[64:67], a[64:67], v[24:27], v[64:67]
  s_add_u32 m0, s25, 4096
  ds_read_b128 v[48:51], v14 offset:8192
  v_mfma_f32_16x16x32_bf16 v[68:71], a[68:71], v[24:27], v[68:71]
  v_mfma_f32_16x16x32_bf16 v[80:83], a[72:75], v[24:27], v[80:83]
  buffer_load_dwordx4 v20, s[12:15], s19 offen lds
  v_mfma_f32_16x16x32_bf16 v[84:87], a[76:79], v[24:27], v[84:87]
  s_waitcnt lgkmcnt(5)
  v_mfma_f32_16x16x32_bf16 v[72:75], a[64:67], v[28:31], v[72:75]
  ds_read_b128 v[52:55], v15 offset:8192
  v_mfma_f32_16x16x32_bf16 v[76:79], a[68:71], v[28:31], v[76:79]
  v_mfma_f32_16x16x32_bf16 v[88:91], a[72:75], v[28:31], v[88:91]
  v_mfma_f32_16x16x32_bf16 v[92:95], a[76:79], v[28:31], v[92:95]
  s_waitcnt lgkmcnt(5)
  v_mfma_f32_16x16x32_bf16 v[64:67], a[80:83], v[32:35], v[64:67]
  s_add_u32 m0, s25, 5120
  ds_read_b128 v[24:27], v8 offset:16384
  v_mfma_f32_16x16x32_bf16 v[68:71], a[84:87], v[32:35], v[68:71]
  v_cvt_pk_bf16_f32 v140, v120, v121
  v_cvt_pk_bf16_f32 v141, v122, v123
  v_mfma_f32_16x16x32_bf16 v[80:83], a[88:91], v[32:35], v[80:83]
  buffer_load_dwordx4 v21, s[12:15], s19 offen lds
  v_mfma_f32_16x16x32_bf16 v[84:87], a[92:95], v[32:35], v[84:87]
  s_waitcnt lgkmcnt(5)
  v_cvt_pk_bf16_f32 v142, v124, v125
  v_cvt_pk_bf16_f32 v143, v126, v127
  v_mfma_f32_16x16x32_bf16 v[72:75], a[80:83], v[36:39], v[72:75]
  ds_read_b128 v[28:31], v9 offset:16384
  v_mfma_f32_16x16x32_bf16 v[76:79], a[84:87], v[36:39], v[76:79]
  v_mfma_f32_16x16x32_bf16 v[88:91], a[88:91], v[36:39], v[88:91]
  v_mfma_f32_16x16x32_bf16 v[92:95], a[92:95], v[36:39], v[92:95]
  s_waitcnt lgkmcnt(5)
  v_mfma_f32_16x16x32_bf16 v[64:67], a[96:99], v[40:43], v[64:67]
  s_add_u32 m0, s25, 6144
  ds_read_b128 v[32:35], v10 offset:16384
  v_mfma_f32_16x16x32_bf16 v[68:71], a[100:103], v[40:43], v[68:71]
  v_mfma_f32_16x16x32_bf16 v[80:83], a[104:107], v[40:43], v[80:83]
  buffer_load_dwordx4 v22, s[12:15], s19 offen lds
  v_mfma_f32_16x16x32_bf16 v[84:87], a[108:111], v[40:43], v[84:87]
  s_waitcnt lgkmcnt(5)
  v_mfma_f32_16x16x32_bf16 v[72:75], a[96:99], v[44:47], v[72:75]
  ds_read_b128 v[36:39], v11 offset:16384
  v_mfma_f32_16x16x32_bf16 v[76:79], a[100:103], v[44:47], v[76:79]
  v_mfma_f32_16x16x32_bf16 v[88:91], a[104:107], v[44:47], v[88:91]
  v_mfma_f32_16x16x32_bf16 v[92:95], a[108:111], v[44:47], v[92:95]
  s_waitcnt lgkmcnt(5)
  v_mfma_f32_16x16x32_bf16 v[64:67], a[112:115], v[48:51], v[64:67]
  s_add_u32 m0, s25, 7168
  ds_read_b128 v[40:43], v12 offset:16384
  v_mfma_f32_16x16x32_bf16 v[68:71], a[116:119], v[48:51], v[68:71]
  v_mfma_f32_16x16x32_bf16 v[80:83], a[120:123], v[48:51], v[80:83]
  buffer_load_dwordx4 v23, s[12:15], s19 offen lds
  v_mfma_f32_16x16x32_bf16 v[84:87], a[124:127], v[48:51], v[84:87]
  s_waitcnt lgkmcnt(5)
  v_mfma_f32_16x16x32_bf16 v[72:75], a[112:115], v[52:55], v[72:75]
  s_cmp_gt_u32 s23, 3
  ds_read_b128 v[44:47], v13 offset:16384
  v_mfma_f32_16x16x32_bf16 v[76:79], a[116:119], v[52:55], v[76:79]
  v_mfma_f32_16x16x32_bf16 v[88:91], a[120:123], v[52:55], v[88:91]
  s_cselect_b32 s26, s20, 0
  v_mfma_f32_16x16x32_bf16 v[92:95], a[124:127], v[52:55], v[92:95]
  s_waitcnt lgkmcnt(5)
  v_mfma_f32_16x16x32_bf16 v[64:67], a[128:131], v[24:27], v[64:67]
  s_add_u32 s19, s19, s26
  ds_read_b128 v[48:51], v14 offset:16384
  v_mfma_f32_16x16x32_bf16 v[68:71], a[132:135], v[24:27], v[68:71]
  v_mfma_f32_16x16x32_bf16 v[80:83], a[136:139], v[24:27], v[80:83]
  s_add_u32 s25, s25, 32768
  v_mfma_f32_16x16x32_bf16 v[84:87], a[140:143], v[24:27], v[84:87]
  s_waitcnt lgkmcnt(5)
  v_mfma_f32_16x16x32_bf16 v[72:75], a[128:131], v[28:31], v[72:75]
  s_and_b32 s25, s25, 0x1ffff
  ds_read_b128 v[52:55], v15 offset:16384
  v_mfma_f32_16x16x32_bf16 v[76:79], a[132:135], v[28:31], v[76:79]
  v_mfma_f32_16x16x32_bf16 v[88:91], a[136:139], v[28:31], v[88:91]
  buffer_store_dwordx4 v[128:131], v7, s[4:7], s21 offen offset:0 sc1
  v_mfma_f32_16x16x32_bf16 v[92:95], a[140:143], v[28:31], v[92:95]
  s_waitcnt lgkmcnt(5)
  v_mfma_f32_16x16x32_bf16 v[64:67], a[144:147], v[32:35], v[64:67]
  ds_read_b128 v[24:27], v8 offset:24576
  v_mfma_f32_16x16x32_bf16 v[68:71], a[148:151], v[32:35], v[68:71]
  v_mfma_f32_16x16x32_bf16 v[80:83], a[152:155], v[32:35], v[80:83]
  v_mfma_f32_16x16x32_bf16 v[84:87], a[156:159], v[32:35], v[84:87]
  s_waitcnt lgkmcnt(5)
  v_mfma_f32_16x16x32_bf16 v[72:75], a[144:147], v[36:39], v[72:75]
  ds_read_b128 v[28:31], v9 offset:24576
  v_mfma_f32_16x16x32_bf16 v[76:79], a[148:151], v[36:39], v[76:79]
  v_mfma_f32_16x16x32_bf16 v[88:91], a[152:155], v[36:39], v[88:91]
  buffer_store_dwordx4 v[132:135], v7, s[4:7], s21 offen offset:256 sc1
  v_mfma_f32_16x16x32_bf16 v[92:95], a[156:159], v[36:39], v[92:95]
  s_waitcnt lgkmcnt(5)
  v_mfma_f32_16x16x32_bf16 v[64:67], a[160:163], v[40:43], v[64:67]
  ds_read_b128 v[32:35], v10 offset:24576
  v_mfma_f32_16x16x32_bf16 v[68:71], a[164:167], v[40:43], v[68:71]
  v_mfma_f32_16x16x32_bf16 v[80:83], a[168:171], v[40:43], v[80:83]
  v_mfma_f32_16x16x32_bf16 v[84:87], a[172:175], v[40:43], v[84:87]
  s_waitcnt lgkmcnt(5)
  v_mfma_f32_16x16x32_bf16 v[72:75], a[160:163], v[44:47], v[72:75]
  ds_read_b128 v[36:39], v11 offset:24576
  v_mfma_f32_16x16x32_bf16 v[76:79], a[164:167], v[44:47], v[76:79]
  v_mfma_f32_16x16x32_bf16 v[88:91], a[168:171], v[44:47], v[88:91]
  buffer_store_dwordx4 v[136:139], v7, s[4:7], s21 offen offset:2048 sc1
  v_mfma_f32_16x16x32_bf16 v[92:95], a[172:175], v[44:47], v[92:95]
  s_waitcnt lgkmcnt(5)
  v_mfma_f32_16x16x32_bf16 v[64:67], a[176:179], v[48:51], v[64:67]
  ds_read_b128 v[40:43], v12 offset:24576
  v_mfma_f32_16x16x32_bf16 v[68:71], a[180:183], v[48:51], v[68:71]
  v_mfma_f32_16x16x32_bf16 v[80:83], a[184:187], v[48:51], v[80:83]
  v_mfma_f32_16x16x32_bf16 v[84:87], a[188:191], v[48:51], v[84:87]
  s_waitcnt lgkmcnt(5)
  v_mfma_f32_16x16x32_bf16 v[72:75], a[176:179], v[52:55], v[72:75]
  ds_read_b128 v[44:47], v13 offset:24576
  v_mfma_f32_16x16x32_bf16 v[76:79], a[180:183], v[52:55], v[76:79]
  v_mfma_f32_16x16x32_bf16 v[88:91], a[184:187], v[52:55], v[88:91]
  buffer_store_dwordx4 v[140:143], v7, s[4:7], s21 offen offset:2304 sc1
  v_mfma_f32_16x16x32_bf16 v[92:95], a[188:191], v[52:55], v[92:95]
  s_waitcnt lgkmcnt(5)
  v_mfma_f32_16x16x32_bf16 v[64:67], a[192:195], v[24:27], v[64:67]
  s_mov_b32 s21, s27
  ds_read_b128 v[48:51], v14 offset:24576
  v_mfma_f32_16x16x32_bf16 v[68:71], a[196:199], v[24:27], v[68:71]
  v_mov_b32 v7, v56
  v_mfma_f32_16x16x32_bf16 v[80:83], a[200:203], v[24:27], v[80:83]
  v_mfma_f32_16x16x32_bf16 v[84:87], a[204:207], v[24:27], v[84:87]
  s_waitcnt lgkmcnt(5)
  v_mfma_f32_16x16x32_bf16 v[72:75], a[192:195], v[28:31], v[72:75]
  s_add_u32 s27, s27, s22
  ds_read_b128 v[52:55], v15 offset:24576
  v_mfma_f32_16x16x32_bf16 v[76:79], a[196:199], v[28:31], v[76:79]
  v_mfma_f32_16x16x32_bf16 v[88:91], a[200:203], v[28:31], v[88:91]
  s_waitcnt vmcnt(13)
  s_barrier
  v_mfma_f32_16x16x32_bf16 v[92:95], a[204:207], v[28:31], v[92:95]
  s_waitcnt lgkmcnt(5)
  v_mfma_f32_16x16x32_bf16 v[64:67], a[208:211], v[32:35], v[64:67]
  ds_read_b128 v[24:27], v8 offset:32768
  v_mfma_f32_16x16x32_bf16 v[68:71], a[212:215], v[32:35], v[68:71]
  v_mfma_f32_16x16x32_bf16 v[80:83], a[216:219], v[32:35], v[80:83]
  v_mfma_f32_16x16x32_bf16 v[84:87], a[220:223], v[32:35], v[84:87]
  s_waitcnt lgkmcnt(5)
  v_mfma_f32_16x16x32_bf16 v[72:75], a[208:211], v[36:39], v[72:75]
  s_add_u32 s29, s29, 1
  ds_read_b128 v[28:31], v9 offset:32768
  v_mfma_f32_16x16x32_bf16 v[76:79], a[212:215], v[36:39], v[76:79]
  v_mfma_f32_16x16x32_bf16 v[88:91], a[216:219], v[36:39], v[88:91]
  s_max_i32 s30, s29, 0
  v_mfma_f32_16x16x32_bf16 v[92:95], a[220:223], v[36:39], v[92:95]
  s_waitcnt lgkmcnt(5)
  v_mov_b32 v144, s30
  v_mfma_f32_16x16x32_bf16 v[64:67], a[224:227], v[40:43], v[64:67]
  ds_read_b128 v[32:35], v10 offset:32768
  v_mfma_f32_16x16x32_bf16 v[68:71], a[228:231], v[40:43], v[68:71]
  v_mfma_f32_16x16x32_bf16 v[80:83], a[232:235], v[40:43], v[80:83]
  buffer_store_dword v144, v145, s[4:7], s31 offen sc1
  v_mfma_f32_16x16x32_bf16 v[84:87], a[236:239], v[40:43], v[84:87]
  s_waitcnt lgkmcnt(5)
  v_mfma_f32_16x16x32_bf16 v[72:75], a[224:227], v[44:47], v[72:75]
  ds_read_b128 v[36:39], v11 offset:32768
  v_mfma_f32_16x16x32_bf16 v[76:79], a[228:231], v[44:47], v[76:79]
  v_mfma_f32_16x16x32_bf16 v[88:91], a[232:235], v[44:47], v[88:91]
  v_mfma_f32_16x16x32_bf16 v[92:95], a[236:239], v[44:47], v[92:95]
  s_waitcnt lgkmcnt(5)
  v_mfma_f32_16x16x32_bf16 v[64:67], a[240:243], v[48:51], v[64:67]
  s_sub_u32 s23, s23, 1
  ds_read_b128 v[40:43], v12 offset:32768
  v_mfma_f32_16x16x32_bf16 v[68:71], a[244:247], v[48:51], v[68:71]
  v_mfma_f32_16x16x32_bf16 v[80:83], a[248:251], v[48:51], v[80:83]
  v_mfma_f32_16x16x32_bf16 v[84:87], a[252:255], v[48:51], v[84:87]
  s_waitcnt lgkmcnt(5)
  v_mfma_f32_16x16x32_bf16 v[72:75], a[240:243], v[52:55], v[72:75]
  s_cmp_eq_u32 s23, 0
  ds_read_b128 v[44:47], v13 offset:32768
  v_mfma_f32_16x16x32_bf16 v[76:79], a[244:247], v[52:55], v[76:79]
  v_mfma_f32_16x16x32_bf16 v[88:91], a[248:251], v[52:55], v[88:91]
  v_mfma_f32_16x16x32_bf16 v[92:95], a[252:255], v[52:55], v[92:95]
  s_cbranch_scc1 G_done0_134
  s_waitcnt lgkmcnt(5)
  v_mfma_f32_16x16x32_bf16 v[96:99], a[0:3], v[24:27], 0
  s_add_u32 m0, s25, 0
  ds_read_b128 v[48:51], v14 offset:32768
  v_mfma_f32_16x16x32_bf16 v[100:103], a[4:7], v[24:27], 0
  v_mfma_f32_16x16x32_bf16 v[112:115], a[8:11], v[24:27], 0
  buffer_load_dwordx4 v16, s[12:15], s19 offen lds
  v_mfma_f32_16x16x32_bf16 v[116:119], a[12:15], v[24:27], 0
  s_waitcnt lgkmcnt(5)
  v_mfma_f32_16x16x32_bf16 v[104:107], a[0:3], v[28:31], 0
  ds_read_b128 v[52:55], v15 offset:32768
  v_mfma_f32_16x16x32_bf16 v[108:111], a[4:7], v[28:31], 0
  v_cvt_pk_bf16_f32 v128, v64, v65
  v_cvt_pk_bf16_f32 v129, v66, v67
  v_mfma_f32_16x16x32_bf16 v[120:123], a[8:11], v[28:31], 0
  v_mfma_f32_16x16x32_bf16 v[124:127], a[12:15], v[28:31], 0
  s_waitcnt lgkmcnt(5)
  v_cvt_pk_bf16_f32 v130, v68, v69
  v_cvt_pk_bf16_f32 v131, v70, v71
  v_mfma_f32_16x16x32_bf16 v[96:99], a[16:19], v[32:35], v[96:99]
  s_add_u32 m0, s25, 1024
  ds_read_b128 v[24:27], v8 offset:40960
  v_mfma_f32_16x16x32_bf16 v[100:103], a[20:23], v[32:35], v[100:103]
  v_mfma_f32_16x16x32_bf16 v[112:115], a[24:27], v[32:35], v[112:115]
  buffer_load_dwordx4 v17, s[12:15], s19 offen lds
  v_mfma_f32_16x16x32_bf16 v[116:119], a[28:31], v[32:35], v[116:119]
  s_waitcnt lgkmcnt(5)
  v_mfma_f32_16x16x32_bf16 v[104:107], a[16:19], v[36:39], v[104:107]
  ds_read_b128 v[28:31], v9 offset:40960
  v_mfma_f32_16x16x32_bf16 v[108:111], a[20:23], v[36:39], v[108:111]
  v_mfma_f32_16x16x32_bf16 v[120:123], a[24:27], v[36:39], v[120:123]
  v_mfma_f32_16x16x32_bf16 v[124:127], a[28:31], v[36:39], v[124:127]
  s_waitcnt lgkmcnt(5)
  v_mfma_f32_16x16x32_bf16 v[96:99], a[32:35], v[40:43], v[96:99]
  s_add_u32 m0, s25, 2048
  ds_read_b128 v[32:35], v10 offset:40960
  v_mfma_f32_16x16x32_bf16 v[100:103], a[36:39], v[40:43], v[100:103]
  v_cvt_pk_bf16_f32 v132, v72, v73
  v_cvt_pk_bf16_f32 v133, v74, v75
  v_mfma_f32_16x16x32_bf16 v[112:115], a[40:43], v[40:43], v[112:115]
  buffer_load_dwordx4 v18, s[12:15], s19 offen lds
  v_mfma_f32_16x16x32_bf16 v[116:119], a[44:47], v[40:43], v[116:119]
  s_waitcnt lgkmcnt(5)
  v_cvt_pk_bf16_f32 v134, v76, v77
  v_cvt_pk_bf16_f32 v135, v78, v79
  v_mfma_f32_16x16x32_bf16 v[104:107], a[32:35], v[44:47], v[104:107]
  ds_read_b128 v[36:39], v11 offset:40960
  v_mfma_f32_16x16x32_bf16 v[108:111], a[36:39], v[44:47], v[108:111]
  v_mfma_f32_16x16x32_bf16 v[120:123], a[40:43], v[44:47], v[120:123]
  v_mfma_f32_16x16x32_bf16 v[124:127], a[44:47], v[44:47], v[124:127]
  s_waitcnt lgkmcnt(5)
  v_mfma_f32_16x16x32_bf16 v[96:99], a[48:51], v[48:51], v[96:99]
  s_add_u32 m0, s25, 3072
  ds_read_b128 v[40:43], v12 offset:40960
  v_mfma_f32_16x16x32_bf16 v[100:103], a[52:55], v[48:51], v[100:103]
  v_mfma_f32_16x16x32_bf16 v[112:115], a[56:59], v[48:51], v[112:115]
  buffer_load_dwordx4 v19, s[12:15], s19 offen lds
  v_mfma_f32_16x16x32_bf16 v[116:119], a[60:63], v[48:51], v[116:119]
  s_waitcnt lgkmcnt(5)
  v_mfma_f32_16x16x32_bf16 v[104:107], a[48:51], v[52:55], v[104:107]
  ds_read_b128 v[44:47], v13 offset:40960
  v_mfma_f32_16x16x32_bf16 v[108:111], a[52:55], v[52:55], v[108:111]
  v_cvt_pk_bf16_f32 v136, v80, v81
  v_cvt_pk_bf16_f32 v137, v82, v83
  v_mfma_f32_16x16x32_bf16 v[120:123], a[56:59], v[52:55], v[120:123]
  v_mfma_f32_16x16x32_bf16 v[124:127], a[60:63], v[52:55], v[124:127]
  s_waitcnt lgkmcnt(5)
  v_cvt_pk_bf16_f32 v138, v84, v85
  v_cvt_pk_bf16_f32 v139, v86, v87
  v_mfma_f32_16x16x32_bf16 v[96:99], a[64:67], v[24:27], v[96:99]
  s_add_u32 m0, s25, 4096
  ds_read_b128 v[48:51], v14 offset:40960
  v_mfma_f32_16x16x32_bf16 v[100:103], a[68:71], v[24:27], v[100:103]
  v_mfma_f32_16x16x32_bf16 v[112:115], a[72:75], v[24:27], v[112:115]
  buffer_load_dwordx4 v20, s[12:15], s19 offen lds
  v_mfma_f32_16x16x32_bf16 v[116:119], a[76:79], v[24:27], v[116:119]
  s_waitcnt lgkmcnt(5)
  v_mfma_f32_16x16x32_bf16 v[104:107], a[64:67], v[28:31], v[104:107]
  ds_read_b128 v[52:55], v15 offset:40960
  v_mfma_f32_16x16x32_bf16 v[108:111], a[68:71], v[28:31], v[108:111]
  v_mfma_f32_16x16x32_bf16 v[120:123], a[72:75], v[28:31], v[120:123]
  v_mfma_f32_16x16x32_bf16 v[124:127], a[76:79], v[28:31], v[124:127]
  s_waitcnt lgkmcnt(5)
  v_mfma_f32_16x16x32_bf16 v[96:99], a[80:83], v[32:35], v[96:99]
  s_add_u32 m0, s25, 5120
  ds_read_b128 v[24:27], v8 offset:49152
  v_mfma_f32_16x16x32_bf16 v[100:103], a[84:87], v[32:35], v[100:103]
  v_cvt_pk_bf16_f32 v140, v88, v89
  v_cvt_pk_bf16_f32 v141, v90, v91
  v_mfma_f32_16x16x32_bf16 v[112:115], a[88:91], v[32:35], v[112:115]
  buffer_load_dwordx4 v21, s[12:15], s19 offen lds
  v_mfma_f32_16x16x32_bf16 v[116:119], a[92:95], v[32:35], v[116:119]
  s_waitcnt lgkmcnt(5)
  v_cvt_pk_bf16_f32 v142, v92, v93
  v_cvt_pk_bf16_f32 v143, v94, v95
  v_mfma_f32_16x16x32_bf16 v[104:107], a[80:83], v[36:39], v[104:107]
  ds_read_b128 v[28:31], v9 offset:49152
  v_mfma_f32_16x16x32_bf16 v[108:111], a[84:87], v[36:39], v[108:111]
  v_mfma_f32_16x16x32_bf16 v[120:123], a[88:91], v[36:39], v[120:123]
  v_mfma_f32_16x16x32_bf16 v[124:127], a[92:95], v[36:39], v[124:127]
  s_waitcnt lgkmcnt(5)
  v_mfma_f32_16x16x32_bf16 v[96:99], a[96:99], v[40:43], v[96:99]
  s_add_u32 m0, s25, 6144
  ds_read_b128 v[32:35], v10 offset:49152
  v_mfma_f32_16x16x32_bf16 v[100:103], a[100:103], v[40:43], v[100:103]
  v_mfma_f32_16x16x32_bf16 v[112:115], a[104:107], v[40:43], v[112:115]
  buffer_load_dwordx4 v22, s[12:15], s19 offen lds
  v_mfma_f32_16x16x32_bf16 v[116:119], a[108:111], v[40:43], v[116:119]
  s_waitcnt lgkmcnt(5)
  v_mfma_f32_16x16x32_bf16 v[104:107], a[96:99], v[44:47], v[104:107]
  ds_read_b128 v[36:39], v11 offset:49152
  v_mfma_f32_16x16x32_bf16 v[108:111], a[100:103], v[44:47], v[108:111]
  v_mfma_f32_16x16x32_bf16 v[120:123], a[104:107], v[44:47], v[120:123]
  v_mfma_f32_16x16x32_bf16 v[124:127], a[108:111], v[44:47], v[124:127]
  s_waitcnt lgkmcnt(5)
  v_mfma_f32_16x16x32_bf16 v[96:99], a[112:115], v[48:51], v[96:99]
  s_add_u32 m0, s25, 7168
  ds_read_b128 v[40:43], v12 offset:49152
  v_mfma_f32_16x16x32_bf16 v[100:103], a[116:119], v[48:51], v[100:103]
  v_mfma_f32_16x16x32_bf16 v[112:115], a[120:123], v[48:51], v[112:115]
  buffer_load_dwordx4 v23, s[12:15], s19 offen lds
  v_mfma_f32_16x16x32_bf16 v[116:119], a[124:127], v[48:51], v[116:119]
  s_waitcnt lgkmcnt(5)
  v_mfma_f32_16x16x32_bf16 v[104:107], a[112:115], v[52:55], v[104:107]
  s_cmp_gt_u32 s23, 3
  ds_read_b128 v[44:47], v13 offset:49152
  v_mfma_f32_16x16x32_bf16 v[108:111], a[116:119], v[52:55], v[108:111]
  v_mfma_f32_16x16x32_bf16 v[120:123], a[120:123], v[52:55], v[120:123]
  s_cselect_b32 s26, s20, 0
  v_mfma_f32_16x16x32_bf16 v[124:127], a[124:127], v[52:55], v[124:127]
  s_waitcnt lgkmcnt(5)
  v_mfma_f32_16x16x32_bf16 v[96:99], a[128:131], v[24:27], v[96:99]
  s_add_u32 s19, s19, s26
  ds_read_b128 v[48:51], v14 offset:49152
  v_mfma_f32_16x16x32_bf16 v[100:103], a[132:135], v[24:27], v[100:103]
  v_mfma_f32_16x16x32_bf16 v[112:115], a[136:139], v[24:27], v[112:115]
  s_add_u32 s25, s25, 32768
  v_mfma_f32_16x16x32_bf16 v[116:119], a[140:143], v[24:27], v[116:119]
  s_waitcnt lgkmcnt(5)
  v_mfma_f32_16x16x32_bf16 v[104:107], a[128:131], v[28:31], v[104:107]
  s_and_b32 s25, s25, 0x1ffff
  ds_read_b128 v[52:55], v15 offset:49152
  v_mfma_f32_16x16x32_bf16 v[108:111], a[132:135], v[28:31], v[108:111]
  v_mfma_f32_16x16x32_bf16 v[120:123], a[136:139], v[28:31], v[120:123]
  buffer_store_dwordx4 v[128:131], v7, s[4:7], s21 offen offset:0 sc1
  v_mfma_f32_16x16x32_bf16 v[124:127], a[140:143], v[28:31], v[124:127]
  s_waitcnt lgkmcnt(5)
  v_mfma_f32_16x16x32_bf16 v[96:99], a[144:147], v[32:35], v[96:99]
  ds_read_b128 v[24:27], v8 offset:57344
  v_mfma_f32_16x16x32_bf16 v[100:103], a[148:151], v[32:35], v[100:103]
  v_mfma_f32_16x16x32_bf16 v[112:115], a[152:155], v[32:35], v[112:115]
  v_mfma_f32_16x16x32_bf16 v[116:119], a[156:159], v[32:35], v[116:119]
  s_waitcnt lgkmcnt(5)
  v_xor_b32 v8, 0x10000, v8
  v_mfma_f32_16x16x32_bf16 v[104:107], a[144:147], v[36:39], v[104:107]
  ds_read_b128 v[28:31], v9 offset:57344
  v_mfma_f32_16x16x32_bf16 v[108:111], a[148:151], v[36:39], v[108:111]
  v_mfma_f32_16x16x32_bf16 v[120:123], a[152:155], v[36:39], v[120:123]
  buffer_store_dwordx4 v[132:135], v7, s[4:7], s21 offen offset:256 sc1
  v_mfma_f32_16x16x32_bf16 v[124:127], a[156:159], v[36:39], v[124:127]
  s_waitcnt lgkmcnt(5)
  v_xor_b32 v9, 0x10000, v9
  v_mfma_f32_16x16x32_bf16 v[96:99], a[160:163], v[40:43], v[96:99]
  ds_read_b128 v[32:35], v10 offset:57344
  v_mfma_f32_16x16x32_bf16 v[100:103], a[164:167], v[40:43], v[100:103]
  v_mfma_f32_16x16x32_bf16 v[112:115], a[168:171], v[40:43], v[112:115]
  v_mfma_f32_16x16x32_bf16 v[116:119], a[172:175], v[40:43], v[116:119]
  s_waitcnt lgkmcnt(5)
  v_xor_b32 v10, 0x10000, v10
  v_mfma_f32_16x16x32_bf16 v[104:107], a[160:163], v[44:47], v[104:107]
  ds_read_b128 v[36:39], v11 offset:57344
  v_mfma_f32_16x16x32_bf16 v[108:111], a[164:167], v[44:47], v[108:111]
  v_mfma_f32_16x16x32_bf16 v[120:123], a[168:171], v[44:47], v[120:123]
  buffer_store_dwordx4 v[136:139], v7, s[4:7], s21 offen offset:2048 sc1
  v_mfma_f32_16x16x32_bf16 v[124:127], a[172:175], v[44:47], v[124:127]
  s_waitcnt lgkmcnt(5)
  v_xor_b32 v11, 0x10000, v11
  v_mfma_f32_16x16x32_bf16 v[96:99], a[176:179], v[48:51], v[96:99]
  ds_read_b128 v[40:43], v12 offset:57344
  v_mfma_f32_16x16x32_bf16 v[100:103], a[180:183], v[48:51], v[100:103]
  v_mfma_f32_16x16x32_bf16 v[112:115], a[184:187], v[48:51], v[112:115]
  v_mfma_f32_16x16x32_bf16 v[116:119], a[188:191], v[48:51], v[116:119]
  s_waitcnt lgkmcnt(5)
  v_xor_b32 v12, 0x10000, v12
  v_mfma_f32_16x16x32_bf16 v[104:107], a[176:179], v[52:55], v[104:107]
  ds_read_b128 v[44:47], v13 offset:57344
  v_mfma_f32_16x16x32_bf16 v[108:111], a[180:183], v[52:55], v[108:111]
  v_mfma_f32_16x16x32_bf16 v[120:123], a[184:187], v[52:55], v[120:123]
  buffer_store_dwordx4 v[140:143], v7, s[4:7], s21 offen offset:2304 sc1
  v_mfma_f32_16x16x32_bf16 v[124:127], a[188:191], v[52:55], v[124:127]
  s_waitcnt lgkmcnt(5)
  v_xor_b32 v13, 0x10000, v13
  v_mfma_f32_16x16x32_bf16 v[96:99], a[192:195], v[24:27], v[96:99]
  s_mov_b32 s21, s27
  ds_read_b128 v[48:51], v14 offset:57344
  v_mfma_f32_16x16x32_bf16 v[100:103], a[196:199], v[24:27], v[100:103]
  v_mov_b32 v7, v56
  v_mfma_f32_16x16x32_bf16 v[112:115], a[200:203], v[24:27], v[112:115]
  v_mfma_f32_16x16x32_bf16 v[116:119], a[204:207], v[24:27], v[116:119]
  s_waitcnt lgkmcnt(5)
  v_xor_b32 v14, 0x10000, v14
  v_mfma_f32_16x16x32_bf16 v[104:107], a[192:195], v[28:31], v[104:107]
  s_add_u32 s27, s27, s22
  ds_read_b128 v[52:55], v15 offset:57344
  v_mfma_f32_16x16x32_bf16 v[108:111], a[196:199], v[28:31], v[108:111]
  v_mfma_f32_16x16x32_bf16 v[120:123], a[200:203], v[28:31], v[120:123]
  s_waitcnt vmcnt(13)
  s_barrier
  v_mfma_f32_16x16x32_bf16 v[124:127], a[204:207], v[28:31], v[124:127]
  s_waitcnt lgkmcnt(5)
  v_xor_b32 v15, 0x10000, v15
  v_mfma_f32_16x16x32_bf16 v[96:99], a[208:211], v[32:35], v[96:99]
  ds_read_b128 v[24:27], v8 offset:0
  v_mfma_f32_16x16x32_bf16 v[100:103], a[212:215], v[32:35], v[100:103]
  v_mfma_f32_16x16x32_bf16 v[112:115], a[216:219], v[32:35], v[112:115]
  v_mfma_f32_16x16x32_bf16 v[116:119], a[220:223], v[32:35], v[116:119]
  s_waitcnt lgkmcnt(5)
  v_mfma_f32_16x16x32_bf16 v[104:107], a[208:211], v[36:39], v[104:107]
  s_add_u32 s29, s29, 1
  ds_read_b128 v[28:31], v9 offset:0
  v_mfma_f32_16x16x32_bf16 v[108:111], a[212:215], v[36:39], v[108:111]
  v_mfma_f32_16x16x32_bf16 v[120:123], a[216:219], v[36:39], v[120:123]
  s_max_i32 s30, s29, 0
  v_mfma_f32_16x16x32_bf16 v[124:127], a[220:223], v[36:39], v[124:127]
  s_waitcnt lgkmcnt(5)
  v_mov_b32 v144, s30
  v_mfma_f32_16x16x32_bf16 v[96:99], a[224:227], v[40:43], v[96:99]
  ds_read_b128 v[32:35], v10 offset:0
  v_mfma_f32_16x16x32_bf16 v[100:103], a[228:231], v[40:43], v[100:103]
  v_mfma_f32_16x16x32_bf16 v[112:115], a[232:235], v[40:43], v[112:115]
  buffer_store_dword v144, v145, s[4:7], s31 offen sc1
  v_mfma_f32_16x16x32_bf16 v[116:119], a[236:239], v[40:43], v[116:119]
  s_waitcnt lgkmcnt(5)
  v_mfma_f32_16x16x32_bf16 v[104:107], a[224:227], v[44:47], v[104:107]
  ds_read_b128 v[36:39], v11 offset:0
  v_mfma_f32_16x16x32_bf16 v[108:111], a[228:231], v[44:47], v[108:111]
  v_mfma_f32_16x16x32_bf16 v[120:123], a[232:235], v[44:47], v[120:123]
  v_mfma_f32_16x16x32_bf16 v[124:127], a[236:239], v[44:47], v[124:127]
  s_waitcnt lgkmcnt(5)
  v_mfma_f32_16x16x32_bf16 v[96:99], a[240:243], v[48:51], v[96:99]
  s_sub_u32 s23, s23, 1
  ds_read_b128 v[40:43], v12 offset:0
  v_mfma_f32_16x16x32_bf16 v[100:103], a[244:247], v[48:51], v[100:103]
  v_mfma_f32_16x16x32_bf16 v[112:115], a[248:251], v[48:51], v[112:115]
  v_mfma_f32_16x16x32_bf16 v[116:119], a[252:255], v[48:51], v[116:119]
  s_waitcnt lgkmcnt(5)
  v_mfma_f32_16x16x32_bf16 v[104:107], a[240:243], v[52:55], v[104:107]
  s_cmp_eq_u32 s23, 0
  ds_read_b128 v[44:47], v13 offset:0
  v_mfma_f32_16x16x32_bf16 v[108:111], a[244:247], v[52:55], v[108:111]
  v_mfma_f32_16x16x32_bf16 v[120:123], a[248:251], v[52:55], v[120:123]
  v_mfma_f32_16x16x32_bf16 v[124:127], a[252:255], v[52:55], v[124:127]
  s_cbranch_scc1 G_done1_135
  s_branch G_top_133
G_done0_134:
  s_nop 7
  s_nop 3
  v_cvt_pk_bf16_f32 v128, v64, v65
  v_cvt_pk_bf16_f32 v129, v66, v67
  v_cvt_pk_bf16_f32 v130, v68, v69
  v_cvt_pk_bf16_f32 v131, v70, v71
  buffer_store_dwordx4 v[128:131], v7, s[4:7], s21 offen offset:0 sc1
  v_cvt_pk_bf16_f32 v132, v72, v73
  v_cvt_pk_bf16_f32 v133, v74, v75
  v_cvt_pk_bf16_f32 v134, v76, v77
  v_cvt_pk_bf16_f32 v135, v78, v79
  buffer_store_dwordx4 v[132:135], v7, s[4:7], s21 offen offset:256 sc1
  v_cvt_pk_bf16_f32 v136, v80, v81
  v_cvt_pk_bf16_f32 v137, v82, v83
  v_cvt_pk_bf16_f32 v138, v84, v85
  v_cvt_pk_bf16_f32 v139, v86, v87
  buffer_store_dwordx4 v[136:139], v7, s[4:7], s21 offen offset:2048 sc1
  v_cvt_pk_bf16_f32 v140, v88, v89
  v_cvt_pk_bf16_f32 v141, v90, v91
  v_cvt_pk_bf16_f32 v142, v92, v93
  v_cvt_pk_bf16_f32 v143, v94, v95
  buffer_store_dwordx4 v[140:143], v7, s[4:7], s21 offen offset:2304 sc1
  s_branch G_fin_136
G_done1_135:
  s_nop 7
  s_nop 3
  v_cvt_pk_bf16_f32 v128, v96, v97
  v_cvt_pk_bf16_f32 v129, v98, v99
  v_cvt_pk_bf16_f32 v130, v100, v101
  v_cvt_pk_bf16_f32 v131, v102, v103
  buffer_store_dwordx4 v[128:131], v7, s[4:7], s21 offen offset:0 sc1
  v_cvt_pk_bf16_f32 v132, v104, v105
  v_cvt_pk_bf16_f32 v133, v106, v107
  v_cvt_pk_bf16_f32 v134, v108, v109
  v_cvt_pk_bf16_f32 v135, v110, v111
  buffer_store_dwordx4 v[132:135], v7, s[4:7], s21 offen offset:256 sc1
  v_cvt_pk_bf16_f32 v136, v112, v113
  v_cvt_pk_bf16_f32 v137, v114, v115
  v_cvt_pk_bf16_f32 v138, v116, v117
  v_cvt_pk_bf16_f32 v139, v118, v119
  buffer_store_dwordx4 v[136:139], v7, s[4:7], s21 offen offset:2048 sc1
  v_cvt_pk_bf16_f32 v140, v120, v121
  v_cvt_pk_bf16_f32 v141, v122, v123
  v_cvt_pk_bf16_f32 v142, v124, v125
  v_cvt_pk_bf16_f32 v143, v126, v127
  buffer_store_dwordx4 v[140:143], v7, s[4:7], s21 offen offset:2304 sc1
G_fin_136:
  s_waitcnt vmcnt(0) lgkmcnt(0)
  s_barrier
  s_add_u32 s30, s29, 2
  v_mov_b32 v144, s30
  v_min_u32 v145, 1, v0
  v_lshlrev_b32 v145, 30, v145
  buffer_store_dword v144, v145, s[4:7], s31 offen sc1
  s_branch P_end_131
P_q_132:
  s_mov_b32 s27, s21
  v_mov_b32 v7, 0x40000000
  s_mov_b32 s29, -2
  v_min_u32 v145, 1, v0
  v_lshlrev_b32 v145, 30, v145
  ds_read_b128 v[24:27], v8 offset:0
  ds_read_b128 v[28:31], v9 offset:0
  ds_read_b128 v[32:35], v10 offset:0
  ds_read_b128 v[36:39], v11 offset:0
  ds_read_b128 v[40:43], v12 offset:0
  ds_read_b128 v[44:47], v13 offset:0
.p2align 6
G_top_137:
  s_waitcnt lgkmcnt(5)
  v_mfma_f32_16x16x32_bf16 v[64:67], a[0:3], v[24:27], 0
  s_add_u32 m0, s25, 0
  ds_read_b128 v[48:51], v14 offset:0
  v_mfma_f32_16x16x32_bf16 v[68:71], a[4:7], v[24:27], 0
  v_mfma_f32_16x16x32_bf16 v[80:83], a[8:11], v[24:27], 0
  buffer_load_dwordx4 v16, s[12:15], s19 offen lds
  v_mfma_f32_16x16x32_bf16 v[84:87], a[12:15], v[24:27], 0
  s_waitcnt lgkmcnt(5)
  v_mfma_f32_16x16x32_bf16 v[72:75], a[0:3], v[28:31], 0
  ds_read_b128 v[52:55], v15 offset:0
  v_mfma_f32_16x16x32_bf16 v[76:79], a[4:7], v[28:31], 0
  v_mul_f32 v96, s24, v96
  v_mul_f32 v97, s24, v97
  v_mfma_f32_16x16x32_bf16 v[88:91], a[8:11], v[28:31], 0
  v_mfma_f32_16x16x32_bf16 v[92:95], a[12:15], v[28:31], 0
  s_waitcnt lgkmcnt(5)
  v_cvt_pk_bf16_f32 v128, v96, v97
  v_mul_f32 v98, s24, v98
  v_mfma_f32_16x16x32_bf16 v[64:67], a[16:19], v[32:35], v[64:67]
  s_add_u32 m0, s25, 1024
  ds_read_b128 v[24:27], v8 offset:8192
  v_mfma_f32_16x16x32_bf16 v[68:71], a[20:23], v[32:35], v[68:71]
  v_mul_f32 v99, s24, v99
  v_cvt_pk_bf16_f32 v129, v98, v99
  v_mfma_f32_16x16x32_bf16 v[80:83], a[24:27], v[32:35], v[80:83]
  buffer_load_dwordx4 v17, s[12:15], s19 offen lds
  v_mfma_f32_16x16x32_bf16 v[84:87], a[28:31], v[32:35], v[84:87]
  s_waitcnt lgkmcnt(5)
  v_mul_f32 v100, s24, v100
  v_mul_f32 v101, s24, v101
  v_mfma_f32_16x16x32_bf16 v[72:75], a[16:19], v[36:39], v[72:75]
  ds_read_b128 v[28:31], v9 offset:8192
  v_mfma_f32_16x16x32_bf16 v[76:79], a[20:23], v[36:39], v[76:79]
  v_cvt_pk_bf16_f32 v130, v100, v101
  v_mul_f32 v102, s24, v102
  v_mfma_f32_16x16x32_bf16 v[88:91], a[24:27], v[36:39], v[88:91]
  v_mfma_f32_16x16x32_bf16 v[92:95], a[28:31], v[36:39], v[92:95]
  s_waitcnt lgkmcnt(5)
  v_mul_f32 v103, s24, v103
  v_cvt_pk_bf16_f32 v131, v102, v103
  v_mfma_f32_16x16x32_bf16 v[64:67], a[32:35], v[40:43], v[64:67]
  s_add_u32 m0, s25, 2048
  ds_read_b128 v[32:35], v10 offset:8192
  v_mfma_f32_16x16x32_bf16 v[68:71], a[36:39], v[40:43], v[68:71]
  v_mul_f32 v104, s24, v104
  v_mul_f32 v105, s24, v105
  v_mfma_f32_16x16x32_bf16 v[80:83], a[40:43], v[40:43], v[80:83]
  buffer_load_dwordx4 v18, s[12:15], s19 offen lds
  v_mfma_f32_16x16x32_bf16 v[84:87], a[44:47], v[40:43], v[84:87]
  s_waitcnt lgkmcnt(5)
  v_cvt_pk_bf16_f32 v132, v104, v105
  v_mul_f32 v106, s24, v106
  v_mfma_f32_16x16x32_bf16 v[72:75], a[32:35], v[44:47], v[72:75]
  ds_read_b128 v[36:39], v11 offset:8192
  v_mfma_f32_16x16x32_bf16 v[76:79], a[36:39], v[44:47], v[76:79]
  v_mul_f32 v107, s24, v107
  v_cvt_pk_bf16_f32 v133, v106, v107
  v_mfma_f32_16x16x32_bf16 v[88:91], a[40:43], v[44:47], v[88:91]
  v_mfma_f32_16x16x32_bf16 v[92:95], a[44:47], v[44:47], v[92:95]
  s_waitcnt lgkmcnt(5)
  v_mul_f32 v108, s24, v108
  v_mul_f32 v109, s24, v109
  v_mfma_f32_16x16x32_bf16 v[64:67], a[48:51], v[48:51], v[64:67]
  s_add_u32 m0, s25, 3072
  ds_read_b128 v[40:43], v12 offset:8192
  v_mfma_f32_16x16x32_bf16 v[68:71], a[52:55], v[48:51], v[68:71]
  v_cvt_pk_bf16_f32 v134, v108, v109
  v_mul_f32 v110, s24, v110
  v_mfma_f32_16x16x32_bf16 v[80:83], a[56:59], v[48:51], v[80:83]
  buffer_load_dwordx4 v19, s[12:15], s19 offen lds
  v_mfma_f32_16x16x32_bf16 v[84:87], a[60:63], v[48:51], v[84:87]
  s_waitcnt lgkmcnt(5)
  v_mul_f32 v111, s24, v111
  v_cvt_pk_bf16_f32 v135, v110, v111
  v_mfma_f32_16x16x32_bf16 v[72:75], a[48:51], v[52:55], v[72:75]
  ds_read_b128 v[44:47], v13 offset:8192
  v_mfma_f32_16x16x32_bf16 v[76:79], a[52:55], v[52:55], v[76:79]
  v_mul_f32 v112, s24, v112
  v_mul_f32 v113, s24, v113
  v_mfma_f32_16x16x32_bf16 v[88:91], a[56:59], v[52:55], v[88:91]
  v_mfma_f32_16x16x32_bf16 v[92:95], a[60:63], v[52:55], v[92:95]
  s_waitcnt lgkmcnt(5)
  v_cvt_pk_bf16_f32 v136, v112, v113
  v_mul_f32 v114, s24, v114
  v_mfma_f32_16x16x32_bf16 v[64:67], a[64:67], v[24:27], v[64:67]
  s_add_u32 m0, s25, 4096
  ds_read_b128 v[48:51], v14 offset:8192
  v_mfma_f32_16x16x32_bf16 v[68:71], a[68:71], v[24:27], v[68:71]
  v_mul_f32 v115, s24, v115
  v_cvt_pk_bf16_f32 v137, v114, v115
  v_mfma_f32_16x16x32_bf16 v[80:83], a[72:75], v[24:27], v[80:83]
  buffer_load_dwordx4 v20, s[12:15], s19 offen lds
  v_mfma_f32_16x16x32_bf16 v[84:87], a[76:79], v[24:27], v[84:87]
  s_waitcnt lgkmcnt(5)
  v_mul_f32 v116, s24, v116
  v_mul_f32 v117, s24, v117
  v_mfma_f32_16x16x32_bf16 v[72:75], a[64:67], v[28:31], v[72:75]
  ds_read_b128 v[52:55], v15 offset:8192
  v_mfma_f32_16x16x32_bf16 v[76:79], a[68:71], v[28:31], v[76:79]
  v_cvt_pk_bf16_f32 v138, v116, v117
  v_mul_f32 v118, s24, v118
  v_mfma_f32_16x16x32_bf16 v[88:91], a[72:75], v[28:31], v[88:91]
  v_mfma_f32_16x16x32_bf16 v[92:95], a[76:79], v[28:31], v[92:95]
  s_waitcnt lgkmcnt(5)
  v_mul_f32 v119, s24, v119
  v_cvt_pk_bf16_f32 v139, v118, v119
  v_mfma_f32_16x16x32_bf16 v[64:67], a[80:83], v[32:35], v[64:67]
  s_add_u32 m0, s25, 5120
  ds_read_b128 v[24:27], v8 offset:16384
  v_mfma_f32_16x16x32_bf16 v[68:71], a[84:87], v[32:35], v[68:71]
  v_mul_f32 v120, s24, v120
  v_mul_f32 v121, s24, v121
  v_mfma_f32_16x16x32_bf16 v[80:83], a[88:91], v[32:35], v[80:83]
  buffer_load_dwordx4 v21, s[12:15], s19 offen lds
  v_mfma_f32_16x16x32_bf16 v[84:87], a[92:95], v[32:35], v[84:87]
  s_waitcnt lgkmcnt(5)
  v_cvt_pk_bf16_f32 v140, v120, v121
  v_mul_f32 v122, s24, v122
  v_mfma_f32_16x16x32_bf16 v[72:75], a[80:83], v[36:39], v[72:75]
  ds_read_b128 v[28:31], v9 offset:16384
  v_mfma_f32_16x16x32_bf16 v[76:79], a[84:87], v[36:39], v[76:79]
  v_mul_f32 v123, s24, v123
  v_cvt_pk_bf16_f32 v141, v122, v123
  v_mfma_f32_16x16x32_bf16 v[88:91], a[88:91], v[36:39], v[88:91]
  v_mfma_f32_16x16x32_bf16 v[92:95], a[92:95], v[36:39], v[92:95]
  s_waitcnt lgkmcnt(5)
  v_mul_f32 v124, s24, v124
  v_mul_f32 v125, s24, v125
  v_mfma_f32_16x16x32_bf16 v[64:67], a[96:99], v[40:43], v[64:67]
  s_add_u32 m0, s25, 6144
  ds_read_b128 v[32:35], v10 offset:16384
  v_mfma_f32_16x16x32_bf16 v[68:71], a[100:103], v[40:43], v[68:71]
  v_cvt_pk_bf16_f32 v142, v124, v125
  v_mul_f32 v126, s24, v126
  v_mfma_f32_16x16x32_bf16 v[80:83], a[104:107], v[40:43], v[80:83]
  buffer_load_dwordx4 v22, s[12:15], s19 offen lds
  v_mfma_f32_16x16x32_bf16 v[84:87], a[108:111], v[40:43], v[84:87]
  s_waitcnt lgkmcnt(5)
  v_mul_f32 v127, s24, v127
  v_cvt_pk_bf16_f32 v143, v126, v127
  v_mfma_f32_16x16x32_bf16 v[72:75], a[96:99], v[44:47], v[72:75]
  ds_read_b128 v[36:39], v11 offset:16384
  v_mfma_f32_16x16x32_bf16 v[76:79], a[100:103], v[44:47], v[76:79]
  v_mfma_f32_16x16x32_bf16 v[88:91], a[104:107], v[44:47], v[88:91]
  v_mfma_f32_16x16x32_bf16 v[92:95], a[108:111], v[44:47], v[92:95]
  s_waitcnt lgkmcnt(5)
  v_mfma_f32_16x16x32_bf16 v[64:67], a[112:115], v[48:51], v[64:67]
  s_add_u32 m0, s25, 7168
  ds_read_b128 v[40:43], v12 offset:16384
  v_mfma_f32_16x16x32_bf16 v[68:71], a[116:119], v[48:51], v[68:71]
  v_mfma_f32_16x16x32_bf16 v[80:83], a[120:123], v[48:51], v[80:83]
  buffer_load_dwordx4 v23, s[12:15], s19 offen lds
  v_mfma_f32_16x16x32_bf16 v[84:87], a[124:127], v[48:51], v[84:87]
  s_waitcnt lgkmcnt(5)
  v_mfma_f32_16x16x32_bf16 v[72:75], a[112:115], v[52:55], v[72:75]
  s_cmp_gt_u32 s23, 3
  ds_read_b128 v[44:47], v13 offset:16384
  v_mfma_f32_16x16x32_bf16 v[76:79], a[116:119], v[52:55], v[76:79]
  v_mfma_f32_16x16x32_bf16 v[88:91], a[120:123], v[52:55], v[88:91]
  s_cselect_b32 s26, s20, 0
  v_mfma_f32_16x16x32_bf16 v[92:95], a[124:127], v[52:55], v[92:95]
  s_waitcnt lgkmcnt(5)
  v_mfma_f32_16x16x32_bf16 v[64:67], a[128:131], v[24:27], v[64:67]
  s_add_u32 s19, s19, s26
  ds_read_b128 v[48:51], v14 offset:16384
  v_mfma_f32_16x16x32_bf16 v[68:71], a[132:135], v[24:27], v[68:71]
  v_mfma_f32_16x16x32_bf16 v[80:83], a[136:139], v[24:27], v[80:83]
  s_add_u32 s25, s25, 32768
  v_mfma_f32_16x16x32_bf16 v[84:87], a[140:143], v[24:27], v[84:87]
  s_waitcnt lgkmcnt(5)
  v_mfma_f32_16x16x32_bf16 v[72:75], a[128:131], v[28:31], v[72:75]
  s_and_b32 s25, s25, 0x1ffff
  ds_read_b128 v[52:55], v15 offset:16384
  v_mfma_f32_16x16x32_bf16 v[76:79], a[132:135], v[28:31], v[76:79]
  v_mfma_f32_16x16x32_bf16 v[88:91], a[136:139], v[28:31], v[88:91]
  buffer_store_dwordx4 v[128:131], v7, s[4:7], s21 offen offset:0 sc1
  v_mfma_f32_16x16x32_bf16 v[92:95], a[140:143], v[28:31], v[92:95]
  s_waitcnt lgkmcnt(5)
  v_mfma_f32_16x16x32_bf16 v[64:67], a[144:147], v[32:35], v[64:67]
  ds_read_b128 v[24:27], v8 offset:24576
  v_mfma_f32_16x16x32_bf16 v[68:71], a[148:151], v[32:35], v[68:71]
  v_mfma_f32_16x16x32_bf16 v[80:83], a[152:155], v[32:35], v[80:83]
  v_mfma_f32_16x16x32_bf16 v[84:87], a[156:159], v[32:35], v[84:87]
  s_waitcnt lgkmcnt(5)
  v_mfma_f32_16x16x32_bf16 v[72:75], a[144:147], v[36:39], v[72:75]
  ds_read_b128 v[28:31], v9 offset:24576
  v_mfma_f32_16x16x32_bf16 v[76:79], a[148:151], v[36:39], v[76:79]
  v_mfma_f32_16x16x32_bf16 v[88:91], a[152:155], v[36:39], v[88:91]
  buffer_store_dwordx4 v[132:135], v7, s[4:7], s21 offen offset:256 sc1
  v_mfma_f32_16x16x32_bf16 v[92:95], a[156:159], v[36:39], v[92:95]
  s_waitcnt lgkmcnt(5)
  v_mfma_f32_16x16x32_bf16 v[64:67], a[160:163], v[40:43], v[64:67]
  ds_read_b128 v[32:35], v10 offset:24576
  v_mfma_f32_16x16x32_bf16 v[68:71], a[164:167], v[40:43], v[68:71]
  v_mfma_f32_16x16x32_bf16 v[80:83], a[168:171], v[40:43], v[80:83]
  v_mfma_f32_16x16x32_bf16 v[84:87], a[172:175], v[40:43], v[84:87]
  s_waitcnt lgkmcnt(5)
  v_mfma_f32_16x16x32_bf16 v[72:75], a[160:163], v[44:47], v[72:75]
  ds_read_b128 v[36:39], v11 offset:24576
  v_mfma_f32_16x16x32_bf16 v[76:79], a[164:167], v[44:47], v[76:79]
  v_mfma_f32_16x16x32_bf16 v[88:91], a[168:171], v[44:47], v[88:91]
  buffer_store_dwordx4 v[136:139], v7, s[4:7], s21 offen offset:2048 sc1
  v_mfma_f32_16x16x32_bf16 v[92:95], a[172:175], v[44:47], v[92:95]
  s_waitcnt lgkmcnt(5)
  v_mfma_f32_16x16x32_bf16 v[64:67], a[176:179], v[48:51], v[64:67]
  ds_read_b128 v[40:43], v12 offset:24576
  v_mfma_f32_16x16x32_bf16 v[68:71], a[180:183], v[48:51], v[68:71]
  v_mfma_f32_16x16x32_bf16 v[80:83], a[184:187], v[48:51], v[80:83]
  v_mfma_f32_16x16x32_bf16 v[84:87], a[188:191], v[48:51], v[84:87]
  s_waitcnt lgkmcnt(5)
  v_mfma_f32_16x16x32_bf16 v[72:75], a[176:179], v[52:55], v[72:75]
  ds_read_b128 v[44:47], v13 offset:24576
  v_mfma_f32_16x16x32_bf16 v[76:79], a[180:183], v[52:55], v[76:79]
  v_mfma_f32_16x16x32_bf16 v[88:91], a[184:187], v[52:55], v[88:91]
  buffer_store_dwordx4 v[140:143], v7, s[4:7], s21 offen offset:2304 sc1
  v_mfma_f32_16x16x32_bf16 v[92:95], a[188:191], v[52:55], v[92:95]
  s_waitcnt lgkmcnt(5)
  v_mfma_f32_16x16x32_bf16 v[64:67], a[192:195], v[24:27], v[64:67]
  s_mov_b32 s21, s27
  ds_read_b128 v[48:51], v14 offset:24576
  v_mfma_f32_16x16x32_bf16 v[68:71], a[196:199], v[24:27], v[68:71]
  v_mov_b32 v7, v56
  v_mfma_f32_16x16x32_bf16 v[80:83], a[200:203], v[24:27], v[80:83]
  v_mfma_f32_16x16x32_bf16 v[84:87], a[204:207], v[24:27], v[84:87]
  s_waitcnt lgkmcnt(5)
  v_mfma_f32_16x16x32_bf16 v[72:75], a[192:195], v[28:31], v[72:75]
  s_add_u32 s27, s27, s22
  ds_read_b128 v[52:55], v15 offset:24576
  v_mfma_f32_16x16x32_bf16 v[76:79], a[196:199], v[28:31], v[76:79]
  v_mfma_f32_16x16x32_bf16 v[88:91], a[200:203], v[28:31], v[88:91]
  s_waitcnt vmcnt(13)
  s_barrier
  v_mfma_f32_16x16x32_bf16 v[92:95], a[204:207], v[28:31], v[92:95]
  s_waitcnt lgkmcnt(5)
  v_mfma_f32_16x16x32_bf16 v[64:67], a[208:211], v[32:35], v[64:67]
  ds_read_b128 v[24:27], v8 offset:32768
  v_mfma_f32_16x16x32_bf16 v[68:71], a[212:215], v[32:35], v[68:71]
  v_mfma_f32_16x16x32_bf16 v[80:83], a[216:219], v[32:35], v[80:83]
  v_mfma_f32_16x16x32_bf16 v[84:87], a[220:223], v[32:35], v[84:87]
  s_waitcnt lgkmcnt(5)
  v_mfma_f32_16x16x32_bf16 v[72:75], a[208:211], v[36:39], v[72:75]
  s_add_u32 s29, s29, 1
  ds_read_b128 v[28:31], v9 offset:32768
  v_mfma_f32_16x16x32_bf16 v[76:79], a[212:215], v[36:39], v[76:79]
  v_mfma_f32_16x16x32_bf16 v[88:91], a[216:219], v[36:39], v[88:91]
  s_max_i32 s30, s29, 0
  v_mfma_f32_16x16x32_bf16 v[92:95], a[220:223], v[36:39], v[92:95]
  s_waitcnt lgkmcnt(5)
  v_mov_b32 v144, s30
  v_mfma_f32_16x16x32_bf16 v[64:67], a[224:227], v[40:43], v[64:67]
  ds_read_b128 v[32:35], v10 offset:32768
  v_mfma_f32_16x16x32_bf16 v[68:71], a[228:231], v[40:43], v[68:71]
  v_mfma_f32_16x16x32_bf16 v[80:83], a[232:235], v[40:43], v[80:83]
  buffer_store_dword v144, v145, s[4:7], s31 offen sc1
  v_mfma_f32_16x16x32_bf16 v[84:87], a[236:239], v[40:43], v[84:87]
  s_waitcnt lgkmcnt(5)
  v_mfma_f32_16x16x32_bf16 v[72:75], a[224:227], v[44:47], v[72:75]
  ds_read_b128 v[36:39], v11 offset:32768
  v_mfma_f32_16x16x32_bf16 v[76:79], a[228:231], v[44:47], v[76:79]
  v_mfma_f32_16x16x32_bf16 v[88:91], a[232:235], v[44:47], v[88:91]
  v_mfma_f32_16x16x32_bf16 v[92:95], a[236:239], v[44:47], v[92:95]
  s_waitcnt lgkmcnt(5)
  v_mfma_f32_16x16x32_bf16 v[64:67], a[240:243], v[48:51], v[64:67]
  s_sub_u32 s23, s23, 1
  ds_read_b128 v[40:43], v12 offset:32768
  v_mfma_f32_16x16x32_bf16 v[68:71], a[244:247], v[48:51], v[68:71]
  v_mfma_f32_16x16x32_bf16 v[80:83], a[248:251], v[48:51], v[80:83]
  v_mfma_f32_16x16x32_bf16 v[84:87], a[252:255], v[48:51], v[84:87]
  s_waitcnt lgkmcnt(5)
  v_mfma_f32_16x16x32_bf16 v[72:75], a[240:243], v[52:55], v[72:75]
  s_cmp_eq_u32 s23, 0
  ds_read_b128 v[44:47], v13 offset:32768
  v_mfma_f32_16x16x32_bf16 v[76:79], a[244:247], v[52:55], v[76:79]
  v_mfma_f32_16x16x32_bf16 v[88:91], a[248:251], v[52:55], v[88:91]
  v_mfma_f32_16x16x32_bf16 v[92:95], a[252:255], v[52:55], v[92:95]
  s_cbranch_scc1 G_done0_138
  s_waitcnt lgkmcnt(5)
  v_mfma_f32_16x16x32_bf16 v[96:99], a[0:3], v[24:27], 0
  s_add_u32 m0, s25, 0
  ds_read_b128 v[48:51], v14 offset:32768
  v_mfma_f32_16x16x32_bf16 v[100:103], a[4:7], v[24:27], 0
  v_mfma_f32_16x16x32_bf16 v[112:115], a[8:11], v[24:27], 0
  buffer_load_dwordx4 v16, s[12:15], s19 offen lds
  v_mfma_f32_16x16x32_bf16 v[116:119], a[12:15], v[24:27], 0
  s_waitcnt lgkmcnt(5)
  v_mfma_f32_16x16x32_bf16 v[104:107], a[0:3], v[28:31], 0
  ds_read_b128 v[52:55], v15 offset:32768
  v_mfma_f32_16x16x32_bf16 v[108:111], a[4:7], v[28:31], 0
  v_mul_f32 v64, s24, v64
  v_mul_f32 v65, s24, v65
  v_mfma_f32_16x16x32_bf16 v[120:123], a[8:11], v[28:31], 0
  v_mfma_f32_16x16x32_bf16 v[124:127], a[12:15], v[28:31], 0
  s_waitcnt lgkmcnt(5)
  v_cvt_pk_bf16_f32 v128, v64, v65
  v_mul_f32 v66, s24, v66
  v_mfma_f32_16x16x32_bf16 v[96:99], a[16:19], v[32:35], v[96:99]
  s_add_u32 m0, s25, 1024
  ds_read_b128 v[24:27], v8 offset:40960
  v_mfma_f32_16x16x32_bf16 v[100:103], a[20:23], v[32:35], v[100:103]
  v_mul_f32 v67, s24, v67
  v_cvt_pk_bf16_f32 v129, v66, v67
  v_mfma_f32_16x16x32_bf16 v[112:115], a[24:27], v[32:35], v[112:115]
  buffer_load_dwordx4 v17, s[12:15], s19 offen lds
  v_mfma_f32_16x16x32_bf16 v[116:119], a[28:31], v[32:35], v[116:119]
  s_waitcnt lgkmcnt(5)
  v_mul_f32 v68, s24, v68
  v_mul_f32 v69, s24, v69
  v_mfma_f32_16x16x32_bf16 v[104:107], a[16:19], v[36:39], v[104:107]
  ds_read_b128 v[28:31], v9 offset:40960
  v_mfma_f32_16x16x32_bf16 v[108:111], a[20:23], v[36:39], v[108:111]
  v_cvt_pk_bf16_f32 v130, v68, v69
  v_mul_f32 v70, s24, v70
  v_mfma_f32_16x16x32_bf16 v[120:123], a[24:27], v[36:39], v[120:123]
  v_mfma_f32_16x16x32_bf16 v[124:127], a[28:31], v[36:39], v[124:127]
  s_waitcnt lgkmcnt(5)
  v_mul_f32 v71, s24, v71
  v_cvt_pk_bf16_f32 v131, v70, v71
  v_mfma_f32_16x16x32_bf16 v[96:99], a[32:35], v[40:43], v[96:99]
  s_add_u32 m0, s25, 2048
  ds_read_b128 v[32:35], v10 offset:40960
  v_mfma_f32_16x16x32_bf16 v[100:103], a[36:39], v[40:43], v[100:103]
  v_mul_f32 v72, s24, v72
  v_mul_f32 v73, s24, v73
  v_mfma_f32_16x16x32_bf16 v[112:115], a[40:43], v[40:43], v[112:115]
  buffer_load_dwordx4 v18, s[12:15], s19 offen lds
  v_mfma_f32_16x16x32_bf16 v[116:119], a[44:47], v[40:43], v[116:119]
  s_waitcnt lgkmcnt(5)
  v_cvt_pk_bf16_f32 v132, v72, v73
  v_mul_f32 v74, s24, v74
  v_mfma_f32_16x16x32_bf16 v[104:107], a[32:35], v[44:47], v[104:107]
  ds_read_b128 v[36:39], v11 offset:40960
  v_mfma_f32_16x16x32_bf16 v[108:111], a[36:39], v[44:47], v[108:111]
  v_mul_f32 v75, s24, v75
  v_cvt_pk_bf16_f32 v133, v74, v75
  v_mfma_f32_16x16x32_bf16 v[120:123], a[40:43], v[44:47], v[120:123]
  v_mfma_f32_16x16x32_bf16 v[124:127], a[44:47], v[44:47], v[124:127]
  s_waitcnt lgkmcnt(5)
  v_mul_f32 v76, s24, v76
  v_mul_f32 v77, s24, v77
  v_mfma_f32_16x16x32_bf16 v[96:99], a[48:51], v[48:51], v[96:99]
  s_add_u32 m0, s25, 3072
  ds_read_b128 v[40:43], v12 offset:40960
  v_mfma_f32_16x16x32_bf16 v[100:103], a[52:55], v[48:51], v[100:103]
  v_cvt_pk_bf16_f32 v134, v76, v77
  v_mul_f32 v78, s24, v78
  v_mfma_f32_16x16x32_bf16 v[112:115], a[56:59], v[48:51], v[112:115]
  buffer_load_dwordx4 v19, s[12:15], s19 offen lds
  v_mfma_f32_16x16x32_bf16 v[116:119], a[60:63], v[48:51], v[116:119]
  s_waitcnt lgkmcnt(5)
  v_mul_f32 v79, s24, v79
  v_cvt_pk_bf16_f32 v135, v78, v79
  v_mfma_f32_16x16x32_bf16 v[104:107], a[48:51], v[52:55], v[104:107]
  ds_read_b128 v[44:47], v13 offset:40960
  v_mfma_f32_16x16x32_bf16 v[108:111], a[52:55], v[52:55], v[108:111]
  v_mul_f32 v80, s24, v80
  v_mul_f32 v81, s24, v81
  v_mfma_f32_16x16x32_bf16 v[120:123], a[56:59], v[52:55], v[120:123]
  v_mfma_f32_16x16x32_bf16 v[124:127], a[60:63], v[52:55], v[124:127]
  s_waitcnt lgkmcnt(5)
  v_cvt_pk_bf16_f32 v136, v80, v81
  v_mul_f32 v82, s24, v82
  v_mfma_f32_16x16x32_bf16 v[96:99], a[64:67], v[24:27], v[96:99]
  s_add_u32 m0, s25, 4096
  ds_read_b128 v[48:51], v14 offset:40960
  v_mfma_f32_16x16x32_bf16 v[100:103], a[68:71], v[24:27], v[100:103]
  v_mul_f32 v83, s24, v83
  v_cvt_pk_bf16_f32 v137, v82, v83
  v_mfma_f32_16x16x32_bf16 v[112:115], a[72:75], v[24:27], v[112:115]
  buffer_load_dwordx4 v20, s[12:15], s19 offen lds
  v_mfma_f32_16x16x32_bf16 v[116:119], a[76:79], v[24:27], v[116:119]
  s_waitcnt lgkmcnt(5)
  v_mul_f32 v84, s24, v84
  v_mul_f32 v85, s24, v85
  v_mfma_f32_16x16x32_bf16 v[104:107], a[64:67], v[28:31], v[104:107]
  ds_read_b128 v[52:55], v15 offset:40960
  v_mfma_f32_16x16x32_bf16 v[108:111], a[68:71], v[28:31], v[108:111]
  v_cvt_pk_bf16_f32 v138, v84, v85
  v_mul_f32 v86, s24, v86
  v_mfma_f32_16x16x32_bf16 v[120:123], a[72:75], v[28:31], v[120:123]
  v_mfma_f32_16x16x32_bf16 v[124:127], a[76:79], v[28:31], v[124:127]
  s_waitcnt lgkmcnt(5)
  v_mul_f32 v87, s24, v87
  v_cvt_pk_bf16_f32 v139, v86, v87
  v_mfma_f32_16x16x32_bf16 v[96:99], a[80:83], v[32:35], v[96:99]
  s_add_u32 m0, s25, 5120
  ds_read_b128 v[24:27], v8 offset:49152
  v_mfma_f32_16x16x32_bf16 v[100:103], a[84:87], v[32:35], v[100:103]
  v_mul_f32 v88, s24, v88
  v_mul_f32 v89, s24, v89
  v_mfma_f32_16x16x32_bf16 v[112:115], a[88:91], v[32:35], v[112:115]
  buffer_load_dwordx4 v21, s[12:15], s19 offen lds
  v_mfma_f32_16x16x32_bf16 v[116:119], a[92:95], v[32:35], v[116:119]
  s_waitcnt lgkmcnt(5)
  v_cvt_pk_bf16_f32 v140, v88, v89
  v_mul_f32 v90, s24, v90
  v_mfma_f32_16x16x32_bf16 v[104:107], a[80:83], v[36:39], v[104:107]
  ds_read_b128 v[28:31], v9 offset:49152
  v_mfma_f32_16x16x32_bf16 v[108:111], a[84:87], v[36:39], v[108:111]
  v_mul_f32 v91, s24, v91
  v_cvt_pk_bf16_f32 v141, v90, v91
  v_mfma_f32_16x16x32_bf16 v[120:123], a[88:91], v[36:39], v[120:123]
  v_mfma_f32_16x16x32_bf16 v[124:127], a[92:95], v[36:39], v[124:127]
  s_waitcnt lgkmcnt(5)
  v_mul_f32 v92, s24, v92
  v_mul_f32 v93, s24, v93
  v_mfma_f32_16x16x32_bf16 v[96:99], a[96:99], v[40:43], v[96:99]
  s_add_u32 m0, s25, 6144
  ds_read_b128 v[32:35], v10 offset:49152
  v_mfma_f32_16x16x32_bf16 v[100:103], a[100:103], v[40:43], v[100:103]
  v_cvt_pk_bf16_f32 v142, v92, v93
  v_mul_f32 v94, s24, v94
  v_mfma_f32_16x16x32_bf16 v[112:115], a[104:107], v[40:43], v[112:115]
  buffer_load_dwordx4 v22, s[12:15], s19 offen lds
  v_mfma_f32_16x16x32_bf16 v[116:119], a[108:111], v[40:43], v[116:119]
  s_waitcnt lgkmcnt(5)
  v_mul_f32 v95, s24, v95
  v_cvt_pk_bf16_f32 v143, v94, v95
  v_mfma_f32_16x16x32_bf16 v[104:107], a[96:99], v[44:47], v[104:107]
  ds_read_b128 v[36:39], v11 offset:49152
  v_mfma_f32_16x16x32_bf16 v[108:111], a[100:103], v[44:47], v[108:111]
  v_mfma_f32_16x16x32_bf16 v[120:123], a[104:107], v[44:47], v[120:123]
  v_mfma_f32_16x16x32_bf16 v[124:127], a[108:111], v[44:47], v[124:127]
  s_waitcnt lgkmcnt(5)
  v_mfma_f32_16x16x32_bf16 v[96:99], a[112:115], v[48:51], v[96:99]
  s_add_u32 m0, s25, 7168
  ds_read_b128 v[40:43], v12 offset:49152
  v_mfma_f32_16x16x32_bf16 v[100:103], a[116:119], v[48:51], v[100:103]
  v_mfma_f32_16x16x32_bf16 v[112:115], a[120:123], v[48:51], v[112:115]
  buffer_load_dwordx4 v23, s[12:15], s19 offen lds
  v_mfma_f32_16x16x32_bf16 v[116:119], a[124:127], v[48:51], v[116:119]
  s_waitcnt lgkmcnt(5)
  v_mfma_f32_16x16x32_bf16 v[104:107], a[112:115], v[52:55], v[104:107]
  s_cmp_gt_u32 s23, 3
  ds_read_b128 v[44:47], v13 offset:49152
  v_mfma_f32_16x16x32_bf16 v[108:111], a[116:119], v[52:55], v[108:111]
  v_mfma_f32_16x16x32_bf16 v[120:123], a[120:123], v[52:55], v[120:123]
  s_cselect_b32 s26, s20, 0
  v_mfma_f32_16x16x32_bf16 v[124:127], a[124:127], v[52:55], v[124:127]
  s_waitcnt lgkmcnt(5)
  v_mfma_f32_16x16x32_bf16 v[96:99], a[128:131], v[24:27], v[96:99]
  s_add_u32 s19, s19, s26
  ds_read_b128 v[48:51], v14 offset:49152
  v_mfma_f32_16x16x32_bf16 v[100:103], a[132:135], v[24:27], v[100:103]
  v_mfma_f32_16x16x32_bf16 v[112:115], a[136:139], v[24:27], v[112:115]
  s_add_u32 s25, s25, 32768
  v_mfma_f32_16x16x32_bf16 v[116:119], a[140:143], v[24:27], v[116:119]
  s_waitcnt lgkmcnt(5)
  v_mfma_f32_16x16x32_bf16 v[104:107], a[128:131], v[28:31], v[104:107]
  s_and_b32 s25, s25, 0x1ffff
  ds_read_b128 v[52:55], v15 offset:49152
  v_mfma_f32_16x16x32_bf16 v[108:111], a[132:135], v[28:31], v[108:111]
  v_mfma_f32_16x16x32_bf16 v[120:123], a[136:139], v[28:31], v[120:123]
  buffer_store_dwordx4 v[128:131], v7, s[4:7], s21 offen offset:0 sc1
  v_mfma_f32_16x16x32_bf16 v[124:127], a[140:143], v[28:31], v[124:127]
  s_waitcnt lgkmcnt(5)
  v_mfma_f32_16x16x32_bf16 v[96:99], a[144:147], v[32:35], v[96:99]
  ds_read_b128 v[24:27], v8 offset:57344
  v_mfma_f32_16x16x32_bf16 v[100:103], a[148:151], v[32:35], v[100:103]
  v_mfma_f32_16x16x32_bf16 v[112:115], a[152:155], v[32:35], v[112:115]
  v_mfma_f32_16x16x32_bf16 v[116:119], a[156:159], v[32:35], v[116:119]
  s_waitcnt lgkmcnt(5)
  v_xor_b32 v8, 0x10000, v8
  v_mfma_f32_16x16x32_bf16 v[104:107], a[144:147], v[36:39], v[104:107]
  ds_read_b128 v[28:31], v9 offset:57344
  v_mfma_f32_16x16x32_bf16 v[108:111], a[148:151], v[36:39], v[108:111]
  v_mfma_f32_16x16x32_bf16 v[120:123], a[152:155], v[36:39], v[120:123]
  buffer_store_dwordx4 v[132:135], v7, s[4:7], s21 offen offset:256 sc1
  v_mfma_f32_16x16x32_bf16 v[124:127], a[156:159], v[36:39], v[124:127]
  s_waitcnt lgkmcnt(5)
  v_xor_b32 v9, 0x10000, v9
  v_mfma_f32_16x16x32_bf16 v[96:99], a[160:163], v[40:43], v[96:99]
  ds_read_b128 v[32:35], v10 offset:57344
  v_mfma_f32_16x16x32_bf16 v[100:103], a[164:167], v[40:43], v[100:103]
  v_mfma_f32_16x16x32_bf16 v[112:115], a[168:171], v[40:43], v[112:115]
  v_mfma_f32_16x16x32_bf16 v[116:119], a[172:175], v[40:43], v[116:119]
  s_waitcnt lgkmcnt(5)
  v_xor_b32 v10, 0x10000, v10
  v_mfma_f32_16x16x32_bf16 v[104:107], a[160:163], v[44:47], v[104:107]
  ds_read_b128 v[36:39], v11 offset:57344
  v_mfma_f32_16x16x32_bf16 v[108:111], a[164:167], v[44:47], v[108:111]
  v_mfma_f32_16x16x32_bf16 v[120:123], a[168:171], v[44:47], v[120:123]
  buffer_store_dwordx4 v[136:139], v7, s[4:7], s21 offen offset:2048 sc1
  v_mfma_f32_16x16x32_bf16 v[124:127], a[172:175], v[44:47], v[124:127]
  s_waitcnt lgkmcnt(5)
  v_xor_b32 v11, 0x10000, v11
  v_mfma_f32_16x16x32_bf16 v[96:99], a[176:179], v[48:51], v[96:99]
  ds_read_b128 v[40:43], v12 offset:57344
  v_mfma_f32_16x16x32_bf16 v[100:103], a[180:183], v[48:51], v[100:103]
  v_mfma_f32_16x16x32_bf16 v[112:115], a[184:187], v[48:51], v[112:115]
  v_mfma_f32_16x16x32_bf16 v[116:119], a[188:191], v[48:51], v[116:119]
  s_waitcnt lgkmcnt(5)
  v_xor_b32 v12, 0x10000, v12
  v_mfma_f32_16x16x32_bf16 v[104:107], a[176:179], v[52:55], v[104:107]
  ds_read_b128 v[44:47], v13 offset:57344
  v_mfma_f32_16x16x32_bf16 v[108:111], a[180:183], v[52:55], v[108:111]
  v_mfma_f32_16x16x32_bf16 v[120:123], a[184:187], v[52:55], v[120:123]
  buffer_store_dwordx4 v[140:143], v7, s[4:7], s21 offen offset:2304 sc1
  v_mfma_f32_16x16x32_bf16 v[124:127], a[188:191], v[52:55], v[124:127]
  s_waitcnt lgkmcnt(5)
  v_xor_b32 v13, 0x10000, v13
  v_mfma_f32_16x16x32_bf16 v[96:99], a[192:195], v[24:27], v[96:99]
  s_mov_b32 s21, s27
  ds_read_b128 v[48:51], v14 offset:57344
  v_mfma_f32_16x16x32_bf16 v[100:103], a[196:199], v[24:27], v[100:103]
  v_mov_b32 v7, v56
  v_mfma_f32_16x16x32_bf16 v[112:115], a[200:203], v[24:27], v[112:115]
  v_mfma_f32_16x16x32_bf16 v[116:119], a[204:207], v[24:27], v[116:119]
  s_waitcnt lgkmcnt(5)
  v_xor_b32 v14, 0x10000, v14
  v_mfma_f32_16x16x32_bf16 v[104:107], a[192:195], v[28:31], v[104:107]
  s_add_u32 s27, s27, s22
  ds_read_b128 v[52:55], v15 offset:57344
  v_mfma_f32_16x16x32_bf16 v[108:111], a[196:199], v[28:31], v[108:111]
  v_mfma_f32_16x16x32_bf16 v[120:123], a[200:203], v[28:31], v[120:123]
  s_waitcnt vmcnt(13)
  s_barrier
  v_mfma_f32_16x16x32_bf16 v[124:127], a[204:207], v[28:31], v[124:127]
  s_waitcnt lgkmcnt(5)
  v_xor_b32 v15, 0x10000, v15
  v_mfma_f32_16x16x32_bf16 v[96:99], a[208:211], v[32:35], v[96:99]
  ds_read_b128 v[24:27], v8 offset:0
  v_mfma_f32_16x16x32_bf16 v[100:103], a[212:215], v[32:35], v[100:103]
  v_mfma_f32_16x16x32_bf16 v[112:115], a[216:219], v[32:35], v[112:115]
  v_mfma_f32_16x16x32_bf16 v[116:119], a[220:223], v[32:35], v[116:119]
  s_waitcnt lgkmcnt(5)
  v_mfma_f32_16x16x32_bf16 v[104:107], a[208:211], v[36:39], v[104:107]
  s_add_u32 s29, s29, 1
  ds_read_b128 v[28:31], v9 offset:0
  v_mfma_f32_16x16x32_bf16 v[108:111], a[212:215], v[36:39], v[108:111]
  v_mfma_f32_16x16x32_bf16 v[120:123], a[216:219], v[36:39], v[120:123]
  s_max_i32 s30, s29, 0
  v_mfma_f32_16x16x32_bf16 v[124:127], a[220:223], v[36:39], v[124:127]
  s_waitcnt lgkmcnt(5)
  v_mov_b32 v144, s30
  v_mfma_f32_16x16x32_bf16 v[96:99], a[224:227], v[40:43], v[96:99]
  ds_read_b128 v[32:35], v10 offset:0
  v_mfma_f32_16x16x32_bf16 v[100:103], a[228:231], v[40:43], v[100:103]
  v_mfma_f32_16x16x32_bf16 v[112:115], a[232:235], v[40:43], v[112:115]
  buffer_store_dword v144, v145, s[4:7], s31 offen sc1
  v_mfma_f32_16x16x32_bf16 v[116:119], a[236:239], v[40:43], v[116:119]
  s_waitcnt lgkmcnt(5)
  v_mfma_f32_16x16x32_bf16 v[104:107], a[224:227], v[44:47], v[104:107]
  ds_read_b128 v[36:39], v11 offset:0
  v_mfma_f32_16x16x32_bf16 v[108:111], a[228:231], v[44:47], v[108:111]
  v_mfma_f32_16x16x32_bf16 v[120:123], a[232:235], v[44:47], v[120:123]
  v_mfma_f32_16x16x32_bf16 v[124:127], a[236:239], v[44:47], v[124:127]
  s_waitcnt lgkmcnt(5)
  v_mfma_f32_16x16x32_bf16 v[96:99], a[240:243], v[48:51], v[96:99]
  s_sub_u32 s23, s23, 1
  ds_read_b128 v[40:43], v12 offset:0
  v_mfma_f32_16x16x32_bf16 v[100:103], a[244:247], v[48:51], v[100:103]
  v_mfma_f32_16x16x32_bf16 v[112:115], a[248:251], v[48:51], v[112:115]
  v_mfma_f32_16x16x32_bf16 v[116:119], a[252:255], v[48:51], v[116:119]
  s_waitcnt lgkmcnt(5)
  v_mfma_f32_16x16x32_bf16 v[104:107], a[240:243], v[52:55], v[104:107]
  s_cmp_eq_u32 s23, 0
  ds_read_b128 v[44:47], v13 offset:0
  v_mfma_f32_16x16x32_bf16 v[108:111], a[244:247], v[52:55], v[108:111]
  v_mfma_f32_16x16x32_bf16 v[120:123], a[248:251], v[52:55], v[120:123]
  v_mfma_f32_16x16x32_bf16 v[124:127], a[252:255], v[52:55], v[124:127]
  s_cbranch_scc1 G_done1_139
  s_branch G_top_137
G_done0_138:
  s_nop 7
  s_nop 3
  v_mul_f32 v64, s24, v64
  v_mul_f32 v65, s24, v65
  v_cvt_pk_bf16_f32 v128, v64, v65
  v_mul_f32 v66, s24, v66
  v_mul_f32 v67, s24, v67
  v_cvt_pk_bf16_f32 v129, v66, v67
  v_mul_f32 v68, s24, v68
  v_mul_f32 v69, s24, v69
  v_cvt_pk_bf16_f32 v130, v68, v69
  v_mul_f32 v70, s24, v70
  v_mul_f32 v71, s24, v71
  v_cvt_pk_bf16_f32 v131, v70, v71
  buffer_store_dwordx4 v[128:131], v7, s[4:7], s21 offen offset:0 sc1
  v_mul_f32 v72, s24, v72
  v_mul_f32 v73, s24, v73
  v_cvt_pk_bf16_f32 v132, v72, v73
  v_mul_f32 v74, s24, v74
  v_mul_f32 v75, s24, v75
  v_cvt_pk_bf16_f32 v133, v74, v75
  v_mul_f32 v76, s24, v76
  v_mul_f32 v77, s24, v77
  v_cvt_pk_bf16_f32 v134, v76, v77
  v_mul_f32 v78, s24, v78
  v_mul_f32 v79, s24, v79
  v_cvt_pk_bf16_f32 v135, v78, v79
  buffer_store_dwordx4 v[132:135], v7, s[4:7], s21 offen offset:256 sc1
  v_mul_f32 v80, s24, v80
  v_mul_f32 v81, s24, v81
  v_cvt_pk_bf16_f32 v136, v80, v81
  v_mul_f32 v82, s24, v82
  v_mul_f32 v83, s24, v83
  v_cvt_pk_bf16_f32 v137, v82, v83
  v_mul_f32 v84, s24, v84
  v_mul_f32 v85, s24, v85
  v_cvt_pk_bf16_f32 v138, v84, v85
  v_mul_f32 v86, s24, v86
  v_mul_f32 v87, s24, v87
  v_cvt_pk_bf16_f32 v139, v86, v87
  buffer_store_dwordx4 v[136:139], v7, s[4:7], s21 offen offset:2048 sc1
  v_mul_f32 v88, s24, v88
  v_mul_f32 v89, s24, v89
  v_cvt_pk_bf16_f32 v140, v88, v89
  v_mul_f32 v90, s24, v90
  v_mul_f32 v91, s24, v91
  v_cvt_pk_bf16_f32 v141, v90, v91
  v_mul_f32 v92, s24, v92
  v_mul_f32 v93, s24, v93
  v_cvt_pk_bf16_f32 v142, v92, v93
  v_mul_f32 v94, s24, v94
  v_mul_f32 v95, s24, v95
  v_cvt_pk_bf16_f32 v143, v94, v95
  buffer_store_dwordx4 v[140:143], v7, s[4:7], s21 offen offset:2304 sc1
  s_branch G_fin_140
G_done1_139:
  s_nop 7
  s_nop 3
  v_mul_f32 v96, s24, v96
  v_mul_f32 v97, s24, v97
  v_cvt_pk_bf16_f32 v128, v96, v97
  v_mul_f32 v98, s24, v98
  v_mul_f32 v99, s24, v99
  v_cvt_pk_bf16_f32 v129, v98, v99
  v_mul_f32 v100, s24, v100
  v_mul_f32 v101, s24, v101
  v_cvt_pk_bf16_f32 v130, v100, v101
  v_mul_f32 v102, s24, v102
  v_mul_f32 v103, s24, v103
  v_cvt_pk_bf16_f32 v131, v102, v103
  buffer_store_dwordx4 v[128:131], v7, s[4:7], s21 offen offset:0 sc1
  v_mul_f32 v104, s24, v104
  v_mul_f32 v105, s24, v105
  v_cvt_pk_bf16_f32 v132, v104, v105
  v_mul_f32 v106, s24, v106
  v_mul_f32 v107, s24, v107
  v_cvt_pk_bf16_f32 v133, v106, v107
  v_mul_f32 v108, s24, v108
  v_mul_f32 v109, s24, v109
  v_cvt_pk_bf16_f32 v134, v108, v109
  v_mul_f32 v110, s24, v110
  v_mul_f32 v111, s24, v111
  v_cvt_pk_bf16_f32 v135, v110, v111
  buffer_store_dwordx4 v[132:135], v7, s[4:7], s21 offen offset:256 sc1
  v_mul_f32 v112, s24, v112
  v_mul_f32 v113, s24, v113
  v_cvt_pk_bf16_f32 v136, v112, v113
  v_mul_f32 v114, s24, v114
  v_mul_f32 v115, s24, v115
  v_cvt_pk_bf16_f32 v137, v114, v115
  v_mul_f32 v116, s24, v116
  v_mul_f32 v117, s24, v117
  v_cvt_pk_bf16_f32 v138, v116, v117
  v_mul_f32 v118, s24, v118
  v_mul_f32 v119, s24, v119
  v_cvt_pk_bf16_f32 v139, v118, v119
  buffer_store_dwordx4 v[136:139], v7, s[4:7], s21 offen offset:2048 sc1
  v_mul_f32 v120, s24, v120
  v_mul_f32 v121, s24, v121
  v_cvt_pk_bf16_f32 v140, v120, v121
  v_mul_f32 v122, s24, v122
  v_mul_f32 v123, s24, v123
  v_cvt_pk_bf16_f32 v141, v122, v123
  v_mul_f32 v124, s24, v124
  v_mul_f32 v125, s24, v125
  v_cvt_pk_bf16_f32 v142, v124, v125
  v_mul_f32 v126, s24, v126
  v_mul_f32 v127, s24, v127
  v_cvt_pk_bf16_f32 v143, v126, v127
  buffer_store_dwordx4 v[140:143], v7, s[4:7], s21 offen offset:2304 sc1
G_fin_140:
  s_waitcnt vmcnt(0) lgkmcnt(0)
  s_barrier
  s_add_u32 s30, s29, 2
  v_mov_b32 v144, s30
  v_min_u32 v145, 1, v0
  v_lshlrev_b32 v145, 30, v145
  buffer_store_dword v144, v145, s[4:7], s31 offen sc1
  s_branch P_end_131
P_v_130:
  s_mov_b32 s27, s21
  v_mov_b32 v7, 0x40000000
  s_mov_b32 s29, -2
  v_min_u32 v145, 1, v0
  v_lshlrev_b32 v145, 30, v145
  ds_read_b128 v[24:27], v8 offset:0
  ds_read_b128 v[28:31], v9 offset:0
  ds_read_b128 v[32:35], v10 offset:0
  ds_read_b128 v[36:39], v11 offset:0
  ds_read_b128 v[40:43], v12 offset:0
  ds_read_b128 v[44:47], v13 offset:0
.p2align 6
G_top_141:
  s_waitcnt lgkmcnt(5)
  v_mfma_f32_16x16x32_bf16 v[64:67], v[24:27], a[0:3], 0
  s_add_u32 m0, s25, 0
  ds_read_b128 v[48:51], v14 offset:0
  v_mfma_f32_16x16x32_bf16 v[72:75], v[24:27], a[4:7], 0
  v_mfma_f32_16x16x32_bf16 v[80:83], v[24:27], a[8:11], 0
  buffer_load_dwordx4 v16, s[12:15], s19 offen lds
  v_mfma_f32_16x16x32_bf16 v[88:91], v[24:27], a[12:15], 0
  s_waitcnt lgkmcnt(5)
  v_mfma_f32_16x16x32_bf16 v[68:71], v[28:31], a[0:3], 0
  ds_read_b128 v[52:55], v15 offset:0
  v_mfma_f32_16x16x32_bf16 v[76:79], v[28:31], a[4:7], 0
  v_cvt_pk_bf16_f32 v128, v96, v97
  v_cvt_pk_bf16_f32 v129, v98, v99
  v_mfma_f32_16x16x32_bf16 v[84:87], v[28:31], a[8:11], 0
  v_mfma_f32_16x16x32_bf16 v[92:95], v[28:31], a[12:15], 0
  s_waitcnt lgkmcnt(5)
  v_cvt_pk_bf16_f32 v130, v100, v101
  v_cvt_pk_bf16_f32 v131, v102, v103
  v_mfma_f32_16x16x32_bf16 v[64:67], v[32:35], a[16:19], v[64:67]
  s_add_u32 m0, s25, 1024
  ds_read_b128 v[24:27], v8 offset:8192
  v_mfma_f32_16x16x32_bf16 v[72:75], v[32:35], a[20:23], v[72:75]
  v_mfma_f32_16x16x32_bf16 v[80:83], v[32:35], a[24:27], v[80:83]
  buffer_load_dwordx4 v17, s[12:15], s19 offen lds
  v_mfma_f32_16x16x32_bf16 v[88:91], v[32:35], a[28:31], v[88:91]
  s_waitcnt lgkmcnt(5)
  v_mfma_f32_16x16x32_bf16 v[68:71], v[36:39], a[16:19], v[68:71]
  ds_read_b128 v[28:31], v9 offset:8192
  v_mfma_f32_16x16x32_bf16 v[76:79], v[36:39], a[20:23], v[76:79]
  v_mfma_f32_16x16x32_bf16 v[84:87], v[36:39], a[24:27], v[84:87]
  v_mfma_f32_16x16x32_bf16 v[92:95], v[36:39], a[28:31], v[92:95]
  s_waitcnt lgkmcnt(5)
  v_mfma_f32_16x16x32_bf16 v[64:67], v[40:43], a[32:35], v[64:67]
  s_add_u32 m0, s25, 2048
  ds_read_b128 v[32:35], v10 offset:8192
  v_mfma_f32_16x16x32_bf16 v[72:75], v[40:43], a[36:39], v[72:75]
  v_cvt_pk_bf16_f32 v132, v104, v105
  v_cvt_pk_bf16_f32 v133, v106, v107
  v_mfma_f32_16x16x32_bf16 v[80:83], v[40:43], a[40:43], v[80:83]
  buffer_load_dwordx4 v18, s[12:15], s19 offen lds
  v_mfma_f32_16x16x32_bf16 v[88:91], v[40:43], a[44:47], v[88:91]
  s_waitcnt lgkmcnt(5)
  v_cvt_pk_bf16_f32 v134, v108, v109
  v_cvt_pk_bf16_f32 v135, v110, v111
  v_mfma_f32_16x16x32_bf16 v[68:71], v[44:47], a[32:35], v[68:71]
  ds_read_b128 v[36:39], v11 offset:8192
  v_mfma_f32_16x16x32_bf16 v[76:79], v[44:47], a[36:39], v[76:79]
  v_mfma_f32_16x16x32_bf16 v[84:87], v[44:47], a[40:43], v[84:87]
  v_mfma_f32_16x16x32_bf16 v[92:95], v[44:47], a[44:47], v[92:95]
  s_waitcnt lgkmcnt(5)
  v_mfma_f32_16x16x32_bf16 v[64:67], v[48:51], a[48:51], v[64:67]
  s_add_u32 m0, s25, 3072
  ds_read_b128 v[40:43], v12 offset:8192
  v_mfma_f32_16x16x32_bf16 v[72:75], v[48:51], a[52:55], v[72:75]
  v_mfma_f32_16x16x32_bf16 v[80:83], v[48:51], a[56:59], v[80:83]
  buffer_load_dwordx4 v19, s[12:15], s19 offen lds
  v_mfma_f32_16x16x32_bf16 v[88:91], v[48:51], a[60:63], v[88:91]
  s_waitcnt lgkmcnt(5)
  v_mfma_f32_16x16x32_bf16 v[68:71], v[52:55], a[48:51], v[68:71]
  ds_read_b128 v[44:47], v13 offset:8192
  v_mfma_f32_16x16x32_bf16 v[76:79], v[52:55], a[52:55], v[76:79]
  v_cvt_pk_bf16_f32 v136, v112, v113
  v_cvt_pk_bf16_f32 v137, v114, v115
  v_mfma_f32_16x16x32_bf16 v[84:87], v[52:55], a[56:59], v[84:87]
  v_mfma_f32_16x16x32_bf16 v[92:95], v[52:55], a[60:63], v[92:95]
  s_waitcnt lgkmcnt(5)
  v_cvt_pk_bf16_f32 v138, v116, v117
  v_cvt_pk_bf16_f32 v139, v118, v119
  v_mfma_f32_16x16x32_bf16 v[64:67], v[24:27], a[64:67], v[64:67]
  s_add_u32 m0, s25, 4096
  ds_read_b128 v[48:51], v14 offset:8192
  v_mfma_f32_16x16x32_bf16 v[72:75], v[24:27], a[68:71], v[72:75]
  v_mfma_f32_16x16x32_bf16 v[80:83], v[24:27], a[72:75], v[80:83]
  buffer_load_dwordx4 v20, s[12:15], s19 offen lds
  v_mfma_f32_16x16x32_bf16 v[88:91], v[24:27], a[76:79], v[88:91]
  s_waitcnt lgkmcnt(5)
  v_mfma_f32_16x16x32_bf16 v[68:71], v[28:31], a[64:67], v[68:71]
  ds_read_b128 v[52:55], v15 offset:8192
  v_mfma_f32_16x16x32_bf16 v[76:79], v[28:31], a[68:71], v[76:79]
  v_mfma_f32_16x16x32_bf16 v[84:87], v[28:31], a[72:75], v[84:87]
  v_mfma_f32_16x16x32_bf16 v[92:95], v[28:31], a[76:79], v[92:95]
  s_waitcnt lgkmcnt(5)
  v_mfma_f32_16x16x32_bf16 v[64:67], v[32:35], a[80:83], v[64:67]
  s_add_u32 m0, s25, 5120
  ds_read_b128 v[24:27], v8 offset:16384
  v_mfma_f32_16x16x32_bf16 v[72:75], v[32:35], a[84:87], v[72:75]
  v_cvt_pk_bf16_f32 v140, v120, v121
  v_cvt_pk_bf16_f32 v141, v122, v123
  v_mfma_f32_16x16x32_bf16 v[80:83], v[32:35], a[88:91], v[80:83]
  buffer_load_dwordx4 v21, s[12:15], s19 offen lds
  v_mfma_f32_16x16x32_bf16 v[88:91], v[32:35], a[92:95], v[88:91]
  s_waitcnt lgkmcnt(5)
  v_cvt_pk_bf16_f32 v142, v124, v125
  v_cvt_pk_bf16_f32 v143, v126, v127
  v_mfma_f32_16x16x32_bf16 v[68:71], v[36:39], a[80:83], v[68:71]
  ds_read_b128 v[28:31], v9 offset:16384
  v_mfma_f32_16x16x32_bf16 v[76:79], v[36:39], a[84:87], v[76:79]
  v_mfma_f32_16x16x32_bf16 v[84:87], v[36:39], a[88:91], v[84:87]
  v_mfma_f32_16x16x32_bf16 v[92:95], v[36:39], a[92:95], v[92:95]
  s_waitcnt lgkmcnt(5)
  v_mfma_f32_16x16x32_bf16 v[64:67], v[40:43], a[96:99], v[64:67]
  s_add_u32 m0, s25, 6144
  ds_read_b128 v[32:35], v10 offset:16384
  v_mfma_f32_16x16x32_bf16 v[72:75], v[40:43], a[100:103], v[72:75]
  v_mfma_f32_16x16x32_bf16 v[80:83], v[40:43], a[104:107], v[80:83]
  buffer_load_dwordx4 v22, s[12:15], s19 offen lds
  v_mfma_f32_16x16x32_bf16 v[88:91], v[40:43], a[108:111], v[88:91]
  s_waitcnt lgkmcnt(5)
  v_mfma_f32_16x16x32_bf16 v[68:71], v[44:47], a[96:99], v[68:71]
  ds_read_b128 v[36:39], v11 offset:16384
  v_mfma_f32_16x16x32_bf16 v[76:79], v[44:47], a[100:103], v[76:79]
  v_mfma_f32_16x16x32_bf16 v[84:87], v[44:47], a[104:107], v[84:87]
  v_mfma_f32_16x16x32_bf16 v[92:95], v[44:47], a[108:111], v[92:95]
  s_waitcnt lgkmcnt(5)
  v_mfma_f32_16x16x32_bf16 v[64:67], v[48:51], a[112:115], v[64:67]
  s_add_u32 m0, s25, 7168
  ds_read_b128 v[40:43], v12 offset:16384
  v_mfma_f32_16x16x32_bf16 v[72:75], v[48:51], a[116:119], v[72:75]
  v_mfma_f32_16x16x32_bf16 v[80:83], v[48:51], a[120:123], v[80:83]
  buffer_load_dwordx4 v23, s[12:15], s19 offen lds
  v_mfma_f32_16x16x32_bf16 v[88:91], v[48:51], a[124:127], v[88:91]
  s_waitcnt lgkmcnt(5)
  v_mfma_f32_16x16x32_bf16 v[68:71], v[52:55], a[112:115], v[68:71]
  s_cmp_gt_u32 s23, 3
  ds_read_b128 v[44:47], v13 offset:16384
  v_mfma_f32_16x16x32_bf16 v[76:79], v[52:55], a[116:119], v[76:79]
  v_mfma_f32_16x16x32_bf16 v[84:87], v[52:55], a[120:123], v[84:87]
  s_cselect_b32 s26, s20, 0
  v_mfma_f32_16x16x32_bf16 v[92:95], v[52:55], a[124:127], v[92:95]
  s_waitcnt lgkmcnt(5)
  v_mfma_f32_16x16x32_bf16 v[64:67], v[24:27], a[128:131], v[64:67]
  s_add_u32 s19, s19, s26
  ds_read_b128 v[48:51], v14 offset:16384
  v_mfma_f32_16x16x32_bf16 v[72:75], v[24:27], a[132:135], v[72:75]
  v_mfma_f32_16x16x32_bf16 v[80:83], v[24:27], a[136:139], v[80:83]
  s_add_u32 s25, s25, 32768
  v_mfma_f32_16x16x32_bf16 v[88:91], v[24:27], a[140:143], v[88:91]
  s_waitcnt lgkmcnt(5)
  v_mfma_f32_16x16x32_bf16 v[68:71], v[28:31], a[128:131], v[68:71]
  s_and_b32 s25, s25, 0x1ffff
  ds_read_b128 v[52:55], v15 offset:16384
  v_mfma_f32_16x16x32_bf16 v[76:79], v[28:31], a[132:135], v[76:79]
  v_mfma_f32_16x16x32_bf16 v[84:87], v[28:31], a[136:139], v[84:87]
  buffer_store_dwordx4 v[128:131], v7, s[4:7], s21 offen offset:0 sc1
  v_mfma_f32_16x16x32_bf16 v[92:95], v[28:31], a[140:143], v[92:95]
  s_waitcnt lgkmcnt(5)
  v_mfma_f32_16x16x32_bf16 v[64:67], v[32:35], a[144:147], v[64:67]
  ds_read_b128 v[24:27], v8 offset:24576
  v_mfma_f32_16x16x32_bf16 v[72:75], v[32:35], a[148:151], v[72:75]
  v_mfma_f32_16x16x32_bf16 v[80:83], v[32:35], a[152:155], v[80:83]
  v_mfma_f32_16x16x32_bf16 v[88:91], v[32:35], a[156:159], v[88:91]
  s_waitcnt lgkmcnt(5)
  v_mfma_f32_16x16x32_bf16 v[68:71], v[36:39], a[144:147], v[68:71]
  ds_read_b128 v[28:31], v9 offset:24576
  v_mfma_f32_16x16x32_bf16 v[76:79], v[36:39], a[148:151], v[76:79]
  v_mfma_f32_16x16x32_bf16 v[84:87], v[36:39], a[152:155], v[84:87]
  buffer_store_dwordx4 v[132:135], v7, s[4:7], s21 offen offset:256 sc1
  v_mfma_f32_16x16x32_bf16 v[92:95], v[36:39], a[156:159], v[92:95]
  s_waitcnt lgkmcnt(5)
  v_mfma_f32_16x16x32_bf16 v[64:67], v[40:43], a[160:163], v[64:67]
  ds_read_b128 v[32:35], v10 offset:24576
  v_mfma_f32_16x16x32_bf16 v[72:75], v[40:43], a[164:167], v[72:75]
  v_mfma_f32_16x16x32_bf16 v[80:83], v[40:43], a[168:171], v[80:83]
  v_mfma_f32_16x16x32_bf16 v[88:91], v[40:43], a[172:175], v[88:91]
  s_waitcnt lgkmcnt(5)
  v_mfma_f32_16x16x32_bf16 v[68:71], v[44:47], a[160:163], v[68:71]
  ds_read_b128 v[36:39], v11 offset:24576
  v_mfma_f32_16x16x32_bf16 v[76:79], v[44:47], a[164:167], v[76:79]
  v_mfma_f32_16x16x32_bf16 v[84:87], v[44:47], a[168:171], v[84:87]
  buffer_store_dwordx4 v[136:139], v7, s[4:7], s21 offen offset:2048 sc1
  v_mfma_f32_16x16x32_bf16 v[92:95], v[44:47], a[172:175], v[92:95]
  s_waitcnt lgkmcnt(5)
  v_mfma_f32_16x16x32_bf16 v[64:67], v[48:51], a[176:179], v[64:67]
  ds_read_b128 v[40:43], v12 offset:24576
  v_mfma_f32_16x16x32_bf16 v[72:75], v[48:51], a[180:183], v[72:75]
  v_mfma_f32_16x16x32_bf16 v[80:83], v[48:51], a[184:187], v[80:83]
  v_mfma_f32_16x16x32_bf16 v[88:91], v[48:51], a[188:191], v[88:91]
  s_waitcnt lgkmcnt(5)
  v_mfma_f32_16x16x32_bf16 v[68:71], v[52:55], a[176:179], v[68:71]
  ds_read_b128 v[44:47], v13 offset:24576
  v_mfma_f32_16x16x32_bf16 v[76:79], v[52:55], a[180:183], v[76:79]
  v_mfma_f32_16x16x32_bf16 v[84:87], v[52:55], a[184:187], v[84:87]
  buffer_store_dwordx4 v[140:143], v7, s[4:7], s21 offen offset:2304 sc1
  v_mfma_f32_16x16x32_bf16 v[92:95], v[52:55], a[188:191], v[92:95]
  s_waitcnt lgkmcnt(5)
  v_mfma_f32_16x16x32_bf16 v[64:67], v[24:27], a[192:195], v[64:67]
  s_mov_b32 s21, s27
  ds_read_b128 v[48:51], v14 offset:24576
  v_mfma_f32_16x16x32_bf16 v[72:75], v[24:27], a[196:199], v[72:75]
  v_mov_b32 v7, v56
  v_mfma_f32_16x16x32_bf16 v[80:83], v[24:27], a[200:203], v[80:83]
  v_mfma_f32_16x16x32_bf16 v[88:91], v[24:27], a[204:207], v[88:91]
  s_waitcnt lgkmcnt(5)
  v_mfma_f32_16x16x32_bf16 v[68:71], v[28:31], a[192:195], v[68:71]
  s_add_u32 s27, s27, s22
  ds_read_b128 v[52:55], v15 offset:24576
  v_mfma_f32_16x16x32_bf16 v[76:79], v[28:31], a[196:199], v[76:79]
  v_mfma_f32_16x16x32_bf16 v[84:87], v[28:31], a[200:203], v[84:87]
  s_waitcnt vmcnt(13)
  s_barrier
  v_mfma_f32_16x16x32_bf16 v[92:95], v[28:31], a[204:207], v[92:95]
  s_waitcnt lgkmcnt(5)
  v_mfma_f32_16x16x32_bf16 v[64:67], v[32:35], a[208:211], v[64:67]
  ds_read_b128 v[24:27], v8 offset:32768
  v_mfma_f32_16x16x32_bf16 v[72:75], v[32:35], a[212:215], v[72:75]
  v_mfma_f32_16x16x32_bf16 v[80:83], v[32:35], a[216:219], v[80:83]
  v_mfma_f32_16x16x32_bf16 v[88:91], v[32:35], a[220:223], v[88:91]
  s_waitcnt lgkmcnt(5)
  v_mfma_f32_16x16x32_bf16 v[68:71], v[36:39], a[208:211], v[68:71]
  s_add_u32 s29, s29, 1
  ds_read_b128 v[28:31], v9 offset:32768
  v_mfma_f32_16x16x32_bf16 v[76:79], v[36:39], a[212:215], v[76:79]
  v_mfma_f32_16x16x32_bf16 v[84:87], v[36:39], a[216:219], v[84:87]
  s_max_i32 s30, s29, 0
  v_mfma_f32_16x16x32_bf16 v[92:95], v[36:39], a[220:223], v[92:95]
  s_waitcnt lgkmcnt(5)
  v_mov_b32 v144, s30
  v_mfma_f32_16x16x32_bf16 v[64:67], v[40:43], a[224:227], v[64:67]
  ds_read_b128 v[32:35], v10 offset:32768
  v_mfma_f32_16x16x32_bf16 v[72:75], v[40:43], a[228:231], v[72:75]
  v_mfma_f32_16x16x32_bf16 v[80:83], v[40:43], a[232:235], v[80:83]
  buffer_store_dword v144, v145, s[4:7], s31 offen sc1
  v_mfma_f32_16x16x32_bf16 v[88:91], v[40:43], a[236:239], v[88:91]
  s_waitcnt lgkmcnt(5)
  v_mfma_f32_16x16x32_bf16 v[68:71], v[44:47], a[224:227], v[68:71]
  ds_read_b128 v[36:39], v11 offset:32768
  v_mfma_f32_16x16x32_bf16 v[76:79], v[44:47], a[228:231], v[76:79]
  v_mfma_f32_16x16x32_bf16 v[84:87], v[44:47], a[232:235], v[84:87]
  v_mfma_f32_16x16x32_bf16 v[92:95], v[44:47], a[236:239], v[92:95]
  s_waitcnt lgkmcnt(5)
  v_mfma_f32_16x16x32_bf16 v[64:67], v[48:51], a[240:243], v[64:67]
  s_sub_u32 s23, s23, 1
  ds_read_b128 v[40:43], v12 offset:32768
  v_mfma_f32_16x16x32_bf16 v[72:75], v[48:51], a[244:247], v[72:75]
  v_mfma_f32_16x16x32_bf16 v[80:83], v[48:51], a[248:251], v[80:83]
  v_mfma_f32_16x16x32_bf16 v[88:91], v[48:51], a[252:255], v[88:91]
  s_waitcnt lgkmcnt(5)
  v_mfma_f32_16x16x32_bf16 v[68:71], v[52:55], a[240:243], v[68:71]
  s_cmp_eq_u32 s23, 0
  ds_read_b128 v[44:47], v13 offset:32768
  v_mfma_f32_16x16x32_bf16 v[76:79], v[52:55], a[244:247], v[76:79]
  v_mfma_f32_16x16x32_bf16 v[84:87], v[52:55], a[248:251], v[84:87]
  v_mfma_f32_16x16x32_bf16 v[92:95], v[52:55], a[252:255], v[92:95]
  s_cbranch_scc1 G_done0_142
  s_waitcnt lgkmcnt(5)
  v_mfma_f32_16x16x32_bf16 v[96:99], v[24:27], a[0:3], 0
  s_add_u32 m0, s25, 0
  ds_read_b128 v[48:51], v14 offset:32768
  v_mfma_f32_16x16x32_bf16 v[104:107], v[24:27], a[4:7], 0
  v_mfma_f32_16x16x32_bf16 v[112:115], v[24:27], a[8:11], 0
  buffer_load_dwordx4 v16, s[12:15], s19 offen lds
  v_mfma_f32_16x16x32_bf16 v[120:123], v[24:27], a[12:15], 0
  s_waitcnt lgkmcnt(5)
  v_mfma_f32_16x16x32_bf16 v[100:103], v[28:31], a[0:3], 0
  ds_read_b128 v[52:55], v15 offset:32768
  v_mfma_f32_16x16x32_bf16 v[108:111], v[28:31], a[4:7], 0
  v_cvt_pk_bf16_f32 v128, v64, v65
  v_cvt_pk_bf16_f32 v129, v66, v67
  v_mfma_f32_16x16x32_bf16 v[116:119], v[28:31], a[8:11], 0
  v_mfma_f32_16x16x32_bf16 v[124:127], v[28:31], a[12:15], 0
  s_waitcnt lgkmcnt(5)
  v_cvt_pk_bf16_f32 v130, v68, v69
  v_cvt_pk_bf16_f32 v131, v70, v71
  v_mfma_f32_16x16x32_bf16 v[96:99], v[32:35], a[16:19], v[96:99]
  s_add_u32 m0, s25, 1024
  ds_read_b128 v[24:27], v8 offset:40960
  v_mfma_f32_16x16x32_bf16 v[104:107], v[32:35], a[20:23], v[104:107]
  v_mfma_f32_16x16x32_bf16 v[112:115], v[32:35], a[24:27], v[112:115]
  buffer_load_dwordx4 v17, s[12:15], s19 offen lds
  v_mfma_f32_16x16x32_bf16 v[120:123], v[32:35], a[28:31], v[120:123]
  s_waitcnt lgkmcnt(5)
  v_mfma_f32_16x16x32_bf16 v[100:103], v[36:39], a[16:19], v[100:103]
  ds_read_b128 v[28:31], v9 offset:40960
  v_mfma_f32_16x16x32_bf16 v[108:111], v[36:39], a[20:23], v[108:111]
  v_mfma_f32_16x16x32_bf16 v[116:119], v[36:39], a[24:27], v[116:119]
  v_mfma_f32_16x16x32_bf16 v[124:127], v[36:39], a[28:31], v[124:127]
  s_waitcnt lgkmcnt(5)
  v_mfma_f32_16x16x32_bf16 v[96:99], v[40:43], a[32:35], v[96:99]
  s_add_u32 m0, s25, 2048
  ds_read_b128 v[32:35], v10 offset:40960
  v_mfma_f32_16x16x32_bf16 v[104:107], v[40:43], a[36:39], v[104:107]
  v_cvt_pk_bf16_f32 v132, v72, v73
  v_cvt_pk_bf16_f32 v133, v74, v75
  v_mfma_f32_16x16x32_bf16 v[112:115], v[40:43], a[40:43], v[112:115]
  buffer_load_dwordx4 v18, s[12:15], s19 offen lds
  v_mfma_f32_16x16x32_bf16 v[120:123], v[40:43], a[44:47], v[120:123]
  s_waitcnt lgkmcnt(5)
  v_cvt_pk_bf16_f32 v134, v76, v77
  v_cvt_pk_bf16_f32 v135, v78, v79
  v_mfma_f32_16x16x32_bf16 v[100:103], v[44:47], a[32:35], v[100:103]
  ds_read_b128 v[36:39], v11 offset:40960
  v_mfma_f32_16x16x32_bf16 v[108:111], v[44:47], a[36:39], v[108:111]
  v_mfma_f32_16x16x32_bf16 v[116:119], v[44:47], a[40:43], v[116:119]
  v_mfma_f32_16x16x32_bf16 v[124:127], v[44:47], a[44:47], v[124:127]
  s_waitcnt lgkmcnt(5)
  v_mfma_f32_16x16x32_bf16 v[96:99], v[48:51], a[48:51], v[96:99]
  s_add_u32 m0, s25, 3072
  ds_read_b128 v[40:43], v12 offset:40960
  v_mfma_f32_16x16x32_bf16 v[104:107], v[48:51], a[52:55], v[104:107]
  v_mfma_f32_16x16x32_bf16 v[112:115], v[48:51], a[56:59], v[112:115]
  buffer_load_dwordx4 v19, s[12:15], s19 offen lds
  v_mfma_f32_16x16x32_bf16 v[120:123], v[48:51], a[60:63], v[120:123]
  s_waitcnt lgkmcnt(5)
  v_mfma_f32_16x16x32_bf16 v[100:103], v[52:55], a[48:51], v[100:103]
  ds_read_b128 v[44:47], v13 offset:40960
  v_mfma_f32_16x16x32_bf16 v[108:111], v[52:55], a[52:55], v[108:111]
  v_cvt_pk_bf16_f32 v136, v80, v81
  v_cvt_pk_bf16_f32 v137, v82, v83
  v_mfma_f32_16x16x32_bf16 v[116:119], v[52:55], a[56:59], v[116:119]
  v_mfma_f32_16x16x32_bf16 v[124:127], v[52:55], a[60:63], v[124:127]
  s_waitcnt lgkmcnt(5)
  v_cvt_pk_bf16_f32 v138, v84, v85
  v_cvt_pk_bf16_f32 v139, v86, v87
  v_mfma_f32_16x16x32_bf16 v[96:99], v[24:27], a[64:67], v[96:99]
  s_add_u32 m0, s25, 4096
  ds_read_b128 v[48:51], v14 offset:40960
  v_mfma_f32_16x16x32_bf16 v[104:107], v[24:27], a[68:71], v[104:107]
  v_mfma_f32_16x16x32_bf16 v[112:115], v[24:27], a[72:75], v[112:115]
  buffer_load_dwordx4 v20, s[12:15], s19 offen lds
  v_mfma_f32_16x16x32_bf16 v[120:123], v[24:27], a[76:79], v[120:123]
  s_waitcnt lgkmcnt(5)
  v_mfma_f32_16x16x32_bf16 v[100:103], v[28:31], a[64:67], v[100:103]
  ds_read_b128 v[52:55], v15 offset:40960
  v_mfma_f32_16x16x32_bf16 v[108:111], v[28:31], a[68:71], v[108:111]
  v_mfma_f32_16x16x32_bf16 v[116:119], v[28:31], a[72:75], v[116:119]
  v_mfma_f32_16x16x32_bf16 v[124:127], v[28:31], a[76:79], v[124:127]
  s_waitcnt lgkmcnt(5)
  v_mfma_f32_16x16x32_bf16 v[96:99], v[32:35], a[80:83], v[96:99]
  s_add_u32 m0, s25, 5120
  ds_read_b128 v[24:27], v8 offset:49152
  v_mfma_f32_16x16x32_bf16 v[104:107], v[32:35], a[84:87], v[104:107]
  v_cvt_pk_bf16_f32 v140, v88, v89
  v_cvt_pk_bf16_f32 v141, v90, v91
  v_mfma_f32_16x16x32_bf16 v[112:115], v[32:35], a[88:91], v[112:115]
  buffer_load_dwordx4 v21, s[12:15], s19 offen lds
  v_mfma_f32_16x16x32_bf16 v[120:123], v[32:35], a[92:95], v[120:123]
  s_waitcnt lgkmcnt(5)
  v_cvt_pk_bf16_f32 v142, v92, v93
  v_cvt_pk_bf16_f32 v143, v94, v95
  v_mfma_f32_16x16x32_bf16 v[100:103], v[36:39], a[80:83], v[100:103]
  ds_read_b128 v[28:31], v9 offset:49152
  v_mfma_f32_16x16x32_bf16 v[108:111], v[36:39], a[84:87], v[108:111]
  v_mfma_f32_16x16x32_bf16 v[116:119], v[36:39], a[88:91], v[116:119]
  v_mfma_f32_16x16x32_bf16 v[124:127], v[36:39], a[92:95], v[124:127]
  s_waitcnt lgkmcnt(5)
  v_mfma_f32_16x16x32_bf16 v[96:99], v[40:43], a[96:99], v[96:99]
  s_add_u32 m0, s25, 6144
  ds_read_b128 v[32:35], v10 offset:49152
  v_mfma_f32_16x16x32_bf16 v[104:107], v[40:43], a[100:103], v[104:107]
  v_mfma_f32_16x16x32_bf16 v[112:115], v[40:43], a[104:107], v[112:115]
  buffer_load_dwordx4 v22, s[12:15], s19 offen lds
  v_mfma_f32_16x16x32_bf16 v[120:123], v[40:43], a[108:111], v[120:123]
  s_waitcnt lgkmcnt(5)
  v_mfma_f32_16x16x32_bf16 v[100:103], v[44:47], a[96:99], v[100:103]
  ds_read_b128 v[36:39], v11 offset:49152
  v_mfma_f32_16x16x32_bf16 v[108:111], v[44:47], a[100:103], v[108:111]
  v_mfma_f32_16x16x32_bf16 v[116:119], v[44:47], a[104:107], v[116:119]
  v_mfma_f32_16x16x32_bf16 v[124:127], v[44:47], a[108:111], v[124:127]
  s_waitcnt lgkmcnt(5)
  v_mfma_f32_16x16x32_bf16 v[96:99], v[48:51], a[112:115], v[96:99]
  s_add_u32 m0, s25, 7168
  ds_read_b128 v[40:43], v12 offset:49152
  v_mfma_f32_16x16x32_bf16 v[104:107], v[48:51], a[116:119], v[104:107]
  v_mfma_f32_16x16x32_bf16 v[112:115], v[48:51], a[120:123], v[112:115]
  buffer_load_dwordx4 v23, s[12:15], s19 offen lds
  v_mfma_f32_16x16x32_bf16 v[120:123], v[48:51], a[124:127], v[120:123]
  s_waitcnt lgkmcnt(5)
  v_mfma_f32_16x16x32_bf16 v[100:103], v[52:55], a[112:115], v[100:103]
  s_cmp_gt_u32 s23, 3
  ds_read_b128 v[44:47], v13 offset:49152
  v_mfma_f32_16x16x32_bf16 v[108:111], v[52:55], a[116:119], v[108:111]
  v_mfma_f32_16x16x32_bf16 v[116:119], v[52:55], a[120:123], v[116:119]
  s_cselect_b32 s26, s20, 0
  v_mfma_f32_16x16x32_bf16 v[124:127], v[52:55], a[124:127], v[124:127]
  s_waitcnt lgkmcnt(5)
  v_mfma_f32_16x16x32_bf16 v[96:99], v[24:27], a[128:131], v[96:99]
  s_add_u32 s19, s19, s26
  ds_read_b128 v[48:51], v14 offset:49152
  v_mfma_f32_16x16x32_bf16 v[104:107], v[24:27], a[132:135], v[104:107]
  v_mfma_f32_16x16x32_bf16 v[112:115], v[24:27], a[136:139], v[112:115]
  s_add_u32 s25, s25, 32768
  v_mfma_f32_16x16x32_bf16 v[120:123], v[24:27], a[140:143], v[120:123]
  s_waitcnt lgkmcnt(5)
  v_mfma_f32_16x16x32_bf16 v[100:103], v[28:31], a[128:131], v[100:103]
  s_and_b32 s25, s25, 0x1ffff
  ds_read_b128 v[52:55], v15 offset:49152
  v_mfma_f32_16x16x32_bf16 v[108:111], v[28:31], a[132:135], v[108:111]
  v_mfma_f32_16x16x32_bf16 v[116:119], v[28:31], a[136:139], v[116:119]
  buffer_store_dwordx4 v[128:131], v7, s[4:7], s21 offen offset:0 sc1
  v_mfma_f32_16x16x32_bf16 v[124:127], v[28:31], a[140:143], v[124:127]
  s_waitcnt lgkmcnt(5)
  v_mfma_f32_16x16x32_bf16 v[96:99], v[32:35], a[144:147], v[96:99]
  ds_read_b128 v[24:27], v8 offset:57344
  v_mfma_f32_16x16x32_bf16 v[104:107], v[32:35], a[148:151], v[104:107]
  v_mfma_f32_16x16x32_bf16 v[112:115], v[32:35], a[152:155], v[112:115]
  v_mfma_f32_16x16x32_bf16 v[120:123], v[32:35], a[156:159], v[120:123]
  s_waitcnt lgkmcnt(5)
  v_xor_b32 v8, 0x10000, v8
  v_mfma_f32_16x16x32_bf16 v[100:103], v[36:39], a[144:147], v[100:103]
  ds_read_b128 v[28:31], v9 offset:57344
  v_mfma_f32_16x16x32_bf16 v[108:111], v[36:39], a[148:151], v[108:111]
  v_mfma_f32_16x16x32_bf16 v[116:119], v[36:39], a[152:155], v[116:119]
  buffer_store_dwordx4 v[132:135], v7, s[4:7], s21 offen offset:256 sc1
  v_mfma_f32_16x16x32_bf16 v[124:127], v[36:39], a[156:159], v[124:127]
  s_waitcnt lgkmcnt(5)
  v_xor_b32 v9, 0x10000, v9
  v_mfma_f32_16x16x32_bf16 v[96:99], v[40:43], a[160:163], v[96:99]
  ds_read_b128 v[32:35], v10 offset:57344
  v_mfma_f32_16x16x32_bf16 v[104:107], v[40:43], a[164:167], v[104:107]
  v_mfma_f32_16x16x32_bf16 v[112:115], v[40:43], a[168:171], v[112:115]
  v_mfma_f32_16x16x32_bf16 v[120:123], v[40:43], a[172:175], v[120:123]
  s_waitcnt lgkmcnt(5)
  v_xor_b32 v10, 0x10000, v10
  v_mfma_f32_16x16x32_bf16 v[100:103], v[44:47], a[160:163], v[100:103]
  ds_read_b128 v[36:39], v11 offset:57344
  v_mfma_f32_16x16x32_bf16 v[108:111], v[44:47], a[164:167], v[108:111]
  v_mfma_f32_16x16x32_bf16 v[116:119], v[44:47], a[168:171], v[116:119]
  buffer_store_dwordx4 v[136:139], v7, s[4:7], s21 offen offset:2048 sc1
  v_mfma_f32_16x16x32_bf16 v[124:127], v[44:47], a[172:175], v[124:127]
  s_waitcnt lgkmcnt(5)
  v_xor_b32 v11, 0x10000, v11
  v_mfma_f32_16x16x32_bf16 v[96:99], v[48:51], a[176:179], v[96:99]
  ds_read_b128 v[40:43], v12 offset:57344
  v_mfma_f32_16x16x32_bf16 v[104:107], v[48:51], a[180:183], v[104:107]
  v_mfma_f32_16x16x32_bf16 v[112:115], v[48:51], a[184:187], v[112:115]
  v_mfma_f32_16x16x32_bf16 v[120:123], v[48:51], a[188:191], v[120:123]
  s_waitcnt lgkmcnt(5)
  v_xor_b32 v12, 0x10000, v12
  v_mfma_f32_16x16x32_bf16 v[100:103], v[52:55], a[176:179], v[100:103]
  ds_read_b128 v[44:47], v13 offset:57344
  v_mfma_f32_16x16x32_bf16 v[108:111], v[52:55], a[180:183], v[108:111]
  v_mfma_f32_16x16x32_bf16 v[116:119], v[52:55], a[184:187], v[116:119]
  buffer_store_dwordx4 v[140:143], v7, s[4:7], s21 offen offset:2304 sc1
  v_mfma_f32_16x16x32_bf16 v[124:127], v[52:55], a[188:191], v[124:127]
  s_waitcnt lgkmcnt(5)
  v_xor_b32 v13, 0x10000, v13
  v_mfma_f32_16x16x32_bf16 v[96:99], v[24:27], a[192:195], v[96:99]
  s_mov_b32 s21, s27
  ds_read_b128 v[48:51], v14 offset:57344
  v_mfma_f32_16x16x32_bf16 v[104:107], v[24:27], a[196:199], v[104:107]
  v_mov_b32 v7, v56
  v_mfma_f32_16x16x32_bf16 v[112:115], v[24:27], a[200:203], v[112:115]
  v_mfma_f32_16x16x32_bf16 v[120:123], v[24:27], a[204:207], v[120:123]
  s_waitcnt lgkmcnt(5)
  v_xor_b32 v14, 0x10000, v14
  v_mfma_f32_16x16x32_bf16 v[100:103], v[28:31], a[192:195], v[100:103]
  s_add_u32 s27, s27, s22
  ds_read_b128 v[52:55], v15 offset:57344
  v_mfma_f32_16x16x32_bf16 v[108:111], v[28:31], a[196:199], v[108:111]
  v_mfma_f32_16x16x32_bf16 v[116:119], v[28:31], a[200:203], v[116:119]
  s_waitcnt vmcnt(13)
  s_barrier
  v_mfma_f32_16x16x32_bf16 v[124:127], v[28:31], a[204:207], v[124:127]
  s_waitcnt lgkmcnt(5)
  v_xor_b32 v15, 0x10000, v15
  v_mfma_f32_16x16x32_bf16 v[96:99], v[32:35], a[208:211], v[96:99]
  ds_read_b128 v[24:27], v8 offset:0
  v_mfma_f32_16x16x32_bf16 v[104:107], v[32:35], a[212:215], v[104:107]
  v_mfma_f32_16x16x32_bf16 v[112:115], v[32:35], a[216:219], v[112:115]
  v_mfma_f32_16x16x32_bf16 v[120:123], v[32:35], a[220:223], v[120:123]
  s_waitcnt lgkmcnt(5)
  v_mfma_f32_16x16x32_bf16 v[100:103], v[36:39], a[208:211], v[100:103]
  s_add_u32 s29, s29, 1
  ds_read_b128 v[28:31], v9 offset:0
  v_mfma_f32_16x16x32_bf16 v[108:111], v[36:39], a[212:215], v[108:111]
  v_mfma_f32_16x16x32_bf16 v[116:119], v[36:39], a[216:219], v[116:119]
  s_max_i32 s30, s29, 0
  v_mfma_f32_16x16x32_bf16 v[124:127], v[36:39], a[220:223], v[124:127]
  s_waitcnt lgkmcnt(5)
  v_mov_b32 v144, s30
  v_mfma_f32_16x16x32_bf16 v[96:99], v[40:43], a[224:227], v[96:99]
  ds_read_b128 v[32:35], v10 offset:0
  v_mfma_f32_16x16x32_bf16 v[104:107], v[40:43], a[228:231], v[104:107]
  v_mfma_f32_16x16x32_bf16 v[112:115], v[40:43], a[232:235], v[112:115]
  buffer_store_dword v144, v145, s[4:7], s31 offen sc1
  v_mfma_f32_16x16x32_bf16 v[120:123], v[40:43], a[236:239], v[120:123]
  s_waitcnt lgkmcnt(5)
  v_mfma_f32_16x16x32_bf16 v[100:103], v[44:47], a[224:227], v[100:103]
  ds_read_b128 v[36:39], v11 offset:0
  v_mfma_f32_16x16x32_bf16 v[108:111], v[44:47], a[228:231], v[108:111]
  v_mfma_f32_16x16x32_bf16 v[116:119], v[44:47], a[232:235], v[116:119]
  v_mfma_f32_16x16x32_bf16 v[124:127], v[44:47], a[236:239], v[124:127]
  s_waitcnt lgkmcnt(5)
  v_mfma_f32_16x16x32_bf16 v[96:99], v[48:51], a[240:243], v[96:99]
  s_sub_u32 s23, s23, 1
  ds_read_b128 v[40:43], v12 offset:0
  v_mfma_f32_16x16x32_bf16 v[104:107], v[48:51], a[244:247], v[104:107]
  v_mfma_f32_16x16x32_bf16 v[112:115], v[48:51], a[248:251], v[112:115]
  v_mfma_f32_16x16x32_bf16 v[120:123], v[48:51], a[252:255], v[120:123]
  s_waitcnt lgkmcnt(5)
  v_mfma_f32_16x16x32_bf16 v[100:103], v[52:55], a[240:243], v[100:103]
  s_cmp_eq_u32 s23, 0
  ds_read_b128 v[44:47], v13 offset:0
  v_mfma_f32_16x16x32_bf16 v[108:111], v[52:55], a[244:247], v[108:111]
  v_mfma_f32_16x16x32_bf16 v[116:119], v[52:55], a[248:251], v[116:119]
  v_mfma_f32_16x16x32_bf16 v[124:127], v[52:55], a[252:255], v[124:127]
  s_cbranch_scc1 G_done1_143
  s_branch G_top_141
G_done0_142:
  s_nop 7
  s_nop 3
  v_cvt_pk_bf16_f32 v128, v64, v65
  v_cvt_pk_bf16_f32 v129, v66, v67
  v_cvt_pk_bf16_f32 v130, v68, v69
  v_cvt_pk_bf16_f32 v131, v70, v71
  buffer_store_dwordx4 v[128:131], v7, s[4:7], s21 offen offset:0 sc1
  v_cvt_pk_bf16_f32 v132, v72, v73
  v_cvt_pk_bf16_f32 v133, v74, v75
  v_cvt_pk_bf16_f32 v134, v76, v77
  v_cvt_pk_bf16_f32 v135, v78, v79
  buffer_store_dwordx4 v[132:135], v7, s[4:7], s21 offen offset:256 sc1
  v_cvt_pk_bf16_f32 v136, v80, v81
  v_cvt_pk_bf16_f32 v137, v82, v83
  v_cvt_pk_bf16_f32 v138, v84, v85
  v_cvt_pk_bf16_f32 v139, v86, v87
  buffer_store_dwordx4 v[136:139], v7, s[4:7], s21 offen offset:2048 sc1
  v_cvt_pk_bf16_f32 v140, v88, v89
  v_cvt_pk_bf16_f32 v141, v90, v91
  v_cvt_pk_bf16_f32 v142, v92, v93
  v_cvt_pk_bf16_f32 v143, v94, v95
  buffer_store_dwordx4 v[140:143], v7, s[4:7], s21 offen offset:2304 sc1
  s_branch G_fin_144
G_done1_143:
  s_nop 7
  s_nop 3
  v_cvt_pk_bf16_f32 v128, v96, v97
  v_cvt_pk_bf16_f32 v129, v98, v99
  v_cvt_pk_bf16_f32 v130, v100, v101
  v_cvt_pk_bf16_f32 v131, v102, v103
  buffer_store_dwordx4 v[128:131], v7, s[4:7], s21 offen offset:0 sc1
  v_cvt_pk_bf16_f32 v132, v104, v105
  v_cvt_pk_bf16_f32 v133, v106, v107
  v_cvt_pk_bf16_f32 v134, v108, v109
  v_cvt_pk_bf16_f32 v135, v110, v111
  buffer_store_dwordx4 v[132:135], v7, s[4:7], s21 offen offset:256 sc1
  v_cvt_pk_bf16_f32 v136, v112, v113
  v_cvt_pk_bf16_f32 v137, v114, v115
  v_cvt_pk_bf16_f32 v138, v116, v117
  v_cvt_pk_bf16_f32 v139, v118, v119
  buffer_store_dwordx4 v[136:139], v7, s[4:7], s21 offen offset:2048 sc1
  v_cvt_pk_bf16_f32 v140, v120, v121
  v_cvt_pk_bf16_f32 v141, v122, v123
  v_cvt_pk_bf16_f32 v142, v124, v125
  v_cvt_pk_bf16_f32 v143, v126, v127
  buffer_store_dwordx4 v[140:143], v7, s[4:7], s21 offen offset:2304 sc1
G_fin_144:
  s_waitcnt vmcnt(0) lgkmcnt(0)
  s_barrier
  s_add_u32 s30, s29, 2
  v_mov_b32 v144, s30
  v_min_u32 v145, 1, v0
  v_lshlrev_b32 v145, 30, v145
  buffer_store_dword v144, v145, s[4:7], s31 offen sc1
P_end_131:
  s_mov_b32 s71, 0
  s_branch M_sg_146
M_sw_145:
  s_sleep 8
  s_add_u32 s71, s71, 1
  s_cmp_gt_u32 s71, 262144
  s_cbranch_scc1 M_exit
M_sg_146:
  s_mov_b32 s79, 0
  s_atomic_or s79, s[74:75], 128 glc
  s_waitcnt lgkmcnt(0)
  s_cmp_lt_u32 s79, 256
  s_cbranch_scc1 M_sw_145
  s_cmp_eq_u32 s65, 6
  s_cbranch_scc1 M_follow
  s_mov_b32 s68, 0
  s_mov_b32 s36, -1
  s_mov_b32 s69, s53
  s_mov_b32 s70, s54
  s_load_dwordx2 s[8:9], s[0:1], 40
  s_mul_i32 s76, s64, 6
  s_add_u32 s76, s76, s65
  s_mul_i32 s76, s76, 21888
  v_min_u32 v200, 170, v0
  v_mul_u32_u24 v200, 128, v200
  v_add_u32 v200, s76, v200
  s_waitcnt lgkmcnt(0)
  s_and_b32 s9, s9, 0xffff
  s_mov_b32 s10, 4194304
  s_mov_b32 s11, 0x20000
M_att:
  s_mov_b32 s24, 0xf149f2ca
  s_mov_b32 s29, 0
  v_mov_b32 v6, 0
  v_mov_b32 v7, 0
  s_lshl_b32 s26, s16, 11
  v_add_u32 v3, s26, v2
  v_and_b32 v5, 31, v1
  v_lshrrev_b32 v12, 5, v1
  v_lshlrev_b32 v12, 2, v12
  v_sub_u32 v5, v5, v12
  s_lshl_b32 s26, s64, 19
  s_add_u32 s19, s26, 16777216
  s_add_u32 s20, s26, 33554432
  s_lshl_b32 s27, s69, 2
  s_add_u32 s27, s27, s16
  s_lshl_b32 s27, s27, 14
  s_add_u32 s25, s26, s27
  s_bfe_u32 s78, s70, 0x80000
  s_add_u32 s76, s67, 512
  s_mov_b32 s71, 0
  s_branch M_sg_148
M_sw_147:
  s_sleep 8
  s_add_u32 s71, s71, 1
  s_cmp_gt_u32 s71, 262144
  s_cbranch_scc1 M_exit
M_sg_148:
  s_mov_b32 s79, 0
  s_atomic_or s79, s[72:73], s76 glc
  s_waitcnt lgkmcnt(0)
  s_cmp_lt_u32 s79, s78
  s_cbranch_scc1 M_sw_147
  s_bfe_u32 s78, s70, 0x80008
  s_add_u32 s76, s67, 640
  s_mov_b32 s71, 0
  s_branch M_sg_150
M_sw_149:
  s_sleep 8
  s_add_u32 s71, s71, 1
  s_cmp_gt_u32 s71, 262144
  s_cbranch_scc1 M_exit
M_sg_150:
  s_mov_b32 s79, 0
  s_atomic_or s79, s[72:73], s76 glc
  s_waitcnt lgkmcnt(0)
  s_cmp_lt_u32 s79, s78
  s_cbranch_scc1 M_sw_149
  s_lshl_b32 s27, s69, 16
  s_add_u32 s27, s27, 16384
  s_add_u32 s17, s19, s27
M_kv_151:
  s_cmp_ge_u32 s17, s36
  s_cbranch_scc1 M_kvok_152
  s_mov_b32 s76, 0
  s_mov_b32 s78, 25
  s_mov_b32 s77, 319488
  s_cmp_eq_u32 s68, 1
  s_cmov_b32 s76, 128
  s_cmov_b32 s78, 29
  s_cmov_b32 s77, 81920
  s_cmp_eq_u32 s68, 2
  s_cmov_b32 s76, 768
  s_cmov_b32 s78, 10
  s_cmov_b32 s77, 0
  s_add_u32 s76, s76, s67
  s_mov_b32 s71, 0
  s_branch M_sg_154
M_sw_153:
  s_sleep 8
  s_add_u32 s71, s71, 1
  s_cmp_gt_u32 s71, 262144
  s_cbranch_scc1 M_exit
M_sg_154:
  s_mov_b32 s79, 0
  s_atomic_or s79, s[72:73], s76 glc
  s_waitcnt lgkmcnt(0)
  s_cmp_lt_u32 s79, s78
  s_cbranch_scc1 M_sw_153
  s_add_u32 s36, s77, s19
  s_add_u32 s68, s68, 1
  s_branch M_kv_151
M_kvok_152:
  s_add_u32 s28, s25, 0
  buffer_load_dwordx4 a[128:131], v2, s[4:7], s28 offen offset:0 sc1
  buffer_load_dwordx4 a[132:135], v2, s[4:7], s28 offen offset:1024 sc1
  buffer_load_dwordx4 a[136:139], v2, s[4:7], s28 offen offset:2048 sc1
  buffer_load_dwordx4 a[140:143], v2, s[4:7], s28 offen offset:3072 sc1
  s_add_u32 s28, s25, 4096
  buffer_load_dwordx4 a[144:147], v2, s[4:7], s28 offen offset:0 sc1
  buffer_load_dwordx4 a[148:151], v2, s[4:7], s28 offen offset:1024 sc1
  buffer_load_dwordx4 a[152:155], v2, s[4:7], s28 offen offset:2048 sc1
  buffer_load_dwordx4 a[156:159], v2, s[4:7], s28 offen offset:3072 sc1
  s_add_u32 s28, s25, 8192
  buffer_load_dwordx4 a[160:163], v2, s[4:7], s28 offen offset:0 sc1
  buffer_load_dwordx4 a[164:167], v2, s[4:7], s28 offen offset:1024 sc1
  buffer_load_dwordx4 a[168:171], v2, s[4:7], s28 offen offset:2048 sc1
  buffer_load_dwordx4 a[172:175], v2, s[4:7], s28 offen offset:3072 sc1
  s_add_u32 s28, s25, 12288
  buffer_load_dwordx4 a[176:179], v2, s[4:7], s28 offen offset:0 sc1
  buffer_load_dwordx4 a[180:183], v2, s[4:7], s28 offen offset:1024 sc1
  buffer_load_dwordx4 a[184:187], v2, s[4:7], s28 offen offset:2048 sc1
  buffer_load_dwordx4 a[188:191], v2, s[4:7], s28 offen offset:3072 sc1
A_again_155:
  s_lshl_b32 s27, s69, 16
  s_add_u32 s27, s27, 57344
  s_add_u32 s17, s19, s27
  s_add_u32 s18, s20, s27
  s_lshl_b32 s21, s16, 11
  s_mov_b32 m0, s21
  s_nop 0
  buffer_load_dwordx4 v3, s[4:7], s18 offen offset:0 sc1 lds
  buffer_load_dwordx4 v3, s[4:7], s18 offen offset:1024 sc1 lds
  s_add_u32 m0, s21, 8192
  s_nop 0
  buffer_load_dwordx4 v3, s[4:7], s17 offen offset:0 sc1 lds
  buffer_load_dwordx4 v3, s[4:7], s17 offen offset:1024 sc1 lds
  s_add_u32 s18, s18, 8192
  s_sub_u32 s18, s18, 8192
  s_max_i32 s18, s18, s20
  s_sub_u32 s17, s17, 8192
  s_max_i32 s17, s17, s19
  s_add_u32 s21, s21, 16384
  s_and_b32 s21, s21, 131071
  s_mov_b32 m0, s21
  s_nop 0
  buffer_load_dwordx4 v3, s[4:7], s18 offen offset:0 sc1 lds
  buffer_load_dwordx4 v3, s[4:7], s18 offen offset:1024 sc1 lds
  s_add_u32 m0, s21, 8192
  s_nop 0
  buffer_load_dwordx4 v3, s[4:7], s17 offen offset:0 sc1 lds
  buffer_load_dwordx4 v3, s[4:7], s17 offen offset:1024 sc1 lds
  s_sub_u32 s18, s18, 8192
  s_max_i32 s18, s18, s20
  s_sub_u32 s17, s17, 8192
  s_max_i32 s17, s17, s19
  s_add_u32 s21, s21, 16384
  s_and_b32 s21, s21, 131071
  s_mov_b32 m0, s21
  s_nop 0
  buffer_load_dwordx4 v3, s[4:7], s18 offen offset:0 sc1 lds
  buffer_load_dwordx4 v3, s[4:7], s18 offen offset:1024 sc1 lds
  s_add_u32 m0, s21, 8192
  s_nop 0
  buffer_load_dwordx4 v3, s[4:7], s17 offen offset:0 sc1 lds
  buffer_load_dwordx4 v3, s[4:7], s17 offen offset:1024 sc1 lds
  s_sub_u32 s18, s18, 8192
  s_max_i32 s18, s18, s20
  s_sub_u32 s17, s17, 8192
  s_max_i32 s17, s17, s19
  s_add_u32 s21, s21, 16384
  s_and_b32 s21, s21, 131071
  s_mov_b32 m0, s21
  s_nop 0
  buffer_load_dwordx4 v3, s[4:7], s18 offen offset:0 sc1 lds
  buffer_load_dwordx4 v3, s[4:7], s18 offen offset:1024 sc1 lds
  s_add_u32 m0, s21, 8192
  s_nop 0
  buffer_load_dwordx4 v3, s[4:7], s17 offen offset:0 sc1 lds
  buffer_load_dwordx4 v3, s[4:7], s17 offen offset:1024 sc1 lds
  s_sub_u32 s18, s18, 8192
  s_max_i32 s18, s18, s20
  s_sub_u32 s17, s17, 8192
  s_max_i32 s17, s17, s19
  s_add_u32 s21, s21, 16384
  s_and_b32 s21, s21, 131071
  s_mov_b32 m0, s21
  s_nop 0
  buffer_load_dwordx4 v3, s[4:7], s18 offen offset:0 sc1 lds
  buffer_load_dwordx4 v3, s[4:7], s18 offen offset:1024 sc1 lds
  s_add_u32 m0, s21, 8192
  s_nop 0
  buffer_load_dwordx4 v3, s[4:7], s17 offen offset:0 sc1 lds
  buffer_load_dwordx4 v3, s[4:7], s17 offen offset:1024 sc1 lds
  s_sub_u32 s18, s18, 8192
  s_max_i32 s18, s18, s20
  s_sub_u32 s17, s17, 8192
  s_max_i32 s17, s17, s19
  s_add_u32 s21, s21, 16384
  s_and_b32 s21, s21, 131071
  s_mov_b32 m0, s21
  s_nop 0
  buffer_load_dwordx4 v3, s[4:7], s18 offen offset:0 sc1 lds
  buffer_load_dwordx4 v3, s[4:7], s18 offen offset:1024 sc1 lds
  s_add_u32 m0, s21, 8192
  s_nop 0
  buffer_load_dwordx4 v3, s[4:7], s17 offen offset:0 sc1 lds
  buffer_load_dwordx4 v3, s[4:7], s17 offen offset:1024 sc1 lds
  v_accvgpr_write_b32 a0, 0
  v_accvgpr_write_b32 a1, 0
  v_accvgpr_write_b32 a2, 0
  v_accvgpr_write_b32 a3, 0
  v_accvgpr_write_b32 a4, 0
  v_accvgpr_write_b32 a5, 0
  v_accvgpr_write_b32 a6, 0
  v_accvgpr_write_b32 a7, 0
  v_accvgpr_write_b32 a8, 0
  v_accvgpr_write_b32 a9, 0
  v_accvgpr_write_b32 a10, 0
  v_accvgpr_write_b32 a11, 0
  v_accvgpr_write_b32 a12, 0
  v_accvgpr_write_b32 a13, 0
  v_accvgpr_write_b32 a14, 0
  v_accvgpr_write_b32 a15, 0
  v_accvgpr_write_b32 a16, 0
  v_accvgpr_write_b32 a17, 0
  v_accvgpr_write_b32 a18, 0
  v_accvgpr_write_b32 a19, 0
  v_accvgpr_write_b32 a20, 0
  v_accvgpr_write_b32 a21, 0
  v_accvgpr_write_b32 a22, 0
  v_accvgpr_write_b32 a23, 0
  v_accvgpr_write_b32 a24, 0
  v_accvgpr_write_b32 a25, 0
  v_accvgpr_write_b32 a26, 0
  v_accvgpr_write_b32 a27, 0
  v_accvgpr_write_b32 a28, 0
  v_accvgpr_write_b32 a29, 0
  v_accvgpr_write_b32 a30, 0
  v_accvgpr_write_b32 a31, 0
  v_accvgpr_write_b32 a32, 0
  v_accvgpr_write_b32 a33, 0
  v_accvgpr_write_b32 a34, 0
  v_accvgpr_write_b32 a35, 0
  v_accvgpr_write_b32 a36, 0
  v_accvgpr_write_b32 a37, 0
  v_accvgpr_write_b32 a38, 0
  v_accvgpr_write_b32 a39, 0
  v_accvgpr_write_b32 a40, 0
  v_accvgpr_write_b32 a41, 0
  v_accvgpr_write_b32 a42, 0
  v_accvgpr_write_b32 a43, 0
  v_accvgpr_write_b32 a44, 0
  v_accvgpr_write_b32 a45, 0
  v_accvgpr_write_b32 a46, 0
  v_accvgpr_write_b32 a47, 0
  v_accvgpr_write_b32 a48, 0
  v_accvgpr_write_b32 a49, 0
  v_accvgpr_write_b32 a50, 0
  v_accvgpr_write_b32 a51, 0
  v_accvgpr_write_b32 a52, 0
  v_accvgpr_write_b32 a53, 0
  v_accvgpr_write_b32 a54, 0
  v_accvgpr_write_b32 a55, 0
  v_accvgpr_write_b32 a56, 0
  v_accvgpr_write_b32 a57, 0
  v_accvgpr_write_b32 a58, 0
  v_accvgpr_write_b32 a59, 0
  v_accvgpr_write_b32 a60, 0
  v_accvgpr_write_b32 a61, 0
  v_accvgpr_write_b32 a62, 0
  v_accvgpr_write_b32 a63, 0
  v_accvgpr_write_b32 a64, 0
  v_accvgpr_write_b32 a65, 0
  v_accvgpr_write_b32 a66, 0
  v_accvgpr_write_b32 a67, 0
  v_accvgpr_write_b32 a68, 0
  v_accvgpr_write_b32 a69, 0
  v_accvgpr_write_b32 a70, 0
  v_accvgpr_write_b32 a71, 0
  v_accvgpr_write_b32 a72, 0
  v_accvgpr_write_b32 a73, 0
  v_accvgpr_write_b32 a74, 0
  v_accvgpr_write_b32 a75, 0
  v_accvgpr_write_b32 a76, 0
  v_accvgpr_write_b32 a77, 0
  v_accvgpr_write_b32 a78, 0
  v_accvgpr_write_b32 a79, 0
  v_accvgpr_write_b32 a80, 0
  v_accvgpr_write_b32 a81, 0
  v_accvgpr_write_b32 a82, 0
  v_accvgpr_write_b32 a83, 0
  v_accvgpr_write_b32 a84, 0
  v_accvgpr_write_b32 a85, 0
  v_accvgpr_write_b32 a86, 0
  v_accvgpr_write_b32 a87, 0
  v_accvgpr_write_b32 a88, 0
  v_accvgpr_write_b32 a89, 0
  v_accvgpr_write_b32 a90, 0
  v_accvgpr_write_b32 a91, 0
  v_accvgpr_write_b32 a92, 0
  v_accvgpr_write_b32 a93, 0
  v_accvgpr_write_b32 a94, 0
  v_accvgpr_write_b32 a95, 0
  v_accvgpr_write_b32 a96, 0
  v_accvgpr_write_b32 a97, 0
  v_accvgpr_write_b32 a98, 0
  v_accvgpr_write_b32 a99, 0
  v_accvgpr_write_b32 a100, 0
  v_accvgpr_write_b32 a101, 0
  v_accvgpr_write_b32 a102, 0
  v_accvgpr_write_b32 a103, 0
  v_accvgpr_write_b32 a104, 0
  v_accvgpr_write_b32 a105, 0
  v_accvgpr_write_b32 a106, 0
  v_accvgpr_write_b32 a107, 0
  v_accvgpr_write_b32 a108, 0
  v_accvgpr_write_b32 a109, 0
  v_accvgpr_write_b32 a110, 0
  v_accvgpr_write_b32 a111, 0
  v_accvgpr_write_b32 a112, 0
  v_accvgpr_write_b32 a113, 0
  v_accvgpr_write_b32 a114, 0
  v_accvgpr_write_b32 a115, 0
  v_accvgpr_write_b32 a116, 0
  v_accvgpr_write_b32 a117, 0
  v_accvgpr_write_b32 a118, 0
  v_accvgpr_write_b32 a119, 0
  v_accvgpr_write_b32 a120, 0
  v_accvgpr_write_b32 a121, 0
  v_accvgpr_write_b32 a122, 0
  v_accvgpr_write_b32 a123, 0
  v_accvgpr_write_b32 a124, 0
  v_accvgpr_write_b32 a125, 0
  v_accvgpr_write_b32 a126, 0
  v_accvgpr_write_b32 a127, 0
  v_mov_b32 v8, 0
  v_mov_b32 v9, 0
  v_mov_b32 v10, 0
  v_mov_b32 v11, 0
  v_mov_b32 v52, 0
  v_mov_b32 v53, 0
  v_mov_b32 v54, s24
  v_mov_b32 v55, s24
  v_mov_b32 v56, s24
  v_mov_b32 v57, s24
  v_mov_b32 v58, s24
  v_mov_b32 v59, s24
  v_mov_b32 v60, s24
  v_mov_b32 v61, s24
  v_mov_b32 v62, s24
  v_mov_b32 v63, s24
  v_mov_b32 v104, 0
  v_mov_b32 v105, 0
  v_mov_b32 v4, v2
  v_mov_b32 v64, s24
  v_mov_b32 v65, s24
  v_mov_b32 v66, s24
  v_mov_b32 v67, s24
  v_mov_b32 v68, s24
  v_mov_b32 v69, s24
  v_mov_b32 v70, s24
  v_mov_b32 v71, s24
  v_mov_b32 v72, s24
  v_mov_b32 v73, s24
  v_mov_b32 v74, s24
  v_mov_b32 v75, s24
  v_mov_b32 v76, s24
  v_mov_b32 v77, s24
  v_mov_b32 v78, s24
  v_mov_b32 v79, s24
  v_mov_b32 v12, s24
  v_cmp_le_i32 s[40:41], 0, v5
  v_cmp_le_i32 s[42:43], 1, v5
  v_cmp_le_i32 s[44:45], 2, v5
  v_cmp_le_i32 s[46:47], 3, v5
  v_cndmask_b32 v80, v12, v7, s[40:41]
  v_cndmask_b32 v81, v12, v7, s[42:43]
  v_cndmask_b32 v82, v12, v7, s[44:45]
  v_cndmask_b32 v83, v12, v7, s[46:47]
  v_cmp_le_i32 s[40:41], 8, v5
  v_cmp_le_i32 s[42:43], 9, v5
  v_cmp_le_i32 s[44:45], 10, v5
  v_cmp_le_i32 s[46:47], 11, v5
  v_cndmask_b32 v84, v12, v7, s[40:41]
  v_cndmask_b32 v85, v12, v7, s[42:43]
  v_cndmask_b32 v86, v12, v7, s[44:45]
  v_cndmask_b32 v87, v12, v7, s[46:47]
  v_cmp_le_i32 s[40:41], 16, v5
  v_cmp_le_i32 s[42:43], 17, v5
  v_cmp_le_i32 s[44:45], 18, v5
  v_cmp_le_i32 s[46:47], 19, v5
  v_cndmask_b32 v88, v12, v7, s[40:41]
  v_cndmask_b32 v89, v12, v7, s[42:43]
  v_cndmask_b32 v90, v12, v7, s[44:45]
  v_cndmask_b32 v91, v12, v7, s[46:47]
  v_cmp_le_i32 s[40:41], 24, v5
  v_cmp_le_i32 s[42:43], 25, v5
  v_cmp_le_i32 s[44:45], 26, v5
  v_cmp_le_i32 s[46:47], 27, v5
  v_cndmask_b32 v92, v12, v7, s[40:41]
  v_cndmask_b32 v93, v12, v7, s[42:43]
  v_cndmask_b32 v94, v12, v7, s[44:45]
  v_cndmask_b32 v95, v12, v7, s[46:47]
  s_lshl_b32 s22, s69, 3
  s_add_u32 s22, s22, 8
  s_lshl_b32 s26, s16, 1
  s_sub_u32 s23, 6, s26
  s_waitcnt vmcnt(20)
  s_barrier
  s_cmp_eq_u32 s23, 0
  s_cbranch_scc1 A_go_157
A_idle_156:
  s_waitcnt vmcnt(16)
  s_barrier
  s_sub_u32 s18, s18, 8192
  s_max_i32 s18, s18, s20
  s_sub_u32 s17, s17, 8192
  s_max_i32 s17, s17, s19
  s_add_u32 s21, s21, 16384
  s_and_b32 s21, s21, 131071
M_kv_158:
  s_cmp_ge_u32 s17, s36
  s_cbranch_scc1 M_kvok_159
  s_mov_b32 s76, 0
  s_mov_b32 s78, 25
  s_mov_b32 s77, 319488
  s_cmp_eq_u32 s68, 1
  s_cmov_b32 s76, 128
  s_cmov_b32 s78, 29
  s_cmov_b32 s77, 81920
  s_cmp_eq_u32 s68, 2
  s_cmov_b32 s76, 768
  s_cmov_b32 s78, 10
  s_cmov_b32 s77, 0
  s_add_u32 s76, s76, s67
  s_mov_b32 s71, 0
  s_branch M_sg_161
M_sw_160:
  s_sleep 8
  s_add_u32 s71, s71, 1
  s_cmp_gt_u32 s71, 262144
  s_cbranch_scc1 M_exit
M_sg_161:
  s_mov_b32 s79, 0
  s_atomic_or s79, s[72:73], s76 glc
  s_waitcnt lgkmcnt(0)
  s_cmp_lt_u32 s79, s78
  s_cbranch_scc1 M_sw_160
  s_add_u32 s36, s77, s19
  s_add_u32 s68, s68, 1
  s_branch M_kv_158
M_kvok_159:
  s_mov_b32 m0, s21
  s_nop 0
  buffer_load_dwordx4 v3, s[4:7], s18 offen offset:0 sc1 lds
  buffer_load_dwordx4 v3, s[4:7], s18 offen offset:1024 sc1 lds
  s_add_u32 m0, s21, 8192
  s_nop 0
  buffer_load_dwordx4 v3, s[4:7], s17 offen offset:0 sc1 lds
  buffer_load_dwordx4 v3, s[4:7], s17 offen offset:1024 sc1 lds
  v_add_u32 v4, 16384, v4
  v_and_b32 v4, 131071, v4
  s_sub_u32 s22, s22, 1
  s_sub_u32 s23, s23, 1
  s_cmp_lg_u32 s23, 0
  s_cbranch_scc1 A_idle_156
A_go_157:
  ds_read_b128 a[224:227], v4 offset:0
  ds_read_b128 a[228:231], v4 offset:2048
  ds_read_b128 a[232:235], v4 offset:4096
  ds_read_b128 a[236:239], v4 offset:6144
  ds_read_b128 a[240:243], v4 offset:1024
  ds_read_b128 a[244:247], v4 offset:3072
  ds_read_b128 a[248:251], v4 offset:5120
  ds_read_b128 a[252:255], v4 offset:7168
  ds_read_b128 a[192:195], v4 offset:8192
  ds_read_b128 a[196:199], v4 offset:9216
  ds_read_b128 a[200:203], v4 offset:10240
  ds_read_b128 a[204:207], v4 offset:11264
  ds_read_b128 a[208:211], v4 offset:12288
  ds_read_b128 a[212:215], v4 offset:13312
  ds_read_b128 a[216:219], v4 offset:14336
  ds_read_b128 a[220:223], v4 offset:15360
  v_add_u32 v4, 16384, v4
  v_and_b32 v4, 131071, v4
  s_waitcnt lgkmcnt(8)
.p2align 6
A_top_162:
  s_waitcnt lgkmcnt(7)
  v_mfma_f32_32x32x16_bf16 v[32:47], a[192:195], a[128:131], v[64:79]
  s_waitcnt lgkmcnt(6)
  v_exp_f32 v54, v54
  v_add_f32 v11, v11, v53
  v_cvt_pk_bf16_f32 v106, v52, v53
  v_mfma_f32_32x32x16_bf16 v[32:47], a[196:199], a[132:135], v[32:47]
  s_waitcnt lgkmcnt(4)
  v_exp_f32 v55, v55
  v_add_f32 v10, v10, v54
  v_mfma_f32_32x32x16_bf16 v[32:47], a[200:203], a[136:139], v[32:47]
  v_exp_f32 v56, v56
  v_add_f32 v11, v11, v55
  v_cvt_pk_bf16_f32 v107, v54, v55
  v_mfma_f32_32x32x16_bf16 v[32:47], a[204:207], a[140:143], v[32:47]
  s_waitcnt lgkmcnt(2)
  v_exp_f32 v57, v57
  v_add_f32 v10, v10, v56
  v_mfma_f32_32x32x16_bf16 v[32:47], a[208:211], a[144:147], v[32:47]
  v_exp_f32 v58, v58
  v_add_f32 v11, v11, v57
  v_cvt_pk_bf16_f32 v108, v56, v57
  v_mfma_f32_32x32x16_bf16 v[32:47], a[212:215], a[148:151], v[32:47]
  s_waitcnt lgkmcnt(0)
  v_exp_f32 v59, v59
  v_add_f32 v10, v10, v58
  v_mfma_f32_32x32x16_bf16 v[32:47], a[216:219], a[152:155], v[32:47]
  v_exp_f32 v60, v60
  v_add_f32 v11, v11, v59
  v_cvt_pk_bf16_f32 v109, v58, v59
  v_mfma_f32_32x32x16_bf16 v[32:47], a[220:223], a[156:159], v[32:47]
  s_waitcnt vmcnt(16)
  s_barrier
  v_exp_f32 v61, v61
  v_add_f32 v10, v10, v60
  v_mfma_f32_32x32x16_bf16 a[64:79], a[224:227], v[104:107], a[64:79]
  ds_read_b128 a[224:227], v4 offset:0
  v_exp_f32 v62, v62
  v_add_f32 v11, v11, v61
  v_cvt_pk_bf16_f32 v110, v60, v61
  v_mfma_f32_32x32x16_bf16 a[80:95], a[228:231], v[104:107], a[80:95]
  s_sub_u32 s18, s18, 8192
  ds_read_b128 a[228:231], v4 offset:2048
  v_exp_f32 v63, v63
  v_add_f32 v10, v10, v62
  v_mfma_f32_32x32x16_bf16 a[96:111], a[232:235], v[104:107], a[96:111]
  s_max_i32 s18, s18, s20
  ds_read_b128 a[232:235], v4 offset:4096
  v_exp_f32 v32, v32
  v_add_f32 v11, v11, v63
  v_cvt_pk_bf16_f32 v111, v62, v63
  v_mfma_f32_32x32x16_bf16 a[112:127], a[236:239], v[104:107], a[112:127]
  s_sub_u32 s17, s17, 8192
  ds_read_b128 a[236:239], v4 offset:6144
  v_exp_f32 v33, v33
  v_add_f32 v8, v8, v32
  v_mfma_f32_32x32x16_bf16 a[64:79], a[240:243], v[108:111], a[64:79]
  s_max_i32 s17, s17, s19
  ds_read_b128 a[240:243], v4 offset:1024
  v_exp_f32 v34, v34
  v_add_f32 v9, v9, v33
  v_cvt_pk_bf16_f32 v96, v32, v33
  v_mfma_f32_32x32x16_bf16 a[80:95], a[244:247], v[108:111], a[80:95]
  s_add_u32 s21, s21, 16384
  ds_read_b128 a[244:247], v4 offset:3072
  v_exp_f32 v35, v35
  v_add_f32 v8, v8, v34
  v_mfma_f32_32x32x16_bf16 a[96:111], a[248:251], v[108:111], a[96:111]
  s_and_b32 s21, s21, 131071
  ds_read_b128 a[248:251], v4 offset:5120
  v_exp_f32 v36, v36
  v_add_f32 v9, v9, v35
  v_cvt_pk_bf16_f32 v97, v34, v35
  v_mfma_f32_32x32x16_bf16 a[112:127], a[252:255], v[108:111], a[112:127]
  ds_read_b128 a[252:255], v4 offset:7168
  v_exp_f32 v37, v37
  v_add_f32 v8, v8, v36
  v_mfma_f32_32x32x16_bf16 v[48:63], a[192:195], a[160:163], v[80:95]
  s_add_u32 s23, s23, 1
  ds_read_b128 a[192:195], v4 offset:8192
  v_exp_f32 v38, v38
  v_add_f32 v9, v9, v37
  v_cvt_pk_bf16_f32 v98, v36, v37
  v_mfma_f32_32x32x16_bf16 v[48:63], a[196:199], a[164:167], v[48:63]
  s_sub_u32 s22, s22, 1
  ds_read_b128 a[196:199], v4 offset:9216
  v_exp_f32 v39, v39
  v_add_f32 v8, v8, v38
  v_mfma_f32_32x32x16_bf16 v[48:63], a[200:203], a[168:171], v[48:63]
  s_cmp_lt_u32 s23, 3
  ds_read_b128 a[200:203], v4 offset:10240
  v_exp_f32 v40, v40
  v_add_f32 v9, v9, v39
  v_cvt_pk_bf16_f32 v99, v38, v39
  v_mfma_f32_32x32x16_bf16 v[48:63], a[204:207], a[172:175], v[48:63]
  s_cbranch_scc1 A_upd_163
A_back_164:
  ds_read_b128 a[204:207], v4 offset:11264
  v_exp_f32 v41, v41
  v_add_f32 v8, v8, v40
  v_mfma_f32_32x32x16_bf16 v[48:63], a[208:211], a[176:179], v[48:63]
  s_cmp_lt_u32 s17, s36
  ds_read_b128 a[208:211], v4 offset:12288
  v_exp_f32 v42, v42
  v_add_f32 v9, v9, v41
  v_cvt_pk_bf16_f32 v100, v40, v41
  v_mfma_f32_32x32x16_bf16 v[48:63], a[212:215], a[180:183], v[48:63]
  s_cbranch_scc1 A_kvw_166
A_kvb_167:
  ds_read_b128 a[212:215], v4 offset:13312
  v_exp_f32 v43, v43
  v_add_f32 v8, v8, v42
  v_mfma_f32_32x32x16_bf16 v[48:63], a[216:219], a[184:187], v[48:63]
  s_mov_b32 m0, s21
  ds_read_b128 a[216:219], v4 offset:14336
  v_exp_f32 v44, v44
  v_add_f32 v9, v9, v43
  v_cvt_pk_bf16_f32 v101, v42, v43
  v_mfma_f32_32x32x16_bf16 v[48:63], a[220:223], a[188:191], v[48:63]
  s_waitcnt lgkmcnt(13)
  ds_read_b128 a[220:223], v4 offset:15360
  v_exp_f32 v45, v45
  v_add_f32 v8, v8, v44
  v_mfma_f32_32x32x16_bf16 a[0:15], a[224:227], v[96:99], a[0:15]
  buffer_load_dwordx4 v3, s[4:7], s18 offen offset:0 sc1 lds
  v_exp_f32 v46, v46
  v_add_f32 v9, v9, v45
  v_cvt_pk_bf16_f32 v102, v44, v45
  v_mfma_f32_32x32x16_bf16 a[16:31], a[228:231], v[96:99], a[16:31]
  s_waitcnt lgkmcnt(12)
  v_exp_f32 v47, v47
  v_add_f32 v8, v8, v46
  v_add_u32 v4, 16384, v4
  v_mfma_f32_32x32x16_bf16 a[32:47], a[232:235], v[96:99], a[32:47]
  buffer_load_dwordx4 v3, s[4:7], s18 offen offset:1024 sc1 lds
  v_exp_f32 v48, v48
  v_add_f32 v9, v9, v47
  v_cvt_pk_bf16_f32 v103, v46, v47
  v_mfma_f32_32x32x16_bf16 a[48:63], a[236:239], v[96:99], a[48:63]
  s_waitcnt lgkmcnt(10)
  s_add_u32 m0, s21, 8192
  v_exp_f32 v49, v49
  v_add_f32 v10, v10, v48
  v_and_b32 v4, 131071, v4
  v_mfma_f32_32x32x16_bf16 a[0:15], a[240:243], v[100:103], a[0:15]
  buffer_load_dwordx4 v3, s[4:7], s17 offen offset:0 sc1 lds
  v_exp_f32 v50, v50
  v_add_f32 v11, v11, v49
  v_cvt_pk_bf16_f32 v104, v48, v49
  v_mfma_f32_32x32x16_bf16 a[16:31], a[244:247], v[100:103], a[16:31]
  s_waitcnt lgkmcnt(8)
  s_cmp_lg_u32 s22, 0
  v_exp_f32 v51, v51
  v_add_f32 v10, v10, v50
  v_mfma_f32_32x32x16_bf16 a[32:47], a[248:251], v[100:103], a[32:47]
  buffer_load_dwordx4 v3, s[4:7], s17 offen offset:1024 sc1 lds
  v_exp_f32 v52, v52
  v_add_f32 v11, v11, v51
  v_cvt_pk_bf16_f32 v105, v50, v51
  v_mfma_f32_32x32x16_bf16 a[48:63], a[252:255], v[100:103], a[48:63]
  v_exp_f32 v53, v53
  v_add_f32 v10, v10, v52
  s_cbranch_scc1 A_top_162
  v_exp_f32 v54, v54
  v_add_f32 v11, v11, v53
  v_cvt_pk_bf16_f32 v106, v52, v53
  v_exp_f32 v55, v55
  v_add_f32 v10, v10, v54
  v_exp_f32 v56, v56
  v_add_f32 v11, v11, v55
  v_cvt_pk_bf16_f32 v107, v54, v55
  v_exp_f32 v57, v57
  v_add_f32 v10, v10, v56
  v_exp_f32 v58, v58
  v_add_f32 v11, v11, v57
  v_cvt_pk_bf16_f32 v108, v56, v57
  v_exp_f32 v59, v59
  v_add_f32 v10, v10, v58
  v_exp_f32 v60, v60
  v_add_f32 v11, v11, v59
  v_cvt_pk_bf16_f32 v109, v58, v59
  v_exp_f32 v61, v61
  v_add_f32 v10, v10, v60
  v_exp_f32 v62, v62
  v_add_f32 v11, v11, v61
  v_cvt_pk_bf16_f32 v110, v60, v61
  v_exp_f32 v63, v63
  v_add_f32 v10, v10, v62
  v_add_f32 v11, v11, v63
  v_cvt_pk_bf16_f32 v111, v62, v63
  s_nop 1
  v_mfma_f32_32x32x16_bf16 a[64:79], a[224:227], v[104:107], a[64:79]
  v_mfma_f32_32x32x16_bf16 a[80:95], a[228:231], v[104:107], a[80:95]
  v_mfma_f32_32x32x16_bf16 a[96:111], a[232:235], v[104:107], a[96:111]
  v_mfma_f32_32x32x16_bf16 a[112:127], a[236:239], v[104:107], a[112:127]
  v_mfma_f32_32x32x16_bf16 a[64:79], a[240:243], v[108:111], a[64:79]
  v_mfma_f32_32x32x16_bf16 a[80:95], a[244:247], v[108:111], a[80:95]
  v_mfma_f32_32x32x16_bf16 a[96:111], a[248:251], v[108:111], a[96:111]
  v_mfma_f32_32x32x16_bf16 a[112:127], a[252:255], v[108:111], a[112:127]
  v_add_f32 v8, v8, v9
  v_mov_b32 v9, v8
  s_nop 1
  v_permlane32_swap_b32 v8, v9
  s_nop 1
  v_add_f32 v8, v8, v9
  v_add_f32 v10, v10, v11
  v_mov_b32 v11, v10
  s_nop 1
  v_permlane32_swap_b32 v10, v11
  s_nop 1
  v_add_f32 v10, v10, v11
  v_subrev_u32 v12, 0x2f800000, v8
  v_subrev_u32 v13, 0x2f800000, v10
  v_max_u32 v12, v12, v13
  v_cmp_le_u32 vcc, 0x28000000, v12
  s_nop 1
  s_cmp_lg_u64 vcc, 0
  s_cselect_b32 s26, 1, 0
  v_mov_b32 v12, s26
  s_lshl_b32 s26, s16, 2
  s_add_u32 s26, s26, 131072
  v_mov_b32 v13, s26
  ds_write_b32 v13, v12
  v_mov_b32 v14, 131072
  s_waitcnt vmcnt(0) lgkmcnt(0)
  s_barrier
  ds_read_b128 v[16:19], v14
  v_rcp_f32 v8, v8
  v_rcp_f32 v10, v10
  s_waitcnt lgkmcnt(0)
  v_or3_b32 v12, v16, v17, v18
  v_or_b32 v12, v12, v19
  s_nop 0
  v_readfirstlane_b32 s26, v12
  s_nop 1
  s_cmp_gt_u32 s26, s29
  s_cbranch_scc1 A_slow_168
  s_add_u32 s28, s25, 100663296
  v_accvgpr_read_b32 v112, a0
  v_accvgpr_read_b32 v113, a1
  v_accvgpr_read_b32 v114, a2
  v_accvgpr_read_b32 v115, a3
  v_accvgpr_read_b32 v116, a4
  v_accvgpr_read_b32 v117, a5
  v_accvgpr_read_b32 v118, a6
  v_accvgpr_read_b32 v119, a7
  v_pk_mul_f32 v[112:113], v[112:113], v[8:9] op_sel_hi:[1,0]
  v_pk_mul_f32 v[114:115], v[114:115], v[8:9] op_sel_hi:[1,0]
  v_pk_mul_f32 v[116:117], v[116:117], v[8:9] op_sel_hi:[1,0]
  v_pk_mul_f32 v[118:119], v[118:119], v[8:9] op_sel_hi:[1,0]
  v_cvt_pk_bf16_f32 v120, v112, v113
  v_cvt_pk_bf16_f32 v121, v114, v115
  v_cvt_pk_bf16_f32 v122, v116, v117
  v_cvt_pk_bf16_f32 v123, v118, v119
  buffer_store_dwordx4 v[120:123], v2, s[4:7], s28 offen offset:0 sc1
  v_accvgpr_read_b32 v124, a8
  v_accvgpr_read_b32 v125, a9
  v_accvgpr_read_b32 v126, a10
  v_accvgpr_read_b32 v127, a11
  v_accvgpr_read_b32 v128, a12
  v_accvgpr_read_b32 v129, a13
  v_accvgpr_read_b32 v130, a14
  v_accvgpr_read_b32 v131, a15
  v_pk_mul_f32 v[124:125], v[124:125], v[8:9] op_sel_hi:[1,0]
  v_pk_mul_f32 v[126:127], v[126:127], v[8:9] op_sel_hi:[1,0]
  v_pk_mul_f32 v[128:129], v[128:129], v[8:9] op_sel_hi:[1,0]
  v_pk_mul_f32 v[130:131], v[130:131], v[8:9] op_sel_hi:[1,0]
  v_cvt_pk_bf16_f32 v132, v124, v125
  v_cvt_pk_bf16_f32 v133, v126, v127
  v_cvt_pk_bf16_f32 v134, v128, v129
  v_cvt_pk_bf16_f32 v135, v130, v131
  buffer_store_dwordx4 v[132:135], v2, s[4:7], s28 offen offset:1024 sc1
  v_accvgpr_read_b32 v136, a16
  v_accvgpr_read_b32 v137, a17
  v_accvgpr_read_b32 v138, a18
  v_accvgpr_read_b32 v139, a19
  v_accvgpr_read_b32 v140, a20
  v_accvgpr_read_b32 v141, a21
  v_accvgpr_read_b32 v142, a22
  v_accvgpr_read_b32 v143, a23
  v_pk_mul_f32 v[136:137], v[136:137], v[8:9] op_sel_hi:[1,0]
  v_pk_mul_f32 v[138:139], v[138:139], v[8:9] op_sel_hi:[1,0]
  v_pk_mul_f32 v[140:141], v[140:141], v[8:9] op_sel_hi:[1,0]
  v_pk_mul_f32 v[142:143], v[142:143], v[8:9] op_sel_hi:[1,0]
  v_cvt_pk_bf16_f32 v144, v136, v137
  v_cvt_pk_bf16_f32 v145, v138, v139
  v_cvt_pk_bf16_f32 v146, v140, v141
  v_cvt_pk_bf16_f32 v147, v142, v143
  buffer_store_dwordx4 v[144:147], v2, s[4:7], s28 offen offset:2048 sc1
  v_accvgpr_read_b32 v148, a24
  v_accvgpr_read_b32 v149, a25
  v_accvgpr_read_b32 v150, a26
  v_accvgpr_read_b32 v151, a27
  v_accvgpr_read_b32 v152, a28
  v_accvgpr_read_b32 v153, a29
  v_accvgpr_read_b32 v154, a30
  v_accvgpr_read_b32 v155, a31
  v_pk_mul_f32 v[148:149], v[148:149], v[8:9] op_sel_hi:[1,0]
  v_pk_mul_f32 v[150:151], v[150:151], v[8:9] op_sel_hi:[1,0]
  v_pk_mul_f32 v[152:153], v[152:153], v[8:9] op_sel_hi:[1,0]
  v_pk_mul_f32 v[154:155], v[154:155], v[8:9] op_sel_hi:[1,0]
  v_cvt_pk_bf16_f32 v156, v148, v149
  v_cvt_pk_bf16_f32 v157, v150, v151
  v_cvt_pk_bf16_f32 v158, v152, v153
  v_cvt_pk_bf16_f32 v159, v154, v155
  buffer_store_dwordx4 v[156:159], v2, s[4:7], s28 offen offset:3072 sc1
  s_add_u32 s28, s25, 100667392
  v_accvgpr_read_b32 v112, a32
  v_accvgpr_read_b32 v113, a33
  v_accvgpr_read_b32 v114, a34
  v_accvgpr_read_b32 v115, a35
  v_accvgpr_read_b32 v116, a36
  v_accvgpr_read_b32 v117, a37
  v_accvgpr_read_b32 v118, a38
  v_accvgpr_read_b32 v119, a39
  v_pk_mul_f32 v[112:113], v[112:113], v[8:9] op_sel_hi:[1,0]
  v_pk_mul_f32 v[114:115], v[114:115], v[8:9] op_sel_hi:[1,0]
  v_pk_mul_f32 v[116:117], v[116:117], v[8:9] op_sel_hi:[1,0]
  v_pk_mul_f32 v[118:119], v[118:119], v[8:9] op_sel_hi:[1,0]
  v_cvt_pk_bf16_f32 v120, v112, v113
  v_cvt_pk_bf16_f32 v121, v114, v115
  v_cvt_pk_bf16_f32 v122, v116, v117
  v_cvt_pk_bf16_f32 v123, v118, v119
  buffer_store_dwordx4 v[120:123], v2, s[4:7], s28 offen offset:0 sc1
  v_accvgpr_read_b32 v124, a40
  v_accvgpr_read_b32 v125, a41
  v_accvgpr_read_b32 v126, a42
  v_accvgpr_read_b32 v127, a43
  v_accvgpr_read_b32 v128, a44
  v_accvgpr_read_b32 v129, a45
  v_accvgpr_read_b32 v130, a46
  v_accvgpr_read_b32 v131, a47
  v_pk_mul_f32 v[124:125], v[124:125], v[8:9] op_sel_hi:[1,0]
  v_pk_mul_f32 v[126:127], v[126:127], v[8:9] op_sel_hi:[1,0]
  v_pk_mul_f32 v[128:129], v[128:129], v[8:9] op_sel_hi:[1,0]
  v_pk_mul_f32 v[130:131], v[130:131], v[8:9] op_sel_hi:[1,0]
  v_cvt_pk_bf16_f32 v132, v124, v125
  v_cvt_pk_bf16_f32 v133, v126, v127
  v_cvt_pk_bf16_f32 v134, v128, v129
  v_cvt_pk_bf16_f32 v135, v130, v131
  buffer_store_dwordx4 v[132:135], v2, s[4:7], s28 offen offset:1024 sc1
  v_accvgpr_read_b32 v136, a48
  v_accvgpr_read_b32 v137, a49
  v_accvgpr_read_b32 v138, a50
  v_accvgpr_read_b32 v139, a51
  v_accvgpr_read_b32 v140, a52
  v_accvgpr_read_b32 v141, a53
  v_accvgpr_read_b32 v142, a54
  v_accvgpr_read_b32 v143, a55
  v_pk_mul_f32 v[136:137], v[136:137], v[8:9] op_sel_hi:[1,0]
  v_pk_mul_f32 v[138:139], v[138:139], v[8:9] op_sel_hi:[1,0]
  v_pk_mul_f32 v[140:141], v[140:141], v[8:9] op_sel_hi:[1,0]
  v_pk_mul_f32 v[142:143], v[142:143], v[8:9] op_sel_hi:[1,0]
  v_cvt_pk_bf16_f32 v144, v136, v137
  v_cvt_pk_bf16_f32 v145, v138, v139
  v_cvt_pk_bf16_f32 v146, v140, v141
  v_cvt_pk_bf16_f32 v147, v142, v143
  buffer_store_dwordx4 v[144:147], v2, s[4:7], s28 offen offset:2048 sc1
  v_accvgpr_read_b32 v148, a56
  v_accvgpr_read_b32 v149, a57
  v_accvgpr_read_b32 v150, a58
  v_accvgpr_read_b32 v151, a59
  v_accvgpr_read_b32 v152, a60
  v_accvgpr_read_b32 v153, a61
  v_accvgpr_read_b32 v154, a62
  v_accvgpr_read_b32 v155, a63
  v_pk_mul_f32 v[148:149], v[148:149], v[8:9] op_sel_hi:[1,0]
  v_pk_mul_f32 v[150:151], v[150:151], v[8:9] op_sel_hi:[1,0]
  v_pk_mul_f32 v[152:153], v[152:153], v[8:9] op_sel_hi:[1,0]
  v_pk_mul_f32 v[154:155], v[154:155], v[8:9] op_sel_hi:[1,0]
  v_cvt_pk_bf16_f32 v156, v148, v149
  v_cvt_pk_bf16_f32 v157, v150, v151
  v_cvt_pk_bf16_f32 v158, v152, v153
  v_cvt_pk_bf16_f32 v159, v154, v155
  buffer_store_dwordx4 v[156:159], v2, s[4:7], s28 offen offset:3072 sc1
  s_add_u32 s28, s25, 100671488
  v_accvgpr_read_b32 v112, a64
  v_accvgpr_read_b32 v113, a65
  v_accvgpr_read_b32 v114, a66
  v_accvgpr_read_b32 v115, a67
  v_accvgpr_read_b32 v116, a68
  v_accvgpr_read_b32 v117, a69
  v_accvgpr_read_b32 v118, a70
  v_accvgpr_read_b32 v119, a71
  v_pk_mul_f32 v[112:113], v[112:113], v[10:11] op_sel_hi:[1,0]
  v_pk_mul_f32 v[114:115], v[114:115], v[10:11] op_sel_hi:[1,0]
  v_pk_mul_f32 v[116:117], v[116:117], v[10:11] op_sel_hi:[1,0]
  v_pk_mul_f32 v[118:119], v[118:119], v[10:11] op_sel_hi:[1,0]
  v_cvt_pk_bf16_f32 v120, v112, v113
  v_cvt_pk_bf16_f32 v121, v114, v115
  v_cvt_pk_bf16_f32 v122, v116, v117
  v_cvt_pk_bf16_f32 v123, v118, v119
  buffer_store_dwordx4 v[120:123], v2, s[4:7], s28 offen offset:0 sc1
  v_accvgpr_read_b32 v124, a72
  v_accvgpr_read_b32 v125, a73
  v_accvgpr_read_b32 v126, a74
  v_accvgpr_read_b32 v127, a75
  v_accvgpr_read_b32 v128, a76
  v_accvgpr_read_b32 v129, a77
  v_accvgpr_read_b32 v130, a78
  v_accvgpr_read_b32 v131, a79
  v_pk_mul_f32 v[124:125], v[124:125], v[10:11] op_sel_hi:[1,0]
  v_pk_mul_f32 v[126:127], v[126:127], v[10:11] op_sel_hi:[1,0]
  v_pk_mul_f32 v[128:129], v[128:129], v[10:11] op_sel_hi:[1,0]
  v_pk_mul_f32 v[130:131], v[130:131], v[10:11] op_sel_hi:[1,0]
  v_cvt_pk_bf16_f32 v132, v124, v125
  v_cvt_pk_bf16_f32 v133, v126, v127
  v_cvt_pk_bf16_f32 v134, v128, v129
  v_cvt_pk_bf16_f32 v135, v130, v131
  buffer_store_dwordx4 v[132:135], v2, s[4:7], s28 offen offset:1024 sc1
  v_accvgpr_read_b32 v136, a80
  v_accvgpr_read_b32 v137, a81
  v_accvgpr_read_b32 v138, a82
  v_accvgpr_read_b32 v139, a83
  v_accvgpr_read_b32 v140, a84
  v_accvgpr_read_b32 v141, a85
  v_accvgpr_read_b32 v142, a86
  v_accvgpr_read_b32 v143, a87
  v_pk_mul_f32 v[136:137], v[136:137], v[10:11] op_sel_hi:[1,0]
  v_pk_mul_f32 v[138:139], v[138:139], v[10:11] op_sel_hi:[1,0]
  v_pk_mul_f32 v[140:141], v[140:141], v[10:11] op_sel_hi:[1,0]
  v_pk_mul_f32 v[142:143], v[142:143], v[10:11] op_sel_hi:[1,0]
  v_cvt_pk_bf16_f32 v144, v136, v137
  v_cvt_pk_bf16_f32 v145, v138, v139
  v_cvt_pk_bf16_f32 v146, v140, v141
  v_cvt_pk_bf16_f32 v147, v142, v143
  buffer_store_dwordx4 v[144:147], v2, s[4:7], s28 offen offset:2048 sc1
  v_accvgpr_read_b32 v148, a88
  v_accvgpr_read_b32 v149, a89
  v_accvgpr_read_b32 v150, a90
  v_accvgpr_read_b32 v151, a91
  v_accvgpr_read_b32 v152, a92
  v_accvgpr_read_b32 v153, a93
  v_accvgpr_read_b32 v154, a94
  v_accvgpr_read_b32 v155, a95
  v_pk_mul_f32 v[148:149], v[148:149], v[10:11] op_sel_hi:[1,0]
  v_pk_mul_f32 v[150:151], v[150:151], v[10:11] op_sel_hi:[1,0]
  v_pk_mul_f32 v[152:153], v[152:153], v[10:11] op_sel_hi:[1,0]
  v_pk_mul_f32 v[154:155], v[154:155], v[10:11] op_sel_hi:[1,0]
  v_cvt_pk_bf16_f32 v156, v148, v149
  v_cvt_pk_bf16_f32 v157, v150, v151
  v_cvt_pk_bf16_f32 v158, v152, v153
  v_cvt_pk_bf16_f32 v159, v154, v155
  buffer_store_dwordx4 v[156:159], v2, s[4:7], s28 offen offset:3072 sc1
  s_add_u32 s28, s25, 100675584
  v_accvgpr_read_b32 v112, a96
  v_accvgpr_read_b32 v113, a97
  v_accvgpr_read_b32 v114, a98
  v_accvgpr_read_b32 v115, a99
  v_accvgpr_read_b32 v116, a100
  v_accvgpr_read_b32 v117, a101
  v_accvgpr_read_b32 v118, a102
  v_accvgpr_read_b32 v119, a103
  v_pk_mul_f32 v[112:113], v[112:113], v[10:11] op_sel_hi:[1,0]
  v_pk_mul_f32 v[114:115], v[114:115], v[10:11] op_sel_hi:[1,0]
  v_pk_mul_f32 v[116:117], v[116:117], v[10:11] op_sel_hi:[1,0]
  v_pk_mul_f32 v[118:119], v[118:119], v[10:11] op_sel_hi:[1,0]
  v_cvt_pk_bf16_f32 v120, v112, v113
  v_cvt_pk_bf16_f32 v121, v114, v115
  v_cvt_pk_bf16_f32 v122, v116, v117
  v_cvt_pk_bf16_f32 v123, v118, v119
  buffer_store_dwordx4 v[120:123], v2, s[4:7], s28 offen offset:0 sc1
  v_accvgpr_read_b32 v124, a104
  v_accvgpr_read_b32 v125, a105
  v_accvgpr_read_b32 v126, a106
  v_accvgpr_read_b32 v127, a107
  v_accvgpr_read_b32 v128, a108
  v_accvgpr_read_b32 v129, a109
  v_accvgpr_read_b32 v130, a110
  v_accvgpr_read_b32 v131, a111
  v_pk_mul_f32 v[124:125], v[124:125], v[10:11] op_sel_hi:[1,0]
  v_pk_mul_f32 v[126:127], v[126:127], v[10:11] op_sel_hi:[1,0]
  v_pk_mul_f32 v[128:129], v[128:129], v[10:11] op_sel_hi:[1,0]
  v_pk_mul_f32 v[130:131], v[130:131], v[10:11] op_sel_hi:[1,0]
  v_cvt_pk_bf16_f32 v132, v124, v125
  v_cvt_pk_bf16_f32 v133, v126, v127
  v_cvt_pk_bf16_f32 v134, v128, v129
  v_cvt_pk_bf16_f32 v135, v130, v131
  buffer_store_dwordx4 v[132:135], v2, s[4:7], s28 offen offset:1024 sc1
  v_accvgpr_read_b32 v136, a112
  v_accvgpr_read_b32 v137, a113
  v_accvgpr_read_b32 v138, a114
  v_accvgpr_read_b32 v139, a115
  v_accvgpr_read_b32 v140, a116
  v_accvgpr_read_b32 v141, a117
  v_accvgpr_read_b32 v142, a118
  v_accvgpr_read_b32 v143, a119
  v_pk_mul_f32 v[136:137], v[136:137], v[10:11] op_sel_hi:[1,0]
  v_pk_mul_f32 v[138:139], v[138:139], v[10:11] op_sel_hi:[1,0]
  v_pk_mul_f32 v[140:141], v[140:141], v[10:11] op_sel_hi:[1,0]
  v_pk_mul_f32 v[142:143], v[142:143], v[10:11] op_sel_hi:[1,0]
  v_cvt_pk_bf16_f32 v144, v136, v137
  v_cvt_pk_bf16_f32 v145, v138, v139
  v_cvt_pk_bf16_f32 v146, v140, v141
  v_cvt_pk_bf16_f32 v147, v142, v143
  buffer_store_dwordx4 v[144:147], v2, s[4:7], s28 offen offset:2048 sc1
  v_accvgpr_read_b32 v148, a120
  v_accvgpr_read_b32 v149, a121
  v_accvgpr_read_b32 v150, a122
  v_accvgpr_read_b32 v151, a123
  v_accvgpr_read_b32 v152, a124
  v_accvgpr_read_b32 v153, a125
  v_accvgpr_read_b32 v154, a126
  v_accvgpr_read_b32 v155, a127
  v_pk_mul_f32 v[148:149], v[148:149], v[10:11] op_sel_hi:[1,0]
  v_pk_mul_f32 v[150:151], v[150:151], v[10:11] op_sel_hi:[1,0]
  v_pk_mul_f32 v[152:153], v[152:153], v[10:11] op_sel_hi:[1,0]
  v_pk_mul_f32 v[154:155], v[154:155], v[10:11] op_sel_hi:[1,0]
  v_cvt_pk_bf16_f32 v156, v148, v149
  v_cvt_pk_bf16_f32 v157, v150, v151
  v_cvt_pk_bf16_f32 v158, v152, v153
  v_cvt_pk_bf16_f32 v159, v154, v155
  buffer_store_dwordx4 v[156:159], v2, s[4:7], s28 offen offset:3072 sc1
  s_branch A_out_165
A_kvw_166:
M_kv_169:
  s_cmp_ge_u32 s17, s36
  s_cbranch_scc1 M_kvok_170
  s_mov_b32 s76, 0
  s_mov_b32 s78, 25
  s_mov_b32 s77, 319488
  s_cmp_eq_u32 s68, 1
  s_cmov_b32 s76, 128
  s_cmov_b32 s78, 29
  s_cmov_b32 s77, 81920
  s_cmp_eq_u32 s68, 2
  s_cmov_b32 s76, 768
  s_cmov_b32 s78, 10
  s_cmov_b32 s77, 0
  s_add_u32 s76, s76, s67
  s_mov_b32 s71, 0
  s_branch M_sg_172
M_sw_171:
  s_sleep 8
  s_add_u32 s71, s71, 1
  s_cmp_gt_u32 s71, 262144
  s_cbranch_scc1 M_exit
M_sg_172:
  s_mov_b32 s79, 0
  s_atomic_or s79, s[72:73], s76 glc
  s_waitcnt lgkmcnt(0)
  s_cmp_lt_u32 s79, s78
  s_cbranch_scc1 M_sw_171
  s_add_u32 s36, s77, s19
  s_add_u32 s68, s68, 1
  s_branch M_kv_169
M_kvok_170:
  s_branch A_kvb_167
A_upd_163:
  s_cmp_eq_u32 s23, 2
  s_cbranch_scc1 A_upd2_173
  v_mov_b32 v12, s24
  v_cmp_le_i32 s[40:41], 0, v5
  v_cmp_le_i32 s[42:43], 1, v5
  v_cmp_le_i32 s[44:45], 2, v5
  v_cmp_le_i32 s[46:47], 3, v5
  v_cndmask_b32 v64, v12, v6, s[40:41]
  v_cndmask_b32 v65, v12, v6, s[42:43]
  v_cndmask_b32 v66, v12, v6, s[44:45]
  v_cndmask_b32 v67, v12, v6, s[46:47]
  v_cmp_le_i32 s[40:41], 8, v5
  v_cmp_le_i32 s[42:43], 9, v5
  v_cmp_le_i32 s[44:45], 10, v5
  v_cmp_le_i32 s[46:47], 11, v5
  v_cndmask_b32 v68, v12, v6, s[40:41]
  v_cndmask_b32 v69, v12, v6, s[42:43]
  v_cndmask_b32 v70, v12, v6, s[44:45]
  v_cndmask_b32 v71, v12, v6, s[46:47]
  v_cmp_le_i32 s[40:41], 16, v5
  v_cmp_le_i32 s[42:43], 17, v5
  v_cmp_le_i32 s[44:45], 18, v5
  v_cmp_le_i32 s[46:47], 19, v5
  v_cndmask_b32 v72, v12, v6, s[40:41]
  v_cndmask_b32 v73, v12, v6, s[42:43]
  v_cndmask_b32 v74, v12, v6, s[44:45]
  v_cndmask_b32 v75, v12, v6, s[46:47]
  v_cmp_le_i32 s[40:41], 24, v5
  v_cmp_le_i32 s[42:43], 25, v5
  v_cmp_le_i32 s[44:45], 26, v5
  v_cmp_le_i32 s[46:47], 27, v5
  v_cndmask_b32 v76, v12, v6, s[40:41]
  v_cndmask_b32 v77, v12, v6, s[42:43]
  v_cndmask_b32 v78, v12, v6, s[44:45]
  v_cndmask_b32 v79, v12, v6, s[46:47]
  v_mov_b32 v80, v7
  v_mov_b32 v81, v7
  v_mov_b32 v82, v7
  v_mov_b32 v83, v7
  v_mov_b32 v84, v7
  v_mov_b32 v85, v7
  v_mov_b32 v86, v7
  v_mov_b32 v87, v7
  v_mov_b32 v88, v7
  v_mov_b32 v89, v7
  v_mov_b32 v90, v7
  v_mov_b32 v91, v7
  v_mov_b32 v92, v7
  v_mov_b32 v93, v7
  v_mov_b32 v94, v7
  v_mov_b32 v95, v7
  s_branch A_back_164
A_upd2_173:
  v_mov_b32 v64, v6
  v_mov_b32 v65, v6
  v_mov_b32 v66, v6
  v_mov_b32 v67, v6
  v_mov_b32 v68, v6
  v_mov_b32 v69, v6
  v_mov_b32 v70, v6
  v_mov_b32 v71, v6
  v_mov_b32 v72, v6
  v_mov_b32 v73, v6
  v_mov_b32 v74, v6
  v_mov_b32 v75, v6
  v_mov_b32 v76, v6
  v_mov_b32 v77, v6
  v_mov_b32 v78, v6
  v_mov_b32 v79, v6
  s_branch A_back_164
A_slow_168:
  s_mov_b32 s29, 1
  v_mov_b32 v64, s24
  v_mov_b32 v65, s24
  v_mov_b32 v66, s24
  v_mov_b32 v67, s24
  v_mov_b32 v68, s24
  v_mov_b32 v69, s24
  v_mov_b32 v70, s24
  v_mov_b32 v71, s24
  v_mov_b32 v72, s24
  v_mov_b32 v73, s24
  v_mov_b32 v74, s24
  v_mov_b32 v75, s24
  v_mov_b32 v76, s24
  v_mov_b32 v77, s24
  v_mov_b32 v78, s24
  v_mov_b32 v79, s24
  v_mov_b32 v12, s24
  v_cmp_le_i32 s[40:41], 0, v5
  v_cmp_le_i32 s[42:43], 1, v5
  v_cmp_le_i32 s[44:45], 2, v5
  v_cmp_le_i32 s[46:47], 3, v5
  v_cndmask_b32 v80, v12, v7, s[40:41]
  v_cndmask_b32 v81, v12, v7, s[42:43]
  v_cndmask_b32 v82, v12, v7, s[44:45]
  v_cndmask_b32 v83, v12, v7, s[46:47]
  v_cmp_le_i32 s[40:41], 8, v5
  v_cmp_le_i32 s[42:43], 9, v5
  v_cmp_le_i32 s[44:45], 10, v5
  v_cmp_le_i32 s[46:47], 11, v5
  v_cndmask_b32 v84, v12, v7, s[40:41]
  v_cndmask_b32 v85, v12, v7, s[42:43]
  v_cndmask_b32 v86, v12, v7, s[44:45]
  v_cndmask_b32 v87, v12, v7, s[46:47]
  v_cmp_le_i32 s[40:41], 16, v5
  v_cmp_le_i32 s[42:43], 17, v5
  v_cmp_le_i32 s[44:45], 18, v5
  v_cmp_le_i32 s[46:47], 19, v5
  v_cndmask_b32 v88, v12, v7, s[40:41]
  v_cndmask_b32 v89, v12, v7, s[42:43]
  v_cndmask_b32 v90, v12, v7, s[44:45]
  v_cndmask_b32 v91, v12, v7, s[46:47]
  v_cmp_le_i32 s[40:41], 24, v5
  v_cmp_le_i32 s[42:43], 25, v5
  v_cmp_le_i32 s[44:45], 26, v5
  v_cmp_le_i32 s[46:47], 27, v5
  v_cndmask_b32 v92, v12, v7, s[40:41]
  v_cndmask_b32 v93, v12, v7, s[42:43]
  v_cndmask_b32 v94, v12, v7, s[44:45]
  v_cndmask_b32 v95, v12, v7, s[46:47]
  v_mov_b32 v8, s24
  v_mov_b32 v10, s24
  s_add_u32 s17, s25, 16785408
  s_mov_b32 s23, 0
A_ml_174:
  s_add_u32 s28, s17, 4096
  buffer_load_dwordx4 a[192:195], v2, s[4:7], s17 offen offset:0 sc1
  buffer_load_dwordx4 a[196:199], v2, s[4:7], s17 offen offset:1024 sc1
  buffer_load_dwordx4 a[200:203], v2, s[4:7], s17 offen offset:2048 sc1
  buffer_load_dwordx4 a[204:207], v2, s[4:7], s17 offen offset:3072 sc1
  buffer_load_dwordx4 a[208:211], v2, s[4:7], s28 offen offset:0 sc1
  buffer_load_dwordx4 a[212:215], v2, s[4:7], s28 offen offset:1024 sc1
  buffer_load_dwordx4 a[216:219], v2, s[4:7], s28 offen offset:2048 sc1
  buffer_load_dwordx4 a[220:223], v2, s[4:7], s28 offen offset:3072 sc1
  s_waitcnt vmcnt(0)
  v_mfma_f32_32x32x16_bf16 v[32:47], a[192:195], a[128:131], v[64:79]
  v_mfma_f32_32x32x16_bf16 v[32:47], a[196:199], a[132:135], v[32:47]
  v_mfma_f32_32x32x16_bf16 v[32:47], a[200:203], a[136:139], v[32:47]
  v_mfma_f32_32x32x16_bf16 v[32:47], a[204:207], a[140:143], v[32:47]
  v_mfma_f32_32x32x16_bf16 v[32:47], a[208:211], a[144:147], v[32:47]
  v_mfma_f32_32x32x16_bf16 v[32:47], a[212:215], a[148:151], v[32:47]
  v_mfma_f32_32x32x16_bf16 v[32:47], a[216:219], a[152:155], v[32:47]
  v_mfma_f32_32x32x16_bf16 v[32:47], a[220:223], a[156:159], v[32:47]
  v_mfma_f32_32x32x16_bf16 v[48:63], a[192:195], a[160:163], v[80:95]
  v_mfma_f32_32x32x16_bf16 v[48:63], a[196:199], a[164:167], v[48:63]
  v_mfma_f32_32x32x16_bf16 v[48:63], a[200:203], a[168:171], v[48:63]
  v_mfma_f32_32x32x16_bf16 v[48:63], a[204:207], a[172:175], v[48:63]
  v_mfma_f32_32x32x16_bf16 v[48:63], a[208:211], a[176:179], v[48:63]
  v_mfma_f32_32x32x16_bf16 v[48:63], a[212:215], a[180:183], v[48:63]
  v_mfma_f32_32x32x16_bf16 v[48:63], a[216:219], a[184:187], v[48:63]
  v_mfma_f32_32x32x16_bf16 v[48:63], a[220:223], a[188:191], v[48:63]
  s_nop 7
  s_nop 3
  v_max3_f32 v8, v8, v32, v33
  v_max3_f32 v8, v8, v34, v35
  v_max3_f32 v8, v8, v36, v37
  v_max3_f32 v8, v8, v38, v39
  v_max3_f32 v8, v8, v40, v41
  v_max3_f32 v8, v8, v42, v43
  v_max3_f32 v8, v8, v44, v45
  v_max3_f32 v8, v8, v46, v47
  v_max3_f32 v10, v10, v48, v49
  v_max3_f32 v10, v10, v50, v51
  v_max3_f32 v10, v10, v52, v53
  v_max3_f32 v10, v10, v54, v55
  v_max3_f32 v10, v10, v56, v57
  v_max3_f32 v10, v10, v58, v59
  v_max3_f32 v10, v10, v60, v61
  v_max3_f32 v10, v10, v62, v63
  s_add_u32 s23, s23, 1
  s_cmp_lg_u32 s23, 1
  s_cbranch_scc1 A_m2_175
  v_mov_b32 v12, s24
  v_cmp_le_i32 s[40:41], 0, v5
  v_cmp_le_i32 s[42:43], 1, v5
  v_cmp_le_i32 s[44:45], 2, v5
  v_cmp_le_i32 s[46:47], 3, v5
  v_cndmask_b32 v64, v12, v6, s[40:41]
  v_cndmask_b32 v65, v12, v6, s[42:43]
  v_cndmask_b32 v66, v12, v6, s[44:45]
  v_cndmask_b32 v67, v12, v6, s[46:47]
  v_cmp_le_i32 s[40:41], 8, v5
  v_cmp_le_i32 s[42:43], 9, v5
  v_cmp_le_i32 s[44:45], 10, v5
  v_cmp_le_i32 s[46:47], 11, v5
  v_cndmask_b32 v68, v12, v6, s[40:41]
  v_cndmask_b32 v69, v12, v6, s[42:43]
  v_cndmask_b32 v70, v12, v6, s[44:45]
  v_cndmask_b32 v71, v12, v6, s[46:47]
  v_cmp_le_i32 s[40:41], 16, v5
  v_cmp_le_i32 s[42:43], 17, v5
  v_cmp_le_i32 s[44:45], 18, v5
  v_cmp_le_i32 s[46:47], 19, v5
  v_cndmask_b32 v72, v12, v6, s[40:41]
  v_cndmask_b32 v73, v12, v6, s[42:43]
  v_cndmask_b32 v74, v12, v6, s[44:45]
  v_cndmask_b32 v75, v12, v6, s[46:47]
  v_cmp_le_i32 s[40:41], 24, v5
  v_cmp_le_i32 s[42:43], 25, v5
  v_cmp_le_i32 s[44:45], 26, v5
  v_cmp_le_i32 s[46:47], 27, v5
  v_cndmask_b32 v76, v12, v6, s[40:41]
  v_cndmask_b32 v77, v12, v6, s[42:43]
  v_cndmask_b32 v78, v12, v6, s[44:45]
  v_cndmask_b32 v79, v12, v6, s[46:47]
  v_mov_b32 v80, v7
  v_mov_b32 v81, v7
  v_mov_b32 v82, v7
  v_mov_b32 v83, v7
  v_mov_b32 v84, v7
  v_mov_b32 v85, v7
  v_mov_b32 v86, v7
  v_mov_b32 v87, v7
  v_mov_b32 v88, v7
  v_mov_b32 v89, v7
  v_mov_b32 v90, v7
  v_mov_b32 v91, v7
  v_mov_b32 v92, v7
  v_mov_b32 v93, v7
  v_mov_b32 v94, v7
  v_mov_b32 v95, v7
A_m2_175:
  s_cmp_lg_u32 s23, 2
  s_cbranch_scc1 A_m3_176
  v_mov_b32 v64, v6
  v_mov_b32 v65, v6
  v_mov_b32 v66, v6
  v_mov_b32 v67, v6
  v_mov_b32 v68, v6
  v_mov_b32 v69, v6
  v_mov_b32 v70, v6
  v_mov_b32 v71, v6
  v_mov_b32 v72, v6
  v_mov_b32 v73, v6
  v_mov_b32 v74, v6
  v_mov_b32 v75, v6
  v_mov_b32 v76, v6
  v_mov_b32 v77, v6
  v_mov_b32 v78, v6
  v_mov_b32 v79, v6
A_m3_176:
  s_sub_u32 s17, s17, 8192
  s_cmp_ge_i32 s17, s19
  s_cbranch_scc1 A_ml_174
  v_mov_b32 v9, v8
  s_nop 1
  v_permlane32_swap_b32 v8, v9
  s_nop 1
  v_max_f32 v8, v8, v9
  v_sub_f32 v6, 0, v8
  v_mov_b32 v11, v10
  s_nop 1
  v_permlane32_swap_b32 v10, v11
  s_nop 1
  v_max_f32 v10, v10, v11
  v_sub_f32 v7, 0, v10
  s_branch A_again_155
A_out_165:
  s_mov_b32 s69, s55
  s_mov_b32 s70, s56
  s_sub_u32 s52, s52, 1
  s_cmp_lg_u32 s52, 0
  s_cbranch_scc1 M_att
  s_waitcnt vmcnt(0)
  s_barrier
  s_mov_b32 s30, 512
  v_mov_b32 v144, s30
  v_min_u32 v145, 1, v0
  v_lshlrev_b32 v145, 30, v145
  buffer_store_dword v144, v145, s[4:7], s31 offen sc1
  s_lshr_b32 s48, s64, 2
  s_bfe_u32 s49, s64, 0x10001
  s_and_b32 s50, s64, 1
  s_mul_i32 s50, s50, 6
  s_add_u32 s50, s50, s65
  s_mov_b32 s51, 12
  s_cmp_lt_u32 s50, 4
  s_cselect_b32 s23, 6, 5
  s_load_dwordx2 s[8:9], s[0:1], 40
  s_lshl_b32 s17, s48, 19
  s_lshl_b32 s26, s49, 2
  s_add_u32 s26, s26, s16
  s_lshl_b32 s27, s26, 7
  s_add_u32 s17, s17, s27
  s_mov_b32 s18, 1024
  s_lshl_b32 s21, s48, 6
  s_add_u32 s21, s21, s50
  s_lshl_b32 s21, s21, 3
  s_add_u32 s21, s21, s26
  s_lshl_b32 s21, s21, 12
  s_add_u32 s21, s21, 150994944
  s_lshl_b32 s22, s51, 15
  s_mov_b32 s24, 1.0
  s_waitcnt lgkmcnt(0)
  s_and_b32 s9, s9, 0xffff
  s_mov_b32 s10, 4194304
  s_mov_b32 s11, 0x20000
  s_mov_b32 s12, s4
  s_mov_b32 s13, s5
  s_mov_b32 s14, 268435456
  s_mov_b32 s15, 0x20000
  s_lshl_b32 s19, s48, 8
  s_add_u32 s19, s19, s50
  s_lshl_b32 s19, s19, 13
  s_add_u32 s19, s19, 100663296
  s_lshl_b32 s20, s51, 13
  v_lshrrev_b32 v144, 4, v1
  v_and_b32 v56, 0xff, v2
  v_lshl_add_u32 v56, v144, 9, v56
  s_mul_i32 s26, s16, 524288
  v_add_u32 v8, 0, v56
  v_add_u32 v16, 0, v2
  v_add_u32 v16, s26, v16
  v_add_u32 v9, 256, v56
  v_add_u32 v17, 1024, v2
  v_add_u32 v17, s26, v17
  v_add_u32 v10, 2048, v56
  v_add_u32 v18, 2048, v2
  v_add_u32 v18, s26, v18
  v_add_u32 v11, 2304, v56
  v_add_u32 v19, 3072, v2
  v_add_u32 v19, s26, v19
  v_add_u32 v12, 4096, v56
  v_add_u32 v20, 4096, v2
  v_add_u32 v20, s26, v20
  v_add_u32 v13, 4352, v56
  v_add_u32 v21, 5120, v2
  v_add_u32 v21, s26, v21
  v_add_u32 v14, 6144, v56
  v_add_u32 v22, 6144, v2
  v_add_u32 v22, s26, v22
  v_add_u32 v15, 6400, v56
  v_add_u32 v23, 7168, v2
  v_add_u32 v23, s26, v23
  v_lshrrev_b32 v144, 3, v1
  v_mul_lo_u32 v144, v144, s18
  v_and_b32 v145, 7, v1
  v_lshl_add_u32 v144, v145, 4, v144
  s_lshl_b32 s28, s16, 15
  s_add_u32 s28, s28, 32768
  s_lshl_b32 s29, s18, 3
  s_add_u32 m0, s28, 0
  s_nop 0
  buffer_load_dwordx4 v144, s[8:11], s17 offen lds
  s_add_u32 s17, s17, s29
  s_add_u32 m0, s28, 1024
  s_nop 0
  buffer_load_dwordx4 v144, s[8:11], s17 offen lds
  s_add_u32 s17, s17, s29
  s_add_u32 m0, s28, 2048
  s_nop 0
  buffer_load_dwordx4 v144, s[8:11], s17 offen lds
  s_add_u32 s17, s17, s29
  s_add_u32 m0, s28, 3072
  s_nop 0
  buffer_load_dwordx4 v144, s[8:11], s17 offen lds
  s_add_u32 s17, s17, s29
  s_add_u32 m0, s28, 4096
  s_nop 0
  buffer_load_dwordx4 v144, s[8:11], s17 offen lds
  s_add_u32 s17, s17, s29
  s_add_u32 m0, s28, 5120
  s_nop 0
  buffer_load_dwordx4 v144, s[8:11], s17 offen lds
  s_add_u32 s17, s17, s29
  s_add_u32 m0, s28, 6144
  s_nop 0
  buffer_load_dwordx4 v144, s[8:11], s17 offen lds
  s_add_u32 s17, s17, s29
  s_add_u32 m0, s28, 7168
  s_nop 0
  buffer_load_dwordx4 v144, s[8:11], s17 offen lds
  s_add_u32 s17, s17, s29
  v_bfe_u32 v148, v1, 2, 2
  v_lshrrev_b32 v149, 5, v1
  v_lshl_add_u32 v148, v149, 4, v148
  v_bfe_u32 v149, v1, 4, 1
  v_lshl_add_u32 v148, v149, 2, v148
  v_and_b32 v149, 3, v1
  v_lshlrev_b32 v149, 4, v149
  s_mov_b32 s26, 8
  v_lshl_add_u32 v148, v148, 7, v149
  v_add_u32 v152, s28, v148
  v_add_u32 v153, 1024, v152
  v_add_u32 v154, s26, v152
  v_add_u32 v155, s26, v153
  s_waitcnt vmcnt(4)
  ds_read_b64_tr_b16 a[0:1], v152 offset:0
  ds_read_b64_tr_b16 a[2:3], v153 offset:0
  ds_read_b64_tr_b16 a[4:5], v154 offset:0
  ds_read_b64_tr_b16 a[6:7], v155 offset:0
  ds_read_b64_tr_b16 a[8:9], v152 offset:64
  ds_read_b64_tr_b16 a[10:11], v153 offset:64
  ds_read_b64_tr_b16 a[12:13], v154 offset:64
  ds_read_b64_tr_b16 a[14:15], v155 offset:64
  s_waitcnt lgkmcnt(0)
  s_add_u32 m0, s28, 8192
  s_nop 0
  buffer_load_dwordx4 v144, s[8:11], s17 offen lds
  s_add_u32 s17, s17, s29
  s_add_u32 m0, s28, 9216
  s_nop 0
  buffer_load_dwordx4 v144, s[8:11], s17 offen lds
  s_add_u32 s17, s17, s29
  s_add_u32 m0, s28, 10240
  s_nop 0
  buffer_load_dwordx4 v144, s[8:11], s17 offen lds
  s_add_u32 s17, s17, s29
  s_add_u32 m0, s28, 11264
  s_nop 0
  buffer_load_dwordx4 v144, s[8:11], s17 offen lds
  s_add_u32 s17, s17, s29
  s_waitcnt vmcnt(4)
  ds_read_b64_tr_b16 a[16:17], v152 offset:4096
  ds_read_b64_tr_b16 a[18:19], v153 offset:4096
  ds_read_b64_tr_b16 a[20:21], v154 offset:4096
  ds_read_b64_tr_b16 a[22:23], v155 offset:4096
  ds_read_b64_tr_b16 a[24:25], v152 offset:4160
  ds_read_b64_tr_b16 a[26:27], v153 offset:4160
  ds_read_b64_tr_b16 a[28:29], v154 offset:4160
  ds_read_b64_tr_b16 a[30:31], v155 offset:4160
  s_waitcnt lgkmcnt(0)
  s_add_u32 m0, s28, 12288
  s_nop 0
  buffer_load_dwordx4 v144, s[8:11], s17 offen lds
  s_add_u32 s17, s17, s29
  s_add_u32 m0, s28, 13312
  s_nop 0
  buffer_load_dwordx4 v144, s[8:11], s17 offen lds
  s_add_u32 s17, s17, s29
  s_add_u32 m0, s28, 14336
  s_nop 0
  buffer_load_dwordx4 v144, s[8:11], s17 offen lds
  s_add_u32 s17, s17, s29
  s_add_u32 m0, s28, 15360
  s_nop 0
  buffer_load_dwordx4 v144, s[8:11], s17 offen lds
  s_add_u32 s17, s17, s29
  s_waitcnt vmcnt(4)
  ds_read_b64_tr_b16 a[32:33], v152 offset:8192
  ds_read_b64_tr_b16 a[34:35], v153 offset:8192
  ds_read_b64_tr_b16 a[36:37], v154 offset:8192
  ds_read_b64_tr_b16 a[38:39], v155 offset:8192
  ds_read_b64_tr_b16 a[40:41], v152 offset:8256
  ds_read_b64_tr_b16 a[42:43], v153 offset:8256
  ds_read_b64_tr_b16 a[44:45], v154 offset:8256
  ds_read_b64_tr_b16 a[46:47], v155 offset:8256
  s_waitcnt lgkmcnt(0)
  s_add_u32 m0, s28, 16384
  s_nop 0
  buffer_load_dwordx4 v144, s[8:11], s17 offen lds
  s_add_u32 s17, s17, s29
  s_add_u32 m0, s28, 17408
  s_nop 0
  buffer_load_dwordx4 v144, s[8:11], s17 offen lds
  s_add_u32 s17, s17, s29
  s_add_u32 m0, s28, 18432
  s_nop 0
  buffer_load_dwordx4 v144, s[8:11], s17 offen lds
  s_add_u32 s17, s17, s29
  s_add_u32 m0, s28, 19456
  s_nop 0
  buffer_load_dwordx4 v144, s[8:11], s17 offen lds
  s_add_u32 s17, s17, s29
  s_waitcnt vmcnt(4)
  ds_read_b64_tr_b16 a[48:49], v152 offset:12288
  ds_read_b64_tr_b16 a[50:51], v153 offset:12288
  ds_read_b64_tr_b16 a[52:53], v154 offset:12288
  ds_read_b64_tr_b16 a[54:55], v155 offset:12288
  ds_read_b64_tr_b16 a[56:57], v152 offset:12352
  ds_read_b64_tr_b16 a[58:59], v153 offset:12352
  ds_read_b64_tr_b16 a[60:61], v154 offset:12352
  ds_read_b64_tr_b16 a[62:63], v155 offset:12352
  s_waitcnt lgkmcnt(0)
  s_add_u32 m0, s28, 20480
  s_nop 0
  buffer_load_dwordx4 v144, s[8:11], s17 offen lds
  s_add_u32 s17, s17, s29
  s_add_u32 m0, s28, 21504
  s_nop 0
  buffer_load_dwordx4 v144, s[8:11], s17 offen lds
  s_add_u32 s17, s17, s29
  s_add_u32 m0, s28, 22528
  s_nop 0
  buffer_load_dwordx4 v144, s[8:11], s17 offen lds
  s_add_u32 s17, s17, s29
  s_add_u32 m0, s28, 23552
  s_nop 0
  buffer_load_dwordx4 v144, s[8:11], s17 offen lds
  s_add_u32 s17, s17, s29
  s_waitcnt vmcnt(4)
  ds_read_b64_tr_b16 a[64:65], v152 offset:16384
  ds_read_b64_tr_b16 a[66:67], v153 offset:16384
  ds_read_b64_tr_b16 a[68:69], v154 offset:16384
  ds_read_b64_tr_b16 a[70:71], v155 offset:16384
  ds_read_b64_tr_b16 a[72:73], v152 offset:16448
  ds_read_b64_tr_b16 a[74:75], v153 offset:16448
  ds_read_b64_tr_b16 a[76:77], v154 offset:16448
  ds_read_b64_tr_b16 a[78:79], v155 offset:16448
  s_waitcnt lgkmcnt(0)
  s_add_u32 m0, s28, 24576
  s_nop 0
  buffer_load_dwordx4 v144, s[8:11], s17 offen lds
  s_add_u32 s17, s17, s29
  s_add_u32 m0, s28, 25600
  s_nop 0
  buffer_load_dwordx4 v144, s[8:11], s17 offen lds
  s_add_u32 s17, s17, s29
  s_add_u32 m0, s28, 26624
  s_nop 0
  buffer_load_dwordx4 v144, s[8:11], s17 offen lds
  s_add_u32 s17, s17, s29
  s_add_u32 m0, s28, 27648
  s_nop 0
  buffer_load_dwordx4 v144, s[8:11], s17 offen lds
  s_add_u32 s17, s17, s29
  s_waitcnt vmcnt(4)
  ds_read_b64_tr_b16 a[80:81], v152 offset:20480
  ds_read_b64_tr_b16 a[82:83], v153 offset:20480
  ds_read_b64_tr_b16 a[84:85], v154 offset:20480
  ds_read_b64_tr_b16 a[86:87], v155 offset:20480
  ds_read_b64_tr_b16 a[88:89], v152 offset:20544
  ds_read_b64_tr_b16 a[90:91], v153 offset:20544
  ds_read_b64_tr_b16 a[92:93], v154 offset:20544
  ds_read_b64_tr_b16 a[94:95], v155 offset:20544
  s_waitcnt lgkmcnt(0)
  s_add_u32 m0, s28, 28672
  s_nop 0
  buffer_load_dwordx4 v144, s[8:11], s17 offen lds
  s_add_u32 s17, s17, s29
  s_add_u32 m0, s28, 29696
  s_nop 0
  buffer_load_dwordx4 v144, s[8:11], s17 offen lds
  s_add_u32 s17, s17, s29
  s_add_u32 m0, s28, 30720
  s_nop 0
  buffer_load_dwordx4 v144, s[8:11], s17 offen lds
  s_add_u32 s17, s17, s29
  s_add_u32 m0, s28, 31744
  s_nop 0
  buffer_load_dwordx4 v144, s[8:11], s17 offen lds
  s_add_u32 s17, s17, s29
  s_waitcnt vmcnt(4)
  ds_read_b64_tr_b16 a[96:97], v152 offset:24576
  ds_read_b64_tr_b16 a[98:99], v153 offset:24576
  ds_read_b64_tr_b16 a[100:101], v154 offset:24576
  ds_read_b64_tr_b16 a[102:103], v155 offset:24576
  ds_read_b64_tr_b16 a[104:105], v152 offset:24640
  ds_read_b64_tr_b16 a[106:107], v153 offset:24640
  ds_read_b64_tr_b16 a[108:109], v154 offset:24640
  ds_read_b64_tr_b16 a[110:111], v155 offset:24640
  s_waitcnt lgkmcnt(0)
  s_add_u32 m0, s28, 0
  s_nop 0
  buffer_load_dwordx4 v144, s[8:11], s17 offen lds
  s_add_u32 s17, s17, s29
  s_add_u32 m0, s28, 1024
  s_nop 0
  buffer_load_dwordx4 v144, s[8:11], s17 offen lds
  s_add_u32 s17, s17, s29
  s_add_u32 m0, s28, 2048
  s_nop 0
  buffer_load_dwordx4 v144, s[8:11], s17 offen lds
  s_add_u32 s17, s17, s29
  s_add_u32 m0, s28, 3072
  s_nop 0
  buffer_load_dwordx4 v144, s[8:11], s17 offen lds
  s_add_u32 s17, s17, s29
  s_waitcnt vmcnt(4)
  ds_read_b64_tr_b16 a[112:113], v152 offset:28672
  ds_read_b64_tr_b16 a[114:115], v153 offset:28672
  ds_read_b64_tr_b16 a[116:117], v154 offset:28672
  ds_read_b64_tr_b16 a[118:119], v155 offset:28672
  ds_read_b64_tr_b16 a[120:121], v152 offset:28736
  ds_read_b64_tr_b16 a[122:123], v153 offset:28736
  ds_read_b64_tr_b16 a[124:125], v154 offset:28736
  ds_read_b64_tr_b16 a[126:127], v155 offset:28736
  s_waitcnt lgkmcnt(0)
  s_add_u32 m0, s28, 4096
  s_nop 0
  buffer_load_dwordx4 v144, s[8:11], s17 offen lds
  s_add_u32 s17, s17, s29
  s_add_u32 m0, s28, 5120
  s_nop 0
  buffer_load_dwordx4 v144, s[8:11], s17 offen lds
  s_add_u32 s17, s17, s29
  s_add_u32 m0, s28, 6144
  s_nop 0
  buffer_load_dwordx4 v144, s[8:11], s17 offen lds
  s_add_u32 s17, s17, s29
  s_add_u32 m0, s28, 7168
  s_nop 0
  buffer_load_dwordx4 v144, s[8:11], s17 offen lds
  s_add_u32 s17, s17, s29
  s_waitcnt vmcnt(4)
  ds_read_b64_tr_b16 a[128:129], v152 offset:0
  ds_read_b64_tr_b16 a[130:131], v153 offset:0
  ds_read_b64_tr_b16 a[132:133], v154 offset:0
  ds_read_b64_tr_b16 a[134:135], v155 offset:0
  ds_read_b64_tr_b16 a[136:137], v152 offset:64
  ds_read_b64_tr_b16 a[138:139], v153 offset:64
  ds_read_b64_tr_b16 a[140:141], v154 offset:64
  ds_read_b64_tr_b16 a[142:143], v155 offset:64
  s_waitcnt lgkmcnt(0)
  s_add_u32 m0, s28, 8192
  s_nop 0
  buffer_load_dwordx4 v144, s[8:11], s17 offen lds
  s_add_u32 s17, s17, s29
  s_add_u32 m0, s28, 9216
  s_nop 0
  buffer_load_dwordx4 v144, s[8:11], s17 offen lds
  s_add_u32 s17, s17, s29
  s_add_u32 m0, s28, 10240
  s_nop 0
  buffer_load_dwordx4 v144, s[8:11], s17 offen lds
  s_add_u32 s17, s17, s29
  s_add_u32 m0, s28, 11264
  s_nop 0
  buffer_load_dwordx4 v144, s[8:11], s17 offen lds
  s_add_u32 s17, s17, s29
  s_waitcnt vmcnt(4)
  ds_read_b64_tr_b16 a[144:145], v152 offset:4096
  ds_read_b64_tr_b16 a[146:147], v153 offset:4096
  ds_read_b64_tr_b16 a[148:149], v154 offset:4096
  ds_read_b64_tr_b16 a[150:151], v155 offset:4096
  ds_read_b64_tr_b16 a[152:153], v152 offset:4160
  ds_read_b64_tr_b16 a[154:155], v153 offset:4160
  ds_read_b64_tr_b16 a[156:157], v154 offset:4160
  ds_read_b64_tr_b16 a[158:159], v155 offset:4160
  s_waitcnt lgkmcnt(0)
  s_add_u32 m0, s28, 12288
  s_nop 0
  buffer_load_dwordx4 v144, s[8:11], s17 offen lds
  s_add_u32 s17, s17, s29
  s_add_u32 m0, s28, 13312
  s_nop 0
  buffer_load_dwordx4 v144, s[8:11], s17 offen lds
  s_add_u32 s17, s17, s29
  s_add_u32 m0, s28, 14336
  s_nop 0
  buffer_load_dwordx4 v144, s[8:11], s17 offen lds
  s_add_u32 s17, s17, s29
  s_add_u32 m0, s28, 15360
  s_nop 0
  buffer_load_dwordx4 v144, s[8:11], s17 offen lds
  s_add_u32 s17, s17, s29
  s_waitcnt vmcnt(4)
  ds_read_b64_tr_b16 a[160:161], v152 offset:8192
  ds_read_b64_tr_b16 a[162:163], v153 offset:8192
  ds_read_b64_tr_b16 a[164:165], v154 offset:8192
  ds_read_b64_tr_b16 a[166:167], v155 offset:8192
  ds_read_b64_tr_b16 a[168:169], v152 offset:8256
  ds_read_b64_tr_b16 a[170:171], v153 offset:8256
  ds_read_b64_tr_b16 a[172:173], v154 offset:8256
  ds_read_b64_tr_b16 a[174:175], v155 offset:8256
  s_waitcnt lgkmcnt(0)
  s_add_u32 m0, s28, 16384
  s_nop 0
  buffer_load_dwordx4 v144, s[8:11], s17 offen lds
  s_add_u32 s17, s17, s29
  s_add_u32 m0, s28, 17408
  s_nop 0
  buffer_load_dwordx4 v144, s[8:11], s17 offen lds
  s_add_u32 s17, s17, s29
  s_add_u32 m0, s28, 18432
  s_nop 0
  buffer_load_dwordx4 v144, s[8:11], s17 offen lds
  s_add_u32 s17, s17, s29
  s_add_u32 m0, s28, 19456
  s_nop 0
  buffer_load_dwordx4 v144, s[8:11], s17 offen lds
  s_add_u32 s17, s17, s29
  s_waitcnt vmcnt(4)
  ds_read_b64_tr_b16 a[176:177], v152 offset:12288
  ds_read_b64_tr_b16 a[178:179], v153 offset:12288
  ds_read_b64_tr_b16 a[180:181], v154 offset:12288
  ds_read_b64_tr_b16 a[182:183], v155 offset:12288
  ds_read_b64_tr_b16 a[184:185], v152 offset:12352
  ds_read_b64_tr_b16 a[186:187], v153 offset:12352
  ds_read_b64_tr_b16 a[188:189], v154 offset:12352
  ds_read_b64_tr_b16 a[190:191], v155 offset:12352
  s_waitcnt lgkmcnt(0)
  s_add_u32 m0, s28, 20480
  s_nop 0
  buffer_load_dwordx4 v144, s[8:11], s17 offen lds
  s_add_u32 s17, s17, s29
  s_add_u32 m0, s28, 21504
  s_nop 0
  buffer_load_dwordx4 v144, s[8:11], s17 offen lds
  s_add_u32 s17, s17, s29
  s_add_u32 m0, s28, 22528
  s_nop 0
  buffer_load_dwordx4 v144, s[8:11], s17 offen lds
  s_add_u32 s17, s17, s29
  s_add_u32 m0, s28, 23552
  s_nop 0
  buffer_load_dwordx4 v144, s[8:11], s17 offen lds
  s_add_u32 s17, s17, s29
  s_waitcnt vmcnt(4)
  ds_read_b64_tr_b16 a[192:193], v152 offset:16384
  ds_read_b64_tr_b16 a[194:195], v153 offset:16384
  ds_read_b64_tr_b16 a[196:197], v154 offset:16384
  ds_read_b64_tr_b16 a[198:199], v155 offset:16384
  ds_read_b64_tr_b16 a[200:201], v152 offset:16448
  ds_read_b64_tr_b16 a[202:203], v153 offset:16448
  ds_read_b64_tr_b16 a[204:205], v154 offset:16448
  ds_read_b64_tr_b16 a[206:207], v155 offset:16448
  s_waitcnt lgkmcnt(0)
  s_add_u32 m0, s28, 24576
  s_nop 0
  buffer_load_dwordx4 v144, s[8:11], s17 offen lds
  s_add_u32 s17, s17, s29
  s_add_u32 m0, s28, 25600
  s_nop 0
  buffer_load_dwordx4 v144, s[8:11], s17 offen lds
  s_add_u32 s17, s17, s29
  s_add_u32 m0, s28, 26624
  s_nop 0
  buffer_load_dwordx4 v144, s[8:11], s17 offen lds
  s_add_u32 s17, s17, s29
  s_add_u32 m0, s28, 27648
  s_nop 0
  buffer_load_dwordx4 v144, s[8:11], s17 offen lds
  s_add_u32 s17, s17, s29
  s_waitcnt vmcnt(4)
  ds_read_b64_tr_b16 a[208:209], v152 offset:20480
  ds_read_b64_tr_b16 a[210:211], v153 offset:20480
  ds_read_b64_tr_b16 a[212:213], v154 offset:20480
  ds_read_b64_tr_b16 a[214:215], v155 offset:20480
  ds_read_b64_tr_b16 a[216:217], v152 offset:20544
  ds_read_b64_tr_b16 a[218:219], v153 offset:20544
  ds_read_b64_tr_b16 a[220:221], v154 offset:20544
  ds_read_b64_tr_b16 a[222:223], v155 offset:20544
  s_waitcnt lgkmcnt(0)
  s_add_u32 m0, s28, 28672
  s_nop 0
  buffer_load_dwordx4 v144, s[8:11], s17 offen lds
  s_add_u32 s17, s17, s29
  s_add_u32 m0, s28, 29696
  s_nop 0
  buffer_load_dwordx4 v144, s[8:11], s17 offen lds
  s_add_u32 s17, s17, s29
  s_add_u32 m0, s28, 30720
  s_nop 0
  buffer_load_dwordx4 v144, s[8:11], s17 offen lds
  s_add_u32 s17, s17, s29
  s_add_u32 m0, s28, 31744
  s_nop 0
  buffer_load_dwordx4 v144, s[8:11], s17 offen lds
  s_add_u32 s17, s17, s29
  s_waitcnt vmcnt(4)
  ds_read_b64_tr_b16 a[224:225], v152 offset:24576
  ds_read_b64_tr_b16 a[226:227], v153 offset:24576
  ds_read_b64_tr_b16 a[228:229], v154 offset:24576
  ds_read_b64_tr_b16 a[230:231], v155 offset:24576
  ds_read_b64_tr_b16 a[232:233], v152 offset:24640
  ds_read_b64_tr_b16 a[234:235], v153 offset:24640
  ds_read_b64_tr_b16 a[236:237], v154 offset:24640
  ds_read_b64_tr_b16 a[238:239], v155 offset:24640
  s_waitcnt lgkmcnt(0)
  s_waitcnt vmcnt(0)
  ds_read_b64_tr_b16 a[240:241], v152 offset:28672
  ds_read_b64_tr_b16 a[242:243], v153 offset:28672
  ds_read_b64_tr_b16 a[244:245], v154 offset:28672
  ds_read_b64_tr_b16 a[246:247], v155 offset:28672
  ds_read_b64_tr_b16 a[248:249], v152 offset:28736
  ds_read_b64_tr_b16 a[250:251], v153 offset:28736
  ds_read_b64_tr_b16 a[252:253], v154 offset:28736
  ds_read_b64_tr_b16 a[254:255], v155 offset:28736
  s_waitcnt lgkmcnt(0)
  v_min_u32 v4, 27, v1
  v_mul_u32_u24 v5, 37, v4
  v_lshrrev_b32 v5, 8, v5
  v_mul_u32_u24 v5, 7, v5
  v_sub_u32 v5, v4, v5
  v_mov_b32 v6, 0x200
  v_cmp_ne_u32 vcc, 6, v5
  s_mul_i32 s76, s48, 3584
  s_add_u32 s76, s76, 148897792
  v_cndmask_b32 v5, 0, v6, vcc
  v_lshl_add_u32 v4, v4, 7, s76
  s_mov_b32 s71, 0
  s_branch M_vg_178
M_vw_177:
  s_sleep 2
  s_add_u32 s71, s71, 1
  s_cmp_gt_u32 s71, 262144
  s_cbranch_scc1 M_exit
M_vg_178:
  buffer_load_dword v6, v4, s[4:7], 0 offen sc1
  s_waitcnt vmcnt(0)
  v_cmp_lt_u32 vcc, v6, v5
  s_cbranch_vccnz M_vw_177
  s_barrier
  s_lshl_b32 s25, s16, 13
  s_add_u32 m0, s25, 0
  s_nop 0
  buffer_load_dwordx4 v16, s[12:15], s19 offen sc1 lds
  s_add_u32 m0, s25, 1024
  s_nop 0
  buffer_load_dwordx4 v17, s[12:15], s19 offen sc1 lds
  s_add_u32 m0, s25, 2048
  s_nop 0
  buffer_load_dwordx4 v18, s[12:15], s19 offen sc1 lds
  s_add_u32 m0, s25, 3072
  s_nop 0
  buffer_load_dwordx4 v19, s[12:15], s19 offen sc1 lds
  s_add_u32 m0, s25, 4096
  s_nop 0
  buffer_load_dwordx4 v20, s[12:15], s19 offen sc1 lds
  s_add_u32 m0, s25, 5120
  s_nop 0
  buffer_load_dwordx4 v21, s[12:15], s19 offen sc1 lds
  s_add_u32 m0, s25, 6144
  s_nop 0
  buffer_load_dwordx4 v22, s[12:15], s19 offen sc1 lds
  s_add_u32 m0, s25, 7168
  s_nop 0
  buffer_load_dwordx4 v23, s[12:15], s19 offen sc1 lds
  s_cmp_gt_u32 s23, 1
  s_cselect_b32 s26, s20, 0
  s_add_u32 s19, s19, s26
  s_add_u32 s25, s25, 32768
  s_and_b32 s25, s25, 0x1ffff
  s_waitcnt vmcnt(2)
  s_add_u32 m0, s25, 0
  s_nop 0
  buffer_load_dwordx4 v16, s[12:15], s19 offen sc1 lds
  s_add_u32 m0, s25, 1024
  s_nop 0
  buffer_load_dwordx4 v17, s[12:15], s19 offen sc1 lds
  s_add_u32 m0, s25, 2048
  s_nop 0
  buffer_load_dwordx4 v18, s[12:15], s19 offen sc1 lds
  s_add_u32 m0, s25, 3072
  s_nop 0
  buffer_load_dwordx4 v19, s[12:15], s19 offen sc1 lds
  s_add_u32 m0, s25, 4096
  s_nop 0
  buffer_load_dwordx4 v20, s[12:15], s19 offen sc1 lds
  s_add_u32 m0, s25, 5120
  s_nop 0
  buffer_load_dwordx4 v21, s[12:15], s19 offen sc1 lds
  s_add_u32 m0, s25, 6144
  s_nop 0
  buffer_load_dwordx4 v22, s[12:15], s19 offen sc1 lds
  s_add_u32 m0, s25, 7168
  s_nop 0
  buffer_load_dwordx4 v23, s[12:15], s19 offen sc1 lds
  s_cmp_gt_u32 s23, 2
  s_cselect_b32 s26, s20, 0
  s_add_u32 s19, s19, s26
  s_add_u32 s25, s25, 32768
  s_and_b32 s25, s25, 0x1ffff
  s_waitcnt vmcnt(0)
  s_barrier
  s_mov_b32 s27, s21
  v_mov_b32 v7, 0x40000000
  ds_read_b128 v[24:27], v8 offset:0
  ds_read_b128 v[28:31], v9 offset:0
  ds_read_b128 v[32:35], v10 offset:0
  ds_read_b128 v[36:39], v11 offset:0
  ds_read_b128 v[40:43], v12 offset:0
  ds_read_b128 v[44:47], v13 offset:0
.p2align 6
G_top_179:
  s_waitcnt lgkmcnt(5)
  v_mfma_f32_16x16x32_bf16 v[64:67], a[0:3], v[24:27], 0
  s_add_u32 m0, s25, 0
  ds_read_b128 v[48:51], v14 offset:0
  v_mfma_f32_16x16x32_bf16 v[68:71], a[4:7], v[24:27], 0
  v_mfma_f32_16x16x32_bf16 v[80:83], a[8:11], v[24:27], 0
  buffer_load_dwordx4 v16, s[12:15], s19 offen sc1 lds
  v_mfma_f32_16x16x32_bf16 v[84:87], a[12:15], v[24:27], 0
  s_waitcnt lgkmcnt(5)
  v_mfma_f32_16x16x32_bf16 v[72:75], a[0:3], v[28:31], 0
  ds_read_b128 v[52:55], v15 offset:0
  v_mfma_f32_16x16x32_bf16 v[76:79], a[4:7], v[28:31], 0
  v_cvt_pk_bf16_f32 v128, v96, v97
  v_cvt_pk_bf16_f32 v129, v98, v99
  v_mfma_f32_16x16x32_bf16 v[88:91], a[8:11], v[28:31], 0
  v_mfma_f32_16x16x32_bf16 v[92:95], a[12:15], v[28:31], 0
  s_waitcnt lgkmcnt(5)
  v_cvt_pk_bf16_f32 v130, v100, v101
  v_cvt_pk_bf16_f32 v131, v102, v103
  v_mfma_f32_16x16x32_bf16 v[64:67], a[16:19], v[32:35], v[64:67]
  s_add_u32 m0, s25, 1024
  ds_read_b128 v[24:27], v8 offset:8192
  v_mfma_f32_16x16x32_bf16 v[68:71], a[20:23], v[32:35], v[68:71]
  v_mfma_f32_16x16x32_bf16 v[80:83], a[24:27], v[32:35], v[80:83]
  buffer_load_dwordx4 v17, s[12:15], s19 offen sc1 lds
  v_mfma_f32_16x16x32_bf16 v[84:87], a[28:31], v[32:35], v[84:87]
  s_waitcnt lgkmcnt(5)
  v_mfma_f32_16x16x32_bf16 v[72:75], a[16:19], v[36:39], v[72:75]
  ds_read_b128 v[28:31], v9 offset:8192
  v_mfma_f32_16x16x32_bf16 v[76:79], a[20:23], v[36:39], v[76:79]
  v_mfma_f32_16x16x32_bf16 v[88:91], a[24:27], v[36:39], v[88:91]
  v_mfma_f32_16x16x32_bf16 v[92:95], a[28:31], v[36:39], v[92:95]
  s_waitcnt lgkmcnt(5)
  v_mfma_f32_16x16x32_bf16 v[64:67], a[32:35], v[40:43], v[64:67]
  s_add_u32 m0, s25, 2048
  ds_read_b128 v[32:35], v10 offset:8192
  v_mfma_f32_16x16x32_bf16 v[68:71], a[36:39], v[40:43], v[68:71]
  v_cvt_pk_bf16_f32 v132, v104, v105
  v_cvt_pk_bf16_f32 v133, v106, v107
  v_mfma_f32_16x16x32_bf16 v[80:83], a[40:43], v[40:43], v[80:83]
  buffer_load_dwordx4 v18, s[12:15], s19 offen sc1 lds
  v_mfma_f32_16x16x32_bf16 v[84:87], a[44:47], v[40:43], v[84:87]
  s_waitcnt lgkmcnt(5)
  v_cvt_pk_bf16_f32 v134, v108, v109
  v_cvt_pk_bf16_f32 v135, v110, v111
  v_mfma_f32_16x16x32_bf16 v[72:75], a[32:35], v[44:47], v[72:75]
  ds_read_b128 v[36:39], v11 offset:8192
  v_mfma_f32_16x16x32_bf16 v[76:79], a[36:39], v[44:47], v[76:79]
  v_mfma_f32_16x16x32_bf16 v[88:91], a[40:43], v[44:47], v[88:91]
  v_mfma_f32_16x16x32_bf16 v[92:95], a[44:47], v[44:47], v[92:95]
  s_waitcnt lgkmcnt(5)
  v_mfma_f32_16x16x32_bf16 v[64:67], a[48:51], v[48:51], v[64:67]
  s_add_u32 m0, s25, 3072
  ds_read_b128 v[40:43], v12 offset:8192
  v_mfma_f32_16x16x32_bf16 v[68:71], a[52:55], v[48:51], v[68:71]
  v_mfma_f32_16x16x32_bf16 v[80:83], a[56:59], v[48:51], v[80:83]
  buffer_load_dwordx4 v19, s[12:15], s19 offen sc1 lds
  v_mfma_f32_16x16x32_bf16 v[84:87], a[60:63], v[48:51], v[84:87]
  s_waitcnt lgkmcnt(5)
  v_mfma_f32_16x16x32_bf16 v[72:75], a[48:51], v[52:55], v[72:75]
  ds_read_b128 v[44:47], v13 offset:8192
  v_mfma_f32_16x16x32_bf16 v[76:79], a[52:55], v[52:55], v[76:79]
  v_cvt_pk_bf16_f32 v136, v112, v113
  v_cvt_pk_bf16_f32 v137, v114, v115
  v_mfma_f32_16x16x32_bf16 v[88:91], a[56:59], v[52:55], v[88:91]
  v_mfma_f32_16x16x32_bf16 v[92:95], a[60:63], v[52:55], v[92:95]
  s_waitcnt lgkmcnt(5)
  v_cvt_pk_bf16_f32 v138, v116, v117
  v_cvt_pk_bf16_f32 v139, v118, v119
  v_mfma_f32_16x16x32_bf16 v[64:67], a[64:67], v[24:27], v[64:67]
  s_add_u32 m0, s25, 4096
  ds_read_b128 v[48:51], v14 offset:8192
  v_mfma_f32_16x16x32_bf16 v[68:71], a[68:71], v[24:27], v[68:71]
  v_mfma_f32_16x16x32_bf16 v[80:83], a[72:75], v[24:27], v[80:83]
  buffer_load_dwordx4 v20, s[12:15], s19 offen sc1 lds
  v_mfma_f32_16x16x32_bf16 v[84:87], a[76:79], v[24:27], v[84:87]
  s_waitcnt lgkmcnt(5)
  v_mfma_f32_16x16x32_bf16 v[72:75], a[64:67], v[28:31], v[72:75]
  ds_read_b128 v[52:55], v15 offset:8192
  v_mfma_f32_16x16x32_bf16 v[76:79], a[68:71], v[28:31], v[76:79]
  v_mfma_f32_16x16x32_bf16 v[88:91], a[72:75], v[28:31], v[88:91]
  v_mfma_f32_16x16x32_bf16 v[92:95], a[76:79], v[28:31], v[92:95]
  s_waitcnt lgkmcnt(5)
  v_mfma_f32_16x16x32_bf16 v[64:67], a[80:83], v[32:35], v[64:67]
  s_add_u32 m0, s25, 5120
  ds_read_b128 v[24:27], v8 offset:16384
  v_mfma_f32_16x16x32_bf16 v[68:71], a[84:87], v[32:35], v[68:71]
  v_cvt_pk_bf16_f32 v140, v120, v121
  v_cvt_pk_bf16_f32 v141, v122, v123
  v_mfma_f32_16x16x32_bf16 v[80:83], a[88:91], v[32:35], v[80:83]
  buffer_load_dwordx4 v21, s[12:15], s19 offen sc1 lds
  v_mfma_f32_16x16x32_bf16 v[84:87], a[92:95], v[32:35], v[84:87]
  s_waitcnt lgkmcnt(5)
  v_cvt_pk_bf16_f32 v142, v124, v125
  v_cvt_pk_bf16_f32 v143, v126, v127
  v_mfma_f32_16x16x32_bf16 v[72:75], a[80:83], v[36:39], v[72:75]
  ds_read_b128 v[28:31], v9 offset:16384
  v_mfma_f32_16x16x32_bf16 v[76:79], a[84:87], v[36:39], v[76:79]
  v_mfma_f32_16x16x32_bf16 v[88:91], a[88:91], v[36:39], v[88:91]
  v_mfma_f32_16x16x32_bf16 v[92:95], a[92:95], v[36:39], v[92:95]
  s_waitcnt lgkmcnt(5)
  v_mfma_f32_16x16x32_bf16 v[64:67], a[96:99], v[40:43], v[64:67]
  s_add_u32 m0, s25, 6144
  ds_read_b128 v[32:35], v10 offset:16384
  v_mfma_f32_16x16x32_bf16 v[68:71], a[100:103], v[40:43], v[68:71]
  v_mfma_f32_16x16x32_bf16 v[80:83], a[104:107], v[40:43], v[80:83]
  buffer_load_dwordx4 v22, s[12:15], s19 offen sc1 lds
  v_mfma_f32_16x16x32_bf16 v[84:87], a[108:111], v[40:43], v[84:87]
  s_waitcnt lgkmcnt(5)
  v_mfma_f32_16x16x32_bf16 v[72:75], a[96:99], v[44:47], v[72:75]
  ds_read_b128 v[36:39], v11 offset:16384
  v_mfma_f32_16x16x32_bf16 v[76:79], a[100:103], v[44:47], v[76:79]
  v_mfma_f32_16x16x32_bf16 v[88:91], a[104:107], v[44:47], v[88:91]
  v_mfma_f32_16x16x32_bf16 v[92:95], a[108:111], v[44:47], v[92:95]
  s_waitcnt lgkmcnt(5)
  v_mfma_f32_16x16x32_bf16 v[64:67], a[112:115], v[48:51], v[64:67]
  s_add_u32 m0, s25, 7168
  ds_read_b128 v[40:43], v12 offset:16384
  v_mfma_f32_16x16x32_bf16 v[68:71], a[116:119], v[48:51], v[68:71]
  v_mfma_f32_16x16x32_bf16 v[80:83], a[120:123], v[48:51], v[80:83]
  buffer_load_dwordx4 v23, s[12:15], s19 offen sc1 lds
  v_mfma_f32_16x16x32_bf16 v[84:87], a[124:127], v[48:51], v[84:87]
  s_waitcnt lgkmcnt(5)
  v_mfma_f32_16x16x32_bf16 v[72:75], a[112:115], v[52:55], v[72:75]
  s_cmp_gt_u32 s23, 3
  ds_read_b128 v[44:47], v13 offset:16384
  v_mfma_f32_16x16x32_bf16 v[76:79], a[116:119], v[52:55], v[76:79]
  v_mfma_f32_16x16x32_bf16 v[88:91], a[120:123], v[52:55], v[88:91]
  s_cselect_b32 s26, s20, 0
  v_mfma_f32_16x16x32_bf16 v[92:95], a[124:127], v[52:55], v[92:95]
  s_waitcnt lgkmcnt(5)
  v_mfma_f32_16x16x32_bf16 v[64:67], a[128:131], v[24:27], v[64:67]
  s_add_u32 s19, s19, s26
  ds_read_b128 v[48:51], v14 offset:16384
  v_mfma_f32_16x16x32_bf16 v[68:71], a[132:135], v[24:27], v[68:71]
  v_mfma_f32_16x16x32_bf16 v[80:83], a[136:139], v[24:27], v[80:83]
  s_add_u32 s25, s25, 32768
  v_mfma_f32_16x16x32_bf16 v[84:87], a[140:143], v[24:27], v[84:87]
  s_waitcnt lgkmcnt(5)
  v_mfma_f32_16x16x32_bf16 v[72:75], a[128:131], v[28:31], v[72:75]
  s_and_b32 s25, s25, 0x1ffff
  ds_read_b128 v[52:55], v15 offset:16384
  v_mfma_f32_16x16x32_bf16 v[76:79], a[132:135], v[28:31], v[76:79]
  v_mfma_f32_16x16x32_bf16 v[88:91], a[136:139], v[28:31], v[88:91]
  buffer_store_dwordx4 v[128:131], v7, s[4:7], s21 offen offset:0 sc1
  v_mfma_f32_16x16x32_bf16 v[92:95], a[140:143], v[28:31], v[92:95]
  s_waitcnt lgkmcnt(5)
  v_mfma_f32_16x16x32_bf16 v[64:67], a[144:147], v[32:35], v[64:67]
  ds_read_b128 v[24:27], v8 offset:24576
  v_mfma_f32_16x16x32_bf16 v[68:71], a[148:151], v[32:35], v[68:71]
  v_mfma_f32_16x16x32_bf16 v[80:83], a[152:155], v[32:35], v[80:83]
  v_mfma_f32_16x16x32_bf16 v[84:87], a[156:159], v[32:35], v[84:87]
  s_waitcnt lgkmcnt(5)
  v_mfma_f32_16x16x32_bf16 v[72:75], a[144:147], v[36:39], v[72:75]
  ds_read_b128 v[28:31], v9 offset:24576
  v_mfma_f32_16x16x32_bf16 v[76:79], a[148:151], v[36:39], v[76:79]
  v_mfma_f32_16x16x32_bf16 v[88:91], a[152:155], v[36:39], v[88:91]
  buffer_store_dwordx4 v[132:135], v7, s[4:7], s21 offen offset:256 sc1
  v_mfma_f32_16x16x32_bf16 v[92:95], a[156:159], v[36:39], v[92:95]
  s_waitcnt lgkmcnt(5)
  v_mfma_f32_16x16x32_bf16 v[64:67], a[160:163], v[40:43], v[64:67]
  ds_read_b128 v[32:35], v10 offset:24576
  v_mfma_f32_16x16x32_bf16 v[68:71], a[164:167], v[40:43], v[68:71]
  v_mfma_f32_16x16x32_bf16 v[80:83], a[168:171], v[40:43], v[80:83]
  v_mfma_f32_16x16x32_bf16 v[84:87], a[172:175], v[40:43], v[84:87]
  s_waitcnt lgkmcnt(5)
  v_mfma_f32_16x16x32_bf16 v[72:75], a[160:163], v[44:47], v[72:75]
  ds_read_b128 v[36:39], v11 offset:24576
  v_mfma_f32_16x16x32_bf16 v[76:79], a[164:167], v[44:47], v[76:79]
  v_mfma_f32_16x16x32_bf16 v[88:91], a[168:171], v[44:47], v[88:91]
  buffer_store_dwordx4 v[136:139], v7, s[4:7], s21 offen offset:2048 sc1
  v_mfma_f32_16x16x32_bf16 v[92:95], a[172:175], v[44:47], v[92:95]
  s_waitcnt lgkmcnt(5)
  v_mfma_f32_16x16x32_bf16 v[64:67], a[176:179], v[48:51], v[64:67]
  ds_read_b128 v[40:43], v12 offset:24576
  v_mfma_f32_16x16x32_bf16 v[68:71], a[180:183], v[48:51], v[68:71]
  v_mfma_f32_16x16x32_bf16 v[80:83], a[184:187], v[48:51], v[80:83]
  v_mfma_f32_16x16x32_bf16 v[84:87], a[188:191], v[48:51], v[84:87]
  s_waitcnt lgkmcnt(5)
  v_mfma_f32_16x16x32_bf16 v[72:75], a[176:179], v[52:55], v[72:75]
  ds_read_b128 v[44:47], v13 offset:24576
  v_mfma_f32_16x16x32_bf16 v[76:79], a[180:183], v[52:55], v[76:79]
  v_mfma_f32_16x16x32_bf16 v[88:91], a[184:187], v[52:55], v[88:91]
  buffer_store_dwordx4 v[140:143], v7, s[4:7], s21 offen offset:2304 sc1
  v_mfma_f32_16x16x32_bf16 v[92:95], a[188:191], v[52:55], v[92:95]
  s_waitcnt lgkmcnt(5)
  v_mfma_f32_16x16x32_bf16 v[64:67], a[192:195], v[24:27], v[64:67]
  s_mov_b32 s21, s27
  ds_read_b128 v[48:51], v14 offset:24576
  v_mfma_f32_16x16x32_bf16 v[68:71], a[196:199], v[24:27], v[68:71]
  v_mov_b32 v7, v56
  v_mfma_f32_16x16x32_bf16 v[80:83], a[200:203], v[24:27], v[80:83]
  v_mfma_f32_16x16x32_bf16 v[84:87], a[204:207], v[24:27], v[84:87]
  s_waitcnt lgkmcnt(5)
  v_mfma_f32_16x16x32_bf16 v[72:75], a[192:195], v[28:31], v[72:75]
  s_add_u32 s27, s27, s22
  ds_read_b128 v[52:55], v15 offset:24576
  v_mfma_f32_16x16x32_bf16 v[76:79], a[196:199], v[28:31], v[76:79]
  v_mfma_f32_16x16x32_bf16 v[88:91], a[200:203], v[28:31], v[88:91]
  s_waitcnt vmcnt(16)
  s_barrier
  v_mfma_f32_16x16x32_bf16 v[92:95], a[204:207], v[28:31], v[92:95]
  s_waitcnt lgkmcnt(5)
  v_mfma_f32_16x16x32_bf16 v[64:67], a[208:211], v[32:35], v[64:67]
  ds_read_b128 v[24:27], v8 offset:32768
  v_mfma_f32_16x16x32_bf16 v[68:71], a[212:215], v[32:35], v[68:71]
  v_mfma_f32_16x16x32_bf16 v[80:83], a[216:219], v[32:35], v[80:83]
  v_mfma_f32_16x16x32_bf16 v[84:87], a[220:223], v[32:35], v[84:87]
  s_waitcnt lgkmcnt(5)
  v_mfma_f32_16x16x32_bf16 v[72:75], a[208:211], v[36:39], v[72:75]
  ds_read_b128 v[28:31], v9 offset:32768
  v_mfma_f32_16x16x32_bf16 v[76:79], a[212:215], v[36:39], v[76:79]
  v_mfma_f32_16x16x32_bf16 v[88:91], a[216:219], v[36:39], v[88:91]
  v_mfma_f32_16x16x32_bf16 v[92:95], a[220:223], v[36:39], v[92:95]
  s_waitcnt lgkmcnt(5)
  v_mfma_f32_16x16x32_bf16 v[64:67], a[224:227], v[40:43], v[64:67]
  ds_read_b128 v[32:35], v10 offset:32768
  v_mfma_f32_16x16x32_bf16 v[68:71], a[228:231], v[40:43], v[68:71]
  v_mfma_f32_16x16x32_bf16 v[80:83], a[232:235], v[40:43], v[80:83]
  v_mfma_f32_16x16x32_bf16 v[84:87], a[236:239], v[40:43], v[84:87]
  s_waitcnt lgkmcnt(5)
  v_mfma_f32_16x16x32_bf16 v[72:75], a[224:227], v[44:47], v[72:75]
  ds_read_b128 v[36:39], v11 offset:32768
  v_mfma_f32_16x16x32_bf16 v[76:79], a[228:231], v[44:47], v[76:79]
  v_mfma_f32_16x16x32_bf16 v[88:91], a[232:235], v[44:47], v[88:91]
  v_mfma_f32_16x16x32_bf16 v[92:95], a[236:239], v[44:47], v[92:95]
  s_waitcnt lgkmcnt(5)
  v_mfma_f32_16x16x32_bf16 v[64:67], a[240:243], v[48:51], v[64:67]
  s_sub_u32 s23, s23, 1
  ds_read_b128 v[40:43], v12 offset:32768
  v_mfma_f32_16x16x32_bf16 v[68:71], a[244:247], v[48:51], v[68:71]
  v_mfma_f32_16x16x32_bf16 v[80:83], a[248:251], v[48:51], v[80:83]
  v_mfma_f32_16x16x32_bf16 v[84:87], a[252:255], v[48:51], v[84:87]
  s_waitcnt lgkmcnt(5)
  v_mfma_f32_16x16x32_bf16 v[72:75], a[240:243], v[52:55], v[72:75]
  s_cmp_eq_u32 s23, 0
  ds_read_b128 v[44:47], v13 offset:32768
  v_mfma_f32_16x16x32_bf16 v[76:79], a[244:247], v[52:55], v[76:79]
  v_mfma_f32_16x16x32_bf16 v[88:91], a[248:251], v[52:55], v[88:91]
  v_mfma_f32_16x16x32_bf16 v[92:95], a[252:255], v[52:55], v[92:95]
  s_cbranch_scc1 G_done0_180
  s_waitcnt lgkmcnt(5)
  v_mfma_f32_16x16x32_bf16 v[96:99], a[0:3], v[24:27], 0
  s_add_u32 m0, s25, 0
  ds_read_b128 v[48:51], v14 offset:32768
  v_mfma_f32_16x16x32_bf16 v[100:103], a[4:7], v[24:27], 0
  v_mfma_f32_16x16x32_bf16 v[112:115], a[8:11], v[24:27], 0
  buffer_load_dwordx4 v16, s[12:15], s19 offen sc1 lds
  v_mfma_f32_16x16x32_bf16 v[116:119], a[12:15], v[24:27], 0
  s_waitcnt lgkmcnt(5)
  v_mfma_f32_16x16x32_bf16 v[104:107], a[0:3], v[28:31], 0
  ds_read_b128 v[52:55], v15 offset:32768
  v_mfma_f32_16x16x32_bf16 v[108:111], a[4:7], v[28:31], 0
  v_cvt_pk_bf16_f32 v128, v64, v65
  v_cvt_pk_bf16_f32 v129, v66, v67
  v_mfma_f32_16x16x32_bf16 v[120:123], a[8:11], v[28:31], 0
  v_mfma_f32_16x16x32_bf16 v[124:127], a[12:15], v[28:31], 0
  s_waitcnt lgkmcnt(5)
  v_cvt_pk_bf16_f32 v130, v68, v69
  v_cvt_pk_bf16_f32 v131, v70, v71
  v_mfma_f32_16x16x32_bf16 v[96:99], a[16:19], v[32:35], v[96:99]
  s_add_u32 m0, s25, 1024
  ds_read_b128 v[24:27], v8 offset:40960
  v_mfma_f32_16x16x32_bf16 v[100:103], a[20:23], v[32:35], v[100:103]
  v_mfma_f32_16x16x32_bf16 v[112:115], a[24:27], v[32:35], v[112:115]
  buffer_load_dwordx4 v17, s[12:15], s19 offen sc1 lds
  v_mfma_f32_16x16x32_bf16 v[116:119], a[28:31], v[32:35], v[116:119]
  s_waitcnt lgkmcnt(5)
  v_mfma_f32_16x16x32_bf16 v[104:107], a[16:19], v[36:39], v[104:107]
  ds_read_b128 v[28:31], v9 offset:40960
  v_mfma_f32_16x16x32_bf16 v[108:111], a[20:23], v[36:39], v[108:111]
  v_mfma_f32_16x16x32_bf16 v[120:123], a[24:27], v[36:39], v[120:123]
  v_mfma_f32_16x16x32_bf16 v[124:127], a[28:31], v[36:39], v[124:127]
  s_waitcnt lgkmcnt(5)
  v_mfma_f32_16x16x32_bf16 v[96:99], a[32:35], v[40:43], v[96:99]
  s_add_u32 m0, s25, 2048
  ds_read_b128 v[32:35], v10 offset:40960
  v_mfma_f32_16x16x32_bf16 v[100:103], a[36:39], v[40:43], v[100:103]
  v_cvt_pk_bf16_f32 v132, v72, v73
  v_cvt_pk_bf16_f32 v133, v74, v75
  v_mfma_f32_16x16x32_bf16 v[112:115], a[40:43], v[40:43], v[112:115]
  buffer_load_dwordx4 v18, s[12:15], s19 offen sc1 lds
  v_mfma_f32_16x16x32_bf16 v[116:119], a[44:47], v[40:43], v[116:119]
  s_waitcnt lgkmcnt(5)
  v_cvt_pk_bf16_f32 v134, v76, v77
  v_cvt_pk_bf16_f32 v135, v78, v79
  v_mfma_f32_16x16x32_bf16 v[104:107], a[32:35], v[44:47], v[104:107]
  ds_read_b128 v[36:39], v11 offset:40960
  v_mfma_f32_16x16x32_bf16 v[108:111], a[36:39], v[44:47], v[108:111]
  v_mfma_f32_16x16x32_bf16 v[120:123], a[40:43], v[44:47], v[120:123]
  v_mfma_f32_16x16x32_bf16 v[124:127], a[44:47], v[44:47], v[124:127]
  s_waitcnt lgkmcnt(5)
  v_mfma_f32_16x16x32_bf16 v[96:99], a[48:51], v[48:51], v[96:99]
  s_add_u32 m0, s25, 3072
  ds_read_b128 v[40:43], v12 offset:40960
  v_mfma_f32_16x16x32_bf16 v[100:103], a[52:55], v[48:51], v[100:103]
  v_mfma_f32_16x16x32_bf16 v[112:115], a[56:59], v[48:51], v[112:115]
  buffer_load_dwordx4 v19, s[12:15], s19 offen sc1 lds
  v_mfma_f32_16x16x32_bf16 v[116:119], a[60:63], v[48:51], v[116:119]
  s_waitcnt lgkmcnt(5)
  v_mfma_f32_16x16x32_bf16 v[104:107], a[48:51], v[52:55], v[104:107]
  ds_read_b128 v[44:47], v13 offset:40960
  v_mfma_f32_16x16x32_bf16 v[108:111], a[52:55], v[52:55], v[108:111]
  v_cvt_pk_bf16_f32 v136, v80, v81
  v_cvt_pk_bf16_f32 v137, v82, v83
  v_mfma_f32_16x16x32_bf16 v[120:123], a[56:59], v[52:55], v[120:123]
  v_mfma_f32_16x16x32_bf16 v[124:127], a[60:63], v[52:55], v[124:127]
  s_waitcnt lgkmcnt(5)
  v_cvt_pk_bf16_f32 v138, v84, v85
  v_cvt_pk_bf16_f32 v139, v86, v87
  v_mfma_f32_16x16x32_bf16 v[96:99], a[64:67], v[24:27], v[96:99]
  s_add_u32 m0, s25, 4096
  ds_read_b128 v[48:51], v14 offset:40960
  v_mfma_f32_16x16x32_bf16 v[100:103], a[68:71], v[24:27], v[100:103]
  v_mfma_f32_16x16x32_bf16 v[112:115], a[72:75], v[24:27], v[112:115]
  buffer_load_dwordx4 v20, s[12:15], s19 offen sc1 lds
  v_mfma_f32_16x16x32_bf16 v[116:119], a[76:79], v[24:27], v[116:119]
  s_waitcnt lgkmcnt(5)
  v_mfma_f32_16x16x32_bf16 v[104:107], a[64:67], v[28:31], v[104:107]
  ds_read_b128 v[52:55], v15 offset:40960
  v_mfma_f32_16x16x32_bf16 v[108:111], a[68:71], v[28:31], v[108:111]
  v_mfma_f32_16x16x32_bf16 v[120:123], a[72:75], v[28:31], v[120:123]
  v_mfma_f32_16x16x32_bf16 v[124:127], a[76:79], v[28:31], v[124:127]
  s_waitcnt lgkmcnt(5)
  v_mfma_f32_16x16x32_bf16 v[96:99], a[80:83], v[32:35], v[96:99]
  s_add_u32 m0, s25, 5120
  ds_read_b128 v[24:27], v8 offset:49152
  v_mfma_f32_16x16x32_bf16 v[100:103], a[84:87], v[32:35], v[100:103]
  v_cvt_pk_bf16_f32 v140, v88, v89
  v_cvt_pk_bf16_f32 v141, v90, v91
  v_mfma_f32_16x16x32_bf16 v[112:115], a[88:91], v[32:35], v[112:115]
  buffer_load_dwordx4 v21, s[12:15], s19 offen sc1 lds
  v_mfma_f32_16x16x32_bf16 v[116:119], a[92:95], v[32:35], v[116:119]
  s_waitcnt lgkmcnt(5)
  v_cvt_pk_bf16_f32 v142, v92, v93
  v_cvt_pk_bf16_f32 v143, v94, v95
  v_mfma_f32_16x16x32_bf16 v[104:107], a[80:83], v[36:39], v[104:107]
  ds_read_b128 v[28:31], v9 offset:49152
  v_mfma_f32_16x16x32_bf16 v[108:111], a[84:87], v[36:39], v[108:111]
  v_mfma_f32_16x16x32_bf16 v[120:123], a[88:91], v[36:39], v[120:123]
  v_mfma_f32_16x16x32_bf16 v[124:127], a[92:95], v[36:39], v[124:127]
  s_waitcnt lgkmcnt(5)
  v_mfma_f32_16x16x32_bf16 v[96:99], a[96:99], v[40:43], v[96:99]
  s_add_u32 m0, s25, 6144
  ds_read_b128 v[32:35], v10 offset:49152
  v_mfma_f32_16x16x32_bf16 v[100:103], a[100:103], v[40:43], v[100:103]
  v_mfma_f32_16x16x32_bf16 v[112:115], a[104:107], v[40:43], v[112:115]
  buffer_load_dwordx4 v22, s[12:15], s19 offen sc1 lds
  v_mfma_f32_16x16x32_bf16 v[116:119], a[108:111], v[40:43], v[116:119]
  s_waitcnt lgkmcnt(5)
  v_mfma_f32_16x16x32_bf16 v[104:107], a[96:99], v[44:47], v[104:107]
  ds_read_b128 v[36:39], v11 offset:49152
  v_mfma_f32_16x16x32_bf16 v[108:111], a[100:103], v[44:47], v[108:111]
  v_mfma_f32_16x16x32_bf16 v[120:123], a[104:107], v[44:47], v[120:123]
  v_mfma_f32_16x16x32_bf16 v[124:127], a[108:111], v[44:47], v[124:127]
  s_waitcnt lgkmcnt(5)
  v_mfma_f32_16x16x32_bf16 v[96:99], a[112:115], v[48:51], v[96:99]
  s_add_u32 m0, s25, 7168
  ds_read_b128 v[40:43], v12 offset:49152
  v_mfma_f32_16x16x32_bf16 v[100:103], a[116:119], v[48:51], v[100:103]
  v_mfma_f32_16x16x32_bf16 v[112:115], a[120:123], v[48:51], v[112:115]
  buffer_load_dwordx4 v23, s[12:15], s19 offen sc1 lds
  v_mfma_f32_16x16x32_bf16 v[116:119], a[124:127], v[48:51], v[116:119]
  s_waitcnt lgkmcnt(5)
  v_mfma_f32_16x16x32_bf16 v[104:107], a[112:115], v[52:55], v[104:107]
  s_cmp_gt_u32 s23, 3
  ds_read_b128 v[44:47], v13 offset:49152
  v_mfma_f32_16x16x32_bf16 v[108:111], a[116:119], v[52:55], v[108:111]
  v_mfma_f32_16x16x32_bf16 v[120:123], a[120:123], v[52:55], v[120:123]
  s_cselect_b32 s26, s20, 0
  v_mfma_f32_16x16x32_bf16 v[124:127], a[124:127], v[52:55], v[124:127]
  s_waitcnt lgkmcnt(5)
  v_mfma_f32_16x16x32_bf16 v[96:99], a[128:131], v[24:27], v[96:99]
  s_add_u32 s19, s19, s26
  ds_read_b128 v[48:51], v14 offset:49152
  v_mfma_f32_16x16x32_bf16 v[100:103], a[132:135], v[24:27], v[100:103]
  v_mfma_f32_16x16x32_bf16 v[112:115], a[136:139], v[24:27], v[112:115]
  s_add_u32 s25, s25, 32768
  v_mfma_f32_16x16x32_bf16 v[116:119], a[140:143], v[24:27], v[116:119]
  s_waitcnt lgkmcnt(5)
  v_mfma_f32_16x16x32_bf16 v[104:107], a[128:131], v[28:31], v[104:107]
  s_and_b32 s25, s25, 0x1ffff
  ds_read_b128 v[52:55], v15 offset:49152
  v_mfma_f32_16x16x32_bf16 v[108:111], a[132:135], v[28:31], v[108:111]
  v_mfma_f32_16x16x32_bf16 v[120:123], a[136:139], v[28:31], v[120:123]
  buffer_store_dwordx4 v[128:131], v7, s[4:7], s21 offen offset:0 sc1
  v_mfma_f32_16x16x32_bf16 v[124:127], a[140:143], v[28:31], v[124:127]
  s_waitcnt lgkmcnt(5)
  v_mfma_f32_16x16x32_bf16 v[96:99], a[144:147], v[32:35], v[96:99]
  ds_read_b128 v[24:27], v8 offset:57344
  v_mfma_f32_16x16x32_bf16 v[100:103], a[148:151], v[32:35], v[100:103]
  v_mfma_f32_16x16x32_bf16 v[112:115], a[152:155], v[32:35], v[112:115]
  v_mfma_f32_16x16x32_bf16 v[116:119], a[156:159], v[32:35], v[116:119]
  s_waitcnt lgkmcnt(5)
  v_xor_b32 v8, 0x10000, v8
  v_mfma_f32_16x16x32_bf16 v[104:107], a[144:147], v[36:39], v[104:107]
  ds_read_b128 v[28:31], v9 offset:57344
  v_mfma_f32_16x16x32_bf16 v[108:111], a[148:151], v[36:39], v[108:111]
  v_mfma_f32_16x16x32_bf16 v[120:123], a[152:155], v[36:39], v[120:123]
  buffer_store_dwordx4 v[132:135], v7, s[4:7], s21 offen offset:256 sc1
  v_mfma_f32_16x16x32_bf16 v[124:127], a[156:159], v[36:39], v[124:127]
  s_waitcnt lgkmcnt(5)
  v_xor_b32 v9, 0x10000, v9
  v_mfma_f32_16x16x32_bf16 v[96:99], a[160:163], v[40:43], v[96:99]
  ds_read_b128 v[32:35], v10 offset:57344
  v_mfma_f32_16x16x32_bf16 v[100:103], a[164:167], v[40:43], v[100:103]
  v_mfma_f32_16x16x32_bf16 v[112:115], a[168:171], v[40:43], v[112:115]
  v_mfma_f32_16x16x32_bf16 v[116:119], a[172:175], v[40:43], v[116:119]
  s_waitcnt lgkmcnt(5)
  v_xor_b32 v10, 0x10000, v10
  v_mfma_f32_16x16x32_bf16 v[104:107], a[160:163], v[44:47], v[104:107]
  ds_read_b128 v[36:39], v11 offset:57344
  v_mfma_f32_16x16x32_bf16 v[108:111], a[164:167], v[44:47], v[108:111]
  v_mfma_f32_16x16x32_bf16 v[120:123], a[168:171], v[44:47], v[120:123]
  buffer_store_dwordx4 v[136:139], v7, s[4:7], s21 offen offset:2048 sc1
  v_mfma_f32_16x16x32_bf16 v[124:127], a[172:175], v[44:47], v[124:127]
  s_waitcnt lgkmcnt(5)
  v_xor_b32 v11, 0x10000, v11
  v_mfma_f32_16x16x32_bf16 v[96:99], a[176:179], v[48:51], v[96:99]
  ds_read_b128 v[40:43], v12 offset:57344
  v_mfma_f32_16x16x32_bf16 v[100:103], a[180:183], v[48:51], v[100:103]
  v_mfma_f32_16x16x32_bf16 v[112:115], a[184:187], v[48:51], v[112:115]
  v_mfma_f32_16x16x32_bf16 v[116:119], a[188:191], v[48:51], v[116:119]
  s_waitcnt lgkmcnt(5)
  v_xor_b32 v12, 0x10000, v12
  v_mfma_f32_16x16x32_bf16 v[104:107], a[176:179], v[52:55], v[104:107]
  ds_read_b128 v[44:47], v13 offset:57344
  v_mfma_f32_16x16x32_bf16 v[108:111], a[180:183], v[52:55], v[108:111]
  v_mfma_f32_16x16x32_bf16 v[120:123], a[184:187], v[52:55], v[120:123]
  buffer_store_dwordx4 v[140:143], v7, s[4:7], s21 offen offset:2304 sc1
  v_mfma_f32_16x16x32_bf16 v[124:127], a[188:191], v[52:55], v[124:127]
  s_waitcnt lgkmcnt(5)
  v_xor_b32 v13, 0x10000, v13
  v_mfma_f32_16x16x32_bf16 v[96:99], a[192:195], v[24:27], v[96:99]
  s_mov_b32 s21, s27
  ds_read_b128 v[48:51], v14 offset:57344
  v_mfma_f32_16x16x32_bf16 v[100:103], a[196:199], v[24:27], v[100:103]
  v_mov_b32 v7, v56
  v_mfma_f32_16x16x32_bf16 v[112:115], a[200:203], v[24:27], v[112:115]
  v_mfma_f32_16x16x32_bf16 v[116:119], a[204:207], v[24:27], v[116:119]
  s_waitcnt lgkmcnt(5)
  v_xor_b32 v14, 0x10000, v14
  v_mfma_f32_16x16x32_bf16 v[104:107], a[192:195], v[28:31], v[104:107]
  s_add_u32 s27, s27, s22
  ds_read_b128 v[52:55], v15 offset:57344
  v_mfma_f32_16x16x32_bf16 v[108:111], a[196:199], v[28:31], v[108:111]
  v_mfma_f32_16x16x32_bf16 v[120:123], a[200:203], v[28:31], v[120:123]
  s_waitcnt vmcnt(16)
  s_barrier
  v_mfma_f32_16x16x32_bf16 v[124:127], a[204:207], v[28:31], v[124:127]
  s_waitcnt lgkmcnt(5)
  v_xor_b32 v15, 0x10000, v15
  v_mfma_f32_16x16x32_bf16 v[96:99], a[208:211], v[32:35], v[96:99]
  ds_read_b128 v[24:27], v8 offset:0
  v_mfma_f32_16x16x32_bf16 v[100:103], a[212:215], v[32:35], v[100:103]
  v_mfma_f32_16x16x32_bf16 v[112:115], a[216:219], v[32:35], v[112:115]
  v_mfma_f32_16x16x32_bf16 v[116:119], a[220:223], v[32:35], v[116:119]
  s_waitcnt lgkmcnt(5)
  v_mfma_f32_16x16x32_bf16 v[104:107], a[208:211], v[36:39], v[104:107]
  ds_read_b128 v[28:31], v9 offset:0
  v_mfma_f32_16x16x32_bf16 v[108:111], a[212:215], v[36:39], v[108:111]
  v_mfma_f32_16x16x32_bf16 v[120:123], a[216:219], v[36:39], v[120:123]
  v_mfma_f32_16x16x32_bf16 v[124:127], a[220:223], v[36:39], v[124:127]
  s_waitcnt lgkmcnt(5)
  v_mfma_f32_16x16x32_bf16 v[96:99], a[224:227], v[40:43], v[96:99]
  ds_read_b128 v[32:35], v10 offset:0
  v_mfma_f32_16x16x32_bf16 v[100:103], a[228:231], v[40:43], v[100:103]
  v_mfma_f32_16x16x32_bf16 v[112:115], a[232:235], v[40:43], v[112:115]
  v_mfma_f32_16x16x32_bf16 v[116:119], a[236:239], v[40:43], v[116:119]
  s_waitcnt lgkmcnt(5)
  v_mfma_f32_16x16x32_bf16 v[104:107], a[224:227], v[44:47], v[104:107]
  ds_read_b128 v[36:39], v11 offset:0
  v_mfma_f32_16x16x32_bf16 v[108:111], a[228:231], v[44:47], v[108:111]
  v_mfma_f32_16x16x32_bf16 v[120:123], a[232:235], v[44:47], v[120:123]
  v_mfma_f32_16x16x32_bf16 v[124:127], a[236:239], v[44:47], v[124:127]
  s_waitcnt lgkmcnt(5)
  v_mfma_f32_16x16x32_bf16 v[96:99], a[240:243], v[48:51], v[96:99]
  s_sub_u32 s23, s23, 1
  ds_read_b128 v[40:43], v12 offset:0
  v_mfma_f32_16x16x32_bf16 v[100:103], a[244:247], v[48:51], v[100:103]
  v_mfma_f32_16x16x32_bf16 v[112:115], a[248:251], v[48:51], v[112:115]
  v_mfma_f32_16x16x32_bf16 v[116:119], a[252:255], v[48:51], v[116:119]
  s_waitcnt lgkmcnt(5)
  v_mfma_f32_16x16x32_bf16 v[104:107], a[240:243], v[52:55], v[104:107]
  s_cmp_eq_u32 s23, 0
  ds_read_b128 v[44:47], v13 offset:0
  v_mfma_f32_16x16x32_bf16 v[108:111], a[244:247], v[52:55], v[108:111]
  v_mfma_f32_16x16x32_bf16 v[120:123], a[248:251], v[52:55], v[120:123]
  v_mfma_f32_16x16x32_bf16 v[124:127], a[252:255], v[52:55], v[124:127]
  s_cbranch_scc1 G_done1_181
  s_branch G_top_179
G_done0_180:
  s_nop 7
  s_nop 3
  v_cvt_pk_bf16_f32 v128, v64, v65
  v_cvt_pk_bf16_f32 v129, v66, v67
  v_cvt_pk_bf16_f32 v130, v68, v69
  v_cvt_pk_bf16_f32 v131, v70, v71
  buffer_store_dwordx4 v[128:131], v7, s[4:7], s21 offen offset:0 sc1
  v_cvt_pk_bf16_f32 v132, v72, v73
  v_cvt_pk_bf16_f32 v133, v74, v75
  v_cvt_pk_bf16_f32 v134, v76, v77
  v_cvt_pk_bf16_f32 v135, v78, v79
  buffer_store_dwordx4 v[132:135], v7, s[4:7], s21 offen offset:256 sc1
  v_cvt_pk_bf16_f32 v136, v80, v81
  v_cvt_pk_bf16_f32 v137, v82, v83
  v_cvt_pk_bf16_f32 v138, v84, v85
  v_cvt_pk_bf16_f32 v139, v86, v87
  buffer_store_dwordx4 v[136:139], v7, s[4:7], s21 offen offset:2048 sc1
  v_cvt_pk_bf16_f32 v140, v88, v89
  v_cvt_pk_bf16_f32 v141, v90, v91
  v_cvt_pk_bf16_f32 v142, v92, v93
  v_cvt_pk_bf16_f32 v143, v94, v95
  buffer_store_dwordx4 v[140:143], v7, s[4:7], s21 offen offset:2304 sc1
  s_branch G_fin_182
G_done1_181:
  s_nop 7
  s_nop 3
  v_cvt_pk_bf16_f32 v128, v96, v97
  v_cvt_pk_bf16_f32 v129, v98, v99
  v_cvt_pk_bf16_f32 v130, v100, v101
  v_cvt_pk_bf16_f32 v131, v102, v103
  buffer_store_dwordx4 v[128:131], v7, s[4:7], s21 offen offset:0 sc1
  v_cvt_pk_bf16_f32 v132, v104, v105
  v_cvt_pk_bf16_f32 v133, v106, v107
  v_cvt_pk_bf16_f32 v134, v108, v109
  v_cvt_pk_bf16_f32 v135, v110, v111
  buffer_store_dwordx4 v[132:135], v7, s[4:7], s21 offen offset:256 sc1
  v_cvt_pk_bf16_f32 v136, v112, v113
  v_cvt_pk_bf16_f32 v137, v114, v115
  v_cvt_pk_bf16_f32 v138, v116, v117
  v_cvt_pk_bf16_f32 v139, v118, v119
  buffer_store_dwordx4 v[136:139], v7, s[4:7], s21 offen offset:2048 sc1
  v_cvt_pk_bf16_f32 v140, v120, v121
  v_cvt_pk_bf16_f32 v141, v122, v123
  v_cvt_pk_bf16_f32 v142, v124, v125
  v_cvt_pk_bf16_f32 v143, v126, v127
  buffer_store_dwordx4 v[140:143], v7, s[4:7], s21 offen offset:2304 sc1
G_fin_182:
  s_waitcnt vmcnt(0) lgkmcnt(0)
  s_barrier
  s_waitcnt vmcnt(0)
  s_barrier
  s_mov_b32 s30, 768
  v_mov_b32 v144, s30
  v_min_u32 v145, 1, v0
  v_lshlrev_b32 v145, 30, v145
  buffer_store_dword v144, v145, s[4:7], s31 offen sc1
  s_mul_i32 s50, s64, 6
  s_add_u32 s50, s50, s65
  s_mul_i32 s76, s50, 21846
  s_lshr_b32 s76, s76, 16
  s_mul_i32 s77, s76, 3
  s_add_u32 s51, s50, 64
  s_cmp_eq_u32 s77, s50
  s_cselect_b32 s50, s76, s51
M_fin:
  s_lshr_b32 s48, s50, 2
  s_and_b32 s49, s50, 3
  s_load_dwordx2 s[8:9], s[0:1], 0
  s_load_dwordx2 s[12:13], s[0:1], 104
  s_load_dwordx2 s[32:33], s[0:1], 112
  v_and_b32 v4, 31, v1
  v_lshrrev_b32 v5, 5, v1
  v_lshlrev_b32 v5, 4, v5
  v_lshl_add_u32 v6, v4, 10, v5
  s_lshl_b32 s26, s16, 8
  s_lshl_b32 s27, s48, 15
  s_add_u32 s27, s27, s26
  s_waitcnt lgkmcnt(0)
  s_and_b32 s9, s9, 0xffff
  s_mov_b32 s10, 2097152
  s_mov_b32 s11, 0x20000
  s_and_b32 s13, s13, 0xffff
  s_mov_b32 s14, 1024
  s_mov_b32 s15, 0x20000
  s_and_b32 s33, s33, 0xffff
  s_mov_b32 s34, 2097152
  s_mov_b32 s35, 0x20000
  buffer_load_dwordx4 v[16:19], v6, s[8:11], s27 offen offset:0
  buffer_load_dwordx4 v[48:51], v5, s[12:15], s26 offen offset:0
  buffer_load_dwordx4 v[20:23], v6, s[8:11], s27 offen offset:32
  buffer_load_dwordx4 v[52:55], v5, s[12:15], s26 offen offset:32
  buffer_load_dwordx4 v[24:27], v6, s[8:11], s27 offen offset:64
  buffer_load_dwordx4 v[56:59], v5, s[12:15], s26 offen offset:64
  buffer_load_dwordx4 v[28:31], v6, s[8:11], s27 offen offset:96
  buffer_load_dwordx4 v[60:63], v5, s[12:15], s26 offen offset:96
  buffer_load_dwordx4 v[32:35], v6, s[8:11], s27 offen offset:128
  buffer_load_dwordx4 v[64:67], v5, s[12:15], s26 offen offset:128
  buffer_load_dwordx4 v[36:39], v6, s[8:11], s27 offen offset:160
  buffer_load_dwordx4 v[68:71], v5, s[12:15], s26 offen offset:160
  buffer_load_dwordx4 v[40:43], v6, s[8:11], s27 offen offset:192
  buffer_load_dwordx4 v[72:75], v5, s[12:15], s26 offen offset:192
  buffer_load_dwordx4 v[44:47], v6, s[8:11], s27 offen offset:224
  buffer_load_dwordx4 v[76:79], v5, s[12:15], s26 offen offset:224
  s_lshl_b32 s28, s48, 2
  s_add_u32 s28, s28, s49
  s_lshl_b32 s28, s28, 2
  s_add_u32 s28, s28, s16
  s_lshl_b32 s28, s28, 11
  s_waitcnt vmcnt(14)
  v_mfma_f32_32x32x16_bf16 v[80:95], v[48:51], v[16:19], 0
  s_waitcnt vmcnt(12)
  v_mfma_f32_32x32x16_bf16 v[80:95], v[52:55], v[20:23], v[80:95]
  s_waitcnt vmcnt(10)
  v_mfma_f32_32x32x16_bf16 v[80:95], v[56:59], v[24:27], v[80:95]
  s_waitcnt vmcnt(8)
  v_mfma_f32_32x32x16_bf16 v[80:95], v[60:63], v[28:31], v[80:95]
  s_waitcnt vmcnt(6)
  v_mfma_f32_32x32x16_bf16 v[80:95], v[64:67], v[32:35], v[80:95]
  s_waitcnt vmcnt(4)
  v_mfma_f32_32x32x16_bf16 v[80:95], v[68:71], v[36:39], v[80:95]
  s_waitcnt vmcnt(2)
  v_mfma_f32_32x32x16_bf16 v[80:95], v[72:75], v[40:43], v[80:95]
  s_waitcnt vmcnt(0)
  v_mfma_f32_32x32x16_bf16 v[80:95], v[76:79], v[44:47], v[80:95]
  s_mul_i32 s76, s48, 43
  s_lshr_b32 s76, s76, 9
  s_mul_i32 s76, s76, 12
  s_sub_u32 s76, s48, s76
  s_cmp_ge_u32 s76, 6
  s_addc_u32 s76, s76, 0
  s_and_b32 s77, s49, 2
  s_mul_i32 s77, s77, 7
  s_add_u32 s76, s76, s77
  v_mov_b32 v193, 0x300
  s_lshl_b32 s76, s76, 7
  s_add_u32 s76, s76, 148897792
  v_and_b32 v192, 7, v1
  v_mul_u32_u24 v192, 3584, v192
  v_add_u32 v192, s76, v192
  s_mov_b32 s71, 0
  s_branch M_vg_184
M_vw_183:
  s_sleep 2
  s_add_u32 s71, s71, 1
  s_cmp_gt_u32 s71, 262144
  s_cbranch_scc1 M_exit
M_vg_184:
  buffer_load_dword v194, v192, s[4:7], 0 offen sc1
  s_waitcnt vmcnt(0)
  v_cmp_lt_u32 vcc, v194, v193
  s_cbranch_vccnz M_vw_183
  s_add_u32 s29, s28, 150994944
  buffer_load_dwordx4 v[96:99], v2, s[4:7], s29 offen offset:0 sc1
  buffer_load_dwordx4 v[100:103], v2, s[4:7], s29 offen offset:1024 sc1
  s_add_u32 s29, s28, 153092096
  buffer_load_dwordx4 v[104:107], v2, s[4:7], s29 offen offset:0 sc1
  buffer_load_dwordx4 v[108:111], v2, s[4:7], s29 offen offset:1024 sc1
  s_add_u32 s29, s28, 155189248
  s_waitcnt vmcnt(2)
  buffer_load_dwordx4 v[112:115], v2, s[4:7], s29 offen offset:0 sc1
  buffer_load_dwordx4 v[116:119], v2, s[4:7], s29 offen offset:1024 sc1
  s_add_u32 s29, s28, 157286400
  s_waitcnt vmcnt(2)
  buffer_load_dwordx4 v[120:123], v2, s[4:7], s29 offen offset:0 sc1
  buffer_load_dwordx4 v[124:127], v2, s[4:7], s29 offen offset:1024 sc1
  s_add_u32 s29, s28, 159383552
  s_waitcnt vmcnt(2)
  buffer_load_dwordx4 v[128:131], v2, s[4:7], s29 offen offset:0 sc1
  buffer_load_dwordx4 v[132:135], v2, s[4:7], s29 offen offset:1024 sc1
  s_add_u32 s29, s28, 161480704
  s_waitcnt vmcnt(2)
  buffer_load_dwordx4 v[136:139], v2, s[4:7], s29 offen offset:0 sc1
  buffer_load_dwordx4 v[140:143], v2, s[4:7], s29 offen offset:1024 sc1
  s_add_u32 s29, s28, 163577856
  s_waitcnt vmcnt(2)
  buffer_load_dwordx4 v[144:147], v2, s[4:7], s29 offen offset:0 sc1
  buffer_load_dwordx4 v[148:151], v2, s[4:7], s29 offen offset:1024 sc1
  s_add_u32 s29, s28, 165675008
  s_waitcnt vmcnt(2)
  buffer_load_dwordx4 v[152:155], v2, s[4:7], s29 offen offset:0 sc1
  buffer_load_dwordx4 v[156:159], v2, s[4:7], s29 offen offset:1024 sc1
  v_lshlrev_b32 v7, 4, v4
  s_lshl_b32 s26, s16, 2
  v_add_u32 v4, s26, v7
  s_barrier
  ds_write_b32 v4, v80
  s_waitcnt lgkmcnt(0)
  s_barrier
  ds_read_b128 v[84:87], v7
  s_waitcnt lgkmcnt(0)
  v_add_f32 v80, v84, v85
  v_add_f32 v81, v86, v87
  v_add_f32 v80, v80, v81
  v_mul_f32 v80, 0xbfb8aa3b, v80
  v_exp_f32 v80, v80
  s_nop 0
  v_add_f32 v80, 1.0, v80
  v_rcp_f32 v80, v80
  s_nop 0
  v_sub_f32 v82, 1.0, v80
  s_waitcnt vmcnt(14)
  v_lshlrev_b32 v160, 16, v96
  v_and_b32 v161, 0xffff0000, v96
  v_lshlrev_b32 v162, 16, v97
  v_and_b32 v163, 0xffff0000, v97
  v_lshlrev_b32 v164, 16, v98
  v_and_b32 v165, 0xffff0000, v98
  v_lshlrev_b32 v166, 16, v99
  v_and_b32 v167, 0xffff0000, v99
  v_lshlrev_b32 v168, 16, v100
  v_and_b32 v169, 0xffff0000, v100
  v_lshlrev_b32 v170, 16, v101
  v_and_b32 v171, 0xffff0000, v101
  v_lshlrev_b32 v172, 16, v102
  v_and_b32 v173, 0xffff0000, v102
  v_lshlrev_b32 v174, 16, v103
  v_and_b32 v175, 0xffff0000, v103
  s_waitcnt vmcnt(12)
  v_lshlrev_b32 v8, 16, v104
  v_and_b32 v9, 0xffff0000, v104
  v_pk_add_f32 v[160:161], v[160:161], v[8:9]
  v_lshlrev_b32 v10, 16, v105
  v_and_b32 v11, 0xffff0000, v105
  v_pk_add_f32 v[162:163], v[162:163], v[10:11]
  v_lshlrev_b32 v12, 16, v106
  v_and_b32 v13, 0xffff0000, v106
  v_pk_add_f32 v[164:165], v[164:165], v[12:13]
  v_lshlrev_b32 v14, 16, v107
  v_and_b32 v15, 0xffff0000, v107
  v_pk_add_f32 v[166:167], v[166:167], v[14:15]
  v_lshlrev_b32 v8, 16, v108
  v_and_b32 v9, 0xffff0000, v108
  v_pk_add_f32 v[168:169], v[168:169], v[8:9]
  v_lshlrev_b32 v10, 16, v109
  v_and_b32 v11, 0xffff0000, v109
  v_pk_add_f32 v[170:171], v[170:171], v[10:11]
  v_lshlrev_b32 v12, 16, v110
  v_and_b32 v13, 0xffff0000, v110
  v_pk_add_f32 v[172:173], v[172:173], v[12:13]
  v_lshlrev_b32 v14, 16, v111
  v_and_b32 v15, 0xffff0000, v111
  v_pk_add_f32 v[174:175], v[174:175], v[14:15]
  s_waitcnt vmcnt(10)
  v_lshlrev_b32 v8, 16, v112
  v_and_b32 v9, 0xffff0000, v112
  v_pk_add_f32 v[160:161], v[160:161], v[8:9]
  v_lshlrev_b32 v10, 16, v113
  v_and_b32 v11, 0xffff0000, v113
  v_pk_add_f32 v[162:163], v[162:163], v[10:11]
  v_lshlrev_b32 v12, 16, v114
  v_and_b32 v13, 0xffff0000, v114
  v_pk_add_f32 v[164:165], v[164:165], v[12:13]
  v_lshlrev_b32 v14, 16, v115
  v_and_b32 v15, 0xffff0000, v115
  v_pk_add_f32 v[166:167], v[166:167], v[14:15]
  v_lshlrev_b32 v8, 16, v116
  v_and_b32 v9, 0xffff0000, v116
  v_pk_add_f32 v[168:169], v[168:169], v[8:9]
  v_lshlrev_b32 v10, 16, v117
  v_and_b32 v11, 0xffff0000, v117
  v_pk_add_f32 v[170:171], v[170:171], v[10:11]
  v_lshlrev_b32 v12, 16, v118
  v_and_b32 v13, 0xffff0000, v118
  v_pk_add_f32 v[172:173], v[172:173], v[12:13]
  v_lshlrev_b32 v14, 16, v119
  v_and_b32 v15, 0xffff0000, v119
  v_pk_add_f32 v[174:175], v[174:175], v[14:15]
  s_waitcnt vmcnt(8)
  v_lshlrev_b32 v8, 16, v120
  v_and_b32 v9, 0xffff0000, v120
  v_pk_add_f32 v[160:161], v[160:161], v[8:9]
  v_lshlrev_b32 v10, 16, v121
  v_and_b32 v11, 0xffff0000, v121
  v_pk_add_f32 v[162:163], v[162:163], v[10:11]
  v_lshlrev_b32 v12, 16, v122
  v_and_b32 v13, 0xffff0000, v122
  v_pk_add_f32 v[164:165], v[164:165], v[12:13]
  v_lshlrev_b32 v14, 16, v123
  v_and_b32 v15, 0xffff0000, v123
  v_pk_add_f32 v[166:167], v[166:167], v[14:15]
  v_lshlrev_b32 v8, 16, v124
  v_and_b32 v9, 0xffff0000, v124
  v_pk_add_f32 v[168:169], v[168:169], v[8:9]
  v_lshlrev_b32 v10, 16, v125
  v_and_b32 v11, 0xffff0000, v125
  v_pk_add_f32 v[170:171], v[170:171], v[10:11]
  v_lshlrev_b32 v12, 16, v126
  v_and_b32 v13, 0xffff0000, v126
  v_pk_add_f32 v[172:173], v[172:173], v[12:13]
  v_lshlrev_b32 v14, 16, v127
  v_and_b32 v15, 0xffff0000, v127
  v_pk_add_f32 v[174:175], v[174:175], v[14:15]
  s_waitcnt vmcnt(6)
  v_lshlrev_b32 v8, 16, v128
  v_and_b32 v9, 0xffff0000, v128
  v_pk_add_f32 v[160:161], v[160:161], v[8:9]
  v_lshlrev_b32 v10, 16, v129
  v_and_b32 v11, 0xffff0000, v129
  v_pk_add_f32 v[162:163], v[162:163], v[10:11]
  v_lshlrev_b32 v12, 16, v130
  v_and_b32 v13, 0xffff0000, v130
  v_pk_add_f32 v[164:165], v[164:165], v[12:13]
  v_lshlrev_b32 v14, 16, v131
  v_and_b32 v15, 0xffff0000, v131
  v_pk_add_f32 v[166:167], v[166:167], v[14:15]
  v_lshlrev_b32 v8, 16, v132
  v_and_b32 v9, 0xffff0000, v132
  v_pk_add_f32 v[168:169], v[168:169], v[8:9]
  v_lshlrev_b32 v10, 16, v133
  v_and_b32 v11, 0xffff0000, v133
  v_pk_add_f32 v[170:171], v[170:171], v[10:11]
  v_lshlrev_b32 v12, 16, v134
  v_and_b32 v13, 0xffff0000, v134
  v_pk_add_f32 v[172:173], v[172:173], v[12:13]
  v_lshlrev_b32 v14, 16, v135
  v_and_b32 v15, 0xffff0000, v135
  v_pk_add_f32 v[174:175], v[174:175], v[14:15]
  s_waitcnt vmcnt(4)
  v_lshlrev_b32 v8, 16, v136
  v_and_b32 v9, 0xffff0000, v136
  v_pk_add_f32 v[160:161], v[160:161], v[8:9]
  v_lshlrev_b32 v10, 16, v137
  v_and_b32 v11, 0xffff0000, v137
  v_pk_add_f32 v[162:163], v[162:163], v[10:11]
  v_lshlrev_b32 v12, 16, v138
  v_and_b32 v13, 0xffff0000, v138
  v_pk_add_f32 v[164:165], v[164:165], v[12:13]
  v_lshlrev_b32 v14, 16, v139
  v_and_b32 v15, 0xffff0000, v139
  v_pk_add_f32 v[166:167], v[166:167], v[14:15]
  v_lshlrev_b32 v8, 16, v140
  v_and_b32 v9, 0xffff0000, v140
  v_pk_add_f32 v[168:169], v[168:169], v[8:9]
  v_lshlrev_b32 v10, 16, v141
  v_and_b32 v11, 0xffff0000, v141
  v_pk_add_f32 v[170:171], v[170:171], v[10:11]
  v_lshlrev_b32 v12, 16, v142
  v_and_b32 v13, 0xffff0000, v142
  v_pk_add_f32 v[172:173], v[172:173], v[12:13]
  v_lshlrev_b32 v14, 16, v143
  v_and_b32 v15, 0xffff0000, v143
  v_pk_add_f32 v[174:175], v[174:175], v[14:15]
  s_waitcnt vmcnt(2)
  v_lshlrev_b32 v8, 16, v144
  v_and_b32 v9, 0xffff0000, v144
  v_pk_add_f32 v[160:161], v[160:161], v[8:9]
  v_lshlrev_b32 v10, 16, v145
  v_and_b32 v11, 0xffff0000, v145
  v_pk_add_f32 v[162:163], v[162:163], v[10:11]
  v_lshlrev_b32 v12, 16, v146
  v_and_b32 v13, 0xffff0000, v146
  v_pk_add_f32 v[164:165], v[164:165], v[12:13]
  v_lshlrev_b32 v14, 16, v147
  v_and_b32 v15, 0xffff0000, v147
  v_pk_add_f32 v[166:167], v[166:167], v[14:15]
  v_lshlrev_b32 v8, 16, v148
  v_and_b32 v9, 0xffff0000, v148
  v_pk_add_f32 v[168:169], v[168:169], v[8:9]
  v_lshlrev_b32 v10, 16, v149
  v_and_b32 v11, 0xffff0000, v149
  v_pk_add_f32 v[170:171], v[170:171], v[10:11]
  v_lshlrev_b32 v12, 16, v150
  v_and_b32 v13, 0xffff0000, v150
  v_pk_add_f32 v[172:173], v[172:173], v[12:13]
  v_lshlrev_b32 v14, 16, v151
  v_and_b32 v15, 0xffff0000, v151
  v_pk_add_f32 v[174:175], v[174:175], v[14:15]
  s_waitcnt vmcnt(0)
  v_lshlrev_b32 v8, 16, v152
  v_and_b32 v9, 0xffff0000, v152
  v_pk_add_f32 v[160:161], v[160:161], v[8:9]
  v_lshlrev_b32 v10, 16, v153
  v_and_b32 v11, 0xffff0000, v153
  v_pk_add_f32 v[162:163], v[162:163], v[10:11]
  v_lshlrev_b32 v12, 16, v154
  v_and_b32 v13, 0xffff0000, v154
  v_pk_add_f32 v[164:165], v[164:165], v[12:13]
  v_lshlrev_b32 v14, 16, v155
  v_and_b32 v15, 0xffff0000, v155
  v_pk_add_f32 v[166:167], v[166:167], v[14:15]
  v_lshlrev_b32 v8, 16, v156
  v_and_b32 v9, 0xffff0000, v156
  v_pk_add_f32 v[168:169], v[168:169], v[8:9]
  v_lshlrev_b32 v10, 16, v157
  v_and_b32 v11, 0xffff0000, v157
  v_pk_add_f32 v[170:171], v[170:171], v[10:11]
  v_lshlrev_b32 v12, 16, v158
  v_and_b32 v13, 0xffff0000, v158
  v_pk_add_f32 v[172:173], v[172:173], v[12:13]
  v_lshlrev_b32 v14, 16, v159
  v_and_b32 v15, 0xffff0000, v159
  v_pk_add_f32 v[174:175], v[174:175], v[14:15]
  s_and_b32 s76, s48, 1
  s_lshl_b32 s76, s76, 1
  s_lshr_b32 s77, s49, 1
  s_add_u32 s76, s76, s77
  s_mul_i32 s76, s76, 7
  s_add_u32 s76, s76, 6
  s_lshr_b32 s77, s48, 1
  s_add_u32 s77, s77, 0x201
  v_mov_b32 v193, s77
  s_lshl_b32 s76, s76, 7
  s_add_u32 s76, s76, 148897792
  v_and_b32 v192, 7, v1
  v_mul_u32_u24 v192, 3584, v192
  v_add_u32 v192, s76, v192
  s_mov_b32 s71, 0
  s_branch M_vg_186
M_vw_185:
  s_sleep 2
  s_add_u32 s71, s71, 1
  s_cmp_gt_u32 s71, 262144
  s_cbranch_scc1 M_exit
M_vg_186:
  buffer_load_dword v194, v192, s[4:7], 0 offen sc1
  s_waitcnt vmcnt(0)
  v_cmp_lt_u32 vcc, v194, v193
  s_cbranch_vccnz M_vw_185
  s_cmp_ge_u32 s48, 58
  s_cbranch_scc1 Z_fast_187
  s_add_u32 s29, s28, 167772160
  buffer_load_dwordx4 v[96:99], v2, s[4:7], s29 offen offset:0 sc1
  buffer_load_dwordx4 v[100:103], v2, s[4:7], s29 offen offset:1024 sc1
  s_add_u32 s29, s28, 169869312
  buffer_load_dwordx4 v[104:107], v2, s[4:7], s29 offen offset:0 sc1
  buffer_load_dwordx4 v[108:111], v2, s[4:7], s29 offen offset:1024 sc1
  s_add_u32 s29, s28, 171966464
  s_waitcnt vmcnt(2)
  buffer_load_dwordx4 v[112:115], v2, s[4:7], s29 offen offset:0 sc1
  buffer_load_dwordx4 v[116:119], v2, s[4:7], s29 offen offset:1024 sc1
  s_add_u32 s29, s28, 174063616
  s_waitcnt vmcnt(2)
  buffer_load_dwordx4 v[120:123], v2, s[4:7], s29 offen offset:0 sc1
  buffer_load_dwordx4 v[124:127], v2, s[4:7], s29 offen offset:1024 sc1
  s_add_u32 s29, s28, 176160768
  s_waitcnt vmcnt(2)
  buffer_load_dwordx4 v[128:131], v2, s[4:7], s29 offen offset:0 sc1
  buffer_load_dwordx4 v[132:135], v2, s[4:7], s29 offen offset:1024 sc1
  s_add_u32 s29, s28, 178257920
  s_waitcnt vmcnt(2)
  buffer_load_dwordx4 v[136:139], v2, s[4:7], s29 offen offset:0 sc1
  buffer_load_dwordx4 v[140:143], v2, s[4:7], s29 offen offset:1024 sc1
  s_add_u32 s29, s28, 180355072
  s_waitcnt vmcnt(2)
  buffer_load_dwordx4 v[144:147], v2, s[4:7], s29 offen offset:0 sc1
  buffer_load_dwordx4 v[148:151], v2, s[4:7], s29 offen offset:1024 sc1
  s_add_u32 s29, s28, 182452224
  s_waitcnt vmcnt(2)
  buffer_load_dwordx4 v[152:155], v2, s[4:7], s29 offen offset:0 sc1
  buffer_load_dwordx4 v[156:159], v2, s[4:7], s29 offen offset:1024 sc1
  s_branch Z_join_188
Z_fast_187:
  s_add_u32 s29, s28, 167772160
  buffer_load_dwordx4 v[96:99], v2, s[4:7], s29 offen offset:0 sc1
  buffer_load_dwordx4 v[100:103], v2, s[4:7], s29 offen offset:1024 sc1
  s_add_u32 s29, s28, 169869312
  buffer_load_dwordx4 v[104:107], v2, s[4:7], s29 offen offset:0 sc1
  buffer_load_dwordx4 v[108:111], v2, s[4:7], s29 offen offset:1024 sc1
  s_add_u32 s29, s28, 171966464
  buffer_load_dwordx4 v[112:115], v2, s[4:7], s29 offen offset:0 sc1
  buffer_load_dwordx4 v[116:119], v2, s[4:7], s29 offen offset:1024 sc1
  s_add_u32 s29, s28, 174063616
  buffer_load_dwordx4 v[120:123], v2, s[4:7], s29 offen offset:0 sc1
  buffer_load_dwordx4 v[124:127], v2, s[4:7], s29 offen offset:1024 sc1
  s_add_u32 s29, s28, 176160768
  buffer_load_dwordx4 v[128:131], v2, s[4:7], s29 offen offset:0 sc1
  buffer_load_dwordx4 v[132:135], v2, s[4:7], s29 offen offset:1024 sc1
  s_add_u32 s29, s28, 178257920
  buffer_load_dwordx4 v[136:139], v2, s[4:7], s29 offen offset:0 sc1
  buffer_load_dwordx4 v[140:143], v2, s[4:7], s29 offen offset:1024 sc1
  s_add_u32 s29, s28, 180355072
  buffer_load_dwordx4 v[144:147], v2, s[4:7], s29 offen offset:0 sc1
  buffer_load_dwordx4 v[148:151], v2, s[4:7], s29 offen offset:1024 sc1
  s_add_u32 s29, s28, 182452224
  buffer_load_dwordx4 v[152:155], v2, s[4:7], s29 offen offset:0 sc1
  buffer_load_dwordx4 v[156:159], v2, s[4:7], s29 offen offset:1024 sc1
Z_join_188:
  v_pk_mul_f32 v[160:161], v[160:161], v[80:81] op_sel_hi:[1,0]
  v_pk_mul_f32 v[162:163], v[162:163], v[80:81] op_sel_hi:[1,0]
  v_pk_mul_f32 v[164:165], v[164:165], v[80:81] op_sel_hi:[1,0]
  v_pk_mul_f32 v[166:167], v[166:167], v[80:81] op_sel_hi:[1,0]
  v_pk_mul_f32 v[168:169], v[168:169], v[80:81] op_sel_hi:[1,0]
  v_pk_mul_f32 v[170:171], v[170:171], v[80:81] op_sel_hi:[1,0]
  v_pk_mul_f32 v[172:173], v[172:173], v[80:81] op_sel_hi:[1,0]
  v_pk_mul_f32 v[174:175], v[174:175], v[80:81] op_sel_hi:[1,0]
  s_waitcnt vmcnt(14)
  v_lshlrev_b32 v176, 16, v96
  v_and_b32 v177, 0xffff0000, v96
  v_lshlrev_b32 v178, 16, v97
  v_and_b32 v179, 0xffff0000, v97
  v_lshlrev_b32 v180, 16, v98
  v_and_b32 v181, 0xffff0000, v98
  v_lshlrev_b32 v182, 16, v99
  v_and_b32 v183, 0xffff0000, v99
  v_lshlrev_b32 v184, 16, v100
  v_and_b32 v185, 0xffff0000, v100
  v_lshlrev_b32 v186, 16, v101
  v_and_b32 v187, 0xffff0000, v101
  v_lshlrev_b32 v188, 16, v102
  v_and_b32 v189, 0xffff0000, v102
  v_lshlrev_b32 v190, 16, v103
  v_and_b32 v191, 0xffff0000, v103
  s_waitcnt vmcnt(12)
  v_lshlrev_b32 v8, 16, v104
  v_and_b32 v9, 0xffff0000, v104
  v_pk_add_f32 v[176:177], v[176:177], v[8:9]
  v_lshlrev_b32 v10, 16, v105
  v_and_b32 v11, 0xffff0000, v105
  v_pk_add_f32 v[178:179], v[178:179], v[10:11]
  v_lshlrev_b32 v12, 16, v106
  v_and_b32 v13, 0xffff0000, v106
  v_pk_add_f32 v[180:181], v[180:181], v[12:13]
  v_lshlrev_b32 v14, 16, v107
  v_and_b32 v15, 0xffff0000, v107
  v_pk_add_f32 v[182:183], v[182:183], v[14:15]
  v_lshlrev_b32 v8, 16, v108
  v_and_b32 v9, 0xffff0000, v108
  v_pk_add_f32 v[184:185], v[184:185], v[8:9]
  v_lshlrev_b32 v10, 16, v109
  v_and_b32 v11, 0xffff0000, v109
  v_pk_add_f32 v[186:187], v[186:187], v[10:11]
  v_lshlrev_b32 v12, 16, v110
  v_and_b32 v13, 0xffff0000, v110
  v_pk_add_f32 v[188:189], v[188:189], v[12:13]
  v_lshlrev_b32 v14, 16, v111
  v_and_b32 v15, 0xffff0000, v111
  v_pk_add_f32 v[190:191], v[190:191], v[14:15]
  s_waitcnt vmcnt(10)
  v_lshlrev_b32 v8, 16, v112
  v_and_b32 v9, 0xffff0000, v112
  v_pk_add_f32 v[176:177], v[176:177], v[8:9]
  v_lshlrev_b32 v10, 16, v113
  v_and_b32 v11, 0xffff0000, v113
  v_pk_add_f32 v[178:179], v[178:179], v[10:11]
  v_lshlrev_b32 v12, 16, v114
  v_and_b32 v13, 0xffff0000, v114
  v_pk_add_f32 v[180:181], v[180:181], v[12:13]
  v_lshlrev_b32 v14, 16, v115
  v_and_b32 v15, 0xffff0000, v115
  v_pk_add_f32 v[182:183], v[182:183], v[14:15]
  v_lshlrev_b32 v8, 16, v116
  v_and_b32 v9, 0xffff0000, v116
  v_pk_add_f32 v[184:185], v[184:185], v[8:9]
  v_lshlrev_b32 v10, 16, v117
  v_and_b32 v11, 0xffff0000, v117
  v_pk_add_f32 v[186:187], v[186:187], v[10:11]
  v_lshlrev_b32 v12, 16, v118
  v_and_b32 v13, 0xffff0000, v118
  v_pk_add_f32 v[188:189], v[188:189], v[12:13]
  v_lshlrev_b32 v14, 16, v119
  v_and_b32 v15, 0xffff0000, v119
  v_pk_add_f32 v[190:191], v[190:191], v[14:15]
  s_waitcnt vmcnt(8)
  v_lshlrev_b32 v8, 16, v120
  v_and_b32 v9, 0xffff0000, v120
  v_pk_add_f32 v[176:177], v[176:177], v[8:9]
  v_lshlrev_b32 v10, 16, v121
  v_and_b32 v11, 0xffff0000, v121
  v_pk_add_f32 v[178:179], v[178:179], v[10:11]
  v_lshlrev_b32 v12, 16, v122
  v_and_b32 v13, 0xffff0000, v122
  v_pk_add_f32 v[180:181], v[180:181], v[12:13]
  v_lshlrev_b32 v14, 16, v123
  v_and_b32 v15, 0xffff0000, v123
  v_pk_add_f32 v[182:183], v[182:183], v[14:15]
  v_lshlrev_b32 v8, 16, v124
  v_and_b32 v9, 0xffff0000, v124
  v_pk_add_f32 v[184:185], v[184:185], v[8:9]
  v_lshlrev_b32 v10, 16, v125
  v_and_b32 v11, 0xffff0000, v125
  v_pk_add_f32 v[186:187], v[186:187], v[10:11]
  v_lshlrev_b32 v12, 16, v126
  v_and_b32 v13, 0xffff0000, v126
  v_pk_add_f32 v[188:189], v[188:189], v[12:13]
  v_lshlrev_b32 v14, 16, v127
  v_and_b32 v15, 0xffff0000, v127
  v_pk_add_f32 v[190:191], v[190:191], v[14:15]
  s_waitcnt vmcnt(6)
  v_lshlrev_b32 v8, 16, v128
  v_and_b32 v9, 0xffff0000, v128
  v_pk_add_f32 v[176:177], v[176:177], v[8:9]
  v_lshlrev_b32 v10, 16, v129
  v_and_b32 v11, 0xffff0000, v129
  v_pk_add_f32 v[178:179], v[178:179], v[10:11]
  v_lshlrev_b32 v12, 16, v130
  v_and_b32 v13, 0xffff0000, v130
  v_pk_add_f32 v[180:181], v[180:181], v[12:13]
  v_lshlrev_b32 v14, 16, v131
  v_and_b32 v15, 0xffff0000, v131
  v_pk_add_f32 v[182:183], v[182:183], v[14:15]
  v_lshlrev_b32 v8, 16, v132
  v_and_b32 v9, 0xffff0000, v132
  v_pk_add_f32 v[184:185], v[184:185], v[8:9]
  v_lshlrev_b32 v10, 16, v133
  v_and_b32 v11, 0xffff0000, v133
  v_pk_add_f32 v[186:187], v[186:187], v[10:11]
  v_lshlrev_b32 v12, 16, v134
  v_and_b32 v13, 0xffff0000, v134
  v_pk_add_f32 v[188:189], v[188:189], v[12:13]
  v_lshlrev_b32 v14, 16, v135
  v_and_b32 v15, 0xffff0000, v135
  v_pk_add_f32 v[190:191], v[190:191], v[14:15]
  s_waitcnt vmcnt(4)
  v_lshlrev_b32 v8, 16, v136
  v_and_b32 v9, 0xffff0000, v136
  v_pk_add_f32 v[176:177], v[176:177], v[8:9]
  v_lshlrev_b32 v10, 16, v137
  v_and_b32 v11, 0xffff0000, v137
  v_pk_add_f32 v[178:179], v[178:179], v[10:11]
  v_lshlrev_b32 v12, 16, v138
  v_and_b32 v13, 0xffff0000, v138
  v_pk_add_f32 v[180:181], v[180:181], v[12:13]
  v_lshlrev_b32 v14, 16, v139
  v_and_b32 v15, 0xffff0000, v139
  v_pk_add_f32 v[182:183], v[182:183], v[14:15]
  v_lshlrev_b32 v8, 16, v140
  v_and_b32 v9, 0xffff0000, v140
  v_pk_add_f32 v[184:185], v[184:185], v[8:9]
  v_lshlrev_b32 v10, 16, v141
  v_and_b32 v11, 0xffff0000, v141
  v_pk_add_f32 v[186:187], v[186:187], v[10:11]
  v_lshlrev_b32 v12, 16, v142
  v_and_b32 v13, 0xffff0000, v142
  v_pk_add_f32 v[188:189], v[188:189], v[12:13]
  v_lshlrev_b32 v14, 16, v143
  v_and_b32 v15, 0xffff0000, v143
  v_pk_add_f32 v[190:191], v[190:191], v[14:15]
  s_waitcnt vmcnt(2)
  v_lshlrev_b32 v8, 16, v144
  v_and_b32 v9, 0xffff0000, v144
  v_pk_add_f32 v[176:177], v[176:177], v[8:9]
  v_lshlrev_b32 v10, 16, v145
  v_and_b32 v11, 0xffff0000, v145
  v_pk_add_f32 v[178:179], v[178:179], v[10:11]
  v_lshlrev_b32 v12, 16, v146
  v_and_b32 v13, 0xffff0000, v146
  v_pk_add_f32 v[180:181], v[180:181], v[12:13]
  v_lshlrev_b32 v14, 16, v147
  v_and_b32 v15, 0xffff0000, v147
  v_pk_add_f32 v[182:183], v[182:183], v[14:15]
  v_lshlrev_b32 v8, 16, v148
  v_and_b32 v9, 0xffff0000, v148
  v_pk_add_f32 v[184:185], v[184:185], v[8:9]
  v_lshlrev_b32 v10, 16, v149
  v_and_b32 v11, 0xffff0000, v149
  v_pk_add_f32 v[186:187], v[186:187], v[10:11]
  v_lshlrev_b32 v12, 16, v150
  v_and_b32 v13, 0xffff0000, v150
  v_pk_add_f32 v[188:189], v[188:189], v[12:13]
  v_lshlrev_b32 v14, 16, v151
  v_and_b32 v15, 0xffff0000, v151
  v_pk_add_f32 v[190:191], v[190:191], v[14:15]
  s_waitcnt vmcnt(0)
  v_lshlrev_b32 v8, 16, v152
  v_and_b32 v9, 0xffff0000, v152
  v_pk_add_f32 v[176:177], v[176:177], v[8:9]
  v_lshlrev_b32 v10, 16, v153
  v_and_b32 v11, 0xffff0000, v153
  v_pk_add_f32 v[178:179], v[178:179], v[10:11]
  v_lshlrev_b32 v12, 16, v154
  v_and_b32 v13, 0xffff0000, v154
  v_pk_add_f32 v[180:181], v[180:181], v[12:13]
  v_lshlrev_b32 v14, 16, v155
  v_and_b32 v15, 0xffff0000, v155
  v_pk_add_f32 v[182:183], v[182:183], v[14:15]
  v_lshlrev_b32 v8, 16, v156
  v_and_b32 v9, 0xffff0000, v156
  v_pk_add_f32 v[184:185], v[184:185], v[8:9]
  v_lshlrev_b32 v10, 16, v157
  v_and_b32 v11, 0xffff0000, v157
  v_pk_add_f32 v[186:187], v[186:187], v[10:11]
  v_lshlrev_b32 v12, 16, v158
  v_and_b32 v13, 0xffff0000, v158
  v_pk_add_f32 v[188:189], v[188:189], v[12:13]
  v_lshlrev_b32 v14, 16, v159
  v_and_b32 v15, 0xffff0000, v159
  v_pk_add_f32 v[190:191], v[190:191], v[14:15]
  v_pk_fma_f32 v[160:161], v[176:177], v[82:83], v[160:161] op_sel_hi:[1,0,1]
  v_cvt_pk_bf16_f32 v16, v160, v161
  v_pk_fma_f32 v[162:163], v[178:179], v[82:83], v[162:163] op_sel_hi:[1,0,1]
  v_cvt_pk_bf16_f32 v17, v162, v163
  v_pk_fma_f32 v[164:165], v[180:181], v[82:83], v[164:165] op_sel_hi:[1,0,1]
  v_cvt_pk_bf16_f32 v18, v164, v165
  v_pk_fma_f32 v[166:167], v[182:183], v[82:83], v[166:167] op_sel_hi:[1,0,1]
  v_cvt_pk_bf16_f32 v19, v166, v167
  v_pk_fma_f32 v[168:169], v[184:185], v[82:83], v[168:169] op_sel_hi:[1,0,1]
  v_cvt_pk_bf16_f32 v20, v168, v169
  v_pk_fma_f32 v[170:171], v[186:187], v[82:83], v[170:171] op_sel_hi:[1,0,1]
  v_cvt_pk_bf16_f32 v21, v170, v171
  v_pk_fma_f32 v[172:173], v[188:189], v[82:83], v[172:173] op_sel_hi:[1,0,1]
  v_cvt_pk_bf16_f32 v22, v172, v173
  v_pk_fma_f32 v[174:175], v[190:191], v[82:83], v[174:175] op_sel_hi:[1,0,1]
  v_cvt_pk_bf16_f32 v23, v174, v175
  s_lshl_b32 s26, s49, 2
  s_add_u32 s26, s26, s16
  s_lshl_b32 s26, s26, 6
  s_lshl_b32 s27, s48, 15
  s_add_u32 s26, s26, s27
  buffer_store_dwordx4 v[16:19], v6, s[32:35], s26 offen offset:0
  buffer_store_dwordx4 v[20:23], v6, s[32:35], s26 offen offset:32
  s_cmp_lt_u32 s50, 64
  s_mov_b32 s50, s51
  s_cbranch_scc1 M_fin
  s_branch M_done
M_follow:
  s_lshr_b32 s48, s64, 2
  s_and_b32 s49, s64, 1
  s_bfe_u32 s50, s64, 0x10001
  s_mov_b32 s51, 2
  s_mov_b32 s23, 32
  s_load_dwordx2 s[8:9], s[0:1], 88
  s_lshl_b32 s17, s48, 19
  s_lshl_b32 s26, s49, 2
  s_add_u32 s26, s26, s16
  s_lshl_b32 s27, s26, 7
  s_add_u32 s17, s17, s27
  s_mov_b32 s18, 1024
  s_lshl_b32 s21, s48, 6
  s_add_u32 s21, s21, s50
  s_lshl_b32 s21, s21, 3
  s_add_u32 s21, s21, s26
  s_lshl_b32 s21, s21, 12
  s_add_u32 s21, s21, 167772160
  s_lshl_b32 s22, s51, 15
  s_mov_b32 s24, 1.0
  s_waitcnt lgkmcnt(0)
  s_and_b32 s9, s9, 0xffff
  s_mov_b32 s10, 4194304
  s_mov_b32 s11, 0x20000
  v_lshrrev_b32 v144, 4, v1
  v_and_b32 v56, 0xff, v2
  v_lshl_add_u32 v56, v144, 9, v56
  s_mul_i32 s26, s16, 0
  v_add_u32 v8, 0, v56
  v_add_u32 v16, 0, v2
  v_add_u32 v16, s26, v16
  v_add_u32 v9, 256, v56
  v_add_u32 v17, 1024, v2
  v_add_u32 v17, s26, v17
  v_add_u32 v10, 2048, v56
  v_add_u32 v18, 2048, v2
  v_add_u32 v18, s26, v18
  v_add_u32 v11, 2304, v56
  v_add_u32 v19, 3072, v2
  v_add_u32 v19, s26, v19
  v_add_u32 v12, 4096, v56
  v_add_u32 v20, 4096, v2
  v_add_u32 v20, s26, v20
  v_add_u32 v13, 4352, v56
  v_add_u32 v21, 5120, v2
  v_add_u32 v21, s26, v21
  v_add_u32 v14, 6144, v56
  v_add_u32 v22, 6144, v2
  v_add_u32 v22, s26, v22
  v_add_u32 v15, 6400, v56
  v_add_u32 v23, 7168, v2
  v_add_u32 v23, s26, v23
  v_mov_b32 v20, v56
  v_lshrrev_b32 v144, 3, v1
  v_mul_lo_u32 v144, v144, s18
  v_and_b32 v145, 7, v1
  v_lshl_add_u32 v144, v145, 4, v144
  s_lshl_b32 s28, s16, 15
  s_add_u32 s28, s28, 32768
  s_lshl_b32 s29, s18, 3
  s_add_u32 m0, s28, 0
  s_nop 0
  buffer_load_dwordx4 v144, s[8:11], s17 offen lds
  s_add_u32 s17, s17, s29
  s_add_u32 m0, s28, 1024
  s_nop 0
  buffer_load_dwordx4 v144, s[8:11], s17 offen lds
  s_add_u32 s17, s17, s29
  s_add_u32 m0, s28, 2048
  s_nop 0
  buffer_load_dwordx4 v144, s[8:11], s17 offen lds
  s_add_u32 s17, s17, s29
  s_add_u32 m0, s28, 3072
  s_nop 0
  buffer_load_dwordx4 v144, s[8:11], s17 offen lds
  s_add_u32 s17, s17, s29
  s_add_u32 m0, s28, 4096
  s_nop 0
  buffer_load_dwordx4 v144, s[8:11], s17 offen lds
  s_add_u32 s17, s17, s29
  s_add_u32 m0, s28, 5120
  s_nop 0
  buffer_load_dwordx4 v144, s[8:11], s17 offen lds
  s_add_u32 s17, s17, s29
  s_add_u32 m0, s28, 6144
  s_nop 0
  buffer_load_dwordx4 v144, s[8:11], s17 offen lds
  s_add_u32 s17, s17, s29
  s_add_u32 m0, s28, 7168
  s_nop 0
  buffer_load_dwordx4 v144, s[8:11], s17 offen lds
  s_add_u32 s17, s17, s29
  s_add_u32 m0, s28, 8192
  s_nop 0
  buffer_load_dwordx4 v144, s[8:11], s17 offen lds
  s_add_u32 s17, s17, s29
  s_add_u32 m0, s28, 9216
  s_nop 0
  buffer_load_dwordx4 v144, s[8:11], s17 offen lds
  s_add_u32 s17, s17, s29
  s_add_u32 m0, s28, 10240
  s_nop 0
  buffer_load_dwordx4 v144, s[8:11], s17 offen lds
  s_add_u32 s17, s17, s29
  s_add_u32 m0, s28, 11264
  s_nop 0
  buffer_load_dwordx4 v144, s[8:11], s17 offen lds
  s_add_u32 s17, s17, s29
  s_add_u32 m0, s28, 12288
  s_nop 0
  buffer_load_dwordx4 v144, s[8:11], s17 offen lds
  s_add_u32 s17, s17, s29
  s_add_u32 m0, s28, 13312
  s_nop 0
  buffer_load_dwordx4 v144, s[8:11], s17 offen lds
  s_add_u32 s17, s17, s29
  s_add_u32 m0, s28, 14336
  s_nop 0
  buffer_load_dwordx4 v144, s[8:11], s17 offen lds
  s_add_u32 s17, s17, s29
  s_add_u32 m0, s28, 15360
  s_nop 0
  buffer_load_dwordx4 v144, s[8:11], s17 offen lds
  s_add_u32 s17, s17, s29
  s_add_u32 m0, s28, 16384
  s_nop 0
  buffer_load_dwordx4 v144, s[8:11], s17 offen lds
  s_add_u32 s17, s17, s29
  s_add_u32 m0, s28, 17408
  s_nop 0
  buffer_load_dwordx4 v144, s[8:11], s17 offen lds
  s_add_u32 s17, s17, s29
  s_add_u32 m0, s28, 18432
  s_nop 0
  buffer_load_dwordx4 v144, s[8:11], s17 offen lds
  s_add_u32 s17, s17, s29
  s_add_u32 m0, s28, 19456
  s_nop 0
  buffer_load_dwordx4 v144, s[8:11], s17 offen lds
  s_add_u32 s17, s17, s29
  s_add_u32 m0, s28, 20480
  s_nop 0
  buffer_load_dwordx4 v144, s[8:11], s17 offen lds
  s_add_u32 s17, s17, s29
  s_add_u32 m0, s28, 21504
  s_nop 0
  buffer_load_dwordx4 v144, s[8:11], s17 offen lds
  s_add_u32 s17, s17, s29
  s_add_u32 m0, s28, 22528
  s_nop 0
  buffer_load_dwordx4 v144, s[8:11], s17 offen lds
  s_add_u32 s17, s17, s29
  s_add_u32 m0, s28, 23552
  s_nop 0
  buffer_load_dwordx4 v144, s[8:11], s17 offen lds
  s_add_u32 s17, s17, s29
  s_add_u32 m0, s28, 24576
  s_nop 0
  buffer_load_dwordx4 v144, s[8:11], s17 offen lds
  s_add_u32 s17, s17, s29
  s_add_u32 m0, s28, 25600
  s_nop 0
  buffer_load_dwordx4 v144, s[8:11], s17 offen lds
  s_add_u32 s17, s17, s29
  s_add_u32 m0, s28, 26624
  s_nop 0
  buffer_load_dwordx4 v144, s[8:11], s17 offen lds
  s_add_u32 s17, s17, s29
  s_add_u32 m0, s28, 27648
  s_nop 0
  buffer_load_dwordx4 v144, s[8:11], s17 offen lds
  s_add_u32 s17, s17, s29
  s_add_u32 m0, s28, 28672
  s_nop 0
  buffer_load_dwordx4 v144, s[8:11], s17 offen lds
  s_add_u32 s17, s17, s29
  s_add_u32 m0, s28, 29696
  s_nop 0
  buffer_load_dwordx4 v144, s[8:11], s17 offen lds
  s_add_u32 s17, s17, s29
  s_add_u32 m0, s28, 30720
  s_nop 0
  buffer_load_dwordx4 v144, s[8:11], s17 offen lds
  s_add_u32 s17, s17, s29
  s_add_u32 m0, s28, 31744
  s_nop 0
  buffer_load_dwordx4 v144, s[8:11], s17 offen lds
  s_add_u32 s17, s17, s29
  v_bfe_u32 v148, v1, 2, 2
  v_lshrrev_b32 v149, 5, v1
  v_lshl_add_u32 v148, v149, 4, v148
  v_bfe_u32 v149, v1, 4, 1
  v_lshl_add_u32 v148, v149, 2, v148
  v_and_b32 v149, 3, v1
  v_lshlrev_b32 v149, 4, v149
  s_mov_b32 s26, 8
  v_lshl_add_u32 v148, v148, 7, v149
  v_add_u32 v152, s28, v148
  v_add_u32 v153, 1024, v152
  v_add_u32 v154, s26, v152
  v_add_u32 v155, s26, v153
  s_waitcnt vmcnt(28)
  ds_read_b64_tr_b16 a[0:1], v152 offset:0
  ds_read_b64_tr_b16 a[2:3], v153 offset:0
  ds_read_b64_tr_b16 a[4:5], v154 offset:0
  ds_read_b64_tr_b16 a[6:7], v155 offset:0
  ds_read_b64_tr_b16 a[8:9], v152 offset:64
  ds_read_b64_tr_b16 a[10:11], v153 offset:64
  ds_read_b64_tr_b16 a[12:13], v154 offset:64
  ds_read_b64_tr_b16 a[14:15], v155 offset:64
  s_waitcnt lgkmcnt(0)
  s_add_u32 m0, s28, 0
  s_nop 0
  buffer_load_dwordx4 v144, s[8:11], s17 offen lds
  s_add_u32 s17, s17, s29
  s_add_u32 m0, s28, 1024
  s_nop 0
  buffer_load_dwordx4 v144, s[8:11], s17 offen lds
  s_add_u32 s17, s17, s29
  s_add_u32 m0, s28, 2048
  s_nop 0
  buffer_load_dwordx4 v144, s[8:11], s17 offen lds
  s_add_u32 s17, s17, s29
  s_add_u32 m0, s28, 3072
  s_nop 0
  buffer_load_dwordx4 v144, s[8:11], s17 offen lds
  s_add_u32 s17, s17, s29
  s_waitcnt vmcnt(28)
  ds_read_b64_tr_b16 a[16:17], v152 offset:4096
  ds_read_b64_tr_b16 a[18:19], v153 offset:4096
  ds_read_b64_tr_b16 a[20:21], v154 offset:4096
  ds_read_b64_tr_b16 a[22:23], v155 offset:4096
  ds_read_b64_tr_b16 a[24:25], v152 offset:4160
  ds_read_b64_tr_b16 a[26:27], v153 offset:4160
  ds_read_b64_tr_b16 a[28:29], v154 offset:4160
  ds_read_b64_tr_b16 a[30:31], v155 offset:4160
  s_waitcnt lgkmcnt(0)
  s_add_u32 m0, s28, 4096
  s_nop 0
  buffer_load_dwordx4 v144, s[8:11], s17 offen lds
  s_add_u32 s17, s17, s29
  s_add_u32 m0, s28, 5120
  s_nop 0
  buffer_load_dwordx4 v144, s[8:11], s17 offen lds
  s_add_u32 s17, s17, s29
  s_add_u32 m0, s28, 6144
  s_nop 0
  buffer_load_dwordx4 v144, s[8:11], s17 offen lds
  s_add_u32 s17, s17, s29
  s_add_u32 m0, s28, 7168
  s_nop 0
  buffer_load_dwordx4 v144, s[8:11], s17 offen lds
  s_add_u32 s17, s17, s29
  s_waitcnt vmcnt(28)
  ds_read_b64_tr_b16 a[32:33], v152 offset:8192
  ds_read_b64_tr_b16 a[34:35], v153 offset:8192
  ds_read_b64_tr_b16 a[36:37], v154 offset:8192
  ds_read_b64_tr_b16 a[38:39], v155 offset:8192
  ds_read_b64_tr_b16 a[40:41], v152 offset:8256
  ds_read_b64_tr_b16 a[42:43], v153 offset:8256
  ds_read_b64_tr_b16 a[44:45], v154 offset:8256
  ds_read_b64_tr_b16 a[46:47], v155 offset:8256
  s_waitcnt lgkmcnt(0)
  s_add_u32 m0, s28, 8192
  s_nop 0
  buffer_load_dwordx4 v144, s[8:11], s17 offen lds
  s_add_u32 s17, s17, s29
  s_add_u32 m0, s28, 9216
  s_nop 0
  buffer_load_dwordx4 v144, s[8:11], s17 offen lds
  s_add_u32 s17, s17, s29
  s_add_u32 m0, s28, 10240
  s_nop 0
  buffer_load_dwordx4 v144, s[8:11], s17 offen lds
  s_add_u32 s17, s17, s29
  s_add_u32 m0, s28, 11264
  s_nop 0
  buffer_load_dwordx4 v144, s[8:11], s17 offen lds
  s_add_u32 s17, s17, s29
  s_waitcnt vmcnt(28)
  ds_read_b64_tr_b16 a[48:49], v152 offset:12288
  ds_read_b64_tr_b16 a[50:51], v153 offset:12288
  ds_read_b64_tr_b16 a[52:53], v154 offset:12288
  ds_read_b64_tr_b16 a[54:55], v155 offset:12288
  ds_read_b64_tr_b16 a[56:57], v152 offset:12352
  ds_read_b64_tr_b16 a[58:59], v153 offset:12352
  ds_read_b64_tr_b16 a[60:61], v154 offset:12352
  ds_read_b64_tr_b16 a[62:63], v155 offset:12352
  s_waitcnt lgkmcnt(0)
  s_add_u32 m0, s28, 12288
  s_nop 0
  buffer_load_dwordx4 v144, s[8:11], s17 offen lds
  s_add_u32 s17, s17, s29
  s_add_u32 m0, s28, 13312
  s_nop 0
  buffer_load_dwordx4 v144, s[8:11], s17 offen lds
  s_add_u32 s17, s17, s29
  s_add_u32 m0, s28, 14336
  s_nop 0
  buffer_load_dwordx4 v144, s[8:11], s17 offen lds
  s_add_u32 s17, s17, s29
  s_add_u32 m0, s28, 15360
  s_nop 0
  buffer_load_dwordx4 v144, s[8:11], s17 offen lds
  s_add_u32 s17, s17, s29
  s_waitcnt vmcnt(28)
  ds_read_b64_tr_b16 a[64:65], v152 offset:16384
  ds_read_b64_tr_b16 a[66:67], v153 offset:16384
  ds_read_b64_tr_b16 a[68:69], v154 offset:16384
  ds_read_b64_tr_b16 a[70:71], v155 offset:16384
  ds_read_b64_tr_b16 a[72:73], v152 offset:16448
  ds_read_b64_tr_b16 a[74:75], v153 offset:16448
  ds_read_b64_tr_b16 a[76:77], v154 offset:16448
  ds_read_b64_tr_b16 a[78:79], v155 offset:16448
  s_waitcnt lgkmcnt(0)
  s_add_u32 m0, s28, 16384
  s_nop 0
  buffer_load_dwordx4 v144, s[8:11], s17 offen lds
  s_add_u32 s17, s17, s29
  s_add_u32 m0, s28, 17408
  s_nop 0
  buffer_load_dwordx4 v144, s[8:11], s17 offen lds
  s_add_u32 s17, s17, s29
  s_add_u32 m0, s28, 18432
  s_nop 0
  buffer_load_dwordx4 v144, s[8:11], s17 offen lds
  s_add_u32 s17, s17, s29
  s_add_u32 m0, s28, 19456
  s_nop 0
  buffer_load_dwordx4 v144, s[8:11], s17 offen lds
  s_add_u32 s17, s17, s29
  s_waitcnt vmcnt(28)
  ds_read_b64_tr_b16 a[80:81], v152 offset:20480
  ds_read_b64_tr_b16 a[82:83], v153 offset:20480
  ds_read_b64_tr_b16 a[84:85], v154 offset:20480
  ds_read_b64_tr_b16 a[86:87], v155 offset:20480
  ds_read_b64_tr_b16 a[88:89], v152 offset:20544
  ds_read_b64_tr_b16 a[90:91], v153 offset:20544
  ds_read_b64_tr_b16 a[92:93], v154 offset:20544
  ds_read_b64_tr_b16 a[94:95], v155 offset:20544
  s_waitcnt lgkmcnt(0)
  s_add_u32 m0, s28, 20480
  s_nop 0
  buffer_load_dwordx4 v144, s[8:11], s17 offen lds
  s_add_u32 s17, s17, s29
  s_add_u32 m0, s28, 21504
  s_nop 0
  buffer_load_dwordx4 v144, s[8:11], s17 offen lds
  s_add_u32 s17, s17, s29
  s_add_u32 m0, s28, 22528
  s_nop 0
  buffer_load_dwordx4 v144, s[8:11], s17 offen lds
  s_add_u32 s17, s17, s29
  s_add_u32 m0, s28, 23552
  s_nop 0
  buffer_load_dwordx4 v144, s[8:11], s17 offen lds
  s_add_u32 s17, s17, s29
  s_waitcnt vmcnt(28)
  ds_read_b64_tr_b16 a[96:97], v152 offset:24576
  ds_read_b64_tr_b16 a[98:99], v153 offset:24576
  ds_read_b64_tr_b16 a[100:101], v154 offset:24576
  ds_read_b64_tr_b16 a[102:103], v155 offset:24576
  ds_read_b64_tr_b16 a[104:105], v152 offset:24640
  ds_read_b64_tr_b16 a[106:107], v153 offset:24640
  ds_read_b64_tr_b16 a[108:109], v154 offset:24640
  ds_read_b64_tr_b16 a[110:111], v155 offset:24640
  s_waitcnt lgkmcnt(0)
  s_add_u32 m0, s28, 24576
  s_nop 0
  buffer_load_dwordx4 v144, s[8:11], s17 offen lds
  s_add_u32 s17, s17, s29
  s_add_u32 m0, s28, 25600
  s_nop 0
  buffer_load_dwordx4 v144, s[8:11], s17 offen lds
  s_add_u32 s17, s17, s29
  s_add_u32 m0, s28, 26624
  s_nop 0
  buffer_load_dwordx4 v144, s[8:11], s17 offen lds
  s_add_u32 s17, s17, s29
  s_add_u32 m0, s28, 27648
  s_nop 0
  buffer_load_dwordx4 v144, s[8:11], s17 offen lds
  s_add_u32 s17, s17, s29
  s_waitcnt vmcnt(28)
  ds_read_b64_tr_b16 a[112:113], v152 offset:28672
  ds_read_b64_tr_b16 a[114:115], v153 offset:28672
  ds_read_b64_tr_b16 a[116:117], v154 offset:28672
  ds_read_b64_tr_b16 a[118:119], v155 offset:28672
  ds_read_b64_tr_b16 a[120:121], v152 offset:28736
  ds_read_b64_tr_b16 a[122:123], v153 offset:28736
  ds_read_b64_tr_b16 a[124:125], v154 offset:28736
  ds_read_b64_tr_b16 a[126:127], v155 offset:28736
  s_waitcnt lgkmcnt(0)
  s_add_u32 m0, s28, 28672
  s_nop 0
  buffer_load_dwordx4 v144, s[8:11], s17 offen lds
  s_add_u32 s17, s17, s29
  s_add_u32 m0, s28, 29696
  s_nop 0
  buffer_load_dwordx4 v144, s[8:11], s17 offen lds
  s_add_u32 s17, s17, s29
  s_add_u32 m0, s28, 30720
  s_nop 0
  buffer_load_dwordx4 v144, s[8:11], s17 offen lds
  s_add_u32 s17, s17, s29
  s_add_u32 m0, s28, 31744
  s_nop 0
  buffer_load_dwordx4 v144, s[8:11], s17 offen lds
  s_add_u32 s17, s17, s29
  s_waitcnt vmcnt(28)
  ds_read_b64_tr_b16 a[128:129], v152 offset:0
  ds_read_b64_tr_b16 a[130:131], v153 offset:0
  ds_read_b64_tr_b16 a[132:133], v154 offset:0
  ds_read_b64_tr_b16 a[134:135], v155 offset:0
  ds_read_b64_tr_b16 a[136:137], v152 offset:64
  ds_read_b64_tr_b16 a[138:139], v153 offset:64
  ds_read_b64_tr_b16 a[140:141], v154 offset:64
  ds_read_b64_tr_b16 a[142:143], v155 offset:64
  s_waitcnt lgkmcnt(0)
  s_waitcnt vmcnt(24)
  ds_read_b64_tr_b16 a[144:145], v152 offset:4096
  ds_read_b64_tr_b16 a[146:147], v153 offset:4096
  ds_read_b64_tr_b16 a[148:149], v154 offset:4096
  ds_read_b64_tr_b16 a[150:151], v155 offset:4096
  ds_read_b64_tr_b16 a[152:153], v152 offset:4160
  ds_read_b64_tr_b16 a[154:155], v153 offset:4160
  ds_read_b64_tr_b16 a[156:157], v154 offset:4160
  ds_read_b64_tr_b16 a[158:159], v155 offset:4160
  s_waitcnt lgkmcnt(0)
  s_waitcnt vmcnt(20)
  ds_read_b64_tr_b16 a[160:161], v152 offset:8192
  ds_read_b64_tr_b16 a[162:163], v153 offset:8192
  ds_read_b64_tr_b16 a[164:165], v154 offset:8192
  ds_read_b64_tr_b16 a[166:167], v155 offset:8192
  ds_read_b64_tr_b16 a[168:169], v152 offset:8256
  ds_read_b64_tr_b16 a[170:171], v153 offset:8256
  ds_read_b64_tr_b16 a[172:173], v154 offset:8256
  ds_read_b64_tr_b16 a[174:175], v155 offset:8256
  s_waitcnt lgkmcnt(0)
  s_waitcnt vmcnt(16)
  ds_read_b64_tr_b16 a[176:177], v152 offset:12288
  ds_read_b64_tr_b16 a[178:179], v153 offset:12288
  ds_read_b64_tr_b16 a[180:181], v154 offset:12288
  ds_read_b64_tr_b16 a[182:183], v155 offset:12288
  ds_read_b64_tr_b16 a[184:185], v152 offset:12352
  ds_read_b64_tr_b16 a[186:187], v153 offset:12352
  ds_read_b64_tr_b16 a[188:189], v154 offset:12352
  ds_read_b64_tr_b16 a[190:191], v155 offset:12352
  s_waitcnt lgkmcnt(0)
  s_waitcnt vmcnt(12)
  ds_read_b64_tr_b16 a[192:193], v152 offset:16384
  ds_read_b64_tr_b16 a[194:195], v153 offset:16384
  ds_read_b64_tr_b16 a[196:197], v154 offset:16384
  ds_read_b64_tr_b16 a[198:199], v155 offset:16384
  ds_read_b64_tr_b16 a[200:201], v152 offset:16448
  ds_read_b64_tr_b16 a[202:203], v153 offset:16448
  ds_read_b64_tr_b16 a[204:205], v154 offset:16448
  ds_read_b64_tr_b16 a[206:207], v155 offset:16448
  s_waitcnt lgkmcnt(0)
  s_waitcnt vmcnt(8)
  ds_read_b64_tr_b16 a[208:209], v152 offset:20480
  ds_read_b64_tr_b16 a[210:211], v153 offset:20480
  ds_read_b64_tr_b16 a[212:213], v154 offset:20480
  ds_read_b64_tr_b16 a[214:215], v155 offset:20480
  ds_read_b64_tr_b16 a[216:217], v152 offset:20544
  ds_read_b64_tr_b16 a[218:219], v153 offset:20544
  ds_read_b64_tr_b16 a[220:221], v154 offset:20544
  ds_read_b64_tr_b16 a[222:223], v155 offset:20544
  s_waitcnt lgkmcnt(0)
  s_waitcnt vmcnt(4)
  ds_read_b64_tr_b16 a[224:225], v152 offset:24576
  ds_read_b64_tr_b16 a[226:227], v153 offset:24576
  ds_read_b64_tr_b16 a[228:229], v154 offset:24576
  ds_read_b64_tr_b16 a[230:231], v155 offset:24576
  ds_read_b64_tr_b16 a[232:233], v152 offset:24640
  ds_read_b64_tr_b16 a[234:235], v153 offset:24640
  ds_read_b64_tr_b16 a[236:237], v154 offset:24640
  ds_read_b64_tr_b16 a[238:239], v155 offset:24640
  s_waitcnt lgkmcnt(0)
  s_waitcnt vmcnt(0)
  ds_read_b64_tr_b16 a[240:241], v152 offset:28672
  ds_read_b64_tr_b16 a[242:243], v153 offset:28672
  ds_read_b64_tr_b16 a[244:245], v154 offset:28672
  ds_read_b64_tr_b16 a[246:247], v155 offset:28672
  ds_read_b64_tr_b16 a[248:249], v152 offset:28736
  ds_read_b64_tr_b16 a[250:251], v153 offset:28736
  ds_read_b64_tr_b16 a[252:253], v154 offset:28736
  ds_read_b64_tr_b16 a[254:255], v155 offset:28736
  s_waitcnt lgkmcnt(0)
  s_lshl_b32 s26, s48, 2
  s_add_u32 s26, s26, s16
  s_lshl_b32 s27, s26, 6
  s_add_u32 s27, s27, s50
  s_lshl_b32 s19, s27, 13
  s_lshl_b32 s27, s50, 5
  s_add_u32 s27, s27, s26
  s_mul_i32 s27, s27, 4096
  s_add_u32 s20, s27, 135266304
  s_lshl_b32 s25, s16, 12
  s_add_u32 s25, s25, 65536
  s_lshl_b32 s26, s16, 13
  v_add_u32 v3, s26, v2
  v_lshrrev_b32 v16, 5, v1
  v_and_b32 v17, 31, v1
  v_bfe_u32 v18, v1, 4, 1
  v_lshl_add_u32 v18, v18, 1, v16
  v_and_b32 v19, 15, v1
  v_lshl_add_u32 v18, v18, 4, v19
  v_lshl_add_u32 v5, v18, 4, s25
  v_bfe_u32 v18, v1, 2, 2
  v_lshl_add_u32 v18, v16, 2, v18
  v_and_b32 v19, 1, v1
  v_lshl_add_u32 v18, v19, 4, v18
  v_lshl_add_u32 v4, v18, 4, s25
  v_lshlrev_b32 v16, 2, v16
  v_sub_u32 v17, v17, v16
  v_mov_b32 v18, 0xf149f2ca
  v_cmp_le_i32 vcc, 0, v17
  s_nop 1
  v_cndmask_b32 v240, v18, 0, vcc
  v_cmp_le_i32 vcc, 1, v17
  s_nop 1
  v_cndmask_b32 v241, v18, 0, vcc
  v_cmp_le_i32 vcc, 2, v17
  s_nop 1
  v_cndmask_b32 v242, v18, 0, vcc
  v_cmp_le_i32 vcc, 3, v17
  s_nop 1
  v_cndmask_b32 v243, v18, 0, vcc
  v_cmp_le_i32 vcc, 8, v17
  s_nop 1
  v_cndmask_b32 v244, v18, 0, vcc
  v_cmp_le_i32 vcc, 9, v17
  s_nop 1
  v_cndmask_b32 v245, v18, 0, vcc
  v_cmp_le_i32 vcc, 10, v17
  s_nop 1
  v_cndmask_b32 v246, v18, 0, vcc
  v_cmp_le_i32 vcc, 11, v17
  s_nop 1
  v_cndmask_b32 v247, v18, 0, vcc
  v_cmp_le_i32 vcc, 16, v17
  s_nop 1
  v_cndmask_b32 v248, v18, 0, vcc
  v_cmp_le_i32 vcc, 17, v17
  s_nop 1
  v_cndmask_b32 v249, v18, 0, vcc
  v_cmp_le_i32 vcc, 18, v17
  s_nop 1
  v_cndmask_b32 v250, v18, 0, vcc
  v_cmp_le_i32 vcc, 19, v17
  s_nop 1
  v_cndmask_b32 v251, v18, 0, vcc
  v_cmp_le_i32 vcc, 24, v17
  s_nop 1
  v_cndmask_b32 v252, v18, 0, vcc
  v_cmp_le_i32 vcc, 25, v17
  s_nop 1
  v_cndmask_b32 v253, v18, 0, vcc
  v_cmp_le_i32 vcc, 26, v17
  s_nop 1
  v_cndmask_b32 v254, v18, 0, vcc
  v_cmp_le_i32 vcc, 27, v17
  s_nop 1
  v_cndmask_b32 v255, v18, 0, vcc
  v_mov_b32 v21, v2
  s_barrier
  s_lshl_b32 s77, s48, 2
  s_add_u32 s77, s77, s16
  s_mul_i32 s78, s77, 896
  s_add_u32 s76, s78, 148898304
  s_mov_b32 s71, 0
  s_branch M_sg_191
M_sw_190:
  s_sleep 8
  s_add_u32 s71, s71, 1
  s_cmp_gt_u32 s71, 262144
  s_cbranch_scc1 M_exit
M_sg_191:
  s_mov_b32 s79, 0
  s_atomic_or s79, s[72:73], s76 glc
  s_waitcnt lgkmcnt(0)
  s_cmp_lt_u32 s79, 12
  s_cbranch_scc1 M_sw_190
  s_add_u32 s76, s78, 148898048
  s_mov_b32 s71, 0
  s_branch M_sg_193
M_sw_192:
  s_sleep 8
  s_add_u32 s71, s71, 1
  s_cmp_gt_u32 s71, 262144
  s_cbranch_scc1 M_exit
M_sg_193:
  s_mov_b32 s79, 0
  s_atomic_or s79, s[72:73], s76 glc
  s_waitcnt lgkmcnt(0)
  s_cmp_lt_u32 s79, 6
  s_cbranch_scc1 M_sw_192
  s_add_u32 s76, s78, 148898176
  s_mov_b32 s71, 0
  s_branch M_sg_195
M_sw_194:
  s_sleep 8
  s_add_u32 s71, s71, 1
  s_cmp_gt_u32 s71, 262144
  s_cbranch_scc1 M_exit
M_sg_195:
  s_mov_b32 s79, 0
  s_atomic_or s79, s[72:73], s76 glc
  s_waitcnt lgkmcnt(0)
  s_cmp_lt_u32 s79, 6
  s_cbranch_scc1 M_sw_194
M_xok_189:
  s_lshl_b32 s77, s77, 7
  s_add_u32 s54, s77, 148926464
  s_add_u32 s52, s50, 1
  s_mov_b32 s53, 0
  s_mov_b32 s30, 0x200
  s_add_u32 s28, s19, 50331648
  buffer_load_dwordx4 v[144:147], v21, s[4:7], s28 offen offset:0 sc1
  buffer_load_dwordx4 v[148:151], v21, s[4:7], s28 offen offset:1024 sc1
  buffer_load_dwordx4 v[152:155], v21, s[4:7], s28 offen offset:2048 sc1
  buffer_load_dwordx4 v[156:159], v21, s[4:7], s28 offen offset:3072 sc1
  s_add_u32 s29, s19, 50335744
  buffer_load_dwordx4 v[160:163], v21, s[4:7], s29 offen offset:0 sc1
  buffer_load_dwordx4 v[164:167], v21, s[4:7], s29 offen offset:1024 sc1
  buffer_load_dwordx4 v[168:171], v21, s[4:7], s29 offen offset:2048 sc1
  buffer_load_dwordx4 v[172:175], v21, s[4:7], s29 offen offset:3072 sc1
  s_add_u32 s28, s19, 67108864
  buffer_load_dwordx4 v[176:179], v21, s[4:7], s28 offen offset:0 sc1
  buffer_load_dwordx4 v[180:183], v21, s[4:7], s28 offen offset:1024 sc1
  buffer_load_dwordx4 v[184:187], v21, s[4:7], s28 offen offset:2048 sc1
  buffer_load_dwordx4 v[188:191], v21, s[4:7], s28 offen offset:3072 sc1
  s_add_u32 s29, s19, 67112960
  buffer_load_dwordx4 v[192:195], v21, s[4:7], s29 offen offset:0 sc1
  buffer_load_dwordx4 v[196:199], v21, s[4:7], s29 offen offset:1024 sc1
  buffer_load_dwordx4 v[200:203], v21, s[4:7], s29 offen offset:2048 sc1
  buffer_load_dwordx4 v[204:207], v21, s[4:7], s29 offen offset:3072 sc1
  s_add_u32 s28, s19, 83886080
  buffer_load_dwordx4 v[208:211], v21, s[4:7], s28 offen offset:0 sc1
  buffer_load_dwordx4 v[212:215], v21, s[4:7], s28 offen offset:1024 sc1
  buffer_load_dwordx4 v[216:219], v21, s[4:7], s28 offen offset:2048 sc1
  buffer_load_dwordx4 v[220:223], v21, s[4:7], s28 offen offset:3072 sc1
  s_add_u32 s29, s19, 83890176
  buffer_load_dwordx4 v[224:227], v21, s[4:7], s29 offen offset:0 sc1
  buffer_load_dwordx4 v[228:231], v21, s[4:7], s29 offen offset:1024 sc1
  buffer_load_dwordx4 v[232:235], v21, s[4:7], s29 offen offset:2048 sc1
  buffer_load_dwordx4 v[236:239], v21, s[4:7], s29 offen offset:3072 sc1
  s_mov_b32 s24, 0
  v_mov_b32 v22, 0x40000000
  s_sub_u32 s21, s21, s22
F_top_196:
  s_waitcnt vmcnt(8)
  v_mfma_f32_32x32x16_bf16 v[24:39], v[176:179], v[144:147], v[240:255]
  s_nop 1
  v_cvt_pk_bf16_f32 v128, v64, v65
  v_cvt_pk_bf16_f32 v129, v66, v67
  v_cvt_pk_bf16_f32 v130, v68, v69
  v_cvt_pk_bf16_f32 v131, v70, v71
  v_mfma_f32_32x32x16_bf16 v[24:39], v[180:183], v[148:151], v[24:39]
  buffer_store_dwordx4 v[128:131], v22, s[4:7], s21 offen offset:0 sc1
  v_mfma_f32_32x32x16_bf16 v[24:39], v[184:187], v[152:155], v[24:39]
  v_cvt_pk_bf16_f32 v132, v72, v73
  v_cvt_pk_bf16_f32 v133, v74, v75
  v_cvt_pk_bf16_f32 v134, v76, v77
  v_cvt_pk_bf16_f32 v135, v78, v79
  v_mfma_f32_32x32x16_bf16 v[24:39], v[188:191], v[156:159], v[24:39]
  buffer_store_dwordx4 v[132:135], v22, s[4:7], s21 offen offset:256 sc1
  v_mfma_f32_32x32x16_bf16 v[24:39], v[192:195], v[160:163], v[24:39]
  v_cvt_pk_bf16_f32 v136, v80, v81
  v_cvt_pk_bf16_f32 v137, v82, v83
  v_cvt_pk_bf16_f32 v138, v84, v85
  v_cvt_pk_bf16_f32 v139, v86, v87
  v_mfma_f32_32x32x16_bf16 v[24:39], v[196:199], v[164:167], v[24:39]
  buffer_store_dwordx4 v[136:139], v22, s[4:7], s21 offen offset:2048 sc1
  v_mfma_f32_32x32x16_bf16 v[24:39], v[200:203], v[168:171], v[24:39]
  v_cvt_pk_bf16_f32 v140, v88, v89
  v_cvt_pk_bf16_f32 v141, v90, v91
  v_cvt_pk_bf16_f32 v142, v92, v93
  v_cvt_pk_bf16_f32 v143, v94, v95
  v_mfma_f32_32x32x16_bf16 v[24:39], v[204:207], v[172:175], v[24:39]
  buffer_store_dwordx4 v[140:143], v22, s[4:7], s21 offen offset:2304 sc1
  s_add_u32 s21, s21, s22
  v_mov_b32 v22, v20
  s_cmp_lg_u32 s24, 0
  s_cbranch_scc1 F_have_197
  s_cmp_le_u32 s52, 58
  s_cbranch_scc1 M_dp_198
  s_mov_b32 s71, 0
  v_add_u32 v16, s25, v2
  s_waitcnt vmcnt(9)
  s_branch M_dp_200
M_dp_199:
  s_add_u32 s71, s71, 1
  s_cmp_gt_u32 s71, 262144
  s_cbranch_scc1 M_exit
  buffer_load_dword v23, off, s[4:7], s54 sc1
  buffer_load_dwordx4 v[96:99], v2, s[4:7], s20 offen offset:0 sc1
  buffer_load_dwordx4 v[100:103], v2, s[4:7], s20 offen offset:1024 sc1
  buffer_load_dwordx4 v[104:107], v2, s[4:7], s20 offen offset:2048 sc1
  buffer_load_dwordx4 v[108:111], v2, s[4:7], s20 offen offset:3072 sc1
  s_waitcnt vmcnt(0)
M_dp_200:
  v_max_u32 v17, v96, v97
  v_max3_u32 v17, v17, v98, v99
  v_max3_u32 v17, v17, v100, v101
  v_max3_u32 v17, v17, v102, v103
  v_max3_u32 v17, v17, v104, v105
  v_max3_u32 v17, v17, v106, v107
  v_max3_u32 v17, v17, v108, v109
  v_max3_u32 v17, v17, v110, v111
  v_cmp_eq_u32 vcc, -1, v17
  s_cbranch_vccz M_dp_201
  v_cmp_gt_u32 vcc, s52, v23
  s_cbranch_vccnz M_dp_199
  s_branch M_dp_198
M_dp_201:
  ds_write_b128 v16, v[96:99] offset:0
  ds_write_b128 v16, v[100:103] offset:1024
  ds_write_b128 v16, v[104:107] offset:2048
  ds_write_b128 v16, v[108:111] offset:3072
  s_branch F_have_197
M_dp_198:
  v_mov_b32 v16, s54
  v_mov_b32 v17, s52
  s_mov_b32 s71, 0
  s_branch M_vg_203
M_vw_202:
  s_sleep 2
  s_add_u32 s71, s71, 1
  s_cmp_gt_u32 s71, 262144
  s_cbranch_scc1 M_exit
M_vg_203:
  buffer_load_dword v23, v16, s[4:7], 0 offen sc1
  s_waitcnt vmcnt(0)
  v_cmp_lt_u32 vcc, v23, v17
  s_cbranch_vccnz M_vw_202
  s_mov_b32 m0, s25
  s_nop 0
  buffer_load_dwordx4 v2, s[4:7], s20 offen offset:0 sc1 lds
  buffer_load_dwordx4 v2, s[4:7], s20 offen offset:1024 sc1 lds
  buffer_load_dwordx4 v2, s[4:7], s20 offen offset:2048 sc1 lds
  buffer_load_dwordx4 v2, s[4:7], s20 offen offset:3072 sc1 lds
  s_waitcnt vmcnt(0)
F_have_197:
  ds_read_b64_tr_b16 v[176:177], v4 offset:8
  ds_read_b64_tr_b16 v[178:179], v4 offset:136
  ds_read_b64_tr_b16 v[180:181], v4 offset:520
  ds_read_b64_tr_b16 v[182:183], v4 offset:648
  ds_read_b64_tr_b16 v[184:185], v4 offset:1032
  ds_read_b64_tr_b16 v[186:187], v4 offset:1160
  ds_read_b64_tr_b16 v[188:189], v4 offset:1544
  ds_read_b64_tr_b16 v[190:191], v4 offset:1672
  ds_read_b64_tr_b16 v[192:193], v4 offset:2056
  ds_read_b64_tr_b16 v[194:195], v4 offset:2184
  ds_read_b64_tr_b16 v[196:197], v4 offset:2568
  ds_read_b64_tr_b16 v[198:199], v4 offset:2696
  s_sub_u32 s23, s23, 1
  s_cmp_gt_u32 s23, 0
  s_cselect_b32 s26, s51, 0
  s_cselect_b32 s27, 0, 0x40000000
  v_or_b32 v21, s27, v21
  s_lshl_b32 s27, s26, 13
  s_add_u32 s19, s19, s27
  s_mul_i32 s27, s26, 131072
  s_add_u32 s20, s20, s27
  s_cmp_lg_u32 s23, 26
  s_cbranch_scc1 M_xok_204
  s_lshl_b32 s77, s48, 2
  s_add_u32 s77, s77, s16
  s_mul_i32 s78, s77, 896
  s_add_u32 s76, s78, 148898304
  s_mov_b32 s71, 0
  s_branch M_sg_206
M_sw_205:
  s_sleep 8
  s_add_u32 s71, s71, 1
  s_cmp_gt_u32 s71, 262144
  s_cbranch_scc1 M_exit
M_sg_206:
  s_mov_b32 s79, 0
  s_atomic_or s79, s[72:73], s76 glc
  s_waitcnt lgkmcnt(0)
  s_cmp_lt_u32 s79, 20
  s_cbranch_scc1 M_sw_205
  s_add_u32 s76, s78, 148898048
  s_mov_b32 s71, 0
  s_branch M_sg_208
M_sw_207:
  s_sleep 8
  s_add_u32 s71, s71, 1
  s_cmp_gt_u32 s71, 262144
  s_cbranch_scc1 M_exit
M_sg_208:
  s_mov_b32 s79, 0
  s_atomic_or s79, s[72:73], s76 glc
  s_waitcnt lgkmcnt(0)
  s_cmp_lt_u32 s79, 10
  s_cbranch_scc1 M_sw_207
  s_add_u32 s76, s78, 148898176
  s_mov_b32 s71, 0
  s_branch M_sg_210
M_sw_209:
  s_sleep 8
  s_add_u32 s71, s71, 1
  s_cmp_gt_u32 s71, 262144
  s_cbranch_scc1 M_exit
M_sg_210:
  s_mov_b32 s79, 0
  s_atomic_or s79, s[72:73], s76 glc
  s_waitcnt lgkmcnt(0)
  s_cmp_lt_u32 s79, 10
  s_cbranch_scc1 M_sw_209
M_xok_204:
  s_cmp_lg_u32 s23, 22
  s_cbranch_scc1 M_xok_211
  s_lshl_b32 s77, s48, 2
  s_add_u32 s77, s77, s16
  s_mul_i32 s78, s77, 896
  s_add_u32 s76, s78, 148898304
  s_mov_b32 s71, 0
  s_branch M_sg_213
M_sw_212:
  s_sleep 8
  s_add_u32 s71, s71, 1
  s_cmp_gt_u32 s71, 262144
  s_cbranch_scc1 M_exit
M_sg_213:
  s_mov_b32 s79, 0
  s_atomic_or s79, s[72:73], s76 glc
  s_waitcnt lgkmcnt(0)
  s_cmp_lt_u32 s79, 32
  s_cbranch_scc1 M_sw_212
  s_add_u32 s76, s78, 148898432
  s_mov_b32 s71, 0
  s_branch M_sg_215
M_sw_214:
  s_sleep 8
  s_add_u32 s71, s71, 1
  s_cmp_gt_u32 s71, 262144
  s_cbranch_scc1 M_exit
M_sg_215:
  s_mov_b32 s79, 0
  s_atomic_or s79, s[72:73], s76 glc
  s_waitcnt lgkmcnt(0)
  s_cmp_lt_u32 s79, 32
  s_cbranch_scc1 M_sw_214
  s_add_u32 s76, s78, 148898048
  s_mov_b32 s71, 0
  s_branch M_sg_217
M_sw_216:
  s_sleep 8
  s_add_u32 s71, s71, 1
  s_cmp_gt_u32 s71, 262144
  s_cbranch_scc1 M_exit
M_sg_217:
  s_mov_b32 s79, 0
  s_atomic_or s79, s[72:73], s76 glc
  s_waitcnt lgkmcnt(0)
  s_cmp_lt_u32 s79, 32
  s_cbranch_scc1 M_sw_216
  s_add_u32 s76, s78, 148898176
  s_mov_b32 s71, 0
  s_branch M_sg_219
M_sw_218:
  s_sleep 8
  s_add_u32 s71, s71, 1
  s_cmp_gt_u32 s71, 262144
  s_cbranch_scc1 M_exit
M_sg_219:
  s_mov_b32 s79, 0
  s_atomic_or s79, s[72:73], s76 glc
  s_waitcnt lgkmcnt(0)
  s_cmp_lt_u32 s79, 32
  s_cbranch_scc1 M_sw_218
M_xok_211:
  s_waitcnt lgkmcnt(10)
  v_mfma_f32_32x32x16_bf16 v[40:55], v[176:179], v[144:147], 0
  ds_read_b64_tr_b16 v[200:201], v4 offset:3080
  ds_read_b64_tr_b16 v[202:203], v4 offset:3208
  v_max_f32 v6, v24, v25
  s_waitcnt lgkmcnt(10)
  v_mfma_f32_32x32x16_bf16 v[40:55], v[180:183], v[148:151], v[40:55]
  ds_read_b64_tr_b16 v[204:205], v4 offset:3592
  ds_read_b64_tr_b16 v[206:207], v4 offset:3720
  v_max3_f32 v6, v6, v26, v27
  s_waitcnt lgkmcnt(10)
  v_mfma_f32_32x32x16_bf16 v[40:55], v[184:187], v[152:155], v[40:55]
  ds_read_b64 v[56:57], v5 offset:0
  ds_read_b64 v[58:59], v5 offset:1024
  v_max3_f32 v6, v6, v28, v29
  s_waitcnt lgkmcnt(10)
  v_mfma_f32_32x32x16_bf16 v[40:55], v[188:191], v[156:159], v[40:55]
  ds_read_b64 v[60:61], v5 offset:2048
  ds_read_b64 v[62:63], v5 offset:3072
  v_max3_f32 v6, v6, v30, v31
  s_waitcnt lgkmcnt(10)
  v_mfma_f32_32x32x16_bf16 v[40:55], v[192:195], v[160:163], v[40:55]
  v_max3_f32 v6, v6, v32, v33
  s_waitcnt lgkmcnt(8)
  v_mfma_f32_32x32x16_bf16 v[40:55], v[196:199], v[164:167], v[40:55]
  v_max3_f32 v6, v6, v34, v35
  s_waitcnt lgkmcnt(6)
  v_mfma_f32_32x32x16_bf16 v[40:55], v[200:203], v[168:171], v[40:55]
  v_max3_f32 v6, v6, v36, v37
  s_waitcnt lgkmcnt(4)
  v_mfma_f32_32x32x16_bf16 v[40:55], v[204:207], v[172:175], v[40:55]
  v_max3_f32 v6, v6, v38, v39
  s_add_u32 s28, s19, 50331648
  buffer_load_dwordx4 v[144:147], v21, s[4:7], s28 offen offset:0 sc1
  buffer_load_dwordx4 v[148:151], v21, s[4:7], s28 offen offset:1024 sc1
  s_nop 7
  v_max3_f32 v6, v6, v40, v41
  v_max3_f32 v6, v6, v42, v43
  v_mov_b32 v16, v6
  s_nop 1
  v_permlane32_swap_b32 v6, v16
  s_nop 1
  v_max_f32 v6, v6, v16
  v_pk_add_f32 v[24:25], v[24:25], v[6:7] op_sel_hi:[1,0] neg_lo:[0,1] neg_hi:[0,1]
  v_pk_add_f32 v[26:27], v[26:27], v[6:7] op_sel_hi:[1,0] neg_lo:[0,1] neg_hi:[0,1]
  v_pk_add_f32 v[28:29], v[28:29], v[6:7] op_sel_hi:[1,0] neg_lo:[0,1] neg_hi:[0,1]
  v_pk_add_f32 v[30:31], v[30:31], v[6:7] op_sel_hi:[1,0] neg_lo:[0,1] neg_hi:[0,1]
  v_pk_add_f32 v[32:33], v[32:33], v[6:7] op_sel_hi:[1,0] neg_lo:[0,1] neg_hi:[0,1]
  v_pk_add_f32 v[34:35], v[34:35], v[6:7] op_sel_hi:[1,0] neg_lo:[0,1] neg_hi:[0,1]
  v_pk_add_f32 v[36:37], v[36:37], v[6:7] op_sel_hi:[1,0] neg_lo:[0,1] neg_hi:[0,1]
  v_pk_add_f32 v[38:39], v[38:39], v[6:7] op_sel_hi:[1,0] neg_lo:[0,1] neg_hi:[0,1]
  v_pk_add_f32 v[40:41], v[40:41], v[6:7] op_sel_hi:[1,0] neg_lo:[0,1] neg_hi:[0,1]
  v_pk_add_f32 v[42:43], v[42:43], v[6:7] op_sel_hi:[1,0] neg_lo:[0,1] neg_hi:[0,1]
  v_exp_f32 v24, v24
  v_exp_f32 v25, v25
  v_exp_f32 v26, v26
  v_exp_f32 v27, v27
  v_exp_f32 v28, v28
  v_exp_f32 v29, v29
  v_exp_f32 v30, v30
  v_exp_f32 v31, v31
  v_exp_f32 v32, v32
  v_exp_f32 v33, v33
  buffer_load_dwordx4 v[152:155], v21, s[4:7], s28 offen offset:2048 sc1
  v_exp_f32 v34, v34
  v_exp_f32 v35, v35
  v_exp_f32 v36, v36
  v_exp_f32 v37, v37
  v_exp_f32 v38, v38
  v_exp_f32 v39, v39
  v_exp_f32 v40, v40
  v_exp_f32 v41, v41
  v_exp_f32 v42, v42
  v_exp_f32 v43, v43
  v_pk_add_f32 v[16:17], v[24:25], v[26:27]
  v_pk_add_f32 v[16:17], v[16:17], v[28:29]
  v_pk_add_f32 v[16:17], v[16:17], v[30:31]
  v_pk_add_f32 v[16:17], v[16:17], v[32:33]
  v_pk_add_f32 v[16:17], v[16:17], v[34:35]
  v_pk_add_f32 v[16:17], v[16:17], v[36:37]
  v_pk_add_f32 v[16:17], v[16:17], v[38:39]
  v_pk_add_f32 v[16:17], v[16:17], v[40:41]
  v_pk_add_f32 v[16:17], v[16:17], v[42:43]
  v_add_f32 v16, v16, v17
  v_mov_b32 v17, v16
  buffer_load_dwordx4 v[156:159], v21, s[4:7], s28 offen offset:3072 sc1
  s_nop 0
  v_permlane32_swap_b32 v16, v17
  s_nop 1
  v_add_f32 v16, v16, v17
  v_rcp_f32 v6, v16
  s_nop 0
  v_pk_mul_f32 v[24:25], v[24:25], v[6:7] op_sel_hi:[1,0]
  v_pk_mul_f32 v[26:27], v[26:27], v[6:7] op_sel_hi:[1,0]
  v_pk_mul_f32 v[28:29], v[28:29], v[6:7] op_sel_hi:[1,0]
  v_pk_mul_f32 v[30:31], v[30:31], v[6:7] op_sel_hi:[1,0]
  v_pk_mul_f32 v[32:33], v[32:33], v[6:7] op_sel_hi:[1,0]
  v_pk_mul_f32 v[34:35], v[34:35], v[6:7] op_sel_hi:[1,0]
  v_pk_mul_f32 v[36:37], v[36:37], v[6:7] op_sel_hi:[1,0]
  v_pk_mul_f32 v[38:39], v[38:39], v[6:7] op_sel_hi:[1,0]
  v_pk_mul_f32 v[40:41], v[40:41], v[6:7] op_sel_hi:[1,0]
  v_pk_mul_f32 v[42:43], v[42:43], v[6:7] op_sel_hi:[1,0]
  v_cvt_pk_bf16_f32 v128, v24, v25
  v_cvt_pk_bf16_f32 v129, v26, v27
  v_cvt_pk_bf16_f32 v130, v28, v29
  v_cvt_pk_bf16_f32 v131, v30, v31
  v_cvt_pk_bf16_f32 v132, v32, v33
  v_cvt_pk_bf16_f32 v133, v34, v35
  v_cvt_pk_bf16_f32 v134, v36, v37
  v_cvt_pk_bf16_f32 v135, v38, v39
  v_cvt_pk_bf16_f32 v136, v40, v41
  v_cvt_pk_bf16_f32 v137, v42, v43
  s_waitcnt vmcnt(8) lgkmcnt(0)
  v_mfma_f32_32x32x16_bf16 v[64:79], v[208:211], v[128:131], 0
  s_add_u32 s29, s19, 50335744
  buffer_load_dwordx4 v[160:163], v21, s[4:7], s29 offen offset:0 sc1
  v_mfma_f32_32x32x16_bf16 v[64:79], v[212:215], v[132:135], v[64:79]
  v_mfma_f32_32x32x8_bf16 v[64:79], v[56:57], v[136:137], v[64:79]
  v_mfma_f32_32x32x16_bf16 v[80:95], v[216:219], v[128:131], 0
  buffer_load_dwordx4 v[164:167], v21, s[4:7], s29 offen offset:1024 sc1
  v_mfma_f32_32x32x16_bf16 v[80:95], v[220:223], v[132:135], v[80:95]
  v_cvt_pk_bf16_f32 v24, v64, v65
  v_cvt_pk_bf16_f32 v25, v66, v67
  v_cvt_pk_bf16_f32 v26, v68, v69
  v_cvt_pk_bf16_f32 v27, v70, v71
  v_mfma_f32_32x32x8_bf16 v[80:95], v[58:59], v[136:137], v[80:95]
  ds_write_b128 v3, v[24:27] offset:0
  v_cvt_pk_bf16_f32 v28, v72, v73
  v_cvt_pk_bf16_f32 v29, v74, v75
  v_cvt_pk_bf16_f32 v30, v76, v77
  v_cvt_pk_bf16_f32 v31, v78, v79
  v_mfma_f32_32x32x16_bf16 v[96:111], v[224:227], v[128:131], 0
  ds_write_b128 v3, v[28:31] offset:1024
  buffer_load_dwordx4 v[168:171], v21, s[4:7], s29 offen offset:2048 sc1
  v_mfma_f32_32x32x16_bf16 v[96:111], v[228:231], v[132:135], v[96:111]
  v_cvt_pk_bf16_f32 v32, v80, v81
  v_cvt_pk_bf16_f32 v33, v82, v83
  v_cvt_pk_bf16_f32 v34, v84, v85
  v_cvt_pk_bf16_f32 v35, v86, v87
  v_mfma_f32_32x32x8_bf16 v[96:111], v[60:61], v[136:137], v[96:111]
  ds_write_b128 v3, v[32:35] offset:2048
  v_cvt_pk_bf16_f32 v36, v88, v89
  v_cvt_pk_bf16_f32 v37, v90, v91
  v_cvt_pk_bf16_f32 v38, v92, v93
  v_cvt_pk_bf16_f32 v39, v94, v95
  v_mfma_f32_32x32x16_bf16 v[112:127], v[232:235], v[128:131], 0
  ds_write_b128 v3, v[36:39] offset:3072
  buffer_load_dwordx4 v[172:175], v21, s[4:7], s29 offen offset:3072 sc1
  v_mfma_f32_32x32x16_bf16 v[112:127], v[236:239], v[132:135], v[112:127]
  v_cvt_pk_bf16_f32 v40, v96, v97
  v_cvt_pk_bf16_f32 v41, v98, v99
  v_cvt_pk_bf16_f32 v42, v100, v101
  v_cvt_pk_bf16_f32 v43, v102, v103
  v_mfma_f32_32x32x8_bf16 v[112:127], v[62:63], v[136:137], v[112:127]
  ds_write_b128 v3, v[40:43] offset:4096
  v_cvt_pk_bf16_f32 v44, v104, v105
  v_cvt_pk_bf16_f32 v45, v106, v107
  v_cvt_pk_bf16_f32 v46, v108, v109
  v_cvt_pk_bf16_f32 v47, v110, v111
  ds_write_b128 v3, v[44:47] offset:5120
  s_nop 5
  v_cvt_pk_bf16_f32 v48, v112, v113
  v_cvt_pk_bf16_f32 v49, v114, v115
  v_cvt_pk_bf16_f32 v50, v116, v117
  v_cvt_pk_bf16_f32 v51, v118, v119
  ds_write_b128 v3, v[48:51] offset:6144
  v_cvt_pk_bf16_f32 v52, v120, v121
  v_cvt_pk_bf16_f32 v53, v122, v123
  v_cvt_pk_bf16_f32 v54, v124, v125
  v_cvt_pk_bf16_f32 v55, v126, v127
  ds_write_b128 v3, v[52:55] offset:7168
  s_waitcnt vmcnt(8)
  s_waitcnt lgkmcnt(0)
  s_barrier
  ds_read_b128 v[24:27], v8 offset:0
  ds_read_b128 v[28:31], v9 offset:0
  ds_read_b128 v[32:35], v10 offset:0
  ds_read_b128 v[36:39], v11 offset:0
  ds_read_b128 v[40:43], v12 offset:0
  ds_read_b128 v[44:47], v13 offset:0
  buffer_load_dword v23, off, s[4:7], s54 sc1
  v_mov_b32 v16, s30
  v_min_u32 v17, 1, v0
  v_lshlrev_b32 v17, 30, v17
  buffer_store_dword v16, v17, s[4:7], s31 offen sc1
  s_add_u32 s30, s30, 1
  s_add_u32 s52, s52, 2
  s_waitcnt lgkmcnt(5)
  v_mfma_f32_16x16x32_bf16 v[64:67], a[0:3], v[24:27], 0
  s_add_u32 s28, s19, 67108864
  ds_read_b128 v[48:51], v14 offset:0
  v_mfma_f32_16x16x32_bf16 v[68:71], a[4:7], v[24:27], 0
  v_mfma_f32_16x16x32_bf16 v[80:83], a[8:11], v[24:27], 0
  v_mfma_f32_16x16x32_bf16 v[84:87], a[12:15], v[24:27], 0
  s_waitcnt lgkmcnt(5)
  v_mfma_f32_16x16x32_bf16 v[72:75], a[0:3], v[28:31], 0
  ds_read_b128 v[52:55], v15 offset:0
  v_mfma_f32_16x16x32_bf16 v[76:79], a[4:7], v[28:31], 0
  v_mfma_f32_16x16x32_bf16 v[88:91], a[8:11], v[28:31], 0
  buffer_load_dwordx4 v[176:179], v21, s[4:7], s28 offen offset:0 sc1
  v_mfma_f32_16x16x32_bf16 v[92:95], a[12:15], v[28:31], 0
  s_waitcnt lgkmcnt(5)
  v_mfma_f32_16x16x32_bf16 v[64:67], a[16:19], v[32:35], v[64:67]
  ds_read_b128 v[24:27], v8 offset:8192
  v_mfma_f32_16x16x32_bf16 v[68:71], a[20:23], v[32:35], v[68:71]
  v_mfma_f32_16x16x32_bf16 v[80:83], a[24:27], v[32:35], v[80:83]
  v_mfma_f32_16x16x32_bf16 v[84:87], a[28:31], v[32:35], v[84:87]
  s_waitcnt lgkmcnt(5)
  v_mfma_f32_16x16x32_bf16 v[72:75], a[16:19], v[36:39], v[72:75]
  ds_read_b128 v[28:31], v9 offset:8192
  v_mfma_f32_16x16x32_bf16 v[76:79], a[20:23], v[36:39], v[76:79]
  v_mfma_f32_16x16x32_bf16 v[88:91], a[24:27], v[36:39], v[88:91]
  buffer_load_dwordx4 v[180:183], v21, s[4:7], s28 offen offset:1024 sc1
  v_mfma_f32_16x16x32_bf16 v[92:95], a[28:31], v[36:39], v[92:95]
  s_waitcnt lgkmcnt(5)
  v_mfma_f32_16x16x32_bf16 v[64:67], a[32:35], v[40:43], v[64:67]
  ds_read_b128 v[32:35], v10 offset:8192
  v_mfma_f32_16x16x32_bf16 v[68:71], a[36:39], v[40:43], v[68:71]
  v_mfma_f32_16x16x32_bf16 v[80:83], a[40:43], v[40:43], v[80:83]
  v_mfma_f32_16x16x32_bf16 v[84:87], a[44:47], v[40:43], v[84:87]
  s_waitcnt lgkmcnt(5)
  v_mfma_f32_16x16x32_bf16 v[72:75], a[32:35], v[44:47], v[72:75]
  ds_read_b128 v[36:39], v11 offset:8192
  v_mfma_f32_16x16x32_bf16 v[76:79], a[36:39], v[44:47], v[76:79]
  v_mfma_f32_16x16x32_bf16 v[88:91], a[40:43], v[44:47], v[88:91]
  buffer_load_dwordx4 v[184:187], v21, s[4:7], s28 offen offset:2048 sc1
  v_mfma_f32_16x16x32_bf16 v[92:95], a[44:47], v[44:47], v[92:95]
  s_waitcnt lgkmcnt(5)
  v_mfma_f32_16x16x32_bf16 v[64:67], a[48:51], v[48:51], v[64:67]
  ds_read_b128 v[40:43], v12 offset:8192
  v_mfma_f32_16x16x32_bf16 v[68:71], a[52:55], v[48:51], v[68:71]
  v_mfma_f32_16x16x32_bf16 v[80:83], a[56:59], v[48:51], v[80:83]
  v_mfma_f32_16x16x32_bf16 v[84:87], a[60:63], v[48:51], v[84:87]
  s_waitcnt lgkmcnt(5)
  v_mfma_f32_16x16x32_bf16 v[72:75], a[48:51], v[52:55], v[72:75]
  ds_read_b128 v[44:47], v13 offset:8192
  v_mfma_f32_16x16x32_bf16 v[76:79], a[52:55], v[52:55], v[76:79]
  v_mfma_f32_16x16x32_bf16 v[88:91], a[56:59], v[52:55], v[88:91]
  buffer_load_dwordx4 v[188:191], v21, s[4:7], s28 offen offset:3072 sc1
  v_mfma_f32_16x16x32_bf16 v[92:95], a[60:63], v[52:55], v[92:95]
  s_waitcnt lgkmcnt(5)
  v_mfma_f32_16x16x32_bf16 v[64:67], a[64:67], v[24:27], v[64:67]
  s_add_u32 s29, s19, 67112960
  ds_read_b128 v[48:51], v14 offset:8192
  v_mfma_f32_16x16x32_bf16 v[68:71], a[68:71], v[24:27], v[68:71]
  v_mfma_f32_16x16x32_bf16 v[80:83], a[72:75], v[24:27], v[80:83]
  v_mfma_f32_16x16x32_bf16 v[84:87], a[76:79], v[24:27], v[84:87]
  s_waitcnt lgkmcnt(5)
  v_mfma_f32_16x16x32_bf16 v[72:75], a[64:67], v[28:31], v[72:75]
  ds_read_b128 v[52:55], v15 offset:8192
  v_mfma_f32_16x16x32_bf16 v[76:79], a[68:71], v[28:31], v[76:79]
  v_mfma_f32_16x16x32_bf16 v[88:91], a[72:75], v[28:31], v[88:91]
  buffer_load_dwordx4 v[192:195], v21, s[4:7], s29 offen offset:0 sc1
  v_mfma_f32_16x16x32_bf16 v[92:95], a[76:79], v[28:31], v[92:95]
  s_waitcnt lgkmcnt(5)
  v_mfma_f32_16x16x32_bf16 v[64:67], a[80:83], v[32:35], v[64:67]
  ds_read_b128 v[24:27], v8 offset:16384
  v_mfma_f32_16x16x32_bf16 v[68:71], a[84:87], v[32:35], v[68:71]
  v_mfma_f32_16x16x32_bf16 v[80:83], a[88:91], v[32:35], v[80:83]
  v_mfma_f32_16x16x32_bf16 v[84:87], a[92:95], v[32:35], v[84:87]
  s_waitcnt lgkmcnt(5)
  v_mfma_f32_16x16x32_bf16 v[72:75], a[80:83], v[36:39], v[72:75]
  ds_read_b128 v[28:31], v9 offset:16384
  v_mfma_f32_16x16x32_bf16 v[76:79], a[84:87], v[36:39], v[76:79]
  v_mfma_f32_16x16x32_bf16 v[88:91], a[88:91], v[36:39], v[88:91]
  buffer_load_dwordx4 v[196:199], v21, s[4:7], s29 offen offset:1024 sc1
  v_mfma_f32_16x16x32_bf16 v[92:95], a[92:95], v[36:39], v[92:95]
  s_waitcnt lgkmcnt(5)
  v_mfma_f32_16x16x32_bf16 v[64:67], a[96:99], v[40:43], v[64:67]
  ds_read_b128 v[32:35], v10 offset:16384
  v_mfma_f32_16x16x32_bf16 v[68:71], a[100:103], v[40:43], v[68:71]
  v_mfma_f32_16x16x32_bf16 v[80:83], a[104:107], v[40:43], v[80:83]
  v_mfma_f32_16x16x32_bf16 v[84:87], a[108:111], v[40:43], v[84:87]
  s_waitcnt lgkmcnt(5)
  s_waitcnt vmcnt(7)
  v_readfirstlane_b32 s53, v23
  s_nop 0
  s_cmp_ge_u32 s53, s52
  s_cselect_b32 s24, 1, 0
  s_cbranch_scc0 F_nopre_220
  s_mov_b32 m0, s25
  s_nop 0
  buffer_load_dwordx4 v2, s[4:7], s20 offen offset:0 sc1 lds
  buffer_load_dwordx4 v2, s[4:7], s20 offen offset:1024 sc1 lds
  buffer_load_dwordx4 v2, s[4:7], s20 offen offset:2048 sc1 lds
  buffer_load_dwordx4 v2, s[4:7], s20 offen offset:3072 sc1 lds
F_nopre_220:
  v_mfma_f32_16x16x32_bf16 v[72:75], a[96:99], v[44:47], v[72:75]
  ds_read_b128 v[36:39], v11 offset:16384
  v_mfma_f32_16x16x32_bf16 v[76:79], a[100:103], v[44:47], v[76:79]
  v_mfma_f32_16x16x32_bf16 v[88:91], a[104:107], v[44:47], v[88:91]
  buffer_load_dwordx4 v[200:203], v21, s[4:7], s29 offen offset:2048 sc1
  v_mfma_f32_16x16x32_bf16 v[92:95], a[108:111], v[44:47], v[92:95]
  s_waitcnt lgkmcnt(5)
  v_mfma_f32_16x16x32_bf16 v[64:67], a[112:115], v[48:51], v[64:67]
  ds_read_b128 v[40:43], v12 offset:16384
  v_mfma_f32_16x16x32_bf16 v[68:71], a[116:119], v[48:51], v[68:71]
  v_mfma_f32_16x16x32_bf16 v[80:83], a[120:123], v[48:51], v[80:83]
  v_mfma_f32_16x16x32_bf16 v[84:87], a[124:127], v[48:51], v[84:87]
  s_waitcnt lgkmcnt(5)
  v_mfma_f32_16x16x32_bf16 v[72:75], a[112:115], v[52:55], v[72:75]
  ds_read_b128 v[44:47], v13 offset:16384
  v_mfma_f32_16x16x32_bf16 v[76:79], a[116:119], v[52:55], v[76:79]
  v_mfma_f32_16x16x32_bf16 v[88:91], a[120:123], v[52:55], v[88:91]
  buffer_load_dwordx4 v[204:207], v21, s[4:7], s29 offen offset:3072 sc1
  v_mfma_f32_16x16x32_bf16 v[92:95], a[124:127], v[52:55], v[92:95]
  s_waitcnt lgkmcnt(5)
  v_mfma_f32_16x16x32_bf16 v[64:67], a[128:131], v[24:27], v[64:67]
  s_add_u32 s28, s19, 83886080
  ds_read_b128 v[48:51], v14 offset:16384
  v_mfma_f32_16x16x32_bf16 v[68:71], a[132:135], v[24:27], v[68:71]
  v_mfma_f32_16x16x32_bf16 v[80:83], a[136:139], v[24:27], v[80:83]
  v_mfma_f32_16x16x32_bf16 v[84:87], a[140:143], v[24:27], v[84:87]
  s_waitcnt lgkmcnt(5)
  v_mfma_f32_16x16x32_bf16 v[72:75], a[128:131], v[28:31], v[72:75]
  ds_read_b128 v[52:55], v15 offset:16384
  v_mfma_f32_16x16x32_bf16 v[76:79], a[132:135], v[28:31], v[76:79]
  v_mfma_f32_16x16x32_bf16 v[88:91], a[136:139], v[28:31], v[88:91]
  buffer_load_dwordx4 v[208:211], v21, s[4:7], s28 offen offset:0 sc1
  v_mfma_f32_16x16x32_bf16 v[92:95], a[140:143], v[28:31], v[92:95]
  s_waitcnt lgkmcnt(5)
  v_mfma_f32_16x16x32_bf16 v[64:67], a[144:147], v[32:35], v[64:67]
  ds_read_b128 v[24:27], v8 offset:24576
  v_mfma_f32_16x16x32_bf16 v[68:71], a[148:151], v[32:35], v[68:71]
  v_mfma_f32_16x16x32_bf16 v[80:83], a[152:155], v[32:35], v[80:83]
  v_mfma_f32_16x16x32_bf16 v[84:87], a[156:159], v[32:35], v[84:87]
  s_waitcnt lgkmcnt(5)
  v_mfma_f32_16x16x32_bf16 v[72:75], a[144:147], v[36:39], v[72:75]
  ds_read_b128 v[28:31], v9 offset:24576
  v_mfma_f32_16x16x32_bf16 v[76:79], a[148:151], v[36:39], v[76:79]
  v_mfma_f32_16x16x32_bf16 v[88:91], a[152:155], v[36:39], v[88:91]
  buffer_load_dwordx4 v[212:215], v21, s[4:7], s28 offen offset:1024 sc1
  v_mfma_f32_16x16x32_bf16 v[92:95], a[156:159], v[36:39], v[92:95]
  s_waitcnt lgkmcnt(5)
  v_mfma_f32_16x16x32_bf16 v[64:67], a[160:163], v[40:43], v[64:67]
  ds_read_b128 v[32:35], v10 offset:24576
  v_mfma_f32_16x16x32_bf16 v[68:71], a[164:167], v[40:43], v[68:71]
  v_mfma_f32_16x16x32_bf16 v[80:83], a[168:171], v[40:43], v[80:83]
  v_mfma_f32_16x16x32_bf16 v[84:87], a[172:175], v[40:43], v[84:87]
  s_waitcnt lgkmcnt(5)
  v_mfma_f32_16x16x32_bf16 v[72:75], a[160:163], v[44:47], v[72:75]
  ds_read_b128 v[36:39], v11 offset:24576
  v_mfma_f32_16x16x32_bf16 v[76:79], a[164:167], v[44:47], v[76:79]
  v_mfma_f32_16x16x32_bf16 v[88:91], a[168:171], v[44:47], v[88:91]
  buffer_load_dwordx4 v[216:219], v21, s[4:7], s28 offen offset:2048 sc1
  v_mfma_f32_16x16x32_bf16 v[92:95], a[172:175], v[44:47], v[92:95]
  s_waitcnt lgkmcnt(5)
  v_mfma_f32_16x16x32_bf16 v[64:67], a[176:179], v[48:51], v[64:67]
  ds_read_b128 v[40:43], v12 offset:24576
  v_mfma_f32_16x16x32_bf16 v[68:71], a[180:183], v[48:51], v[68:71]
  v_mfma_f32_16x16x32_bf16 v[80:83], a[184:187], v[48:51], v[80:83]
  v_mfma_f32_16x16x32_bf16 v[84:87], a[188:191], v[48:51], v[84:87]
  s_waitcnt lgkmcnt(5)
  s_cmp_lg_u32 s24, 0
  s_cselect_b32 s76, 0, s52
  s_sub_u32 s76, s76, 59
  s_cmp_ge_u32 s76, 6
  s_cbranch_scc1 M_nosp_221
  buffer_load_dword v23, off, s[4:7], s54 sc1
  buffer_load_dwordx4 v[96:99], v2, s[4:7], s20 offen offset:0 sc1
  buffer_load_dwordx4 v[100:103], v2, s[4:7], s20 offen offset:1024 sc1
  buffer_load_dwordx4 v[104:107], v2, s[4:7], s20 offen offset:2048 sc1
  buffer_load_dwordx4 v[108:111], v2, s[4:7], s20 offen offset:3072 sc1
M_nosp_221:
  v_mfma_f32_16x16x32_bf16 v[72:75], a[176:179], v[52:55], v[72:75]
  ds_read_b128 v[44:47], v13 offset:24576
  v_mfma_f32_16x16x32_bf16 v[76:79], a[180:183], v[52:55], v[76:79]
  v_mfma_f32_16x16x32_bf16 v[88:91], a[184:187], v[52:55], v[88:91]
  buffer_load_dwordx4 v[220:223], v21, s[4:7], s28 offen offset:3072 sc1
  v_mfma_f32_16x16x32_bf16 v[92:95], a[188:191], v[52:55], v[92:95]
  s_waitcnt lgkmcnt(5)
  v_mfma_f32_16x16x32_bf16 v[64:67], a[192:195], v[24:27], v[64:67]
  s_add_u32 s29, s19, 83890176
  ds_read_b128 v[48:51], v14 offset:24576
  v_mfma_f32_16x16x32_bf16 v[68:71], a[196:199], v[24:27], v[68:71]
  v_mfma_f32_16x16x32_bf16 v[80:83], a[200:203], v[24:27], v[80:83]
  v_mfma_f32_16x16x32_bf16 v[84:87], a[204:207], v[24:27], v[84:87]
  s_waitcnt lgkmcnt(5)
  v_mfma_f32_16x16x32_bf16 v[72:75], a[192:195], v[28:31], v[72:75]
  ds_read_b128 v[52:55], v15 offset:24576
  v_mfma_f32_16x16x32_bf16 v[76:79], a[196:199], v[28:31], v[76:79]
  v_mfma_f32_16x16x32_bf16 v[88:91], a[200:203], v[28:31], v[88:91]
  buffer_load_dwordx4 v[224:227], v21, s[4:7], s29 offen offset:0 sc1
  v_mfma_f32_16x16x32_bf16 v[92:95], a[204:207], v[28:31], v[92:95]
  s_waitcnt lgkmcnt(5)
  v_mfma_f32_16x16x32_bf16 v[64:67], a[208:211], v[32:35], v[64:67]
  v_mfma_f32_16x16x32_bf16 v[68:71], a[212:215], v[32:35], v[68:71]
  v_mfma_f32_16x16x32_bf16 v[80:83], a[216:219], v[32:35], v[80:83]
  v_mfma_f32_16x16x32_bf16 v[84:87], a[220:223], v[32:35], v[84:87]
  s_waitcnt lgkmcnt(4)
  v_mfma_f32_16x16x32_bf16 v[72:75], a[208:211], v[36:39], v[72:75]
  v_mfma_f32_16x16x32_bf16 v[76:79], a[212:215], v[36:39], v[76:79]
  v_xor_b32 v8, 0x8000, v8
  v_mfma_f32_16x16x32_bf16 v[88:91], a[216:219], v[36:39], v[88:91]
  buffer_load_dwordx4 v[228:231], v21, s[4:7], s29 offen offset:1024 sc1
  v_mfma_f32_16x16x32_bf16 v[92:95], a[220:223], v[36:39], v[92:95]
  s_waitcnt lgkmcnt(3)
  v_xor_b32 v9, 0x8000, v9
  v_mfma_f32_16x16x32_bf16 v[64:67], a[224:227], v[40:43], v[64:67]
  v_mfma_f32_16x16x32_bf16 v[68:71], a[228:231], v[40:43], v[68:71]
  v_xor_b32 v10, 0x8000, v10
  v_mfma_f32_16x16x32_bf16 v[80:83], a[232:235], v[40:43], v[80:83]
  v_mfma_f32_16x16x32_bf16 v[84:87], a[236:239], v[40:43], v[84:87]
  s_waitcnt lgkmcnt(2)
  v_xor_b32 v11, 0x8000, v11
  v_mfma_f32_16x16x32_bf16 v[72:75], a[224:227], v[44:47], v[72:75]
  v_mfma_f32_16x16x32_bf16 v[76:79], a[228:231], v[44:47], v[76:79]
  v_xor_b32 v12, 0x8000, v12
  v_mfma_f32_16x16x32_bf16 v[88:91], a[232:235], v[44:47], v[88:91]
  buffer_load_dwordx4 v[232:235], v21, s[4:7], s29 offen offset:2048 sc1
  v_mfma_f32_16x16x32_bf16 v[92:95], a[236:239], v[44:47], v[92:95]
  s_waitcnt lgkmcnt(1)
  v_xor_b32 v13, 0x8000, v13
  v_mfma_f32_16x16x32_bf16 v[64:67], a[240:243], v[48:51], v[64:67]
  v_mfma_f32_16x16x32_bf16 v[68:71], a[244:247], v[48:51], v[68:71]
  v_xor_b32 v14, 0x8000, v14
  v_mfma_f32_16x16x32_bf16 v[80:83], a[248:251], v[48:51], v[80:83]
  v_mfma_f32_16x16x32_bf16 v[84:87], a[252:255], v[48:51], v[84:87]
  s_waitcnt lgkmcnt(0)
  v_xor_b32 v15, 0x8000, v15
  v_mfma_f32_16x16x32_bf16 v[72:75], a[240:243], v[52:55], v[72:75]
  v_mfma_f32_16x16x32_bf16 v[76:79], a[244:247], v[52:55], v[76:79]
  v_xor_b32 v3, 0x8000, v3
  v_mfma_f32_16x16x32_bf16 v[88:91], a[248:251], v[52:55], v[88:91]
  buffer_load_dwordx4 v[236:239], v21, s[4:7], s29 offen offset:3072 sc1
  v_mfma_f32_16x16x32_bf16 v[92:95], a[252:255], v[52:55], v[92:95]
  s_cmp_gt_u32 s23, 0
  s_cbranch_scc1 F_top_196
  s_nop 2
  v_cvt_pk_bf16_f32 v128, v64, v65
  v_cvt_pk_bf16_f32 v129, v66, v67
  v_cvt_pk_bf16_f32 v130, v68, v69
  v_cvt_pk_bf16_f32 v131, v70, v71
  buffer_store_dwordx4 v[128:131], v22, s[4:7], s21 offen offset:0 sc1
  v_cvt_pk_bf16_f32 v132, v72, v73
  v_cvt_pk_bf16_f32 v133, v74, v75
  v_cvt_pk_bf16_f32 v134, v76, v77
  v_cvt_pk_bf16_f32 v135, v78, v79
  buffer_store_dwordx4 v[132:135], v22, s[4:7], s21 offen offset:256 sc1
  v_cvt_pk_bf16_f32 v136, v80, v81
  v_cvt_pk_bf16_f32 v137, v82, v83
  v_cvt_pk_bf16_f32 v138, v84, v85
  v_cvt_pk_bf16_f32 v139, v86, v87
  buffer_store_dwordx4 v[136:139], v22, s[4:7], s21 offen offset:2048 sc1
  v_cvt_pk_bf16_f32 v140, v88, v89
  v_cvt_pk_bf16_f32 v141, v90, v91
  v_cvt_pk_bf16_f32 v142, v92, v93
  v_cvt_pk_bf16_f32 v143, v94, v95
  buffer_store_dwordx4 v[140:143], v22, s[4:7], s21 offen offset:2304 sc1
  s_waitcnt vmcnt(0) lgkmcnt(0)
  s_barrier
  v_mov_b32 v144, s30
  v_min_u32 v145, 1, v0
  v_lshlrev_b32 v145, 30, v145
  buffer_store_dword v144, v145, s[4:7], s31 offen sc1
M_done:
M_exit:
  s_endpgm
.p2align 6
.type M_table,@object
M_table:
.long 0x1, 0x3f, 0xffffffff, 0x19, 0x1, 0x7, 0x800, 0x0, 0x8, 0x0, 0x0, 0x0, 0x0, 0x0, 0x0, 0x0
.long 0x1, 0x26, 0xffffffff, 0x1d, 0x1, 0x6, 0x1000, 0x0, 0x8, 0x1, 0x0, 0x0, 0x0, 0x0, 0x0, 0x0
.long 0x2, 0x0, 0x2, 0x20, 0x1, 0x5, 0x1800, 0x0, 0x8, 0x0, 0x0, 0x0, 0x0, 0x0, 0x0, 0x0
.long 0x2, 0x1, 0x2, 0x20, 0x1, 0x4, 0x2000, 0x0, 0x8, 0x1, 0x0, 0x0, 0x0, 0x0, 0x0, 0x0
.long 0x0, 0x0, 0x1, 0x20, 0x2, 0x3, 0x20, 0x0, 0x8, 0x2, 0x0, 0x0, 0x0, 0x0, 0x0, 0x0
.long 0x0, 0x3f, 0xffffffff, 0x20, 0x2, 0x2, 0x18, 0x1, 0x10, 0x0, 0x0, 0x0, 0x0, 0x0, 0x0, 0x0
.long 0x1, 0x9, 0xffffffff, 0xa, 0x0, 0x0, 0x8, 0x0, 0x8, 0x2, 0x0, 0x0, 0x0, 0x0, 0x0, 0x0
.size M_table, 448
.section .rodata,"a"
.p2align 6
.amdhsa_kernel gated_mix__compressed_kv_cla__memory_aug_recurrent_mem_tr__prompt_kernel
.amdhsa_next_free_vgpr 512
.amdhsa_next_free_sgpr 102
.amdhsa_accum_offset 256
.amdhsa_group_segment_fixed_size 0
.amdhsa_kernarg_size 136
.amdhsa_user_sgpr_count 2
.amdhsa_user_sgpr_kernarg_segment_ptr 1
.amdhsa_system_sgpr_workgroup_id_x 1
.end_amdhsa_kernel
```

```asm
; @launch grid=(256,1,1) block=(256,1,1) lds=163840
.amdgcn_target "amdgcn-amd-amdhsa--gfx950"
.text
.globl gated_mix__compressed_kv_cla__memory_aug_recurrent_mem_tr__prompt_kernel
.p2align 8
.type gated_mix__compressed_kv_cla__memory_aug_recurrent_mem_tr__prompt_kernel,@function
gated_mix__compressed_kv_cla__memory_aug_recurrent_mem_tr__prompt_kernel:
  s_cmp_ge_u32 s2, 256
  s_cbranch_scc1 M_exit
  s_getpc_b64 s[60:61]
M_pc0:
  s_lshr_b32 s62, s2, 3
  s_and_b32 s62, s62, 3
  s_lshl_b32 s62, s62, 15
  v_lshl_add_u32 v104, v0, 7, s62
  v_min_u32 v104, M_table-M_pc0, v104
  global_load_dword v105, v104, s[60:61]
  s_lshr_b32 s77, s2, 3
  s_and_b32 s76, s2, 7
  s_cbranch_scc1 M_worker
  s_mov_b32 s12, s77
  s_load_dwordx4 s[60:63], s[0:1], 64
  s_load_dwordx4 s[64:67], s[0:1], 80
  s_load_dwordx4 s[68:71], s[0:1], 120
  s_load_dwordx2 s[72:73], s[0:1], 56
  v_lshrrev_b32 v1, 6, v0
  v_and_b32 v20, 63, v0
  v_readfirstlane_b32 s13, v1
  v_lshrrev_b32 v26, 3, v20
  v_lshlrev_b32 v26, 10, v26
  v_and_b32 v1, 7, v20
  v_lshl_add_u32 v26, v1, 4, v26
  s_lshl_b32 s36, s13, 7
  s_lshl_b32 s38, s12, 17
  s_add_u32 s36, s36, s38
  v_add_u32 v26, s36, v26
  s_lshl_b32 s39, s13, 15
  s_add_u32 s39, s39, 32768
  s_waitcnt lgkmcnt(0)
  s_mov_b32 s48, s66
  s_and_b32 s49, s67, 0xffff
  s_mov_b32 s50, 0x400000
  s_mov_b32 s51, 0x20000
  s_xor_b32 s36, s13, 0
  s_lshl_b32 s36, s36, 15
  s_add_u32 m0, s39, 28672
  s_add_u32 s37, s36, 0
  buffer_load_dwordx4 v26, s[48:51], s37 offen lds
  s_add_u32 m0, s39, 29696
  s_add_u32 s37, s36, 8192
  buffer_load_dwordx4 v26, s[48:51], s37 offen lds
  s_add_u32 m0, s39, 30720
  s_add_u32 s37, s36, 16384
  buffer_load_dwordx4 v26, s[48:51], s37 offen lds
  s_add_u32 m0, s39, 31744
  s_add_u32 s37, s36, 24576
  buffer_load_dwordx4 v26, s[48:51], s37 offen lds
  s_xor_b32 s36, s13, 0
  s_lshl_b32 s36, s36, 15
  s_add_u32 m0, s39, 24576
  s_add_u32 s37, s36, 512
  buffer_load_dwordx4 v26, s[48:51], s37 offen lds
  s_add_u32 m0, s39, 25600
  s_add_u32 s37, s36, 8704
  buffer_load_dwordx4 v26, s[48:51], s37 offen lds
  s_add_u32 m0, s39, 26624
  s_add_u32 s37, s36, 16896
  buffer_load_dwordx4 v26, s[48:51], s37 offen lds
  s_add_u32 m0, s39, 27648
  s_add_u32 s37, s36, 25088
  buffer_load_dwordx4 v26, s[48:51], s37 offen lds
  s_xor_b32 s36, s13, 1
  s_lshl_b32 s36, s36, 15
  s_add_u32 m0, s39, 12288
  s_add_u32 s37, s36, 0
  buffer_load_dwordx4 v26, s[48:51], s37 offen lds
  s_add_u32 m0, s39, 13312
  s_add_u32 s37, s36, 8192
  buffer_load_dwordx4 v26, s[48:51], s37 offen lds
  s_add_u32 m0, s39, 14336
  s_add_u32 s37, s36, 16384
  buffer_load_dwordx4 v26, s[48:51], s37 offen lds
  s_add_u32 m0, s39, 15360
  s_add_u32 s37, s36, 24576
  buffer_load_dwordx4 v26, s[48:51], s37 offen lds
  s_xor_b32 s36, s13, 1
  s_lshl_b32 s36, s36, 15
  s_add_u32 m0, s39, 8192
  s_add_u32 s37, s36, 512
  buffer_load_dwordx4 v26, s[48:51], s37 offen lds
  s_add_u32 m0, s39, 9216
  s_add_u32 s37, s36, 8704
  buffer_load_dwordx4 v26, s[48:51], s37 offen lds
  s_add_u32 m0, s39, 10240
  s_add_u32 s37, s36, 16896
  buffer_load_dwordx4 v26, s[48:51], s37 offen lds
  s_add_u32 m0, s39, 11264
  s_add_u32 s37, s36, 25088
  buffer_load_dwordx4 v26, s[48:51], s37 offen lds
  s_mov_b32 s8, s60
  s_and_b32 s9, s61, 0xffff
  s_mov_b32 s10, 0x400000
  s_mov_b32 s11, 0x20000
  s_mov_b32 s40, s62
  s_and_b32 s41, s63, 0xffff
  s_mov_b32 s42, 0x400000
  s_mov_b32 s43, 0x20000
  s_mov_b32 s44, s64
  s_and_b32 s45, s65, 0xffff
  s_mov_b32 s46, 0x400000
  s_mov_b32 s47, 0x20000
  s_mov_b32 s4, s70
  s_and_b32 s5, s71, 0xffff
  s_mov_b32 s6, 0x10000000
  s_mov_b32 s7, 0x20000
  s_mov_b32 s76, s72
  s_and_b32 s77, s73, 0xffff
  s_mov_b32 s78, 0x2000
  s_mov_b32 s79, 0x20000
  s_mov_b32 s72, s68
  s_and_b32 s73, s69, 0xffff
  s_mov_b32 s74, 0x100
  s_mov_b32 s75, 0x20000
  s_mov_b64 s[52:53], s[68:69]
  s_mov_b64 s[58:59], s[70:71]
  s_mul_i32 s99, s12, 896
  s_add_u32 s99, s99, 148898048
  s_lshl_b32 s15, s12, 7
  s_add_u32 s15, s15, 148926464
  v_lshrrev_b32 v21, 4, v20
  v_and_b32 v22, 15, v20
  v_and_b32 v23, 1, v21
  v_lshrrev_b32 v24, 1, v21
  v_lshlrev_b32 v2, 4, v20
  s_lshl_b32 s36, s13, 10
  v_add_u32 v59, s36, v2
  s_mov_b32 s37, s39
  v_add_u32 v4, s37, v2
  v_lshrrev_b32 v25, 2, v20
  v_lshlrev_b32 v25, 13, v25
  v_and_b32 v1, 3, v20
  v_lshl_add_u32 v25, v1, 4, v25
  s_lshl_b32 s36, s13, 6
  s_lshl_b32 s38, s12, 8
  s_add_u32 s36, s36, s38
  v_add_u32 v25, s36, v25
  v_bfe_u32 v29, v20, 2, 1
  v_bfe_u32 v30, v20, 3, 1
  v_and_b32 v31, 3, v20
  v_lshl_add_u32 v27, v21, 2, v29
  v_lshlrev_b32 v27, 6, v27
  v_lshl_add_u32 v27, v30, 5, v27
  v_lshl_add_u32 v27, v31, 3, v27
  v_add_u32 v27, s37, v27
  v_xor_b32 v36, 1, v30
  v_lshl_add_u32 v36, v36, 11, v27
  v_lshl_add_u32 v27, v30, 11, v27
  v_lshl_add_u32 v28, v23, 2, v24
  v_lshl_add_u32 v28, v28, 2, v29
  v_lshlrev_b32 v28, 7, v28
  v_lshl_add_u32 v28, v30, 6, v28
  v_lshl_add_u32 v28, v31, 4, v28
  v_add_u32 v28, s37, v28
  v_lshrrev_b32 v25, 3, v20
  v_lshlrev_b32 v25, 13, v25
  v_and_b32 v1, 7, v20
  v_lshl_add_u32 v25, v1, 4, v25
  s_lshr_b32 s36, s13, 1
  s_lshl1_add_u32 s36, s12, s36
  s_lshl_b32 s36, s36, 7
  v_add_u32 v25, s36, v25
  v_lshl_add_u32 v27, v21, 2, v29
  v_lshlrev_b32 v27, 7, v27
  v_lshl_add_u32 v27, v30, 5, v27
  v_lshl_add_u32 v27, v31, 3, v27
  s_and_b32 s36, s13, 1
  s_lshl_b32 s36, s36, 6
  s_xor_b32 s37, s13, 1
  s_lshl_b32 s37, s37, 15
  s_add_u32 s37, s37, s36
  s_add_u32 s37, s37, 32768
  s_add_u32 s36, s36, s39
  v_add_u32 v36, s37, v27
  v_add_u32 v27, s36, v27
  v_lshlrev_b32 v101, 12, v30
  v_xor_b32 v100, 0x1000, v101
  v_mov_b32 v0, 0x4444
  v_mov_b32 v1, 0xeeee
  v_cmp_lt_u32 vcc, 7, v22
  s_nop 1
  v_cndmask_b32 v32, v0, v1, vcc
  v_mov_b32 v0, v32
  v_and_b32 v32, 7, v20
  v_lshlrev_b32 v32, 4, v32
  v_lshl_add_u32 v11, v21, 7, v32
  v_xor_b32 v1, 128, v2
  v_lshl_add_u32 v33, v24, 4, v22
  s_lshl_b32 s36, s13, 5
  v_add_u32 v33, s36, v33
  v_lshlrev_b32 v33, 3, v33
  v_mul_u32_u24 v34, 1152, v23
  v_add_u32 v5, v33, v34
  v_bfe_u32 v33, v20, 2, 2
  v_lshl_add_u32 v33, v23, 2, v33
  v_lshl_add_u32 v33, v24, 4, v33
  v_lshlrev_b32 v33, 3, v33
  v_and_b32 v34, 1, v20
  v_mul_u32_u24 v34, 1152, v34
  v_add_u32 v6, v33, v34
  s_lshl_b32 s36, s13, 3
  v_lshrrev_b32 v33, 3, v20
  v_add_u32 v33, s36, v33
  v_mul_u32_u24 v34, 0, v33
  v_add_u32 v34, s12, v34
  v_and_b32 v34, 31, v34
  v_lshrrev_b32 v37, 1, v32
  v_lshl_add_u32 v33, v33, 13, v37
  v_lshl_add_u32 v7, v34, 7, v33
  v_and_b32 v37, 1, v20
  v_bfe_u32 v38, v20, 1, 1
  v_lshl_add_u32 v37, v29, 1, v37
  s_lshr_b32 s36, s12, 3
  s_lshl_b32 s36, s36, 10
  s_and_b32 s37, s12, 1
  s_lshl_b32 s37, s37, 9
  s_add_u32 s36, s36, s37
  s_and_b32 s37, s12, 6
  s_lshl_b32 s37, s37, 5
  s_add_u32 s36, s36, s37
  v_lshlrev_b32 v33, 4, v21
  v_lshl_add_u32 v33, v37, 2, v33
  v_lshl_add_u32 v33, v38, 8, v33
  v_lshl_add_u32 v33, v30, 30, v33
  v_add_u32 v8, s36, v33
  v_mov_b32 v39, v21
  s_lshr_b32 s36, s12, 2
  s_lshl_b32 s36, s36, 6
  s_and_b32 s37, s12, 1
  s_lshl_b32 s37, s37, 5
  s_add_u32 s36, s36, s37
  s_and_b32 s37, s12, 2
  s_lshl_b32 s37, s37, 11
  s_add_u32 s36, s36, s37
  v_lshlrev_b32 v35, 10, v39
  v_lshl_add_u32 v35, v37, 2, v35
  v_lshl_add_u32 v35, v38, 4, v35
  v_add_u32 v35, s36, v35
  buffer_load_ushort v44, v35, s[76:79], 0 offen offset:0
  buffer_load_ushort v45, v35, s[76:79], 0 offen offset:2
  buffer_load_ushort v46, v35, s[76:79], 0 offen offset:512
  buffer_load_ushort v47, v35, s[76:79], 0 offen offset:514
  v_lshlrev_b32 v33, 4, v29
  v_mov_b32 v34, 0x3f80
  v_lshlrev_b32 v33, v33, v34
  v_and_b32 v34, 1, v20
  v_lshl_add_u32 v34, v34, 1, v30
  v_cmp_eq_u32 vcc, 0, v34
  s_nop 1
  v_cndmask_b32 v48, 0, v33, vcc
  v_cmp_eq_u32 vcc, 1, v34
  s_nop 1
  v_cndmask_b32 v49, 0, v33, vcc
  v_cmp_eq_u32 vcc, 2, v34
  s_nop 1
  v_cndmask_b32 v50, 0, v33, vcc
  v_cmp_eq_u32 vcc, 3, v34
  s_nop 1
  v_cndmask_b32 v51, 0, v33, vcc
  ds_write_b128 v2, v[48:51] offset:31232
  v_lshlrev_b32 v33, 9, v21
  s_lshl_b32 s36, s13, 11
  v_add_u32 v33, s36, v33
  v_lshl_add_u32 v10, v22, 4, v33
  v_lshl_add_u32 v33, v30, 8, v33
  v_add_u32 v9, v33, v32
  v_mov_b32 v12, 0x3f803f80
  v_mov_b32 v13, 0x3f803f80
  v_mov_b32 v14, 0x3f803f80
  v_mov_b32 v15, 0x3f803f80
  s_mov_b32 s2, 0x3f803f80
  s_mov_b32 s3, 0x3f803f80
  s_mov_b32 s98, 0
  v_and_b32 v33, 1, v20
  v_mul_u32_u24 v33, 128, v33
  v_min_u32 v34, 1, v20
  v_lshlrev_b32 v34, 30, v34
  s_cmp_eq_u32 s13, 3
  s_cselect_b64 vcc, -1, 0
  v_cndmask_b32 v19, v34, v33, vcc
  v_mov_b64 v[60:61], 0
  v_mov_b32 v62, 32256
  ds_write_b64 v62, v[60:61]
  s_mov_b32 s16, 0
  s_mov_b32 s17, -1
  s_mov_b32 s18, 0x3e0293ee
  s_mov_b32 s54, 0x2f800000
  s_mov_b32 s55, 0x28000000
  s_mov_b32 s96, s55
  s_lshl_b32 s36, s13, 10
  s_add_u32 s31, s36, 8192
  s_add_u32 s32, s36, 12160
  s_add_u32 s33, s36, 16384
  s_add_u32 s34, s36, 20224
  s_lshl_b32 s36, s12, 19
  s_add_u32 s27, s36, 67108864
  s_add_u32 s28, s36, 83886080
  s_mul_i32 s36, s12, 4096
  s_add_u32 s29, s36, 135266304
  s_lshl_b32 s36, s12, 13
  s_add_u32 s22, s36, 144703488
  s_add_u32 s23, s36, 144707584
  s_mov_b32 s20, 144703488
  s_mov_b32 s21, 144707584
  v_mov_b32 v40, -1
  v_mov_b32 v41, -1
  v_mov_b32 v42, -1
  v_mov_b32 v43, -1
  s_lshl_b32 s36, s13, 13
  s_add_u32 s36, s36, 145752064
  s_add_u32 s37, s36, 4096
  buffer_store_dwordx4 v[40:43], v59, s[4:7], s22 offen sc1
  buffer_store_dwordx4 v[40:43], v59, s[4:7], s23 offen sc1
  buffer_store_dword v40, v8, s[4:7], s36 offen sc1
  buffer_store_dword v40, v8, s[4:7], s37 offen sc1
  v_mov_b32 v52, 0
  v_min_u32 v53, 1, v59
  v_lshlrev_b32 v53, 30, v53
  buffer_store_dword v52, v53, s[4:7], s15 offen sc1
  s_waitcnt vmcnt(21)
  ds_read_b64_tr_b16 a[160:161], v28 offset:28672
  ds_read_b64_tr_b16 a[162:163], v28 offset:28928
  ds_read_b64_tr_b16 a[164:165], v28 offset:29696
  ds_read_b64_tr_b16 a[166:167], v28 offset:29952
  ds_read_b64_tr_b16 a[168:169], v28 offset:28680
  ds_read_b64_tr_b16 a[170:171], v28 offset:28936
  ds_read_b64_tr_b16 a[172:173], v28 offset:29704
  ds_read_b64_tr_b16 a[174:175], v28 offset:29960
  s_waitcnt lgkmcnt(0)
  s_waitcnt vmcnt(17)
  ds_read_b64_tr_b16 a[176:177], v28 offset:24576
  ds_read_b64_tr_b16 a[178:179], v28 offset:24832
  ds_read_b64_tr_b16 a[180:181], v28 offset:25600
  ds_read_b64_tr_b16 a[182:183], v28 offset:25856
  ds_read_b64_tr_b16 a[184:185], v28 offset:24584
  ds_read_b64_tr_b16 a[186:187], v28 offset:24840
  ds_read_b64_tr_b16 a[188:189], v28 offset:25608
  ds_read_b64_tr_b16 a[190:191], v28 offset:25864
  s_waitcnt lgkmcnt(0)
  s_xor_b32 s36, s13, 2
  s_lshl_b32 s36, s36, 15
  s_add_u32 m0, s39, 28672
  s_add_u32 s37, s36, 0
  buffer_load_dwordx4 v26, s[48:51], s37 offen lds
  s_add_u32 m0, s39, 29696
  s_add_u32 s37, s36, 8192
  buffer_load_dwordx4 v26, s[48:51], s37 offen lds
  s_add_u32 m0, s39, 30720
  s_add_u32 s37, s36, 16384
  buffer_load_dwordx4 v26, s[48:51], s37 offen lds
  s_add_u32 m0, s39, 31744
  s_add_u32 s37, s36, 24576
  buffer_load_dwordx4 v26, s[48:51], s37 offen lds
  s_xor_b32 s36, s13, 3
  s_lshl_b32 s36, s36, 15
  s_add_u32 m0, s39, 24576
  s_add_u32 s37, s36, 0
  buffer_load_dwordx4 v26, s[48:51], s37 offen lds
  s_add_u32 m0, s39, 25600
  s_add_u32 s37, s36, 8192
  buffer_load_dwordx4 v26, s[48:51], s37 offen lds
  s_add_u32 m0, s39, 26624
  s_add_u32 s37, s36, 16384
  buffer_load_dwordx4 v26, s[48:51], s37 offen lds
  s_add_u32 m0, s39, 27648
  s_add_u32 s37, s36, 24576
  buffer_load_dwordx4 v26, s[48:51], s37 offen lds
  s_waitcnt vmcnt(21)
  ds_read_b64_tr_b16 a[192:193], v28 offset:12288
  ds_read_b64_tr_b16 a[194:195], v28 offset:12544
  ds_read_b64_tr_b16 a[196:197], v28 offset:13312
  ds_read_b64_tr_b16 a[198:199], v28 offset:13568
  ds_read_b64_tr_b16 a[200:201], v28 offset:12296
  ds_read_b64_tr_b16 a[202:203], v28 offset:12552
  ds_read_b64_tr_b16 a[204:205], v28 offset:13320
  ds_read_b64_tr_b16 a[206:207], v28 offset:13576
  s_waitcnt lgkmcnt(0)
  s_waitcnt vmcnt(17)
  ds_read_b64_tr_b16 a[208:209], v28 offset:8192
  ds_read_b64_tr_b16 a[210:211], v28 offset:8448
  ds_read_b64_tr_b16 a[212:213], v28 offset:9216
  ds_read_b64_tr_b16 a[214:215], v28 offset:9472
  ds_read_b64_tr_b16 a[216:217], v28 offset:8200
  ds_read_b64_tr_b16 a[218:219], v28 offset:8456
  ds_read_b64_tr_b16 a[220:221], v28 offset:9224
  ds_read_b64_tr_b16 a[222:223], v28 offset:9480
  s_waitcnt lgkmcnt(0)
  s_xor_b32 s36, s13, 2
  s_lshl_b32 s36, s36, 19
  s_add_u32 m0, s39, 12288
  s_add_u32 s37, s36, 0
  buffer_load_dwordx4 v25, s[8:11], s37 offen lds
  s_add_u32 m0, s39, 13312
  s_add_u32 s37, s36, 65536
  buffer_load_dwordx4 v25, s[8:11], s37 offen lds
  s_add_u32 m0, s39, 14336
  s_add_u32 s37, s36, 131072
  buffer_load_dwordx4 v25, s[8:11], s37 offen lds
  s_add_u32 m0, s39, 15360
  s_add_u32 s37, s36, 196608
  buffer_load_dwordx4 v25, s[8:11], s37 offen lds
  s_xor_b32 s36, s13, 2
  s_lshl_b32 s36, s36, 19
  s_add_u32 m0, s39, 8192
  s_add_u32 s37, s36, 262144
  buffer_load_dwordx4 v25, s[8:11], s37 offen lds
  s_add_u32 m0, s39, 9216
  s_add_u32 s37, s36, 327680
  buffer_load_dwordx4 v25, s[8:11], s37 offen lds
  s_add_u32 m0, s39, 10240
  s_add_u32 s37, s36, 393216
  buffer_load_dwordx4 v25, s[8:11], s37 offen lds
  s_add_u32 m0, s39, 11264
  s_add_u32 s37, s36, 458752
  buffer_load_dwordx4 v25, s[8:11], s37 offen lds
  s_waitcnt vmcnt(12)
  ds_read_b64_tr_b16 a[224:225], v28 offset:28672
  ds_read_b64_tr_b16 a[226:227], v28 offset:28928
  ds_read_b64_tr_b16 a[228:229], v28 offset:29696
  ds_read_b64_tr_b16 a[230:231], v28 offset:29952
  ds_read_b64_tr_b16 a[232:233], v28 offset:28680
  ds_read_b64_tr_b16 a[234:235], v28 offset:28936
  ds_read_b64_tr_b16 a[236:237], v28 offset:29704
  ds_read_b64_tr_b16 a[238:239], v28 offset:29960
  s_waitcnt lgkmcnt(0)
  s_waitcnt vmcnt(8)
  ds_read_b64_tr_b16 a[240:241], v28 offset:24576
  ds_read_b64_tr_b16 a[242:243], v28 offset:24832
  ds_read_b64_tr_b16 a[244:245], v28 offset:25600
  ds_read_b64_tr_b16 a[246:247], v28 offset:25856
  ds_read_b64_tr_b16 a[248:249], v28 offset:24584
  ds_read_b64_tr_b16 a[250:251], v28 offset:24840
  ds_read_b64_tr_b16 a[252:253], v28 offset:25608
  ds_read_b64_tr_b16 a[254:255], v28 offset:25864
  s_waitcnt lgkmcnt(0)
  s_xor_b32 s36, s13, 4
  s_lshl_b32 s36, s36, 19
  s_add_u32 m0, s39, 28672
  s_add_u32 s37, s36, 0
  buffer_load_dwordx4 v25, s[8:11], s37 offen lds
  s_add_u32 m0, s39, 29696
  s_add_u32 s37, s36, 65536
  buffer_load_dwordx4 v25, s[8:11], s37 offen lds
  s_add_u32 m0, s39, 30720
  s_add_u32 s37, s36, 131072
  buffer_load_dwordx4 v25, s[8:11], s37 offen lds
  s_add_u32 m0, s39, 31744
  s_add_u32 s37, s36, 196608
  buffer_load_dwordx4 v25, s[8:11], s37 offen lds
  s_xor_b32 s36, s13, 4
  s_lshl_b32 s36, s36, 19
  s_add_u32 m0, s39, 24576
  s_add_u32 s37, s36, 262144
  buffer_load_dwordx4 v25, s[8:11], s37 offen lds
  s_add_u32 m0, s39, 25600
  s_add_u32 s37, s36, 327680
  buffer_load_dwordx4 v25, s[8:11], s37 offen lds
  s_add_u32 m0, s39, 26624
  s_add_u32 s37, s36, 393216
  buffer_load_dwordx4 v25, s[8:11], s37 offen lds
  s_add_u32 m0, s39, 27648
  s_add_u32 s37, s36, 458752
  buffer_load_dwordx4 v25, s[8:11], s37 offen lds
  s_barrier
  s_cmp_lg_u32 s13, 0
  s_cbranch_scc1 T_arm_1
  s_getreg_b32 s36, hwreg(HW_REG_XCC_ID, 0, 3)
  s_lshl_b32 s36, s36, 3
  s_lshl_b64 s[60:61], 1, s36
  s_mov_b32 s62, 1
  s_atomic_add_x2 s[60:61], s[52:53], 0
  s_atomic_add s62, s[52:53], 128
  v_lshl_or_b32 v44, v45, 16, v44
  v_lshl_or_b32 v46, v47, 16, v46
  v_min_u32 v44, -2, v44
  v_min_u32 v46, -2, v46
  s_mov_b32 s36, 145752064
  s_mov_b32 s37, 145756160
  buffer_store_dword v44, v8, s[4:7], s36 offen sc1
  buffer_store_dword v46, v8, s[4:7], s37 offen sc1
T_arm_1:
  v_mad_u32_u24 v96, v100, 1, v27
  v_mad_u32_u24 v97, v101, 1, v27
  v_mad_u32_u24 v98, v100, 1, v36
  v_mad_u32_u24 v99, v101, 1, v36
  s_waitcnt vmcnt(8)
  s_barrier
  ds_read_b64_tr_b16 v[160:161], v96 offset:8192
  ds_read_b64_tr_b16 v[162:163], v96 offset:8448
  ds_read_b64_tr_b16 v[164:165], v96 offset:10240
  ds_read_b64_tr_b16 v[166:167], v96 offset:10496
  ds_read_b64_tr_b16 v[168:169], v97 offset:8192
  ds_read_b64_tr_b16 v[170:171], v97 offset:8448
  ds_read_b64_tr_b16 v[172:173], v97 offset:10240
  ds_read_b64_tr_b16 v[174:175], v97 offset:10496
  ds_read_b64_tr_b16 v[192:193], v98 offset:8192
  ds_read_b64_tr_b16 v[194:195], v98 offset:8448
  ds_read_b64_tr_b16 v[196:197], v98 offset:10240
  ds_read_b64_tr_b16 v[198:199], v98 offset:10496
  ds_read_b64_tr_b16 v[200:201], v99 offset:8192
  ds_read_b64_tr_b16 v[202:203], v99 offset:8448
  ds_read_b64_tr_b16 v[204:205], v99 offset:10240
  ds_read_b64_tr_b16 v[206:207], v99 offset:10496
  s_waitcnt lgkmcnt(0)
  s_barrier
  s_xor_b32 s36, s13, 4
  s_lshl_b32 s36, s36, 19
  s_add_u32 m0, s39, 12288
  s_add_u32 s37, s36, 0
  buffer_load_dwordx4 v25, s[40:43], s37 offen lds
  s_add_u32 m0, s39, 13312
  s_add_u32 s37, s36, 65536
  buffer_load_dwordx4 v25, s[40:43], s37 offen lds
  s_add_u32 m0, s39, 14336
  s_add_u32 s37, s36, 131072
  buffer_load_dwordx4 v25, s[40:43], s37 offen lds
  s_add_u32 m0, s39, 15360
  s_add_u32 s37, s36, 196608
  buffer_load_dwordx4 v25, s[40:43], s37 offen lds
  s_xor_b32 s36, s13, 4
  s_lshl_b32 s36, s36, 19
  s_add_u32 m0, s39, 8192
  s_add_u32 s37, s36, 262144
  buffer_load_dwordx4 v25, s[40:43], s37 offen lds
  s_add_u32 m0, s39, 9216
  s_add_u32 s37, s36, 327680
  buffer_load_dwordx4 v25, s[40:43], s37 offen lds
  s_add_u32 m0, s39, 10240
  s_add_u32 s37, s36, 393216
  buffer_load_dwordx4 v25, s[40:43], s37 offen lds
  s_add_u32 m0, s39, 11264
  s_add_u32 s37, s36, 458752
  buffer_load_dwordx4 v25, s[40:43], s37 offen lds
  v_mad_u32_u24 v96, v100, 1, v27
  v_mad_u32_u24 v97, v101, 1, v27
  v_mad_u32_u24 v98, v100, 1, v36
  v_mad_u32_u24 v99, v101, 1, v36
  s_waitcnt vmcnt(8)
  s_barrier
  ds_read_b64_tr_b16 v[224:225], v96 offset:24576
  ds_read_b64_tr_b16 v[226:227], v96 offset:24832
  ds_read_b64_tr_b16 v[228:229], v96 offset:26624
  ds_read_b64_tr_b16 v[230:231], v96 offset:26880
  ds_read_b64_tr_b16 v[232:233], v97 offset:24576
  ds_read_b64_tr_b16 v[234:235], v97 offset:24832
  ds_read_b64_tr_b16 v[236:237], v97 offset:26624
  ds_read_b64_tr_b16 v[238:239], v97 offset:26880
  ds_read_b64_tr_b16 a[16:17], v98 offset:24576
  ds_read_b64_tr_b16 a[18:19], v98 offset:24832
  ds_read_b64_tr_b16 a[20:21], v98 offset:26624
  ds_read_b64_tr_b16 a[22:23], v98 offset:26880
  ds_read_b64_tr_b16 a[24:25], v99 offset:24576
  ds_read_b64_tr_b16 a[26:27], v99 offset:24832
  ds_read_b64_tr_b16 a[28:29], v99 offset:26624
  ds_read_b64_tr_b16 a[30:31], v99 offset:26880
  s_waitcnt lgkmcnt(0)
  s_barrier
  s_xor_b32 s36, s13, 4
  s_lshl_b32 s36, s36, 19
  s_add_u32 m0, s39, 28672
  s_add_u32 s37, s36, 0
  buffer_load_dwordx4 v25, s[44:47], s37 offen lds
  s_add_u32 m0, s39, 29696
  s_add_u32 s37, s36, 65536
  buffer_load_dwordx4 v25, s[44:47], s37 offen lds
  s_add_u32 m0, s39, 30720
  s_add_u32 s37, s36, 131072
  buffer_load_dwordx4 v25, s[44:47], s37 offen lds
  s_add_u32 m0, s39, 31744
  s_add_u32 s37, s36, 196608
  buffer_load_dwordx4 v25, s[44:47], s37 offen lds
  s_xor_b32 s36, s13, 4
  s_lshl_b32 s36, s36, 19
  s_add_u32 m0, s39, 24576
  s_add_u32 s37, s36, 262144
  buffer_load_dwordx4 v25, s[44:47], s37 offen lds
  s_add_u32 m0, s39, 25600
  s_add_u32 s37, s36, 327680
  buffer_load_dwordx4 v25, s[44:47], s37 offen lds
  s_add_u32 m0, s39, 26624
  s_add_u32 s37, s36, 393216
  buffer_load_dwordx4 v25, s[44:47], s37 offen lds
  s_add_u32 m0, s39, 27648
  s_add_u32 s37, s36, 458752
  buffer_load_dwordx4 v25, s[44:47], s37 offen lds
  v_mad_u32_u24 v96, v100, 1, v27
  v_mad_u32_u24 v97, v101, 1, v27
  v_mad_u32_u24 v98, v100, 1, v36
  v_mad_u32_u24 v99, v101, 1, v36
  s_waitcnt vmcnt(8)
  s_barrier
  ds_read_b64_tr_b16 v[240:241], v96 offset:8192
  ds_read_b64_tr_b16 v[242:243], v96 offset:8448
  ds_read_b64_tr_b16 v[244:245], v96 offset:10240
  ds_read_b64_tr_b16 v[246:247], v96 offset:10496
  ds_read_b64_tr_b16 v[248:249], v97 offset:8192
  ds_read_b64_tr_b16 v[250:251], v97 offset:8448
  ds_read_b64_tr_b16 v[252:253], v97 offset:10240
  ds_read_b64_tr_b16 v[254:255], v97 offset:10496
  ds_read_b64_tr_b16 a[32:33], v98 offset:8192
  ds_read_b64_tr_b16 a[34:35], v98 offset:8448
  ds_read_b64_tr_b16 a[36:37], v98 offset:10240
  ds_read_b64_tr_b16 a[38:39], v98 offset:10496
  ds_read_b64_tr_b16 a[40:41], v99 offset:8192
  ds_read_b64_tr_b16 a[42:43], v99 offset:8448
  ds_read_b64_tr_b16 a[44:45], v99 offset:10240
  ds_read_b64_tr_b16 a[46:47], v99 offset:10496
  s_waitcnt lgkmcnt(0)
  s_barrier
  s_xor_b32 s36, s13, 6
  s_lshl_b32 s36, s36, 19
  s_add_u32 m0, s39, 12288
  s_add_u32 s37, s36, 0
  buffer_load_dwordx4 v25, s[8:11], s37 offen lds
  s_add_u32 m0, s39, 13312
  s_add_u32 s37, s36, 65536
  buffer_load_dwordx4 v25, s[8:11], s37 offen lds
  s_add_u32 m0, s39, 14336
  s_add_u32 s37, s36, 131072
  buffer_load_dwordx4 v25, s[8:11], s37 offen lds
  s_add_u32 m0, s39, 15360
  s_add_u32 s37, s36, 196608
  buffer_load_dwordx4 v25, s[8:11], s37 offen lds
  s_xor_b32 s36, s13, 6
  s_lshl_b32 s36, s36, 19
  s_add_u32 m0, s39, 8192
  s_add_u32 s37, s36, 262144
  buffer_load_dwordx4 v25, s[8:11], s37 offen lds
  s_add_u32 m0, s39, 9216
  s_add_u32 s37, s36, 327680
  buffer_load_dwordx4 v25, s[8:11], s37 offen lds
  s_add_u32 m0, s39, 10240
  s_add_u32 s37, s36, 393216
  buffer_load_dwordx4 v25, s[8:11], s37 offen lds
  s_add_u32 m0, s39, 11264
  s_add_u32 s37, s36, 458752
  buffer_load_dwordx4 v25, s[8:11], s37 offen lds
  v_mad_u32_u24 v96, v100, 1, v27
  v_mad_u32_u24 v97, v101, 1, v27
  v_mad_u32_u24 v98, v100, 1, v36
  v_mad_u32_u24 v99, v101, 1, v36
  s_waitcnt vmcnt(8)
  s_barrier
  ds_read_b64_tr_b16 a[0:1], v96 offset:24576
  ds_read_b64_tr_b16 a[2:3], v96 offset:24832
  ds_read_b64_tr_b16 a[4:5], v96 offset:26624
  ds_read_b64_tr_b16 a[6:7], v96 offset:26880
  ds_read_b64_tr_b16 a[8:9], v97 offset:24576
  ds_read_b64_tr_b16 a[10:11], v97 offset:24832
  ds_read_b64_tr_b16 a[12:13], v97 offset:26624
  ds_read_b64_tr_b16 a[14:15], v97 offset:26880
  ds_read_b64_tr_b16 a[48:49], v98 offset:24576
  ds_read_b64_tr_b16 a[50:51], v98 offset:24832
  ds_read_b64_tr_b16 a[52:53], v98 offset:26624
  ds_read_b64_tr_b16 a[54:55], v98 offset:26880
  ds_read_b64_tr_b16 a[56:57], v99 offset:24576
  ds_read_b64_tr_b16 a[58:59], v99 offset:24832
  ds_read_b64_tr_b16 a[60:61], v99 offset:26624
  ds_read_b64_tr_b16 a[62:63], v99 offset:26880
  s_waitcnt lgkmcnt(0)
  s_barrier
  s_xor_b32 s36, s13, 6
  s_lshl_b32 s36, s36, 19
  s_add_u32 m0, s39, 28672
  s_add_u32 s37, s36, 0
  buffer_load_dwordx4 v25, s[40:43], s37 offen lds
  s_add_u32 m0, s39, 29696
  s_add_u32 s37, s36, 65536
  buffer_load_dwordx4 v25, s[40:43], s37 offen lds
  s_add_u32 m0, s39, 30720
  s_add_u32 s37, s36, 131072
  buffer_load_dwordx4 v25, s[40:43], s37 offen lds
  s_add_u32 m0, s39, 31744
  s_add_u32 s37, s36, 196608
  buffer_load_dwordx4 v25, s[40:43], s37 offen lds
  s_xor_b32 s36, s13, 6
  s_lshl_b32 s36, s36, 19
  s_add_u32 m0, s39, 24576
  s_add_u32 s37, s36, 262144
  buffer_load_dwordx4 v25, s[40:43], s37 offen lds
  s_add_u32 m0, s39, 25600
  s_add_u32 s37, s36, 327680
  buffer_load_dwordx4 v25, s[40:43], s37 offen lds
  s_add_u32 m0, s39, 26624
  s_add_u32 s37, s36, 393216
  buffer_load_dwordx4 v25, s[40:43], s37 offen lds
  s_add_u32 m0, s39, 27648
  s_add_u32 s37, s36, 458752
  buffer_load_dwordx4 v25, s[40:43], s37 offen lds
  v_mad_u32_u24 v96, v100, 1, v27
  v_mad_u32_u24 v97, v101, 1, v27
  v_mad_u32_u24 v98, v100, 1, v36
  v_mad_u32_u24 v99, v101, 1, v36
  s_waitcnt vmcnt(8)
  s_barrier
  ds_read_b64_tr_b16 a[64:65], v96 offset:8192
  ds_read_b64_tr_b16 a[66:67], v96 offset:8448
  ds_read_b64_tr_b16 a[68:69], v96 offset:10240
  ds_read_b64_tr_b16 a[70:71], v96 offset:10496
  ds_read_b64_tr_b16 a[72:73], v97 offset:8192
  ds_read_b64_tr_b16 a[74:75], v97 offset:8448
  ds_read_b64_tr_b16 a[76:77], v97 offset:10240
  ds_read_b64_tr_b16 a[78:79], v97 offset:10496
  ds_read_b64_tr_b16 a[112:113], v98 offset:8192
  ds_read_b64_tr_b16 a[114:115], v98 offset:8448
  ds_read_b64_tr_b16 a[116:117], v98 offset:10240
  ds_read_b64_tr_b16 a[118:119], v98 offset:10496
  ds_read_b64_tr_b16 a[120:121], v99 offset:8192
  ds_read_b64_tr_b16 a[122:123], v99 offset:8448
  ds_read_b64_tr_b16 a[124:125], v99 offset:10240
  ds_read_b64_tr_b16 a[126:127], v99 offset:10496
  s_waitcnt lgkmcnt(0)
  s_barrier
  s_xor_b32 s36, s13, 6
  s_lshl_b32 s36, s36, 19
  s_add_u32 m0, s39, 12288
  s_add_u32 s37, s36, 0
  buffer_load_dwordx4 v25, s[44:47], s37 offen lds
  s_add_u32 m0, s39, 13312
  s_add_u32 s37, s36, 65536
  buffer_load_dwordx4 v25, s[44:47], s37 offen lds
  s_add_u32 m0, s39, 14336
  s_add_u32 s37, s36, 131072
  buffer_load_dwordx4 v25, s[44:47], s37 offen lds
  s_add_u32 m0, s39, 15360
  s_add_u32 s37, s36, 196608
  buffer_load_dwordx4 v25, s[44:47], s37 offen lds
  s_xor_b32 s36, s13, 6
  s_lshl_b32 s36, s36, 19
  s_add_u32 m0, s39, 8192
  s_add_u32 s37, s36, 262144
  buffer_load_dwordx4 v25, s[44:47], s37 offen lds
  s_add_u32 m0, s39, 9216
  s_add_u32 s37, s36, 327680
  buffer_load_dwordx4 v25, s[44:47], s37 offen lds
  s_add_u32 m0, s39, 10240
  s_add_u32 s37, s36, 393216
  buffer_load_dwordx4 v25, s[44:47], s37 offen lds
  s_add_u32 m0, s39, 11264
  s_add_u32 s37, s36, 458752
  buffer_load_dwordx4 v25, s[44:47], s37 offen lds
  v_mad_u32_u24 v96, v100, 1, v27
  v_mad_u32_u24 v97, v101, 1, v27
  v_mad_u32_u24 v98, v100, 1, v36
  v_mad_u32_u24 v99, v101, 1, v36
  s_waitcnt vmcnt(8)
  s_barrier
  ds_read_b64_tr_b16 a[80:81], v96 offset:24576
  ds_read_b64_tr_b16 a[82:83], v96 offset:24832
  ds_read_b64_tr_b16 a[84:85], v96 offset:26624
  ds_read_b64_tr_b16 a[86:87], v96 offset:26880
  ds_read_b64_tr_b16 a[88:89], v97 offset:24576
  ds_read_b64_tr_b16 a[90:91], v97 offset:24832
  ds_read_b64_tr_b16 a[92:93], v97 offset:26624
  ds_read_b64_tr_b16 a[94:95], v97 offset:26880
  ds_read_b64_tr_b16 a[128:129], v98 offset:24576
  ds_read_b64_tr_b16 a[130:131], v98 offset:24832
  ds_read_b64_tr_b16 a[132:133], v98 offset:26624
  ds_read_b64_tr_b16 a[134:135], v98 offset:26880
  ds_read_b64_tr_b16 a[136:137], v99 offset:24576
  ds_read_b64_tr_b16 a[138:139], v99 offset:24832
  ds_read_b64_tr_b16 a[140:141], v99 offset:26624
  ds_read_b64_tr_b16 a[142:143], v99 offset:26880
  s_waitcnt lgkmcnt(0)
  s_barrier
  s_xor_b32 s36, s13, 0
  s_lshl_b32 s36, s36, 19
  s_add_u32 m0, s39, 28672
  s_add_u32 s37, s36, 0
  buffer_load_dwordx4 v25, s[8:11], s37 offen lds
  s_add_u32 m0, s39, 29696
  s_add_u32 s37, s36, 65536
  buffer_load_dwordx4 v25, s[8:11], s37 offen lds
  s_add_u32 m0, s39, 30720
  s_add_u32 s37, s36, 131072
  buffer_load_dwordx4 v25, s[8:11], s37 offen lds
  s_add_u32 m0, s39, 31744
  s_add_u32 s37, s36, 196608
  buffer_load_dwordx4 v25, s[8:11], s37 offen lds
  s_xor_b32 s36, s13, 0
  s_lshl_b32 s36, s36, 19
  s_add_u32 m0, s39, 0
  s_add_u32 s37, s36, 262144
  buffer_load_dwordx4 v25, s[8:11], s37 offen lds
  s_add_u32 m0, s39, 1024
  s_add_u32 s37, s36, 327680
  buffer_load_dwordx4 v25, s[8:11], s37 offen lds
  s_add_u32 m0, s39, 2048
  s_add_u32 s37, s36, 393216
  buffer_load_dwordx4 v25, s[8:11], s37 offen lds
  s_add_u32 m0, s39, 3072
  s_add_u32 s37, s36, 458752
  buffer_load_dwordx4 v25, s[8:11], s37 offen lds
  v_mad_u32_u24 v96, v100, 1, v27
  v_mad_u32_u24 v97, v101, 1, v27
  v_mad_u32_u24 v98, v100, 1, v36
  v_mad_u32_u24 v99, v101, 1, v36
  s_waitcnt vmcnt(8)
  s_barrier
  ds_read_b64_tr_b16 a[96:97], v96 offset:8192
  ds_read_b64_tr_b16 a[98:99], v96 offset:8448
  ds_read_b64_tr_b16 a[100:101], v96 offset:10240
  ds_read_b64_tr_b16 a[102:103], v96 offset:10496
  ds_read_b64_tr_b16 a[104:105], v97 offset:8192
  ds_read_b64_tr_b16 a[106:107], v97 offset:8448
  ds_read_b64_tr_b16 a[108:109], v97 offset:10240
  ds_read_b64_tr_b16 a[110:111], v97 offset:10496
  ds_read_b64_tr_b16 a[144:145], v98 offset:8192
  ds_read_b64_tr_b16 a[146:147], v98 offset:8448
  ds_read_b64_tr_b16 a[148:149], v98 offset:10240
  ds_read_b64_tr_b16 a[150:151], v98 offset:10496
  ds_read_b64_tr_b16 a[152:153], v99 offset:8192
  ds_read_b64_tr_b16 a[154:155], v99 offset:8448
  ds_read_b64_tr_b16 a[156:157], v99 offset:10240
  ds_read_b64_tr_b16 a[158:159], v99 offset:10496
  s_waitcnt lgkmcnt(0)
  s_barrier
  s_xor_b32 s36, s13, 0
  s_lshl_b32 s36, s36, 19
  s_add_u32 m0, s39, 24576
  s_add_u32 s37, s36, 0
  buffer_load_dwordx4 v25, s[40:43], s37 offen lds
  s_add_u32 m0, s39, 25600
  s_add_u32 s37, s36, 65536
  buffer_load_dwordx4 v25, s[40:43], s37 offen lds
  s_add_u32 m0, s39, 26624
  s_add_u32 s37, s36, 131072
  buffer_load_dwordx4 v25, s[40:43], s37 offen lds
  s_add_u32 m0, s39, 27648
  s_add_u32 s37, s36, 196608
  buffer_load_dwordx4 v25, s[40:43], s37 offen lds
  s_xor_b32 s36, s13, 0
  s_lshl_b32 s36, s36, 19
  s_add_u32 m0, s39, 4096
  s_add_u32 s37, s36, 262144
  buffer_load_dwordx4 v25, s[40:43], s37 offen lds
  s_add_u32 m0, s39, 5120
  s_add_u32 s37, s36, 327680
  buffer_load_dwordx4 v25, s[40:43], s37 offen lds
  s_add_u32 m0, s39, 6144
  s_add_u32 s37, s36, 393216
  buffer_load_dwordx4 v25, s[40:43], s37 offen lds
  s_add_u32 m0, s39, 7168
  s_add_u32 s37, s36, 458752
  buffer_load_dwordx4 v25, s[40:43], s37 offen lds
  v_mad_u32_u24 v96, v100, 7, v27
  v_mad_u32_u24 v97, v101, 7, v27
  v_mad_u32_u24 v98, v100, 7, v36
  v_mad_u32_u24 v99, v101, 7, v36
  s_waitcnt vmcnt(8)
  s_barrier
  ds_read_b64_tr_b16 v[128:129], v98 offset:0
  ds_read_b64_tr_b16 v[130:131], v98 offset:256
  ds_read_b64_tr_b16 v[132:133], v98 offset:2048
  ds_read_b64_tr_b16 v[134:135], v98 offset:2304
  ds_read_b64_tr_b16 v[136:137], v99 offset:0
  ds_read_b64_tr_b16 v[138:139], v99 offset:256
  ds_read_b64_tr_b16 v[140:141], v99 offset:2048
  ds_read_b64_tr_b16 v[142:143], v99 offset:2304
  ds_read_b64_tr_b16 v[64:65], v96 offset:0
  ds_read_b64_tr_b16 v[66:67], v96 offset:256
  ds_read_b64_tr_b16 v[68:69], v96 offset:2048
  ds_read_b64_tr_b16 v[70:71], v96 offset:2304
  ds_read_b64_tr_b16 v[72:73], v97 offset:0
  ds_read_b64_tr_b16 v[74:75], v97 offset:256
  ds_read_b64_tr_b16 v[76:77], v97 offset:2048
  ds_read_b64_tr_b16 v[78:79], v97 offset:2304
  s_waitcnt lgkmcnt(0)
  s_barrier
  ds_write_b128 v4, v[64:67] offset:0
  ds_write_b128 v4, v[68:71] offset:1024
  ds_write_b128 v4, v[72:75] offset:2048
  ds_write_b128 v4, v[76:79] offset:3072
  s_xor_b32 s36, s13, 2
  s_lshl_b32 s36, s36, 19
  s_add_u32 m0, s39, 28672
  s_add_u32 s37, s36, 0
  buffer_load_dwordx4 v25, s[40:43], s37 offen lds
  s_add_u32 m0, s39, 29696
  s_add_u32 s37, s36, 65536
  buffer_load_dwordx4 v25, s[40:43], s37 offen lds
  s_add_u32 m0, s39, 30720
  s_add_u32 s37, s36, 131072
  buffer_load_dwordx4 v25, s[40:43], s37 offen lds
  s_add_u32 m0, s39, 31744
  s_add_u32 s37, s36, 196608
  buffer_load_dwordx4 v25, s[40:43], s37 offen lds
  s_xor_b32 s36, s13, 2
  s_lshl_b32 s36, s36, 19
  s_add_u32 m0, s39, 16384
  s_add_u32 s37, s36, 262144
  buffer_load_dwordx4 v25, s[40:43], s37 offen lds
  s_add_u32 m0, s39, 17408
  s_add_u32 s37, s36, 327680
  buffer_load_dwordx4 v25, s[40:43], s37 offen lds
  s_add_u32 m0, s39, 18432
  s_add_u32 s37, s36, 393216
  buffer_load_dwordx4 v25, s[40:43], s37 offen lds
  s_add_u32 m0, s39, 19456
  s_add_u32 s37, s36, 458752
  buffer_load_dwordx4 v25, s[40:43], s37 offen lds
  s_getpc_b64 s[60:61]
T_pc_2:
  s_add_u32 s60, s60, T_code-T_pc_2
  s_addc_u32 s61, s61, 0
  v_lshlrev_b32 v102, 3, v59
  v_min_u32 v102, 12800, v102
  global_load_dword v103, v102, s[60:61]
  buffer_load_dwordx2 v[54:55], off, s[72:75], 0 sc1
  buffer_load_dword v56, off, s[72:75], 0 offset:128 sc1
  v_mad_u32_u24 v96, v100, 5, v27
  v_mad_u32_u24 v97, v101, 5, v27
  v_mad_u32_u24 v98, v100, 5, v36
  v_mad_u32_u24 v99, v101, 5, v36
  s_waitcnt vmcnt(11)
  s_barrier
  ds_read_b64_tr_b16 v[144:145], v98 offset:4096
  ds_read_b64_tr_b16 v[146:147], v98 offset:4352
  ds_read_b64_tr_b16 v[148:149], v98 offset:6144
  ds_read_b64_tr_b16 v[150:151], v98 offset:6400
  ds_read_b64_tr_b16 v[152:153], v99 offset:4096
  ds_read_b64_tr_b16 v[154:155], v99 offset:4352
  ds_read_b64_tr_b16 v[156:157], v99 offset:6144
  ds_read_b64_tr_b16 v[158:159], v99 offset:6400
  ds_read_b64_tr_b16 v[64:65], v96 offset:4096
  ds_read_b64_tr_b16 v[66:67], v96 offset:4352
  ds_read_b64_tr_b16 v[68:69], v96 offset:6144
  ds_read_b64_tr_b16 v[70:71], v96 offset:6400
  ds_read_b64_tr_b16 v[72:73], v97 offset:4096
  ds_read_b64_tr_b16 v[74:75], v97 offset:4352
  ds_read_b64_tr_b16 v[76:77], v97 offset:6144
  ds_read_b64_tr_b16 v[78:79], v97 offset:6400
  s_waitcnt lgkmcnt(0)
  s_barrier
  ds_write_b128 v4, v[64:67] offset:4096
  ds_write_b128 v4, v[68:71] offset:5120
  ds_write_b128 v4, v[72:75] offset:6144
  ds_write_b128 v4, v[76:79] offset:7168
  s_xor_b32 s36, s13, 2
  s_lshl_b32 s36, s36, 19
  s_add_u32 m0, s39, 24576
  s_add_u32 s37, s36, 0
  buffer_load_dwordx4 v25, s[44:47], s37 offen lds
  s_add_u32 m0, s39, 25600
  s_add_u32 s37, s36, 65536
  buffer_load_dwordx4 v25, s[44:47], s37 offen lds
  s_add_u32 m0, s39, 26624
  s_add_u32 s37, s36, 131072
  buffer_load_dwordx4 v25, s[44:47], s37 offen lds
  s_add_u32 m0, s39, 27648
  s_add_u32 s37, s36, 196608
  buffer_load_dwordx4 v25, s[44:47], s37 offen lds
  s_xor_b32 s36, s13, 2
  s_lshl_b32 s36, s36, 19
  s_add_u32 m0, s39, 20480
  s_add_u32 s37, s36, 262144
  buffer_load_dwordx4 v25, s[44:47], s37 offen lds
  s_add_u32 m0, s39, 21504
  s_add_u32 s37, s36, 327680
  buffer_load_dwordx4 v25, s[44:47], s37 offen lds
  s_add_u32 m0, s39, 22528
  s_add_u32 s37, s36, 393216
  buffer_load_dwordx4 v25, s[44:47], s37 offen lds
  s_add_u32 m0, s39, 23552
  s_add_u32 s37, s36, 458752
  buffer_load_dwordx4 v25, s[44:47], s37 offen lds
  v_mad_u32_u24 v96, v100, 3, v27
  v_mad_u32_u24 v97, v101, 3, v27
  v_mad_u32_u24 v98, v100, 3, v36
  v_mad_u32_u24 v99, v101, 3, v36
  s_waitcnt vmcnt(11)
  s_barrier
  ds_read_b64_tr_b16 v[176:177], v96 offset:16384
  ds_read_b64_tr_b16 v[178:179], v96 offset:16640
  ds_read_b64_tr_b16 v[180:181], v96 offset:18432
  ds_read_b64_tr_b16 v[182:183], v96 offset:18688
  ds_read_b64_tr_b16 v[184:185], v97 offset:16384
  ds_read_b64_tr_b16 v[186:187], v97 offset:16640
  ds_read_b64_tr_b16 v[188:189], v97 offset:18432
  ds_read_b64_tr_b16 v[190:191], v97 offset:18688
  ds_read_b64_tr_b16 v[64:65], v98 offset:16384
  ds_read_b64_tr_b16 v[66:67], v98 offset:16640
  ds_read_b64_tr_b16 v[68:69], v98 offset:18432
  ds_read_b64_tr_b16 v[70:71], v98 offset:18688
  ds_read_b64_tr_b16 v[72:73], v99 offset:16384
  ds_read_b64_tr_b16 v[74:75], v99 offset:16640
  ds_read_b64_tr_b16 v[76:77], v99 offset:18432
  ds_read_b64_tr_b16 v[78:79], v99 offset:18688
  s_waitcnt lgkmcnt(0)
  s_barrier
  ds_write_b128 v4, v[64:67] offset:16384
  ds_write_b128 v4, v[68:71] offset:17408
  ds_write_b128 v4, v[72:75] offset:18432
  ds_write_b128 v4, v[76:79] offset:19456
  s_xor_b32 s36, s13, 0
  s_lshl_b32 s36, s36, 19
  s_add_u32 m0, s39, 8192
  s_add_u32 s37, s36, 0
  buffer_load_dwordx4 v25, s[44:47], s37 offen lds
  s_add_u32 m0, s39, 9216
  s_add_u32 s37, s36, 65536
  buffer_load_dwordx4 v25, s[44:47], s37 offen lds
  s_add_u32 m0, s39, 10240
  s_add_u32 s37, s36, 131072
  buffer_load_dwordx4 v25, s[44:47], s37 offen lds
  s_add_u32 m0, s39, 11264
  s_add_u32 s37, s36, 196608
  buffer_load_dwordx4 v25, s[44:47], s37 offen lds
  s_xor_b32 s36, s13, 0
  s_lshl_b32 s36, s36, 19
  s_add_u32 m0, s39, 12288
  s_add_u32 s37, s36, 262144
  buffer_load_dwordx4 v25, s[44:47], s37 offen lds
  s_add_u32 m0, s39, 13312
  s_add_u32 s37, s36, 327680
  buffer_load_dwordx4 v25, s[44:47], s37 offen lds
  s_add_u32 m0, s39, 14336
  s_add_u32 s37, s36, 393216
  buffer_load_dwordx4 v25, s[44:47], s37 offen lds
  s_add_u32 m0, s39, 15360
  s_add_u32 s37, s36, 458752
  buffer_load_dwordx4 v25, s[44:47], s37 offen lds
  v_mad_u32_u24 v96, v100, 1, v27
  v_mad_u32_u24 v97, v101, 1, v27
  v_mad_u32_u24 v98, v100, 1, v36
  v_mad_u32_u24 v99, v101, 1, v36
  s_waitcnt vmcnt(8)
  s_barrier
  ds_read_b64_tr_b16 v[208:209], v98 offset:20480
  ds_read_b64_tr_b16 v[210:211], v98 offset:20736
  ds_read_b64_tr_b16 v[212:213], v98 offset:22528
  ds_read_b64_tr_b16 v[214:215], v98 offset:22784
  ds_read_b64_tr_b16 v[216:217], v99 offset:20480
  ds_read_b64_tr_b16 v[218:219], v99 offset:20736
  ds_read_b64_tr_b16 v[220:221], v99 offset:22528
  ds_read_b64_tr_b16 v[222:223], v99 offset:22784
  ds_read_b64_tr_b16 v[64:65], v96 offset:20480
  ds_read_b64_tr_b16 v[66:67], v96 offset:20736
  ds_read_b64_tr_b16 v[68:69], v96 offset:22528
  ds_read_b64_tr_b16 v[70:71], v96 offset:22784
  ds_read_b64_tr_b16 v[72:73], v97 offset:20480
  ds_read_b64_tr_b16 v[74:75], v97 offset:20736
  ds_read_b64_tr_b16 v[76:77], v97 offset:22528
  ds_read_b64_tr_b16 v[78:79], v97 offset:22784
  s_waitcnt lgkmcnt(0)
  s_barrier
  ds_write_b128 v4, v[64:67] offset:20480
  ds_write_b128 v4, v[68:71] offset:21504
  ds_write_b128 v4, v[72:75] offset:22528
  ds_write_b128 v4, v[76:79] offset:23552
  s_xor_b32 s36, s13, 2
  s_lshl_b32 s36, s36, 15
  s_add_u32 m0, s39, 24576
  s_add_u32 s37, s36, 512
  buffer_load_dwordx4 v26, s[48:51], s37 offen lds
  s_add_u32 m0, s39, 25600
  s_add_u32 s37, s36, 8704
  buffer_load_dwordx4 v26, s[48:51], s37 offen lds
  s_add_u32 m0, s39, 26624
  s_add_u32 s37, s36, 16896
  buffer_load_dwordx4 v26, s[48:51], s37 offen lds
  s_add_u32 m0, s39, 27648
  s_add_u32 s37, s36, 25088
  buffer_load_dwordx4 v26, s[48:51], s37 offen lds
  s_xor_b32 s36, s13, 3
  s_lshl_b32 s36, s36, 15
  s_add_u32 m0, s39, 28672
  s_add_u32 s37, s36, 512
  buffer_load_dwordx4 v26, s[48:51], s37 offen lds
  s_add_u32 m0, s39, 29696
  s_add_u32 s37, s36, 8704
  buffer_load_dwordx4 v26, s[48:51], s37 offen lds
  s_add_u32 m0, s39, 30720
  s_add_u32 s37, s36, 16896
  buffer_load_dwordx4 v26, s[48:51], s37 offen lds
  s_add_u32 m0, s39, 31744
  s_add_u32 s37, s36, 25088
  buffer_load_dwordx4 v26, s[48:51], s37 offen lds
  s_mov_b32 s19, 0
  s_branch T_arrgo_4
T_arr_3:
  s_add_u32 s19, s19, 1
  s_cmp_gt_u32 s19, 32768
  s_cbranch_scc1 M_exit
  buffer_load_dwordx2 v[54:55], off, s[72:75], 0 sc1
  buffer_load_dword v56, off, s[72:75], 0 offset:128 sc1
  s_waitcnt vmcnt(0)
T_arrgo_4:
  v_sad_u8 v57, v54, 0, 0
  v_sad_u8 v57, v55, 0, v57
  v_or_b32 v58, v54, v55
  v_cmp_gt_u32 vcc, 32, v57
  s_cbranch_vccnz T_arr_3
  v_cmp_gt_u32 vcc, 0x100, v56
  s_cbranch_vccnz T_arr_3
  v_readfirstlane_b32 s36, v58
  s_nop 0
  s_and_b32 s36, s36, 0x20202020
  s_cselect_b32 s56, 0, 1
  s_mov_b32 s14, -1
  s_mov_b32 s30, -1
  s_mov_b32 s19, 0
  s_branch T_kvok_6
T_kv_5:
  s_sleep 4
  s_add_u32 s19, s19, 1
  s_cmp_gt_u32 s19, 32768
  s_cbranch_scc1 M_exit
T_kvok_6:
  s_add_u32 s39, s99, 128
  s_mov_b32 s38, 0
  s_mov_b32 s37, 0
  s_atomic_or s38, s[58:59], s99 glc
  s_atomic_or s37, s[58:59], s39 glc
  s_waitcnt lgkmcnt(0)
  s_lshl_b32 s38, s38, 1
  s_lshl1_add_u32 s37, s37, 1
  s_min_u32 s38, s38, s37
  s_cmp_ge_u32 s38, 64
  s_cselect_b32 s38, 100, s38
  s_sub_u32 s38, s38, 1
  s_max_i32 s30, s30, s38
  s_cmp_ge_i32 s14, s30
  s_cbranch_scc1 T_kv_5
  s_mov_b32 m0, s31
  s_nop 0
  buffer_load_dwordx4 v9, s[4:7], s27 offen sc1 lds
  s_mov_b32 m0, s32
  s_nop 0
  buffer_load_dwordx4 v9, s[4:7], s27 offen offset:128 sc1 lds
  s_mov_b32 m0, s33
  s_nop 0
  buffer_load_dwordx4 v10, s[4:7], s28 offen sc1 lds
  s_mov_b32 m0, s34
  s_nop 0
  buffer_load_dwordx4 v10, s[4:7], s28 offen offset:256 sc1 lds
  s_add_u32 s27, s27, 8192
  s_add_u32 s28, s28, 8192
  s_lshl_b32 s36, s12, 10
  s_add_u32 s36, s36, 145752064
  buffer_load_dwordx4 v[40:43], v2, s[4:7], s36 offen sc1
  v_mad_u32_u24 v96, v101, 1, v27
  v_mad_u32_u24 v97, v100, 1, v27
  v_mad_u32_u24 v98, v101, 1, v36
  v_mad_u32_u24 v99, v100, 1, v36
  s_waitcnt vmcnt(13)
  s_barrier
  ds_read_b64_tr_b16 v[64:65], v96 offset:8192
  ds_read_b64_tr_b16 v[66:67], v96 offset:8448
  ds_read_b64_tr_b16 v[68:69], v96 offset:10240
  ds_read_b64_tr_b16 v[70:71], v96 offset:10496
  ds_read_b64_tr_b16 v[72:73], v97 offset:8192
  ds_read_b64_tr_b16 v[74:75], v97 offset:8448
  ds_read_b64_tr_b16 v[76:77], v97 offset:10240
  ds_read_b64_tr_b16 v[78:79], v97 offset:10496
  ds_read_b64_tr_b16 v[80:81], v98 offset:8192
  ds_read_b64_tr_b16 v[82:83], v98 offset:8448
  ds_read_b64_tr_b16 v[84:85], v98 offset:10240
  ds_read_b64_tr_b16 v[86:87], v98 offset:10496
  ds_read_b64_tr_b16 v[88:89], v99 offset:8192
  ds_read_b64_tr_b16 v[90:91], v99 offset:8448
  ds_read_b64_tr_b16 v[92:93], v99 offset:10240
  ds_read_b64_tr_b16 v[94:95], v99 offset:10496
  s_waitcnt lgkmcnt(0)
  s_barrier
  ds_write_b128 v4, v[64:67] offset:8192
  ds_write_b128 v4, v[68:71] offset:9216
  ds_write_b128 v4, v[72:75] offset:10240
  ds_write_b128 v4, v[76:79] offset:11264
  ds_write_b128 v4, v[80:83] offset:12288
  ds_write_b128 v4, v[84:87] offset:13312
  ds_write_b128 v4, v[88:91] offset:14336
  ds_write_b128 v4, v[92:95] offset:15360
  s_waitcnt vmcnt(9)
  ds_read_b64_tr_b16 v[64:65], v28 offset:24576
  ds_read_b64_tr_b16 v[66:67], v28 offset:24832
  ds_read_b64_tr_b16 v[68:69], v28 offset:25600
  ds_read_b64_tr_b16 v[70:71], v28 offset:25856
  ds_read_b64_tr_b16 v[72:73], v28 offset:24584
  ds_read_b64_tr_b16 v[74:75], v28 offset:24840
  ds_read_b64_tr_b16 v[76:77], v28 offset:25608
  ds_read_b64_tr_b16 v[78:79], v28 offset:25864
  s_waitcnt lgkmcnt(0)
  ds_write_b128 v4, v[64:67] offset:24576
  ds_write_b128 v4, v[68:71] offset:25600
  ds_write_b128 v4, v[72:75] offset:26624
  ds_write_b128 v4, v[76:79] offset:27648
  s_waitcnt lgkmcnt(0)
  s_waitcnt vmcnt(5)
  ds_read_b64_tr_b16 v[64:65], v28 offset:28672
  ds_read_b64_tr_b16 v[66:67], v28 offset:28928
  ds_read_b64_tr_b16 v[68:69], v28 offset:29696
  ds_read_b64_tr_b16 v[70:71], v28 offset:29952
  ds_read_b64_tr_b16 v[72:73], v28 offset:28680
  ds_read_b64_tr_b16 v[74:75], v28 offset:28936
  ds_read_b64_tr_b16 v[76:77], v28 offset:29704
  ds_read_b64_tr_b16 v[78:79], v28 offset:29960
  s_waitcnt lgkmcnt(0)
  ds_write_b128 v4, v[64:67] offset:28672
  ds_write_b128 v4, v[68:71] offset:29696
  ds_write_b128 v4, v[72:75] offset:30720
  ds_write_b128 v4, v[76:79] offset:31744
  s_waitcnt lgkmcnt(0)
  s_mov_b32 s14, 1
  s_cmp_lt_i32 s14, s30
  s_cbranch_scc1 T_kv2_7
  s_mov_b32 s19, 0
  s_branch T_kvok_9
T_kv_8:
  s_sleep 4
  s_add_u32 s19, s19, 1
  s_cmp_gt_u32 s19, 32768
  s_cbranch_scc1 M_exit
T_kvok_9:
  s_add_u32 s39, s99, 128
  s_mov_b32 s38, 0
  s_mov_b32 s37, 0
  s_atomic_or s38, s[58:59], s99 glc
  s_atomic_or s37, s[58:59], s39 glc
  s_waitcnt lgkmcnt(0)
  s_lshl_b32 s38, s38, 1
  s_lshl1_add_u32 s37, s37, 1
  s_min_u32 s38, s38, s37
  s_cmp_ge_u32 s38, 64
  s_cselect_b32 s38, 100, s38
  s_sub_u32 s38, s38, 1
  s_max_i32 s30, s30, s38
  s_cmp_ge_i32 s14, s30
  s_cbranch_scc1 T_kv_8
T_kv2_7:
  s_waitcnt vmcnt(0) lgkmcnt(0)
  s_barrier
  s_cmp_ge_u32 s13, 2
  s_cselect_b64 vcc, -1, 0
  v_cndmask_b32 v3, v8, v19, vcc
  ds_read_b128 v[68:71], v4 offset:0
  ds_read_b128 v[72:75], v4 offset:1024
  ds_read_b128 v[76:79], v4 offset:4096
  ds_read_b128 v[80:83], v4 offset:5120
  ds_read_b128 v[84:87], v4 offset:8192
  ds_read_b128 v[88:91], v4 offset:9216
  ds_read_b128 v[92:95], v4 offset:2048
  ds_read_b128 v[96:99], v4 offset:3072
  ds_read_b128 v[100:103], v4 offset:6144
  ds_read_b128 v[104:107], v4 offset:7168
  ds_read_b128 v[108:111], v4 offset:10240
  ds_read_b128 v[112:115], v4 offset:11264
  ds_read_b128 v[28:31], v59 offset:16384
  ds_read_b128 v[32:35], v59 offset:20480
  ds_read_b128 v[36:39], v2 offset:8192
  ds_read_b128 v[40:43], v2 offset:9216
  ds_read_b128 v[44:47], v2 offset:10240
  ds_read_b128 v[48:51], v2 offset:11264
  ds_read_b128 v[52:55], v2 offset:12288
  ds_read_b128 v[56:59], v2 offset:13312
  ds_read_b128 v[60:63], v2 offset:14336
  ds_read_b128 v[64:67], v2 offset:15360
  s_and_b32 s36, s13, 1
  s_lshl_b32 s36, s36, 12
  s_add_u32 s22, s22, s36
  s_add_u32 s23, s36, 145752064
  s_mov_b32 s14, -1
  s_and_b32 s57, s14, 1
  s_and_b32 s36, s14, 3
  s_lshl_b32 s36, s36, 13
  s_add_u32 s26, s36, s23
  s_add_u32 s36, s36, 8192
  s_and_b32 s36, s36, 0x7fff
  s_add_u32 s24, s36, 145752064
  s_add_u32 s25, s36, 145756160
  s_add_u32 s35, s36, s23
  s_waitcnt lgkmcnt(0)
  s_cmp_lg_u32 s56, 0
  s_cbranch_scc1 M_global
T_code:
  s_cmp_eq_u32 s13, 1
  s_cbranch_scc1 T_w_11
  s_cmp_eq_u32 s13, 2
  s_cbranch_scc1 T_w_12
  s_cmp_eq_u32 s13, 3
  s_cbranch_scc1 T_w_13
T_w_10:
  s_mov_b32 s19, 0
  s_add_u32 s14, s14, 1
  s_and_b32 s57, s14, 1
  v_mov_b64 v[16:17], 0
  v_mov_b64 v[18:19], 0
  v_mov_b64 v[20:21], 0
  v_mov_b64 v[22:23], 0
  v_mov_b64 v[24:25], 0
  v_mov_b64 v[26:27], 0
  buffer_load_dwordx4 v[124:127], v2, s[4:7], s24 offen offset:0 sc1
  buffer_load_dwordx4 v[116:119], v2, s[4:7], s25 offen offset:0 sc1
  buffer_load_dwordx4 v[124:127], v2, s[4:7], s24 offen offset:0 sc1
  buffer_load_dwordx4 v[116:119], v2, s[4:7], s25 offen offset:0 sc1
  s_branch T_loop_14
.p2align 6
T_retry_15:
  s_mov_b64 exec, vcc
  buffer_load_dwordx4 v[124:127], v2, s[4:7], s24 offen offset:0 sc1
  buffer_load_dwordx4 v[116:119], v2, s[4:7], s25 offen offset:0 sc1
  s_mov_b64 exec, -1
  s_add_u32 s19, s19, 1
  s_cmp_gt_u32 s19, 32768
  s_cbranch_scc1 M_exit
  s_nop 0
  v_mov_b64 v[16:17], 0
  v_mov_b64 v[18:19], 0
T_loop_14:
  s_waitcnt vmcnt(3) lgkmcnt(0)
  v_max3_u32 v123, v124, v125, v126
  v_max_u32 v123, v123, v127
  v_mov_b32_dpp v120, v124 row_ror:8 row_mask:0xf bank_mask:0xf
  v_mov_b32_dpp v121, v125 row_ror:8 row_mask:0xf bank_mask:0xf
  s_waitcnt vmcnt(2)
  v_max3_u32 v123, v123, v116, v117
  v_max3_u32 v123, v123, v118, v119
  v_cmp_eq_u32 vcc, -1, v123
  v_smfmac_f32_16x16x64_bf16 v[16:19], v[124:127], v[68:75], v0
  s_cbranch_vccnz T_retry_15
  ds_write_b128 v2, v[124:127] offset:0
  v_mov_b32_dpp v122, v126 row_ror:8 row_mask:0xf bank_mask:0xf
  v_smfmac_f32_16x16x64_bf16 v[20:23], v[124:127], v[76:83], v0
  s_and_b32 s57, s14, 1
  v_mov_b32_dpp v123, v127 row_ror:8 row_mask:0xf bank_mask:0xf
  v_smfmac_f32_16x16x64_bf16 v[24:27], v[124:127], v[84:91], v0
  s_and_b32 s36, s14, 3
  ds_write_b128 v2, v[116:119] offset:4096
  v_smfmac_f32_16x16x64_bf16 v[16:19], v[120:123], v[92:99], v0
  s_lshl_b32 s36, s36, 13
  v_mov_b32_dpp v84, v116 row_ror:8 row_mask:0xf bank_mask:0xf
  v_smfmac_f32_16x16x64_bf16 v[20:23], v[120:123], v[100:107], v0
  s_add_u32 s26, s36, s23
  ds_read_b128 v[68:71], v4 offset:12288
  v_mov_b32_dpp v85, v117 row_ror:8 row_mask:0xf bank_mask:0xf
  v_smfmac_f32_16x16x64_bf16 v[24:27], v[120:123], v[108:115], v0
  s_add_u32 s36, s36, 8192
  ds_read_b128 v[72:75], v4 offset:13312
  v_mov_b32_dpp v86, v118 row_ror:8 row_mask:0xf bank_mask:0xf
  v_smfmac_f32_16x16x64_bf16 v[16:19], v[116:119], v[224:231], v0
  s_and_b32 s36, s36, 0x7fff
  ds_read_b128 v[76:79], v4 offset:14336
  v_mov_b32_dpp v87, v119 row_ror:8 row_mask:0xf bank_mask:0xf
  v_smfmac_f32_16x16x64_bf16 v[20:23], v[116:119], v[240:247], v0
  s_waitcnt lgkmcnt(3)
  s_barrier
  ds_read_b128 v[100:103], v2 offset:1024
  v_smfmac_f32_16x16x64_bf16 v[24:27], v[116:119], a[0:7], v0
  s_mov_b32 m0, s31
  ds_read_b128 v[120:123], v1 offset:1024
  buffer_load_dwordx4 v9, s[4:7], s27 offen sc1 lds
  v_smfmac_f32_16x16x64_bf16 v[16:19], v[84:87], v[232:239], v0
  s_mov_b32 m0, s32
  v_smfmac_f32_16x16x64_bf16 v[20:23], v[84:87], v[248:255], v0
  ds_read_b128 v[80:83], v4 offset:15360
  v_smfmac_f32_16x16x64_bf16 v[24:27], v[84:87], a[8:15], v0
  s_waitcnt lgkmcnt(2)
  v_smfmac_f32_16x16x64_bf16 v[16:19], v[100:103], v[128:135], v0
  ds_read_b128 v[92:95], v2 offset:2048
  buffer_load_dwordx4 v9, s[4:7], s27 offen offset:128 sc1 lds
  v_smfmac_f32_16x16x64_bf16 v[20:23], v[100:103], v[144:151], v0
  ds_read_b128 v[96:99], v1 offset:2048
  s_mov_b32 m0, s33
  v_smfmac_f32_16x16x64_bf16 v[24:27], v[100:103], v[68:75], v0
  s_waitcnt vmcnt(2) lgkmcnt(3)
  ds_read_b128 v[116:119], v2 offset:3072
  v_smfmac_f32_16x16x64_bf16 v[16:19], v[120:123], v[136:143], v0
  ds_read_b128 v[124:127], v1 offset:3072
  v_smfmac_f32_16x16x64_bf16 v[20:23], v[120:123], v[152:159], v0
  s_waitcnt lgkmcnt(4)
  ds_read_b128 v[104:107], v2 offset:5120
  buffer_load_dwordx4 v10, s[4:7], s28 offen sc1 lds
  v_smfmac_f32_16x16x64_bf16 v[24:27], v[120:123], v[76:83], v0
  s_waitcnt lgkmcnt(4)
  ds_read_b128 v[108:111], v1 offset:5120
  s_mov_b32 m0, s34
  v_smfmac_f32_16x16x64_bf16 v[16:19], v[92:95], v[160:167], v0
  s_waitcnt lgkmcnt(4)
  ds_read_b128 v[112:115], v2 offset:6144
  v_smfmac_f32_16x16x64_bf16 v[16:19], v[96:99], v[168:175], v0
  s_waitcnt lgkmcnt(4)
  ds_read_b128 v[84:87], v1 offset:6144
  v_smfmac_f32_16x16x64_bf16 v[16:19], v[116:119], v[192:199], v0
  s_waitcnt lgkmcnt(4)
  ds_read_b128 v[88:91], v2 offset:7168
  buffer_load_dwordx4 v10, s[4:7], s28 offen offset:256 sc1 lds
  v_smfmac_f32_16x16x64_bf16 v[16:19], v[124:127], v[200:207], v0
  s_waitcnt lgkmcnt(4)
  ds_read_b128 v[100:103], v1 offset:7168
  v_smfmac_f32_16x16x64_bf16 v[16:19], v[104:107], a[16:23], v0
  s_waitcnt lgkmcnt(4)
  ds_read_b128 v[68:71], v4 offset:16384
  v_smfmac_f32_16x16x64_bf16 v[16:19], v[108:111], a[24:31], v0
  s_waitcnt lgkmcnt(4)
  ds_read_b128 v[72:75], v4 offset:17408
  v_smfmac_f32_16x16x64_bf16 v[16:19], v[112:115], a[64:71], v0
  s_waitcnt lgkmcnt(4)
  ds_read_b128 v[76:79], v4 offset:18432
  v_smfmac_f32_16x16x64_bf16 v[16:19], v[84:87], a[72:79], v0
  s_waitcnt lgkmcnt(4)
  ds_read_b128 v[80:83], v4 offset:19456
  v_smfmac_f32_16x16x64_bf16 v[16:19], v[88:91], a[112:119], v0
  s_waitcnt lgkmcnt(4)
  v_smfmac_f32_16x16x64_bf16 v[16:19], v[100:103], a[120:127], v0
  s_add_u32 s24, s36, 145752064
  s_add_u32 s25, s36, 145756160
  v_smfmac_f32_16x16x64_bf16 v[20:23], v[92:95], v[176:183], v0
  s_add_u32 s35, s36, s23
  v_smfmac_f32_16x16x64_bf16 v[20:23], v[96:99], v[184:191], v0
  s_waitcnt lgkmcnt(2)
  v_smfmac_f32_16x16x64_bf16 v[20:23], v[116:119], v[68:75], v0
  s_waitcnt lgkmcnt(0)
  ds_read_b128 v[68:71], v4 offset:20480
  v_mul_f32 v16, s18, v16
  v_smfmac_f32_16x16x64_bf16 v[20:23], v[124:127], v[76:83], v0
  ds_read_b128 v[72:75], v4 offset:21504
  v_mul_f32 v17, s18, v17
  v_smfmac_f32_16x16x64_bf16 v[20:23], v[104:107], a[32:39], v0
  ds_read_b128 v[76:79], v4 offset:22528
  v_mul_f32 v18, s18, v18
  v_smfmac_f32_16x16x64_bf16 v[20:23], v[108:111], a[40:47], v0
  ds_read_b128 v[80:83], v4 offset:23552
  v_mul_f32 v19, s18, v19
  v_smfmac_f32_16x16x64_bf16 v[20:23], v[112:115], a[80:87], v0
  v_cvt_pk_bf16_f32 v120, v16, v17
  v_smfmac_f32_16x16x64_bf16 v[20:23], v[84:87], a[88:95], v0
  v_cvt_pk_bf16_f32 v121, v18, v19
  v_smfmac_f32_16x16x64_bf16 v[20:23], v[88:91], a[128:135], v0
  ds_write_b64 v5, v[120:121] offset:24576
  v_smfmac_f32_16x16x64_bf16 v[20:23], v[100:103], a[136:143], v0
  s_waitcnt lgkmcnt(3)
  v_smfmac_f32_16x16x64_bf16 v[24:27], v[92:95], v[68:75], v0
  s_waitcnt lgkmcnt(1)
  v_mov_b64 v[92:93], 0
  v_smfmac_f32_16x16x64_bf16 v[24:27], v[96:99], v[76:83], v0
  s_nop 1
  v_cvt_pk_bf16_f32 v122, v20, v21
  v_cvt_pk_bf16_f32 v123, v22, v23
  v_smfmac_f32_16x16x64_bf16 v[24:27], v[116:119], v[208:215], v0
  ds_write_b64 v5, v[122:123] offset:26880
  v_mov_b64 v[94:95], 0
  v_smfmac_f32_16x16x64_bf16 v[24:27], v[124:127], v[216:223], v0
  s_waitcnt lgkmcnt(1)
  s_barrier
  ds_read_b64_tr_b16 v[68:69], v6 offset:24576
  v_smfmac_f32_16x16x64_bf16 v[24:27], v[104:107], a[48:55], v0
  s_add_u32 s27, s27, 8192
  ds_read_b64_tr_b16 v[70:71], v6 offset:24640
  ds_read_b64_tr_b16 v[72:73], v6 offset:24832
  v_smfmac_f32_16x16x64_bf16 v[24:27], v[108:111], a[56:63], v0
  s_add_u32 s28, s28, 8192
  ds_read_b64_tr_b16 v[74:75], v6 offset:24896
  ds_read_b64_tr_b16 v[76:77], v6 offset:25088
  v_smfmac_f32_16x16x64_bf16 v[24:27], v[112:115], a[96:103], v0
  s_nop 0
  ds_read_b64_tr_b16 v[78:79], v6 offset:25152
  ds_read_b64_tr_b16 v[80:81], v6 offset:25344
  v_smfmac_f32_16x16x64_bf16 v[24:27], v[84:87], a[104:111], v0
  ds_read_b64_tr_b16 v[82:83], v6 offset:25408
  v_mov_b64 v[96:97], 0
  v_smfmac_f32_16x16x64_bf16 v[24:27], v[88:91], a[144:151], v0
  s_waitcnt lgkmcnt(8)
  s_barrier
  ds_read_b64_tr_b16 v[116:117], v6 offset:26880
  v_smfmac_f32_16x16x64_bf16 v[24:27], v[100:103], a[152:159], v0
  s_waitcnt lgkmcnt(7)
  ds_read_b64_tr_b16 v[118:119], v6 offset:26944
  v_mfma_f32_16x16x32_bf16 v[16:19], v[36:39], v[68:71], 0
  s_waitcnt lgkmcnt(6)
  ds_read_b64_tr_b16 v[124:125], v6 offset:27136
  ds_read_b64_tr_b16 v[126:127], v6 offset:27200
  v_mfma_f32_16x16x32_bf16 v[16:19], v[40:43], v[72:75], v[16:19]
  s_waitcnt lgkmcnt(6)
  ds_read_b64_tr_b16 v[104:105], v6 offset:27392
  ds_read_b64_tr_b16 v[106:107], v6 offset:27456
  v_mfma_f32_16x16x32_bf16 v[16:19], v[44:47], v[76:79], v[16:19]
  s_waitcnt lgkmcnt(6)
  ds_read_b64_tr_b16 v[108:109], v6 offset:27648
  ds_read_b64_tr_b16 v[110:111], v6 offset:27712
  v_mfma_f32_16x16x32_bf16 v[16:19], v[48:51], v[80:83], v[16:19]
  s_waitcnt lgkmcnt(6)
  v_cvt_pk_bf16_f32 v120, v24, v25
  v_cvt_pk_bf16_f32 v121, v26, v27
  v_mfma_f32_16x16x32_bf16 v[112:115], v[116:119], v[68:71], 0
  s_waitcnt lgkmcnt(4)
  buffer_store_dwordx4 v[120:123], v2, s[4:7], s29 offen offset:0 sc1
  v_mov_b64 v[98:99], 0
  v_mfma_f32_16x16x32_bf16 v[112:115], v[124:127], v[72:75], v[112:115]
  s_waitcnt lgkmcnt(2)
  v_mov_b64 v[36:37], 0
  v_exp_f32 v100, v16
  v_mfma_f32_16x16x32_bf16 v[112:115], v[104:107], v[76:79], v[112:115]
  s_waitcnt lgkmcnt(0)
  v_exp_f32 v101, v17
  v_mfma_f32_16x16x32_bf16 v[112:115], v[108:111], v[80:83], v[112:115]
  v_exp_f32 v102, v18
  v_mfma_f32_16x16x32_bf16 v[20:23], v[52:55], v[68:71], 0
  v_exp_f32 v103, v19
  v_mfma_f32_16x16x32_bf16 v[20:23], v[56:59], v[72:75], v[20:23]
  v_cvt_pk_bf16_f32 v44, v100, v101
  v_cvt_pk_bf16_f32 v45, v102, v103
  v_mfma_f32_16x16x32_bf16 v[20:23], v[60:63], v[76:79], v[20:23]
  s_add_u32 s29, s29, 131072
  v_exp_f32 v100, v112
  v_mfma_f32_16x16x32_bf16 v[20:23], v[64:67], v[80:83], v[20:23]
  v_exp_f32 v101, v113
  v_exp_f32 v102, v114
  v_exp_f32 v103, v115
  v_cvt_pk_bf16_f32 v84, v100, v101
  v_cvt_pk_bf16_f32 v85, v102, v103
  v_cndmask_b32 v48, v84, 0, s[16:17]
  v_cndmask_b32 v49, v85, 0, s[16:17]
  v_cndmask_b32 v50, 0, v84, s[16:17]
  v_cndmask_b32 v51, 0, v85, s[16:17]
  v_exp_f32 v100, v20
  v_mfma_f32_16x16x16_bf16 v[88:91], v[12:13], v[48:49], 0
  v_exp_f32 v101, v21
  v_mfma_f32_16x16x16_bf16 v[24:27], v[120:121], v[48:49], 0
  v_exp_f32 v102, v22
  v_mfma_f32_16x16x16_bf16 v[116:119], v[120:121], v[50:51], 0
  v_exp_f32 v103, v23
  v_cvt_pk_bf16_f32 v46, v100, v101
  v_cvt_pk_bf16_f32 v47, v102, v103
  v_mov_b64 v[38:39], 0
  s_nop 0
  v_mfma_f32_16x16x32_bf16 v[88:91], v[12:15], v[44:47], v[88:91]
  v_mov_b64 v[40:41], 0
  v_mov_b64 v[42:43], 0
  v_mfma_f32_16x16x32_bf16 v[24:27], v[28:31], v[44:47], v[24:27]
  ds_read_b128 v[52:55], v4 offset:24576
  ds_read_b128 v[56:59], v4 offset:25600
  v_mfma_f32_16x16x32_bf16 v[116:119], v[32:35], v[44:47], v[116:119]
  s_nop 1
T_back_22:
  v_rcp_f32 v89, v88
  v_subrev_u32 v100, s54, v88
  v_cmp_le_u32 vcc, s96, v100
  v_mul_f32 v24, v89, v24
  v_mul_f32 v25, v89, v25
  v_cvt_pk_bf16_f32 v124, v24, v25
  v_pk_mul_f32 v[26:27], v[26:27], v[88:89] op_sel:[0,1] op_sel_hi:[1,1]
  v_pk_mul_f32 v[116:117], v[116:117], v[88:89] op_sel:[0,1] op_sel_hi:[1,1]
  v_pk_mul_f32 v[118:119], v[118:119], v[88:89] op_sel:[0,1] op_sel_hi:[1,1]
  v_cvt_pk_bf16_f32 v125, v26, v27
  v_cvt_pk_bf16_f32 v126, v116, v117
  v_cvt_pk_bf16_f32 v127, v118, v119
  ds_write_b128 v11, v[124:127] offset:29184
  s_cbranch_vccnz T_slow_21
  v_smfmac_f32_16x16x64_bf16 v[92:95], v[124:127], a[160:167], v0
  s_mov_b32 s96, s55
  v_smfmac_f32_16x16x64_bf16 v[96:99], v[124:127], a[168:175], v0
  s_cmp_eq_u32 s14, 63
  v_smfmac_f32_16x16x64_bf16 v[36:39], v[124:127], a[176:183], v0
  s_waitcnt lgkmcnt(0)
  s_barrier
  ds_read_b128 v[104:107], v11 offset:29696
  ds_read_b128 v[108:111], v11 offset:30208
  ds_read_b128 v[68:71], v11 offset:30720
  s_cbranch_scc1 M_tdone
  v_smfmac_f32_16x16x64_bf16 v[40:43], v[124:127], a[184:191], v0
  s_waitcnt lgkmcnt(2)
  v_smfmac_f32_16x16x64_bf16 v[92:95], v[104:107], a[192:199], v0
  s_waitcnt lgkmcnt(1)
  ds_read_b128 v[76:79], v4 offset:28672
  v_smfmac_f32_16x16x64_bf16 v[92:95], v[108:111], a[224:231], v0
  s_waitcnt lgkmcnt(1)
  ds_read_b128 v[80:83], v4 offset:29696
  v_smfmac_f32_16x16x64_bf16 v[92:95], v[68:71], a[240:247], v0
  ds_read_b128 v[60:63], v4 offset:26624
  v_smfmac_f32_16x16x64_bf16 v[96:99], v[104:107], a[200:207], v0
  ds_read_b128 v[64:67], v4 offset:27648
  v_smfmac_f32_16x16x64_bf16 v[96:99], v[108:111], a[232:239], v0
  ds_read_b128 v[28:31], v4 offset:30720
  s_nop 0
  v_cvt_pk_bf16_f32 v16, v92, v93
  v_cvt_pk_bf16_f32 v17, v94, v95
  v_bfi_b32 v16, 1, s57, v16
  v_smfmac_f32_16x16x64_bf16 v[96:99], v[68:71], a[248:255], v0
  buffer_store_dwordx2 v[16:17], v7, s[4:7], s20 offen offset:0
  v_smfmac_f32_16x16x64_bf16 v[36:39], v[104:107], a[208:215], v0
  ds_read_b128 v[32:35], v4 offset:31744
  v_smfmac_f32_16x16x64_bf16 v[36:39], v[108:111], v[52:59], v0
  s_waitcnt lgkmcnt(4)
  s_nop 0
  v_cvt_pk_bf16_f32 v18, v96, v97
  v_cvt_pk_bf16_f32 v19, v98, v99
  v_bfi_b32 v18, 1, s57, v18
  v_smfmac_f32_16x16x64_bf16 v[36:39], v[68:71], v[76:83], v0
  buffer_store_dwordx2 v[18:19], v7, s[4:7], s20 offen offset:64
  v_smfmac_f32_16x16x64_bf16 v[40:43], v[104:107], a[216:223], v0
  s_waitcnt lgkmcnt(2)
  ds_read_b128 v[116:119], v2 offset:31232
  v_smfmac_f32_16x16x64_bf16 v[40:43], v[108:111], v[60:67], v0
  s_waitcnt lgkmcnt(1)
  s_nop 0
  v_cvt_pk_bf16_f32 v20, v36, v37
  v_cvt_pk_bf16_f32 v21, v38, v39
  v_bfi_b32 v20, 1, s57, v20
  v_smfmac_f32_16x16x64_bf16 v[40:43], v[68:71], v[28:35], v0
  buffer_store_dwordx2 v[20:21], v7, s[4:7], s21 offen offset:0
  s_nop 6
  v_cvt_pk_bf16_f32 v22, v40, v41
  v_cvt_pk_bf16_f32 v23, v42, v43
  v_bfi_b32 v22, 1, s57, v22
  buffer_store_dwordx2 v[22:23], v7, s[4:7], s21 offen offset:64
  ds_read_b128 v[68:71], v4 offset:0
  ds_read_b128 v[72:75], v4 offset:1024
  ds_read_b128 v[76:79], v4 offset:4096
  ds_read_b128 v[80:83], v4 offset:5120
  ds_read_b128 v[84:87], v4 offset:8192
  ds_read_b128 v[88:91], v4 offset:9216
  v_mov_b64 v[16:17], 0
  v_mov_b64 v[18:19], 0
  v_mov_b64 v[20:21], 0
  v_mov_b64 v[22:23], 0
  v_mov_b64 v[24:25], 0
  v_mov_b64 v[26:27], 0
  s_mov_b32 s19, 0
  v_mov_b32 v49, -1
  s_waitcnt vmcnt(2)
  buffer_load_dwordx4 v[52:55], v2, s[4:7], s22 offen offset:0 sc1
  buffer_load_dwordx4 v[56:59], v2, s[4:7], s22 offen offset:1024 sc1
  buffer_load_dwordx4 v[60:63], v2, s[4:7], s22 offen offset:2048 sc1
  buffer_load_dwordx4 v[64:67], v2, s[4:7], s22 offen offset:3072 sc1
  ds_read_b128 v[92:95], v4 offset:2048
  ds_read_b128 v[96:99], v4 offset:3072
  ds_read_b128 v[100:103], v4 offset:6144
  ds_read_b128 v[104:107], v4 offset:7168
  ds_read_b128 v[108:111], v4 offset:10240
  ds_read_b128 v[112:115], v4 offset:11264
  ds_read_b64 v[44:45], v2 offset:32256
  s_waitcnt lgkmcnt(0)
  v_readfirstlane_b32 s38, v44
  v_readfirstlane_b32 s37, v45
  s_nop 0
  s_lshl_b32 s38, s38, 1
  s_lshl1_add_u32 s37, s37, 1
  s_min_u32 s38, s38, s37
  s_cmp_ge_u32 s38, 64
  s_cselect_b32 s38, 100, s38
  s_sub_u32 s38, s38, 1
  s_max_i32 s30, s30, s38
  s_waitcnt lgkmcnt(12)
  s_waitcnt vmcnt(3)
  v_mfma_f32_16x16x32_bf16 v[120:123], v[116:119], v[52:55], 0
  v_xor_b32 v48, s57, v52
  v_bitop3_b32 v48, v48, v54, s57 bitop3:0xf6
  s_waitcnt vmcnt(2)
  v_mfma_f32_16x16x32_bf16 v[120:123], v[116:119], v[56:59], v[120:123]
  v_bitop3_b32 v48, v48, v56, s57 bitop3:0xf6
  v_bitop3_b32 v48, v48, v58, s57 bitop3:0xf6
  s_waitcnt vmcnt(1)
  v_mfma_f32_16x16x32_bf16 v[120:123], v[116:119], v[60:63], v[120:123]
  v_bitop3_b32 v48, v48, v60, s57 bitop3:0xf6
  v_bitop3_b32 v48, v48, v62, s57 bitop3:0xf6
  s_waitcnt vmcnt(0)
  v_mfma_f32_16x16x32_bf16 v[120:123], v[116:119], v[64:67], v[120:123]
  v_bitop3_b32 v48, v48, v64, s57 bitop3:0xf6
  v_bitop3_b32 v48, v48, v66, s57 bitop3:0xf6
  v_and_b32 v48, 1, v48
  v_cmp_ne_u32 vcc, 0, v48
  s_cbranch_vccnz T_p1re_24
T_p1ok_25:
  s_nop 2
  v_add_f32_dpp v120, v120, v120 row_ror:8 row_mask:0xf bank_mask:0xf
  v_add_f32_dpp v121, v121, v121 row_ror:8 row_mask:0xf bank_mask:0xf
  v_cvt_pk_bf16_f32 v48, v120, v121
  buffer_store_dword v48, v8, s[4:7], s35 offen
  buffer_store_dword v49, v8, s[4:7], s26 offen
  s_barrier
  ds_read_b128 v[28:31], v2 offset:16384
  ds_read_b128 v[32:35], v2 offset:20480
  ds_read_b128 v[36:39], v2 offset:8192
  ds_read_b128 v[40:43], v2 offset:9216
  ds_read_b128 v[44:47], v2 offset:10240
  ds_read_b128 v[48:51], v2 offset:11264
  buffer_load_dwordx4 v[124:127], v2, s[4:7], s24 offen offset:0 sc1
  buffer_load_dwordx4 v[116:119], v2, s[4:7], s25 offen offset:0 sc1
  ds_read_b128 v[52:55], v2 offset:12288
  ds_read_b128 v[56:59], v2 offset:13312
  ds_read_b128 v[60:63], v2 offset:14336
  ds_read_b128 v[64:67], v2 offset:15360
  buffer_load_dwordx4 v[124:127], v2, s[4:7], s24 offen offset:0 sc1
  buffer_load_dwordx4 v[116:119], v2, s[4:7], s25 offen offset:0 sc1
  s_add_u32 s14, s14, 1
  s_cmp_ge_i32 s14, s30
  s_cbranch_scc1 T_kvw_18
T_kvb_19:
  s_mov_b32 s19, 0
  s_branch T_loop_14
T_p1re_24:
  s_mov_b64 exec, vcc
  buffer_load_dwordx4 v[52:55], v2, s[4:7], s22 offen offset:0 sc1
  buffer_load_dwordx4 v[56:59], v2, s[4:7], s22 offen offset:1024 sc1
  buffer_load_dwordx4 v[60:63], v2, s[4:7], s22 offen offset:2048 sc1
  buffer_load_dwordx4 v[64:67], v2, s[4:7], s22 offen offset:3072 sc1
  s_mov_b64 exec, -1
  s_add_u32 s19, s19, 1
  s_cmp_gt_u32 s19, 32768
  s_cbranch_scc1 M_exit
  s_waitcnt vmcnt(3)
  v_mfma_f32_16x16x32_bf16 v[120:123], v[116:119], v[52:55], 0
  v_xor_b32 v48, s57, v52
  v_bitop3_b32 v48, v48, v54, s57 bitop3:0xf6
  s_waitcnt vmcnt(2)
  v_mfma_f32_16x16x32_bf16 v[120:123], v[116:119], v[56:59], v[120:123]
  v_bitop3_b32 v48, v48, v56, s57 bitop3:0xf6
  v_bitop3_b32 v48, v48, v58, s57 bitop3:0xf6
  s_waitcnt vmcnt(1)
  v_mfma_f32_16x16x32_bf16 v[120:123], v[116:119], v[60:63], v[120:123]
  v_bitop3_b32 v48, v48, v60, s57 bitop3:0xf6
  v_bitop3_b32 v48, v48, v62, s57 bitop3:0xf6
  s_waitcnt vmcnt(0)
  v_mfma_f32_16x16x32_bf16 v[120:123], v[116:119], v[64:67], v[120:123]
  v_bitop3_b32 v48, v48, v64, s57 bitop3:0xf6
  v_bitop3_b32 v48, v48, v66, s57 bitop3:0xf6
  v_and_b32 v48, 1, v48
  v_cmp_ne_u32 vcc, 0, v48
  s_cbranch_vccnz T_p1re_24
  s_branch T_p1ok_25
T_kvw_18:
  s_mov_b32 s19, 0
  s_branch T_kvok_27
T_kv_26:
  s_sleep 4
  s_add_u32 s19, s19, 1
  s_cmp_gt_u32 s19, 32768
  s_cbranch_scc1 M_exit
T_kvok_27:
  s_add_u32 s39, s99, 128
  s_mov_b32 s38, 0
  s_mov_b32 s37, 0
  s_atomic_or s38, s[58:59], s99 glc
  s_atomic_or s37, s[58:59], s39 glc
  s_waitcnt lgkmcnt(0)
  s_lshl_b32 s38, s38, 1
  s_lshl1_add_u32 s37, s37, 1
  s_min_u32 s38, s38, s37
  s_cmp_ge_u32 s38, 64
  s_cselect_b32 s38, 100, s38
  s_sub_u32 s38, s38, 1
  s_max_i32 s30, s30, s38
  s_cmp_ge_i32 s14, s30
  s_cbranch_scc1 T_kv_26
  s_branch T_kvb_19
T_slow_21:
  s_nop 7
  v_max3_f32 v100, v16, v17, v18
  v_max3_f32 v100, v100, v19, v20
  v_max3_f32 v100, v100, v21, v22
  v_max3_f32 v100, v100, v23, v112
  v_max3_f32 v100, v100, v113, v114
  v_max_f32 v100, v100, v115
  v_mov_b32 v101, v100
  s_nop 1
  v_permlane32_swap_b32 v100, v101
  s_nop 1
  v_max_f32 v100, v100, v101
  v_mov_b32 v101, v100
  s_nop 1
  v_permlane16_swap_b32 v100, v101
  s_nop 1
  v_max_f32 v100, v100, v101
  v_sub_f32 v16, v16, v100
  v_sub_f32 v17, v17, v100
  v_sub_f32 v18, v18, v100
  v_sub_f32 v19, v19, v100
  v_exp_f32 v16, v16
  v_exp_f32 v17, v17
  v_exp_f32 v18, v18
  v_exp_f32 v19, v19
  v_sub_f32 v20, v20, v100
  v_sub_f32 v21, v21, v100
  v_sub_f32 v22, v22, v100
  v_sub_f32 v23, v23, v100
  v_exp_f32 v20, v20
  v_exp_f32 v21, v21
  v_exp_f32 v22, v22
  v_exp_f32 v23, v23
  v_sub_f32 v112, v112, v100
  v_sub_f32 v113, v113, v100
  v_sub_f32 v114, v114, v100
  v_sub_f32 v115, v115, v100
  v_exp_f32 v112, v112
  v_exp_f32 v113, v113
  v_exp_f32 v114, v114
  v_exp_f32 v115, v115
  s_nop 0
  v_cvt_pk_bf16_f32 v44, v16, v17
  v_cvt_pk_bf16_f32 v45, v18, v19
  v_cvt_pk_bf16_f32 v46, v20, v21
  v_cvt_pk_bf16_f32 v47, v22, v23
  v_cvt_pk_bf16_f32 v84, v112, v113
  v_cvt_pk_bf16_f32 v85, v114, v115
  v_cndmask_b32 v48, v84, 0, s[16:17]
  v_cndmask_b32 v49, v85, 0, s[16:17]
  v_cndmask_b32 v50, 0, v84, s[16:17]
  v_cndmask_b32 v51, 0, v85, s[16:17]
  s_nop 1
  v_mfma_f32_16x16x16_bf16 v[88:91], v[12:13], v[48:49], 0
  v_mfma_f32_16x16x16_bf16 v[24:27], v[120:121], v[48:49], 0
  v_mfma_f32_16x16x16_bf16 v[116:119], v[120:121], v[50:51], 0
  v_mfma_f32_16x16x32_bf16 v[88:91], v[12:15], v[44:47], v[88:91]
  v_mfma_f32_16x16x32_bf16 v[24:27], v[28:31], v[44:47], v[24:27]
  v_mfma_f32_16x16x32_bf16 v[116:119], v[32:35], v[44:47], v[116:119]
  s_nop 7
  s_nop 1
  s_mov_b32 s96, -1
  s_branch T_back_22
T_w_11:
  s_mov_b32 s19, 0
  s_add_u32 s14, s14, 1
  s_and_b32 s57, s14, 1
  v_mov_b64 v[16:17], 0
  v_mov_b64 v[18:19], 0
  v_mov_b64 v[20:21], 0
  v_mov_b64 v[22:23], 0
  v_mov_b64 v[24:25], 0
  v_mov_b64 v[26:27], 0
  buffer_load_dwordx4 v[124:127], v2, s[4:7], s24 offen offset:1024 sc1
  buffer_load_dwordx4 v[116:119], v2, s[4:7], s25 offen offset:1024 sc1
  buffer_load_dwordx4 v[124:127], v2, s[4:7], s24 offen offset:1024 sc1
  buffer_load_dwordx4 v[116:119], v2, s[4:7], s25 offen offset:1024 sc1
  s_branch T_loop_28
.p2align 6
T_retry_29:
  s_mov_b64 exec, vcc
  buffer_load_dwordx4 v[124:127], v2, s[4:7], s24 offen offset:1024 sc1
  buffer_load_dwordx4 v[116:119], v2, s[4:7], s25 offen offset:1024 sc1
  s_mov_b64 exec, -1
  s_add_u32 s19, s19, 1
  s_cmp_gt_u32 s19, 32768
  s_cbranch_scc1 M_exit
  s_nop 0
  v_mov_b64 v[16:17], 0
  v_mov_b64 v[18:19], 0
T_loop_28:
  s_waitcnt vmcnt(3) lgkmcnt(0)
  v_max3_u32 v123, v124, v125, v126
  v_max_u32 v123, v123, v127
  v_mov_b32_dpp v120, v124 row_ror:8 row_mask:0xf bank_mask:0xf
  v_mov_b32_dpp v121, v125 row_ror:8 row_mask:0xf bank_mask:0xf
  s_waitcnt vmcnt(2)
  v_max3_u32 v123, v123, v116, v117
  v_max3_u32 v123, v123, v118, v119
  v_cmp_eq_u32 vcc, -1, v123
  v_smfmac_f32_16x16x64_bf16 v[16:19], v[124:127], v[68:75], v0
  s_cbranch_vccnz T_retry_29
  ds_write_b128 v2, v[124:127] offset:1024
  v_mov_b32_dpp v122, v126 row_ror:8 row_mask:0xf bank_mask:0xf
  v_smfmac_f32_16x16x64_bf16 v[20:23], v[124:127], v[76:83], v0
  s_and_b32 s57, s14, 1
  v_mov_b32_dpp v123, v127 row_ror:8 row_mask:0xf bank_mask:0xf
  v_smfmac_f32_16x16x64_bf16 v[24:27], v[124:127], v[84:91], v0
  s_and_b32 s36, s14, 3
  ds_write_b128 v2, v[116:119] offset:5120
  v_smfmac_f32_16x16x64_bf16 v[16:19], v[120:123], v[92:99], v0
  s_lshl_b32 s36, s36, 13
  v_mov_b32_dpp v84, v116 row_ror:8 row_mask:0xf bank_mask:0xf
  v_smfmac_f32_16x16x64_bf16 v[20:23], v[120:123], v[100:107], v0
  s_add_u32 s26, s36, s23
  ds_read_b128 v[68:71], v4 offset:12288
  v_mov_b32_dpp v85, v117 row_ror:8 row_mask:0xf bank_mask:0xf
  v_smfmac_f32_16x16x64_bf16 v[24:27], v[120:123], v[108:115], v0
  s_add_u32 s36, s36, 8192
  ds_read_b128 v[72:75], v4 offset:13312
  v_mov_b32_dpp v86, v118 row_ror:8 row_mask:0xf bank_mask:0xf
  v_smfmac_f32_16x16x64_bf16 v[16:19], v[116:119], v[224:231], v0
  s_and_b32 s36, s36, 0x7fff
  ds_read_b128 v[76:79], v4 offset:14336
  v_mov_b32_dpp v87, v119 row_ror:8 row_mask:0xf bank_mask:0xf
  v_smfmac_f32_16x16x64_bf16 v[20:23], v[116:119], v[240:247], v0
  s_waitcnt lgkmcnt(3)
  s_barrier
  ds_read_b128 v[100:103], v2 offset:0
  v_smfmac_f32_16x16x64_bf16 v[24:27], v[116:119], a[0:7], v0
  s_mov_b32 m0, s31
  ds_read_b128 v[120:123], v1 offset:0
  v_smfmac_f32_16x16x64_bf16 v[16:19], v[84:87], v[232:239], v0
  buffer_load_dwordx4 v9, s[4:7], s27 offen sc1 lds
  v_smfmac_f32_16x16x64_bf16 v[20:23], v[84:87], v[248:255], v0
  ds_read_b128 v[80:83], v4 offset:15360
  s_mov_b32 m0, s32
  v_smfmac_f32_16x16x64_bf16 v[24:27], v[84:87], a[8:15], v0
  s_waitcnt lgkmcnt(2)
  v_smfmac_f32_16x16x64_bf16 v[16:19], v[100:103], v[128:135], v0
  ds_read_b128 v[92:95], v2 offset:3072
  v_smfmac_f32_16x16x64_bf16 v[20:23], v[100:103], v[144:151], v0
  ds_read_b128 v[96:99], v1 offset:3072
  buffer_load_dwordx4 v9, s[4:7], s27 offen offset:128 sc1 lds
  v_smfmac_f32_16x16x64_bf16 v[24:27], v[100:103], v[68:75], v0
  s_waitcnt vmcnt(2) lgkmcnt(3)
  ds_read_b128 v[116:119], v2 offset:2048
  s_mov_b32 m0, s33
  v_smfmac_f32_16x16x64_bf16 v[16:19], v[120:123], v[136:143], v0
  ds_read_b128 v[124:127], v1 offset:2048
  v_smfmac_f32_16x16x64_bf16 v[20:23], v[120:123], v[152:159], v0
  s_waitcnt lgkmcnt(4)
  ds_read_b128 v[104:107], v2 offset:4096
  v_smfmac_f32_16x16x64_bf16 v[24:27], v[120:123], v[76:83], v0
  s_waitcnt lgkmcnt(4)
  ds_read_b128 v[108:111], v1 offset:4096
  buffer_load_dwordx4 v10, s[4:7], s28 offen sc1 lds
  v_smfmac_f32_16x16x64_bf16 v[16:19], v[92:95], v[160:167], v0
  s_waitcnt lgkmcnt(4)
  ds_read_b128 v[112:115], v2 offset:7168
  s_mov_b32 m0, s34
  v_smfmac_f32_16x16x64_bf16 v[16:19], v[96:99], v[168:175], v0
  s_waitcnt lgkmcnt(4)
  ds_read_b128 v[84:87], v1 offset:7168
  v_smfmac_f32_16x16x64_bf16 v[16:19], v[116:119], v[192:199], v0
  s_waitcnt lgkmcnt(4)
  ds_read_b128 v[88:91], v2 offset:6144
  v_smfmac_f32_16x16x64_bf16 v[16:19], v[124:127], v[200:207], v0
  s_waitcnt lgkmcnt(4)
  ds_read_b128 v[100:103], v1 offset:6144
  buffer_load_dwordx4 v10, s[4:7], s28 offen offset:256 sc1 lds
  v_smfmac_f32_16x16x64_bf16 v[16:19], v[104:107], a[16:23], v0
  s_waitcnt lgkmcnt(4)
  ds_read_b128 v[68:71], v4 offset:16384
  v_smfmac_f32_16x16x64_bf16 v[16:19], v[108:111], a[24:31], v0
  s_waitcnt lgkmcnt(4)
  ds_read_b128 v[72:75], v4 offset:17408
  v_smfmac_f32_16x16x64_bf16 v[16:19], v[112:115], a[64:71], v0
  s_waitcnt lgkmcnt(4)
  ds_read_b128 v[76:79], v4 offset:18432
  v_smfmac_f32_16x16x64_bf16 v[16:19], v[84:87], a[72:79], v0
  s_waitcnt lgkmcnt(4)
  ds_read_b128 v[80:83], v4 offset:19456
  v_smfmac_f32_16x16x64_bf16 v[16:19], v[88:91], a[112:119], v0
  s_waitcnt lgkmcnt(4)
  v_smfmac_f32_16x16x64_bf16 v[16:19], v[100:103], a[120:127], v0
  s_add_u32 s24, s36, 145752064
  s_add_u32 s25, s36, 145756160
  v_smfmac_f32_16x16x64_bf16 v[20:23], v[92:95], v[176:183], v0
  s_add_u32 s35, s36, s23
  v_smfmac_f32_16x16x64_bf16 v[20:23], v[96:99], v[184:191], v0
  s_waitcnt lgkmcnt(2)
  v_smfmac_f32_16x16x64_bf16 v[20:23], v[116:119], v[68:75], v0
  s_waitcnt lgkmcnt(0)
  ds_read_b128 v[68:71], v4 offset:20480
  v_mul_f32 v16, s18, v16
  v_smfmac_f32_16x16x64_bf16 v[20:23], v[124:127], v[76:83], v0
  ds_read_b128 v[72:75], v4 offset:21504
  v_mul_f32 v17, s18, v17
  v_smfmac_f32_16x16x64_bf16 v[20:23], v[104:107], a[32:39], v0
  ds_read_b128 v[76:79], v4 offset:22528
  v_mul_f32 v18, s18, v18
  v_smfmac_f32_16x16x64_bf16 v[20:23], v[108:111], a[40:47], v0
  ds_read_b128 v[80:83], v4 offset:23552
  v_mul_f32 v19, s18, v19
  v_smfmac_f32_16x16x64_bf16 v[20:23], v[112:115], a[80:87], v0
  v_cvt_pk_bf16_f32 v120, v16, v17
  v_smfmac_f32_16x16x64_bf16 v[20:23], v[84:87], a[88:95], v0
  v_cvt_pk_bf16_f32 v121, v18, v19
  v_smfmac_f32_16x16x64_bf16 v[20:23], v[88:91], a[128:135], v0
  ds_write_b64 v5, v[120:121] offset:24576
  v_smfmac_f32_16x16x64_bf16 v[20:23], v[100:103], a[136:143], v0
  s_waitcnt lgkmcnt(3)
  v_smfmac_f32_16x16x64_bf16 v[24:27], v[92:95], v[68:75], v0
  s_waitcnt lgkmcnt(1)
  v_mov_b64 v[92:93], 0
  v_smfmac_f32_16x16x64_bf16 v[24:27], v[96:99], v[76:83], v0
  s_nop 1
  v_cvt_pk_bf16_f32 v122, v20, v21
  v_cvt_pk_bf16_f32 v123, v22, v23
  v_smfmac_f32_16x16x64_bf16 v[24:27], v[116:119], v[208:215], v0
  ds_write_b64 v5, v[122:123] offset:26880
  v_mov_b64 v[94:95], 0
  v_smfmac_f32_16x16x64_bf16 v[24:27], v[124:127], v[216:223], v0
  s_waitcnt lgkmcnt(1)
  s_barrier
  ds_read_b64_tr_b16 v[68:69], v6 offset:24576
  v_smfmac_f32_16x16x64_bf16 v[24:27], v[104:107], a[48:55], v0
  s_add_u32 s27, s27, 8192
  ds_read_b64_tr_b16 v[70:71], v6 offset:24640
  ds_read_b64_tr_b16 v[72:73], v6 offset:24832
  v_smfmac_f32_16x16x64_bf16 v[24:27], v[108:111], a[56:63], v0
  s_add_u32 s28, s28, 8192
  ds_read_b64_tr_b16 v[74:75], v6 offset:24896
  ds_read_b64_tr_b16 v[76:77], v6 offset:25088
  v_smfmac_f32_16x16x64_bf16 v[24:27], v[112:115], a[96:103], v0
  s_nop 0
  ds_read_b64_tr_b16 v[78:79], v6 offset:25152
  ds_read_b64_tr_b16 v[80:81], v6 offset:25344
  v_smfmac_f32_16x16x64_bf16 v[24:27], v[84:87], a[104:111], v0
  ds_read_b64_tr_b16 v[82:83], v6 offset:25408
  v_mov_b64 v[96:97], 0
  v_smfmac_f32_16x16x64_bf16 v[24:27], v[88:91], a[144:151], v0
  s_waitcnt lgkmcnt(8)
  s_barrier
  ds_read_b64_tr_b16 v[116:117], v6 offset:26880
  v_smfmac_f32_16x16x64_bf16 v[24:27], v[100:103], a[152:159], v0
  s_waitcnt lgkmcnt(7)
  ds_read_b64_tr_b16 v[118:119], v6 offset:26944
  v_mfma_f32_16x16x32_bf16 v[16:19], v[36:39], v[68:71], 0
  s_waitcnt lgkmcnt(6)
  ds_read_b64_tr_b16 v[124:125], v6 offset:27136
  ds_read_b64_tr_b16 v[126:127], v6 offset:27200
  v_mfma_f32_16x16x32_bf16 v[16:19], v[40:43], v[72:75], v[16:19]
  s_waitcnt lgkmcnt(6)
  ds_read_b64_tr_b16 v[104:105], v6 offset:27392
  ds_read_b64_tr_b16 v[106:107], v6 offset:27456
  v_mfma_f32_16x16x32_bf16 v[16:19], v[44:47], v[76:79], v[16:19]
  s_waitcnt lgkmcnt(6)
  ds_read_b64_tr_b16 v[108:109], v6 offset:27648
  ds_read_b64_tr_b16 v[110:111], v6 offset:27712
  v_mfma_f32_16x16x32_bf16 v[16:19], v[48:51], v[80:83], v[16:19]
  s_waitcnt lgkmcnt(6)
  v_cvt_pk_bf16_f32 v120, v24, v25
  v_cvt_pk_bf16_f32 v121, v26, v27
  v_mfma_f32_16x16x32_bf16 v[112:115], v[116:119], v[68:71], 0
  s_waitcnt lgkmcnt(4)
  v_mov_b64 v[98:99], 0
  v_mfma_f32_16x16x32_bf16 v[112:115], v[124:127], v[72:75], v[112:115]
  s_waitcnt lgkmcnt(2)
  buffer_store_dwordx4 v[120:123], v2, s[4:7], s29 offen offset:1024 sc1
  v_mov_b64 v[36:37], 0
  v_exp_f32 v100, v16
  v_mfma_f32_16x16x32_bf16 v[112:115], v[104:107], v[76:79], v[112:115]
  s_waitcnt lgkmcnt(0)
  v_exp_f32 v101, v17
  v_mfma_f32_16x16x32_bf16 v[112:115], v[108:111], v[80:83], v[112:115]
  v_exp_f32 v102, v18
  v_mfma_f32_16x16x32_bf16 v[20:23], v[52:55], v[68:71], 0
  v_exp_f32 v103, v19
  v_mfma_f32_16x16x32_bf16 v[20:23], v[56:59], v[72:75], v[20:23]
  v_cvt_pk_bf16_f32 v44, v100, v101
  v_cvt_pk_bf16_f32 v45, v102, v103
  v_mfma_f32_16x16x32_bf16 v[20:23], v[60:63], v[76:79], v[20:23]
  s_add_u32 s29, s29, 131072
  v_exp_f32 v100, v112
  v_mfma_f32_16x16x32_bf16 v[20:23], v[64:67], v[80:83], v[20:23]
  v_exp_f32 v101, v113
  v_exp_f32 v102, v114
  v_exp_f32 v103, v115
  v_cvt_pk_bf16_f32 v84, v100, v101
  v_cvt_pk_bf16_f32 v85, v102, v103
  v_cndmask_b32 v48, v84, 0, s[16:17]
  v_cndmask_b32 v49, v85, 0, s[16:17]
  v_cndmask_b32 v50, 0, v84, s[16:17]
  v_cndmask_b32 v51, 0, v85, s[16:17]
  v_exp_f32 v100, v20
  v_mfma_f32_16x16x16_bf16 v[88:91], v[12:13], v[48:49], 0
  v_exp_f32 v101, v21
  v_mfma_f32_16x16x16_bf16 v[24:27], v[120:121], v[48:49], 0
  v_exp_f32 v102, v22
  v_mfma_f32_16x16x16_bf16 v[116:119], v[120:121], v[50:51], 0
  v_exp_f32 v103, v23
  v_cvt_pk_bf16_f32 v46, v100, v101
  v_cvt_pk_bf16_f32 v47, v102, v103
  v_mov_b64 v[38:39], 0
  s_nop 0
  v_mfma_f32_16x16x32_bf16 v[88:91], v[12:15], v[44:47], v[88:91]
  v_mov_b64 v[40:41], 0
  v_mov_b64 v[42:43], 0
  v_mfma_f32_16x16x32_bf16 v[24:27], v[28:31], v[44:47], v[24:27]
  ds_read_b128 v[52:55], v4 offset:24576
  ds_read_b128 v[56:59], v4 offset:25600
  v_mfma_f32_16x16x32_bf16 v[116:119], v[32:35], v[44:47], v[116:119]
  s_nop 1
T_back_36:
  v_rcp_f32 v89, v88
  v_subrev_u32 v100, s54, v88
  v_cmp_le_u32 vcc, s96, v100
  v_mul_f32 v24, v89, v24
  v_mul_f32 v25, v89, v25
  v_cvt_pk_bf16_f32 v124, v24, v25
  v_pk_mul_f32 v[26:27], v[26:27], v[88:89] op_sel:[0,1] op_sel_hi:[1,1]
  v_pk_mul_f32 v[116:117], v[116:117], v[88:89] op_sel:[0,1] op_sel_hi:[1,1]
  v_pk_mul_f32 v[118:119], v[118:119], v[88:89] op_sel:[0,1] op_sel_hi:[1,1]
  v_cvt_pk_bf16_f32 v125, v26, v27
  v_cvt_pk_bf16_f32 v126, v116, v117
  v_cvt_pk_bf16_f32 v127, v118, v119
  ds_write_b128 v11, v[124:127] offset:29696
  s_cbranch_vccnz T_slow_35
  v_smfmac_f32_16x16x64_bf16 v[92:95], v[124:127], a[160:167], v0
  s_mov_b32 s96, s55
  v_smfmac_f32_16x16x64_bf16 v[96:99], v[124:127], a[168:175], v0
  s_cmp_eq_u32 s14, 63
  v_smfmac_f32_16x16x64_bf16 v[36:39], v[124:127], a[176:183], v0
  s_waitcnt lgkmcnt(0)
  s_barrier
  ds_read_b128 v[104:107], v11 offset:29184
  ds_read_b128 v[108:111], v11 offset:30720
  ds_read_b128 v[68:71], v11 offset:30208
  s_cbranch_scc1 M_tdone
  v_smfmac_f32_16x16x64_bf16 v[40:43], v[124:127], a[184:191], v0
  s_waitcnt lgkmcnt(2)
  v_smfmac_f32_16x16x64_bf16 v[92:95], v[104:107], a[192:199], v0
  s_waitcnt lgkmcnt(1)
  ds_read_b128 v[76:79], v4 offset:28672
  v_smfmac_f32_16x16x64_bf16 v[92:95], v[108:111], a[224:231], v0
  s_waitcnt lgkmcnt(1)
  ds_read_b128 v[80:83], v4 offset:29696
  v_smfmac_f32_16x16x64_bf16 v[92:95], v[68:71], a[240:247], v0
  ds_read_b128 v[60:63], v4 offset:26624
  v_smfmac_f32_16x16x64_bf16 v[96:99], v[104:107], a[200:207], v0
  ds_read_b128 v[64:67], v4 offset:27648
  v_smfmac_f32_16x16x64_bf16 v[96:99], v[108:111], a[232:239], v0
  ds_read_b128 v[28:31], v4 offset:30720
  s_nop 0
  v_cvt_pk_bf16_f32 v16, v92, v93
  v_cvt_pk_bf16_f32 v17, v94, v95
  v_bfi_b32 v16, 1, s57, v16
  v_smfmac_f32_16x16x64_bf16 v[96:99], v[68:71], a[248:255], v0
  buffer_store_dwordx2 v[16:17], v7, s[4:7], s20 offen offset:0
  v_smfmac_f32_16x16x64_bf16 v[36:39], v[104:107], a[208:215], v0
  ds_read_b128 v[32:35], v4 offset:31744
  v_smfmac_f32_16x16x64_bf16 v[36:39], v[108:111], v[52:59], v0
  s_waitcnt lgkmcnt(4)
  s_nop 0
  v_cvt_pk_bf16_f32 v18, v96, v97
  v_cvt_pk_bf16_f32 v19, v98, v99
  v_bfi_b32 v18, 1, s57, v18
  v_smfmac_f32_16x16x64_bf16 v[36:39], v[68:71], v[76:83], v0
  buffer_store_dwordx2 v[18:19], v7, s[4:7], s20 offen offset:64
  v_smfmac_f32_16x16x64_bf16 v[40:43], v[104:107], a[216:223], v0
  s_waitcnt lgkmcnt(2)
  ds_read_b128 v[116:119], v2 offset:31232
  v_smfmac_f32_16x16x64_bf16 v[40:43], v[108:111], v[60:67], v0
  s_waitcnt lgkmcnt(1)
  s_nop 0
  v_cvt_pk_bf16_f32 v20, v36, v37
  v_cvt_pk_bf16_f32 v21, v38, v39
  v_bfi_b32 v20, 1, s57, v20
  v_smfmac_f32_16x16x64_bf16 v[40:43], v[68:71], v[28:35], v0
  buffer_store_dwordx2 v[20:21], v7, s[4:7], s21 offen offset:0
  s_nop 6
  v_cvt_pk_bf16_f32 v22, v40, v41
  v_cvt_pk_bf16_f32 v23, v42, v43
  v_bfi_b32 v22, 1, s57, v22
  buffer_store_dwordx2 v[22:23], v7, s[4:7], s21 offen offset:64
  ds_read_b128 v[68:71], v4 offset:0
  ds_read_b128 v[72:75], v4 offset:1024
  ds_read_b128 v[76:79], v4 offset:4096
  ds_read_b128 v[80:83], v4 offset:5120
  ds_read_b128 v[84:87], v4 offset:8192
  ds_read_b128 v[88:91], v4 offset:9216
  ds_read_b128 v[92:95], v4 offset:2048
  ds_read_b128 v[96:99], v4 offset:3072
  ds_read_b128 v[100:103], v4 offset:6144
  ds_read_b128 v[104:107], v4 offset:7168
  ds_read_b128 v[108:111], v4 offset:10240
  ds_read_b128 v[112:115], v4 offset:11264
  v_mov_b64 v[16:17], 0
  v_mov_b64 v[18:19], 0
  v_mov_b64 v[20:21], 0
  v_mov_b64 v[22:23], 0
  v_mov_b64 v[24:25], 0
  v_mov_b64 v[26:27], 0
  s_mov_b32 s19, 0
  v_mov_b32 v49, -1
  ds_read_b64 v[44:45], v2 offset:32256
  s_waitcnt lgkmcnt(0)
  v_readfirstlane_b32 s38, v44
  v_readfirstlane_b32 s37, v45
  s_nop 0
  s_lshl_b32 s38, s38, 1
  s_lshl1_add_u32 s37, s37, 1
  s_min_u32 s38, s38, s37
  s_cmp_ge_u32 s38, 64
  s_cselect_b32 s38, 100, s38
  s_sub_u32 s38, s38, 1
  s_max_i32 s30, s30, s38
  s_waitcnt vmcnt(0)
  buffer_load_dwordx4 v[52:55], v2, s[4:7], s22 offen offset:0 sc1
  buffer_load_dwordx4 v[56:59], v2, s[4:7], s22 offen offset:1024 sc1
  buffer_load_dwordx4 v[60:63], v2, s[4:7], s22 offen offset:2048 sc1
  buffer_load_dwordx4 v[64:67], v2, s[4:7], s22 offen offset:3072 sc1
  s_waitcnt lgkmcnt(12)
  s_waitcnt vmcnt(3)
  v_mfma_f32_16x16x32_bf16 v[120:123], v[116:119], v[52:55], 0
  v_xor_b32 v48, s57, v52
  v_bitop3_b32 v48, v48, v54, s57 bitop3:0xf6
  s_waitcnt vmcnt(2)
  v_mfma_f32_16x16x32_bf16 v[120:123], v[116:119], v[56:59], v[120:123]
  v_bitop3_b32 v48, v48, v56, s57 bitop3:0xf6
  v_bitop3_b32 v48, v48, v58, s57 bitop3:0xf6
  s_waitcnt vmcnt(1)
  v_mfma_f32_16x16x32_bf16 v[120:123], v[116:119], v[60:63], v[120:123]
  v_bitop3_b32 v48, v48, v60, s57 bitop3:0xf6
  v_bitop3_b32 v48, v48, v62, s57 bitop3:0xf6
  s_waitcnt vmcnt(0)
  v_mfma_f32_16x16x32_bf16 v[120:123], v[116:119], v[64:67], v[120:123]
  v_bitop3_b32 v48, v48, v64, s57 bitop3:0xf6
  v_bitop3_b32 v48, v48, v66, s57 bitop3:0xf6
  v_and_b32 v48, 1, v48
  v_cmp_ne_u32 vcc, 0, v48
  s_cbranch_vccnz T_p1re_38
T_p1ok_39:
  s_nop 2
  v_add_f32_dpp v120, v120, v120 row_ror:8 row_mask:0xf bank_mask:0xf
  v_add_f32_dpp v121, v121, v121 row_ror:8 row_mask:0xf bank_mask:0xf
  v_cvt_pk_bf16_f32 v48, v120, v121
  buffer_store_dword v48, v8, s[4:7], s35 offen
  buffer_store_dword v49, v8, s[4:7], s26 offen
  s_barrier
  ds_read_b128 v[28:31], v2 offset:17408
  ds_read_b128 v[32:35], v2 offset:21504
  ds_read_b128 v[36:39], v2 offset:8192
  ds_read_b128 v[40:43], v2 offset:9216
  ds_read_b128 v[44:47], v2 offset:10240
  ds_read_b128 v[48:51], v2 offset:11264
  buffer_load_dwordx4 v[124:127], v2, s[4:7], s24 offen offset:1024 sc1
  buffer_load_dwordx4 v[116:119], v2, s[4:7], s25 offen offset:1024 sc1
  ds_read_b128 v[52:55], v2 offset:12288
  ds_read_b128 v[56:59], v2 offset:13312
  ds_read_b128 v[60:63], v2 offset:14336
  ds_read_b128 v[64:67], v2 offset:15360
  buffer_load_dwordx4 v[124:127], v2, s[4:7], s24 offen offset:1024 sc1
  buffer_load_dwordx4 v[116:119], v2, s[4:7], s25 offen offset:1024 sc1
  s_add_u32 s14, s14, 1
  s_cmp_ge_i32 s14, s30
  s_cbranch_scc1 T_kvw_32
T_kvb_33:
  s_mov_b32 s19, 0
  s_branch T_loop_28
T_p1re_38:
  s_mov_b64 exec, vcc
  buffer_load_dwordx4 v[52:55], v2, s[4:7], s22 offen offset:0 sc1
  buffer_load_dwordx4 v[56:59], v2, s[4:7], s22 offen offset:1024 sc1
  buffer_load_dwordx4 v[60:63], v2, s[4:7], s22 offen offset:2048 sc1
  buffer_load_dwordx4 v[64:67], v2, s[4:7], s22 offen offset:3072 sc1
  s_mov_b64 exec, -1
  s_add_u32 s19, s19, 1
  s_cmp_gt_u32 s19, 32768
  s_cbranch_scc1 M_exit
  s_waitcnt vmcnt(3)
  v_mfma_f32_16x16x32_bf16 v[120:123], v[116:119], v[52:55], 0
  v_xor_b32 v48, s57, v52
  v_bitop3_b32 v48, v48, v54, s57 bitop3:0xf6
  s_waitcnt vmcnt(2)
  v_mfma_f32_16x16x32_bf16 v[120:123], v[116:119], v[56:59], v[120:123]
  v_bitop3_b32 v48, v48, v56, s57 bitop3:0xf6
  v_bitop3_b32 v48, v48, v58, s57 bitop3:0xf6
  s_waitcnt vmcnt(1)
  v_mfma_f32_16x16x32_bf16 v[120:123], v[116:119], v[60:63], v[120:123]
  v_bitop3_b32 v48, v48, v60, s57 bitop3:0xf6
  v_bitop3_b32 v48, v48, v62, s57 bitop3:0xf6
  s_waitcnt vmcnt(0)
  v_mfma_f32_16x16x32_bf16 v[120:123], v[116:119], v[64:67], v[120:123]
  v_bitop3_b32 v48, v48, v64, s57 bitop3:0xf6
  v_bitop3_b32 v48, v48, v66, s57 bitop3:0xf6
  v_and_b32 v48, 1, v48
  v_cmp_ne_u32 vcc, 0, v48
  s_cbranch_vccnz T_p1re_38
  s_branch T_p1ok_39
T_kvw_32:
  s_mov_b32 s19, 0
  s_branch T_kvok_41
T_kv_40:
  s_sleep 4
  s_add_u32 s19, s19, 1
  s_cmp_gt_u32 s19, 32768
  s_cbranch_scc1 M_exit
T_kvok_41:
  s_add_u32 s39, s99, 128
  s_mov_b32 s38, 0
  s_mov_b32 s37, 0
  s_atomic_or s38, s[58:59], s99 glc
  s_atomic_or s37, s[58:59], s39 glc
  s_waitcnt lgkmcnt(0)
  s_lshl_b32 s38, s38, 1
  s_lshl1_add_u32 s37, s37, 1
  s_min_u32 s38, s38, s37
  s_cmp_ge_u32 s38, 64
  s_cselect_b32 s38, 100, s38
  s_sub_u32 s38, s38, 1
  s_max_i32 s30, s30, s38
  s_cmp_ge_i32 s14, s30
  s_cbranch_scc1 T_kv_40
  s_branch T_kvb_33
T_slow_35:
  s_nop 7
  v_max3_f32 v100, v16, v17, v18
  v_max3_f32 v100, v100, v19, v20
  v_max3_f32 v100, v100, v21, v22
  v_max3_f32 v100, v100, v23, v112
  v_max3_f32 v100, v100, v113, v114
  v_max_f32 v100, v100, v115
  v_mov_b32 v101, v100
  s_nop 1
  v_permlane32_swap_b32 v100, v101
  s_nop 1
  v_max_f32 v100, v100, v101
  v_mov_b32 v101, v100
  s_nop 1
  v_permlane16_swap_b32 v100, v101
  s_nop 1
  v_max_f32 v100, v100, v101
  v_sub_f32 v16, v16, v100
  v_sub_f32 v17, v17, v100
  v_sub_f32 v18, v18, v100
  v_sub_f32 v19, v19, v100
  v_exp_f32 v16, v16
  v_exp_f32 v17, v17
  v_exp_f32 v18, v18
  v_exp_f32 v19, v19
  v_sub_f32 v20, v20, v100
  v_sub_f32 v21, v21, v100
  v_sub_f32 v22, v22, v100
  v_sub_f32 v23, v23, v100
  v_exp_f32 v20, v20
  v_exp_f32 v21, v21
  v_exp_f32 v22, v22
  v_exp_f32 v23, v23
  v_sub_f32 v112, v112, v100
  v_sub_f32 v113, v113, v100
  v_sub_f32 v114, v114, v100
  v_sub_f32 v115, v115, v100
  v_exp_f32 v112, v112
  v_exp_f32 v113, v113
  v_exp_f32 v114, v114
  v_exp_f32 v115, v115
  s_nop 0
  v_cvt_pk_bf16_f32 v44, v16, v17
  v_cvt_pk_bf16_f32 v45, v18, v19
  v_cvt_pk_bf16_f32 v46, v20, v21
  v_cvt_pk_bf16_f32 v47, v22, v23
  v_cvt_pk_bf16_f32 v84, v112, v113
  v_cvt_pk_bf16_f32 v85, v114, v115
  v_cndmask_b32 v48, v84, 0, s[16:17]
  v_cndmask_b32 v49, v85, 0, s[16:17]
  v_cndmask_b32 v50, 0, v84, s[16:17]
  v_cndmask_b32 v51, 0, v85, s[16:17]
  s_nop 1
  v_mfma_f32_16x16x16_bf16 v[88:91], v[12:13], v[48:49], 0
  v_mfma_f32_16x16x16_bf16 v[24:27], v[120:121], v[48:49], 0
  v_mfma_f32_16x16x16_bf16 v[116:119], v[120:121], v[50:51], 0
  v_mfma_f32_16x16x32_bf16 v[88:91], v[12:15], v[44:47], v[88:91]
  v_mfma_f32_16x16x32_bf16 v[24:27], v[28:31], v[44:47], v[24:27]
  v_mfma_f32_16x16x32_bf16 v[116:119], v[32:35], v[44:47], v[116:119]
  s_nop 7
  s_nop 1
  s_mov_b32 s96, -1
  s_branch T_back_36
T_w_12:
  s_mov_b32 s19, 0
  s_add_u32 s14, s14, 1
  s_and_b32 s57, s14, 1
  v_mov_b64 v[16:17], 0
  v_mov_b64 v[18:19], 0
  v_mov_b64 v[20:21], 0
  v_mov_b64 v[22:23], 0
  v_mov_b64 v[24:25], 0
  v_mov_b64 v[26:27], 0
  buffer_load_dwordx4 v[124:127], v2, s[4:7], s24 offen offset:2048 sc1
  buffer_load_dwordx4 v[116:119], v2, s[4:7], s25 offen offset:2048 sc1
  buffer_load_dwordx4 v[124:127], v2, s[4:7], s24 offen offset:2048 sc1
  buffer_load_dwordx4 v[116:119], v2, s[4:7], s25 offen offset:2048 sc1
  s_branch T_loop_42
.p2align 6
T_retry_43:
  s_mov_b64 exec, vcc
  buffer_load_dwordx4 v[124:127], v2, s[4:7], s24 offen offset:2048 sc1
  buffer_load_dwordx4 v[116:119], v2, s[4:7], s25 offen offset:2048 sc1
  s_mov_b64 exec, -1
  s_add_u32 s19, s19, 1
  s_cmp_gt_u32 s19, 32768
  s_cbranch_scc1 M_exit
  s_nop 0
  v_mov_b64 v[16:17], 0
  v_mov_b64 v[18:19], 0
T_loop_42:
  s_waitcnt vmcnt(3) lgkmcnt(0)
  v_max3_u32 v123, v124, v125, v126
  v_max_u32 v123, v123, v127
  v_mov_b32_dpp v120, v124 row_ror:8 row_mask:0xf bank_mask:0xf
  v_mov_b32_dpp v121, v125 row_ror:8 row_mask:0xf bank_mask:0xf
  s_waitcnt vmcnt(2)
  v_max3_u32 v123, v123, v116, v117
  v_max3_u32 v123, v123, v118, v119
  v_cmp_eq_u32 vcc, -1, v123
  v_smfmac_f32_16x16x64_bf16 v[16:19], v[124:127], v[68:75], v0
  s_cbranch_vccnz T_retry_43
  ds_write_b128 v2, v[124:127] offset:2048
  v_mov_b32_dpp v122, v126 row_ror:8 row_mask:0xf bank_mask:0xf
  v_smfmac_f32_16x16x64_bf16 v[20:23], v[124:127], v[76:83], v0
  s_and_b32 s57, s14, 1
  v_mov_b32_dpp v123, v127 row_ror:8 row_mask:0xf bank_mask:0xf
  v_smfmac_f32_16x16x64_bf16 v[24:27], v[124:127], v[84:91], v0
  s_and_b32 s36, s14, 3
  ds_write_b128 v2, v[116:119] offset:6144
  v_smfmac_f32_16x16x64_bf16 v[16:19], v[120:123], v[92:99], v0
  s_lshl_b32 s36, s36, 13
  v_mov_b32_dpp v84, v116 row_ror:8 row_mask:0xf bank_mask:0xf
  v_smfmac_f32_16x16x64_bf16 v[20:23], v[120:123], v[100:107], v0
  s_add_u32 s26, s36, s23
  ds_read_b128 v[68:71], v4 offset:12288
  v_mov_b32_dpp v85, v117 row_ror:8 row_mask:0xf bank_mask:0xf
  v_smfmac_f32_16x16x64_bf16 v[24:27], v[120:123], v[108:115], v0
  s_add_u32 s36, s36, 8192
  ds_read_b128 v[72:75], v4 offset:13312
  v_mov_b32_dpp v86, v118 row_ror:8 row_mask:0xf bank_mask:0xf
  v_smfmac_f32_16x16x64_bf16 v[16:19], v[116:119], v[224:231], v0
  s_and_b32 s36, s36, 0x7fff
  ds_read_b128 v[76:79], v4 offset:14336
  v_mov_b32_dpp v87, v119 row_ror:8 row_mask:0xf bank_mask:0xf
  v_smfmac_f32_16x16x64_bf16 v[20:23], v[116:119], v[240:247], v0
  s_waitcnt lgkmcnt(3)
  s_barrier
  ds_read_b128 v[100:103], v2 offset:3072
  v_smfmac_f32_16x16x64_bf16 v[24:27], v[116:119], a[0:7], v0
  s_mov_b32 m0, s31
  ds_read_b128 v[120:123], v1 offset:3072
  v_smfmac_f32_16x16x64_bf16 v[16:19], v[84:87], v[232:239], v0
  v_smfmac_f32_16x16x64_bf16 v[20:23], v[84:87], v[248:255], v0
  ds_read_b128 v[80:83], v4 offset:15360
  buffer_load_dwordx4 v9, s[4:7], s27 offen sc1 lds
  v_smfmac_f32_16x16x64_bf16 v[24:27], v[84:87], a[8:15], v0
  s_waitcnt lgkmcnt(2)
  s_mov_b32 m0, s32
  v_smfmac_f32_16x16x64_bf16 v[16:19], v[100:103], v[128:135], v0
  ds_read_b128 v[92:95], v2 offset:0
  v_smfmac_f32_16x16x64_bf16 v[20:23], v[100:103], v[144:151], v0
  ds_read_b128 v[96:99], v1 offset:0
  v_smfmac_f32_16x16x64_bf16 v[24:27], v[100:103], v[68:75], v0
  s_waitcnt vmcnt(1) lgkmcnt(3)
  ds_read_b128 v[116:119], v2 offset:1024
  buffer_load_dwordx4 v9, s[4:7], s27 offen offset:128 sc1 lds
  v_smfmac_f32_16x16x64_bf16 v[16:19], v[120:123], v[136:143], v0
  ds_read_b128 v[124:127], v1 offset:1024
  s_mov_b32 m0, s33
  v_smfmac_f32_16x16x64_bf16 v[20:23], v[120:123], v[152:159], v0
  s_waitcnt lgkmcnt(4)
  ds_read_b128 v[104:107], v2 offset:7168
  v_smfmac_f32_16x16x64_bf16 v[24:27], v[120:123], v[76:83], v0
  s_waitcnt lgkmcnt(4)
  ds_read_b128 v[108:111], v1 offset:7168
  v_smfmac_f32_16x16x64_bf16 v[16:19], v[92:95], v[160:167], v0
  s_waitcnt lgkmcnt(4)
  ds_read_b128 v[112:115], v2 offset:4096
  v_mov_b32 v122, s98
  buffer_load_dwordx4 v10, s[4:7], s28 offen sc1 lds
  v_smfmac_f32_16x16x64_bf16 v[16:19], v[96:99], v[168:175], v0
  s_waitcnt lgkmcnt(4)
  ds_read_b128 v[84:87], v1 offset:4096
  s_mov_b32 m0, s34
  v_smfmac_f32_16x16x64_bf16 v[16:19], v[116:119], v[192:199], v0
  s_waitcnt lgkmcnt(4)
  ds_read_b128 v[88:91], v2 offset:5120
  v_smfmac_f32_16x16x64_bf16 v[16:19], v[124:127], v[200:207], v0
  s_waitcnt lgkmcnt(4)
  ds_read_b128 v[100:103], v1 offset:5120
  v_smfmac_f32_16x16x64_bf16 v[16:19], v[104:107], a[16:23], v0
  s_waitcnt lgkmcnt(4)
  ds_read_b128 v[68:71], v4 offset:16384
  buffer_load_dwordx4 v10, s[4:7], s28 offen offset:256 sc1 lds
  v_smfmac_f32_16x16x64_bf16 v[16:19], v[108:111], a[24:31], v0
  s_waitcnt lgkmcnt(4)
  ds_read_b128 v[72:75], v4 offset:17408
  v_smfmac_f32_16x16x64_bf16 v[16:19], v[112:115], a[64:71], v0
  s_waitcnt lgkmcnt(4)
  ds_read_b128 v[76:79], v4 offset:18432
  v_smfmac_f32_16x16x64_bf16 v[16:19], v[84:87], a[72:79], v0
  s_waitcnt lgkmcnt(4)
  ds_read_b128 v[80:83], v4 offset:19456
  v_smfmac_f32_16x16x64_bf16 v[16:19], v[88:91], a[112:119], v0
  s_waitcnt lgkmcnt(4)
  buffer_store_dword v122, v3, s[4:7], s15 offen sc1
  v_smfmac_f32_16x16x64_bf16 v[16:19], v[100:103], a[120:127], v0
  s_add_u32 s98, s14, 1
  s_add_u32 s24, s36, 145752064
  s_add_u32 s25, s36, 145756160
  v_smfmac_f32_16x16x64_bf16 v[20:23], v[92:95], v[176:183], v0
  s_add_u32 s35, s36, s23
  v_smfmac_f32_16x16x64_bf16 v[20:23], v[96:99], v[184:191], v0
  s_waitcnt lgkmcnt(2)
  v_smfmac_f32_16x16x64_bf16 v[20:23], v[116:119], v[68:75], v0
  s_waitcnt lgkmcnt(0)
  ds_read_b128 v[68:71], v4 offset:20480
  v_mul_f32 v16, s18, v16
  v_smfmac_f32_16x16x64_bf16 v[20:23], v[124:127], v[76:83], v0
  ds_read_b128 v[72:75], v4 offset:21504
  v_mul_f32 v17, s18, v17
  v_smfmac_f32_16x16x64_bf16 v[20:23], v[104:107], a[32:39], v0
  ds_read_b128 v[76:79], v4 offset:22528
  v_mul_f32 v18, s18, v18
  v_smfmac_f32_16x16x64_bf16 v[20:23], v[108:111], a[40:47], v0
  ds_read_b128 v[80:83], v4 offset:23552
  v_mul_f32 v19, s18, v19
  v_smfmac_f32_16x16x64_bf16 v[20:23], v[112:115], a[80:87], v0
  v_cvt_pk_bf16_f32 v120, v16, v17
  v_smfmac_f32_16x16x64_bf16 v[20:23], v[84:87], a[88:95], v0
  v_cvt_pk_bf16_f32 v121, v18, v19
  v_smfmac_f32_16x16x64_bf16 v[20:23], v[88:91], a[128:135], v0
  ds_write_b64 v5, v[120:121] offset:24576
  v_smfmac_f32_16x16x64_bf16 v[20:23], v[100:103], a[136:143], v0
  s_waitcnt lgkmcnt(3)
  v_smfmac_f32_16x16x64_bf16 v[24:27], v[92:95], v[68:75], v0
  s_waitcnt lgkmcnt(1)
  v_mov_b64 v[92:93], 0
  v_smfmac_f32_16x16x64_bf16 v[24:27], v[96:99], v[76:83], v0
  s_nop 1
  v_cvt_pk_bf16_f32 v122, v20, v21
  v_cvt_pk_bf16_f32 v123, v22, v23
  v_smfmac_f32_16x16x64_bf16 v[24:27], v[116:119], v[208:215], v0
  ds_write_b64 v5, v[122:123] offset:26880
  v_mov_b64 v[94:95], 0
  v_smfmac_f32_16x16x64_bf16 v[24:27], v[124:127], v[216:223], v0
  s_waitcnt lgkmcnt(1)
  s_barrier
  ds_read_b64_tr_b16 v[68:69], v6 offset:24576
  v_smfmac_f32_16x16x64_bf16 v[24:27], v[104:107], a[48:55], v0
  s_add_u32 s27, s27, 8192
  ds_read_b64_tr_b16 v[70:71], v6 offset:24640
  ds_read_b64_tr_b16 v[72:73], v6 offset:24832
  v_smfmac_f32_16x16x64_bf16 v[24:27], v[108:111], a[56:63], v0
  s_add_u32 s28, s28, 8192
  ds_read_b64_tr_b16 v[74:75], v6 offset:24896
  ds_read_b64_tr_b16 v[76:77], v6 offset:25088
  v_smfmac_f32_16x16x64_bf16 v[24:27], v[112:115], a[96:103], v0
  s_nop 0
  ds_read_b64_tr_b16 v[78:79], v6 offset:25152
  ds_read_b64_tr_b16 v[80:81], v6 offset:25344
  v_smfmac_f32_16x16x64_bf16 v[24:27], v[84:87], a[104:111], v0
  ds_read_b64_tr_b16 v[82:83], v6 offset:25408
  v_mov_b64 v[96:97], 0
  v_smfmac_f32_16x16x64_bf16 v[24:27], v[88:91], a[144:151], v0
  s_waitcnt lgkmcnt(8)
  s_barrier
  ds_read_b64_tr_b16 v[116:117], v6 offset:26880
  v_smfmac_f32_16x16x64_bf16 v[24:27], v[100:103], a[152:159], v0
  s_waitcnt lgkmcnt(7)
  ds_read_b64_tr_b16 v[118:119], v6 offset:26944
  v_mfma_f32_16x16x32_bf16 v[16:19], v[36:39], v[68:71], 0
  s_waitcnt lgkmcnt(6)
  ds_read_b64_tr_b16 v[124:125], v6 offset:27136
  ds_read_b64_tr_b16 v[126:127], v6 offset:27200
  v_mfma_f32_16x16x32_bf16 v[16:19], v[40:43], v[72:75], v[16:19]
  s_waitcnt lgkmcnt(6)
  ds_read_b64_tr_b16 v[104:105], v6 offset:27392
  ds_read_b64_tr_b16 v[106:107], v6 offset:27456
  v_mfma_f32_16x16x32_bf16 v[16:19], v[44:47], v[76:79], v[16:19]
  s_waitcnt lgkmcnt(6)
  ds_read_b64_tr_b16 v[108:109], v6 offset:27648
  ds_read_b64_tr_b16 v[110:111], v6 offset:27712
  v_mfma_f32_16x16x32_bf16 v[16:19], v[48:51], v[80:83], v[16:19]
  s_waitcnt lgkmcnt(6)
  v_cvt_pk_bf16_f32 v120, v24, v25
  v_cvt_pk_bf16_f32 v121, v26, v27
  v_mfma_f32_16x16x32_bf16 v[112:115], v[116:119], v[68:71], 0
  s_waitcnt lgkmcnt(4)
  v_mov_b64 v[98:99], 0
  v_mfma_f32_16x16x32_bf16 v[112:115], v[124:127], v[72:75], v[112:115]
  s_waitcnt lgkmcnt(2)
  v_mov_b64 v[36:37], 0
  v_exp_f32 v100, v16
  v_mfma_f32_16x16x32_bf16 v[112:115], v[104:107], v[76:79], v[112:115]
  s_waitcnt lgkmcnt(0)
  buffer_store_dwordx4 v[120:123], v2, s[4:7], s29 offen offset:2048 sc1
  v_exp_f32 v101, v17
  v_mfma_f32_16x16x32_bf16 v[112:115], v[108:111], v[80:83], v[112:115]
  v_exp_f32 v102, v18
  v_mfma_f32_16x16x32_bf16 v[20:23], v[52:55], v[68:71], 0
  v_exp_f32 v103, v19
  v_mfma_f32_16x16x32_bf16 v[20:23], v[56:59], v[72:75], v[20:23]
  v_cvt_pk_bf16_f32 v44, v100, v101
  v_cvt_pk_bf16_f32 v45, v102, v103
  v_mfma_f32_16x16x32_bf16 v[20:23], v[60:63], v[76:79], v[20:23]
  s_add_u32 s29, s29, 131072
  v_exp_f32 v100, v112
  v_mfma_f32_16x16x32_bf16 v[20:23], v[64:67], v[80:83], v[20:23]
  v_exp_f32 v101, v113
  v_exp_f32 v102, v114
  v_exp_f32 v103, v115
  v_cvt_pk_bf16_f32 v84, v100, v101
  v_cvt_pk_bf16_f32 v85, v102, v103
  v_cndmask_b32 v48, v84, 0, s[16:17]
  v_cndmask_b32 v49, v85, 0, s[16:17]
  v_cndmask_b32 v50, 0, v84, s[16:17]
  v_cndmask_b32 v51, 0, v85, s[16:17]
  v_exp_f32 v100, v20
  v_mfma_f32_16x16x16_bf16 v[88:91], v[12:13], v[48:49], 0
  v_exp_f32 v101, v21
  v_mfma_f32_16x16x16_bf16 v[24:27], v[120:121], v[48:49], 0
  v_exp_f32 v102, v22
  v_mfma_f32_16x16x16_bf16 v[116:119], v[120:121], v[50:51], 0
  v_exp_f32 v103, v23
  v_cvt_pk_bf16_f32 v46, v100, v101
  v_cvt_pk_bf16_f32 v47, v102, v103
  v_mov_b64 v[38:39], 0
  s_nop 0
  v_mfma_f32_16x16x32_bf16 v[88:91], v[12:15], v[44:47], v[88:91]
  v_mov_b64 v[40:41], 0
  v_mov_b64 v[42:43], 0
  v_mfma_f32_16x16x32_bf16 v[24:27], v[28:31], v[44:47], v[24:27]
  ds_read_b128 v[52:55], v4 offset:24576
  ds_read_b128 v[56:59], v4 offset:25600
  v_mfma_f32_16x16x32_bf16 v[116:119], v[32:35], v[44:47], v[116:119]
  s_nop 1
T_back_50:
  v_rcp_f32 v89, v88
  v_subrev_u32 v100, s54, v88
  v_cmp_le_u32 vcc, s96, v100
  v_mul_f32 v24, v89, v24
  v_mul_f32 v25, v89, v25
  v_cvt_pk_bf16_f32 v124, v24, v25
  v_pk_mul_f32 v[26:27], v[26:27], v[88:89] op_sel:[0,1] op_sel_hi:[1,1]
  v_pk_mul_f32 v[116:117], v[116:117], v[88:89] op_sel:[0,1] op_sel_hi:[1,1]
  v_pk_mul_f32 v[118:119], v[118:119], v[88:89] op_sel:[0,1] op_sel_hi:[1,1]
  v_cvt_pk_bf16_f32 v125, v26, v27
  v_cvt_pk_bf16_f32 v126, v116, v117
  v_cvt_pk_bf16_f32 v127, v118, v119
  ds_write_b128 v11, v[124:127] offset:30208
  s_cbranch_vccnz T_slow_49
  v_smfmac_f32_16x16x64_bf16 v[92:95], v[124:127], a[160:167], v0
  s_mov_b32 s96, s55
  v_smfmac_f32_16x16x64_bf16 v[96:99], v[124:127], a[168:175], v0
  s_cmp_eq_u32 s14, 63
  v_smfmac_f32_16x16x64_bf16 v[36:39], v[124:127], a[176:183], v0
  s_waitcnt lgkmcnt(0)
  s_barrier
  ds_read_b128 v[104:107], v11 offset:30720
  ds_read_b128 v[108:111], v11 offset:29184
  ds_read_b128 v[68:71], v11 offset:29696
  s_cbranch_scc1 M_tdone
  v_smfmac_f32_16x16x64_bf16 v[40:43], v[124:127], a[184:191], v0
  s_waitcnt lgkmcnt(2)
  v_smfmac_f32_16x16x64_bf16 v[92:95], v[104:107], a[192:199], v0
  s_waitcnt lgkmcnt(1)
  ds_read_b128 v[76:79], v4 offset:28672
  v_smfmac_f32_16x16x64_bf16 v[92:95], v[108:111], a[224:231], v0
  s_waitcnt lgkmcnt(1)
  ds_read_b128 v[80:83], v4 offset:29696
  v_smfmac_f32_16x16x64_bf16 v[92:95], v[68:71], a[240:247], v0
  ds_read_b128 v[60:63], v4 offset:26624
  v_smfmac_f32_16x16x64_bf16 v[96:99], v[104:107], a[200:207], v0
  ds_read_b128 v[64:67], v4 offset:27648
  v_smfmac_f32_16x16x64_bf16 v[96:99], v[108:111], a[232:239], v0
  ds_read_b128 v[28:31], v4 offset:30720
  s_nop 0
  v_cvt_pk_bf16_f32 v16, v92, v93
  v_cvt_pk_bf16_f32 v17, v94, v95
  v_bfi_b32 v16, 1, s57, v16
  v_smfmac_f32_16x16x64_bf16 v[96:99], v[68:71], a[248:255], v0
  buffer_store_dwordx2 v[16:17], v7, s[4:7], s20 offen offset:0
  v_smfmac_f32_16x16x64_bf16 v[36:39], v[104:107], a[208:215], v0
  ds_read_b128 v[32:35], v4 offset:31744
  v_smfmac_f32_16x16x64_bf16 v[36:39], v[108:111], v[52:59], v0
  s_waitcnt lgkmcnt(4)
  s_nop 0
  v_cvt_pk_bf16_f32 v18, v96, v97
  v_cvt_pk_bf16_f32 v19, v98, v99
  v_bfi_b32 v18, 1, s57, v18
  v_smfmac_f32_16x16x64_bf16 v[36:39], v[68:71], v[76:83], v0
  buffer_store_dwordx2 v[18:19], v7, s[4:7], s20 offen offset:64
  v_smfmac_f32_16x16x64_bf16 v[40:43], v[104:107], a[216:223], v0
  s_waitcnt lgkmcnt(2)
  v_smfmac_f32_16x16x64_bf16 v[40:43], v[108:111], v[60:67], v0
  s_waitcnt lgkmcnt(0)
  s_nop 0
  v_cvt_pk_bf16_f32 v20, v36, v37
  v_cvt_pk_bf16_f32 v21, v38, v39
  v_bfi_b32 v20, 1, s57, v20
  v_smfmac_f32_16x16x64_bf16 v[40:43], v[68:71], v[28:35], v0
  buffer_store_dwordx2 v[20:21], v7, s[4:7], s21 offen offset:0
  s_nop 6
  v_cvt_pk_bf16_f32 v22, v40, v41
  v_cvt_pk_bf16_f32 v23, v42, v43
  v_bfi_b32 v22, 1, s57, v22
  buffer_store_dwordx2 v[22:23], v7, s[4:7], s21 offen offset:64
  ds_read_b128 v[68:71], v4 offset:0
  ds_read_b128 v[72:75], v4 offset:1024
  ds_read_b128 v[76:79], v4 offset:4096
  ds_read_b128 v[80:83], v4 offset:5120
  ds_read_b128 v[84:87], v4 offset:8192
  ds_read_b128 v[88:91], v4 offset:9216
  ds_read_b128 v[92:95], v4 offset:2048
  ds_read_b128 v[96:99], v4 offset:3072
  ds_read_b128 v[100:103], v4 offset:6144
  ds_read_b128 v[104:107], v4 offset:7168
  ds_read_b128 v[108:111], v4 offset:10240
  ds_read_b128 v[112:115], v4 offset:11264
  v_mov_b64 v[16:17], 0
  v_mov_b64 v[18:19], 0
  v_mov_b64 v[20:21], 0
  v_mov_b64 v[22:23], 0
  v_mov_b64 v[24:25], 0
  v_mov_b64 v[26:27], 0
  ds_read_b64 v[44:45], v2 offset:32256
  s_waitcnt lgkmcnt(0)
  v_readfirstlane_b32 s38, v44
  v_readfirstlane_b32 s37, v45
  s_nop 0
  s_lshl_b32 s38, s38, 1
  s_lshl1_add_u32 s37, s37, 1
  s_min_u32 s38, s38, s37
  s_cmp_ge_u32 s38, 64
  s_cselect_b32 s38, 100, s38
  s_sub_u32 s38, s38, 1
  s_max_i32 s30, s30, s38
  s_waitcnt vmcnt(4)
  s_barrier
  ds_read_b128 v[28:31], v2 offset:18432
  ds_read_b128 v[32:35], v2 offset:22528
  ds_read_b128 v[36:39], v2 offset:8192
  ds_read_b128 v[40:43], v2 offset:9216
  ds_read_b128 v[44:47], v2 offset:10240
  ds_read_b128 v[48:51], v2 offset:11264
  buffer_load_dwordx4 v[124:127], v2, s[4:7], s24 offen offset:2048 sc1
  buffer_load_dwordx4 v[116:119], v2, s[4:7], s25 offen offset:2048 sc1
  ds_read_b128 v[52:55], v2 offset:12288
  ds_read_b128 v[56:59], v2 offset:13312
  ds_read_b128 v[60:63], v2 offset:14336
  ds_read_b128 v[64:67], v2 offset:15360
  buffer_load_dwordx4 v[124:127], v2, s[4:7], s24 offen offset:2048 sc1
  buffer_load_dwordx4 v[116:119], v2, s[4:7], s25 offen offset:2048 sc1
  s_add_u32 s14, s14, 1
  s_cmp_ge_i32 s14, s30
  s_cbranch_scc1 T_kvw_46
T_kvb_47:
  s_mov_b32 s19, 0
  s_branch T_loop_42
T_kvw_46:
  s_mov_b32 s19, 0
  s_branch T_kvok_55
T_kv_54:
  s_sleep 4
  s_add_u32 s19, s19, 1
  s_cmp_gt_u32 s19, 32768
  s_cbranch_scc1 M_exit
T_kvok_55:
  s_add_u32 s39, s99, 128
  s_mov_b32 s38, 0
  s_mov_b32 s37, 0
  s_atomic_or s38, s[58:59], s99 glc
  s_atomic_or s37, s[58:59], s39 glc
  s_waitcnt lgkmcnt(0)
  s_lshl_b32 s38, s38, 1
  s_lshl1_add_u32 s37, s37, 1
  s_min_u32 s38, s38, s37
  s_cmp_ge_u32 s38, 64
  s_cselect_b32 s38, 100, s38
  s_sub_u32 s38, s38, 1
  s_max_i32 s30, s30, s38
  s_cmp_ge_i32 s14, s30
  s_cbranch_scc1 T_kv_54
  s_branch T_kvb_47
T_slow_49:
  s_nop 7
  v_max3_f32 v100, v16, v17, v18
  v_max3_f32 v100, v100, v19, v20
  v_max3_f32 v100, v100, v21, v22
  v_max3_f32 v100, v100, v23, v112
  v_max3_f32 v100, v100, v113, v114
  v_max_f32 v100, v100, v115
  v_mov_b32 v101, v100
  s_nop 1
  v_permlane32_swap_b32 v100, v101
  s_nop 1
  v_max_f32 v100, v100, v101
  v_mov_b32 v101, v100
  s_nop 1
  v_permlane16_swap_b32 v100, v101
  s_nop 1
  v_max_f32 v100, v100, v101
  v_sub_f32 v16, v16, v100
  v_sub_f32 v17, v17, v100
  v_sub_f32 v18, v18, v100
  v_sub_f32 v19, v19, v100
  v_exp_f32 v16, v16
  v_exp_f32 v17, v17
  v_exp_f32 v18, v18
  v_exp_f32 v19, v19
  v_sub_f32 v20, v20, v100
  v_sub_f32 v21, v21, v100
  v_sub_f32 v22, v22, v100
  v_sub_f32 v23, v23, v100
  v_exp_f32 v20, v20
  v_exp_f32 v21, v21
  v_exp_f32 v22, v22
  v_exp_f32 v23, v23
  v_sub_f32 v112, v112, v100
  v_sub_f32 v113, v113, v100
  v_sub_f32 v114, v114, v100
  v_sub_f32 v115, v115, v100
  v_exp_f32 v112, v112
  v_exp_f32 v113, v113
  v_exp_f32 v114, v114
  v_exp_f32 v115, v115
  s_nop 0
  v_cvt_pk_bf16_f32 v44, v16, v17
  v_cvt_pk_bf16_f32 v45, v18, v19
  v_cvt_pk_bf16_f32 v46, v20, v21
  v_cvt_pk_bf16_f32 v47, v22, v23
  v_cvt_pk_bf16_f32 v84, v112, v113
  v_cvt_pk_bf16_f32 v85, v114, v115
  v_cndmask_b32 v48, v84, 0, s[16:17]
  v_cndmask_b32 v49, v85, 0, s[16:17]
  v_cndmask_b32 v50, 0, v84, s[16:17]
  v_cndmask_b32 v51, 0, v85, s[16:17]
  s_nop 1
  v_mfma_f32_16x16x16_bf16 v[88:91], v[12:13], v[48:49], 0
  v_mfma_f32_16x16x16_bf16 v[24:27], v[120:121], v[48:49], 0
  v_mfma_f32_16x16x16_bf16 v[116:119], v[120:121], v[50:51], 0
  v_mfma_f32_16x16x32_bf16 v[88:91], v[12:15], v[44:47], v[88:91]
  v_mfma_f32_16x16x32_bf16 v[24:27], v[28:31], v[44:47], v[24:27]
  v_mfma_f32_16x16x32_bf16 v[116:119], v[32:35], v[44:47], v[116:119]
  s_nop 7
  s_nop 1
  s_mov_b32 s96, -1
  s_branch T_back_50
T_w_13:
  s_mov_b32 s19, 0
  s_add_u32 s14, s14, 1
  s_and_b32 s57, s14, 1
  v_mov_b64 v[16:17], 0
  v_mov_b64 v[18:19], 0
  v_mov_b64 v[20:21], 0
  v_mov_b64 v[22:23], 0
  v_mov_b64 v[24:25], 0
  v_mov_b64 v[26:27], 0
  buffer_load_dwordx4 v[124:127], v2, s[4:7], s24 offen offset:3072 sc1
  buffer_load_dwordx4 v[116:119], v2, s[4:7], s25 offen offset:3072 sc1
  buffer_load_dwordx4 v[124:127], v2, s[4:7], s24 offen offset:3072 sc1
  buffer_load_dwordx4 v[116:119], v2, s[4:7], s25 offen offset:3072 sc1
  s_branch T_loop_56
.p2align 6
T_retry_57:
  s_mov_b64 exec, vcc
  buffer_load_dwordx4 v[124:127], v2, s[4:7], s24 offen offset:3072 sc1
  buffer_load_dwordx4 v[116:119], v2, s[4:7], s25 offen offset:3072 sc1
  s_mov_b64 exec, -1
  s_add_u32 s19, s19, 1
  s_cmp_gt_u32 s19, 32768
  s_cbranch_scc1 M_exit
  s_nop 0
  v_mov_b64 v[16:17], 0
  v_mov_b64 v[18:19], 0
T_loop_56:
  s_waitcnt vmcnt(3) lgkmcnt(0)
  v_max3_u32 v123, v124, v125, v126
  v_max_u32 v123, v123, v127
  v_mov_b32_dpp v120, v124 row_ror:8 row_mask:0xf bank_mask:0xf
  v_mov_b32_dpp v121, v125 row_ror:8 row_mask:0xf bank_mask:0xf
  s_waitcnt vmcnt(2)
  v_max3_u32 v123, v123, v116, v117
  v_max3_u32 v123, v123, v118, v119
  v_cmp_eq_u32 vcc, -1, v123
  v_smfmac_f32_16x16x64_bf16 v[16:19], v[124:127], v[68:75], v0
  s_cbranch_vccnz T_retry_57
  ds_write_b128 v2, v[124:127] offset:3072
  v_mov_b32_dpp v122, v126 row_ror:8 row_mask:0xf bank_mask:0xf
  v_smfmac_f32_16x16x64_bf16 v[20:23], v[124:127], v[76:83], v0
  s_and_b32 s57, s14, 1
  v_mov_b32_dpp v123, v127 row_ror:8 row_mask:0xf bank_mask:0xf
  v_smfmac_f32_16x16x64_bf16 v[24:27], v[124:127], v[84:91], v0
  s_and_b32 s36, s14, 3
  ds_write_b128 v2, v[116:119] offset:7168
  v_smfmac_f32_16x16x64_bf16 v[16:19], v[120:123], v[92:99], v0
  s_lshl_b32 s36, s36, 13
  v_mov_b32_dpp v84, v116 row_ror:8 row_mask:0xf bank_mask:0xf
  v_smfmac_f32_16x16x64_bf16 v[20:23], v[120:123], v[100:107], v0
  s_add_u32 s26, s36, s23
  ds_read_b128 v[68:71], v4 offset:12288
  v_mov_b32_dpp v85, v117 row_ror:8 row_mask:0xf bank_mask:0xf
  v_smfmac_f32_16x16x64_bf16 v[24:27], v[120:123], v[108:115], v0
  s_add_u32 s36, s36, 8192
  ds_read_b128 v[72:75], v4 offset:13312
  v_mov_b32_dpp v86, v118 row_ror:8 row_mask:0xf bank_mask:0xf
  v_smfmac_f32_16x16x64_bf16 v[16:19], v[116:119], v[224:231], v0
  s_and_b32 s36, s36, 0x7fff
  ds_read_b128 v[76:79], v4 offset:14336
  v_mov_b32_dpp v87, v119 row_ror:8 row_mask:0xf bank_mask:0xf
  v_smfmac_f32_16x16x64_bf16 v[20:23], v[116:119], v[240:247], v0
  s_waitcnt lgkmcnt(3)
  s_barrier
  ds_read_b128 v[100:103], v2 offset:2048
  v_smfmac_f32_16x16x64_bf16 v[24:27], v[116:119], a[0:7], v0
  s_mov_b32 m0, s31
  ds_read_b128 v[120:123], v1 offset:2048
  v_smfmac_f32_16x16x64_bf16 v[16:19], v[84:87], v[232:239], v0
  v_smfmac_f32_16x16x64_bf16 v[20:23], v[84:87], v[248:255], v0
  ds_read_b128 v[80:83], v4 offset:15360
  v_smfmac_f32_16x16x64_bf16 v[24:27], v[84:87], a[8:15], v0
  s_waitcnt lgkmcnt(2)
  buffer_load_dwordx4 v9, s[4:7], s27 offen sc1 lds
  v_smfmac_f32_16x16x64_bf16 v[16:19], v[100:103], v[128:135], v0
  ds_read_b128 v[92:95], v2 offset:1024
  s_mov_b32 m0, s32
  v_smfmac_f32_16x16x64_bf16 v[20:23], v[100:103], v[144:151], v0
  ds_read_b128 v[96:99], v1 offset:1024
  v_smfmac_f32_16x16x64_bf16 v[24:27], v[100:103], v[68:75], v0
  s_waitcnt vmcnt(1) lgkmcnt(3)
  ds_read_b128 v[116:119], v2 offset:0
  v_smfmac_f32_16x16x64_bf16 v[16:19], v[120:123], v[136:143], v0
  ds_read_b128 v[124:127], v1 offset:0
  buffer_load_dwordx4 v9, s[4:7], s27 offen offset:128 sc1 lds
  v_smfmac_f32_16x16x64_bf16 v[20:23], v[120:123], v[152:159], v0
  s_waitcnt lgkmcnt(4)
  ds_read_b128 v[104:107], v2 offset:6144
  s_mov_b32 m0, s33
  v_smfmac_f32_16x16x64_bf16 v[24:27], v[120:123], v[76:83], v0
  s_waitcnt lgkmcnt(4)
  ds_read_b128 v[108:111], v1 offset:6144
  v_smfmac_f32_16x16x64_bf16 v[16:19], v[92:95], v[160:167], v0
  s_waitcnt lgkmcnt(4)
  ds_read_b128 v[112:115], v2 offset:5120
  v_smfmac_f32_16x16x64_bf16 v[16:19], v[96:99], v[168:175], v0
  s_waitcnt lgkmcnt(4)
  ds_read_b128 v[84:87], v1 offset:5120
  buffer_load_dwordx4 v10, s[4:7], s28 offen sc1 lds
  v_smfmac_f32_16x16x64_bf16 v[16:19], v[116:119], v[192:199], v0
  s_waitcnt lgkmcnt(4)
  ds_read_b128 v[88:91], v2 offset:4096
  s_mov_b32 m0, s34
  v_smfmac_f32_16x16x64_bf16 v[16:19], v[124:127], v[200:207], v0
  s_waitcnt lgkmcnt(4)
  ds_read_b128 v[100:103], v1 offset:4096
  v_smfmac_f32_16x16x64_bf16 v[16:19], v[104:107], a[16:23], v0
  s_waitcnt lgkmcnt(4)
  ds_read_b128 v[68:71], v4 offset:16384
  v_smfmac_f32_16x16x64_bf16 v[16:19], v[108:111], a[24:31], v0
  s_waitcnt lgkmcnt(4)
  ds_read_b128 v[72:75], v4 offset:17408
  buffer_load_dwordx4 v10, s[4:7], s28 offen offset:256 sc1 lds
  v_smfmac_f32_16x16x64_bf16 v[16:19], v[112:115], a[64:71], v0
  s_waitcnt lgkmcnt(4)
  ds_read_b128 v[76:79], v4 offset:18432
  s_mov_b32 m0, 32256
  v_smfmac_f32_16x16x64_bf16 v[16:19], v[84:87], a[72:79], v0
  s_waitcnt lgkmcnt(4)
  ds_read_b128 v[80:83], v4 offset:19456
  v_smfmac_f32_16x16x64_bf16 v[16:19], v[88:91], a[112:119], v0
  s_waitcnt lgkmcnt(4)
  v_smfmac_f32_16x16x64_bf16 v[16:19], v[100:103], a[120:127], v0
  buffer_load_dword v3, s[4:7], s99 offen sc1 lds
  s_add_u32 s24, s36, 145752064
  s_add_u32 s25, s36, 145756160
  v_smfmac_f32_16x16x64_bf16 v[20:23], v[92:95], v[176:183], v0
  s_add_u32 s35, s36, s23
  v_smfmac_f32_16x16x64_bf16 v[20:23], v[96:99], v[184:191], v0
  s_waitcnt lgkmcnt(2)
  v_smfmac_f32_16x16x64_bf16 v[20:23], v[116:119], v[68:75], v0
  s_waitcnt lgkmcnt(0)
  ds_read_b128 v[68:71], v4 offset:20480
  v_mul_f32 v16, s18, v16
  v_smfmac_f32_16x16x64_bf16 v[20:23], v[124:127], v[76:83], v0
  ds_read_b128 v[72:75], v4 offset:21504
  v_mul_f32 v17, s18, v17
  v_smfmac_f32_16x16x64_bf16 v[20:23], v[104:107], a[32:39], v0
  ds_read_b128 v[76:79], v4 offset:22528
  v_mul_f32 v18, s18, v18
  v_smfmac_f32_16x16x64_bf16 v[20:23], v[108:111], a[40:47], v0
  ds_read_b128 v[80:83], v4 offset:23552
  v_mul_f32 v19, s18, v19
  v_smfmac_f32_16x16x64_bf16 v[20:23], v[112:115], a[80:87], v0
  v_cvt_pk_bf16_f32 v120, v16, v17
  v_smfmac_f32_16x16x64_bf16 v[20:23], v[84:87], a[88:95], v0
  v_cvt_pk_bf16_f32 v121, v18, v19
  v_smfmac_f32_16x16x64_bf16 v[20:23], v[88:91], a[128:135], v0
  ds_write_b64 v5, v[120:121] offset:24576
  v_smfmac_f32_16x16x64_bf16 v[20:23], v[100:103], a[136:143], v0
  s_waitcnt lgkmcnt(3)
  v_smfmac_f32_16x16x64_bf16 v[24:27], v[92:95], v[68:75], v0
  s_waitcnt lgkmcnt(1)
  v_mov_b64 v[92:93], 0
  v_smfmac_f32_16x16x64_bf16 v[24:27], v[96:99], v[76:83], v0
  s_nop 1
  v_cvt_pk_bf16_f32 v122, v20, v21
  v_cvt_pk_bf16_f32 v123, v22, v23
  v_smfmac_f32_16x16x64_bf16 v[24:27], v[116:119], v[208:215], v0
  ds_write_b64 v5, v[122:123] offset:26880
  v_mov_b64 v[94:95], 0
  v_smfmac_f32_16x16x64_bf16 v[24:27], v[124:127], v[216:223], v0
  s_waitcnt lgkmcnt(1)
  s_barrier
  ds_read_b64_tr_b16 v[68:69], v6 offset:24576
  v_smfmac_f32_16x16x64_bf16 v[24:27], v[104:107], a[48:55], v0
  s_add_u32 s27, s27, 8192
  ds_read_b64_tr_b16 v[70:71], v6 offset:24640
  ds_read_b64_tr_b16 v[72:73], v6 offset:24832
  v_smfmac_f32_16x16x64_bf16 v[24:27], v[108:111], a[56:63], v0
  s_add_u32 s28, s28, 8192
  ds_read_b64_tr_b16 v[74:75], v6 offset:24896
  ds_read_b64_tr_b16 v[76:77], v6 offset:25088
  v_smfmac_f32_16x16x64_bf16 v[24:27], v[112:115], a[96:103], v0
  s_nop 0
  ds_read_b64_tr_b16 v[78:79], v6 offset:25152
  ds_read_b64_tr_b16 v[80:81], v6 offset:25344
  v_smfmac_f32_16x16x64_bf16 v[24:27], v[84:87], a[104:111], v0
  ds_read_b64_tr_b16 v[82:83], v6 offset:25408
  v_mov_b64 v[96:97], 0
  v_smfmac_f32_16x16x64_bf16 v[24:27], v[88:91], a[144:151], v0
  s_waitcnt lgkmcnt(8)
  s_barrier
  ds_read_b64_tr_b16 v[116:117], v6 offset:26880
  v_smfmac_f32_16x16x64_bf16 v[24:27], v[100:103], a[152:159], v0
  s_waitcnt lgkmcnt(7)
  ds_read_b64_tr_b16 v[118:119], v6 offset:26944
  v_mfma_f32_16x16x32_bf16 v[16:19], v[36:39], v[68:71], 0
  s_waitcnt lgkmcnt(6)
  ds_read_b64_tr_b16 v[124:125], v6 offset:27136
  ds_read_b64_tr_b16 v[126:127], v6 offset:27200
  v_mfma_f32_16x16x32_bf16 v[16:19], v[40:43], v[72:75], v[16:19]
  s_waitcnt lgkmcnt(6)
  ds_read_b64_tr_b16 v[104:105], v6 offset:27392
  ds_read_b64_tr_b16 v[106:107], v6 offset:27456
  v_mfma_f32_16x16x32_bf16 v[16:19], v[44:47], v[76:79], v[16:19]
  s_waitcnt lgkmcnt(6)
  ds_read_b64_tr_b16 v[108:109], v6 offset:27648
  ds_read_b64_tr_b16 v[110:111], v6 offset:27712
  v_mfma_f32_16x16x32_bf16 v[16:19], v[48:51], v[80:83], v[16:19]
  s_waitcnt lgkmcnt(6)
  v_cvt_pk_bf16_f32 v120, v24, v25
  v_cvt_pk_bf16_f32 v121, v26, v27
  v_mfma_f32_16x16x32_bf16 v[112:115], v[116:119], v[68:71], 0
  s_waitcnt lgkmcnt(4)
  v_mov_b64 v[98:99], 0
  v_mfma_f32_16x16x32_bf16 v[112:115], v[124:127], v[72:75], v[112:115]
  s_waitcnt lgkmcnt(2)
  v_mov_b64 v[36:37], 0
  v_exp_f32 v100, v16
  v_mfma_f32_16x16x32_bf16 v[112:115], v[104:107], v[76:79], v[112:115]
  s_waitcnt lgkmcnt(0)
  v_exp_f32 v101, v17
  v_mfma_f32_16x16x32_bf16 v[112:115], v[108:111], v[80:83], v[112:115]
  buffer_store_dwordx4 v[120:123], v2, s[4:7], s29 offen offset:3072 sc1
  v_exp_f32 v102, v18
  v_mfma_f32_16x16x32_bf16 v[20:23], v[52:55], v[68:71], 0
  v_exp_f32 v103, v19
  v_mfma_f32_16x16x32_bf16 v[20:23], v[56:59], v[72:75], v[20:23]
  v_cvt_pk_bf16_f32 v44, v100, v101
  v_cvt_pk_bf16_f32 v45, v102, v103
  v_mfma_f32_16x16x32_bf16 v[20:23], v[60:63], v[76:79], v[20:23]
  s_add_u32 s29, s29, 131072
  v_exp_f32 v100, v112
  v_mfma_f32_16x16x32_bf16 v[20:23], v[64:67], v[80:83], v[20:23]
  v_exp_f32 v101, v113
  v_exp_f32 v102, v114
  v_exp_f32 v103, v115
  v_cvt_pk_bf16_f32 v84, v100, v101
  v_cvt_pk_bf16_f32 v85, v102, v103
  v_cndmask_b32 v48, v84, 0, s[16:17]
  v_cndmask_b32 v49, v85, 0, s[16:17]
  v_cndmask_b32 v50, 0, v84, s[16:17]
  v_cndmask_b32 v51, 0, v85, s[16:17]
  v_exp_f32 v100, v20
  v_mfma_f32_16x16x16_bf16 v[88:91], v[12:13], v[48:49], 0
  v_exp_f32 v101, v21
  v_mfma_f32_16x16x16_bf16 v[24:27], v[120:121], v[48:49], 0
  v_exp_f32 v102, v22
  v_mfma_f32_16x16x16_bf16 v[116:119], v[120:121], v[50:51], 0
  v_exp_f32 v103, v23
  v_cvt_pk_bf16_f32 v46, v100, v101
  v_cvt_pk_bf16_f32 v47, v102, v103
  v_mov_b64 v[38:39], 0
  s_nop 0
  v_mfma_f32_16x16x32_bf16 v[88:91], v[12:15], v[44:47], v[88:91]
  v_mov_b64 v[40:41], 0
  v_mov_b64 v[42:43], 0
  v_mfma_f32_16x16x32_bf16 v[24:27], v[28:31], v[44:47], v[24:27]
  ds_read_b128 v[52:55], v4 offset:24576
  ds_read_b128 v[56:59], v4 offset:25600
  v_mfma_f32_16x16x32_bf16 v[116:119], v[32:35], v[44:47], v[116:119]
  s_nop 1
T_back_64:
  v_rcp_f32 v89, v88
  v_subrev_u32 v100, s54, v88
  v_cmp_le_u32 vcc, s96, v100
  v_mul_f32 v24, v89, v24
  v_mul_f32 v25, v89, v25
  v_cvt_pk_bf16_f32 v124, v24, v25
  v_pk_mul_f32 v[26:27], v[26:27], v[88:89] op_sel:[0,1] op_sel_hi:[1,1]
  v_pk_mul_f32 v[116:117], v[116:117], v[88:89] op_sel:[0,1] op_sel_hi:[1,1]
  v_pk_mul_f32 v[118:119], v[118:119], v[88:89] op_sel:[0,1] op_sel_hi:[1,1]
  v_cvt_pk_bf16_f32 v125, v26, v27
  v_cvt_pk_bf16_f32 v126, v116, v117
  v_cvt_pk_bf16_f32 v127, v118, v119
  ds_write_b128 v11, v[124:127] offset:30720
  s_cbranch_vccnz T_slow_63
  v_smfmac_f32_16x16x64_bf16 v[92:95], v[124:127], a[160:167], v0
  s_mov_b32 s96, s55
  v_smfmac_f32_16x16x64_bf16 v[96:99], v[124:127], a[168:175], v0
  s_cmp_eq_u32 s14, 63
  v_smfmac_f32_16x16x64_bf16 v[36:39], v[124:127], a[176:183], v0
  s_waitcnt lgkmcnt(0)
  s_barrier
  ds_read_b128 v[104:107], v11 offset:30208
  ds_read_b128 v[108:111], v11 offset:29696
  ds_read_b128 v[68:71], v11 offset:29184
  s_cbranch_scc1 M_tdone
  v_smfmac_f32_16x16x64_bf16 v[40:43], v[124:127], a[184:191], v0
  s_waitcnt lgkmcnt(2)
  v_smfmac_f32_16x16x64_bf16 v[92:95], v[104:107], a[192:199], v0
  s_waitcnt lgkmcnt(1)
  ds_read_b128 v[76:79], v4 offset:28672
  v_smfmac_f32_16x16x64_bf16 v[92:95], v[108:111], a[224:231], v0
  s_waitcnt lgkmcnt(1)
  ds_read_b128 v[80:83], v4 offset:29696
  v_smfmac_f32_16x16x64_bf16 v[92:95], v[68:71], a[240:247], v0
  ds_read_b128 v[60:63], v4 offset:26624
  v_smfmac_f32_16x16x64_bf16 v[96:99], v[104:107], a[200:207], v0
  ds_read_b128 v[64:67], v4 offset:27648
  v_smfmac_f32_16x16x64_bf16 v[96:99], v[108:111], a[232:239], v0
  ds_read_b128 v[28:31], v4 offset:30720
  s_nop 0
  v_cvt_pk_bf16_f32 v16, v92, v93
  v_cvt_pk_bf16_f32 v17, v94, v95
  v_bfi_b32 v16, 1, s57, v16
  v_smfmac_f32_16x16x64_bf16 v[96:99], v[68:71], a[248:255], v0
  buffer_store_dwordx2 v[16:17], v7, s[4:7], s20 offen offset:0
  v_smfmac_f32_16x16x64_bf16 v[36:39], v[104:107], a[208:215], v0
  ds_read_b128 v[32:35], v4 offset:31744
  v_smfmac_f32_16x16x64_bf16 v[36:39], v[108:111], v[52:59], v0
  s_waitcnt lgkmcnt(4)
  s_nop 0
  v_cvt_pk_bf16_f32 v18, v96, v97
  v_cvt_pk_bf16_f32 v19, v98, v99
  v_bfi_b32 v18, 1, s57, v18
  v_smfmac_f32_16x16x64_bf16 v[36:39], v[68:71], v[76:83], v0
  buffer_store_dwordx2 v[18:19], v7, s[4:7], s20 offen offset:64
  v_smfmac_f32_16x16x64_bf16 v[40:43], v[104:107], a[216:223], v0
  s_waitcnt lgkmcnt(2)
  v_smfmac_f32_16x16x64_bf16 v[40:43], v[108:111], v[60:67], v0
  s_waitcnt lgkmcnt(0)
  s_nop 0
  v_cvt_pk_bf16_f32 v20, v36, v37
  v_cvt_pk_bf16_f32 v21, v38, v39
  v_bfi_b32 v20, 1, s57, v20
  v_smfmac_f32_16x16x64_bf16 v[40:43], v[68:71], v[28:35], v0
  buffer_store_dwordx2 v[20:21], v7, s[4:7], s21 offen offset:0
  s_nop 6
  v_cvt_pk_bf16_f32 v22, v40, v41
  v_cvt_pk_bf16_f32 v23, v42, v43
  v_bfi_b32 v22, 1, s57, v22
  buffer_store_dwordx2 v[22:23], v7, s[4:7], s21 offen offset:64
  ds_read_b128 v[68:71], v4 offset:0
  ds_read_b128 v[72:75], v4 offset:1024
  ds_read_b128 v[76:79], v4 offset:4096
  ds_read_b128 v[80:83], v4 offset:5120
  ds_read_b128 v[84:87], v4 offset:8192
  ds_read_b128 v[88:91], v4 offset:9216
  ds_read_b128 v[92:95], v4 offset:2048
  ds_read_b128 v[96:99], v4 offset:3072
  ds_read_b128 v[100:103], v4 offset:6144
  ds_read_b128 v[104:107], v4 offset:7168
  ds_read_b128 v[108:111], v4 offset:10240
  ds_read_b128 v[112:115], v4 offset:11264
  v_mov_b64 v[16:17], 0
  v_mov_b64 v[18:19], 0
  v_mov_b64 v[20:21], 0
  v_mov_b64 v[22:23], 0
  v_mov_b64 v[24:25], 0
  v_mov_b64 v[26:27], 0
  ds_read_b64 v[44:45], v2 offset:32256
  s_waitcnt lgkmcnt(0)
  v_readfirstlane_b32 s38, v44
  v_readfirstlane_b32 s37, v45
  s_nop 0
  s_lshl_b32 s38, s38, 1
  s_lshl1_add_u32 s37, s37, 1
  s_min_u32 s38, s38, s37
  s_cmp_ge_u32 s38, 64
  s_cselect_b32 s38, 100, s38
  s_sub_u32 s38, s38, 1
  s_max_i32 s30, s30, s38
  s_waitcnt vmcnt(4)
  s_barrier
  ds_read_b128 v[28:31], v2 offset:19456
  ds_read_b128 v[32:35], v2 offset:23552
  ds_read_b128 v[36:39], v2 offset:8192
  ds_read_b128 v[40:43], v2 offset:9216
  ds_read_b128 v[44:47], v2 offset:10240
  ds_read_b128 v[48:51], v2 offset:11264
  buffer_load_dwordx4 v[124:127], v2, s[4:7], s24 offen offset:3072 sc1
  buffer_load_dwordx4 v[116:119], v2, s[4:7], s25 offen offset:3072 sc1
  ds_read_b128 v[52:55], v2 offset:12288
  ds_read_b128 v[56:59], v2 offset:13312
  ds_read_b128 v[60:63], v2 offset:14336
  ds_read_b128 v[64:67], v2 offset:15360
  buffer_load_dwordx4 v[124:127], v2, s[4:7], s24 offen offset:3072 sc1
  buffer_load_dwordx4 v[116:119], v2, s[4:7], s25 offen offset:3072 sc1
  s_add_u32 s14, s14, 1
  s_cmp_ge_i32 s14, s30
  s_cbranch_scc1 T_kvw_60
T_kvb_61:
  s_mov_b32 s19, 0
  s_branch T_loop_56
T_kvw_60:
  s_mov_b32 s19, 0
  s_branch T_kvok_69
T_kv_68:
  s_sleep 4
  s_add_u32 s19, s19, 1
  s_cmp_gt_u32 s19, 32768
  s_cbranch_scc1 M_exit
T_kvok_69:
  s_add_u32 s39, s99, 128
  s_mov_b32 s38, 0
  s_mov_b32 s37, 0
  s_atomic_or s38, s[58:59], s99 glc
  s_atomic_or s37, s[58:59], s39 glc
  s_waitcnt lgkmcnt(0)
  s_lshl_b32 s38, s38, 1
  s_lshl1_add_u32 s37, s37, 1
  s_min_u32 s38, s38, s37
  s_cmp_ge_u32 s38, 64
  s_cselect_b32 s38, 100, s38
  s_sub_u32 s38, s38, 1
  s_max_i32 s30, s30, s38
  s_cmp_ge_i32 s14, s30
  s_cbranch_scc1 T_kv_68
  s_branch T_kvb_61
T_slow_63:
  s_nop 7
  v_max3_f32 v100, v16, v17, v18
  v_max3_f32 v100, v100, v19, v20
  v_max3_f32 v100, v100, v21, v22
  v_max3_f32 v100, v100, v23, v112
  v_max3_f32 v100, v100, v113, v114
  v_max_f32 v100, v100, v115
  v_mov_b32 v101, v100
  s_nop 1
  v_permlane32_swap_b32 v100, v101
  s_nop 1
  v_max_f32 v100, v100, v101
  v_mov_b32 v101, v100
  s_nop 1
  v_permlane16_swap_b32 v100, v101
  s_nop 1
  v_max_f32 v100, v100, v101
  v_sub_f32 v16, v16, v100
  v_sub_f32 v17, v17, v100
  v_sub_f32 v18, v18, v100
  v_sub_f32 v19, v19, v100
  v_exp_f32 v16, v16
  v_exp_f32 v17, v17
  v_exp_f32 v18, v18
  v_exp_f32 v19, v19
  v_sub_f32 v20, v20, v100
  v_sub_f32 v21, v21, v100
  v_sub_f32 v22, v22, v100
  v_sub_f32 v23, v23, v100
  v_exp_f32 v20, v20
  v_exp_f32 v21, v21
  v_exp_f32 v22, v22
  v_exp_f32 v23, v23
  v_sub_f32 v112, v112, v100
  v_sub_f32 v113, v113, v100
  v_sub_f32 v114, v114, v100
  v_sub_f32 v115, v115, v100
  v_exp_f32 v112, v112
  v_exp_f32 v113, v113
  v_exp_f32 v114, v114
  v_exp_f32 v115, v115
  s_nop 0
  v_cvt_pk_bf16_f32 v44, v16, v17
  v_cvt_pk_bf16_f32 v45, v18, v19
  v_cvt_pk_bf16_f32 v46, v20, v21
  v_cvt_pk_bf16_f32 v47, v22, v23
  v_cvt_pk_bf16_f32 v84, v112, v113
  v_cvt_pk_bf16_f32 v85, v114, v115
  v_cndmask_b32 v48, v84, 0, s[16:17]
  v_cndmask_b32 v49, v85, 0, s[16:17]
  v_cndmask_b32 v50, 0, v84, s[16:17]
  v_cndmask_b32 v51, 0, v85, s[16:17]
  s_nop 1
  v_mfma_f32_16x16x16_bf16 v[88:91], v[12:13], v[48:49], 0
  v_mfma_f32_16x16x16_bf16 v[24:27], v[120:121], v[48:49], 0
  v_mfma_f32_16x16x16_bf16 v[116:119], v[120:121], v[50:51], 0
  v_mfma_f32_16x16x32_bf16 v[88:91], v[12:15], v[44:47], v[88:91]
  v_mfma_f32_16x16x32_bf16 v[24:27], v[28:31], v[44:47], v[24:27]
  v_mfma_f32_16x16x32_bf16 v[116:119], v[32:35], v[44:47], v[116:119]
  s_nop 7
  s_nop 1
  s_mov_b32 s96, -1
  s_branch T_back_64
M_global:
  s_cmp_eq_u32 s13, 1
  s_cbranch_scc1 T_w_71
  s_cmp_eq_u32 s13, 2
  s_cbranch_scc1 T_w_72
  s_cmp_eq_u32 s13, 3
  s_cbranch_scc1 T_w_73
T_w_70:
  s_mov_b32 s19, 0
  s_add_u32 s14, s14, 1
  s_and_b32 s57, s14, 1
  v_mov_b64 v[16:17], 0
  v_mov_b64 v[18:19], 0
  v_mov_b64 v[20:21], 0
  v_mov_b64 v[22:23], 0
  v_mov_b64 v[24:25], 0
  v_mov_b64 v[26:27], 0
  buffer_load_dwordx4 v[124:127], v2, s[4:7], s24 offen offset:0 sc1
  buffer_load_dwordx4 v[116:119], v2, s[4:7], s25 offen offset:0 sc1
  buffer_load_dwordx4 v[124:127], v2, s[4:7], s24 offen offset:0 sc1
  buffer_load_dwordx4 v[116:119], v2, s[4:7], s25 offen offset:0 sc1
  s_branch T_loop_74
.p2align 6
T_retry_75:
  s_mov_b64 exec, vcc
  buffer_load_dwordx4 v[124:127], v2, s[4:7], s24 offen offset:0 sc1
  buffer_load_dwordx4 v[116:119], v2, s[4:7], s25 offen offset:0 sc1
  s_mov_b64 exec, -1
  s_add_u32 s19, s19, 1
  s_cmp_gt_u32 s19, 32768
  s_cbranch_scc1 M_exit
  s_nop 0
  v_mov_b64 v[16:17], 0
  v_mov_b64 v[18:19], 0
T_loop_74:
  s_waitcnt vmcnt(3) lgkmcnt(0)
  v_max3_u32 v123, v124, v125, v126
  v_max_u32 v123, v123, v127
  v_mov_b32_dpp v120, v124 row_ror:8 row_mask:0xf bank_mask:0xf
  v_mov_b32_dpp v121, v125 row_ror:8 row_mask:0xf bank_mask:0xf
  s_waitcnt vmcnt(2)
  v_max3_u32 v123, v123, v116, v117
  v_max3_u32 v123, v123, v118, v119
  v_cmp_eq_u32 vcc, -1, v123
  v_smfmac_f32_16x16x64_bf16 v[16:19], v[124:127], v[68:75], v0
  s_cbranch_vccnz T_retry_75
  ds_write_b128 v2, v[124:127] offset:0
  v_mov_b32_dpp v122, v126 row_ror:8 row_mask:0xf bank_mask:0xf
  v_smfmac_f32_16x16x64_bf16 v[20:23], v[124:127], v[76:83], v0
  s_and_b32 s57, s14, 1
  v_mov_b32_dpp v123, v127 row_ror:8 row_mask:0xf bank_mask:0xf
  v_smfmac_f32_16x16x64_bf16 v[24:27], v[124:127], v[84:91], v0
  s_and_b32 s36, s14, 3
  ds_write_b128 v2, v[116:119] offset:4096
  v_smfmac_f32_16x16x64_bf16 v[16:19], v[120:123], v[92:99], v0
  s_lshl_b32 s36, s36, 13
  v_mov_b32_dpp v84, v116 row_ror:8 row_mask:0xf bank_mask:0xf
  v_smfmac_f32_16x16x64_bf16 v[20:23], v[120:123], v[100:107], v0
  s_add_u32 s26, s36, s23
  ds_read_b128 v[68:71], v4 offset:12288
  v_mov_b32_dpp v85, v117 row_ror:8 row_mask:0xf bank_mask:0xf
  v_smfmac_f32_16x16x64_bf16 v[24:27], v[120:123], v[108:115], v0
  s_add_u32 s36, s36, 8192
  ds_read_b128 v[72:75], v4 offset:13312
  v_mov_b32_dpp v86, v118 row_ror:8 row_mask:0xf bank_mask:0xf
  v_smfmac_f32_16x16x64_bf16 v[16:19], v[116:119], v[224:231], v0
  s_and_b32 s36, s36, 0x7fff
  ds_read_b128 v[76:79], v4 offset:14336
  v_mov_b32_dpp v87, v119 row_ror:8 row_mask:0xf bank_mask:0xf
  v_smfmac_f32_16x16x64_bf16 v[20:23], v[116:119], v[240:247], v0
  s_waitcnt lgkmcnt(3)
  s_barrier
  ds_read_b128 v[100:103], v2 offset:1024
  v_smfmac_f32_16x16x64_bf16 v[24:27], v[116:119], a[0:7], v0
  s_mov_b32 m0, s31
  ds_read_b128 v[120:123], v1 offset:1024
  buffer_load_dwordx4 v9, s[4:7], s27 offen sc1 lds
  v_smfmac_f32_16x16x64_bf16 v[16:19], v[84:87], v[232:239], v0
  s_mov_b32 m0, s32
  v_smfmac_f32_16x16x64_bf16 v[20:23], v[84:87], v[248:255], v0
  ds_read_b128 v[80:83], v4 offset:15360
  v_smfmac_f32_16x16x64_bf16 v[24:27], v[84:87], a[8:15], v0
  s_waitcnt lgkmcnt(2)
  v_smfmac_f32_16x16x64_bf16 v[16:19], v[100:103], v[128:135], v0
  ds_read_b128 v[92:95], v2 offset:2048
  buffer_load_dwordx4 v9, s[4:7], s27 offen offset:128 sc1 lds
  v_smfmac_f32_16x16x64_bf16 v[20:23], v[100:103], v[144:151], v0
  ds_read_b128 v[96:99], v1 offset:2048
  s_mov_b32 m0, s33
  v_smfmac_f32_16x16x64_bf16 v[24:27], v[100:103], v[68:75], v0
  s_waitcnt vmcnt(2) lgkmcnt(3)
  ds_read_b128 v[116:119], v2 offset:3072
  v_smfmac_f32_16x16x64_bf16 v[16:19], v[120:123], v[136:143], v0
  ds_read_b128 v[124:127], v1 offset:3072
  v_smfmac_f32_16x16x64_bf16 v[20:23], v[120:123], v[152:159], v0
  s_waitcnt lgkmcnt(4)
  ds_read_b128 v[104:107], v2 offset:5120
  buffer_load_dwordx4 v10, s[4:7], s28 offen sc1 lds
  v_smfmac_f32_16x16x64_bf16 v[24:27], v[120:123], v[76:83], v0
  s_waitcnt lgkmcnt(4)
  ds_read_b128 v[108:111], v1 offset:5120
  s_mov_b32 m0, s34
  v_smfmac_f32_16x16x64_bf16 v[16:19], v[92:95], v[160:167], v0
  s_waitcnt lgkmcnt(4)
  ds_read_b128 v[112:115], v2 offset:6144
  v_smfmac_f32_16x16x64_bf16 v[16:19], v[96:99], v[168:175], v0
  s_waitcnt lgkmcnt(4)
  ds_read_b128 v[84:87], v1 offset:6144
  v_smfmac_f32_16x16x64_bf16 v[16:19], v[116:119], v[192:199], v0
  s_waitcnt lgkmcnt(4)
  ds_read_b128 v[88:91], v2 offset:7168
  buffer_load_dwordx4 v10, s[4:7], s28 offen offset:256 sc1 lds
  v_smfmac_f32_16x16x64_bf16 v[16:19], v[124:127], v[200:207], v0
  s_waitcnt lgkmcnt(4)
  ds_read_b128 v[100:103], v1 offset:7168
  v_smfmac_f32_16x16x64_bf16 v[16:19], v[104:107], a[16:23], v0
  s_waitcnt lgkmcnt(4)
  ds_read_b128 v[68:71], v4 offset:16384
  v_smfmac_f32_16x16x64_bf16 v[16:19], v[108:111], a[24:31], v0
  s_waitcnt lgkmcnt(4)
  ds_read_b128 v[72:75], v4 offset:17408
  v_smfmac_f32_16x16x64_bf16 v[16:19], v[112:115], a[64:71], v0
  s_waitcnt lgkmcnt(4)
  ds_read_b128 v[76:79], v4 offset:18432
  v_smfmac_f32_16x16x64_bf16 v[16:19], v[84:87], a[72:79], v0
  s_waitcnt lgkmcnt(4)
  ds_read_b128 v[80:83], v4 offset:19456
  v_smfmac_f32_16x16x64_bf16 v[16:19], v[88:91], a[112:119], v0
  s_waitcnt lgkmcnt(4)
  v_smfmac_f32_16x16x64_bf16 v[16:19], v[100:103], a[120:127], v0
  s_add_u32 s24, s36, 145752064
  s_add_u32 s25, s36, 145756160
  v_smfmac_f32_16x16x64_bf16 v[20:23], v[92:95], v[176:183], v0
  s_add_u32 s35, s36, s23
  v_smfmac_f32_16x16x64_bf16 v[20:23], v[96:99], v[184:191], v0
  s_waitcnt lgkmcnt(2)
  v_smfmac_f32_16x16x64_bf16 v[20:23], v[116:119], v[68:75], v0
  s_waitcnt lgkmcnt(0)
  ds_read_b128 v[68:71], v4 offset:20480
  v_mul_f32 v16, s18, v16
  v_smfmac_f32_16x16x64_bf16 v[20:23], v[124:127], v[76:83], v0
  ds_read_b128 v[72:75], v4 offset:21504
  v_mul_f32 v17, s18, v17
  v_smfmac_f32_16x16x64_bf16 v[20:23], v[104:107], a[32:39], v0
  ds_read_b128 v[76:79], v4 offset:22528
  v_mul_f32 v18, s18, v18
  v_smfmac_f32_16x16x64_bf16 v[20:23], v[108:111], a[40:47], v0
  ds_read_b128 v[80:83], v4 offset:23552
  v_mul_f32 v19, s18, v19
  v_smfmac_f32_16x16x64_bf16 v[20:23], v[112:115], a[80:87], v0
  v_cvt_pk_bf16_f32 v120, v16, v17
  v_smfmac_f32_16x16x64_bf16 v[20:23], v[84:87], a[88:95], v0
  v_cvt_pk_bf16_f32 v121, v18, v19
  v_smfmac_f32_16x16x64_bf16 v[20:23], v[88:91], a[128:135], v0
  ds_write_b64 v5, v[120:121] offset:24576
  v_smfmac_f32_16x16x64_bf16 v[20:23], v[100:103], a[136:143], v0
  s_waitcnt lgkmcnt(3)
  v_smfmac_f32_16x16x64_bf16 v[24:27], v[92:95], v[68:75], v0
  s_waitcnt lgkmcnt(1)
  v_mov_b64 v[92:93], 0
  v_smfmac_f32_16x16x64_bf16 v[24:27], v[96:99], v[76:83], v0
  s_nop 1
  v_cvt_pk_bf16_f32 v122, v20, v21
  v_cvt_pk_bf16_f32 v123, v22, v23
  v_smfmac_f32_16x16x64_bf16 v[24:27], v[116:119], v[208:215], v0
  ds_write_b64 v5, v[122:123] offset:26880
  v_mov_b64 v[94:95], 0
  v_smfmac_f32_16x16x64_bf16 v[24:27], v[124:127], v[216:223], v0
  s_waitcnt lgkmcnt(1)
  s_barrier
  ds_read_b64_tr_b16 v[68:69], v6 offset:24576
  v_smfmac_f32_16x16x64_bf16 v[24:27], v[104:107], a[48:55], v0
  s_add_u32 s27, s27, 8192
  ds_read_b64_tr_b16 v[70:71], v6 offset:24640
  ds_read_b64_tr_b16 v[72:73], v6 offset:24832
  v_smfmac_f32_16x16x64_bf16 v[24:27], v[108:111], a[56:63], v0
  s_add_u32 s28, s28, 8192
  ds_read_b64_tr_b16 v[74:75], v6 offset:24896
  ds_read_b64_tr_b16 v[76:77], v6 offset:25088
  v_smfmac_f32_16x16x64_bf16 v[24:27], v[112:115], a[96:103], v0
  s_nop 0
  ds_read_b64_tr_b16 v[78:79], v6 offset:25152
  ds_read_b64_tr_b16 v[80:81], v6 offset:25344
  v_smfmac_f32_16x16x64_bf16 v[24:27], v[84:87], a[104:111], v0
  ds_read_b64_tr_b16 v[82:83], v6 offset:25408
  v_mov_b64 v[96:97], 0
  v_smfmac_f32_16x16x64_bf16 v[24:27], v[88:91], a[144:151], v0
  s_waitcnt lgkmcnt(8)
  s_barrier
  ds_read_b64_tr_b16 v[116:117], v6 offset:26880
  v_smfmac_f32_16x16x64_bf16 v[24:27], v[100:103], a[152:159], v0
  s_waitcnt lgkmcnt(7)
  ds_read_b64_tr_b16 v[118:119], v6 offset:26944
  v_mfma_f32_16x16x32_bf16 v[16:19], v[36:39], v[68:71], 0
  s_waitcnt lgkmcnt(6)
  ds_read_b64_tr_b16 v[124:125], v6 offset:27136
  ds_read_b64_tr_b16 v[126:127], v6 offset:27200
  v_mfma_f32_16x16x32_bf16 v[16:19], v[40:43], v[72:75], v[16:19]
  s_waitcnt lgkmcnt(6)
  ds_read_b64_tr_b16 v[104:105], v6 offset:27392
  ds_read_b64_tr_b16 v[106:107], v6 offset:27456
  v_mfma_f32_16x16x32_bf16 v[16:19], v[44:47], v[76:79], v[16:19]
  s_waitcnt lgkmcnt(6)
  ds_read_b64_tr_b16 v[108:109], v6 offset:27648
  ds_read_b64_tr_b16 v[110:111], v6 offset:27712
  v_mfma_f32_16x16x32_bf16 v[16:19], v[48:51], v[80:83], v[16:19]
  s_waitcnt lgkmcnt(6)
  v_cvt_pk_bf16_f32 v120, v24, v25
  v_cvt_pk_bf16_f32 v121, v26, v27
  v_mfma_f32_16x16x32_bf16 v[112:115], v[116:119], v[68:71], 0
  s_waitcnt lgkmcnt(4)
  buffer_store_dwordx4 v[120:123], v2, s[4:7], s29 offen offset:0 sc1
  v_mov_b64 v[98:99], 0
  v_mfma_f32_16x16x32_bf16 v[112:115], v[124:127], v[72:75], v[112:115]
  s_waitcnt lgkmcnt(2)
  v_mov_b64 v[36:37], 0
  v_exp_f32 v100, v16
  v_mfma_f32_16x16x32_bf16 v[112:115], v[104:107], v[76:79], v[112:115]
  s_waitcnt lgkmcnt(0)
  v_exp_f32 v101, v17
  v_mfma_f32_16x16x32_bf16 v[112:115], v[108:111], v[80:83], v[112:115]
  v_exp_f32 v102, v18
  v_mfma_f32_16x16x32_bf16 v[20:23], v[52:55], v[68:71], 0
  v_exp_f32 v103, v19
  v_mfma_f32_16x16x32_bf16 v[20:23], v[56:59], v[72:75], v[20:23]
  v_cvt_pk_bf16_f32 v44, v100, v101
  v_cvt_pk_bf16_f32 v45, v102, v103
  v_mfma_f32_16x16x32_bf16 v[20:23], v[60:63], v[76:79], v[20:23]
  s_add_u32 s29, s29, 131072
  v_exp_f32 v100, v112
  v_mfma_f32_16x16x32_bf16 v[20:23], v[64:67], v[80:83], v[20:23]
  v_exp_f32 v101, v113
  v_exp_f32 v102, v114
  v_exp_f32 v103, v115
  v_cvt_pk_bf16_f32 v84, v100, v101
  v_cvt_pk_bf16_f32 v85, v102, v103
  v_cndmask_b32 v48, v84, 0, s[16:17]
  v_cndmask_b32 v49, v85, 0, s[16:17]
  v_cndmask_b32 v50, 0, v84, s[16:17]
  v_cndmask_b32 v51, 0, v85, s[16:17]
  v_exp_f32 v100, v20
  v_mfma_f32_16x16x16_bf16 v[88:91], v[12:13], v[48:49], 0
  v_exp_f32 v101, v21
  v_mfma_f32_16x16x16_bf16 v[24:27], v[120:121], v[48:49], 0
  v_exp_f32 v102, v22
  v_mfma_f32_16x16x16_bf16 v[116:119], v[120:121], v[50:51], 0
  v_exp_f32 v103, v23
  v_cvt_pk_bf16_f32 v46, v100, v101
  v_cvt_pk_bf16_f32 v47, v102, v103
  v_mov_b64 v[38:39], 0
  s_nop 0
  v_mfma_f32_16x16x32_bf16 v[88:91], v[12:15], v[44:47], v[88:91]
  v_mov_b64 v[40:41], 0
  v_mov_b64 v[42:43], 0
  v_mfma_f32_16x16x32_bf16 v[24:27], v[28:31], v[44:47], v[24:27]
  ds_read_b128 v[52:55], v4 offset:24576
  ds_read_b128 v[56:59], v4 offset:25600
  v_mfma_f32_16x16x32_bf16 v[116:119], v[32:35], v[44:47], v[116:119]
  s_nop 1
T_back_82:
  v_rcp_f32 v89, v88
  v_subrev_u32 v100, s54, v88
  v_cmp_le_u32 vcc, s96, v100
  v_mul_f32 v24, v89, v24
  v_mul_f32 v25, v89, v25
  v_cvt_pk_bf16_f32 v124, v24, v25
  v_pk_mul_f32 v[26:27], v[26:27], v[88:89] op_sel:[0,1] op_sel_hi:[1,1]
  v_pk_mul_f32 v[116:117], v[116:117], v[88:89] op_sel:[0,1] op_sel_hi:[1,1]
  v_pk_mul_f32 v[118:119], v[118:119], v[88:89] op_sel:[0,1] op_sel_hi:[1,1]
  v_cvt_pk_bf16_f32 v125, v26, v27
  v_cvt_pk_bf16_f32 v126, v116, v117
  v_cvt_pk_bf16_f32 v127, v118, v119
  ds_write_b128 v11, v[124:127] offset:29184
  s_cbranch_vccnz T_slow_81
  v_smfmac_f32_16x16x64_bf16 v[92:95], v[124:127], a[160:167], v0
  s_mov_b32 s96, s55
  v_smfmac_f32_16x16x64_bf16 v[96:99], v[124:127], a[168:175], v0
  s_cmp_eq_u32 s14, 63
  v_smfmac_f32_16x16x64_bf16 v[36:39], v[124:127], a[176:183], v0
  s_waitcnt lgkmcnt(0)
  s_barrier
  ds_read_b128 v[104:107], v11 offset:29696
  ds_read_b128 v[108:111], v11 offset:30208
  ds_read_b128 v[68:71], v11 offset:30720
  s_cbranch_scc1 M_tdone
  v_smfmac_f32_16x16x64_bf16 v[40:43], v[124:127], a[184:191], v0
  s_waitcnt lgkmcnt(2)
  v_smfmac_f32_16x16x64_bf16 v[92:95], v[104:107], a[192:199], v0
  s_waitcnt lgkmcnt(1)
  ds_read_b128 v[76:79], v4 offset:28672
  v_smfmac_f32_16x16x64_bf16 v[92:95], v[108:111], a[224:231], v0
  s_waitcnt lgkmcnt(1)
  ds_read_b128 v[80:83], v4 offset:29696
  v_smfmac_f32_16x16x64_bf16 v[92:95], v[68:71], a[240:247], v0
  ds_read_b128 v[60:63], v4 offset:26624
  v_smfmac_f32_16x16x64_bf16 v[96:99], v[104:107], a[200:207], v0
  ds_read_b128 v[64:67], v4 offset:27648
  v_smfmac_f32_16x16x64_bf16 v[96:99], v[108:111], a[232:239], v0
  ds_read_b128 v[28:31], v4 offset:30720
  s_nop 0
  v_cvt_pk_bf16_f32 v16, v92, v93
  v_cvt_pk_bf16_f32 v17, v94, v95
  v_bfi_b32 v16, 1, s57, v16
  v_smfmac_f32_16x16x64_bf16 v[96:99], v[68:71], a[248:255], v0
  buffer_store_dwordx2 v[16:17], v7, s[4:7], s20 offen offset:0 sc1
  v_smfmac_f32_16x16x64_bf16 v[36:39], v[104:107], a[208:215], v0
  ds_read_b128 v[32:35], v4 offset:31744
  v_smfmac_f32_16x16x64_bf16 v[36:39], v[108:111], v[52:59], v0
  s_waitcnt lgkmcnt(4)
  s_nop 0
  v_cvt_pk_bf16_f32 v18, v96, v97
  v_cvt_pk_bf16_f32 v19, v98, v99
  v_bfi_b32 v18, 1, s57, v18
  v_smfmac_f32_16x16x64_bf16 v[36:39], v[68:71], v[76:83], v0
  buffer_store_dwordx2 v[18:19], v7, s[4:7], s20 offen offset:64 sc1
  v_smfmac_f32_16x16x64_bf16 v[40:43], v[104:107], a[216:223], v0
  s_waitcnt lgkmcnt(2)
  ds_read_b128 v[116:119], v2 offset:31232
  v_smfmac_f32_16x16x64_bf16 v[40:43], v[108:111], v[60:67], v0
  s_waitcnt lgkmcnt(1)
  s_nop 0
  v_cvt_pk_bf16_f32 v20, v36, v37
  v_cvt_pk_bf16_f32 v21, v38, v39
  v_bfi_b32 v20, 1, s57, v20
  v_smfmac_f32_16x16x64_bf16 v[40:43], v[68:71], v[28:35], v0
  buffer_store_dwordx2 v[20:21], v7, s[4:7], s21 offen offset:0 sc1
  s_nop 6
  v_cvt_pk_bf16_f32 v22, v40, v41
  v_cvt_pk_bf16_f32 v23, v42, v43
  v_bfi_b32 v22, 1, s57, v22
  buffer_store_dwordx2 v[22:23], v7, s[4:7], s21 offen offset:64 sc1
  ds_read_b128 v[68:71], v4 offset:0
  ds_read_b128 v[72:75], v4 offset:1024
  ds_read_b128 v[76:79], v4 offset:4096
  ds_read_b128 v[80:83], v4 offset:5120
  ds_read_b128 v[84:87], v4 offset:8192
  ds_read_b128 v[88:91], v4 offset:9216
  v_mov_b64 v[16:17], 0
  v_mov_b64 v[18:19], 0
  v_mov_b64 v[20:21], 0
  v_mov_b64 v[22:23], 0
  v_mov_b64 v[24:25], 0
  v_mov_b64 v[26:27], 0
  s_mov_b32 s19, 0
  v_mov_b32 v49, -1
  s_waitcnt vmcnt(2)
  buffer_load_dwordx4 v[52:55], v2, s[4:7], s22 offen offset:0 sc1
  buffer_load_dwordx4 v[56:59], v2, s[4:7], s22 offen offset:1024 sc1
  buffer_load_dwordx4 v[60:63], v2, s[4:7], s22 offen offset:2048 sc1
  buffer_load_dwordx4 v[64:67], v2, s[4:7], s22 offen offset:3072 sc1
  ds_read_b128 v[92:95], v4 offset:2048
  ds_read_b128 v[96:99], v4 offset:3072
  ds_read_b128 v[100:103], v4 offset:6144
  ds_read_b128 v[104:107], v4 offset:7168
  ds_read_b128 v[108:111], v4 offset:10240
  ds_read_b128 v[112:115], v4 offset:11264
  ds_read_b64 v[44:45], v2 offset:32256
  s_waitcnt lgkmcnt(0)
  v_readfirstlane_b32 s38, v44
  v_readfirstlane_b32 s37, v45
  s_nop 0
  s_lshl_b32 s38, s38, 1
  s_lshl1_add_u32 s37, s37, 1
  s_min_u32 s38, s38, s37
  s_cmp_ge_u32 s38, 64
  s_cselect_b32 s38, 100, s38
  s_sub_u32 s38, s38, 1
  s_max_i32 s30, s30, s38
  s_waitcnt lgkmcnt(12)
  s_waitcnt vmcnt(3)
  v_mfma_f32_16x16x32_bf16 v[120:123], v[116:119], v[52:55], 0
  v_xor_b32 v48, s57, v52
  v_bitop3_b32 v48, v48, v54, s57 bitop3:0xf6
  s_waitcnt vmcnt(2)
  v_mfma_f32_16x16x32_bf16 v[120:123], v[116:119], v[56:59], v[120:123]
  v_bitop3_b32 v48, v48, v56, s57 bitop3:0xf6
  v_bitop3_b32 v48, v48, v58, s57 bitop3:0xf6
  s_waitcnt vmcnt(1)
  v_mfma_f32_16x16x32_bf16 v[120:123], v[116:119], v[60:63], v[120:123]
  v_bitop3_b32 v48, v48, v60, s57 bitop3:0xf6
  v_bitop3_b32 v48, v48, v62, s57 bitop3:0xf6
  s_waitcnt vmcnt(0)
  v_mfma_f32_16x16x32_bf16 v[120:123], v[116:119], v[64:67], v[120:123]
  v_bitop3_b32 v48, v48, v64, s57 bitop3:0xf6
  v_bitop3_b32 v48, v48, v66, s57 bitop3:0xf6
  v_and_b32 v48, 1, v48
  v_cmp_ne_u32 vcc, 0, v48
  s_cbranch_vccnz T_p1re_84
T_p1ok_85:
  s_nop 2
  v_add_f32_dpp v120, v120, v120 row_ror:8 row_mask:0xf bank_mask:0xf
  v_add_f32_dpp v121, v121, v121 row_ror:8 row_mask:0xf bank_mask:0xf
  v_cvt_pk_bf16_f32 v48, v120, v121
  buffer_store_dword v48, v8, s[4:7], s35 offen sc1
  buffer_store_dword v49, v8, s[4:7], s26 offen sc1
  s_barrier
  ds_read_b128 v[28:31], v2 offset:16384
  ds_read_b128 v[32:35], v2 offset:20480
  ds_read_b128 v[36:39], v2 offset:8192
  ds_read_b128 v[40:43], v2 offset:9216
  ds_read_b128 v[44:47], v2 offset:10240
  ds_read_b128 v[48:51], v2 offset:11264
  buffer_load_dwordx4 v[124:127], v2, s[4:7], s24 offen offset:0 sc1
  buffer_load_dwordx4 v[116:119], v2, s[4:7], s25 offen offset:0 sc1
  ds_read_b128 v[52:55], v2 offset:12288
  ds_read_b128 v[56:59], v2 offset:13312
  ds_read_b128 v[60:63], v2 offset:14336
  ds_read_b128 v[64:67], v2 offset:15360
  buffer_load_dwordx4 v[124:127], v2, s[4:7], s24 offen offset:0 sc1
  buffer_load_dwordx4 v[116:119], v2, s[4:7], s25 offen offset:0 sc1
  s_add_u32 s14, s14, 1
  s_cmp_ge_i32 s14, s30
  s_cbranch_scc1 T_kvw_78
T_kvb_79:
  s_mov_b32 s19, 0
  s_branch T_loop_74
T_p1re_84:
  s_mov_b64 exec, vcc
  buffer_load_dwordx4 v[52:55], v2, s[4:7], s22 offen offset:0 sc1
  buffer_load_dwordx4 v[56:59], v2, s[4:7], s22 offen offset:1024 sc1
  buffer_load_dwordx4 v[60:63], v2, s[4:7], s22 offen offset:2048 sc1
  buffer_load_dwordx4 v[64:67], v2, s[4:7], s22 offen offset:3072 sc1
  s_mov_b64 exec, -1
  s_add_u32 s19, s19, 1
  s_cmp_gt_u32 s19, 32768
  s_cbranch_scc1 M_exit
  s_waitcnt vmcnt(3)
  v_mfma_f32_16x16x32_bf16 v[120:123], v[116:119], v[52:55], 0
  v_xor_b32 v48, s57, v52
  v_bitop3_b32 v48, v48, v54, s57 bitop3:0xf6
  s_waitcnt vmcnt(2)
  v_mfma_f32_16x16x32_bf16 v[120:123], v[116:119], v[56:59], v[120:123]
  v_bitop3_b32 v48, v48, v56, s57 bitop3:0xf6
  v_bitop3_b32 v48, v48, v58, s57 bitop3:0xf6
  s_waitcnt vmcnt(1)
  v_mfma_f32_16x16x32_bf16 v[120:123], v[116:119], v[60:63], v[120:123]
  v_bitop3_b32 v48, v48, v60, s57 bitop3:0xf6
  v_bitop3_b32 v48, v48, v62, s57 bitop3:0xf6
  s_waitcnt vmcnt(0)
  v_mfma_f32_16x16x32_bf16 v[120:123], v[116:119], v[64:67], v[120:123]
  v_bitop3_b32 v48, v48, v64, s57 bitop3:0xf6
  v_bitop3_b32 v48, v48, v66, s57 bitop3:0xf6
  v_and_b32 v48, 1, v48
  v_cmp_ne_u32 vcc, 0, v48
  s_cbranch_vccnz T_p1re_84
  s_branch T_p1ok_85
T_kvw_78:
  s_mov_b32 s19, 0
  s_branch T_kvok_87
T_kv_86:
  s_sleep 4
  s_add_u32 s19, s19, 1
  s_cmp_gt_u32 s19, 32768
  s_cbranch_scc1 M_exit
T_kvok_87:
  s_add_u32 s39, s99, 128
  s_mov_b32 s38, 0
  s_mov_b32 s37, 0
  s_atomic_or s38, s[58:59], s99 glc
  s_atomic_or s37, s[58:59], s39 glc
  s_waitcnt lgkmcnt(0)
  s_lshl_b32 s38, s38, 1
  s_lshl1_add_u32 s37, s37, 1
  s_min_u32 s38, s38, s37
  s_cmp_ge_u32 s38, 64
  s_cselect_b32 s38, 100, s38
  s_sub_u32 s38, s38, 1
  s_max_i32 s30, s30, s38
  s_cmp_ge_i32 s14, s30
  s_cbranch_scc1 T_kv_86
  s_branch T_kvb_79
T_slow_81:
  s_nop 7
  v_max3_f32 v100, v16, v17, v18
  v_max3_f32 v100, v100, v19, v20
  v_max3_f32 v100, v100, v21, v22
  v_max3_f32 v100, v100, v23, v112
  v_max3_f32 v100, v100, v113, v114
  v_max_f32 v100, v100, v115
  v_mov_b32 v101, v100
  s_nop 1
  v_permlane32_swap_b32 v100, v101
  s_nop 1
  v_max_f32 v100, v100, v101
  v_mov_b32 v101, v100
  s_nop 1
  v_permlane16_swap_b32 v100, v101
  s_nop 1
  v_max_f32 v100, v100, v101
  v_sub_f32 v16, v16, v100
  v_sub_f32 v17, v17, v100
  v_sub_f32 v18, v18, v100
  v_sub_f32 v19, v19, v100
  v_exp_f32 v16, v16
  v_exp_f32 v17, v17
  v_exp_f32 v18, v18
  v_exp_f32 v19, v19
  v_sub_f32 v20, v20, v100
  v_sub_f32 v21, v21, v100
  v_sub_f32 v22, v22, v100
  v_sub_f32 v23, v23, v100
  v_exp_f32 v20, v20
  v_exp_f32 v21, v21
  v_exp_f32 v22, v22
  v_exp_f32 v23, v23
  v_sub_f32 v112, v112, v100
  v_sub_f32 v113, v113, v100
  v_sub_f32 v114, v114, v100
  v_sub_f32 v115, v115, v100
  v_exp_f32 v112, v112
  v_exp_f32 v113, v113
  v_exp_f32 v114, v114
  v_exp_f32 v115, v115
  s_nop 0
  v_cvt_pk_bf16_f32 v44, v16, v17
  v_cvt_pk_bf16_f32 v45, v18, v19
  v_cvt_pk_bf16_f32 v46, v20, v21
  v_cvt_pk_bf16_f32 v47, v22, v23
  v_cvt_pk_bf16_f32 v84, v112, v113
  v_cvt_pk_bf16_f32 v85, v114, v115
  v_cndmask_b32 v48, v84, 0, s[16:17]
  v_cndmask_b32 v49, v85, 0, s[16:17]
  v_cndmask_b32 v50, 0, v84, s[16:17]
  v_cndmask_b32 v51, 0, v85, s[16:17]
  s_nop 1
  v_mfma_f32_16x16x16_bf16 v[88:91], v[12:13], v[48:49], 0
  v_mfma_f32_16x16x16_bf16 v[24:27], v[120:121], v[48:49], 0
  v_mfma_f32_16x16x16_bf16 v[116:119], v[120:121], v[50:51], 0
  v_mfma_f32_16x16x32_bf16 v[88:91], v[12:15], v[44:47], v[88:91]
  v_mfma_f32_16x16x32_bf16 v[24:27], v[28:31], v[44:47], v[24:27]
  v_mfma_f32_16x16x32_bf16 v[116:119], v[32:35], v[44:47], v[116:119]
  s_nop 7
  s_nop 1
  s_mov_b32 s96, -1
  s_branch T_back_82
T_w_71:
  s_mov_b32 s19, 0
  s_add_u32 s14, s14, 1
  s_and_b32 s57, s14, 1
  v_mov_b64 v[16:17], 0
  v_mov_b64 v[18:19], 0
  v_mov_b64 v[20:21], 0
  v_mov_b64 v[22:23], 0
  v_mov_b64 v[24:25], 0
  v_mov_b64 v[26:27], 0
  buffer_load_dwordx4 v[124:127], v2, s[4:7], s24 offen offset:1024 sc1
  buffer_load_dwordx4 v[116:119], v2, s[4:7], s25 offen offset:1024 sc1
  buffer_load_dwordx4 v[124:127], v2, s[4:7], s24 offen offset:1024 sc1
  buffer_load_dwordx4 v[116:119], v2, s[4:7], s25 offen offset:1024 sc1
  s_branch T_loop_88
.p2align 6
T_retry_89:
  s_mov_b64 exec, vcc
  buffer_load_dwordx4 v[124:127], v2, s[4:7], s24 offen offset:1024 sc1
  buffer_load_dwordx4 v[116:119], v2, s[4:7], s25 offen offset:1024 sc1
  s_mov_b64 exec, -1
  s_add_u32 s19, s19, 1
  s_cmp_gt_u32 s19, 32768
  s_cbranch_scc1 M_exit
  s_nop 0
  v_mov_b64 v[16:17], 0
  v_mov_b64 v[18:19], 0
T_loop_88:
  s_waitcnt vmcnt(3) lgkmcnt(0)
  v_max3_u32 v123, v124, v125, v126
  v_max_u32 v123, v123, v127
  v_mov_b32_dpp v120, v124 row_ror:8 row_mask:0xf bank_mask:0xf
  v_mov_b32_dpp v121, v125 row_ror:8 row_mask:0xf bank_mask:0xf
  s_waitcnt vmcnt(2)
  v_max3_u32 v123, v123, v116, v117
  v_max3_u32 v123, v123, v118, v119
  v_cmp_eq_u32 vcc, -1, v123
  v_smfmac_f32_16x16x64_bf16 v[16:19], v[124:127], v[68:75], v0
  s_cbranch_vccnz T_retry_89
  ds_write_b128 v2, v[124:127] offset:1024
  v_mov_b32_dpp v122, v126 row_ror:8 row_mask:0xf bank_mask:0xf
  v_smfmac_f32_16x16x64_bf16 v[20:23], v[124:127], v[76:83], v0
  s_and_b32 s57, s14, 1
  v_mov_b32_dpp v123, v127 row_ror:8 row_mask:0xf bank_mask:0xf
  v_smfmac_f32_16x16x64_bf16 v[24:27], v[124:127], v[84:91], v0
  s_and_b32 s36, s14, 3
  ds_write_b128 v2, v[116:119] offset:5120
  v_smfmac_f32_16x16x64_bf16 v[16:19], v[120:123], v[92:99], v0
  s_lshl_b32 s36, s36, 13
  v_mov_b32_dpp v84, v116 row_ror:8 row_mask:0xf bank_mask:0xf
  v_smfmac_f32_16x16x64_bf16 v[20:23], v[120:123], v[100:107], v0
  s_add_u32 s26, s36, s23
  ds_read_b128 v[68:71], v4 offset:12288
  v_mov_b32_dpp v85, v117 row_ror:8 row_mask:0xf bank_mask:0xf
  v_smfmac_f32_16x16x64_bf16 v[24:27], v[120:123], v[108:115], v0
  s_add_u32 s36, s36, 8192
  ds_read_b128 v[72:75], v4 offset:13312
  v_mov_b32_dpp v86, v118 row_ror:8 row_mask:0xf bank_mask:0xf
  v_smfmac_f32_16x16x64_bf16 v[16:19], v[116:119], v[224:231], v0
  s_and_b32 s36, s36, 0x7fff
  ds_read_b128 v[76:79], v4 offset:14336
  v_mov_b32_dpp v87, v119 row_ror:8 row_mask:0xf bank_mask:0xf
  v_smfmac_f32_16x16x64_bf16 v[20:23], v[116:119], v[240:247], v0
  s_waitcnt lgkmcnt(3)
  s_barrier
  ds_read_b128 v[100:103], v2 offset:0
  v_smfmac_f32_16x16x64_bf16 v[24:27], v[116:119], a[0:7], v0
  s_mov_b32 m0, s31
  ds_read_b128 v[120:123], v1 offset:0
  v_smfmac_f32_16x16x64_bf16 v[16:19], v[84:87], v[232:239], v0
  buffer_load_dwordx4 v9, s[4:7], s27 offen sc1 lds
  v_smfmac_f32_16x16x64_bf16 v[20:23], v[84:87], v[248:255], v0
  ds_read_b128 v[80:83], v4 offset:15360
  s_mov_b32 m0, s32
  v_smfmac_f32_16x16x64_bf16 v[24:27], v[84:87], a[8:15], v0
  s_waitcnt lgkmcnt(2)
  v_smfmac_f32_16x16x64_bf16 v[16:19], v[100:103], v[128:135], v0
  ds_read_b128 v[92:95], v2 offset:3072
  v_smfmac_f32_16x16x64_bf16 v[20:23], v[100:103], v[144:151], v0
  ds_read_b128 v[96:99], v1 offset:3072
  buffer_load_dwordx4 v9, s[4:7], s27 offen offset:128 sc1 lds
  v_smfmac_f32_16x16x64_bf16 v[24:27], v[100:103], v[68:75], v0
  s_waitcnt vmcnt(2) lgkmcnt(3)
  ds_read_b128 v[116:119], v2 offset:2048
  s_mov_b32 m0, s33
  v_smfmac_f32_16x16x64_bf16 v[16:19], v[120:123], v[136:143], v0
  ds_read_b128 v[124:127], v1 offset:2048
  v_smfmac_f32_16x16x64_bf16 v[20:23], v[120:123], v[152:159], v0
  s_waitcnt lgkmcnt(4)
  ds_read_b128 v[104:107], v2 offset:4096
  v_smfmac_f32_16x16x64_bf16 v[24:27], v[120:123], v[76:83], v0
  s_waitcnt lgkmcnt(4)
  ds_read_b128 v[108:111], v1 offset:4096
  buffer_load_dwordx4 v10, s[4:7], s28 offen sc1 lds
  v_smfmac_f32_16x16x64_bf16 v[16:19], v[92:95], v[160:167], v0
  s_waitcnt lgkmcnt(4)
  ds_read_b128 v[112:115], v2 offset:7168
  s_mov_b32 m0, s34
  v_smfmac_f32_16x16x64_bf16 v[16:19], v[96:99], v[168:175], v0
  s_waitcnt lgkmcnt(4)
  ds_read_b128 v[84:87], v1 offset:7168
  v_smfmac_f32_16x16x64_bf16 v[16:19], v[116:119], v[192:199], v0
  s_waitcnt lgkmcnt(4)
  ds_read_b128 v[88:91], v2 offset:6144
  v_smfmac_f32_16x16x64_bf16 v[16:19], v[124:127], v[200:207], v0
  s_waitcnt lgkmcnt(4)
  ds_read_b128 v[100:103], v1 offset:6144
  buffer_load_dwordx4 v10, s[4:7], s28 offen offset:256 sc1 lds
  v_smfmac_f32_16x16x64_bf16 v[16:19], v[104:107], a[16:23], v0
  s_waitcnt lgkmcnt(4)
  ds_read_b128 v[68:71], v4 offset:16384
  v_smfmac_f32_16x16x64_bf16 v[16:19], v[108:111], a[24:31], v0
  s_waitcnt lgkmcnt(4)
  ds_read_b128 v[72:75], v4 offset:17408
  v_smfmac_f32_16x16x64_bf16 v[16:19], v[112:115], a[64:71], v0
  s_waitcnt lgkmcnt(4)
  ds_read_b128 v[76:79], v4 offset:18432
  v_smfmac_f32_16x16x64_bf16 v[16:19], v[84:87], a[72:79], v0
  s_waitcnt lgkmcnt(4)
  ds_read_b128 v[80:83], v4 offset:19456
  v_smfmac_f32_16x16x64_bf16 v[16:19], v[88:91], a[112:119], v0
  s_waitcnt lgkmcnt(4)
  v_smfmac_f32_16x16x64_bf16 v[16:19], v[100:103], a[120:127], v0
  s_add_u32 s24, s36, 145752064
  s_add_u32 s25, s36, 145756160
  v_smfmac_f32_16x16x64_bf16 v[20:23], v[92:95], v[176:183], v0
  s_add_u32 s35, s36, s23
  v_smfmac_f32_16x16x64_bf16 v[20:23], v[96:99], v[184:191], v0
  s_waitcnt lgkmcnt(2)
  v_smfmac_f32_16x16x64_bf16 v[20:23], v[116:119], v[68:75], v0
  s_waitcnt lgkmcnt(0)
  ds_read_b128 v[68:71], v4 offset:20480
  v_mul_f32 v16, s18, v16
  v_smfmac_f32_16x16x64_bf16 v[20:23], v[124:127], v[76:83], v0
  ds_read_b128 v[72:75], v4 offset:21504
  v_mul_f32 v17, s18, v17
  v_smfmac_f32_16x16x64_bf16 v[20:23], v[104:107], a[32:39], v0
  ds_read_b128 v[76:79], v4 offset:22528
  v_mul_f32 v18, s18, v18
  v_smfmac_f32_16x16x64_bf16 v[20:23], v[108:111], a[40:47], v0
  ds_read_b128 v[80:83], v4 offset:23552
  v_mul_f32 v19, s18, v19
  v_smfmac_f32_16x16x64_bf16 v[20:23], v[112:115], a[80:87], v0
  v_cvt_pk_bf16_f32 v120, v16, v17
  v_smfmac_f32_16x16x64_bf16 v[20:23], v[84:87], a[88:95], v0
  v_cvt_pk_bf16_f32 v121, v18, v19
  v_smfmac_f32_16x16x64_bf16 v[20:23], v[88:91], a[128:135], v0
  ds_write_b64 v5, v[120:121] offset:24576
  v_smfmac_f32_16x16x64_bf16 v[20:23], v[100:103], a[136:143], v0
  s_waitcnt lgkmcnt(3)
  v_smfmac_f32_16x16x64_bf16 v[24:27], v[92:95], v[68:75], v0
  s_waitcnt lgkmcnt(1)
  v_mov_b64 v[92:93], 0
  v_smfmac_f32_16x16x64_bf16 v[24:27], v[96:99], v[76:83], v0
  s_nop 1
  v_cvt_pk_bf16_f32 v122, v20, v21
  v_cvt_pk_bf16_f32 v123, v22, v23
  v_smfmac_f32_16x16x64_bf16 v[24:27], v[116:119], v[208:215], v0
  ds_write_b64 v5, v[122:123] offset:26880
  v_mov_b64 v[94:95], 0
  v_smfmac_f32_16x16x64_bf16 v[24:27], v[124:127], v[216:223], v0
  s_waitcnt lgkmcnt(1)
  s_barrier
  ds_read_b64_tr_b16 v[68:69], v6 offset:24576
  v_smfmac_f32_16x16x64_bf16 v[24:27], v[104:107], a[48:55], v0
  s_add_u32 s27, s27, 8192
  ds_read_b64_tr_b16 v[70:71], v6 offset:24640
  ds_read_b64_tr_b16 v[72:73], v6 offset:24832
  v_smfmac_f32_16x16x64_bf16 v[24:27], v[108:111], a[56:63], v0
  s_add_u32 s28, s28, 8192
  ds_read_b64_tr_b16 v[74:75], v6 offset:24896
  ds_read_b64_tr_b16 v[76:77], v6 offset:25088
  v_smfmac_f32_16x16x64_bf16 v[24:27], v[112:115], a[96:103], v0
  s_nop 0
  ds_read_b64_tr_b16 v[78:79], v6 offset:25152
  ds_read_b64_tr_b16 v[80:81], v6 offset:25344
  v_smfmac_f32_16x16x64_bf16 v[24:27], v[84:87], a[104:111], v0
  ds_read_b64_tr_b16 v[82:83], v6 offset:25408
  v_mov_b64 v[96:97], 0
  v_smfmac_f32_16x16x64_bf16 v[24:27], v[88:91], a[144:151], v0
  s_waitcnt lgkmcnt(8)
  s_barrier
  ds_read_b64_tr_b16 v[116:117], v6 offset:26880
  v_smfmac_f32_16x16x64_bf16 v[24:27], v[100:103], a[152:159], v0
  s_waitcnt lgkmcnt(7)
  ds_read_b64_tr_b16 v[118:119], v6 offset:26944
  v_mfma_f32_16x16x32_bf16 v[16:19], v[36:39], v[68:71], 0
  s_waitcnt lgkmcnt(6)
  ds_read_b64_tr_b16 v[124:125], v6 offset:27136
  ds_read_b64_tr_b16 v[126:127], v6 offset:27200
  v_mfma_f32_16x16x32_bf16 v[16:19], v[40:43], v[72:75], v[16:19]
  s_waitcnt lgkmcnt(6)
  ds_read_b64_tr_b16 v[104:105], v6 offset:27392
  ds_read_b64_tr_b16 v[106:107], v6 offset:27456
  v_mfma_f32_16x16x32_bf16 v[16:19], v[44:47], v[76:79], v[16:19]
  s_waitcnt lgkmcnt(6)
  ds_read_b64_tr_b16 v[108:109], v6 offset:27648
  ds_read_b64_tr_b16 v[110:111], v6 offset:27712
  v_mfma_f32_16x16x32_bf16 v[16:19], v[48:51], v[80:83], v[16:19]
  s_waitcnt lgkmcnt(6)
  v_cvt_pk_bf16_f32 v120, v24, v25
  v_cvt_pk_bf16_f32 v121, v26, v27
  v_mfma_f32_16x16x32_bf16 v[112:115], v[116:119], v[68:71], 0
  s_waitcnt lgkmcnt(4)
  v_mov_b64 v[98:99], 0
  v_mfma_f32_16x16x32_bf16 v[112:115], v[124:127], v[72:75], v[112:115]
  s_waitcnt lgkmcnt(2)
  buffer_store_dwordx4 v[120:123], v2, s[4:7], s29 offen offset:1024 sc1
  v_mov_b64 v[36:37], 0
  v_exp_f32 v100, v16
  v_mfma_f32_16x16x32_bf16 v[112:115], v[104:107], v[76:79], v[112:115]
  s_waitcnt lgkmcnt(0)
  v_exp_f32 v101, v17
  v_mfma_f32_16x16x32_bf16 v[112:115], v[108:111], v[80:83], v[112:115]
  v_exp_f32 v102, v18
  v_mfma_f32_16x16x32_bf16 v[20:23], v[52:55], v[68:71], 0
  v_exp_f32 v103, v19
  v_mfma_f32_16x16x32_bf16 v[20:23], v[56:59], v[72:75], v[20:23]
  v_cvt_pk_bf16_f32 v44, v100, v101
  v_cvt_pk_bf16_f32 v45, v102, v103
  v_mfma_f32_16x16x32_bf16 v[20:23], v[60:63], v[76:79], v[20:23]
  s_add_u32 s29, s29, 131072
  v_exp_f32 v100, v112
  v_mfma_f32_16x16x32_bf16 v[20:23], v[64:67], v[80:83], v[20:23]
  v_exp_f32 v101, v113
  v_exp_f32 v102, v114
  v_exp_f32 v103, v115
  v_cvt_pk_bf16_f32 v84, v100, v101
  v_cvt_pk_bf16_f32 v85, v102, v103
  v_cndmask_b32 v48, v84, 0, s[16:17]
  v_cndmask_b32 v49, v85, 0, s[16:17]
  v_cndmask_b32 v50, 0, v84, s[16:17]
  v_cndmask_b32 v51, 0, v85, s[16:17]
  v_exp_f32 v100, v20
  v_mfma_f32_16x16x16_bf16 v[88:91], v[12:13], v[48:49], 0
  v_exp_f32 v101, v21
  v_mfma_f32_16x16x16_bf16 v[24:27], v[120:121], v[48:49], 0
  v_exp_f32 v102, v22
  v_mfma_f32_16x16x16_bf16 v[116:119], v[120:121], v[50:51], 0
  v_exp_f32 v103, v23
  v_cvt_pk_bf16_f32 v46, v100, v101
  v_cvt_pk_bf16_f32 v47, v102, v103
  v_mov_b64 v[38:39], 0
  s_nop 0
  v_mfma_f32_16x16x32_bf16 v[88:91], v[12:15], v[44:47], v[88:91]
  v_mov_b64 v[40:41], 0
  v_mov_b64 v[42:43], 0
  v_mfma_f32_16x16x32_bf16 v[24:27], v[28:31], v[44:47], v[24:27]
  ds_read_b128 v[52:55], v4 offset:24576
  ds_read_b128 v[56:59], v4 offset:25600
  v_mfma_f32_16x16x32_bf16 v[116:119], v[32:35], v[44:47], v[116:119]
  s_nop 1
T_back_96:
  v_rcp_f32 v89, v88
  v_subrev_u32 v100, s54, v88
  v_cmp_le_u32 vcc, s96, v100
  v_mul_f32 v24, v89, v24
  v_mul_f32 v25, v89, v25
  v_cvt_pk_bf16_f32 v124, v24, v25
  v_pk_mul_f32 v[26:27], v[26:27], v[88:89] op_sel:[0,1] op_sel_hi:[1,1]
  v_pk_mul_f32 v[116:117], v[116:117], v[88:89] op_sel:[0,1] op_sel_hi:[1,1]
  v_pk_mul_f32 v[118:119], v[118:119], v[88:89] op_sel:[0,1] op_sel_hi:[1,1]
  v_cvt_pk_bf16_f32 v125, v26, v27
  v_cvt_pk_bf16_f32 v126, v116, v117
  v_cvt_pk_bf16_f32 v127, v118, v119
  ds_write_b128 v11, v[124:127] offset:29696
  s_cbranch_vccnz T_slow_95
  v_smfmac_f32_16x16x64_bf16 v[92:95], v[124:127], a[160:167], v0
  s_mov_b32 s96, s55
  v_smfmac_f32_16x16x64_bf16 v[96:99], v[124:127], a[168:175], v0
  s_cmp_eq_u32 s14, 63
  v_smfmac_f32_16x16x64_bf16 v[36:39], v[124:127], a[176:183], v0
  s_waitcnt lgkmcnt(0)
  s_barrier
  ds_read_b128 v[104:107], v11 offset:29184
  ds_read_b128 v[108:111], v11 offset:30720
  ds_read_b128 v[68:71], v11 offset:30208
  s_cbranch_scc1 M_tdone
  v_smfmac_f32_16x16x64_bf16 v[40:43], v[124:127], a[184:191], v0
  s_waitcnt lgkmcnt(2)
  v_smfmac_f32_16x16x64_bf16 v[92:95], v[104:107], a[192:199], v0
  s_waitcnt lgkmcnt(1)
  ds_read_b128 v[76:79], v4 offset:28672
  v_smfmac_f32_16x16x64_bf16 v[92:95], v[108:111], a[224:231], v0
  s_waitcnt lgkmcnt(1)
  ds_read_b128 v[80:83], v4 offset:29696
  v_smfmac_f32_16x16x64_bf16 v[92:95], v[68:71], a[240:247], v0
  ds_read_b128 v[60:63], v4 offset:26624
  v_smfmac_f32_16x16x64_bf16 v[96:99], v[104:107], a[200:207], v0
  ds_read_b128 v[64:67], v4 offset:27648
  v_smfmac_f32_16x16x64_bf16 v[96:99], v[108:111], a[232:239], v0
  ds_read_b128 v[28:31], v4 offset:30720
  s_nop 0
  v_cvt_pk_bf16_f32 v16, v92, v93
  v_cvt_pk_bf16_f32 v17, v94, v95
  v_bfi_b32 v16, 1, s57, v16
  v_smfmac_f32_16x16x64_bf16 v[96:99], v[68:71], a[248:255], v0
  buffer_store_dwordx2 v[16:17], v7, s[4:7], s20 offen offset:0 sc1
  v_smfmac_f32_16x16x64_bf16 v[36:39], v[104:107], a[208:215], v0
  ds_read_b128 v[32:35], v4 offset:31744
  v_smfmac_f32_16x16x64_bf16 v[36:39], v[108:111], v[52:59], v0
  s_waitcnt lgkmcnt(4)
  s_nop 0
  v_cvt_pk_bf16_f32 v18, v96, v97
  v_cvt_pk_bf16_f32 v19, v98, v99
  v_bfi_b32 v18, 1, s57, v18
  v_smfmac_f32_16x16x64_bf16 v[36:39], v[68:71], v[76:83], v0
  buffer_store_dwordx2 v[18:19], v7, s[4:7], s20 offen offset:64 sc1
  v_smfmac_f32_16x16x64_bf16 v[40:43], v[104:107], a[216:223], v0
  s_waitcnt lgkmcnt(2)
  ds_read_b128 v[116:119], v2 offset:31232
  v_smfmac_f32_16x16x64_bf16 v[40:43], v[108:111], v[60:67], v0
  s_waitcnt lgkmcnt(1)
  s_nop 0
  v_cvt_pk_bf16_f32 v20, v36, v37
  v_cvt_pk_bf16_f32 v21, v38, v39
  v_bfi_b32 v20, 1, s57, v20
  v_smfmac_f32_16x16x64_bf16 v[40:43], v[68:71], v[28:35], v0
  buffer_store_dwordx2 v[20:21], v7, s[4:7], s21 offen offset:0 sc1
  s_nop 6
  v_cvt_pk_bf16_f32 v22, v40, v41
  v_cvt_pk_bf16_f32 v23, v42, v43
  v_bfi_b32 v22, 1, s57, v22
  buffer_store_dwordx2 v[22:23], v7, s[4:7], s21 offen offset:64 sc1
  ds_read_b128 v[68:71], v4 offset:0
  ds_read_b128 v[72:75], v4 offset:1024
  ds_read_b128 v[76:79], v4 offset:4096
  ds_read_b128 v[80:83], v4 offset:5120
  ds_read_b128 v[84:87], v4 offset:8192
  ds_read_b128 v[88:91], v4 offset:9216
  ds_read_b128 v[92:95], v4 offset:2048
  ds_read_b128 v[96:99], v4 offset:3072
  ds_read_b128 v[100:103], v4 offset:6144
  ds_read_b128 v[104:107], v4 offset:7168
  ds_read_b128 v[108:111], v4 offset:10240
  ds_read_b128 v[112:115], v4 offset:11264
  v_mov_b64 v[16:17], 0
  v_mov_b64 v[18:19], 0
  v_mov_b64 v[20:21], 0
  v_mov_b64 v[22:23], 0
  v_mov_b64 v[24:25], 0
  v_mov_b64 v[26:27], 0
  s_mov_b32 s19, 0
  v_mov_b32 v49, -1
  ds_read_b64 v[44:45], v2 offset:32256
  s_waitcnt lgkmcnt(0)
  v_readfirstlane_b32 s38, v44
  v_readfirstlane_b32 s37, v45
  s_nop 0
  s_lshl_b32 s38, s38, 1
  s_lshl1_add_u32 s37, s37, 1
  s_min_u32 s38, s38, s37
  s_cmp_ge_u32 s38, 64
  s_cselect_b32 s38, 100, s38
  s_sub_u32 s38, s38, 1
  s_max_i32 s30, s30, s38
  s_waitcnt vmcnt(0)
  buffer_load_dwordx4 v[52:55], v2, s[4:7], s22 offen offset:0 sc1
  buffer_load_dwordx4 v[56:59], v2, s[4:7], s22 offen offset:1024 sc1
  buffer_load_dwordx4 v[60:63], v2, s[4:7], s22 offen offset:2048 sc1
  buffer_load_dwordx4 v[64:67], v2, s[4:7], s22 offen offset:3072 sc1
  s_waitcnt lgkmcnt(12)
  s_waitcnt vmcnt(3)
  v_mfma_f32_16x16x32_bf16 v[120:123], v[116:119], v[52:55], 0
  v_xor_b32 v48, s57, v52
  v_bitop3_b32 v48, v48, v54, s57 bitop3:0xf6
  s_waitcnt vmcnt(2)
  v_mfma_f32_16x16x32_bf16 v[120:123], v[116:119], v[56:59], v[120:123]
  v_bitop3_b32 v48, v48, v56, s57 bitop3:0xf6
  v_bitop3_b32 v48, v48, v58, s57 bitop3:0xf6
  s_waitcnt vmcnt(1)
  v_mfma_f32_16x16x32_bf16 v[120:123], v[116:119], v[60:63], v[120:123]
  v_bitop3_b32 v48, v48, v60, s57 bitop3:0xf6
  v_bitop3_b32 v48, v48, v62, s57 bitop3:0xf6
  s_waitcnt vmcnt(0)
  v_mfma_f32_16x16x32_bf16 v[120:123], v[116:119], v[64:67], v[120:123]
  v_bitop3_b32 v48, v48, v64, s57 bitop3:0xf6
  v_bitop3_b32 v48, v48, v66, s57 bitop3:0xf6
  v_and_b32 v48, 1, v48
  v_cmp_ne_u32 vcc, 0, v48
  s_cbranch_vccnz T_p1re_98
T_p1ok_99:
  s_nop 2
  v_add_f32_dpp v120, v120, v120 row_ror:8 row_mask:0xf bank_mask:0xf
  v_add_f32_dpp v121, v121, v121 row_ror:8 row_mask:0xf bank_mask:0xf
  v_cvt_pk_bf16_f32 v48, v120, v121
  buffer_store_dword v48, v8, s[4:7], s35 offen sc1
  buffer_store_dword v49, v8, s[4:7], s26 offen sc1
  s_barrier
  ds_read_b128 v[28:31], v2 offset:17408
  ds_read_b128 v[32:35], v2 offset:21504
  ds_read_b128 v[36:39], v2 offset:8192
  ds_read_b128 v[40:43], v2 offset:9216
  ds_read_b128 v[44:47], v2 offset:10240
  ds_read_b128 v[48:51], v2 offset:11264
  buffer_load_dwordx4 v[124:127], v2, s[4:7], s24 offen offset:1024 sc1
  buffer_load_dwordx4 v[116:119], v2, s[4:7], s25 offen offset:1024 sc1
  ds_read_b128 v[52:55], v2 offset:12288
  ds_read_b128 v[56:59], v2 offset:13312
  ds_read_b128 v[60:63], v2 offset:14336
  ds_read_b128 v[64:67], v2 offset:15360
  buffer_load_dwordx4 v[124:127], v2, s[4:7], s24 offen offset:1024 sc1
  buffer_load_dwordx4 v[116:119], v2, s[4:7], s25 offen offset:1024 sc1
  s_add_u32 s14, s14, 1
  s_cmp_ge_i32 s14, s30
  s_cbranch_scc1 T_kvw_92
T_kvb_93:
  s_mov_b32 s19, 0
  s_branch T_loop_88
T_p1re_98:
  s_mov_b64 exec, vcc
  buffer_load_dwordx4 v[52:55], v2, s[4:7], s22 offen offset:0 sc1
  buffer_load_dwordx4 v[56:59], v2, s[4:7], s22 offen offset:1024 sc1
  buffer_load_dwordx4 v[60:63], v2, s[4:7], s22 offen offset:2048 sc1
  buffer_load_dwordx4 v[64:67], v2, s[4:7], s22 offen offset:3072 sc1
  s_mov_b64 exec, -1
  s_add_u32 s19, s19, 1
  s_cmp_gt_u32 s19, 32768
  s_cbranch_scc1 M_exit
  s_waitcnt vmcnt(3)
  v_mfma_f32_16x16x32_bf16 v[120:123], v[116:119], v[52:55], 0
  v_xor_b32 v48, s57, v52
  v_bitop3_b32 v48, v48, v54, s57 bitop3:0xf6
  s_waitcnt vmcnt(2)
  v_mfma_f32_16x16x32_bf16 v[120:123], v[116:119], v[56:59], v[120:123]
  v_bitop3_b32 v48, v48, v56, s57 bitop3:0xf6
  v_bitop3_b32 v48, v48, v58, s57 bitop3:0xf6
  s_waitcnt vmcnt(1)
  v_mfma_f32_16x16x32_bf16 v[120:123], v[116:119], v[60:63], v[120:123]
  v_bitop3_b32 v48, v48, v60, s57 bitop3:0xf6
  v_bitop3_b32 v48, v48, v62, s57 bitop3:0xf6
  s_waitcnt vmcnt(0)
  v_mfma_f32_16x16x32_bf16 v[120:123], v[116:119], v[64:67], v[120:123]
  v_bitop3_b32 v48, v48, v64, s57 bitop3:0xf6
  v_bitop3_b32 v48, v48, v66, s57 bitop3:0xf6
  v_and_b32 v48, 1, v48
  v_cmp_ne_u32 vcc, 0, v48
  s_cbranch_vccnz T_p1re_98
  s_branch T_p1ok_99
T_kvw_92:
  s_mov_b32 s19, 0
  s_branch T_kvok_101
T_kv_100:
  s_sleep 4
  s_add_u32 s19, s19, 1
  s_cmp_gt_u32 s19, 32768
  s_cbranch_scc1 M_exit
T_kvok_101:
  s_add_u32 s39, s99, 128
  s_mov_b32 s38, 0
  s_mov_b32 s37, 0
  s_atomic_or s38, s[58:59], s99 glc
  s_atomic_or s37, s[58:59], s39 glc
  s_waitcnt lgkmcnt(0)
  s_lshl_b32 s38, s38, 1
  s_lshl1_add_u32 s37, s37, 1
  s_min_u32 s38, s38, s37
  s_cmp_ge_u32 s38, 64
  s_cselect_b32 s38, 100, s38
  s_sub_u32 s38, s38, 1
  s_max_i32 s30, s30, s38
  s_cmp_ge_i32 s14, s30
  s_cbranch_scc1 T_kv_100
  s_branch T_kvb_93
T_slow_95:
  s_nop 7
  v_max3_f32 v100, v16, v17, v18
  v_max3_f32 v100, v100, v19, v20
  v_max3_f32 v100, v100, v21, v22
  v_max3_f32 v100, v100, v23, v112
  v_max3_f32 v100, v100, v113, v114
  v_max_f32 v100, v100, v115
  v_mov_b32 v101, v100
  s_nop 1
  v_permlane32_swap_b32 v100, v101
  s_nop 1
  v_max_f32 v100, v100, v101
  v_mov_b32 v101, v100
  s_nop 1
  v_permlane16_swap_b32 v100, v101
  s_nop 1
  v_max_f32 v100, v100, v101
  v_sub_f32 v16, v16, v100
  v_sub_f32 v17, v17, v100
  v_sub_f32 v18, v18, v100
  v_sub_f32 v19, v19, v100
  v_exp_f32 v16, v16
  v_exp_f32 v17, v17
  v_exp_f32 v18, v18
  v_exp_f32 v19, v19
  v_sub_f32 v20, v20, v100
  v_sub_f32 v21, v21, v100
  v_sub_f32 v22, v22, v100
  v_sub_f32 v23, v23, v100
  v_exp_f32 v20, v20
  v_exp_f32 v21, v21
  v_exp_f32 v22, v22
  v_exp_f32 v23, v23
  v_sub_f32 v112, v112, v100
  v_sub_f32 v113, v113, v100
  v_sub_f32 v114, v114, v100
  v_sub_f32 v115, v115, v100
  v_exp_f32 v112, v112
  v_exp_f32 v113, v113
  v_exp_f32 v114, v114
  v_exp_f32 v115, v115
  s_nop 0
  v_cvt_pk_bf16_f32 v44, v16, v17
  v_cvt_pk_bf16_f32 v45, v18, v19
  v_cvt_pk_bf16_f32 v46, v20, v21
  v_cvt_pk_bf16_f32 v47, v22, v23
  v_cvt_pk_bf16_f32 v84, v112, v113
  v_cvt_pk_bf16_f32 v85, v114, v115
  v_cndmask_b32 v48, v84, 0, s[16:17]
  v_cndmask_b32 v49, v85, 0, s[16:17]
  v_cndmask_b32 v50, 0, v84, s[16:17]
  v_cndmask_b32 v51, 0, v85, s[16:17]
  s_nop 1
  v_mfma_f32_16x16x16_bf16 v[88:91], v[12:13], v[48:49], 0
  v_mfma_f32_16x16x16_bf16 v[24:27], v[120:121], v[48:49], 0
  v_mfma_f32_16x16x16_bf16 v[116:119], v[120:121], v[50:51], 0
  v_mfma_f32_16x16x32_bf16 v[88:91], v[12:15], v[44:47], v[88:91]
  v_mfma_f32_16x16x32_bf16 v[24:27], v[28:31], v[44:47], v[24:27]
  v_mfma_f32_16x16x32_bf16 v[116:119], v[32:35], v[44:47], v[116:119]
  s_nop 7
  s_nop 1
  s_mov_b32 s96, -1
  s_branch T_back_96
T_w_72:
  s_mov_b32 s19, 0
  s_add_u32 s14, s14, 1
  s_and_b32 s57, s14, 1
  v_mov_b64 v[16:17], 0
  v_mov_b64 v[18:19], 0
  v_mov_b64 v[20:21], 0
  v_mov_b64 v[22:23], 0
  v_mov_b64 v[24:25], 0
  v_mov_b64 v[26:27], 0
  buffer_load_dwordx4 v[124:127], v2, s[4:7], s24 offen offset:2048 sc1
  buffer_load_dwordx4 v[116:119], v2, s[4:7], s25 offen offset:2048 sc1
  buffer_load_dwordx4 v[124:127], v2, s[4:7], s24 offen offset:2048 sc1
  buffer_load_dwordx4 v[116:119], v2, s[4:7], s25 offen offset:2048 sc1
  s_branch T_loop_102
.p2align 6
T_retry_103:
  s_mov_b64 exec, vcc
  buffer_load_dwordx4 v[124:127], v2, s[4:7], s24 offen offset:2048 sc1
  buffer_load_dwordx4 v[116:119], v2, s[4:7], s25 offen offset:2048 sc1
  s_mov_b64 exec, -1
  s_add_u32 s19, s19, 1
  s_cmp_gt_u32 s19, 32768
  s_cbranch_scc1 M_exit
  s_nop 0
  v_mov_b64 v[16:17], 0
  v_mov_b64 v[18:19], 0
T_loop_102:
  s_waitcnt vmcnt(3) lgkmcnt(0)
  v_max3_u32 v123, v124, v125, v126
  v_max_u32 v123, v123, v127
  v_mov_b32_dpp v120, v124 row_ror:8 row_mask:0xf bank_mask:0xf
  v_mov_b32_dpp v121, v125 row_ror:8 row_mask:0xf bank_mask:0xf
  s_waitcnt vmcnt(2)
  v_max3_u32 v123, v123, v116, v117
  v_max3_u32 v123, v123, v118, v119
  v_cmp_eq_u32 vcc, -1, v123
  v_smfmac_f32_16x16x64_bf16 v[16:19], v[124:127], v[68:75], v0
  s_cbranch_vccnz T_retry_103
  ds_write_b128 v2, v[124:127] offset:2048
  v_mov_b32_dpp v122, v126 row_ror:8 row_mask:0xf bank_mask:0xf
  v_smfmac_f32_16x16x64_bf16 v[20:23], v[124:127], v[76:83], v0
  s_and_b32 s57, s14, 1
  v_mov_b32_dpp v123, v127 row_ror:8 row_mask:0xf bank_mask:0xf
  v_smfmac_f32_16x16x64_bf16 v[24:27], v[124:127], v[84:91], v0
  s_and_b32 s36, s14, 3
  ds_write_b128 v2, v[116:119] offset:6144
  v_smfmac_f32_16x16x64_bf16 v[16:19], v[120:123], v[92:99], v0
  s_lshl_b32 s36, s36, 13
  v_mov_b32_dpp v84, v116 row_ror:8 row_mask:0xf bank_mask:0xf
  v_smfmac_f32_16x16x64_bf16 v[20:23], v[120:123], v[100:107], v0
  s_add_u32 s26, s36, s23
  ds_read_b128 v[68:71], v4 offset:12288
  v_mov_b32_dpp v85, v117 row_ror:8 row_mask:0xf bank_mask:0xf
  v_smfmac_f32_16x16x64_bf16 v[24:27], v[120:123], v[108:115], v0
  s_add_u32 s36, s36, 8192
  ds_read_b128 v[72:75], v4 offset:13312
  v_mov_b32_dpp v86, v118 row_ror:8 row_mask:0xf bank_mask:0xf
  v_smfmac_f32_16x16x64_bf16 v[16:19], v[116:119], v[224:231], v0
  s_and_b32 s36, s36, 0x7fff
  ds_read_b128 v[76:79], v4 offset:14336
  v_mov_b32_dpp v87, v119 row_ror:8 row_mask:0xf bank_mask:0xf
  v_smfmac_f32_16x16x64_bf16 v[20:23], v[116:119], v[240:247], v0
  s_waitcnt lgkmcnt(3)
  s_barrier
  ds_read_b128 v[100:103], v2 offset:3072
  v_smfmac_f32_16x16x64_bf16 v[24:27], v[116:119], a[0:7], v0
  s_mov_b32 m0, s31
  ds_read_b128 v[120:123], v1 offset:3072
  v_smfmac_f32_16x16x64_bf16 v[16:19], v[84:87], v[232:239], v0
  v_smfmac_f32_16x16x64_bf16 v[20:23], v[84:87], v[248:255], v0
  ds_read_b128 v[80:83], v4 offset:15360
  buffer_load_dwordx4 v9, s[4:7], s27 offen sc1 lds
  v_smfmac_f32_16x16x64_bf16 v[24:27], v[84:87], a[8:15], v0
  s_waitcnt lgkmcnt(2)
  s_mov_b32 m0, s32
  v_smfmac_f32_16x16x64_bf16 v[16:19], v[100:103], v[128:135], v0
  ds_read_b128 v[92:95], v2 offset:0
  v_smfmac_f32_16x16x64_bf16 v[20:23], v[100:103], v[144:151], v0
  ds_read_b128 v[96:99], v1 offset:0
  v_smfmac_f32_16x16x64_bf16 v[24:27], v[100:103], v[68:75], v0
  s_waitcnt vmcnt(1) lgkmcnt(3)
  ds_read_b128 v[116:119], v2 offset:1024
  buffer_load_dwordx4 v9, s[4:7], s27 offen offset:128 sc1 lds
  v_smfmac_f32_16x16x64_bf16 v[16:19], v[120:123], v[136:143], v0
  ds_read_b128 v[124:127], v1 offset:1024
  s_mov_b32 m0, s33
  v_smfmac_f32_16x16x64_bf16 v[20:23], v[120:123], v[152:159], v0
  s_waitcnt lgkmcnt(4)
  ds_read_b128 v[104:107], v2 offset:7168
  v_smfmac_f32_16x16x64_bf16 v[24:27], v[120:123], v[76:83], v0
  s_waitcnt lgkmcnt(4)
  ds_read_b128 v[108:111], v1 offset:7168
  v_smfmac_f32_16x16x64_bf16 v[16:19], v[92:95], v[160:167], v0
  s_waitcnt lgkmcnt(4)
  ds_read_b128 v[112:115], v2 offset:4096
  v_mov_b32 v122, s98
  buffer_load_dwordx4 v10, s[4:7], s28 offen sc1 lds
  v_smfmac_f32_16x16x64_bf16 v[16:19], v[96:99], v[168:175], v0
  s_waitcnt lgkmcnt(4)
  ds_read_b128 v[84:87], v1 offset:4096
  s_mov_b32 m0, s34
  v_smfmac_f32_16x16x64_bf16 v[16:19], v[116:119], v[192:199], v0
  s_waitcnt lgkmcnt(4)
  ds_read_b128 v[88:91], v2 offset:5120
  v_smfmac_f32_16x16x64_bf16 v[16:19], v[124:127], v[200:207], v0
  s_waitcnt lgkmcnt(4)
  ds_read_b128 v[100:103], v1 offset:5120
  v_smfmac_f32_16x16x64_bf16 v[16:19], v[104:107], a[16:23], v0
  s_waitcnt lgkmcnt(4)
  ds_read_b128 v[68:71], v4 offset:16384
  buffer_load_dwordx4 v10, s[4:7], s28 offen offset:256 sc1 lds
  v_smfmac_f32_16x16x64_bf16 v[16:19], v[108:111], a[24:31], v0
  s_waitcnt lgkmcnt(4)
  ds_read_b128 v[72:75], v4 offset:17408
  v_smfmac_f32_16x16x64_bf16 v[16:19], v[112:115], a[64:71], v0
  s_waitcnt lgkmcnt(4)
  ds_read_b128 v[76:79], v4 offset:18432
  v_smfmac_f32_16x16x64_bf16 v[16:19], v[84:87], a[72:79], v0
  s_waitcnt lgkmcnt(4)
  ds_read_b128 v[80:83], v4 offset:19456
  v_smfmac_f32_16x16x64_bf16 v[16:19], v[88:91], a[112:119], v0
  s_waitcnt lgkmcnt(4)
  buffer_store_dword v122, v3, s[4:7], s15 offen sc1
  v_smfmac_f32_16x16x64_bf16 v[16:19], v[100:103], a[120:127], v0
  s_add_u32 s98, s14, 1
  s_add_u32 s24, s36, 145752064
  s_add_u32 s25, s36, 145756160
  v_smfmac_f32_16x16x64_bf16 v[20:23], v[92:95], v[176:183], v0
  s_add_u32 s35, s36, s23
  v_smfmac_f32_16x16x64_bf16 v[20:23], v[96:99], v[184:191], v0
  s_waitcnt lgkmcnt(2)
  v_smfmac_f32_16x16x64_bf16 v[20:23], v[116:119], v[68:75], v0
  s_waitcnt lgkmcnt(0)
  ds_read_b128 v[68:71], v4 offset:20480
  v_mul_f32 v16, s18, v16
  v_smfmac_f32_16x16x64_bf16 v[20:23], v[124:127], v[76:83], v0
  ds_read_b128 v[72:75], v4 offset:21504
  v_mul_f32 v17, s18, v17
  v_smfmac_f32_16x16x64_bf16 v[20:23], v[104:107], a[32:39], v0
  ds_read_b128 v[76:79], v4 offset:22528
  v_mul_f32 v18, s18, v18
  v_smfmac_f32_16x16x64_bf16 v[20:23], v[108:111], a[40:47], v0
  ds_read_b128 v[80:83], v4 offset:23552
  v_mul_f32 v19, s18, v19
  v_smfmac_f32_16x16x64_bf16 v[20:23], v[112:115], a[80:87], v0
  v_cvt_pk_bf16_f32 v120, v16, v17
  v_smfmac_f32_16x16x64_bf16 v[20:23], v[84:87], a[88:95], v0
  v_cvt_pk_bf16_f32 v121, v18, v19
  v_smfmac_f32_16x16x64_bf16 v[20:23], v[88:91], a[128:135], v0
  ds_write_b64 v5, v[120:121] offset:24576
  v_smfmac_f32_16x16x64_bf16 v[20:23], v[100:103], a[136:143], v0
  s_waitcnt lgkmcnt(3)
  v_smfmac_f32_16x16x64_bf16 v[24:27], v[92:95], v[68:75], v0
  s_waitcnt lgkmcnt(1)
  v_mov_b64 v[92:93], 0
  v_smfmac_f32_16x16x64_bf16 v[24:27], v[96:99], v[76:83], v0
  s_nop 1
  v_cvt_pk_bf16_f32 v122, v20, v21
  v_cvt_pk_bf16_f32 v123, v22, v23
  v_smfmac_f32_16x16x64_bf16 v[24:27], v[116:119], v[208:215], v0
  ds_write_b64 v5, v[122:123] offset:26880
  v_mov_b64 v[94:95], 0
  v_smfmac_f32_16x16x64_bf16 v[24:27], v[124:127], v[216:223], v0
  s_waitcnt lgkmcnt(1)
  s_barrier
  ds_read_b64_tr_b16 v[68:69], v6 offset:24576
  v_smfmac_f32_16x16x64_bf16 v[24:27], v[104:107], a[48:55], v0
  s_add_u32 s27, s27, 8192
  ds_read_b64_tr_b16 v[70:71], v6 offset:24640
  ds_read_b64_tr_b16 v[72:73], v6 offset:24832
  v_smfmac_f32_16x16x64_bf16 v[24:27], v[108:111], a[56:63], v0
  s_add_u32 s28, s28, 8192
  ds_read_b64_tr_b16 v[74:75], v6 offset:24896
  ds_read_b64_tr_b16 v[76:77], v6 offset:25088
  v_smfmac_f32_16x16x64_bf16 v[24:27], v[112:115], a[96:103], v0
  s_nop 0
  ds_read_b64_tr_b16 v[78:79], v6 offset:25152
  ds_read_b64_tr_b16 v[80:81], v6 offset:25344
  v_smfmac_f32_16x16x64_bf16 v[24:27], v[84:87], a[104:111], v0
  ds_read_b64_tr_b16 v[82:83], v6 offset:25408
  v_mov_b64 v[96:97], 0
  v_smfmac_f32_16x16x64_bf16 v[24:27], v[88:91], a[144:151], v0
  s_waitcnt lgkmcnt(8)
  s_barrier
  ds_read_b64_tr_b16 v[116:117], v6 offset:26880
  v_smfmac_f32_16x16x64_bf16 v[24:27], v[100:103], a[152:159], v0
  s_waitcnt lgkmcnt(7)
  ds_read_b64_tr_b16 v[118:119], v6 offset:26944
  v_mfma_f32_16x16x32_bf16 v[16:19], v[36:39], v[68:71], 0
  s_waitcnt lgkmcnt(6)
  ds_read_b64_tr_b16 v[124:125], v6 offset:27136
  ds_read_b64_tr_b16 v[126:127], v6 offset:27200
  v_mfma_f32_16x16x32_bf16 v[16:19], v[40:43], v[72:75], v[16:19]
  s_waitcnt lgkmcnt(6)
  ds_read_b64_tr_b16 v[104:105], v6 offset:27392
  ds_read_b64_tr_b16 v[106:107], v6 offset:27456
  v_mfma_f32_16x16x32_bf16 v[16:19], v[44:47], v[76:79], v[16:19]
  s_waitcnt lgkmcnt(6)
  ds_read_b64_tr_b16 v[108:109], v6 offset:27648
  ds_read_b64_tr_b16 v[110:111], v6 offset:27712
  v_mfma_f32_16x16x32_bf16 v[16:19], v[48:51], v[80:83], v[16:19]
  s_waitcnt lgkmcnt(6)
  v_cvt_pk_bf16_f32 v120, v24, v25
  v_cvt_pk_bf16_f32 v121, v26, v27
  v_mfma_f32_16x16x32_bf16 v[112:115], v[116:119], v[68:71], 0
  s_waitcnt lgkmcnt(4)
  v_mov_b64 v[98:99], 0
  v_mfma_f32_16x16x32_bf16 v[112:115], v[124:127], v[72:75], v[112:115]
  s_waitcnt lgkmcnt(2)
  v_mov_b64 v[36:37], 0
  v_exp_f32 v100, v16
  v_mfma_f32_16x16x32_bf16 v[112:115], v[104:107], v[76:79], v[112:115]
  s_waitcnt lgkmcnt(0)
  buffer_store_dwordx4 v[120:123], v2, s[4:7], s29 offen offset:2048 sc1
  v_exp_f32 v101, v17
  v_mfma_f32_16x16x32_bf16 v[112:115], v[108:111], v[80:83], v[112:115]
  v_exp_f32 v102, v18
  v_mfma_f32_16x16x32_bf16 v[20:23], v[52:55], v[68:71], 0
  v_exp_f32 v103, v19
  v_mfma_f32_16x16x32_bf16 v[20:23], v[56:59], v[72:75], v[20:23]
  v_cvt_pk_bf16_f32 v44, v100, v101
  v_cvt_pk_bf16_f32 v45, v102, v103
  v_mfma_f32_16x16x32_bf16 v[20:23], v[60:63], v[76:79], v[20:23]
  s_add_u32 s29, s29, 131072
  v_exp_f32 v100, v112
  v_mfma_f32_16x16x32_bf16 v[20:23], v[64:67], v[80:83], v[20:23]
  v_exp_f32 v101, v113
  v_exp_f32 v102, v114
  v_exp_f32 v103, v115
  v_cvt_pk_bf16_f32 v84, v100, v101
  v_cvt_pk_bf16_f32 v85, v102, v103
  v_cndmask_b32 v48, v84, 0, s[16:17]
  v_cndmask_b32 v49, v85, 0, s[16:17]
  v_cndmask_b32 v50, 0, v84, s[16:17]
  v_cndmask_b32 v51, 0, v85, s[16:17]
  v_exp_f32 v100, v20
  v_mfma_f32_16x16x16_bf16 v[88:91], v[12:13], v[48:49], 0
  v_exp_f32 v101, v21
  v_mfma_f32_16x16x16_bf16 v[24:27], v[120:121], v[48:49], 0
  v_exp_f32 v102, v22
  v_mfma_f32_16x16x16_bf16 v[116:119], v[120:121], v[50:51], 0
  v_exp_f32 v103, v23
  v_cvt_pk_bf16_f32 v46, v100, v101
  v_cvt_pk_bf16_f32 v47, v102, v103
  v_mov_b64 v[38:39], 0
  s_nop 0
  v_mfma_f32_16x16x32_bf16 v[88:91], v[12:15], v[44:47], v[88:91]
  v_mov_b64 v[40:41], 0
  v_mov_b64 v[42:43], 0
  v_mfma_f32_16x16x32_bf16 v[24:27], v[28:31], v[44:47], v[24:27]
  ds_read_b128 v[52:55], v4 offset:24576
  ds_read_b128 v[56:59], v4 offset:25600
  v_mfma_f32_16x16x32_bf16 v[116:119], v[32:35], v[44:47], v[116:119]
  s_nop 1
T_back_110:
  v_rcp_f32 v89, v88
  v_subrev_u32 v100, s54, v88
  v_cmp_le_u32 vcc, s96, v100
  v_mul_f32 v24, v89, v24
  v_mul_f32 v25, v89, v25
  v_cvt_pk_bf16_f32 v124, v24, v25
  v_pk_mul_f32 v[26:27], v[26:27], v[88:89] op_sel:[0,1] op_sel_hi:[1,1]
  v_pk_mul_f32 v[116:117], v[116:117], v[88:89] op_sel:[0,1] op_sel_hi:[1,1]
  v_pk_mul_f32 v[118:119], v[118:119], v[88:89] op_sel:[0,1] op_sel_hi:[1,1]
  v_cvt_pk_bf16_f32 v125, v26, v27
  v_cvt_pk_bf16_f32 v126, v116, v117
  v_cvt_pk_bf16_f32 v127, v118, v119
  ds_write_b128 v11, v[124:127] offset:30208
  s_cbranch_vccnz T_slow_109
  v_smfmac_f32_16x16x64_bf16 v[92:95], v[124:127], a[160:167], v0
  s_mov_b32 s96, s55
  v_smfmac_f32_16x16x64_bf16 v[96:99], v[124:127], a[168:175], v0
  s_cmp_eq_u32 s14, 63
  v_smfmac_f32_16x16x64_bf16 v[36:39], v[124:127], a[176:183], v0
  s_waitcnt lgkmcnt(0)
  s_barrier
  ds_read_b128 v[104:107], v11 offset:30720
  ds_read_b128 v[108:111], v11 offset:29184
  ds_read_b128 v[68:71], v11 offset:29696
  s_cbranch_scc1 M_tdone
  v_smfmac_f32_16x16x64_bf16 v[40:43], v[124:127], a[184:191], v0
  s_waitcnt lgkmcnt(2)
  v_smfmac_f32_16x16x64_bf16 v[92:95], v[104:107], a[192:199], v0
  s_waitcnt lgkmcnt(1)
  ds_read_b128 v[76:79], v4 offset:28672
  v_smfmac_f32_16x16x64_bf16 v[92:95], v[108:111], a[224:231], v0
  s_waitcnt lgkmcnt(1)
  ds_read_b128 v[80:83], v4 offset:29696
  v_smfmac_f32_16x16x64_bf16 v[92:95], v[68:71], a[240:247], v0
  ds_read_b128 v[60:63], v4 offset:26624
  v_smfmac_f32_16x16x64_bf16 v[96:99], v[104:107], a[200:207], v0
  ds_read_b128 v[64:67], v4 offset:27648
  v_smfmac_f32_16x16x64_bf16 v[96:99], v[108:111], a[232:239], v0
  ds_read_b128 v[28:31], v4 offset:30720
  s_nop 0
  v_cvt_pk_bf16_f32 v16, v92, v93
  v_cvt_pk_bf16_f32 v17, v94, v95
  v_bfi_b32 v16, 1, s57, v16
  v_smfmac_f32_16x16x64_bf16 v[96:99], v[68:71], a[248:255], v0
  buffer_store_dwordx2 v[16:17], v7, s[4:7], s20 offen offset:0 sc1
  v_smfmac_f32_16x16x64_bf16 v[36:39], v[104:107], a[208:215], v0
  ds_read_b128 v[32:35], v4 offset:31744
  v_smfmac_f32_16x16x64_bf16 v[36:39], v[108:111], v[52:59], v0
  s_waitcnt lgkmcnt(4)
  s_nop 0
  v_cvt_pk_bf16_f32 v18, v96, v97
  v_cvt_pk_bf16_f32 v19, v98, v99
  v_bfi_b32 v18, 1, s57, v18
  v_smfmac_f32_16x16x64_bf16 v[36:39], v[68:71], v[76:83], v0
  buffer_store_dwordx2 v[18:19], v7, s[4:7], s20 offen offset:64 sc1
  v_smfmac_f32_16x16x64_bf16 v[40:43], v[104:107], a[216:223], v0
  s_waitcnt lgkmcnt(2)
  v_smfmac_f32_16x16x64_bf16 v[40:43], v[108:111], v[60:67], v0
  s_waitcnt lgkmcnt(0)
  s_nop 0
  v_cvt_pk_bf16_f32 v20, v36, v37
  v_cvt_pk_bf16_f32 v21, v38, v39
  v_bfi_b32 v20, 1, s57, v20
  v_smfmac_f32_16x16x64_bf16 v[40:43], v[68:71], v[28:35], v0
  buffer_store_dwordx2 v[20:21], v7, s[4:7], s21 offen offset:0 sc1
  s_nop 6
  v_cvt_pk_bf16_f32 v22, v40, v41
  v_cvt_pk_bf16_f32 v23, v42, v43
  v_bfi_b32 v22, 1, s57, v22
  buffer_store_dwordx2 v[22:23], v7, s[4:7], s21 offen offset:64 sc1
  ds_read_b128 v[68:71], v4 offset:0
  ds_read_b128 v[72:75], v4 offset:1024
  ds_read_b128 v[76:79], v4 offset:4096
  ds_read_b128 v[80:83], v4 offset:5120
  ds_read_b128 v[84:87], v4 offset:8192
  ds_read_b128 v[88:91], v4 offset:9216
  ds_read_b128 v[92:95], v4 offset:2048
  ds_read_b128 v[96:99], v4 offset:3072
  ds_read_b128 v[100:103], v4 offset:6144
  ds_read_b128 v[104:107], v4 offset:7168
  ds_read_b128 v[108:111], v4 offset:10240
  ds_read_b128 v[112:115], v4 offset:11264
  v_mov_b64 v[16:17], 0
  v_mov_b64 v[18:19], 0
  v_mov_b64 v[20:21], 0
  v_mov_b64 v[22:23], 0
  v_mov_b64 v[24:25], 0
  v_mov_b64 v[26:27], 0
  ds_read_b64 v[44:45], v2 offset:32256
  s_waitcnt lgkmcnt(0)
  v_readfirstlane_b32 s38, v44
  v_readfirstlane_b32 s37, v45
  s_nop 0
  s_lshl_b32 s38, s38, 1
  s_lshl1_add_u32 s37, s37, 1
  s_min_u32 s38, s38, s37
  s_cmp_ge_u32 s38, 64
  s_cselect_b32 s38, 100, s38
  s_sub_u32 s38, s38, 1
  s_max_i32 s30, s30, s38
  s_waitcnt vmcnt(4)
  s_barrier
  ds_read_b128 v[28:31], v2 offset:18432
  ds_read_b128 v[32:35], v2 offset:22528
  ds_read_b128 v[36:39], v2 offset:8192
  ds_read_b128 v[40:43], v2 offset:9216
  ds_read_b128 v[44:47], v2 offset:10240
  ds_read_b128 v[48:51], v2 offset:11264
  buffer_load_dwordx4 v[124:127], v2, s[4:7], s24 offen offset:2048 sc1
  buffer_load_dwordx4 v[116:119], v2, s[4:7], s25 offen offset:2048 sc1
  ds_read_b128 v[52:55], v2 offset:12288
  ds_read_b128 v[56:59], v2 offset:13312
  ds_read_b128 v[60:63], v2 offset:14336
  ds_read_b128 v[64:67], v2 offset:15360
  buffer_load_dwordx4 v[124:127], v2, s[4:7], s24 offen offset:2048 sc1
  buffer_load_dwordx4 v[116:119], v2, s[4:7], s25 offen offset:2048 sc1
  s_add_u32 s14, s14, 1
  s_cmp_ge_i32 s14, s30
  s_cbranch_scc1 T_kvw_106
T_kvb_107:
  s_mov_b32 s19, 0
  s_branch T_loop_102
T_kvw_106:
  s_mov_b32 s19, 0
  s_branch T_kvok_115
T_kv_114:
  s_sleep 4
  s_add_u32 s19, s19, 1
  s_cmp_gt_u32 s19, 32768
  s_cbranch_scc1 M_exit
T_kvok_115:
  s_add_u32 s39, s99, 128
  s_mov_b32 s38, 0
  s_mov_b32 s37, 0
  s_atomic_or s38, s[58:59], s99 glc
  s_atomic_or s37, s[58:59], s39 glc
  s_waitcnt lgkmcnt(0)
  s_lshl_b32 s38, s38, 1
  s_lshl1_add_u32 s37, s37, 1
  s_min_u32 s38, s38, s37
  s_cmp_ge_u32 s38, 64
  s_cselect_b32 s38, 100, s38
  s_sub_u32 s38, s38, 1
  s_max_i32 s30, s30, s38
  s_cmp_ge_i32 s14, s30
  s_cbranch_scc1 T_kv_114
  s_branch T_kvb_107
T_slow_109:
  s_nop 7
  v_max3_f32 v100, v16, v17, v18
  v_max3_f32 v100, v100, v19, v20
  v_max3_f32 v100, v100, v21, v22
  v_max3_f32 v100, v100, v23, v112
  v_max3_f32 v100, v100, v113, v114
  v_max_f32 v100, v100, v115
  v_mov_b32 v101, v100
  s_nop 1
  v_permlane32_swap_b32 v100, v101
  s_nop 1
  v_max_f32 v100, v100, v101
  v_mov_b32 v101, v100
  s_nop 1
  v_permlane16_swap_b32 v100, v101
  s_nop 1
  v_max_f32 v100, v100, v101
  v_sub_f32 v16, v16, v100
  v_sub_f32 v17, v17, v100
  v_sub_f32 v18, v18, v100
  v_sub_f32 v19, v19, v100
  v_exp_f32 v16, v16
  v_exp_f32 v17, v17
  v_exp_f32 v18, v18
  v_exp_f32 v19, v19
  v_sub_f32 v20, v20, v100
  v_sub_f32 v21, v21, v100
  v_sub_f32 v22, v22, v100
  v_sub_f32 v23, v23, v100
  v_exp_f32 v20, v20
  v_exp_f32 v21, v21
  v_exp_f32 v22, v22
  v_exp_f32 v23, v23
  v_sub_f32 v112, v112, v100
  v_sub_f32 v113, v113, v100
  v_sub_f32 v114, v114, v100
  v_sub_f32 v115, v115, v100
  v_exp_f32 v112, v112
  v_exp_f32 v113, v113
  v_exp_f32 v114, v114
  v_exp_f32 v115, v115
  s_nop 0
  v_cvt_pk_bf16_f32 v44, v16, v17
  v_cvt_pk_bf16_f32 v45, v18, v19
  v_cvt_pk_bf16_f32 v46, v20, v21
  v_cvt_pk_bf16_f32 v47, v22, v23
  v_cvt_pk_bf16_f32 v84, v112, v113
  v_cvt_pk_bf16_f32 v85, v114, v115
  v_cndmask_b32 v48, v84, 0, s[16:17]
  v_cndmask_b32 v49, v85, 0, s[16:17]
  v_cndmask_b32 v50, 0, v84, s[16:17]
  v_cndmask_b32 v51, 0, v85, s[16:17]
  s_nop 1
  v_mfma_f32_16x16x16_bf16 v[88:91], v[12:13], v[48:49], 0
  v_mfma_f32_16x16x16_bf16 v[24:27], v[120:121], v[48:49], 0
  v_mfma_f32_16x16x16_bf16 v[116:119], v[120:121], v[50:51], 0
  v_mfma_f32_16x16x32_bf16 v[88:91], v[12:15], v[44:47], v[88:91]
  v_mfma_f32_16x16x32_bf16 v[24:27], v[28:31], v[44:47], v[24:27]
  v_mfma_f32_16x16x32_bf16 v[116:119], v[32:35], v[44:47], v[116:119]
  s_nop 7
  s_nop 1
  s_mov_b32 s96, -1
  s_branch T_back_110
T_w_73:
  s_mov_b32 s19, 0
  s_add_u32 s14, s14, 1
  s_and_b32 s57, s14, 1
  v_mov_b64 v[16:17], 0
  v_mov_b64 v[18:19], 0
  v_mov_b64 v[20:21], 0
  v_mov_b64 v[22:23], 0
  v_mov_b64 v[24:25], 0
  v_mov_b64 v[26:27], 0
  buffer_load_dwordx4 v[124:127], v2, s[4:7], s24 offen offset:3072 sc1
  buffer_load_dwordx4 v[116:119], v2, s[4:7], s25 offen offset:3072 sc1
  buffer_load_dwordx4 v[124:127], v2, s[4:7], s24 offen offset:3072 sc1
  buffer_load_dwordx4 v[116:119], v2, s[4:7], s25 offen offset:3072 sc1
  s_branch T_loop_116
.p2align 6
T_retry_117:
  s_mov_b64 exec, vcc
  buffer_load_dwordx4 v[124:127], v2, s[4:7], s24 offen offset:3072 sc1
  buffer_load_dwordx4 v[116:119], v2, s[4:7], s25 offen offset:3072 sc1
  s_mov_b64 exec, -1
  s_add_u32 s19, s19, 1
  s_cmp_gt_u32 s19, 32768
  s_cbranch_scc1 M_exit
  s_nop 0
  v_mov_b64 v[16:17], 0
  v_mov_b64 v[18:19], 0
T_loop_116:
  s_waitcnt vmcnt(3) lgkmcnt(0)
  v_max3_u32 v123, v124, v125, v126
  v_max_u32 v123, v123, v127
  v_mov_b32_dpp v120, v124 row_ror:8 row_mask:0xf bank_mask:0xf
  v_mov_b32_dpp v121, v125 row_ror:8 row_mask:0xf bank_mask:0xf
  s_waitcnt vmcnt(2)
  v_max3_u32 v123, v123, v116, v117
  v_max3_u32 v123, v123, v118, v119
  v_cmp_eq_u32 vcc, -1, v123
  v_smfmac_f32_16x16x64_bf16 v[16:19], v[124:127], v[68:75], v0
  s_cbranch_vccnz T_retry_117
  ds_write_b128 v2, v[124:127] offset:3072
  v_mov_b32_dpp v122, v126 row_ror:8 row_mask:0xf bank_mask:0xf
  v_smfmac_f32_16x16x64_bf16 v[20:23], v[124:127], v[76:83], v0
  s_and_b32 s57, s14, 1
  v_mov_b32_dpp v123, v127 row_ror:8 row_mask:0xf bank_mask:0xf
  v_smfmac_f32_16x16x64_bf16 v[24:27], v[124:127], v[84:91], v0
  s_and_b32 s36, s14, 3
  ds_write_b128 v2, v[116:119] offset:7168
  v_smfmac_f32_16x16x64_bf16 v[16:19], v[120:123], v[92:99], v0
  s_lshl_b32 s36, s36, 13
  v_mov_b32_dpp v84, v116 row_ror:8 row_mask:0xf bank_mask:0xf
  v_smfmac_f32_16x16x64_bf16 v[20:23], v[120:123], v[100:107], v0
  s_add_u32 s26, s36, s23
  ds_read_b128 v[68:71], v4 offset:12288
  v_mov_b32_dpp v85, v117 row_ror:8 row_mask:0xf bank_mask:0xf
  v_smfmac_f32_16x16x64_bf16 v[24:27], v[120:123], v[108:115], v0
  s_add_u32 s36, s36, 8192
  ds_read_b128 v[72:75], v4 offset:13312
  v_mov_b32_dpp v86, v118 row_ror:8 row_mask:0xf bank_mask:0xf
  v_smfmac_f32_16x16x64_bf16 v[16:19], v[116:119], v[224:231], v0
  s_and_b32 s36, s36, 0x7fff
  ds_read_b128 v[76:79], v4 offset:14336
  v_mov_b32_dpp v87, v119 row_ror:8 row_mask:0xf bank_mask:0xf
  v_smfmac_f32_16x16x64_bf16 v[20:23], v[116:119], v[240:247], v0
  s_waitcnt lgkmcnt(3)
  s_barrier
  ds_read_b128 v[100:103], v2 offset:2048
  v_smfmac_f32_16x16x64_bf16 v[24:27], v[116:119], a[0:7], v0
  s_mov_b32 m0, s31
  ds_read_b128 v[120:123], v1 offset:2048
  v_smfmac_f32_16x16x64_bf16 v[16:19], v[84:87], v[232:239], v0
  v_smfmac_f32_16x16x64_bf16 v[20:23], v[84:87], v[248:255], v0
  ds_read_b128 v[80:83], v4 offset:15360
  v_smfmac_f32_16x16x64_bf16 v[24:27], v[84:87], a[8:15], v0
  s_waitcnt lgkmcnt(2)
  buffer_load_dwordx4 v9, s[4:7], s27 offen sc1 lds
  v_smfmac_f32_16x16x64_bf16 v[16:19], v[100:103], v[128:135], v0
  ds_read_b128 v[92:95], v2 offset:1024
  s_mov_b32 m0, s32
  v_smfmac_f32_16x16x64_bf16 v[20:23], v[100:103], v[144:151], v0
  ds_read_b128 v[96:99], v1 offset:1024
  v_smfmac_f32_16x16x64_bf16 v[24:27], v[100:103], v[68:75], v0
  s_waitcnt vmcnt(1) lgkmcnt(3)
  ds_read_b128 v[116:119], v2 offset:0
  v_smfmac_f32_16x16x64_bf16 v[16:19], v[120:123], v[136:143], v0
  ds_read_b128 v[124:127], v1 offset:0
  buffer_load_dwordx4 v9, s[4:7], s27 offen offset:128 sc1 lds
  v_smfmac_f32_16x16x64_bf16 v[20:23], v[120:123], v[152:159], v0
  s_waitcnt lgkmcnt(4)
  ds_read_b128 v[104:107], v2 offset:6144
  s_mov_b32 m0, s33
  v_smfmac_f32_16x16x64_bf16 v[24:27], v[120:123], v[76:83], v0
  s_waitcnt lgkmcnt(4)
  ds_read_b128 v[108:111], v1 offset:6144
  v_smfmac_f32_16x16x64_bf16 v[16:19], v[92:95], v[160:167], v0
  s_waitcnt lgkmcnt(4)
  ds_read_b128 v[112:115], v2 offset:5120
  v_smfmac_f32_16x16x64_bf16 v[16:19], v[96:99], v[168:175], v0
  s_waitcnt lgkmcnt(4)
  ds_read_b128 v[84:87], v1 offset:5120
  buffer_load_dwordx4 v10, s[4:7], s28 offen sc1 lds
  v_smfmac_f32_16x16x64_bf16 v[16:19], v[116:119], v[192:199], v0
  s_waitcnt lgkmcnt(4)
  ds_read_b128 v[88:91], v2 offset:4096
  s_mov_b32 m0, s34
  v_smfmac_f32_16x16x64_bf16 v[16:19], v[124:127], v[200:207], v0
  s_waitcnt lgkmcnt(4)
  ds_read_b128 v[100:103], v1 offset:4096
  v_smfmac_f32_16x16x64_bf16 v[16:19], v[104:107], a[16:23], v0
  s_waitcnt lgkmcnt(4)
  ds_read_b128 v[68:71], v4 offset:16384
  v_smfmac_f32_16x16x64_bf16 v[16:19], v[108:111], a[24:31], v0
  s_waitcnt lgkmcnt(4)
  ds_read_b128 v[72:75], v4 offset:17408
  buffer_load_dwordx4 v10, s[4:7], s28 offen offset:256 sc1 lds
  v_smfmac_f32_16x16x64_bf16 v[16:19], v[112:115], a[64:71], v0
  s_waitcnt lgkmcnt(4)
  ds_read_b128 v[76:79], v4 offset:18432
  s_mov_b32 m0, 32256
  v_smfmac_f32_16x16x64_bf16 v[16:19], v[84:87], a[72:79], v0
  s_waitcnt lgkmcnt(4)
  ds_read_b128 v[80:83], v4 offset:19456
  v_smfmac_f32_16x16x64_bf16 v[16:19], v[88:91], a[112:119], v0
  s_waitcnt lgkmcnt(4)
  v_smfmac_f32_16x16x64_bf16 v[16:19], v[100:103], a[120:127], v0
  buffer_load_dword v3, s[4:7], s99 offen sc1 lds
  s_add_u32 s24, s36, 145752064
  s_add_u32 s25, s36, 145756160
  v_smfmac_f32_16x16x64_bf16 v[20:23], v[92:95], v[176:183], v0
  s_add_u32 s35, s36, s23
  v_smfmac_f32_16x16x64_bf16 v[20:23], v[96:99], v[184:191], v0
  s_waitcnt lgkmcnt(2)
  v_smfmac_f32_16x16x64_bf16 v[20:23], v[116:119], v[68:75], v0
  s_waitcnt lgkmcnt(0)
  ds_read_b128 v[68:71], v4 offset:20480
  v_mul_f32 v16, s18, v16
  v_smfmac_f32_16x16x64_bf16 v[20:23], v[124:127], v[76:83], v0
  ds_read_b128 v[72:75], v4 offset:21504
  v_mul_f32 v17, s18, v17
  v_smfmac_f32_16x16x64_bf16 v[20:23], v[104:107], a[32:39], v0
  ds_read_b128 v[76:79], v4 offset:22528
  v_mul_f32 v18, s18, v18
  v_smfmac_f32_16x16x64_bf16 v[20:23], v[108:111], a[40:47], v0
  ds_read_b128 v[80:83], v4 offset:23552
  v_mul_f32 v19, s18, v19
  v_smfmac_f32_16x16x64_bf16 v[20:23], v[112:115], a[80:87], v0
  v_cvt_pk_bf16_f32 v120, v16, v17
  v_smfmac_f32_16x16x64_bf16 v[20:23], v[84:87], a[88:95], v0
  v_cvt_pk_bf16_f32 v121, v18, v19
  v_smfmac_f32_16x16x64_bf16 v[20:23], v[88:91], a[128:135], v0
  ds_write_b64 v5, v[120:121] offset:24576
  v_smfmac_f32_16x16x64_bf16 v[20:23], v[100:103], a[136:143], v0
  s_waitcnt lgkmcnt(3)
  v_smfmac_f32_16x16x64_bf16 v[24:27], v[92:95], v[68:75], v0
  s_waitcnt lgkmcnt(1)
  v_mov_b64 v[92:93], 0
  v_smfmac_f32_16x16x64_bf16 v[24:27], v[96:99], v[76:83], v0
  s_nop 1
  v_cvt_pk_bf16_f32 v122, v20, v21
  v_cvt_pk_bf16_f32 v123, v22, v23
  v_smfmac_f32_16x16x64_bf16 v[24:27], v[116:119], v[208:215], v0
  ds_write_b64 v5, v[122:123] offset:26880
  v_mov_b64 v[94:95], 0
  v_smfmac_f32_16x16x64_bf16 v[24:27], v[124:127], v[216:223], v0
  s_waitcnt lgkmcnt(1)
  s_barrier
  ds_read_b64_tr_b16 v[68:69], v6 offset:24576
  v_smfmac_f32_16x16x64_bf16 v[24:27], v[104:107], a[48:55], v0
  s_add_u32 s27, s27, 8192
  ds_read_b64_tr_b16 v[70:71], v6 offset:24640
  ds_read_b64_tr_b16 v[72:73], v6 offset:24832
  v_smfmac_f32_16x16x64_bf16 v[24:27], v[108:111], a[56:63], v0
  s_add_u32 s28, s28, 8192
  ds_read_b64_tr_b16 v[74:75], v6 offset:24896
  ds_read_b64_tr_b16 v[76:77], v6 offset:25088
  v_smfmac_f32_16x16x64_bf16 v[24:27], v[112:115], a[96:103], v0
  s_nop 0
  ds_read_b64_tr_b16 v[78:79], v6 offset:25152
  ds_read_b64_tr_b16 v[80:81], v6 offset:25344
  v_smfmac_f32_16x16x64_bf16 v[24:27], v[84:87], a[104:111], v0
  ds_read_b64_tr_b16 v[82:83], v6 offset:25408
  v_mov_b64 v[96:97], 0
  v_smfmac_f32_16x16x64_bf16 v[24:27], v[88:91], a[144:151], v0
  s_waitcnt lgkmcnt(8)
  s_barrier
  ds_read_b64_tr_b16 v[116:117], v6 offset:26880
  v_smfmac_f32_16x16x64_bf16 v[24:27], v[100:103], a[152:159], v0
  s_waitcnt lgkmcnt(7)
  ds_read_b64_tr_b16 v[118:119], v6 offset:26944
  v_mfma_f32_16x16x32_bf16 v[16:19], v[36:39], v[68:71], 0
  s_waitcnt lgkmcnt(6)
  ds_read_b64_tr_b16 v[124:125], v6 offset:27136
  ds_read_b64_tr_b16 v[126:127], v6 offset:27200
  v_mfma_f32_16x16x32_bf16 v[16:19], v[40:43], v[72:75], v[16:19]
  s_waitcnt lgkmcnt(6)
  ds_read_b64_tr_b16 v[104:105], v6 offset:27392
  ds_read_b64_tr_b16 v[106:107], v6 offset:27456
  v_mfma_f32_16x16x32_bf16 v[16:19], v[44:47], v[76:79], v[16:19]
  s_waitcnt lgkmcnt(6)
  ds_read_b64_tr_b16 v[108:109], v6 offset:27648
  ds_read_b64_tr_b16 v[110:111], v6 offset:27712
  v_mfma_f32_16x16x32_bf16 v[16:19], v[48:51], v[80:83], v[16:19]
  s_waitcnt lgkmcnt(6)
  v_cvt_pk_bf16_f32 v120, v24, v25
  v_cvt_pk_bf16_f32 v121, v26, v27
  v_mfma_f32_16x16x32_bf16 v[112:115], v[116:119], v[68:71], 0
  s_waitcnt lgkmcnt(4)
  v_mov_b64 v[98:99], 0
  v_mfma_f32_16x16x32_bf16 v[112:115], v[124:127], v[72:75], v[112:115]
  s_waitcnt lgkmcnt(2)
  v_mov_b64 v[36:37], 0
  v_exp_f32 v100, v16
  v_mfma_f32_16x16x32_bf16 v[112:115], v[104:107], v[76:79], v[112:115]
  s_waitcnt lgkmcnt(0)
  v_exp_f32 v101, v17
  v_mfma_f32_16x16x32_bf16 v[112:115], v[108:111], v[80:83], v[112:115]
  buffer_store_dwordx4 v[120:123], v2, s[4:7], s29 offen offset:3072 sc1
  v_exp_f32 v102, v18
  v_mfma_f32_16x16x32_bf16 v[20:23], v[52:55], v[68:71], 0
  v_exp_f32 v103, v19
  v_mfma_f32_16x16x32_bf16 v[20:23], v[56:59], v[72:75], v[20:23]
  v_cvt_pk_bf16_f32 v44, v100, v101
  v_cvt_pk_bf16_f32 v45, v102, v103
  v_mfma_f32_16x16x32_bf16 v[20:23], v[60:63], v[76:79], v[20:23]
  s_add_u32 s29, s29, 131072
  v_exp_f32 v100, v112
  v_mfma_f32_16x16x32_bf16 v[20:23], v[64:67], v[80:83], v[20:23]
  v_exp_f32 v101, v113
  v_exp_f32 v102, v114
  v_exp_f32 v103, v115
  v_cvt_pk_bf16_f32 v84, v100, v101
  v_cvt_pk_bf16_f32 v85, v102, v103
  v_cndmask_b32 v48, v84, 0, s[16:17]
  v_cndmask_b32 v49, v85, 0, s[16:17]
  v_cndmask_b32 v50, 0, v84, s[16:17]
  v_cndmask_b32 v51, 0, v85, s[16:17]
  v_exp_f32 v100, v20
  v_mfma_f32_16x16x16_bf16 v[88:91], v[12:13], v[48:49], 0
  v_exp_f32 v101, v21
  v_mfma_f32_16x16x16_bf16 v[24:27], v[120:121], v[48:49], 0
  v_exp_f32 v102, v22
  v_mfma_f32_16x16x16_bf16 v[116:119], v[120:121], v[50:51], 0
  v_exp_f32 v103, v23
  v_cvt_pk_bf16_f32 v46, v100, v101
  v_cvt_pk_bf16_f32 v47, v102, v103
  v_mov_b64 v[38:39], 0
  s_nop 0
  v_mfma_f32_16x16x32_bf16 v[88:91], v[12:15], v[44:47], v[88:91]
  v_mov_b64 v[40:41], 0
  v_mov_b64 v[42:43], 0
  v_mfma_f32_16x16x32_bf16 v[24:27], v[28:31], v[44:47], v[24:27]
  ds_read_b128 v[52:55], v4 offset:24576
  ds_read_b128 v[56:59], v4 offset:25600
  v_mfma_f32_16x16x32_bf16 v[116:119], v[32:35], v[44:47], v[116:119]
  s_nop 1
T_back_124:
  v_rcp_f32 v89, v88
  v_subrev_u32 v100, s54, v88
  v_cmp_le_u32 vcc, s96, v100
  v_mul_f32 v24, v89, v24
  v_mul_f32 v25, v89, v25
  v_cvt_pk_bf16_f32 v124, v24, v25
  v_pk_mul_f32 v[26:27], v[26:27], v[88:89] op_sel:[0,1] op_sel_hi:[1,1]
  v_pk_mul_f32 v[116:117], v[116:117], v[88:89] op_sel:[0,1] op_sel_hi:[1,1]
  v_pk_mul_f32 v[118:119], v[118:119], v[88:89] op_sel:[0,1] op_sel_hi:[1,1]
  v_cvt_pk_bf16_f32 v125, v26, v27
  v_cvt_pk_bf16_f32 v126, v116, v117
  v_cvt_pk_bf16_f32 v127, v118, v119
  ds_write_b128 v11, v[124:127] offset:30720
  s_cbranch_vccnz T_slow_123
  v_smfmac_f32_16x16x64_bf16 v[92:95], v[124:127], a[160:167], v0
  s_mov_b32 s96, s55
  v_smfmac_f32_16x16x64_bf16 v[96:99], v[124:127], a[168:175], v0
  s_cmp_eq_u32 s14, 63
  v_smfmac_f32_16x16x64_bf16 v[36:39], v[124:127], a[176:183], v0
  s_waitcnt lgkmcnt(0)
  s_barrier
  ds_read_b128 v[104:107], v11 offset:30208
  ds_read_b128 v[108:111], v11 offset:29696
  ds_read_b128 v[68:71], v11 offset:29184
  s_cbranch_scc1 M_tdone
  v_smfmac_f32_16x16x64_bf16 v[40:43], v[124:127], a[184:191], v0
  s_waitcnt lgkmcnt(2)
  v_smfmac_f32_16x16x64_bf16 v[92:95], v[104:107], a[192:199], v0
  s_waitcnt lgkmcnt(1)
  ds_read_b128 v[76:79], v4 offset:28672
  v_smfmac_f32_16x16x64_bf16 v[92:95], v[108:111], a[224:231], v0
  s_waitcnt lgkmcnt(1)
  ds_read_b128 v[80:83], v4 offset:29696
  v_smfmac_f32_16x16x64_bf16 v[92:95], v[68:71], a[240:247], v0
  ds_read_b128 v[60:63], v4 offset:26624
  v_smfmac_f32_16x16x64_bf16 v[96:99], v[104:107], a[200:207], v0
  ds_read_b128 v[64:67], v4 offset:27648
  v_smfmac_f32_16x16x64_bf16 v[96:99], v[108:111], a[232:239], v0
  ds_read_b128 v[28:31], v4 offset:30720
  s_nop 0
  v_cvt_pk_bf16_f32 v16, v92, v93
  v_cvt_pk_bf16_f32 v17, v94, v95
  v_bfi_b32 v16, 1, s57, v16
  v_smfmac_f32_16x16x64_bf16 v[96:99], v[68:71], a[248:255], v0
  buffer_store_dwordx2 v[16:17], v7, s[4:7], s20 offen offset:0 sc1
  v_smfmac_f32_16x16x64_bf16 v[36:39], v[104:107], a[208:215], v0
  ds_read_b128 v[32:35], v4 offset:31744
  v_smfmac_f32_16x16x64_bf16 v[36:39], v[108:111], v[52:59], v0
  s_waitcnt lgkmcnt(4)
  s_nop 0
  v_cvt_pk_bf16_f32 v18, v96, v97
  v_cvt_pk_bf16_f32 v19, v98, v99
  v_bfi_b32 v18, 1, s57, v18
  v_smfmac_f32_16x16x64_bf16 v[36:39], v[68:71], v[76:83], v0
  buffer_store_dwordx2 v[18:19], v7, s[4:7], s20 offen offset:64 sc1
  v_smfmac_f32_16x16x64_bf16 v[40:43], v[104:107], a[216:223], v0
  s_waitcnt lgkmcnt(2)
  v_smfmac_f32_16x16x64_bf16 v[40:43], v[108:111], v[60:67], v0
  s_waitcnt lgkmcnt(0)
  s_nop 0
  v_cvt_pk_bf16_f32 v20, v36, v37
  v_cvt_pk_bf16_f32 v21, v38, v39
  v_bfi_b32 v20, 1, s57, v20
  v_smfmac_f32_16x16x64_bf16 v[40:43], v[68:71], v[28:35], v0
  buffer_store_dwordx2 v[20:21], v7, s[4:7], s21 offen offset:0 sc1
  s_nop 6
  v_cvt_pk_bf16_f32 v22, v40, v41
  v_cvt_pk_bf16_f32 v23, v42, v43
  v_bfi_b32 v22, 1, s57, v22
  buffer_store_dwordx2 v[22:23], v7, s[4:7], s21 offen offset:64 sc1
  ds_read_b128 v[68:71], v4 offset:0
  ds_read_b128 v[72:75], v4 offset:1024
  ds_read_b128 v[76:79], v4 offset:4096
  ds_read_b128 v[80:83], v4 offset:5120
  ds_read_b128 v[84:87], v4 offset:8192
  ds_read_b128 v[88:91], v4 offset:9216
  ds_read_b128 v[92:95], v4 offset:2048
  ds_read_b128 v[96:99], v4 offset:3072
  ds_read_b128 v[100:103], v4 offset:6144
  ds_read_b128 v[104:107], v4 offset:7168
  ds_read_b128 v[108:111], v4 offset:10240
  ds_read_b128 v[112:115], v4 offset:11264
  v_mov_b64 v[16:17], 0
  v_mov_b64 v[18:19], 0
  v_mov_b64 v[20:21], 0
  v_mov_b64 v[22:23], 0
  v_mov_b64 v[24:25], 0
  v_mov_b64 v[26:27], 0
  ds_read_b64 v[44:45], v2 offset:32256
  s_waitcnt lgkmcnt(0)
  v_readfirstlane_b32 s38, v44
  v_readfirstlane_b32 s37, v45
  s_nop 0
  s_lshl_b32 s38, s38, 1
  s_lshl1_add_u32 s37, s37, 1
  s_min_u32 s38, s38, s37
  s_cmp_ge_u32 s38, 64
  s_cselect_b32 s38, 100, s38
  s_sub_u32 s38, s38, 1
  s_max_i32 s30, s30, s38
  s_waitcnt vmcnt(4)
  s_barrier
  ds_read_b128 v[28:31], v2 offset:19456
  ds_read_b128 v[32:35], v2 offset:23552
  ds_read_b128 v[36:39], v2 offset:8192
  ds_read_b128 v[40:43], v2 offset:9216
  ds_read_b128 v[44:47], v2 offset:10240
  ds_read_b128 v[48:51], v2 offset:11264
  buffer_load_dwordx4 v[124:127], v2, s[4:7], s24 offen offset:3072 sc1
  buffer_load_dwordx4 v[116:119], v2, s[4:7], s25 offen offset:3072 sc1
  ds_read_b128 v[52:55], v2 offset:12288
  ds_read_b128 v[56:59], v2 offset:13312
  ds_read_b128 v[60:63], v2 offset:14336
  ds_read_b128 v[64:67], v2 offset:15360
  buffer_load_dwordx4 v[124:127], v2, s[4:7], s24 offen offset:3072 sc1
  buffer_load_dwordx4 v[116:119], v2, s[4:7], s25 offen offset:3072 sc1
  s_add_u32 s14, s14, 1
  s_cmp_ge_i32 s14, s30
  s_cbranch_scc1 T_kvw_120
T_kvb_121:
  s_mov_b32 s19, 0
  s_branch T_loop_116
T_kvw_120:
  s_mov_b32 s19, 0
  s_branch T_kvok_129
T_kv_128:
  s_sleep 4
  s_add_u32 s19, s19, 1
  s_cmp_gt_u32 s19, 32768
  s_cbranch_scc1 M_exit
T_kvok_129:
  s_add_u32 s39, s99, 128
  s_mov_b32 s38, 0
  s_mov_b32 s37, 0
  s_atomic_or s38, s[58:59], s99 glc
  s_atomic_or s37, s[58:59], s39 glc
  s_waitcnt lgkmcnt(0)
  s_lshl_b32 s38, s38, 1
  s_lshl1_add_u32 s37, s37, 1
  s_min_u32 s38, s38, s37
  s_cmp_ge_u32 s38, 64
  s_cselect_b32 s38, 100, s38
  s_sub_u32 s38, s38, 1
  s_max_i32 s30, s30, s38
  s_cmp_ge_i32 s14, s30
  s_cbranch_scc1 T_kv_128
  s_branch T_kvb_121
T_slow_123:
  s_nop 7
  v_max3_f32 v100, v16, v17, v18
  v_max3_f32 v100, v100, v19, v20
  v_max3_f32 v100, v100, v21, v22
  v_max3_f32 v100, v100, v23, v112
  v_max3_f32 v100, v100, v113, v114
  v_max_f32 v100, v100, v115
  v_mov_b32 v101, v100
  s_nop 1
  v_permlane32_swap_b32 v100, v101
  s_nop 1
  v_max_f32 v100, v100, v101
  v_mov_b32 v101, v100
  s_nop 1
  v_permlane16_swap_b32 v100, v101
  s_nop 1
  v_max_f32 v100, v100, v101
  v_sub_f32 v16, v16, v100
  v_sub_f32 v17, v17, v100
  v_sub_f32 v18, v18, v100
  v_sub_f32 v19, v19, v100
  v_exp_f32 v16, v16
  v_exp_f32 v17, v17
  v_exp_f32 v18, v18
  v_exp_f32 v19, v19
  v_sub_f32 v20, v20, v100
  v_sub_f32 v21, v21, v100
  v_sub_f32 v22, v22, v100
  v_sub_f32 v23, v23, v100
  v_exp_f32 v20, v20
  v_exp_f32 v21, v21
  v_exp_f32 v22, v22
  v_exp_f32 v23, v23
  v_sub_f32 v112, v112, v100
  v_sub_f32 v113, v113, v100
  v_sub_f32 v114, v114, v100
  v_sub_f32 v115, v115, v100
  v_exp_f32 v112, v112
  v_exp_f32 v113, v113
  v_exp_f32 v114, v114
  v_exp_f32 v115, v115
  s_nop 0
  v_cvt_pk_bf16_f32 v44, v16, v17
  v_cvt_pk_bf16_f32 v45, v18, v19
  v_cvt_pk_bf16_f32 v46, v20, v21
  v_cvt_pk_bf16_f32 v47, v22, v23
  v_cvt_pk_bf16_f32 v84, v112, v113
  v_cvt_pk_bf16_f32 v85, v114, v115
  v_cndmask_b32 v48, v84, 0, s[16:17]
  v_cndmask_b32 v49, v85, 0, s[16:17]
  v_cndmask_b32 v50, 0, v84, s[16:17]
  v_cndmask_b32 v51, 0, v85, s[16:17]
  s_nop 1
  v_mfma_f32_16x16x16_bf16 v[88:91], v[12:13], v[48:49], 0
  v_mfma_f32_16x16x16_bf16 v[24:27], v[120:121], v[48:49], 0
  v_mfma_f32_16x16x16_bf16 v[116:119], v[120:121], v[50:51], 0
  v_mfma_f32_16x16x32_bf16 v[88:91], v[12:15], v[44:47], v[88:91]
  v_mfma_f32_16x16x32_bf16 v[24:27], v[28:31], v[44:47], v[24:27]
  v_mfma_f32_16x16x32_bf16 v[116:119], v[32:35], v[44:47], v[116:119]
  s_nop 7
  s_nop 1
  s_mov_b32 s96, -1
  s_branch T_back_124
M_tdone:
  v_mov_b32 v16, 64
  v_or_b32 v17, s13, v2
  v_min_u32 v17, 1, v17
  v_lshlrev_b32 v17, 30, v17
  s_waitcnt vmcnt(0)
  s_barrier
  buffer_store_dword v16, v17, s[4:7], s15 offen sc1
  s_branch M_done
M_worker:
  s_load_dwordx4 s[72:75], s[0:1], 120
  v_lshrrev_b32 v3, 6, v0
  v_and_b32 v1, 63, v0
  v_readfirstlane_b32 s16, v3
  v_lshlrev_b32 v2, 4, v1
  s_waitcnt lgkmcnt(0)
  s_mov_b64 s[4:5], s[74:75]
  s_mov_b64 s[74:75], s[72:73]
  s_mov_b64 s[72:73], s[4:5]
  s_and_b32 s5, s5, 0xffff
  s_mov_b32 s6, 268435456
  s_mov_b32 s7, 0x20000
  s_sub_u32 s66, s76, 1
  s_lshl_b32 s66, s66, 5
  s_add_u32 s66, s66, s77
  s_mul_i32 s64, s66, 9363
  s_lshr_b32 s64, s64, 16
  s_mul_i32 s67, s64, 7
  s_sub_u32 s65, s66, s67
  s_lshl_b32 s31, s66, 7
  s_add_u32 s31, s31, 148897792
  s_lshl_b32 s67, s67, 7
  s_add_u32 s67, s67, 148897792
  s_getpc_b64 s[76:77]
M_pc:
  s_add_u32 s76, s76, M_table-M_pc
  s_addc_u32 s77, s77, 0
  s_lshl_b32 s26, s65, 6
  s_load_dwordx16 s[48:63], s[76:77], s26
  s_waitcnt lgkmcnt(0)
  s_mov_b32 s23, s51
  s_cmp_lg_u32 s48, 1
  s_cbranch_scc1 M_nobpf
  s_load_dwordx8 s[36:43], s[0:1], 64
  s_mul_i32 s76, s64, 3
  s_add_u32 s76, s76, s57
  v_lshlrev_b32 v4, 7, v0
  s_mov_b32 s10, 4194304
  s_mov_b32 s11, 0x20000
  s_waitcnt lgkmcnt(0)
  s_mov_b32 s8, s42
  s_and_b32 s9, s43, 0xffff
  s_mul_i32 s77, s76, 43776
  s_add_u32 s77, s77, 0
  v_min_u32 v5, 32640, v4
  v_add_u32 v5, s77, v5
  s_add_u32 s77, s77, 32768
  buffer_load_dword v6, v5, s[8:11], 0 offen
  v_min_u32 v5, 10880, v4
  v_add_u32 v5, s77, v5
  s_add_u32 s77, s77, 32768
  buffer_load_dword v6, v5, s[8:11], 0 offen
  s_mov_b32 s8, s38
  s_and_b32 s9, s39, 0xffff
  s_mul_i32 s77, s76, 21888
  s_add_u32 s77, s77, 2097152
  v_min_u32 v5, 21760, v4
  v_add_u32 v5, s77, v5
  s_add_u32 s77, s77, 32768
  buffer_load_dword v6, v5, s[8:11], 0 offen
  s_mov_b32 s8, s40
  s_and_b32 s9, s41, 0xffff
  s_mul_i32 s77, s76, 21888
  s_add_u32 s77, s77, 2097152
  v_min_u32 v5, 21760, v4
  v_add_u32 v5, s77, v5
  s_add_u32 s77, s77, 32768
  buffer_load_dword v6, v5, s[8:11], 0 offen
  s_mov_b32 s8, s36
  s_and_b32 s9, s37, 0xffff
  s_mul_i32 s77, s76, 21888
  s_add_u32 s77, s77, 2097152
  v_min_u32 v5, 21760, v4
  v_add_u32 v5, s77, v5
  s_add_u32 s77, s77, 32768
  buffer_load_dword v6, v5, s[8:11], 0 offen
  s_waitcnt vmcnt(0)
M_nobpf:
  s_lshr_b32 s29, s16, 1
  s_cmp_eq_u32 s29, 0
  s_cselect_b32 s26, 2, 8
  s_cselect_b32 s27, 3, 4
  s_cselect_b32 s28, 9, 10
  s_cmp_eq_u32 s48, 1
  s_cselect_b32 s26, s27, s26
  s_cmp_eq_u32 s48, 2
  s_cselect_b32 s26, s28, s26
  s_lshl_b32 s26, s26, 3
  s_load_dwordx2 s[8:9], s[0:1], s26
  s_cmp_eq_u32 s48, 1
  s_cselect_b32 s26, 8, 0
  s_load_dwordx2 s[12:13], s[0:1], s26
  s_cmp_eq_u32 s29, 0
  s_cselect_b32 s21, 0, 3
  s_cselect_b32 s27, 1, 2
  s_cselect_b32 s28, 4, 5
  s_cmp_eq_u32 s48, 1
  s_cselect_b32 s21, s27, s21
  s_cmp_eq_u32 s48, 2
  s_cselect_b32 s21, s28, s21
  s_lshl_b32 s21, s21, 5
  s_add_u32 s21, s21, s64
  s_lshl_b32 s21, s21, 6
  s_add_u32 s21, s21, s49
  s_and_b32 s27, s16, 1
  s_lshl_b32 s21, s21, 1
  s_add_u32 s21, s21, s27
  s_lshl_b32 s21, s21, 12
  s_lshl_b32 s22, s50, 13
  s_lshl_b32 s19, s49, 15
  s_lshl_b32 s20, s50, 15
  s_lshl_b32 s17, s64, 1
  s_add_u32 s17, s17, s27
  s_lshl_b32 s17, s17, 7
  s_mov_b32 s18, 8192
  s_mov_b32 s24, 0x3e0293ee
  s_waitcnt lgkmcnt(0)
  s_and_b32 s9, s9, 0xffff
  s_mov_b32 s10, 4194304
  s_mov_b32 s11, 0x20000
  s_and_b32 s13, s13, 0xffff
  s_mov_b32 s14, 2097152
  s_mov_b32 s15, 0x20000
  s_cmp_eq_u32 s48, 0
  s_cselect_b32 s32, 0, s16
  s_lshr_b32 s32, s32, 1
  v_lshrrev_b32 v144, 4, v1
  v_and_b32 v56, 0xff, v2
  v_lshl_add_u32 v56, v144, 9, v56
  v_and_b32 v146, 15, v1
  v_and_b32 v144, 8, v1
  v_add_u32 v144, v144, v146
  s_cmp_lg_u32 s32, 0
  s_cselect_b64 vcc, -1, 0
  s_cselect_b32 s26, 8, 16
  v_cndmask_b32 v144, v146, v144, vcc
  v_lshrrev_b32 v145, 4, v1
  v_add_u32 v148, s26, v144
  v_xor_b32 v147, 0, v145
  v_xor_b32 v147, v147, v146
  v_lshlrev_b32 v147, 4, v147
  v_lshl_add_u32 v8, v144, 8, v147
  v_xor_b32 v147, 8, v145
  v_xor_b32 v147, v147, v146
  v_lshlrev_b32 v147, 4, v147
  v_lshl_add_u32 v9, v148, 8, v147
  v_xor_b32 v147, 4, v145
  v_xor_b32 v147, v147, v146
  v_lshlrev_b32 v147, 4, v147
  v_lshl_add_u32 v10, v144, 8, v147
  v_xor_b32 v147, 12, v145
  v_xor_b32 v147, v147, v146
  v_lshlrev_b32 v147, 4, v147
  v_lshl_add_u32 v11, v148, 8, v147
  v_xor_b32 v147, 8, v145
  v_xor_b32 v147, v147, v146
  v_lshlrev_b32 v147, 4, v147
  v_lshl_add_u32 v12, v144, 8, v147
  v_xor_b32 v147, 0, v145
  v_xor_b32 v147, v147, v146
  v_lshlrev_b32 v147, 4, v147
  v_lshl_add_u32 v13, v148, 8, v147
  v_xor_b32 v147, 12, v145
  v_xor_b32 v147, v147, v146
  v_lshlrev_b32 v147, 4, v147
  v_lshl_add_u32 v14, v144, 8, v147
  v_xor_b32 v147, 4, v145
  v_xor_b32 v147, v147, v146
  v_lshlrev_b32 v147, 4, v147
  v_lshl_add_u32 v15, v148, 8, v147
  v_lshrrev_b32 v144, 4, v1
  s_lshl_b32 s26, s16, 8
  v_add_u32 v145, 0, v144
  v_or_b32 v147, 0, v144
  v_xor_b32 v147, v147, v146
  v_lshlrev_b32 v147, 4, v147
  v_lshl_add_u32 v147, v145, 10, v147
  v_add_u32 v16, s26, v147
  v_add_u32 v145, 4, v144
  v_or_b32 v147, 4, v144
  v_xor_b32 v147, v147, v146
  v_lshlrev_b32 v147, 4, v147
  v_lshl_add_u32 v147, v145, 10, v147
  v_add_u32 v17, s26, v147
  v_add_u32 v145, 8, v144
  v_or_b32 v147, 8, v144
  v_xor_b32 v147, v147, v146
  v_lshlrev_b32 v147, 4, v147
  v_lshl_add_u32 v147, v145, 10, v147
  v_add_u32 v18, s26, v147
  v_add_u32 v145, 12, v144
  v_or_b32 v147, 12, v144
  v_xor_b32 v147, v147, v146
  v_lshlrev_b32 v147, 4, v147
  v_lshl_add_u32 v147, v145, 10, v147
  v_add_u32 v19, s26, v147
  v_add_u32 v145, 16, v144
  v_or_b32 v147, 8, v144
  v_xor_b32 v147, v147, v146
  v_lshlrev_b32 v147, 4, v147
  v_lshl_add_u32 v147, v145, 10, v147
  v_add_u32 v20, s26, v147
  v_add_u32 v145, 20, v144
  v_or_b32 v147, 12, v144
  v_xor_b32 v147, v147, v146
  v_lshlrev_b32 v147, 4, v147
  v_lshl_add_u32 v147, v145, 10, v147
  v_add_u32 v21, s26, v147
  v_add_u32 v145, 24, v144
  v_or_b32 v147, 0, v144
  v_xor_b32 v147, v147, v146
  v_lshlrev_b32 v147, 4, v147
  v_lshl_add_u32 v147, v145, 10, v147
  v_add_u32 v22, s26, v147
  v_add_u32 v145, 28, v144
  v_or_b32 v147, 4, v144
  v_xor_b32 v147, v147, v146
  v_lshlrev_b32 v147, 4, v147
  v_lshl_add_u32 v147, v145, 10, v147
  v_add_u32 v23, s26, v147
  v_lshrrev_b32 v144, 3, v1
  v_mul_lo_u32 v144, v144, s18
  v_and_b32 v145, 7, v1
  v_lshl_add_u32 v144, v145, 4, v144
  s_lshl_b32 s28, s16, 15
  s_add_u32 s28, s28, 32768
  s_lshl_b32 s29, s18, 3
  s_add_u32 m0, s28, 0
  s_nop 0
  buffer_load_dwordx4 v144, s[8:11], s17 offen lds
  s_add_u32 s17, s17, s29
  s_add_u32 m0, s28, 1024
  s_nop 0
  buffer_load_dwordx4 v144, s[8:11], s17 offen lds
  s_add_u32 s17, s17, s29
  s_add_u32 m0, s28, 2048
  s_nop 0
  buffer_load_dwordx4 v144, s[8:11], s17 offen lds
  s_add_u32 s17, s17, s29
  s_add_u32 m0, s28, 3072
  s_nop 0
  buffer_load_dwordx4 v144, s[8:11], s17 offen lds
  s_add_u32 s17, s17, s29
  s_add_u32 m0, s28, 4096
  s_nop 0
  buffer_load_dwordx4 v144, s[8:11], s17 offen lds
  s_add_u32 s17, s17, s29
  s_add_u32 m0, s28, 5120
  s_nop 0
  buffer_load_dwordx4 v144, s[8:11], s17 offen lds
  s_add_u32 s17, s17, s29
  s_add_u32 m0, s28, 6144
  s_nop 0
  buffer_load_dwordx4 v144, s[8:11], s17 offen lds
  s_add_u32 s17, s17, s29
  s_add_u32 m0, s28, 7168
  s_nop 0
  buffer_load_dwordx4 v144, s[8:11], s17 offen lds
  s_add_u32 s17, s17, s29
  s_add_u32 m0, s28, 8192
  s_nop 0
  buffer_load_dwordx4 v144, s[8:11], s17 offen lds
  s_add_u32 s17, s17, s29
  s_add_u32 m0, s28, 9216
  s_nop 0
  buffer_load_dwordx4 v144, s[8:11], s17 offen lds
  s_add_u32 s17, s17, s29
  s_add_u32 m0, s28, 10240
  s_nop 0
  buffer_load_dwordx4 v144, s[8:11], s17 offen lds
  s_add_u32 s17, s17, s29
  s_add_u32 m0, s28, 11264
  s_nop 0
  buffer_load_dwordx4 v144, s[8:11], s17 offen lds
  s_add_u32 s17, s17, s29
  s_add_u32 m0, s28, 12288
  s_nop 0
  buffer_load_dwordx4 v144, s[8:11], s17 offen lds
  s_add_u32 s17, s17, s29
  s_add_u32 m0, s28, 13312
  s_nop 0
  buffer_load_dwordx4 v144, s[8:11], s17 offen lds
  s_add_u32 s17, s17, s29
  s_add_u32 m0, s28, 14336
  s_nop 0
  buffer_load_dwordx4 v144, s[8:11], s17 offen lds
  s_add_u32 s17, s17, s29
  s_add_u32 m0, s28, 15360
  s_nop 0
  buffer_load_dwordx4 v144, s[8:11], s17 offen lds
  s_add_u32 s17, s17, s29
  s_add_u32 m0, s28, 16384
  s_nop 0
  buffer_load_dwordx4 v144, s[8:11], s17 offen lds
  s_add_u32 s17, s17, s29
  s_add_u32 m0, s28, 17408
  s_nop 0
  buffer_load_dwordx4 v144, s[8:11], s17 offen lds
  s_add_u32 s17, s17, s29
  s_add_u32 m0, s28, 18432
  s_nop 0
  buffer_load_dwordx4 v144, s[8:11], s17 offen lds
  s_add_u32 s17, s17, s29
  s_add_u32 m0, s28, 19456
  s_nop 0
  buffer_load_dwordx4 v144, s[8:11], s17 offen lds
  s_add_u32 s17, s17, s29
  s_add_u32 m0, s28, 20480
  s_nop 0
  buffer_load_dwordx4 v144, s[8:11], s17 offen lds
  s_add_u32 s17, s17, s29
  s_add_u32 m0, s28, 21504
  s_nop 0
  buffer_load_dwordx4 v144, s[8:11], s17 offen lds
  s_add_u32 s17, s17, s29
  s_add_u32 m0, s28, 22528
  s_nop 0
  buffer_load_dwordx4 v144, s[8:11], s17 offen lds
  s_add_u32 s17, s17, s29
  s_add_u32 m0, s28, 23552
  s_nop 0
  buffer_load_dwordx4 v144, s[8:11], s17 offen lds
  s_add_u32 s17, s17, s29
  s_add_u32 m0, s28, 24576
  s_nop 0
  buffer_load_dwordx4 v144, s[8:11], s17 offen lds
  s_add_u32 s17, s17, s29
  s_add_u32 m0, s28, 25600
  s_nop 0
  buffer_load_dwordx4 v144, s[8:11], s17 offen lds
  s_add_u32 s17, s17, s29
  s_add_u32 m0, s28, 26624
  s_nop 0
  buffer_load_dwordx4 v144, s[8:11], s17 offen lds
  s_add_u32 s17, s17, s29
  s_add_u32 m0, s28, 27648
  s_nop 0
  buffer_load_dwordx4 v144, s[8:11], s17 offen lds
  s_add_u32 s17, s17, s29
  s_add_u32 m0, s28, 28672
  s_nop 0
  buffer_load_dwordx4 v144, s[8:11], s17 offen lds
  s_add_u32 s17, s17, s29
  s_add_u32 m0, s28, 29696
  s_nop 0
  buffer_load_dwordx4 v144, s[8:11], s17 offen lds
  s_add_u32 s17, s17, s29
  s_add_u32 m0, s28, 30720
  s_nop 0
  buffer_load_dwordx4 v144, s[8:11], s17 offen lds
  s_add_u32 s17, s17, s29
  s_add_u32 m0, s28, 31744
  s_nop 0
  buffer_load_dwordx4 v144, s[8:11], s17 offen lds
  s_add_u32 s17, s17, s29
  s_lshl_b32 s25, s16, 13
  s_add_u32 m0, s25, 0
  s_nop 0
  buffer_load_dwordx4 v16, s[12:15], s19 offen lds
  s_add_u32 m0, s25, 1024
  s_nop 0
  buffer_load_dwordx4 v17, s[12:15], s19 offen lds
  s_add_u32 m0, s25, 2048
  s_nop 0
  buffer_load_dwordx4 v18, s[12:15], s19 offen lds
  s_add_u32 m0, s25, 3072
  s_nop 0
  buffer_load_dwordx4 v19, s[12:15], s19 offen lds
  s_add_u32 m0, s25, 4096
  s_nop 0
  buffer_load_dwordx4 v20, s[12:15], s19 offen lds
  s_add_u32 m0, s25, 5120
  s_nop 0
  buffer_load_dwordx4 v21, s[12:15], s19 offen lds
  s_add_u32 m0, s25, 6144
  s_nop 0
  buffer_load_dwordx4 v22, s[12:15], s19 offen lds
  s_add_u32 m0, s25, 7168
  s_nop 0
  buffer_load_dwordx4 v23, s[12:15], s19 offen lds
  s_cmp_gt_u32 s23, 1
  s_cselect_b32 s26, s20, 0
  s_add_u32 s19, s19, s26
  s_add_u32 s25, s25, 32768
  s_and_b32 s25, s25, 0x1ffff
  s_cmp_lg_u32 s16, 3
  s_cbranch_scc1 M_noinit
  s_mov_b32 s79, 0
  s_atomic_swap s79, s[72:73], s31 glc
  s_waitcnt lgkmcnt(0)
  s_mov_b32 s79, 1
  s_atomic_add s79, s[74:75], 128
M_noinit:
  s_cmp_lg_u32 s65, 3
  s_cbranch_scc1 M_noarm
  v_lshlrev_b32 v4, 4, v0
  v_mov_b64 v[60:61], -1
  v_mov_b64 v[62:63], -1
  s_mul_i32 s76, s64, 4096
  s_add_u32 s77, s76, 142868480
  buffer_store_dwordx4 v[60:63], v4, s[4:7], s77 offen sc1
  s_add_u32 s77, s76, 142999552
  buffer_store_dwordx4 v[60:63], v4, s[4:7], s77 offen sc1
  s_add_u32 s77, s76, 143130624
  buffer_store_dwordx4 v[60:63], v4, s[4:7], s77 offen sc1
  s_add_u32 s77, s76, 143261696
  buffer_store_dwordx4 v[60:63], v4, s[4:7], s77 offen sc1
  s_add_u32 s77, s76, 143392768
  buffer_store_dwordx4 v[60:63], v4, s[4:7], s77 offen sc1
  s_add_u32 s77, s76, 143523840
  buffer_store_dwordx4 v[60:63], v4, s[4:7], s77 offen sc1
M_noarm:
  s_mul_i32 s76, s64, 3
  s_add_u32 s76, s76, s57
  s_mul_i32 s76, s76, 24576
  v_lshlrev_b32 v4, 7, v0
  v_add_u32 v4, s76, v4
  buffer_load_dword v5, v4, s[12:15], 0 offen
  v_bfe_u32 v148, v1, 2, 2
  v_lshrrev_b32 v149, 5, v1
  v_lshl_add_u32 v148, v149, 4, v148
  v_bfe_u32 v149, v1, 4, 1
  v_lshl_add_u32 v148, v149, 3, v148
  v_and_b32 v149, 3, v1
  v_and_b32 v150, 2, v149
  v_add_u32 v150, v150, v149
  s_cmp_lg_u32 s32, 0
  s_cselect_b64 vcc, -1, 0
  s_cselect_b32 s26, 32, 16
  v_cndmask_b32 v149, v150, v149, vcc
  v_lshlrev_b32 v149, 3, v149
  v_lshl_add_u32 v148, v148, 7, v149
  v_add_u32 v152, s28, v148
  v_add_u32 v153, 512, v152
  v_add_u32 v154, s26, v152
  v_add_u32 v155, s26, v153
  s_waitcnt vmcnt(37)
  ds_read_b64_tr_b16 a[0:1], v152 offset:0
  ds_read_b64_tr_b16 a[2:3], v153 offset:0
  ds_read_b64_tr_b16 a[4:5], v154 offset:0
  ds_read_b64_tr_b16 a[6:7], v155 offset:0
  ds_read_b64_tr_b16 a[8:9], v152 offset:64
  ds_read_b64_tr_b16 a[10:11], v153 offset:64
  ds_read_b64_tr_b16 a[12:13], v154 offset:64
  ds_read_b64_tr_b16 a[14:15], v155 offset:64
  s_waitcnt lgkmcnt(0)
  s_add_u32 m0, s28, 0
  s_nop 0
  buffer_load_dwordx4 v144, s[8:11], s17 offen lds
  s_add_u32 s17, s17, s29
  s_add_u32 m0, s28, 1024
  s_nop 0
  buffer_load_dwordx4 v144, s[8:11], s17 offen lds
  s_add_u32 s17, s17, s29
  s_add_u32 m0, s28, 2048
  s_nop 0
  buffer_load_dwordx4 v144, s[8:11], s17 offen lds
  s_add_u32 s17, s17, s29
  s_add_u32 m0, s28, 3072
  s_nop 0
  buffer_load_dwordx4 v144, s[8:11], s17 offen lds
  s_add_u32 s17, s17, s29
  s_waitcnt vmcnt(37)
  ds_read_b64_tr_b16 a[16:17], v152 offset:4096
  ds_read_b64_tr_b16 a[18:19], v153 offset:4096
  ds_read_b64_tr_b16 a[20:21], v154 offset:4096
  ds_read_b64_tr_b16 a[22:23], v155 offset:4096
  ds_read_b64_tr_b16 a[24:25], v152 offset:4160
  ds_read_b64_tr_b16 a[26:27], v153 offset:4160
  ds_read_b64_tr_b16 a[28:29], v154 offset:4160
  ds_read_b64_tr_b16 a[30:31], v155 offset:4160
  s_waitcnt lgkmcnt(0)
  s_add_u32 m0, s28, 4096
  s_nop 0
  buffer_load_dwordx4 v144, s[8:11], s17 offen lds
  s_add_u32 s17, s17, s29
  s_add_u32 m0, s28, 5120
  s_nop 0
  buffer_load_dwordx4 v144, s[8:11], s17 offen lds
  s_add_u32 s17, s17, s29
  s_add_u32 m0, s28, 6144
  s_nop 0
  buffer_load_dwordx4 v144, s[8:11], s17 offen lds
  s_add_u32 s17, s17, s29
  s_add_u32 m0, s28, 7168
  s_nop 0
  buffer_load_dwordx4 v144, s[8:11], s17 offen lds
  s_add_u32 s17, s17, s29
  s_waitcnt vmcnt(37)
  ds_read_b64_tr_b16 a[32:33], v152 offset:8192
  ds_read_b64_tr_b16 a[34:35], v153 offset:8192
  ds_read_b64_tr_b16 a[36:37], v154 offset:8192
  ds_read_b64_tr_b16 a[38:39], v155 offset:8192
  ds_read_b64_tr_b16 a[40:41], v152 offset:8256
  ds_read_b64_tr_b16 a[42:43], v153 offset:8256
  ds_read_b64_tr_b16 a[44:45], v154 offset:8256
  ds_read_b64_tr_b16 a[46:47], v155 offset:8256
  s_waitcnt lgkmcnt(0)
  s_add_u32 m0, s28, 8192
  s_nop 0
  buffer_load_dwordx4 v144, s[8:11], s17 offen lds
  s_add_u32 s17, s17, s29
  s_add_u32 m0, s28, 9216
  s_nop 0
  buffer_load_dwordx4 v144, s[8:11], s17 offen lds
  s_add_u32 s17, s17, s29
  s_add_u32 m0, s28, 10240
  s_nop 0
  buffer_load_dwordx4 v144, s[8:11], s17 offen lds
  s_add_u32 s17, s17, s29
  s_add_u32 m0, s28, 11264
  s_nop 0
  buffer_load_dwordx4 v144, s[8:11], s17 offen lds
  s_add_u32 s17, s17, s29
  s_waitcnt vmcnt(37)
  ds_read_b64_tr_b16 a[48:49], v152 offset:12288
  ds_read_b64_tr_b16 a[50:51], v153 offset:12288
  ds_read_b64_tr_b16 a[52:53], v154 offset:12288
  ds_read_b64_tr_b16 a[54:55], v155 offset:12288
  ds_read_b64_tr_b16 a[56:57], v152 offset:12352
  ds_read_b64_tr_b16 a[58:59], v153 offset:12352
  ds_read_b64_tr_b16 a[60:61], v154 offset:12352
  ds_read_b64_tr_b16 a[62:63], v155 offset:12352
  s_waitcnt lgkmcnt(0)
  s_add_u32 m0, s28, 12288
  s_nop 0
  buffer_load_dwordx4 v144, s[8:11], s17 offen lds
  s_add_u32 s17, s17, s29
  s_add_u32 m0, s28, 13312
  s_nop 0
  buffer_load_dwordx4 v144, s[8:11], s17 offen lds
  s_add_u32 s17, s17, s29
  s_add_u32 m0, s28, 14336
  s_nop 0
  buffer_load_dwordx4 v144, s[8:11], s17 offen lds
  s_add_u32 s17, s17, s29
  s_add_u32 m0, s28, 15360
  s_nop 0
  buffer_load_dwordx4 v144, s[8:11], s17 offen lds
  s_add_u32 s17, s17, s29
  s_waitcnt vmcnt(37)
  ds_read_b64_tr_b16 a[64:65], v152 offset:16384
  ds_read_b64_tr_b16 a[66:67], v153 offset:16384
  ds_read_b64_tr_b16 a[68:69], v154 offset:16384
  ds_read_b64_tr_b16 a[70:71], v155 offset:16384
  ds_read_b64_tr_b16 a[72:73], v152 offset:16448
  ds_read_b64_tr_b16 a[74:75], v153 offset:16448
  ds_read_b64_tr_b16 a[76:77], v154 offset:16448
  ds_read_b64_tr_b16 a[78:79], v155 offset:16448
  s_waitcnt lgkmcnt(0)
  s_add_u32 m0, s28, 16384
  s_nop 0
  buffer_load_dwordx4 v144, s[8:11], s17 offen lds
  s_add_u32 s17, s17, s29
  s_add_u32 m0, s28, 17408
  s_nop 0
  buffer_load_dwordx4 v144, s[8:11], s17 offen lds
  s_add_u32 s17, s17, s29
  s_add_u32 m0, s28, 18432
  s_nop 0
  buffer_load_dwordx4 v144, s[8:11], s17 offen lds
  s_add_u32 s17, s17, s29
  s_add_u32 m0, s28, 19456
  s_nop 0
  buffer_load_dwordx4 v144, s[8:11], s17 offen lds
  s_add_u32 s17, s17, s29
  s_waitcnt vmcnt(37)
  ds_read_b64_tr_b16 a[80:81], v152 offset:20480
  ds_read_b64_tr_b16 a[82:83], v153 offset:20480
  ds_read_b64_tr_b16 a[84:85], v154 offset:20480
  ds_read_b64_tr_b16 a[86:87], v155 offset:20480
  ds_read_b64_tr_b16 a[88:89], v152 offset:20544
  ds_read_b64_tr_b16 a[90:91], v153 offset:20544
  ds_read_b64_tr_b16 a[92:93], v154 offset:20544
  ds_read_b64_tr_b16 a[94:95], v155 offset:20544
  s_waitcnt lgkmcnt(0)
  s_add_u32 m0, s28, 20480
  s_nop 0
  buffer_load_dwordx4 v144, s[8:11], s17 offen lds
  s_add_u32 s17, s17, s29
  s_add_u32 m0, s28, 21504
  s_nop 0
  buffer_load_dwordx4 v144, s[8:11], s17 offen lds
  s_add_u32 s17, s17, s29
  s_add_u32 m0, s28, 22528
  s_nop 0
  buffer_load_dwordx4 v144, s[8:11], s17 offen lds
  s_add_u32 s17, s17, s29
  s_add_u32 m0, s28, 23552
  s_nop 0
  buffer_load_dwordx4 v144, s[8:11], s17 offen lds
  s_add_u32 s17, s17, s29
  s_waitcnt vmcnt(37)
  ds_read_b64_tr_b16 a[96:97], v152 offset:24576
  ds_read_b64_tr_b16 a[98:99], v153 offset:24576
  ds_read_b64_tr_b16 a[100:101], v154 offset:24576
  ds_read_b64_tr_b16 a[102:103], v155 offset:24576
  ds_read_b64_tr_b16 a[104:105], v152 offset:24640
  ds_read_b64_tr_b16 a[106:107], v153 offset:24640
  ds_read_b64_tr_b16 a[108:109], v154 offset:24640
  ds_read_b64_tr_b16 a[110:111], v155 offset:24640
  s_waitcnt lgkmcnt(0)
  s_add_u32 m0, s28, 24576
  s_nop 0
  buffer_load_dwordx4 v144, s[8:11], s17 offen lds
  s_add_u32 s17, s17, s29
  s_add_u32 m0, s28, 25600
  s_nop 0
  buffer_load_dwordx4 v144, s[8:11], s17 offen lds
  s_add_u32 s17, s17, s29
  s_add_u32 m0, s28, 26624
  s_nop 0
  buffer_load_dwordx4 v144, s[8:11], s17 offen lds
  s_add_u32 s17, s17, s29
  s_add_u32 m0, s28, 27648
  s_nop 0
  buffer_load_dwordx4 v144, s[8:11], s17 offen lds
  s_add_u32 s17, s17, s29
  s_waitcnt vmcnt(37)
  ds_read_b64_tr_b16 a[112:113], v152 offset:28672
  ds_read_b64_tr_b16 a[114:115], v153 offset:28672
  ds_read_b64_tr_b16 a[116:117], v154 offset:28672
  ds_read_b64_tr_b16 a[118:119], v155 offset:28672
  ds_read_b64_tr_b16 a[120:121], v152 offset:28736
  ds_read_b64_tr_b16 a[122:123], v153 offset:28736
  ds_read_b64_tr_b16 a[124:125], v154 offset:28736
  ds_read_b64_tr_b16 a[126:127], v155 offset:28736
  s_waitcnt lgkmcnt(0)
  s_add_u32 m0, s28, 28672
  s_nop 0
  buffer_load_dwordx4 v144, s[8:11], s17 offen lds
  s_add_u32 s17, s17, s29
  s_add_u32 m0, s28, 29696
  s_nop 0
  buffer_load_dwordx4 v144, s[8:11], s17 offen lds
  s_add_u32 s17, s17, s29
  s_add_u32 m0, s28, 30720
  s_nop 0
  buffer_load_dwordx4 v144, s[8:11], s17 offen lds
  s_add_u32 s17, s17, s29
  s_add_u32 m0, s28, 31744
  s_nop 0
  buffer_load_dwordx4 v144, s[8:11], s17 offen lds
  s_add_u32 s17, s17, s29
  s_waitcnt vmcnt(28)
  ds_read_b64_tr_b16 a[128:129], v152 offset:0
  ds_read_b64_tr_b16 a[130:131], v153 offset:0
  ds_read_b64_tr_b16 a[132:133], v154 offset:0
  ds_read_b64_tr_b16 a[134:135], v155 offset:0
  ds_read_b64_tr_b16 a[136:137], v152 offset:64
  ds_read_b64_tr_b16 a[138:139], v153 offset:64
  ds_read_b64_tr_b16 a[140:141], v154 offset:64
  ds_read_b64_tr_b16 a[142:143], v155 offset:64
  s_waitcnt lgkmcnt(0)
  s_waitcnt vmcnt(24)
  ds_read_b64_tr_b16 a[144:145], v152 offset:4096
  ds_read_b64_tr_b16 a[146:147], v153 offset:4096
  ds_read_b64_tr_b16 a[148:149], v154 offset:4096
  ds_read_b64_tr_b16 a[150:151], v155 offset:4096
  ds_read_b64_tr_b16 a[152:153], v152 offset:4160
  ds_read_b64_tr_b16 a[154:155], v153 offset:4160
  ds_read_b64_tr_b16 a[156:157], v154 offset:4160
  ds_read_b64_tr_b16 a[158:159], v155 offset:4160
  s_waitcnt lgkmcnt(0)
  s_waitcnt vmcnt(20)
  ds_read_b64_tr_b16 a[160:161], v152 offset:8192
  ds_read_b64_tr_b16 a[162:163], v153 offset:8192
  ds_read_b64_tr_b16 a[164:165], v154 offset:8192
  ds_read_b64_tr_b16 a[166:167], v155 offset:8192
  ds_read_b64_tr_b16 a[168:169], v152 offset:8256
  ds_read_b64_tr_b16 a[170:171], v153 offset:8256
  ds_read_b64_tr_b16 a[172:173], v154 offset:8256
  ds_read_b64_tr_b16 a[174:175], v155 offset:8256
  s_waitcnt lgkmcnt(0)
  s_waitcnt vmcnt(16)
  ds_read_b64_tr_b16 a[176:177], v152 offset:12288
  ds_read_b64_tr_b16 a[178:179], v153 offset:12288
  ds_read_b64_tr_b16 a[180:181], v154 offset:12288
  ds_read_b64_tr_b16 a[182:183], v155 offset:12288
  ds_read_b64_tr_b16 a[184:185], v152 offset:12352
  ds_read_b64_tr_b16 a[186:187], v153 offset:12352
  ds_read_b64_tr_b16 a[188:189], v154 offset:12352
  ds_read_b64_tr_b16 a[190:191], v155 offset:12352
  s_waitcnt lgkmcnt(0)
  s_waitcnt vmcnt(12)
  ds_read_b64_tr_b16 a[192:193], v152 offset:16384
  ds_read_b64_tr_b16 a[194:195], v153 offset:16384
  ds_read_b64_tr_b16 a[196:197], v154 offset:16384
  ds_read_b64_tr_b16 a[198:199], v155 offset:16384
  ds_read_b64_tr_b16 a[200:201], v152 offset:16448
  ds_read_b64_tr_b16 a[202:203], v153 offset:16448
  ds_read_b64_tr_b16 a[204:205], v154 offset:16448
  ds_read_b64_tr_b16 a[206:207], v155 offset:16448
  s_waitcnt lgkmcnt(0)
  s_waitcnt vmcnt(8)
  ds_read_b64_tr_b16 a[208:209], v152 offset:20480
  ds_read_b64_tr_b16 a[210:211], v153 offset:20480
  ds_read_b64_tr_b16 a[212:213], v154 offset:20480
  ds_read_b64_tr_b16 a[214:215], v155 offset:20480
  ds_read_b64_tr_b16 a[216:217], v152 offset:20544
  ds_read_b64_tr_b16 a[218:219], v153 offset:20544
  ds_read_b64_tr_b16 a[220:221], v154 offset:20544
  ds_read_b64_tr_b16 a[222:223], v155 offset:20544
  s_waitcnt lgkmcnt(0)
  s_waitcnt vmcnt(4)
  ds_read_b64_tr_b16 a[224:225], v152 offset:24576
  ds_read_b64_tr_b16 a[226:227], v153 offset:24576
  ds_read_b64_tr_b16 a[228:229], v154 offset:24576
  ds_read_b64_tr_b16 a[230:231], v155 offset:24576
  ds_read_b64_tr_b16 a[232:233], v152 offset:24640
  ds_read_b64_tr_b16 a[234:235], v153 offset:24640
  ds_read_b64_tr_b16 a[236:237], v154 offset:24640
  ds_read_b64_tr_b16 a[238:239], v155 offset:24640
  s_waitcnt lgkmcnt(0)
  s_waitcnt vmcnt(0)
  ds_read_b64_tr_b16 a[240:241], v152 offset:28672
  ds_read_b64_tr_b16 a[242:243], v153 offset:28672
  ds_read_b64_tr_b16 a[244:245], v154 offset:28672
  ds_read_b64_tr_b16 a[246:247], v155 offset:28672
  ds_read_b64_tr_b16 a[248:249], v152 offset:28736
  ds_read_b64_tr_b16 a[250:251], v153 offset:28736
  ds_read_b64_tr_b16 a[252:253], v154 offset:28736
  ds_read_b64_tr_b16 a[254:255], v155 offset:28736
  s_waitcnt lgkmcnt(0)
  s_barrier
  s_add_u32 m0, s25, 0
  s_nop 0
  buffer_load_dwordx4 v16, s[12:15], s19 offen lds
  s_add_u32 m0, s25, 1024
  s_nop 0
  buffer_load_dwordx4 v17, s[12:15], s19 offen lds
  s_add_u32 m0, s25, 2048
  s_nop 0
  buffer_load_dwordx4 v18, s[12:15], s19 offen lds
  s_add_u32 m0, s25, 3072
  s_nop 0
  buffer_load_dwordx4 v19, s[12:15], s19 offen lds
  s_add_u32 m0, s25, 4096
  s_nop 0
  buffer_load_dwordx4 v20, s[12:15], s19 offen lds
  s_add_u32 m0, s25, 5120
  s_nop 0
  buffer_load_dwordx4 v21, s[12:15], s19 offen lds
  s_add_u32 m0, s25, 6144
  s_nop 0
  buffer_load_dwordx4 v22, s[12:15], s19 offen lds
  s_add_u32 m0, s25, 7168
  s_nop 0
  buffer_load_dwordx4 v23, s[12:15], s19 offen lds
  s_cmp_gt_u32 s23, 2
  s_cselect_b32 s26, s20, 0
  s_add_u32 s19, s19, s26
  s_add_u32 s25, s25, 32768
  s_and_b32 s25, s25, 0x1ffff
  s_waitcnt vmcnt(0)
  s_barrier
  s_load_dwordx2 s[8:9], s[0:1], 40
  s_mul_i32 s76, s66, 18816
  v_min_u32 v200, 146, v0
  v_lshl_add_u32 v200, v200, 7, s76
  s_waitcnt lgkmcnt(0)
  s_and_b32 s9, s9, 0xffff
  buffer_load_dword v201, v200, s[8:11], 0 offen
  s_cmp_lg_u32 s32, 0
  s_cbranch_scc1 P_v_130
  s_cmp_eq_u32 s48, 0
  s_cbranch_scc1 P_q_132
  s_mov_b32 s27, s21
  v_mov_b32 v7, 0x40000000
  s_mov_b32 s29, -2
  v_min_u32 v145, 1, v0
  v_lshlrev_b32 v145, 30, v145
  ds_read_b128 v[24:27], v8 offset:0
  ds_read_b128 v[28:31], v9 offset:0
  ds_read_b128 v[32:35], v10 offset:0
  ds_read_b128 v[36:39], v11 offset:0
  ds_read_b128 v[40:43], v12 offset:0
  ds_read_b128 v[44:47], v13 offset:0
.p2align 6
G_top_133:
  s_waitcnt lgkmcnt(5)
  v_mfma_f32_16x16x32_bf16 v[64:67], a[0:3], v[24:27], 0
  s_add_u32 m0, s25, 0
  ds_read_b128 v[48:51], v14 offset:0
  v_mfma_f32_16x16x32_bf16 v[68:71], a[4:7], v[24:27], 0
  v_mfma_f32_16x16x32_bf16 v[80:83], a[8:11], v[24:27], 0
  buffer_load_dwordx4 v16, s[12:15], s19 offen lds
  v_mfma_f32_16x16x32_bf16 v[84:87], a[12:15], v[24:27], 0
  s_waitcnt lgkmcnt(5)
  v_mfma_f32_16x16x32_bf16 v[72:75], a[0:3], v[28:31], 0
  ds_read_b128 v[52:55], v15 offset:0
  v_mfma_f32_16x16x32_bf16 v[76:79], a[4:7], v[28:31], 0
  v_cvt_pk_bf16_f32 v128, v96, v97
  v_cvt_pk_bf16_f32 v129, v98, v99
  v_mfma_f32_16x16x32_bf16 v[88:91], a[8:11], v[28:31], 0
  v_mfma_f32_16x16x32_bf16 v[92:95], a[12:15], v[28:31], 0
  s_waitcnt lgkmcnt(5)
  v_cvt_pk_bf16_f32 v130, v100, v101
  v_cvt_pk_bf16_f32 v131, v102, v103
  v_mfma_f32_16x16x32_bf16 v[64:67], a[16:19], v[32:35], v[64:67]
  s_add_u32 m0, s25, 1024
  ds_read_b128 v[24:27], v8 offset:8192
  v_mfma_f32_16x16x32_bf16 v[68:71], a[20:23], v[32:35], v[68:71]
  v_mfma_f32_16x16x32_bf16 v[80:83], a[24:27], v[32:35], v[80:83]
  buffer_load_dwordx4 v17, s[12:15], s19 offen lds
  v_mfma_f32_16x16x32_bf16 v[84:87], a[28:31], v[32:35], v[84:87]
  s_waitcnt lgkmcnt(5)
  v_mfma_f32_16x16x32_bf16 v[72:75], a[16:19], v[36:39], v[72:75]
  ds_read_b128 v[28:31], v9 offset:8192
  v_mfma_f32_16x16x32_bf16 v[76:79], a[20:23], v[36:39], v[76:79]
  v_mfma_f32_16x16x32_bf16 v[88:91], a[24:27], v[36:39], v[88:91]
  v_mfma_f32_16x16x32_bf16 v[92:95], a[28:31], v[36:39], v[92:95]
  s_waitcnt lgkmcnt(5)
  v_mfma_f32_16x16x32_bf16 v[64:67], a[32:35], v[40:43], v[64:67]
  s_add_u32 m0, s25, 2048
  ds_read_b128 v[32:35], v10 offset:8192
  v_mfma_f32_16x16x32_bf16 v[68:71], a[36:39], v[40:43], v[68:71]
  v_cvt_pk_bf16_f32 v132, v104, v105
  v_cvt_pk_bf16_f32 v133, v106, v107
  v_mfma_f32_16x16x32_bf16 v[80:83], a[40:43], v[40:43], v[80:83]
  buffer_load_dwordx4 v18, s[12:15], s19 offen lds
  v_mfma_f32_16x16x32_bf16 v[84:87], a[44:47], v[40:43], v[84:87]
  s_waitcnt lgkmcnt(5)
  v_cvt_pk_bf16_f32 v134, v108, v109
  v_cvt_pk_bf16_f32 v135, v110, v111
  v_mfma_f32_16x16x32_bf16 v[72:75], a[32:35], v[44:47], v[72:75]
  ds_read_b128 v[36:39], v11 offset:8192
  v_mfma_f32_16x16x32_bf16 v[76:79], a[36:39], v[44:47], v[76:79]
  v_mfma_f32_16x16x32_bf16 v[88:91], a[40:43], v[44:47], v[88:91]
  v_mfma_f32_16x16x32_bf16 v[92:95], a[44:47], v[44:47], v[92:95]
  s_waitcnt lgkmcnt(5)
  v_mfma_f32_16x16x32_bf16 v[64:67], a[48:51], v[48:51], v[64:67]
  s_add_u32 m0, s25, 3072
  ds_read_b128 v[40:43], v12 offset:8192
  v_mfma_f32_16x16x32_bf16 v[68:71], a[52:55], v[48:51], v[68:71]
  v_mfma_f32_16x16x32_bf16 v[80:83], a[56:59], v[48:51], v[80:83]
  buffer_load_dwordx4 v19, s[12:15], s19 offen lds
  v_mfma_f32_16x16x32_bf16 v[84:87], a[60:63], v[48:51], v[84:87]
  s_waitcnt lgkmcnt(5)
  v_mfma_f32_16x16x32_bf16 v[72:75], a[48:51], v[52:55], v[72:75]
  ds_read_b128 v[44:47], v13 offset:8192
  v_mfma_f32_16x16x32_bf16 v[76:79], a[52:55], v[52:55], v[76:79]
  v_cvt_pk_bf16_f32 v136, v112, v113
  v_cvt_pk_bf16_f32 v137, v114, v115
  v_mfma_f32_16x16x32_bf16 v[88:91], a[56:59], v[52:55], v[88:91]
  v_mfma_f32_16x16x32_bf16 v[92:95], a[60:63], v[52:55], v[92:95]
  s_waitcnt lgkmcnt(5)
  v_cvt_pk_bf16_f32 v138, v116, v117
  v_cvt_pk_bf16_f32 v139, v118, v119
  v_mfma_f32_16x16x32_bf16 v[64:67], a[64:67], v[24:27], v[64:67]
  s_add_u32 m0, s25, 4096
  ds_read_b128 v[48:51], v14 offset:8192
  v_mfma_f32_16x16x32_bf16 v[68:71], a[68:71], v[24:27], v[68:71]
  v_mfma_f32_16x16x32_bf16 v[80:83], a[72:75], v[24:27], v[80:83]
  buffer_load_dwordx4 v20, s[12:15], s19 offen lds
  v_mfma_f32_16x16x32_bf16 v[84:87], a[76:79], v[24:27], v[84:87]
  s_waitcnt lgkmcnt(5)
  v_mfma_f32_16x16x32_bf16 v[72:75], a[64:67], v[28:31], v[72:75]
  ds_read_b128 v[52:55], v15 offset:8192
  v_mfma_f32_16x16x32_bf16 v[76:79], a[68:71], v[28:31], v[76:79]
  v_mfma_f32_16x16x32_bf16 v[88:91], a[72:75], v[28:31], v[88:91]
  v_mfma_f32_16x16x32_bf16 v[92:95], a[76:79], v[28:31], v[92:95]
  s_waitcnt lgkmcnt(5)
  v_mfma_f32_16x16x32_bf16 v[64:67], a[80:83], v[32:35], v[64:67]
  s_add_u32 m0, s25, 5120
  ds_read_b128 v[24:27], v8 offset:16384
  v_mfma_f32_16x16x32_bf16 v[68:71], a[84:87], v[32:35], v[68:71]
  v_cvt_pk_bf16_f32 v140, v120, v121
  v_cvt_pk_bf16_f32 v141, v122, v123
  v_mfma_f32_16x16x32_bf16 v[80:83], a[88:91], v[32:35], v[80:83]
  buffer_load_dwordx4 v21, s[12:15], s19 offen lds
  v_mfma_f32_16x16x32_bf16 v[84:87], a[92:95], v[32:35], v[84:87]
  s_waitcnt lgkmcnt(5)
  v_cvt_pk_bf16_f32 v142, v124, v125
  v_cvt_pk_bf16_f32 v143, v126, v127
  v_mfma_f32_16x16x32_bf16 v[72:75], a[80:83], v[36:39], v[72:75]
  ds_read_b128 v[28:31], v9 offset:16384
  v_mfma_f32_16x16x32_bf16 v[76:79], a[84:87], v[36:39], v[76:79]
  v_mfma_f32_16x16x32_bf16 v[88:91], a[88:91], v[36:39], v[88:91]
  v_mfma_f32_16x16x32_bf16 v[92:95], a[92:95], v[36:39], v[92:95]
  s_waitcnt lgkmcnt(5)
  v_mfma_f32_16x16x32_bf16 v[64:67], a[96:99], v[40:43], v[64:67]
  s_add_u32 m0, s25, 6144
  ds_read_b128 v[32:35], v10 offset:16384
  v_mfma_f32_16x16x32_bf16 v[68:71], a[100:103], v[40:43], v[68:71]
  v_mfma_f32_16x16x32_bf16 v[80:83], a[104:107], v[40:43], v[80:83]
  buffer_load_dwordx4 v22, s[12:15], s19 offen lds
  v_mfma_f32_16x16x32_bf16 v[84:87], a[108:111], v[40:43], v[84:87]
  s_waitcnt lgkmcnt(5)
  v_mfma_f32_16x16x32_bf16 v[72:75], a[96:99], v[44:47], v[72:75]
  ds_read_b128 v[36:39], v11 offset:16384
  v_mfma_f32_16x16x32_bf16 v[76:79], a[100:103], v[44:47], v[76:79]
  v_mfma_f32_16x16x32_bf16 v[88:91], a[104:107], v[44:47], v[88:91]
  v_mfma_f32_16x16x32_bf16 v[92:95], a[108:111], v[44:47], v[92:95]
  s_waitcnt lgkmcnt(5)
  v_mfma_f32_16x16x32_bf16 v[64:67], a[112:115], v[48:51], v[64:67]
  s_add_u32 m0, s25, 7168
  ds_read_b128 v[40:43], v12 offset:16384
  v_mfma_f32_16x16x32_bf16 v[68:71], a[116:119], v[48:51], v[68:71]
  v_mfma_f32_16x16x32_bf16 v[80:83], a[120:123], v[48:51], v[80:83]
  buffer_load_dwordx4 v23, s[12:15], s19 offen lds
  v_mfma_f32_16x16x32_bf16 v[84:87], a[124:127], v[48:51], v[84:87]
  s_waitcnt lgkmcnt(5)
  v_mfma_f32_16x16x32_bf16 v[72:75], a[112:115], v[52:55], v[72:75]
  s_cmp_gt_u32 s23, 3
  ds_read_b128 v[44:47], v13 offset:16384
  v_mfma_f32_16x16x32_bf16 v[76:79], a[116:119], v[52:55], v[76:79]
  v_mfma_f32_16x16x32_bf16 v[88:91], a[120:123], v[52:55], v[88:91]
  s_cselect_b32 s26, s20, 0
  v_mfma_f32_16x16x32_bf16 v[92:95], a[124:127], v[52:55], v[92:95]
  s_waitcnt lgkmcnt(5)
  v_mfma_f32_16x16x32_bf16 v[64:67], a[128:131], v[24:27], v[64:67]
  s_add_u32 s19, s19, s26
  ds_read_b128 v[48:51], v14 offset:16384
  v_mfma_f32_16x16x32_bf16 v[68:71], a[132:135], v[24:27], v[68:71]
  v_mfma_f32_16x16x32_bf16 v[80:83], a[136:139], v[24:27], v[80:83]
  s_add_u32 s25, s25, 32768
  v_mfma_f32_16x16x32_bf16 v[84:87], a[140:143], v[24:27], v[84:87]
  s_waitcnt lgkmcnt(5)
  v_mfma_f32_16x16x32_bf16 v[72:75], a[128:131], v[28:31], v[72:75]
  s_and_b32 s25, s25, 0x1ffff
  ds_read_b128 v[52:55], v15 offset:16384
  v_mfma_f32_16x16x32_bf16 v[76:79], a[132:135], v[28:31], v[76:79]
  v_mfma_f32_16x16x32_bf16 v[88:91], a[136:139], v[28:31], v[88:91]
  buffer_store_dwordx4 v[128:131], v7, s[4:7], s21 offen offset:0 sc1
  v_mfma_f32_16x16x32_bf16 v[92:95], a[140:143], v[28:31], v[92:95]
  s_waitcnt lgkmcnt(5)
  v_mfma_f32_16x16x32_bf16 v[64:67], a[144:147], v[32:35], v[64:67]
  ds_read_b128 v[24:27], v8 offset:24576
  v_mfma_f32_16x16x32_bf16 v[68:71], a[148:151], v[32:35], v[68:71]
  v_mfma_f32_16x16x32_bf16 v[80:83], a[152:155], v[32:35], v[80:83]
  v_mfma_f32_16x16x32_bf16 v[84:87], a[156:159], v[32:35], v[84:87]
  s_waitcnt lgkmcnt(5)
  v_mfma_f32_16x16x32_bf16 v[72:75], a[144:147], v[36:39], v[72:75]
  ds_read_b128 v[28:31], v9 offset:24576
  v_mfma_f32_16x16x32_bf16 v[76:79], a[148:151], v[36:39], v[76:79]
  v_mfma_f32_16x16x32_bf16 v[88:91], a[152:155], v[36:39], v[88:91]
  buffer_store_dwordx4 v[132:135], v7, s[4:7], s21 offen offset:256 sc1
  v_mfma_f32_16x16x32_bf16 v[92:95], a[156:159], v[36:39], v[92:95]
  s_waitcnt lgkmcnt(5)
  v_mfma_f32_16x16x32_bf16 v[64:67], a[160:163], v[40:43], v[64:67]
  ds_read_b128 v[32:35], v10 offset:24576
  v_mfma_f32_16x16x32_bf16 v[68:71], a[164:167], v[40:43], v[68:71]
  v_mfma_f32_16x16x32_bf16 v[80:83], a[168:171], v[40:43], v[80:83]
  v_mfma_f32_16x16x32_bf16 v[84:87], a[172:175], v[40:43], v[84:87]
  s_waitcnt lgkmcnt(5)
  v_mfma_f32_16x16x32_bf16 v[72:75], a[160:163], v[44:47], v[72:75]
  ds_read_b128 v[36:39], v11 offset:24576
  v_mfma_f32_16x16x32_bf16 v[76:79], a[164:167], v[44:47], v[76:79]
  v_mfma_f32_16x16x32_bf16 v[88:91], a[168:171], v[44:47], v[88:91]
  buffer_store_dwordx4 v[136:139], v7, s[4:7], s21 offen offset:2048 sc1
  v_mfma_f32_16x16x32_bf16 v[92:95], a[172:175], v[44:47], v[92:95]
  s_waitcnt lgkmcnt(5)
  v_mfma_f32_16x16x32_bf16 v[64:67], a[176:179], v[48:51], v[64:67]
  ds_read_b128 v[40:43], v12 offset:24576
  v_mfma_f32_16x16x32_bf16 v[68:71], a[180:183], v[48:51], v[68:71]
  v_mfma_f32_16x16x32_bf16 v[80:83], a[184:187], v[48:51], v[80:83]
  v_mfma_f32_16x16x32_bf16 v[84:87], a[188:191], v[48:51], v[84:87]
  s_waitcnt lgkmcnt(5)
  v_mfma_f32_16x16x32_bf16 v[72:75], a[176:179], v[52:55], v[72:75]
  ds_read_b128 v[44:47], v13 offset:24576
  v_mfma_f32_16x16x32_bf16 v[76:79], a[180:183], v[52:55], v[76:79]
  v_mfma_f32_16x16x32_bf16 v[88:91], a[184:187], v[52:55], v[88:91]
  buffer_store_dwordx4 v[140:143], v7, s[4:7], s21 offen offset:2304 sc1
  v_mfma_f32_16x16x32_bf16 v[92:95], a[188:191], v[52:55], v[92:95]
  s_waitcnt lgkmcnt(5)
  v_mfma_f32_16x16x32_bf16 v[64:67], a[192:195], v[24:27], v[64:67]
  s_mov_b32 s21, s27
  ds_read_b128 v[48:51], v14 offset:24576
  v_mfma_f32_16x16x32_bf16 v[68:71], a[196:199], v[24:27], v[68:71]
  v_mov_b32 v7, v56
  v_mfma_f32_16x16x32_bf16 v[80:83], a[200:203], v[24:27], v[80:83]
  v_mfma_f32_16x16x32_bf16 v[84:87], a[204:207], v[24:27], v[84:87]
  s_waitcnt lgkmcnt(5)
  v_mfma_f32_16x16x32_bf16 v[72:75], a[192:195], v[28:31], v[72:75]
  s_add_u32 s27, s27, s22
  ds_read_b128 v[52:55], v15 offset:24576
  v_mfma_f32_16x16x32_bf16 v[76:79], a[196:199], v[28:31], v[76:79]
  v_mfma_f32_16x16x32_bf16 v[88:91], a[200:203], v[28:31], v[88:91]
  s_waitcnt vmcnt(13)
  s_barrier
  v_mfma_f32_16x16x32_bf16 v[92:95], a[204:207], v[28:31], v[92:95]
  s_waitcnt lgkmcnt(5)
  v_mfma_f32_16x16x32_bf16 v[64:67], a[208:211], v[32:35], v[64:67]
  ds_read_b128 v[24:27], v8 offset:32768
  v_mfma_f32_16x16x32_bf16 v[68:71], a[212:215], v[32:35], v[68:71]
  v_mfma_f32_16x16x32_bf16 v[80:83], a[216:219], v[32:35], v[80:83]
  v_mfma_f32_16x16x32_bf16 v[84:87], a[220:223], v[32:35], v[84:87]
  s_waitcnt lgkmcnt(5)
  v_mfma_f32_16x16x32_bf16 v[72:75], a[208:211], v[36:39], v[72:75]
  s_add_u32 s29, s29, 1
  ds_read_b128 v[28:31], v9 offset:32768
  v_mfma_f32_16x16x32_bf16 v[76:79], a[212:215], v[36:39], v[76:79]
  v_mfma_f32_16x16x32_bf16 v[88:91], a[216:219], v[36:39], v[88:91]
  s_max_i32 s30, s29, 0
  v_mfma_f32_16x16x32_bf16 v[92:95], a[220:223], v[36:39], v[92:95]
  s_waitcnt lgkmcnt(5)
  v_mov_b32 v144, s30
  v_mfma_f32_16x16x32_bf16 v[64:67], a[224:227], v[40:43], v[64:67]
  ds_read_b128 v[32:35], v10 offset:32768
  v_mfma_f32_16x16x32_bf16 v[68:71], a[228:231], v[40:43], v[68:71]
  v_mfma_f32_16x16x32_bf16 v[80:83], a[232:235], v[40:43], v[80:83]
  buffer_store_dword v144, v145, s[4:7], s31 offen sc1
  v_mfma_f32_16x16x32_bf16 v[84:87], a[236:239], v[40:43], v[84:87]
  s_waitcnt lgkmcnt(5)
  v_mfma_f32_16x16x32_bf16 v[72:75], a[224:227], v[44:47], v[72:75]
  ds_read_b128 v[36:39], v11 offset:32768
  v_mfma_f32_16x16x32_bf16 v[76:79], a[228:231], v[44:47], v[76:79]
  v_mfma_f32_16x16x32_bf16 v[88:91], a[232:235], v[44:47], v[88:91]
  v_mfma_f32_16x16x32_bf16 v[92:95], a[236:239], v[44:47], v[92:95]
  s_waitcnt lgkmcnt(5)
  v_mfma_f32_16x16x32_bf16 v[64:67], a[240:243], v[48:51], v[64:67]
  s_sub_u32 s23, s23, 1
  ds_read_b128 v[40:43], v12 offset:32768
  v_mfma_f32_16x16x32_bf16 v[68:71], a[244:247], v[48:51], v[68:71]
  v_mfma_f32_16x16x32_bf16 v[80:83], a[248:251], v[48:51], v[80:83]
  v_mfma_f32_16x16x32_bf16 v[84:87], a[252:255], v[48:51], v[84:87]
  s_waitcnt lgkmcnt(5)
  v_mfma_f32_16x16x32_bf16 v[72:75], a[240:243], v[52:55], v[72:75]
  s_cmp_eq_u32 s23, 0
  ds_read_b128 v[44:47], v13 offset:32768
  v_mfma_f32_16x16x32_bf16 v[76:79], a[244:247], v[52:55], v[76:79]
  v_mfma_f32_16x16x32_bf16 v[88:91], a[248:251], v[52:55], v[88:91]
  v_mfma_f32_16x16x32_bf16 v[92:95], a[252:255], v[52:55], v[92:95]
  s_cbranch_scc1 G_done0_134
  s_waitcnt lgkmcnt(5)
  v_mfma_f32_16x16x32_bf16 v[96:99], a[0:3], v[24:27], 0
  s_add_u32 m0, s25, 0
  ds_read_b128 v[48:51], v14 offset:32768
  v_mfma_f32_16x16x32_bf16 v[100:103], a[4:7], v[24:27], 0
  v_mfma_f32_16x16x32_bf16 v[112:115], a[8:11], v[24:27], 0
  buffer_load_dwordx4 v16, s[12:15], s19 offen lds
  v_mfma_f32_16x16x32_bf16 v[116:119], a[12:15], v[24:27], 0
  s_waitcnt lgkmcnt(5)
  v_mfma_f32_16x16x32_bf16 v[104:107], a[0:3], v[28:31], 0
  ds_read_b128 v[52:55], v15 offset:32768
  v_mfma_f32_16x16x32_bf16 v[108:111], a[4:7], v[28:31], 0
  v_cvt_pk_bf16_f32 v128, v64, v65
  v_cvt_pk_bf16_f32 v129, v66, v67
  v_mfma_f32_16x16x32_bf16 v[120:123], a[8:11], v[28:31], 0
  v_mfma_f32_16x16x32_bf16 v[124:127], a[12:15], v[28:31], 0
  s_waitcnt lgkmcnt(5)
  v_cvt_pk_bf16_f32 v130, v68, v69
  v_cvt_pk_bf16_f32 v131, v70, v71
  v_mfma_f32_16x16x32_bf16 v[96:99], a[16:19], v[32:35], v[96:99]
  s_add_u32 m0, s25, 1024
  ds_read_b128 v[24:27], v8 offset:40960
  v_mfma_f32_16x16x32_bf16 v[100:103], a[20:23], v[32:35], v[100:103]
  v_mfma_f32_16x16x32_bf16 v[112:115], a[24:27], v[32:35], v[112:115]
  buffer_load_dwordx4 v17, s[12:15], s19 offen lds
  v_mfma_f32_16x16x32_bf16 v[116:119], a[28:31], v[32:35], v[116:119]
  s_waitcnt lgkmcnt(5)
  v_mfma_f32_16x16x32_bf16 v[104:107], a[16:19], v[36:39], v[104:107]
  ds_read_b128 v[28:31], v9 offset:40960
  v_mfma_f32_16x16x32_bf16 v[108:111], a[20:23], v[36:39], v[108:111]
  v_mfma_f32_16x16x32_bf16 v[120:123], a[24:27], v[36:39], v[120:123]
  v_mfma_f32_16x16x32_bf16 v[124:127], a[28:31], v[36:39], v[124:127]
  s_waitcnt lgkmcnt(5)
  v_mfma_f32_16x16x32_bf16 v[96:99], a[32:35], v[40:43], v[96:99]
  s_add_u32 m0, s25, 2048
  ds_read_b128 v[32:35], v10 offset:40960
  v_mfma_f32_16x16x32_bf16 v[100:103], a[36:39], v[40:43], v[100:103]
  v_cvt_pk_bf16_f32 v132, v72, v73
  v_cvt_pk_bf16_f32 v133, v74, v75
  v_mfma_f32_16x16x32_bf16 v[112:115], a[40:43], v[40:43], v[112:115]
  buffer_load_dwordx4 v18, s[12:15], s19 offen lds
  v_mfma_f32_16x16x32_bf16 v[116:119], a[44:47], v[40:43], v[116:119]
  s_waitcnt lgkmcnt(5)
  v_cvt_pk_bf16_f32 v134, v76, v77
  v_cvt_pk_bf16_f32 v135, v78, v79
  v_mfma_f32_16x16x32_bf16 v[104:107], a[32:35], v[44:47], v[104:107]
  ds_read_b128 v[36:39], v11 offset:40960
  v_mfma_f32_16x16x32_bf16 v[108:111], a[36:39], v[44:47], v[108:111]
  v_mfma_f32_16x16x32_bf16 v[120:123], a[40:43], v[44:47], v[120:123]
  v_mfma_f32_16x16x32_bf16 v[124:127], a[44:47], v[44:47], v[124:127]
  s_waitcnt lgkmcnt(5)
  v_mfma_f32_16x16x32_bf16 v[96:99], a[48:51], v[48:51], v[96:99]
  s_add_u32 m0, s25, 3072
  ds_read_b128 v[40:43], v12 offset:40960
  v_mfma_f32_16x16x32_bf16 v[100:103], a[52:55], v[48:51], v[100:103]
  v_mfma_f32_16x16x32_bf16 v[112:115], a[56:59], v[48:51], v[112:115]
  buffer_load_dwordx4 v19, s[12:15], s19 offen lds
  v_mfma_f32_16x16x32_bf16 v[116:119], a[60:63], v[48:51], v[116:119]
  s_waitcnt lgkmcnt(5)
  v_mfma_f32_16x16x32_bf16 v[104:107], a[48:51], v[52:55], v[104:107]
  ds_read_b128 v[44:47], v13 offset:40960
  v_mfma_f32_16x16x32_bf16 v[108:111], a[52:55], v[52:55], v[108:111]
  v_cvt_pk_bf16_f32 v136, v80, v81
  v_cvt_pk_bf16_f32 v137, v82, v83
  v_mfma_f32_16x16x32_bf16 v[120:123], a[56:59], v[52:55], v[120:123]
  v_mfma_f32_16x16x32_bf16 v[124:127], a[60:63], v[52:55], v[124:127]
  s_waitcnt lgkmcnt(5)
  v_cvt_pk_bf16_f32 v138, v84, v85
  v_cvt_pk_bf16_f32 v139, v86, v87
  v_mfma_f32_16x16x32_bf16 v[96:99], a[64:67], v[24:27], v[96:99]
  s_add_u32 m0, s25, 4096
  ds_read_b128 v[48:51], v14 offset:40960
  v_mfma_f32_16x16x32_bf16 v[100:103], a[68:71], v[24:27], v[100:103]
  v_mfma_f32_16x16x32_bf16 v[112:115], a[72:75], v[24:27], v[112:115]
  buffer_load_dwordx4 v20, s[12:15], s19 offen lds
  v_mfma_f32_16x16x32_bf16 v[116:119], a[76:79], v[24:27], v[116:119]
  s_waitcnt lgkmcnt(5)
  v_mfma_f32_16x16x32_bf16 v[104:107], a[64:67], v[28:31], v[104:107]
  ds_read_b128 v[52:55], v15 offset:40960
  v_mfma_f32_16x16x32_bf16 v[108:111], a[68:71], v[28:31], v[108:111]
  v_mfma_f32_16x16x32_bf16 v[120:123], a[72:75], v[28:31], v[120:123]
  v_mfma_f32_16x16x32_bf16 v[124:127], a[76:79], v[28:31], v[124:127]
  s_waitcnt lgkmcnt(5)
  v_mfma_f32_16x16x32_bf16 v[96:99], a[80:83], v[32:35], v[96:99]
  s_add_u32 m0, s25, 5120
  ds_read_b128 v[24:27], v8 offset:49152
  v_mfma_f32_16x16x32_bf16 v[100:103], a[84:87], v[32:35], v[100:103]
  v_cvt_pk_bf16_f32 v140, v88, v89
  v_cvt_pk_bf16_f32 v141, v90, v91
  v_mfma_f32_16x16x32_bf16 v[112:115], a[88:91], v[32:35], v[112:115]
  buffer_load_dwordx4 v21, s[12:15], s19 offen lds
  v_mfma_f32_16x16x32_bf16 v[116:119], a[92:95], v[32:35], v[116:119]
  s_waitcnt lgkmcnt(5)
  v_cvt_pk_bf16_f32 v142, v92, v93
  v_cvt_pk_bf16_f32 v143, v94, v95
  v_mfma_f32_16x16x32_bf16 v[104:107], a[80:83], v[36:39], v[104:107]
  ds_read_b128 v[28:31], v9 offset:49152
  v_mfma_f32_16x16x32_bf16 v[108:111], a[84:87], v[36:39], v[108:111]
  v_mfma_f32_16x16x32_bf16 v[120:123], a[88:91], v[36:39], v[120:123]
  v_mfma_f32_16x16x32_bf16 v[124:127], a[92:95], v[36:39], v[124:127]
  s_waitcnt lgkmcnt(5)
  v_mfma_f32_16x16x32_bf16 v[96:99], a[96:99], v[40:43], v[96:99]
  s_add_u32 m0, s25, 6144
  ds_read_b128 v[32:35], v10 offset:49152
  v_mfma_f32_16x16x32_bf16 v[100:103], a[100:103], v[40:43], v[100:103]
  v_mfma_f32_16x16x32_bf16 v[112:115], a[104:107], v[40:43], v[112:115]
  buffer_load_dwordx4 v22, s[12:15], s19 offen lds
  v_mfma_f32_16x16x32_bf16 v[116:119], a[108:111], v[40:43], v[116:119]
  s_waitcnt lgkmcnt(5)
  v_mfma_f32_16x16x32_bf16 v[104:107], a[96:99], v[44:47], v[104:107]
  ds_read_b128 v[36:39], v11 offset:49152
  v_mfma_f32_16x16x32_bf16 v[108:111], a[100:103], v[44:47], v[108:111]
  v_mfma_f32_16x16x32_bf16 v[120:123], a[104:107], v[44:47], v[120:123]
  v_mfma_f32_16x16x32_bf16 v[124:127], a[108:111], v[44:47], v[124:127]
  s_waitcnt lgkmcnt(5)
  v_mfma_f32_16x16x32_bf16 v[96:99], a[112:115], v[48:51], v[96:99]
  s_add_u32 m0, s25, 7168
  ds_read_b128 v[40:43], v12 offset:49152
  v_mfma_f32_16x16x32_bf16 v[100:103], a[116:119], v[48:51], v[100:103]
  v_mfma_f32_16x16x32_bf16 v[112:115], a[120:123], v[48:51], v[112:115]
  buffer_load_dwordx4 v23, s[12:15], s19 offen lds
  v_mfma_f32_16x16x32_bf16 v[116:119], a[124:127], v[48:51], v[116:119]
  s_waitcnt lgkmcnt(5)
  v_mfma_f32_16x16x32_bf16 v[104:107], a[112:115], v[52:55], v[104:107]
  s_cmp_gt_u32 s23, 3
  ds_read_b128 v[44:47], v13 offset:49152
  v_mfma_f32_16x16x32_bf16 v[108:111], a[116:119], v[52:55], v[108:111]
  v_mfma_f32_16x16x32_bf16 v[120:123], a[120:123], v[52:55], v[120:123]
  s_cselect_b32 s26, s20, 0
  v_mfma_f32_16x16x32_bf16 v[124:127], a[124:127], v[52:55], v[124:127]
  s_waitcnt lgkmcnt(5)
  v_mfma_f32_16x16x32_bf16 v[96:99], a[128:131], v[24:27], v[96:99]
  s_add_u32 s19, s19, s26
  ds_read_b128 v[48:51], v14 offset:49152
  v_mfma_f32_16x16x32_bf16 v[100:103], a[132:135], v[24:27], v[100:103]
  v_mfma_f32_16x16x32_bf16 v[112:115], a[136:139], v[24:27], v[112:115]
  s_add_u32 s25, s25, 32768
  v_mfma_f32_16x16x32_bf16 v[116:119], a[140:143], v[24:27], v[116:119]
  s_waitcnt lgkmcnt(5)
  v_mfma_f32_16x16x32_bf16 v[104:107], a[128:131], v[28:31], v[104:107]
  s_and_b32 s25, s25, 0x1ffff
  ds_read_b128 v[52:55], v15 offset:49152
  v_mfma_f32_16x16x32_bf16 v[108:111], a[132:135], v[28:31], v[108:111]
  v_mfma_f32_16x16x32_bf16 v[120:123], a[136:139], v[28:31], v[120:123]
  buffer_store_dwordx4 v[128:131], v7, s[4:7], s21 offen offset:0 sc1
  v_mfma_f32_16x16x32_bf16 v[124:127], a[140:143], v[28:31], v[124:127]
  s_waitcnt lgkmcnt(5)
  v_mfma_f32_16x16x32_bf16 v[96:99], a[144:147], v[32:35], v[96:99]
  ds_read_b128 v[24:27], v8 offset:57344
  v_mfma_f32_16x16x32_bf16 v[100:103], a[148:151], v[32:35], v[100:103]
  v_mfma_f32_16x16x32_bf16 v[112:115], a[152:155], v[32:35], v[112:115]
  v_mfma_f32_16x16x32_bf16 v[116:119], a[156:159], v[32:35], v[116:119]
  s_waitcnt lgkmcnt(5)
  v_xor_b32 v8, 0x10000, v8
  v_mfma_f32_16x16x32_bf16 v[104:107], a[144:147], v[36:39], v[104:107]
  ds_read_b128 v[28:31], v9 offset:57344
  v_mfma_f32_16x16x32_bf16 v[108:111], a[148:151], v[36:39], v[108:111]
  v_mfma_f32_16x16x32_bf16 v[120:123], a[152:155], v[36:39], v[120:123]
  buffer_store_dwordx4 v[132:135], v7, s[4:7], s21 offen offset:256 sc1
  v_mfma_f32_16x16x32_bf16 v[124:127], a[156:159], v[36:39], v[124:127]
  s_waitcnt lgkmcnt(5)
  v_xor_b32 v9, 0x10000, v9
  v_mfma_f32_16x16x32_bf16 v[96:99], a[160:163], v[40:43], v[96:99]
  ds_read_b128 v[32:35], v10 offset:57344
  v_mfma_f32_16x16x32_bf16 v[100:103], a[164:167], v[40:43], v[100:103]
  v_mfma_f32_16x16x32_bf16 v[112:115], a[168:171], v[40:43], v[112:115]
  v_mfma_f32_16x16x32_bf16 v[116:119], a[172:175], v[40:43], v[116:119]
  s_waitcnt lgkmcnt(5)
  v_xor_b32 v10, 0x10000, v10
  v_mfma_f32_16x16x32_bf16 v[104:107], a[160:163], v[44:47], v[104:107]
  ds_read_b128 v[36:39], v11 offset:57344
  v_mfma_f32_16x16x32_bf16 v[108:111], a[164:167], v[44:47], v[108:111]
  v_mfma_f32_16x16x32_bf16 v[120:123], a[168:171], v[44:47], v[120:123]
  buffer_store_dwordx4 v[136:139], v7, s[4:7], s21 offen offset:2048 sc1
  v_mfma_f32_16x16x32_bf16 v[124:127], a[172:175], v[44:47], v[124:127]
  s_waitcnt lgkmcnt(5)
  v_xor_b32 v11, 0x10000, v11
  v_mfma_f32_16x16x32_bf16 v[96:99], a[176:179], v[48:51], v[96:99]
  ds_read_b128 v[40:43], v12 offset:57344
  v_mfma_f32_16x16x32_bf16 v[100:103], a[180:183], v[48:51], v[100:103]
  v_mfma_f32_16x16x32_bf16 v[112:115], a[184:187], v[48:51], v[112:115]
  v_mfma_f32_16x16x32_bf16 v[116:119], a[188:191], v[48:51], v[116:119]
  s_waitcnt lgkmcnt(5)
  v_xor_b32 v12, 0x10000, v12
  v_mfma_f32_16x16x32_bf16 v[104:107], a[176:179], v[52:55], v[104:107]
  ds_read_b128 v[44:47], v13 offset:57344
  v_mfma_f32_16x16x32_bf16 v[108:111], a[180:183], v[52:55], v[108:111]
  v_mfma_f32_16x16x32_bf16 v[120:123], a[184:187], v[52:55], v[120:123]
  buffer_store_dwordx4 v[140:143], v7, s[4:7], s21 offen offset:2304 sc1
  v_mfma_f32_16x16x32_bf16 v[124:127], a[188:191], v[52:55], v[124:127]
  s_waitcnt lgkmcnt(5)
  v_xor_b32 v13, 0x10000, v13
  v_mfma_f32_16x16x32_bf16 v[96:99], a[192:195], v[24:27], v[96:99]
  s_mov_b32 s21, s27
  ds_read_b128 v[48:51], v14 offset:57344
  v_mfma_f32_16x16x32_bf16 v[100:103], a[196:199], v[24:27], v[100:103]
  v_mov_b32 v7, v56
  v_mfma_f32_16x16x32_bf16 v[112:115], a[200:203], v[24:27], v[112:115]
  v_mfma_f32_16x16x32_bf16 v[116:119], a[204:207], v[24:27], v[116:119]
  s_waitcnt lgkmcnt(5)
  v_xor_b32 v14, 0x10000, v14
  v_mfma_f32_16x16x32_bf16 v[104:107], a[192:195], v[28:31], v[104:107]
  s_add_u32 s27, s27, s22
  ds_read_b128 v[52:55], v15 offset:57344
  v_mfma_f32_16x16x32_bf16 v[108:111], a[196:199], v[28:31], v[108:111]
  v_mfma_f32_16x16x32_bf16 v[120:123], a[200:203], v[28:31], v[120:123]
  s_waitcnt vmcnt(13)
  s_barrier
  v_mfma_f32_16x16x32_bf16 v[124:127], a[204:207], v[28:31], v[124:127]
  s_waitcnt lgkmcnt(5)
  v_xor_b32 v15, 0x10000, v15
  v_mfma_f32_16x16x32_bf16 v[96:99], a[208:211], v[32:35], v[96:99]
  ds_read_b128 v[24:27], v8 offset:0
  v_mfma_f32_16x16x32_bf16 v[100:103], a[212:215], v[32:35], v[100:103]
  v_mfma_f32_16x16x32_bf16 v[112:115], a[216:219], v[32:35], v[112:115]
  v_mfma_f32_16x16x32_bf16 v[116:119], a[220:223], v[32:35], v[116:119]
  s_waitcnt lgkmcnt(5)
  v_mfma_f32_16x16x32_bf16 v[104:107], a[208:211], v[36:39], v[104:107]
  s_add_u32 s29, s29, 1
  ds_read_b128 v[28:31], v9 offset:0
  v_mfma_f32_16x16x32_bf16 v[108:111], a[212:215], v[36:39], v[108:111]
  v_mfma_f32_16x16x32_bf16 v[120:123], a[216:219], v[36:39], v[120:123]
  s_max_i32 s30, s29, 0
  v_mfma_f32_16x16x32_bf16 v[124:127], a[220:223], v[36:39], v[124:127]
  s_waitcnt lgkmcnt(5)
  v_mov_b32 v144, s30
  v_mfma_f32_16x16x32_bf16 v[96:99], a[224:227], v[40:43], v[96:99]
  ds_read_b128 v[32:35], v10 offset:0
  v_mfma_f32_16x16x32_bf16 v[100:103], a[228:231], v[40:43], v[100:103]
  v_mfma_f32_16x16x32_bf16 v[112:115], a[232:235], v[40:43], v[112:115]
  buffer_store_dword v144, v145, s[4:7], s31 offen sc1
  v_mfma_f32_16x16x32_bf16 v[116:119], a[236:239], v[40:43], v[116:119]
  s_waitcnt lgkmcnt(5)
  v_mfma_f32_16x16x32_bf16 v[104:107], a[224:227], v[44:47], v[104:107]
  ds_read_b128 v[36:39], v11 offset:0
  v_mfma_f32_16x16x32_bf16 v[108:111], a[228:231], v[44:47], v[108:111]
  v_mfma_f32_16x16x32_bf16 v[120:123], a[232:235], v[44:47], v[120:123]
  v_mfma_f32_16x16x32_bf16 v[124:127], a[236:239], v[44:47], v[124:127]
  s_waitcnt lgkmcnt(5)
  v_mfma_f32_16x16x32_bf16 v[96:99], a[240:243], v[48:51], v[96:99]
  s_sub_u32 s23, s23, 1
  ds_read_b128 v[40:43], v12 offset:0
  v_mfma_f32_16x16x32_bf16 v[100:103], a[244:247], v[48:51], v[100:103]
  v_mfma_f32_16x16x32_bf16 v[112:115], a[248:251], v[48:51], v[112:115]
  v_mfma_f32_16x16x32_bf16 v[116:119], a[252:255], v[48:51], v[116:119]
  s_waitcnt lgkmcnt(5)
  v_mfma_f32_16x16x32_bf16 v[104:107], a[240:243], v[52:55], v[104:107]
  s_cmp_eq_u32 s23, 0
  ds_read_b128 v[44:47], v13 offset:0
  v_mfma_f32_16x16x32_bf16 v[108:111], a[244:247], v[52:55], v[108:111]
  v_mfma_f32_16x16x32_bf16 v[120:123], a[248:251], v[52:55], v[120:123]
  v_mfma_f32_16x16x32_bf16 v[124:127], a[252:255], v[52:55], v[124:127]
  s_cbranch_scc1 G_done1_135
  s_branch G_top_133
G_done0_134:
  s_nop 7
  s_nop 3
  v_cvt_pk_bf16_f32 v128, v64, v65
  v_cvt_pk_bf16_f32 v129, v66, v67
  v_cvt_pk_bf16_f32 v130, v68, v69
  v_cvt_pk_bf16_f32 v131, v70, v71
  buffer_store_dwordx4 v[128:131], v7, s[4:7], s21 offen offset:0 sc1
  v_cvt_pk_bf16_f32 v132, v72, v73
  v_cvt_pk_bf16_f32 v133, v74, v75
  v_cvt_pk_bf16_f32 v134, v76, v77
  v_cvt_pk_bf16_f32 v135, v78, v79
  buffer_store_dwordx4 v[132:135], v7, s[4:7], s21 offen offset:256 sc1
  v_cvt_pk_bf16_f32 v136, v80, v81
  v_cvt_pk_bf16_f32 v137, v82, v83
  v_cvt_pk_bf16_f32 v138, v84, v85
  v_cvt_pk_bf16_f32 v139, v86, v87
  buffer_store_dwordx4 v[136:139], v7, s[4:7], s21 offen offset:2048 sc1
  v_cvt_pk_bf16_f32 v140, v88, v89
  v_cvt_pk_bf16_f32 v141, v90, v91
  v_cvt_pk_bf16_f32 v142, v92, v93
  v_cvt_pk_bf16_f32 v143, v94, v95
  buffer_store_dwordx4 v[140:143], v7, s[4:7], s21 offen offset:2304 sc1
  s_branch G_fin_136
G_done1_135:
  s_nop 7
  s_nop 3
  v_cvt_pk_bf16_f32 v128, v96, v97
  v_cvt_pk_bf16_f32 v129, v98, v99
  v_cvt_pk_bf16_f32 v130, v100, v101
  v_cvt_pk_bf16_f32 v131, v102, v103
  buffer_store_dwordx4 v[128:131], v7, s[4:7], s21 offen offset:0 sc1
  v_cvt_pk_bf16_f32 v132, v104, v105
  v_cvt_pk_bf16_f32 v133, v106, v107
  v_cvt_pk_bf16_f32 v134, v108, v109
  v_cvt_pk_bf16_f32 v135, v110, v111
  buffer_store_dwordx4 v[132:135], v7, s[4:7], s21 offen offset:256 sc1
  v_cvt_pk_bf16_f32 v136, v112, v113
  v_cvt_pk_bf16_f32 v137, v114, v115
  v_cvt_pk_bf16_f32 v138, v116, v117
  v_cvt_pk_bf16_f32 v139, v118, v119
  buffer_store_dwordx4 v[136:139], v7, s[4:7], s21 offen offset:2048 sc1
  v_cvt_pk_bf16_f32 v140, v120, v121
  v_cvt_pk_bf16_f32 v141, v122, v123
  v_cvt_pk_bf16_f32 v142, v124, v125
  v_cvt_pk_bf16_f32 v143, v126, v127
  buffer_store_dwordx4 v[140:143], v7, s[4:7], s21 offen offset:2304 sc1
G_fin_136:
  s_waitcnt vmcnt(0) lgkmcnt(0)
  s_barrier
  s_add_u32 s30, s29, 2
  v_mov_b32 v144, s30
  v_min_u32 v145, 1, v0
  v_lshlrev_b32 v145, 30, v145
  buffer_store_dword v144, v145, s[4:7], s31 offen sc1
  s_branch P_end_131
P_q_132:
  s_mov_b32 s27, s21
  v_mov_b32 v7, 0x40000000
  s_mov_b32 s29, -2
  v_min_u32 v145, 1, v0
  v_lshlrev_b32 v145, 30, v145
  ds_read_b128 v[24:27], v8 offset:0
  ds_read_b128 v[28:31], v9 offset:0
  ds_read_b128 v[32:35], v10 offset:0
  ds_read_b128 v[36:39], v11 offset:0
  ds_read_b128 v[40:43], v12 offset:0
  ds_read_b128 v[44:47], v13 offset:0
.p2align 6
G_top_137:
  s_waitcnt lgkmcnt(5)
  v_mfma_f32_16x16x32_bf16 v[64:67], a[0:3], v[24:27], 0
  s_add_u32 m0, s25, 0
  ds_read_b128 v[48:51], v14 offset:0
  v_mfma_f32_16x16x32_bf16 v[68:71], a[4:7], v[24:27], 0
  v_mfma_f32_16x16x32_bf16 v[80:83], a[8:11], v[24:27], 0
  buffer_load_dwordx4 v16, s[12:15], s19 offen lds
  v_mfma_f32_16x16x32_bf16 v[84:87], a[12:15], v[24:27], 0
  s_waitcnt lgkmcnt(5)
  v_mfma_f32_16x16x32_bf16 v[72:75], a[0:3], v[28:31], 0
  ds_read_b128 v[52:55], v15 offset:0
  v_mfma_f32_16x16x32_bf16 v[76:79], a[4:7], v[28:31], 0
  v_mul_f32 v96, s24, v96
  v_mul_f32 v97, s24, v97
  v_mfma_f32_16x16x32_bf16 v[88:91], a[8:11], v[28:31], 0
  v_mfma_f32_16x16x32_bf16 v[92:95], a[12:15], v[28:31], 0
  s_waitcnt lgkmcnt(5)
  v_cvt_pk_bf16_f32 v128, v96, v97
  v_mul_f32 v98, s24, v98
  v_mfma_f32_16x16x32_bf16 v[64:67], a[16:19], v[32:35], v[64:67]
  s_add_u32 m0, s25, 1024
  ds_read_b128 v[24:27], v8 offset:8192
  v_mfma_f32_16x16x32_bf16 v[68:71], a[20:23], v[32:35], v[68:71]
  v_mul_f32 v99, s24, v99
  v_cvt_pk_bf16_f32 v129, v98, v99
  v_mfma_f32_16x16x32_bf16 v[80:83], a[24:27], v[32:35], v[80:83]
  buffer_load_dwordx4 v17, s[12:15], s19 offen lds
  v_mfma_f32_16x16x32_bf16 v[84:87], a[28:31], v[32:35], v[84:87]
  s_waitcnt lgkmcnt(5)
  v_mul_f32 v100, s24, v100
  v_mul_f32 v101, s24, v101
  v_mfma_f32_16x16x32_bf16 v[72:75], a[16:19], v[36:39], v[72:75]
  ds_read_b128 v[28:31], v9 offset:8192
  v_mfma_f32_16x16x32_bf16 v[76:79], a[20:23], v[36:39], v[76:79]
  v_cvt_pk_bf16_f32 v130, v100, v101
  v_mul_f32 v102, s24, v102
  v_mfma_f32_16x16x32_bf16 v[88:91], a[24:27], v[36:39], v[88:91]
  v_mfma_f32_16x16x32_bf16 v[92:95], a[28:31], v[36:39], v[92:95]
  s_waitcnt lgkmcnt(5)
  v_mul_f32 v103, s24, v103
  v_cvt_pk_bf16_f32 v131, v102, v103
  v_mfma_f32_16x16x32_bf16 v[64:67], a[32:35], v[40:43], v[64:67]
  s_add_u32 m0, s25, 2048
  ds_read_b128 v[32:35], v10 offset:8192
  v_mfma_f32_16x16x32_bf16 v[68:71], a[36:39], v[40:43], v[68:71]
  v_mul_f32 v104, s24, v104
  v_mul_f32 v105, s24, v105
  v_mfma_f32_16x16x32_bf16 v[80:83], a[40:43], v[40:43], v[80:83]
  buffer_load_dwordx4 v18, s[12:15], s19 offen lds
  v_mfma_f32_16x16x32_bf16 v[84:87], a[44:47], v[40:43], v[84:87]
  s_waitcnt lgkmcnt(5)
  v_cvt_pk_bf16_f32 v132, v104, v105
  v_mul_f32 v106, s24, v106
  v_mfma_f32_16x16x32_bf16 v[72:75], a[32:35], v[44:47], v[72:75]
  ds_read_b128 v[36:39], v11 offset:8192
  v_mfma_f32_16x16x32_bf16 v[76:79], a[36:39], v[44:47], v[76:79]
  v_mul_f32 v107, s24, v107
  v_cvt_pk_bf16_f32 v133, v106, v107
  v_mfma_f32_16x16x32_bf16 v[88:91], a[40:43], v[44:47], v[88:91]
  v_mfma_f32_16x16x32_bf16 v[92:95], a[44:47], v[44:47], v[92:95]
  s_waitcnt lgkmcnt(5)
  v_mul_f32 v108, s24, v108
  v_mul_f32 v109, s24, v109
  v_mfma_f32_16x16x32_bf16 v[64:67], a[48:51], v[48:51], v[64:67]
  s_add_u32 m0, s25, 3072
  ds_read_b128 v[40:43], v12 offset:8192
  v_mfma_f32_16x16x32_bf16 v[68:71], a[52:55], v[48:51], v[68:71]
  v_cvt_pk_bf16_f32 v134, v108, v109
  v_mul_f32 v110, s24, v110
  v_mfma_f32_16x16x32_bf16 v[80:83], a[56:59], v[48:51], v[80:83]
  buffer_load_dwordx4 v19, s[12:15], s19 offen lds
  v_mfma_f32_16x16x32_bf16 v[84:87], a[60:63], v[48:51], v[84:87]
  s_waitcnt lgkmcnt(5)
  v_mul_f32 v111, s24, v111
  v_cvt_pk_bf16_f32 v135, v110, v111
  v_mfma_f32_16x16x32_bf16 v[72:75], a[48:51], v[52:55], v[72:75]
  ds_read_b128 v[44:47], v13 offset:8192
  v_mfma_f32_16x16x32_bf16 v[76:79], a[52:55], v[52:55], v[76:79]
  v_mul_f32 v112, s24, v112
  v_mul_f32 v113, s24, v113
  v_mfma_f32_16x16x32_bf16 v[88:91], a[56:59], v[52:55], v[88:91]
  v_mfma_f32_16x16x32_bf16 v[92:95], a[60:63], v[52:55], v[92:95]
  s_waitcnt lgkmcnt(5)
  v_cvt_pk_bf16_f32 v136, v112, v113
  v_mul_f32 v114, s24, v114
  v_mfma_f32_16x16x32_bf16 v[64:67], a[64:67], v[24:27], v[64:67]
  s_add_u32 m0, s25, 4096
  ds_read_b128 v[48:51], v14 offset:8192
  v_mfma_f32_16x16x32_bf16 v[68:71], a[68:71], v[24:27], v[68:71]
  v_mul_f32 v115, s24, v115
  v_cvt_pk_bf16_f32 v137, v114, v115
  v_mfma_f32_16x16x32_bf16 v[80:83], a[72:75], v[24:27], v[80:83]
  buffer_load_dwordx4 v20, s[12:15], s19 offen lds
  v_mfma_f32_16x16x32_bf16 v[84:87], a[76:79], v[24:27], v[84:87]
  s_waitcnt lgkmcnt(5)
  v_mul_f32 v116, s24, v116
  v_mul_f32 v117, s24, v117
  v_mfma_f32_16x16x32_bf16 v[72:75], a[64:67], v[28:31], v[72:75]
  ds_read_b128 v[52:55], v15 offset:8192
  v_mfma_f32_16x16x32_bf16 v[76:79], a[68:71], v[28:31], v[76:79]
  v_cvt_pk_bf16_f32 v138, v116, v117
  v_mul_f32 v118, s24, v118
  v_mfma_f32_16x16x32_bf16 v[88:91], a[72:75], v[28:31], v[88:91]
  v_mfma_f32_16x16x32_bf16 v[92:95], a[76:79], v[28:31], v[92:95]
  s_waitcnt lgkmcnt(5)
  v_mul_f32 v119, s24, v119
  v_cvt_pk_bf16_f32 v139, v118, v119
  v_mfma_f32_16x16x32_bf16 v[64:67], a[80:83], v[32:35], v[64:67]
  s_add_u32 m0, s25, 5120
  ds_read_b128 v[24:27], v8 offset:16384
  v_mfma_f32_16x16x32_bf16 v[68:71], a[84:87], v[32:35], v[68:71]
  v_mul_f32 v120, s24, v120
  v_mul_f32 v121, s24, v121
  v_mfma_f32_16x16x32_bf16 v[80:83], a[88:91], v[32:35], v[80:83]
  buffer_load_dwordx4 v21, s[12:15], s19 offen lds
  v_mfma_f32_16x16x32_bf16 v[84:87], a[92:95], v[32:35], v[84:87]
  s_waitcnt lgkmcnt(5)
  v_cvt_pk_bf16_f32 v140, v120, v121
  v_mul_f32 v122, s24, v122
  v_mfma_f32_16x16x32_bf16 v[72:75], a[80:83], v[36:39], v[72:75]
  ds_read_b128 v[28:31], v9 offset:16384
  v_mfma_f32_16x16x32_bf16 v[76:79], a[84:87], v[36:39], v[76:79]
  v_mul_f32 v123, s24, v123
  v_cvt_pk_bf16_f32 v141, v122, v123
  v_mfma_f32_16x16x32_bf16 v[88:91], a[88:91], v[36:39], v[88:91]
  v_mfma_f32_16x16x32_bf16 v[92:95], a[92:95], v[36:39], v[92:95]
  s_waitcnt lgkmcnt(5)
  v_mul_f32 v124, s24, v124
  v_mul_f32 v125, s24, v125
  v_mfma_f32_16x16x32_bf16 v[64:67], a[96:99], v[40:43], v[64:67]
  s_add_u32 m0, s25, 6144
  ds_read_b128 v[32:35], v10 offset:16384
  v_mfma_f32_16x16x32_bf16 v[68:71], a[100:103], v[40:43], v[68:71]
  v_cvt_pk_bf16_f32 v142, v124, v125
  v_mul_f32 v126, s24, v126
  v_mfma_f32_16x16x32_bf16 v[80:83], a[104:107], v[40:43], v[80:83]
  buffer_load_dwordx4 v22, s[12:15], s19 offen lds
  v_mfma_f32_16x16x32_bf16 v[84:87], a[108:111], v[40:43], v[84:87]
  s_waitcnt lgkmcnt(5)
  v_mul_f32 v127, s24, v127
  v_cvt_pk_bf16_f32 v143, v126, v127
  v_mfma_f32_16x16x32_bf16 v[72:75], a[96:99], v[44:47], v[72:75]
  ds_read_b128 v[36:39], v11 offset:16384
  v_mfma_f32_16x16x32_bf16 v[76:79], a[100:103], v[44:47], v[76:79]
  v_mfma_f32_16x16x32_bf16 v[88:91], a[104:107], v[44:47], v[88:91]
  v_mfma_f32_16x16x32_bf16 v[92:95], a[108:111], v[44:47], v[92:95]
  s_waitcnt lgkmcnt(5)
  v_mfma_f32_16x16x32_bf16 v[64:67], a[112:115], v[48:51], v[64:67]
  s_add_u32 m0, s25, 7168
  ds_read_b128 v[40:43], v12 offset:16384
  v_mfma_f32_16x16x32_bf16 v[68:71], a[116:119], v[48:51], v[68:71]
  v_mfma_f32_16x16x32_bf16 v[80:83], a[120:123], v[48:51], v[80:83]
  buffer_load_dwordx4 v23, s[12:15], s19 offen lds
  v_mfma_f32_16x16x32_bf16 v[84:87], a[124:127], v[48:51], v[84:87]
  s_waitcnt lgkmcnt(5)
  v_mfma_f32_16x16x32_bf16 v[72:75], a[112:115], v[52:55], v[72:75]
  s_cmp_gt_u32 s23, 3
  ds_read_b128 v[44:47], v13 offset:16384
  v_mfma_f32_16x16x32_bf16 v[76:79], a[116:119], v[52:55], v[76:79]
  v_mfma_f32_16x16x32_bf16 v[88:91], a[120:123], v[52:55], v[88:91]
  s_cselect_b32 s26, s20, 0
  v_mfma_f32_16x16x32_bf16 v[92:95], a[124:127], v[52:55], v[92:95]
  s_waitcnt lgkmcnt(5)
  v_mfma_f32_16x16x32_bf16 v[64:67], a[128:131], v[24:27], v[64:67]
  s_add_u32 s19, s19, s26
  ds_read_b128 v[48:51], v14 offset:16384
  v_mfma_f32_16x16x32_bf16 v[68:71], a[132:135], v[24:27], v[68:71]
  v_mfma_f32_16x16x32_bf16 v[80:83], a[136:139], v[24:27], v[80:83]
  s_add_u32 s25, s25, 32768
  v_mfma_f32_16x16x32_bf16 v[84:87], a[140:143], v[24:27], v[84:87]
  s_waitcnt lgkmcnt(5)
  v_mfma_f32_16x16x32_bf16 v[72:75], a[128:131], v[28:31], v[72:75]
  s_and_b32 s25, s25, 0x1ffff
  ds_read_b128 v[52:55], v15 offset:16384
  v_mfma_f32_16x16x32_bf16 v[76:79], a[132:135], v[28:31], v[76:79]
  v_mfma_f32_16x16x32_bf16 v[88:91], a[136:139], v[28:31], v[88:91]
  buffer_store_dwordx4 v[128:131], v7, s[4:7], s21 offen offset:0 sc1
  v_mfma_f32_16x16x32_bf16 v[92:95], a[140:143], v[28:31], v[92:95]
  s_waitcnt lgkmcnt(5)
  v_mfma_f32_16x16x32_bf16 v[64:67], a[144:147], v[32:35], v[64:67]
  ds_read_b128 v[24:27], v8 offset:24576
  v_mfma_f32_16x16x32_bf16 v[68:71], a[148:151], v[32:35], v[68:71]
  v_mfma_f32_16x16x32_bf16 v[80:83], a[152:155], v[32:35], v[80:83]
  v_mfma_f32_16x16x32_bf16 v[84:87], a[156:159], v[32:35], v[84:87]
  s_waitcnt lgkmcnt(5)
  v_mfma_f32_16x16x32_bf16 v[72:75], a[144:147], v[36:39], v[72:75]
  ds_read_b128 v[28:31], v9 offset:24576
  v_mfma_f32_16x16x32_bf16 v[76:79], a[148:151], v[36:39], v[76:79]
  v_mfma_f32_16x16x32_bf16 v[88:91], a[152:155], v[36:39], v[88:91]
  buffer_store_dwordx4 v[132:135], v7, s[4:7], s21 offen offset:256 sc1
  v_mfma_f32_16x16x32_bf16 v[92:95], a[156:159], v[36:39], v[92:95]
  s_waitcnt lgkmcnt(5)
  v_mfma_f32_16x16x32_bf16 v[64:67], a[160:163], v[40:43], v[64:67]
  ds_read_b128 v[32:35], v10 offset:24576
  v_mfma_f32_16x16x32_bf16 v[68:71], a[164:167], v[40:43], v[68:71]
  v_mfma_f32_16x16x32_bf16 v[80:83], a[168:171], v[40:43], v[80:83]
  v_mfma_f32_16x16x32_bf16 v[84:87], a[172:175], v[40:43], v[84:87]
  s_waitcnt lgkmcnt(5)
  v_mfma_f32_16x16x32_bf16 v[72:75], a[160:163], v[44:47], v[72:75]
  ds_read_b128 v[36:39], v11 offset:24576
  v_mfma_f32_16x16x32_bf16 v[76:79], a[164:167], v[44:47], v[76:79]
  v_mfma_f32_16x16x32_bf16 v[88:91], a[168:171], v[44:47], v[88:91]
  buffer_store_dwordx4 v[136:139], v7, s[4:7], s21 offen offset:2048 sc1
  v_mfma_f32_16x16x32_bf16 v[92:95], a[172:175], v[44:47], v[92:95]
  s_waitcnt lgkmcnt(5)
  v_mfma_f32_16x16x32_bf16 v[64:67], a[176:179], v[48:51], v[64:67]
  ds_read_b128 v[40:43], v12 offset:24576
  v_mfma_f32_16x16x32_bf16 v[68:71], a[180:183], v[48:51], v[68:71]
  v_mfma_f32_16x16x32_bf16 v[80:83], a[184:187], v[48:51], v[80:83]
  v_mfma_f32_16x16x32_bf16 v[84:87], a[188:191], v[48:51], v[84:87]
  s_waitcnt lgkmcnt(5)
  v_mfma_f32_16x16x32_bf16 v[72:75], a[176:179], v[52:55], v[72:75]
  ds_read_b128 v[44:47], v13 offset:24576
  v_mfma_f32_16x16x32_bf16 v[76:79], a[180:183], v[52:55], v[76:79]
  v_mfma_f32_16x16x32_bf16 v[88:91], a[184:187], v[52:55], v[88:91]
  buffer_store_dwordx4 v[140:143], v7, s[4:7], s21 offen offset:2304 sc1
  v_mfma_f32_16x16x32_bf16 v[92:95], a[188:191], v[52:55], v[92:95]
  s_waitcnt lgkmcnt(5)
  v_mfma_f32_16x16x32_bf16 v[64:67], a[192:195], v[24:27], v[64:67]
  s_mov_b32 s21, s27
  ds_read_b128 v[48:51], v14 offset:24576
  v_mfma_f32_16x16x32_bf16 v[68:71], a[196:199], v[24:27], v[68:71]
  v_mov_b32 v7, v56
  v_mfma_f32_16x16x32_bf16 v[80:83], a[200:203], v[24:27], v[80:83]
  v_mfma_f32_16x16x32_bf16 v[84:87], a[204:207], v[24:27], v[84:87]
  s_waitcnt lgkmcnt(5)
  v_mfma_f32_16x16x32_bf16 v[72:75], a[192:195], v[28:31], v[72:75]
  s_add_u32 s27, s27, s22
  ds_read_b128 v[52:55], v15 offset:24576
  v_mfma_f32_16x16x32_bf16 v[76:79], a[196:199], v[28:31], v[76:79]
  v_mfma_f32_16x16x32_bf16 v[88:91], a[200:203], v[28:31], v[88:91]
  s_waitcnt vmcnt(13)
  s_barrier
  v_mfma_f32_16x16x32_bf16 v[92:95], a[204:207], v[28:31], v[92:95]
  s_waitcnt lgkmcnt(5)
  v_mfma_f32_16x16x32_bf16 v[64:67], a[208:211], v[32:35], v[64:67]
  ds_read_b128 v[24:27], v8 offset:32768
  v_mfma_f32_16x16x32_bf16 v[68:71], a[212:215], v[32:35], v[68:71]
  v_mfma_f32_16x16x32_bf16 v[80:83], a[216:219], v[32:35], v[80:83]
  v_mfma_f32_16x16x32_bf16 v[84:87], a[220:223], v[32:35], v[84:87]
  s_waitcnt lgkmcnt(5)
  v_mfma_f32_16x16x32_bf16 v[72:75], a[208:211], v[36:39], v[72:75]
  s_add_u32 s29, s29, 1
  ds_read_b128 v[28:31], v9 offset:32768
  v_mfma_f32_16x16x32_bf16 v[76:79], a[212:215], v[36:39], v[76:79]
  v_mfma_f32_16x16x32_bf16 v[88:91], a[216:219], v[36:39], v[88:91]
  s_max_i32 s30, s29, 0
  v_mfma_f32_16x16x32_bf16 v[92:95], a[220:223], v[36:39], v[92:95]
  s_waitcnt lgkmcnt(5)
  v_mov_b32 v144, s30
  v_mfma_f32_16x16x32_bf16 v[64:67], a[224:227], v[40:43], v[64:67]
  ds_read_b128 v[32:35], v10 offset:32768
  v_mfma_f32_16x16x32_bf16 v[68:71], a[228:231], v[40:43], v[68:71]
  v_mfma_f32_16x16x32_bf16 v[80:83], a[232:235], v[40:43], v[80:83]
  buffer_store_dword v144, v145, s[4:7], s31 offen sc1
  v_mfma_f32_16x16x32_bf16 v[84:87], a[236:239], v[40:43], v[84:87]
  s_waitcnt lgkmcnt(5)
  v_mfma_f32_16x16x32_bf16 v[72:75], a[224:227], v[44:47], v[72:75]
  ds_read_b128 v[36:39], v11 offset:32768
  v_mfma_f32_16x16x32_bf16 v[76:79], a[228:231], v[44:47], v[76:79]
  v_mfma_f32_16x16x32_bf16 v[88:91], a[232:235], v[44:47], v[88:91]
  v_mfma_f32_16x16x32_bf16 v[92:95], a[236:239], v[44:47], v[92:95]
  s_waitcnt lgkmcnt(5)
  v_mfma_f32_16x16x32_bf16 v[64:67], a[240:243], v[48:51], v[64:67]
  s_sub_u32 s23, s23, 1
  ds_read_b128 v[40:43], v12 offset:32768
  v_mfma_f32_16x16x32_bf16 v[68:71], a[244:247], v[48:51], v[68:71]
  v_mfma_f32_16x16x32_bf16 v[80:83], a[248:251], v[48:51], v[80:83]
  v_mfma_f32_16x16x32_bf16 v[84:87], a[252:255], v[48:51], v[84:87]
  s_waitcnt lgkmcnt(5)
  v_mfma_f32_16x16x32_bf16 v[72:75], a[240:243], v[52:55], v[72:75]
  s_cmp_eq_u32 s23, 0
  ds_read_b128 v[44:47], v13 offset:32768
  v_mfma_f32_16x16x32_bf16 v[76:79], a[244:247], v[52:55], v[76:79]
  v_mfma_f32_16x16x32_bf16 v[88:91], a[248:251], v[52:55], v[88:91]
  v_mfma_f32_16x16x32_bf16 v[92:95], a[252:255], v[52:55], v[92:95]
  s_cbranch_scc1 G_done0_138
  s_waitcnt lgkmcnt(5)
  v_mfma_f32_16x16x32_bf16 v[96:99], a[0:3], v[24:27], 0
  s_add_u32 m0, s25, 0
  ds_read_b128 v[48:51], v14 offset:32768
  v_mfma_f32_16x16x32_bf16 v[100:103], a[4:7], v[24:27], 0
  v_mfma_f32_16x16x32_bf16 v[112:115], a[8:11], v[24:27], 0
  buffer_load_dwordx4 v16, s[12:15], s19 offen lds
  v_mfma_f32_16x16x32_bf16 v[116:119], a[12:15], v[24:27], 0
  s_waitcnt lgkmcnt(5)
  v_mfma_f32_16x16x32_bf16 v[104:107], a[0:3], v[28:31], 0
  ds_read_b128 v[52:55], v15 offset:32768
  v_mfma_f32_16x16x32_bf16 v[108:111], a[4:7], v[28:31], 0
  v_mul_f32 v64, s24, v64
  v_mul_f32 v65, s24, v65
  v_mfma_f32_16x16x32_bf16 v[120:123], a[8:11], v[28:31], 0
  v_mfma_f32_16x16x32_bf16 v[124:127], a[12:15], v[28:31], 0
  s_waitcnt lgkmcnt(5)
  v_cvt_pk_bf16_f32 v128, v64, v65
  v_mul_f32 v66, s24, v66
  v_mfma_f32_16x16x32_bf16 v[96:99], a[16:19], v[32:35], v[96:99]
  s_add_u32 m0, s25, 1024
  ds_read_b128 v[24:27], v8 offset:40960
  v_mfma_f32_16x16x32_bf16 v[100:103], a[20:23], v[32:35], v[100:103]
  v_mul_f32 v67, s24, v67
  v_cvt_pk_bf16_f32 v129, v66, v67
  v_mfma_f32_16x16x32_bf16 v[112:115], a[24:27], v[32:35], v[112:115]
  buffer_load_dwordx4 v17, s[12:15], s19 offen lds
  v_mfma_f32_16x16x32_bf16 v[116:119], a[28:31], v[32:35], v[116:119]
  s_waitcnt lgkmcnt(5)
  v_mul_f32 v68, s24, v68
  v_mul_f32 v69, s24, v69
  v_mfma_f32_16x16x32_bf16 v[104:107], a[16:19], v[36:39], v[104:107]
  ds_read_b128 v[28:31], v9 offset:40960
  v_mfma_f32_16x16x32_bf16 v[108:111], a[20:23], v[36:39], v[108:111]
  v_cvt_pk_bf16_f32 v130, v68, v69
  v_mul_f32 v70, s24, v70
  v_mfma_f32_16x16x32_bf16 v[120:123], a[24:27], v[36:39], v[120:123]
  v_mfma_f32_16x16x32_bf16 v[124:127], a[28:31], v[36:39], v[124:127]
  s_waitcnt lgkmcnt(5)
  v_mul_f32 v71, s24, v71
  v_cvt_pk_bf16_f32 v131, v70, v71
  v_mfma_f32_16x16x32_bf16 v[96:99], a[32:35], v[40:43], v[96:99]
  s_add_u32 m0, s25, 2048
  ds_read_b128 v[32:35], v10 offset:40960
  v_mfma_f32_16x16x32_bf16 v[100:103], a[36:39], v[40:43], v[100:103]
  v_mul_f32 v72, s24, v72
  v_mul_f32 v73, s24, v73
  v_mfma_f32_16x16x32_bf16 v[112:115], a[40:43], v[40:43], v[112:115]
  buffer_load_dwordx4 v18, s[12:15], s19 offen lds
  v_mfma_f32_16x16x32_bf16 v[116:119], a[44:47], v[40:43], v[116:119]
  s_waitcnt lgkmcnt(5)
  v_cvt_pk_bf16_f32 v132, v72, v73
  v_mul_f32 v74, s24, v74
  v_mfma_f32_16x16x32_bf16 v[104:107], a[32:35], v[44:47], v[104:107]
  ds_read_b128 v[36:39], v11 offset:40960
  v_mfma_f32_16x16x32_bf16 v[108:111], a[36:39], v[44:47], v[108:111]
  v_mul_f32 v75, s24, v75
  v_cvt_pk_bf16_f32 v133, v74, v75
  v_mfma_f32_16x16x32_bf16 v[120:123], a[40:43], v[44:47], v[120:123]
  v_mfma_f32_16x16x32_bf16 v[124:127], a[44:47], v[44:47], v[124:127]
  s_waitcnt lgkmcnt(5)
  v_mul_f32 v76, s24, v76
  v_mul_f32 v77, s24, v77
  v_mfma_f32_16x16x32_bf16 v[96:99], a[48:51], v[48:51], v[96:99]
  s_add_u32 m0, s25, 3072
  ds_read_b128 v[40:43], v12 offset:40960
  v_mfma_f32_16x16x32_bf16 v[100:103], a[52:55], v[48:51], v[100:103]
  v_cvt_pk_bf16_f32 v134, v76, v77
  v_mul_f32 v78, s24, v78
  v_mfma_f32_16x16x32_bf16 v[112:115], a[56:59], v[48:51], v[112:115]
  buffer_load_dwordx4 v19, s[12:15], s19 offen lds
  v_mfma_f32_16x16x32_bf16 v[116:119], a[60:63], v[48:51], v[116:119]
  s_waitcnt lgkmcnt(5)
  v_mul_f32 v79, s24, v79
  v_cvt_pk_bf16_f32 v135, v78, v79
  v_mfma_f32_16x16x32_bf16 v[104:107], a[48:51], v[52:55], v[104:107]
  ds_read_b128 v[44:47], v13 offset:40960
  v_mfma_f32_16x16x32_bf16 v[108:111], a[52:55], v[52:55], v[108:111]
  v_mul_f32 v80, s24, v80
  v_mul_f32 v81, s24, v81
  v_mfma_f32_16x16x32_bf16 v[120:123], a[56:59], v[52:55], v[120:123]
  v_mfma_f32_16x16x32_bf16 v[124:127], a[60:63], v[52:55], v[124:127]
  s_waitcnt lgkmcnt(5)
  v_cvt_pk_bf16_f32 v136, v80, v81
  v_mul_f32 v82, s24, v82
  v_mfma_f32_16x16x32_bf16 v[96:99], a[64:67], v[24:27], v[96:99]
  s_add_u32 m0, s25, 4096
  ds_read_b128 v[48:51], v14 offset:40960
  v_mfma_f32_16x16x32_bf16 v[100:103], a[68:71], v[24:27], v[100:103]
  v_mul_f32 v83, s24, v83
  v_cvt_pk_bf16_f32 v137, v82, v83
  v_mfma_f32_16x16x32_bf16 v[112:115], a[72:75], v[24:27], v[112:115]
  buffer_load_dwordx4 v20, s[12:15], s19 offen lds
  v_mfma_f32_16x16x32_bf16 v[116:119], a[76:79], v[24:27], v[116:119]
  s_waitcnt lgkmcnt(5)
  v_mul_f32 v84, s24, v84
  v_mul_f32 v85, s24, v85
  v_mfma_f32_16x16x32_bf16 v[104:107], a[64:67], v[28:31], v[104:107]
  ds_read_b128 v[52:55], v15 offset:40960
  v_mfma_f32_16x16x32_bf16 v[108:111], a[68:71], v[28:31], v[108:111]
  v_cvt_pk_bf16_f32 v138, v84, v85
  v_mul_f32 v86, s24, v86
  v_mfma_f32_16x16x32_bf16 v[120:123], a[72:75], v[28:31], v[120:123]
  v_mfma_f32_16x16x32_bf16 v[124:127], a[76:79], v[28:31], v[124:127]
  s_waitcnt lgkmcnt(5)
  v_mul_f32 v87, s24, v87
  v_cvt_pk_bf16_f32 v139, v86, v87
  v_mfma_f32_16x16x32_bf16 v[96:99], a[80:83], v[32:35], v[96:99]
  s_add_u32 m0, s25, 5120
  ds_read_b128 v[24:27], v8 offset:49152
  v_mfma_f32_16x16x32_bf16 v[100:103], a[84:87], v[32:35], v[100:103]
  v_mul_f32 v88, s24, v88
  v_mul_f32 v89, s24, v89
  v_mfma_f32_16x16x32_bf16 v[112:115], a[88:91], v[32:35], v[112:115]
  buffer_load_dwordx4 v21, s[12:15], s19 offen lds
  v_mfma_f32_16x16x32_bf16 v[116:119], a[92:95], v[32:35], v[116:119]
  s_waitcnt lgkmcnt(5)
  v_cvt_pk_bf16_f32 v140, v88, v89
  v_mul_f32 v90, s24, v90
  v_mfma_f32_16x16x32_bf16 v[104:107], a[80:83], v[36:39], v[104:107]
  ds_read_b128 v[28:31], v9 offset:49152
  v_mfma_f32_16x16x32_bf16 v[108:111], a[84:87], v[36:39], v[108:111]
  v_mul_f32 v91, s24, v91
  v_cvt_pk_bf16_f32 v141, v90, v91
  v_mfma_f32_16x16x32_bf16 v[120:123], a[88:91], v[36:39], v[120:123]
  v_mfma_f32_16x16x32_bf16 v[124:127], a[92:95], v[36:39], v[124:127]
  s_waitcnt lgkmcnt(5)
  v_mul_f32 v92, s24, v92
  v_mul_f32 v93, s24, v93
  v_mfma_f32_16x16x32_bf16 v[96:99], a[96:99], v[40:43], v[96:99]
  s_add_u32 m0, s25, 6144
  ds_read_b128 v[32:35], v10 offset:49152
  v_mfma_f32_16x16x32_bf16 v[100:103], a[100:103], v[40:43], v[100:103]
  v_cvt_pk_bf16_f32 v142, v92, v93
  v_mul_f32 v94, s24, v94
  v_mfma_f32_16x16x32_bf16 v[112:115], a[104:107], v[40:43], v[112:115]
  buffer_load_dwordx4 v22, s[12:15], s19 offen lds
  v_mfma_f32_16x16x32_bf16 v[116:119], a[108:111], v[40:43], v[116:119]
  s_waitcnt lgkmcnt(5)
  v_mul_f32 v95, s24, v95
  v_cvt_pk_bf16_f32 v143, v94, v95
  v_mfma_f32_16x16x32_bf16 v[104:107], a[96:99], v[44:47], v[104:107]
  ds_read_b128 v[36:39], v11 offset:49152
  v_mfma_f32_16x16x32_bf16 v[108:111], a[100:103], v[44:47], v[108:111]
  v_mfma_f32_16x16x32_bf16 v[120:123], a[104:107], v[44:47], v[120:123]
  v_mfma_f32_16x16x32_bf16 v[124:127], a[108:111], v[44:47], v[124:127]
  s_waitcnt lgkmcnt(5)
  v_mfma_f32_16x16x32_bf16 v[96:99], a[112:115], v[48:51], v[96:99]
  s_add_u32 m0, s25, 7168
  ds_read_b128 v[40:43], v12 offset:49152
  v_mfma_f32_16x16x32_bf16 v[100:103], a[116:119], v[48:51], v[100:103]
  v_mfma_f32_16x16x32_bf16 v[112:115], a[120:123], v[48:51], v[112:115]
  buffer_load_dwordx4 v23, s[12:15], s19 offen lds
  v_mfma_f32_16x16x32_bf16 v[116:119], a[124:127], v[48:51], v[116:119]
  s_waitcnt lgkmcnt(5)
  v_mfma_f32_16x16x32_bf16 v[104:107], a[112:115], v[52:55], v[104:107]
  s_cmp_gt_u32 s23, 3
  ds_read_b128 v[44:47], v13 offset:49152
  v_mfma_f32_16x16x32_bf16 v[108:111], a[116:119], v[52:55], v[108:111]
  v_mfma_f32_16x16x32_bf16 v[120:123], a[120:123], v[52:55], v[120:123]
  s_cselect_b32 s26, s20, 0
  v_mfma_f32_16x16x32_bf16 v[124:127], a[124:127], v[52:55], v[124:127]
  s_waitcnt lgkmcnt(5)
  v_mfma_f32_16x16x32_bf16 v[96:99], a[128:131], v[24:27], v[96:99]
  s_add_u32 s19, s19, s26
  ds_read_b128 v[48:51], v14 offset:49152
  v_mfma_f32_16x16x32_bf16 v[100:103], a[132:135], v[24:27], v[100:103]
  v_mfma_f32_16x16x32_bf16 v[112:115], a[136:139], v[24:27], v[112:115]
  s_add_u32 s25, s25, 32768
  v_mfma_f32_16x16x32_bf16 v[116:119], a[140:143], v[24:27], v[116:119]
  s_waitcnt lgkmcnt(5)
  v_mfma_f32_16x16x32_bf16 v[104:107], a[128:131], v[28:31], v[104:107]
  s_and_b32 s25, s25, 0x1ffff
  ds_read_b128 v[52:55], v15 offset:49152
  v_mfma_f32_16x16x32_bf16 v[108:111], a[132:135], v[28:31], v[108:111]
  v_mfma_f32_16x16x32_bf16 v[120:123], a[136:139], v[28:31], v[120:123]
  buffer_store_dwordx4 v[128:131], v7, s[4:7], s21 offen offset:0 sc1
  v_mfma_f32_16x16x32_bf16 v[124:127], a[140:143], v[28:31], v[124:127]
  s_waitcnt lgkmcnt(5)
  v_mfma_f32_16x16x32_bf16 v[96:99], a[144:147], v[32:35], v[96:99]
  ds_read_b128 v[24:27], v8 offset:57344
  v_mfma_f32_16x16x32_bf16 v[100:103], a[148:151], v[32:35], v[100:103]
  v_mfma_f32_16x16x32_bf16 v[112:115], a[152:155], v[32:35], v[112:115]
  v_mfma_f32_16x16x32_bf16 v[116:119], a[156:159], v[32:35], v[116:119]
  s_waitcnt lgkmcnt(5)
  v_xor_b32 v8, 0x10000, v8
  v_mfma_f32_16x16x32_bf16 v[104:107], a[144:147], v[36:39], v[104:107]
  ds_read_b128 v[28:31], v9 offset:57344
  v_mfma_f32_16x16x32_bf16 v[108:111], a[148:151], v[36:39], v[108:111]
  v_mfma_f32_16x16x32_bf16 v[120:123], a[152:155], v[36:39], v[120:123]
  buffer_store_dwordx4 v[132:135], v7, s[4:7], s21 offen offset:256 sc1
  v_mfma_f32_16x16x32_bf16 v[124:127], a[156:159], v[36:39], v[124:127]
  s_waitcnt lgkmcnt(5)
  v_xor_b32 v9, 0x10000, v9
  v_mfma_f32_16x16x32_bf16 v[96:99], a[160:163], v[40:43], v[96:99]
  ds_read_b128 v[32:35], v10 offset:57344
  v_mfma_f32_16x16x32_bf16 v[100:103], a[164:167], v[40:43], v[100:103]
  v_mfma_f32_16x16x32_bf16 v[112:115], a[168:171], v[40:43], v[112:115]
  v_mfma_f32_16x16x32_bf16 v[116:119], a[172:175], v[40:43], v[116:119]
  s_waitcnt lgkmcnt(5)
  v_xor_b32 v10, 0x10000, v10
  v_mfma_f32_16x16x32_bf16 v[104:107], a[160:163], v[44:47], v[104:107]
  ds_read_b128 v[36:39], v11 offset:57344
  v_mfma_f32_16x16x32_bf16 v[108:111], a[164:167], v[44:47], v[108:111]
  v_mfma_f32_16x16x32_bf16 v[120:123], a[168:171], v[44:47], v[120:123]
  buffer_store_dwordx4 v[136:139], v7, s[4:7], s21 offen offset:2048 sc1
  v_mfma_f32_16x16x32_bf16 v[124:127], a[172:175], v[44:47], v[124:127]
  s_waitcnt lgkmcnt(5)
  v_xor_b32 v11, 0x10000, v11
  v_mfma_f32_16x16x32_bf16 v[96:99], a[176:179], v[48:51], v[96:99]
  ds_read_b128 v[40:43], v12 offset:57344
  v_mfma_f32_16x16x32_bf16 v[100:103], a[180:183], v[48:51], v[100:103]
  v_mfma_f32_16x16x32_bf16 v[112:115], a[184:187], v[48:51], v[112:115]
  v_mfma_f32_16x16x32_bf16 v[116:119], a[188:191], v[48:51], v[116:119]
  s_waitcnt lgkmcnt(5)
  v_xor_b32 v12, 0x10000, v12
  v_mfma_f32_16x16x32_bf16 v[104:107], a[176:179], v[52:55], v[104:107]
  ds_read_b128 v[44:47], v13 offset:57344
  v_mfma_f32_16x16x32_bf16 v[108:111], a[180:183], v[52:55], v[108:111]
  v_mfma_f32_16x16x32_bf16 v[120:123], a[184:187], v[52:55], v[120:123]
  buffer_store_dwordx4 v[140:143], v7, s[4:7], s21 offen offset:2304 sc1
  v_mfma_f32_16x16x32_bf16 v[124:127], a[188:191], v[52:55], v[124:127]
  s_waitcnt lgkmcnt(5)
  v_xor_b32 v13, 0x10000, v13
  v_mfma_f32_16x16x32_bf16 v[96:99], a[192:195], v[24:27], v[96:99]
  s_mov_b32 s21, s27
  ds_read_b128 v[48:51], v14 offset:57344
  v_mfma_f32_16x16x32_bf16 v[100:103], a[196:199], v[24:27], v[100:103]
  v_mov_b32 v7, v56
  v_mfma_f32_16x16x32_bf16 v[112:115], a[200:203], v[24:27], v[112:115]
  v_mfma_f32_16x16x32_bf16 v[116:119], a[204:207], v[24:27], v[116:119]
  s_waitcnt lgkmcnt(5)
  v_xor_b32 v14, 0x10000, v14
  v_mfma_f32_16x16x32_bf16 v[104:107], a[192:195], v[28:31], v[104:107]
  s_add_u32 s27, s27, s22
  ds_read_b128 v[52:55], v15 offset:57344
  v_mfma_f32_16x16x32_bf16 v[108:111], a[196:199], v[28:31], v[108:111]
  v_mfma_f32_16x16x32_bf16 v[120:123], a[200:203], v[28:31], v[120:123]
  s_waitcnt vmcnt(13)
  s_barrier
  v_mfma_f32_16x16x32_bf16 v[124:127], a[204:207], v[28:31], v[124:127]
  s_waitcnt lgkmcnt(5)
  v_xor_b32 v15, 0x10000, v15
  v_mfma_f32_16x16x32_bf16 v[96:99], a[208:211], v[32:35], v[96:99]
  ds_read_b128 v[24:27], v8 offset:0
  v_mfma_f32_16x16x32_bf16 v[100:103], a[212:215], v[32:35], v[100:103]
  v_mfma_f32_16x16x32_bf16 v[112:115], a[216:219], v[32:35], v[112:115]
  v_mfma_f32_16x16x32_bf16 v[116:119], a[220:223], v[32:35], v[116:119]
  s_waitcnt lgkmcnt(5)
  v_mfma_f32_16x16x32_bf16 v[104:107], a[208:211], v[36:39], v[104:107]
  s_add_u32 s29, s29, 1
  ds_read_b128 v[28:31], v9 offset:0
  v_mfma_f32_16x16x32_bf16 v[108:111], a[212:215], v[36:39], v[108:111]
  v_mfma_f32_16x16x32_bf16 v[120:123], a[216:219], v[36:39], v[120:123]
  s_max_i32 s30, s29, 0
  v_mfma_f32_16x16x32_bf16 v[124:127], a[220:223], v[36:39], v[124:127]
  s_waitcnt lgkmcnt(5)
  v_mov_b32 v144, s30
  v_mfma_f32_16x16x32_bf16 v[96:99], a[224:227], v[40:43], v[96:99]
  ds_read_b128 v[32:35], v10 offset:0
  v_mfma_f32_16x16x32_bf16 v[100:103], a[228:231], v[40:43], v[100:103]
  v_mfma_f32_16x16x32_bf16 v[112:115], a[232:235], v[40:43], v[112:115]
  buffer_store_dword v144, v145, s[4:7], s31 offen sc1
  v_mfma_f32_16x16x32_bf16 v[116:119], a[236:239], v[40:43], v[116:119]
  s_waitcnt lgkmcnt(5)
  v_mfma_f32_16x16x32_bf16 v[104:107], a[224:227], v[44:47], v[104:107]
  ds_read_b128 v[36:39], v11 offset:0
  v_mfma_f32_16x16x32_bf16 v[108:111], a[228:231], v[44:47], v[108:111]
  v_mfma_f32_16x16x32_bf16 v[120:123], a[232:235], v[44:47], v[120:123]
  v_mfma_f32_16x16x32_bf16 v[124:127], a[236:239], v[44:47], v[124:127]
  s_waitcnt lgkmcnt(5)
  v_mfma_f32_16x16x32_bf16 v[96:99], a[240:243], v[48:51], v[96:99]
  s_sub_u32 s23, s23, 1
  ds_read_b128 v[40:43], v12 offset:0
  v_mfma_f32_16x16x32_bf16 v[100:103], a[244:247], v[48:51], v[100:103]
  v_mfma_f32_16x16x32_bf16 v[112:115], a[248:251], v[48:51], v[112:115]
  v_mfma_f32_16x16x32_bf16 v[116:119], a[252:255], v[48:51], v[116:119]
  s_waitcnt lgkmcnt(5)
  v_mfma_f32_16x16x32_bf16 v[104:107], a[240:243], v[52:55], v[104:107]
  s_cmp_eq_u32 s23, 0
  ds_read_b128 v[44:47], v13 offset:0
  v_mfma_f32_16x16x32_bf16 v[108:111], a[244:247], v[52:55], v[108:111]
  v_mfma_f32_16x16x32_bf16 v[120:123], a[248:251], v[52:55], v[120:123]
  v_mfma_f32_16x16x32_bf16 v[124:127], a[252:255], v[52:55], v[124:127]
  s_cbranch_scc1 G_done1_139
  s_branch G_top_137
G_done0_138:
  s_nop 7
  s_nop 3
  v_mul_f32 v64, s24, v64
  v_mul_f32 v65, s24, v65
  v_cvt_pk_bf16_f32 v128, v64, v65
  v_mul_f32 v66, s24, v66
  v_mul_f32 v67, s24, v67
  v_cvt_pk_bf16_f32 v129, v66, v67
  v_mul_f32 v68, s24, v68
  v_mul_f32 v69, s24, v69
  v_cvt_pk_bf16_f32 v130, v68, v69
  v_mul_f32 v70, s24, v70
  v_mul_f32 v71, s24, v71
  v_cvt_pk_bf16_f32 v131, v70, v71
  buffer_store_dwordx4 v[128:131], v7, s[4:7], s21 offen offset:0 sc1
  v_mul_f32 v72, s24, v72
  v_mul_f32 v73, s24, v73
  v_cvt_pk_bf16_f32 v132, v72, v73
  v_mul_f32 v74, s24, v74
  v_mul_f32 v75, s24, v75
  v_cvt_pk_bf16_f32 v133, v74, v75
  v_mul_f32 v76, s24, v76
  v_mul_f32 v77, s24, v77
  v_cvt_pk_bf16_f32 v134, v76, v77
  v_mul_f32 v78, s24, v78
  v_mul_f32 v79, s24, v79
  v_cvt_pk_bf16_f32 v135, v78, v79
  buffer_store_dwordx4 v[132:135], v7, s[4:7], s21 offen offset:256 sc1
  v_mul_f32 v80, s24, v80
  v_mul_f32 v81, s24, v81
  v_cvt_pk_bf16_f32 v136, v80, v81
  v_mul_f32 v82, s24, v82
  v_mul_f32 v83, s24, v83
  v_cvt_pk_bf16_f32 v137, v82, v83
  v_mul_f32 v84, s24, v84
  v_mul_f32 v85, s24, v85
  v_cvt_pk_bf16_f32 v138, v84, v85
  v_mul_f32 v86, s24, v86
  v_mul_f32 v87, s24, v87
  v_cvt_pk_bf16_f32 v139, v86, v87
  buffer_store_dwordx4 v[136:139], v7, s[4:7], s21 offen offset:2048 sc1
  v_mul_f32 v88, s24, v88
  v_mul_f32 v89, s24, v89
  v_cvt_pk_bf16_f32 v140, v88, v89
  v_mul_f32 v90, s24, v90
  v_mul_f32 v91, s24, v91
  v_cvt_pk_bf16_f32 v141, v90, v91
  v_mul_f32 v92, s24, v92
  v_mul_f32 v93, s24, v93
  v_cvt_pk_bf16_f32 v142, v92, v93
  v_mul_f32 v94, s24, v94
  v_mul_f32 v95, s24, v95
  v_cvt_pk_bf16_f32 v143, v94, v95
  buffer_store_dwordx4 v[140:143], v7, s[4:7], s21 offen offset:2304 sc1
  s_branch G_fin_140
G_done1_139:
  s_nop 7
  s_nop 3
  v_mul_f32 v96, s24, v96
  v_mul_f32 v97, s24, v97
  v_cvt_pk_bf16_f32 v128, v96, v97
  v_mul_f32 v98, s24, v98
  v_mul_f32 v99, s24, v99
  v_cvt_pk_bf16_f32 v129, v98, v99
  v_mul_f32 v100, s24, v100
  v_mul_f32 v101, s24, v101
  v_cvt_pk_bf16_f32 v130, v100, v101
  v_mul_f32 v102, s24, v102
  v_mul_f32 v103, s24, v103
  v_cvt_pk_bf16_f32 v131, v102, v103
  buffer_store_dwordx4 v[128:131], v7, s[4:7], s21 offen offset:0 sc1
  v_mul_f32 v104, s24, v104
  v_mul_f32 v105, s24, v105
  v_cvt_pk_bf16_f32 v132, v104, v105
  v_mul_f32 v106, s24, v106
  v_mul_f32 v107, s24, v107
  v_cvt_pk_bf16_f32 v133, v106, v107
  v_mul_f32 v108, s24, v108
  v_mul_f32 v109, s24, v109
  v_cvt_pk_bf16_f32 v134, v108, v109
  v_mul_f32 v110, s24, v110
  v_mul_f32 v111, s24, v111
  v_cvt_pk_bf16_f32 v135, v110, v111
  buffer_store_dwordx4 v[132:135], v7, s[4:7], s21 offen offset:256 sc1
  v_mul_f32 v112, s24, v112
  v_mul_f32 v113, s24, v113
  v_cvt_pk_bf16_f32 v136, v112, v113
  v_mul_f32 v114, s24, v114
  v_mul_f32 v115, s24, v115
  v_cvt_pk_bf16_f32 v137, v114, v115
  v_mul_f32 v116, s24, v116
  v_mul_f32 v117, s24, v117
  v_cvt_pk_bf16_f32 v138, v116, v117
  v_mul_f32 v118, s24, v118
  v_mul_f32 v119, s24, v119
  v_cvt_pk_bf16_f32 v139, v118, v119
  buffer_store_dwordx4 v[136:139], v7, s[4:7], s21 offen offset:2048 sc1
  v_mul_f32 v120, s24, v120
  v_mul_f32 v121, s24, v121
  v_cvt_pk_bf16_f32 v140, v120, v121
  v_mul_f32 v122, s24, v122
  v_mul_f32 v123, s24, v123
  v_cvt_pk_bf16_f32 v141, v122, v123
  v_mul_f32 v124, s24, v124
  v_mul_f32 v125, s24, v125
  v_cvt_pk_bf16_f32 v142, v124, v125
  v_mul_f32 v126, s24, v126
  v_mul_f32 v127, s24, v127
  v_cvt_pk_bf16_f32 v143, v126, v127
  buffer_store_dwordx4 v[140:143], v7, s[4:7], s21 offen offset:2304 sc1
G_fin_140:
  s_waitcnt vmcnt(0) lgkmcnt(0)
  s_barrier
  s_add_u32 s30, s29, 2
  v_mov_b32 v144, s30
  v_min_u32 v145, 1, v0
  v_lshlrev_b32 v145, 30, v145
  buffer_store_dword v144, v145, s[4:7], s31 offen sc1
  s_branch P_end_131
P_v_130:
  s_mov_b32 s27, s21
  v_mov_b32 v7, 0x40000000
  s_mov_b32 s29, -2
  v_min_u32 v145, 1, v0
  v_lshlrev_b32 v145, 30, v145
  ds_read_b128 v[24:27], v8 offset:0
  ds_read_b128 v[28:31], v9 offset:0
  ds_read_b128 v[32:35], v10 offset:0
  ds_read_b128 v[36:39], v11 offset:0
  ds_read_b128 v[40:43], v12 offset:0
  ds_read_b128 v[44:47], v13 offset:0
.p2align 6
G_top_141:
  s_waitcnt lgkmcnt(5)
  v_mfma_f32_16x16x32_bf16 v[64:67], v[24:27], a[0:3], 0
  s_add_u32 m0, s25, 0
  ds_read_b128 v[48:51], v14 offset:0
  v_mfma_f32_16x16x32_bf16 v[72:75], v[24:27], a[4:7], 0
  v_mfma_f32_16x16x32_bf16 v[80:83], v[24:27], a[8:11], 0
  buffer_load_dwordx4 v16, s[12:15], s19 offen lds
  v_mfma_f32_16x16x32_bf16 v[88:91], v[24:27], a[12:15], 0
  s_waitcnt lgkmcnt(5)
  v_mfma_f32_16x16x32_bf16 v[68:71], v[28:31], a[0:3], 0
  ds_read_b128 v[52:55], v15 offset:0
  v_mfma_f32_16x16x32_bf16 v[76:79], v[28:31], a[4:7], 0
  v_cvt_pk_bf16_f32 v128, v96, v97
  v_cvt_pk_bf16_f32 v129, v98, v99
  v_mfma_f32_16x16x32_bf16 v[84:87], v[28:31], a[8:11], 0
  v_mfma_f32_16x16x32_bf16 v[92:95], v[28:31], a[12:15], 0
  s_waitcnt lgkmcnt(5)
  v_cvt_pk_bf16_f32 v130, v100, v101
  v_cvt_pk_bf16_f32 v131, v102, v103
  v_mfma_f32_16x16x32_bf16 v[64:67], v[32:35], a[16:19], v[64:67]
  s_add_u32 m0, s25, 1024
  ds_read_b128 v[24:27], v8 offset:8192
  v_mfma_f32_16x16x32_bf16 v[72:75], v[32:35], a[20:23], v[72:75]
  v_mfma_f32_16x16x32_bf16 v[80:83], v[32:35], a[24:27], v[80:83]
  buffer_load_dwordx4 v17, s[12:15], s19 offen lds
  v_mfma_f32_16x16x32_bf16 v[88:91], v[32:35], a[28:31], v[88:91]
  s_waitcnt lgkmcnt(5)
  v_mfma_f32_16x16x32_bf16 v[68:71], v[36:39], a[16:19], v[68:71]
  ds_read_b128 v[28:31], v9 offset:8192
  v_mfma_f32_16x16x32_bf16 v[76:79], v[36:39], a[20:23], v[76:79]
  v_mfma_f32_16x16x32_bf16 v[84:87], v[36:39], a[24:27], v[84:87]
  v_mfma_f32_16x16x32_bf16 v[92:95], v[36:39], a[28:31], v[92:95]
  s_waitcnt lgkmcnt(5)
  v_mfma_f32_16x16x32_bf16 v[64:67], v[40:43], a[32:35], v[64:67]
  s_add_u32 m0, s25, 2048
  ds_read_b128 v[32:35], v10 offset:8192
  v_mfma_f32_16x16x32_bf16 v[72:75], v[40:43], a[36:39], v[72:75]
  v_cvt_pk_bf16_f32 v132, v104, v105
  v_cvt_pk_bf16_f32 v133, v106, v107
  v_mfma_f32_16x16x32_bf16 v[80:83], v[40:43], a[40:43], v[80:83]
  buffer_load_dwordx4 v18, s[12:15], s19 offen lds
  v_mfma_f32_16x16x32_bf16 v[88:91], v[40:43], a[44:47], v[88:91]
  s_waitcnt lgkmcnt(5)
  v_cvt_pk_bf16_f32 v134, v108, v109
  v_cvt_pk_bf16_f32 v135, v110, v111
  v_mfma_f32_16x16x32_bf16 v[68:71], v[44:47], a[32:35], v[68:71]
  ds_read_b128 v[36:39], v11 offset:8192
  v_mfma_f32_16x16x32_bf16 v[76:79], v[44:47], a[36:39], v[76:79]
  v_mfma_f32_16x16x32_bf16 v[84:87], v[44:47], a[40:43], v[84:87]
  v_mfma_f32_16x16x32_bf16 v[92:95], v[44:47], a[44:47], v[92:95]
  s_waitcnt lgkmcnt(5)
  v_mfma_f32_16x16x32_bf16 v[64:67], v[48:51], a[48:51], v[64:67]
  s_add_u32 m0, s25, 3072
  ds_read_b128 v[40:43], v12 offset:8192
  v_mfma_f32_16x16x32_bf16 v[72:75], v[48:51], a[52:55], v[72:75]
  v_mfma_f32_16x16x32_bf16 v[80:83], v[48:51], a[56:59], v[80:83]
  buffer_load_dwordx4 v19, s[12:15], s19 offen lds
  v_mfma_f32_16x16x32_bf16 v[88:91], v[48:51], a[60:63], v[88:91]
  s_waitcnt lgkmcnt(5)
  v_mfma_f32_16x16x32_bf16 v[68:71], v[52:55], a[48:51], v[68:71]
  ds_read_b128 v[44:47], v13 offset:8192
  v_mfma_f32_16x16x32_bf16 v[76:79], v[52:55], a[52:55], v[76:79]
  v_cvt_pk_bf16_f32 v136, v112, v113
  v_cvt_pk_bf16_f32 v137, v114, v115
  v_mfma_f32_16x16x32_bf16 v[84:87], v[52:55], a[56:59], v[84:87]
  v_mfma_f32_16x16x32_bf16 v[92:95], v[52:55], a[60:63], v[92:95]
  s_waitcnt lgkmcnt(5)
  v_cvt_pk_bf16_f32 v138, v116, v117
  v_cvt_pk_bf16_f32 v139, v118, v119
  v_mfma_f32_16x16x32_bf16 v[64:67], v[24:27], a[64:67], v[64:67]
  s_add_u32 m0, s25, 4096
  ds_read_b128 v[48:51], v14 offset:8192
  v_mfma_f32_16x16x32_bf16 v[72:75], v[24:27], a[68:71], v[72:75]
  v_mfma_f32_16x16x32_bf16 v[80:83], v[24:27], a[72:75], v[80:83]
  buffer_load_dwordx4 v20, s[12:15], s19 offen lds
  v_mfma_f32_16x16x32_bf16 v[88:91], v[24:27], a[76:79], v[88:91]
  s_waitcnt lgkmcnt(5)
  v_mfma_f32_16x16x32_bf16 v[68:71], v[28:31], a[64:67], v[68:71]
  ds_read_b128 v[52:55], v15 offset:8192
  v_mfma_f32_16x16x32_bf16 v[76:79], v[28:31], a[68:71], v[76:79]
  v_mfma_f32_16x16x32_bf16 v[84:87], v[28:31], a[72:75], v[84:87]
  v_mfma_f32_16x16x32_bf16 v[92:95], v[28:31], a[76:79], v[92:95]
  s_waitcnt lgkmcnt(5)
  v_mfma_f32_16x16x32_bf16 v[64:67], v[32:35], a[80:83], v[64:67]
  s_add_u32 m0, s25, 5120
  ds_read_b128 v[24:27], v8 offset:16384
  v_mfma_f32_16x16x32_bf16 v[72:75], v[32:35], a[84:87], v[72:75]
  v_cvt_pk_bf16_f32 v140, v120, v121
  v_cvt_pk_bf16_f32 v141, v122, v123
  v_mfma_f32_16x16x32_bf16 v[80:83], v[32:35], a[88:91], v[80:83]
  buffer_load_dwordx4 v21, s[12:15], s19 offen lds
  v_mfma_f32_16x16x32_bf16 v[88:91], v[32:35], a[92:95], v[88:91]
  s_waitcnt lgkmcnt(5)
  v_cvt_pk_bf16_f32 v142, v124, v125
  v_cvt_pk_bf16_f32 v143, v126, v127
  v_mfma_f32_16x16x32_bf16 v[68:71], v[36:39], a[80:83], v[68:71]
  ds_read_b128 v[28:31], v9 offset:16384
  v_mfma_f32_16x16x32_bf16 v[76:79], v[36:39], a[84:87], v[76:79]
  v_mfma_f32_16x16x32_bf16 v[84:87], v[36:39], a[88:91], v[84:87]
  v_mfma_f32_16x16x32_bf16 v[92:95], v[36:39], a[92:95], v[92:95]
  s_waitcnt lgkmcnt(5)
  v_mfma_f32_16x16x32_bf16 v[64:67], v[40:43], a[96:99], v[64:67]
  s_add_u32 m0, s25, 6144
  ds_read_b128 v[32:35], v10 offset:16384
  v_mfma_f32_16x16x32_bf16 v[72:75], v[40:43], a[100:103], v[72:75]
  v_mfma_f32_16x16x32_bf16 v[80:83], v[40:43], a[104:107], v[80:83]
  buffer_load_dwordx4 v22, s[12:15], s19 offen lds
  v_mfma_f32_16x16x32_bf16 v[88:91], v[40:43], a[108:111], v[88:91]
  s_waitcnt lgkmcnt(5)
  v_mfma_f32_16x16x32_bf16 v[68:71], v[44:47], a[96:99], v[68:71]
  ds_read_b128 v[36:39], v11 offset:16384
  v_mfma_f32_16x16x32_bf16 v[76:79], v[44:47], a[100:103], v[76:79]
  v_mfma_f32_16x16x32_bf16 v[84:87], v[44:47], a[104:107], v[84:87]
  v_mfma_f32_16x16x32_bf16 v[92:95], v[44:47], a[108:111], v[92:95]
  s_waitcnt lgkmcnt(5)
  v_mfma_f32_16x16x32_bf16 v[64:67], v[48:51], a[112:115], v[64:67]
  s_add_u32 m0, s25, 7168
  ds_read_b128 v[40:43], v12 offset:16384
  v_mfma_f32_16x16x32_bf16 v[72:75], v[48:51], a[116:119], v[72:75]
  v_mfma_f32_16x16x32_bf16 v[80:83], v[48:51], a[120:123], v[80:83]
  buffer_load_dwordx4 v23, s[12:15], s19 offen lds
  v_mfma_f32_16x16x32_bf16 v[88:91], v[48:51], a[124:127], v[88:91]
  s_waitcnt lgkmcnt(5)
  v_mfma_f32_16x16x32_bf16 v[68:71], v[52:55], a[112:115], v[68:71]
  s_cmp_gt_u32 s23, 3
  ds_read_b128 v[44:47], v13 offset:16384
  v_mfma_f32_16x16x32_bf16 v[76:79], v[52:55], a[116:119], v[76:79]
  v_mfma_f32_16x16x32_bf16 v[84:87], v[52:55], a[120:123], v[84:87]
  s_cselect_b32 s26, s20, 0
  v_mfma_f32_16x16x32_bf16 v[92:95], v[52:55], a[124:127], v[92:95]
  s_waitcnt lgkmcnt(5)
  v_mfma_f32_16x16x32_bf16 v[64:67], v[24:27], a[128:131], v[64:67]
  s_add_u32 s19, s19, s26
  ds_read_b128 v[48:51], v14 offset:16384
  v_mfma_f32_16x16x32_bf16 v[72:75], v[24:27], a[132:135], v[72:75]
  v_mfma_f32_16x16x32_bf16 v[80:83], v[24:27], a[136:139], v[80:83]
  s_add_u32 s25, s25, 32768
  v_mfma_f32_16x16x32_bf16 v[88:91], v[24:27], a[140:143], v[88:91]
  s_waitcnt lgkmcnt(5)
  v_mfma_f32_16x16x32_bf16 v[68:71], v[28:31], a[128:131], v[68:71]
  s_and_b32 s25, s25, 0x1ffff
  ds_read_b128 v[52:55], v15 offset:16384
  v_mfma_f32_16x16x32_bf16 v[76:79], v[28:31], a[132:135], v[76:79]
  v_mfma_f32_16x16x32_bf16 v[84:87], v[28:31], a[136:139], v[84:87]
  buffer_store_dwordx4 v[128:131], v7, s[4:7], s21 offen offset:0 sc1
  v_mfma_f32_16x16x32_bf16 v[92:95], v[28:31], a[140:143], v[92:95]
  s_waitcnt lgkmcnt(5)
  v_mfma_f32_16x16x32_bf16 v[64:67], v[32:35], a[144:147], v[64:67]
  ds_read_b128 v[24:27], v8 offset:24576
  v_mfma_f32_16x16x32_bf16 v[72:75], v[32:35], a[148:151], v[72:75]
  v_mfma_f32_16x16x32_bf16 v[80:83], v[32:35], a[152:155], v[80:83]
  v_mfma_f32_16x16x32_bf16 v[88:91], v[32:35], a[156:159], v[88:91]
  s_waitcnt lgkmcnt(5)
  v_mfma_f32_16x16x32_bf16 v[68:71], v[36:39], a[144:147], v[68:71]
  ds_read_b128 v[28:31], v9 offset:24576
  v_mfma_f32_16x16x32_bf16 v[76:79], v[36:39], a[148:151], v[76:79]
  v_mfma_f32_16x16x32_bf16 v[84:87], v[36:39], a[152:155], v[84:87]
  buffer_store_dwordx4 v[132:135], v7, s[4:7], s21 offen offset:256 sc1
  v_mfma_f32_16x16x32_bf16 v[92:95], v[36:39], a[156:159], v[92:95]
  s_waitcnt lgkmcnt(5)
  v_mfma_f32_16x16x32_bf16 v[64:67], v[40:43], a[160:163], v[64:67]
  ds_read_b128 v[32:35], v10 offset:24576
  v_mfma_f32_16x16x32_bf16 v[72:75], v[40:43], a[164:167], v[72:75]
  v_mfma_f32_16x16x32_bf16 v[80:83], v[40:43], a[168:171], v[80:83]
  v_mfma_f32_16x16x32_bf16 v[88:91], v[40:43], a[172:175], v[88:91]
  s_waitcnt lgkmcnt(5)
  v_mfma_f32_16x16x32_bf16 v[68:71], v[44:47], a[160:163], v[68:71]
  ds_read_b128 v[36:39], v11 offset:24576
  v_mfma_f32_16x16x32_bf16 v[76:79], v[44:47], a[164:167], v[76:79]
  v_mfma_f32_16x16x32_bf16 v[84:87], v[44:47], a[168:171], v[84:87]
  buffer_store_dwordx4 v[136:139], v7, s[4:7], s21 offen offset:2048 sc1
  v_mfma_f32_16x16x32_bf16 v[92:95], v[44:47], a[172:175], v[92:95]
  s_waitcnt lgkmcnt(5)
  v_mfma_f32_16x16x32_bf16 v[64:67], v[48:51], a[176:179], v[64:67]
  ds_read_b128 v[40:43], v12 offset:24576
  v_mfma_f32_16x16x32_bf16 v[72:75], v[48:51], a[180:183], v[72:75]
  v_mfma_f32_16x16x32_bf16 v[80:83], v[48:51], a[184:187], v[80:83]
  v_mfma_f32_16x16x32_bf16 v[88:91], v[48:51], a[188:191], v[88:91]
  s_waitcnt lgkmcnt(5)
  v_mfma_f32_16x16x32_bf16 v[68:71], v[52:55], a[176:179], v[68:71]
  ds_read_b128 v[44:47], v13 offset:24576
  v_mfma_f32_16x16x32_bf16 v[76:79], v[52:55], a[180:183], v[76:79]
  v_mfma_f32_16x16x32_bf16 v[84:87], v[52:55], a[184:187], v[84:87]
  buffer_store_dwordx4 v[140:143], v7, s[4:7], s21 offen offset:2304 sc1
  v_mfma_f32_16x16x32_bf16 v[92:95], v[52:55], a[188:191], v[92:95]
  s_waitcnt lgkmcnt(5)
  v_mfma_f32_16x16x32_bf16 v[64:67], v[24:27], a[192:195], v[64:67]
  s_mov_b32 s21, s27
  ds_read_b128 v[48:51], v14 offset:24576
  v_mfma_f32_16x16x32_bf16 v[72:75], v[24:27], a[196:199], v[72:75]
  v_mov_b32 v7, v56
  v_mfma_f32_16x16x32_bf16 v[80:83], v[24:27], a[200:203], v[80:83]
  v_mfma_f32_16x16x32_bf16 v[88:91], v[24:27], a[204:207], v[88:91]
  s_waitcnt lgkmcnt(5)
  v_mfma_f32_16x16x32_bf16 v[68:71], v[28:31], a[192:195], v[68:71]
  s_add_u32 s27, s27, s22
  ds_read_b128 v[52:55], v15 offset:24576
  v_mfma_f32_16x16x32_bf16 v[76:79], v[28:31], a[196:199], v[76:79]
  v_mfma_f32_16x16x32_bf16 v[84:87], v[28:31], a[200:203], v[84:87]
  s_waitcnt vmcnt(13)
  s_barrier
  v_mfma_f32_16x16x32_bf16 v[92:95], v[28:31], a[204:207], v[92:95]
  s_waitcnt lgkmcnt(5)
  v_mfma_f32_16x16x32_bf16 v[64:67], v[32:35], a[208:211], v[64:67]
  ds_read_b128 v[24:27], v8 offset:32768
  v_mfma_f32_16x16x32_bf16 v[72:75], v[32:35], a[212:215], v[72:75]
  v_mfma_f32_16x16x32_bf16 v[80:83], v[32:35], a[216:219], v[80:83]
  v_mfma_f32_16x16x32_bf16 v[88:91], v[32:35], a[220:223], v[88:91]
  s_waitcnt lgkmcnt(5)
  v_mfma_f32_16x16x32_bf16 v[68:71], v[36:39], a[208:211], v[68:71]
  s_add_u32 s29, s29, 1
  ds_read_b128 v[28:31], v9 offset:32768
  v_mfma_f32_16x16x32_bf16 v[76:79], v[36:39], a[212:215], v[76:79]
  v_mfma_f32_16x16x32_bf16 v[84:87], v[36:39], a[216:219], v[84:87]
  s_max_i32 s30, s29, 0
  v_mfma_f32_16x16x32_bf16 v[92:95], v[36:39], a[220:223], v[92:95]
  s_waitcnt lgkmcnt(5)
  v_mov_b32 v144, s30
  v_mfma_f32_16x16x32_bf16 v[64:67], v[40:43], a[224:227], v[64:67]
  ds_read_b128 v[32:35], v10 offset:32768
  v_mfma_f32_16x16x32_bf16 v[72:75], v[40:43], a[228:231], v[72:75]
  v_mfma_f32_16x16x32_bf16 v[80:83], v[40:43], a[232:235], v[80:83]
  buffer_store_dword v144, v145, s[4:7], s31 offen sc1
  v_mfma_f32_16x16x32_bf16 v[88:91], v[40:43], a[236:239], v[88:91]
  s_waitcnt lgkmcnt(5)
  v_mfma_f32_16x16x32_bf16 v[68:71], v[44:47], a[224:227], v[68:71]
  ds_read_b128 v[36:39], v11 offset:32768
  v_mfma_f32_16x16x32_bf16 v[76:79], v[44:47], a[228:231], v[76:79]
  v_mfma_f32_16x16x32_bf16 v[84:87], v[44:47], a[232:235], v[84:87]
  v_mfma_f32_16x16x32_bf16 v[92:95], v[44:47], a[236:239], v[92:95]
  s_waitcnt lgkmcnt(5)
  v_mfma_f32_16x16x32_bf16 v[64:67], v[48:51], a[240:243], v[64:67]
  s_sub_u32 s23, s23, 1
  ds_read_b128 v[40:43], v12 offset:32768
  v_mfma_f32_16x16x32_bf16 v[72:75], v[48:51], a[244:247], v[72:75]
  v_mfma_f32_16x16x32_bf16 v[80:83], v[48:51], a[248:251], v[80:83]
  v_mfma_f32_16x16x32_bf16 v[88:91], v[48:51], a[252:255], v[88:91]
  s_waitcnt lgkmcnt(5)
  v_mfma_f32_16x16x32_bf16 v[68:71], v[52:55], a[240:243], v[68:71]
  s_cmp_eq_u32 s23, 0
  ds_read_b128 v[44:47], v13 offset:32768
  v_mfma_f32_16x16x32_bf16 v[76:79], v[52:55], a[244:247], v[76:79]
  v_mfma_f32_16x16x32_bf16 v[84:87], v[52:55], a[248:251], v[84:87]
  v_mfma_f32_16x16x32_bf16 v[92:95], v[52:55], a[252:255], v[92:95]
  s_cbranch_scc1 G_done0_142
  s_waitcnt lgkmcnt(5)
  v_mfma_f32_16x16x32_bf16 v[96:99], v[24:27], a[0:3], 0
  s_add_u32 m0, s25, 0
  ds_read_b128 v[48:51], v14 offset:32768
  v_mfma_f32_16x16x32_bf16 v[104:107], v[24:27], a[4:7], 0
  v_mfma_f32_16x16x32_bf16 v[112:115], v[24:27], a[8:11], 0
  buffer_load_dwordx4 v16, s[12:15], s19 offen lds
  v_mfma_f32_16x16x32_bf16 v[120:123], v[24:27], a[12:15], 0
  s_waitcnt lgkmcnt(5)
  v_mfma_f32_16x16x32_bf16 v[100:103], v[28:31], a[0:3], 0
  ds_read_b128 v[52:55], v15 offset:32768
  v_mfma_f32_16x16x32_bf16 v[108:111], v[28:31], a[4:7], 0
  v_cvt_pk_bf16_f32 v128, v64, v65
  v_cvt_pk_bf16_f32 v129, v66, v67
  v_mfma_f32_16x16x32_bf16 v[116:119], v[28:31], a[8:11], 0
  v_mfma_f32_16x16x32_bf16 v[124:127], v[28:31], a[12:15], 0
  s_waitcnt lgkmcnt(5)
  v_cvt_pk_bf16_f32 v130, v68, v69
  v_cvt_pk_bf16_f32 v131, v70, v71
  v_mfma_f32_16x16x32_bf16 v[96:99], v[32:35], a[16:19], v[96:99]
  s_add_u32 m0, s25, 1024
  ds_read_b128 v[24:27], v8 offset:40960
  v_mfma_f32_16x16x32_bf16 v[104:107], v[32:35], a[20:23], v[104:107]
  v_mfma_f32_16x16x32_bf16 v[112:115], v[32:35], a[24:27], v[112:115]
  buffer_load_dwordx4 v17, s[12:15], s19 offen lds
  v_mfma_f32_16x16x32_bf16 v[120:123], v[32:35], a[28:31], v[120:123]
  s_waitcnt lgkmcnt(5)
  v_mfma_f32_16x16x32_bf16 v[100:103], v[36:39], a[16:19], v[100:103]
  ds_read_b128 v[28:31], v9 offset:40960
  v_mfma_f32_16x16x32_bf16 v[108:111], v[36:39], a[20:23], v[108:111]
  v_mfma_f32_16x16x32_bf16 v[116:119], v[36:39], a[24:27], v[116:119]
  v_mfma_f32_16x16x32_bf16 v[124:127], v[36:39], a[28:31], v[124:127]
  s_waitcnt lgkmcnt(5)
  v_mfma_f32_16x16x32_bf16 v[96:99], v[40:43], a[32:35], v[96:99]
  s_add_u32 m0, s25, 2048
  ds_read_b128 v[32:35], v10 offset:40960
  v_mfma_f32_16x16x32_bf16 v[104:107], v[40:43], a[36:39], v[104:107]
  v_cvt_pk_bf16_f32 v132, v72, v73
  v_cvt_pk_bf16_f32 v133, v74, v75
  v_mfma_f32_16x16x32_bf16 v[112:115], v[40:43], a[40:43], v[112:115]
  buffer_load_dwordx4 v18, s[12:15], s19 offen lds
  v_mfma_f32_16x16x32_bf16 v[120:123], v[40:43], a[44:47], v[120:123]
  s_waitcnt lgkmcnt(5)
  v_cvt_pk_bf16_f32 v134, v76, v77
  v_cvt_pk_bf16_f32 v135, v78, v79
  v_mfma_f32_16x16x32_bf16 v[100:103], v[44:47], a[32:35], v[100:103]
  ds_read_b128 v[36:39], v11 offset:40960
  v_mfma_f32_16x16x32_bf16 v[108:111], v[44:47], a[36:39], v[108:111]
  v_mfma_f32_16x16x32_bf16 v[116:119], v[44:47], a[40:43], v[116:119]
  v_mfma_f32_16x16x32_bf16 v[124:127], v[44:47], a[44:47], v[124:127]
  s_waitcnt lgkmcnt(5)
  v_mfma_f32_16x16x32_bf16 v[96:99], v[48:51], a[48:51], v[96:99]
  s_add_u32 m0, s25, 3072
  ds_read_b128 v[40:43], v12 offset:40960
  v_mfma_f32_16x16x32_bf16 v[104:107], v[48:51], a[52:55], v[104:107]
  v_mfma_f32_16x16x32_bf16 v[112:115], v[48:51], a[56:59], v[112:115]
  buffer_load_dwordx4 v19, s[12:15], s19 offen lds
  v_mfma_f32_16x16x32_bf16 v[120:123], v[48:51], a[60:63], v[120:123]
  s_waitcnt lgkmcnt(5)
  v_mfma_f32_16x16x32_bf16 v[100:103], v[52:55], a[48:51], v[100:103]
  ds_read_b128 v[44:47], v13 offset:40960
  v_mfma_f32_16x16x32_bf16 v[108:111], v[52:55], a[52:55], v[108:111]
  v_cvt_pk_bf16_f32 v136, v80, v81
  v_cvt_pk_bf16_f32 v137, v82, v83
  v_mfma_f32_16x16x32_bf16 v[116:119], v[52:55], a[56:59], v[116:119]
  v_mfma_f32_16x16x32_bf16 v[124:127], v[52:55], a[60:63], v[124:127]
  s_waitcnt lgkmcnt(5)
  v_cvt_pk_bf16_f32 v138, v84, v85
  v_cvt_pk_bf16_f32 v139, v86, v87
  v_mfma_f32_16x16x32_bf16 v[96:99], v[24:27], a[64:67], v[96:99]
  s_add_u32 m0, s25, 4096
  ds_read_b128 v[48:51], v14 offset:40960
  v_mfma_f32_16x16x32_bf16 v[104:107], v[24:27], a[68:71], v[104:107]
  v_mfma_f32_16x16x32_bf16 v[112:115], v[24:27], a[72:75], v[112:115]
  buffer_load_dwordx4 v20, s[12:15], s19 offen lds
  v_mfma_f32_16x16x32_bf16 v[120:123], v[24:27], a[76:79], v[120:123]
  s_waitcnt lgkmcnt(5)
  v_mfma_f32_16x16x32_bf16 v[100:103], v[28:31], a[64:67], v[100:103]
  ds_read_b128 v[52:55], v15 offset:40960
  v_mfma_f32_16x16x32_bf16 v[108:111], v[28:31], a[68:71], v[108:111]
  v_mfma_f32_16x16x32_bf16 v[116:119], v[28:31], a[72:75], v[116:119]
  v_mfma_f32_16x16x32_bf16 v[124:127], v[28:31], a[76:79], v[124:127]
  s_waitcnt lgkmcnt(5)
  v_mfma_f32_16x16x32_bf16 v[96:99], v[32:35], a[80:83], v[96:99]
  s_add_u32 m0, s25, 5120
  ds_read_b128 v[24:27], v8 offset:49152
  v_mfma_f32_16x16x32_bf16 v[104:107], v[32:35], a[84:87], v[104:107]
  v_cvt_pk_bf16_f32 v140, v88, v89
  v_cvt_pk_bf16_f32 v141, v90, v91
  v_mfma_f32_16x16x32_bf16 v[112:115], v[32:35], a[88:91], v[112:115]
  buffer_load_dwordx4 v21, s[12:15], s19 offen lds
  v_mfma_f32_16x16x32_bf16 v[120:123], v[32:35], a[92:95], v[120:123]
  s_waitcnt lgkmcnt(5)
  v_cvt_pk_bf16_f32 v142, v92, v93
  v_cvt_pk_bf16_f32 v143, v94, v95
  v_mfma_f32_16x16x32_bf16 v[100:103], v[36:39], a[80:83], v[100:103]
  ds_read_b128 v[28:31], v9 offset:49152
  v_mfma_f32_16x16x32_bf16 v[108:111], v[36:39], a[84:87], v[108:111]
  v_mfma_f32_16x16x32_bf16 v[116:119], v[36:39], a[88:91], v[116:119]
  v_mfma_f32_16x16x32_bf16 v[124:127], v[36:39], a[92:95], v[124:127]
  s_waitcnt lgkmcnt(5)
  v_mfma_f32_16x16x32_bf16 v[96:99], v[40:43], a[96:99], v[96:99]
  s_add_u32 m0, s25, 6144
  ds_read_b128 v[32:35], v10 offset:49152
  v_mfma_f32_16x16x32_bf16 v[104:107], v[40:43], a[100:103], v[104:107]
  v_mfma_f32_16x16x32_bf16 v[112:115], v[40:43], a[104:107], v[112:115]
  buffer_load_dwordx4 v22, s[12:15], s19 offen lds
  v_mfma_f32_16x16x32_bf16 v[120:123], v[40:43], a[108:111], v[120:123]
  s_waitcnt lgkmcnt(5)
  v_mfma_f32_16x16x32_bf16 v[100:103], v[44:47], a[96:99], v[100:103]
  ds_read_b128 v[36:39], v11 offset:49152
  v_mfma_f32_16x16x32_bf16 v[108:111], v[44:47], a[100:103], v[108:111]
  v_mfma_f32_16x16x32_bf16 v[116:119], v[44:47], a[104:107], v[116:119]
  v_mfma_f32_16x16x32_bf16 v[124:127], v[44:47], a[108:111], v[124:127]
  s_waitcnt lgkmcnt(5)
  v_mfma_f32_16x16x32_bf16 v[96:99], v[48:51], a[112:115], v[96:99]
  s_add_u32 m0, s25, 7168
  ds_read_b128 v[40:43], v12 offset:49152
  v_mfma_f32_16x16x32_bf16 v[104:107], v[48:51], a[116:119], v[104:107]
  v_mfma_f32_16x16x32_bf16 v[112:115], v[48:51], a[120:123], v[112:115]
  buffer_load_dwordx4 v23, s[12:15], s19 offen lds
  v_mfma_f32_16x16x32_bf16 v[120:123], v[48:51], a[124:127], v[120:123]
  s_waitcnt lgkmcnt(5)
  v_mfma_f32_16x16x32_bf16 v[100:103], v[52:55], a[112:115], v[100:103]
  s_cmp_gt_u32 s23, 3
  ds_read_b128 v[44:47], v13 offset:49152
  v_mfma_f32_16x16x32_bf16 v[108:111], v[52:55], a[116:119], v[108:111]
  v_mfma_f32_16x16x32_bf16 v[116:119], v[52:55], a[120:123], v[116:119]
  s_cselect_b32 s26, s20, 0
  v_mfma_f32_16x16x32_bf16 v[124:127], v[52:55], a[124:127], v[124:127]
  s_waitcnt lgkmcnt(5)
  v_mfma_f32_16x16x32_bf16 v[96:99], v[24:27], a[128:131], v[96:99]
  s_add_u32 s19, s19, s26
  ds_read_b128 v[48:51], v14 offset:49152
  v_mfma_f32_16x16x32_bf16 v[104:107], v[24:27], a[132:135], v[104:107]
  v_mfma_f32_16x16x32_bf16 v[112:115], v[24:27], a[136:139], v[112:115]
  s_add_u32 s25, s25, 32768
  v_mfma_f32_16x16x32_bf16 v[120:123], v[24:27], a[140:143], v[120:123]
  s_waitcnt lgkmcnt(5)
  v_mfma_f32_16x16x32_bf16 v[100:103], v[28:31], a[128:131], v[100:103]
  s_and_b32 s25, s25, 0x1ffff
  ds_read_b128 v[52:55], v15 offset:49152
  v_mfma_f32_16x16x32_bf16 v[108:111], v[28:31], a[132:135], v[108:111]
  v_mfma_f32_16x16x32_bf16 v[116:119], v[28:31], a[136:139], v[116:119]
  buffer_store_dwordx4 v[128:131], v7, s[4:7], s21 offen offset:0 sc1
  v_mfma_f32_16x16x32_bf16 v[124:127], v[28:31], a[140:143], v[124:127]
  s_waitcnt lgkmcnt(5)
  v_mfma_f32_16x16x32_bf16 v[96:99], v[32:35], a[144:147], v[96:99]
  ds_read_b128 v[24:27], v8 offset:57344
  v_mfma_f32_16x16x32_bf16 v[104:107], v[32:35], a[148:151], v[104:107]
  v_mfma_f32_16x16x32_bf16 v[112:115], v[32:35], a[152:155], v[112:115]
  v_mfma_f32_16x16x32_bf16 v[120:123], v[32:35], a[156:159], v[120:123]
  s_waitcnt lgkmcnt(5)
  v_xor_b32 v8, 0x10000, v8
  v_mfma_f32_16x16x32_bf16 v[100:103], v[36:39], a[144:147], v[100:103]
  ds_read_b128 v[28:31], v9 offset:57344
  v_mfma_f32_16x16x32_bf16 v[108:111], v[36:39], a[148:151], v[108:111]
  v_mfma_f32_16x16x32_bf16 v[116:119], v[36:39], a[152:155], v[116:119]
  buffer_store_dwordx4 v[132:135], v7, s[4:7], s21 offen offset:256 sc1
  v_mfma_f32_16x16x32_bf16 v[124:127], v[36:39], a[156:159], v[124:127]
  s_waitcnt lgkmcnt(5)
  v_xor_b32 v9, 0x10000, v9
  v_mfma_f32_16x16x32_bf16 v[96:99], v[40:43], a[160:163], v[96:99]
  ds_read_b128 v[32:35], v10 offset:57344
  v_mfma_f32_16x16x32_bf16 v[104:107], v[40:43], a[164:167], v[104:107]
  v_mfma_f32_16x16x32_bf16 v[112:115], v[40:43], a[168:171], v[112:115]
  v_mfma_f32_16x16x32_bf16 v[120:123], v[40:43], a[172:175], v[120:123]
  s_waitcnt lgkmcnt(5)
  v_xor_b32 v10, 0x10000, v10
  v_mfma_f32_16x16x32_bf16 v[100:103], v[44:47], a[160:163], v[100:103]
  ds_read_b128 v[36:39], v11 offset:57344
  v_mfma_f32_16x16x32_bf16 v[108:111], v[44:47], a[164:167], v[108:111]
  v_mfma_f32_16x16x32_bf16 v[116:119], v[44:47], a[168:171], v[116:119]
  buffer_store_dwordx4 v[136:139], v7, s[4:7], s21 offen offset:2048 sc1
  v_mfma_f32_16x16x32_bf16 v[124:127], v[44:47], a[172:175], v[124:127]
  s_waitcnt lgkmcnt(5)
  v_xor_b32 v11, 0x10000, v11
  v_mfma_f32_16x16x32_bf16 v[96:99], v[48:51], a[176:179], v[96:99]
  ds_read_b128 v[40:43], v12 offset:57344
  v_mfma_f32_16x16x32_bf16 v[104:107], v[48:51], a[180:183], v[104:107]
  v_mfma_f32_16x16x32_bf16 v[112:115], v[48:51], a[184:187], v[112:115]
  v_mfma_f32_16x16x32_bf16 v[120:123], v[48:51], a[188:191], v[120:123]
  s_waitcnt lgkmcnt(5)
  v_xor_b32 v12, 0x10000, v12
  v_mfma_f32_16x16x32_bf16 v[100:103], v[52:55], a[176:179], v[100:103]
  ds_read_b128 v[44:47], v13 offset:57344
  v_mfma_f32_16x16x32_bf16 v[108:111], v[52:55], a[180:183], v[108:111]
  v_mfma_f32_16x16x32_bf16 v[116:119], v[52:55], a[184:187], v[116:119]
  buffer_store_dwordx4 v[140:143], v7, s[4:7], s21 offen offset:2304 sc1
  v_mfma_f32_16x16x32_bf16 v[124:127], v[52:55], a[188:191], v[124:127]
  s_waitcnt lgkmcnt(5)
  v_xor_b32 v13, 0x10000, v13
  v_mfma_f32_16x16x32_bf16 v[96:99], v[24:27], a[192:195], v[96:99]
  s_mov_b32 s21, s27
  ds_read_b128 v[48:51], v14 offset:57344
  v_mfma_f32_16x16x32_bf16 v[104:107], v[24:27], a[196:199], v[104:107]
  v_mov_b32 v7, v56
  v_mfma_f32_16x16x32_bf16 v[112:115], v[24:27], a[200:203], v[112:115]
  v_mfma_f32_16x16x32_bf16 v[120:123], v[24:27], a[204:207], v[120:123]
  s_waitcnt lgkmcnt(5)
  v_xor_b32 v14, 0x10000, v14
  v_mfma_f32_16x16x32_bf16 v[100:103], v[28:31], a[192:195], v[100:103]
  s_add_u32 s27, s27, s22
  ds_read_b128 v[52:55], v15 offset:57344
  v_mfma_f32_16x16x32_bf16 v[108:111], v[28:31], a[196:199], v[108:111]
  v_mfma_f32_16x16x32_bf16 v[116:119], v[28:31], a[200:203], v[116:119]
  s_waitcnt vmcnt(13)
  s_barrier
  v_mfma_f32_16x16x32_bf16 v[124:127], v[28:31], a[204:207], v[124:127]
  s_waitcnt lgkmcnt(5)
  v_xor_b32 v15, 0x10000, v15
  v_mfma_f32_16x16x32_bf16 v[96:99], v[32:35], a[208:211], v[96:99]
  ds_read_b128 v[24:27], v8 offset:0
  v_mfma_f32_16x16x32_bf16 v[104:107], v[32:35], a[212:215], v[104:107]
  v_mfma_f32_16x16x32_bf16 v[112:115], v[32:35], a[216:219], v[112:115]
  v_mfma_f32_16x16x32_bf16 v[120:123], v[32:35], a[220:223], v[120:123]
  s_waitcnt lgkmcnt(5)
  v_mfma_f32_16x16x32_bf16 v[100:103], v[36:39], a[208:211], v[100:103]
  s_add_u32 s29, s29, 1
  ds_read_b128 v[28:31], v9 offset:0
  v_mfma_f32_16x16x32_bf16 v[108:111], v[36:39], a[212:215], v[108:111]
  v_mfma_f32_16x16x32_bf16 v[116:119], v[36:39], a[216:219], v[116:119]
  s_max_i32 s30, s29, 0
  v_mfma_f32_16x16x32_bf16 v[124:127], v[36:39], a[220:223], v[124:127]
  s_waitcnt lgkmcnt(5)
  v_mov_b32 v144, s30
  v_mfma_f32_16x16x32_bf16 v[96:99], v[40:43], a[224:227], v[96:99]
  ds_read_b128 v[32:35], v10 offset:0
  v_mfma_f32_16x16x32_bf16 v[104:107], v[40:43], a[228:231], v[104:107]
  v_mfma_f32_16x16x32_bf16 v[112:115], v[40:43], a[232:235], v[112:115]
  buffer_store_dword v144, v145, s[4:7], s31 offen sc1
  v_mfma_f32_16x16x32_bf16 v[120:123], v[40:43], a[236:239], v[120:123]
  s_waitcnt lgkmcnt(5)
  v_mfma_f32_16x16x32_bf16 v[100:103], v[44:47], a[224:227], v[100:103]
  ds_read_b128 v[36:39], v11 offset:0
  v_mfma_f32_16x16x32_bf16 v[108:111], v[44:47], a[228:231], v[108:111]
  v_mfma_f32_16x16x32_bf16 v[116:119], v[44:47], a[232:235], v[116:119]
  v_mfma_f32_16x16x32_bf16 v[124:127], v[44:47], a[236:239], v[124:127]
  s_waitcnt lgkmcnt(5)
  v_mfma_f32_16x16x32_bf16 v[96:99], v[48:51], a[240:243], v[96:99]
  s_sub_u32 s23, s23, 1
  ds_read_b128 v[40:43], v12 offset:0
  v_mfma_f32_16x16x32_bf16 v[104:107], v[48:51], a[244:247], v[104:107]
  v_mfma_f32_16x16x32_bf16 v[112:115], v[48:51], a[248:251], v[112:115]
  v_mfma_f32_16x16x32_bf16 v[120:123], v[48:51], a[252:255], v[120:123]
  s_waitcnt lgkmcnt(5)
  v_mfma_f32_16x16x32_bf16 v[100:103], v[52:55], a[240:243], v[100:103]
  s_cmp_eq_u32 s23, 0
  ds_read_b128 v[44:47], v13 offset:0
  v_mfma_f32_16x16x32_bf16 v[108:111], v[52:55], a[244:247], v[108:111]
  v_mfma_f32_16x16x32_bf16 v[116:119], v[52:55], a[248:251], v[116:119]
  v_mfma_f32_16x16x32_bf16 v[124:127], v[52:55], a[252:255], v[124:127]
  s_cbranch_scc1 G_done1_143
  s_branch G_top_141
G_done0_142:
  s_nop 7
  s_nop 3
  v_cvt_pk_bf16_f32 v128, v64, v65
  v_cvt_pk_bf16_f32 v129, v66, v67
  v_cvt_pk_bf16_f32 v130, v68, v69
  v_cvt_pk_bf16_f32 v131, v70, v71
  buffer_store_dwordx4 v[128:131], v7, s[4:7], s21 offen offset:0 sc1
  v_cvt_pk_bf16_f32 v132, v72, v73
  v_cvt_pk_bf16_f32 v133, v74, v75
  v_cvt_pk_bf16_f32 v134, v76, v77
  v_cvt_pk_bf16_f32 v135, v78, v79
  buffer_store_dwordx4 v[132:135], v7, s[4:7], s21 offen offset:256 sc1
  v_cvt_pk_bf16_f32 v136, v80, v81
  v_cvt_pk_bf16_f32 v137, v82, v83
  v_cvt_pk_bf16_f32 v138, v84, v85
  v_cvt_pk_bf16_f32 v139, v86, v87
  buffer_store_dwordx4 v[136:139], v7, s[4:7], s21 offen offset:2048 sc1
  v_cvt_pk_bf16_f32 v140, v88, v89
  v_cvt_pk_bf16_f32 v141, v90, v91
  v_cvt_pk_bf16_f32 v142, v92, v93
  v_cvt_pk_bf16_f32 v143, v94, v95
  buffer_store_dwordx4 v[140:143], v7, s[4:7], s21 offen offset:2304 sc1
  s_branch G_fin_144
G_done1_143:
  s_nop 7
  s_nop 3
  v_cvt_pk_bf16_f32 v128, v96, v97
  v_cvt_pk_bf16_f32 v129, v98, v99
  v_cvt_pk_bf16_f32 v130, v100, v101
  v_cvt_pk_bf16_f32 v131, v102, v103
  buffer_store_dwordx4 v[128:131], v7, s[4:7], s21 offen offset:0 sc1
  v_cvt_pk_bf16_f32 v132, v104, v105
  v_cvt_pk_bf16_f32 v133, v106, v107
  v_cvt_pk_bf16_f32 v134, v108, v109
  v_cvt_pk_bf16_f32 v135, v110, v111
  buffer_store_dwordx4 v[132:135], v7, s[4:7], s21 offen offset:256 sc1
  v_cvt_pk_bf16_f32 v136, v112, v113
  v_cvt_pk_bf16_f32 v137, v114, v115
  v_cvt_pk_bf16_f32 v138, v116, v117
  v_cvt_pk_bf16_f32 v139, v118, v119
  buffer_store_dwordx4 v[136:139], v7, s[4:7], s21 offen offset:2048 sc1
  v_cvt_pk_bf16_f32 v140, v120, v121
  v_cvt_pk_bf16_f32 v141, v122, v123
  v_cvt_pk_bf16_f32 v142, v124, v125
  v_cvt_pk_bf16_f32 v143, v126, v127
  buffer_store_dwordx4 v[140:143], v7, s[4:7], s21 offen offset:2304 sc1
G_fin_144:
  s_waitcnt vmcnt(0) lgkmcnt(0)
  s_barrier
  s_add_u32 s30, s29, 2
  v_mov_b32 v144, s30
  v_min_u32 v145, 1, v0
  v_lshlrev_b32 v145, 30, v145
  buffer_store_dword v144, v145, s[4:7], s31 offen sc1
P_end_131:
  s_mov_b32 s71, 0
  s_branch M_sg_146
M_sw_145:
  s_sleep 8
  s_add_u32 s71, s71, 1
  s_cmp_gt_u32 s71, 262144
  s_cbranch_scc1 M_exit
M_sg_146:
  s_mov_b32 s79, 0
  s_atomic_or s79, s[74:75], 128 glc
  s_waitcnt lgkmcnt(0)
  s_cmp_lt_u32 s79, 256
  s_cbranch_scc1 M_sw_145
  s_cmp_eq_u32 s65, 6
  s_cbranch_scc1 M_follow
  s_mov_b32 s68, 0
  s_mov_b32 s36, -1
  s_mov_b32 s69, s53
  s_mov_b32 s70, s54
  s_load_dwordx2 s[8:9], s[0:1], 40
  s_mul_i32 s76, s64, 6
  s_add_u32 s76, s76, s65
  s_mul_i32 s76, s76, 21888
  v_min_u32 v200, 170, v0
  v_mul_u32_u24 v200, 128, v200
  v_add_u32 v200, s76, v200
  s_waitcnt lgkmcnt(0)
  s_and_b32 s9, s9, 0xffff
  s_mov_b32 s10, 4194304
  s_mov_b32 s11, 0x20000
M_att:
  s_mov_b32 s24, 0xf149f2ca
  s_mov_b32 s29, 0
  v_mov_b32 v6, 0
  v_mov_b32 v7, 0
  s_lshl_b32 s26, s16, 11
  v_add_u32 v3, s26, v2
  v_and_b32 v5, 31, v1
  v_lshrrev_b32 v12, 5, v1
  v_lshlrev_b32 v12, 2, v12
  v_sub_u32 v5, v5, v12
  s_lshl_b32 s26, s64, 19
  s_add_u32 s19, s26, 16777216
  s_add_u32 s20, s26, 33554432
  s_lshl_b32 s27, s69, 2
  s_add_u32 s27, s27, s16
  s_lshl_b32 s27, s27, 14
  s_add_u32 s25, s26, s27
  s_bfe_u32 s78, s70, 0x80000
  s_add_u32 s76, s67, 512
  s_mov_b32 s71, 0
  s_branch M_sg_148
M_sw_147:
  s_sleep 8
  s_add_u32 s71, s71, 1
  s_cmp_gt_u32 s71, 262144
  s_cbranch_scc1 M_exit
M_sg_148:
  s_mov_b32 s79, 0
  s_atomic_or s79, s[72:73], s76 glc
  s_waitcnt lgkmcnt(0)
  s_cmp_lt_u32 s79, s78
  s_cbranch_scc1 M_sw_147
  s_bfe_u32 s78, s70, 0x80008
  s_add_u32 s76, s67, 640
  s_mov_b32 s71, 0
  s_branch M_sg_150
M_sw_149:
  s_sleep 8
  s_add_u32 s71, s71, 1
  s_cmp_gt_u32 s71, 262144
  s_cbranch_scc1 M_exit
M_sg_150:
  s_mov_b32 s79, 0
  s_atomic_or s79, s[72:73], s76 glc
  s_waitcnt lgkmcnt(0)
  s_cmp_lt_u32 s79, s78
  s_cbranch_scc1 M_sw_149
  s_lshl_b32 s27, s69, 16
  s_add_u32 s27, s27, 16384
  s_add_u32 s17, s19, s27
M_kv_151:
  s_cmp_ge_u32 s17, s36
  s_cbranch_scc1 M_kvok_152
  s_mov_b32 s76, 0
  s_mov_b32 s78, 25
  s_mov_b32 s77, 319488
  s_cmp_eq_u32 s68, 1
  s_cmov_b32 s76, 128
  s_cmov_b32 s78, 29
  s_cmov_b32 s77, 81920
  s_cmp_eq_u32 s68, 2
  s_cmov_b32 s76, 768
  s_cmov_b32 s78, 10
  s_cmov_b32 s77, 0
  s_add_u32 s76, s76, s67
  s_mov_b32 s71, 0
  s_branch M_sg_154
M_sw_153:
  s_sleep 8
  s_add_u32 s71, s71, 1
  s_cmp_gt_u32 s71, 262144
  s_cbranch_scc1 M_exit
M_sg_154:
  s_mov_b32 s79, 0
  s_atomic_or s79, s[72:73], s76 glc
  s_waitcnt lgkmcnt(0)
  s_cmp_lt_u32 s79, s78
  s_cbranch_scc1 M_sw_153
  s_add_u32 s36, s77, s19
  s_add_u32 s68, s68, 1
  s_branch M_kv_151
M_kvok_152:
  s_add_u32 s28, s25, 0
  buffer_load_dwordx4 a[128:131], v2, s[4:7], s28 offen offset:0 sc1
  buffer_load_dwordx4 a[132:135], v2, s[4:7], s28 offen offset:1024 sc1
  buffer_load_dwordx4 a[136:139], v2, s[4:7], s28 offen offset:2048 sc1
  buffer_load_dwordx4 a[140:143], v2, s[4:7], s28 offen offset:3072 sc1
  s_add_u32 s28, s25, 4096
  buffer_load_dwordx4 a[144:147], v2, s[4:7], s28 offen offset:0 sc1
  buffer_load_dwordx4 a[148:151], v2, s[4:7], s28 offen offset:1024 sc1
  buffer_load_dwordx4 a[152:155], v2, s[4:7], s28 offen offset:2048 sc1
  buffer_load_dwordx4 a[156:159], v2, s[4:7], s28 offen offset:3072 sc1
  s_add_u32 s28, s25, 8192
  buffer_load_dwordx4 a[160:163], v2, s[4:7], s28 offen offset:0 sc1
  buffer_load_dwordx4 a[164:167], v2, s[4:7], s28 offen offset:1024 sc1
  buffer_load_dwordx4 a[168:171], v2, s[4:7], s28 offen offset:2048 sc1
  buffer_load_dwordx4 a[172:175], v2, s[4:7], s28 offen offset:3072 sc1
  s_add_u32 s28, s25, 12288
  buffer_load_dwordx4 a[176:179], v2, s[4:7], s28 offen offset:0 sc1
  buffer_load_dwordx4 a[180:183], v2, s[4:7], s28 offen offset:1024 sc1
  buffer_load_dwordx4 a[184:187], v2, s[4:7], s28 offen offset:2048 sc1
  buffer_load_dwordx4 a[188:191], v2, s[4:7], s28 offen offset:3072 sc1
A_again_155:
  s_lshl_b32 s27, s69, 16
  s_add_u32 s27, s27, 57344
  s_add_u32 s17, s19, s27
  s_add_u32 s18, s20, s27
  s_lshl_b32 s21, s16, 11
  s_mov_b32 m0, s21
  s_nop 0
  buffer_load_dwordx4 v3, s[4:7], s18 offen offset:0 sc1 lds
  buffer_load_dwordx4 v3, s[4:7], s18 offen offset:1024 sc1 lds
  s_add_u32 m0, s21, 8192
  s_nop 0
  buffer_load_dwordx4 v3, s[4:7], s17 offen offset:0 sc1 lds
  buffer_load_dwordx4 v3, s[4:7], s17 offen offset:1024 sc1 lds
  s_add_u32 s18, s18, 8192
  s_sub_u32 s18, s18, 8192
  s_max_i32 s18, s18, s20
  s_sub_u32 s17, s17, 8192
  s_max_i32 s17, s17, s19
  s_add_u32 s21, s21, 16384
  s_and_b32 s21, s21, 131071
  s_mov_b32 m0, s21
  s_nop 0
  buffer_load_dwordx4 v3, s[4:7], s18 offen offset:0 sc1 lds
  buffer_load_dwordx4 v3, s[4:7], s18 offen offset:1024 sc1 lds
  s_add_u32 m0, s21, 8192
  s_nop 0
  buffer_load_dwordx4 v3, s[4:7], s17 offen offset:0 sc1 lds
  buffer_load_dwordx4 v3, s[4:7], s17 offen offset:1024 sc1 lds
  s_sub_u32 s18, s18, 8192
  s_max_i32 s18, s18, s20
  s_sub_u32 s17, s17, 8192
  s_max_i32 s17, s17, s19
  s_add_u32 s21, s21, 16384
  s_and_b32 s21, s21, 131071
  s_mov_b32 m0, s21
  s_nop 0
  buffer_load_dwordx4 v3, s[4:7], s18 offen offset:0 sc1 lds
  buffer_load_dwordx4 v3, s[4:7], s18 offen offset:1024 sc1 lds
  s_add_u32 m0, s21, 8192
  s_nop 0
  buffer_load_dwordx4 v3, s[4:7], s17 offen offset:0 sc1 lds
  buffer_load_dwordx4 v3, s[4:7], s17 offen offset:1024 sc1 lds
  s_sub_u32 s18, s18, 8192
  s_max_i32 s18, s18, s20
  s_sub_u32 s17, s17, 8192
  s_max_i32 s17, s17, s19
  s_add_u32 s21, s21, 16384
  s_and_b32 s21, s21, 131071
  s_mov_b32 m0, s21
  s_nop 0
  buffer_load_dwordx4 v3, s[4:7], s18 offen offset:0 sc1 lds
  buffer_load_dwordx4 v3, s[4:7], s18 offen offset:1024 sc1 lds
  s_add_u32 m0, s21, 8192
  s_nop 0
  buffer_load_dwordx4 v3, s[4:7], s17 offen offset:0 sc1 lds
  buffer_load_dwordx4 v3, s[4:7], s17 offen offset:1024 sc1 lds
  s_sub_u32 s18, s18, 8192
  s_max_i32 s18, s18, s20
  s_sub_u32 s17, s17, 8192
  s_max_i32 s17, s17, s19
  s_add_u32 s21, s21, 16384
  s_and_b32 s21, s21, 131071
  s_mov_b32 m0, s21
  s_nop 0
  buffer_load_dwordx4 v3, s[4:7], s18 offen offset:0 sc1 lds
  buffer_load_dwordx4 v3, s[4:7], s18 offen offset:1024 sc1 lds
  s_add_u32 m0, s21, 8192
  s_nop 0
  buffer_load_dwordx4 v3, s[4:7], s17 offen offset:0 sc1 lds
  buffer_load_dwordx4 v3, s[4:7], s17 offen offset:1024 sc1 lds
  s_sub_u32 s18, s18, 8192
  s_max_i32 s18, s18, s20
  s_sub_u32 s17, s17, 8192
  s_max_i32 s17, s17, s19
  s_add_u32 s21, s21, 16384
  s_and_b32 s21, s21, 131071
  s_mov_b32 m0, s21
  s_nop 0
  buffer_load_dwordx4 v3, s[4:7], s18 offen offset:0 sc1 lds
  buffer_load_dwordx4 v3, s[4:7], s18 offen offset:1024 sc1 lds
  s_add_u32 m0, s21, 8192
  s_nop 0
  buffer_load_dwordx4 v3, s[4:7], s17 offen offset:0 sc1 lds
  buffer_load_dwordx4 v3, s[4:7], s17 offen offset:1024 sc1 lds
  v_accvgpr_write_b32 a0, 0
  v_accvgpr_write_b32 a1, 0
  v_accvgpr_write_b32 a2, 0
  v_accvgpr_write_b32 a3, 0
  v_accvgpr_write_b32 a4, 0
  v_accvgpr_write_b32 a5, 0
  v_accvgpr_write_b32 a6, 0
  v_accvgpr_write_b32 a7, 0
  v_accvgpr_write_b32 a8, 0
  v_accvgpr_write_b32 a9, 0
  v_accvgpr_write_b32 a10, 0
  v_accvgpr_write_b32 a11, 0
  v_accvgpr_write_b32 a12, 0
  v_accvgpr_write_b32 a13, 0
  v_accvgpr_write_b32 a14, 0
  v_accvgpr_write_b32 a15, 0
  v_accvgpr_write_b32 a16, 0
  v_accvgpr_write_b32 a17, 0
  v_accvgpr_write_b32 a18, 0
  v_accvgpr_write_b32 a19, 0
  v_accvgpr_write_b32 a20, 0
  v_accvgpr_write_b32 a21, 0
  v_accvgpr_write_b32 a22, 0
  v_accvgpr_write_b32 a23, 0
  v_accvgpr_write_b32 a24, 0
  v_accvgpr_write_b32 a25, 0
  v_accvgpr_write_b32 a26, 0
  v_accvgpr_write_b32 a27, 0
  v_accvgpr_write_b32 a28, 0
  v_accvgpr_write_b32 a29, 0
  v_accvgpr_write_b32 a30, 0
  v_accvgpr_write_b32 a31, 0
  v_accvgpr_write_b32 a32, 0
  v_accvgpr_write_b32 a33, 0
  v_accvgpr_write_b32 a34, 0
  v_accvgpr_write_b32 a35, 0
  v_accvgpr_write_b32 a36, 0
  v_accvgpr_write_b32 a37, 0
  v_accvgpr_write_b32 a38, 0
  v_accvgpr_write_b32 a39, 0
  v_accvgpr_write_b32 a40, 0
  v_accvgpr_write_b32 a41, 0
  v_accvgpr_write_b32 a42, 0
  v_accvgpr_write_b32 a43, 0
  v_accvgpr_write_b32 a44, 0
  v_accvgpr_write_b32 a45, 0
  v_accvgpr_write_b32 a46, 0
  v_accvgpr_write_b32 a47, 0
  v_accvgpr_write_b32 a48, 0
  v_accvgpr_write_b32 a49, 0
  v_accvgpr_write_b32 a50, 0
  v_accvgpr_write_b32 a51, 0
  v_accvgpr_write_b32 a52, 0
  v_accvgpr_write_b32 a53, 0
  v_accvgpr_write_b32 a54, 0
  v_accvgpr_write_b32 a55, 0
  v_accvgpr_write_b32 a56, 0
  v_accvgpr_write_b32 a57, 0
  v_accvgpr_write_b32 a58, 0
  v_accvgpr_write_b32 a59, 0
  v_accvgpr_write_b32 a60, 0
  v_accvgpr_write_b32 a61, 0
  v_accvgpr_write_b32 a62, 0
  v_accvgpr_write_b32 a63, 0
  v_accvgpr_write_b32 a64, 0
  v_accvgpr_write_b32 a65, 0
  v_accvgpr_write_b32 a66, 0
  v_accvgpr_write_b32 a67, 0
  v_accvgpr_write_b32 a68, 0
  v_accvgpr_write_b32 a69, 0
  v_accvgpr_write_b32 a70, 0
  v_accvgpr_write_b32 a71, 0
  v_accvgpr_write_b32 a72, 0
  v_accvgpr_write_b32 a73, 0
  v_accvgpr_write_b32 a74, 0
  v_accvgpr_write_b32 a75, 0
  v_accvgpr_write_b32 a76, 0
  v_accvgpr_write_b32 a77, 0
  v_accvgpr_write_b32 a78, 0
  v_accvgpr_write_b32 a79, 0
  v_accvgpr_write_b32 a80, 0
  v_accvgpr_write_b32 a81, 0
  v_accvgpr_write_b32 a82, 0
  v_accvgpr_write_b32 a83, 0
  v_accvgpr_write_b32 a84, 0
  v_accvgpr_write_b32 a85, 0
  v_accvgpr_write_b32 a86, 0
  v_accvgpr_write_b32 a87, 0
  v_accvgpr_write_b32 a88, 0
  v_accvgpr_write_b32 a89, 0
  v_accvgpr_write_b32 a90, 0
  v_accvgpr_write_b32 a91, 0
  v_accvgpr_write_b32 a92, 0
  v_accvgpr_write_b32 a93, 0
  v_accvgpr_write_b32 a94, 0
  v_accvgpr_write_b32 a95, 0
  v_accvgpr_write_b32 a96, 0
  v_accvgpr_write_b32 a97, 0
  v_accvgpr_write_b32 a98, 0
  v_accvgpr_write_b32 a99, 0
  v_accvgpr_write_b32 a100, 0
  v_accvgpr_write_b32 a101, 0
  v_accvgpr_write_b32 a102, 0
  v_accvgpr_write_b32 a103, 0
  v_accvgpr_write_b32 a104, 0
  v_accvgpr_write_b32 a105, 0
  v_accvgpr_write_b32 a106, 0
  v_accvgpr_write_b32 a107, 0
  v_accvgpr_write_b32 a108, 0
  v_accvgpr_write_b32 a109, 0
  v_accvgpr_write_b32 a110, 0
  v_accvgpr_write_b32 a111, 0
  v_accvgpr_write_b32 a112, 0
  v_accvgpr_write_b32 a113, 0
  v_accvgpr_write_b32 a114, 0
  v_accvgpr_write_b32 a115, 0
  v_accvgpr_write_b32 a116, 0
  v_accvgpr_write_b32 a117, 0
  v_accvgpr_write_b32 a118, 0
  v_accvgpr_write_b32 a119, 0
  v_accvgpr_write_b32 a120, 0
  v_accvgpr_write_b32 a121, 0
  v_accvgpr_write_b32 a122, 0
  v_accvgpr_write_b32 a123, 0
  v_accvgpr_write_b32 a124, 0
  v_accvgpr_write_b32 a125, 0
  v_accvgpr_write_b32 a126, 0
  v_accvgpr_write_b32 a127, 0
  v_mov_b32 v8, 0
  v_mov_b32 v9, 0
  v_mov_b32 v10, 0
  v_mov_b32 v11, 0
  v_mov_b32 v52, 0
  v_mov_b32 v53, 0
  v_mov_b32 v54, s24
  v_mov_b32 v55, s24
  v_mov_b32 v56, s24
  v_mov_b32 v57, s24
  v_mov_b32 v58, s24
  v_mov_b32 v59, s24
  v_mov_b32 v60, s24
  v_mov_b32 v61, s24
  v_mov_b32 v62, s24
  v_mov_b32 v63, s24
  v_mov_b32 v104, 0
  v_mov_b32 v105, 0
  v_mov_b32 v4, v2
  v_mov_b32 v64, s24
  v_mov_b32 v65, s24
  v_mov_b32 v66, s24
  v_mov_b32 v67, s24
  v_mov_b32 v68, s24
  v_mov_b32 v69, s24
  v_mov_b32 v70, s24
  v_mov_b32 v71, s24
  v_mov_b32 v72, s24
  v_mov_b32 v73, s24
  v_mov_b32 v74, s24
  v_mov_b32 v75, s24
  v_mov_b32 v76, s24
  v_mov_b32 v77, s24
  v_mov_b32 v78, s24
  v_mov_b32 v79, s24
  v_mov_b32 v12, s24
  v_cmp_le_i32 s[40:41], 0, v5
  v_cmp_le_i32 s[42:43], 1, v5
  v_cmp_le_i32 s[44:45], 2, v5
  v_cmp_le_i32 s[46:47], 3, v5
  v_cndmask_b32 v80, v12, v7, s[40:41]
  v_cndmask_b32 v81, v12, v7, s[42:43]
  v_cndmask_b32 v82, v12, v7, s[44:45]
  v_cndmask_b32 v83, v12, v7, s[46:47]
  v_cmp_le_i32 s[40:41], 8, v5
  v_cmp_le_i32 s[42:43], 9, v5
  v_cmp_le_i32 s[44:45], 10, v5
  v_cmp_le_i32 s[46:47], 11, v5
  v_cndmask_b32 v84, v12, v7, s[40:41]
  v_cndmask_b32 v85, v12, v7, s[42:43]
  v_cndmask_b32 v86, v12, v7, s[44:45]
  v_cndmask_b32 v87, v12, v7, s[46:47]
  v_cmp_le_i32 s[40:41], 16, v5
  v_cmp_le_i32 s[42:43], 17, v5
  v_cmp_le_i32 s[44:45], 18, v5
  v_cmp_le_i32 s[46:47], 19, v5
  v_cndmask_b32 v88, v12, v7, s[40:41]
  v_cndmask_b32 v89, v12, v7, s[42:43]
  v_cndmask_b32 v90, v12, v7, s[44:45]
  v_cndmask_b32 v91, v12, v7, s[46:47]
  v_cmp_le_i32 s[40:41], 24, v5
  v_cmp_le_i32 s[42:43], 25, v5
  v_cmp_le_i32 s[44:45], 26, v5
  v_cmp_le_i32 s[46:47], 27, v5
  v_cndmask_b32 v92, v12, v7, s[40:41]
  v_cndmask_b32 v93, v12, v7, s[42:43]
  v_cndmask_b32 v94, v12, v7, s[44:45]
  v_cndmask_b32 v95, v12, v7, s[46:47]
  s_lshl_b32 s22, s69, 3
  s_add_u32 s22, s22, 8
  s_lshl_b32 s26, s16, 1
  s_sub_u32 s23, 6, s26
  s_waitcnt vmcnt(20)
  s_barrier
  s_cmp_eq_u32 s23, 0
  s_cbranch_scc1 A_go_157
A_idle_156:
  s_waitcnt vmcnt(16)
  s_barrier
  s_sub_u32 s18, s18, 8192
  s_max_i32 s18, s18, s20
  s_sub_u32 s17, s17, 8192
  s_max_i32 s17, s17, s19
  s_add_u32 s21, s21, 16384
  s_and_b32 s21, s21, 131071
M_kv_158:
  s_cmp_ge_u32 s17, s36
  s_cbranch_scc1 M_kvok_159
  s_mov_b32 s76, 0
  s_mov_b32 s78, 25
  s_mov_b32 s77, 319488
  s_cmp_eq_u32 s68, 1
  s_cmov_b32 s76, 128
  s_cmov_b32 s78, 29
  s_cmov_b32 s77, 81920
  s_cmp_eq_u32 s68, 2
  s_cmov_b32 s76, 768
  s_cmov_b32 s78, 10
  s_cmov_b32 s77, 0
  s_add_u32 s76, s76, s67
  s_mov_b32 s71, 0
  s_branch M_sg_161
M_sw_160:
  s_sleep 8
  s_add_u32 s71, s71, 1
  s_cmp_gt_u32 s71, 262144
  s_cbranch_scc1 M_exit
M_sg_161:
  s_mov_b32 s79, 0
  s_atomic_or s79, s[72:73], s76 glc
  s_waitcnt lgkmcnt(0)
  s_cmp_lt_u32 s79, s78
  s_cbranch_scc1 M_sw_160
  s_add_u32 s36, s77, s19
  s_add_u32 s68, s68, 1
  s_branch M_kv_158
M_kvok_159:
  s_mov_b32 m0, s21
  s_nop 0
  buffer_load_dwordx4 v3, s[4:7], s18 offen offset:0 sc1 lds
  buffer_load_dwordx4 v3, s[4:7], s18 offen offset:1024 sc1 lds
  s_add_u32 m0, s21, 8192
  s_nop 0
  buffer_load_dwordx4 v3, s[4:7], s17 offen offset:0 sc1 lds
  buffer_load_dwordx4 v3, s[4:7], s17 offen offset:1024 sc1 lds
  v_add_u32 v4, 16384, v4
  v_and_b32 v4, 131071, v4
  s_sub_u32 s22, s22, 1
  s_sub_u32 s23, s23, 1
  s_cmp_lg_u32 s23, 0
  s_cbranch_scc1 A_idle_156
A_go_157:
  ds_read_b128 a[224:227], v4 offset:0
  ds_read_b128 a[228:231], v4 offset:2048
  ds_read_b128 a[232:235], v4 offset:4096
  ds_read_b128 a[236:239], v4 offset:6144
  ds_read_b128 a[240:243], v4 offset:1024
  ds_read_b128 a[244:247], v4 offset:3072
  ds_read_b128 a[248:251], v4 offset:5120
  ds_read_b128 a[252:255], v4 offset:7168
  ds_read_b128 a[192:195], v4 offset:8192
  ds_read_b128 a[196:199], v4 offset:9216
  ds_read_b128 a[200:203], v4 offset:10240
  ds_read_b128 a[204:207], v4 offset:11264
  ds_read_b128 a[208:211], v4 offset:12288
  ds_read_b128 a[212:215], v4 offset:13312
  ds_read_b128 a[216:219], v4 offset:14336
  ds_read_b128 a[220:223], v4 offset:15360
  v_add_u32 v4, 16384, v4
  v_and_b32 v4, 131071, v4
  s_waitcnt lgkmcnt(8)
.p2align 6
A_top_162:
  s_waitcnt lgkmcnt(7)
  v_mfma_f32_32x32x16_bf16 v[32:47], a[192:195], a[128:131], v[64:79]
  s_waitcnt lgkmcnt(6)
  v_exp_f32 v54, v54
  v_add_f32 v11, v11, v53
  v_cvt_pk_bf16_f32 v106, v52, v53
  v_mfma_f32_32x32x16_bf16 v[32:47], a[196:199], a[132:135], v[32:47]
  s_waitcnt lgkmcnt(4)
  v_exp_f32 v55, v55
  v_add_f32 v10, v10, v54
  v_mfma_f32_32x32x16_bf16 v[32:47], a[200:203], a[136:139], v[32:47]
  v_exp_f32 v56, v56
  v_add_f32 v11, v11, v55
  v_cvt_pk_bf16_f32 v107, v54, v55
  v_mfma_f32_32x32x16_bf16 v[32:47], a[204:207], a[140:143], v[32:47]
  s_waitcnt lgkmcnt(2)
  v_exp_f32 v57, v57
  v_add_f32 v10, v10, v56
  v_mfma_f32_32x32x16_bf16 v[32:47], a[208:211], a[144:147], v[32:47]
  v_exp_f32 v58, v58
  v_add_f32 v11, v11, v57
  v_cvt_pk_bf16_f32 v108, v56, v57
  v_mfma_f32_32x32x16_bf16 v[32:47], a[212:215], a[148:151], v[32:47]
  s_waitcnt lgkmcnt(0)
  v_exp_f32 v59, v59
  v_add_f32 v10, v10, v58
  v_mfma_f32_32x32x16_bf16 v[32:47], a[216:219], a[152:155], v[32:47]
  v_exp_f32 v60, v60
  v_add_f32 v11, v11, v59
  v_cvt_pk_bf16_f32 v109, v58, v59
  v_mfma_f32_32x32x16_bf16 v[32:47], a[220:223], a[156:159], v[32:47]
  s_waitcnt vmcnt(16)
  s_barrier
  v_exp_f32 v61, v61
  v_add_f32 v10, v10, v60
  v_mfma_f32_32x32x16_bf16 a[64:79], a[224:227], v[104:107], a[64:79]
  ds_read_b128 a[224:227], v4 offset:0
  v_exp_f32 v62, v62
  v_add_f32 v11, v11, v61
  v_cvt_pk_bf16_f32 v110, v60, v61
  v_mfma_f32_32x32x16_bf16 a[80:95], a[228:231], v[104:107], a[80:95]
  s_sub_u32 s18, s18, 8192
  ds_read_b128 a[228:231], v4 offset:2048
  v_exp_f32 v63, v63
  v_add_f32 v10, v10, v62
  v_mfma_f32_32x32x16_bf16 a[96:111], a[232:235], v[104:107], a[96:111]
  s_max_i32 s18, s18, s20
  ds_read_b128 a[232:235], v4 offset:4096
  v_exp_f32 v32, v32
  v_add_f32 v11, v11, v63
  v_cvt_pk_bf16_f32 v111, v62, v63
  v_mfma_f32_32x32x16_bf16 a[112:127], a[236:239], v[104:107], a[112:127]
  s_sub_u32 s17, s17, 8192
  ds_read_b128 a[236:239], v4 offset:6144
  v_exp_f32 v33, v33
  v_add_f32 v8, v8, v32
  v_mfma_f32_32x32x16_bf16 a[64:79], a[240:243], v[108:111], a[64:79]
  s_max_i32 s17, s17, s19
  ds_read_b128 a[240:243], v4 offset:1024
  v_exp_f32 v34, v34
  v_add_f32 v9, v9, v33
  v_cvt_pk_bf16_f32 v96, v32, v33
  v_mfma_f32_32x32x16_bf16 a[80:95], a[244:247], v[108:111], a[80:95]
  s_add_u32 s21, s21, 16384
  ds_read_b128 a[244:247], v4 offset:3072
  v_exp_f32 v35, v35
  v_add_f32 v8, v8, v34
  v_mfma_f32_32x32x16_bf16 a[96:111], a[248:251], v[108:111], a[96:111]
  s_and_b32 s21, s21, 131071
  ds_read_b128 a[248:251], v4 offset:5120
  v_exp_f32 v36, v36
  v_add_f32 v9, v9, v35
  v_cvt_pk_bf16_f32 v97, v34, v35
  v_mfma_f32_32x32x16_bf16 a[112:127], a[252:255], v[108:111], a[112:127]
  ds_read_b128 a[252:255], v4 offset:7168
  v_exp_f32 v37, v37
  v_add_f32 v8, v8, v36
  v_mfma_f32_32x32x16_bf16 v[48:63], a[192:195], a[160:163], v[80:95]
  s_add_u32 s23, s23, 1
  ds_read_b128 a[192:195], v4 offset:8192
  v_exp_f32 v38, v38
  v_add_f32 v9, v9, v37
  v_cvt_pk_bf16_f32 v98, v36, v37
  v_mfma_f32_32x32x16_bf16 v[48:63], a[196:199], a[164:167], v[48:63]
  s_sub_u32 s22, s22, 1
  ds_read_b128 a[196:199], v4 offset:9216
  v_exp_f32 v39, v39
  v_add_f32 v8, v8, v38
  v_mfma_f32_32x32x16_bf16 v[48:63], a[200:203], a[168:171], v[48:63]
  s_cmp_lt_u32 s23, 3
  ds_read_b128 a[200:203], v4 offset:10240
  v_exp_f32 v40, v40
  v_add_f32 v9, v9, v39
  v_cvt_pk_bf16_f32 v99, v38, v39
  v_mfma_f32_32x32x16_bf16 v[48:63], a[204:207], a[172:175], v[48:63]
  s_cbranch_scc1 A_upd_163
A_back_164:
  ds_read_b128 a[204:207], v4 offset:11264
  v_exp_f32 v41, v41
  v_add_f32 v8, v8, v40
  v_mfma_f32_32x32x16_bf16 v[48:63], a[208:211], a[176:179], v[48:63]
  s_cmp_lt_u32 s17, s36
  ds_read_b128 a[208:211], v4 offset:12288
  v_exp_f32 v42, v42
  v_add_f32 v9, v9, v41
  v_cvt_pk_bf16_f32 v100, v40, v41
  v_mfma_f32_32x32x16_bf16 v[48:63], a[212:215], a[180:183], v[48:63]
  s_cbranch_scc1 A_kvw_166
A_kvb_167:
  ds_read_b128 a[212:215], v4 offset:13312
  v_exp_f32 v43, v43
  v_add_f32 v8, v8, v42
  v_mfma_f32_32x32x16_bf16 v[48:63], a[216:219], a[184:187], v[48:63]
  s_mov_b32 m0, s21
  ds_read_b128 a[216:219], v4 offset:14336
  v_exp_f32 v44, v44
  v_add_f32 v9, v9, v43
  v_cvt_pk_bf16_f32 v101, v42, v43
  v_mfma_f32_32x32x16_bf16 v[48:63], a[220:223], a[188:191], v[48:63]
  s_waitcnt lgkmcnt(13)
  ds_read_b128 a[220:223], v4 offset:15360
  v_exp_f32 v45, v45
  v_add_f32 v8, v8, v44
  v_mfma_f32_32x32x16_bf16 a[0:15], a[224:227], v[96:99], a[0:15]
  buffer_load_dwordx4 v3, s[4:7], s18 offen offset:0 sc1 lds
  v_exp_f32 v46, v46
  v_add_f32 v9, v9, v45
  v_cvt_pk_bf16_f32 v102, v44, v45
  v_mfma_f32_32x32x16_bf16 a[16:31], a[228:231], v[96:99], a[16:31]
  s_waitcnt lgkmcnt(12)
  v_exp_f32 v47, v47
  v_add_f32 v8, v8, v46
  v_add_u32 v4, 16384, v4
  v_mfma_f32_32x32x16_bf16 a[32:47], a[232:235], v[96:99], a[32:47]
  buffer_load_dwordx4 v3, s[4:7], s18 offen offset:1024 sc1 lds
  v_exp_f32 v48, v48
  v_add_f32 v9, v9, v47
  v_cvt_pk_bf16_f32 v103, v46, v47
  v_mfma_f32_32x32x16_bf16 a[48:63], a[236:239], v[96:99], a[48:63]
  s_waitcnt lgkmcnt(10)
  s_add_u32 m0, s21, 8192
  v_exp_f32 v49, v49
  v_add_f32 v10, v10, v48
  v_and_b32 v4, 131071, v4
  v_mfma_f32_32x32x16_bf16 a[0:15], a[240:243], v[100:103], a[0:15]
  buffer_load_dwordx4 v3, s[4:7], s17 offen offset:0 sc1 lds
  v_exp_f32 v50, v50
  v_add_f32 v11, v11, v49
  v_cvt_pk_bf16_f32 v104, v48, v49
  v_mfma_f32_32x32x16_bf16 a[16:31], a[244:247], v[100:103], a[16:31]
  s_waitcnt lgkmcnt(8)
  s_cmp_lg_u32 s22, 0
  v_exp_f32 v51, v51
  v_add_f32 v10, v10, v50
  v_mfma_f32_32x32x16_bf16 a[32:47], a[248:251], v[100:103], a[32:47]
  buffer_load_dwordx4 v3, s[4:7], s17 offen offset:1024 sc1 lds
  v_exp_f32 v52, v52
  v_add_f32 v11, v11, v51
  v_cvt_pk_bf16_f32 v105, v50, v51
  v_mfma_f32_32x32x16_bf16 a[48:63], a[252:255], v[100:103], a[48:63]
  v_exp_f32 v53, v53
  v_add_f32 v10, v10, v52
  s_cbranch_scc1 A_top_162
  v_exp_f32 v54, v54
  v_add_f32 v11, v11, v53
  v_cvt_pk_bf16_f32 v106, v52, v53
  v_exp_f32 v55, v55
  v_add_f32 v10, v10, v54
  v_exp_f32 v56, v56
  v_add_f32 v11, v11, v55
  v_cvt_pk_bf16_f32 v107, v54, v55
  v_exp_f32 v57, v57
  v_add_f32 v10, v10, v56
  v_exp_f32 v58, v58
  v_add_f32 v11, v11, v57
  v_cvt_pk_bf16_f32 v108, v56, v57
  v_exp_f32 v59, v59
  v_add_f32 v10, v10, v58
  v_exp_f32 v60, v60
  v_add_f32 v11, v11, v59
  v_cvt_pk_bf16_f32 v109, v58, v59
  v_exp_f32 v61, v61
  v_add_f32 v10, v10, v60
  v_exp_f32 v62, v62
  v_add_f32 v11, v11, v61
  v_cvt_pk_bf16_f32 v110, v60, v61
  v_exp_f32 v63, v63
  v_add_f32 v10, v10, v62
  v_add_f32 v11, v11, v63
  v_cvt_pk_bf16_f32 v111, v62, v63
  s_nop 1
  v_mfma_f32_32x32x16_bf16 a[64:79], a[224:227], v[104:107], a[64:79]
  v_mfma_f32_32x32x16_bf16 a[80:95], a[228:231], v[104:107], a[80:95]
  v_mfma_f32_32x32x16_bf16 a[96:111], a[232:235], v[104:107], a[96:111]
  v_mfma_f32_32x32x16_bf16 a[112:127], a[236:239], v[104:107], a[112:127]
  v_mfma_f32_32x32x16_bf16 a[64:79], a[240:243], v[108:111], a[64:79]
  v_mfma_f32_32x32x16_bf16 a[80:95], a[244:247], v[108:111], a[80:95]
  v_mfma_f32_32x32x16_bf16 a[96:111], a[248:251], v[108:111], a[96:111]
  v_mfma_f32_32x32x16_bf16 a[112:127], a[252:255], v[108:111], a[112:127]
  v_add_f32 v8, v8, v9
  v_mov_b32 v9, v8
  s_nop 1
  v_permlane32_swap_b32 v8, v9
  s_nop 1
  v_add_f32 v8, v8, v9
  v_add_f32 v10, v10, v11
  v_mov_b32 v11, v10
  s_nop 1
  v_permlane32_swap_b32 v10, v11
  s_nop 1
  v_add_f32 v10, v10, v11
  v_subrev_u32 v12, 0x2f800000, v8
  v_subrev_u32 v13, 0x2f800000, v10
  v_max_u32 v12, v12, v13
  v_cmp_le_u32 vcc, 0x28000000, v12
  s_nop 1
  s_cmp_lg_u64 vcc, 0
  s_cselect_b32 s26, 1, 0
  v_mov_b32 v12, s26
  s_lshl_b32 s26, s16, 2
  s_add_u32 s26, s26, 131072
  v_mov_b32 v13, s26
  ds_write_b32 v13, v12
  v_mov_b32 v14, 131072
  s_waitcnt vmcnt(0) lgkmcnt(0)
  s_barrier
  ds_read_b128 v[16:19], v14
  v_rcp_f32 v8, v8
  v_rcp_f32 v10, v10
  s_waitcnt lgkmcnt(0)
  v_or3_b32 v12, v16, v17, v18
  v_or_b32 v12, v12, v19
  s_nop 0
  v_readfirstlane_b32 s26, v12
  s_nop 1
  s_cmp_gt_u32 s26, s29
  s_cbranch_scc1 A_slow_168
  s_add_u32 s28, s25, 100663296
  v_accvgpr_read_b32 v112, a0
  v_accvgpr_read_b32 v113, a1
  v_accvgpr_read_b32 v114, a2
  v_accvgpr_read_b32 v115, a3
  v_accvgpr_read_b32 v116, a4
  v_accvgpr_read_b32 v117, a5
  v_accvgpr_read_b32 v118, a6
  v_accvgpr_read_b32 v119, a7
  v_pk_mul_f32 v[112:113], v[112:113], v[8:9] op_sel_hi:[1,0]
  v_pk_mul_f32 v[114:115], v[114:115], v[8:9] op_sel_hi:[1,0]
  v_pk_mul_f32 v[116:117], v[116:117], v[8:9] op_sel_hi:[1,0]
  v_pk_mul_f32 v[118:119], v[118:119], v[8:9] op_sel_hi:[1,0]
  v_cvt_pk_bf16_f32 v120, v112, v113
  v_cvt_pk_bf16_f32 v121, v114, v115
  v_cvt_pk_bf16_f32 v122, v116, v117
  v_cvt_pk_bf16_f32 v123, v118, v119
  buffer_store_dwordx4 v[120:123], v2, s[4:7], s28 offen offset:0 sc1
  v_accvgpr_read_b32 v124, a8
  v_accvgpr_read_b32 v125, a9
  v_accvgpr_read_b32 v126, a10
  v_accvgpr_read_b32 v127, a11
  v_accvgpr_read_b32 v128, a12
  v_accvgpr_read_b32 v129, a13
  v_accvgpr_read_b32 v130, a14
  v_accvgpr_read_b32 v131, a15
  v_pk_mul_f32 v[124:125], v[124:125], v[8:9] op_sel_hi:[1,0]
  v_pk_mul_f32 v[126:127], v[126:127], v[8:9] op_sel_hi:[1,0]
  v_pk_mul_f32 v[128:129], v[128:129], v[8:9] op_sel_hi:[1,0]
  v_pk_mul_f32 v[130:131], v[130:131], v[8:9] op_sel_hi:[1,0]
  v_cvt_pk_bf16_f32 v132, v124, v125
  v_cvt_pk_bf16_f32 v133, v126, v127
  v_cvt_pk_bf16_f32 v134, v128, v129
  v_cvt_pk_bf16_f32 v135, v130, v131
  buffer_store_dwordx4 v[132:135], v2, s[4:7], s28 offen offset:1024 sc1
  v_accvgpr_read_b32 v136, a16
  v_accvgpr_read_b32 v137, a17
  v_accvgpr_read_b32 v138, a18
  v_accvgpr_read_b32 v139, a19
  v_accvgpr_read_b32 v140, a20
  v_accvgpr_read_b32 v141, a21
  v_accvgpr_read_b32 v142, a22
  v_accvgpr_read_b32 v143, a23
  v_pk_mul_f32 v[136:137], v[136:137], v[8:9] op_sel_hi:[1,0]
  v_pk_mul_f32 v[138:139], v[138:139], v[8:9] op_sel_hi:[1,0]
  v_pk_mul_f32 v[140:141], v[140:141], v[8:9] op_sel_hi:[1,0]
  v_pk_mul_f32 v[142:143], v[142:143], v[8:9] op_sel_hi:[1,0]
  v_cvt_pk_bf16_f32 v144, v136, v137
  v_cvt_pk_bf16_f32 v145, v138, v139
  v_cvt_pk_bf16_f32 v146, v140, v141
  v_cvt_pk_bf16_f32 v147, v142, v143
  buffer_store_dwordx4 v[144:147], v2, s[4:7], s28 offen offset:2048 sc1
  v_accvgpr_read_b32 v148, a24
  v_accvgpr_read_b32 v149, a25
  v_accvgpr_read_b32 v150, a26
  v_accvgpr_read_b32 v151, a27
  v_accvgpr_read_b32 v152, a28
  v_accvgpr_read_b32 v153, a29
  v_accvgpr_read_b32 v154, a30
  v_accvgpr_read_b32 v155, a31
  v_pk_mul_f32 v[148:149], v[148:149], v[8:9] op_sel_hi:[1,0]
  v_pk_mul_f32 v[150:151], v[150:151], v[8:9] op_sel_hi:[1,0]
  v_pk_mul_f32 v[152:153], v[152:153], v[8:9] op_sel_hi:[1,0]
  v_pk_mul_f32 v[154:155], v[154:155], v[8:9] op_sel_hi:[1,0]
  v_cvt_pk_bf16_f32 v156, v148, v149
  v_cvt_pk_bf16_f32 v157, v150, v151
  v_cvt_pk_bf16_f32 v158, v152, v153
  v_cvt_pk_bf16_f32 v159, v154, v155
  buffer_store_dwordx4 v[156:159], v2, s[4:7], s28 offen offset:3072 sc1
  s_add_u32 s28, s25, 100667392
  v_accvgpr_read_b32 v112, a32
  v_accvgpr_read_b32 v113, a33
  v_accvgpr_read_b32 v114, a34
  v_accvgpr_read_b32 v115, a35
  v_accvgpr_read_b32 v116, a36
  v_accvgpr_read_b32 v117, a37
  v_accvgpr_read_b32 v118, a38
  v_accvgpr_read_b32 v119, a39
  v_pk_mul_f32 v[112:113], v[112:113], v[8:9] op_sel_hi:[1,0]
  v_pk_mul_f32 v[114:115], v[114:115], v[8:9] op_sel_hi:[1,0]
  v_pk_mul_f32 v[116:117], v[116:117], v[8:9] op_sel_hi:[1,0]
  v_pk_mul_f32 v[118:119], v[118:119], v[8:9] op_sel_hi:[1,0]
  v_cvt_pk_bf16_f32 v120, v112, v113
  v_cvt_pk_bf16_f32 v121, v114, v115
  v_cvt_pk_bf16_f32 v122, v116, v117
  v_cvt_pk_bf16_f32 v123, v118, v119
  buffer_store_dwordx4 v[120:123], v2, s[4:7], s28 offen offset:0 sc1
  v_accvgpr_read_b32 v124, a40
  v_accvgpr_read_b32 v125, a41
  v_accvgpr_read_b32 v126, a42
  v_accvgpr_read_b32 v127, a43
  v_accvgpr_read_b32 v128, a44
  v_accvgpr_read_b32 v129, a45
  v_accvgpr_read_b32 v130, a46
  v_accvgpr_read_b32 v131, a47
  v_pk_mul_f32 v[124:125], v[124:125], v[8:9] op_sel_hi:[1,0]
  v_pk_mul_f32 v[126:127], v[126:127], v[8:9] op_sel_hi:[1,0]
  v_pk_mul_f32 v[128:129], v[128:129], v[8:9] op_sel_hi:[1,0]
  v_pk_mul_f32 v[130:131], v[130:131], v[8:9] op_sel_hi:[1,0]
  v_cvt_pk_bf16_f32 v132, v124, v125
  v_cvt_pk_bf16_f32 v133, v126, v127
  v_cvt_pk_bf16_f32 v134, v128, v129
  v_cvt_pk_bf16_f32 v135, v130, v131
  buffer_store_dwordx4 v[132:135], v2, s[4:7], s28 offen offset:1024 sc1
  v_accvgpr_read_b32 v136, a48
  v_accvgpr_read_b32 v137, a49
  v_accvgpr_read_b32 v138, a50
  v_accvgpr_read_b32 v139, a51
  v_accvgpr_read_b32 v140, a52
  v_accvgpr_read_b32 v141, a53
  v_accvgpr_read_b32 v142, a54
  v_accvgpr_read_b32 v143, a55
  v_pk_mul_f32 v[136:137], v[136:137], v[8:9] op_sel_hi:[1,0]
  v_pk_mul_f32 v[138:139], v[138:139], v[8:9] op_sel_hi:[1,0]
  v_pk_mul_f32 v[140:141], v[140:141], v[8:9] op_sel_hi:[1,0]
  v_pk_mul_f32 v[142:143], v[142:143], v[8:9] op_sel_hi:[1,0]
  v_cvt_pk_bf16_f32 v144, v136, v137
  v_cvt_pk_bf16_f32 v145, v138, v139
  v_cvt_pk_bf16_f32 v146, v140, v141
  v_cvt_pk_bf16_f32 v147, v142, v143
  buffer_store_dwordx4 v[144:147], v2, s[4:7], s28 offen offset:2048 sc1
  v_accvgpr_read_b32 v148, a56
  v_accvgpr_read_b32 v149, a57
  v_accvgpr_read_b32 v150, a58
  v_accvgpr_read_b32 v151, a59
  v_accvgpr_read_b32 v152, a60
  v_accvgpr_read_b32 v153, a61
  v_accvgpr_read_b32 v154, a62
  v_accvgpr_read_b32 v155, a63
  v_pk_mul_f32 v[148:149], v[148:149], v[8:9] op_sel_hi:[1,0]
  v_pk_mul_f32 v[150:151], v[150:151], v[8:9] op_sel_hi:[1,0]
  v_pk_mul_f32 v[152:153], v[152:153], v[8:9] op_sel_hi:[1,0]
  v_pk_mul_f32 v[154:155], v[154:155], v[8:9] op_sel_hi:[1,0]
  v_cvt_pk_bf16_f32 v156, v148, v149
  v_cvt_pk_bf16_f32 v157, v150, v151
  v_cvt_pk_bf16_f32 v158, v152, v153
  v_cvt_pk_bf16_f32 v159, v154, v155
  buffer_store_dwordx4 v[156:159], v2, s[4:7], s28 offen offset:3072 sc1
  s_add_u32 s28, s25, 100671488
  v_accvgpr_read_b32 v112, a64
  v_accvgpr_read_b32 v113, a65
  v_accvgpr_read_b32 v114, a66
  v_accvgpr_read_b32 v115, a67
  v_accvgpr_read_b32 v116, a68
  v_accvgpr_read_b32 v117, a69
  v_accvgpr_read_b32 v118, a70
  v_accvgpr_read_b32 v119, a71
  v_pk_mul_f32 v[112:113], v[112:113], v[10:11] op_sel_hi:[1,0]
  v_pk_mul_f32 v[114:115], v[114:115], v[10:11] op_sel_hi:[1,0]
  v_pk_mul_f32 v[116:117], v[116:117], v[10:11] op_sel_hi:[1,0]
  v_pk_mul_f32 v[118:119], v[118:119], v[10:11] op_sel_hi:[1,0]
  v_cvt_pk_bf16_f32 v120, v112, v113
  v_cvt_pk_bf16_f32 v121, v114, v115
  v_cvt_pk_bf16_f32 v122, v116, v117
  v_cvt_pk_bf16_f32 v123, v118, v119
  buffer_store_dwordx4 v[120:123], v2, s[4:7], s28 offen offset:0 sc1
  v_accvgpr_read_b32 v124, a72
  v_accvgpr_read_b32 v125, a73
  v_accvgpr_read_b32 v126, a74
  v_accvgpr_read_b32 v127, a75
  v_accvgpr_read_b32 v128, a76
  v_accvgpr_read_b32 v129, a77
  v_accvgpr_read_b32 v130, a78
  v_accvgpr_read_b32 v131, a79
  v_pk_mul_f32 v[124:125], v[124:125], v[10:11] op_sel_hi:[1,0]
  v_pk_mul_f32 v[126:127], v[126:127], v[10:11] op_sel_hi:[1,0]
  v_pk_mul_f32 v[128:129], v[128:129], v[10:11] op_sel_hi:[1,0]
  v_pk_mul_f32 v[130:131], v[130:131], v[10:11] op_sel_hi:[1,0]
  v_cvt_pk_bf16_f32 v132, v124, v125
  v_cvt_pk_bf16_f32 v133, v126, v127
  v_cvt_pk_bf16_f32 v134, v128, v129
  v_cvt_pk_bf16_f32 v135, v130, v131
  buffer_store_dwordx4 v[132:135], v2, s[4:7], s28 offen offset:1024 sc1
  v_accvgpr_read_b32 v136, a80
  v_accvgpr_read_b32 v137, a81
  v_accvgpr_read_b32 v138, a82
  v_accvgpr_read_b32 v139, a83
  v_accvgpr_read_b32 v140, a84
  v_accvgpr_read_b32 v141, a85
  v_accvgpr_read_b32 v142, a86
  v_accvgpr_read_b32 v143, a87
  v_pk_mul_f32 v[136:137], v[136:137], v[10:11] op_sel_hi:[1,0]
  v_pk_mul_f32 v[138:139], v[138:139], v[10:11] op_sel_hi:[1,0]
  v_pk_mul_f32 v[140:141], v[140:141], v[10:11] op_sel_hi:[1,0]
  v_pk_mul_f32 v[142:143], v[142:143], v[10:11] op_sel_hi:[1,0]
  v_cvt_pk_bf16_f32 v144, v136, v137
  v_cvt_pk_bf16_f32 v145, v138, v139
  v_cvt_pk_bf16_f32 v146, v140, v141
  v_cvt_pk_bf16_f32 v147, v142, v143
  buffer_store_dwordx4 v[144:147], v2, s[4:7], s28 offen offset:2048 sc1
  v_accvgpr_read_b32 v148, a88
  v_accvgpr_read_b32 v149, a89
  v_accvgpr_read_b32 v150, a90
  v_accvgpr_read_b32 v151, a91
  v_accvgpr_read_b32 v152, a92
  v_accvgpr_read_b32 v153, a93
  v_accvgpr_read_b32 v154, a94
  v_accvgpr_read_b32 v155, a95
  v_pk_mul_f32 v[148:149], v[148:149], v[10:11] op_sel_hi:[1,0]
  v_pk_mul_f32 v[150:151], v[150:151], v[10:11] op_sel_hi:[1,0]
  v_pk_mul_f32 v[152:153], v[152:153], v[10:11] op_sel_hi:[1,0]
  v_pk_mul_f32 v[154:155], v[154:155], v[10:11] op_sel_hi:[1,0]
  v_cvt_pk_bf16_f32 v156, v148, v149
  v_cvt_pk_bf16_f32 v157, v150, v151
  v_cvt_pk_bf16_f32 v158, v152, v153
  v_cvt_pk_bf16_f32 v159, v154, v155
  buffer_store_dwordx4 v[156:159], v2, s[4:7], s28 offen offset:3072 sc1
  s_add_u32 s28, s25, 100675584
  v_accvgpr_read_b32 v112, a96
  v_accvgpr_read_b32 v113, a97
  v_accvgpr_read_b32 v114, a98
  v_accvgpr_read_b32 v115, a99
  v_accvgpr_read_b32 v116, a100
  v_accvgpr_read_b32 v117, a101
  v_accvgpr_read_b32 v118, a102
  v_accvgpr_read_b32 v119, a103
  v_pk_mul_f32 v[112:113], v[112:113], v[10:11] op_sel_hi:[1,0]
  v_pk_mul_f32 v[114:115], v[114:115], v[10:11] op_sel_hi:[1,0]
  v_pk_mul_f32 v[116:117], v[116:117], v[10:11] op_sel_hi:[1,0]
  v_pk_mul_f32 v[118:119], v[118:119], v[10:11] op_sel_hi:[1,0]
  v_cvt_pk_bf16_f32 v120, v112, v113
  v_cvt_pk_bf16_f32 v121, v114, v115
  v_cvt_pk_bf16_f32 v122, v116, v117
  v_cvt_pk_bf16_f32 v123, v118, v119
  buffer_store_dwordx4 v[120:123], v2, s[4:7], s28 offen offset:0 sc1
  v_accvgpr_read_b32 v124, a104
  v_accvgpr_read_b32 v125, a105
  v_accvgpr_read_b32 v126, a106
  v_accvgpr_read_b32 v127, a107
  v_accvgpr_read_b32 v128, a108
  v_accvgpr_read_b32 v129, a109
  v_accvgpr_read_b32 v130, a110
  v_accvgpr_read_b32 v131, a111
  v_pk_mul_f32 v[124:125], v[124:125], v[10:11] op_sel_hi:[1,0]
  v_pk_mul_f32 v[126:127], v[126:127], v[10:11] op_sel_hi:[1,0]
  v_pk_mul_f32 v[128:129], v[128:129], v[10:11] op_sel_hi:[1,0]
  v_pk_mul_f32 v[130:131], v[130:131], v[10:11] op_sel_hi:[1,0]
  v_cvt_pk_bf16_f32 v132, v124, v125
  v_cvt_pk_bf16_f32 v133, v126, v127
  v_cvt_pk_bf16_f32 v134, v128, v129
  v_cvt_pk_bf16_f32 v135, v130, v131
  buffer_store_dwordx4 v[132:135], v2, s[4:7], s28 offen offset:1024 sc1
  v_accvgpr_read_b32 v136, a112
  v_accvgpr_read_b32 v137, a113
  v_accvgpr_read_b32 v138, a114
  v_accvgpr_read_b32 v139, a115
  v_accvgpr_read_b32 v140, a116
  v_accvgpr_read_b32 v141, a117
  v_accvgpr_read_b32 v142, a118
  v_accvgpr_read_b32 v143, a119
  v_pk_mul_f32 v[136:137], v[136:137], v[10:11] op_sel_hi:[1,0]
  v_pk_mul_f32 v[138:139], v[138:139], v[10:11] op_sel_hi:[1,0]
  v_pk_mul_f32 v[140:141], v[140:141], v[10:11] op_sel_hi:[1,0]
  v_pk_mul_f32 v[142:143], v[142:143], v[10:11] op_sel_hi:[1,0]
  v_cvt_pk_bf16_f32 v144, v136, v137
  v_cvt_pk_bf16_f32 v145, v138, v139
  v_cvt_pk_bf16_f32 v146, v140, v141
  v_cvt_pk_bf16_f32 v147, v142, v143
  buffer_store_dwordx4 v[144:147], v2, s[4:7], s28 offen offset:2048 sc1
  v_accvgpr_read_b32 v148, a120
  v_accvgpr_read_b32 v149, a121
  v_accvgpr_read_b32 v150, a122
  v_accvgpr_read_b32 v151, a123
  v_accvgpr_read_b32 v152, a124
  v_accvgpr_read_b32 v153, a125
  v_accvgpr_read_b32 v154, a126
  v_accvgpr_read_b32 v155, a127
  v_pk_mul_f32 v[148:149], v[148:149], v[10:11] op_sel_hi:[1,0]
  v_pk_mul_f32 v[150:151], v[150:151], v[10:11] op_sel_hi:[1,0]
  v_pk_mul_f32 v[152:153], v[152:153], v[10:11] op_sel_hi:[1,0]
  v_pk_mul_f32 v[154:155], v[154:155], v[10:11] op_sel_hi:[1,0]
  v_cvt_pk_bf16_f32 v156, v148, v149
  v_cvt_pk_bf16_f32 v157, v150, v151
  v_cvt_pk_bf16_f32 v158, v152, v153
  v_cvt_pk_bf16_f32 v159, v154, v155
  buffer_store_dwordx4 v[156:159], v2, s[4:7], s28 offen offset:3072 sc1
  s_branch A_out_165
A_kvw_166:
M_kv_169:
  s_cmp_ge_u32 s17, s36
  s_cbranch_scc1 M_kvok_170
  s_mov_b32 s76, 0
  s_mov_b32 s78, 25
  s_mov_b32 s77, 319488
  s_cmp_eq_u32 s68, 1
  s_cmov_b32 s76, 128
  s_cmov_b32 s78, 29
  s_cmov_b32 s77, 81920
  s_cmp_eq_u32 s68, 2
  s_cmov_b32 s76, 768
  s_cmov_b32 s78, 10
  s_cmov_b32 s77, 0
  s_add_u32 s76, s76, s67
  s_mov_b32 s71, 0
  s_branch M_sg_172
M_sw_171:
  s_sleep 8
  s_add_u32 s71, s71, 1
  s_cmp_gt_u32 s71, 262144
  s_cbranch_scc1 M_exit
M_sg_172:
  s_mov_b32 s79, 0
  s_atomic_or s79, s[72:73], s76 glc
  s_waitcnt lgkmcnt(0)
  s_cmp_lt_u32 s79, s78
  s_cbranch_scc1 M_sw_171
  s_add_u32 s36, s77, s19
  s_add_u32 s68, s68, 1
  s_branch M_kv_169
M_kvok_170:
  s_branch A_kvb_167
A_upd_163:
  s_cmp_eq_u32 s23, 2
  s_cbranch_scc1 A_upd2_173
  v_mov_b32 v12, s24
  v_cmp_le_i32 s[40:41], 0, v5
  v_cmp_le_i32 s[42:43], 1, v5
  v_cmp_le_i32 s[44:45], 2, v5
  v_cmp_le_i32 s[46:47], 3, v5
  v_cndmask_b32 v64, v12, v6, s[40:41]
  v_cndmask_b32 v65, v12, v6, s[42:43]
  v_cndmask_b32 v66, v12, v6, s[44:45]
  v_cndmask_b32 v67, v12, v6, s[46:47]
  v_cmp_le_i32 s[40:41], 8, v5
  v_cmp_le_i32 s[42:43], 9, v5
  v_cmp_le_i32 s[44:45], 10, v5
  v_cmp_le_i32 s[46:47], 11, v5
  v_cndmask_b32 v68, v12, v6, s[40:41]
  v_cndmask_b32 v69, v12, v6, s[42:43]
  v_cndmask_b32 v70, v12, v6, s[44:45]
  v_cndmask_b32 v71, v12, v6, s[46:47]
  v_cmp_le_i32 s[40:41], 16, v5
  v_cmp_le_i32 s[42:43], 17, v5
  v_cmp_le_i32 s[44:45], 18, v5
  v_cmp_le_i32 s[46:47], 19, v5
  v_cndmask_b32 v72, v12, v6, s[40:41]
  v_cndmask_b32 v73, v12, v6, s[42:43]
  v_cndmask_b32 v74, v12, v6, s[44:45]
  v_cndmask_b32 v75, v12, v6, s[46:47]
  v_cmp_le_i32 s[40:41], 24, v5
  v_cmp_le_i32 s[42:43], 25, v5
  v_cmp_le_i32 s[44:45], 26, v5
  v_cmp_le_i32 s[46:47], 27, v5
  v_cndmask_b32 v76, v12, v6, s[40:41]
  v_cndmask_b32 v77, v12, v6, s[42:43]
  v_cndmask_b32 v78, v12, v6, s[44:45]
  v_cndmask_b32 v79, v12, v6, s[46:47]
  v_mov_b32 v80, v7
  v_mov_b32 v81, v7
  v_mov_b32 v82, v7
  v_mov_b32 v83, v7
  v_mov_b32 v84, v7
  v_mov_b32 v85, v7
  v_mov_b32 v86, v7
  v_mov_b32 v87, v7
  v_mov_b32 v88, v7
  v_mov_b32 v89, v7
  v_mov_b32 v90, v7
  v_mov_b32 v91, v7
  v_mov_b32 v92, v7
  v_mov_b32 v93, v7
  v_mov_b32 v94, v7
  v_mov_b32 v95, v7
  s_branch A_back_164
A_upd2_173:
  v_mov_b32 v64, v6
  v_mov_b32 v65, v6
  v_mov_b32 v66, v6
  v_mov_b32 v67, v6
  v_mov_b32 v68, v6
  v_mov_b32 v69, v6
  v_mov_b32 v70, v6
  v_mov_b32 v71, v6
  v_mov_b32 v72, v6
  v_mov_b32 v73, v6
  v_mov_b32 v74, v6
  v_mov_b32 v75, v6
  v_mov_b32 v76, v6
  v_mov_b32 v77, v6
  v_mov_b32 v78, v6
  v_mov_b32 v79, v6
  s_branch A_back_164
A_slow_168:
  s_mov_b32 s29, 1
  v_mov_b32 v64, s24
  v_mov_b32 v65, s24
  v_mov_b32 v66, s24
  v_mov_b32 v67, s24
  v_mov_b32 v68, s24
  v_mov_b32 v69, s24
  v_mov_b32 v70, s24
  v_mov_b32 v71, s24
  v_mov_b32 v72, s24
  v_mov_b32 v73, s24
  v_mov_b32 v74, s24
  v_mov_b32 v75, s24
  v_mov_b32 v76, s24
  v_mov_b32 v77, s24
  v_mov_b32 v78, s24
  v_mov_b32 v79, s24
  v_mov_b32 v12, s24
  v_cmp_le_i32 s[40:41], 0, v5
  v_cmp_le_i32 s[42:43], 1, v5
  v_cmp_le_i32 s[44:45], 2, v5
  v_cmp_le_i32 s[46:47], 3, v5
  v_cndmask_b32 v80, v12, v7, s[40:41]
  v_cndmask_b32 v81, v12, v7, s[42:43]
  v_cndmask_b32 v82, v12, v7, s[44:45]
  v_cndmask_b32 v83, v12, v7, s[46:47]
  v_cmp_le_i32 s[40:41], 8, v5
  v_cmp_le_i32 s[42:43], 9, v5
  v_cmp_le_i32 s[44:45], 10, v5
  v_cmp_le_i32 s[46:47], 11, v5
  v_cndmask_b32 v84, v12, v7, s[40:41]
  v_cndmask_b32 v85, v12, v7, s[42:43]
  v_cndmask_b32 v86, v12, v7, s[44:45]
  v_cndmask_b32 v87, v12, v7, s[46:47]
  v_cmp_le_i32 s[40:41], 16, v5
  v_cmp_le_i32 s[42:43], 17, v5
  v_cmp_le_i32 s[44:45], 18, v5
  v_cmp_le_i32 s[46:47], 19, v5
  v_cndmask_b32 v88, v12, v7, s[40:41]
  v_cndmask_b32 v89, v12, v7, s[42:43]
  v_cndmask_b32 v90, v12, v7, s[44:45]
  v_cndmask_b32 v91, v12, v7, s[46:47]
  v_cmp_le_i32 s[40:41], 24, v5
  v_cmp_le_i32 s[42:43], 25, v5
  v_cmp_le_i32 s[44:45], 26, v5
  v_cmp_le_i32 s[46:47], 27, v5
  v_cndmask_b32 v92, v12, v7, s[40:41]
  v_cndmask_b32 v93, v12, v7, s[42:43]
  v_cndmask_b32 v94, v12, v7, s[44:45]
  v_cndmask_b32 v95, v12, v7, s[46:47]
  v_mov_b32 v8, s24
  v_mov_b32 v10, s24
  s_add_u32 s17, s25, 16785408
  s_mov_b32 s23, 0
A_ml_174:
  s_add_u32 s28, s17, 4096
  buffer_load_dwordx4 a[192:195], v2, s[4:7], s17 offen offset:0 sc1
  buffer_load_dwordx4 a[196:199], v2, s[4:7], s17 offen offset:1024 sc1
  buffer_load_dwordx4 a[200:203], v2, s[4:7], s17 offen offset:2048 sc1
  buffer_load_dwordx4 a[204:207], v2, s[4:7], s17 offen offset:3072 sc1
  buffer_load_dwordx4 a[208:211], v2, s[4:7], s28 offen offset:0 sc1
  buffer_load_dwordx4 a[212:215], v2, s[4:7], s28 offen offset:1024 sc1
  buffer_load_dwordx4 a[216:219], v2, s[4:7], s28 offen offset:2048 sc1
  buffer_load_dwordx4 a[220:223], v2, s[4:7], s28 offen offset:3072 sc1
  s_waitcnt vmcnt(0)
  v_mfma_f32_32x32x16_bf16 v[32:47], a[192:195], a[128:131], v[64:79]
  v_mfma_f32_32x32x16_bf16 v[32:47], a[196:199], a[132:135], v[32:47]
  v_mfma_f32_32x32x16_bf16 v[32:47], a[200:203], a[136:139], v[32:47]
  v_mfma_f32_32x32x16_bf16 v[32:47], a[204:207], a[140:143], v[32:47]
  v_mfma_f32_32x32x16_bf16 v[32:47], a[208:211], a[144:147], v[32:47]
  v_mfma_f32_32x32x16_bf16 v[32:47], a[212:215], a[148:151], v[32:47]
  v_mfma_f32_32x32x16_bf16 v[32:47], a[216:219], a[152:155], v[32:47]
  v_mfma_f32_32x32x16_bf16 v[32:47], a[220:223], a[156:159], v[32:47]
  v_mfma_f32_32x32x16_bf16 v[48:63], a[192:195], a[160:163], v[80:95]
  v_mfma_f32_32x32x16_bf16 v[48:63], a[196:199], a[164:167], v[48:63]
  v_mfma_f32_32x32x16_bf16 v[48:63], a[200:203], a[168:171], v[48:63]
  v_mfma_f32_32x32x16_bf16 v[48:63], a[204:207], a[172:175], v[48:63]
  v_mfma_f32_32x32x16_bf16 v[48:63], a[208:211], a[176:179], v[48:63]
  v_mfma_f32_32x32x16_bf16 v[48:63], a[212:215], a[180:183], v[48:63]
  v_mfma_f32_32x32x16_bf16 v[48:63], a[216:219], a[184:187], v[48:63]
  v_mfma_f32_32x32x16_bf16 v[48:63], a[220:223], a[188:191], v[48:63]
  s_nop 7
  s_nop 3
  v_max3_f32 v8, v8, v32, v33
  v_max3_f32 v8, v8, v34, v35
  v_max3_f32 v8, v8, v36, v37
  v_max3_f32 v8, v8, v38, v39
  v_max3_f32 v8, v8, v40, v41
  v_max3_f32 v8, v8, v42, v43
  v_max3_f32 v8, v8, v44, v45
  v_max3_f32 v8, v8, v46, v47
  v_max3_f32 v10, v10, v48, v49
  v_max3_f32 v10, v10, v50, v51
  v_max3_f32 v10, v10, v52, v53
  v_max3_f32 v10, v10, v54, v55
  v_max3_f32 v10, v10, v56, v57
  v_max3_f32 v10, v10, v58, v59
  v_max3_f32 v10, v10, v60, v61
  v_max3_f32 v10, v10, v62, v63
  s_add_u32 s23, s23, 1
  s_cmp_lg_u32 s23, 1
  s_cbranch_scc1 A_m2_175
  v_mov_b32 v12, s24
  v_cmp_le_i32 s[40:41], 0, v5
  v_cmp_le_i32 s[42:43], 1, v5
  v_cmp_le_i32 s[44:45], 2, v5
  v_cmp_le_i32 s[46:47], 3, v5
  v_cndmask_b32 v64, v12, v6, s[40:41]
  v_cndmask_b32 v65, v12, v6, s[42:43]
  v_cndmask_b32 v66, v12, v6, s[44:45]
  v_cndmask_b32 v67, v12, v6, s[46:47]
  v_cmp_le_i32 s[40:41], 8, v5
  v_cmp_le_i32 s[42:43], 9, v5
  v_cmp_le_i32 s[44:45], 10, v5
  v_cmp_le_i32 s[46:47], 11, v5
  v_cndmask_b32 v68, v12, v6, s[40:41]
  v_cndmask_b32 v69, v12, v6, s[42:43]
  v_cndmask_b32 v70, v12, v6, s[44:45]
  v_cndmask_b32 v71, v12, v6, s[46:47]
  v_cmp_le_i32 s[40:41], 16, v5
  v_cmp_le_i32 s[42:43], 17, v5
  v_cmp_le_i32 s[44:45], 18, v5
  v_cmp_le_i32 s[46:47], 19, v5
  v_cndmask_b32 v72, v12, v6, s[40:41]
  v_cndmask_b32 v73, v12, v6, s[42:43]
  v_cndmask_b32 v74, v12, v6, s[44:45]
  v_cndmask_b32 v75, v12, v6, s[46:47]
  v_cmp_le_i32 s[40:41], 24, v5
  v_cmp_le_i32 s[42:43], 25, v5
  v_cmp_le_i32 s[44:45], 26, v5
  v_cmp_le_i32 s[46:47], 27, v5
  v_cndmask_b32 v76, v12, v6, s[40:41]
  v_cndmask_b32 v77, v12, v6, s[42:43]
  v_cndmask_b32 v78, v12, v6, s[44:45]
  v_cndmask_b32 v79, v12, v6, s[46:47]
  v_mov_b32 v80, v7
  v_mov_b32 v81, v7
  v_mov_b32 v82, v7
  v_mov_b32 v83, v7
  v_mov_b32 v84, v7
  v_mov_b32 v85, v7
  v_mov_b32 v86, v7
  v_mov_b32 v87, v7
  v_mov_b32 v88, v7
  v_mov_b32 v89, v7
  v_mov_b32 v90, v7
  v_mov_b32 v91, v7
  v_mov_b32 v92, v7
  v_mov_b32 v93, v7
  v_mov_b32 v94, v7
  v_mov_b32 v95, v7
A_m2_175:
  s_cmp_lg_u32 s23, 2
  s_cbranch_scc1 A_m3_176
  v_mov_b32 v64, v6
  v_mov_b32 v65, v6
  v_mov_b32 v66, v6
  v_mov_b32 v67, v6
  v_mov_b32 v68, v6
  v_mov_b32 v69, v6
  v_mov_b32 v70, v6
  v_mov_b32 v71, v6
  v_mov_b32 v72, v6
  v_mov_b32 v73, v6
  v_mov_b32 v74, v6
  v_mov_b32 v75, v6
  v_mov_b32 v76, v6
  v_mov_b32 v77, v6
  v_mov_b32 v78, v6
  v_mov_b32 v79, v6
A_m3_176:
  s_sub_u32 s17, s17, 8192
  s_cmp_ge_i32 s17, s19
  s_cbranch_scc1 A_ml_174
  v_mov_b32 v9, v8
  s_nop 1
  v_permlane32_swap_b32 v8, v9
  s_nop 1
  v_max_f32 v8, v8, v9
  v_sub_f32 v6, 0, v8
  v_mov_b32 v11, v10
  s_nop 1
  v_permlane32_swap_b32 v10, v11
  s_nop 1
  v_max_f32 v10, v10, v11
  v_sub_f32 v7, 0, v10
  s_branch A_again_155
A_out_165:
  s_mov_b32 s69, s55
  s_mov_b32 s70, s56
  s_sub_u32 s52, s52, 1
  s_cmp_lg_u32 s52, 0
  s_cbranch_scc1 M_att
  s_waitcnt vmcnt(0)
  s_barrier
  s_mov_b32 s30, 512
  v_mov_b32 v144, s30
  v_min_u32 v145, 1, v0
  v_lshlrev_b32 v145, 30, v145
  buffer_store_dword v144, v145, s[4:7], s31 offen sc1
  s_lshr_b32 s48, s64, 2
  s_bfe_u32 s49, s64, 0x10001
  s_and_b32 s50, s64, 1
  s_mul_i32 s50, s50, 6
  s_add_u32 s50, s50, s65
  s_mov_b32 s51, 12
  s_cmp_lt_u32 s50, 4
  s_cselect_b32 s23, 6, 5
  s_load_dwordx2 s[8:9], s[0:1], 40
  s_lshl_b32 s17, s48, 19
  s_lshl_b32 s26, s49, 2
  s_add_u32 s26, s26, s16
  s_lshl_b32 s27, s26, 7
  s_add_u32 s17, s17, s27
  s_mov_b32 s18, 1024
  s_lshl_b32 s21, s48, 6
  s_add_u32 s21, s21, s50
  s_lshl_b32 s21, s21, 3
  s_add_u32 s21, s21, s26
  s_lshl_b32 s21, s21, 12
  s_add_u32 s21, s21, 150994944
  s_lshl_b32 s22, s51, 15
  s_mov_b32 s24, 1.0
  s_waitcnt lgkmcnt(0)
  s_and_b32 s9, s9, 0xffff
  s_mov_b32 s10, 4194304
  s_mov_b32 s11, 0x20000
  s_mov_b32 s12, s4
  s_mov_b32 s13, s5
  s_mov_b32 s14, 268435456
  s_mov_b32 s15, 0x20000
  s_lshl_b32 s19, s48, 8
  s_add_u32 s19, s19, s50
  s_lshl_b32 s19, s19, 13
  s_add_u32 s19, s19, 100663296
  s_lshl_b32 s20, s51, 13
  v_lshrrev_b32 v144, 4, v1
  v_and_b32 v56, 0xff, v2
  v_lshl_add_u32 v56, v144, 9, v56
  s_mul_i32 s26, s16, 524288
  v_add_u32 v8, 0, v56
  v_add_u32 v16, 0, v2
  v_add_u32 v16, s26, v16
  v_add_u32 v9, 256, v56
  v_add_u32 v17, 1024, v2
  v_add_u32 v17, s26, v17
  v_add_u32 v10, 2048, v56
  v_add_u32 v18, 2048, v2
  v_add_u32 v18, s26, v18
  v_add_u32 v11, 2304, v56
  v_add_u32 v19, 3072, v2
  v_add_u32 v19, s26, v19
  v_add_u32 v12, 4096, v56
  v_add_u32 v20, 4096, v2
  v_add_u32 v20, s26, v20
  v_add_u32 v13, 4352, v56
  v_add_u32 v21, 5120, v2
  v_add_u32 v21, s26, v21
  v_add_u32 v14, 6144, v56
  v_add_u32 v22, 6144, v2
  v_add_u32 v22, s26, v22
  v_add_u32 v15, 6400, v56
  v_add_u32 v23, 7168, v2
  v_add_u32 v23, s26, v23
  v_lshrrev_b32 v144, 3, v1
  v_mul_lo_u32 v144, v144, s18
  v_and_b32 v145, 7, v1
  v_lshl_add_u32 v144, v145, 4, v144
  s_lshl_b32 s28, s16, 15
  s_add_u32 s28, s28, 32768
  s_lshl_b32 s29, s18, 3
  s_add_u32 m0, s28, 0
  s_nop 0
  buffer_load_dwordx4 v144, s[8:11], s17 offen lds
  s_add_u32 s17, s17, s29
  s_add_u32 m0, s28, 1024
  s_nop 0
  buffer_load_dwordx4 v144, s[8:11], s17 offen lds
  s_add_u32 s17, s17, s29
  s_add_u32 m0, s28, 2048
  s_nop 0
  buffer_load_dwordx4 v144, s[8:11], s17 offen lds
  s_add_u32 s17, s17, s29
  s_add_u32 m0, s28, 3072
  s_nop 0
  buffer_load_dwordx4 v144, s[8:11], s17 offen lds
  s_add_u32 s17, s17, s29
  s_add_u32 m0, s28, 4096
  s_nop 0
  buffer_load_dwordx4 v144, s[8:11], s17 offen lds
  s_add_u32 s17, s17, s29
  s_add_u32 m0, s28, 5120
  s_nop 0
  buffer_load_dwordx4 v144, s[8:11], s17 offen lds
  s_add_u32 s17, s17, s29
  s_add_u32 m0, s28, 6144
  s_nop 0
  buffer_load_dwordx4 v144, s[8:11], s17 offen lds
  s_add_u32 s17, s17, s29
  s_add_u32 m0, s28, 7168
  s_nop 0
  buffer_load_dwordx4 v144, s[8:11], s17 offen lds
  s_add_u32 s17, s17, s29
  v_bfe_u32 v148, v1, 2, 2
  v_lshrrev_b32 v149, 5, v1
  v_lshl_add_u32 v148, v149, 4, v148
  v_bfe_u32 v149, v1, 4, 1
  v_lshl_add_u32 v148, v149, 2, v148
  v_and_b32 v149, 3, v1
  v_lshlrev_b32 v149, 4, v149
  s_mov_b32 s26, 8
  v_lshl_add_u32 v148, v148, 7, v149
  v_add_u32 v152, s28, v148
  v_add_u32 v153, 1024, v152
  v_add_u32 v154, s26, v152
  v_add_u32 v155, s26, v153
  s_waitcnt vmcnt(4)
  ds_read_b64_tr_b16 a[0:1], v152 offset:0
  ds_read_b64_tr_b16 a[2:3], v153 offset:0
  ds_read_b64_tr_b16 a[4:5], v154 offset:0
  ds_read_b64_tr_b16 a[6:7], v155 offset:0
  ds_read_b64_tr_b16 a[8:9], v152 offset:64
  ds_read_b64_tr_b16 a[10:11], v153 offset:64
  ds_read_b64_tr_b16 a[12:13], v154 offset:64
  ds_read_b64_tr_b16 a[14:15], v155 offset:64
  s_waitcnt lgkmcnt(0)
  s_add_u32 m0, s28, 8192
  s_nop 0
  buffer_load_dwordx4 v144, s[8:11], s17 offen lds
  s_add_u32 s17, s17, s29
  s_add_u32 m0, s28, 9216
  s_nop 0
  buffer_load_dwordx4 v144, s[8:11], s17 offen lds
  s_add_u32 s17, s17, s29
  s_add_u32 m0, s28, 10240
  s_nop 0
  buffer_load_dwordx4 v144, s[8:11], s17 offen lds
  s_add_u32 s17, s17, s29
  s_add_u32 m0, s28, 11264
  s_nop 0
  buffer_load_dwordx4 v144, s[8:11], s17 offen lds
  s_add_u32 s17, s17, s29
  s_waitcnt vmcnt(4)
  ds_read_b64_tr_b16 a[16:17], v152 offset:4096
  ds_read_b64_tr_b16 a[18:19], v153 offset:4096
  ds_read_b64_tr_b16 a[20:21], v154 offset:4096
  ds_read_b64_tr_b16 a[22:23], v155 offset:4096
  ds_read_b64_tr_b16 a[24:25], v152 offset:4160
  ds_read_b64_tr_b16 a[26:27], v153 offset:4160
  ds_read_b64_tr_b16 a[28:29], v154 offset:4160
  ds_read_b64_tr_b16 a[30:31], v155 offset:4160
  s_waitcnt lgkmcnt(0)
  s_add_u32 m0, s28, 12288
  s_nop 0
  buffer_load_dwordx4 v144, s[8:11], s17 offen lds
  s_add_u32 s17, s17, s29
  s_add_u32 m0, s28, 13312
  s_nop 0
  buffer_load_dwordx4 v144, s[8:11], s17 offen lds
  s_add_u32 s17, s17, s29
  s_add_u32 m0, s28, 14336
  s_nop 0
  buffer_load_dwordx4 v144, s[8:11], s17 offen lds
  s_add_u32 s17, s17, s29
  s_add_u32 m0, s28, 15360
  s_nop 0
  buffer_load_dwordx4 v144, s[8:11], s17 offen lds
  s_add_u32 s17, s17, s29
  s_waitcnt vmcnt(4)
  ds_read_b64_tr_b16 a[32:33], v152 offset:8192
  ds_read_b64_tr_b16 a[34:35], v153 offset:8192
  ds_read_b64_tr_b16 a[36:37], v154 offset:8192
  ds_read_b64_tr_b16 a[38:39], v155 offset:8192
  ds_read_b64_tr_b16 a[40:41], v152 offset:8256
  ds_read_b64_tr_b16 a[42:43], v153 offset:8256
  ds_read_b64_tr_b16 a[44:45], v154 offset:8256
  ds_read_b64_tr_b16 a[46:47], v155 offset:8256
  s_waitcnt lgkmcnt(0)
  s_add_u32 m0, s28, 16384
  s_nop 0
  buffer_load_dwordx4 v144, s[8:11], s17 offen lds
  s_add_u32 s17, s17, s29
  s_add_u32 m0, s28, 17408
  s_nop 0
  buffer_load_dwordx4 v144, s[8:11], s17 offen lds
  s_add_u32 s17, s17, s29
  s_add_u32 m0, s28, 18432
  s_nop 0
  buffer_load_dwordx4 v144, s[8:11], s17 offen lds
  s_add_u32 s17, s17, s29
  s_add_u32 m0, s28, 19456
  s_nop 0
  buffer_load_dwordx4 v144, s[8:11], s17 offen lds
  s_add_u32 s17, s17, s29
  s_waitcnt vmcnt(4)
  ds_read_b64_tr_b16 a[48:49], v152 offset:12288
  ds_read_b64_tr_b16 a[50:51], v153 offset:12288
  ds_read_b64_tr_b16 a[52:53], v154 offset:12288
  ds_read_b64_tr_b16 a[54:55], v155 offset:12288
  ds_read_b64_tr_b16 a[56:57], v152 offset:12352
  ds_read_b64_tr_b16 a[58:59], v153 offset:12352
  ds_read_b64_tr_b16 a[60:61], v154 offset:12352
  ds_read_b64_tr_b16 a[62:63], v155 offset:12352
  s_waitcnt lgkmcnt(0)
  s_add_u32 m0, s28, 20480
  s_nop 0
  buffer_load_dwordx4 v144, s[8:11], s17 offen lds
  s_add_u32 s17, s17, s29
  s_add_u32 m0, s28, 21504
  s_nop 0
  buffer_load_dwordx4 v144, s[8:11], s17 offen lds
  s_add_u32 s17, s17, s29
  s_add_u32 m0, s28, 22528
  s_nop 0
  buffer_load_dwordx4 v144, s[8:11], s17 offen lds
  s_add_u32 s17, s17, s29
  s_add_u32 m0, s28, 23552
  s_nop 0
  buffer_load_dwordx4 v144, s[8:11], s17 offen lds
  s_add_u32 s17, s17, s29
  s_waitcnt vmcnt(4)
  ds_read_b64_tr_b16 a[64:65], v152 offset:16384
  ds_read_b64_tr_b16 a[66:67], v153 offset:16384
  ds_read_b64_tr_b16 a[68:69], v154 offset:16384
  ds_read_b64_tr_b16 a[70:71], v155 offset:16384
  ds_read_b64_tr_b16 a[72:73], v152 offset:16448
  ds_read_b64_tr_b16 a[74:75], v153 offset:16448
  ds_read_b64_tr_b16 a[76:77], v154 offset:16448
  ds_read_b64_tr_b16 a[78:79], v155 offset:16448
  s_waitcnt lgkmcnt(0)
  s_add_u32 m0, s28, 24576
  s_nop 0
  buffer_load_dwordx4 v144, s[8:11], s17 offen lds
  s_add_u32 s17, s17, s29
  s_add_u32 m0, s28, 25600
  s_nop 0
  buffer_load_dwordx4 v144, s[8:11], s17 offen lds
  s_add_u32 s17, s17, s29
  s_add_u32 m0, s28, 26624
  s_nop 0
  buffer_load_dwordx4 v144, s[8:11], s17 offen lds
  s_add_u32 s17, s17, s29
  s_add_u32 m0, s28, 27648
  s_nop 0
  buffer_load_dwordx4 v144, s[8:11], s17 offen lds
  s_add_u32 s17, s17, s29
  s_waitcnt vmcnt(4)
  ds_read_b64_tr_b16 a[80:81], v152 offset:20480
  ds_read_b64_tr_b16 a[82:83], v153 offset:20480
  ds_read_b64_tr_b16 a[84:85], v154 offset:20480
  ds_read_b64_tr_b16 a[86:87], v155 offset:20480
  ds_read_b64_tr_b16 a[88:89], v152 offset:20544
  ds_read_b64_tr_b16 a[90:91], v153 offset:20544
  ds_read_b64_tr_b16 a[92:93], v154 offset:20544
  ds_read_b64_tr_b16 a[94:95], v155 offset:20544
  s_waitcnt lgkmcnt(0)
  s_add_u32 m0, s28, 28672
  s_nop 0
  buffer_load_dwordx4 v144, s[8:11], s17 offen lds
  s_add_u32 s17, s17, s29
  s_add_u32 m0, s28, 29696
  s_nop 0
  buffer_load_dwordx4 v144, s[8:11], s17 offen lds
  s_add_u32 s17, s17, s29
  s_add_u32 m0, s28, 30720
  s_nop 0
  buffer_load_dwordx4 v144, s[8:11], s17 offen lds
  s_add_u32 s17, s17, s29
  s_add_u32 m0, s28, 31744
  s_nop 0
  buffer_load_dwordx4 v144, s[8:11], s17 offen lds
  s_add_u32 s17, s17, s29
  s_waitcnt vmcnt(4)
  ds_read_b64_tr_b16 a[96:97], v152 offset:24576
  ds_read_b64_tr_b16 a[98:99], v153 offset:24576
  ds_read_b64_tr_b16 a[100:101], v154 offset:24576
  ds_read_b64_tr_b16 a[102:103], v155 offset:24576
  ds_read_b64_tr_b16 a[104:105], v152 offset:24640
  ds_read_b64_tr_b16 a[106:107], v153 offset:24640
  ds_read_b64_tr_b16 a[108:109], v154 offset:24640
  ds_read_b64_tr_b16 a[110:111], v155 offset:24640
  s_waitcnt lgkmcnt(0)
  s_add_u32 m0, s28, 0
  s_nop 0
  buffer_load_dwordx4 v144, s[8:11], s17 offen lds
  s_add_u32 s17, s17, s29
  s_add_u32 m0, s28, 1024
  s_nop 0
  buffer_load_dwordx4 v144, s[8:11], s17 offen lds
  s_add_u32 s17, s17, s29
  s_add_u32 m0, s28, 2048
  s_nop 0
  buffer_load_dwordx4 v144, s[8:11], s17 offen lds
  s_add_u32 s17, s17, s29
  s_add_u32 m0, s28, 3072
  s_nop 0
  buffer_load_dwordx4 v144, s[8:11], s17 offen lds
  s_add_u32 s17, s17, s29
  s_waitcnt vmcnt(4)
  ds_read_b64_tr_b16 a[112:113], v152 offset:28672
  ds_read_b64_tr_b16 a[114:115], v153 offset:28672
  ds_read_b64_tr_b16 a[116:117], v154 offset:28672
  ds_read_b64_tr_b16 a[118:119], v155 offset:28672
  ds_read_b64_tr_b16 a[120:121], v152 offset:28736
  ds_read_b64_tr_b16 a[122:123], v153 offset:28736
  ds_read_b64_tr_b16 a[124:125], v154 offset:28736
  ds_read_b64_tr_b16 a[126:127], v155 offset:28736
  s_waitcnt lgkmcnt(0)
  s_add_u32 m0, s28, 4096
  s_nop 0
  buffer_load_dwordx4 v144, s[8:11], s17 offen lds
  s_add_u32 s17, s17, s29
  s_add_u32 m0, s28, 5120
  s_nop 0
  buffer_load_dwordx4 v144, s[8:11], s17 offen lds
  s_add_u32 s17, s17, s29
  s_add_u32 m0, s28, 6144
  s_nop 0
  buffer_load_dwordx4 v144, s[8:11], s17 offen lds
  s_add_u32 s17, s17, s29
  s_add_u32 m0, s28, 7168
  s_nop 0
  buffer_load_dwordx4 v144, s[8:11], s17 offen lds
  s_add_u32 s17, s17, s29
  s_waitcnt vmcnt(4)
  ds_read_b64_tr_b16 a[128:129], v152 offset:0
  ds_read_b64_tr_b16 a[130:131], v153 offset:0
  ds_read_b64_tr_b16 a[132:133], v154 offset:0
  ds_read_b64_tr_b16 a[134:135], v155 offset:0
  ds_read_b64_tr_b16 a[136:137], v152 offset:64
  ds_read_b64_tr_b16 a[138:139], v153 offset:64
  ds_read_b64_tr_b16 a[140:141], v154 offset:64
  ds_read_b64_tr_b16 a[142:143], v155 offset:64
  s_waitcnt lgkmcnt(0)
  s_add_u32 m0, s28, 8192
  s_nop 0
  buffer_load_dwordx4 v144, s[8:11], s17 offen lds
  s_add_u32 s17, s17, s29
  s_add_u32 m0, s28, 9216
  s_nop 0
  buffer_load_dwordx4 v144, s[8:11], s17 offen lds
  s_add_u32 s17, s17, s29
  s_add_u32 m0, s28, 10240
  s_nop 0
  buffer_load_dwordx4 v144, s[8:11], s17 offen lds
  s_add_u32 s17, s17, s29
  s_add_u32 m0, s28, 11264
  s_nop 0
  buffer_load_dwordx4 v144, s[8:11], s17 offen lds
  s_add_u32 s17, s17, s29
  s_waitcnt vmcnt(4)
  ds_read_b64_tr_b16 a[144:145], v152 offset:4096
  ds_read_b64_tr_b16 a[146:147], v153 offset:4096
  ds_read_b64_tr_b16 a[148:149], v154 offset:4096
  ds_read_b64_tr_b16 a[150:151], v155 offset:4096
  ds_read_b64_tr_b16 a[152:153], v152 offset:4160
  ds_read_b64_tr_b16 a[154:155], v153 offset:4160
  ds_read_b64_tr_b16 a[156:157], v154 offset:4160
  ds_read_b64_tr_b16 a[158:159], v155 offset:4160
  s_waitcnt lgkmcnt(0)
  s_add_u32 m0, s28, 12288
  s_nop 0
  buffer_load_dwordx4 v144, s[8:11], s17 offen lds
  s_add_u32 s17, s17, s29
  s_add_u32 m0, s28, 13312
  s_nop 0
  buffer_load_dwordx4 v144, s[8:11], s17 offen lds
  s_add_u32 s17, s17, s29
  s_add_u32 m0, s28, 14336
  s_nop 0
  buffer_load_dwordx4 v144, s[8:11], s17 offen lds
  s_add_u32 s17, s17, s29
  s_add_u32 m0, s28, 15360
  s_nop 0
  buffer_load_dwordx4 v144, s[8:11], s17 offen lds
  s_add_u32 s17, s17, s29
  s_waitcnt vmcnt(4)
  ds_read_b64_tr_b16 a[160:161], v152 offset:8192
  ds_read_b64_tr_b16 a[162:163], v153 offset:8192
  ds_read_b64_tr_b16 a[164:165], v154 offset:8192
  ds_read_b64_tr_b16 a[166:167], v155 offset:8192
  ds_read_b64_tr_b16 a[168:169], v152 offset:8256
  ds_read_b64_tr_b16 a[170:171], v153 offset:8256
  ds_read_b64_tr_b16 a[172:173], v154 offset:8256
  ds_read_b64_tr_b16 a[174:175], v155 offset:8256
  s_waitcnt lgkmcnt(0)
  s_add_u32 m0, s28, 16384
  s_nop 0
  buffer_load_dwordx4 v144, s[8:11], s17 offen lds
  s_add_u32 s17, s17, s29
  s_add_u32 m0, s28, 17408
  s_nop 0
  buffer_load_dwordx4 v144, s[8:11], s17 offen lds
  s_add_u32 s17, s17, s29
  s_add_u32 m0, s28, 18432
  s_nop 0
  buffer_load_dwordx4 v144, s[8:11], s17 offen lds
  s_add_u32 s17, s17, s29
  s_add_u32 m0, s28, 19456
  s_nop 0
  buffer_load_dwordx4 v144, s[8:11], s17 offen lds
  s_add_u32 s17, s17, s29
  s_waitcnt vmcnt(4)
  ds_read_b64_tr_b16 a[176:177], v152 offset:12288
  ds_read_b64_tr_b16 a[178:179], v153 offset:12288
  ds_read_b64_tr_b16 a[180:181], v154 offset:12288
  ds_read_b64_tr_b16 a[182:183], v155 offset:12288
  ds_read_b64_tr_b16 a[184:185], v152 offset:12352
  ds_read_b64_tr_b16 a[186:187], v153 offset:12352
  ds_read_b64_tr_b16 a[188:189], v154 offset:12352
  ds_read_b64_tr_b16 a[190:191], v155 offset:12352
  s_waitcnt lgkmcnt(0)
  s_add_u32 m0, s28, 20480
  s_nop 0
  buffer_load_dwordx4 v144, s[8:11], s17 offen lds
  s_add_u32 s17, s17, s29
  s_add_u32 m0, s28, 21504
  s_nop 0
  buffer_load_dwordx4 v144, s[8:11], s17 offen lds
  s_add_u32 s17, s17, s29
  s_add_u32 m0, s28, 22528
  s_nop 0
  buffer_load_dwordx4 v144, s[8:11], s17 offen lds
  s_add_u32 s17, s17, s29
  s_add_u32 m0, s28, 23552
  s_nop 0
  buffer_load_dwordx4 v144, s[8:11], s17 offen lds
  s_add_u32 s17, s17, s29
  s_waitcnt vmcnt(4)
  ds_read_b64_tr_b16 a[192:193], v152 offset:16384
  ds_read_b64_tr_b16 a[194:195], v153 offset:16384
  ds_read_b64_tr_b16 a[196:197], v154 offset:16384
  ds_read_b64_tr_b16 a[198:199], v155 offset:16384
  ds_read_b64_tr_b16 a[200:201], v152 offset:16448
  ds_read_b64_tr_b16 a[202:203], v153 offset:16448
  ds_read_b64_tr_b16 a[204:205], v154 offset:16448
  ds_read_b64_tr_b16 a[206:207], v155 offset:16448
  s_waitcnt lgkmcnt(0)
  s_add_u32 m0, s28, 24576
  s_nop 0
  buffer_load_dwordx4 v144, s[8:11], s17 offen lds
  s_add_u32 s17, s17, s29
  s_add_u32 m0, s28, 25600
  s_nop 0
  buffer_load_dwordx4 v144, s[8:11], s17 offen lds
  s_add_u32 s17, s17, s29
  s_add_u32 m0, s28, 26624
  s_nop 0
  buffer_load_dwordx4 v144, s[8:11], s17 offen lds
  s_add_u32 s17, s17, s29
  s_add_u32 m0, s28, 27648
  s_nop 0
  buffer_load_dwordx4 v144, s[8:11], s17 offen lds
  s_add_u32 s17, s17, s29
  s_waitcnt vmcnt(4)
  ds_read_b64_tr_b16 a[208:209], v152 offset:20480
  ds_read_b64_tr_b16 a[210:211], v153 offset:20480
  ds_read_b64_tr_b16 a[212:213], v154 offset:20480
  ds_read_b64_tr_b16 a[214:215], v155 offset:20480
  ds_read_b64_tr_b16 a[216:217], v152 offset:20544
  ds_read_b64_tr_b16 a[218:219], v153 offset:20544
  ds_read_b64_tr_b16 a[220:221], v154 offset:20544
  ds_read_b64_tr_b16 a[222:223], v155 offset:20544
  s_waitcnt lgkmcnt(0)
  s_add_u32 m0, s28, 28672
  s_nop 0
  buffer_load_dwordx4 v144, s[8:11], s17 offen lds
  s_add_u32 s17, s17, s29
  s_add_u32 m0, s28, 29696
  s_nop 0
  buffer_load_dwordx4 v144, s[8:11], s17 offen lds
  s_add_u32 s17, s17, s29
  s_add_u32 m0, s28, 30720
  s_nop 0
  buffer_load_dwordx4 v144, s[8:11], s17 offen lds
  s_add_u32 s17, s17, s29
  s_add_u32 m0, s28, 31744
  s_nop 0
  buffer_load_dwordx4 v144, s[8:11], s17 offen lds
  s_add_u32 s17, s17, s29
  s_waitcnt vmcnt(4)
  ds_read_b64_tr_b16 a[224:225], v152 offset:24576
  ds_read_b64_tr_b16 a[226:227], v153 offset:24576
  ds_read_b64_tr_b16 a[228:229], v154 offset:24576
  ds_read_b64_tr_b16 a[230:231], v155 offset:24576
  ds_read_b64_tr_b16 a[232:233], v152 offset:24640
  ds_read_b64_tr_b16 a[234:235], v153 offset:24640
  ds_read_b64_tr_b16 a[236:237], v154 offset:24640
  ds_read_b64_tr_b16 a[238:239], v155 offset:24640
  s_waitcnt lgkmcnt(0)
  s_waitcnt vmcnt(0)
  ds_read_b64_tr_b16 a[240:241], v152 offset:28672
  ds_read_b64_tr_b16 a[242:243], v153 offset:28672
  ds_read_b64_tr_b16 a[244:245], v154 offset:28672
  ds_read_b64_tr_b16 a[246:247], v155 offset:28672
  ds_read_b64_tr_b16 a[248:249], v152 offset:28736
  ds_read_b64_tr_b16 a[250:251], v153 offset:28736
  ds_read_b64_tr_b16 a[252:253], v154 offset:28736
  ds_read_b64_tr_b16 a[254:255], v155 offset:28736
  s_waitcnt lgkmcnt(0)
  v_min_u32 v4, 27, v1
  v_mul_u32_u24 v5, 37, v4
  v_lshrrev_b32 v5, 8, v5
  v_mul_u32_u24 v5, 7, v5
  v_sub_u32 v5, v4, v5
  v_mov_b32 v6, 0x200
  v_cmp_ne_u32 vcc, 6, v5
  s_mul_i32 s76, s48, 3584
  s_add_u32 s76, s76, 148897792
  v_cndmask_b32 v5, 0, v6, vcc
  v_lshl_add_u32 v4, v4, 7, s76
  s_mov_b32 s71, 0
  s_branch M_vg_178
M_vw_177:
  s_sleep 2
  s_add_u32 s71, s71, 1
  s_cmp_gt_u32 s71, 262144
  s_cbranch_scc1 M_exit
M_vg_178:
  buffer_load_dword v6, v4, s[4:7], 0 offen sc1
  s_waitcnt vmcnt(0)
  v_cmp_lt_u32 vcc, v6, v5
  s_cbranch_vccnz M_vw_177
  s_barrier
  s_lshl_b32 s25, s16, 13
  s_add_u32 m0, s25, 0
  s_nop 0
  buffer_load_dwordx4 v16, s[12:15], s19 offen sc1 lds
  s_add_u32 m0, s25, 1024
  s_nop 0
  buffer_load_dwordx4 v17, s[12:15], s19 offen sc1 lds
  s_add_u32 m0, s25, 2048
  s_nop 0
  buffer_load_dwordx4 v18, s[12:15], s19 offen sc1 lds
  s_add_u32 m0, s25, 3072
  s_nop 0
  buffer_load_dwordx4 v19, s[12:15], s19 offen sc1 lds
  s_add_u32 m0, s25, 4096
  s_nop 0
  buffer_load_dwordx4 v20, s[12:15], s19 offen sc1 lds
  s_add_u32 m0, s25, 5120
  s_nop 0
  buffer_load_dwordx4 v21, s[12:15], s19 offen sc1 lds
  s_add_u32 m0, s25, 6144
  s_nop 0
  buffer_load_dwordx4 v22, s[12:15], s19 offen sc1 lds
  s_add_u32 m0, s25, 7168
  s_nop 0
  buffer_load_dwordx4 v23, s[12:15], s19 offen sc1 lds
  s_cmp_gt_u32 s23, 1
  s_cselect_b32 s26, s20, 0
  s_add_u32 s19, s19, s26
  s_add_u32 s25, s25, 32768
  s_and_b32 s25, s25, 0x1ffff
  s_waitcnt vmcnt(2)
  s_add_u32 m0, s25, 0
  s_nop 0
  buffer_load_dwordx4 v16, s[12:15], s19 offen sc1 lds
  s_add_u32 m0, s25, 1024
  s_nop 0
  buffer_load_dwordx4 v17, s[12:15], s19 offen sc1 lds
  s_add_u32 m0, s25, 2048
  s_nop 0
  buffer_load_dwordx4 v18, s[12:15], s19 offen sc1 lds
  s_add_u32 m0, s25, 3072
  s_nop 0
  buffer_load_dwordx4 v19, s[12:15], s19 offen sc1 lds
  s_add_u32 m0, s25, 4096
  s_nop 0
  buffer_load_dwordx4 v20, s[12:15], s19 offen sc1 lds
  s_add_u32 m0, s25, 5120
  s_nop 0
  buffer_load_dwordx4 v21, s[12:15], s19 offen sc1 lds
  s_add_u32 m0, s25, 6144
  s_nop 0
  buffer_load_dwordx4 v22, s[12:15], s19 offen sc1 lds
  s_add_u32 m0, s25, 7168
  s_nop 0
  buffer_load_dwordx4 v23, s[12:15], s19 offen sc1 lds
  s_cmp_gt_u32 s23, 2
  s_cselect_b32 s26, s20, 0
  s_add_u32 s19, s19, s26
  s_add_u32 s25, s25, 32768
  s_and_b32 s25, s25, 0x1ffff
  s_waitcnt vmcnt(0)
  s_barrier
  s_mov_b32 s27, s21
  v_mov_b32 v7, 0x40000000
  ds_read_b128 v[24:27], v8 offset:0
  ds_read_b128 v[28:31], v9 offset:0
  ds_read_b128 v[32:35], v10 offset:0
  ds_read_b128 v[36:39], v11 offset:0
  ds_read_b128 v[40:43], v12 offset:0
  ds_read_b128 v[44:47], v13 offset:0
.p2align 6
G_top_179:
  s_waitcnt lgkmcnt(5)
  v_mfma_f32_16x16x32_bf16 v[64:67], a[0:3], v[24:27], 0
  s_add_u32 m0, s25, 0
  ds_read_b128 v[48:51], v14 offset:0
  v_mfma_f32_16x16x32_bf16 v[68:71], a[4:7], v[24:27], 0
  v_mfma_f32_16x16x32_bf16 v[80:83], a[8:11], v[24:27], 0
  buffer_load_dwordx4 v16, s[12:15], s19 offen sc1 lds
  v_mfma_f32_16x16x32_bf16 v[84:87], a[12:15], v[24:27], 0
  s_waitcnt lgkmcnt(5)
  v_mfma_f32_16x16x32_bf16 v[72:75], a[0:3], v[28:31], 0
  ds_read_b128 v[52:55], v15 offset:0
  v_mfma_f32_16x16x32_bf16 v[76:79], a[4:7], v[28:31], 0
  v_cvt_pk_bf16_f32 v128, v96, v97
  v_cvt_pk_bf16_f32 v129, v98, v99
  v_mfma_f32_16x16x32_bf16 v[88:91], a[8:11], v[28:31], 0
  v_mfma_f32_16x16x32_bf16 v[92:95], a[12:15], v[28:31], 0
  s_waitcnt lgkmcnt(5)
  v_cvt_pk_bf16_f32 v130, v100, v101
  v_cvt_pk_bf16_f32 v131, v102, v103
  v_mfma_f32_16x16x32_bf16 v[64:67], a[16:19], v[32:35], v[64:67]
  s_add_u32 m0, s25, 1024
  ds_read_b128 v[24:27], v8 offset:8192
  v_mfma_f32_16x16x32_bf16 v[68:71], a[20:23], v[32:35], v[68:71]
  v_mfma_f32_16x16x32_bf16 v[80:83], a[24:27], v[32:35], v[80:83]
  buffer_load_dwordx4 v17, s[12:15], s19 offen sc1 lds
  v_mfma_f32_16x16x32_bf16 v[84:87], a[28:31], v[32:35], v[84:87]
  s_waitcnt lgkmcnt(5)
  v_mfma_f32_16x16x32_bf16 v[72:75], a[16:19], v[36:39], v[72:75]
  ds_read_b128 v[28:31], v9 offset:8192
  v_mfma_f32_16x16x32_bf16 v[76:79], a[20:23], v[36:39], v[76:79]
  v_mfma_f32_16x16x32_bf16 v[88:91], a[24:27], v[36:39], v[88:91]
  v_mfma_f32_16x16x32_bf16 v[92:95], a[28:31], v[36:39], v[92:95]
  s_waitcnt lgkmcnt(5)
  v_mfma_f32_16x16x32_bf16 v[64:67], a[32:35], v[40:43], v[64:67]
  s_add_u32 m0, s25, 2048
  ds_read_b128 v[32:35], v10 offset:8192
  v_mfma_f32_16x16x32_bf16 v[68:71], a[36:39], v[40:43], v[68:71]
  v_cvt_pk_bf16_f32 v132, v104, v105
  v_cvt_pk_bf16_f32 v133, v106, v107
  v_mfma_f32_16x16x32_bf16 v[80:83], a[40:43], v[40:43], v[80:83]
  buffer_load_dwordx4 v18, s[12:15], s19 offen sc1 lds
  v_mfma_f32_16x16x32_bf16 v[84:87], a[44:47], v[40:43], v[84:87]
  s_waitcnt lgkmcnt(5)
  v_cvt_pk_bf16_f32 v134, v108, v109
  v_cvt_pk_bf16_f32 v135, v110, v111
  v_mfma_f32_16x16x32_bf16 v[72:75], a[32:35], v[44:47], v[72:75]
  ds_read_b128 v[36:39], v11 offset:8192
  v_mfma_f32_16x16x32_bf16 v[76:79], a[36:39], v[44:47], v[76:79]
  v_mfma_f32_16x16x32_bf16 v[88:91], a[40:43], v[44:47], v[88:91]
  v_mfma_f32_16x16x32_bf16 v[92:95], a[44:47], v[44:47], v[92:95]
  s_waitcnt lgkmcnt(5)
  v_mfma_f32_16x16x32_bf16 v[64:67], a[48:51], v[48:51], v[64:67]
  s_add_u32 m0, s25, 3072
  ds_read_b128 v[40:43], v12 offset:8192
  v_mfma_f32_16x16x32_bf16 v[68:71], a[52:55], v[48:51], v[68:71]
  v_mfma_f32_16x16x32_bf16 v[80:83], a[56:59], v[48:51], v[80:83]
  buffer_load_dwordx4 v19, s[12:15], s19 offen sc1 lds
  v_mfma_f32_16x16x32_bf16 v[84:87], a[60:63], v[48:51], v[84:87]
  s_waitcnt lgkmcnt(5)
  v_mfma_f32_16x16x32_bf16 v[72:75], a[48:51], v[52:55], v[72:75]
  ds_read_b128 v[44:47], v13 offset:8192
  v_mfma_f32_16x16x32_bf16 v[76:79], a[52:55], v[52:55], v[76:79]
  v_cvt_pk_bf16_f32 v136, v112, v113
  v_cvt_pk_bf16_f32 v137, v114, v115
  v_mfma_f32_16x16x32_bf16 v[88:91], a[56:59], v[52:55], v[88:91]
  v_mfma_f32_16x16x32_bf16 v[92:95], a[60:63], v[52:55], v[92:95]
  s_waitcnt lgkmcnt(5)
  v_cvt_pk_bf16_f32 v138, v116, v117
  v_cvt_pk_bf16_f32 v139, v118, v119
  v_mfma_f32_16x16x32_bf16 v[64:67], a[64:67], v[24:27], v[64:67]
  s_add_u32 m0, s25, 4096
  ds_read_b128 v[48:51], v14 offset:8192
  v_mfma_f32_16x16x32_bf16 v[68:71], a[68:71], v[24:27], v[68:71]
  v_mfma_f32_16x16x32_bf16 v[80:83], a[72:75], v[24:27], v[80:83]
  buffer_load_dwordx4 v20, s[12:15], s19 offen sc1 lds
  v_mfma_f32_16x16x32_bf16 v[84:87], a[76:79], v[24:27], v[84:87]
  s_waitcnt lgkmcnt(5)
  v_mfma_f32_16x16x32_bf16 v[72:75], a[64:67], v[28:31], v[72:75]
  ds_read_b128 v[52:55], v15 offset:8192
  v_mfma_f32_16x16x32_bf16 v[76:79], a[68:71], v[28:31], v[76:79]
  v_mfma_f32_16x16x32_bf16 v[88:91], a[72:75], v[28:31], v[88:91]
  v_mfma_f32_16x16x32_bf16 v[92:95], a[76:79], v[28:31], v[92:95]
  s_waitcnt lgkmcnt(5)
  v_mfma_f32_16x16x32_bf16 v[64:67], a[80:83], v[32:35], v[64:67]
  s_add_u32 m0, s25, 5120
  ds_read_b128 v[24:27], v8 offset:16384
  v_mfma_f32_16x16x32_bf16 v[68:71], a[84:87], v[32:35], v[68:71]
  v_cvt_pk_bf16_f32 v140, v120, v121
  v_cvt_pk_bf16_f32 v141, v122, v123
  v_mfma_f32_16x16x32_bf16 v[80:83], a[88:91], v[32:35], v[80:83]
  buffer_load_dwordx4 v21, s[12:15], s19 offen sc1 lds
  v_mfma_f32_16x16x32_bf16 v[84:87], a[92:95], v[32:35], v[84:87]
  s_waitcnt lgkmcnt(5)
  v_cvt_pk_bf16_f32 v142, v124, v125
  v_cvt_pk_bf16_f32 v143, v126, v127
  v_mfma_f32_16x16x32_bf16 v[72:75], a[80:83], v[36:39], v[72:75]
  ds_read_b128 v[28:31], v9 offset:16384
  v_mfma_f32_16x16x32_bf16 v[76:79], a[84:87], v[36:39], v[76:79]
  v_mfma_f32_16x16x32_bf16 v[88:91], a[88:91], v[36:39], v[88:91]
  v_mfma_f32_16x16x32_bf16 v[92:95], a[92:95], v[36:39], v[92:95]
  s_waitcnt lgkmcnt(5)
  v_mfma_f32_16x16x32_bf16 v[64:67], a[96:99], v[40:43], v[64:67]
  s_add_u32 m0, s25, 6144
  ds_read_b128 v[32:35], v10 offset:16384
  v_mfma_f32_16x16x32_bf16 v[68:71], a[100:103], v[40:43], v[68:71]
  v_mfma_f32_16x16x32_bf16 v[80:83], a[104:107], v[40:43], v[80:83]
  buffer_load_dwordx4 v22, s[12:15], s19 offen sc1 lds
  v_mfma_f32_16x16x32_bf16 v[84:87], a[108:111], v[40:43], v[84:87]
  s_waitcnt lgkmcnt(5)
  v_mfma_f32_16x16x32_bf16 v[72:75], a[96:99], v[44:47], v[72:75]
  ds_read_b128 v[36:39], v11 offset:16384
  v_mfma_f32_16x16x32_bf16 v[76:79], a[100:103], v[44:47], v[76:79]
  v_mfma_f32_16x16x32_bf16 v[88:91], a[104:107], v[44:47], v[88:91]
  v_mfma_f32_16x16x32_bf16 v[92:95], a[108:111], v[44:47], v[92:95]
  s_waitcnt lgkmcnt(5)
  v_mfma_f32_16x16x32_bf16 v[64:67], a[112:115], v[48:51], v[64:67]
  s_add_u32 m0, s25, 7168
  ds_read_b128 v[40:43], v12 offset:16384
  v_mfma_f32_16x16x32_bf16 v[68:71], a[116:119], v[48:51], v[68:71]
  v_mfma_f32_16x16x32_bf16 v[80:83], a[120:123], v[48:51], v[80:83]
  buffer_load_dwordx4 v23, s[12:15], s19 offen sc1 lds
  v_mfma_f32_16x16x32_bf16 v[84:87], a[124:127], v[48:51], v[84:87]
  s_waitcnt lgkmcnt(5)
  v_mfma_f32_16x16x32_bf16 v[72:75], a[112:115], v[52:55], v[72:75]
  s_cmp_gt_u32 s23, 3
  ds_read_b128 v[44:47], v13 offset:16384
  v_mfma_f32_16x16x32_bf16 v[76:79], a[116:119], v[52:55], v[76:79]
  v_mfma_f32_16x16x32_bf16 v[88:91], a[120:123], v[52:55], v[88:91]
  s_cselect_b32 s26, s20, 0
  v_mfma_f32_16x16x32_bf16 v[92:95], a[124:127], v[52:55], v[92:95]
  s_waitcnt lgkmcnt(5)
  v_mfma_f32_16x16x32_bf16 v[64:67], a[128:131], v[24:27], v[64:67]
  s_add_u32 s19, s19, s26
  ds_read_b128 v[48:51], v14 offset:16384
  v_mfma_f32_16x16x32_bf16 v[68:71], a[132:135], v[24:27], v[68:71]
  v_mfma_f32_16x16x32_bf16 v[80:83], a[136:139], v[24:27], v[80:83]
  s_add_u32 s25, s25, 32768
  v_mfma_f32_16x16x32_bf16 v[84:87], a[140:143], v[24:27], v[84:87]
  s_waitcnt lgkmcnt(5)
  v_mfma_f32_16x16x32_bf16 v[72:75], a[128:131], v[28:31], v[72:75]
  s_and_b32 s25, s25, 0x1ffff
  ds_read_b128 v[52:55], v15 offset:16384
  v_mfma_f32_16x16x32_bf16 v[76:79], a[132:135], v[28:31], v[76:79]
  v_mfma_f32_16x16x32_bf16 v[88:91], a[136:139], v[28:31], v[88:91]
  buffer_store_dwordx4 v[128:131], v7, s[4:7], s21 offen offset:0 sc1
  v_mfma_f32_16x16x32_bf16 v[92:95], a[140:143], v[28:31], v[92:95]
  s_waitcnt lgkmcnt(5)
  v_mfma_f32_16x16x32_bf16 v[64:67], a[144:147], v[32:35], v[64:67]
  ds_read_b128 v[24:27], v8 offset:24576
  v_mfma_f32_16x16x32_bf16 v[68:71], a[148:151], v[32:35], v[68:71]
  v_mfma_f32_16x16x32_bf16 v[80:83], a[152:155], v[32:35], v[80:83]
  v_mfma_f32_16x16x32_bf16 v[84:87], a[156:159], v[32:35], v[84:87]
  s_waitcnt lgkmcnt(5)
  v_mfma_f32_16x16x32_bf16 v[72:75], a[144:147], v[36:39], v[72:75]
  ds_read_b128 v[28:31], v9 offset:24576
  v_mfma_f32_16x16x32_bf16 v[76:79], a[148:151], v[36:39], v[76:79]
  v_mfma_f32_16x16x32_bf16 v[88:91], a[152:155], v[36:39], v[88:91]
  buffer_store_dwordx4 v[132:135], v7, s[4:7], s21 offen offset:256 sc1
  v_mfma_f32_16x16x32_bf16 v[92:95], a[156:159], v[36:39], v[92:95]
  s_waitcnt lgkmcnt(5)
  v_mfma_f32_16x16x32_bf16 v[64:67], a[160:163], v[40:43], v[64:67]
  ds_read_b128 v[32:35], v10 offset:24576
  v_mfma_f32_16x16x32_bf16 v[68:71], a[164:167], v[40:43], v[68:71]
  v_mfma_f32_16x16x32_bf16 v[80:83], a[168:171], v[40:43], v[80:83]
  v_mfma_f32_16x16x32_bf16 v[84:87], a[172:175], v[40:43], v[84:87]
  s_waitcnt lgkmcnt(5)
  v_mfma_f32_16x16x32_bf16 v[72:75], a[160:163], v[44:47], v[72:75]
  ds_read_b128 v[36:39], v11 offset:24576
  v_mfma_f32_16x16x32_bf16 v[76:79], a[164:167], v[44:47], v[76:79]
  v_mfma_f32_16x16x32_bf16 v[88:91], a[168:171], v[44:47], v[88:91]
  buffer_store_dwordx4 v[136:139], v7, s[4:7], s21 offen offset:2048 sc1
  v_mfma_f32_16x16x32_bf16 v[92:95], a[172:175], v[44:47], v[92:95]
  s_waitcnt lgkmcnt(5)
  v_mfma_f32_16x16x32_bf16 v[64:67], a[176:179], v[48:51], v[64:67]
  ds_read_b128 v[40:43], v12 offset:24576
  v_mfma_f32_16x16x32_bf16 v[68:71], a[180:183], v[48:51], v[68:71]
  v_mfma_f32_16x16x32_bf16 v[80:83], a[184:187], v[48:51], v[80:83]
  v_mfma_f32_16x16x32_bf16 v[84:87], a[188:191], v[48:51], v[84:87]
  s_waitcnt lgkmcnt(5)
  v_mfma_f32_16x16x32_bf16 v[72:75], a[176:179], v[52:55], v[72:75]
  ds_read_b128 v[44:47], v13 offset:24576
  v_mfma_f32_16x16x32_bf16 v[76:79], a[180:183], v[52:55], v[76:79]
  v_mfma_f32_16x16x32_bf16 v[88:91], a[184:187], v[52:55], v[88:91]
  buffer_store_dwordx4 v[140:143], v7, s[4:7], s21 offen offset:2304 sc1
  v_mfma_f32_16x16x32_bf16 v[92:95], a[188:191], v[52:55], v[92:95]
  s_waitcnt lgkmcnt(5)
  v_mfma_f32_16x16x32_bf16 v[64:67], a[192:195], v[24:27], v[64:67]
  s_mov_b32 s21, s27
  ds_read_b128 v[48:51], v14 offset:24576
  v_mfma_f32_16x16x32_bf16 v[68:71], a[196:199], v[24:27], v[68:71]
  v_mov_b32 v7, v56
  v_mfma_f32_16x16x32_bf16 v[80:83], a[200:203], v[24:27], v[80:83]
  v_mfma_f32_16x16x32_bf16 v[84:87], a[204:207], v[24:27], v[84:87]
  s_waitcnt lgkmcnt(5)
  v_mfma_f32_16x16x32_bf16 v[72:75], a[192:195], v[28:31], v[72:75]
  s_add_u32 s27, s27, s22
  ds_read_b128 v[52:55], v15 offset:24576
  v_mfma_f32_16x16x32_bf16 v[76:79], a[196:199], v[28:31], v[76:79]
  v_mfma_f32_16x16x32_bf16 v[88:91], a[200:203], v[28:31], v[88:91]
  s_waitcnt vmcnt(16)
  s_barrier
  v_mfma_f32_16x16x32_bf16 v[92:95], a[204:207], v[28:31], v[92:95]
  s_waitcnt lgkmcnt(5)
  v_mfma_f32_16x16x32_bf16 v[64:67], a[208:211], v[32:35], v[64:67]
  ds_read_b128 v[24:27], v8 offset:32768
  v_mfma_f32_16x16x32_bf16 v[68:71], a[212:215], v[32:35], v[68:71]
  v_mfma_f32_16x16x32_bf16 v[80:83], a[216:219], v[32:35], v[80:83]
  v_mfma_f32_16x16x32_bf16 v[84:87], a[220:223], v[32:35], v[84:87]
  s_waitcnt lgkmcnt(5)
  v_mfma_f32_16x16x32_bf16 v[72:75], a[208:211], v[36:39], v[72:75]
  ds_read_b128 v[28:31], v9 offset:32768
  v_mfma_f32_16x16x32_bf16 v[76:79], a[212:215], v[36:39], v[76:79]
  v_mfma_f32_16x16x32_bf16 v[88:91], a[216:219], v[36:39], v[88:91]
  v_mfma_f32_16x16x32_bf16 v[92:95], a[220:223], v[36:39], v[92:95]
  s_waitcnt lgkmcnt(5)
  v_mfma_f32_16x16x32_bf16 v[64:67], a[224:227], v[40:43], v[64:67]
  ds_read_b128 v[32:35], v10 offset:32768
  v_mfma_f32_16x16x32_bf16 v[68:71], a[228:231], v[40:43], v[68:71]
  v_mfma_f32_16x16x32_bf16 v[80:83], a[232:235], v[40:43], v[80:83]
  v_mfma_f32_16x16x32_bf16 v[84:87], a[236:239], v[40:43], v[84:87]
  s_waitcnt lgkmcnt(5)
  v_mfma_f32_16x16x32_bf16 v[72:75], a[224:227], v[44:47], v[72:75]
  ds_read_b128 v[36:39], v11 offset:32768
  v_mfma_f32_16x16x32_bf16 v[76:79], a[228:231], v[44:47], v[76:79]
  v_mfma_f32_16x16x32_bf16 v[88:91], a[232:235], v[44:47], v[88:91]
  v_mfma_f32_16x16x32_bf16 v[92:95], a[236:239], v[44:47], v[92:95]
  s_waitcnt lgkmcnt(5)
  v_mfma_f32_16x16x32_bf16 v[64:67], a[240:243], v[48:51], v[64:67]
  s_sub_u32 s23, s23, 1
  ds_read_b128 v[40:43], v12 offset:32768
  v_mfma_f32_16x16x32_bf16 v[68:71], a[244:247], v[48:51], v[68:71]
  v_mfma_f32_16x16x32_bf16 v[80:83], a[248:251], v[48:51], v[80:83]
  v_mfma_f32_16x16x32_bf16 v[84:87], a[252:255], v[48:51], v[84:87]
  s_waitcnt lgkmcnt(5)
  v_mfma_f32_16x16x32_bf16 v[72:75], a[240:243], v[52:55], v[72:75]
  s_cmp_eq_u32 s23, 0
  ds_read_b128 v[44:47], v13 offset:32768
  v_mfma_f32_16x16x32_bf16 v[76:79], a[244:247], v[52:55], v[76:79]
  v_mfma_f32_16x16x32_bf16 v[88:91], a[248:251], v[52:55], v[88:91]
  v_mfma_f32_16x16x32_bf16 v[92:95], a[252:255], v[52:55], v[92:95]
  s_cbranch_scc1 G_done0_180
  s_waitcnt lgkmcnt(5)
  v_mfma_f32_16x16x32_bf16 v[96:99], a[0:3], v[24:27], 0
  s_add_u32 m0, s25, 0
  ds_read_b128 v[48:51], v14 offset:32768
  v_mfma_f32_16x16x32_bf16 v[100:103], a[4:7], v[24:27], 0
  v_mfma_f32_16x16x32_bf16 v[112:115], a[8:11], v[24:27], 0
  buffer_load_dwordx4 v16, s[12:15], s19 offen sc1 lds
  v_mfma_f32_16x16x32_bf16 v[116:119], a[12:15], v[24:27], 0
  s_waitcnt lgkmcnt(5)
  v_mfma_f32_16x16x32_bf16 v[104:107], a[0:3], v[28:31], 0
  ds_read_b128 v[52:55], v15 offset:32768
  v_mfma_f32_16x16x32_bf16 v[108:111], a[4:7], v[28:31], 0
  v_cvt_pk_bf16_f32 v128, v64, v65
  v_cvt_pk_bf16_f32 v129, v66, v67
  v_mfma_f32_16x16x32_bf16 v[120:123], a[8:11], v[28:31], 0
  v_mfma_f32_16x16x32_bf16 v[124:127], a[12:15], v[28:31], 0
  s_waitcnt lgkmcnt(5)
  v_cvt_pk_bf16_f32 v130, v68, v69
  v_cvt_pk_bf16_f32 v131, v70, v71
  v_mfma_f32_16x16x32_bf16 v[96:99], a[16:19], v[32:35], v[96:99]
  s_add_u32 m0, s25, 1024
  ds_read_b128 v[24:27], v8 offset:40960
  v_mfma_f32_16x16x32_bf16 v[100:103], a[20:23], v[32:35], v[100:103]
  v_mfma_f32_16x16x32_bf16 v[112:115], a[24:27], v[32:35], v[112:115]
  buffer_load_dwordx4 v17, s[12:15], s19 offen sc1 lds
  v_mfma_f32_16x16x32_bf16 v[116:119], a[28:31], v[32:35], v[116:119]
  s_waitcnt lgkmcnt(5)
  v_mfma_f32_16x16x32_bf16 v[104:107], a[16:19], v[36:39], v[104:107]
  ds_read_b128 v[28:31], v9 offset:40960
  v_mfma_f32_16x16x32_bf16 v[108:111], a[20:23], v[36:39], v[108:111]
  v_mfma_f32_16x16x32_bf16 v[120:123], a[24:27], v[36:39], v[120:123]
  v_mfma_f32_16x16x32_bf16 v[124:127], a[28:31], v[36:39], v[124:127]
  s_waitcnt lgkmcnt(5)
  v_mfma_f32_16x16x32_bf16 v[96:99], a[32:35], v[40:43], v[96:99]
  s_add_u32 m0, s25, 2048
  ds_read_b128 v[32:35], v10 offset:40960
  v_mfma_f32_16x16x32_bf16 v[100:103], a[36:39], v[40:43], v[100:103]
  v_cvt_pk_bf16_f32 v132, v72, v73
  v_cvt_pk_bf16_f32 v133, v74, v75
  v_mfma_f32_16x16x32_bf16 v[112:115], a[40:43], v[40:43], v[112:115]
  buffer_load_dwordx4 v18, s[12:15], s19 offen sc1 lds
  v_mfma_f32_16x16x32_bf16 v[116:119], a[44:47], v[40:43], v[116:119]
  s_waitcnt lgkmcnt(5)
  v_cvt_pk_bf16_f32 v134, v76, v77
  v_cvt_pk_bf16_f32 v135, v78, v79
  v_mfma_f32_16x16x32_bf16 v[104:107], a[32:35], v[44:47], v[104:107]
  ds_read_b128 v[36:39], v11 offset:40960
  v_mfma_f32_16x16x32_bf16 v[108:111], a[36:39], v[44:47], v[108:111]
  v_mfma_f32_16x16x32_bf16 v[120:123], a[40:43], v[44:47], v[120:123]
  v_mfma_f32_16x16x32_bf16 v[124:127], a[44:47], v[44:47], v[124:127]
  s_waitcnt lgkmcnt(5)
  v_mfma_f32_16x16x32_bf16 v[96:99], a[48:51], v[48:51], v[96:99]
  s_add_u32 m0, s25, 3072
  ds_read_b128 v[40:43], v12 offset:40960
  v_mfma_f32_16x16x32_bf16 v[100:103], a[52:55], v[48:51], v[100:103]
  v_mfma_f32_16x16x32_bf16 v[112:115], a[56:59], v[48:51], v[112:115]
  buffer_load_dwordx4 v19, s[12:15], s19 offen sc1 lds
  v_mfma_f32_16x16x32_bf16 v[116:119], a[60:63], v[48:51], v[116:119]
  s_waitcnt lgkmcnt(5)
  v_mfma_f32_16x16x32_bf16 v[104:107], a[48:51], v[52:55], v[104:107]
  ds_read_b128 v[44:47], v13 offset:40960
  v_mfma_f32_16x16x32_bf16 v[108:111], a[52:55], v[52:55], v[108:111]
  v_cvt_pk_bf16_f32 v136, v80, v81
  v_cvt_pk_bf16_f32 v137, v82, v83
  v_mfma_f32_16x16x32_bf16 v[120:123], a[56:59], v[52:55], v[120:123]
  v_mfma_f32_16x16x32_bf16 v[124:127], a[60:63], v[52:55], v[124:127]
  s_waitcnt lgkmcnt(5)
  v_cvt_pk_bf16_f32 v138, v84, v85
  v_cvt_pk_bf16_f32 v139, v86, v87
  v_mfma_f32_16x16x32_bf16 v[96:99], a[64:67], v[24:27], v[96:99]
  s_add_u32 m0, s25, 4096
  ds_read_b128 v[48:51], v14 offset:40960
  v_mfma_f32_16x16x32_bf16 v[100:103], a[68:71], v[24:27], v[100:103]
  v_mfma_f32_16x16x32_bf16 v[112:115], a[72:75], v[24:27], v[112:115]
  buffer_load_dwordx4 v20, s[12:15], s19 offen sc1 lds
  v_mfma_f32_16x16x32_bf16 v[116:119], a[76:79], v[24:27], v[116:119]
  s_waitcnt lgkmcnt(5)
  v_mfma_f32_16x16x32_bf16 v[104:107], a[64:67], v[28:31], v[104:107]
  ds_read_b128 v[52:55], v15 offset:40960
  v_mfma_f32_16x16x32_bf16 v[108:111], a[68:71], v[28:31], v[108:111]
  v_mfma_f32_16x16x32_bf16 v[120:123], a[72:75], v[28:31], v[120:123]
  v_mfma_f32_16x16x32_bf16 v[124:127], a[76:79], v[28:31], v[124:127]
  s_waitcnt lgkmcnt(5)
  v_mfma_f32_16x16x32_bf16 v[96:99], a[80:83], v[32:35], v[96:99]
  s_add_u32 m0, s25, 5120
  ds_read_b128 v[24:27], v8 offset:49152
  v_mfma_f32_16x16x32_bf16 v[100:103], a[84:87], v[32:35], v[100:103]
  v_cvt_pk_bf16_f32 v140, v88, v89
  v_cvt_pk_bf16_f32 v141, v90, v91
  v_mfma_f32_16x16x32_bf16 v[112:115], a[88:91], v[32:35], v[112:115]
  buffer_load_dwordx4 v21, s[12:15], s19 offen sc1 lds
  v_mfma_f32_16x16x32_bf16 v[116:119], a[92:95], v[32:35], v[116:119]
  s_waitcnt lgkmcnt(5)
  v_cvt_pk_bf16_f32 v142, v92, v93
  v_cvt_pk_bf16_f32 v143, v94, v95
  v_mfma_f32_16x16x32_bf16 v[104:107], a[80:83], v[36:39], v[104:107]
  ds_read_b128 v[28:31], v9 offset:49152
  v_mfma_f32_16x16x32_bf16 v[108:111], a[84:87], v[36:39], v[108:111]
  v_mfma_f32_16x16x32_bf16 v[120:123], a[88:91], v[36:39], v[120:123]
  v_mfma_f32_16x16x32_bf16 v[124:127], a[92:95], v[36:39], v[124:127]
  s_waitcnt lgkmcnt(5)
  v_mfma_f32_16x16x32_bf16 v[96:99], a[96:99], v[40:43], v[96:99]
  s_add_u32 m0, s25, 6144
  ds_read_b128 v[32:35], v10 offset:49152
  v_mfma_f32_16x16x32_bf16 v[100:103], a[100:103], v[40:43], v[100:103]
  v_mfma_f32_16x16x32_bf16 v[112:115], a[104:107], v[40:43], v[112:115]
  buffer_load_dwordx4 v22, s[12:15], s19 offen sc1 lds
  v_mfma_f32_16x16x32_bf16 v[116:119], a[108:111], v[40:43], v[116:119]
  s_waitcnt lgkmcnt(5)
  v_mfma_f32_16x16x32_bf16 v[104:107], a[96:99], v[44:47], v[104:107]
  ds_read_b128 v[36:39], v11 offset:49152
  v_mfma_f32_16x16x32_bf16 v[108:111], a[100:103], v[44:47], v[108:111]
  v_mfma_f32_16x16x32_bf16 v[120:123], a[104:107], v[44:47], v[120:123]
  v_mfma_f32_16x16x32_bf16 v[124:127], a[108:111], v[44:47], v[124:127]
  s_waitcnt lgkmcnt(5)
  v_mfma_f32_16x16x32_bf16 v[96:99], a[112:115], v[48:51], v[96:99]
  s_add_u32 m0, s25, 7168
  ds_read_b128 v[40:43], v12 offset:49152
  v_mfma_f32_16x16x32_bf16 v[100:103], a[116:119], v[48:51], v[100:103]
  v_mfma_f32_16x16x32_bf16 v[112:115], a[120:123], v[48:51], v[112:115]
  buffer_load_dwordx4 v23, s[12:15], s19 offen sc1 lds
  v_mfma_f32_16x16x32_bf16 v[116:119], a[124:127], v[48:51], v[116:119]
  s_waitcnt lgkmcnt(5)
  v_mfma_f32_16x16x32_bf16 v[104:107], a[112:115], v[52:55], v[104:107]
  s_cmp_gt_u32 s23, 3
  ds_read_b128 v[44:47], v13 offset:49152
  v_mfma_f32_16x16x32_bf16 v[108:111], a[116:119], v[52:55], v[108:111]
  v_mfma_f32_16x16x32_bf16 v[120:123], a[120:123], v[52:55], v[120:123]
  s_cselect_b32 s26, s20, 0
  v_mfma_f32_16x16x32_bf16 v[124:127], a[124:127], v[52:55], v[124:127]
  s_waitcnt lgkmcnt(5)
  v_mfma_f32_16x16x32_bf16 v[96:99], a[128:131], v[24:27], v[96:99]
  s_add_u32 s19, s19, s26
  ds_read_b128 v[48:51], v14 offset:49152
  v_mfma_f32_16x16x32_bf16 v[100:103], a[132:135], v[24:27], v[100:103]
  v_mfma_f32_16x16x32_bf16 v[112:115], a[136:139], v[24:27], v[112:115]
  s_add_u32 s25, s25, 32768
  v_mfma_f32_16x16x32_bf16 v[116:119], a[140:143], v[24:27], v[116:119]
  s_waitcnt lgkmcnt(5)
  v_mfma_f32_16x16x32_bf16 v[104:107], a[128:131], v[28:31], v[104:107]
  s_and_b32 s25, s25, 0x1ffff
  ds_read_b128 v[52:55], v15 offset:49152
  v_mfma_f32_16x16x32_bf16 v[108:111], a[132:135], v[28:31], v[108:111]
  v_mfma_f32_16x16x32_bf16 v[120:123], a[136:139], v[28:31], v[120:123]
  buffer_store_dwordx4 v[128:131], v7, s[4:7], s21 offen offset:0 sc1
  v_mfma_f32_16x16x32_bf16 v[124:127], a[140:143], v[28:31], v[124:127]
  s_waitcnt lgkmcnt(5)
  v_mfma_f32_16x16x32_bf16 v[96:99], a[144:147], v[32:35], v[96:99]
  ds_read_b128 v[24:27], v8 offset:57344
  v_mfma_f32_16x16x32_bf16 v[100:103], a[148:151], v[32:35], v[100:103]
  v_mfma_f32_16x16x32_bf16 v[112:115], a[152:155], v[32:35], v[112:115]
  v_mfma_f32_16x16x32_bf16 v[116:119], a[156:159], v[32:35], v[116:119]
  s_waitcnt lgkmcnt(5)
  v_xor_b32 v8, 0x10000, v8
  v_mfma_f32_16x16x32_bf16 v[104:107], a[144:147], v[36:39], v[104:107]
  ds_read_b128 v[28:31], v9 offset:57344
  v_mfma_f32_16x16x32_bf16 v[108:111], a[148:151], v[36:39], v[108:111]
  v_mfma_f32_16x16x32_bf16 v[120:123], a[152:155], v[36:39], v[120:123]
  buffer_store_dwordx4 v[132:135], v7, s[4:7], s21 offen offset:256 sc1
  v_mfma_f32_16x16x32_bf16 v[124:127], a[156:159], v[36:39], v[124:127]
  s_waitcnt lgkmcnt(5)
  v_xor_b32 v9, 0x10000, v9
  v_mfma_f32_16x16x32_bf16 v[96:99], a[160:163], v[40:43], v[96:99]
  ds_read_b128 v[32:35], v10 offset:57344
  v_mfma_f32_16x16x32_bf16 v[100:103], a[164:167], v[40:43], v[100:103]
  v_mfma_f32_16x16x32_bf16 v[112:115], a[168:171], v[40:43], v[112:115]
  v_mfma_f32_16x16x32_bf16 v[116:119], a[172:175], v[40:43], v[116:119]
  s_waitcnt lgkmcnt(5)
  v_xor_b32 v10, 0x10000, v10
  v_mfma_f32_16x16x32_bf16 v[104:107], a[160:163], v[44:47], v[104:107]
  ds_read_b128 v[36:39], v11 offset:57344
  v_mfma_f32_16x16x32_bf16 v[108:111], a[164:167], v[44:47], v[108:111]
  v_mfma_f32_16x16x32_bf16 v[120:123], a[168:171], v[44:47], v[120:123]
  buffer_store_dwordx4 v[136:139], v7, s[4:7], s21 offen offset:2048 sc1
  v_mfma_f32_16x16x32_bf16 v[124:127], a[172:175], v[44:47], v[124:127]
  s_waitcnt lgkmcnt(5)
  v_xor_b32 v11, 0x10000, v11
  v_mfma_f32_16x16x32_bf16 v[96:99], a[176:179], v[48:51], v[96:99]
  ds_read_b128 v[40:43], v12 offset:57344
  v_mfma_f32_16x16x32_bf16 v[100:103], a[180:183], v[48:51], v[100:103]
  v_mfma_f32_16x16x32_bf16 v[112:115], a[184:187], v[48:51], v[112:115]
  v_mfma_f32_16x16x32_bf16 v[116:119], a[188:191], v[48:51], v[116:119]
  s_waitcnt lgkmcnt(5)
  v_xor_b32 v12, 0x10000, v12
  v_mfma_f32_16x16x32_bf16 v[104:107], a[176:179], v[52:55], v[104:107]
  ds_read_b128 v[44:47], v13 offset:57344
  v_mfma_f32_16x16x32_bf16 v[108:111], a[180:183], v[52:55], v[108:111]
  v_mfma_f32_16x16x32_bf16 v[120:123], a[184:187], v[52:55], v[120:123]
  buffer_store_dwordx4 v[140:143], v7, s[4:7], s21 offen offset:2304 sc1
  v_mfma_f32_16x16x32_bf16 v[124:127], a[188:191], v[52:55], v[124:127]
  s_waitcnt lgkmcnt(5)
  v_xor_b32 v13, 0x10000, v13
  v_mfma_f32_16x16x32_bf16 v[96:99], a[192:195], v[24:27], v[96:99]
  s_mov_b32 s21, s27
  ds_read_b128 v[48:51], v14 offset:57344
  v_mfma_f32_16x16x32_bf16 v[100:103], a[196:199], v[24:27], v[100:103]
  v_mov_b32 v7, v56
  v_mfma_f32_16x16x32_bf16 v[112:115], a[200:203], v[24:27], v[112:115]
  v_mfma_f32_16x16x32_bf16 v[116:119], a[204:207], v[24:27], v[116:119]
  s_waitcnt lgkmcnt(5)
  v_xor_b32 v14, 0x10000, v14
  v_mfma_f32_16x16x32_bf16 v[104:107], a[192:195], v[28:31], v[104:107]
  s_add_u32 s27, s27, s22
  ds_read_b128 v[52:55], v15 offset:57344
  v_mfma_f32_16x16x32_bf16 v[108:111], a[196:199], v[28:31], v[108:111]
  v_mfma_f32_16x16x32_bf16 v[120:123], a[200:203], v[28:31], v[120:123]
  s_waitcnt vmcnt(16)
  s_barrier
  v_mfma_f32_16x16x32_bf16 v[124:127], a[204:207], v[28:31], v[124:127]
  s_waitcnt lgkmcnt(5)
  v_xor_b32 v15, 0x10000, v15
  v_mfma_f32_16x16x32_bf16 v[96:99], a[208:211], v[32:35], v[96:99]
  ds_read_b128 v[24:27], v8 offset:0
  v_mfma_f32_16x16x32_bf16 v[100:103], a[212:215], v[32:35], v[100:103]
  v_mfma_f32_16x16x32_bf16 v[112:115], a[216:219], v[32:35], v[112:115]
  v_mfma_f32_16x16x32_bf16 v[116:119], a[220:223], v[32:35], v[116:119]
  s_waitcnt lgkmcnt(5)
  v_mfma_f32_16x16x32_bf16 v[104:107], a[208:211], v[36:39], v[104:107]
  ds_read_b128 v[28:31], v9 offset:0
  v_mfma_f32_16x16x32_bf16 v[108:111], a[212:215], v[36:39], v[108:111]
  v_mfma_f32_16x16x32_bf16 v[120:123], a[216:219], v[36:39], v[120:123]
  v_mfma_f32_16x16x32_bf16 v[124:127], a[220:223], v[36:39], v[124:127]
  s_waitcnt lgkmcnt(5)
  v_mfma_f32_16x16x32_bf16 v[96:99], a[224:227], v[40:43], v[96:99]
  ds_read_b128 v[32:35], v10 offset:0
  v_mfma_f32_16x16x32_bf16 v[100:103], a[228:231], v[40:43], v[100:103]
  v_mfma_f32_16x16x32_bf16 v[112:115], a[232:235], v[40:43], v[112:115]
  v_mfma_f32_16x16x32_bf16 v[116:119], a[236:239], v[40:43], v[116:119]
  s_waitcnt lgkmcnt(5)
  v_mfma_f32_16x16x32_bf16 v[104:107], a[224:227], v[44:47], v[104:107]
  ds_read_b128 v[36:39], v11 offset:0
  v_mfma_f32_16x16x32_bf16 v[108:111], a[228:231], v[44:47], v[108:111]
  v_mfma_f32_16x16x32_bf16 v[120:123], a[232:235], v[44:47], v[120:123]
  v_mfma_f32_16x16x32_bf16 v[124:127], a[236:239], v[44:47], v[124:127]
  s_waitcnt lgkmcnt(5)
  v_mfma_f32_16x16x32_bf16 v[96:99], a[240:243], v[48:51], v[96:99]
  s_sub_u32 s23, s23, 1
  ds_read_b128 v[40:43], v12 offset:0
  v_mfma_f32_16x16x32_bf16 v[100:103], a[244:247], v[48:51], v[100:103]
  v_mfma_f32_16x16x32_bf16 v[112:115], a[248:251], v[48:51], v[112:115]
  v_mfma_f32_16x16x32_bf16 v[116:119], a[252:255], v[48:51], v[116:119]
  s_waitcnt lgkmcnt(5)
  v_mfma_f32_16x16x32_bf16 v[104:107], a[240:243], v[52:55], v[104:107]
  s_cmp_eq_u32 s23, 0
  ds_read_b128 v[44:47], v13 offset:0
  v_mfma_f32_16x16x32_bf16 v[108:111], a[244:247], v[52:55], v[108:111]
  v_mfma_f32_16x16x32_bf16 v[120:123], a[248:251], v[52:55], v[120:123]
  v_mfma_f32_16x16x32_bf16 v[124:127], a[252:255], v[52:55], v[124:127]
  s_cbranch_scc1 G_done1_181
  s_branch G_top_179
G_done0_180:
  s_nop 7
  s_nop 3
  v_cvt_pk_bf16_f32 v128, v64, v65
  v_cvt_pk_bf16_f32 v129, v66, v67
  v_cvt_pk_bf16_f32 v130, v68, v69
  v_cvt_pk_bf16_f32 v131, v70, v71
  buffer_store_dwordx4 v[128:131], v7, s[4:7], s21 offen offset:0 sc1
  v_cvt_pk_bf16_f32 v132, v72, v73
  v_cvt_pk_bf16_f32 v133, v74, v75
  v_cvt_pk_bf16_f32 v134, v76, v77
  v_cvt_pk_bf16_f32 v135, v78, v79
  buffer_store_dwordx4 v[132:135], v7, s[4:7], s21 offen offset:256 sc1
  v_cvt_pk_bf16_f32 v136, v80, v81
  v_cvt_pk_bf16_f32 v137, v82, v83
  v_cvt_pk_bf16_f32 v138, v84, v85
  v_cvt_pk_bf16_f32 v139, v86, v87
  buffer_store_dwordx4 v[136:139], v7, s[4:7], s21 offen offset:2048 sc1
  v_cvt_pk_bf16_f32 v140, v88, v89
  v_cvt_pk_bf16_f32 v141, v90, v91
  v_cvt_pk_bf16_f32 v142, v92, v93
  v_cvt_pk_bf16_f32 v143, v94, v95
  buffer_store_dwordx4 v[140:143], v7, s[4:7], s21 offen offset:2304 sc1
  s_branch G_fin_182
G_done1_181:
  s_nop 7
  s_nop 3
  v_cvt_pk_bf16_f32 v128, v96, v97
  v_cvt_pk_bf16_f32 v129, v98, v99
  v_cvt_pk_bf16_f32 v130, v100, v101
  v_cvt_pk_bf16_f32 v131, v102, v103
  buffer_store_dwordx4 v[128:131], v7, s[4:7], s21 offen offset:0 sc1
  v_cvt_pk_bf16_f32 v132, v104, v105
  v_cvt_pk_bf16_f32 v133, v106, v107
  v_cvt_pk_bf16_f32 v134, v108, v109
  v_cvt_pk_bf16_f32 v135, v110, v111
  buffer_store_dwordx4 v[132:135], v7, s[4:7], s21 offen offset:256 sc1
  v_cvt_pk_bf16_f32 v136, v112, v113
  v_cvt_pk_bf16_f32 v137, v114, v115
  v_cvt_pk_bf16_f32 v138, v116, v117
  v_cvt_pk_bf16_f32 v139, v118, v119
  buffer_store_dwordx4 v[136:139], v7, s[4:7], s21 offen offset:2048 sc1
  v_cvt_pk_bf16_f32 v140, v120, v121
  v_cvt_pk_bf16_f32 v141, v122, v123
  v_cvt_pk_bf16_f32 v142, v124, v125
  v_cvt_pk_bf16_f32 v143, v126, v127
  buffer_store_dwordx4 v[140:143], v7, s[4:7], s21 offen offset:2304 sc1
G_fin_182:
  s_waitcnt vmcnt(0) lgkmcnt(0)
  s_barrier
  s_waitcnt vmcnt(0)
  s_barrier
  s_mov_b32 s30, 768
  v_mov_b32 v144, s30
  v_min_u32 v145, 1, v0
  v_lshlrev_b32 v145, 30, v145
  buffer_store_dword v144, v145, s[4:7], s31 offen sc1
  s_mul_i32 s50, s64, 6
  s_add_u32 s50, s50, s65
  s_mul_i32 s76, s50, 21846
  s_lshr_b32 s76, s76, 16
  s_mul_i32 s77, s76, 3
  s_add_u32 s51, s50, 64
  s_cmp_eq_u32 s77, s50
  s_cselect_b32 s50, s76, s51
M_fin:
  s_lshr_b32 s48, s50, 2
  s_and_b32 s49, s50, 3
  s_load_dwordx2 s[8:9], s[0:1], 0
  s_load_dwordx2 s[12:13], s[0:1], 104
  s_load_dwordx2 s[32:33], s[0:1], 112
  v_and_b32 v4, 31, v1
  v_lshrrev_b32 v5, 5, v1
  v_lshlrev_b32 v5, 4, v5
  v_lshl_add_u32 v6, v4, 10, v5
  s_lshl_b32 s26, s16, 8
  s_lshl_b32 s27, s48, 15
  s_add_u32 s27, s27, s26
  s_waitcnt lgkmcnt(0)
  s_and_b32 s9, s9, 0xffff
  s_mov_b32 s10, 2097152
  s_mov_b32 s11, 0x20000
  s_and_b32 s13, s13, 0xffff
  s_mov_b32 s14, 1024
  s_mov_b32 s15, 0x20000
  s_and_b32 s33, s33, 0xffff
  s_mov_b32 s34, 2097152
  s_mov_b32 s35, 0x20000
  buffer_load_dwordx4 v[16:19], v6, s[8:11], s27 offen offset:0
  buffer_load_dwordx4 v[48:51], v5, s[12:15], s26 offen offset:0
  buffer_load_dwordx4 v[20:23], v6, s[8:11], s27 offen offset:32
  buffer_load_dwordx4 v[52:55], v5, s[12:15], s26 offen offset:32
  buffer_load_dwordx4 v[24:27], v6, s[8:11], s27 offen offset:64
  buffer_load_dwordx4 v[56:59], v5, s[12:15], s26 offen offset:64
  buffer_load_dwordx4 v[28:31], v6, s[8:11], s27 offen offset:96
  buffer_load_dwordx4 v[60:63], v5, s[12:15], s26 offen offset:96
  buffer_load_dwordx4 v[32:35], v6, s[8:11], s27 offen offset:128
  buffer_load_dwordx4 v[64:67], v5, s[12:15], s26 offen offset:128
  buffer_load_dwordx4 v[36:39], v6, s[8:11], s27 offen offset:160
  buffer_load_dwordx4 v[68:71], v5, s[12:15], s26 offen offset:160
  buffer_load_dwordx4 v[40:43], v6, s[8:11], s27 offen offset:192
  buffer_load_dwordx4 v[72:75], v5, s[12:15], s26 offen offset:192
  buffer_load_dwordx4 v[44:47], v6, s[8:11], s27 offen offset:224
  buffer_load_dwordx4 v[76:79], v5, s[12:15], s26 offen offset:224
  s_lshl_b32 s28, s48, 2
  s_add_u32 s28, s28, s49
  s_lshl_b32 s28, s28, 2
  s_add_u32 s28, s28, s16
  s_lshl_b32 s28, s28, 11
  s_waitcnt vmcnt(14)
  v_mfma_f32_32x32x16_bf16 v[80:95], v[48:51], v[16:19], 0
  s_waitcnt vmcnt(12)
  v_mfma_f32_32x32x16_bf16 v[80:95], v[52:55], v[20:23], v[80:95]
  s_waitcnt vmcnt(10)
  v_mfma_f32_32x32x16_bf16 v[80:95], v[56:59], v[24:27], v[80:95]
  s_waitcnt vmcnt(8)
  v_mfma_f32_32x32x16_bf16 v[80:95], v[60:63], v[28:31], v[80:95]
  s_waitcnt vmcnt(6)
  v_mfma_f32_32x32x16_bf16 v[80:95], v[64:67], v[32:35], v[80:95]
  s_waitcnt vmcnt(4)
  v_mfma_f32_32x32x16_bf16 v[80:95], v[68:71], v[36:39], v[80:95]
  s_waitcnt vmcnt(2)
  v_mfma_f32_32x32x16_bf16 v[80:95], v[72:75], v[40:43], v[80:95]
  s_waitcnt vmcnt(0)
  v_mfma_f32_32x32x16_bf16 v[80:95], v[76:79], v[44:47], v[80:95]
  s_mul_i32 s76, s48, 43
  s_lshr_b32 s76, s76, 9
  s_mul_i32 s76, s76, 12
  s_sub_u32 s76, s48, s76
  s_cmp_ge_u32 s76, 6
  s_addc_u32 s76, s76, 0
  s_and_b32 s77, s49, 2
  s_mul_i32 s77, s77, 7
  s_add_u32 s76, s76, s77
  v_mov_b32 v193, 0x300
  s_lshl_b32 s76, s76, 7
  s_add_u32 s76, s76, 148897792
  v_and_b32 v192, 7, v1
  v_mul_u32_u24 v192, 3584, v192
  v_add_u32 v192, s76, v192
  s_mov_b32 s71, 0
  s_branch M_vg_184
M_vw_183:
  s_sleep 2
  s_add_u32 s71, s71, 1
  s_cmp_gt_u32 s71, 262144
  s_cbranch_scc1 M_exit
M_vg_184:
  buffer_load_dword v194, v192, s[4:7], 0 offen sc1
  s_waitcnt vmcnt(0)
  v_cmp_lt_u32 vcc, v194, v193
  s_cbranch_vccnz M_vw_183
  s_add_u32 s29, s28, 150994944
  buffer_load_dwordx4 v[96:99], v2, s[4:7], s29 offen offset:0 sc1
  buffer_load_dwordx4 v[100:103], v2, s[4:7], s29 offen offset:1024 sc1
  s_add_u32 s29, s28, 153092096
  buffer_load_dwordx4 v[104:107], v2, s[4:7], s29 offen offset:0 sc1
  buffer_load_dwordx4 v[108:111], v2, s[4:7], s29 offen offset:1024 sc1
  s_add_u32 s29, s28, 155189248
  s_waitcnt vmcnt(2)
  buffer_load_dwordx4 v[112:115], v2, s[4:7], s29 offen offset:0 sc1
  buffer_load_dwordx4 v[116:119], v2, s[4:7], s29 offen offset:1024 sc1
  s_add_u32 s29, s28, 157286400
  s_waitcnt vmcnt(2)
  buffer_load_dwordx4 v[120:123], v2, s[4:7], s29 offen offset:0 sc1
  buffer_load_dwordx4 v[124:127], v2, s[4:7], s29 offen offset:1024 sc1
  s_add_u32 s29, s28, 159383552
  s_waitcnt vmcnt(2)
  buffer_load_dwordx4 v[128:131], v2, s[4:7], s29 offen offset:0 sc1
  buffer_load_dwordx4 v[132:135], v2, s[4:7], s29 offen offset:1024 sc1
  s_add_u32 s29, s28, 161480704
  s_waitcnt vmcnt(2)
  buffer_load_dwordx4 v[136:139], v2, s[4:7], s29 offen offset:0 sc1
  buffer_load_dwordx4 v[140:143], v2, s[4:7], s29 offen offset:1024 sc1
  s_add_u32 s29, s28, 163577856
  s_waitcnt vmcnt(2)
  buffer_load_dwordx4 v[144:147], v2, s[4:7], s29 offen offset:0 sc1
  buffer_load_dwordx4 v[148:151], v2, s[4:7], s29 offen offset:1024 sc1
  s_add_u32 s29, s28, 165675008
  s_waitcnt vmcnt(2)
  buffer_load_dwordx4 v[152:155], v2, s[4:7], s29 offen offset:0 sc1
  buffer_load_dwordx4 v[156:159], v2, s[4:7], s29 offen offset:1024 sc1
  v_lshlrev_b32 v7, 4, v4
  s_lshl_b32 s26, s16, 2
  v_add_u32 v4, s26, v7
  s_barrier
  ds_write_b32 v4, v80
  s_waitcnt lgkmcnt(0)
  s_barrier
  ds_read_b128 v[84:87], v7
  s_waitcnt lgkmcnt(0)
  v_add_f32 v80, v84, v85
  v_add_f32 v81, v86, v87
  v_add_f32 v80, v80, v81
  v_mul_f32 v80, 0xbfb8aa3b, v80
  v_exp_f32 v80, v80
  s_nop 0
  v_add_f32 v80, 1.0, v80
  v_rcp_f32 v80, v80
  s_nop 0
  v_sub_f32 v82, 1.0, v80
  s_waitcnt vmcnt(14)
  v_lshlrev_b32 v160, 16, v96
  v_and_b32 v161, 0xffff0000, v96
  v_lshlrev_b32 v162, 16, v97
  v_and_b32 v163, 0xffff0000, v97
  v_lshlrev_b32 v164, 16, v98
  v_and_b32 v165, 0xffff0000, v98
  v_lshlrev_b32 v166, 16, v99
  v_and_b32 v167, 0xffff0000, v99
  v_lshlrev_b32 v168, 16, v100
  v_and_b32 v169, 0xffff0000, v100
  v_lshlrev_b32 v170, 16, v101
  v_and_b32 v171, 0xffff0000, v101
  v_lshlrev_b32 v172, 16, v102
  v_and_b32 v173, 0xffff0000, v102
  v_lshlrev_b32 v174, 16, v103
  v_and_b32 v175, 0xffff0000, v103
  s_waitcnt vmcnt(12)
  v_lshlrev_b32 v8, 16, v104
  v_and_b32 v9, 0xffff0000, v104
  v_pk_add_f32 v[160:161], v[160:161], v[8:9]
  v_lshlrev_b32 v10, 16, v105
  v_and_b32 v11, 0xffff0000, v105
  v_pk_add_f32 v[162:163], v[162:163], v[10:11]
  v_lshlrev_b32 v12, 16, v106
  v_and_b32 v13, 0xffff0000, v106
  v_pk_add_f32 v[164:165], v[164:165], v[12:13]
  v_lshlrev_b32 v14, 16, v107
  v_and_b32 v15, 0xffff0000, v107
  v_pk_add_f32 v[166:167], v[166:167], v[14:15]
  v_lshlrev_b32 v8, 16, v108
  v_and_b32 v9, 0xffff0000, v108
  v_pk_add_f32 v[168:169], v[168:169], v[8:9]
  v_lshlrev_b32 v10, 16, v109
  v_and_b32 v11, 0xffff0000, v109
  v_pk_add_f32 v[170:171], v[170:171], v[10:11]
  v_lshlrev_b32 v12, 16, v110
  v_and_b32 v13, 0xffff0000, v110
  v_pk_add_f32 v[172:173], v[172:173], v[12:13]
  v_lshlrev_b32 v14, 16, v111
  v_and_b32 v15, 0xffff0000, v111
  v_pk_add_f32 v[174:175], v[174:175], v[14:15]
  s_waitcnt vmcnt(10)
  v_lshlrev_b32 v8, 16, v112
  v_and_b32 v9, 0xffff0000, v112
  v_pk_add_f32 v[160:161], v[160:161], v[8:9]
  v_lshlrev_b32 v10, 16, v113
  v_and_b32 v11, 0xffff0000, v113
  v_pk_add_f32 v[162:163], v[162:163], v[10:11]
  v_lshlrev_b32 v12, 16, v114
  v_and_b32 v13, 0xffff0000, v114
  v_pk_add_f32 v[164:165], v[164:165], v[12:13]
  v_lshlrev_b32 v14, 16, v115
  v_and_b32 v15, 0xffff0000, v115
  v_pk_add_f32 v[166:167], v[166:167], v[14:15]
  v_lshlrev_b32 v8, 16, v116
  v_and_b32 v9, 0xffff0000, v116
  v_pk_add_f32 v[168:169], v[168:169], v[8:9]
  v_lshlrev_b32 v10, 16, v117
  v_and_b32 v11, 0xffff0000, v117
  v_pk_add_f32 v[170:171], v[170:171], v[10:11]
  v_lshlrev_b32 v12, 16, v118
  v_and_b32 v13, 0xffff0000, v118
  v_pk_add_f32 v[172:173], v[172:173], v[12:13]
  v_lshlrev_b32 v14, 16, v119
  v_and_b32 v15, 0xffff0000, v119
  v_pk_add_f32 v[174:175], v[174:175], v[14:15]
  s_waitcnt vmcnt(8)
  v_lshlrev_b32 v8, 16, v120
  v_and_b32 v9, 0xffff0000, v120
  v_pk_add_f32 v[160:161], v[160:161], v[8:9]
  v_lshlrev_b32 v10, 16, v121
  v_and_b32 v11, 0xffff0000, v121
  v_pk_add_f32 v[162:163], v[162:163], v[10:11]
  v_lshlrev_b32 v12, 16, v122
  v_and_b32 v13, 0xffff0000, v122
  v_pk_add_f32 v[164:165], v[164:165], v[12:13]
  v_lshlrev_b32 v14, 16, v123
  v_and_b32 v15, 0xffff0000, v123
  v_pk_add_f32 v[166:167], v[166:167], v[14:15]
  v_lshlrev_b32 v8, 16, v124
  v_and_b32 v9, 0xffff0000, v124
  v_pk_add_f32 v[168:169], v[168:169], v[8:9]
  v_lshlrev_b32 v10, 16, v125
  v_and_b32 v11, 0xffff0000, v125
  v_pk_add_f32 v[170:171], v[170:171], v[10:11]
  v_lshlrev_b32 v12, 16, v126
  v_and_b32 v13, 0xffff0000, v126
  v_pk_add_f32 v[172:173], v[172:173], v[12:13]
  v_lshlrev_b32 v14, 16, v127
  v_and_b32 v15, 0xffff0000, v127
  v_pk_add_f32 v[174:175], v[174:175], v[14:15]
  s_waitcnt vmcnt(6)
  v_lshlrev_b32 v8, 16, v128
  v_and_b32 v9, 0xffff0000, v128
  v_pk_add_f32 v[160:161], v[160:161], v[8:9]
  v_lshlrev_b32 v10, 16, v129
  v_and_b32 v11, 0xffff0000, v129
  v_pk_add_f32 v[162:163], v[162:163], v[10:11]
  v_lshlrev_b32 v12, 16, v130
  v_and_b32 v13, 0xffff0000, v130
  v_pk_add_f32 v[164:165], v[164:165], v[12:13]
  v_lshlrev_b32 v14, 16, v131
  v_and_b32 v15, 0xffff0000, v131
  v_pk_add_f32 v[166:167], v[166:167], v[14:15]
  v_lshlrev_b32 v8, 16, v132
  v_and_b32 v9, 0xffff0000, v132
  v_pk_add_f32 v[168:169], v[168:169], v[8:9]
  v_lshlrev_b32 v10, 16, v133
  v_and_b32 v11, 0xffff0000, v133
  v_pk_add_f32 v[170:171], v[170:171], v[10:11]
  v_lshlrev_b32 v12, 16, v134
  v_and_b32 v13, 0xffff0000, v134
  v_pk_add_f32 v[172:173], v[172:173], v[12:13]
  v_lshlrev_b32 v14, 16, v135
  v_and_b32 v15, 0xffff0000, v135
  v_pk_add_f32 v[174:175], v[174:175], v[14:15]
  s_waitcnt vmcnt(4)
  v_lshlrev_b32 v8, 16, v136
  v_and_b32 v9, 0xffff0000, v136
  v_pk_add_f32 v[160:161], v[160:161], v[8:9]
  v_lshlrev_b32 v10, 16, v137
  v_and_b32 v11, 0xffff0000, v137
  v_pk_add_f32 v[162:163], v[162:163], v[10:11]
  v_lshlrev_b32 v12, 16, v138
  v_and_b32 v13, 0xffff0000, v138
  v_pk_add_f32 v[164:165], v[164:165], v[12:13]
  v_lshlrev_b32 v14, 16, v139
  v_and_b32 v15, 0xffff0000, v139
  v_pk_add_f32 v[166:167], v[166:167], v[14:15]
  v_lshlrev_b32 v8, 16, v140
  v_and_b32 v9, 0xffff0000, v140
  v_pk_add_f32 v[168:169], v[168:169], v[8:9]
  v_lshlrev_b32 v10, 16, v141
  v_and_b32 v11, 0xffff0000, v141
  v_pk_add_f32 v[170:171], v[170:171], v[10:11]
  v_lshlrev_b32 v12, 16, v142
  v_and_b32 v13, 0xffff0000, v142
  v_pk_add_f32 v[172:173], v[172:173], v[12:13]
  v_lshlrev_b32 v14, 16, v143
  v_and_b32 v15, 0xffff0000, v143
  v_pk_add_f32 v[174:175], v[174:175], v[14:15]
  s_waitcnt vmcnt(2)
  v_lshlrev_b32 v8, 16, v144
  v_and_b32 v9, 0xffff0000, v144
  v_pk_add_f32 v[160:161], v[160:161], v[8:9]
  v_lshlrev_b32 v10, 16, v145
  v_and_b32 v11, 0xffff0000, v145
  v_pk_add_f32 v[162:163], v[162:163], v[10:11]
  v_lshlrev_b32 v12, 16, v146
  v_and_b32 v13, 0xffff0000, v146
  v_pk_add_f32 v[164:165], v[164:165], v[12:13]
  v_lshlrev_b32 v14, 16, v147
  v_and_b32 v15, 0xffff0000, v147
  v_pk_add_f32 v[166:167], v[166:167], v[14:15]
  v_lshlrev_b32 v8, 16, v148
  v_and_b32 v9, 0xffff0000, v148
  v_pk_add_f32 v[168:169], v[168:169], v[8:9]
  v_lshlrev_b32 v10, 16, v149
  v_and_b32 v11, 0xffff0000, v149
  v_pk_add_f32 v[170:171], v[170:171], v[10:11]
  v_lshlrev_b32 v12, 16, v150
  v_and_b32 v13, 0xffff0000, v150
  v_pk_add_f32 v[172:173], v[172:173], v[12:13]
  v_lshlrev_b32 v14, 16, v151
  v_and_b32 v15, 0xffff0000, v151
  v_pk_add_f32 v[174:175], v[174:175], v[14:15]
  s_waitcnt vmcnt(0)
  v_lshlrev_b32 v8, 16, v152
  v_and_b32 v9, 0xffff0000, v152
  v_pk_add_f32 v[160:161], v[160:161], v[8:9]
  v_lshlrev_b32 v10, 16, v153
  v_and_b32 v11, 0xffff0000, v153
  v_pk_add_f32 v[162:163], v[162:163], v[10:11]
  v_lshlrev_b32 v12, 16, v154
  v_and_b32 v13, 0xffff0000, v154
  v_pk_add_f32 v[164:165], v[164:165], v[12:13]
  v_lshlrev_b32 v14, 16, v155
  v_and_b32 v15, 0xffff0000, v155
  v_pk_add_f32 v[166:167], v[166:167], v[14:15]
  v_lshlrev_b32 v8, 16, v156
  v_and_b32 v9, 0xffff0000, v156
  v_pk_add_f32 v[168:169], v[168:169], v[8:9]
  v_lshlrev_b32 v10, 16, v157
  v_and_b32 v11, 0xffff0000, v157
  v_pk_add_f32 v[170:171], v[170:171], v[10:11]
  v_lshlrev_b32 v12, 16, v158
  v_and_b32 v13, 0xffff0000, v158
  v_pk_add_f32 v[172:173], v[172:173], v[12:13]
  v_lshlrev_b32 v14, 16, v159
  v_and_b32 v15, 0xffff0000, v159
  v_pk_add_f32 v[174:175], v[174:175], v[14:15]
  s_and_b32 s76, s48, 1
  s_lshl_b32 s76, s76, 1
  s_lshr_b32 s77, s49, 1
  s_add_u32 s76, s76, s77
  s_mul_i32 s76, s76, 7
  s_add_u32 s76, s76, 6
  s_lshr_b32 s77, s48, 1
  s_add_u32 s77, s77, 0x201
  v_mov_b32 v193, s77
  s_lshl_b32 s76, s76, 7
  s_add_u32 s76, s76, 148897792
  v_and_b32 v192, 7, v1
  v_mul_u32_u24 v192, 3584, v192
  v_add_u32 v192, s76, v192
  s_mov_b32 s71, 0
  s_branch M_vg_186
M_vw_185:
  s_sleep 2
  s_add_u32 s71, s71, 1
  s_cmp_gt_u32 s71, 262144
  s_cbranch_scc1 M_exit
M_vg_186:
  buffer_load_dword v194, v192, s[4:7], 0 offen sc1
  s_waitcnt vmcnt(0)
  v_cmp_lt_u32 vcc, v194, v193
  s_cbranch_vccnz M_vw_185
  s_cmp_ge_u32 s48, 58
  s_cbranch_scc1 Z_fast_187
  s_add_u32 s29, s28, 167772160
  buffer_load_dwordx4 v[96:99], v2, s[4:7], s29 offen offset:0 sc1
  buffer_load_dwordx4 v[100:103], v2, s[4:7], s29 offen offset:1024 sc1
  s_add_u32 s29, s28, 169869312
  buffer_load_dwordx4 v[104:107], v2, s[4:7], s29 offen offset:0 sc1
  buffer_load_dwordx4 v[108:111], v2, s[4:7], s29 offen offset:1024 sc1
  s_add_u32 s29, s28, 171966464
  s_waitcnt vmcnt(2)
  buffer_load_dwordx4 v[112:115], v2, s[4:7], s29 offen offset:0 sc1
  buffer_load_dwordx4 v[116:119], v2, s[4:7], s29 offen offset:1024 sc1
  s_add_u32 s29, s28, 174063616
  s_waitcnt vmcnt(2)
  buffer_load_dwordx4 v[120:123], v2, s[4:7], s29 offen offset:0 sc1
  buffer_load_dwordx4 v[124:127], v2, s[4:7], s29 offen offset:1024 sc1
  s_add_u32 s29, s28, 176160768
  s_waitcnt vmcnt(2)
  buffer_load_dwordx4 v[128:131], v2, s[4:7], s29 offen offset:0 sc1
  buffer_load_dwordx4 v[132:135], v2, s[4:7], s29 offen offset:1024 sc1
  s_add_u32 s29, s28, 178257920
  s_waitcnt vmcnt(2)
  buffer_load_dwordx4 v[136:139], v2, s[4:7], s29 offen offset:0 sc1
  buffer_load_dwordx4 v[140:143], v2, s[4:7], s29 offen offset:1024 sc1
  s_add_u32 s29, s28, 180355072
  s_waitcnt vmcnt(2)
  buffer_load_dwordx4 v[144:147], v2, s[4:7], s29 offen offset:0 sc1
  buffer_load_dwordx4 v[148:151], v2, s[4:7], s29 offen offset:1024 sc1
  s_add_u32 s29, s28, 182452224
  s_waitcnt vmcnt(2)
  buffer_load_dwordx4 v[152:155], v2, s[4:7], s29 offen offset:0 sc1
  buffer_load_dwordx4 v[156:159], v2, s[4:7], s29 offen offset:1024 sc1
  s_branch Z_join_188
Z_fast_187:
  s_add_u32 s29, s28, 167772160
  buffer_load_dwordx4 v[96:99], v2, s[4:7], s29 offen offset:0 sc1
  buffer_load_dwordx4 v[100:103], v2, s[4:7], s29 offen offset:1024 sc1
  s_add_u32 s29, s28, 169869312
  buffer_load_dwordx4 v[104:107], v2, s[4:7], s29 offen offset:0 sc1
  buffer_load_dwordx4 v[108:111], v2, s[4:7], s29 offen offset:1024 sc1
  s_add_u32 s29, s28, 171966464
  buffer_load_dwordx4 v[112:115], v2, s[4:7], s29 offen offset:0 sc1
  buffer_load_dwordx4 v[116:119], v2, s[4:7], s29 offen offset:1024 sc1
  s_add_u32 s29, s28, 174063616
  buffer_load_dwordx4 v[120:123], v2, s[4:7], s29 offen offset:0 sc1
  buffer_load_dwordx4 v[124:127], v2, s[4:7], s29 offen offset:1024 sc1
  s_add_u32 s29, s28, 176160768
  buffer_load_dwordx4 v[128:131], v2, s[4:7], s29 offen offset:0 sc1
  buffer_load_dwordx4 v[132:135], v2, s[4:7], s29 offen offset:1024 sc1
  s_add_u32 s29, s28, 178257920
  buffer_load_dwordx4 v[136:139], v2, s[4:7], s29 offen offset:0 sc1
  buffer_load_dwordx4 v[140:143], v2, s[4:7], s29 offen offset:1024 sc1
  s_add_u32 s29, s28, 180355072
  buffer_load_dwordx4 v[144:147], v2, s[4:7], s29 offen offset:0 sc1
  buffer_load_dwordx4 v[148:151], v2, s[4:7], s29 offen offset:1024 sc1
  s_add_u32 s29, s28, 182452224
  buffer_load_dwordx4 v[152:155], v2, s[4:7], s29 offen offset:0 sc1
  buffer_load_dwordx4 v[156:159], v2, s[4:7], s29 offen offset:1024 sc1
Z_join_188:
  v_pk_mul_f32 v[160:161], v[160:161], v[80:81] op_sel_hi:[1,0]
  v_pk_mul_f32 v[162:163], v[162:163], v[80:81] op_sel_hi:[1,0]
  v_pk_mul_f32 v[164:165], v[164:165], v[80:81] op_sel_hi:[1,0]
  v_pk_mul_f32 v[166:167], v[166:167], v[80:81] op_sel_hi:[1,0]
  v_pk_mul_f32 v[168:169], v[168:169], v[80:81] op_sel_hi:[1,0]
  v_pk_mul_f32 v[170:171], v[170:171], v[80:81] op_sel_hi:[1,0]
  v_pk_mul_f32 v[172:173], v[172:173], v[80:81] op_sel_hi:[1,0]
  v_pk_mul_f32 v[174:175], v[174:175], v[80:81] op_sel_hi:[1,0]
  s_waitcnt vmcnt(14)
  v_lshlrev_b32 v176, 16, v96
  v_and_b32 v177, 0xffff0000, v96
  v_lshlrev_b32 v178, 16, v97
  v_and_b32 v179, 0xffff0000, v97
  v_lshlrev_b32 v180, 16, v98
  v_and_b32 v181, 0xffff0000, v98
  v_lshlrev_b32 v182, 16, v99
  v_and_b32 v183, 0xffff0000, v99
  v_lshlrev_b32 v184, 16, v100
  v_and_b32 v185, 0xffff0000, v100
  v_lshlrev_b32 v186, 16, v101
  v_and_b32 v187, 0xffff0000, v101
  v_lshlrev_b32 v188, 16, v102
  v_and_b32 v189, 0xffff0000, v102
  v_lshlrev_b32 v190, 16, v103
  v_and_b32 v191, 0xffff0000, v103
  s_waitcnt vmcnt(12)
  v_lshlrev_b32 v8, 16, v104
  v_and_b32 v9, 0xffff0000, v104
  v_pk_add_f32 v[176:177], v[176:177], v[8:9]
  v_lshlrev_b32 v10, 16, v105
  v_and_b32 v11, 0xffff0000, v105
  v_pk_add_f32 v[178:179], v[178:179], v[10:11]
  v_lshlrev_b32 v12, 16, v106
  v_and_b32 v13, 0xffff0000, v106
  v_pk_add_f32 v[180:181], v[180:181], v[12:13]
  v_lshlrev_b32 v14, 16, v107
  v_and_b32 v15, 0xffff0000, v107
  v_pk_add_f32 v[182:183], v[182:183], v[14:15]
  v_lshlrev_b32 v8, 16, v108
  v_and_b32 v9, 0xffff0000, v108
  v_pk_add_f32 v[184:185], v[184:185], v[8:9]
  v_lshlrev_b32 v10, 16, v109
  v_and_b32 v11, 0xffff0000, v109
  v_pk_add_f32 v[186:187], v[186:187], v[10:11]
  v_lshlrev_b32 v12, 16, v110
  v_and_b32 v13, 0xffff0000, v110
  v_pk_add_f32 v[188:189], v[188:189], v[12:13]
  v_lshlrev_b32 v14, 16, v111
  v_and_b32 v15, 0xffff0000, v111
  v_pk_add_f32 v[190:191], v[190:191], v[14:15]
  s_waitcnt vmcnt(10)
  v_lshlrev_b32 v8, 16, v112
  v_and_b32 v9, 0xffff0000, v112
  v_pk_add_f32 v[176:177], v[176:177], v[8:9]
  v_lshlrev_b32 v10, 16, v113
  v_and_b32 v11, 0xffff0000, v113
  v_pk_add_f32 v[178:179], v[178:179], v[10:11]
  v_lshlrev_b32 v12, 16, v114
  v_and_b32 v13, 0xffff0000, v114
  v_pk_add_f32 v[180:181], v[180:181], v[12:13]
  v_lshlrev_b32 v14, 16, v115
  v_and_b32 v15, 0xffff0000, v115
  v_pk_add_f32 v[182:183], v[182:183], v[14:15]
  v_lshlrev_b32 v8, 16, v116
  v_and_b32 v9, 0xffff0000, v116
  v_pk_add_f32 v[184:185], v[184:185], v[8:9]
  v_lshlrev_b32 v10, 16, v117
  v_and_b32 v11, 0xffff0000, v117
  v_pk_add_f32 v[186:187], v[186:187], v[10:11]
  v_lshlrev_b32 v12, 16, v118
  v_and_b32 v13, 0xffff0000, v118
  v_pk_add_f32 v[188:189], v[188:189], v[12:13]
  v_lshlrev_b32 v14, 16, v119
  v_and_b32 v15, 0xffff0000, v119
  v_pk_add_f32 v[190:191], v[190:191], v[14:15]
  s_waitcnt vmcnt(8)
  v_lshlrev_b32 v8, 16, v120
  v_and_b32 v9, 0xffff0000, v120
  v_pk_add_f32 v[176:177], v[176:177], v[8:9]
  v_lshlrev_b32 v10, 16, v121
  v_and_b32 v11, 0xffff0000, v121
  v_pk_add_f32 v[178:179], v[178:179], v[10:11]
  v_lshlrev_b32 v12, 16, v122
  v_and_b32 v13, 0xffff0000, v122
  v_pk_add_f32 v[180:181], v[180:181], v[12:13]
  v_lshlrev_b32 v14, 16, v123
  v_and_b32 v15, 0xffff0000, v123
  v_pk_add_f32 v[182:183], v[182:183], v[14:15]
  v_lshlrev_b32 v8, 16, v124
  v_and_b32 v9, 0xffff0000, v124
  v_pk_add_f32 v[184:185], v[184:185], v[8:9]
  v_lshlrev_b32 v10, 16, v125
  v_and_b32 v11, 0xffff0000, v125
  v_pk_add_f32 v[186:187], v[186:187], v[10:11]
  v_lshlrev_b32 v12, 16, v126
  v_and_b32 v13, 0xffff0000, v126
  v_pk_add_f32 v[188:189], v[188:189], v[12:13]
  v_lshlrev_b32 v14, 16, v127
  v_and_b32 v15, 0xffff0000, v127
  v_pk_add_f32 v[190:191], v[190:191], v[14:15]
  s_waitcnt vmcnt(6)
  v_lshlrev_b32 v8, 16, v128
  v_and_b32 v9, 0xffff0000, v128
  v_pk_add_f32 v[176:177], v[176:177], v[8:9]
  v_lshlrev_b32 v10, 16, v129
  v_and_b32 v11, 0xffff0000, v129
  v_pk_add_f32 v[178:179], v[178:179], v[10:11]
  v_lshlrev_b32 v12, 16, v130
  v_and_b32 v13, 0xffff0000, v130
  v_pk_add_f32 v[180:181], v[180:181], v[12:13]
  v_lshlrev_b32 v14, 16, v131
  v_and_b32 v15, 0xffff0000, v131
  v_pk_add_f32 v[182:183], v[182:183], v[14:15]
  v_lshlrev_b32 v8, 16, v132
  v_and_b32 v9, 0xffff0000, v132
  v_pk_add_f32 v[184:185], v[184:185], v[8:9]
  v_lshlrev_b32 v10, 16, v133
  v_and_b32 v11, 0xffff0000, v133
  v_pk_add_f32 v[186:187], v[186:187], v[10:11]
  v_lshlrev_b32 v12, 16, v134
  v_and_b32 v13, 0xffff0000, v134
  v_pk_add_f32 v[188:189], v[188:189], v[12:13]
  v_lshlrev_b32 v14, 16, v135
  v_and_b32 v15, 0xffff0000, v135
  v_pk_add_f32 v[190:191], v[190:191], v[14:15]
  s_waitcnt vmcnt(4)
  v_lshlrev_b32 v8, 16, v136
  v_and_b32 v9, 0xffff0000, v136
  v_pk_add_f32 v[176:177], v[176:177], v[8:9]
  v_lshlrev_b32 v10, 16, v137
  v_and_b32 v11, 0xffff0000, v137
  v_pk_add_f32 v[178:179], v[178:179], v[10:11]
  v_lshlrev_b32 v12, 16, v138
  v_and_b32 v13, 0xffff0000, v138
  v_pk_add_f32 v[180:181], v[180:181], v[12:13]
  v_lshlrev_b32 v14, 16, v139
  v_and_b32 v15, 0xffff0000, v139
  v_pk_add_f32 v[182:183], v[182:183], v[14:15]
  v_lshlrev_b32 v8, 16, v140
  v_and_b32 v9, 0xffff0000, v140
  v_pk_add_f32 v[184:185], v[184:185], v[8:9]
  v_lshlrev_b32 v10, 16, v141
  v_and_b32 v11, 0xffff0000, v141
  v_pk_add_f32 v[186:187], v[186:187], v[10:11]
  v_lshlrev_b32 v12, 16, v142
  v_and_b32 v13, 0xffff0000, v142
  v_pk_add_f32 v[188:189], v[188:189], v[12:13]
  v_lshlrev_b32 v14, 16, v143
  v_and_b32 v15, 0xffff0000, v143
  v_pk_add_f32 v[190:191], v[190:191], v[14:15]
  s_waitcnt vmcnt(2)
  v_lshlrev_b32 v8, 16, v144
  v_and_b32 v9, 0xffff0000, v144
  v_pk_add_f32 v[176:177], v[176:177], v[8:9]
  v_lshlrev_b32 v10, 16, v145
  v_and_b32 v11, 0xffff0000, v145
  v_pk_add_f32 v[178:179], v[178:179], v[10:11]
  v_lshlrev_b32 v12, 16, v146
  v_and_b32 v13, 0xffff0000, v146
  v_pk_add_f32 v[180:181], v[180:181], v[12:13]
  v_lshlrev_b32 v14, 16, v147
  v_and_b32 v15, 0xffff0000, v147
  v_pk_add_f32 v[182:183], v[182:183], v[14:15]
  v_lshlrev_b32 v8, 16, v148
  v_and_b32 v9, 0xffff0000, v148
  v_pk_add_f32 v[184:185], v[184:185], v[8:9]
  v_lshlrev_b32 v10, 16, v149
  v_and_b32 v11, 0xffff0000, v149
  v_pk_add_f32 v[186:187], v[186:187], v[10:11]
  v_lshlrev_b32 v12, 16, v150
  v_and_b32 v13, 0xffff0000, v150
  v_pk_add_f32 v[188:189], v[188:189], v[12:13]
  v_lshlrev_b32 v14, 16, v151
  v_and_b32 v15, 0xffff0000, v151
  v_pk_add_f32 v[190:191], v[190:191], v[14:15]
  s_waitcnt vmcnt(0)
  v_lshlrev_b32 v8, 16, v152
  v_and_b32 v9, 0xffff0000, v152
  v_pk_add_f32 v[176:177], v[176:177], v[8:9]
  v_lshlrev_b32 v10, 16, v153
  v_and_b32 v11, 0xffff0000, v153
  v_pk_add_f32 v[178:179], v[178:179], v[10:11]
  v_lshlrev_b32 v12, 16, v154
  v_and_b32 v13, 0xffff0000, v154
  v_pk_add_f32 v[180:181], v[180:181], v[12:13]
  v_lshlrev_b32 v14, 16, v155
  v_and_b32 v15, 0xffff0000, v155
  v_pk_add_f32 v[182:183], v[182:183], v[14:15]
  v_lshlrev_b32 v8, 16, v156
  v_and_b32 v9, 0xffff0000, v156
  v_pk_add_f32 v[184:185], v[184:185], v[8:9]
  v_lshlrev_b32 v10, 16, v157
  v_and_b32 v11, 0xffff0000, v157
  v_pk_add_f32 v[186:187], v[186:187], v[10:11]
  v_lshlrev_b32 v12, 16, v158
  v_and_b32 v13, 0xffff0000, v158
  v_pk_add_f32 v[188:189], v[188:189], v[12:13]
  v_lshlrev_b32 v14, 16, v159
  v_and_b32 v15, 0xffff0000, v159
  v_pk_add_f32 v[190:191], v[190:191], v[14:15]
  v_pk_fma_f32 v[160:161], v[176:177], v[82:83], v[160:161] op_sel_hi:[1,0,1]
  v_cvt_pk_bf16_f32 v16, v160, v161
  v_pk_fma_f32 v[162:163], v[178:179], v[82:83], v[162:163] op_sel_hi:[1,0,1]
  v_cvt_pk_bf16_f32 v17, v162, v163
  v_pk_fma_f32 v[164:165], v[180:181], v[82:83], v[164:165] op_sel_hi:[1,0,1]
  v_cvt_pk_bf16_f32 v18, v164, v165
  v_pk_fma_f32 v[166:167], v[182:183], v[82:83], v[166:167] op_sel_hi:[1,0,1]
  v_cvt_pk_bf16_f32 v19, v166, v167
  v_pk_fma_f32 v[168:169], v[184:185], v[82:83], v[168:169] op_sel_hi:[1,0,1]
  v_cvt_pk_bf16_f32 v20, v168, v169
  v_pk_fma_f32 v[170:171], v[186:187], v[82:83], v[170:171] op_sel_hi:[1,0,1]
  v_cvt_pk_bf16_f32 v21, v170, v171
  v_pk_fma_f32 v[172:173], v[188:189], v[82:83], v[172:173] op_sel_hi:[1,0,1]
  v_cvt_pk_bf16_f32 v22, v172, v173
  v_pk_fma_f32 v[174:175], v[190:191], v[82:83], v[174:175] op_sel_hi:[1,0,1]
  v_cvt_pk_bf16_f32 v23, v174, v175
  s_lshl_b32 s26, s49, 2
  s_add_u32 s26, s26, s16
  s_lshl_b32 s26, s26, 6
  s_lshl_b32 s27, s48, 15
  s_add_u32 s26, s26, s27
  buffer_store_dwordx4 v[16:19], v6, s[32:35], s26 offen offset:0
  buffer_store_dwordx4 v[20:23], v6, s[32:35], s26 offen offset:32
  s_cmp_lt_u32 s50, 64
  s_mov_b32 s50, s51
  s_cbranch_scc1 M_fin
  s_branch M_done
M_follow:
  s_lshr_b32 s48, s64, 2
  s_and_b32 s49, s64, 1
  s_bfe_u32 s50, s64, 0x10001
  s_mov_b32 s51, 2
  s_mov_b32 s23, 32
  s_load_dwordx2 s[8:9], s[0:1], 88
  s_lshl_b32 s17, s48, 19
  s_lshl_b32 s26, s49, 2
  s_add_u32 s26, s26, s16
  s_lshl_b32 s27, s26, 7
  s_add_u32 s17, s17, s27
  s_mov_b32 s18, 1024
  s_lshl_b32 s21, s48, 6
  s_add_u32 s21, s21, s50
  s_lshl_b32 s21, s21, 3
  s_add_u32 s21, s21, s26
  s_lshl_b32 s21, s21, 12
  s_add_u32 s21, s21, 167772160
  s_lshl_b32 s22, s51, 15
  s_mov_b32 s24, 1.0
  s_waitcnt lgkmcnt(0)
  s_and_b32 s9, s9, 0xffff
  s_mov_b32 s10, 4194304
  s_mov_b32 s11, 0x20000
  v_lshrrev_b32 v144, 4, v1
  v_and_b32 v56, 0xff, v2
  v_lshl_add_u32 v56, v144, 9, v56
  s_mul_i32 s26, s16, 0
  v_add_u32 v8, 0, v56
  v_add_u32 v16, 0, v2
  v_add_u32 v16, s26, v16
  v_add_u32 v9, 256, v56
  v_add_u32 v17, 1024, v2
  v_add_u32 v17, s26, v17
  v_add_u32 v10, 2048, v56
  v_add_u32 v18, 2048, v2
  v_add_u32 v18, s26, v18
  v_add_u32 v11, 2304, v56
  v_add_u32 v19, 3072, v2
  v_add_u32 v19, s26, v19
  v_add_u32 v12, 4096, v56
  v_add_u32 v20, 4096, v2
  v_add_u32 v20, s26, v20
  v_add_u32 v13, 4352, v56
  v_add_u32 v21, 5120, v2
  v_add_u32 v21, s26, v21
  v_add_u32 v14, 6144, v56
  v_add_u32 v22, 6144, v2
  v_add_u32 v22, s26, v22
  v_add_u32 v15, 6400, v56
  v_add_u32 v23, 7168, v2
  v_add_u32 v23, s26, v23
  v_mov_b32 v20, v56
  v_lshrrev_b32 v144, 3, v1
  v_mul_lo_u32 v144, v144, s18
  v_and_b32 v145, 7, v1
  v_lshl_add_u32 v144, v145, 4, v144
  s_lshl_b32 s28, s16, 15
  s_add_u32 s28, s28, 32768
  s_lshl_b32 s29, s18, 3
  s_add_u32 m0, s28, 0
  s_nop 0
  buffer_load_dwordx4 v144, s[8:11], s17 offen lds
  s_add_u32 s17, s17, s29
  s_add_u32 m0, s28, 1024
  s_nop 0
  buffer_load_dwordx4 v144, s[8:11], s17 offen lds
  s_add_u32 s17, s17, s29
  s_add_u32 m0, s28, 2048
  s_nop 0
  buffer_load_dwordx4 v144, s[8:11], s17 offen lds
  s_add_u32 s17, s17, s29
  s_add_u32 m0, s28, 3072
  s_nop 0
  buffer_load_dwordx4 v144, s[8:11], s17 offen lds
  s_add_u32 s17, s17, s29
  s_add_u32 m0, s28, 4096
  s_nop 0
  buffer_load_dwordx4 v144, s[8:11], s17 offen lds
  s_add_u32 s17, s17, s29
  s_add_u32 m0, s28, 5120
  s_nop 0
  buffer_load_dwordx4 v144, s[8:11], s17 offen lds
  s_add_u32 s17, s17, s29
  s_add_u32 m0, s28, 6144
  s_nop 0
  buffer_load_dwordx4 v144, s[8:11], s17 offen lds
  s_add_u32 s17, s17, s29
  s_add_u32 m0, s28, 7168
  s_nop 0
  buffer_load_dwordx4 v144, s[8:11], s17 offen lds
  s_add_u32 s17, s17, s29
  s_add_u32 m0, s28, 8192
  s_nop 0
  buffer_load_dwordx4 v144, s[8:11], s17 offen lds
  s_add_u32 s17, s17, s29
  s_add_u32 m0, s28, 9216
  s_nop 0
  buffer_load_dwordx4 v144, s[8:11], s17 offen lds
  s_add_u32 s17, s17, s29
  s_add_u32 m0, s28, 10240
  s_nop 0
  buffer_load_dwordx4 v144, s[8:11], s17 offen lds
  s_add_u32 s17, s17, s29
  s_add_u32 m0, s28, 11264
  s_nop 0
  buffer_load_dwordx4 v144, s[8:11], s17 offen lds
  s_add_u32 s17, s17, s29
  s_add_u32 m0, s28, 12288
  s_nop 0
  buffer_load_dwordx4 v144, s[8:11], s17 offen lds
  s_add_u32 s17, s17, s29
  s_add_u32 m0, s28, 13312
  s_nop 0
  buffer_load_dwordx4 v144, s[8:11], s17 offen lds
  s_add_u32 s17, s17, s29
  s_add_u32 m0, s28, 14336
  s_nop 0
  buffer_load_dwordx4 v144, s[8:11], s17 offen lds
  s_add_u32 s17, s17, s29
  s_add_u32 m0, s28, 15360
  s_nop 0
  buffer_load_dwordx4 v144, s[8:11], s17 offen lds
  s_add_u32 s17, s17, s29
  s_add_u32 m0, s28, 16384
  s_nop 0
  buffer_load_dwordx4 v144, s[8:11], s17 offen lds
  s_add_u32 s17, s17, s29
  s_add_u32 m0, s28, 17408
  s_nop 0
  buffer_load_dwordx4 v144, s[8:11], s17 offen lds
  s_add_u32 s17, s17, s29
  s_add_u32 m0, s28, 18432
  s_nop 0
  buffer_load_dwordx4 v144, s[8:11], s17 offen lds
  s_add_u32 s17, s17, s29
  s_add_u32 m0, s28, 19456
  s_nop 0
  buffer_load_dwordx4 v144, s[8:11], s17 offen lds
  s_add_u32 s17, s17, s29
  s_add_u32 m0, s28, 20480
  s_nop 0
  buffer_load_dwordx4 v144, s[8:11], s17 offen lds
  s_add_u32 s17, s17, s29
  s_add_u32 m0, s28, 21504
  s_nop 0
  buffer_load_dwordx4 v144, s[8:11], s17 offen lds
  s_add_u32 s17, s17, s29
  s_add_u32 m0, s28, 22528
  s_nop 0
  buffer_load_dwordx4 v144, s[8:11], s17 offen lds
  s_add_u32 s17, s17, s29
  s_add_u32 m0, s28, 23552
  s_nop 0
  buffer_load_dwordx4 v144, s[8:11], s17 offen lds
  s_add_u32 s17, s17, s29
  s_add_u32 m0, s28, 24576
  s_nop 0
  buffer_load_dwordx4 v144, s[8:11], s17 offen lds
  s_add_u32 s17, s17, s29
  s_add_u32 m0, s28, 25600
  s_nop 0
  buffer_load_dwordx4 v144, s[8:11], s17 offen lds
  s_add_u32 s17, s17, s29
  s_add_u32 m0, s28, 26624
  s_nop 0
  buffer_load_dwordx4 v144, s[8:11], s17 offen lds
  s_add_u32 s17, s17, s29
  s_add_u32 m0, s28, 27648
  s_nop 0
  buffer_load_dwordx4 v144, s[8:11], s17 offen lds
  s_add_u32 s17, s17, s29
  s_add_u32 m0, s28, 28672
  s_nop 0
  buffer_load_dwordx4 v144, s[8:11], s17 offen lds
  s_add_u32 s17, s17, s29
  s_add_u32 m0, s28, 29696
  s_nop 0
  buffer_load_dwordx4 v144, s[8:11], s17 offen lds
  s_add_u32 s17, s17, s29
  s_add_u32 m0, s28, 30720
  s_nop 0
  buffer_load_dwordx4 v144, s[8:11], s17 offen lds
  s_add_u32 s17, s17, s29
  s_add_u32 m0, s28, 31744
  s_nop 0
  buffer_load_dwordx4 v144, s[8:11], s17 offen lds
  s_add_u32 s17, s17, s29
  v_bfe_u32 v148, v1, 2, 2
  v_lshrrev_b32 v149, 5, v1
  v_lshl_add_u32 v148, v149, 4, v148
  v_bfe_u32 v149, v1, 4, 1
  v_lshl_add_u32 v148, v149, 2, v148
  v_and_b32 v149, 3, v1
  v_lshlrev_b32 v149, 4, v149
  s_mov_b32 s26, 8
  v_lshl_add_u32 v148, v148, 7, v149
  v_add_u32 v152, s28, v148
  v_add_u32 v153, 1024, v152
  v_add_u32 v154, s26, v152
  v_add_u32 v155, s26, v153
  s_waitcnt vmcnt(28)
  ds_read_b64_tr_b16 a[0:1], v152 offset:0
  ds_read_b64_tr_b16 a[2:3], v153 offset:0
  ds_read_b64_tr_b16 a[4:5], v154 offset:0
  ds_read_b64_tr_b16 a[6:7], v155 offset:0
  ds_read_b64_tr_b16 a[8:9], v152 offset:64
  ds_read_b64_tr_b16 a[10:11], v153 offset:64
  ds_read_b64_tr_b16 a[12:13], v154 offset:64
  ds_read_b64_tr_b16 a[14:15], v155 offset:64
  s_waitcnt lgkmcnt(0)
  s_add_u32 m0, s28, 0
  s_nop 0
  buffer_load_dwordx4 v144, s[8:11], s17 offen lds
  s_add_u32 s17, s17, s29
  s_add_u32 m0, s28, 1024
  s_nop 0
  buffer_load_dwordx4 v144, s[8:11], s17 offen lds
  s_add_u32 s17, s17, s29
  s_add_u32 m0, s28, 2048
  s_nop 0
  buffer_load_dwordx4 v144, s[8:11], s17 offen lds
  s_add_u32 s17, s17, s29
  s_add_u32 m0, s28, 3072
  s_nop 0
  buffer_load_dwordx4 v144, s[8:11], s17 offen lds
  s_add_u32 s17, s17, s29
  s_waitcnt vmcnt(28)
  ds_read_b64_tr_b16 a[16:17], v152 offset:4096
  ds_read_b64_tr_b16 a[18:19], v153 offset:4096
  ds_read_b64_tr_b16 a[20:21], v154 offset:4096
  ds_read_b64_tr_b16 a[22:23], v155 offset:4096
  ds_read_b64_tr_b16 a[24:25], v152 offset:4160
  ds_read_b64_tr_b16 a[26:27], v153 offset:4160
  ds_read_b64_tr_b16 a[28:29], v154 offset:4160
  ds_read_b64_tr_b16 a[30:31], v155 offset:4160
  s_waitcnt lgkmcnt(0)
  s_add_u32 m0, s28, 4096
  s_nop 0
  buffer_load_dwordx4 v144, s[8:11], s17 offen lds
  s_add_u32 s17, s17, s29
  s_add_u32 m0, s28, 5120
  s_nop 0
  buffer_load_dwordx4 v144, s[8:11], s17 offen lds
  s_add_u32 s17, s17, s29
  s_add_u32 m0, s28, 6144
  s_nop 0
  buffer_load_dwordx4 v144, s[8:11], s17 offen lds
  s_add_u32 s17, s17, s29
  s_add_u32 m0, s28, 7168
  s_nop 0
  buffer_load_dwordx4 v144, s[8:11], s17 offen lds
  s_add_u32 s17, s17, s29
  s_waitcnt vmcnt(28)
  ds_read_b64_tr_b16 a[32:33], v152 offset:8192
  ds_read_b64_tr_b16 a[34:35], v153 offset:8192
  ds_read_b64_tr_b16 a[36:37], v154 offset:8192
  ds_read_b64_tr_b16 a[38:39], v155 offset:8192
  ds_read_b64_tr_b16 a[40:41], v152 offset:8256
  ds_read_b64_tr_b16 a[42:43], v153 offset:8256
  ds_read_b64_tr_b16 a[44:45], v154 offset:8256
  ds_read_b64_tr_b16 a[46:47], v155 offset:8256
  s_waitcnt lgkmcnt(0)
  s_add_u32 m0, s28, 8192
  s_nop 0
  buffer_load_dwordx4 v144, s[8:11], s17 offen lds
  s_add_u32 s17, s17, s29
  s_add_u32 m0, s28, 9216
  s_nop 0
  buffer_load_dwordx4 v144, s[8:11], s17 offen lds
  s_add_u32 s17, s17, s29
  s_add_u32 m0, s28, 10240
  s_nop 0
  buffer_load_dwordx4 v144, s[8:11], s17 offen lds
  s_add_u32 s17, s17, s29
  s_add_u32 m0, s28, 11264
  s_nop 0
  buffer_load_dwordx4 v144, s[8:11], s17 offen lds
  s_add_u32 s17, s17, s29
  s_waitcnt vmcnt(28)
  ds_read_b64_tr_b16 a[48:49], v152 offset:12288
  ds_read_b64_tr_b16 a[50:51], v153 offset:12288
  ds_read_b64_tr_b16 a[52:53], v154 offset:12288
  ds_read_b64_tr_b16 a[54:55], v155 offset:12288
  ds_read_b64_tr_b16 a[56:57], v152 offset:12352
  ds_read_b64_tr_b16 a[58:59], v153 offset:12352
  ds_read_b64_tr_b16 a[60:61], v154 offset:12352
  ds_read_b64_tr_b16 a[62:63], v155 offset:12352
  s_waitcnt lgkmcnt(0)
  s_add_u32 m0, s28, 12288
  s_nop 0
  buffer_load_dwordx4 v144, s[8:11], s17 offen lds
  s_add_u32 s17, s17, s29
  s_add_u32 m0, s28, 13312
  s_nop 0
  buffer_load_dwordx4 v144, s[8:11], s17 offen lds
  s_add_u32 s17, s17, s29
  s_add_u32 m0, s28, 14336
  s_nop 0
  buffer_load_dwordx4 v144, s[8:11], s17 offen lds
  s_add_u32 s17, s17, s29
  s_add_u32 m0, s28, 15360
  s_nop 0
  buffer_load_dwordx4 v144, s[8:11], s17 offen lds
  s_add_u32 s17, s17, s29
  s_waitcnt vmcnt(28)
  ds_read_b64_tr_b16 a[64:65], v152 offset:16384
  ds_read_b64_tr_b16 a[66:67], v153 offset:16384
  ds_read_b64_tr_b16 a[68:69], v154 offset:16384
  ds_read_b64_tr_b16 a[70:71], v155 offset:16384
  ds_read_b64_tr_b16 a[72:73], v152 offset:16448
  ds_read_b64_tr_b16 a[74:75], v153 offset:16448
  ds_read_b64_tr_b16 a[76:77], v154 offset:16448
  ds_read_b64_tr_b16 a[78:79], v155 offset:16448
  s_waitcnt lgkmcnt(0)
  s_add_u32 m0, s28, 16384
  s_nop 0
  buffer_load_dwordx4 v144, s[8:11], s17 offen lds
  s_add_u32 s17, s17, s29
  s_add_u32 m0, s28, 17408
  s_nop 0
  buffer_load_dwordx4 v144, s[8:11], s17 offen lds
  s_add_u32 s17, s17, s29
  s_add_u32 m0, s28, 18432
  s_nop 0
  buffer_load_dwordx4 v144, s[8:11], s17 offen lds
  s_add_u32 s17, s17, s29
  s_add_u32 m0, s28, 19456
  s_nop 0
  buffer_load_dwordx4 v144, s[8:11], s17 offen lds
  s_add_u32 s17, s17, s29
  s_waitcnt vmcnt(28)
  ds_read_b64_tr_b16 a[80:81], v152 offset:20480
  ds_read_b64_tr_b16 a[82:83], v153 offset:20480
  ds_read_b64_tr_b16 a[84:85], v154 offset:20480
  ds_read_b64_tr_b16 a[86:87], v155 offset:20480
  ds_read_b64_tr_b16 a[88:89], v152 offset:20544
  ds_read_b64_tr_b16 a[90:91], v153 offset:20544
  ds_read_b64_tr_b16 a[92:93], v154 offset:20544
  ds_read_b64_tr_b16 a[94:95], v155 offset:20544
  s_waitcnt lgkmcnt(0)
  s_add_u32 m0, s28, 20480
  s_nop 0
  buffer_load_dwordx4 v144, s[8:11], s17 offen lds
  s_add_u32 s17, s17, s29
  s_add_u32 m0, s28, 21504
  s_nop 0
  buffer_load_dwordx4 v144, s[8:11], s17 offen lds
  s_add_u32 s17, s17, s29
  s_add_u32 m0, s28, 22528
  s_nop 0
  buffer_load_dwordx4 v144, s[8:11], s17 offen lds
  s_add_u32 s17, s17, s29
  s_add_u32 m0, s28, 23552
  s_nop 0
  buffer_load_dwordx4 v144, s[8:11], s17 offen lds
  s_add_u32 s17, s17, s29
  s_waitcnt vmcnt(28)
  ds_read_b64_tr_b16 a[96:97], v152 offset:24576
  ds_read_b64_tr_b16 a[98:99], v153 offset:24576
  ds_read_b64_tr_b16 a[100:101], v154 offset:24576
  ds_read_b64_tr_b16 a[102:103], v155 offset:24576
  ds_read_b64_tr_b16 a[104:105], v152 offset:24640
  ds_read_b64_tr_b16 a[106:107], v153 offset:24640
  ds_read_b64_tr_b16 a[108:109], v154 offset:24640
  ds_read_b64_tr_b16 a[110:111], v155 offset:24640
  s_waitcnt lgkmcnt(0)
  s_add_u32 m0, s28, 24576
  s_nop 0
  buffer_load_dwordx4 v144, s[8:11], s17 offen lds
  s_add_u32 s17, s17, s29
  s_add_u32 m0, s28, 25600
  s_nop 0
  buffer_load_dwordx4 v144, s[8:11], s17 offen lds
  s_add_u32 s17, s17, s29
  s_add_u32 m0, s28, 26624
  s_nop 0
  buffer_load_dwordx4 v144, s[8:11], s17 offen lds
  s_add_u32 s17, s17, s29
  s_add_u32 m0, s28, 27648
  s_nop 0
  buffer_load_dwordx4 v144, s[8:11], s17 offen lds
  s_add_u32 s17, s17, s29
  s_waitcnt vmcnt(28)
  ds_read_b64_tr_b16 a[112:113], v152 offset:28672
  ds_read_b64_tr_b16 a[114:115], v153 offset:28672
  ds_read_b64_tr_b16 a[116:117], v154 offset:28672
  ds_read_b64_tr_b16 a[118:119], v155 offset:28672
  ds_read_b64_tr_b16 a[120:121], v152 offset:28736
  ds_read_b64_tr_b16 a[122:123], v153 offset:28736
  ds_read_b64_tr_b16 a[124:125], v154 offset:28736
  ds_read_b64_tr_b16 a[126:127], v155 offset:28736
  s_waitcnt lgkmcnt(0)
  s_add_u32 m0, s28, 28672
  s_nop 0
  buffer_load_dwordx4 v144, s[8:11], s17 offen lds
  s_add_u32 s17, s17, s29
  s_add_u32 m0, s28, 29696
  s_nop 0
  buffer_load_dwordx4 v144, s[8:11], s17 offen lds
  s_add_u32 s17, s17, s29
  s_add_u32 m0, s28, 30720
  s_nop 0
  buffer_load_dwordx4 v144, s[8:11], s17 offen lds
  s_add_u32 s17, s17, s29
  s_add_u32 m0, s28, 31744
  s_nop 0
  buffer_load_dwordx4 v144, s[8:11], s17 offen lds
  s_add_u32 s17, s17, s29
  s_waitcnt vmcnt(28)
  ds_read_b64_tr_b16 a[128:129], v152 offset:0
  ds_read_b64_tr_b16 a[130:131], v153 offset:0
  ds_read_b64_tr_b16 a[132:133], v154 offset:0
  ds_read_b64_tr_b16 a[134:135], v155 offset:0
  ds_read_b64_tr_b16 a[136:137], v152 offset:64
  ds_read_b64_tr_b16 a[138:139], v153 offset:64
  ds_read_b64_tr_b16 a[140:141], v154 offset:64
  ds_read_b64_tr_b16 a[142:143], v155 offset:64
  s_waitcnt lgkmcnt(0)
  s_waitcnt vmcnt(24)
  ds_read_b64_tr_b16 a[144:145], v152 offset:4096
  ds_read_b64_tr_b16 a[146:147], v153 offset:4096
  ds_read_b64_tr_b16 a[148:149], v154 offset:4096
  ds_read_b64_tr_b16 a[150:151], v155 offset:4096
  ds_read_b64_tr_b16 a[152:153], v152 offset:4160
  ds_read_b64_tr_b16 a[154:155], v153 offset:4160
  ds_read_b64_tr_b16 a[156:157], v154 offset:4160
  ds_read_b64_tr_b16 a[158:159], v155 offset:4160
  s_waitcnt lgkmcnt(0)
  s_waitcnt vmcnt(20)
  ds_read_b64_tr_b16 a[160:161], v152 offset:8192
  ds_read_b64_tr_b16 a[162:163], v153 offset:8192
  ds_read_b64_tr_b16 a[164:165], v154 offset:8192
  ds_read_b64_tr_b16 a[166:167], v155 offset:8192
  ds_read_b64_tr_b16 a[168:169], v152 offset:8256
  ds_read_b64_tr_b16 a[170:171], v153 offset:8256
  ds_read_b64_tr_b16 a[172:173], v154 offset:8256
  ds_read_b64_tr_b16 a[174:175], v155 offset:8256
  s_waitcnt lgkmcnt(0)
  s_waitcnt vmcnt(16)
  ds_read_b64_tr_b16 a[176:177], v152 offset:12288
  ds_read_b64_tr_b16 a[178:179], v153 offset:12288
  ds_read_b64_tr_b16 a[180:181], v154 offset:12288
  ds_read_b64_tr_b16 a[182:183], v155 offset:12288
  ds_read_b64_tr_b16 a[184:185], v152 offset:12352
  ds_read_b64_tr_b16 a[186:187], v153 offset:12352
  ds_read_b64_tr_b16 a[188:189], v154 offset:12352
  ds_read_b64_tr_b16 a[190:191], v155 offset:12352
  s_waitcnt lgkmcnt(0)
  s_waitcnt vmcnt(12)
  ds_read_b64_tr_b16 a[192:193], v152 offset:16384
  ds_read_b64_tr_b16 a[194:195], v153 offset:16384
  ds_read_b64_tr_b16 a[196:197], v154 offset:16384
  ds_read_b64_tr_b16 a[198:199], v155 offset:16384
  ds_read_b64_tr_b16 a[200:201], v152 offset:16448
  ds_read_b64_tr_b16 a[202:203], v153 offset:16448
  ds_read_b64_tr_b16 a[204:205], v154 offset:16448
  ds_read_b64_tr_b16 a[206:207], v155 offset:16448
  s_waitcnt lgkmcnt(0)
  s_waitcnt vmcnt(8)
  ds_read_b64_tr_b16 a[208:209], v152 offset:20480
  ds_read_b64_tr_b16 a[210:211], v153 offset:20480
  ds_read_b64_tr_b16 a[212:213], v154 offset:20480
  ds_read_b64_tr_b16 a[214:215], v155 offset:20480
  ds_read_b64_tr_b16 a[216:217], v152 offset:20544
  ds_read_b64_tr_b16 a[218:219], v153 offset:20544
  ds_read_b64_tr_b16 a[220:221], v154 offset:20544
  ds_read_b64_tr_b16 a[222:223], v155 offset:20544
  s_waitcnt lgkmcnt(0)
  s_waitcnt vmcnt(4)
  ds_read_b64_tr_b16 a[224:225], v152 offset:24576
  ds_read_b64_tr_b16 a[226:227], v153 offset:24576
  ds_read_b64_tr_b16 a[228:229], v154 offset:24576
  ds_read_b64_tr_b16 a[230:231], v155 offset:24576
  ds_read_b64_tr_b16 a[232:233], v152 offset:24640
  ds_read_b64_tr_b16 a[234:235], v153 offset:24640
  ds_read_b64_tr_b16 a[236:237], v154 offset:24640
  ds_read_b64_tr_b16 a[238:239], v155 offset:24640
  s_waitcnt lgkmcnt(0)
  s_waitcnt vmcnt(0)
  ds_read_b64_tr_b16 a[240:241], v152 offset:28672
  ds_read_b64_tr_b16 a[242:243], v153 offset:28672
  ds_read_b64_tr_b16 a[244:245], v154 offset:28672
  ds_read_b64_tr_b16 a[246:247], v155 offset:28672
  ds_read_b64_tr_b16 a[248:249], v152 offset:28736
  ds_read_b64_tr_b16 a[250:251], v153 offset:28736
  ds_read_b64_tr_b16 a[252:253], v154 offset:28736
  ds_read_b64_tr_b16 a[254:255], v155 offset:28736
  s_waitcnt lgkmcnt(0)
  s_lshl_b32 s26, s48, 2
  s_add_u32 s26, s26, s16
  s_lshl_b32 s27, s26, 6
  s_add_u32 s27, s27, s50
  s_lshl_b32 s19, s27, 13
  s_lshl_b32 s27, s50, 5
  s_add_u32 s27, s27, s26
  s_mul_i32 s27, s27, 4096
  s_add_u32 s20, s27, 135266304
  s_lshl_b32 s25, s16, 12
  s_add_u32 s25, s25, 65536
  s_lshl_b32 s26, s16, 13
  v_add_u32 v3, s26, v2
  v_lshrrev_b32 v16, 5, v1
  v_and_b32 v17, 31, v1
  v_bfe_u32 v18, v1, 4, 1
  v_lshl_add_u32 v18, v18, 1, v16
  v_and_b32 v19, 15, v1
  v_lshl_add_u32 v18, v18, 4, v19
  v_lshl_add_u32 v5, v18, 4, s25
  v_bfe_u32 v18, v1, 2, 2
  v_lshl_add_u32 v18, v16, 2, v18
  v_and_b32 v19, 1, v1
  v_lshl_add_u32 v18, v19, 4, v18
  v_lshl_add_u32 v4, v18, 4, s25
  v_lshlrev_b32 v16, 2, v16
  v_sub_u32 v17, v17, v16
  v_mov_b32 v18, 0xf149f2ca
  v_cmp_le_i32 vcc, 0, v17
  s_nop 1
  v_cndmask_b32 v240, v18, 0, vcc
  v_cmp_le_i32 vcc, 1, v17
  s_nop 1
  v_cndmask_b32 v241, v18, 0, vcc
  v_cmp_le_i32 vcc, 2, v17
  s_nop 1
  v_cndmask_b32 v242, v18, 0, vcc
  v_cmp_le_i32 vcc, 3, v17
  s_nop 1
  v_cndmask_b32 v243, v18, 0, vcc
  v_cmp_le_i32 vcc, 8, v17
  s_nop 1
  v_cndmask_b32 v244, v18, 0, vcc
  v_cmp_le_i32 vcc, 9, v17
  s_nop 1
  v_cndmask_b32 v245, v18, 0, vcc
  v_cmp_le_i32 vcc, 10, v17
  s_nop 1
  v_cndmask_b32 v246, v18, 0, vcc
  v_cmp_le_i32 vcc, 11, v17
  s_nop 1
  v_cndmask_b32 v247, v18, 0, vcc
  v_cmp_le_i32 vcc, 16, v17
  s_nop 1
  v_cndmask_b32 v248, v18, 0, vcc
  v_cmp_le_i32 vcc, 17, v17
  s_nop 1
  v_cndmask_b32 v249, v18, 0, vcc
  v_cmp_le_i32 vcc, 18, v17
  s_nop 1
  v_cndmask_b32 v250, v18, 0, vcc
  v_cmp_le_i32 vcc, 19, v17
  s_nop 1
  v_cndmask_b32 v251, v18, 0, vcc
  v_cmp_le_i32 vcc, 24, v17
  s_nop 1
  v_cndmask_b32 v252, v18, 0, vcc
  v_cmp_le_i32 vcc, 25, v17
  s_nop 1
  v_cndmask_b32 v253, v18, 0, vcc
  v_cmp_le_i32 vcc, 26, v17
  s_nop 1
  v_cndmask_b32 v254, v18, 0, vcc
  v_cmp_le_i32 vcc, 27, v17
  s_nop 1
  v_cndmask_b32 v255, v18, 0, vcc
  v_mov_b32 v21, v2
  s_barrier
  s_lshl_b32 s77, s48, 2
  s_add_u32 s77, s77, s16
  s_mul_i32 s78, s77, 896
  s_add_u32 s76, s78, 148898304
  s_mov_b32 s71, 0
  s_branch M_sg_191
M_sw_190:
  s_sleep 8
  s_add_u32 s71, s71, 1
  s_cmp_gt_u32 s71, 262144
  s_cbranch_scc1 M_exit
M_sg_191:
  s_mov_b32 s79, 0
  s_atomic_or s79, s[72:73], s76 glc
  s_waitcnt lgkmcnt(0)
  s_cmp_lt_u32 s79, 12
  s_cbranch_scc1 M_sw_190
  s_add_u32 s76, s78, 148898048
  s_mov_b32 s71, 0
  s_branch M_sg_193
M_sw_192:
  s_sleep 8
  s_add_u32 s71, s71, 1
  s_cmp_gt_u32 s71, 262144
  s_cbranch_scc1 M_exit
M_sg_193:
  s_mov_b32 s79, 0
  s_atomic_or s79, s[72:73], s76 glc
  s_waitcnt lgkmcnt(0)
  s_cmp_lt_u32 s79, 6
  s_cbranch_scc1 M_sw_192
  s_add_u32 s76, s78, 148898176
  s_mov_b32 s71, 0
  s_branch M_sg_195
M_sw_194:
  s_sleep 8
  s_add_u32 s71, s71, 1
  s_cmp_gt_u32 s71, 262144
  s_cbranch_scc1 M_exit
M_sg_195:
  s_mov_b32 s79, 0
  s_atomic_or s79, s[72:73], s76 glc
  s_waitcnt lgkmcnt(0)
  s_cmp_lt_u32 s79, 6
  s_cbranch_scc1 M_sw_194
M_xok_189:
  s_lshl_b32 s77, s77, 7
  s_add_u32 s54, s77, 148926464
  s_add_u32 s52, s50, 1
  s_mov_b32 s53, 0
  s_mov_b32 s30, 0x200
  s_add_u32 s28, s19, 50331648
  buffer_load_dwordx4 v[144:147], v21, s[4:7], s28 offen offset:0 sc1
  buffer_load_dwordx4 v[148:151], v21, s[4:7], s28 offen offset:1024 sc1
  buffer_load_dwordx4 v[152:155], v21, s[4:7], s28 offen offset:2048 sc1
  buffer_load_dwordx4 v[156:159], v21, s[4:7], s28 offen offset:3072 sc1
  s_add_u32 s29, s19, 50335744
  buffer_load_dwordx4 v[160:163], v21, s[4:7], s29 offen offset:0 sc1
  buffer_load_dwordx4 v[164:167], v21, s[4:7], s29 offen offset:1024 sc1
  buffer_load_dwordx4 v[168:171], v21, s[4:7], s29 offen offset:2048 sc1
  buffer_load_dwordx4 v[172:175], v21, s[4:7], s29 offen offset:3072 sc1
  s_add_u32 s28, s19, 67108864
  buffer_load_dwordx4 v[176:179], v21, s[4:7], s28 offen offset:0 sc1
  buffer_load_dwordx4 v[180:183], v21, s[4:7], s28 offen offset:1024 sc1
  buffer_load_dwordx4 v[184:187], v21, s[4:7], s28 offen offset:2048 sc1
  buffer_load_dwordx4 v[188:191], v21, s[4:7], s28 offen offset:3072 sc1
  s_add_u32 s29, s19, 67112960
  buffer_load_dwordx4 v[192:195], v21, s[4:7], s29 offen offset:0 sc1
  buffer_load_dwordx4 v[196:199], v21, s[4:7], s29 offen offset:1024 sc1
  buffer_load_dwordx4 v[200:203], v21, s[4:7], s29 offen offset:2048 sc1
  buffer_load_dwordx4 v[204:207], v21, s[4:7], s29 offen offset:3072 sc1
  s_add_u32 s28, s19, 83886080
  buffer_load_dwordx4 v[208:211], v21, s[4:7], s28 offen offset:0 sc1
  buffer_load_dwordx4 v[212:215], v21, s[4:7], s28 offen offset:1024 sc1
  buffer_load_dwordx4 v[216:219], v21, s[4:7], s28 offen offset:2048 sc1
  buffer_load_dwordx4 v[220:223], v21, s[4:7], s28 offen offset:3072 sc1
  s_add_u32 s29, s19, 83890176
  buffer_load_dwordx4 v[224:227], v21, s[4:7], s29 offen offset:0 sc1
  buffer_load_dwordx4 v[228:231], v21, s[4:7], s29 offen offset:1024 sc1
  buffer_load_dwordx4 v[232:235], v21, s[4:7], s29 offen offset:2048 sc1
  buffer_load_dwordx4 v[236:239], v21, s[4:7], s29 offen offset:3072 sc1
  s_mov_b32 s24, 0
  v_mov_b32 v22, 0x40000000
  s_sub_u32 s21, s21, s22
  s_sub_u32 s21, s21, s22
  s_mov_b32 s55, 0
  v_xor_b32 v8, 0x8000, v8
  v_xor_b32 v9, 0x8000, v9
  v_xor_b32 v10, 0x8000, v10
  v_xor_b32 v11, 0x8000, v11
  v_xor_b32 v12, 0x8000, v12
  v_xor_b32 v13, 0x8000, v13
  v_xor_b32 v14, 0x8000, v14
  v_xor_b32 v15, 0x8000, v15
F_ftop_198:
  s_waitcnt vmcnt(8)
  v_mfma_f32_32x32x16_bf16 v[96:111], v[176:179], v[144:147], v[240:255]
  buffer_load_dword v23, off, s[4:7], s54 sc1
  v_cvt_pk_bf16_f32 v128, v64, v65
  v_cvt_pk_bf16_f32 v129, v66, v67
  v_cvt_pk_bf16_f32 v130, v68, v69
  v_cvt_pk_bf16_f32 v131, v70, v71
  v_mfma_f32_32x32x16_bf16 v[96:111], v[180:183], v[148:151], v[96:111]
  s_waitcnt lgkmcnt(0)
  s_barrier
  buffer_store_dwordx4 v[128:131], v22, s[4:7], s21 offen offset:0 sc1
  v_mfma_f32_32x32x16_bf16 v[96:111], v[184:187], v[152:155], v[96:111]
  ds_read_b128 v[24:27], v8 offset:0
  v_cvt_pk_bf16_f32 v132, v72, v73
  v_cvt_pk_bf16_f32 v133, v74, v75
  v_cvt_pk_bf16_f32 v134, v76, v77
  v_cvt_pk_bf16_f32 v135, v78, v79
  v_mfma_f32_32x32x16_bf16 v[96:111], v[188:191], v[156:159], v[96:111]
  ds_read_b128 v[28:31], v9 offset:0
  buffer_store_dwordx4 v[132:135], v22, s[4:7], s21 offen offset:256 sc1
  v_mfma_f32_32x32x16_bf16 v[96:111], v[192:195], v[160:163], v[96:111]
  ds_read_b128 v[32:35], v10 offset:0
  v_cvt_pk_bf16_f32 v136, v80, v81
  v_cvt_pk_bf16_f32 v137, v82, v83
  v_cvt_pk_bf16_f32 v138, v84, v85
  v_cvt_pk_bf16_f32 v139, v86, v87
  v_mfma_f32_32x32x16_bf16 v[96:111], v[196:199], v[164:167], v[96:111]
  ds_read_b128 v[36:39], v11 offset:0
  buffer_store_dwordx4 v[136:139], v22, s[4:7], s21 offen offset:2048 sc1
  v_mfma_f32_32x32x16_bf16 v[96:111], v[200:203], v[168:171], v[96:111]
  ds_read_b128 v[40:43], v12 offset:0
  v_cvt_pk_bf16_f32 v140, v88, v89
  v_cvt_pk_bf16_f32 v141, v90, v91
  v_cvt_pk_bf16_f32 v142, v92, v93
  v_cvt_pk_bf16_f32 v143, v94, v95
  v_mfma_f32_32x32x16_bf16 v[96:111], v[204:207], v[172:175], v[96:111]
  ds_read_b128 v[44:47], v13 offset:0
  buffer_store_dwordx4 v[140:143], v22, s[4:7], s21 offen offset:2304 sc1
  s_cmp_lg_u32 s24, 0
  s_cbranch_scc1 F_fhave_199
  v_mov_b32 v16, s54
  v_mov_b32 v17, s52
  s_mov_b32 s71, 0
  s_branch M_vg_201
M_vw_200:
  s_sleep 2
  s_add_u32 s71, s71, 1
  s_cmp_gt_u32 s71, 262144
  s_cbranch_scc1 M_exit
M_vg_201:
  buffer_load_dword v23, v16, s[4:7], 0 offen sc1
  s_waitcnt vmcnt(0)
  v_cmp_lt_u32 vcc, v23, v17
  s_cbranch_vccnz M_vw_200
  s_mov_b32 m0, s25
  s_nop 0
  buffer_load_dwordx4 v2, s[4:7], s20 offen offset:0 sc1 lds
  buffer_load_dwordx4 v2, s[4:7], s20 offen offset:1024 sc1 lds
  buffer_load_dwordx4 v2, s[4:7], s20 offen offset:2048 sc1 lds
  buffer_load_dwordx4 v2, s[4:7], s20 offen offset:3072 sc1 lds
  s_waitcnt vmcnt(0)
F_fhave_199:
  ds_read_b64_tr_b16 v[176:177], v4 offset:8
  ds_read_b64_tr_b16 v[178:179], v4 offset:136
  ds_read_b64_tr_b16 v[180:181], v4 offset:520
  ds_read_b64_tr_b16 v[182:183], v4 offset:648
  s_waitcnt lgkmcnt(9)
  v_mfma_f32_16x16x32_bf16 v[64:67], a[0:3], v[24:27], 0
  ds_read_b128 v[48:51], v14 offset:0
  v_mfma_f32_16x16x32_bf16 v[68:71], a[4:7], v[24:27], 0
  ds_read_b64_tr_b16 v[184:185], v4 offset:1032
  v_mfma_f32_16x16x32_bf16 v[80:83], a[8:11], v[24:27], 0
  ds_read_b64_tr_b16 v[186:187], v4 offset:1160
  v_mfma_f32_16x16x32_bf16 v[84:87], a[12:15], v[24:27], 0
  s_waitcnt lgkmcnt(11)
  ds_read_b64_tr_b16 v[188:189], v4 offset:1544
  v_mfma_f32_16x16x32_bf16 v[72:75], a[0:3], v[28:31], 0
  ds_read_b128 v[52:55], v15 offset:0
  v_mfma_f32_16x16x32_bf16 v[76:79], a[4:7], v[28:31], 0
  ds_read_b64_tr_b16 v[190:191], v4 offset:1672
  v_mfma_f32_16x16x32_bf16 v[88:91], a[8:11], v[28:31], 0
  ds_read_b64_tr_b16 v[192:193], v4 offset:2056
  v_mfma_f32_16x16x32_bf16 v[92:95], a[12:15], v[28:31], 0
  s_waitcnt lgkmcnt(14)
  ds_read_b64_tr_b16 v[194:195], v4 offset:2184
  v_mfma_f32_16x16x32_bf16 v[64:67], a[16:19], v[32:35], v[64:67]
  ds_read_b128 v[24:27], v8 offset:8192
  v_mfma_f32_16x16x32_bf16 v[68:71], a[20:23], v[32:35], v[68:71]
  ds_read_b64_tr_b16 v[196:197], v4 offset:2568
  v_mfma_f32_16x16x32_bf16 v[80:83], a[24:27], v[32:35], v[80:83]
  ds_read_b64_tr_b16 v[198:199], v4 offset:2696
  v_mfma_f32_16x16x32_bf16 v[84:87], a[28:31], v[32:35], v[84:87]
  s_waitcnt lgkmcnt(15)
  ds_read_b64_tr_b16 v[200:201], v4 offset:3080
  s_waitcnt lgkmcnt(14)
  v_mfma_f32_32x32x16_bf16 v[112:127], v[176:179], v[144:147], 0
  s_add_u32 s21, s21, s22
  ds_read_b64_tr_b16 v[202:203], v4 offset:3208
  ds_read_b64_tr_b16 v[204:205], v4 offset:3592
  ds_read_b64_tr_b16 v[206:207], v4 offset:3720
  v_max_f32 v6, v96, v97
  s_waitcnt lgkmcnt(15)
  v_mfma_f32_32x32x16_bf16 v[112:127], v[180:183], v[148:151], v[112:127]
  s_sub_u32 s23, s23, 1
  ds_read_b64 v[56:57], v5 offset:0
  ds_read_b64 v[58:59], v5 offset:1024
  ds_read_b64 v[60:61], v5 offset:2048
  v_max3_f32 v6, v6, v98, v99
  s_waitcnt lgkmcnt(15)
  v_mfma_f32_32x32x16_bf16 v[112:127], v[184:187], v[152:155], v[112:127]
  s_lshl_b32 s27, s51, 13
  ds_read_b64 v[62:63], v5 offset:3072
  v_max3_f32 v6, v6, v100, v101
  s_waitcnt lgkmcnt(13)
  v_mfma_f32_32x32x16_bf16 v[112:127], v[188:191], v[156:159], v[112:127]
  s_add_u32 s19, s19, s27
  v_max3_f32 v6, v6, v102, v103
  s_waitcnt lgkmcnt(11)
  v_mfma_f32_32x32x16_bf16 v[112:127], v[192:195], v[160:163], v[112:127]
  s_mul_i32 s27, s51, 131072
  v_max3_f32 v6, v6, v104, v105
  s_waitcnt lgkmcnt(8)
  v_mfma_f32_32x32x16_bf16 v[112:127], v[196:199], v[164:167], v[112:127]
  s_add_u32 s20, s20, s27
  v_max3_f32 v6, v6, v106, v107
  s_waitcnt lgkmcnt(6)
  v_mfma_f32_32x32x16_bf16 v[112:127], v[200:203], v[168:171], v[112:127]
  s_add_u32 s55, s55, 1
  v_max3_f32 v6, v6, v108, v109
  s_waitcnt lgkmcnt(4)
  v_mfma_f32_32x32x16_bf16 v[112:127], v[204:207], v[172:175], v[112:127]
  v_max3_f32 v6, v6, v110, v111
  s_cmp_ge_u32 s55, 2
  s_cselect_b32 s27, 0, 0x40000000
  v_or_b32 v22, s27, v20
  s_cmp_lg_u32 s23, 26
  s_cbranch_scc1 M_xok_202
  s_lshl_b32 s77, s48, 2
  s_add_u32 s77, s77, s16
  s_mul_i32 s78, s77, 896
  s_add_u32 s76, s78, 148898304
  s_mov_b32 s71, 0
  s_branch M_sg_204
M_sw_203:
  s_sleep 8
  s_add_u32 s71, s71, 1
  s_cmp_gt_u32 s71, 262144
  s_cbranch_scc1 M_exit
M_sg_204:
  s_mov_b32 s79, 0
  s_atomic_or s79, s[72:73], s76 glc
  s_waitcnt lgkmcnt(0)
  s_cmp_lt_u32 s79, 20
  s_cbranch_scc1 M_sw_203
  s_add_u32 s76, s78, 148898048
  s_mov_b32 s71, 0
  s_branch M_sg_206
M_sw_205:
  s_sleep 8
  s_add_u32 s71, s71, 1
  s_cmp_gt_u32 s71, 262144
  s_cbranch_scc1 M_exit
M_sg_206:
  s_mov_b32 s79, 0
  s_atomic_or s79, s[72:73], s76 glc
  s_waitcnt lgkmcnt(0)
  s_cmp_lt_u32 s79, 10
  s_cbranch_scc1 M_sw_205
  s_add_u32 s76, s78, 148898176
  s_mov_b32 s71, 0
  s_branch M_sg_208
M_sw_207:
  s_sleep 8
  s_add_u32 s71, s71, 1
  s_cmp_gt_u32 s71, 262144
  s_cbranch_scc1 M_exit
M_sg_208:
  s_mov_b32 s79, 0
  s_atomic_or s79, s[72:73], s76 glc
  s_waitcnt lgkmcnt(0)
  s_cmp_lt_u32 s79, 10
  s_cbranch_scc1 M_sw_207
M_xok_202:
  s_cmp_lg_u32 s23, 22
  s_cbranch_scc1 M_xok_209
  s_lshl_b32 s77, s48, 2
  s_add_u32 s77, s77, s16
  s_mul_i32 s78, s77, 896
  s_add_u32 s76, s78, 148898304
  s_mov_b32 s71, 0
  s_branch M_sg_211
M_sw_210:
  s_sleep 8
  s_add_u32 s71, s71, 1
  s_cmp_gt_u32 s71, 262144
  s_cbranch_scc1 M_exit
M_sg_211:
  s_mov_b32 s79, 0
  s_atomic_or s79, s[72:73], s76 glc
  s_waitcnt lgkmcnt(0)
  s_cmp_lt_u32 s79, 32
  s_cbranch_scc1 M_sw_210
  s_add_u32 s76, s78, 148898432
  s_mov_b32 s71, 0
  s_branch M_sg_213
M_sw_212:
  s_sleep 8
  s_add_u32 s71, s71, 1
  s_cmp_gt_u32 s71, 262144
  s_cbranch_scc1 M_exit
M_sg_213:
  s_mov_b32 s79, 0
  s_atomic_or s79, s[72:73], s76 glc
  s_waitcnt lgkmcnt(0)
  s_cmp_lt_u32 s79, 32
  s_cbranch_scc1 M_sw_212
  s_add_u32 s76, s78, 148898048
  s_mov_b32 s71, 0
  s_branch M_sg_215
M_sw_214:
  s_sleep 8
  s_add_u32 s71, s71, 1
  s_cmp_gt_u32 s71, 262144
  s_cbranch_scc1 M_exit
M_sg_215:
  s_mov_b32 s79, 0
  s_atomic_or s79, s[72:73], s76 glc
  s_waitcnt lgkmcnt(0)
  s_cmp_lt_u32 s79, 32
  s_cbranch_scc1 M_sw_214
  s_add_u32 s76, s78, 148898176
  s_mov_b32 s71, 0
  s_branch M_sg_217
M_sw_216:
  s_sleep 8
  s_add_u32 s71, s71, 1
  s_cmp_gt_u32 s71, 262144
  s_cbranch_scc1 M_exit
M_sg_217:
  s_mov_b32 s79, 0
  s_atomic_or s79, s[72:73], s76 glc
  s_waitcnt lgkmcnt(0)
  s_cmp_lt_u32 s79, 32
  s_cbranch_scc1 M_sw_216
M_xok_209:
  v_mfma_f32_16x16x32_bf16 v[72:75], a[16:19], v[36:39], v[72:75]
  ds_read_b128 v[28:31], v9 offset:8192
  v_mfma_f32_16x16x32_bf16 v[76:79], a[20:23], v[36:39], v[76:79]
  v_mfma_f32_16x16x32_bf16 v[88:91], a[24:27], v[36:39], v[88:91]
  v_mfma_f32_16x16x32_bf16 v[92:95], a[28:31], v[36:39], v[92:95]
  s_add_u32 s28, s19, 50331648
  buffer_load_dwordx4 v[144:147], v21, s[4:7], s28 offen offset:0 sc1
  v_max3_f32 v6, v6, v112, v113
  v_mfma_f32_16x16x32_bf16 v[64:67], a[32:35], v[40:43], v[64:67]
  ds_read_b128 v[32:35], v10 offset:8192
  v_max3_f32 v6, v6, v114, v115
  v_mfma_f32_16x16x32_bf16 v[68:71], a[36:39], v[40:43], v[68:71]
  v_mov_b32 v16, v6
  s_nop 1
  v_mfma_f32_16x16x32_bf16 v[80:83], a[40:43], v[40:43], v[80:83]
  v_permlane32_swap_b32 v6, v16
  v_mfma_f32_16x16x32_bf16 v[84:87], a[44:47], v[40:43], v[84:87]
  buffer_load_dwordx4 v[148:151], v21, s[4:7], s28 offen offset:1024 sc1
  s_nop 1
  v_mfma_f32_16x16x32_bf16 v[72:75], a[32:35], v[44:47], v[72:75]
  ds_read_b128 v[36:39], v11 offset:8192
  v_max_f32 v6, v6, v16
  v_mfma_f32_16x16x32_bf16 v[76:79], a[36:39], v[44:47], v[76:79]
  v_sub_f32 v96, v96, v6
  v_sub_f32 v97, v97, v6
  v_mfma_f32_16x16x32_bf16 v[88:91], a[40:43], v[44:47], v[88:91]
  v_exp_f32 v96, v96
  v_mfma_f32_16x16x32_bf16 v[92:95], a[44:47], v[44:47], v[92:95]
  buffer_load_dwordx4 v[152:155], v21, s[4:7], s28 offen offset:2048 sc1
  v_sub_f32 v98, v98, v6
  v_mfma_f32_16x16x32_bf16 v[64:67], a[48:51], v[48:51], v[64:67]
  ds_read_b128 v[40:43], v12 offset:8192
  v_mfma_f32_16x16x32_bf16 v[68:71], a[52:55], v[48:51], v[68:71]
  v_exp_f32 v97, v97
  v_mfma_f32_16x16x32_bf16 v[80:83], a[56:59], v[48:51], v[80:83]
  v_sub_f32 v99, v99, v6
  v_mfma_f32_16x16x32_bf16 v[84:87], a[60:63], v[48:51], v[84:87]
  buffer_load_dwordx4 v[156:159], v21, s[4:7], s28 offen offset:3072 sc1
  v_mfma_f32_16x16x32_bf16 v[72:75], a[48:51], v[52:55], v[72:75]
  ds_read_b128 v[44:47], v13 offset:8192
  v_mfma_f32_16x16x32_bf16 v[76:79], a[52:55], v[52:55], v[76:79]
  v_exp_f32 v98, v98
  v_mfma_f32_16x16x32_bf16 v[88:91], a[56:59], v[52:55], v[88:91]
  v_sub_f32 v100, v100, v6
  v_add_f32 v16, v96, v97
  v_mfma_f32_16x16x32_bf16 v[92:95], a[60:63], v[52:55], v[92:95]
  s_add_u32 s29, s19, 50335744
  buffer_load_dwordx4 v[160:163], v21, s[4:7], s29 offen offset:0 sc1
  v_mfma_f32_16x16x32_bf16 v[64:67], a[64:67], v[24:27], v[64:67]
  ds_read_b128 v[48:51], v14 offset:8192
  v_mfma_f32_16x16x32_bf16 v[68:71], a[68:71], v[24:27], v[68:71]
  v_exp_f32 v99, v99
  v_mfma_f32_16x16x32_bf16 v[80:83], a[72:75], v[24:27], v[80:83]
  v_sub_f32 v101, v101, v6
  v_add_f32 v16, v16, v98
  v_mfma_f32_16x16x32_bf16 v[84:87], a[76:79], v[24:27], v[84:87]
  s_waitcnt lgkmcnt(5)
  buffer_load_dwordx4 v[164:167], v21, s[4:7], s29 offen offset:1024 sc1
  v_mfma_f32_16x16x32_bf16 v[72:75], a[64:67], v[28:31], v[72:75]
  ds_read_b128 v[52:55], v15 offset:8192
  v_mfma_f32_16x16x32_bf16 v[76:79], a[68:71], v[28:31], v[76:79]
  v_exp_f32 v100, v100
  v_mfma_f32_16x16x32_bf16 v[88:91], a[72:75], v[28:31], v[88:91]
  v_sub_f32 v102, v102, v6
  v_add_f32 v16, v16, v99
  v_mfma_f32_16x16x32_bf16 v[92:95], a[76:79], v[28:31], v[92:95]
  s_waitcnt lgkmcnt(5)
  buffer_load_dwordx4 v[168:171], v21, s[4:7], s29 offen offset:2048 sc1
  v_mfma_f32_16x16x32_bf16 v[64:67], a[80:83], v[32:35], v[64:67]
  ds_read_b128 v[24:27], v8 offset:16384
  v_mfma_f32_16x16x32_bf16 v[68:71], a[84:87], v[32:35], v[68:71]
  v_exp_f32 v101, v101
  v_mfma_f32_16x16x32_bf16 v[80:83], a[88:91], v[32:35], v[80:83]
  v_sub_f32 v103, v103, v6
  v_add_f32 v16, v16, v100
  v_mfma_f32_16x16x32_bf16 v[84:87], a[92:95], v[32:35], v[84:87]
  s_waitcnt lgkmcnt(5)
  buffer_load_dwordx4 v[172:175], v21, s[4:7], s29 offen offset:3072 sc1
  v_mfma_f32_16x16x32_bf16 v[72:75], a[80:83], v[36:39], v[72:75]
  ds_read_b128 v[28:31], v9 offset:16384
  v_mfma_f32_16x16x32_bf16 v[76:79], a[84:87], v[36:39], v[76:79]
  v_exp_f32 v102, v102
  v_mfma_f32_16x16x32_bf16 v[88:91], a[88:91], v[36:39], v[88:91]
  v_sub_f32 v104, v104, v6
  v_add_f32 v16, v16, v101
  v_mfma_f32_16x16x32_bf16 v[92:95], a[92:95], v[36:39], v[92:95]
  s_waitcnt lgkmcnt(5)
  s_waitcnt vmcnt(12)
  v_readfirstlane_b32 s53, v23
  s_add_u32 s52, s52, 2
  s_cmp_ge_u32 s53, s52
  s_cselect_b32 s24, 1, 0
  s_cbranch_scc0 F_nopre_218
  s_mov_b32 m0, s25
  s_nop 0
  buffer_load_dwordx4 v2, s[4:7], s20 offen offset:0 sc1 lds
  buffer_load_dwordx4 v2, s[4:7], s20 offen offset:1024 sc1 lds
  buffer_load_dwordx4 v2, s[4:7], s20 offen offset:2048 sc1 lds
  buffer_load_dwordx4 v2, s[4:7], s20 offen offset:3072 sc1 lds
F_nopre_218:
  v_mfma_f32_16x16x32_bf16 v[64:67], a[96:99], v[40:43], v[64:67]
  ds_read_b128 v[32:35], v10 offset:16384
  v_mfma_f32_16x16x32_bf16 v[68:71], a[100:103], v[40:43], v[68:71]
  v_exp_f32 v103, v103
  v_mfma_f32_16x16x32_bf16 v[80:83], a[104:107], v[40:43], v[80:83]
  v_sub_f32 v105, v105, v6
  v_add_f32 v16, v16, v102
  v_mfma_f32_16x16x32_bf16 v[84:87], a[108:111], v[40:43], v[84:87]
  s_waitcnt lgkmcnt(5)
  s_add_u32 s28, s19, 67108864
  buffer_load_dwordx4 v[176:179], v21, s[4:7], s28 offen offset:0 sc1
  v_mfma_f32_16x16x32_bf16 v[72:75], a[96:99], v[44:47], v[72:75]
  ds_read_b128 v[36:39], v11 offset:16384
  v_mfma_f32_16x16x32_bf16 v[76:79], a[100:103], v[44:47], v[76:79]
  v_exp_f32 v104, v104
  v_mfma_f32_16x16x32_bf16 v[88:91], a[104:107], v[44:47], v[88:91]
  v_sub_f32 v106, v106, v6
  v_add_f32 v16, v16, v103
  v_mfma_f32_16x16x32_bf16 v[92:95], a[108:111], v[44:47], v[92:95]
  s_waitcnt lgkmcnt(5)
  buffer_load_dwordx4 v[180:183], v21, s[4:7], s28 offen offset:1024 sc1
  v_mfma_f32_16x16x32_bf16 v[64:67], a[112:115], v[48:51], v[64:67]
  ds_read_b128 v[40:43], v12 offset:16384
  v_mfma_f32_16x16x32_bf16 v[68:71], a[116:119], v[48:51], v[68:71]
  v_exp_f32 v105, v105
  v_mfma_f32_16x16x32_bf16 v[80:83], a[120:123], v[48:51], v[80:83]
  v_sub_f32 v107, v107, v6
  v_add_f32 v16, v16, v104
  v_mfma_f32_16x16x32_bf16 v[84:87], a[124:127], v[48:51], v[84:87]
  s_waitcnt lgkmcnt(5)
  buffer_load_dwordx4 v[184:187], v21, s[4:7], s28 offen offset:2048 sc1
  v_mfma_f32_16x16x32_bf16 v[72:75], a[112:115], v[52:55], v[72:75]
  ds_read_b128 v[44:47], v13 offset:16384
  v_mfma_f32_16x16x32_bf16 v[76:79], a[116:119], v[52:55], v[76:79]
  v_exp_f32 v106, v106
  v_mfma_f32_16x16x32_bf16 v[88:91], a[120:123], v[52:55], v[88:91]
  v_sub_f32 v108, v108, v6
  v_add_f32 v16, v16, v105
  v_mfma_f32_16x16x32_bf16 v[92:95], a[124:127], v[52:55], v[92:95]
  s_waitcnt lgkmcnt(5)
  buffer_load_dwordx4 v[188:191], v21, s[4:7], s28 offen offset:3072 sc1
  v_mfma_f32_16x16x32_bf16 v[64:67], a[128:131], v[24:27], v[64:67]
  ds_read_b128 v[48:51], v14 offset:16384
  v_mfma_f32_16x16x32_bf16 v[68:71], a[132:135], v[24:27], v[68:71]
  v_exp_f32 v107, v107
  v_mfma_f32_16x16x32_bf16 v[80:83], a[136:139], v[24:27], v[80:83]
  v_sub_f32 v109, v109, v6
  v_add_f32 v16, v16, v106
  v_mfma_f32_16x16x32_bf16 v[84:87], a[140:143], v[24:27], v[84:87]
  s_waitcnt lgkmcnt(5)
  s_add_u32 s29, s19, 67112960
  buffer_load_dwordx4 v[192:195], v21, s[4:7], s29 offen offset:0 sc1
  v_mfma_f32_16x16x32_bf16 v[72:75], a[128:131], v[28:31], v[72:75]
  ds_read_b128 v[52:55], v15 offset:16384
  v_mfma_f32_16x16x32_bf16 v[76:79], a[132:135], v[28:31], v[76:79]
  v_exp_f32 v108, v108
  v_mfma_f32_16x16x32_bf16 v[88:91], a[136:139], v[28:31], v[88:91]
  v_sub_f32 v110, v110, v6
  v_add_f32 v16, v16, v107
  v_mfma_f32_16x16x32_bf16 v[92:95], a[140:143], v[28:31], v[92:95]
  s_waitcnt lgkmcnt(5)
  buffer_load_dwordx4 v[196:199], v21, s[4:7], s29 offen offset:1024 sc1
  v_mfma_f32_16x16x32_bf16 v[64:67], a[144:147], v[32:35], v[64:67]
  ds_read_b128 v[24:27], v8 offset:24576
  v_mfma_f32_16x16x32_bf16 v[68:71], a[148:151], v[32:35], v[68:71]
  v_exp_f32 v109, v109
  v_mfma_f32_16x16x32_bf16 v[80:83], a[152:155], v[32:35], v[80:83]
  v_sub_f32 v111, v111, v6
  v_add_f32 v16, v16, v108
  v_mfma_f32_16x16x32_bf16 v[84:87], a[156:159], v[32:35], v[84:87]
  s_waitcnt lgkmcnt(5)
  buffer_load_dwordx4 v[200:203], v21, s[4:7], s29 offen offset:2048 sc1
  v_mfma_f32_16x16x32_bf16 v[72:75], a[144:147], v[36:39], v[72:75]
  ds_read_b128 v[28:31], v9 offset:24576
  v_mfma_f32_16x16x32_bf16 v[76:79], a[148:151], v[36:39], v[76:79]
  v_exp_f32 v110, v110
  v_mfma_f32_16x16x32_bf16 v[88:91], a[152:155], v[36:39], v[88:91]
  v_sub_f32 v112, v112, v6
  v_add_f32 v16, v16, v109
  v_mfma_f32_16x16x32_bf16 v[92:95], a[156:159], v[36:39], v[92:95]
  s_waitcnt lgkmcnt(5)
  buffer_load_dwordx4 v[204:207], v21, s[4:7], s29 offen offset:3072 sc1
  v_mfma_f32_16x16x32_bf16 v[64:67], a[160:163], v[40:43], v[64:67]
  ds_read_b128 v[32:35], v10 offset:24576
  v_mfma_f32_16x16x32_bf16 v[68:71], a[164:167], v[40:43], v[68:71]
  v_exp_f32 v111, v111
  v_mfma_f32_16x16x32_bf16 v[80:83], a[168:171], v[40:43], v[80:83]
  v_sub_f32 v113, v113, v6
  v_add_f32 v16, v16, v110
  v_mfma_f32_16x16x32_bf16 v[84:87], a[172:175], v[40:43], v[84:87]
  s_waitcnt lgkmcnt(5)
  v_exp_f32 v112, v112
  v_mfma_f32_16x16x32_bf16 v[72:75], a[160:163], v[44:47], v[72:75]
  ds_read_b128 v[36:39], v11 offset:24576
  v_sub_f32 v114, v114, v6
  v_mfma_f32_16x16x32_bf16 v[76:79], a[164:167], v[44:47], v[76:79]
  v_add_f32 v16, v16, v111
  v_mfma_f32_16x16x32_bf16 v[88:91], a[168:171], v[44:47], v[88:91]
  v_exp_f32 v113, v113
  v_mfma_f32_16x16x32_bf16 v[92:95], a[172:175], v[44:47], v[92:95]
  s_waitcnt lgkmcnt(5)
  v_sub_f32 v115, v115, v6
  v_add_f32 v16, v16, v112
  v_mfma_f32_16x16x32_bf16 v[64:67], a[176:179], v[48:51], v[64:67]
  ds_read_b128 v[40:43], v12 offset:24576
  v_mfma_f32_16x16x32_bf16 v[68:71], a[180:183], v[48:51], v[68:71]
  v_exp_f32 v114, v114
  v_mfma_f32_16x16x32_bf16 v[80:83], a[184:187], v[48:51], v[80:83]
  v_add_f32 v16, v16, v113
  v_mfma_f32_16x16x32_bf16 v[84:87], a[188:191], v[48:51], v[84:87]
  s_waitcnt lgkmcnt(5)
  v_exp_f32 v115, v115
  v_mfma_f32_16x16x32_bf16 v[72:75], a[176:179], v[52:55], v[72:75]
  ds_read_b128 v[44:47], v13 offset:24576
  v_add_f32 v16, v16, v114
  v_mfma_f32_16x16x32_bf16 v[76:79], a[180:183], v[52:55], v[76:79]
  v_add_f32 v16, v16, v115
  v_mov_b32 v17, v16
  v_mfma_f32_16x16x32_bf16 v[88:91], a[184:187], v[52:55], v[88:91]
  s_nop 1
  v_mfma_f32_16x16x32_bf16 v[92:95], a[188:191], v[52:55], v[92:95]
  s_waitcnt lgkmcnt(5)
  v_permlane32_swap_b32 v16, v17
  v_mfma_f32_16x16x32_bf16 v[64:67], a[192:195], v[24:27], v[64:67]
  ds_read_b128 v[48:51], v14 offset:24576
  s_nop 1
  v_mfma_f32_16x16x32_bf16 v[68:71], a[196:199], v[24:27], v[68:71]
  v_add_f32 v16, v16, v17
  v_mfma_f32_16x16x32_bf16 v[80:83], a[200:203], v[24:27], v[80:83]
  v_rcp_f32 v6, v16
  v_mfma_f32_16x16x32_bf16 v[84:87], a[204:207], v[24:27], v[84:87]
  s_waitcnt lgkmcnt(5)
  s_nop 0
  v_mul_f32 v96, v6, v96
  v_mfma_f32_16x16x32_bf16 v[72:75], a[192:195], v[28:31], v[72:75]
  ds_read_b128 v[52:55], v15 offset:24576
  v_mul_f32 v97, v6, v97
  v_mfma_f32_16x16x32_bf16 v[76:79], a[196:199], v[28:31], v[76:79]
  v_cvt_pk_bf16_f32 v128, v96, v97
  v_mul_f32 v98, v6, v98
  v_mfma_f32_16x16x32_bf16 v[88:91], a[200:203], v[28:31], v[88:91]
  v_mul_f32 v99, v6, v99
  v_cvt_pk_bf16_f32 v129, v98, v99
  v_mfma_f32_16x16x32_bf16 v[92:95], a[204:207], v[28:31], v[92:95]
  s_waitcnt lgkmcnt(5)
  v_mul_f32 v100, v6, v100
  v_mul_f32 v101, v6, v101
  v_mfma_f32_16x16x32_bf16 v[64:67], a[208:211], v[32:35], v[64:67]
  v_cvt_pk_bf16_f32 v130, v100, v101
  v_mul_f32 v102, v6, v102
  v_mfma_f32_16x16x32_bf16 v[68:71], a[212:215], v[32:35], v[68:71]
  v_mul_f32 v103, v6, v103
  v_cvt_pk_bf16_f32 v131, v102, v103
  v_mfma_f32_16x16x32_bf16 v[80:83], a[216:219], v[32:35], v[80:83]
  v_mul_f32 v104, v6, v104
  v_mul_f32 v105, v6, v105
  v_mfma_f32_16x16x32_bf16 v[84:87], a[220:223], v[32:35], v[84:87]
  s_waitcnt lgkmcnt(4)
  v_cvt_pk_bf16_f32 v132, v104, v105
  v_mul_f32 v106, v6, v106
  v_mfma_f32_16x16x32_bf16 v[72:75], a[208:211], v[36:39], v[72:75]
  v_mul_f32 v107, v6, v107
  v_cvt_pk_bf16_f32 v133, v106, v107
  v_mfma_f32_16x16x32_bf16 v[76:79], a[212:215], v[36:39], v[76:79]
  v_mul_f32 v108, v6, v108
  v_mul_f32 v109, v6, v109
  v_mfma_f32_16x16x32_bf16 v[88:91], a[216:219], v[36:39], v[88:91]
  v_cvt_pk_bf16_f32 v134, v108, v109
  v_mul_f32 v110, v6, v110
  v_mfma_f32_16x16x32_bf16 v[92:95], a[220:223], v[36:39], v[92:95]
  s_waitcnt lgkmcnt(3)
  v_mul_f32 v111, v6, v111
  v_cvt_pk_bf16_f32 v135, v110, v111
  v_mfma_f32_16x16x32_bf16 v[64:67], a[224:227], v[40:43], v[64:67]
  v_mul_f32 v112, v6, v112
  v_mul_f32 v113, v6, v113
  v_mfma_f32_16x16x32_bf16 v[68:71], a[228:231], v[40:43], v[68:71]
  v_cvt_pk_bf16_f32 v136, v112, v113
  v_mul_f32 v114, v6, v114
  v_mfma_f32_16x16x32_bf16 v[80:83], a[232:235], v[40:43], v[80:83]
  v_mul_f32 v115, v6, v115
  v_cvt_pk_bf16_f32 v137, v114, v115
  v_mfma_f32_16x16x32_bf16 v[84:87], a[236:239], v[40:43], v[84:87]
  s_waitcnt lgkmcnt(2)
  v_mfma_f32_16x16x32_bf16 v[72:75], a[224:227], v[44:47], v[72:75]
  v_mfma_f32_16x16x32_bf16 v[76:79], a[228:231], v[44:47], v[76:79]
  s_nop 0
  v_mfma_f32_32x32x16_bf16 v[112:127], v[208:211], v[128:131], 0
  v_mfma_f32_32x32x16_bf16 v[112:127], v[212:215], v[132:135], v[112:127]
  v_mfma_f32_32x32x8_bf16 v[112:127], v[56:57], v[136:137], v[112:127]
  v_mfma_f32_32x32x16_bf16 v[96:111], v[216:219], v[128:131], 0
  s_add_u32 s28, s19, 83886080
  buffer_load_dwordx4 v[208:211], v21, s[4:7], s28 offen offset:0 sc1
  buffer_load_dwordx4 v[212:215], v21, s[4:7], s28 offen offset:1024 sc1
  v_mfma_f32_32x32x16_bf16 v[96:111], v[220:223], v[132:135], v[96:111]
  v_cvt_pk_bf16_f32 v112, v112, v113
  v_cvt_pk_bf16_f32 v113, v114, v115
  v_cvt_pk_bf16_f32 v114, v116, v117
  v_cvt_pk_bf16_f32 v115, v118, v119
  v_cvt_pk_bf16_f32 v116, v120, v121
  v_cvt_pk_bf16_f32 v117, v122, v123
  v_mfma_f32_32x32x8_bf16 v[96:111], v[58:59], v[136:137], v[96:111]
  ds_write_b128 v3, v[112:115] offset:0
  v_cvt_pk_bf16_f32 v118, v124, v125
  v_cvt_pk_bf16_f32 v119, v126, v127
  ds_write_b128 v3, v[116:119] offset:1024
  v_mfma_f32_32x32x16_bf16 v[112:127], v[224:227], v[128:131], 0
  buffer_load_dwordx4 v[216:219], v21, s[4:7], s28 offen offset:2048 sc1
  buffer_load_dwordx4 v[220:223], v21, s[4:7], s28 offen offset:3072 sc1
  v_mfma_f32_32x32x16_bf16 v[112:127], v[228:231], v[132:135], v[112:127]
  v_cvt_pk_bf16_f32 v96, v96, v97
  v_cvt_pk_bf16_f32 v97, v98, v99
  v_cvt_pk_bf16_f32 v98, v100, v101
  v_cvt_pk_bf16_f32 v99, v102, v103
  v_cvt_pk_bf16_f32 v100, v104, v105
  v_cvt_pk_bf16_f32 v101, v106, v107
  v_mfma_f32_32x32x8_bf16 v[112:127], v[60:61], v[136:137], v[112:127]
  ds_write_b128 v3, v[96:99] offset:2048
  v_cvt_pk_bf16_f32 v102, v108, v109
  v_cvt_pk_bf16_f32 v103, v110, v111
  ds_write_b128 v3, v[100:103] offset:3072
  v_mfma_f32_32x32x16_bf16 v[96:111], v[232:235], v[128:131], 0
  s_add_u32 s29, s19, 83890176
  buffer_load_dwordx4 v[224:227], v21, s[4:7], s29 offen offset:0 sc1
  buffer_load_dwordx4 v[228:231], v21, s[4:7], s29 offen offset:1024 sc1
  v_mfma_f32_32x32x16_bf16 v[96:111], v[236:239], v[132:135], v[96:111]
  v_cvt_pk_bf16_f32 v112, v112, v113
  v_cvt_pk_bf16_f32 v113, v114, v115
  v_cvt_pk_bf16_f32 v114, v116, v117
  v_cvt_pk_bf16_f32 v115, v118, v119
  v_cvt_pk_bf16_f32 v116, v120, v121
  v_cvt_pk_bf16_f32 v117, v122, v123
  v_mfma_f32_32x32x8_bf16 v[96:111], v[62:63], v[136:137], v[96:111]
  ds_write_b128 v3, v[112:115] offset:4096
  v_cvt_pk_bf16_f32 v118, v124, v125
  v_cvt_pk_bf16_f32 v119, v126, v127
  ds_write_b128 v3, v[116:119] offset:5120
  v_mfma_f32_16x16x32_bf16 v[88:91], a[232:235], v[44:47], v[88:91]
  buffer_load_dwordx4 v[232:235], v21, s[4:7], s29 offen offset:2048 sc1
  v_mfma_f32_16x16x32_bf16 v[92:95], a[236:239], v[44:47], v[92:95]
  s_waitcnt lgkmcnt(7)
  buffer_load_dwordx4 v[236:239], v21, s[4:7], s29 offen offset:3072 sc1
  v_mfma_f32_16x16x32_bf16 v[64:67], a[240:243], v[48:51], v[64:67]
  v_mfma_f32_16x16x32_bf16 v[68:71], a[244:247], v[48:51], v[68:71]
  v_cvt_pk_bf16_f32 v96, v96, v97
  v_cvt_pk_bf16_f32 v97, v98, v99
  v_mfma_f32_16x16x32_bf16 v[80:83], a[248:251], v[48:51], v[80:83]
  v_cvt_pk_bf16_f32 v98, v100, v101
  v_cvt_pk_bf16_f32 v99, v102, v103
  v_mfma_f32_16x16x32_bf16 v[84:87], a[252:255], v[48:51], v[84:87]
  s_waitcnt lgkmcnt(6)
  v_cvt_pk_bf16_f32 v100, v104, v105
  v_cvt_pk_bf16_f32 v101, v106, v107
  v_mfma_f32_16x16x32_bf16 v[72:75], a[240:243], v[52:55], v[72:75]
  v_cvt_pk_bf16_f32 v102, v108, v109
  v_cvt_pk_bf16_f32 v103, v110, v111
  v_mfma_f32_16x16x32_bf16 v[76:79], a[244:247], v[52:55], v[76:79]
  v_mfma_f32_16x16x32_bf16 v[88:91], a[248:251], v[52:55], v[88:91]
  ds_write_b128 v3, v[96:99] offset:6144
  v_xor_b32 v8, 0x8000, v8
  v_mfma_f32_16x16x32_bf16 v[92:95], a[252:255], v[52:55], v[92:95]
  ds_write_b128 v3, v[100:103] offset:7168
  v_xor_b32 v9, 0x8000, v9
  v_xor_b32 v10, 0x8000, v10
  v_xor_b32 v11, 0x8000, v11
  v_xor_b32 v12, 0x8000, v12
  v_xor_b32 v13, 0x8000, v13
  v_xor_b32 v14, 0x8000, v14
  v_xor_b32 v15, 0x8000, v15
  v_xor_b32 v3, 0x8000, v3
  s_cmp_lt_u32 s55, 25
  s_cbranch_scc1 F_ftop_198
  s_waitcnt lgkmcnt(0)
  s_barrier
  ds_read_b128 v[24:27], v8 offset:0
  ds_read_b128 v[28:31], v9 offset:0
  ds_read_b128 v[32:35], v10 offset:0
  ds_read_b128 v[36:39], v11 offset:0
  ds_read_b128 v[40:43], v12 offset:0
  ds_read_b128 v[44:47], v13 offset:0
  v_cvt_pk_bf16_f32 v128, v64, v65
  v_cvt_pk_bf16_f32 v129, v66, v67
  v_cvt_pk_bf16_f32 v130, v68, v69
  v_cvt_pk_bf16_f32 v131, v70, v71
  buffer_store_dwordx4 v[128:131], v22, s[4:7], s21 offen offset:0 sc1
  v_cvt_pk_bf16_f32 v132, v72, v73
  v_cvt_pk_bf16_f32 v133, v74, v75
  v_cvt_pk_bf16_f32 v134, v76, v77
  v_cvt_pk_bf16_f32 v135, v78, v79
  buffer_store_dwordx4 v[132:135], v22, s[4:7], s21 offen offset:256 sc1
  v_cvt_pk_bf16_f32 v136, v80, v81
  v_cvt_pk_bf16_f32 v137, v82, v83
  v_cvt_pk_bf16_f32 v138, v84, v85
  v_cvt_pk_bf16_f32 v139, v86, v87
  buffer_store_dwordx4 v[136:139], v22, s[4:7], s21 offen offset:2048 sc1
  v_cvt_pk_bf16_f32 v140, v88, v89
  v_cvt_pk_bf16_f32 v141, v90, v91
  v_cvt_pk_bf16_f32 v142, v92, v93
  v_cvt_pk_bf16_f32 v143, v94, v95
  buffer_store_dwordx4 v[140:143], v22, s[4:7], s21 offen offset:2304 sc1
  s_add_u32 s21, s21, s22
  s_waitcnt lgkmcnt(5)
  v_mfma_f32_16x16x32_bf16 v[64:67], a[0:3], v[24:27], 0
  ds_read_b128 v[48:51], v14 offset:0
  v_mfma_f32_16x16x32_bf16 v[68:71], a[4:7], v[24:27], 0
  v_mfma_f32_16x16x32_bf16 v[80:83], a[8:11], v[24:27], 0
  v_mfma_f32_16x16x32_bf16 v[84:87], a[12:15], v[24:27], 0
  s_waitcnt lgkmcnt(5)
  v_mfma_f32_16x16x32_bf16 v[72:75], a[0:3], v[28:31], 0
  ds_read_b128 v[52:55], v15 offset:0
  v_mfma_f32_16x16x32_bf16 v[76:79], a[4:7], v[28:31], 0
  v_mfma_f32_16x16x32_bf16 v[88:91], a[8:11], v[28:31], 0
  v_mfma_f32_16x16x32_bf16 v[92:95], a[12:15], v[28:31], 0
  s_waitcnt lgkmcnt(5)
  v_mfma_f32_16x16x32_bf16 v[64:67], a[16:19], v[32:35], v[64:67]
  ds_read_b128 v[24:27], v8 offset:8192
  v_mfma_f32_16x16x32_bf16 v[68:71], a[20:23], v[32:35], v[68:71]
  v_mfma_f32_16x16x32_bf16 v[80:83], a[24:27], v[32:35], v[80:83]
  v_mfma_f32_16x16x32_bf16 v[84:87], a[28:31], v[32:35], v[84:87]
  s_waitcnt lgkmcnt(5)
  v_mfma_f32_16x16x32_bf16 v[72:75], a[16:19], v[36:39], v[72:75]
  ds_read_b128 v[28:31], v9 offset:8192
  v_mfma_f32_16x16x32_bf16 v[76:79], a[20:23], v[36:39], v[76:79]
  v_mfma_f32_16x16x32_bf16 v[88:91], a[24:27], v[36:39], v[88:91]
  v_mfma_f32_16x16x32_bf16 v[92:95], a[28:31], v[36:39], v[92:95]
  s_waitcnt lgkmcnt(5)
  v_mfma_f32_16x16x32_bf16 v[64:67], a[32:35], v[40:43], v[64:67]
  ds_read_b128 v[32:35], v10 offset:8192
  v_mfma_f32_16x16x32_bf16 v[68:71], a[36:39], v[40:43], v[68:71]
  v_mfma_f32_16x16x32_bf16 v[80:83], a[40:43], v[40:43], v[80:83]
  v_mfma_f32_16x16x32_bf16 v[84:87], a[44:47], v[40:43], v[84:87]
  s_waitcnt lgkmcnt(5)
  v_mfma_f32_16x16x32_bf16 v[72:75], a[32:35], v[44:47], v[72:75]
  ds_read_b128 v[36:39], v11 offset:8192
  v_mfma_f32_16x16x32_bf16 v[76:79], a[36:39], v[44:47], v[76:79]
  v_mfma_f32_16x16x32_bf16 v[88:91], a[40:43], v[44:47], v[88:91]
  v_mfma_f32_16x16x32_bf16 v[92:95], a[44:47], v[44:47], v[92:95]
  s_waitcnt lgkmcnt(5)
  v_mfma_f32_16x16x32_bf16 v[64:67], a[48:51], v[48:51], v[64:67]
  ds_read_b128 v[40:43], v12 offset:8192
  v_mfma_f32_16x16x32_bf16 v[68:71], a[52:55], v[48:51], v[68:71]
  v_mfma_f32_16x16x32_bf16 v[80:83], a[56:59], v[48:51], v[80:83]
  v_mfma_f32_16x16x32_bf16 v[84:87], a[60:63], v[48:51], v[84:87]
  s_waitcnt lgkmcnt(5)
  v_mfma_f32_16x16x32_bf16 v[72:75], a[48:51], v[52:55], v[72:75]
  ds_read_b128 v[44:47], v13 offset:8192
  v_mfma_f32_16x16x32_bf16 v[76:79], a[52:55], v[52:55], v[76:79]
  v_mfma_f32_16x16x32_bf16 v[88:91], a[56:59], v[52:55], v[88:91]
  v_mfma_f32_16x16x32_bf16 v[92:95], a[60:63], v[52:55], v[92:95]
  s_waitcnt lgkmcnt(5)
  v_mfma_f32_16x16x32_bf16 v[64:67], a[64:67], v[24:27], v[64:67]
  ds_read_b128 v[48:51], v14 offset:8192
  v_mfma_f32_16x16x32_bf16 v[68:71], a[68:71], v[24:27], v[68:71]
  v_mfma_f32_16x16x32_bf16 v[80:83], a[72:75], v[24:27], v[80:83]
  v_mfma_f32_16x16x32_bf16 v[84:87], a[76:79], v[24:27], v[84:87]
  s_waitcnt lgkmcnt(5)
  v_mfma_f32_16x16x32_bf16 v[72:75], a[64:67], v[28:31], v[72:75]
  ds_read_b128 v[52:55], v15 offset:8192
  v_mfma_f32_16x16x32_bf16 v[76:79], a[68:71], v[28:31], v[76:79]
  v_mfma_f32_16x16x32_bf16 v[88:91], a[72:75], v[28:31], v[88:91]
  v_mfma_f32_16x16x32_bf16 v[92:95], a[76:79], v[28:31], v[92:95]
  s_waitcnt lgkmcnt(5)
  v_mfma_f32_16x16x32_bf16 v[64:67], a[80:83], v[32:35], v[64:67]
  ds_read_b128 v[24:27], v8 offset:16384
  v_mfma_f32_16x16x32_bf16 v[68:71], a[84:87], v[32:35], v[68:71]
  v_mfma_f32_16x16x32_bf16 v[80:83], a[88:91], v[32:35], v[80:83]
  v_mfma_f32_16x16x32_bf16 v[84:87], a[92:95], v[32:35], v[84:87]
  s_waitcnt lgkmcnt(5)
  v_mfma_f32_16x16x32_bf16 v[72:75], a[80:83], v[36:39], v[72:75]
  ds_read_b128 v[28:31], v9 offset:16384
  v_mfma_f32_16x16x32_bf16 v[76:79], a[84:87], v[36:39], v[76:79]
  v_mfma_f32_16x16x32_bf16 v[88:91], a[88:91], v[36:39], v[88:91]
  v_mfma_f32_16x16x32_bf16 v[92:95], a[92:95], v[36:39], v[92:95]
  s_waitcnt lgkmcnt(5)
  v_mfma_f32_16x16x32_bf16 v[64:67], a[96:99], v[40:43], v[64:67]
  ds_read_b128 v[32:35], v10 offset:16384
  v_mfma_f32_16x16x32_bf16 v[68:71], a[100:103], v[40:43], v[68:71]
  v_mfma_f32_16x16x32_bf16 v[80:83], a[104:107], v[40:43], v[80:83]
  v_mfma_f32_16x16x32_bf16 v[84:87], a[108:111], v[40:43], v[84:87]
  s_waitcnt lgkmcnt(5)
  v_mfma_f32_16x16x32_bf16 v[72:75], a[96:99], v[44:47], v[72:75]
  ds_read_b128 v[36:39], v11 offset:16384
  v_mfma_f32_16x16x32_bf16 v[76:79], a[100:103], v[44:47], v[76:79]
  v_mfma_f32_16x16x32_bf16 v[88:91], a[104:107], v[44:47], v[88:91]
  v_mfma_f32_16x16x32_bf16 v[92:95], a[108:111], v[44:47], v[92:95]
  s_waitcnt lgkmcnt(5)
  v_mfma_f32_16x16x32_bf16 v[64:67], a[112:115], v[48:51], v[64:67]
  ds_read_b128 v[40:43], v12 offset:16384
  v_mfma_f32_16x16x32_bf16 v[68:71], a[116:119], v[48:51], v[68:71]
  v_mfma_f32_16x16x32_bf16 v[80:83], a[120:123], v[48:51], v[80:83]
  v_mfma_f32_16x16x32_bf16 v[84:87], a[124:127], v[48:51], v[84:87]
  s_waitcnt lgkmcnt(5)
  v_mfma_f32_16x16x32_bf16 v[72:75], a[112:115], v[52:55], v[72:75]
  ds_read_b128 v[44:47], v13 offset:16384
  v_mfma_f32_16x16x32_bf16 v[76:79], a[116:119], v[52:55], v[76:79]
  v_mfma_f32_16x16x32_bf16 v[88:91], a[120:123], v[52:55], v[88:91]
  v_mfma_f32_16x16x32_bf16 v[92:95], a[124:127], v[52:55], v[92:95]
  s_waitcnt lgkmcnt(5)
  v_mfma_f32_16x16x32_bf16 v[64:67], a[128:131], v[24:27], v[64:67]
  ds_read_b128 v[48:51], v14 offset:16384
  v_mfma_f32_16x16x32_bf16 v[68:71], a[132:135], v[24:27], v[68:71]
  v_mfma_f32_16x16x32_bf16 v[80:83], a[136:139], v[24:27], v[80:83]
  v_mfma_f32_16x16x32_bf16 v[84:87], a[140:143], v[24:27], v[84:87]
  s_waitcnt lgkmcnt(5)
  v_mfma_f32_16x16x32_bf16 v[72:75], a[128:131], v[28:31], v[72:75]
  ds_read_b128 v[52:55], v15 offset:16384
  v_mfma_f32_16x16x32_bf16 v[76:79], a[132:135], v[28:31], v[76:79]
  v_mfma_f32_16x16x32_bf16 v[88:91], a[136:139], v[28:31], v[88:91]
  v_mfma_f32_16x16x32_bf16 v[92:95], a[140:143], v[28:31], v[92:95]
  s_waitcnt lgkmcnt(5)
  v_mfma_f32_16x16x32_bf16 v[64:67], a[144:147], v[32:35], v[64:67]
  ds_read_b128 v[24:27], v8 offset:24576
  v_mfma_f32_16x16x32_bf16 v[68:71], a[148:151], v[32:35], v[68:71]
  v_mfma_f32_16x16x32_bf16 v[80:83], a[152:155], v[32:35], v[80:83]
  v_mfma_f32_16x16x32_bf16 v[84:87], a[156:159], v[32:35], v[84:87]
  s_waitcnt lgkmcnt(5)
  v_mfma_f32_16x16x32_bf16 v[72:75], a[144:147], v[36:39], v[72:75]
  ds_read_b128 v[28:31], v9 offset:24576
  v_mfma_f32_16x16x32_bf16 v[76:79], a[148:151], v[36:39], v[76:79]
  v_mfma_f32_16x16x32_bf16 v[88:91], a[152:155], v[36:39], v[88:91]
  v_mfma_f32_16x16x32_bf16 v[92:95], a[156:159], v[36:39], v[92:95]
  s_waitcnt lgkmcnt(5)
  v_mfma_f32_16x16x32_bf16 v[64:67], a[160:163], v[40:43], v[64:67]
  ds_read_b128 v[32:35], v10 offset:24576
  v_mfma_f32_16x16x32_bf16 v[68:71], a[164:167], v[40:43], v[68:71]
  v_mfma_f32_16x16x32_bf16 v[80:83], a[168:171], v[40:43], v[80:83]
  v_mfma_f32_16x16x32_bf16 v[84:87], a[172:175], v[40:43], v[84:87]
  s_waitcnt lgkmcnt(5)
  v_mfma_f32_16x16x32_bf16 v[72:75], a[160:163], v[44:47], v[72:75]
  ds_read_b128 v[36:39], v11 offset:24576
  v_mfma_f32_16x16x32_bf16 v[76:79], a[164:167], v[44:47], v[76:79]
  v_mfma_f32_16x16x32_bf16 v[88:91], a[168:171], v[44:47], v[88:91]
  v_mfma_f32_16x16x32_bf16 v[92:95], a[172:175], v[44:47], v[92:95]
  s_waitcnt lgkmcnt(5)
  v_mfma_f32_16x16x32_bf16 v[64:67], a[176:179], v[48:51], v[64:67]
  ds_read_b128 v[40:43], v12 offset:24576
  v_mfma_f32_16x16x32_bf16 v[68:71], a[180:183], v[48:51], v[68:71]
  v_mfma_f32_16x16x32_bf16 v[80:83], a[184:187], v[48:51], v[80:83]
  v_mfma_f32_16x16x32_bf16 v[84:87], a[188:191], v[48:51], v[84:87]
  s_waitcnt lgkmcnt(5)
  v_mfma_f32_16x16x32_bf16 v[72:75], a[176:179], v[52:55], v[72:75]
  ds_read_b128 v[44:47], v13 offset:24576
  v_mfma_f32_16x16x32_bf16 v[76:79], a[180:183], v[52:55], v[76:79]
  v_mfma_f32_16x16x32_bf16 v[88:91], a[184:187], v[52:55], v[88:91]
  v_mfma_f32_16x16x32_bf16 v[92:95], a[188:191], v[52:55], v[92:95]
  s_waitcnt lgkmcnt(5)
  v_mfma_f32_16x16x32_bf16 v[64:67], a[192:195], v[24:27], v[64:67]
  ds_read_b128 v[48:51], v14 offset:24576
  v_mfma_f32_16x16x32_bf16 v[68:71], a[196:199], v[24:27], v[68:71]
  v_mfma_f32_16x16x32_bf16 v[80:83], a[200:203], v[24:27], v[80:83]
  v_mfma_f32_16x16x32_bf16 v[84:87], a[204:207], v[24:27], v[84:87]
  s_waitcnt lgkmcnt(5)
  v_mfma_f32_16x16x32_bf16 v[72:75], a[192:195], v[28:31], v[72:75]
  ds_read_b128 v[52:55], v15 offset:24576
  v_mfma_f32_16x16x32_bf16 v[76:79], a[196:199], v[28:31], v[76:79]
  v_mfma_f32_16x16x32_bf16 v[88:91], a[200:203], v[28:31], v[88:91]
  v_mfma_f32_16x16x32_bf16 v[92:95], a[204:207], v[28:31], v[92:95]
  s_waitcnt lgkmcnt(5)
  v_mfma_f32_16x16x32_bf16 v[64:67], a[208:211], v[32:35], v[64:67]
  v_mfma_f32_16x16x32_bf16 v[68:71], a[212:215], v[32:35], v[68:71]
  v_mfma_f32_16x16x32_bf16 v[80:83], a[216:219], v[32:35], v[80:83]
  v_mfma_f32_16x16x32_bf16 v[84:87], a[220:223], v[32:35], v[84:87]
  s_waitcnt lgkmcnt(4)
  v_mfma_f32_16x16x32_bf16 v[72:75], a[208:211], v[36:39], v[72:75]
  v_mfma_f32_16x16x32_bf16 v[76:79], a[212:215], v[36:39], v[76:79]
  v_mfma_f32_16x16x32_bf16 v[88:91], a[216:219], v[36:39], v[88:91]
  v_mfma_f32_16x16x32_bf16 v[92:95], a[220:223], v[36:39], v[92:95]
  s_waitcnt lgkmcnt(3)
  v_mfma_f32_16x16x32_bf16 v[64:67], a[224:227], v[40:43], v[64:67]
  v_mfma_f32_16x16x32_bf16 v[68:71], a[228:231], v[40:43], v[68:71]
  v_mfma_f32_16x16x32_bf16 v[80:83], a[232:235], v[40:43], v[80:83]
  v_mfma_f32_16x16x32_bf16 v[84:87], a[236:239], v[40:43], v[84:87]
  s_waitcnt lgkmcnt(2)
  v_mfma_f32_16x16x32_bf16 v[72:75], a[224:227], v[44:47], v[72:75]
  v_mfma_f32_16x16x32_bf16 v[76:79], a[228:231], v[44:47], v[76:79]
  v_mfma_f32_16x16x32_bf16 v[88:91], a[232:235], v[44:47], v[88:91]
  v_mfma_f32_16x16x32_bf16 v[92:95], a[236:239], v[44:47], v[92:95]
  s_waitcnt lgkmcnt(1)
  v_mfma_f32_16x16x32_bf16 v[64:67], a[240:243], v[48:51], v[64:67]
  v_mfma_f32_16x16x32_bf16 v[68:71], a[244:247], v[48:51], v[68:71]
  v_mfma_f32_16x16x32_bf16 v[80:83], a[248:251], v[48:51], v[80:83]
  v_mfma_f32_16x16x32_bf16 v[84:87], a[252:255], v[48:51], v[84:87]
  s_waitcnt lgkmcnt(0)
  v_mfma_f32_16x16x32_bf16 v[72:75], a[240:243], v[52:55], v[72:75]
  v_mfma_f32_16x16x32_bf16 v[76:79], a[244:247], v[52:55], v[76:79]
  v_mfma_f32_16x16x32_bf16 v[88:91], a[248:251], v[52:55], v[88:91]
  v_mfma_f32_16x16x32_bf16 v[92:95], a[252:255], v[52:55], v[92:95]
  v_xor_b32 v8, 0x8000, v8
  v_xor_b32 v9, 0x8000, v9
  v_xor_b32 v10, 0x8000, v10
  v_xor_b32 v11, 0x8000, v11
  v_xor_b32 v12, 0x8000, v12
  v_xor_b32 v13, 0x8000, v13
  v_xor_b32 v14, 0x8000, v14
  v_xor_b32 v15, 0x8000, v15
  s_mov_b32 s30, 537
F_top_196:
  s_waitcnt vmcnt(8)
  v_mfma_f32_32x32x16_bf16 v[24:39], v[176:179], v[144:147], v[240:255]
  s_nop 1
  v_cvt_pk_bf16_f32 v128, v64, v65
  v_cvt_pk_bf16_f32 v129, v66, v67
  v_cvt_pk_bf16_f32 v130, v68, v69
  v_cvt_pk_bf16_f32 v131, v70, v71
  v_mfma_f32_32x32x16_bf16 v[24:39], v[180:183], v[148:151], v[24:39]
  buffer_store_dwordx4 v[128:131], v22, s[4:7], s21 offen offset:0 sc1
  v_mfma_f32_32x32x16_bf16 v[24:39], v[184:187], v[152:155], v[24:39]
  v_cvt_pk_bf16_f32 v132, v72, v73
  v_cvt_pk_bf16_f32 v133, v74, v75
  v_cvt_pk_bf16_f32 v134, v76, v77
  v_cvt_pk_bf16_f32 v135, v78, v79
  v_mfma_f32_32x32x16_bf16 v[24:39], v[188:191], v[156:159], v[24:39]
  buffer_store_dwordx4 v[132:135], v22, s[4:7], s21 offen offset:256 sc1
  v_mfma_f32_32x32x16_bf16 v[24:39], v[192:195], v[160:163], v[24:39]
  v_cvt_pk_bf16_f32 v136, v80, v81
  v_cvt_pk_bf16_f32 v137, v82, v83
  v_cvt_pk_bf16_f32 v138, v84, v85
  v_cvt_pk_bf16_f32 v139, v86, v87
  v_mfma_f32_32x32x16_bf16 v[24:39], v[196:199], v[164:167], v[24:39]
  buffer_store_dwordx4 v[136:139], v22, s[4:7], s21 offen offset:2048 sc1
  v_mfma_f32_32x32x16_bf16 v[24:39], v[200:203], v[168:171], v[24:39]
  v_cvt_pk_bf16_f32 v140, v88, v89
  v_cvt_pk_bf16_f32 v141, v90, v91
  v_cvt_pk_bf16_f32 v142, v92, v93
  v_cvt_pk_bf16_f32 v143, v94, v95
  v_mfma_f32_32x32x16_bf16 v[24:39], v[204:207], v[172:175], v[24:39]
  buffer_store_dwordx4 v[140:143], v22, s[4:7], s21 offen offset:2304 sc1
  s_add_u32 s21, s21, s22
  v_mov_b32 v22, v20
  s_cmp_lg_u32 s24, 0
  s_cbranch_scc1 F_have_197
  s_cmp_le_u32 s52, 58
  s_cbranch_scc1 M_dp_219
  s_mov_b32 s71, 0
  v_add_u32 v16, s25, v2
  s_waitcnt vmcnt(9)
  s_branch M_dp_221
M_dp_220:
  s_add_u32 s71, s71, 1
  s_cmp_gt_u32 s71, 262144
  s_cbranch_scc1 M_exit
  buffer_load_dword v23, off, s[4:7], s54 sc1
  buffer_load_dwordx4 v[96:99], v2, s[4:7], s20 offen offset:0 sc1
  buffer_load_dwordx4 v[100:103], v2, s[4:7], s20 offen offset:1024 sc1
  buffer_load_dwordx4 v[104:107], v2, s[4:7], s20 offen offset:2048 sc1
  buffer_load_dwordx4 v[108:111], v2, s[4:7], s20 offen offset:3072 sc1
  s_waitcnt vmcnt(0)
M_dp_221:
  v_max_u32 v17, v96, v97
  v_max3_u32 v17, v17, v98, v99
  v_max3_u32 v17, v17, v100, v101
  v_max3_u32 v17, v17, v102, v103
  v_max3_u32 v17, v17, v104, v105
  v_max3_u32 v17, v17, v106, v107
  v_max3_u32 v17, v17, v108, v109
  v_max3_u32 v17, v17, v110, v111
  v_cmp_eq_u32 vcc, -1, v17
  s_cbranch_vccz M_dp_222
  v_cmp_gt_u32 vcc, s52, v23
  s_cbranch_vccnz M_dp_220
  s_branch M_dp_219
M_dp_222:
  ds_write_b128 v16, v[96:99] offset:0
  ds_write_b128 v16, v[100:103] offset:1024
  ds_write_b128 v16, v[104:107] offset:2048
  ds_write_b128 v16, v[108:111] offset:3072
  s_branch F_have_197
M_dp_219:
  v_mov_b32 v16, s54
  v_mov_b32 v17, s52
  s_mov_b32 s71, 0
  s_branch M_vg_224
M_vw_223:
  s_sleep 2
  s_add_u32 s71, s71, 1
  s_cmp_gt_u32 s71, 262144
  s_cbranch_scc1 M_exit
M_vg_224:
  buffer_load_dword v23, v16, s[4:7], 0 offen sc1
  s_waitcnt vmcnt(0)
  v_cmp_lt_u32 vcc, v23, v17
  s_cbranch_vccnz M_vw_223
  s_mov_b32 m0, s25
  s_nop 0
  buffer_load_dwordx4 v2, s[4:7], s20 offen offset:0 sc1 lds
  buffer_load_dwordx4 v2, s[4:7], s20 offen offset:1024 sc1 lds
  buffer_load_dwordx4 v2, s[4:7], s20 offen offset:2048 sc1 lds
  buffer_load_dwordx4 v2, s[4:7], s20 offen offset:3072 sc1 lds
  s_waitcnt vmcnt(0)
F_have_197:
  ds_read_b64_tr_b16 v[176:177], v4 offset:8
  ds_read_b64_tr_b16 v[178:179], v4 offset:136
  ds_read_b64_tr_b16 v[180:181], v4 offset:520
  ds_read_b64_tr_b16 v[182:183], v4 offset:648
  ds_read_b64_tr_b16 v[184:185], v4 offset:1032
  ds_read_b64_tr_b16 v[186:187], v4 offset:1160
  ds_read_b64_tr_b16 v[188:189], v4 offset:1544
  ds_read_b64_tr_b16 v[190:191], v4 offset:1672
  ds_read_b64_tr_b16 v[192:193], v4 offset:2056
  ds_read_b64_tr_b16 v[194:195], v4 offset:2184
  ds_read_b64_tr_b16 v[196:197], v4 offset:2568
  ds_read_b64_tr_b16 v[198:199], v4 offset:2696
  s_sub_u32 s23, s23, 1
  s_cmp_gt_u32 s23, 0
  s_cselect_b32 s26, s51, 0
  s_cselect_b32 s27, 0, 0x40000000
  v_or_b32 v21, s27, v21
  s_lshl_b32 s27, s26, 13
  s_add_u32 s19, s19, s27
  s_mul_i32 s27, s26, 131072
  s_add_u32 s20, s20, s27
  s_cmp_lg_u32 s23, 26
  s_cbranch_scc1 M_xok_225
  s_lshl_b32 s77, s48, 2
  s_add_u32 s77, s77, s16
  s_mul_i32 s78, s77, 896
  s_add_u32 s76, s78, 148898304
  s_mov_b32 s71, 0
  s_branch M_sg_227
M_sw_226:
  s_sleep 8
  s_add_u32 s71, s71, 1
  s_cmp_gt_u32 s71, 262144
  s_cbranch_scc1 M_exit
M_sg_227:
  s_mov_b32 s79, 0
  s_atomic_or s79, s[72:73], s76 glc
  s_waitcnt lgkmcnt(0)
  s_cmp_lt_u32 s79, 20
  s_cbranch_scc1 M_sw_226
  s_add_u32 s76, s78, 148898048
  s_mov_b32 s71, 0
  s_branch M_sg_229
M_sw_228:
  s_sleep 8
  s_add_u32 s71, s71, 1
  s_cmp_gt_u32 s71, 262144
  s_cbranch_scc1 M_exit
M_sg_229:
  s_mov_b32 s79, 0
  s_atomic_or s79, s[72:73], s76 glc
  s_waitcnt lgkmcnt(0)
  s_cmp_lt_u32 s79, 10
  s_cbranch_scc1 M_sw_228
  s_add_u32 s76, s78, 148898176
  s_mov_b32 s71, 0
  s_branch M_sg_231
M_sw_230:
  s_sleep 8
  s_add_u32 s71, s71, 1
  s_cmp_gt_u32 s71, 262144
  s_cbranch_scc1 M_exit
M_sg_231:
  s_mov_b32 s79, 0
  s_atomic_or s79, s[72:73], s76 glc
  s_waitcnt lgkmcnt(0)
  s_cmp_lt_u32 s79, 10
  s_cbranch_scc1 M_sw_230
M_xok_225:
  s_cmp_lg_u32 s23, 22
  s_cbranch_scc1 M_xok_232
  s_lshl_b32 s77, s48, 2
  s_add_u32 s77, s77, s16
  s_mul_i32 s78, s77, 896
  s_add_u32 s76, s78, 148898304
  s_mov_b32 s71, 0
  s_branch M_sg_234
M_sw_233:
  s_sleep 8
  s_add_u32 s71, s71, 1
  s_cmp_gt_u32 s71, 262144
  s_cbranch_scc1 M_exit
M_sg_234:
  s_mov_b32 s79, 0
  s_atomic_or s79, s[72:73], s76 glc
  s_waitcnt lgkmcnt(0)
  s_cmp_lt_u32 s79, 32
  s_cbranch_scc1 M_sw_233
  s_add_u32 s76, s78, 148898432
  s_mov_b32 s71, 0
  s_branch M_sg_236
M_sw_235:
  s_sleep 8
  s_add_u32 s71, s71, 1
  s_cmp_gt_u32 s71, 262144
  s_cbranch_scc1 M_exit
M_sg_236:
  s_mov_b32 s79, 0
  s_atomic_or s79, s[72:73], s76 glc
  s_waitcnt lgkmcnt(0)
  s_cmp_lt_u32 s79, 32
  s_cbranch_scc1 M_sw_235
  s_add_u32 s76, s78, 148898048
  s_mov_b32 s71, 0
  s_branch M_sg_238
M_sw_237:
  s_sleep 8
  s_add_u32 s71, s71, 1
  s_cmp_gt_u32 s71, 262144
  s_cbranch_scc1 M_exit
M_sg_238:
  s_mov_b32 s79, 0
  s_atomic_or s79, s[72:73], s76 glc
  s_waitcnt lgkmcnt(0)
  s_cmp_lt_u32 s79, 32
  s_cbranch_scc1 M_sw_237
  s_add_u32 s76, s78, 148898176
  s_mov_b32 s71, 0
  s_branch M_sg_240
M_sw_239:
  s_sleep 8
  s_add_u32 s71, s71, 1
  s_cmp_gt_u32 s71, 262144
  s_cbranch_scc1 M_exit
M_sg_240:
  s_mov_b32 s79, 0
  s_atomic_or s79, s[72:73], s76 glc
  s_waitcnt lgkmcnt(0)
  s_cmp_lt_u32 s79, 32
  s_cbranch_scc1 M_sw_239
M_xok_232:
  s_waitcnt lgkmcnt(10)
  v_mfma_f32_32x32x16_bf16 v[40:55], v[176:179], v[144:147], 0
  ds_read_b64_tr_b16 v[200:201], v4 offset:3080
  ds_read_b64_tr_b16 v[202:203], v4 offset:3208
  v_max_f32 v6, v24, v25
  s_waitcnt lgkmcnt(10)
  v_mfma_f32_32x32x16_bf16 v[40:55], v[180:183], v[148:151], v[40:55]
  ds_read_b64_tr_b16 v[204:205], v4 offset:3592
  ds_read_b64_tr_b16 v[206:207], v4 offset:3720
  v_max3_f32 v6, v6, v26, v27
  s_waitcnt lgkmcnt(10)
  v_mfma_f32_32x32x16_bf16 v[40:55], v[184:187], v[152:155], v[40:55]
  ds_read_b64 v[56:57], v5 offset:0
  ds_read_b64 v[58:59], v5 offset:1024
  v_max3_f32 v6, v6, v28, v29
  s_waitcnt lgkmcnt(10)
  v_mfma_f32_32x32x16_bf16 v[40:55], v[188:191], v[156:159], v[40:55]
  ds_read_b64 v[60:61], v5 offset:2048
  ds_read_b64 v[62:63], v5 offset:3072
  v_max3_f32 v6, v6, v30, v31
  s_waitcnt lgkmcnt(10)
  v_mfma_f32_32x32x16_bf16 v[40:55], v[192:195], v[160:163], v[40:55]
  v_max3_f32 v6, v6, v32, v33
  s_waitcnt lgkmcnt(8)
  v_mfma_f32_32x32x16_bf16 v[40:55], v[196:199], v[164:167], v[40:55]
  v_max3_f32 v6, v6, v34, v35
  s_waitcnt lgkmcnt(6)
  v_mfma_f32_32x32x16_bf16 v[40:55], v[200:203], v[168:171], v[40:55]
  v_max3_f32 v6, v6, v36, v37
  s_waitcnt lgkmcnt(4)
  v_mfma_f32_32x32x16_bf16 v[40:55], v[204:207], v[172:175], v[40:55]
  v_max3_f32 v6, v6, v38, v39
  s_add_u32 s28, s19, 50331648
  buffer_load_dwordx4 v[144:147], v21, s[4:7], s28 offen offset:0 sc1
  buffer_load_dwordx4 v[148:151], v21, s[4:7], s28 offen offset:1024 sc1
  s_nop 7
  v_max3_f32 v6, v6, v40, v41
  v_max3_f32 v6, v6, v42, v43
  v_mov_b32 v16, v6
  s_nop 1
  v_permlane32_swap_b32 v6, v16
  s_nop 1
  v_max_f32 v6, v6, v16
  v_pk_add_f32 v[24:25], v[24:25], v[6:7] op_sel_hi:[1,0] neg_lo:[0,1] neg_hi:[0,1]
  v_pk_add_f32 v[26:27], v[26:27], v[6:7] op_sel_hi:[1,0] neg_lo:[0,1] neg_hi:[0,1]
  v_pk_add_f32 v[28:29], v[28:29], v[6:7] op_sel_hi:[1,0] neg_lo:[0,1] neg_hi:[0,1]
  v_pk_add_f32 v[30:31], v[30:31], v[6:7] op_sel_hi:[1,0] neg_lo:[0,1] neg_hi:[0,1]
  v_pk_add_f32 v[32:33], v[32:33], v[6:7] op_sel_hi:[1,0] neg_lo:[0,1] neg_hi:[0,1]
  v_pk_add_f32 v[34:35], v[34:35], v[6:7] op_sel_hi:[1,0] neg_lo:[0,1] neg_hi:[0,1]
  v_pk_add_f32 v[36:37], v[36:37], v[6:7] op_sel_hi:[1,0] neg_lo:[0,1] neg_hi:[0,1]
  v_pk_add_f32 v[38:39], v[38:39], v[6:7] op_sel_hi:[1,0] neg_lo:[0,1] neg_hi:[0,1]
  v_pk_add_f32 v[40:41], v[40:41], v[6:7] op_sel_hi:[1,0] neg_lo:[0,1] neg_hi:[0,1]
  v_pk_add_f32 v[42:43], v[42:43], v[6:7] op_sel_hi:[1,0] neg_lo:[0,1] neg_hi:[0,1]
  v_exp_f32 v24, v24
  v_exp_f32 v25, v25
  v_exp_f32 v26, v26
  v_exp_f32 v27, v27
  v_exp_f32 v28, v28
  v_exp_f32 v29, v29
  v_exp_f32 v30, v30
  v_exp_f32 v31, v31
  v_exp_f32 v32, v32
  v_exp_f32 v33, v33
  buffer_load_dwordx4 v[152:155], v21, s[4:7], s28 offen offset:2048 sc1
  v_exp_f32 v34, v34
  v_exp_f32 v35, v35
  v_exp_f32 v36, v36
  v_exp_f32 v37, v37
  v_exp_f32 v38, v38
  v_exp_f32 v39, v39
  v_exp_f32 v40, v40
  v_exp_f32 v41, v41
  v_exp_f32 v42, v42
  v_exp_f32 v43, v43
  v_pk_add_f32 v[16:17], v[24:25], v[26:27]
  v_pk_add_f32 v[16:17], v[16:17], v[28:29]
  v_pk_add_f32 v[16:17], v[16:17], v[30:31]
  v_pk_add_f32 v[16:17], v[16:17], v[32:33]
  v_pk_add_f32 v[16:17], v[16:17], v[34:35]
  v_pk_add_f32 v[16:17], v[16:17], v[36:37]
  v_pk_add_f32 v[16:17], v[16:17], v[38:39]
  v_pk_add_f32 v[16:17], v[16:17], v[40:41]
  v_pk_add_f32 v[16:17], v[16:17], v[42:43]
  v_add_f32 v16, v16, v17
  v_mov_b32 v17, v16
  buffer_load_dwordx4 v[156:159], v21, s[4:7], s28 offen offset:3072 sc1
  s_nop 0
  v_permlane32_swap_b32 v16, v17
  s_nop 1
  v_add_f32 v16, v16, v17
  v_rcp_f32 v6, v16
  s_nop 0
  v_pk_mul_f32 v[24:25], v[24:25], v[6:7] op_sel_hi:[1,0]
  v_pk_mul_f32 v[26:27], v[26:27], v[6:7] op_sel_hi:[1,0]
  v_pk_mul_f32 v[28:29], v[28:29], v[6:7] op_sel_hi:[1,0]
  v_pk_mul_f32 v[30:31], v[30:31], v[6:7] op_sel_hi:[1,0]
  v_pk_mul_f32 v[32:33], v[32:33], v[6:7] op_sel_hi:[1,0]
  v_pk_mul_f32 v[34:35], v[34:35], v[6:7] op_sel_hi:[1,0]
  v_pk_mul_f32 v[36:37], v[36:37], v[6:7] op_sel_hi:[1,0]
  v_pk_mul_f32 v[38:39], v[38:39], v[6:7] op_sel_hi:[1,0]
  v_pk_mul_f32 v[40:41], v[40:41], v[6:7] op_sel_hi:[1,0]
  v_pk_mul_f32 v[42:43], v[42:43], v[6:7] op_sel_hi:[1,0]
  v_cvt_pk_bf16_f32 v128, v24, v25
  v_cvt_pk_bf16_f32 v129, v26, v27
  v_cvt_pk_bf16_f32 v130, v28, v29
  v_cvt_pk_bf16_f32 v131, v30, v31
  v_cvt_pk_bf16_f32 v132, v32, v33
  v_cvt_pk_bf16_f32 v133, v34, v35
  v_cvt_pk_bf16_f32 v134, v36, v37
  v_cvt_pk_bf16_f32 v135, v38, v39
  v_cvt_pk_bf16_f32 v136, v40, v41
  v_cvt_pk_bf16_f32 v137, v42, v43
  s_waitcnt vmcnt(8) lgkmcnt(0)
  v_mfma_f32_32x32x16_bf16 v[64:79], v[208:211], v[128:131], 0
  s_add_u32 s29, s19, 50335744
  buffer_load_dwordx4 v[160:163], v21, s[4:7], s29 offen offset:0 sc1
  v_mfma_f32_32x32x16_bf16 v[64:79], v[212:215], v[132:135], v[64:79]
  v_mfma_f32_32x32x8_bf16 v[64:79], v[56:57], v[136:137], v[64:79]
  v_mfma_f32_32x32x16_bf16 v[80:95], v[216:219], v[128:131], 0
  buffer_load_dwordx4 v[164:167], v21, s[4:7], s29 offen offset:1024 sc1
  v_mfma_f32_32x32x16_bf16 v[80:95], v[220:223], v[132:135], v[80:95]
  v_cvt_pk_bf16_f32 v24, v64, v65
  v_cvt_pk_bf16_f32 v25, v66, v67
  v_cvt_pk_bf16_f32 v26, v68, v69
  v_cvt_pk_bf16_f32 v27, v70, v71
  v_mfma_f32_32x32x8_bf16 v[80:95], v[58:59], v[136:137], v[80:95]
  ds_write_b128 v3, v[24:27] offset:0
  v_cvt_pk_bf16_f32 v28, v72, v73
  v_cvt_pk_bf16_f32 v29, v74, v75
  v_cvt_pk_bf16_f32 v30, v76, v77
  v_cvt_pk_bf16_f32 v31, v78, v79
  v_mfma_f32_32x32x16_bf16 v[96:111], v[224:227], v[128:131], 0
  ds_write_b128 v3, v[28:31] offset:1024
  buffer_load_dwordx4 v[168:171], v21, s[4:7], s29 offen offset:2048 sc1
  v_mfma_f32_32x32x16_bf16 v[96:111], v[228:231], v[132:135], v[96:111]
  v_cvt_pk_bf16_f32 v32, v80, v81
  v_cvt_pk_bf16_f32 v33, v82, v83
  v_cvt_pk_bf16_f32 v34, v84, v85
  v_cvt_pk_bf16_f32 v35, v86, v87
  v_mfma_f32_32x32x8_bf16 v[96:111], v[60:61], v[136:137], v[96:111]
  ds_write_b128 v3, v[32:35] offset:2048
  v_cvt_pk_bf16_f32 v36, v88, v89
  v_cvt_pk_bf16_f32 v37, v90, v91
  v_cvt_pk_bf16_f32 v38, v92, v93
  v_cvt_pk_bf16_f32 v39, v94, v95
  v_mfma_f32_32x32x16_bf16 v[112:127], v[232:235], v[128:131], 0
  ds_write_b128 v3, v[36:39] offset:3072
  buffer_load_dwordx4 v[172:175], v21, s[4:7], s29 offen offset:3072 sc1
  v_mfma_f32_32x32x16_bf16 v[112:127], v[236:239], v[132:135], v[112:127]
  v_cvt_pk_bf16_f32 v40, v96, v97
  v_cvt_pk_bf16_f32 v41, v98, v99
  v_cvt_pk_bf16_f32 v42, v100, v101
  v_cvt_pk_bf16_f32 v43, v102, v103
  v_mfma_f32_32x32x8_bf16 v[112:127], v[62:63], v[136:137], v[112:127]
  ds_write_b128 v3, v[40:43] offset:4096
  v_cvt_pk_bf16_f32 v44, v104, v105
  v_cvt_pk_bf16_f32 v45, v106, v107
  v_cvt_pk_bf16_f32 v46, v108, v109
  v_cvt_pk_bf16_f32 v47, v110, v111
  ds_write_b128 v3, v[44:47] offset:5120
  s_nop 5
  v_cvt_pk_bf16_f32 v48, v112, v113
  v_cvt_pk_bf16_f32 v49, v114, v115
  v_cvt_pk_bf16_f32 v50, v116, v117
  v_cvt_pk_bf16_f32 v51, v118, v119
  ds_write_b128 v3, v[48:51] offset:6144
  v_cvt_pk_bf16_f32 v52, v120, v121
  v_cvt_pk_bf16_f32 v53, v122, v123
  v_cvt_pk_bf16_f32 v54, v124, v125
  v_cvt_pk_bf16_f32 v55, v126, v127
  ds_write_b128 v3, v[52:55] offset:7168
  s_waitcnt vmcnt(8)
  s_waitcnt lgkmcnt(0)
  s_barrier
  ds_read_b128 v[24:27], v8 offset:0
  ds_read_b128 v[28:31], v9 offset:0
  ds_read_b128 v[32:35], v10 offset:0
  ds_read_b128 v[36:39], v11 offset:0
  ds_read_b128 v[40:43], v12 offset:0
  ds_read_b128 v[44:47], v13 offset:0
  buffer_load_dword v23, off, s[4:7], s54 sc1
  v_mov_b32 v16, s30
  v_min_u32 v17, 1, v0
  v_lshlrev_b32 v17, 30, v17
  buffer_store_dword v16, v17, s[4:7], s31 offen sc1
  s_add_u32 s30, s30, 1
  s_waitcnt lgkmcnt(5)
  v_mfma_f32_16x16x32_bf16 v[64:67], a[0:3], v[24:27], 0
  s_add_u32 s28, s19, 67108864
  ds_read_b128 v[48:51], v14 offset:0
  v_mfma_f32_16x16x32_bf16 v[68:71], a[4:7], v[24:27], 0
  v_mfma_f32_16x16x32_bf16 v[80:83], a[8:11], v[24:27], 0
  v_mfma_f32_16x16x32_bf16 v[84:87], a[12:15], v[24:27], 0
  s_waitcnt lgkmcnt(5)
  v_mfma_f32_16x16x32_bf16 v[72:75], a[0:3], v[28:31], 0
  ds_read_b128 v[52:55], v15 offset:0
  v_mfma_f32_16x16x32_bf16 v[76:79], a[4:7], v[28:31], 0
  v_mfma_f32_16x16x32_bf16 v[88:91], a[8:11], v[28:31], 0
  buffer_load_dwordx4 v[176:179], v21, s[4:7], s28 offen offset:0 sc1
  v_mfma_f32_16x16x32_bf16 v[92:95], a[12:15], v[28:31], 0
  s_waitcnt lgkmcnt(5)
  v_mfma_f32_16x16x32_bf16 v[64:67], a[16:19], v[32:35], v[64:67]
  ds_read_b128 v[24:27], v8 offset:8192
  v_mfma_f32_16x16x32_bf16 v[68:71], a[20:23], v[32:35], v[68:71]
  v_mfma_f32_16x16x32_bf16 v[80:83], a[24:27], v[32:35], v[80:83]
  v_mfma_f32_16x16x32_bf16 v[84:87], a[28:31], v[32:35], v[84:87]
  s_waitcnt lgkmcnt(5)
  v_mfma_f32_16x16x32_bf16 v[72:75], a[16:19], v[36:39], v[72:75]
  ds_read_b128 v[28:31], v9 offset:8192
  v_mfma_f32_16x16x32_bf16 v[76:79], a[20:23], v[36:39], v[76:79]
  v_mfma_f32_16x16x32_bf16 v[88:91], a[24:27], v[36:39], v[88:91]
  buffer_load_dwordx4 v[180:183], v21, s[4:7], s28 offen offset:1024 sc1
  v_mfma_f32_16x16x32_bf16 v[92:95], a[28:31], v[36:39], v[92:95]
  s_waitcnt lgkmcnt(5)
  v_mfma_f32_16x16x32_bf16 v[64:67], a[32:35], v[40:43], v[64:67]
  ds_read_b128 v[32:35], v10 offset:8192
  v_mfma_f32_16x16x32_bf16 v[68:71], a[36:39], v[40:43], v[68:71]
  v_mfma_f32_16x16x32_bf16 v[80:83], a[40:43], v[40:43], v[80:83]
  v_mfma_f32_16x16x32_bf16 v[84:87], a[44:47], v[40:43], v[84:87]
  s_waitcnt lgkmcnt(5)
  v_mfma_f32_16x16x32_bf16 v[72:75], a[32:35], v[44:47], v[72:75]
  ds_read_b128 v[36:39], v11 offset:8192
  v_mfma_f32_16x16x32_bf16 v[76:79], a[36:39], v[44:47], v[76:79]
  v_mfma_f32_16x16x32_bf16 v[88:91], a[40:43], v[44:47], v[88:91]
  buffer_load_dwordx4 v[184:187], v21, s[4:7], s28 offen offset:2048 sc1
  v_mfma_f32_16x16x32_bf16 v[92:95], a[44:47], v[44:47], v[92:95]
  s_waitcnt lgkmcnt(5)
  v_mfma_f32_16x16x32_bf16 v[64:67], a[48:51], v[48:51], v[64:67]
  ds_read_b128 v[40:43], v12 offset:8192
  v_mfma_f32_16x16x32_bf16 v[68:71], a[52:55], v[48:51], v[68:71]
  v_mfma_f32_16x16x32_bf16 v[80:83], a[56:59], v[48:51], v[80:83]
  v_mfma_f32_16x16x32_bf16 v[84:87], a[60:63], v[48:51], v[84:87]
  s_waitcnt lgkmcnt(5)
  v_mfma_f32_16x16x32_bf16 v[72:75], a[48:51], v[52:55], v[72:75]
  ds_read_b128 v[44:47], v13 offset:8192
  v_mfma_f32_16x16x32_bf16 v[76:79], a[52:55], v[52:55], v[76:79]
  v_mfma_f32_16x16x32_bf16 v[88:91], a[56:59], v[52:55], v[88:91]
  buffer_load_dwordx4 v[188:191], v21, s[4:7], s28 offen offset:3072 sc1
  v_mfma_f32_16x16x32_bf16 v[92:95], a[60:63], v[52:55], v[92:95]
  s_waitcnt lgkmcnt(5)
  v_mfma_f32_16x16x32_bf16 v[64:67], a[64:67], v[24:27], v[64:67]
  s_add_u32 s29, s19, 67112960
  ds_read_b128 v[48:51], v14 offset:8192
  v_mfma_f32_16x16x32_bf16 v[68:71], a[68:71], v[24:27], v[68:71]
  v_mfma_f32_16x16x32_bf16 v[80:83], a[72:75], v[24:27], v[80:83]
  v_mfma_f32_16x16x32_bf16 v[84:87], a[76:79], v[24:27], v[84:87]
  s_waitcnt lgkmcnt(5)
  v_mfma_f32_16x16x32_bf16 v[72:75], a[64:67], v[28:31], v[72:75]
  ds_read_b128 v[52:55], v15 offset:8192
  v_mfma_f32_16x16x32_bf16 v[76:79], a[68:71], v[28:31], v[76:79]
  v_mfma_f32_16x16x32_bf16 v[88:91], a[72:75], v[28:31], v[88:91]
  buffer_load_dwordx4 v[192:195], v21, s[4:7], s29 offen offset:0 sc1
  v_mfma_f32_16x16x32_bf16 v[92:95], a[76:79], v[28:31], v[92:95]
  s_waitcnt lgkmcnt(5)
  v_mfma_f32_16x16x32_bf16 v[64:67], a[80:83], v[32:35], v[64:67]
  ds_read_b128 v[24:27], v8 offset:16384
  v_mfma_f32_16x16x32_bf16 v[68:71], a[84:87], v[32:35], v[68:71]
  v_mfma_f32_16x16x32_bf16 v[80:83], a[88:91], v[32:35], v[80:83]
  v_mfma_f32_16x16x32_bf16 v[84:87], a[92:95], v[32:35], v[84:87]
  s_waitcnt lgkmcnt(5)
  v_mfma_f32_16x16x32_bf16 v[72:75], a[80:83], v[36:39], v[72:75]
  ds_read_b128 v[28:31], v9 offset:16384
  v_mfma_f32_16x16x32_bf16 v[76:79], a[84:87], v[36:39], v[76:79]
  v_mfma_f32_16x16x32_bf16 v[88:91], a[88:91], v[36:39], v[88:91]
  buffer_load_dwordx4 v[196:199], v21, s[4:7], s29 offen offset:1024 sc1
  v_mfma_f32_16x16x32_bf16 v[92:95], a[92:95], v[36:39], v[92:95]
  s_waitcnt lgkmcnt(5)
  v_mfma_f32_16x16x32_bf16 v[64:67], a[96:99], v[40:43], v[64:67]
  ds_read_b128 v[32:35], v10 offset:16384
  v_mfma_f32_16x16x32_bf16 v[68:71], a[100:103], v[40:43], v[68:71]
  v_mfma_f32_16x16x32_bf16 v[80:83], a[104:107], v[40:43], v[80:83]
  v_mfma_f32_16x16x32_bf16 v[84:87], a[108:111], v[40:43], v[84:87]
  s_waitcnt lgkmcnt(5)
  s_waitcnt vmcnt(7)
  v_readfirstlane_b32 s53, v23
  s_add_u32 s52, s52, 2
  s_cmp_ge_u32 s53, s52
  s_cselect_b32 s24, 1, 0
  s_cbranch_scc0 F_nopre_241
  s_mov_b32 m0, s25
  s_nop 0
  buffer_load_dwordx4 v2, s[4:7], s20 offen offset:0 sc1 lds
  buffer_load_dwordx4 v2, s[4:7], s20 offen offset:1024 sc1 lds
  buffer_load_dwordx4 v2, s[4:7], s20 offen offset:2048 sc1 lds
  buffer_load_dwordx4 v2, s[4:7], s20 offen offset:3072 sc1 lds
F_nopre_241:
  v_mfma_f32_16x16x32_bf16 v[72:75], a[96:99], v[44:47], v[72:75]
  ds_read_b128 v[36:39], v11 offset:16384
  v_mfma_f32_16x16x32_bf16 v[76:79], a[100:103], v[44:47], v[76:79]
  v_mfma_f32_16x16x32_bf16 v[88:91], a[104:107], v[44:47], v[88:91]
  buffer_load_dwordx4 v[200:203], v21, s[4:7], s29 offen offset:2048 sc1
  v_mfma_f32_16x16x32_bf16 v[92:95], a[108:111], v[44:47], v[92:95]
  s_waitcnt lgkmcnt(5)
  v_mfma_f32_16x16x32_bf16 v[64:67], a[112:115], v[48:51], v[64:67]
  ds_read_b128 v[40:43], v12 offset:16384
  v_mfma_f32_16x16x32_bf16 v[68:71], a[116:119], v[48:51], v[68:71]
  v_mfma_f32_16x16x32_bf16 v[80:83], a[120:123], v[48:51], v[80:83]
  v_mfma_f32_16x16x32_bf16 v[84:87], a[124:127], v[48:51], v[84:87]
  s_waitcnt lgkmcnt(5)
  v_mfma_f32_16x16x32_bf16 v[72:75], a[112:115], v[52:55], v[72:75]
  ds_read_b128 v[44:47], v13 offset:16384
  v_mfma_f32_16x16x32_bf16 v[76:79], a[116:119], v[52:55], v[76:79]
  v_mfma_f32_16x16x32_bf16 v[88:91], a[120:123], v[52:55], v[88:91]
  buffer_load_dwordx4 v[204:207], v21, s[4:7], s29 offen offset:3072 sc1
  v_mfma_f32_16x16x32_bf16 v[92:95], a[124:127], v[52:55], v[92:95]
  s_waitcnt lgkmcnt(5)
  v_mfma_f32_16x16x32_bf16 v[64:67], a[128:131], v[24:27], v[64:67]
  s_add_u32 s28, s19, 83886080
  ds_read_b128 v[48:51], v14 offset:16384
  v_mfma_f32_16x16x32_bf16 v[68:71], a[132:135], v[24:27], v[68:71]
  v_mfma_f32_16x16x32_bf16 v[80:83], a[136:139], v[24:27], v[80:83]
  v_mfma_f32_16x16x32_bf16 v[84:87], a[140:143], v[24:27], v[84:87]
  s_waitcnt lgkmcnt(5)
  v_mfma_f32_16x16x32_bf16 v[72:75], a[128:131], v[28:31], v[72:75]
  ds_read_b128 v[52:55], v15 offset:16384
  v_mfma_f32_16x16x32_bf16 v[76:79], a[132:135], v[28:31], v[76:79]
  v_mfma_f32_16x16x32_bf16 v[88:91], a[136:139], v[28:31], v[88:91]
  buffer_load_dwordx4 v[208:211], v21, s[4:7], s28 offen offset:0 sc1
  v_mfma_f32_16x16x32_bf16 v[92:95], a[140:143], v[28:31], v[92:95]
  s_waitcnt lgkmcnt(5)
  v_mfma_f32_16x16x32_bf16 v[64:67], a[144:147], v[32:35], v[64:67]
  ds_read_b128 v[24:27], v8 offset:24576
  v_mfma_f32_16x16x32_bf16 v[68:71], a[148:151], v[32:35], v[68:71]
  v_mfma_f32_16x16x32_bf16 v[80:83], a[152:155], v[32:35], v[80:83]
  v_mfma_f32_16x16x32_bf16 v[84:87], a[156:159], v[32:35], v[84:87]
  s_waitcnt lgkmcnt(5)
  v_mfma_f32_16x16x32_bf16 v[72:75], a[144:147], v[36:39], v[72:75]
  ds_read_b128 v[28:31], v9 offset:24576
  v_mfma_f32_16x16x32_bf16 v[76:79], a[148:151], v[36:39], v[76:79]
  v_mfma_f32_16x16x32_bf16 v[88:91], a[152:155], v[36:39], v[88:91]
  buffer_load_dwordx4 v[212:215], v21, s[4:7], s28 offen offset:1024 sc1
  v_mfma_f32_16x16x32_bf16 v[92:95], a[156:159], v[36:39], v[92:95]
  s_waitcnt lgkmcnt(5)
  v_mfma_f32_16x16x32_bf16 v[64:67], a[160:163], v[40:43], v[64:67]
  ds_read_b128 v[32:35], v10 offset:24576
  v_mfma_f32_16x16x32_bf16 v[68:71], a[164:167], v[40:43], v[68:71]
  v_mfma_f32_16x16x32_bf16 v[80:83], a[168:171], v[40:43], v[80:83]
  v_mfma_f32_16x16x32_bf16 v[84:87], a[172:175], v[40:43], v[84:87]
  s_waitcnt lgkmcnt(5)
  v_mfma_f32_16x16x32_bf16 v[72:75], a[160:163], v[44:47], v[72:75]
  ds_read_b128 v[36:39], v11 offset:24576
  v_mfma_f32_16x16x32_bf16 v[76:79], a[164:167], v[44:47], v[76:79]
  v_mfma_f32_16x16x32_bf16 v[88:91], a[168:171], v[44:47], v[88:91]
  buffer_load_dwordx4 v[216:219], v21, s[4:7], s28 offen offset:2048 sc1
  v_mfma_f32_16x16x32_bf16 v[92:95], a[172:175], v[44:47], v[92:95]
  s_waitcnt lgkmcnt(5)
  v_mfma_f32_16x16x32_bf16 v[64:67], a[176:179], v[48:51], v[64:67]
  ds_read_b128 v[40:43], v12 offset:24576
  v_mfma_f32_16x16x32_bf16 v[68:71], a[180:183], v[48:51], v[68:71]
  v_mfma_f32_16x16x32_bf16 v[80:83], a[184:187], v[48:51], v[80:83]
  v_mfma_f32_16x16x32_bf16 v[84:87], a[188:191], v[48:51], v[84:87]
  s_waitcnt lgkmcnt(5)
  s_cmp_lg_u32 s24, 0
  s_cselect_b32 s76, 0, s52
  s_sub_u32 s76, s76, 59
  s_cmp_ge_u32 s76, 6
  s_cbranch_scc1 M_nosp_242
  buffer_load_dword v23, off, s[4:7], s54 sc1
  buffer_load_dwordx4 v[96:99], v2, s[4:7], s20 offen offset:0 sc1
  buffer_load_dwordx4 v[100:103], v2, s[4:7], s20 offen offset:1024 sc1
  buffer_load_dwordx4 v[104:107], v2, s[4:7], s20 offen offset:2048 sc1
  buffer_load_dwordx4 v[108:111], v2, s[4:7], s20 offen offset:3072 sc1
M_nosp_242:
  v_mfma_f32_16x16x32_bf16 v[72:75], a[176:179], v[52:55], v[72:75]
  ds_read_b128 v[44:47], v13 offset:24576
  v_mfma_f32_16x16x32_bf16 v[76:79], a[180:183], v[52:55], v[76:79]
  v_mfma_f32_16x16x32_bf16 v[88:91], a[184:187], v[52:55], v[88:91]
  buffer_load_dwordx4 v[220:223], v21, s[4:7], s28 offen offset:3072 sc1
  v_mfma_f32_16x16x32_bf16 v[92:95], a[188:191], v[52:55], v[92:95]
  s_waitcnt lgkmcnt(5)
  v_mfma_f32_16x16x32_bf16 v[64:67], a[192:195], v[24:27], v[64:67]
  s_add_u32 s29, s19, 83890176
  ds_read_b128 v[48:51], v14 offset:24576
  v_mfma_f32_16x16x32_bf16 v[68:71], a[196:199], v[24:27], v[68:71]
  v_mfma_f32_16x16x32_bf16 v[80:83], a[200:203], v[24:27], v[80:83]
  v_mfma_f32_16x16x32_bf16 v[84:87], a[204:207], v[24:27], v[84:87]
  s_waitcnt lgkmcnt(5)
  v_mfma_f32_16x16x32_bf16 v[72:75], a[192:195], v[28:31], v[72:75]
  ds_read_b128 v[52:55], v15 offset:24576
  v_mfma_f32_16x16x32_bf16 v[76:79], a[196:199], v[28:31], v[76:79]
  v_mfma_f32_16x16x32_bf16 v[88:91], a[200:203], v[28:31], v[88:91]
  buffer_load_dwordx4 v[224:227], v21, s[4:7], s29 offen offset:0 sc1
  v_mfma_f32_16x16x32_bf16 v[92:95], a[204:207], v[28:31], v[92:95]
  s_waitcnt lgkmcnt(5)
  v_mfma_f32_16x16x32_bf16 v[64:67], a[208:211], v[32:35], v[64:67]
  v_mfma_f32_16x16x32_bf16 v[68:71], a[212:215], v[32:35], v[68:71]
  v_mfma_f32_16x16x32_bf16 v[80:83], a[216:219], v[32:35], v[80:83]
  v_mfma_f32_16x16x32_bf16 v[84:87], a[220:223], v[32:35], v[84:87]
  s_waitcnt lgkmcnt(4)
  v_mfma_f32_16x16x32_bf16 v[72:75], a[208:211], v[36:39], v[72:75]
  v_mfma_f32_16x16x32_bf16 v[76:79], a[212:215], v[36:39], v[76:79]
  v_xor_b32 v8, 0x8000, v8
  v_mfma_f32_16x16x32_bf16 v[88:91], a[216:219], v[36:39], v[88:91]
  buffer_load_dwordx4 v[228:231], v21, s[4:7], s29 offen offset:1024 sc1
  v_mfma_f32_16x16x32_bf16 v[92:95], a[220:223], v[36:39], v[92:95]
  s_waitcnt lgkmcnt(3)
  v_xor_b32 v9, 0x8000, v9
  v_mfma_f32_16x16x32_bf16 v[64:67], a[224:227], v[40:43], v[64:67]
  v_mfma_f32_16x16x32_bf16 v[68:71], a[228:231], v[40:43], v[68:71]
  v_xor_b32 v10, 0x8000, v10
  v_mfma_f32_16x16x32_bf16 v[80:83], a[232:235], v[40:43], v[80:83]
  v_mfma_f32_16x16x32_bf16 v[84:87], a[236:239], v[40:43], v[84:87]
  s_waitcnt lgkmcnt(2)
  v_xor_b32 v11, 0x8000, v11
  v_mfma_f32_16x16x32_bf16 v[72:75], a[224:227], v[44:47], v[72:75]
  v_mfma_f32_16x16x32_bf16 v[76:79], a[228:231], v[44:47], v[76:79]
  v_xor_b32 v12, 0x8000, v12
  v_mfma_f32_16x16x32_bf16 v[88:91], a[232:235], v[44:47], v[88:91]
  buffer_load_dwordx4 v[232:235], v21, s[4:7], s29 offen offset:2048 sc1
  v_mfma_f32_16x16x32_bf16 v[92:95], a[236:239], v[44:47], v[92:95]
  s_waitcnt lgkmcnt(1)
  v_xor_b32 v13, 0x8000, v13
  v_mfma_f32_16x16x32_bf16 v[64:67], a[240:243], v[48:51], v[64:67]
  v_mfma_f32_16x16x32_bf16 v[68:71], a[244:247], v[48:51], v[68:71]
  v_xor_b32 v14, 0x8000, v14
  v_mfma_f32_16x16x32_bf16 v[80:83], a[248:251], v[48:51], v[80:83]
  v_mfma_f32_16x16x32_bf16 v[84:87], a[252:255], v[48:51], v[84:87]
  s_waitcnt lgkmcnt(0)
  v_xor_b32 v15, 0x8000, v15
  v_mfma_f32_16x16x32_bf16 v[72:75], a[240:243], v[52:55], v[72:75]
  v_mfma_f32_16x16x32_bf16 v[76:79], a[244:247], v[52:55], v[76:79]
  v_xor_b32 v3, 0x8000, v3
  v_mfma_f32_16x16x32_bf16 v[88:91], a[248:251], v[52:55], v[88:91]
  buffer_load_dwordx4 v[236:239], v21, s[4:7], s29 offen offset:3072 sc1
  v_mfma_f32_16x16x32_bf16 v[92:95], a[252:255], v[52:55], v[92:95]
  s_cmp_gt_u32 s23, 0
  s_cbranch_scc1 F_top_196
  s_nop 2
  v_cvt_pk_bf16_f32 v128, v64, v65
  v_cvt_pk_bf16_f32 v129, v66, v67
  v_cvt_pk_bf16_f32 v130, v68, v69
  v_cvt_pk_bf16_f32 v131, v70, v71
  buffer_store_dwordx4 v[128:131], v22, s[4:7], s21 offen offset:0 sc1
  v_cvt_pk_bf16_f32 v132, v72, v73
  v_cvt_pk_bf16_f32 v133, v74, v75
  v_cvt_pk_bf16_f32 v134, v76, v77
  v_cvt_pk_bf16_f32 v135, v78, v79
  buffer_store_dwordx4 v[132:135], v22, s[4:7], s21 offen offset:256 sc1
  v_cvt_pk_bf16_f32 v136, v80, v81
  v_cvt_pk_bf16_f32 v137, v82, v83
  v_cvt_pk_bf16_f32 v138, v84, v85
  v_cvt_pk_bf16_f32 v139, v86, v87
  buffer_store_dwordx4 v[136:139], v22, s[4:7], s21 offen offset:2048 sc1
  v_cvt_pk_bf16_f32 v140, v88, v89
  v_cvt_pk_bf16_f32 v141, v90, v91
  v_cvt_pk_bf16_f32 v142, v92, v93
  v_cvt_pk_bf16_f32 v143, v94, v95
  buffer_store_dwordx4 v[140:143], v22, s[4:7], s21 offen offset:2304 sc1
  s_waitcnt vmcnt(0) lgkmcnt(0)
  s_barrier
  v_mov_b32 v144, s30
  v_min_u32 v145, 1, v0
  v_lshlrev_b32 v145, 30, v145
  buffer_store_dword v144, v145, s[4:7], s31 offen sc1
M_done:
M_exit:
  s_endpgm
.p2align 6
.type M_table,@object
M_table:
.long 0x1, 0x3f, 0xffffffff, 0x19, 0x1, 0x7, 0x800, 0x0, 0x8, 0x0, 0x0, 0x0, 0x0, 0x0, 0x0, 0x0
.long 0x1, 0x26, 0xffffffff, 0x1d, 0x1, 0x6, 0x1000, 0x0, 0x8, 0x1, 0x0, 0x0, 0x0, 0x0, 0x0, 0x0
.long 0x2, 0x0, 0x2, 0x20, 0x1, 0x5, 0x1800, 0x0, 0x8, 0x0, 0x0, 0x0, 0x0, 0x0, 0x0, 0x0
.long 0x2, 0x1, 0x2, 0x20, 0x1, 0x4, 0x2000, 0x0, 0x8, 0x1, 0x0, 0x0, 0x0, 0x0, 0x0, 0x0
.long 0x0, 0x0, 0x1, 0x20, 0x2, 0x3, 0x20, 0x0, 0x8, 0x2, 0x0, 0x0, 0x0, 0x0, 0x0, 0x0
.long 0x0, 0x3f, 0xffffffff, 0x20, 0x2, 0x2, 0x18, 0x1, 0x10, 0x0, 0x0, 0x0, 0x0, 0x0, 0x0, 0x0
.long 0x1, 0x9, 0xffffffff, 0xa, 0x0, 0x0, 0x8, 0x0, 0x8, 0x2, 0x0, 0x0, 0x0, 0x0, 0x0, 0x0
.size M_table, 448
.section .rodata,"a"
.p2align 6
.amdhsa_kernel gated_mix__compressed_kv_cla__memory_aug_recurrent_mem_tr__prompt_kernel
.amdhsa_next_free_vgpr 512
.amdhsa_next_free_sgpr 102
.amdhsa_accum_offset 256
.amdhsa_group_segment_fixed_size 0
.amdhsa_kernarg_size 136
.amdhsa_user_sgpr_count 2
.amdhsa_user_sgpr_kernarg_segment_ptr 1
.amdhsa_system_sgpr_workgroup_id_x 1
.end_amdhsa_kernel
```
